```python
import torch

def _softmax(x, axis=-1):
    return torch.softmax(x, dim=axis)
def _gelu(x):
    return torch.nn.functional.gelu(x, approximate="tanh")
def _silu(x):
    return torch.nn.functional.silu(x)
def _sigmoid(x):
    return torch.sigmoid(x)
def _layernorm(x, axis=-1, eps=1e-5):
    m = x.mean(dim=axis, keepdim=True)
    v = x.var(dim=axis, keepdim=True, unbiased=False)
    return (x - m) / torch.sqrt(v + eps)
def _scatter_add(tgt, idx, src, axis=0):
    return tgt.clone().index_add_(axis, idx, src)
def _segment_sum(src, seg, n):
    out = torch.zeros((n,) + src.shape[1:], dtype=src.dtype)
    return out.index_add_(0, seg, src)
def _pad(x, pw):
    flat = tuple(v for pair in reversed(pw) for v in pair)
    return torch.nn.functional.pad(x, flat)

kernel_name = 'concat_heads__sliding_local_dilated__compressed_kv_cla__prompt'

def setup_inputs():

    _w = (lambda a: (lambda t: t.to(torch.bfloat16) if t.is_floating_point() else t)(torch.as_tensor(a)))
    def _A_setup():
        B, S, D = 1, 2048, 1024
        return {
            "x": _w((lambda *s: torch.randn(*s, dtype=torch.bfloat16) * 0.2)(B, S, D)),
            "wqkv": _w((lambda *s: torch.randn(*s, dtype=torch.bfloat16) * 0.2)(D, 3 * D)),
            "wo": _w((lambda *s: torch.randn(*s, dtype=torch.bfloat16) * 0.05)(D, D)),
        }
    _A_in = _A_setup()

    def _B_setup():
        B, H, Sq, Sk, D, M = 1, 32, 2048, 2048, 128, 1024
        Dc = 4 * D
        return {
            "x": _w((lambda *s: torch.randn(*s, dtype=torch.bfloat16) * 0.2)(B, Sq, M)),
            "c_kv": _w((lambda *s: torch.randn(*s, dtype=torch.bfloat16) * 1.6)(B, Sk, Dc)),
            "w_q": _w((lambda *s: torch.randn(*s, dtype=torch.bfloat16) * 3.2)(M, H, D) * (M ** -0.5)),
            "w_uk": _w((lambda *s: torch.randn(*s, dtype=torch.bfloat16) * 3.2)(Dc, H, D) * (Dc ** -0.5)),
            "w_uv": _w((lambda *s: torch.randn(*s, dtype=torch.bfloat16) * 1.6)(Dc, H, D) * (Dc ** -0.5)),
            "w_o": _w((lambda *s: torch.randn(*s, dtype=torch.bfloat16) * 1.6)(H, D, M) * ((H * D) ** -0.5)),
        }
    _B_in = _B_setup()

    return {
        "A_x": _A_in["x"],
        "A_wqkv": _A_in["wqkv"],
        "A_wo": _A_in["wo"],
        "B_x": _B_in["x"],
        "B_c_kv": _B_in["c_kv"],
        "B_w_q": _B_in["w_q"],
        "B_w_uk": _B_in["w_uk"],
        "B_w_uv": _B_in["w_uv"],
        "B_w_o": _B_in["w_o"],
    }

def reference(A_x, A_wqkv, A_wo, B_x, B_c_kv, B_w_q, B_w_uk, B_w_uv, B_w_o):
    def _A_ref(x, wqkv, wo):
        B, S, D = x.shape
        H = 32; Dh = D // H
        W, dil = 8, 2
        qkv = (lambda x, *d: x.permute(*d))((x @ wqkv).reshape(B, S, 3, H, Dh), 2, 0, 3, 1, 4)
        q, k, v = qkv[0], qkv[1], qkv[2]
        scale = Dh ** -0.5
        pos = torch.arange(S)
        off = torch.arange(W) * dil
        idx = pos[:, None] - off[None, :]
        mask = idx >= 0
        idx_c = torch.where(mask, idx, 0).reshape(-1)
        kg = k[:, :, idx_c, :].reshape(B, H, S, W, Dh)
        vg = v[:, :, idx_c, :].reshape(B, H, S, W, Dh)
        logits = torch.einsum("bhsd,bhswd->bhsw", q, kg) * scale
        logits = torch.where(mask[None, None, :, :], logits, -1e9)
        attn = _softmax(logits, axis=-1)
        o = torch.einsum("bhsw,bhswd->bhsd", attn, vg)
        return (lambda x, *d: x.permute(*d))(o, 0, 2, 1, 3).reshape(B, S, D) @ wo

    def _B_ref(x, c_kv, w_q, w_uk, w_uv, w_o):
        B, Sq, M = x.shape[0], x.shape[1], x.shape[2]
        Sk = c_kv.shape[1]
        H, D = w_q.shape[1], w_q.shape[2]
        q = torch.einsum("bqm,mhd->bhqd", x, w_q)
        k = torch.einsum("bkc,chd->bhkd", c_kv, w_uk)
        v = torch.einsum("bkc,chd->bhkd", c_kv, w_uv)
        scores = torch.einsum("bhqd,bhkd->bhqk", q, k) * (D ** -0.5)
        off = Sk - Sq
        qi = torch.arange(Sq)[:, None]
        kj = torch.arange(Sk)[None, :]
        cmask = kj <= (qi + off)
        scores = torch.where(cmask[None, None], scores, -1e9)
        p = _softmax(scores, axis=-1)
        ctx = torch.einsum("bhqk,bhkd->bhqd", p, v)
        return torch.einsum("bhqd,hdm->bqm", ctx, w_o)

    a = _A_ref(A_x, A_wqkv, A_wo)
    b = _B_ref(B_x, B_c_kv, B_w_q, B_w_uk, B_w_uv, B_w_o)
    return torch.concatenate([a, b], axis=-1)
```

```asm
; @launch kernel=gemm1_kernel grid=(256,1,1) block=(256,1,1) lds=163840
; @launch kernel=attn_kernel grid=(256,1,1) block=(256,1,1) lds=131072
; @launch kernel=gemm3_kernel grid=(256,1,1) block=(256,1,1) lds=163840
.amdgcn_target "amdgcn-amd-amdhsa--gfx950"
.text
.globl gemm1_kernel
.p2align 8
.type gemm1_kernel,@function
gemm1_kernel:
    s_cmp_ge_u32 s2, 256
    s_cbranch_scc1 gemm1_kernel_end1
    s_load_dwordx16 s[4:19], s[0:1], 0
    s_load_dwordx2 s[20:21], s[0:1], 88
    v_and_b32 v1, 63, v0
    v_lshrrev_b32 v20, 6, v0
    s_nop 0
    v_readfirstlane_b32 s45, v20
    s_and_b32 s54, s2, 7
    s_lshr_b32 s62, s2, 3
    s_lshr_b32 s60, s54, 1
    s_and_b32 s54, s54, 1
    s_lshl_b32 s54, s54, 2
    s_and_b32 s59, s62, 3
    s_add_u32 s59, s59, s54
    s_lshr_b32 s61, s62, 2
    s_lshr_b32 s46, s45, 1
    s_and_b32 s47, s45, 1
    s_mov_b32 s27, 0x20000
    s_mov_b32 s31, 0x20000
    v_and_b32 v20, 15, v1
    v_lshrrev_b32 v21, 4, v1
    v_bfe_u32 v22, v1, 1, 3
    v_xor_b32 v22, v22, v21
    s_lshl_b32 s54, s46, 14
    v_lshlrev_b32 v23, 7, v20
    v_add_u32 v23, s54, v23
    v_xor_b32 v24, 0, v22
    v_lshl_add_u32 v2, v24, 4, v23
    v_xor_b32 v24, 4, v22
    v_lshl_add_u32 v3, v24, 4, v23
    v_bfe_u32 v22, v1, 2, 2
    v_lshl_add_u32 v23, v21, 3, v22
    v_lshlrev_b32 v23, 9, v23
    v_and_b32 v24, 3, v1
    v_lshlrev_b32 v24, 3, v24
    v_add_u32 v23, v23, v24
    s_lshl_b32 s54, s47, 8
    s_add_u32 s54, s54, 98304
    v_add_u32 v23, s54, v23
    v_bfe_u32 v22, v1, 2, 3
    v_xor_b32 v24, 0, v22
    v_lshl_add_u32 v4, v24, 5, v23
    v_xor_b32 v24, 1, v22
    v_lshl_add_u32 v5, v24, 5, v23
    v_xor_b32 v24, 2, v22
    v_lshl_add_u32 v6, v24, 5, v23
    v_xor_b32 v24, 3, v22
    v_lshl_add_u32 v7, v24, 5, v23
    v_xor_b32 v24, 4, v22
    v_lshl_add_u32 v8, v24, 5, v23
    v_xor_b32 v24, 5, v22
    v_lshl_add_u32 v9, v24, 5, v23
    v_xor_b32 v24, 6, v22
    v_lshl_add_u32 v10, v24, 5, v23
    v_xor_b32 v24, 7, v22
    v_lshl_add_u32 v11, v24, 5, v23
    v_lshlrev_b32 v18, 4, v1
    s_lshl_b32 s48, s45, 13
    s_add_u32 s49, s48, 98304
    s_mov_b32 s51, 0
    s_mov_b32 s22, 32768
    s_mov_b32 s23, 229376
    s_mul_i32 s54, s60, 7
    s_add_u32 s54, s54, s61
    s_sub_u32 s55, s54, 12
    s_cmp_lt_u32 s54, 12
    s_mov_b32 s56, 8388608
    s_cselect_b32 s68, 6291456, s56
    s_mov_b32 s56, 8192
    s_cselect_b32 s70, 6144, s56
    s_cselect_b32 s73, 1, 0
    s_cselect_b32 s54, s54, s55
    s_mov_b32 s65, 4194304
    s_mov_b32 s69, 2048
    s_mov_b32 s74, 16
    s_lshl_b32 s72, s54, 9
    s_lshl_b32 s71, s59, 19
    s_cmp_eq_u32 s73, 0
    s_cbranch_scc1 gemm1_kernel_lb2
    s_lshr_b32 s55, s54, 2
    s_cmp_eq_u32 s55, 0
    s_cselect_b32 s76, 1048744942, 0
    s_lshl_b32 s56, s55, 22
    s_add_u32 s77, s56, 50331648
    s_and_b32 s56, s54, 3
    s_lshl_b32 s56, s56, 1
    s_add_u32 s56, s56, s47
    s_lshl_b32 s56, s56, 19
    s_add_u32 s77, s77, s56
    s_lshl_b32 s56, s46, 3
    s_add_u32 s56, s56, s59
    s_cmp_eq_u32 s55, 2
    s_cbranch_scc1 gemm1_kernel_lv4
    s_lshl_b32 s56, s56, 13
    s_add_u32 s77, s77, s56
    s_mov_b32 s75, 0
    s_mov_b32 s78, 131072
    s_mov_b32 s79, 1024
    s_branch gemm1_kernel_ld3
gemm1_kernel_lv4:
    s_lshl_b32 s56, s56, 12
    s_add_u32 s77, s77, s56
    s_mov_b32 s75, 1
    s_mov_b32 s78, 1024
    s_mov_b32 s79, 65536
    s_branch gemm1_kernel_ld3
gemm1_kernel_lb2:
    s_mov_b32 s75, 0
    s_mov_b32 s76, 1040356334
    s_lshl_b32 s55, s54, 1
    s_add_u32 s55, s55, s47
    s_lshl_b32 s55, s55, 19
    s_lshl_b32 s56, s59, 1
    s_add_u32 s56, s56, s46
    s_lshl_b32 s56, s56, 15
    s_add_u32 s77, s55, s56
    s_add_u32 s77, s77, 0
    s_mov_b32 s78, 1024
    s_mov_b32 s79, 4096
gemm1_kernel_ld3:
    s_lshl_b32 s54, s60, 3
    s_add_u32 s54, s54, s61
    s_cmp_lt_u32 s54, 16
    s_cselect_b32 s92, 0, 1
    s_mov_b32 s55, 33554432
    s_cselect_b32 s94, 16777216, s55
    s_mov_b32 s55, 8192
    s_cselect_b32 s95, 1024, s55
    s_mov_b32 s55, 1024
    s_cselect_b32 s96, 4096, s55
    s_mov_b32 s82, 2097152
    s_mov_b32 s86, 1024
    s_mov_b32 s91, 8
    s_mov_b32 s90, 0
    s_mov_b32 s85, 4194304
    s_mov_b32 s87, 8192
    s_mov_b32 s93, 0
    s_and_b32 s54, s54, 15
    s_lshl_b32 s89, s54, 9
    s_lshl_b32 s88, s59, 18
    s_lshl_b32 s55, s54, 1
    s_add_u32 s55, s55, s47
    s_lshl_b32 s55, s55, 19
    s_lshl_b32 s56, s59, 1
    s_add_u32 s56, s56, s46
    s_lshl_b32 s56, s56, 15
    s_add_u32 s94, s94, s55
    s_add_u32 s94, s94, s56
    s_mov_b32 s58, 1
    s_cmp_lt_u32 s62, 28
    s_cbranch_scc1 gemm1_kernel_haslong5
    s_mov_b32 s65, s82
    s_mov_b32 s68, s85
    s_mov_b32 s69, s86
    s_mov_b32 s70, s87
    s_mov_b32 s71, s88
    s_mov_b32 s72, s89
    s_mov_b32 s73, s90
    s_mov_b32 s74, s91
    s_mov_b32 s75, s92
    s_mov_b32 s76, s93
    s_mov_b32 s77, s94
    s_mov_b32 s78, s95
    s_mov_b32 s79, s96
    s_mov_b32 s58, 0
gemm1_kernel_haslong5:
    s_mov_b32 s26, s65
    s_mov_b32 s30, s68
    s_lshl_b32 s54, s69, 4
    s_lshl_b32 s54, s54, s73
    s_mov_b32 s36, s71
    s_mul_i32 s55, s54, 1
    s_add_u32 s37, s55, s71
    s_sub_u32 s37, s37, 2048
    s_mul_i32 s55, s54, 2
    s_add_u32 s38, s55, s71
    s_mul_i32 s55, s54, 3
    s_add_u32 s39, s55, s71
    s_sub_u32 s39, s39, 2048
    s_mov_b32 s40, s72
    s_lshl_b32 s54, s70, 2
    s_mul_i32 s55, s54, 1
    s_add_u32 s41, s55, s72
    s_sub_u32 s41, s41, 2048
    s_mul_i32 s55, s54, 2
    s_add_u32 s42, s55, s72
    s_mul_i32 s55, s54, 3
    s_add_u32 s43, s55, s72
    s_sub_u32 s43, s43, 2048
    s_lshl_b32 s44, s70, 6
    s_lshl_b32 s54, s47, 7
    s_add_u32 s54, s54, s46
    s_lshl_b32 s55, s45, 6
    s_cmp_eq_u32 s73, 1
    s_cselect_b32 s54, s54, s55
    v_lshrrev_b32 v20, 3, v1
    v_lshlrev_b32 v20, s73, v20
    v_add_u32 v20, s54, v20
    v_mul_lo_u32 v20, v20, s69
    v_lshrrev_b32 v21, 4, v1
    v_and_b32 v22, 7, v1
    v_xor_b32 v21, v21, v22
    v_lshl_add_u32 v12, v21, 4, v20
    v_xor_b32 v21, 4, v21
    v_lshl_add_u32 v13, v21, 4, v20
    s_lshl_b32 s54, s69, 3
    s_lshl_b32 s54, s54, s73
    s_sub_u32 s54, s54, 1024
    v_add_u32 v13, s54, v13
    v_lshrrev_b32 v20, 5, v1
    s_lshl_b32 s54, s45, 4
    v_add_u32 v21, s54, v20
    v_mul_lo_u32 v21, v21, s70
    v_lshlrev_b32 v20, 1, v20
    v_and_b32 v22, 31, v1
    v_xor_b32 v20, v20, v22
    s_lshl_b32 s54, s70, 1
    s_sub_u32 s54, s54, 1024
    v_add_u32 v23, s54, v21
    v_xor_b32 v22, 0, v20
    v_lshl_add_u32 v14, v22, 4, v21
    v_xor_b32 v22, 4, v20
    v_lshl_add_u32 v15, v22, 4, v23
    v_xor_b32 v22, 8, v20
    v_lshl_add_u32 v16, v22, 4, v21
    v_xor_b32 v22, 12, v20
    v_lshl_add_u32 v17, v22, 4, v23
    s_waitcnt lgkmcnt(0)
    s_cmp_eq_u32 s73, 1
    s_cselect_b32 s63, s4, s10
    s_cselect_b32 s64, s5, s11
    s_cselect_b32 s66, s6, s14
    s_cselect_b32 s67, s7, s15
    s_cmp_eq_u32 s92, 0
    s_cselect_b32 s83, s16, s18
    s_cselect_b32 s84, s17, s19
    s_mov_b32 s80, s12
    s_mov_b32 s81, s13
    s_cmp_lt_u32 s62, 28
    s_cbranch_scc1 gemm1_kernel_hl26
    s_mov_b32 s63, s80
    s_mov_b32 s64, s81
    s_mov_b32 s66, s83
    s_mov_b32 s67, s84
gemm1_kernel_hl26:
    s_mov_b32 s24, s63
    s_mov_b32 s25, s64
    s_mov_b32 s28, s66
    s_mov_b32 s29, s67
    s_mov_b32 s32, s20
    s_mov_b32 s33, s21
    s_mov_b32 s34, 268435456
    s_mov_b32 s35, 0x20000
    s_add_u32 m0, s48, 0
    s_nop 0
    buffer_load_dwordx4 v12, s[24:27], s36 offen offset:0 lds
    buffer_load_dwordx4 v13, s[24:27], s36 offen offset:1024 lds
    s_add_u32 s36, s36, 128
    buffer_load_dwordx4 v12, s[24:27], s37 offen offset:2048 lds
    buffer_load_dwordx4 v13, s[24:27], s37 offen offset:3072 lds
    s_add_u32 s37, s37, 128
    s_add_u32 m0, s48, 4096
    s_nop 0
    buffer_load_dwordx4 v12, s[24:27], s38 offen offset:0 lds
    buffer_load_dwordx4 v13, s[24:27], s38 offen offset:1024 lds
    s_add_u32 s38, s38, 128
    buffer_load_dwordx4 v12, s[24:27], s39 offen offset:2048 lds
    buffer_load_dwordx4 v13, s[24:27], s39 offen offset:3072 lds
    s_add_u32 s39, s39, 128
    s_add_u32 s48, s48, 32768
    s_cmp_ge_u32 s48, 98304
    s_cselect_b32 s54, 98304, 0
    s_sub_u32 s48, s48, s54
    s_add_u32 m0, s49, 0
    s_nop 0
    buffer_load_dwordx4 v14, s[28:31], s40 offen offset:0 lds
    buffer_load_dwordx4 v15, s[28:31], s40 offen offset:1024 lds
    s_add_u32 s40, s40, s44
    buffer_load_dwordx4 v14, s[28:31], s41 offen offset:2048 lds
    buffer_load_dwordx4 v15, s[28:31], s41 offen offset:3072 lds
    s_add_u32 s41, s41, s44
    s_add_u32 m0, s49, 4096
    s_nop 0
    buffer_load_dwordx4 v16, s[28:31], s42 offen offset:0 lds
    buffer_load_dwordx4 v17, s[28:31], s42 offen offset:1024 lds
    s_add_u32 s42, s42, s44
    buffer_load_dwordx4 v16, s[28:31], s43 offen offset:2048 lds
    buffer_load_dwordx4 v17, s[28:31], s43 offen offset:3072 lds
    s_add_u32 s43, s43, s44
    s_xor_b32 s49, s49, 229376
    s_add_u32 m0, s48, 0
    s_nop 0
    buffer_load_dwordx4 v12, s[24:27], s36 offen offset:0 lds
    buffer_load_dwordx4 v13, s[24:27], s36 offen offset:1024 lds
    s_add_u32 s36, s36, 128
    buffer_load_dwordx4 v12, s[24:27], s37 offen offset:2048 lds
    buffer_load_dwordx4 v13, s[24:27], s37 offen offset:3072 lds
    s_add_u32 s37, s37, 128
    s_add_u32 m0, s48, 4096
    s_nop 0
    buffer_load_dwordx4 v12, s[24:27], s38 offen offset:0 lds
    buffer_load_dwordx4 v13, s[24:27], s38 offen offset:1024 lds
    s_add_u32 s38, s38, 128
    buffer_load_dwordx4 v12, s[24:27], s39 offen offset:2048 lds
    buffer_load_dwordx4 v13, s[24:27], s39 offen offset:3072 lds
    s_add_u32 s39, s39, 128
    s_add_u32 s48, s48, 32768
    s_cmp_ge_u32 s48, 98304
    s_cselect_b32 s54, 98304, 0
    s_sub_u32 s48, s48, s54
    s_add_u32 m0, s49, 0
    s_nop 0
    buffer_load_dwordx4 v14, s[28:31], s40 offen offset:0 lds
    buffer_load_dwordx4 v15, s[28:31], s40 offen offset:1024 lds
    s_add_u32 s40, s40, s44
    buffer_load_dwordx4 v14, s[28:31], s41 offen offset:2048 lds
    buffer_load_dwordx4 v15, s[28:31], s41 offen offset:3072 lds
    s_add_u32 s41, s41, s44
    s_add_u32 m0, s49, 4096
    s_nop 0
    buffer_load_dwordx4 v16, s[28:31], s42 offen offset:0 lds
    buffer_load_dwordx4 v17, s[28:31], s42 offen offset:1024 lds
    s_add_u32 s42, s42, s44
    buffer_load_dwordx4 v16, s[28:31], s43 offen offset:2048 lds
    buffer_load_dwordx4 v17, s[28:31], s43 offen offset:3072 lds
    s_add_u32 s43, s43, s44
    s_xor_b32 s49, s49, 229376
    s_waitcnt vmcnt(16)
    s_barrier
    ds_read_b64_tr_b16 a[64:65], v4 offset:0
    ds_read_b64_tr_b16 a[66:67], v4 offset:2048
    ds_read_b128 a[0:3], v2 offset:0
    ds_read_b128 a[4:7], v2 offset:2048
    ds_read_b64_tr_b16 a[68:69], v5 offset:0
    ds_read_b64_tr_b16 a[70:71], v5 offset:2048
    ds_read_b128 a[8:11], v2 offset:4096
    ds_read_b128 a[12:15], v2 offset:6144
    ds_read_b64_tr_b16 a[72:73], v6 offset:0
    ds_read_b64_tr_b16 a[74:75], v6 offset:2048
    ds_read_b128 a[16:19], v2 offset:8192
    ds_read_b128 a[20:23], v2 offset:10240
    ds_read_b64_tr_b16 a[76:77], v7 offset:0
    ds_read_b64_tr_b16 a[78:79], v7 offset:2048
    ds_read_b128 a[24:27], v2 offset:12288
    ds_read_b128 a[28:31], v2 offset:14336
    ds_read_b64_tr_b16 a[80:81], v8 offset:0
    ds_read_b64_tr_b16 a[82:83], v8 offset:2048
    ds_read_b64_tr_b16 a[84:85], v9 offset:0
    ds_read_b64_tr_b16 a[86:87], v9 offset:2048
    ds_read_b64_tr_b16 a[88:89], v10 offset:0
    ds_read_b64_tr_b16 a[90:91], v10 offset:2048
    ds_read_b64_tr_b16 a[92:93], v11 offset:0
    ds_read_b64_tr_b16 a[94:95], v11 offset:2048
    s_mov_b32 s53, 1
gemm1_kernel_tile7:
    s_sub_u32 s52, s74, 1
    s_cmp_eq_u32 s75, 1
    s_cbranch_scc1 gemm1_kernel_swp9
    s_waitcnt lgkmcnt(15)
    v_mfma_f32_16x16x32_bf16 v[32:35], a[64:67], a[0:3], 0
    v_mfma_f32_16x16x32_bf16 v[40:43], a[64:67], a[4:7], 0
    v_mfma_f32_16x16x32_bf16 v[48:51], a[64:67], a[8:11], 0
    v_mfma_f32_16x16x32_bf16 v[56:59], a[64:67], a[12:15], 0
    s_waitcnt lgkmcnt(13)
    v_mfma_f32_16x16x32_bf16 v[64:67], a[64:67], a[16:19], 0
    s_add_u32 m0, s48, 0
    s_nop 0
    buffer_load_dwordx4 v12, s[24:27], s36 offen offset:0 lds
    s_waitcnt lgkmcnt(12)
    v_mfma_f32_16x16x32_bf16 v[72:75], a[64:67], a[20:23], 0
    s_waitcnt lgkmcnt(9)
    v_mfma_f32_16x16x32_bf16 v[80:83], a[64:67], a[24:27], 0
    s_waitcnt lgkmcnt(8)
    v_mfma_f32_16x16x32_bf16 v[88:91], a[64:67], a[28:31], 0
    ds_read_b64_tr_b16 a[64:65], v4 offset:16384
    v_mfma_f32_16x16x32_bf16 v[36:39], a[68:71], a[0:3], 0
    ds_read_b64_tr_b16 a[66:67], v4 offset:18432
    v_mfma_f32_16x16x32_bf16 v[44:47], a[68:71], a[4:7], 0
    v_mfma_f32_16x16x32_bf16 v[52:55], a[68:71], a[8:11], 0
    ds_read_b128 a[32:35], v3 offset:0
    v_mfma_f32_16x16x32_bf16 v[60:63], a[68:71], a[12:15], 0
    buffer_load_dwordx4 v13, s[24:27], s36 offen offset:1024 lds
    s_add_u32 s36, s36, 128
    v_mfma_f32_16x16x32_bf16 v[68:71], a[68:71], a[16:19], 0
    v_mfma_f32_16x16x32_bf16 v[76:79], a[68:71], a[20:23], 0
    v_mfma_f32_16x16x32_bf16 v[84:87], a[68:71], a[24:27], 0
    ds_read_b128 a[36:39], v3 offset:2048
    v_mfma_f32_16x16x32_bf16 v[92:95], a[68:71], a[28:31], 0
    ds_read_b64_tr_b16 a[68:69], v5 offset:16384
    v_mfma_f32_16x16x32_bf16 v[96:99], a[72:75], a[0:3], 0
    ds_read_b64_tr_b16 a[70:71], v5 offset:18432
    v_mfma_f32_16x16x32_bf16 v[104:107], a[72:75], a[4:7], 0
    buffer_load_dwordx4 v12, s[24:27], s37 offen offset:2048 lds
    v_mfma_f32_16x16x32_bf16 v[112:115], a[72:75], a[8:11], 0
    ds_read_b128 a[40:43], v3 offset:4096
    v_mfma_f32_16x16x32_bf16 v[120:123], a[72:75], a[12:15], 0
    v_mfma_f32_16x16x32_bf16 v[128:131], a[72:75], a[16:19], 0
    v_mfma_f32_16x16x32_bf16 v[136:139], a[72:75], a[20:23], 0
    v_mfma_f32_16x16x32_bf16 v[144:147], a[72:75], a[24:27], 0
    ds_read_b128 a[44:47], v3 offset:6144
    v_mfma_f32_16x16x32_bf16 v[152:155], a[72:75], a[28:31], 0
    ds_read_b64_tr_b16 a[72:73], v6 offset:16384
    buffer_load_dwordx4 v13, s[24:27], s37 offen offset:3072 lds
    s_add_u32 s37, s37, 128
    v_mfma_f32_16x16x32_bf16 v[100:103], a[76:79], a[0:3], 0
    ds_read_b64_tr_b16 a[74:75], v6 offset:18432
    v_mfma_f32_16x16x32_bf16 v[108:111], a[76:79], a[4:7], 0
    v_mfma_f32_16x16x32_bf16 v[116:119], a[76:79], a[8:11], 0
    ds_read_b128 a[48:51], v3 offset:8192
    v_mfma_f32_16x16x32_bf16 v[124:127], a[76:79], a[12:15], 0
    v_mfma_f32_16x16x32_bf16 v[132:135], a[76:79], a[16:19], 0
    s_add_u32 m0, s48, 4096
    s_nop 0
    buffer_load_dwordx4 v12, s[24:27], s38 offen offset:0 lds
    v_mfma_f32_16x16x32_bf16 v[140:143], a[76:79], a[20:23], 0
    v_mfma_f32_16x16x32_bf16 v[148:151], a[76:79], a[24:27], 0
    ds_read_b128 a[52:55], v3 offset:10240
    v_mfma_f32_16x16x32_bf16 v[156:159], a[76:79], a[28:31], 0
    ds_read_b64_tr_b16 a[76:77], v7 offset:16384
    s_waitcnt lgkmcnt(15)
    v_mfma_f32_16x16x32_bf16 v[160:163], a[80:83], a[0:3], 0
    ds_read_b64_tr_b16 a[78:79], v7 offset:18432
    v_mfma_f32_16x16x32_bf16 v[168:171], a[80:83], a[4:7], 0
    v_mfma_f32_16x16x32_bf16 v[176:179], a[80:83], a[8:11], 0
    ds_read_b128 a[56:59], v3 offset:12288
    v_mfma_f32_16x16x32_bf16 v[184:187], a[80:83], a[12:15], 0
    buffer_load_dwordx4 v13, s[24:27], s38 offen offset:1024 lds
    s_add_u32 s38, s38, 128
    v_mfma_f32_16x16x32_bf16 v[192:195], a[80:83], a[16:19], 0
    v_mfma_f32_16x16x32_bf16 v[200:203], a[80:83], a[20:23], 0
    v_mfma_f32_16x16x32_bf16 v[208:211], a[80:83], a[24:27], 0
    ds_read_b128 a[60:63], v3 offset:14336
    v_mfma_f32_16x16x32_bf16 v[216:219], a[80:83], a[28:31], 0
    ds_read_b64_tr_b16 a[80:81], v8 offset:16384
    v_mfma_f32_16x16x32_bf16 v[164:167], a[84:87], a[0:3], 0
    ds_read_b64_tr_b16 a[82:83], v8 offset:18432
    v_mfma_f32_16x16x32_bf16 v[172:175], a[84:87], a[4:7], 0
    buffer_load_dwordx4 v12, s[24:27], s39 offen offset:2048 lds
    v_mfma_f32_16x16x32_bf16 v[180:183], a[84:87], a[8:11], 0
    v_mfma_f32_16x16x32_bf16 v[188:191], a[84:87], a[12:15], 0
    v_mfma_f32_16x16x32_bf16 v[196:199], a[84:87], a[16:19], 0
    v_mfma_f32_16x16x32_bf16 v[204:207], a[84:87], a[20:23], 0
    v_mfma_f32_16x16x32_bf16 v[212:215], a[84:87], a[24:27], 0
    buffer_load_dwordx4 v13, s[24:27], s39 offen offset:3072 lds
    s_add_u32 s39, s39, 128
    v_mfma_f32_16x16x32_bf16 v[220:223], a[84:87], a[28:31], 0
    ds_read_b64_tr_b16 a[84:85], v9 offset:16384
    v_mfma_f32_16x16x32_bf16 v[224:227], a[88:91], a[0:3], 0
    ds_read_b64_tr_b16 a[86:87], v9 offset:18432
    v_mfma_f32_16x16x32_bf16 v[232:235], a[88:91], a[4:7], 0
    v_mfma_f32_16x16x32_bf16 v[240:243], a[88:91], a[8:11], 0
    v_mfma_f32_16x16x32_bf16 v[248:251], a[88:91], a[12:15], 0
    v_mfma_f32_16x16x32_bf16 a[96:99], a[88:91], a[16:19], 0
    v_mfma_f32_16x16x32_bf16 a[104:107], a[88:91], a[20:23], 0
    s_add_u32 s48, s48, 32768
    s_cmp_ge_u32 s48, 98304
    s_cselect_b32 s54, 98304, 0
    s_sub_u32 s48, s48, s54
    v_mfma_f32_16x16x32_bf16 a[112:115], a[88:91], a[24:27], 0
    v_mfma_f32_16x16x32_bf16 a[120:123], a[88:91], a[28:31], 0
    ds_read_b64_tr_b16 a[88:89], v10 offset:16384
    s_waitcnt lgkmcnt(15)
    v_mfma_f32_16x16x32_bf16 v[228:231], a[92:95], a[0:3], 0
    ds_read_b64_tr_b16 a[90:91], v10 offset:18432
    v_mfma_f32_16x16x32_bf16 v[236:239], a[92:95], a[4:7], 0
    s_add_u32 s51, s51, 32768
    s_cmp_ge_u32 s51, 98304
    s_cselect_b32 s50, 4294901760, s22
    s_cselect_b32 s51, 0, s51
    v_mfma_f32_16x16x32_bf16 v[244:247], a[92:95], a[8:11], 0
    v_add_u32 v2, s50, v2
    v_mfma_f32_16x16x32_bf16 v[252:255], a[92:95], a[12:15], 0
    v_add_u32 v3, s50, v3
    v_mfma_f32_16x16x32_bf16 a[100:103], a[92:95], a[16:19], 0
    v_mfma_f32_16x16x32_bf16 a[108:111], a[92:95], a[20:23], 0
    v_mfma_f32_16x16x32_bf16 a[116:119], a[92:95], a[24:27], 0
    v_mfma_f32_16x16x32_bf16 a[124:127], a[92:95], a[28:31], 0
    ds_read_b64_tr_b16 a[92:93], v11 offset:16384
    ds_read_b64_tr_b16 a[94:95], v11 offset:18432
    v_mfma_f32_16x16x32_bf16 v[32:35], a[64:67], a[32:35], v[32:35]
    v_xor_b32 v4, s23, v4
    v_mfma_f32_16x16x32_bf16 v[40:43], a[64:67], a[36:39], v[40:43]
    v_xor_b32 v5, s23, v5
    s_waitcnt lgkmcnt(15)
    v_mfma_f32_16x16x32_bf16 v[48:51], a[64:67], a[40:43], v[48:51]
    v_xor_b32 v6, s23, v6
    v_mfma_f32_16x16x32_bf16 v[56:59], a[64:67], a[44:47], v[56:59]
    v_xor_b32 v7, s23, v7
    s_waitcnt lgkmcnt(13)
    v_mfma_f32_16x16x32_bf16 v[64:67], a[64:67], a[48:51], v[64:67]
    v_xor_b32 v8, s23, v8
    s_waitcnt lgkmcnt(12)
    v_mfma_f32_16x16x32_bf16 v[72:75], a[64:67], a[52:55], v[72:75]
    v_xor_b32 v9, s23, v9
    s_waitcnt lgkmcnt(9)
    v_mfma_f32_16x16x32_bf16 v[80:83], a[64:67], a[56:59], v[80:83]
    v_xor_b32 v10, s23, v10
    v_xor_b32 v11, s23, v11
    s_waitcnt lgkmcnt(8)
    s_waitcnt lgkmcnt(0)
    s_waitcnt vmcnt(40)
    s_cmp_eq_u32 s53, 0
    s_cbranch_scc1 gemm1_kernel_w10
    s_waitcnt vmcnt(8)
gemm1_kernel_w10:
    v_mfma_f32_16x16x32_bf16 v[88:91], a[64:67], a[60:63], v[88:91]
    s_barrier
    ds_read_b64_tr_b16 a[64:65], v4 offset:0
    v_mfma_f32_16x16x32_bf16 v[36:39], a[68:71], a[32:35], v[36:39]
    ds_read_b64_tr_b16 a[66:67], v4 offset:2048
    v_mfma_f32_16x16x32_bf16 v[44:47], a[68:71], a[36:39], v[44:47]
    s_add_u32 m0, s49, 0
    s_nop 0
    buffer_load_dwordx4 v14, s[28:31], s40 offen offset:0 lds
    v_mfma_f32_16x16x32_bf16 v[52:55], a[68:71], a[40:43], v[52:55]
    ds_read_b128 a[0:3], v2 offset:0
    v_mfma_f32_16x16x32_bf16 v[60:63], a[68:71], a[44:47], v[60:63]
    v_mfma_f32_16x16x32_bf16 v[68:71], a[68:71], a[48:51], v[68:71]
    v_mfma_f32_16x16x32_bf16 v[76:79], a[68:71], a[52:55], v[76:79]
    buffer_load_dwordx4 v15, s[28:31], s40 offen offset:1024 lds
    s_add_u32 s40, s40, s44
    v_mfma_f32_16x16x32_bf16 v[84:87], a[68:71], a[56:59], v[84:87]
    ds_read_b128 a[4:7], v2 offset:2048
    v_mfma_f32_16x16x32_bf16 v[92:95], a[68:71], a[60:63], v[92:95]
    ds_read_b64_tr_b16 a[68:69], v5 offset:0
    v_mfma_f32_16x16x32_bf16 v[96:99], a[72:75], a[32:35], v[96:99]
    ds_read_b64_tr_b16 a[70:71], v5 offset:2048
    v_mfma_f32_16x16x32_bf16 v[104:107], a[72:75], a[36:39], v[104:107]
    buffer_load_dwordx4 v14, s[28:31], s41 offen offset:2048 lds
    v_mfma_f32_16x16x32_bf16 v[112:115], a[72:75], a[40:43], v[112:115]
    ds_read_b128 a[8:11], v2 offset:4096
    v_mfma_f32_16x16x32_bf16 v[120:123], a[72:75], a[44:47], v[120:123]
    v_mfma_f32_16x16x32_bf16 v[128:131], a[72:75], a[48:51], v[128:131]
    v_mfma_f32_16x16x32_bf16 v[136:139], a[72:75], a[52:55], v[136:139]
    buffer_load_dwordx4 v15, s[28:31], s41 offen offset:3072 lds
    s_add_u32 s41, s41, s44
    v_mfma_f32_16x16x32_bf16 v[144:147], a[72:75], a[56:59], v[144:147]
    ds_read_b128 a[12:15], v2 offset:6144
    v_mfma_f32_16x16x32_bf16 v[152:155], a[72:75], a[60:63], v[152:155]
    ds_read_b64_tr_b16 a[72:73], v6 offset:0
    v_mfma_f32_16x16x32_bf16 v[100:103], a[76:79], a[32:35], v[100:103]
    ds_read_b64_tr_b16 a[74:75], v6 offset:2048
    v_mfma_f32_16x16x32_bf16 v[108:111], a[76:79], a[36:39], v[108:111]
    s_add_u32 m0, s49, 4096
    s_nop 0
    buffer_load_dwordx4 v16, s[28:31], s42 offen offset:0 lds
    v_mfma_f32_16x16x32_bf16 v[116:119], a[76:79], a[40:43], v[116:119]
    ds_read_b128 a[16:19], v2 offset:8192
    v_mfma_f32_16x16x32_bf16 v[124:127], a[76:79], a[44:47], v[124:127]
    v_mfma_f32_16x16x32_bf16 v[132:135], a[76:79], a[48:51], v[132:135]
    v_mfma_f32_16x16x32_bf16 v[140:143], a[76:79], a[52:55], v[140:143]
    buffer_load_dwordx4 v17, s[28:31], s42 offen offset:1024 lds
    s_add_u32 s42, s42, s44
    v_mfma_f32_16x16x32_bf16 v[148:151], a[76:79], a[56:59], v[148:151]
    ds_read_b128 a[20:23], v2 offset:10240
    v_mfma_f32_16x16x32_bf16 v[156:159], a[76:79], a[60:63], v[156:159]
    ds_read_b64_tr_b16 a[76:77], v7 offset:0
    v_mfma_f32_16x16x32_bf16 v[160:163], a[80:83], a[32:35], v[160:163]
    ds_read_b64_tr_b16 a[78:79], v7 offset:2048
    v_mfma_f32_16x16x32_bf16 v[168:171], a[80:83], a[36:39], v[168:171]
    buffer_load_dwordx4 v16, s[28:31], s43 offen offset:2048 lds
    v_mfma_f32_16x16x32_bf16 v[176:179], a[80:83], a[40:43], v[176:179]
    ds_read_b128 a[24:27], v2 offset:12288
    v_mfma_f32_16x16x32_bf16 v[184:187], a[80:83], a[44:47], v[184:187]
    v_mfma_f32_16x16x32_bf16 v[192:195], a[80:83], a[48:51], v[192:195]
    v_mfma_f32_16x16x32_bf16 v[200:203], a[80:83], a[52:55], v[200:203]
    buffer_load_dwordx4 v17, s[28:31], s43 offen offset:3072 lds
    s_add_u32 s43, s43, s44
    v_mfma_f32_16x16x32_bf16 v[208:211], a[80:83], a[56:59], v[208:211]
    ds_read_b128 a[28:31], v2 offset:14336
    v_mfma_f32_16x16x32_bf16 v[216:219], a[80:83], a[60:63], v[216:219]
    ds_read_b64_tr_b16 a[80:81], v8 offset:0
    v_mfma_f32_16x16x32_bf16 v[164:167], a[84:87], a[32:35], v[164:167]
    ds_read_b64_tr_b16 a[82:83], v8 offset:2048
    v_mfma_f32_16x16x32_bf16 v[172:175], a[84:87], a[36:39], v[172:175]
    v_mfma_f32_16x16x32_bf16 v[180:183], a[84:87], a[40:43], v[180:183]
    v_mfma_f32_16x16x32_bf16 v[188:191], a[84:87], a[44:47], v[188:191]
    v_mfma_f32_16x16x32_bf16 v[196:199], a[84:87], a[48:51], v[196:199]
    s_xor_b32 s49, s49, 229376
    v_mfma_f32_16x16x32_bf16 v[204:207], a[84:87], a[52:55], v[204:207]
    v_mfma_f32_16x16x32_bf16 v[212:215], a[84:87], a[56:59], v[212:215]
    v_mfma_f32_16x16x32_bf16 v[220:223], a[84:87], a[60:63], v[220:223]
    ds_read_b64_tr_b16 a[84:85], v9 offset:0
    v_mfma_f32_16x16x32_bf16 v[224:227], a[88:91], a[32:35], v[224:227]
    ds_read_b64_tr_b16 a[86:87], v9 offset:2048
    v_mfma_f32_16x16x32_bf16 v[232:235], a[88:91], a[36:39], v[232:235]
    v_mfma_f32_16x16x32_bf16 v[240:243], a[88:91], a[40:43], v[240:243]
    v_mfma_f32_16x16x32_bf16 v[248:251], a[88:91], a[44:47], v[248:251]
    v_mfma_f32_16x16x32_bf16 a[96:99], a[88:91], a[48:51], a[96:99]
    v_mfma_f32_16x16x32_bf16 a[104:107], a[88:91], a[52:55], a[104:107]
    v_mfma_f32_16x16x32_bf16 a[112:115], a[88:91], a[56:59], a[112:115]
    v_mfma_f32_16x16x32_bf16 a[120:123], a[88:91], a[60:63], a[120:123]
    ds_read_b64_tr_b16 a[88:89], v10 offset:0
    v_mfma_f32_16x16x32_bf16 v[228:231], a[92:95], a[32:35], v[228:231]
    ds_read_b64_tr_b16 a[90:91], v10 offset:2048
    v_mfma_f32_16x16x32_bf16 v[236:239], a[92:95], a[36:39], v[236:239]
    v_mfma_f32_16x16x32_bf16 v[244:247], a[92:95], a[40:43], v[244:247]
    v_mfma_f32_16x16x32_bf16 v[252:255], a[92:95], a[44:47], v[252:255]
    v_mfma_f32_16x16x32_bf16 a[100:103], a[92:95], a[48:51], a[100:103]
    v_mfma_f32_16x16x32_bf16 a[108:111], a[92:95], a[52:55], a[108:111]
    v_mfma_f32_16x16x32_bf16 a[116:119], a[92:95], a[56:59], a[116:119]
    v_mfma_f32_16x16x32_bf16 a[124:127], a[92:95], a[60:63], a[124:127]
    ds_read_b64_tr_b16 a[92:93], v11 offset:0
    ds_read_b64_tr_b16 a[94:95], v11 offset:2048
gemm1_kernel_loop11:
    s_cmp_eq_u32 s52, 2
    s_cbranch_scc1 gemm1_kernel_dosw13
gemm1_kernel_nosw12:
    s_waitcnt lgkmcnt(15)
    v_mfma_f32_16x16x32_bf16 v[32:35], a[64:67], a[0:3], v[32:35]
    v_mfma_f32_16x16x32_bf16 v[40:43], a[64:67], a[4:7], v[40:43]
    v_mfma_f32_16x16x32_bf16 v[48:51], a[64:67], a[8:11], v[48:51]
    v_mfma_f32_16x16x32_bf16 v[56:59], a[64:67], a[12:15], v[56:59]
    s_waitcnt lgkmcnt(13)
    v_mfma_f32_16x16x32_bf16 v[64:67], a[64:67], a[16:19], v[64:67]
    s_add_u32 m0, s48, 0
    s_nop 0
    buffer_load_dwordx4 v12, s[24:27], s36 offen offset:0 lds
    s_waitcnt lgkmcnt(12)
    v_mfma_f32_16x16x32_bf16 v[72:75], a[64:67], a[20:23], v[72:75]
    s_waitcnt lgkmcnt(9)
    v_mfma_f32_16x16x32_bf16 v[80:83], a[64:67], a[24:27], v[80:83]
    s_waitcnt lgkmcnt(8)
    v_mfma_f32_16x16x32_bf16 v[88:91], a[64:67], a[28:31], v[88:91]
    ds_read_b64_tr_b16 a[64:65], v4 offset:16384
    v_mfma_f32_16x16x32_bf16 v[36:39], a[68:71], a[0:3], v[36:39]
    ds_read_b64_tr_b16 a[66:67], v4 offset:18432
    v_mfma_f32_16x16x32_bf16 v[44:47], a[68:71], a[4:7], v[44:47]
    v_mfma_f32_16x16x32_bf16 v[52:55], a[68:71], a[8:11], v[52:55]
    ds_read_b128 a[32:35], v3 offset:0
    v_mfma_f32_16x16x32_bf16 v[60:63], a[68:71], a[12:15], v[60:63]
    buffer_load_dwordx4 v13, s[24:27], s36 offen offset:1024 lds
    s_add_u32 s36, s36, 128
    v_mfma_f32_16x16x32_bf16 v[68:71], a[68:71], a[16:19], v[68:71]
    v_mfma_f32_16x16x32_bf16 v[76:79], a[68:71], a[20:23], v[76:79]
    v_mfma_f32_16x16x32_bf16 v[84:87], a[68:71], a[24:27], v[84:87]
    ds_read_b128 a[36:39], v3 offset:2048
    v_mfma_f32_16x16x32_bf16 v[92:95], a[68:71], a[28:31], v[92:95]
    ds_read_b64_tr_b16 a[68:69], v5 offset:16384
    v_mfma_f32_16x16x32_bf16 v[96:99], a[72:75], a[0:3], v[96:99]
    ds_read_b64_tr_b16 a[70:71], v5 offset:18432
    v_mfma_f32_16x16x32_bf16 v[104:107], a[72:75], a[4:7], v[104:107]
    buffer_load_dwordx4 v12, s[24:27], s37 offen offset:2048 lds
    v_mfma_f32_16x16x32_bf16 v[112:115], a[72:75], a[8:11], v[112:115]
    ds_read_b128 a[40:43], v3 offset:4096
    v_mfma_f32_16x16x32_bf16 v[120:123], a[72:75], a[12:15], v[120:123]
    v_mfma_f32_16x16x32_bf16 v[128:131], a[72:75], a[16:19], v[128:131]
    v_mfma_f32_16x16x32_bf16 v[136:139], a[72:75], a[20:23], v[136:139]
    v_mfma_f32_16x16x32_bf16 v[144:147], a[72:75], a[24:27], v[144:147]
    ds_read_b128 a[44:47], v3 offset:6144
    v_mfma_f32_16x16x32_bf16 v[152:155], a[72:75], a[28:31], v[152:155]
    ds_read_b64_tr_b16 a[72:73], v6 offset:16384
    buffer_load_dwordx4 v13, s[24:27], s37 offen offset:3072 lds
    s_add_u32 s37, s37, 128
    v_mfma_f32_16x16x32_bf16 v[100:103], a[76:79], a[0:3], v[100:103]
    ds_read_b64_tr_b16 a[74:75], v6 offset:18432
    v_mfma_f32_16x16x32_bf16 v[108:111], a[76:79], a[4:7], v[108:111]
    v_mfma_f32_16x16x32_bf16 v[116:119], a[76:79], a[8:11], v[116:119]
    ds_read_b128 a[48:51], v3 offset:8192
    v_mfma_f32_16x16x32_bf16 v[124:127], a[76:79], a[12:15], v[124:127]
    v_mfma_f32_16x16x32_bf16 v[132:135], a[76:79], a[16:19], v[132:135]
    s_add_u32 m0, s48, 4096
    s_nop 0
    buffer_load_dwordx4 v12, s[24:27], s38 offen offset:0 lds
    v_mfma_f32_16x16x32_bf16 v[140:143], a[76:79], a[20:23], v[140:143]
    v_mfma_f32_16x16x32_bf16 v[148:151], a[76:79], a[24:27], v[148:151]
    ds_read_b128 a[52:55], v3 offset:10240
    v_mfma_f32_16x16x32_bf16 v[156:159], a[76:79], a[28:31], v[156:159]
    ds_read_b64_tr_b16 a[76:77], v7 offset:16384
    s_waitcnt lgkmcnt(15)
    v_mfma_f32_16x16x32_bf16 v[160:163], a[80:83], a[0:3], v[160:163]
    ds_read_b64_tr_b16 a[78:79], v7 offset:18432
    v_mfma_f32_16x16x32_bf16 v[168:171], a[80:83], a[4:7], v[168:171]
    v_mfma_f32_16x16x32_bf16 v[176:179], a[80:83], a[8:11], v[176:179]
    ds_read_b128 a[56:59], v3 offset:12288
    v_mfma_f32_16x16x32_bf16 v[184:187], a[80:83], a[12:15], v[184:187]
    buffer_load_dwordx4 v13, s[24:27], s38 offen offset:1024 lds
    s_add_u32 s38, s38, 128
    v_mfma_f32_16x16x32_bf16 v[192:195], a[80:83], a[16:19], v[192:195]
    v_mfma_f32_16x16x32_bf16 v[200:203], a[80:83], a[20:23], v[200:203]
    v_mfma_f32_16x16x32_bf16 v[208:211], a[80:83], a[24:27], v[208:211]
    ds_read_b128 a[60:63], v3 offset:14336
    v_mfma_f32_16x16x32_bf16 v[216:219], a[80:83], a[28:31], v[216:219]
    ds_read_b64_tr_b16 a[80:81], v8 offset:16384
    v_mfma_f32_16x16x32_bf16 v[164:167], a[84:87], a[0:3], v[164:167]
    ds_read_b64_tr_b16 a[82:83], v8 offset:18432
    v_mfma_f32_16x16x32_bf16 v[172:175], a[84:87], a[4:7], v[172:175]
    buffer_load_dwordx4 v12, s[24:27], s39 offen offset:2048 lds
    v_mfma_f32_16x16x32_bf16 v[180:183], a[84:87], a[8:11], v[180:183]
    v_mfma_f32_16x16x32_bf16 v[188:191], a[84:87], a[12:15], v[188:191]
    v_mfma_f32_16x16x32_bf16 v[196:199], a[84:87], a[16:19], v[196:199]
    v_mfma_f32_16x16x32_bf16 v[204:207], a[84:87], a[20:23], v[204:207]
    v_mfma_f32_16x16x32_bf16 v[212:215], a[84:87], a[24:27], v[212:215]
    buffer_load_dwordx4 v13, s[24:27], s39 offen offset:3072 lds
    s_add_u32 s39, s39, 128
    v_mfma_f32_16x16x32_bf16 v[220:223], a[84:87], a[28:31], v[220:223]
    ds_read_b64_tr_b16 a[84:85], v9 offset:16384
    v_mfma_f32_16x16x32_bf16 v[224:227], a[88:91], a[0:3], v[224:227]
    ds_read_b64_tr_b16 a[86:87], v9 offset:18432
    v_mfma_f32_16x16x32_bf16 v[232:235], a[88:91], a[4:7], v[232:235]
    v_mfma_f32_16x16x32_bf16 v[240:243], a[88:91], a[8:11], v[240:243]
    v_mfma_f32_16x16x32_bf16 v[248:251], a[88:91], a[12:15], v[248:251]
    v_mfma_f32_16x16x32_bf16 a[96:99], a[88:91], a[16:19], a[96:99]
    v_mfma_f32_16x16x32_bf16 a[104:107], a[88:91], a[20:23], a[104:107]
    s_add_u32 s48, s48, 32768
    s_cmp_ge_u32 s48, 98304
    s_cselect_b32 s54, 98304, 0
    s_sub_u32 s48, s48, s54
    v_mfma_f32_16x16x32_bf16 a[112:115], a[88:91], a[24:27], a[112:115]
    v_mfma_f32_16x16x32_bf16 a[120:123], a[88:91], a[28:31], a[120:123]
    ds_read_b64_tr_b16 a[88:89], v10 offset:16384
    s_waitcnt lgkmcnt(15)
    v_mfma_f32_16x16x32_bf16 v[228:231], a[92:95], a[0:3], v[228:231]
    ds_read_b64_tr_b16 a[90:91], v10 offset:18432
    v_mfma_f32_16x16x32_bf16 v[236:239], a[92:95], a[4:7], v[236:239]
    s_add_u32 s51, s51, 32768
    s_cmp_ge_u32 s51, 98304
    s_cselect_b32 s50, 4294901760, s22
    s_cselect_b32 s51, 0, s51
    v_mfma_f32_16x16x32_bf16 v[244:247], a[92:95], a[8:11], v[244:247]
    v_add_u32 v2, s50, v2
    v_mfma_f32_16x16x32_bf16 v[252:255], a[92:95], a[12:15], v[252:255]
    v_add_u32 v3, s50, v3
    v_mfma_f32_16x16x32_bf16 a[100:103], a[92:95], a[16:19], a[100:103]
    v_mfma_f32_16x16x32_bf16 a[108:111], a[92:95], a[20:23], a[108:111]
    v_mfma_f32_16x16x32_bf16 a[116:119], a[92:95], a[24:27], a[116:119]
    v_mfma_f32_16x16x32_bf16 a[124:127], a[92:95], a[28:31], a[124:127]
    ds_read_b64_tr_b16 a[92:93], v11 offset:16384
    ds_read_b64_tr_b16 a[94:95], v11 offset:18432
    v_mfma_f32_16x16x32_bf16 v[32:35], a[64:67], a[32:35], v[32:35]
    v_xor_b32 v4, s23, v4
    v_mfma_f32_16x16x32_bf16 v[40:43], a[64:67], a[36:39], v[40:43]
    v_xor_b32 v5, s23, v5
    s_waitcnt lgkmcnt(15)
    v_mfma_f32_16x16x32_bf16 v[48:51], a[64:67], a[40:43], v[48:51]
    v_xor_b32 v6, s23, v6
    v_mfma_f32_16x16x32_bf16 v[56:59], a[64:67], a[44:47], v[56:59]
    v_xor_b32 v7, s23, v7
    s_waitcnt lgkmcnt(13)
    v_mfma_f32_16x16x32_bf16 v[64:67], a[64:67], a[48:51], v[64:67]
    v_xor_b32 v8, s23, v8
    s_waitcnt lgkmcnt(12)
    v_mfma_f32_16x16x32_bf16 v[72:75], a[64:67], a[52:55], v[72:75]
    v_xor_b32 v9, s23, v9
    s_waitcnt lgkmcnt(9)
    v_mfma_f32_16x16x32_bf16 v[80:83], a[64:67], a[56:59], v[80:83]
    v_xor_b32 v10, s23, v10
    v_xor_b32 v11, s23, v11
    s_waitcnt lgkmcnt(8)
    s_waitcnt lgkmcnt(0)
    s_waitcnt vmcnt(8)
    v_mfma_f32_16x16x32_bf16 v[88:91], a[64:67], a[60:63], v[88:91]
    s_barrier
    ds_read_b64_tr_b16 a[64:65], v4 offset:0
    v_mfma_f32_16x16x32_bf16 v[36:39], a[68:71], a[32:35], v[36:39]
    ds_read_b64_tr_b16 a[66:67], v4 offset:2048
    v_mfma_f32_16x16x32_bf16 v[44:47], a[68:71], a[36:39], v[44:47]
    s_add_u32 m0, s49, 0
    s_nop 0
    buffer_load_dwordx4 v14, s[28:31], s40 offen offset:0 lds
    v_mfma_f32_16x16x32_bf16 v[52:55], a[68:71], a[40:43], v[52:55]
    ds_read_b128 a[0:3], v2 offset:0
    v_mfma_f32_16x16x32_bf16 v[60:63], a[68:71], a[44:47], v[60:63]
    v_mfma_f32_16x16x32_bf16 v[68:71], a[68:71], a[48:51], v[68:71]
    v_mfma_f32_16x16x32_bf16 v[76:79], a[68:71], a[52:55], v[76:79]
    buffer_load_dwordx4 v15, s[28:31], s40 offen offset:1024 lds
    s_add_u32 s40, s40, s44
    v_mfma_f32_16x16x32_bf16 v[84:87], a[68:71], a[56:59], v[84:87]
    ds_read_b128 a[4:7], v2 offset:2048
    v_mfma_f32_16x16x32_bf16 v[92:95], a[68:71], a[60:63], v[92:95]
    ds_read_b64_tr_b16 a[68:69], v5 offset:0
    v_mfma_f32_16x16x32_bf16 v[96:99], a[72:75], a[32:35], v[96:99]
    ds_read_b64_tr_b16 a[70:71], v5 offset:2048
    v_mfma_f32_16x16x32_bf16 v[104:107], a[72:75], a[36:39], v[104:107]
    buffer_load_dwordx4 v14, s[28:31], s41 offen offset:2048 lds
    v_mfma_f32_16x16x32_bf16 v[112:115], a[72:75], a[40:43], v[112:115]
    ds_read_b128 a[8:11], v2 offset:4096
    v_mfma_f32_16x16x32_bf16 v[120:123], a[72:75], a[44:47], v[120:123]
    v_mfma_f32_16x16x32_bf16 v[128:131], a[72:75], a[48:51], v[128:131]
    v_mfma_f32_16x16x32_bf16 v[136:139], a[72:75], a[52:55], v[136:139]
    buffer_load_dwordx4 v15, s[28:31], s41 offen offset:3072 lds
    s_add_u32 s41, s41, s44
    v_mfma_f32_16x16x32_bf16 v[144:147], a[72:75], a[56:59], v[144:147]
    ds_read_b128 a[12:15], v2 offset:6144
    v_mfma_f32_16x16x32_bf16 v[152:155], a[72:75], a[60:63], v[152:155]
    ds_read_b64_tr_b16 a[72:73], v6 offset:0
    v_mfma_f32_16x16x32_bf16 v[100:103], a[76:79], a[32:35], v[100:103]
    ds_read_b64_tr_b16 a[74:75], v6 offset:2048
    v_mfma_f32_16x16x32_bf16 v[108:111], a[76:79], a[36:39], v[108:111]
    s_add_u32 m0, s49, 4096
    s_nop 0
    buffer_load_dwordx4 v16, s[28:31], s42 offen offset:0 lds
    v_mfma_f32_16x16x32_bf16 v[116:119], a[76:79], a[40:43], v[116:119]
    ds_read_b128 a[16:19], v2 offset:8192
    v_mfma_f32_16x16x32_bf16 v[124:127], a[76:79], a[44:47], v[124:127]
    v_mfma_f32_16x16x32_bf16 v[132:135], a[76:79], a[48:51], v[132:135]
    v_mfma_f32_16x16x32_bf16 v[140:143], a[76:79], a[52:55], v[140:143]
    buffer_load_dwordx4 v17, s[28:31], s42 offen offset:1024 lds
    s_add_u32 s42, s42, s44
    v_mfma_f32_16x16x32_bf16 v[148:151], a[76:79], a[56:59], v[148:151]
    ds_read_b128 a[20:23], v2 offset:10240
    v_mfma_f32_16x16x32_bf16 v[156:159], a[76:79], a[60:63], v[156:159]
    ds_read_b64_tr_b16 a[76:77], v7 offset:0
    v_mfma_f32_16x16x32_bf16 v[160:163], a[80:83], a[32:35], v[160:163]
    ds_read_b64_tr_b16 a[78:79], v7 offset:2048
    v_mfma_f32_16x16x32_bf16 v[168:171], a[80:83], a[36:39], v[168:171]
    buffer_load_dwordx4 v16, s[28:31], s43 offen offset:2048 lds
    v_mfma_f32_16x16x32_bf16 v[176:179], a[80:83], a[40:43], v[176:179]
    ds_read_b128 a[24:27], v2 offset:12288
    v_mfma_f32_16x16x32_bf16 v[184:187], a[80:83], a[44:47], v[184:187]
    v_mfma_f32_16x16x32_bf16 v[192:195], a[80:83], a[48:51], v[192:195]
    v_mfma_f32_16x16x32_bf16 v[200:203], a[80:83], a[52:55], v[200:203]
    buffer_load_dwordx4 v17, s[28:31], s43 offen offset:3072 lds
    s_add_u32 s43, s43, s44
    v_mfma_f32_16x16x32_bf16 v[208:211], a[80:83], a[56:59], v[208:211]
    ds_read_b128 a[28:31], v2 offset:14336
    v_mfma_f32_16x16x32_bf16 v[216:219], a[80:83], a[60:63], v[216:219]
    ds_read_b64_tr_b16 a[80:81], v8 offset:0
    v_mfma_f32_16x16x32_bf16 v[164:167], a[84:87], a[32:35], v[164:167]
    ds_read_b64_tr_b16 a[82:83], v8 offset:2048
    v_mfma_f32_16x16x32_bf16 v[172:175], a[84:87], a[36:39], v[172:175]
    v_mfma_f32_16x16x32_bf16 v[180:183], a[84:87], a[40:43], v[180:183]
    v_mfma_f32_16x16x32_bf16 v[188:191], a[84:87], a[44:47], v[188:191]
    v_mfma_f32_16x16x32_bf16 v[196:199], a[84:87], a[48:51], v[196:199]
    s_xor_b32 s49, s49, 229376
    v_mfma_f32_16x16x32_bf16 v[204:207], a[84:87], a[52:55], v[204:207]
    v_mfma_f32_16x16x32_bf16 v[212:215], a[84:87], a[56:59], v[212:215]
    v_mfma_f32_16x16x32_bf16 v[220:223], a[84:87], a[60:63], v[220:223]
    ds_read_b64_tr_b16 a[84:85], v9 offset:0
    v_mfma_f32_16x16x32_bf16 v[224:227], a[88:91], a[32:35], v[224:227]
    ds_read_b64_tr_b16 a[86:87], v9 offset:2048
    v_mfma_f32_16x16x32_bf16 v[232:235], a[88:91], a[36:39], v[232:235]
    v_mfma_f32_16x16x32_bf16 v[240:243], a[88:91], a[40:43], v[240:243]
    v_mfma_f32_16x16x32_bf16 v[248:251], a[88:91], a[44:47], v[248:251]
    v_mfma_f32_16x16x32_bf16 a[96:99], a[88:91], a[48:51], a[96:99]
    v_mfma_f32_16x16x32_bf16 a[104:107], a[88:91], a[52:55], a[104:107]
    v_mfma_f32_16x16x32_bf16 a[112:115], a[88:91], a[56:59], a[112:115]
    v_mfma_f32_16x16x32_bf16 a[120:123], a[88:91], a[60:63], a[120:123]
    ds_read_b64_tr_b16 a[88:89], v10 offset:0
    v_mfma_f32_16x16x32_bf16 v[228:231], a[92:95], a[32:35], v[228:231]
    ds_read_b64_tr_b16 a[90:91], v10 offset:2048
    v_mfma_f32_16x16x32_bf16 v[236:239], a[92:95], a[36:39], v[236:239]
    v_mfma_f32_16x16x32_bf16 v[244:247], a[92:95], a[40:43], v[244:247]
    v_mfma_f32_16x16x32_bf16 v[252:255], a[92:95], a[44:47], v[252:255]
    v_mfma_f32_16x16x32_bf16 a[100:103], a[92:95], a[48:51], a[100:103]
    v_mfma_f32_16x16x32_bf16 a[108:111], a[92:95], a[52:55], a[108:111]
    v_mfma_f32_16x16x32_bf16 a[116:119], a[92:95], a[56:59], a[116:119]
    v_mfma_f32_16x16x32_bf16 a[124:127], a[92:95], a[60:63], a[124:127]
    ds_read_b64_tr_b16 a[92:93], v11 offset:0
    ds_read_b64_tr_b16 a[94:95], v11 offset:2048
    s_sub_u32 s52, s52, 1
    s_cmp_lg_u32 s52, 0
    s_cbranch_scc1 gemm1_kernel_loop11
    s_branch gemm1_kernel_epi8
gemm1_kernel_swp9:
    s_waitcnt lgkmcnt(15)
    v_mfma_f32_16x16x32_bf16 v[32:35], a[0:3], a[64:67], 0
    v_mfma_f32_16x16x32_bf16 v[36:39], a[4:7], a[64:67], 0
    v_mfma_f32_16x16x32_bf16 v[96:99], a[8:11], a[64:67], 0
    v_mfma_f32_16x16x32_bf16 v[100:103], a[12:15], a[64:67], 0
    s_waitcnt lgkmcnt(13)
    v_mfma_f32_16x16x32_bf16 v[160:163], a[16:19], a[64:67], 0
    s_add_u32 m0, s48, 0
    s_nop 0
    buffer_load_dwordx4 v12, s[24:27], s36 offen offset:0 lds
    s_waitcnt lgkmcnt(12)
    v_mfma_f32_16x16x32_bf16 v[164:167], a[20:23], a[64:67], 0
    s_waitcnt lgkmcnt(9)
    v_mfma_f32_16x16x32_bf16 v[224:227], a[24:27], a[64:67], 0
    s_waitcnt lgkmcnt(8)
    v_mfma_f32_16x16x32_bf16 v[228:231], a[28:31], a[64:67], 0
    ds_read_b64_tr_b16 a[64:65], v4 offset:16384
    v_mfma_f32_16x16x32_bf16 v[40:43], a[0:3], a[68:71], 0
    ds_read_b64_tr_b16 a[66:67], v4 offset:18432
    v_mfma_f32_16x16x32_bf16 v[44:47], a[4:7], a[68:71], 0
    v_mfma_f32_16x16x32_bf16 v[104:107], a[8:11], a[68:71], 0
    ds_read_b128 a[32:35], v3 offset:0
    v_mfma_f32_16x16x32_bf16 v[108:111], a[12:15], a[68:71], 0
    buffer_load_dwordx4 v13, s[24:27], s36 offen offset:1024 lds
    s_add_u32 s36, s36, 128
    v_mfma_f32_16x16x32_bf16 v[168:171], a[16:19], a[68:71], 0
    v_mfma_f32_16x16x32_bf16 v[172:175], a[20:23], a[68:71], 0
    v_mfma_f32_16x16x32_bf16 v[232:235], a[24:27], a[68:71], 0
    ds_read_b128 a[36:39], v3 offset:2048
    v_mfma_f32_16x16x32_bf16 v[236:239], a[28:31], a[68:71], 0
    ds_read_b64_tr_b16 a[68:69], v5 offset:16384
    v_mfma_f32_16x16x32_bf16 v[48:51], a[0:3], a[72:75], 0
    ds_read_b64_tr_b16 a[70:71], v5 offset:18432
    v_mfma_f32_16x16x32_bf16 v[52:55], a[4:7], a[72:75], 0
    buffer_load_dwordx4 v12, s[24:27], s37 offen offset:2048 lds
    v_mfma_f32_16x16x32_bf16 v[112:115], a[8:11], a[72:75], 0
    ds_read_b128 a[40:43], v3 offset:4096
    v_mfma_f32_16x16x32_bf16 v[116:119], a[12:15], a[72:75], 0
    v_mfma_f32_16x16x32_bf16 v[176:179], a[16:19], a[72:75], 0
    v_mfma_f32_16x16x32_bf16 v[180:183], a[20:23], a[72:75], 0
    v_mfma_f32_16x16x32_bf16 v[240:243], a[24:27], a[72:75], 0
    ds_read_b128 a[44:47], v3 offset:6144
    v_mfma_f32_16x16x32_bf16 v[244:247], a[28:31], a[72:75], 0
    ds_read_b64_tr_b16 a[72:73], v6 offset:16384
    buffer_load_dwordx4 v13, s[24:27], s37 offen offset:3072 lds
    s_add_u32 s37, s37, 128
    v_mfma_f32_16x16x32_bf16 v[56:59], a[0:3], a[76:79], 0
    ds_read_b64_tr_b16 a[74:75], v6 offset:18432
    v_mfma_f32_16x16x32_bf16 v[60:63], a[4:7], a[76:79], 0
    v_mfma_f32_16x16x32_bf16 v[120:123], a[8:11], a[76:79], 0
    ds_read_b128 a[48:51], v3 offset:8192
    v_mfma_f32_16x16x32_bf16 v[124:127], a[12:15], a[76:79], 0
    v_mfma_f32_16x16x32_bf16 v[184:187], a[16:19], a[76:79], 0
    s_add_u32 m0, s48, 4096
    s_nop 0
    buffer_load_dwordx4 v12, s[24:27], s38 offen offset:0 lds
    v_mfma_f32_16x16x32_bf16 v[188:191], a[20:23], a[76:79], 0
    v_mfma_f32_16x16x32_bf16 v[248:251], a[24:27], a[76:79], 0
    ds_read_b128 a[52:55], v3 offset:10240
    v_mfma_f32_16x16x32_bf16 v[252:255], a[28:31], a[76:79], 0
    ds_read_b64_tr_b16 a[76:77], v7 offset:16384
    s_waitcnt lgkmcnt(15)
    v_mfma_f32_16x16x32_bf16 v[64:67], a[0:3], a[80:83], 0
    ds_read_b64_tr_b16 a[78:79], v7 offset:18432
    v_mfma_f32_16x16x32_bf16 v[68:71], a[4:7], a[80:83], 0
    v_mfma_f32_16x16x32_bf16 v[128:131], a[8:11], a[80:83], 0
    ds_read_b128 a[56:59], v3 offset:12288
    v_mfma_f32_16x16x32_bf16 v[132:135], a[12:15], a[80:83], 0
    buffer_load_dwordx4 v13, s[24:27], s38 offen offset:1024 lds
    s_add_u32 s38, s38, 128
    v_mfma_f32_16x16x32_bf16 v[192:195], a[16:19], a[80:83], 0
    v_mfma_f32_16x16x32_bf16 v[196:199], a[20:23], a[80:83], 0
    v_mfma_f32_16x16x32_bf16 a[96:99], a[24:27], a[80:83], 0
    ds_read_b128 a[60:63], v3 offset:14336
    v_mfma_f32_16x16x32_bf16 a[100:103], a[28:31], a[80:83], 0
    ds_read_b64_tr_b16 a[80:81], v8 offset:16384
    v_mfma_f32_16x16x32_bf16 v[72:75], a[0:3], a[84:87], 0
    ds_read_b64_tr_b16 a[82:83], v8 offset:18432
    v_mfma_f32_16x16x32_bf16 v[76:79], a[4:7], a[84:87], 0
    buffer_load_dwordx4 v12, s[24:27], s39 offen offset:2048 lds
    v_mfma_f32_16x16x32_bf16 v[136:139], a[8:11], a[84:87], 0
    v_mfma_f32_16x16x32_bf16 v[140:143], a[12:15], a[84:87], 0
    v_mfma_f32_16x16x32_bf16 v[200:203], a[16:19], a[84:87], 0
    v_mfma_f32_16x16x32_bf16 v[204:207], a[20:23], a[84:87], 0
    v_mfma_f32_16x16x32_bf16 a[104:107], a[24:27], a[84:87], 0
    buffer_load_dwordx4 v13, s[24:27], s39 offen offset:3072 lds
    s_add_u32 s39, s39, 128
    v_mfma_f32_16x16x32_bf16 a[108:111], a[28:31], a[84:87], 0
    ds_read_b64_tr_b16 a[84:85], v9 offset:16384
    v_mfma_f32_16x16x32_bf16 v[80:83], a[0:3], a[88:91], 0
    ds_read_b64_tr_b16 a[86:87], v9 offset:18432
    v_mfma_f32_16x16x32_bf16 v[84:87], a[4:7], a[88:91], 0
    v_mfma_f32_16x16x32_bf16 v[144:147], a[8:11], a[88:91], 0
    v_mfma_f32_16x16x32_bf16 v[148:151], a[12:15], a[88:91], 0
    v_mfma_f32_16x16x32_bf16 v[208:211], a[16:19], a[88:91], 0
    v_mfma_f32_16x16x32_bf16 v[212:215], a[20:23], a[88:91], 0
    s_add_u32 s48, s48, 32768
    s_cmp_ge_u32 s48, 98304
    s_cselect_b32 s54, 98304, 0
    s_sub_u32 s48, s48, s54
    v_mfma_f32_16x16x32_bf16 a[112:115], a[24:27], a[88:91], 0
    v_mfma_f32_16x16x32_bf16 a[116:119], a[28:31], a[88:91], 0
    ds_read_b64_tr_b16 a[88:89], v10 offset:16384
    s_waitcnt lgkmcnt(15)
    v_mfma_f32_16x16x32_bf16 v[88:91], a[0:3], a[92:95], 0
    ds_read_b64_tr_b16 a[90:91], v10 offset:18432
    v_mfma_f32_16x16x32_bf16 v[92:95], a[4:7], a[92:95], 0
    s_add_u32 s51, s51, 32768
    s_cmp_ge_u32 s51, 98304
    s_cselect_b32 s50, 4294901760, s22
    s_cselect_b32 s51, 0, s51
    v_mfma_f32_16x16x32_bf16 v[152:155], a[8:11], a[92:95], 0
    v_add_u32 v2, s50, v2
    v_mfma_f32_16x16x32_bf16 v[156:159], a[12:15], a[92:95], 0
    v_add_u32 v3, s50, v3
    v_mfma_f32_16x16x32_bf16 v[216:219], a[16:19], a[92:95], 0
    v_mfma_f32_16x16x32_bf16 v[220:223], a[20:23], a[92:95], 0
    v_mfma_f32_16x16x32_bf16 a[120:123], a[24:27], a[92:95], 0
    v_mfma_f32_16x16x32_bf16 a[124:127], a[28:31], a[92:95], 0
    ds_read_b64_tr_b16 a[92:93], v11 offset:16384
    ds_read_b64_tr_b16 a[94:95], v11 offset:18432
    v_mfma_f32_16x16x32_bf16 v[32:35], a[32:35], a[64:67], v[32:35]
    v_xor_b32 v4, s23, v4
    v_mfma_f32_16x16x32_bf16 v[36:39], a[36:39], a[64:67], v[36:39]
    v_xor_b32 v5, s23, v5
    s_waitcnt lgkmcnt(15)
    v_mfma_f32_16x16x32_bf16 v[96:99], a[40:43], a[64:67], v[96:99]
    v_xor_b32 v6, s23, v6
    v_mfma_f32_16x16x32_bf16 v[100:103], a[44:47], a[64:67], v[100:103]
    v_xor_b32 v7, s23, v7
    s_waitcnt lgkmcnt(13)
    v_mfma_f32_16x16x32_bf16 v[160:163], a[48:51], a[64:67], v[160:163]
    v_xor_b32 v8, s23, v8
    s_waitcnt lgkmcnt(12)
    v_mfma_f32_16x16x32_bf16 v[164:167], a[52:55], a[64:67], v[164:167]
    v_xor_b32 v9, s23, v9
    s_waitcnt lgkmcnt(9)
    v_mfma_f32_16x16x32_bf16 v[224:227], a[56:59], a[64:67], v[224:227]
    v_xor_b32 v10, s23, v10
    v_xor_b32 v11, s23, v11
    s_waitcnt lgkmcnt(8)
    s_waitcnt lgkmcnt(0)
    s_waitcnt vmcnt(40)
    s_cmp_eq_u32 s53, 0
    s_cbranch_scc1 gemm1_kernel_w14
    s_waitcnt vmcnt(8)
gemm1_kernel_w14:
    v_mfma_f32_16x16x32_bf16 v[228:231], a[60:63], a[64:67], v[228:231]
    s_barrier
    ds_read_b64_tr_b16 a[64:65], v4 offset:0
    v_mfma_f32_16x16x32_bf16 v[40:43], a[32:35], a[68:71], v[40:43]
    ds_read_b64_tr_b16 a[66:67], v4 offset:2048
    v_mfma_f32_16x16x32_bf16 v[44:47], a[36:39], a[68:71], v[44:47]
    s_add_u32 m0, s49, 0
    s_nop 0
    buffer_load_dwordx4 v14, s[28:31], s40 offen offset:0 lds
    v_mfma_f32_16x16x32_bf16 v[104:107], a[40:43], a[68:71], v[104:107]
    ds_read_b128 a[0:3], v2 offset:0
    v_mfma_f32_16x16x32_bf16 v[108:111], a[44:47], a[68:71], v[108:111]
    v_mfma_f32_16x16x32_bf16 v[168:171], a[48:51], a[68:71], v[168:171]
    v_mfma_f32_16x16x32_bf16 v[172:175], a[52:55], a[68:71], v[172:175]
    buffer_load_dwordx4 v15, s[28:31], s40 offen offset:1024 lds
    s_add_u32 s40, s40, s44
    v_mfma_f32_16x16x32_bf16 v[232:235], a[56:59], a[68:71], v[232:235]
    ds_read_b128 a[4:7], v2 offset:2048
    v_mfma_f32_16x16x32_bf16 v[236:239], a[60:63], a[68:71], v[236:239]
    ds_read_b64_tr_b16 a[68:69], v5 offset:0
    v_mfma_f32_16x16x32_bf16 v[48:51], a[32:35], a[72:75], v[48:51]
    ds_read_b64_tr_b16 a[70:71], v5 offset:2048
    v_mfma_f32_16x16x32_bf16 v[52:55], a[36:39], a[72:75], v[52:55]
    buffer_load_dwordx4 v14, s[28:31], s41 offen offset:2048 lds
    v_mfma_f32_16x16x32_bf16 v[112:115], a[40:43], a[72:75], v[112:115]
    ds_read_b128 a[8:11], v2 offset:4096
    v_mfma_f32_16x16x32_bf16 v[116:119], a[44:47], a[72:75], v[116:119]
    v_mfma_f32_16x16x32_bf16 v[176:179], a[48:51], a[72:75], v[176:179]
    v_mfma_f32_16x16x32_bf16 v[180:183], a[52:55], a[72:75], v[180:183]
    buffer_load_dwordx4 v15, s[28:31], s41 offen offset:3072 lds
    s_add_u32 s41, s41, s44
    v_mfma_f32_16x16x32_bf16 v[240:243], a[56:59], a[72:75], v[240:243]
    ds_read_b128 a[12:15], v2 offset:6144
    v_mfma_f32_16x16x32_bf16 v[244:247], a[60:63], a[72:75], v[244:247]
    ds_read_b64_tr_b16 a[72:73], v6 offset:0
    v_mfma_f32_16x16x32_bf16 v[56:59], a[32:35], a[76:79], v[56:59]
    ds_read_b64_tr_b16 a[74:75], v6 offset:2048
    v_mfma_f32_16x16x32_bf16 v[60:63], a[36:39], a[76:79], v[60:63]
    s_add_u32 m0, s49, 4096
    s_nop 0
    buffer_load_dwordx4 v16, s[28:31], s42 offen offset:0 lds
    v_mfma_f32_16x16x32_bf16 v[120:123], a[40:43], a[76:79], v[120:123]
    ds_read_b128 a[16:19], v2 offset:8192
    v_mfma_f32_16x16x32_bf16 v[124:127], a[44:47], a[76:79], v[124:127]
    v_mfma_f32_16x16x32_bf16 v[184:187], a[48:51], a[76:79], v[184:187]
    v_mfma_f32_16x16x32_bf16 v[188:191], a[52:55], a[76:79], v[188:191]
    buffer_load_dwordx4 v17, s[28:31], s42 offen offset:1024 lds
    s_add_u32 s42, s42, s44
    v_mfma_f32_16x16x32_bf16 v[248:251], a[56:59], a[76:79], v[248:251]
    ds_read_b128 a[20:23], v2 offset:10240
    v_mfma_f32_16x16x32_bf16 v[252:255], a[60:63], a[76:79], v[252:255]
    ds_read_b64_tr_b16 a[76:77], v7 offset:0
    v_mfma_f32_16x16x32_bf16 v[64:67], a[32:35], a[80:83], v[64:67]
    ds_read_b64_tr_b16 a[78:79], v7 offset:2048
    v_mfma_f32_16x16x32_bf16 v[68:71], a[36:39], a[80:83], v[68:71]
    buffer_load_dwordx4 v16, s[28:31], s43 offen offset:2048 lds
    v_mfma_f32_16x16x32_bf16 v[128:131], a[40:43], a[80:83], v[128:131]
    ds_read_b128 a[24:27], v2 offset:12288
    v_mfma_f32_16x16x32_bf16 v[132:135], a[44:47], a[80:83], v[132:135]
    v_mfma_f32_16x16x32_bf16 v[192:195], a[48:51], a[80:83], v[192:195]
    v_mfma_f32_16x16x32_bf16 v[196:199], a[52:55], a[80:83], v[196:199]
    buffer_load_dwordx4 v17, s[28:31], s43 offen offset:3072 lds
    s_add_u32 s43, s43, s44
    v_mfma_f32_16x16x32_bf16 a[96:99], a[56:59], a[80:83], a[96:99]
    ds_read_b128 a[28:31], v2 offset:14336
    v_mfma_f32_16x16x32_bf16 a[100:103], a[60:63], a[80:83], a[100:103]
    ds_read_b64_tr_b16 a[80:81], v8 offset:0
    v_mfma_f32_16x16x32_bf16 v[72:75], a[32:35], a[84:87], v[72:75]
    ds_read_b64_tr_b16 a[82:83], v8 offset:2048
    v_mfma_f32_16x16x32_bf16 v[76:79], a[36:39], a[84:87], v[76:79]
    v_mfma_f32_16x16x32_bf16 v[136:139], a[40:43], a[84:87], v[136:139]
    v_mfma_f32_16x16x32_bf16 v[140:143], a[44:47], a[84:87], v[140:143]
    v_mfma_f32_16x16x32_bf16 v[200:203], a[48:51], a[84:87], v[200:203]
    s_xor_b32 s49, s49, 229376
    v_mfma_f32_16x16x32_bf16 v[204:207], a[52:55], a[84:87], v[204:207]
    v_mfma_f32_16x16x32_bf16 a[104:107], a[56:59], a[84:87], a[104:107]
    v_mfma_f32_16x16x32_bf16 a[108:111], a[60:63], a[84:87], a[108:111]
    ds_read_b64_tr_b16 a[84:85], v9 offset:0
    v_mfma_f32_16x16x32_bf16 v[80:83], a[32:35], a[88:91], v[80:83]
    ds_read_b64_tr_b16 a[86:87], v9 offset:2048
    v_mfma_f32_16x16x32_bf16 v[84:87], a[36:39], a[88:91], v[84:87]
    v_mfma_f32_16x16x32_bf16 v[144:147], a[40:43], a[88:91], v[144:147]
    v_mfma_f32_16x16x32_bf16 v[148:151], a[44:47], a[88:91], v[148:151]
    v_mfma_f32_16x16x32_bf16 v[208:211], a[48:51], a[88:91], v[208:211]
    v_mfma_f32_16x16x32_bf16 v[212:215], a[52:55], a[88:91], v[212:215]
    v_mfma_f32_16x16x32_bf16 a[112:115], a[56:59], a[88:91], a[112:115]
    v_mfma_f32_16x16x32_bf16 a[116:119], a[60:63], a[88:91], a[116:119]
    ds_read_b64_tr_b16 a[88:89], v10 offset:0
    v_mfma_f32_16x16x32_bf16 v[88:91], a[32:35], a[92:95], v[88:91]
    ds_read_b64_tr_b16 a[90:91], v10 offset:2048
    v_mfma_f32_16x16x32_bf16 v[92:95], a[36:39], a[92:95], v[92:95]
    v_mfma_f32_16x16x32_bf16 v[152:155], a[40:43], a[92:95], v[152:155]
    v_mfma_f32_16x16x32_bf16 v[156:159], a[44:47], a[92:95], v[156:159]
    v_mfma_f32_16x16x32_bf16 v[216:219], a[48:51], a[92:95], v[216:219]
    v_mfma_f32_16x16x32_bf16 v[220:223], a[52:55], a[92:95], v[220:223]
    v_mfma_f32_16x16x32_bf16 a[120:123], a[56:59], a[92:95], a[120:123]
    v_mfma_f32_16x16x32_bf16 a[124:127], a[60:63], a[92:95], a[124:127]
    ds_read_b64_tr_b16 a[92:93], v11 offset:0
    ds_read_b64_tr_b16 a[94:95], v11 offset:2048
gemm1_kernel_loop15:
    s_cmp_eq_u32 s52, 2
    s_cbranch_scc1 gemm1_kernel_dosw17
gemm1_kernel_nosw16:
    s_waitcnt lgkmcnt(15)
    v_mfma_f32_16x16x32_bf16 v[32:35], a[0:3], a[64:67], v[32:35]
    v_mfma_f32_16x16x32_bf16 v[36:39], a[4:7], a[64:67], v[36:39]
    v_mfma_f32_16x16x32_bf16 v[96:99], a[8:11], a[64:67], v[96:99]
    v_mfma_f32_16x16x32_bf16 v[100:103], a[12:15], a[64:67], v[100:103]
    s_waitcnt lgkmcnt(13)
    v_mfma_f32_16x16x32_bf16 v[160:163], a[16:19], a[64:67], v[160:163]
    s_add_u32 m0, s48, 0
    s_nop 0
    buffer_load_dwordx4 v12, s[24:27], s36 offen offset:0 lds
    s_waitcnt lgkmcnt(12)
    v_mfma_f32_16x16x32_bf16 v[164:167], a[20:23], a[64:67], v[164:167]
    s_waitcnt lgkmcnt(9)
    v_mfma_f32_16x16x32_bf16 v[224:227], a[24:27], a[64:67], v[224:227]
    s_waitcnt lgkmcnt(8)
    v_mfma_f32_16x16x32_bf16 v[228:231], a[28:31], a[64:67], v[228:231]
    ds_read_b64_tr_b16 a[64:65], v4 offset:16384
    v_mfma_f32_16x16x32_bf16 v[40:43], a[0:3], a[68:71], v[40:43]
    ds_read_b64_tr_b16 a[66:67], v4 offset:18432
    v_mfma_f32_16x16x32_bf16 v[44:47], a[4:7], a[68:71], v[44:47]
    v_mfma_f32_16x16x32_bf16 v[104:107], a[8:11], a[68:71], v[104:107]
    ds_read_b128 a[32:35], v3 offset:0
    v_mfma_f32_16x16x32_bf16 v[108:111], a[12:15], a[68:71], v[108:111]
    buffer_load_dwordx4 v13, s[24:27], s36 offen offset:1024 lds
    s_add_u32 s36, s36, 128
    v_mfma_f32_16x16x32_bf16 v[168:171], a[16:19], a[68:71], v[168:171]
    v_mfma_f32_16x16x32_bf16 v[172:175], a[20:23], a[68:71], v[172:175]
    v_mfma_f32_16x16x32_bf16 v[232:235], a[24:27], a[68:71], v[232:235]
    ds_read_b128 a[36:39], v3 offset:2048
    v_mfma_f32_16x16x32_bf16 v[236:239], a[28:31], a[68:71], v[236:239]
    ds_read_b64_tr_b16 a[68:69], v5 offset:16384
    v_mfma_f32_16x16x32_bf16 v[48:51], a[0:3], a[72:75], v[48:51]
    ds_read_b64_tr_b16 a[70:71], v5 offset:18432
    v_mfma_f32_16x16x32_bf16 v[52:55], a[4:7], a[72:75], v[52:55]
    buffer_load_dwordx4 v12, s[24:27], s37 offen offset:2048 lds
    v_mfma_f32_16x16x32_bf16 v[112:115], a[8:11], a[72:75], v[112:115]
    ds_read_b128 a[40:43], v3 offset:4096
    v_mfma_f32_16x16x32_bf16 v[116:119], a[12:15], a[72:75], v[116:119]
    v_mfma_f32_16x16x32_bf16 v[176:179], a[16:19], a[72:75], v[176:179]
    v_mfma_f32_16x16x32_bf16 v[180:183], a[20:23], a[72:75], v[180:183]
    v_mfma_f32_16x16x32_bf16 v[240:243], a[24:27], a[72:75], v[240:243]
    ds_read_b128 a[44:47], v3 offset:6144
    v_mfma_f32_16x16x32_bf16 v[244:247], a[28:31], a[72:75], v[244:247]
    ds_read_b64_tr_b16 a[72:73], v6 offset:16384
    buffer_load_dwordx4 v13, s[24:27], s37 offen offset:3072 lds
    s_add_u32 s37, s37, 128
    v_mfma_f32_16x16x32_bf16 v[56:59], a[0:3], a[76:79], v[56:59]
    ds_read_b64_tr_b16 a[74:75], v6 offset:18432
    v_mfma_f32_16x16x32_bf16 v[60:63], a[4:7], a[76:79], v[60:63]
    v_mfma_f32_16x16x32_bf16 v[120:123], a[8:11], a[76:79], v[120:123]
    ds_read_b128 a[48:51], v3 offset:8192
    v_mfma_f32_16x16x32_bf16 v[124:127], a[12:15], a[76:79], v[124:127]
    v_mfma_f32_16x16x32_bf16 v[184:187], a[16:19], a[76:79], v[184:187]
    s_add_u32 m0, s48, 4096
    s_nop 0
    buffer_load_dwordx4 v12, s[24:27], s38 offen offset:0 lds
    v_mfma_f32_16x16x32_bf16 v[188:191], a[20:23], a[76:79], v[188:191]
    v_mfma_f32_16x16x32_bf16 v[248:251], a[24:27], a[76:79], v[248:251]
    ds_read_b128 a[52:55], v3 offset:10240
    v_mfma_f32_16x16x32_bf16 v[252:255], a[28:31], a[76:79], v[252:255]
    ds_read_b64_tr_b16 a[76:77], v7 offset:16384
    s_waitcnt lgkmcnt(15)
    v_mfma_f32_16x16x32_bf16 v[64:67], a[0:3], a[80:83], v[64:67]
    ds_read_b64_tr_b16 a[78:79], v7 offset:18432
    v_mfma_f32_16x16x32_bf16 v[68:71], a[4:7], a[80:83], v[68:71]
    v_mfma_f32_16x16x32_bf16 v[128:131], a[8:11], a[80:83], v[128:131]
    ds_read_b128 a[56:59], v3 offset:12288
    v_mfma_f32_16x16x32_bf16 v[132:135], a[12:15], a[80:83], v[132:135]
    buffer_load_dwordx4 v13, s[24:27], s38 offen offset:1024 lds
    s_add_u32 s38, s38, 128
    v_mfma_f32_16x16x32_bf16 v[192:195], a[16:19], a[80:83], v[192:195]
    v_mfma_f32_16x16x32_bf16 v[196:199], a[20:23], a[80:83], v[196:199]
    v_mfma_f32_16x16x32_bf16 a[96:99], a[24:27], a[80:83], a[96:99]
    ds_read_b128 a[60:63], v3 offset:14336
    v_mfma_f32_16x16x32_bf16 a[100:103], a[28:31], a[80:83], a[100:103]
    ds_read_b64_tr_b16 a[80:81], v8 offset:16384
    v_mfma_f32_16x16x32_bf16 v[72:75], a[0:3], a[84:87], v[72:75]
    ds_read_b64_tr_b16 a[82:83], v8 offset:18432
    v_mfma_f32_16x16x32_bf16 v[76:79], a[4:7], a[84:87], v[76:79]
    buffer_load_dwordx4 v12, s[24:27], s39 offen offset:2048 lds
    v_mfma_f32_16x16x32_bf16 v[136:139], a[8:11], a[84:87], v[136:139]
    v_mfma_f32_16x16x32_bf16 v[140:143], a[12:15], a[84:87], v[140:143]
    v_mfma_f32_16x16x32_bf16 v[200:203], a[16:19], a[84:87], v[200:203]
    v_mfma_f32_16x16x32_bf16 v[204:207], a[20:23], a[84:87], v[204:207]
    v_mfma_f32_16x16x32_bf16 a[104:107], a[24:27], a[84:87], a[104:107]
    buffer_load_dwordx4 v13, s[24:27], s39 offen offset:3072 lds
    s_add_u32 s39, s39, 128
    v_mfma_f32_16x16x32_bf16 a[108:111], a[28:31], a[84:87], a[108:111]
    ds_read_b64_tr_b16 a[84:85], v9 offset:16384
    v_mfma_f32_16x16x32_bf16 v[80:83], a[0:3], a[88:91], v[80:83]
    ds_read_b64_tr_b16 a[86:87], v9 offset:18432
    v_mfma_f32_16x16x32_bf16 v[84:87], a[4:7], a[88:91], v[84:87]
    v_mfma_f32_16x16x32_bf16 v[144:147], a[8:11], a[88:91], v[144:147]
    v_mfma_f32_16x16x32_bf16 v[148:151], a[12:15], a[88:91], v[148:151]
    v_mfma_f32_16x16x32_bf16 v[208:211], a[16:19], a[88:91], v[208:211]
    v_mfma_f32_16x16x32_bf16 v[212:215], a[20:23], a[88:91], v[212:215]
    s_add_u32 s48, s48, 32768
    s_cmp_ge_u32 s48, 98304
    s_cselect_b32 s54, 98304, 0
    s_sub_u32 s48, s48, s54
    v_mfma_f32_16x16x32_bf16 a[112:115], a[24:27], a[88:91], a[112:115]
    v_mfma_f32_16x16x32_bf16 a[116:119], a[28:31], a[88:91], a[116:119]
    ds_read_b64_tr_b16 a[88:89], v10 offset:16384
    s_waitcnt lgkmcnt(15)
    v_mfma_f32_16x16x32_bf16 v[88:91], a[0:3], a[92:95], v[88:91]
    ds_read_b64_tr_b16 a[90:91], v10 offset:18432
    v_mfma_f32_16x16x32_bf16 v[92:95], a[4:7], a[92:95], v[92:95]
    s_add_u32 s51, s51, 32768
    s_cmp_ge_u32 s51, 98304
    s_cselect_b32 s50, 4294901760, s22
    s_cselect_b32 s51, 0, s51
    v_mfma_f32_16x16x32_bf16 v[152:155], a[8:11], a[92:95], v[152:155]
    v_add_u32 v2, s50, v2
    v_mfma_f32_16x16x32_bf16 v[156:159], a[12:15], a[92:95], v[156:159]
    v_add_u32 v3, s50, v3
    v_mfma_f32_16x16x32_bf16 v[216:219], a[16:19], a[92:95], v[216:219]
    v_mfma_f32_16x16x32_bf16 v[220:223], a[20:23], a[92:95], v[220:223]
    v_mfma_f32_16x16x32_bf16 a[120:123], a[24:27], a[92:95], a[120:123]
    v_mfma_f32_16x16x32_bf16 a[124:127], a[28:31], a[92:95], a[124:127]
    ds_read_b64_tr_b16 a[92:93], v11 offset:16384
    ds_read_b64_tr_b16 a[94:95], v11 offset:18432
    v_mfma_f32_16x16x32_bf16 v[32:35], a[32:35], a[64:67], v[32:35]
    v_xor_b32 v4, s23, v4
    v_mfma_f32_16x16x32_bf16 v[36:39], a[36:39], a[64:67], v[36:39]
    v_xor_b32 v5, s23, v5
    s_waitcnt lgkmcnt(15)
    v_mfma_f32_16x16x32_bf16 v[96:99], a[40:43], a[64:67], v[96:99]
    v_xor_b32 v6, s23, v6
    v_mfma_f32_16x16x32_bf16 v[100:103], a[44:47], a[64:67], v[100:103]
    v_xor_b32 v7, s23, v7
    s_waitcnt lgkmcnt(13)
    v_mfma_f32_16x16x32_bf16 v[160:163], a[48:51], a[64:67], v[160:163]
    v_xor_b32 v8, s23, v8
    s_waitcnt lgkmcnt(12)
    v_mfma_f32_16x16x32_bf16 v[164:167], a[52:55], a[64:67], v[164:167]
    v_xor_b32 v9, s23, v9
    s_waitcnt lgkmcnt(9)
    v_mfma_f32_16x16x32_bf16 v[224:227], a[56:59], a[64:67], v[224:227]
    v_xor_b32 v10, s23, v10
    v_xor_b32 v11, s23, v11
    s_waitcnt lgkmcnt(8)
    s_waitcnt lgkmcnt(0)
    s_waitcnt vmcnt(8)
    v_mfma_f32_16x16x32_bf16 v[228:231], a[60:63], a[64:67], v[228:231]
    s_barrier
    ds_read_b64_tr_b16 a[64:65], v4 offset:0
    v_mfma_f32_16x16x32_bf16 v[40:43], a[32:35], a[68:71], v[40:43]
    ds_read_b64_tr_b16 a[66:67], v4 offset:2048
    v_mfma_f32_16x16x32_bf16 v[44:47], a[36:39], a[68:71], v[44:47]
    s_add_u32 m0, s49, 0
    s_nop 0
    buffer_load_dwordx4 v14, s[28:31], s40 offen offset:0 lds
    v_mfma_f32_16x16x32_bf16 v[104:107], a[40:43], a[68:71], v[104:107]
    ds_read_b128 a[0:3], v2 offset:0
    v_mfma_f32_16x16x32_bf16 v[108:111], a[44:47], a[68:71], v[108:111]
    v_mfma_f32_16x16x32_bf16 v[168:171], a[48:51], a[68:71], v[168:171]
    v_mfma_f32_16x16x32_bf16 v[172:175], a[52:55], a[68:71], v[172:175]
    buffer_load_dwordx4 v15, s[28:31], s40 offen offset:1024 lds
    s_add_u32 s40, s40, s44
    v_mfma_f32_16x16x32_bf16 v[232:235], a[56:59], a[68:71], v[232:235]
    ds_read_b128 a[4:7], v2 offset:2048
    v_mfma_f32_16x16x32_bf16 v[236:239], a[60:63], a[68:71], v[236:239]
    ds_read_b64_tr_b16 a[68:69], v5 offset:0
    v_mfma_f32_16x16x32_bf16 v[48:51], a[32:35], a[72:75], v[48:51]
    ds_read_b64_tr_b16 a[70:71], v5 offset:2048
    v_mfma_f32_16x16x32_bf16 v[52:55], a[36:39], a[72:75], v[52:55]
    buffer_load_dwordx4 v14, s[28:31], s41 offen offset:2048 lds
    v_mfma_f32_16x16x32_bf16 v[112:115], a[40:43], a[72:75], v[112:115]
    ds_read_b128 a[8:11], v2 offset:4096
    v_mfma_f32_16x16x32_bf16 v[116:119], a[44:47], a[72:75], v[116:119]
    v_mfma_f32_16x16x32_bf16 v[176:179], a[48:51], a[72:75], v[176:179]
    v_mfma_f32_16x16x32_bf16 v[180:183], a[52:55], a[72:75], v[180:183]
    buffer_load_dwordx4 v15, s[28:31], s41 offen offset:3072 lds
    s_add_u32 s41, s41, s44
    v_mfma_f32_16x16x32_bf16 v[240:243], a[56:59], a[72:75], v[240:243]
    ds_read_b128 a[12:15], v2 offset:6144
    v_mfma_f32_16x16x32_bf16 v[244:247], a[60:63], a[72:75], v[244:247]
    ds_read_b64_tr_b16 a[72:73], v6 offset:0
    v_mfma_f32_16x16x32_bf16 v[56:59], a[32:35], a[76:79], v[56:59]
    ds_read_b64_tr_b16 a[74:75], v6 offset:2048
    v_mfma_f32_16x16x32_bf16 v[60:63], a[36:39], a[76:79], v[60:63]
    s_add_u32 m0, s49, 4096
    s_nop 0
    buffer_load_dwordx4 v16, s[28:31], s42 offen offset:0 lds
    v_mfma_f32_16x16x32_bf16 v[120:123], a[40:43], a[76:79], v[120:123]
    ds_read_b128 a[16:19], v2 offset:8192
    v_mfma_f32_16x16x32_bf16 v[124:127], a[44:47], a[76:79], v[124:127]
    v_mfma_f32_16x16x32_bf16 v[184:187], a[48:51], a[76:79], v[184:187]
    v_mfma_f32_16x16x32_bf16 v[188:191], a[52:55], a[76:79], v[188:191]
    buffer_load_dwordx4 v17, s[28:31], s42 offen offset:1024 lds
    s_add_u32 s42, s42, s44
    v_mfma_f32_16x16x32_bf16 v[248:251], a[56:59], a[76:79], v[248:251]
    ds_read_b128 a[20:23], v2 offset:10240
    v_mfma_f32_16x16x32_bf16 v[252:255], a[60:63], a[76:79], v[252:255]
    ds_read_b64_tr_b16 a[76:77], v7 offset:0
    v_mfma_f32_16x16x32_bf16 v[64:67], a[32:35], a[80:83], v[64:67]
    ds_read_b64_tr_b16 a[78:79], v7 offset:2048
    v_mfma_f32_16x16x32_bf16 v[68:71], a[36:39], a[80:83], v[68:71]
    buffer_load_dwordx4 v16, s[28:31], s43 offen offset:2048 lds
    v_mfma_f32_16x16x32_bf16 v[128:131], a[40:43], a[80:83], v[128:131]
    ds_read_b128 a[24:27], v2 offset:12288
    v_mfma_f32_16x16x32_bf16 v[132:135], a[44:47], a[80:83], v[132:135]
    v_mfma_f32_16x16x32_bf16 v[192:195], a[48:51], a[80:83], v[192:195]
    v_mfma_f32_16x16x32_bf16 v[196:199], a[52:55], a[80:83], v[196:199]
    buffer_load_dwordx4 v17, s[28:31], s43 offen offset:3072 lds
    s_add_u32 s43, s43, s44
    v_mfma_f32_16x16x32_bf16 a[96:99], a[56:59], a[80:83], a[96:99]
    ds_read_b128 a[28:31], v2 offset:14336
    v_mfma_f32_16x16x32_bf16 a[100:103], a[60:63], a[80:83], a[100:103]
    ds_read_b64_tr_b16 a[80:81], v8 offset:0
    v_mfma_f32_16x16x32_bf16 v[72:75], a[32:35], a[84:87], v[72:75]
    ds_read_b64_tr_b16 a[82:83], v8 offset:2048
    v_mfma_f32_16x16x32_bf16 v[76:79], a[36:39], a[84:87], v[76:79]
    v_mfma_f32_16x16x32_bf16 v[136:139], a[40:43], a[84:87], v[136:139]
    v_mfma_f32_16x16x32_bf16 v[140:143], a[44:47], a[84:87], v[140:143]
    v_mfma_f32_16x16x32_bf16 v[200:203], a[48:51], a[84:87], v[200:203]
    s_xor_b32 s49, s49, 229376
    v_mfma_f32_16x16x32_bf16 v[204:207], a[52:55], a[84:87], v[204:207]
    v_mfma_f32_16x16x32_bf16 a[104:107], a[56:59], a[84:87], a[104:107]
    v_mfma_f32_16x16x32_bf16 a[108:111], a[60:63], a[84:87], a[108:111]
    ds_read_b64_tr_b16 a[84:85], v9 offset:0
    v_mfma_f32_16x16x32_bf16 v[80:83], a[32:35], a[88:91], v[80:83]
    ds_read_b64_tr_b16 a[86:87], v9 offset:2048
    v_mfma_f32_16x16x32_bf16 v[84:87], a[36:39], a[88:91], v[84:87]
    v_mfma_f32_16x16x32_bf16 v[144:147], a[40:43], a[88:91], v[144:147]
    v_mfma_f32_16x16x32_bf16 v[148:151], a[44:47], a[88:91], v[148:151]
    v_mfma_f32_16x16x32_bf16 v[208:211], a[48:51], a[88:91], v[208:211]
    v_mfma_f32_16x16x32_bf16 v[212:215], a[52:55], a[88:91], v[212:215]
    v_mfma_f32_16x16x32_bf16 a[112:115], a[56:59], a[88:91], a[112:115]
    v_mfma_f32_16x16x32_bf16 a[116:119], a[60:63], a[88:91], a[116:119]
    ds_read_b64_tr_b16 a[88:89], v10 offset:0
    v_mfma_f32_16x16x32_bf16 v[88:91], a[32:35], a[92:95], v[88:91]
    ds_read_b64_tr_b16 a[90:91], v10 offset:2048
    v_mfma_f32_16x16x32_bf16 v[92:95], a[36:39], a[92:95], v[92:95]
    v_mfma_f32_16x16x32_bf16 v[152:155], a[40:43], a[92:95], v[152:155]
    v_mfma_f32_16x16x32_bf16 v[156:159], a[44:47], a[92:95], v[156:159]
    v_mfma_f32_16x16x32_bf16 v[216:219], a[48:51], a[92:95], v[216:219]
    v_mfma_f32_16x16x32_bf16 v[220:223], a[52:55], a[92:95], v[220:223]
    v_mfma_f32_16x16x32_bf16 a[120:123], a[56:59], a[92:95], a[120:123]
    v_mfma_f32_16x16x32_bf16 a[124:127], a[60:63], a[92:95], a[124:127]
    ds_read_b64_tr_b16 a[92:93], v11 offset:0
    ds_read_b64_tr_b16 a[94:95], v11 offset:2048
    s_sub_u32 s52, s52, 1
    s_cmp_lg_u32 s52, 0
    s_cbranch_scc1 gemm1_kernel_loop15
gemm1_kernel_epi8:
    s_nop 7
    s_cmp_eq_u32 s76, 0
    s_cbranch_scc1 gemm1_kernel_noscale18
    s_mov_b32 s55, s77
    s_mov_b32 s56, s55
    v_mul_f32 v32, s76, v32
    v_mul_f32 v33, s76, v33
    v_mul_f32 v34, s76, v34
    v_mul_f32 v35, s76, v35
    v_mul_f32 v36, s76, v36
    v_mul_f32 v37, s76, v37
    v_mul_f32 v38, s76, v38
    v_mul_f32 v39, s76, v39
    v_cvt_pk_bf16_f32 v32, v32, v33
    v_cvt_pk_bf16_f32 v33, v34, v35
    v_cvt_pk_bf16_f32 v34, v36, v37
    v_cvt_pk_bf16_f32 v35, v38, v39
    buffer_store_dwordx4 v[32:35], v18, s[32:35], s56 offen
    s_add_u32 s56, s56, s79
    v_mul_f32 v40, s76, v40
    v_mul_f32 v41, s76, v41
    v_mul_f32 v42, s76, v42
    v_mul_f32 v43, s76, v43
    v_mul_f32 v44, s76, v44
    v_mul_f32 v45, s76, v45
    v_mul_f32 v46, s76, v46
    v_mul_f32 v47, s76, v47
    v_cvt_pk_bf16_f32 v40, v40, v41
    v_cvt_pk_bf16_f32 v41, v42, v43
    v_cvt_pk_bf16_f32 v42, v44, v45
    v_cvt_pk_bf16_f32 v43, v46, v47
    buffer_store_dwordx4 v[40:43], v18, s[32:35], s56 offen
    s_add_u32 s56, s56, s79
    v_mul_f32 v48, s76, v48
    v_mul_f32 v49, s76, v49
    v_mul_f32 v50, s76, v50
    v_mul_f32 v51, s76, v51
    v_mul_f32 v52, s76, v52
    v_mul_f32 v53, s76, v53
    v_mul_f32 v54, s76, v54
    v_mul_f32 v55, s76, v55
    v_cvt_pk_bf16_f32 v48, v48, v49
    v_cvt_pk_bf16_f32 v49, v50, v51
    v_cvt_pk_bf16_f32 v50, v52, v53
    v_cvt_pk_bf16_f32 v51, v54, v55
    buffer_store_dwordx4 v[48:51], v18, s[32:35], s56 offen
    s_add_u32 s56, s56, s79
    v_mul_f32 v56, s76, v56
    v_mul_f32 v57, s76, v57
    v_mul_f32 v58, s76, v58
    v_mul_f32 v59, s76, v59
    v_mul_f32 v60, s76, v60
    v_mul_f32 v61, s76, v61
    v_mul_f32 v62, s76, v62
    v_mul_f32 v63, s76, v63
    v_cvt_pk_bf16_f32 v56, v56, v57
    v_cvt_pk_bf16_f32 v57, v58, v59
    v_cvt_pk_bf16_f32 v58, v60, v61
    v_cvt_pk_bf16_f32 v59, v62, v63
    buffer_store_dwordx4 v[56:59], v18, s[32:35], s56 offen
    s_add_u32 s56, s56, s79
    v_mul_f32 v64, s76, v64
    v_mul_f32 v65, s76, v65
    v_mul_f32 v66, s76, v66
    v_mul_f32 v67, s76, v67
    v_mul_f32 v68, s76, v68
    v_mul_f32 v69, s76, v69
    v_mul_f32 v70, s76, v70
    v_mul_f32 v71, s76, v71
    v_cvt_pk_bf16_f32 v64, v64, v65
    v_cvt_pk_bf16_f32 v65, v66, v67
    v_cvt_pk_bf16_f32 v66, v68, v69
    v_cvt_pk_bf16_f32 v67, v70, v71
    buffer_store_dwordx4 v[64:67], v18, s[32:35], s56 offen
    s_add_u32 s56, s56, s79
    v_mul_f32 v72, s76, v72
    v_mul_f32 v73, s76, v73
    v_mul_f32 v74, s76, v74
    v_mul_f32 v75, s76, v75
    v_mul_f32 v76, s76, v76
    v_mul_f32 v77, s76, v77
    v_mul_f32 v78, s76, v78
    v_mul_f32 v79, s76, v79
    v_cvt_pk_bf16_f32 v72, v72, v73
    v_cvt_pk_bf16_f32 v73, v74, v75
    v_cvt_pk_bf16_f32 v74, v76, v77
    v_cvt_pk_bf16_f32 v75, v78, v79
    buffer_store_dwordx4 v[72:75], v18, s[32:35], s56 offen
    s_add_u32 s56, s56, s79
    v_mul_f32 v80, s76, v80
    v_mul_f32 v81, s76, v81
    v_mul_f32 v82, s76, v82
    v_mul_f32 v83, s76, v83
    v_mul_f32 v84, s76, v84
    v_mul_f32 v85, s76, v85
    v_mul_f32 v86, s76, v86
    v_mul_f32 v87, s76, v87
    v_cvt_pk_bf16_f32 v80, v80, v81
    v_cvt_pk_bf16_f32 v81, v82, v83
    v_cvt_pk_bf16_f32 v82, v84, v85
    v_cvt_pk_bf16_f32 v83, v86, v87
    buffer_store_dwordx4 v[80:83], v18, s[32:35], s56 offen
    s_add_u32 s56, s56, s79
    v_mul_f32 v88, s76, v88
    v_mul_f32 v89, s76, v89
    v_mul_f32 v90, s76, v90
    v_mul_f32 v91, s76, v91
    v_mul_f32 v92, s76, v92
    v_mul_f32 v93, s76, v93
    v_mul_f32 v94, s76, v94
    v_mul_f32 v95, s76, v95
    v_cvt_pk_bf16_f32 v88, v88, v89
    v_cvt_pk_bf16_f32 v89, v90, v91
    v_cvt_pk_bf16_f32 v90, v92, v93
    v_cvt_pk_bf16_f32 v91, v94, v95
    buffer_store_dwordx4 v[88:91], v18, s[32:35], s56 offen
    s_add_u32 s56, s56, s79
    s_add_u32 s55, s55, s78
    s_mov_b32 s56, s55
    v_mul_f32 v96, s76, v96
    v_mul_f32 v97, s76, v97
    v_mul_f32 v98, s76, v98
    v_mul_f32 v99, s76, v99
    v_mul_f32 v100, s76, v100
    v_mul_f32 v101, s76, v101
    v_mul_f32 v102, s76, v102
    v_mul_f32 v103, s76, v103
    v_cvt_pk_bf16_f32 v96, v96, v97
    v_cvt_pk_bf16_f32 v97, v98, v99
    v_cvt_pk_bf16_f32 v98, v100, v101
    v_cvt_pk_bf16_f32 v99, v102, v103
    buffer_store_dwordx4 v[96:99], v18, s[32:35], s56 offen
    s_add_u32 s56, s56, s79
    v_mul_f32 v104, s76, v104
    v_mul_f32 v105, s76, v105
    v_mul_f32 v106, s76, v106
    v_mul_f32 v107, s76, v107
    v_mul_f32 v108, s76, v108
    v_mul_f32 v109, s76, v109
    v_mul_f32 v110, s76, v110
    v_mul_f32 v111, s76, v111
    v_cvt_pk_bf16_f32 v104, v104, v105
    v_cvt_pk_bf16_f32 v105, v106, v107
    v_cvt_pk_bf16_f32 v106, v108, v109
    v_cvt_pk_bf16_f32 v107, v110, v111
    buffer_store_dwordx4 v[104:107], v18, s[32:35], s56 offen
    s_add_u32 s56, s56, s79
    v_mul_f32 v112, s76, v112
    v_mul_f32 v113, s76, v113
    v_mul_f32 v114, s76, v114
    v_mul_f32 v115, s76, v115
    v_mul_f32 v116, s76, v116
    v_mul_f32 v117, s76, v117
    v_mul_f32 v118, s76, v118
    v_mul_f32 v119, s76, v119
    v_cvt_pk_bf16_f32 v112, v112, v113
    v_cvt_pk_bf16_f32 v113, v114, v115
    v_cvt_pk_bf16_f32 v114, v116, v117
    v_cvt_pk_bf16_f32 v115, v118, v119
    buffer_store_dwordx4 v[112:115], v18, s[32:35], s56 offen
    s_add_u32 s56, s56, s79
    v_mul_f32 v120, s76, v120
    v_mul_f32 v121, s76, v121
    v_mul_f32 v122, s76, v122
    v_mul_f32 v123, s76, v123
    v_mul_f32 v124, s76, v124
    v_mul_f32 v125, s76, v125
    v_mul_f32 v126, s76, v126
    v_mul_f32 v127, s76, v127
    v_cvt_pk_bf16_f32 v120, v120, v121
    v_cvt_pk_bf16_f32 v121, v122, v123
    v_cvt_pk_bf16_f32 v122, v124, v125
    v_cvt_pk_bf16_f32 v123, v126, v127
    buffer_store_dwordx4 v[120:123], v18, s[32:35], s56 offen
    s_add_u32 s56, s56, s79
    v_mul_f32 v128, s76, v128
    v_mul_f32 v129, s76, v129
    v_mul_f32 v130, s76, v130
    v_mul_f32 v131, s76, v131
    v_mul_f32 v132, s76, v132
    v_mul_f32 v133, s76, v133
    v_mul_f32 v134, s76, v134
    v_mul_f32 v135, s76, v135
    v_cvt_pk_bf16_f32 v128, v128, v129
    v_cvt_pk_bf16_f32 v129, v130, v131
    v_cvt_pk_bf16_f32 v130, v132, v133
    v_cvt_pk_bf16_f32 v131, v134, v135
    buffer_store_dwordx4 v[128:131], v18, s[32:35], s56 offen
    s_add_u32 s56, s56, s79
    v_mul_f32 v136, s76, v136
    v_mul_f32 v137, s76, v137
    v_mul_f32 v138, s76, v138
    v_mul_f32 v139, s76, v139
    v_mul_f32 v140, s76, v140
    v_mul_f32 v141, s76, v141
    v_mul_f32 v142, s76, v142
    v_mul_f32 v143, s76, v143
    v_cvt_pk_bf16_f32 v136, v136, v137
    v_cvt_pk_bf16_f32 v137, v138, v139
    v_cvt_pk_bf16_f32 v138, v140, v141
    v_cvt_pk_bf16_f32 v139, v142, v143
    buffer_store_dwordx4 v[136:139], v18, s[32:35], s56 offen
    s_add_u32 s56, s56, s79
    v_mul_f32 v144, s76, v144
    v_mul_f32 v145, s76, v145
    v_mul_f32 v146, s76, v146
    v_mul_f32 v147, s76, v147
    v_mul_f32 v148, s76, v148
    v_mul_f32 v149, s76, v149
    v_mul_f32 v150, s76, v150
    v_mul_f32 v151, s76, v151
    v_cvt_pk_bf16_f32 v144, v144, v145
    v_cvt_pk_bf16_f32 v145, v146, v147
    v_cvt_pk_bf16_f32 v146, v148, v149
    v_cvt_pk_bf16_f32 v147, v150, v151
    buffer_store_dwordx4 v[144:147], v18, s[32:35], s56 offen
    s_add_u32 s56, s56, s79
    v_mul_f32 v152, s76, v152
    v_mul_f32 v153, s76, v153
    v_mul_f32 v154, s76, v154
    v_mul_f32 v155, s76, v155
    v_mul_f32 v156, s76, v156
    v_mul_f32 v157, s76, v157
    v_mul_f32 v158, s76, v158
    v_mul_f32 v159, s76, v159
    v_cvt_pk_bf16_f32 v152, v152, v153
    v_cvt_pk_bf16_f32 v153, v154, v155
    v_cvt_pk_bf16_f32 v154, v156, v157
    v_cvt_pk_bf16_f32 v155, v158, v159
    buffer_store_dwordx4 v[152:155], v18, s[32:35], s56 offen
    s_add_u32 s56, s56, s79
    s_add_u32 s55, s55, s78
    s_mov_b32 s56, s55
    v_mul_f32 v160, s76, v160
    v_mul_f32 v161, s76, v161
    v_mul_f32 v162, s76, v162
    v_mul_f32 v163, s76, v163
    v_mul_f32 v164, s76, v164
    v_mul_f32 v165, s76, v165
    v_mul_f32 v166, s76, v166
    v_mul_f32 v167, s76, v167
    v_cvt_pk_bf16_f32 v160, v160, v161
    v_cvt_pk_bf16_f32 v161, v162, v163
    v_cvt_pk_bf16_f32 v162, v164, v165
    v_cvt_pk_bf16_f32 v163, v166, v167
    buffer_store_dwordx4 v[160:163], v18, s[32:35], s56 offen
    s_add_u32 s56, s56, s79
    v_mul_f32 v168, s76, v168
    v_mul_f32 v169, s76, v169
    v_mul_f32 v170, s76, v170
    v_mul_f32 v171, s76, v171
    v_mul_f32 v172, s76, v172
    v_mul_f32 v173, s76, v173
    v_mul_f32 v174, s76, v174
    v_mul_f32 v175, s76, v175
    v_cvt_pk_bf16_f32 v168, v168, v169
    v_cvt_pk_bf16_f32 v169, v170, v171
    v_cvt_pk_bf16_f32 v170, v172, v173
    v_cvt_pk_bf16_f32 v171, v174, v175
    buffer_store_dwordx4 v[168:171], v18, s[32:35], s56 offen
    s_add_u32 s56, s56, s79
    v_mul_f32 v176, s76, v176
    v_mul_f32 v177, s76, v177
    v_mul_f32 v178, s76, v178
    v_mul_f32 v179, s76, v179
    v_mul_f32 v180, s76, v180
    v_mul_f32 v181, s76, v181
    v_mul_f32 v182, s76, v182
    v_mul_f32 v183, s76, v183
    v_cvt_pk_bf16_f32 v176, v176, v177
    v_cvt_pk_bf16_f32 v177, v178, v179
    v_cvt_pk_bf16_f32 v178, v180, v181
    v_cvt_pk_bf16_f32 v179, v182, v183
    buffer_store_dwordx4 v[176:179], v18, s[32:35], s56 offen
    s_add_u32 s56, s56, s79
    v_mul_f32 v184, s76, v184
    v_mul_f32 v185, s76, v185
    v_mul_f32 v186, s76, v186
    v_mul_f32 v187, s76, v187
    v_mul_f32 v188, s76, v188
    v_mul_f32 v189, s76, v189
    v_mul_f32 v190, s76, v190
    v_mul_f32 v191, s76, v191
    v_cvt_pk_bf16_f32 v184, v184, v185
    v_cvt_pk_bf16_f32 v185, v186, v187
    v_cvt_pk_bf16_f32 v186, v188, v189
    v_cvt_pk_bf16_f32 v187, v190, v191
    buffer_store_dwordx4 v[184:187], v18, s[32:35], s56 offen
    s_add_u32 s56, s56, s79
    v_mul_f32 v192, s76, v192
    v_mul_f32 v193, s76, v193
    v_mul_f32 v194, s76, v194
    v_mul_f32 v195, s76, v195
    v_mul_f32 v196, s76, v196
    v_mul_f32 v197, s76, v197
    v_mul_f32 v198, s76, v198
    v_mul_f32 v199, s76, v199
    v_cvt_pk_bf16_f32 v192, v192, v193
    v_cvt_pk_bf16_f32 v193, v194, v195
    v_cvt_pk_bf16_f32 v194, v196, v197
    v_cvt_pk_bf16_f32 v195, v198, v199
    buffer_store_dwordx4 v[192:195], v18, s[32:35], s56 offen
    s_add_u32 s56, s56, s79
    v_mul_f32 v200, s76, v200
    v_mul_f32 v201, s76, v201
    v_mul_f32 v202, s76, v202
    v_mul_f32 v203, s76, v203
    v_mul_f32 v204, s76, v204
    v_mul_f32 v205, s76, v205
    v_mul_f32 v206, s76, v206
    v_mul_f32 v207, s76, v207
    v_cvt_pk_bf16_f32 v200, v200, v201
    v_cvt_pk_bf16_f32 v201, v202, v203
    v_cvt_pk_bf16_f32 v202, v204, v205
    v_cvt_pk_bf16_f32 v203, v206, v207
    buffer_store_dwordx4 v[200:203], v18, s[32:35], s56 offen
    s_add_u32 s56, s56, s79
    v_mul_f32 v208, s76, v208
    v_mul_f32 v209, s76, v209
    v_mul_f32 v210, s76, v210
    v_mul_f32 v211, s76, v211
    v_mul_f32 v212, s76, v212
    v_mul_f32 v213, s76, v213
    v_mul_f32 v214, s76, v214
    v_mul_f32 v215, s76, v215
    v_cvt_pk_bf16_f32 v208, v208, v209
    v_cvt_pk_bf16_f32 v209, v210, v211
    v_cvt_pk_bf16_f32 v210, v212, v213
    v_cvt_pk_bf16_f32 v211, v214, v215
    buffer_store_dwordx4 v[208:211], v18, s[32:35], s56 offen
    s_add_u32 s56, s56, s79
    v_mul_f32 v216, s76, v216
    v_mul_f32 v217, s76, v217
    v_mul_f32 v218, s76, v218
    v_mul_f32 v219, s76, v219
    v_mul_f32 v220, s76, v220
    v_mul_f32 v221, s76, v221
    v_mul_f32 v222, s76, v222
    v_mul_f32 v223, s76, v223
    v_cvt_pk_bf16_f32 v216, v216, v217
    v_cvt_pk_bf16_f32 v217, v218, v219
    v_cvt_pk_bf16_f32 v218, v220, v221
    v_cvt_pk_bf16_f32 v219, v222, v223
    buffer_store_dwordx4 v[216:219], v18, s[32:35], s56 offen
    s_add_u32 s56, s56, s79
    s_add_u32 s55, s55, s78
    s_mov_b32 s56, s55
    v_mul_f32 v224, s76, v224
    v_mul_f32 v225, s76, v225
    v_mul_f32 v226, s76, v226
    v_mul_f32 v227, s76, v227
    v_mul_f32 v228, s76, v228
    v_mul_f32 v229, s76, v229
    v_mul_f32 v230, s76, v230
    v_mul_f32 v231, s76, v231
    v_cvt_pk_bf16_f32 v224, v224, v225
    v_cvt_pk_bf16_f32 v225, v226, v227
    v_cvt_pk_bf16_f32 v226, v228, v229
    v_cvt_pk_bf16_f32 v227, v230, v231
    buffer_store_dwordx4 v[224:227], v18, s[32:35], s56 offen
    s_add_u32 s56, s56, s79
    v_mul_f32 v232, s76, v232
    v_mul_f32 v233, s76, v233
    v_mul_f32 v234, s76, v234
    v_mul_f32 v235, s76, v235
    v_mul_f32 v236, s76, v236
    v_mul_f32 v237, s76, v237
    v_mul_f32 v238, s76, v238
    v_mul_f32 v239, s76, v239
    v_cvt_pk_bf16_f32 v232, v232, v233
    v_cvt_pk_bf16_f32 v233, v234, v235
    v_cvt_pk_bf16_f32 v234, v236, v237
    v_cvt_pk_bf16_f32 v235, v238, v239
    buffer_store_dwordx4 v[232:235], v18, s[32:35], s56 offen
    s_add_u32 s56, s56, s79
    v_mul_f32 v240, s76, v240
    v_mul_f32 v241, s76, v241
    v_mul_f32 v242, s76, v242
    v_mul_f32 v243, s76, v243
    v_mul_f32 v244, s76, v244
    v_mul_f32 v245, s76, v245
    v_mul_f32 v246, s76, v246
    v_mul_f32 v247, s76, v247
    v_cvt_pk_bf16_f32 v240, v240, v241
    v_cvt_pk_bf16_f32 v241, v242, v243
    v_cvt_pk_bf16_f32 v242, v244, v245
    v_cvt_pk_bf16_f32 v243, v246, v247
    buffer_store_dwordx4 v[240:243], v18, s[32:35], s56 offen
    s_add_u32 s56, s56, s79
    v_mul_f32 v248, s76, v248
    v_mul_f32 v249, s76, v249
    v_mul_f32 v250, s76, v250
    v_mul_f32 v251, s76, v251
    v_mul_f32 v252, s76, v252
    v_mul_f32 v253, s76, v253
    v_mul_f32 v254, s76, v254
    v_mul_f32 v255, s76, v255
    v_cvt_pk_bf16_f32 v248, v248, v249
    v_cvt_pk_bf16_f32 v249, v250, v251
    v_cvt_pk_bf16_f32 v250, v252, v253
    v_cvt_pk_bf16_f32 v251, v254, v255
    buffer_store_dwordx4 v[248:251], v18, s[32:35], s56 offen
    s_add_u32 s56, s56, s79
    v_accvgpr_read_b32 v20, a96
    v_accvgpr_read_b32 v21, a97
    v_accvgpr_read_b32 v22, a98
    v_accvgpr_read_b32 v23, a99
    v_accvgpr_read_b32 v24, a100
    v_accvgpr_read_b32 v25, a101
    v_accvgpr_read_b32 v26, a102
    v_accvgpr_read_b32 v27, a103
    v_mul_f32 v20, s76, v20
    v_mul_f32 v21, s76, v21
    v_mul_f32 v22, s76, v22
    v_mul_f32 v23, s76, v23
    v_mul_f32 v24, s76, v24
    v_mul_f32 v25, s76, v25
    v_mul_f32 v26, s76, v26
    v_mul_f32 v27, s76, v27
    v_cvt_pk_bf16_f32 v20, v20, v21
    v_cvt_pk_bf16_f32 v21, v22, v23
    v_cvt_pk_bf16_f32 v22, v24, v25
    v_cvt_pk_bf16_f32 v23, v26, v27
    buffer_store_dwordx4 v[20:23], v18, s[32:35], s56 offen
    s_add_u32 s56, s56, s79
    s_nop 1
    v_accvgpr_read_b32 v20, a104
    v_accvgpr_read_b32 v21, a105
    v_accvgpr_read_b32 v22, a106
    v_accvgpr_read_b32 v23, a107
    v_accvgpr_read_b32 v24, a108
    v_accvgpr_read_b32 v25, a109
    v_accvgpr_read_b32 v26, a110
    v_accvgpr_read_b32 v27, a111
    v_mul_f32 v20, s76, v20
    v_mul_f32 v21, s76, v21
    v_mul_f32 v22, s76, v22
    v_mul_f32 v23, s76, v23
    v_mul_f32 v24, s76, v24
    v_mul_f32 v25, s76, v25
    v_mul_f32 v26, s76, v26
    v_mul_f32 v27, s76, v27
    v_cvt_pk_bf16_f32 v20, v20, v21
    v_cvt_pk_bf16_f32 v21, v22, v23
    v_cvt_pk_bf16_f32 v22, v24, v25
    v_cvt_pk_bf16_f32 v23, v26, v27
    buffer_store_dwordx4 v[20:23], v18, s[32:35], s56 offen
    s_add_u32 s56, s56, s79
    s_nop 1
    v_accvgpr_read_b32 v20, a112
    v_accvgpr_read_b32 v21, a113
    v_accvgpr_read_b32 v22, a114
    v_accvgpr_read_b32 v23, a115
    v_accvgpr_read_b32 v24, a116
    v_accvgpr_read_b32 v25, a117
    v_accvgpr_read_b32 v26, a118
    v_accvgpr_read_b32 v27, a119
    v_mul_f32 v20, s76, v20
    v_mul_f32 v21, s76, v21
    v_mul_f32 v22, s76, v22
    v_mul_f32 v23, s76, v23
    v_mul_f32 v24, s76, v24
    v_mul_f32 v25, s76, v25
    v_mul_f32 v26, s76, v26
    v_mul_f32 v27, s76, v27
    v_cvt_pk_bf16_f32 v20, v20, v21
    v_cvt_pk_bf16_f32 v21, v22, v23
    v_cvt_pk_bf16_f32 v22, v24, v25
    v_cvt_pk_bf16_f32 v23, v26, v27
    buffer_store_dwordx4 v[20:23], v18, s[32:35], s56 offen
    s_add_u32 s56, s56, s79
    s_nop 1
    v_accvgpr_read_b32 v20, a120
    v_accvgpr_read_b32 v21, a121
    v_accvgpr_read_b32 v22, a122
    v_accvgpr_read_b32 v23, a123
    v_accvgpr_read_b32 v24, a124
    v_accvgpr_read_b32 v25, a125
    v_accvgpr_read_b32 v26, a126
    v_accvgpr_read_b32 v27, a127
    v_mul_f32 v20, s76, v20
    v_mul_f32 v21, s76, v21
    v_mul_f32 v22, s76, v22
    v_mul_f32 v23, s76, v23
    v_mul_f32 v24, s76, v24
    v_mul_f32 v25, s76, v25
    v_mul_f32 v26, s76, v26
    v_mul_f32 v27, s76, v27
    v_cvt_pk_bf16_f32 v20, v20, v21
    v_cvt_pk_bf16_f32 v21, v22, v23
    v_cvt_pk_bf16_f32 v22, v24, v25
    v_cvt_pk_bf16_f32 v23, v26, v27
    buffer_store_dwordx4 v[20:23], v18, s[32:35], s56 offen
    s_add_u32 s56, s56, s79
    s_nop 1
    s_add_u32 s55, s55, s78
    s_branch gemm1_kernel_epd19
gemm1_kernel_noscale18:
    s_mov_b32 s55, s77
    s_mov_b32 s56, s55
    v_cvt_pk_bf16_f32 v32, v32, v33
    v_cvt_pk_bf16_f32 v33, v34, v35
    v_cvt_pk_bf16_f32 v34, v36, v37
    v_cvt_pk_bf16_f32 v35, v38, v39
    buffer_store_dwordx4 v[32:35], v18, s[32:35], s56 offen
    s_add_u32 s56, s56, s79
    v_cvt_pk_bf16_f32 v40, v40, v41
    v_cvt_pk_bf16_f32 v41, v42, v43
    v_cvt_pk_bf16_f32 v42, v44, v45
    v_cvt_pk_bf16_f32 v43, v46, v47
    buffer_store_dwordx4 v[40:43], v18, s[32:35], s56 offen
    s_add_u32 s56, s56, s79
    v_cvt_pk_bf16_f32 v48, v48, v49
    v_cvt_pk_bf16_f32 v49, v50, v51
    v_cvt_pk_bf16_f32 v50, v52, v53
    v_cvt_pk_bf16_f32 v51, v54, v55
    buffer_store_dwordx4 v[48:51], v18, s[32:35], s56 offen
    s_add_u32 s56, s56, s79
    v_cvt_pk_bf16_f32 v56, v56, v57
    v_cvt_pk_bf16_f32 v57, v58, v59
    v_cvt_pk_bf16_f32 v58, v60, v61
    v_cvt_pk_bf16_f32 v59, v62, v63
    buffer_store_dwordx4 v[56:59], v18, s[32:35], s56 offen
    s_add_u32 s56, s56, s79
    v_cvt_pk_bf16_f32 v64, v64, v65
    v_cvt_pk_bf16_f32 v65, v66, v67
    v_cvt_pk_bf16_f32 v66, v68, v69
    v_cvt_pk_bf16_f32 v67, v70, v71
    buffer_store_dwordx4 v[64:67], v18, s[32:35], s56 offen
    s_add_u32 s56, s56, s79
    v_cvt_pk_bf16_f32 v72, v72, v73
    v_cvt_pk_bf16_f32 v73, v74, v75
    v_cvt_pk_bf16_f32 v74, v76, v77
    v_cvt_pk_bf16_f32 v75, v78, v79
    buffer_store_dwordx4 v[72:75], v18, s[32:35], s56 offen
    s_add_u32 s56, s56, s79
    v_cvt_pk_bf16_f32 v80, v80, v81
    v_cvt_pk_bf16_f32 v81, v82, v83
    v_cvt_pk_bf16_f32 v82, v84, v85
    v_cvt_pk_bf16_f32 v83, v86, v87
    buffer_store_dwordx4 v[80:83], v18, s[32:35], s56 offen
    s_add_u32 s56, s56, s79
    v_cvt_pk_bf16_f32 v88, v88, v89
    v_cvt_pk_bf16_f32 v89, v90, v91
    v_cvt_pk_bf16_f32 v90, v92, v93
    v_cvt_pk_bf16_f32 v91, v94, v95
    buffer_store_dwordx4 v[88:91], v18, s[32:35], s56 offen
    s_add_u32 s56, s56, s79
    s_add_u32 s55, s55, s78
    s_mov_b32 s56, s55
    v_cvt_pk_bf16_f32 v96, v96, v97
    v_cvt_pk_bf16_f32 v97, v98, v99
    v_cvt_pk_bf16_f32 v98, v100, v101
    v_cvt_pk_bf16_f32 v99, v102, v103
    buffer_store_dwordx4 v[96:99], v18, s[32:35], s56 offen
    s_add_u32 s56, s56, s79
    v_cvt_pk_bf16_f32 v104, v104, v105
    v_cvt_pk_bf16_f32 v105, v106, v107
    v_cvt_pk_bf16_f32 v106, v108, v109
    v_cvt_pk_bf16_f32 v107, v110, v111
    buffer_store_dwordx4 v[104:107], v18, s[32:35], s56 offen
    s_add_u32 s56, s56, s79
    v_cvt_pk_bf16_f32 v112, v112, v113
    v_cvt_pk_bf16_f32 v113, v114, v115
    v_cvt_pk_bf16_f32 v114, v116, v117
    v_cvt_pk_bf16_f32 v115, v118, v119
    buffer_store_dwordx4 v[112:115], v18, s[32:35], s56 offen
    s_add_u32 s56, s56, s79
    v_cvt_pk_bf16_f32 v120, v120, v121
    v_cvt_pk_bf16_f32 v121, v122, v123
    v_cvt_pk_bf16_f32 v122, v124, v125
    v_cvt_pk_bf16_f32 v123, v126, v127
    buffer_store_dwordx4 v[120:123], v18, s[32:35], s56 offen
    s_add_u32 s56, s56, s79
    v_cvt_pk_bf16_f32 v128, v128, v129
    v_cvt_pk_bf16_f32 v129, v130, v131
    v_cvt_pk_bf16_f32 v130, v132, v133
    v_cvt_pk_bf16_f32 v131, v134, v135
    buffer_store_dwordx4 v[128:131], v18, s[32:35], s56 offen
    s_add_u32 s56, s56, s79
    v_cvt_pk_bf16_f32 v136, v136, v137
    v_cvt_pk_bf16_f32 v137, v138, v139
    v_cvt_pk_bf16_f32 v138, v140, v141
    v_cvt_pk_bf16_f32 v139, v142, v143
    buffer_store_dwordx4 v[136:139], v18, s[32:35], s56 offen
    s_add_u32 s56, s56, s79
    v_cvt_pk_bf16_f32 v144, v144, v145
    v_cvt_pk_bf16_f32 v145, v146, v147
    v_cvt_pk_bf16_f32 v146, v148, v149
    v_cvt_pk_bf16_f32 v147, v150, v151
    buffer_store_dwordx4 v[144:147], v18, s[32:35], s56 offen
    s_add_u32 s56, s56, s79
    v_cvt_pk_bf16_f32 v152, v152, v153
    v_cvt_pk_bf16_f32 v153, v154, v155
    v_cvt_pk_bf16_f32 v154, v156, v157
    v_cvt_pk_bf16_f32 v155, v158, v159
    buffer_store_dwordx4 v[152:155], v18, s[32:35], s56 offen
    s_add_u32 s56, s56, s79
    s_add_u32 s55, s55, s78
    s_mov_b32 s56, s55
    v_cvt_pk_bf16_f32 v160, v160, v161
    v_cvt_pk_bf16_f32 v161, v162, v163
    v_cvt_pk_bf16_f32 v162, v164, v165
    v_cvt_pk_bf16_f32 v163, v166, v167
    buffer_store_dwordx4 v[160:163], v18, s[32:35], s56 offen
    s_add_u32 s56, s56, s79
    v_cvt_pk_bf16_f32 v168, v168, v169
    v_cvt_pk_bf16_f32 v169, v170, v171
    v_cvt_pk_bf16_f32 v170, v172, v173
    v_cvt_pk_bf16_f32 v171, v174, v175
    buffer_store_dwordx4 v[168:171], v18, s[32:35], s56 offen
    s_add_u32 s56, s56, s79
    v_cvt_pk_bf16_f32 v176, v176, v177
    v_cvt_pk_bf16_f32 v177, v178, v179
    v_cvt_pk_bf16_f32 v178, v180, v181
    v_cvt_pk_bf16_f32 v179, v182, v183
    buffer_store_dwordx4 v[176:179], v18, s[32:35], s56 offen
    s_add_u32 s56, s56, s79
    v_cvt_pk_bf16_f32 v184, v184, v185
    v_cvt_pk_bf16_f32 v185, v186, v187
    v_cvt_pk_bf16_f32 v186, v188, v189
    v_cvt_pk_bf16_f32 v187, v190, v191
    buffer_store_dwordx4 v[184:187], v18, s[32:35], s56 offen
    s_add_u32 s56, s56, s79
    v_cvt_pk_bf16_f32 v192, v192, v193
    v_cvt_pk_bf16_f32 v193, v194, v195
    v_cvt_pk_bf16_f32 v194, v196, v197
    v_cvt_pk_bf16_f32 v195, v198, v199
    buffer_store_dwordx4 v[192:195], v18, s[32:35], s56 offen
    s_add_u32 s56, s56, s79
    v_cvt_pk_bf16_f32 v200, v200, v201
    v_cvt_pk_bf16_f32 v201, v202, v203
    v_cvt_pk_bf16_f32 v202, v204, v205
    v_cvt_pk_bf16_f32 v203, v206, v207
    buffer_store_dwordx4 v[200:203], v18, s[32:35], s56 offen
    s_add_u32 s56, s56, s79
    v_cvt_pk_bf16_f32 v208, v208, v209
    v_cvt_pk_bf16_f32 v209, v210, v211
    v_cvt_pk_bf16_f32 v210, v212, v213
    v_cvt_pk_bf16_f32 v211, v214, v215
    buffer_store_dwordx4 v[208:211], v18, s[32:35], s56 offen
    s_add_u32 s56, s56, s79
    v_cvt_pk_bf16_f32 v216, v216, v217
    v_cvt_pk_bf16_f32 v217, v218, v219
    v_cvt_pk_bf16_f32 v218, v220, v221
    v_cvt_pk_bf16_f32 v219, v222, v223
    buffer_store_dwordx4 v[216:219], v18, s[32:35], s56 offen
    s_add_u32 s56, s56, s79
    s_add_u32 s55, s55, s78
    s_mov_b32 s56, s55
    v_cvt_pk_bf16_f32 v224, v224, v225
    v_cvt_pk_bf16_f32 v225, v226, v227
    v_cvt_pk_bf16_f32 v226, v228, v229
    v_cvt_pk_bf16_f32 v227, v230, v231
    buffer_store_dwordx4 v[224:227], v18, s[32:35], s56 offen
    s_add_u32 s56, s56, s79
    v_cvt_pk_bf16_f32 v232, v232, v233
    v_cvt_pk_bf16_f32 v233, v234, v235
    v_cvt_pk_bf16_f32 v234, v236, v237
    v_cvt_pk_bf16_f32 v235, v238, v239
    buffer_store_dwordx4 v[232:235], v18, s[32:35], s56 offen
    s_add_u32 s56, s56, s79
    v_cvt_pk_bf16_f32 v240, v240, v241
    v_cvt_pk_bf16_f32 v241, v242, v243
    v_cvt_pk_bf16_f32 v242, v244, v245
    v_cvt_pk_bf16_f32 v243, v246, v247
    buffer_store_dwordx4 v[240:243], v18, s[32:35], s56 offen
    s_add_u32 s56, s56, s79
    v_cvt_pk_bf16_f32 v248, v248, v249
    v_cvt_pk_bf16_f32 v249, v250, v251
    v_cvt_pk_bf16_f32 v250, v252, v253
    v_cvt_pk_bf16_f32 v251, v254, v255
    buffer_store_dwordx4 v[248:251], v18, s[32:35], s56 offen
    s_add_u32 s56, s56, s79
    v_accvgpr_read_b32 v20, a96
    v_accvgpr_read_b32 v21, a97
    v_accvgpr_read_b32 v22, a98
    v_accvgpr_read_b32 v23, a99
    v_accvgpr_read_b32 v24, a100
    v_accvgpr_read_b32 v25, a101
    v_accvgpr_read_b32 v26, a102
    v_accvgpr_read_b32 v27, a103
    v_cvt_pk_bf16_f32 v20, v20, v21
    v_cvt_pk_bf16_f32 v21, v22, v23
    v_cvt_pk_bf16_f32 v22, v24, v25
    v_cvt_pk_bf16_f32 v23, v26, v27
    buffer_store_dwordx4 v[20:23], v18, s[32:35], s56 offen
    s_add_u32 s56, s56, s79
    s_nop 1
    v_accvgpr_read_b32 v20, a104
    v_accvgpr_read_b32 v21, a105
    v_accvgpr_read_b32 v22, a106
    v_accvgpr_read_b32 v23, a107
    v_accvgpr_read_b32 v24, a108
    v_accvgpr_read_b32 v25, a109
    v_accvgpr_read_b32 v26, a110
    v_accvgpr_read_b32 v27, a111
    v_cvt_pk_bf16_f32 v20, v20, v21
    v_cvt_pk_bf16_f32 v21, v22, v23
    v_cvt_pk_bf16_f32 v22, v24, v25
    v_cvt_pk_bf16_f32 v23, v26, v27
    buffer_store_dwordx4 v[20:23], v18, s[32:35], s56 offen
    s_add_u32 s56, s56, s79
    s_nop 1
    v_accvgpr_read_b32 v20, a112
    v_accvgpr_read_b32 v21, a113
    v_accvgpr_read_b32 v22, a114
    v_accvgpr_read_b32 v23, a115
    v_accvgpr_read_b32 v24, a116
    v_accvgpr_read_b32 v25, a117
    v_accvgpr_read_b32 v26, a118
    v_accvgpr_read_b32 v27, a119
    v_cvt_pk_bf16_f32 v20, v20, v21
    v_cvt_pk_bf16_f32 v21, v22, v23
    v_cvt_pk_bf16_f32 v22, v24, v25
    v_cvt_pk_bf16_f32 v23, v26, v27
    buffer_store_dwordx4 v[20:23], v18, s[32:35], s56 offen
    s_add_u32 s56, s56, s79
    s_nop 1
    v_accvgpr_read_b32 v20, a120
    v_accvgpr_read_b32 v21, a121
    v_accvgpr_read_b32 v22, a122
    v_accvgpr_read_b32 v23, a123
    v_accvgpr_read_b32 v24, a124
    v_accvgpr_read_b32 v25, a125
    v_accvgpr_read_b32 v26, a126
    v_accvgpr_read_b32 v27, a127
    v_cvt_pk_bf16_f32 v20, v20, v21
    v_cvt_pk_bf16_f32 v21, v22, v23
    v_cvt_pk_bf16_f32 v22, v24, v25
    v_cvt_pk_bf16_f32 v23, v26, v27
    buffer_store_dwordx4 v[20:23], v18, s[32:35], s56 offen
    s_add_u32 s56, s56, s79
    s_nop 1
    s_add_u32 s55, s55, s78
gemm1_kernel_epd19:
    s_cmp_eq_u32 s58, 0
    s_cbranch_scc1 gemm1_kernel_fin20
    s_mov_b32 s74, s91
    s_mov_b32 s75, s92
    s_mov_b32 s76, s93
    s_mov_b32 s77, s94
    s_mov_b32 s78, s95
    s_mov_b32 s79, s96
    s_mov_b32 s58, 0
    s_mov_b32 s53, 0
    s_branch gemm1_kernel_tile7
gemm1_kernel_fin20:
gemm1_kernel_end1:
    s_endpgm
gemm1_kernel_dosw13:
    s_cmp_eq_u32 s58, 0
    s_cbranch_scc1 gemm1_kernel_nonext21
    s_mov_b32 s26, s82
    s_mov_b32 s30, s85
    s_lshl_b32 s54, s86, 4
    s_lshl_b32 s54, s54, s90
    s_mov_b32 s36, s88
    s_mul_i32 s55, s54, 1
    s_add_u32 s37, s55, s88
    s_sub_u32 s37, s37, 2048
    s_mul_i32 s55, s54, 2
    s_add_u32 s38, s55, s88
    s_mul_i32 s55, s54, 3
    s_add_u32 s39, s55, s88
    s_sub_u32 s39, s39, 2048
    s_mov_b32 s40, s89
    s_lshl_b32 s54, s87, 2
    s_mul_i32 s55, s54, 1
    s_add_u32 s41, s55, s89
    s_sub_u32 s41, s41, 2048
    s_mul_i32 s55, s54, 2
    s_add_u32 s42, s55, s89
    s_mul_i32 s55, s54, 3
    s_add_u32 s43, s55, s89
    s_sub_u32 s43, s43, 2048
    s_lshl_b32 s44, s87, 6
    s_lshl_b32 s54, s47, 7
    s_add_u32 s54, s54, s46
    s_lshl_b32 s55, s45, 6
    s_cmp_eq_u32 s90, 1
    s_cselect_b32 s54, s54, s55
    v_lshrrev_b32 v20, 3, v1
    v_lshlrev_b32 v20, s90, v20
    v_add_u32 v20, s54, v20
    v_mul_lo_u32 v20, v20, s86
    v_lshrrev_b32 v21, 4, v1
    v_and_b32 v22, 7, v1
    v_xor_b32 v21, v21, v22
    v_lshl_add_u32 v12, v21, 4, v20
    v_xor_b32 v21, 4, v21
    v_lshl_add_u32 v13, v21, 4, v20
    s_lshl_b32 s54, s86, 3
    s_lshl_b32 s54, s54, s90
    s_sub_u32 s54, s54, 1024
    v_add_u32 v13, s54, v13
    v_lshrrev_b32 v20, 5, v1
    s_lshl_b32 s54, s45, 4
    v_add_u32 v21, s54, v20
    v_mul_lo_u32 v21, v21, s87
    v_lshlrev_b32 v20, 1, v20
    v_and_b32 v22, 31, v1
    v_xor_b32 v20, v20, v22
    s_lshl_b32 s54, s87, 1
    s_sub_u32 s54, s54, 1024
    v_add_u32 v23, s54, v21
    v_xor_b32 v22, 0, v20
    v_lshl_add_u32 v14, v22, 4, v21
    v_xor_b32 v22, 4, v20
    v_lshl_add_u32 v15, v22, 4, v23
    v_xor_b32 v22, 8, v20
    v_lshl_add_u32 v16, v22, 4, v21
    v_xor_b32 v22, 12, v20
    v_lshl_add_u32 v17, v22, 4, v23
    s_mov_b32 s24, s80
    s_mov_b32 s25, s81
    s_mov_b32 s28, s83
    s_mov_b32 s29, s84
    s_branch gemm1_kernel_nosw12
gemm1_kernel_nonext21:
    s_mov_b32 s26, 0
    s_mov_b32 s30, 0
    s_branch gemm1_kernel_nosw12
gemm1_kernel_dosw17:
    s_cmp_eq_u32 s58, 0
    s_cbranch_scc1 gemm1_kernel_nonext22
    s_mov_b32 s26, s82
    s_mov_b32 s30, s85
    s_lshl_b32 s54, s86, 4
    s_lshl_b32 s54, s54, s90
    s_mov_b32 s36, s88
    s_mul_i32 s55, s54, 1
    s_add_u32 s37, s55, s88
    s_sub_u32 s37, s37, 2048
    s_mul_i32 s55, s54, 2
    s_add_u32 s38, s55, s88
    s_mul_i32 s55, s54, 3
    s_add_u32 s39, s55, s88
    s_sub_u32 s39, s39, 2048
    s_mov_b32 s40, s89
    s_lshl_b32 s54, s87, 2
    s_mul_i32 s55, s54, 1
    s_add_u32 s41, s55, s89
    s_sub_u32 s41, s41, 2048
    s_mul_i32 s55, s54, 2
    s_add_u32 s42, s55, s89
    s_mul_i32 s55, s54, 3
    s_add_u32 s43, s55, s89
    s_sub_u32 s43, s43, 2048
    s_lshl_b32 s44, s87, 6
    s_lshl_b32 s54, s47, 7
    s_add_u32 s54, s54, s46
    s_lshl_b32 s55, s45, 6
    s_cmp_eq_u32 s90, 1
    s_cselect_b32 s54, s54, s55
    v_lshrrev_b32 v20, 3, v1
    v_lshlrev_b32 v20, s90, v20
    v_add_u32 v20, s54, v20
    v_mul_lo_u32 v20, v20, s86
    v_lshrrev_b32 v21, 4, v1
    v_and_b32 v22, 7, v1
    v_xor_b32 v21, v21, v22
    v_lshl_add_u32 v12, v21, 4, v20
    v_xor_b32 v21, 4, v21
    v_lshl_add_u32 v13, v21, 4, v20
    s_lshl_b32 s54, s86, 3
    s_lshl_b32 s54, s54, s90
    s_sub_u32 s54, s54, 1024
    v_add_u32 v13, s54, v13
    v_lshrrev_b32 v20, 5, v1
    s_lshl_b32 s54, s45, 4
    v_add_u32 v21, s54, v20
    v_mul_lo_u32 v21, v21, s87
    v_lshlrev_b32 v20, 1, v20
    v_and_b32 v22, 31, v1
    v_xor_b32 v20, v20, v22
    s_lshl_b32 s54, s87, 1
    s_sub_u32 s54, s54, 1024
    v_add_u32 v23, s54, v21
    v_xor_b32 v22, 0, v20
    v_lshl_add_u32 v14, v22, 4, v21
    v_xor_b32 v22, 4, v20
    v_lshl_add_u32 v15, v22, 4, v23
    v_xor_b32 v22, 8, v20
    v_lshl_add_u32 v16, v22, 4, v21
    v_xor_b32 v22, 12, v20
    v_lshl_add_u32 v17, v22, 4, v23
    s_mov_b32 s24, s80
    s_mov_b32 s25, s81
    s_mov_b32 s28, s83
    s_mov_b32 s29, s84
    s_branch gemm1_kernel_nosw16
gemm1_kernel_nonext22:
    s_mov_b32 s26, 0
    s_mov_b32 s30, 0
    s_branch gemm1_kernel_nosw16
.text
.globl attn_kernel
.p2align 8
.type attn_kernel,@function
attn_kernel:
    s_cmp_ge_u32 s2, 256
    s_cbranch_scc1 attn_kernel_end1
    s_load_dwordx2 s[4:5], s[0:1], 88
    v_and_b32 v1, 63, v0
    v_lshrrev_b32 v28, 6, v0
    s_nop 0
    v_readfirstlane_b32 s20, v28
    s_and_b32 s40, s2, 7
    s_lshl_b32 s40, s40, 2
    s_bfe_u32 s41, s2, 0x20003
    s_add_u32 s21, s40, s41
    s_lshr_b32 s22, s2, 5
    v_bfe_u32 v28, v1, 4, 1
    v_and_b32 v29, 7, v1
    v_lshl_add_u32 v28, v28, 3, v29
    v_lshrrev_b32 v29, 5, v1
    v_lshl_add_u32 v28, v29, 4, v28
    v_lshlrev_b32 v28, 4, v28
    v_bfe_u32 v30, v1, 3, 1
    v_lshl_add_u32 v2, v30, 12, v28
    v_lshl_add_u32 v3, v30, 10, v28
    v_add_u32 v3, 65536, v3
    v_and_b32 v28, 15, v1
    v_lshl_add_u32 v28, v29, 4, v28
    v_lshlrev_b32 v28, 4, v28
    v_bfe_u32 v30, v1, 4, 1
    v_lshl_add_u32 v7, v30, 12, v28
    v_lshl_add_u32 v44, v30, 17, v28
    v_and_b32 v15, 31, v1
    v_lshlrev_b32 v29, 2, v29
    v_sub_u32 v15, v15, v29
    s_lshl_b32 s28, s20, 12
    s_add_u32 s29, s28, 65536
    v_lshlrev_b32 v6, 4, v1
    v_add_u32 v6, s28, v6
    v_mov_b32 v13, 0xff800000
    v_mov_b32 v14, 0
    s_mov_b32 s33, 1233125376
    s_sub_u32 s40, 15, s22
    s_lshl_b32 s40, s40, 3
    s_lshl_b32 s41, s20, 1
    s_add_u32 s48, s40, s41
    s_lshl_b32 s40, s22, 3
    s_add_u32 s49, s40, s41
    s_lshl_b32 s40, s22, 2
    s_sub_u32 s40, 64, s40
    s_lshl_b32 s10, s40, 13
    s_mov_b32 s14, s10
    s_mov_b32 s11, 0x20000
    s_mov_b32 s15, 0x20000
    s_mov_b32 s19, 0x20000
    s_mov_b32 s18, 268435456
    s_lshl_b32 s42, s21, 19
    s_waitcnt lgkmcnt(0)
    s_add_u32 s40, s42, 16777216
    s_add_u32 s8, s4, s40
    s_addc_u32 s9, s5, 0
    s_add_u32 s40, s42, 33554432
    s_add_u32 s12, s4, s40
    s_addc_u32 s13, s5, 0
    s_mov_b32 s16, s4
    s_mov_b32 s17, s5
    s_mov_b32 s23, 0
    s_mov_b32 s24, 0
    s_mov_b32 m0, s28
    s_nop 0
    buffer_load_dwordx4 v6, s[8:11], s23 offen offset:0 lds
    buffer_load_dwordx4 v6, s[8:11], s23 offen offset:1024 lds
    buffer_load_dwordx4 v6, s[8:11], s23 offen offset:2048 lds
    buffer_load_dwordx4 v6, s[8:11], s23 offen offset:3072 lds
    s_lshl_b32 s40, s48, 12
    s_add_u32 s40, s40, s42
    s_add_u32 s40, s40, 0
    buffer_load_dwordx4 a[128:131], v7, s[16:19], s40 offen offset:0
    buffer_load_dwordx4 a[132:135], v7, s[16:19], s40 offen offset:512
    buffer_load_dwordx4 a[136:139], v7, s[16:19], s40 offen offset:1024
    buffer_load_dwordx4 a[140:143], v7, s[16:19], s40 offen offset:1536
    buffer_load_dwordx4 a[144:147], v7, s[16:19], s40 offen offset:2048
    buffer_load_dwordx4 a[148:151], v7, s[16:19], s40 offen offset:2560
    buffer_load_dwordx4 a[152:155], v7, s[16:19], s40 offen offset:3072
    buffer_load_dwordx4 a[156:159], v7, s[16:19], s40 offen offset:3584
    s_lshl_b32 s40, s49, 12
    s_add_u32 s40, s40, s42
    s_add_u32 s40, s40, 0
    buffer_load_dwordx4 a[160:163], v7, s[16:19], s40 offen offset:0
    buffer_load_dwordx4 a[164:167], v7, s[16:19], s40 offen offset:512
    buffer_load_dwordx4 a[168:171], v7, s[16:19], s40 offen offset:1024
    buffer_load_dwordx4 a[172:175], v7, s[16:19], s40 offen offset:1536
    buffer_load_dwordx4 a[176:179], v7, s[16:19], s40 offen offset:2048
    buffer_load_dwordx4 a[180:183], v7, s[16:19], s40 offen offset:2560
    buffer_load_dwordx4 a[184:187], v7, s[16:19], s40 offen offset:3072
    buffer_load_dwordx4 a[188:191], v7, s[16:19], s40 offen offset:3584
    s_add_u32 s23, s23, 16384
    s_add_u32 m0, s28, 16384
    s_nop 0
    buffer_load_dwordx4 v6, s[8:11], s23 offen offset:0 lds
    buffer_load_dwordx4 v6, s[8:11], s23 offen offset:1024 lds
    buffer_load_dwordx4 v6, s[8:11], s23 offen offset:2048 lds
    buffer_load_dwordx4 v6, s[8:11], s23 offen offset:3072 lds
    s_add_u32 m0, s29, 0
    s_nop 0
    buffer_load_dwordx4 v6, s[12:15], s24 offen offset:0 lds
    buffer_load_dwordx4 v6, s[12:15], s24 offen offset:1024 lds
    buffer_load_dwordx4 v6, s[12:15], s24 offen offset:2048 lds
    buffer_load_dwordx4 v6, s[12:15], s24 offen offset:3072 lds
    s_add_u32 s24, s24, 16384
    s_add_u32 s23, s23, 16384
    s_add_u32 m0, s28, 32768
    s_nop 0
    buffer_load_dwordx4 v6, s[8:11], s23 offen offset:0 lds
    buffer_load_dwordx4 v6, s[8:11], s23 offen offset:1024 lds
    buffer_load_dwordx4 v6, s[8:11], s23 offen offset:2048 lds
    buffer_load_dwordx4 v6, s[8:11], s23 offen offset:3072 lds
    s_add_u32 m0, s29, 16384
    s_nop 0
    buffer_load_dwordx4 v6, s[12:15], s24 offen offset:0 lds
    buffer_load_dwordx4 v6, s[12:15], s24 offen offset:1024 lds
    buffer_load_dwordx4 v6, s[12:15], s24 offen offset:2048 lds
    buffer_load_dwordx4 v6, s[12:15], s24 offen offset:3072 lds
    s_add_u32 s24, s24, 16384
    s_add_u32 s23, s23, 16384
    s_add_u32 m0, s28, 49152
    s_nop 0
    buffer_load_dwordx4 v6, s[8:11], s23 offen offset:0 lds
    buffer_load_dwordx4 v6, s[8:11], s23 offen offset:1024 lds
    buffer_load_dwordx4 v6, s[8:11], s23 offen offset:2048 lds
    buffer_load_dwordx4 v6, s[8:11], s23 offen offset:3072 lds
    s_add_u32 m0, s29, 32768
    s_nop 0
    buffer_load_dwordx4 v6, s[12:15], s24 offen offset:0 lds
    buffer_load_dwordx4 v6, s[12:15], s24 offen offset:1024 lds
    buffer_load_dwordx4 v6, s[12:15], s24 offen offset:2048 lds
    buffer_load_dwordx4 v6, s[12:15], s24 offen offset:3072 lds
    s_add_u32 s24, s24, 16384
    s_add_u32 s23, s23, 16384
    s_mov_b32 s25, 32768
    s_mov_b32 s26, 49152
    s_mov_b32 s27, 0
    v_mov_b32 v4, v2
    v_mov_b32 v5, v3
    v_accvgpr_write_b32 a0, 0
    v_accvgpr_write_b32 a1, 0
    v_accvgpr_write_b32 a2, 0
    v_accvgpr_write_b32 a3, 0
    v_accvgpr_write_b32 a4, 0
    v_accvgpr_write_b32 a5, 0
    v_accvgpr_write_b32 a6, 0
    v_accvgpr_write_b32 a7, 0
    v_accvgpr_write_b32 a8, 0
    v_accvgpr_write_b32 a9, 0
    v_accvgpr_write_b32 a10, 0
    v_accvgpr_write_b32 a11, 0
    v_accvgpr_write_b32 a12, 0
    v_accvgpr_write_b32 a13, 0
    v_accvgpr_write_b32 a14, 0
    v_accvgpr_write_b32 a15, 0
    v_accvgpr_write_b32 a16, 0
    v_accvgpr_write_b32 a17, 0
    v_accvgpr_write_b32 a18, 0
    v_accvgpr_write_b32 a19, 0
    v_accvgpr_write_b32 a20, 0
    v_accvgpr_write_b32 a21, 0
    v_accvgpr_write_b32 a22, 0
    v_accvgpr_write_b32 a23, 0
    v_accvgpr_write_b32 a24, 0
    v_accvgpr_write_b32 a25, 0
    v_accvgpr_write_b32 a26, 0
    v_accvgpr_write_b32 a27, 0
    v_accvgpr_write_b32 a28, 0
    v_accvgpr_write_b32 a29, 0
    v_accvgpr_write_b32 a30, 0
    v_accvgpr_write_b32 a31, 0
    v_accvgpr_write_b32 a32, 0
    v_accvgpr_write_b32 a33, 0
    v_accvgpr_write_b32 a34, 0
    v_accvgpr_write_b32 a35, 0
    v_accvgpr_write_b32 a36, 0
    v_accvgpr_write_b32 a37, 0
    v_accvgpr_write_b32 a38, 0
    v_accvgpr_write_b32 a39, 0
    v_accvgpr_write_b32 a40, 0
    v_accvgpr_write_b32 a41, 0
    v_accvgpr_write_b32 a42, 0
    v_accvgpr_write_b32 a43, 0
    v_accvgpr_write_b32 a44, 0
    v_accvgpr_write_b32 a45, 0
    v_accvgpr_write_b32 a46, 0
    v_accvgpr_write_b32 a47, 0
    v_accvgpr_write_b32 a48, 0
    v_accvgpr_write_b32 a49, 0
    v_accvgpr_write_b32 a50, 0
    v_accvgpr_write_b32 a51, 0
    v_accvgpr_write_b32 a52, 0
    v_accvgpr_write_b32 a53, 0
    v_accvgpr_write_b32 a54, 0
    v_accvgpr_write_b32 a55, 0
    v_accvgpr_write_b32 a56, 0
    v_accvgpr_write_b32 a57, 0
    v_accvgpr_write_b32 a58, 0
    v_accvgpr_write_b32 a59, 0
    v_accvgpr_write_b32 a60, 0
    v_accvgpr_write_b32 a61, 0
    v_accvgpr_write_b32 a62, 0
    v_accvgpr_write_b32 a63, 0
    v_accvgpr_write_b32 a64, 0
    v_accvgpr_write_b32 a65, 0
    v_accvgpr_write_b32 a66, 0
    v_accvgpr_write_b32 a67, 0
    v_accvgpr_write_b32 a68, 0
    v_accvgpr_write_b32 a69, 0
    v_accvgpr_write_b32 a70, 0
    v_accvgpr_write_b32 a71, 0
    v_accvgpr_write_b32 a72, 0
    v_accvgpr_write_b32 a73, 0
    v_accvgpr_write_b32 a74, 0
    v_accvgpr_write_b32 a75, 0
    v_accvgpr_write_b32 a76, 0
    v_accvgpr_write_b32 a77, 0
    v_accvgpr_write_b32 a78, 0
    v_accvgpr_write_b32 a79, 0
    v_accvgpr_write_b32 a80, 0
    v_accvgpr_write_b32 a81, 0
    v_accvgpr_write_b32 a82, 0
    v_accvgpr_write_b32 a83, 0
    v_accvgpr_write_b32 a84, 0
    v_accvgpr_write_b32 a85, 0
    v_accvgpr_write_b32 a86, 0
    v_accvgpr_write_b32 a87, 0
    v_accvgpr_write_b32 a88, 0
    v_accvgpr_write_b32 a89, 0
    v_accvgpr_write_b32 a90, 0
    v_accvgpr_write_b32 a91, 0
    v_accvgpr_write_b32 a92, 0
    v_accvgpr_write_b32 a93, 0
    v_accvgpr_write_b32 a94, 0
    v_accvgpr_write_b32 a95, 0
    v_accvgpr_write_b32 a96, 0
    v_accvgpr_write_b32 a97, 0
    v_accvgpr_write_b32 a98, 0
    v_accvgpr_write_b32 a99, 0
    v_accvgpr_write_b32 a100, 0
    v_accvgpr_write_b32 a101, 0
    v_accvgpr_write_b32 a102, 0
    v_accvgpr_write_b32 a103, 0
    v_accvgpr_write_b32 a104, 0
    v_accvgpr_write_b32 a105, 0
    v_accvgpr_write_b32 a106, 0
    v_accvgpr_write_b32 a107, 0
    v_accvgpr_write_b32 a108, 0
    v_accvgpr_write_b32 a109, 0
    v_accvgpr_write_b32 a110, 0
    v_accvgpr_write_b32 a111, 0
    v_accvgpr_write_b32 a112, 0
    v_accvgpr_write_b32 a113, 0
    v_accvgpr_write_b32 a114, 0
    v_accvgpr_write_b32 a115, 0
    v_accvgpr_write_b32 a116, 0
    v_accvgpr_write_b32 a117, 0
    v_accvgpr_write_b32 a118, 0
    v_accvgpr_write_b32 a119, 0
    v_accvgpr_write_b32 a120, 0
    v_accvgpr_write_b32 a121, 0
    v_accvgpr_write_b32 a122, 0
    v_accvgpr_write_b32 a123, 0
    v_accvgpr_write_b32 a124, 0
    v_accvgpr_write_b32 a125, 0
    v_accvgpr_write_b32 a126, 0
    v_accvgpr_write_b32 a127, 0
    v_mov_b32 v160, 0
    v_mov_b32 v161, 0
    v_mov_b32 v162, 0
    v_mov_b32 v163, 0
    v_mov_b32 v164, 0
    v_mov_b32 v165, 0
    v_mov_b32 v166, 0
    v_mov_b32 v167, 0
    v_mov_b32 v168, 0
    v_mov_b32 v169, 0
    v_mov_b32 v170, 0
    v_mov_b32 v171, 0
    v_mov_b32 v172, 0
    v_mov_b32 v173, 0
    v_mov_b32 v174, 0
    v_mov_b32 v175, 0
    v_mov_b32 v176, 0
    v_mov_b32 v177, 0
    v_mov_b32 v178, 0
    v_mov_b32 v179, 0
    v_mov_b32 v180, 0
    v_mov_b32 v181, 0
    v_mov_b32 v182, 0
    v_mov_b32 v183, 0
    v_mov_b32 v184, 0
    v_mov_b32 v185, 0
    v_mov_b32 v186, 0
    v_mov_b32 v187, 0
    v_mov_b32 v188, 0
    v_mov_b32 v189, 0
    v_mov_b32 v190, 0
    v_mov_b32 v191, 0
    v_mov_b32 v8, 0
    v_mov_b32 v9, 0
    v_mov_b32 v10, 0
    v_mov_b32 v11, 0
    s_lshl_b32 s31, s22, 2
    s_add_u32 s31, s31, s20
    s_mov_b32 s32, 0
    s_waitcnt vmcnt(24)
    s_barrier
    ds_read_b128 a[192:195], v4 offset:0
    ds_read_b128 a[196:199], v4 offset:512
    ds_read_b128 a[200:203], v4 offset:1024
    ds_read_b128 a[204:207], v4 offset:1536
    ds_read_b128 a[208:211], v4 offset:2048
    ds_read_b128 a[212:215], v4 offset:2560
    ds_read_b128 a[216:219], v4 offset:3072
    ds_read_b128 a[220:223], v4 offset:3584
    s_sub_u32 s31, s31, 1
    s_cbranch_scc1 attn_kernel_stub7
attn_kernel_ret8:
    s_waitcnt lgkmcnt(0)
    v_mfma_f32_32x32x16_bf16 v[64:79], a[192:195], a[128:131], v[160:175]
    v_mfma_f32_32x32x16_bf16 v[80:95], a[192:195], a[160:163], v[176:191]
    ds_read_b128 a[192:195], v4 offset:8192
    v_mfma_f32_32x32x16_bf16 v[64:79], a[196:199], a[132:135], v[64:79]
    v_mfma_f32_32x32x16_bf16 v[80:95], a[196:199], a[164:167], v[80:95]
    ds_read_b128 a[196:199], v4 offset:8704
    v_mfma_f32_32x32x16_bf16 v[64:79], a[200:203], a[136:139], v[64:79]
    v_mfma_f32_32x32x16_bf16 v[80:95], a[200:203], a[168:171], v[80:95]
    ds_read_b128 a[200:203], v4 offset:9216
    v_mfma_f32_32x32x16_bf16 v[64:79], a[204:207], a[140:143], v[64:79]
    v_mfma_f32_32x32x16_bf16 v[80:95], a[204:207], a[172:175], v[80:95]
    ds_read_b128 a[204:207], v4 offset:9728
    v_mfma_f32_32x32x16_bf16 v[64:79], a[208:211], a[144:147], v[64:79]
    v_mfma_f32_32x32x16_bf16 v[80:95], a[208:211], a[176:179], v[80:95]
    ds_read_b128 a[208:211], v4 offset:10240
    v_mfma_f32_32x32x16_bf16 v[64:79], a[212:215], a[148:151], v[64:79]
    v_mfma_f32_32x32x16_bf16 v[80:95], a[212:215], a[180:183], v[80:95]
    ds_read_b128 a[212:215], v4 offset:10752
    v_mfma_f32_32x32x16_bf16 v[64:79], a[216:219], a[152:155], v[64:79]
    v_mfma_f32_32x32x16_bf16 v[80:95], a[216:219], a[184:187], v[80:95]
    ds_read_b128 a[216:219], v4 offset:11264
    v_mfma_f32_32x32x16_bf16 v[64:79], a[220:223], a[156:159], v[64:79]
    v_mfma_f32_32x32x16_bf16 v[80:95], a[220:223], a[188:191], v[80:95]
    ds_read_b128 a[220:223], v4 offset:11776
    s_nop 11
    v_max3_f32 v28, v64, v65, v66
    v_max3_f32 v28, v28, v67, v68
    v_max3_f32 v28, v28, v69, v70
    v_max3_f32 v28, v28, v71, v72
    v_max3_f32 v28, v28, v73, v74
    v_max3_f32 v28, v28, v75, v76
    v_max3_f32 v28, v28, v77, v78
    v_max_f32 v28, v28, v79
    v_mov_b32 v29, v28
    v_max3_f32 v30, v80, v81, v82
    v_max3_f32 v30, v30, v83, v84
    v_max3_f32 v30, v30, v85, v86
    v_max3_f32 v30, v30, v87, v88
    v_max3_f32 v30, v30, v89, v90
    v_max3_f32 v30, v30, v91, v92
    v_max3_f32 v30, v30, v93, v94
    v_max_f32 v30, v30, v95
    v_mov_b32 v31, v30
    s_nop 1
    v_permlane32_swap_b32 v28, v29
    v_permlane32_swap_b32 v30, v31
    s_nop 1
    v_max_f32 v28, v28, v29
    v_max_f32 v30, v30, v31
    v_sub_f32 v160, v160, v28
    v_sub_f32 v161, v161, v28
    v_sub_f32 v162, v162, v28
    v_sub_f32 v163, v163, v28
    v_sub_f32 v164, v164, v28
    v_sub_f32 v165, v165, v28
    v_sub_f32 v166, v166, v28
    v_sub_f32 v167, v167, v28
    v_sub_f32 v168, v168, v28
    v_sub_f32 v169, v169, v28
    v_sub_f32 v170, v170, v28
    v_sub_f32 v171, v171, v28
    v_sub_f32 v172, v172, v28
    v_sub_f32 v173, v173, v28
    v_sub_f32 v174, v174, v28
    v_sub_f32 v175, v175, v28
    v_sub_f32 v176, v176, v30
    v_sub_f32 v177, v177, v30
    v_sub_f32 v178, v178, v30
    v_sub_f32 v179, v179, v30
    v_sub_f32 v180, v180, v30
    v_sub_f32 v181, v181, v30
    v_sub_f32 v182, v182, v30
    v_sub_f32 v183, v183, v30
    v_sub_f32 v184, v184, v30
    v_sub_f32 v185, v185, v30
    v_sub_f32 v186, v186, v30
    v_sub_f32 v187, v187, v30
    v_sub_f32 v188, v188, v30
    v_sub_f32 v189, v189, v30
    v_sub_f32 v190, v190, v30
    v_sub_f32 v191, v191, v30
    v_sub_f32 v64, v64, v28
    v_sub_f32 v65, v65, v28
    v_sub_f32 v66, v66, v28
    v_sub_f32 v67, v67, v28
    v_sub_f32 v68, v68, v28
    v_sub_f32 v69, v69, v28
    v_sub_f32 v70, v70, v28
    v_sub_f32 v71, v71, v28
    v_sub_f32 v72, v72, v28
    v_sub_f32 v73, v73, v28
    v_sub_f32 v74, v74, v28
    v_sub_f32 v75, v75, v28
    v_sub_f32 v76, v76, v28
    v_sub_f32 v77, v77, v28
    v_sub_f32 v78, v78, v28
    v_sub_f32 v79, v79, v28
    v_sub_f32 v80, v80, v30
    v_sub_f32 v81, v81, v30
    v_sub_f32 v82, v82, v30
    v_sub_f32 v83, v83, v30
    v_sub_f32 v84, v84, v30
    v_sub_f32 v85, v85, v30
    v_sub_f32 v86, v86, v30
    v_sub_f32 v87, v87, v30
    v_sub_f32 v88, v88, v30
    v_sub_f32 v89, v89, v30
    v_sub_f32 v90, v90, v30
    v_sub_f32 v91, v91, v30
    v_sub_f32 v92, v92, v30
    v_sub_f32 v93, v93, v30
    v_sub_f32 v94, v94, v30
    v_sub_f32 v95, v95, v30
    s_sub_u32 s31, s31, 1
    s_cbranch_scc1 attn_kernel_stub9
attn_kernel_ret10:
    s_waitcnt lgkmcnt(0)
    v_mfma_f32_32x32x16_bf16 v[96:111], a[192:195], a[128:131], v[160:175]
    v_add_f32 v8, v8, v10
    v_add_f32 v9, v9, v11
    v_exp_f32 v20, v64
    v_exp_f32 v24, v80
    v_exp_f32 v21, v65
    v_mfma_f32_32x32x16_bf16 v[112:127], a[192:195], a[160:163], v[176:191]
    v_exp_f32 v25, v81
    v_exp_f32 v22, v66
    v_exp_f32 v26, v82
    v_add_f32 v10, v20, v21
    v_mfma_f32_32x32x16_bf16 v[96:111], a[196:199], a[132:135], v[96:111]
    v_add_f32 v11, v24, v25
    v_cvt_pk_bf16_f32 v128, v20, v21
    v_cvt_pk_bf16_f32 v136, v24, v25
    v_exp_f32 v23, v67
    v_exp_f32 v27, v83
    v_mfma_f32_32x32x16_bf16 v[112:127], a[196:199], a[164:167], v[112:127]
    v_exp_f32 v20, v68
    v_exp_f32 v24, v84
    v_add_f32 v10, v10, v22
    v_add_f32 v11, v11, v26
    v_add_f32 v10, v10, v23
    v_add_f32 v11, v11, v27
    v_mfma_f32_32x32x16_bf16 v[96:111], a[200:203], a[136:139], v[96:111]
    v_cvt_pk_bf16_f32 v129, v22, v23
    v_cvt_pk_bf16_f32 v137, v26, v27
    v_exp_f32 v21, v69
    v_exp_f32 v25, v85
    v_exp_f32 v22, v70
    v_mfma_f32_32x32x16_bf16 v[112:127], a[200:203], a[168:171], v[112:127]
    v_exp_f32 v26, v86
    v_add_f32 v10, v10, v20
    v_add_f32 v11, v11, v24
    v_add_f32 v10, v10, v21
    v_add_f32 v11, v11, v25
    v_cvt_pk_bf16_f32 v130, v20, v21
    v_cvt_pk_bf16_f32 v138, v24, v25
    v_mfma_f32_32x32x16_bf16 v[96:111], a[204:207], a[140:143], v[96:111]
    v_exp_f32 v23, v71
    v_exp_f32 v27, v87
    v_exp_f32 v20, v72
    v_exp_f32 v24, v88
    v_mfma_f32_32x32x16_bf16 v[112:127], a[204:207], a[172:175], v[112:127]
    v_add_f32 v10, v10, v22
    v_add_f32 v11, v11, v26
    v_add_f32 v10, v10, v23
    v_add_f32 v11, v11, v27
    v_cvt_pk_bf16_f32 v131, v22, v23
    v_cvt_pk_bf16_f32 v139, v26, v27
    v_mfma_f32_32x32x16_bf16 v[96:111], a[208:211], a[144:147], v[96:111]
    v_exp_f32 v21, v73
    v_exp_f32 v25, v89
    v_exp_f32 v22, v74
    v_exp_f32 v26, v90
    v_mfma_f32_32x32x16_bf16 v[112:127], a[208:211], a[176:179], v[112:127]
    v_add_f32 v10, v10, v20
    v_add_f32 v11, v11, v24
    v_add_f32 v10, v10, v21
    v_add_f32 v11, v11, v25
    v_cvt_pk_bf16_f32 v132, v20, v21
    v_cvt_pk_bf16_f32 v140, v24, v25
    v_exp_f32 v23, v75
    v_mfma_f32_32x32x16_bf16 v[96:111], a[212:215], a[148:151], v[96:111]
    v_exp_f32 v27, v91
    v_exp_f32 v20, v76
    v_exp_f32 v24, v92
    v_add_f32 v10, v10, v22
    v_add_f32 v11, v11, v26
    v_mfma_f32_32x32x16_bf16 v[112:127], a[212:215], a[180:183], v[112:127]
    v_add_f32 v10, v10, v23
    v_add_f32 v11, v11, v27
    v_cvt_pk_bf16_f32 v133, v22, v23
    v_cvt_pk_bf16_f32 v141, v26, v27
    v_exp_f32 v21, v77
    v_exp_f32 v25, v93
    v_mfma_f32_32x32x16_bf16 v[96:111], a[216:219], a[152:155], v[96:111]
    v_exp_f32 v22, v78
    v_exp_f32 v26, v94
    v_add_f32 v10, v10, v20
    v_add_f32 v11, v11, v24
    v_add_f32 v10, v10, v21
    v_mfma_f32_32x32x16_bf16 v[112:127], a[216:219], a[184:187], v[112:127]
    v_add_f32 v11, v11, v25
    v_cvt_pk_bf16_f32 v134, v20, v21
    v_cvt_pk_bf16_f32 v142, v24, v25
    v_exp_f32 v23, v79
    v_exp_f32 v27, v95
    v_mfma_f32_32x32x16_bf16 v[96:111], a[220:223], a[156:159], v[96:111]
    v_add_f32 v10, v10, v22
    v_add_f32 v11, v11, v26
    v_add_f32 v10, v10, v23
    v_add_f32 v11, v11, v27
    v_cvt_pk_bf16_f32 v135, v22, v23
    v_cvt_pk_bf16_f32 v143, v26, v27
    v_max_f32 v12, v10, v11
    v_cmp_lt_f32 vcc, s33, v12
    v_mfma_f32_32x32x16_bf16 v[112:127], a[220:223], a[188:191], v[112:127]
    s_waitcnt vmcnt(16)
    s_barrier
    s_mov_b32 s25, s26
    s_mov_b32 s26, s27
    s_add_u32 s27, s27, 16384
    s_and_b32 s27, s27, 0xffff
    v_add_u32 v4, s27, v2
    v_add_u32 v5, s26, v3
    ds_read_b128 a[192:195], v4 offset:0
    ds_read_b128 a[196:199], v4 offset:512
    ds_read_b128 a[200:203], v4 offset:1024
    ds_read_b128 a[204:207], v4 offset:1536
    ds_read_b128 a[208:211], v4 offset:2048
    ds_read_b128 a[212:215], v4 offset:2560
    ds_read_b128 a[216:219], v4 offset:3072
    ds_read_b128 a[220:223], v4 offset:3584
    s_cbranch_vccnz attn_kernel_stub11
attn_kernel_ret12:
    s_lshl_b32 s30, s22, 1
    s_add_u32 s30, s30, 1
attn_kernel_dual13:
    s_sub_u32 s31, s31, 1
    s_cbranch_scc1 attn_kernel_stub14
attn_kernel_ret15:
    s_waitcnt lgkmcnt(0)
    v_mfma_f32_32x32x16_bf16 v[64:79], a[192:195], a[128:131], v[160:175]
    ds_read_b128 a[224:227], v5 offset:0
    v_add_f32 v8, v8, v10
    v_add_f32 v9, v9, v11
    v_exp_f32 v20, v96
    v_mfma_f32_32x32x16_bf16 v[80:95], a[192:195], a[160:163], v[176:191]
    ds_read_b128 a[228:231], v5 offset:2048
    v_exp_f32 v24, v112
    v_exp_f32 v21, v97
    v_mfma_f32_32x32x16_bf16 v[64:79], a[196:199], a[132:135], v[64:79]
    ds_read_b128 a[232:235], v5 offset:4096
    s_add_u32 m0, s26, s28
    s_nop 0
    buffer_load_dwordx4 v6, s[8:11], s23 offen offset:0 lds
    v_exp_f32 v25, v113
    v_mfma_f32_32x32x16_bf16 v[80:95], a[196:199], a[164:167], v[80:95]
    ds_read_b128 a[236:239], v5 offset:6144
    v_exp_f32 v22, v98
    v_exp_f32 v26, v114
    v_mfma_f32_32x32x16_bf16 v[64:79], a[200:203], a[136:139], v[64:79]
    ds_read_b128 a[240:243], v5 offset:512
    v_add_f32 v10, v20, v21
    v_add_f32 v11, v24, v25
    v_cvt_pk_bf16_f32 v144, v20, v21
    v_mfma_f32_32x32x16_bf16 v[80:95], a[200:203], a[168:171], v[80:95]
    ds_read_b128 a[244:247], v5 offset:2560
    v_cvt_pk_bf16_f32 v152, v24, v25
    v_exp_f32 v23, v99
    v_mfma_f32_32x32x16_bf16 v[64:79], a[204:207], a[140:143], v[64:79]
    ds_read_b128 a[248:251], v5 offset:4608
    buffer_load_dwordx4 v6, s[8:11], s23 offen offset:1024 lds
    v_exp_f32 v27, v115
    v_mfma_f32_32x32x16_bf16 v[80:95], a[204:207], a[172:175], v[80:95]
    ds_read_b128 a[252:255], v5 offset:6656
    v_exp_f32 v20, v100
    v_exp_f32 v24, v116
    v_mfma_f32_32x32x16_bf16 v[64:79], a[208:211], a[144:147], v[64:79]
    v_add_f32 v10, v10, v22
    v_add_f32 v11, v11, v26
    v_add_f32 v10, v10, v23
    v_add_f32 v11, v11, v27
    v_cvt_pk_bf16_f32 v145, v22, v23
    v_mfma_f32_32x32x16_bf16 v[80:95], a[208:211], a[176:179], v[80:95]
    v_cvt_pk_bf16_f32 v153, v26, v27
    v_exp_f32 v21, v101
    v_exp_f32 v25, v117
    v_mfma_f32_32x32x16_bf16 v[64:79], a[212:215], a[148:151], v[64:79]
    buffer_load_dwordx4 v6, s[8:11], s23 offen offset:2048 lds
    v_exp_f32 v22, v102
    v_mfma_f32_32x32x16_bf16 v[80:95], a[212:215], a[180:183], v[80:95]
    v_exp_f32 v26, v118
    v_add_f32 v10, v10, v20
    v_add_f32 v11, v11, v24
    v_add_f32 v10, v10, v21
    v_mfma_f32_32x32x16_bf16 v[64:79], a[216:219], a[152:155], v[64:79]
    v_add_f32 v11, v11, v25
    v_cvt_pk_bf16_f32 v146, v20, v21
    v_cvt_pk_bf16_f32 v154, v24, v25
    v_exp_f32 v23, v103
    v_mfma_f32_32x32x16_bf16 v[80:95], a[216:219], a[184:187], v[80:95]
    v_exp_f32 v27, v119
    v_exp_f32 v20, v104
    v_mfma_f32_32x32x16_bf16 v[64:79], a[220:223], a[156:159], v[64:79]
    buffer_load_dwordx4 v6, s[8:11], s23 offen offset:3072 lds
    v_exp_f32 v24, v120
    v_add_f32 v10, v10, v22
    v_add_f32 v11, v11, v26
    v_mfma_f32_32x32x16_bf16 v[80:95], a[220:223], a[188:191], v[80:95]
    v_add_f32 v10, v10, v23
    v_add_f32 v11, v11, v27
    v_cvt_pk_bf16_f32 v147, v22, v23
    v_cvt_pk_bf16_f32 v155, v26, v27
    s_waitcnt lgkmcnt(0)
    v_mfma_f32_32x32x16_bf16 a[0:15], a[224:227], v[128:131], a[0:15]
    ds_read_b128 a[192:195], v4 offset:8192
    v_exp_f32 v21, v105
    v_exp_f32 v25, v121
    v_mfma_f32_32x32x16_bf16 a[64:79], a[224:227], v[136:139], a[64:79]
    ds_read_b128 a[196:199], v4 offset:8704
    v_exp_f32 v22, v106
    v_exp_f32 v26, v122
    v_mfma_f32_32x32x16_bf16 a[16:31], a[228:231], v[128:131], a[16:31]
    ds_read_b128 a[200:203], v4 offset:9216
    s_add_u32 m0, s25, s29
    s_add_u32 s23, s23, 16384
    buffer_load_dwordx4 v6, s[12:15], s24 offen offset:0 lds
    v_add_f32 v10, v10, v20
    v_mfma_f32_32x32x16_bf16 a[80:95], a[228:231], v[136:139], a[80:95]
    ds_read_b128 a[204:207], v4 offset:9728
    v_add_f32 v11, v11, v24
    v_add_f32 v10, v10, v21
    v_add_f32 v11, v11, v25
    v_mfma_f32_32x32x16_bf16 a[32:47], a[232:235], v[128:131], a[32:47]
    ds_read_b128 a[208:211], v4 offset:10240
    v_cvt_pk_bf16_f32 v148, v20, v21
    v_cvt_pk_bf16_f32 v156, v24, v25
    v_exp_f32 v23, v107
    v_mfma_f32_32x32x16_bf16 a[96:111], a[232:235], v[136:139], a[96:111]
    ds_read_b128 a[212:215], v4 offset:10752
    v_exp_f32 v27, v123
    v_exp_f32 v20, v108
    v_mfma_f32_32x32x16_bf16 a[48:63], a[236:239], v[128:131], a[48:63]
    ds_read_b128 a[216:219], v4 offset:11264
    buffer_load_dwordx4 v6, s[12:15], s24 offen offset:1024 lds
    v_exp_f32 v24, v124
    v_mfma_f32_32x32x16_bf16 a[112:127], a[236:239], v[136:139], a[112:127]
    ds_read_b128 a[220:223], v4 offset:11776
    v_add_f32 v10, v10, v22
    v_add_f32 v11, v11, v26
    v_add_f32 v10, v10, v23
    v_add_f32 v11, v11, v27
    v_mfma_f32_32x32x16_bf16 a[0:15], a[240:243], v[132:135], a[0:15]
    v_cvt_pk_bf16_f32 v149, v22, v23
    v_cvt_pk_bf16_f32 v157, v26, v27
    v_exp_f32 v21, v109
    v_mfma_f32_32x32x16_bf16 a[64:79], a[240:243], v[140:143], a[64:79]
    v_exp_f32 v25, v125
    v_exp_f32 v22, v110
    v_exp_f32 v26, v126
    v_mfma_f32_32x32x16_bf16 a[16:31], a[244:247], v[132:135], a[16:31]
    buffer_load_dwordx4 v6, s[12:15], s24 offen offset:2048 lds
    v_add_f32 v10, v10, v20
    v_add_f32 v11, v11, v24
    v_mfma_f32_32x32x16_bf16 a[80:95], a[244:247], v[140:143], a[80:95]
    v_add_f32 v10, v10, v21
    v_add_f32 v11, v11, v25
    v_cvt_pk_bf16_f32 v150, v20, v21
    v_cvt_pk_bf16_f32 v158, v24, v25
    v_mfma_f32_32x32x16_bf16 a[32:47], a[248:251], v[132:135], a[32:47]
    v_exp_f32 v23, v111
    v_exp_f32 v27, v127
    v_add_f32 v10, v10, v22
    v_mfma_f32_32x32x16_bf16 a[96:111], a[248:251], v[140:143], a[96:111]
    v_add_f32 v11, v11, v26
    v_add_f32 v10, v10, v23
    v_add_f32 v11, v11, v27
    v_cvt_pk_bf16_f32 v151, v22, v23
    v_cvt_pk_bf16_f32 v159, v26, v27
    v_mfma_f32_32x32x16_bf16 a[48:63], a[252:255], v[132:135], a[48:63]
    buffer_load_dwordx4 v6, s[12:15], s24 offen offset:3072 lds
    s_add_u32 s24, s24, 16384
    v_max_f32 v12, v10, v11
    v_cmp_lt_f32 vcc, s33, v12
    v_mfma_f32_32x32x16_bf16 a[112:127], a[252:255], v[140:143], a[112:127]
    s_cbranch_vccnz attn_kernel_stub16
attn_kernel_ret17:
    s_sub_u32 s31, s31, 1
    s_cbranch_scc1 attn_kernel_stub18
attn_kernel_ret19:
    s_waitcnt lgkmcnt(0)
    v_mfma_f32_32x32x16_bf16 v[96:111], a[192:195], a[128:131], v[160:175]
    ds_read_b128 a[224:227], v5 offset:8192
    v_add_f32 v8, v8, v10
    v_add_f32 v9, v9, v11
    v_exp_f32 v20, v64
    v_mfma_f32_32x32x16_bf16 v[112:127], a[192:195], a[160:163], v[176:191]
    ds_read_b128 a[228:231], v5 offset:10240
    v_exp_f32 v24, v80
    v_mfma_f32_32x32x16_bf16 v[96:111], a[196:199], a[132:135], v[96:111]
    ds_read_b128 a[232:235], v5 offset:12288
    v_exp_f32 v21, v65
    v_exp_f32 v25, v81
    v_mfma_f32_32x32x16_bf16 v[112:127], a[196:199], a[164:167], v[112:127]
    ds_read_b128 a[236:239], v5 offset:14336
    v_exp_f32 v22, v66
    v_exp_f32 v26, v82
    v_mfma_f32_32x32x16_bf16 v[96:111], a[200:203], a[136:139], v[96:111]
    ds_read_b128 a[240:243], v5 offset:8704
    v_add_f32 v10, v20, v21
    v_add_f32 v11, v24, v25
    v_cvt_pk_bf16_f32 v128, v20, v21
    v_mfma_f32_32x32x16_bf16 v[112:127], a[200:203], a[168:171], v[112:127]
    ds_read_b128 a[244:247], v5 offset:10752
    v_cvt_pk_bf16_f32 v136, v24, v25
    v_exp_f32 v23, v67
    v_mfma_f32_32x32x16_bf16 v[96:111], a[204:207], a[140:143], v[96:111]
    ds_read_b128 a[248:251], v5 offset:12800
    v_exp_f32 v27, v83
    v_exp_f32 v20, v68
    v_mfma_f32_32x32x16_bf16 v[112:127], a[204:207], a[172:175], v[112:127]
    ds_read_b128 a[252:255], v5 offset:14848
    v_exp_f32 v24, v84
    v_add_f32 v10, v10, v22
    v_mfma_f32_32x32x16_bf16 v[96:111], a[208:211], a[144:147], v[96:111]
    v_add_f32 v11, v11, v26
    v_add_f32 v10, v10, v23
    v_add_f32 v11, v11, v27
    v_cvt_pk_bf16_f32 v129, v22, v23
    v_cvt_pk_bf16_f32 v137, v26, v27
    v_mfma_f32_32x32x16_bf16 v[112:127], a[208:211], a[176:179], v[112:127]
    v_exp_f32 v21, v69
    v_exp_f32 v25, v85
    v_mfma_f32_32x32x16_bf16 v[96:111], a[212:215], a[148:151], v[96:111]
    v_exp_f32 v22, v70
    v_exp_f32 v26, v86
    v_add_f32 v10, v10, v20
    v_mfma_f32_32x32x16_bf16 v[112:127], a[212:215], a[180:183], v[112:127]
    v_add_f32 v11, v11, v24
    v_add_f32 v10, v10, v21
    v_add_f32 v11, v11, v25
    v_cvt_pk_bf16_f32 v130, v20, v21
    v_mfma_f32_32x32x16_bf16 v[96:111], a[216:219], a[152:155], v[96:111]
    v_cvt_pk_bf16_f32 v138, v24, v25
    v_exp_f32 v23, v71
    v_exp_f32 v27, v87
    v_mfma_f32_32x32x16_bf16 v[112:127], a[216:219], a[184:187], v[112:127]
    v_exp_f32 v20, v72
    v_exp_f32 v24, v88
    v_mfma_f32_32x32x16_bf16 v[96:111], a[220:223], a[156:159], v[96:111]
    v_add_f32 v10, v10, v22
    v_add_f32 v11, v11, v26
    v_add_f32 v10, v10, v23
    v_add_f32 v11, v11, v27
    v_mfma_f32_32x32x16_bf16 v[112:127], a[220:223], a[188:191], v[112:127]
    v_cvt_pk_bf16_f32 v131, v22, v23
    v_cvt_pk_bf16_f32 v139, v26, v27
    v_exp_f32 v21, v73
    s_waitcnt lgkmcnt(0)
    s_waitcnt vmcnt(16)
    v_mfma_f32_32x32x16_bf16 a[0:15], a[224:227], v[144:147], a[0:15]
    s_barrier
    s_mov_b32 s25, s26
    s_mov_b32 s26, s27
    s_add_u32 s27, s27, 16384
    s_and_b32 s27, s27, 0xffff
    v_mfma_f32_32x32x16_bf16 a[64:79], a[224:227], v[152:155], a[64:79]
    v_add_u32 v4, s27, v2
    v_add_u32 v5, s26, v3
    v_exp_f32 v25, v89
    v_mfma_f32_32x32x16_bf16 a[16:31], a[228:231], v[144:147], a[16:31]
    ds_read_b128 a[192:195], v4 offset:0
    v_exp_f32 v22, v74
    v_exp_f32 v26, v90
    v_mfma_f32_32x32x16_bf16 a[80:95], a[228:231], v[152:155], a[80:95]
    ds_read_b128 a[196:199], v4 offset:512
    v_add_f32 v10, v10, v20
    v_add_f32 v11, v11, v24
    v_add_f32 v10, v10, v21
    v_mfma_f32_32x32x16_bf16 a[32:47], a[232:235], v[144:147], a[32:47]
    ds_read_b128 a[200:203], v4 offset:1024
    v_add_f32 v11, v11, v25
    v_cvt_pk_bf16_f32 v132, v20, v21
    v_cvt_pk_bf16_f32 v140, v24, v25
    v_mfma_f32_32x32x16_bf16 a[96:111], a[232:235], v[152:155], a[96:111]
    ds_read_b128 a[204:207], v4 offset:1536
    v_exp_f32 v23, v75
    v_exp_f32 v27, v91
    v_mfma_f32_32x32x16_bf16 a[48:63], a[236:239], v[144:147], a[48:63]
    ds_read_b128 a[208:211], v4 offset:2048
    v_exp_f32 v20, v76
    v_exp_f32 v24, v92
    v_mfma_f32_32x32x16_bf16 a[112:127], a[236:239], v[152:155], a[112:127]
    ds_read_b128 a[212:215], v4 offset:2560
    v_add_f32 v10, v10, v22
    v_add_f32 v11, v11, v26
    v_add_f32 v10, v10, v23
    v_mfma_f32_32x32x16_bf16 a[0:15], a[240:243], v[148:151], a[0:15]
    ds_read_b128 a[216:219], v4 offset:3072
    v_add_f32 v11, v11, v27
    v_cvt_pk_bf16_f32 v133, v22, v23
    v_cvt_pk_bf16_f32 v141, v26, v27
    v_mfma_f32_32x32x16_bf16 a[64:79], a[240:243], v[156:159], a[64:79]
    ds_read_b128 a[220:223], v4 offset:3584
    v_exp_f32 v21, v77
    v_exp_f32 v25, v93
    v_mfma_f32_32x32x16_bf16 a[16:31], a[244:247], v[148:151], a[16:31]
    v_exp_f32 v22, v78
    v_exp_f32 v26, v94
    v_mfma_f32_32x32x16_bf16 a[80:95], a[244:247], v[156:159], a[80:95]
    v_add_f32 v10, v10, v20
    v_add_f32 v11, v11, v24
    v_add_f32 v10, v10, v21
    v_add_f32 v11, v11, v25
    v_cvt_pk_bf16_f32 v134, v20, v21
    v_mfma_f32_32x32x16_bf16 a[32:47], a[248:251], v[148:151], a[32:47]
    v_cvt_pk_bf16_f32 v142, v24, v25
    v_exp_f32 v23, v79
    v_exp_f32 v27, v95
    v_mfma_f32_32x32x16_bf16 a[96:111], a[248:251], v[156:159], a[96:111]
    v_add_f32 v10, v10, v22
    v_add_f32 v11, v11, v26
    v_add_f32 v10, v10, v23
    v_add_f32 v11, v11, v27
    v_mfma_f32_32x32x16_bf16 a[48:63], a[252:255], v[148:151], a[48:63]
    v_cvt_pk_bf16_f32 v135, v22, v23
    v_cvt_pk_bf16_f32 v143, v26, v27
    v_max_f32 v12, v10, v11
    v_cmp_lt_f32 vcc, s33, v12
    v_mfma_f32_32x32x16_bf16 a[112:127], a[252:255], v[156:159], a[112:127]
    s_cbranch_vccnz attn_kernel_stub20
attn_kernel_ret21:
    s_sub_u32 s30, s30, 1
    s_cmp_lg_u32 s30, 0
    s_cbranch_scc1 attn_kernel_dual13
    s_sub_u32 s31, s31, 1
    s_cbranch_scc1 attn_kernel_stub22
attn_kernel_ret23:
    s_waitcnt lgkmcnt(0)
    v_mfma_f32_32x32x16_bf16 v[64:79], a[192:195], a[128:131], v[160:175]
    ds_read_b128 a[224:227], v5 offset:0
    ds_read_b128 a[228:231], v5 offset:2048
    v_add_f32 v8, v8, v10
    v_add_f32 v9, v9, v11
    v_exp_f32 v20, v96
    v_mfma_f32_32x32x16_bf16 v[64:79], a[196:199], a[132:135], v[64:79]
    ds_read_b128 a[232:235], v5 offset:4096
    ds_read_b128 a[236:239], v5 offset:6144
    s_add_u32 m0, s26, s28
    s_nop 0
    buffer_load_dwordx4 v6, s[8:11], s23 offen offset:0 lds
    v_exp_f32 v24, v112
    v_mfma_f32_32x32x16_bf16 v[64:79], a[200:203], a[136:139], v[64:79]
    ds_read_b128 a[240:243], v5 offset:512
    ds_read_b128 a[244:247], v5 offset:2560
    v_exp_f32 v21, v97
    v_exp_f32 v25, v113
    v_exp_f32 v22, v98
    v_mfma_f32_32x32x16_bf16 v[64:79], a[204:207], a[140:143], v[64:79]
    ds_read_b128 a[248:251], v5 offset:4608
    ds_read_b128 a[252:255], v5 offset:6656
    v_exp_f32 v26, v114
    v_add_f32 v10, v20, v21
    v_add_f32 v11, v24, v25
    v_mfma_f32_32x32x16_bf16 v[64:79], a[208:211], a[144:147], v[64:79]
    buffer_load_dwordx4 v6, s[8:11], s23 offen offset:1024 lds
    v_cvt_pk_bf16_f32 v144, v20, v21
    v_cvt_pk_bf16_f32 v152, v24, v25
    v_exp_f32 v23, v99
    v_mfma_f32_32x32x16_bf16 v[64:79], a[212:215], a[148:151], v[64:79]
    v_exp_f32 v27, v115
    v_exp_f32 v20, v100
    v_exp_f32 v24, v116
    v_add_f32 v10, v10, v22
    v_mfma_f32_32x32x16_bf16 v[64:79], a[216:219], a[152:155], v[64:79]
    v_add_f32 v11, v11, v26
    v_add_f32 v10, v10, v23
    v_add_f32 v11, v11, v27
    v_cvt_pk_bf16_f32 v145, v22, v23
    v_cvt_pk_bf16_f32 v153, v26, v27
    v_exp_f32 v21, v101
    v_mfma_f32_32x32x16_bf16 v[64:79], a[220:223], a[156:159], v[64:79]
    buffer_load_dwordx4 v6, s[8:11], s23 offen offset:2048 lds
    v_exp_f32 v25, v117
    v_exp_f32 v22, v102
    s_waitcnt lgkmcnt(0)
    v_mfma_f32_32x32x16_bf16 a[0:15], a[224:227], v[128:131], a[0:15]
    ds_read_b128 a[192:195], v4 offset:8192
    v_exp_f32 v26, v118
    v_add_f32 v10, v10, v20
    v_add_f32 v11, v11, v24
    v_add_f32 v10, v10, v21
    v_mfma_f32_32x32x16_bf16 a[64:79], a[224:227], v[136:139], a[64:79]
    ds_read_b128 a[196:199], v4 offset:8704
    v_add_f32 v11, v11, v25
    v_cvt_pk_bf16_f32 v146, v20, v21
    v_cvt_pk_bf16_f32 v154, v24, v25
    v_exp_f32 v23, v103
    v_mfma_f32_32x32x16_bf16 a[16:31], a[228:231], v[128:131], a[16:31]
    ds_read_b128 a[200:203], v4 offset:9216
    buffer_load_dwordx4 v6, s[8:11], s23 offen offset:3072 lds
    v_exp_f32 v27, v119
    v_exp_f32 v20, v104
    v_mfma_f32_32x32x16_bf16 a[80:95], a[228:231], v[136:139], a[80:95]
    ds_read_b128 a[204:207], v4 offset:9728
    v_exp_f32 v24, v120
    v_add_f32 v10, v10, v22
    v_add_f32 v11, v11, v26
    v_add_f32 v10, v10, v23
    v_mfma_f32_32x32x16_bf16 a[32:47], a[232:235], v[128:131], a[32:47]
    ds_read_b128 a[208:211], v4 offset:10240
    v_add_f32 v11, v11, v27
    v_cvt_pk_bf16_f32 v147, v22, v23
    v_cvt_pk_bf16_f32 v155, v26, v27
    v_exp_f32 v21, v105
    v_mfma_f32_32x32x16_bf16 a[96:111], a[232:235], v[136:139], a[96:111]
    ds_read_b128 a[212:215], v4 offset:10752
    s_add_u32 m0, s25, s29
    s_add_u32 s23, s23, 16384
    buffer_load_dwordx4 v6, s[12:15], s24 offen offset:0 lds
    v_exp_f32 v25, v121
    v_exp_f32 v22, v106
    v_mfma_f32_32x32x16_bf16 a[48:63], a[236:239], v[128:131], a[48:63]
    ds_read_b128 a[216:219], v4 offset:11264
    v_exp_f32 v26, v122
    v_add_f32 v10, v10, v20
    v_add_f32 v11, v11, v24
    v_add_f32 v10, v10, v21
    v_mfma_f32_32x32x16_bf16 a[112:127], a[236:239], v[136:139], a[112:127]
    ds_read_b128 a[220:223], v4 offset:11776
    v_add_f32 v11, v11, v25
    v_cvt_pk_bf16_f32 v148, v20, v21
    v_cvt_pk_bf16_f32 v156, v24, v25
    v_exp_f32 v23, v107
    v_mfma_f32_32x32x16_bf16 a[0:15], a[240:243], v[132:135], a[0:15]
    buffer_load_dwordx4 v6, s[12:15], s24 offen offset:1024 lds
    v_exp_f32 v27, v123
    v_exp_f32 v20, v108
    v_mfma_f32_32x32x16_bf16 a[64:79], a[240:243], v[140:143], a[64:79]
    v_exp_f32 v24, v124
    v_add_f32 v10, v10, v22
    v_add_f32 v11, v11, v26
    v_add_f32 v10, v10, v23
    v_add_f32 v11, v11, v27
    v_cvt_pk_bf16_f32 v149, v22, v23
    v_mfma_f32_32x32x16_bf16 a[16:31], a[244:247], v[132:135], a[16:31]
    v_cvt_pk_bf16_f32 v157, v26, v27
    v_exp_f32 v21, v109
    v_exp_f32 v25, v125
    v_exp_f32 v22, v110
    v_mfma_f32_32x32x16_bf16 a[80:95], a[244:247], v[140:143], a[80:95]
    buffer_load_dwordx4 v6, s[12:15], s24 offen offset:2048 lds
    v_exp_f32 v26, v126
    v_add_f32 v10, v10, v20
    v_add_f32 v11, v11, v24
    v_mfma_f32_32x32x16_bf16 a[32:47], a[248:251], v[132:135], a[32:47]
    v_add_f32 v10, v10, v21
    v_add_f32 v11, v11, v25
    v_cvt_pk_bf16_f32 v150, v20, v21
    v_cvt_pk_bf16_f32 v158, v24, v25
    v_exp_f32 v23, v111
    v_mfma_f32_32x32x16_bf16 a[96:111], a[248:251], v[140:143], a[96:111]
    v_exp_f32 v27, v127
    v_add_f32 v10, v10, v22
    v_add_f32 v11, v11, v26
    v_add_f32 v10, v10, v23
    v_add_f32 v11, v11, v27
    v_cvt_pk_bf16_f32 v151, v22, v23
    v_mfma_f32_32x32x16_bf16 a[48:63], a[252:255], v[132:135], a[48:63]
    buffer_load_dwordx4 v6, s[12:15], s24 offen offset:3072 lds
    s_add_u32 s24, s24, 16384
    v_cvt_pk_bf16_f32 v159, v26, v27
    v_max_f32 v12, v10, v11
    v_cmp_lt_f32 vcc, s33, v12
    v_mfma_f32_32x32x16_bf16 a[112:127], a[252:255], v[140:143], a[112:127]
    s_cbranch_vccnz attn_kernel_stub24
attn_kernel_ret25:
    s_sub_u32 s31, s31, 1
    s_cbranch_scc1 attn_kernel_stub26
attn_kernel_ret27:
    s_waitcnt lgkmcnt(0)
    v_mfma_f32_32x32x16_bf16 v[96:111], a[192:195], a[128:131], v[160:175]
    ds_read_b128 a[224:227], v5 offset:8192
    ds_read_b128 a[228:231], v5 offset:10240
    v_add_f32 v8, v8, v10
    v_mfma_f32_32x32x16_bf16 v[96:111], a[196:199], a[132:135], v[96:111]
    ds_read_b128 a[232:235], v5 offset:12288
    ds_read_b128 a[236:239], v5 offset:14336
    v_exp_f32 v20, v64
    v_mfma_f32_32x32x16_bf16 v[96:111], a[200:203], a[136:139], v[96:111]
    ds_read_b128 a[240:243], v5 offset:8704
    ds_read_b128 a[244:247], v5 offset:10752
    v_exp_f32 v21, v65
    v_mfma_f32_32x32x16_bf16 v[96:111], a[204:207], a[140:143], v[96:111]
    ds_read_b128 a[248:251], v5 offset:12800
    ds_read_b128 a[252:255], v5 offset:14848
    v_exp_f32 v22, v66
    v_mfma_f32_32x32x16_bf16 v[96:111], a[208:211], a[144:147], v[96:111]
    v_add_f32 v10, v20, v21
    v_cvt_pk_bf16_f32 v128, v20, v21
    v_mfma_f32_32x32x16_bf16 v[96:111], a[212:215], a[148:151], v[96:111]
    v_exp_f32 v23, v67
    v_exp_f32 v20, v68
    v_mfma_f32_32x32x16_bf16 v[96:111], a[216:219], a[152:155], v[96:111]
    v_add_f32 v10, v10, v22
    v_add_f32 v10, v10, v23
    v_cvt_pk_bf16_f32 v129, v22, v23
    v_mfma_f32_32x32x16_bf16 v[96:111], a[220:223], a[156:159], v[96:111]
    v_exp_f32 v21, v69
    v_exp_f32 v22, v70
    s_waitcnt lgkmcnt(0)
    s_waitcnt vmcnt(16)
    v_mfma_f32_32x32x16_bf16 a[0:15], a[224:227], v[144:147], a[0:15]
    s_barrier
    s_mov_b32 s25, s26
    s_mov_b32 s26, s27
    s_add_u32 s27, s27, 16384
    s_and_b32 s27, s27, 0xffff
    v_mfma_f32_32x32x16_bf16 a[64:79], a[224:227], v[152:155], a[64:79]
    v_add_u32 v4, s27, v2
    v_add_u32 v5, s26, v3
    v_mfma_f32_32x32x16_bf16 a[16:31], a[228:231], v[144:147], a[16:31]
    ds_read_b128 a[192:195], v4 offset:0
    v_add_f32 v10, v10, v20
    v_add_f32 v10, v10, v21
    v_cvt_pk_bf16_f32 v130, v20, v21
    v_mfma_f32_32x32x16_bf16 a[80:95], a[228:231], v[152:155], a[80:95]
    ds_read_b128 a[196:199], v4 offset:512
    v_exp_f32 v23, v71
    v_mfma_f32_32x32x16_bf16 a[32:47], a[232:235], v[144:147], a[32:47]
    ds_read_b128 a[200:203], v4 offset:1024
    v_exp_f32 v20, v72
    v_add_f32 v10, v10, v22
    v_mfma_f32_32x32x16_bf16 a[96:111], a[232:235], v[152:155], a[96:111]
    ds_read_b128 a[204:207], v4 offset:1536
    v_add_f32 v10, v10, v23
    v_cvt_pk_bf16_f32 v131, v22, v23
    v_mfma_f32_32x32x16_bf16 a[48:63], a[236:239], v[144:147], a[48:63]
    ds_read_b128 a[208:211], v4 offset:2048
    v_exp_f32 v21, v73
    v_mfma_f32_32x32x16_bf16 a[112:127], a[236:239], v[152:155], a[112:127]
    ds_read_b128 a[212:215], v4 offset:2560
    v_exp_f32 v22, v74
    v_add_f32 v10, v10, v20
    v_mfma_f32_32x32x16_bf16 a[0:15], a[240:243], v[148:151], a[0:15]
    ds_read_b128 a[216:219], v4 offset:3072
    v_add_f32 v10, v10, v21
    v_cvt_pk_bf16_f32 v132, v20, v21
    v_mfma_f32_32x32x16_bf16 a[64:79], a[240:243], v[156:159], a[64:79]
    ds_read_b128 a[220:223], v4 offset:3584
    v_exp_f32 v23, v75
    v_exp_f32 v20, v76
    v_mfma_f32_32x32x16_bf16 a[16:31], a[244:247], v[148:151], a[16:31]
    v_add_f32 v10, v10, v22
    v_add_f32 v10, v10, v23
    v_cvt_pk_bf16_f32 v133, v22, v23
    v_mfma_f32_32x32x16_bf16 a[80:95], a[244:247], v[156:159], a[80:95]
    v_exp_f32 v21, v77
    v_exp_f32 v22, v78
    v_mfma_f32_32x32x16_bf16 a[32:47], a[248:251], v[148:151], a[32:47]
    v_add_f32 v10, v10, v20
    v_add_f32 v10, v10, v21
    v_cvt_pk_bf16_f32 v134, v20, v21
    v_mfma_f32_32x32x16_bf16 a[96:111], a[248:251], v[156:159], a[96:111]
    v_exp_f32 v23, v79
    s_nop 0
    v_mfma_f32_32x32x16_bf16 a[48:63], a[252:255], v[148:151], a[48:63]
    v_add_f32 v10, v10, v22
    v_add_f32 v10, v10, v23
    v_cvt_pk_bf16_f32 v135, v22, v23
    v_cmp_lt_f32 vcc, s33, v10
    v_mfma_f32_32x32x16_bf16 a[112:127], a[252:255], v[156:159], a[112:127]
    s_cbranch_vccnz attn_kernel_stub28
attn_kernel_ret29:
    v_add_f32 v28, v9, v11
    v_mov_b32 v29, v28
    s_nop 1
    v_permlane32_swap_b32 v28, v29
    s_nop 1
    v_add_f32 v28, v28, v29
    v_rcp_f32 v12, v28
    s_lshl_b32 s40, s49, 17
    s_lshl_b32 s41, s21, 12
    s_add_u32 s40, s40, s41
    s_add_u32 s40, s40, 67108864
    s_nop 7
    v_accvgpr_read_b32 v28, a64
    v_accvgpr_read_b32 v29, a65
    v_accvgpr_read_b32 v30, a66
    v_accvgpr_read_b32 v31, a67
    v_accvgpr_read_b32 v32, a68
    v_accvgpr_read_b32 v33, a69
    v_accvgpr_read_b32 v34, a70
    v_accvgpr_read_b32 v35, a71
    v_mul_f32 v28, v12, v28
    v_mul_f32 v29, v12, v29
    v_mul_f32 v30, v12, v30
    v_mul_f32 v31, v12, v31
    v_mul_f32 v32, v12, v32
    v_mul_f32 v33, v12, v33
    v_mul_f32 v34, v12, v34
    v_mul_f32 v35, v12, v35
    v_cvt_pk_bf16_f32 v28, v28, v29
    v_cvt_pk_bf16_f32 v29, v30, v31
    v_cvt_pk_bf16_f32 v30, v32, v33
    v_cvt_pk_bf16_f32 v31, v34, v35
    buffer_store_dwordx4 v[28:31], v44, s[16:19], s40 offen offset:0
    v_accvgpr_read_b32 v36, a72
    v_accvgpr_read_b32 v37, a73
    v_accvgpr_read_b32 v38, a74
    v_accvgpr_read_b32 v39, a75
    v_accvgpr_read_b32 v40, a76
    v_accvgpr_read_b32 v41, a77
    v_accvgpr_read_b32 v42, a78
    v_accvgpr_read_b32 v43, a79
    v_mul_f32 v36, v12, v36
    v_mul_f32 v37, v12, v37
    v_mul_f32 v38, v12, v38
    v_mul_f32 v39, v12, v39
    v_mul_f32 v40, v12, v40
    v_mul_f32 v41, v12, v41
    v_mul_f32 v42, v12, v42
    v_mul_f32 v43, v12, v43
    v_cvt_pk_bf16_f32 v36, v36, v37
    v_cvt_pk_bf16_f32 v37, v38, v39
    v_cvt_pk_bf16_f32 v38, v40, v41
    v_cvt_pk_bf16_f32 v39, v42, v43
    buffer_store_dwordx4 v[36:39], v44, s[16:19], s40 offen offset:512
    v_accvgpr_read_b32 v28, a80
    v_accvgpr_read_b32 v29, a81
    v_accvgpr_read_b32 v30, a82
    v_accvgpr_read_b32 v31, a83
    v_accvgpr_read_b32 v32, a84
    v_accvgpr_read_b32 v33, a85
    v_accvgpr_read_b32 v34, a86
    v_accvgpr_read_b32 v35, a87
    v_mul_f32 v28, v12, v28
    v_mul_f32 v29, v12, v29
    v_mul_f32 v30, v12, v30
    v_mul_f32 v31, v12, v31
    v_mul_f32 v32, v12, v32
    v_mul_f32 v33, v12, v33
    v_mul_f32 v34, v12, v34
    v_mul_f32 v35, v12, v35
    v_cvt_pk_bf16_f32 v28, v28, v29
    v_cvt_pk_bf16_f32 v29, v30, v31
    v_cvt_pk_bf16_f32 v30, v32, v33
    v_cvt_pk_bf16_f32 v31, v34, v35
    buffer_store_dwordx4 v[28:31], v44, s[16:19], s40 offen offset:1024
    v_accvgpr_read_b32 v36, a88
    v_accvgpr_read_b32 v37, a89
    v_accvgpr_read_b32 v38, a90
    v_accvgpr_read_b32 v39, a91
    v_accvgpr_read_b32 v40, a92
    v_accvgpr_read_b32 v41, a93
    v_accvgpr_read_b32 v42, a94
    v_accvgpr_read_b32 v43, a95
    v_mul_f32 v36, v12, v36
    v_mul_f32 v37, v12, v37
    v_mul_f32 v38, v12, v38
    v_mul_f32 v39, v12, v39
    v_mul_f32 v40, v12, v40
    v_mul_f32 v41, v12, v41
    v_mul_f32 v42, v12, v42
    v_mul_f32 v43, v12, v43
    v_cvt_pk_bf16_f32 v36, v36, v37
    v_cvt_pk_bf16_f32 v37, v38, v39
    v_cvt_pk_bf16_f32 v38, v40, v41
    v_cvt_pk_bf16_f32 v39, v42, v43
    buffer_store_dwordx4 v[36:39], v44, s[16:19], s40 offen offset:1536
    v_accvgpr_read_b32 v28, a96
    v_accvgpr_read_b32 v29, a97
    v_accvgpr_read_b32 v30, a98
    v_accvgpr_read_b32 v31, a99
    v_accvgpr_read_b32 v32, a100
    v_accvgpr_read_b32 v33, a101
    v_accvgpr_read_b32 v34, a102
    v_accvgpr_read_b32 v35, a103
    v_mul_f32 v28, v12, v28
    v_mul_f32 v29, v12, v29
    v_mul_f32 v30, v12, v30
    v_mul_f32 v31, v12, v31
    v_mul_f32 v32, v12, v32
    v_mul_f32 v33, v12, v33
    v_mul_f32 v34, v12, v34
    v_mul_f32 v35, v12, v35
    v_cvt_pk_bf16_f32 v28, v28, v29
    v_cvt_pk_bf16_f32 v29, v30, v31
    v_cvt_pk_bf16_f32 v30, v32, v33
    v_cvt_pk_bf16_f32 v31, v34, v35
    buffer_store_dwordx4 v[28:31], v44, s[16:19], s40 offen offset:2048
    v_accvgpr_read_b32 v36, a104
    v_accvgpr_read_b32 v37, a105
    v_accvgpr_read_b32 v38, a106
    v_accvgpr_read_b32 v39, a107
    v_accvgpr_read_b32 v40, a108
    v_accvgpr_read_b32 v41, a109
    v_accvgpr_read_b32 v42, a110
    v_accvgpr_read_b32 v43, a111
    v_mul_f32 v36, v12, v36
    v_mul_f32 v37, v12, v37
    v_mul_f32 v38, v12, v38
    v_mul_f32 v39, v12, v39
    v_mul_f32 v40, v12, v40
    v_mul_f32 v41, v12, v41
    v_mul_f32 v42, v12, v42
    v_mul_f32 v43, v12, v43
    v_cvt_pk_bf16_f32 v36, v36, v37
    v_cvt_pk_bf16_f32 v37, v38, v39
    v_cvt_pk_bf16_f32 v38, v40, v41
    v_cvt_pk_bf16_f32 v39, v42, v43
    buffer_store_dwordx4 v[36:39], v44, s[16:19], s40 offen offset:2560
    v_accvgpr_read_b32 v28, a112
    v_accvgpr_read_b32 v29, a113
    v_accvgpr_read_b32 v30, a114
    v_accvgpr_read_b32 v31, a115
    v_accvgpr_read_b32 v32, a116
    v_accvgpr_read_b32 v33, a117
    v_accvgpr_read_b32 v34, a118
    v_accvgpr_read_b32 v35, a119
    v_mul_f32 v28, v12, v28
    v_mul_f32 v29, v12, v29
    v_mul_f32 v30, v12, v30
    v_mul_f32 v31, v12, v31
    v_mul_f32 v32, v12, v32
    v_mul_f32 v33, v12, v33
    v_mul_f32 v34, v12, v34
    v_mul_f32 v35, v12, v35
    v_cvt_pk_bf16_f32 v28, v28, v29
    v_cvt_pk_bf16_f32 v29, v30, v31
    v_cvt_pk_bf16_f32 v30, v32, v33
    v_cvt_pk_bf16_f32 v31, v34, v35
    buffer_store_dwordx4 v[28:31], v44, s[16:19], s40 offen offset:3072
    v_accvgpr_read_b32 v36, a120
    v_accvgpr_read_b32 v37, a121
    v_accvgpr_read_b32 v38, a122
    v_accvgpr_read_b32 v39, a123
    v_accvgpr_read_b32 v40, a124
    v_accvgpr_read_b32 v41, a125
    v_accvgpr_read_b32 v42, a126
    v_accvgpr_read_b32 v43, a127
    v_mul_f32 v36, v12, v36
    v_mul_f32 v37, v12, v37
    v_mul_f32 v38, v12, v38
    v_mul_f32 v39, v12, v39
    v_mul_f32 v40, v12, v40
    v_mul_f32 v41, v12, v41
    v_mul_f32 v42, v12, v42
    v_mul_f32 v43, v12, v43
    v_cvt_pk_bf16_f32 v36, v36, v37
    v_cvt_pk_bf16_f32 v37, v38, v39
    v_cvt_pk_bf16_f32 v38, v40, v41
    v_cvt_pk_bf16_f32 v39, v42, v43
    buffer_store_dwordx4 v[36:39], v44, s[16:19], s40 offen offset:3584
    s_and_b32 s40, s2, 7
    s_lshl_b32 s40, s40, 4
    s_lshl_b32 s41, s20, 2
    s_add_u32 s50, s40, s41
    s_lshr_b32 s42, s2, 3
    s_lshl_b32 s42, s42, 17
    s_lshl_b32 s40, s50, 10
    s_add_u32 s40, s40, s42
    s_add_u32 s41, s40, 50331648
    v_lshlrev_b32 v28, 4, v1
    buffer_load_dwordx4 v[192:195], v28, s[16:19], s41 offen offset:0
    buffer_load_dwordx4 v[196:199], v28, s[16:19], s41 offen offset:1024
    buffer_load_dwordx4 v[200:203], v28, s[16:19], s41 offen offset:2048
    buffer_load_dwordx4 v[204:207], v28, s[16:19], s41 offen offset:3072
    s_add_u32 s41, s40, 54525952
    buffer_load_dwordx4 v[212:215], v28, s[16:19], s41 offen offset:0
    buffer_load_dwordx4 v[216:219], v28, s[16:19], s41 offen offset:1024
    buffer_load_dwordx4 v[220:223], v28, s[16:19], s41 offen offset:2048
    buffer_load_dwordx4 v[224:227], v28, s[16:19], s41 offen offset:3072
    s_and_b32 s51, s50, 63
    s_cmp_eq_u32 s51, 0
    s_cselect_b32 s43, 0, 1024
    s_sub_u32 s41, s41, s43
    buffer_load_dwordx4 v[208:211], v28, s[16:19], s41 offen
    s_lshl_b32 s40, s50, 9
    s_add_u32 s40, s40, s42
    s_add_u32 s40, s40, 58720256
    buffer_load_dwordx4 v[232:235], v28, s[16:19], s40 offen offset:0
    buffer_load_dwordx4 v[236:239], v28, s[16:19], s40 offen offset:1024
    s_sub_u32 s41, s40, s43
    buffer_load_dwordx4 v[228:231], v28, s[16:19], s41 offen
    s_add_u32 s40, s40, 65536
    buffer_load_dwordx4 v[244:247], v28, s[16:19], s40 offen offset:0
    buffer_load_dwordx4 v[248:251], v28, s[16:19], s40 offen offset:1024
    s_sub_u32 s41, s40, s43
    buffer_load_dwordx4 v[240:243], v28, s[16:19], s41 offen
    s_lshl_b32 s30, s22, 2
    s_sub_u32 s30, 29, s30
attn_kernel_single30:
    s_sub_u32 s31, s31, 1
    s_cbranch_scc1 attn_kernel_stub31
attn_kernel_ret32:
    s_waitcnt lgkmcnt(0)
    v_mfma_f32_32x32x16_bf16 v[64:79], a[192:195], a[128:131], v[160:175]
    ds_read_b128 a[224:227], v5 offset:0
    ds_read_b128 a[228:231], v5 offset:2048
    v_add_f32 v8, v8, v10
    v_exp_f32 v20, v96
    v_exp_f32 v21, v97
    v_mfma_f32_32x32x16_bf16 v[64:79], a[196:199], a[132:135], v[64:79]
    ds_read_b128 a[232:235], v5 offset:4096
    ds_read_b128 a[236:239], v5 offset:6144
    s_add_u32 m0, s26, s28
    s_nop 0
    buffer_load_dwordx4 v6, s[8:11], s23 offen offset:0 lds
    v_exp_f32 v22, v98
    v_mfma_f32_32x32x16_bf16 v[64:79], a[200:203], a[136:139], v[64:79]
    ds_read_b128 a[240:243], v5 offset:512
    ds_read_b128 a[244:247], v5 offset:2560
    v_add_f32 v10, v20, v21
    v_cvt_pk_bf16_f32 v144, v20, v21
    v_exp_f32 v23, v99
    v_mfma_f32_32x32x16_bf16 v[64:79], a[204:207], a[140:143], v[64:79]
    ds_read_b128 a[248:251], v5 offset:4608
    ds_read_b128 a[252:255], v5 offset:6656
    buffer_load_dwordx4 v6, s[8:11], s23 offen offset:1024 lds
    v_exp_f32 v20, v100
    v_mfma_f32_32x32x16_bf16 v[64:79], a[208:211], a[144:147], v[64:79]
    v_add_f32 v10, v10, v22
    v_add_f32 v10, v10, v23
    v_cvt_pk_bf16_f32 v145, v22, v23
    v_exp_f32 v21, v101
    v_mfma_f32_32x32x16_bf16 v[64:79], a[212:215], a[148:151], v[64:79]
    buffer_load_dwordx4 v6, s[8:11], s23 offen offset:2048 lds
    v_exp_f32 v22, v102
    v_add_f32 v10, v10, v20
    v_add_f32 v10, v10, v21
    v_cvt_pk_bf16_f32 v146, v20, v21
    v_mfma_f32_32x32x16_bf16 v[64:79], a[216:219], a[152:155], v[64:79]
    v_exp_f32 v23, v103
    v_exp_f32 v20, v104
    v_add_f32 v10, v10, v22
    v_add_f32 v10, v10, v23
    v_mfma_f32_32x32x16_bf16 v[64:79], a[220:223], a[156:159], v[64:79]
    buffer_load_dwordx4 v6, s[8:11], s23 offen offset:3072 lds
    v_cvt_pk_bf16_f32 v147, v22, v23
    v_exp_f32 v21, v105
    v_exp_f32 v22, v106
    s_waitcnt lgkmcnt(0)
    v_mfma_f32_32x32x16_bf16 a[0:15], a[224:227], v[128:131], a[0:15]
    ds_read_b128 a[192:195], v4 offset:8192
    ds_read_b128 a[196:199], v4 offset:8704
    v_add_f32 v10, v10, v20
    v_add_f32 v10, v10, v21
    v_cvt_pk_bf16_f32 v148, v20, v21
    v_mfma_f32_32x32x16_bf16 a[16:31], a[228:231], v[128:131], a[16:31]
    ds_read_b128 a[200:203], v4 offset:9216
    ds_read_b128 a[204:207], v4 offset:9728
    s_add_u32 m0, s25, s29
    s_add_u32 s23, s23, 16384
    buffer_load_dwordx4 v6, s[12:15], s24 offen offset:0 lds
    v_exp_f32 v23, v107
    v_mfma_f32_32x32x16_bf16 a[32:47], a[232:235], v[128:131], a[32:47]
    ds_read_b128 a[208:211], v4 offset:10240
    ds_read_b128 a[212:215], v4 offset:10752
    v_exp_f32 v20, v108
    v_add_f32 v10, v10, v22
    v_mfma_f32_32x32x16_bf16 a[48:63], a[236:239], v[128:131], a[48:63]
    ds_read_b128 a[216:219], v4 offset:11264
    ds_read_b128 a[220:223], v4 offset:11776
    buffer_load_dwordx4 v6, s[12:15], s24 offen offset:1024 lds
    v_add_f32 v10, v10, v23
    v_cvt_pk_bf16_f32 v149, v22, v23
    v_mfma_f32_32x32x16_bf16 a[0:15], a[240:243], v[132:135], a[0:15]
    v_exp_f32 v21, v109
    v_exp_f32 v22, v110
    v_add_f32 v10, v10, v20
    v_add_f32 v10, v10, v21
    v_cvt_pk_bf16_f32 v150, v20, v21
    v_mfma_f32_32x32x16_bf16 a[16:31], a[244:247], v[132:135], a[16:31]
    buffer_load_dwordx4 v6, s[12:15], s24 offen offset:2048 lds
    v_exp_f32 v23, v111
    s_nop 0
    v_add_f32 v10, v10, v22
    v_mfma_f32_32x32x16_bf16 a[32:47], a[248:251], v[132:135], a[32:47]
    buffer_load_dwordx4 v6, s[12:15], s24 offen offset:3072 lds
    s_add_u32 s24, s24, 16384
    v_add_f32 v10, v10, v23
    v_cvt_pk_bf16_f32 v151, v22, v23
    v_cmp_lt_f32 vcc, s33, v10
    v_mfma_f32_32x32x16_bf16 a[48:63], a[252:255], v[132:135], a[48:63]
    s_cbranch_vccnz attn_kernel_stub33
attn_kernel_ret34:
    s_sub_u32 s31, s31, 1
    s_cbranch_scc1 attn_kernel_stub35
attn_kernel_ret36:
    s_waitcnt lgkmcnt(0)
    v_mfma_f32_32x32x16_bf16 v[96:111], a[192:195], a[128:131], v[160:175]
    ds_read_b128 a[224:227], v5 offset:8192
    ds_read_b128 a[228:231], v5 offset:10240
    v_add_f32 v8, v8, v10
    v_exp_f32 v20, v64
    v_mfma_f32_32x32x16_bf16 v[96:111], a[196:199], a[132:135], v[96:111]
    ds_read_b128 a[232:235], v5 offset:12288
    ds_read_b128 a[236:239], v5 offset:14336
    v_exp_f32 v21, v65
    v_exp_f32 v22, v66
    v_mfma_f32_32x32x16_bf16 v[96:111], a[200:203], a[136:139], v[96:111]
    ds_read_b128 a[240:243], v5 offset:8704
    ds_read_b128 a[244:247], v5 offset:10752
    v_add_f32 v10, v20, v21
    v_cvt_pk_bf16_f32 v128, v20, v21
    v_exp_f32 v23, v67
    v_mfma_f32_32x32x16_bf16 v[96:111], a[204:207], a[140:143], v[96:111]
    ds_read_b128 a[248:251], v5 offset:12800
    ds_read_b128 a[252:255], v5 offset:14848
    v_exp_f32 v20, v68
    v_add_f32 v10, v10, v22
    v_mfma_f32_32x32x16_bf16 v[96:111], a[208:211], a[144:147], v[96:111]
    v_add_f32 v10, v10, v23
    v_cvt_pk_bf16_f32 v129, v22, v23
    v_exp_f32 v21, v69
    v_exp_f32 v22, v70
    v_mfma_f32_32x32x16_bf16 v[96:111], a[212:215], a[148:151], v[96:111]
    v_add_f32 v10, v10, v20
    v_add_f32 v10, v10, v21
    v_cvt_pk_bf16_f32 v130, v20, v21
    v_exp_f32 v23, v71
    v_mfma_f32_32x32x16_bf16 v[96:111], a[216:219], a[152:155], v[96:111]
    v_exp_f32 v20, v72
    v_add_f32 v10, v10, v22
    v_add_f32 v10, v10, v23
    v_cvt_pk_bf16_f32 v131, v22, v23
    v_mfma_f32_32x32x16_bf16 v[96:111], a[220:223], a[156:159], v[96:111]
    v_exp_f32 v21, v73
    v_exp_f32 v22, v74
    v_add_f32 v10, v10, v20
    s_waitcnt lgkmcnt(0)
    s_waitcnt vmcnt(16)
    v_mfma_f32_32x32x16_bf16 a[0:15], a[224:227], v[144:147], a[0:15]
    s_barrier
    s_mov_b32 s25, s26
    s_mov_b32 s26, s27
    s_add_u32 s27, s27, 16384
    s_and_b32 s27, s27, 0xffff
    v_add_f32 v10, v10, v21
    v_mfma_f32_32x32x16_bf16 a[16:31], a[228:231], v[144:147], a[16:31]
    v_add_u32 v4, s27, v2
    v_add_u32 v5, s26, v3
    v_cvt_pk_bf16_f32 v132, v20, v21
    v_exp_f32 v23, v75
    v_mfma_f32_32x32x16_bf16 a[32:47], a[232:235], v[144:147], a[32:47]
    ds_read_b128 a[192:195], v4 offset:0
    ds_read_b128 a[196:199], v4 offset:512
    v_exp_f32 v20, v76
    v_add_f32 v10, v10, v22
    v_mfma_f32_32x32x16_bf16 a[48:63], a[236:239], v[144:147], a[48:63]
    ds_read_b128 a[200:203], v4 offset:1024
    ds_read_b128 a[204:207], v4 offset:1536
    v_add_f32 v10, v10, v23
    v_cvt_pk_bf16_f32 v133, v22, v23
    v_exp_f32 v21, v77
    v_mfma_f32_32x32x16_bf16 a[0:15], a[240:243], v[148:151], a[0:15]
    ds_read_b128 a[208:211], v4 offset:2048
    ds_read_b128 a[212:215], v4 offset:2560
    v_exp_f32 v22, v78
    v_add_f32 v10, v10, v20
    v_mfma_f32_32x32x16_bf16 a[16:31], a[244:247], v[148:151], a[16:31]
    ds_read_b128 a[216:219], v4 offset:3072
    ds_read_b128 a[220:223], v4 offset:3584
    v_add_f32 v10, v10, v21
    v_cvt_pk_bf16_f32 v134, v20, v21
    v_exp_f32 v23, v79
    v_mfma_f32_32x32x16_bf16 a[32:47], a[248:251], v[148:151], a[32:47]
    s_nop 0
    v_add_f32 v10, v10, v22
    v_add_f32 v10, v10, v23
    v_cvt_pk_bf16_f32 v135, v22, v23
    v_cmp_lt_f32 vcc, s33, v10
    v_mfma_f32_32x32x16_bf16 a[48:63], a[252:255], v[148:151], a[48:63]
    s_cbranch_vccnz attn_kernel_stub37
attn_kernel_ret38:
    s_sub_u32 s30, s30, 1
    s_cmp_lg_u32 s30, 0
    s_cbranch_scc1 attn_kernel_single30
    ds_read_b128 a[224:227], v5 offset:0
    ds_read_b128 a[228:231], v5 offset:2048
    ds_read_b128 a[232:235], v5 offset:4096
    ds_read_b128 a[236:239], v5 offset:6144
    ds_read_b128 a[240:243], v5 offset:512
    ds_read_b128 a[244:247], v5 offset:2560
    ds_read_b128 a[248:251], v5 offset:4608
    ds_read_b128 a[252:255], v5 offset:6656
    s_waitcnt lgkmcnt(0)
    v_mfma_f32_32x32x16_bf16 a[0:15], a[224:227], v[128:131], a[0:15]
    v_add_f32 v8, v8, v10
    v_exp_f32 v20, v96
    v_exp_f32 v21, v97
    v_exp_f32 v22, v98
    v_add_f32 v10, v20, v21
    v_mfma_f32_32x32x16_bf16 a[16:31], a[228:231], v[128:131], a[16:31]
    v_cvt_pk_bf16_f32 v144, v20, v21
    v_exp_f32 v23, v99
    v_exp_f32 v20, v100
    v_add_f32 v10, v10, v22
    v_add_f32 v10, v10, v23
    v_cvt_pk_bf16_f32 v145, v22, v23
    v_mfma_f32_32x32x16_bf16 a[32:47], a[232:235], v[128:131], a[32:47]
    v_exp_f32 v21, v101
    v_exp_f32 v22, v102
    v_add_f32 v10, v10, v20
    v_add_f32 v10, v10, v21
    v_cvt_pk_bf16_f32 v146, v20, v21
    v_exp_f32 v23, v103
    v_mfma_f32_32x32x16_bf16 a[48:63], a[236:239], v[128:131], a[48:63]
    v_exp_f32 v20, v104
    v_add_f32 v10, v10, v22
    v_add_f32 v10, v10, v23
    v_cvt_pk_bf16_f32 v147, v22, v23
    v_exp_f32 v21, v105
    v_exp_f32 v22, v106
    v_mfma_f32_32x32x16_bf16 a[0:15], a[240:243], v[132:135], a[0:15]
    v_add_f32 v10, v10, v20
    v_add_f32 v10, v10, v21
    v_cvt_pk_bf16_f32 v148, v20, v21
    v_exp_f32 v23, v107
    v_exp_f32 v20, v108
    v_mfma_f32_32x32x16_bf16 a[16:31], a[244:247], v[132:135], a[16:31]
    v_add_f32 v10, v10, v22
    v_add_f32 v10, v10, v23
    v_cvt_pk_bf16_f32 v149, v22, v23
    v_exp_f32 v21, v109
    v_exp_f32 v22, v110
    v_add_f32 v10, v10, v20
    v_add_f32 v10, v10, v21
    v_mfma_f32_32x32x16_bf16 a[32:47], a[248:251], v[132:135], a[32:47]
    v_cvt_pk_bf16_f32 v150, v20, v21
    v_exp_f32 v23, v111
    s_nop 0
    v_add_f32 v10, v10, v22
    v_add_f32 v10, v10, v23
    v_cvt_pk_bf16_f32 v151, v22, v23
    v_cmp_lt_f32 vcc, s33, v10
    v_mfma_f32_32x32x16_bf16 a[48:63], a[252:255], v[132:135], a[48:63]
    s_cbranch_vccnz attn_kernel_stub39
attn_kernel_ret40:
    s_nop 1
    ds_read_b128 a[224:227], v5 offset:8192
    ds_read_b128 a[228:231], v5 offset:10240
    ds_read_b128 a[232:235], v5 offset:12288
    ds_read_b128 a[236:239], v5 offset:14336
    ds_read_b128 a[240:243], v5 offset:8704
    ds_read_b128 a[244:247], v5 offset:10752
    ds_read_b128 a[248:251], v5 offset:12800
    ds_read_b128 a[252:255], v5 offset:14848
    s_waitcnt lgkmcnt(0)
    v_mfma_f32_32x32x16_bf16 a[0:15], a[224:227], v[144:147], a[0:15]
    v_mfma_f32_32x32x16_bf16 a[16:31], a[228:231], v[144:147], a[16:31]
    v_mfma_f32_32x32x16_bf16 a[32:47], a[232:235], v[144:147], a[32:47]
    v_mfma_f32_32x32x16_bf16 a[48:63], a[236:239], v[144:147], a[48:63]
    v_mfma_f32_32x32x16_bf16 a[0:15], a[240:243], v[148:151], a[0:15]
    v_mfma_f32_32x32x16_bf16 a[16:31], a[244:247], v[148:151], a[16:31]
    v_mfma_f32_32x32x16_bf16 a[32:47], a[248:251], v[148:151], a[32:47]
    v_mfma_f32_32x32x16_bf16 a[48:63], a[252:255], v[148:151], a[48:63]
    v_add_f32 v28, v8, v10
    v_mov_b32 v29, v28
    s_nop 1
    v_permlane32_swap_b32 v28, v29
    s_nop 1
    v_add_f32 v28, v28, v29
    v_rcp_f32 v12, v28
    s_lshl_b32 s40, s48, 17
    s_lshl_b32 s41, s21, 12
    s_add_u32 s40, s40, s41
    s_add_u32 s40, s40, 67108864
    s_nop 7
    v_accvgpr_read_b32 v28, a0
    v_accvgpr_read_b32 v29, a1
    v_accvgpr_read_b32 v30, a2
    v_accvgpr_read_b32 v31, a3
    v_accvgpr_read_b32 v32, a4
    v_accvgpr_read_b32 v33, a5
    v_accvgpr_read_b32 v34, a6
    v_accvgpr_read_b32 v35, a7
    v_mul_f32 v28, v12, v28
    v_mul_f32 v29, v12, v29
    v_mul_f32 v30, v12, v30
    v_mul_f32 v31, v12, v31
    v_mul_f32 v32, v12, v32
    v_mul_f32 v33, v12, v33
    v_mul_f32 v34, v12, v34
    v_mul_f32 v35, v12, v35
    v_cvt_pk_bf16_f32 v28, v28, v29
    v_cvt_pk_bf16_f32 v29, v30, v31
    v_cvt_pk_bf16_f32 v30, v32, v33
    v_cvt_pk_bf16_f32 v31, v34, v35
    buffer_store_dwordx4 v[28:31], v44, s[16:19], s40 offen offset:0
    v_accvgpr_read_b32 v36, a8
    v_accvgpr_read_b32 v37, a9
    v_accvgpr_read_b32 v38, a10
    v_accvgpr_read_b32 v39, a11
    v_accvgpr_read_b32 v40, a12
    v_accvgpr_read_b32 v41, a13
    v_accvgpr_read_b32 v42, a14
    v_accvgpr_read_b32 v43, a15
    v_mul_f32 v36, v12, v36
    v_mul_f32 v37, v12, v37
    v_mul_f32 v38, v12, v38
    v_mul_f32 v39, v12, v39
    v_mul_f32 v40, v12, v40
    v_mul_f32 v41, v12, v41
    v_mul_f32 v42, v12, v42
    v_mul_f32 v43, v12, v43
    v_cvt_pk_bf16_f32 v36, v36, v37
    v_cvt_pk_bf16_f32 v37, v38, v39
    v_cvt_pk_bf16_f32 v38, v40, v41
    v_cvt_pk_bf16_f32 v39, v42, v43
    buffer_store_dwordx4 v[36:39], v44, s[16:19], s40 offen offset:512
    v_accvgpr_read_b32 v28, a16
    v_accvgpr_read_b32 v29, a17
    v_accvgpr_read_b32 v30, a18
    v_accvgpr_read_b32 v31, a19
    v_accvgpr_read_b32 v32, a20
    v_accvgpr_read_b32 v33, a21
    v_accvgpr_read_b32 v34, a22
    v_accvgpr_read_b32 v35, a23
    v_mul_f32 v28, v12, v28
    v_mul_f32 v29, v12, v29
    v_mul_f32 v30, v12, v30
    v_mul_f32 v31, v12, v31
    v_mul_f32 v32, v12, v32
    v_mul_f32 v33, v12, v33
    v_mul_f32 v34, v12, v34
    v_mul_f32 v35, v12, v35
    v_cvt_pk_bf16_f32 v28, v28, v29
    v_cvt_pk_bf16_f32 v29, v30, v31
    v_cvt_pk_bf16_f32 v30, v32, v33
    v_cvt_pk_bf16_f32 v31, v34, v35
    buffer_store_dwordx4 v[28:31], v44, s[16:19], s40 offen offset:1024
    v_accvgpr_read_b32 v36, a24
    v_accvgpr_read_b32 v37, a25
    v_accvgpr_read_b32 v38, a26
    v_accvgpr_read_b32 v39, a27
    v_accvgpr_read_b32 v40, a28
    v_accvgpr_read_b32 v41, a29
    v_accvgpr_read_b32 v42, a30
    v_accvgpr_read_b32 v43, a31
    v_mul_f32 v36, v12, v36
    v_mul_f32 v37, v12, v37
    v_mul_f32 v38, v12, v38
    v_mul_f32 v39, v12, v39
    v_mul_f32 v40, v12, v40
    v_mul_f32 v41, v12, v41
    v_mul_f32 v42, v12, v42
    v_mul_f32 v43, v12, v43
    v_cvt_pk_bf16_f32 v36, v36, v37
    v_cvt_pk_bf16_f32 v37, v38, v39
    v_cvt_pk_bf16_f32 v38, v40, v41
    v_cvt_pk_bf16_f32 v39, v42, v43
    buffer_store_dwordx4 v[36:39], v44, s[16:19], s40 offen offset:1536
    v_accvgpr_read_b32 v28, a32
    v_accvgpr_read_b32 v29, a33
    v_accvgpr_read_b32 v30, a34
    v_accvgpr_read_b32 v31, a35
    v_accvgpr_read_b32 v32, a36
    v_accvgpr_read_b32 v33, a37
    v_accvgpr_read_b32 v34, a38
    v_accvgpr_read_b32 v35, a39
    v_mul_f32 v28, v12, v28
    v_mul_f32 v29, v12, v29
    v_mul_f32 v30, v12, v30
    v_mul_f32 v31, v12, v31
    v_mul_f32 v32, v12, v32
    v_mul_f32 v33, v12, v33
    v_mul_f32 v34, v12, v34
    v_mul_f32 v35, v12, v35
    v_cvt_pk_bf16_f32 v28, v28, v29
    v_cvt_pk_bf16_f32 v29, v30, v31
    v_cvt_pk_bf16_f32 v30, v32, v33
    v_cvt_pk_bf16_f32 v31, v34, v35
    buffer_store_dwordx4 v[28:31], v44, s[16:19], s40 offen offset:2048
    v_accvgpr_read_b32 v36, a40
    v_accvgpr_read_b32 v37, a41
    v_accvgpr_read_b32 v38, a42
    v_accvgpr_read_b32 v39, a43
    v_accvgpr_read_b32 v40, a44
    v_accvgpr_read_b32 v41, a45
    v_accvgpr_read_b32 v42, a46
    v_accvgpr_read_b32 v43, a47
    v_mul_f32 v36, v12, v36
    v_mul_f32 v37, v12, v37
    v_mul_f32 v38, v12, v38
    v_mul_f32 v39, v12, v39
    v_mul_f32 v40, v12, v40
    v_mul_f32 v41, v12, v41
    v_mul_f32 v42, v12, v42
    v_mul_f32 v43, v12, v43
    v_cvt_pk_bf16_f32 v36, v36, v37
    v_cvt_pk_bf16_f32 v37, v38, v39
    v_cvt_pk_bf16_f32 v38, v40, v41
    v_cvt_pk_bf16_f32 v39, v42, v43
    buffer_store_dwordx4 v[36:39], v44, s[16:19], s40 offen offset:2560
    v_accvgpr_read_b32 v28, a48
    v_accvgpr_read_b32 v29, a49
    v_accvgpr_read_b32 v30, a50
    v_accvgpr_read_b32 v31, a51
    v_accvgpr_read_b32 v32, a52
    v_accvgpr_read_b32 v33, a53
    v_accvgpr_read_b32 v34, a54
    v_accvgpr_read_b32 v35, a55
    v_mul_f32 v28, v12, v28
    v_mul_f32 v29, v12, v29
    v_mul_f32 v30, v12, v30
    v_mul_f32 v31, v12, v31
    v_mul_f32 v32, v12, v32
    v_mul_f32 v33, v12, v33
    v_mul_f32 v34, v12, v34
    v_mul_f32 v35, v12, v35
    v_cvt_pk_bf16_f32 v28, v28, v29
    v_cvt_pk_bf16_f32 v29, v30, v31
    v_cvt_pk_bf16_f32 v30, v32, v33
    v_cvt_pk_bf16_f32 v31, v34, v35
    buffer_store_dwordx4 v[28:31], v44, s[16:19], s40 offen offset:3072
    v_accvgpr_read_b32 v36, a56
    v_accvgpr_read_b32 v37, a57
    v_accvgpr_read_b32 v38, a58
    v_accvgpr_read_b32 v39, a59
    v_accvgpr_read_b32 v40, a60
    v_accvgpr_read_b32 v41, a61
    v_accvgpr_read_b32 v42, a62
    v_accvgpr_read_b32 v43, a63
    v_mul_f32 v36, v12, v36
    v_mul_f32 v37, v12, v37
    v_mul_f32 v38, v12, v38
    v_mul_f32 v39, v12, v39
    v_mul_f32 v40, v12, v40
    v_mul_f32 v41, v12, v41
    v_mul_f32 v42, v12, v42
    v_mul_f32 v43, v12, v43
    v_cvt_pk_bf16_f32 v36, v36, v37
    v_cvt_pk_bf16_f32 v37, v38, v39
    v_cvt_pk_bf16_f32 v38, v40, v41
    v_cvt_pk_bf16_f32 v39, v42, v43
    buffer_store_dwordx4 v[36:39], v44, s[16:19], s40 offen offset:3584
    v_and_b32 v28, 15, v1
    v_lshrrev_b32 v29, 4, v1
    v_lshlrev_b32 v29, 2, v29
    v_sub_u32 v28, v28, v29
    v_cmp_ge_i32 vcc, -9, v28
    v_subrev_u32 v30, 0, v28
    v_cmp_ge_u32 s[36:37], 7, v30
    s_nop 0
    v_cndmask_b32 v64, v13, 0, vcc
    v_cndmask_b32 v68, v13, 0, s[36:37]
    v_cmp_ge_i32 vcc, -8, v28
    v_subrev_u32 v30, 1, v28
    v_cmp_ge_u32 s[36:37], 7, v30
    s_nop 0
    v_cndmask_b32 v65, v13, 0, vcc
    v_cndmask_b32 v69, v13, 0, s[36:37]
    v_cmp_ge_i32 vcc, -7, v28
    v_subrev_u32 v30, 2, v28
    v_cmp_ge_u32 s[36:37], 7, v30
    s_nop 0
    v_cndmask_b32 v66, v13, 0, vcc
    v_cndmask_b32 v70, v13, 0, s[36:37]
    v_cmp_ge_i32 vcc, -6, v28
    v_subrev_u32 v30, 3, v28
    v_cmp_ge_u32 s[36:37], 7, v30
    s_nop 0
    v_cndmask_b32 v67, v13, 0, vcc
    v_cndmask_b32 v71, v13, 0, s[36:37]
    s_cmp_eq_u32 s51, 0
    s_cselect_b64 vcc, -1, 0
    s_nop 0
    v_cndmask_b32 v72, v64, v13, vcc
    v_cndmask_b32 v73, v65, v13, vcc
    v_cndmask_b32 v74, v66, v13, vcc
    v_cndmask_b32 v75, v67, v13, vcc
    s_waitcnt vmcnt(8)
    s_nop 0
    v_mfma_f32_16x16x32_bf16 v[80:83], v[208:211], v[192:195], v[72:75]
    v_mfma_f32_16x16x32_bf16 v[84:87], v[212:215], v[192:195], v[68:71]
    v_mfma_f32_16x16x32_bf16 v[88:91], v[212:215], v[196:199], v[64:67]
    v_mfma_f32_16x16x32_bf16 v[92:95], v[216:219], v[196:199], v[68:71]
    v_mfma_f32_16x16x32_bf16 v[96:99], v[216:219], v[200:203], v[64:67]
    v_mfma_f32_16x16x32_bf16 v[100:103], v[220:223], v[200:203], v[68:71]
    v_mfma_f32_16x16x32_bf16 v[104:107], v[220:223], v[204:207], v[64:67]
    v_mfma_f32_16x16x32_bf16 v[108:111], v[224:227], v[204:207], v[68:71]
    s_nop 7
    v_max3_f32 v112, v80, v81, v82
    v_max3_f32 v113, v88, v89, v90
    v_max3_f32 v114, v96, v97, v98
    v_max3_f32 v115, v104, v105, v106
    v_max3_f32 v112, v112, v83, v84
    v_max3_f32 v113, v113, v91, v92
    v_max3_f32 v114, v114, v99, v100
    v_max3_f32 v115, v115, v107, v108
    v_max3_f32 v112, v112, v85, v86
    v_max3_f32 v113, v113, v93, v94
    v_max3_f32 v114, v114, v101, v102
    v_max3_f32 v115, v115, v109, v110
    v_max_f32 v112, v112, v87
    v_max_f32 v113, v113, v95
    v_max_f32 v114, v114, v103
    v_max_f32 v115, v115, v111
    v_mov_b32 v116, v112
    v_mov_b32 v117, v113
    v_mov_b32 v118, v114
    v_mov_b32 v119, v115
    s_nop 1
    v_permlane32_swap_b32 v112, v116
    v_permlane32_swap_b32 v113, v117
    v_permlane32_swap_b32 v114, v118
    v_permlane32_swap_b32 v115, v119
    s_nop 1
    v_max_f32 v112, v112, v116
    v_max_f32 v113, v113, v117
    v_max_f32 v114, v114, v118
    v_max_f32 v115, v115, v119
    v_mov_b32 v116, v112
    v_mov_b32 v117, v113
    v_mov_b32 v118, v114
    v_mov_b32 v119, v115
    s_nop 1
    v_permlane16_swap_b32 v112, v116
    v_permlane16_swap_b32 v113, v117
    v_permlane16_swap_b32 v114, v118
    v_permlane16_swap_b32 v115, v119
    s_nop 1
    v_max_f32 v112, v112, v116
    v_max_f32 v113, v113, v117
    v_max_f32 v114, v114, v118
    v_max_f32 v115, v115, v119
    v_sub_f32 v80, v80, v112
    v_sub_f32 v81, v81, v112
    v_sub_f32 v82, v82, v112
    v_sub_f32 v83, v83, v112
    v_sub_f32 v84, v84, v112
    v_sub_f32 v85, v85, v112
    v_sub_f32 v86, v86, v112
    v_sub_f32 v87, v87, v112
    v_sub_f32 v88, v88, v113
    v_sub_f32 v89, v89, v113
    v_sub_f32 v90, v90, v113
    v_sub_f32 v91, v91, v113
    v_sub_f32 v92, v92, v113
    v_sub_f32 v93, v93, v113
    v_sub_f32 v94, v94, v113
    v_sub_f32 v95, v95, v113
    v_sub_f32 v96, v96, v114
    v_sub_f32 v97, v97, v114
    v_sub_f32 v98, v98, v114
    v_sub_f32 v99, v99, v114
    v_sub_f32 v100, v100, v114
    v_sub_f32 v101, v101, v114
    v_sub_f32 v102, v102, v114
    v_sub_f32 v103, v103, v114
    v_sub_f32 v104, v104, v115
    v_sub_f32 v105, v105, v115
    v_sub_f32 v106, v106, v115
    v_sub_f32 v107, v107, v115
    v_sub_f32 v108, v108, v115
    v_sub_f32 v109, v109, v115
    v_sub_f32 v110, v110, v115
    v_sub_f32 v111, v111, v115
    v_exp_f32 v80, v80
    v_exp_f32 v81, v81
    v_exp_f32 v82, v82
    v_exp_f32 v83, v83
    v_exp_f32 v84, v84
    v_exp_f32 v85, v85
    v_exp_f32 v86, v86
    v_exp_f32 v87, v87
    v_exp_f32 v88, v88
    v_exp_f32 v89, v89
    v_exp_f32 v90, v90
    v_exp_f32 v91, v91
    v_exp_f32 v92, v92
    v_exp_f32 v93, v93
    v_exp_f32 v94, v94
    v_exp_f32 v95, v95
    v_exp_f32 v96, v96
    v_exp_f32 v97, v97
    v_exp_f32 v98, v98
    v_exp_f32 v99, v99
    v_exp_f32 v100, v100
    v_exp_f32 v101, v101
    v_exp_f32 v102, v102
    v_exp_f32 v103, v103
    v_exp_f32 v104, v104
    v_exp_f32 v105, v105
    v_exp_f32 v106, v106
    v_exp_f32 v107, v107
    v_exp_f32 v108, v108
    v_exp_f32 v109, v109
    v_exp_f32 v110, v110
    v_exp_f32 v111, v111
    v_cvt_pk_bf16_f32 v120, v80, v81
    v_cvt_pk_bf16_f32 v121, v82, v83
    v_cvt_pk_bf16_f32 v122, v84, v85
    v_cvt_pk_bf16_f32 v123, v86, v87
    v_cvt_pk_bf16_f32 v124, v88, v89
    v_cvt_pk_bf16_f32 v125, v90, v91
    v_cvt_pk_bf16_f32 v126, v92, v93
    v_cvt_pk_bf16_f32 v127, v94, v95
    v_cvt_pk_bf16_f32 v128, v96, v97
    v_cvt_pk_bf16_f32 v129, v98, v99
    v_cvt_pk_bf16_f32 v130, v100, v101
    v_cvt_pk_bf16_f32 v131, v102, v103
    v_cvt_pk_bf16_f32 v132, v104, v105
    v_cvt_pk_bf16_f32 v133, v106, v107
    v_cvt_pk_bf16_f32 v134, v108, v109
    v_cvt_pk_bf16_f32 v135, v110, v111
    v_add_f32 v112, v80, v81
    v_add_f32 v113, v88, v89
    v_add_f32 v114, v96, v97
    v_add_f32 v115, v104, v105
    v_mfma_f32_16x16x32_bf16 v[136:139], v[230:233], v[120:123], 0
    v_mfma_f32_16x16x32_bf16 v[140:143], v[242:245], v[120:123], 0
    v_mfma_f32_16x16x32_bf16 v[144:147], v[232:235], v[124:127], 0
    v_mfma_f32_16x16x32_bf16 v[148:151], v[244:247], v[124:127], 0
    v_mfma_f32_16x16x32_bf16 v[152:155], v[234:237], v[128:131], 0
    v_mfma_f32_16x16x32_bf16 v[156:159], v[246:249], v[128:131], 0
    v_mfma_f32_16x16x32_bf16 v[160:163], v[236:239], v[132:135], 0
    v_mfma_f32_16x16x32_bf16 v[164:167], v[248:251], v[132:135], 0
    v_add_f32 v112, v112, v82
    v_add_f32 v113, v113, v90
    v_add_f32 v114, v114, v98
    v_add_f32 v115, v115, v106
    v_add_f32 v112, v112, v83
    v_add_f32 v113, v113, v91
    v_add_f32 v114, v114, v99
    v_add_f32 v115, v115, v107
    v_add_f32 v112, v112, v84
    v_add_f32 v113, v113, v92
    v_add_f32 v114, v114, v100
    v_add_f32 v115, v115, v108
    v_add_f32 v112, v112, v85
    v_add_f32 v113, v113, v93
    v_add_f32 v114, v114, v101
    v_add_f32 v115, v115, v109
    v_add_f32 v112, v112, v86
    v_add_f32 v113, v113, v94
    v_add_f32 v114, v114, v102
    v_add_f32 v115, v115, v110
    v_add_f32 v112, v112, v87
    v_add_f32 v113, v113, v95
    v_add_f32 v114, v114, v103
    v_add_f32 v115, v115, v111
    v_mov_b32 v116, v112
    v_mov_b32 v117, v113
    v_mov_b32 v118, v114
    v_mov_b32 v119, v115
    s_nop 1
    v_permlane32_swap_b32 v112, v116
    v_permlane32_swap_b32 v113, v117
    v_permlane32_swap_b32 v114, v118
    v_permlane32_swap_b32 v115, v119
    s_nop 1
    v_add_f32 v112, v112, v116
    v_add_f32 v113, v113, v117
    v_add_f32 v114, v114, v118
    v_add_f32 v115, v115, v119
    v_mov_b32 v116, v112
    v_mov_b32 v117, v113
    v_mov_b32 v118, v114
    v_mov_b32 v119, v115
    s_nop 1
    v_permlane16_swap_b32 v112, v116
    v_permlane16_swap_b32 v113, v117
    v_permlane16_swap_b32 v114, v118
    v_permlane16_swap_b32 v115, v119
    s_nop 1
    v_add_f32 v112, v112, v116
    v_add_f32 v113, v113, v117
    v_add_f32 v114, v114, v118
    v_add_f32 v115, v115, v119
    v_rcp_f32 v112, v112
    v_rcp_f32 v113, v113
    v_rcp_f32 v114, v114
    v_rcp_f32 v115, v115
    s_lshl_b32 s40, s50, 15
    s_lshr_b32 s41, s2, 3
    s_lshl_b32 s41, s41, 10
    s_add_u32 s40, s40, s41
    s_add_u32 s40, s40, 83886080
    v_lshlrev_b32 v28, 4, v1
    v_mul_f32 v136, v136, v112
    v_mul_f32 v137, v137, v112
    v_mul_f32 v138, v138, v112
    v_mul_f32 v139, v139, v112
    v_mul_f32 v140, v140, v112
    v_mul_f32 v141, v141, v112
    v_mul_f32 v142, v142, v112
    v_mul_f32 v143, v143, v112
    v_cvt_pk_bf16_f32 v136, v136, v137
    v_cvt_pk_bf16_f32 v137, v138, v139
    v_cvt_pk_bf16_f32 v138, v140, v141
    v_cvt_pk_bf16_f32 v139, v142, v143
    buffer_store_dwordx4 v[136:139], v28, s[16:19], s40 offen
    s_add_u32 s40, s40, 32768
    v_mul_f32 v144, v144, v113
    v_mul_f32 v145, v145, v113
    v_mul_f32 v146, v146, v113
    v_mul_f32 v147, v147, v113
    v_mul_f32 v148, v148, v113
    v_mul_f32 v149, v149, v113
    v_mul_f32 v150, v150, v113
    v_mul_f32 v151, v151, v113
    v_cvt_pk_bf16_f32 v144, v144, v145
    v_cvt_pk_bf16_f32 v145, v146, v147
    v_cvt_pk_bf16_f32 v146, v148, v149
    v_cvt_pk_bf16_f32 v147, v150, v151
    buffer_store_dwordx4 v[144:147], v28, s[16:19], s40 offen
    s_add_u32 s40, s40, 32768
    v_mul_f32 v152, v152, v114
    v_mul_f32 v153, v153, v114
    v_mul_f32 v154, v154, v114
    v_mul_f32 v155, v155, v114
    v_mul_f32 v156, v156, v114
    v_mul_f32 v157, v157, v114
    v_mul_f32 v158, v158, v114
    v_mul_f32 v159, v159, v114
    v_cvt_pk_bf16_f32 v152, v152, v153
    v_cvt_pk_bf16_f32 v153, v154, v155
    v_cvt_pk_bf16_f32 v154, v156, v157
    v_cvt_pk_bf16_f32 v155, v158, v159
    buffer_store_dwordx4 v[152:155], v28, s[16:19], s40 offen
    s_add_u32 s40, s40, 32768
    v_mul_f32 v160, v160, v115
    v_mul_f32 v161, v161, v115
    v_mul_f32 v162, v162, v115
    v_mul_f32 v163, v163, v115
    v_mul_f32 v164, v164, v115
    v_mul_f32 v165, v165, v115
    v_mul_f32 v166, v166, v115
    v_mul_f32 v167, v167, v115
    v_cvt_pk_bf16_f32 v160, v160, v161
    v_cvt_pk_bf16_f32 v161, v162, v163
    v_cvt_pk_bf16_f32 v162, v164, v165
    v_cvt_pk_bf16_f32 v163, v166, v167
    buffer_store_dwordx4 v[160:163], v28, s[16:19], s40 offen
    s_add_u32 s40, s40, 32768
attn_kernel_end1:
    s_endpgm
attn_kernel_stub7:
    s_call_b64 s[34:35], attn_kernel_ev2
    s_branch attn_kernel_ret8
attn_kernel_stub9:
    s_call_b64 s[34:35], attn_kernel_ev2
    s_branch attn_kernel_ret10
attn_kernel_stub11:
    s_call_b64 s[34:35], attn_kernel_rs024
    s_branch attn_kernel_ret12
attn_kernel_stub14:
    s_call_b64 s[34:35], attn_kernel_ev2
    s_branch attn_kernel_ret15
attn_kernel_stub16:
    s_call_b64 s[34:35], attn_kernel_rs126
    s_branch attn_kernel_ret17
attn_kernel_stub18:
    s_call_b64 s[34:35], attn_kernel_ev2
    s_branch attn_kernel_ret19
attn_kernel_stub20:
    s_call_b64 s[34:35], attn_kernel_rs024
    s_branch attn_kernel_ret21
attn_kernel_stub22:
    s_call_b64 s[34:35], attn_kernel_ev2
    s_branch attn_kernel_ret23
attn_kernel_stub24:
    s_call_b64 s[34:35], attn_kernel_rs126
    s_branch attn_kernel_ret25
attn_kernel_stub26:
    s_call_b64 s[34:35], attn_kernel_ev2
    s_branch attn_kernel_ret27
attn_kernel_stub28:
    s_call_b64 s[34:35], attn_kernel_rs013
    s_branch attn_kernel_ret29
attn_kernel_stub31:
    s_call_b64 s[34:35], attn_kernel_ev2
    s_branch attn_kernel_ret32
attn_kernel_stub33:
    s_call_b64 s[34:35], attn_kernel_rs115
    s_branch attn_kernel_ret34
attn_kernel_stub35:
    s_call_b64 s[34:35], attn_kernel_ev2
    s_branch attn_kernel_ret36
attn_kernel_stub37:
    s_call_b64 s[34:35], attn_kernel_rs013
    s_branch attn_kernel_ret38
attn_kernel_stub39:
    s_call_b64 s[34:35], attn_kernel_rs115
    s_branch attn_kernel_ret40
attn_kernel_ev2:
attn_kernel_e41:
    s_cmp_lg_u32 s32, 0
    s_cbranch_scc1 attn_kernel_e42
    v_cmp_le_i32 vcc, 0, v15
    v_cmp_le_i32 s[36:37], 1, v15
    v_cmp_le_i32 s[38:39], 2, v15
    s_nop 1
    v_cndmask_b32 v176, v13, v176, vcc
    v_cndmask_b32 v177, v13, v177, s[36:37]
    v_cndmask_b32 v178, v13, v178, s[38:39]
    v_cmp_le_i32 vcc, 3, v15
    v_cmp_le_i32 s[36:37], 16, v15
    v_cmp_le_i32 s[38:39], 17, v15
    s_nop 1
    v_cndmask_b32 v179, v13, v179, vcc
    v_cndmask_b32 v180, v13, v180, s[36:37]
    v_cndmask_b32 v181, v13, v181, s[38:39]
    v_cmp_le_i32 vcc, 18, v15
    v_cmp_le_i32 s[36:37], 19, v15
    v_cmp_le_i32 s[38:39], 8, v15
    s_nop 1
    v_cndmask_b32 v182, v13, v182, vcc
    v_cndmask_b32 v183, v13, v183, s[36:37]
    v_cndmask_b32 v184, v13, v184, s[38:39]
    v_cmp_le_i32 vcc, 9, v15
    v_cmp_le_i32 s[36:37], 10, v15
    v_cmp_le_i32 s[38:39], 11, v15
    s_nop 1
    v_cndmask_b32 v185, v13, v185, vcc
    v_cndmask_b32 v186, v13, v186, s[36:37]
    v_cndmask_b32 v187, v13, v187, s[38:39]
    v_cmp_le_i32 vcc, 24, v15
    v_cmp_le_i32 s[36:37], 25, v15
    v_cmp_le_i32 s[38:39], 26, v15
    s_nop 1
    v_cndmask_b32 v188, v13, v188, vcc
    v_cndmask_b32 v189, v13, v189, s[36:37]
    v_cndmask_b32 v190, v13, v190, s[38:39]
    v_cmp_le_i32 vcc, 27, v15
    s_nop 1
    v_cndmask_b32 v191, v13, v191, vcc
    s_mov_b32 s31, 0
    s_mov_b32 s32, 1
    s_nop 1
    s_setpc_b64 s[34:35]
attn_kernel_e42:
    s_cmp_lg_u32 s32, 1
    s_cbranch_scc1 attn_kernel_e43
    v_mov_b32 v176, v13
    v_mov_b32 v177, v13
    v_mov_b32 v178, v13
    v_mov_b32 v179, v13
    v_mov_b32 v180, v13
    v_mov_b32 v181, v13
    v_mov_b32 v182, v13
    v_mov_b32 v183, v13
    v_mov_b32 v184, v13
    v_mov_b32 v185, v13
    v_mov_b32 v186, v13
    v_mov_b32 v187, v13
    v_mov_b32 v188, v13
    v_mov_b32 v189, v13
    v_mov_b32 v190, v13
    v_mov_b32 v191, v13
    s_lshl_b32 s31, s22, 3
    s_sub_u32 s31, 58, s31
    s_mov_b32 s32, 2
    s_nop 1
    s_setpc_b64 s[34:35]
attn_kernel_e43:
    s_cmp_lg_u32 s32, 2
    s_cbranch_scc1 attn_kernel_e44
    v_cmp_le_i32 vcc, 0, v15
    v_cmp_le_i32 s[36:37], 1, v15
    v_cmp_le_i32 s[38:39], 2, v15
    s_nop 1
    v_cndmask_b32 v160, v13, v160, vcc
    v_cndmask_b32 v161, v13, v161, s[36:37]
    v_cndmask_b32 v162, v13, v162, s[38:39]
    v_cmp_le_i32 vcc, 3, v15
    v_cmp_le_i32 s[36:37], 16, v15
    v_cmp_le_i32 s[38:39], 17, v15
    s_nop 1
    v_cndmask_b32 v163, v13, v163, vcc
    v_cndmask_b32 v164, v13, v164, s[36:37]
    v_cndmask_b32 v165, v13, v165, s[38:39]
    v_cmp_le_i32 vcc, 18, v15
    v_cmp_le_i32 s[36:37], 19, v15
    v_cmp_le_i32 s[38:39], 8, v15
    s_nop 1
    v_cndmask_b32 v166, v13, v166, vcc
    v_cndmask_b32 v167, v13, v167, s[36:37]
    v_cndmask_b32 v168, v13, v168, s[38:39]
    v_cmp_le_i32 vcc, 9, v15
    v_cmp_le_i32 s[36:37], 10, v15
    v_cmp_le_i32 s[38:39], 11, v15
    s_nop 1
    v_cndmask_b32 v169, v13, v169, vcc
    v_cndmask_b32 v170, v13, v170, s[36:37]
    v_cndmask_b32 v171, v13, v171, s[38:39]
    v_cmp_le_i32 vcc, 24, v15
    v_cmp_le_i32 s[36:37], 25, v15
    v_cmp_le_i32 s[38:39], 26, v15
    s_nop 1
    v_cndmask_b32 v172, v13, v172, vcc
    v_cndmask_b32 v173, v13, v173, s[36:37]
    v_cndmask_b32 v174, v13, v174, s[38:39]
    v_cmp_le_i32 vcc, 27, v15
    s_nop 1
    v_cndmask_b32 v175, v13, v175, vcc
    s_mov_b32 s31, 0
    s_mov_b32 s32, 3
    s_nop 1
    s_setpc_b64 s[34:35]
attn_kernel_e44:
    s_cmp_lg_u32 s32, 3
    s_cbranch_scc1 attn_kernel_e45
    v_mov_b32 v160, v13
    v_mov_b32 v161, v13
    v_mov_b32 v162, v13
    v_mov_b32 v163, v13
    v_mov_b32 v164, v13
    v_mov_b32 v165, v13
    v_mov_b32 v166, v13
    v_mov_b32 v167, v13
    v_mov_b32 v168, v13
    v_mov_b32 v169, v13
    v_mov_b32 v170, v13
    v_mov_b32 v171, v13
    v_mov_b32 v172, v13
    v_mov_b32 v173, v13
    v_mov_b32 v174, v13
    v_mov_b32 v175, v13
    s_mov_b32 s31, 1000
    s_mov_b32 s32, 4
    s_nop 1
    s_setpc_b64 s[34:35]
attn_kernel_e45:
    s_mov_b32 s31, 1000
    s_setpc_b64 s[34:35]
attn_kernel_rs013:
    s_nop 15
    v_max3_f32 v28, v64, v65, v66
    v_max3_f32 v28, v28, v67, v68
    v_max3_f32 v28, v28, v69, v70
    v_max3_f32 v28, v28, v71, v72
    v_max3_f32 v28, v28, v73, v74
    v_max3_f32 v28, v28, v75, v76
    v_max3_f32 v28, v28, v77, v78
    v_max3_f32 v28, v28, v79, v14
    v_mov_b32 v29, v28
    s_nop 1
    v_permlane32_swap_b32 v28, v29
    s_nop 1
    v_max_f32 v28, v28, v29
    v_max_f32 v29, 0, v28
    v_exp_f32 v29, -v29
    v_sub_f32 v64, v64, v28
    v_sub_f32 v65, v65, v28
    v_sub_f32 v66, v66, v28
    v_sub_f32 v67, v67, v28
    v_sub_f32 v68, v68, v28
    v_sub_f32 v69, v69, v28
    v_sub_f32 v70, v70, v28
    v_sub_f32 v71, v71, v28
    v_sub_f32 v72, v72, v28
    v_sub_f32 v73, v73, v28
    v_sub_f32 v74, v74, v28
    v_sub_f32 v75, v75, v28
    v_sub_f32 v76, v76, v28
    v_sub_f32 v77, v77, v28
    v_sub_f32 v78, v78, v28
    v_sub_f32 v79, v79, v28
    v_sub_f32 v96, v96, v28
    v_sub_f32 v97, v97, v28
    v_sub_f32 v98, v98, v28
    v_sub_f32 v99, v99, v28
    v_sub_f32 v100, v100, v28
    v_sub_f32 v101, v101, v28
    v_sub_f32 v102, v102, v28
    v_sub_f32 v103, v103, v28
    v_sub_f32 v104, v104, v28
    v_sub_f32 v105, v105, v28
    v_sub_f32 v106, v106, v28
    v_sub_f32 v107, v107, v28
    v_sub_f32 v108, v108, v28
    v_sub_f32 v109, v109, v28
    v_sub_f32 v110, v110, v28
    v_sub_f32 v111, v111, v28
    v_sub_f32 v160, v160, v28
    v_sub_f32 v161, v161, v28
    v_sub_f32 v162, v162, v28
    v_sub_f32 v163, v163, v28
    v_sub_f32 v164, v164, v28
    v_sub_f32 v165, v165, v28
    v_sub_f32 v166, v166, v28
    v_sub_f32 v167, v167, v28
    v_sub_f32 v168, v168, v28
    v_sub_f32 v169, v169, v28
    v_sub_f32 v170, v170, v28
    v_sub_f32 v171, v171, v28
    v_sub_f32 v172, v172, v28
    v_sub_f32 v173, v173, v28
    v_sub_f32 v174, v174, v28
    v_sub_f32 v175, v175, v28
    v_mul_f32 v8, v8, v29
    v_accvgpr_read_b32 v32, a0
    v_accvgpr_read_b32 v33, a1
    v_accvgpr_read_b32 v34, a2
    v_accvgpr_read_b32 v35, a3
    v_accvgpr_read_b32 v36, a4
    v_accvgpr_read_b32 v37, a5
    v_accvgpr_read_b32 v38, a6
    v_accvgpr_read_b32 v39, a7
    v_mul_f32 v32, v32, v29
    v_mul_f32 v33, v33, v29
    v_mul_f32 v34, v34, v29
    v_mul_f32 v35, v35, v29
    v_mul_f32 v36, v36, v29
    v_mul_f32 v37, v37, v29
    v_mul_f32 v38, v38, v29
    v_mul_f32 v39, v39, v29
    v_accvgpr_write_b32 a0, v32
    v_accvgpr_write_b32 a1, v33
    v_accvgpr_write_b32 a2, v34
    v_accvgpr_write_b32 a3, v35
    v_accvgpr_write_b32 a4, v36
    v_accvgpr_write_b32 a5, v37
    v_accvgpr_write_b32 a6, v38
    v_accvgpr_write_b32 a7, v39
    v_accvgpr_read_b32 v32, a8
    v_accvgpr_read_b32 v33, a9
    v_accvgpr_read_b32 v34, a10
    v_accvgpr_read_b32 v35, a11
    v_accvgpr_read_b32 v36, a12
    v_accvgpr_read_b32 v37, a13
    v_accvgpr_read_b32 v38, a14
    v_accvgpr_read_b32 v39, a15
    v_mul_f32 v32, v32, v29
    v_mul_f32 v33, v33, v29
    v_mul_f32 v34, v34, v29
    v_mul_f32 v35, v35, v29
    v_mul_f32 v36, v36, v29
    v_mul_f32 v37, v37, v29
    v_mul_f32 v38, v38, v29
    v_mul_f32 v39, v39, v29
    v_accvgpr_write_b32 a8, v32
    v_accvgpr_write_b32 a9, v33
    v_accvgpr_write_b32 a10, v34
    v_accvgpr_write_b32 a11, v35
    v_accvgpr_write_b32 a12, v36
    v_accvgpr_write_b32 a13, v37
    v_accvgpr_write_b32 a14, v38
    v_accvgpr_write_b32 a15, v39
    v_accvgpr_read_b32 v32, a16
    v_accvgpr_read_b32 v33, a17
    v_accvgpr_read_b32 v34, a18
    v_accvgpr_read_b32 v35, a19
    v_accvgpr_read_b32 v36, a20
    v_accvgpr_read_b32 v37, a21
    v_accvgpr_read_b32 v38, a22
    v_accvgpr_read_b32 v39, a23
    v_mul_f32 v32, v32, v29
    v_mul_f32 v33, v33, v29
    v_mul_f32 v34, v34, v29
    v_mul_f32 v35, v35, v29
    v_mul_f32 v36, v36, v29
    v_mul_f32 v37, v37, v29
    v_mul_f32 v38, v38, v29
    v_mul_f32 v39, v39, v29
    v_accvgpr_write_b32 a16, v32
    v_accvgpr_write_b32 a17, v33
    v_accvgpr_write_b32 a18, v34
    v_accvgpr_write_b32 a19, v35
    v_accvgpr_write_b32 a20, v36
    v_accvgpr_write_b32 a21, v37
    v_accvgpr_write_b32 a22, v38
    v_accvgpr_write_b32 a23, v39
    v_accvgpr_read_b32 v32, a24
    v_accvgpr_read_b32 v33, a25
    v_accvgpr_read_b32 v34, a26
    v_accvgpr_read_b32 v35, a27
    v_accvgpr_read_b32 v36, a28
    v_accvgpr_read_b32 v37, a29
    v_accvgpr_read_b32 v38, a30
    v_accvgpr_read_b32 v39, a31
    v_mul_f32 v32, v32, v29
    v_mul_f32 v33, v33, v29
    v_mul_f32 v34, v34, v29
    v_mul_f32 v35, v35, v29
    v_mul_f32 v36, v36, v29
    v_mul_f32 v37, v37, v29
    v_mul_f32 v38, v38, v29
    v_mul_f32 v39, v39, v29
    v_accvgpr_write_b32 a24, v32
    v_accvgpr_write_b32 a25, v33
    v_accvgpr_write_b32 a26, v34
    v_accvgpr_write_b32 a27, v35
    v_accvgpr_write_b32 a28, v36
    v_accvgpr_write_b32 a29, v37
    v_accvgpr_write_b32 a30, v38
    v_accvgpr_write_b32 a31, v39
    v_accvgpr_read_b32 v32, a32
    v_accvgpr_read_b32 v33, a33
    v_accvgpr_read_b32 v34, a34
    v_accvgpr_read_b32 v35, a35
    v_accvgpr_read_b32 v36, a36
    v_accvgpr_read_b32 v37, a37
    v_accvgpr_read_b32 v38, a38
    v_accvgpr_read_b32 v39, a39
    v_mul_f32 v32, v32, v29
    v_mul_f32 v33, v33, v29
    v_mul_f32 v34, v34, v29
    v_mul_f32 v35, v35, v29
    v_mul_f32 v36, v36, v29
    v_mul_f32 v37, v37, v29
    v_mul_f32 v38, v38, v29
    v_mul_f32 v39, v39, v29
    v_accvgpr_write_b32 a32, v32
    v_accvgpr_write_b32 a33, v33
    v_accvgpr_write_b32 a34, v34
    v_accvgpr_write_b32 a35, v35
    v_accvgpr_write_b32 a36, v36
    v_accvgpr_write_b32 a37, v37
    v_accvgpr_write_b32 a38, v38
    v_accvgpr_write_b32 a39, v39
    v_accvgpr_read_b32 v32, a40
    v_accvgpr_read_b32 v33, a41
    v_accvgpr_read_b32 v34, a42
    v_accvgpr_read_b32 v35, a43
    v_accvgpr_read_b32 v36, a44
    v_accvgpr_read_b32 v37, a45
    v_accvgpr_read_b32 v38, a46
    v_accvgpr_read_b32 v39, a47
    v_mul_f32 v32, v32, v29
    v_mul_f32 v33, v33, v29
    v_mul_f32 v34, v34, v29
    v_mul_f32 v35, v35, v29
    v_mul_f32 v36, v36, v29
    v_mul_f32 v37, v37, v29
    v_mul_f32 v38, v38, v29
    v_mul_f32 v39, v39, v29
    v_accvgpr_write_b32 a40, v32
    v_accvgpr_write_b32 a41, v33
    v_accvgpr_write_b32 a42, v34
    v_accvgpr_write_b32 a43, v35
    v_accvgpr_write_b32 a44, v36
    v_accvgpr_write_b32 a45, v37
    v_accvgpr_write_b32 a46, v38
    v_accvgpr_write_b32 a47, v39
    v_accvgpr_read_b32 v32, a48
    v_accvgpr_read_b32 v33, a49
    v_accvgpr_read_b32 v34, a50
    v_accvgpr_read_b32 v35, a51
    v_accvgpr_read_b32 v36, a52
    v_accvgpr_read_b32 v37, a53
    v_accvgpr_read_b32 v38, a54
    v_accvgpr_read_b32 v39, a55
    v_mul_f32 v32, v32, v29
    v_mul_f32 v33, v33, v29
    v_mul_f32 v34, v34, v29
    v_mul_f32 v35, v35, v29
    v_mul_f32 v36, v36, v29
    v_mul_f32 v37, v37, v29
    v_mul_f32 v38, v38, v29
    v_mul_f32 v39, v39, v29
    v_accvgpr_write_b32 a48, v32
    v_accvgpr_write_b32 a49, v33
    v_accvgpr_write_b32 a50, v34
    v_accvgpr_write_b32 a51, v35
    v_accvgpr_write_b32 a52, v36
    v_accvgpr_write_b32 a53, v37
    v_accvgpr_write_b32 a54, v38
    v_accvgpr_write_b32 a55, v39
    v_accvgpr_read_b32 v32, a56
    v_accvgpr_read_b32 v33, a57
    v_accvgpr_read_b32 v34, a58
    v_accvgpr_read_b32 v35, a59
    v_accvgpr_read_b32 v36, a60
    v_accvgpr_read_b32 v37, a61
    v_accvgpr_read_b32 v38, a62
    v_accvgpr_read_b32 v39, a63
    v_mul_f32 v32, v32, v29
    v_mul_f32 v33, v33, v29
    v_mul_f32 v34, v34, v29
    v_mul_f32 v35, v35, v29
    v_mul_f32 v36, v36, v29
    v_mul_f32 v37, v37, v29
    v_mul_f32 v38, v38, v29
    v_mul_f32 v39, v39, v29
    v_accvgpr_write_b32 a56, v32
    v_accvgpr_write_b32 a57, v33
    v_accvgpr_write_b32 a58, v34
    v_accvgpr_write_b32 a59, v35
    v_accvgpr_write_b32 a60, v36
    v_accvgpr_write_b32 a61, v37
    v_accvgpr_write_b32 a62, v38
    v_accvgpr_write_b32 a63, v39
    v_exp_f32 v32, v64
    v_exp_f32 v33, v65
    v_exp_f32 v34, v66
    v_exp_f32 v35, v67
    v_exp_f32 v36, v68
    v_exp_f32 v37, v69
    v_exp_f32 v38, v70
    v_exp_f32 v39, v71
    s_nop 0
    v_add_f32 v10, v32, v33
    v_add_f32 v10, v10, v34
    v_add_f32 v10, v10, v35
    v_add_f32 v10, v10, v36
    v_add_f32 v10, v10, v37
    v_add_f32 v10, v10, v38
    v_add_f32 v10, v10, v39
    v_cvt_pk_bf16_f32 v128, v32, v33
    v_cvt_pk_bf16_f32 v129, v34, v35
    v_cvt_pk_bf16_f32 v130, v36, v37
    v_cvt_pk_bf16_f32 v131, v38, v39
    v_exp_f32 v32, v72
    v_exp_f32 v33, v73
    v_exp_f32 v34, v74
    v_exp_f32 v35, v75
    v_exp_f32 v36, v76
    v_exp_f32 v37, v77
    v_exp_f32 v38, v78
    v_exp_f32 v39, v79
    s_nop 0
    v_add_f32 v10, v10, v32
    v_add_f32 v10, v10, v33
    v_add_f32 v10, v10, v34
    v_add_f32 v10, v10, v35
    v_add_f32 v10, v10, v36
    v_add_f32 v10, v10, v37
    v_add_f32 v10, v10, v38
    v_add_f32 v10, v10, v39
    v_cvt_pk_bf16_f32 v132, v32, v33
    v_cvt_pk_bf16_f32 v133, v34, v35
    v_cvt_pk_bf16_f32 v134, v36, v37
    v_cvt_pk_bf16_f32 v135, v38, v39
    s_nop 1
    s_setpc_b64 s[34:35]
attn_kernel_rs024:
    s_nop 15
    v_max3_f32 v28, v64, v65, v66
    v_max3_f32 v28, v28, v67, v68
    v_max3_f32 v28, v28, v69, v70
    v_max3_f32 v28, v28, v71, v72
    v_max3_f32 v28, v28, v73, v74
    v_max3_f32 v28, v28, v75, v76
    v_max3_f32 v28, v28, v77, v78
    v_max3_f32 v28, v28, v79, v14
    v_mov_b32 v29, v28
    s_nop 1
    v_permlane32_swap_b32 v28, v29
    s_nop 1
    v_max_f32 v28, v28, v29
    v_max_f32 v29, 0, v28
    v_exp_f32 v29, -v29
    v_sub_f32 v64, v64, v28
    v_sub_f32 v65, v65, v28
    v_sub_f32 v66, v66, v28
    v_sub_f32 v67, v67, v28
    v_sub_f32 v68, v68, v28
    v_sub_f32 v69, v69, v28
    v_sub_f32 v70, v70, v28
    v_sub_f32 v71, v71, v28
    v_sub_f32 v72, v72, v28
    v_sub_f32 v73, v73, v28
    v_sub_f32 v74, v74, v28
    v_sub_f32 v75, v75, v28
    v_sub_f32 v76, v76, v28
    v_sub_f32 v77, v77, v28
    v_sub_f32 v78, v78, v28
    v_sub_f32 v79, v79, v28
    v_sub_f32 v96, v96, v28
    v_sub_f32 v97, v97, v28
    v_sub_f32 v98, v98, v28
    v_sub_f32 v99, v99, v28
    v_sub_f32 v100, v100, v28
    v_sub_f32 v101, v101, v28
    v_sub_f32 v102, v102, v28
    v_sub_f32 v103, v103, v28
    v_sub_f32 v104, v104, v28
    v_sub_f32 v105, v105, v28
    v_sub_f32 v106, v106, v28
    v_sub_f32 v107, v107, v28
    v_sub_f32 v108, v108, v28
    v_sub_f32 v109, v109, v28
    v_sub_f32 v110, v110, v28
    v_sub_f32 v111, v111, v28
    v_sub_f32 v160, v160, v28
    v_sub_f32 v161, v161, v28
    v_sub_f32 v162, v162, v28
    v_sub_f32 v163, v163, v28
    v_sub_f32 v164, v164, v28
    v_sub_f32 v165, v165, v28
    v_sub_f32 v166, v166, v28
    v_sub_f32 v167, v167, v28
    v_sub_f32 v168, v168, v28
    v_sub_f32 v169, v169, v28
    v_sub_f32 v170, v170, v28
    v_sub_f32 v171, v171, v28
    v_sub_f32 v172, v172, v28
    v_sub_f32 v173, v173, v28
    v_sub_f32 v174, v174, v28
    v_sub_f32 v175, v175, v28
    v_mul_f32 v8, v8, v29
    v_accvgpr_read_b32 v32, a0
    v_accvgpr_read_b32 v33, a1
    v_accvgpr_read_b32 v34, a2
    v_accvgpr_read_b32 v35, a3
    v_accvgpr_read_b32 v36, a4
    v_accvgpr_read_b32 v37, a5
    v_accvgpr_read_b32 v38, a6
    v_accvgpr_read_b32 v39, a7
    v_mul_f32 v32, v32, v29
    v_mul_f32 v33, v33, v29
    v_mul_f32 v34, v34, v29
    v_mul_f32 v35, v35, v29
    v_mul_f32 v36, v36, v29
    v_mul_f32 v37, v37, v29
    v_mul_f32 v38, v38, v29
    v_mul_f32 v39, v39, v29
    v_accvgpr_write_b32 a0, v32
    v_accvgpr_write_b32 a1, v33
    v_accvgpr_write_b32 a2, v34
    v_accvgpr_write_b32 a3, v35
    v_accvgpr_write_b32 a4, v36
    v_accvgpr_write_b32 a5, v37
    v_accvgpr_write_b32 a6, v38
    v_accvgpr_write_b32 a7, v39
    v_accvgpr_read_b32 v32, a8
    v_accvgpr_read_b32 v33, a9
    v_accvgpr_read_b32 v34, a10
    v_accvgpr_read_b32 v35, a11
    v_accvgpr_read_b32 v36, a12
    v_accvgpr_read_b32 v37, a13
    v_accvgpr_read_b32 v38, a14
    v_accvgpr_read_b32 v39, a15
    v_mul_f32 v32, v32, v29
    v_mul_f32 v33, v33, v29
    v_mul_f32 v34, v34, v29
    v_mul_f32 v35, v35, v29
    v_mul_f32 v36, v36, v29
    v_mul_f32 v37, v37, v29
    v_mul_f32 v38, v38, v29
    v_mul_f32 v39, v39, v29
    v_accvgpr_write_b32 a8, v32
    v_accvgpr_write_b32 a9, v33
    v_accvgpr_write_b32 a10, v34
    v_accvgpr_write_b32 a11, v35
    v_accvgpr_write_b32 a12, v36
    v_accvgpr_write_b32 a13, v37
    v_accvgpr_write_b32 a14, v38
    v_accvgpr_write_b32 a15, v39
    v_accvgpr_read_b32 v32, a16
    v_accvgpr_read_b32 v33, a17
    v_accvgpr_read_b32 v34, a18
    v_accvgpr_read_b32 v35, a19
    v_accvgpr_read_b32 v36, a20
    v_accvgpr_read_b32 v37, a21
    v_accvgpr_read_b32 v38, a22
    v_accvgpr_read_b32 v39, a23
    v_mul_f32 v32, v32, v29
    v_mul_f32 v33, v33, v29
    v_mul_f32 v34, v34, v29
    v_mul_f32 v35, v35, v29
    v_mul_f32 v36, v36, v29
    v_mul_f32 v37, v37, v29
    v_mul_f32 v38, v38, v29
    v_mul_f32 v39, v39, v29
    v_accvgpr_write_b32 a16, v32
    v_accvgpr_write_b32 a17, v33
    v_accvgpr_write_b32 a18, v34
    v_accvgpr_write_b32 a19, v35
    v_accvgpr_write_b32 a20, v36
    v_accvgpr_write_b32 a21, v37
    v_accvgpr_write_b32 a22, v38
    v_accvgpr_write_b32 a23, v39
    v_accvgpr_read_b32 v32, a24
    v_accvgpr_read_b32 v33, a25
    v_accvgpr_read_b32 v34, a26
    v_accvgpr_read_b32 v35, a27
    v_accvgpr_read_b32 v36, a28
    v_accvgpr_read_b32 v37, a29
    v_accvgpr_read_b32 v38, a30
    v_accvgpr_read_b32 v39, a31
    v_mul_f32 v32, v32, v29
    v_mul_f32 v33, v33, v29
    v_mul_f32 v34, v34, v29
    v_mul_f32 v35, v35, v29
    v_mul_f32 v36, v36, v29
    v_mul_f32 v37, v37, v29
    v_mul_f32 v38, v38, v29
    v_mul_f32 v39, v39, v29
    v_accvgpr_write_b32 a24, v32
    v_accvgpr_write_b32 a25, v33
    v_accvgpr_write_b32 a26, v34
    v_accvgpr_write_b32 a27, v35
    v_accvgpr_write_b32 a28, v36
    v_accvgpr_write_b32 a29, v37
    v_accvgpr_write_b32 a30, v38
    v_accvgpr_write_b32 a31, v39
    v_accvgpr_read_b32 v32, a32
    v_accvgpr_read_b32 v33, a33
    v_accvgpr_read_b32 v34, a34
    v_accvgpr_read_b32 v35, a35
    v_accvgpr_read_b32 v36, a36
    v_accvgpr_read_b32 v37, a37
    v_accvgpr_read_b32 v38, a38
    v_accvgpr_read_b32 v39, a39
    v_mul_f32 v32, v32, v29
    v_mul_f32 v33, v33, v29
    v_mul_f32 v34, v34, v29
    v_mul_f32 v35, v35, v29
    v_mul_f32 v36, v36, v29
    v_mul_f32 v37, v37, v29
    v_mul_f32 v38, v38, v29
    v_mul_f32 v39, v39, v29
    v_accvgpr_write_b32 a32, v32
    v_accvgpr_write_b32 a33, v33
    v_accvgpr_write_b32 a34, v34
    v_accvgpr_write_b32 a35, v35
    v_accvgpr_write_b32 a36, v36
    v_accvgpr_write_b32 a37, v37
    v_accvgpr_write_b32 a38, v38
    v_accvgpr_write_b32 a39, v39
    v_accvgpr_read_b32 v32, a40
    v_accvgpr_read_b32 v33, a41
    v_accvgpr_read_b32 v34, a42
    v_accvgpr_read_b32 v35, a43
    v_accvgpr_read_b32 v36, a44
    v_accvgpr_read_b32 v37, a45
    v_accvgpr_read_b32 v38, a46
    v_accvgpr_read_b32 v39, a47
    v_mul_f32 v32, v32, v29
    v_mul_f32 v33, v33, v29
    v_mul_f32 v34, v34, v29
    v_mul_f32 v35, v35, v29
    v_mul_f32 v36, v36, v29
    v_mul_f32 v37, v37, v29
    v_mul_f32 v38, v38, v29
    v_mul_f32 v39, v39, v29
    v_accvgpr_write_b32 a40, v32
    v_accvgpr_write_b32 a41, v33
    v_accvgpr_write_b32 a42, v34
    v_accvgpr_write_b32 a43, v35
    v_accvgpr_write_b32 a44, v36
    v_accvgpr_write_b32 a45, v37
    v_accvgpr_write_b32 a46, v38
    v_accvgpr_write_b32 a47, v39
    v_accvgpr_read_b32 v32, a48
    v_accvgpr_read_b32 v33, a49
    v_accvgpr_read_b32 v34, a50
    v_accvgpr_read_b32 v35, a51
    v_accvgpr_read_b32 v36, a52
    v_accvgpr_read_b32 v37, a53
    v_accvgpr_read_b32 v38, a54
    v_accvgpr_read_b32 v39, a55
    v_mul_f32 v32, v32, v29
    v_mul_f32 v33, v33, v29
    v_mul_f32 v34, v34, v29
    v_mul_f32 v35, v35, v29
    v_mul_f32 v36, v36, v29
    v_mul_f32 v37, v37, v29
    v_mul_f32 v38, v38, v29
    v_mul_f32 v39, v39, v29
    v_accvgpr_write_b32 a48, v32
    v_accvgpr_write_b32 a49, v33
    v_accvgpr_write_b32 a50, v34
    v_accvgpr_write_b32 a51, v35
    v_accvgpr_write_b32 a52, v36
    v_accvgpr_write_b32 a53, v37
    v_accvgpr_write_b32 a54, v38
    v_accvgpr_write_b32 a55, v39
    v_accvgpr_read_b32 v32, a56
    v_accvgpr_read_b32 v33, a57
    v_accvgpr_read_b32 v34, a58
    v_accvgpr_read_b32 v35, a59
    v_accvgpr_read_b32 v36, a60
    v_accvgpr_read_b32 v37, a61
    v_accvgpr_read_b32 v38, a62
    v_accvgpr_read_b32 v39, a63
    v_mul_f32 v32, v32, v29
    v_mul_f32 v33, v33, v29
    v_mul_f32 v34, v34, v29
    v_mul_f32 v35, v35, v29
    v_mul_f32 v36, v36, v29
    v_mul_f32 v37, v37, v29
    v_mul_f32 v38, v38, v29
    v_mul_f32 v39, v39, v29
    v_accvgpr_write_b32 a56, v32
    v_accvgpr_write_b32 a57, v33
    v_accvgpr_write_b32 a58, v34
    v_accvgpr_write_b32 a59, v35
    v_accvgpr_write_b32 a60, v36
    v_accvgpr_write_b32 a61, v37
    v_accvgpr_write_b32 a62, v38
    v_accvgpr_write_b32 a63, v39
    v_exp_f32 v32, v64
    v_exp_f32 v33, v65
    v_exp_f32 v34, v66
    v_exp_f32 v35, v67
    v_exp_f32 v36, v68
    v_exp_f32 v37, v69
    v_exp_f32 v38, v70
    v_exp_f32 v39, v71
    s_nop 0
    v_add_f32 v10, v32, v33
    v_add_f32 v10, v10, v34
    v_add_f32 v10, v10, v35
    v_add_f32 v10, v10, v36
    v_add_f32 v10, v10, v37
    v_add_f32 v10, v10, v38
    v_add_f32 v10, v10, v39
    v_cvt_pk_bf16_f32 v128, v32, v33
    v_cvt_pk_bf16_f32 v129, v34, v35
    v_cvt_pk_bf16_f32 v130, v36, v37
    v_cvt_pk_bf16_f32 v131, v38, v39
    v_exp_f32 v32, v72
    v_exp_f32 v33, v73
    v_exp_f32 v34, v74
    v_exp_f32 v35, v75
    v_exp_f32 v36, v76
    v_exp_f32 v37, v77
    v_exp_f32 v38, v78
    v_exp_f32 v39, v79
    s_nop 0
    v_add_f32 v10, v10, v32
    v_add_f32 v10, v10, v33
    v_add_f32 v10, v10, v34
    v_add_f32 v10, v10, v35
    v_add_f32 v10, v10, v36
    v_add_f32 v10, v10, v37
    v_add_f32 v10, v10, v38
    v_add_f32 v10, v10, v39
    v_cvt_pk_bf16_f32 v132, v32, v33
    v_cvt_pk_bf16_f32 v133, v34, v35
    v_cvt_pk_bf16_f32 v134, v36, v37
    v_cvt_pk_bf16_f32 v135, v38, v39
    v_max3_f32 v28, v80, v81, v82
    v_max3_f32 v28, v28, v83, v84
    v_max3_f32 v28, v28, v85, v86
    v_max3_f32 v28, v28, v87, v88
    v_max3_f32 v28, v28, v89, v90
    v_max3_f32 v28, v28, v91, v92
    v_max3_f32 v28, v28, v93, v94
    v_max3_f32 v28, v28, v95, v14
    v_mov_b32 v29, v28
    s_nop 1
    v_permlane32_swap_b32 v28, v29
    s_nop 1
    v_max_f32 v28, v28, v29
    v_max_f32 v29, 0, v28
    v_exp_f32 v29, -v29
    v_sub_f32 v80, v80, v28
    v_sub_f32 v81, v81, v28
    v_sub_f32 v82, v82, v28
    v_sub_f32 v83, v83, v28
    v_sub_f32 v84, v84, v28
    v_sub_f32 v85, v85, v28
    v_sub_f32 v86, v86, v28
    v_sub_f32 v87, v87, v28
    v_sub_f32 v88, v88, v28
    v_sub_f32 v89, v89, v28
    v_sub_f32 v90, v90, v28
    v_sub_f32 v91, v91, v28
    v_sub_f32 v92, v92, v28
    v_sub_f32 v93, v93, v28
    v_sub_f32 v94, v94, v28
    v_sub_f32 v95, v95, v28
    v_sub_f32 v112, v112, v28
    v_sub_f32 v113, v113, v28
    v_sub_f32 v114, v114, v28
    v_sub_f32 v115, v115, v28
    v_sub_f32 v116, v116, v28
    v_sub_f32 v117, v117, v28
    v_sub_f32 v118, v118, v28
    v_sub_f32 v119, v119, v28
    v_sub_f32 v120, v120, v28
    v_sub_f32 v121, v121, v28
    v_sub_f32 v122, v122, v28
    v_sub_f32 v123, v123, v28
    v_sub_f32 v124, v124, v28
    v_sub_f32 v125, v125, v28
    v_sub_f32 v126, v126, v28
    v_sub_f32 v127, v127, v28
    v_sub_f32 v176, v176, v28
    v_sub_f32 v177, v177, v28
    v_sub_f32 v178, v178, v28
    v_sub_f32 v179, v179, v28
    v_sub_f32 v180, v180, v28
    v_sub_f32 v181, v181, v28
    v_sub_f32 v182, v182, v28
    v_sub_f32 v183, v183, v28
    v_sub_f32 v184, v184, v28
    v_sub_f32 v185, v185, v28
    v_sub_f32 v186, v186, v28
    v_sub_f32 v187, v187, v28
    v_sub_f32 v188, v188, v28
    v_sub_f32 v189, v189, v28
    v_sub_f32 v190, v190, v28
    v_sub_f32 v191, v191, v28
    v_mul_f32 v9, v9, v29
    v_accvgpr_read_b32 v32, a64
    v_accvgpr_read_b32 v33, a65
    v_accvgpr_read_b32 v34, a66
    v_accvgpr_read_b32 v35, a67
    v_accvgpr_read_b32 v36, a68
    v_accvgpr_read_b32 v37, a69
    v_accvgpr_read_b32 v38, a70
    v_accvgpr_read_b32 v39, a71
    v_mul_f32 v32, v32, v29
    v_mul_f32 v33, v33, v29
    v_mul_f32 v34, v34, v29
    v_mul_f32 v35, v35, v29
    v_mul_f32 v36, v36, v29
    v_mul_f32 v37, v37, v29
    v_mul_f32 v38, v38, v29
    v_mul_f32 v39, v39, v29
    v_accvgpr_write_b32 a64, v32
    v_accvgpr_write_b32 a65, v33
    v_accvgpr_write_b32 a66, v34
    v_accvgpr_write_b32 a67, v35
    v_accvgpr_write_b32 a68, v36
    v_accvgpr_write_b32 a69, v37
    v_accvgpr_write_b32 a70, v38
    v_accvgpr_write_b32 a71, v39
    v_accvgpr_read_b32 v32, a72
    v_accvgpr_read_b32 v33, a73
    v_accvgpr_read_b32 v34, a74
    v_accvgpr_read_b32 v35, a75
    v_accvgpr_read_b32 v36, a76
    v_accvgpr_read_b32 v37, a77
    v_accvgpr_read_b32 v38, a78
    v_accvgpr_read_b32 v39, a79
    v_mul_f32 v32, v32, v29
    v_mul_f32 v33, v33, v29
    v_mul_f32 v34, v34, v29
    v_mul_f32 v35, v35, v29
    v_mul_f32 v36, v36, v29
    v_mul_f32 v37, v37, v29
    v_mul_f32 v38, v38, v29
    v_mul_f32 v39, v39, v29
    v_accvgpr_write_b32 a72, v32
    v_accvgpr_write_b32 a73, v33
    v_accvgpr_write_b32 a74, v34
    v_accvgpr_write_b32 a75, v35
    v_accvgpr_write_b32 a76, v36
    v_accvgpr_write_b32 a77, v37
    v_accvgpr_write_b32 a78, v38
    v_accvgpr_write_b32 a79, v39
    v_accvgpr_read_b32 v32, a80
    v_accvgpr_read_b32 v33, a81
    v_accvgpr_read_b32 v34, a82
    v_accvgpr_read_b32 v35, a83
    v_accvgpr_read_b32 v36, a84
    v_accvgpr_read_b32 v37, a85
    v_accvgpr_read_b32 v38, a86
    v_accvgpr_read_b32 v39, a87
    v_mul_f32 v32, v32, v29
    v_mul_f32 v33, v33, v29
    v_mul_f32 v34, v34, v29
    v_mul_f32 v35, v35, v29
    v_mul_f32 v36, v36, v29
    v_mul_f32 v37, v37, v29
    v_mul_f32 v38, v38, v29
    v_mul_f32 v39, v39, v29
    v_accvgpr_write_b32 a80, v32
    v_accvgpr_write_b32 a81, v33
    v_accvgpr_write_b32 a82, v34
    v_accvgpr_write_b32 a83, v35
    v_accvgpr_write_b32 a84, v36
    v_accvgpr_write_b32 a85, v37
    v_accvgpr_write_b32 a86, v38
    v_accvgpr_write_b32 a87, v39
    v_accvgpr_read_b32 v32, a88
    v_accvgpr_read_b32 v33, a89
    v_accvgpr_read_b32 v34, a90
    v_accvgpr_read_b32 v35, a91
    v_accvgpr_read_b32 v36, a92
    v_accvgpr_read_b32 v37, a93
    v_accvgpr_read_b32 v38, a94
    v_accvgpr_read_b32 v39, a95
    v_mul_f32 v32, v32, v29
    v_mul_f32 v33, v33, v29
    v_mul_f32 v34, v34, v29
    v_mul_f32 v35, v35, v29
    v_mul_f32 v36, v36, v29
    v_mul_f32 v37, v37, v29
    v_mul_f32 v38, v38, v29
    v_mul_f32 v39, v39, v29
    v_accvgpr_write_b32 a88, v32
    v_accvgpr_write_b32 a89, v33
    v_accvgpr_write_b32 a90, v34
    v_accvgpr_write_b32 a91, v35
    v_accvgpr_write_b32 a92, v36
    v_accvgpr_write_b32 a93, v37
    v_accvgpr_write_b32 a94, v38
    v_accvgpr_write_b32 a95, v39
    v_accvgpr_read_b32 v32, a96
    v_accvgpr_read_b32 v33, a97
    v_accvgpr_read_b32 v34, a98
    v_accvgpr_read_b32 v35, a99
    v_accvgpr_read_b32 v36, a100
    v_accvgpr_read_b32 v37, a101
    v_accvgpr_read_b32 v38, a102
    v_accvgpr_read_b32 v39, a103
    v_mul_f32 v32, v32, v29
    v_mul_f32 v33, v33, v29
    v_mul_f32 v34, v34, v29
    v_mul_f32 v35, v35, v29
    v_mul_f32 v36, v36, v29
    v_mul_f32 v37, v37, v29
    v_mul_f32 v38, v38, v29
    v_mul_f32 v39, v39, v29
    v_accvgpr_write_b32 a96, v32
    v_accvgpr_write_b32 a97, v33
    v_accvgpr_write_b32 a98, v34
    v_accvgpr_write_b32 a99, v35
    v_accvgpr_write_b32 a100, v36
    v_accvgpr_write_b32 a101, v37
    v_accvgpr_write_b32 a102, v38
    v_accvgpr_write_b32 a103, v39
    v_accvgpr_read_b32 v32, a104
    v_accvgpr_read_b32 v33, a105
    v_accvgpr_read_b32 v34, a106
    v_accvgpr_read_b32 v35, a107
    v_accvgpr_read_b32 v36, a108
    v_accvgpr_read_b32 v37, a109
    v_accvgpr_read_b32 v38, a110
    v_accvgpr_read_b32 v39, a111
    v_mul_f32 v32, v32, v29
    v_mul_f32 v33, v33, v29
    v_mul_f32 v34, v34, v29
    v_mul_f32 v35, v35, v29
    v_mul_f32 v36, v36, v29
    v_mul_f32 v37, v37, v29
    v_mul_f32 v38, v38, v29
    v_mul_f32 v39, v39, v29
    v_accvgpr_write_b32 a104, v32
    v_accvgpr_write_b32 a105, v33
    v_accvgpr_write_b32 a106, v34
    v_accvgpr_write_b32 a107, v35
    v_accvgpr_write_b32 a108, v36
    v_accvgpr_write_b32 a109, v37
    v_accvgpr_write_b32 a110, v38
    v_accvgpr_write_b32 a111, v39
    v_accvgpr_read_b32 v32, a112
    v_accvgpr_read_b32 v33, a113
    v_accvgpr_read_b32 v34, a114
    v_accvgpr_read_b32 v35, a115
    v_accvgpr_read_b32 v36, a116
    v_accvgpr_read_b32 v37, a117
    v_accvgpr_read_b32 v38, a118
    v_accvgpr_read_b32 v39, a119
    v_mul_f32 v32, v32, v29
    v_mul_f32 v33, v33, v29
    v_mul_f32 v34, v34, v29
    v_mul_f32 v35, v35, v29
    v_mul_f32 v36, v36, v29
    v_mul_f32 v37, v37, v29
    v_mul_f32 v38, v38, v29
    v_mul_f32 v39, v39, v29
    v_accvgpr_write_b32 a112, v32
    v_accvgpr_write_b32 a113, v33
    v_accvgpr_write_b32 a114, v34
    v_accvgpr_write_b32 a115, v35
    v_accvgpr_write_b32 a116, v36
    v_accvgpr_write_b32 a117, v37
    v_accvgpr_write_b32 a118, v38
    v_accvgpr_write_b32 a119, v39
    v_accvgpr_read_b32 v32, a120
    v_accvgpr_read_b32 v33, a121
    v_accvgpr_read_b32 v34, a122
    v_accvgpr_read_b32 v35, a123
    v_accvgpr_read_b32 v36, a124
    v_accvgpr_read_b32 v37, a125
    v_accvgpr_read_b32 v38, a126
    v_accvgpr_read_b32 v39, a127
    v_mul_f32 v32, v32, v29
    v_mul_f32 v33, v33, v29
    v_mul_f32 v34, v34, v29
    v_mul_f32 v35, v35, v29
    v_mul_f32 v36, v36, v29
    v_mul_f32 v37, v37, v29
    v_mul_f32 v38, v38, v29
    v_mul_f32 v39, v39, v29
    v_accvgpr_write_b32 a120, v32
    v_accvgpr_write_b32 a121, v33
    v_accvgpr_write_b32 a122, v34
    v_accvgpr_write_b32 a123, v35
    v_accvgpr_write_b32 a124, v36
    v_accvgpr_write_b32 a125, v37
    v_accvgpr_write_b32 a126, v38
    v_accvgpr_write_b32 a127, v39
    v_exp_f32 v32, v80
    v_exp_f32 v33, v81
    v_exp_f32 v34, v82
    v_exp_f32 v35, v83
    v_exp_f32 v36, v84
    v_exp_f32 v37, v85
    v_exp_f32 v38, v86
    v_exp_f32 v39, v87
    s_nop 0
    v_add_f32 v11, v32, v33
    v_add_f32 v11, v11, v34
    v_add_f32 v11, v11, v35
    v_add_f32 v11, v11, v36
    v_add_f32 v11, v11, v37
    v_add_f32 v11, v11, v38
    v_add_f32 v11, v11, v39
    v_cvt_pk_bf16_f32 v136, v32, v33
    v_cvt_pk_bf16_f32 v137, v34, v35
    v_cvt_pk_bf16_f32 v138, v36, v37
    v_cvt_pk_bf16_f32 v139, v38, v39
    v_exp_f32 v32, v88
    v_exp_f32 v33, v89
    v_exp_f32 v34, v90
    v_exp_f32 v35, v91
    v_exp_f32 v36, v92
    v_exp_f32 v37, v93
    v_exp_f32 v38, v94
    v_exp_f32 v39, v95
    s_nop 0
    v_add_f32 v11, v11, v32
    v_add_f32 v11, v11, v33
    v_add_f32 v11, v11, v34
    v_add_f32 v11, v11, v35
    v_add_f32 v11, v11, v36
    v_add_f32 v11, v11, v37
    v_add_f32 v11, v11, v38
    v_add_f32 v11, v11, v39
    v_cvt_pk_bf16_f32 v140, v32, v33
    v_cvt_pk_bf16_f32 v141, v34, v35
    v_cvt_pk_bf16_f32 v142, v36, v37
    v_cvt_pk_bf16_f32 v143, v38, v39
    s_nop 1
    s_setpc_b64 s[34:35]
attn_kernel_rs115:
    s_nop 15
    v_max3_f32 v28, v96, v97, v98
    v_max3_f32 v28, v28, v99, v100
    v_max3_f32 v28, v28, v101, v102
    v_max3_f32 v28, v28, v103, v104
    v_max3_f32 v28, v28, v105, v106
    v_max3_f32 v28, v28, v107, v108
    v_max3_f32 v28, v28, v109, v110
    v_max3_f32 v28, v28, v111, v14
    v_mov_b32 v29, v28
    s_nop 1
    v_permlane32_swap_b32 v28, v29
    s_nop 1
    v_max_f32 v28, v28, v29
    v_max_f32 v29, 0, v28
    v_exp_f32 v29, -v29
    v_sub_f32 v96, v96, v28
    v_sub_f32 v97, v97, v28
    v_sub_f32 v98, v98, v28
    v_sub_f32 v99, v99, v28
    v_sub_f32 v100, v100, v28
    v_sub_f32 v101, v101, v28
    v_sub_f32 v102, v102, v28
    v_sub_f32 v103, v103, v28
    v_sub_f32 v104, v104, v28
    v_sub_f32 v105, v105, v28
    v_sub_f32 v106, v106, v28
    v_sub_f32 v107, v107, v28
    v_sub_f32 v108, v108, v28
    v_sub_f32 v109, v109, v28
    v_sub_f32 v110, v110, v28
    v_sub_f32 v111, v111, v28
    v_sub_f32 v64, v64, v28
    v_sub_f32 v65, v65, v28
    v_sub_f32 v66, v66, v28
    v_sub_f32 v67, v67, v28
    v_sub_f32 v68, v68, v28
    v_sub_f32 v69, v69, v28
    v_sub_f32 v70, v70, v28
    v_sub_f32 v71, v71, v28
    v_sub_f32 v72, v72, v28
    v_sub_f32 v73, v73, v28
    v_sub_f32 v74, v74, v28
    v_sub_f32 v75, v75, v28
    v_sub_f32 v76, v76, v28
    v_sub_f32 v77, v77, v28
    v_sub_f32 v78, v78, v28
    v_sub_f32 v79, v79, v28
    v_sub_f32 v160, v160, v28
    v_sub_f32 v161, v161, v28
    v_sub_f32 v162, v162, v28
    v_sub_f32 v163, v163, v28
    v_sub_f32 v164, v164, v28
    v_sub_f32 v165, v165, v28
    v_sub_f32 v166, v166, v28
    v_sub_f32 v167, v167, v28
    v_sub_f32 v168, v168, v28
    v_sub_f32 v169, v169, v28
    v_sub_f32 v170, v170, v28
    v_sub_f32 v171, v171, v28
    v_sub_f32 v172, v172, v28
    v_sub_f32 v173, v173, v28
    v_sub_f32 v174, v174, v28
    v_sub_f32 v175, v175, v28
    v_mul_f32 v8, v8, v29
    v_accvgpr_read_b32 v32, a0
    v_accvgpr_read_b32 v33, a1
    v_accvgpr_read_b32 v34, a2
    v_accvgpr_read_b32 v35, a3
    v_accvgpr_read_b32 v36, a4
    v_accvgpr_read_b32 v37, a5
    v_accvgpr_read_b32 v38, a6
    v_accvgpr_read_b32 v39, a7
    v_mul_f32 v32, v32, v29
    v_mul_f32 v33, v33, v29
    v_mul_f32 v34, v34, v29
    v_mul_f32 v35, v35, v29
    v_mul_f32 v36, v36, v29
    v_mul_f32 v37, v37, v29
    v_mul_f32 v38, v38, v29
    v_mul_f32 v39, v39, v29
    v_accvgpr_write_b32 a0, v32
    v_accvgpr_write_b32 a1, v33
    v_accvgpr_write_b32 a2, v34
    v_accvgpr_write_b32 a3, v35
    v_accvgpr_write_b32 a4, v36
    v_accvgpr_write_b32 a5, v37
    v_accvgpr_write_b32 a6, v38
    v_accvgpr_write_b32 a7, v39
    v_accvgpr_read_b32 v32, a8
    v_accvgpr_read_b32 v33, a9
    v_accvgpr_read_b32 v34, a10
    v_accvgpr_read_b32 v35, a11
    v_accvgpr_read_b32 v36, a12
    v_accvgpr_read_b32 v37, a13
    v_accvgpr_read_b32 v38, a14
    v_accvgpr_read_b32 v39, a15
    v_mul_f32 v32, v32, v29
    v_mul_f32 v33, v33, v29
    v_mul_f32 v34, v34, v29
    v_mul_f32 v35, v35, v29
    v_mul_f32 v36, v36, v29
    v_mul_f32 v37, v37, v29
    v_mul_f32 v38, v38, v29
    v_mul_f32 v39, v39, v29
    v_accvgpr_write_b32 a8, v32
    v_accvgpr_write_b32 a9, v33
    v_accvgpr_write_b32 a10, v34
    v_accvgpr_write_b32 a11, v35
    v_accvgpr_write_b32 a12, v36
    v_accvgpr_write_b32 a13, v37
    v_accvgpr_write_b32 a14, v38
    v_accvgpr_write_b32 a15, v39
    v_accvgpr_read_b32 v32, a16
    v_accvgpr_read_b32 v33, a17
    v_accvgpr_read_b32 v34, a18
    v_accvgpr_read_b32 v35, a19
    v_accvgpr_read_b32 v36, a20
    v_accvgpr_read_b32 v37, a21
    v_accvgpr_read_b32 v38, a22
    v_accvgpr_read_b32 v39, a23
    v_mul_f32 v32, v32, v29
    v_mul_f32 v33, v33, v29
    v_mul_f32 v34, v34, v29
    v_mul_f32 v35, v35, v29
    v_mul_f32 v36, v36, v29
    v_mul_f32 v37, v37, v29
    v_mul_f32 v38, v38, v29
    v_mul_f32 v39, v39, v29
    v_accvgpr_write_b32 a16, v32
    v_accvgpr_write_b32 a17, v33
    v_accvgpr_write_b32 a18, v34
    v_accvgpr_write_b32 a19, v35
    v_accvgpr_write_b32 a20, v36
    v_accvgpr_write_b32 a21, v37
    v_accvgpr_write_b32 a22, v38
    v_accvgpr_write_b32 a23, v39
    v_accvgpr_read_b32 v32, a24
    v_accvgpr_read_b32 v33, a25
    v_accvgpr_read_b32 v34, a26
    v_accvgpr_read_b32 v35, a27
    v_accvgpr_read_b32 v36, a28
    v_accvgpr_read_b32 v37, a29
    v_accvgpr_read_b32 v38, a30
    v_accvgpr_read_b32 v39, a31
    v_mul_f32 v32, v32, v29
    v_mul_f32 v33, v33, v29
    v_mul_f32 v34, v34, v29
    v_mul_f32 v35, v35, v29
    v_mul_f32 v36, v36, v29
    v_mul_f32 v37, v37, v29
    v_mul_f32 v38, v38, v29
    v_mul_f32 v39, v39, v29
    v_accvgpr_write_b32 a24, v32
    v_accvgpr_write_b32 a25, v33
    v_accvgpr_write_b32 a26, v34
    v_accvgpr_write_b32 a27, v35
    v_accvgpr_write_b32 a28, v36
    v_accvgpr_write_b32 a29, v37
    v_accvgpr_write_b32 a30, v38
    v_accvgpr_write_b32 a31, v39
    v_accvgpr_read_b32 v32, a32
    v_accvgpr_read_b32 v33, a33
    v_accvgpr_read_b32 v34, a34
    v_accvgpr_read_b32 v35, a35
    v_accvgpr_read_b32 v36, a36
    v_accvgpr_read_b32 v37, a37
    v_accvgpr_read_b32 v38, a38
    v_accvgpr_read_b32 v39, a39
    v_mul_f32 v32, v32, v29
    v_mul_f32 v33, v33, v29
    v_mul_f32 v34, v34, v29
    v_mul_f32 v35, v35, v29
    v_mul_f32 v36, v36, v29
    v_mul_f32 v37, v37, v29
    v_mul_f32 v38, v38, v29
    v_mul_f32 v39, v39, v29
    v_accvgpr_write_b32 a32, v32
    v_accvgpr_write_b32 a33, v33
    v_accvgpr_write_b32 a34, v34
    v_accvgpr_write_b32 a35, v35
    v_accvgpr_write_b32 a36, v36
    v_accvgpr_write_b32 a37, v37
    v_accvgpr_write_b32 a38, v38
    v_accvgpr_write_b32 a39, v39
    v_accvgpr_read_b32 v32, a40
    v_accvgpr_read_b32 v33, a41
    v_accvgpr_read_b32 v34, a42
    v_accvgpr_read_b32 v35, a43
    v_accvgpr_read_b32 v36, a44
    v_accvgpr_read_b32 v37, a45
    v_accvgpr_read_b32 v38, a46
    v_accvgpr_read_b32 v39, a47
    v_mul_f32 v32, v32, v29
    v_mul_f32 v33, v33, v29
    v_mul_f32 v34, v34, v29
    v_mul_f32 v35, v35, v29
    v_mul_f32 v36, v36, v29
    v_mul_f32 v37, v37, v29
    v_mul_f32 v38, v38, v29
    v_mul_f32 v39, v39, v29
    v_accvgpr_write_b32 a40, v32
    v_accvgpr_write_b32 a41, v33
    v_accvgpr_write_b32 a42, v34
    v_accvgpr_write_b32 a43, v35
    v_accvgpr_write_b32 a44, v36
    v_accvgpr_write_b32 a45, v37
    v_accvgpr_write_b32 a46, v38
    v_accvgpr_write_b32 a47, v39
    v_accvgpr_read_b32 v32, a48
    v_accvgpr_read_b32 v33, a49
    v_accvgpr_read_b32 v34, a50
    v_accvgpr_read_b32 v35, a51
    v_accvgpr_read_b32 v36, a52
    v_accvgpr_read_b32 v37, a53
    v_accvgpr_read_b32 v38, a54
    v_accvgpr_read_b32 v39, a55
    v_mul_f32 v32, v32, v29
    v_mul_f32 v33, v33, v29
    v_mul_f32 v34, v34, v29
    v_mul_f32 v35, v35, v29
    v_mul_f32 v36, v36, v29
    v_mul_f32 v37, v37, v29
    v_mul_f32 v38, v38, v29
    v_mul_f32 v39, v39, v29
    v_accvgpr_write_b32 a48, v32
    v_accvgpr_write_b32 a49, v33
    v_accvgpr_write_b32 a50, v34
    v_accvgpr_write_b32 a51, v35
    v_accvgpr_write_b32 a52, v36
    v_accvgpr_write_b32 a53, v37
    v_accvgpr_write_b32 a54, v38
    v_accvgpr_write_b32 a55, v39
    v_accvgpr_read_b32 v32, a56
    v_accvgpr_read_b32 v33, a57
    v_accvgpr_read_b32 v34, a58
    v_accvgpr_read_b32 v35, a59
    v_accvgpr_read_b32 v36, a60
    v_accvgpr_read_b32 v37, a61
    v_accvgpr_read_b32 v38, a62
    v_accvgpr_read_b32 v39, a63
    v_mul_f32 v32, v32, v29
    v_mul_f32 v33, v33, v29
    v_mul_f32 v34, v34, v29
    v_mul_f32 v35, v35, v29
    v_mul_f32 v36, v36, v29
    v_mul_f32 v37, v37, v29
    v_mul_f32 v38, v38, v29
    v_mul_f32 v39, v39, v29
    v_accvgpr_write_b32 a56, v32
    v_accvgpr_write_b32 a57, v33
    v_accvgpr_write_b32 a58, v34
    v_accvgpr_write_b32 a59, v35
    v_accvgpr_write_b32 a60, v36
    v_accvgpr_write_b32 a61, v37
    v_accvgpr_write_b32 a62, v38
    v_accvgpr_write_b32 a63, v39
    v_exp_f32 v32, v96
    v_exp_f32 v33, v97
    v_exp_f32 v34, v98
    v_exp_f32 v35, v99
    v_exp_f32 v36, v100
    v_exp_f32 v37, v101
    v_exp_f32 v38, v102
    v_exp_f32 v39, v103
    s_nop 0
    v_add_f32 v10, v32, v33
    v_add_f32 v10, v10, v34
    v_add_f32 v10, v10, v35
    v_add_f32 v10, v10, v36
    v_add_f32 v10, v10, v37
    v_add_f32 v10, v10, v38
    v_add_f32 v10, v10, v39
    v_cvt_pk_bf16_f32 v144, v32, v33
    v_cvt_pk_bf16_f32 v145, v34, v35
    v_cvt_pk_bf16_f32 v146, v36, v37
    v_cvt_pk_bf16_f32 v147, v38, v39
    v_exp_f32 v32, v104
    v_exp_f32 v33, v105
    v_exp_f32 v34, v106
    v_exp_f32 v35, v107
    v_exp_f32 v36, v108
    v_exp_f32 v37, v109
    v_exp_f32 v38, v110
    v_exp_f32 v39, v111
    s_nop 0
    v_add_f32 v10, v10, v32
    v_add_f32 v10, v10, v33
    v_add_f32 v10, v10, v34
    v_add_f32 v10, v10, v35
    v_add_f32 v10, v10, v36
    v_add_f32 v10, v10, v37
    v_add_f32 v10, v10, v38
    v_add_f32 v10, v10, v39
    v_cvt_pk_bf16_f32 v148, v32, v33
    v_cvt_pk_bf16_f32 v149, v34, v35
    v_cvt_pk_bf16_f32 v150, v36, v37
    v_cvt_pk_bf16_f32 v151, v38, v39
    s_nop 1
    s_setpc_b64 s[34:35]
attn_kernel_rs126:
    s_nop 15
    v_max3_f32 v28, v96, v97, v98
    v_max3_f32 v28, v28, v99, v100
    v_max3_f32 v28, v28, v101, v102
    v_max3_f32 v28, v28, v103, v104
    v_max3_f32 v28, v28, v105, v106
    v_max3_f32 v28, v28, v107, v108
    v_max3_f32 v28, v28, v109, v110
    v_max3_f32 v28, v28, v111, v14
    v_mov_b32 v29, v28
    s_nop 1
    v_permlane32_swap_b32 v28, v29
    s_nop 1
    v_max_f32 v28, v28, v29
    v_max_f32 v29, 0, v28
    v_exp_f32 v29, -v29
    v_sub_f32 v96, v96, v28
    v_sub_f32 v97, v97, v28
    v_sub_f32 v98, v98, v28
    v_sub_f32 v99, v99, v28
    v_sub_f32 v100, v100, v28
    v_sub_f32 v101, v101, v28
    v_sub_f32 v102, v102, v28
    v_sub_f32 v103, v103, v28
    v_sub_f32 v104, v104, v28
    v_sub_f32 v105, v105, v28
    v_sub_f32 v106, v106, v28
    v_sub_f32 v107, v107, v28
    v_sub_f32 v108, v108, v28
    v_sub_f32 v109, v109, v28
    v_sub_f32 v110, v110, v28
    v_sub_f32 v111, v111, v28
    v_sub_f32 v64, v64, v28
    v_sub_f32 v65, v65, v28
    v_sub_f32 v66, v66, v28
    v_sub_f32 v67, v67, v28
    v_sub_f32 v68, v68, v28
    v_sub_f32 v69, v69, v28
    v_sub_f32 v70, v70, v28
    v_sub_f32 v71, v71, v28
    v_sub_f32 v72, v72, v28
    v_sub_f32 v73, v73, v28
    v_sub_f32 v74, v74, v28
    v_sub_f32 v75, v75, v28
    v_sub_f32 v76, v76, v28
    v_sub_f32 v77, v77, v28
    v_sub_f32 v78, v78, v28
    v_sub_f32 v79, v79, v28
    v_sub_f32 v160, v160, v28
    v_sub_f32 v161, v161, v28
    v_sub_f32 v162, v162, v28
    v_sub_f32 v163, v163, v28
    v_sub_f32 v164, v164, v28
    v_sub_f32 v165, v165, v28
    v_sub_f32 v166, v166, v28
    v_sub_f32 v167, v167, v28
    v_sub_f32 v168, v168, v28
    v_sub_f32 v169, v169, v28
    v_sub_f32 v170, v170, v28
    v_sub_f32 v171, v171, v28
    v_sub_f32 v172, v172, v28
    v_sub_f32 v173, v173, v28
    v_sub_f32 v174, v174, v28
    v_sub_f32 v175, v175, v28
    v_mul_f32 v8, v8, v29
    v_accvgpr_read_b32 v32, a0
    v_accvgpr_read_b32 v33, a1
    v_accvgpr_read_b32 v34, a2
    v_accvgpr_read_b32 v35, a3
    v_accvgpr_read_b32 v36, a4
    v_accvgpr_read_b32 v37, a5
    v_accvgpr_read_b32 v38, a6
    v_accvgpr_read_b32 v39, a7
    v_mul_f32 v32, v32, v29
    v_mul_f32 v33, v33, v29
    v_mul_f32 v34, v34, v29
    v_mul_f32 v35, v35, v29
    v_mul_f32 v36, v36, v29
    v_mul_f32 v37, v37, v29
    v_mul_f32 v38, v38, v29
    v_mul_f32 v39, v39, v29
    v_accvgpr_write_b32 a0, v32
    v_accvgpr_write_b32 a1, v33
    v_accvgpr_write_b32 a2, v34
    v_accvgpr_write_b32 a3, v35
    v_accvgpr_write_b32 a4, v36
    v_accvgpr_write_b32 a5, v37
    v_accvgpr_write_b32 a6, v38
    v_accvgpr_write_b32 a7, v39
    v_accvgpr_read_b32 v32, a8
    v_accvgpr_read_b32 v33, a9
    v_accvgpr_read_b32 v34, a10
    v_accvgpr_read_b32 v35, a11
    v_accvgpr_read_b32 v36, a12
    v_accvgpr_read_b32 v37, a13
    v_accvgpr_read_b32 v38, a14
    v_accvgpr_read_b32 v39, a15
    v_mul_f32 v32, v32, v29
    v_mul_f32 v33, v33, v29
    v_mul_f32 v34, v34, v29
    v_mul_f32 v35, v35, v29
    v_mul_f32 v36, v36, v29
    v_mul_f32 v37, v37, v29
    v_mul_f32 v38, v38, v29
    v_mul_f32 v39, v39, v29
    v_accvgpr_write_b32 a8, v32
    v_accvgpr_write_b32 a9, v33
    v_accvgpr_write_b32 a10, v34
    v_accvgpr_write_b32 a11, v35
    v_accvgpr_write_b32 a12, v36
    v_accvgpr_write_b32 a13, v37
    v_accvgpr_write_b32 a14, v38
    v_accvgpr_write_b32 a15, v39
    v_accvgpr_read_b32 v32, a16
    v_accvgpr_read_b32 v33, a17
    v_accvgpr_read_b32 v34, a18
    v_accvgpr_read_b32 v35, a19
    v_accvgpr_read_b32 v36, a20
    v_accvgpr_read_b32 v37, a21
    v_accvgpr_read_b32 v38, a22
    v_accvgpr_read_b32 v39, a23
    v_mul_f32 v32, v32, v29
    v_mul_f32 v33, v33, v29
    v_mul_f32 v34, v34, v29
    v_mul_f32 v35, v35, v29
    v_mul_f32 v36, v36, v29
    v_mul_f32 v37, v37, v29
    v_mul_f32 v38, v38, v29
    v_mul_f32 v39, v39, v29
    v_accvgpr_write_b32 a16, v32
    v_accvgpr_write_b32 a17, v33
    v_accvgpr_write_b32 a18, v34
    v_accvgpr_write_b32 a19, v35
    v_accvgpr_write_b32 a20, v36
    v_accvgpr_write_b32 a21, v37
    v_accvgpr_write_b32 a22, v38
    v_accvgpr_write_b32 a23, v39
    v_accvgpr_read_b32 v32, a24
    v_accvgpr_read_b32 v33, a25
    v_accvgpr_read_b32 v34, a26
    v_accvgpr_read_b32 v35, a27
    v_accvgpr_read_b32 v36, a28
    v_accvgpr_read_b32 v37, a29
    v_accvgpr_read_b32 v38, a30
    v_accvgpr_read_b32 v39, a31
    v_mul_f32 v32, v32, v29
    v_mul_f32 v33, v33, v29
    v_mul_f32 v34, v34, v29
    v_mul_f32 v35, v35, v29
    v_mul_f32 v36, v36, v29
    v_mul_f32 v37, v37, v29
    v_mul_f32 v38, v38, v29
    v_mul_f32 v39, v39, v29
    v_accvgpr_write_b32 a24, v32
    v_accvgpr_write_b32 a25, v33
    v_accvgpr_write_b32 a26, v34
    v_accvgpr_write_b32 a27, v35
    v_accvgpr_write_b32 a28, v36
    v_accvgpr_write_b32 a29, v37
    v_accvgpr_write_b32 a30, v38
    v_accvgpr_write_b32 a31, v39
    v_accvgpr_read_b32 v32, a32
    v_accvgpr_read_b32 v33, a33
    v_accvgpr_read_b32 v34, a34
    v_accvgpr_read_b32 v35, a35
    v_accvgpr_read_b32 v36, a36
    v_accvgpr_read_b32 v37, a37
    v_accvgpr_read_b32 v38, a38
    v_accvgpr_read_b32 v39, a39
    v_mul_f32 v32, v32, v29
    v_mul_f32 v33, v33, v29
    v_mul_f32 v34, v34, v29
    v_mul_f32 v35, v35, v29
    v_mul_f32 v36, v36, v29
    v_mul_f32 v37, v37, v29
    v_mul_f32 v38, v38, v29
    v_mul_f32 v39, v39, v29
    v_accvgpr_write_b32 a32, v32
    v_accvgpr_write_b32 a33, v33
    v_accvgpr_write_b32 a34, v34
    v_accvgpr_write_b32 a35, v35
    v_accvgpr_write_b32 a36, v36
    v_accvgpr_write_b32 a37, v37
    v_accvgpr_write_b32 a38, v38
    v_accvgpr_write_b32 a39, v39
    v_accvgpr_read_b32 v32, a40
    v_accvgpr_read_b32 v33, a41
    v_accvgpr_read_b32 v34, a42
    v_accvgpr_read_b32 v35, a43
    v_accvgpr_read_b32 v36, a44
    v_accvgpr_read_b32 v37, a45
    v_accvgpr_read_b32 v38, a46
    v_accvgpr_read_b32 v39, a47
    v_mul_f32 v32, v32, v29
    v_mul_f32 v33, v33, v29
    v_mul_f32 v34, v34, v29
    v_mul_f32 v35, v35, v29
    v_mul_f32 v36, v36, v29
    v_mul_f32 v37, v37, v29
    v_mul_f32 v38, v38, v29
    v_mul_f32 v39, v39, v29
    v_accvgpr_write_b32 a40, v32
    v_accvgpr_write_b32 a41, v33
    v_accvgpr_write_b32 a42, v34
    v_accvgpr_write_b32 a43, v35
    v_accvgpr_write_b32 a44, v36
    v_accvgpr_write_b32 a45, v37
    v_accvgpr_write_b32 a46, v38
    v_accvgpr_write_b32 a47, v39
    v_accvgpr_read_b32 v32, a48
    v_accvgpr_read_b32 v33, a49
    v_accvgpr_read_b32 v34, a50
    v_accvgpr_read_b32 v35, a51
    v_accvgpr_read_b32 v36, a52
    v_accvgpr_read_b32 v37, a53
    v_accvgpr_read_b32 v38, a54
    v_accvgpr_read_b32 v39, a55
    v_mul_f32 v32, v32, v29
    v_mul_f32 v33, v33, v29
    v_mul_f32 v34, v34, v29
    v_mul_f32 v35, v35, v29
    v_mul_f32 v36, v36, v29
    v_mul_f32 v37, v37, v29
    v_mul_f32 v38, v38, v29
    v_mul_f32 v39, v39, v29
    v_accvgpr_write_b32 a48, v32
    v_accvgpr_write_b32 a49, v33
    v_accvgpr_write_b32 a50, v34
    v_accvgpr_write_b32 a51, v35
    v_accvgpr_write_b32 a52, v36
    v_accvgpr_write_b32 a53, v37
    v_accvgpr_write_b32 a54, v38
    v_accvgpr_write_b32 a55, v39
    v_accvgpr_read_b32 v32, a56
    v_accvgpr_read_b32 v33, a57
    v_accvgpr_read_b32 v34, a58
    v_accvgpr_read_b32 v35, a59
    v_accvgpr_read_b32 v36, a60
    v_accvgpr_read_b32 v37, a61
    v_accvgpr_read_b32 v38, a62
    v_accvgpr_read_b32 v39, a63
    v_mul_f32 v32, v32, v29
    v_mul_f32 v33, v33, v29
    v_mul_f32 v34, v34, v29
    v_mul_f32 v35, v35, v29
    v_mul_f32 v36, v36, v29
    v_mul_f32 v37, v37, v29
    v_mul_f32 v38, v38, v29
    v_mul_f32 v39, v39, v29
    v_accvgpr_write_b32 a56, v32
    v_accvgpr_write_b32 a57, v33
    v_accvgpr_write_b32 a58, v34
    v_accvgpr_write_b32 a59, v35
    v_accvgpr_write_b32 a60, v36
    v_accvgpr_write_b32 a61, v37
    v_accvgpr_write_b32 a62, v38
    v_accvgpr_write_b32 a63, v39
    v_exp_f32 v32, v96
    v_exp_f32 v33, v97
    v_exp_f32 v34, v98
    v_exp_f32 v35, v99
    v_exp_f32 v36, v100
    v_exp_f32 v37, v101
    v_exp_f32 v38, v102
    v_exp_f32 v39, v103
    s_nop 0
    v_add_f32 v10, v32, v33
    v_add_f32 v10, v10, v34
    v_add_f32 v10, v10, v35
    v_add_f32 v10, v10, v36
    v_add_f32 v10, v10, v37
    v_add_f32 v10, v10, v38
    v_add_f32 v10, v10, v39
    v_cvt_pk_bf16_f32 v144, v32, v33
    v_cvt_pk_bf16_f32 v145, v34, v35
    v_cvt_pk_bf16_f32 v146, v36, v37
    v_cvt_pk_bf16_f32 v147, v38, v39
    v_exp_f32 v32, v104
    v_exp_f32 v33, v105
    v_exp_f32 v34, v106
    v_exp_f32 v35, v107
    v_exp_f32 v36, v108
    v_exp_f32 v37, v109
    v_exp_f32 v38, v110
    v_exp_f32 v39, v111
    s_nop 0
    v_add_f32 v10, v10, v32
    v_add_f32 v10, v10, v33
    v_add_f32 v10, v10, v34
    v_add_f32 v10, v10, v35
    v_add_f32 v10, v10, v36
    v_add_f32 v10, v10, v37
    v_add_f32 v10, v10, v38
    v_add_f32 v10, v10, v39
    v_cvt_pk_bf16_f32 v148, v32, v33
    v_cvt_pk_bf16_f32 v149, v34, v35
    v_cvt_pk_bf16_f32 v150, v36, v37
    v_cvt_pk_bf16_f32 v151, v38, v39
    v_max3_f32 v28, v112, v113, v114
    v_max3_f32 v28, v28, v115, v116
    v_max3_f32 v28, v28, v117, v118
    v_max3_f32 v28, v28, v119, v120
    v_max3_f32 v28, v28, v121, v122
    v_max3_f32 v28, v28, v123, v124
    v_max3_f32 v28, v28, v125, v126
    v_max3_f32 v28, v28, v127, v14
    v_mov_b32 v29, v28
    s_nop 1
    v_permlane32_swap_b32 v28, v29
    s_nop 1
    v_max_f32 v28, v28, v29
    v_max_f32 v29, 0, v28
    v_exp_f32 v29, -v29
    v_sub_f32 v112, v112, v28
    v_sub_f32 v113, v113, v28
    v_sub_f32 v114, v114, v28
    v_sub_f32 v115, v115, v28
    v_sub_f32 v116, v116, v28
    v_sub_f32 v117, v117, v28
    v_sub_f32 v118, v118, v28
    v_sub_f32 v119, v119, v28
    v_sub_f32 v120, v120, v28
    v_sub_f32 v121, v121, v28
    v_sub_f32 v122, v122, v28
    v_sub_f32 v123, v123, v28
    v_sub_f32 v124, v124, v28
    v_sub_f32 v125, v125, v28
    v_sub_f32 v126, v126, v28
    v_sub_f32 v127, v127, v28
    v_sub_f32 v80, v80, v28
    v_sub_f32 v81, v81, v28
    v_sub_f32 v82, v82, v28
    v_sub_f32 v83, v83, v28
    v_sub_f32 v84, v84, v28
    v_sub_f32 v85, v85, v28
    v_sub_f32 v86, v86, v28
    v_sub_f32 v87, v87, v28
    v_sub_f32 v88, v88, v28
    v_sub_f32 v89, v89, v28
    v_sub_f32 v90, v90, v28
    v_sub_f32 v91, v91, v28
    v_sub_f32 v92, v92, v28
    v_sub_f32 v93, v93, v28
    v_sub_f32 v94, v94, v28
    v_sub_f32 v95, v95, v28
    v_sub_f32 v176, v176, v28
    v_sub_f32 v177, v177, v28
    v_sub_f32 v178, v178, v28
    v_sub_f32 v179, v179, v28
    v_sub_f32 v180, v180, v28
    v_sub_f32 v181, v181, v28
    v_sub_f32 v182, v182, v28
    v_sub_f32 v183, v183, v28
    v_sub_f32 v184, v184, v28
    v_sub_f32 v185, v185, v28
    v_sub_f32 v186, v186, v28
    v_sub_f32 v187, v187, v28
    v_sub_f32 v188, v188, v28
    v_sub_f32 v189, v189, v28
    v_sub_f32 v190, v190, v28
    v_sub_f32 v191, v191, v28
    v_mul_f32 v9, v9, v29
    v_accvgpr_read_b32 v32, a64
    v_accvgpr_read_b32 v33, a65
    v_accvgpr_read_b32 v34, a66
    v_accvgpr_read_b32 v35, a67
    v_accvgpr_read_b32 v36, a68
    v_accvgpr_read_b32 v37, a69
    v_accvgpr_read_b32 v38, a70
    v_accvgpr_read_b32 v39, a71
    v_mul_f32 v32, v32, v29
    v_mul_f32 v33, v33, v29
    v_mul_f32 v34, v34, v29
    v_mul_f32 v35, v35, v29
    v_mul_f32 v36, v36, v29
    v_mul_f32 v37, v37, v29
    v_mul_f32 v38, v38, v29
    v_mul_f32 v39, v39, v29
    v_accvgpr_write_b32 a64, v32
    v_accvgpr_write_b32 a65, v33
    v_accvgpr_write_b32 a66, v34
    v_accvgpr_write_b32 a67, v35
    v_accvgpr_write_b32 a68, v36
    v_accvgpr_write_b32 a69, v37
    v_accvgpr_write_b32 a70, v38
    v_accvgpr_write_b32 a71, v39
    v_accvgpr_read_b32 v32, a72
    v_accvgpr_read_b32 v33, a73
    v_accvgpr_read_b32 v34, a74
    v_accvgpr_read_b32 v35, a75
    v_accvgpr_read_b32 v36, a76
    v_accvgpr_read_b32 v37, a77
    v_accvgpr_read_b32 v38, a78
    v_accvgpr_read_b32 v39, a79
    v_mul_f32 v32, v32, v29
    v_mul_f32 v33, v33, v29
    v_mul_f32 v34, v34, v29
    v_mul_f32 v35, v35, v29
    v_mul_f32 v36, v36, v29
    v_mul_f32 v37, v37, v29
    v_mul_f32 v38, v38, v29
    v_mul_f32 v39, v39, v29
    v_accvgpr_write_b32 a72, v32
    v_accvgpr_write_b32 a73, v33
    v_accvgpr_write_b32 a74, v34
    v_accvgpr_write_b32 a75, v35
    v_accvgpr_write_b32 a76, v36
    v_accvgpr_write_b32 a77, v37
    v_accvgpr_write_b32 a78, v38
    v_accvgpr_write_b32 a79, v39
    v_accvgpr_read_b32 v32, a80
    v_accvgpr_read_b32 v33, a81
    v_accvgpr_read_b32 v34, a82
    v_accvgpr_read_b32 v35, a83
    v_accvgpr_read_b32 v36, a84
    v_accvgpr_read_b32 v37, a85
    v_accvgpr_read_b32 v38, a86
    v_accvgpr_read_b32 v39, a87
    v_mul_f32 v32, v32, v29
    v_mul_f32 v33, v33, v29
    v_mul_f32 v34, v34, v29
    v_mul_f32 v35, v35, v29
    v_mul_f32 v36, v36, v29
    v_mul_f32 v37, v37, v29
    v_mul_f32 v38, v38, v29
    v_mul_f32 v39, v39, v29
    v_accvgpr_write_b32 a80, v32
    v_accvgpr_write_b32 a81, v33
    v_accvgpr_write_b32 a82, v34
    v_accvgpr_write_b32 a83, v35
    v_accvgpr_write_b32 a84, v36
    v_accvgpr_write_b32 a85, v37
    v_accvgpr_write_b32 a86, v38
    v_accvgpr_write_b32 a87, v39
    v_accvgpr_read_b32 v32, a88
    v_accvgpr_read_b32 v33, a89
    v_accvgpr_read_b32 v34, a90
    v_accvgpr_read_b32 v35, a91
    v_accvgpr_read_b32 v36, a92
    v_accvgpr_read_b32 v37, a93
    v_accvgpr_read_b32 v38, a94
    v_accvgpr_read_b32 v39, a95
    v_mul_f32 v32, v32, v29
    v_mul_f32 v33, v33, v29
    v_mul_f32 v34, v34, v29
    v_mul_f32 v35, v35, v29
    v_mul_f32 v36, v36, v29
    v_mul_f32 v37, v37, v29
    v_mul_f32 v38, v38, v29
    v_mul_f32 v39, v39, v29
    v_accvgpr_write_b32 a88, v32
    v_accvgpr_write_b32 a89, v33
    v_accvgpr_write_b32 a90, v34
    v_accvgpr_write_b32 a91, v35
    v_accvgpr_write_b32 a92, v36
    v_accvgpr_write_b32 a93, v37
    v_accvgpr_write_b32 a94, v38
    v_accvgpr_write_b32 a95, v39
    v_accvgpr_read_b32 v32, a96
    v_accvgpr_read_b32 v33, a97
    v_accvgpr_read_b32 v34, a98
    v_accvgpr_read_b32 v35, a99
    v_accvgpr_read_b32 v36, a100
    v_accvgpr_read_b32 v37, a101
    v_accvgpr_read_b32 v38, a102
    v_accvgpr_read_b32 v39, a103
    v_mul_f32 v32, v32, v29
    v_mul_f32 v33, v33, v29
    v_mul_f32 v34, v34, v29
    v_mul_f32 v35, v35, v29
    v_mul_f32 v36, v36, v29
    v_mul_f32 v37, v37, v29
    v_mul_f32 v38, v38, v29
    v_mul_f32 v39, v39, v29
    v_accvgpr_write_b32 a96, v32
    v_accvgpr_write_b32 a97, v33
    v_accvgpr_write_b32 a98, v34
    v_accvgpr_write_b32 a99, v35
    v_accvgpr_write_b32 a100, v36
    v_accvgpr_write_b32 a101, v37
    v_accvgpr_write_b32 a102, v38
    v_accvgpr_write_b32 a103, v39
    v_accvgpr_read_b32 v32, a104
    v_accvgpr_read_b32 v33, a105
    v_accvgpr_read_b32 v34, a106
    v_accvgpr_read_b32 v35, a107
    v_accvgpr_read_b32 v36, a108
    v_accvgpr_read_b32 v37, a109
    v_accvgpr_read_b32 v38, a110
    v_accvgpr_read_b32 v39, a111
    v_mul_f32 v32, v32, v29
    v_mul_f32 v33, v33, v29
    v_mul_f32 v34, v34, v29
    v_mul_f32 v35, v35, v29
    v_mul_f32 v36, v36, v29
    v_mul_f32 v37, v37, v29
    v_mul_f32 v38, v38, v29
    v_mul_f32 v39, v39, v29
    v_accvgpr_write_b32 a104, v32
    v_accvgpr_write_b32 a105, v33
    v_accvgpr_write_b32 a106, v34
    v_accvgpr_write_b32 a107, v35
    v_accvgpr_write_b32 a108, v36
    v_accvgpr_write_b32 a109, v37
    v_accvgpr_write_b32 a110, v38
    v_accvgpr_write_b32 a111, v39
    v_accvgpr_read_b32 v32, a112
    v_accvgpr_read_b32 v33, a113
    v_accvgpr_read_b32 v34, a114
    v_accvgpr_read_b32 v35, a115
    v_accvgpr_read_b32 v36, a116
    v_accvgpr_read_b32 v37, a117
    v_accvgpr_read_b32 v38, a118
    v_accvgpr_read_b32 v39, a119
    v_mul_f32 v32, v32, v29
    v_mul_f32 v33, v33, v29
    v_mul_f32 v34, v34, v29
    v_mul_f32 v35, v35, v29
    v_mul_f32 v36, v36, v29
    v_mul_f32 v37, v37, v29
    v_mul_f32 v38, v38, v29
    v_mul_f32 v39, v39, v29
    v_accvgpr_write_b32 a112, v32
    v_accvgpr_write_b32 a113, v33
    v_accvgpr_write_b32 a114, v34
    v_accvgpr_write_b32 a115, v35
    v_accvgpr_write_b32 a116, v36
    v_accvgpr_write_b32 a117, v37
    v_accvgpr_write_b32 a118, v38
    v_accvgpr_write_b32 a119, v39
    v_accvgpr_read_b32 v32, a120
    v_accvgpr_read_b32 v33, a121
    v_accvgpr_read_b32 v34, a122
    v_accvgpr_read_b32 v35, a123
    v_accvgpr_read_b32 v36, a124
    v_accvgpr_read_b32 v37, a125
    v_accvgpr_read_b32 v38, a126
    v_accvgpr_read_b32 v39, a127
    v_mul_f32 v32, v32, v29
    v_mul_f32 v33, v33, v29
    v_mul_f32 v34, v34, v29
    v_mul_f32 v35, v35, v29
    v_mul_f32 v36, v36, v29
    v_mul_f32 v37, v37, v29
    v_mul_f32 v38, v38, v29
    v_mul_f32 v39, v39, v29
    v_accvgpr_write_b32 a120, v32
    v_accvgpr_write_b32 a121, v33
    v_accvgpr_write_b32 a122, v34
    v_accvgpr_write_b32 a123, v35
    v_accvgpr_write_b32 a124, v36
    v_accvgpr_write_b32 a125, v37
    v_accvgpr_write_b32 a126, v38
    v_accvgpr_write_b32 a127, v39
    v_exp_f32 v32, v112
    v_exp_f32 v33, v113
    v_exp_f32 v34, v114
    v_exp_f32 v35, v115
    v_exp_f32 v36, v116
    v_exp_f32 v37, v117
    v_exp_f32 v38, v118
    v_exp_f32 v39, v119
    s_nop 0
    v_add_f32 v11, v32, v33
    v_add_f32 v11, v11, v34
    v_add_f32 v11, v11, v35
    v_add_f32 v11, v11, v36
    v_add_f32 v11, v11, v37
    v_add_f32 v11, v11, v38
    v_add_f32 v11, v11, v39
    v_cvt_pk_bf16_f32 v152, v32, v33
    v_cvt_pk_bf16_f32 v153, v34, v35
    v_cvt_pk_bf16_f32 v154, v36, v37
    v_cvt_pk_bf16_f32 v155, v38, v39
    v_exp_f32 v32, v120
    v_exp_f32 v33, v121
    v_exp_f32 v34, v122
    v_exp_f32 v35, v123
    v_exp_f32 v36, v124
    v_exp_f32 v37, v125
    v_exp_f32 v38, v126
    v_exp_f32 v39, v127
    s_nop 0
    v_add_f32 v11, v11, v32
    v_add_f32 v11, v11, v33
    v_add_f32 v11, v11, v34
    v_add_f32 v11, v11, v35
    v_add_f32 v11, v11, v36
    v_add_f32 v11, v11, v37
    v_add_f32 v11, v11, v38
    v_add_f32 v11, v11, v39
    v_cvt_pk_bf16_f32 v156, v32, v33
    v_cvt_pk_bf16_f32 v157, v34, v35
    v_cvt_pk_bf16_f32 v158, v36, v37
    v_cvt_pk_bf16_f32 v159, v38, v39
    s_nop 1
    s_setpc_b64 s[34:35]
.text
.globl gemm3_kernel
.p2align 8
.type gemm3_kernel,@function
gemm3_kernel:
    s_cmp_ge_u32 s2, 256
    s_cbranch_scc1 gemm3_kernel_end1
    s_load_dwordx8 s[4:11], s[0:1], 64
    s_load_dwordx2 s[12:13], s[0:1], 16
    v_and_b32 v1, 63, v0
    v_lshrrev_b32 v16, 6, v0
    s_nop 0
    v_readfirstlane_b32 s28, v16
    s_lshr_b32 s31, s2, 7
    s_bfe_u32 s41, s2, 0x20001
    s_lshl_b32 s41, s41, 2
    s_bfe_u32 s42, s2, 0x20003
    s_add_u32 s32, s41, s42
    s_and_b32 s41, s2, 1
    s_lshl_b32 s41, s41, 2
    s_bfe_u32 s42, s2, 0x20005
    s_add_u32 s33, s41, s42
    s_lshr_b32 s29, s28, 1
    s_and_b32 s30, s28, 1
    s_lshl_b32 s38, s28, 12
    s_cmp_eq_u32 s31, 1
    s_cselect_b32 s43, 15, 17
    s_cselect_b32 s40, 16, 64
    s_mov_b32 s44, 67108864
    s_cselect_b32 s44, 83886080, s44
    v_lshlrev_b32 v7, 4, v1
    s_lshl_b32 s41, 1, s43
    s_sub_u32 s41, s41, 2048
    v_add_u32 v8, s41, v7
    s_lshl_b32 s41, s32, 3
    s_lshl_b32 s42, s28, 1
    s_add_u32 s41, s41, s42
    s_lshl_b32 s41, s41, s43
    s_add_u32 s34, s41, s44
    v_lshrrev_b32 v16, 4, v1
    s_lshl_b32 s41, s28, 4
    v_add_u32 v17, s41, v16
    v_lshlrev_b32 v17, 11, v17
    v_lshlrev_b32 v16, 1, v16
    v_and_b32 v18, 15, v1
    v_xor_b32 v16, v16, v18
    v_xor_b32 v18, 0, v16
    v_lshl_add_u32 v9, v18, 4, v17
    v_xor_b32 v18, 8, v16
    v_lshl_add_u32 v10, v18, 4, v17
    v_add_u32 v10, 7168, v10
    v_xor_b32 v18, 0, v16
    v_lshl_add_u32 v11, v18, 4, v17
    v_add_u32 v11, 14336, v11
    v_xor_b32 v18, 8, v16
    v_lshl_add_u32 v12, v18, 4, v17
    v_add_u32 v12, 21504, v12
    s_lshl_b32 s35, s33, 8
    s_lshl_b32 s41, s29, 13
    v_add_u32 v2, s41, v7
    v_lshrrev_b32 v16, 2, v1
    v_lshlrev_b32 v16, 8, v16
    v_and_b32 v17, 3, v1
    v_lshl_add_u32 v16, v17, 3, v16
    v_add_u32 v16, 16384, v16
    v_bfe_u32 v17, v1, 2, 3
    s_lshl_b32 s41, s30, 2
    v_xor_b32 v17, s41, v17
    v_xor_b32 v18, 0, v17
    v_lshl_add_u32 v3, v18, 5, v16
    v_xor_b32 v18, 1, v17
    v_lshl_add_u32 v4, v18, 5, v16
    v_xor_b32 v18, 2, v17
    v_lshl_add_u32 v5, v18, 5, v16
    v_xor_b32 v18, 3, v17
    v_lshl_add_u32 v6, v18, 5, v16
    s_mov_b32 s18, 268435456
    s_mov_b32 s19, 0x20000
    s_mov_b32 s23, 0x20000
    s_mov_b32 s27, 0x20000
    s_mov_b32 s26, 8388608
    s_cmp_eq_u32 s31, 1
    s_mov_b32 s41, 8388608
    s_cselect_b32 s22, 2097152, s41
    s_waitcnt lgkmcnt(0)
    s_cselect_b32 s20, s12, s4
    s_cselect_b32 s21, s13, s5
    s_mov_b32 s16, s10
    s_mov_b32 s17, s11
    s_mov_b32 s24, s6
    s_mov_b32 s25, s7
    s_mov_b32 s37, s38
    s_mov_b32 m0, s37
    s_nop 0
    buffer_load_dwordx4 v7, s[16:19], s34 offen offset:0 lds
    buffer_load_dwordx4 v7, s[16:19], s34 offen offset:1024 lds
    buffer_load_dwordx4 v8, s[16:19], s34 offen offset:2048 lds
    buffer_load_dwordx4 v8, s[16:19], s34 offen offset:3072 lds
    s_add_u32 m0, s37, 16384
    s_add_u32 s34, s34, 2048
    buffer_load_dwordx4 v9, s[20:23], s35 offen offset:0 lds
    buffer_load_dwordx4 v10, s[20:23], s35 offen offset:1024 lds
    buffer_load_dwordx4 v11, s[20:23], s35 offen offset:2048 lds
    buffer_load_dwordx4 v12, s[20:23], s35 offen offset:3072 lds
    s_add_u32 s35, s35, 131072
    s_add_u32 s37, s37, 32768
    s_mov_b32 m0, s37
    s_nop 0
    buffer_load_dwordx4 v7, s[16:19], s34 offen offset:0 lds
    buffer_load_dwordx4 v7, s[16:19], s34 offen offset:1024 lds
    buffer_load_dwordx4 v8, s[16:19], s34 offen offset:2048 lds
    buffer_load_dwordx4 v8, s[16:19], s34 offen offset:3072 lds
    s_add_u32 m0, s37, 16384
    s_add_u32 s34, s34, 2048
    buffer_load_dwordx4 v9, s[20:23], s35 offen offset:0 lds
    buffer_load_dwordx4 v10, s[20:23], s35 offen offset:1024 lds
    buffer_load_dwordx4 v11, s[20:23], s35 offen offset:2048 lds
    buffer_load_dwordx4 v12, s[20:23], s35 offen offset:3072 lds
    s_add_u32 s35, s35, 131072
    s_add_u32 s37, s37, 32768
    s_mov_b32 m0, s37
    s_nop 0
    buffer_load_dwordx4 v7, s[16:19], s34 offen offset:0 lds
    buffer_load_dwordx4 v7, s[16:19], s34 offen offset:1024 lds
    buffer_load_dwordx4 v8, s[16:19], s34 offen offset:2048 lds
    buffer_load_dwordx4 v8, s[16:19], s34 offen offset:3072 lds
    s_add_u32 m0, s37, 16384
    s_add_u32 s34, s34, 2048
    buffer_load_dwordx4 v9, s[20:23], s35 offen offset:0 lds
    buffer_load_dwordx4 v10, s[20:23], s35 offen offset:1024 lds
    buffer_load_dwordx4 v11, s[20:23], s35 offen offset:2048 lds
    buffer_load_dwordx4 v12, s[20:23], s35 offen offset:3072 lds
    s_add_u32 s35, s35, 131072
    s_add_u32 s37, s37, 32768
    s_mov_b32 m0, s37
    s_nop 0
    buffer_load_dwordx4 v7, s[16:19], s34 offen offset:0 lds
    buffer_load_dwordx4 v7, s[16:19], s34 offen offset:1024 lds
    buffer_load_dwordx4 v8, s[16:19], s34 offen offset:2048 lds
    buffer_load_dwordx4 v8, s[16:19], s34 offen offset:3072 lds
    s_add_u32 m0, s37, 16384
    s_add_u32 s34, s34, 2048
    buffer_load_dwordx4 v9, s[20:23], s35 offen offset:0 lds
    buffer_load_dwordx4 v10, s[20:23], s35 offen offset:1024 lds
    buffer_load_dwordx4 v11, s[20:23], s35 offen offset:2048 lds
    buffer_load_dwordx4 v12, s[20:23], s35 offen offset:3072 lds
    s_add_u32 s35, s35, 131072
    s_add_u32 s37, s37, 32768
    s_mov_b32 m0, s37
    s_nop 0
    buffer_load_dwordx4 v7, s[16:19], s34 offen offset:0 lds
    buffer_load_dwordx4 v7, s[16:19], s34 offen offset:1024 lds
    buffer_load_dwordx4 v8, s[16:19], s34 offen offset:2048 lds
    buffer_load_dwordx4 v8, s[16:19], s34 offen offset:3072 lds
    s_mov_b32 s36, 0
    s_mov_b32 s50, 32768
    v_mov_b32 v32, 0
    v_mov_b32 v33, 0
    v_mov_b32 v34, 0
    v_mov_b32 v35, 0
    v_mov_b32 v36, 0
    v_mov_b32 v37, 0
    v_mov_b32 v38, 0
    v_mov_b32 v39, 0
    v_mov_b32 v40, 0
    v_mov_b32 v41, 0
    v_mov_b32 v42, 0
    v_mov_b32 v43, 0
    v_mov_b32 v44, 0
    v_mov_b32 v45, 0
    v_mov_b32 v46, 0
    v_mov_b32 v47, 0
    v_mov_b32 v48, 0
    v_mov_b32 v49, 0
    v_mov_b32 v50, 0
    v_mov_b32 v51, 0
    v_mov_b32 v52, 0
    v_mov_b32 v53, 0
    v_mov_b32 v54, 0
    v_mov_b32 v55, 0
    v_mov_b32 v56, 0
    v_mov_b32 v57, 0
    v_mov_b32 v58, 0
    v_mov_b32 v59, 0
    v_mov_b32 v60, 0
    v_mov_b32 v61, 0
    v_mov_b32 v62, 0
    v_mov_b32 v63, 0
    v_mov_b32 v64, 0
    v_mov_b32 v65, 0
    v_mov_b32 v66, 0
    v_mov_b32 v67, 0
    v_mov_b32 v68, 0
    v_mov_b32 v69, 0
    v_mov_b32 v70, 0
    v_mov_b32 v71, 0
    v_mov_b32 v72, 0
    v_mov_b32 v73, 0
    v_mov_b32 v74, 0
    v_mov_b32 v75, 0
    v_mov_b32 v76, 0
    v_mov_b32 v77, 0
    v_mov_b32 v78, 0
    v_mov_b32 v79, 0
    v_mov_b32 v80, 0
    v_mov_b32 v81, 0
    v_mov_b32 v82, 0
    v_mov_b32 v83, 0
    v_mov_b32 v84, 0
    v_mov_b32 v85, 0
    v_mov_b32 v86, 0
    v_mov_b32 v87, 0
    v_mov_b32 v88, 0
    v_mov_b32 v89, 0
    v_mov_b32 v90, 0
    v_mov_b32 v91, 0
    v_mov_b32 v92, 0
    v_mov_b32 v93, 0
    v_mov_b32 v94, 0
    v_mov_b32 v95, 0
    s_waitcnt vmcnt(28)
    s_barrier
    ds_read_b128 v[96:99], v2 offset:0
    ds_read_b64_tr_b16 v[112:113], v3 offset:0
    ds_read_b64_tr_b16 v[114:115], v3 offset:4096
    ds_read_b128 v[100:103], v2 offset:2048
    ds_read_b128 v[104:107], v2 offset:4096
    ds_read_b128 v[108:111], v2 offset:6144
    ds_read_b64_tr_b16 v[116:117], v4 offset:0
    ds_read_b64_tr_b16 v[118:119], v4 offset:4096
    ds_read_b64_tr_b16 v[120:121], v5 offset:0
    ds_read_b64_tr_b16 v[122:123], v5 offset:4096
    ds_read_b64_tr_b16 v[124:125], v6 offset:0
    ds_read_b64_tr_b16 v[126:127], v6 offset:4096
gemm3_kernel_loop2:
    s_waitcnt lgkmcnt(9)
    v_mfma_f32_16x16x32_bf16 v[32:35], v[112:115], v[96:99], v[32:35]
    ds_read_b128 v[128:131], v2 offset:1024
    s_waitcnt lgkmcnt(9)
    v_mfma_f32_16x16x32_bf16 v[40:43], v[112:115], v[100:103], v[40:43]
    ds_read_b64_tr_b16 v[144:145], v3 offset:8192
    s_add_u32 m0, s37, 16384
    s_add_u32 s34, s34, 2048
    buffer_load_dwordx4 v9, s[20:23], s35 offen offset:0 lds
    s_waitcnt lgkmcnt(9)
    v_mfma_f32_16x16x32_bf16 v[48:51], v[112:115], v[104:107], v[48:51]
    ds_read_b64_tr_b16 v[146:147], v3 offset:12288
    s_waitcnt lgkmcnt(9)
    v_mfma_f32_16x16x32_bf16 v[56:59], v[112:115], v[108:111], v[56:59]
    ds_read_b128 v[132:135], v2 offset:3072
    s_waitcnt lgkmcnt(8)
    v_mfma_f32_16x16x32_bf16 v[36:39], v[116:119], v[96:99], v[36:39]
    ds_read_b128 v[136:139], v2 offset:5120
    buffer_load_dwordx4 v10, s[20:23], s35 offen offset:1024 lds
    v_mfma_f32_16x16x32_bf16 v[44:47], v[116:119], v[100:103], v[44:47]
    ds_read_b128 v[140:143], v2 offset:7168
    v_mfma_f32_16x16x32_bf16 v[52:55], v[116:119], v[104:107], v[52:55]
    ds_read_b64_tr_b16 v[148:149], v4 offset:8192
    v_mfma_f32_16x16x32_bf16 v[60:63], v[116:119], v[108:111], v[60:63]
    ds_read_b64_tr_b16 v[150:151], v4 offset:12288
    buffer_load_dwordx4 v11, s[20:23], s35 offen offset:2048 lds
    s_waitcnt lgkmcnt(10)
    v_mfma_f32_16x16x32_bf16 v[64:67], v[120:123], v[96:99], v[64:67]
    ds_read_b64_tr_b16 v[152:153], v5 offset:8192
    v_mfma_f32_16x16x32_bf16 v[72:75], v[120:123], v[100:103], v[72:75]
    ds_read_b64_tr_b16 v[154:155], v5 offset:12288
    v_mfma_f32_16x16x32_bf16 v[80:83], v[120:123], v[104:107], v[80:83]
    ds_read_b64_tr_b16 v[156:157], v6 offset:8192
    buffer_load_dwordx4 v12, s[20:23], s35 offen offset:3072 lds
    s_add_u32 s35, s35, 131072
    v_mfma_f32_16x16x32_bf16 v[88:91], v[120:123], v[108:111], v[88:91]
    ds_read_b64_tr_b16 v[158:159], v6 offset:12288
    s_waitcnt lgkmcnt(12)
    v_mfma_f32_16x16x32_bf16 v[68:71], v[124:127], v[96:99], v[68:71]
    s_add_u32 s37, s36, s38
    s_add_u32 s36, s36, 32768
    v_mfma_f32_16x16x32_bf16 v[76:79], v[124:127], v[100:103], v[76:79]
    s_cmp_ge_u32 s36, 163840
    s_cselect_b32 s39, 4294836224, s50
    v_mfma_f32_16x16x32_bf16 v[84:87], v[124:127], v[104:107], v[84:87]
    s_cselect_b32 s36, 0, s36
    v_add_u32 v2, s39, v2
    v_add_u32 v3, s39, v3
    v_mfma_f32_16x16x32_bf16 v[92:95], v[124:127], v[108:111], v[92:95]
    v_add_u32 v4, s39, v4
    v_add_u32 v5, s39, v5
    s_waitcnt vmcnt(24) lgkmcnt(0)
    v_mfma_f32_16x16x32_bf16 v[32:35], v[144:147], v[128:131], v[32:35]
    s_barrier
    v_add_u32 v6, s39, v6
    v_mfma_f32_16x16x32_bf16 v[40:43], v[144:147], v[132:135], v[40:43]
    ds_read_b128 v[96:99], v2 offset:0
    v_mfma_f32_16x16x32_bf16 v[48:51], v[144:147], v[136:139], v[48:51]
    ds_read_b64_tr_b16 v[112:113], v3 offset:0
    v_mfma_f32_16x16x32_bf16 v[56:59], v[144:147], v[140:143], v[56:59]
    ds_read_b64_tr_b16 v[114:115], v3 offset:4096
    s_mov_b32 m0, s37
    s_nop 0
    buffer_load_dwordx4 v7, s[16:19], s34 offen offset:0 lds
    v_mfma_f32_16x16x32_bf16 v[36:39], v[148:151], v[128:131], v[36:39]
    ds_read_b128 v[100:103], v2 offset:2048
    v_mfma_f32_16x16x32_bf16 v[44:47], v[148:151], v[132:135], v[44:47]
    ds_read_b128 v[104:107], v2 offset:4096
    v_mfma_f32_16x16x32_bf16 v[52:55], v[148:151], v[136:139], v[52:55]
    ds_read_b128 v[108:111], v2 offset:6144
    buffer_load_dwordx4 v7, s[16:19], s34 offen offset:1024 lds
    v_mfma_f32_16x16x32_bf16 v[60:63], v[148:151], v[140:143], v[60:63]
    ds_read_b64_tr_b16 v[116:117], v4 offset:0
    v_mfma_f32_16x16x32_bf16 v[64:67], v[152:155], v[128:131], v[64:67]
    ds_read_b64_tr_b16 v[118:119], v4 offset:4096
    v_mfma_f32_16x16x32_bf16 v[72:75], v[152:155], v[132:135], v[72:75]
    ds_read_b64_tr_b16 v[120:121], v5 offset:0
    buffer_load_dwordx4 v8, s[16:19], s34 offen offset:2048 lds
    v_mfma_f32_16x16x32_bf16 v[80:83], v[152:155], v[136:139], v[80:83]
    ds_read_b64_tr_b16 v[122:123], v5 offset:4096
    v_mfma_f32_16x16x32_bf16 v[88:91], v[152:155], v[140:143], v[88:91]
    ds_read_b64_tr_b16 v[124:125], v6 offset:0
    v_mfma_f32_16x16x32_bf16 v[68:71], v[156:159], v[128:131], v[68:71]
    ds_read_b64_tr_b16 v[126:127], v6 offset:4096
    v_mfma_f32_16x16x32_bf16 v[76:79], v[156:159], v[132:135], v[76:79]
    buffer_load_dwordx4 v8, s[16:19], s34 offen offset:3072 lds
    v_mfma_f32_16x16x32_bf16 v[84:87], v[156:159], v[136:139], v[84:87]
    s_sub_u32 s40, s40, 1
    s_cmp_eq_u32 s40, 5
    s_cselect_b32 s18, 0, s18
    s_cmp_lg_u32 s40, 0
    v_mfma_f32_16x16x32_bf16 v[92:95], v[156:159], v[140:143], v[92:95]
    s_cbranch_scc1 gemm3_kernel_loop2
    v_and_b32 v16, 15, v1
    v_lshlrev_b32 v16, 12, v16
    v_lshlrev_b32 v16, s31, v16
    v_bfe_u32 v17, v1, 4, 1
    v_lshl_add_u32 v16, v17, 5, v16
    v_lshrrev_b32 v17, 5, v1
    v_lshl_add_u32 v13, v17, 4, v16
    s_lshl_b32 s41, s32, 3
    s_lshl_b32 s42, s29, 2
    s_add_u32 s41, s41, s42
    s_lshl_b32 s42, s41, 16
    s_add_u32 s42, s42, 2048
    s_and_b32 s43, s41, 63
    s_lshl_b32 s43, s43, 17
    s_lshr_b32 s44, s41, 6
    s_lshl_b32 s44, s44, 12
    s_add_u32 s43, s43, s44
    s_cmp_eq_u32 s31, 1
    s_cselect_b32 s41, s43, s42
    s_lshl_b32 s42, 0x10000, s31
    s_lshl_b32 s43, s33, 8
    s_lshl_b32 s44, s30, 7
    s_add_u32 s41, s41, s43
    s_add_u32 s41, s41, s44
    v_cvt_pk_bf16_f32 v32, v32, v33
    v_cvt_pk_bf16_f32 v33, v34, v35
    v_cvt_pk_bf16_f32 v34, v36, v37
    v_cvt_pk_bf16_f32 v35, v38, v39
    v_cvt_pk_bf16_f32 v64, v64, v65
    v_cvt_pk_bf16_f32 v65, v66, v67
    v_cvt_pk_bf16_f32 v66, v68, v69
    v_cvt_pk_bf16_f32 v67, v70, v71
    s_nop 1
    v_permlane16_swap_b32 v32, v34
    v_permlane16_swap_b32 v33, v35
    v_permlane16_swap_b32 v64, v66
    v_permlane16_swap_b32 v65, v67
    buffer_store_dwordx4 v[32:35], v13, s[24:27], s41 offen offset:0
    buffer_store_dwordx4 v[64:67], v13, s[24:27], s41 offen offset:64
    s_add_u32 s41, s41, s42
    v_cvt_pk_bf16_f32 v40, v40, v41
    v_cvt_pk_bf16_f32 v41, v42, v43
    v_cvt_pk_bf16_f32 v42, v44, v45
    v_cvt_pk_bf16_f32 v43, v46, v47
    v_cvt_pk_bf16_f32 v72, v72, v73
    v_cvt_pk_bf16_f32 v73, v74, v75
    v_cvt_pk_bf16_f32 v74, v76, v77
    v_cvt_pk_bf16_f32 v75, v78, v79
    s_nop 1
    v_permlane16_swap_b32 v40, v42
    v_permlane16_swap_b32 v41, v43
    v_permlane16_swap_b32 v72, v74
    v_permlane16_swap_b32 v73, v75
    buffer_store_dwordx4 v[40:43], v13, s[24:27], s41 offen offset:0
    buffer_store_dwordx4 v[72:75], v13, s[24:27], s41 offen offset:64
    s_add_u32 s41, s41, s42
    v_cvt_pk_bf16_f32 v48, v48, v49
    v_cvt_pk_bf16_f32 v49, v50, v51
    v_cvt_pk_bf16_f32 v50, v52, v53
    v_cvt_pk_bf16_f32 v51, v54, v55
    v_cvt_pk_bf16_f32 v80, v80, v81
    v_cvt_pk_bf16_f32 v81, v82, v83
    v_cvt_pk_bf16_f32 v82, v84, v85
    v_cvt_pk_bf16_f32 v83, v86, v87
    s_nop 1
    v_permlane16_swap_b32 v48, v50
    v_permlane16_swap_b32 v49, v51
    v_permlane16_swap_b32 v80, v82
    v_permlane16_swap_b32 v81, v83
    buffer_store_dwordx4 v[48:51], v13, s[24:27], s41 offen offset:0
    buffer_store_dwordx4 v[80:83], v13, s[24:27], s41 offen offset:64
    s_add_u32 s41, s41, s42
    v_cvt_pk_bf16_f32 v56, v56, v57
    v_cvt_pk_bf16_f32 v57, v58, v59
    v_cvt_pk_bf16_f32 v58, v60, v61
    v_cvt_pk_bf16_f32 v59, v62, v63
    v_cvt_pk_bf16_f32 v88, v88, v89
    v_cvt_pk_bf16_f32 v89, v90, v91
    v_cvt_pk_bf16_f32 v90, v92, v93
    v_cvt_pk_bf16_f32 v91, v94, v95
    s_nop 1
    v_permlane16_swap_b32 v56, v58
    v_permlane16_swap_b32 v57, v59
    v_permlane16_swap_b32 v88, v90
    v_permlane16_swap_b32 v89, v91
    buffer_store_dwordx4 v[56:59], v13, s[24:27], s41 offen offset:0
    buffer_store_dwordx4 v[88:91], v13, s[24:27], s41 offen offset:64
    s_add_u32 s41, s41, s42
gemm3_kernel_end1:
    s_endpgm
.section .rodata,"a"
.p2align 6
.amdhsa_kernel gemm1_kernel
  .amdhsa_next_free_vgpr 512
  .amdhsa_next_free_sgpr 102
  .amdhsa_accum_offset 256
  .amdhsa_group_segment_fixed_size 0
  .amdhsa_kernarg_size 96
  .amdhsa_user_sgpr_count 2
  .amdhsa_user_sgpr_kernarg_segment_ptr 1
  .amdhsa_system_sgpr_workgroup_id_x 1
.end_amdhsa_kernel
.section .rodata,"a"
.p2align 6
.amdhsa_kernel attn_kernel
  .amdhsa_next_free_vgpr 512
  .amdhsa_next_free_sgpr 102
  .amdhsa_accum_offset 256
  .amdhsa_group_segment_fixed_size 0
  .amdhsa_kernarg_size 96
  .amdhsa_user_sgpr_count 2
  .amdhsa_user_sgpr_kernarg_segment_ptr 1
  .amdhsa_system_sgpr_workgroup_id_x 1
.end_amdhsa_kernel
.section .rodata,"a"
.p2align 6
.amdhsa_kernel gemm3_kernel
  .amdhsa_next_free_vgpr 160
  .amdhsa_next_free_sgpr 102
  .amdhsa_accum_offset 160
  .amdhsa_group_segment_fixed_size 0
  .amdhsa_kernarg_size 96
  .amdhsa_user_sgpr_count 2
  .amdhsa_user_sgpr_kernarg_segment_ptr 1
  .amdhsa_system_sgpr_workgroup_id_x 1
.end_amdhsa_kernel
```

```asm
; @launch kernel=gemm1_kernel grid=(256,1,1) block=(256,1,1) lds=163840
; @launch kernel=attn_kernel grid=(256,1,1) block=(256,1,1) lds=131072
; @launch kernel=gemm3_kernel grid=(256,1,1) block=(256,1,1) lds=163840
.amdgcn_target "amdgcn-amd-amdhsa--gfx950"
.text
.globl gemm1_kernel
.p2align 8
.type gemm1_kernel,@function
gemm1_kernel:
    s_cmp_ge_u32 s2, 256
    s_cbranch_scc1 gemm1_kernel_end1
    s_load_dwordx16 s[4:19], s[0:1], 0
    s_load_dwordx2 s[20:21], s[0:1], 88
    v_and_b32 v1, 63, v0
    v_lshrrev_b32 v20, 6, v0
    s_nop 0
    v_readfirstlane_b32 s45, v20
    s_and_b32 s54, s2, 7
    s_lshr_b32 s62, s2, 3
    s_lshr_b32 s60, s54, 1
    s_and_b32 s54, s54, 1
    s_lshl_b32 s54, s54, 2
    s_and_b32 s59, s62, 3
    s_add_u32 s59, s59, s54
    s_lshr_b32 s61, s62, 2
    s_lshr_b32 s46, s45, 1
    s_and_b32 s47, s45, 1
    s_mov_b32 s27, 0x20000
    s_mov_b32 s31, 0x20000
    v_and_b32 v20, 15, v1
    v_lshrrev_b32 v21, 4, v1
    v_bfe_u32 v22, v1, 1, 3
    v_xor_b32 v22, v22, v21
    s_lshl_b32 s54, s46, 14
    v_lshlrev_b32 v23, 7, v20
    v_add_u32 v23, s54, v23
    v_xor_b32 v24, 0, v22
    v_lshl_add_u32 v2, v24, 4, v23
    v_xor_b32 v24, 4, v22
    v_lshl_add_u32 v3, v24, 4, v23
    v_bfe_u32 v22, v1, 2, 2
    v_lshl_add_u32 v23, v21, 3, v22
    v_lshlrev_b32 v23, 9, v23
    v_and_b32 v24, 3, v1
    v_lshlrev_b32 v24, 3, v24
    v_add_u32 v23, v23, v24
    s_lshl_b32 s54, s47, 8
    s_add_u32 s54, s54, 98304
    v_add_u32 v23, s54, v23
    v_bfe_u32 v22, v1, 2, 3
    v_xor_b32 v24, 0, v22
    v_lshl_add_u32 v4, v24, 5, v23
    v_xor_b32 v24, 1, v22
    v_lshl_add_u32 v5, v24, 5, v23
    v_xor_b32 v24, 2, v22
    v_lshl_add_u32 v6, v24, 5, v23
    v_xor_b32 v24, 3, v22
    v_lshl_add_u32 v7, v24, 5, v23
    v_xor_b32 v24, 4, v22
    v_lshl_add_u32 v8, v24, 5, v23
    v_xor_b32 v24, 5, v22
    v_lshl_add_u32 v9, v24, 5, v23
    v_xor_b32 v24, 6, v22
    v_lshl_add_u32 v10, v24, 5, v23
    v_xor_b32 v24, 7, v22
    v_lshl_add_u32 v11, v24, 5, v23
    v_lshlrev_b32 v18, 4, v1
    s_lshl_b32 s48, s45, 13
    s_add_u32 s49, s48, 98304
    s_mov_b32 s51, 0
    s_mov_b32 s22, 32768
    s_mov_b32 s23, 229376
    s_mul_i32 s54, s60, 7
    s_add_u32 s54, s54, s61
    s_sub_u32 s55, s54, 12
    s_cmp_lt_u32 s54, 12
    s_mov_b32 s56, 8388608
    s_cselect_b32 s68, 6291456, s56
    s_mov_b32 s56, 8192
    s_cselect_b32 s70, 6144, s56
    s_cselect_b32 s73, 1, 0
    s_cselect_b32 s54, s54, s55
    s_mov_b32 s65, 4194304
    s_mov_b32 s69, 2048
    s_mov_b32 s74, 16
    s_lshl_b32 s72, s54, 9
    s_lshl_b32 s71, s59, 19
    s_cmp_eq_u32 s73, 0
    s_cbranch_scc1 gemm1_kernel_lb2
    s_lshr_b32 s55, s54, 2
    s_cmp_eq_u32 s55, 0
    s_cselect_b32 s76, 1048744942, 0
    s_lshl_b32 s56, s55, 22
    s_add_u32 s77, s56, 50331648
    s_and_b32 s56, s54, 3
    s_lshl_b32 s56, s56, 1
    s_add_u32 s56, s56, s47
    s_lshl_b32 s56, s56, 19
    s_add_u32 s77, s77, s56
    s_lshl_b32 s56, s46, 3
    s_add_u32 s56, s56, s59
    s_cmp_eq_u32 s55, 2
    s_cbranch_scc1 gemm1_kernel_lv4
    s_lshl_b32 s56, s56, 13
    s_add_u32 s77, s77, s56
    s_mov_b32 s75, 0
    s_mov_b32 s78, 131072
    s_mov_b32 s79, 1024
    s_branch gemm1_kernel_ld3
gemm1_kernel_lv4:
    s_lshl_b32 s56, s56, 12
    s_add_u32 s77, s77, s56
    s_mov_b32 s75, 1
    s_mov_b32 s78, 1024
    s_mov_b32 s79, 65536
    s_branch gemm1_kernel_ld3
gemm1_kernel_lb2:
    s_mov_b32 s75, 0
    s_mov_b32 s76, 1040356334
    s_lshl_b32 s55, s54, 1
    s_add_u32 s55, s55, s47
    s_lshl_b32 s55, s55, 19
    s_lshl_b32 s56, s59, 1
    s_add_u32 s56, s56, s46
    s_lshl_b32 s56, s56, 15
    s_add_u32 s77, s55, s56
    s_add_u32 s77, s77, 0
    s_mov_b32 s78, 1024
    s_mov_b32 s79, 4096
gemm1_kernel_ld3:
    s_lshl_b32 s54, s60, 3
    s_add_u32 s54, s54, s61
    s_cmp_lt_u32 s54, 16
    s_cselect_b32 s92, 0, 1
    s_mov_b32 s55, 33554432
    s_cselect_b32 s94, 16777216, s55
    s_mov_b32 s55, 8192
    s_cselect_b32 s95, 1024, s55
    s_mov_b32 s55, 1024
    s_cselect_b32 s96, 4096, s55
    s_mov_b32 s82, 2097152
    s_mov_b32 s86, 1024
    s_mov_b32 s91, 8
    s_mov_b32 s90, 0
    s_mov_b32 s85, 4194304
    s_mov_b32 s87, 8192
    s_mov_b32 s93, 0
    s_and_b32 s54, s54, 15
    s_lshl_b32 s89, s54, 9
    s_lshl_b32 s88, s59, 18
    s_lshl_b32 s55, s54, 1
    s_add_u32 s55, s55, s47
    s_lshl_b32 s55, s55, 19
    s_lshl_b32 s56, s59, 1
    s_add_u32 s56, s56, s46
    s_lshl_b32 s56, s56, 15
    s_add_u32 s94, s94, s55
    s_add_u32 s94, s94, s56
    s_mov_b32 s58, 1
    s_cmp_lt_u32 s62, 28
    s_cbranch_scc1 gemm1_kernel_haslong5
    s_mov_b32 s65, s82
    s_mov_b32 s68, s85
    s_mov_b32 s69, s86
    s_mov_b32 s70, s87
    s_mov_b32 s71, s88
    s_mov_b32 s72, s89
    s_mov_b32 s73, s90
    s_mov_b32 s74, s91
    s_mov_b32 s75, s92
    s_mov_b32 s76, s93
    s_mov_b32 s77, s94
    s_mov_b32 s78, s95
    s_mov_b32 s79, s96
    s_mov_b32 s58, 0
gemm1_kernel_haslong5:
    s_mov_b32 s26, s65
    s_mov_b32 s30, s68
    s_lshl_b32 s54, s69, 4
    s_lshl_b32 s54, s54, s73
    s_mov_b32 s36, s71
    s_mul_i32 s55, s54, 1
    s_add_u32 s37, s55, s71
    s_sub_u32 s37, s37, 2048
    s_mul_i32 s55, s54, 2
    s_add_u32 s38, s55, s71
    s_mul_i32 s55, s54, 3
    s_add_u32 s39, s55, s71
    s_sub_u32 s39, s39, 2048
    s_mov_b32 s40, s72
    s_lshl_b32 s54, s70, 2
    s_mul_i32 s55, s54, 1
    s_add_u32 s41, s55, s72
    s_sub_u32 s41, s41, 2048
    s_mul_i32 s55, s54, 2
    s_add_u32 s42, s55, s72
    s_mul_i32 s55, s54, 3
    s_add_u32 s43, s55, s72
    s_sub_u32 s43, s43, 2048
    s_lshl_b32 s44, s70, 6
    s_lshl_b32 s54, s47, 7
    s_add_u32 s54, s54, s46
    s_lshl_b32 s55, s45, 6
    s_cmp_eq_u32 s73, 1
    s_cselect_b32 s54, s54, s55
    v_lshrrev_b32 v20, 3, v1
    v_lshlrev_b32 v20, s73, v20
    v_add_u32 v20, s54, v20
    v_mul_lo_u32 v20, v20, s69
    v_lshrrev_b32 v21, 4, v1
    v_and_b32 v22, 7, v1
    v_xor_b32 v21, v21, v22
    v_lshl_add_u32 v12, v21, 4, v20
    v_xor_b32 v21, 4, v21
    v_lshl_add_u32 v13, v21, 4, v20
    s_lshl_b32 s54, s69, 3
    s_lshl_b32 s54, s54, s73
    s_sub_u32 s54, s54, 1024
    v_add_u32 v13, s54, v13
    v_lshrrev_b32 v20, 5, v1
    s_lshl_b32 s54, s45, 4
    v_add_u32 v21, s54, v20
    v_mul_lo_u32 v21, v21, s70
    v_lshlrev_b32 v20, 1, v20
    v_and_b32 v22, 31, v1
    v_xor_b32 v20, v20, v22
    s_lshl_b32 s54, s70, 1
    s_sub_u32 s54, s54, 1024
    v_add_u32 v23, s54, v21
    v_xor_b32 v22, 0, v20
    v_lshl_add_u32 v14, v22, 4, v21
    v_xor_b32 v22, 4, v20
    v_lshl_add_u32 v15, v22, 4, v23
    v_xor_b32 v22, 8, v20
    v_lshl_add_u32 v16, v22, 4, v21
    v_xor_b32 v22, 12, v20
    v_lshl_add_u32 v17, v22, 4, v23
    s_waitcnt lgkmcnt(0)
    s_cmp_eq_u32 s73, 1
    s_cselect_b32 s63, s4, s10
    s_cselect_b32 s64, s5, s11
    s_cselect_b32 s66, s6, s14
    s_cselect_b32 s67, s7, s15
    s_cmp_eq_u32 s92, 0
    s_cselect_b32 s83, s16, s18
    s_cselect_b32 s84, s17, s19
    s_mov_b32 s80, s12
    s_mov_b32 s81, s13
    s_cmp_lt_u32 s62, 28
    s_cbranch_scc1 gemm1_kernel_hl26
    s_mov_b32 s63, s80
    s_mov_b32 s64, s81
    s_mov_b32 s66, s83
    s_mov_b32 s67, s84
gemm1_kernel_hl26:
    s_cmp_lt_u32 s62, 28
    s_cbranch_scc1 gemm1_kernel_nopf7
    s_load_dwordx2 s[100:101], s[0:1], 64
    s_sub_u32 s57, s2, 224
    s_lshl_b32 s57, s57, 2
    s_add_u32 s57, s57, s45
    v_lshlrev_b32 v20, 7, v1
    v_lshrrev_b32 v21, 3, v1
    v_lshlrev_b32 v21, 11, v21
    v_and_b32 v22, 7, v1
    v_lshl_add_u32 v21, v22, 7, v21
    s_lshl_b32 s56, s57, 13
    s_lshl_b32 s57, s57, 14
    s_add_u32 s57, s57, 1024
    s_mov_b32 s35, 0x20000
    s_waitcnt lgkmcnt(0)
    s_mov_b32 s32, s14
    s_mov_b32 s33, s15
    s_mov_b32 s34, 8388608
    s_add_u32 s54, s56, 4194304
    buffer_load_dword v23, v20, s[32:35], s54 offen
    s_add_u32 s54, s56, 5242880
    buffer_load_dword v23, v20, s[32:35], s54 offen
    s_mov_b32 s32, s6
    s_mov_b32 s33, s7
    s_mov_b32 s34, 6291456
    s_add_u32 s54, s56, 3145728
    buffer_load_dword v23, v20, s[32:35], s54 offen
    s_add_u32 s54, s56, 4194304
    buffer_load_dword v23, v20, s[32:35], s54 offen
    s_mov_b32 s32, s4
    s_mov_b32 s33, s5
    s_mov_b32 s34, 4194304
    s_add_u32 s54, s57, 0
    buffer_load_dword v23, v21, s[32:35], s54 offen
    s_add_u32 s54, s57, 2097152
    buffer_load_dword v23, v21, s[32:35], s54 offen
    s_mov_b32 s32, s10
    s_mov_b32 s33, s11
    s_mov_b32 s34, 4194304
    s_add_u32 s54, s57, 0
    buffer_load_dword v23, v21, s[32:35], s54 offen
    s_add_u32 s54, s57, 2097152
    buffer_load_dword v23, v21, s[32:35], s54 offen
    s_mov_b32 s32, s14
    s_mov_b32 s33, s15
    s_mov_b32 s34, 8388608
    s_add_u32 s54, s56, 6291456
    buffer_load_dword v23, v20, s[32:35], s54 offen
    s_add_u32 s54, s56, 7340032
    buffer_load_dword v23, v20, s[32:35], s54 offen
    s_mov_b32 s32, s6
    s_mov_b32 s33, s7
    s_mov_b32 s34, 6291456
    s_add_u32 s54, s56, 5242880
    buffer_load_dword v23, v20, s[32:35], s54 offen
    s_mov_b32 s32, s12
    s_mov_b32 s33, s13
    s_mov_b32 s34, 2097152
    s_add_u32 s54, s56, 0
    buffer_load_dword v23, v20, s[32:35], s54 offen
    s_add_u32 s54, s56, 1048576
    buffer_load_dword v23, v20, s[32:35], s54 offen
    s_mov_b32 s32, s16
    s_mov_b32 s33, s17
    s_mov_b32 s34, 4194304
    s_add_u32 s54, s56, 0
    buffer_load_dword v23, v20, s[32:35], s54 offen
    s_add_u32 s54, s56, 1048576
    buffer_load_dword v23, v20, s[32:35], s54 offen
    s_add_u32 s54, s56, 2097152
    buffer_load_dword v23, v20, s[32:35], s54 offen
    s_add_u32 s54, s56, 3145728
    buffer_load_dword v23, v20, s[32:35], s54 offen
    s_mov_b32 s32, s18
    s_mov_b32 s33, s19
    s_mov_b32 s34, 4194304
    s_add_u32 s54, s56, 0
    buffer_load_dword v23, v20, s[32:35], s54 offen
    s_add_u32 s54, s56, 1048576
    buffer_load_dword v23, v20, s[32:35], s54 offen
    s_add_u32 s54, s56, 2097152
    buffer_load_dword v23, v20, s[32:35], s54 offen
    s_add_u32 s54, s56, 3145728
    buffer_load_dword v23, v20, s[32:35], s54 offen
    s_mov_b32 s32, s100
    s_mov_b32 s33, s101
    s_mov_b32 s34, 8388608
    s_add_u32 s54, s56, 0
    buffer_load_dword v23, v20, s[32:35], s54 offen
    s_add_u32 s54, s56, 1048576
    buffer_load_dword v23, v20, s[32:35], s54 offen
    s_add_u32 s54, s56, 2097152
    buffer_load_dword v23, v20, s[32:35], s54 offen
    s_add_u32 s54, s56, 3145728
    buffer_load_dword v23, v20, s[32:35], s54 offen
    s_add_u32 s54, s56, 4194304
    buffer_load_dword v23, v20, s[32:35], s54 offen
    s_add_u32 s54, s56, 5242880
    buffer_load_dword v23, v20, s[32:35], s54 offen
    s_add_u32 s54, s56, 6291456
    buffer_load_dword v23, v20, s[32:35], s54 offen
    s_add_u32 s54, s56, 7340032
    buffer_load_dword v23, v20, s[32:35], s54 offen
    s_mov_b32 s32, s8
    s_mov_b32 s33, s9
    s_mov_b32 s34, 2097152
    s_add_u32 s54, s56, 0
    buffer_load_dword v23, v20, s[32:35], s54 offen
    s_add_u32 s54, s56, 1048576
    buffer_load_dword v23, v20, s[32:35], s54 offen
gemm1_kernel_nopf7:
    s_mov_b32 s24, s63
    s_mov_b32 s25, s64
    s_mov_b32 s28, s66
    s_mov_b32 s29, s67
    s_mov_b32 s32, s20
    s_mov_b32 s33, s21
    s_mov_b32 s34, 268435456
    s_mov_b32 s35, 0x20000
    s_add_u32 m0, s48, 0
    s_nop 0
    buffer_load_dwordx4 v12, s[24:27], s36 offen offset:0 lds
    buffer_load_dwordx4 v13, s[24:27], s36 offen offset:1024 lds
    s_add_u32 s36, s36, 128
    buffer_load_dwordx4 v12, s[24:27], s37 offen offset:2048 lds
    buffer_load_dwordx4 v13, s[24:27], s37 offen offset:3072 lds
    s_add_u32 s37, s37, 128
    s_add_u32 m0, s48, 4096
    s_nop 0
    buffer_load_dwordx4 v12, s[24:27], s38 offen offset:0 lds
    buffer_load_dwordx4 v13, s[24:27], s38 offen offset:1024 lds
    s_add_u32 s38, s38, 128
    buffer_load_dwordx4 v12, s[24:27], s39 offen offset:2048 lds
    buffer_load_dwordx4 v13, s[24:27], s39 offen offset:3072 lds
    s_add_u32 s39, s39, 128
    s_add_u32 s48, s48, 32768
    s_cmp_ge_u32 s48, 98304
    s_cselect_b32 s54, 98304, 0
    s_sub_u32 s48, s48, s54
    s_add_u32 m0, s49, 0
    s_nop 0
    buffer_load_dwordx4 v14, s[28:31], s40 offen offset:0 lds
    buffer_load_dwordx4 v15, s[28:31], s40 offen offset:1024 lds
    s_add_u32 s40, s40, s44
    buffer_load_dwordx4 v14, s[28:31], s41 offen offset:2048 lds
    buffer_load_dwordx4 v15, s[28:31], s41 offen offset:3072 lds
    s_add_u32 s41, s41, s44
    s_add_u32 m0, s49, 4096
    s_nop 0
    buffer_load_dwordx4 v16, s[28:31], s42 offen offset:0 lds
    buffer_load_dwordx4 v17, s[28:31], s42 offen offset:1024 lds
    s_add_u32 s42, s42, s44
    buffer_load_dwordx4 v16, s[28:31], s43 offen offset:2048 lds
    buffer_load_dwordx4 v17, s[28:31], s43 offen offset:3072 lds
    s_add_u32 s43, s43, s44
    s_xor_b32 s49, s49, 229376
    s_add_u32 m0, s48, 0
    s_nop 0
    buffer_load_dwordx4 v12, s[24:27], s36 offen offset:0 lds
    buffer_load_dwordx4 v13, s[24:27], s36 offen offset:1024 lds
    s_add_u32 s36, s36, 128
    buffer_load_dwordx4 v12, s[24:27], s37 offen offset:2048 lds
    buffer_load_dwordx4 v13, s[24:27], s37 offen offset:3072 lds
    s_add_u32 s37, s37, 128
    s_add_u32 m0, s48, 4096
    s_nop 0
    buffer_load_dwordx4 v12, s[24:27], s38 offen offset:0 lds
    buffer_load_dwordx4 v13, s[24:27], s38 offen offset:1024 lds
    s_add_u32 s38, s38, 128
    buffer_load_dwordx4 v12, s[24:27], s39 offen offset:2048 lds
    buffer_load_dwordx4 v13, s[24:27], s39 offen offset:3072 lds
    s_add_u32 s39, s39, 128
    s_add_u32 s48, s48, 32768
    s_cmp_ge_u32 s48, 98304
    s_cselect_b32 s54, 98304, 0
    s_sub_u32 s48, s48, s54
    s_add_u32 m0, s49, 0
    s_nop 0
    buffer_load_dwordx4 v14, s[28:31], s40 offen offset:0 lds
    buffer_load_dwordx4 v15, s[28:31], s40 offen offset:1024 lds
    s_add_u32 s40, s40, s44
    buffer_load_dwordx4 v14, s[28:31], s41 offen offset:2048 lds
    buffer_load_dwordx4 v15, s[28:31], s41 offen offset:3072 lds
    s_add_u32 s41, s41, s44
    s_add_u32 m0, s49, 4096
    s_nop 0
    buffer_load_dwordx4 v16, s[28:31], s42 offen offset:0 lds
    buffer_load_dwordx4 v17, s[28:31], s42 offen offset:1024 lds
    s_add_u32 s42, s42, s44
    buffer_load_dwordx4 v16, s[28:31], s43 offen offset:2048 lds
    buffer_load_dwordx4 v17, s[28:31], s43 offen offset:3072 lds
    s_add_u32 s43, s43, s44
    s_xor_b32 s49, s49, 229376
    s_waitcnt vmcnt(16)
    s_barrier
    ds_read_b64_tr_b16 a[64:65], v4 offset:0
    ds_read_b64_tr_b16 a[66:67], v4 offset:2048
    ds_read_b128 a[0:3], v2 offset:0
    ds_read_b128 a[4:7], v2 offset:2048
    ds_read_b64_tr_b16 a[68:69], v5 offset:0
    ds_read_b64_tr_b16 a[70:71], v5 offset:2048
    ds_read_b128 a[8:11], v2 offset:4096
    ds_read_b128 a[12:15], v2 offset:6144
    ds_read_b64_tr_b16 a[72:73], v6 offset:0
    ds_read_b64_tr_b16 a[74:75], v6 offset:2048
    ds_read_b128 a[16:19], v2 offset:8192
    ds_read_b128 a[20:23], v2 offset:10240
    ds_read_b64_tr_b16 a[76:77], v7 offset:0
    ds_read_b64_tr_b16 a[78:79], v7 offset:2048
    ds_read_b128 a[24:27], v2 offset:12288
    ds_read_b128 a[28:31], v2 offset:14336
    ds_read_b64_tr_b16 a[80:81], v8 offset:0
    ds_read_b64_tr_b16 a[82:83], v8 offset:2048
    ds_read_b64_tr_b16 a[84:85], v9 offset:0
    ds_read_b64_tr_b16 a[86:87], v9 offset:2048
    ds_read_b64_tr_b16 a[88:89], v10 offset:0
    ds_read_b64_tr_b16 a[90:91], v10 offset:2048
    ds_read_b64_tr_b16 a[92:93], v11 offset:0
    ds_read_b64_tr_b16 a[94:95], v11 offset:2048
    s_mov_b32 s53, 1
gemm1_kernel_tile8:
    s_sub_u32 s52, s74, 1
    s_cmp_eq_u32 s75, 1
    s_cbranch_scc1 gemm1_kernel_swp10
    s_waitcnt lgkmcnt(15)
    v_mfma_f32_16x16x32_bf16 v[32:35], a[64:67], a[0:3], 0
    v_mfma_f32_16x16x32_bf16 v[40:43], a[64:67], a[4:7], 0
    v_mfma_f32_16x16x32_bf16 v[48:51], a[64:67], a[8:11], 0
    v_mfma_f32_16x16x32_bf16 v[56:59], a[64:67], a[12:15], 0
    s_waitcnt lgkmcnt(13)
    v_mfma_f32_16x16x32_bf16 v[64:67], a[64:67], a[16:19], 0
    s_add_u32 m0, s48, 0
    s_nop 0
    buffer_load_dwordx4 v12, s[24:27], s36 offen offset:0 lds
    s_waitcnt lgkmcnt(12)
    v_mfma_f32_16x16x32_bf16 v[72:75], a[64:67], a[20:23], 0
    s_waitcnt lgkmcnt(9)
    v_mfma_f32_16x16x32_bf16 v[80:83], a[64:67], a[24:27], 0
    s_waitcnt lgkmcnt(8)
    v_mfma_f32_16x16x32_bf16 v[88:91], a[64:67], a[28:31], 0
    ds_read_b64_tr_b16 a[64:65], v4 offset:16384
    v_mfma_f32_16x16x32_bf16 v[36:39], a[68:71], a[0:3], 0
    ds_read_b64_tr_b16 a[66:67], v4 offset:18432
    v_mfma_f32_16x16x32_bf16 v[44:47], a[68:71], a[4:7], 0
    v_mfma_f32_16x16x32_bf16 v[52:55], a[68:71], a[8:11], 0
    ds_read_b128 a[32:35], v3 offset:0
    v_mfma_f32_16x16x32_bf16 v[60:63], a[68:71], a[12:15], 0
    buffer_load_dwordx4 v13, s[24:27], s36 offen offset:1024 lds
    s_add_u32 s36, s36, 128
    v_mfma_f32_16x16x32_bf16 v[68:71], a[68:71], a[16:19], 0
    v_mfma_f32_16x16x32_bf16 v[76:79], a[68:71], a[20:23], 0
    v_mfma_f32_16x16x32_bf16 v[84:87], a[68:71], a[24:27], 0
    ds_read_b128 a[36:39], v3 offset:2048
    v_mfma_f32_16x16x32_bf16 v[92:95], a[68:71], a[28:31], 0
    ds_read_b64_tr_b16 a[68:69], v5 offset:16384
    v_mfma_f32_16x16x32_bf16 v[96:99], a[72:75], a[0:3], 0
    ds_read_b64_tr_b16 a[70:71], v5 offset:18432
    v_mfma_f32_16x16x32_bf16 v[104:107], a[72:75], a[4:7], 0
    buffer_load_dwordx4 v12, s[24:27], s37 offen offset:2048 lds
    v_mfma_f32_16x16x32_bf16 v[112:115], a[72:75], a[8:11], 0
    ds_read_b128 a[40:43], v3 offset:4096
    v_mfma_f32_16x16x32_bf16 v[120:123], a[72:75], a[12:15], 0
    v_mfma_f32_16x16x32_bf16 v[128:131], a[72:75], a[16:19], 0
    v_mfma_f32_16x16x32_bf16 v[136:139], a[72:75], a[20:23], 0
    v_mfma_f32_16x16x32_bf16 v[144:147], a[72:75], a[24:27], 0
    ds_read_b128 a[44:47], v3 offset:6144
    v_mfma_f32_16x16x32_bf16 v[152:155], a[72:75], a[28:31], 0
    ds_read_b64_tr_b16 a[72:73], v6 offset:16384
    buffer_load_dwordx4 v13, s[24:27], s37 offen offset:3072 lds
    s_add_u32 s37, s37, 128
    v_mfma_f32_16x16x32_bf16 v[100:103], a[76:79], a[0:3], 0
    ds_read_b64_tr_b16 a[74:75], v6 offset:18432
    v_mfma_f32_16x16x32_bf16 v[108:111], a[76:79], a[4:7], 0
    v_mfma_f32_16x16x32_bf16 v[116:119], a[76:79], a[8:11], 0
    ds_read_b128 a[48:51], v3 offset:8192
    v_mfma_f32_16x16x32_bf16 v[124:127], a[76:79], a[12:15], 0
    v_mfma_f32_16x16x32_bf16 v[132:135], a[76:79], a[16:19], 0
    s_add_u32 m0, s48, 4096
    s_nop 0
    buffer_load_dwordx4 v12, s[24:27], s38 offen offset:0 lds
    v_mfma_f32_16x16x32_bf16 v[140:143], a[76:79], a[20:23], 0
    v_mfma_f32_16x16x32_bf16 v[148:151], a[76:79], a[24:27], 0
    ds_read_b128 a[52:55], v3 offset:10240
    v_mfma_f32_16x16x32_bf16 v[156:159], a[76:79], a[28:31], 0
    ds_read_b64_tr_b16 a[76:77], v7 offset:16384
    s_waitcnt lgkmcnt(15)
    v_mfma_f32_16x16x32_bf16 v[160:163], a[80:83], a[0:3], 0
    ds_read_b64_tr_b16 a[78:79], v7 offset:18432
    v_mfma_f32_16x16x32_bf16 v[168:171], a[80:83], a[4:7], 0
    v_mfma_f32_16x16x32_bf16 v[176:179], a[80:83], a[8:11], 0
    ds_read_b128 a[56:59], v3 offset:12288
    v_mfma_f32_16x16x32_bf16 v[184:187], a[80:83], a[12:15], 0
    buffer_load_dwordx4 v13, s[24:27], s38 offen offset:1024 lds
    s_add_u32 s38, s38, 128
    v_mfma_f32_16x16x32_bf16 v[192:195], a[80:83], a[16:19], 0
    v_mfma_f32_16x16x32_bf16 v[200:203], a[80:83], a[20:23], 0
    v_mfma_f32_16x16x32_bf16 v[208:211], a[80:83], a[24:27], 0
    ds_read_b128 a[60:63], v3 offset:14336
    v_mfma_f32_16x16x32_bf16 v[216:219], a[80:83], a[28:31], 0
    ds_read_b64_tr_b16 a[80:81], v8 offset:16384
    v_mfma_f32_16x16x32_bf16 v[164:167], a[84:87], a[0:3], 0
    ds_read_b64_tr_b16 a[82:83], v8 offset:18432
    v_mfma_f32_16x16x32_bf16 v[172:175], a[84:87], a[4:7], 0
    buffer_load_dwordx4 v12, s[24:27], s39 offen offset:2048 lds
    v_mfma_f32_16x16x32_bf16 v[180:183], a[84:87], a[8:11], 0
    v_mfma_f32_16x16x32_bf16 v[188:191], a[84:87], a[12:15], 0
    v_mfma_f32_16x16x32_bf16 v[196:199], a[84:87], a[16:19], 0
    v_mfma_f32_16x16x32_bf16 v[204:207], a[84:87], a[20:23], 0
    v_mfma_f32_16x16x32_bf16 v[212:215], a[84:87], a[24:27], 0
    buffer_load_dwordx4 v13, s[24:27], s39 offen offset:3072 lds
    s_add_u32 s39, s39, 128
    v_mfma_f32_16x16x32_bf16 v[220:223], a[84:87], a[28:31], 0
    ds_read_b64_tr_b16 a[84:85], v9 offset:16384
    v_mfma_f32_16x16x32_bf16 v[224:227], a[88:91], a[0:3], 0
    ds_read_b64_tr_b16 a[86:87], v9 offset:18432
    v_mfma_f32_16x16x32_bf16 v[232:235], a[88:91], a[4:7], 0
    v_mfma_f32_16x16x32_bf16 v[240:243], a[88:91], a[8:11], 0
    v_mfma_f32_16x16x32_bf16 v[248:251], a[88:91], a[12:15], 0
    v_mfma_f32_16x16x32_bf16 a[96:99], a[88:91], a[16:19], 0
    v_mfma_f32_16x16x32_bf16 a[104:107], a[88:91], a[20:23], 0
    s_add_u32 s48, s48, 32768
    s_cmp_ge_u32 s48, 98304
    s_cselect_b32 s54, 98304, 0
    s_sub_u32 s48, s48, s54
    v_mfma_f32_16x16x32_bf16 a[112:115], a[88:91], a[24:27], 0
    v_mfma_f32_16x16x32_bf16 a[120:123], a[88:91], a[28:31], 0
    ds_read_b64_tr_b16 a[88:89], v10 offset:16384
    s_waitcnt lgkmcnt(15)
    v_mfma_f32_16x16x32_bf16 v[228:231], a[92:95], a[0:3], 0
    ds_read_b64_tr_b16 a[90:91], v10 offset:18432
    v_mfma_f32_16x16x32_bf16 v[236:239], a[92:95], a[4:7], 0
    s_add_u32 s51, s51, 32768
    s_cmp_ge_u32 s51, 98304
    s_cselect_b32 s50, 4294901760, s22
    s_cselect_b32 s51, 0, s51
    v_mfma_f32_16x16x32_bf16 v[244:247], a[92:95], a[8:11], 0
    v_add_u32 v2, s50, v2
    v_mfma_f32_16x16x32_bf16 v[252:255], a[92:95], a[12:15], 0
    v_add_u32 v3, s50, v3
    v_mfma_f32_16x16x32_bf16 a[100:103], a[92:95], a[16:19], 0
    v_mfma_f32_16x16x32_bf16 a[108:111], a[92:95], a[20:23], 0
    v_mfma_f32_16x16x32_bf16 a[116:119], a[92:95], a[24:27], 0
    v_mfma_f32_16x16x32_bf16 a[124:127], a[92:95], a[28:31], 0
    ds_read_b64_tr_b16 a[92:93], v11 offset:16384
    ds_read_b64_tr_b16 a[94:95], v11 offset:18432
    v_mfma_f32_16x16x32_bf16 v[32:35], a[64:67], a[32:35], v[32:35]
    v_xor_b32 v4, s23, v4
    v_mfma_f32_16x16x32_bf16 v[40:43], a[64:67], a[36:39], v[40:43]
    v_xor_b32 v5, s23, v5
    s_waitcnt lgkmcnt(15)
    v_mfma_f32_16x16x32_bf16 v[48:51], a[64:67], a[40:43], v[48:51]
    v_xor_b32 v6, s23, v6
    v_mfma_f32_16x16x32_bf16 v[56:59], a[64:67], a[44:47], v[56:59]
    v_xor_b32 v7, s23, v7
    s_waitcnt lgkmcnt(13)
    v_mfma_f32_16x16x32_bf16 v[64:67], a[64:67], a[48:51], v[64:67]
    v_xor_b32 v8, s23, v8
    s_waitcnt lgkmcnt(12)
    v_mfma_f32_16x16x32_bf16 v[72:75], a[64:67], a[52:55], v[72:75]
    v_xor_b32 v9, s23, v9
    s_waitcnt lgkmcnt(9)
    v_mfma_f32_16x16x32_bf16 v[80:83], a[64:67], a[56:59], v[80:83]
    v_xor_b32 v10, s23, v10
    v_xor_b32 v11, s23, v11
    s_waitcnt lgkmcnt(8)
    s_waitcnt lgkmcnt(0)
    s_waitcnt vmcnt(40)
    s_cmp_eq_u32 s53, 0
    s_cbranch_scc1 gemm1_kernel_w11
    s_waitcnt vmcnt(8)
gemm1_kernel_w11:
    v_mfma_f32_16x16x32_bf16 v[88:91], a[64:67], a[60:63], v[88:91]
    s_barrier
    ds_read_b64_tr_b16 a[64:65], v4 offset:0
    v_mfma_f32_16x16x32_bf16 v[36:39], a[68:71], a[32:35], v[36:39]
    ds_read_b64_tr_b16 a[66:67], v4 offset:2048
    v_mfma_f32_16x16x32_bf16 v[44:47], a[68:71], a[36:39], v[44:47]
    s_add_u32 m0, s49, 0
    s_nop 0
    buffer_load_dwordx4 v14, s[28:31], s40 offen offset:0 lds
    v_mfma_f32_16x16x32_bf16 v[52:55], a[68:71], a[40:43], v[52:55]
    ds_read_b128 a[0:3], v2 offset:0
    v_mfma_f32_16x16x32_bf16 v[60:63], a[68:71], a[44:47], v[60:63]
    v_mfma_f32_16x16x32_bf16 v[68:71], a[68:71], a[48:51], v[68:71]
    v_mfma_f32_16x16x32_bf16 v[76:79], a[68:71], a[52:55], v[76:79]
    buffer_load_dwordx4 v15, s[28:31], s40 offen offset:1024 lds
    s_add_u32 s40, s40, s44
    v_mfma_f32_16x16x32_bf16 v[84:87], a[68:71], a[56:59], v[84:87]
    ds_read_b128 a[4:7], v2 offset:2048
    v_mfma_f32_16x16x32_bf16 v[92:95], a[68:71], a[60:63], v[92:95]
    ds_read_b64_tr_b16 a[68:69], v5 offset:0
    v_mfma_f32_16x16x32_bf16 v[96:99], a[72:75], a[32:35], v[96:99]
    ds_read_b64_tr_b16 a[70:71], v5 offset:2048
    v_mfma_f32_16x16x32_bf16 v[104:107], a[72:75], a[36:39], v[104:107]
    buffer_load_dwordx4 v14, s[28:31], s41 offen offset:2048 lds
    v_mfma_f32_16x16x32_bf16 v[112:115], a[72:75], a[40:43], v[112:115]
    ds_read_b128 a[8:11], v2 offset:4096
    v_mfma_f32_16x16x32_bf16 v[120:123], a[72:75], a[44:47], v[120:123]
    v_mfma_f32_16x16x32_bf16 v[128:131], a[72:75], a[48:51], v[128:131]
    v_mfma_f32_16x16x32_bf16 v[136:139], a[72:75], a[52:55], v[136:139]
    buffer_load_dwordx4 v15, s[28:31], s41 offen offset:3072 lds
    s_add_u32 s41, s41, s44
    v_mfma_f32_16x16x32_bf16 v[144:147], a[72:75], a[56:59], v[144:147]
    ds_read_b128 a[12:15], v2 offset:6144
    v_mfma_f32_16x16x32_bf16 v[152:155], a[72:75], a[60:63], v[152:155]
    ds_read_b64_tr_b16 a[72:73], v6 offset:0
    v_mfma_f32_16x16x32_bf16 v[100:103], a[76:79], a[32:35], v[100:103]
    ds_read_b64_tr_b16 a[74:75], v6 offset:2048
    v_mfma_f32_16x16x32_bf16 v[108:111], a[76:79], a[36:39], v[108:111]
    s_add_u32 m0, s49, 4096
    s_nop 0
    buffer_load_dwordx4 v16, s[28:31], s42 offen offset:0 lds
    v_mfma_f32_16x16x32_bf16 v[116:119], a[76:79], a[40:43], v[116:119]
    ds_read_b128 a[16:19], v2 offset:8192
    v_mfma_f32_16x16x32_bf16 v[124:127], a[76:79], a[44:47], v[124:127]
    v_mfma_f32_16x16x32_bf16 v[132:135], a[76:79], a[48:51], v[132:135]
    v_mfma_f32_16x16x32_bf16 v[140:143], a[76:79], a[52:55], v[140:143]
    buffer_load_dwordx4 v17, s[28:31], s42 offen offset:1024 lds
    s_add_u32 s42, s42, s44
    v_mfma_f32_16x16x32_bf16 v[148:151], a[76:79], a[56:59], v[148:151]
    ds_read_b128 a[20:23], v2 offset:10240
    v_mfma_f32_16x16x32_bf16 v[156:159], a[76:79], a[60:63], v[156:159]
    ds_read_b64_tr_b16 a[76:77], v7 offset:0
    v_mfma_f32_16x16x32_bf16 v[160:163], a[80:83], a[32:35], v[160:163]
    ds_read_b64_tr_b16 a[78:79], v7 offset:2048
    v_mfma_f32_16x16x32_bf16 v[168:171], a[80:83], a[36:39], v[168:171]
    buffer_load_dwordx4 v16, s[28:31], s43 offen offset:2048 lds
    v_mfma_f32_16x16x32_bf16 v[176:179], a[80:83], a[40:43], v[176:179]
    ds_read_b128 a[24:27], v2 offset:12288
    v_mfma_f32_16x16x32_bf16 v[184:187], a[80:83], a[44:47], v[184:187]
    v_mfma_f32_16x16x32_bf16 v[192:195], a[80:83], a[48:51], v[192:195]
    v_mfma_f32_16x16x32_bf16 v[200:203], a[80:83], a[52:55], v[200:203]
    buffer_load_dwordx4 v17, s[28:31], s43 offen offset:3072 lds
    s_add_u32 s43, s43, s44
    v_mfma_f32_16x16x32_bf16 v[208:211], a[80:83], a[56:59], v[208:211]
    ds_read_b128 a[28:31], v2 offset:14336
    v_mfma_f32_16x16x32_bf16 v[216:219], a[80:83], a[60:63], v[216:219]
    ds_read_b64_tr_b16 a[80:81], v8 offset:0
    v_mfma_f32_16x16x32_bf16 v[164:167], a[84:87], a[32:35], v[164:167]
    ds_read_b64_tr_b16 a[82:83], v8 offset:2048
    v_mfma_f32_16x16x32_bf16 v[172:175], a[84:87], a[36:39], v[172:175]
    v_mfma_f32_16x16x32_bf16 v[180:183], a[84:87], a[40:43], v[180:183]
    v_mfma_f32_16x16x32_bf16 v[188:191], a[84:87], a[44:47], v[188:191]
    v_mfma_f32_16x16x32_bf16 v[196:199], a[84:87], a[48:51], v[196:199]
    s_xor_b32 s49, s49, 229376
    v_mfma_f32_16x16x32_bf16 v[204:207], a[84:87], a[52:55], v[204:207]
    v_mfma_f32_16x16x32_bf16 v[212:215], a[84:87], a[56:59], v[212:215]
    v_mfma_f32_16x16x32_bf16 v[220:223], a[84:87], a[60:63], v[220:223]
    ds_read_b64_tr_b16 a[84:85], v9 offset:0
    v_mfma_f32_16x16x32_bf16 v[224:227], a[88:91], a[32:35], v[224:227]
    ds_read_b64_tr_b16 a[86:87], v9 offset:2048
    v_mfma_f32_16x16x32_bf16 v[232:235], a[88:91], a[36:39], v[232:235]
    v_mfma_f32_16x16x32_bf16 v[240:243], a[88:91], a[40:43], v[240:243]
    v_mfma_f32_16x16x32_bf16 v[248:251], a[88:91], a[44:47], v[248:251]
    v_mfma_f32_16x16x32_bf16 a[96:99], a[88:91], a[48:51], a[96:99]
    v_mfma_f32_16x16x32_bf16 a[104:107], a[88:91], a[52:55], a[104:107]
    v_mfma_f32_16x16x32_bf16 a[112:115], a[88:91], a[56:59], a[112:115]
    v_mfma_f32_16x16x32_bf16 a[120:123], a[88:91], a[60:63], a[120:123]
    ds_read_b64_tr_b16 a[88:89], v10 offset:0
    v_mfma_f32_16x16x32_bf16 v[228:231], a[92:95], a[32:35], v[228:231]
    ds_read_b64_tr_b16 a[90:91], v10 offset:2048
    v_mfma_f32_16x16x32_bf16 v[236:239], a[92:95], a[36:39], v[236:239]
    v_mfma_f32_16x16x32_bf16 v[244:247], a[92:95], a[40:43], v[244:247]
    v_mfma_f32_16x16x32_bf16 v[252:255], a[92:95], a[44:47], v[252:255]
    v_mfma_f32_16x16x32_bf16 a[100:103], a[92:95], a[48:51], a[100:103]
    v_mfma_f32_16x16x32_bf16 a[108:111], a[92:95], a[52:55], a[108:111]
    v_mfma_f32_16x16x32_bf16 a[116:119], a[92:95], a[56:59], a[116:119]
    v_mfma_f32_16x16x32_bf16 a[124:127], a[92:95], a[60:63], a[124:127]
    ds_read_b64_tr_b16 a[92:93], v11 offset:0
    ds_read_b64_tr_b16 a[94:95], v11 offset:2048
gemm1_kernel_loop12:
    s_cmp_eq_u32 s52, 2
    s_cbranch_scc1 gemm1_kernel_dosw14
gemm1_kernel_nosw13:
    s_waitcnt lgkmcnt(15)
    v_mfma_f32_16x16x32_bf16 v[32:35], a[64:67], a[0:3], v[32:35]
    v_mfma_f32_16x16x32_bf16 v[40:43], a[64:67], a[4:7], v[40:43]
    v_mfma_f32_16x16x32_bf16 v[48:51], a[64:67], a[8:11], v[48:51]
    v_mfma_f32_16x16x32_bf16 v[56:59], a[64:67], a[12:15], v[56:59]
    s_waitcnt lgkmcnt(13)
    v_mfma_f32_16x16x32_bf16 v[64:67], a[64:67], a[16:19], v[64:67]
    s_add_u32 m0, s48, 0
    s_nop 0
    buffer_load_dwordx4 v12, s[24:27], s36 offen offset:0 lds
    s_waitcnt lgkmcnt(12)
    v_mfma_f32_16x16x32_bf16 v[72:75], a[64:67], a[20:23], v[72:75]
    s_waitcnt lgkmcnt(9)
    v_mfma_f32_16x16x32_bf16 v[80:83], a[64:67], a[24:27], v[80:83]
    s_waitcnt lgkmcnt(8)
    v_mfma_f32_16x16x32_bf16 v[88:91], a[64:67], a[28:31], v[88:91]
    ds_read_b64_tr_b16 a[64:65], v4 offset:16384
    v_mfma_f32_16x16x32_bf16 v[36:39], a[68:71], a[0:3], v[36:39]
    ds_read_b64_tr_b16 a[66:67], v4 offset:18432
    v_mfma_f32_16x16x32_bf16 v[44:47], a[68:71], a[4:7], v[44:47]
    v_mfma_f32_16x16x32_bf16 v[52:55], a[68:71], a[8:11], v[52:55]
    ds_read_b128 a[32:35], v3 offset:0
    v_mfma_f32_16x16x32_bf16 v[60:63], a[68:71], a[12:15], v[60:63]
    buffer_load_dwordx4 v13, s[24:27], s36 offen offset:1024 lds
    s_add_u32 s36, s36, 128
    v_mfma_f32_16x16x32_bf16 v[68:71], a[68:71], a[16:19], v[68:71]
    v_mfma_f32_16x16x32_bf16 v[76:79], a[68:71], a[20:23], v[76:79]
    v_mfma_f32_16x16x32_bf16 v[84:87], a[68:71], a[24:27], v[84:87]
    ds_read_b128 a[36:39], v3 offset:2048
    v_mfma_f32_16x16x32_bf16 v[92:95], a[68:71], a[28:31], v[92:95]
    ds_read_b64_tr_b16 a[68:69], v5 offset:16384
    v_mfma_f32_16x16x32_bf16 v[96:99], a[72:75], a[0:3], v[96:99]
    ds_read_b64_tr_b16 a[70:71], v5 offset:18432
    v_mfma_f32_16x16x32_bf16 v[104:107], a[72:75], a[4:7], v[104:107]
    buffer_load_dwordx4 v12, s[24:27], s37 offen offset:2048 lds
    v_mfma_f32_16x16x32_bf16 v[112:115], a[72:75], a[8:11], v[112:115]
    ds_read_b128 a[40:43], v3 offset:4096
    v_mfma_f32_16x16x32_bf16 v[120:123], a[72:75], a[12:15], v[120:123]
    v_mfma_f32_16x16x32_bf16 v[128:131], a[72:75], a[16:19], v[128:131]
    v_mfma_f32_16x16x32_bf16 v[136:139], a[72:75], a[20:23], v[136:139]
    v_mfma_f32_16x16x32_bf16 v[144:147], a[72:75], a[24:27], v[144:147]
    ds_read_b128 a[44:47], v3 offset:6144
    v_mfma_f32_16x16x32_bf16 v[152:155], a[72:75], a[28:31], v[152:155]
    ds_read_b64_tr_b16 a[72:73], v6 offset:16384
    buffer_load_dwordx4 v13, s[24:27], s37 offen offset:3072 lds
    s_add_u32 s37, s37, 128
    v_mfma_f32_16x16x32_bf16 v[100:103], a[76:79], a[0:3], v[100:103]
    ds_read_b64_tr_b16 a[74:75], v6 offset:18432
    v_mfma_f32_16x16x32_bf16 v[108:111], a[76:79], a[4:7], v[108:111]
    v_mfma_f32_16x16x32_bf16 v[116:119], a[76:79], a[8:11], v[116:119]
    ds_read_b128 a[48:51], v3 offset:8192
    v_mfma_f32_16x16x32_bf16 v[124:127], a[76:79], a[12:15], v[124:127]
    v_mfma_f32_16x16x32_bf16 v[132:135], a[76:79], a[16:19], v[132:135]
    s_add_u32 m0, s48, 4096
    s_nop 0
    buffer_load_dwordx4 v12, s[24:27], s38 offen offset:0 lds
    v_mfma_f32_16x16x32_bf16 v[140:143], a[76:79], a[20:23], v[140:143]
    v_mfma_f32_16x16x32_bf16 v[148:151], a[76:79], a[24:27], v[148:151]
    ds_read_b128 a[52:55], v3 offset:10240
    v_mfma_f32_16x16x32_bf16 v[156:159], a[76:79], a[28:31], v[156:159]
    ds_read_b64_tr_b16 a[76:77], v7 offset:16384
    s_waitcnt lgkmcnt(15)
    v_mfma_f32_16x16x32_bf16 v[160:163], a[80:83], a[0:3], v[160:163]
    ds_read_b64_tr_b16 a[78:79], v7 offset:18432
    v_mfma_f32_16x16x32_bf16 v[168:171], a[80:83], a[4:7], v[168:171]
    v_mfma_f32_16x16x32_bf16 v[176:179], a[80:83], a[8:11], v[176:179]
    ds_read_b128 a[56:59], v3 offset:12288
    v_mfma_f32_16x16x32_bf16 v[184:187], a[80:83], a[12:15], v[184:187]
    buffer_load_dwordx4 v13, s[24:27], s38 offen offset:1024 lds
    s_add_u32 s38, s38, 128
    v_mfma_f32_16x16x32_bf16 v[192:195], a[80:83], a[16:19], v[192:195]
    v_mfma_f32_16x16x32_bf16 v[200:203], a[80:83], a[20:23], v[200:203]
    v_mfma_f32_16x16x32_bf16 v[208:211], a[80:83], a[24:27], v[208:211]
    ds_read_b128 a[60:63], v3 offset:14336
    v_mfma_f32_16x16x32_bf16 v[216:219], a[80:83], a[28:31], v[216:219]
    ds_read_b64_tr_b16 a[80:81], v8 offset:16384
    v_mfma_f32_16x16x32_bf16 v[164:167], a[84:87], a[0:3], v[164:167]
    ds_read_b64_tr_b16 a[82:83], v8 offset:18432
    v_mfma_f32_16x16x32_bf16 v[172:175], a[84:87], a[4:7], v[172:175]
    buffer_load_dwordx4 v12, s[24:27], s39 offen offset:2048 lds
    v_mfma_f32_16x16x32_bf16 v[180:183], a[84:87], a[8:11], v[180:183]
    v_mfma_f32_16x16x32_bf16 v[188:191], a[84:87], a[12:15], v[188:191]
    v_mfma_f32_16x16x32_bf16 v[196:199], a[84:87], a[16:19], v[196:199]
    v_mfma_f32_16x16x32_bf16 v[204:207], a[84:87], a[20:23], v[204:207]
    v_mfma_f32_16x16x32_bf16 v[212:215], a[84:87], a[24:27], v[212:215]
    buffer_load_dwordx4 v13, s[24:27], s39 offen offset:3072 lds
    s_add_u32 s39, s39, 128
    v_mfma_f32_16x16x32_bf16 v[220:223], a[84:87], a[28:31], v[220:223]
    ds_read_b64_tr_b16 a[84:85], v9 offset:16384
    v_mfma_f32_16x16x32_bf16 v[224:227], a[88:91], a[0:3], v[224:227]
    ds_read_b64_tr_b16 a[86:87], v9 offset:18432
    v_mfma_f32_16x16x32_bf16 v[232:235], a[88:91], a[4:7], v[232:235]
    v_mfma_f32_16x16x32_bf16 v[240:243], a[88:91], a[8:11], v[240:243]
    v_mfma_f32_16x16x32_bf16 v[248:251], a[88:91], a[12:15], v[248:251]
    v_mfma_f32_16x16x32_bf16 a[96:99], a[88:91], a[16:19], a[96:99]
    v_mfma_f32_16x16x32_bf16 a[104:107], a[88:91], a[20:23], a[104:107]
    s_add_u32 s48, s48, 32768
    s_cmp_ge_u32 s48, 98304
    s_cselect_b32 s54, 98304, 0
    s_sub_u32 s48, s48, s54
    v_mfma_f32_16x16x32_bf16 a[112:115], a[88:91], a[24:27], a[112:115]
    v_mfma_f32_16x16x32_bf16 a[120:123], a[88:91], a[28:31], a[120:123]
    ds_read_b64_tr_b16 a[88:89], v10 offset:16384
    s_waitcnt lgkmcnt(15)
    v_mfma_f32_16x16x32_bf16 v[228:231], a[92:95], a[0:3], v[228:231]
    ds_read_b64_tr_b16 a[90:91], v10 offset:18432
    v_mfma_f32_16x16x32_bf16 v[236:239], a[92:95], a[4:7], v[236:239]
    s_add_u32 s51, s51, 32768
    s_cmp_ge_u32 s51, 98304
    s_cselect_b32 s50, 4294901760, s22
    s_cselect_b32 s51, 0, s51
    v_mfma_f32_16x16x32_bf16 v[244:247], a[92:95], a[8:11], v[244:247]
    v_add_u32 v2, s50, v2
    v_mfma_f32_16x16x32_bf16 v[252:255], a[92:95], a[12:15], v[252:255]
    v_add_u32 v3, s50, v3
    v_mfma_f32_16x16x32_bf16 a[100:103], a[92:95], a[16:19], a[100:103]
    v_mfma_f32_16x16x32_bf16 a[108:111], a[92:95], a[20:23], a[108:111]
    v_mfma_f32_16x16x32_bf16 a[116:119], a[92:95], a[24:27], a[116:119]
    v_mfma_f32_16x16x32_bf16 a[124:127], a[92:95], a[28:31], a[124:127]
    ds_read_b64_tr_b16 a[92:93], v11 offset:16384
    ds_read_b64_tr_b16 a[94:95], v11 offset:18432
    v_mfma_f32_16x16x32_bf16 v[32:35], a[64:67], a[32:35], v[32:35]
    v_xor_b32 v4, s23, v4
    v_mfma_f32_16x16x32_bf16 v[40:43], a[64:67], a[36:39], v[40:43]
    v_xor_b32 v5, s23, v5
    s_waitcnt lgkmcnt(15)
    v_mfma_f32_16x16x32_bf16 v[48:51], a[64:67], a[40:43], v[48:51]
    v_xor_b32 v6, s23, v6
    v_mfma_f32_16x16x32_bf16 v[56:59], a[64:67], a[44:47], v[56:59]
    v_xor_b32 v7, s23, v7
    s_waitcnt lgkmcnt(13)
    v_mfma_f32_16x16x32_bf16 v[64:67], a[64:67], a[48:51], v[64:67]
    v_xor_b32 v8, s23, v8
    s_waitcnt lgkmcnt(12)
    v_mfma_f32_16x16x32_bf16 v[72:75], a[64:67], a[52:55], v[72:75]
    v_xor_b32 v9, s23, v9
    s_waitcnt lgkmcnt(9)
    v_mfma_f32_16x16x32_bf16 v[80:83], a[64:67], a[56:59], v[80:83]
    v_xor_b32 v10, s23, v10
    v_xor_b32 v11, s23, v11
    s_waitcnt lgkmcnt(8)
    s_waitcnt lgkmcnt(0)
    s_waitcnt vmcnt(8)
    v_mfma_f32_16x16x32_bf16 v[88:91], a[64:67], a[60:63], v[88:91]
    s_barrier
    ds_read_b64_tr_b16 a[64:65], v4 offset:0
    v_mfma_f32_16x16x32_bf16 v[36:39], a[68:71], a[32:35], v[36:39]
    ds_read_b64_tr_b16 a[66:67], v4 offset:2048
    v_mfma_f32_16x16x32_bf16 v[44:47], a[68:71], a[36:39], v[44:47]
    s_add_u32 m0, s49, 0
    s_nop 0
    buffer_load_dwordx4 v14, s[28:31], s40 offen offset:0 lds
    v_mfma_f32_16x16x32_bf16 v[52:55], a[68:71], a[40:43], v[52:55]
    ds_read_b128 a[0:3], v2 offset:0
    v_mfma_f32_16x16x32_bf16 v[60:63], a[68:71], a[44:47], v[60:63]
    v_mfma_f32_16x16x32_bf16 v[68:71], a[68:71], a[48:51], v[68:71]
    v_mfma_f32_16x16x32_bf16 v[76:79], a[68:71], a[52:55], v[76:79]
    buffer_load_dwordx4 v15, s[28:31], s40 offen offset:1024 lds
    s_add_u32 s40, s40, s44
    v_mfma_f32_16x16x32_bf16 v[84:87], a[68:71], a[56:59], v[84:87]
    ds_read_b128 a[4:7], v2 offset:2048
    v_mfma_f32_16x16x32_bf16 v[92:95], a[68:71], a[60:63], v[92:95]
    ds_read_b64_tr_b16 a[68:69], v5 offset:0
    v_mfma_f32_16x16x32_bf16 v[96:99], a[72:75], a[32:35], v[96:99]
    ds_read_b64_tr_b16 a[70:71], v5 offset:2048
    v_mfma_f32_16x16x32_bf16 v[104:107], a[72:75], a[36:39], v[104:107]
    buffer_load_dwordx4 v14, s[28:31], s41 offen offset:2048 lds
    v_mfma_f32_16x16x32_bf16 v[112:115], a[72:75], a[40:43], v[112:115]
    ds_read_b128 a[8:11], v2 offset:4096
    v_mfma_f32_16x16x32_bf16 v[120:123], a[72:75], a[44:47], v[120:123]
    v_mfma_f32_16x16x32_bf16 v[128:131], a[72:75], a[48:51], v[128:131]
    v_mfma_f32_16x16x32_bf16 v[136:139], a[72:75], a[52:55], v[136:139]
    buffer_load_dwordx4 v15, s[28:31], s41 offen offset:3072 lds
    s_add_u32 s41, s41, s44
    v_mfma_f32_16x16x32_bf16 v[144:147], a[72:75], a[56:59], v[144:147]
    ds_read_b128 a[12:15], v2 offset:6144
    v_mfma_f32_16x16x32_bf16 v[152:155], a[72:75], a[60:63], v[152:155]
    ds_read_b64_tr_b16 a[72:73], v6 offset:0
    v_mfma_f32_16x16x32_bf16 v[100:103], a[76:79], a[32:35], v[100:103]
    ds_read_b64_tr_b16 a[74:75], v6 offset:2048
    v_mfma_f32_16x16x32_bf16 v[108:111], a[76:79], a[36:39], v[108:111]
    s_add_u32 m0, s49, 4096
    s_nop 0
    buffer_load_dwordx4 v16, s[28:31], s42 offen offset:0 lds
    v_mfma_f32_16x16x32_bf16 v[116:119], a[76:79], a[40:43], v[116:119]
    ds_read_b128 a[16:19], v2 offset:8192
    v_mfma_f32_16x16x32_bf16 v[124:127], a[76:79], a[44:47], v[124:127]
    v_mfma_f32_16x16x32_bf16 v[132:135], a[76:79], a[48:51], v[132:135]
    v_mfma_f32_16x16x32_bf16 v[140:143], a[76:79], a[52:55], v[140:143]
    buffer_load_dwordx4 v17, s[28:31], s42 offen offset:1024 lds
    s_add_u32 s42, s42, s44
    v_mfma_f32_16x16x32_bf16 v[148:151], a[76:79], a[56:59], v[148:151]
    ds_read_b128 a[20:23], v2 offset:10240
    v_mfma_f32_16x16x32_bf16 v[156:159], a[76:79], a[60:63], v[156:159]
    ds_read_b64_tr_b16 a[76:77], v7 offset:0
    v_mfma_f32_16x16x32_bf16 v[160:163], a[80:83], a[32:35], v[160:163]
    ds_read_b64_tr_b16 a[78:79], v7 offset:2048
    v_mfma_f32_16x16x32_bf16 v[168:171], a[80:83], a[36:39], v[168:171]
    buffer_load_dwordx4 v16, s[28:31], s43 offen offset:2048 lds
    v_mfma_f32_16x16x32_bf16 v[176:179], a[80:83], a[40:43], v[176:179]
    ds_read_b128 a[24:27], v2 offset:12288
    v_mfma_f32_16x16x32_bf16 v[184:187], a[80:83], a[44:47], v[184:187]
    v_mfma_f32_16x16x32_bf16 v[192:195], a[80:83], a[48:51], v[192:195]
    v_mfma_f32_16x16x32_bf16 v[200:203], a[80:83], a[52:55], v[200:203]
    buffer_load_dwordx4 v17, s[28:31], s43 offen offset:3072 lds
    s_add_u32 s43, s43, s44
    v_mfma_f32_16x16x32_bf16 v[208:211], a[80:83], a[56:59], v[208:211]
    ds_read_b128 a[28:31], v2 offset:14336
    v_mfma_f32_16x16x32_bf16 v[216:219], a[80:83], a[60:63], v[216:219]
    ds_read_b64_tr_b16 a[80:81], v8 offset:0
    v_mfma_f32_16x16x32_bf16 v[164:167], a[84:87], a[32:35], v[164:167]
    ds_read_b64_tr_b16 a[82:83], v8 offset:2048
    v_mfma_f32_16x16x32_bf16 v[172:175], a[84:87], a[36:39], v[172:175]
    v_mfma_f32_16x16x32_bf16 v[180:183], a[84:87], a[40:43], v[180:183]
    v_mfma_f32_16x16x32_bf16 v[188:191], a[84:87], a[44:47], v[188:191]
    v_mfma_f32_16x16x32_bf16 v[196:199], a[84:87], a[48:51], v[196:199]
    s_xor_b32 s49, s49, 229376
    v_mfma_f32_16x16x32_bf16 v[204:207], a[84:87], a[52:55], v[204:207]
    v_mfma_f32_16x16x32_bf16 v[212:215], a[84:87], a[56:59], v[212:215]
    v_mfma_f32_16x16x32_bf16 v[220:223], a[84:87], a[60:63], v[220:223]
    ds_read_b64_tr_b16 a[84:85], v9 offset:0
    v_mfma_f32_16x16x32_bf16 v[224:227], a[88:91], a[32:35], v[224:227]
    ds_read_b64_tr_b16 a[86:87], v9 offset:2048
    v_mfma_f32_16x16x32_bf16 v[232:235], a[88:91], a[36:39], v[232:235]
    v_mfma_f32_16x16x32_bf16 v[240:243], a[88:91], a[40:43], v[240:243]
    v_mfma_f32_16x16x32_bf16 v[248:251], a[88:91], a[44:47], v[248:251]
    v_mfma_f32_16x16x32_bf16 a[96:99], a[88:91], a[48:51], a[96:99]
    v_mfma_f32_16x16x32_bf16 a[104:107], a[88:91], a[52:55], a[104:107]
    v_mfma_f32_16x16x32_bf16 a[112:115], a[88:91], a[56:59], a[112:115]
    v_mfma_f32_16x16x32_bf16 a[120:123], a[88:91], a[60:63], a[120:123]
    ds_read_b64_tr_b16 a[88:89], v10 offset:0
    v_mfma_f32_16x16x32_bf16 v[228:231], a[92:95], a[32:35], v[228:231]
    ds_read_b64_tr_b16 a[90:91], v10 offset:2048
    v_mfma_f32_16x16x32_bf16 v[236:239], a[92:95], a[36:39], v[236:239]
    v_mfma_f32_16x16x32_bf16 v[244:247], a[92:95], a[40:43], v[244:247]
    v_mfma_f32_16x16x32_bf16 v[252:255], a[92:95], a[44:47], v[252:255]
    v_mfma_f32_16x16x32_bf16 a[100:103], a[92:95], a[48:51], a[100:103]
    v_mfma_f32_16x16x32_bf16 a[108:111], a[92:95], a[52:55], a[108:111]
    v_mfma_f32_16x16x32_bf16 a[116:119], a[92:95], a[56:59], a[116:119]
    v_mfma_f32_16x16x32_bf16 a[124:127], a[92:95], a[60:63], a[124:127]
    ds_read_b64_tr_b16 a[92:93], v11 offset:0
    ds_read_b64_tr_b16 a[94:95], v11 offset:2048
    s_sub_u32 s52, s52, 1
    s_cmp_lg_u32 s52, 0
    s_cbranch_scc1 gemm1_kernel_loop12
    s_branch gemm1_kernel_epi9
gemm1_kernel_swp10:
    s_waitcnt lgkmcnt(15)
    v_mfma_f32_16x16x32_bf16 v[32:35], a[0:3], a[64:67], 0
    v_mfma_f32_16x16x32_bf16 v[36:39], a[4:7], a[64:67], 0
    v_mfma_f32_16x16x32_bf16 v[96:99], a[8:11], a[64:67], 0
    v_mfma_f32_16x16x32_bf16 v[100:103], a[12:15], a[64:67], 0
    s_waitcnt lgkmcnt(13)
    v_mfma_f32_16x16x32_bf16 v[160:163], a[16:19], a[64:67], 0
    s_add_u32 m0, s48, 0
    s_nop 0
    buffer_load_dwordx4 v12, s[24:27], s36 offen offset:0 lds
    s_waitcnt lgkmcnt(12)
    v_mfma_f32_16x16x32_bf16 v[164:167], a[20:23], a[64:67], 0
    s_waitcnt lgkmcnt(9)
    v_mfma_f32_16x16x32_bf16 v[224:227], a[24:27], a[64:67], 0
    s_waitcnt lgkmcnt(8)
    v_mfma_f32_16x16x32_bf16 v[228:231], a[28:31], a[64:67], 0
    ds_read_b64_tr_b16 a[64:65], v4 offset:16384
    v_mfma_f32_16x16x32_bf16 v[40:43], a[0:3], a[68:71], 0
    ds_read_b64_tr_b16 a[66:67], v4 offset:18432
    v_mfma_f32_16x16x32_bf16 v[44:47], a[4:7], a[68:71], 0
    v_mfma_f32_16x16x32_bf16 v[104:107], a[8:11], a[68:71], 0
    ds_read_b128 a[32:35], v3 offset:0
    v_mfma_f32_16x16x32_bf16 v[108:111], a[12:15], a[68:71], 0
    buffer_load_dwordx4 v13, s[24:27], s36 offen offset:1024 lds
    s_add_u32 s36, s36, 128
    v_mfma_f32_16x16x32_bf16 v[168:171], a[16:19], a[68:71], 0
    v_mfma_f32_16x16x32_bf16 v[172:175], a[20:23], a[68:71], 0
    v_mfma_f32_16x16x32_bf16 v[232:235], a[24:27], a[68:71], 0
    ds_read_b128 a[36:39], v3 offset:2048
    v_mfma_f32_16x16x32_bf16 v[236:239], a[28:31], a[68:71], 0
    ds_read_b64_tr_b16 a[68:69], v5 offset:16384
    v_mfma_f32_16x16x32_bf16 v[48:51], a[0:3], a[72:75], 0
    ds_read_b64_tr_b16 a[70:71], v5 offset:18432
    v_mfma_f32_16x16x32_bf16 v[52:55], a[4:7], a[72:75], 0
    buffer_load_dwordx4 v12, s[24:27], s37 offen offset:2048 lds
    v_mfma_f32_16x16x32_bf16 v[112:115], a[8:11], a[72:75], 0
    ds_read_b128 a[40:43], v3 offset:4096
    v_mfma_f32_16x16x32_bf16 v[116:119], a[12:15], a[72:75], 0
    v_mfma_f32_16x16x32_bf16 v[176:179], a[16:19], a[72:75], 0
    v_mfma_f32_16x16x32_bf16 v[180:183], a[20:23], a[72:75], 0
    v_mfma_f32_16x16x32_bf16 v[240:243], a[24:27], a[72:75], 0
    ds_read_b128 a[44:47], v3 offset:6144
    v_mfma_f32_16x16x32_bf16 v[244:247], a[28:31], a[72:75], 0
    ds_read_b64_tr_b16 a[72:73], v6 offset:16384
    buffer_load_dwordx4 v13, s[24:27], s37 offen offset:3072 lds
    s_add_u32 s37, s37, 128
    v_mfma_f32_16x16x32_bf16 v[56:59], a[0:3], a[76:79], 0
    ds_read_b64_tr_b16 a[74:75], v6 offset:18432
    v_mfma_f32_16x16x32_bf16 v[60:63], a[4:7], a[76:79], 0
    v_mfma_f32_16x16x32_bf16 v[120:123], a[8:11], a[76:79], 0
    ds_read_b128 a[48:51], v3 offset:8192
    v_mfma_f32_16x16x32_bf16 v[124:127], a[12:15], a[76:79], 0
    v_mfma_f32_16x16x32_bf16 v[184:187], a[16:19], a[76:79], 0
    s_add_u32 m0, s48, 4096
    s_nop 0
    buffer_load_dwordx4 v12, s[24:27], s38 offen offset:0 lds
    v_mfma_f32_16x16x32_bf16 v[188:191], a[20:23], a[76:79], 0
    v_mfma_f32_16x16x32_bf16 v[248:251], a[24:27], a[76:79], 0
    ds_read_b128 a[52:55], v3 offset:10240
    v_mfma_f32_16x16x32_bf16 v[252:255], a[28:31], a[76:79], 0
    ds_read_b64_tr_b16 a[76:77], v7 offset:16384
    s_waitcnt lgkmcnt(15)
    v_mfma_f32_16x16x32_bf16 v[64:67], a[0:3], a[80:83], 0
    ds_read_b64_tr_b16 a[78:79], v7 offset:18432
    v_mfma_f32_16x16x32_bf16 v[68:71], a[4:7], a[80:83], 0
    v_mfma_f32_16x16x32_bf16 v[128:131], a[8:11], a[80:83], 0
    ds_read_b128 a[56:59], v3 offset:12288
    v_mfma_f32_16x16x32_bf16 v[132:135], a[12:15], a[80:83], 0
    buffer_load_dwordx4 v13, s[24:27], s38 offen offset:1024 lds
    s_add_u32 s38, s38, 128
    v_mfma_f32_16x16x32_bf16 v[192:195], a[16:19], a[80:83], 0
    v_mfma_f32_16x16x32_bf16 v[196:199], a[20:23], a[80:83], 0
    v_mfma_f32_16x16x32_bf16 a[96:99], a[24:27], a[80:83], 0
    ds_read_b128 a[60:63], v3 offset:14336
    v_mfma_f32_16x16x32_bf16 a[100:103], a[28:31], a[80:83], 0
    ds_read_b64_tr_b16 a[80:81], v8 offset:16384
    v_mfma_f32_16x16x32_bf16 v[72:75], a[0:3], a[84:87], 0
    ds_read_b64_tr_b16 a[82:83], v8 offset:18432
    v_mfma_f32_16x16x32_bf16 v[76:79], a[4:7], a[84:87], 0
    buffer_load_dwordx4 v12, s[24:27], s39 offen offset:2048 lds
    v_mfma_f32_16x16x32_bf16 v[136:139], a[8:11], a[84:87], 0
    v_mfma_f32_16x16x32_bf16 v[140:143], a[12:15], a[84:87], 0
    v_mfma_f32_16x16x32_bf16 v[200:203], a[16:19], a[84:87], 0
    v_mfma_f32_16x16x32_bf16 v[204:207], a[20:23], a[84:87], 0
    v_mfma_f32_16x16x32_bf16 a[104:107], a[24:27], a[84:87], 0
    buffer_load_dwordx4 v13, s[24:27], s39 offen offset:3072 lds
    s_add_u32 s39, s39, 128
    v_mfma_f32_16x16x32_bf16 a[108:111], a[28:31], a[84:87], 0
    ds_read_b64_tr_b16 a[84:85], v9 offset:16384
    v_mfma_f32_16x16x32_bf16 v[80:83], a[0:3], a[88:91], 0
    ds_read_b64_tr_b16 a[86:87], v9 offset:18432
    v_mfma_f32_16x16x32_bf16 v[84:87], a[4:7], a[88:91], 0
    v_mfma_f32_16x16x32_bf16 v[144:147], a[8:11], a[88:91], 0
    v_mfma_f32_16x16x32_bf16 v[148:151], a[12:15], a[88:91], 0
    v_mfma_f32_16x16x32_bf16 v[208:211], a[16:19], a[88:91], 0
    v_mfma_f32_16x16x32_bf16 v[212:215], a[20:23], a[88:91], 0
    s_add_u32 s48, s48, 32768
    s_cmp_ge_u32 s48, 98304
    s_cselect_b32 s54, 98304, 0
    s_sub_u32 s48, s48, s54
    v_mfma_f32_16x16x32_bf16 a[112:115], a[24:27], a[88:91], 0
    v_mfma_f32_16x16x32_bf16 a[116:119], a[28:31], a[88:91], 0
    ds_read_b64_tr_b16 a[88:89], v10 offset:16384
    s_waitcnt lgkmcnt(15)
    v_mfma_f32_16x16x32_bf16 v[88:91], a[0:3], a[92:95], 0
    ds_read_b64_tr_b16 a[90:91], v10 offset:18432
    v_mfma_f32_16x16x32_bf16 v[92:95], a[4:7], a[92:95], 0
    s_add_u32 s51, s51, 32768
    s_cmp_ge_u32 s51, 98304
    s_cselect_b32 s50, 4294901760, s22
    s_cselect_b32 s51, 0, s51
    v_mfma_f32_16x16x32_bf16 v[152:155], a[8:11], a[92:95], 0
    v_add_u32 v2, s50, v2
    v_mfma_f32_16x16x32_bf16 v[156:159], a[12:15], a[92:95], 0
    v_add_u32 v3, s50, v3
    v_mfma_f32_16x16x32_bf16 v[216:219], a[16:19], a[92:95], 0
    v_mfma_f32_16x16x32_bf16 v[220:223], a[20:23], a[92:95], 0
    v_mfma_f32_16x16x32_bf16 a[120:123], a[24:27], a[92:95], 0
    v_mfma_f32_16x16x32_bf16 a[124:127], a[28:31], a[92:95], 0
    ds_read_b64_tr_b16 a[92:93], v11 offset:16384
    ds_read_b64_tr_b16 a[94:95], v11 offset:18432
    v_mfma_f32_16x16x32_bf16 v[32:35], a[32:35], a[64:67], v[32:35]
    v_xor_b32 v4, s23, v4
    v_mfma_f32_16x16x32_bf16 v[36:39], a[36:39], a[64:67], v[36:39]
    v_xor_b32 v5, s23, v5
    s_waitcnt lgkmcnt(15)
    v_mfma_f32_16x16x32_bf16 v[96:99], a[40:43], a[64:67], v[96:99]
    v_xor_b32 v6, s23, v6
    v_mfma_f32_16x16x32_bf16 v[100:103], a[44:47], a[64:67], v[100:103]
    v_xor_b32 v7, s23, v7
    s_waitcnt lgkmcnt(13)
    v_mfma_f32_16x16x32_bf16 v[160:163], a[48:51], a[64:67], v[160:163]
    v_xor_b32 v8, s23, v8
    s_waitcnt lgkmcnt(12)
    v_mfma_f32_16x16x32_bf16 v[164:167], a[52:55], a[64:67], v[164:167]
    v_xor_b32 v9, s23, v9
    s_waitcnt lgkmcnt(9)
    v_mfma_f32_16x16x32_bf16 v[224:227], a[56:59], a[64:67], v[224:227]
    v_xor_b32 v10, s23, v10
    v_xor_b32 v11, s23, v11
    s_waitcnt lgkmcnt(8)
    s_waitcnt lgkmcnt(0)
    s_waitcnt vmcnt(40)
    s_cmp_eq_u32 s53, 0
    s_cbranch_scc1 gemm1_kernel_w15
    s_waitcnt vmcnt(8)
gemm1_kernel_w15:
    v_mfma_f32_16x16x32_bf16 v[228:231], a[60:63], a[64:67], v[228:231]
    s_barrier
    ds_read_b64_tr_b16 a[64:65], v4 offset:0
    v_mfma_f32_16x16x32_bf16 v[40:43], a[32:35], a[68:71], v[40:43]
    ds_read_b64_tr_b16 a[66:67], v4 offset:2048
    v_mfma_f32_16x16x32_bf16 v[44:47], a[36:39], a[68:71], v[44:47]
    s_add_u32 m0, s49, 0
    s_nop 0
    buffer_load_dwordx4 v14, s[28:31], s40 offen offset:0 lds
    v_mfma_f32_16x16x32_bf16 v[104:107], a[40:43], a[68:71], v[104:107]
    ds_read_b128 a[0:3], v2 offset:0
    v_mfma_f32_16x16x32_bf16 v[108:111], a[44:47], a[68:71], v[108:111]
    v_mfma_f32_16x16x32_bf16 v[168:171], a[48:51], a[68:71], v[168:171]
    v_mfma_f32_16x16x32_bf16 v[172:175], a[52:55], a[68:71], v[172:175]
    buffer_load_dwordx4 v15, s[28:31], s40 offen offset:1024 lds
    s_add_u32 s40, s40, s44
    v_mfma_f32_16x16x32_bf16 v[232:235], a[56:59], a[68:71], v[232:235]
    ds_read_b128 a[4:7], v2 offset:2048
    v_mfma_f32_16x16x32_bf16 v[236:239], a[60:63], a[68:71], v[236:239]
    ds_read_b64_tr_b16 a[68:69], v5 offset:0
    v_mfma_f32_16x16x32_bf16 v[48:51], a[32:35], a[72:75], v[48:51]
    ds_read_b64_tr_b16 a[70:71], v5 offset:2048
    v_mfma_f32_16x16x32_bf16 v[52:55], a[36:39], a[72:75], v[52:55]
    buffer_load_dwordx4 v14, s[28:31], s41 offen offset:2048 lds
    v_mfma_f32_16x16x32_bf16 v[112:115], a[40:43], a[72:75], v[112:115]
    ds_read_b128 a[8:11], v2 offset:4096
    v_mfma_f32_16x16x32_bf16 v[116:119], a[44:47], a[72:75], v[116:119]
    v_mfma_f32_16x16x32_bf16 v[176:179], a[48:51], a[72:75], v[176:179]
    v_mfma_f32_16x16x32_bf16 v[180:183], a[52:55], a[72:75], v[180:183]
    buffer_load_dwordx4 v15, s[28:31], s41 offen offset:3072 lds
    s_add_u32 s41, s41, s44
    v_mfma_f32_16x16x32_bf16 v[240:243], a[56:59], a[72:75], v[240:243]
    ds_read_b128 a[12:15], v2 offset:6144
    v_mfma_f32_16x16x32_bf16 v[244:247], a[60:63], a[72:75], v[244:247]
    ds_read_b64_tr_b16 a[72:73], v6 offset:0
    v_mfma_f32_16x16x32_bf16 v[56:59], a[32:35], a[76:79], v[56:59]
    ds_read_b64_tr_b16 a[74:75], v6 offset:2048
    v_mfma_f32_16x16x32_bf16 v[60:63], a[36:39], a[76:79], v[60:63]
    s_add_u32 m0, s49, 4096
    s_nop 0
    buffer_load_dwordx4 v16, s[28:31], s42 offen offset:0 lds
    v_mfma_f32_16x16x32_bf16 v[120:123], a[40:43], a[76:79], v[120:123]
    ds_read_b128 a[16:19], v2 offset:8192
    v_mfma_f32_16x16x32_bf16 v[124:127], a[44:47], a[76:79], v[124:127]
    v_mfma_f32_16x16x32_bf16 v[184:187], a[48:51], a[76:79], v[184:187]
    v_mfma_f32_16x16x32_bf16 v[188:191], a[52:55], a[76:79], v[188:191]
    buffer_load_dwordx4 v17, s[28:31], s42 offen offset:1024 lds
    s_add_u32 s42, s42, s44
    v_mfma_f32_16x16x32_bf16 v[248:251], a[56:59], a[76:79], v[248:251]
    ds_read_b128 a[20:23], v2 offset:10240
    v_mfma_f32_16x16x32_bf16 v[252:255], a[60:63], a[76:79], v[252:255]
    ds_read_b64_tr_b16 a[76:77], v7 offset:0
    v_mfma_f32_16x16x32_bf16 v[64:67], a[32:35], a[80:83], v[64:67]
    ds_read_b64_tr_b16 a[78:79], v7 offset:2048
    v_mfma_f32_16x16x32_bf16 v[68:71], a[36:39], a[80:83], v[68:71]
    buffer_load_dwordx4 v16, s[28:31], s43 offen offset:2048 lds
    v_mfma_f32_16x16x32_bf16 v[128:131], a[40:43], a[80:83], v[128:131]
    ds_read_b128 a[24:27], v2 offset:12288
    v_mfma_f32_16x16x32_bf16 v[132:135], a[44:47], a[80:83], v[132:135]
    v_mfma_f32_16x16x32_bf16 v[192:195], a[48:51], a[80:83], v[192:195]
    v_mfma_f32_16x16x32_bf16 v[196:199], a[52:55], a[80:83], v[196:199]
    buffer_load_dwordx4 v17, s[28:31], s43 offen offset:3072 lds
    s_add_u32 s43, s43, s44
    v_mfma_f32_16x16x32_bf16 a[96:99], a[56:59], a[80:83], a[96:99]
    ds_read_b128 a[28:31], v2 offset:14336
    v_mfma_f32_16x16x32_bf16 a[100:103], a[60:63], a[80:83], a[100:103]
    ds_read_b64_tr_b16 a[80:81], v8 offset:0
    v_mfma_f32_16x16x32_bf16 v[72:75], a[32:35], a[84:87], v[72:75]
    ds_read_b64_tr_b16 a[82:83], v8 offset:2048
    v_mfma_f32_16x16x32_bf16 v[76:79], a[36:39], a[84:87], v[76:79]
    v_mfma_f32_16x16x32_bf16 v[136:139], a[40:43], a[84:87], v[136:139]
    v_mfma_f32_16x16x32_bf16 v[140:143], a[44:47], a[84:87], v[140:143]
    v_mfma_f32_16x16x32_bf16 v[200:203], a[48:51], a[84:87], v[200:203]
    s_xor_b32 s49, s49, 229376
    v_mfma_f32_16x16x32_bf16 v[204:207], a[52:55], a[84:87], v[204:207]
    v_mfma_f32_16x16x32_bf16 a[104:107], a[56:59], a[84:87], a[104:107]
    v_mfma_f32_16x16x32_bf16 a[108:111], a[60:63], a[84:87], a[108:111]
    ds_read_b64_tr_b16 a[84:85], v9 offset:0
    v_mfma_f32_16x16x32_bf16 v[80:83], a[32:35], a[88:91], v[80:83]
    ds_read_b64_tr_b16 a[86:87], v9 offset:2048
    v_mfma_f32_16x16x32_bf16 v[84:87], a[36:39], a[88:91], v[84:87]
    v_mfma_f32_16x16x32_bf16 v[144:147], a[40:43], a[88:91], v[144:147]
    v_mfma_f32_16x16x32_bf16 v[148:151], a[44:47], a[88:91], v[148:151]
    v_mfma_f32_16x16x32_bf16 v[208:211], a[48:51], a[88:91], v[208:211]
    v_mfma_f32_16x16x32_bf16 v[212:215], a[52:55], a[88:91], v[212:215]
    v_mfma_f32_16x16x32_bf16 a[112:115], a[56:59], a[88:91], a[112:115]
    v_mfma_f32_16x16x32_bf16 a[116:119], a[60:63], a[88:91], a[116:119]
    ds_read_b64_tr_b16 a[88:89], v10 offset:0
    v_mfma_f32_16x16x32_bf16 v[88:91], a[32:35], a[92:95], v[88:91]
    ds_read_b64_tr_b16 a[90:91], v10 offset:2048
    v_mfma_f32_16x16x32_bf16 v[92:95], a[36:39], a[92:95], v[92:95]
    v_mfma_f32_16x16x32_bf16 v[152:155], a[40:43], a[92:95], v[152:155]
    v_mfma_f32_16x16x32_bf16 v[156:159], a[44:47], a[92:95], v[156:159]
    v_mfma_f32_16x16x32_bf16 v[216:219], a[48:51], a[92:95], v[216:219]
    v_mfma_f32_16x16x32_bf16 v[220:223], a[52:55], a[92:95], v[220:223]
    v_mfma_f32_16x16x32_bf16 a[120:123], a[56:59], a[92:95], a[120:123]
    v_mfma_f32_16x16x32_bf16 a[124:127], a[60:63], a[92:95], a[124:127]
    ds_read_b64_tr_b16 a[92:93], v11 offset:0
    ds_read_b64_tr_b16 a[94:95], v11 offset:2048
gemm1_kernel_loop16:
    s_cmp_eq_u32 s52, 2
    s_cbranch_scc1 gemm1_kernel_dosw18
gemm1_kernel_nosw17:
    s_waitcnt lgkmcnt(15)
    v_mfma_f32_16x16x32_bf16 v[32:35], a[0:3], a[64:67], v[32:35]
    v_mfma_f32_16x16x32_bf16 v[36:39], a[4:7], a[64:67], v[36:39]
    v_mfma_f32_16x16x32_bf16 v[96:99], a[8:11], a[64:67], v[96:99]
    v_mfma_f32_16x16x32_bf16 v[100:103], a[12:15], a[64:67], v[100:103]
    s_waitcnt lgkmcnt(13)
    v_mfma_f32_16x16x32_bf16 v[160:163], a[16:19], a[64:67], v[160:163]
    s_add_u32 m0, s48, 0
    s_nop 0
    buffer_load_dwordx4 v12, s[24:27], s36 offen offset:0 lds
    s_waitcnt lgkmcnt(12)
    v_mfma_f32_16x16x32_bf16 v[164:167], a[20:23], a[64:67], v[164:167]
    s_waitcnt lgkmcnt(9)
    v_mfma_f32_16x16x32_bf16 v[224:227], a[24:27], a[64:67], v[224:227]
    s_waitcnt lgkmcnt(8)
    v_mfma_f32_16x16x32_bf16 v[228:231], a[28:31], a[64:67], v[228:231]
    ds_read_b64_tr_b16 a[64:65], v4 offset:16384
    v_mfma_f32_16x16x32_bf16 v[40:43], a[0:3], a[68:71], v[40:43]
    ds_read_b64_tr_b16 a[66:67], v4 offset:18432
    v_mfma_f32_16x16x32_bf16 v[44:47], a[4:7], a[68:71], v[44:47]
    v_mfma_f32_16x16x32_bf16 v[104:107], a[8:11], a[68:71], v[104:107]
    ds_read_b128 a[32:35], v3 offset:0
    v_mfma_f32_16x16x32_bf16 v[108:111], a[12:15], a[68:71], v[108:111]
    buffer_load_dwordx4 v13, s[24:27], s36 offen offset:1024 lds
    s_add_u32 s36, s36, 128
    v_mfma_f32_16x16x32_bf16 v[168:171], a[16:19], a[68:71], v[168:171]
    v_mfma_f32_16x16x32_bf16 v[172:175], a[20:23], a[68:71], v[172:175]
    v_mfma_f32_16x16x32_bf16 v[232:235], a[24:27], a[68:71], v[232:235]
    ds_read_b128 a[36:39], v3 offset:2048
    v_mfma_f32_16x16x32_bf16 v[236:239], a[28:31], a[68:71], v[236:239]
    ds_read_b64_tr_b16 a[68:69], v5 offset:16384
    v_mfma_f32_16x16x32_bf16 v[48:51], a[0:3], a[72:75], v[48:51]
    ds_read_b64_tr_b16 a[70:71], v5 offset:18432
    v_mfma_f32_16x16x32_bf16 v[52:55], a[4:7], a[72:75], v[52:55]
    buffer_load_dwordx4 v12, s[24:27], s37 offen offset:2048 lds
    v_mfma_f32_16x16x32_bf16 v[112:115], a[8:11], a[72:75], v[112:115]
    ds_read_b128 a[40:43], v3 offset:4096
    v_mfma_f32_16x16x32_bf16 v[116:119], a[12:15], a[72:75], v[116:119]
    v_mfma_f32_16x16x32_bf16 v[176:179], a[16:19], a[72:75], v[176:179]
    v_mfma_f32_16x16x32_bf16 v[180:183], a[20:23], a[72:75], v[180:183]
    v_mfma_f32_16x16x32_bf16 v[240:243], a[24:27], a[72:75], v[240:243]
    ds_read_b128 a[44:47], v3 offset:6144
    v_mfma_f32_16x16x32_bf16 v[244:247], a[28:31], a[72:75], v[244:247]
    ds_read_b64_tr_b16 a[72:73], v6 offset:16384
    buffer_load_dwordx4 v13, s[24:27], s37 offen offset:3072 lds
    s_add_u32 s37, s37, 128
    v_mfma_f32_16x16x32_bf16 v[56:59], a[0:3], a[76:79], v[56:59]
    ds_read_b64_tr_b16 a[74:75], v6 offset:18432
    v_mfma_f32_16x16x32_bf16 v[60:63], a[4:7], a[76:79], v[60:63]
    v_mfma_f32_16x16x32_bf16 v[120:123], a[8:11], a[76:79], v[120:123]
    ds_read_b128 a[48:51], v3 offset:8192
    v_mfma_f32_16x16x32_bf16 v[124:127], a[12:15], a[76:79], v[124:127]
    v_mfma_f32_16x16x32_bf16 v[184:187], a[16:19], a[76:79], v[184:187]
    s_add_u32 m0, s48, 4096
    s_nop 0
    buffer_load_dwordx4 v12, s[24:27], s38 offen offset:0 lds
    v_mfma_f32_16x16x32_bf16 v[188:191], a[20:23], a[76:79], v[188:191]
    v_mfma_f32_16x16x32_bf16 v[248:251], a[24:27], a[76:79], v[248:251]
    ds_read_b128 a[52:55], v3 offset:10240
    v_mfma_f32_16x16x32_bf16 v[252:255], a[28:31], a[76:79], v[252:255]
    ds_read_b64_tr_b16 a[76:77], v7 offset:16384
    s_waitcnt lgkmcnt(15)
    v_mfma_f32_16x16x32_bf16 v[64:67], a[0:3], a[80:83], v[64:67]
    ds_read_b64_tr_b16 a[78:79], v7 offset:18432
    v_mfma_f32_16x16x32_bf16 v[68:71], a[4:7], a[80:83], v[68:71]
    v_mfma_f32_16x16x32_bf16 v[128:131], a[8:11], a[80:83], v[128:131]
    ds_read_b128 a[56:59], v3 offset:12288
    v_mfma_f32_16x16x32_bf16 v[132:135], a[12:15], a[80:83], v[132:135]
    buffer_load_dwordx4 v13, s[24:27], s38 offen offset:1024 lds
    s_add_u32 s38, s38, 128
    v_mfma_f32_16x16x32_bf16 v[192:195], a[16:19], a[80:83], v[192:195]
    v_mfma_f32_16x16x32_bf16 v[196:199], a[20:23], a[80:83], v[196:199]
    v_mfma_f32_16x16x32_bf16 a[96:99], a[24:27], a[80:83], a[96:99]
    ds_read_b128 a[60:63], v3 offset:14336
    v_mfma_f32_16x16x32_bf16 a[100:103], a[28:31], a[80:83], a[100:103]
    ds_read_b64_tr_b16 a[80:81], v8 offset:16384
    v_mfma_f32_16x16x32_bf16 v[72:75], a[0:3], a[84:87], v[72:75]
    ds_read_b64_tr_b16 a[82:83], v8 offset:18432
    v_mfma_f32_16x16x32_bf16 v[76:79], a[4:7], a[84:87], v[76:79]
    buffer_load_dwordx4 v12, s[24:27], s39 offen offset:2048 lds
    v_mfma_f32_16x16x32_bf16 v[136:139], a[8:11], a[84:87], v[136:139]
    v_mfma_f32_16x16x32_bf16 v[140:143], a[12:15], a[84:87], v[140:143]
    v_mfma_f32_16x16x32_bf16 v[200:203], a[16:19], a[84:87], v[200:203]
    v_mfma_f32_16x16x32_bf16 v[204:207], a[20:23], a[84:87], v[204:207]
    v_mfma_f32_16x16x32_bf16 a[104:107], a[24:27], a[84:87], a[104:107]
    buffer_load_dwordx4 v13, s[24:27], s39 offen offset:3072 lds
    s_add_u32 s39, s39, 128
    v_mfma_f32_16x16x32_bf16 a[108:111], a[28:31], a[84:87], a[108:111]
    ds_read_b64_tr_b16 a[84:85], v9 offset:16384
    v_mfma_f32_16x16x32_bf16 v[80:83], a[0:3], a[88:91], v[80:83]
    ds_read_b64_tr_b16 a[86:87], v9 offset:18432
    v_mfma_f32_16x16x32_bf16 v[84:87], a[4:7], a[88:91], v[84:87]
    v_mfma_f32_16x16x32_bf16 v[144:147], a[8:11], a[88:91], v[144:147]
    v_mfma_f32_16x16x32_bf16 v[148:151], a[12:15], a[88:91], v[148:151]
    v_mfma_f32_16x16x32_bf16 v[208:211], a[16:19], a[88:91], v[208:211]
    v_mfma_f32_16x16x32_bf16 v[212:215], a[20:23], a[88:91], v[212:215]
    s_add_u32 s48, s48, 32768
    s_cmp_ge_u32 s48, 98304
    s_cselect_b32 s54, 98304, 0
    s_sub_u32 s48, s48, s54
    v_mfma_f32_16x16x32_bf16 a[112:115], a[24:27], a[88:91], a[112:115]
    v_mfma_f32_16x16x32_bf16 a[116:119], a[28:31], a[88:91], a[116:119]
    ds_read_b64_tr_b16 a[88:89], v10 offset:16384
    s_waitcnt lgkmcnt(15)
    v_mfma_f32_16x16x32_bf16 v[88:91], a[0:3], a[92:95], v[88:91]
    ds_read_b64_tr_b16 a[90:91], v10 offset:18432
    v_mfma_f32_16x16x32_bf16 v[92:95], a[4:7], a[92:95], v[92:95]
    s_add_u32 s51, s51, 32768
    s_cmp_ge_u32 s51, 98304
    s_cselect_b32 s50, 4294901760, s22
    s_cselect_b32 s51, 0, s51
    v_mfma_f32_16x16x32_bf16 v[152:155], a[8:11], a[92:95], v[152:155]
    v_add_u32 v2, s50, v2
    v_mfma_f32_16x16x32_bf16 v[156:159], a[12:15], a[92:95], v[156:159]
    v_add_u32 v3, s50, v3
    v_mfma_f32_16x16x32_bf16 v[216:219], a[16:19], a[92:95], v[216:219]
    v_mfma_f32_16x16x32_bf16 v[220:223], a[20:23], a[92:95], v[220:223]
    v_mfma_f32_16x16x32_bf16 a[120:123], a[24:27], a[92:95], a[120:123]
    v_mfma_f32_16x16x32_bf16 a[124:127], a[28:31], a[92:95], a[124:127]
    ds_read_b64_tr_b16 a[92:93], v11 offset:16384
    ds_read_b64_tr_b16 a[94:95], v11 offset:18432
    v_mfma_f32_16x16x32_bf16 v[32:35], a[32:35], a[64:67], v[32:35]
    v_xor_b32 v4, s23, v4
    v_mfma_f32_16x16x32_bf16 v[36:39], a[36:39], a[64:67], v[36:39]
    v_xor_b32 v5, s23, v5
    s_waitcnt lgkmcnt(15)
    v_mfma_f32_16x16x32_bf16 v[96:99], a[40:43], a[64:67], v[96:99]
    v_xor_b32 v6, s23, v6
    v_mfma_f32_16x16x32_bf16 v[100:103], a[44:47], a[64:67], v[100:103]
    v_xor_b32 v7, s23, v7
    s_waitcnt lgkmcnt(13)
    v_mfma_f32_16x16x32_bf16 v[160:163], a[48:51], a[64:67], v[160:163]
    v_xor_b32 v8, s23, v8
    s_waitcnt lgkmcnt(12)
    v_mfma_f32_16x16x32_bf16 v[164:167], a[52:55], a[64:67], v[164:167]
    v_xor_b32 v9, s23, v9
    s_waitcnt lgkmcnt(9)
    v_mfma_f32_16x16x32_bf16 v[224:227], a[56:59], a[64:67], v[224:227]
    v_xor_b32 v10, s23, v10
    v_xor_b32 v11, s23, v11
    s_waitcnt lgkmcnt(8)
    s_waitcnt lgkmcnt(0)
    s_waitcnt vmcnt(8)
    v_mfma_f32_16x16x32_bf16 v[228:231], a[60:63], a[64:67], v[228:231]
    s_barrier
    ds_read_b64_tr_b16 a[64:65], v4 offset:0
    v_mfma_f32_16x16x32_bf16 v[40:43], a[32:35], a[68:71], v[40:43]
    ds_read_b64_tr_b16 a[66:67], v4 offset:2048
    v_mfma_f32_16x16x32_bf16 v[44:47], a[36:39], a[68:71], v[44:47]
    s_add_u32 m0, s49, 0
    s_nop 0
    buffer_load_dwordx4 v14, s[28:31], s40 offen offset:0 lds
    v_mfma_f32_16x16x32_bf16 v[104:107], a[40:43], a[68:71], v[104:107]
    ds_read_b128 a[0:3], v2 offset:0
    v_mfma_f32_16x16x32_bf16 v[108:111], a[44:47], a[68:71], v[108:111]
    v_mfma_f32_16x16x32_bf16 v[168:171], a[48:51], a[68:71], v[168:171]
    v_mfma_f32_16x16x32_bf16 v[172:175], a[52:55], a[68:71], v[172:175]
    buffer_load_dwordx4 v15, s[28:31], s40 offen offset:1024 lds
    s_add_u32 s40, s40, s44
    v_mfma_f32_16x16x32_bf16 v[232:235], a[56:59], a[68:71], v[232:235]
    ds_read_b128 a[4:7], v2 offset:2048
    v_mfma_f32_16x16x32_bf16 v[236:239], a[60:63], a[68:71], v[236:239]
    ds_read_b64_tr_b16 a[68:69], v5 offset:0
    v_mfma_f32_16x16x32_bf16 v[48:51], a[32:35], a[72:75], v[48:51]
    ds_read_b64_tr_b16 a[70:71], v5 offset:2048
    v_mfma_f32_16x16x32_bf16 v[52:55], a[36:39], a[72:75], v[52:55]
    buffer_load_dwordx4 v14, s[28:31], s41 offen offset:2048 lds
    v_mfma_f32_16x16x32_bf16 v[112:115], a[40:43], a[72:75], v[112:115]
    ds_read_b128 a[8:11], v2 offset:4096
    v_mfma_f32_16x16x32_bf16 v[116:119], a[44:47], a[72:75], v[116:119]
    v_mfma_f32_16x16x32_bf16 v[176:179], a[48:51], a[72:75], v[176:179]
    v_mfma_f32_16x16x32_bf16 v[180:183], a[52:55], a[72:75], v[180:183]
    buffer_load_dwordx4 v15, s[28:31], s41 offen offset:3072 lds
    s_add_u32 s41, s41, s44
    v_mfma_f32_16x16x32_bf16 v[240:243], a[56:59], a[72:75], v[240:243]
    ds_read_b128 a[12:15], v2 offset:6144
    v_mfma_f32_16x16x32_bf16 v[244:247], a[60:63], a[72:75], v[244:247]
    ds_read_b64_tr_b16 a[72:73], v6 offset:0
    v_mfma_f32_16x16x32_bf16 v[56:59], a[32:35], a[76:79], v[56:59]
    ds_read_b64_tr_b16 a[74:75], v6 offset:2048
    v_mfma_f32_16x16x32_bf16 v[60:63], a[36:39], a[76:79], v[60:63]
    s_add_u32 m0, s49, 4096
    s_nop 0
    buffer_load_dwordx4 v16, s[28:31], s42 offen offset:0 lds
    v_mfma_f32_16x16x32_bf16 v[120:123], a[40:43], a[76:79], v[120:123]
    ds_read_b128 a[16:19], v2 offset:8192
    v_mfma_f32_16x16x32_bf16 v[124:127], a[44:47], a[76:79], v[124:127]
    v_mfma_f32_16x16x32_bf16 v[184:187], a[48:51], a[76:79], v[184:187]
    v_mfma_f32_16x16x32_bf16 v[188:191], a[52:55], a[76:79], v[188:191]
    buffer_load_dwordx4 v17, s[28:31], s42 offen offset:1024 lds
    s_add_u32 s42, s42, s44
    v_mfma_f32_16x16x32_bf16 v[248:251], a[56:59], a[76:79], v[248:251]
    ds_read_b128 a[20:23], v2 offset:10240
    v_mfma_f32_16x16x32_bf16 v[252:255], a[60:63], a[76:79], v[252:255]
    ds_read_b64_tr_b16 a[76:77], v7 offset:0
    v_mfma_f32_16x16x32_bf16 v[64:67], a[32:35], a[80:83], v[64:67]
    ds_read_b64_tr_b16 a[78:79], v7 offset:2048
    v_mfma_f32_16x16x32_bf16 v[68:71], a[36:39], a[80:83], v[68:71]
    buffer_load_dwordx4 v16, s[28:31], s43 offen offset:2048 lds
    v_mfma_f32_16x16x32_bf16 v[128:131], a[40:43], a[80:83], v[128:131]
    ds_read_b128 a[24:27], v2 offset:12288
    v_mfma_f32_16x16x32_bf16 v[132:135], a[44:47], a[80:83], v[132:135]
    v_mfma_f32_16x16x32_bf16 v[192:195], a[48:51], a[80:83], v[192:195]
    v_mfma_f32_16x16x32_bf16 v[196:199], a[52:55], a[80:83], v[196:199]
    buffer_load_dwordx4 v17, s[28:31], s43 offen offset:3072 lds
    s_add_u32 s43, s43, s44
    v_mfma_f32_16x16x32_bf16 a[96:99], a[56:59], a[80:83], a[96:99]
    ds_read_b128 a[28:31], v2 offset:14336
    v_mfma_f32_16x16x32_bf16 a[100:103], a[60:63], a[80:83], a[100:103]
    ds_read_b64_tr_b16 a[80:81], v8 offset:0
    v_mfma_f32_16x16x32_bf16 v[72:75], a[32:35], a[84:87], v[72:75]
    ds_read_b64_tr_b16 a[82:83], v8 offset:2048
    v_mfma_f32_16x16x32_bf16 v[76:79], a[36:39], a[84:87], v[76:79]
    v_mfma_f32_16x16x32_bf16 v[136:139], a[40:43], a[84:87], v[136:139]
    v_mfma_f32_16x16x32_bf16 v[140:143], a[44:47], a[84:87], v[140:143]
    v_mfma_f32_16x16x32_bf16 v[200:203], a[48:51], a[84:87], v[200:203]
    s_xor_b32 s49, s49, 229376
    v_mfma_f32_16x16x32_bf16 v[204:207], a[52:55], a[84:87], v[204:207]
    v_mfma_f32_16x16x32_bf16 a[104:107], a[56:59], a[84:87], a[104:107]
    v_mfma_f32_16x16x32_bf16 a[108:111], a[60:63], a[84:87], a[108:111]
    ds_read_b64_tr_b16 a[84:85], v9 offset:0
    v_mfma_f32_16x16x32_bf16 v[80:83], a[32:35], a[88:91], v[80:83]
    ds_read_b64_tr_b16 a[86:87], v9 offset:2048
    v_mfma_f32_16x16x32_bf16 v[84:87], a[36:39], a[88:91], v[84:87]
    v_mfma_f32_16x16x32_bf16 v[144:147], a[40:43], a[88:91], v[144:147]
    v_mfma_f32_16x16x32_bf16 v[148:151], a[44:47], a[88:91], v[148:151]
    v_mfma_f32_16x16x32_bf16 v[208:211], a[48:51], a[88:91], v[208:211]
    v_mfma_f32_16x16x32_bf16 v[212:215], a[52:55], a[88:91], v[212:215]
    v_mfma_f32_16x16x32_bf16 a[112:115], a[56:59], a[88:91], a[112:115]
    v_mfma_f32_16x16x32_bf16 a[116:119], a[60:63], a[88:91], a[116:119]
    ds_read_b64_tr_b16 a[88:89], v10 offset:0
    v_mfma_f32_16x16x32_bf16 v[88:91], a[32:35], a[92:95], v[88:91]
    ds_read_b64_tr_b16 a[90:91], v10 offset:2048
    v_mfma_f32_16x16x32_bf16 v[92:95], a[36:39], a[92:95], v[92:95]
    v_mfma_f32_16x16x32_bf16 v[152:155], a[40:43], a[92:95], v[152:155]
    v_mfma_f32_16x16x32_bf16 v[156:159], a[44:47], a[92:95], v[156:159]
    v_mfma_f32_16x16x32_bf16 v[216:219], a[48:51], a[92:95], v[216:219]
    v_mfma_f32_16x16x32_bf16 v[220:223], a[52:55], a[92:95], v[220:223]
    v_mfma_f32_16x16x32_bf16 a[120:123], a[56:59], a[92:95], a[120:123]
    v_mfma_f32_16x16x32_bf16 a[124:127], a[60:63], a[92:95], a[124:127]
    ds_read_b64_tr_b16 a[92:93], v11 offset:0
    ds_read_b64_tr_b16 a[94:95], v11 offset:2048
    s_sub_u32 s52, s52, 1
    s_cmp_lg_u32 s52, 0
    s_cbranch_scc1 gemm1_kernel_loop16
gemm1_kernel_epi9:
    s_nop 7
    s_cmp_eq_u32 s76, 0
    s_cbranch_scc1 gemm1_kernel_noscale19
    s_mov_b32 s55, s77
    s_mov_b32 s56, s55
    v_mul_f32 v32, s76, v32
    v_mul_f32 v33, s76, v33
    v_mul_f32 v34, s76, v34
    v_mul_f32 v35, s76, v35
    v_mul_f32 v36, s76, v36
    v_mul_f32 v37, s76, v37
    v_mul_f32 v38, s76, v38
    v_mul_f32 v39, s76, v39
    v_cvt_pk_bf16_f32 v32, v32, v33
    v_cvt_pk_bf16_f32 v33, v34, v35
    v_cvt_pk_bf16_f32 v34, v36, v37
    v_cvt_pk_bf16_f32 v35, v38, v39
    buffer_store_dwordx4 v[32:35], v18, s[32:35], s56 offen
    s_add_u32 s56, s56, s79
    v_mul_f32 v40, s76, v40
    v_mul_f32 v41, s76, v41
    v_mul_f32 v42, s76, v42
    v_mul_f32 v43, s76, v43
    v_mul_f32 v44, s76, v44
    v_mul_f32 v45, s76, v45
    v_mul_f32 v46, s76, v46
    v_mul_f32 v47, s76, v47
    v_cvt_pk_bf16_f32 v40, v40, v41
    v_cvt_pk_bf16_f32 v41, v42, v43
    v_cvt_pk_bf16_f32 v42, v44, v45
    v_cvt_pk_bf16_f32 v43, v46, v47
    buffer_store_dwordx4 v[40:43], v18, s[32:35], s56 offen
    s_add_u32 s56, s56, s79
    v_mul_f32 v48, s76, v48
    v_mul_f32 v49, s76, v49
    v_mul_f32 v50, s76, v50
    v_mul_f32 v51, s76, v51
    v_mul_f32 v52, s76, v52
    v_mul_f32 v53, s76, v53
    v_mul_f32 v54, s76, v54
    v_mul_f32 v55, s76, v55
    v_cvt_pk_bf16_f32 v48, v48, v49
    v_cvt_pk_bf16_f32 v49, v50, v51
    v_cvt_pk_bf16_f32 v50, v52, v53
    v_cvt_pk_bf16_f32 v51, v54, v55
    buffer_store_dwordx4 v[48:51], v18, s[32:35], s56 offen
    s_add_u32 s56, s56, s79
    v_mul_f32 v56, s76, v56
    v_mul_f32 v57, s76, v57
    v_mul_f32 v58, s76, v58
    v_mul_f32 v59, s76, v59
    v_mul_f32 v60, s76, v60
    v_mul_f32 v61, s76, v61
    v_mul_f32 v62, s76, v62
    v_mul_f32 v63, s76, v63
    v_cvt_pk_bf16_f32 v56, v56, v57
    v_cvt_pk_bf16_f32 v57, v58, v59
    v_cvt_pk_bf16_f32 v58, v60, v61
    v_cvt_pk_bf16_f32 v59, v62, v63
    buffer_store_dwordx4 v[56:59], v18, s[32:35], s56 offen
    s_add_u32 s56, s56, s79
    v_mul_f32 v64, s76, v64
    v_mul_f32 v65, s76, v65
    v_mul_f32 v66, s76, v66
    v_mul_f32 v67, s76, v67
    v_mul_f32 v68, s76, v68
    v_mul_f32 v69, s76, v69
    v_mul_f32 v70, s76, v70
    v_mul_f32 v71, s76, v71
    v_cvt_pk_bf16_f32 v64, v64, v65
    v_cvt_pk_bf16_f32 v65, v66, v67
    v_cvt_pk_bf16_f32 v66, v68, v69
    v_cvt_pk_bf16_f32 v67, v70, v71
    buffer_store_dwordx4 v[64:67], v18, s[32:35], s56 offen
    s_add_u32 s56, s56, s79
    v_mul_f32 v72, s76, v72
    v_mul_f32 v73, s76, v73
    v_mul_f32 v74, s76, v74
    v_mul_f32 v75, s76, v75
    v_mul_f32 v76, s76, v76
    v_mul_f32 v77, s76, v77
    v_mul_f32 v78, s76, v78
    v_mul_f32 v79, s76, v79
    v_cvt_pk_bf16_f32 v72, v72, v73
    v_cvt_pk_bf16_f32 v73, v74, v75
    v_cvt_pk_bf16_f32 v74, v76, v77
    v_cvt_pk_bf16_f32 v75, v78, v79
    buffer_store_dwordx4 v[72:75], v18, s[32:35], s56 offen
    s_add_u32 s56, s56, s79
    v_mul_f32 v80, s76, v80
    v_mul_f32 v81, s76, v81
    v_mul_f32 v82, s76, v82
    v_mul_f32 v83, s76, v83
    v_mul_f32 v84, s76, v84
    v_mul_f32 v85, s76, v85
    v_mul_f32 v86, s76, v86
    v_mul_f32 v87, s76, v87
    v_cvt_pk_bf16_f32 v80, v80, v81
    v_cvt_pk_bf16_f32 v81, v82, v83
    v_cvt_pk_bf16_f32 v82, v84, v85
    v_cvt_pk_bf16_f32 v83, v86, v87
    buffer_store_dwordx4 v[80:83], v18, s[32:35], s56 offen
    s_add_u32 s56, s56, s79
    v_mul_f32 v88, s76, v88
    v_mul_f32 v89, s76, v89
    v_mul_f32 v90, s76, v90
    v_mul_f32 v91, s76, v91
    v_mul_f32 v92, s76, v92
    v_mul_f32 v93, s76, v93
    v_mul_f32 v94, s76, v94
    v_mul_f32 v95, s76, v95
    v_cvt_pk_bf16_f32 v88, v88, v89
    v_cvt_pk_bf16_f32 v89, v90, v91
    v_cvt_pk_bf16_f32 v90, v92, v93
    v_cvt_pk_bf16_f32 v91, v94, v95
    buffer_store_dwordx4 v[88:91], v18, s[32:35], s56 offen
    s_add_u32 s56, s56, s79
    s_add_u32 s55, s55, s78
    s_mov_b32 s56, s55
    v_mul_f32 v96, s76, v96
    v_mul_f32 v97, s76, v97
    v_mul_f32 v98, s76, v98
    v_mul_f32 v99, s76, v99
    v_mul_f32 v100, s76, v100
    v_mul_f32 v101, s76, v101
    v_mul_f32 v102, s76, v102
    v_mul_f32 v103, s76, v103
    v_cvt_pk_bf16_f32 v96, v96, v97
    v_cvt_pk_bf16_f32 v97, v98, v99
    v_cvt_pk_bf16_f32 v98, v100, v101
    v_cvt_pk_bf16_f32 v99, v102, v103
    buffer_store_dwordx4 v[96:99], v18, s[32:35], s56 offen
    s_add_u32 s56, s56, s79
    v_mul_f32 v104, s76, v104
    v_mul_f32 v105, s76, v105
    v_mul_f32 v106, s76, v106
    v_mul_f32 v107, s76, v107
    v_mul_f32 v108, s76, v108
    v_mul_f32 v109, s76, v109
    v_mul_f32 v110, s76, v110
    v_mul_f32 v111, s76, v111
    v_cvt_pk_bf16_f32 v104, v104, v105
    v_cvt_pk_bf16_f32 v105, v106, v107
    v_cvt_pk_bf16_f32 v106, v108, v109
    v_cvt_pk_bf16_f32 v107, v110, v111
    buffer_store_dwordx4 v[104:107], v18, s[32:35], s56 offen
    s_add_u32 s56, s56, s79
    v_mul_f32 v112, s76, v112
    v_mul_f32 v113, s76, v113
    v_mul_f32 v114, s76, v114
    v_mul_f32 v115, s76, v115
    v_mul_f32 v116, s76, v116
    v_mul_f32 v117, s76, v117
    v_mul_f32 v118, s76, v118
    v_mul_f32 v119, s76, v119
    v_cvt_pk_bf16_f32 v112, v112, v113
    v_cvt_pk_bf16_f32 v113, v114, v115
    v_cvt_pk_bf16_f32 v114, v116, v117
    v_cvt_pk_bf16_f32 v115, v118, v119
    buffer_store_dwordx4 v[112:115], v18, s[32:35], s56 offen
    s_add_u32 s56, s56, s79
    v_mul_f32 v120, s76, v120
    v_mul_f32 v121, s76, v121
    v_mul_f32 v122, s76, v122
    v_mul_f32 v123, s76, v123
    v_mul_f32 v124, s76, v124
    v_mul_f32 v125, s76, v125
    v_mul_f32 v126, s76, v126
    v_mul_f32 v127, s76, v127
    v_cvt_pk_bf16_f32 v120, v120, v121
    v_cvt_pk_bf16_f32 v121, v122, v123
    v_cvt_pk_bf16_f32 v122, v124, v125
    v_cvt_pk_bf16_f32 v123, v126, v127
    buffer_store_dwordx4 v[120:123], v18, s[32:35], s56 offen
    s_add_u32 s56, s56, s79
    v_mul_f32 v128, s76, v128
    v_mul_f32 v129, s76, v129
    v_mul_f32 v130, s76, v130
    v_mul_f32 v131, s76, v131
    v_mul_f32 v132, s76, v132
    v_mul_f32 v133, s76, v133
    v_mul_f32 v134, s76, v134
    v_mul_f32 v135, s76, v135
    v_cvt_pk_bf16_f32 v128, v128, v129
    v_cvt_pk_bf16_f32 v129, v130, v131
    v_cvt_pk_bf16_f32 v130, v132, v133
    v_cvt_pk_bf16_f32 v131, v134, v135
    buffer_store_dwordx4 v[128:131], v18, s[32:35], s56 offen
    s_add_u32 s56, s56, s79
    v_mul_f32 v136, s76, v136
    v_mul_f32 v137, s76, v137
    v_mul_f32 v138, s76, v138
    v_mul_f32 v139, s76, v139
    v_mul_f32 v140, s76, v140
    v_mul_f32 v141, s76, v141
    v_mul_f32 v142, s76, v142
    v_mul_f32 v143, s76, v143
    v_cvt_pk_bf16_f32 v136, v136, v137
    v_cvt_pk_bf16_f32 v137, v138, v139
    v_cvt_pk_bf16_f32 v138, v140, v141
    v_cvt_pk_bf16_f32 v139, v142, v143
    buffer_store_dwordx4 v[136:139], v18, s[32:35], s56 offen
    s_add_u32 s56, s56, s79
    v_mul_f32 v144, s76, v144
    v_mul_f32 v145, s76, v145
    v_mul_f32 v146, s76, v146
    v_mul_f32 v147, s76, v147
    v_mul_f32 v148, s76, v148
    v_mul_f32 v149, s76, v149
    v_mul_f32 v150, s76, v150
    v_mul_f32 v151, s76, v151
    v_cvt_pk_bf16_f32 v144, v144, v145
    v_cvt_pk_bf16_f32 v145, v146, v147
    v_cvt_pk_bf16_f32 v146, v148, v149
    v_cvt_pk_bf16_f32 v147, v150, v151
    buffer_store_dwordx4 v[144:147], v18, s[32:35], s56 offen
    s_add_u32 s56, s56, s79
    v_mul_f32 v152, s76, v152
    v_mul_f32 v153, s76, v153
    v_mul_f32 v154, s76, v154
    v_mul_f32 v155, s76, v155
    v_mul_f32 v156, s76, v156
    v_mul_f32 v157, s76, v157
    v_mul_f32 v158, s76, v158
    v_mul_f32 v159, s76, v159
    v_cvt_pk_bf16_f32 v152, v152, v153
    v_cvt_pk_bf16_f32 v153, v154, v155
    v_cvt_pk_bf16_f32 v154, v156, v157
    v_cvt_pk_bf16_f32 v155, v158, v159
    buffer_store_dwordx4 v[152:155], v18, s[32:35], s56 offen
    s_add_u32 s56, s56, s79
    s_add_u32 s55, s55, s78
    s_mov_b32 s56, s55
    v_mul_f32 v160, s76, v160
    v_mul_f32 v161, s76, v161
    v_mul_f32 v162, s76, v162
    v_mul_f32 v163, s76, v163
    v_mul_f32 v164, s76, v164
    v_mul_f32 v165, s76, v165
    v_mul_f32 v166, s76, v166
    v_mul_f32 v167, s76, v167
    v_cvt_pk_bf16_f32 v160, v160, v161
    v_cvt_pk_bf16_f32 v161, v162, v163
    v_cvt_pk_bf16_f32 v162, v164, v165
    v_cvt_pk_bf16_f32 v163, v166, v167
    buffer_store_dwordx4 v[160:163], v18, s[32:35], s56 offen
    s_add_u32 s56, s56, s79
    v_mul_f32 v168, s76, v168
    v_mul_f32 v169, s76, v169
    v_mul_f32 v170, s76, v170
    v_mul_f32 v171, s76, v171
    v_mul_f32 v172, s76, v172
    v_mul_f32 v173, s76, v173
    v_mul_f32 v174, s76, v174
    v_mul_f32 v175, s76, v175
    v_cvt_pk_bf16_f32 v168, v168, v169
    v_cvt_pk_bf16_f32 v169, v170, v171
    v_cvt_pk_bf16_f32 v170, v172, v173
    v_cvt_pk_bf16_f32 v171, v174, v175
    buffer_store_dwordx4 v[168:171], v18, s[32:35], s56 offen
    s_add_u32 s56, s56, s79
    v_mul_f32 v176, s76, v176
    v_mul_f32 v177, s76, v177
    v_mul_f32 v178, s76, v178
    v_mul_f32 v179, s76, v179
    v_mul_f32 v180, s76, v180
    v_mul_f32 v181, s76, v181
    v_mul_f32 v182, s76, v182
    v_mul_f32 v183, s76, v183
    v_cvt_pk_bf16_f32 v176, v176, v177
    v_cvt_pk_bf16_f32 v177, v178, v179
    v_cvt_pk_bf16_f32 v178, v180, v181
    v_cvt_pk_bf16_f32 v179, v182, v183
    buffer_store_dwordx4 v[176:179], v18, s[32:35], s56 offen
    s_add_u32 s56, s56, s79
    v_mul_f32 v184, s76, v184
    v_mul_f32 v185, s76, v185
    v_mul_f32 v186, s76, v186
    v_mul_f32 v187, s76, v187
    v_mul_f32 v188, s76, v188
    v_mul_f32 v189, s76, v189
    v_mul_f32 v190, s76, v190
    v_mul_f32 v191, s76, v191
    v_cvt_pk_bf16_f32 v184, v184, v185
    v_cvt_pk_bf16_f32 v185, v186, v187
    v_cvt_pk_bf16_f32 v186, v188, v189
    v_cvt_pk_bf16_f32 v187, v190, v191
    buffer_store_dwordx4 v[184:187], v18, s[32:35], s56 offen
    s_add_u32 s56, s56, s79
    v_mul_f32 v192, s76, v192
    v_mul_f32 v193, s76, v193
    v_mul_f32 v194, s76, v194
    v_mul_f32 v195, s76, v195
    v_mul_f32 v196, s76, v196
    v_mul_f32 v197, s76, v197
    v_mul_f32 v198, s76, v198
    v_mul_f32 v199, s76, v199
    v_cvt_pk_bf16_f32 v192, v192, v193
    v_cvt_pk_bf16_f32 v193, v194, v195
    v_cvt_pk_bf16_f32 v194, v196, v197
    v_cvt_pk_bf16_f32 v195, v198, v199
    buffer_store_dwordx4 v[192:195], v18, s[32:35], s56 offen
    s_add_u32 s56, s56, s79
    v_mul_f32 v200, s76, v200
    v_mul_f32 v201, s76, v201
    v_mul_f32 v202, s76, v202
    v_mul_f32 v203, s76, v203
    v_mul_f32 v204, s76, v204
    v_mul_f32 v205, s76, v205
    v_mul_f32 v206, s76, v206
    v_mul_f32 v207, s76, v207
    v_cvt_pk_bf16_f32 v200, v200, v201
    v_cvt_pk_bf16_f32 v201, v202, v203
    v_cvt_pk_bf16_f32 v202, v204, v205
    v_cvt_pk_bf16_f32 v203, v206, v207
    buffer_store_dwordx4 v[200:203], v18, s[32:35], s56 offen
    s_add_u32 s56, s56, s79
    v_mul_f32 v208, s76, v208
    v_mul_f32 v209, s76, v209
    v_mul_f32 v210, s76, v210
    v_mul_f32 v211, s76, v211
    v_mul_f32 v212, s76, v212
    v_mul_f32 v213, s76, v213
    v_mul_f32 v214, s76, v214
    v_mul_f32 v215, s76, v215
    v_cvt_pk_bf16_f32 v208, v208, v209
    v_cvt_pk_bf16_f32 v209, v210, v211
    v_cvt_pk_bf16_f32 v210, v212, v213
    v_cvt_pk_bf16_f32 v211, v214, v215
    buffer_store_dwordx4 v[208:211], v18, s[32:35], s56 offen
    s_add_u32 s56, s56, s79
    v_mul_f32 v216, s76, v216
    v_mul_f32 v217, s76, v217
    v_mul_f32 v218, s76, v218
    v_mul_f32 v219, s76, v219
    v_mul_f32 v220, s76, v220
    v_mul_f32 v221, s76, v221
    v_mul_f32 v222, s76, v222
    v_mul_f32 v223, s76, v223
    v_cvt_pk_bf16_f32 v216, v216, v217
    v_cvt_pk_bf16_f32 v217, v218, v219
    v_cvt_pk_bf16_f32 v218, v220, v221
    v_cvt_pk_bf16_f32 v219, v222, v223
    buffer_store_dwordx4 v[216:219], v18, s[32:35], s56 offen
    s_add_u32 s56, s56, s79
    s_add_u32 s55, s55, s78
    s_mov_b32 s56, s55
    v_mul_f32 v224, s76, v224
    v_mul_f32 v225, s76, v225
    v_mul_f32 v226, s76, v226
    v_mul_f32 v227, s76, v227
    v_mul_f32 v228, s76, v228
    v_mul_f32 v229, s76, v229
    v_mul_f32 v230, s76, v230
    v_mul_f32 v231, s76, v231
    v_cvt_pk_bf16_f32 v224, v224, v225
    v_cvt_pk_bf16_f32 v225, v226, v227
    v_cvt_pk_bf16_f32 v226, v228, v229
    v_cvt_pk_bf16_f32 v227, v230, v231
    buffer_store_dwordx4 v[224:227], v18, s[32:35], s56 offen
    s_add_u32 s56, s56, s79
    v_mul_f32 v232, s76, v232
    v_mul_f32 v233, s76, v233
    v_mul_f32 v234, s76, v234
    v_mul_f32 v235, s76, v235
    v_mul_f32 v236, s76, v236
    v_mul_f32 v237, s76, v237
    v_mul_f32 v238, s76, v238
    v_mul_f32 v239, s76, v239
    v_cvt_pk_bf16_f32 v232, v232, v233
    v_cvt_pk_bf16_f32 v233, v234, v235
    v_cvt_pk_bf16_f32 v234, v236, v237
    v_cvt_pk_bf16_f32 v235, v238, v239
    buffer_store_dwordx4 v[232:235], v18, s[32:35], s56 offen
    s_add_u32 s56, s56, s79
    v_mul_f32 v240, s76, v240
    v_mul_f32 v241, s76, v241
    v_mul_f32 v242, s76, v242
    v_mul_f32 v243, s76, v243
    v_mul_f32 v244, s76, v244
    v_mul_f32 v245, s76, v245
    v_mul_f32 v246, s76, v246
    v_mul_f32 v247, s76, v247
    v_cvt_pk_bf16_f32 v240, v240, v241
    v_cvt_pk_bf16_f32 v241, v242, v243
    v_cvt_pk_bf16_f32 v242, v244, v245
    v_cvt_pk_bf16_f32 v243, v246, v247
    buffer_store_dwordx4 v[240:243], v18, s[32:35], s56 offen
    s_add_u32 s56, s56, s79
    v_mul_f32 v248, s76, v248
    v_mul_f32 v249, s76, v249
    v_mul_f32 v250, s76, v250
    v_mul_f32 v251, s76, v251
    v_mul_f32 v252, s76, v252
    v_mul_f32 v253, s76, v253
    v_mul_f32 v254, s76, v254
    v_mul_f32 v255, s76, v255
    v_cvt_pk_bf16_f32 v248, v248, v249
    v_cvt_pk_bf16_f32 v249, v250, v251
    v_cvt_pk_bf16_f32 v250, v252, v253
    v_cvt_pk_bf16_f32 v251, v254, v255
    buffer_store_dwordx4 v[248:251], v18, s[32:35], s56 offen
    s_add_u32 s56, s56, s79
    v_accvgpr_read_b32 v20, a96
    v_accvgpr_read_b32 v21, a97
    v_accvgpr_read_b32 v22, a98
    v_accvgpr_read_b32 v23, a99
    v_accvgpr_read_b32 v24, a100
    v_accvgpr_read_b32 v25, a101
    v_accvgpr_read_b32 v26, a102
    v_accvgpr_read_b32 v27, a103
    v_mul_f32 v20, s76, v20
    v_mul_f32 v21, s76, v21
    v_mul_f32 v22, s76, v22
    v_mul_f32 v23, s76, v23
    v_mul_f32 v24, s76, v24
    v_mul_f32 v25, s76, v25
    v_mul_f32 v26, s76, v26
    v_mul_f32 v27, s76, v27
    v_cvt_pk_bf16_f32 v20, v20, v21
    v_cvt_pk_bf16_f32 v21, v22, v23
    v_cvt_pk_bf16_f32 v22, v24, v25
    v_cvt_pk_bf16_f32 v23, v26, v27
    buffer_store_dwordx4 v[20:23], v18, s[32:35], s56 offen
    s_add_u32 s56, s56, s79
    s_nop 1
    v_accvgpr_read_b32 v20, a104
    v_accvgpr_read_b32 v21, a105
    v_accvgpr_read_b32 v22, a106
    v_accvgpr_read_b32 v23, a107
    v_accvgpr_read_b32 v24, a108
    v_accvgpr_read_b32 v25, a109
    v_accvgpr_read_b32 v26, a110
    v_accvgpr_read_b32 v27, a111
    v_mul_f32 v20, s76, v20
    v_mul_f32 v21, s76, v21
    v_mul_f32 v22, s76, v22
    v_mul_f32 v23, s76, v23
    v_mul_f32 v24, s76, v24
    v_mul_f32 v25, s76, v25
    v_mul_f32 v26, s76, v26
    v_mul_f32 v27, s76, v27
    v_cvt_pk_bf16_f32 v20, v20, v21
    v_cvt_pk_bf16_f32 v21, v22, v23
    v_cvt_pk_bf16_f32 v22, v24, v25
    v_cvt_pk_bf16_f32 v23, v26, v27
    buffer_store_dwordx4 v[20:23], v18, s[32:35], s56 offen
    s_add_u32 s56, s56, s79
    s_nop 1
    v_accvgpr_read_b32 v20, a112
    v_accvgpr_read_b32 v21, a113
    v_accvgpr_read_b32 v22, a114
    v_accvgpr_read_b32 v23, a115
    v_accvgpr_read_b32 v24, a116
    v_accvgpr_read_b32 v25, a117
    v_accvgpr_read_b32 v26, a118
    v_accvgpr_read_b32 v27, a119
    v_mul_f32 v20, s76, v20
    v_mul_f32 v21, s76, v21
    v_mul_f32 v22, s76, v22
    v_mul_f32 v23, s76, v23
    v_mul_f32 v24, s76, v24
    v_mul_f32 v25, s76, v25
    v_mul_f32 v26, s76, v26
    v_mul_f32 v27, s76, v27
    v_cvt_pk_bf16_f32 v20, v20, v21
    v_cvt_pk_bf16_f32 v21, v22, v23
    v_cvt_pk_bf16_f32 v22, v24, v25
    v_cvt_pk_bf16_f32 v23, v26, v27
    buffer_store_dwordx4 v[20:23], v18, s[32:35], s56 offen
    s_add_u32 s56, s56, s79
    s_nop 1
    v_accvgpr_read_b32 v20, a120
    v_accvgpr_read_b32 v21, a121
    v_accvgpr_read_b32 v22, a122
    v_accvgpr_read_b32 v23, a123
    v_accvgpr_read_b32 v24, a124
    v_accvgpr_read_b32 v25, a125
    v_accvgpr_read_b32 v26, a126
    v_accvgpr_read_b32 v27, a127
    v_mul_f32 v20, s76, v20
    v_mul_f32 v21, s76, v21
    v_mul_f32 v22, s76, v22
    v_mul_f32 v23, s76, v23
    v_mul_f32 v24, s76, v24
    v_mul_f32 v25, s76, v25
    v_mul_f32 v26, s76, v26
    v_mul_f32 v27, s76, v27
    v_cvt_pk_bf16_f32 v20, v20, v21
    v_cvt_pk_bf16_f32 v21, v22, v23
    v_cvt_pk_bf16_f32 v22, v24, v25
    v_cvt_pk_bf16_f32 v23, v26, v27
    buffer_store_dwordx4 v[20:23], v18, s[32:35], s56 offen
    s_add_u32 s56, s56, s79
    s_nop 1
    s_add_u32 s55, s55, s78
    s_branch gemm1_kernel_epd20
gemm1_kernel_noscale19:
    s_mov_b32 s55, s77
    s_mov_b32 s56, s55
    v_cvt_pk_bf16_f32 v32, v32, v33
    v_cvt_pk_bf16_f32 v33, v34, v35
    v_cvt_pk_bf16_f32 v34, v36, v37
    v_cvt_pk_bf16_f32 v35, v38, v39
    buffer_store_dwordx4 v[32:35], v18, s[32:35], s56 offen
    s_add_u32 s56, s56, s79
    v_cvt_pk_bf16_f32 v40, v40, v41
    v_cvt_pk_bf16_f32 v41, v42, v43
    v_cvt_pk_bf16_f32 v42, v44, v45
    v_cvt_pk_bf16_f32 v43, v46, v47
    buffer_store_dwordx4 v[40:43], v18, s[32:35], s56 offen
    s_add_u32 s56, s56, s79
    v_cvt_pk_bf16_f32 v48, v48, v49
    v_cvt_pk_bf16_f32 v49, v50, v51
    v_cvt_pk_bf16_f32 v50, v52, v53
    v_cvt_pk_bf16_f32 v51, v54, v55
    buffer_store_dwordx4 v[48:51], v18, s[32:35], s56 offen
    s_add_u32 s56, s56, s79
    v_cvt_pk_bf16_f32 v56, v56, v57
    v_cvt_pk_bf16_f32 v57, v58, v59
    v_cvt_pk_bf16_f32 v58, v60, v61
    v_cvt_pk_bf16_f32 v59, v62, v63
    buffer_store_dwordx4 v[56:59], v18, s[32:35], s56 offen
    s_add_u32 s56, s56, s79
    v_cvt_pk_bf16_f32 v64, v64, v65
    v_cvt_pk_bf16_f32 v65, v66, v67
    v_cvt_pk_bf16_f32 v66, v68, v69
    v_cvt_pk_bf16_f32 v67, v70, v71
    buffer_store_dwordx4 v[64:67], v18, s[32:35], s56 offen
    s_add_u32 s56, s56, s79
    v_cvt_pk_bf16_f32 v72, v72, v73
    v_cvt_pk_bf16_f32 v73, v74, v75
    v_cvt_pk_bf16_f32 v74, v76, v77
    v_cvt_pk_bf16_f32 v75, v78, v79
    buffer_store_dwordx4 v[72:75], v18, s[32:35], s56 offen
    s_add_u32 s56, s56, s79
    v_cvt_pk_bf16_f32 v80, v80, v81
    v_cvt_pk_bf16_f32 v81, v82, v83
    v_cvt_pk_bf16_f32 v82, v84, v85
    v_cvt_pk_bf16_f32 v83, v86, v87
    buffer_store_dwordx4 v[80:83], v18, s[32:35], s56 offen
    s_add_u32 s56, s56, s79
    v_cvt_pk_bf16_f32 v88, v88, v89
    v_cvt_pk_bf16_f32 v89, v90, v91
    v_cvt_pk_bf16_f32 v90, v92, v93
    v_cvt_pk_bf16_f32 v91, v94, v95
    buffer_store_dwordx4 v[88:91], v18, s[32:35], s56 offen
    s_add_u32 s56, s56, s79
    s_add_u32 s55, s55, s78
    s_mov_b32 s56, s55
    v_cvt_pk_bf16_f32 v96, v96, v97
    v_cvt_pk_bf16_f32 v97, v98, v99
    v_cvt_pk_bf16_f32 v98, v100, v101
    v_cvt_pk_bf16_f32 v99, v102, v103
    buffer_store_dwordx4 v[96:99], v18, s[32:35], s56 offen
    s_add_u32 s56, s56, s79
    v_cvt_pk_bf16_f32 v104, v104, v105
    v_cvt_pk_bf16_f32 v105, v106, v107
    v_cvt_pk_bf16_f32 v106, v108, v109
    v_cvt_pk_bf16_f32 v107, v110, v111
    buffer_store_dwordx4 v[104:107], v18, s[32:35], s56 offen
    s_add_u32 s56, s56, s79
    v_cvt_pk_bf16_f32 v112, v112, v113
    v_cvt_pk_bf16_f32 v113, v114, v115
    v_cvt_pk_bf16_f32 v114, v116, v117
    v_cvt_pk_bf16_f32 v115, v118, v119
    buffer_store_dwordx4 v[112:115], v18, s[32:35], s56 offen
    s_add_u32 s56, s56, s79
    v_cvt_pk_bf16_f32 v120, v120, v121
    v_cvt_pk_bf16_f32 v121, v122, v123
    v_cvt_pk_bf16_f32 v122, v124, v125
    v_cvt_pk_bf16_f32 v123, v126, v127
    buffer_store_dwordx4 v[120:123], v18, s[32:35], s56 offen
    s_add_u32 s56, s56, s79
    v_cvt_pk_bf16_f32 v128, v128, v129
    v_cvt_pk_bf16_f32 v129, v130, v131
    v_cvt_pk_bf16_f32 v130, v132, v133
    v_cvt_pk_bf16_f32 v131, v134, v135
    buffer_store_dwordx4 v[128:131], v18, s[32:35], s56 offen
    s_add_u32 s56, s56, s79
    v_cvt_pk_bf16_f32 v136, v136, v137
    v_cvt_pk_bf16_f32 v137, v138, v139
    v_cvt_pk_bf16_f32 v138, v140, v141
    v_cvt_pk_bf16_f32 v139, v142, v143
    buffer_store_dwordx4 v[136:139], v18, s[32:35], s56 offen
    s_add_u32 s56, s56, s79
    v_cvt_pk_bf16_f32 v144, v144, v145
    v_cvt_pk_bf16_f32 v145, v146, v147
    v_cvt_pk_bf16_f32 v146, v148, v149
    v_cvt_pk_bf16_f32 v147, v150, v151
    buffer_store_dwordx4 v[144:147], v18, s[32:35], s56 offen
    s_add_u32 s56, s56, s79
    v_cvt_pk_bf16_f32 v152, v152, v153
    v_cvt_pk_bf16_f32 v153, v154, v155
    v_cvt_pk_bf16_f32 v154, v156, v157
    v_cvt_pk_bf16_f32 v155, v158, v159
    buffer_store_dwordx4 v[152:155], v18, s[32:35], s56 offen
    s_add_u32 s56, s56, s79
    s_add_u32 s55, s55, s78
    s_mov_b32 s56, s55
    v_cvt_pk_bf16_f32 v160, v160, v161
    v_cvt_pk_bf16_f32 v161, v162, v163
    v_cvt_pk_bf16_f32 v162, v164, v165
    v_cvt_pk_bf16_f32 v163, v166, v167
    buffer_store_dwordx4 v[160:163], v18, s[32:35], s56 offen
    s_add_u32 s56, s56, s79
    v_cvt_pk_bf16_f32 v168, v168, v169
    v_cvt_pk_bf16_f32 v169, v170, v171
    v_cvt_pk_bf16_f32 v170, v172, v173
    v_cvt_pk_bf16_f32 v171, v174, v175
    buffer_store_dwordx4 v[168:171], v18, s[32:35], s56 offen
    s_add_u32 s56, s56, s79
    v_cvt_pk_bf16_f32 v176, v176, v177
    v_cvt_pk_bf16_f32 v177, v178, v179
    v_cvt_pk_bf16_f32 v178, v180, v181
    v_cvt_pk_bf16_f32 v179, v182, v183
    buffer_store_dwordx4 v[176:179], v18, s[32:35], s56 offen
    s_add_u32 s56, s56, s79
    v_cvt_pk_bf16_f32 v184, v184, v185
    v_cvt_pk_bf16_f32 v185, v186, v187
    v_cvt_pk_bf16_f32 v186, v188, v189
    v_cvt_pk_bf16_f32 v187, v190, v191
    buffer_store_dwordx4 v[184:187], v18, s[32:35], s56 offen
    s_add_u32 s56, s56, s79
    v_cvt_pk_bf16_f32 v192, v192, v193
    v_cvt_pk_bf16_f32 v193, v194, v195
    v_cvt_pk_bf16_f32 v194, v196, v197
    v_cvt_pk_bf16_f32 v195, v198, v199
    buffer_store_dwordx4 v[192:195], v18, s[32:35], s56 offen
    s_add_u32 s56, s56, s79
    v_cvt_pk_bf16_f32 v200, v200, v201
    v_cvt_pk_bf16_f32 v201, v202, v203
    v_cvt_pk_bf16_f32 v202, v204, v205
    v_cvt_pk_bf16_f32 v203, v206, v207
    buffer_store_dwordx4 v[200:203], v18, s[32:35], s56 offen
    s_add_u32 s56, s56, s79
    v_cvt_pk_bf16_f32 v208, v208, v209
    v_cvt_pk_bf16_f32 v209, v210, v211
    v_cvt_pk_bf16_f32 v210, v212, v213
    v_cvt_pk_bf16_f32 v211, v214, v215
    buffer_store_dwordx4 v[208:211], v18, s[32:35], s56 offen
    s_add_u32 s56, s56, s79
    v_cvt_pk_bf16_f32 v216, v216, v217
    v_cvt_pk_bf16_f32 v217, v218, v219
    v_cvt_pk_bf16_f32 v218, v220, v221
    v_cvt_pk_bf16_f32 v219, v222, v223
    buffer_store_dwordx4 v[216:219], v18, s[32:35], s56 offen
    s_add_u32 s56, s56, s79
    s_add_u32 s55, s55, s78
    s_mov_b32 s56, s55
    v_cvt_pk_bf16_f32 v224, v224, v225
    v_cvt_pk_bf16_f32 v225, v226, v227
    v_cvt_pk_bf16_f32 v226, v228, v229
    v_cvt_pk_bf16_f32 v227, v230, v231
    buffer_store_dwordx4 v[224:227], v18, s[32:35], s56 offen
    s_add_u32 s56, s56, s79
    v_cvt_pk_bf16_f32 v232, v232, v233
    v_cvt_pk_bf16_f32 v233, v234, v235
    v_cvt_pk_bf16_f32 v234, v236, v237
    v_cvt_pk_bf16_f32 v235, v238, v239
    buffer_store_dwordx4 v[232:235], v18, s[32:35], s56 offen
    s_add_u32 s56, s56, s79
    v_cvt_pk_bf16_f32 v240, v240, v241
    v_cvt_pk_bf16_f32 v241, v242, v243
    v_cvt_pk_bf16_f32 v242, v244, v245
    v_cvt_pk_bf16_f32 v243, v246, v247
    buffer_store_dwordx4 v[240:243], v18, s[32:35], s56 offen
    s_add_u32 s56, s56, s79
    v_cvt_pk_bf16_f32 v248, v248, v249
    v_cvt_pk_bf16_f32 v249, v250, v251
    v_cvt_pk_bf16_f32 v250, v252, v253
    v_cvt_pk_bf16_f32 v251, v254, v255
    buffer_store_dwordx4 v[248:251], v18, s[32:35], s56 offen
    s_add_u32 s56, s56, s79
    v_accvgpr_read_b32 v20, a96
    v_accvgpr_read_b32 v21, a97
    v_accvgpr_read_b32 v22, a98
    v_accvgpr_read_b32 v23, a99
    v_accvgpr_read_b32 v24, a100
    v_accvgpr_read_b32 v25, a101
    v_accvgpr_read_b32 v26, a102
    v_accvgpr_read_b32 v27, a103
    v_cvt_pk_bf16_f32 v20, v20, v21
    v_cvt_pk_bf16_f32 v21, v22, v23
    v_cvt_pk_bf16_f32 v22, v24, v25
    v_cvt_pk_bf16_f32 v23, v26, v27
    buffer_store_dwordx4 v[20:23], v18, s[32:35], s56 offen
    s_add_u32 s56, s56, s79
    s_nop 1
    v_accvgpr_read_b32 v20, a104
    v_accvgpr_read_b32 v21, a105
    v_accvgpr_read_b32 v22, a106
    v_accvgpr_read_b32 v23, a107
    v_accvgpr_read_b32 v24, a108
    v_accvgpr_read_b32 v25, a109
    v_accvgpr_read_b32 v26, a110
    v_accvgpr_read_b32 v27, a111
    v_cvt_pk_bf16_f32 v20, v20, v21
    v_cvt_pk_bf16_f32 v21, v22, v23
    v_cvt_pk_bf16_f32 v22, v24, v25
    v_cvt_pk_bf16_f32 v23, v26, v27
    buffer_store_dwordx4 v[20:23], v18, s[32:35], s56 offen
    s_add_u32 s56, s56, s79
    s_nop 1
    v_accvgpr_read_b32 v20, a112
    v_accvgpr_read_b32 v21, a113
    v_accvgpr_read_b32 v22, a114
    v_accvgpr_read_b32 v23, a115
    v_accvgpr_read_b32 v24, a116
    v_accvgpr_read_b32 v25, a117
    v_accvgpr_read_b32 v26, a118
    v_accvgpr_read_b32 v27, a119
    v_cvt_pk_bf16_f32 v20, v20, v21
    v_cvt_pk_bf16_f32 v21, v22, v23
    v_cvt_pk_bf16_f32 v22, v24, v25
    v_cvt_pk_bf16_f32 v23, v26, v27
    buffer_store_dwordx4 v[20:23], v18, s[32:35], s56 offen
    s_add_u32 s56, s56, s79
    s_nop 1
    v_accvgpr_read_b32 v20, a120
    v_accvgpr_read_b32 v21, a121
    v_accvgpr_read_b32 v22, a122
    v_accvgpr_read_b32 v23, a123
    v_accvgpr_read_b32 v24, a124
    v_accvgpr_read_b32 v25, a125
    v_accvgpr_read_b32 v26, a126
    v_accvgpr_read_b32 v27, a127
    v_cvt_pk_bf16_f32 v20, v20, v21
    v_cvt_pk_bf16_f32 v21, v22, v23
    v_cvt_pk_bf16_f32 v22, v24, v25
    v_cvt_pk_bf16_f32 v23, v26, v27
    buffer_store_dwordx4 v[20:23], v18, s[32:35], s56 offen
    s_add_u32 s56, s56, s79
    s_nop 1
    s_add_u32 s55, s55, s78
gemm1_kernel_epd20:
    s_cmp_eq_u32 s58, 0
    s_cbranch_scc1 gemm1_kernel_fin21
    s_mov_b32 s74, s91
    s_mov_b32 s75, s92
    s_mov_b32 s76, s93
    s_mov_b32 s77, s94
    s_mov_b32 s78, s95
    s_mov_b32 s79, s96
    s_mov_b32 s58, 0
    s_mov_b32 s53, 0
    s_branch gemm1_kernel_tile8
gemm1_kernel_fin21:
gemm1_kernel_end1:
    s_endpgm
gemm1_kernel_dosw14:
    s_cmp_eq_u32 s58, 0
    s_cbranch_scc1 gemm1_kernel_nonext22
    s_mov_b32 s26, s82
    s_mov_b32 s30, s85
    s_lshl_b32 s54, s86, 4
    s_lshl_b32 s54, s54, s90
    s_mov_b32 s36, s88
    s_mul_i32 s55, s54, 1
    s_add_u32 s37, s55, s88
    s_sub_u32 s37, s37, 2048
    s_mul_i32 s55, s54, 2
    s_add_u32 s38, s55, s88
    s_mul_i32 s55, s54, 3
    s_add_u32 s39, s55, s88
    s_sub_u32 s39, s39, 2048
    s_mov_b32 s40, s89
    s_lshl_b32 s54, s87, 2
    s_mul_i32 s55, s54, 1
    s_add_u32 s41, s55, s89
    s_sub_u32 s41, s41, 2048
    s_mul_i32 s55, s54, 2
    s_add_u32 s42, s55, s89
    s_mul_i32 s55, s54, 3
    s_add_u32 s43, s55, s89
    s_sub_u32 s43, s43, 2048
    s_lshl_b32 s44, s87, 6
    s_lshl_b32 s54, s47, 7
    s_add_u32 s54, s54, s46
    s_lshl_b32 s55, s45, 6
    s_cmp_eq_u32 s90, 1
    s_cselect_b32 s54, s54, s55
    v_lshrrev_b32 v20, 3, v1
    v_lshlrev_b32 v20, s90, v20
    v_add_u32 v20, s54, v20
    v_mul_lo_u32 v20, v20, s86
    v_lshrrev_b32 v21, 4, v1
    v_and_b32 v22, 7, v1
    v_xor_b32 v21, v21, v22
    v_lshl_add_u32 v12, v21, 4, v20
    v_xor_b32 v21, 4, v21
    v_lshl_add_u32 v13, v21, 4, v20
    s_lshl_b32 s54, s86, 3
    s_lshl_b32 s54, s54, s90
    s_sub_u32 s54, s54, 1024
    v_add_u32 v13, s54, v13
    v_lshrrev_b32 v20, 5, v1
    s_lshl_b32 s54, s45, 4
    v_add_u32 v21, s54, v20
    v_mul_lo_u32 v21, v21, s87
    v_lshlrev_b32 v20, 1, v20
    v_and_b32 v22, 31, v1
    v_xor_b32 v20, v20, v22
    s_lshl_b32 s54, s87, 1
    s_sub_u32 s54, s54, 1024
    v_add_u32 v23, s54, v21
    v_xor_b32 v22, 0, v20
    v_lshl_add_u32 v14, v22, 4, v21
    v_xor_b32 v22, 4, v20
    v_lshl_add_u32 v15, v22, 4, v23
    v_xor_b32 v22, 8, v20
    v_lshl_add_u32 v16, v22, 4, v21
    v_xor_b32 v22, 12, v20
    v_lshl_add_u32 v17, v22, 4, v23
    s_mov_b32 s24, s80
    s_mov_b32 s25, s81
    s_mov_b32 s28, s83
    s_mov_b32 s29, s84
    s_branch gemm1_kernel_nosw13
gemm1_kernel_nonext22:
    s_mov_b32 s26, 0
    s_mov_b32 s30, 0
    s_branch gemm1_kernel_nosw13
gemm1_kernel_dosw18:
    s_cmp_eq_u32 s58, 0
    s_cbranch_scc1 gemm1_kernel_nonext23
    s_mov_b32 s26, s82
    s_mov_b32 s30, s85
    s_lshl_b32 s54, s86, 4
    s_lshl_b32 s54, s54, s90
    s_mov_b32 s36, s88
    s_mul_i32 s55, s54, 1
    s_add_u32 s37, s55, s88
    s_sub_u32 s37, s37, 2048
    s_mul_i32 s55, s54, 2
    s_add_u32 s38, s55, s88
    s_mul_i32 s55, s54, 3
    s_add_u32 s39, s55, s88
    s_sub_u32 s39, s39, 2048
    s_mov_b32 s40, s89
    s_lshl_b32 s54, s87, 2
    s_mul_i32 s55, s54, 1
    s_add_u32 s41, s55, s89
    s_sub_u32 s41, s41, 2048
    s_mul_i32 s55, s54, 2
    s_add_u32 s42, s55, s89
    s_mul_i32 s55, s54, 3
    s_add_u32 s43, s55, s89
    s_sub_u32 s43, s43, 2048
    s_lshl_b32 s44, s87, 6
    s_lshl_b32 s54, s47, 7
    s_add_u32 s54, s54, s46
    s_lshl_b32 s55, s45, 6
    s_cmp_eq_u32 s90, 1
    s_cselect_b32 s54, s54, s55
    v_lshrrev_b32 v20, 3, v1
    v_lshlrev_b32 v20, s90, v20
    v_add_u32 v20, s54, v20
    v_mul_lo_u32 v20, v20, s86
    v_lshrrev_b32 v21, 4, v1
    v_and_b32 v22, 7, v1
    v_xor_b32 v21, v21, v22
    v_lshl_add_u32 v12, v21, 4, v20
    v_xor_b32 v21, 4, v21
    v_lshl_add_u32 v13, v21, 4, v20
    s_lshl_b32 s54, s86, 3
    s_lshl_b32 s54, s54, s90
    s_sub_u32 s54, s54, 1024
    v_add_u32 v13, s54, v13
    v_lshrrev_b32 v20, 5, v1
    s_lshl_b32 s54, s45, 4
    v_add_u32 v21, s54, v20
    v_mul_lo_u32 v21, v21, s87
    v_lshlrev_b32 v20, 1, v20
    v_and_b32 v22, 31, v1
    v_xor_b32 v20, v20, v22
    s_lshl_b32 s54, s87, 1
    s_sub_u32 s54, s54, 1024
    v_add_u32 v23, s54, v21
    v_xor_b32 v22, 0, v20
    v_lshl_add_u32 v14, v22, 4, v21
    v_xor_b32 v22, 4, v20
    v_lshl_add_u32 v15, v22, 4, v23
    v_xor_b32 v22, 8, v20
    v_lshl_add_u32 v16, v22, 4, v21
    v_xor_b32 v22, 12, v20
    v_lshl_add_u32 v17, v22, 4, v23
    s_mov_b32 s24, s80
    s_mov_b32 s25, s81
    s_mov_b32 s28, s83
    s_mov_b32 s29, s84
    s_branch gemm1_kernel_nosw17
gemm1_kernel_nonext23:
    s_mov_b32 s26, 0
    s_mov_b32 s30, 0
    s_branch gemm1_kernel_nosw17
.text
.globl attn_kernel
.p2align 8
.type attn_kernel,@function
attn_kernel:
    s_cmp_ge_u32 s2, 256
    s_cbranch_scc1 attn_kernel_end1
    s_load_dwordx2 s[4:5], s[0:1], 88
    v_and_b32 v1, 63, v0
    v_lshrrev_b32 v36, 6, v0
    s_nop 0
    v_readfirstlane_b32 s20, v36
    s_and_b32 s48, s2, 7
    s_lshl_b32 s48, s48, 2
    s_bfe_u32 s49, s2, 0x20003
    s_add_u32 s21, s48, s49
    s_lshr_b32 s22, s2, 5
    v_bfe_u32 v36, v1, 4, 1
    v_and_b32 v37, 7, v1
    v_lshl_add_u32 v36, v36, 3, v37
    v_lshrrev_b32 v37, 5, v1
    v_lshl_add_u32 v36, v37, 4, v36
    v_lshlrev_b32 v36, 4, v36
    v_bfe_u32 v38, v1, 3, 1
    v_lshl_add_u32 v2, v38, 12, v36
    v_lshl_add_u32 v3, v38, 10, v36
    v_add_u32 v3, 65536, v3
    v_and_b32 v36, 15, v1
    v_lshl_add_u32 v36, v37, 4, v36
    v_lshlrev_b32 v36, 4, v36
    v_bfe_u32 v38, v1, 4, 1
    v_lshl_add_u32 v7, v38, 12, v36
    v_lshl_add_u32 v16, v38, 10, v36
    v_and_b32 v14, 31, v1
    v_lshlrev_b32 v37, 2, v37
    v_sub_u32 v14, v14, v37
    s_lshl_b32 s27, s20, 12
    v_lshlrev_b32 v6, 4, v1
    v_add_u32 v6, s27, v6
    v_mov_b32 v13, 0xff800000
    s_mov_b32 s31, 1233125376
    s_sub_u32 s48, 15, s22
    s_lshl_b32 s48, s48, 3
    s_lshl_b32 s49, s20, 1
    s_add_u32 s56, s48, s49
    s_lshl_b32 s48, s22, 3
    s_add_u32 s57, s48, s49
    s_lshl_b32 s48, s22, 2
    s_sub_u32 s49, 64, s48
    s_lshl_b32 s10, s49, 13
    s_mov_b32 s14, s10
    s_add_u32 s33, s48, s20
    s_add_u32 s34, s33, 1
    s_add_u32 s35, s48, 4
    s_sub_u32 s36, s49, 4
    s_add_u32 s36, s36, s20
    s_add_u32 s37, s36, 1
    s_mov_b32 s38, s49
    s_mov_b32 s11, 0x20000
    s_mov_b32 s15, 0x20000
    s_mov_b32 s19, 0x20000
    s_mov_b32 s18, 268435456
    s_lshl_b32 s60, s21, 19
    s_waitcnt lgkmcnt(0)
    s_mov_b32 s16, s4
    s_mov_b32 s17, s5
    s_add_u32 s48, s60, 16777216
    s_add_u32 s8, s4, s48
    s_addc_u32 s9, s5, 0
    s_add_u32 s48, s60, 33554432
    s_add_u32 s12, s4, s48
    s_addc_u32 s13, s5, 0
    s_mov_b32 s23, 0
    s_mov_b32 s24, 0
    s_mov_b32 m0, s27
    s_nop 0
    buffer_load_dwordx4 v6, s[8:11], s23 offen offset:0 lds
    buffer_load_dwordx4 v6, s[8:11], s23 offen offset:1024 lds
    buffer_load_dwordx4 v6, s[8:11], s23 offen offset:2048 lds
    buffer_load_dwordx4 v6, s[8:11], s23 offen offset:3072 lds
    s_lshl_b32 s48, s56, 12
    s_add_u32 s48, s48, s60
    s_add_u32 s48, s48, 0
    buffer_load_dwordx4 a[128:131], v7, s[16:19], s48 offen offset:0
    buffer_load_dwordx4 a[132:135], v7, s[16:19], s48 offen offset:512
    buffer_load_dwordx4 a[136:139], v7, s[16:19], s48 offen offset:1024
    buffer_load_dwordx4 a[140:143], v7, s[16:19], s48 offen offset:1536
    buffer_load_dwordx4 a[144:147], v7, s[16:19], s48 offen offset:2048
    buffer_load_dwordx4 a[148:151], v7, s[16:19], s48 offen offset:2560
    buffer_load_dwordx4 a[152:155], v7, s[16:19], s48 offen offset:3072
    buffer_load_dwordx4 a[156:159], v7, s[16:19], s48 offen offset:3584
    s_lshl_b32 s48, s57, 12
    s_add_u32 s48, s48, s60
    s_add_u32 s48, s48, 0
    buffer_load_dwordx4 a[160:163], v7, s[16:19], s48 offen offset:0
    buffer_load_dwordx4 a[164:167], v7, s[16:19], s48 offen offset:512
    buffer_load_dwordx4 a[168:171], v7, s[16:19], s48 offen offset:1024
    buffer_load_dwordx4 a[172:175], v7, s[16:19], s48 offen offset:1536
    buffer_load_dwordx4 a[176:179], v7, s[16:19], s48 offen offset:2048
    buffer_load_dwordx4 a[180:183], v7, s[16:19], s48 offen offset:2560
    buffer_load_dwordx4 a[184:187], v7, s[16:19], s48 offen offset:3072
    buffer_load_dwordx4 a[188:191], v7, s[16:19], s48 offen offset:3584
    s_mov_b32 s23, 16384
    s_add_u32 s26, s27, 16384
    s_mov_b32 m0, s26
    s_nop 0
    buffer_load_dwordx4 v6, s[8:11], s23 offen offset:0 lds
    buffer_load_dwordx4 v6, s[8:11], s23 offen offset:1024 lds
    buffer_load_dwordx4 v6, s[8:11], s23 offen offset:2048 lds
    buffer_load_dwordx4 v6, s[8:11], s23 offen offset:3072 lds
    s_add_u32 s23, s23, 16384
    s_add_u32 m0, s26, 65536
    s_nop 0
    buffer_load_dwordx4 v6, s[12:15], s24 offen offset:0 lds
    buffer_load_dwordx4 v6, s[12:15], s24 offen offset:1024 lds
    buffer_load_dwordx4 v6, s[12:15], s24 offen offset:2048 lds
    buffer_load_dwordx4 v6, s[12:15], s24 offen offset:3072 lds
    s_add_u32 s24, s24, 16384
    s_add_u32 s26, s26, 16384
    s_mov_b32 s25, 0
    v_mov_b32 v4, v2
    v_mov_b32 v5, v3
    v_accvgpr_write_b32 a0, 0
    v_accvgpr_write_b32 a1, 0
    v_accvgpr_write_b32 a2, 0
    v_accvgpr_write_b32 a3, 0
    v_accvgpr_write_b32 a4, 0
    v_accvgpr_write_b32 a5, 0
    v_accvgpr_write_b32 a6, 0
    v_accvgpr_write_b32 a7, 0
    v_accvgpr_write_b32 a8, 0
    v_accvgpr_write_b32 a9, 0
    v_accvgpr_write_b32 a10, 0
    v_accvgpr_write_b32 a11, 0
    v_accvgpr_write_b32 a12, 0
    v_accvgpr_write_b32 a13, 0
    v_accvgpr_write_b32 a14, 0
    v_accvgpr_write_b32 a15, 0
    v_accvgpr_write_b32 a16, 0
    v_accvgpr_write_b32 a17, 0
    v_accvgpr_write_b32 a18, 0
    v_accvgpr_write_b32 a19, 0
    v_accvgpr_write_b32 a20, 0
    v_accvgpr_write_b32 a21, 0
    v_accvgpr_write_b32 a22, 0
    v_accvgpr_write_b32 a23, 0
    v_accvgpr_write_b32 a24, 0
    v_accvgpr_write_b32 a25, 0
    v_accvgpr_write_b32 a26, 0
    v_accvgpr_write_b32 a27, 0
    v_accvgpr_write_b32 a28, 0
    v_accvgpr_write_b32 a29, 0
    v_accvgpr_write_b32 a30, 0
    v_accvgpr_write_b32 a31, 0
    v_accvgpr_write_b32 a32, 0
    v_accvgpr_write_b32 a33, 0
    v_accvgpr_write_b32 a34, 0
    v_accvgpr_write_b32 a35, 0
    v_accvgpr_write_b32 a36, 0
    v_accvgpr_write_b32 a37, 0
    v_accvgpr_write_b32 a38, 0
    v_accvgpr_write_b32 a39, 0
    v_accvgpr_write_b32 a40, 0
    v_accvgpr_write_b32 a41, 0
    v_accvgpr_write_b32 a42, 0
    v_accvgpr_write_b32 a43, 0
    v_accvgpr_write_b32 a44, 0
    v_accvgpr_write_b32 a45, 0
    v_accvgpr_write_b32 a46, 0
    v_accvgpr_write_b32 a47, 0
    v_accvgpr_write_b32 a48, 0
    v_accvgpr_write_b32 a49, 0
    v_accvgpr_write_b32 a50, 0
    v_accvgpr_write_b32 a51, 0
    v_accvgpr_write_b32 a52, 0
    v_accvgpr_write_b32 a53, 0
    v_accvgpr_write_b32 a54, 0
    v_accvgpr_write_b32 a55, 0
    v_accvgpr_write_b32 a56, 0
    v_accvgpr_write_b32 a57, 0
    v_accvgpr_write_b32 a58, 0
    v_accvgpr_write_b32 a59, 0
    v_accvgpr_write_b32 a60, 0
    v_accvgpr_write_b32 a61, 0
    v_accvgpr_write_b32 a62, 0
    v_accvgpr_write_b32 a63, 0
    v_accvgpr_write_b32 a64, 0
    v_accvgpr_write_b32 a65, 0
    v_accvgpr_write_b32 a66, 0
    v_accvgpr_write_b32 a67, 0
    v_accvgpr_write_b32 a68, 0
    v_accvgpr_write_b32 a69, 0
    v_accvgpr_write_b32 a70, 0
    v_accvgpr_write_b32 a71, 0
    v_accvgpr_write_b32 a72, 0
    v_accvgpr_write_b32 a73, 0
    v_accvgpr_write_b32 a74, 0
    v_accvgpr_write_b32 a75, 0
    v_accvgpr_write_b32 a76, 0
    v_accvgpr_write_b32 a77, 0
    v_accvgpr_write_b32 a78, 0
    v_accvgpr_write_b32 a79, 0
    v_accvgpr_write_b32 a80, 0
    v_accvgpr_write_b32 a81, 0
    v_accvgpr_write_b32 a82, 0
    v_accvgpr_write_b32 a83, 0
    v_accvgpr_write_b32 a84, 0
    v_accvgpr_write_b32 a85, 0
    v_accvgpr_write_b32 a86, 0
    v_accvgpr_write_b32 a87, 0
    v_accvgpr_write_b32 a88, 0
    v_accvgpr_write_b32 a89, 0
    v_accvgpr_write_b32 a90, 0
    v_accvgpr_write_b32 a91, 0
    v_accvgpr_write_b32 a92, 0
    v_accvgpr_write_b32 a93, 0
    v_accvgpr_write_b32 a94, 0
    v_accvgpr_write_b32 a95, 0
    v_accvgpr_write_b32 a96, 0
    v_accvgpr_write_b32 a97, 0
    v_accvgpr_write_b32 a98, 0
    v_accvgpr_write_b32 a99, 0
    v_accvgpr_write_b32 a100, 0
    v_accvgpr_write_b32 a101, 0
    v_accvgpr_write_b32 a102, 0
    v_accvgpr_write_b32 a103, 0
    v_accvgpr_write_b32 a104, 0
    v_accvgpr_write_b32 a105, 0
    v_accvgpr_write_b32 a106, 0
    v_accvgpr_write_b32 a107, 0
    v_accvgpr_write_b32 a108, 0
    v_accvgpr_write_b32 a109, 0
    v_accvgpr_write_b32 a110, 0
    v_accvgpr_write_b32 a111, 0
    v_accvgpr_write_b32 a112, 0
    v_accvgpr_write_b32 a113, 0
    v_accvgpr_write_b32 a114, 0
    v_accvgpr_write_b32 a115, 0
    v_accvgpr_write_b32 a116, 0
    v_accvgpr_write_b32 a117, 0
    v_accvgpr_write_b32 a118, 0
    v_accvgpr_write_b32 a119, 0
    v_accvgpr_write_b32 a120, 0
    v_accvgpr_write_b32 a121, 0
    v_accvgpr_write_b32 a122, 0
    v_accvgpr_write_b32 a123, 0
    v_accvgpr_write_b32 a124, 0
    v_accvgpr_write_b32 a125, 0
    v_accvgpr_write_b32 a126, 0
    v_accvgpr_write_b32 a127, 0
    v_mov_b32 v160, 0
    v_mov_b32 v161, 0
    v_mov_b32 v162, 0
    v_mov_b32 v163, 0
    v_mov_b32 v164, 0
    v_mov_b32 v165, 0
    v_mov_b32 v166, 0
    v_mov_b32 v167, 0
    v_mov_b32 v168, 0
    v_mov_b32 v169, 0
    v_mov_b32 v170, 0
    v_mov_b32 v171, 0
    v_mov_b32 v172, 0
    v_mov_b32 v173, 0
    v_mov_b32 v174, 0
    v_mov_b32 v175, 0
    v_mov_b32 v176, 0
    v_mov_b32 v177, 0
    v_mov_b32 v178, 0
    v_mov_b32 v179, 0
    v_mov_b32 v180, 0
    v_mov_b32 v181, 0
    v_mov_b32 v182, 0
    v_mov_b32 v183, 0
    v_mov_b32 v184, 0
    v_mov_b32 v185, 0
    v_mov_b32 v186, 0
    v_mov_b32 v187, 0
    v_mov_b32 v188, 0
    v_mov_b32 v189, 0
    v_mov_b32 v190, 0
    v_mov_b32 v191, 0
    v_mov_b32 v8, 0
    v_mov_b32 v9, 0
    v_mov_b32 v10, 0
    v_mov_b32 v11, 0
    s_and_b32 s48, s2, 7
    s_lshl_b32 s48, s48, 4
    s_lshl_b32 s49, s20, 2
    s_add_u32 s58, s48, s49
    s_lshr_b32 s50, s2, 3
    s_lshl_b32 s50, s50, 17
    s_lshl_b32 s48, s58, 10
    s_add_u32 s48, s48, s50
    s_add_u32 s62, s48, 50331648
    s_add_u32 s63, s48, 54525952
    v_lshlrev_b32 v52, 4, v1
    s_and_b32 s59, s58, 63
    s_cmp_eq_u32 s59, 0
    s_cselect_b32 s51, 0, 1024
    s_sub_u32 s64, s63, s51
    s_lshl_b32 s48, s58, 9
    s_add_u32 s48, s48, s50
    s_add_u32 s65, s48, 58720256
    s_sub_u32 s66, s65, s51
    s_add_u32 s67, s65, 65536
    s_add_u32 s68, s66, 65536
    v_cmp_le_i32 vcc, 0, v14
    v_cmp_le_i32 s[44:45], 1, v14
    v_cmp_le_i32 s[46:47], 2, v14
    s_nop 1
    v_cndmask_b32 v17, v13, 0, vcc
    v_cndmask_b32 v18, v13, 0, s[44:45]
    v_cndmask_b32 v19, v13, 0, s[46:47]
    v_cmp_le_i32 vcc, 3, v14
    v_cmp_le_i32 s[44:45], 16, v14
    v_cmp_le_i32 s[46:47], 17, v14
    s_nop 1
    v_cndmask_b32 v53, v13, 0, vcc
    v_cndmask_b32 v54, v13, 0, s[44:45]
    v_cndmask_b32 v55, v13, 0, s[46:47]
    v_cmp_le_i32 vcc, 18, v14
    v_cmp_le_i32 s[44:45], 19, v14
    v_cmp_le_i32 s[46:47], 8, v14
    s_nop 1
    v_cndmask_b32 v56, v13, 0, vcc
    v_cndmask_b32 v57, v13, 0, s[44:45]
    v_cndmask_b32 v58, v13, 0, s[46:47]
    v_cmp_le_i32 vcc, 9, v14
    v_cmp_le_i32 s[44:45], 10, v14
    v_cmp_le_i32 s[46:47], 11, v14
    s_nop 1
    v_cndmask_b32 v59, v13, 0, vcc
    v_cndmask_b32 v60, v13, 0, s[44:45]
    v_cndmask_b32 v61, v13, 0, s[46:47]
    v_cmp_le_i32 vcc, 24, v14
    v_cmp_le_i32 s[44:45], 25, v14
    v_cmp_le_i32 s[46:47], 26, v14
    s_nop 1
    v_cndmask_b32 v62, v13, 0, vcc
    v_cndmask_b32 v63, v13, 0, s[44:45]
    v_cndmask_b32 v252, v13, 0, s[46:47]
    v_cmp_le_i32 vcc, 27, v14
    s_nop 1
    v_cndmask_b32 v253, v13, 0, vcc
    s_mov_b64 s[28:29], 0
    s_sub_u32 s48, s33, 1
    s_bitset1_b64 s[28:29], s48
    s_sub_u32 s48, s34, 1
    s_bitset1_b64 s[28:29], s48
    s_sub_u32 s48, s35, 1
    s_bitset1_b64 s[28:29], s48
    s_sub_u32 s48, s36, 1
    s_bitset1_b64 s[28:29], s48
    s_sub_u32 s48, s37, 1
    s_bitset1_b64 s[28:29], s48
    s_sub_u32 s48, s38, 1
    s_bitset1_b64 s[28:29], s48
    s_mov_b32 s30, 0
    s_cmp_lg_u32 s30, s33
    s_cbranch_scc1 attn_kernel_e6
    v_add_f32 v176, v176, v17
    v_add_f32 v177, v177, v18
    v_add_f32 v178, v178, v19
    v_add_f32 v179, v179, v53
    v_add_f32 v180, v180, v54
    v_add_f32 v181, v181, v55
    v_add_f32 v182, v182, v56
    v_add_f32 v183, v183, v57
    v_add_f32 v184, v184, v58
    v_add_f32 v185, v185, v59
    v_add_f32 v186, v186, v60
    v_add_f32 v187, v187, v61
    v_add_f32 v188, v188, v62
    v_add_f32 v189, v189, v63
    v_add_f32 v190, v190, v252
    v_add_f32 v191, v191, v253
    s_nop 0
attn_kernel_e6:
    s_waitcnt vmcnt(8)
    s_barrier
    ds_read_b128 a[192:195], v4 offset:0
    ds_read_b128 a[196:199], v4 offset:512
    ds_read_b128 a[200:203], v4 offset:1024
    ds_read_b128 a[204:207], v4 offset:1536
    ds_read_b128 a[208:211], v4 offset:2048
    ds_read_b128 a[212:215], v4 offset:2560
    ds_read_b128 a[216:219], v4 offset:3072
    ds_read_b128 a[220:223], v4 offset:3584
    s_waitcnt lgkmcnt(0)
    v_mfma_f32_32x32x16_bf16 v[64:79], a[192:195], a[128:131], v[160:175]
    s_mov_b32 m0, s26
    s_nop 0
    buffer_load_dwordx4 v6, s[8:11], s23 offen offset:0 lds
    v_mfma_f32_32x32x16_bf16 v[80:95], a[192:195], a[160:163], v[176:191]
    ds_read_b128 a[192:195], v4 offset:8192
    v_mfma_f32_32x32x16_bf16 v[64:79], a[196:199], a[132:135], v[64:79]
    buffer_load_dwordx4 v6, s[8:11], s23 offen offset:1024 lds
    v_mfma_f32_32x32x16_bf16 v[80:95], a[196:199], a[164:167], v[80:95]
    ds_read_b128 a[196:199], v4 offset:8704
    v_mfma_f32_32x32x16_bf16 v[64:79], a[200:203], a[136:139], v[64:79]
    buffer_load_dwordx4 v6, s[8:11], s23 offen offset:2048 lds
    v_mfma_f32_32x32x16_bf16 v[80:95], a[200:203], a[168:171], v[80:95]
    ds_read_b128 a[200:203], v4 offset:9216
    v_mfma_f32_32x32x16_bf16 v[64:79], a[204:207], a[140:143], v[64:79]
    buffer_load_dwordx4 v6, s[8:11], s23 offen offset:3072 lds
    s_add_u32 s23, s23, 16384
    v_mfma_f32_32x32x16_bf16 v[80:95], a[204:207], a[172:175], v[80:95]
    ds_read_b128 a[204:207], v4 offset:9728
    v_mfma_f32_32x32x16_bf16 v[64:79], a[208:211], a[144:147], v[64:79]
    s_add_u32 m0, s26, 65536
    s_nop 0
    buffer_load_dwordx4 v6, s[12:15], s24 offen offset:0 lds
    v_mfma_f32_32x32x16_bf16 v[80:95], a[208:211], a[176:179], v[80:95]
    ds_read_b128 a[208:211], v4 offset:10240
    v_mfma_f32_32x32x16_bf16 v[64:79], a[212:215], a[148:151], v[64:79]
    buffer_load_dwordx4 v6, s[12:15], s24 offen offset:1024 lds
    v_mfma_f32_32x32x16_bf16 v[80:95], a[212:215], a[180:183], v[80:95]
    ds_read_b128 a[212:215], v4 offset:10752
    v_mfma_f32_32x32x16_bf16 v[64:79], a[216:219], a[152:155], v[64:79]
    buffer_load_dwordx4 v6, s[12:15], s24 offen offset:2048 lds
    v_mfma_f32_32x32x16_bf16 v[80:95], a[216:219], a[184:187], v[80:95]
    ds_read_b128 a[216:219], v4 offset:11264
    v_mfma_f32_32x32x16_bf16 v[64:79], a[220:223], a[156:159], v[64:79]
    buffer_load_dwordx4 v6, s[12:15], s24 offen offset:3072 lds
    s_add_u32 s24, s24, 16384
    v_mfma_f32_32x32x16_bf16 v[80:95], a[220:223], a[188:191], v[80:95]
    ds_read_b128 a[220:223], v4 offset:11776
    s_add_u32 s26, s26, 16384
    s_mov_b32 s30, 1
    s_nop 9
    v_max3_f32 v36, v64, v65, v66
    v_max3_f32 v36, v36, v67, v68
    v_max3_f32 v36, v36, v69, v70
    v_max3_f32 v36, v36, v71, v72
    v_max3_f32 v36, v36, v73, v74
    v_max3_f32 v36, v36, v75, v76
    v_max3_f32 v36, v36, v77, v78
    v_max_f32 v36, v36, v79
    v_mov_b32 v37, v36
    v_max3_f32 v38, v80, v81, v82
    v_max3_f32 v38, v38, v83, v84
    v_max3_f32 v38, v38, v85, v86
    v_max3_f32 v38, v38, v87, v88
    v_max3_f32 v38, v38, v89, v90
    v_max3_f32 v38, v38, v91, v92
    v_max3_f32 v38, v38, v93, v94
    v_max_f32 v38, v38, v95
    v_mov_b32 v39, v38
    s_nop 1
    v_permlane32_swap_b32 v36, v37
    v_permlane32_swap_b32 v38, v39
    s_nop 1
    v_max_f32 v36, v36, v37
    v_max_f32 v38, v38, v39
    v_sub_f32 v160, v160, v36
    v_sub_f32 v161, v161, v36
    v_sub_f32 v162, v162, v36
    v_sub_f32 v163, v163, v36
    v_sub_f32 v164, v164, v36
    v_sub_f32 v165, v165, v36
    v_sub_f32 v166, v166, v36
    v_sub_f32 v167, v167, v36
    v_sub_f32 v168, v168, v36
    v_sub_f32 v169, v169, v36
    v_sub_f32 v170, v170, v36
    v_sub_f32 v171, v171, v36
    v_sub_f32 v172, v172, v36
    v_sub_f32 v173, v173, v36
    v_sub_f32 v174, v174, v36
    v_sub_f32 v175, v175, v36
    v_sub_f32 v176, v176, v38
    v_sub_f32 v177, v177, v38
    v_sub_f32 v178, v178, v38
    v_sub_f32 v179, v179, v38
    v_sub_f32 v180, v180, v38
    v_sub_f32 v181, v181, v38
    v_sub_f32 v182, v182, v38
    v_sub_f32 v183, v183, v38
    v_sub_f32 v184, v184, v38
    v_sub_f32 v185, v185, v38
    v_sub_f32 v186, v186, v38
    v_sub_f32 v187, v187, v38
    v_sub_f32 v188, v188, v38
    v_sub_f32 v189, v189, v38
    v_sub_f32 v190, v190, v38
    v_sub_f32 v191, v191, v38
    v_sub_f32 v64, v64, v36
    v_sub_f32 v65, v65, v36
    v_sub_f32 v66, v66, v36
    v_sub_f32 v67, v67, v36
    v_sub_f32 v68, v68, v36
    v_sub_f32 v69, v69, v36
    v_sub_f32 v70, v70, v36
    v_sub_f32 v71, v71, v36
    v_sub_f32 v72, v72, v36
    v_sub_f32 v73, v73, v36
    v_sub_f32 v74, v74, v36
    v_sub_f32 v75, v75, v36
    v_sub_f32 v76, v76, v36
    v_sub_f32 v77, v77, v36
    v_sub_f32 v78, v78, v36
    v_sub_f32 v79, v79, v36
    v_sub_f32 v80, v80, v38
    v_sub_f32 v81, v81, v38
    v_sub_f32 v82, v82, v38
    v_sub_f32 v83, v83, v38
    v_sub_f32 v84, v84, v38
    v_sub_f32 v85, v85, v38
    v_sub_f32 v86, v86, v38
    v_sub_f32 v87, v87, v38
    v_sub_f32 v88, v88, v38
    v_sub_f32 v89, v89, v38
    v_sub_f32 v90, v90, v38
    v_sub_f32 v91, v91, v38
    v_sub_f32 v92, v92, v38
    v_sub_f32 v93, v93, v38
    v_sub_f32 v94, v94, v38
    v_sub_f32 v95, v95, v38
    s_cmp_lg_u32 s30, s33
    s_cbranch_scc1 attn_kernel_e7
    v_add_f32 v176, v176, v17
    v_add_f32 v177, v177, v18
    v_add_f32 v178, v178, v19
    v_add_f32 v179, v179, v53
    v_add_f32 v180, v180, v54
    v_add_f32 v181, v181, v55
    v_add_f32 v182, v182, v56
    v_add_f32 v183, v183, v57
    v_add_f32 v184, v184, v58
    v_add_f32 v185, v185, v59
    v_add_f32 v186, v186, v60
    v_add_f32 v187, v187, v61
    v_add_f32 v188, v188, v62
    v_add_f32 v189, v189, v63
    v_add_f32 v190, v190, v252
    v_add_f32 v191, v191, v253
    s_nop 0
attn_kernel_e7:
    s_cmp_lg_u32 s30, s34
    s_cbranch_scc1 attn_kernel_e8
    v_mov_b32 v176, v13
    v_mov_b32 v177, v13
    v_mov_b32 v178, v13
    v_mov_b32 v179, v13
    v_mov_b32 v180, v13
    v_mov_b32 v181, v13
    v_mov_b32 v182, v13
    v_mov_b32 v183, v13
    v_mov_b32 v184, v13
    v_mov_b32 v185, v13
    v_mov_b32 v186, v13
    v_mov_b32 v187, v13
    v_mov_b32 v188, v13
    v_mov_b32 v189, v13
    v_mov_b32 v190, v13
    v_mov_b32 v191, v13
    s_nop 0
attn_kernel_e8:
    s_waitcnt lgkmcnt(0)
    v_mfma_f32_32x32x16_bf16 v[96:111], a[192:195], a[128:131], v[160:175]
    s_mov_b32 m0, s26
    v_add_f32 v8, v8, v10
    v_exp_f32 v20, v64
    v_exp_f32 v28, v80
    v_exp_f32 v21, v65
    v_exp_f32 v29, v81
    v_mfma_f32_32x32x16_bf16 v[112:127], a[192:195], a[160:163], v[176:191]
    buffer_load_dwordx4 v6, s[8:11], s23 offen offset:0 lds
    v_add_f32 v10, v20, v21
    v_exp_f32 v22, v66
    v_exp_f32 v30, v82
    v_exp_f32 v23, v67
    v_mfma_f32_32x32x16_bf16 v[96:111], a[196:199], a[132:135], v[96:111]
    s_bitcmp1_b64 s[28:29], s30
    s_cselect_b32 s32, -1.0, s31
    v_exp_f32 v31, v83
    v_exp_f32 v24, v68
    v_exp_f32 v32, v84
    v_exp_f32 v25, v69
    v_mfma_f32_32x32x16_bf16 v[112:127], a[196:199], a[164:167], v[112:127]
    buffer_load_dwordx4 v6, s[8:11], s23 offen offset:1024 lds
    v_cvt_pk_bf16_f32 v128, v20, v21
    v_exp_f32 v33, v85
    v_exp_f32 v26, v70
    v_exp_f32 v34, v86
    v_mfma_f32_32x32x16_bf16 v[96:111], a[200:203], a[136:139], v[96:111]
    s_add_u32 s30, s30, 1
    v_add_f32 v10, v10, v22
    v_exp_f32 v27, v71
    v_exp_f32 v35, v87
    v_exp_f32 v20, v72
    v_exp_f32 v21, v73
    v_mfma_f32_32x32x16_bf16 v[112:127], a[200:203], a[168:171], v[112:127]
    buffer_load_dwordx4 v6, s[8:11], s23 offen offset:2048 lds
    v_add_f32 v10, v10, v23
    v_cvt_pk_bf16_f32 v129, v22, v23
    v_add_f32 v10, v10, v24
    v_exp_f32 v22, v74
    v_exp_f32 v23, v75
    v_mfma_f32_32x32x16_bf16 v[96:111], a[204:207], a[140:143], v[96:111]
    v_add_f32 v10, v10, v25
    v_cvt_pk_bf16_f32 v130, v24, v25
    v_add_f32 v10, v10, v26
    v_exp_f32 v24, v76
    v_exp_f32 v25, v77
    v_add_f32 v10, v10, v27
    v_cvt_pk_bf16_f32 v131, v26, v27
    v_mfma_f32_32x32x16_bf16 v[112:127], a[204:207], a[172:175], v[112:127]
    buffer_load_dwordx4 v6, s[8:11], s23 offen offset:3072 lds
    v_add_f32 v10, v10, v20
    v_exp_f32 v26, v78
    v_exp_f32 v27, v79
    v_add_f32 v10, v10, v21
    v_cvt_pk_bf16_f32 v132, v20, v21
    v_mfma_f32_32x32x16_bf16 v[96:111], a[208:211], a[144:147], v[96:111]
    s_add_u32 m0, s26, 65536
    v_add_f32 v10, v10, v22
    v_add_f32 v10, v10, v23
    v_cvt_pk_bf16_f32 v133, v22, v23
    v_add_f32 v10, v10, v24
    v_add_f32 v10, v10, v25
    v_cvt_pk_bf16_f32 v134, v24, v25
    v_add_f32 v10, v10, v26
    v_add_f32 v10, v10, v27
    v_cvt_pk_bf16_f32 v135, v26, v27
    v_mfma_f32_32x32x16_bf16 v[112:127], a[208:211], a[176:179], v[112:127]
    buffer_load_dwordx4 v6, s[12:15], s24 offen offset:0 lds
    v_add_f32 v9, v9, v11
    v_add_f32 v11, v28, v29
    v_cvt_pk_bf16_f32 v136, v28, v29
    v_exp_f32 v28, v88
    v_exp_f32 v29, v89
    v_mfma_f32_32x32x16_bf16 v[96:111], a[212:215], a[148:151], v[96:111]
    buffer_load_dwordx4 v6, s[12:15], s24 offen offset:1024 lds
    v_add_f32 v11, v11, v30
    v_add_f32 v11, v11, v31
    v_cvt_pk_bf16_f32 v137, v30, v31
    v_exp_f32 v30, v90
    v_exp_f32 v31, v91
    v_mfma_f32_32x32x16_bf16 v[112:127], a[212:215], a[180:183], v[112:127]
    s_add_u32 s23, s23, 16384
    v_add_f32 v11, v11, v32
    v_add_f32 v11, v11, v33
    v_cvt_pk_bf16_f32 v138, v32, v33
    v_exp_f32 v32, v92
    v_exp_f32 v33, v93
    v_add_f32 v11, v11, v34
    v_add_f32 v11, v11, v35
    v_mfma_f32_32x32x16_bf16 v[96:111], a[216:219], a[152:155], v[96:111]
    buffer_load_dwordx4 v6, s[12:15], s24 offen offset:2048 lds
    v_cvt_pk_bf16_f32 v139, v34, v35
    v_exp_f32 v34, v94
    v_exp_f32 v35, v95
    v_add_f32 v11, v11, v28
    v_add_f32 v11, v11, v29
    v_mfma_f32_32x32x16_bf16 v[112:127], a[216:219], a[184:187], v[112:127]
    v_cvt_pk_bf16_f32 v140, v28, v29
    v_add_f32 v11, v11, v30
    v_add_f32 v11, v11, v31
    v_cvt_pk_bf16_f32 v141, v30, v31
    v_add_f32 v11, v11, v32
    v_add_f32 v11, v11, v33
    v_cvt_pk_bf16_f32 v142, v32, v33
    v_add_f32 v11, v11, v34
    v_add_f32 v11, v11, v35
    v_mfma_f32_32x32x16_bf16 v[96:111], a[220:223], a[156:159], v[96:111]
    buffer_load_dwordx4 v6, s[12:15], s24 offen offset:3072 lds
    v_cvt_pk_bf16_f32 v143, v34, v35
    v_max_f32 v12, v10, v11
    v_cmp_nge_f32 vcc, s32, v12
    v_mfma_f32_32x32x16_bf16 v[112:127], a[220:223], a[188:191], v[112:127]
    s_add_u32 s24, s24, 16384
    s_waitcnt vmcnt(16) lgkmcnt(0)
    s_barrier
    s_add_u32 s26, s25, s27
    s_add_u32 s25, s25, 16384
    s_and_b32 s25, s25, 0xffff
    v_add_u32 v4, s25, v2
    v_add_u32 v5, s25, v3
    ds_read_b128 a[192:195], v4 offset:0
    ds_read_b128 a[196:199], v4 offset:512
    ds_read_b128 a[200:203], v4 offset:1024
    ds_read_b128 a[204:207], v4 offset:1536
    ds_read_b128 a[208:211], v4 offset:2048
    ds_read_b128 a[212:215], v4 offset:2560
    ds_read_b128 a[216:219], v4 offset:3072
    ds_read_b128 a[220:223], v4 offset:3584
    s_waitcnt lgkmcnt(0)
    s_cbranch_vccnz attn_kernel_stub9
attn_kernel_ret10:
attn_kernel_dual11:
    v_mfma_f32_32x32x16_bf16 v[64:79], a[192:195], a[128:131], v[160:175]
    s_bitcmp1_b64 s[28:29], s30
    s_cselect_b32 s32, -1.0, s31
    ds_read_b128 a[224:227], v5 offset:0
    v_exp_f32 v20, v96
    v_exp_f32 v28, v112
    v_mfma_f32_32x32x16_bf16 v[80:95], a[192:195], a[160:163], v[176:191]
    s_mov_b32 m0, s26
    ds_read_b128 a[228:231], v5 offset:2048
    v_add_f32 v8, v8, v10
    v_exp_f32 v21, v97
    v_exp_f32 v29, v113
    v_mfma_f32_32x32x16_bf16 v[64:79], a[196:199], a[132:135], v[64:79]
    buffer_load_dwordx4 v6, s[8:11], s23 offen offset:0 lds
    v_exp_f32 v22, v98
    v_exp_f32 v30, v114
    v_mfma_f32_32x32x16_bf16 v[80:95], a[196:199], a[164:167], v[80:95]
    s_add_u32 s30, s30, 1
    ds_read_b128 a[232:235], v5 offset:4096
    v_add_f32 v10, v20, v21
    v_exp_f32 v23, v99
    v_mfma_f32_32x32x16_bf16 v[64:79], a[200:203], a[136:139], v[64:79]
    ds_read_b128 a[236:239], v5 offset:6144
    v_cvt_pk_bf16_f32 v144, v20, v21
    v_exp_f32 v31, v115
    v_mfma_f32_32x32x16_bf16 v[80:95], a[200:203], a[168:171], v[80:95]
    ds_read_b128 a[240:243], v5 offset:512
    v_add_f32 v10, v10, v22
    v_exp_f32 v24, v100
    v_exp_f32 v32, v116
    v_mfma_f32_32x32x16_bf16 v[64:79], a[204:207], a[140:143], v[64:79]
    buffer_load_dwordx4 v6, s[8:11], s23 offen offset:1024 lds
    v_exp_f32 v25, v101
    v_mfma_f32_32x32x16_bf16 v[80:95], a[204:207], a[172:175], v[80:95]
    ds_read_b128 a[244:247], v5 offset:2560
    v_add_f32 v10, v10, v23
    v_exp_f32 v33, v117
    v_exp_f32 v26, v102
    v_mfma_f32_32x32x16_bf16 v[64:79], a[208:211], a[144:147], v[64:79]
    ds_read_b128 a[248:251], v5 offset:4608
    v_cvt_pk_bf16_f32 v145, v22, v23
    v_exp_f32 v34, v118
    v_mfma_f32_32x32x16_bf16 v[80:95], a[208:211], a[176:179], v[80:95]
    ds_read_b128 a[252:255], v5 offset:6656
    v_add_f32 v10, v10, v24
    v_exp_f32 v27, v103
    v_exp_f32 v35, v119
    v_mfma_f32_32x32x16_bf16 v[64:79], a[212:215], a[148:151], v[64:79]
    buffer_load_dwordx4 v6, s[8:11], s23 offen offset:2048 lds
    v_exp_f32 v20, v104
    v_mfma_f32_32x32x16_bf16 v[80:95], a[212:215], a[180:183], v[80:95]
    v_exp_f32 v21, v105
    v_exp_f32 v22, v106
    v_exp_f32 v23, v107
    v_mfma_f32_32x32x16_bf16 v[64:79], a[216:219], a[152:155], v[64:79]
    v_add_f32 v10, v10, v25
    v_cvt_pk_bf16_f32 v146, v24, v25
    v_exp_f32 v24, v108
    v_mfma_f32_32x32x16_bf16 v[80:95], a[216:219], a[184:187], v[80:95]
    buffer_load_dwordx4 v6, s[8:11], s23 offen offset:3072 lds
    v_exp_f32 v25, v109
    v_add_f32 v10, v10, v26
    v_mfma_f32_32x32x16_bf16 v[64:79], a[220:223], a[156:159], v[64:79]
    s_add_u32 s23, s23, 16384
    v_add_f32 v10, v10, v27
    v_cvt_pk_bf16_f32 v147, v26, v27
    v_exp_f32 v26, v110
    v_mfma_f32_32x32x16_bf16 v[80:95], a[220:223], a[188:191], v[80:95]
    v_add_f32 v10, v10, v20
    v_exp_f32 v27, v111
    v_add_f32 v10, v10, v21
    s_waitcnt lgkmcnt(0)
    v_mfma_f32_32x32x16_bf16 a[0:15], a[224:227], v[128:131], a[0:15]
    ds_read_b128 a[192:195], v4 offset:8192
    v_cvt_pk_bf16_f32 v148, v20, v21
    v_add_f32 v10, v10, v22
    v_add_f32 v10, v10, v23
    v_cvt_pk_bf16_f32 v149, v22, v23
    v_mfma_f32_32x32x16_bf16 a[64:79], a[224:227], v[136:139], a[64:79]
    s_add_u32 m0, s26, 65536
    ds_read_b128 a[196:199], v4 offset:8704
    v_add_f32 v10, v10, v24
    v_add_f32 v10, v10, v25
    v_cvt_pk_bf16_f32 v150, v24, v25
    v_add_f32 v10, v10, v26
    v_mfma_f32_32x32x16_bf16 a[16:31], a[228:231], v[128:131], a[16:31]
    buffer_load_dwordx4 v6, s[12:15], s24 offen offset:0 lds
    v_add_f32 v10, v10, v27
    v_cvt_pk_bf16_f32 v151, v26, v27
    v_add_f32 v9, v9, v11
    v_mfma_f32_32x32x16_bf16 a[80:95], a[228:231], v[136:139], a[80:95]
    ds_read_b128 a[200:203], v4 offset:9216
    v_add_f32 v11, v28, v29
    v_cvt_pk_bf16_f32 v152, v28, v29
    v_add_f32 v11, v11, v30
    v_exp_f32 v28, v120
    v_mfma_f32_32x32x16_bf16 a[32:47], a[232:235], v[128:131], a[32:47]
    ds_read_b128 a[204:207], v4 offset:9728
    v_add_f32 v11, v11, v31
    v_exp_f32 v29, v121
    v_mfma_f32_32x32x16_bf16 a[96:111], a[232:235], v[136:139], a[96:111]
    ds_read_b128 a[208:211], v4 offset:10240
    v_cvt_pk_bf16_f32 v153, v30, v31
    v_exp_f32 v30, v122
    v_exp_f32 v31, v123
    v_mfma_f32_32x32x16_bf16 a[48:63], a[236:239], v[128:131], a[48:63]
    buffer_load_dwordx4 v6, s[12:15], s24 offen offset:1024 lds
    v_add_f32 v11, v11, v32
    v_add_f32 v11, v11, v33
    v_mfma_f32_32x32x16_bf16 a[112:127], a[236:239], v[136:139], a[112:127]
    ds_read_b128 a[212:215], v4 offset:10752
    v_cvt_pk_bf16_f32 v154, v32, v33
    v_exp_f32 v32, v124
    v_exp_f32 v33, v125
    v_mfma_f32_32x32x16_bf16 a[0:15], a[240:243], v[132:135], a[0:15]
    ds_read_b128 a[216:219], v4 offset:11264
    v_add_f32 v11, v11, v34
    v_add_f32 v11, v11, v35
    v_cvt_pk_bf16_f32 v155, v34, v35
    v_mfma_f32_32x32x16_bf16 a[64:79], a[240:243], v[140:143], a[64:79]
    ds_read_b128 a[220:223], v4 offset:11776
    v_add_f32 v11, v11, v28
    v_exp_f32 v34, v126
    v_exp_f32 v35, v127
    v_mfma_f32_32x32x16_bf16 a[16:31], a[244:247], v[132:135], a[16:31]
    buffer_load_dwordx4 v6, s[12:15], s24 offen offset:2048 lds
    v_add_f32 v11, v11, v29
    v_cvt_pk_bf16_f32 v156, v28, v29
    v_mfma_f32_32x32x16_bf16 a[80:95], a[244:247], v[140:143], a[80:95]
    v_add_f32 v11, v11, v30
    v_add_f32 v11, v11, v31
    v_cvt_pk_bf16_f32 v157, v30, v31
    v_add_f32 v11, v11, v32
    v_add_f32 v11, v11, v33
    v_mfma_f32_32x32x16_bf16 a[32:47], a[248:251], v[132:135], a[32:47]
    v_cvt_pk_bf16_f32 v158, v32, v33
    v_add_f32 v11, v11, v34
    v_add_f32 v11, v11, v35
    v_cvt_pk_bf16_f32 v159, v34, v35
    v_mfma_f32_32x32x16_bf16 a[96:111], a[248:251], v[140:143], a[96:111]
    buffer_load_dwordx4 v6, s[12:15], s24 offen offset:3072 lds
    v_max_f32 v12, v10, v11
    v_cmp_nge_f32 vcc, s32, v12
    v_mfma_f32_32x32x16_bf16 a[48:63], a[252:255], v[132:135], a[48:63]
    s_add_u32 s24, s24, 16384
    v_mfma_f32_32x32x16_bf16 a[112:127], a[252:255], v[140:143], a[112:127]
    s_waitcnt lgkmcnt(0)
    s_cbranch_vccnz attn_kernel_stub12
attn_kernel_ret13:
    v_mfma_f32_32x32x16_bf16 v[96:111], a[192:195], a[128:131], v[160:175]
    s_add_u32 s26, s25, s27
    ds_read_b128 a[224:227], v5 offset:8192
    v_add_f32 v8, v8, v10
    v_exp_f32 v20, v64
    v_exp_f32 v28, v80
    v_mfma_f32_32x32x16_bf16 v[112:127], a[192:195], a[160:163], v[176:191]
    s_add_u32 s25, s25, 16384
    ds_read_b128 a[228:231], v5 offset:10240
    v_add_f32 v9, v9, v11
    v_exp_f32 v21, v65
    v_exp_f32 v29, v81
    v_mfma_f32_32x32x16_bf16 v[96:111], a[196:199], a[132:135], v[96:111]
    s_and_b32 s25, s25, 0xffff
    ds_read_b128 a[232:235], v5 offset:12288
    v_add_f32 v10, v20, v21
    v_exp_f32 v22, v66
    v_mfma_f32_32x32x16_bf16 v[112:127], a[196:199], a[164:167], v[112:127]
    s_bitcmp1_b64 s[28:29], s30
    s_cselect_b32 s32, -1.0, s31
    ds_read_b128 a[236:239], v5 offset:14336
    v_exp_f32 v30, v82
    v_mfma_f32_32x32x16_bf16 v[96:111], a[200:203], a[136:139], v[96:111]
    s_add_u32 s30, s30, 1
    ds_read_b128 a[240:243], v5 offset:8704
    v_cvt_pk_bf16_f32 v128, v20, v21
    v_exp_f32 v23, v67
    v_exp_f32 v31, v83
    v_mfma_f32_32x32x16_bf16 v[112:127], a[200:203], a[168:171], v[112:127]
    ds_read_b128 a[244:247], v5 offset:10752
    v_add_f32 v10, v10, v22
    v_exp_f32 v24, v68
    v_mfma_f32_32x32x16_bf16 v[96:111], a[204:207], a[140:143], v[96:111]
    ds_read_b128 a[248:251], v5 offset:12800
    v_add_f32 v10, v10, v23
    v_exp_f32 v32, v84
    v_mfma_f32_32x32x16_bf16 v[112:127], a[204:207], a[172:175], v[112:127]
    ds_read_b128 a[252:255], v5 offset:14848
    v_cvt_pk_bf16_f32 v129, v22, v23
    v_exp_f32 v25, v69
    v_exp_f32 v33, v85
    v_mfma_f32_32x32x16_bf16 v[96:111], a[208:211], a[144:147], v[96:111]
    v_exp_f32 v26, v70
    v_exp_f32 v34, v86
    v_mfma_f32_32x32x16_bf16 v[112:127], a[208:211], a[176:179], v[112:127]
    v_exp_f32 v27, v71
    v_exp_f32 v35, v87
    v_mfma_f32_32x32x16_bf16 v[96:111], a[212:215], a[148:151], v[96:111]
    v_exp_f32 v20, v72
    v_exp_f32 v21, v73
    v_mfma_f32_32x32x16_bf16 v[112:127], a[212:215], a[180:183], v[112:127]
    v_exp_f32 v22, v74
    v_exp_f32 v23, v75
    v_add_f32 v10, v10, v24
    v_mfma_f32_32x32x16_bf16 v[96:111], a[216:219], a[152:155], v[96:111]
    v_add_f32 v10, v10, v25
    v_cvt_pk_bf16_f32 v130, v24, v25
    v_exp_f32 v24, v76
    v_mfma_f32_32x32x16_bf16 v[112:127], a[216:219], a[184:187], v[112:127]
    v_exp_f32 v25, v77
    v_add_f32 v10, v10, v26
    v_add_f32 v10, v10, v27
    v_mfma_f32_32x32x16_bf16 v[96:111], a[220:223], a[156:159], v[96:111]
    v_cvt_pk_bf16_f32 v131, v26, v27
    v_add_f32 v10, v10, v20
    v_exp_f32 v26, v78
    v_exp_f32 v27, v79
    v_mfma_f32_32x32x16_bf16 v[112:127], a[220:223], a[188:191], v[112:127]
    v_add_u32 v4, s25, v2
    v_add_f32 v10, v10, v21
    v_cvt_pk_bf16_f32 v132, v20, v21
    s_waitcnt vmcnt(16) lgkmcnt(0)
    v_mfma_f32_32x32x16_bf16 a[0:15], a[224:227], v[144:147], a[0:15]
    s_barrier
    v_add_u32 v5, s25, v3
    v_mfma_f32_32x32x16_bf16 a[64:79], a[224:227], v[152:155], a[64:79]
    ds_read_b128 a[192:195], v4 offset:0
    v_add_f32 v10, v10, v22
    v_add_f32 v10, v10, v23
    v_cvt_pk_bf16_f32 v133, v22, v23
    v_add_f32 v10, v10, v24
    v_mfma_f32_32x32x16_bf16 a[16:31], a[228:231], v[144:147], a[16:31]
    ds_read_b128 a[196:199], v4 offset:512
    v_add_f32 v10, v10, v25
    v_cvt_pk_bf16_f32 v134, v24, v25
    v_add_f32 v10, v10, v26
    v_add_f32 v10, v10, v27
    v_mfma_f32_32x32x16_bf16 a[80:95], a[228:231], v[152:155], a[80:95]
    ds_read_b128 a[200:203], v4 offset:1024
    v_cvt_pk_bf16_f32 v135, v26, v27
    v_add_f32 v11, v28, v29
    v_cvt_pk_bf16_f32 v136, v28, v29
    v_mfma_f32_32x32x16_bf16 a[32:47], a[232:235], v[144:147], a[32:47]
    ds_read_b128 a[204:207], v4 offset:1536
    v_add_f32 v11, v11, v30
    v_exp_f32 v28, v88
    v_exp_f32 v29, v89
    v_mfma_f32_32x32x16_bf16 a[96:111], a[232:235], v[152:155], a[96:111]
    ds_read_b128 a[208:211], v4 offset:2048
    v_add_f32 v11, v11, v31
    v_cvt_pk_bf16_f32 v137, v30, v31
    v_add_f32 v11, v11, v32
    v_mfma_f32_32x32x16_bf16 a[48:63], a[236:239], v[144:147], a[48:63]
    ds_read_b128 a[212:215], v4 offset:2560
    v_add_f32 v11, v11, v33
    v_exp_f32 v30, v90
    v_mfma_f32_32x32x16_bf16 a[112:127], a[236:239], v[152:155], a[112:127]
    ds_read_b128 a[216:219], v4 offset:3072
    v_cvt_pk_bf16_f32 v138, v32, v33
    v_exp_f32 v31, v91
    v_exp_f32 v32, v92
    v_mfma_f32_32x32x16_bf16 a[0:15], a[240:243], v[148:151], a[0:15]
    ds_read_b128 a[220:223], v4 offset:3584
    v_add_f32 v11, v11, v34
    v_exp_f32 v33, v93
    v_mfma_f32_32x32x16_bf16 a[64:79], a[240:243], v[156:159], a[64:79]
    v_add_f32 v11, v11, v35
    v_cvt_pk_bf16_f32 v139, v34, v35
    v_exp_f32 v34, v94
    v_mfma_f32_32x32x16_bf16 a[16:31], a[244:247], v[148:151], a[16:31]
    v_exp_f32 v35, v95
    v_add_f32 v11, v11, v28
    v_add_f32 v11, v11, v29
    v_mfma_f32_32x32x16_bf16 a[80:95], a[244:247], v[156:159], a[80:95]
    v_cvt_pk_bf16_f32 v140, v28, v29
    v_add_f32 v11, v11, v30
    v_add_f32 v11, v11, v31
    v_cvt_pk_bf16_f32 v141, v30, v31
    v_add_f32 v11, v11, v32
    v_mfma_f32_32x32x16_bf16 a[32:47], a[248:251], v[148:151], a[32:47]
    v_add_f32 v11, v11, v33
    v_cvt_pk_bf16_f32 v142, v32, v33
    v_add_f32 v11, v11, v34
    v_add_f32 v11, v11, v35
    v_mfma_f32_32x32x16_bf16 a[96:111], a[248:251], v[156:159], a[96:111]
    v_cvt_pk_bf16_f32 v143, v34, v35
    v_max_f32 v12, v10, v11
    v_cmp_nge_f32 vcc, s32, v12
    v_mfma_f32_32x32x16_bf16 a[48:63], a[252:255], v[148:151], a[48:63]
    v_mfma_f32_32x32x16_bf16 a[112:127], a[252:255], v[156:159], a[112:127]
    s_waitcnt lgkmcnt(0)
    s_cbranch_vccz attn_kernel_dual11
    v_cmp_lt_f32 vcc, s31, v12
    s_cmp_lg_u32 s30, s33
    s_cbranch_scc1 attn_kernel_e15
    v_add_f32 v176, v176, v17
    v_add_f32 v177, v177, v18
    v_add_f32 v178, v178, v19
    v_add_f32 v179, v179, v53
    v_add_f32 v180, v180, v54
    v_add_f32 v181, v181, v55
    v_add_f32 v182, v182, v56
    v_add_f32 v183, v183, v57
    v_add_f32 v184, v184, v58
    v_add_f32 v185, v185, v59
    v_add_f32 v186, v186, v60
    v_add_f32 v187, v187, v61
    v_add_f32 v188, v188, v62
    v_add_f32 v189, v189, v63
    v_add_f32 v190, v190, v252
    v_add_f32 v191, v191, v253
    s_nop 0
attn_kernel_e15:
    s_cmp_lg_u32 s30, s34
    s_cbranch_scc1 attn_kernel_e16
    v_mov_b32 v176, v13
    v_mov_b32 v177, v13
    v_mov_b32 v178, v13
    v_mov_b32 v179, v13
    v_mov_b32 v180, v13
    v_mov_b32 v181, v13
    v_mov_b32 v182, v13
    v_mov_b32 v183, v13
    v_mov_b32 v184, v13
    v_mov_b32 v185, v13
    v_mov_b32 v186, v13
    v_mov_b32 v187, v13
    v_mov_b32 v188, v13
    v_mov_b32 v189, v13
    v_mov_b32 v190, v13
    v_mov_b32 v191, v13
    s_nop 0
attn_kernel_e16:
    s_cmp_lg_u32 s30, s36
    s_cbranch_scc1 attn_kernel_e17
    v_add_f32 v160, v160, v17
    v_add_f32 v161, v161, v18
    v_add_f32 v162, v162, v19
    v_add_f32 v163, v163, v53
    v_add_f32 v164, v164, v54
    v_add_f32 v165, v165, v55
    v_add_f32 v166, v166, v56
    v_add_f32 v167, v167, v57
    v_add_f32 v168, v168, v58
    v_add_f32 v169, v169, v59
    v_add_f32 v170, v170, v60
    v_add_f32 v171, v171, v61
    v_add_f32 v172, v172, v62
    v_add_f32 v173, v173, v63
    v_add_f32 v174, v174, v252
    v_add_f32 v175, v175, v253
    s_nop 0
attn_kernel_e17:
    s_cbranch_vccnz attn_kernel_rc18
attn_kernel_sp14:
    s_cmp_lg_u32 s30, s35
    s_cbranch_scc1 attn_kernel_dual11
    v_mfma_f32_32x32x16_bf16 v[64:79], a[192:195], a[128:131], v[160:175]
    s_mov_b32 m0, s26
    ds_read_b128 a[224:227], v5 offset:0
    ds_read_b128 a[228:231], v5 offset:2048
    v_add_f32 v8, v8, v10
    v_exp_f32 v20, v96
    v_exp_f32 v28, v112
    v_mfma_f32_32x32x16_bf16 v[64:79], a[196:199], a[132:135], v[64:79]
    ds_read_b128 a[232:235], v5 offset:4096
    buffer_load_dwordx4 v6, s[8:11], s23 offen offset:0 lds
    v_exp_f32 v21, v97
    v_exp_f32 v29, v113
    v_mfma_f32_32x32x16_bf16 v[64:79], a[200:203], a[136:139], v[64:79]
    s_bitcmp1_b64 s[28:29], s30
    s_cselect_b32 s32, -1.0, s31
    ds_read_b128 a[236:239], v5 offset:6144
    ds_read_b128 a[240:243], v5 offset:512
    v_exp_f32 v22, v98
    v_exp_f32 v30, v114
    v_mfma_f32_32x32x16_bf16 v[64:79], a[204:207], a[140:143], v[64:79]
    s_add_u32 s30, s30, 1
    ds_read_b128 a[244:247], v5 offset:2560
    ds_read_b128 a[248:251], v5 offset:4608
    v_add_f32 v10, v20, v21
    v_exp_f32 v23, v99
    v_exp_f32 v31, v115
    v_mfma_f32_32x32x16_bf16 v[64:79], a[208:211], a[144:147], v[64:79]
    ds_read_b128 a[252:255], v5 offset:6656
    v_exp_f32 v24, v100
    v_exp_f32 v32, v116
    v_exp_f32 v25, v101
    v_mfma_f32_32x32x16_bf16 v[64:79], a[212:215], a[148:151], v[64:79]
    buffer_load_dwordx4 v6, s[8:11], s23 offen offset:1024 lds
    v_cvt_pk_bf16_f32 v144, v20, v21
    v_exp_f32 v33, v117
    v_exp_f32 v26, v102
    v_mfma_f32_32x32x16_bf16 v[64:79], a[216:219], a[152:155], v[64:79]
    v_add_f32 v10, v10, v22
    v_exp_f32 v34, v118
    v_exp_f32 v27, v103
    v_mfma_f32_32x32x16_bf16 v[64:79], a[220:223], a[156:159], v[64:79]
    v_exp_f32 v35, v119
    v_exp_f32 v20, v104
    v_exp_f32 v21, v105
    s_waitcnt lgkmcnt(0)
    v_mfma_f32_32x32x16_bf16 a[0:15], a[224:227], v[128:131], a[0:15]
    ds_read_b128 a[192:195], v4 offset:8192
    v_add_f32 v10, v10, v23
    v_cvt_pk_bf16_f32 v145, v22, v23
    v_exp_f32 v22, v106
    v_exp_f32 v23, v107
    v_mfma_f32_32x32x16_bf16 a[64:79], a[224:227], v[136:139], a[64:79]
    ds_read_b128 a[196:199], v4 offset:8704
    v_add_f32 v10, v10, v24
    v_add_f32 v10, v10, v25
    v_cvt_pk_bf16_f32 v146, v24, v25
    v_add_f32 v10, v10, v26
    v_mfma_f32_32x32x16_bf16 a[16:31], a[228:231], v[128:131], a[16:31]
    buffer_load_dwordx4 v6, s[8:11], s23 offen offset:2048 lds
    v_add_f32 v10, v10, v27
    v_exp_f32 v24, v108
    v_exp_f32 v25, v109
    v_mfma_f32_32x32x16_bf16 a[80:95], a[228:231], v[136:139], a[80:95]
    ds_read_b128 a[200:203], v4 offset:9216
    v_cvt_pk_bf16_f32 v147, v26, v27
    v_add_f32 v10, v10, v20
    v_exp_f32 v26, v110
    v_exp_f32 v27, v111
    v_mfma_f32_32x32x16_bf16 a[32:47], a[232:235], v[128:131], a[32:47]
    ds_read_b128 a[204:207], v4 offset:9728
    v_add_f32 v10, v10, v21
    v_cvt_pk_bf16_f32 v148, v20, v21
    v_add_f32 v10, v10, v22
    v_add_f32 v10, v10, v23
    v_cvt_pk_bf16_f32 v149, v22, v23
    v_mfma_f32_32x32x16_bf16 a[96:111], a[232:235], v[136:139], a[96:111]
    ds_read_b128 a[208:211], v4 offset:10240
    v_add_f32 v10, v10, v24
    v_add_f32 v10, v10, v25
    v_cvt_pk_bf16_f32 v150, v24, v25
    v_add_f32 v10, v10, v26
    v_add_f32 v10, v10, v27
    v_mfma_f32_32x32x16_bf16 a[48:63], a[236:239], v[128:131], a[48:63]
    buffer_load_dwordx4 v6, s[8:11], s23 offen offset:3072 lds
    v_cvt_pk_bf16_f32 v151, v26, v27
    v_add_f32 v9, v9, v11
    v_add_f32 v11, v28, v29
    v_cvt_pk_bf16_f32 v152, v28, v29
    v_add_f32 v11, v11, v30
    v_mfma_f32_32x32x16_bf16 a[112:127], a[236:239], v[136:139], a[112:127]
    s_add_u32 s23, s23, 16384
    ds_read_b128 a[212:215], v4 offset:10752
    v_exp_f32 v28, v120
    v_exp_f32 v29, v121
    v_add_f32 v11, v11, v31
    v_mfma_f32_32x32x16_bf16 a[0:15], a[240:243], v[132:135], a[0:15]
    ds_read_b128 a[216:219], v4 offset:11264
    v_cvt_pk_bf16_f32 v153, v30, v31
    v_add_f32 v11, v11, v32
    v_exp_f32 v30, v122
    v_exp_f32 v31, v123
    v_mfma_f32_32x32x16_bf16 a[64:79], a[240:243], v[140:143], a[64:79]
    ds_read_b128 a[220:223], v4 offset:11776
    v_add_f32 v11, v11, v33
    v_cvt_pk_bf16_f32 v154, v32, v33
    v_exp_f32 v32, v124
    v_exp_f32 v33, v125
    v_mfma_f32_32x32x16_bf16 a[16:31], a[244:247], v[132:135], a[16:31]
    s_add_u32 m0, s26, 65536
    v_add_f32 v11, v11, v34
    v_add_f32 v11, v11, v35
    v_cvt_pk_bf16_f32 v155, v34, v35
    v_exp_f32 v34, v126
    v_mfma_f32_32x32x16_bf16 a[80:95], a[244:247], v[140:143], a[80:95]
    buffer_load_dwordx4 v6, s[12:15], s24 offen offset:0 lds
    v_add_f32 v11, v11, v28
    v_exp_f32 v35, v127
    v_add_f32 v11, v11, v29
    v_cvt_pk_bf16_f32 v156, v28, v29
    v_mfma_f32_32x32x16_bf16 a[32:47], a[248:251], v[132:135], a[32:47]
    v_add_f32 v11, v11, v30
    v_add_f32 v11, v11, v31
    v_cvt_pk_bf16_f32 v157, v30, v31
    v_add_f32 v11, v11, v32
    v_add_f32 v11, v11, v33
    v_cvt_pk_bf16_f32 v158, v32, v33
    v_mfma_f32_32x32x16_bf16 a[96:111], a[248:251], v[140:143], a[96:111]
    v_add_f32 v11, v11, v34
    v_add_f32 v11, v11, v35
    v_cvt_pk_bf16_f32 v159, v34, v35
    v_max_f32 v12, v10, v11
    v_cmp_nge_f32 vcc, s32, v12
    v_mfma_f32_32x32x16_bf16 a[48:63], a[252:255], v[132:135], a[48:63]
    v_mfma_f32_32x32x16_bf16 a[112:127], a[252:255], v[140:143], a[112:127]
    s_waitcnt lgkmcnt(0)
    s_cbranch_vccnz attn_kernel_stub19
attn_kernel_ret20:
    v_mfma_f32_32x32x16_bf16 v[96:111], a[192:195], a[128:131], v[160:175]
    s_add_u32 s26, s25, s27
    ds_read_b128 a[224:227], v5 offset:8192
    ds_read_b128 a[228:231], v5 offset:10240
    v_exp_f32 v20, v64
    v_exp_f32 v21, v65
    v_mfma_f32_32x32x16_bf16 v[96:111], a[196:199], a[132:135], v[96:111]
    ds_read_b128 a[232:235], v5 offset:12288
    buffer_load_dwordx4 v6, s[12:15], s24 offen offset:1024 lds
    v_add_f32 v8, v8, v10
    v_exp_f32 v22, v66
    v_mfma_f32_32x32x16_bf16 v[96:111], a[200:203], a[136:139], v[96:111]
    s_add_u32 s25, s25, 16384
    ds_read_b128 a[236:239], v5 offset:14336
    ds_read_b128 a[240:243], v5 offset:8704
    v_exp_f32 v23, v67
    v_mfma_f32_32x32x16_bf16 v[96:111], a[204:207], a[140:143], v[96:111]
    ds_read_b128 a[244:247], v5 offset:10752
    buffer_load_dwordx4 v6, s[12:15], s24 offen offset:2048 lds
    v_add_f32 v10, v20, v21
    v_mfma_f32_32x32x16_bf16 v[96:111], a[208:211], a[144:147], v[96:111]
    s_and_b32 s25, s25, 0xffff
    ds_read_b128 a[248:251], v5 offset:12800
    ds_read_b128 a[252:255], v5 offset:14848
    v_exp_f32 v24, v68
    v_exp_f32 v25, v69
    v_mfma_f32_32x32x16_bf16 v[96:111], a[212:215], a[148:151], v[96:111]
    buffer_load_dwordx4 v6, s[12:15], s24 offen offset:3072 lds
    v_exp_f32 v26, v70
    v_mfma_f32_32x32x16_bf16 v[96:111], a[216:219], a[152:155], v[96:111]
    s_add_u32 s24, s24, 16384
    v_exp_f32 v27, v71
    v_cvt_pk_bf16_f32 v128, v20, v21
    v_mfma_f32_32x32x16_bf16 v[96:111], a[220:223], a[156:159], v[96:111]
    s_bitcmp1_b64 s[28:29], s30
    s_cselect_b32 s32, -1.0, s31
    v_add_u32 v4, s25, v2
    v_add_f32 v10, v10, v22
    v_exp_f32 v20, v72
    s_waitcnt vmcnt(16) lgkmcnt(0)
    v_mfma_f32_32x32x16_bf16 a[0:15], a[224:227], v[144:147], a[0:15]
    s_barrier
    v_add_u32 v5, s25, v3
    v_mfma_f32_32x32x16_bf16 a[64:79], a[224:227], v[152:155], a[64:79]
    s_add_u32 s30, s30, 1
    ds_read_b128 a[192:195], v4 offset:0
    v_add_f32 v10, v10, v23
    v_exp_f32 v21, v73
    v_mfma_f32_32x32x16_bf16 a[16:31], a[228:231], v[144:147], a[16:31]
    buffer_load_dwordx4 v[192:195], v52, s[16:19], s62 offen offset:0
    v_cvt_pk_bf16_f32 v129, v22, v23
    v_add_f32 v10, v10, v24
    v_mfma_f32_32x32x16_bf16 a[80:95], a[228:231], v[152:155], a[80:95]
    ds_read_b128 a[196:199], v4 offset:512
    v_add_f32 v10, v10, v25
    v_exp_f32 v22, v74
    v_mfma_f32_32x32x16_bf16 a[32:47], a[232:235], v[144:147], a[32:47]
    buffer_load_dwordx4 v[196:199], v52, s[16:19], s62 offen offset:1024
    v_exp_f32 v23, v75
    v_cvt_pk_bf16_f32 v130, v24, v25
    v_mfma_f32_32x32x16_bf16 a[96:111], a[232:235], v[152:155], a[96:111]
    ds_read_b128 a[200:203], v4 offset:1024
    v_add_f32 v10, v10, v26
    v_exp_f32 v24, v76
    v_mfma_f32_32x32x16_bf16 a[48:63], a[236:239], v[144:147], a[48:63]
    buffer_load_dwordx4 v[200:203], v52, s[16:19], s62 offen offset:2048
    v_exp_f32 v25, v77
    v_mfma_f32_32x32x16_bf16 a[112:127], a[236:239], v[152:155], a[112:127]
    ds_read_b128 a[204:207], v4 offset:1536
    v_add_f32 v10, v10, v27
    v_cvt_pk_bf16_f32 v131, v26, v27
    v_add_f32 v10, v10, v20
    v_exp_f32 v26, v78
    v_mfma_f32_32x32x16_bf16 a[0:15], a[240:243], v[148:151], a[0:15]
    ds_read_b128 a[208:211], v4 offset:2048
    v_add_f32 v10, v10, v21
    v_exp_f32 v27, v79
    v_mfma_f32_32x32x16_bf16 a[64:79], a[240:243], v[156:159], a[64:79]
    buffer_load_dwordx4 v[204:207], v52, s[16:19], s62 offen offset:3072
    v_cvt_pk_bf16_f32 v132, v20, v21
    v_mfma_f32_32x32x16_bf16 a[16:31], a[244:247], v[148:151], a[16:31]
    ds_read_b128 a[212:215], v4 offset:2560
    v_add_f32 v10, v10, v22
    v_add_f32 v10, v10, v23
    v_cvt_pk_bf16_f32 v133, v22, v23
    v_mfma_f32_32x32x16_bf16 a[80:95], a[244:247], v[156:159], a[80:95]
    buffer_load_dwordx4 v[212:215], v52, s[16:19], s63 offen offset:0
    v_add_f32 v10, v10, v24
    v_add_f32 v10, v10, v25
    v_cvt_pk_bf16_f32 v134, v24, v25
    v_mfma_f32_32x32x16_bf16 a[32:47], a[248:251], v[148:151], a[32:47]
    ds_read_b128 a[216:219], v4 offset:3072
    v_add_f32 v10, v10, v26
    v_add_f32 v10, v10, v27
    v_cvt_pk_bf16_f32 v135, v26, v27
    v_mfma_f32_32x32x16_bf16 a[96:111], a[248:251], v[156:159], a[96:111]
    buffer_load_dwordx4 v[216:219], v52, s[16:19], s63 offen offset:1024
    v_cmp_nge_f32 vcc, s32, v10
    v_mfma_f32_32x32x16_bf16 a[48:63], a[252:255], v[148:151], a[48:63]
    ds_read_b128 a[220:223], v4 offset:3584
    v_mfma_f32_32x32x16_bf16 a[112:127], a[252:255], v[156:159], a[112:127]
    s_waitcnt lgkmcnt(0)
    s_cbranch_vccnz attn_kernel_stub21
attn_kernel_ret22:
    v_add_f32 v36, v9, v11
    v_mov_b32 v37, v36
    s_nop 1
    v_permlane32_swap_b32 v36, v37
    s_nop 1
    v_add_f32 v36, v36, v37
    v_rcp_f32 v12, v36
    s_lshl_b32 s48, s57, 10
    s_add_u32 s48, s48, s60
    s_add_u32 s48, s48, 67108864
    s_nop 7
    v_accvgpr_read_b32 v36, a64
    v_accvgpr_read_b32 v37, a65
    v_accvgpr_read_b32 v38, a66
    v_accvgpr_read_b32 v39, a67
    v_accvgpr_read_b32 v40, a68
    v_accvgpr_read_b32 v41, a69
    v_accvgpr_read_b32 v42, a70
    v_accvgpr_read_b32 v43, a71
    v_mul_f32 v36, v12, v36
    v_mul_f32 v37, v12, v37
    v_mul_f32 v38, v12, v38
    v_mul_f32 v39, v12, v39
    v_mul_f32 v40, v12, v40
    v_mul_f32 v41, v12, v41
    v_mul_f32 v42, v12, v42
    v_mul_f32 v43, v12, v43
    v_cvt_pk_bf16_f32 v36, v36, v37
    v_cvt_pk_bf16_f32 v37, v38, v39
    v_cvt_pk_bf16_f32 v38, v40, v41
    v_cvt_pk_bf16_f32 v39, v42, v43
    buffer_store_dwordx4 v[36:39], v16, s[16:19], s48 offen offset:0 sc1
    buffer_load_dwordx4 v[220:223], v52, s[16:19], s63 offen offset:2048
    v_accvgpr_read_b32 v44, a72
    v_accvgpr_read_b32 v45, a73
    v_accvgpr_read_b32 v46, a74
    v_accvgpr_read_b32 v47, a75
    v_accvgpr_read_b32 v48, a76
    v_accvgpr_read_b32 v49, a77
    v_accvgpr_read_b32 v50, a78
    v_accvgpr_read_b32 v51, a79
    v_mul_f32 v44, v12, v44
    v_mul_f32 v45, v12, v45
    v_mul_f32 v46, v12, v46
    v_mul_f32 v47, v12, v47
    v_mul_f32 v48, v12, v48
    v_mul_f32 v49, v12, v49
    v_mul_f32 v50, v12, v50
    v_mul_f32 v51, v12, v51
    v_cvt_pk_bf16_f32 v44, v44, v45
    v_cvt_pk_bf16_f32 v45, v46, v47
    v_cvt_pk_bf16_f32 v46, v48, v49
    v_cvt_pk_bf16_f32 v47, v50, v51
    buffer_store_dwordx4 v[44:47], v16, s[16:19], s48 offen offset:512 sc1
    buffer_load_dwordx4 v[224:227], v52, s[16:19], s63 offen offset:3072
    s_add_u32 s48, s48, 131072
    v_accvgpr_read_b32 v36, a80
    v_accvgpr_read_b32 v37, a81
    v_accvgpr_read_b32 v38, a82
    v_accvgpr_read_b32 v39, a83
    v_accvgpr_read_b32 v40, a84
    v_accvgpr_read_b32 v41, a85
    v_accvgpr_read_b32 v42, a86
    v_accvgpr_read_b32 v43, a87
    v_mul_f32 v36, v12, v36
    v_mul_f32 v37, v12, v37
    v_mul_f32 v38, v12, v38
    v_mul_f32 v39, v12, v39
    v_mul_f32 v40, v12, v40
    v_mul_f32 v41, v12, v41
    v_mul_f32 v42, v12, v42
    v_mul_f32 v43, v12, v43
    v_cvt_pk_bf16_f32 v36, v36, v37
    v_cvt_pk_bf16_f32 v37, v38, v39
    v_cvt_pk_bf16_f32 v38, v40, v41
    v_cvt_pk_bf16_f32 v39, v42, v43
    buffer_store_dwordx4 v[36:39], v16, s[16:19], s48 offen offset:0 sc1
    buffer_load_dwordx4 v[208:211], v52, s[16:19], s64 offen offset:0
    v_accvgpr_read_b32 v44, a88
    v_accvgpr_read_b32 v45, a89
    v_accvgpr_read_b32 v46, a90
    v_accvgpr_read_b32 v47, a91
    v_accvgpr_read_b32 v48, a92
    v_accvgpr_read_b32 v49, a93
    v_accvgpr_read_b32 v50, a94
    v_accvgpr_read_b32 v51, a95
    v_mul_f32 v44, v12, v44
    v_mul_f32 v45, v12, v45
    v_mul_f32 v46, v12, v46
    v_mul_f32 v47, v12, v47
    v_mul_f32 v48, v12, v48
    v_mul_f32 v49, v12, v49
    v_mul_f32 v50, v12, v50
    v_mul_f32 v51, v12, v51
    v_cvt_pk_bf16_f32 v44, v44, v45
    v_cvt_pk_bf16_f32 v45, v46, v47
    v_cvt_pk_bf16_f32 v46, v48, v49
    v_cvt_pk_bf16_f32 v47, v50, v51
    buffer_store_dwordx4 v[44:47], v16, s[16:19], s48 offen offset:512 sc1
    buffer_load_dwordx4 v[232:235], v52, s[16:19], s65 offen offset:0
    s_add_u32 s48, s48, 131072
    v_accvgpr_read_b32 v36, a96
    v_accvgpr_read_b32 v37, a97
    v_accvgpr_read_b32 v38, a98
    v_accvgpr_read_b32 v39, a99
    v_accvgpr_read_b32 v40, a100
    v_accvgpr_read_b32 v41, a101
    v_accvgpr_read_b32 v42, a102
    v_accvgpr_read_b32 v43, a103
    v_mul_f32 v36, v12, v36
    v_mul_f32 v37, v12, v37
    v_mul_f32 v38, v12, v38
    v_mul_f32 v39, v12, v39
    v_mul_f32 v40, v12, v40
    v_mul_f32 v41, v12, v41
    v_mul_f32 v42, v12, v42
    v_mul_f32 v43, v12, v43
    v_cvt_pk_bf16_f32 v36, v36, v37
    v_cvt_pk_bf16_f32 v37, v38, v39
    v_cvt_pk_bf16_f32 v38, v40, v41
    v_cvt_pk_bf16_f32 v39, v42, v43
    buffer_store_dwordx4 v[36:39], v16, s[16:19], s48 offen offset:0 sc1
    buffer_load_dwordx4 v[236:239], v52, s[16:19], s65 offen offset:1024
    v_accvgpr_read_b32 v44, a104
    v_accvgpr_read_b32 v45, a105
    v_accvgpr_read_b32 v46, a106
    v_accvgpr_read_b32 v47, a107
    v_accvgpr_read_b32 v48, a108
    v_accvgpr_read_b32 v49, a109
    v_accvgpr_read_b32 v50, a110
    v_accvgpr_read_b32 v51, a111
    v_mul_f32 v44, v12, v44
    v_mul_f32 v45, v12, v45
    v_mul_f32 v46, v12, v46
    v_mul_f32 v47, v12, v47
    v_mul_f32 v48, v12, v48
    v_mul_f32 v49, v12, v49
    v_mul_f32 v50, v12, v50
    v_mul_f32 v51, v12, v51
    v_cvt_pk_bf16_f32 v44, v44, v45
    v_cvt_pk_bf16_f32 v45, v46, v47
    v_cvt_pk_bf16_f32 v46, v48, v49
    v_cvt_pk_bf16_f32 v47, v50, v51
    buffer_store_dwordx4 v[44:47], v16, s[16:19], s48 offen offset:512 sc1
    buffer_load_dwordx4 v[228:231], v52, s[16:19], s66 offen offset:0
    s_add_u32 s48, s48, 131072
    v_accvgpr_read_b32 v36, a112
    v_accvgpr_read_b32 v37, a113
    v_accvgpr_read_b32 v38, a114
    v_accvgpr_read_b32 v39, a115
    v_accvgpr_read_b32 v40, a116
    v_accvgpr_read_b32 v41, a117
    v_accvgpr_read_b32 v42, a118
    v_accvgpr_read_b32 v43, a119
    v_mul_f32 v36, v12, v36
    v_mul_f32 v37, v12, v37
    v_mul_f32 v38, v12, v38
    v_mul_f32 v39, v12, v39
    v_mul_f32 v40, v12, v40
    v_mul_f32 v41, v12, v41
    v_mul_f32 v42, v12, v42
    v_mul_f32 v43, v12, v43
    v_cvt_pk_bf16_f32 v36, v36, v37
    v_cvt_pk_bf16_f32 v37, v38, v39
    v_cvt_pk_bf16_f32 v38, v40, v41
    v_cvt_pk_bf16_f32 v39, v42, v43
    buffer_store_dwordx4 v[36:39], v16, s[16:19], s48 offen offset:0 sc1
    buffer_load_dwordx4 v[244:247], v52, s[16:19], s67 offen offset:0
    v_accvgpr_read_b32 v44, a120
    v_accvgpr_read_b32 v45, a121
    v_accvgpr_read_b32 v46, a122
    v_accvgpr_read_b32 v47, a123
    v_accvgpr_read_b32 v48, a124
    v_accvgpr_read_b32 v49, a125
    v_accvgpr_read_b32 v50, a126
    v_accvgpr_read_b32 v51, a127
    v_mul_f32 v44, v12, v44
    v_mul_f32 v45, v12, v45
    v_mul_f32 v46, v12, v46
    v_mul_f32 v47, v12, v47
    v_mul_f32 v48, v12, v48
    v_mul_f32 v49, v12, v49
    v_mul_f32 v50, v12, v50
    v_mul_f32 v51, v12, v51
    v_cvt_pk_bf16_f32 v44, v44, v45
    v_cvt_pk_bf16_f32 v45, v46, v47
    v_cvt_pk_bf16_f32 v46, v48, v49
    v_cvt_pk_bf16_f32 v47, v50, v51
    buffer_store_dwordx4 v[44:47], v16, s[16:19], s48 offen offset:512 sc1
    buffer_load_dwordx4 v[248:251], v52, s[16:19], s67 offen offset:1024
    s_add_u32 s48, s48, 131072
    buffer_load_dwordx4 v[240:243], v52, s[16:19], s68 offen offset:0
attn_kernel_single23:
    v_mfma_f32_32x32x16_bf16 v[64:79], a[192:195], a[128:131], v[160:175]
    s_mov_b32 m0, s26
    ds_read_b128 a[224:227], v5 offset:0
    ds_read_b128 a[228:231], v5 offset:2048
    v_exp_f32 v20, v96
    v_exp_f32 v21, v97
    v_mfma_f32_32x32x16_bf16 v[64:79], a[196:199], a[132:135], v[64:79]
    ds_read_b128 a[232:235], v5 offset:4096
    buffer_load_dwordx4 v6, s[8:11], s23 offen offset:0 lds
    v_add_f32 v8, v8, v10
    v_exp_f32 v22, v98
    v_mfma_f32_32x32x16_bf16 v[64:79], a[200:203], a[136:139], v[64:79]
    s_bitcmp1_b64 s[28:29], s30
    s_cselect_b32 s32, -1.0, s31
    ds_read_b128 a[236:239], v5 offset:6144
    ds_read_b128 a[240:243], v5 offset:512
    v_add_f32 v10, v20, v21
    v_exp_f32 v23, v99
    v_mfma_f32_32x32x16_bf16 v[64:79], a[204:207], a[140:143], v[64:79]
    ds_read_b128 a[244:247], v5 offset:2560
    buffer_load_dwordx4 v6, s[8:11], s23 offen offset:1024 lds
    v_cvt_pk_bf16_f32 v144, v20, v21
    v_exp_f32 v24, v100
    v_mfma_f32_32x32x16_bf16 v[64:79], a[208:211], a[144:147], v[64:79]
    s_add_u32 s30, s30, 1
    ds_read_b128 a[248:251], v5 offset:4608
    ds_read_b128 a[252:255], v5 offset:6656
    v_exp_f32 v25, v101
    v_exp_f32 v26, v102
    v_mfma_f32_32x32x16_bf16 v[64:79], a[212:215], a[148:151], v[64:79]
    buffer_load_dwordx4 v6, s[8:11], s23 offen offset:2048 lds
    v_exp_f32 v27, v103
    v_exp_f32 v20, v104
    v_mfma_f32_32x32x16_bf16 v[64:79], a[216:219], a[152:155], v[64:79]
    v_exp_f32 v21, v105
    v_add_f32 v10, v10, v22
    v_add_f32 v10, v10, v23
    v_cvt_pk_bf16_f32 v145, v22, v23
    v_add_f32 v10, v10, v24
    v_mfma_f32_32x32x16_bf16 v[64:79], a[220:223], a[156:159], v[64:79]
    v_add_f32 v10, v10, v25
    v_exp_f32 v22, v106
    v_exp_f32 v23, v107
    s_waitcnt lgkmcnt(0)
    v_mfma_f32_32x32x16_bf16 a[0:15], a[224:227], v[128:131], a[0:15]
    ds_read_b128 a[192:195], v4 offset:8192
    ds_read_b128 a[196:199], v4 offset:8704
    v_cvt_pk_bf16_f32 v146, v24, v25
    v_add_f32 v10, v10, v26
    v_exp_f32 v24, v108
    v_mfma_f32_32x32x16_bf16 a[16:31], a[228:231], v[128:131], a[16:31]
    ds_read_b128 a[200:203], v4 offset:9216
    buffer_load_dwordx4 v6, s[8:11], s23 offen offset:3072 lds
    v_add_f32 v10, v10, v27
    v_exp_f32 v25, v109
    v_mfma_f32_32x32x16_bf16 a[32:47], a[232:235], v[128:131], a[32:47]
    s_add_u32 m0, s26, 65536
    ds_read_b128 a[204:207], v4 offset:9728
    ds_read_b128 a[208:211], v4 offset:10240
    v_cvt_pk_bf16_f32 v147, v26, v27
    v_add_f32 v10, v10, v20
    v_exp_f32 v26, v110
    v_mfma_f32_32x32x16_bf16 a[48:63], a[236:239], v[128:131], a[48:63]
    ds_read_b128 a[212:215], v4 offset:10752
    buffer_load_dwordx4 v6, s[12:15], s24 offen offset:0 lds
    v_add_f32 v10, v10, v21
    v_exp_f32 v27, v111
    v_mfma_f32_32x32x16_bf16 a[0:15], a[240:243], v[132:135], a[0:15]
    s_add_u32 s23, s23, 16384
    ds_read_b128 a[216:219], v4 offset:11264
    ds_read_b128 a[220:223], v4 offset:11776
    v_cvt_pk_bf16_f32 v148, v20, v21
    v_add_f32 v10, v10, v22
    v_add_f32 v10, v10, v23
    v_cvt_pk_bf16_f32 v149, v22, v23
    v_mfma_f32_32x32x16_bf16 a[16:31], a[244:247], v[132:135], a[16:31]
    buffer_load_dwordx4 v6, s[12:15], s24 offen offset:1024 lds
    v_add_f32 v10, v10, v24
    v_add_f32 v10, v10, v25
    v_cvt_pk_bf16_f32 v150, v24, v25
    v_add_f32 v10, v10, v26
    v_mfma_f32_32x32x16_bf16 a[32:47], a[248:251], v[132:135], a[32:47]
    v_add_f32 v10, v10, v27
    v_cvt_pk_bf16_f32 v151, v26, v27
    v_cmp_nge_f32 vcc, s32, v10
    v_mfma_f32_32x32x16_bf16 a[48:63], a[252:255], v[132:135], a[48:63]
    s_waitcnt lgkmcnt(0)
    s_cbranch_vccnz attn_kernel_stub24
attn_kernel_ret25:
    v_mfma_f32_32x32x16_bf16 v[96:111], a[192:195], a[128:131], v[160:175]
    s_add_u32 s26, s25, s27
    ds_read_b128 a[224:227], v5 offset:8192
    ds_read_b128 a[228:231], v5 offset:10240
    v_exp_f32 v20, v64
    v_exp_f32 v21, v65
    v_mfma_f32_32x32x16_bf16 v[96:111], a[196:199], a[132:135], v[96:111]
    ds_read_b128 a[232:235], v5 offset:12288
    buffer_load_dwordx4 v6, s[12:15], s24 offen offset:2048 lds
    v_add_f32 v8, v8, v10
    v_exp_f32 v22, v66
    v_mfma_f32_32x32x16_bf16 v[96:111], a[200:203], a[136:139], v[96:111]
    s_add_u32 s25, s25, 16384
    ds_read_b128 a[236:239], v5 offset:14336
    ds_read_b128 a[240:243], v5 offset:8704
    v_exp_f32 v23, v67
    v_exp_f32 v24, v68
    v_mfma_f32_32x32x16_bf16 v[96:111], a[204:207], a[140:143], v[96:111]
    s_and_b32 s25, s25, 0xffff
    ds_read_b128 a[244:247], v5 offset:10752
    ds_read_b128 a[248:251], v5 offset:12800
    v_exp_f32 v25, v69
    v_exp_f32 v26, v70
    v_mfma_f32_32x32x16_bf16 v[96:111], a[208:211], a[144:147], v[96:111]
    s_bitcmp1_b64 s[28:29], s30
    s_cselect_b32 s32, -1.0, s31
    ds_read_b128 a[252:255], v5 offset:14848
    v_exp_f32 v27, v71
    v_add_f32 v10, v20, v21
    v_cvt_pk_bf16_f32 v128, v20, v21
    v_mfma_f32_32x32x16_bf16 v[96:111], a[212:215], a[148:151], v[96:111]
    buffer_load_dwordx4 v6, s[12:15], s24 offen offset:3072 lds
    v_exp_f32 v20, v72
    v_exp_f32 v21, v73
    v_mfma_f32_32x32x16_bf16 v[96:111], a[216:219], a[152:155], v[96:111]
    s_add_u32 s24, s24, 16384
    v_add_f32 v10, v10, v22
    v_add_f32 v10, v10, v23
    v_cvt_pk_bf16_f32 v129, v22, v23
    v_add_f32 v10, v10, v24
    v_exp_f32 v22, v74
    v_mfma_f32_32x32x16_bf16 v[96:111], a[220:223], a[156:159], v[96:111]
    s_add_u32 s30, s30, 1
    v_add_u32 v4, s25, v2
    v_exp_f32 v23, v75
    v_add_f32 v10, v10, v25
    v_cvt_pk_bf16_f32 v130, v24, v25
    s_waitcnt vmcnt(16) lgkmcnt(0)
    v_mfma_f32_32x32x16_bf16 a[0:15], a[224:227], v[144:147], a[0:15]
    s_barrier
    v_add_u32 v5, s25, v3
    v_add_f32 v10, v10, v26
    v_mfma_f32_32x32x16_bf16 a[16:31], a[228:231], v[144:147], a[16:31]
    ds_read_b128 a[192:195], v4 offset:0
    ds_read_b128 a[196:199], v4 offset:512
    v_exp_f32 v24, v76
    v_exp_f32 v25, v77
    v_mfma_f32_32x32x16_bf16 a[32:47], a[232:235], v[144:147], a[32:47]
    ds_read_b128 a[200:203], v4 offset:1024
    ds_read_b128 a[204:207], v4 offset:1536
    v_add_f32 v10, v10, v27
    v_cvt_pk_bf16_f32 v131, v26, v27
    v_exp_f32 v26, v78
    v_mfma_f32_32x32x16_bf16 a[48:63], a[236:239], v[144:147], a[48:63]
    ds_read_b128 a[208:211], v4 offset:2048
    ds_read_b128 a[212:215], v4 offset:2560
    v_exp_f32 v27, v79
    v_add_f32 v10, v10, v20
    v_add_f32 v10, v10, v21
    v_mfma_f32_32x32x16_bf16 a[0:15], a[240:243], v[148:151], a[0:15]
    ds_read_b128 a[216:219], v4 offset:3072
    ds_read_b128 a[220:223], v4 offset:3584
    v_cvt_pk_bf16_f32 v132, v20, v21
    v_add_f32 v10, v10, v22
    v_add_f32 v10, v10, v23
    v_cvt_pk_bf16_f32 v133, v22, v23
    v_mfma_f32_32x32x16_bf16 a[16:31], a[244:247], v[148:151], a[16:31]
    v_add_f32 v10, v10, v24
    v_add_f32 v10, v10, v25
    v_cvt_pk_bf16_f32 v134, v24, v25
    v_add_f32 v10, v10, v26
    v_add_f32 v10, v10, v27
    v_cvt_pk_bf16_f32 v135, v26, v27
    v_mfma_f32_32x32x16_bf16 a[32:47], a[248:251], v[148:151], a[32:47]
    v_cmp_nge_f32 vcc, s32, v10
    v_mfma_f32_32x32x16_bf16 a[48:63], a[252:255], v[148:151], a[48:63]
    s_waitcnt lgkmcnt(0)
    s_cbranch_vccz attn_kernel_single23
    v_cmp_lt_f32 vcc, s31, v10
    s_cmp_lg_u32 s30, s36
    s_cbranch_scc1 attn_kernel_e27
    v_add_f32 v160, v160, v17
    v_add_f32 v161, v161, v18
    v_add_f32 v162, v162, v19
    v_add_f32 v163, v163, v53
    v_add_f32 v164, v164, v54
    v_add_f32 v165, v165, v55
    v_add_f32 v166, v166, v56
    v_add_f32 v167, v167, v57
    v_add_f32 v168, v168, v58
    v_add_f32 v169, v169, v59
    v_add_f32 v170, v170, v60
    v_add_f32 v171, v171, v61
    v_add_f32 v172, v172, v62
    v_add_f32 v173, v173, v63
    v_add_f32 v174, v174, v252
    v_add_f32 v175, v175, v253
    s_nop 0
attn_kernel_e27:
    s_cmp_lg_u32 s30, s37
    s_cbranch_scc1 attn_kernel_e28
    v_mov_b32 v160, v13
    v_mov_b32 v161, v13
    v_mov_b32 v162, v13
    v_mov_b32 v163, v13
    v_mov_b32 v164, v13
    v_mov_b32 v165, v13
    v_mov_b32 v166, v13
    v_mov_b32 v167, v13
    v_mov_b32 v168, v13
    v_mov_b32 v169, v13
    v_mov_b32 v170, v13
    v_mov_b32 v171, v13
    v_mov_b32 v172, v13
    v_mov_b32 v173, v13
    v_mov_b32 v174, v13
    v_mov_b32 v175, v13
    s_nop 0
attn_kernel_e28:
    s_cbranch_vccnz attn_kernel_rc29
attn_kernel_sp26:
    s_cmp_lg_u32 s30, s38
    s_cbranch_scc1 attn_kernel_single23
    ds_read_b128 a[224:227], v5 offset:0
    ds_read_b128 a[228:231], v5 offset:2048
    ds_read_b128 a[232:235], v5 offset:4096
    ds_read_b128 a[236:239], v5 offset:6144
    ds_read_b128 a[240:243], v5 offset:512
    ds_read_b128 a[244:247], v5 offset:2560
    ds_read_b128 a[248:251], v5 offset:4608
    ds_read_b128 a[252:255], v5 offset:6656
    s_waitcnt lgkmcnt(0)
    v_mfma_f32_32x32x16_bf16 a[0:15], a[224:227], v[128:131], a[0:15]
    v_add_f32 v8, v8, v10
    v_exp_f32 v20, v96
    v_exp_f32 v21, v97
    v_exp_f32 v22, v98
    v_exp_f32 v23, v99
    v_mfma_f32_32x32x16_bf16 a[16:31], a[228:231], v[128:131], a[16:31]
    v_add_f32 v10, v20, v21
    v_exp_f32 v24, v100
    v_exp_f32 v25, v101
    v_exp_f32 v26, v102
    v_exp_f32 v27, v103
    v_mfma_f32_32x32x16_bf16 a[32:47], a[232:235], v[128:131], a[32:47]
    v_cvt_pk_bf16_f32 v144, v20, v21
    v_exp_f32 v20, v104
    v_exp_f32 v21, v105
    v_add_f32 v10, v10, v22
    v_add_f32 v10, v10, v23
    v_cvt_pk_bf16_f32 v145, v22, v23
    v_add_f32 v10, v10, v24
    v_mfma_f32_32x32x16_bf16 a[48:63], a[236:239], v[128:131], a[48:63]
    v_add_f32 v10, v10, v25
    v_exp_f32 v22, v106
    v_exp_f32 v23, v107
    v_cvt_pk_bf16_f32 v146, v24, v25
    v_add_f32 v10, v10, v26
    v_exp_f32 v24, v108
    v_mfma_f32_32x32x16_bf16 a[0:15], a[240:243], v[132:135], a[0:15]
    v_add_f32 v10, v10, v27
    v_exp_f32 v25, v109
    v_cvt_pk_bf16_f32 v147, v26, v27
    v_add_f32 v10, v10, v20
    v_exp_f32 v26, v110
    v_exp_f32 v27, v111
    v_mfma_f32_32x32x16_bf16 a[16:31], a[244:247], v[132:135], a[16:31]
    v_add_f32 v10, v10, v21
    v_cvt_pk_bf16_f32 v148, v20, v21
    v_add_f32 v10, v10, v22
    v_add_f32 v10, v10, v23
    v_cvt_pk_bf16_f32 v149, v22, v23
    v_add_f32 v10, v10, v24
    v_add_f32 v10, v10, v25
    v_cvt_pk_bf16_f32 v150, v24, v25
    v_add_f32 v10, v10, v26
    v_mfma_f32_32x32x16_bf16 a[32:47], a[248:251], v[132:135], a[32:47]
    v_add_f32 v10, v10, v27
    v_cvt_pk_bf16_f32 v151, v26, v27
    v_cmp_nge_f32 vcc, s31, v10
    v_mfma_f32_32x32x16_bf16 a[48:63], a[252:255], v[132:135], a[48:63]
    s_cbranch_vccnz attn_kernel_stub30
attn_kernel_ret31:
    s_nop 1
    ds_read_b128 a[224:227], v5 offset:8192
    ds_read_b128 a[228:231], v5 offset:10240
    ds_read_b128 a[232:235], v5 offset:12288
    ds_read_b128 a[236:239], v5 offset:14336
    ds_read_b128 a[240:243], v5 offset:8704
    ds_read_b128 a[244:247], v5 offset:10752
    ds_read_b128 a[248:251], v5 offset:12800
    ds_read_b128 a[252:255], v5 offset:14848
    s_waitcnt lgkmcnt(0)
    v_mfma_f32_32x32x16_bf16 a[0:15], a[224:227], v[144:147], a[0:15]
    v_mfma_f32_32x32x16_bf16 a[16:31], a[228:231], v[144:147], a[16:31]
    v_mfma_f32_32x32x16_bf16 a[32:47], a[232:235], v[144:147], a[32:47]
    v_mfma_f32_32x32x16_bf16 a[48:63], a[236:239], v[144:147], a[48:63]
    v_mfma_f32_32x32x16_bf16 a[0:15], a[240:243], v[148:151], a[0:15]
    v_mfma_f32_32x32x16_bf16 a[16:31], a[244:247], v[148:151], a[16:31]
    v_mfma_f32_32x32x16_bf16 a[32:47], a[248:251], v[148:151], a[32:47]
    v_mfma_f32_32x32x16_bf16 a[48:63], a[252:255], v[148:151], a[48:63]
    v_add_f32 v36, v8, v10
    v_mov_b32 v37, v36
    s_nop 1
    v_permlane32_swap_b32 v36, v37
    s_nop 1
    v_add_f32 v36, v36, v37
    v_rcp_f32 v12, v36
    s_lshl_b32 s48, s56, 10
    s_add_u32 s48, s48, s60
    s_add_u32 s48, s48, 67108864
    s_nop 7
    v_accvgpr_read_b32 v36, a0
    v_accvgpr_read_b32 v37, a1
    v_accvgpr_read_b32 v38, a2
    v_accvgpr_read_b32 v39, a3
    v_accvgpr_read_b32 v40, a4
    v_accvgpr_read_b32 v41, a5
    v_accvgpr_read_b32 v42, a6
    v_accvgpr_read_b32 v43, a7
    v_mul_f32 v36, v12, v36
    v_mul_f32 v37, v12, v37
    v_mul_f32 v38, v12, v38
    v_mul_f32 v39, v12, v39
    v_mul_f32 v40, v12, v40
    v_mul_f32 v41, v12, v41
    v_mul_f32 v42, v12, v42
    v_mul_f32 v43, v12, v43
    v_cvt_pk_bf16_f32 v36, v36, v37
    v_cvt_pk_bf16_f32 v37, v38, v39
    v_cvt_pk_bf16_f32 v38, v40, v41
    v_cvt_pk_bf16_f32 v39, v42, v43
    buffer_store_dwordx4 v[36:39], v16, s[16:19], s48 offen offset:0 sc1
    v_accvgpr_read_b32 v44, a8
    v_accvgpr_read_b32 v45, a9
    v_accvgpr_read_b32 v46, a10
    v_accvgpr_read_b32 v47, a11
    v_accvgpr_read_b32 v48, a12
    v_accvgpr_read_b32 v49, a13
    v_accvgpr_read_b32 v50, a14
    v_accvgpr_read_b32 v51, a15
    v_mul_f32 v44, v12, v44
    v_mul_f32 v45, v12, v45
    v_mul_f32 v46, v12, v46
    v_mul_f32 v47, v12, v47
    v_mul_f32 v48, v12, v48
    v_mul_f32 v49, v12, v49
    v_mul_f32 v50, v12, v50
    v_mul_f32 v51, v12, v51
    v_cvt_pk_bf16_f32 v44, v44, v45
    v_cvt_pk_bf16_f32 v45, v46, v47
    v_cvt_pk_bf16_f32 v46, v48, v49
    v_cvt_pk_bf16_f32 v47, v50, v51
    buffer_store_dwordx4 v[44:47], v16, s[16:19], s48 offen offset:512 sc1
    s_add_u32 s48, s48, 131072
    v_accvgpr_read_b32 v36, a16
    v_accvgpr_read_b32 v37, a17
    v_accvgpr_read_b32 v38, a18
    v_accvgpr_read_b32 v39, a19
    v_accvgpr_read_b32 v40, a20
    v_accvgpr_read_b32 v41, a21
    v_accvgpr_read_b32 v42, a22
    v_accvgpr_read_b32 v43, a23
    v_mul_f32 v36, v12, v36
    v_mul_f32 v37, v12, v37
    v_mul_f32 v38, v12, v38
    v_mul_f32 v39, v12, v39
    v_mul_f32 v40, v12, v40
    v_mul_f32 v41, v12, v41
    v_mul_f32 v42, v12, v42
    v_mul_f32 v43, v12, v43
    v_cvt_pk_bf16_f32 v36, v36, v37
    v_cvt_pk_bf16_f32 v37, v38, v39
    v_cvt_pk_bf16_f32 v38, v40, v41
    v_cvt_pk_bf16_f32 v39, v42, v43
    buffer_store_dwordx4 v[36:39], v16, s[16:19], s48 offen offset:0 sc1
    v_accvgpr_read_b32 v44, a24
    v_accvgpr_read_b32 v45, a25
    v_accvgpr_read_b32 v46, a26
    v_accvgpr_read_b32 v47, a27
    v_accvgpr_read_b32 v48, a28
    v_accvgpr_read_b32 v49, a29
    v_accvgpr_read_b32 v50, a30
    v_accvgpr_read_b32 v51, a31
    v_mul_f32 v44, v12, v44
    v_mul_f32 v45, v12, v45
    v_mul_f32 v46, v12, v46
    v_mul_f32 v47, v12, v47
    v_mul_f32 v48, v12, v48
    v_mul_f32 v49, v12, v49
    v_mul_f32 v50, v12, v50
    v_mul_f32 v51, v12, v51
    v_cvt_pk_bf16_f32 v44, v44, v45
    v_cvt_pk_bf16_f32 v45, v46, v47
    v_cvt_pk_bf16_f32 v46, v48, v49
    v_cvt_pk_bf16_f32 v47, v50, v51
    buffer_store_dwordx4 v[44:47], v16, s[16:19], s48 offen offset:512 sc1
    s_add_u32 s48, s48, 131072
    v_accvgpr_read_b32 v36, a32
    v_accvgpr_read_b32 v37, a33
    v_accvgpr_read_b32 v38, a34
    v_accvgpr_read_b32 v39, a35
    v_accvgpr_read_b32 v40, a36
    v_accvgpr_read_b32 v41, a37
    v_accvgpr_read_b32 v42, a38
    v_accvgpr_read_b32 v43, a39
    v_mul_f32 v36, v12, v36
    v_mul_f32 v37, v12, v37
    v_mul_f32 v38, v12, v38
    v_mul_f32 v39, v12, v39
    v_mul_f32 v40, v12, v40
    v_mul_f32 v41, v12, v41
    v_mul_f32 v42, v12, v42
    v_mul_f32 v43, v12, v43
    v_cvt_pk_bf16_f32 v36, v36, v37
    v_cvt_pk_bf16_f32 v37, v38, v39
    v_cvt_pk_bf16_f32 v38, v40, v41
    v_cvt_pk_bf16_f32 v39, v42, v43
    buffer_store_dwordx4 v[36:39], v16, s[16:19], s48 offen offset:0 sc1
    v_accvgpr_read_b32 v44, a40
    v_accvgpr_read_b32 v45, a41
    v_accvgpr_read_b32 v46, a42
    v_accvgpr_read_b32 v47, a43
    v_accvgpr_read_b32 v48, a44
    v_accvgpr_read_b32 v49, a45
    v_accvgpr_read_b32 v50, a46
    v_accvgpr_read_b32 v51, a47
    v_mul_f32 v44, v12, v44
    v_mul_f32 v45, v12, v45
    v_mul_f32 v46, v12, v46
    v_mul_f32 v47, v12, v47
    v_mul_f32 v48, v12, v48
    v_mul_f32 v49, v12, v49
    v_mul_f32 v50, v12, v50
    v_mul_f32 v51, v12, v51
    v_cvt_pk_bf16_f32 v44, v44, v45
    v_cvt_pk_bf16_f32 v45, v46, v47
    v_cvt_pk_bf16_f32 v46, v48, v49
    v_cvt_pk_bf16_f32 v47, v50, v51
    buffer_store_dwordx4 v[44:47], v16, s[16:19], s48 offen offset:512 sc1
    s_add_u32 s48, s48, 131072
    v_accvgpr_read_b32 v36, a48
    v_accvgpr_read_b32 v37, a49
    v_accvgpr_read_b32 v38, a50
    v_accvgpr_read_b32 v39, a51
    v_accvgpr_read_b32 v40, a52
    v_accvgpr_read_b32 v41, a53
    v_accvgpr_read_b32 v42, a54
    v_accvgpr_read_b32 v43, a55
    v_mul_f32 v36, v12, v36
    v_mul_f32 v37, v12, v37
    v_mul_f32 v38, v12, v38
    v_mul_f32 v39, v12, v39
    v_mul_f32 v40, v12, v40
    v_mul_f32 v41, v12, v41
    v_mul_f32 v42, v12, v42
    v_mul_f32 v43, v12, v43
    v_cvt_pk_bf16_f32 v36, v36, v37
    v_cvt_pk_bf16_f32 v37, v38, v39
    v_cvt_pk_bf16_f32 v38, v40, v41
    v_cvt_pk_bf16_f32 v39, v42, v43
    buffer_store_dwordx4 v[36:39], v16, s[16:19], s48 offen offset:0 sc1
    v_accvgpr_read_b32 v44, a56
    v_accvgpr_read_b32 v45, a57
    v_accvgpr_read_b32 v46, a58
    v_accvgpr_read_b32 v47, a59
    v_accvgpr_read_b32 v48, a60
    v_accvgpr_read_b32 v49, a61
    v_accvgpr_read_b32 v50, a62
    v_accvgpr_read_b32 v51, a63
    v_mul_f32 v44, v12, v44
    v_mul_f32 v45, v12, v45
    v_mul_f32 v46, v12, v46
    v_mul_f32 v47, v12, v47
    v_mul_f32 v48, v12, v48
    v_mul_f32 v49, v12, v49
    v_mul_f32 v50, v12, v50
    v_mul_f32 v51, v12, v51
    v_cvt_pk_bf16_f32 v44, v44, v45
    v_cvt_pk_bf16_f32 v45, v46, v47
    v_cvt_pk_bf16_f32 v46, v48, v49
    v_cvt_pk_bf16_f32 v47, v50, v51
    buffer_store_dwordx4 v[44:47], v16, s[16:19], s48 offen offset:512 sc1
    s_add_u32 s48, s48, 131072
    v_and_b32 v36, 15, v1
    v_lshrrev_b32 v37, 4, v1
    v_lshlrev_b32 v37, 2, v37
    v_sub_u32 v36, v36, v37
    v_cmp_ge_i32 vcc, -9, v36
    v_subrev_u32 v38, 0, v36
    v_cmp_ge_u32 s[44:45], 7, v38
    s_nop 0
    v_cndmask_b32 v64, v13, 0, vcc
    v_cndmask_b32 v68, v13, 0, s[44:45]
    v_cmp_ge_i32 vcc, -8, v36
    v_subrev_u32 v38, 1, v36
    v_cmp_ge_u32 s[44:45], 7, v38
    s_nop 0
    v_cndmask_b32 v65, v13, 0, vcc
    v_cndmask_b32 v69, v13, 0, s[44:45]
    v_cmp_ge_i32 vcc, -7, v36
    v_subrev_u32 v38, 2, v36
    v_cmp_ge_u32 s[44:45], 7, v38
    s_nop 0
    v_cndmask_b32 v66, v13, 0, vcc
    v_cndmask_b32 v70, v13, 0, s[44:45]
    v_cmp_ge_i32 vcc, -6, v36
    v_subrev_u32 v38, 3, v36
    v_cmp_ge_u32 s[44:45], 7, v38
    s_nop 0
    v_cndmask_b32 v67, v13, 0, vcc
    v_cndmask_b32 v71, v13, 0, s[44:45]
    s_cmp_eq_u32 s59, 0
    s_cselect_b64 vcc, -1, 0
    s_nop 0
    v_cndmask_b32 v72, v64, v13, vcc
    v_cndmask_b32 v73, v65, v13, vcc
    v_cndmask_b32 v74, v66, v13, vcc
    v_cndmask_b32 v75, v67, v13, vcc
    s_waitcnt vmcnt(8)
    s_nop 0
    v_mfma_f32_16x16x32_bf16 v[80:83], v[208:211], v[192:195], v[72:75]
    v_mfma_f32_16x16x32_bf16 v[84:87], v[212:215], v[192:195], v[68:71]
    v_mfma_f32_16x16x32_bf16 v[88:91], v[212:215], v[196:199], v[64:67]
    v_mfma_f32_16x16x32_bf16 v[92:95], v[216:219], v[196:199], v[68:71]
    v_mfma_f32_16x16x32_bf16 v[96:99], v[216:219], v[200:203], v[64:67]
    v_mfma_f32_16x16x32_bf16 v[100:103], v[220:223], v[200:203], v[68:71]
    v_mfma_f32_16x16x32_bf16 v[104:107], v[220:223], v[204:207], v[64:67]
    v_mfma_f32_16x16x32_bf16 v[108:111], v[224:227], v[204:207], v[68:71]
    s_nop 7
    v_max3_f32 v112, v80, v81, v82
    v_max3_f32 v113, v88, v89, v90
    v_max3_f32 v114, v96, v97, v98
    v_max3_f32 v115, v104, v105, v106
    v_max3_f32 v112, v112, v83, v84
    v_max3_f32 v113, v113, v91, v92
    v_max3_f32 v114, v114, v99, v100
    v_max3_f32 v115, v115, v107, v108
    v_max3_f32 v112, v112, v85, v86
    v_max3_f32 v113, v113, v93, v94
    v_max3_f32 v114, v114, v101, v102
    v_max3_f32 v115, v115, v109, v110
    v_max_f32 v112, v112, v87
    v_max_f32 v113, v113, v95
    v_max_f32 v114, v114, v103
    v_max_f32 v115, v115, v111
    v_mov_b32 v116, v112
    v_mov_b32 v117, v113
    v_mov_b32 v118, v114
    v_mov_b32 v119, v115
    s_nop 1
    v_permlane32_swap_b32 v112, v116
    v_permlane32_swap_b32 v113, v117
    v_permlane32_swap_b32 v114, v118
    v_permlane32_swap_b32 v115, v119
    s_nop 1
    v_max_f32 v112, v112, v116
    v_max_f32 v113, v113, v117
    v_max_f32 v114, v114, v118
    v_max_f32 v115, v115, v119
    v_mov_b32 v116, v112
    v_mov_b32 v117, v113
    v_mov_b32 v118, v114
    v_mov_b32 v119, v115
    s_nop 1
    v_permlane16_swap_b32 v112, v116
    v_permlane16_swap_b32 v113, v117
    v_permlane16_swap_b32 v114, v118
    v_permlane16_swap_b32 v115, v119
    s_nop 1
    v_max_f32 v112, v112, v116
    v_max_f32 v113, v113, v117
    v_max_f32 v114, v114, v118
    v_max_f32 v115, v115, v119
    v_sub_f32 v80, v80, v112
    v_sub_f32 v81, v81, v112
    v_sub_f32 v82, v82, v112
    v_sub_f32 v83, v83, v112
    v_sub_f32 v84, v84, v112
    v_sub_f32 v85, v85, v112
    v_sub_f32 v86, v86, v112
    v_sub_f32 v87, v87, v112
    v_sub_f32 v88, v88, v113
    v_sub_f32 v89, v89, v113
    v_sub_f32 v90, v90, v113
    v_sub_f32 v91, v91, v113
    v_sub_f32 v92, v92, v113
    v_sub_f32 v93, v93, v113
    v_sub_f32 v94, v94, v113
    v_sub_f32 v95, v95, v113
    v_sub_f32 v96, v96, v114
    v_sub_f32 v97, v97, v114
    v_sub_f32 v98, v98, v114
    v_sub_f32 v99, v99, v114
    v_sub_f32 v100, v100, v114
    v_sub_f32 v101, v101, v114
    v_sub_f32 v102, v102, v114
    v_sub_f32 v103, v103, v114
    v_sub_f32 v104, v104, v115
    v_sub_f32 v105, v105, v115
    v_sub_f32 v106, v106, v115
    v_sub_f32 v107, v107, v115
    v_sub_f32 v108, v108, v115
    v_sub_f32 v109, v109, v115
    v_sub_f32 v110, v110, v115
    v_sub_f32 v111, v111, v115
    v_exp_f32 v80, v80
    v_exp_f32 v81, v81
    v_exp_f32 v82, v82
    v_exp_f32 v83, v83
    v_exp_f32 v84, v84
    v_exp_f32 v85, v85
    v_exp_f32 v86, v86
    v_exp_f32 v87, v87
    v_exp_f32 v88, v88
    v_exp_f32 v89, v89
    v_exp_f32 v90, v90
    v_exp_f32 v91, v91
    v_exp_f32 v92, v92
    v_exp_f32 v93, v93
    v_exp_f32 v94, v94
    v_exp_f32 v95, v95
    v_exp_f32 v96, v96
    v_exp_f32 v97, v97
    v_exp_f32 v98, v98
    v_exp_f32 v99, v99
    v_exp_f32 v100, v100
    v_exp_f32 v101, v101
    v_exp_f32 v102, v102
    v_exp_f32 v103, v103
    v_exp_f32 v104, v104
    v_exp_f32 v105, v105
    v_exp_f32 v106, v106
    v_exp_f32 v107, v107
    v_exp_f32 v108, v108
    v_exp_f32 v109, v109
    v_exp_f32 v110, v110
    v_exp_f32 v111, v111
    v_cvt_pk_bf16_f32 v192, v80, v81
    v_cvt_pk_bf16_f32 v193, v82, v83
    v_cvt_pk_bf16_f32 v194, v84, v85
    v_cvt_pk_bf16_f32 v195, v86, v87
    v_cvt_pk_bf16_f32 v196, v88, v89
    v_cvt_pk_bf16_f32 v197, v90, v91
    v_cvt_pk_bf16_f32 v198, v92, v93
    v_cvt_pk_bf16_f32 v199, v94, v95
    v_cvt_pk_bf16_f32 v200, v96, v97
    v_cvt_pk_bf16_f32 v201, v98, v99
    v_cvt_pk_bf16_f32 v202, v100, v101
    v_cvt_pk_bf16_f32 v203, v102, v103
    v_cvt_pk_bf16_f32 v204, v104, v105
    v_cvt_pk_bf16_f32 v205, v106, v107
    v_cvt_pk_bf16_f32 v206, v108, v109
    v_cvt_pk_bf16_f32 v207, v110, v111
    v_add_f32 v112, v80, v81
    v_add_f32 v113, v88, v89
    v_add_f32 v114, v96, v97
    v_add_f32 v115, v104, v105
    v_mfma_f32_16x16x32_bf16 v[128:131], v[230:233], v[192:195], 0
    v_mfma_f32_16x16x32_bf16 v[132:135], v[242:245], v[192:195], 0
    v_mfma_f32_16x16x32_bf16 v[136:139], v[232:235], v[196:199], 0
    v_mfma_f32_16x16x32_bf16 v[140:143], v[244:247], v[196:199], 0
    v_mfma_f32_16x16x32_bf16 v[144:147], v[234:237], v[200:203], 0
    v_mfma_f32_16x16x32_bf16 v[148:151], v[246:249], v[200:203], 0
    v_mfma_f32_16x16x32_bf16 v[152:155], v[236:239], v[204:207], 0
    v_mfma_f32_16x16x32_bf16 v[156:159], v[248:251], v[204:207], 0
    v_add_f32 v112, v112, v82
    v_add_f32 v113, v113, v90
    v_add_f32 v114, v114, v98
    v_add_f32 v115, v115, v106
    v_add_f32 v112, v112, v83
    v_add_f32 v113, v113, v91
    v_add_f32 v114, v114, v99
    v_add_f32 v115, v115, v107
    v_add_f32 v112, v112, v84
    v_add_f32 v113, v113, v92
    v_add_f32 v114, v114, v100
    v_add_f32 v115, v115, v108
    v_add_f32 v112, v112, v85
    v_add_f32 v113, v113, v93
    v_add_f32 v114, v114, v101
    v_add_f32 v115, v115, v109
    v_add_f32 v112, v112, v86
    v_add_f32 v113, v113, v94
    v_add_f32 v114, v114, v102
    v_add_f32 v115, v115, v110
    v_add_f32 v112, v112, v87
    v_add_f32 v113, v113, v95
    v_add_f32 v114, v114, v103
    v_add_f32 v115, v115, v111
    v_mov_b32 v116, v112
    v_mov_b32 v117, v113
    v_mov_b32 v118, v114
    v_mov_b32 v119, v115
    s_nop 1
    v_permlane32_swap_b32 v112, v116
    v_permlane32_swap_b32 v113, v117
    v_permlane32_swap_b32 v114, v118
    v_permlane32_swap_b32 v115, v119
    s_nop 1
    v_add_f32 v112, v112, v116
    v_add_f32 v113, v113, v117
    v_add_f32 v114, v114, v118
    v_add_f32 v115, v115, v119
    v_mov_b32 v116, v112
    v_mov_b32 v117, v113
    v_mov_b32 v118, v114
    v_mov_b32 v119, v115
    s_nop 1
    v_permlane16_swap_b32 v112, v116
    v_permlane16_swap_b32 v113, v117
    v_permlane16_swap_b32 v114, v118
    v_permlane16_swap_b32 v115, v119
    s_nop 1
    v_add_f32 v112, v112, v116
    v_add_f32 v113, v113, v117
    v_add_f32 v114, v114, v118
    v_add_f32 v115, v115, v119
    v_rcp_f32 v112, v112
    v_rcp_f32 v113, v113
    v_rcp_f32 v114, v114
    v_rcp_f32 v115, v115
    s_lshl_b32 s48, s58, 10
    s_lshr_b32 s49, s2, 3
    s_lshl_b32 s49, s49, 17
    s_add_u32 s48, s48, s49
    s_add_u32 s48, s48, 83886080
    v_mul_f32 v128, v128, v112
    v_mul_f32 v129, v129, v112
    v_mul_f32 v130, v130, v112
    v_mul_f32 v131, v131, v112
    v_mul_f32 v132, v132, v112
    v_mul_f32 v133, v133, v112
    v_mul_f32 v134, v134, v112
    v_mul_f32 v135, v135, v112
    v_cvt_pk_bf16_f32 v128, v128, v129
    v_cvt_pk_bf16_f32 v129, v130, v131
    v_cvt_pk_bf16_f32 v130, v132, v133
    v_cvt_pk_bf16_f32 v131, v134, v135
    buffer_store_dwordx4 v[128:131], v52, s[16:19], s48 offen offset:0 sc1
    v_mul_f32 v136, v136, v113
    v_mul_f32 v137, v137, v113
    v_mul_f32 v138, v138, v113
    v_mul_f32 v139, v139, v113
    v_mul_f32 v140, v140, v113
    v_mul_f32 v141, v141, v113
    v_mul_f32 v142, v142, v113
    v_mul_f32 v143, v143, v113
    v_cvt_pk_bf16_f32 v136, v136, v137
    v_cvt_pk_bf16_f32 v137, v138, v139
    v_cvt_pk_bf16_f32 v138, v140, v141
    v_cvt_pk_bf16_f32 v139, v142, v143
    buffer_store_dwordx4 v[136:139], v52, s[16:19], s48 offen offset:1024 sc1
    v_mul_f32 v144, v144, v114
    v_mul_f32 v145, v145, v114
    v_mul_f32 v146, v146, v114
    v_mul_f32 v147, v147, v114
    v_mul_f32 v148, v148, v114
    v_mul_f32 v149, v149, v114
    v_mul_f32 v150, v150, v114
    v_mul_f32 v151, v151, v114
    v_cvt_pk_bf16_f32 v144, v144, v145
    v_cvt_pk_bf16_f32 v145, v146, v147
    v_cvt_pk_bf16_f32 v146, v148, v149
    v_cvt_pk_bf16_f32 v147, v150, v151
    buffer_store_dwordx4 v[144:147], v52, s[16:19], s48 offen offset:2048 sc1
    v_mul_f32 v152, v152, v115
    v_mul_f32 v153, v153, v115
    v_mul_f32 v154, v154, v115
    v_mul_f32 v155, v155, v115
    v_mul_f32 v156, v156, v115
    v_mul_f32 v157, v157, v115
    v_mul_f32 v158, v158, v115
    v_mul_f32 v159, v159, v115
    v_cvt_pk_bf16_f32 v152, v152, v153
    v_cvt_pk_bf16_f32 v153, v154, v155
    v_cvt_pk_bf16_f32 v154, v156, v157
    v_cvt_pk_bf16_f32 v155, v158, v159
    buffer_store_dwordx4 v[152:155], v52, s[16:19], s48 offen offset:3072 sc1
attn_kernel_end1:
    s_endpgm
attn_kernel_stub9:
    v_cmp_lt_f32 vcc, s31, v12
    s_cmp_lg_u32 s30, s33
    s_cbranch_scc1 attn_kernel_e33
    v_add_f32 v176, v176, v17
    v_add_f32 v177, v177, v18
    v_add_f32 v178, v178, v19
    v_add_f32 v179, v179, v53
    v_add_f32 v180, v180, v54
    v_add_f32 v181, v181, v55
    v_add_f32 v182, v182, v56
    v_add_f32 v183, v183, v57
    v_add_f32 v184, v184, v58
    v_add_f32 v185, v185, v59
    v_add_f32 v186, v186, v60
    v_add_f32 v187, v187, v61
    v_add_f32 v188, v188, v62
    v_add_f32 v189, v189, v63
    v_add_f32 v190, v190, v252
    v_add_f32 v191, v191, v253
    s_nop 0
attn_kernel_e33:
    s_cmp_lg_u32 s30, s34
    s_cbranch_scc1 attn_kernel_e34
    v_mov_b32 v176, v13
    v_mov_b32 v177, v13
    v_mov_b32 v178, v13
    v_mov_b32 v179, v13
    v_mov_b32 v180, v13
    v_mov_b32 v181, v13
    v_mov_b32 v182, v13
    v_mov_b32 v183, v13
    v_mov_b32 v184, v13
    v_mov_b32 v185, v13
    v_mov_b32 v186, v13
    v_mov_b32 v187, v13
    v_mov_b32 v188, v13
    v_mov_b32 v189, v13
    v_mov_b32 v190, v13
    v_mov_b32 v191, v13
    s_nop 0
attn_kernel_e34:
    s_cbranch_vccnz attn_kernel_rc35
attn_kernel_sp32:
    s_branch attn_kernel_ret10
attn_kernel_stub12:
    v_cmp_lt_f32 vcc, s31, v12
    s_cmp_lg_u32 s30, s33
    s_cbranch_scc1 attn_kernel_e37
    v_add_f32 v176, v176, v17
    v_add_f32 v177, v177, v18
    v_add_f32 v178, v178, v19
    v_add_f32 v179, v179, v53
    v_add_f32 v180, v180, v54
    v_add_f32 v181, v181, v55
    v_add_f32 v182, v182, v56
    v_add_f32 v183, v183, v57
    v_add_f32 v184, v184, v58
    v_add_f32 v185, v185, v59
    v_add_f32 v186, v186, v60
    v_add_f32 v187, v187, v61
    v_add_f32 v188, v188, v62
    v_add_f32 v189, v189, v63
    v_add_f32 v190, v190, v252
    v_add_f32 v191, v191, v253
    s_nop 0
attn_kernel_e37:
    s_cmp_lg_u32 s30, s34
    s_cbranch_scc1 attn_kernel_e38
    v_mov_b32 v176, v13
    v_mov_b32 v177, v13
    v_mov_b32 v178, v13
    v_mov_b32 v179, v13
    v_mov_b32 v180, v13
    v_mov_b32 v181, v13
    v_mov_b32 v182, v13
    v_mov_b32 v183, v13
    v_mov_b32 v184, v13
    v_mov_b32 v185, v13
    v_mov_b32 v186, v13
    v_mov_b32 v187, v13
    v_mov_b32 v188, v13
    v_mov_b32 v189, v13
    v_mov_b32 v190, v13
    v_mov_b32 v191, v13
    s_nop 0
attn_kernel_e38:
    s_cbranch_vccnz attn_kernel_rc39
attn_kernel_sp36:
    s_branch attn_kernel_ret13
attn_kernel_stub19:
    v_cmp_lt_f32 vcc, s31, v12
    s_cmp_lg_u32 s30, s36
    s_cbranch_scc1 attn_kernel_e41
    v_add_f32 v160, v160, v17
    v_add_f32 v161, v161, v18
    v_add_f32 v162, v162, v19
    v_add_f32 v163, v163, v53
    v_add_f32 v164, v164, v54
    v_add_f32 v165, v165, v55
    v_add_f32 v166, v166, v56
    v_add_f32 v167, v167, v57
    v_add_f32 v168, v168, v58
    v_add_f32 v169, v169, v59
    v_add_f32 v170, v170, v60
    v_add_f32 v171, v171, v61
    v_add_f32 v172, v172, v62
    v_add_f32 v173, v173, v63
    v_add_f32 v174, v174, v252
    v_add_f32 v175, v175, v253
    s_nop 0
attn_kernel_e41:
    s_cmp_lg_u32 s30, s37
    s_cbranch_scc1 attn_kernel_e42
    v_mov_b32 v160, v13
    v_mov_b32 v161, v13
    v_mov_b32 v162, v13
    v_mov_b32 v163, v13
    v_mov_b32 v164, v13
    v_mov_b32 v165, v13
    v_mov_b32 v166, v13
    v_mov_b32 v167, v13
    v_mov_b32 v168, v13
    v_mov_b32 v169, v13
    v_mov_b32 v170, v13
    v_mov_b32 v171, v13
    v_mov_b32 v172, v13
    v_mov_b32 v173, v13
    v_mov_b32 v174, v13
    v_mov_b32 v175, v13
    s_nop 0
attn_kernel_e42:
    s_cbranch_vccnz attn_kernel_rc43
attn_kernel_sp40:
    s_branch attn_kernel_ret20
attn_kernel_stub21:
    v_cmp_lt_f32 vcc, s31, v10
    s_cmp_lg_u32 s30, s36
    s_cbranch_scc1 attn_kernel_e45
    v_add_f32 v160, v160, v17
    v_add_f32 v161, v161, v18
    v_add_f32 v162, v162, v19
    v_add_f32 v163, v163, v53
    v_add_f32 v164, v164, v54
    v_add_f32 v165, v165, v55
    v_add_f32 v166, v166, v56
    v_add_f32 v167, v167, v57
    v_add_f32 v168, v168, v58
    v_add_f32 v169, v169, v59
    v_add_f32 v170, v170, v60
    v_add_f32 v171, v171, v61
    v_add_f32 v172, v172, v62
    v_add_f32 v173, v173, v63
    v_add_f32 v174, v174, v252
    v_add_f32 v175, v175, v253
    s_nop 0
attn_kernel_e45:
    s_cmp_lg_u32 s30, s37
    s_cbranch_scc1 attn_kernel_e46
    v_mov_b32 v160, v13
    v_mov_b32 v161, v13
    v_mov_b32 v162, v13
    v_mov_b32 v163, v13
    v_mov_b32 v164, v13
    v_mov_b32 v165, v13
    v_mov_b32 v166, v13
    v_mov_b32 v167, v13
    v_mov_b32 v168, v13
    v_mov_b32 v169, v13
    v_mov_b32 v170, v13
    v_mov_b32 v171, v13
    v_mov_b32 v172, v13
    v_mov_b32 v173, v13
    v_mov_b32 v174, v13
    v_mov_b32 v175, v13
    s_nop 0
attn_kernel_e46:
    s_cbranch_vccnz attn_kernel_rc47
attn_kernel_sp44:
    s_branch attn_kernel_ret22
attn_kernel_stub24:
    v_cmp_lt_f32 vcc, s31, v10
    s_cmp_lg_u32 s30, s36
    s_cbranch_scc1 attn_kernel_e49
    v_add_f32 v160, v160, v17
    v_add_f32 v161, v161, v18
    v_add_f32 v162, v162, v19
    v_add_f32 v163, v163, v53
    v_add_f32 v164, v164, v54
    v_add_f32 v165, v165, v55
    v_add_f32 v166, v166, v56
    v_add_f32 v167, v167, v57
    v_add_f32 v168, v168, v58
    v_add_f32 v169, v169, v59
    v_add_f32 v170, v170, v60
    v_add_f32 v171, v171, v61
    v_add_f32 v172, v172, v62
    v_add_f32 v173, v173, v63
    v_add_f32 v174, v174, v252
    v_add_f32 v175, v175, v253
    s_nop 0
attn_kernel_e49:
    s_cmp_lg_u32 s30, s37
    s_cbranch_scc1 attn_kernel_e50
    v_mov_b32 v160, v13
    v_mov_b32 v161, v13
    v_mov_b32 v162, v13
    v_mov_b32 v163, v13
    v_mov_b32 v164, v13
    v_mov_b32 v165, v13
    v_mov_b32 v166, v13
    v_mov_b32 v167, v13
    v_mov_b32 v168, v13
    v_mov_b32 v169, v13
    v_mov_b32 v170, v13
    v_mov_b32 v171, v13
    v_mov_b32 v172, v13
    v_mov_b32 v173, v13
    v_mov_b32 v174, v13
    v_mov_b32 v175, v13
    s_nop 0
attn_kernel_e50:
    s_cbranch_vccnz attn_kernel_rc51
attn_kernel_sp48:
    s_branch attn_kernel_ret25
attn_kernel_stub30:
    v_cmp_lt_f32 vcc, s31, v10
    s_cbranch_vccnz attn_kernel_rc53
attn_kernel_sp52:
    s_branch attn_kernel_ret31
attn_kernel_rc18:
    s_call_b64 s[40:41], attn_kernel_rs023
    s_branch attn_kernel_sp14
attn_kernel_rc29:
    s_call_b64 s[40:41], attn_kernel_rs012
    s_branch attn_kernel_sp26
attn_kernel_rc35:
    s_call_b64 s[40:41], attn_kernel_rs023
    s_branch attn_kernel_sp32
attn_kernel_rc39:
    s_call_b64 s[40:41], attn_kernel_rs125
    s_branch attn_kernel_sp36
attn_kernel_rc43:
    s_call_b64 s[40:41], attn_kernel_rs125
    s_branch attn_kernel_sp40
attn_kernel_rc47:
    s_call_b64 s[40:41], attn_kernel_rs012
    s_branch attn_kernel_sp44
attn_kernel_rc51:
    s_call_b64 s[40:41], attn_kernel_rs114
    s_branch attn_kernel_sp48
attn_kernel_rc53:
    s_call_b64 s[40:41], attn_kernel_rs114
    s_branch attn_kernel_sp52
attn_kernel_rs012:
    s_nop 15
    v_max3_f32 v36, v64, v65, v66
    v_max3_f32 v36, v36, v67, v68
    v_max3_f32 v36, v36, v69, v70
    v_max3_f32 v36, v36, v71, v72
    v_max3_f32 v36, v36, v73, v74
    v_max3_f32 v36, v36, v75, v76
    v_max3_f32 v36, v36, v77, v78
    v_max3_f32 v36, v36, v79, 0
    v_mov_b32 v37, v36
    s_nop 1
    v_permlane32_swap_b32 v36, v37
    s_nop 1
    v_max_f32 v36, v36, v37
    v_exp_f32 v37, -v36
    v_sub_f32 v64, v64, v36
    v_sub_f32 v65, v65, v36
    v_sub_f32 v66, v66, v36
    v_sub_f32 v67, v67, v36
    v_sub_f32 v68, v68, v36
    v_sub_f32 v69, v69, v36
    v_sub_f32 v70, v70, v36
    v_sub_f32 v71, v71, v36
    v_sub_f32 v72, v72, v36
    v_sub_f32 v73, v73, v36
    v_sub_f32 v74, v74, v36
    v_sub_f32 v75, v75, v36
    v_sub_f32 v76, v76, v36
    v_sub_f32 v77, v77, v36
    v_sub_f32 v78, v78, v36
    v_sub_f32 v79, v79, v36
    v_sub_f32 v96, v96, v36
    v_sub_f32 v97, v97, v36
    v_sub_f32 v98, v98, v36
    v_sub_f32 v99, v99, v36
    v_sub_f32 v100, v100, v36
    v_sub_f32 v101, v101, v36
    v_sub_f32 v102, v102, v36
    v_sub_f32 v103, v103, v36
    v_sub_f32 v104, v104, v36
    v_sub_f32 v105, v105, v36
    v_sub_f32 v106, v106, v36
    v_sub_f32 v107, v107, v36
    v_sub_f32 v108, v108, v36
    v_sub_f32 v109, v109, v36
    v_sub_f32 v110, v110, v36
    v_sub_f32 v111, v111, v36
    v_sub_f32 v160, v160, v36
    v_sub_f32 v161, v161, v36
    v_sub_f32 v162, v162, v36
    v_sub_f32 v163, v163, v36
    v_sub_f32 v164, v164, v36
    v_sub_f32 v165, v165, v36
    v_sub_f32 v166, v166, v36
    v_sub_f32 v167, v167, v36
    v_sub_f32 v168, v168, v36
    v_sub_f32 v169, v169, v36
    v_sub_f32 v170, v170, v36
    v_sub_f32 v171, v171, v36
    v_sub_f32 v172, v172, v36
    v_sub_f32 v173, v173, v36
    v_sub_f32 v174, v174, v36
    v_sub_f32 v175, v175, v36
    v_mul_f32 v8, v8, v37
    v_accvgpr_read_b32 v40, a0
    v_accvgpr_read_b32 v41, a1
    v_accvgpr_read_b32 v42, a2
    v_accvgpr_read_b32 v43, a3
    v_accvgpr_read_b32 v44, a4
    v_accvgpr_read_b32 v45, a5
    v_accvgpr_read_b32 v46, a6
    v_accvgpr_read_b32 v47, a7
    v_mul_f32 v40, v40, v37
    v_mul_f32 v41, v41, v37
    v_mul_f32 v42, v42, v37
    v_mul_f32 v43, v43, v37
    v_mul_f32 v44, v44, v37
    v_mul_f32 v45, v45, v37
    v_mul_f32 v46, v46, v37
    v_mul_f32 v47, v47, v37
    v_accvgpr_write_b32 a0, v40
    v_accvgpr_write_b32 a1, v41
    v_accvgpr_write_b32 a2, v42
    v_accvgpr_write_b32 a3, v43
    v_accvgpr_write_b32 a4, v44
    v_accvgpr_write_b32 a5, v45
    v_accvgpr_write_b32 a6, v46
    v_accvgpr_write_b32 a7, v47
    v_accvgpr_read_b32 v40, a8
    v_accvgpr_read_b32 v41, a9
    v_accvgpr_read_b32 v42, a10
    v_accvgpr_read_b32 v43, a11
    v_accvgpr_read_b32 v44, a12
    v_accvgpr_read_b32 v45, a13
    v_accvgpr_read_b32 v46, a14
    v_accvgpr_read_b32 v47, a15
    v_mul_f32 v40, v40, v37
    v_mul_f32 v41, v41, v37
    v_mul_f32 v42, v42, v37
    v_mul_f32 v43, v43, v37
    v_mul_f32 v44, v44, v37
    v_mul_f32 v45, v45, v37
    v_mul_f32 v46, v46, v37
    v_mul_f32 v47, v47, v37
    v_accvgpr_write_b32 a8, v40
    v_accvgpr_write_b32 a9, v41
    v_accvgpr_write_b32 a10, v42
    v_accvgpr_write_b32 a11, v43
    v_accvgpr_write_b32 a12, v44
    v_accvgpr_write_b32 a13, v45
    v_accvgpr_write_b32 a14, v46
    v_accvgpr_write_b32 a15, v47
    v_accvgpr_read_b32 v40, a16
    v_accvgpr_read_b32 v41, a17
    v_accvgpr_read_b32 v42, a18
    v_accvgpr_read_b32 v43, a19
    v_accvgpr_read_b32 v44, a20
    v_accvgpr_read_b32 v45, a21
    v_accvgpr_read_b32 v46, a22
    v_accvgpr_read_b32 v47, a23
    v_mul_f32 v40, v40, v37
    v_mul_f32 v41, v41, v37
    v_mul_f32 v42, v42, v37
    v_mul_f32 v43, v43, v37
    v_mul_f32 v44, v44, v37
    v_mul_f32 v45, v45, v37
    v_mul_f32 v46, v46, v37
    v_mul_f32 v47, v47, v37
    v_accvgpr_write_b32 a16, v40
    v_accvgpr_write_b32 a17, v41
    v_accvgpr_write_b32 a18, v42
    v_accvgpr_write_b32 a19, v43
    v_accvgpr_write_b32 a20, v44
    v_accvgpr_write_b32 a21, v45
    v_accvgpr_write_b32 a22, v46
    v_accvgpr_write_b32 a23, v47
    v_accvgpr_read_b32 v40, a24
    v_accvgpr_read_b32 v41, a25
    v_accvgpr_read_b32 v42, a26
    v_accvgpr_read_b32 v43, a27
    v_accvgpr_read_b32 v44, a28
    v_accvgpr_read_b32 v45, a29
    v_accvgpr_read_b32 v46, a30
    v_accvgpr_read_b32 v47, a31
    v_mul_f32 v40, v40, v37
    v_mul_f32 v41, v41, v37
    v_mul_f32 v42, v42, v37
    v_mul_f32 v43, v43, v37
    v_mul_f32 v44, v44, v37
    v_mul_f32 v45, v45, v37
    v_mul_f32 v46, v46, v37
    v_mul_f32 v47, v47, v37
    v_accvgpr_write_b32 a24, v40
    v_accvgpr_write_b32 a25, v41
    v_accvgpr_write_b32 a26, v42
    v_accvgpr_write_b32 a27, v43
    v_accvgpr_write_b32 a28, v44
    v_accvgpr_write_b32 a29, v45
    v_accvgpr_write_b32 a30, v46
    v_accvgpr_write_b32 a31, v47
    v_accvgpr_read_b32 v40, a32
    v_accvgpr_read_b32 v41, a33
    v_accvgpr_read_b32 v42, a34
    v_accvgpr_read_b32 v43, a35
    v_accvgpr_read_b32 v44, a36
    v_accvgpr_read_b32 v45, a37
    v_accvgpr_read_b32 v46, a38
    v_accvgpr_read_b32 v47, a39
    v_mul_f32 v40, v40, v37
    v_mul_f32 v41, v41, v37
    v_mul_f32 v42, v42, v37
    v_mul_f32 v43, v43, v37
    v_mul_f32 v44, v44, v37
    v_mul_f32 v45, v45, v37
    v_mul_f32 v46, v46, v37
    v_mul_f32 v47, v47, v37
    v_accvgpr_write_b32 a32, v40
    v_accvgpr_write_b32 a33, v41
    v_accvgpr_write_b32 a34, v42
    v_accvgpr_write_b32 a35, v43
    v_accvgpr_write_b32 a36, v44
    v_accvgpr_write_b32 a37, v45
    v_accvgpr_write_b32 a38, v46
    v_accvgpr_write_b32 a39, v47
    v_accvgpr_read_b32 v40, a40
    v_accvgpr_read_b32 v41, a41
    v_accvgpr_read_b32 v42, a42
    v_accvgpr_read_b32 v43, a43
    v_accvgpr_read_b32 v44, a44
    v_accvgpr_read_b32 v45, a45
    v_accvgpr_read_b32 v46, a46
    v_accvgpr_read_b32 v47, a47
    v_mul_f32 v40, v40, v37
    v_mul_f32 v41, v41, v37
    v_mul_f32 v42, v42, v37
    v_mul_f32 v43, v43, v37
    v_mul_f32 v44, v44, v37
    v_mul_f32 v45, v45, v37
    v_mul_f32 v46, v46, v37
    v_mul_f32 v47, v47, v37
    v_accvgpr_write_b32 a40, v40
    v_accvgpr_write_b32 a41, v41
    v_accvgpr_write_b32 a42, v42
    v_accvgpr_write_b32 a43, v43
    v_accvgpr_write_b32 a44, v44
    v_accvgpr_write_b32 a45, v45
    v_accvgpr_write_b32 a46, v46
    v_accvgpr_write_b32 a47, v47
    v_accvgpr_read_b32 v40, a48
    v_accvgpr_read_b32 v41, a49
    v_accvgpr_read_b32 v42, a50
    v_accvgpr_read_b32 v43, a51
    v_accvgpr_read_b32 v44, a52
    v_accvgpr_read_b32 v45, a53
    v_accvgpr_read_b32 v46, a54
    v_accvgpr_read_b32 v47, a55
    v_mul_f32 v40, v40, v37
    v_mul_f32 v41, v41, v37
    v_mul_f32 v42, v42, v37
    v_mul_f32 v43, v43, v37
    v_mul_f32 v44, v44, v37
    v_mul_f32 v45, v45, v37
    v_mul_f32 v46, v46, v37
    v_mul_f32 v47, v47, v37
    v_accvgpr_write_b32 a48, v40
    v_accvgpr_write_b32 a49, v41
    v_accvgpr_write_b32 a50, v42
    v_accvgpr_write_b32 a51, v43
    v_accvgpr_write_b32 a52, v44
    v_accvgpr_write_b32 a53, v45
    v_accvgpr_write_b32 a54, v46
    v_accvgpr_write_b32 a55, v47
    v_accvgpr_read_b32 v40, a56
    v_accvgpr_read_b32 v41, a57
    v_accvgpr_read_b32 v42, a58
    v_accvgpr_read_b32 v43, a59
    v_accvgpr_read_b32 v44, a60
    v_accvgpr_read_b32 v45, a61
    v_accvgpr_read_b32 v46, a62
    v_accvgpr_read_b32 v47, a63
    v_mul_f32 v40, v40, v37
    v_mul_f32 v41, v41, v37
    v_mul_f32 v42, v42, v37
    v_mul_f32 v43, v43, v37
    v_mul_f32 v44, v44, v37
    v_mul_f32 v45, v45, v37
    v_mul_f32 v46, v46, v37
    v_mul_f32 v47, v47, v37
    v_accvgpr_write_b32 a56, v40
    v_accvgpr_write_b32 a57, v41
    v_accvgpr_write_b32 a58, v42
    v_accvgpr_write_b32 a59, v43
    v_accvgpr_write_b32 a60, v44
    v_accvgpr_write_b32 a61, v45
    v_accvgpr_write_b32 a62, v46
    v_accvgpr_write_b32 a63, v47
    v_exp_f32 v40, v64
    v_exp_f32 v41, v65
    v_exp_f32 v42, v66
    v_exp_f32 v43, v67
    v_exp_f32 v44, v68
    v_exp_f32 v45, v69
    v_exp_f32 v46, v70
    v_exp_f32 v47, v71
    s_nop 0
    v_add_f32 v10, v40, v41
    v_add_f32 v10, v10, v42
    v_add_f32 v10, v10, v43
    v_add_f32 v10, v10, v44
    v_add_f32 v10, v10, v45
    v_add_f32 v10, v10, v46
    v_add_f32 v10, v10, v47
    v_cvt_pk_bf16_f32 v128, v40, v41
    v_cvt_pk_bf16_f32 v129, v42, v43
    v_cvt_pk_bf16_f32 v130, v44, v45
    v_cvt_pk_bf16_f32 v131, v46, v47
    v_exp_f32 v40, v72
    v_exp_f32 v41, v73
    v_exp_f32 v42, v74
    v_exp_f32 v43, v75
    v_exp_f32 v44, v76
    v_exp_f32 v45, v77
    v_exp_f32 v46, v78
    v_exp_f32 v47, v79
    s_nop 0
    v_add_f32 v10, v10, v40
    v_add_f32 v10, v10, v41
    v_add_f32 v10, v10, v42
    v_add_f32 v10, v10, v43
    v_add_f32 v10, v10, v44
    v_add_f32 v10, v10, v45
    v_add_f32 v10, v10, v46
    v_add_f32 v10, v10, v47
    v_cvt_pk_bf16_f32 v132, v40, v41
    v_cvt_pk_bf16_f32 v133, v42, v43
    v_cvt_pk_bf16_f32 v134, v44, v45
    v_cvt_pk_bf16_f32 v135, v46, v47
    s_nop 1
    s_setpc_b64 s[40:41]
attn_kernel_rs023:
    s_nop 15
    v_max3_f32 v36, v64, v65, v66
    v_max3_f32 v36, v36, v67, v68
    v_max3_f32 v36, v36, v69, v70
    v_max3_f32 v36, v36, v71, v72
    v_max3_f32 v36, v36, v73, v74
    v_max3_f32 v36, v36, v75, v76
    v_max3_f32 v36, v36, v77, v78
    v_max3_f32 v36, v36, v79, 0
    v_mov_b32 v37, v36
    s_nop 1
    v_permlane32_swap_b32 v36, v37
    s_nop 1
    v_max_f32 v36, v36, v37
    v_exp_f32 v37, -v36
    v_sub_f32 v64, v64, v36
    v_sub_f32 v65, v65, v36
    v_sub_f32 v66, v66, v36
    v_sub_f32 v67, v67, v36
    v_sub_f32 v68, v68, v36
    v_sub_f32 v69, v69, v36
    v_sub_f32 v70, v70, v36
    v_sub_f32 v71, v71, v36
    v_sub_f32 v72, v72, v36
    v_sub_f32 v73, v73, v36
    v_sub_f32 v74, v74, v36
    v_sub_f32 v75, v75, v36
    v_sub_f32 v76, v76, v36
    v_sub_f32 v77, v77, v36
    v_sub_f32 v78, v78, v36
    v_sub_f32 v79, v79, v36
    v_sub_f32 v96, v96, v36
    v_sub_f32 v97, v97, v36
    v_sub_f32 v98, v98, v36
    v_sub_f32 v99, v99, v36
    v_sub_f32 v100, v100, v36
    v_sub_f32 v101, v101, v36
    v_sub_f32 v102, v102, v36
    v_sub_f32 v103, v103, v36
    v_sub_f32 v104, v104, v36
    v_sub_f32 v105, v105, v36
    v_sub_f32 v106, v106, v36
    v_sub_f32 v107, v107, v36
    v_sub_f32 v108, v108, v36
    v_sub_f32 v109, v109, v36
    v_sub_f32 v110, v110, v36
    v_sub_f32 v111, v111, v36
    v_sub_f32 v160, v160, v36
    v_sub_f32 v161, v161, v36
    v_sub_f32 v162, v162, v36
    v_sub_f32 v163, v163, v36
    v_sub_f32 v164, v164, v36
    v_sub_f32 v165, v165, v36
    v_sub_f32 v166, v166, v36
    v_sub_f32 v167, v167, v36
    v_sub_f32 v168, v168, v36
    v_sub_f32 v169, v169, v36
    v_sub_f32 v170, v170, v36
    v_sub_f32 v171, v171, v36
    v_sub_f32 v172, v172, v36
    v_sub_f32 v173, v173, v36
    v_sub_f32 v174, v174, v36
    v_sub_f32 v175, v175, v36
    v_mul_f32 v8, v8, v37
    v_accvgpr_read_b32 v40, a0
    v_accvgpr_read_b32 v41, a1
    v_accvgpr_read_b32 v42, a2
    v_accvgpr_read_b32 v43, a3
    v_accvgpr_read_b32 v44, a4
    v_accvgpr_read_b32 v45, a5
    v_accvgpr_read_b32 v46, a6
    v_accvgpr_read_b32 v47, a7
    v_mul_f32 v40, v40, v37
    v_mul_f32 v41, v41, v37
    v_mul_f32 v42, v42, v37
    v_mul_f32 v43, v43, v37
    v_mul_f32 v44, v44, v37
    v_mul_f32 v45, v45, v37
    v_mul_f32 v46, v46, v37
    v_mul_f32 v47, v47, v37
    v_accvgpr_write_b32 a0, v40
    v_accvgpr_write_b32 a1, v41
    v_accvgpr_write_b32 a2, v42
    v_accvgpr_write_b32 a3, v43
    v_accvgpr_write_b32 a4, v44
    v_accvgpr_write_b32 a5, v45
    v_accvgpr_write_b32 a6, v46
    v_accvgpr_write_b32 a7, v47
    v_accvgpr_read_b32 v40, a8
    v_accvgpr_read_b32 v41, a9
    v_accvgpr_read_b32 v42, a10
    v_accvgpr_read_b32 v43, a11
    v_accvgpr_read_b32 v44, a12
    v_accvgpr_read_b32 v45, a13
    v_accvgpr_read_b32 v46, a14
    v_accvgpr_read_b32 v47, a15
    v_mul_f32 v40, v40, v37
    v_mul_f32 v41, v41, v37
    v_mul_f32 v42, v42, v37
    v_mul_f32 v43, v43, v37
    v_mul_f32 v44, v44, v37
    v_mul_f32 v45, v45, v37
    v_mul_f32 v46, v46, v37
    v_mul_f32 v47, v47, v37
    v_accvgpr_write_b32 a8, v40
    v_accvgpr_write_b32 a9, v41
    v_accvgpr_write_b32 a10, v42
    v_accvgpr_write_b32 a11, v43
    v_accvgpr_write_b32 a12, v44
    v_accvgpr_write_b32 a13, v45
    v_accvgpr_write_b32 a14, v46
    v_accvgpr_write_b32 a15, v47
    v_accvgpr_read_b32 v40, a16
    v_accvgpr_read_b32 v41, a17
    v_accvgpr_read_b32 v42, a18
    v_accvgpr_read_b32 v43, a19
    v_accvgpr_read_b32 v44, a20
    v_accvgpr_read_b32 v45, a21
    v_accvgpr_read_b32 v46, a22
    v_accvgpr_read_b32 v47, a23
    v_mul_f32 v40, v40, v37
    v_mul_f32 v41, v41, v37
    v_mul_f32 v42, v42, v37
    v_mul_f32 v43, v43, v37
    v_mul_f32 v44, v44, v37
    v_mul_f32 v45, v45, v37
    v_mul_f32 v46, v46, v37
    v_mul_f32 v47, v47, v37
    v_accvgpr_write_b32 a16, v40
    v_accvgpr_write_b32 a17, v41
    v_accvgpr_write_b32 a18, v42
    v_accvgpr_write_b32 a19, v43
    v_accvgpr_write_b32 a20, v44
    v_accvgpr_write_b32 a21, v45
    v_accvgpr_write_b32 a22, v46
    v_accvgpr_write_b32 a23, v47
    v_accvgpr_read_b32 v40, a24
    v_accvgpr_read_b32 v41, a25
    v_accvgpr_read_b32 v42, a26
    v_accvgpr_read_b32 v43, a27
    v_accvgpr_read_b32 v44, a28
    v_accvgpr_read_b32 v45, a29
    v_accvgpr_read_b32 v46, a30
    v_accvgpr_read_b32 v47, a31
    v_mul_f32 v40, v40, v37
    v_mul_f32 v41, v41, v37
    v_mul_f32 v42, v42, v37
    v_mul_f32 v43, v43, v37
    v_mul_f32 v44, v44, v37
    v_mul_f32 v45, v45, v37
    v_mul_f32 v46, v46, v37
    v_mul_f32 v47, v47, v37
    v_accvgpr_write_b32 a24, v40
    v_accvgpr_write_b32 a25, v41
    v_accvgpr_write_b32 a26, v42
    v_accvgpr_write_b32 a27, v43
    v_accvgpr_write_b32 a28, v44
    v_accvgpr_write_b32 a29, v45
    v_accvgpr_write_b32 a30, v46
    v_accvgpr_write_b32 a31, v47
    v_accvgpr_read_b32 v40, a32
    v_accvgpr_read_b32 v41, a33
    v_accvgpr_read_b32 v42, a34
    v_accvgpr_read_b32 v43, a35
    v_accvgpr_read_b32 v44, a36
    v_accvgpr_read_b32 v45, a37
    v_accvgpr_read_b32 v46, a38
    v_accvgpr_read_b32 v47, a39
    v_mul_f32 v40, v40, v37
    v_mul_f32 v41, v41, v37
    v_mul_f32 v42, v42, v37
    v_mul_f32 v43, v43, v37
    v_mul_f32 v44, v44, v37
    v_mul_f32 v45, v45, v37
    v_mul_f32 v46, v46, v37
    v_mul_f32 v47, v47, v37
    v_accvgpr_write_b32 a32, v40
    v_accvgpr_write_b32 a33, v41
    v_accvgpr_write_b32 a34, v42
    v_accvgpr_write_b32 a35, v43
    v_accvgpr_write_b32 a36, v44
    v_accvgpr_write_b32 a37, v45
    v_accvgpr_write_b32 a38, v46
    v_accvgpr_write_b32 a39, v47
    v_accvgpr_read_b32 v40, a40
    v_accvgpr_read_b32 v41, a41
    v_accvgpr_read_b32 v42, a42
    v_accvgpr_read_b32 v43, a43
    v_accvgpr_read_b32 v44, a44
    v_accvgpr_read_b32 v45, a45
    v_accvgpr_read_b32 v46, a46
    v_accvgpr_read_b32 v47, a47
    v_mul_f32 v40, v40, v37
    v_mul_f32 v41, v41, v37
    v_mul_f32 v42, v42, v37
    v_mul_f32 v43, v43, v37
    v_mul_f32 v44, v44, v37
    v_mul_f32 v45, v45, v37
    v_mul_f32 v46, v46, v37
    v_mul_f32 v47, v47, v37
    v_accvgpr_write_b32 a40, v40
    v_accvgpr_write_b32 a41, v41
    v_accvgpr_write_b32 a42, v42
    v_accvgpr_write_b32 a43, v43
    v_accvgpr_write_b32 a44, v44
    v_accvgpr_write_b32 a45, v45
    v_accvgpr_write_b32 a46, v46
    v_accvgpr_write_b32 a47, v47
    v_accvgpr_read_b32 v40, a48
    v_accvgpr_read_b32 v41, a49
    v_accvgpr_read_b32 v42, a50
    v_accvgpr_read_b32 v43, a51
    v_accvgpr_read_b32 v44, a52
    v_accvgpr_read_b32 v45, a53
    v_accvgpr_read_b32 v46, a54
    v_accvgpr_read_b32 v47, a55
    v_mul_f32 v40, v40, v37
    v_mul_f32 v41, v41, v37
    v_mul_f32 v42, v42, v37
    v_mul_f32 v43, v43, v37
    v_mul_f32 v44, v44, v37
    v_mul_f32 v45, v45, v37
    v_mul_f32 v46, v46, v37
    v_mul_f32 v47, v47, v37
    v_accvgpr_write_b32 a48, v40
    v_accvgpr_write_b32 a49, v41
    v_accvgpr_write_b32 a50, v42
    v_accvgpr_write_b32 a51, v43
    v_accvgpr_write_b32 a52, v44
    v_accvgpr_write_b32 a53, v45
    v_accvgpr_write_b32 a54, v46
    v_accvgpr_write_b32 a55, v47
    v_accvgpr_read_b32 v40, a56
    v_accvgpr_read_b32 v41, a57
    v_accvgpr_read_b32 v42, a58
    v_accvgpr_read_b32 v43, a59
    v_accvgpr_read_b32 v44, a60
    v_accvgpr_read_b32 v45, a61
    v_accvgpr_read_b32 v46, a62
    v_accvgpr_read_b32 v47, a63
    v_mul_f32 v40, v40, v37
    v_mul_f32 v41, v41, v37
    v_mul_f32 v42, v42, v37
    v_mul_f32 v43, v43, v37
    v_mul_f32 v44, v44, v37
    v_mul_f32 v45, v45, v37
    v_mul_f32 v46, v46, v37
    v_mul_f32 v47, v47, v37
    v_accvgpr_write_b32 a56, v40
    v_accvgpr_write_b32 a57, v41
    v_accvgpr_write_b32 a58, v42
    v_accvgpr_write_b32 a59, v43
    v_accvgpr_write_b32 a60, v44
    v_accvgpr_write_b32 a61, v45
    v_accvgpr_write_b32 a62, v46
    v_accvgpr_write_b32 a63, v47
    v_exp_f32 v40, v64
    v_exp_f32 v41, v65
    v_exp_f32 v42, v66
    v_exp_f32 v43, v67
    v_exp_f32 v44, v68
    v_exp_f32 v45, v69
    v_exp_f32 v46, v70
    v_exp_f32 v47, v71
    s_nop 0
    v_add_f32 v10, v40, v41
    v_add_f32 v10, v10, v42
    v_add_f32 v10, v10, v43
    v_add_f32 v10, v10, v44
    v_add_f32 v10, v10, v45
    v_add_f32 v10, v10, v46
    v_add_f32 v10, v10, v47
    v_cvt_pk_bf16_f32 v128, v40, v41
    v_cvt_pk_bf16_f32 v129, v42, v43
    v_cvt_pk_bf16_f32 v130, v44, v45
    v_cvt_pk_bf16_f32 v131, v46, v47
    v_exp_f32 v40, v72
    v_exp_f32 v41, v73
    v_exp_f32 v42, v74
    v_exp_f32 v43, v75
    v_exp_f32 v44, v76
    v_exp_f32 v45, v77
    v_exp_f32 v46, v78
    v_exp_f32 v47, v79
    s_nop 0
    v_add_f32 v10, v10, v40
    v_add_f32 v10, v10, v41
    v_add_f32 v10, v10, v42
    v_add_f32 v10, v10, v43
    v_add_f32 v10, v10, v44
    v_add_f32 v10, v10, v45
    v_add_f32 v10, v10, v46
    v_add_f32 v10, v10, v47
    v_cvt_pk_bf16_f32 v132, v40, v41
    v_cvt_pk_bf16_f32 v133, v42, v43
    v_cvt_pk_bf16_f32 v134, v44, v45
    v_cvt_pk_bf16_f32 v135, v46, v47
    v_max3_f32 v36, v80, v81, v82
    v_max3_f32 v36, v36, v83, v84
    v_max3_f32 v36, v36, v85, v86
    v_max3_f32 v36, v36, v87, v88
    v_max3_f32 v36, v36, v89, v90
    v_max3_f32 v36, v36, v91, v92
    v_max3_f32 v36, v36, v93, v94
    v_max3_f32 v36, v36, v95, 0
    v_mov_b32 v37, v36
    s_nop 1
    v_permlane32_swap_b32 v36, v37
    s_nop 1
    v_max_f32 v36, v36, v37
    v_exp_f32 v37, -v36
    v_sub_f32 v80, v80, v36
    v_sub_f32 v81, v81, v36
    v_sub_f32 v82, v82, v36
    v_sub_f32 v83, v83, v36
    v_sub_f32 v84, v84, v36
    v_sub_f32 v85, v85, v36
    v_sub_f32 v86, v86, v36
    v_sub_f32 v87, v87, v36
    v_sub_f32 v88, v88, v36
    v_sub_f32 v89, v89, v36
    v_sub_f32 v90, v90, v36
    v_sub_f32 v91, v91, v36
    v_sub_f32 v92, v92, v36
    v_sub_f32 v93, v93, v36
    v_sub_f32 v94, v94, v36
    v_sub_f32 v95, v95, v36
    v_sub_f32 v112, v112, v36
    v_sub_f32 v113, v113, v36
    v_sub_f32 v114, v114, v36
    v_sub_f32 v115, v115, v36
    v_sub_f32 v116, v116, v36
    v_sub_f32 v117, v117, v36
    v_sub_f32 v118, v118, v36
    v_sub_f32 v119, v119, v36
    v_sub_f32 v120, v120, v36
    v_sub_f32 v121, v121, v36
    v_sub_f32 v122, v122, v36
    v_sub_f32 v123, v123, v36
    v_sub_f32 v124, v124, v36
    v_sub_f32 v125, v125, v36
    v_sub_f32 v126, v126, v36
    v_sub_f32 v127, v127, v36
    v_sub_f32 v176, v176, v36
    v_sub_f32 v177, v177, v36
    v_sub_f32 v178, v178, v36
    v_sub_f32 v179, v179, v36
    v_sub_f32 v180, v180, v36
    v_sub_f32 v181, v181, v36
    v_sub_f32 v182, v182, v36
    v_sub_f32 v183, v183, v36
    v_sub_f32 v184, v184, v36
    v_sub_f32 v185, v185, v36
    v_sub_f32 v186, v186, v36
    v_sub_f32 v187, v187, v36
    v_sub_f32 v188, v188, v36
    v_sub_f32 v189, v189, v36
    v_sub_f32 v190, v190, v36
    v_sub_f32 v191, v191, v36
    v_mul_f32 v9, v9, v37
    v_accvgpr_read_b32 v40, a64
    v_accvgpr_read_b32 v41, a65
    v_accvgpr_read_b32 v42, a66
    v_accvgpr_read_b32 v43, a67
    v_accvgpr_read_b32 v44, a68
    v_accvgpr_read_b32 v45, a69
    v_accvgpr_read_b32 v46, a70
    v_accvgpr_read_b32 v47, a71
    v_mul_f32 v40, v40, v37
    v_mul_f32 v41, v41, v37
    v_mul_f32 v42, v42, v37
    v_mul_f32 v43, v43, v37
    v_mul_f32 v44, v44, v37
    v_mul_f32 v45, v45, v37
    v_mul_f32 v46, v46, v37
    v_mul_f32 v47, v47, v37
    v_accvgpr_write_b32 a64, v40
    v_accvgpr_write_b32 a65, v41
    v_accvgpr_write_b32 a66, v42
    v_accvgpr_write_b32 a67, v43
    v_accvgpr_write_b32 a68, v44
    v_accvgpr_write_b32 a69, v45
    v_accvgpr_write_b32 a70, v46
    v_accvgpr_write_b32 a71, v47
    v_accvgpr_read_b32 v40, a72
    v_accvgpr_read_b32 v41, a73
    v_accvgpr_read_b32 v42, a74
    v_accvgpr_read_b32 v43, a75
    v_accvgpr_read_b32 v44, a76
    v_accvgpr_read_b32 v45, a77
    v_accvgpr_read_b32 v46, a78
    v_accvgpr_read_b32 v47, a79
    v_mul_f32 v40, v40, v37
    v_mul_f32 v41, v41, v37
    v_mul_f32 v42, v42, v37
    v_mul_f32 v43, v43, v37
    v_mul_f32 v44, v44, v37
    v_mul_f32 v45, v45, v37
    v_mul_f32 v46, v46, v37
    v_mul_f32 v47, v47, v37
    v_accvgpr_write_b32 a72, v40
    v_accvgpr_write_b32 a73, v41
    v_accvgpr_write_b32 a74, v42
    v_accvgpr_write_b32 a75, v43
    v_accvgpr_write_b32 a76, v44
    v_accvgpr_write_b32 a77, v45
    v_accvgpr_write_b32 a78, v46
    v_accvgpr_write_b32 a79, v47
    v_accvgpr_read_b32 v40, a80
    v_accvgpr_read_b32 v41, a81
    v_accvgpr_read_b32 v42, a82
    v_accvgpr_read_b32 v43, a83
    v_accvgpr_read_b32 v44, a84
    v_accvgpr_read_b32 v45, a85
    v_accvgpr_read_b32 v46, a86
    v_accvgpr_read_b32 v47, a87
    v_mul_f32 v40, v40, v37
    v_mul_f32 v41, v41, v37
    v_mul_f32 v42, v42, v37
    v_mul_f32 v43, v43, v37
    v_mul_f32 v44, v44, v37
    v_mul_f32 v45, v45, v37
    v_mul_f32 v46, v46, v37
    v_mul_f32 v47, v47, v37
    v_accvgpr_write_b32 a80, v40
    v_accvgpr_write_b32 a81, v41
    v_accvgpr_write_b32 a82, v42
    v_accvgpr_write_b32 a83, v43
    v_accvgpr_write_b32 a84, v44
    v_accvgpr_write_b32 a85, v45
    v_accvgpr_write_b32 a86, v46
    v_accvgpr_write_b32 a87, v47
    v_accvgpr_read_b32 v40, a88
    v_accvgpr_read_b32 v41, a89
    v_accvgpr_read_b32 v42, a90
    v_accvgpr_read_b32 v43, a91
    v_accvgpr_read_b32 v44, a92
    v_accvgpr_read_b32 v45, a93
    v_accvgpr_read_b32 v46, a94
    v_accvgpr_read_b32 v47, a95
    v_mul_f32 v40, v40, v37
    v_mul_f32 v41, v41, v37
    v_mul_f32 v42, v42, v37
    v_mul_f32 v43, v43, v37
    v_mul_f32 v44, v44, v37
    v_mul_f32 v45, v45, v37
    v_mul_f32 v46, v46, v37
    v_mul_f32 v47, v47, v37
    v_accvgpr_write_b32 a88, v40
    v_accvgpr_write_b32 a89, v41
    v_accvgpr_write_b32 a90, v42
    v_accvgpr_write_b32 a91, v43
    v_accvgpr_write_b32 a92, v44
    v_accvgpr_write_b32 a93, v45
    v_accvgpr_write_b32 a94, v46
    v_accvgpr_write_b32 a95, v47
    v_accvgpr_read_b32 v40, a96
    v_accvgpr_read_b32 v41, a97
    v_accvgpr_read_b32 v42, a98
    v_accvgpr_read_b32 v43, a99
    v_accvgpr_read_b32 v44, a100
    v_accvgpr_read_b32 v45, a101
    v_accvgpr_read_b32 v46, a102
    v_accvgpr_read_b32 v47, a103
    v_mul_f32 v40, v40, v37
    v_mul_f32 v41, v41, v37
    v_mul_f32 v42, v42, v37
    v_mul_f32 v43, v43, v37
    v_mul_f32 v44, v44, v37
    v_mul_f32 v45, v45, v37
    v_mul_f32 v46, v46, v37
    v_mul_f32 v47, v47, v37
    v_accvgpr_write_b32 a96, v40
    v_accvgpr_write_b32 a97, v41
    v_accvgpr_write_b32 a98, v42
    v_accvgpr_write_b32 a99, v43
    v_accvgpr_write_b32 a100, v44
    v_accvgpr_write_b32 a101, v45
    v_accvgpr_write_b32 a102, v46
    v_accvgpr_write_b32 a103, v47
    v_accvgpr_read_b32 v40, a104
    v_accvgpr_read_b32 v41, a105
    v_accvgpr_read_b32 v42, a106
    v_accvgpr_read_b32 v43, a107
    v_accvgpr_read_b32 v44, a108
    v_accvgpr_read_b32 v45, a109
    v_accvgpr_read_b32 v46, a110
    v_accvgpr_read_b32 v47, a111
    v_mul_f32 v40, v40, v37
    v_mul_f32 v41, v41, v37
    v_mul_f32 v42, v42, v37
    v_mul_f32 v43, v43, v37
    v_mul_f32 v44, v44, v37
    v_mul_f32 v45, v45, v37
    v_mul_f32 v46, v46, v37
    v_mul_f32 v47, v47, v37
    v_accvgpr_write_b32 a104, v40
    v_accvgpr_write_b32 a105, v41
    v_accvgpr_write_b32 a106, v42
    v_accvgpr_write_b32 a107, v43
    v_accvgpr_write_b32 a108, v44
    v_accvgpr_write_b32 a109, v45
    v_accvgpr_write_b32 a110, v46
    v_accvgpr_write_b32 a111, v47
    v_accvgpr_read_b32 v40, a112
    v_accvgpr_read_b32 v41, a113
    v_accvgpr_read_b32 v42, a114
    v_accvgpr_read_b32 v43, a115
    v_accvgpr_read_b32 v44, a116
    v_accvgpr_read_b32 v45, a117
    v_accvgpr_read_b32 v46, a118
    v_accvgpr_read_b32 v47, a119
    v_mul_f32 v40, v40, v37
    v_mul_f32 v41, v41, v37
    v_mul_f32 v42, v42, v37
    v_mul_f32 v43, v43, v37
    v_mul_f32 v44, v44, v37
    v_mul_f32 v45, v45, v37
    v_mul_f32 v46, v46, v37
    v_mul_f32 v47, v47, v37
    v_accvgpr_write_b32 a112, v40
    v_accvgpr_write_b32 a113, v41
    v_accvgpr_write_b32 a114, v42
    v_accvgpr_write_b32 a115, v43
    v_accvgpr_write_b32 a116, v44
    v_accvgpr_write_b32 a117, v45
    v_accvgpr_write_b32 a118, v46
    v_accvgpr_write_b32 a119, v47
    v_accvgpr_read_b32 v40, a120
    v_accvgpr_read_b32 v41, a121
    v_accvgpr_read_b32 v42, a122
    v_accvgpr_read_b32 v43, a123
    v_accvgpr_read_b32 v44, a124
    v_accvgpr_read_b32 v45, a125
    v_accvgpr_read_b32 v46, a126
    v_accvgpr_read_b32 v47, a127
    v_mul_f32 v40, v40, v37
    v_mul_f32 v41, v41, v37
    v_mul_f32 v42, v42, v37
    v_mul_f32 v43, v43, v37
    v_mul_f32 v44, v44, v37
    v_mul_f32 v45, v45, v37
    v_mul_f32 v46, v46, v37
    v_mul_f32 v47, v47, v37
    v_accvgpr_write_b32 a120, v40
    v_accvgpr_write_b32 a121, v41
    v_accvgpr_write_b32 a122, v42
    v_accvgpr_write_b32 a123, v43
    v_accvgpr_write_b32 a124, v44
    v_accvgpr_write_b32 a125, v45
    v_accvgpr_write_b32 a126, v46
    v_accvgpr_write_b32 a127, v47
    v_exp_f32 v40, v80
    v_exp_f32 v41, v81
    v_exp_f32 v42, v82
    v_exp_f32 v43, v83
    v_exp_f32 v44, v84
    v_exp_f32 v45, v85
    v_exp_f32 v46, v86
    v_exp_f32 v47, v87
    s_nop 0
    v_add_f32 v11, v40, v41
    v_add_f32 v11, v11, v42
    v_add_f32 v11, v11, v43
    v_add_f32 v11, v11, v44
    v_add_f32 v11, v11, v45
    v_add_f32 v11, v11, v46
    v_add_f32 v11, v11, v47
    v_cvt_pk_bf16_f32 v136, v40, v41
    v_cvt_pk_bf16_f32 v137, v42, v43
    v_cvt_pk_bf16_f32 v138, v44, v45
    v_cvt_pk_bf16_f32 v139, v46, v47
    v_exp_f32 v40, v88
    v_exp_f32 v41, v89
    v_exp_f32 v42, v90
    v_exp_f32 v43, v91
    v_exp_f32 v44, v92
    v_exp_f32 v45, v93
    v_exp_f32 v46, v94
    v_exp_f32 v47, v95
    s_nop 0
    v_add_f32 v11, v11, v40
    v_add_f32 v11, v11, v41
    v_add_f32 v11, v11, v42
    v_add_f32 v11, v11, v43
    v_add_f32 v11, v11, v44
    v_add_f32 v11, v11, v45
    v_add_f32 v11, v11, v46
    v_add_f32 v11, v11, v47
    v_cvt_pk_bf16_f32 v140, v40, v41
    v_cvt_pk_bf16_f32 v141, v42, v43
    v_cvt_pk_bf16_f32 v142, v44, v45
    v_cvt_pk_bf16_f32 v143, v46, v47
    s_nop 1
    s_setpc_b64 s[40:41]
attn_kernel_rs114:
    s_nop 15
    v_max3_f32 v36, v96, v97, v98
    v_max3_f32 v36, v36, v99, v100
    v_max3_f32 v36, v36, v101, v102
    v_max3_f32 v36, v36, v103, v104
    v_max3_f32 v36, v36, v105, v106
    v_max3_f32 v36, v36, v107, v108
    v_max3_f32 v36, v36, v109, v110
    v_max3_f32 v36, v36, v111, 0
    v_mov_b32 v37, v36
    s_nop 1
    v_permlane32_swap_b32 v36, v37
    s_nop 1
    v_max_f32 v36, v36, v37
    v_exp_f32 v37, -v36
    v_sub_f32 v96, v96, v36
    v_sub_f32 v97, v97, v36
    v_sub_f32 v98, v98, v36
    v_sub_f32 v99, v99, v36
    v_sub_f32 v100, v100, v36
    v_sub_f32 v101, v101, v36
    v_sub_f32 v102, v102, v36
    v_sub_f32 v103, v103, v36
    v_sub_f32 v104, v104, v36
    v_sub_f32 v105, v105, v36
    v_sub_f32 v106, v106, v36
    v_sub_f32 v107, v107, v36
    v_sub_f32 v108, v108, v36
    v_sub_f32 v109, v109, v36
    v_sub_f32 v110, v110, v36
    v_sub_f32 v111, v111, v36
    v_sub_f32 v64, v64, v36
    v_sub_f32 v65, v65, v36
    v_sub_f32 v66, v66, v36
    v_sub_f32 v67, v67, v36
    v_sub_f32 v68, v68, v36
    v_sub_f32 v69, v69, v36
    v_sub_f32 v70, v70, v36
    v_sub_f32 v71, v71, v36
    v_sub_f32 v72, v72, v36
    v_sub_f32 v73, v73, v36
    v_sub_f32 v74, v74, v36
    v_sub_f32 v75, v75, v36
    v_sub_f32 v76, v76, v36
    v_sub_f32 v77, v77, v36
    v_sub_f32 v78, v78, v36
    v_sub_f32 v79, v79, v36
    v_sub_f32 v160, v160, v36
    v_sub_f32 v161, v161, v36
    v_sub_f32 v162, v162, v36
    v_sub_f32 v163, v163, v36
    v_sub_f32 v164, v164, v36
    v_sub_f32 v165, v165, v36
    v_sub_f32 v166, v166, v36
    v_sub_f32 v167, v167, v36
    v_sub_f32 v168, v168, v36
    v_sub_f32 v169, v169, v36
    v_sub_f32 v170, v170, v36
    v_sub_f32 v171, v171, v36
    v_sub_f32 v172, v172, v36
    v_sub_f32 v173, v173, v36
    v_sub_f32 v174, v174, v36
    v_sub_f32 v175, v175, v36
    v_mul_f32 v8, v8, v37
    v_accvgpr_read_b32 v40, a0
    v_accvgpr_read_b32 v41, a1
    v_accvgpr_read_b32 v42, a2
    v_accvgpr_read_b32 v43, a3
    v_accvgpr_read_b32 v44, a4
    v_accvgpr_read_b32 v45, a5
    v_accvgpr_read_b32 v46, a6
    v_accvgpr_read_b32 v47, a7
    v_mul_f32 v40, v40, v37
    v_mul_f32 v41, v41, v37
    v_mul_f32 v42, v42, v37
    v_mul_f32 v43, v43, v37
    v_mul_f32 v44, v44, v37
    v_mul_f32 v45, v45, v37
    v_mul_f32 v46, v46, v37
    v_mul_f32 v47, v47, v37
    v_accvgpr_write_b32 a0, v40
    v_accvgpr_write_b32 a1, v41
    v_accvgpr_write_b32 a2, v42
    v_accvgpr_write_b32 a3, v43
    v_accvgpr_write_b32 a4, v44
    v_accvgpr_write_b32 a5, v45
    v_accvgpr_write_b32 a6, v46
    v_accvgpr_write_b32 a7, v47
    v_accvgpr_read_b32 v40, a8
    v_accvgpr_read_b32 v41, a9
    v_accvgpr_read_b32 v42, a10
    v_accvgpr_read_b32 v43, a11
    v_accvgpr_read_b32 v44, a12
    v_accvgpr_read_b32 v45, a13
    v_accvgpr_read_b32 v46, a14
    v_accvgpr_read_b32 v47, a15
    v_mul_f32 v40, v40, v37
    v_mul_f32 v41, v41, v37
    v_mul_f32 v42, v42, v37
    v_mul_f32 v43, v43, v37
    v_mul_f32 v44, v44, v37
    v_mul_f32 v45, v45, v37
    v_mul_f32 v46, v46, v37
    v_mul_f32 v47, v47, v37
    v_accvgpr_write_b32 a8, v40
    v_accvgpr_write_b32 a9, v41
    v_accvgpr_write_b32 a10, v42
    v_accvgpr_write_b32 a11, v43
    v_accvgpr_write_b32 a12, v44
    v_accvgpr_write_b32 a13, v45
    v_accvgpr_write_b32 a14, v46
    v_accvgpr_write_b32 a15, v47
    v_accvgpr_read_b32 v40, a16
    v_accvgpr_read_b32 v41, a17
    v_accvgpr_read_b32 v42, a18
    v_accvgpr_read_b32 v43, a19
    v_accvgpr_read_b32 v44, a20
    v_accvgpr_read_b32 v45, a21
    v_accvgpr_read_b32 v46, a22
    v_accvgpr_read_b32 v47, a23
    v_mul_f32 v40, v40, v37
    v_mul_f32 v41, v41, v37
    v_mul_f32 v42, v42, v37
    v_mul_f32 v43, v43, v37
    v_mul_f32 v44, v44, v37
    v_mul_f32 v45, v45, v37
    v_mul_f32 v46, v46, v37
    v_mul_f32 v47, v47, v37
    v_accvgpr_write_b32 a16, v40
    v_accvgpr_write_b32 a17, v41
    v_accvgpr_write_b32 a18, v42
    v_accvgpr_write_b32 a19, v43
    v_accvgpr_write_b32 a20, v44
    v_accvgpr_write_b32 a21, v45
    v_accvgpr_write_b32 a22, v46
    v_accvgpr_write_b32 a23, v47
    v_accvgpr_read_b32 v40, a24
    v_accvgpr_read_b32 v41, a25
    v_accvgpr_read_b32 v42, a26
    v_accvgpr_read_b32 v43, a27
    v_accvgpr_read_b32 v44, a28
    v_accvgpr_read_b32 v45, a29
    v_accvgpr_read_b32 v46, a30
    v_accvgpr_read_b32 v47, a31
    v_mul_f32 v40, v40, v37
    v_mul_f32 v41, v41, v37
    v_mul_f32 v42, v42, v37
    v_mul_f32 v43, v43, v37
    v_mul_f32 v44, v44, v37
    v_mul_f32 v45, v45, v37
    v_mul_f32 v46, v46, v37
    v_mul_f32 v47, v47, v37
    v_accvgpr_write_b32 a24, v40
    v_accvgpr_write_b32 a25, v41
    v_accvgpr_write_b32 a26, v42
    v_accvgpr_write_b32 a27, v43
    v_accvgpr_write_b32 a28, v44
    v_accvgpr_write_b32 a29, v45
    v_accvgpr_write_b32 a30, v46
    v_accvgpr_write_b32 a31, v47
    v_accvgpr_read_b32 v40, a32
    v_accvgpr_read_b32 v41, a33
    v_accvgpr_read_b32 v42, a34
    v_accvgpr_read_b32 v43, a35
    v_accvgpr_read_b32 v44, a36
    v_accvgpr_read_b32 v45, a37
    v_accvgpr_read_b32 v46, a38
    v_accvgpr_read_b32 v47, a39
    v_mul_f32 v40, v40, v37
    v_mul_f32 v41, v41, v37
    v_mul_f32 v42, v42, v37
    v_mul_f32 v43, v43, v37
    v_mul_f32 v44, v44, v37
    v_mul_f32 v45, v45, v37
    v_mul_f32 v46, v46, v37
    v_mul_f32 v47, v47, v37
    v_accvgpr_write_b32 a32, v40
    v_accvgpr_write_b32 a33, v41
    v_accvgpr_write_b32 a34, v42
    v_accvgpr_write_b32 a35, v43
    v_accvgpr_write_b32 a36, v44
    v_accvgpr_write_b32 a37, v45
    v_accvgpr_write_b32 a38, v46
    v_accvgpr_write_b32 a39, v47
    v_accvgpr_read_b32 v40, a40
    v_accvgpr_read_b32 v41, a41
    v_accvgpr_read_b32 v42, a42
    v_accvgpr_read_b32 v43, a43
    v_accvgpr_read_b32 v44, a44
    v_accvgpr_read_b32 v45, a45
    v_accvgpr_read_b32 v46, a46
    v_accvgpr_read_b32 v47, a47
    v_mul_f32 v40, v40, v37
    v_mul_f32 v41, v41, v37
    v_mul_f32 v42, v42, v37
    v_mul_f32 v43, v43, v37
    v_mul_f32 v44, v44, v37
    v_mul_f32 v45, v45, v37
    v_mul_f32 v46, v46, v37
    v_mul_f32 v47, v47, v37
    v_accvgpr_write_b32 a40, v40
    v_accvgpr_write_b32 a41, v41
    v_accvgpr_write_b32 a42, v42
    v_accvgpr_write_b32 a43, v43
    v_accvgpr_write_b32 a44, v44
    v_accvgpr_write_b32 a45, v45
    v_accvgpr_write_b32 a46, v46
    v_accvgpr_write_b32 a47, v47
    v_accvgpr_read_b32 v40, a48
    v_accvgpr_read_b32 v41, a49
    v_accvgpr_read_b32 v42, a50
    v_accvgpr_read_b32 v43, a51
    v_accvgpr_read_b32 v44, a52
    v_accvgpr_read_b32 v45, a53
    v_accvgpr_read_b32 v46, a54
    v_accvgpr_read_b32 v47, a55
    v_mul_f32 v40, v40, v37
    v_mul_f32 v41, v41, v37
    v_mul_f32 v42, v42, v37
    v_mul_f32 v43, v43, v37
    v_mul_f32 v44, v44, v37
    v_mul_f32 v45, v45, v37
    v_mul_f32 v46, v46, v37
    v_mul_f32 v47, v47, v37
    v_accvgpr_write_b32 a48, v40
    v_accvgpr_write_b32 a49, v41
    v_accvgpr_write_b32 a50, v42
    v_accvgpr_write_b32 a51, v43
    v_accvgpr_write_b32 a52, v44
    v_accvgpr_write_b32 a53, v45
    v_accvgpr_write_b32 a54, v46
    v_accvgpr_write_b32 a55, v47
    v_accvgpr_read_b32 v40, a56
    v_accvgpr_read_b32 v41, a57
    v_accvgpr_read_b32 v42, a58
    v_accvgpr_read_b32 v43, a59
    v_accvgpr_read_b32 v44, a60
    v_accvgpr_read_b32 v45, a61
    v_accvgpr_read_b32 v46, a62
    v_accvgpr_read_b32 v47, a63
    v_mul_f32 v40, v40, v37
    v_mul_f32 v41, v41, v37
    v_mul_f32 v42, v42, v37
    v_mul_f32 v43, v43, v37
    v_mul_f32 v44, v44, v37
    v_mul_f32 v45, v45, v37
    v_mul_f32 v46, v46, v37
    v_mul_f32 v47, v47, v37
    v_accvgpr_write_b32 a56, v40
    v_accvgpr_write_b32 a57, v41
    v_accvgpr_write_b32 a58, v42
    v_accvgpr_write_b32 a59, v43
    v_accvgpr_write_b32 a60, v44
    v_accvgpr_write_b32 a61, v45
    v_accvgpr_write_b32 a62, v46
    v_accvgpr_write_b32 a63, v47
    v_exp_f32 v40, v96
    v_exp_f32 v41, v97
    v_exp_f32 v42, v98
    v_exp_f32 v43, v99
    v_exp_f32 v44, v100
    v_exp_f32 v45, v101
    v_exp_f32 v46, v102
    v_exp_f32 v47, v103
    s_nop 0
    v_add_f32 v10, v40, v41
    v_add_f32 v10, v10, v42
    v_add_f32 v10, v10, v43
    v_add_f32 v10, v10, v44
    v_add_f32 v10, v10, v45
    v_add_f32 v10, v10, v46
    v_add_f32 v10, v10, v47
    v_cvt_pk_bf16_f32 v144, v40, v41
    v_cvt_pk_bf16_f32 v145, v42, v43
    v_cvt_pk_bf16_f32 v146, v44, v45
    v_cvt_pk_bf16_f32 v147, v46, v47
    v_exp_f32 v40, v104
    v_exp_f32 v41, v105
    v_exp_f32 v42, v106
    v_exp_f32 v43, v107
    v_exp_f32 v44, v108
    v_exp_f32 v45, v109
    v_exp_f32 v46, v110
    v_exp_f32 v47, v111
    s_nop 0
    v_add_f32 v10, v10, v40
    v_add_f32 v10, v10, v41
    v_add_f32 v10, v10, v42
    v_add_f32 v10, v10, v43
    v_add_f32 v10, v10, v44
    v_add_f32 v10, v10, v45
    v_add_f32 v10, v10, v46
    v_add_f32 v10, v10, v47
    v_cvt_pk_bf16_f32 v148, v40, v41
    v_cvt_pk_bf16_f32 v149, v42, v43
    v_cvt_pk_bf16_f32 v150, v44, v45
    v_cvt_pk_bf16_f32 v151, v46, v47
    s_nop 1
    s_setpc_b64 s[40:41]
attn_kernel_rs125:
    s_nop 15
    v_max3_f32 v36, v96, v97, v98
    v_max3_f32 v36, v36, v99, v100
    v_max3_f32 v36, v36, v101, v102
    v_max3_f32 v36, v36, v103, v104
    v_max3_f32 v36, v36, v105, v106
    v_max3_f32 v36, v36, v107, v108
    v_max3_f32 v36, v36, v109, v110
    v_max3_f32 v36, v36, v111, 0
    v_mov_b32 v37, v36
    s_nop 1
    v_permlane32_swap_b32 v36, v37
    s_nop 1
    v_max_f32 v36, v36, v37
    v_exp_f32 v37, -v36
    v_sub_f32 v96, v96, v36
    v_sub_f32 v97, v97, v36
    v_sub_f32 v98, v98, v36
    v_sub_f32 v99, v99, v36
    v_sub_f32 v100, v100, v36
    v_sub_f32 v101, v101, v36
    v_sub_f32 v102, v102, v36
    v_sub_f32 v103, v103, v36
    v_sub_f32 v104, v104, v36
    v_sub_f32 v105, v105, v36
    v_sub_f32 v106, v106, v36
    v_sub_f32 v107, v107, v36
    v_sub_f32 v108, v108, v36
    v_sub_f32 v109, v109, v36
    v_sub_f32 v110, v110, v36
    v_sub_f32 v111, v111, v36
    v_sub_f32 v64, v64, v36
    v_sub_f32 v65, v65, v36
    v_sub_f32 v66, v66, v36
    v_sub_f32 v67, v67, v36
    v_sub_f32 v68, v68, v36
    v_sub_f32 v69, v69, v36
    v_sub_f32 v70, v70, v36
    v_sub_f32 v71, v71, v36
    v_sub_f32 v72, v72, v36
    v_sub_f32 v73, v73, v36
    v_sub_f32 v74, v74, v36
    v_sub_f32 v75, v75, v36
    v_sub_f32 v76, v76, v36
    v_sub_f32 v77, v77, v36
    v_sub_f32 v78, v78, v36
    v_sub_f32 v79, v79, v36
    v_sub_f32 v160, v160, v36
    v_sub_f32 v161, v161, v36
    v_sub_f32 v162, v162, v36
    v_sub_f32 v163, v163, v36
    v_sub_f32 v164, v164, v36
    v_sub_f32 v165, v165, v36
    v_sub_f32 v166, v166, v36
    v_sub_f32 v167, v167, v36
    v_sub_f32 v168, v168, v36
    v_sub_f32 v169, v169, v36
    v_sub_f32 v170, v170, v36
    v_sub_f32 v171, v171, v36
    v_sub_f32 v172, v172, v36
    v_sub_f32 v173, v173, v36
    v_sub_f32 v174, v174, v36
    v_sub_f32 v175, v175, v36
    v_mul_f32 v8, v8, v37
    v_accvgpr_read_b32 v40, a0
    v_accvgpr_read_b32 v41, a1
    v_accvgpr_read_b32 v42, a2
    v_accvgpr_read_b32 v43, a3
    v_accvgpr_read_b32 v44, a4
    v_accvgpr_read_b32 v45, a5
    v_accvgpr_read_b32 v46, a6
    v_accvgpr_read_b32 v47, a7
    v_mul_f32 v40, v40, v37
    v_mul_f32 v41, v41, v37
    v_mul_f32 v42, v42, v37
    v_mul_f32 v43, v43, v37
    v_mul_f32 v44, v44, v37
    v_mul_f32 v45, v45, v37
    v_mul_f32 v46, v46, v37
    v_mul_f32 v47, v47, v37
    v_accvgpr_write_b32 a0, v40
    v_accvgpr_write_b32 a1, v41
    v_accvgpr_write_b32 a2, v42
    v_accvgpr_write_b32 a3, v43
    v_accvgpr_write_b32 a4, v44
    v_accvgpr_write_b32 a5, v45
    v_accvgpr_write_b32 a6, v46
    v_accvgpr_write_b32 a7, v47
    v_accvgpr_read_b32 v40, a8
    v_accvgpr_read_b32 v41, a9
    v_accvgpr_read_b32 v42, a10
    v_accvgpr_read_b32 v43, a11
    v_accvgpr_read_b32 v44, a12
    v_accvgpr_read_b32 v45, a13
    v_accvgpr_read_b32 v46, a14
    v_accvgpr_read_b32 v47, a15
    v_mul_f32 v40, v40, v37
    v_mul_f32 v41, v41, v37
    v_mul_f32 v42, v42, v37
    v_mul_f32 v43, v43, v37
    v_mul_f32 v44, v44, v37
    v_mul_f32 v45, v45, v37
    v_mul_f32 v46, v46, v37
    v_mul_f32 v47, v47, v37
    v_accvgpr_write_b32 a8, v40
    v_accvgpr_write_b32 a9, v41
    v_accvgpr_write_b32 a10, v42
    v_accvgpr_write_b32 a11, v43
    v_accvgpr_write_b32 a12, v44
    v_accvgpr_write_b32 a13, v45
    v_accvgpr_write_b32 a14, v46
    v_accvgpr_write_b32 a15, v47
    v_accvgpr_read_b32 v40, a16
    v_accvgpr_read_b32 v41, a17
    v_accvgpr_read_b32 v42, a18
    v_accvgpr_read_b32 v43, a19
    v_accvgpr_read_b32 v44, a20
    v_accvgpr_read_b32 v45, a21
    v_accvgpr_read_b32 v46, a22
    v_accvgpr_read_b32 v47, a23
    v_mul_f32 v40, v40, v37
    v_mul_f32 v41, v41, v37
    v_mul_f32 v42, v42, v37
    v_mul_f32 v43, v43, v37
    v_mul_f32 v44, v44, v37
    v_mul_f32 v45, v45, v37
    v_mul_f32 v46, v46, v37
    v_mul_f32 v47, v47, v37
    v_accvgpr_write_b32 a16, v40
    v_accvgpr_write_b32 a17, v41
    v_accvgpr_write_b32 a18, v42
    v_accvgpr_write_b32 a19, v43
    v_accvgpr_write_b32 a20, v44
    v_accvgpr_write_b32 a21, v45
    v_accvgpr_write_b32 a22, v46
    v_accvgpr_write_b32 a23, v47
    v_accvgpr_read_b32 v40, a24
    v_accvgpr_read_b32 v41, a25
    v_accvgpr_read_b32 v42, a26
    v_accvgpr_read_b32 v43, a27
    v_accvgpr_read_b32 v44, a28
    v_accvgpr_read_b32 v45, a29
    v_accvgpr_read_b32 v46, a30
    v_accvgpr_read_b32 v47, a31
    v_mul_f32 v40, v40, v37
    v_mul_f32 v41, v41, v37
    v_mul_f32 v42, v42, v37
    v_mul_f32 v43, v43, v37
    v_mul_f32 v44, v44, v37
    v_mul_f32 v45, v45, v37
    v_mul_f32 v46, v46, v37
    v_mul_f32 v47, v47, v37
    v_accvgpr_write_b32 a24, v40
    v_accvgpr_write_b32 a25, v41
    v_accvgpr_write_b32 a26, v42
    v_accvgpr_write_b32 a27, v43
    v_accvgpr_write_b32 a28, v44
    v_accvgpr_write_b32 a29, v45
    v_accvgpr_write_b32 a30, v46
    v_accvgpr_write_b32 a31, v47
    v_accvgpr_read_b32 v40, a32
    v_accvgpr_read_b32 v41, a33
    v_accvgpr_read_b32 v42, a34
    v_accvgpr_read_b32 v43, a35
    v_accvgpr_read_b32 v44, a36
    v_accvgpr_read_b32 v45, a37
    v_accvgpr_read_b32 v46, a38
    v_accvgpr_read_b32 v47, a39
    v_mul_f32 v40, v40, v37
    v_mul_f32 v41, v41, v37
    v_mul_f32 v42, v42, v37
    v_mul_f32 v43, v43, v37
    v_mul_f32 v44, v44, v37
    v_mul_f32 v45, v45, v37
    v_mul_f32 v46, v46, v37
    v_mul_f32 v47, v47, v37
    v_accvgpr_write_b32 a32, v40
    v_accvgpr_write_b32 a33, v41
    v_accvgpr_write_b32 a34, v42
    v_accvgpr_write_b32 a35, v43
    v_accvgpr_write_b32 a36, v44
    v_accvgpr_write_b32 a37, v45
    v_accvgpr_write_b32 a38, v46
    v_accvgpr_write_b32 a39, v47
    v_accvgpr_read_b32 v40, a40
    v_accvgpr_read_b32 v41, a41
    v_accvgpr_read_b32 v42, a42
    v_accvgpr_read_b32 v43, a43
    v_accvgpr_read_b32 v44, a44
    v_accvgpr_read_b32 v45, a45
    v_accvgpr_read_b32 v46, a46
    v_accvgpr_read_b32 v47, a47
    v_mul_f32 v40, v40, v37
    v_mul_f32 v41, v41, v37
    v_mul_f32 v42, v42, v37
    v_mul_f32 v43, v43, v37
    v_mul_f32 v44, v44, v37
    v_mul_f32 v45, v45, v37
    v_mul_f32 v46, v46, v37
    v_mul_f32 v47, v47, v37
    v_accvgpr_write_b32 a40, v40
    v_accvgpr_write_b32 a41, v41
    v_accvgpr_write_b32 a42, v42
    v_accvgpr_write_b32 a43, v43
    v_accvgpr_write_b32 a44, v44
    v_accvgpr_write_b32 a45, v45
    v_accvgpr_write_b32 a46, v46
    v_accvgpr_write_b32 a47, v47
    v_accvgpr_read_b32 v40, a48
    v_accvgpr_read_b32 v41, a49
    v_accvgpr_read_b32 v42, a50
    v_accvgpr_read_b32 v43, a51
    v_accvgpr_read_b32 v44, a52
    v_accvgpr_read_b32 v45, a53
    v_accvgpr_read_b32 v46, a54
    v_accvgpr_read_b32 v47, a55
    v_mul_f32 v40, v40, v37
    v_mul_f32 v41, v41, v37
    v_mul_f32 v42, v42, v37
    v_mul_f32 v43, v43, v37
    v_mul_f32 v44, v44, v37
    v_mul_f32 v45, v45, v37
    v_mul_f32 v46, v46, v37
    v_mul_f32 v47, v47, v37
    v_accvgpr_write_b32 a48, v40
    v_accvgpr_write_b32 a49, v41
    v_accvgpr_write_b32 a50, v42
    v_accvgpr_write_b32 a51, v43
    v_accvgpr_write_b32 a52, v44
    v_accvgpr_write_b32 a53, v45
    v_accvgpr_write_b32 a54, v46
    v_accvgpr_write_b32 a55, v47
    v_accvgpr_read_b32 v40, a56
    v_accvgpr_read_b32 v41, a57
    v_accvgpr_read_b32 v42, a58
    v_accvgpr_read_b32 v43, a59
    v_accvgpr_read_b32 v44, a60
    v_accvgpr_read_b32 v45, a61
    v_accvgpr_read_b32 v46, a62
    v_accvgpr_read_b32 v47, a63
    v_mul_f32 v40, v40, v37
    v_mul_f32 v41, v41, v37
    v_mul_f32 v42, v42, v37
    v_mul_f32 v43, v43, v37
    v_mul_f32 v44, v44, v37
    v_mul_f32 v45, v45, v37
    v_mul_f32 v46, v46, v37
    v_mul_f32 v47, v47, v37
    v_accvgpr_write_b32 a56, v40
    v_accvgpr_write_b32 a57, v41
    v_accvgpr_write_b32 a58, v42
    v_accvgpr_write_b32 a59, v43
    v_accvgpr_write_b32 a60, v44
    v_accvgpr_write_b32 a61, v45
    v_accvgpr_write_b32 a62, v46
    v_accvgpr_write_b32 a63, v47
    v_exp_f32 v40, v96
    v_exp_f32 v41, v97
    v_exp_f32 v42, v98
    v_exp_f32 v43, v99
    v_exp_f32 v44, v100
    v_exp_f32 v45, v101
    v_exp_f32 v46, v102
    v_exp_f32 v47, v103
    s_nop 0
    v_add_f32 v10, v40, v41
    v_add_f32 v10, v10, v42
    v_add_f32 v10, v10, v43
    v_add_f32 v10, v10, v44
    v_add_f32 v10, v10, v45
    v_add_f32 v10, v10, v46
    v_add_f32 v10, v10, v47
    v_cvt_pk_bf16_f32 v144, v40, v41
    v_cvt_pk_bf16_f32 v145, v42, v43
    v_cvt_pk_bf16_f32 v146, v44, v45
    v_cvt_pk_bf16_f32 v147, v46, v47
    v_exp_f32 v40, v104
    v_exp_f32 v41, v105
    v_exp_f32 v42, v106
    v_exp_f32 v43, v107
    v_exp_f32 v44, v108
    v_exp_f32 v45, v109
    v_exp_f32 v46, v110
    v_exp_f32 v47, v111
    s_nop 0
    v_add_f32 v10, v10, v40
    v_add_f32 v10, v10, v41
    v_add_f32 v10, v10, v42
    v_add_f32 v10, v10, v43
    v_add_f32 v10, v10, v44
    v_add_f32 v10, v10, v45
    v_add_f32 v10, v10, v46
    v_add_f32 v10, v10, v47
    v_cvt_pk_bf16_f32 v148, v40, v41
    v_cvt_pk_bf16_f32 v149, v42, v43
    v_cvt_pk_bf16_f32 v150, v44, v45
    v_cvt_pk_bf16_f32 v151, v46, v47
    v_max3_f32 v36, v112, v113, v114
    v_max3_f32 v36, v36, v115, v116
    v_max3_f32 v36, v36, v117, v118
    v_max3_f32 v36, v36, v119, v120
    v_max3_f32 v36, v36, v121, v122
    v_max3_f32 v36, v36, v123, v124
    v_max3_f32 v36, v36, v125, v126
    v_max3_f32 v36, v36, v127, 0
    v_mov_b32 v37, v36
    s_nop 1
    v_permlane32_swap_b32 v36, v37
    s_nop 1
    v_max_f32 v36, v36, v37
    v_exp_f32 v37, -v36
    v_sub_f32 v112, v112, v36
    v_sub_f32 v113, v113, v36
    v_sub_f32 v114, v114, v36
    v_sub_f32 v115, v115, v36
    v_sub_f32 v116, v116, v36
    v_sub_f32 v117, v117, v36
    v_sub_f32 v118, v118, v36
    v_sub_f32 v119, v119, v36
    v_sub_f32 v120, v120, v36
    v_sub_f32 v121, v121, v36
    v_sub_f32 v122, v122, v36
    v_sub_f32 v123, v123, v36
    v_sub_f32 v124, v124, v36
    v_sub_f32 v125, v125, v36
    v_sub_f32 v126, v126, v36
    v_sub_f32 v127, v127, v36
    v_sub_f32 v80, v80, v36
    v_sub_f32 v81, v81, v36
    v_sub_f32 v82, v82, v36
    v_sub_f32 v83, v83, v36
    v_sub_f32 v84, v84, v36
    v_sub_f32 v85, v85, v36
    v_sub_f32 v86, v86, v36
    v_sub_f32 v87, v87, v36
    v_sub_f32 v88, v88, v36
    v_sub_f32 v89, v89, v36
    v_sub_f32 v90, v90, v36
    v_sub_f32 v91, v91, v36
    v_sub_f32 v92, v92, v36
    v_sub_f32 v93, v93, v36
    v_sub_f32 v94, v94, v36
    v_sub_f32 v95, v95, v36
    v_sub_f32 v176, v176, v36
    v_sub_f32 v177, v177, v36
    v_sub_f32 v178, v178, v36
    v_sub_f32 v179, v179, v36
    v_sub_f32 v180, v180, v36
    v_sub_f32 v181, v181, v36
    v_sub_f32 v182, v182, v36
    v_sub_f32 v183, v183, v36
    v_sub_f32 v184, v184, v36
    v_sub_f32 v185, v185, v36
    v_sub_f32 v186, v186, v36
    v_sub_f32 v187, v187, v36
    v_sub_f32 v188, v188, v36
    v_sub_f32 v189, v189, v36
    v_sub_f32 v190, v190, v36
    v_sub_f32 v191, v191, v36
    v_mul_f32 v9, v9, v37
    v_accvgpr_read_b32 v40, a64
    v_accvgpr_read_b32 v41, a65
    v_accvgpr_read_b32 v42, a66
    v_accvgpr_read_b32 v43, a67
    v_accvgpr_read_b32 v44, a68
    v_accvgpr_read_b32 v45, a69
    v_accvgpr_read_b32 v46, a70
    v_accvgpr_read_b32 v47, a71
    v_mul_f32 v40, v40, v37
    v_mul_f32 v41, v41, v37
    v_mul_f32 v42, v42, v37
    v_mul_f32 v43, v43, v37
    v_mul_f32 v44, v44, v37
    v_mul_f32 v45, v45, v37
    v_mul_f32 v46, v46, v37
    v_mul_f32 v47, v47, v37
    v_accvgpr_write_b32 a64, v40
    v_accvgpr_write_b32 a65, v41
    v_accvgpr_write_b32 a66, v42
    v_accvgpr_write_b32 a67, v43
    v_accvgpr_write_b32 a68, v44
    v_accvgpr_write_b32 a69, v45
    v_accvgpr_write_b32 a70, v46
    v_accvgpr_write_b32 a71, v47
    v_accvgpr_read_b32 v40, a72
    v_accvgpr_read_b32 v41, a73
    v_accvgpr_read_b32 v42, a74
    v_accvgpr_read_b32 v43, a75
    v_accvgpr_read_b32 v44, a76
    v_accvgpr_read_b32 v45, a77
    v_accvgpr_read_b32 v46, a78
    v_accvgpr_read_b32 v47, a79
    v_mul_f32 v40, v40, v37
    v_mul_f32 v41, v41, v37
    v_mul_f32 v42, v42, v37
    v_mul_f32 v43, v43, v37
    v_mul_f32 v44, v44, v37
    v_mul_f32 v45, v45, v37
    v_mul_f32 v46, v46, v37
    v_mul_f32 v47, v47, v37
    v_accvgpr_write_b32 a72, v40
    v_accvgpr_write_b32 a73, v41
    v_accvgpr_write_b32 a74, v42
    v_accvgpr_write_b32 a75, v43
    v_accvgpr_write_b32 a76, v44
    v_accvgpr_write_b32 a77, v45
    v_accvgpr_write_b32 a78, v46
    v_accvgpr_write_b32 a79, v47
    v_accvgpr_read_b32 v40, a80
    v_accvgpr_read_b32 v41, a81
    v_accvgpr_read_b32 v42, a82
    v_accvgpr_read_b32 v43, a83
    v_accvgpr_read_b32 v44, a84
    v_accvgpr_read_b32 v45, a85
    v_accvgpr_read_b32 v46, a86
    v_accvgpr_read_b32 v47, a87
    v_mul_f32 v40, v40, v37
    v_mul_f32 v41, v41, v37
    v_mul_f32 v42, v42, v37
    v_mul_f32 v43, v43, v37
    v_mul_f32 v44, v44, v37
    v_mul_f32 v45, v45, v37
    v_mul_f32 v46, v46, v37
    v_mul_f32 v47, v47, v37
    v_accvgpr_write_b32 a80, v40
    v_accvgpr_write_b32 a81, v41
    v_accvgpr_write_b32 a82, v42
    v_accvgpr_write_b32 a83, v43
    v_accvgpr_write_b32 a84, v44
    v_accvgpr_write_b32 a85, v45
    v_accvgpr_write_b32 a86, v46
    v_accvgpr_write_b32 a87, v47
    v_accvgpr_read_b32 v40, a88
    v_accvgpr_read_b32 v41, a89
    v_accvgpr_read_b32 v42, a90
    v_accvgpr_read_b32 v43, a91
    v_accvgpr_read_b32 v44, a92
    v_accvgpr_read_b32 v45, a93
    v_accvgpr_read_b32 v46, a94
    v_accvgpr_read_b32 v47, a95
    v_mul_f32 v40, v40, v37
    v_mul_f32 v41, v41, v37
    v_mul_f32 v42, v42, v37
    v_mul_f32 v43, v43, v37
    v_mul_f32 v44, v44, v37
    v_mul_f32 v45, v45, v37
    v_mul_f32 v46, v46, v37
    v_mul_f32 v47, v47, v37
    v_accvgpr_write_b32 a88, v40
    v_accvgpr_write_b32 a89, v41
    v_accvgpr_write_b32 a90, v42
    v_accvgpr_write_b32 a91, v43
    v_accvgpr_write_b32 a92, v44
    v_accvgpr_write_b32 a93, v45
    v_accvgpr_write_b32 a94, v46
    v_accvgpr_write_b32 a95, v47
    v_accvgpr_read_b32 v40, a96
    v_accvgpr_read_b32 v41, a97
    v_accvgpr_read_b32 v42, a98
    v_accvgpr_read_b32 v43, a99
    v_accvgpr_read_b32 v44, a100
    v_accvgpr_read_b32 v45, a101
    v_accvgpr_read_b32 v46, a102
    v_accvgpr_read_b32 v47, a103
    v_mul_f32 v40, v40, v37
    v_mul_f32 v41, v41, v37
    v_mul_f32 v42, v42, v37
    v_mul_f32 v43, v43, v37
    v_mul_f32 v44, v44, v37
    v_mul_f32 v45, v45, v37
    v_mul_f32 v46, v46, v37
    v_mul_f32 v47, v47, v37
    v_accvgpr_write_b32 a96, v40
    v_accvgpr_write_b32 a97, v41
    v_accvgpr_write_b32 a98, v42
    v_accvgpr_write_b32 a99, v43
    v_accvgpr_write_b32 a100, v44
    v_accvgpr_write_b32 a101, v45
    v_accvgpr_write_b32 a102, v46
    v_accvgpr_write_b32 a103, v47
    v_accvgpr_read_b32 v40, a104
    v_accvgpr_read_b32 v41, a105
    v_accvgpr_read_b32 v42, a106
    v_accvgpr_read_b32 v43, a107
    v_accvgpr_read_b32 v44, a108
    v_accvgpr_read_b32 v45, a109
    v_accvgpr_read_b32 v46, a110
    v_accvgpr_read_b32 v47, a111
    v_mul_f32 v40, v40, v37
    v_mul_f32 v41, v41, v37
    v_mul_f32 v42, v42, v37
    v_mul_f32 v43, v43, v37
    v_mul_f32 v44, v44, v37
    v_mul_f32 v45, v45, v37
    v_mul_f32 v46, v46, v37
    v_mul_f32 v47, v47, v37
    v_accvgpr_write_b32 a104, v40
    v_accvgpr_write_b32 a105, v41
    v_accvgpr_write_b32 a106, v42
    v_accvgpr_write_b32 a107, v43
    v_accvgpr_write_b32 a108, v44
    v_accvgpr_write_b32 a109, v45
    v_accvgpr_write_b32 a110, v46
    v_accvgpr_write_b32 a111, v47
    v_accvgpr_read_b32 v40, a112
    v_accvgpr_read_b32 v41, a113
    v_accvgpr_read_b32 v42, a114
    v_accvgpr_read_b32 v43, a115
    v_accvgpr_read_b32 v44, a116
    v_accvgpr_read_b32 v45, a117
    v_accvgpr_read_b32 v46, a118
    v_accvgpr_read_b32 v47, a119
    v_mul_f32 v40, v40, v37
    v_mul_f32 v41, v41, v37
    v_mul_f32 v42, v42, v37
    v_mul_f32 v43, v43, v37
    v_mul_f32 v44, v44, v37
    v_mul_f32 v45, v45, v37
    v_mul_f32 v46, v46, v37
    v_mul_f32 v47, v47, v37
    v_accvgpr_write_b32 a112, v40
    v_accvgpr_write_b32 a113, v41
    v_accvgpr_write_b32 a114, v42
    v_accvgpr_write_b32 a115, v43
    v_accvgpr_write_b32 a116, v44
    v_accvgpr_write_b32 a117, v45
    v_accvgpr_write_b32 a118, v46
    v_accvgpr_write_b32 a119, v47
    v_accvgpr_read_b32 v40, a120
    v_accvgpr_read_b32 v41, a121
    v_accvgpr_read_b32 v42, a122
    v_accvgpr_read_b32 v43, a123
    v_accvgpr_read_b32 v44, a124
    v_accvgpr_read_b32 v45, a125
    v_accvgpr_read_b32 v46, a126
    v_accvgpr_read_b32 v47, a127
    v_mul_f32 v40, v40, v37
    v_mul_f32 v41, v41, v37
    v_mul_f32 v42, v42, v37
    v_mul_f32 v43, v43, v37
    v_mul_f32 v44, v44, v37
    v_mul_f32 v45, v45, v37
    v_mul_f32 v46, v46, v37
    v_mul_f32 v47, v47, v37
    v_accvgpr_write_b32 a120, v40
    v_accvgpr_write_b32 a121, v41
    v_accvgpr_write_b32 a122, v42
    v_accvgpr_write_b32 a123, v43
    v_accvgpr_write_b32 a124, v44
    v_accvgpr_write_b32 a125, v45
    v_accvgpr_write_b32 a126, v46
    v_accvgpr_write_b32 a127, v47
    v_exp_f32 v40, v112
    v_exp_f32 v41, v113
    v_exp_f32 v42, v114
    v_exp_f32 v43, v115
    v_exp_f32 v44, v116
    v_exp_f32 v45, v117
    v_exp_f32 v46, v118
    v_exp_f32 v47, v119
    s_nop 0
    v_add_f32 v11, v40, v41
    v_add_f32 v11, v11, v42
    v_add_f32 v11, v11, v43
    v_add_f32 v11, v11, v44
    v_add_f32 v11, v11, v45
    v_add_f32 v11, v11, v46
    v_add_f32 v11, v11, v47
    v_cvt_pk_bf16_f32 v152, v40, v41
    v_cvt_pk_bf16_f32 v153, v42, v43
    v_cvt_pk_bf16_f32 v154, v44, v45
    v_cvt_pk_bf16_f32 v155, v46, v47
    v_exp_f32 v40, v120
    v_exp_f32 v41, v121
    v_exp_f32 v42, v122
    v_exp_f32 v43, v123
    v_exp_f32 v44, v124
    v_exp_f32 v45, v125
    v_exp_f32 v46, v126
    v_exp_f32 v47, v127
    s_nop 0
    v_add_f32 v11, v11, v40
    v_add_f32 v11, v11, v41
    v_add_f32 v11, v11, v42
    v_add_f32 v11, v11, v43
    v_add_f32 v11, v11, v44
    v_add_f32 v11, v11, v45
    v_add_f32 v11, v11, v46
    v_add_f32 v11, v11, v47
    v_cvt_pk_bf16_f32 v156, v40, v41
    v_cvt_pk_bf16_f32 v157, v42, v43
    v_cvt_pk_bf16_f32 v158, v44, v45
    v_cvt_pk_bf16_f32 v159, v46, v47
    s_nop 1
    s_setpc_b64 s[40:41]
.text
.globl gemm3_kernel
.p2align 8
.type gemm3_kernel,@function
gemm3_kernel:
    s_cmp_ge_u32 s2, 256
    s_cbranch_scc1 gemm3_kernel_end1
    s_load_dwordx8 s[4:11], s[0:1], 64
    s_load_dwordx2 s[12:13], s[0:1], 16
    v_and_b32 v1, 63, v0
    v_lshrrev_b32 v16, 6, v0
    s_nop 0
    v_readfirstlane_b32 s36, v16
    s_bfe_u32 s39, s2, 0x10002
    s_xor_b32 s39, s39, 1
    s_bfe_u32 s51, s2, 0x10001
    s_lshl_b32 s51, s51, 3
    s_bfe_u32 s52, s2, 0x30003
    s_add_u32 s40, s51, s52
    s_and_b32 s51, s2, 1
    s_lshl_b32 s51, s51, 2
    s_lshr_b32 s52, s2, 6
    s_add_u32 s41, s51, s52
    s_lshl_b32 s42, s40, 3
    s_add_u32 s42, s42, s41
    s_lshr_b32 s37, s36, 1
    s_and_b32 s38, s36, 1
    s_lshl_b32 s48, s36, 12
    v_lshlrev_b32 v7, 4, v1
    s_lshl_b32 s51, s40, 13
    s_lshl_b32 s52, s38, 12
    s_add_u32 s51, s51, s52
    s_lshl_b32 s52, s37, 17
    s_add_u32 s43, s51, s52
    s_mul_i32 s51, s39, 10485760
    s_add_u32 s44, s43, s51
    s_add_u32 s44, s44, 67108864
    s_mul_i32 s51, s39, 5242880
    s_lshl_b32 s45, s41, 8
    s_add_u32 s45, s45, s51
    v_lshrrev_b32 v16, 4, v1
    s_lshl_b32 s51, s36, 4
    v_add_u32 v17, s51, v16
    v_lshlrev_b32 v17, 11, v17
    v_lshlrev_b32 v16, 1, v16
    v_and_b32 v18, 15, v1
    v_xor_b32 v16, v16, v18
    v_xor_b32 v18, 0, v16
    v_lshl_add_u32 v8, v18, 4, v17
    v_xor_b32 v18, 8, v16
    v_lshl_add_u32 v9, v18, 4, v17
    v_add_u32 v9, 7168, v9
    v_xor_b32 v18, 0, v16
    v_lshl_add_u32 v10, v18, 4, v17
    v_add_u32 v10, 14336, v10
    v_xor_b32 v18, 8, v16
    v_lshl_add_u32 v11, v18, 4, v17
    v_add_u32 v11, 21504, v11
    s_mov_b32 s18, 268435456
    s_mov_b32 s19, 0x20000
    s_mov_b32 s23, 0x20000
    s_mov_b32 s22, 8388608
    s_mov_b32 s47, s48
    s_waitcnt lgkmcnt(0)
    s_mov_b32 s20, s4
    s_mov_b32 s21, s5
    s_mov_b32 s16, s10
    s_mov_b32 s17, s11
    s_mov_b32 m0, s47
    s_nop 0
    buffer_load_dwordx4 v7, s[16:19], s44 offen offset:0 lds
    buffer_load_dwordx4 v7, s[16:19], s44 offen offset:1024 lds
    buffer_load_dwordx4 v7, s[16:19], s44 offen offset:2048 lds
    buffer_load_dwordx4 v7, s[16:19], s44 offen offset:3072 lds
    s_add_u32 m0, s47, 16384
    s_add_u32 s44, s44, 262144
    buffer_load_dwordx4 v8, s[20:23], s45 offen offset:0 lds
    buffer_load_dwordx4 v9, s[20:23], s45 offen offset:1024 lds
    buffer_load_dwordx4 v10, s[20:23], s45 offen offset:2048 lds
    buffer_load_dwordx4 v11, s[20:23], s45 offen offset:3072 lds
    s_add_u32 s45, s45, 131072
    s_add_u32 s47, s47, 32768
    s_lshl_b32 s51, s37, 12
    v_add_u32 v2, s51, v7
    v_lshrrev_b32 v16, 2, v1
    v_lshlrev_b32 v16, 8, v16
    v_and_b32 v17, 3, v1
    v_lshl_add_u32 v16, v17, 3, v16
    v_add_u32 v16, 16384, v16
    v_bfe_u32 v17, v1, 2, 3
    s_lshl_b32 s51, s38, 2
    v_xor_b32 v17, s51, v17
    v_xor_b32 v18, 0, v17
    v_lshl_add_u32 v3, v18, 5, v16
    v_xor_b32 v18, 1, v17
    v_lshl_add_u32 v4, v18, 5, v16
    v_xor_b32 v18, 2, v17
    v_lshl_add_u32 v5, v18, 5, v16
    v_xor_b32 v18, 3, v17
    v_lshl_add_u32 v6, v18, 5, v16
    s_mov_b32 s24, s6
    s_mov_b32 s25, s7
    s_mov_b32 s27, 0x20000
    s_mov_b32 s26, 8388608
    s_mov_b32 s28, s10
    s_mov_b32 s29, s11
    s_mov_b32 s31, 0x20000
    s_mov_b32 s30, 268435456
    s_mov_b32 s32, s8
    s_mov_b32 s33, s9
    s_mov_b32 s35, 0x20000
    s_mov_b32 s34, 256
    s_mov_b32 s46, 0
    s_mov_b32 s60, 32768
    s_mov_b32 s50, 39
    v_mov_b32 v15, 0
    v_mov_b32 v32, 0
    v_mov_b32 v33, 0
    v_mov_b32 v34, 0
    v_mov_b32 v35, 0
    v_mov_b32 v36, 0
    v_mov_b32 v37, 0
    v_mov_b32 v38, 0
    v_mov_b32 v39, 0
    v_mov_b32 v40, 0
    v_mov_b32 v41, 0
    v_mov_b32 v42, 0
    v_mov_b32 v43, 0
    v_mov_b32 v44, 0
    v_mov_b32 v45, 0
    v_mov_b32 v46, 0
    v_mov_b32 v47, 0
    v_mov_b32 v48, 0
    v_mov_b32 v49, 0
    v_mov_b32 v50, 0
    v_mov_b32 v51, 0
    v_mov_b32 v52, 0
    v_mov_b32 v53, 0
    v_mov_b32 v54, 0
    v_mov_b32 v55, 0
    v_mov_b32 v56, 0
    v_mov_b32 v57, 0
    v_mov_b32 v58, 0
    v_mov_b32 v59, 0
    v_mov_b32 v60, 0
    v_mov_b32 v61, 0
    v_mov_b32 v62, 0
    v_mov_b32 v63, 0
    v_mov_b32 v64, 0
    v_mov_b32 v65, 0
    v_mov_b32 v66, 0
    v_mov_b32 v67, 0
    v_mov_b32 v68, 0
    v_mov_b32 v69, 0
    v_mov_b32 v70, 0
    v_mov_b32 v71, 0
    v_mov_b32 v72, 0
    v_mov_b32 v73, 0
    v_mov_b32 v74, 0
    v_mov_b32 v75, 0
    v_mov_b32 v76, 0
    v_mov_b32 v77, 0
    v_mov_b32 v78, 0
    v_mov_b32 v79, 0
    v_mov_b32 v80, 0
    v_mov_b32 v81, 0
    v_mov_b32 v82, 0
    v_mov_b32 v83, 0
    v_mov_b32 v84, 0
    v_mov_b32 v85, 0
    v_mov_b32 v86, 0
    v_mov_b32 v87, 0
    v_mov_b32 v88, 0
    v_mov_b32 v89, 0
    v_mov_b32 v90, 0
    v_mov_b32 v91, 0
    v_mov_b32 v92, 0
    v_mov_b32 v93, 0
    v_mov_b32 v94, 0
    v_mov_b32 v95, 0
    s_mov_b32 m0, s47
    s_nop 0
    buffer_load_dwordx4 v7, s[16:19], s44 offen offset:0 lds
    buffer_load_dwordx4 v7, s[16:19], s44 offen offset:1024 lds
    buffer_load_dwordx4 v7, s[16:19], s44 offen offset:2048 lds
    buffer_load_dwordx4 v7, s[16:19], s44 offen offset:3072 lds
    s_add_u32 m0, s47, 16384
    s_add_u32 s44, s44, 262144
    buffer_load_dwordx4 v8, s[20:23], s45 offen offset:0 lds
    buffer_load_dwordx4 v9, s[20:23], s45 offen offset:1024 lds
    buffer_load_dwordx4 v10, s[20:23], s45 offen offset:2048 lds
    buffer_load_dwordx4 v11, s[20:23], s45 offen offset:3072 lds
    s_add_u32 s45, s45, 131072
    s_add_u32 s47, s47, 32768
    s_mov_b32 m0, s47
    s_nop 0
    buffer_load_dwordx4 v7, s[16:19], s44 offen offset:0 lds
    buffer_load_dwordx4 v7, s[16:19], s44 offen offset:1024 lds
    buffer_load_dwordx4 v7, s[16:19], s44 offen offset:2048 lds
    buffer_load_dwordx4 v7, s[16:19], s44 offen offset:3072 lds
    s_add_u32 m0, s47, 16384
    s_add_u32 s44, s44, 262144
    buffer_load_dwordx4 v8, s[20:23], s45 offen offset:0 lds
    buffer_load_dwordx4 v9, s[20:23], s45 offen offset:1024 lds
    buffer_load_dwordx4 v10, s[20:23], s45 offen offset:2048 lds
    buffer_load_dwordx4 v11, s[20:23], s45 offen offset:3072 lds
    s_add_u32 s45, s45, 131072
    s_add_u32 s47, s47, 32768
    s_mov_b32 m0, s47
    s_nop 0
    buffer_load_dwordx4 v7, s[16:19], s44 offen offset:0 lds
    buffer_load_dwordx4 v7, s[16:19], s44 offen offset:1024 lds
    buffer_load_dwordx4 v7, s[16:19], s44 offen offset:2048 lds
    buffer_load_dwordx4 v7, s[16:19], s44 offen offset:3072 lds
    s_add_u32 m0, s47, 16384
    s_add_u32 s44, s44, 262144
    buffer_load_dwordx4 v8, s[20:23], s45 offen offset:0 lds
    buffer_load_dwordx4 v9, s[20:23], s45 offen offset:1024 lds
    buffer_load_dwordx4 v10, s[20:23], s45 offen offset:2048 lds
    buffer_load_dwordx4 v11, s[20:23], s45 offen offset:3072 lds
    s_add_u32 s45, s45, 131072
    s_add_u32 s47, s47, 32768
    s_mov_b32 m0, s47
    s_nop 0
    buffer_load_dwordx4 v7, s[16:19], s44 offen offset:0 lds
    buffer_load_dwordx4 v7, s[16:19], s44 offen offset:1024 lds
    buffer_load_dwordx4 v7, s[16:19], s44 offen offset:2048 lds
    buffer_load_dwordx4 v7, s[16:19], s44 offen offset:3072 lds
    s_cmp_eq_u32 s39, 1
    s_cselect_b32 s61, 19, 33
    s_cselect_b32 s62, 0, 8
    s_waitcnt vmcnt(28)
    s_barrier
    ds_read_b128 v[96:99], v2 offset:0
    ds_read_b64_tr_b16 v[112:113], v3 offset:0
    ds_read_b64_tr_b16 v[114:115], v3 offset:4096
    ds_read_b128 v[100:103], v2 offset:1024
    ds_read_b128 v[104:107], v2 offset:2048
    ds_read_b128 v[108:111], v2 offset:3072
    ds_read_b64_tr_b16 v[116:117], v4 offset:0
    ds_read_b64_tr_b16 v[118:119], v4 offset:4096
    ds_read_b64_tr_b16 v[120:121], v5 offset:0
    ds_read_b64_tr_b16 v[122:123], v5 offset:4096
    ds_read_b64_tr_b16 v[124:125], v6 offset:0
    ds_read_b64_tr_b16 v[126:127], v6 offset:4096
gemm3_kernel_loop2:
    s_sub_u32 s61, s61, 1
    s_cbranch_scc1 gemm3_kernel_ev3
gemm3_kernel_back4:
    s_waitcnt lgkmcnt(9)
    v_mfma_f32_16x16x32_bf16 v[32:35], v[112:115], v[96:99], v[32:35]
    ds_read_b128 v[128:131], v2 offset:8192
    s_waitcnt lgkmcnt(9)
    v_mfma_f32_16x16x32_bf16 v[40:43], v[112:115], v[100:103], v[40:43]
    ds_read_b64_tr_b16 v[144:145], v3 offset:8192
    s_add_u32 m0, s47, 16384
    s_add_u32 s44, s44, 262144
    buffer_load_dwordx4 v8, s[20:23], s45 offen offset:0 lds
    s_waitcnt lgkmcnt(9)
    v_mfma_f32_16x16x32_bf16 v[48:51], v[112:115], v[104:107], v[48:51]
    ds_read_b64_tr_b16 v[146:147], v3 offset:12288
    s_waitcnt lgkmcnt(9)
    v_mfma_f32_16x16x32_bf16 v[56:59], v[112:115], v[108:111], v[56:59]
    ds_read_b128 v[132:135], v2 offset:9216
    s_waitcnt lgkmcnt(8)
    v_mfma_f32_16x16x32_bf16 v[36:39], v[116:119], v[96:99], v[36:39]
    ds_read_b128 v[136:139], v2 offset:10240
    buffer_load_dwordx4 v9, s[20:23], s45 offen offset:1024 lds
    v_mfma_f32_16x16x32_bf16 v[44:47], v[116:119], v[100:103], v[44:47]
    ds_read_b128 v[140:143], v2 offset:11264
    v_mfma_f32_16x16x32_bf16 v[52:55], v[116:119], v[104:107], v[52:55]
    ds_read_b64_tr_b16 v[148:149], v4 offset:8192
    v_mfma_f32_16x16x32_bf16 v[60:63], v[116:119], v[108:111], v[60:63]
    ds_read_b64_tr_b16 v[150:151], v4 offset:12288
    buffer_load_dwordx4 v10, s[20:23], s45 offen offset:2048 lds
    s_waitcnt lgkmcnt(10)
    v_mfma_f32_16x16x32_bf16 v[64:67], v[120:123], v[96:99], v[64:67]
    ds_read_b64_tr_b16 v[152:153], v5 offset:8192
    v_mfma_f32_16x16x32_bf16 v[72:75], v[120:123], v[100:103], v[72:75]
    ds_read_b64_tr_b16 v[154:155], v5 offset:12288
    v_mfma_f32_16x16x32_bf16 v[80:83], v[120:123], v[104:107], v[80:83]
    ds_read_b64_tr_b16 v[156:157], v6 offset:8192
    buffer_load_dwordx4 v11, s[20:23], s45 offen offset:3072 lds
    s_add_u32 s45, s45, 131072
    v_mfma_f32_16x16x32_bf16 v[88:91], v[120:123], v[108:111], v[88:91]
    ds_read_b64_tr_b16 v[158:159], v6 offset:12288
    s_waitcnt lgkmcnt(12)
    v_mfma_f32_16x16x32_bf16 v[68:71], v[124:127], v[96:99], v[68:71]
    s_add_u32 s47, s46, s48
    s_add_u32 s46, s46, 32768
    v_mfma_f32_16x16x32_bf16 v[76:79], v[124:127], v[100:103], v[76:79]
    s_cmp_ge_u32 s46, 163840
    s_cselect_b32 s49, 4294836224, s60
    v_mfma_f32_16x16x32_bf16 v[84:87], v[124:127], v[104:107], v[84:87]
    s_cselect_b32 s46, 0, s46
    v_add_u32 v2, s49, v2
    v_add_u32 v3, s49, v3
    v_mfma_f32_16x16x32_bf16 v[92:95], v[124:127], v[108:111], v[92:95]
    v_add_u32 v4, s49, v4
    v_add_u32 v5, s49, v5
    s_waitcnt vmcnt(24) lgkmcnt(0)
    v_mfma_f32_16x16x32_bf16 v[32:35], v[144:147], v[128:131], v[32:35]
    s_barrier
    v_add_u32 v6, s49, v6
    v_mfma_f32_16x16x32_bf16 v[40:43], v[144:147], v[132:135], v[40:43]
    ds_read_b128 v[96:99], v2 offset:0
    v_mfma_f32_16x16x32_bf16 v[48:51], v[144:147], v[136:139], v[48:51]
    ds_read_b64_tr_b16 v[112:113], v3 offset:0
    v_mfma_f32_16x16x32_bf16 v[56:59], v[144:147], v[140:143], v[56:59]
    ds_read_b64_tr_b16 v[114:115], v3 offset:4096
    s_mov_b32 m0, s47
    s_nop 0
    buffer_load_dwordx4 v7, s[16:19], s44 offen offset:0 lds
    v_mfma_f32_16x16x32_bf16 v[36:39], v[148:151], v[128:131], v[36:39]
    ds_read_b128 v[100:103], v2 offset:1024
    v_mfma_f32_16x16x32_bf16 v[44:47], v[148:151], v[132:135], v[44:47]
    ds_read_b128 v[104:107], v2 offset:2048
    v_mfma_f32_16x16x32_bf16 v[52:55], v[148:151], v[136:139], v[52:55]
    ds_read_b128 v[108:111], v2 offset:3072
    buffer_load_dwordx4 v7, s[16:19], s44 offen offset:1024 lds
    v_mfma_f32_16x16x32_bf16 v[60:63], v[148:151], v[140:143], v[60:63]
    ds_read_b64_tr_b16 v[116:117], v4 offset:0
    v_mfma_f32_16x16x32_bf16 v[64:67], v[152:155], v[128:131], v[64:67]
    ds_read_b64_tr_b16 v[118:119], v4 offset:4096
    v_mfma_f32_16x16x32_bf16 v[72:75], v[152:155], v[132:135], v[72:75]
    ds_read_b64_tr_b16 v[120:121], v5 offset:0
    buffer_load_dwordx4 v7, s[16:19], s44 offen offset:2048 lds
    v_mfma_f32_16x16x32_bf16 v[80:83], v[152:155], v[136:139], v[80:83]
    ds_read_b64_tr_b16 v[122:123], v5 offset:4096
    v_mfma_f32_16x16x32_bf16 v[88:91], v[152:155], v[140:143], v[88:91]
    ds_read_b64_tr_b16 v[124:125], v6 offset:0
    v_mfma_f32_16x16x32_bf16 v[68:71], v[156:159], v[128:131], v[68:71]
    ds_read_b64_tr_b16 v[126:127], v6 offset:4096
    v_mfma_f32_16x16x32_bf16 v[76:79], v[156:159], v[132:135], v[76:79]
    buffer_load_dwordx4 v7, s[16:19], s44 offen offset:3072 lds
    v_mfma_f32_16x16x32_bf16 v[84:87], v[156:159], v[136:139], v[84:87]
    v_mfma_f32_16x16x32_bf16 v[92:95], v[156:159], v[140:143], v[92:95]
    s_sub_u32 s50, s50, 1
    s_cbranch_scc0 gemm3_kernel_loop2
    v_and_b32 v16, 15, v1
    v_lshlrev_b32 v16, 12, v16
    v_lshlrev_b32 v16, s39, v16
    v_bfe_u32 v17, v1, 4, 1
    v_lshl_add_u32 v16, v17, 5, v16
    v_lshrrev_b32 v17, 5, v1
    v_lshl_add_u32 v12, v17, 4, v16
    s_lshl_b32 s51, s40, 3
    s_lshl_b32 s52, s37, 2
    s_add_u32 s51, s51, s52
    s_lshl_b32 s52, s51, 16
    s_add_u32 s52, s52, 2048
    s_and_b32 s53, s51, 63
    s_lshl_b32 s53, s53, 17
    s_lshr_b32 s54, s51, 6
    s_lshl_b32 s54, s54, 12
    s_add_u32 s53, s53, s54
    s_cmp_eq_u32 s39, 1
    s_cselect_b32 s51, s53, s52
    s_lshl_b32 s52, 0x10000, s39
    s_lshl_b32 s53, s41, 8
    s_lshl_b32 s54, s38, 7
    s_add_u32 s51, s51, s53
    s_add_u32 s51, s51, s54
    s_cmp_eq_u32 s39, 1
    s_cbranch_scc1 gemm3_kernel_noadd5
    s_waitcnt vmcnt(0)
    v_add_f32 v32, v32, v160
    v_add_f32 v33, v33, v161
    v_add_f32 v34, v34, v162
    v_add_f32 v35, v35, v163
    v_add_f32 v36, v36, v164
    v_add_f32 v37, v37, v165
    v_add_f32 v38, v38, v166
    v_add_f32 v39, v39, v167
    v_add_f32 v40, v40, v168
    v_add_f32 v41, v41, v169
    v_add_f32 v42, v42, v170
    v_add_f32 v43, v43, v171
    v_add_f32 v44, v44, v172
    v_add_f32 v45, v45, v173
    v_add_f32 v46, v46, v174
    v_add_f32 v47, v47, v175
    v_add_f32 v48, v48, v176
    v_add_f32 v49, v49, v177
    v_add_f32 v50, v50, v178
    v_add_f32 v51, v51, v179
    v_add_f32 v52, v52, v180
    v_add_f32 v53, v53, v181
    v_add_f32 v54, v54, v182
    v_add_f32 v55, v55, v183
    v_add_f32 v56, v56, v184
    v_add_f32 v57, v57, v185
    v_add_f32 v58, v58, v186
    v_add_f32 v59, v59, v187
    v_add_f32 v60, v60, v188
    v_add_f32 v61, v61, v189
    v_add_f32 v62, v62, v190
    v_add_f32 v63, v63, v191
    v_add_f32 v64, v64, v192
    v_add_f32 v65, v65, v193
    v_add_f32 v66, v66, v194
    v_add_f32 v67, v67, v195
    v_add_f32 v68, v68, v196
    v_add_f32 v69, v69, v197
    v_add_f32 v70, v70, v198
    v_add_f32 v71, v71, v199
    v_add_f32 v72, v72, v200
    v_add_f32 v73, v73, v201
    v_add_f32 v74, v74, v202
    v_add_f32 v75, v75, v203
    v_add_f32 v76, v76, v204
    v_add_f32 v77, v77, v205
    v_add_f32 v78, v78, v206
    v_add_f32 v79, v79, v207
    v_add_f32 v80, v80, v208
    v_add_f32 v81, v81, v209
    v_add_f32 v82, v82, v210
    v_add_f32 v83, v83, v211
    v_add_f32 v84, v84, v212
    v_add_f32 v85, v85, v213
    v_add_f32 v86, v86, v214
    v_add_f32 v87, v87, v215
    v_add_f32 v88, v88, v216
    v_add_f32 v89, v89, v217
    v_add_f32 v90, v90, v218
    v_add_f32 v91, v91, v219
    v_add_f32 v92, v92, v220
    v_add_f32 v93, v93, v221
    v_add_f32 v94, v94, v222
    v_add_f32 v95, v95, v223
gemm3_kernel_noadd5:
    v_cvt_pk_bf16_f32 v32, v32, v33
    v_cvt_pk_bf16_f32 v33, v34, v35
    v_cvt_pk_bf16_f32 v34, v36, v37
    v_cvt_pk_bf16_f32 v35, v38, v39
    v_cvt_pk_bf16_f32 v64, v64, v65
    v_cvt_pk_bf16_f32 v65, v66, v67
    v_cvt_pk_bf16_f32 v66, v68, v69
    v_cvt_pk_bf16_f32 v67, v70, v71
    s_nop 1
    v_permlane16_swap_b32 v32, v34
    v_permlane16_swap_b32 v33, v35
    v_permlane16_swap_b32 v64, v66
    v_permlane16_swap_b32 v65, v67
    buffer_store_dwordx4 v[32:35], v12, s[24:27], s51 offen offset:0
    buffer_store_dwordx4 v[64:67], v12, s[24:27], s51 offen offset:64
    s_add_u32 s51, s51, s52
    v_cvt_pk_bf16_f32 v40, v40, v41
    v_cvt_pk_bf16_f32 v41, v42, v43
    v_cvt_pk_bf16_f32 v42, v44, v45
    v_cvt_pk_bf16_f32 v43, v46, v47
    v_cvt_pk_bf16_f32 v72, v72, v73
    v_cvt_pk_bf16_f32 v73, v74, v75
    v_cvt_pk_bf16_f32 v74, v76, v77
    v_cvt_pk_bf16_f32 v75, v78, v79
    s_nop 1
    v_permlane16_swap_b32 v40, v42
    v_permlane16_swap_b32 v41, v43
    v_permlane16_swap_b32 v72, v74
    v_permlane16_swap_b32 v73, v75
    buffer_store_dwordx4 v[40:43], v12, s[24:27], s51 offen offset:0
    buffer_store_dwordx4 v[72:75], v12, s[24:27], s51 offen offset:64
    s_add_u32 s51, s51, s52
    v_cvt_pk_bf16_f32 v48, v48, v49
    v_cvt_pk_bf16_f32 v49, v50, v51
    v_cvt_pk_bf16_f32 v50, v52, v53
    v_cvt_pk_bf16_f32 v51, v54, v55
    v_cvt_pk_bf16_f32 v80, v80, v81
    v_cvt_pk_bf16_f32 v81, v82, v83
    v_cvt_pk_bf16_f32 v82, v84, v85
    v_cvt_pk_bf16_f32 v83, v86, v87
    s_nop 1
    v_permlane16_swap_b32 v48, v50
    v_permlane16_swap_b32 v49, v51
    v_permlane16_swap_b32 v80, v82
    v_permlane16_swap_b32 v81, v83
    buffer_store_dwordx4 v[48:51], v12, s[24:27], s51 offen offset:0
    buffer_store_dwordx4 v[80:83], v12, s[24:27], s51 offen offset:64
    s_add_u32 s51, s51, s52
    v_cvt_pk_bf16_f32 v56, v56, v57
    v_cvt_pk_bf16_f32 v57, v58, v59
    v_cvt_pk_bf16_f32 v58, v60, v61
    v_cvt_pk_bf16_f32 v59, v62, v63
    v_cvt_pk_bf16_f32 v88, v88, v89
    v_cvt_pk_bf16_f32 v89, v90, v91
    v_cvt_pk_bf16_f32 v90, v92, v93
    v_cvt_pk_bf16_f32 v91, v94, v95
    s_nop 1
    v_permlane16_swap_b32 v56, v58
    v_permlane16_swap_b32 v57, v59
    v_permlane16_swap_b32 v88, v90
    v_permlane16_swap_b32 v89, v91
    buffer_store_dwordx4 v[56:59], v12, s[24:27], s51 offen offset:0
    buffer_store_dwordx4 v[88:91], v12, s[24:27], s51 offen offset:64
    s_add_u32 s51, s51, s52
gemm3_kernel_end1:
    s_endpgm
gemm3_kernel_ev3:
    s_cmp_lg_u32 s62, 0
    s_cbranch_scc1 gemm3_kernel_n6
    s_add_u32 s44, s43, 83623936
    s_mov_b32 s61, 0
    s_mov_b32 s62, 1
    s_branch gemm3_kernel_back4
gemm3_kernel_n6:
    s_cmp_lg_u32 s62, 1
    s_cbranch_scc1 gemm3_kernel_n7
    s_mov_b32 s20, s12
    s_mov_b32 s21, s13
    s_mov_b32 s22, 2097152
    s_lshl_b32 s45, s41, 8
    s_mov_b32 s61, 3
    s_mov_b32 s62, 2
    s_branch gemm3_kernel_back4
gemm3_kernel_n7:
    s_cmp_lg_u32 s62, 2
    s_cbranch_scc1 gemm3_kernel_n8
    s_lshl_b32 s51, s42, 16
    s_lshl_b32 s52, s36, 14
    s_add_u32 s51, s51, s52
    s_add_u32 s51, s51, 100663296
    s_nop 7
    buffer_store_dwordx4 v[32:35], v7, s[28:31], s51 offen offset:0 sc1
    buffer_store_dwordx4 v[36:39], v7, s[28:31], s51 offen offset:1024 sc1
    buffer_store_dwordx4 v[40:43], v7, s[28:31], s51 offen offset:2048 sc1
    buffer_store_dwordx4 v[44:47], v7, s[28:31], s51 offen offset:3072 sc1
    s_add_u32 s51, s51, 4096
    buffer_store_dwordx4 v[48:51], v7, s[28:31], s51 offen offset:0 sc1
    buffer_store_dwordx4 v[52:55], v7, s[28:31], s51 offen offset:1024 sc1
    buffer_store_dwordx4 v[56:59], v7, s[28:31], s51 offen offset:2048 sc1
    buffer_store_dwordx4 v[60:63], v7, s[28:31], s51 offen offset:3072 sc1
    s_add_u32 s51, s51, 4096
    buffer_store_dwordx4 v[64:67], v7, s[28:31], s51 offen offset:0 sc1
    buffer_store_dwordx4 v[68:71], v7, s[28:31], s51 offen offset:1024 sc1
    buffer_store_dwordx4 v[72:75], v7, s[28:31], s51 offen offset:2048 sc1
    buffer_store_dwordx4 v[76:79], v7, s[28:31], s51 offen offset:3072 sc1
    s_add_u32 s51, s51, 4096
    buffer_store_dwordx4 v[80:83], v7, s[28:31], s51 offen offset:0 sc1
    buffer_store_dwordx4 v[84:87], v7, s[28:31], s51 offen offset:1024 sc1
    buffer_store_dwordx4 v[88:91], v7, s[28:31], s51 offen offset:2048 sc1
    buffer_store_dwordx4 v[92:95], v7, s[28:31], s51 offen offset:3072 sc1
    s_add_u32 s51, s51, 4096
    s_nop 1
    v_mov_b32 v32, 0
    v_mov_b32 v33, 0
    v_mov_b32 v34, 0
    v_mov_b32 v35, 0
    v_mov_b32 v36, 0
    v_mov_b32 v37, 0
    v_mov_b32 v38, 0
    v_mov_b32 v39, 0
    v_mov_b32 v40, 0
    v_mov_b32 v41, 0
    v_mov_b32 v42, 0
    v_mov_b32 v43, 0
    v_mov_b32 v44, 0
    v_mov_b32 v45, 0
    v_mov_b32 v46, 0
    v_mov_b32 v47, 0
    v_mov_b32 v48, 0
    v_mov_b32 v49, 0
    v_mov_b32 v50, 0
    v_mov_b32 v51, 0
    v_mov_b32 v52, 0
    v_mov_b32 v53, 0
    v_mov_b32 v54, 0
    v_mov_b32 v55, 0
    v_mov_b32 v56, 0
    v_mov_b32 v57, 0
    v_mov_b32 v58, 0
    v_mov_b32 v59, 0
    v_mov_b32 v60, 0
    v_mov_b32 v61, 0
    v_mov_b32 v62, 0
    v_mov_b32 v63, 0
    v_mov_b32 v64, 0
    v_mov_b32 v65, 0
    v_mov_b32 v66, 0
    v_mov_b32 v67, 0
    v_mov_b32 v68, 0
    v_mov_b32 v69, 0
    v_mov_b32 v70, 0
    v_mov_b32 v71, 0
    v_mov_b32 v72, 0
    v_mov_b32 v73, 0
    v_mov_b32 v74, 0
    v_mov_b32 v75, 0
    v_mov_b32 v76, 0
    v_mov_b32 v77, 0
    v_mov_b32 v78, 0
    v_mov_b32 v79, 0
    v_mov_b32 v80, 0
    v_mov_b32 v81, 0
    v_mov_b32 v82, 0
    v_mov_b32 v83, 0
    v_mov_b32 v84, 0
    v_mov_b32 v85, 0
    v_mov_b32 v86, 0
    v_mov_b32 v87, 0
    v_mov_b32 v88, 0
    v_mov_b32 v89, 0
    v_mov_b32 v90, 0
    v_mov_b32 v91, 0
    v_mov_b32 v92, 0
    v_mov_b32 v93, 0
    v_mov_b32 v94, 0
    v_mov_b32 v95, 0
    s_nop 1
    s_mov_b32 s61, 4
    s_mov_b32 s62, 3
    s_branch gemm3_kernel_back4
gemm3_kernel_n8:
    s_cmp_lg_u32 s62, 3
    s_cbranch_scc1 gemm3_kernel_n9
    s_cmp_lg_u32 s36, 0
    s_cbranch_scc1 gemm3_kernel_np10
    s_lshl_b32 s51, s42, 1
    v_mov_b32 v16, 1
    s_mov_b64 s[64:65], exec
    s_mov_b64 exec, 1
    buffer_store_short v16, v15, s[32:35], s51 offen sc1
    s_mov_b64 exec, s[64:65]
gemm3_kernel_np10:
    s_mov_b32 s61, 5
    s_mov_b32 s62, 4
    s_branch gemm3_kernel_back4
gemm3_kernel_n9:
    s_cmp_lg_u32 s62, 4
    s_cbranch_scc1 gemm3_kernel_n11
    s_mov_b32 s18, 0
    s_mov_b32 s61, 1000
    s_mov_b32 s62, 5
    s_branch gemm3_kernel_back4
gemm3_kernel_n11:
    s_cmp_lg_u32 s62, 8
    s_cbranch_scc1 gemm3_kernel_n12
    s_lshl_b32 s51, s42, 1
    buffer_load_ushort v14, v15, s[32:35], s51 offen sc1
    s_mov_b32 s61, 1
    s_mov_b32 s62, 9
    s_branch gemm3_kernel_back4
gemm3_kernel_n12:
    s_cmp_lg_u32 s62, 9
    s_cbranch_scc1 gemm3_kernel_n13
    s_mov_b32 s18, 0
    s_mov_b32 s61, 0
    s_mov_b32 s62, 10
    s_branch gemm3_kernel_back4
gemm3_kernel_n13:
    s_cmp_lg_u32 s62, 10
    s_cbranch_scc1 gemm3_kernel_n14
    s_mov_b32 s22, 0
    s_waitcnt vmcnt(16)
gemm3_kernel_spin15:
    v_readfirstlane_b32 s52, v14
    s_nop 3
    s_cmp_lg_u32 s52, 0
    s_cbranch_scc1 gemm3_kernel_ok16
    s_sleep 8
    s_lshl_b32 s51, s42, 1
    buffer_load_ushort v14, v15, s[32:35], s51 offen sc1
    s_waitcnt vmcnt(0)
    s_branch gemm3_kernel_spin15
gemm3_kernel_ok16:
    s_lshl_b32 s51, s42, 16
    s_lshl_b32 s52, s36, 14
    s_add_u32 s51, s51, s52
    s_add_u32 s51, s51, 100663296
    buffer_load_dwordx4 v[160:163], v7, s[28:31], s51 offen offset:0 sc1
    buffer_load_dwordx4 v[164:167], v7, s[28:31], s51 offen offset:1024 sc1
    buffer_load_dwordx4 v[168:171], v7, s[28:31], s51 offen offset:2048 sc1
    buffer_load_dwordx4 v[172:175], v7, s[28:31], s51 offen offset:3072 sc1
    s_add_u32 s51, s51, 4096
    buffer_load_dwordx4 v[176:179], v7, s[28:31], s51 offen offset:0 sc1
    buffer_load_dwordx4 v[180:183], v7, s[28:31], s51 offen offset:1024 sc1
    buffer_load_dwordx4 v[184:187], v7, s[28:31], s51 offen offset:2048 sc1
    buffer_load_dwordx4 v[188:191], v7, s[28:31], s51 offen offset:3072 sc1
    s_add_u32 s51, s51, 4096
    buffer_load_dwordx4 v[192:195], v7, s[28:31], s51 offen offset:0 sc1
    buffer_load_dwordx4 v[196:199], v7, s[28:31], s51 offen offset:1024 sc1
    buffer_load_dwordx4 v[200:203], v7, s[28:31], s51 offen offset:2048 sc1
    buffer_load_dwordx4 v[204:207], v7, s[28:31], s51 offen offset:3072 sc1
    s_add_u32 s51, s51, 4096
    buffer_load_dwordx4 v[208:211], v7, s[28:31], s51 offen offset:0 sc1
    buffer_load_dwordx4 v[212:215], v7, s[28:31], s51 offen offset:1024 sc1
    buffer_load_dwordx4 v[216:219], v7, s[28:31], s51 offen offset:2048 sc1
    buffer_load_dwordx4 v[220:223], v7, s[28:31], s51 offen offset:3072 sc1
    s_add_u32 s51, s51, 4096
    s_mov_b32 s61, 1000
    s_mov_b32 s62, 11
    s_branch gemm3_kernel_back4
gemm3_kernel_n14:
    s_mov_b32 s61, 1000
    s_branch gemm3_kernel_back4
.section .rodata,"a"
.p2align 6
.amdhsa_kernel gemm1_kernel
  .amdhsa_next_free_vgpr 512
  .amdhsa_next_free_sgpr 102
  .amdhsa_accum_offset 256
  .amdhsa_group_segment_fixed_size 0
  .amdhsa_kernarg_size 96
  .amdhsa_user_sgpr_count 2
  .amdhsa_user_sgpr_kernarg_segment_ptr 1
  .amdhsa_system_sgpr_workgroup_id_x 1
.end_amdhsa_kernel
.section .rodata,"a"
.p2align 6
.amdhsa_kernel attn_kernel
  .amdhsa_next_free_vgpr 512
  .amdhsa_next_free_sgpr 102
  .amdhsa_accum_offset 256
  .amdhsa_group_segment_fixed_size 0
  .amdhsa_kernarg_size 96
  .amdhsa_user_sgpr_count 2
  .amdhsa_user_sgpr_kernarg_segment_ptr 1
  .amdhsa_system_sgpr_workgroup_id_x 1
.end_amdhsa_kernel
.section .rodata,"a"
.p2align 6
.amdhsa_kernel gemm3_kernel
  .amdhsa_next_free_vgpr 224
  .amdhsa_next_free_sgpr 102
  .amdhsa_accum_offset 224
  .amdhsa_group_segment_fixed_size 0
  .amdhsa_kernarg_size 96
  .amdhsa_user_sgpr_count 2
  .amdhsa_user_sgpr_kernarg_segment_ptr 1
  .amdhsa_system_sgpr_workgroup_id_x 1
.end_amdhsa_kernel
```

```asm
; @launch kernel=mega_kernel grid=(256,1,1) block=(256,1,1) lds=163840
; @launch kernel=gemm3_kernel grid=(256,1,1) block=(256,1,1) lds=163840
.amdgcn_target "amdgcn-amd-amdhsa--gfx950"
.text
.globl mega_kernel
.p2align 8
.type mega_kernel,@function
mega_kernel:
    s_cmp_ge_u32 s2, 256
    s_cbranch_scc1 mega_kernel_end1
    s_load_dwordx16 s[24:39], s[0:1], 0
    s_load_dwordx4 s[4:7], s[0:1], 80
    v_and_b32 v1, 63, v0
    v_lshrrev_b32 v24, 6, v0
    s_nop 0
    v_readfirstlane_b32 s16, v24
    s_lshr_b32 s68, s2, 3
    s_lshr_b32 s57, s16, 1
    s_and_b32 s58, s16, 1
    s_mov_b32 s43, 0x20000
    s_mov_b32 s47, 0x20000
    s_cmp_lt_u32 s68, 30
    s_cbranch_scc1 mega_kernel_ncp2
    s_sub_u32 s91, s68, 30
    s_lshl_b32 s91, s91, 2
    s_add_u32 s91, s91, s16
    s_getpc_b64 s[8:9]
mega_kernel_pc3:
    s_sub_u32 s8, s8, mega_kernel_pc3-mega_kernel
    s_subb_u32 s9, s9, 0
    s_mov_b32 s10, gemm3_kernel_end-mega_kernel
    s_mov_b32 s11, 0x20000
    s_lshl_b32 s90, s91, 13
    v_lshlrev_b32 v24, 7, v1
    buffer_load_dword v22, v24, s[8:11], s90 offen
mega_kernel_ncp2:
    v_and_b32 v24, 15, v1
    v_lshrrev_b32 v25, 4, v1
    v_bfe_u32 v26, v1, 1, 3
    v_xor_b32 v26, v26, v25
    s_lshl_b32 s90, s57, 14
    v_lshlrev_b32 v27, 7, v24
    v_add_u32 v27, s90, v27
    v_xor_b32 v28, 0, v26
    v_lshl_add_u32 v6, v28, 4, v27
    v_xor_b32 v28, 4, v26
    v_lshl_add_u32 v7, v28, 4, v27
    v_bfe_u32 v26, v1, 2, 2
    v_lshl_add_u32 v27, v25, 3, v26
    v_lshlrev_b32 v27, 9, v27
    v_and_b32 v28, 3, v1
    v_lshlrev_b32 v28, 3, v28
    v_add_u32 v27, v27, v28
    s_lshl_b32 s90, s58, 8
    s_add_u32 s90, s90, 98304
    v_add_u32 v27, s90, v27
    v_bfe_u32 v26, v1, 2, 3
    v_xor_b32 v28, 0, v26
    v_lshl_add_u32 v8, v28, 5, v27
    v_xor_b32 v28, 1, v26
    v_lshl_add_u32 v9, v28, 5, v27
    v_xor_b32 v28, 2, v26
    v_lshl_add_u32 v10, v28, 5, v27
    v_xor_b32 v28, 3, v26
    v_lshl_add_u32 v11, v28, 5, v27
    v_xor_b32 v28, 4, v26
    v_lshl_add_u32 v12, v28, 5, v27
    v_xor_b32 v28, 5, v26
    v_lshl_add_u32 v13, v28, 5, v27
    v_xor_b32 v28, 6, v26
    v_lshl_add_u32 v14, v28, 5, v27
    v_xor_b32 v28, 7, v26
    v_lshl_add_u32 v15, v28, 5, v27
    v_lshlrev_b32 v2, 4, v1
    s_lshl_b32 s61, s16, 13
    s_add_u32 s62, s61, 98304
    s_mov_b32 s64, 0
    s_mov_b32 s59, 32768
    s_mov_b32 s60, 229376
    s_waitcnt lgkmcnt(0)
    s_mov_b32 s8, s6
    s_mov_b32 s9, s7
    s_mov_b32 s10, 268435456
    s_mov_b32 s11, 0x20000
    s_mov_b32 s70, 0
    s_cmp_ge_u32 s68, 16
    s_cbranch_scc1 mega_kernel_typea4
    s_and_b32 s69, s68, 3
    s_and_b32 s90, s2, 1
    s_lshl_b32 s90, s90, 2
    s_add_u32 s69, s69, s90
    s_bfe_u32 s90, s2, 0x20001
    s_mul_i32 s90, s90, 4
    s_bfe_u32 s91, s68, 0x20002
    s_add_u32 s90, s90, s91
    s_mov_b32 s76, 8388608
    s_mov_b32 s78, 8192
    s_mov_b32 s81, 0
    s_mov_b32 s73, 4194304
    s_mov_b32 s77, 2048
    s_mov_b32 s82, 16
    s_lshl_b32 s80, s90, 9
    s_lshl_b32 s79, s69, 19
    s_lshl_b32 s88, s90, 4
    s_add_u32 s88, s88, s69
    s_lshl_b32 s88, s88, 3
    s_mov_b32 s83, 0
    s_mov_b32 s84, 1040356334
    s_lshl_b32 s91, s90, 1
    s_add_u32 s91, s91, s58
    s_lshl_b32 s91, s91, 19
    s_lshl_b32 s92, s69, 1
    s_add_u32 s92, s92, s57
    s_lshl_b32 s92, s92, 15
    s_add_u32 s85, s91, s92
    s_add_u32 s85, s85, 0
    s_mov_b32 s86, 1024
    s_mov_b32 s87, 4096
    s_mov_b32 s71, s30
    s_mov_b32 s72, s31
    s_mov_b32 s74, s34
    s_mov_b32 s75, s35
    s_branch mega_kernel_go15
mega_kernel_typea4:
    s_cmp_lt_u32 s68, 28
    s_cbranch_scc1 mega_kernel_nopf6
    s_mov_b32 s70, 1
    s_sub_u32 s93, s2, 224
    s_lshl_b32 s93, s93, 2
    s_add_u32 s93, s93, s16
    v_lshlrev_b32 v24, 7, v1
    v_lshrrev_b32 v25, 3, v1
    v_lshlrev_b32 v25, 11, v25
    v_and_b32 v26, 7, v1
    v_lshl_add_u32 v25, v26, 7, v25
    s_lshl_b32 s92, s93, 13
    s_lshl_b32 s93, s93, 14
    s_add_u32 s93, s93, 1024
    s_mov_b32 s40, s26
    s_mov_b32 s41, s27
    s_mov_b32 s42, 6291456
    s_add_u32 s90, s92, 0
    buffer_load_dword v22, v24, s[40:43], s90 offen
    s_add_u32 s90, s92, 1048576
    buffer_load_dword v22, v24, s[40:43], s90 offen
    s_mov_b32 s40, s24
    s_mov_b32 s41, s25
    s_mov_b32 s42, 4194304
    s_add_u32 s90, s92, 0
    buffer_load_dword v22, v24, s[40:43], s90 offen
    s_add_u32 s90, s92, 1048576
    buffer_load_dword v22, v24, s[40:43], s90 offen
    s_add_u32 s90, s92, 2097152
    buffer_load_dword v22, v24, s[40:43], s90 offen
    s_add_u32 s90, s92, 3145728
    buffer_load_dword v22, v24, s[40:43], s90 offen
    s_mov_b32 s40, s34
    s_mov_b32 s41, s35
    s_mov_b32 s42, 8388608
    s_add_u32 s90, s92, 4194304
    buffer_load_dword v22, v24, s[40:43], s90 offen
    s_add_u32 s90, s92, 5242880
    buffer_load_dword v22, v24, s[40:43], s90 offen
    s_mov_b32 s40, s30
    s_mov_b32 s41, s31
    s_mov_b32 s42, 4194304
    s_add_u32 s90, s93, 0
    buffer_load_dword v22, v25, s[40:43], s90 offen
    s_add_u32 s90, s93, 2097152
    buffer_load_dword v22, v25, s[40:43], s90 offen
    s_mov_b32 s40, s26
    s_mov_b32 s41, s27
    s_mov_b32 s42, 6291456
    s_add_u32 s90, s92, 2097152
    buffer_load_dword v22, v24, s[40:43], s90 offen
    s_mov_b32 s40, s34
    s_mov_b32 s41, s35
    s_mov_b32 s42, 8388608
    s_add_u32 s90, s92, 6291456
    buffer_load_dword v22, v24, s[40:43], s90 offen
    s_add_u32 s90, s92, 7340032
    buffer_load_dword v22, v24, s[40:43], s90 offen
    s_mov_b32 s40, s26
    s_mov_b32 s41, s27
    s_mov_b32 s42, 6291456
    s_add_u32 s90, s92, 3145728
    buffer_load_dword v22, v24, s[40:43], s90 offen
    s_add_u32 s90, s92, 4194304
    buffer_load_dword v22, v24, s[40:43], s90 offen
    s_add_u32 s90, s92, 5242880
    buffer_load_dword v22, v24, s[40:43], s90 offen
    s_mov_b32 s40, s32
    s_mov_b32 s41, s33
    s_mov_b32 s42, 2097152
    s_add_u32 s90, s92, 1048576
    buffer_load_dword v22, v24, s[40:43], s90 offen
mega_kernel_nopf6:
    s_bfe_u32 s69, s68, 0x20002
    s_add_u32 s69, s69, 0
    s_and_b32 s90, s2, 7
    s_lshl_b32 s90, s90, 2
    s_and_b32 s91, s68, 3
    s_add_u32 s90, s90, s91
    s_cmp_lt_u32 s90, 16
    s_cselect_b32 s83, 0, 1
    s_mov_b32 s91, 33554432
    s_cselect_b32 s85, 16777216, s91
    s_mov_b32 s91, 8192
    s_cselect_b32 s86, 1024, s91
    s_mov_b32 s91, 1024
    s_cselect_b32 s87, 4096, s91
    s_cselect_b32 s74, s36, s38
    s_cselect_b32 s75, s37, s39
    s_mov_b32 s71, s32
    s_mov_b32 s72, s33
    s_mov_b32 s73, 2097152
    s_mov_b32 s77, 1024
    s_mov_b32 s82, 8
    s_mov_b32 s81, 0
    s_mov_b32 s76, 4194304
    s_mov_b32 s78, 8192
    s_mov_b32 s84, 0
    s_and_b32 s90, s90, 15
    s_lshl_b32 s80, s90, 9
    s_lshl_b32 s79, s69, 18
    s_mul_i32 s91, s83, 3
    s_add_u32 s91, s91, s69
    s_add_u32 s91, s91, 8
    s_lshl_b32 s92, s83, 2
    s_add_u32 s92, s92, s69
    s_add_u32 s92, s92, 508
    s_cmp_ge_u32 s69, 4
    s_cselect_b32 s91, s92, s91
    s_add_u32 s92, s83, 256
    s_cmp_eq_u32 s69, 3
    s_cselect_b32 s91, s92, s91
    s_lshl_b32 s88, s90, 4
    s_add_u32 s88, s88, s91
    s_lshl_b32 s88, s88, 3
    s_lshl_b32 s91, s90, 1
    s_add_u32 s91, s91, s58
    s_lshl_b32 s91, s91, 19
    s_lshl_b32 s92, s69, 1
    s_add_u32 s92, s92, s57
    s_lshl_b32 s92, s92, 15
    s_add_u32 s85, s85, s91
    s_add_u32 s85, s85, s92
mega_kernel_go15:
    s_mov_b32 s42, s73
    s_mov_b32 s46, s76
    s_lshl_b32 s90, s77, 4
    s_lshl_b32 s90, s90, s81
    s_mov_b32 s48, s79
    s_mul_i32 s91, s90, 1
    s_add_u32 s49, s91, s79
    s_sub_u32 s49, s49, 2048
    s_mul_i32 s91, s90, 2
    s_add_u32 s50, s91, s79
    s_mul_i32 s91, s90, 3
    s_add_u32 s51, s91, s79
    s_sub_u32 s51, s51, 2048
    s_mov_b32 s52, s80
    s_lshl_b32 s90, s78, 2
    s_mul_i32 s91, s90, 1
    s_add_u32 s53, s91, s80
    s_sub_u32 s53, s53, 2048
    s_mul_i32 s91, s90, 2
    s_add_u32 s54, s91, s80
    s_mul_i32 s91, s90, 3
    s_add_u32 s55, s91, s80
    s_sub_u32 s55, s55, 2048
    s_lshl_b32 s56, s78, 6
    s_lshl_b32 s90, s58, 7
    s_add_u32 s90, s90, s57
    s_lshl_b32 s91, s16, 6
    s_cmp_eq_u32 s81, 1
    s_cselect_b32 s90, s90, s91
    v_lshrrev_b32 v24, 3, v1
    v_lshlrev_b32 v24, s81, v24
    v_add_u32 v24, s90, v24
    v_mul_lo_u32 v24, v24, s77
    v_lshrrev_b32 v25, 4, v1
    v_and_b32 v26, 7, v1
    v_xor_b32 v25, v25, v26
    v_lshl_add_u32 v16, v25, 4, v24
    v_xor_b32 v25, 4, v25
    v_lshl_add_u32 v17, v25, 4, v24
    s_lshl_b32 s90, s77, 3
    s_lshl_b32 s90, s90, s81
    s_sub_u32 s90, s90, 1024
    v_add_u32 v17, s90, v17
    v_lshrrev_b32 v24, 5, v1
    s_lshl_b32 s90, s16, 4
    v_add_u32 v25, s90, v24
    v_mul_lo_u32 v25, v25, s78
    v_lshlrev_b32 v24, 1, v24
    v_and_b32 v26, 31, v1
    v_xor_b32 v24, v24, v26
    s_lshl_b32 s90, s78, 1
    s_sub_u32 s90, s90, 1024
    v_add_u32 v27, s90, v25
    v_xor_b32 v26, 0, v24
    v_lshl_add_u32 v18, v26, 4, v25
    v_xor_b32 v26, 4, v24
    v_lshl_add_u32 v19, v26, 4, v27
    v_xor_b32 v26, 8, v24
    v_lshl_add_u32 v20, v26, 4, v25
    v_xor_b32 v26, 12, v24
    v_lshl_add_u32 v21, v26, 4, v27
    s_mov_b32 s40, s71
    s_mov_b32 s41, s72
    s_mov_b32 s44, s74
    s_mov_b32 s45, s75
    s_mov_b32 s95, s82
    s_mov_b32 s96, s83
    s_mov_b32 s97, s84
    s_mov_b32 s98, s85
    s_mov_b32 s99, s86
    s_mov_b32 s100, s87
    s_mov_b32 s101, s88
    s_add_u32 m0, s61, 0
    s_nop 0
    buffer_load_dwordx4 v16, s[40:43], s48 offen offset:0 lds
    buffer_load_dwordx4 v17, s[40:43], s48 offen offset:1024 lds
    s_add_u32 s48, s48, 128
    buffer_load_dwordx4 v16, s[40:43], s49 offen offset:2048 lds
    buffer_load_dwordx4 v17, s[40:43], s49 offen offset:3072 lds
    s_add_u32 s49, s49, 128
    s_add_u32 m0, s61, 4096
    s_nop 0
    buffer_load_dwordx4 v16, s[40:43], s50 offen offset:0 lds
    buffer_load_dwordx4 v17, s[40:43], s50 offen offset:1024 lds
    s_add_u32 s50, s50, 128
    buffer_load_dwordx4 v16, s[40:43], s51 offen offset:2048 lds
    buffer_load_dwordx4 v17, s[40:43], s51 offen offset:3072 lds
    s_add_u32 s51, s51, 128
    s_add_u32 s61, s61, 32768
    s_cmp_ge_u32 s61, 98304
    s_cselect_b32 s90, 98304, 0
    s_sub_u32 s61, s61, s90
    s_add_u32 m0, s62, 0
    s_nop 0
    buffer_load_dwordx4 v18, s[44:47], s52 offen offset:0 lds
    buffer_load_dwordx4 v19, s[44:47], s52 offen offset:1024 lds
    s_add_u32 s52, s52, s56
    buffer_load_dwordx4 v18, s[44:47], s53 offen offset:2048 lds
    buffer_load_dwordx4 v19, s[44:47], s53 offen offset:3072 lds
    s_add_u32 s53, s53, s56
    s_add_u32 m0, s62, 4096
    s_nop 0
    buffer_load_dwordx4 v20, s[44:47], s54 offen offset:0 lds
    buffer_load_dwordx4 v21, s[44:47], s54 offen offset:1024 lds
    s_add_u32 s54, s54, s56
    buffer_load_dwordx4 v20, s[44:47], s55 offen offset:2048 lds
    buffer_load_dwordx4 v21, s[44:47], s55 offen offset:3072 lds
    s_add_u32 s55, s55, s56
    s_xor_b32 s62, s62, 229376
    s_cmp_ge_u32 s68, 16
    s_cbranch_scc1 mega_kernel_typea7
    s_bfe_u32 s69, s68, 0x20002
    s_add_u32 s69, s69, 4
    s_and_b32 s90, s2, 7
    s_lshl_b32 s90, s90, 2
    s_and_b32 s91, s68, 3
    s_add_u32 s90, s90, s91
    s_cmp_lt_u32 s90, 16
    s_cselect_b32 s83, 0, 1
    s_mov_b32 s91, 33554432
    s_cselect_b32 s85, 16777216, s91
    s_mov_b32 s91, 8192
    s_cselect_b32 s86, 1024, s91
    s_mov_b32 s91, 1024
    s_cselect_b32 s87, 4096, s91
    s_cselect_b32 s74, s36, s38
    s_cselect_b32 s75, s37, s39
    s_mov_b32 s71, s32
    s_mov_b32 s72, s33
    s_mov_b32 s73, 2097152
    s_mov_b32 s77, 1024
    s_mov_b32 s82, 8
    s_mov_b32 s81, 0
    s_mov_b32 s76, 4194304
    s_mov_b32 s78, 8192
    s_mov_b32 s84, 0
    s_and_b32 s90, s90, 15
    s_lshl_b32 s80, s90, 9
    s_lshl_b32 s79, s69, 18
    s_mul_i32 s91, s83, 3
    s_add_u32 s91, s91, s69
    s_add_u32 s91, s91, 8
    s_lshl_b32 s92, s83, 2
    s_add_u32 s92, s92, s69
    s_add_u32 s92, s92, 508
    s_cmp_ge_u32 s69, 4
    s_cselect_b32 s91, s92, s91
    s_add_u32 s92, s83, 256
    s_cmp_eq_u32 s69, 3
    s_cselect_b32 s91, s92, s91
    s_lshl_b32 s88, s90, 4
    s_add_u32 s88, s88, s91
    s_lshl_b32 s88, s88, 3
    s_lshl_b32 s91, s90, 1
    s_add_u32 s91, s91, s58
    s_lshl_b32 s91, s91, 19
    s_lshl_b32 s92, s69, 1
    s_add_u32 s92, s92, s57
    s_lshl_b32 s92, s92, 15
    s_add_u32 s85, s85, s91
    s_add_u32 s85, s85, s92
    s_branch mega_kernel_go28
mega_kernel_typea7:
    s_and_b32 s69, s68, 3
    s_and_b32 s90, s2, 1
    s_lshl_b32 s90, s90, 2
    s_add_u32 s69, s69, s90
    s_bfe_u32 s90, s2, 0x20001
    s_mul_i32 s90, s90, 3
    s_bfe_u32 s91, s68, 0x20002
    s_add_u32 s90, s90, s91
    s_mov_b32 s76, 6291456
    s_mov_b32 s78, 6144
    s_mov_b32 s81, 1
    s_mov_b32 s73, 4194304
    s_mov_b32 s77, 2048
    s_mov_b32 s82, 16
    s_lshl_b32 s80, s90, 9
    s_lshl_b32 s79, s69, 19
    s_and_b32 s92, s90, 3
    s_lshr_b32 s91, s90, 2
    s_lshl_b32 s88, s92, 2
    s_add_u32 s88, s88, s91
    s_lshl_b32 s88, s88, 3
    s_add_u32 s88, s88, s69
    s_lshl_b32 s88, s88, 3
    s_add_u32 s88, s88, 6144
    s_cmp_eq_u32 s91, 0
    s_cselect_b32 s84, 1048744942, 0
    s_lshl_b32 s93, s91, 22
    s_add_u32 s85, s93, 50331648
    s_lshl_b32 s92, s92, 1
    s_add_u32 s92, s92, s58
    s_lshl_b32 s92, s92, 19
    s_add_u32 s85, s85, s92
    s_lshl_b32 s92, s57, 3
    s_add_u32 s92, s92, s69
    s_cmp_eq_u32 s91, 2
    s_cselect_b32 s83, 1, 0
    s_cselect_b32 s93, 12, 13
    s_mov_b32 s91, 131072
    s_cselect_b32 s86, 1024, s91
    s_mov_b32 s91, 1024
    s_cselect_b32 s87, 65536, s91
    s_lshl_b32 s92, s92, s93
    s_add_u32 s85, s85, s92
    s_mov_b32 s71, s24
    s_mov_b32 s72, s25
    s_mov_b32 s74, s26
    s_mov_b32 s75, s27
mega_kernel_go28:
    s_xor_b32 s94, s70, 1
    s_mov_b32 s67, 2
    s_mov_b32 s17, -1
    s_mov_b32 s12, s4
    s_mov_b32 s13, s5
    s_mov_b32 s14, 256
    s_mov_b32 s15, 0x20000
    s_lshl_b32 s90, s2, 2
    s_add_u32 s90, s90, s16
    s_cmp_lg_u32 s90, 0
    s_cbranch_scc1 mega_kernel_tok9
    s_memrealtime s[92:93]
    s_waitcnt lgkmcnt(0)
    s_or_b32 s92, s92, 1
    v_mov_b32 v4, s92
    v_mov_b32 v5, s93
    s_mov_b64 exec, 1
    buffer_store_dwordx2 v[4:5], off, s[12:15], 0 sc1
    s_mov_b64 exec, -1
mega_kernel_tok9:
    s_add_u32 m0, s61, 0
    s_nop 0
    buffer_load_dwordx4 v16, s[40:43], s48 offen offset:0 lds
    buffer_load_dwordx4 v17, s[40:43], s48 offen offset:1024 lds
    s_add_u32 s48, s48, 128
    buffer_load_dwordx4 v16, s[40:43], s49 offen offset:2048 lds
    buffer_load_dwordx4 v17, s[40:43], s49 offen offset:3072 lds
    s_add_u32 s49, s49, 128
    s_add_u32 m0, s61, 4096
    s_nop 0
    buffer_load_dwordx4 v16, s[40:43], s50 offen offset:0 lds
    buffer_load_dwordx4 v17, s[40:43], s50 offen offset:1024 lds
    s_add_u32 s50, s50, 128
    buffer_load_dwordx4 v16, s[40:43], s51 offen offset:2048 lds
    buffer_load_dwordx4 v17, s[40:43], s51 offen offset:3072 lds
    s_add_u32 s51, s51, 128
    s_add_u32 s61, s61, 32768
    s_cmp_ge_u32 s61, 98304
    s_cselect_b32 s90, 98304, 0
    s_sub_u32 s61, s61, s90
    s_add_u32 m0, s62, 0
    s_nop 0
    buffer_load_dwordx4 v18, s[44:47], s52 offen offset:0 lds
    buffer_load_dwordx4 v19, s[44:47], s52 offen offset:1024 lds
    s_add_u32 s52, s52, s56
    buffer_load_dwordx4 v18, s[44:47], s53 offen offset:2048 lds
    buffer_load_dwordx4 v19, s[44:47], s53 offen offset:3072 lds
    s_add_u32 s53, s53, s56
    s_add_u32 m0, s62, 4096
    s_nop 0
    buffer_load_dwordx4 v20, s[44:47], s54 offen offset:0 lds
    buffer_load_dwordx4 v21, s[44:47], s54 offen offset:1024 lds
    s_add_u32 s54, s54, s56
    buffer_load_dwordx4 v20, s[44:47], s55 offen offset:2048 lds
    buffer_load_dwordx4 v21, s[44:47], s55 offen offset:3072 lds
    s_add_u32 s55, s55, s56
    s_xor_b32 s62, s62, 229376
    s_waitcnt vmcnt(16)
    s_barrier
    ds_read_b64_tr_b16 a[64:65], v8 offset:0
    ds_read_b64_tr_b16 a[66:67], v8 offset:2048
    ds_read_b128 a[0:3], v6 offset:0
    ds_read_b128 a[4:7], v6 offset:2048
    ds_read_b64_tr_b16 a[68:69], v9 offset:0
    ds_read_b64_tr_b16 a[70:71], v9 offset:2048
    ds_read_b128 a[8:11], v6 offset:4096
    ds_read_b128 a[12:15], v6 offset:6144
    ds_read_b64_tr_b16 a[72:73], v10 offset:0
    ds_read_b64_tr_b16 a[74:75], v10 offset:2048
    ds_read_b128 a[16:19], v6 offset:8192
    ds_read_b128 a[20:23], v6 offset:10240
    ds_read_b64_tr_b16 a[76:77], v11 offset:0
    ds_read_b64_tr_b16 a[78:79], v11 offset:2048
    ds_read_b128 a[24:27], v6 offset:12288
    ds_read_b128 a[28:31], v6 offset:14336
    ds_read_b64_tr_b16 a[80:81], v12 offset:0
    ds_read_b64_tr_b16 a[82:83], v12 offset:2048
    ds_read_b64_tr_b16 a[84:85], v13 offset:0
    ds_read_b64_tr_b16 a[86:87], v13 offset:2048
    ds_read_b64_tr_b16 a[88:89], v14 offset:0
    ds_read_b64_tr_b16 a[90:91], v14 offset:2048
    ds_read_b64_tr_b16 a[92:93], v15 offset:0
    ds_read_b64_tr_b16 a[94:95], v15 offset:2048
    s_mov_b32 s66, 1
mega_kernel_tile10:
    s_sub_u32 s65, s95, 1
    s_cmp_eq_u32 s96, 1
    s_cbranch_scc1 mega_kernel_swp12
    s_waitcnt lgkmcnt(15)
    v_mfma_f32_16x16x32_bf16 v[32:35], a[64:67], a[0:3], 0
    v_mfma_f32_16x16x32_bf16 v[40:43], a[64:67], a[4:7], 0
    v_mfma_f32_16x16x32_bf16 v[48:51], a[64:67], a[8:11], 0
    v_mfma_f32_16x16x32_bf16 v[56:59], a[64:67], a[12:15], 0
    s_waitcnt lgkmcnt(13)
    v_mfma_f32_16x16x32_bf16 v[64:67], a[64:67], a[16:19], 0
    s_add_u32 m0, s61, 0
    s_nop 0
    buffer_load_dwordx4 v16, s[40:43], s48 offen offset:0 lds
    s_waitcnt lgkmcnt(12)
    v_mfma_f32_16x16x32_bf16 v[72:75], a[64:67], a[20:23], 0
    s_waitcnt lgkmcnt(9)
    v_mfma_f32_16x16x32_bf16 v[80:83], a[64:67], a[24:27], 0
    s_waitcnt lgkmcnt(8)
    v_mfma_f32_16x16x32_bf16 v[88:91], a[64:67], a[28:31], 0
    ds_read_b64_tr_b16 a[64:65], v8 offset:16384
    v_mfma_f32_16x16x32_bf16 v[36:39], a[68:71], a[0:3], 0
    ds_read_b64_tr_b16 a[66:67], v8 offset:18432
    v_mfma_f32_16x16x32_bf16 v[44:47], a[68:71], a[4:7], 0
    v_mfma_f32_16x16x32_bf16 v[52:55], a[68:71], a[8:11], 0
    ds_read_b128 a[32:35], v7 offset:0
    v_mfma_f32_16x16x32_bf16 v[60:63], a[68:71], a[12:15], 0
    buffer_load_dwordx4 v17, s[40:43], s48 offen offset:1024 lds
    s_add_u32 s48, s48, 128
    v_mfma_f32_16x16x32_bf16 v[68:71], a[68:71], a[16:19], 0
    v_mfma_f32_16x16x32_bf16 v[76:79], a[68:71], a[20:23], 0
    v_mfma_f32_16x16x32_bf16 v[84:87], a[68:71], a[24:27], 0
    ds_read_b128 a[36:39], v7 offset:2048
    v_mfma_f32_16x16x32_bf16 v[92:95], a[68:71], a[28:31], 0
    ds_read_b64_tr_b16 a[68:69], v9 offset:16384
    v_mfma_f32_16x16x32_bf16 v[96:99], a[72:75], a[0:3], 0
    ds_read_b64_tr_b16 a[70:71], v9 offset:18432
    v_mfma_f32_16x16x32_bf16 v[104:107], a[72:75], a[4:7], 0
    buffer_load_dwordx4 v16, s[40:43], s49 offen offset:2048 lds
    v_mfma_f32_16x16x32_bf16 v[112:115], a[72:75], a[8:11], 0
    ds_read_b128 a[40:43], v7 offset:4096
    v_mfma_f32_16x16x32_bf16 v[120:123], a[72:75], a[12:15], 0
    v_mfma_f32_16x16x32_bf16 v[128:131], a[72:75], a[16:19], 0
    v_mfma_f32_16x16x32_bf16 v[136:139], a[72:75], a[20:23], 0
    v_mfma_f32_16x16x32_bf16 v[144:147], a[72:75], a[24:27], 0
    ds_read_b128 a[44:47], v7 offset:6144
    v_mfma_f32_16x16x32_bf16 v[152:155], a[72:75], a[28:31], 0
    ds_read_b64_tr_b16 a[72:73], v10 offset:16384
    buffer_load_dwordx4 v17, s[40:43], s49 offen offset:3072 lds
    s_add_u32 s49, s49, 128
    v_mfma_f32_16x16x32_bf16 v[100:103], a[76:79], a[0:3], 0
    ds_read_b64_tr_b16 a[74:75], v10 offset:18432
    v_mfma_f32_16x16x32_bf16 v[108:111], a[76:79], a[4:7], 0
    v_mfma_f32_16x16x32_bf16 v[116:119], a[76:79], a[8:11], 0
    ds_read_b128 a[48:51], v7 offset:8192
    v_mfma_f32_16x16x32_bf16 v[124:127], a[76:79], a[12:15], 0
    v_mfma_f32_16x16x32_bf16 v[132:135], a[76:79], a[16:19], 0
    s_add_u32 m0, s61, 4096
    s_nop 0
    buffer_load_dwordx4 v16, s[40:43], s50 offen offset:0 lds
    v_mfma_f32_16x16x32_bf16 v[140:143], a[76:79], a[20:23], 0
    v_mfma_f32_16x16x32_bf16 v[148:151], a[76:79], a[24:27], 0
    ds_read_b128 a[52:55], v7 offset:10240
    v_mfma_f32_16x16x32_bf16 v[156:159], a[76:79], a[28:31], 0
    ds_read_b64_tr_b16 a[76:77], v11 offset:16384
    s_waitcnt lgkmcnt(15)
    v_mfma_f32_16x16x32_bf16 v[160:163], a[80:83], a[0:3], 0
    ds_read_b64_tr_b16 a[78:79], v11 offset:18432
    v_mfma_f32_16x16x32_bf16 v[168:171], a[80:83], a[4:7], 0
    v_mfma_f32_16x16x32_bf16 v[176:179], a[80:83], a[8:11], 0
    ds_read_b128 a[56:59], v7 offset:12288
    v_mfma_f32_16x16x32_bf16 v[184:187], a[80:83], a[12:15], 0
    buffer_load_dwordx4 v17, s[40:43], s50 offen offset:1024 lds
    s_add_u32 s50, s50, 128
    v_mfma_f32_16x16x32_bf16 v[192:195], a[80:83], a[16:19], 0
    v_mfma_f32_16x16x32_bf16 v[200:203], a[80:83], a[20:23], 0
    v_mfma_f32_16x16x32_bf16 v[208:211], a[80:83], a[24:27], 0
    ds_read_b128 a[60:63], v7 offset:14336
    v_mfma_f32_16x16x32_bf16 v[216:219], a[80:83], a[28:31], 0
    ds_read_b64_tr_b16 a[80:81], v12 offset:16384
    v_mfma_f32_16x16x32_bf16 v[164:167], a[84:87], a[0:3], 0
    ds_read_b64_tr_b16 a[82:83], v12 offset:18432
    v_mfma_f32_16x16x32_bf16 v[172:175], a[84:87], a[4:7], 0
    buffer_load_dwordx4 v16, s[40:43], s51 offen offset:2048 lds
    v_mfma_f32_16x16x32_bf16 v[180:183], a[84:87], a[8:11], 0
    v_mfma_f32_16x16x32_bf16 v[188:191], a[84:87], a[12:15], 0
    v_mfma_f32_16x16x32_bf16 v[196:199], a[84:87], a[16:19], 0
    v_mfma_f32_16x16x32_bf16 v[204:207], a[84:87], a[20:23], 0
    v_mfma_f32_16x16x32_bf16 v[212:215], a[84:87], a[24:27], 0
    buffer_load_dwordx4 v17, s[40:43], s51 offen offset:3072 lds
    s_add_u32 s51, s51, 128
    v_mfma_f32_16x16x32_bf16 v[220:223], a[84:87], a[28:31], 0
    ds_read_b64_tr_b16 a[84:85], v13 offset:16384
    v_mfma_f32_16x16x32_bf16 v[224:227], a[88:91], a[0:3], 0
    ds_read_b64_tr_b16 a[86:87], v13 offset:18432
    v_mfma_f32_16x16x32_bf16 v[232:235], a[88:91], a[4:7], 0
    v_mfma_f32_16x16x32_bf16 v[240:243], a[88:91], a[8:11], 0
    v_mfma_f32_16x16x32_bf16 v[248:251], a[88:91], a[12:15], 0
    v_mfma_f32_16x16x32_bf16 a[96:99], a[88:91], a[16:19], 0
    v_mfma_f32_16x16x32_bf16 a[104:107], a[88:91], a[20:23], 0
    s_add_u32 s61, s61, 32768
    s_cmp_ge_u32 s61, 98304
    s_cselect_b32 s90, 98304, 0
    s_sub_u32 s61, s61, s90
    v_mfma_f32_16x16x32_bf16 a[112:115], a[88:91], a[24:27], 0
    v_mfma_f32_16x16x32_bf16 a[120:123], a[88:91], a[28:31], 0
    ds_read_b64_tr_b16 a[88:89], v14 offset:16384
    s_waitcnt lgkmcnt(15)
    v_mfma_f32_16x16x32_bf16 v[228:231], a[92:95], a[0:3], 0
    ds_read_b64_tr_b16 a[90:91], v14 offset:18432
    v_mfma_f32_16x16x32_bf16 v[236:239], a[92:95], a[4:7], 0
    s_add_u32 s64, s64, 32768
    s_cmp_ge_u32 s64, 98304
    s_cselect_b32 s63, 4294901760, s59
    s_cselect_b32 s64, 0, s64
    v_mfma_f32_16x16x32_bf16 v[244:247], a[92:95], a[8:11], 0
    v_add_u32 v6, s63, v6
    v_mfma_f32_16x16x32_bf16 v[252:255], a[92:95], a[12:15], 0
    v_add_u32 v7, s63, v7
    v_mfma_f32_16x16x32_bf16 a[100:103], a[92:95], a[16:19], 0
    v_mfma_f32_16x16x32_bf16 a[108:111], a[92:95], a[20:23], 0
    v_mfma_f32_16x16x32_bf16 a[116:119], a[92:95], a[24:27], 0
    v_mfma_f32_16x16x32_bf16 a[124:127], a[92:95], a[28:31], 0
    ds_read_b64_tr_b16 a[92:93], v15 offset:16384
    ds_read_b64_tr_b16 a[94:95], v15 offset:18432
    v_mfma_f32_16x16x32_bf16 v[32:35], a[64:67], a[32:35], v[32:35]
    v_xor_b32 v8, s60, v8
    v_mfma_f32_16x16x32_bf16 v[40:43], a[64:67], a[36:39], v[40:43]
    v_xor_b32 v9, s60, v9
    s_waitcnt lgkmcnt(15)
    v_mfma_f32_16x16x32_bf16 v[48:51], a[64:67], a[40:43], v[48:51]
    v_xor_b32 v10, s60, v10
    v_mfma_f32_16x16x32_bf16 v[56:59], a[64:67], a[44:47], v[56:59]
    v_xor_b32 v11, s60, v11
    s_waitcnt lgkmcnt(13)
    v_mfma_f32_16x16x32_bf16 v[64:67], a[64:67], a[48:51], v[64:67]
    v_xor_b32 v12, s60, v12
    s_waitcnt lgkmcnt(12)
    v_mfma_f32_16x16x32_bf16 v[72:75], a[64:67], a[52:55], v[72:75]
    v_xor_b32 v13, s60, v13
    s_waitcnt lgkmcnt(9)
    v_mfma_f32_16x16x32_bf16 v[80:83], a[64:67], a[56:59], v[80:83]
    v_xor_b32 v14, s60, v14
    v_xor_b32 v15, s60, v15
    s_waitcnt lgkmcnt(8)
    s_waitcnt lgkmcnt(0)
    s_waitcnt vmcnt(40)
    s_cmp_eq_u32 s66, 0
    s_cbranch_scc1 mega_kernel_w13
    s_waitcnt vmcnt(8)
mega_kernel_w13:
    v_mfma_f32_16x16x32_bf16 v[88:91], a[64:67], a[60:63], v[88:91]
    s_barrier
    ds_read_b64_tr_b16 a[64:65], v8 offset:0
    v_mfma_f32_16x16x32_bf16 v[36:39], a[68:71], a[32:35], v[36:39]
    ds_read_b64_tr_b16 a[66:67], v8 offset:2048
    v_mfma_f32_16x16x32_bf16 v[44:47], a[68:71], a[36:39], v[44:47]
    s_add_u32 m0, s62, 0
    s_nop 0
    buffer_load_dwordx4 v18, s[44:47], s52 offen offset:0 lds
    v_mfma_f32_16x16x32_bf16 v[52:55], a[68:71], a[40:43], v[52:55]
    ds_read_b128 a[0:3], v6 offset:0
    v_mfma_f32_16x16x32_bf16 v[60:63], a[68:71], a[44:47], v[60:63]
    v_mfma_f32_16x16x32_bf16 v[68:71], a[68:71], a[48:51], v[68:71]
    v_mfma_f32_16x16x32_bf16 v[76:79], a[68:71], a[52:55], v[76:79]
    buffer_load_dwordx4 v19, s[44:47], s52 offen offset:1024 lds
    s_add_u32 s52, s52, s56
    v_mfma_f32_16x16x32_bf16 v[84:87], a[68:71], a[56:59], v[84:87]
    ds_read_b128 a[4:7], v6 offset:2048
    v_mfma_f32_16x16x32_bf16 v[92:95], a[68:71], a[60:63], v[92:95]
    ds_read_b64_tr_b16 a[68:69], v9 offset:0
    v_mfma_f32_16x16x32_bf16 v[96:99], a[72:75], a[32:35], v[96:99]
    ds_read_b64_tr_b16 a[70:71], v9 offset:2048
    v_mfma_f32_16x16x32_bf16 v[104:107], a[72:75], a[36:39], v[104:107]
    buffer_load_dwordx4 v18, s[44:47], s53 offen offset:2048 lds
    v_mfma_f32_16x16x32_bf16 v[112:115], a[72:75], a[40:43], v[112:115]
    ds_read_b128 a[8:11], v6 offset:4096
    v_mfma_f32_16x16x32_bf16 v[120:123], a[72:75], a[44:47], v[120:123]
    v_mfma_f32_16x16x32_bf16 v[128:131], a[72:75], a[48:51], v[128:131]
    v_mfma_f32_16x16x32_bf16 v[136:139], a[72:75], a[52:55], v[136:139]
    buffer_load_dwordx4 v19, s[44:47], s53 offen offset:3072 lds
    s_add_u32 s53, s53, s56
    v_mfma_f32_16x16x32_bf16 v[144:147], a[72:75], a[56:59], v[144:147]
    ds_read_b128 a[12:15], v6 offset:6144
    v_mfma_f32_16x16x32_bf16 v[152:155], a[72:75], a[60:63], v[152:155]
    ds_read_b64_tr_b16 a[72:73], v10 offset:0
    v_mfma_f32_16x16x32_bf16 v[100:103], a[76:79], a[32:35], v[100:103]
    ds_read_b64_tr_b16 a[74:75], v10 offset:2048
    v_mfma_f32_16x16x32_bf16 v[108:111], a[76:79], a[36:39], v[108:111]
    s_add_u32 m0, s62, 4096
    s_nop 0
    buffer_load_dwordx4 v20, s[44:47], s54 offen offset:0 lds
    v_mfma_f32_16x16x32_bf16 v[116:119], a[76:79], a[40:43], v[116:119]
    ds_read_b128 a[16:19], v6 offset:8192
    v_mfma_f32_16x16x32_bf16 v[124:127], a[76:79], a[44:47], v[124:127]
    v_mfma_f32_16x16x32_bf16 v[132:135], a[76:79], a[48:51], v[132:135]
    v_mfma_f32_16x16x32_bf16 v[140:143], a[76:79], a[52:55], v[140:143]
    buffer_load_dwordx4 v21, s[44:47], s54 offen offset:1024 lds
    s_add_u32 s54, s54, s56
    v_mfma_f32_16x16x32_bf16 v[148:151], a[76:79], a[56:59], v[148:151]
    ds_read_b128 a[20:23], v6 offset:10240
    v_mfma_f32_16x16x32_bf16 v[156:159], a[76:79], a[60:63], v[156:159]
    ds_read_b64_tr_b16 a[76:77], v11 offset:0
    v_mfma_f32_16x16x32_bf16 v[160:163], a[80:83], a[32:35], v[160:163]
    ds_read_b64_tr_b16 a[78:79], v11 offset:2048
    v_mfma_f32_16x16x32_bf16 v[168:171], a[80:83], a[36:39], v[168:171]
    buffer_load_dwordx4 v20, s[44:47], s55 offen offset:2048 lds
    v_mfma_f32_16x16x32_bf16 v[176:179], a[80:83], a[40:43], v[176:179]
    ds_read_b128 a[24:27], v6 offset:12288
    v_mfma_f32_16x16x32_bf16 v[184:187], a[80:83], a[44:47], v[184:187]
    v_mfma_f32_16x16x32_bf16 v[192:195], a[80:83], a[48:51], v[192:195]
    v_mfma_f32_16x16x32_bf16 v[200:203], a[80:83], a[52:55], v[200:203]
    buffer_load_dwordx4 v21, s[44:47], s55 offen offset:3072 lds
    s_add_u32 s55, s55, s56
    v_mfma_f32_16x16x32_bf16 v[208:211], a[80:83], a[56:59], v[208:211]
    ds_read_b128 a[28:31], v6 offset:14336
    v_mfma_f32_16x16x32_bf16 v[216:219], a[80:83], a[60:63], v[216:219]
    ds_read_b64_tr_b16 a[80:81], v12 offset:0
    v_mfma_f32_16x16x32_bf16 v[164:167], a[84:87], a[32:35], v[164:167]
    ds_read_b64_tr_b16 a[82:83], v12 offset:2048
    v_mfma_f32_16x16x32_bf16 v[172:175], a[84:87], a[36:39], v[172:175]
    v_mfma_f32_16x16x32_bf16 v[180:183], a[84:87], a[40:43], v[180:183]
    v_mfma_f32_16x16x32_bf16 v[188:191], a[84:87], a[44:47], v[188:191]
    v_mfma_f32_16x16x32_bf16 v[196:199], a[84:87], a[48:51], v[196:199]
    s_xor_b32 s62, s62, 229376
    v_mfma_f32_16x16x32_bf16 v[204:207], a[84:87], a[52:55], v[204:207]
    v_mfma_f32_16x16x32_bf16 v[212:215], a[84:87], a[56:59], v[212:215]
    v_mfma_f32_16x16x32_bf16 v[220:223], a[84:87], a[60:63], v[220:223]
    ds_read_b64_tr_b16 a[84:85], v13 offset:0
    v_mfma_f32_16x16x32_bf16 v[224:227], a[88:91], a[32:35], v[224:227]
    ds_read_b64_tr_b16 a[86:87], v13 offset:2048
    v_mfma_f32_16x16x32_bf16 v[232:235], a[88:91], a[36:39], v[232:235]
    v_mfma_f32_16x16x32_bf16 v[240:243], a[88:91], a[40:43], v[240:243]
    v_mfma_f32_16x16x32_bf16 v[248:251], a[88:91], a[44:47], v[248:251]
    v_mfma_f32_16x16x32_bf16 a[96:99], a[88:91], a[48:51], a[96:99]
    v_mfma_f32_16x16x32_bf16 a[104:107], a[88:91], a[52:55], a[104:107]
    v_mfma_f32_16x16x32_bf16 a[112:115], a[88:91], a[56:59], a[112:115]
    v_mfma_f32_16x16x32_bf16 a[120:123], a[88:91], a[60:63], a[120:123]
    ds_read_b64_tr_b16 a[88:89], v14 offset:0
    v_mfma_f32_16x16x32_bf16 v[228:231], a[92:95], a[32:35], v[228:231]
    ds_read_b64_tr_b16 a[90:91], v14 offset:2048
    v_mfma_f32_16x16x32_bf16 v[236:239], a[92:95], a[36:39], v[236:239]
    v_mfma_f32_16x16x32_bf16 v[244:247], a[92:95], a[40:43], v[244:247]
    v_mfma_f32_16x16x32_bf16 v[252:255], a[92:95], a[44:47], v[252:255]
    v_mfma_f32_16x16x32_bf16 a[100:103], a[92:95], a[48:51], a[100:103]
    v_mfma_f32_16x16x32_bf16 a[108:111], a[92:95], a[52:55], a[108:111]
    v_mfma_f32_16x16x32_bf16 a[116:119], a[92:95], a[56:59], a[116:119]
    v_mfma_f32_16x16x32_bf16 a[124:127], a[92:95], a[60:63], a[124:127]
    ds_read_b64_tr_b16 a[92:93], v15 offset:0
    ds_read_b64_tr_b16 a[94:95], v15 offset:2048
mega_kernel_loop14:
    s_cmp_le_u32 s65, s67
    s_cbranch_scc1 mega_kernel_dosw16
mega_kernel_nosw15:
    s_waitcnt lgkmcnt(15)
    v_mfma_f32_16x16x32_bf16 v[32:35], a[64:67], a[0:3], v[32:35]
    v_mfma_f32_16x16x32_bf16 v[40:43], a[64:67], a[4:7], v[40:43]
    v_mfma_f32_16x16x32_bf16 v[48:51], a[64:67], a[8:11], v[48:51]
    v_mfma_f32_16x16x32_bf16 v[56:59], a[64:67], a[12:15], v[56:59]
    s_waitcnt lgkmcnt(13)
    v_mfma_f32_16x16x32_bf16 v[64:67], a[64:67], a[16:19], v[64:67]
    s_add_u32 m0, s61, 0
    s_nop 0
    buffer_load_dwordx4 v16, s[40:43], s48 offen offset:0 lds
    s_waitcnt lgkmcnt(12)
    v_mfma_f32_16x16x32_bf16 v[72:75], a[64:67], a[20:23], v[72:75]
    s_waitcnt lgkmcnt(9)
    v_mfma_f32_16x16x32_bf16 v[80:83], a[64:67], a[24:27], v[80:83]
    s_waitcnt lgkmcnt(8)
    v_mfma_f32_16x16x32_bf16 v[88:91], a[64:67], a[28:31], v[88:91]
    ds_read_b64_tr_b16 a[64:65], v8 offset:16384
    v_mfma_f32_16x16x32_bf16 v[36:39], a[68:71], a[0:3], v[36:39]
    ds_read_b64_tr_b16 a[66:67], v8 offset:18432
    v_mfma_f32_16x16x32_bf16 v[44:47], a[68:71], a[4:7], v[44:47]
    v_mfma_f32_16x16x32_bf16 v[52:55], a[68:71], a[8:11], v[52:55]
    ds_read_b128 a[32:35], v7 offset:0
    v_mfma_f32_16x16x32_bf16 v[60:63], a[68:71], a[12:15], v[60:63]
    buffer_load_dwordx4 v17, s[40:43], s48 offen offset:1024 lds
    s_add_u32 s48, s48, 128
    v_mfma_f32_16x16x32_bf16 v[68:71], a[68:71], a[16:19], v[68:71]
    v_mfma_f32_16x16x32_bf16 v[76:79], a[68:71], a[20:23], v[76:79]
    v_mfma_f32_16x16x32_bf16 v[84:87], a[68:71], a[24:27], v[84:87]
    ds_read_b128 a[36:39], v7 offset:2048
    v_mfma_f32_16x16x32_bf16 v[92:95], a[68:71], a[28:31], v[92:95]
    ds_read_b64_tr_b16 a[68:69], v9 offset:16384
    v_mfma_f32_16x16x32_bf16 v[96:99], a[72:75], a[0:3], v[96:99]
    ds_read_b64_tr_b16 a[70:71], v9 offset:18432
    v_mfma_f32_16x16x32_bf16 v[104:107], a[72:75], a[4:7], v[104:107]
    buffer_load_dwordx4 v16, s[40:43], s49 offen offset:2048 lds
    v_mfma_f32_16x16x32_bf16 v[112:115], a[72:75], a[8:11], v[112:115]
    ds_read_b128 a[40:43], v7 offset:4096
    v_mfma_f32_16x16x32_bf16 v[120:123], a[72:75], a[12:15], v[120:123]
    v_mfma_f32_16x16x32_bf16 v[128:131], a[72:75], a[16:19], v[128:131]
    v_mfma_f32_16x16x32_bf16 v[136:139], a[72:75], a[20:23], v[136:139]
    v_mfma_f32_16x16x32_bf16 v[144:147], a[72:75], a[24:27], v[144:147]
    ds_read_b128 a[44:47], v7 offset:6144
    v_mfma_f32_16x16x32_bf16 v[152:155], a[72:75], a[28:31], v[152:155]
    ds_read_b64_tr_b16 a[72:73], v10 offset:16384
    buffer_load_dwordx4 v17, s[40:43], s49 offen offset:3072 lds
    s_add_u32 s49, s49, 128
    v_mfma_f32_16x16x32_bf16 v[100:103], a[76:79], a[0:3], v[100:103]
    ds_read_b64_tr_b16 a[74:75], v10 offset:18432
    v_mfma_f32_16x16x32_bf16 v[108:111], a[76:79], a[4:7], v[108:111]
    v_mfma_f32_16x16x32_bf16 v[116:119], a[76:79], a[8:11], v[116:119]
    ds_read_b128 a[48:51], v7 offset:8192
    v_mfma_f32_16x16x32_bf16 v[124:127], a[76:79], a[12:15], v[124:127]
    v_mfma_f32_16x16x32_bf16 v[132:135], a[76:79], a[16:19], v[132:135]
    s_add_u32 m0, s61, 4096
    s_nop 0
    buffer_load_dwordx4 v16, s[40:43], s50 offen offset:0 lds
    v_mfma_f32_16x16x32_bf16 v[140:143], a[76:79], a[20:23], v[140:143]
    v_mfma_f32_16x16x32_bf16 v[148:151], a[76:79], a[24:27], v[148:151]
    ds_read_b128 a[52:55], v7 offset:10240
    v_mfma_f32_16x16x32_bf16 v[156:159], a[76:79], a[28:31], v[156:159]
    ds_read_b64_tr_b16 a[76:77], v11 offset:16384
    s_waitcnt lgkmcnt(15)
    v_mfma_f32_16x16x32_bf16 v[160:163], a[80:83], a[0:3], v[160:163]
    ds_read_b64_tr_b16 a[78:79], v11 offset:18432
    v_mfma_f32_16x16x32_bf16 v[168:171], a[80:83], a[4:7], v[168:171]
    v_mfma_f32_16x16x32_bf16 v[176:179], a[80:83], a[8:11], v[176:179]
    ds_read_b128 a[56:59], v7 offset:12288
    v_mfma_f32_16x16x32_bf16 v[184:187], a[80:83], a[12:15], v[184:187]
    buffer_load_dwordx4 v17, s[40:43], s50 offen offset:1024 lds
    s_add_u32 s50, s50, 128
    v_mfma_f32_16x16x32_bf16 v[192:195], a[80:83], a[16:19], v[192:195]
    v_mfma_f32_16x16x32_bf16 v[200:203], a[80:83], a[20:23], v[200:203]
    v_mfma_f32_16x16x32_bf16 v[208:211], a[80:83], a[24:27], v[208:211]
    ds_read_b128 a[60:63], v7 offset:14336
    v_mfma_f32_16x16x32_bf16 v[216:219], a[80:83], a[28:31], v[216:219]
    ds_read_b64_tr_b16 a[80:81], v12 offset:16384
    v_mfma_f32_16x16x32_bf16 v[164:167], a[84:87], a[0:3], v[164:167]
    ds_read_b64_tr_b16 a[82:83], v12 offset:18432
    v_mfma_f32_16x16x32_bf16 v[172:175], a[84:87], a[4:7], v[172:175]
    buffer_load_dwordx4 v16, s[40:43], s51 offen offset:2048 lds
    v_mfma_f32_16x16x32_bf16 v[180:183], a[84:87], a[8:11], v[180:183]
    v_mfma_f32_16x16x32_bf16 v[188:191], a[84:87], a[12:15], v[188:191]
    v_mfma_f32_16x16x32_bf16 v[196:199], a[84:87], a[16:19], v[196:199]
    v_mfma_f32_16x16x32_bf16 v[204:207], a[84:87], a[20:23], v[204:207]
    v_mfma_f32_16x16x32_bf16 v[212:215], a[84:87], a[24:27], v[212:215]
    buffer_load_dwordx4 v17, s[40:43], s51 offen offset:3072 lds
    s_add_u32 s51, s51, 128
    v_mfma_f32_16x16x32_bf16 v[220:223], a[84:87], a[28:31], v[220:223]
    ds_read_b64_tr_b16 a[84:85], v13 offset:16384
    v_mfma_f32_16x16x32_bf16 v[224:227], a[88:91], a[0:3], v[224:227]
    ds_read_b64_tr_b16 a[86:87], v13 offset:18432
    v_mfma_f32_16x16x32_bf16 v[232:235], a[88:91], a[4:7], v[232:235]
    v_mfma_f32_16x16x32_bf16 v[240:243], a[88:91], a[8:11], v[240:243]
    v_mfma_f32_16x16x32_bf16 v[248:251], a[88:91], a[12:15], v[248:251]
    v_mfma_f32_16x16x32_bf16 a[96:99], a[88:91], a[16:19], a[96:99]
    v_mfma_f32_16x16x32_bf16 a[104:107], a[88:91], a[20:23], a[104:107]
    s_add_u32 s61, s61, 32768
    s_cmp_ge_u32 s61, 98304
    s_cselect_b32 s90, 98304, 0
    s_sub_u32 s61, s61, s90
    v_mfma_f32_16x16x32_bf16 a[112:115], a[88:91], a[24:27], a[112:115]
    v_mfma_f32_16x16x32_bf16 a[120:123], a[88:91], a[28:31], a[120:123]
    ds_read_b64_tr_b16 a[88:89], v14 offset:16384
    s_waitcnt lgkmcnt(15)
    v_mfma_f32_16x16x32_bf16 v[228:231], a[92:95], a[0:3], v[228:231]
    ds_read_b64_tr_b16 a[90:91], v14 offset:18432
    v_mfma_f32_16x16x32_bf16 v[236:239], a[92:95], a[4:7], v[236:239]
    s_add_u32 s64, s64, 32768
    s_cmp_ge_u32 s64, 98304
    s_cselect_b32 s63, 4294901760, s59
    s_cselect_b32 s64, 0, s64
    v_mfma_f32_16x16x32_bf16 v[244:247], a[92:95], a[8:11], v[244:247]
    v_add_u32 v6, s63, v6
    v_mfma_f32_16x16x32_bf16 v[252:255], a[92:95], a[12:15], v[252:255]
    v_add_u32 v7, s63, v7
    v_mfma_f32_16x16x32_bf16 a[100:103], a[92:95], a[16:19], a[100:103]
    v_mfma_f32_16x16x32_bf16 a[108:111], a[92:95], a[20:23], a[108:111]
    v_mfma_f32_16x16x32_bf16 a[116:119], a[92:95], a[24:27], a[116:119]
    v_mfma_f32_16x16x32_bf16 a[124:127], a[92:95], a[28:31], a[124:127]
    ds_read_b64_tr_b16 a[92:93], v15 offset:16384
    ds_read_b64_tr_b16 a[94:95], v15 offset:18432
    v_mfma_f32_16x16x32_bf16 v[32:35], a[64:67], a[32:35], v[32:35]
    v_xor_b32 v8, s60, v8
    v_mfma_f32_16x16x32_bf16 v[40:43], a[64:67], a[36:39], v[40:43]
    v_xor_b32 v9, s60, v9
    s_waitcnt lgkmcnt(15)
    v_mfma_f32_16x16x32_bf16 v[48:51], a[64:67], a[40:43], v[48:51]
    v_xor_b32 v10, s60, v10
    v_mfma_f32_16x16x32_bf16 v[56:59], a[64:67], a[44:47], v[56:59]
    v_xor_b32 v11, s60, v11
    s_waitcnt lgkmcnt(13)
    v_mfma_f32_16x16x32_bf16 v[64:67], a[64:67], a[48:51], v[64:67]
    v_xor_b32 v12, s60, v12
    s_waitcnt lgkmcnt(12)
    v_mfma_f32_16x16x32_bf16 v[72:75], a[64:67], a[52:55], v[72:75]
    v_xor_b32 v13, s60, v13
    s_waitcnt lgkmcnt(9)
    v_mfma_f32_16x16x32_bf16 v[80:83], a[64:67], a[56:59], v[80:83]
    v_xor_b32 v14, s60, v14
    v_xor_b32 v15, s60, v15
    s_waitcnt lgkmcnt(8)
    s_waitcnt lgkmcnt(0)
    s_waitcnt vmcnt(8)
    v_mfma_f32_16x16x32_bf16 v[88:91], a[64:67], a[60:63], v[88:91]
    s_barrier
    ds_read_b64_tr_b16 a[64:65], v8 offset:0
    v_mfma_f32_16x16x32_bf16 v[36:39], a[68:71], a[32:35], v[36:39]
    ds_read_b64_tr_b16 a[66:67], v8 offset:2048
    v_mfma_f32_16x16x32_bf16 v[44:47], a[68:71], a[36:39], v[44:47]
    s_add_u32 m0, s62, 0
    s_nop 0
    buffer_load_dwordx4 v18, s[44:47], s52 offen offset:0 lds
    v_mfma_f32_16x16x32_bf16 v[52:55], a[68:71], a[40:43], v[52:55]
    ds_read_b128 a[0:3], v6 offset:0
    v_mfma_f32_16x16x32_bf16 v[60:63], a[68:71], a[44:47], v[60:63]
    v_mfma_f32_16x16x32_bf16 v[68:71], a[68:71], a[48:51], v[68:71]
    v_mfma_f32_16x16x32_bf16 v[76:79], a[68:71], a[52:55], v[76:79]
    buffer_load_dwordx4 v19, s[44:47], s52 offen offset:1024 lds
    s_add_u32 s52, s52, s56
    v_mfma_f32_16x16x32_bf16 v[84:87], a[68:71], a[56:59], v[84:87]
    ds_read_b128 a[4:7], v6 offset:2048
    v_mfma_f32_16x16x32_bf16 v[92:95], a[68:71], a[60:63], v[92:95]
    ds_read_b64_tr_b16 a[68:69], v9 offset:0
    v_mfma_f32_16x16x32_bf16 v[96:99], a[72:75], a[32:35], v[96:99]
    ds_read_b64_tr_b16 a[70:71], v9 offset:2048
    v_mfma_f32_16x16x32_bf16 v[104:107], a[72:75], a[36:39], v[104:107]
    buffer_load_dwordx4 v18, s[44:47], s53 offen offset:2048 lds
    v_mfma_f32_16x16x32_bf16 v[112:115], a[72:75], a[40:43], v[112:115]
    ds_read_b128 a[8:11], v6 offset:4096
    v_mfma_f32_16x16x32_bf16 v[120:123], a[72:75], a[44:47], v[120:123]
    v_mfma_f32_16x16x32_bf16 v[128:131], a[72:75], a[48:51], v[128:131]
    v_mfma_f32_16x16x32_bf16 v[136:139], a[72:75], a[52:55], v[136:139]
    buffer_load_dwordx4 v19, s[44:47], s53 offen offset:3072 lds
    s_add_u32 s53, s53, s56
    v_mfma_f32_16x16x32_bf16 v[144:147], a[72:75], a[56:59], v[144:147]
    ds_read_b128 a[12:15], v6 offset:6144
    v_mfma_f32_16x16x32_bf16 v[152:155], a[72:75], a[60:63], v[152:155]
    ds_read_b64_tr_b16 a[72:73], v10 offset:0
    v_mfma_f32_16x16x32_bf16 v[100:103], a[76:79], a[32:35], v[100:103]
    ds_read_b64_tr_b16 a[74:75], v10 offset:2048
    v_mfma_f32_16x16x32_bf16 v[108:111], a[76:79], a[36:39], v[108:111]
    s_add_u32 m0, s62, 4096
    s_nop 0
    buffer_load_dwordx4 v20, s[44:47], s54 offen offset:0 lds
    v_mfma_f32_16x16x32_bf16 v[116:119], a[76:79], a[40:43], v[116:119]
    ds_read_b128 a[16:19], v6 offset:8192
    v_mfma_f32_16x16x32_bf16 v[124:127], a[76:79], a[44:47], v[124:127]
    v_mfma_f32_16x16x32_bf16 v[132:135], a[76:79], a[48:51], v[132:135]
    v_mfma_f32_16x16x32_bf16 v[140:143], a[76:79], a[52:55], v[140:143]
    buffer_load_dwordx4 v21, s[44:47], s54 offen offset:1024 lds
    s_add_u32 s54, s54, s56
    v_mfma_f32_16x16x32_bf16 v[148:151], a[76:79], a[56:59], v[148:151]
    ds_read_b128 a[20:23], v6 offset:10240
    v_mfma_f32_16x16x32_bf16 v[156:159], a[76:79], a[60:63], v[156:159]
    ds_read_b64_tr_b16 a[76:77], v11 offset:0
    v_mfma_f32_16x16x32_bf16 v[160:163], a[80:83], a[32:35], v[160:163]
    ds_read_b64_tr_b16 a[78:79], v11 offset:2048
    v_mfma_f32_16x16x32_bf16 v[168:171], a[80:83], a[36:39], v[168:171]
    buffer_load_dwordx4 v20, s[44:47], s55 offen offset:2048 lds
    v_mfma_f32_16x16x32_bf16 v[176:179], a[80:83], a[40:43], v[176:179]
    ds_read_b128 a[24:27], v6 offset:12288
    v_mfma_f32_16x16x32_bf16 v[184:187], a[80:83], a[44:47], v[184:187]
    v_mfma_f32_16x16x32_bf16 v[192:195], a[80:83], a[48:51], v[192:195]
    v_mfma_f32_16x16x32_bf16 v[200:203], a[80:83], a[52:55], v[200:203]
    buffer_load_dwordx4 v21, s[44:47], s55 offen offset:3072 lds
    s_add_u32 s55, s55, s56
    v_mfma_f32_16x16x32_bf16 v[208:211], a[80:83], a[56:59], v[208:211]
    ds_read_b128 a[28:31], v6 offset:14336
    v_mfma_f32_16x16x32_bf16 v[216:219], a[80:83], a[60:63], v[216:219]
    ds_read_b64_tr_b16 a[80:81], v12 offset:0
    v_mfma_f32_16x16x32_bf16 v[164:167], a[84:87], a[32:35], v[164:167]
    ds_read_b64_tr_b16 a[82:83], v12 offset:2048
    v_mfma_f32_16x16x32_bf16 v[172:175], a[84:87], a[36:39], v[172:175]
    v_mfma_f32_16x16x32_bf16 v[180:183], a[84:87], a[40:43], v[180:183]
    v_mfma_f32_16x16x32_bf16 v[188:191], a[84:87], a[44:47], v[188:191]
    v_mfma_f32_16x16x32_bf16 v[196:199], a[84:87], a[48:51], v[196:199]
    s_xor_b32 s62, s62, 229376
    v_mfma_f32_16x16x32_bf16 v[204:207], a[84:87], a[52:55], v[204:207]
    v_mfma_f32_16x16x32_bf16 v[212:215], a[84:87], a[56:59], v[212:215]
    v_mfma_f32_16x16x32_bf16 v[220:223], a[84:87], a[60:63], v[220:223]
    ds_read_b64_tr_b16 a[84:85], v13 offset:0
    v_mfma_f32_16x16x32_bf16 v[224:227], a[88:91], a[32:35], v[224:227]
    ds_read_b64_tr_b16 a[86:87], v13 offset:2048
    v_mfma_f32_16x16x32_bf16 v[232:235], a[88:91], a[36:39], v[232:235]
    v_mfma_f32_16x16x32_bf16 v[240:243], a[88:91], a[40:43], v[240:243]
    v_mfma_f32_16x16x32_bf16 v[248:251], a[88:91], a[44:47], v[248:251]
    v_mfma_f32_16x16x32_bf16 a[96:99], a[88:91], a[48:51], a[96:99]
    v_mfma_f32_16x16x32_bf16 a[104:107], a[88:91], a[52:55], a[104:107]
    v_mfma_f32_16x16x32_bf16 a[112:115], a[88:91], a[56:59], a[112:115]
    v_mfma_f32_16x16x32_bf16 a[120:123], a[88:91], a[60:63], a[120:123]
    ds_read_b64_tr_b16 a[88:89], v14 offset:0
    v_mfma_f32_16x16x32_bf16 v[228:231], a[92:95], a[32:35], v[228:231]
    ds_read_b64_tr_b16 a[90:91], v14 offset:2048
    v_mfma_f32_16x16x32_bf16 v[236:239], a[92:95], a[36:39], v[236:239]
    v_mfma_f32_16x16x32_bf16 v[244:247], a[92:95], a[40:43], v[244:247]
    v_mfma_f32_16x16x32_bf16 v[252:255], a[92:95], a[44:47], v[252:255]
    v_mfma_f32_16x16x32_bf16 a[100:103], a[92:95], a[48:51], a[100:103]
    v_mfma_f32_16x16x32_bf16 a[108:111], a[92:95], a[52:55], a[108:111]
    v_mfma_f32_16x16x32_bf16 a[116:119], a[92:95], a[56:59], a[116:119]
    v_mfma_f32_16x16x32_bf16 a[124:127], a[92:95], a[60:63], a[124:127]
    ds_read_b64_tr_b16 a[92:93], v15 offset:0
    ds_read_b64_tr_b16 a[94:95], v15 offset:2048
    s_sub_u32 s65, s65, 1
    s_cmp_lg_u32 s65, 0
    s_cbranch_scc1 mega_kernel_loop14
    s_branch mega_kernel_epi11
mega_kernel_swp12:
    s_waitcnt lgkmcnt(15)
    v_mfma_f32_16x16x32_bf16 v[32:35], a[0:3], a[64:67], 0
    v_mfma_f32_16x16x32_bf16 v[36:39], a[4:7], a[64:67], 0
    v_mfma_f32_16x16x32_bf16 v[96:99], a[8:11], a[64:67], 0
    v_mfma_f32_16x16x32_bf16 v[100:103], a[12:15], a[64:67], 0
    s_waitcnt lgkmcnt(13)
    v_mfma_f32_16x16x32_bf16 v[160:163], a[16:19], a[64:67], 0
    s_add_u32 m0, s61, 0
    s_nop 0
    buffer_load_dwordx4 v16, s[40:43], s48 offen offset:0 lds
    s_waitcnt lgkmcnt(12)
    v_mfma_f32_16x16x32_bf16 v[164:167], a[20:23], a[64:67], 0
    s_waitcnt lgkmcnt(9)
    v_mfma_f32_16x16x32_bf16 v[224:227], a[24:27], a[64:67], 0
    s_waitcnt lgkmcnt(8)
    v_mfma_f32_16x16x32_bf16 v[228:231], a[28:31], a[64:67], 0
    ds_read_b64_tr_b16 a[64:65], v8 offset:16384
    v_mfma_f32_16x16x32_bf16 v[40:43], a[0:3], a[68:71], 0
    ds_read_b64_tr_b16 a[66:67], v8 offset:18432
    v_mfma_f32_16x16x32_bf16 v[44:47], a[4:7], a[68:71], 0
    v_mfma_f32_16x16x32_bf16 v[104:107], a[8:11], a[68:71], 0
    ds_read_b128 a[32:35], v7 offset:0
    v_mfma_f32_16x16x32_bf16 v[108:111], a[12:15], a[68:71], 0
    buffer_load_dwordx4 v17, s[40:43], s48 offen offset:1024 lds
    s_add_u32 s48, s48, 128
    v_mfma_f32_16x16x32_bf16 v[168:171], a[16:19], a[68:71], 0
    v_mfma_f32_16x16x32_bf16 v[172:175], a[20:23], a[68:71], 0
    v_mfma_f32_16x16x32_bf16 v[232:235], a[24:27], a[68:71], 0
    ds_read_b128 a[36:39], v7 offset:2048
    v_mfma_f32_16x16x32_bf16 v[236:239], a[28:31], a[68:71], 0
    ds_read_b64_tr_b16 a[68:69], v9 offset:16384
    v_mfma_f32_16x16x32_bf16 v[48:51], a[0:3], a[72:75], 0
    ds_read_b64_tr_b16 a[70:71], v9 offset:18432
    v_mfma_f32_16x16x32_bf16 v[52:55], a[4:7], a[72:75], 0
    buffer_load_dwordx4 v16, s[40:43], s49 offen offset:2048 lds
    v_mfma_f32_16x16x32_bf16 v[112:115], a[8:11], a[72:75], 0
    ds_read_b128 a[40:43], v7 offset:4096
    v_mfma_f32_16x16x32_bf16 v[116:119], a[12:15], a[72:75], 0
    v_mfma_f32_16x16x32_bf16 v[176:179], a[16:19], a[72:75], 0
    v_mfma_f32_16x16x32_bf16 v[180:183], a[20:23], a[72:75], 0
    v_mfma_f32_16x16x32_bf16 v[240:243], a[24:27], a[72:75], 0
    ds_read_b128 a[44:47], v7 offset:6144
    v_mfma_f32_16x16x32_bf16 v[244:247], a[28:31], a[72:75], 0
    ds_read_b64_tr_b16 a[72:73], v10 offset:16384
    buffer_load_dwordx4 v17, s[40:43], s49 offen offset:3072 lds
    s_add_u32 s49, s49, 128
    v_mfma_f32_16x16x32_bf16 v[56:59], a[0:3], a[76:79], 0
    ds_read_b64_tr_b16 a[74:75], v10 offset:18432
    v_mfma_f32_16x16x32_bf16 v[60:63], a[4:7], a[76:79], 0
    v_mfma_f32_16x16x32_bf16 v[120:123], a[8:11], a[76:79], 0
    ds_read_b128 a[48:51], v7 offset:8192
    v_mfma_f32_16x16x32_bf16 v[124:127], a[12:15], a[76:79], 0
    v_mfma_f32_16x16x32_bf16 v[184:187], a[16:19], a[76:79], 0
    s_add_u32 m0, s61, 4096
    s_nop 0
    buffer_load_dwordx4 v16, s[40:43], s50 offen offset:0 lds
    v_mfma_f32_16x16x32_bf16 v[188:191], a[20:23], a[76:79], 0
    v_mfma_f32_16x16x32_bf16 v[248:251], a[24:27], a[76:79], 0
    ds_read_b128 a[52:55], v7 offset:10240
    v_mfma_f32_16x16x32_bf16 v[252:255], a[28:31], a[76:79], 0
    ds_read_b64_tr_b16 a[76:77], v11 offset:16384
    s_waitcnt lgkmcnt(15)
    v_mfma_f32_16x16x32_bf16 v[64:67], a[0:3], a[80:83], 0
    ds_read_b64_tr_b16 a[78:79], v11 offset:18432
    v_mfma_f32_16x16x32_bf16 v[68:71], a[4:7], a[80:83], 0
    v_mfma_f32_16x16x32_bf16 v[128:131], a[8:11], a[80:83], 0
    ds_read_b128 a[56:59], v7 offset:12288
    v_mfma_f32_16x16x32_bf16 v[132:135], a[12:15], a[80:83], 0
    buffer_load_dwordx4 v17, s[40:43], s50 offen offset:1024 lds
    s_add_u32 s50, s50, 128
    v_mfma_f32_16x16x32_bf16 v[192:195], a[16:19], a[80:83], 0
    v_mfma_f32_16x16x32_bf16 v[196:199], a[20:23], a[80:83], 0
    v_mfma_f32_16x16x32_bf16 a[96:99], a[24:27], a[80:83], 0
    ds_read_b128 a[60:63], v7 offset:14336
    v_mfma_f32_16x16x32_bf16 a[100:103], a[28:31], a[80:83], 0
    ds_read_b64_tr_b16 a[80:81], v12 offset:16384
    v_mfma_f32_16x16x32_bf16 v[72:75], a[0:3], a[84:87], 0
    ds_read_b64_tr_b16 a[82:83], v12 offset:18432
    v_mfma_f32_16x16x32_bf16 v[76:79], a[4:7], a[84:87], 0
    buffer_load_dwordx4 v16, s[40:43], s51 offen offset:2048 lds
    v_mfma_f32_16x16x32_bf16 v[136:139], a[8:11], a[84:87], 0
    v_mfma_f32_16x16x32_bf16 v[140:143], a[12:15], a[84:87], 0
    v_mfma_f32_16x16x32_bf16 v[200:203], a[16:19], a[84:87], 0
    v_mfma_f32_16x16x32_bf16 v[204:207], a[20:23], a[84:87], 0
    v_mfma_f32_16x16x32_bf16 a[104:107], a[24:27], a[84:87], 0
    buffer_load_dwordx4 v17, s[40:43], s51 offen offset:3072 lds
    s_add_u32 s51, s51, 128
    v_mfma_f32_16x16x32_bf16 a[108:111], a[28:31], a[84:87], 0
    ds_read_b64_tr_b16 a[84:85], v13 offset:16384
    v_mfma_f32_16x16x32_bf16 v[80:83], a[0:3], a[88:91], 0
    ds_read_b64_tr_b16 a[86:87], v13 offset:18432
    v_mfma_f32_16x16x32_bf16 v[84:87], a[4:7], a[88:91], 0
    v_mfma_f32_16x16x32_bf16 v[144:147], a[8:11], a[88:91], 0
    v_mfma_f32_16x16x32_bf16 v[148:151], a[12:15], a[88:91], 0
    v_mfma_f32_16x16x32_bf16 v[208:211], a[16:19], a[88:91], 0
    v_mfma_f32_16x16x32_bf16 v[212:215], a[20:23], a[88:91], 0
    s_add_u32 s61, s61, 32768
    s_cmp_ge_u32 s61, 98304
    s_cselect_b32 s90, 98304, 0
    s_sub_u32 s61, s61, s90
    v_mfma_f32_16x16x32_bf16 a[112:115], a[24:27], a[88:91], 0
    v_mfma_f32_16x16x32_bf16 a[116:119], a[28:31], a[88:91], 0
    ds_read_b64_tr_b16 a[88:89], v14 offset:16384
    s_waitcnt lgkmcnt(15)
    v_mfma_f32_16x16x32_bf16 v[88:91], a[0:3], a[92:95], 0
    ds_read_b64_tr_b16 a[90:91], v14 offset:18432
    v_mfma_f32_16x16x32_bf16 v[92:95], a[4:7], a[92:95], 0
    s_add_u32 s64, s64, 32768
    s_cmp_ge_u32 s64, 98304
    s_cselect_b32 s63, 4294901760, s59
    s_cselect_b32 s64, 0, s64
    v_mfma_f32_16x16x32_bf16 v[152:155], a[8:11], a[92:95], 0
    v_add_u32 v6, s63, v6
    v_mfma_f32_16x16x32_bf16 v[156:159], a[12:15], a[92:95], 0
    v_add_u32 v7, s63, v7
    v_mfma_f32_16x16x32_bf16 v[216:219], a[16:19], a[92:95], 0
    v_mfma_f32_16x16x32_bf16 v[220:223], a[20:23], a[92:95], 0
    v_mfma_f32_16x16x32_bf16 a[120:123], a[24:27], a[92:95], 0
    v_mfma_f32_16x16x32_bf16 a[124:127], a[28:31], a[92:95], 0
    ds_read_b64_tr_b16 a[92:93], v15 offset:16384
    ds_read_b64_tr_b16 a[94:95], v15 offset:18432
    v_mfma_f32_16x16x32_bf16 v[32:35], a[32:35], a[64:67], v[32:35]
    v_xor_b32 v8, s60, v8
    v_mfma_f32_16x16x32_bf16 v[36:39], a[36:39], a[64:67], v[36:39]
    v_xor_b32 v9, s60, v9
    s_waitcnt lgkmcnt(15)
    v_mfma_f32_16x16x32_bf16 v[96:99], a[40:43], a[64:67], v[96:99]
    v_xor_b32 v10, s60, v10
    v_mfma_f32_16x16x32_bf16 v[100:103], a[44:47], a[64:67], v[100:103]
    v_xor_b32 v11, s60, v11
    s_waitcnt lgkmcnt(13)
    v_mfma_f32_16x16x32_bf16 v[160:163], a[48:51], a[64:67], v[160:163]
    v_xor_b32 v12, s60, v12
    s_waitcnt lgkmcnt(12)
    v_mfma_f32_16x16x32_bf16 v[164:167], a[52:55], a[64:67], v[164:167]
    v_xor_b32 v13, s60, v13
    s_waitcnt lgkmcnt(9)
    v_mfma_f32_16x16x32_bf16 v[224:227], a[56:59], a[64:67], v[224:227]
    v_xor_b32 v14, s60, v14
    v_xor_b32 v15, s60, v15
    s_waitcnt lgkmcnt(8)
    s_waitcnt lgkmcnt(0)
    s_waitcnt vmcnt(40)
    s_cmp_eq_u32 s66, 0
    s_cbranch_scc1 mega_kernel_w17
    s_waitcnt vmcnt(8)
mega_kernel_w17:
    v_mfma_f32_16x16x32_bf16 v[228:231], a[60:63], a[64:67], v[228:231]
    s_barrier
    ds_read_b64_tr_b16 a[64:65], v8 offset:0
    v_mfma_f32_16x16x32_bf16 v[40:43], a[32:35], a[68:71], v[40:43]
    ds_read_b64_tr_b16 a[66:67], v8 offset:2048
    v_mfma_f32_16x16x32_bf16 v[44:47], a[36:39], a[68:71], v[44:47]
    s_add_u32 m0, s62, 0
    s_nop 0
    buffer_load_dwordx4 v18, s[44:47], s52 offen offset:0 lds
    v_mfma_f32_16x16x32_bf16 v[104:107], a[40:43], a[68:71], v[104:107]
    ds_read_b128 a[0:3], v6 offset:0
    v_mfma_f32_16x16x32_bf16 v[108:111], a[44:47], a[68:71], v[108:111]
    v_mfma_f32_16x16x32_bf16 v[168:171], a[48:51], a[68:71], v[168:171]
    v_mfma_f32_16x16x32_bf16 v[172:175], a[52:55], a[68:71], v[172:175]
    buffer_load_dwordx4 v19, s[44:47], s52 offen offset:1024 lds
    s_add_u32 s52, s52, s56
    v_mfma_f32_16x16x32_bf16 v[232:235], a[56:59], a[68:71], v[232:235]
    ds_read_b128 a[4:7], v6 offset:2048
    v_mfma_f32_16x16x32_bf16 v[236:239], a[60:63], a[68:71], v[236:239]
    ds_read_b64_tr_b16 a[68:69], v9 offset:0
    v_mfma_f32_16x16x32_bf16 v[48:51], a[32:35], a[72:75], v[48:51]
    ds_read_b64_tr_b16 a[70:71], v9 offset:2048
    v_mfma_f32_16x16x32_bf16 v[52:55], a[36:39], a[72:75], v[52:55]
    buffer_load_dwordx4 v18, s[44:47], s53 offen offset:2048 lds
    v_mfma_f32_16x16x32_bf16 v[112:115], a[40:43], a[72:75], v[112:115]
    ds_read_b128 a[8:11], v6 offset:4096
    v_mfma_f32_16x16x32_bf16 v[116:119], a[44:47], a[72:75], v[116:119]
    v_mfma_f32_16x16x32_bf16 v[176:179], a[48:51], a[72:75], v[176:179]
    v_mfma_f32_16x16x32_bf16 v[180:183], a[52:55], a[72:75], v[180:183]
    buffer_load_dwordx4 v19, s[44:47], s53 offen offset:3072 lds
    s_add_u32 s53, s53, s56
    v_mfma_f32_16x16x32_bf16 v[240:243], a[56:59], a[72:75], v[240:243]
    ds_read_b128 a[12:15], v6 offset:6144
    v_mfma_f32_16x16x32_bf16 v[244:247], a[60:63], a[72:75], v[244:247]
    ds_read_b64_tr_b16 a[72:73], v10 offset:0
    v_mfma_f32_16x16x32_bf16 v[56:59], a[32:35], a[76:79], v[56:59]
    ds_read_b64_tr_b16 a[74:75], v10 offset:2048
    v_mfma_f32_16x16x32_bf16 v[60:63], a[36:39], a[76:79], v[60:63]
    s_add_u32 m0, s62, 4096
    s_nop 0
    buffer_load_dwordx4 v20, s[44:47], s54 offen offset:0 lds
    v_mfma_f32_16x16x32_bf16 v[120:123], a[40:43], a[76:79], v[120:123]
    ds_read_b128 a[16:19], v6 offset:8192
    v_mfma_f32_16x16x32_bf16 v[124:127], a[44:47], a[76:79], v[124:127]
    v_mfma_f32_16x16x32_bf16 v[184:187], a[48:51], a[76:79], v[184:187]
    v_mfma_f32_16x16x32_bf16 v[188:191], a[52:55], a[76:79], v[188:191]
    buffer_load_dwordx4 v21, s[44:47], s54 offen offset:1024 lds
    s_add_u32 s54, s54, s56
    v_mfma_f32_16x16x32_bf16 v[248:251], a[56:59], a[76:79], v[248:251]
    ds_read_b128 a[20:23], v6 offset:10240
    v_mfma_f32_16x16x32_bf16 v[252:255], a[60:63], a[76:79], v[252:255]
    ds_read_b64_tr_b16 a[76:77], v11 offset:0
    v_mfma_f32_16x16x32_bf16 v[64:67], a[32:35], a[80:83], v[64:67]
    ds_read_b64_tr_b16 a[78:79], v11 offset:2048
    v_mfma_f32_16x16x32_bf16 v[68:71], a[36:39], a[80:83], v[68:71]
    buffer_load_dwordx4 v20, s[44:47], s55 offen offset:2048 lds
    v_mfma_f32_16x16x32_bf16 v[128:131], a[40:43], a[80:83], v[128:131]
    ds_read_b128 a[24:27], v6 offset:12288
    v_mfma_f32_16x16x32_bf16 v[132:135], a[44:47], a[80:83], v[132:135]
    v_mfma_f32_16x16x32_bf16 v[192:195], a[48:51], a[80:83], v[192:195]
    v_mfma_f32_16x16x32_bf16 v[196:199], a[52:55], a[80:83], v[196:199]
    buffer_load_dwordx4 v21, s[44:47], s55 offen offset:3072 lds
    s_add_u32 s55, s55, s56
    v_mfma_f32_16x16x32_bf16 a[96:99], a[56:59], a[80:83], a[96:99]
    ds_read_b128 a[28:31], v6 offset:14336
    v_mfma_f32_16x16x32_bf16 a[100:103], a[60:63], a[80:83], a[100:103]
    ds_read_b64_tr_b16 a[80:81], v12 offset:0
    v_mfma_f32_16x16x32_bf16 v[72:75], a[32:35], a[84:87], v[72:75]
    ds_read_b64_tr_b16 a[82:83], v12 offset:2048
    v_mfma_f32_16x16x32_bf16 v[76:79], a[36:39], a[84:87], v[76:79]
    v_mfma_f32_16x16x32_bf16 v[136:139], a[40:43], a[84:87], v[136:139]
    v_mfma_f32_16x16x32_bf16 v[140:143], a[44:47], a[84:87], v[140:143]
    v_mfma_f32_16x16x32_bf16 v[200:203], a[48:51], a[84:87], v[200:203]
    s_xor_b32 s62, s62, 229376
    v_mfma_f32_16x16x32_bf16 v[204:207], a[52:55], a[84:87], v[204:207]
    v_mfma_f32_16x16x32_bf16 a[104:107], a[56:59], a[84:87], a[104:107]
    v_mfma_f32_16x16x32_bf16 a[108:111], a[60:63], a[84:87], a[108:111]
    ds_read_b64_tr_b16 a[84:85], v13 offset:0
    v_mfma_f32_16x16x32_bf16 v[80:83], a[32:35], a[88:91], v[80:83]
    ds_read_b64_tr_b16 a[86:87], v13 offset:2048
    v_mfma_f32_16x16x32_bf16 v[84:87], a[36:39], a[88:91], v[84:87]
    v_mfma_f32_16x16x32_bf16 v[144:147], a[40:43], a[88:91], v[144:147]
    v_mfma_f32_16x16x32_bf16 v[148:151], a[44:47], a[88:91], v[148:151]
    v_mfma_f32_16x16x32_bf16 v[208:211], a[48:51], a[88:91], v[208:211]
    v_mfma_f32_16x16x32_bf16 v[212:215], a[52:55], a[88:91], v[212:215]
    v_mfma_f32_16x16x32_bf16 a[112:115], a[56:59], a[88:91], a[112:115]
    v_mfma_f32_16x16x32_bf16 a[116:119], a[60:63], a[88:91], a[116:119]
    ds_read_b64_tr_b16 a[88:89], v14 offset:0
    v_mfma_f32_16x16x32_bf16 v[88:91], a[32:35], a[92:95], v[88:91]
    ds_read_b64_tr_b16 a[90:91], v14 offset:2048
    v_mfma_f32_16x16x32_bf16 v[92:95], a[36:39], a[92:95], v[92:95]
    v_mfma_f32_16x16x32_bf16 v[152:155], a[40:43], a[92:95], v[152:155]
    v_mfma_f32_16x16x32_bf16 v[156:159], a[44:47], a[92:95], v[156:159]
    v_mfma_f32_16x16x32_bf16 v[216:219], a[48:51], a[92:95], v[216:219]
    v_mfma_f32_16x16x32_bf16 v[220:223], a[52:55], a[92:95], v[220:223]
    v_mfma_f32_16x16x32_bf16 a[120:123], a[56:59], a[92:95], a[120:123]
    v_mfma_f32_16x16x32_bf16 a[124:127], a[60:63], a[92:95], a[124:127]
    ds_read_b64_tr_b16 a[92:93], v15 offset:0
    ds_read_b64_tr_b16 a[94:95], v15 offset:2048
mega_kernel_loop18:
    s_cmp_le_u32 s65, s67
    s_cbranch_scc1 mega_kernel_dosw20
mega_kernel_nosw19:
    s_waitcnt lgkmcnt(15)
    v_mfma_f32_16x16x32_bf16 v[32:35], a[0:3], a[64:67], v[32:35]
    v_mfma_f32_16x16x32_bf16 v[36:39], a[4:7], a[64:67], v[36:39]
    v_mfma_f32_16x16x32_bf16 v[96:99], a[8:11], a[64:67], v[96:99]
    v_mfma_f32_16x16x32_bf16 v[100:103], a[12:15], a[64:67], v[100:103]
    s_waitcnt lgkmcnt(13)
    v_mfma_f32_16x16x32_bf16 v[160:163], a[16:19], a[64:67], v[160:163]
    s_add_u32 m0, s61, 0
    s_nop 0
    buffer_load_dwordx4 v16, s[40:43], s48 offen offset:0 lds
    s_waitcnt lgkmcnt(12)
    v_mfma_f32_16x16x32_bf16 v[164:167], a[20:23], a[64:67], v[164:167]
    s_waitcnt lgkmcnt(9)
    v_mfma_f32_16x16x32_bf16 v[224:227], a[24:27], a[64:67], v[224:227]
    s_waitcnt lgkmcnt(8)
    v_mfma_f32_16x16x32_bf16 v[228:231], a[28:31], a[64:67], v[228:231]
    ds_read_b64_tr_b16 a[64:65], v8 offset:16384
    v_mfma_f32_16x16x32_bf16 v[40:43], a[0:3], a[68:71], v[40:43]
    ds_read_b64_tr_b16 a[66:67], v8 offset:18432
    v_mfma_f32_16x16x32_bf16 v[44:47], a[4:7], a[68:71], v[44:47]
    v_mfma_f32_16x16x32_bf16 v[104:107], a[8:11], a[68:71], v[104:107]
    ds_read_b128 a[32:35], v7 offset:0
    v_mfma_f32_16x16x32_bf16 v[108:111], a[12:15], a[68:71], v[108:111]
    buffer_load_dwordx4 v17, s[40:43], s48 offen offset:1024 lds
    s_add_u32 s48, s48, 128
    v_mfma_f32_16x16x32_bf16 v[168:171], a[16:19], a[68:71], v[168:171]
    v_mfma_f32_16x16x32_bf16 v[172:175], a[20:23], a[68:71], v[172:175]
    v_mfma_f32_16x16x32_bf16 v[232:235], a[24:27], a[68:71], v[232:235]
    ds_read_b128 a[36:39], v7 offset:2048
    v_mfma_f32_16x16x32_bf16 v[236:239], a[28:31], a[68:71], v[236:239]
    ds_read_b64_tr_b16 a[68:69], v9 offset:16384
    v_mfma_f32_16x16x32_bf16 v[48:51], a[0:3], a[72:75], v[48:51]
    ds_read_b64_tr_b16 a[70:71], v9 offset:18432
    v_mfma_f32_16x16x32_bf16 v[52:55], a[4:7], a[72:75], v[52:55]
    buffer_load_dwordx4 v16, s[40:43], s49 offen offset:2048 lds
    v_mfma_f32_16x16x32_bf16 v[112:115], a[8:11], a[72:75], v[112:115]
    ds_read_b128 a[40:43], v7 offset:4096
    v_mfma_f32_16x16x32_bf16 v[116:119], a[12:15], a[72:75], v[116:119]
    v_mfma_f32_16x16x32_bf16 v[176:179], a[16:19], a[72:75], v[176:179]
    v_mfma_f32_16x16x32_bf16 v[180:183], a[20:23], a[72:75], v[180:183]
    v_mfma_f32_16x16x32_bf16 v[240:243], a[24:27], a[72:75], v[240:243]
    ds_read_b128 a[44:47], v7 offset:6144
    v_mfma_f32_16x16x32_bf16 v[244:247], a[28:31], a[72:75], v[244:247]
    ds_read_b64_tr_b16 a[72:73], v10 offset:16384
    buffer_load_dwordx4 v17, s[40:43], s49 offen offset:3072 lds
    s_add_u32 s49, s49, 128
    v_mfma_f32_16x16x32_bf16 v[56:59], a[0:3], a[76:79], v[56:59]
    ds_read_b64_tr_b16 a[74:75], v10 offset:18432
    v_mfma_f32_16x16x32_bf16 v[60:63], a[4:7], a[76:79], v[60:63]
    v_mfma_f32_16x16x32_bf16 v[120:123], a[8:11], a[76:79], v[120:123]
    ds_read_b128 a[48:51], v7 offset:8192
    v_mfma_f32_16x16x32_bf16 v[124:127], a[12:15], a[76:79], v[124:127]
    v_mfma_f32_16x16x32_bf16 v[184:187], a[16:19], a[76:79], v[184:187]
    s_add_u32 m0, s61, 4096
    s_nop 0
    buffer_load_dwordx4 v16, s[40:43], s50 offen offset:0 lds
    v_mfma_f32_16x16x32_bf16 v[188:191], a[20:23], a[76:79], v[188:191]
    v_mfma_f32_16x16x32_bf16 v[248:251], a[24:27], a[76:79], v[248:251]
    ds_read_b128 a[52:55], v7 offset:10240
    v_mfma_f32_16x16x32_bf16 v[252:255], a[28:31], a[76:79], v[252:255]
    ds_read_b64_tr_b16 a[76:77], v11 offset:16384
    s_waitcnt lgkmcnt(15)
    v_mfma_f32_16x16x32_bf16 v[64:67], a[0:3], a[80:83], v[64:67]
    ds_read_b64_tr_b16 a[78:79], v11 offset:18432
    v_mfma_f32_16x16x32_bf16 v[68:71], a[4:7], a[80:83], v[68:71]
    v_mfma_f32_16x16x32_bf16 v[128:131], a[8:11], a[80:83], v[128:131]
    ds_read_b128 a[56:59], v7 offset:12288
    v_mfma_f32_16x16x32_bf16 v[132:135], a[12:15], a[80:83], v[132:135]
    buffer_load_dwordx4 v17, s[40:43], s50 offen offset:1024 lds
    s_add_u32 s50, s50, 128
    v_mfma_f32_16x16x32_bf16 v[192:195], a[16:19], a[80:83], v[192:195]
    v_mfma_f32_16x16x32_bf16 v[196:199], a[20:23], a[80:83], v[196:199]
    v_mfma_f32_16x16x32_bf16 a[96:99], a[24:27], a[80:83], a[96:99]
    ds_read_b128 a[60:63], v7 offset:14336
    v_mfma_f32_16x16x32_bf16 a[100:103], a[28:31], a[80:83], a[100:103]
    ds_read_b64_tr_b16 a[80:81], v12 offset:16384
    v_mfma_f32_16x16x32_bf16 v[72:75], a[0:3], a[84:87], v[72:75]
    ds_read_b64_tr_b16 a[82:83], v12 offset:18432
    v_mfma_f32_16x16x32_bf16 v[76:79], a[4:7], a[84:87], v[76:79]
    buffer_load_dwordx4 v16, s[40:43], s51 offen offset:2048 lds
    v_mfma_f32_16x16x32_bf16 v[136:139], a[8:11], a[84:87], v[136:139]
    v_mfma_f32_16x16x32_bf16 v[140:143], a[12:15], a[84:87], v[140:143]
    v_mfma_f32_16x16x32_bf16 v[200:203], a[16:19], a[84:87], v[200:203]
    v_mfma_f32_16x16x32_bf16 v[204:207], a[20:23], a[84:87], v[204:207]
    v_mfma_f32_16x16x32_bf16 a[104:107], a[24:27], a[84:87], a[104:107]
    buffer_load_dwordx4 v17, s[40:43], s51 offen offset:3072 lds
    s_add_u32 s51, s51, 128
    v_mfma_f32_16x16x32_bf16 a[108:111], a[28:31], a[84:87], a[108:111]
    ds_read_b64_tr_b16 a[84:85], v13 offset:16384
    v_mfma_f32_16x16x32_bf16 v[80:83], a[0:3], a[88:91], v[80:83]
    ds_read_b64_tr_b16 a[86:87], v13 offset:18432
    v_mfma_f32_16x16x32_bf16 v[84:87], a[4:7], a[88:91], v[84:87]
    v_mfma_f32_16x16x32_bf16 v[144:147], a[8:11], a[88:91], v[144:147]
    v_mfma_f32_16x16x32_bf16 v[148:151], a[12:15], a[88:91], v[148:151]
    v_mfma_f32_16x16x32_bf16 v[208:211], a[16:19], a[88:91], v[208:211]
    v_mfma_f32_16x16x32_bf16 v[212:215], a[20:23], a[88:91], v[212:215]
    s_add_u32 s61, s61, 32768
    s_cmp_ge_u32 s61, 98304
    s_cselect_b32 s90, 98304, 0
    s_sub_u32 s61, s61, s90
    v_mfma_f32_16x16x32_bf16 a[112:115], a[24:27], a[88:91], a[112:115]
    v_mfma_f32_16x16x32_bf16 a[116:119], a[28:31], a[88:91], a[116:119]
    ds_read_b64_tr_b16 a[88:89], v14 offset:16384
    s_waitcnt lgkmcnt(15)
    v_mfma_f32_16x16x32_bf16 v[88:91], a[0:3], a[92:95], v[88:91]
    ds_read_b64_tr_b16 a[90:91], v14 offset:18432
    v_mfma_f32_16x16x32_bf16 v[92:95], a[4:7], a[92:95], v[92:95]
    s_add_u32 s64, s64, 32768
    s_cmp_ge_u32 s64, 98304
    s_cselect_b32 s63, 4294901760, s59
    s_cselect_b32 s64, 0, s64
    v_mfma_f32_16x16x32_bf16 v[152:155], a[8:11], a[92:95], v[152:155]
    v_add_u32 v6, s63, v6
    v_mfma_f32_16x16x32_bf16 v[156:159], a[12:15], a[92:95], v[156:159]
    v_add_u32 v7, s63, v7
    v_mfma_f32_16x16x32_bf16 v[216:219], a[16:19], a[92:95], v[216:219]
    v_mfma_f32_16x16x32_bf16 v[220:223], a[20:23], a[92:95], v[220:223]
    v_mfma_f32_16x16x32_bf16 a[120:123], a[24:27], a[92:95], a[120:123]
    v_mfma_f32_16x16x32_bf16 a[124:127], a[28:31], a[92:95], a[124:127]
    ds_read_b64_tr_b16 a[92:93], v15 offset:16384
    ds_read_b64_tr_b16 a[94:95], v15 offset:18432
    v_mfma_f32_16x16x32_bf16 v[32:35], a[32:35], a[64:67], v[32:35]
    v_xor_b32 v8, s60, v8
    v_mfma_f32_16x16x32_bf16 v[36:39], a[36:39], a[64:67], v[36:39]
    v_xor_b32 v9, s60, v9
    s_waitcnt lgkmcnt(15)
    v_mfma_f32_16x16x32_bf16 v[96:99], a[40:43], a[64:67], v[96:99]
    v_xor_b32 v10, s60, v10
    v_mfma_f32_16x16x32_bf16 v[100:103], a[44:47], a[64:67], v[100:103]
    v_xor_b32 v11, s60, v11
    s_waitcnt lgkmcnt(13)
    v_mfma_f32_16x16x32_bf16 v[160:163], a[48:51], a[64:67], v[160:163]
    v_xor_b32 v12, s60, v12
    s_waitcnt lgkmcnt(12)
    v_mfma_f32_16x16x32_bf16 v[164:167], a[52:55], a[64:67], v[164:167]
    v_xor_b32 v13, s60, v13
    s_waitcnt lgkmcnt(9)
    v_mfma_f32_16x16x32_bf16 v[224:227], a[56:59], a[64:67], v[224:227]
    v_xor_b32 v14, s60, v14
    v_xor_b32 v15, s60, v15
    s_waitcnt lgkmcnt(8)
    s_waitcnt lgkmcnt(0)
    s_waitcnt vmcnt(8)
    v_mfma_f32_16x16x32_bf16 v[228:231], a[60:63], a[64:67], v[228:231]
    s_barrier
    ds_read_b64_tr_b16 a[64:65], v8 offset:0
    v_mfma_f32_16x16x32_bf16 v[40:43], a[32:35], a[68:71], v[40:43]
    ds_read_b64_tr_b16 a[66:67], v8 offset:2048
    v_mfma_f32_16x16x32_bf16 v[44:47], a[36:39], a[68:71], v[44:47]
    s_add_u32 m0, s62, 0
    s_nop 0
    buffer_load_dwordx4 v18, s[44:47], s52 offen offset:0 lds
    v_mfma_f32_16x16x32_bf16 v[104:107], a[40:43], a[68:71], v[104:107]
    ds_read_b128 a[0:3], v6 offset:0
    v_mfma_f32_16x16x32_bf16 v[108:111], a[44:47], a[68:71], v[108:111]
    v_mfma_f32_16x16x32_bf16 v[168:171], a[48:51], a[68:71], v[168:171]
    v_mfma_f32_16x16x32_bf16 v[172:175], a[52:55], a[68:71], v[172:175]
    buffer_load_dwordx4 v19, s[44:47], s52 offen offset:1024 lds
    s_add_u32 s52, s52, s56
    v_mfma_f32_16x16x32_bf16 v[232:235], a[56:59], a[68:71], v[232:235]
    ds_read_b128 a[4:7], v6 offset:2048
    v_mfma_f32_16x16x32_bf16 v[236:239], a[60:63], a[68:71], v[236:239]
    ds_read_b64_tr_b16 a[68:69], v9 offset:0
    v_mfma_f32_16x16x32_bf16 v[48:51], a[32:35], a[72:75], v[48:51]
    ds_read_b64_tr_b16 a[70:71], v9 offset:2048
    v_mfma_f32_16x16x32_bf16 v[52:55], a[36:39], a[72:75], v[52:55]
    buffer_load_dwordx4 v18, s[44:47], s53 offen offset:2048 lds
    v_mfma_f32_16x16x32_bf16 v[112:115], a[40:43], a[72:75], v[112:115]
    ds_read_b128 a[8:11], v6 offset:4096
    v_mfma_f32_16x16x32_bf16 v[116:119], a[44:47], a[72:75], v[116:119]
    v_mfma_f32_16x16x32_bf16 v[176:179], a[48:51], a[72:75], v[176:179]
    v_mfma_f32_16x16x32_bf16 v[180:183], a[52:55], a[72:75], v[180:183]
    buffer_load_dwordx4 v19, s[44:47], s53 offen offset:3072 lds
    s_add_u32 s53, s53, s56
    v_mfma_f32_16x16x32_bf16 v[240:243], a[56:59], a[72:75], v[240:243]
    ds_read_b128 a[12:15], v6 offset:6144
    v_mfma_f32_16x16x32_bf16 v[244:247], a[60:63], a[72:75], v[244:247]
    ds_read_b64_tr_b16 a[72:73], v10 offset:0
    v_mfma_f32_16x16x32_bf16 v[56:59], a[32:35], a[76:79], v[56:59]
    ds_read_b64_tr_b16 a[74:75], v10 offset:2048
    v_mfma_f32_16x16x32_bf16 v[60:63], a[36:39], a[76:79], v[60:63]
    s_add_u32 m0, s62, 4096
    s_nop 0
    buffer_load_dwordx4 v20, s[44:47], s54 offen offset:0 lds
    v_mfma_f32_16x16x32_bf16 v[120:123], a[40:43], a[76:79], v[120:123]
    ds_read_b128 a[16:19], v6 offset:8192
    v_mfma_f32_16x16x32_bf16 v[124:127], a[44:47], a[76:79], v[124:127]
    v_mfma_f32_16x16x32_bf16 v[184:187], a[48:51], a[76:79], v[184:187]
    v_mfma_f32_16x16x32_bf16 v[188:191], a[52:55], a[76:79], v[188:191]
    buffer_load_dwordx4 v21, s[44:47], s54 offen offset:1024 lds
    s_add_u32 s54, s54, s56
    v_mfma_f32_16x16x32_bf16 v[248:251], a[56:59], a[76:79], v[248:251]
    ds_read_b128 a[20:23], v6 offset:10240
    v_mfma_f32_16x16x32_bf16 v[252:255], a[60:63], a[76:79], v[252:255]
    ds_read_b64_tr_b16 a[76:77], v11 offset:0
    v_mfma_f32_16x16x32_bf16 v[64:67], a[32:35], a[80:83], v[64:67]
    ds_read_b64_tr_b16 a[78:79], v11 offset:2048
    v_mfma_f32_16x16x32_bf16 v[68:71], a[36:39], a[80:83], v[68:71]
    buffer_load_dwordx4 v20, s[44:47], s55 offen offset:2048 lds
    v_mfma_f32_16x16x32_bf16 v[128:131], a[40:43], a[80:83], v[128:131]
    ds_read_b128 a[24:27], v6 offset:12288
    v_mfma_f32_16x16x32_bf16 v[132:135], a[44:47], a[80:83], v[132:135]
    v_mfma_f32_16x16x32_bf16 v[192:195], a[48:51], a[80:83], v[192:195]
    v_mfma_f32_16x16x32_bf16 v[196:199], a[52:55], a[80:83], v[196:199]
    buffer_load_dwordx4 v21, s[44:47], s55 offen offset:3072 lds
    s_add_u32 s55, s55, s56
    v_mfma_f32_16x16x32_bf16 a[96:99], a[56:59], a[80:83], a[96:99]
    ds_read_b128 a[28:31], v6 offset:14336
    v_mfma_f32_16x16x32_bf16 a[100:103], a[60:63], a[80:83], a[100:103]
    ds_read_b64_tr_b16 a[80:81], v12 offset:0
    v_mfma_f32_16x16x32_bf16 v[72:75], a[32:35], a[84:87], v[72:75]
    ds_read_b64_tr_b16 a[82:83], v12 offset:2048
    v_mfma_f32_16x16x32_bf16 v[76:79], a[36:39], a[84:87], v[76:79]
    v_mfma_f32_16x16x32_bf16 v[136:139], a[40:43], a[84:87], v[136:139]
    v_mfma_f32_16x16x32_bf16 v[140:143], a[44:47], a[84:87], v[140:143]
    v_mfma_f32_16x16x32_bf16 v[200:203], a[48:51], a[84:87], v[200:203]
    s_xor_b32 s62, s62, 229376
    v_mfma_f32_16x16x32_bf16 v[204:207], a[52:55], a[84:87], v[204:207]
    v_mfma_f32_16x16x32_bf16 a[104:107], a[56:59], a[84:87], a[104:107]
    v_mfma_f32_16x16x32_bf16 a[108:111], a[60:63], a[84:87], a[108:111]
    ds_read_b64_tr_b16 a[84:85], v13 offset:0
    v_mfma_f32_16x16x32_bf16 v[80:83], a[32:35], a[88:91], v[80:83]
    ds_read_b64_tr_b16 a[86:87], v13 offset:2048
    v_mfma_f32_16x16x32_bf16 v[84:87], a[36:39], a[88:91], v[84:87]
    v_mfma_f32_16x16x32_bf16 v[144:147], a[40:43], a[88:91], v[144:147]
    v_mfma_f32_16x16x32_bf16 v[148:151], a[44:47], a[88:91], v[148:151]
    v_mfma_f32_16x16x32_bf16 v[208:211], a[48:51], a[88:91], v[208:211]
    v_mfma_f32_16x16x32_bf16 v[212:215], a[52:55], a[88:91], v[212:215]
    v_mfma_f32_16x16x32_bf16 a[112:115], a[56:59], a[88:91], a[112:115]
    v_mfma_f32_16x16x32_bf16 a[116:119], a[60:63], a[88:91], a[116:119]
    ds_read_b64_tr_b16 a[88:89], v14 offset:0
    v_mfma_f32_16x16x32_bf16 v[88:91], a[32:35], a[92:95], v[88:91]
    ds_read_b64_tr_b16 a[90:91], v14 offset:2048
    v_mfma_f32_16x16x32_bf16 v[92:95], a[36:39], a[92:95], v[92:95]
    v_mfma_f32_16x16x32_bf16 v[152:155], a[40:43], a[92:95], v[152:155]
    v_mfma_f32_16x16x32_bf16 v[156:159], a[44:47], a[92:95], v[156:159]
    v_mfma_f32_16x16x32_bf16 v[216:219], a[48:51], a[92:95], v[216:219]
    v_mfma_f32_16x16x32_bf16 v[220:223], a[52:55], a[92:95], v[220:223]
    v_mfma_f32_16x16x32_bf16 a[120:123], a[56:59], a[92:95], a[120:123]
    v_mfma_f32_16x16x32_bf16 a[124:127], a[60:63], a[92:95], a[124:127]
    ds_read_b64_tr_b16 a[92:93], v15 offset:0
    ds_read_b64_tr_b16 a[94:95], v15 offset:2048
    s_sub_u32 s65, s65, 1
    s_cmp_lg_u32 s65, 0
    s_cbranch_scc1 mega_kernel_loop18
mega_kernel_epi11:
    s_cmp_eq_u32 s94, 0
    s_cbranch_scc1 mega_kernel_last22
    s_mov_b32 s3, 1048576
mega_kernel_spin26:
    v_readfirstlane_b32 s4, v4
    v_readfirstlane_b32 s5, v5
    s_nop 3
    s_cmp_lg_u32 s4, 0
    s_cbranch_scc1 mega_kernel_ok27
    s_sub_u32 s3, s3, 1
    s_cbranch_scc1 mega_kernel_ok27
    s_sleep 32
    buffer_load_dwordx2 v[4:5], off, s[12:15], 0 sc1
    s_waitcnt vmcnt(0)
    s_branch mega_kernel_spin26
mega_kernel_ok27:
    s_call_b64 s[20:21], mega_kernel_epf21
    s_mov_b32 s17, s101
    s_mov_b32 s95, s82
    s_mov_b32 s96, s83
    s_mov_b32 s97, s84
    s_mov_b32 s98, s85
    s_mov_b32 s99, s86
    s_mov_b32 s100, s87
    s_mov_b32 s101, s88
    s_sub_u32 s67, s95, 2
    s_mov_b32 s94, 0
    s_mov_b32 s66, 0
    s_branch mega_kernel_tile10
mega_kernel_last22:
    s_cmp_eq_u32 s70, 0
    s_cbranch_scc1 mega_kernel_kvl25
    buffer_load_dwordx2 v[4:5], off, s[12:15], 0 sc1
    s_call_b64 s[20:21], mega_kernel_epf21
    s_waitcnt vmcnt(0)
    s_barrier
    s_mov_b32 s3, 1048576
mega_kernel_spin28:
    v_readfirstlane_b32 s4, v4
    v_readfirstlane_b32 s5, v5
    s_nop 3
    s_cmp_lg_u32 s4, 0
    s_cbranch_scc1 mega_kernel_ok29
    s_sub_u32 s3, s3, 1
    s_cbranch_scc1 mega_kernel_ok29
    s_sleep 32
    buffer_load_dwordx2 v[4:5], off, s[12:15], 0 sc1
    s_waitcnt vmcnt(0)
    s_branch mega_kernel_spin28
mega_kernel_ok29:
    s_cmp_lg_u32 s16, 0
    s_cbranch_scc1 mega_kernel_np30
    v_mov_b32 v4, s4
    v_mov_b32 v5, s5
    s_add_u32 s90, s101, 117440512
    s_mov_b64 exec, 1
    buffer_store_dwordx2 v[4:5], off, s[8:11], s90 sc1
    s_mov_b64 exec, -1
mega_kernel_np30:
    s_cmp_lg_u32 s16, 0
    s_cbranch_scc1 mega_kernel_pw31
    s_and_b32 s92, s2, 7
    s_lshl_b32 s92, s92, 2
    s_bfe_u32 s93, s2, 0x20003
    s_add_u32 s92, s92, s93
    s_lshr_b32 s93, s2, 5
    s_lshr_b32 s90, s92, 1
    s_lshl_b32 s90, s90, 7
    s_add_u32 s90, s90, 117440512
    v_min_u32 v0, 13, v1
    v_lshlrev_b32 v0, 3, v0
    buffer_load_dwordx2 v[4:5], v0, s[8:11], s90 offen sc1
    s_waitcnt vmcnt(0)
    s_mov_b32 s3, 1048576
mega_kernel_spin32:
    v_cmp_ne_u64 s[22:23], s[4:5], v[4:5]
    s_nop 3
    s_cmp_eq_u64 s[22:23], 0
    s_cbranch_scc1 mega_kernel_ok33
    s_sub_u32 s3, s3, 1
    s_cbranch_scc1 mega_kernel_ok33
    s_sleep 32
    s_and_b32 s92, s2, 7
    s_lshl_b32 s92, s92, 2
    s_bfe_u32 s93, s2, 0x20003
    s_add_u32 s92, s92, s93
    s_lshr_b32 s93, s2, 5
    s_lshr_b32 s90, s92, 1
    s_lshl_b32 s90, s90, 7
    s_add_u32 s90, s90, 117440512
    v_min_u32 v0, 13, v1
    v_lshlrev_b32 v0, 3, v0
    buffer_load_dwordx2 v[4:5], v0, s[8:11], s90 offen sc1
    s_waitcnt vmcnt(0)
    s_branch mega_kernel_spin32
mega_kernel_ok33:
mega_kernel_pw31:
    s_barrier
    s_and_b32 s92, s2, 7
    s_lshl_b32 s92, s92, 2
    s_bfe_u32 s93, s2, 0x20003
    s_add_u32 s92, s92, s93
    s_lshr_b32 s93, s2, 5
    s_sub_u32 s90, 14, s93
    s_cmp_eq_u32 s93, 7
    s_cselect_b32 s90, 15, s90
    s_lshl_b32 s90, s90, 3
    s_lshl_b32 s91, s16, 1
    s_add_u32 s90, s90, s91
    s_lshl_b32 s90, s90, 12
    s_lshl_b32 s91, s92, 19
    s_add_u32 s90, s90, s91
    s_add_u32 s90, s90, 0
    buffer_load_dwordx4 a[128:131], v2, s[8:11], s90 offen offset:0 sc1
    buffer_load_dwordx4 a[132:135], v2, s[8:11], s90 offen offset:1024 sc1
    buffer_load_dwordx4 a[136:139], v2, s[8:11], s90 offen offset:2048 sc1
    buffer_load_dwordx4 a[140:143], v2, s[8:11], s90 offen offset:3072 sc1
    s_sub_u32 s90, 14, s93
    s_cmp_eq_u32 s93, 7
    s_cselect_b32 s90, 15, s90
    s_lshl_b32 s90, s90, 3
    s_lshl_b32 s91, s16, 1
    s_add_u32 s90, s90, s91
    s_lshl_b32 s90, s90, 12
    s_lshl_b32 s91, s92, 19
    s_add_u32 s90, s90, s91
    s_add_u32 s90, s90, 4096
    buffer_load_dwordx4 a[144:147], v2, s[8:11], s90 offen offset:0 sc1
    buffer_load_dwordx4 a[148:151], v2, s[8:11], s90 offen offset:1024 sc1
    buffer_load_dwordx4 a[152:155], v2, s[8:11], s90 offen offset:2048 sc1
    buffer_load_dwordx4 a[156:159], v2, s[8:11], s90 offen offset:3072 sc1
    s_lshl_b32 s90, s93, 3
    s_lshl_b32 s91, s16, 1
    s_add_u32 s90, s90, s91
    s_lshl_b32 s90, s90, 12
    s_lshl_b32 s91, s92, 19
    s_add_u32 s90, s90, s91
    s_add_u32 s90, s90, 0
    buffer_load_dwordx4 a[160:163], v2, s[8:11], s90 offen offset:0 sc1
    buffer_load_dwordx4 a[164:167], v2, s[8:11], s90 offen offset:1024 sc1
    buffer_load_dwordx4 a[168:171], v2, s[8:11], s90 offen offset:2048 sc1
    buffer_load_dwordx4 a[172:175], v2, s[8:11], s90 offen offset:3072 sc1
    s_lshl_b32 s90, s93, 3
    s_lshl_b32 s91, s16, 1
    s_add_u32 s90, s90, s91
    s_lshl_b32 s90, s90, 12
    s_lshl_b32 s91, s92, 19
    s_add_u32 s90, s90, s91
    s_add_u32 s90, s90, 4096
    buffer_load_dwordx4 a[176:179], v2, s[8:11], s90 offen offset:0 sc1
    buffer_load_dwordx4 a[180:183], v2, s[8:11], s90 offen offset:1024 sc1
    buffer_load_dwordx4 a[184:187], v2, s[8:11], s90 offen offset:2048 sc1
    buffer_load_dwordx4 a[188:191], v2, s[8:11], s90 offen offset:3072 sc1
    s_mov_b32 s94, 1
mega_kernel_kvl25:
    s_waitcnt vmcnt(0) lgkmcnt(0)
    s_barrier
    s_and_b32 s92, s2, 7
    s_lshl_b32 s92, s92, 2
    s_bfe_u32 s93, s2, 0x20003
    s_add_u32 s92, s92, s93
    s_lshr_b32 s93, s2, 5
    s_mov_b32 s32, s92
    s_add_u32 s34, s93, 1
    s_sub_u32 s33, 15, s93
    s_cmp_eq_u32 s93, 7
    s_cselect_b32 s33, 16, s33
    s_lshl_b32 s56, s16, 12
    v_add_u32 v7, s56, v2
    s_lshl_b32 s90, s34, 2
    s_lshl_b32 s91, s33, 2
    s_lshl_b32 s26, s91, 13
    s_mov_b32 s30, s26
    s_sub_u32 s63, s90, 4
    s_add_u32 s63, s63, s16
    s_add_u32 s64, s63, 1
    s_mov_b32 s65, s90
    s_sub_u32 s66, s91, 4
    s_add_u32 s66, s66, s16
    s_add_u32 s67, s66, 1
    s_mov_b32 s68, s91
    s_mov_b32 s27, 0x20000
    s_mov_b32 s31, 0x20000
    s_lshl_b32 s78, s32, 19
    s_add_u32 s90, s78, 16777216
    s_add_u32 s24, s6, s90
    s_addc_u32 s25, s7, 0
    s_add_u32 s90, s78, 33554432
    s_add_u32 s28, s6, s90
    s_addc_u32 s29, s7, 0
    s_mov_b32 s52, 0
    s_mov_b32 s53, 0
    s_mov_b32 m0, s56
    s_nop 0
    buffer_load_dwordx4 v7, s[24:27], s52 offen offset:0 sc1 lds
    buffer_load_dwordx4 v7, s[24:27], s52 offen offset:1024 sc1 lds
    buffer_load_dwordx4 v7, s[24:27], s52 offen offset:2048 sc1 lds
    buffer_load_dwordx4 v7, s[24:27], s52 offen offset:3072 sc1 lds
    s_mov_b32 s52, 16384
    s_add_u32 s55, s56, 32768
    s_mov_b32 m0, s55
    s_nop 0
    buffer_load_dwordx4 v7, s[24:27], s52 offen offset:0 sc1 lds
    buffer_load_dwordx4 v7, s[24:27], s52 offen offset:1024 sc1 lds
    buffer_load_dwordx4 v7, s[24:27], s52 offen offset:2048 sc1 lds
    buffer_load_dwordx4 v7, s[24:27], s52 offen offset:3072 sc1 lds
    s_add_u32 s52, s52, 16384
    s_add_u32 m0, s55, 16384
    s_nop 0
    buffer_load_dwordx4 v7, s[28:31], s53 offen offset:0 sc1 lds
    buffer_load_dwordx4 v7, s[28:31], s53 offen offset:1024 sc1 lds
    buffer_load_dwordx4 v7, s[28:31], s53 offen offset:2048 sc1 lds
    buffer_load_dwordx4 v7, s[28:31], s53 offen offset:3072 sc1 lds
    s_add_u32 s53, s53, 16384
    s_add_u32 s55, s55, 32768
    s_mov_b32 m0, s55
    s_nop 0
    buffer_load_dwordx4 v7, s[24:27], s52 offen offset:0 sc1 lds
    buffer_load_dwordx4 v7, s[24:27], s52 offen offset:1024 sc1 lds
    buffer_load_dwordx4 v7, s[24:27], s52 offen offset:2048 sc1 lds
    buffer_load_dwordx4 v7, s[24:27], s52 offen offset:3072 sc1 lds
    s_add_u32 s52, s52, 16384
    s_add_u32 m0, s55, 16384
    s_nop 0
    buffer_load_dwordx4 v7, s[28:31], s53 offen offset:0 sc1 lds
    buffer_load_dwordx4 v7, s[28:31], s53 offen offset:1024 sc1 lds
    buffer_load_dwordx4 v7, s[28:31], s53 offen offset:2048 sc1 lds
    buffer_load_dwordx4 v7, s[28:31], s53 offen offset:3072 sc1 lds
    s_add_u32 s53, s53, 16384
    s_add_u32 s55, s55, 32768
    s_mov_b32 m0, s55
    s_nop 0
    buffer_load_dwordx4 v7, s[24:27], s52 offen offset:0 sc1 lds
    buffer_load_dwordx4 v7, s[24:27], s52 offen offset:1024 sc1 lds
    buffer_load_dwordx4 v7, s[24:27], s52 offen offset:2048 sc1 lds
    buffer_load_dwordx4 v7, s[24:27], s52 offen offset:3072 sc1 lds
    s_add_u32 s52, s52, 16384
    s_add_u32 m0, s55, 16384
    s_nop 0
    buffer_load_dwordx4 v7, s[28:31], s53 offen offset:0 sc1 lds
    buffer_load_dwordx4 v7, s[28:31], s53 offen offset:1024 sc1 lds
    buffer_load_dwordx4 v7, s[28:31], s53 offen offset:2048 sc1 lds
    buffer_load_dwordx4 v7, s[28:31], s53 offen offset:3072 sc1 lds
    s_add_u32 s53, s53, 16384
    s_add_u32 s55, s55, 32768
    s_cmp_eq_u32 s94, 1
    s_cbranch_scc1 mega_kernel_w055
    s_call_b64 s[20:21], mega_kernel_epl53
    s_mov_b32 s17, s101
    s_mov_b32 s38, 268435456
    s_branch mega_kernel_init24
mega_kernel_w055:
    s_waitcnt vmcnt(0)
    s_mov_b32 s38, 0
mega_kernel_init24:
    s_nop 1
    v_mov_b32 v9, 0xff800000
    s_mov_b32 s61, 1233125376
    s_lshl_b32 s91, s16, 1
    s_sub_u32 s91, s91, 8
    s_lshl_b32 s74, s33, 3
    s_add_u32 s74, s74, s91
    s_lshl_b32 s75, s34, 3
    s_add_u32 s75, s75, s91
    s_mov_b32 s36, s6
    s_mov_b32 s37, s7
    s_mov_b32 s39, 0x20000
    s_load_dwordx2 s[48:49], s[0:1], 64
    s_load_dwordx2 s[50:51], s[0:1], 16
    s_mov_b32 s47, 0x20000
    s_lshl_b32 s90, s99, 1
    s_add_u32 s98, s98, s90
    s_lshl_b32 s90, s100, 2
    s_add_u32 s40, s98, s90
    s_lshr_b32 s90, s32, 1
    s_lshl_b32 s90, s90, 7
    s_add_u32 s90, s90, 117444608
    s_lshr_b32 s91, s2, 6
    s_lshl_b32 s91, s91, 8
    s_add_u32 s91, s91, 117446592
    v_min_u32 v10, 31, v1
    v_lshlrev_b32 v10, 3, v10
    v_mov_b32 v11, s90
    v_mov_b32 v8, s91
    v_cmp_gt_u32 vcc, 8, v1
    s_nop 1
    v_cndmask_b32 v11, v8, v11, vcc
    v_add_u32 v10, v10, v11
    s_lshl_b32 s90, s16, 8
    s_add_u32 s90, s90, s2
    s_cmp_ge_u32 s90, 128
    s_cbranch_scc1 mega_kernel_c356
    s_lshl_b32 s90, s90, 7
    s_add_u32 s90, s90, 117506048
    v_mov_b32 v8, 0
    s_mov_b64 exec, 1
    buffer_store_dword v8, off, s[8:11], s90 sc1
    s_mov_b64 exec, -1
mega_kernel_c356:
    s_mov_b32 s54, 0
    v_mov_b32 v6, v2
    v_accvgpr_write_b32 a0, 0
    v_accvgpr_write_b32 a1, 0
    v_accvgpr_write_b32 a2, 0
    v_accvgpr_write_b32 a3, 0
    v_accvgpr_write_b32 a4, 0
    v_accvgpr_write_b32 a5, 0
    v_accvgpr_write_b32 a6, 0
    v_accvgpr_write_b32 a7, 0
    v_accvgpr_write_b32 a8, 0
    v_accvgpr_write_b32 a9, 0
    v_accvgpr_write_b32 a10, 0
    v_accvgpr_write_b32 a11, 0
    v_accvgpr_write_b32 a12, 0
    v_accvgpr_write_b32 a13, 0
    v_accvgpr_write_b32 a14, 0
    v_accvgpr_write_b32 a15, 0
    v_accvgpr_write_b32 a16, 0
    v_accvgpr_write_b32 a17, 0
    v_accvgpr_write_b32 a18, 0
    v_accvgpr_write_b32 a19, 0
    v_accvgpr_write_b32 a20, 0
    v_accvgpr_write_b32 a21, 0
    v_accvgpr_write_b32 a22, 0
    v_accvgpr_write_b32 a23, 0
    v_accvgpr_write_b32 a24, 0
    v_accvgpr_write_b32 a25, 0
    v_accvgpr_write_b32 a26, 0
    v_accvgpr_write_b32 a27, 0
    v_accvgpr_write_b32 a28, 0
    v_accvgpr_write_b32 a29, 0
    v_accvgpr_write_b32 a30, 0
    v_accvgpr_write_b32 a31, 0
    v_accvgpr_write_b32 a32, 0
    v_accvgpr_write_b32 a33, 0
    v_accvgpr_write_b32 a34, 0
    v_accvgpr_write_b32 a35, 0
    v_accvgpr_write_b32 a36, 0
    v_accvgpr_write_b32 a37, 0
    v_accvgpr_write_b32 a38, 0
    v_accvgpr_write_b32 a39, 0
    v_accvgpr_write_b32 a40, 0
    v_accvgpr_write_b32 a41, 0
    v_accvgpr_write_b32 a42, 0
    v_accvgpr_write_b32 a43, 0
    v_accvgpr_write_b32 a44, 0
    v_accvgpr_write_b32 a45, 0
    v_accvgpr_write_b32 a46, 0
    v_accvgpr_write_b32 a47, 0
    v_accvgpr_write_b32 a48, 0
    v_accvgpr_write_b32 a49, 0
    v_accvgpr_write_b32 a50, 0
    v_accvgpr_write_b32 a51, 0
    v_accvgpr_write_b32 a52, 0
    v_accvgpr_write_b32 a53, 0
    v_accvgpr_write_b32 a54, 0
    v_accvgpr_write_b32 a55, 0
    v_accvgpr_write_b32 a56, 0
    v_accvgpr_write_b32 a57, 0
    v_accvgpr_write_b32 a58, 0
    v_accvgpr_write_b32 a59, 0
    v_accvgpr_write_b32 a60, 0
    v_accvgpr_write_b32 a61, 0
    v_accvgpr_write_b32 a62, 0
    v_accvgpr_write_b32 a63, 0
    v_accvgpr_write_b32 a64, 0
    v_accvgpr_write_b32 a65, 0
    v_accvgpr_write_b32 a66, 0
    v_accvgpr_write_b32 a67, 0
    v_accvgpr_write_b32 a68, 0
    v_accvgpr_write_b32 a69, 0
    v_accvgpr_write_b32 a70, 0
    v_accvgpr_write_b32 a71, 0
    v_accvgpr_write_b32 a72, 0
    v_accvgpr_write_b32 a73, 0
    v_accvgpr_write_b32 a74, 0
    v_accvgpr_write_b32 a75, 0
    v_accvgpr_write_b32 a76, 0
    v_accvgpr_write_b32 a77, 0
    v_accvgpr_write_b32 a78, 0
    v_accvgpr_write_b32 a79, 0
    v_accvgpr_write_b32 a80, 0
    v_accvgpr_write_b32 a81, 0
    v_accvgpr_write_b32 a82, 0
    v_accvgpr_write_b32 a83, 0
    v_accvgpr_write_b32 a84, 0
    v_accvgpr_write_b32 a85, 0
    v_accvgpr_write_b32 a86, 0
    v_accvgpr_write_b32 a87, 0
    v_accvgpr_write_b32 a88, 0
    v_accvgpr_write_b32 a89, 0
    v_accvgpr_write_b32 a90, 0
    v_accvgpr_write_b32 a91, 0
    v_accvgpr_write_b32 a92, 0
    v_accvgpr_write_b32 a93, 0
    v_accvgpr_write_b32 a94, 0
    v_accvgpr_write_b32 a95, 0
    v_accvgpr_write_b32 a96, 0
    v_accvgpr_write_b32 a97, 0
    v_accvgpr_write_b32 a98, 0
    v_accvgpr_write_b32 a99, 0
    v_accvgpr_write_b32 a100, 0
    v_accvgpr_write_b32 a101, 0
    v_accvgpr_write_b32 a102, 0
    v_accvgpr_write_b32 a103, 0
    v_accvgpr_write_b32 a104, 0
    v_accvgpr_write_b32 a105, 0
    v_accvgpr_write_b32 a106, 0
    v_accvgpr_write_b32 a107, 0
    v_accvgpr_write_b32 a108, 0
    v_accvgpr_write_b32 a109, 0
    v_accvgpr_write_b32 a110, 0
    v_accvgpr_write_b32 a111, 0
    v_accvgpr_write_b32 a112, 0
    v_accvgpr_write_b32 a113, 0
    v_accvgpr_write_b32 a114, 0
    v_accvgpr_write_b32 a115, 0
    v_accvgpr_write_b32 a116, 0
    v_accvgpr_write_b32 a117, 0
    v_accvgpr_write_b32 a118, 0
    v_accvgpr_write_b32 a119, 0
    v_accvgpr_write_b32 a120, 0
    v_accvgpr_write_b32 a121, 0
    v_accvgpr_write_b32 a122, 0
    v_accvgpr_write_b32 a123, 0
    v_accvgpr_write_b32 a124, 0
    v_accvgpr_write_b32 a125, 0
    v_accvgpr_write_b32 a126, 0
    v_accvgpr_write_b32 a127, 0
    v_mov_b32 v160, 0
    v_mov_b32 v161, 0
    v_mov_b32 v162, 0
    v_mov_b32 v163, 0
    v_mov_b32 v164, 0
    v_mov_b32 v165, 0
    v_mov_b32 v166, 0
    v_mov_b32 v167, 0
    v_mov_b32 v168, 0
    v_mov_b32 v169, 0
    v_mov_b32 v170, 0
    v_mov_b32 v171, 0
    v_mov_b32 v172, 0
    v_mov_b32 v173, 0
    v_mov_b32 v174, 0
    v_mov_b32 v175, 0
    v_mov_b32 v176, 0
    v_mov_b32 v177, 0
    v_mov_b32 v178, 0
    v_mov_b32 v179, 0
    v_mov_b32 v180, 0
    v_mov_b32 v181, 0
    v_mov_b32 v182, 0
    v_mov_b32 v183, 0
    v_mov_b32 v184, 0
    v_mov_b32 v185, 0
    v_mov_b32 v186, 0
    v_mov_b32 v187, 0
    v_mov_b32 v188, 0
    v_mov_b32 v189, 0
    v_mov_b32 v190, 0
    v_mov_b32 v191, 0
    v_mov_b32 v12, 0
    v_mov_b32 v28, 0
    v_mov_b32 v44, 0x3f803f80
    v_mov_b32 v13, 0
    v_mov_b32 v32, 0
    v_mov_b32 v45, 0x3f803f80
    v_mov_b32 v14, 0
    v_mov_b32 v36, 0
    v_mov_b32 v46, 0x3f803f80
    v_mov_b32 v15, 0
    v_mov_b32 v40, 0
    v_mov_b32 v47, 0x3f803f80
    s_and_b32 s90, s2, 7
    s_lshl_b32 s90, s90, 4
    s_lshl_b32 s91, s16, 2
    s_add_u32 s76, s90, s91
    s_lshr_b32 s92, s2, 3
    s_lshl_b32 s92, s92, 17
    s_lshl_b32 s90, s76, 10
    s_add_u32 s90, s90, s92
    s_add_u32 s79, s90, 50331648
    s_add_u32 s80, s90, 54525952
    s_and_b32 s77, s76, 63
    s_cmp_eq_u32 s77, 0
    s_cselect_b32 s93, 0, 1024
    s_sub_u32 s81, s80, s93
    s_lshl_b32 s90, s76, 9
    s_add_u32 s90, s90, s92
    s_add_u32 s82, s90, 58720256
    s_sub_u32 s83, s82, s93
    s_add_u32 s84, s82, 65536
    s_add_u32 s85, s83, 65536
    v_and_b32 v48, 15, v1
    v_lshrrev_b32 v49, 4, v1
    v_lshlrev_b32 v49, 2, v49
    v_sub_u32 v48, v48, v49
    v_cmp_le_i32 vcc, 0, v48
    s_nop 1
    v_cndmask_b32 v16, v9, 0, vcc
    v_cmp_le_i32 vcc, 1, v48
    s_nop 1
    v_cndmask_b32 v17, v9, 0, vcc
    v_cmp_le_i32 vcc, 2, v48
    s_nop 1
    v_cndmask_b32 v18, v9, 0, vcc
    v_cmp_le_i32 vcc, 3, v48
    s_nop 1
    v_cndmask_b32 v19, v9, 0, vcc
    s_mov_b32 s58, 35791400
    s_mov_b32 s59, 0
    s_sub_u32 s90, s63, 1
    s_bitset1_b64 s[58:59], s90
    s_sub_u32 s90, s64, 1
    s_bitset1_b64 s[58:59], s90
    s_sub_u32 s90, s65, 1
    s_bitset1_b64 s[58:59], s90
    s_sub_u32 s90, s66, 1
    s_bitset1_b64 s[58:59], s90
    s_sub_u32 s90, s67, 1
    s_bitset1_b64 s[58:59], s90
    s_sub_u32 s90, s68, 1
    s_bitset1_b64 s[58:59], s90
    s_mov_b32 s60, 0
    s_cmp_lg_u32 s60, s63
    s_cbranch_scc1 mega_kernel_e61
    v_add_f32 v176, v176, v16
    v_mov_b32 v180, v9
    v_add_f32 v188, v188, v16
    v_add_f32 v177, v177, v17
    v_mov_b32 v181, v9
    v_add_f32 v189, v189, v17
    v_add_f32 v178, v178, v18
    v_mov_b32 v182, v9
    v_add_f32 v190, v190, v18
    v_add_f32 v179, v179, v19
    v_mov_b32 v183, v9
    v_add_f32 v191, v191, v19
    s_nop 0
mega_kernel_e61:
    s_waitcnt vmcnt(40) lgkmcnt(0)
    s_barrier
    ds_read_b128 a[192:195], v6 offset:0
    ds_read_b128 a[196:199], v6 offset:1024
    ds_read_b128 a[200:203], v6 offset:2048
    ds_read_b128 a[204:207], v6 offset:3072
    ds_read_b128 a[208:211], v6 offset:4096
    ds_read_b128 a[212:215], v6 offset:5120
    ds_read_b128 a[216:219], v6 offset:6144
    ds_read_b128 a[220:223], v6 offset:7168
    s_waitcnt lgkmcnt(0)
    v_mfma_f32_16x16x32_bf16 v[64:67], a[192:195], a[128:131], v[160:163]
    v_mfma_f32_16x16x32_bf16 v[64:67], a[196:199], a[132:135], v[64:67]
    v_mfma_f32_16x16x32_bf16 v[64:67], a[200:203], a[136:139], v[64:67]
    v_mfma_f32_16x16x32_bf16 v[64:67], a[204:207], a[140:143], v[64:67]
    buffer_store_dwordx4 v[192:195], v2, s[36:39], s40 offen sc1
    s_add_u32 s40, s40, s100
    v_mfma_f32_16x16x32_bf16 v[72:75], a[192:195], a[144:147], v[168:171]
    v_mfma_f32_16x16x32_bf16 v[72:75], a[196:199], a[148:151], v[72:75]
    v_mfma_f32_16x16x32_bf16 v[72:75], a[200:203], a[152:155], v[72:75]
    v_mfma_f32_16x16x32_bf16 v[72:75], a[204:207], a[156:159], v[72:75]
    v_mfma_f32_16x16x32_bf16 v[80:83], a[192:195], a[160:163], v[176:179]
    v_mfma_f32_16x16x32_bf16 v[80:83], a[196:199], a[164:167], v[80:83]
    v_mfma_f32_16x16x32_bf16 v[80:83], a[200:203], a[168:171], v[80:83]
    v_mfma_f32_16x16x32_bf16 v[80:83], a[204:207], a[172:175], v[80:83]
    buffer_store_dwordx4 v[196:199], v2, s[36:39], s40 offen sc1
    s_add_u32 s40, s40, s100
    v_mfma_f32_16x16x32_bf16 v[88:91], a[192:195], a[176:179], v[184:187]
    v_mfma_f32_16x16x32_bf16 v[88:91], a[196:199], a[180:183], v[88:91]
    v_mfma_f32_16x16x32_bf16 v[88:91], a[200:203], a[184:187], v[88:91]
    v_mfma_f32_16x16x32_bf16 v[88:91], a[204:207], a[188:191], v[88:91]
    v_mfma_f32_16x16x32_bf16 v[68:71], a[208:211], a[128:131], v[164:167]
    ds_read_b128 a[192:195], v6 offset:8192
    v_mfma_f32_16x16x32_bf16 v[68:71], a[212:215], a[132:135], v[68:71]
    ds_read_b128 a[196:199], v6 offset:9216
    v_mfma_f32_16x16x32_bf16 v[68:71], a[216:219], a[136:139], v[68:71]
    ds_read_b128 a[200:203], v6 offset:10240
    v_mfma_f32_16x16x32_bf16 v[68:71], a[220:223], a[140:143], v[68:71]
    buffer_store_dwordx4 v[200:203], v2, s[36:39], s40 offen sc1
    s_add_u32 s40, s40, s100
    ds_read_b128 a[204:207], v6 offset:11264
    v_mfma_f32_16x16x32_bf16 v[76:79], a[208:211], a[144:147], v[172:175]
    v_mfma_f32_16x16x32_bf16 v[76:79], a[212:215], a[148:151], v[76:79]
    v_mfma_f32_16x16x32_bf16 v[76:79], a[216:219], a[152:155], v[76:79]
    v_mfma_f32_16x16x32_bf16 v[76:79], a[220:223], a[156:159], v[76:79]
    v_mfma_f32_16x16x32_bf16 v[84:87], a[208:211], a[160:163], v[180:183]
    v_mfma_f32_16x16x32_bf16 v[84:87], a[212:215], a[164:167], v[84:87]
    v_mfma_f32_16x16x32_bf16 v[84:87], a[216:219], a[168:171], v[84:87]
    v_mfma_f32_16x16x32_bf16 v[84:87], a[220:223], a[172:175], v[84:87]
    buffer_store_dwordx4 v[204:207], v2, s[36:39], s40 offen sc1
    s_add_u32 s40, s98, s99
    v_mfma_f32_16x16x32_bf16 v[92:95], a[208:211], a[176:179], v[188:191]
    v_mfma_f32_16x16x32_bf16 v[92:95], a[212:215], a[180:183], v[92:95]
    v_mfma_f32_16x16x32_bf16 v[92:95], a[216:219], a[184:187], v[92:95]
    v_mfma_f32_16x16x32_bf16 v[92:95], a[220:223], a[188:191], v[92:95]
    ds_read_b128 a[208:211], v6 offset:12288
    ds_read_b128 a[212:215], v6 offset:13312
    ds_read_b128 a[216:219], v6 offset:14336
    ds_read_b128 a[220:223], v6 offset:15360
    s_mov_b32 s60, 1
    s_nop 0
    s_nop 3
    v_max3_f32 v48, v64, v65, v66
    v_max3_f32 v49, v72, v73, v74
    v_max3_f32 v50, v80, v81, v82
    v_max3_f32 v51, v88, v89, v90
    v_max3_f32 v48, v48, v67, v68
    v_max3_f32 v49, v49, v75, v76
    v_max3_f32 v50, v50, v83, v84
    v_max3_f32 v51, v51, v91, v92
    v_max3_f32 v48, v48, v69, v70
    v_max3_f32 v49, v49, v77, v78
    v_max3_f32 v50, v50, v85, v86
    v_max3_f32 v51, v51, v93, v94
    v_max_f32 v48, v48, v71
    v_max_f32 v49, v49, v79
    v_max_f32 v50, v50, v87
    v_max_f32 v51, v51, v95
    v_mov_b32 v52, v48
    v_mov_b32 v53, v49
    v_mov_b32 v54, v50
    v_mov_b32 v55, v51
    s_nop 1
    v_permlane32_swap_b32 v48, v52
    v_permlane32_swap_b32 v49, v53
    v_permlane32_swap_b32 v50, v54
    v_permlane32_swap_b32 v51, v55
    s_nop 1
    v_max_f32 v48, v48, v52
    v_max_f32 v49, v49, v53
    v_max_f32 v50, v50, v54
    v_max_f32 v51, v51, v55
    v_mov_b32 v52, v48
    v_mov_b32 v53, v49
    v_mov_b32 v54, v50
    v_mov_b32 v55, v51
    s_nop 1
    v_permlane16_swap_b32 v48, v52
    v_permlane16_swap_b32 v49, v53
    v_permlane16_swap_b32 v50, v54
    v_permlane16_swap_b32 v51, v55
    s_nop 1
    v_max_f32 v48, v48, v52
    v_max_f32 v49, v49, v53
    v_max_f32 v50, v50, v54
    v_max_f32 v51, v51, v55
    v_sub_f32 v160, v160, v48
    v_sub_f32 v161, v161, v48
    v_sub_f32 v162, v162, v48
    v_sub_f32 v163, v163, v48
    v_sub_f32 v164, v164, v48
    v_sub_f32 v165, v165, v48
    v_sub_f32 v166, v166, v48
    v_sub_f32 v167, v167, v48
    v_sub_f32 v168, v168, v49
    v_sub_f32 v169, v169, v49
    v_sub_f32 v170, v170, v49
    v_sub_f32 v171, v171, v49
    v_sub_f32 v172, v172, v49
    v_sub_f32 v173, v173, v49
    v_sub_f32 v174, v174, v49
    v_sub_f32 v175, v175, v49
    v_sub_f32 v176, v176, v50
    v_sub_f32 v177, v177, v50
    v_sub_f32 v178, v178, v50
    v_sub_f32 v179, v179, v50
    v_sub_f32 v180, v180, v50
    v_sub_f32 v181, v181, v50
    v_sub_f32 v182, v182, v50
    v_sub_f32 v183, v183, v50
    v_sub_f32 v184, v184, v51
    v_sub_f32 v185, v185, v51
    v_sub_f32 v186, v186, v51
    v_sub_f32 v187, v187, v51
    v_sub_f32 v188, v188, v51
    v_sub_f32 v189, v189, v51
    v_sub_f32 v190, v190, v51
    v_sub_f32 v191, v191, v51
    v_sub_f32 v64, v64, v48
    v_sub_f32 v65, v65, v48
    v_sub_f32 v66, v66, v48
    v_sub_f32 v67, v67, v48
    v_sub_f32 v68, v68, v48
    v_sub_f32 v69, v69, v48
    v_sub_f32 v70, v70, v48
    v_sub_f32 v71, v71, v48
    v_sub_f32 v72, v72, v49
    v_sub_f32 v73, v73, v49
    v_sub_f32 v74, v74, v49
    v_sub_f32 v75, v75, v49
    v_sub_f32 v76, v76, v49
    v_sub_f32 v77, v77, v49
    v_sub_f32 v78, v78, v49
    v_sub_f32 v79, v79, v49
    v_sub_f32 v80, v80, v50
    v_sub_f32 v81, v81, v50
    v_sub_f32 v82, v82, v50
    v_sub_f32 v83, v83, v50
    v_sub_f32 v84, v84, v50
    v_sub_f32 v85, v85, v50
    v_sub_f32 v86, v86, v50
    v_sub_f32 v87, v87, v50
    v_sub_f32 v88, v88, v51
    v_sub_f32 v89, v89, v51
    v_sub_f32 v90, v90, v51
    v_sub_f32 v91, v91, v51
    v_sub_f32 v92, v92, v51
    v_sub_f32 v93, v93, v51
    v_sub_f32 v94, v94, v51
    v_sub_f32 v95, v95, v51
    s_cmp_lg_u32 s60, s63
    s_cbranch_scc1 mega_kernel_e62
    v_add_f32 v176, v176, v16
    v_mov_b32 v180, v9
    v_add_f32 v188, v188, v16
    v_add_f32 v177, v177, v17
    v_mov_b32 v181, v9
    v_add_f32 v189, v189, v17
    v_add_f32 v178, v178, v18
    v_mov_b32 v182, v9
    v_add_f32 v190, v190, v18
    v_add_f32 v179, v179, v19
    v_mov_b32 v183, v9
    v_add_f32 v191, v191, v19
    s_nop 0
mega_kernel_e62:
    s_cmp_lg_u32 s60, s64
    s_cbranch_scc1 mega_kernel_e63
    v_mov_b32 v176, v9
    v_mov_b32 v184, v9
    v_mov_b32 v188, v9
    v_mov_b32 v177, v9
    v_mov_b32 v185, v9
    v_mov_b32 v189, v9
    v_mov_b32 v178, v9
    v_mov_b32 v186, v9
    v_mov_b32 v190, v9
    v_mov_b32 v179, v9
    v_mov_b32 v187, v9
    v_mov_b32 v191, v9
    s_nop 0
mega_kernel_e63:
    s_waitcnt lgkmcnt(0)
    v_mfma_f32_16x16x32_bf16 v[96:99], a[192:195], a[128:131], v[160:163]
    s_bitcmp1_b64 s[58:59], s60
    s_cselect_b32 s62, -1.0, s61
    v_exp_f32 v20, v64
    v_mfma_f32_16x16x32_bf16 v[96:99], a[196:199], a[132:135], v[96:99]
    s_add_u32 s60, s60, 1
    v_exp_f32 v21, v65
    v_add_f32 v12, v12, v28
    v_mfma_f32_16x16x32_bf16 v[96:99], a[200:203], a[136:139], v[96:99]
    v_exp_f32 v22, v66
    v_cvt_pk_bf16_f32 v128, v20, v21
    v_mfma_f32_16x16x32_bf16 v[96:99], a[204:207], a[140:143], v[96:99]
    buffer_store_dwordx4 v[208:211], v2, s[36:39], s40 offen sc1
    v_add_f32 v13, v13, v32
    v_mfma_f32_16x16x32_bf16 v[104:107], a[192:195], a[144:147], v[168:171]
    s_add_u32 s40, s40, s100
    v_exp_f32 v23, v67
    v_add_f32 v14, v14, v36
    v_mfma_f32_16x16x32_bf16 v[104:107], a[196:199], a[148:151], v[104:107]
    v_exp_f32 v24, v68
    v_cvt_pk_bf16_f32 v129, v22, v23
    v_mfma_f32_16x16x32_bf16 v[104:107], a[200:203], a[152:155], v[104:107]
    v_exp_f32 v25, v69
    v_add_f32 v15, v15, v40
    v_mfma_f32_16x16x32_bf16 v[104:107], a[204:207], a[156:159], v[104:107]
    v_exp_f32 v26, v70
    v_cvt_pk_bf16_f32 v130, v24, v25
    v_mfma_f32_16x16x32_bf16 v[112:115], a[192:195], a[160:163], v[176:179]
    v_exp_f32 v27, v71
    v_mfma_f32_16x16x32_bf16 v[112:115], a[196:199], a[164:167], v[112:115]
    v_exp_f32 v20, v72
    v_cvt_pk_bf16_f32 v131, v26, v27
    v_mfma_f32_16x16x32_bf16 v[112:115], a[200:203], a[168:171], v[112:115]
    buffer_store_dwordx4 v[212:215], v2, s[36:39], s40 offen sc1
    v_exp_f32 v21, v73
    v_mfma_f32_16x16x32_bf16 v[28:31], v[44:47], v[128:131], 0
    v_exp_f32 v22, v74
    v_cvt_pk_bf16_f32 v132, v20, v21
    v_mfma_f32_16x16x32_bf16 v[112:115], a[204:207], a[172:175], v[112:115]
    s_add_u32 s40, s40, s100
    v_exp_f32 v23, v75
    v_mfma_f32_16x16x32_bf16 v[120:123], a[192:195], a[176:179], v[184:187]
    v_exp_f32 v24, v76
    v_cvt_pk_bf16_f32 v133, v22, v23
    v_mfma_f32_16x16x32_bf16 v[120:123], a[196:199], a[180:183], v[120:123]
    v_exp_f32 v25, v77
    v_exp_f32 v26, v78
    v_mfma_f32_16x16x32_bf16 v[120:123], a[200:203], a[184:187], v[120:123]
    v_cvt_pk_bf16_f32 v134, v24, v25
    v_exp_f32 v27, v79
    v_mfma_f32_16x16x32_bf16 v[120:123], a[204:207], a[188:191], v[120:123]
    s_waitcnt lgkmcnt(0)
    v_exp_f32 v20, v80
    v_cvt_pk_bf16_f32 v135, v26, v27
    v_mfma_f32_16x16x32_bf16 v[100:103], a[208:211], a[128:131], v[164:167]
    v_exp_f32 v21, v81
    v_mfma_f32_16x16x32_bf16 v[32:35], v[44:47], v[132:135], 0
    v_exp_f32 v22, v82
    v_cvt_pk_bf16_f32 v136, v20, v21
    v_mfma_f32_16x16x32_bf16 v[100:103], a[212:215], a[132:135], v[100:103]
    v_exp_f32 v23, v83
    v_exp_f32 v24, v84
    v_mfma_f32_16x16x32_bf16 v[100:103], a[216:219], a[136:139], v[100:103]
    buffer_store_dwordx4 v[216:219], v2, s[36:39], s40 offen sc1
    v_cvt_pk_bf16_f32 v137, v22, v23
    v_mfma_f32_16x16x32_bf16 v[100:103], a[220:223], a[140:143], v[100:103]
    s_add_u32 s40, s40, s100
    v_exp_f32 v25, v85
    v_mfma_f32_16x16x32_bf16 v[108:111], a[208:211], a[144:147], v[172:175]
    v_exp_f32 v26, v86
    v_cvt_pk_bf16_f32 v138, v24, v25
    v_mfma_f32_16x16x32_bf16 v[108:111], a[212:215], a[148:151], v[108:111]
    v_exp_f32 v27, v87
    v_exp_f32 v20, v88
    v_mfma_f32_16x16x32_bf16 v[108:111], a[216:219], a[152:155], v[108:111]
    v_cvt_pk_bf16_f32 v139, v26, v27
    v_exp_f32 v21, v89
    v_mfma_f32_16x16x32_bf16 v[108:111], a[220:223], a[156:159], v[108:111]
    v_exp_f32 v22, v90
    v_cvt_pk_bf16_f32 v140, v20, v21
    v_mfma_f32_16x16x32_bf16 v[36:39], v[44:47], v[136:139], 0
    v_exp_f32 v23, v91
    v_mfma_f32_16x16x32_bf16 v[116:119], a[208:211], a[160:163], v[180:183]
    v_exp_f32 v24, v92
    v_cvt_pk_bf16_f32 v141, v22, v23
    v_mfma_f32_16x16x32_bf16 v[116:119], a[212:215], a[164:167], v[116:119]
    buffer_store_dwordx4 v[220:223], v2, s[36:39], s40 offen sc1
    v_exp_f32 v25, v93
    v_mfma_f32_16x16x32_bf16 v[116:119], a[216:219], a[168:171], v[116:119]
    s_add_u32 s40, s40, s100
    v_exp_f32 v26, v94
    v_cvt_pk_bf16_f32 v142, v24, v25
    v_mfma_f32_16x16x32_bf16 v[116:119], a[220:223], a[172:175], v[116:119]
    v_exp_f32 v27, v95
    s_nop 0
    v_cvt_pk_bf16_f32 v143, v26, v27
    s_nop 1
    v_mfma_f32_16x16x32_bf16 v[40:43], v[44:47], v[140:143], 0
    s_nop 2
    v_mfma_f32_16x16x32_bf16 v[124:127], a[208:211], a[176:179], v[188:191]
    s_nop 2
    v_mfma_f32_16x16x32_bf16 v[124:127], a[212:215], a[180:183], v[124:127]
    v_max3_f32 v8, v28, v32, v36
    v_max_f32 v8, v8, v40
    v_mfma_f32_16x16x32_bf16 v[124:127], a[216:219], a[184:187], v[124:127]
    v_cmp_nge_f32 vcc, s62, v8
    v_mfma_f32_16x16x32_bf16 v[124:127], a[220:223], a[188:191], v[124:127]
    s_waitcnt vmcnt(40) lgkmcnt(0)
    s_barrier
    s_add_u32 s55, s54, s56
    s_add_u32 s54, s54, 32768
    s_and_b32 s54, s54, 0x1ffff
    v_add_u32 v6, s54, v2
    ds_read_b128 a[192:195], v6 offset:0
    ds_read_b128 a[196:199], v6 offset:1024
    ds_read_b128 a[200:203], v6 offset:2048
    ds_read_b128 a[204:207], v6 offset:3072
    ds_read_b128 a[208:211], v6 offset:4096
    ds_read_b128 a[212:215], v6 offset:5120
    ds_read_b128 a[216:219], v6 offset:6144
    ds_read_b128 a[220:223], v6 offset:7168
    s_waitcnt lgkmcnt(0)
    s_cbranch_vccnz mega_kernel_stub64
mega_kernel_ret65:
mega_kernel_dual66:
    v_mfma_f32_16x16x32_bf16 v[64:67], a[192:195], a[128:131], v[160:163]
    s_bitcmp1_b64 s[58:59], s60
    s_cselect_b32 s62, -1.0, s61
    v_add_f32 v12, v12, v28
    v_mfma_f32_16x16x32_bf16 v[64:67], a[196:199], a[132:135], v[64:67]
    s_add_u32 s60, s60, 1
    ds_read_b128 a[224:227], v6 offset:16384
    v_add_f32 v13, v13, v32
    v_mfma_f32_16x16x32_bf16 v[64:67], a[200:203], a[136:139], v[64:67]
    v_exp_f32 v20, v96
    v_mfma_f32_16x16x32_bf16 v[64:67], a[204:207], a[140:143], v[64:67]
    v_exp_f32 v21, v97
    v_mfma_f32_16x16x32_bf16 v[72:75], a[192:195], a[144:147], v[168:171]
    s_mov_b32 m0, s55
    ds_read_b128 a[228:231], v6 offset:17408
    v_cvt_pk_bf16_f32 v144, v20, v21
    v_mfma_f32_16x16x32_bf16 v[72:75], a[196:199], a[148:151], v[72:75]
    buffer_load_dwordx4 v7, s[24:27], s52 offen offset:0 sc1 lds
    v_mfma_f32_16x16x32_bf16 v[72:75], a[200:203], a[152:155], v[72:75]
    v_exp_f32 v22, v98
    v_mfma_f32_16x16x32_bf16 v[72:75], a[204:207], a[156:159], v[72:75]
    ds_read_b128 a[232:235], v6 offset:18432
    v_add_f32 v14, v14, v36
    v_mfma_f32_16x16x32_bf16 v[80:83], a[192:195], a[160:163], v[176:179]
    v_exp_f32 v23, v99
    v_mfma_f32_16x16x32_bf16 v[80:83], a[196:199], a[164:167], v[80:83]
    v_exp_f32 v24, v100
    v_mfma_f32_16x16x32_bf16 v[80:83], a[200:203], a[168:171], v[80:83]
    ds_read_b128 a[236:239], v6 offset:19456
    v_cvt_pk_bf16_f32 v145, v22, v23
    v_mfma_f32_16x16x32_bf16 v[80:83], a[204:207], a[172:175], v[80:83]
    v_exp_f32 v25, v101
    v_mfma_f32_16x16x32_bf16 v[88:91], a[192:195], a[176:179], v[184:187]
    v_exp_f32 v26, v102
    v_mfma_f32_16x16x32_bf16 v[88:91], a[196:199], a[180:183], v[88:91]
    ds_read_b128 a[240:243], v6 offset:20480
    v_cvt_pk_bf16_f32 v146, v24, v25
    v_mfma_f32_16x16x32_bf16 v[88:91], a[200:203], a[184:187], v[88:91]
    v_exp_f32 v27, v103
    v_mfma_f32_16x16x32_bf16 v[88:91], a[204:207], a[188:191], v[88:91]
    s_waitcnt lgkmcnt(5)
    v_exp_f32 v20, v104
    v_mfma_f32_16x16x32_bf16 v[68:71], a[208:211], a[128:131], v[164:167]
    ds_read_b128 a[244:247], v6 offset:21504
    v_cvt_pk_bf16_f32 v147, v26, v27
    v_mfma_f32_16x16x32_bf16 v[68:71], a[212:215], a[132:135], v[68:71]
    v_exp_f32 v21, v105
    v_mfma_f32_16x16x32_bf16 v[28:31], v[44:47], v[144:147], 0
    v_exp_f32 v22, v106
    v_mfma_f32_16x16x32_bf16 v[68:71], a[216:219], a[136:139], v[68:71]
    buffer_load_dwordx4 v7, s[24:27], s52 offen offset:1024 sc1 lds
    v_mfma_f32_16x16x32_bf16 v[68:71], a[220:223], a[140:143], v[68:71]
    ds_read_b128 a[248:251], v6 offset:22528
    v_cvt_pk_bf16_f32 v148, v20, v21
    v_mfma_f32_16x16x32_bf16 v[76:79], a[208:211], a[144:147], v[172:175]
    v_exp_f32 v23, v107
    v_mfma_f32_16x16x32_bf16 v[76:79], a[212:215], a[148:151], v[76:79]
    v_exp_f32 v24, v108
    v_mfma_f32_16x16x32_bf16 v[76:79], a[216:219], a[152:155], v[76:79]
    ds_read_b128 a[252:255], v6 offset:23552
    v_cvt_pk_bf16_f32 v149, v22, v23
    v_mfma_f32_16x16x32_bf16 v[76:79], a[220:223], a[156:159], v[76:79]
    v_exp_f32 v25, v109
    v_mfma_f32_16x16x32_bf16 v[84:87], a[208:211], a[160:163], v[180:183]
    v_exp_f32 v26, v110
    v_mfma_f32_16x16x32_bf16 v[84:87], a[212:215], a[164:167], v[84:87]
    v_cvt_pk_bf16_f32 v150, v24, v25
    v_add_f32 v15, v15, v40
    v_mfma_f32_16x16x32_bf16 v[84:87], a[216:219], a[168:171], v[84:87]
    v_exp_f32 v27, v111
    v_mfma_f32_16x16x32_bf16 v[84:87], a[220:223], a[172:175], v[84:87]
    buffer_load_dwordx4 v7, s[24:27], s52 offen offset:2048 sc1 lds
    v_mfma_f32_16x16x32_bf16 v[92:95], a[208:211], a[176:179], v[188:191]
    v_exp_f32 v20, v112
    v_mfma_f32_16x16x32_bf16 v[92:95], a[212:215], a[180:183], v[92:95]
    v_cvt_pk_bf16_f32 v151, v26, v27
    v_mfma_f32_16x16x32_bf16 v[92:95], a[216:219], a[184:187], v[92:95]
    v_exp_f32 v21, v113
    v_mfma_f32_16x16x32_bf16 v[32:35], v[44:47], v[148:151], 0
    v_exp_f32 v22, v114
    v_mfma_f32_16x16x32_bf16 v[92:95], a[220:223], a[188:191], v[92:95]
    s_waitcnt lgkmcnt(0)
    v_cvt_pk_bf16_f32 v152, v20, v21
    v_mfma_f32_16x16x32_bf16 a[0:3], a[224:227], v[128:131], a[0:3]
    ds_read_b128 a[192:195], v6 offset:8192
    v_mfma_f32_16x16x32_bf16 a[32:35], a[224:227], v[132:135], a[32:35]
    v_exp_f32 v23, v115
    v_mfma_f32_16x16x32_bf16 a[64:67], a[224:227], v[136:139], a[64:67]
    v_exp_f32 v24, v116
    v_mfma_f32_16x16x32_bf16 a[96:99], a[224:227], v[140:143], a[96:99]
    ds_read_b128 a[196:199], v6 offset:9216
    v_cvt_pk_bf16_f32 v153, v22, v23
    v_mfma_f32_16x16x32_bf16 a[4:7], a[228:231], v[128:131], a[4:7]
    v_exp_f32 v25, v117
    v_mfma_f32_16x16x32_bf16 a[36:39], a[228:231], v[132:135], a[36:39]
    v_exp_f32 v26, v118
    v_mfma_f32_16x16x32_bf16 a[68:71], a[228:231], v[136:139], a[68:71]
    ds_read_b128 a[200:203], v6 offset:10240
    v_cvt_pk_bf16_f32 v154, v24, v25
    v_mfma_f32_16x16x32_bf16 a[100:103], a[228:231], v[140:143], a[100:103]
    v_exp_f32 v27, v119
    v_mfma_f32_16x16x32_bf16 a[8:11], a[232:235], v[128:131], a[8:11]
    v_exp_f32 v20, v120
    v_mfma_f32_16x16x32_bf16 a[40:43], a[232:235], v[132:135], a[40:43]
    ds_read_b128 a[204:207], v6 offset:11264
    v_cvt_pk_bf16_f32 v155, v26, v27
    v_mfma_f32_16x16x32_bf16 a[72:75], a[232:235], v[136:139], a[72:75]
    v_exp_f32 v21, v121
    v_mfma_f32_16x16x32_bf16 v[36:39], v[44:47], v[152:155], 0
    v_exp_f32 v22, v122
    v_mfma_f32_16x16x32_bf16 a[104:107], a[232:235], v[140:143], a[104:107]
    buffer_load_dwordx4 v7, s[24:27], s52 offen offset:3072 sc1 lds
    v_mfma_f32_16x16x32_bf16 a[12:15], a[236:239], v[128:131], a[12:15]
    s_add_u32 s52, s52, 16384
    v_cvt_pk_bf16_f32 v156, v20, v21
    v_mfma_f32_16x16x32_bf16 a[44:47], a[236:239], v[132:135], a[44:47]
    v_exp_f32 v23, v123
    v_mfma_f32_16x16x32_bf16 a[76:79], a[236:239], v[136:139], a[76:79]
    v_exp_f32 v24, v124
    v_mfma_f32_16x16x32_bf16 a[108:111], a[236:239], v[140:143], a[108:111]
    v_cvt_pk_bf16_f32 v157, v22, v23
    v_mfma_f32_16x16x32_bf16 a[16:19], a[240:243], v[128:131], a[16:19]
    v_exp_f32 v25, v125
    v_mfma_f32_16x16x32_bf16 a[48:51], a[240:243], v[132:135], a[48:51]
    v_exp_f32 v26, v126
    v_mfma_f32_16x16x32_bf16 a[80:83], a[240:243], v[136:139], a[80:83]
    v_cvt_pk_bf16_f32 v158, v24, v25
    v_mfma_f32_16x16x32_bf16 a[112:115], a[240:243], v[140:143], a[112:115]
    s_add_u32 m0, s55, 16384
    v_exp_f32 v27, v127
    v_mfma_f32_16x16x32_bf16 a[20:23], a[244:247], v[128:131], a[20:23]
    buffer_load_dwordx4 v7, s[28:31], s53 offen offset:0 sc1 lds
    v_mfma_f32_16x16x32_bf16 a[52:55], a[244:247], v[132:135], a[52:55]
    v_cvt_pk_bf16_f32 v159, v26, v27
    v_mfma_f32_16x16x32_bf16 a[84:87], a[244:247], v[136:139], a[84:87]
    v_mfma_f32_16x16x32_bf16 a[116:119], a[244:247], v[140:143], a[116:119]
    v_mfma_f32_16x16x32_bf16 v[40:43], v[44:47], v[156:159], 0
    s_nop 2
    v_mfma_f32_16x16x32_bf16 a[24:27], a[248:251], v[128:131], a[24:27]
    s_nop 2
    v_mfma_f32_16x16x32_bf16 a[56:59], a[248:251], v[132:135], a[56:59]
    v_max3_f32 v8, v28, v32, v36
    v_max_f32 v8, v8, v40
    v_mfma_f32_16x16x32_bf16 a[88:91], a[248:251], v[136:139], a[88:91]
    v_cmp_nge_f32 vcc, s62, v8
    v_mfma_f32_16x16x32_bf16 a[120:123], a[248:251], v[140:143], a[120:123]
    ds_read_b128 a[208:211], v6 offset:12288
    v_mfma_f32_16x16x32_bf16 a[28:31], a[252:255], v[128:131], a[28:31]
    ds_read_b128 a[212:215], v6 offset:13312
    v_mfma_f32_16x16x32_bf16 a[60:63], a[252:255], v[132:135], a[60:63]
    ds_read_b128 a[216:219], v6 offset:14336
    v_mfma_f32_16x16x32_bf16 a[92:95], a[252:255], v[136:139], a[92:95]
    ds_read_b128 a[220:223], v6 offset:15360
    v_mfma_f32_16x16x32_bf16 a[124:127], a[252:255], v[140:143], a[124:127]
    s_waitcnt lgkmcnt(4)
    s_cbranch_vccnz mega_kernel_stub67
mega_kernel_ret68:
    v_mfma_f32_16x16x32_bf16 v[96:99], a[192:195], a[128:131], v[160:163]
    s_add_u32 s55, s54, s56
    v_exp_f32 v20, v64
    v_mfma_f32_16x16x32_bf16 v[96:99], a[196:199], a[132:135], v[96:99]
    s_add_u32 s54, s54, 32768
    ds_read_b128 a[224:227], v6 offset:24576
    v_add_f32 v12, v12, v28
    v_mfma_f32_16x16x32_bf16 v[96:99], a[200:203], a[136:139], v[96:99]
    s_and_b32 s54, s54, 0x1ffff
    v_exp_f32 v21, v65
    v_mfma_f32_16x16x32_bf16 v[96:99], a[204:207], a[140:143], v[96:99]
    s_bitcmp1_b64 s[58:59], s60
    s_cselect_b32 s62, -1.0, s61
    v_cvt_pk_bf16_f32 v128, v20, v21
    v_mfma_f32_16x16x32_bf16 v[104:107], a[192:195], a[144:147], v[168:171]
    s_add_u32 s60, s60, 1
    ds_read_b128 a[228:231], v6 offset:25600
    v_add_f32 v13, v13, v32
    v_mfma_f32_16x16x32_bf16 v[104:107], a[196:199], a[148:151], v[104:107]
    v_exp_f32 v22, v66
    v_mfma_f32_16x16x32_bf16 v[104:107], a[200:203], a[152:155], v[104:107]
    buffer_load_dwordx4 v7, s[28:31], s53 offen offset:1024 sc1 lds
    v_mfma_f32_16x16x32_bf16 v[104:107], a[204:207], a[156:159], v[104:107]
    ds_read_b128 a[232:235], v6 offset:26624
    v_add_f32 v14, v14, v36
    v_mfma_f32_16x16x32_bf16 v[112:115], a[192:195], a[160:163], v[176:179]
    v_exp_f32 v23, v67
    v_mfma_f32_16x16x32_bf16 v[112:115], a[196:199], a[164:167], v[112:115]
    v_exp_f32 v24, v68
    v_mfma_f32_16x16x32_bf16 v[112:115], a[200:203], a[168:171], v[112:115]
    ds_read_b128 a[236:239], v6 offset:27648
    v_cvt_pk_bf16_f32 v129, v22, v23
    v_mfma_f32_16x16x32_bf16 v[112:115], a[204:207], a[172:175], v[112:115]
    v_exp_f32 v25, v69
    v_mfma_f32_16x16x32_bf16 v[120:123], a[192:195], a[176:179], v[184:187]
    v_exp_f32 v26, v70
    v_mfma_f32_16x16x32_bf16 v[120:123], a[196:199], a[180:183], v[120:123]
    ds_read_b128 a[240:243], v6 offset:28672
    v_cvt_pk_bf16_f32 v130, v24, v25
    v_mfma_f32_16x16x32_bf16 v[120:123], a[200:203], a[184:187], v[120:123]
    v_exp_f32 v27, v71
    v_mfma_f32_16x16x32_bf16 v[120:123], a[204:207], a[188:191], v[120:123]
    s_waitcnt lgkmcnt(5)
    v_exp_f32 v20, v72
    v_mfma_f32_16x16x32_bf16 v[100:103], a[208:211], a[128:131], v[164:167]
    ds_read_b128 a[244:247], v6 offset:29696
    v_cvt_pk_bf16_f32 v131, v26, v27
    v_mfma_f32_16x16x32_bf16 v[100:103], a[212:215], a[132:135], v[100:103]
    v_exp_f32 v21, v73
    v_mfma_f32_16x16x32_bf16 v[28:31], v[44:47], v[128:131], 0
    v_exp_f32 v22, v74
    v_mfma_f32_16x16x32_bf16 v[100:103], a[216:219], a[136:139], v[100:103]
    buffer_load_dwordx4 v7, s[28:31], s53 offen offset:2048 sc1 lds
    v_mfma_f32_16x16x32_bf16 v[100:103], a[220:223], a[140:143], v[100:103]
    ds_read_b128 a[248:251], v6 offset:30720
    v_cvt_pk_bf16_f32 v132, v20, v21
    v_mfma_f32_16x16x32_bf16 v[108:111], a[208:211], a[144:147], v[172:175]
    v_exp_f32 v23, v75
    v_mfma_f32_16x16x32_bf16 v[108:111], a[212:215], a[148:151], v[108:111]
    v_exp_f32 v24, v76
    v_mfma_f32_16x16x32_bf16 v[108:111], a[216:219], a[152:155], v[108:111]
    ds_read_b128 a[252:255], v6 offset:31744
    v_cvt_pk_bf16_f32 v133, v22, v23
    v_mfma_f32_16x16x32_bf16 v[108:111], a[220:223], a[156:159], v[108:111]
    v_exp_f32 v25, v77
    v_mfma_f32_16x16x32_bf16 v[116:119], a[208:211], a[160:163], v[180:183]
    v_exp_f32 v26, v78
    v_mfma_f32_16x16x32_bf16 v[116:119], a[212:215], a[164:167], v[116:119]
    v_cvt_pk_bf16_f32 v134, v24, v25
    v_add_f32 v15, v15, v40
    v_mfma_f32_16x16x32_bf16 v[116:119], a[216:219], a[168:171], v[116:119]
    v_exp_f32 v27, v79
    v_mfma_f32_16x16x32_bf16 v[116:119], a[220:223], a[172:175], v[116:119]
    buffer_load_dwordx4 v7, s[28:31], s53 offen offset:3072 sc1 lds
    v_mfma_f32_16x16x32_bf16 v[124:127], a[208:211], a[176:179], v[188:191]
    s_add_u32 s53, s53, 16384
    v_exp_f32 v20, v80
    v_mfma_f32_16x16x32_bf16 v[124:127], a[212:215], a[180:183], v[124:127]
    v_cvt_pk_bf16_f32 v135, v26, v27
    v_mfma_f32_16x16x32_bf16 v[124:127], a[216:219], a[184:187], v[124:127]
    v_exp_f32 v21, v81
    v_mfma_f32_16x16x32_bf16 v[32:35], v[44:47], v[132:135], 0
    v_exp_f32 v22, v82
    v_mfma_f32_16x16x32_bf16 v[124:127], a[220:223], a[188:191], v[124:127]
    s_waitcnt vmcnt(16) lgkmcnt(0)
    v_add_u32 v6, s54, v2
    v_cvt_pk_bf16_f32 v136, v20, v21
    v_mfma_f32_16x16x32_bf16 a[0:3], a[224:227], v[144:147], a[0:3]
    s_barrier
    v_mfma_f32_16x16x32_bf16 a[32:35], a[224:227], v[148:151], a[32:35]
    ds_read_b128 a[192:195], v6 offset:0
    v_mfma_f32_16x16x32_bf16 a[64:67], a[224:227], v[152:155], a[64:67]
    v_exp_f32 v23, v83
    v_mfma_f32_16x16x32_bf16 a[96:99], a[224:227], v[156:159], a[96:99]
    v_exp_f32 v24, v84
    v_mfma_f32_16x16x32_bf16 a[4:7], a[228:231], v[144:147], a[4:7]
    ds_read_b128 a[196:199], v6 offset:1024
    v_cvt_pk_bf16_f32 v137, v22, v23
    v_mfma_f32_16x16x32_bf16 a[36:39], a[228:231], v[148:151], a[36:39]
    v_exp_f32 v25, v85
    v_mfma_f32_16x16x32_bf16 a[68:71], a[228:231], v[152:155], a[68:71]
    v_exp_f32 v26, v86
    v_mfma_f32_16x16x32_bf16 a[100:103], a[228:231], v[156:159], a[100:103]
    ds_read_b128 a[200:203], v6 offset:2048
    v_cvt_pk_bf16_f32 v138, v24, v25
    v_mfma_f32_16x16x32_bf16 a[8:11], a[232:235], v[144:147], a[8:11]
    v_exp_f32 v27, v87
    v_mfma_f32_16x16x32_bf16 a[40:43], a[232:235], v[148:151], a[40:43]
    v_exp_f32 v20, v88
    v_mfma_f32_16x16x32_bf16 a[72:75], a[232:235], v[152:155], a[72:75]
    ds_read_b128 a[204:207], v6 offset:3072
    v_cvt_pk_bf16_f32 v139, v26, v27
    v_mfma_f32_16x16x32_bf16 a[104:107], a[232:235], v[156:159], a[104:107]
    v_exp_f32 v21, v89
    v_mfma_f32_16x16x32_bf16 v[36:39], v[44:47], v[136:139], 0
    v_exp_f32 v22, v90
    v_mfma_f32_16x16x32_bf16 a[12:15], a[236:239], v[144:147], a[12:15]
    v_cvt_pk_bf16_f32 v140, v20, v21
    v_mfma_f32_16x16x32_bf16 a[44:47], a[236:239], v[148:151], a[44:47]
    v_exp_f32 v23, v91
    v_mfma_f32_16x16x32_bf16 a[76:79], a[236:239], v[152:155], a[76:79]
    v_exp_f32 v24, v92
    v_mfma_f32_16x16x32_bf16 a[108:111], a[236:239], v[156:159], a[108:111]
    v_cvt_pk_bf16_f32 v141, v22, v23
    v_mfma_f32_16x16x32_bf16 a[16:19], a[240:243], v[144:147], a[16:19]
    v_exp_f32 v25, v93
    v_mfma_f32_16x16x32_bf16 a[48:51], a[240:243], v[148:151], a[48:51]
    v_exp_f32 v26, v94
    v_mfma_f32_16x16x32_bf16 a[80:83], a[240:243], v[152:155], a[80:83]
    v_cvt_pk_bf16_f32 v142, v24, v25
    v_mfma_f32_16x16x32_bf16 a[112:115], a[240:243], v[156:159], a[112:115]
    v_exp_f32 v27, v95
    v_mfma_f32_16x16x32_bf16 a[20:23], a[244:247], v[144:147], a[20:23]
    v_cvt_pk_bf16_f32 v143, v26, v27
    v_mfma_f32_16x16x32_bf16 a[52:55], a[244:247], v[148:151], a[52:55]
    v_mfma_f32_16x16x32_bf16 a[84:87], a[244:247], v[152:155], a[84:87]
    v_mfma_f32_16x16x32_bf16 v[40:43], v[44:47], v[140:143], 0
    s_nop 2
    v_mfma_f32_16x16x32_bf16 a[116:119], a[244:247], v[156:159], a[116:119]
    s_nop 2
    v_mfma_f32_16x16x32_bf16 a[24:27], a[248:251], v[144:147], a[24:27]
    v_max3_f32 v8, v28, v32, v36
    v_max_f32 v8, v8, v40
    v_mfma_f32_16x16x32_bf16 a[56:59], a[248:251], v[148:151], a[56:59]
    v_cmp_nge_f32 vcc, s62, v8
    v_mfma_f32_16x16x32_bf16 a[88:91], a[248:251], v[152:155], a[88:91]
    v_mfma_f32_16x16x32_bf16 a[120:123], a[248:251], v[156:159], a[120:123]
    ds_read_b128 a[208:211], v6 offset:4096
    v_mfma_f32_16x16x32_bf16 a[28:31], a[252:255], v[144:147], a[28:31]
    ds_read_b128 a[212:215], v6 offset:5120
    v_mfma_f32_16x16x32_bf16 a[60:63], a[252:255], v[148:151], a[60:63]
    ds_read_b128 a[216:219], v6 offset:6144
    v_mfma_f32_16x16x32_bf16 a[92:95], a[252:255], v[152:155], a[92:95]
    ds_read_b128 a[220:223], v6 offset:7168
    v_mfma_f32_16x16x32_bf16 a[124:127], a[252:255], v[156:159], a[124:127]
    s_waitcnt lgkmcnt(4)
    s_cbranch_vccz mega_kernel_dual66
    v_cmp_lt_f32 vcc, s61, v8
    s_cmp_lg_u32 s60, s63
    s_cbranch_scc1 mega_kernel_e70
    v_add_f32 v176, v176, v16
    v_mov_b32 v180, v9
    v_add_f32 v188, v188, v16
    v_add_f32 v177, v177, v17
    v_mov_b32 v181, v9
    v_add_f32 v189, v189, v17
    v_add_f32 v178, v178, v18
    v_mov_b32 v182, v9
    v_add_f32 v190, v190, v18
    v_add_f32 v179, v179, v19
    v_mov_b32 v183, v9
    v_add_f32 v191, v191, v19
    s_nop 0
mega_kernel_e70:
    s_cmp_lg_u32 s60, s64
    s_cbranch_scc1 mega_kernel_e71
    v_mov_b32 v176, v9
    v_mov_b32 v184, v9
    v_mov_b32 v188, v9
    v_mov_b32 v177, v9
    v_mov_b32 v185, v9
    v_mov_b32 v189, v9
    v_mov_b32 v178, v9
    v_mov_b32 v186, v9
    v_mov_b32 v190, v9
    v_mov_b32 v179, v9
    v_mov_b32 v187, v9
    v_mov_b32 v191, v9
    s_nop 0
mega_kernel_e71:
    s_cmp_lg_u32 s60, s66
    s_cbranch_scc1 mega_kernel_e72
    v_add_f32 v160, v160, v16
    v_mov_b32 v164, v9
    v_add_f32 v172, v172, v16
    v_add_f32 v161, v161, v17
    v_mov_b32 v165, v9
    v_add_f32 v173, v173, v17
    v_add_f32 v162, v162, v18
    v_mov_b32 v166, v9
    v_add_f32 v174, v174, v18
    v_add_f32 v163, v163, v19
    v_mov_b32 v167, v9
    v_add_f32 v175, v175, v19
    s_nop 0
mega_kernel_e72:
    s_cmp_gt_u32 s60, 26
    s_cbranch_scc1 mega_kernel_e73
    s_cmp_lg_u32 s60, 4
    s_cbranch_scc1 mega_kernel_e75
    buffer_store_dwordx4 v[224:227], v2, s[36:39], s40 offen sc1
    s_add_u32 s40, s40, s100
    buffer_store_dwordx4 v[228:231], v2, s[36:39], s40 offen sc1
    s_add_u32 s40, s40, s100
    buffer_store_dwordx4 v[232:235], v2, s[36:39], s40 offen sc1
    s_add_u32 s40, s40, s100
    buffer_store_dwordx4 v[236:239], v2, s[36:39], s40 offen sc1
    s_mov_b32 s40, s98
    s_branch mega_kernel_e73
mega_kernel_e75:
    s_cmp_lg_u32 s60, 6
    s_cbranch_scc1 mega_kernel_e76
    buffer_store_dwordx4 v[240:243], v2, s[36:39], s40 offen sc1
    s_add_u32 s40, s40, s100
    buffer_store_dwordx4 v[244:247], v2, s[36:39], s40 offen sc1
    s_add_u32 s40, s40, s100
    buffer_store_dwordx4 v[248:251], v2, s[36:39], s40 offen sc1
    s_add_u32 s40, s40, s100
    buffer_store_dwordx4 v[252:255], v2, s[36:39], s40 offen sc1
    s_add_u32 s40, s40, s100
    s_branch mega_kernel_e73
mega_kernel_e76:
    s_cmp_lg_u32 s60, 10
    s_cbranch_scc1 mega_kernel_e77
    s_cmp_eq_u32 s17, -1
    s_cbranch_scc1 mega_kernel_e73
    s_cmp_lg_u32 s16, 0
    s_cbranch_scc1 mega_kernel_np78
    v_mov_b32 v4, s4
    v_mov_b32 v5, s5
    s_add_u32 s90, s17, 117440512
    s_mov_b64 exec, 1
    buffer_store_dwordx2 v[4:5], off, s[8:11], s90 sc1
    s_mov_b64 exec, -1
mega_kernel_np78:
    s_branch mega_kernel_e73
mega_kernel_e77:
    s_cmp_lg_u32 s60, 14
    s_cbranch_scc1 mega_kernel_e79
    s_lshr_b32 s90, s32, 1
    s_lshl_b32 s90, s90, 7
    s_add_u32 s90, s90, 117442560
    v_min_u32 v0, 1, v1
    v_lshlrev_b32 v0, 3, v0
    buffer_load_dwordx2 v[4:5], v0, s[8:11], s90 offen sc1
    s_mov_b32 s44, s48
    s_mov_b32 s45, s49
    s_mov_b32 s46, 8388608
    s_lshl_b32 s90, s2, 2
    s_add_u32 s90, s90, s16
    s_lshl_b32 s90, s90, 13
    v_lshlrev_b32 v62, 7, v1
    buffer_load_dword v255, v62, s[44:47], s90 offen
    s_branch mega_kernel_e73
mega_kernel_e79:
    s_cmp_lg_u32 s60, 18
    s_cbranch_scc1 mega_kernel_e80
    s_waitcnt vmcnt(16)
    s_mov_b32 s3, 1048576
mega_kernel_spin81:
    v_cmp_ne_u64 s[72:73], s[4:5], v[4:5]
    s_nop 3
    s_cmp_eq_u64 s[72:73], 0
    s_cbranch_scc1 mega_kernel_e73
    s_sub_u32 s3, s3, 1
    s_cbranch_scc1 mega_kernel_e73
    s_sleep 32
    s_lshr_b32 s90, s32, 1
    s_lshl_b32 s90, s90, 7
    s_add_u32 s90, s90, 117442560
    v_min_u32 v0, 1, v1
    v_lshlrev_b32 v0, 3, v0
    buffer_load_dwordx2 v[4:5], v0, s[8:11], s90 offen sc1
    s_waitcnt vmcnt(0)
    s_branch mega_kernel_spin81
    s_branch mega_kernel_e73
mega_kernel_e80:
    s_cmp_lg_u32 s60, 22
    s_cbranch_scc1 mega_kernel_e82
    buffer_load_dwordx2 v[4:5], v10, s[8:11], 0 offen sc1
    s_mov_b32 s44, s50
    s_mov_b32 s45, s51
    s_mov_b32 s46, 2097152
    s_lshl_b32 s90, s2, 2
    s_add_u32 s90, s90, s16
    s_lshl_b32 s90, s90, 13
    v_lshlrev_b32 v62, 7, v1
    buffer_load_dword v255, v62, s[44:47], s90 offen
    s_branch mega_kernel_e73
mega_kernel_e82:
    s_cmp_lg_u32 s60, 26
    s_cbranch_scc1 mega_kernel_e83
    s_waitcnt vmcnt(16)
    s_mov_b32 s3, 1048576
mega_kernel_spin84:
    v_cmp_ne_u64 s[72:73], s[4:5], v[4:5]
    s_nop 3
    s_cmp_eq_u64 s[72:73], 0
    s_cbranch_scc1 mega_kernel_e73
    s_sub_u32 s3, s3, 1
    s_cbranch_scc1 mega_kernel_e73
    s_sleep 32
    buffer_load_dwordx2 v[4:5], v10, s[8:11], 0 offen sc1
    s_waitcnt vmcnt(0)
    s_branch mega_kernel_spin84
    s_branch mega_kernel_e73
mega_kernel_e83:
mega_kernel_e73:
    s_cbranch_vccnz mega_kernel_rc85
mega_kernel_sp69:
    s_cmp_lg_u32 s60, s65
    s_cbranch_scc1 mega_kernel_dual66
    v_mfma_f32_16x16x32_bf16 v[64:67], a[192:195], a[128:131], v[160:163]
    s_bitcmp1_b64 s[58:59], s60
    s_cselect_b32 s62, -1.0, s61
    v_add_f32 v12, v12, v28
    v_mfma_f32_16x16x32_bf16 v[64:67], a[196:199], a[132:135], v[64:67]
    s_add_u32 s60, s60, 1
    ds_read_b128 a[224:227], v6 offset:16384
    v_exp_f32 v20, v96
    v_mfma_f32_16x16x32_bf16 v[64:67], a[200:203], a[136:139], v[64:67]
    s_mov_b32 m0, s55
    ds_read_b128 a[228:231], v6 offset:17408
    v_add_f32 v13, v13, v32
    v_mfma_f32_16x16x32_bf16 v[64:67], a[204:207], a[140:143], v[64:67]
    buffer_load_dwordx4 v7, s[24:27], s52 offen offset:0 sc1 lds
    v_mfma_f32_16x16x32_bf16 v[72:75], a[192:195], a[144:147], v[168:171]
    ds_read_b128 a[232:235], v6 offset:18432
    v_add_f32 v14, v14, v36
    v_mfma_f32_16x16x32_bf16 v[72:75], a[196:199], a[148:151], v[72:75]
    ds_read_b128 a[236:239], v6 offset:19456
    v_exp_f32 v21, v97
    v_mfma_f32_16x16x32_bf16 v[72:75], a[200:203], a[152:155], v[72:75]
    ds_read_b128 a[240:243], v6 offset:20480
    v_cvt_pk_bf16_f32 v144, v20, v21
    v_mfma_f32_16x16x32_bf16 v[72:75], a[204:207], a[156:159], v[72:75]
    s_waitcnt lgkmcnt(5)
    ds_read_b128 a[244:247], v6 offset:21504
    v_add_f32 v15, v15, v40
    v_mfma_f32_16x16x32_bf16 v[68:71], a[208:211], a[128:131], v[164:167]
    ds_read_b128 a[248:251], v6 offset:22528
    v_exp_f32 v22, v98
    v_mfma_f32_16x16x32_bf16 v[68:71], a[212:215], a[132:135], v[68:71]
    ds_read_b128 a[252:255], v6 offset:23552
    v_exp_f32 v23, v99
    v_mfma_f32_16x16x32_bf16 v[68:71], a[216:219], a[136:139], v[68:71]
    v_exp_f32 v24, v100
    v_mfma_f32_16x16x32_bf16 v[68:71], a[220:223], a[140:143], v[68:71]
    buffer_load_dwordx4 v7, s[24:27], s52 offen offset:1024 sc1 lds
    v_mfma_f32_16x16x32_bf16 v[76:79], a[208:211], a[144:147], v[172:175]
    v_cvt_pk_bf16_f32 v145, v22, v23
    v_exp_f32 v25, v101
    v_mfma_f32_16x16x32_bf16 v[76:79], a[212:215], a[148:151], v[76:79]
    v_exp_f32 v26, v102
    v_mfma_f32_16x16x32_bf16 v[76:79], a[216:219], a[152:155], v[76:79]
    v_cvt_pk_bf16_f32 v146, v24, v25
    v_exp_f32 v27, v103
    v_mfma_f32_16x16x32_bf16 v[76:79], a[220:223], a[156:159], v[76:79]
    s_waitcnt lgkmcnt(0)
    v_exp_f32 v20, v104
    v_mfma_f32_16x16x32_bf16 a[0:3], a[224:227], v[128:131], a[0:3]
    ds_read_b128 a[192:195], v6 offset:8192
    v_cvt_pk_bf16_f32 v147, v26, v27
    v_mfma_f32_16x16x32_bf16 a[32:35], a[224:227], v[132:135], a[32:35]
    v_exp_f32 v21, v105
    v_mfma_f32_16x16x32_bf16 v[28:31], v[44:47], v[144:147], 0
    v_exp_f32 v22, v106
    v_mfma_f32_16x16x32_bf16 a[64:67], a[224:227], v[136:139], a[64:67]
    v_cvt_pk_bf16_f32 v148, v20, v21
    v_exp_f32 v23, v107
    v_mfma_f32_16x16x32_bf16 a[96:99], a[224:227], v[140:143], a[96:99]
    ds_read_b128 a[196:199], v6 offset:9216
    v_cvt_pk_bf16_f32 v149, v22, v23
    v_mfma_f32_16x16x32_bf16 a[4:7], a[228:231], v[128:131], a[4:7]
    v_exp_f32 v24, v108
    v_mfma_f32_16x16x32_bf16 a[36:39], a[228:231], v[132:135], a[36:39]
    buffer_load_dwordx4 v7, s[24:27], s52 offen offset:2048 sc1 lds
    v_mfma_f32_16x16x32_bf16 a[68:71], a[228:231], v[136:139], a[68:71]
    ds_read_b128 a[200:203], v6 offset:10240
    v_exp_f32 v25, v109
    v_mfma_f32_16x16x32_bf16 a[100:103], a[228:231], v[140:143], a[100:103]
    v_exp_f32 v26, v110
    v_mfma_f32_16x16x32_bf16 a[8:11], a[232:235], v[128:131], a[8:11]
    v_cvt_pk_bf16_f32 v150, v24, v25
    v_exp_f32 v27, v111
    v_mfma_f32_16x16x32_bf16 a[40:43], a[232:235], v[132:135], a[40:43]
    ds_read_b128 a[204:207], v6 offset:11264
    v_cvt_pk_bf16_f32 v151, v26, v27
    v_mfma_f32_16x16x32_bf16 a[72:75], a[232:235], v[136:139], a[72:75]
    v_exp_f32 v20, v112
    v_mfma_f32_16x16x32_bf16 v[32:35], v[44:47], v[148:151], 0
    v_exp_f32 v21, v113
    v_mfma_f32_16x16x32_bf16 a[104:107], a[232:235], v[140:143], a[104:107]
    v_exp_f32 v22, v114
    v_mfma_f32_16x16x32_bf16 a[12:15], a[236:239], v[128:131], a[12:15]
    v_cvt_pk_bf16_f32 v152, v20, v21
    v_exp_f32 v23, v115
    v_mfma_f32_16x16x32_bf16 a[44:47], a[236:239], v[132:135], a[44:47]
    v_exp_f32 v24, v116
    v_mfma_f32_16x16x32_bf16 a[76:79], a[236:239], v[136:139], a[76:79]
    v_cvt_pk_bf16_f32 v153, v22, v23
    v_exp_f32 v25, v117
    v_mfma_f32_16x16x32_bf16 a[108:111], a[236:239], v[140:143], a[108:111]
    buffer_load_dwordx4 v7, s[24:27], s52 offen offset:3072 sc1 lds
    v_mfma_f32_16x16x32_bf16 a[16:19], a[240:243], v[128:131], a[16:19]
    s_add_u32 s52, s52, 16384
    v_exp_f32 v26, v118
    v_mfma_f32_16x16x32_bf16 a[48:51], a[240:243], v[132:135], a[48:51]
    v_cvt_pk_bf16_f32 v154, v24, v25
    v_exp_f32 v27, v119
    v_mfma_f32_16x16x32_bf16 a[80:83], a[240:243], v[136:139], a[80:83]
    v_exp_f32 v20, v120
    v_mfma_f32_16x16x32_bf16 a[112:115], a[240:243], v[140:143], a[112:115]
    v_cvt_pk_bf16_f32 v155, v26, v27
    v_exp_f32 v21, v121
    v_mfma_f32_16x16x32_bf16 a[20:23], a[244:247], v[128:131], a[20:23]
    v_exp_f32 v22, v122
    v_mfma_f32_16x16x32_bf16 v[36:39], v[44:47], v[152:155], 0
    v_cvt_pk_bf16_f32 v156, v20, v21
    v_mfma_f32_16x16x32_bf16 a[52:55], a[244:247], v[132:135], a[52:55]
    v_exp_f32 v23, v123
    v_mfma_f32_16x16x32_bf16 a[84:87], a[244:247], v[136:139], a[84:87]
    v_exp_f32 v24, v124
    v_cvt_pk_bf16_f32 v157, v22, v23
    v_mfma_f32_16x16x32_bf16 a[116:119], a[244:247], v[140:143], a[116:119]
    v_exp_f32 v25, v125
    v_mfma_f32_16x16x32_bf16 a[24:27], a[248:251], v[128:131], a[24:27]
    s_add_u32 m0, s55, 16384
    v_exp_f32 v26, v126
    v_mfma_f32_16x16x32_bf16 a[56:59], a[248:251], v[132:135], a[56:59]
    buffer_load_dwordx4 v7, s[28:31], s53 offen offset:0 sc1 lds
    v_mfma_f32_16x16x32_bf16 a[88:91], a[248:251], v[136:139], a[88:91]
    v_cvt_pk_bf16_f32 v158, v24, v25
    v_exp_f32 v27, v127
    v_mfma_f32_16x16x32_bf16 a[120:123], a[248:251], v[140:143], a[120:123]
    ds_read_b128 a[208:211], v6 offset:12288
    v_cvt_pk_bf16_f32 v159, v26, v27
    s_nop 1
    v_mfma_f32_16x16x32_bf16 v[40:43], v[44:47], v[156:159], 0
    s_nop 2
    v_mfma_f32_16x16x32_bf16 a[28:31], a[252:255], v[128:131], a[28:31]
    ds_read_b128 a[212:215], v6 offset:13312
    s_nop 0
    v_mfma_f32_16x16x32_bf16 a[60:63], a[252:255], v[132:135], a[60:63]
    ds_read_b128 a[216:219], v6 offset:14336
    v_max3_f32 v8, v28, v32, v36
    v_mfma_f32_16x16x32_bf16 a[92:95], a[252:255], v[136:139], a[92:95]
    ds_read_b128 a[220:223], v6 offset:15360
    v_max_f32 v8, v8, v40
    v_cmp_nge_f32 vcc, s62, v8
    v_mfma_f32_16x16x32_bf16 a[124:127], a[252:255], v[140:143], a[124:127]
    s_waitcnt lgkmcnt(4)
    s_cbranch_vccnz mega_kernel_stub86
mega_kernel_ret87:
    v_mfma_f32_16x16x32_bf16 v[96:99], a[192:195], a[128:131], v[160:163]
    s_add_u32 s55, s54, s56
    v_exp_f32 v20, v64
    v_mfma_f32_16x16x32_bf16 v[96:99], a[196:199], a[132:135], v[96:99]
    s_add_u32 s54, s54, 32768
    ds_read_b128 a[224:227], v6 offset:24576
    v_add_f32 v12, v12, v28
    v_mfma_f32_16x16x32_bf16 v[96:99], a[200:203], a[136:139], v[96:99]
    s_and_b32 s54, s54, 0x1ffff
    ds_read_b128 a[228:231], v6 offset:25600
    v_add_f32 v13, v13, v32
    v_mfma_f32_16x16x32_bf16 v[96:99], a[204:207], a[140:143], v[96:99]
    buffer_load_dwordx4 v7, s[28:31], s53 offen offset:1024 sc1 lds
    v_mfma_f32_16x16x32_bf16 v[104:107], a[192:195], a[144:147], v[168:171]
    s_bitcmp1_b64 s[58:59], s60
    s_cselect_b32 s62, -1.0, s61
    ds_read_b128 a[232:235], v6 offset:26624
    v_mfma_f32_16x16x32_bf16 v[104:107], a[196:199], a[148:151], v[104:107]
    s_add_u32 s60, s60, 1
    ds_read_b128 a[236:239], v6 offset:27648
    v_mfma_f32_16x16x32_bf16 v[104:107], a[200:203], a[152:155], v[104:107]
    ds_read_b128 a[240:243], v6 offset:28672
    v_mfma_f32_16x16x32_bf16 v[104:107], a[204:207], a[156:159], v[104:107]
    s_waitcnt lgkmcnt(5)
    ds_read_b128 a[244:247], v6 offset:29696
    v_mfma_f32_16x16x32_bf16 v[100:103], a[208:211], a[128:131], v[164:167]
    buffer_load_dwordx4 v7, s[28:31], s53 offen offset:2048 sc1 lds
    v_mfma_f32_16x16x32_bf16 v[100:103], a[212:215], a[132:135], v[100:103]
    ds_read_b128 a[248:251], v6 offset:30720
    v_mfma_f32_16x16x32_bf16 v[100:103], a[216:219], a[136:139], v[100:103]
    ds_read_b128 a[252:255], v6 offset:31744
    v_mfma_f32_16x16x32_bf16 v[100:103], a[220:223], a[140:143], v[100:103]
    v_exp_f32 v21, v65
    v_mfma_f32_16x16x32_bf16 v[108:111], a[208:211], a[144:147], v[172:175]
    v_exp_f32 v22, v66
    v_mfma_f32_16x16x32_bf16 v[108:111], a[212:215], a[148:151], v[108:111]
    buffer_load_dwordx4 v7, s[28:31], s53 offen offset:3072 sc1 lds
    v_mfma_f32_16x16x32_bf16 v[108:111], a[216:219], a[152:155], v[108:111]
    s_add_u32 s53, s53, 16384
    v_cvt_pk_bf16_f32 v128, v20, v21
    v_mfma_f32_16x16x32_bf16 v[108:111], a[220:223], a[156:159], v[108:111]
    s_waitcnt vmcnt(16) lgkmcnt(0)
    v_add_u32 v6, s54, v2
    v_mfma_f32_16x16x32_bf16 a[0:3], a[224:227], v[144:147], a[0:3]
    s_barrier
    v_mfma_f32_16x16x32_bf16 a[32:35], a[224:227], v[148:151], a[32:35]
    ds_read_b128 a[192:195], v6 offset:0
    v_mfma_f32_16x16x32_bf16 a[64:67], a[224:227], v[152:155], a[64:67]
    v_exp_f32 v23, v67
    v_mfma_f32_16x16x32_bf16 a[96:99], a[224:227], v[156:159], a[96:99]
    v_exp_f32 v24, v68
    v_mfma_f32_16x16x32_bf16 a[4:7], a[228:231], v[144:147], a[4:7]
    ds_read_b128 a[196:199], v6 offset:1024
    v_cvt_pk_bf16_f32 v129, v22, v23
    v_mfma_f32_16x16x32_bf16 a[36:39], a[228:231], v[148:151], a[36:39]
    v_exp_f32 v25, v69
    v_mfma_f32_16x16x32_bf16 a[68:71], a[228:231], v[152:155], a[68:71]
    v_exp_f32 v26, v70
    v_mfma_f32_16x16x32_bf16 a[100:103], a[228:231], v[156:159], a[100:103]
    ds_read_b128 a[200:203], v6 offset:2048
    v_cvt_pk_bf16_f32 v130, v24, v25
    v_mfma_f32_16x16x32_bf16 a[8:11], a[232:235], v[144:147], a[8:11]
    v_exp_f32 v27, v71
    v_mfma_f32_16x16x32_bf16 a[40:43], a[232:235], v[148:151], a[40:43]
    v_exp_f32 v20, v72
    v_mfma_f32_16x16x32_bf16 a[72:75], a[232:235], v[152:155], a[72:75]
    ds_read_b128 a[204:207], v6 offset:3072
    v_cvt_pk_bf16_f32 v131, v26, v27
    v_mfma_f32_16x16x32_bf16 a[104:107], a[232:235], v[156:159], a[104:107]
    v_exp_f32 v21, v73
    v_mfma_f32_16x16x32_bf16 v[28:31], v[44:47], v[128:131], 0
    v_exp_f32 v22, v74
    v_mfma_f32_16x16x32_bf16 a[12:15], a[236:239], v[144:147], a[12:15]
    v_cvt_pk_bf16_f32 v132, v20, v21
    v_mfma_f32_16x16x32_bf16 a[44:47], a[236:239], v[148:151], a[44:47]
    v_exp_f32 v23, v75
    v_mfma_f32_16x16x32_bf16 a[76:79], a[236:239], v[152:155], a[76:79]
    v_exp_f32 v24, v76
    v_mfma_f32_16x16x32_bf16 a[108:111], a[236:239], v[156:159], a[108:111]
    v_cvt_pk_bf16_f32 v133, v22, v23
    v_mfma_f32_16x16x32_bf16 a[16:19], a[240:243], v[144:147], a[16:19]
    v_exp_f32 v25, v77
    v_mfma_f32_16x16x32_bf16 a[48:51], a[240:243], v[148:151], a[48:51]
    v_exp_f32 v26, v78
    v_mfma_f32_16x16x32_bf16 a[80:83], a[240:243], v[152:155], a[80:83]
    v_cvt_pk_bf16_f32 v134, v24, v25
    v_mfma_f32_16x16x32_bf16 a[112:115], a[240:243], v[156:159], a[112:115]
    v_exp_f32 v27, v79
    v_mfma_f32_16x16x32_bf16 a[20:23], a[244:247], v[144:147], a[20:23]
    v_cvt_pk_bf16_f32 v135, v26, v27
    v_mfma_f32_16x16x32_bf16 a[52:55], a[244:247], v[148:151], a[52:55]
    v_mfma_f32_16x16x32_bf16 a[84:87], a[244:247], v[152:155], a[84:87]
    v_mfma_f32_16x16x32_bf16 v[32:35], v[44:47], v[132:135], 0
    s_nop 2
    v_mfma_f32_16x16x32_bf16 a[116:119], a[244:247], v[156:159], a[116:119]
    s_nop 2
    v_mfma_f32_16x16x32_bf16 a[24:27], a[248:251], v[144:147], a[24:27]
    v_max_f32 v8, v28, v32
    v_cmp_nge_f32 vcc, s62, v8
    v_mfma_f32_16x16x32_bf16 a[56:59], a[248:251], v[148:151], a[56:59]
    v_mfma_f32_16x16x32_bf16 a[88:91], a[248:251], v[152:155], a[88:91]
    v_mfma_f32_16x16x32_bf16 a[120:123], a[248:251], v[156:159], a[120:123]
    ds_read_b128 a[208:211], v6 offset:4096
    v_mfma_f32_16x16x32_bf16 a[28:31], a[252:255], v[144:147], a[28:31]
    ds_read_b128 a[212:215], v6 offset:5120
    v_mfma_f32_16x16x32_bf16 a[60:63], a[252:255], v[148:151], a[60:63]
    ds_read_b128 a[216:219], v6 offset:6144
    v_mfma_f32_16x16x32_bf16 a[92:95], a[252:255], v[152:155], a[92:95]
    ds_read_b128 a[220:223], v6 offset:7168
    v_mfma_f32_16x16x32_bf16 a[124:127], a[252:255], v[156:159], a[124:127]
    s_waitcnt lgkmcnt(4)
    s_cbranch_vccnz mega_kernel_stub88
mega_kernel_ret89:
    v_add_f32 v20, v14, v36
    v_add_f32 v21, v15, v40
    s_nop 3
    v_rcp_f32 v20, v20
    v_rcp_f32 v21, v21
    s_lshl_b32 s90, s75, 10
    s_add_u32 s90, s90, s78
    s_add_u32 s90, s90, 67108864
    v_accvgpr_read_b32 v48, a64
    v_accvgpr_read_b32 v49, a65
    v_accvgpr_read_b32 v50, a66
    v_accvgpr_read_b32 v51, a67
    v_accvgpr_read_b32 v52, a68
    v_accvgpr_read_b32 v53, a69
    v_accvgpr_read_b32 v54, a70
    v_accvgpr_read_b32 v55, a71
    v_mul_f32 v48, v20, v48
    v_mul_f32 v49, v20, v49
    v_mul_f32 v50, v20, v50
    v_mul_f32 v51, v20, v51
    v_mul_f32 v52, v20, v52
    v_mul_f32 v53, v20, v53
    v_mul_f32 v54, v20, v54
    v_mul_f32 v55, v20, v55
    v_cvt_pk_bf16_f32 v48, v48, v49
    v_cvt_pk_bf16_f32 v49, v50, v51
    v_cvt_pk_bf16_f32 v50, v52, v53
    v_cvt_pk_bf16_f32 v51, v54, v55
    buffer_store_dwordx4 v[48:51], v2, s[8:11], s90 offen offset:0 sc1
    v_accvgpr_read_b32 v56, a96
    v_accvgpr_read_b32 v57, a97
    v_accvgpr_read_b32 v58, a98
    v_accvgpr_read_b32 v59, a99
    v_accvgpr_read_b32 v60, a100
    v_accvgpr_read_b32 v61, a101
    v_accvgpr_read_b32 v62, a102
    v_accvgpr_read_b32 v63, a103
    v_mul_f32 v56, v21, v56
    v_mul_f32 v57, v21, v57
    v_mul_f32 v58, v21, v58
    v_mul_f32 v59, v21, v59
    v_mul_f32 v60, v21, v60
    v_mul_f32 v61, v21, v61
    v_mul_f32 v62, v21, v62
    v_mul_f32 v63, v21, v63
    v_cvt_pk_bf16_f32 v56, v56, v57
    v_cvt_pk_bf16_f32 v57, v58, v59
    v_cvt_pk_bf16_f32 v58, v60, v61
    v_cvt_pk_bf16_f32 v59, v62, v63
    buffer_store_dwordx4 v[56:59], v2, s[8:11], s90 offen offset:1024 sc1
    s_add_u32 s90, s90, 131072
    v_accvgpr_read_b32 v48, a72
    v_accvgpr_read_b32 v49, a73
    v_accvgpr_read_b32 v50, a74
    v_accvgpr_read_b32 v51, a75
    v_accvgpr_read_b32 v52, a76
    v_accvgpr_read_b32 v53, a77
    v_accvgpr_read_b32 v54, a78
    v_accvgpr_read_b32 v55, a79
    v_mul_f32 v48, v20, v48
    v_mul_f32 v49, v20, v49
    v_mul_f32 v50, v20, v50
    v_mul_f32 v51, v20, v51
    v_mul_f32 v52, v20, v52
    v_mul_f32 v53, v20, v53
    v_mul_f32 v54, v20, v54
    v_mul_f32 v55, v20, v55
    v_cvt_pk_bf16_f32 v48, v48, v49
    v_cvt_pk_bf16_f32 v49, v50, v51
    v_cvt_pk_bf16_f32 v50, v52, v53
    v_cvt_pk_bf16_f32 v51, v54, v55
    buffer_store_dwordx4 v[48:51], v2, s[8:11], s90 offen offset:0 sc1
    v_accvgpr_read_b32 v56, a104
    v_accvgpr_read_b32 v57, a105
    v_accvgpr_read_b32 v58, a106
    v_accvgpr_read_b32 v59, a107
    v_accvgpr_read_b32 v60, a108
    v_accvgpr_read_b32 v61, a109
    v_accvgpr_read_b32 v62, a110
    v_accvgpr_read_b32 v63, a111
    v_mul_f32 v56, v21, v56
    v_mul_f32 v57, v21, v57
    v_mul_f32 v58, v21, v58
    v_mul_f32 v59, v21, v59
    v_mul_f32 v60, v21, v60
    v_mul_f32 v61, v21, v61
    v_mul_f32 v62, v21, v62
    v_mul_f32 v63, v21, v63
    v_cvt_pk_bf16_f32 v56, v56, v57
    v_cvt_pk_bf16_f32 v57, v58, v59
    v_cvt_pk_bf16_f32 v58, v60, v61
    v_cvt_pk_bf16_f32 v59, v62, v63
    buffer_store_dwordx4 v[56:59], v2, s[8:11], s90 offen offset:1024 sc1
    s_add_u32 s90, s90, 131072
    v_accvgpr_read_b32 v48, a80
    v_accvgpr_read_b32 v49, a81
    v_accvgpr_read_b32 v50, a82
    v_accvgpr_read_b32 v51, a83
    v_accvgpr_read_b32 v52, a84
    v_accvgpr_read_b32 v53, a85
    v_accvgpr_read_b32 v54, a86
    v_accvgpr_read_b32 v55, a87
    v_mul_f32 v48, v20, v48
    v_mul_f32 v49, v20, v49
    v_mul_f32 v50, v20, v50
    v_mul_f32 v51, v20, v51
    v_mul_f32 v52, v20, v52
    v_mul_f32 v53, v20, v53
    v_mul_f32 v54, v20, v54
    v_mul_f32 v55, v20, v55
    v_cvt_pk_bf16_f32 v48, v48, v49
    v_cvt_pk_bf16_f32 v49, v50, v51
    v_cvt_pk_bf16_f32 v50, v52, v53
    v_cvt_pk_bf16_f32 v51, v54, v55
    buffer_store_dwordx4 v[48:51], v2, s[8:11], s90 offen offset:0 sc1
    v_accvgpr_read_b32 v56, a112
    v_accvgpr_read_b32 v57, a113
    v_accvgpr_read_b32 v58, a114
    v_accvgpr_read_b32 v59, a115
    v_accvgpr_read_b32 v60, a116
    v_accvgpr_read_b32 v61, a117
    v_accvgpr_read_b32 v62, a118
    v_accvgpr_read_b32 v63, a119
    v_mul_f32 v56, v21, v56
    v_mul_f32 v57, v21, v57
    v_mul_f32 v58, v21, v58
    v_mul_f32 v59, v21, v59
    v_mul_f32 v60, v21, v60
    v_mul_f32 v61, v21, v61
    v_mul_f32 v62, v21, v62
    v_mul_f32 v63, v21, v63
    v_cvt_pk_bf16_f32 v56, v56, v57
    v_cvt_pk_bf16_f32 v57, v58, v59
    v_cvt_pk_bf16_f32 v58, v60, v61
    v_cvt_pk_bf16_f32 v59, v62, v63
    buffer_store_dwordx4 v[56:59], v2, s[8:11], s90 offen offset:1024 sc1
    s_add_u32 s90, s90, 131072
    v_accvgpr_read_b32 v48, a88
    v_accvgpr_read_b32 v49, a89
    v_accvgpr_read_b32 v50, a90
    v_accvgpr_read_b32 v51, a91
    v_accvgpr_read_b32 v52, a92
    v_accvgpr_read_b32 v53, a93
    v_accvgpr_read_b32 v54, a94
    v_accvgpr_read_b32 v55, a95
    v_mul_f32 v48, v20, v48
    v_mul_f32 v49, v20, v49
    v_mul_f32 v50, v20, v50
    v_mul_f32 v51, v20, v51
    v_mul_f32 v52, v20, v52
    v_mul_f32 v53, v20, v53
    v_mul_f32 v54, v20, v54
    v_mul_f32 v55, v20, v55
    v_cvt_pk_bf16_f32 v48, v48, v49
    v_cvt_pk_bf16_f32 v49, v50, v51
    v_cvt_pk_bf16_f32 v50, v52, v53
    v_cvt_pk_bf16_f32 v51, v54, v55
    buffer_store_dwordx4 v[48:51], v2, s[8:11], s90 offen offset:0 sc1
    v_accvgpr_read_b32 v56, a120
    v_accvgpr_read_b32 v57, a121
    v_accvgpr_read_b32 v58, a122
    v_accvgpr_read_b32 v59, a123
    v_accvgpr_read_b32 v60, a124
    v_accvgpr_read_b32 v61, a125
    v_accvgpr_read_b32 v62, a126
    v_accvgpr_read_b32 v63, a127
    v_mul_f32 v56, v21, v56
    v_mul_f32 v57, v21, v57
    v_mul_f32 v58, v21, v58
    v_mul_f32 v59, v21, v59
    v_mul_f32 v60, v21, v60
    v_mul_f32 v61, v21, v61
    v_mul_f32 v62, v21, v62
    v_mul_f32 v63, v21, v63
    v_cvt_pk_bf16_f32 v56, v56, v57
    v_cvt_pk_bf16_f32 v57, v58, v59
    v_cvt_pk_bf16_f32 v58, v60, v61
    v_cvt_pk_bf16_f32 v59, v62, v63
    buffer_store_dwordx4 v[56:59], v2, s[8:11], s90 offen offset:1024 sc1
    s_add_u32 s90, s90, 131072
mega_kernel_single90:
    v_mfma_f32_16x16x32_bf16 v[64:67], a[192:195], a[128:131], v[160:163]
    s_bitcmp1_b64 s[58:59], s60
    s_cselect_b32 s62, -1.0, s61
    v_add_f32 v12, v12, v28
    v_mfma_f32_16x16x32_bf16 v[64:67], a[196:199], a[132:135], v[64:67]
    s_mov_b32 m0, s55
    ds_read_b128 a[224:227], v6 offset:16384
    v_add_f32 v13, v13, v32
    v_mfma_f32_16x16x32_bf16 v[64:67], a[200:203], a[136:139], v[64:67]
    buffer_load_dwordx4 v7, s[24:27], s52 offen offset:0 sc1 lds
    v_mfma_f32_16x16x32_bf16 v[64:67], a[204:207], a[140:143], v[64:67]
    s_add_u32 s60, s60, 1
    ds_read_b128 a[228:231], v6 offset:17408
    v_exp_f32 v20, v96
    v_mfma_f32_16x16x32_bf16 v[72:75], a[192:195], a[144:147], v[168:171]
    ds_read_b128 a[232:235], v6 offset:18432
    v_exp_f32 v21, v97
    v_mfma_f32_16x16x32_bf16 v[72:75], a[196:199], a[148:151], v[72:75]
    ds_read_b128 a[236:239], v6 offset:19456
    v_cvt_pk_bf16_f32 v144, v20, v21
    v_mfma_f32_16x16x32_bf16 v[72:75], a[200:203], a[152:155], v[72:75]
    ds_read_b128 a[240:243], v6 offset:20480
    v_exp_f32 v22, v98
    v_mfma_f32_16x16x32_bf16 v[72:75], a[204:207], a[156:159], v[72:75]
    s_waitcnt lgkmcnt(5)
    ds_read_b128 a[244:247], v6 offset:21504
    v_mfma_f32_16x16x32_bf16 v[68:71], a[208:211], a[128:131], v[164:167]
    ds_read_b128 a[248:251], v6 offset:22528
    v_exp_f32 v23, v99
    v_mfma_f32_16x16x32_bf16 v[68:71], a[212:215], a[132:135], v[68:71]
    ds_read_b128 a[252:255], v6 offset:23552
    v_cvt_pk_bf16_f32 v145, v22, v23
    v_mfma_f32_16x16x32_bf16 v[68:71], a[216:219], a[136:139], v[68:71]
    buffer_load_dwordx4 v7, s[24:27], s52 offen offset:1024 sc1 lds
    v_mfma_f32_16x16x32_bf16 v[68:71], a[220:223], a[140:143], v[68:71]
    v_exp_f32 v24, v100
    v_mfma_f32_16x16x32_bf16 v[76:79], a[208:211], a[144:147], v[172:175]
    v_exp_f32 v25, v101
    v_mfma_f32_16x16x32_bf16 v[76:79], a[212:215], a[148:151], v[76:79]
    v_exp_f32 v26, v102
    v_mfma_f32_16x16x32_bf16 v[76:79], a[216:219], a[152:155], v[76:79]
    buffer_load_dwordx4 v7, s[24:27], s52 offen offset:2048 sc1 lds
    v_cvt_pk_bf16_f32 v146, v24, v25
    v_mfma_f32_16x16x32_bf16 v[76:79], a[220:223], a[156:159], v[76:79]
    s_waitcnt lgkmcnt(0)
    v_exp_f32 v27, v103
    v_mfma_f32_16x16x32_bf16 a[0:3], a[224:227], v[128:131], a[0:3]
    ds_read_b128 a[192:195], v6 offset:8192
    v_cvt_pk_bf16_f32 v147, v26, v27
    v_mfma_f32_16x16x32_bf16 a[32:35], a[224:227], v[132:135], a[32:35]
    v_exp_f32 v20, v104
    v_mfma_f32_16x16x32_bf16 v[28:31], v[44:47], v[144:147], 0
    v_exp_f32 v21, v105
    v_mfma_f32_16x16x32_bf16 a[4:7], a[228:231], v[128:131], a[4:7]
    ds_read_b128 a[196:199], v6 offset:9216
    v_exp_f32 v22, v106
    v_mfma_f32_16x16x32_bf16 a[36:39], a[228:231], v[132:135], a[36:39]
    buffer_load_dwordx4 v7, s[24:27], s52 offen offset:3072 sc1 lds
    v_mfma_f32_16x16x32_bf16 a[8:11], a[232:235], v[128:131], a[8:11]
    s_add_u32 s52, s52, 16384
    ds_read_b128 a[200:203], v6 offset:10240
    v_cvt_pk_bf16_f32 v148, v20, v21
    v_mfma_f32_16x16x32_bf16 a[40:43], a[232:235], v[132:135], a[40:43]
    v_exp_f32 v23, v107
    v_mfma_f32_16x16x32_bf16 a[12:15], a[236:239], v[128:131], a[12:15]
    ds_read_b128 a[204:207], v6 offset:11264
    v_exp_f32 v24, v108
    v_mfma_f32_16x16x32_bf16 a[44:47], a[236:239], v[132:135], a[44:47]
    v_cvt_pk_bf16_f32 v149, v22, v23
    v_exp_f32 v25, v109
    v_mfma_f32_16x16x32_bf16 a[16:19], a[240:243], v[128:131], a[16:19]
    v_exp_f32 v26, v110
    v_mfma_f32_16x16x32_bf16 a[48:51], a[240:243], v[132:135], a[48:51]
    v_cvt_pk_bf16_f32 v150, v24, v25
    v_exp_f32 v27, v111
    v_mfma_f32_16x16x32_bf16 a[20:23], a[244:247], v[128:131], a[20:23]
    ds_read_b128 a[208:211], v6 offset:12288
    v_cvt_pk_bf16_f32 v151, v26, v27
    v_mfma_f32_16x16x32_bf16 a[52:55], a[244:247], v[132:135], a[52:55]
    s_add_u32 m0, s55, 16384
    ds_read_b128 a[212:215], v6 offset:13312
    v_mfma_f32_16x16x32_bf16 v[32:35], v[44:47], v[148:151], 0
    s_nop 2
    v_mfma_f32_16x16x32_bf16 a[24:27], a[248:251], v[128:131], a[24:27]
    buffer_load_dwordx4 v7, s[28:31], s53 offen offset:0 sc1 lds
    v_mfma_f32_16x16x32_bf16 a[56:59], a[248:251], v[132:135], a[56:59]
    ds_read_b128 a[216:219], v6 offset:14336
    s_nop 0
    v_mfma_f32_16x16x32_bf16 a[28:31], a[252:255], v[128:131], a[28:31]
    ds_read_b128 a[220:223], v6 offset:15360
    v_max_f32 v8, v28, v32
    v_cmp_nge_f32 vcc, s62, v8
    v_mfma_f32_16x16x32_bf16 a[60:63], a[252:255], v[132:135], a[60:63]
    s_waitcnt lgkmcnt(4)
    s_cbranch_vccnz mega_kernel_stub91
mega_kernel_ret92:
    v_mfma_f32_16x16x32_bf16 v[96:99], a[192:195], a[128:131], v[160:163]
    s_add_u32 s55, s54, s56
    v_exp_f32 v20, v64
    v_mfma_f32_16x16x32_bf16 v[96:99], a[196:199], a[132:135], v[96:99]
    s_add_u32 s54, s54, 32768
    ds_read_b128 a[224:227], v6 offset:24576
    v_add_f32 v12, v12, v28
    v_mfma_f32_16x16x32_bf16 v[96:99], a[200:203], a[136:139], v[96:99]
    s_and_b32 s54, s54, 0x1ffff
    ds_read_b128 a[228:231], v6 offset:25600
    v_exp_f32 v21, v65
    v_mfma_f32_16x16x32_bf16 v[96:99], a[204:207], a[140:143], v[96:99]
    s_bitcmp1_b64 s[58:59], s60
    s_cselect_b32 s62, -1.0, s61
    ds_read_b128 a[232:235], v6 offset:26624
    v_mfma_f32_16x16x32_bf16 v[104:107], a[192:195], a[144:147], v[168:171]
    buffer_load_dwordx4 v7, s[28:31], s53 offen offset:1024 sc1 lds
    v_mfma_f32_16x16x32_bf16 v[104:107], a[196:199], a[148:151], v[104:107]
    s_add_u32 s60, s60, 1
    ds_read_b128 a[236:239], v6 offset:27648
    v_cvt_pk_bf16_f32 v128, v20, v21
    v_mfma_f32_16x16x32_bf16 v[104:107], a[200:203], a[152:155], v[104:107]
    ds_read_b128 a[240:243], v6 offset:28672
    v_exp_f32 v22, v66
    v_mfma_f32_16x16x32_bf16 v[104:107], a[204:207], a[156:159], v[104:107]
    s_waitcnt lgkmcnt(5)
    ds_read_b128 a[244:247], v6 offset:29696
    v_add_f32 v13, v13, v32
    v_mfma_f32_16x16x32_bf16 v[100:103], a[208:211], a[128:131], v[164:167]
    ds_read_b128 a[248:251], v6 offset:30720
    v_exp_f32 v23, v67
    v_mfma_f32_16x16x32_bf16 v[100:103], a[212:215], a[132:135], v[100:103]
    buffer_load_dwordx4 v7, s[28:31], s53 offen offset:2048 sc1 lds
    v_mfma_f32_16x16x32_bf16 v[100:103], a[216:219], a[136:139], v[100:103]
    ds_read_b128 a[252:255], v6 offset:31744
    v_cvt_pk_bf16_f32 v129, v22, v23
    v_mfma_f32_16x16x32_bf16 v[100:103], a[220:223], a[140:143], v[100:103]
    v_exp_f32 v24, v68
    v_mfma_f32_16x16x32_bf16 v[108:111], a[208:211], a[144:147], v[172:175]
    v_exp_f32 v25, v69
    v_mfma_f32_16x16x32_bf16 v[108:111], a[212:215], a[148:151], v[108:111]
    buffer_load_dwordx4 v7, s[28:31], s53 offen offset:3072 sc1 lds
    v_mfma_f32_16x16x32_bf16 v[108:111], a[216:219], a[152:155], v[108:111]
    s_add_u32 s53, s53, 16384
    v_exp_f32 v26, v70
    v_cvt_pk_bf16_f32 v130, v24, v25
    v_mfma_f32_16x16x32_bf16 v[108:111], a[220:223], a[156:159], v[108:111]
    s_waitcnt vmcnt(16) lgkmcnt(0)
    v_add_u32 v6, s54, v2
    v_exp_f32 v27, v71
    v_mfma_f32_16x16x32_bf16 a[0:3], a[224:227], v[144:147], a[0:3]
    s_barrier
    v_mfma_f32_16x16x32_bf16 a[32:35], a[224:227], v[148:151], a[32:35]
    ds_read_b128 a[192:195], v6 offset:0
    v_cvt_pk_bf16_f32 v131, v26, v27
    v_mfma_f32_16x16x32_bf16 a[4:7], a[228:231], v[144:147], a[4:7]
    v_exp_f32 v20, v72
    v_mfma_f32_16x16x32_bf16 v[28:31], v[44:47], v[128:131], 0
    v_exp_f32 v21, v73
    v_mfma_f32_16x16x32_bf16 a[36:39], a[228:231], v[148:151], a[36:39]
    ds_read_b128 a[196:199], v6 offset:1024
    v_cvt_pk_bf16_f32 v132, v20, v21
    v_mfma_f32_16x16x32_bf16 a[8:11], a[232:235], v[144:147], a[8:11]
    v_exp_f32 v22, v74
    v_mfma_f32_16x16x32_bf16 a[40:43], a[232:235], v[148:151], a[40:43]
    ds_read_b128 a[200:203], v6 offset:2048
    v_exp_f32 v23, v75
    v_mfma_f32_16x16x32_bf16 a[12:15], a[236:239], v[144:147], a[12:15]
    v_exp_f32 v24, v76
    v_mfma_f32_16x16x32_bf16 a[44:47], a[236:239], v[148:151], a[44:47]
    ds_read_b128 a[204:207], v6 offset:3072
    v_cvt_pk_bf16_f32 v133, v22, v23
    v_mfma_f32_16x16x32_bf16 a[16:19], a[240:243], v[144:147], a[16:19]
    v_exp_f32 v25, v77
    v_mfma_f32_16x16x32_bf16 a[48:51], a[240:243], v[148:151], a[48:51]
    v_exp_f32 v26, v78
    v_cvt_pk_bf16_f32 v134, v24, v25
    v_mfma_f32_16x16x32_bf16 a[20:23], a[244:247], v[144:147], a[20:23]
    v_exp_f32 v27, v79
    v_mfma_f32_16x16x32_bf16 a[52:55], a[244:247], v[148:151], a[52:55]
    ds_read_b128 a[208:211], v6 offset:4096
    v_cvt_pk_bf16_f32 v135, v26, v27
    s_nop 1
    v_mfma_f32_16x16x32_bf16 v[32:35], v[44:47], v[132:135], 0
    s_nop 2
    v_mfma_f32_16x16x32_bf16 a[24:27], a[248:251], v[144:147], a[24:27]
    ds_read_b128 a[212:215], v6 offset:5120
    s_nop 0
    v_mfma_f32_16x16x32_bf16 a[56:59], a[248:251], v[148:151], a[56:59]
    ds_read_b128 a[216:219], v6 offset:6144
    v_max_f32 v8, v28, v32
    v_mfma_f32_16x16x32_bf16 a[28:31], a[252:255], v[144:147], a[28:31]
    ds_read_b128 a[220:223], v6 offset:7168
    v_cmp_nge_f32 vcc, s62, v8
    v_mfma_f32_16x16x32_bf16 a[60:63], a[252:255], v[148:151], a[60:63]
    s_waitcnt lgkmcnt(4)
    s_cbranch_vccz mega_kernel_single90
    v_cmp_lt_f32 vcc, s61, v8
    s_cmp_lg_u32 s60, s66
    s_cbranch_scc1 mega_kernel_e94
    v_add_f32 v160, v160, v16
    v_mov_b32 v164, v9
    v_add_f32 v172, v172, v16
    v_add_f32 v161, v161, v17
    v_mov_b32 v165, v9
    v_add_f32 v173, v173, v17
    v_add_f32 v162, v162, v18
    v_mov_b32 v166, v9
    v_add_f32 v174, v174, v18
    v_add_f32 v163, v163, v19
    v_mov_b32 v167, v9
    v_add_f32 v175, v175, v19
    s_nop 0
mega_kernel_e94:
    s_cmp_lg_u32 s60, s67
    s_cbranch_scc1 mega_kernel_e95
    v_mov_b32 v160, v9
    v_mov_b32 v168, v9
    v_mov_b32 v172, v9
    v_mov_b32 v161, v9
    v_mov_b32 v169, v9
    v_mov_b32 v173, v9
    v_mov_b32 v162, v9
    v_mov_b32 v170, v9
    v_mov_b32 v174, v9
    v_mov_b32 v163, v9
    v_mov_b32 v171, v9
    v_mov_b32 v175, v9
    s_nop 0
mega_kernel_e95:
    s_cmp_gt_u32 s60, 26
    s_cbranch_scc1 mega_kernel_e96
    s_cmp_lg_u32 s60, 4
    s_cbranch_scc1 mega_kernel_e98
    buffer_store_dwordx4 v[224:227], v2, s[36:39], s40 offen sc1
    s_add_u32 s40, s40, s100
    buffer_store_dwordx4 v[228:231], v2, s[36:39], s40 offen sc1
    s_add_u32 s40, s40, s100
    buffer_store_dwordx4 v[232:235], v2, s[36:39], s40 offen sc1
    s_add_u32 s40, s40, s100
    buffer_store_dwordx4 v[236:239], v2, s[36:39], s40 offen sc1
    s_mov_b32 s40, s98
    s_branch mega_kernel_e96
mega_kernel_e98:
    s_cmp_lg_u32 s60, 6
    s_cbranch_scc1 mega_kernel_e99
    buffer_store_dwordx4 v[240:243], v2, s[36:39], s40 offen sc1
    s_add_u32 s40, s40, s100
    buffer_store_dwordx4 v[244:247], v2, s[36:39], s40 offen sc1
    s_add_u32 s40, s40, s100
    buffer_store_dwordx4 v[248:251], v2, s[36:39], s40 offen sc1
    s_add_u32 s40, s40, s100
    buffer_store_dwordx4 v[252:255], v2, s[36:39], s40 offen sc1
    s_add_u32 s40, s40, s100
    s_branch mega_kernel_e96
mega_kernel_e99:
    s_cmp_lg_u32 s60, 10
    s_cbranch_scc1 mega_kernel_e100
    s_cmp_eq_u32 s17, -1
    s_cbranch_scc1 mega_kernel_e96
    s_cmp_lg_u32 s16, 0
    s_cbranch_scc1 mega_kernel_np101
    v_mov_b32 v4, s4
    v_mov_b32 v5, s5
    s_add_u32 s90, s17, 117440512
    s_mov_b64 exec, 1
    buffer_store_dwordx2 v[4:5], off, s[8:11], s90 sc1
    s_mov_b64 exec, -1
mega_kernel_np101:
    s_branch mega_kernel_e96
mega_kernel_e100:
    s_cmp_lg_u32 s60, 14
    s_cbranch_scc1 mega_kernel_e102
    s_lshr_b32 s90, s32, 1
    s_lshl_b32 s90, s90, 7
    s_add_u32 s90, s90, 117442560
    v_min_u32 v0, 1, v1
    v_lshlrev_b32 v0, 3, v0
    buffer_load_dwordx2 v[4:5], v0, s[8:11], s90 offen sc1
    s_mov_b32 s44, s48
    s_mov_b32 s45, s49
    s_mov_b32 s46, 8388608
    s_lshl_b32 s90, s2, 2
    s_add_u32 s90, s90, s16
    s_lshl_b32 s90, s90, 13
    v_lshlrev_b32 v62, 7, v1
    buffer_load_dword v255, v62, s[44:47], s90 offen
    s_branch mega_kernel_e96
mega_kernel_e102:
    s_cmp_lg_u32 s60, 18
    s_cbranch_scc1 mega_kernel_e103
    s_waitcnt vmcnt(16)
    s_mov_b32 s3, 1048576
mega_kernel_spin104:
    v_cmp_ne_u64 s[72:73], s[4:5], v[4:5]
    s_nop 3
    s_cmp_eq_u64 s[72:73], 0
    s_cbranch_scc1 mega_kernel_e96
    s_sub_u32 s3, s3, 1
    s_cbranch_scc1 mega_kernel_e96
    s_sleep 32
    s_lshr_b32 s90, s32, 1
    s_lshl_b32 s90, s90, 7
    s_add_u32 s90, s90, 117442560
    v_min_u32 v0, 1, v1
    v_lshlrev_b32 v0, 3, v0
    buffer_load_dwordx2 v[4:5], v0, s[8:11], s90 offen sc1
    s_waitcnt vmcnt(0)
    s_branch mega_kernel_spin104
    s_branch mega_kernel_e96
mega_kernel_e103:
    s_cmp_lg_u32 s60, 22
    s_cbranch_scc1 mega_kernel_e105
    buffer_load_dwordx2 v[4:5], v10, s[8:11], 0 offen sc1
    s_mov_b32 s44, s50
    s_mov_b32 s45, s51
    s_mov_b32 s46, 2097152
    s_lshl_b32 s90, s2, 2
    s_add_u32 s90, s90, s16
    s_lshl_b32 s90, s90, 13
    v_lshlrev_b32 v62, 7, v1
    buffer_load_dword v255, v62, s[44:47], s90 offen
    s_branch mega_kernel_e96
mega_kernel_e105:
    s_cmp_lg_u32 s60, 26
    s_cbranch_scc1 mega_kernel_e106
    s_waitcnt vmcnt(16)
    s_mov_b32 s3, 1048576
mega_kernel_spin107:
    v_cmp_ne_u64 s[72:73], s[4:5], v[4:5]
    s_nop 3
    s_cmp_eq_u64 s[72:73], 0
    s_cbranch_scc1 mega_kernel_e96
    s_sub_u32 s3, s3, 1
    s_cbranch_scc1 mega_kernel_e96
    s_sleep 32
    buffer_load_dwordx2 v[4:5], v10, s[8:11], 0 offen sc1
    s_waitcnt vmcnt(0)
    s_branch mega_kernel_spin107
    s_branch mega_kernel_e96
mega_kernel_e106:
mega_kernel_e96:
    s_cbranch_vccnz mega_kernel_rc108
mega_kernel_sp93:
    s_cmp_lg_u32 s60, s68
    s_cbranch_scc1 mega_kernel_single90
    ds_read_b128 a[224:227], v6 offset:16384
    ds_read_b128 a[228:231], v6 offset:17408
    ds_read_b128 a[232:235], v6 offset:18432
    ds_read_b128 a[236:239], v6 offset:19456
    ds_read_b128 a[240:243], v6 offset:20480
    ds_read_b128 a[244:247], v6 offset:21504
    ds_read_b128 a[248:251], v6 offset:22528
    ds_read_b128 a[252:255], v6 offset:23552
    s_waitcnt lgkmcnt(0)
    v_mfma_f32_16x16x32_bf16 a[0:3], a[224:227], v[128:131], a[0:3]
    buffer_load_dwordx4 v[192:195], v2, s[8:11], s79 offen offset:0 sc1
    v_exp_f32 v20, v96
    v_mfma_f32_16x16x32_bf16 a[32:35], a[224:227], v[132:135], a[32:35]
    v_exp_f32 v21, v97
    v_exp_f32 v22, v98
    v_mfma_f32_16x16x32_bf16 a[4:7], a[228:231], v[128:131], a[4:7]
    buffer_load_dwordx4 v[196:199], v2, s[8:11], s79 offen offset:1024 sc1
    v_cvt_pk_bf16_f32 v144, v20, v21
    v_add_f32 v12, v12, v28
    v_mfma_f32_16x16x32_bf16 a[36:39], a[228:231], v[132:135], a[36:39]
    v_exp_f32 v23, v99
    v_exp_f32 v24, v100
    v_cvt_pk_bf16_f32 v145, v22, v23
    v_mfma_f32_16x16x32_bf16 a[8:11], a[232:235], v[128:131], a[8:11]
    buffer_load_dwordx4 v[200:203], v2, s[8:11], s79 offen offset:2048 sc1
    v_exp_f32 v25, v101
    v_mfma_f32_16x16x32_bf16 a[40:43], a[232:235], v[132:135], a[40:43]
    v_exp_f32 v26, v102
    v_cvt_pk_bf16_f32 v146, v24, v25
    v_add_f32 v13, v13, v32
    v_mfma_f32_16x16x32_bf16 a[12:15], a[236:239], v[128:131], a[12:15]
    buffer_load_dwordx4 v[204:207], v2, s[8:11], s79 offen offset:3072 sc1
    v_exp_f32 v27, v103
    v_mfma_f32_16x16x32_bf16 a[44:47], a[236:239], v[132:135], a[44:47]
    v_exp_f32 v20, v104
    v_cvt_pk_bf16_f32 v147, v26, v27
    v_mfma_f32_16x16x32_bf16 a[16:19], a[240:243], v[128:131], a[16:19]
    buffer_load_dwordx4 v[212:215], v2, s[8:11], s80 offen offset:0 sc1
    v_exp_f32 v21, v105
    v_mfma_f32_16x16x32_bf16 v[28:31], v[44:47], v[144:147], 0
    v_exp_f32 v22, v106
    v_cvt_pk_bf16_f32 v148, v20, v21
    v_exp_f32 v23, v107
    v_mfma_f32_16x16x32_bf16 a[48:51], a[240:243], v[132:135], a[48:51]
    v_exp_f32 v24, v108
    v_cvt_pk_bf16_f32 v149, v22, v23
    v_exp_f32 v25, v109
    v_mfma_f32_16x16x32_bf16 a[20:23], a[244:247], v[128:131], a[20:23]
    buffer_load_dwordx4 v[216:219], v2, s[8:11], s80 offen offset:1024 sc1
    v_exp_f32 v26, v110
    v_mfma_f32_16x16x32_bf16 a[52:55], a[244:247], v[132:135], a[52:55]
    v_cvt_pk_bf16_f32 v150, v24, v25
    v_exp_f32 v27, v111
    s_nop 0
    v_cvt_pk_bf16_f32 v151, v26, v27
    s_nop 1
    v_mfma_f32_16x16x32_bf16 v[32:35], v[44:47], v[148:151], 0
    s_nop 2
    v_mfma_f32_16x16x32_bf16 a[24:27], a[248:251], v[128:131], a[24:27]
    buffer_load_dwordx4 v[220:223], v2, s[8:11], s80 offen offset:2048 sc1
    v_mfma_f32_16x16x32_bf16 a[56:59], a[248:251], v[132:135], a[56:59]
    s_nop 2
    v_mfma_f32_16x16x32_bf16 a[28:31], a[252:255], v[128:131], a[28:31]
    v_max_f32 v8, v28, v32
    v_cmp_nge_f32 vcc, s61, v8
    v_mfma_f32_16x16x32_bf16 a[60:63], a[252:255], v[132:135], a[60:63]
    s_cbranch_vccnz mega_kernel_stub109
mega_kernel_ret110:
    s_nop 1
    ds_read_b128 a[224:227], v6 offset:24576
    ds_read_b128 a[228:231], v6 offset:25600
    ds_read_b128 a[232:235], v6 offset:26624
    ds_read_b128 a[236:239], v6 offset:27648
    ds_read_b128 a[240:243], v6 offset:28672
    ds_read_b128 a[244:247], v6 offset:29696
    ds_read_b128 a[248:251], v6 offset:30720
    ds_read_b128 a[252:255], v6 offset:31744
    s_waitcnt lgkmcnt(0)
    v_mfma_f32_16x16x32_bf16 a[0:3], a[224:227], v[144:147], a[0:3]
    buffer_load_dwordx4 v[224:227], v2, s[8:11], s80 offen offset:3072 sc1
    v_mfma_f32_16x16x32_bf16 a[32:35], a[224:227], v[148:151], a[32:35]
    v_mfma_f32_16x16x32_bf16 a[4:7], a[228:231], v[144:147], a[4:7]
    buffer_load_dwordx4 v[208:211], v2, s[8:11], s81 offen offset:0 sc1
    v_mfma_f32_16x16x32_bf16 a[36:39], a[228:231], v[148:151], a[36:39]
    v_mfma_f32_16x16x32_bf16 a[8:11], a[232:235], v[144:147], a[8:11]
    buffer_load_dwordx4 v[232:235], v2, s[8:11], s82 offen offset:0 sc1
    v_mfma_f32_16x16x32_bf16 a[40:43], a[232:235], v[148:151], a[40:43]
    v_mfma_f32_16x16x32_bf16 a[12:15], a[236:239], v[144:147], a[12:15]
    buffer_load_dwordx4 v[236:239], v2, s[8:11], s82 offen offset:1024 sc1
    v_mfma_f32_16x16x32_bf16 a[44:47], a[236:239], v[148:151], a[44:47]
    v_mfma_f32_16x16x32_bf16 a[16:19], a[240:243], v[144:147], a[16:19]
    buffer_load_dwordx4 v[228:231], v2, s[8:11], s83 offen offset:0 sc1
    v_mfma_f32_16x16x32_bf16 a[48:51], a[240:243], v[148:151], a[48:51]
    v_mfma_f32_16x16x32_bf16 a[20:23], a[244:247], v[144:147], a[20:23]
    buffer_load_dwordx4 v[244:247], v2, s[8:11], s84 offen offset:0 sc1
    v_mfma_f32_16x16x32_bf16 a[52:55], a[244:247], v[148:151], a[52:55]
    v_mfma_f32_16x16x32_bf16 a[24:27], a[248:251], v[144:147], a[24:27]
    buffer_load_dwordx4 v[248:251], v2, s[8:11], s84 offen offset:1024 sc1
    v_mfma_f32_16x16x32_bf16 a[56:59], a[248:251], v[148:151], a[56:59]
    v_mfma_f32_16x16x32_bf16 a[28:31], a[252:255], v[144:147], a[28:31]
    buffer_load_dwordx4 v[240:243], v2, s[8:11], s85 offen offset:0 sc1
    v_mfma_f32_16x16x32_bf16 a[60:63], a[252:255], v[148:151], a[60:63]
    v_add_f32 v20, v12, v28
    v_add_f32 v21, v13, v32
    s_nop 3
    v_rcp_f32 v20, v20
    v_rcp_f32 v21, v21
    s_lshl_b32 s90, s74, 10
    s_add_u32 s90, s90, s78
    s_add_u32 s90, s90, 67108864
    v_accvgpr_read_b32 v48, a0
    v_accvgpr_read_b32 v49, a1
    v_accvgpr_read_b32 v50, a2
    v_accvgpr_read_b32 v51, a3
    v_accvgpr_read_b32 v52, a4
    v_accvgpr_read_b32 v53, a5
    v_accvgpr_read_b32 v54, a6
    v_accvgpr_read_b32 v55, a7
    v_mul_f32 v48, v20, v48
    v_mul_f32 v49, v20, v49
    v_mul_f32 v50, v20, v50
    v_mul_f32 v51, v20, v51
    v_mul_f32 v52, v20, v52
    v_mul_f32 v53, v20, v53
    v_mul_f32 v54, v20, v54
    v_mul_f32 v55, v20, v55
    v_cvt_pk_bf16_f32 v48, v48, v49
    v_cvt_pk_bf16_f32 v49, v50, v51
    v_cvt_pk_bf16_f32 v50, v52, v53
    v_cvt_pk_bf16_f32 v51, v54, v55
    buffer_store_dwordx4 v[48:51], v2, s[8:11], s90 offen offset:0 sc1
    v_accvgpr_read_b32 v56, a32
    v_accvgpr_read_b32 v57, a33
    v_accvgpr_read_b32 v58, a34
    v_accvgpr_read_b32 v59, a35
    v_accvgpr_read_b32 v60, a36
    v_accvgpr_read_b32 v61, a37
    v_accvgpr_read_b32 v62, a38
    v_accvgpr_read_b32 v63, a39
    v_mul_f32 v56, v21, v56
    v_mul_f32 v57, v21, v57
    v_mul_f32 v58, v21, v58
    v_mul_f32 v59, v21, v59
    v_mul_f32 v60, v21, v60
    v_mul_f32 v61, v21, v61
    v_mul_f32 v62, v21, v62
    v_mul_f32 v63, v21, v63
    v_cvt_pk_bf16_f32 v56, v56, v57
    v_cvt_pk_bf16_f32 v57, v58, v59
    v_cvt_pk_bf16_f32 v58, v60, v61
    v_cvt_pk_bf16_f32 v59, v62, v63
    buffer_store_dwordx4 v[56:59], v2, s[8:11], s90 offen offset:1024 sc1
    s_add_u32 s90, s90, 131072
    v_accvgpr_read_b32 v48, a8
    v_accvgpr_read_b32 v49, a9
    v_accvgpr_read_b32 v50, a10
    v_accvgpr_read_b32 v51, a11
    v_accvgpr_read_b32 v52, a12
    v_accvgpr_read_b32 v53, a13
    v_accvgpr_read_b32 v54, a14
    v_accvgpr_read_b32 v55, a15
    v_mul_f32 v48, v20, v48
    v_mul_f32 v49, v20, v49
    v_mul_f32 v50, v20, v50
    v_mul_f32 v51, v20, v51
    v_mul_f32 v52, v20, v52
    v_mul_f32 v53, v20, v53
    v_mul_f32 v54, v20, v54
    v_mul_f32 v55, v20, v55
    v_cvt_pk_bf16_f32 v48, v48, v49
    v_cvt_pk_bf16_f32 v49, v50, v51
    v_cvt_pk_bf16_f32 v50, v52, v53
    v_cvt_pk_bf16_f32 v51, v54, v55
    buffer_store_dwordx4 v[48:51], v2, s[8:11], s90 offen offset:0 sc1
    v_accvgpr_read_b32 v56, a40
    v_accvgpr_read_b32 v57, a41
    v_accvgpr_read_b32 v58, a42
    v_accvgpr_read_b32 v59, a43
    v_accvgpr_read_b32 v60, a44
    v_accvgpr_read_b32 v61, a45
    v_accvgpr_read_b32 v62, a46
    v_accvgpr_read_b32 v63, a47
    v_mul_f32 v56, v21, v56
    v_mul_f32 v57, v21, v57
    v_mul_f32 v58, v21, v58
    v_mul_f32 v59, v21, v59
    v_mul_f32 v60, v21, v60
    v_mul_f32 v61, v21, v61
    v_mul_f32 v62, v21, v62
    v_mul_f32 v63, v21, v63
    v_cvt_pk_bf16_f32 v56, v56, v57
    v_cvt_pk_bf16_f32 v57, v58, v59
    v_cvt_pk_bf16_f32 v58, v60, v61
    v_cvt_pk_bf16_f32 v59, v62, v63
    buffer_store_dwordx4 v[56:59], v2, s[8:11], s90 offen offset:1024 sc1
    s_add_u32 s90, s90, 131072
    v_accvgpr_read_b32 v48, a16
    v_accvgpr_read_b32 v49, a17
    v_accvgpr_read_b32 v50, a18
    v_accvgpr_read_b32 v51, a19
    v_accvgpr_read_b32 v52, a20
    v_accvgpr_read_b32 v53, a21
    v_accvgpr_read_b32 v54, a22
    v_accvgpr_read_b32 v55, a23
    v_mul_f32 v48, v20, v48
    v_mul_f32 v49, v20, v49
    v_mul_f32 v50, v20, v50
    v_mul_f32 v51, v20, v51
    v_mul_f32 v52, v20, v52
    v_mul_f32 v53, v20, v53
    v_mul_f32 v54, v20, v54
    v_mul_f32 v55, v20, v55
    v_cvt_pk_bf16_f32 v48, v48, v49
    v_cvt_pk_bf16_f32 v49, v50, v51
    v_cvt_pk_bf16_f32 v50, v52, v53
    v_cvt_pk_bf16_f32 v51, v54, v55
    buffer_store_dwordx4 v[48:51], v2, s[8:11], s90 offen offset:0 sc1
    v_accvgpr_read_b32 v56, a48
    v_accvgpr_read_b32 v57, a49
    v_accvgpr_read_b32 v58, a50
    v_accvgpr_read_b32 v59, a51
    v_accvgpr_read_b32 v60, a52
    v_accvgpr_read_b32 v61, a53
    v_accvgpr_read_b32 v62, a54
    v_accvgpr_read_b32 v63, a55
    v_mul_f32 v56, v21, v56
    v_mul_f32 v57, v21, v57
    v_mul_f32 v58, v21, v58
    v_mul_f32 v59, v21, v59
    v_mul_f32 v60, v21, v60
    v_mul_f32 v61, v21, v61
    v_mul_f32 v62, v21, v62
    v_mul_f32 v63, v21, v63
    v_cvt_pk_bf16_f32 v56, v56, v57
    v_cvt_pk_bf16_f32 v57, v58, v59
    v_cvt_pk_bf16_f32 v58, v60, v61
    v_cvt_pk_bf16_f32 v59, v62, v63
    buffer_store_dwordx4 v[56:59], v2, s[8:11], s90 offen offset:1024 sc1
    s_add_u32 s90, s90, 131072
    v_accvgpr_read_b32 v48, a24
    v_accvgpr_read_b32 v49, a25
    v_accvgpr_read_b32 v50, a26
    v_accvgpr_read_b32 v51, a27
    v_accvgpr_read_b32 v52, a28
    v_accvgpr_read_b32 v53, a29
    v_accvgpr_read_b32 v54, a30
    v_accvgpr_read_b32 v55, a31
    v_mul_f32 v48, v20, v48
    v_mul_f32 v49, v20, v49
    v_mul_f32 v50, v20, v50
    v_mul_f32 v51, v20, v51
    v_mul_f32 v52, v20, v52
    v_mul_f32 v53, v20, v53
    v_mul_f32 v54, v20, v54
    v_mul_f32 v55, v20, v55
    v_cvt_pk_bf16_f32 v48, v48, v49
    v_cvt_pk_bf16_f32 v49, v50, v51
    v_cvt_pk_bf16_f32 v50, v52, v53
    v_cvt_pk_bf16_f32 v51, v54, v55
    buffer_store_dwordx4 v[48:51], v2, s[8:11], s90 offen offset:0 sc1
    v_accvgpr_read_b32 v56, a56
    v_accvgpr_read_b32 v57, a57
    v_accvgpr_read_b32 v58, a58
    v_accvgpr_read_b32 v59, a59
    v_accvgpr_read_b32 v60, a60
    v_accvgpr_read_b32 v61, a61
    v_accvgpr_read_b32 v62, a62
    v_accvgpr_read_b32 v63, a63
    v_mul_f32 v56, v21, v56
    v_mul_f32 v57, v21, v57
    v_mul_f32 v58, v21, v58
    v_mul_f32 v59, v21, v59
    v_mul_f32 v60, v21, v60
    v_mul_f32 v61, v21, v61
    v_mul_f32 v62, v21, v62
    v_mul_f32 v63, v21, v63
    v_cvt_pk_bf16_f32 v56, v56, v57
    v_cvt_pk_bf16_f32 v57, v58, v59
    v_cvt_pk_bf16_f32 v58, v60, v61
    v_cvt_pk_bf16_f32 v59, v62, v63
    buffer_store_dwordx4 v[56:59], v2, s[8:11], s90 offen offset:1024 sc1
    s_add_u32 s90, s90, 131072
    v_and_b32 v48, 15, v1
    v_lshrrev_b32 v49, 4, v1
    v_lshlrev_b32 v49, 2, v49
    v_sub_u32 v48, v48, v49
    v_cmp_ge_i32 vcc, -9, v48
    v_subrev_u32 v50, 0, v48
    v_cmp_ge_u32 s[72:73], 7, v50
    s_nop 0
    v_cndmask_b32 v64, v9, 0, vcc
    v_cndmask_b32 v68, v9, 0, s[72:73]
    v_cmp_ge_i32 vcc, -8, v48
    v_subrev_u32 v50, 1, v48
    v_cmp_ge_u32 s[72:73], 7, v50
    s_nop 0
    v_cndmask_b32 v65, v9, 0, vcc
    v_cndmask_b32 v69, v9, 0, s[72:73]
    v_cmp_ge_i32 vcc, -7, v48
    v_subrev_u32 v50, 2, v48
    v_cmp_ge_u32 s[72:73], 7, v50
    s_nop 0
    v_cndmask_b32 v66, v9, 0, vcc
    v_cndmask_b32 v70, v9, 0, s[72:73]
    v_cmp_ge_i32 vcc, -6, v48
    v_subrev_u32 v50, 3, v48
    v_cmp_ge_u32 s[72:73], 7, v50
    s_nop 0
    v_cndmask_b32 v67, v9, 0, vcc
    v_cndmask_b32 v71, v9, 0, s[72:73]
    s_cmp_eq_u32 s77, 0
    s_cselect_b64 vcc, -1, 0
    s_nop 0
    v_cndmask_b32 v72, v64, v9, vcc
    v_cndmask_b32 v73, v65, v9, vcc
    v_cndmask_b32 v74, v66, v9, vcc
    v_cndmask_b32 v75, v67, v9, vcc
    s_waitcnt vmcnt(8)
    s_nop 0
    v_mfma_f32_16x16x32_bf16 v[80:83], v[208:211], v[192:195], v[72:75]
    v_mfma_f32_16x16x32_bf16 v[84:87], v[212:215], v[192:195], v[68:71]
    v_mfma_f32_16x16x32_bf16 v[88:91], v[212:215], v[196:199], v[64:67]
    v_mfma_f32_16x16x32_bf16 v[92:95], v[216:219], v[196:199], v[68:71]
    v_mfma_f32_16x16x32_bf16 v[96:99], v[216:219], v[200:203], v[64:67]
    v_mfma_f32_16x16x32_bf16 v[100:103], v[220:223], v[200:203], v[68:71]
    v_mfma_f32_16x16x32_bf16 v[104:107], v[220:223], v[204:207], v[64:67]
    v_mfma_f32_16x16x32_bf16 v[108:111], v[224:227], v[204:207], v[68:71]
    s_nop 7
    v_max3_f32 v112, v80, v81, v82
    v_max3_f32 v113, v88, v89, v90
    v_max3_f32 v114, v96, v97, v98
    v_max3_f32 v115, v104, v105, v106
    v_max3_f32 v112, v112, v83, v84
    v_max3_f32 v113, v113, v91, v92
    v_max3_f32 v114, v114, v99, v100
    v_max3_f32 v115, v115, v107, v108
    v_max3_f32 v112, v112, v85, v86
    v_max3_f32 v113, v113, v93, v94
    v_max3_f32 v114, v114, v101, v102
    v_max3_f32 v115, v115, v109, v110
    v_max_f32 v112, v112, v87
    v_max_f32 v113, v113, v95
    v_max_f32 v114, v114, v103
    v_max_f32 v115, v115, v111
    v_mov_b32 v116, v112
    v_mov_b32 v117, v113
    v_mov_b32 v118, v114
    v_mov_b32 v119, v115
    s_nop 1
    v_permlane32_swap_b32 v112, v116
    v_permlane32_swap_b32 v113, v117
    v_permlane32_swap_b32 v114, v118
    v_permlane32_swap_b32 v115, v119
    s_nop 1
    v_max_f32 v112, v112, v116
    v_max_f32 v113, v113, v117
    v_max_f32 v114, v114, v118
    v_max_f32 v115, v115, v119
    v_mov_b32 v116, v112
    v_mov_b32 v117, v113
    v_mov_b32 v118, v114
    v_mov_b32 v119, v115
    s_nop 1
    v_permlane16_swap_b32 v112, v116
    v_permlane16_swap_b32 v113, v117
    v_permlane16_swap_b32 v114, v118
    v_permlane16_swap_b32 v115, v119
    s_nop 1
    v_max_f32 v112, v112, v116
    v_max_f32 v113, v113, v117
    v_max_f32 v114, v114, v118
    v_max_f32 v115, v115, v119
    v_sub_f32 v80, v80, v112
    v_sub_f32 v81, v81, v112
    v_sub_f32 v82, v82, v112
    v_sub_f32 v83, v83, v112
    v_sub_f32 v84, v84, v112
    v_sub_f32 v85, v85, v112
    v_sub_f32 v86, v86, v112
    v_sub_f32 v87, v87, v112
    v_sub_f32 v88, v88, v113
    v_sub_f32 v89, v89, v113
    v_sub_f32 v90, v90, v113
    v_sub_f32 v91, v91, v113
    v_sub_f32 v92, v92, v113
    v_sub_f32 v93, v93, v113
    v_sub_f32 v94, v94, v113
    v_sub_f32 v95, v95, v113
    v_sub_f32 v96, v96, v114
    v_sub_f32 v97, v97, v114
    v_sub_f32 v98, v98, v114
    v_sub_f32 v99, v99, v114
    v_sub_f32 v100, v100, v114
    v_sub_f32 v101, v101, v114
    v_sub_f32 v102, v102, v114
    v_sub_f32 v103, v103, v114
    v_sub_f32 v104, v104, v115
    v_sub_f32 v105, v105, v115
    v_sub_f32 v106, v106, v115
    v_sub_f32 v107, v107, v115
    v_sub_f32 v108, v108, v115
    v_sub_f32 v109, v109, v115
    v_sub_f32 v110, v110, v115
    v_sub_f32 v111, v111, v115
    v_exp_f32 v80, v80
    v_exp_f32 v81, v81
    v_exp_f32 v82, v82
    v_exp_f32 v83, v83
    v_exp_f32 v84, v84
    v_exp_f32 v85, v85
    v_exp_f32 v86, v86
    v_exp_f32 v87, v87
    v_exp_f32 v88, v88
    v_exp_f32 v89, v89
    v_exp_f32 v90, v90
    v_exp_f32 v91, v91
    v_exp_f32 v92, v92
    v_exp_f32 v93, v93
    v_exp_f32 v94, v94
    v_exp_f32 v95, v95
    v_exp_f32 v96, v96
    v_exp_f32 v97, v97
    v_exp_f32 v98, v98
    v_exp_f32 v99, v99
    v_exp_f32 v100, v100
    v_exp_f32 v101, v101
    v_exp_f32 v102, v102
    v_exp_f32 v103, v103
    v_exp_f32 v104, v104
    v_exp_f32 v105, v105
    v_exp_f32 v106, v106
    v_exp_f32 v107, v107
    v_exp_f32 v108, v108
    v_exp_f32 v109, v109
    v_exp_f32 v110, v110
    v_exp_f32 v111, v111
    v_cvt_pk_bf16_f32 v192, v80, v81
    v_cvt_pk_bf16_f32 v193, v82, v83
    v_cvt_pk_bf16_f32 v194, v84, v85
    v_cvt_pk_bf16_f32 v195, v86, v87
    v_cvt_pk_bf16_f32 v196, v88, v89
    v_cvt_pk_bf16_f32 v197, v90, v91
    v_cvt_pk_bf16_f32 v198, v92, v93
    v_cvt_pk_bf16_f32 v199, v94, v95
    v_cvt_pk_bf16_f32 v200, v96, v97
    v_cvt_pk_bf16_f32 v201, v98, v99
    v_cvt_pk_bf16_f32 v202, v100, v101
    v_cvt_pk_bf16_f32 v203, v102, v103
    v_cvt_pk_bf16_f32 v204, v104, v105
    v_cvt_pk_bf16_f32 v205, v106, v107
    v_cvt_pk_bf16_f32 v206, v108, v109
    v_cvt_pk_bf16_f32 v207, v110, v111
    v_add_f32 v112, v80, v81
    v_add_f32 v113, v88, v89
    v_add_f32 v114, v96, v97
    v_add_f32 v115, v104, v105
    v_mfma_f32_16x16x32_bf16 v[128:131], v[230:233], v[192:195], 0
    v_mfma_f32_16x16x32_bf16 v[132:135], v[242:245], v[192:195], 0
    v_mfma_f32_16x16x32_bf16 v[136:139], v[232:235], v[196:199], 0
    v_mfma_f32_16x16x32_bf16 v[140:143], v[244:247], v[196:199], 0
    v_mfma_f32_16x16x32_bf16 v[144:147], v[234:237], v[200:203], 0
    v_mfma_f32_16x16x32_bf16 v[148:151], v[246:249], v[200:203], 0
    v_mfma_f32_16x16x32_bf16 v[152:155], v[236:239], v[204:207], 0
    v_mfma_f32_16x16x32_bf16 v[156:159], v[248:251], v[204:207], 0
    v_add_f32 v112, v112, v82
    v_add_f32 v113, v113, v90
    v_add_f32 v114, v114, v98
    v_add_f32 v115, v115, v106
    v_add_f32 v112, v112, v83
    v_add_f32 v113, v113, v91
    v_add_f32 v114, v114, v99
    v_add_f32 v115, v115, v107
    v_add_f32 v112, v112, v84
    v_add_f32 v113, v113, v92
    v_add_f32 v114, v114, v100
    v_add_f32 v115, v115, v108
    v_add_f32 v112, v112, v85
    v_add_f32 v113, v113, v93
    v_add_f32 v114, v114, v101
    v_add_f32 v115, v115, v109
    v_add_f32 v112, v112, v86
    v_add_f32 v113, v113, v94
    v_add_f32 v114, v114, v102
    v_add_f32 v115, v115, v110
    v_add_f32 v112, v112, v87
    v_add_f32 v113, v113, v95
    v_add_f32 v114, v114, v103
    v_add_f32 v115, v115, v111
    v_mov_b32 v116, v112
    v_mov_b32 v117, v113
    v_mov_b32 v118, v114
    v_mov_b32 v119, v115
    s_nop 1
    v_permlane32_swap_b32 v112, v116
    v_permlane32_swap_b32 v113, v117
    v_permlane32_swap_b32 v114, v118
    v_permlane32_swap_b32 v115, v119
    s_nop 1
    v_add_f32 v112, v112, v116
    v_add_f32 v113, v113, v117
    v_add_f32 v114, v114, v118
    v_add_f32 v115, v115, v119
    v_mov_b32 v116, v112
    v_mov_b32 v117, v113
    v_mov_b32 v118, v114
    v_mov_b32 v119, v115
    s_nop 1
    v_permlane16_swap_b32 v112, v116
    v_permlane16_swap_b32 v113, v117
    v_permlane16_swap_b32 v114, v118
    v_permlane16_swap_b32 v115, v119
    s_nop 1
    v_add_f32 v112, v112, v116
    v_add_f32 v113, v113, v117
    v_add_f32 v114, v114, v118
    v_add_f32 v115, v115, v119
    v_rcp_f32 v112, v112
    v_rcp_f32 v113, v113
    v_rcp_f32 v114, v114
    v_rcp_f32 v115, v115
    s_lshl_b32 s90, s76, 10
    s_lshr_b32 s91, s2, 3
    s_lshl_b32 s91, s91, 17
    s_add_u32 s90, s90, s91
    s_add_u32 s90, s90, 83886080
    v_mul_f32 v128, v128, v112
    v_mul_f32 v129, v129, v112
    v_mul_f32 v130, v130, v112
    v_mul_f32 v131, v131, v112
    v_mul_f32 v132, v132, v112
    v_mul_f32 v133, v133, v112
    v_mul_f32 v134, v134, v112
    v_mul_f32 v135, v135, v112
    v_cvt_pk_bf16_f32 v128, v128, v129
    v_cvt_pk_bf16_f32 v129, v130, v131
    v_cvt_pk_bf16_f32 v130, v132, v133
    v_cvt_pk_bf16_f32 v131, v134, v135
    buffer_store_dwordx4 v[128:131], v2, s[8:11], s90 offen offset:0 sc1
    v_mul_f32 v136, v136, v113
    v_mul_f32 v137, v137, v113
    v_mul_f32 v138, v138, v113
    v_mul_f32 v139, v139, v113
    v_mul_f32 v140, v140, v113
    v_mul_f32 v141, v141, v113
    v_mul_f32 v142, v142, v113
    v_mul_f32 v143, v143, v113
    v_cvt_pk_bf16_f32 v136, v136, v137
    v_cvt_pk_bf16_f32 v137, v138, v139
    v_cvt_pk_bf16_f32 v138, v140, v141
    v_cvt_pk_bf16_f32 v139, v142, v143
    buffer_store_dwordx4 v[136:139], v2, s[8:11], s90 offen offset:1024 sc1
    v_mul_f32 v144, v144, v114
    v_mul_f32 v145, v145, v114
    v_mul_f32 v146, v146, v114
    v_mul_f32 v147, v147, v114
    v_mul_f32 v148, v148, v114
    v_mul_f32 v149, v149, v114
    v_mul_f32 v150, v150, v114
    v_mul_f32 v151, v151, v114
    v_cvt_pk_bf16_f32 v144, v144, v145
    v_cvt_pk_bf16_f32 v145, v146, v147
    v_cvt_pk_bf16_f32 v146, v148, v149
    v_cvt_pk_bf16_f32 v147, v150, v151
    buffer_store_dwordx4 v[144:147], v2, s[8:11], s90 offen offset:2048 sc1
    v_mul_f32 v152, v152, v115
    v_mul_f32 v153, v153, v115
    v_mul_f32 v154, v154, v115
    v_mul_f32 v155, v155, v115
    v_mul_f32 v156, v156, v115
    v_mul_f32 v157, v157, v115
    v_mul_f32 v158, v158, v115
    v_mul_f32 v159, v159, v115
    v_cvt_pk_bf16_f32 v152, v152, v153
    v_cvt_pk_bf16_f32 v153, v154, v155
    v_cvt_pk_bf16_f32 v154, v156, v157
    v_cvt_pk_bf16_f32 v155, v158, v159
    buffer_store_dwordx4 v[152:155], v2, s[8:11], s90 offen offset:3072 sc1
mega_kernel_end1:
    s_endpgm
mega_kernel_stub64:
    v_cmp_lt_f32 vcc, s61, v8
    s_cmp_lg_u32 s60, s63
    s_cbranch_scc1 mega_kernel_e112
    v_add_f32 v176, v176, v16
    v_mov_b32 v180, v9
    v_add_f32 v188, v188, v16
    v_add_f32 v177, v177, v17
    v_mov_b32 v181, v9
    v_add_f32 v189, v189, v17
    v_add_f32 v178, v178, v18
    v_mov_b32 v182, v9
    v_add_f32 v190, v190, v18
    v_add_f32 v179, v179, v19
    v_mov_b32 v183, v9
    v_add_f32 v191, v191, v19
    s_nop 0
mega_kernel_e112:
    s_cmp_lg_u32 s60, s64
    s_cbranch_scc1 mega_kernel_e113
    v_mov_b32 v176, v9
    v_mov_b32 v184, v9
    v_mov_b32 v188, v9
    v_mov_b32 v177, v9
    v_mov_b32 v185, v9
    v_mov_b32 v189, v9
    v_mov_b32 v178, v9
    v_mov_b32 v186, v9
    v_mov_b32 v190, v9
    v_mov_b32 v179, v9
    v_mov_b32 v187, v9
    v_mov_b32 v191, v9
    s_nop 0
mega_kernel_e113:
    s_cbranch_vccnz mega_kernel_rc114
mega_kernel_sp111:
    s_branch mega_kernel_ret65
mega_kernel_stub67:
    v_cmp_lt_f32 vcc, s61, v8
    s_cmp_lg_u32 s60, s63
    s_cbranch_scc1 mega_kernel_e116
    v_add_f32 v176, v176, v16
    v_mov_b32 v180, v9
    v_add_f32 v188, v188, v16
    v_add_f32 v177, v177, v17
    v_mov_b32 v181, v9
    v_add_f32 v189, v189, v17
    v_add_f32 v178, v178, v18
    v_mov_b32 v182, v9
    v_add_f32 v190, v190, v18
    v_add_f32 v179, v179, v19
    v_mov_b32 v183, v9
    v_add_f32 v191, v191, v19
    s_nop 0
mega_kernel_e116:
    s_cmp_lg_u32 s60, s64
    s_cbranch_scc1 mega_kernel_e117
    v_mov_b32 v176, v9
    v_mov_b32 v184, v9
    v_mov_b32 v188, v9
    v_mov_b32 v177, v9
    v_mov_b32 v185, v9
    v_mov_b32 v189, v9
    v_mov_b32 v178, v9
    v_mov_b32 v186, v9
    v_mov_b32 v190, v9
    v_mov_b32 v179, v9
    v_mov_b32 v187, v9
    v_mov_b32 v191, v9
    s_nop 0
mega_kernel_e117:
    s_cbranch_vccnz mega_kernel_rc118
mega_kernel_sp115:
    s_branch mega_kernel_ret68
mega_kernel_stub86:
    v_cmp_lt_f32 vcc, s61, v8
    s_cmp_lg_u32 s60, s66
    s_cbranch_scc1 mega_kernel_e120
    v_add_f32 v160, v160, v16
    v_mov_b32 v164, v9
    v_add_f32 v172, v172, v16
    v_add_f32 v161, v161, v17
    v_mov_b32 v165, v9
    v_add_f32 v173, v173, v17
    v_add_f32 v162, v162, v18
    v_mov_b32 v166, v9
    v_add_f32 v174, v174, v18
    v_add_f32 v163, v163, v19
    v_mov_b32 v167, v9
    v_add_f32 v175, v175, v19
    s_nop 0
mega_kernel_e120:
    s_cmp_lg_u32 s60, s67
    s_cbranch_scc1 mega_kernel_e121
    v_mov_b32 v160, v9
    v_mov_b32 v168, v9
    v_mov_b32 v172, v9
    v_mov_b32 v161, v9
    v_mov_b32 v169, v9
    v_mov_b32 v173, v9
    v_mov_b32 v162, v9
    v_mov_b32 v170, v9
    v_mov_b32 v174, v9
    v_mov_b32 v163, v9
    v_mov_b32 v171, v9
    v_mov_b32 v175, v9
    s_nop 0
mega_kernel_e121:
    s_cbranch_vccnz mega_kernel_rc122
mega_kernel_sp119:
    s_branch mega_kernel_ret87
mega_kernel_stub88:
    v_cmp_lt_f32 vcc, s61, v8
    s_cmp_lg_u32 s60, s66
    s_cbranch_scc1 mega_kernel_e124
    v_add_f32 v160, v160, v16
    v_mov_b32 v164, v9
    v_add_f32 v172, v172, v16
    v_add_f32 v161, v161, v17
    v_mov_b32 v165, v9
    v_add_f32 v173, v173, v17
    v_add_f32 v162, v162, v18
    v_mov_b32 v166, v9
    v_add_f32 v174, v174, v18
    v_add_f32 v163, v163, v19
    v_mov_b32 v167, v9
    v_add_f32 v175, v175, v19
    s_nop 0
mega_kernel_e124:
    s_cmp_lg_u32 s60, s67
    s_cbranch_scc1 mega_kernel_e125
    v_mov_b32 v160, v9
    v_mov_b32 v168, v9
    v_mov_b32 v172, v9
    v_mov_b32 v161, v9
    v_mov_b32 v169, v9
    v_mov_b32 v173, v9
    v_mov_b32 v162, v9
    v_mov_b32 v170, v9
    v_mov_b32 v174, v9
    v_mov_b32 v163, v9
    v_mov_b32 v171, v9
    v_mov_b32 v175, v9
    s_nop 0
mega_kernel_e125:
    s_cmp_gt_u32 s60, 26
    s_cbranch_scc1 mega_kernel_e126
    s_cmp_lg_u32 s60, 4
    s_cbranch_scc1 mega_kernel_e128
    buffer_store_dwordx4 v[224:227], v2, s[36:39], s40 offen sc1
    s_add_u32 s40, s40, s100
    buffer_store_dwordx4 v[228:231], v2, s[36:39], s40 offen sc1
    s_add_u32 s40, s40, s100
    buffer_store_dwordx4 v[232:235], v2, s[36:39], s40 offen sc1
    s_add_u32 s40, s40, s100
    buffer_store_dwordx4 v[236:239], v2, s[36:39], s40 offen sc1
    s_mov_b32 s40, s98
    s_branch mega_kernel_e126
mega_kernel_e128:
    s_cmp_lg_u32 s60, 6
    s_cbranch_scc1 mega_kernel_e129
    buffer_store_dwordx4 v[240:243], v2, s[36:39], s40 offen sc1
    s_add_u32 s40, s40, s100
    buffer_store_dwordx4 v[244:247], v2, s[36:39], s40 offen sc1
    s_add_u32 s40, s40, s100
    buffer_store_dwordx4 v[248:251], v2, s[36:39], s40 offen sc1
    s_add_u32 s40, s40, s100
    buffer_store_dwordx4 v[252:255], v2, s[36:39], s40 offen sc1
    s_add_u32 s40, s40, s100
    s_branch mega_kernel_e126
mega_kernel_e129:
    s_cmp_lg_u32 s60, 10
    s_cbranch_scc1 mega_kernel_e130
    s_cmp_eq_u32 s17, -1
    s_cbranch_scc1 mega_kernel_e126
    s_cmp_lg_u32 s16, 0
    s_cbranch_scc1 mega_kernel_np131
    v_mov_b32 v4, s4
    v_mov_b32 v5, s5
    s_add_u32 s90, s17, 117440512
    s_mov_b64 exec, 1
    buffer_store_dwordx2 v[4:5], off, s[8:11], s90 sc1
    s_mov_b64 exec, -1
mega_kernel_np131:
    s_branch mega_kernel_e126
mega_kernel_e130:
    s_cmp_lg_u32 s60, 14
    s_cbranch_scc1 mega_kernel_e132
    s_lshr_b32 s90, s32, 1
    s_lshl_b32 s90, s90, 7
    s_add_u32 s90, s90, 117442560
    v_min_u32 v0, 1, v1
    v_lshlrev_b32 v0, 3, v0
    buffer_load_dwordx2 v[4:5], v0, s[8:11], s90 offen sc1
    s_mov_b32 s44, s48
    s_mov_b32 s45, s49
    s_mov_b32 s46, 8388608
    s_lshl_b32 s90, s2, 2
    s_add_u32 s90, s90, s16
    s_lshl_b32 s90, s90, 13
    v_lshlrev_b32 v62, 7, v1
    buffer_load_dword v255, v62, s[44:47], s90 offen
    s_branch mega_kernel_e126
mega_kernel_e132:
    s_cmp_lg_u32 s60, 18
    s_cbranch_scc1 mega_kernel_e133
    s_waitcnt vmcnt(16)
    s_mov_b32 s3, 1048576
mega_kernel_spin134:
    v_cmp_ne_u64 s[72:73], s[4:5], v[4:5]
    s_nop 3
    s_cmp_eq_u64 s[72:73], 0
    s_cbranch_scc1 mega_kernel_e126
    s_sub_u32 s3, s3, 1
    s_cbranch_scc1 mega_kernel_e126
    s_sleep 32
    s_lshr_b32 s90, s32, 1
    s_lshl_b32 s90, s90, 7
    s_add_u32 s90, s90, 117442560
    v_min_u32 v0, 1, v1
    v_lshlrev_b32 v0, 3, v0
    buffer_load_dwordx2 v[4:5], v0, s[8:11], s90 offen sc1
    s_waitcnt vmcnt(0)
    s_branch mega_kernel_spin134
    s_branch mega_kernel_e126
mega_kernel_e133:
    s_cmp_lg_u32 s60, 22
    s_cbranch_scc1 mega_kernel_e135
    buffer_load_dwordx2 v[4:5], v10, s[8:11], 0 offen sc1
    s_mov_b32 s44, s50
    s_mov_b32 s45, s51
    s_mov_b32 s46, 2097152
    s_lshl_b32 s90, s2, 2
    s_add_u32 s90, s90, s16
    s_lshl_b32 s90, s90, 13
    v_lshlrev_b32 v62, 7, v1
    buffer_load_dword v255, v62, s[44:47], s90 offen
    s_branch mega_kernel_e126
mega_kernel_e135:
    s_cmp_lg_u32 s60, 26
    s_cbranch_scc1 mega_kernel_e136
    s_waitcnt vmcnt(16)
    s_mov_b32 s3, 1048576
mega_kernel_spin137:
    v_cmp_ne_u64 s[72:73], s[4:5], v[4:5]
    s_nop 3
    s_cmp_eq_u64 s[72:73], 0
    s_cbranch_scc1 mega_kernel_e126
    s_sub_u32 s3, s3, 1
    s_cbranch_scc1 mega_kernel_e126
    s_sleep 32
    buffer_load_dwordx2 v[4:5], v10, s[8:11], 0 offen sc1
    s_waitcnt vmcnt(0)
    s_branch mega_kernel_spin137
    s_branch mega_kernel_e126
mega_kernel_e136:
mega_kernel_e126:
    s_cbranch_vccnz mega_kernel_rc138
mega_kernel_sp123:
    s_branch mega_kernel_ret89
mega_kernel_stub91:
    v_cmp_lt_f32 vcc, s61, v8
    s_cmp_lg_u32 s60, s66
    s_cbranch_scc1 mega_kernel_e140
    v_add_f32 v160, v160, v16
    v_mov_b32 v164, v9
    v_add_f32 v172, v172, v16
    v_add_f32 v161, v161, v17
    v_mov_b32 v165, v9
    v_add_f32 v173, v173, v17
    v_add_f32 v162, v162, v18
    v_mov_b32 v166, v9
    v_add_f32 v174, v174, v18
    v_add_f32 v163, v163, v19
    v_mov_b32 v167, v9
    v_add_f32 v175, v175, v19
    s_nop 0
mega_kernel_e140:
    s_cmp_lg_u32 s60, s67
    s_cbranch_scc1 mega_kernel_e141
    v_mov_b32 v160, v9
    v_mov_b32 v168, v9
    v_mov_b32 v172, v9
    v_mov_b32 v161, v9
    v_mov_b32 v169, v9
    v_mov_b32 v173, v9
    v_mov_b32 v162, v9
    v_mov_b32 v170, v9
    v_mov_b32 v174, v9
    v_mov_b32 v163, v9
    v_mov_b32 v171, v9
    v_mov_b32 v175, v9
    s_nop 0
mega_kernel_e141:
    s_cbranch_vccnz mega_kernel_rc142
mega_kernel_sp139:
    s_branch mega_kernel_ret92
mega_kernel_stub109:
    v_cmp_lt_f32 vcc, s61, v8
    s_cbranch_vccnz mega_kernel_rc144
mega_kernel_sp143:
    s_branch mega_kernel_ret110
mega_kernel_rc85:
    s_call_b64 s[70:71], mega_kernel_rs0458
    s_branch mega_kernel_sp69
mega_kernel_rc108:
    s_call_b64 s[70:71], mega_kernel_rs0257
    s_branch mega_kernel_sp93
mega_kernel_rc114:
    s_call_b64 s[70:71], mega_kernel_rs0458
    s_branch mega_kernel_sp111
mega_kernel_rc118:
    s_call_b64 s[70:71], mega_kernel_rs1460
    s_branch mega_kernel_sp115
mega_kernel_rc122:
    s_call_b64 s[70:71], mega_kernel_rs1460
    s_branch mega_kernel_sp119
mega_kernel_rc138:
    s_call_b64 s[70:71], mega_kernel_rs0257
    s_branch mega_kernel_sp123
mega_kernel_rc142:
    s_call_b64 s[70:71], mega_kernel_rs1259
    s_branch mega_kernel_sp139
mega_kernel_rc144:
    s_call_b64 s[70:71], mega_kernel_rs1259
    s_branch mega_kernel_sp143
mega_kernel_rs0257:
    s_nop 15
    v_max3_f32 v48, v64, v65, v66
    v_max3_f32 v48, v48, v67, v68
    v_max3_f32 v48, v48, v69, v70
    v_max3_f32 v48, v48, v71, 0
    v_mov_b32 v49, v48
    s_nop 1
    v_permlane32_swap_b32 v48, v49
    s_nop 1
    v_max_f32 v48, v48, v49
    v_mov_b32 v49, v48
    s_nop 1
    v_permlane16_swap_b32 v48, v49
    s_nop 1
    v_max_f32 v48, v48, v49
    v_exp_f32 v49, -v48
    v_sub_f32 v64, v64, v48
    v_sub_f32 v65, v65, v48
    v_sub_f32 v66, v66, v48
    v_sub_f32 v67, v67, v48
    v_sub_f32 v68, v68, v48
    v_sub_f32 v69, v69, v48
    v_sub_f32 v70, v70, v48
    v_sub_f32 v71, v71, v48
    v_sub_f32 v96, v96, v48
    v_sub_f32 v97, v97, v48
    v_sub_f32 v98, v98, v48
    v_sub_f32 v99, v99, v48
    v_sub_f32 v100, v100, v48
    v_sub_f32 v101, v101, v48
    v_sub_f32 v102, v102, v48
    v_sub_f32 v103, v103, v48
    v_sub_f32 v160, v160, v48
    v_sub_f32 v161, v161, v48
    v_sub_f32 v162, v162, v48
    v_sub_f32 v163, v163, v48
    v_sub_f32 v164, v164, v48
    v_sub_f32 v165, v165, v48
    v_sub_f32 v166, v166, v48
    v_sub_f32 v167, v167, v48
    v_mul_f32 v12, v12, v49
    v_accvgpr_read_b32 v52, a0
    v_accvgpr_read_b32 v53, a1
    v_accvgpr_read_b32 v54, a2
    v_accvgpr_read_b32 v55, a3
    v_accvgpr_read_b32 v56, a4
    v_accvgpr_read_b32 v57, a5
    v_accvgpr_read_b32 v58, a6
    v_accvgpr_read_b32 v59, a7
    v_mul_f32 v52, v52, v49
    v_mul_f32 v53, v53, v49
    v_mul_f32 v54, v54, v49
    v_mul_f32 v55, v55, v49
    v_mul_f32 v56, v56, v49
    v_mul_f32 v57, v57, v49
    v_mul_f32 v58, v58, v49
    v_mul_f32 v59, v59, v49
    v_accvgpr_write_b32 a0, v52
    v_accvgpr_write_b32 a1, v53
    v_accvgpr_write_b32 a2, v54
    v_accvgpr_write_b32 a3, v55
    v_accvgpr_write_b32 a4, v56
    v_accvgpr_write_b32 a5, v57
    v_accvgpr_write_b32 a6, v58
    v_accvgpr_write_b32 a7, v59
    v_accvgpr_read_b32 v52, a8
    v_accvgpr_read_b32 v53, a9
    v_accvgpr_read_b32 v54, a10
    v_accvgpr_read_b32 v55, a11
    v_accvgpr_read_b32 v56, a12
    v_accvgpr_read_b32 v57, a13
    v_accvgpr_read_b32 v58, a14
    v_accvgpr_read_b32 v59, a15
    v_mul_f32 v52, v52, v49
    v_mul_f32 v53, v53, v49
    v_mul_f32 v54, v54, v49
    v_mul_f32 v55, v55, v49
    v_mul_f32 v56, v56, v49
    v_mul_f32 v57, v57, v49
    v_mul_f32 v58, v58, v49
    v_mul_f32 v59, v59, v49
    v_accvgpr_write_b32 a8, v52
    v_accvgpr_write_b32 a9, v53
    v_accvgpr_write_b32 a10, v54
    v_accvgpr_write_b32 a11, v55
    v_accvgpr_write_b32 a12, v56
    v_accvgpr_write_b32 a13, v57
    v_accvgpr_write_b32 a14, v58
    v_accvgpr_write_b32 a15, v59
    v_accvgpr_read_b32 v52, a16
    v_accvgpr_read_b32 v53, a17
    v_accvgpr_read_b32 v54, a18
    v_accvgpr_read_b32 v55, a19
    v_accvgpr_read_b32 v56, a20
    v_accvgpr_read_b32 v57, a21
    v_accvgpr_read_b32 v58, a22
    v_accvgpr_read_b32 v59, a23
    v_mul_f32 v52, v52, v49
    v_mul_f32 v53, v53, v49
    v_mul_f32 v54, v54, v49
    v_mul_f32 v55, v55, v49
    v_mul_f32 v56, v56, v49
    v_mul_f32 v57, v57, v49
    v_mul_f32 v58, v58, v49
    v_mul_f32 v59, v59, v49
    v_accvgpr_write_b32 a16, v52
    v_accvgpr_write_b32 a17, v53
    v_accvgpr_write_b32 a18, v54
    v_accvgpr_write_b32 a19, v55
    v_accvgpr_write_b32 a20, v56
    v_accvgpr_write_b32 a21, v57
    v_accvgpr_write_b32 a22, v58
    v_accvgpr_write_b32 a23, v59
    v_accvgpr_read_b32 v52, a24
    v_accvgpr_read_b32 v53, a25
    v_accvgpr_read_b32 v54, a26
    v_accvgpr_read_b32 v55, a27
    v_accvgpr_read_b32 v56, a28
    v_accvgpr_read_b32 v57, a29
    v_accvgpr_read_b32 v58, a30
    v_accvgpr_read_b32 v59, a31
    v_mul_f32 v52, v52, v49
    v_mul_f32 v53, v53, v49
    v_mul_f32 v54, v54, v49
    v_mul_f32 v55, v55, v49
    v_mul_f32 v56, v56, v49
    v_mul_f32 v57, v57, v49
    v_mul_f32 v58, v58, v49
    v_mul_f32 v59, v59, v49
    v_accvgpr_write_b32 a24, v52
    v_accvgpr_write_b32 a25, v53
    v_accvgpr_write_b32 a26, v54
    v_accvgpr_write_b32 a27, v55
    v_accvgpr_write_b32 a28, v56
    v_accvgpr_write_b32 a29, v57
    v_accvgpr_write_b32 a30, v58
    v_accvgpr_write_b32 a31, v59
    v_exp_f32 v52, v64
    v_exp_f32 v53, v65
    v_exp_f32 v54, v66
    v_exp_f32 v55, v67
    v_exp_f32 v56, v68
    v_exp_f32 v57, v69
    v_exp_f32 v58, v70
    v_exp_f32 v59, v71
    s_nop 0
    v_cvt_pk_bf16_f32 v128, v52, v53
    v_cvt_pk_bf16_f32 v129, v54, v55
    v_cvt_pk_bf16_f32 v130, v56, v57
    v_cvt_pk_bf16_f32 v131, v58, v59
    s_nop 1
    v_mfma_f32_16x16x32_bf16 v[28:31], v[44:47], v[128:131], 0
    v_max3_f32 v48, v72, v73, v74
    v_max3_f32 v48, v48, v75, v76
    v_max3_f32 v48, v48, v77, v78
    v_max3_f32 v48, v48, v79, 0
    v_mov_b32 v49, v48
    s_nop 1
    v_permlane32_swap_b32 v48, v49
    s_nop 1
    v_max_f32 v48, v48, v49
    v_mov_b32 v49, v48
    s_nop 1
    v_permlane16_swap_b32 v48, v49
    s_nop 1
    v_max_f32 v48, v48, v49
    v_exp_f32 v49, -v48
    v_sub_f32 v72, v72, v48
    v_sub_f32 v73, v73, v48
    v_sub_f32 v74, v74, v48
    v_sub_f32 v75, v75, v48
    v_sub_f32 v76, v76, v48
    v_sub_f32 v77, v77, v48
    v_sub_f32 v78, v78, v48
    v_sub_f32 v79, v79, v48
    v_sub_f32 v104, v104, v48
    v_sub_f32 v105, v105, v48
    v_sub_f32 v106, v106, v48
    v_sub_f32 v107, v107, v48
    v_sub_f32 v108, v108, v48
    v_sub_f32 v109, v109, v48
    v_sub_f32 v110, v110, v48
    v_sub_f32 v111, v111, v48
    v_sub_f32 v168, v168, v48
    v_sub_f32 v169, v169, v48
    v_sub_f32 v170, v170, v48
    v_sub_f32 v171, v171, v48
    v_sub_f32 v172, v172, v48
    v_sub_f32 v173, v173, v48
    v_sub_f32 v174, v174, v48
    v_sub_f32 v175, v175, v48
    v_mul_f32 v13, v13, v49
    v_accvgpr_read_b32 v52, a32
    v_accvgpr_read_b32 v53, a33
    v_accvgpr_read_b32 v54, a34
    v_accvgpr_read_b32 v55, a35
    v_accvgpr_read_b32 v56, a36
    v_accvgpr_read_b32 v57, a37
    v_accvgpr_read_b32 v58, a38
    v_accvgpr_read_b32 v59, a39
    v_mul_f32 v52, v52, v49
    v_mul_f32 v53, v53, v49
    v_mul_f32 v54, v54, v49
    v_mul_f32 v55, v55, v49
    v_mul_f32 v56, v56, v49
    v_mul_f32 v57, v57, v49
    v_mul_f32 v58, v58, v49
    v_mul_f32 v59, v59, v49
    v_accvgpr_write_b32 a32, v52
    v_accvgpr_write_b32 a33, v53
    v_accvgpr_write_b32 a34, v54
    v_accvgpr_write_b32 a35, v55
    v_accvgpr_write_b32 a36, v56
    v_accvgpr_write_b32 a37, v57
    v_accvgpr_write_b32 a38, v58
    v_accvgpr_write_b32 a39, v59
    v_accvgpr_read_b32 v52, a40
    v_accvgpr_read_b32 v53, a41
    v_accvgpr_read_b32 v54, a42
    v_accvgpr_read_b32 v55, a43
    v_accvgpr_read_b32 v56, a44
    v_accvgpr_read_b32 v57, a45
    v_accvgpr_read_b32 v58, a46
    v_accvgpr_read_b32 v59, a47
    v_mul_f32 v52, v52, v49
    v_mul_f32 v53, v53, v49
    v_mul_f32 v54, v54, v49
    v_mul_f32 v55, v55, v49
    v_mul_f32 v56, v56, v49
    v_mul_f32 v57, v57, v49
    v_mul_f32 v58, v58, v49
    v_mul_f32 v59, v59, v49
    v_accvgpr_write_b32 a40, v52
    v_accvgpr_write_b32 a41, v53
    v_accvgpr_write_b32 a42, v54
    v_accvgpr_write_b32 a43, v55
    v_accvgpr_write_b32 a44, v56
    v_accvgpr_write_b32 a45, v57
    v_accvgpr_write_b32 a46, v58
    v_accvgpr_write_b32 a47, v59
    v_accvgpr_read_b32 v52, a48
    v_accvgpr_read_b32 v53, a49
    v_accvgpr_read_b32 v54, a50
    v_accvgpr_read_b32 v55, a51
    v_accvgpr_read_b32 v56, a52
    v_accvgpr_read_b32 v57, a53
    v_accvgpr_read_b32 v58, a54
    v_accvgpr_read_b32 v59, a55
    v_mul_f32 v52, v52, v49
    v_mul_f32 v53, v53, v49
    v_mul_f32 v54, v54, v49
    v_mul_f32 v55, v55, v49
    v_mul_f32 v56, v56, v49
    v_mul_f32 v57, v57, v49
    v_mul_f32 v58, v58, v49
    v_mul_f32 v59, v59, v49
    v_accvgpr_write_b32 a48, v52
    v_accvgpr_write_b32 a49, v53
    v_accvgpr_write_b32 a50, v54
    v_accvgpr_write_b32 a51, v55
    v_accvgpr_write_b32 a52, v56
    v_accvgpr_write_b32 a53, v57
    v_accvgpr_write_b32 a54, v58
    v_accvgpr_write_b32 a55, v59
    v_accvgpr_read_b32 v52, a56
    v_accvgpr_read_b32 v53, a57
    v_accvgpr_read_b32 v54, a58
    v_accvgpr_read_b32 v55, a59
    v_accvgpr_read_b32 v56, a60
    v_accvgpr_read_b32 v57, a61
    v_accvgpr_read_b32 v58, a62
    v_accvgpr_read_b32 v59, a63
    v_mul_f32 v52, v52, v49
    v_mul_f32 v53, v53, v49
    v_mul_f32 v54, v54, v49
    v_mul_f32 v55, v55, v49
    v_mul_f32 v56, v56, v49
    v_mul_f32 v57, v57, v49
    v_mul_f32 v58, v58, v49
    v_mul_f32 v59, v59, v49
    v_accvgpr_write_b32 a56, v52
    v_accvgpr_write_b32 a57, v53
    v_accvgpr_write_b32 a58, v54
    v_accvgpr_write_b32 a59, v55
    v_accvgpr_write_b32 a60, v56
    v_accvgpr_write_b32 a61, v57
    v_accvgpr_write_b32 a62, v58
    v_accvgpr_write_b32 a63, v59
    v_exp_f32 v52, v72
    v_exp_f32 v53, v73
    v_exp_f32 v54, v74
    v_exp_f32 v55, v75
    v_exp_f32 v56, v76
    v_exp_f32 v57, v77
    v_exp_f32 v58, v78
    v_exp_f32 v59, v79
    s_nop 0
    v_cvt_pk_bf16_f32 v132, v52, v53
    v_cvt_pk_bf16_f32 v133, v54, v55
    v_cvt_pk_bf16_f32 v134, v56, v57
    v_cvt_pk_bf16_f32 v135, v58, v59
    s_nop 1
    v_mfma_f32_16x16x32_bf16 v[32:35], v[44:47], v[132:135], 0
    s_nop 7
    s_setpc_b64 s[70:71]
mega_kernel_rs0458:
    s_nop 15
    v_max3_f32 v48, v64, v65, v66
    v_max3_f32 v48, v48, v67, v68
    v_max3_f32 v48, v48, v69, v70
    v_max3_f32 v48, v48, v71, 0
    v_mov_b32 v49, v48
    s_nop 1
    v_permlane32_swap_b32 v48, v49
    s_nop 1
    v_max_f32 v48, v48, v49
    v_mov_b32 v49, v48
    s_nop 1
    v_permlane16_swap_b32 v48, v49
    s_nop 1
    v_max_f32 v48, v48, v49
    v_exp_f32 v49, -v48
    v_sub_f32 v64, v64, v48
    v_sub_f32 v65, v65, v48
    v_sub_f32 v66, v66, v48
    v_sub_f32 v67, v67, v48
    v_sub_f32 v68, v68, v48
    v_sub_f32 v69, v69, v48
    v_sub_f32 v70, v70, v48
    v_sub_f32 v71, v71, v48
    v_sub_f32 v96, v96, v48
    v_sub_f32 v97, v97, v48
    v_sub_f32 v98, v98, v48
    v_sub_f32 v99, v99, v48
    v_sub_f32 v100, v100, v48
    v_sub_f32 v101, v101, v48
    v_sub_f32 v102, v102, v48
    v_sub_f32 v103, v103, v48
    v_sub_f32 v160, v160, v48
    v_sub_f32 v161, v161, v48
    v_sub_f32 v162, v162, v48
    v_sub_f32 v163, v163, v48
    v_sub_f32 v164, v164, v48
    v_sub_f32 v165, v165, v48
    v_sub_f32 v166, v166, v48
    v_sub_f32 v167, v167, v48
    v_mul_f32 v12, v12, v49
    v_accvgpr_read_b32 v52, a0
    v_accvgpr_read_b32 v53, a1
    v_accvgpr_read_b32 v54, a2
    v_accvgpr_read_b32 v55, a3
    v_accvgpr_read_b32 v56, a4
    v_accvgpr_read_b32 v57, a5
    v_accvgpr_read_b32 v58, a6
    v_accvgpr_read_b32 v59, a7
    v_mul_f32 v52, v52, v49
    v_mul_f32 v53, v53, v49
    v_mul_f32 v54, v54, v49
    v_mul_f32 v55, v55, v49
    v_mul_f32 v56, v56, v49
    v_mul_f32 v57, v57, v49
    v_mul_f32 v58, v58, v49
    v_mul_f32 v59, v59, v49
    v_accvgpr_write_b32 a0, v52
    v_accvgpr_write_b32 a1, v53
    v_accvgpr_write_b32 a2, v54
    v_accvgpr_write_b32 a3, v55
    v_accvgpr_write_b32 a4, v56
    v_accvgpr_write_b32 a5, v57
    v_accvgpr_write_b32 a6, v58
    v_accvgpr_write_b32 a7, v59
    v_accvgpr_read_b32 v52, a8
    v_accvgpr_read_b32 v53, a9
    v_accvgpr_read_b32 v54, a10
    v_accvgpr_read_b32 v55, a11
    v_accvgpr_read_b32 v56, a12
    v_accvgpr_read_b32 v57, a13
    v_accvgpr_read_b32 v58, a14
    v_accvgpr_read_b32 v59, a15
    v_mul_f32 v52, v52, v49
    v_mul_f32 v53, v53, v49
    v_mul_f32 v54, v54, v49
    v_mul_f32 v55, v55, v49
    v_mul_f32 v56, v56, v49
    v_mul_f32 v57, v57, v49
    v_mul_f32 v58, v58, v49
    v_mul_f32 v59, v59, v49
    v_accvgpr_write_b32 a8, v52
    v_accvgpr_write_b32 a9, v53
    v_accvgpr_write_b32 a10, v54
    v_accvgpr_write_b32 a11, v55
    v_accvgpr_write_b32 a12, v56
    v_accvgpr_write_b32 a13, v57
    v_accvgpr_write_b32 a14, v58
    v_accvgpr_write_b32 a15, v59
    v_accvgpr_read_b32 v52, a16
    v_accvgpr_read_b32 v53, a17
    v_accvgpr_read_b32 v54, a18
    v_accvgpr_read_b32 v55, a19
    v_accvgpr_read_b32 v56, a20
    v_accvgpr_read_b32 v57, a21
    v_accvgpr_read_b32 v58, a22
    v_accvgpr_read_b32 v59, a23
    v_mul_f32 v52, v52, v49
    v_mul_f32 v53, v53, v49
    v_mul_f32 v54, v54, v49
    v_mul_f32 v55, v55, v49
    v_mul_f32 v56, v56, v49
    v_mul_f32 v57, v57, v49
    v_mul_f32 v58, v58, v49
    v_mul_f32 v59, v59, v49
    v_accvgpr_write_b32 a16, v52
    v_accvgpr_write_b32 a17, v53
    v_accvgpr_write_b32 a18, v54
    v_accvgpr_write_b32 a19, v55
    v_accvgpr_write_b32 a20, v56
    v_accvgpr_write_b32 a21, v57
    v_accvgpr_write_b32 a22, v58
    v_accvgpr_write_b32 a23, v59
    v_accvgpr_read_b32 v52, a24
    v_accvgpr_read_b32 v53, a25
    v_accvgpr_read_b32 v54, a26
    v_accvgpr_read_b32 v55, a27
    v_accvgpr_read_b32 v56, a28
    v_accvgpr_read_b32 v57, a29
    v_accvgpr_read_b32 v58, a30
    v_accvgpr_read_b32 v59, a31
    v_mul_f32 v52, v52, v49
    v_mul_f32 v53, v53, v49
    v_mul_f32 v54, v54, v49
    v_mul_f32 v55, v55, v49
    v_mul_f32 v56, v56, v49
    v_mul_f32 v57, v57, v49
    v_mul_f32 v58, v58, v49
    v_mul_f32 v59, v59, v49
    v_accvgpr_write_b32 a24, v52
    v_accvgpr_write_b32 a25, v53
    v_accvgpr_write_b32 a26, v54
    v_accvgpr_write_b32 a27, v55
    v_accvgpr_write_b32 a28, v56
    v_accvgpr_write_b32 a29, v57
    v_accvgpr_write_b32 a30, v58
    v_accvgpr_write_b32 a31, v59
    v_exp_f32 v52, v64
    v_exp_f32 v53, v65
    v_exp_f32 v54, v66
    v_exp_f32 v55, v67
    v_exp_f32 v56, v68
    v_exp_f32 v57, v69
    v_exp_f32 v58, v70
    v_exp_f32 v59, v71
    s_nop 0
    v_cvt_pk_bf16_f32 v128, v52, v53
    v_cvt_pk_bf16_f32 v129, v54, v55
    v_cvt_pk_bf16_f32 v130, v56, v57
    v_cvt_pk_bf16_f32 v131, v58, v59
    s_nop 1
    v_mfma_f32_16x16x32_bf16 v[28:31], v[44:47], v[128:131], 0
    v_max3_f32 v48, v72, v73, v74
    v_max3_f32 v48, v48, v75, v76
    v_max3_f32 v48, v48, v77, v78
    v_max3_f32 v48, v48, v79, 0
    v_mov_b32 v49, v48
    s_nop 1
    v_permlane32_swap_b32 v48, v49
    s_nop 1
    v_max_f32 v48, v48, v49
    v_mov_b32 v49, v48
    s_nop 1
    v_permlane16_swap_b32 v48, v49
    s_nop 1
    v_max_f32 v48, v48, v49
    v_exp_f32 v49, -v48
    v_sub_f32 v72, v72, v48
    v_sub_f32 v73, v73, v48
    v_sub_f32 v74, v74, v48
    v_sub_f32 v75, v75, v48
    v_sub_f32 v76, v76, v48
    v_sub_f32 v77, v77, v48
    v_sub_f32 v78, v78, v48
    v_sub_f32 v79, v79, v48
    v_sub_f32 v104, v104, v48
    v_sub_f32 v105, v105, v48
    v_sub_f32 v106, v106, v48
    v_sub_f32 v107, v107, v48
    v_sub_f32 v108, v108, v48
    v_sub_f32 v109, v109, v48
    v_sub_f32 v110, v110, v48
    v_sub_f32 v111, v111, v48
    v_sub_f32 v168, v168, v48
    v_sub_f32 v169, v169, v48
    v_sub_f32 v170, v170, v48
    v_sub_f32 v171, v171, v48
    v_sub_f32 v172, v172, v48
    v_sub_f32 v173, v173, v48
    v_sub_f32 v174, v174, v48
    v_sub_f32 v175, v175, v48
    v_mul_f32 v13, v13, v49
    v_accvgpr_read_b32 v52, a32
    v_accvgpr_read_b32 v53, a33
    v_accvgpr_read_b32 v54, a34
    v_accvgpr_read_b32 v55, a35
    v_accvgpr_read_b32 v56, a36
    v_accvgpr_read_b32 v57, a37
    v_accvgpr_read_b32 v58, a38
    v_accvgpr_read_b32 v59, a39
    v_mul_f32 v52, v52, v49
    v_mul_f32 v53, v53, v49
    v_mul_f32 v54, v54, v49
    v_mul_f32 v55, v55, v49
    v_mul_f32 v56, v56, v49
    v_mul_f32 v57, v57, v49
    v_mul_f32 v58, v58, v49
    v_mul_f32 v59, v59, v49
    v_accvgpr_write_b32 a32, v52
    v_accvgpr_write_b32 a33, v53
    v_accvgpr_write_b32 a34, v54
    v_accvgpr_write_b32 a35, v55
    v_accvgpr_write_b32 a36, v56
    v_accvgpr_write_b32 a37, v57
    v_accvgpr_write_b32 a38, v58
    v_accvgpr_write_b32 a39, v59
    v_accvgpr_read_b32 v52, a40
    v_accvgpr_read_b32 v53, a41
    v_accvgpr_read_b32 v54, a42
    v_accvgpr_read_b32 v55, a43
    v_accvgpr_read_b32 v56, a44
    v_accvgpr_read_b32 v57, a45
    v_accvgpr_read_b32 v58, a46
    v_accvgpr_read_b32 v59, a47
    v_mul_f32 v52, v52, v49
    v_mul_f32 v53, v53, v49
    v_mul_f32 v54, v54, v49
    v_mul_f32 v55, v55, v49
    v_mul_f32 v56, v56, v49
    v_mul_f32 v57, v57, v49
    v_mul_f32 v58, v58, v49
    v_mul_f32 v59, v59, v49
    v_accvgpr_write_b32 a40, v52
    v_accvgpr_write_b32 a41, v53
    v_accvgpr_write_b32 a42, v54
    v_accvgpr_write_b32 a43, v55
    v_accvgpr_write_b32 a44, v56
    v_accvgpr_write_b32 a45, v57
    v_accvgpr_write_b32 a46, v58
    v_accvgpr_write_b32 a47, v59
    v_accvgpr_read_b32 v52, a48
    v_accvgpr_read_b32 v53, a49
    v_accvgpr_read_b32 v54, a50
    v_accvgpr_read_b32 v55, a51
    v_accvgpr_read_b32 v56, a52
    v_accvgpr_read_b32 v57, a53
    v_accvgpr_read_b32 v58, a54
    v_accvgpr_read_b32 v59, a55
    v_mul_f32 v52, v52, v49
    v_mul_f32 v53, v53, v49
    v_mul_f32 v54, v54, v49
    v_mul_f32 v55, v55, v49
    v_mul_f32 v56, v56, v49
    v_mul_f32 v57, v57, v49
    v_mul_f32 v58, v58, v49
    v_mul_f32 v59, v59, v49
    v_accvgpr_write_b32 a48, v52
    v_accvgpr_write_b32 a49, v53
    v_accvgpr_write_b32 a50, v54
    v_accvgpr_write_b32 a51, v55
    v_accvgpr_write_b32 a52, v56
    v_accvgpr_write_b32 a53, v57
    v_accvgpr_write_b32 a54, v58
    v_accvgpr_write_b32 a55, v59
    v_accvgpr_read_b32 v52, a56
    v_accvgpr_read_b32 v53, a57
    v_accvgpr_read_b32 v54, a58
    v_accvgpr_read_b32 v55, a59
    v_accvgpr_read_b32 v56, a60
    v_accvgpr_read_b32 v57, a61
    v_accvgpr_read_b32 v58, a62
    v_accvgpr_read_b32 v59, a63
    v_mul_f32 v52, v52, v49
    v_mul_f32 v53, v53, v49
    v_mul_f32 v54, v54, v49
    v_mul_f32 v55, v55, v49
    v_mul_f32 v56, v56, v49
    v_mul_f32 v57, v57, v49
    v_mul_f32 v58, v58, v49
    v_mul_f32 v59, v59, v49
    v_accvgpr_write_b32 a56, v52
    v_accvgpr_write_b32 a57, v53
    v_accvgpr_write_b32 a58, v54
    v_accvgpr_write_b32 a59, v55
    v_accvgpr_write_b32 a60, v56
    v_accvgpr_write_b32 a61, v57
    v_accvgpr_write_b32 a62, v58
    v_accvgpr_write_b32 a63, v59
    v_exp_f32 v52, v72
    v_exp_f32 v53, v73
    v_exp_f32 v54, v74
    v_exp_f32 v55, v75
    v_exp_f32 v56, v76
    v_exp_f32 v57, v77
    v_exp_f32 v58, v78
    v_exp_f32 v59, v79
    s_nop 0
    v_cvt_pk_bf16_f32 v132, v52, v53
    v_cvt_pk_bf16_f32 v133, v54, v55
    v_cvt_pk_bf16_f32 v134, v56, v57
    v_cvt_pk_bf16_f32 v135, v58, v59
    s_nop 1
    v_mfma_f32_16x16x32_bf16 v[32:35], v[44:47], v[132:135], 0
    v_max3_f32 v48, v80, v81, v82
    v_max3_f32 v48, v48, v83, v84
    v_max3_f32 v48, v48, v85, v86
    v_max3_f32 v48, v48, v87, 0
    v_mov_b32 v49, v48
    s_nop 1
    v_permlane32_swap_b32 v48, v49
    s_nop 1
    v_max_f32 v48, v48, v49
    v_mov_b32 v49, v48
    s_nop 1
    v_permlane16_swap_b32 v48, v49
    s_nop 1
    v_max_f32 v48, v48, v49
    v_exp_f32 v49, -v48
    v_sub_f32 v80, v80, v48
    v_sub_f32 v81, v81, v48
    v_sub_f32 v82, v82, v48
    v_sub_f32 v83, v83, v48
    v_sub_f32 v84, v84, v48
    v_sub_f32 v85, v85, v48
    v_sub_f32 v86, v86, v48
    v_sub_f32 v87, v87, v48
    v_sub_f32 v112, v112, v48
    v_sub_f32 v113, v113, v48
    v_sub_f32 v114, v114, v48
    v_sub_f32 v115, v115, v48
    v_sub_f32 v116, v116, v48
    v_sub_f32 v117, v117, v48
    v_sub_f32 v118, v118, v48
    v_sub_f32 v119, v119, v48
    v_sub_f32 v176, v176, v48
    v_sub_f32 v177, v177, v48
    v_sub_f32 v178, v178, v48
    v_sub_f32 v179, v179, v48
    v_sub_f32 v180, v180, v48
    v_sub_f32 v181, v181, v48
    v_sub_f32 v182, v182, v48
    v_sub_f32 v183, v183, v48
    v_mul_f32 v14, v14, v49
    v_accvgpr_read_b32 v52, a64
    v_accvgpr_read_b32 v53, a65
    v_accvgpr_read_b32 v54, a66
    v_accvgpr_read_b32 v55, a67
    v_accvgpr_read_b32 v56, a68
    v_accvgpr_read_b32 v57, a69
    v_accvgpr_read_b32 v58, a70
    v_accvgpr_read_b32 v59, a71
    v_mul_f32 v52, v52, v49
    v_mul_f32 v53, v53, v49
    v_mul_f32 v54, v54, v49
    v_mul_f32 v55, v55, v49
    v_mul_f32 v56, v56, v49
    v_mul_f32 v57, v57, v49
    v_mul_f32 v58, v58, v49
    v_mul_f32 v59, v59, v49
    v_accvgpr_write_b32 a64, v52
    v_accvgpr_write_b32 a65, v53
    v_accvgpr_write_b32 a66, v54
    v_accvgpr_write_b32 a67, v55
    v_accvgpr_write_b32 a68, v56
    v_accvgpr_write_b32 a69, v57
    v_accvgpr_write_b32 a70, v58
    v_accvgpr_write_b32 a71, v59
    v_accvgpr_read_b32 v52, a72
    v_accvgpr_read_b32 v53, a73
    v_accvgpr_read_b32 v54, a74
    v_accvgpr_read_b32 v55, a75
    v_accvgpr_read_b32 v56, a76
    v_accvgpr_read_b32 v57, a77
    v_accvgpr_read_b32 v58, a78
    v_accvgpr_read_b32 v59, a79
    v_mul_f32 v52, v52, v49
    v_mul_f32 v53, v53, v49
    v_mul_f32 v54, v54, v49
    v_mul_f32 v55, v55, v49
    v_mul_f32 v56, v56, v49
    v_mul_f32 v57, v57, v49
    v_mul_f32 v58, v58, v49
    v_mul_f32 v59, v59, v49
    v_accvgpr_write_b32 a72, v52
    v_accvgpr_write_b32 a73, v53
    v_accvgpr_write_b32 a74, v54
    v_accvgpr_write_b32 a75, v55
    v_accvgpr_write_b32 a76, v56
    v_accvgpr_write_b32 a77, v57
    v_accvgpr_write_b32 a78, v58
    v_accvgpr_write_b32 a79, v59
    v_accvgpr_read_b32 v52, a80
    v_accvgpr_read_b32 v53, a81
    v_accvgpr_read_b32 v54, a82
    v_accvgpr_read_b32 v55, a83
    v_accvgpr_read_b32 v56, a84
    v_accvgpr_read_b32 v57, a85
    v_accvgpr_read_b32 v58, a86
    v_accvgpr_read_b32 v59, a87
    v_mul_f32 v52, v52, v49
    v_mul_f32 v53, v53, v49
    v_mul_f32 v54, v54, v49
    v_mul_f32 v55, v55, v49
    v_mul_f32 v56, v56, v49
    v_mul_f32 v57, v57, v49
    v_mul_f32 v58, v58, v49
    v_mul_f32 v59, v59, v49
    v_accvgpr_write_b32 a80, v52
    v_accvgpr_write_b32 a81, v53
    v_accvgpr_write_b32 a82, v54
    v_accvgpr_write_b32 a83, v55
    v_accvgpr_write_b32 a84, v56
    v_accvgpr_write_b32 a85, v57
    v_accvgpr_write_b32 a86, v58
    v_accvgpr_write_b32 a87, v59
    v_accvgpr_read_b32 v52, a88
    v_accvgpr_read_b32 v53, a89
    v_accvgpr_read_b32 v54, a90
    v_accvgpr_read_b32 v55, a91
    v_accvgpr_read_b32 v56, a92
    v_accvgpr_read_b32 v57, a93
    v_accvgpr_read_b32 v58, a94
    v_accvgpr_read_b32 v59, a95
    v_mul_f32 v52, v52, v49
    v_mul_f32 v53, v53, v49
    v_mul_f32 v54, v54, v49
    v_mul_f32 v55, v55, v49
    v_mul_f32 v56, v56, v49
    v_mul_f32 v57, v57, v49
    v_mul_f32 v58, v58, v49
    v_mul_f32 v59, v59, v49
    v_accvgpr_write_b32 a88, v52
    v_accvgpr_write_b32 a89, v53
    v_accvgpr_write_b32 a90, v54
    v_accvgpr_write_b32 a91, v55
    v_accvgpr_write_b32 a92, v56
    v_accvgpr_write_b32 a93, v57
    v_accvgpr_write_b32 a94, v58
    v_accvgpr_write_b32 a95, v59
    v_exp_f32 v52, v80
    v_exp_f32 v53, v81
    v_exp_f32 v54, v82
    v_exp_f32 v55, v83
    v_exp_f32 v56, v84
    v_exp_f32 v57, v85
    v_exp_f32 v58, v86
    v_exp_f32 v59, v87
    s_nop 0
    v_cvt_pk_bf16_f32 v136, v52, v53
    v_cvt_pk_bf16_f32 v137, v54, v55
    v_cvt_pk_bf16_f32 v138, v56, v57
    v_cvt_pk_bf16_f32 v139, v58, v59
    s_nop 1
    v_mfma_f32_16x16x32_bf16 v[36:39], v[44:47], v[136:139], 0
    v_max3_f32 v48, v88, v89, v90
    v_max3_f32 v48, v48, v91, v92
    v_max3_f32 v48, v48, v93, v94
    v_max3_f32 v48, v48, v95, 0
    v_mov_b32 v49, v48
    s_nop 1
    v_permlane32_swap_b32 v48, v49
    s_nop 1
    v_max_f32 v48, v48, v49
    v_mov_b32 v49, v48
    s_nop 1
    v_permlane16_swap_b32 v48, v49
    s_nop 1
    v_max_f32 v48, v48, v49
    v_exp_f32 v49, -v48
    v_sub_f32 v88, v88, v48
    v_sub_f32 v89, v89, v48
    v_sub_f32 v90, v90, v48
    v_sub_f32 v91, v91, v48
    v_sub_f32 v92, v92, v48
    v_sub_f32 v93, v93, v48
    v_sub_f32 v94, v94, v48
    v_sub_f32 v95, v95, v48
    v_sub_f32 v120, v120, v48
    v_sub_f32 v121, v121, v48
    v_sub_f32 v122, v122, v48
    v_sub_f32 v123, v123, v48
    v_sub_f32 v124, v124, v48
    v_sub_f32 v125, v125, v48
    v_sub_f32 v126, v126, v48
    v_sub_f32 v127, v127, v48
    v_sub_f32 v184, v184, v48
    v_sub_f32 v185, v185, v48
    v_sub_f32 v186, v186, v48
    v_sub_f32 v187, v187, v48
    v_sub_f32 v188, v188, v48
    v_sub_f32 v189, v189, v48
    v_sub_f32 v190, v190, v48
    v_sub_f32 v191, v191, v48
    v_mul_f32 v15, v15, v49
    v_accvgpr_read_b32 v52, a96
    v_accvgpr_read_b32 v53, a97
    v_accvgpr_read_b32 v54, a98
    v_accvgpr_read_b32 v55, a99
    v_accvgpr_read_b32 v56, a100
    v_accvgpr_read_b32 v57, a101
    v_accvgpr_read_b32 v58, a102
    v_accvgpr_read_b32 v59, a103
    v_mul_f32 v52, v52, v49
    v_mul_f32 v53, v53, v49
    v_mul_f32 v54, v54, v49
    v_mul_f32 v55, v55, v49
    v_mul_f32 v56, v56, v49
    v_mul_f32 v57, v57, v49
    v_mul_f32 v58, v58, v49
    v_mul_f32 v59, v59, v49
    v_accvgpr_write_b32 a96, v52
    v_accvgpr_write_b32 a97, v53
    v_accvgpr_write_b32 a98, v54
    v_accvgpr_write_b32 a99, v55
    v_accvgpr_write_b32 a100, v56
    v_accvgpr_write_b32 a101, v57
    v_accvgpr_write_b32 a102, v58
    v_accvgpr_write_b32 a103, v59
    v_accvgpr_read_b32 v52, a104
    v_accvgpr_read_b32 v53, a105
    v_accvgpr_read_b32 v54, a106
    v_accvgpr_read_b32 v55, a107
    v_accvgpr_read_b32 v56, a108
    v_accvgpr_read_b32 v57, a109
    v_accvgpr_read_b32 v58, a110
    v_accvgpr_read_b32 v59, a111
    v_mul_f32 v52, v52, v49
    v_mul_f32 v53, v53, v49
    v_mul_f32 v54, v54, v49
    v_mul_f32 v55, v55, v49
    v_mul_f32 v56, v56, v49
    v_mul_f32 v57, v57, v49
    v_mul_f32 v58, v58, v49
    v_mul_f32 v59, v59, v49
    v_accvgpr_write_b32 a104, v52
    v_accvgpr_write_b32 a105, v53
    v_accvgpr_write_b32 a106, v54
    v_accvgpr_write_b32 a107, v55
    v_accvgpr_write_b32 a108, v56
    v_accvgpr_write_b32 a109, v57
    v_accvgpr_write_b32 a110, v58
    v_accvgpr_write_b32 a111, v59
    v_accvgpr_read_b32 v52, a112
    v_accvgpr_read_b32 v53, a113
    v_accvgpr_read_b32 v54, a114
    v_accvgpr_read_b32 v55, a115
    v_accvgpr_read_b32 v56, a116
    v_accvgpr_read_b32 v57, a117
    v_accvgpr_read_b32 v58, a118
    v_accvgpr_read_b32 v59, a119
    v_mul_f32 v52, v52, v49
    v_mul_f32 v53, v53, v49
    v_mul_f32 v54, v54, v49
    v_mul_f32 v55, v55, v49
    v_mul_f32 v56, v56, v49
    v_mul_f32 v57, v57, v49
    v_mul_f32 v58, v58, v49
    v_mul_f32 v59, v59, v49
    v_accvgpr_write_b32 a112, v52
    v_accvgpr_write_b32 a113, v53
    v_accvgpr_write_b32 a114, v54
    v_accvgpr_write_b32 a115, v55
    v_accvgpr_write_b32 a116, v56
    v_accvgpr_write_b32 a117, v57
    v_accvgpr_write_b32 a118, v58
    v_accvgpr_write_b32 a119, v59
    v_accvgpr_read_b32 v52, a120
    v_accvgpr_read_b32 v53, a121
    v_accvgpr_read_b32 v54, a122
    v_accvgpr_read_b32 v55, a123
    v_accvgpr_read_b32 v56, a124
    v_accvgpr_read_b32 v57, a125
    v_accvgpr_read_b32 v58, a126
    v_accvgpr_read_b32 v59, a127
    v_mul_f32 v52, v52, v49
    v_mul_f32 v53, v53, v49
    v_mul_f32 v54, v54, v49
    v_mul_f32 v55, v55, v49
    v_mul_f32 v56, v56, v49
    v_mul_f32 v57, v57, v49
    v_mul_f32 v58, v58, v49
    v_mul_f32 v59, v59, v49
    v_accvgpr_write_b32 a120, v52
    v_accvgpr_write_b32 a121, v53
    v_accvgpr_write_b32 a122, v54
    v_accvgpr_write_b32 a123, v55
    v_accvgpr_write_b32 a124, v56
    v_accvgpr_write_b32 a125, v57
    v_accvgpr_write_b32 a126, v58
    v_accvgpr_write_b32 a127, v59
    v_exp_f32 v52, v88
    v_exp_f32 v53, v89
    v_exp_f32 v54, v90
    v_exp_f32 v55, v91
    v_exp_f32 v56, v92
    v_exp_f32 v57, v93
    v_exp_f32 v58, v94
    v_exp_f32 v59, v95
    s_nop 0
    v_cvt_pk_bf16_f32 v140, v52, v53
    v_cvt_pk_bf16_f32 v141, v54, v55
    v_cvt_pk_bf16_f32 v142, v56, v57
    v_cvt_pk_bf16_f32 v143, v58, v59
    s_nop 1
    v_mfma_f32_16x16x32_bf16 v[40:43], v[44:47], v[140:143], 0
    s_nop 7
    s_setpc_b64 s[70:71]
mega_kernel_rs1259:
    s_nop 15
    v_max3_f32 v48, v96, v97, v98
    v_max3_f32 v48, v48, v99, v100
    v_max3_f32 v48, v48, v101, v102
    v_max3_f32 v48, v48, v103, 0
    v_mov_b32 v49, v48
    s_nop 1
    v_permlane32_swap_b32 v48, v49
    s_nop 1
    v_max_f32 v48, v48, v49
    v_mov_b32 v49, v48
    s_nop 1
    v_permlane16_swap_b32 v48, v49
    s_nop 1
    v_max_f32 v48, v48, v49
    v_exp_f32 v49, -v48
    v_sub_f32 v96, v96, v48
    v_sub_f32 v97, v97, v48
    v_sub_f32 v98, v98, v48
    v_sub_f32 v99, v99, v48
    v_sub_f32 v100, v100, v48
    v_sub_f32 v101, v101, v48
    v_sub_f32 v102, v102, v48
    v_sub_f32 v103, v103, v48
    v_sub_f32 v64, v64, v48
    v_sub_f32 v65, v65, v48
    v_sub_f32 v66, v66, v48
    v_sub_f32 v67, v67, v48
    v_sub_f32 v68, v68, v48
    v_sub_f32 v69, v69, v48
    v_sub_f32 v70, v70, v48
    v_sub_f32 v71, v71, v48
    v_sub_f32 v160, v160, v48
    v_sub_f32 v161, v161, v48
    v_sub_f32 v162, v162, v48
    v_sub_f32 v163, v163, v48
    v_sub_f32 v164, v164, v48
    v_sub_f32 v165, v165, v48
    v_sub_f32 v166, v166, v48
    v_sub_f32 v167, v167, v48
    v_mul_f32 v12, v12, v49
    v_accvgpr_read_b32 v52, a0
    v_accvgpr_read_b32 v53, a1
    v_accvgpr_read_b32 v54, a2
    v_accvgpr_read_b32 v55, a3
    v_accvgpr_read_b32 v56, a4
    v_accvgpr_read_b32 v57, a5
    v_accvgpr_read_b32 v58, a6
    v_accvgpr_read_b32 v59, a7
    v_mul_f32 v52, v52, v49
    v_mul_f32 v53, v53, v49
    v_mul_f32 v54, v54, v49
    v_mul_f32 v55, v55, v49
    v_mul_f32 v56, v56, v49
    v_mul_f32 v57, v57, v49
    v_mul_f32 v58, v58, v49
    v_mul_f32 v59, v59, v49
    v_accvgpr_write_b32 a0, v52
    v_accvgpr_write_b32 a1, v53
    v_accvgpr_write_b32 a2, v54
    v_accvgpr_write_b32 a3, v55
    v_accvgpr_write_b32 a4, v56
    v_accvgpr_write_b32 a5, v57
    v_accvgpr_write_b32 a6, v58
    v_accvgpr_write_b32 a7, v59
    v_accvgpr_read_b32 v52, a8
    v_accvgpr_read_b32 v53, a9
    v_accvgpr_read_b32 v54, a10
    v_accvgpr_read_b32 v55, a11
    v_accvgpr_read_b32 v56, a12
    v_accvgpr_read_b32 v57, a13
    v_accvgpr_read_b32 v58, a14
    v_accvgpr_read_b32 v59, a15
    v_mul_f32 v52, v52, v49
    v_mul_f32 v53, v53, v49
    v_mul_f32 v54, v54, v49
    v_mul_f32 v55, v55, v49
    v_mul_f32 v56, v56, v49
    v_mul_f32 v57, v57, v49
    v_mul_f32 v58, v58, v49
    v_mul_f32 v59, v59, v49
    v_accvgpr_write_b32 a8, v52
    v_accvgpr_write_b32 a9, v53
    v_accvgpr_write_b32 a10, v54
    v_accvgpr_write_b32 a11, v55
    v_accvgpr_write_b32 a12, v56
    v_accvgpr_write_b32 a13, v57
    v_accvgpr_write_b32 a14, v58
    v_accvgpr_write_b32 a15, v59
    v_accvgpr_read_b32 v52, a16
    v_accvgpr_read_b32 v53, a17
    v_accvgpr_read_b32 v54, a18
    v_accvgpr_read_b32 v55, a19
    v_accvgpr_read_b32 v56, a20
    v_accvgpr_read_b32 v57, a21
    v_accvgpr_read_b32 v58, a22
    v_accvgpr_read_b32 v59, a23
    v_mul_f32 v52, v52, v49
    v_mul_f32 v53, v53, v49
    v_mul_f32 v54, v54, v49
    v_mul_f32 v55, v55, v49
    v_mul_f32 v56, v56, v49
    v_mul_f32 v57, v57, v49
    v_mul_f32 v58, v58, v49
    v_mul_f32 v59, v59, v49
    v_accvgpr_write_b32 a16, v52
    v_accvgpr_write_b32 a17, v53
    v_accvgpr_write_b32 a18, v54
    v_accvgpr_write_b32 a19, v55
    v_accvgpr_write_b32 a20, v56
    v_accvgpr_write_b32 a21, v57
    v_accvgpr_write_b32 a22, v58
    v_accvgpr_write_b32 a23, v59
    v_accvgpr_read_b32 v52, a24
    v_accvgpr_read_b32 v53, a25
    v_accvgpr_read_b32 v54, a26
    v_accvgpr_read_b32 v55, a27
    v_accvgpr_read_b32 v56, a28
    v_accvgpr_read_b32 v57, a29
    v_accvgpr_read_b32 v58, a30
    v_accvgpr_read_b32 v59, a31
    v_mul_f32 v52, v52, v49
    v_mul_f32 v53, v53, v49
    v_mul_f32 v54, v54, v49
    v_mul_f32 v55, v55, v49
    v_mul_f32 v56, v56, v49
    v_mul_f32 v57, v57, v49
    v_mul_f32 v58, v58, v49
    v_mul_f32 v59, v59, v49
    v_accvgpr_write_b32 a24, v52
    v_accvgpr_write_b32 a25, v53
    v_accvgpr_write_b32 a26, v54
    v_accvgpr_write_b32 a27, v55
    v_accvgpr_write_b32 a28, v56
    v_accvgpr_write_b32 a29, v57
    v_accvgpr_write_b32 a30, v58
    v_accvgpr_write_b32 a31, v59
    v_exp_f32 v52, v96
    v_exp_f32 v53, v97
    v_exp_f32 v54, v98
    v_exp_f32 v55, v99
    v_exp_f32 v56, v100
    v_exp_f32 v57, v101
    v_exp_f32 v58, v102
    v_exp_f32 v59, v103
    s_nop 0
    v_cvt_pk_bf16_f32 v144, v52, v53
    v_cvt_pk_bf16_f32 v145, v54, v55
    v_cvt_pk_bf16_f32 v146, v56, v57
    v_cvt_pk_bf16_f32 v147, v58, v59
    s_nop 1
    v_mfma_f32_16x16x32_bf16 v[28:31], v[44:47], v[144:147], 0
    v_max3_f32 v48, v104, v105, v106
    v_max3_f32 v48, v48, v107, v108
    v_max3_f32 v48, v48, v109, v110
    v_max3_f32 v48, v48, v111, 0
    v_mov_b32 v49, v48
    s_nop 1
    v_permlane32_swap_b32 v48, v49
    s_nop 1
    v_max_f32 v48, v48, v49
    v_mov_b32 v49, v48
    s_nop 1
    v_permlane16_swap_b32 v48, v49
    s_nop 1
    v_max_f32 v48, v48, v49
    v_exp_f32 v49, -v48
    v_sub_f32 v104, v104, v48
    v_sub_f32 v105, v105, v48
    v_sub_f32 v106, v106, v48
    v_sub_f32 v107, v107, v48
    v_sub_f32 v108, v108, v48
    v_sub_f32 v109, v109, v48
    v_sub_f32 v110, v110, v48
    v_sub_f32 v111, v111, v48
    v_sub_f32 v72, v72, v48
    v_sub_f32 v73, v73, v48
    v_sub_f32 v74, v74, v48
    v_sub_f32 v75, v75, v48
    v_sub_f32 v76, v76, v48
    v_sub_f32 v77, v77, v48
    v_sub_f32 v78, v78, v48
    v_sub_f32 v79, v79, v48
    v_sub_f32 v168, v168, v48
    v_sub_f32 v169, v169, v48
    v_sub_f32 v170, v170, v48
    v_sub_f32 v171, v171, v48
    v_sub_f32 v172, v172, v48
    v_sub_f32 v173, v173, v48
    v_sub_f32 v174, v174, v48
    v_sub_f32 v175, v175, v48
    v_mul_f32 v13, v13, v49
    v_accvgpr_read_b32 v52, a32
    v_accvgpr_read_b32 v53, a33
    v_accvgpr_read_b32 v54, a34
    v_accvgpr_read_b32 v55, a35
    v_accvgpr_read_b32 v56, a36
    v_accvgpr_read_b32 v57, a37
    v_accvgpr_read_b32 v58, a38
    v_accvgpr_read_b32 v59, a39
    v_mul_f32 v52, v52, v49
    v_mul_f32 v53, v53, v49
    v_mul_f32 v54, v54, v49
    v_mul_f32 v55, v55, v49
    v_mul_f32 v56, v56, v49
    v_mul_f32 v57, v57, v49
    v_mul_f32 v58, v58, v49
    v_mul_f32 v59, v59, v49
    v_accvgpr_write_b32 a32, v52
    v_accvgpr_write_b32 a33, v53
    v_accvgpr_write_b32 a34, v54
    v_accvgpr_write_b32 a35, v55
    v_accvgpr_write_b32 a36, v56
    v_accvgpr_write_b32 a37, v57
    v_accvgpr_write_b32 a38, v58
    v_accvgpr_write_b32 a39, v59
    v_accvgpr_read_b32 v52, a40
    v_accvgpr_read_b32 v53, a41
    v_accvgpr_read_b32 v54, a42
    v_accvgpr_read_b32 v55, a43
    v_accvgpr_read_b32 v56, a44
    v_accvgpr_read_b32 v57, a45
    v_accvgpr_read_b32 v58, a46
    v_accvgpr_read_b32 v59, a47
    v_mul_f32 v52, v52, v49
    v_mul_f32 v53, v53, v49
    v_mul_f32 v54, v54, v49
    v_mul_f32 v55, v55, v49
    v_mul_f32 v56, v56, v49
    v_mul_f32 v57, v57, v49
    v_mul_f32 v58, v58, v49
    v_mul_f32 v59, v59, v49
    v_accvgpr_write_b32 a40, v52
    v_accvgpr_write_b32 a41, v53
    v_accvgpr_write_b32 a42, v54
    v_accvgpr_write_b32 a43, v55
    v_accvgpr_write_b32 a44, v56
    v_accvgpr_write_b32 a45, v57
    v_accvgpr_write_b32 a46, v58
    v_accvgpr_write_b32 a47, v59
    v_accvgpr_read_b32 v52, a48
    v_accvgpr_read_b32 v53, a49
    v_accvgpr_read_b32 v54, a50
    v_accvgpr_read_b32 v55, a51
    v_accvgpr_read_b32 v56, a52
    v_accvgpr_read_b32 v57, a53
    v_accvgpr_read_b32 v58, a54
    v_accvgpr_read_b32 v59, a55
    v_mul_f32 v52, v52, v49
    v_mul_f32 v53, v53, v49
    v_mul_f32 v54, v54, v49
    v_mul_f32 v55, v55, v49
    v_mul_f32 v56, v56, v49
    v_mul_f32 v57, v57, v49
    v_mul_f32 v58, v58, v49
    v_mul_f32 v59, v59, v49
    v_accvgpr_write_b32 a48, v52
    v_accvgpr_write_b32 a49, v53
    v_accvgpr_write_b32 a50, v54
    v_accvgpr_write_b32 a51, v55
    v_accvgpr_write_b32 a52, v56
    v_accvgpr_write_b32 a53, v57
    v_accvgpr_write_b32 a54, v58
    v_accvgpr_write_b32 a55, v59
    v_accvgpr_read_b32 v52, a56
    v_accvgpr_read_b32 v53, a57
    v_accvgpr_read_b32 v54, a58
    v_accvgpr_read_b32 v55, a59
    v_accvgpr_read_b32 v56, a60
    v_accvgpr_read_b32 v57, a61
    v_accvgpr_read_b32 v58, a62
    v_accvgpr_read_b32 v59, a63
    v_mul_f32 v52, v52, v49
    v_mul_f32 v53, v53, v49
    v_mul_f32 v54, v54, v49
    v_mul_f32 v55, v55, v49
    v_mul_f32 v56, v56, v49
    v_mul_f32 v57, v57, v49
    v_mul_f32 v58, v58, v49
    v_mul_f32 v59, v59, v49
    v_accvgpr_write_b32 a56, v52
    v_accvgpr_write_b32 a57, v53
    v_accvgpr_write_b32 a58, v54
    v_accvgpr_write_b32 a59, v55
    v_accvgpr_write_b32 a60, v56
    v_accvgpr_write_b32 a61, v57
    v_accvgpr_write_b32 a62, v58
    v_accvgpr_write_b32 a63, v59
    v_exp_f32 v52, v104
    v_exp_f32 v53, v105
    v_exp_f32 v54, v106
    v_exp_f32 v55, v107
    v_exp_f32 v56, v108
    v_exp_f32 v57, v109
    v_exp_f32 v58, v110
    v_exp_f32 v59, v111
    s_nop 0
    v_cvt_pk_bf16_f32 v148, v52, v53
    v_cvt_pk_bf16_f32 v149, v54, v55
    v_cvt_pk_bf16_f32 v150, v56, v57
    v_cvt_pk_bf16_f32 v151, v58, v59
    s_nop 1
    v_mfma_f32_16x16x32_bf16 v[32:35], v[44:47], v[148:151], 0
    s_nop 7
    s_setpc_b64 s[70:71]
mega_kernel_rs1460:
    s_nop 15
    v_max3_f32 v48, v96, v97, v98
    v_max3_f32 v48, v48, v99, v100
    v_max3_f32 v48, v48, v101, v102
    v_max3_f32 v48, v48, v103, 0
    v_mov_b32 v49, v48
    s_nop 1
    v_permlane32_swap_b32 v48, v49
    s_nop 1
    v_max_f32 v48, v48, v49
    v_mov_b32 v49, v48
    s_nop 1
    v_permlane16_swap_b32 v48, v49
    s_nop 1
    v_max_f32 v48, v48, v49
    v_exp_f32 v49, -v48
    v_sub_f32 v96, v96, v48
    v_sub_f32 v97, v97, v48
    v_sub_f32 v98, v98, v48
    v_sub_f32 v99, v99, v48
    v_sub_f32 v100, v100, v48
    v_sub_f32 v101, v101, v48
    v_sub_f32 v102, v102, v48
    v_sub_f32 v103, v103, v48
    v_sub_f32 v64, v64, v48
    v_sub_f32 v65, v65, v48
    v_sub_f32 v66, v66, v48
    v_sub_f32 v67, v67, v48
    v_sub_f32 v68, v68, v48
    v_sub_f32 v69, v69, v48
    v_sub_f32 v70, v70, v48
    v_sub_f32 v71, v71, v48
    v_sub_f32 v160, v160, v48
    v_sub_f32 v161, v161, v48
    v_sub_f32 v162, v162, v48
    v_sub_f32 v163, v163, v48
    v_sub_f32 v164, v164, v48
    v_sub_f32 v165, v165, v48
    v_sub_f32 v166, v166, v48
    v_sub_f32 v167, v167, v48
    v_mul_f32 v12, v12, v49
    v_accvgpr_read_b32 v52, a0
    v_accvgpr_read_b32 v53, a1
    v_accvgpr_read_b32 v54, a2
    v_accvgpr_read_b32 v55, a3
    v_accvgpr_read_b32 v56, a4
    v_accvgpr_read_b32 v57, a5
    v_accvgpr_read_b32 v58, a6
    v_accvgpr_read_b32 v59, a7
    v_mul_f32 v52, v52, v49
    v_mul_f32 v53, v53, v49
    v_mul_f32 v54, v54, v49
    v_mul_f32 v55, v55, v49
    v_mul_f32 v56, v56, v49
    v_mul_f32 v57, v57, v49
    v_mul_f32 v58, v58, v49
    v_mul_f32 v59, v59, v49
    v_accvgpr_write_b32 a0, v52
    v_accvgpr_write_b32 a1, v53
    v_accvgpr_write_b32 a2, v54
    v_accvgpr_write_b32 a3, v55
    v_accvgpr_write_b32 a4, v56
    v_accvgpr_write_b32 a5, v57
    v_accvgpr_write_b32 a6, v58
    v_accvgpr_write_b32 a7, v59
    v_accvgpr_read_b32 v52, a8
    v_accvgpr_read_b32 v53, a9
    v_accvgpr_read_b32 v54, a10
    v_accvgpr_read_b32 v55, a11
    v_accvgpr_read_b32 v56, a12
    v_accvgpr_read_b32 v57, a13
    v_accvgpr_read_b32 v58, a14
    v_accvgpr_read_b32 v59, a15
    v_mul_f32 v52, v52, v49
    v_mul_f32 v53, v53, v49
    v_mul_f32 v54, v54, v49
    v_mul_f32 v55, v55, v49
    v_mul_f32 v56, v56, v49
    v_mul_f32 v57, v57, v49
    v_mul_f32 v58, v58, v49
    v_mul_f32 v59, v59, v49
    v_accvgpr_write_b32 a8, v52
    v_accvgpr_write_b32 a9, v53
    v_accvgpr_write_b32 a10, v54
    v_accvgpr_write_b32 a11, v55
    v_accvgpr_write_b32 a12, v56
    v_accvgpr_write_b32 a13, v57
    v_accvgpr_write_b32 a14, v58
    v_accvgpr_write_b32 a15, v59
    v_accvgpr_read_b32 v52, a16
    v_accvgpr_read_b32 v53, a17
    v_accvgpr_read_b32 v54, a18
    v_accvgpr_read_b32 v55, a19
    v_accvgpr_read_b32 v56, a20
    v_accvgpr_read_b32 v57, a21
    v_accvgpr_read_b32 v58, a22
    v_accvgpr_read_b32 v59, a23
    v_mul_f32 v52, v52, v49
    v_mul_f32 v53, v53, v49
    v_mul_f32 v54, v54, v49
    v_mul_f32 v55, v55, v49
    v_mul_f32 v56, v56, v49
    v_mul_f32 v57, v57, v49
    v_mul_f32 v58, v58, v49
    v_mul_f32 v59, v59, v49
    v_accvgpr_write_b32 a16, v52
    v_accvgpr_write_b32 a17, v53
    v_accvgpr_write_b32 a18, v54
    v_accvgpr_write_b32 a19, v55
    v_accvgpr_write_b32 a20, v56
    v_accvgpr_write_b32 a21, v57
    v_accvgpr_write_b32 a22, v58
    v_accvgpr_write_b32 a23, v59
    v_accvgpr_read_b32 v52, a24
    v_accvgpr_read_b32 v53, a25
    v_accvgpr_read_b32 v54, a26
    v_accvgpr_read_b32 v55, a27
    v_accvgpr_read_b32 v56, a28
    v_accvgpr_read_b32 v57, a29
    v_accvgpr_read_b32 v58, a30
    v_accvgpr_read_b32 v59, a31
    v_mul_f32 v52, v52, v49
    v_mul_f32 v53, v53, v49
    v_mul_f32 v54, v54, v49
    v_mul_f32 v55, v55, v49
    v_mul_f32 v56, v56, v49
    v_mul_f32 v57, v57, v49
    v_mul_f32 v58, v58, v49
    v_mul_f32 v59, v59, v49
    v_accvgpr_write_b32 a24, v52
    v_accvgpr_write_b32 a25, v53
    v_accvgpr_write_b32 a26, v54
    v_accvgpr_write_b32 a27, v55
    v_accvgpr_write_b32 a28, v56
    v_accvgpr_write_b32 a29, v57
    v_accvgpr_write_b32 a30, v58
    v_accvgpr_write_b32 a31, v59
    v_exp_f32 v52, v96
    v_exp_f32 v53, v97
    v_exp_f32 v54, v98
    v_exp_f32 v55, v99
    v_exp_f32 v56, v100
    v_exp_f32 v57, v101
    v_exp_f32 v58, v102
    v_exp_f32 v59, v103
    s_nop 0
    v_cvt_pk_bf16_f32 v144, v52, v53
    v_cvt_pk_bf16_f32 v145, v54, v55
    v_cvt_pk_bf16_f32 v146, v56, v57
    v_cvt_pk_bf16_f32 v147, v58, v59
    s_nop 1
    v_mfma_f32_16x16x32_bf16 v[28:31], v[44:47], v[144:147], 0
    v_max3_f32 v48, v104, v105, v106
    v_max3_f32 v48, v48, v107, v108
    v_max3_f32 v48, v48, v109, v110
    v_max3_f32 v48, v48, v111, 0
    v_mov_b32 v49, v48
    s_nop 1
    v_permlane32_swap_b32 v48, v49
    s_nop 1
    v_max_f32 v48, v48, v49
    v_mov_b32 v49, v48
    s_nop 1
    v_permlane16_swap_b32 v48, v49
    s_nop 1
    v_max_f32 v48, v48, v49
    v_exp_f32 v49, -v48
    v_sub_f32 v104, v104, v48
    v_sub_f32 v105, v105, v48
    v_sub_f32 v106, v106, v48
    v_sub_f32 v107, v107, v48
    v_sub_f32 v108, v108, v48
    v_sub_f32 v109, v109, v48
    v_sub_f32 v110, v110, v48
    v_sub_f32 v111, v111, v48
    v_sub_f32 v72, v72, v48
    v_sub_f32 v73, v73, v48
    v_sub_f32 v74, v74, v48
    v_sub_f32 v75, v75, v48
    v_sub_f32 v76, v76, v48
    v_sub_f32 v77, v77, v48
    v_sub_f32 v78, v78, v48
    v_sub_f32 v79, v79, v48
    v_sub_f32 v168, v168, v48
    v_sub_f32 v169, v169, v48
    v_sub_f32 v170, v170, v48
    v_sub_f32 v171, v171, v48
    v_sub_f32 v172, v172, v48
    v_sub_f32 v173, v173, v48
    v_sub_f32 v174, v174, v48
    v_sub_f32 v175, v175, v48
    v_mul_f32 v13, v13, v49
    v_accvgpr_read_b32 v52, a32
    v_accvgpr_read_b32 v53, a33
    v_accvgpr_read_b32 v54, a34
    v_accvgpr_read_b32 v55, a35
    v_accvgpr_read_b32 v56, a36
    v_accvgpr_read_b32 v57, a37
    v_accvgpr_read_b32 v58, a38
    v_accvgpr_read_b32 v59, a39
    v_mul_f32 v52, v52, v49
    v_mul_f32 v53, v53, v49
    v_mul_f32 v54, v54, v49
    v_mul_f32 v55, v55, v49
    v_mul_f32 v56, v56, v49
    v_mul_f32 v57, v57, v49
    v_mul_f32 v58, v58, v49
    v_mul_f32 v59, v59, v49
    v_accvgpr_write_b32 a32, v52
    v_accvgpr_write_b32 a33, v53
    v_accvgpr_write_b32 a34, v54
    v_accvgpr_write_b32 a35, v55
    v_accvgpr_write_b32 a36, v56
    v_accvgpr_write_b32 a37, v57
    v_accvgpr_write_b32 a38, v58
    v_accvgpr_write_b32 a39, v59
    v_accvgpr_read_b32 v52, a40
    v_accvgpr_read_b32 v53, a41
    v_accvgpr_read_b32 v54, a42
    v_accvgpr_read_b32 v55, a43
    v_accvgpr_read_b32 v56, a44
    v_accvgpr_read_b32 v57, a45
    v_accvgpr_read_b32 v58, a46
    v_accvgpr_read_b32 v59, a47
    v_mul_f32 v52, v52, v49
    v_mul_f32 v53, v53, v49
    v_mul_f32 v54, v54, v49
    v_mul_f32 v55, v55, v49
    v_mul_f32 v56, v56, v49
    v_mul_f32 v57, v57, v49
    v_mul_f32 v58, v58, v49
    v_mul_f32 v59, v59, v49
    v_accvgpr_write_b32 a40, v52
    v_accvgpr_write_b32 a41, v53
    v_accvgpr_write_b32 a42, v54
    v_accvgpr_write_b32 a43, v55
    v_accvgpr_write_b32 a44, v56
    v_accvgpr_write_b32 a45, v57
    v_accvgpr_write_b32 a46, v58
    v_accvgpr_write_b32 a47, v59
    v_accvgpr_read_b32 v52, a48
    v_accvgpr_read_b32 v53, a49
    v_accvgpr_read_b32 v54, a50
    v_accvgpr_read_b32 v55, a51
    v_accvgpr_read_b32 v56, a52
    v_accvgpr_read_b32 v57, a53
    v_accvgpr_read_b32 v58, a54
    v_accvgpr_read_b32 v59, a55
    v_mul_f32 v52, v52, v49
    v_mul_f32 v53, v53, v49
    v_mul_f32 v54, v54, v49
    v_mul_f32 v55, v55, v49
    v_mul_f32 v56, v56, v49
    v_mul_f32 v57, v57, v49
    v_mul_f32 v58, v58, v49
    v_mul_f32 v59, v59, v49
    v_accvgpr_write_b32 a48, v52
    v_accvgpr_write_b32 a49, v53
    v_accvgpr_write_b32 a50, v54
    v_accvgpr_write_b32 a51, v55
    v_accvgpr_write_b32 a52, v56
    v_accvgpr_write_b32 a53, v57
    v_accvgpr_write_b32 a54, v58
    v_accvgpr_write_b32 a55, v59
    v_accvgpr_read_b32 v52, a56
    v_accvgpr_read_b32 v53, a57
    v_accvgpr_read_b32 v54, a58
    v_accvgpr_read_b32 v55, a59
    v_accvgpr_read_b32 v56, a60
    v_accvgpr_read_b32 v57, a61
    v_accvgpr_read_b32 v58, a62
    v_accvgpr_read_b32 v59, a63
    v_mul_f32 v52, v52, v49
    v_mul_f32 v53, v53, v49
    v_mul_f32 v54, v54, v49
    v_mul_f32 v55, v55, v49
    v_mul_f32 v56, v56, v49
    v_mul_f32 v57, v57, v49
    v_mul_f32 v58, v58, v49
    v_mul_f32 v59, v59, v49
    v_accvgpr_write_b32 a56, v52
    v_accvgpr_write_b32 a57, v53
    v_accvgpr_write_b32 a58, v54
    v_accvgpr_write_b32 a59, v55
    v_accvgpr_write_b32 a60, v56
    v_accvgpr_write_b32 a61, v57
    v_accvgpr_write_b32 a62, v58
    v_accvgpr_write_b32 a63, v59
    v_exp_f32 v52, v104
    v_exp_f32 v53, v105
    v_exp_f32 v54, v106
    v_exp_f32 v55, v107
    v_exp_f32 v56, v108
    v_exp_f32 v57, v109
    v_exp_f32 v58, v110
    v_exp_f32 v59, v111
    s_nop 0
    v_cvt_pk_bf16_f32 v148, v52, v53
    v_cvt_pk_bf16_f32 v149, v54, v55
    v_cvt_pk_bf16_f32 v150, v56, v57
    v_cvt_pk_bf16_f32 v151, v58, v59
    s_nop 1
    v_mfma_f32_16x16x32_bf16 v[32:35], v[44:47], v[148:151], 0
    v_max3_f32 v48, v112, v113, v114
    v_max3_f32 v48, v48, v115, v116
    v_max3_f32 v48, v48, v117, v118
    v_max3_f32 v48, v48, v119, 0
    v_mov_b32 v49, v48
    s_nop 1
    v_permlane32_swap_b32 v48, v49
    s_nop 1
    v_max_f32 v48, v48, v49
    v_mov_b32 v49, v48
    s_nop 1
    v_permlane16_swap_b32 v48, v49
    s_nop 1
    v_max_f32 v48, v48, v49
    v_exp_f32 v49, -v48
    v_sub_f32 v112, v112, v48
    v_sub_f32 v113, v113, v48
    v_sub_f32 v114, v114, v48
    v_sub_f32 v115, v115, v48
    v_sub_f32 v116, v116, v48
    v_sub_f32 v117, v117, v48
    v_sub_f32 v118, v118, v48
    v_sub_f32 v119, v119, v48
    v_sub_f32 v80, v80, v48
    v_sub_f32 v81, v81, v48
    v_sub_f32 v82, v82, v48
    v_sub_f32 v83, v83, v48
    v_sub_f32 v84, v84, v48
    v_sub_f32 v85, v85, v48
    v_sub_f32 v86, v86, v48
    v_sub_f32 v87, v87, v48
    v_sub_f32 v176, v176, v48
    v_sub_f32 v177, v177, v48
    v_sub_f32 v178, v178, v48
    v_sub_f32 v179, v179, v48
    v_sub_f32 v180, v180, v48
    v_sub_f32 v181, v181, v48
    v_sub_f32 v182, v182, v48
    v_sub_f32 v183, v183, v48
    v_mul_f32 v14, v14, v49
    v_accvgpr_read_b32 v52, a64
    v_accvgpr_read_b32 v53, a65
    v_accvgpr_read_b32 v54, a66
    v_accvgpr_read_b32 v55, a67
    v_accvgpr_read_b32 v56, a68
    v_accvgpr_read_b32 v57, a69
    v_accvgpr_read_b32 v58, a70
    v_accvgpr_read_b32 v59, a71
    v_mul_f32 v52, v52, v49
    v_mul_f32 v53, v53, v49
    v_mul_f32 v54, v54, v49
    v_mul_f32 v55, v55, v49
    v_mul_f32 v56, v56, v49
    v_mul_f32 v57, v57, v49
    v_mul_f32 v58, v58, v49
    v_mul_f32 v59, v59, v49
    v_accvgpr_write_b32 a64, v52
    v_accvgpr_write_b32 a65, v53
    v_accvgpr_write_b32 a66, v54
    v_accvgpr_write_b32 a67, v55
    v_accvgpr_write_b32 a68, v56
    v_accvgpr_write_b32 a69, v57
    v_accvgpr_write_b32 a70, v58
    v_accvgpr_write_b32 a71, v59
    v_accvgpr_read_b32 v52, a72
    v_accvgpr_read_b32 v53, a73
    v_accvgpr_read_b32 v54, a74
    v_accvgpr_read_b32 v55, a75
    v_accvgpr_read_b32 v56, a76
    v_accvgpr_read_b32 v57, a77
    v_accvgpr_read_b32 v58, a78
    v_accvgpr_read_b32 v59, a79
    v_mul_f32 v52, v52, v49
    v_mul_f32 v53, v53, v49
    v_mul_f32 v54, v54, v49
    v_mul_f32 v55, v55, v49
    v_mul_f32 v56, v56, v49
    v_mul_f32 v57, v57, v49
    v_mul_f32 v58, v58, v49
    v_mul_f32 v59, v59, v49
    v_accvgpr_write_b32 a72, v52
    v_accvgpr_write_b32 a73, v53
    v_accvgpr_write_b32 a74, v54
    v_accvgpr_write_b32 a75, v55
    v_accvgpr_write_b32 a76, v56
    v_accvgpr_write_b32 a77, v57
    v_accvgpr_write_b32 a78, v58
    v_accvgpr_write_b32 a79, v59
    v_accvgpr_read_b32 v52, a80
    v_accvgpr_read_b32 v53, a81
    v_accvgpr_read_b32 v54, a82
    v_accvgpr_read_b32 v55, a83
    v_accvgpr_read_b32 v56, a84
    v_accvgpr_read_b32 v57, a85
    v_accvgpr_read_b32 v58, a86
    v_accvgpr_read_b32 v59, a87
    v_mul_f32 v52, v52, v49
    v_mul_f32 v53, v53, v49
    v_mul_f32 v54, v54, v49
    v_mul_f32 v55, v55, v49
    v_mul_f32 v56, v56, v49
    v_mul_f32 v57, v57, v49
    v_mul_f32 v58, v58, v49
    v_mul_f32 v59, v59, v49
    v_accvgpr_write_b32 a80, v52
    v_accvgpr_write_b32 a81, v53
    v_accvgpr_write_b32 a82, v54
    v_accvgpr_write_b32 a83, v55
    v_accvgpr_write_b32 a84, v56
    v_accvgpr_write_b32 a85, v57
    v_accvgpr_write_b32 a86, v58
    v_accvgpr_write_b32 a87, v59
    v_accvgpr_read_b32 v52, a88
    v_accvgpr_read_b32 v53, a89
    v_accvgpr_read_b32 v54, a90
    v_accvgpr_read_b32 v55, a91
    v_accvgpr_read_b32 v56, a92
    v_accvgpr_read_b32 v57, a93
    v_accvgpr_read_b32 v58, a94
    v_accvgpr_read_b32 v59, a95
    v_mul_f32 v52, v52, v49
    v_mul_f32 v53, v53, v49
    v_mul_f32 v54, v54, v49
    v_mul_f32 v55, v55, v49
    v_mul_f32 v56, v56, v49
    v_mul_f32 v57, v57, v49
    v_mul_f32 v58, v58, v49
    v_mul_f32 v59, v59, v49
    v_accvgpr_write_b32 a88, v52
    v_accvgpr_write_b32 a89, v53
    v_accvgpr_write_b32 a90, v54
    v_accvgpr_write_b32 a91, v55
    v_accvgpr_write_b32 a92, v56
    v_accvgpr_write_b32 a93, v57
    v_accvgpr_write_b32 a94, v58
    v_accvgpr_write_b32 a95, v59
    v_exp_f32 v52, v112
    v_exp_f32 v53, v113
    v_exp_f32 v54, v114
    v_exp_f32 v55, v115
    v_exp_f32 v56, v116
    v_exp_f32 v57, v117
    v_exp_f32 v58, v118
    v_exp_f32 v59, v119
    s_nop 0
    v_cvt_pk_bf16_f32 v152, v52, v53
    v_cvt_pk_bf16_f32 v153, v54, v55
    v_cvt_pk_bf16_f32 v154, v56, v57
    v_cvt_pk_bf16_f32 v155, v58, v59
    s_nop 1
    v_mfma_f32_16x16x32_bf16 v[36:39], v[44:47], v[152:155], 0
    v_max3_f32 v48, v120, v121, v122
    v_max3_f32 v48, v48, v123, v124
    v_max3_f32 v48, v48, v125, v126
    v_max3_f32 v48, v48, v127, 0
    v_mov_b32 v49, v48
    s_nop 1
    v_permlane32_swap_b32 v48, v49
    s_nop 1
    v_max_f32 v48, v48, v49
    v_mov_b32 v49, v48
    s_nop 1
    v_permlane16_swap_b32 v48, v49
    s_nop 1
    v_max_f32 v48, v48, v49
    v_exp_f32 v49, -v48
    v_sub_f32 v120, v120, v48
    v_sub_f32 v121, v121, v48
    v_sub_f32 v122, v122, v48
    v_sub_f32 v123, v123, v48
    v_sub_f32 v124, v124, v48
    v_sub_f32 v125, v125, v48
    v_sub_f32 v126, v126, v48
    v_sub_f32 v127, v127, v48
    v_sub_f32 v88, v88, v48
    v_sub_f32 v89, v89, v48
    v_sub_f32 v90, v90, v48
    v_sub_f32 v91, v91, v48
    v_sub_f32 v92, v92, v48
    v_sub_f32 v93, v93, v48
    v_sub_f32 v94, v94, v48
    v_sub_f32 v95, v95, v48
    v_sub_f32 v184, v184, v48
    v_sub_f32 v185, v185, v48
    v_sub_f32 v186, v186, v48
    v_sub_f32 v187, v187, v48
    v_sub_f32 v188, v188, v48
    v_sub_f32 v189, v189, v48
    v_sub_f32 v190, v190, v48
    v_sub_f32 v191, v191, v48
    v_mul_f32 v15, v15, v49
    v_accvgpr_read_b32 v52, a96
    v_accvgpr_read_b32 v53, a97
    v_accvgpr_read_b32 v54, a98
    v_accvgpr_read_b32 v55, a99
    v_accvgpr_read_b32 v56, a100
    v_accvgpr_read_b32 v57, a101
    v_accvgpr_read_b32 v58, a102
    v_accvgpr_read_b32 v59, a103
    v_mul_f32 v52, v52, v49
    v_mul_f32 v53, v53, v49
    v_mul_f32 v54, v54, v49
    v_mul_f32 v55, v55, v49
    v_mul_f32 v56, v56, v49
    v_mul_f32 v57, v57, v49
    v_mul_f32 v58, v58, v49
    v_mul_f32 v59, v59, v49
    v_accvgpr_write_b32 a96, v52
    v_accvgpr_write_b32 a97, v53
    v_accvgpr_write_b32 a98, v54
    v_accvgpr_write_b32 a99, v55
    v_accvgpr_write_b32 a100, v56
    v_accvgpr_write_b32 a101, v57
    v_accvgpr_write_b32 a102, v58
    v_accvgpr_write_b32 a103, v59
    v_accvgpr_read_b32 v52, a104
    v_accvgpr_read_b32 v53, a105
    v_accvgpr_read_b32 v54, a106
    v_accvgpr_read_b32 v55, a107
    v_accvgpr_read_b32 v56, a108
    v_accvgpr_read_b32 v57, a109
    v_accvgpr_read_b32 v58, a110
    v_accvgpr_read_b32 v59, a111
    v_mul_f32 v52, v52, v49
    v_mul_f32 v53, v53, v49
    v_mul_f32 v54, v54, v49
    v_mul_f32 v55, v55, v49
    v_mul_f32 v56, v56, v49
    v_mul_f32 v57, v57, v49
    v_mul_f32 v58, v58, v49
    v_mul_f32 v59, v59, v49
    v_accvgpr_write_b32 a104, v52
    v_accvgpr_write_b32 a105, v53
    v_accvgpr_write_b32 a106, v54
    v_accvgpr_write_b32 a107, v55
    v_accvgpr_write_b32 a108, v56
    v_accvgpr_write_b32 a109, v57
    v_accvgpr_write_b32 a110, v58
    v_accvgpr_write_b32 a111, v59
    v_accvgpr_read_b32 v52, a112
    v_accvgpr_read_b32 v53, a113
    v_accvgpr_read_b32 v54, a114
    v_accvgpr_read_b32 v55, a115
    v_accvgpr_read_b32 v56, a116
    v_accvgpr_read_b32 v57, a117
    v_accvgpr_read_b32 v58, a118
    v_accvgpr_read_b32 v59, a119
    v_mul_f32 v52, v52, v49
    v_mul_f32 v53, v53, v49
    v_mul_f32 v54, v54, v49
    v_mul_f32 v55, v55, v49
    v_mul_f32 v56, v56, v49
    v_mul_f32 v57, v57, v49
    v_mul_f32 v58, v58, v49
    v_mul_f32 v59, v59, v49
    v_accvgpr_write_b32 a112, v52
    v_accvgpr_write_b32 a113, v53
    v_accvgpr_write_b32 a114, v54
    v_accvgpr_write_b32 a115, v55
    v_accvgpr_write_b32 a116, v56
    v_accvgpr_write_b32 a117, v57
    v_accvgpr_write_b32 a118, v58
    v_accvgpr_write_b32 a119, v59
    v_accvgpr_read_b32 v52, a120
    v_accvgpr_read_b32 v53, a121
    v_accvgpr_read_b32 v54, a122
    v_accvgpr_read_b32 v55, a123
    v_accvgpr_read_b32 v56, a124
    v_accvgpr_read_b32 v57, a125
    v_accvgpr_read_b32 v58, a126
    v_accvgpr_read_b32 v59, a127
    v_mul_f32 v52, v52, v49
    v_mul_f32 v53, v53, v49
    v_mul_f32 v54, v54, v49
    v_mul_f32 v55, v55, v49
    v_mul_f32 v56, v56, v49
    v_mul_f32 v57, v57, v49
    v_mul_f32 v58, v58, v49
    v_mul_f32 v59, v59, v49
    v_accvgpr_write_b32 a120, v52
    v_accvgpr_write_b32 a121, v53
    v_accvgpr_write_b32 a122, v54
    v_accvgpr_write_b32 a123, v55
    v_accvgpr_write_b32 a124, v56
    v_accvgpr_write_b32 a125, v57
    v_accvgpr_write_b32 a126, v58
    v_accvgpr_write_b32 a127, v59
    v_exp_f32 v52, v120
    v_exp_f32 v53, v121
    v_exp_f32 v54, v122
    v_exp_f32 v55, v123
    v_exp_f32 v56, v124
    v_exp_f32 v57, v125
    v_exp_f32 v58, v126
    v_exp_f32 v59, v127
    s_nop 0
    v_cvt_pk_bf16_f32 v156, v52, v53
    v_cvt_pk_bf16_f32 v157, v54, v55
    v_cvt_pk_bf16_f32 v158, v56, v57
    v_cvt_pk_bf16_f32 v159, v58, v59
    s_nop 1
    v_mfma_f32_16x16x32_bf16 v[40:43], v[44:47], v[156:159], 0
    s_nop 7
    s_setpc_b64 s[70:71]
mega_kernel_dosw16:
    s_cmp_eq_u32 s17, -1
    s_cbranch_scc1 mega_kernel_x34
    s_cmp_lg_u32 s16, 0
    s_cbranch_scc1 mega_kernel_np40
    v_mov_b32 v4, s4
    v_mov_b32 v5, s5
    s_add_u32 s90, s17, 117440512
    s_mov_b64 exec, 1
    buffer_store_dwordx2 v[4:5], off, s[8:11], s90 sc1
    s_mov_b64 exec, -1
mega_kernel_np40:
    s_mov_b32 s17, -1
    s_mov_b32 s67, 3
    s_branch mega_kernel_nosw15
mega_kernel_x34:
    s_cmp_eq_u32 s94, 0
    s_cbranch_scc1 mega_kernel_x35
    s_mov_b32 s42, s73
    s_mov_b32 s46, s76
    s_lshl_b32 s90, s77, 4
    s_lshl_b32 s90, s90, s81
    s_mov_b32 s48, s79
    s_mul_i32 s91, s90, 1
    s_add_u32 s49, s91, s79
    s_sub_u32 s49, s49, 2048
    s_mul_i32 s91, s90, 2
    s_add_u32 s50, s91, s79
    s_mul_i32 s91, s90, 3
    s_add_u32 s51, s91, s79
    s_sub_u32 s51, s51, 2048
    s_mov_b32 s52, s80
    s_lshl_b32 s90, s78, 2
    s_mul_i32 s91, s90, 1
    s_add_u32 s53, s91, s80
    s_sub_u32 s53, s53, 2048
    s_mul_i32 s91, s90, 2
    s_add_u32 s54, s91, s80
    s_mul_i32 s91, s90, 3
    s_add_u32 s55, s91, s80
    s_sub_u32 s55, s55, 2048
    s_lshl_b32 s56, s78, 6
    s_lshl_b32 s90, s58, 7
    s_add_u32 s90, s90, s57
    s_lshl_b32 s91, s16, 6
    s_cmp_eq_u32 s81, 1
    s_cselect_b32 s90, s90, s91
    v_lshrrev_b32 v24, 3, v1
    v_lshlrev_b32 v24, s81, v24
    v_add_u32 v24, s90, v24
    v_mul_lo_u32 v24, v24, s77
    v_lshrrev_b32 v25, 4, v1
    v_and_b32 v26, 7, v1
    v_xor_b32 v25, v25, v26
    v_lshl_add_u32 v16, v25, 4, v24
    v_xor_b32 v25, 4, v25
    v_lshl_add_u32 v17, v25, 4, v24
    s_lshl_b32 s90, s77, 3
    s_lshl_b32 s90, s90, s81
    s_sub_u32 s90, s90, 1024
    v_add_u32 v17, s90, v17
    v_lshrrev_b32 v24, 5, v1
    s_lshl_b32 s90, s16, 4
    v_add_u32 v25, s90, v24
    v_mul_lo_u32 v25, v25, s78
    v_lshlrev_b32 v24, 1, v24
    v_and_b32 v26, 31, v1
    v_xor_b32 v24, v24, v26
    s_lshl_b32 s90, s78, 1
    s_sub_u32 s90, s90, 1024
    v_add_u32 v27, s90, v25
    v_xor_b32 v26, 0, v24
    v_lshl_add_u32 v18, v26, 4, v25
    v_xor_b32 v26, 4, v24
    v_lshl_add_u32 v19, v26, 4, v27
    v_xor_b32 v26, 8, v24
    v_lshl_add_u32 v20, v26, 4, v25
    v_xor_b32 v26, 12, v24
    v_lshl_add_u32 v21, v26, 4, v27
    s_mov_b32 s40, s71
    s_mov_b32 s41, s72
    s_mov_b32 s44, s74
    s_mov_b32 s45, s75
    buffer_load_dwordx2 v[4:5], off, s[12:15], 0 sc1
    s_mov_b32 s67, 0
    s_branch mega_kernel_nosw15
mega_kernel_x35:
    s_cmp_eq_u32 s70, 1
    s_cbranch_scc1 mega_kernel_x39
    s_cmp_lg_u32 s65, 3
    s_cbranch_scc1 mega_kernel_x37
    s_and_b32 s92, s2, 7
    s_lshl_b32 s92, s92, 2
    s_bfe_u32 s93, s2, 0x20003
    s_add_u32 s92, s92, s93
    s_lshr_b32 s93, s2, 5
    s_lshr_b32 s90, s92, 1
    s_lshl_b32 s90, s90, 7
    s_add_u32 s90, s90, 117440512
    v_min_u32 v0, 13, v1
    v_lshlrev_b32 v0, 3, v0
    buffer_load_dwordx2 v[4:5], v0, s[8:11], s90 offen sc1
    s_branch mega_kernel_nosw15
mega_kernel_x37:
    s_cmp_lg_u32 s65, 2
    s_cbranch_scc1 mega_kernel_x38
    s_waitcnt vmcnt(16)
    s_mov_b32 s3, 1048576
mega_kernel_spin41:
    v_cmp_ne_u64 s[22:23], s[4:5], v[4:5]
    s_nop 3
    s_cmp_eq_u64 s[22:23], 0
    s_cbranch_scc1 mega_kernel_ok42
    s_sub_u32 s3, s3, 1
    s_cbranch_scc1 mega_kernel_ok42
    s_sleep 32
    s_and_b32 s92, s2, 7
    s_lshl_b32 s92, s92, 2
    s_bfe_u32 s93, s2, 0x20003
    s_add_u32 s92, s92, s93
    s_lshr_b32 s93, s2, 5
    s_lshr_b32 s90, s92, 1
    s_lshl_b32 s90, s90, 7
    s_add_u32 s90, s90, 117440512
    v_min_u32 v0, 13, v1
    v_lshlrev_b32 v0, 3, v0
    buffer_load_dwordx2 v[4:5], v0, s[8:11], s90 offen sc1
    s_waitcnt vmcnt(0)
    s_branch mega_kernel_spin41
mega_kernel_ok42:
    s_and_b32 s92, s2, 7
    s_lshl_b32 s92, s92, 2
    s_bfe_u32 s93, s2, 0x20003
    s_add_u32 s92, s92, s93
    s_lshr_b32 s93, s2, 5
    s_sub_u32 s90, 14, s93
    s_cmp_eq_u32 s93, 7
    s_cselect_b32 s90, 15, s90
    s_lshl_b32 s90, s90, 3
    s_lshl_b32 s91, s16, 1
    s_add_u32 s90, s90, s91
    s_lshl_b32 s90, s90, 12
    s_lshl_b32 s91, s92, 19
    s_add_u32 s90, s90, s91
    s_add_u32 s90, s90, 0
    buffer_load_dwordx4 a[128:131], v2, s[8:11], s90 offen offset:0 sc1
    buffer_load_dwordx4 a[132:135], v2, s[8:11], s90 offen offset:1024 sc1
    buffer_load_dwordx4 a[136:139], v2, s[8:11], s90 offen offset:2048 sc1
    buffer_load_dwordx4 a[140:143], v2, s[8:11], s90 offen offset:3072 sc1
    s_sub_u32 s90, 14, s93
    s_cmp_eq_u32 s93, 7
    s_cselect_b32 s90, 15, s90
    s_lshl_b32 s90, s90, 3
    s_lshl_b32 s91, s16, 1
    s_add_u32 s90, s90, s91
    s_lshl_b32 s90, s90, 12
    s_lshl_b32 s91, s92, 19
    s_add_u32 s90, s90, s91
    s_add_u32 s90, s90, 4096
    buffer_load_dwordx4 a[144:147], v2, s[8:11], s90 offen offset:0 sc1
    buffer_load_dwordx4 a[148:151], v2, s[8:11], s90 offen offset:1024 sc1
    buffer_load_dwordx4 a[152:155], v2, s[8:11], s90 offen offset:2048 sc1
    buffer_load_dwordx4 a[156:159], v2, s[8:11], s90 offen offset:3072 sc1
mega_kernel_x39:
    s_mov_b32 s42, 0
    s_mov_b32 s46, 0
    s_branch mega_kernel_nosw15
mega_kernel_x38:
    s_and_b32 s92, s2, 7
    s_lshl_b32 s92, s92, 2
    s_bfe_u32 s93, s2, 0x20003
    s_add_u32 s92, s92, s93
    s_lshr_b32 s93, s2, 5
    s_lshl_b32 s90, s93, 3
    s_lshl_b32 s91, s16, 1
    s_add_u32 s90, s90, s91
    s_lshl_b32 s90, s90, 12
    s_lshl_b32 s91, s92, 19
    s_add_u32 s90, s90, s91
    s_add_u32 s90, s90, 0
    buffer_load_dwordx4 a[160:163], v2, s[8:11], s90 offen offset:0 sc1
    buffer_load_dwordx4 a[164:167], v2, s[8:11], s90 offen offset:1024 sc1
    buffer_load_dwordx4 a[168:171], v2, s[8:11], s90 offen offset:2048 sc1
    buffer_load_dwordx4 a[172:175], v2, s[8:11], s90 offen offset:3072 sc1
    s_lshl_b32 s90, s93, 3
    s_lshl_b32 s91, s16, 1
    s_add_u32 s90, s90, s91
    s_lshl_b32 s90, s90, 12
    s_lshl_b32 s91, s92, 19
    s_add_u32 s90, s90, s91
    s_add_u32 s90, s90, 4096
    buffer_load_dwordx4 a[176:179], v2, s[8:11], s90 offen offset:0 sc1
    buffer_load_dwordx4 a[180:183], v2, s[8:11], s90 offen offset:1024 sc1
    buffer_load_dwordx4 a[184:187], v2, s[8:11], s90 offen offset:2048 sc1
    buffer_load_dwordx4 a[188:191], v2, s[8:11], s90 offen offset:3072 sc1
    s_branch mega_kernel_nosw15
mega_kernel_dosw20:
    s_cmp_eq_u32 s17, -1
    s_cbranch_scc1 mega_kernel_x43
    s_cmp_lg_u32 s16, 0
    s_cbranch_scc1 mega_kernel_np49
    v_mov_b32 v4, s4
    v_mov_b32 v5, s5
    s_add_u32 s90, s17, 117440512
    s_mov_b64 exec, 1
    buffer_store_dwordx2 v[4:5], off, s[8:11], s90 sc1
    s_mov_b64 exec, -1
mega_kernel_np49:
    s_mov_b32 s17, -1
    s_mov_b32 s67, 3
    s_branch mega_kernel_nosw19
mega_kernel_x43:
    s_cmp_eq_u32 s94, 0
    s_cbranch_scc1 mega_kernel_x44
    s_mov_b32 s42, s73
    s_mov_b32 s46, s76
    s_lshl_b32 s90, s77, 4
    s_lshl_b32 s90, s90, s81
    s_mov_b32 s48, s79
    s_mul_i32 s91, s90, 1
    s_add_u32 s49, s91, s79
    s_sub_u32 s49, s49, 2048
    s_mul_i32 s91, s90, 2
    s_add_u32 s50, s91, s79
    s_mul_i32 s91, s90, 3
    s_add_u32 s51, s91, s79
    s_sub_u32 s51, s51, 2048
    s_mov_b32 s52, s80
    s_lshl_b32 s90, s78, 2
    s_mul_i32 s91, s90, 1
    s_add_u32 s53, s91, s80
    s_sub_u32 s53, s53, 2048
    s_mul_i32 s91, s90, 2
    s_add_u32 s54, s91, s80
    s_mul_i32 s91, s90, 3
    s_add_u32 s55, s91, s80
    s_sub_u32 s55, s55, 2048
    s_lshl_b32 s56, s78, 6
    s_lshl_b32 s90, s58, 7
    s_add_u32 s90, s90, s57
    s_lshl_b32 s91, s16, 6
    s_cmp_eq_u32 s81, 1
    s_cselect_b32 s90, s90, s91
    v_lshrrev_b32 v24, 3, v1
    v_lshlrev_b32 v24, s81, v24
    v_add_u32 v24, s90, v24
    v_mul_lo_u32 v24, v24, s77
    v_lshrrev_b32 v25, 4, v1
    v_and_b32 v26, 7, v1
    v_xor_b32 v25, v25, v26
    v_lshl_add_u32 v16, v25, 4, v24
    v_xor_b32 v25, 4, v25
    v_lshl_add_u32 v17, v25, 4, v24
    s_lshl_b32 s90, s77, 3
    s_lshl_b32 s90, s90, s81
    s_sub_u32 s90, s90, 1024
    v_add_u32 v17, s90, v17
    v_lshrrev_b32 v24, 5, v1
    s_lshl_b32 s90, s16, 4
    v_add_u32 v25, s90, v24
    v_mul_lo_u32 v25, v25, s78
    v_lshlrev_b32 v24, 1, v24
    v_and_b32 v26, 31, v1
    v_xor_b32 v24, v24, v26
    s_lshl_b32 s90, s78, 1
    s_sub_u32 s90, s90, 1024
    v_add_u32 v27, s90, v25
    v_xor_b32 v26, 0, v24
    v_lshl_add_u32 v18, v26, 4, v25
    v_xor_b32 v26, 4, v24
    v_lshl_add_u32 v19, v26, 4, v27
    v_xor_b32 v26, 8, v24
    v_lshl_add_u32 v20, v26, 4, v25
    v_xor_b32 v26, 12, v24
    v_lshl_add_u32 v21, v26, 4, v27
    s_mov_b32 s40, s71
    s_mov_b32 s41, s72
    s_mov_b32 s44, s74
    s_mov_b32 s45, s75
    buffer_load_dwordx2 v[4:5], off, s[12:15], 0 sc1
    s_mov_b32 s67, 0
    s_branch mega_kernel_nosw19
mega_kernel_x44:
    s_cmp_eq_u32 s70, 1
    s_cbranch_scc1 mega_kernel_x48
    s_cmp_lg_u32 s65, 3
    s_cbranch_scc1 mega_kernel_x46
    s_and_b32 s92, s2, 7
    s_lshl_b32 s92, s92, 2
    s_bfe_u32 s93, s2, 0x20003
    s_add_u32 s92, s92, s93
    s_lshr_b32 s93, s2, 5
    s_lshr_b32 s90, s92, 1
    s_lshl_b32 s90, s90, 7
    s_add_u32 s90, s90, 117440512
    v_min_u32 v0, 13, v1
    v_lshlrev_b32 v0, 3, v0
    buffer_load_dwordx2 v[4:5], v0, s[8:11], s90 offen sc1
    s_branch mega_kernel_nosw19
mega_kernel_x46:
    s_cmp_lg_u32 s65, 2
    s_cbranch_scc1 mega_kernel_x47
    s_waitcnt vmcnt(16)
    s_mov_b32 s3, 1048576
mega_kernel_spin50:
    v_cmp_ne_u64 s[22:23], s[4:5], v[4:5]
    s_nop 3
    s_cmp_eq_u64 s[22:23], 0
    s_cbranch_scc1 mega_kernel_ok51
    s_sub_u32 s3, s3, 1
    s_cbranch_scc1 mega_kernel_ok51
    s_sleep 32
    s_and_b32 s92, s2, 7
    s_lshl_b32 s92, s92, 2
    s_bfe_u32 s93, s2, 0x20003
    s_add_u32 s92, s92, s93
    s_lshr_b32 s93, s2, 5
    s_lshr_b32 s90, s92, 1
    s_lshl_b32 s90, s90, 7
    s_add_u32 s90, s90, 117440512
    v_min_u32 v0, 13, v1
    v_lshlrev_b32 v0, 3, v0
    buffer_load_dwordx2 v[4:5], v0, s[8:11], s90 offen sc1
    s_waitcnt vmcnt(0)
    s_branch mega_kernel_spin50
mega_kernel_ok51:
    s_and_b32 s92, s2, 7
    s_lshl_b32 s92, s92, 2
    s_bfe_u32 s93, s2, 0x20003
    s_add_u32 s92, s92, s93
    s_lshr_b32 s93, s2, 5
    s_sub_u32 s90, 14, s93
    s_cmp_eq_u32 s93, 7
    s_cselect_b32 s90, 15, s90
    s_lshl_b32 s90, s90, 3
    s_lshl_b32 s91, s16, 1
    s_add_u32 s90, s90, s91
    s_lshl_b32 s90, s90, 12
    s_lshl_b32 s91, s92, 19
    s_add_u32 s90, s90, s91
    s_add_u32 s90, s90, 0
    buffer_load_dwordx4 a[128:131], v2, s[8:11], s90 offen offset:0 sc1
    buffer_load_dwordx4 a[132:135], v2, s[8:11], s90 offen offset:1024 sc1
    buffer_load_dwordx4 a[136:139], v2, s[8:11], s90 offen offset:2048 sc1
    buffer_load_dwordx4 a[140:143], v2, s[8:11], s90 offen offset:3072 sc1
    s_sub_u32 s90, 14, s93
    s_cmp_eq_u32 s93, 7
    s_cselect_b32 s90, 15, s90
    s_lshl_b32 s90, s90, 3
    s_lshl_b32 s91, s16, 1
    s_add_u32 s90, s90, s91
    s_lshl_b32 s90, s90, 12
    s_lshl_b32 s91, s92, 19
    s_add_u32 s90, s90, s91
    s_add_u32 s90, s90, 4096
    buffer_load_dwordx4 a[144:147], v2, s[8:11], s90 offen offset:0 sc1
    buffer_load_dwordx4 a[148:151], v2, s[8:11], s90 offen offset:1024 sc1
    buffer_load_dwordx4 a[152:155], v2, s[8:11], s90 offen offset:2048 sc1
    buffer_load_dwordx4 a[156:159], v2, s[8:11], s90 offen offset:3072 sc1
mega_kernel_x48:
    s_mov_b32 s42, 0
    s_mov_b32 s46, 0
    s_branch mega_kernel_nosw19
mega_kernel_x47:
    s_and_b32 s92, s2, 7
    s_lshl_b32 s92, s92, 2
    s_bfe_u32 s93, s2, 0x20003
    s_add_u32 s92, s92, s93
    s_lshr_b32 s93, s2, 5
    s_lshl_b32 s90, s93, 3
    s_lshl_b32 s91, s16, 1
    s_add_u32 s90, s90, s91
    s_lshl_b32 s90, s90, 12
    s_lshl_b32 s91, s92, 19
    s_add_u32 s90, s90, s91
    s_add_u32 s90, s90, 0
    buffer_load_dwordx4 a[160:163], v2, s[8:11], s90 offen offset:0 sc1
    buffer_load_dwordx4 a[164:167], v2, s[8:11], s90 offen offset:1024 sc1
    buffer_load_dwordx4 a[168:171], v2, s[8:11], s90 offen offset:2048 sc1
    buffer_load_dwordx4 a[172:175], v2, s[8:11], s90 offen offset:3072 sc1
    s_lshl_b32 s90, s93, 3
    s_lshl_b32 s91, s16, 1
    s_add_u32 s90, s90, s91
    s_lshl_b32 s90, s90, 12
    s_lshl_b32 s91, s92, 19
    s_add_u32 s90, s90, s91
    s_add_u32 s90, s90, 4096
    buffer_load_dwordx4 a[176:179], v2, s[8:11], s90 offen offset:0 sc1
    buffer_load_dwordx4 a[180:183], v2, s[8:11], s90 offen offset:1024 sc1
    buffer_load_dwordx4 a[184:187], v2, s[8:11], s90 offen offset:2048 sc1
    buffer_load_dwordx4 a[188:191], v2, s[8:11], s90 offen offset:3072 sc1
    s_branch mega_kernel_nosw19
mega_kernel_epf21:
    s_nop 7
    s_cmp_eq_u32 s97, 0
    s_cbranch_scc1 mega_kernel_noscale52
    s_mov_b32 s91, s98
    s_mov_b32 s92, s97
    s_mov_b32 s93, s97
    s_mov_b32 s90, s91
    v_pk_mul_f32 v[32:33], v[32:33], s[92:93]
    v_pk_mul_f32 v[34:35], v[34:35], s[92:93]
    v_pk_mul_f32 v[36:37], v[36:37], s[92:93]
    v_pk_mul_f32 v[38:39], v[38:39], s[92:93]
    v_cvt_pk_bf16_f32 v32, v32, v33
    v_cvt_pk_bf16_f32 v33, v34, v35
    v_cvt_pk_bf16_f32 v34, v36, v37
    v_cvt_pk_bf16_f32 v35, v38, v39
    buffer_store_dwordx4 v[32:35], v2, s[8:11], s90 offen sc1
    s_add_u32 s90, s90, s100
    v_pk_mul_f32 v[40:41], v[40:41], s[92:93]
    v_pk_mul_f32 v[42:43], v[42:43], s[92:93]
    v_pk_mul_f32 v[44:45], v[44:45], s[92:93]
    v_pk_mul_f32 v[46:47], v[46:47], s[92:93]
    v_cvt_pk_bf16_f32 v40, v40, v41
    v_cvt_pk_bf16_f32 v41, v42, v43
    v_cvt_pk_bf16_f32 v42, v44, v45
    v_cvt_pk_bf16_f32 v43, v46, v47
    buffer_store_dwordx4 v[40:43], v2, s[8:11], s90 offen sc1
    s_add_u32 s90, s90, s100
    v_pk_mul_f32 v[48:49], v[48:49], s[92:93]
    v_pk_mul_f32 v[50:51], v[50:51], s[92:93]
    v_pk_mul_f32 v[52:53], v[52:53], s[92:93]
    v_pk_mul_f32 v[54:55], v[54:55], s[92:93]
    v_cvt_pk_bf16_f32 v48, v48, v49
    v_cvt_pk_bf16_f32 v49, v50, v51
    v_cvt_pk_bf16_f32 v50, v52, v53
    v_cvt_pk_bf16_f32 v51, v54, v55
    buffer_store_dwordx4 v[48:51], v2, s[8:11], s90 offen sc1
    s_add_u32 s90, s90, s100
    v_pk_mul_f32 v[56:57], v[56:57], s[92:93]
    v_pk_mul_f32 v[58:59], v[58:59], s[92:93]
    v_pk_mul_f32 v[60:61], v[60:61], s[92:93]
    v_pk_mul_f32 v[62:63], v[62:63], s[92:93]
    v_cvt_pk_bf16_f32 v56, v56, v57
    v_cvt_pk_bf16_f32 v57, v58, v59
    v_cvt_pk_bf16_f32 v58, v60, v61
    v_cvt_pk_bf16_f32 v59, v62, v63
    buffer_store_dwordx4 v[56:59], v2, s[8:11], s90 offen sc1
    s_add_u32 s90, s90, s100
    v_pk_mul_f32 v[64:65], v[64:65], s[92:93]
    v_pk_mul_f32 v[66:67], v[66:67], s[92:93]
    v_pk_mul_f32 v[68:69], v[68:69], s[92:93]
    v_pk_mul_f32 v[70:71], v[70:71], s[92:93]
    v_cvt_pk_bf16_f32 v64, v64, v65
    v_cvt_pk_bf16_f32 v65, v66, v67
    v_cvt_pk_bf16_f32 v66, v68, v69
    v_cvt_pk_bf16_f32 v67, v70, v71
    buffer_store_dwordx4 v[64:67], v2, s[8:11], s90 offen sc1
    s_add_u32 s90, s90, s100
    v_pk_mul_f32 v[72:73], v[72:73], s[92:93]
    v_pk_mul_f32 v[74:75], v[74:75], s[92:93]
    v_pk_mul_f32 v[76:77], v[76:77], s[92:93]
    v_pk_mul_f32 v[78:79], v[78:79], s[92:93]
    v_cvt_pk_bf16_f32 v72, v72, v73
    v_cvt_pk_bf16_f32 v73, v74, v75
    v_cvt_pk_bf16_f32 v74, v76, v77
    v_cvt_pk_bf16_f32 v75, v78, v79
    buffer_store_dwordx4 v[72:75], v2, s[8:11], s90 offen sc1
    s_add_u32 s90, s90, s100
    v_pk_mul_f32 v[80:81], v[80:81], s[92:93]
    v_pk_mul_f32 v[82:83], v[82:83], s[92:93]
    v_pk_mul_f32 v[84:85], v[84:85], s[92:93]
    v_pk_mul_f32 v[86:87], v[86:87], s[92:93]
    v_cvt_pk_bf16_f32 v80, v80, v81
    v_cvt_pk_bf16_f32 v81, v82, v83
    v_cvt_pk_bf16_f32 v82, v84, v85
    v_cvt_pk_bf16_f32 v83, v86, v87
    buffer_store_dwordx4 v[80:83], v2, s[8:11], s90 offen sc1
    s_add_u32 s90, s90, s100
    v_pk_mul_f32 v[88:89], v[88:89], s[92:93]
    v_pk_mul_f32 v[90:91], v[90:91], s[92:93]
    v_pk_mul_f32 v[92:93], v[92:93], s[92:93]
    v_pk_mul_f32 v[94:95], v[94:95], s[92:93]
    v_cvt_pk_bf16_f32 v88, v88, v89
    v_cvt_pk_bf16_f32 v89, v90, v91
    v_cvt_pk_bf16_f32 v90, v92, v93
    v_cvt_pk_bf16_f32 v91, v94, v95
    buffer_store_dwordx4 v[88:91], v2, s[8:11], s90 offen sc1
    s_add_u32 s90, s90, s100
    s_add_u32 s91, s91, s99
    s_mov_b32 s90, s91
    v_pk_mul_f32 v[96:97], v[96:97], s[92:93]
    v_pk_mul_f32 v[98:99], v[98:99], s[92:93]
    v_pk_mul_f32 v[100:101], v[100:101], s[92:93]
    v_pk_mul_f32 v[102:103], v[102:103], s[92:93]
    v_cvt_pk_bf16_f32 v96, v96, v97
    v_cvt_pk_bf16_f32 v97, v98, v99
    v_cvt_pk_bf16_f32 v98, v100, v101
    v_cvt_pk_bf16_f32 v99, v102, v103
    buffer_store_dwordx4 v[96:99], v2, s[8:11], s90 offen sc1
    s_add_u32 s90, s90, s100
    v_pk_mul_f32 v[104:105], v[104:105], s[92:93]
    v_pk_mul_f32 v[106:107], v[106:107], s[92:93]
    v_pk_mul_f32 v[108:109], v[108:109], s[92:93]
    v_pk_mul_f32 v[110:111], v[110:111], s[92:93]
    v_cvt_pk_bf16_f32 v104, v104, v105
    v_cvt_pk_bf16_f32 v105, v106, v107
    v_cvt_pk_bf16_f32 v106, v108, v109
    v_cvt_pk_bf16_f32 v107, v110, v111
    buffer_store_dwordx4 v[104:107], v2, s[8:11], s90 offen sc1
    s_add_u32 s90, s90, s100
    v_pk_mul_f32 v[112:113], v[112:113], s[92:93]
    v_pk_mul_f32 v[114:115], v[114:115], s[92:93]
    v_pk_mul_f32 v[116:117], v[116:117], s[92:93]
    v_pk_mul_f32 v[118:119], v[118:119], s[92:93]
    v_cvt_pk_bf16_f32 v112, v112, v113
    v_cvt_pk_bf16_f32 v113, v114, v115
    v_cvt_pk_bf16_f32 v114, v116, v117
    v_cvt_pk_bf16_f32 v115, v118, v119
    buffer_store_dwordx4 v[112:115], v2, s[8:11], s90 offen sc1
    s_add_u32 s90, s90, s100
    v_pk_mul_f32 v[120:121], v[120:121], s[92:93]
    v_pk_mul_f32 v[122:123], v[122:123], s[92:93]
    v_pk_mul_f32 v[124:125], v[124:125], s[92:93]
    v_pk_mul_f32 v[126:127], v[126:127], s[92:93]
    v_cvt_pk_bf16_f32 v120, v120, v121
    v_cvt_pk_bf16_f32 v121, v122, v123
    v_cvt_pk_bf16_f32 v122, v124, v125
    v_cvt_pk_bf16_f32 v123, v126, v127
    buffer_store_dwordx4 v[120:123], v2, s[8:11], s90 offen sc1
    s_add_u32 s90, s90, s100
    v_pk_mul_f32 v[128:129], v[128:129], s[92:93]
    v_pk_mul_f32 v[130:131], v[130:131], s[92:93]
    v_pk_mul_f32 v[132:133], v[132:133], s[92:93]
    v_pk_mul_f32 v[134:135], v[134:135], s[92:93]
    v_cvt_pk_bf16_f32 v128, v128, v129
    v_cvt_pk_bf16_f32 v129, v130, v131
    v_cvt_pk_bf16_f32 v130, v132, v133
    v_cvt_pk_bf16_f32 v131, v134, v135
    buffer_store_dwordx4 v[128:131], v2, s[8:11], s90 offen sc1
    s_add_u32 s90, s90, s100
    v_pk_mul_f32 v[136:137], v[136:137], s[92:93]
    v_pk_mul_f32 v[138:139], v[138:139], s[92:93]
    v_pk_mul_f32 v[140:141], v[140:141], s[92:93]
    v_pk_mul_f32 v[142:143], v[142:143], s[92:93]
    v_cvt_pk_bf16_f32 v136, v136, v137
    v_cvt_pk_bf16_f32 v137, v138, v139
    v_cvt_pk_bf16_f32 v138, v140, v141
    v_cvt_pk_bf16_f32 v139, v142, v143
    buffer_store_dwordx4 v[136:139], v2, s[8:11], s90 offen sc1
    s_add_u32 s90, s90, s100
    v_pk_mul_f32 v[144:145], v[144:145], s[92:93]
    v_pk_mul_f32 v[146:147], v[146:147], s[92:93]
    v_pk_mul_f32 v[148:149], v[148:149], s[92:93]
    v_pk_mul_f32 v[150:151], v[150:151], s[92:93]
    v_cvt_pk_bf16_f32 v144, v144, v145
    v_cvt_pk_bf16_f32 v145, v146, v147
    v_cvt_pk_bf16_f32 v146, v148, v149
    v_cvt_pk_bf16_f32 v147, v150, v151
    buffer_store_dwordx4 v[144:147], v2, s[8:11], s90 offen sc1
    s_add_u32 s90, s90, s100
    v_pk_mul_f32 v[152:153], v[152:153], s[92:93]
    v_pk_mul_f32 v[154:155], v[154:155], s[92:93]
    v_pk_mul_f32 v[156:157], v[156:157], s[92:93]
    v_pk_mul_f32 v[158:159], v[158:159], s[92:93]
    v_cvt_pk_bf16_f32 v152, v152, v153
    v_cvt_pk_bf16_f32 v153, v154, v155
    v_cvt_pk_bf16_f32 v154, v156, v157
    v_cvt_pk_bf16_f32 v155, v158, v159
    buffer_store_dwordx4 v[152:155], v2, s[8:11], s90 offen sc1
    s_add_u32 s90, s90, s100
    s_add_u32 s91, s91, s99
    s_mov_b32 s90, s91
    v_pk_mul_f32 v[160:161], v[160:161], s[92:93]
    v_pk_mul_f32 v[162:163], v[162:163], s[92:93]
    v_pk_mul_f32 v[164:165], v[164:165], s[92:93]
    v_pk_mul_f32 v[166:167], v[166:167], s[92:93]
    v_cvt_pk_bf16_f32 v160, v160, v161
    v_cvt_pk_bf16_f32 v161, v162, v163
    v_cvt_pk_bf16_f32 v162, v164, v165
    v_cvt_pk_bf16_f32 v163, v166, v167
    buffer_store_dwordx4 v[160:163], v2, s[8:11], s90 offen sc1
    s_add_u32 s90, s90, s100
    v_pk_mul_f32 v[168:169], v[168:169], s[92:93]
    v_pk_mul_f32 v[170:171], v[170:171], s[92:93]
    v_pk_mul_f32 v[172:173], v[172:173], s[92:93]
    v_pk_mul_f32 v[174:175], v[174:175], s[92:93]
    v_cvt_pk_bf16_f32 v168, v168, v169
    v_cvt_pk_bf16_f32 v169, v170, v171
    v_cvt_pk_bf16_f32 v170, v172, v173
    v_cvt_pk_bf16_f32 v171, v174, v175
    buffer_store_dwordx4 v[168:171], v2, s[8:11], s90 offen sc1
    s_add_u32 s90, s90, s100
    v_pk_mul_f32 v[176:177], v[176:177], s[92:93]
    v_pk_mul_f32 v[178:179], v[178:179], s[92:93]
    v_pk_mul_f32 v[180:181], v[180:181], s[92:93]
    v_pk_mul_f32 v[182:183], v[182:183], s[92:93]
    v_cvt_pk_bf16_f32 v176, v176, v177
    v_cvt_pk_bf16_f32 v177, v178, v179
    v_cvt_pk_bf16_f32 v178, v180, v181
    v_cvt_pk_bf16_f32 v179, v182, v183
    buffer_store_dwordx4 v[176:179], v2, s[8:11], s90 offen sc1
    s_add_u32 s90, s90, s100
    v_pk_mul_f32 v[184:185], v[184:185], s[92:93]
    v_pk_mul_f32 v[186:187], v[186:187], s[92:93]
    v_pk_mul_f32 v[188:189], v[188:189], s[92:93]
    v_pk_mul_f32 v[190:191], v[190:191], s[92:93]
    v_cvt_pk_bf16_f32 v184, v184, v185
    v_cvt_pk_bf16_f32 v185, v186, v187
    v_cvt_pk_bf16_f32 v186, v188, v189
    v_cvt_pk_bf16_f32 v187, v190, v191
    buffer_store_dwordx4 v[184:187], v2, s[8:11], s90 offen sc1
    s_add_u32 s90, s90, s100
    v_pk_mul_f32 v[192:193], v[192:193], s[92:93]
    v_pk_mul_f32 v[194:195], v[194:195], s[92:93]
    v_pk_mul_f32 v[196:197], v[196:197], s[92:93]
    v_pk_mul_f32 v[198:199], v[198:199], s[92:93]
    v_cvt_pk_bf16_f32 v192, v192, v193
    v_cvt_pk_bf16_f32 v193, v194, v195
    v_cvt_pk_bf16_f32 v194, v196, v197
    v_cvt_pk_bf16_f32 v195, v198, v199
    buffer_store_dwordx4 v[192:195], v2, s[8:11], s90 offen sc1
    s_add_u32 s90, s90, s100
    v_pk_mul_f32 v[200:201], v[200:201], s[92:93]
    v_pk_mul_f32 v[202:203], v[202:203], s[92:93]
    v_pk_mul_f32 v[204:205], v[204:205], s[92:93]
    v_pk_mul_f32 v[206:207], v[206:207], s[92:93]
    v_cvt_pk_bf16_f32 v200, v200, v201
    v_cvt_pk_bf16_f32 v201, v202, v203
    v_cvt_pk_bf16_f32 v202, v204, v205
    v_cvt_pk_bf16_f32 v203, v206, v207
    buffer_store_dwordx4 v[200:203], v2, s[8:11], s90 offen sc1
    s_add_u32 s90, s90, s100
    v_pk_mul_f32 v[208:209], v[208:209], s[92:93]
    v_pk_mul_f32 v[210:211], v[210:211], s[92:93]
    v_pk_mul_f32 v[212:213], v[212:213], s[92:93]
    v_pk_mul_f32 v[214:215], v[214:215], s[92:93]
    v_cvt_pk_bf16_f32 v208, v208, v209
    v_cvt_pk_bf16_f32 v209, v210, v211
    v_cvt_pk_bf16_f32 v210, v212, v213
    v_cvt_pk_bf16_f32 v211, v214, v215
    buffer_store_dwordx4 v[208:211], v2, s[8:11], s90 offen sc1
    s_add_u32 s90, s90, s100
    v_pk_mul_f32 v[216:217], v[216:217], s[92:93]
    v_pk_mul_f32 v[218:219], v[218:219], s[92:93]
    v_pk_mul_f32 v[220:221], v[220:221], s[92:93]
    v_pk_mul_f32 v[222:223], v[222:223], s[92:93]
    v_cvt_pk_bf16_f32 v216, v216, v217
    v_cvt_pk_bf16_f32 v217, v218, v219
    v_cvt_pk_bf16_f32 v218, v220, v221
    v_cvt_pk_bf16_f32 v219, v222, v223
    buffer_store_dwordx4 v[216:219], v2, s[8:11], s90 offen sc1
    s_add_u32 s90, s90, s100
    s_add_u32 s91, s91, s99
    s_mov_b32 s90, s91
    v_pk_mul_f32 v[224:225], v[224:225], s[92:93]
    v_pk_mul_f32 v[226:227], v[226:227], s[92:93]
    v_pk_mul_f32 v[228:229], v[228:229], s[92:93]
    v_pk_mul_f32 v[230:231], v[230:231], s[92:93]
    v_cvt_pk_bf16_f32 v224, v224, v225
    v_cvt_pk_bf16_f32 v225, v226, v227
    v_cvt_pk_bf16_f32 v226, v228, v229
    v_cvt_pk_bf16_f32 v227, v230, v231
    buffer_store_dwordx4 v[224:227], v2, s[8:11], s90 offen sc1
    s_add_u32 s90, s90, s100
    v_pk_mul_f32 v[232:233], v[232:233], s[92:93]
    v_pk_mul_f32 v[234:235], v[234:235], s[92:93]
    v_pk_mul_f32 v[236:237], v[236:237], s[92:93]
    v_pk_mul_f32 v[238:239], v[238:239], s[92:93]
    v_cvt_pk_bf16_f32 v232, v232, v233
    v_cvt_pk_bf16_f32 v233, v234, v235
    v_cvt_pk_bf16_f32 v234, v236, v237
    v_cvt_pk_bf16_f32 v235, v238, v239
    buffer_store_dwordx4 v[232:235], v2, s[8:11], s90 offen sc1
    s_add_u32 s90, s90, s100
    v_pk_mul_f32 v[240:241], v[240:241], s[92:93]
    v_pk_mul_f32 v[242:243], v[242:243], s[92:93]
    v_pk_mul_f32 v[244:245], v[244:245], s[92:93]
    v_pk_mul_f32 v[246:247], v[246:247], s[92:93]
    v_cvt_pk_bf16_f32 v240, v240, v241
    v_cvt_pk_bf16_f32 v241, v242, v243
    v_cvt_pk_bf16_f32 v242, v244, v245
    v_cvt_pk_bf16_f32 v243, v246, v247
    buffer_store_dwordx4 v[240:243], v2, s[8:11], s90 offen sc1
    s_add_u32 s90, s90, s100
    v_pk_mul_f32 v[248:249], v[248:249], s[92:93]
    v_pk_mul_f32 v[250:251], v[250:251], s[92:93]
    v_pk_mul_f32 v[252:253], v[252:253], s[92:93]
    v_pk_mul_f32 v[254:255], v[254:255], s[92:93]
    v_cvt_pk_bf16_f32 v248, v248, v249
    v_cvt_pk_bf16_f32 v249, v250, v251
    v_cvt_pk_bf16_f32 v250, v252, v253
    v_cvt_pk_bf16_f32 v251, v254, v255
    buffer_store_dwordx4 v[248:251], v2, s[8:11], s90 offen sc1
    s_add_u32 s90, s90, s100
    v_accvgpr_read_b32 v24, a96
    v_accvgpr_read_b32 v25, a97
    v_accvgpr_read_b32 v26, a98
    v_accvgpr_read_b32 v27, a99
    v_accvgpr_read_b32 v28, a100
    v_accvgpr_read_b32 v29, a101
    v_accvgpr_read_b32 v30, a102
    v_accvgpr_read_b32 v31, a103
    v_pk_mul_f32 v[24:25], v[24:25], s[92:93]
    v_pk_mul_f32 v[26:27], v[26:27], s[92:93]
    v_pk_mul_f32 v[28:29], v[28:29], s[92:93]
    v_pk_mul_f32 v[30:31], v[30:31], s[92:93]
    v_cvt_pk_bf16_f32 v24, v24, v25
    v_cvt_pk_bf16_f32 v25, v26, v27
    v_cvt_pk_bf16_f32 v26, v28, v29
    v_cvt_pk_bf16_f32 v27, v30, v31
    buffer_store_dwordx4 v[24:27], v2, s[8:11], s90 offen sc1
    s_add_u32 s90, s90, s100
    s_nop 1
    v_accvgpr_read_b32 v24, a104
    v_accvgpr_read_b32 v25, a105
    v_accvgpr_read_b32 v26, a106
    v_accvgpr_read_b32 v27, a107
    v_accvgpr_read_b32 v28, a108
    v_accvgpr_read_b32 v29, a109
    v_accvgpr_read_b32 v30, a110
    v_accvgpr_read_b32 v31, a111
    v_pk_mul_f32 v[24:25], v[24:25], s[92:93]
    v_pk_mul_f32 v[26:27], v[26:27], s[92:93]
    v_pk_mul_f32 v[28:29], v[28:29], s[92:93]
    v_pk_mul_f32 v[30:31], v[30:31], s[92:93]
    v_cvt_pk_bf16_f32 v24, v24, v25
    v_cvt_pk_bf16_f32 v25, v26, v27
    v_cvt_pk_bf16_f32 v26, v28, v29
    v_cvt_pk_bf16_f32 v27, v30, v31
    buffer_store_dwordx4 v[24:27], v2, s[8:11], s90 offen sc1
    s_add_u32 s90, s90, s100
    s_nop 1
    v_accvgpr_read_b32 v24, a112
    v_accvgpr_read_b32 v25, a113
    v_accvgpr_read_b32 v26, a114
    v_accvgpr_read_b32 v27, a115
    v_accvgpr_read_b32 v28, a116
    v_accvgpr_read_b32 v29, a117
    v_accvgpr_read_b32 v30, a118
    v_accvgpr_read_b32 v31, a119
    v_pk_mul_f32 v[24:25], v[24:25], s[92:93]
    v_pk_mul_f32 v[26:27], v[26:27], s[92:93]
    v_pk_mul_f32 v[28:29], v[28:29], s[92:93]
    v_pk_mul_f32 v[30:31], v[30:31], s[92:93]
    v_cvt_pk_bf16_f32 v24, v24, v25
    v_cvt_pk_bf16_f32 v25, v26, v27
    v_cvt_pk_bf16_f32 v26, v28, v29
    v_cvt_pk_bf16_f32 v27, v30, v31
    buffer_store_dwordx4 v[24:27], v2, s[8:11], s90 offen sc1
    s_add_u32 s90, s90, s100
    s_nop 1
    v_accvgpr_read_b32 v24, a120
    v_accvgpr_read_b32 v25, a121
    v_accvgpr_read_b32 v26, a122
    v_accvgpr_read_b32 v27, a123
    v_accvgpr_read_b32 v28, a124
    v_accvgpr_read_b32 v29, a125
    v_accvgpr_read_b32 v30, a126
    v_accvgpr_read_b32 v31, a127
    v_pk_mul_f32 v[24:25], v[24:25], s[92:93]
    v_pk_mul_f32 v[26:27], v[26:27], s[92:93]
    v_pk_mul_f32 v[28:29], v[28:29], s[92:93]
    v_pk_mul_f32 v[30:31], v[30:31], s[92:93]
    v_cvt_pk_bf16_f32 v24, v24, v25
    v_cvt_pk_bf16_f32 v25, v26, v27
    v_cvt_pk_bf16_f32 v26, v28, v29
    v_cvt_pk_bf16_f32 v27, v30, v31
    buffer_store_dwordx4 v[24:27], v2, s[8:11], s90 offen sc1
    s_add_u32 s90, s90, s100
    s_nop 1
    s_add_u32 s91, s91, s99
    s_setpc_b64 s[20:21]
mega_kernel_noscale52:
    s_mov_b32 s91, s98
    s_mov_b32 s92, s97
    s_mov_b32 s93, s97
    s_mov_b32 s90, s91
    v_cvt_pk_bf16_f32 v32, v32, v33
    v_cvt_pk_bf16_f32 v33, v34, v35
    v_cvt_pk_bf16_f32 v34, v36, v37
    v_cvt_pk_bf16_f32 v35, v38, v39
    buffer_store_dwordx4 v[32:35], v2, s[8:11], s90 offen sc1
    s_add_u32 s90, s90, s100
    v_cvt_pk_bf16_f32 v40, v40, v41
    v_cvt_pk_bf16_f32 v41, v42, v43
    v_cvt_pk_bf16_f32 v42, v44, v45
    v_cvt_pk_bf16_f32 v43, v46, v47
    buffer_store_dwordx4 v[40:43], v2, s[8:11], s90 offen sc1
    s_add_u32 s90, s90, s100
    v_cvt_pk_bf16_f32 v48, v48, v49
    v_cvt_pk_bf16_f32 v49, v50, v51
    v_cvt_pk_bf16_f32 v50, v52, v53
    v_cvt_pk_bf16_f32 v51, v54, v55
    buffer_store_dwordx4 v[48:51], v2, s[8:11], s90 offen sc1
    s_add_u32 s90, s90, s100
    v_cvt_pk_bf16_f32 v56, v56, v57
    v_cvt_pk_bf16_f32 v57, v58, v59
    v_cvt_pk_bf16_f32 v58, v60, v61
    v_cvt_pk_bf16_f32 v59, v62, v63
    buffer_store_dwordx4 v[56:59], v2, s[8:11], s90 offen sc1
    s_add_u32 s90, s90, s100
    v_cvt_pk_bf16_f32 v64, v64, v65
    v_cvt_pk_bf16_f32 v65, v66, v67
    v_cvt_pk_bf16_f32 v66, v68, v69
    v_cvt_pk_bf16_f32 v67, v70, v71
    buffer_store_dwordx4 v[64:67], v2, s[8:11], s90 offen sc1
    s_add_u32 s90, s90, s100
    v_cvt_pk_bf16_f32 v72, v72, v73
    v_cvt_pk_bf16_f32 v73, v74, v75
    v_cvt_pk_bf16_f32 v74, v76, v77
    v_cvt_pk_bf16_f32 v75, v78, v79
    buffer_store_dwordx4 v[72:75], v2, s[8:11], s90 offen sc1
    s_add_u32 s90, s90, s100
    v_cvt_pk_bf16_f32 v80, v80, v81
    v_cvt_pk_bf16_f32 v81, v82, v83
    v_cvt_pk_bf16_f32 v82, v84, v85
    v_cvt_pk_bf16_f32 v83, v86, v87
    buffer_store_dwordx4 v[80:83], v2, s[8:11], s90 offen sc1
    s_add_u32 s90, s90, s100
    v_cvt_pk_bf16_f32 v88, v88, v89
    v_cvt_pk_bf16_f32 v89, v90, v91
    v_cvt_pk_bf16_f32 v90, v92, v93
    v_cvt_pk_bf16_f32 v91, v94, v95
    buffer_store_dwordx4 v[88:91], v2, s[8:11], s90 offen sc1
    s_add_u32 s90, s90, s100
    s_add_u32 s91, s91, s99
    s_mov_b32 s90, s91
    v_cvt_pk_bf16_f32 v96, v96, v97
    v_cvt_pk_bf16_f32 v97, v98, v99
    v_cvt_pk_bf16_f32 v98, v100, v101
    v_cvt_pk_bf16_f32 v99, v102, v103
    buffer_store_dwordx4 v[96:99], v2, s[8:11], s90 offen sc1
    s_add_u32 s90, s90, s100
    v_cvt_pk_bf16_f32 v104, v104, v105
    v_cvt_pk_bf16_f32 v105, v106, v107
    v_cvt_pk_bf16_f32 v106, v108, v109
    v_cvt_pk_bf16_f32 v107, v110, v111
    buffer_store_dwordx4 v[104:107], v2, s[8:11], s90 offen sc1
    s_add_u32 s90, s90, s100
    v_cvt_pk_bf16_f32 v112, v112, v113
    v_cvt_pk_bf16_f32 v113, v114, v115
    v_cvt_pk_bf16_f32 v114, v116, v117
    v_cvt_pk_bf16_f32 v115, v118, v119
    buffer_store_dwordx4 v[112:115], v2, s[8:11], s90 offen sc1
    s_add_u32 s90, s90, s100
    v_cvt_pk_bf16_f32 v120, v120, v121
    v_cvt_pk_bf16_f32 v121, v122, v123
    v_cvt_pk_bf16_f32 v122, v124, v125
    v_cvt_pk_bf16_f32 v123, v126, v127
    buffer_store_dwordx4 v[120:123], v2, s[8:11], s90 offen sc1
    s_add_u32 s90, s90, s100
    v_cvt_pk_bf16_f32 v128, v128, v129
    v_cvt_pk_bf16_f32 v129, v130, v131
    v_cvt_pk_bf16_f32 v130, v132, v133
    v_cvt_pk_bf16_f32 v131, v134, v135
    buffer_store_dwordx4 v[128:131], v2, s[8:11], s90 offen sc1
    s_add_u32 s90, s90, s100
    v_cvt_pk_bf16_f32 v136, v136, v137
    v_cvt_pk_bf16_f32 v137, v138, v139
    v_cvt_pk_bf16_f32 v138, v140, v141
    v_cvt_pk_bf16_f32 v139, v142, v143
    buffer_store_dwordx4 v[136:139], v2, s[8:11], s90 offen sc1
    s_add_u32 s90, s90, s100
    v_cvt_pk_bf16_f32 v144, v144, v145
    v_cvt_pk_bf16_f32 v145, v146, v147
    v_cvt_pk_bf16_f32 v146, v148, v149
    v_cvt_pk_bf16_f32 v147, v150, v151
    buffer_store_dwordx4 v[144:147], v2, s[8:11], s90 offen sc1
    s_add_u32 s90, s90, s100
    v_cvt_pk_bf16_f32 v152, v152, v153
    v_cvt_pk_bf16_f32 v153, v154, v155
    v_cvt_pk_bf16_f32 v154, v156, v157
    v_cvt_pk_bf16_f32 v155, v158, v159
    buffer_store_dwordx4 v[152:155], v2, s[8:11], s90 offen sc1
    s_add_u32 s90, s90, s100
    s_add_u32 s91, s91, s99
    s_mov_b32 s90, s91
    v_cvt_pk_bf16_f32 v160, v160, v161
    v_cvt_pk_bf16_f32 v161, v162, v163
    v_cvt_pk_bf16_f32 v162, v164, v165
    v_cvt_pk_bf16_f32 v163, v166, v167
    buffer_store_dwordx4 v[160:163], v2, s[8:11], s90 offen sc1
    s_add_u32 s90, s90, s100
    v_cvt_pk_bf16_f32 v168, v168, v169
    v_cvt_pk_bf16_f32 v169, v170, v171
    v_cvt_pk_bf16_f32 v170, v172, v173
    v_cvt_pk_bf16_f32 v171, v174, v175
    buffer_store_dwordx4 v[168:171], v2, s[8:11], s90 offen sc1
    s_add_u32 s90, s90, s100
    v_cvt_pk_bf16_f32 v176, v176, v177
    v_cvt_pk_bf16_f32 v177, v178, v179
    v_cvt_pk_bf16_f32 v178, v180, v181
    v_cvt_pk_bf16_f32 v179, v182, v183
    buffer_store_dwordx4 v[176:179], v2, s[8:11], s90 offen sc1
    s_add_u32 s90, s90, s100
    v_cvt_pk_bf16_f32 v184, v184, v185
    v_cvt_pk_bf16_f32 v185, v186, v187
    v_cvt_pk_bf16_f32 v186, v188, v189
    v_cvt_pk_bf16_f32 v187, v190, v191
    buffer_store_dwordx4 v[184:187], v2, s[8:11], s90 offen sc1
    s_add_u32 s90, s90, s100
    v_cvt_pk_bf16_f32 v192, v192, v193
    v_cvt_pk_bf16_f32 v193, v194, v195
    v_cvt_pk_bf16_f32 v194, v196, v197
    v_cvt_pk_bf16_f32 v195, v198, v199
    buffer_store_dwordx4 v[192:195], v2, s[8:11], s90 offen sc1
    s_add_u32 s90, s90, s100
    v_cvt_pk_bf16_f32 v200, v200, v201
    v_cvt_pk_bf16_f32 v201, v202, v203
    v_cvt_pk_bf16_f32 v202, v204, v205
    v_cvt_pk_bf16_f32 v203, v206, v207
    buffer_store_dwordx4 v[200:203], v2, s[8:11], s90 offen sc1
    s_add_u32 s90, s90, s100
    v_cvt_pk_bf16_f32 v208, v208, v209
    v_cvt_pk_bf16_f32 v209, v210, v211
    v_cvt_pk_bf16_f32 v210, v212, v213
    v_cvt_pk_bf16_f32 v211, v214, v215
    buffer_store_dwordx4 v[208:211], v2, s[8:11], s90 offen sc1
    s_add_u32 s90, s90, s100
    v_cvt_pk_bf16_f32 v216, v216, v217
    v_cvt_pk_bf16_f32 v217, v218, v219
    v_cvt_pk_bf16_f32 v218, v220, v221
    v_cvt_pk_bf16_f32 v219, v222, v223
    buffer_store_dwordx4 v[216:219], v2, s[8:11], s90 offen sc1
    s_add_u32 s90, s90, s100
    s_add_u32 s91, s91, s99
    s_mov_b32 s90, s91
    v_cvt_pk_bf16_f32 v224, v224, v225
    v_cvt_pk_bf16_f32 v225, v226, v227
    v_cvt_pk_bf16_f32 v226, v228, v229
    v_cvt_pk_bf16_f32 v227, v230, v231
    buffer_store_dwordx4 v[224:227], v2, s[8:11], s90 offen sc1
    s_add_u32 s90, s90, s100
    v_cvt_pk_bf16_f32 v232, v232, v233
    v_cvt_pk_bf16_f32 v233, v234, v235
    v_cvt_pk_bf16_f32 v234, v236, v237
    v_cvt_pk_bf16_f32 v235, v238, v239
    buffer_store_dwordx4 v[232:235], v2, s[8:11], s90 offen sc1
    s_add_u32 s90, s90, s100
    v_cvt_pk_bf16_f32 v240, v240, v241
    v_cvt_pk_bf16_f32 v241, v242, v243
    v_cvt_pk_bf16_f32 v242, v244, v245
    v_cvt_pk_bf16_f32 v243, v246, v247
    buffer_store_dwordx4 v[240:243], v2, s[8:11], s90 offen sc1
    s_add_u32 s90, s90, s100
    v_cvt_pk_bf16_f32 v248, v248, v249
    v_cvt_pk_bf16_f32 v249, v250, v251
    v_cvt_pk_bf16_f32 v250, v252, v253
    v_cvt_pk_bf16_f32 v251, v254, v255
    buffer_store_dwordx4 v[248:251], v2, s[8:11], s90 offen sc1
    s_add_u32 s90, s90, s100
    v_accvgpr_read_b32 v24, a96
    v_accvgpr_read_b32 v25, a97
    v_accvgpr_read_b32 v26, a98
    v_accvgpr_read_b32 v27, a99
    v_accvgpr_read_b32 v28, a100
    v_accvgpr_read_b32 v29, a101
    v_accvgpr_read_b32 v30, a102
    v_accvgpr_read_b32 v31, a103
    v_cvt_pk_bf16_f32 v24, v24, v25
    v_cvt_pk_bf16_f32 v25, v26, v27
    v_cvt_pk_bf16_f32 v26, v28, v29
    v_cvt_pk_bf16_f32 v27, v30, v31
    buffer_store_dwordx4 v[24:27], v2, s[8:11], s90 offen sc1
    s_add_u32 s90, s90, s100
    s_nop 1
    v_accvgpr_read_b32 v24, a104
    v_accvgpr_read_b32 v25, a105
    v_accvgpr_read_b32 v26, a106
    v_accvgpr_read_b32 v27, a107
    v_accvgpr_read_b32 v28, a108
    v_accvgpr_read_b32 v29, a109
    v_accvgpr_read_b32 v30, a110
    v_accvgpr_read_b32 v31, a111
    v_cvt_pk_bf16_f32 v24, v24, v25
    v_cvt_pk_bf16_f32 v25, v26, v27
    v_cvt_pk_bf16_f32 v26, v28, v29
    v_cvt_pk_bf16_f32 v27, v30, v31
    buffer_store_dwordx4 v[24:27], v2, s[8:11], s90 offen sc1
    s_add_u32 s90, s90, s100
    s_nop 1
    v_accvgpr_read_b32 v24, a112
    v_accvgpr_read_b32 v25, a113
    v_accvgpr_read_b32 v26, a114
    v_accvgpr_read_b32 v27, a115
    v_accvgpr_read_b32 v28, a116
    v_accvgpr_read_b32 v29, a117
    v_accvgpr_read_b32 v30, a118
    v_accvgpr_read_b32 v31, a119
    v_cvt_pk_bf16_f32 v24, v24, v25
    v_cvt_pk_bf16_f32 v25, v26, v27
    v_cvt_pk_bf16_f32 v26, v28, v29
    v_cvt_pk_bf16_f32 v27, v30, v31
    buffer_store_dwordx4 v[24:27], v2, s[8:11], s90 offen sc1
    s_add_u32 s90, s90, s100
    s_nop 1
    v_accvgpr_read_b32 v24, a120
    v_accvgpr_read_b32 v25, a121
    v_accvgpr_read_b32 v26, a122
    v_accvgpr_read_b32 v27, a123
    v_accvgpr_read_b32 v28, a124
    v_accvgpr_read_b32 v29, a125
    v_accvgpr_read_b32 v30, a126
    v_accvgpr_read_b32 v31, a127
    v_cvt_pk_bf16_f32 v24, v24, v25
    v_cvt_pk_bf16_f32 v25, v26, v27
    v_cvt_pk_bf16_f32 v26, v28, v29
    v_cvt_pk_bf16_f32 v27, v30, v31
    buffer_store_dwordx4 v[24:27], v2, s[8:11], s90 offen sc1
    s_add_u32 s90, s90, s100
    s_nop 1
    s_add_u32 s91, s91, s99
    s_setpc_b64 s[20:21]
mega_kernel_epl53:
    s_mov_b32 s92, s97
    s_mov_b32 s93, s97
    s_cmp_eq_u32 s97, 0
    s_cbranch_scc1 mega_kernel_ns254
    s_mov_b32 s90, s98
    v_pk_mul_f32 v[32:33], v[32:33], s[92:93]
    v_pk_mul_f32 v[34:35], v[34:35], s[92:93]
    v_pk_mul_f32 v[36:37], v[36:37], s[92:93]
    v_pk_mul_f32 v[38:39], v[38:39], s[92:93]
    v_cvt_pk_bf16_f32 v32, v32, v33
    v_cvt_pk_bf16_f32 v33, v34, v35
    v_cvt_pk_bf16_f32 v34, v36, v37
    v_cvt_pk_bf16_f32 v35, v38, v39
    buffer_store_dwordx4 v[32:35], v2, s[8:11], s90 offen sc1
    s_add_u32 s90, s90, s100
    v_pk_mul_f32 v[40:41], v[40:41], s[92:93]
    v_pk_mul_f32 v[42:43], v[42:43], s[92:93]
    v_pk_mul_f32 v[44:45], v[44:45], s[92:93]
    v_pk_mul_f32 v[46:47], v[46:47], s[92:93]
    v_cvt_pk_bf16_f32 v40, v40, v41
    v_cvt_pk_bf16_f32 v41, v42, v43
    v_cvt_pk_bf16_f32 v42, v44, v45
    v_cvt_pk_bf16_f32 v43, v46, v47
    buffer_store_dwordx4 v[40:43], v2, s[8:11], s90 offen sc1
    s_add_u32 s90, s90, s100
    v_pk_mul_f32 v[48:49], v[48:49], s[92:93]
    v_pk_mul_f32 v[50:51], v[50:51], s[92:93]
    v_pk_mul_f32 v[52:53], v[52:53], s[92:93]
    v_pk_mul_f32 v[54:55], v[54:55], s[92:93]
    v_cvt_pk_bf16_f32 v48, v48, v49
    v_cvt_pk_bf16_f32 v49, v50, v51
    v_cvt_pk_bf16_f32 v50, v52, v53
    v_cvt_pk_bf16_f32 v51, v54, v55
    buffer_store_dwordx4 v[48:51], v2, s[8:11], s90 offen sc1
    s_add_u32 s90, s90, s100
    v_pk_mul_f32 v[56:57], v[56:57], s[92:93]
    v_pk_mul_f32 v[58:59], v[58:59], s[92:93]
    v_pk_mul_f32 v[60:61], v[60:61], s[92:93]
    v_pk_mul_f32 v[62:63], v[62:63], s[92:93]
    v_cvt_pk_bf16_f32 v56, v56, v57
    v_cvt_pk_bf16_f32 v57, v58, v59
    v_cvt_pk_bf16_f32 v58, v60, v61
    v_cvt_pk_bf16_f32 v59, v62, v63
    buffer_store_dwordx4 v[56:59], v2, s[8:11], s90 offen sc1
    s_add_u32 s90, s90, s100
    v_pk_mul_f32 v[64:65], v[64:65], s[92:93]
    v_pk_mul_f32 v[66:67], v[66:67], s[92:93]
    v_pk_mul_f32 v[68:69], v[68:69], s[92:93]
    v_pk_mul_f32 v[70:71], v[70:71], s[92:93]
    v_cvt_pk_bf16_f32 v64, v64, v65
    v_cvt_pk_bf16_f32 v65, v66, v67
    v_cvt_pk_bf16_f32 v66, v68, v69
    v_cvt_pk_bf16_f32 v67, v70, v71
    buffer_store_dwordx4 v[64:67], v2, s[8:11], s90 offen sc1
    s_add_u32 s90, s90, s100
    v_pk_mul_f32 v[72:73], v[72:73], s[92:93]
    v_pk_mul_f32 v[74:75], v[74:75], s[92:93]
    v_pk_mul_f32 v[76:77], v[76:77], s[92:93]
    v_pk_mul_f32 v[78:79], v[78:79], s[92:93]
    v_cvt_pk_bf16_f32 v72, v72, v73
    v_cvt_pk_bf16_f32 v73, v74, v75
    v_cvt_pk_bf16_f32 v74, v76, v77
    v_cvt_pk_bf16_f32 v75, v78, v79
    buffer_store_dwordx4 v[72:75], v2, s[8:11], s90 offen sc1
    s_add_u32 s90, s90, s100
    v_pk_mul_f32 v[80:81], v[80:81], s[92:93]
    v_pk_mul_f32 v[82:83], v[82:83], s[92:93]
    v_pk_mul_f32 v[84:85], v[84:85], s[92:93]
    v_pk_mul_f32 v[86:87], v[86:87], s[92:93]
    v_cvt_pk_bf16_f32 v80, v80, v81
    v_cvt_pk_bf16_f32 v81, v82, v83
    v_cvt_pk_bf16_f32 v82, v84, v85
    v_cvt_pk_bf16_f32 v83, v86, v87
    buffer_store_dwordx4 v[80:83], v2, s[8:11], s90 offen sc1
    s_add_u32 s90, s90, s100
    v_pk_mul_f32 v[88:89], v[88:89], s[92:93]
    v_pk_mul_f32 v[90:91], v[90:91], s[92:93]
    v_pk_mul_f32 v[92:93], v[92:93], s[92:93]
    v_pk_mul_f32 v[94:95], v[94:95], s[92:93]
    v_cvt_pk_bf16_f32 v88, v88, v89
    v_cvt_pk_bf16_f32 v89, v90, v91
    v_cvt_pk_bf16_f32 v90, v92, v93
    v_cvt_pk_bf16_f32 v91, v94, v95
    buffer_store_dwordx4 v[88:91], v2, s[8:11], s90 offen sc1
    s_add_u32 s90, s98, s99
    v_pk_mul_f32 v[96:97], v[96:97], s[92:93]
    v_pk_mul_f32 v[98:99], v[98:99], s[92:93]
    v_pk_mul_f32 v[100:101], v[100:101], s[92:93]
    v_pk_mul_f32 v[102:103], v[102:103], s[92:93]
    v_cvt_pk_bf16_f32 v96, v96, v97
    v_cvt_pk_bf16_f32 v97, v98, v99
    v_cvt_pk_bf16_f32 v98, v100, v101
    v_cvt_pk_bf16_f32 v99, v102, v103
    buffer_store_dwordx4 v[96:99], v2, s[8:11], s90 offen sc1
    s_add_u32 s90, s90, s100
    v_pk_mul_f32 v[104:105], v[104:105], s[92:93]
    v_pk_mul_f32 v[106:107], v[106:107], s[92:93]
    v_pk_mul_f32 v[108:109], v[108:109], s[92:93]
    v_pk_mul_f32 v[110:111], v[110:111], s[92:93]
    v_cvt_pk_bf16_f32 v104, v104, v105
    v_cvt_pk_bf16_f32 v105, v106, v107
    v_cvt_pk_bf16_f32 v106, v108, v109
    v_cvt_pk_bf16_f32 v107, v110, v111
    buffer_store_dwordx4 v[104:107], v2, s[8:11], s90 offen sc1
    s_add_u32 s90, s90, s100
    v_pk_mul_f32 v[112:113], v[112:113], s[92:93]
    v_pk_mul_f32 v[114:115], v[114:115], s[92:93]
    v_pk_mul_f32 v[116:117], v[116:117], s[92:93]
    v_pk_mul_f32 v[118:119], v[118:119], s[92:93]
    v_cvt_pk_bf16_f32 v112, v112, v113
    v_cvt_pk_bf16_f32 v113, v114, v115
    v_cvt_pk_bf16_f32 v114, v116, v117
    v_cvt_pk_bf16_f32 v115, v118, v119
    buffer_store_dwordx4 v[112:115], v2, s[8:11], s90 offen sc1
    s_add_u32 s90, s90, s100
    v_pk_mul_f32 v[120:121], v[120:121], s[92:93]
    v_pk_mul_f32 v[122:123], v[122:123], s[92:93]
    v_pk_mul_f32 v[124:125], v[124:125], s[92:93]
    v_pk_mul_f32 v[126:127], v[126:127], s[92:93]
    v_cvt_pk_bf16_f32 v120, v120, v121
    v_cvt_pk_bf16_f32 v121, v122, v123
    v_cvt_pk_bf16_f32 v122, v124, v125
    v_cvt_pk_bf16_f32 v123, v126, v127
    buffer_store_dwordx4 v[120:123], v2, s[8:11], s90 offen sc1
    s_add_u32 s90, s90, s100
    v_pk_mul_f32 v[128:129], v[128:129], s[92:93]
    v_pk_mul_f32 v[130:131], v[130:131], s[92:93]
    v_pk_mul_f32 v[132:133], v[132:133], s[92:93]
    v_pk_mul_f32 v[134:135], v[134:135], s[92:93]
    v_cvt_pk_bf16_f32 v128, v128, v129
    v_cvt_pk_bf16_f32 v129, v130, v131
    v_cvt_pk_bf16_f32 v130, v132, v133
    v_cvt_pk_bf16_f32 v131, v134, v135
    buffer_store_dwordx4 v[128:131], v2, s[8:11], s90 offen sc1
    s_add_u32 s90, s90, s100
    v_pk_mul_f32 v[136:137], v[136:137], s[92:93]
    v_pk_mul_f32 v[138:139], v[138:139], s[92:93]
    v_pk_mul_f32 v[140:141], v[140:141], s[92:93]
    v_pk_mul_f32 v[142:143], v[142:143], s[92:93]
    v_cvt_pk_bf16_f32 v136, v136, v137
    v_cvt_pk_bf16_f32 v137, v138, v139
    v_cvt_pk_bf16_f32 v138, v140, v141
    v_cvt_pk_bf16_f32 v139, v142, v143
    buffer_store_dwordx4 v[136:139], v2, s[8:11], s90 offen sc1
    s_add_u32 s90, s90, s100
    v_pk_mul_f32 v[144:145], v[144:145], s[92:93]
    v_pk_mul_f32 v[146:147], v[146:147], s[92:93]
    v_pk_mul_f32 v[148:149], v[148:149], s[92:93]
    v_pk_mul_f32 v[150:151], v[150:151], s[92:93]
    v_cvt_pk_bf16_f32 v144, v144, v145
    v_cvt_pk_bf16_f32 v145, v146, v147
    v_cvt_pk_bf16_f32 v146, v148, v149
    v_cvt_pk_bf16_f32 v147, v150, v151
    buffer_store_dwordx4 v[144:147], v2, s[8:11], s90 offen sc1
    s_add_u32 s90, s90, s100
    v_pk_mul_f32 v[152:153], v[152:153], s[92:93]
    v_pk_mul_f32 v[154:155], v[154:155], s[92:93]
    v_pk_mul_f32 v[156:157], v[156:157], s[92:93]
    v_pk_mul_f32 v[158:159], v[158:159], s[92:93]
    v_cvt_pk_bf16_f32 v152, v152, v153
    v_cvt_pk_bf16_f32 v153, v154, v155
    v_cvt_pk_bf16_f32 v154, v156, v157
    v_cvt_pk_bf16_f32 v155, v158, v159
    buffer_store_dwordx4 v[152:155], v2, s[8:11], s90 offen sc1
    s_add_u32 s90, s90, s100
    v_pk_mul_f32 v[192:193], v[192:193], s[92:93]
    v_pk_mul_f32 v[194:195], v[194:195], s[92:93]
    v_pk_mul_f32 v[196:197], v[196:197], s[92:93]
    v_pk_mul_f32 v[198:199], v[198:199], s[92:93]
    v_cvt_pk_bf16_f32 v192, v192, v193
    v_cvt_pk_bf16_f32 v193, v194, v195
    v_cvt_pk_bf16_f32 v194, v196, v197
    v_cvt_pk_bf16_f32 v195, v198, v199
    v_pk_mul_f32 v[200:201], v[200:201], s[92:93]
    v_pk_mul_f32 v[202:203], v[202:203], s[92:93]
    v_pk_mul_f32 v[204:205], v[204:205], s[92:93]
    v_pk_mul_f32 v[206:207], v[206:207], s[92:93]
    v_cvt_pk_bf16_f32 v196, v200, v201
    v_cvt_pk_bf16_f32 v197, v202, v203
    v_cvt_pk_bf16_f32 v198, v204, v205
    v_cvt_pk_bf16_f32 v199, v206, v207
    v_pk_mul_f32 v[208:209], v[208:209], s[92:93]
    v_pk_mul_f32 v[210:211], v[210:211], s[92:93]
    v_pk_mul_f32 v[212:213], v[212:213], s[92:93]
    v_pk_mul_f32 v[214:215], v[214:215], s[92:93]
    v_cvt_pk_bf16_f32 v200, v208, v209
    v_cvt_pk_bf16_f32 v201, v210, v211
    v_cvt_pk_bf16_f32 v202, v212, v213
    v_cvt_pk_bf16_f32 v203, v214, v215
    v_pk_mul_f32 v[216:217], v[216:217], s[92:93]
    v_pk_mul_f32 v[218:219], v[218:219], s[92:93]
    v_pk_mul_f32 v[220:221], v[220:221], s[92:93]
    v_pk_mul_f32 v[222:223], v[222:223], s[92:93]
    v_cvt_pk_bf16_f32 v204, v216, v217
    v_cvt_pk_bf16_f32 v205, v218, v219
    v_cvt_pk_bf16_f32 v206, v220, v221
    v_cvt_pk_bf16_f32 v207, v222, v223
    v_pk_mul_f32 v[224:225], v[224:225], s[92:93]
    v_pk_mul_f32 v[226:227], v[226:227], s[92:93]
    v_pk_mul_f32 v[228:229], v[228:229], s[92:93]
    v_pk_mul_f32 v[230:231], v[230:231], s[92:93]
    v_cvt_pk_bf16_f32 v208, v224, v225
    v_cvt_pk_bf16_f32 v209, v226, v227
    v_cvt_pk_bf16_f32 v210, v228, v229
    v_cvt_pk_bf16_f32 v211, v230, v231
    v_pk_mul_f32 v[232:233], v[232:233], s[92:93]
    v_pk_mul_f32 v[234:235], v[234:235], s[92:93]
    v_pk_mul_f32 v[236:237], v[236:237], s[92:93]
    v_pk_mul_f32 v[238:239], v[238:239], s[92:93]
    v_cvt_pk_bf16_f32 v212, v232, v233
    v_cvt_pk_bf16_f32 v213, v234, v235
    v_cvt_pk_bf16_f32 v214, v236, v237
    v_cvt_pk_bf16_f32 v215, v238, v239
    v_pk_mul_f32 v[240:241], v[240:241], s[92:93]
    v_pk_mul_f32 v[242:243], v[242:243], s[92:93]
    v_pk_mul_f32 v[244:245], v[244:245], s[92:93]
    v_pk_mul_f32 v[246:247], v[246:247], s[92:93]
    v_cvt_pk_bf16_f32 v216, v240, v241
    v_cvt_pk_bf16_f32 v217, v242, v243
    v_cvt_pk_bf16_f32 v218, v244, v245
    v_cvt_pk_bf16_f32 v219, v246, v247
    v_pk_mul_f32 v[248:249], v[248:249], s[92:93]
    v_pk_mul_f32 v[250:251], v[250:251], s[92:93]
    v_pk_mul_f32 v[252:253], v[252:253], s[92:93]
    v_pk_mul_f32 v[254:255], v[254:255], s[92:93]
    v_cvt_pk_bf16_f32 v220, v248, v249
    v_cvt_pk_bf16_f32 v221, v250, v251
    v_cvt_pk_bf16_f32 v222, v252, v253
    v_cvt_pk_bf16_f32 v223, v254, v255
    v_accvgpr_read_b32 v24, a96
    v_accvgpr_read_b32 v25, a97
    v_accvgpr_read_b32 v26, a98
    v_accvgpr_read_b32 v27, a99
    v_accvgpr_read_b32 v28, a100
    v_accvgpr_read_b32 v29, a101
    v_accvgpr_read_b32 v30, a102
    v_accvgpr_read_b32 v31, a103
    v_pk_mul_f32 v[24:25], v[24:25], s[92:93]
    v_pk_mul_f32 v[26:27], v[26:27], s[92:93]
    v_pk_mul_f32 v[28:29], v[28:29], s[92:93]
    v_pk_mul_f32 v[30:31], v[30:31], s[92:93]
    v_cvt_pk_bf16_f32 v224, v24, v25
    v_cvt_pk_bf16_f32 v225, v26, v27
    v_cvt_pk_bf16_f32 v226, v28, v29
    v_cvt_pk_bf16_f32 v227, v30, v31
    v_accvgpr_read_b32 v24, a104
    v_accvgpr_read_b32 v25, a105
    v_accvgpr_read_b32 v26, a106
    v_accvgpr_read_b32 v27, a107
    v_accvgpr_read_b32 v28, a108
    v_accvgpr_read_b32 v29, a109
    v_accvgpr_read_b32 v30, a110
    v_accvgpr_read_b32 v31, a111
    v_pk_mul_f32 v[24:25], v[24:25], s[92:93]
    v_pk_mul_f32 v[26:27], v[26:27], s[92:93]
    v_pk_mul_f32 v[28:29], v[28:29], s[92:93]
    v_pk_mul_f32 v[30:31], v[30:31], s[92:93]
    v_cvt_pk_bf16_f32 v228, v24, v25
    v_cvt_pk_bf16_f32 v229, v26, v27
    v_cvt_pk_bf16_f32 v230, v28, v29
    v_cvt_pk_bf16_f32 v231, v30, v31
    v_accvgpr_read_b32 v24, a112
    v_accvgpr_read_b32 v25, a113
    v_accvgpr_read_b32 v26, a114
    v_accvgpr_read_b32 v27, a115
    v_accvgpr_read_b32 v28, a116
    v_accvgpr_read_b32 v29, a117
    v_accvgpr_read_b32 v30, a118
    v_accvgpr_read_b32 v31, a119
    v_pk_mul_f32 v[24:25], v[24:25], s[92:93]
    v_pk_mul_f32 v[26:27], v[26:27], s[92:93]
    v_pk_mul_f32 v[28:29], v[28:29], s[92:93]
    v_pk_mul_f32 v[30:31], v[30:31], s[92:93]
    v_cvt_pk_bf16_f32 v232, v24, v25
    v_cvt_pk_bf16_f32 v233, v26, v27
    v_cvt_pk_bf16_f32 v234, v28, v29
    v_cvt_pk_bf16_f32 v235, v30, v31
    v_accvgpr_read_b32 v24, a120
    v_accvgpr_read_b32 v25, a121
    v_accvgpr_read_b32 v26, a122
    v_accvgpr_read_b32 v27, a123
    v_accvgpr_read_b32 v28, a124
    v_accvgpr_read_b32 v29, a125
    v_accvgpr_read_b32 v30, a126
    v_accvgpr_read_b32 v31, a127
    v_pk_mul_f32 v[24:25], v[24:25], s[92:93]
    v_pk_mul_f32 v[26:27], v[26:27], s[92:93]
    v_pk_mul_f32 v[28:29], v[28:29], s[92:93]
    v_pk_mul_f32 v[30:31], v[30:31], s[92:93]
    v_cvt_pk_bf16_f32 v236, v24, v25
    v_cvt_pk_bf16_f32 v237, v26, v27
    v_cvt_pk_bf16_f32 v238, v28, v29
    v_cvt_pk_bf16_f32 v239, v30, v31
    v_pk_mul_f32 v[160:161], v[160:161], s[92:93]
    v_pk_mul_f32 v[162:163], v[162:163], s[92:93]
    v_pk_mul_f32 v[164:165], v[164:165], s[92:93]
    v_pk_mul_f32 v[166:167], v[166:167], s[92:93]
    v_cvt_pk_bf16_f32 v240, v160, v161
    v_cvt_pk_bf16_f32 v241, v162, v163
    v_cvt_pk_bf16_f32 v242, v164, v165
    v_cvt_pk_bf16_f32 v243, v166, v167
    v_pk_mul_f32 v[168:169], v[168:169], s[92:93]
    v_pk_mul_f32 v[170:171], v[170:171], s[92:93]
    v_pk_mul_f32 v[172:173], v[172:173], s[92:93]
    v_pk_mul_f32 v[174:175], v[174:175], s[92:93]
    v_cvt_pk_bf16_f32 v244, v168, v169
    v_cvt_pk_bf16_f32 v245, v170, v171
    v_cvt_pk_bf16_f32 v246, v172, v173
    v_cvt_pk_bf16_f32 v247, v174, v175
    v_pk_mul_f32 v[176:177], v[176:177], s[92:93]
    v_pk_mul_f32 v[178:179], v[178:179], s[92:93]
    v_pk_mul_f32 v[180:181], v[180:181], s[92:93]
    v_pk_mul_f32 v[182:183], v[182:183], s[92:93]
    v_cvt_pk_bf16_f32 v248, v176, v177
    v_cvt_pk_bf16_f32 v249, v178, v179
    v_cvt_pk_bf16_f32 v250, v180, v181
    v_cvt_pk_bf16_f32 v251, v182, v183
    v_pk_mul_f32 v[184:185], v[184:185], s[92:93]
    v_pk_mul_f32 v[186:187], v[186:187], s[92:93]
    v_pk_mul_f32 v[188:189], v[188:189], s[92:93]
    v_pk_mul_f32 v[190:191], v[190:191], s[92:93]
    v_cvt_pk_bf16_f32 v252, v184, v185
    v_cvt_pk_bf16_f32 v253, v186, v187
    v_cvt_pk_bf16_f32 v254, v188, v189
    v_cvt_pk_bf16_f32 v255, v190, v191
    s_setpc_b64 s[20:21]
mega_kernel_ns254:
    s_mov_b32 s90, s98
    v_cvt_pk_bf16_f32 v32, v32, v33
    v_cvt_pk_bf16_f32 v33, v34, v35
    v_cvt_pk_bf16_f32 v34, v36, v37
    v_cvt_pk_bf16_f32 v35, v38, v39
    buffer_store_dwordx4 v[32:35], v2, s[8:11], s90 offen sc1
    s_add_u32 s90, s90, s100
    v_cvt_pk_bf16_f32 v40, v40, v41
    v_cvt_pk_bf16_f32 v41, v42, v43
    v_cvt_pk_bf16_f32 v42, v44, v45
    v_cvt_pk_bf16_f32 v43, v46, v47
    buffer_store_dwordx4 v[40:43], v2, s[8:11], s90 offen sc1
    s_add_u32 s90, s90, s100
    v_cvt_pk_bf16_f32 v48, v48, v49
    v_cvt_pk_bf16_f32 v49, v50, v51
    v_cvt_pk_bf16_f32 v50, v52, v53
    v_cvt_pk_bf16_f32 v51, v54, v55
    buffer_store_dwordx4 v[48:51], v2, s[8:11], s90 offen sc1
    s_add_u32 s90, s90, s100
    v_cvt_pk_bf16_f32 v56, v56, v57
    v_cvt_pk_bf16_f32 v57, v58, v59
    v_cvt_pk_bf16_f32 v58, v60, v61
    v_cvt_pk_bf16_f32 v59, v62, v63
    buffer_store_dwordx4 v[56:59], v2, s[8:11], s90 offen sc1
    s_add_u32 s90, s90, s100
    v_cvt_pk_bf16_f32 v64, v64, v65
    v_cvt_pk_bf16_f32 v65, v66, v67
    v_cvt_pk_bf16_f32 v66, v68, v69
    v_cvt_pk_bf16_f32 v67, v70, v71
    buffer_store_dwordx4 v[64:67], v2, s[8:11], s90 offen sc1
    s_add_u32 s90, s90, s100
    v_cvt_pk_bf16_f32 v72, v72, v73
    v_cvt_pk_bf16_f32 v73, v74, v75
    v_cvt_pk_bf16_f32 v74, v76, v77
    v_cvt_pk_bf16_f32 v75, v78, v79
    buffer_store_dwordx4 v[72:75], v2, s[8:11], s90 offen sc1
    s_add_u32 s90, s90, s100
    v_cvt_pk_bf16_f32 v80, v80, v81
    v_cvt_pk_bf16_f32 v81, v82, v83
    v_cvt_pk_bf16_f32 v82, v84, v85
    v_cvt_pk_bf16_f32 v83, v86, v87
    buffer_store_dwordx4 v[80:83], v2, s[8:11], s90 offen sc1
    s_add_u32 s90, s90, s100
    v_cvt_pk_bf16_f32 v88, v88, v89
    v_cvt_pk_bf16_f32 v89, v90, v91
    v_cvt_pk_bf16_f32 v90, v92, v93
    v_cvt_pk_bf16_f32 v91, v94, v95
    buffer_store_dwordx4 v[88:91], v2, s[8:11], s90 offen sc1
    s_add_u32 s90, s98, s99
    v_cvt_pk_bf16_f32 v96, v96, v97
    v_cvt_pk_bf16_f32 v97, v98, v99
    v_cvt_pk_bf16_f32 v98, v100, v101
    v_cvt_pk_bf16_f32 v99, v102, v103
    buffer_store_dwordx4 v[96:99], v2, s[8:11], s90 offen sc1
    s_add_u32 s90, s90, s100
    v_cvt_pk_bf16_f32 v104, v104, v105
    v_cvt_pk_bf16_f32 v105, v106, v107
    v_cvt_pk_bf16_f32 v106, v108, v109
    v_cvt_pk_bf16_f32 v107, v110, v111
    buffer_store_dwordx4 v[104:107], v2, s[8:11], s90 offen sc1
    s_add_u32 s90, s90, s100
    v_cvt_pk_bf16_f32 v112, v112, v113
    v_cvt_pk_bf16_f32 v113, v114, v115
    v_cvt_pk_bf16_f32 v114, v116, v117
    v_cvt_pk_bf16_f32 v115, v118, v119
    buffer_store_dwordx4 v[112:115], v2, s[8:11], s90 offen sc1
    s_add_u32 s90, s90, s100
    v_cvt_pk_bf16_f32 v120, v120, v121
    v_cvt_pk_bf16_f32 v121, v122, v123
    v_cvt_pk_bf16_f32 v122, v124, v125
    v_cvt_pk_bf16_f32 v123, v126, v127
    buffer_store_dwordx4 v[120:123], v2, s[8:11], s90 offen sc1
    s_add_u32 s90, s90, s100
    v_cvt_pk_bf16_f32 v128, v128, v129
    v_cvt_pk_bf16_f32 v129, v130, v131
    v_cvt_pk_bf16_f32 v130, v132, v133
    v_cvt_pk_bf16_f32 v131, v134, v135
    buffer_store_dwordx4 v[128:131], v2, s[8:11], s90 offen sc1
    s_add_u32 s90, s90, s100
    v_cvt_pk_bf16_f32 v136, v136, v137
    v_cvt_pk_bf16_f32 v137, v138, v139
    v_cvt_pk_bf16_f32 v138, v140, v141
    v_cvt_pk_bf16_f32 v139, v142, v143
    buffer_store_dwordx4 v[136:139], v2, s[8:11], s90 offen sc1
    s_add_u32 s90, s90, s100
    v_cvt_pk_bf16_f32 v144, v144, v145
    v_cvt_pk_bf16_f32 v145, v146, v147
    v_cvt_pk_bf16_f32 v146, v148, v149
    v_cvt_pk_bf16_f32 v147, v150, v151
    buffer_store_dwordx4 v[144:147], v2, s[8:11], s90 offen sc1
    s_add_u32 s90, s90, s100
    v_cvt_pk_bf16_f32 v152, v152, v153
    v_cvt_pk_bf16_f32 v153, v154, v155
    v_cvt_pk_bf16_f32 v154, v156, v157
    v_cvt_pk_bf16_f32 v155, v158, v159
    buffer_store_dwordx4 v[152:155], v2, s[8:11], s90 offen sc1
    s_add_u32 s90, s90, s100
    v_cvt_pk_bf16_f32 v192, v192, v193
    v_cvt_pk_bf16_f32 v193, v194, v195
    v_cvt_pk_bf16_f32 v194, v196, v197
    v_cvt_pk_bf16_f32 v195, v198, v199
    v_cvt_pk_bf16_f32 v196, v200, v201
    v_cvt_pk_bf16_f32 v197, v202, v203
    v_cvt_pk_bf16_f32 v198, v204, v205
    v_cvt_pk_bf16_f32 v199, v206, v207
    v_cvt_pk_bf16_f32 v200, v208, v209
    v_cvt_pk_bf16_f32 v201, v210, v211
    v_cvt_pk_bf16_f32 v202, v212, v213
    v_cvt_pk_bf16_f32 v203, v214, v215
    v_cvt_pk_bf16_f32 v204, v216, v217
    v_cvt_pk_bf16_f32 v205, v218, v219
    v_cvt_pk_bf16_f32 v206, v220, v221
    v_cvt_pk_bf16_f32 v207, v222, v223
    v_cvt_pk_bf16_f32 v208, v224, v225
    v_cvt_pk_bf16_f32 v209, v226, v227
    v_cvt_pk_bf16_f32 v210, v228, v229
    v_cvt_pk_bf16_f32 v211, v230, v231
    v_cvt_pk_bf16_f32 v212, v232, v233
    v_cvt_pk_bf16_f32 v213, v234, v235
    v_cvt_pk_bf16_f32 v214, v236, v237
    v_cvt_pk_bf16_f32 v215, v238, v239
    v_cvt_pk_bf16_f32 v216, v240, v241
    v_cvt_pk_bf16_f32 v217, v242, v243
    v_cvt_pk_bf16_f32 v218, v244, v245
    v_cvt_pk_bf16_f32 v219, v246, v247
    v_cvt_pk_bf16_f32 v220, v248, v249
    v_cvt_pk_bf16_f32 v221, v250, v251
    v_cvt_pk_bf16_f32 v222, v252, v253
    v_cvt_pk_bf16_f32 v223, v254, v255
    v_accvgpr_read_b32 v24, a96
    v_accvgpr_read_b32 v25, a97
    v_accvgpr_read_b32 v26, a98
    v_accvgpr_read_b32 v27, a99
    v_accvgpr_read_b32 v28, a100
    v_accvgpr_read_b32 v29, a101
    v_accvgpr_read_b32 v30, a102
    v_accvgpr_read_b32 v31, a103
    v_cvt_pk_bf16_f32 v224, v24, v25
    v_cvt_pk_bf16_f32 v225, v26, v27
    v_cvt_pk_bf16_f32 v226, v28, v29
    v_cvt_pk_bf16_f32 v227, v30, v31
    v_accvgpr_read_b32 v24, a104
    v_accvgpr_read_b32 v25, a105
    v_accvgpr_read_b32 v26, a106
    v_accvgpr_read_b32 v27, a107
    v_accvgpr_read_b32 v28, a108
    v_accvgpr_read_b32 v29, a109
    v_accvgpr_read_b32 v30, a110
    v_accvgpr_read_b32 v31, a111
    v_cvt_pk_bf16_f32 v228, v24, v25
    v_cvt_pk_bf16_f32 v229, v26, v27
    v_cvt_pk_bf16_f32 v230, v28, v29
    v_cvt_pk_bf16_f32 v231, v30, v31
    v_accvgpr_read_b32 v24, a112
    v_accvgpr_read_b32 v25, a113
    v_accvgpr_read_b32 v26, a114
    v_accvgpr_read_b32 v27, a115
    v_accvgpr_read_b32 v28, a116
    v_accvgpr_read_b32 v29, a117
    v_accvgpr_read_b32 v30, a118
    v_accvgpr_read_b32 v31, a119
    v_cvt_pk_bf16_f32 v232, v24, v25
    v_cvt_pk_bf16_f32 v233, v26, v27
    v_cvt_pk_bf16_f32 v234, v28, v29
    v_cvt_pk_bf16_f32 v235, v30, v31
    v_accvgpr_read_b32 v24, a120
    v_accvgpr_read_b32 v25, a121
    v_accvgpr_read_b32 v26, a122
    v_accvgpr_read_b32 v27, a123
    v_accvgpr_read_b32 v28, a124
    v_accvgpr_read_b32 v29, a125
    v_accvgpr_read_b32 v30, a126
    v_accvgpr_read_b32 v31, a127
    v_cvt_pk_bf16_f32 v236, v24, v25
    v_cvt_pk_bf16_f32 v237, v26, v27
    v_cvt_pk_bf16_f32 v238, v28, v29
    v_cvt_pk_bf16_f32 v239, v30, v31
    v_cvt_pk_bf16_f32 v240, v160, v161
    v_cvt_pk_bf16_f32 v241, v162, v163
    v_cvt_pk_bf16_f32 v242, v164, v165
    v_cvt_pk_bf16_f32 v243, v166, v167
    v_cvt_pk_bf16_f32 v244, v168, v169
    v_cvt_pk_bf16_f32 v245, v170, v171
    v_cvt_pk_bf16_f32 v246, v172, v173
    v_cvt_pk_bf16_f32 v247, v174, v175
    v_cvt_pk_bf16_f32 v248, v176, v177
    v_cvt_pk_bf16_f32 v249, v178, v179
    v_cvt_pk_bf16_f32 v250, v180, v181
    v_cvt_pk_bf16_f32 v251, v182, v183
    v_cvt_pk_bf16_f32 v252, v184, v185
    v_cvt_pk_bf16_f32 v253, v186, v187
    v_cvt_pk_bf16_f32 v254, v188, v189
    v_cvt_pk_bf16_f32 v255, v190, v191
    s_setpc_b64 s[20:21]
mega_kernel_end:
.text
.globl gemm3_kernel
.p2align 8
.type gemm3_kernel,@function
gemm3_kernel:
    s_cmp_ge_u32 s2, 256
    s_cbranch_scc1 gemm3_kernel_end1
    s_load_dwordx8 s[4:11], s[0:1], 64
    s_load_dwordx2 s[12:13], s[0:1], 16
    v_and_b32 v1, 63, v0
    v_lshrrev_b32 v16, 6, v0
    s_nop 0
    v_readfirstlane_b32 s36, v16
    s_cmp_lt_u32 s2, 248
    s_cbranch_scc1 gemm3_kernel_ncp2
    s_getpc_b64 s[24:25]
gemm3_kernel_pc3:
    s_sub_u32 s24, s24, gemm3_kernel_pc3-gemm3_kernel
    s_subb_u32 s25, s25, 0
    s_mov_b32 s26, gemm3_kernel_end-gemm3_kernel
    s_mov_b32 s27, 0x20000
    s_lshl_b32 s51, s36, 13
    v_lshlrev_b32 v22, 7, v1
    buffer_load_dword v23, v22, s[24:27], s51 offen
gemm3_kernel_ncp2:
    s_bfe_u32 s39, s2, 0x10002
    s_xor_b32 s39, s39, 1
    s_bfe_u32 s51, s2, 0x10001
    s_lshl_b32 s51, s51, 3
    s_bfe_u32 s52, s2, 0x30003
    s_add_u32 s40, s51, s52
    s_and_b32 s51, s2, 1
    s_lshl_b32 s51, s51, 2
    s_lshr_b32 s52, s2, 6
    s_add_u32 s41, s51, s52
    s_lshl_b32 s42, s40, 3
    s_add_u32 s42, s42, s41
    s_lshr_b32 s37, s36, 1
    s_and_b32 s38, s36, 1
    s_lshl_b32 s48, s36, 12
    v_lshlrev_b32 v7, 4, v1
    s_lshl_b32 s51, s40, 13
    s_lshl_b32 s52, s38, 12
    s_add_u32 s51, s51, s52
    s_lshl_b32 s52, s37, 17
    s_add_u32 s43, s51, s52
    s_mul_i32 s51, s39, 10485760
    s_add_u32 s44, s43, s51
    s_add_u32 s44, s44, 67108864
    s_mul_i32 s51, s39, 5242880
    s_lshl_b32 s45, s41, 8
    s_add_u32 s45, s45, s51
    v_lshrrev_b32 v16, 4, v1
    s_lshl_b32 s51, s36, 4
    v_add_u32 v17, s51, v16
    v_lshlrev_b32 v17, 11, v17
    v_lshlrev_b32 v16, 1, v16
    v_and_b32 v18, 15, v1
    v_xor_b32 v16, v16, v18
    v_xor_b32 v18, 0, v16
    v_lshl_add_u32 v8, v18, 4, v17
    v_xor_b32 v18, 8, v16
    v_lshl_add_u32 v9, v18, 4, v17
    v_add_u32 v9, 7168, v9
    v_xor_b32 v18, 0, v16
    v_lshl_add_u32 v10, v18, 4, v17
    v_add_u32 v10, 14336, v10
    v_xor_b32 v18, 8, v16
    v_lshl_add_u32 v11, v18, 4, v17
    v_add_u32 v11, 21504, v11
    s_mov_b32 s18, 268435456
    s_mov_b32 s19, 0x20000
    s_mov_b32 s23, 0x20000
    s_mov_b32 s22, 8388608
    s_mov_b32 s47, s48
    s_waitcnt lgkmcnt(0)
    s_mov_b32 s20, s4
    s_mov_b32 s21, s5
    s_mov_b32 s16, s10
    s_mov_b32 s17, s11
    s_mov_b32 m0, s47
    s_nop 0
    buffer_load_dwordx4 v7, s[16:19], s44 offen offset:0 lds
    buffer_load_dwordx4 v7, s[16:19], s44 offen offset:1024 lds
    buffer_load_dwordx4 v7, s[16:19], s44 offen offset:2048 lds
    buffer_load_dwordx4 v7, s[16:19], s44 offen offset:3072 lds
    s_add_u32 m0, s47, 16384
    s_add_u32 s44, s44, 262144
    buffer_load_dwordx4 v8, s[20:23], s45 offen offset:0 lds
    buffer_load_dwordx4 v9, s[20:23], s45 offen offset:1024 lds
    buffer_load_dwordx4 v10, s[20:23], s45 offen offset:2048 lds
    buffer_load_dwordx4 v11, s[20:23], s45 offen offset:3072 lds
    s_add_u32 s45, s45, 131072
    s_add_u32 s47, s47, 32768
    s_lshl_b32 s51, s37, 12
    v_add_u32 v2, s51, v7
    v_lshrrev_b32 v16, 2, v1
    v_lshlrev_b32 v16, 8, v16
    v_and_b32 v17, 3, v1
    v_lshl_add_u32 v16, v17, 3, v16
    v_add_u32 v16, 16384, v16
    v_bfe_u32 v17, v1, 2, 3
    s_lshl_b32 s51, s38, 2
    v_xor_b32 v17, s51, v17
    v_xor_b32 v18, 0, v17
    v_lshl_add_u32 v3, v18, 5, v16
    v_xor_b32 v18, 1, v17
    v_lshl_add_u32 v4, v18, 5, v16
    v_xor_b32 v18, 2, v17
    v_lshl_add_u32 v5, v18, 5, v16
    v_xor_b32 v18, 3, v17
    v_lshl_add_u32 v6, v18, 5, v16
    s_mov_b32 s24, s6
    s_mov_b32 s25, s7
    s_mov_b32 s27, 0x20000
    s_mov_b32 s26, 8388608
    s_mov_b32 s28, s10
    s_mov_b32 s29, s11
    s_mov_b32 s31, 0x20000
    s_mov_b32 s30, 268435456
    s_mov_b32 s32, s8
    s_mov_b32 s33, s9
    s_mov_b32 s35, 0x20000
    s_mov_b32 s34, 256
    s_mov_b32 s46, 0
    s_mov_b32 s60, 32768
    s_mov_b32 s50, 39
    v_mov_b32 v15, 0
    v_mov_b32 v32, 0
    v_mov_b32 v33, 0
    v_mov_b32 v34, 0
    v_mov_b32 v35, 0
    v_mov_b32 v36, 0
    v_mov_b32 v37, 0
    v_mov_b32 v38, 0
    v_mov_b32 v39, 0
    v_mov_b32 v40, 0
    v_mov_b32 v41, 0
    v_mov_b32 v42, 0
    v_mov_b32 v43, 0
    v_mov_b32 v44, 0
    v_mov_b32 v45, 0
    v_mov_b32 v46, 0
    v_mov_b32 v47, 0
    v_mov_b32 v48, 0
    v_mov_b32 v49, 0
    v_mov_b32 v50, 0
    v_mov_b32 v51, 0
    v_mov_b32 v52, 0
    v_mov_b32 v53, 0
    v_mov_b32 v54, 0
    v_mov_b32 v55, 0
    v_mov_b32 v56, 0
    v_mov_b32 v57, 0
    v_mov_b32 v58, 0
    v_mov_b32 v59, 0
    v_mov_b32 v60, 0
    v_mov_b32 v61, 0
    v_mov_b32 v62, 0
    v_mov_b32 v63, 0
    v_mov_b32 v64, 0
    v_mov_b32 v65, 0
    v_mov_b32 v66, 0
    v_mov_b32 v67, 0
    v_mov_b32 v68, 0
    v_mov_b32 v69, 0
    v_mov_b32 v70, 0
    v_mov_b32 v71, 0
    v_mov_b32 v72, 0
    v_mov_b32 v73, 0
    v_mov_b32 v74, 0
    v_mov_b32 v75, 0
    v_mov_b32 v76, 0
    v_mov_b32 v77, 0
    v_mov_b32 v78, 0
    v_mov_b32 v79, 0
    v_mov_b32 v80, 0
    v_mov_b32 v81, 0
    v_mov_b32 v82, 0
    v_mov_b32 v83, 0
    v_mov_b32 v84, 0
    v_mov_b32 v85, 0
    v_mov_b32 v86, 0
    v_mov_b32 v87, 0
    v_mov_b32 v88, 0
    v_mov_b32 v89, 0
    v_mov_b32 v90, 0
    v_mov_b32 v91, 0
    v_mov_b32 v92, 0
    v_mov_b32 v93, 0
    v_mov_b32 v94, 0
    v_mov_b32 v95, 0
    s_mov_b32 m0, s47
    s_nop 0
    buffer_load_dwordx4 v7, s[16:19], s44 offen offset:0 lds
    buffer_load_dwordx4 v7, s[16:19], s44 offen offset:1024 lds
    buffer_load_dwordx4 v7, s[16:19], s44 offen offset:2048 lds
    buffer_load_dwordx4 v7, s[16:19], s44 offen offset:3072 lds
    s_add_u32 m0, s47, 16384
    s_add_u32 s44, s44, 262144
    buffer_load_dwordx4 v8, s[20:23], s45 offen offset:0 lds
    buffer_load_dwordx4 v9, s[20:23], s45 offen offset:1024 lds
    buffer_load_dwordx4 v10, s[20:23], s45 offen offset:2048 lds
    buffer_load_dwordx4 v11, s[20:23], s45 offen offset:3072 lds
    s_add_u32 s45, s45, 131072
    s_add_u32 s47, s47, 32768
    s_mov_b32 m0, s47
    s_nop 0
    buffer_load_dwordx4 v7, s[16:19], s44 offen offset:0 lds
    buffer_load_dwordx4 v7, s[16:19], s44 offen offset:1024 lds
    buffer_load_dwordx4 v7, s[16:19], s44 offen offset:2048 lds
    buffer_load_dwordx4 v7, s[16:19], s44 offen offset:3072 lds
    s_add_u32 m0, s47, 16384
    s_add_u32 s44, s44, 262144
    buffer_load_dwordx4 v8, s[20:23], s45 offen offset:0 lds
    buffer_load_dwordx4 v9, s[20:23], s45 offen offset:1024 lds
    buffer_load_dwordx4 v10, s[20:23], s45 offen offset:2048 lds
    buffer_load_dwordx4 v11, s[20:23], s45 offen offset:3072 lds
    s_add_u32 s45, s45, 131072
    s_add_u32 s47, s47, 32768
    s_mov_b32 m0, s47
    s_nop 0
    buffer_load_dwordx4 v7, s[16:19], s44 offen offset:0 lds
    buffer_load_dwordx4 v7, s[16:19], s44 offen offset:1024 lds
    buffer_load_dwordx4 v7, s[16:19], s44 offen offset:2048 lds
    buffer_load_dwordx4 v7, s[16:19], s44 offen offset:3072 lds
    s_add_u32 m0, s47, 16384
    s_add_u32 s44, s44, 262144
    buffer_load_dwordx4 v8, s[20:23], s45 offen offset:0 lds
    buffer_load_dwordx4 v9, s[20:23], s45 offen offset:1024 lds
    buffer_load_dwordx4 v10, s[20:23], s45 offen offset:2048 lds
    buffer_load_dwordx4 v11, s[20:23], s45 offen offset:3072 lds
    s_add_u32 s45, s45, 131072
    s_add_u32 s47, s47, 32768
    s_mov_b32 m0, s47
    s_nop 0
    buffer_load_dwordx4 v7, s[16:19], s44 offen offset:0 lds
    buffer_load_dwordx4 v7, s[16:19], s44 offen offset:1024 lds
    buffer_load_dwordx4 v7, s[16:19], s44 offen offset:2048 lds
    buffer_load_dwordx4 v7, s[16:19], s44 offen offset:3072 lds
    s_cmp_eq_u32 s39, 1
    s_cselect_b32 s61, 19, 33
    s_cselect_b32 s62, 0, 8
    s_waitcnt vmcnt(28)
    s_barrier
    ds_read_b128 v[96:99], v2 offset:0
    ds_read_b64_tr_b16 v[112:113], v3 offset:0
    ds_read_b64_tr_b16 v[114:115], v3 offset:4096
    ds_read_b128 v[100:103], v2 offset:1024
    ds_read_b128 v[104:107], v2 offset:2048
    ds_read_b128 v[108:111], v2 offset:3072
    ds_read_b64_tr_b16 v[116:117], v4 offset:0
    ds_read_b64_tr_b16 v[118:119], v4 offset:4096
    ds_read_b64_tr_b16 v[120:121], v5 offset:0
    ds_read_b64_tr_b16 v[122:123], v5 offset:4096
    ds_read_b64_tr_b16 v[124:125], v6 offset:0
    ds_read_b64_tr_b16 v[126:127], v6 offset:4096
gemm3_kernel_loop4:
    s_sub_u32 s61, s61, 1
    s_cbranch_scc1 gemm3_kernel_ev5
gemm3_kernel_back6:
    s_waitcnt lgkmcnt(9)
    v_mfma_f32_16x16x32_bf16 v[32:35], v[112:115], v[96:99], v[32:35]
    ds_read_b128 v[128:131], v2 offset:8192
    s_waitcnt lgkmcnt(9)
    v_mfma_f32_16x16x32_bf16 v[40:43], v[112:115], v[100:103], v[40:43]
    ds_read_b64_tr_b16 v[144:145], v3 offset:8192
    s_add_u32 m0, s47, 16384
    s_add_u32 s44, s44, 262144
    buffer_load_dwordx4 v8, s[20:23], s45 offen offset:0 lds
    s_waitcnt lgkmcnt(9)
    v_mfma_f32_16x16x32_bf16 v[48:51], v[112:115], v[104:107], v[48:51]
    ds_read_b64_tr_b16 v[146:147], v3 offset:12288
    s_waitcnt lgkmcnt(9)
    v_mfma_f32_16x16x32_bf16 v[56:59], v[112:115], v[108:111], v[56:59]
    ds_read_b128 v[132:135], v2 offset:9216
    s_waitcnt lgkmcnt(8)
    v_mfma_f32_16x16x32_bf16 v[36:39], v[116:119], v[96:99], v[36:39]
    ds_read_b128 v[136:139], v2 offset:10240
    buffer_load_dwordx4 v9, s[20:23], s45 offen offset:1024 lds
    v_mfma_f32_16x16x32_bf16 v[44:47], v[116:119], v[100:103], v[44:47]
    ds_read_b128 v[140:143], v2 offset:11264
    v_mfma_f32_16x16x32_bf16 v[52:55], v[116:119], v[104:107], v[52:55]
    ds_read_b64_tr_b16 v[148:149], v4 offset:8192
    v_mfma_f32_16x16x32_bf16 v[60:63], v[116:119], v[108:111], v[60:63]
    ds_read_b64_tr_b16 v[150:151], v4 offset:12288
    buffer_load_dwordx4 v10, s[20:23], s45 offen offset:2048 lds
    s_waitcnt lgkmcnt(10)
    v_mfma_f32_16x16x32_bf16 v[64:67], v[120:123], v[96:99], v[64:67]
    ds_read_b64_tr_b16 v[152:153], v5 offset:8192
    v_mfma_f32_16x16x32_bf16 v[72:75], v[120:123], v[100:103], v[72:75]
    ds_read_b64_tr_b16 v[154:155], v5 offset:12288
    v_mfma_f32_16x16x32_bf16 v[80:83], v[120:123], v[104:107], v[80:83]
    ds_read_b64_tr_b16 v[156:157], v6 offset:8192
    buffer_load_dwordx4 v11, s[20:23], s45 offen offset:3072 lds
    s_add_u32 s45, s45, 131072
    v_mfma_f32_16x16x32_bf16 v[88:91], v[120:123], v[108:111], v[88:91]
    ds_read_b64_tr_b16 v[158:159], v6 offset:12288
    s_waitcnt lgkmcnt(12)
    v_mfma_f32_16x16x32_bf16 v[68:71], v[124:127], v[96:99], v[68:71]
    s_add_u32 s47, s46, s48
    s_add_u32 s46, s46, 32768
    v_mfma_f32_16x16x32_bf16 v[76:79], v[124:127], v[100:103], v[76:79]
    s_cmp_ge_u32 s46, 163840
    s_cselect_b32 s49, 4294836224, s60
    v_mfma_f32_16x16x32_bf16 v[84:87], v[124:127], v[104:107], v[84:87]
    s_cselect_b32 s46, 0, s46
    v_add_u32 v2, s49, v2
    v_add_u32 v3, s49, v3
    v_mfma_f32_16x16x32_bf16 v[92:95], v[124:127], v[108:111], v[92:95]
    v_add_u32 v4, s49, v4
    v_add_u32 v5, s49, v5
    s_waitcnt vmcnt(24) lgkmcnt(0)
    v_mfma_f32_16x16x32_bf16 v[32:35], v[144:147], v[128:131], v[32:35]
    s_barrier
    v_add_u32 v6, s49, v6
    v_mfma_f32_16x16x32_bf16 v[40:43], v[144:147], v[132:135], v[40:43]
    ds_read_b128 v[96:99], v2 offset:0
    v_mfma_f32_16x16x32_bf16 v[48:51], v[144:147], v[136:139], v[48:51]
    ds_read_b64_tr_b16 v[112:113], v3 offset:0
    v_mfma_f32_16x16x32_bf16 v[56:59], v[144:147], v[140:143], v[56:59]
    ds_read_b64_tr_b16 v[114:115], v3 offset:4096
    s_mov_b32 m0, s47
    s_nop 0
    buffer_load_dwordx4 v7, s[16:19], s44 offen offset:0 lds
    v_mfma_f32_16x16x32_bf16 v[36:39], v[148:151], v[128:131], v[36:39]
    ds_read_b128 v[100:103], v2 offset:1024
    v_mfma_f32_16x16x32_bf16 v[44:47], v[148:151], v[132:135], v[44:47]
    ds_read_b128 v[104:107], v2 offset:2048
    v_mfma_f32_16x16x32_bf16 v[52:55], v[148:151], v[136:139], v[52:55]
    ds_read_b128 v[108:111], v2 offset:3072
    buffer_load_dwordx4 v7, s[16:19], s44 offen offset:1024 lds
    v_mfma_f32_16x16x32_bf16 v[60:63], v[148:151], v[140:143], v[60:63]
    ds_read_b64_tr_b16 v[116:117], v4 offset:0
    v_mfma_f32_16x16x32_bf16 v[64:67], v[152:155], v[128:131], v[64:67]
    ds_read_b64_tr_b16 v[118:119], v4 offset:4096
    v_mfma_f32_16x16x32_bf16 v[72:75], v[152:155], v[132:135], v[72:75]
    ds_read_b64_tr_b16 v[120:121], v5 offset:0
    buffer_load_dwordx4 v7, s[16:19], s44 offen offset:2048 lds
    v_mfma_f32_16x16x32_bf16 v[80:83], v[152:155], v[136:139], v[80:83]
    ds_read_b64_tr_b16 v[122:123], v5 offset:4096
    v_mfma_f32_16x16x32_bf16 v[88:91], v[152:155], v[140:143], v[88:91]
    ds_read_b64_tr_b16 v[124:125], v6 offset:0
    v_mfma_f32_16x16x32_bf16 v[68:71], v[156:159], v[128:131], v[68:71]
    ds_read_b64_tr_b16 v[126:127], v6 offset:4096
    v_mfma_f32_16x16x32_bf16 v[76:79], v[156:159], v[132:135], v[76:79]
    buffer_load_dwordx4 v7, s[16:19], s44 offen offset:3072 lds
    v_mfma_f32_16x16x32_bf16 v[84:87], v[156:159], v[136:139], v[84:87]
    v_mfma_f32_16x16x32_bf16 v[92:95], v[156:159], v[140:143], v[92:95]
    s_sub_u32 s50, s50, 1
    s_cbranch_scc0 gemm3_kernel_loop4
    v_and_b32 v16, 15, v1
    v_lshlrev_b32 v16, 12, v16
    v_lshlrev_b32 v16, s39, v16
    v_bfe_u32 v17, v1, 4, 1
    v_lshl_add_u32 v16, v17, 5, v16
    v_lshrrev_b32 v17, 5, v1
    v_lshl_add_u32 v12, v17, 4, v16
    s_lshl_b32 s51, s40, 3
    s_lshl_b32 s52, s37, 2
    s_add_u32 s51, s51, s52
    s_lshl_b32 s52, s51, 16
    s_add_u32 s52, s52, 2048
    s_and_b32 s53, s51, 63
    s_lshl_b32 s53, s53, 17
    s_lshr_b32 s54, s51, 6
    s_lshl_b32 s54, s54, 12
    s_add_u32 s53, s53, s54
    s_cmp_eq_u32 s39, 1
    s_cselect_b32 s51, s53, s52
    s_lshl_b32 s52, 0x10000, s39
    s_lshl_b32 s53, s41, 8
    s_lshl_b32 s54, s38, 7
    s_add_u32 s51, s51, s53
    s_add_u32 s51, s51, s54
    s_cmp_eq_u32 s39, 1
    s_cbranch_scc1 gemm3_kernel_noadd7
    s_waitcnt vmcnt(0)
    v_add_f32 v32, v32, v160
    v_add_f32 v33, v33, v161
    v_add_f32 v34, v34, v162
    v_add_f32 v35, v35, v163
    v_add_f32 v36, v36, v164
    v_add_f32 v37, v37, v165
    v_add_f32 v38, v38, v166
    v_add_f32 v39, v39, v167
    v_add_f32 v40, v40, v168
    v_add_f32 v41, v41, v169
    v_add_f32 v42, v42, v170
    v_add_f32 v43, v43, v171
    v_add_f32 v44, v44, v172
    v_add_f32 v45, v45, v173
    v_add_f32 v46, v46, v174
    v_add_f32 v47, v47, v175
    v_add_f32 v48, v48, v176
    v_add_f32 v49, v49, v177
    v_add_f32 v50, v50, v178
    v_add_f32 v51, v51, v179
    v_add_f32 v52, v52, v180
    v_add_f32 v53, v53, v181
    v_add_f32 v54, v54, v182
    v_add_f32 v55, v55, v183
    v_add_f32 v56, v56, v184
    v_add_f32 v57, v57, v185
    v_add_f32 v58, v58, v186
    v_add_f32 v59, v59, v187
    v_add_f32 v60, v60, v188
    v_add_f32 v61, v61, v189
    v_add_f32 v62, v62, v190
    v_add_f32 v63, v63, v191
    v_add_f32 v64, v64, v192
    v_add_f32 v65, v65, v193
    v_add_f32 v66, v66, v194
    v_add_f32 v67, v67, v195
    v_add_f32 v68, v68, v196
    v_add_f32 v69, v69, v197
    v_add_f32 v70, v70, v198
    v_add_f32 v71, v71, v199
    v_add_f32 v72, v72, v200
    v_add_f32 v73, v73, v201
    v_add_f32 v74, v74, v202
    v_add_f32 v75, v75, v203
    v_add_f32 v76, v76, v204
    v_add_f32 v77, v77, v205
    v_add_f32 v78, v78, v206
    v_add_f32 v79, v79, v207
    v_add_f32 v80, v80, v208
    v_add_f32 v81, v81, v209
    v_add_f32 v82, v82, v210
    v_add_f32 v83, v83, v211
    v_add_f32 v84, v84, v212
    v_add_f32 v85, v85, v213
    v_add_f32 v86, v86, v214
    v_add_f32 v87, v87, v215
    v_add_f32 v88, v88, v216
    v_add_f32 v89, v89, v217
    v_add_f32 v90, v90, v218
    v_add_f32 v91, v91, v219
    v_add_f32 v92, v92, v220
    v_add_f32 v93, v93, v221
    v_add_f32 v94, v94, v222
    v_add_f32 v95, v95, v223
gemm3_kernel_noadd7:
    v_cvt_pk_bf16_f32 v32, v32, v33
    v_cvt_pk_bf16_f32 v33, v34, v35
    v_cvt_pk_bf16_f32 v34, v36, v37
    v_cvt_pk_bf16_f32 v35, v38, v39
    v_cvt_pk_bf16_f32 v64, v64, v65
    v_cvt_pk_bf16_f32 v65, v66, v67
    v_cvt_pk_bf16_f32 v66, v68, v69
    v_cvt_pk_bf16_f32 v67, v70, v71
    s_nop 1
    v_permlane16_swap_b32 v32, v34
    v_permlane16_swap_b32 v33, v35
    v_permlane16_swap_b32 v64, v66
    v_permlane16_swap_b32 v65, v67
    buffer_store_dwordx4 v[32:35], v12, s[24:27], s51 offen offset:0
    buffer_store_dwordx4 v[64:67], v12, s[24:27], s51 offen offset:64
    s_add_u32 s51, s51, s52
    v_cvt_pk_bf16_f32 v40, v40, v41
    v_cvt_pk_bf16_f32 v41, v42, v43
    v_cvt_pk_bf16_f32 v42, v44, v45
    v_cvt_pk_bf16_f32 v43, v46, v47
    v_cvt_pk_bf16_f32 v72, v72, v73
    v_cvt_pk_bf16_f32 v73, v74, v75
    v_cvt_pk_bf16_f32 v74, v76, v77
    v_cvt_pk_bf16_f32 v75, v78, v79
    s_nop 1
    v_permlane16_swap_b32 v40, v42
    v_permlane16_swap_b32 v41, v43
    v_permlane16_swap_b32 v72, v74
    v_permlane16_swap_b32 v73, v75
    buffer_store_dwordx4 v[40:43], v12, s[24:27], s51 offen offset:0
    buffer_store_dwordx4 v[72:75], v12, s[24:27], s51 offen offset:64
    s_add_u32 s51, s51, s52
    v_cvt_pk_bf16_f32 v48, v48, v49
    v_cvt_pk_bf16_f32 v49, v50, v51
    v_cvt_pk_bf16_f32 v50, v52, v53
    v_cvt_pk_bf16_f32 v51, v54, v55
    v_cvt_pk_bf16_f32 v80, v80, v81
    v_cvt_pk_bf16_f32 v81, v82, v83
    v_cvt_pk_bf16_f32 v82, v84, v85
    v_cvt_pk_bf16_f32 v83, v86, v87
    s_nop 1
    v_permlane16_swap_b32 v48, v50
    v_permlane16_swap_b32 v49, v51
    v_permlane16_swap_b32 v80, v82
    v_permlane16_swap_b32 v81, v83
    buffer_store_dwordx4 v[48:51], v12, s[24:27], s51 offen offset:0
    buffer_store_dwordx4 v[80:83], v12, s[24:27], s51 offen offset:64
    s_add_u32 s51, s51, s52
    v_cvt_pk_bf16_f32 v56, v56, v57
    v_cvt_pk_bf16_f32 v57, v58, v59
    v_cvt_pk_bf16_f32 v58, v60, v61
    v_cvt_pk_bf16_f32 v59, v62, v63
    v_cvt_pk_bf16_f32 v88, v88, v89
    v_cvt_pk_bf16_f32 v89, v90, v91
    v_cvt_pk_bf16_f32 v90, v92, v93
    v_cvt_pk_bf16_f32 v91, v94, v95
    s_nop 1
    v_permlane16_swap_b32 v56, v58
    v_permlane16_swap_b32 v57, v59
    v_permlane16_swap_b32 v88, v90
    v_permlane16_swap_b32 v89, v91
    buffer_store_dwordx4 v[56:59], v12, s[24:27], s51 offen offset:0
    buffer_store_dwordx4 v[88:91], v12, s[24:27], s51 offen offset:64
    s_add_u32 s51, s51, s52
gemm3_kernel_end1:
    s_endpgm
gemm3_kernel_ev5:
    s_cmp_lg_u32 s62, 0
    s_cbranch_scc1 gemm3_kernel_n8
    s_add_u32 s44, s43, 83623936
    s_mov_b32 s61, 0
    s_mov_b32 s62, 1
    s_branch gemm3_kernel_back6
gemm3_kernel_n8:
    s_cmp_lg_u32 s62, 1
    s_cbranch_scc1 gemm3_kernel_n9
    s_mov_b32 s20, s12
    s_mov_b32 s21, s13
    s_mov_b32 s22, 2097152
    s_lshl_b32 s45, s41, 8
    s_mov_b32 s61, 3
    s_mov_b32 s62, 2
    s_branch gemm3_kernel_back6
gemm3_kernel_n9:
    s_cmp_lg_u32 s62, 2
    s_cbranch_scc1 gemm3_kernel_n10
    s_lshl_b32 s51, s42, 16
    s_lshl_b32 s52, s36, 14
    s_add_u32 s51, s51, s52
    s_add_u32 s51, s51, 100663296
    s_nop 7
    buffer_store_dwordx4 v[32:35], v7, s[28:31], s51 offen offset:0 sc1
    buffer_store_dwordx4 v[36:39], v7, s[28:31], s51 offen offset:1024 sc1
    buffer_store_dwordx4 v[40:43], v7, s[28:31], s51 offen offset:2048 sc1
    buffer_store_dwordx4 v[44:47], v7, s[28:31], s51 offen offset:3072 sc1
    s_add_u32 s51, s51, 4096
    buffer_store_dwordx4 v[48:51], v7, s[28:31], s51 offen offset:0 sc1
    buffer_store_dwordx4 v[52:55], v7, s[28:31], s51 offen offset:1024 sc1
    buffer_store_dwordx4 v[56:59], v7, s[28:31], s51 offen offset:2048 sc1
    buffer_store_dwordx4 v[60:63], v7, s[28:31], s51 offen offset:3072 sc1
    s_add_u32 s51, s51, 4096
    buffer_store_dwordx4 v[64:67], v7, s[28:31], s51 offen offset:0 sc1
    buffer_store_dwordx4 v[68:71], v7, s[28:31], s51 offen offset:1024 sc1
    buffer_store_dwordx4 v[72:75], v7, s[28:31], s51 offen offset:2048 sc1
    buffer_store_dwordx4 v[76:79], v7, s[28:31], s51 offen offset:3072 sc1
    s_add_u32 s51, s51, 4096
    buffer_store_dwordx4 v[80:83], v7, s[28:31], s51 offen offset:0 sc1
    buffer_store_dwordx4 v[84:87], v7, s[28:31], s51 offen offset:1024 sc1
    buffer_store_dwordx4 v[88:91], v7, s[28:31], s51 offen offset:2048 sc1
    buffer_store_dwordx4 v[92:95], v7, s[28:31], s51 offen offset:3072 sc1
    s_add_u32 s51, s51, 4096
    s_nop 1
    v_mov_b32 v32, 0
    v_mov_b32 v33, 0
    v_mov_b32 v34, 0
    v_mov_b32 v35, 0
    v_mov_b32 v36, 0
    v_mov_b32 v37, 0
    v_mov_b32 v38, 0
    v_mov_b32 v39, 0
    v_mov_b32 v40, 0
    v_mov_b32 v41, 0
    v_mov_b32 v42, 0
    v_mov_b32 v43, 0
    v_mov_b32 v44, 0
    v_mov_b32 v45, 0
    v_mov_b32 v46, 0
    v_mov_b32 v47, 0
    v_mov_b32 v48, 0
    v_mov_b32 v49, 0
    v_mov_b32 v50, 0
    v_mov_b32 v51, 0
    v_mov_b32 v52, 0
    v_mov_b32 v53, 0
    v_mov_b32 v54, 0
    v_mov_b32 v55, 0
    v_mov_b32 v56, 0
    v_mov_b32 v57, 0
    v_mov_b32 v58, 0
    v_mov_b32 v59, 0
    v_mov_b32 v60, 0
    v_mov_b32 v61, 0
    v_mov_b32 v62, 0
    v_mov_b32 v63, 0
    v_mov_b32 v64, 0
    v_mov_b32 v65, 0
    v_mov_b32 v66, 0
    v_mov_b32 v67, 0
    v_mov_b32 v68, 0
    v_mov_b32 v69, 0
    v_mov_b32 v70, 0
    v_mov_b32 v71, 0
    v_mov_b32 v72, 0
    v_mov_b32 v73, 0
    v_mov_b32 v74, 0
    v_mov_b32 v75, 0
    v_mov_b32 v76, 0
    v_mov_b32 v77, 0
    v_mov_b32 v78, 0
    v_mov_b32 v79, 0
    v_mov_b32 v80, 0
    v_mov_b32 v81, 0
    v_mov_b32 v82, 0
    v_mov_b32 v83, 0
    v_mov_b32 v84, 0
    v_mov_b32 v85, 0
    v_mov_b32 v86, 0
    v_mov_b32 v87, 0
    v_mov_b32 v88, 0
    v_mov_b32 v89, 0
    v_mov_b32 v90, 0
    v_mov_b32 v91, 0
    v_mov_b32 v92, 0
    v_mov_b32 v93, 0
    v_mov_b32 v94, 0
    v_mov_b32 v95, 0
    s_nop 1
    s_mov_b32 s61, 4
    s_mov_b32 s62, 3
    s_branch gemm3_kernel_back6
gemm3_kernel_n10:
    s_cmp_lg_u32 s62, 3
    s_cbranch_scc1 gemm3_kernel_n11
    s_cmp_lg_u32 s36, 0
    s_cbranch_scc1 gemm3_kernel_np12
    s_lshl_b32 s51, s42, 7
    s_add_u32 s51, s51, 117506048
    v_mov_b32 v16, 1
    s_mov_b64 exec, 1
    buffer_store_dword v16, off, s[28:31], s51 sc1
    s_mov_b64 exec, -1
gemm3_kernel_np12:
    s_mov_b32 s61, 5
    s_mov_b32 s62, 4
    s_branch gemm3_kernel_back6
gemm3_kernel_n11:
    s_cmp_lg_u32 s62, 4
    s_cbranch_scc1 gemm3_kernel_n13
    s_mov_b32 s18, 0
    s_mov_b32 s61, 1000
    s_mov_b32 s62, 5
    s_branch gemm3_kernel_back6
gemm3_kernel_n13:
    s_cmp_lg_u32 s62, 8
    s_cbranch_scc1 gemm3_kernel_n14
    s_lshl_b32 s51, s42, 7
    s_add_u32 s51, s51, 117506048
    buffer_load_dword v14, off, s[28:31], s51 sc1
    s_mov_b32 s61, 1
    s_mov_b32 s62, 9
    s_branch gemm3_kernel_back6
gemm3_kernel_n14:
    s_cmp_lg_u32 s62, 9
    s_cbranch_scc1 gemm3_kernel_n15
    s_mov_b32 s18, 0
    s_mov_b32 s61, 0
    s_mov_b32 s62, 10
    s_branch gemm3_kernel_back6
gemm3_kernel_n15:
    s_cmp_lg_u32 s62, 10
    s_cbranch_scc1 gemm3_kernel_n16
    s_mov_b32 s22, 0
    s_waitcnt vmcnt(16)
    s_mov_b32 s3, 1048576
gemm3_kernel_spin17:
    v_readfirstlane_b32 s52, v14
    s_nop 3
    s_cmp_lg_u32 s52, 0
    s_cbranch_scc1 gemm3_kernel_ok18
    s_sub_u32 s3, s3, 1
    s_cbranch_scc1 gemm3_kernel_ok18
    s_sleep 8
    s_lshl_b32 s51, s42, 7
    s_add_u32 s51, s51, 117506048
    buffer_load_dword v14, off, s[28:31], s51 sc1
    s_waitcnt vmcnt(0)
    s_branch gemm3_kernel_spin17
gemm3_kernel_ok18:
    s_lshl_b32 s51, s42, 16
    s_lshl_b32 s52, s36, 14
    s_add_u32 s51, s51, s52
    s_add_u32 s51, s51, 100663296
    buffer_load_dwordx4 v[160:163], v7, s[28:31], s51 offen offset:0 sc1
    buffer_load_dwordx4 v[164:167], v7, s[28:31], s51 offen offset:1024 sc1
    buffer_load_dwordx4 v[168:171], v7, s[28:31], s51 offen offset:2048 sc1
    buffer_load_dwordx4 v[172:175], v7, s[28:31], s51 offen offset:3072 sc1
    s_add_u32 s51, s51, 4096
    buffer_load_dwordx4 v[176:179], v7, s[28:31], s51 offen offset:0 sc1
    buffer_load_dwordx4 v[180:183], v7, s[28:31], s51 offen offset:1024 sc1
    buffer_load_dwordx4 v[184:187], v7, s[28:31], s51 offen offset:2048 sc1
    buffer_load_dwordx4 v[188:191], v7, s[28:31], s51 offen offset:3072 sc1
    s_add_u32 s51, s51, 4096
    buffer_load_dwordx4 v[192:195], v7, s[28:31], s51 offen offset:0 sc1
    buffer_load_dwordx4 v[196:199], v7, s[28:31], s51 offen offset:1024 sc1
    buffer_load_dwordx4 v[200:203], v7, s[28:31], s51 offen offset:2048 sc1
    buffer_load_dwordx4 v[204:207], v7, s[28:31], s51 offen offset:3072 sc1
    s_add_u32 s51, s51, 4096
    buffer_load_dwordx4 v[208:211], v7, s[28:31], s51 offen offset:0 sc1
    buffer_load_dwordx4 v[212:215], v7, s[28:31], s51 offen offset:1024 sc1
    buffer_load_dwordx4 v[216:219], v7, s[28:31], s51 offen offset:2048 sc1
    buffer_load_dwordx4 v[220:223], v7, s[28:31], s51 offen offset:3072 sc1
    s_add_u32 s51, s51, 4096
    s_mov_b32 s61, 1000
    s_mov_b32 s62, 11
    s_branch gemm3_kernel_back6
gemm3_kernel_n16:
    s_mov_b32 s61, 1000
    s_branch gemm3_kernel_back6
gemm3_kernel_end:
.section .rodata,"a"
.p2align 6
.amdhsa_kernel mega_kernel
  .amdhsa_next_free_vgpr 512
  .amdhsa_next_free_sgpr 102
  .amdhsa_accum_offset 256
  .amdhsa_group_segment_fixed_size 0
  .amdhsa_kernarg_size 96
  .amdhsa_user_sgpr_count 2
  .amdhsa_user_sgpr_kernarg_segment_ptr 1
  .amdhsa_system_sgpr_workgroup_id_x 1
.end_amdhsa_kernel
.section .rodata,"a"
.p2align 6
.amdhsa_kernel gemm3_kernel
  .amdhsa_next_free_vgpr 224
  .amdhsa_next_free_sgpr 102
  .amdhsa_accum_offset 224
  .amdhsa_group_segment_fixed_size 0
  .amdhsa_kernarg_size 96
  .amdhsa_user_sgpr_count 2
  .amdhsa_user_sgpr_kernarg_segment_ptr 1
  .amdhsa_system_sgpr_workgroup_id_x 1
.end_amdhsa_kernel
```

```asm
; @launch kernel=mega_kernel grid=(256,1,1) block=(256,1,1) lds=163840
; @launch kernel=gemm3_kernel grid=(256,1,1) block=(512,1,1) lds=163840
.amdgcn_target "amdgcn-amd-amdhsa--gfx950"
.text
.globl mega_kernel
.p2align 8
.type mega_kernel,@function
mega_kernel:
    s_cmp_ge_u32 s2, 256
    s_cbranch_scc1 mega_kernel_end1
    s_load_dwordx16 s[24:39], s[0:1], 0
    s_load_dwordx4 s[4:7], s[0:1], 80
    v_and_b32 v1, 63, v0
    v_lshrrev_b32 v24, 6, v0
    s_nop 0
    v_readfirstlane_b32 s16, v24
    s_lshr_b32 s68, s2, 3
    s_lshr_b32 s57, s16, 1
    s_and_b32 s58, s16, 1
    s_mov_b32 s43, 0x20000
    s_mov_b32 s47, 0x20000
    s_cmp_lt_u32 s68, 30
    s_cbranch_scc1 mega_kernel_ncp2
    s_sub_u32 s91, s68, 30
    s_lshl_b32 s91, s91, 2
    s_add_u32 s91, s91, s16
    s_getpc_b64 s[8:9]
mega_kernel_pc3:
    s_sub_u32 s8, s8, mega_kernel_pc3-mega_kernel
    s_subb_u32 s9, s9, 0
    s_mov_b32 s10, gemm3_kernel_end-mega_kernel
    s_mov_b32 s11, 0x20000
    s_lshl_b32 s90, s91, 13
    v_lshlrev_b32 v24, 7, v1
    buffer_load_dword v22, v24, s[8:11], s90 offen
mega_kernel_ncp2:
    v_and_b32 v24, 15, v1
    v_lshrrev_b32 v25, 4, v1
    v_bfe_u32 v26, v1, 1, 3
    v_xor_b32 v26, v26, v25
    s_lshl_b32 s90, s57, 14
    v_lshlrev_b32 v27, 7, v24
    v_add_u32 v27, s90, v27
    v_xor_b32 v28, 0, v26
    v_lshl_add_u32 v6, v28, 4, v27
    v_xor_b32 v28, 4, v26
    v_lshl_add_u32 v7, v28, 4, v27
    v_bfe_u32 v26, v1, 2, 2
    v_lshl_add_u32 v27, v25, 3, v26
    v_lshlrev_b32 v27, 9, v27
    v_and_b32 v28, 3, v1
    v_lshlrev_b32 v28, 3, v28
    v_add_u32 v27, v27, v28
    s_lshl_b32 s90, s58, 8
    s_add_u32 s90, s90, 98304
    v_add_u32 v27, s90, v27
    v_bfe_u32 v26, v1, 2, 3
    v_xor_b32 v28, 0, v26
    v_lshl_add_u32 v8, v28, 5, v27
    v_xor_b32 v28, 1, v26
    v_lshl_add_u32 v9, v28, 5, v27
    v_xor_b32 v28, 2, v26
    v_lshl_add_u32 v10, v28, 5, v27
    v_xor_b32 v28, 3, v26
    v_lshl_add_u32 v11, v28, 5, v27
    v_xor_b32 v28, 4, v26
    v_lshl_add_u32 v12, v28, 5, v27
    v_xor_b32 v28, 5, v26
    v_lshl_add_u32 v13, v28, 5, v27
    v_xor_b32 v28, 6, v26
    v_lshl_add_u32 v14, v28, 5, v27
    v_xor_b32 v28, 7, v26
    v_lshl_add_u32 v15, v28, 5, v27
    v_lshlrev_b32 v2, 4, v1
    s_lshl_b32 s61, s16, 13
    s_add_u32 s62, s61, 98304
    s_mov_b32 s64, 0
    s_mov_b32 s59, 32768
    s_mov_b32 s60, 229376
    s_waitcnt lgkmcnt(0)
    s_mov_b32 s8, s6
    s_mov_b32 s9, s7
    s_mov_b32 s10, 268435456
    s_mov_b32 s11, 0x20000
    s_mov_b32 s70, 0
    s_cmp_ge_u32 s68, 16
    s_cbranch_scc1 mega_kernel_typea4
    s_and_b32 s69, s68, 3
    s_and_b32 s90, s2, 1
    s_lshl_b32 s90, s90, 2
    s_add_u32 s69, s69, s90
    s_bfe_u32 s90, s2, 0x20001
    s_mul_i32 s90, s90, 4
    s_bfe_u32 s91, s68, 0x20002
    s_add_u32 s90, s90, s91
    s_mov_b32 s76, 8388608
    s_mov_b32 s78, 8192
    s_mov_b32 s81, 0
    s_mov_b32 s73, 4194304
    s_mov_b32 s77, 2048
    s_mov_b32 s82, 16
    s_lshl_b32 s80, s90, 9
    s_lshl_b32 s79, s69, 19
    s_lshl_b32 s88, s90, 4
    s_add_u32 s88, s88, s69
    s_lshl_b32 s88, s88, 3
    s_mov_b32 s83, 0
    s_mov_b32 s84, 1040356334
    s_lshl_b32 s91, s90, 1
    s_add_u32 s91, s91, s58
    s_lshl_b32 s91, s91, 19
    s_lshl_b32 s92, s69, 1
    s_add_u32 s92, s92, s57
    s_lshl_b32 s92, s92, 15
    s_add_u32 s85, s91, s92
    s_add_u32 s85, s85, 0
    s_mov_b32 s86, 1024
    s_mov_b32 s87, 4096
    s_mov_b32 s71, s30
    s_mov_b32 s72, s31
    s_mov_b32 s74, s34
    s_mov_b32 s75, s35
    s_branch mega_kernel_go15
mega_kernel_typea4:
    s_cmp_lt_u32 s68, 28
    s_cbranch_scc1 mega_kernel_nopf6
    s_mov_b32 s70, 1
    s_sub_u32 s93, s2, 224
    s_lshl_b32 s93, s93, 2
    s_add_u32 s93, s93, s16
    v_lshlrev_b32 v24, 7, v1
    v_lshrrev_b32 v25, 3, v1
    v_lshlrev_b32 v25, 11, v25
    v_and_b32 v26, 7, v1
    v_lshl_add_u32 v25, v26, 7, v25
    s_lshl_b32 s92, s93, 13
    s_lshl_b32 s93, s93, 14
    s_add_u32 s93, s93, 1024
    s_mov_b32 s40, s26
    s_mov_b32 s41, s27
    s_mov_b32 s42, 6291456
    s_add_u32 s90, s92, 0
    buffer_load_dword v22, v24, s[40:43], s90 offen
    s_add_u32 s90, s92, 1048576
    buffer_load_dword v22, v24, s[40:43], s90 offen
    s_mov_b32 s40, s24
    s_mov_b32 s41, s25
    s_mov_b32 s42, 4194304
    s_add_u32 s90, s92, 0
    buffer_load_dword v22, v24, s[40:43], s90 offen
    s_add_u32 s90, s92, 1048576
    buffer_load_dword v22, v24, s[40:43], s90 offen
    s_add_u32 s90, s92, 2097152
    buffer_load_dword v22, v24, s[40:43], s90 offen
    s_add_u32 s90, s92, 3145728
    buffer_load_dword v22, v24, s[40:43], s90 offen
    s_mov_b32 s40, s34
    s_mov_b32 s41, s35
    s_mov_b32 s42, 8388608
    s_add_u32 s90, s92, 4194304
    buffer_load_dword v22, v24, s[40:43], s90 offen
    s_add_u32 s90, s92, 5242880
    buffer_load_dword v22, v24, s[40:43], s90 offen
    s_mov_b32 s40, s30
    s_mov_b32 s41, s31
    s_mov_b32 s42, 4194304
    s_add_u32 s90, s93, 0
    buffer_load_dword v22, v25, s[40:43], s90 offen
    s_add_u32 s90, s93, 2097152
    buffer_load_dword v22, v25, s[40:43], s90 offen
    s_mov_b32 s40, s26
    s_mov_b32 s41, s27
    s_mov_b32 s42, 6291456
    s_add_u32 s90, s92, 2097152
    buffer_load_dword v22, v24, s[40:43], s90 offen
    s_mov_b32 s40, s34
    s_mov_b32 s41, s35
    s_mov_b32 s42, 8388608
    s_add_u32 s90, s92, 6291456
    buffer_load_dword v22, v24, s[40:43], s90 offen
    s_add_u32 s90, s92, 7340032
    buffer_load_dword v22, v24, s[40:43], s90 offen
    s_mov_b32 s40, s26
    s_mov_b32 s41, s27
    s_mov_b32 s42, 6291456
    s_add_u32 s90, s92, 3145728
    buffer_load_dword v22, v24, s[40:43], s90 offen
    s_add_u32 s90, s92, 4194304
    buffer_load_dword v22, v24, s[40:43], s90 offen
    s_add_u32 s90, s92, 5242880
    buffer_load_dword v22, v24, s[40:43], s90 offen
    s_mov_b32 s40, s32
    s_mov_b32 s41, s33
    s_mov_b32 s42, 2097152
    s_add_u32 s90, s92, 1048576
    buffer_load_dword v22, v24, s[40:43], s90 offen
mega_kernel_nopf6:
    s_bfe_u32 s69, s68, 0x20002
    s_add_u32 s69, s69, 0
    s_and_b32 s90, s2, 7
    s_lshl_b32 s90, s90, 2
    s_and_b32 s91, s68, 3
    s_add_u32 s90, s90, s91
    s_cmp_lt_u32 s90, 16
    s_cselect_b32 s83, 0, 1
    s_mov_b32 s91, 33554432
    s_cselect_b32 s85, 16777216, s91
    s_mov_b32 s91, 8192
    s_cselect_b32 s86, 1024, s91
    s_mov_b32 s91, 1024
    s_cselect_b32 s87, 4096, s91
    s_cselect_b32 s74, s36, s38
    s_cselect_b32 s75, s37, s39
    s_mov_b32 s71, s32
    s_mov_b32 s72, s33
    s_mov_b32 s73, 2097152
    s_mov_b32 s77, 1024
    s_mov_b32 s82, 8
    s_mov_b32 s81, 0
    s_mov_b32 s76, 4194304
    s_mov_b32 s78, 8192
    s_mov_b32 s84, 0
    s_and_b32 s90, s90, 15
    s_lshl_b32 s80, s90, 9
    s_lshl_b32 s79, s69, 18
    s_mul_i32 s91, s83, 3
    s_add_u32 s91, s91, s69
    s_add_u32 s91, s91, 8
    s_lshl_b32 s92, s83, 2
    s_add_u32 s92, s92, s69
    s_add_u32 s92, s92, 508
    s_cmp_ge_u32 s69, 4
    s_cselect_b32 s91, s92, s91
    s_add_u32 s92, s83, 256
    s_cmp_eq_u32 s69, 3
    s_cselect_b32 s91, s92, s91
    s_lshl_b32 s88, s90, 4
    s_add_u32 s88, s88, s91
    s_lshl_b32 s88, s88, 3
    s_lshl_b32 s91, s90, 1
    s_add_u32 s91, s91, s58
    s_lshl_b32 s91, s91, 19
    s_lshl_b32 s92, s69, 1
    s_add_u32 s92, s92, s57
    s_lshl_b32 s92, s92, 15
    s_add_u32 s85, s85, s91
    s_add_u32 s85, s85, s92
mega_kernel_go15:
    s_mov_b32 s42, s73
    s_mov_b32 s46, s76
    s_lshl_b32 s90, s77, 4
    s_lshl_b32 s90, s90, s81
    s_mov_b32 s48, s79
    s_mul_i32 s91, s90, 1
    s_add_u32 s49, s91, s79
    s_sub_u32 s49, s49, 2048
    s_mul_i32 s91, s90, 2
    s_add_u32 s50, s91, s79
    s_mul_i32 s91, s90, 3
    s_add_u32 s51, s91, s79
    s_sub_u32 s51, s51, 2048
    s_mov_b32 s52, s80
    s_lshl_b32 s90, s78, 2
    s_mul_i32 s91, s90, 1
    s_add_u32 s53, s91, s80
    s_sub_u32 s53, s53, 2048
    s_mul_i32 s91, s90, 2
    s_add_u32 s54, s91, s80
    s_mul_i32 s91, s90, 3
    s_add_u32 s55, s91, s80
    s_sub_u32 s55, s55, 2048
    s_lshl_b32 s56, s78, 6
    s_lshl_b32 s90, s58, 7
    s_add_u32 s90, s90, s57
    s_lshl_b32 s91, s16, 6
    s_cmp_eq_u32 s81, 1
    s_cselect_b32 s90, s90, s91
    v_lshrrev_b32 v24, 3, v1
    v_lshlrev_b32 v24, s81, v24
    v_add_u32 v24, s90, v24
    v_mul_lo_u32 v24, v24, s77
    v_lshrrev_b32 v25, 4, v1
    v_and_b32 v26, 7, v1
    v_xor_b32 v25, v25, v26
    v_lshl_add_u32 v16, v25, 4, v24
    v_xor_b32 v25, 4, v25
    v_lshl_add_u32 v17, v25, 4, v24
    s_lshl_b32 s90, s77, 3
    s_lshl_b32 s90, s90, s81
    s_sub_u32 s90, s90, 1024
    v_add_u32 v17, s90, v17
    v_lshrrev_b32 v24, 5, v1
    s_lshl_b32 s90, s16, 4
    v_add_u32 v25, s90, v24
    v_mul_lo_u32 v25, v25, s78
    v_lshlrev_b32 v24, 1, v24
    v_and_b32 v26, 31, v1
    v_xor_b32 v24, v24, v26
    s_lshl_b32 s90, s78, 1
    s_sub_u32 s90, s90, 1024
    v_add_u32 v27, s90, v25
    v_xor_b32 v26, 0, v24
    v_lshl_add_u32 v18, v26, 4, v25
    v_xor_b32 v26, 4, v24
    v_lshl_add_u32 v19, v26, 4, v27
    v_xor_b32 v26, 8, v24
    v_lshl_add_u32 v20, v26, 4, v25
    v_xor_b32 v26, 12, v24
    v_lshl_add_u32 v21, v26, 4, v27
    s_mov_b32 s40, s71
    s_mov_b32 s41, s72
    s_mov_b32 s44, s74
    s_mov_b32 s45, s75
    s_mov_b32 s95, s82
    s_mov_b32 s96, s83
    s_mov_b32 s97, s84
    s_mov_b32 s98, s85
    s_mov_b32 s99, s86
    s_mov_b32 s100, s87
    s_mov_b32 s101, s88
    s_add_u32 m0, s61, 0
    s_nop 0
    buffer_load_dwordx4 v16, s[40:43], s48 offen offset:0 lds
    buffer_load_dwordx4 v17, s[40:43], s48 offen offset:1024 lds
    s_add_u32 s48, s48, 128
    buffer_load_dwordx4 v16, s[40:43], s49 offen offset:2048 lds
    buffer_load_dwordx4 v17, s[40:43], s49 offen offset:3072 lds
    s_add_u32 s49, s49, 128
    s_add_u32 m0, s61, 4096
    s_nop 0
    buffer_load_dwordx4 v16, s[40:43], s50 offen offset:0 lds
    buffer_load_dwordx4 v17, s[40:43], s50 offen offset:1024 lds
    s_add_u32 s50, s50, 128
    buffer_load_dwordx4 v16, s[40:43], s51 offen offset:2048 lds
    buffer_load_dwordx4 v17, s[40:43], s51 offen offset:3072 lds
    s_add_u32 s51, s51, 128
    s_add_u32 s61, s61, 32768
    s_cmp_ge_u32 s61, 98304
    s_cselect_b32 s90, 98304, 0
    s_sub_u32 s61, s61, s90
    s_add_u32 m0, s62, 0
    s_nop 0
    buffer_load_dwordx4 v18, s[44:47], s52 offen offset:0 lds
    buffer_load_dwordx4 v19, s[44:47], s52 offen offset:1024 lds
    s_add_u32 s52, s52, s56
    buffer_load_dwordx4 v18, s[44:47], s53 offen offset:2048 lds
    buffer_load_dwordx4 v19, s[44:47], s53 offen offset:3072 lds
    s_add_u32 s53, s53, s56
    s_add_u32 m0, s62, 4096
    s_nop 0
    buffer_load_dwordx4 v20, s[44:47], s54 offen offset:0 lds
    buffer_load_dwordx4 v21, s[44:47], s54 offen offset:1024 lds
    s_add_u32 s54, s54, s56
    buffer_load_dwordx4 v20, s[44:47], s55 offen offset:2048 lds
    buffer_load_dwordx4 v21, s[44:47], s55 offen offset:3072 lds
    s_add_u32 s55, s55, s56
    s_xor_b32 s62, s62, 229376
    s_cmp_ge_u32 s68, 16
    s_cbranch_scc1 mega_kernel_typea7
    s_bfe_u32 s69, s68, 0x20002
    s_add_u32 s69, s69, 4
    s_and_b32 s90, s2, 7
    s_lshl_b32 s90, s90, 2
    s_and_b32 s91, s68, 3
    s_add_u32 s90, s90, s91
    s_cmp_lt_u32 s90, 16
    s_cselect_b32 s83, 0, 1
    s_mov_b32 s91, 33554432
    s_cselect_b32 s85, 16777216, s91
    s_mov_b32 s91, 8192
    s_cselect_b32 s86, 1024, s91
    s_mov_b32 s91, 1024
    s_cselect_b32 s87, 4096, s91
    s_cselect_b32 s74, s36, s38
    s_cselect_b32 s75, s37, s39
    s_mov_b32 s71, s32
    s_mov_b32 s72, s33
    s_mov_b32 s73, 2097152
    s_mov_b32 s77, 1024
    s_mov_b32 s82, 8
    s_mov_b32 s81, 0
    s_mov_b32 s76, 4194304
    s_mov_b32 s78, 8192
    s_mov_b32 s84, 0
    s_and_b32 s90, s90, 15
    s_lshl_b32 s80, s90, 9
    s_lshl_b32 s79, s69, 18
    s_mul_i32 s91, s83, 3
    s_add_u32 s91, s91, s69
    s_add_u32 s91, s91, 8
    s_lshl_b32 s92, s83, 2
    s_add_u32 s92, s92, s69
    s_add_u32 s92, s92, 508
    s_cmp_ge_u32 s69, 4
    s_cselect_b32 s91, s92, s91
    s_add_u32 s92, s83, 256
    s_cmp_eq_u32 s69, 3
    s_cselect_b32 s91, s92, s91
    s_lshl_b32 s88, s90, 4
    s_add_u32 s88, s88, s91
    s_lshl_b32 s88, s88, 3
    s_lshl_b32 s91, s90, 1
    s_add_u32 s91, s91, s58
    s_lshl_b32 s91, s91, 19
    s_lshl_b32 s92, s69, 1
    s_add_u32 s92, s92, s57
    s_lshl_b32 s92, s92, 15
    s_add_u32 s85, s85, s91
    s_add_u32 s85, s85, s92
    s_branch mega_kernel_go28
mega_kernel_typea7:
    s_and_b32 s69, s68, 3
    s_and_b32 s90, s2, 1
    s_lshl_b32 s90, s90, 2
    s_add_u32 s69, s69, s90
    s_bfe_u32 s90, s2, 0x20001
    s_mul_i32 s90, s90, 3
    s_bfe_u32 s91, s68, 0x20002
    s_add_u32 s90, s90, s91
    s_mov_b32 s76, 6291456
    s_mov_b32 s78, 6144
    s_mov_b32 s81, 1
    s_mov_b32 s73, 4194304
    s_mov_b32 s77, 2048
    s_mov_b32 s82, 16
    s_lshl_b32 s80, s90, 9
    s_lshl_b32 s79, s69, 19
    s_and_b32 s92, s90, 3
    s_lshr_b32 s91, s90, 2
    s_lshl_b32 s88, s92, 2
    s_add_u32 s88, s88, s91
    s_lshl_b32 s88, s88, 3
    s_add_u32 s88, s88, s69
    s_lshl_b32 s88, s88, 3
    s_add_u32 s88, s88, 6144
    s_cmp_eq_u32 s91, 0
    s_cselect_b32 s84, 1048744942, 0
    s_lshl_b32 s93, s91, 22
    s_add_u32 s85, s93, 50331648
    s_lshl_b32 s92, s92, 1
    s_add_u32 s92, s92, s58
    s_lshl_b32 s92, s92, 19
    s_add_u32 s85, s85, s92
    s_lshl_b32 s92, s57, 3
    s_add_u32 s92, s92, s69
    s_cmp_eq_u32 s91, 2
    s_cselect_b32 s83, 1, 0
    s_cselect_b32 s93, 12, 13
    s_mov_b32 s91, 131072
    s_cselect_b32 s86, 1024, s91
    s_mov_b32 s91, 1024
    s_cselect_b32 s87, 65536, s91
    s_lshl_b32 s92, s92, s93
    s_add_u32 s85, s85, s92
    s_mov_b32 s71, s24
    s_mov_b32 s72, s25
    s_mov_b32 s74, s26
    s_mov_b32 s75, s27
mega_kernel_go28:
    s_xor_b32 s94, s70, 1
    s_mov_b32 s67, 2
    s_mov_b32 s17, -1
    s_mov_b32 s12, s4
    s_mov_b32 s13, s5
    s_mov_b32 s14, 256
    s_mov_b32 s15, 0x20000
    s_lshl_b32 s90, s2, 2
    s_add_u32 s90, s90, s16
    s_cmp_lg_u32 s90, 0
    s_cbranch_scc1 mega_kernel_tok9
    s_memrealtime s[92:93]
    s_waitcnt lgkmcnt(0)
    s_or_b32 s92, s92, 1
    v_mov_b32 v4, s92
    v_mov_b32 v5, s93
    s_mov_b64 exec, 1
    buffer_store_dwordx2 v[4:5], off, s[12:15], 0 sc1
    s_mov_b64 exec, -1
mega_kernel_tok9:
    s_add_u32 m0, s61, 0
    s_nop 0
    buffer_load_dwordx4 v16, s[40:43], s48 offen offset:0 lds
    buffer_load_dwordx4 v17, s[40:43], s48 offen offset:1024 lds
    s_add_u32 s48, s48, 128
    buffer_load_dwordx4 v16, s[40:43], s49 offen offset:2048 lds
    buffer_load_dwordx4 v17, s[40:43], s49 offen offset:3072 lds
    s_add_u32 s49, s49, 128
    s_add_u32 m0, s61, 4096
    s_nop 0
    buffer_load_dwordx4 v16, s[40:43], s50 offen offset:0 lds
    buffer_load_dwordx4 v17, s[40:43], s50 offen offset:1024 lds
    s_add_u32 s50, s50, 128
    buffer_load_dwordx4 v16, s[40:43], s51 offen offset:2048 lds
    buffer_load_dwordx4 v17, s[40:43], s51 offen offset:3072 lds
    s_add_u32 s51, s51, 128
    s_add_u32 s61, s61, 32768
    s_cmp_ge_u32 s61, 98304
    s_cselect_b32 s90, 98304, 0
    s_sub_u32 s61, s61, s90
    s_add_u32 m0, s62, 0
    s_nop 0
    buffer_load_dwordx4 v18, s[44:47], s52 offen offset:0 lds
    buffer_load_dwordx4 v19, s[44:47], s52 offen offset:1024 lds
    s_add_u32 s52, s52, s56
    buffer_load_dwordx4 v18, s[44:47], s53 offen offset:2048 lds
    buffer_load_dwordx4 v19, s[44:47], s53 offen offset:3072 lds
    s_add_u32 s53, s53, s56
    s_add_u32 m0, s62, 4096
    s_nop 0
    buffer_load_dwordx4 v20, s[44:47], s54 offen offset:0 lds
    buffer_load_dwordx4 v21, s[44:47], s54 offen offset:1024 lds
    s_add_u32 s54, s54, s56
    buffer_load_dwordx4 v20, s[44:47], s55 offen offset:2048 lds
    buffer_load_dwordx4 v21, s[44:47], s55 offen offset:3072 lds
    s_add_u32 s55, s55, s56
    s_xor_b32 s62, s62, 229376
    s_waitcnt vmcnt(16)
    s_barrier
    ds_read_b64_tr_b16 a[64:65], v8 offset:0
    ds_read_b64_tr_b16 a[66:67], v8 offset:2048
    ds_read_b128 a[0:3], v6 offset:0
    ds_read_b128 a[4:7], v6 offset:2048
    ds_read_b64_tr_b16 a[68:69], v9 offset:0
    ds_read_b64_tr_b16 a[70:71], v9 offset:2048
    ds_read_b128 a[8:11], v6 offset:4096
    ds_read_b128 a[12:15], v6 offset:6144
    ds_read_b64_tr_b16 a[72:73], v10 offset:0
    ds_read_b64_tr_b16 a[74:75], v10 offset:2048
    ds_read_b128 a[16:19], v6 offset:8192
    ds_read_b128 a[20:23], v6 offset:10240
    ds_read_b64_tr_b16 a[76:77], v11 offset:0
    ds_read_b64_tr_b16 a[78:79], v11 offset:2048
    ds_read_b128 a[24:27], v6 offset:12288
    ds_read_b128 a[28:31], v6 offset:14336
    ds_read_b64_tr_b16 a[80:81], v12 offset:0
    ds_read_b64_tr_b16 a[82:83], v12 offset:2048
    ds_read_b64_tr_b16 a[84:85], v13 offset:0
    ds_read_b64_tr_b16 a[86:87], v13 offset:2048
    ds_read_b64_tr_b16 a[88:89], v14 offset:0
    ds_read_b64_tr_b16 a[90:91], v14 offset:2048
    ds_read_b64_tr_b16 a[92:93], v15 offset:0
    ds_read_b64_tr_b16 a[94:95], v15 offset:2048
    s_mov_b32 s66, 1
mega_kernel_tile10:
    s_sub_u32 s65, s95, 1
    s_cmp_eq_u32 s96, 1
    s_cbranch_scc1 mega_kernel_swp12
    s_waitcnt lgkmcnt(15)
    v_mfma_f32_16x16x32_bf16 v[32:35], a[64:67], a[0:3], 0
    v_mfma_f32_16x16x32_bf16 v[40:43], a[64:67], a[4:7], 0
    v_mfma_f32_16x16x32_bf16 v[48:51], a[64:67], a[8:11], 0
    v_mfma_f32_16x16x32_bf16 v[56:59], a[64:67], a[12:15], 0
    s_waitcnt lgkmcnt(13)
    v_mfma_f32_16x16x32_bf16 v[64:67], a[64:67], a[16:19], 0
    s_add_u32 m0, s61, 0
    s_nop 0
    buffer_load_dwordx4 v16, s[40:43], s48 offen offset:0 lds
    s_waitcnt lgkmcnt(12)
    v_mfma_f32_16x16x32_bf16 v[72:75], a[64:67], a[20:23], 0
    s_waitcnt lgkmcnt(9)
    v_mfma_f32_16x16x32_bf16 v[80:83], a[64:67], a[24:27], 0
    s_waitcnt lgkmcnt(8)
    v_mfma_f32_16x16x32_bf16 v[88:91], a[64:67], a[28:31], 0
    ds_read_b64_tr_b16 a[64:65], v8 offset:16384
    v_mfma_f32_16x16x32_bf16 v[36:39], a[68:71], a[0:3], 0
    ds_read_b64_tr_b16 a[66:67], v8 offset:18432
    v_mfma_f32_16x16x32_bf16 v[44:47], a[68:71], a[4:7], 0
    v_mfma_f32_16x16x32_bf16 v[52:55], a[68:71], a[8:11], 0
    ds_read_b128 a[32:35], v7 offset:0
    v_mfma_f32_16x16x32_bf16 v[60:63], a[68:71], a[12:15], 0
    buffer_load_dwordx4 v17, s[40:43], s48 offen offset:1024 lds
    s_add_u32 s48, s48, 128
    v_mfma_f32_16x16x32_bf16 v[68:71], a[68:71], a[16:19], 0
    v_mfma_f32_16x16x32_bf16 v[76:79], a[68:71], a[20:23], 0
    v_mfma_f32_16x16x32_bf16 v[84:87], a[68:71], a[24:27], 0
    ds_read_b128 a[36:39], v7 offset:2048
    v_mfma_f32_16x16x32_bf16 v[92:95], a[68:71], a[28:31], 0
    ds_read_b64_tr_b16 a[68:69], v9 offset:16384
    v_mfma_f32_16x16x32_bf16 v[96:99], a[72:75], a[0:3], 0
    ds_read_b64_tr_b16 a[70:71], v9 offset:18432
    v_mfma_f32_16x16x32_bf16 v[104:107], a[72:75], a[4:7], 0
    buffer_load_dwordx4 v16, s[40:43], s49 offen offset:2048 lds
    v_mfma_f32_16x16x32_bf16 v[112:115], a[72:75], a[8:11], 0
    ds_read_b128 a[40:43], v7 offset:4096
    v_mfma_f32_16x16x32_bf16 v[120:123], a[72:75], a[12:15], 0
    v_mfma_f32_16x16x32_bf16 v[128:131], a[72:75], a[16:19], 0
    v_mfma_f32_16x16x32_bf16 v[136:139], a[72:75], a[20:23], 0
    v_mfma_f32_16x16x32_bf16 v[144:147], a[72:75], a[24:27], 0
    ds_read_b128 a[44:47], v7 offset:6144
    v_mfma_f32_16x16x32_bf16 v[152:155], a[72:75], a[28:31], 0
    ds_read_b64_tr_b16 a[72:73], v10 offset:16384
    buffer_load_dwordx4 v17, s[40:43], s49 offen offset:3072 lds
    s_add_u32 s49, s49, 128
    v_mfma_f32_16x16x32_bf16 v[100:103], a[76:79], a[0:3], 0
    ds_read_b64_tr_b16 a[74:75], v10 offset:18432
    v_mfma_f32_16x16x32_bf16 v[108:111], a[76:79], a[4:7], 0
    v_mfma_f32_16x16x32_bf16 v[116:119], a[76:79], a[8:11], 0
    ds_read_b128 a[48:51], v7 offset:8192
    v_mfma_f32_16x16x32_bf16 v[124:127], a[76:79], a[12:15], 0
    v_mfma_f32_16x16x32_bf16 v[132:135], a[76:79], a[16:19], 0
    s_add_u32 m0, s61, 4096
    s_nop 0
    buffer_load_dwordx4 v16, s[40:43], s50 offen offset:0 lds
    v_mfma_f32_16x16x32_bf16 v[140:143], a[76:79], a[20:23], 0
    v_mfma_f32_16x16x32_bf16 v[148:151], a[76:79], a[24:27], 0
    ds_read_b128 a[52:55], v7 offset:10240
    v_mfma_f32_16x16x32_bf16 v[156:159], a[76:79], a[28:31], 0
    ds_read_b64_tr_b16 a[76:77], v11 offset:16384
    s_waitcnt lgkmcnt(15)
    v_mfma_f32_16x16x32_bf16 v[160:163], a[80:83], a[0:3], 0
    ds_read_b64_tr_b16 a[78:79], v11 offset:18432
    v_mfma_f32_16x16x32_bf16 v[168:171], a[80:83], a[4:7], 0
    v_mfma_f32_16x16x32_bf16 v[176:179], a[80:83], a[8:11], 0
    ds_read_b128 a[56:59], v7 offset:12288
    v_mfma_f32_16x16x32_bf16 v[184:187], a[80:83], a[12:15], 0
    buffer_load_dwordx4 v17, s[40:43], s50 offen offset:1024 lds
    s_add_u32 s50, s50, 128
    v_mfma_f32_16x16x32_bf16 v[192:195], a[80:83], a[16:19], 0
    v_mfma_f32_16x16x32_bf16 v[200:203], a[80:83], a[20:23], 0
    v_mfma_f32_16x16x32_bf16 v[208:211], a[80:83], a[24:27], 0
    ds_read_b128 a[60:63], v7 offset:14336
    v_mfma_f32_16x16x32_bf16 v[216:219], a[80:83], a[28:31], 0
    ds_read_b64_tr_b16 a[80:81], v12 offset:16384
    v_mfma_f32_16x16x32_bf16 v[164:167], a[84:87], a[0:3], 0
    ds_read_b64_tr_b16 a[82:83], v12 offset:18432
    v_mfma_f32_16x16x32_bf16 v[172:175], a[84:87], a[4:7], 0
    buffer_load_dwordx4 v16, s[40:43], s51 offen offset:2048 lds
    v_mfma_f32_16x16x32_bf16 v[180:183], a[84:87], a[8:11], 0
    v_mfma_f32_16x16x32_bf16 v[188:191], a[84:87], a[12:15], 0
    v_mfma_f32_16x16x32_bf16 v[196:199], a[84:87], a[16:19], 0
    v_mfma_f32_16x16x32_bf16 v[204:207], a[84:87], a[20:23], 0
    v_mfma_f32_16x16x32_bf16 v[212:215], a[84:87], a[24:27], 0
    buffer_load_dwordx4 v17, s[40:43], s51 offen offset:3072 lds
    s_add_u32 s51, s51, 128
    v_mfma_f32_16x16x32_bf16 v[220:223], a[84:87], a[28:31], 0
    ds_read_b64_tr_b16 a[84:85], v13 offset:16384
    v_mfma_f32_16x16x32_bf16 v[224:227], a[88:91], a[0:3], 0
    ds_read_b64_tr_b16 a[86:87], v13 offset:18432
    v_mfma_f32_16x16x32_bf16 v[232:235], a[88:91], a[4:7], 0
    v_mfma_f32_16x16x32_bf16 v[240:243], a[88:91], a[8:11], 0
    v_mfma_f32_16x16x32_bf16 v[248:251], a[88:91], a[12:15], 0
    v_mfma_f32_16x16x32_bf16 a[96:99], a[88:91], a[16:19], 0
    v_mfma_f32_16x16x32_bf16 a[104:107], a[88:91], a[20:23], 0
    s_add_u32 s61, s61, 32768
    s_cmp_ge_u32 s61, 98304
    s_cselect_b32 s90, 98304, 0
    s_sub_u32 s61, s61, s90
    v_mfma_f32_16x16x32_bf16 a[112:115], a[88:91], a[24:27], 0
    v_mfma_f32_16x16x32_bf16 a[120:123], a[88:91], a[28:31], 0
    ds_read_b64_tr_b16 a[88:89], v14 offset:16384
    s_waitcnt lgkmcnt(15)
    v_mfma_f32_16x16x32_bf16 v[228:231], a[92:95], a[0:3], 0
    ds_read_b64_tr_b16 a[90:91], v14 offset:18432
    v_mfma_f32_16x16x32_bf16 v[236:239], a[92:95], a[4:7], 0
    s_add_u32 s64, s64, 32768
    s_cmp_ge_u32 s64, 98304
    s_cselect_b32 s63, 4294901760, s59
    s_cselect_b32 s64, 0, s64
    v_mfma_f32_16x16x32_bf16 v[244:247], a[92:95], a[8:11], 0
    v_add_u32 v6, s63, v6
    v_mfma_f32_16x16x32_bf16 v[252:255], a[92:95], a[12:15], 0
    v_add_u32 v7, s63, v7
    v_mfma_f32_16x16x32_bf16 a[100:103], a[92:95], a[16:19], 0
    v_mfma_f32_16x16x32_bf16 a[108:111], a[92:95], a[20:23], 0
    v_mfma_f32_16x16x32_bf16 a[116:119], a[92:95], a[24:27], 0
    v_mfma_f32_16x16x32_bf16 a[124:127], a[92:95], a[28:31], 0
    ds_read_b64_tr_b16 a[92:93], v15 offset:16384
    ds_read_b64_tr_b16 a[94:95], v15 offset:18432
    v_mfma_f32_16x16x32_bf16 v[32:35], a[64:67], a[32:35], v[32:35]
    v_xor_b32 v8, s60, v8
    v_mfma_f32_16x16x32_bf16 v[40:43], a[64:67], a[36:39], v[40:43]
    v_xor_b32 v9, s60, v9
    s_waitcnt lgkmcnt(15)
    v_mfma_f32_16x16x32_bf16 v[48:51], a[64:67], a[40:43], v[48:51]
    v_xor_b32 v10, s60, v10
    v_mfma_f32_16x16x32_bf16 v[56:59], a[64:67], a[44:47], v[56:59]
    v_xor_b32 v11, s60, v11
    s_waitcnt lgkmcnt(13)
    v_mfma_f32_16x16x32_bf16 v[64:67], a[64:67], a[48:51], v[64:67]
    v_xor_b32 v12, s60, v12
    s_waitcnt lgkmcnt(12)
    v_mfma_f32_16x16x32_bf16 v[72:75], a[64:67], a[52:55], v[72:75]
    v_xor_b32 v13, s60, v13
    s_waitcnt lgkmcnt(9)
    v_mfma_f32_16x16x32_bf16 v[80:83], a[64:67], a[56:59], v[80:83]
    v_xor_b32 v14, s60, v14
    v_xor_b32 v15, s60, v15
    s_waitcnt lgkmcnt(8)
    s_waitcnt lgkmcnt(0)
    s_waitcnt vmcnt(40)
    s_cmp_eq_u32 s66, 0
    s_cbranch_scc1 mega_kernel_w13
    s_waitcnt vmcnt(8)
mega_kernel_w13:
    v_mfma_f32_16x16x32_bf16 v[88:91], a[64:67], a[60:63], v[88:91]
    s_barrier
    ds_read_b64_tr_b16 a[64:65], v8 offset:0
    v_mfma_f32_16x16x32_bf16 v[36:39], a[68:71], a[32:35], v[36:39]
    ds_read_b64_tr_b16 a[66:67], v8 offset:2048
    v_mfma_f32_16x16x32_bf16 v[44:47], a[68:71], a[36:39], v[44:47]
    s_add_u32 m0, s62, 0
    s_nop 0
    buffer_load_dwordx4 v18, s[44:47], s52 offen offset:0 lds
    v_mfma_f32_16x16x32_bf16 v[52:55], a[68:71], a[40:43], v[52:55]
    ds_read_b128 a[0:3], v6 offset:0
    v_mfma_f32_16x16x32_bf16 v[60:63], a[68:71], a[44:47], v[60:63]
    v_mfma_f32_16x16x32_bf16 v[68:71], a[68:71], a[48:51], v[68:71]
    v_mfma_f32_16x16x32_bf16 v[76:79], a[68:71], a[52:55], v[76:79]
    buffer_load_dwordx4 v19, s[44:47], s52 offen offset:1024 lds
    s_add_u32 s52, s52, s56
    v_mfma_f32_16x16x32_bf16 v[84:87], a[68:71], a[56:59], v[84:87]
    ds_read_b128 a[4:7], v6 offset:2048
    v_mfma_f32_16x16x32_bf16 v[92:95], a[68:71], a[60:63], v[92:95]
    ds_read_b64_tr_b16 a[68:69], v9 offset:0
    v_mfma_f32_16x16x32_bf16 v[96:99], a[72:75], a[32:35], v[96:99]
    ds_read_b64_tr_b16 a[70:71], v9 offset:2048
    v_mfma_f32_16x16x32_bf16 v[104:107], a[72:75], a[36:39], v[104:107]
    buffer_load_dwordx4 v18, s[44:47], s53 offen offset:2048 lds
    v_mfma_f32_16x16x32_bf16 v[112:115], a[72:75], a[40:43], v[112:115]
    ds_read_b128 a[8:11], v6 offset:4096
    v_mfma_f32_16x16x32_bf16 v[120:123], a[72:75], a[44:47], v[120:123]
    v_mfma_f32_16x16x32_bf16 v[128:131], a[72:75], a[48:51], v[128:131]
    v_mfma_f32_16x16x32_bf16 v[136:139], a[72:75], a[52:55], v[136:139]
    buffer_load_dwordx4 v19, s[44:47], s53 offen offset:3072 lds
    s_add_u32 s53, s53, s56
    v_mfma_f32_16x16x32_bf16 v[144:147], a[72:75], a[56:59], v[144:147]
    ds_read_b128 a[12:15], v6 offset:6144
    v_mfma_f32_16x16x32_bf16 v[152:155], a[72:75], a[60:63], v[152:155]
    ds_read_b64_tr_b16 a[72:73], v10 offset:0
    v_mfma_f32_16x16x32_bf16 v[100:103], a[76:79], a[32:35], v[100:103]
    ds_read_b64_tr_b16 a[74:75], v10 offset:2048
    v_mfma_f32_16x16x32_bf16 v[108:111], a[76:79], a[36:39], v[108:111]
    s_add_u32 m0, s62, 4096
    s_nop 0
    buffer_load_dwordx4 v20, s[44:47], s54 offen offset:0 lds
    v_mfma_f32_16x16x32_bf16 v[116:119], a[76:79], a[40:43], v[116:119]
    ds_read_b128 a[16:19], v6 offset:8192
    v_mfma_f32_16x16x32_bf16 v[124:127], a[76:79], a[44:47], v[124:127]
    v_mfma_f32_16x16x32_bf16 v[132:135], a[76:79], a[48:51], v[132:135]
    v_mfma_f32_16x16x32_bf16 v[140:143], a[76:79], a[52:55], v[140:143]
    buffer_load_dwordx4 v21, s[44:47], s54 offen offset:1024 lds
    s_add_u32 s54, s54, s56
    v_mfma_f32_16x16x32_bf16 v[148:151], a[76:79], a[56:59], v[148:151]
    ds_read_b128 a[20:23], v6 offset:10240
    v_mfma_f32_16x16x32_bf16 v[156:159], a[76:79], a[60:63], v[156:159]
    ds_read_b64_tr_b16 a[76:77], v11 offset:0
    v_mfma_f32_16x16x32_bf16 v[160:163], a[80:83], a[32:35], v[160:163]
    ds_read_b64_tr_b16 a[78:79], v11 offset:2048
    v_mfma_f32_16x16x32_bf16 v[168:171], a[80:83], a[36:39], v[168:171]
    buffer_load_dwordx4 v20, s[44:47], s55 offen offset:2048 lds
    v_mfma_f32_16x16x32_bf16 v[176:179], a[80:83], a[40:43], v[176:179]
    ds_read_b128 a[24:27], v6 offset:12288
    v_mfma_f32_16x16x32_bf16 v[184:187], a[80:83], a[44:47], v[184:187]
    v_mfma_f32_16x16x32_bf16 v[192:195], a[80:83], a[48:51], v[192:195]
    v_mfma_f32_16x16x32_bf16 v[200:203], a[80:83], a[52:55], v[200:203]
    buffer_load_dwordx4 v21, s[44:47], s55 offen offset:3072 lds
    s_add_u32 s55, s55, s56
    v_mfma_f32_16x16x32_bf16 v[208:211], a[80:83], a[56:59], v[208:211]
    ds_read_b128 a[28:31], v6 offset:14336
    v_mfma_f32_16x16x32_bf16 v[216:219], a[80:83], a[60:63], v[216:219]
    ds_read_b64_tr_b16 a[80:81], v12 offset:0
    v_mfma_f32_16x16x32_bf16 v[164:167], a[84:87], a[32:35], v[164:167]
    ds_read_b64_tr_b16 a[82:83], v12 offset:2048
    v_mfma_f32_16x16x32_bf16 v[172:175], a[84:87], a[36:39], v[172:175]
    v_mfma_f32_16x16x32_bf16 v[180:183], a[84:87], a[40:43], v[180:183]
    v_mfma_f32_16x16x32_bf16 v[188:191], a[84:87], a[44:47], v[188:191]
    v_mfma_f32_16x16x32_bf16 v[196:199], a[84:87], a[48:51], v[196:199]
    s_xor_b32 s62, s62, 229376
    v_mfma_f32_16x16x32_bf16 v[204:207], a[84:87], a[52:55], v[204:207]
    v_mfma_f32_16x16x32_bf16 v[212:215], a[84:87], a[56:59], v[212:215]
    v_mfma_f32_16x16x32_bf16 v[220:223], a[84:87], a[60:63], v[220:223]
    ds_read_b64_tr_b16 a[84:85], v13 offset:0
    v_mfma_f32_16x16x32_bf16 v[224:227], a[88:91], a[32:35], v[224:227]
    ds_read_b64_tr_b16 a[86:87], v13 offset:2048
    v_mfma_f32_16x16x32_bf16 v[232:235], a[88:91], a[36:39], v[232:235]
    v_mfma_f32_16x16x32_bf16 v[240:243], a[88:91], a[40:43], v[240:243]
    v_mfma_f32_16x16x32_bf16 v[248:251], a[88:91], a[44:47], v[248:251]
    v_mfma_f32_16x16x32_bf16 a[96:99], a[88:91], a[48:51], a[96:99]
    v_mfma_f32_16x16x32_bf16 a[104:107], a[88:91], a[52:55], a[104:107]
    v_mfma_f32_16x16x32_bf16 a[112:115], a[88:91], a[56:59], a[112:115]
    v_mfma_f32_16x16x32_bf16 a[120:123], a[88:91], a[60:63], a[120:123]
    ds_read_b64_tr_b16 a[88:89], v14 offset:0
    v_mfma_f32_16x16x32_bf16 v[228:231], a[92:95], a[32:35], v[228:231]
    ds_read_b64_tr_b16 a[90:91], v14 offset:2048
    v_mfma_f32_16x16x32_bf16 v[236:239], a[92:95], a[36:39], v[236:239]
    v_mfma_f32_16x16x32_bf16 v[244:247], a[92:95], a[40:43], v[244:247]
    v_mfma_f32_16x16x32_bf16 v[252:255], a[92:95], a[44:47], v[252:255]
    v_mfma_f32_16x16x32_bf16 a[100:103], a[92:95], a[48:51], a[100:103]
    v_mfma_f32_16x16x32_bf16 a[108:111], a[92:95], a[52:55], a[108:111]
    v_mfma_f32_16x16x32_bf16 a[116:119], a[92:95], a[56:59], a[116:119]
    v_mfma_f32_16x16x32_bf16 a[124:127], a[92:95], a[60:63], a[124:127]
    ds_read_b64_tr_b16 a[92:93], v15 offset:0
    ds_read_b64_tr_b16 a[94:95], v15 offset:2048
mega_kernel_loop14:
    s_cmp_le_u32 s65, s67
    s_cbranch_scc1 mega_kernel_dosw16
mega_kernel_nosw15:
    s_waitcnt lgkmcnt(15)
    v_mfma_f32_16x16x32_bf16 v[32:35], a[64:67], a[0:3], v[32:35]
    v_mfma_f32_16x16x32_bf16 v[40:43], a[64:67], a[4:7], v[40:43]
    v_mfma_f32_16x16x32_bf16 v[48:51], a[64:67], a[8:11], v[48:51]
    v_mfma_f32_16x16x32_bf16 v[56:59], a[64:67], a[12:15], v[56:59]
    s_waitcnt lgkmcnt(13)
    v_mfma_f32_16x16x32_bf16 v[64:67], a[64:67], a[16:19], v[64:67]
    s_add_u32 m0, s61, 0
    s_nop 0
    buffer_load_dwordx4 v16, s[40:43], s48 offen offset:0 lds
    s_waitcnt lgkmcnt(12)
    v_mfma_f32_16x16x32_bf16 v[72:75], a[64:67], a[20:23], v[72:75]
    s_waitcnt lgkmcnt(9)
    v_mfma_f32_16x16x32_bf16 v[80:83], a[64:67], a[24:27], v[80:83]
    s_waitcnt lgkmcnt(8)
    v_mfma_f32_16x16x32_bf16 v[88:91], a[64:67], a[28:31], v[88:91]
    ds_read_b64_tr_b16 a[64:65], v8 offset:16384
    v_mfma_f32_16x16x32_bf16 v[36:39], a[68:71], a[0:3], v[36:39]
    ds_read_b64_tr_b16 a[66:67], v8 offset:18432
    v_mfma_f32_16x16x32_bf16 v[44:47], a[68:71], a[4:7], v[44:47]
    v_mfma_f32_16x16x32_bf16 v[52:55], a[68:71], a[8:11], v[52:55]
    ds_read_b128 a[32:35], v7 offset:0
    v_mfma_f32_16x16x32_bf16 v[60:63], a[68:71], a[12:15], v[60:63]
    buffer_load_dwordx4 v17, s[40:43], s48 offen offset:1024 lds
    s_add_u32 s48, s48, 128
    v_mfma_f32_16x16x32_bf16 v[68:71], a[68:71], a[16:19], v[68:71]
    v_mfma_f32_16x16x32_bf16 v[76:79], a[68:71], a[20:23], v[76:79]
    v_mfma_f32_16x16x32_bf16 v[84:87], a[68:71], a[24:27], v[84:87]
    ds_read_b128 a[36:39], v7 offset:2048
    v_mfma_f32_16x16x32_bf16 v[92:95], a[68:71], a[28:31], v[92:95]
    ds_read_b64_tr_b16 a[68:69], v9 offset:16384
    v_mfma_f32_16x16x32_bf16 v[96:99], a[72:75], a[0:3], v[96:99]
    ds_read_b64_tr_b16 a[70:71], v9 offset:18432
    v_mfma_f32_16x16x32_bf16 v[104:107], a[72:75], a[4:7], v[104:107]
    buffer_load_dwordx4 v16, s[40:43], s49 offen offset:2048 lds
    v_mfma_f32_16x16x32_bf16 v[112:115], a[72:75], a[8:11], v[112:115]
    ds_read_b128 a[40:43], v7 offset:4096
    v_mfma_f32_16x16x32_bf16 v[120:123], a[72:75], a[12:15], v[120:123]
    v_mfma_f32_16x16x32_bf16 v[128:131], a[72:75], a[16:19], v[128:131]
    v_mfma_f32_16x16x32_bf16 v[136:139], a[72:75], a[20:23], v[136:139]
    v_mfma_f32_16x16x32_bf16 v[144:147], a[72:75], a[24:27], v[144:147]
    ds_read_b128 a[44:47], v7 offset:6144
    v_mfma_f32_16x16x32_bf16 v[152:155], a[72:75], a[28:31], v[152:155]
    ds_read_b64_tr_b16 a[72:73], v10 offset:16384
    buffer_load_dwordx4 v17, s[40:43], s49 offen offset:3072 lds
    s_add_u32 s49, s49, 128
    v_mfma_f32_16x16x32_bf16 v[100:103], a[76:79], a[0:3], v[100:103]
    ds_read_b64_tr_b16 a[74:75], v10 offset:18432
    v_mfma_f32_16x16x32_bf16 v[108:111], a[76:79], a[4:7], v[108:111]
    v_mfma_f32_16x16x32_bf16 v[116:119], a[76:79], a[8:11], v[116:119]
    ds_read_b128 a[48:51], v7 offset:8192
    v_mfma_f32_16x16x32_bf16 v[124:127], a[76:79], a[12:15], v[124:127]
    v_mfma_f32_16x16x32_bf16 v[132:135], a[76:79], a[16:19], v[132:135]
    s_add_u32 m0, s61, 4096
    s_nop 0
    buffer_load_dwordx4 v16, s[40:43], s50 offen offset:0 lds
    v_mfma_f32_16x16x32_bf16 v[140:143], a[76:79], a[20:23], v[140:143]
    v_mfma_f32_16x16x32_bf16 v[148:151], a[76:79], a[24:27], v[148:151]
    ds_read_b128 a[52:55], v7 offset:10240
    v_mfma_f32_16x16x32_bf16 v[156:159], a[76:79], a[28:31], v[156:159]
    ds_read_b64_tr_b16 a[76:77], v11 offset:16384
    s_waitcnt lgkmcnt(15)
    v_mfma_f32_16x16x32_bf16 v[160:163], a[80:83], a[0:3], v[160:163]
    ds_read_b64_tr_b16 a[78:79], v11 offset:18432
    v_mfma_f32_16x16x32_bf16 v[168:171], a[80:83], a[4:7], v[168:171]
    v_mfma_f32_16x16x32_bf16 v[176:179], a[80:83], a[8:11], v[176:179]
    ds_read_b128 a[56:59], v7 offset:12288
    v_mfma_f32_16x16x32_bf16 v[184:187], a[80:83], a[12:15], v[184:187]
    buffer_load_dwordx4 v17, s[40:43], s50 offen offset:1024 lds
    s_add_u32 s50, s50, 128
    v_mfma_f32_16x16x32_bf16 v[192:195], a[80:83], a[16:19], v[192:195]
    v_mfma_f32_16x16x32_bf16 v[200:203], a[80:83], a[20:23], v[200:203]
    v_mfma_f32_16x16x32_bf16 v[208:211], a[80:83], a[24:27], v[208:211]
    ds_read_b128 a[60:63], v7 offset:14336
    v_mfma_f32_16x16x32_bf16 v[216:219], a[80:83], a[28:31], v[216:219]
    ds_read_b64_tr_b16 a[80:81], v12 offset:16384
    v_mfma_f32_16x16x32_bf16 v[164:167], a[84:87], a[0:3], v[164:167]
    ds_read_b64_tr_b16 a[82:83], v12 offset:18432
    v_mfma_f32_16x16x32_bf16 v[172:175], a[84:87], a[4:7], v[172:175]
    buffer_load_dwordx4 v16, s[40:43], s51 offen offset:2048 lds
    v_mfma_f32_16x16x32_bf16 v[180:183], a[84:87], a[8:11], v[180:183]
    v_mfma_f32_16x16x32_bf16 v[188:191], a[84:87], a[12:15], v[188:191]
    v_mfma_f32_16x16x32_bf16 v[196:199], a[84:87], a[16:19], v[196:199]
    v_mfma_f32_16x16x32_bf16 v[204:207], a[84:87], a[20:23], v[204:207]
    v_mfma_f32_16x16x32_bf16 v[212:215], a[84:87], a[24:27], v[212:215]
    buffer_load_dwordx4 v17, s[40:43], s51 offen offset:3072 lds
    s_add_u32 s51, s51, 128
    v_mfma_f32_16x16x32_bf16 v[220:223], a[84:87], a[28:31], v[220:223]
    ds_read_b64_tr_b16 a[84:85], v13 offset:16384
    v_mfma_f32_16x16x32_bf16 v[224:227], a[88:91], a[0:3], v[224:227]
    ds_read_b64_tr_b16 a[86:87], v13 offset:18432
    v_mfma_f32_16x16x32_bf16 v[232:235], a[88:91], a[4:7], v[232:235]
    v_mfma_f32_16x16x32_bf16 v[240:243], a[88:91], a[8:11], v[240:243]
    v_mfma_f32_16x16x32_bf16 v[248:251], a[88:91], a[12:15], v[248:251]
    v_mfma_f32_16x16x32_bf16 a[96:99], a[88:91], a[16:19], a[96:99]
    v_mfma_f32_16x16x32_bf16 a[104:107], a[88:91], a[20:23], a[104:107]
    s_add_u32 s61, s61, 32768
    s_cmp_ge_u32 s61, 98304
    s_cselect_b32 s90, 98304, 0
    s_sub_u32 s61, s61, s90
    v_mfma_f32_16x16x32_bf16 a[112:115], a[88:91], a[24:27], a[112:115]
    v_mfma_f32_16x16x32_bf16 a[120:123], a[88:91], a[28:31], a[120:123]
    ds_read_b64_tr_b16 a[88:89], v14 offset:16384
    s_waitcnt lgkmcnt(15)
    v_mfma_f32_16x16x32_bf16 v[228:231], a[92:95], a[0:3], v[228:231]
    ds_read_b64_tr_b16 a[90:91], v14 offset:18432
    v_mfma_f32_16x16x32_bf16 v[236:239], a[92:95], a[4:7], v[236:239]
    s_add_u32 s64, s64, 32768
    s_cmp_ge_u32 s64, 98304
    s_cselect_b32 s63, 4294901760, s59
    s_cselect_b32 s64, 0, s64
    v_mfma_f32_16x16x32_bf16 v[244:247], a[92:95], a[8:11], v[244:247]
    v_add_u32 v6, s63, v6
    v_mfma_f32_16x16x32_bf16 v[252:255], a[92:95], a[12:15], v[252:255]
    v_add_u32 v7, s63, v7
    v_mfma_f32_16x16x32_bf16 a[100:103], a[92:95], a[16:19], a[100:103]
    v_mfma_f32_16x16x32_bf16 a[108:111], a[92:95], a[20:23], a[108:111]
    v_mfma_f32_16x16x32_bf16 a[116:119], a[92:95], a[24:27], a[116:119]
    v_mfma_f32_16x16x32_bf16 a[124:127], a[92:95], a[28:31], a[124:127]
    ds_read_b64_tr_b16 a[92:93], v15 offset:16384
    ds_read_b64_tr_b16 a[94:95], v15 offset:18432
    v_mfma_f32_16x16x32_bf16 v[32:35], a[64:67], a[32:35], v[32:35]
    v_xor_b32 v8, s60, v8
    v_mfma_f32_16x16x32_bf16 v[40:43], a[64:67], a[36:39], v[40:43]
    v_xor_b32 v9, s60, v9
    s_waitcnt lgkmcnt(15)
    v_mfma_f32_16x16x32_bf16 v[48:51], a[64:67], a[40:43], v[48:51]
    v_xor_b32 v10, s60, v10
    v_mfma_f32_16x16x32_bf16 v[56:59], a[64:67], a[44:47], v[56:59]
    v_xor_b32 v11, s60, v11
    s_waitcnt lgkmcnt(13)
    v_mfma_f32_16x16x32_bf16 v[64:67], a[64:67], a[48:51], v[64:67]
    v_xor_b32 v12, s60, v12
    s_waitcnt lgkmcnt(12)
    v_mfma_f32_16x16x32_bf16 v[72:75], a[64:67], a[52:55], v[72:75]
    v_xor_b32 v13, s60, v13
    s_waitcnt lgkmcnt(9)
    v_mfma_f32_16x16x32_bf16 v[80:83], a[64:67], a[56:59], v[80:83]
    v_xor_b32 v14, s60, v14
    v_xor_b32 v15, s60, v15
    s_waitcnt lgkmcnt(8)
    s_waitcnt lgkmcnt(0)
    s_waitcnt vmcnt(8)
    v_mfma_f32_16x16x32_bf16 v[88:91], a[64:67], a[60:63], v[88:91]
    s_barrier
    ds_read_b64_tr_b16 a[64:65], v8 offset:0
    v_mfma_f32_16x16x32_bf16 v[36:39], a[68:71], a[32:35], v[36:39]
    ds_read_b64_tr_b16 a[66:67], v8 offset:2048
    v_mfma_f32_16x16x32_bf16 v[44:47], a[68:71], a[36:39], v[44:47]
    s_add_u32 m0, s62, 0
    s_nop 0
    buffer_load_dwordx4 v18, s[44:47], s52 offen offset:0 lds
    v_mfma_f32_16x16x32_bf16 v[52:55], a[68:71], a[40:43], v[52:55]
    ds_read_b128 a[0:3], v6 offset:0
    v_mfma_f32_16x16x32_bf16 v[60:63], a[68:71], a[44:47], v[60:63]
    v_mfma_f32_16x16x32_bf16 v[68:71], a[68:71], a[48:51], v[68:71]
    v_mfma_f32_16x16x32_bf16 v[76:79], a[68:71], a[52:55], v[76:79]
    buffer_load_dwordx4 v19, s[44:47], s52 offen offset:1024 lds
    s_add_u32 s52, s52, s56
    v_mfma_f32_16x16x32_bf16 v[84:87], a[68:71], a[56:59], v[84:87]
    ds_read_b128 a[4:7], v6 offset:2048
    v_mfma_f32_16x16x32_bf16 v[92:95], a[68:71], a[60:63], v[92:95]
    ds_read_b64_tr_b16 a[68:69], v9 offset:0
    v_mfma_f32_16x16x32_bf16 v[96:99], a[72:75], a[32:35], v[96:99]
    ds_read_b64_tr_b16 a[70:71], v9 offset:2048
    v_mfma_f32_16x16x32_bf16 v[104:107], a[72:75], a[36:39], v[104:107]
    buffer_load_dwordx4 v18, s[44:47], s53 offen offset:2048 lds
    v_mfma_f32_16x16x32_bf16 v[112:115], a[72:75], a[40:43], v[112:115]
    ds_read_b128 a[8:11], v6 offset:4096
    v_mfma_f32_16x16x32_bf16 v[120:123], a[72:75], a[44:47], v[120:123]
    v_mfma_f32_16x16x32_bf16 v[128:131], a[72:75], a[48:51], v[128:131]
    v_mfma_f32_16x16x32_bf16 v[136:139], a[72:75], a[52:55], v[136:139]
    buffer_load_dwordx4 v19, s[44:47], s53 offen offset:3072 lds
    s_add_u32 s53, s53, s56
    v_mfma_f32_16x16x32_bf16 v[144:147], a[72:75], a[56:59], v[144:147]
    ds_read_b128 a[12:15], v6 offset:6144
    v_mfma_f32_16x16x32_bf16 v[152:155], a[72:75], a[60:63], v[152:155]
    ds_read_b64_tr_b16 a[72:73], v10 offset:0
    v_mfma_f32_16x16x32_bf16 v[100:103], a[76:79], a[32:35], v[100:103]
    ds_read_b64_tr_b16 a[74:75], v10 offset:2048
    v_mfma_f32_16x16x32_bf16 v[108:111], a[76:79], a[36:39], v[108:111]
    s_add_u32 m0, s62, 4096
    s_nop 0
    buffer_load_dwordx4 v20, s[44:47], s54 offen offset:0 lds
    v_mfma_f32_16x16x32_bf16 v[116:119], a[76:79], a[40:43], v[116:119]
    ds_read_b128 a[16:19], v6 offset:8192
    v_mfma_f32_16x16x32_bf16 v[124:127], a[76:79], a[44:47], v[124:127]
    v_mfma_f32_16x16x32_bf16 v[132:135], a[76:79], a[48:51], v[132:135]
    v_mfma_f32_16x16x32_bf16 v[140:143], a[76:79], a[52:55], v[140:143]
    buffer_load_dwordx4 v21, s[44:47], s54 offen offset:1024 lds
    s_add_u32 s54, s54, s56
    v_mfma_f32_16x16x32_bf16 v[148:151], a[76:79], a[56:59], v[148:151]
    ds_read_b128 a[20:23], v6 offset:10240
    v_mfma_f32_16x16x32_bf16 v[156:159], a[76:79], a[60:63], v[156:159]
    ds_read_b64_tr_b16 a[76:77], v11 offset:0
    v_mfma_f32_16x16x32_bf16 v[160:163], a[80:83], a[32:35], v[160:163]
    ds_read_b64_tr_b16 a[78:79], v11 offset:2048
    v_mfma_f32_16x16x32_bf16 v[168:171], a[80:83], a[36:39], v[168:171]
    buffer_load_dwordx4 v20, s[44:47], s55 offen offset:2048 lds
    v_mfma_f32_16x16x32_bf16 v[176:179], a[80:83], a[40:43], v[176:179]
    ds_read_b128 a[24:27], v6 offset:12288
    v_mfma_f32_16x16x32_bf16 v[184:187], a[80:83], a[44:47], v[184:187]
    v_mfma_f32_16x16x32_bf16 v[192:195], a[80:83], a[48:51], v[192:195]
    v_mfma_f32_16x16x32_bf16 v[200:203], a[80:83], a[52:55], v[200:203]
    buffer_load_dwordx4 v21, s[44:47], s55 offen offset:3072 lds
    s_add_u32 s55, s55, s56
    v_mfma_f32_16x16x32_bf16 v[208:211], a[80:83], a[56:59], v[208:211]
    ds_read_b128 a[28:31], v6 offset:14336
    v_mfma_f32_16x16x32_bf16 v[216:219], a[80:83], a[60:63], v[216:219]
    ds_read_b64_tr_b16 a[80:81], v12 offset:0
    v_mfma_f32_16x16x32_bf16 v[164:167], a[84:87], a[32:35], v[164:167]
    ds_read_b64_tr_b16 a[82:83], v12 offset:2048
    v_mfma_f32_16x16x32_bf16 v[172:175], a[84:87], a[36:39], v[172:175]
    v_mfma_f32_16x16x32_bf16 v[180:183], a[84:87], a[40:43], v[180:183]
    v_mfma_f32_16x16x32_bf16 v[188:191], a[84:87], a[44:47], v[188:191]
    v_mfma_f32_16x16x32_bf16 v[196:199], a[84:87], a[48:51], v[196:199]
    s_xor_b32 s62, s62, 229376
    v_mfma_f32_16x16x32_bf16 v[204:207], a[84:87], a[52:55], v[204:207]
    v_mfma_f32_16x16x32_bf16 v[212:215], a[84:87], a[56:59], v[212:215]
    v_mfma_f32_16x16x32_bf16 v[220:223], a[84:87], a[60:63], v[220:223]
    ds_read_b64_tr_b16 a[84:85], v13 offset:0
    v_mfma_f32_16x16x32_bf16 v[224:227], a[88:91], a[32:35], v[224:227]
    ds_read_b64_tr_b16 a[86:87], v13 offset:2048
    v_mfma_f32_16x16x32_bf16 v[232:235], a[88:91], a[36:39], v[232:235]
    v_mfma_f32_16x16x32_bf16 v[240:243], a[88:91], a[40:43], v[240:243]
    v_mfma_f32_16x16x32_bf16 v[248:251], a[88:91], a[44:47], v[248:251]
    v_mfma_f32_16x16x32_bf16 a[96:99], a[88:91], a[48:51], a[96:99]
    v_mfma_f32_16x16x32_bf16 a[104:107], a[88:91], a[52:55], a[104:107]
    v_mfma_f32_16x16x32_bf16 a[112:115], a[88:91], a[56:59], a[112:115]
    v_mfma_f32_16x16x32_bf16 a[120:123], a[88:91], a[60:63], a[120:123]
    ds_read_b64_tr_b16 a[88:89], v14 offset:0
    v_mfma_f32_16x16x32_bf16 v[228:231], a[92:95], a[32:35], v[228:231]
    ds_read_b64_tr_b16 a[90:91], v14 offset:2048
    v_mfma_f32_16x16x32_bf16 v[236:239], a[92:95], a[36:39], v[236:239]
    v_mfma_f32_16x16x32_bf16 v[244:247], a[92:95], a[40:43], v[244:247]
    v_mfma_f32_16x16x32_bf16 v[252:255], a[92:95], a[44:47], v[252:255]
    v_mfma_f32_16x16x32_bf16 a[100:103], a[92:95], a[48:51], a[100:103]
    v_mfma_f32_16x16x32_bf16 a[108:111], a[92:95], a[52:55], a[108:111]
    v_mfma_f32_16x16x32_bf16 a[116:119], a[92:95], a[56:59], a[116:119]
    v_mfma_f32_16x16x32_bf16 a[124:127], a[92:95], a[60:63], a[124:127]
    ds_read_b64_tr_b16 a[92:93], v15 offset:0
    ds_read_b64_tr_b16 a[94:95], v15 offset:2048
    s_sub_u32 s65, s65, 1
    s_cmp_lg_u32 s65, 0
    s_cbranch_scc1 mega_kernel_loop14
    s_branch mega_kernel_epi11
mega_kernel_swp12:
    s_waitcnt lgkmcnt(15)
    v_mfma_f32_16x16x32_bf16 v[32:35], a[0:3], a[64:67], 0
    v_mfma_f32_16x16x32_bf16 v[36:39], a[4:7], a[64:67], 0
    v_mfma_f32_16x16x32_bf16 v[96:99], a[8:11], a[64:67], 0
    v_mfma_f32_16x16x32_bf16 v[100:103], a[12:15], a[64:67], 0
    s_waitcnt lgkmcnt(13)
    v_mfma_f32_16x16x32_bf16 v[160:163], a[16:19], a[64:67], 0
    s_add_u32 m0, s61, 0
    s_nop 0
    buffer_load_dwordx4 v16, s[40:43], s48 offen offset:0 lds
    s_waitcnt lgkmcnt(12)
    v_mfma_f32_16x16x32_bf16 v[164:167], a[20:23], a[64:67], 0
    s_waitcnt lgkmcnt(9)
    v_mfma_f32_16x16x32_bf16 v[224:227], a[24:27], a[64:67], 0
    s_waitcnt lgkmcnt(8)
    v_mfma_f32_16x16x32_bf16 v[228:231], a[28:31], a[64:67], 0
    ds_read_b64_tr_b16 a[64:65], v8 offset:16384
    v_mfma_f32_16x16x32_bf16 v[40:43], a[0:3], a[68:71], 0
    ds_read_b64_tr_b16 a[66:67], v8 offset:18432
    v_mfma_f32_16x16x32_bf16 v[44:47], a[4:7], a[68:71], 0
    v_mfma_f32_16x16x32_bf16 v[104:107], a[8:11], a[68:71], 0
    ds_read_b128 a[32:35], v7 offset:0
    v_mfma_f32_16x16x32_bf16 v[108:111], a[12:15], a[68:71], 0
    buffer_load_dwordx4 v17, s[40:43], s48 offen offset:1024 lds
    s_add_u32 s48, s48, 128
    v_mfma_f32_16x16x32_bf16 v[168:171], a[16:19], a[68:71], 0
    v_mfma_f32_16x16x32_bf16 v[172:175], a[20:23], a[68:71], 0
    v_mfma_f32_16x16x32_bf16 v[232:235], a[24:27], a[68:71], 0
    ds_read_b128 a[36:39], v7 offset:2048
    v_mfma_f32_16x16x32_bf16 v[236:239], a[28:31], a[68:71], 0
    ds_read_b64_tr_b16 a[68:69], v9 offset:16384
    v_mfma_f32_16x16x32_bf16 v[48:51], a[0:3], a[72:75], 0
    ds_read_b64_tr_b16 a[70:71], v9 offset:18432
    v_mfma_f32_16x16x32_bf16 v[52:55], a[4:7], a[72:75], 0
    buffer_load_dwordx4 v16, s[40:43], s49 offen offset:2048 lds
    v_mfma_f32_16x16x32_bf16 v[112:115], a[8:11], a[72:75], 0
    ds_read_b128 a[40:43], v7 offset:4096
    v_mfma_f32_16x16x32_bf16 v[116:119], a[12:15], a[72:75], 0
    v_mfma_f32_16x16x32_bf16 v[176:179], a[16:19], a[72:75], 0
    v_mfma_f32_16x16x32_bf16 v[180:183], a[20:23], a[72:75], 0
    v_mfma_f32_16x16x32_bf16 v[240:243], a[24:27], a[72:75], 0
    ds_read_b128 a[44:47], v7 offset:6144
    v_mfma_f32_16x16x32_bf16 v[244:247], a[28:31], a[72:75], 0
    ds_read_b64_tr_b16 a[72:73], v10 offset:16384
    buffer_load_dwordx4 v17, s[40:43], s49 offen offset:3072 lds
    s_add_u32 s49, s49, 128
    v_mfma_f32_16x16x32_bf16 v[56:59], a[0:3], a[76:79], 0
    ds_read_b64_tr_b16 a[74:75], v10 offset:18432
    v_mfma_f32_16x16x32_bf16 v[60:63], a[4:7], a[76:79], 0
    v_mfma_f32_16x16x32_bf16 v[120:123], a[8:11], a[76:79], 0
    ds_read_b128 a[48:51], v7 offset:8192
    v_mfma_f32_16x16x32_bf16 v[124:127], a[12:15], a[76:79], 0
    v_mfma_f32_16x16x32_bf16 v[184:187], a[16:19], a[76:79], 0
    s_add_u32 m0, s61, 4096
    s_nop 0
    buffer_load_dwordx4 v16, s[40:43], s50 offen offset:0 lds
    v_mfma_f32_16x16x32_bf16 v[188:191], a[20:23], a[76:79], 0
    v_mfma_f32_16x16x32_bf16 v[248:251], a[24:27], a[76:79], 0
    ds_read_b128 a[52:55], v7 offset:10240
    v_mfma_f32_16x16x32_bf16 v[252:255], a[28:31], a[76:79], 0
    ds_read_b64_tr_b16 a[76:77], v11 offset:16384
    s_waitcnt lgkmcnt(15)
    v_mfma_f32_16x16x32_bf16 v[64:67], a[0:3], a[80:83], 0
    ds_read_b64_tr_b16 a[78:79], v11 offset:18432
    v_mfma_f32_16x16x32_bf16 v[68:71], a[4:7], a[80:83], 0
    v_mfma_f32_16x16x32_bf16 v[128:131], a[8:11], a[80:83], 0
    ds_read_b128 a[56:59], v7 offset:12288
    v_mfma_f32_16x16x32_bf16 v[132:135], a[12:15], a[80:83], 0
    buffer_load_dwordx4 v17, s[40:43], s50 offen offset:1024 lds
    s_add_u32 s50, s50, 128
    v_mfma_f32_16x16x32_bf16 v[192:195], a[16:19], a[80:83], 0
    v_mfma_f32_16x16x32_bf16 v[196:199], a[20:23], a[80:83], 0
    v_mfma_f32_16x16x32_bf16 a[96:99], a[24:27], a[80:83], 0
    ds_read_b128 a[60:63], v7 offset:14336
    v_mfma_f32_16x16x32_bf16 a[100:103], a[28:31], a[80:83], 0
    ds_read_b64_tr_b16 a[80:81], v12 offset:16384
    v_mfma_f32_16x16x32_bf16 v[72:75], a[0:3], a[84:87], 0
    ds_read_b64_tr_b16 a[82:83], v12 offset:18432
    v_mfma_f32_16x16x32_bf16 v[76:79], a[4:7], a[84:87], 0
    buffer_load_dwordx4 v16, s[40:43], s51 offen offset:2048 lds
    v_mfma_f32_16x16x32_bf16 v[136:139], a[8:11], a[84:87], 0
    v_mfma_f32_16x16x32_bf16 v[140:143], a[12:15], a[84:87], 0
    v_mfma_f32_16x16x32_bf16 v[200:203], a[16:19], a[84:87], 0
    v_mfma_f32_16x16x32_bf16 v[204:207], a[20:23], a[84:87], 0
    v_mfma_f32_16x16x32_bf16 a[104:107], a[24:27], a[84:87], 0
    buffer_load_dwordx4 v17, s[40:43], s51 offen offset:3072 lds
    s_add_u32 s51, s51, 128
    v_mfma_f32_16x16x32_bf16 a[108:111], a[28:31], a[84:87], 0
    ds_read_b64_tr_b16 a[84:85], v13 offset:16384
    v_mfma_f32_16x16x32_bf16 v[80:83], a[0:3], a[88:91], 0
    ds_read_b64_tr_b16 a[86:87], v13 offset:18432
    v_mfma_f32_16x16x32_bf16 v[84:87], a[4:7], a[88:91], 0
    v_mfma_f32_16x16x32_bf16 v[144:147], a[8:11], a[88:91], 0
    v_mfma_f32_16x16x32_bf16 v[148:151], a[12:15], a[88:91], 0
    v_mfma_f32_16x16x32_bf16 v[208:211], a[16:19], a[88:91], 0
    v_mfma_f32_16x16x32_bf16 v[212:215], a[20:23], a[88:91], 0
    s_add_u32 s61, s61, 32768
    s_cmp_ge_u32 s61, 98304
    s_cselect_b32 s90, 98304, 0
    s_sub_u32 s61, s61, s90
    v_mfma_f32_16x16x32_bf16 a[112:115], a[24:27], a[88:91], 0
    v_mfma_f32_16x16x32_bf16 a[116:119], a[28:31], a[88:91], 0
    ds_read_b64_tr_b16 a[88:89], v14 offset:16384
    s_waitcnt lgkmcnt(15)
    v_mfma_f32_16x16x32_bf16 v[88:91], a[0:3], a[92:95], 0
    ds_read_b64_tr_b16 a[90:91], v14 offset:18432
    v_mfma_f32_16x16x32_bf16 v[92:95], a[4:7], a[92:95], 0
    s_add_u32 s64, s64, 32768
    s_cmp_ge_u32 s64, 98304
    s_cselect_b32 s63, 4294901760, s59
    s_cselect_b32 s64, 0, s64
    v_mfma_f32_16x16x32_bf16 v[152:155], a[8:11], a[92:95], 0
    v_add_u32 v6, s63, v6
    v_mfma_f32_16x16x32_bf16 v[156:159], a[12:15], a[92:95], 0
    v_add_u32 v7, s63, v7
    v_mfma_f32_16x16x32_bf16 v[216:219], a[16:19], a[92:95], 0
    v_mfma_f32_16x16x32_bf16 v[220:223], a[20:23], a[92:95], 0
    v_mfma_f32_16x16x32_bf16 a[120:123], a[24:27], a[92:95], 0
    v_mfma_f32_16x16x32_bf16 a[124:127], a[28:31], a[92:95], 0
    ds_read_b64_tr_b16 a[92:93], v15 offset:16384
    ds_read_b64_tr_b16 a[94:95], v15 offset:18432
    v_mfma_f32_16x16x32_bf16 v[32:35], a[32:35], a[64:67], v[32:35]
    v_xor_b32 v8, s60, v8
    v_mfma_f32_16x16x32_bf16 v[36:39], a[36:39], a[64:67], v[36:39]
    v_xor_b32 v9, s60, v9
    s_waitcnt lgkmcnt(15)
    v_mfma_f32_16x16x32_bf16 v[96:99], a[40:43], a[64:67], v[96:99]
    v_xor_b32 v10, s60, v10
    v_mfma_f32_16x16x32_bf16 v[100:103], a[44:47], a[64:67], v[100:103]
    v_xor_b32 v11, s60, v11
    s_waitcnt lgkmcnt(13)
    v_mfma_f32_16x16x32_bf16 v[160:163], a[48:51], a[64:67], v[160:163]
    v_xor_b32 v12, s60, v12
    s_waitcnt lgkmcnt(12)
    v_mfma_f32_16x16x32_bf16 v[164:167], a[52:55], a[64:67], v[164:167]
    v_xor_b32 v13, s60, v13
    s_waitcnt lgkmcnt(9)
    v_mfma_f32_16x16x32_bf16 v[224:227], a[56:59], a[64:67], v[224:227]
    v_xor_b32 v14, s60, v14
    v_xor_b32 v15, s60, v15
    s_waitcnt lgkmcnt(8)
    s_waitcnt lgkmcnt(0)
    s_waitcnt vmcnt(40)
    s_cmp_eq_u32 s66, 0
    s_cbranch_scc1 mega_kernel_w17
    s_waitcnt vmcnt(8)
mega_kernel_w17:
    v_mfma_f32_16x16x32_bf16 v[228:231], a[60:63], a[64:67], v[228:231]
    s_barrier
    ds_read_b64_tr_b16 a[64:65], v8 offset:0
    v_mfma_f32_16x16x32_bf16 v[40:43], a[32:35], a[68:71], v[40:43]
    ds_read_b64_tr_b16 a[66:67], v8 offset:2048
    v_mfma_f32_16x16x32_bf16 v[44:47], a[36:39], a[68:71], v[44:47]
    s_add_u32 m0, s62, 0
    s_nop 0
    buffer_load_dwordx4 v18, s[44:47], s52 offen offset:0 lds
    v_mfma_f32_16x16x32_bf16 v[104:107], a[40:43], a[68:71], v[104:107]
    ds_read_b128 a[0:3], v6 offset:0
    v_mfma_f32_16x16x32_bf16 v[108:111], a[44:47], a[68:71], v[108:111]
    v_mfma_f32_16x16x32_bf16 v[168:171], a[48:51], a[68:71], v[168:171]
    v_mfma_f32_16x16x32_bf16 v[172:175], a[52:55], a[68:71], v[172:175]
    buffer_load_dwordx4 v19, s[44:47], s52 offen offset:1024 lds
    s_add_u32 s52, s52, s56
    v_mfma_f32_16x16x32_bf16 v[232:235], a[56:59], a[68:71], v[232:235]
    ds_read_b128 a[4:7], v6 offset:2048
    v_mfma_f32_16x16x32_bf16 v[236:239], a[60:63], a[68:71], v[236:239]
    ds_read_b64_tr_b16 a[68:69], v9 offset:0
    v_mfma_f32_16x16x32_bf16 v[48:51], a[32:35], a[72:75], v[48:51]
    ds_read_b64_tr_b16 a[70:71], v9 offset:2048
    v_mfma_f32_16x16x32_bf16 v[52:55], a[36:39], a[72:75], v[52:55]
    buffer_load_dwordx4 v18, s[44:47], s53 offen offset:2048 lds
    v_mfma_f32_16x16x32_bf16 v[112:115], a[40:43], a[72:75], v[112:115]
    ds_read_b128 a[8:11], v6 offset:4096
    v_mfma_f32_16x16x32_bf16 v[116:119], a[44:47], a[72:75], v[116:119]
    v_mfma_f32_16x16x32_bf16 v[176:179], a[48:51], a[72:75], v[176:179]
    v_mfma_f32_16x16x32_bf16 v[180:183], a[52:55], a[72:75], v[180:183]
    buffer_load_dwordx4 v19, s[44:47], s53 offen offset:3072 lds
    s_add_u32 s53, s53, s56
    v_mfma_f32_16x16x32_bf16 v[240:243], a[56:59], a[72:75], v[240:243]
    ds_read_b128 a[12:15], v6 offset:6144
    v_mfma_f32_16x16x32_bf16 v[244:247], a[60:63], a[72:75], v[244:247]
    ds_read_b64_tr_b16 a[72:73], v10 offset:0
    v_mfma_f32_16x16x32_bf16 v[56:59], a[32:35], a[76:79], v[56:59]
    ds_read_b64_tr_b16 a[74:75], v10 offset:2048
    v_mfma_f32_16x16x32_bf16 v[60:63], a[36:39], a[76:79], v[60:63]
    s_add_u32 m0, s62, 4096
    s_nop 0
    buffer_load_dwordx4 v20, s[44:47], s54 offen offset:0 lds
    v_mfma_f32_16x16x32_bf16 v[120:123], a[40:43], a[76:79], v[120:123]
    ds_read_b128 a[16:19], v6 offset:8192
    v_mfma_f32_16x16x32_bf16 v[124:127], a[44:47], a[76:79], v[124:127]
    v_mfma_f32_16x16x32_bf16 v[184:187], a[48:51], a[76:79], v[184:187]
    v_mfma_f32_16x16x32_bf16 v[188:191], a[52:55], a[76:79], v[188:191]
    buffer_load_dwordx4 v21, s[44:47], s54 offen offset:1024 lds
    s_add_u32 s54, s54, s56
    v_mfma_f32_16x16x32_bf16 v[248:251], a[56:59], a[76:79], v[248:251]
    ds_read_b128 a[20:23], v6 offset:10240
    v_mfma_f32_16x16x32_bf16 v[252:255], a[60:63], a[76:79], v[252:255]
    ds_read_b64_tr_b16 a[76:77], v11 offset:0
    v_mfma_f32_16x16x32_bf16 v[64:67], a[32:35], a[80:83], v[64:67]
    ds_read_b64_tr_b16 a[78:79], v11 offset:2048
    v_mfma_f32_16x16x32_bf16 v[68:71], a[36:39], a[80:83], v[68:71]
    buffer_load_dwordx4 v20, s[44:47], s55 offen offset:2048 lds
    v_mfma_f32_16x16x32_bf16 v[128:131], a[40:43], a[80:83], v[128:131]
    ds_read_b128 a[24:27], v6 offset:12288
    v_mfma_f32_16x16x32_bf16 v[132:135], a[44:47], a[80:83], v[132:135]
    v_mfma_f32_16x16x32_bf16 v[192:195], a[48:51], a[80:83], v[192:195]
    v_mfma_f32_16x16x32_bf16 v[196:199], a[52:55], a[80:83], v[196:199]
    buffer_load_dwordx4 v21, s[44:47], s55 offen offset:3072 lds
    s_add_u32 s55, s55, s56
    v_mfma_f32_16x16x32_bf16 a[96:99], a[56:59], a[80:83], a[96:99]
    ds_read_b128 a[28:31], v6 offset:14336
    v_mfma_f32_16x16x32_bf16 a[100:103], a[60:63], a[80:83], a[100:103]
    ds_read_b64_tr_b16 a[80:81], v12 offset:0
    v_mfma_f32_16x16x32_bf16 v[72:75], a[32:35], a[84:87], v[72:75]
    ds_read_b64_tr_b16 a[82:83], v12 offset:2048
    v_mfma_f32_16x16x32_bf16 v[76:79], a[36:39], a[84:87], v[76:79]
    v_mfma_f32_16x16x32_bf16 v[136:139], a[40:43], a[84:87], v[136:139]
    v_mfma_f32_16x16x32_bf16 v[140:143], a[44:47], a[84:87], v[140:143]
    v_mfma_f32_16x16x32_bf16 v[200:203], a[48:51], a[84:87], v[200:203]
    s_xor_b32 s62, s62, 229376
    v_mfma_f32_16x16x32_bf16 v[204:207], a[52:55], a[84:87], v[204:207]
    v_mfma_f32_16x16x32_bf16 a[104:107], a[56:59], a[84:87], a[104:107]
    v_mfma_f32_16x16x32_bf16 a[108:111], a[60:63], a[84:87], a[108:111]
    ds_read_b64_tr_b16 a[84:85], v13 offset:0
    v_mfma_f32_16x16x32_bf16 v[80:83], a[32:35], a[88:91], v[80:83]
    ds_read_b64_tr_b16 a[86:87], v13 offset:2048
    v_mfma_f32_16x16x32_bf16 v[84:87], a[36:39], a[88:91], v[84:87]
    v_mfma_f32_16x16x32_bf16 v[144:147], a[40:43], a[88:91], v[144:147]
    v_mfma_f32_16x16x32_bf16 v[148:151], a[44:47], a[88:91], v[148:151]
    v_mfma_f32_16x16x32_bf16 v[208:211], a[48:51], a[88:91], v[208:211]
    v_mfma_f32_16x16x32_bf16 v[212:215], a[52:55], a[88:91], v[212:215]
    v_mfma_f32_16x16x32_bf16 a[112:115], a[56:59], a[88:91], a[112:115]
    v_mfma_f32_16x16x32_bf16 a[116:119], a[60:63], a[88:91], a[116:119]
    ds_read_b64_tr_b16 a[88:89], v14 offset:0
    v_mfma_f32_16x16x32_bf16 v[88:91], a[32:35], a[92:95], v[88:91]
    ds_read_b64_tr_b16 a[90:91], v14 offset:2048
    v_mfma_f32_16x16x32_bf16 v[92:95], a[36:39], a[92:95], v[92:95]
    v_mfma_f32_16x16x32_bf16 v[152:155], a[40:43], a[92:95], v[152:155]
    v_mfma_f32_16x16x32_bf16 v[156:159], a[44:47], a[92:95], v[156:159]
    v_mfma_f32_16x16x32_bf16 v[216:219], a[48:51], a[92:95], v[216:219]
    v_mfma_f32_16x16x32_bf16 v[220:223], a[52:55], a[92:95], v[220:223]
    v_mfma_f32_16x16x32_bf16 a[120:123], a[56:59], a[92:95], a[120:123]
    v_mfma_f32_16x16x32_bf16 a[124:127], a[60:63], a[92:95], a[124:127]
    ds_read_b64_tr_b16 a[92:93], v15 offset:0
    ds_read_b64_tr_b16 a[94:95], v15 offset:2048
mega_kernel_loop18:
    s_cmp_le_u32 s65, s67
    s_cbranch_scc1 mega_kernel_dosw20
mega_kernel_nosw19:
    s_waitcnt lgkmcnt(15)
    v_mfma_f32_16x16x32_bf16 v[32:35], a[0:3], a[64:67], v[32:35]
    v_mfma_f32_16x16x32_bf16 v[36:39], a[4:7], a[64:67], v[36:39]
    v_mfma_f32_16x16x32_bf16 v[96:99], a[8:11], a[64:67], v[96:99]
    v_mfma_f32_16x16x32_bf16 v[100:103], a[12:15], a[64:67], v[100:103]
    s_waitcnt lgkmcnt(13)
    v_mfma_f32_16x16x32_bf16 v[160:163], a[16:19], a[64:67], v[160:163]
    s_add_u32 m0, s61, 0
    s_nop 0
    buffer_load_dwordx4 v16, s[40:43], s48 offen offset:0 lds
    s_waitcnt lgkmcnt(12)
    v_mfma_f32_16x16x32_bf16 v[164:167], a[20:23], a[64:67], v[164:167]
    s_waitcnt lgkmcnt(9)
    v_mfma_f32_16x16x32_bf16 v[224:227], a[24:27], a[64:67], v[224:227]
    s_waitcnt lgkmcnt(8)
    v_mfma_f32_16x16x32_bf16 v[228:231], a[28:31], a[64:67], v[228:231]
    ds_read_b64_tr_b16 a[64:65], v8 offset:16384
    v_mfma_f32_16x16x32_bf16 v[40:43], a[0:3], a[68:71], v[40:43]
    ds_read_b64_tr_b16 a[66:67], v8 offset:18432
    v_mfma_f32_16x16x32_bf16 v[44:47], a[4:7], a[68:71], v[44:47]
    v_mfma_f32_16x16x32_bf16 v[104:107], a[8:11], a[68:71], v[104:107]
    ds_read_b128 a[32:35], v7 offset:0
    v_mfma_f32_16x16x32_bf16 v[108:111], a[12:15], a[68:71], v[108:111]
    buffer_load_dwordx4 v17, s[40:43], s48 offen offset:1024 lds
    s_add_u32 s48, s48, 128
    v_mfma_f32_16x16x32_bf16 v[168:171], a[16:19], a[68:71], v[168:171]
    v_mfma_f32_16x16x32_bf16 v[172:175], a[20:23], a[68:71], v[172:175]
    v_mfma_f32_16x16x32_bf16 v[232:235], a[24:27], a[68:71], v[232:235]
    ds_read_b128 a[36:39], v7 offset:2048
    v_mfma_f32_16x16x32_bf16 v[236:239], a[28:31], a[68:71], v[236:239]
    ds_read_b64_tr_b16 a[68:69], v9 offset:16384
    v_mfma_f32_16x16x32_bf16 v[48:51], a[0:3], a[72:75], v[48:51]
    ds_read_b64_tr_b16 a[70:71], v9 offset:18432
    v_mfma_f32_16x16x32_bf16 v[52:55], a[4:7], a[72:75], v[52:55]
    buffer_load_dwordx4 v16, s[40:43], s49 offen offset:2048 lds
    v_mfma_f32_16x16x32_bf16 v[112:115], a[8:11], a[72:75], v[112:115]
    ds_read_b128 a[40:43], v7 offset:4096
    v_mfma_f32_16x16x32_bf16 v[116:119], a[12:15], a[72:75], v[116:119]
    v_mfma_f32_16x16x32_bf16 v[176:179], a[16:19], a[72:75], v[176:179]
    v_mfma_f32_16x16x32_bf16 v[180:183], a[20:23], a[72:75], v[180:183]
    v_mfma_f32_16x16x32_bf16 v[240:243], a[24:27], a[72:75], v[240:243]
    ds_read_b128 a[44:47], v7 offset:6144
    v_mfma_f32_16x16x32_bf16 v[244:247], a[28:31], a[72:75], v[244:247]
    ds_read_b64_tr_b16 a[72:73], v10 offset:16384
    buffer_load_dwordx4 v17, s[40:43], s49 offen offset:3072 lds
    s_add_u32 s49, s49, 128
    v_mfma_f32_16x16x32_bf16 v[56:59], a[0:3], a[76:79], v[56:59]
    ds_read_b64_tr_b16 a[74:75], v10 offset:18432
    v_mfma_f32_16x16x32_bf16 v[60:63], a[4:7], a[76:79], v[60:63]
    v_mfma_f32_16x16x32_bf16 v[120:123], a[8:11], a[76:79], v[120:123]
    ds_read_b128 a[48:51], v7 offset:8192
    v_mfma_f32_16x16x32_bf16 v[124:127], a[12:15], a[76:79], v[124:127]
    v_mfma_f32_16x16x32_bf16 v[184:187], a[16:19], a[76:79], v[184:187]
    s_add_u32 m0, s61, 4096
    s_nop 0
    buffer_load_dwordx4 v16, s[40:43], s50 offen offset:0 lds
    v_mfma_f32_16x16x32_bf16 v[188:191], a[20:23], a[76:79], v[188:191]
    v_mfma_f32_16x16x32_bf16 v[248:251], a[24:27], a[76:79], v[248:251]
    ds_read_b128 a[52:55], v7 offset:10240
    v_mfma_f32_16x16x32_bf16 v[252:255], a[28:31], a[76:79], v[252:255]
    ds_read_b64_tr_b16 a[76:77], v11 offset:16384
    s_waitcnt lgkmcnt(15)
    v_mfma_f32_16x16x32_bf16 v[64:67], a[0:3], a[80:83], v[64:67]
    ds_read_b64_tr_b16 a[78:79], v11 offset:18432
    v_mfma_f32_16x16x32_bf16 v[68:71], a[4:7], a[80:83], v[68:71]
    v_mfma_f32_16x16x32_bf16 v[128:131], a[8:11], a[80:83], v[128:131]
    ds_read_b128 a[56:59], v7 offset:12288
    v_mfma_f32_16x16x32_bf16 v[132:135], a[12:15], a[80:83], v[132:135]
    buffer_load_dwordx4 v17, s[40:43], s50 offen offset:1024 lds
    s_add_u32 s50, s50, 128
    v_mfma_f32_16x16x32_bf16 v[192:195], a[16:19], a[80:83], v[192:195]
    v_mfma_f32_16x16x32_bf16 v[196:199], a[20:23], a[80:83], v[196:199]
    v_mfma_f32_16x16x32_bf16 a[96:99], a[24:27], a[80:83], a[96:99]
    ds_read_b128 a[60:63], v7 offset:14336
    v_mfma_f32_16x16x32_bf16 a[100:103], a[28:31], a[80:83], a[100:103]
    ds_read_b64_tr_b16 a[80:81], v12 offset:16384
    v_mfma_f32_16x16x32_bf16 v[72:75], a[0:3], a[84:87], v[72:75]
    ds_read_b64_tr_b16 a[82:83], v12 offset:18432
    v_mfma_f32_16x16x32_bf16 v[76:79], a[4:7], a[84:87], v[76:79]
    buffer_load_dwordx4 v16, s[40:43], s51 offen offset:2048 lds
    v_mfma_f32_16x16x32_bf16 v[136:139], a[8:11], a[84:87], v[136:139]
    v_mfma_f32_16x16x32_bf16 v[140:143], a[12:15], a[84:87], v[140:143]
    v_mfma_f32_16x16x32_bf16 v[200:203], a[16:19], a[84:87], v[200:203]
    v_mfma_f32_16x16x32_bf16 v[204:207], a[20:23], a[84:87], v[204:207]
    v_mfma_f32_16x16x32_bf16 a[104:107], a[24:27], a[84:87], a[104:107]
    buffer_load_dwordx4 v17, s[40:43], s51 offen offset:3072 lds
    s_add_u32 s51, s51, 128
    v_mfma_f32_16x16x32_bf16 a[108:111], a[28:31], a[84:87], a[108:111]
    ds_read_b64_tr_b16 a[84:85], v13 offset:16384
    v_mfma_f32_16x16x32_bf16 v[80:83], a[0:3], a[88:91], v[80:83]
    ds_read_b64_tr_b16 a[86:87], v13 offset:18432
    v_mfma_f32_16x16x32_bf16 v[84:87], a[4:7], a[88:91], v[84:87]
    v_mfma_f32_16x16x32_bf16 v[144:147], a[8:11], a[88:91], v[144:147]
    v_mfma_f32_16x16x32_bf16 v[148:151], a[12:15], a[88:91], v[148:151]
    v_mfma_f32_16x16x32_bf16 v[208:211], a[16:19], a[88:91], v[208:211]
    v_mfma_f32_16x16x32_bf16 v[212:215], a[20:23], a[88:91], v[212:215]
    s_add_u32 s61, s61, 32768
    s_cmp_ge_u32 s61, 98304
    s_cselect_b32 s90, 98304, 0
    s_sub_u32 s61, s61, s90
    v_mfma_f32_16x16x32_bf16 a[112:115], a[24:27], a[88:91], a[112:115]
    v_mfma_f32_16x16x32_bf16 a[116:119], a[28:31], a[88:91], a[116:119]
    ds_read_b64_tr_b16 a[88:89], v14 offset:16384
    s_waitcnt lgkmcnt(15)
    v_mfma_f32_16x16x32_bf16 v[88:91], a[0:3], a[92:95], v[88:91]
    ds_read_b64_tr_b16 a[90:91], v14 offset:18432
    v_mfma_f32_16x16x32_bf16 v[92:95], a[4:7], a[92:95], v[92:95]
    s_add_u32 s64, s64, 32768
    s_cmp_ge_u32 s64, 98304
    s_cselect_b32 s63, 4294901760, s59
    s_cselect_b32 s64, 0, s64
    v_mfma_f32_16x16x32_bf16 v[152:155], a[8:11], a[92:95], v[152:155]
    v_add_u32 v6, s63, v6
    v_mfma_f32_16x16x32_bf16 v[156:159], a[12:15], a[92:95], v[156:159]
    v_add_u32 v7, s63, v7
    v_mfma_f32_16x16x32_bf16 v[216:219], a[16:19], a[92:95], v[216:219]
    v_mfma_f32_16x16x32_bf16 v[220:223], a[20:23], a[92:95], v[220:223]
    v_mfma_f32_16x16x32_bf16 a[120:123], a[24:27], a[92:95], a[120:123]
    v_mfma_f32_16x16x32_bf16 a[124:127], a[28:31], a[92:95], a[124:127]
    ds_read_b64_tr_b16 a[92:93], v15 offset:16384
    ds_read_b64_tr_b16 a[94:95], v15 offset:18432
    v_mfma_f32_16x16x32_bf16 v[32:35], a[32:35], a[64:67], v[32:35]
    v_xor_b32 v8, s60, v8
    v_mfma_f32_16x16x32_bf16 v[36:39], a[36:39], a[64:67], v[36:39]
    v_xor_b32 v9, s60, v9
    s_waitcnt lgkmcnt(15)
    v_mfma_f32_16x16x32_bf16 v[96:99], a[40:43], a[64:67], v[96:99]
    v_xor_b32 v10, s60, v10
    v_mfma_f32_16x16x32_bf16 v[100:103], a[44:47], a[64:67], v[100:103]
    v_xor_b32 v11, s60, v11
    s_waitcnt lgkmcnt(13)
    v_mfma_f32_16x16x32_bf16 v[160:163], a[48:51], a[64:67], v[160:163]
    v_xor_b32 v12, s60, v12
    s_waitcnt lgkmcnt(12)
    v_mfma_f32_16x16x32_bf16 v[164:167], a[52:55], a[64:67], v[164:167]
    v_xor_b32 v13, s60, v13
    s_waitcnt lgkmcnt(9)
    v_mfma_f32_16x16x32_bf16 v[224:227], a[56:59], a[64:67], v[224:227]
    v_xor_b32 v14, s60, v14
    v_xor_b32 v15, s60, v15
    s_waitcnt lgkmcnt(8)
    s_waitcnt lgkmcnt(0)
    s_waitcnt vmcnt(8)
    v_mfma_f32_16x16x32_bf16 v[228:231], a[60:63], a[64:67], v[228:231]
    s_barrier
    ds_read_b64_tr_b16 a[64:65], v8 offset:0
    v_mfma_f32_16x16x32_bf16 v[40:43], a[32:35], a[68:71], v[40:43]
    ds_read_b64_tr_b16 a[66:67], v8 offset:2048
    v_mfma_f32_16x16x32_bf16 v[44:47], a[36:39], a[68:71], v[44:47]
    s_add_u32 m0, s62, 0
    s_nop 0
    buffer_load_dwordx4 v18, s[44:47], s52 offen offset:0 lds
    v_mfma_f32_16x16x32_bf16 v[104:107], a[40:43], a[68:71], v[104:107]
    ds_read_b128 a[0:3], v6 offset:0
    v_mfma_f32_16x16x32_bf16 v[108:111], a[44:47], a[68:71], v[108:111]
    v_mfma_f32_16x16x32_bf16 v[168:171], a[48:51], a[68:71], v[168:171]
    v_mfma_f32_16x16x32_bf16 v[172:175], a[52:55], a[68:71], v[172:175]
    buffer_load_dwordx4 v19, s[44:47], s52 offen offset:1024 lds
    s_add_u32 s52, s52, s56
    v_mfma_f32_16x16x32_bf16 v[232:235], a[56:59], a[68:71], v[232:235]
    ds_read_b128 a[4:7], v6 offset:2048
    v_mfma_f32_16x16x32_bf16 v[236:239], a[60:63], a[68:71], v[236:239]
    ds_read_b64_tr_b16 a[68:69], v9 offset:0
    v_mfma_f32_16x16x32_bf16 v[48:51], a[32:35], a[72:75], v[48:51]
    ds_read_b64_tr_b16 a[70:71], v9 offset:2048
    v_mfma_f32_16x16x32_bf16 v[52:55], a[36:39], a[72:75], v[52:55]
    buffer_load_dwordx4 v18, s[44:47], s53 offen offset:2048 lds
    v_mfma_f32_16x16x32_bf16 v[112:115], a[40:43], a[72:75], v[112:115]
    ds_read_b128 a[8:11], v6 offset:4096
    v_mfma_f32_16x16x32_bf16 v[116:119], a[44:47], a[72:75], v[116:119]
    v_mfma_f32_16x16x32_bf16 v[176:179], a[48:51], a[72:75], v[176:179]
    v_mfma_f32_16x16x32_bf16 v[180:183], a[52:55], a[72:75], v[180:183]
    buffer_load_dwordx4 v19, s[44:47], s53 offen offset:3072 lds
    s_add_u32 s53, s53, s56
    v_mfma_f32_16x16x32_bf16 v[240:243], a[56:59], a[72:75], v[240:243]
    ds_read_b128 a[12:15], v6 offset:6144
    v_mfma_f32_16x16x32_bf16 v[244:247], a[60:63], a[72:75], v[244:247]
    ds_read_b64_tr_b16 a[72:73], v10 offset:0
    v_mfma_f32_16x16x32_bf16 v[56:59], a[32:35], a[76:79], v[56:59]
    ds_read_b64_tr_b16 a[74:75], v10 offset:2048
    v_mfma_f32_16x16x32_bf16 v[60:63], a[36:39], a[76:79], v[60:63]
    s_add_u32 m0, s62, 4096
    s_nop 0
    buffer_load_dwordx4 v20, s[44:47], s54 offen offset:0 lds
    v_mfma_f32_16x16x32_bf16 v[120:123], a[40:43], a[76:79], v[120:123]
    ds_read_b128 a[16:19], v6 offset:8192
    v_mfma_f32_16x16x32_bf16 v[124:127], a[44:47], a[76:79], v[124:127]
    v_mfma_f32_16x16x32_bf16 v[184:187], a[48:51], a[76:79], v[184:187]
    v_mfma_f32_16x16x32_bf16 v[188:191], a[52:55], a[76:79], v[188:191]
    buffer_load_dwordx4 v21, s[44:47], s54 offen offset:1024 lds
    s_add_u32 s54, s54, s56
    v_mfma_f32_16x16x32_bf16 v[248:251], a[56:59], a[76:79], v[248:251]
    ds_read_b128 a[20:23], v6 offset:10240
    v_mfma_f32_16x16x32_bf16 v[252:255], a[60:63], a[76:79], v[252:255]
    ds_read_b64_tr_b16 a[76:77], v11 offset:0
    v_mfma_f32_16x16x32_bf16 v[64:67], a[32:35], a[80:83], v[64:67]
    ds_read_b64_tr_b16 a[78:79], v11 offset:2048
    v_mfma_f32_16x16x32_bf16 v[68:71], a[36:39], a[80:83], v[68:71]
    buffer_load_dwordx4 v20, s[44:47], s55 offen offset:2048 lds
    v_mfma_f32_16x16x32_bf16 v[128:131], a[40:43], a[80:83], v[128:131]
    ds_read_b128 a[24:27], v6 offset:12288
    v_mfma_f32_16x16x32_bf16 v[132:135], a[44:47], a[80:83], v[132:135]
    v_mfma_f32_16x16x32_bf16 v[192:195], a[48:51], a[80:83], v[192:195]
    v_mfma_f32_16x16x32_bf16 v[196:199], a[52:55], a[80:83], v[196:199]
    buffer_load_dwordx4 v21, s[44:47], s55 offen offset:3072 lds
    s_add_u32 s55, s55, s56
    v_mfma_f32_16x16x32_bf16 a[96:99], a[56:59], a[80:83], a[96:99]
    ds_read_b128 a[28:31], v6 offset:14336
    v_mfma_f32_16x16x32_bf16 a[100:103], a[60:63], a[80:83], a[100:103]
    ds_read_b64_tr_b16 a[80:81], v12 offset:0
    v_mfma_f32_16x16x32_bf16 v[72:75], a[32:35], a[84:87], v[72:75]
    ds_read_b64_tr_b16 a[82:83], v12 offset:2048
    v_mfma_f32_16x16x32_bf16 v[76:79], a[36:39], a[84:87], v[76:79]
    v_mfma_f32_16x16x32_bf16 v[136:139], a[40:43], a[84:87], v[136:139]
    v_mfma_f32_16x16x32_bf16 v[140:143], a[44:47], a[84:87], v[140:143]
    v_mfma_f32_16x16x32_bf16 v[200:203], a[48:51], a[84:87], v[200:203]
    s_xor_b32 s62, s62, 229376
    v_mfma_f32_16x16x32_bf16 v[204:207], a[52:55], a[84:87], v[204:207]
    v_mfma_f32_16x16x32_bf16 a[104:107], a[56:59], a[84:87], a[104:107]
    v_mfma_f32_16x16x32_bf16 a[108:111], a[60:63], a[84:87], a[108:111]
    ds_read_b64_tr_b16 a[84:85], v13 offset:0
    v_mfma_f32_16x16x32_bf16 v[80:83], a[32:35], a[88:91], v[80:83]
    ds_read_b64_tr_b16 a[86:87], v13 offset:2048
    v_mfma_f32_16x16x32_bf16 v[84:87], a[36:39], a[88:91], v[84:87]
    v_mfma_f32_16x16x32_bf16 v[144:147], a[40:43], a[88:91], v[144:147]
    v_mfma_f32_16x16x32_bf16 v[148:151], a[44:47], a[88:91], v[148:151]
    v_mfma_f32_16x16x32_bf16 v[208:211], a[48:51], a[88:91], v[208:211]
    v_mfma_f32_16x16x32_bf16 v[212:215], a[52:55], a[88:91], v[212:215]
    v_mfma_f32_16x16x32_bf16 a[112:115], a[56:59], a[88:91], a[112:115]
    v_mfma_f32_16x16x32_bf16 a[116:119], a[60:63], a[88:91], a[116:119]
    ds_read_b64_tr_b16 a[88:89], v14 offset:0
    v_mfma_f32_16x16x32_bf16 v[88:91], a[32:35], a[92:95], v[88:91]
    ds_read_b64_tr_b16 a[90:91], v14 offset:2048
    v_mfma_f32_16x16x32_bf16 v[92:95], a[36:39], a[92:95], v[92:95]
    v_mfma_f32_16x16x32_bf16 v[152:155], a[40:43], a[92:95], v[152:155]
    v_mfma_f32_16x16x32_bf16 v[156:159], a[44:47], a[92:95], v[156:159]
    v_mfma_f32_16x16x32_bf16 v[216:219], a[48:51], a[92:95], v[216:219]
    v_mfma_f32_16x16x32_bf16 v[220:223], a[52:55], a[92:95], v[220:223]
    v_mfma_f32_16x16x32_bf16 a[120:123], a[56:59], a[92:95], a[120:123]
    v_mfma_f32_16x16x32_bf16 a[124:127], a[60:63], a[92:95], a[124:127]
    ds_read_b64_tr_b16 a[92:93], v15 offset:0
    ds_read_b64_tr_b16 a[94:95], v15 offset:2048
    s_sub_u32 s65, s65, 1
    s_cmp_lg_u32 s65, 0
    s_cbranch_scc1 mega_kernel_loop18
mega_kernel_epi11:
    s_cmp_eq_u32 s94, 0
    s_cbranch_scc1 mega_kernel_last22
    s_mov_b32 s3, 1048576
mega_kernel_spin26:
    v_readfirstlane_b32 s4, v4
    v_readfirstlane_b32 s5, v5
    s_nop 3
    s_cmp_lg_u32 s4, 0
    s_cbranch_scc1 mega_kernel_ok27
    s_sub_u32 s3, s3, 1
    s_cbranch_scc1 mega_kernel_ok27
    s_sleep 32
    buffer_load_dwordx2 v[4:5], off, s[12:15], 0 sc1
    s_waitcnt vmcnt(0)
    s_branch mega_kernel_spin26
mega_kernel_ok27:
    s_call_b64 s[20:21], mega_kernel_epf21
    s_mov_b32 s17, s101
    s_mov_b32 s95, s82
    s_mov_b32 s96, s83
    s_mov_b32 s97, s84
    s_mov_b32 s98, s85
    s_mov_b32 s99, s86
    s_mov_b32 s100, s87
    s_mov_b32 s101, s88
    s_sub_u32 s67, s95, 2
    s_mov_b32 s94, 0
    s_mov_b32 s66, 0
    s_branch mega_kernel_tile10
mega_kernel_last22:
    s_cmp_eq_u32 s70, 0
    s_cbranch_scc1 mega_kernel_kvl25
    buffer_load_dwordx2 v[4:5], off, s[12:15], 0 sc1
    s_call_b64 s[20:21], mega_kernel_epf21
    s_waitcnt vmcnt(0)
    s_barrier
    s_mov_b32 s3, 1048576
mega_kernel_spin28:
    v_readfirstlane_b32 s4, v4
    v_readfirstlane_b32 s5, v5
    s_nop 3
    s_cmp_lg_u32 s4, 0
    s_cbranch_scc1 mega_kernel_ok29
    s_sub_u32 s3, s3, 1
    s_cbranch_scc1 mega_kernel_ok29
    s_sleep 32
    buffer_load_dwordx2 v[4:5], off, s[12:15], 0 sc1
    s_waitcnt vmcnt(0)
    s_branch mega_kernel_spin28
mega_kernel_ok29:
    s_cmp_lg_u32 s16, 0
    s_cbranch_scc1 mega_kernel_np30
    v_mov_b32 v4, s4
    v_mov_b32 v5, s5
    s_add_u32 s90, s101, 117440512
    s_mov_b64 exec, 1
    buffer_store_dwordx2 v[4:5], off, s[8:11], s90 sc1
    s_mov_b64 exec, -1
mega_kernel_np30:
    s_cmp_lg_u32 s16, 0
    s_cbranch_scc1 mega_kernel_pw31
    s_and_b32 s92, s2, 7
    s_lshl_b32 s92, s92, 2
    s_bfe_u32 s93, s2, 0x20003
    s_add_u32 s92, s92, s93
    s_lshr_b32 s93, s2, 5
    s_lshl_b32 s93, s93, 2
    s_or_b32 s93, s93, 0x40000
    s_lshr_b32 s90, s92, 1
    s_lshl_b32 s90, s90, 7
    s_add_u32 s90, s90, 117440512
    s_bfe_u32 s91, 1645237363, s93
    s_lshr_b32 s91, s91, 1
    v_add_u32 v0, 8, v1
    v_mov_b32 v4, s91
    v_cmp_gt_u32 vcc, 6, v1
    s_bfe_u32 s91, 4242446987, s93
    s_lshr_b32 s91, s91, 1
    v_cndmask_b32 v0, v4, v0, vcc
    v_writelane_b32 v0, s91, 6
    v_lshlrev_b32 v0, 3, v0
    buffer_load_dwordx2 v[4:5], v0, s[8:11], s90 offen sc1
    s_waitcnt vmcnt(0)
    s_mov_b32 s3, 1048576
mega_kernel_spin32:
    v_cmp_ne_u64 s[22:23], s[4:5], v[4:5]
    s_nop 3
    s_cmp_eq_u64 s[22:23], 0
    s_cbranch_scc1 mega_kernel_ok33
    s_sub_u32 s3, s3, 1
    s_cbranch_scc1 mega_kernel_ok33
    s_sleep 32
    s_and_b32 s92, s2, 7
    s_lshl_b32 s92, s92, 2
    s_bfe_u32 s93, s2, 0x20003
    s_add_u32 s92, s92, s93
    s_lshr_b32 s93, s2, 5
    s_lshl_b32 s93, s93, 2
    s_or_b32 s93, s93, 0x40000
    s_lshr_b32 s90, s92, 1
    s_lshl_b32 s90, s90, 7
    s_add_u32 s90, s90, 117440512
    s_bfe_u32 s91, 1645237363, s93
    s_lshr_b32 s91, s91, 1
    v_add_u32 v0, 8, v1
    v_mov_b32 v4, s91
    v_cmp_gt_u32 vcc, 6, v1
    s_bfe_u32 s91, 4242446987, s93
    s_lshr_b32 s91, s91, 1
    v_cndmask_b32 v0, v4, v0, vcc
    v_writelane_b32 v0, s91, 6
    v_lshlrev_b32 v0, 3, v0
    buffer_load_dwordx2 v[4:5], v0, s[8:11], s90 offen sc1
    s_waitcnt vmcnt(0)
    s_branch mega_kernel_spin32
mega_kernel_ok33:
mega_kernel_pw31:
    s_barrier
    s_and_b32 s92, s2, 7
    s_lshl_b32 s92, s92, 2
    s_bfe_u32 s93, s2, 0x20003
    s_add_u32 s92, s92, s93
    s_lshr_b32 s93, s2, 5
    s_lshl_b32 s93, s93, 2
    s_or_b32 s93, s93, 0x40000
    s_bfe_u32 s90, 4242446987, s93
    s_lshl_b32 s90, s90, 3
    s_lshl_b32 s91, s16, 1
    s_add_u32 s90, s90, s91
    s_lshl_b32 s90, s90, 12
    s_lshl_b32 s91, s92, 19
    s_add_u32 s90, s90, s91
    s_add_u32 s90, s90, 0
    buffer_load_dwordx4 a[128:131], v2, s[8:11], s90 offen offset:0 sc1
    buffer_load_dwordx4 a[132:135], v2, s[8:11], s90 offen offset:1024 sc1
    buffer_load_dwordx4 a[136:139], v2, s[8:11], s90 offen offset:2048 sc1
    buffer_load_dwordx4 a[140:143], v2, s[8:11], s90 offen offset:3072 sc1
    s_bfe_u32 s90, 4242446987, s93
    s_lshl_b32 s90, s90, 3
    s_lshl_b32 s91, s16, 1
    s_add_u32 s90, s90, s91
    s_lshl_b32 s90, s90, 12
    s_lshl_b32 s91, s92, 19
    s_add_u32 s90, s90, s91
    s_add_u32 s90, s90, 4096
    buffer_load_dwordx4 a[144:147], v2, s[8:11], s90 offen offset:0 sc1
    buffer_load_dwordx4 a[148:151], v2, s[8:11], s90 offen offset:1024 sc1
    buffer_load_dwordx4 a[152:155], v2, s[8:11], s90 offen offset:2048 sc1
    buffer_load_dwordx4 a[156:159], v2, s[8:11], s90 offen offset:3072 sc1
    s_bfe_u32 s90, 1645237363, s93
    s_lshl_b32 s90, s90, 3
    s_lshl_b32 s91, s16, 1
    s_add_u32 s90, s90, s91
    s_lshl_b32 s90, s90, 12
    s_lshl_b32 s91, s92, 19
    s_add_u32 s90, s90, s91
    s_add_u32 s90, s90, 0
    buffer_load_dwordx4 a[160:163], v2, s[8:11], s90 offen offset:0 sc1
    buffer_load_dwordx4 a[164:167], v2, s[8:11], s90 offen offset:1024 sc1
    buffer_load_dwordx4 a[168:171], v2, s[8:11], s90 offen offset:2048 sc1
    buffer_load_dwordx4 a[172:175], v2, s[8:11], s90 offen offset:3072 sc1
    s_bfe_u32 s90, 1645237363, s93
    s_lshl_b32 s90, s90, 3
    s_lshl_b32 s91, s16, 1
    s_add_u32 s90, s90, s91
    s_lshl_b32 s90, s90, 12
    s_lshl_b32 s91, s92, 19
    s_add_u32 s90, s90, s91
    s_add_u32 s90, s90, 4096
    buffer_load_dwordx4 a[176:179], v2, s[8:11], s90 offen offset:0 sc1
    buffer_load_dwordx4 a[180:183], v2, s[8:11], s90 offen offset:1024 sc1
    buffer_load_dwordx4 a[184:187], v2, s[8:11], s90 offen offset:2048 sc1
    buffer_load_dwordx4 a[188:191], v2, s[8:11], s90 offen offset:3072 sc1
    s_mov_b32 s94, 1
mega_kernel_kvl25:
    s_waitcnt vmcnt(0) lgkmcnt(0)
    s_barrier
    s_and_b32 s92, s2, 7
    s_lshl_b32 s92, s92, 2
    s_bfe_u32 s93, s2, 0x20003
    s_add_u32 s92, s92, s93
    s_lshr_b32 s93, s2, 5
    s_lshl_b32 s93, s93, 2
    s_or_b32 s93, s93, 0x40000
    s_mov_b32 s32, s92
    s_bfe_u32 s33, 4242446987, s93
    s_add_u32 s33, s33, 1
    s_bfe_u32 s34, 1645237363, s93
    s_add_u32 s34, s34, 1
    s_lshl_b32 s56, s16, 12
    v_add_u32 v7, s56, v2
    s_lshl_b32 s90, s34, 2
    s_lshl_b32 s91, s33, 2
    s_lshl_b32 s26, s91, 13
    s_mov_b32 s30, s26
    s_sub_u32 s63, s90, 4
    s_add_u32 s63, s63, s16
    s_add_u32 s64, s63, 1
    s_mov_b32 s65, s90
    s_sub_u32 s66, s91, 4
    s_add_u32 s66, s66, s16
    s_add_u32 s67, s66, 1
    s_mov_b32 s68, s91
    s_mov_b32 s27, 0x20000
    s_mov_b32 s31, 0x20000
    s_lshl_b32 s78, s32, 19
    s_add_u32 s90, s78, 16777216
    s_add_u32 s24, s6, s90
    s_addc_u32 s25, s7, 0
    s_add_u32 s90, s78, 33554432
    s_add_u32 s28, s6, s90
    s_addc_u32 s29, s7, 0
    s_mov_b32 s52, 0
    s_mov_b32 s53, 0
    s_mov_b32 m0, s56
    s_nop 0
    buffer_load_dwordx4 v7, s[24:27], s52 offen offset:0 sc1 lds
    buffer_load_dwordx4 v7, s[24:27], s52 offen offset:1024 sc1 lds
    buffer_load_dwordx4 v7, s[24:27], s52 offen offset:2048 sc1 lds
    buffer_load_dwordx4 v7, s[24:27], s52 offen offset:3072 sc1 lds
    s_mov_b32 s52, 16384
    s_add_u32 s55, s56, 32768
    s_mov_b32 m0, s55
    s_nop 0
    buffer_load_dwordx4 v7, s[24:27], s52 offen offset:0 sc1 lds
    buffer_load_dwordx4 v7, s[24:27], s52 offen offset:1024 sc1 lds
    buffer_load_dwordx4 v7, s[24:27], s52 offen offset:2048 sc1 lds
    buffer_load_dwordx4 v7, s[24:27], s52 offen offset:3072 sc1 lds
    s_add_u32 s52, s52, 16384
    s_add_u32 m0, s55, 16384
    s_nop 0
    buffer_load_dwordx4 v7, s[28:31], s53 offen offset:0 sc1 lds
    buffer_load_dwordx4 v7, s[28:31], s53 offen offset:1024 sc1 lds
    buffer_load_dwordx4 v7, s[28:31], s53 offen offset:2048 sc1 lds
    buffer_load_dwordx4 v7, s[28:31], s53 offen offset:3072 sc1 lds
    s_add_u32 s53, s53, 16384
    s_add_u32 s55, s55, 32768
    s_mov_b32 m0, s55
    s_nop 0
    buffer_load_dwordx4 v7, s[24:27], s52 offen offset:0 sc1 lds
    buffer_load_dwordx4 v7, s[24:27], s52 offen offset:1024 sc1 lds
    buffer_load_dwordx4 v7, s[24:27], s52 offen offset:2048 sc1 lds
    buffer_load_dwordx4 v7, s[24:27], s52 offen offset:3072 sc1 lds
    s_add_u32 s52, s52, 16384
    s_add_u32 m0, s55, 16384
    s_nop 0
    buffer_load_dwordx4 v7, s[28:31], s53 offen offset:0 sc1 lds
    buffer_load_dwordx4 v7, s[28:31], s53 offen offset:1024 sc1 lds
    buffer_load_dwordx4 v7, s[28:31], s53 offen offset:2048 sc1 lds
    buffer_load_dwordx4 v7, s[28:31], s53 offen offset:3072 sc1 lds
    s_add_u32 s53, s53, 16384
    s_add_u32 s55, s55, 32768
    s_mov_b32 m0, s55
    s_nop 0
    buffer_load_dwordx4 v7, s[24:27], s52 offen offset:0 sc1 lds
    buffer_load_dwordx4 v7, s[24:27], s52 offen offset:1024 sc1 lds
    buffer_load_dwordx4 v7, s[24:27], s52 offen offset:2048 sc1 lds
    buffer_load_dwordx4 v7, s[24:27], s52 offen offset:3072 sc1 lds
    s_add_u32 s52, s52, 16384
    s_add_u32 m0, s55, 16384
    s_nop 0
    buffer_load_dwordx4 v7, s[28:31], s53 offen offset:0 sc1 lds
    buffer_load_dwordx4 v7, s[28:31], s53 offen offset:1024 sc1 lds
    buffer_load_dwordx4 v7, s[28:31], s53 offen offset:2048 sc1 lds
    buffer_load_dwordx4 v7, s[28:31], s53 offen offset:3072 sc1 lds
    s_add_u32 s53, s53, 16384
    s_add_u32 s55, s55, 32768
    s_cmp_eq_u32 s94, 1
    s_cbranch_scc1 mega_kernel_w055
    s_call_b64 s[20:21], mega_kernel_epl53
    s_mov_b32 s17, s101
    s_mov_b32 s38, 268435456
    s_branch mega_kernel_init24
mega_kernel_w055:
    s_waitcnt vmcnt(0)
    s_mov_b32 s38, 0
mega_kernel_init24:
    s_nop 1
    v_mov_b32 v9, 0xff800000
    s_mov_b32 s61, 1233125376
    s_lshl_b32 s91, s16, 1
    s_sub_u32 s91, s91, 8
    s_lshl_b32 s74, s33, 3
    s_add_u32 s74, s74, s91
    s_lshl_b32 s75, s34, 3
    s_add_u32 s75, s75, s91
    s_mov_b32 s36, s6
    s_mov_b32 s37, s7
    s_mov_b32 s39, 0x20000
    s_load_dwordx2 s[48:49], s[0:1], 64
    s_load_dwordx2 s[50:51], s[0:1], 16
    s_mov_b32 s47, 0x20000
    s_lshl_b32 s90, s99, 1
    s_add_u32 s98, s98, s90
    s_lshl_b32 s90, s100, 2
    s_add_u32 s40, s98, s90
    s_lshr_b32 s90, s32, 1
    s_lshl_b32 s90, s90, 7
    s_add_u32 s90, s90, 117444608
    s_lshr_b32 s91, s2, 6
    s_lshl_b32 s91, s91, 8
    s_add_u32 s91, s91, 117446592
    v_min_u32 v10, 31, v1
    v_lshlrev_b32 v10, 3, v10
    v_mov_b32 v11, s90
    v_mov_b32 v8, s91
    v_cmp_gt_u32 vcc, 8, v1
    s_nop 1
    v_cndmask_b32 v11, v8, v11, vcc
    v_add_u32 v10, v10, v11
    s_lshl_b32 s90, s16, 8
    s_add_u32 s90, s90, s2
    s_cmp_ge_u32 s90, 128
    s_cbranch_scc1 mega_kernel_c356
    s_lshl_b32 s90, s90, 7
    s_add_u32 s90, s90, 117506048
    v_mov_b32 v8, 0
    s_mov_b64 exec, 1
    buffer_store_dword v8, off, s[8:11], s90 sc1
    s_mov_b64 exec, -1
mega_kernel_c356:
    s_mov_b32 s54, 0
    v_mov_b32 v6, v2
    v_accvgpr_write_b32 a0, 0
    v_accvgpr_write_b32 a1, 0
    v_accvgpr_write_b32 a2, 0
    v_accvgpr_write_b32 a3, 0
    v_accvgpr_write_b32 a4, 0
    v_accvgpr_write_b32 a5, 0
    v_accvgpr_write_b32 a6, 0
    v_accvgpr_write_b32 a7, 0
    v_accvgpr_write_b32 a8, 0
    v_accvgpr_write_b32 a9, 0
    v_accvgpr_write_b32 a10, 0
    v_accvgpr_write_b32 a11, 0
    v_accvgpr_write_b32 a12, 0
    v_accvgpr_write_b32 a13, 0
    v_accvgpr_write_b32 a14, 0
    v_accvgpr_write_b32 a15, 0
    v_accvgpr_write_b32 a16, 0
    v_accvgpr_write_b32 a17, 0
    v_accvgpr_write_b32 a18, 0
    v_accvgpr_write_b32 a19, 0
    v_accvgpr_write_b32 a20, 0
    v_accvgpr_write_b32 a21, 0
    v_accvgpr_write_b32 a22, 0
    v_accvgpr_write_b32 a23, 0
    v_accvgpr_write_b32 a24, 0
    v_accvgpr_write_b32 a25, 0
    v_accvgpr_write_b32 a26, 0
    v_accvgpr_write_b32 a27, 0
    v_accvgpr_write_b32 a28, 0
    v_accvgpr_write_b32 a29, 0
    v_accvgpr_write_b32 a30, 0
    v_accvgpr_write_b32 a31, 0
    v_accvgpr_write_b32 a32, 0
    v_accvgpr_write_b32 a33, 0
    v_accvgpr_write_b32 a34, 0
    v_accvgpr_write_b32 a35, 0
    v_accvgpr_write_b32 a36, 0
    v_accvgpr_write_b32 a37, 0
    v_accvgpr_write_b32 a38, 0
    v_accvgpr_write_b32 a39, 0
    v_accvgpr_write_b32 a40, 0
    v_accvgpr_write_b32 a41, 0
    v_accvgpr_write_b32 a42, 0
    v_accvgpr_write_b32 a43, 0
    v_accvgpr_write_b32 a44, 0
    v_accvgpr_write_b32 a45, 0
    v_accvgpr_write_b32 a46, 0
    v_accvgpr_write_b32 a47, 0
    v_accvgpr_write_b32 a48, 0
    v_accvgpr_write_b32 a49, 0
    v_accvgpr_write_b32 a50, 0
    v_accvgpr_write_b32 a51, 0
    v_accvgpr_write_b32 a52, 0
    v_accvgpr_write_b32 a53, 0
    v_accvgpr_write_b32 a54, 0
    v_accvgpr_write_b32 a55, 0
    v_accvgpr_write_b32 a56, 0
    v_accvgpr_write_b32 a57, 0
    v_accvgpr_write_b32 a58, 0
    v_accvgpr_write_b32 a59, 0
    v_accvgpr_write_b32 a60, 0
    v_accvgpr_write_b32 a61, 0
    v_accvgpr_write_b32 a62, 0
    v_accvgpr_write_b32 a63, 0
    v_accvgpr_write_b32 a64, 0
    v_accvgpr_write_b32 a65, 0
    v_accvgpr_write_b32 a66, 0
    v_accvgpr_write_b32 a67, 0
    v_accvgpr_write_b32 a68, 0
    v_accvgpr_write_b32 a69, 0
    v_accvgpr_write_b32 a70, 0
    v_accvgpr_write_b32 a71, 0
    v_accvgpr_write_b32 a72, 0
    v_accvgpr_write_b32 a73, 0
    v_accvgpr_write_b32 a74, 0
    v_accvgpr_write_b32 a75, 0
    v_accvgpr_write_b32 a76, 0
    v_accvgpr_write_b32 a77, 0
    v_accvgpr_write_b32 a78, 0
    v_accvgpr_write_b32 a79, 0
    v_accvgpr_write_b32 a80, 0
    v_accvgpr_write_b32 a81, 0
    v_accvgpr_write_b32 a82, 0
    v_accvgpr_write_b32 a83, 0
    v_accvgpr_write_b32 a84, 0
    v_accvgpr_write_b32 a85, 0
    v_accvgpr_write_b32 a86, 0
    v_accvgpr_write_b32 a87, 0
    v_accvgpr_write_b32 a88, 0
    v_accvgpr_write_b32 a89, 0
    v_accvgpr_write_b32 a90, 0
    v_accvgpr_write_b32 a91, 0
    v_accvgpr_write_b32 a92, 0
    v_accvgpr_write_b32 a93, 0
    v_accvgpr_write_b32 a94, 0
    v_accvgpr_write_b32 a95, 0
    v_accvgpr_write_b32 a96, 0
    v_accvgpr_write_b32 a97, 0
    v_accvgpr_write_b32 a98, 0
    v_accvgpr_write_b32 a99, 0
    v_accvgpr_write_b32 a100, 0
    v_accvgpr_write_b32 a101, 0
    v_accvgpr_write_b32 a102, 0
    v_accvgpr_write_b32 a103, 0
    v_accvgpr_write_b32 a104, 0
    v_accvgpr_write_b32 a105, 0
    v_accvgpr_write_b32 a106, 0
    v_accvgpr_write_b32 a107, 0
    v_accvgpr_write_b32 a108, 0
    v_accvgpr_write_b32 a109, 0
    v_accvgpr_write_b32 a110, 0
    v_accvgpr_write_b32 a111, 0
    v_accvgpr_write_b32 a112, 0
    v_accvgpr_write_b32 a113, 0
    v_accvgpr_write_b32 a114, 0
    v_accvgpr_write_b32 a115, 0
    v_accvgpr_write_b32 a116, 0
    v_accvgpr_write_b32 a117, 0
    v_accvgpr_write_b32 a118, 0
    v_accvgpr_write_b32 a119, 0
    v_accvgpr_write_b32 a120, 0
    v_accvgpr_write_b32 a121, 0
    v_accvgpr_write_b32 a122, 0
    v_accvgpr_write_b32 a123, 0
    v_accvgpr_write_b32 a124, 0
    v_accvgpr_write_b32 a125, 0
    v_accvgpr_write_b32 a126, 0
    v_accvgpr_write_b32 a127, 0
    v_mov_b32 v160, 0
    v_mov_b32 v161, 0
    v_mov_b32 v162, 0
    v_mov_b32 v163, 0
    v_mov_b32 v164, 0
    v_mov_b32 v165, 0
    v_mov_b32 v166, 0
    v_mov_b32 v167, 0
    v_mov_b32 v168, 0
    v_mov_b32 v169, 0
    v_mov_b32 v170, 0
    v_mov_b32 v171, 0
    v_mov_b32 v172, 0
    v_mov_b32 v173, 0
    v_mov_b32 v174, 0
    v_mov_b32 v175, 0
    v_mov_b32 v176, 0
    v_mov_b32 v177, 0
    v_mov_b32 v178, 0
    v_mov_b32 v179, 0
    v_mov_b32 v180, 0
    v_mov_b32 v181, 0
    v_mov_b32 v182, 0
    v_mov_b32 v183, 0
    v_mov_b32 v184, 0
    v_mov_b32 v185, 0
    v_mov_b32 v186, 0
    v_mov_b32 v187, 0
    v_mov_b32 v188, 0
    v_mov_b32 v189, 0
    v_mov_b32 v190, 0
    v_mov_b32 v191, 0
    v_mov_b32 v12, 0
    v_mov_b32 v28, 0
    v_mov_b32 v44, 0x3f803f80
    v_mov_b32 v13, 0
    v_mov_b32 v32, 0
    v_mov_b32 v45, 0x3f803f80
    v_mov_b32 v14, 0
    v_mov_b32 v36, 0
    v_mov_b32 v46, 0x3f803f80
    v_mov_b32 v15, 0
    v_mov_b32 v40, 0
    v_mov_b32 v47, 0x3f803f80
    s_and_b32 s90, s2, 7
    s_lshl_b32 s90, s90, 4
    s_lshl_b32 s91, s16, 2
    s_add_u32 s76, s90, s91
    s_lshr_b32 s92, s2, 3
    s_lshl_b32 s92, s92, 17
    s_lshl_b32 s90, s76, 10
    s_add_u32 s90, s90, s92
    s_add_u32 s79, s90, 50331648
    s_add_u32 s80, s90, 54525952
    s_and_b32 s77, s76, 63
    s_cmp_eq_u32 s77, 0
    s_cselect_b32 s93, 0, 1024
    s_sub_u32 s81, s80, s93
    s_lshl_b32 s90, s76, 9
    s_add_u32 s90, s90, s92
    s_add_u32 s82, s90, 58720256
    s_sub_u32 s83, s82, s93
    s_add_u32 s84, s82, 65536
    s_add_u32 s85, s83, 65536
    v_and_b32 v48, 15, v1
    v_lshrrev_b32 v49, 4, v1
    v_lshlrev_b32 v49, 2, v49
    v_sub_u32 v48, v48, v49
    v_cmp_le_i32 vcc, 0, v48
    s_nop 1
    v_cndmask_b32 v16, v9, 0, vcc
    v_cmp_le_i32 vcc, 1, v48
    s_nop 1
    v_cndmask_b32 v17, v9, 0, vcc
    v_cmp_le_i32 vcc, 2, v48
    s_nop 1
    v_cndmask_b32 v18, v9, 0, vcc
    v_cmp_le_i32 vcc, 3, v48
    s_nop 1
    v_cndmask_b32 v19, v9, 0, vcc
    s_mov_b32 s58, 35791400
    s_mov_b32 s59, 0
    s_sub_u32 s90, s63, 1
    s_bitset1_b64 s[58:59], s90
    s_sub_u32 s90, s64, 1
    s_bitset1_b64 s[58:59], s90
    s_sub_u32 s90, s65, 1
    s_bitset1_b64 s[58:59], s90
    s_sub_u32 s90, s66, 1
    s_bitset1_b64 s[58:59], s90
    s_sub_u32 s90, s67, 1
    s_bitset1_b64 s[58:59], s90
    s_sub_u32 s90, s68, 1
    s_bitset1_b64 s[58:59], s90
    s_mov_b32 s60, 0
    s_cmp_lg_u32 s60, s63
    s_cbranch_scc1 mega_kernel_e61
    v_add_f32 v176, v176, v16
    v_mov_b32 v180, v9
    v_add_f32 v188, v188, v16
    v_add_f32 v177, v177, v17
    v_mov_b32 v181, v9
    v_add_f32 v189, v189, v17
    v_add_f32 v178, v178, v18
    v_mov_b32 v182, v9
    v_add_f32 v190, v190, v18
    v_add_f32 v179, v179, v19
    v_mov_b32 v183, v9
    v_add_f32 v191, v191, v19
    s_nop 0
mega_kernel_e61:
    s_waitcnt vmcnt(40) lgkmcnt(0)
    s_barrier
    ds_read_b128 a[192:195], v6 offset:0
    ds_read_b128 a[196:199], v6 offset:1024
    ds_read_b128 a[200:203], v6 offset:2048
    ds_read_b128 a[204:207], v6 offset:3072
    ds_read_b128 a[208:211], v6 offset:4096
    ds_read_b128 a[212:215], v6 offset:5120
    ds_read_b128 a[216:219], v6 offset:6144
    ds_read_b128 a[220:223], v6 offset:7168
    s_waitcnt lgkmcnt(0)
    v_mfma_f32_16x16x32_bf16 v[64:67], a[192:195], a[128:131], v[160:163]
    v_mfma_f32_16x16x32_bf16 v[64:67], a[196:199], a[132:135], v[64:67]
    v_mfma_f32_16x16x32_bf16 v[64:67], a[200:203], a[136:139], v[64:67]
    v_mfma_f32_16x16x32_bf16 v[64:67], a[204:207], a[140:143], v[64:67]
    buffer_store_dwordx4 v[192:195], v2, s[36:39], s40 offen sc1
    s_add_u32 s40, s40, s100
    v_mfma_f32_16x16x32_bf16 v[72:75], a[192:195], a[144:147], v[168:171]
    v_mfma_f32_16x16x32_bf16 v[72:75], a[196:199], a[148:151], v[72:75]
    v_mfma_f32_16x16x32_bf16 v[72:75], a[200:203], a[152:155], v[72:75]
    v_mfma_f32_16x16x32_bf16 v[72:75], a[204:207], a[156:159], v[72:75]
    v_mfma_f32_16x16x32_bf16 v[80:83], a[192:195], a[160:163], v[176:179]
    v_mfma_f32_16x16x32_bf16 v[80:83], a[196:199], a[164:167], v[80:83]
    v_mfma_f32_16x16x32_bf16 v[80:83], a[200:203], a[168:171], v[80:83]
    v_mfma_f32_16x16x32_bf16 v[80:83], a[204:207], a[172:175], v[80:83]
    buffer_store_dwordx4 v[196:199], v2, s[36:39], s40 offen sc1
    s_add_u32 s40, s40, s100
    v_mfma_f32_16x16x32_bf16 v[88:91], a[192:195], a[176:179], v[184:187]
    v_mfma_f32_16x16x32_bf16 v[88:91], a[196:199], a[180:183], v[88:91]
    v_mfma_f32_16x16x32_bf16 v[88:91], a[200:203], a[184:187], v[88:91]
    v_mfma_f32_16x16x32_bf16 v[88:91], a[204:207], a[188:191], v[88:91]
    v_mfma_f32_16x16x32_bf16 v[68:71], a[208:211], a[128:131], v[164:167]
    ds_read_b128 a[192:195], v6 offset:8192
    v_mfma_f32_16x16x32_bf16 v[68:71], a[212:215], a[132:135], v[68:71]
    ds_read_b128 a[196:199], v6 offset:9216
    v_mfma_f32_16x16x32_bf16 v[68:71], a[216:219], a[136:139], v[68:71]
    ds_read_b128 a[200:203], v6 offset:10240
    v_mfma_f32_16x16x32_bf16 v[68:71], a[220:223], a[140:143], v[68:71]
    buffer_store_dwordx4 v[200:203], v2, s[36:39], s40 offen sc1
    s_add_u32 s40, s40, s100
    ds_read_b128 a[204:207], v6 offset:11264
    v_mfma_f32_16x16x32_bf16 v[76:79], a[208:211], a[144:147], v[172:175]
    v_mfma_f32_16x16x32_bf16 v[76:79], a[212:215], a[148:151], v[76:79]
    v_mfma_f32_16x16x32_bf16 v[76:79], a[216:219], a[152:155], v[76:79]
    v_mfma_f32_16x16x32_bf16 v[76:79], a[220:223], a[156:159], v[76:79]
    v_mfma_f32_16x16x32_bf16 v[84:87], a[208:211], a[160:163], v[180:183]
    v_mfma_f32_16x16x32_bf16 v[84:87], a[212:215], a[164:167], v[84:87]
    v_mfma_f32_16x16x32_bf16 v[84:87], a[216:219], a[168:171], v[84:87]
    v_mfma_f32_16x16x32_bf16 v[84:87], a[220:223], a[172:175], v[84:87]
    buffer_store_dwordx4 v[204:207], v2, s[36:39], s40 offen sc1
    s_add_u32 s40, s98, s99
    v_mfma_f32_16x16x32_bf16 v[92:95], a[208:211], a[176:179], v[188:191]
    v_mfma_f32_16x16x32_bf16 v[92:95], a[212:215], a[180:183], v[92:95]
    v_mfma_f32_16x16x32_bf16 v[92:95], a[216:219], a[184:187], v[92:95]
    v_mfma_f32_16x16x32_bf16 v[92:95], a[220:223], a[188:191], v[92:95]
    ds_read_b128 a[208:211], v6 offset:12288
    ds_read_b128 a[212:215], v6 offset:13312
    ds_read_b128 a[216:219], v6 offset:14336
    ds_read_b128 a[220:223], v6 offset:15360
    s_mov_b32 s60, 1
    s_nop 0
    s_nop 3
    v_max3_f32 v48, v64, v65, v66
    v_max3_f32 v49, v72, v73, v74
    v_max3_f32 v50, v80, v81, v82
    v_max3_f32 v51, v88, v89, v90
    v_max3_f32 v48, v48, v67, v68
    v_max3_f32 v49, v49, v75, v76
    v_max3_f32 v50, v50, v83, v84
    v_max3_f32 v51, v51, v91, v92
    v_max3_f32 v48, v48, v69, v70
    v_max3_f32 v49, v49, v77, v78
    v_max3_f32 v50, v50, v85, v86
    v_max3_f32 v51, v51, v93, v94
    v_max_f32 v48, v48, v71
    v_max_f32 v49, v49, v79
    v_max_f32 v50, v50, v87
    v_max_f32 v51, v51, v95
    v_mov_b32 v52, v48
    v_mov_b32 v53, v49
    v_mov_b32 v54, v50
    v_mov_b32 v55, v51
    s_nop 1
    v_permlane32_swap_b32 v48, v52
    v_permlane32_swap_b32 v49, v53
    v_permlane32_swap_b32 v50, v54
    v_permlane32_swap_b32 v51, v55
    s_nop 1
    v_max_f32 v48, v48, v52
    v_max_f32 v49, v49, v53
    v_max_f32 v50, v50, v54
    v_max_f32 v51, v51, v55
    v_mov_b32 v52, v48
    v_mov_b32 v53, v49
    v_mov_b32 v54, v50
    v_mov_b32 v55, v51
    s_nop 1
    v_permlane16_swap_b32 v48, v52
    v_permlane16_swap_b32 v49, v53
    v_permlane16_swap_b32 v50, v54
    v_permlane16_swap_b32 v51, v55
    s_nop 1
    v_max_f32 v48, v48, v52
    v_max_f32 v49, v49, v53
    v_max_f32 v50, v50, v54
    v_max_f32 v51, v51, v55
    v_sub_f32 v160, v160, v48
    v_sub_f32 v161, v161, v48
    v_sub_f32 v162, v162, v48
    v_sub_f32 v163, v163, v48
    v_sub_f32 v164, v164, v48
    v_sub_f32 v165, v165, v48
    v_sub_f32 v166, v166, v48
    v_sub_f32 v167, v167, v48
    v_sub_f32 v168, v168, v49
    v_sub_f32 v169, v169, v49
    v_sub_f32 v170, v170, v49
    v_sub_f32 v171, v171, v49
    v_sub_f32 v172, v172, v49
    v_sub_f32 v173, v173, v49
    v_sub_f32 v174, v174, v49
    v_sub_f32 v175, v175, v49
    v_sub_f32 v176, v176, v50
    v_sub_f32 v177, v177, v50
    v_sub_f32 v178, v178, v50
    v_sub_f32 v179, v179, v50
    v_sub_f32 v180, v180, v50
    v_sub_f32 v181, v181, v50
    v_sub_f32 v182, v182, v50
    v_sub_f32 v183, v183, v50
    v_sub_f32 v184, v184, v51
    v_sub_f32 v185, v185, v51
    v_sub_f32 v186, v186, v51
    v_sub_f32 v187, v187, v51
    v_sub_f32 v188, v188, v51
    v_sub_f32 v189, v189, v51
    v_sub_f32 v190, v190, v51
    v_sub_f32 v191, v191, v51
    v_sub_f32 v64, v64, v48
    v_sub_f32 v65, v65, v48
    v_sub_f32 v66, v66, v48
    v_sub_f32 v67, v67, v48
    v_sub_f32 v68, v68, v48
    v_sub_f32 v69, v69, v48
    v_sub_f32 v70, v70, v48
    v_sub_f32 v71, v71, v48
    v_sub_f32 v72, v72, v49
    v_sub_f32 v73, v73, v49
    v_sub_f32 v74, v74, v49
    v_sub_f32 v75, v75, v49
    v_sub_f32 v76, v76, v49
    v_sub_f32 v77, v77, v49
    v_sub_f32 v78, v78, v49
    v_sub_f32 v79, v79, v49
    v_sub_f32 v80, v80, v50
    v_sub_f32 v81, v81, v50
    v_sub_f32 v82, v82, v50
    v_sub_f32 v83, v83, v50
    v_sub_f32 v84, v84, v50
    v_sub_f32 v85, v85, v50
    v_sub_f32 v86, v86, v50
    v_sub_f32 v87, v87, v50
    v_sub_f32 v88, v88, v51
    v_sub_f32 v89, v89, v51
    v_sub_f32 v90, v90, v51
    v_sub_f32 v91, v91, v51
    v_sub_f32 v92, v92, v51
    v_sub_f32 v93, v93, v51
    v_sub_f32 v94, v94, v51
    v_sub_f32 v95, v95, v51
    s_cmp_lg_u32 s60, s63
    s_cbranch_scc1 mega_kernel_e62
    v_add_f32 v176, v176, v16
    v_mov_b32 v180, v9
    v_add_f32 v188, v188, v16
    v_add_f32 v177, v177, v17
    v_mov_b32 v181, v9
    v_add_f32 v189, v189, v17
    v_add_f32 v178, v178, v18
    v_mov_b32 v182, v9
    v_add_f32 v190, v190, v18
    v_add_f32 v179, v179, v19
    v_mov_b32 v183, v9
    v_add_f32 v191, v191, v19
    s_nop 0
mega_kernel_e62:
    s_cmp_lg_u32 s60, s64
    s_cbranch_scc1 mega_kernel_e63
    v_mov_b32 v176, v9
    v_mov_b32 v184, v9
    v_mov_b32 v188, v9
    v_mov_b32 v177, v9
    v_mov_b32 v185, v9
    v_mov_b32 v189, v9
    v_mov_b32 v178, v9
    v_mov_b32 v186, v9
    v_mov_b32 v190, v9
    v_mov_b32 v179, v9
    v_mov_b32 v187, v9
    v_mov_b32 v191, v9
    s_nop 0
mega_kernel_e63:
    s_waitcnt lgkmcnt(0)
    v_mfma_f32_16x16x32_bf16 v[96:99], a[192:195], a[128:131], v[160:163]
    s_bitcmp1_b64 s[58:59], s60
    s_cselect_b32 s62, -1.0, s61
    v_exp_f32 v20, v64
    v_mfma_f32_16x16x32_bf16 v[96:99], a[196:199], a[132:135], v[96:99]
    s_add_u32 s60, s60, 1
    v_exp_f32 v21, v65
    v_add_f32 v12, v12, v28
    v_mfma_f32_16x16x32_bf16 v[96:99], a[200:203], a[136:139], v[96:99]
    v_exp_f32 v22, v66
    v_cvt_pk_bf16_f32 v128, v20, v21
    v_mfma_f32_16x16x32_bf16 v[96:99], a[204:207], a[140:143], v[96:99]
    buffer_store_dwordx4 v[208:211], v2, s[36:39], s40 offen sc1
    v_add_f32 v13, v13, v32
    v_mfma_f32_16x16x32_bf16 v[104:107], a[192:195], a[144:147], v[168:171]
    s_add_u32 s40, s40, s100
    v_exp_f32 v23, v67
    v_add_f32 v14, v14, v36
    v_mfma_f32_16x16x32_bf16 v[104:107], a[196:199], a[148:151], v[104:107]
    v_exp_f32 v24, v68
    v_cvt_pk_bf16_f32 v129, v22, v23
    v_mfma_f32_16x16x32_bf16 v[104:107], a[200:203], a[152:155], v[104:107]
    v_exp_f32 v25, v69
    v_add_f32 v15, v15, v40
    v_mfma_f32_16x16x32_bf16 v[104:107], a[204:207], a[156:159], v[104:107]
    v_exp_f32 v26, v70
    v_cvt_pk_bf16_f32 v130, v24, v25
    v_mfma_f32_16x16x32_bf16 v[112:115], a[192:195], a[160:163], v[176:179]
    v_exp_f32 v27, v71
    v_mfma_f32_16x16x32_bf16 v[112:115], a[196:199], a[164:167], v[112:115]
    v_exp_f32 v20, v72
    v_cvt_pk_bf16_f32 v131, v26, v27
    v_mfma_f32_16x16x32_bf16 v[112:115], a[200:203], a[168:171], v[112:115]
    buffer_store_dwordx4 v[212:215], v2, s[36:39], s40 offen sc1
    v_exp_f32 v21, v73
    v_mfma_f32_16x16x32_bf16 v[28:31], v[44:47], v[128:131], 0
    v_exp_f32 v22, v74
    v_cvt_pk_bf16_f32 v132, v20, v21
    v_mfma_f32_16x16x32_bf16 v[112:115], a[204:207], a[172:175], v[112:115]
    s_add_u32 s40, s40, s100
    v_exp_f32 v23, v75
    v_mfma_f32_16x16x32_bf16 v[120:123], a[192:195], a[176:179], v[184:187]
    v_exp_f32 v24, v76
    v_cvt_pk_bf16_f32 v133, v22, v23
    v_mfma_f32_16x16x32_bf16 v[120:123], a[196:199], a[180:183], v[120:123]
    v_exp_f32 v25, v77
    v_exp_f32 v26, v78
    v_mfma_f32_16x16x32_bf16 v[120:123], a[200:203], a[184:187], v[120:123]
    v_cvt_pk_bf16_f32 v134, v24, v25
    v_exp_f32 v27, v79
    v_mfma_f32_16x16x32_bf16 v[120:123], a[204:207], a[188:191], v[120:123]
    s_waitcnt lgkmcnt(0)
    v_exp_f32 v20, v80
    v_cvt_pk_bf16_f32 v135, v26, v27
    v_mfma_f32_16x16x32_bf16 v[100:103], a[208:211], a[128:131], v[164:167]
    v_exp_f32 v21, v81
    v_mfma_f32_16x16x32_bf16 v[32:35], v[44:47], v[132:135], 0
    v_exp_f32 v22, v82
    v_cvt_pk_bf16_f32 v136, v20, v21
    v_mfma_f32_16x16x32_bf16 v[100:103], a[212:215], a[132:135], v[100:103]
    v_exp_f32 v23, v83
    v_exp_f32 v24, v84
    v_mfma_f32_16x16x32_bf16 v[100:103], a[216:219], a[136:139], v[100:103]
    buffer_store_dwordx4 v[216:219], v2, s[36:39], s40 offen sc1
    v_cvt_pk_bf16_f32 v137, v22, v23
    v_mfma_f32_16x16x32_bf16 v[100:103], a[220:223], a[140:143], v[100:103]
    s_add_u32 s40, s40, s100
    v_exp_f32 v25, v85
    v_mfma_f32_16x16x32_bf16 v[108:111], a[208:211], a[144:147], v[172:175]
    v_exp_f32 v26, v86
    v_cvt_pk_bf16_f32 v138, v24, v25
    v_mfma_f32_16x16x32_bf16 v[108:111], a[212:215], a[148:151], v[108:111]
    v_exp_f32 v27, v87
    v_exp_f32 v20, v88
    v_mfma_f32_16x16x32_bf16 v[108:111], a[216:219], a[152:155], v[108:111]
    v_cvt_pk_bf16_f32 v139, v26, v27
    v_exp_f32 v21, v89
    v_mfma_f32_16x16x32_bf16 v[108:111], a[220:223], a[156:159], v[108:111]
    v_exp_f32 v22, v90
    v_cvt_pk_bf16_f32 v140, v20, v21
    v_mfma_f32_16x16x32_bf16 v[36:39], v[44:47], v[136:139], 0
    v_exp_f32 v23, v91
    v_mfma_f32_16x16x32_bf16 v[116:119], a[208:211], a[160:163], v[180:183]
    v_exp_f32 v24, v92
    v_cvt_pk_bf16_f32 v141, v22, v23
    v_mfma_f32_16x16x32_bf16 v[116:119], a[212:215], a[164:167], v[116:119]
    buffer_store_dwordx4 v[220:223], v2, s[36:39], s40 offen sc1
    v_exp_f32 v25, v93
    v_mfma_f32_16x16x32_bf16 v[116:119], a[216:219], a[168:171], v[116:119]
    s_add_u32 s40, s40, s100
    v_exp_f32 v26, v94
    v_cvt_pk_bf16_f32 v142, v24, v25
    v_mfma_f32_16x16x32_bf16 v[116:119], a[220:223], a[172:175], v[116:119]
    v_exp_f32 v27, v95
    s_nop 0
    v_cvt_pk_bf16_f32 v143, v26, v27
    s_nop 1
    v_mfma_f32_16x16x32_bf16 v[40:43], v[44:47], v[140:143], 0
    s_nop 2
    v_mfma_f32_16x16x32_bf16 v[124:127], a[208:211], a[176:179], v[188:191]
    s_nop 2
    v_mfma_f32_16x16x32_bf16 v[124:127], a[212:215], a[180:183], v[124:127]
    v_max3_f32 v8, v28, v32, v36
    v_max_f32 v8, v8, v40
    v_mfma_f32_16x16x32_bf16 v[124:127], a[216:219], a[184:187], v[124:127]
    v_cmp_nge_f32 vcc, s62, v8
    v_mfma_f32_16x16x32_bf16 v[124:127], a[220:223], a[188:191], v[124:127]
    s_waitcnt vmcnt(40) lgkmcnt(0)
    s_barrier
    s_add_u32 s55, s54, s56
    s_add_u32 s54, s54, 32768
    s_and_b32 s54, s54, 0x1ffff
    v_add_u32 v6, s54, v2
    ds_read_b128 a[192:195], v6 offset:0
    ds_read_b128 a[196:199], v6 offset:1024
    ds_read_b128 a[200:203], v6 offset:2048
    ds_read_b128 a[204:207], v6 offset:3072
    ds_read_b128 a[208:211], v6 offset:4096
    ds_read_b128 a[212:215], v6 offset:5120
    ds_read_b128 a[216:219], v6 offset:6144
    ds_read_b128 a[220:223], v6 offset:7168
    s_waitcnt lgkmcnt(0)
    s_cbranch_vccnz mega_kernel_stub64
mega_kernel_ret65:
mega_kernel_dual66:
    v_mfma_f32_16x16x32_bf16 v[64:67], a[192:195], a[128:131], v[160:163]
    s_bitcmp1_b64 s[58:59], s60
    s_cselect_b32 s62, -1.0, s61
    v_add_f32 v12, v12, v28
    v_mfma_f32_16x16x32_bf16 v[64:67], a[196:199], a[132:135], v[64:67]
    s_add_u32 s60, s60, 1
    ds_read_b128 a[224:227], v6 offset:16384
    v_add_f32 v13, v13, v32
    v_mfma_f32_16x16x32_bf16 v[64:67], a[200:203], a[136:139], v[64:67]
    v_exp_f32 v20, v96
    v_mfma_f32_16x16x32_bf16 v[64:67], a[204:207], a[140:143], v[64:67]
    v_exp_f32 v21, v97
    v_mfma_f32_16x16x32_bf16 v[72:75], a[192:195], a[144:147], v[168:171]
    s_mov_b32 m0, s55
    ds_read_b128 a[228:231], v6 offset:17408
    v_cvt_pk_bf16_f32 v144, v20, v21
    v_mfma_f32_16x16x32_bf16 v[72:75], a[196:199], a[148:151], v[72:75]
    buffer_load_dwordx4 v7, s[24:27], s52 offen offset:0 sc1 lds
    v_mfma_f32_16x16x32_bf16 v[72:75], a[200:203], a[152:155], v[72:75]
    v_exp_f32 v22, v98
    v_mfma_f32_16x16x32_bf16 v[72:75], a[204:207], a[156:159], v[72:75]
    ds_read_b128 a[232:235], v6 offset:18432
    v_add_f32 v14, v14, v36
    v_mfma_f32_16x16x32_bf16 v[80:83], a[192:195], a[160:163], v[176:179]
    v_exp_f32 v23, v99
    v_mfma_f32_16x16x32_bf16 v[80:83], a[196:199], a[164:167], v[80:83]
    v_exp_f32 v24, v100
    v_mfma_f32_16x16x32_bf16 v[80:83], a[200:203], a[168:171], v[80:83]
    ds_read_b128 a[236:239], v6 offset:19456
    v_cvt_pk_bf16_f32 v145, v22, v23
    v_mfma_f32_16x16x32_bf16 v[80:83], a[204:207], a[172:175], v[80:83]
    v_exp_f32 v25, v101
    v_mfma_f32_16x16x32_bf16 v[88:91], a[192:195], a[176:179], v[184:187]
    v_exp_f32 v26, v102
    v_mfma_f32_16x16x32_bf16 v[88:91], a[196:199], a[180:183], v[88:91]
    ds_read_b128 a[240:243], v6 offset:20480
    v_cvt_pk_bf16_f32 v146, v24, v25
    v_mfma_f32_16x16x32_bf16 v[88:91], a[200:203], a[184:187], v[88:91]
    v_exp_f32 v27, v103
    v_mfma_f32_16x16x32_bf16 v[88:91], a[204:207], a[188:191], v[88:91]
    s_waitcnt lgkmcnt(5)
    v_exp_f32 v20, v104
    v_mfma_f32_16x16x32_bf16 v[68:71], a[208:211], a[128:131], v[164:167]
    ds_read_b128 a[244:247], v6 offset:21504
    v_cvt_pk_bf16_f32 v147, v26, v27
    v_mfma_f32_16x16x32_bf16 v[68:71], a[212:215], a[132:135], v[68:71]
    v_exp_f32 v21, v105
    v_mfma_f32_16x16x32_bf16 v[28:31], v[44:47], v[144:147], 0
    v_exp_f32 v22, v106
    v_mfma_f32_16x16x32_bf16 v[68:71], a[216:219], a[136:139], v[68:71]
    buffer_load_dwordx4 v7, s[24:27], s52 offen offset:1024 sc1 lds
    v_mfma_f32_16x16x32_bf16 v[68:71], a[220:223], a[140:143], v[68:71]
    ds_read_b128 a[248:251], v6 offset:22528
    v_cvt_pk_bf16_f32 v148, v20, v21
    v_mfma_f32_16x16x32_bf16 v[76:79], a[208:211], a[144:147], v[172:175]
    v_exp_f32 v23, v107
    v_mfma_f32_16x16x32_bf16 v[76:79], a[212:215], a[148:151], v[76:79]
    v_exp_f32 v24, v108
    v_mfma_f32_16x16x32_bf16 v[76:79], a[216:219], a[152:155], v[76:79]
    ds_read_b128 a[252:255], v6 offset:23552
    v_cvt_pk_bf16_f32 v149, v22, v23
    v_mfma_f32_16x16x32_bf16 v[76:79], a[220:223], a[156:159], v[76:79]
    v_exp_f32 v25, v109
    v_mfma_f32_16x16x32_bf16 v[84:87], a[208:211], a[160:163], v[180:183]
    v_exp_f32 v26, v110
    v_mfma_f32_16x16x32_bf16 v[84:87], a[212:215], a[164:167], v[84:87]
    v_cvt_pk_bf16_f32 v150, v24, v25
    v_add_f32 v15, v15, v40
    v_mfma_f32_16x16x32_bf16 v[84:87], a[216:219], a[168:171], v[84:87]
    v_exp_f32 v27, v111
    v_mfma_f32_16x16x32_bf16 v[84:87], a[220:223], a[172:175], v[84:87]
    buffer_load_dwordx4 v7, s[24:27], s52 offen offset:2048 sc1 lds
    v_mfma_f32_16x16x32_bf16 v[92:95], a[208:211], a[176:179], v[188:191]
    v_exp_f32 v20, v112
    v_mfma_f32_16x16x32_bf16 v[92:95], a[212:215], a[180:183], v[92:95]
    v_cvt_pk_bf16_f32 v151, v26, v27
    v_mfma_f32_16x16x32_bf16 v[92:95], a[216:219], a[184:187], v[92:95]
    v_exp_f32 v21, v113
    v_mfma_f32_16x16x32_bf16 v[32:35], v[44:47], v[148:151], 0
    v_exp_f32 v22, v114
    v_mfma_f32_16x16x32_bf16 v[92:95], a[220:223], a[188:191], v[92:95]
    s_waitcnt lgkmcnt(0)
    v_cvt_pk_bf16_f32 v152, v20, v21
    v_mfma_f32_16x16x32_bf16 a[0:3], a[224:227], v[128:131], a[0:3]
    ds_read_b128 a[192:195], v6 offset:8192
    v_mfma_f32_16x16x32_bf16 a[32:35], a[224:227], v[132:135], a[32:35]
    v_exp_f32 v23, v115
    v_mfma_f32_16x16x32_bf16 a[64:67], a[224:227], v[136:139], a[64:67]
    v_exp_f32 v24, v116
    v_mfma_f32_16x16x32_bf16 a[96:99], a[224:227], v[140:143], a[96:99]
    ds_read_b128 a[196:199], v6 offset:9216
    v_cvt_pk_bf16_f32 v153, v22, v23
    v_mfma_f32_16x16x32_bf16 a[4:7], a[228:231], v[128:131], a[4:7]
    v_exp_f32 v25, v117
    v_mfma_f32_16x16x32_bf16 a[36:39], a[228:231], v[132:135], a[36:39]
    v_exp_f32 v26, v118
    v_mfma_f32_16x16x32_bf16 a[68:71], a[228:231], v[136:139], a[68:71]
    ds_read_b128 a[200:203], v6 offset:10240
    v_cvt_pk_bf16_f32 v154, v24, v25
    v_mfma_f32_16x16x32_bf16 a[100:103], a[228:231], v[140:143], a[100:103]
    v_exp_f32 v27, v119
    v_mfma_f32_16x16x32_bf16 a[8:11], a[232:235], v[128:131], a[8:11]
    v_exp_f32 v20, v120
    v_mfma_f32_16x16x32_bf16 a[40:43], a[232:235], v[132:135], a[40:43]
    ds_read_b128 a[204:207], v6 offset:11264
    v_cvt_pk_bf16_f32 v155, v26, v27
    v_mfma_f32_16x16x32_bf16 a[72:75], a[232:235], v[136:139], a[72:75]
    v_exp_f32 v21, v121
    v_mfma_f32_16x16x32_bf16 v[36:39], v[44:47], v[152:155], 0
    v_exp_f32 v22, v122
    v_mfma_f32_16x16x32_bf16 a[104:107], a[232:235], v[140:143], a[104:107]
    buffer_load_dwordx4 v7, s[24:27], s52 offen offset:3072 sc1 lds
    v_mfma_f32_16x16x32_bf16 a[12:15], a[236:239], v[128:131], a[12:15]
    s_add_u32 s52, s52, 16384
    v_cvt_pk_bf16_f32 v156, v20, v21
    v_mfma_f32_16x16x32_bf16 a[44:47], a[236:239], v[132:135], a[44:47]
    v_exp_f32 v23, v123
    v_mfma_f32_16x16x32_bf16 a[76:79], a[236:239], v[136:139], a[76:79]
    v_exp_f32 v24, v124
    v_mfma_f32_16x16x32_bf16 a[108:111], a[236:239], v[140:143], a[108:111]
    v_cvt_pk_bf16_f32 v157, v22, v23
    v_mfma_f32_16x16x32_bf16 a[16:19], a[240:243], v[128:131], a[16:19]
    v_exp_f32 v25, v125
    v_mfma_f32_16x16x32_bf16 a[48:51], a[240:243], v[132:135], a[48:51]
    v_exp_f32 v26, v126
    v_mfma_f32_16x16x32_bf16 a[80:83], a[240:243], v[136:139], a[80:83]
    v_cvt_pk_bf16_f32 v158, v24, v25
    v_mfma_f32_16x16x32_bf16 a[112:115], a[240:243], v[140:143], a[112:115]
    s_add_u32 m0, s55, 16384
    v_exp_f32 v27, v127
    v_mfma_f32_16x16x32_bf16 a[20:23], a[244:247], v[128:131], a[20:23]
    buffer_load_dwordx4 v7, s[28:31], s53 offen offset:0 sc1 lds
    v_mfma_f32_16x16x32_bf16 a[52:55], a[244:247], v[132:135], a[52:55]
    v_cvt_pk_bf16_f32 v159, v26, v27
    v_mfma_f32_16x16x32_bf16 a[84:87], a[244:247], v[136:139], a[84:87]
    v_mfma_f32_16x16x32_bf16 a[116:119], a[244:247], v[140:143], a[116:119]
    v_mfma_f32_16x16x32_bf16 v[40:43], v[44:47], v[156:159], 0
    s_nop 2
    v_mfma_f32_16x16x32_bf16 a[24:27], a[248:251], v[128:131], a[24:27]
    s_nop 2
    v_mfma_f32_16x16x32_bf16 a[56:59], a[248:251], v[132:135], a[56:59]
    v_max3_f32 v8, v28, v32, v36
    v_max_f32 v8, v8, v40
    v_mfma_f32_16x16x32_bf16 a[88:91], a[248:251], v[136:139], a[88:91]
    v_cmp_nge_f32 vcc, s62, v8
    v_mfma_f32_16x16x32_bf16 a[120:123], a[248:251], v[140:143], a[120:123]
    ds_read_b128 a[208:211], v6 offset:12288
    v_mfma_f32_16x16x32_bf16 a[28:31], a[252:255], v[128:131], a[28:31]
    ds_read_b128 a[212:215], v6 offset:13312
    v_mfma_f32_16x16x32_bf16 a[60:63], a[252:255], v[132:135], a[60:63]
    ds_read_b128 a[216:219], v6 offset:14336
    v_mfma_f32_16x16x32_bf16 a[92:95], a[252:255], v[136:139], a[92:95]
    ds_read_b128 a[220:223], v6 offset:15360
    v_mfma_f32_16x16x32_bf16 a[124:127], a[252:255], v[140:143], a[124:127]
    s_waitcnt lgkmcnt(4)
    s_cbranch_vccnz mega_kernel_stub67
mega_kernel_ret68:
    v_mfma_f32_16x16x32_bf16 v[96:99], a[192:195], a[128:131], v[160:163]
    s_add_u32 s55, s54, s56
    v_exp_f32 v20, v64
    v_mfma_f32_16x16x32_bf16 v[96:99], a[196:199], a[132:135], v[96:99]
    s_add_u32 s54, s54, 32768
    ds_read_b128 a[224:227], v6 offset:24576
    v_add_f32 v12, v12, v28
    v_mfma_f32_16x16x32_bf16 v[96:99], a[200:203], a[136:139], v[96:99]
    s_and_b32 s54, s54, 0x1ffff
    v_exp_f32 v21, v65
    v_mfma_f32_16x16x32_bf16 v[96:99], a[204:207], a[140:143], v[96:99]
    s_bitcmp1_b64 s[58:59], s60
    s_cselect_b32 s62, -1.0, s61
    v_cvt_pk_bf16_f32 v128, v20, v21
    v_mfma_f32_16x16x32_bf16 v[104:107], a[192:195], a[144:147], v[168:171]
    s_add_u32 s60, s60, 1
    ds_read_b128 a[228:231], v6 offset:25600
    v_add_f32 v13, v13, v32
    v_mfma_f32_16x16x32_bf16 v[104:107], a[196:199], a[148:151], v[104:107]
    v_exp_f32 v22, v66
    v_mfma_f32_16x16x32_bf16 v[104:107], a[200:203], a[152:155], v[104:107]
    buffer_load_dwordx4 v7, s[28:31], s53 offen offset:1024 sc1 lds
    v_mfma_f32_16x16x32_bf16 v[104:107], a[204:207], a[156:159], v[104:107]
    ds_read_b128 a[232:235], v6 offset:26624
    v_add_f32 v14, v14, v36
    v_mfma_f32_16x16x32_bf16 v[112:115], a[192:195], a[160:163], v[176:179]
    v_exp_f32 v23, v67
    v_mfma_f32_16x16x32_bf16 v[112:115], a[196:199], a[164:167], v[112:115]
    v_exp_f32 v24, v68
    v_mfma_f32_16x16x32_bf16 v[112:115], a[200:203], a[168:171], v[112:115]
    ds_read_b128 a[236:239], v6 offset:27648
    v_cvt_pk_bf16_f32 v129, v22, v23
    v_mfma_f32_16x16x32_bf16 v[112:115], a[204:207], a[172:175], v[112:115]
    v_exp_f32 v25, v69
    v_mfma_f32_16x16x32_bf16 v[120:123], a[192:195], a[176:179], v[184:187]
    v_exp_f32 v26, v70
    v_mfma_f32_16x16x32_bf16 v[120:123], a[196:199], a[180:183], v[120:123]
    ds_read_b128 a[240:243], v6 offset:28672
    v_cvt_pk_bf16_f32 v130, v24, v25
    v_mfma_f32_16x16x32_bf16 v[120:123], a[200:203], a[184:187], v[120:123]
    v_exp_f32 v27, v71
    v_mfma_f32_16x16x32_bf16 v[120:123], a[204:207], a[188:191], v[120:123]
    s_waitcnt lgkmcnt(5)
    v_exp_f32 v20, v72
    v_mfma_f32_16x16x32_bf16 v[100:103], a[208:211], a[128:131], v[164:167]
    ds_read_b128 a[244:247], v6 offset:29696
    v_cvt_pk_bf16_f32 v131, v26, v27
    v_mfma_f32_16x16x32_bf16 v[100:103], a[212:215], a[132:135], v[100:103]
    v_exp_f32 v21, v73
    v_mfma_f32_16x16x32_bf16 v[28:31], v[44:47], v[128:131], 0
    v_exp_f32 v22, v74
    v_mfma_f32_16x16x32_bf16 v[100:103], a[216:219], a[136:139], v[100:103]
    buffer_load_dwordx4 v7, s[28:31], s53 offen offset:2048 sc1 lds
    v_mfma_f32_16x16x32_bf16 v[100:103], a[220:223], a[140:143], v[100:103]
    ds_read_b128 a[248:251], v6 offset:30720
    v_cvt_pk_bf16_f32 v132, v20, v21
    v_mfma_f32_16x16x32_bf16 v[108:111], a[208:211], a[144:147], v[172:175]
    v_exp_f32 v23, v75
    v_mfma_f32_16x16x32_bf16 v[108:111], a[212:215], a[148:151], v[108:111]
    v_exp_f32 v24, v76
    v_mfma_f32_16x16x32_bf16 v[108:111], a[216:219], a[152:155], v[108:111]
    ds_read_b128 a[252:255], v6 offset:31744
    v_cvt_pk_bf16_f32 v133, v22, v23
    v_mfma_f32_16x16x32_bf16 v[108:111], a[220:223], a[156:159], v[108:111]
    v_exp_f32 v25, v77
    v_mfma_f32_16x16x32_bf16 v[116:119], a[208:211], a[160:163], v[180:183]
    v_exp_f32 v26, v78
    v_mfma_f32_16x16x32_bf16 v[116:119], a[212:215], a[164:167], v[116:119]
    v_cvt_pk_bf16_f32 v134, v24, v25
    v_add_f32 v15, v15, v40
    v_mfma_f32_16x16x32_bf16 v[116:119], a[216:219], a[168:171], v[116:119]
    v_exp_f32 v27, v79
    v_mfma_f32_16x16x32_bf16 v[116:119], a[220:223], a[172:175], v[116:119]
    buffer_load_dwordx4 v7, s[28:31], s53 offen offset:3072 sc1 lds
    v_mfma_f32_16x16x32_bf16 v[124:127], a[208:211], a[176:179], v[188:191]
    s_add_u32 s53, s53, 16384
    v_exp_f32 v20, v80
    v_mfma_f32_16x16x32_bf16 v[124:127], a[212:215], a[180:183], v[124:127]
    v_cvt_pk_bf16_f32 v135, v26, v27
    v_mfma_f32_16x16x32_bf16 v[124:127], a[216:219], a[184:187], v[124:127]
    v_exp_f32 v21, v81
    v_mfma_f32_16x16x32_bf16 v[32:35], v[44:47], v[132:135], 0
    v_exp_f32 v22, v82
    v_mfma_f32_16x16x32_bf16 v[124:127], a[220:223], a[188:191], v[124:127]
    s_waitcnt vmcnt(16) lgkmcnt(0)
    v_add_u32 v6, s54, v2
    v_cvt_pk_bf16_f32 v136, v20, v21
    v_mfma_f32_16x16x32_bf16 a[0:3], a[224:227], v[144:147], a[0:3]
    s_barrier
    v_mfma_f32_16x16x32_bf16 a[32:35], a[224:227], v[148:151], a[32:35]
    ds_read_b128 a[192:195], v6 offset:0
    v_mfma_f32_16x16x32_bf16 a[64:67], a[224:227], v[152:155], a[64:67]
    v_exp_f32 v23, v83
    v_mfma_f32_16x16x32_bf16 a[96:99], a[224:227], v[156:159], a[96:99]
    v_exp_f32 v24, v84
    v_mfma_f32_16x16x32_bf16 a[4:7], a[228:231], v[144:147], a[4:7]
    ds_read_b128 a[196:199], v6 offset:1024
    v_cvt_pk_bf16_f32 v137, v22, v23
    v_mfma_f32_16x16x32_bf16 a[36:39], a[228:231], v[148:151], a[36:39]
    v_exp_f32 v25, v85
    v_mfma_f32_16x16x32_bf16 a[68:71], a[228:231], v[152:155], a[68:71]
    v_exp_f32 v26, v86
    v_mfma_f32_16x16x32_bf16 a[100:103], a[228:231], v[156:159], a[100:103]
    ds_read_b128 a[200:203], v6 offset:2048
    v_cvt_pk_bf16_f32 v138, v24, v25
    v_mfma_f32_16x16x32_bf16 a[8:11], a[232:235], v[144:147], a[8:11]
    v_exp_f32 v27, v87
    v_mfma_f32_16x16x32_bf16 a[40:43], a[232:235], v[148:151], a[40:43]
    v_exp_f32 v20, v88
    v_mfma_f32_16x16x32_bf16 a[72:75], a[232:235], v[152:155], a[72:75]
    ds_read_b128 a[204:207], v6 offset:3072
    v_cvt_pk_bf16_f32 v139, v26, v27
    v_mfma_f32_16x16x32_bf16 a[104:107], a[232:235], v[156:159], a[104:107]
    v_exp_f32 v21, v89
    v_mfma_f32_16x16x32_bf16 v[36:39], v[44:47], v[136:139], 0
    v_exp_f32 v22, v90
    v_mfma_f32_16x16x32_bf16 a[12:15], a[236:239], v[144:147], a[12:15]
    v_cvt_pk_bf16_f32 v140, v20, v21
    v_mfma_f32_16x16x32_bf16 a[44:47], a[236:239], v[148:151], a[44:47]
    v_exp_f32 v23, v91
    v_mfma_f32_16x16x32_bf16 a[76:79], a[236:239], v[152:155], a[76:79]
    v_exp_f32 v24, v92
    v_mfma_f32_16x16x32_bf16 a[108:111], a[236:239], v[156:159], a[108:111]
    v_cvt_pk_bf16_f32 v141, v22, v23
    v_mfma_f32_16x16x32_bf16 a[16:19], a[240:243], v[144:147], a[16:19]
    v_exp_f32 v25, v93
    v_mfma_f32_16x16x32_bf16 a[48:51], a[240:243], v[148:151], a[48:51]
    v_exp_f32 v26, v94
    v_mfma_f32_16x16x32_bf16 a[80:83], a[240:243], v[152:155], a[80:83]
    v_cvt_pk_bf16_f32 v142, v24, v25
    v_mfma_f32_16x16x32_bf16 a[112:115], a[240:243], v[156:159], a[112:115]
    v_exp_f32 v27, v95
    v_mfma_f32_16x16x32_bf16 a[20:23], a[244:247], v[144:147], a[20:23]
    v_cvt_pk_bf16_f32 v143, v26, v27
    v_mfma_f32_16x16x32_bf16 a[52:55], a[244:247], v[148:151], a[52:55]
    v_mfma_f32_16x16x32_bf16 a[84:87], a[244:247], v[152:155], a[84:87]
    v_mfma_f32_16x16x32_bf16 v[40:43], v[44:47], v[140:143], 0
    s_nop 2
    v_mfma_f32_16x16x32_bf16 a[116:119], a[244:247], v[156:159], a[116:119]
    s_nop 2
    v_mfma_f32_16x16x32_bf16 a[24:27], a[248:251], v[144:147], a[24:27]
    v_max3_f32 v8, v28, v32, v36
    v_max_f32 v8, v8, v40
    v_mfma_f32_16x16x32_bf16 a[56:59], a[248:251], v[148:151], a[56:59]
    v_cmp_nge_f32 vcc, s62, v8
    v_mfma_f32_16x16x32_bf16 a[88:91], a[248:251], v[152:155], a[88:91]
    v_mfma_f32_16x16x32_bf16 a[120:123], a[248:251], v[156:159], a[120:123]
    ds_read_b128 a[208:211], v6 offset:4096
    v_mfma_f32_16x16x32_bf16 a[28:31], a[252:255], v[144:147], a[28:31]
    ds_read_b128 a[212:215], v6 offset:5120
    v_mfma_f32_16x16x32_bf16 a[60:63], a[252:255], v[148:151], a[60:63]
    ds_read_b128 a[216:219], v6 offset:6144
    v_mfma_f32_16x16x32_bf16 a[92:95], a[252:255], v[152:155], a[92:95]
    ds_read_b128 a[220:223], v6 offset:7168
    v_mfma_f32_16x16x32_bf16 a[124:127], a[252:255], v[156:159], a[124:127]
    s_waitcnt lgkmcnt(4)
    s_cbranch_vccz mega_kernel_dual66
    v_cmp_lt_f32 vcc, s61, v8
    s_cmp_lg_u32 s60, s63
    s_cbranch_scc1 mega_kernel_e70
    v_add_f32 v176, v176, v16
    v_mov_b32 v180, v9
    v_add_f32 v188, v188, v16
    v_add_f32 v177, v177, v17
    v_mov_b32 v181, v9
    v_add_f32 v189, v189, v17
    v_add_f32 v178, v178, v18
    v_mov_b32 v182, v9
    v_add_f32 v190, v190, v18
    v_add_f32 v179, v179, v19
    v_mov_b32 v183, v9
    v_add_f32 v191, v191, v19
    s_nop 0
mega_kernel_e70:
    s_cmp_lg_u32 s60, s64
    s_cbranch_scc1 mega_kernel_e71
    v_mov_b32 v176, v9
    v_mov_b32 v184, v9
    v_mov_b32 v188, v9
    v_mov_b32 v177, v9
    v_mov_b32 v185, v9
    v_mov_b32 v189, v9
    v_mov_b32 v178, v9
    v_mov_b32 v186, v9
    v_mov_b32 v190, v9
    v_mov_b32 v179, v9
    v_mov_b32 v187, v9
    v_mov_b32 v191, v9
    s_nop 0
mega_kernel_e71:
    s_cmp_lg_u32 s60, s66
    s_cbranch_scc1 mega_kernel_e72
    v_add_f32 v160, v160, v16
    v_mov_b32 v164, v9
    v_add_f32 v172, v172, v16
    v_add_f32 v161, v161, v17
    v_mov_b32 v165, v9
    v_add_f32 v173, v173, v17
    v_add_f32 v162, v162, v18
    v_mov_b32 v166, v9
    v_add_f32 v174, v174, v18
    v_add_f32 v163, v163, v19
    v_mov_b32 v167, v9
    v_add_f32 v175, v175, v19
    s_nop 0
mega_kernel_e72:
    s_cmp_gt_u32 s60, 26
    s_cbranch_scc1 mega_kernel_e73
    s_cmp_lg_u32 s60, 4
    s_cbranch_scc1 mega_kernel_e75
    buffer_store_dwordx4 v[224:227], v2, s[36:39], s40 offen sc1
    s_add_u32 s40, s40, s100
    buffer_store_dwordx4 v[228:231], v2, s[36:39], s40 offen sc1
    s_add_u32 s40, s40, s100
    buffer_store_dwordx4 v[232:235], v2, s[36:39], s40 offen sc1
    s_add_u32 s40, s40, s100
    buffer_store_dwordx4 v[236:239], v2, s[36:39], s40 offen sc1
    s_mov_b32 s40, s98
    s_branch mega_kernel_e73
mega_kernel_e75:
    s_cmp_lg_u32 s60, 6
    s_cbranch_scc1 mega_kernel_e76
    buffer_store_dwordx4 v[240:243], v2, s[36:39], s40 offen sc1
    s_add_u32 s40, s40, s100
    buffer_store_dwordx4 v[244:247], v2, s[36:39], s40 offen sc1
    s_add_u32 s40, s40, s100
    buffer_store_dwordx4 v[248:251], v2, s[36:39], s40 offen sc1
    s_add_u32 s40, s40, s100
    buffer_store_dwordx4 v[252:255], v2, s[36:39], s40 offen sc1
    s_add_u32 s40, s40, s100
    s_branch mega_kernel_e73
mega_kernel_e76:
    s_cmp_lg_u32 s60, 10
    s_cbranch_scc1 mega_kernel_e77
    s_cmp_eq_u32 s17, -1
    s_cbranch_scc1 mega_kernel_e73
    s_cmp_lg_u32 s16, 0
    s_cbranch_scc1 mega_kernel_np78
    v_mov_b32 v4, s4
    v_mov_b32 v5, s5
    s_add_u32 s90, s17, 117440512
    s_mov_b64 exec, 1
    buffer_store_dwordx2 v[4:5], off, s[8:11], s90 sc1
    s_mov_b64 exec, -1
mega_kernel_np78:
    s_branch mega_kernel_e73
mega_kernel_e77:
    s_cmp_lg_u32 s60, 14
    s_cbranch_scc1 mega_kernel_e79
    s_lshr_b32 s90, s32, 1
    s_lshl_b32 s90, s90, 7
    s_add_u32 s90, s90, 117442560
    v_min_u32 v0, 1, v1
    v_lshlrev_b32 v0, 3, v0
    buffer_load_dwordx2 v[4:5], v0, s[8:11], s90 offen sc1
    s_mov_b32 s44, s48
    s_mov_b32 s45, s49
    s_mov_b32 s46, 8388608
    s_lshl_b32 s90, s2, 2
    s_add_u32 s90, s90, s16
    s_lshl_b32 s90, s90, 13
    v_lshlrev_b32 v62, 7, v1
    buffer_load_dword v255, v62, s[44:47], s90 offen
    s_branch mega_kernel_e73
mega_kernel_e79:
    s_cmp_lg_u32 s60, 18
    s_cbranch_scc1 mega_kernel_e80
    s_waitcnt vmcnt(16)
    s_mov_b32 s3, 1048576
mega_kernel_spin81:
    v_cmp_ne_u64 s[72:73], s[4:5], v[4:5]
    s_nop 3
    s_cmp_eq_u64 s[72:73], 0
    s_cbranch_scc1 mega_kernel_e73
    s_sub_u32 s3, s3, 1
    s_cbranch_scc1 mega_kernel_e73
    s_sleep 32
    s_lshr_b32 s90, s32, 1
    s_lshl_b32 s90, s90, 7
    s_add_u32 s90, s90, 117442560
    v_min_u32 v0, 1, v1
    v_lshlrev_b32 v0, 3, v0
    buffer_load_dwordx2 v[4:5], v0, s[8:11], s90 offen sc1
    s_waitcnt vmcnt(0)
    s_branch mega_kernel_spin81
    s_branch mega_kernel_e73
mega_kernel_e80:
    s_cmp_lg_u32 s60, 22
    s_cbranch_scc1 mega_kernel_e82
    buffer_load_dwordx2 v[4:5], v10, s[8:11], 0 offen sc1
    s_mov_b32 s44, s50
    s_mov_b32 s45, s51
    s_mov_b32 s46, 2097152
    s_lshl_b32 s90, s2, 2
    s_add_u32 s90, s90, s16
    s_lshl_b32 s90, s90, 13
    v_lshlrev_b32 v62, 7, v1
    buffer_load_dword v255, v62, s[44:47], s90 offen
    s_branch mega_kernel_e73
mega_kernel_e82:
    s_cmp_lg_u32 s60, 26
    s_cbranch_scc1 mega_kernel_e83
    s_waitcnt vmcnt(16)
    s_mov_b32 s3, 1048576
mega_kernel_spin84:
    v_cmp_ne_u64 s[72:73], s[4:5], v[4:5]
    s_nop 3
    s_cmp_eq_u64 s[72:73], 0
    s_cbranch_scc1 mega_kernel_e73
    s_sub_u32 s3, s3, 1
    s_cbranch_scc1 mega_kernel_e73
    s_sleep 32
    buffer_load_dwordx2 v[4:5], v10, s[8:11], 0 offen sc1
    s_waitcnt vmcnt(0)
    s_branch mega_kernel_spin84
    s_branch mega_kernel_e73
mega_kernel_e83:
mega_kernel_e73:
    s_cbranch_vccnz mega_kernel_rc85
mega_kernel_sp69:
    s_cmp_lg_u32 s60, s65
    s_cbranch_scc1 mega_kernel_dual66
    v_mfma_f32_16x16x32_bf16 v[64:67], a[192:195], a[128:131], v[160:163]
    s_bitcmp1_b64 s[58:59], s60
    s_cselect_b32 s62, -1.0, s61
    v_add_f32 v12, v12, v28
    v_mfma_f32_16x16x32_bf16 v[64:67], a[196:199], a[132:135], v[64:67]
    s_add_u32 s60, s60, 1
    ds_read_b128 a[224:227], v6 offset:16384
    v_exp_f32 v20, v96
    v_mfma_f32_16x16x32_bf16 v[64:67], a[200:203], a[136:139], v[64:67]
    s_mov_b32 m0, s55
    ds_read_b128 a[228:231], v6 offset:17408
    v_add_f32 v13, v13, v32
    v_mfma_f32_16x16x32_bf16 v[64:67], a[204:207], a[140:143], v[64:67]
    buffer_load_dwordx4 v7, s[24:27], s52 offen offset:0 sc1 lds
    v_mfma_f32_16x16x32_bf16 v[72:75], a[192:195], a[144:147], v[168:171]
    ds_read_b128 a[232:235], v6 offset:18432
    v_add_f32 v14, v14, v36
    v_mfma_f32_16x16x32_bf16 v[72:75], a[196:199], a[148:151], v[72:75]
    ds_read_b128 a[236:239], v6 offset:19456
    v_exp_f32 v21, v97
    v_mfma_f32_16x16x32_bf16 v[72:75], a[200:203], a[152:155], v[72:75]
    ds_read_b128 a[240:243], v6 offset:20480
    v_cvt_pk_bf16_f32 v144, v20, v21
    v_mfma_f32_16x16x32_bf16 v[72:75], a[204:207], a[156:159], v[72:75]
    s_waitcnt lgkmcnt(5)
    ds_read_b128 a[244:247], v6 offset:21504
    v_add_f32 v15, v15, v40
    v_mfma_f32_16x16x32_bf16 v[68:71], a[208:211], a[128:131], v[164:167]
    ds_read_b128 a[248:251], v6 offset:22528
    v_exp_f32 v22, v98
    v_mfma_f32_16x16x32_bf16 v[68:71], a[212:215], a[132:135], v[68:71]
    ds_read_b128 a[252:255], v6 offset:23552
    v_exp_f32 v23, v99
    v_mfma_f32_16x16x32_bf16 v[68:71], a[216:219], a[136:139], v[68:71]
    v_exp_f32 v24, v100
    v_mfma_f32_16x16x32_bf16 v[68:71], a[220:223], a[140:143], v[68:71]
    buffer_load_dwordx4 v7, s[24:27], s52 offen offset:1024 sc1 lds
    v_mfma_f32_16x16x32_bf16 v[76:79], a[208:211], a[144:147], v[172:175]
    v_cvt_pk_bf16_f32 v145, v22, v23
    v_exp_f32 v25, v101
    v_mfma_f32_16x16x32_bf16 v[76:79], a[212:215], a[148:151], v[76:79]
    v_exp_f32 v26, v102
    v_mfma_f32_16x16x32_bf16 v[76:79], a[216:219], a[152:155], v[76:79]
    v_cvt_pk_bf16_f32 v146, v24, v25
    v_exp_f32 v27, v103
    v_mfma_f32_16x16x32_bf16 v[76:79], a[220:223], a[156:159], v[76:79]
    s_waitcnt lgkmcnt(0)
    v_exp_f32 v20, v104
    v_mfma_f32_16x16x32_bf16 a[0:3], a[224:227], v[128:131], a[0:3]
    ds_read_b128 a[192:195], v6 offset:8192
    v_cvt_pk_bf16_f32 v147, v26, v27
    v_mfma_f32_16x16x32_bf16 a[32:35], a[224:227], v[132:135], a[32:35]
    v_exp_f32 v21, v105
    v_mfma_f32_16x16x32_bf16 v[28:31], v[44:47], v[144:147], 0
    v_exp_f32 v22, v106
    v_mfma_f32_16x16x32_bf16 a[64:67], a[224:227], v[136:139], a[64:67]
    v_cvt_pk_bf16_f32 v148, v20, v21
    v_exp_f32 v23, v107
    v_mfma_f32_16x16x32_bf16 a[96:99], a[224:227], v[140:143], a[96:99]
    ds_read_b128 a[196:199], v6 offset:9216
    v_cvt_pk_bf16_f32 v149, v22, v23
    v_mfma_f32_16x16x32_bf16 a[4:7], a[228:231], v[128:131], a[4:7]
    v_exp_f32 v24, v108
    v_mfma_f32_16x16x32_bf16 a[36:39], a[228:231], v[132:135], a[36:39]
    buffer_load_dwordx4 v7, s[24:27], s52 offen offset:2048 sc1 lds
    v_mfma_f32_16x16x32_bf16 a[68:71], a[228:231], v[136:139], a[68:71]
    ds_read_b128 a[200:203], v6 offset:10240
    v_exp_f32 v25, v109
    v_mfma_f32_16x16x32_bf16 a[100:103], a[228:231], v[140:143], a[100:103]
    v_exp_f32 v26, v110
    v_mfma_f32_16x16x32_bf16 a[8:11], a[232:235], v[128:131], a[8:11]
    v_cvt_pk_bf16_f32 v150, v24, v25
    v_exp_f32 v27, v111
    v_mfma_f32_16x16x32_bf16 a[40:43], a[232:235], v[132:135], a[40:43]
    ds_read_b128 a[204:207], v6 offset:11264
    v_cvt_pk_bf16_f32 v151, v26, v27
    v_mfma_f32_16x16x32_bf16 a[72:75], a[232:235], v[136:139], a[72:75]
    v_exp_f32 v20, v112
    v_mfma_f32_16x16x32_bf16 v[32:35], v[44:47], v[148:151], 0
    v_exp_f32 v21, v113
    v_mfma_f32_16x16x32_bf16 a[104:107], a[232:235], v[140:143], a[104:107]
    v_exp_f32 v22, v114
    v_mfma_f32_16x16x32_bf16 a[12:15], a[236:239], v[128:131], a[12:15]
    v_cvt_pk_bf16_f32 v152, v20, v21
    v_exp_f32 v23, v115
    v_mfma_f32_16x16x32_bf16 a[44:47], a[236:239], v[132:135], a[44:47]
    v_exp_f32 v24, v116
    v_mfma_f32_16x16x32_bf16 a[76:79], a[236:239], v[136:139], a[76:79]
    v_cvt_pk_bf16_f32 v153, v22, v23
    v_exp_f32 v25, v117
    v_mfma_f32_16x16x32_bf16 a[108:111], a[236:239], v[140:143], a[108:111]
    buffer_load_dwordx4 v7, s[24:27], s52 offen offset:3072 sc1 lds
    v_mfma_f32_16x16x32_bf16 a[16:19], a[240:243], v[128:131], a[16:19]
    s_add_u32 s52, s52, 16384
    v_exp_f32 v26, v118
    v_mfma_f32_16x16x32_bf16 a[48:51], a[240:243], v[132:135], a[48:51]
    v_cvt_pk_bf16_f32 v154, v24, v25
    v_exp_f32 v27, v119
    v_mfma_f32_16x16x32_bf16 a[80:83], a[240:243], v[136:139], a[80:83]
    v_exp_f32 v20, v120
    v_mfma_f32_16x16x32_bf16 a[112:115], a[240:243], v[140:143], a[112:115]
    v_cvt_pk_bf16_f32 v155, v26, v27
    v_exp_f32 v21, v121
    v_mfma_f32_16x16x32_bf16 a[20:23], a[244:247], v[128:131], a[20:23]
    v_exp_f32 v22, v122
    v_mfma_f32_16x16x32_bf16 v[36:39], v[44:47], v[152:155], 0
    v_cvt_pk_bf16_f32 v156, v20, v21
    v_mfma_f32_16x16x32_bf16 a[52:55], a[244:247], v[132:135], a[52:55]
    v_exp_f32 v23, v123
    v_mfma_f32_16x16x32_bf16 a[84:87], a[244:247], v[136:139], a[84:87]
    v_exp_f32 v24, v124
    v_cvt_pk_bf16_f32 v157, v22, v23
    v_mfma_f32_16x16x32_bf16 a[116:119], a[244:247], v[140:143], a[116:119]
    v_exp_f32 v25, v125
    v_mfma_f32_16x16x32_bf16 a[24:27], a[248:251], v[128:131], a[24:27]
    s_add_u32 m0, s55, 16384
    v_exp_f32 v26, v126
    v_mfma_f32_16x16x32_bf16 a[56:59], a[248:251], v[132:135], a[56:59]
    buffer_load_dwordx4 v7, s[28:31], s53 offen offset:0 sc1 lds
    v_mfma_f32_16x16x32_bf16 a[88:91], a[248:251], v[136:139], a[88:91]
    v_cvt_pk_bf16_f32 v158, v24, v25
    v_exp_f32 v27, v127
    v_mfma_f32_16x16x32_bf16 a[120:123], a[248:251], v[140:143], a[120:123]
    ds_read_b128 a[208:211], v6 offset:12288
    v_cvt_pk_bf16_f32 v159, v26, v27
    s_nop 1
    v_mfma_f32_16x16x32_bf16 v[40:43], v[44:47], v[156:159], 0
    s_nop 2
    v_mfma_f32_16x16x32_bf16 a[28:31], a[252:255], v[128:131], a[28:31]
    ds_read_b128 a[212:215], v6 offset:13312
    s_nop 0
    v_mfma_f32_16x16x32_bf16 a[60:63], a[252:255], v[132:135], a[60:63]
    ds_read_b128 a[216:219], v6 offset:14336
    v_max3_f32 v8, v28, v32, v36
    v_mfma_f32_16x16x32_bf16 a[92:95], a[252:255], v[136:139], a[92:95]
    ds_read_b128 a[220:223], v6 offset:15360
    v_max_f32 v8, v8, v40
    v_cmp_nge_f32 vcc, s62, v8
    v_mfma_f32_16x16x32_bf16 a[124:127], a[252:255], v[140:143], a[124:127]
    s_waitcnt lgkmcnt(4)
    s_cbranch_vccnz mega_kernel_stub86
mega_kernel_ret87:
    v_mfma_f32_16x16x32_bf16 v[96:99], a[192:195], a[128:131], v[160:163]
    s_add_u32 s55, s54, s56
    v_exp_f32 v20, v64
    v_mfma_f32_16x16x32_bf16 v[96:99], a[196:199], a[132:135], v[96:99]
    s_add_u32 s54, s54, 32768
    ds_read_b128 a[224:227], v6 offset:24576
    v_add_f32 v12, v12, v28
    v_mfma_f32_16x16x32_bf16 v[96:99], a[200:203], a[136:139], v[96:99]
    s_and_b32 s54, s54, 0x1ffff
    ds_read_b128 a[228:231], v6 offset:25600
    v_add_f32 v13, v13, v32
    v_mfma_f32_16x16x32_bf16 v[96:99], a[204:207], a[140:143], v[96:99]
    buffer_load_dwordx4 v7, s[28:31], s53 offen offset:1024 sc1 lds
    v_mfma_f32_16x16x32_bf16 v[104:107], a[192:195], a[144:147], v[168:171]
    s_bitcmp1_b64 s[58:59], s60
    s_cselect_b32 s62, -1.0, s61
    ds_read_b128 a[232:235], v6 offset:26624
    v_mfma_f32_16x16x32_bf16 v[104:107], a[196:199], a[148:151], v[104:107]
    s_add_u32 s60, s60, 1
    ds_read_b128 a[236:239], v6 offset:27648
    v_mfma_f32_16x16x32_bf16 v[104:107], a[200:203], a[152:155], v[104:107]
    ds_read_b128 a[240:243], v6 offset:28672
    v_mfma_f32_16x16x32_bf16 v[104:107], a[204:207], a[156:159], v[104:107]
    s_waitcnt lgkmcnt(5)
    ds_read_b128 a[244:247], v6 offset:29696
    v_mfma_f32_16x16x32_bf16 v[100:103], a[208:211], a[128:131], v[164:167]
    buffer_load_dwordx4 v7, s[28:31], s53 offen offset:2048 sc1 lds
    v_mfma_f32_16x16x32_bf16 v[100:103], a[212:215], a[132:135], v[100:103]
    ds_read_b128 a[248:251], v6 offset:30720
    v_mfma_f32_16x16x32_bf16 v[100:103], a[216:219], a[136:139], v[100:103]
    ds_read_b128 a[252:255], v6 offset:31744
    v_mfma_f32_16x16x32_bf16 v[100:103], a[220:223], a[140:143], v[100:103]
    v_exp_f32 v21, v65
    v_mfma_f32_16x16x32_bf16 v[108:111], a[208:211], a[144:147], v[172:175]
    v_exp_f32 v22, v66
    v_mfma_f32_16x16x32_bf16 v[108:111], a[212:215], a[148:151], v[108:111]
    buffer_load_dwordx4 v7, s[28:31], s53 offen offset:3072 sc1 lds
    v_mfma_f32_16x16x32_bf16 v[108:111], a[216:219], a[152:155], v[108:111]
    s_add_u32 s53, s53, 16384
    v_cvt_pk_bf16_f32 v128, v20, v21
    v_mfma_f32_16x16x32_bf16 v[108:111], a[220:223], a[156:159], v[108:111]
    s_waitcnt vmcnt(16) lgkmcnt(0)
    v_add_u32 v6, s54, v2
    v_mfma_f32_16x16x32_bf16 a[0:3], a[224:227], v[144:147], a[0:3]
    s_barrier
    v_mfma_f32_16x16x32_bf16 a[32:35], a[224:227], v[148:151], a[32:35]
    ds_read_b128 a[192:195], v6 offset:0
    v_mfma_f32_16x16x32_bf16 a[64:67], a[224:227], v[152:155], a[64:67]
    v_exp_f32 v23, v67
    v_mfma_f32_16x16x32_bf16 a[96:99], a[224:227], v[156:159], a[96:99]
    v_exp_f32 v24, v68
    v_mfma_f32_16x16x32_bf16 a[4:7], a[228:231], v[144:147], a[4:7]
    ds_read_b128 a[196:199], v6 offset:1024
    v_cvt_pk_bf16_f32 v129, v22, v23
    v_mfma_f32_16x16x32_bf16 a[36:39], a[228:231], v[148:151], a[36:39]
    v_exp_f32 v25, v69
    v_mfma_f32_16x16x32_bf16 a[68:71], a[228:231], v[152:155], a[68:71]
    v_exp_f32 v26, v70
    v_mfma_f32_16x16x32_bf16 a[100:103], a[228:231], v[156:159], a[100:103]
    ds_read_b128 a[200:203], v6 offset:2048
    v_cvt_pk_bf16_f32 v130, v24, v25
    v_mfma_f32_16x16x32_bf16 a[8:11], a[232:235], v[144:147], a[8:11]
    v_exp_f32 v27, v71
    v_mfma_f32_16x16x32_bf16 a[40:43], a[232:235], v[148:151], a[40:43]
    v_exp_f32 v20, v72
    v_mfma_f32_16x16x32_bf16 a[72:75], a[232:235], v[152:155], a[72:75]
    ds_read_b128 a[204:207], v6 offset:3072
    v_cvt_pk_bf16_f32 v131, v26, v27
    v_mfma_f32_16x16x32_bf16 a[104:107], a[232:235], v[156:159], a[104:107]
    v_exp_f32 v21, v73
    v_mfma_f32_16x16x32_bf16 v[28:31], v[44:47], v[128:131], 0
    v_exp_f32 v22, v74
    v_mfma_f32_16x16x32_bf16 a[12:15], a[236:239], v[144:147], a[12:15]
    v_cvt_pk_bf16_f32 v132, v20, v21
    v_mfma_f32_16x16x32_bf16 a[44:47], a[236:239], v[148:151], a[44:47]
    v_exp_f32 v23, v75
    v_mfma_f32_16x16x32_bf16 a[76:79], a[236:239], v[152:155], a[76:79]
    v_exp_f32 v24, v76
    v_mfma_f32_16x16x32_bf16 a[108:111], a[236:239], v[156:159], a[108:111]
    v_cvt_pk_bf16_f32 v133, v22, v23
    v_mfma_f32_16x16x32_bf16 a[16:19], a[240:243], v[144:147], a[16:19]
    v_exp_f32 v25, v77
    v_mfma_f32_16x16x32_bf16 a[48:51], a[240:243], v[148:151], a[48:51]
    v_exp_f32 v26, v78
    v_mfma_f32_16x16x32_bf16 a[80:83], a[240:243], v[152:155], a[80:83]
    v_cvt_pk_bf16_f32 v134, v24, v25
    v_mfma_f32_16x16x32_bf16 a[112:115], a[240:243], v[156:159], a[112:115]
    v_exp_f32 v27, v79
    v_mfma_f32_16x16x32_bf16 a[20:23], a[244:247], v[144:147], a[20:23]
    v_cvt_pk_bf16_f32 v135, v26, v27
    v_mfma_f32_16x16x32_bf16 a[52:55], a[244:247], v[148:151], a[52:55]
    v_mfma_f32_16x16x32_bf16 a[84:87], a[244:247], v[152:155], a[84:87]
    v_mfma_f32_16x16x32_bf16 v[32:35], v[44:47], v[132:135], 0
    s_nop 2
    v_mfma_f32_16x16x32_bf16 a[116:119], a[244:247], v[156:159], a[116:119]
    s_nop 2
    v_mfma_f32_16x16x32_bf16 a[24:27], a[248:251], v[144:147], a[24:27]
    v_max_f32 v8, v28, v32
    v_cmp_nge_f32 vcc, s62, v8
    v_mfma_f32_16x16x32_bf16 a[56:59], a[248:251], v[148:151], a[56:59]
    v_mfma_f32_16x16x32_bf16 a[88:91], a[248:251], v[152:155], a[88:91]
    v_mfma_f32_16x16x32_bf16 a[120:123], a[248:251], v[156:159], a[120:123]
    ds_read_b128 a[208:211], v6 offset:4096
    v_mfma_f32_16x16x32_bf16 a[28:31], a[252:255], v[144:147], a[28:31]
    ds_read_b128 a[212:215], v6 offset:5120
    v_mfma_f32_16x16x32_bf16 a[60:63], a[252:255], v[148:151], a[60:63]
    ds_read_b128 a[216:219], v6 offset:6144
    v_mfma_f32_16x16x32_bf16 a[92:95], a[252:255], v[152:155], a[92:95]
    ds_read_b128 a[220:223], v6 offset:7168
    v_mfma_f32_16x16x32_bf16 a[124:127], a[252:255], v[156:159], a[124:127]
    s_waitcnt lgkmcnt(4)
    s_cbranch_vccnz mega_kernel_stub88
mega_kernel_ret89:
    v_add_f32 v20, v14, v36
    v_add_f32 v21, v15, v40
    s_nop 3
    v_rcp_f32 v20, v20
    v_rcp_f32 v21, v21
    s_lshl_b32 s90, s75, 10
    s_add_u32 s90, s90, s78
    s_add_u32 s90, s90, 67108864
    v_accvgpr_read_b32 v48, a64
    v_accvgpr_read_b32 v49, a65
    v_accvgpr_read_b32 v50, a66
    v_accvgpr_read_b32 v51, a67
    v_accvgpr_read_b32 v52, a68
    v_accvgpr_read_b32 v53, a69
    v_accvgpr_read_b32 v54, a70
    v_accvgpr_read_b32 v55, a71
    v_mul_f32 v48, v20, v48
    v_mul_f32 v49, v20, v49
    v_mul_f32 v50, v20, v50
    v_mul_f32 v51, v20, v51
    v_mul_f32 v52, v20, v52
    v_mul_f32 v53, v20, v53
    v_mul_f32 v54, v20, v54
    v_mul_f32 v55, v20, v55
    v_cvt_pk_bf16_f32 v48, v48, v49
    v_cvt_pk_bf16_f32 v49, v50, v51
    v_cvt_pk_bf16_f32 v50, v52, v53
    v_cvt_pk_bf16_f32 v51, v54, v55
    buffer_store_dwordx4 v[48:51], v2, s[8:11], s90 offen offset:0 sc1
    v_accvgpr_read_b32 v56, a96
    v_accvgpr_read_b32 v57, a97
    v_accvgpr_read_b32 v58, a98
    v_accvgpr_read_b32 v59, a99
    v_accvgpr_read_b32 v60, a100
    v_accvgpr_read_b32 v61, a101
    v_accvgpr_read_b32 v62, a102
    v_accvgpr_read_b32 v63, a103
    v_mul_f32 v56, v21, v56
    v_mul_f32 v57, v21, v57
    v_mul_f32 v58, v21, v58
    v_mul_f32 v59, v21, v59
    v_mul_f32 v60, v21, v60
    v_mul_f32 v61, v21, v61
    v_mul_f32 v62, v21, v62
    v_mul_f32 v63, v21, v63
    v_cvt_pk_bf16_f32 v56, v56, v57
    v_cvt_pk_bf16_f32 v57, v58, v59
    v_cvt_pk_bf16_f32 v58, v60, v61
    v_cvt_pk_bf16_f32 v59, v62, v63
    buffer_store_dwordx4 v[56:59], v2, s[8:11], s90 offen offset:1024 sc1
    s_add_u32 s90, s90, 131072
    v_accvgpr_read_b32 v48, a72
    v_accvgpr_read_b32 v49, a73
    v_accvgpr_read_b32 v50, a74
    v_accvgpr_read_b32 v51, a75
    v_accvgpr_read_b32 v52, a76
    v_accvgpr_read_b32 v53, a77
    v_accvgpr_read_b32 v54, a78
    v_accvgpr_read_b32 v55, a79
    v_mul_f32 v48, v20, v48
    v_mul_f32 v49, v20, v49
    v_mul_f32 v50, v20, v50
    v_mul_f32 v51, v20, v51
    v_mul_f32 v52, v20, v52
    v_mul_f32 v53, v20, v53
    v_mul_f32 v54, v20, v54
    v_mul_f32 v55, v20, v55
    v_cvt_pk_bf16_f32 v48, v48, v49
    v_cvt_pk_bf16_f32 v49, v50, v51
    v_cvt_pk_bf16_f32 v50, v52, v53
    v_cvt_pk_bf16_f32 v51, v54, v55
    buffer_store_dwordx4 v[48:51], v2, s[8:11], s90 offen offset:0 sc1
    v_accvgpr_read_b32 v56, a104
    v_accvgpr_read_b32 v57, a105
    v_accvgpr_read_b32 v58, a106
    v_accvgpr_read_b32 v59, a107
    v_accvgpr_read_b32 v60, a108
    v_accvgpr_read_b32 v61, a109
    v_accvgpr_read_b32 v62, a110
    v_accvgpr_read_b32 v63, a111
    v_mul_f32 v56, v21, v56
    v_mul_f32 v57, v21, v57
    v_mul_f32 v58, v21, v58
    v_mul_f32 v59, v21, v59
    v_mul_f32 v60, v21, v60
    v_mul_f32 v61, v21, v61
    v_mul_f32 v62, v21, v62
    v_mul_f32 v63, v21, v63
    v_cvt_pk_bf16_f32 v56, v56, v57
    v_cvt_pk_bf16_f32 v57, v58, v59
    v_cvt_pk_bf16_f32 v58, v60, v61
    v_cvt_pk_bf16_f32 v59, v62, v63
    buffer_store_dwordx4 v[56:59], v2, s[8:11], s90 offen offset:1024 sc1
    s_add_u32 s90, s90, 131072
    v_accvgpr_read_b32 v48, a80
    v_accvgpr_read_b32 v49, a81
    v_accvgpr_read_b32 v50, a82
    v_accvgpr_read_b32 v51, a83
    v_accvgpr_read_b32 v52, a84
    v_accvgpr_read_b32 v53, a85
    v_accvgpr_read_b32 v54, a86
    v_accvgpr_read_b32 v55, a87
    v_mul_f32 v48, v20, v48
    v_mul_f32 v49, v20, v49
    v_mul_f32 v50, v20, v50
    v_mul_f32 v51, v20, v51
    v_mul_f32 v52, v20, v52
    v_mul_f32 v53, v20, v53
    v_mul_f32 v54, v20, v54
    v_mul_f32 v55, v20, v55
    v_cvt_pk_bf16_f32 v48, v48, v49
    v_cvt_pk_bf16_f32 v49, v50, v51
    v_cvt_pk_bf16_f32 v50, v52, v53
    v_cvt_pk_bf16_f32 v51, v54, v55
    buffer_store_dwordx4 v[48:51], v2, s[8:11], s90 offen offset:0 sc1
    v_accvgpr_read_b32 v56, a112
    v_accvgpr_read_b32 v57, a113
    v_accvgpr_read_b32 v58, a114
    v_accvgpr_read_b32 v59, a115
    v_accvgpr_read_b32 v60, a116
    v_accvgpr_read_b32 v61, a117
    v_accvgpr_read_b32 v62, a118
    v_accvgpr_read_b32 v63, a119
    v_mul_f32 v56, v21, v56
    v_mul_f32 v57, v21, v57
    v_mul_f32 v58, v21, v58
    v_mul_f32 v59, v21, v59
    v_mul_f32 v60, v21, v60
    v_mul_f32 v61, v21, v61
    v_mul_f32 v62, v21, v62
    v_mul_f32 v63, v21, v63
    v_cvt_pk_bf16_f32 v56, v56, v57
    v_cvt_pk_bf16_f32 v57, v58, v59
    v_cvt_pk_bf16_f32 v58, v60, v61
    v_cvt_pk_bf16_f32 v59, v62, v63
    buffer_store_dwordx4 v[56:59], v2, s[8:11], s90 offen offset:1024 sc1
    s_add_u32 s90, s90, 131072
    v_accvgpr_read_b32 v48, a88
    v_accvgpr_read_b32 v49, a89
    v_accvgpr_read_b32 v50, a90
    v_accvgpr_read_b32 v51, a91
    v_accvgpr_read_b32 v52, a92
    v_accvgpr_read_b32 v53, a93
    v_accvgpr_read_b32 v54, a94
    v_accvgpr_read_b32 v55, a95
    v_mul_f32 v48, v20, v48
    v_mul_f32 v49, v20, v49
    v_mul_f32 v50, v20, v50
    v_mul_f32 v51, v20, v51
    v_mul_f32 v52, v20, v52
    v_mul_f32 v53, v20, v53
    v_mul_f32 v54, v20, v54
    v_mul_f32 v55, v20, v55
    v_cvt_pk_bf16_f32 v48, v48, v49
    v_cvt_pk_bf16_f32 v49, v50, v51
    v_cvt_pk_bf16_f32 v50, v52, v53
    v_cvt_pk_bf16_f32 v51, v54, v55
    buffer_store_dwordx4 v[48:51], v2, s[8:11], s90 offen offset:0 sc1
    v_accvgpr_read_b32 v56, a120
    v_accvgpr_read_b32 v57, a121
    v_accvgpr_read_b32 v58, a122
    v_accvgpr_read_b32 v59, a123
    v_accvgpr_read_b32 v60, a124
    v_accvgpr_read_b32 v61, a125
    v_accvgpr_read_b32 v62, a126
    v_accvgpr_read_b32 v63, a127
    v_mul_f32 v56, v21, v56
    v_mul_f32 v57, v21, v57
    v_mul_f32 v58, v21, v58
    v_mul_f32 v59, v21, v59
    v_mul_f32 v60, v21, v60
    v_mul_f32 v61, v21, v61
    v_mul_f32 v62, v21, v62
    v_mul_f32 v63, v21, v63
    v_cvt_pk_bf16_f32 v56, v56, v57
    v_cvt_pk_bf16_f32 v57, v58, v59
    v_cvt_pk_bf16_f32 v58, v60, v61
    v_cvt_pk_bf16_f32 v59, v62, v63
    buffer_store_dwordx4 v[56:59], v2, s[8:11], s90 offen offset:1024 sc1
    s_add_u32 s90, s90, 131072
mega_kernel_single90:
    v_mfma_f32_16x16x32_bf16 v[64:67], a[192:195], a[128:131], v[160:163]
    s_bitcmp1_b64 s[58:59], s60
    s_cselect_b32 s62, -1.0, s61
    v_add_f32 v12, v12, v28
    v_mfma_f32_16x16x32_bf16 v[64:67], a[196:199], a[132:135], v[64:67]
    s_mov_b32 m0, s55
    ds_read_b128 a[224:227], v6 offset:16384
    v_add_f32 v13, v13, v32
    v_mfma_f32_16x16x32_bf16 v[64:67], a[200:203], a[136:139], v[64:67]
    buffer_load_dwordx4 v7, s[24:27], s52 offen offset:0 sc1 lds
    v_mfma_f32_16x16x32_bf16 v[64:67], a[204:207], a[140:143], v[64:67]
    s_add_u32 s60, s60, 1
    ds_read_b128 a[228:231], v6 offset:17408
    v_exp_f32 v20, v96
    v_mfma_f32_16x16x32_bf16 v[72:75], a[192:195], a[144:147], v[168:171]
    ds_read_b128 a[232:235], v6 offset:18432
    v_exp_f32 v21, v97
    v_mfma_f32_16x16x32_bf16 v[72:75], a[196:199], a[148:151], v[72:75]
    ds_read_b128 a[236:239], v6 offset:19456
    v_cvt_pk_bf16_f32 v144, v20, v21
    v_mfma_f32_16x16x32_bf16 v[72:75], a[200:203], a[152:155], v[72:75]
    ds_read_b128 a[240:243], v6 offset:20480
    v_exp_f32 v22, v98
    v_mfma_f32_16x16x32_bf16 v[72:75], a[204:207], a[156:159], v[72:75]
    s_waitcnt lgkmcnt(5)
    ds_read_b128 a[244:247], v6 offset:21504
    v_mfma_f32_16x16x32_bf16 v[68:71], a[208:211], a[128:131], v[164:167]
    ds_read_b128 a[248:251], v6 offset:22528
    v_exp_f32 v23, v99
    v_mfma_f32_16x16x32_bf16 v[68:71], a[212:215], a[132:135], v[68:71]
    ds_read_b128 a[252:255], v6 offset:23552
    v_cvt_pk_bf16_f32 v145, v22, v23
    v_mfma_f32_16x16x32_bf16 v[68:71], a[216:219], a[136:139], v[68:71]
    buffer_load_dwordx4 v7, s[24:27], s52 offen offset:1024 sc1 lds
    v_mfma_f32_16x16x32_bf16 v[68:71], a[220:223], a[140:143], v[68:71]
    v_exp_f32 v24, v100
    v_mfma_f32_16x16x32_bf16 v[76:79], a[208:211], a[144:147], v[172:175]
    v_exp_f32 v25, v101
    v_mfma_f32_16x16x32_bf16 v[76:79], a[212:215], a[148:151], v[76:79]
    v_exp_f32 v26, v102
    v_mfma_f32_16x16x32_bf16 v[76:79], a[216:219], a[152:155], v[76:79]
    buffer_load_dwordx4 v7, s[24:27], s52 offen offset:2048 sc1 lds
    v_cvt_pk_bf16_f32 v146, v24, v25
    v_mfma_f32_16x16x32_bf16 v[76:79], a[220:223], a[156:159], v[76:79]
    s_waitcnt lgkmcnt(0)
    v_exp_f32 v27, v103
    v_mfma_f32_16x16x32_bf16 a[0:3], a[224:227], v[128:131], a[0:3]
    ds_read_b128 a[192:195], v6 offset:8192
    v_cvt_pk_bf16_f32 v147, v26, v27
    v_mfma_f32_16x16x32_bf16 a[32:35], a[224:227], v[132:135], a[32:35]
    v_exp_f32 v20, v104
    v_mfma_f32_16x16x32_bf16 v[28:31], v[44:47], v[144:147], 0
    v_exp_f32 v21, v105
    v_mfma_f32_16x16x32_bf16 a[4:7], a[228:231], v[128:131], a[4:7]
    ds_read_b128 a[196:199], v6 offset:9216
    v_exp_f32 v22, v106
    v_mfma_f32_16x16x32_bf16 a[36:39], a[228:231], v[132:135], a[36:39]
    buffer_load_dwordx4 v7, s[24:27], s52 offen offset:3072 sc1 lds
    v_mfma_f32_16x16x32_bf16 a[8:11], a[232:235], v[128:131], a[8:11]
    s_add_u32 s52, s52, 16384
    ds_read_b128 a[200:203], v6 offset:10240
    v_cvt_pk_bf16_f32 v148, v20, v21
    v_mfma_f32_16x16x32_bf16 a[40:43], a[232:235], v[132:135], a[40:43]
    v_exp_f32 v23, v107
    v_mfma_f32_16x16x32_bf16 a[12:15], a[236:239], v[128:131], a[12:15]
    ds_read_b128 a[204:207], v6 offset:11264
    v_exp_f32 v24, v108
    v_mfma_f32_16x16x32_bf16 a[44:47], a[236:239], v[132:135], a[44:47]
    v_cvt_pk_bf16_f32 v149, v22, v23
    v_exp_f32 v25, v109
    v_mfma_f32_16x16x32_bf16 a[16:19], a[240:243], v[128:131], a[16:19]
    v_exp_f32 v26, v110
    v_mfma_f32_16x16x32_bf16 a[48:51], a[240:243], v[132:135], a[48:51]
    v_cvt_pk_bf16_f32 v150, v24, v25
    v_exp_f32 v27, v111
    v_mfma_f32_16x16x32_bf16 a[20:23], a[244:247], v[128:131], a[20:23]
    ds_read_b128 a[208:211], v6 offset:12288
    v_cvt_pk_bf16_f32 v151, v26, v27
    v_mfma_f32_16x16x32_bf16 a[52:55], a[244:247], v[132:135], a[52:55]
    s_add_u32 m0, s55, 16384
    ds_read_b128 a[212:215], v6 offset:13312
    v_mfma_f32_16x16x32_bf16 v[32:35], v[44:47], v[148:151], 0
    s_nop 2
    v_mfma_f32_16x16x32_bf16 a[24:27], a[248:251], v[128:131], a[24:27]
    buffer_load_dwordx4 v7, s[28:31], s53 offen offset:0 sc1 lds
    v_mfma_f32_16x16x32_bf16 a[56:59], a[248:251], v[132:135], a[56:59]
    ds_read_b128 a[216:219], v6 offset:14336
    s_nop 0
    v_mfma_f32_16x16x32_bf16 a[28:31], a[252:255], v[128:131], a[28:31]
    ds_read_b128 a[220:223], v6 offset:15360
    v_max_f32 v8, v28, v32
    v_cmp_nge_f32 vcc, s62, v8
    v_mfma_f32_16x16x32_bf16 a[60:63], a[252:255], v[132:135], a[60:63]
    s_waitcnt lgkmcnt(4)
    s_cbranch_vccnz mega_kernel_stub91
mega_kernel_ret92:
    v_mfma_f32_16x16x32_bf16 v[96:99], a[192:195], a[128:131], v[160:163]
    s_add_u32 s55, s54, s56
    v_exp_f32 v20, v64
    v_mfma_f32_16x16x32_bf16 v[96:99], a[196:199], a[132:135], v[96:99]
    s_add_u32 s54, s54, 32768
    ds_read_b128 a[224:227], v6 offset:24576
    v_add_f32 v12, v12, v28
    v_mfma_f32_16x16x32_bf16 v[96:99], a[200:203], a[136:139], v[96:99]
    s_and_b32 s54, s54, 0x1ffff
    ds_read_b128 a[228:231], v6 offset:25600
    v_exp_f32 v21, v65
    v_mfma_f32_16x16x32_bf16 v[96:99], a[204:207], a[140:143], v[96:99]
    s_bitcmp1_b64 s[58:59], s60
    s_cselect_b32 s62, -1.0, s61
    ds_read_b128 a[232:235], v6 offset:26624
    v_mfma_f32_16x16x32_bf16 v[104:107], a[192:195], a[144:147], v[168:171]
    buffer_load_dwordx4 v7, s[28:31], s53 offen offset:1024 sc1 lds
    v_mfma_f32_16x16x32_bf16 v[104:107], a[196:199], a[148:151], v[104:107]
    s_add_u32 s60, s60, 1
    ds_read_b128 a[236:239], v6 offset:27648
    v_cvt_pk_bf16_f32 v128, v20, v21
    v_mfma_f32_16x16x32_bf16 v[104:107], a[200:203], a[152:155], v[104:107]
    ds_read_b128 a[240:243], v6 offset:28672
    v_exp_f32 v22, v66
    v_mfma_f32_16x16x32_bf16 v[104:107], a[204:207], a[156:159], v[104:107]
    s_waitcnt lgkmcnt(5)
    ds_read_b128 a[244:247], v6 offset:29696
    v_add_f32 v13, v13, v32
    v_mfma_f32_16x16x32_bf16 v[100:103], a[208:211], a[128:131], v[164:167]
    ds_read_b128 a[248:251], v6 offset:30720
    v_exp_f32 v23, v67
    v_mfma_f32_16x16x32_bf16 v[100:103], a[212:215], a[132:135], v[100:103]
    buffer_load_dwordx4 v7, s[28:31], s53 offen offset:2048 sc1 lds
    v_mfma_f32_16x16x32_bf16 v[100:103], a[216:219], a[136:139], v[100:103]
    ds_read_b128 a[252:255], v6 offset:31744
    v_cvt_pk_bf16_f32 v129, v22, v23
    v_mfma_f32_16x16x32_bf16 v[100:103], a[220:223], a[140:143], v[100:103]
    v_exp_f32 v24, v68
    v_mfma_f32_16x16x32_bf16 v[108:111], a[208:211], a[144:147], v[172:175]
    v_exp_f32 v25, v69
    v_mfma_f32_16x16x32_bf16 v[108:111], a[212:215], a[148:151], v[108:111]
    buffer_load_dwordx4 v7, s[28:31], s53 offen offset:3072 sc1 lds
    v_mfma_f32_16x16x32_bf16 v[108:111], a[216:219], a[152:155], v[108:111]
    s_add_u32 s53, s53, 16384
    v_exp_f32 v26, v70
    v_cvt_pk_bf16_f32 v130, v24, v25
    v_mfma_f32_16x16x32_bf16 v[108:111], a[220:223], a[156:159], v[108:111]
    s_waitcnt vmcnt(16) lgkmcnt(0)
    v_add_u32 v6, s54, v2
    v_exp_f32 v27, v71
    v_mfma_f32_16x16x32_bf16 a[0:3], a[224:227], v[144:147], a[0:3]
    s_barrier
    v_mfma_f32_16x16x32_bf16 a[32:35], a[224:227], v[148:151], a[32:35]
    ds_read_b128 a[192:195], v6 offset:0
    v_cvt_pk_bf16_f32 v131, v26, v27
    v_mfma_f32_16x16x32_bf16 a[4:7], a[228:231], v[144:147], a[4:7]
    v_exp_f32 v20, v72
    v_mfma_f32_16x16x32_bf16 v[28:31], v[44:47], v[128:131], 0
    v_exp_f32 v21, v73
    v_mfma_f32_16x16x32_bf16 a[36:39], a[228:231], v[148:151], a[36:39]
    ds_read_b128 a[196:199], v6 offset:1024
    v_cvt_pk_bf16_f32 v132, v20, v21
    v_mfma_f32_16x16x32_bf16 a[8:11], a[232:235], v[144:147], a[8:11]
    v_exp_f32 v22, v74
    v_mfma_f32_16x16x32_bf16 a[40:43], a[232:235], v[148:151], a[40:43]
    ds_read_b128 a[200:203], v6 offset:2048
    v_exp_f32 v23, v75
    v_mfma_f32_16x16x32_bf16 a[12:15], a[236:239], v[144:147], a[12:15]
    v_exp_f32 v24, v76
    v_mfma_f32_16x16x32_bf16 a[44:47], a[236:239], v[148:151], a[44:47]
    ds_read_b128 a[204:207], v6 offset:3072
    v_cvt_pk_bf16_f32 v133, v22, v23
    v_mfma_f32_16x16x32_bf16 a[16:19], a[240:243], v[144:147], a[16:19]
    v_exp_f32 v25, v77
    v_mfma_f32_16x16x32_bf16 a[48:51], a[240:243], v[148:151], a[48:51]
    v_exp_f32 v26, v78
    v_cvt_pk_bf16_f32 v134, v24, v25
    v_mfma_f32_16x16x32_bf16 a[20:23], a[244:247], v[144:147], a[20:23]
    v_exp_f32 v27, v79
    v_mfma_f32_16x16x32_bf16 a[52:55], a[244:247], v[148:151], a[52:55]
    ds_read_b128 a[208:211], v6 offset:4096
    v_cvt_pk_bf16_f32 v135, v26, v27
    s_nop 1
    v_mfma_f32_16x16x32_bf16 v[32:35], v[44:47], v[132:135], 0
    s_nop 2
    v_mfma_f32_16x16x32_bf16 a[24:27], a[248:251], v[144:147], a[24:27]
    ds_read_b128 a[212:215], v6 offset:5120
    s_nop 0
    v_mfma_f32_16x16x32_bf16 a[56:59], a[248:251], v[148:151], a[56:59]
    ds_read_b128 a[216:219], v6 offset:6144
    v_max_f32 v8, v28, v32
    v_mfma_f32_16x16x32_bf16 a[28:31], a[252:255], v[144:147], a[28:31]
    ds_read_b128 a[220:223], v6 offset:7168
    v_cmp_nge_f32 vcc, s62, v8
    v_mfma_f32_16x16x32_bf16 a[60:63], a[252:255], v[148:151], a[60:63]
    s_waitcnt lgkmcnt(4)
    s_cbranch_vccz mega_kernel_single90
    v_cmp_lt_f32 vcc, s61, v8
    s_cmp_lg_u32 s60, s66
    s_cbranch_scc1 mega_kernel_e94
    v_add_f32 v160, v160, v16
    v_mov_b32 v164, v9
    v_add_f32 v172, v172, v16
    v_add_f32 v161, v161, v17
    v_mov_b32 v165, v9
    v_add_f32 v173, v173, v17
    v_add_f32 v162, v162, v18
    v_mov_b32 v166, v9
    v_add_f32 v174, v174, v18
    v_add_f32 v163, v163, v19
    v_mov_b32 v167, v9
    v_add_f32 v175, v175, v19
    s_nop 0
mega_kernel_e94:
    s_cmp_lg_u32 s60, s67
    s_cbranch_scc1 mega_kernel_e95
    v_mov_b32 v160, v9
    v_mov_b32 v168, v9
    v_mov_b32 v172, v9
    v_mov_b32 v161, v9
    v_mov_b32 v169, v9
    v_mov_b32 v173, v9
    v_mov_b32 v162, v9
    v_mov_b32 v170, v9
    v_mov_b32 v174, v9
    v_mov_b32 v163, v9
    v_mov_b32 v171, v9
    v_mov_b32 v175, v9
    s_nop 0
mega_kernel_e95:
    s_cmp_gt_u32 s60, 26
    s_cbranch_scc1 mega_kernel_e96
    s_cmp_lg_u32 s60, 4
    s_cbranch_scc1 mega_kernel_e98
    buffer_store_dwordx4 v[224:227], v2, s[36:39], s40 offen sc1
    s_add_u32 s40, s40, s100
    buffer_store_dwordx4 v[228:231], v2, s[36:39], s40 offen sc1
    s_add_u32 s40, s40, s100
    buffer_store_dwordx4 v[232:235], v2, s[36:39], s40 offen sc1
    s_add_u32 s40, s40, s100
    buffer_store_dwordx4 v[236:239], v2, s[36:39], s40 offen sc1
    s_mov_b32 s40, s98
    s_branch mega_kernel_e96
mega_kernel_e98:
    s_cmp_lg_u32 s60, 6
    s_cbranch_scc1 mega_kernel_e99
    buffer_store_dwordx4 v[240:243], v2, s[36:39], s40 offen sc1
    s_add_u32 s40, s40, s100
    buffer_store_dwordx4 v[244:247], v2, s[36:39], s40 offen sc1
    s_add_u32 s40, s40, s100
    buffer_store_dwordx4 v[248:251], v2, s[36:39], s40 offen sc1
    s_add_u32 s40, s40, s100
    buffer_store_dwordx4 v[252:255], v2, s[36:39], s40 offen sc1
    s_add_u32 s40, s40, s100
    s_branch mega_kernel_e96
mega_kernel_e99:
    s_cmp_lg_u32 s60, 10
    s_cbranch_scc1 mega_kernel_e100
    s_cmp_eq_u32 s17, -1
    s_cbranch_scc1 mega_kernel_e96
    s_cmp_lg_u32 s16, 0
    s_cbranch_scc1 mega_kernel_np101
    v_mov_b32 v4, s4
    v_mov_b32 v5, s5
    s_add_u32 s90, s17, 117440512
    s_mov_b64 exec, 1
    buffer_store_dwordx2 v[4:5], off, s[8:11], s90 sc1
    s_mov_b64 exec, -1
mega_kernel_np101:
    s_branch mega_kernel_e96
mega_kernel_e100:
    s_cmp_lg_u32 s60, 14
    s_cbranch_scc1 mega_kernel_e102
    s_lshr_b32 s90, s32, 1
    s_lshl_b32 s90, s90, 7
    s_add_u32 s90, s90, 117442560
    v_min_u32 v0, 1, v1
    v_lshlrev_b32 v0, 3, v0
    buffer_load_dwordx2 v[4:5], v0, s[8:11], s90 offen sc1
    s_mov_b32 s44, s48
    s_mov_b32 s45, s49
    s_mov_b32 s46, 8388608
    s_lshl_b32 s90, s2, 2
    s_add_u32 s90, s90, s16
    s_lshl_b32 s90, s90, 13
    v_lshlrev_b32 v62, 7, v1
    buffer_load_dword v255, v62, s[44:47], s90 offen
    s_branch mega_kernel_e96
mega_kernel_e102:
    s_cmp_lg_u32 s60, 18
    s_cbranch_scc1 mega_kernel_e103
    s_waitcnt vmcnt(16)
    s_mov_b32 s3, 1048576
mega_kernel_spin104:
    v_cmp_ne_u64 s[72:73], s[4:5], v[4:5]
    s_nop 3
    s_cmp_eq_u64 s[72:73], 0
    s_cbranch_scc1 mega_kernel_e96
    s_sub_u32 s3, s3, 1
    s_cbranch_scc1 mega_kernel_e96
    s_sleep 32
    s_lshr_b32 s90, s32, 1
    s_lshl_b32 s90, s90, 7
    s_add_u32 s90, s90, 117442560
    v_min_u32 v0, 1, v1
    v_lshlrev_b32 v0, 3, v0
    buffer_load_dwordx2 v[4:5], v0, s[8:11], s90 offen sc1
    s_waitcnt vmcnt(0)
    s_branch mega_kernel_spin104
    s_branch mega_kernel_e96
mega_kernel_e103:
    s_cmp_lg_u32 s60, 22
    s_cbranch_scc1 mega_kernel_e105
    buffer_load_dwordx2 v[4:5], v10, s[8:11], 0 offen sc1
    s_mov_b32 s44, s50
    s_mov_b32 s45, s51
    s_mov_b32 s46, 2097152
    s_lshl_b32 s90, s2, 2
    s_add_u32 s90, s90, s16
    s_lshl_b32 s90, s90, 13
    v_lshlrev_b32 v62, 7, v1
    buffer_load_dword v255, v62, s[44:47], s90 offen
    s_branch mega_kernel_e96
mega_kernel_e105:
    s_cmp_lg_u32 s60, 26
    s_cbranch_scc1 mega_kernel_e106
    s_waitcnt vmcnt(16)
    s_mov_b32 s3, 1048576
mega_kernel_spin107:
    v_cmp_ne_u64 s[72:73], s[4:5], v[4:5]
    s_nop 3
    s_cmp_eq_u64 s[72:73], 0
    s_cbranch_scc1 mega_kernel_e96
    s_sub_u32 s3, s3, 1
    s_cbranch_scc1 mega_kernel_e96
    s_sleep 32
    buffer_load_dwordx2 v[4:5], v10, s[8:11], 0 offen sc1
    s_waitcnt vmcnt(0)
    s_branch mega_kernel_spin107
    s_branch mega_kernel_e96
mega_kernel_e106:
mega_kernel_e96:
    s_cbranch_vccnz mega_kernel_rc108
mega_kernel_sp93:
    s_cmp_lg_u32 s60, s68
    s_cbranch_scc1 mega_kernel_single90
    ds_read_b128 a[224:227], v6 offset:16384
    ds_read_b128 a[228:231], v6 offset:17408
    ds_read_b128 a[232:235], v6 offset:18432
    ds_read_b128 a[236:239], v6 offset:19456
    ds_read_b128 a[240:243], v6 offset:20480
    ds_read_b128 a[244:247], v6 offset:21504
    ds_read_b128 a[248:251], v6 offset:22528
    ds_read_b128 a[252:255], v6 offset:23552
    s_waitcnt lgkmcnt(0)
    v_mfma_f32_16x16x32_bf16 a[0:3], a[224:227], v[128:131], a[0:3]
    buffer_load_dwordx4 v[192:195], v2, s[8:11], s79 offen offset:0 sc1
    v_exp_f32 v20, v96
    v_mfma_f32_16x16x32_bf16 a[32:35], a[224:227], v[132:135], a[32:35]
    v_exp_f32 v21, v97
    v_exp_f32 v22, v98
    v_mfma_f32_16x16x32_bf16 a[4:7], a[228:231], v[128:131], a[4:7]
    buffer_load_dwordx4 v[196:199], v2, s[8:11], s79 offen offset:1024 sc1
    v_cvt_pk_bf16_f32 v144, v20, v21
    v_add_f32 v12, v12, v28
    v_mfma_f32_16x16x32_bf16 a[36:39], a[228:231], v[132:135], a[36:39]
    v_exp_f32 v23, v99
    v_exp_f32 v24, v100
    v_cvt_pk_bf16_f32 v145, v22, v23
    v_mfma_f32_16x16x32_bf16 a[8:11], a[232:235], v[128:131], a[8:11]
    buffer_load_dwordx4 v[200:203], v2, s[8:11], s79 offen offset:2048 sc1
    v_exp_f32 v25, v101
    v_mfma_f32_16x16x32_bf16 a[40:43], a[232:235], v[132:135], a[40:43]
    v_exp_f32 v26, v102
    v_cvt_pk_bf16_f32 v146, v24, v25
    v_add_f32 v13, v13, v32
    v_mfma_f32_16x16x32_bf16 a[12:15], a[236:239], v[128:131], a[12:15]
    buffer_load_dwordx4 v[204:207], v2, s[8:11], s79 offen offset:3072 sc1
    v_exp_f32 v27, v103
    v_mfma_f32_16x16x32_bf16 a[44:47], a[236:239], v[132:135], a[44:47]
    v_exp_f32 v20, v104
    v_cvt_pk_bf16_f32 v147, v26, v27
    v_mfma_f32_16x16x32_bf16 a[16:19], a[240:243], v[128:131], a[16:19]
    buffer_load_dwordx4 v[212:215], v2, s[8:11], s80 offen offset:0 sc1
    v_exp_f32 v21, v105
    v_mfma_f32_16x16x32_bf16 v[28:31], v[44:47], v[144:147], 0
    v_exp_f32 v22, v106
    v_cvt_pk_bf16_f32 v148, v20, v21
    v_exp_f32 v23, v107
    v_mfma_f32_16x16x32_bf16 a[48:51], a[240:243], v[132:135], a[48:51]
    v_exp_f32 v24, v108
    v_cvt_pk_bf16_f32 v149, v22, v23
    v_exp_f32 v25, v109
    v_mfma_f32_16x16x32_bf16 a[20:23], a[244:247], v[128:131], a[20:23]
    buffer_load_dwordx4 v[216:219], v2, s[8:11], s80 offen offset:1024 sc1
    v_exp_f32 v26, v110
    v_mfma_f32_16x16x32_bf16 a[52:55], a[244:247], v[132:135], a[52:55]
    v_cvt_pk_bf16_f32 v150, v24, v25
    v_exp_f32 v27, v111
    s_nop 0
    v_cvt_pk_bf16_f32 v151, v26, v27
    s_nop 1
    v_mfma_f32_16x16x32_bf16 v[32:35], v[44:47], v[148:151], 0
    s_nop 2
    v_mfma_f32_16x16x32_bf16 a[24:27], a[248:251], v[128:131], a[24:27]
    buffer_load_dwordx4 v[220:223], v2, s[8:11], s80 offen offset:2048 sc1
    v_mfma_f32_16x16x32_bf16 a[56:59], a[248:251], v[132:135], a[56:59]
    s_nop 2
    v_mfma_f32_16x16x32_bf16 a[28:31], a[252:255], v[128:131], a[28:31]
    v_max_f32 v8, v28, v32
    v_cmp_nge_f32 vcc, s61, v8
    v_mfma_f32_16x16x32_bf16 a[60:63], a[252:255], v[132:135], a[60:63]
    s_cbranch_vccnz mega_kernel_stub109
mega_kernel_ret110:
    s_nop 1
    ds_read_b128 a[224:227], v6 offset:24576
    ds_read_b128 a[228:231], v6 offset:25600
    ds_read_b128 a[232:235], v6 offset:26624
    ds_read_b128 a[236:239], v6 offset:27648
    ds_read_b128 a[240:243], v6 offset:28672
    ds_read_b128 a[244:247], v6 offset:29696
    ds_read_b128 a[248:251], v6 offset:30720
    ds_read_b128 a[252:255], v6 offset:31744
    s_waitcnt lgkmcnt(0)
    v_mfma_f32_16x16x32_bf16 a[0:3], a[224:227], v[144:147], a[0:3]
    buffer_load_dwordx4 v[224:227], v2, s[8:11], s80 offen offset:3072 sc1
    v_mfma_f32_16x16x32_bf16 a[32:35], a[224:227], v[148:151], a[32:35]
    v_mfma_f32_16x16x32_bf16 a[4:7], a[228:231], v[144:147], a[4:7]
    buffer_load_dwordx4 v[208:211], v2, s[8:11], s81 offen offset:0 sc1
    v_mfma_f32_16x16x32_bf16 a[36:39], a[228:231], v[148:151], a[36:39]
    v_mfma_f32_16x16x32_bf16 a[8:11], a[232:235], v[144:147], a[8:11]
    buffer_load_dwordx4 v[232:235], v2, s[8:11], s82 offen offset:0 sc1
    v_mfma_f32_16x16x32_bf16 a[40:43], a[232:235], v[148:151], a[40:43]
    v_mfma_f32_16x16x32_bf16 a[12:15], a[236:239], v[144:147], a[12:15]
    buffer_load_dwordx4 v[236:239], v2, s[8:11], s82 offen offset:1024 sc1
    v_mfma_f32_16x16x32_bf16 a[44:47], a[236:239], v[148:151], a[44:47]
    v_mfma_f32_16x16x32_bf16 a[16:19], a[240:243], v[144:147], a[16:19]
    buffer_load_dwordx4 v[228:231], v2, s[8:11], s83 offen offset:0 sc1
    v_mfma_f32_16x16x32_bf16 a[48:51], a[240:243], v[148:151], a[48:51]
    v_mfma_f32_16x16x32_bf16 a[20:23], a[244:247], v[144:147], a[20:23]
    buffer_load_dwordx4 v[244:247], v2, s[8:11], s84 offen offset:0 sc1
    v_mfma_f32_16x16x32_bf16 a[52:55], a[244:247], v[148:151], a[52:55]
    v_mfma_f32_16x16x32_bf16 a[24:27], a[248:251], v[144:147], a[24:27]
    buffer_load_dwordx4 v[248:251], v2, s[8:11], s84 offen offset:1024 sc1
    v_mfma_f32_16x16x32_bf16 a[56:59], a[248:251], v[148:151], a[56:59]
    v_mfma_f32_16x16x32_bf16 a[28:31], a[252:255], v[144:147], a[28:31]
    buffer_load_dwordx4 v[240:243], v2, s[8:11], s85 offen offset:0 sc1
    v_mfma_f32_16x16x32_bf16 a[60:63], a[252:255], v[148:151], a[60:63]
    v_add_f32 v20, v12, v28
    v_add_f32 v21, v13, v32
    s_nop 3
    v_rcp_f32 v20, v20
    v_rcp_f32 v21, v21
    s_lshl_b32 s90, s74, 10
    s_add_u32 s90, s90, s78
    s_add_u32 s90, s90, 67108864
    v_accvgpr_read_b32 v48, a0
    v_accvgpr_read_b32 v49, a1
    v_accvgpr_read_b32 v50, a2
    v_accvgpr_read_b32 v51, a3
    v_accvgpr_read_b32 v52, a4
    v_accvgpr_read_b32 v53, a5
    v_accvgpr_read_b32 v54, a6
    v_accvgpr_read_b32 v55, a7
    v_mul_f32 v48, v20, v48
    v_mul_f32 v49, v20, v49
    v_mul_f32 v50, v20, v50
    v_mul_f32 v51, v20, v51
    v_mul_f32 v52, v20, v52
    v_mul_f32 v53, v20, v53
    v_mul_f32 v54, v20, v54
    v_mul_f32 v55, v20, v55
    v_cvt_pk_bf16_f32 v48, v48, v49
    v_cvt_pk_bf16_f32 v49, v50, v51
    v_cvt_pk_bf16_f32 v50, v52, v53
    v_cvt_pk_bf16_f32 v51, v54, v55
    buffer_store_dwordx4 v[48:51], v2, s[8:11], s90 offen offset:0 sc1
    v_accvgpr_read_b32 v56, a32
    v_accvgpr_read_b32 v57, a33
    v_accvgpr_read_b32 v58, a34
    v_accvgpr_read_b32 v59, a35
    v_accvgpr_read_b32 v60, a36
    v_accvgpr_read_b32 v61, a37
    v_accvgpr_read_b32 v62, a38
    v_accvgpr_read_b32 v63, a39
    v_mul_f32 v56, v21, v56
    v_mul_f32 v57, v21, v57
    v_mul_f32 v58, v21, v58
    v_mul_f32 v59, v21, v59
    v_mul_f32 v60, v21, v60
    v_mul_f32 v61, v21, v61
    v_mul_f32 v62, v21, v62
    v_mul_f32 v63, v21, v63
    v_cvt_pk_bf16_f32 v56, v56, v57
    v_cvt_pk_bf16_f32 v57, v58, v59
    v_cvt_pk_bf16_f32 v58, v60, v61
    v_cvt_pk_bf16_f32 v59, v62, v63
    buffer_store_dwordx4 v[56:59], v2, s[8:11], s90 offen offset:1024 sc1
    s_add_u32 s90, s90, 131072
    v_accvgpr_read_b32 v48, a8
    v_accvgpr_read_b32 v49, a9
    v_accvgpr_read_b32 v50, a10
    v_accvgpr_read_b32 v51, a11
    v_accvgpr_read_b32 v52, a12
    v_accvgpr_read_b32 v53, a13
    v_accvgpr_read_b32 v54, a14
    v_accvgpr_read_b32 v55, a15
    v_mul_f32 v48, v20, v48
    v_mul_f32 v49, v20, v49
    v_mul_f32 v50, v20, v50
    v_mul_f32 v51, v20, v51
    v_mul_f32 v52, v20, v52
    v_mul_f32 v53, v20, v53
    v_mul_f32 v54, v20, v54
    v_mul_f32 v55, v20, v55
    v_cvt_pk_bf16_f32 v48, v48, v49
    v_cvt_pk_bf16_f32 v49, v50, v51
    v_cvt_pk_bf16_f32 v50, v52, v53
    v_cvt_pk_bf16_f32 v51, v54, v55
    buffer_store_dwordx4 v[48:51], v2, s[8:11], s90 offen offset:0 sc1
    v_accvgpr_read_b32 v56, a40
    v_accvgpr_read_b32 v57, a41
    v_accvgpr_read_b32 v58, a42
    v_accvgpr_read_b32 v59, a43
    v_accvgpr_read_b32 v60, a44
    v_accvgpr_read_b32 v61, a45
    v_accvgpr_read_b32 v62, a46
    v_accvgpr_read_b32 v63, a47
    v_mul_f32 v56, v21, v56
    v_mul_f32 v57, v21, v57
    v_mul_f32 v58, v21, v58
    v_mul_f32 v59, v21, v59
    v_mul_f32 v60, v21, v60
    v_mul_f32 v61, v21, v61
    v_mul_f32 v62, v21, v62
    v_mul_f32 v63, v21, v63
    v_cvt_pk_bf16_f32 v56, v56, v57
    v_cvt_pk_bf16_f32 v57, v58, v59
    v_cvt_pk_bf16_f32 v58, v60, v61
    v_cvt_pk_bf16_f32 v59, v62, v63
    buffer_store_dwordx4 v[56:59], v2, s[8:11], s90 offen offset:1024 sc1
    s_add_u32 s90, s90, 131072
    v_accvgpr_read_b32 v48, a16
    v_accvgpr_read_b32 v49, a17
    v_accvgpr_read_b32 v50, a18
    v_accvgpr_read_b32 v51, a19
    v_accvgpr_read_b32 v52, a20
    v_accvgpr_read_b32 v53, a21
    v_accvgpr_read_b32 v54, a22
    v_accvgpr_read_b32 v55, a23
    v_mul_f32 v48, v20, v48
    v_mul_f32 v49, v20, v49
    v_mul_f32 v50, v20, v50
    v_mul_f32 v51, v20, v51
    v_mul_f32 v52, v20, v52
    v_mul_f32 v53, v20, v53
    v_mul_f32 v54, v20, v54
    v_mul_f32 v55, v20, v55
    v_cvt_pk_bf16_f32 v48, v48, v49
    v_cvt_pk_bf16_f32 v49, v50, v51
    v_cvt_pk_bf16_f32 v50, v52, v53
    v_cvt_pk_bf16_f32 v51, v54, v55
    buffer_store_dwordx4 v[48:51], v2, s[8:11], s90 offen offset:0 sc1
    v_accvgpr_read_b32 v56, a48
    v_accvgpr_read_b32 v57, a49
    v_accvgpr_read_b32 v58, a50
    v_accvgpr_read_b32 v59, a51
    v_accvgpr_read_b32 v60, a52
    v_accvgpr_read_b32 v61, a53
    v_accvgpr_read_b32 v62, a54
    v_accvgpr_read_b32 v63, a55
    v_mul_f32 v56, v21, v56
    v_mul_f32 v57, v21, v57
    v_mul_f32 v58, v21, v58
    v_mul_f32 v59, v21, v59
    v_mul_f32 v60, v21, v60
    v_mul_f32 v61, v21, v61
    v_mul_f32 v62, v21, v62
    v_mul_f32 v63, v21, v63
    v_cvt_pk_bf16_f32 v56, v56, v57
    v_cvt_pk_bf16_f32 v57, v58, v59
    v_cvt_pk_bf16_f32 v58, v60, v61
    v_cvt_pk_bf16_f32 v59, v62, v63
    buffer_store_dwordx4 v[56:59], v2, s[8:11], s90 offen offset:1024 sc1
    s_add_u32 s90, s90, 131072
    v_accvgpr_read_b32 v48, a24
    v_accvgpr_read_b32 v49, a25
    v_accvgpr_read_b32 v50, a26
    v_accvgpr_read_b32 v51, a27
    v_accvgpr_read_b32 v52, a28
    v_accvgpr_read_b32 v53, a29
    v_accvgpr_read_b32 v54, a30
    v_accvgpr_read_b32 v55, a31
    v_mul_f32 v48, v20, v48
    v_mul_f32 v49, v20, v49
    v_mul_f32 v50, v20, v50
    v_mul_f32 v51, v20, v51
    v_mul_f32 v52, v20, v52
    v_mul_f32 v53, v20, v53
    v_mul_f32 v54, v20, v54
    v_mul_f32 v55, v20, v55
    v_cvt_pk_bf16_f32 v48, v48, v49
    v_cvt_pk_bf16_f32 v49, v50, v51
    v_cvt_pk_bf16_f32 v50, v52, v53
    v_cvt_pk_bf16_f32 v51, v54, v55
    buffer_store_dwordx4 v[48:51], v2, s[8:11], s90 offen offset:0 sc1
    v_accvgpr_read_b32 v56, a56
    v_accvgpr_read_b32 v57, a57
    v_accvgpr_read_b32 v58, a58
    v_accvgpr_read_b32 v59, a59
    v_accvgpr_read_b32 v60, a60
    v_accvgpr_read_b32 v61, a61
    v_accvgpr_read_b32 v62, a62
    v_accvgpr_read_b32 v63, a63
    v_mul_f32 v56, v21, v56
    v_mul_f32 v57, v21, v57
    v_mul_f32 v58, v21, v58
    v_mul_f32 v59, v21, v59
    v_mul_f32 v60, v21, v60
    v_mul_f32 v61, v21, v61
    v_mul_f32 v62, v21, v62
    v_mul_f32 v63, v21, v63
    v_cvt_pk_bf16_f32 v56, v56, v57
    v_cvt_pk_bf16_f32 v57, v58, v59
    v_cvt_pk_bf16_f32 v58, v60, v61
    v_cvt_pk_bf16_f32 v59, v62, v63
    buffer_store_dwordx4 v[56:59], v2, s[8:11], s90 offen offset:1024 sc1
    s_add_u32 s90, s90, 131072
    v_lshrrev_b32 v10, 3, v1
    v_lshlrev_b32 v10, 11, v10
    v_and_b32 v11, 7, v1
    v_lshl_add_u32 v10, v11, 7, v10
    s_lshr_b32 s90, s2, 3
    s_lshl_b32 s90, s90, 2
    s_add_u32 s90, s90, s16
    s_lshl_b32 s90, s90, 14
    s_and_b32 s91, s2, 1
    s_lshl_b32 s91, s91, 10
    s_add_u32 s90, s90, s91
    s_bitcmp1_b32 s2, 2
    s_cselect_b32 s91, 0, 5373952
    s_mov_b32 s92, 8388608
    s_cselect_b32 s46, 5373952, s92
    s_cselect_b32 s93, 0, 2097152
    s_add_u32 s91, s91, s90
    s_mov_b32 s44, s48
    s_mov_b32 s45, s49
    s_add_u32 s92, s91, 0
    buffer_load_dword v255, v10, s[44:47], s92 offen
    s_add_u32 s92, s91, 2097152
    buffer_load_dword v255, v10, s[44:47], s92 offen
    s_add_u32 s92, s91, 4194304
    buffer_load_dword v255, v10, s[44:47], s92 offen
    s_mov_b32 s44, s50
    s_mov_b32 s45, s51
    s_mov_b32 s46, s93
    buffer_load_dword v255, v10, s[44:47], s90 offen
    v_and_b32 v48, 15, v1
    v_lshrrev_b32 v49, 4, v1
    v_lshlrev_b32 v49, 2, v49
    v_sub_u32 v48, v48, v49
    v_cmp_ge_i32 vcc, -9, v48
    v_subrev_u32 v50, 0, v48
    v_cmp_ge_u32 s[72:73], 7, v50
    s_nop 0
    v_cndmask_b32 v64, v9, 0, vcc
    v_cndmask_b32 v68, v9, 0, s[72:73]
    v_cmp_ge_i32 vcc, -8, v48
    v_subrev_u32 v50, 1, v48
    v_cmp_ge_u32 s[72:73], 7, v50
    s_nop 0
    v_cndmask_b32 v65, v9, 0, vcc
    v_cndmask_b32 v69, v9, 0, s[72:73]
    v_cmp_ge_i32 vcc, -7, v48
    v_subrev_u32 v50, 2, v48
    v_cmp_ge_u32 s[72:73], 7, v50
    s_nop 0
    v_cndmask_b32 v66, v9, 0, vcc
    v_cndmask_b32 v70, v9, 0, s[72:73]
    v_cmp_ge_i32 vcc, -6, v48
    v_subrev_u32 v50, 3, v48
    v_cmp_ge_u32 s[72:73], 7, v50
    s_nop 0
    v_cndmask_b32 v67, v9, 0, vcc
    v_cndmask_b32 v71, v9, 0, s[72:73]
    s_cmp_eq_u32 s77, 0
    s_cselect_b64 vcc, -1, 0
    s_nop 0
    v_cndmask_b32 v72, v64, v9, vcc
    v_cndmask_b32 v73, v65, v9, vcc
    v_cndmask_b32 v74, v66, v9, vcc
    v_cndmask_b32 v75, v67, v9, vcc
    s_waitcnt vmcnt(12)
    s_nop 0
    v_mfma_f32_16x16x32_bf16 v[80:83], v[208:211], v[192:195], v[72:75]
    v_mfma_f32_16x16x32_bf16 v[84:87], v[212:215], v[192:195], v[68:71]
    v_mfma_f32_16x16x32_bf16 v[88:91], v[212:215], v[196:199], v[64:67]
    v_mfma_f32_16x16x32_bf16 v[92:95], v[216:219], v[196:199], v[68:71]
    v_mfma_f32_16x16x32_bf16 v[96:99], v[216:219], v[200:203], v[64:67]
    v_mfma_f32_16x16x32_bf16 v[100:103], v[220:223], v[200:203], v[68:71]
    v_mfma_f32_16x16x32_bf16 v[104:107], v[220:223], v[204:207], v[64:67]
    v_mfma_f32_16x16x32_bf16 v[108:111], v[224:227], v[204:207], v[68:71]
    s_nop 7
    v_max3_f32 v112, v80, v81, v82
    v_max3_f32 v113, v88, v89, v90
    v_max3_f32 v114, v96, v97, v98
    v_max3_f32 v115, v104, v105, v106
    v_max3_f32 v112, v112, v83, v84
    v_max3_f32 v113, v113, v91, v92
    v_max3_f32 v114, v114, v99, v100
    v_max3_f32 v115, v115, v107, v108
    v_max3_f32 v112, v112, v85, v86
    v_max3_f32 v113, v113, v93, v94
    v_max3_f32 v114, v114, v101, v102
    v_max3_f32 v115, v115, v109, v110
    v_max_f32 v112, v112, v87
    v_max_f32 v113, v113, v95
    v_max_f32 v114, v114, v103
    v_max_f32 v115, v115, v111
    v_mov_b32 v116, v112
    v_mov_b32 v117, v113
    v_mov_b32 v118, v114
    v_mov_b32 v119, v115
    s_nop 1
    v_permlane32_swap_b32 v112, v116
    v_permlane32_swap_b32 v113, v117
    v_permlane32_swap_b32 v114, v118
    v_permlane32_swap_b32 v115, v119
    s_nop 1
    v_max_f32 v112, v112, v116
    v_max_f32 v113, v113, v117
    v_max_f32 v114, v114, v118
    v_max_f32 v115, v115, v119
    v_mov_b32 v116, v112
    v_mov_b32 v117, v113
    v_mov_b32 v118, v114
    v_mov_b32 v119, v115
    s_nop 1
    v_permlane16_swap_b32 v112, v116
    v_permlane16_swap_b32 v113, v117
    v_permlane16_swap_b32 v114, v118
    v_permlane16_swap_b32 v115, v119
    s_nop 1
    v_max_f32 v112, v112, v116
    v_max_f32 v113, v113, v117
    v_max_f32 v114, v114, v118
    v_max_f32 v115, v115, v119
    v_sub_f32 v80, v80, v112
    v_sub_f32 v81, v81, v112
    v_sub_f32 v82, v82, v112
    v_sub_f32 v83, v83, v112
    v_sub_f32 v84, v84, v112
    v_sub_f32 v85, v85, v112
    v_sub_f32 v86, v86, v112
    v_sub_f32 v87, v87, v112
    v_sub_f32 v88, v88, v113
    v_sub_f32 v89, v89, v113
    v_sub_f32 v90, v90, v113
    v_sub_f32 v91, v91, v113
    v_sub_f32 v92, v92, v113
    v_sub_f32 v93, v93, v113
    v_sub_f32 v94, v94, v113
    v_sub_f32 v95, v95, v113
    v_sub_f32 v96, v96, v114
    v_sub_f32 v97, v97, v114
    v_sub_f32 v98, v98, v114
    v_sub_f32 v99, v99, v114
    v_sub_f32 v100, v100, v114
    v_sub_f32 v101, v101, v114
    v_sub_f32 v102, v102, v114
    v_sub_f32 v103, v103, v114
    v_sub_f32 v104, v104, v115
    v_sub_f32 v105, v105, v115
    v_sub_f32 v106, v106, v115
    v_sub_f32 v107, v107, v115
    v_sub_f32 v108, v108, v115
    v_sub_f32 v109, v109, v115
    v_sub_f32 v110, v110, v115
    v_sub_f32 v111, v111, v115
    v_exp_f32 v80, v80
    v_exp_f32 v81, v81
    v_exp_f32 v82, v82
    v_exp_f32 v83, v83
    v_exp_f32 v84, v84
    v_exp_f32 v85, v85
    v_exp_f32 v86, v86
    v_exp_f32 v87, v87
    v_exp_f32 v88, v88
    v_exp_f32 v89, v89
    v_exp_f32 v90, v90
    v_exp_f32 v91, v91
    v_exp_f32 v92, v92
    v_exp_f32 v93, v93
    v_exp_f32 v94, v94
    v_exp_f32 v95, v95
    v_exp_f32 v96, v96
    v_exp_f32 v97, v97
    v_exp_f32 v98, v98
    v_exp_f32 v99, v99
    v_exp_f32 v100, v100
    v_exp_f32 v101, v101
    v_exp_f32 v102, v102
    v_exp_f32 v103, v103
    v_exp_f32 v104, v104
    v_exp_f32 v105, v105
    v_exp_f32 v106, v106
    v_exp_f32 v107, v107
    v_exp_f32 v108, v108
    v_exp_f32 v109, v109
    v_exp_f32 v110, v110
    v_exp_f32 v111, v111
    v_cvt_pk_bf16_f32 v192, v80, v81
    v_cvt_pk_bf16_f32 v193, v82, v83
    v_cvt_pk_bf16_f32 v194, v84, v85
    v_cvt_pk_bf16_f32 v195, v86, v87
    v_cvt_pk_bf16_f32 v196, v88, v89
    v_cvt_pk_bf16_f32 v197, v90, v91
    v_cvt_pk_bf16_f32 v198, v92, v93
    v_cvt_pk_bf16_f32 v199, v94, v95
    v_cvt_pk_bf16_f32 v200, v96, v97
    v_cvt_pk_bf16_f32 v201, v98, v99
    v_cvt_pk_bf16_f32 v202, v100, v101
    v_cvt_pk_bf16_f32 v203, v102, v103
    v_cvt_pk_bf16_f32 v204, v104, v105
    v_cvt_pk_bf16_f32 v205, v106, v107
    v_cvt_pk_bf16_f32 v206, v108, v109
    v_cvt_pk_bf16_f32 v207, v110, v111
    v_add_f32 v112, v80, v81
    v_add_f32 v113, v88, v89
    v_add_f32 v114, v96, v97
    v_add_f32 v115, v104, v105
    v_mfma_f32_16x16x32_bf16 v[128:131], v[230:233], v[192:195], 0
    v_mfma_f32_16x16x32_bf16 v[132:135], v[242:245], v[192:195], 0
    v_mfma_f32_16x16x32_bf16 v[136:139], v[232:235], v[196:199], 0
    v_mfma_f32_16x16x32_bf16 v[140:143], v[244:247], v[196:199], 0
    v_mfma_f32_16x16x32_bf16 v[144:147], v[234:237], v[200:203], 0
    v_mfma_f32_16x16x32_bf16 v[148:151], v[246:249], v[200:203], 0
    v_mfma_f32_16x16x32_bf16 v[152:155], v[236:239], v[204:207], 0
    v_mfma_f32_16x16x32_bf16 v[156:159], v[248:251], v[204:207], 0
    v_add_f32 v112, v112, v82
    v_add_f32 v113, v113, v90
    v_add_f32 v114, v114, v98
    v_add_f32 v115, v115, v106
    v_add_f32 v112, v112, v83
    v_add_f32 v113, v113, v91
    v_add_f32 v114, v114, v99
    v_add_f32 v115, v115, v107
    v_add_f32 v112, v112, v84
    v_add_f32 v113, v113, v92
    v_add_f32 v114, v114, v100
    v_add_f32 v115, v115, v108
    v_add_f32 v112, v112, v85
    v_add_f32 v113, v113, v93
    v_add_f32 v114, v114, v101
    v_add_f32 v115, v115, v109
    v_add_f32 v112, v112, v86
    v_add_f32 v113, v113, v94
    v_add_f32 v114, v114, v102
    v_add_f32 v115, v115, v110
    v_add_f32 v112, v112, v87
    v_add_f32 v113, v113, v95
    v_add_f32 v114, v114, v103
    v_add_f32 v115, v115, v111
    v_mov_b32 v116, v112
    v_mov_b32 v117, v113
    v_mov_b32 v118, v114
    v_mov_b32 v119, v115
    s_nop 1
    v_permlane32_swap_b32 v112, v116
    v_permlane32_swap_b32 v113, v117
    v_permlane32_swap_b32 v114, v118
    v_permlane32_swap_b32 v115, v119
    s_nop 1
    v_add_f32 v112, v112, v116
    v_add_f32 v113, v113, v117
    v_add_f32 v114, v114, v118
    v_add_f32 v115, v115, v119
    v_mov_b32 v116, v112
    v_mov_b32 v117, v113
    v_mov_b32 v118, v114
    v_mov_b32 v119, v115
    s_nop 1
    v_permlane16_swap_b32 v112, v116
    v_permlane16_swap_b32 v113, v117
    v_permlane16_swap_b32 v114, v118
    v_permlane16_swap_b32 v115, v119
    s_nop 1
    v_add_f32 v112, v112, v116
    v_add_f32 v113, v113, v117
    v_add_f32 v114, v114, v118
    v_add_f32 v115, v115, v119
    v_rcp_f32 v112, v112
    v_rcp_f32 v113, v113
    v_rcp_f32 v114, v114
    v_rcp_f32 v115, v115
    s_lshl_b32 s90, s76, 10
    s_lshr_b32 s91, s2, 3
    s_lshl_b32 s91, s91, 17
    s_add_u32 s90, s90, s91
    s_add_u32 s90, s90, 83886080
    v_mul_f32 v128, v128, v112
    v_mul_f32 v129, v129, v112
    v_mul_f32 v130, v130, v112
    v_mul_f32 v131, v131, v112
    v_mul_f32 v132, v132, v112
    v_mul_f32 v133, v133, v112
    v_mul_f32 v134, v134, v112
    v_mul_f32 v135, v135, v112
    v_cvt_pk_bf16_f32 v128, v128, v129
    v_cvt_pk_bf16_f32 v129, v130, v131
    v_cvt_pk_bf16_f32 v130, v132, v133
    v_cvt_pk_bf16_f32 v131, v134, v135
    buffer_store_dwordx4 v[128:131], v2, s[8:11], s90 offen offset:0 sc1
    v_mul_f32 v136, v136, v113
    v_mul_f32 v137, v137, v113
    v_mul_f32 v138, v138, v113
    v_mul_f32 v139, v139, v113
    v_mul_f32 v140, v140, v113
    v_mul_f32 v141, v141, v113
    v_mul_f32 v142, v142, v113
    v_mul_f32 v143, v143, v113
    v_cvt_pk_bf16_f32 v136, v136, v137
    v_cvt_pk_bf16_f32 v137, v138, v139
    v_cvt_pk_bf16_f32 v138, v140, v141
    v_cvt_pk_bf16_f32 v139, v142, v143
    buffer_store_dwordx4 v[136:139], v2, s[8:11], s90 offen offset:1024 sc1
    v_mul_f32 v144, v144, v114
    v_mul_f32 v145, v145, v114
    v_mul_f32 v146, v146, v114
    v_mul_f32 v147, v147, v114
    v_mul_f32 v148, v148, v114
    v_mul_f32 v149, v149, v114
    v_mul_f32 v150, v150, v114
    v_mul_f32 v151, v151, v114
    v_cvt_pk_bf16_f32 v144, v144, v145
    v_cvt_pk_bf16_f32 v145, v146, v147
    v_cvt_pk_bf16_f32 v146, v148, v149
    v_cvt_pk_bf16_f32 v147, v150, v151
    buffer_store_dwordx4 v[144:147], v2, s[8:11], s90 offen offset:2048 sc1
    v_mul_f32 v152, v152, v115
    v_mul_f32 v153, v153, v115
    v_mul_f32 v154, v154, v115
    v_mul_f32 v155, v155, v115
    v_mul_f32 v156, v156, v115
    v_mul_f32 v157, v157, v115
    v_mul_f32 v158, v158, v115
    v_mul_f32 v159, v159, v115
    v_cvt_pk_bf16_f32 v152, v152, v153
    v_cvt_pk_bf16_f32 v153, v154, v155
    v_cvt_pk_bf16_f32 v154, v156, v157
    v_cvt_pk_bf16_f32 v155, v158, v159
    buffer_store_dwordx4 v[152:155], v2, s[8:11], s90 offen offset:3072 sc1
mega_kernel_end1:
    s_endpgm
mega_kernel_stub64:
    v_cmp_lt_f32 vcc, s61, v8
    s_cmp_lg_u32 s60, s63
    s_cbranch_scc1 mega_kernel_e112
    v_add_f32 v176, v176, v16
    v_mov_b32 v180, v9
    v_add_f32 v188, v188, v16
    v_add_f32 v177, v177, v17
    v_mov_b32 v181, v9
    v_add_f32 v189, v189, v17
    v_add_f32 v178, v178, v18
    v_mov_b32 v182, v9
    v_add_f32 v190, v190, v18
    v_add_f32 v179, v179, v19
    v_mov_b32 v183, v9
    v_add_f32 v191, v191, v19
    s_nop 0
mega_kernel_e112:
    s_cmp_lg_u32 s60, s64
    s_cbranch_scc1 mega_kernel_e113
    v_mov_b32 v176, v9
    v_mov_b32 v184, v9
    v_mov_b32 v188, v9
    v_mov_b32 v177, v9
    v_mov_b32 v185, v9
    v_mov_b32 v189, v9
    v_mov_b32 v178, v9
    v_mov_b32 v186, v9
    v_mov_b32 v190, v9
    v_mov_b32 v179, v9
    v_mov_b32 v187, v9
    v_mov_b32 v191, v9
    s_nop 0
mega_kernel_e113:
    s_cbranch_vccnz mega_kernel_rc114
mega_kernel_sp111:
    s_branch mega_kernel_ret65
mega_kernel_stub67:
    v_cmp_lt_f32 vcc, s61, v8
    s_cmp_lg_u32 s60, s63
    s_cbranch_scc1 mega_kernel_e116
    v_add_f32 v176, v176, v16
    v_mov_b32 v180, v9
    v_add_f32 v188, v188, v16
    v_add_f32 v177, v177, v17
    v_mov_b32 v181, v9
    v_add_f32 v189, v189, v17
    v_add_f32 v178, v178, v18
    v_mov_b32 v182, v9
    v_add_f32 v190, v190, v18
    v_add_f32 v179, v179, v19
    v_mov_b32 v183, v9
    v_add_f32 v191, v191, v19
    s_nop 0
mega_kernel_e116:
    s_cmp_lg_u32 s60, s64
    s_cbranch_scc1 mega_kernel_e117
    v_mov_b32 v176, v9
    v_mov_b32 v184, v9
    v_mov_b32 v188, v9
    v_mov_b32 v177, v9
    v_mov_b32 v185, v9
    v_mov_b32 v189, v9
    v_mov_b32 v178, v9
    v_mov_b32 v186, v9
    v_mov_b32 v190, v9
    v_mov_b32 v179, v9
    v_mov_b32 v187, v9
    v_mov_b32 v191, v9
    s_nop 0
mega_kernel_e117:
    s_cbranch_vccnz mega_kernel_rc118
mega_kernel_sp115:
    s_branch mega_kernel_ret68
mega_kernel_stub86:
    v_cmp_lt_f32 vcc, s61, v8
    s_cmp_lg_u32 s60, s66
    s_cbranch_scc1 mega_kernel_e120
    v_add_f32 v160, v160, v16
    v_mov_b32 v164, v9
    v_add_f32 v172, v172, v16
    v_add_f32 v161, v161, v17
    v_mov_b32 v165, v9
    v_add_f32 v173, v173, v17
    v_add_f32 v162, v162, v18
    v_mov_b32 v166, v9
    v_add_f32 v174, v174, v18
    v_add_f32 v163, v163, v19
    v_mov_b32 v167, v9
    v_add_f32 v175, v175, v19
    s_nop 0
mega_kernel_e120:
    s_cmp_lg_u32 s60, s67
    s_cbranch_scc1 mega_kernel_e121
    v_mov_b32 v160, v9
    v_mov_b32 v168, v9
    v_mov_b32 v172, v9
    v_mov_b32 v161, v9
    v_mov_b32 v169, v9
    v_mov_b32 v173, v9
    v_mov_b32 v162, v9
    v_mov_b32 v170, v9
    v_mov_b32 v174, v9
    v_mov_b32 v163, v9
    v_mov_b32 v171, v9
    v_mov_b32 v175, v9
    s_nop 0
mega_kernel_e121:
    s_cbranch_vccnz mega_kernel_rc122
mega_kernel_sp119:
    s_branch mega_kernel_ret87
mega_kernel_stub88:
    v_cmp_lt_f32 vcc, s61, v8
    s_cmp_lg_u32 s60, s66
    s_cbranch_scc1 mega_kernel_e124
    v_add_f32 v160, v160, v16
    v_mov_b32 v164, v9
    v_add_f32 v172, v172, v16
    v_add_f32 v161, v161, v17
    v_mov_b32 v165, v9
    v_add_f32 v173, v173, v17
    v_add_f32 v162, v162, v18
    v_mov_b32 v166, v9
    v_add_f32 v174, v174, v18
    v_add_f32 v163, v163, v19
    v_mov_b32 v167, v9
    v_add_f32 v175, v175, v19
    s_nop 0
mega_kernel_e124:
    s_cmp_lg_u32 s60, s67
    s_cbranch_scc1 mega_kernel_e125
    v_mov_b32 v160, v9
    v_mov_b32 v168, v9
    v_mov_b32 v172, v9
    v_mov_b32 v161, v9
    v_mov_b32 v169, v9
    v_mov_b32 v173, v9
    v_mov_b32 v162, v9
    v_mov_b32 v170, v9
    v_mov_b32 v174, v9
    v_mov_b32 v163, v9
    v_mov_b32 v171, v9
    v_mov_b32 v175, v9
    s_nop 0
mega_kernel_e125:
    s_cmp_gt_u32 s60, 26
    s_cbranch_scc1 mega_kernel_e126
    s_cmp_lg_u32 s60, 4
    s_cbranch_scc1 mega_kernel_e128
    buffer_store_dwordx4 v[224:227], v2, s[36:39], s40 offen sc1
    s_add_u32 s40, s40, s100
    buffer_store_dwordx4 v[228:231], v2, s[36:39], s40 offen sc1
    s_add_u32 s40, s40, s100
    buffer_store_dwordx4 v[232:235], v2, s[36:39], s40 offen sc1
    s_add_u32 s40, s40, s100
    buffer_store_dwordx4 v[236:239], v2, s[36:39], s40 offen sc1
    s_mov_b32 s40, s98
    s_branch mega_kernel_e126
mega_kernel_e128:
    s_cmp_lg_u32 s60, 6
    s_cbranch_scc1 mega_kernel_e129
    buffer_store_dwordx4 v[240:243], v2, s[36:39], s40 offen sc1
    s_add_u32 s40, s40, s100
    buffer_store_dwordx4 v[244:247], v2, s[36:39], s40 offen sc1
    s_add_u32 s40, s40, s100
    buffer_store_dwordx4 v[248:251], v2, s[36:39], s40 offen sc1
    s_add_u32 s40, s40, s100
    buffer_store_dwordx4 v[252:255], v2, s[36:39], s40 offen sc1
    s_add_u32 s40, s40, s100
    s_branch mega_kernel_e126
mega_kernel_e129:
    s_cmp_lg_u32 s60, 10
    s_cbranch_scc1 mega_kernel_e130
    s_cmp_eq_u32 s17, -1
    s_cbranch_scc1 mega_kernel_e126
    s_cmp_lg_u32 s16, 0
    s_cbranch_scc1 mega_kernel_np131
    v_mov_b32 v4, s4
    v_mov_b32 v5, s5
    s_add_u32 s90, s17, 117440512
    s_mov_b64 exec, 1
    buffer_store_dwordx2 v[4:5], off, s[8:11], s90 sc1
    s_mov_b64 exec, -1
mega_kernel_np131:
    s_branch mega_kernel_e126
mega_kernel_e130:
    s_cmp_lg_u32 s60, 14
    s_cbranch_scc1 mega_kernel_e132
    s_lshr_b32 s90, s32, 1
    s_lshl_b32 s90, s90, 7
    s_add_u32 s90, s90, 117442560
    v_min_u32 v0, 1, v1
    v_lshlrev_b32 v0, 3, v0
    buffer_load_dwordx2 v[4:5], v0, s[8:11], s90 offen sc1
    s_mov_b32 s44, s48
    s_mov_b32 s45, s49
    s_mov_b32 s46, 8388608
    s_lshl_b32 s90, s2, 2
    s_add_u32 s90, s90, s16
    s_lshl_b32 s90, s90, 13
    v_lshlrev_b32 v62, 7, v1
    buffer_load_dword v255, v62, s[44:47], s90 offen
    s_branch mega_kernel_e126
mega_kernel_e132:
    s_cmp_lg_u32 s60, 18
    s_cbranch_scc1 mega_kernel_e133
    s_waitcnt vmcnt(16)
    s_mov_b32 s3, 1048576
mega_kernel_spin134:
    v_cmp_ne_u64 s[72:73], s[4:5], v[4:5]
    s_nop 3
    s_cmp_eq_u64 s[72:73], 0
    s_cbranch_scc1 mega_kernel_e126
    s_sub_u32 s3, s3, 1
    s_cbranch_scc1 mega_kernel_e126
    s_sleep 32
    s_lshr_b32 s90, s32, 1
    s_lshl_b32 s90, s90, 7
    s_add_u32 s90, s90, 117442560
    v_min_u32 v0, 1, v1
    v_lshlrev_b32 v0, 3, v0
    buffer_load_dwordx2 v[4:5], v0, s[8:11], s90 offen sc1
    s_waitcnt vmcnt(0)
    s_branch mega_kernel_spin134
    s_branch mega_kernel_e126
mega_kernel_e133:
    s_cmp_lg_u32 s60, 22
    s_cbranch_scc1 mega_kernel_e135
    buffer_load_dwordx2 v[4:5], v10, s[8:11], 0 offen sc1
    s_mov_b32 s44, s50
    s_mov_b32 s45, s51
    s_mov_b32 s46, 2097152
    s_lshl_b32 s90, s2, 2
    s_add_u32 s90, s90, s16
    s_lshl_b32 s90, s90, 13
    v_lshlrev_b32 v62, 7, v1
    buffer_load_dword v255, v62, s[44:47], s90 offen
    s_branch mega_kernel_e126
mega_kernel_e135:
    s_cmp_lg_u32 s60, 26
    s_cbranch_scc1 mega_kernel_e136
    s_waitcnt vmcnt(16)
    s_mov_b32 s3, 1048576
mega_kernel_spin137:
    v_cmp_ne_u64 s[72:73], s[4:5], v[4:5]
    s_nop 3
    s_cmp_eq_u64 s[72:73], 0
    s_cbranch_scc1 mega_kernel_e126
    s_sub_u32 s3, s3, 1
    s_cbranch_scc1 mega_kernel_e126
    s_sleep 32
    buffer_load_dwordx2 v[4:5], v10, s[8:11], 0 offen sc1
    s_waitcnt vmcnt(0)
    s_branch mega_kernel_spin137
    s_branch mega_kernel_e126
mega_kernel_e136:
mega_kernel_e126:
    s_cbranch_vccnz mega_kernel_rc138
mega_kernel_sp123:
    s_branch mega_kernel_ret89
mega_kernel_stub91:
    v_cmp_lt_f32 vcc, s61, v8
    s_cmp_lg_u32 s60, s66
    s_cbranch_scc1 mega_kernel_e140
    v_add_f32 v160, v160, v16
    v_mov_b32 v164, v9
    v_add_f32 v172, v172, v16
    v_add_f32 v161, v161, v17
    v_mov_b32 v165, v9
    v_add_f32 v173, v173, v17
    v_add_f32 v162, v162, v18
    v_mov_b32 v166, v9
    v_add_f32 v174, v174, v18
    v_add_f32 v163, v163, v19
    v_mov_b32 v167, v9
    v_add_f32 v175, v175, v19
    s_nop 0
mega_kernel_e140:
    s_cmp_lg_u32 s60, s67
    s_cbranch_scc1 mega_kernel_e141
    v_mov_b32 v160, v9
    v_mov_b32 v168, v9
    v_mov_b32 v172, v9
    v_mov_b32 v161, v9
    v_mov_b32 v169, v9
    v_mov_b32 v173, v9
    v_mov_b32 v162, v9
    v_mov_b32 v170, v9
    v_mov_b32 v174, v9
    v_mov_b32 v163, v9
    v_mov_b32 v171, v9
    v_mov_b32 v175, v9
    s_nop 0
mega_kernel_e141:
    s_cbranch_vccnz mega_kernel_rc142
mega_kernel_sp139:
    s_branch mega_kernel_ret92
mega_kernel_stub109:
    v_cmp_lt_f32 vcc, s61, v8
    s_cbranch_vccnz mega_kernel_rc144
mega_kernel_sp143:
    s_branch mega_kernel_ret110
mega_kernel_rc85:
    s_call_b64 s[70:71], mega_kernel_rs0458
    s_branch mega_kernel_sp69
mega_kernel_rc108:
    s_call_b64 s[70:71], mega_kernel_rs0257
    s_branch mega_kernel_sp93
mega_kernel_rc114:
    s_call_b64 s[70:71], mega_kernel_rs0458
    s_branch mega_kernel_sp111
mega_kernel_rc118:
    s_call_b64 s[70:71], mega_kernel_rs1460
    s_branch mega_kernel_sp115
mega_kernel_rc122:
    s_call_b64 s[70:71], mega_kernel_rs1460
    s_branch mega_kernel_sp119
mega_kernel_rc138:
    s_call_b64 s[70:71], mega_kernel_rs0257
    s_branch mega_kernel_sp123
mega_kernel_rc142:
    s_call_b64 s[70:71], mega_kernel_rs1259
    s_branch mega_kernel_sp139
mega_kernel_rc144:
    s_call_b64 s[70:71], mega_kernel_rs1259
    s_branch mega_kernel_sp143
mega_kernel_rs0257:
    s_nop 15
    v_max3_f32 v48, v64, v65, v66
    v_max3_f32 v48, v48, v67, v68
    v_max3_f32 v48, v48, v69, v70
    v_max3_f32 v48, v48, v71, 0
    v_mov_b32 v49, v48
    s_nop 1
    v_permlane32_swap_b32 v48, v49
    s_nop 1
    v_max_f32 v48, v48, v49
    v_mov_b32 v49, v48
    s_nop 1
    v_permlane16_swap_b32 v48, v49
    s_nop 1
    v_max_f32 v48, v48, v49
    v_exp_f32 v49, -v48
    v_sub_f32 v64, v64, v48
    v_sub_f32 v65, v65, v48
    v_sub_f32 v66, v66, v48
    v_sub_f32 v67, v67, v48
    v_sub_f32 v68, v68, v48
    v_sub_f32 v69, v69, v48
    v_sub_f32 v70, v70, v48
    v_sub_f32 v71, v71, v48
    v_sub_f32 v96, v96, v48
    v_sub_f32 v97, v97, v48
    v_sub_f32 v98, v98, v48
    v_sub_f32 v99, v99, v48
    v_sub_f32 v100, v100, v48
    v_sub_f32 v101, v101, v48
    v_sub_f32 v102, v102, v48
    v_sub_f32 v103, v103, v48
    v_sub_f32 v160, v160, v48
    v_sub_f32 v161, v161, v48
    v_sub_f32 v162, v162, v48
    v_sub_f32 v163, v163, v48
    v_sub_f32 v164, v164, v48
    v_sub_f32 v165, v165, v48
    v_sub_f32 v166, v166, v48
    v_sub_f32 v167, v167, v48
    v_mul_f32 v12, v12, v49
    v_accvgpr_read_b32 v52, a0
    v_accvgpr_read_b32 v53, a1
    v_accvgpr_read_b32 v54, a2
    v_accvgpr_read_b32 v55, a3
    v_accvgpr_read_b32 v56, a4
    v_accvgpr_read_b32 v57, a5
    v_accvgpr_read_b32 v58, a6
    v_accvgpr_read_b32 v59, a7
    v_mul_f32 v52, v52, v49
    v_mul_f32 v53, v53, v49
    v_mul_f32 v54, v54, v49
    v_mul_f32 v55, v55, v49
    v_mul_f32 v56, v56, v49
    v_mul_f32 v57, v57, v49
    v_mul_f32 v58, v58, v49
    v_mul_f32 v59, v59, v49
    v_accvgpr_write_b32 a0, v52
    v_accvgpr_write_b32 a1, v53
    v_accvgpr_write_b32 a2, v54
    v_accvgpr_write_b32 a3, v55
    v_accvgpr_write_b32 a4, v56
    v_accvgpr_write_b32 a5, v57
    v_accvgpr_write_b32 a6, v58
    v_accvgpr_write_b32 a7, v59
    v_accvgpr_read_b32 v52, a8
    v_accvgpr_read_b32 v53, a9
    v_accvgpr_read_b32 v54, a10
    v_accvgpr_read_b32 v55, a11
    v_accvgpr_read_b32 v56, a12
    v_accvgpr_read_b32 v57, a13
    v_accvgpr_read_b32 v58, a14
    v_accvgpr_read_b32 v59, a15
    v_mul_f32 v52, v52, v49
    v_mul_f32 v53, v53, v49
    v_mul_f32 v54, v54, v49
    v_mul_f32 v55, v55, v49
    v_mul_f32 v56, v56, v49
    v_mul_f32 v57, v57, v49
    v_mul_f32 v58, v58, v49
    v_mul_f32 v59, v59, v49
    v_accvgpr_write_b32 a8, v52
    v_accvgpr_write_b32 a9, v53
    v_accvgpr_write_b32 a10, v54
    v_accvgpr_write_b32 a11, v55
    v_accvgpr_write_b32 a12, v56
    v_accvgpr_write_b32 a13, v57
    v_accvgpr_write_b32 a14, v58
    v_accvgpr_write_b32 a15, v59
    v_accvgpr_read_b32 v52, a16
    v_accvgpr_read_b32 v53, a17
    v_accvgpr_read_b32 v54, a18
    v_accvgpr_read_b32 v55, a19
    v_accvgpr_read_b32 v56, a20
    v_accvgpr_read_b32 v57, a21
    v_accvgpr_read_b32 v58, a22
    v_accvgpr_read_b32 v59, a23
    v_mul_f32 v52, v52, v49
    v_mul_f32 v53, v53, v49
    v_mul_f32 v54, v54, v49
    v_mul_f32 v55, v55, v49
    v_mul_f32 v56, v56, v49
    v_mul_f32 v57, v57, v49
    v_mul_f32 v58, v58, v49
    v_mul_f32 v59, v59, v49
    v_accvgpr_write_b32 a16, v52
    v_accvgpr_write_b32 a17, v53
    v_accvgpr_write_b32 a18, v54
    v_accvgpr_write_b32 a19, v55
    v_accvgpr_write_b32 a20, v56
    v_accvgpr_write_b32 a21, v57
    v_accvgpr_write_b32 a22, v58
    v_accvgpr_write_b32 a23, v59
    v_accvgpr_read_b32 v52, a24
    v_accvgpr_read_b32 v53, a25
    v_accvgpr_read_b32 v54, a26
    v_accvgpr_read_b32 v55, a27
    v_accvgpr_read_b32 v56, a28
    v_accvgpr_read_b32 v57, a29
    v_accvgpr_read_b32 v58, a30
    v_accvgpr_read_b32 v59, a31
    v_mul_f32 v52, v52, v49
    v_mul_f32 v53, v53, v49
    v_mul_f32 v54, v54, v49
    v_mul_f32 v55, v55, v49
    v_mul_f32 v56, v56, v49
    v_mul_f32 v57, v57, v49
    v_mul_f32 v58, v58, v49
    v_mul_f32 v59, v59, v49
    v_accvgpr_write_b32 a24, v52
    v_accvgpr_write_b32 a25, v53
    v_accvgpr_write_b32 a26, v54
    v_accvgpr_write_b32 a27, v55
    v_accvgpr_write_b32 a28, v56
    v_accvgpr_write_b32 a29, v57
    v_accvgpr_write_b32 a30, v58
    v_accvgpr_write_b32 a31, v59
    v_exp_f32 v52, v64
    v_exp_f32 v53, v65
    v_exp_f32 v54, v66
    v_exp_f32 v55, v67
    v_exp_f32 v56, v68
    v_exp_f32 v57, v69
    v_exp_f32 v58, v70
    v_exp_f32 v59, v71
    s_nop 0
    v_cvt_pk_bf16_f32 v128, v52, v53
    v_cvt_pk_bf16_f32 v129, v54, v55
    v_cvt_pk_bf16_f32 v130, v56, v57
    v_cvt_pk_bf16_f32 v131, v58, v59
    s_nop 1
    v_mfma_f32_16x16x32_bf16 v[28:31], v[44:47], v[128:131], 0
    v_max3_f32 v48, v72, v73, v74
    v_max3_f32 v48, v48, v75, v76
    v_max3_f32 v48, v48, v77, v78
    v_max3_f32 v48, v48, v79, 0
    v_mov_b32 v49, v48
    s_nop 1
    v_permlane32_swap_b32 v48, v49
    s_nop 1
    v_max_f32 v48, v48, v49
    v_mov_b32 v49, v48
    s_nop 1
    v_permlane16_swap_b32 v48, v49
    s_nop 1
    v_max_f32 v48, v48, v49
    v_exp_f32 v49, -v48
    v_sub_f32 v72, v72, v48
    v_sub_f32 v73, v73, v48
    v_sub_f32 v74, v74, v48
    v_sub_f32 v75, v75, v48
    v_sub_f32 v76, v76, v48
    v_sub_f32 v77, v77, v48
    v_sub_f32 v78, v78, v48
    v_sub_f32 v79, v79, v48
    v_sub_f32 v104, v104, v48
    v_sub_f32 v105, v105, v48
    v_sub_f32 v106, v106, v48
    v_sub_f32 v107, v107, v48
    v_sub_f32 v108, v108, v48
    v_sub_f32 v109, v109, v48
    v_sub_f32 v110, v110, v48
    v_sub_f32 v111, v111, v48
    v_sub_f32 v168, v168, v48
    v_sub_f32 v169, v169, v48
    v_sub_f32 v170, v170, v48
    v_sub_f32 v171, v171, v48
    v_sub_f32 v172, v172, v48
    v_sub_f32 v173, v173, v48
    v_sub_f32 v174, v174, v48
    v_sub_f32 v175, v175, v48
    v_mul_f32 v13, v13, v49
    v_accvgpr_read_b32 v52, a32
    v_accvgpr_read_b32 v53, a33
    v_accvgpr_read_b32 v54, a34
    v_accvgpr_read_b32 v55, a35
    v_accvgpr_read_b32 v56, a36
    v_accvgpr_read_b32 v57, a37
    v_accvgpr_read_b32 v58, a38
    v_accvgpr_read_b32 v59, a39
    v_mul_f32 v52, v52, v49
    v_mul_f32 v53, v53, v49
    v_mul_f32 v54, v54, v49
    v_mul_f32 v55, v55, v49
    v_mul_f32 v56, v56, v49
    v_mul_f32 v57, v57, v49
    v_mul_f32 v58, v58, v49
    v_mul_f32 v59, v59, v49
    v_accvgpr_write_b32 a32, v52
    v_accvgpr_write_b32 a33, v53
    v_accvgpr_write_b32 a34, v54
    v_accvgpr_write_b32 a35, v55
    v_accvgpr_write_b32 a36, v56
    v_accvgpr_write_b32 a37, v57
    v_accvgpr_write_b32 a38, v58
    v_accvgpr_write_b32 a39, v59
    v_accvgpr_read_b32 v52, a40
    v_accvgpr_read_b32 v53, a41
    v_accvgpr_read_b32 v54, a42
    v_accvgpr_read_b32 v55, a43
    v_accvgpr_read_b32 v56, a44
    v_accvgpr_read_b32 v57, a45
    v_accvgpr_read_b32 v58, a46
    v_accvgpr_read_b32 v59, a47
    v_mul_f32 v52, v52, v49
    v_mul_f32 v53, v53, v49
    v_mul_f32 v54, v54, v49
    v_mul_f32 v55, v55, v49
    v_mul_f32 v56, v56, v49
    v_mul_f32 v57, v57, v49
    v_mul_f32 v58, v58, v49
    v_mul_f32 v59, v59, v49
    v_accvgpr_write_b32 a40, v52
    v_accvgpr_write_b32 a41, v53
    v_accvgpr_write_b32 a42, v54
    v_accvgpr_write_b32 a43, v55
    v_accvgpr_write_b32 a44, v56
    v_accvgpr_write_b32 a45, v57
    v_accvgpr_write_b32 a46, v58
    v_accvgpr_write_b32 a47, v59
    v_accvgpr_read_b32 v52, a48
    v_accvgpr_read_b32 v53, a49
    v_accvgpr_read_b32 v54, a50
    v_accvgpr_read_b32 v55, a51
    v_accvgpr_read_b32 v56, a52
    v_accvgpr_read_b32 v57, a53
    v_accvgpr_read_b32 v58, a54
    v_accvgpr_read_b32 v59, a55
    v_mul_f32 v52, v52, v49
    v_mul_f32 v53, v53, v49
    v_mul_f32 v54, v54, v49
    v_mul_f32 v55, v55, v49
    v_mul_f32 v56, v56, v49
    v_mul_f32 v57, v57, v49
    v_mul_f32 v58, v58, v49
    v_mul_f32 v59, v59, v49
    v_accvgpr_write_b32 a48, v52
    v_accvgpr_write_b32 a49, v53
    v_accvgpr_write_b32 a50, v54
    v_accvgpr_write_b32 a51, v55
    v_accvgpr_write_b32 a52, v56
    v_accvgpr_write_b32 a53, v57
    v_accvgpr_write_b32 a54, v58
    v_accvgpr_write_b32 a55, v59
    v_accvgpr_read_b32 v52, a56
    v_accvgpr_read_b32 v53, a57
    v_accvgpr_read_b32 v54, a58
    v_accvgpr_read_b32 v55, a59
    v_accvgpr_read_b32 v56, a60
    v_accvgpr_read_b32 v57, a61
    v_accvgpr_read_b32 v58, a62
    v_accvgpr_read_b32 v59, a63
    v_mul_f32 v52, v52, v49
    v_mul_f32 v53, v53, v49
    v_mul_f32 v54, v54, v49
    v_mul_f32 v55, v55, v49
    v_mul_f32 v56, v56, v49
    v_mul_f32 v57, v57, v49
    v_mul_f32 v58, v58, v49
    v_mul_f32 v59, v59, v49
    v_accvgpr_write_b32 a56, v52
    v_accvgpr_write_b32 a57, v53
    v_accvgpr_write_b32 a58, v54
    v_accvgpr_write_b32 a59, v55
    v_accvgpr_write_b32 a60, v56
    v_accvgpr_write_b32 a61, v57
    v_accvgpr_write_b32 a62, v58
    v_accvgpr_write_b32 a63, v59
    v_exp_f32 v52, v72
    v_exp_f32 v53, v73
    v_exp_f32 v54, v74
    v_exp_f32 v55, v75
    v_exp_f32 v56, v76
    v_exp_f32 v57, v77
    v_exp_f32 v58, v78
    v_exp_f32 v59, v79
    s_nop 0
    v_cvt_pk_bf16_f32 v132, v52, v53
    v_cvt_pk_bf16_f32 v133, v54, v55
    v_cvt_pk_bf16_f32 v134, v56, v57
    v_cvt_pk_bf16_f32 v135, v58, v59
    s_nop 1
    v_mfma_f32_16x16x32_bf16 v[32:35], v[44:47], v[132:135], 0
    s_nop 7
    s_setpc_b64 s[70:71]
mega_kernel_rs0458:
    s_nop 15
    v_max3_f32 v48, v64, v65, v66
    v_max3_f32 v48, v48, v67, v68
    v_max3_f32 v48, v48, v69, v70
    v_max3_f32 v48, v48, v71, 0
    v_mov_b32 v49, v48
    s_nop 1
    v_permlane32_swap_b32 v48, v49
    s_nop 1
    v_max_f32 v48, v48, v49
    v_mov_b32 v49, v48
    s_nop 1
    v_permlane16_swap_b32 v48, v49
    s_nop 1
    v_max_f32 v48, v48, v49
    v_exp_f32 v49, -v48
    v_sub_f32 v64, v64, v48
    v_sub_f32 v65, v65, v48
    v_sub_f32 v66, v66, v48
    v_sub_f32 v67, v67, v48
    v_sub_f32 v68, v68, v48
    v_sub_f32 v69, v69, v48
    v_sub_f32 v70, v70, v48
    v_sub_f32 v71, v71, v48
    v_sub_f32 v96, v96, v48
    v_sub_f32 v97, v97, v48
    v_sub_f32 v98, v98, v48
    v_sub_f32 v99, v99, v48
    v_sub_f32 v100, v100, v48
    v_sub_f32 v101, v101, v48
    v_sub_f32 v102, v102, v48
    v_sub_f32 v103, v103, v48
    v_sub_f32 v160, v160, v48
    v_sub_f32 v161, v161, v48
    v_sub_f32 v162, v162, v48
    v_sub_f32 v163, v163, v48
    v_sub_f32 v164, v164, v48
    v_sub_f32 v165, v165, v48
    v_sub_f32 v166, v166, v48
    v_sub_f32 v167, v167, v48
    v_mul_f32 v12, v12, v49
    v_accvgpr_read_b32 v52, a0
    v_accvgpr_read_b32 v53, a1
    v_accvgpr_read_b32 v54, a2
    v_accvgpr_read_b32 v55, a3
    v_accvgpr_read_b32 v56, a4
    v_accvgpr_read_b32 v57, a5
    v_accvgpr_read_b32 v58, a6
    v_accvgpr_read_b32 v59, a7
    v_mul_f32 v52, v52, v49
    v_mul_f32 v53, v53, v49
    v_mul_f32 v54, v54, v49
    v_mul_f32 v55, v55, v49
    v_mul_f32 v56, v56, v49
    v_mul_f32 v57, v57, v49
    v_mul_f32 v58, v58, v49
    v_mul_f32 v59, v59, v49
    v_accvgpr_write_b32 a0, v52
    v_accvgpr_write_b32 a1, v53
    v_accvgpr_write_b32 a2, v54
    v_accvgpr_write_b32 a3, v55
    v_accvgpr_write_b32 a4, v56
    v_accvgpr_write_b32 a5, v57
    v_accvgpr_write_b32 a6, v58
    v_accvgpr_write_b32 a7, v59
    v_accvgpr_read_b32 v52, a8
    v_accvgpr_read_b32 v53, a9
    v_accvgpr_read_b32 v54, a10
    v_accvgpr_read_b32 v55, a11
    v_accvgpr_read_b32 v56, a12
    v_accvgpr_read_b32 v57, a13
    v_accvgpr_read_b32 v58, a14
    v_accvgpr_read_b32 v59, a15
    v_mul_f32 v52, v52, v49
    v_mul_f32 v53, v53, v49
    v_mul_f32 v54, v54, v49
    v_mul_f32 v55, v55, v49
    v_mul_f32 v56, v56, v49
    v_mul_f32 v57, v57, v49
    v_mul_f32 v58, v58, v49
    v_mul_f32 v59, v59, v49
    v_accvgpr_write_b32 a8, v52
    v_accvgpr_write_b32 a9, v53
    v_accvgpr_write_b32 a10, v54
    v_accvgpr_write_b32 a11, v55
    v_accvgpr_write_b32 a12, v56
    v_accvgpr_write_b32 a13, v57
    v_accvgpr_write_b32 a14, v58
    v_accvgpr_write_b32 a15, v59
    v_accvgpr_read_b32 v52, a16
    v_accvgpr_read_b32 v53, a17
    v_accvgpr_read_b32 v54, a18
    v_accvgpr_read_b32 v55, a19
    v_accvgpr_read_b32 v56, a20
    v_accvgpr_read_b32 v57, a21
    v_accvgpr_read_b32 v58, a22
    v_accvgpr_read_b32 v59, a23
    v_mul_f32 v52, v52, v49
    v_mul_f32 v53, v53, v49
    v_mul_f32 v54, v54, v49
    v_mul_f32 v55, v55, v49
    v_mul_f32 v56, v56, v49
    v_mul_f32 v57, v57, v49
    v_mul_f32 v58, v58, v49
    v_mul_f32 v59, v59, v49
    v_accvgpr_write_b32 a16, v52
    v_accvgpr_write_b32 a17, v53
    v_accvgpr_write_b32 a18, v54
    v_accvgpr_write_b32 a19, v55
    v_accvgpr_write_b32 a20, v56
    v_accvgpr_write_b32 a21, v57
    v_accvgpr_write_b32 a22, v58
    v_accvgpr_write_b32 a23, v59
    v_accvgpr_read_b32 v52, a24
    v_accvgpr_read_b32 v53, a25
    v_accvgpr_read_b32 v54, a26
    v_accvgpr_read_b32 v55, a27
    v_accvgpr_read_b32 v56, a28
    v_accvgpr_read_b32 v57, a29
    v_accvgpr_read_b32 v58, a30
    v_accvgpr_read_b32 v59, a31
    v_mul_f32 v52, v52, v49
    v_mul_f32 v53, v53, v49
    v_mul_f32 v54, v54, v49
    v_mul_f32 v55, v55, v49
    v_mul_f32 v56, v56, v49
    v_mul_f32 v57, v57, v49
    v_mul_f32 v58, v58, v49
    v_mul_f32 v59, v59, v49
    v_accvgpr_write_b32 a24, v52
    v_accvgpr_write_b32 a25, v53
    v_accvgpr_write_b32 a26, v54
    v_accvgpr_write_b32 a27, v55
    v_accvgpr_write_b32 a28, v56
    v_accvgpr_write_b32 a29, v57
    v_accvgpr_write_b32 a30, v58
    v_accvgpr_write_b32 a31, v59
    v_exp_f32 v52, v64
    v_exp_f32 v53, v65
    v_exp_f32 v54, v66
    v_exp_f32 v55, v67
    v_exp_f32 v56, v68
    v_exp_f32 v57, v69
    v_exp_f32 v58, v70
    v_exp_f32 v59, v71
    s_nop 0
    v_cvt_pk_bf16_f32 v128, v52, v53
    v_cvt_pk_bf16_f32 v129, v54, v55
    v_cvt_pk_bf16_f32 v130, v56, v57
    v_cvt_pk_bf16_f32 v131, v58, v59
    s_nop 1
    v_mfma_f32_16x16x32_bf16 v[28:31], v[44:47], v[128:131], 0
    v_max3_f32 v48, v72, v73, v74
    v_max3_f32 v48, v48, v75, v76
    v_max3_f32 v48, v48, v77, v78
    v_max3_f32 v48, v48, v79, 0
    v_mov_b32 v49, v48
    s_nop 1
    v_permlane32_swap_b32 v48, v49
    s_nop 1
    v_max_f32 v48, v48, v49
    v_mov_b32 v49, v48
    s_nop 1
    v_permlane16_swap_b32 v48, v49
    s_nop 1
    v_max_f32 v48, v48, v49
    v_exp_f32 v49, -v48
    v_sub_f32 v72, v72, v48
    v_sub_f32 v73, v73, v48
    v_sub_f32 v74, v74, v48
    v_sub_f32 v75, v75, v48
    v_sub_f32 v76, v76, v48
    v_sub_f32 v77, v77, v48
    v_sub_f32 v78, v78, v48
    v_sub_f32 v79, v79, v48
    v_sub_f32 v104, v104, v48
    v_sub_f32 v105, v105, v48
    v_sub_f32 v106, v106, v48
    v_sub_f32 v107, v107, v48
    v_sub_f32 v108, v108, v48
    v_sub_f32 v109, v109, v48
    v_sub_f32 v110, v110, v48
    v_sub_f32 v111, v111, v48
    v_sub_f32 v168, v168, v48
    v_sub_f32 v169, v169, v48
    v_sub_f32 v170, v170, v48
    v_sub_f32 v171, v171, v48
    v_sub_f32 v172, v172, v48
    v_sub_f32 v173, v173, v48
    v_sub_f32 v174, v174, v48
    v_sub_f32 v175, v175, v48
    v_mul_f32 v13, v13, v49
    v_accvgpr_read_b32 v52, a32
    v_accvgpr_read_b32 v53, a33
    v_accvgpr_read_b32 v54, a34
    v_accvgpr_read_b32 v55, a35
    v_accvgpr_read_b32 v56, a36
    v_accvgpr_read_b32 v57, a37
    v_accvgpr_read_b32 v58, a38
    v_accvgpr_read_b32 v59, a39
    v_mul_f32 v52, v52, v49
    v_mul_f32 v53, v53, v49
    v_mul_f32 v54, v54, v49
    v_mul_f32 v55, v55, v49
    v_mul_f32 v56, v56, v49
    v_mul_f32 v57, v57, v49
    v_mul_f32 v58, v58, v49
    v_mul_f32 v59, v59, v49
    v_accvgpr_write_b32 a32, v52
    v_accvgpr_write_b32 a33, v53
    v_accvgpr_write_b32 a34, v54
    v_accvgpr_write_b32 a35, v55
    v_accvgpr_write_b32 a36, v56
    v_accvgpr_write_b32 a37, v57
    v_accvgpr_write_b32 a38, v58
    v_accvgpr_write_b32 a39, v59
    v_accvgpr_read_b32 v52, a40
    v_accvgpr_read_b32 v53, a41
    v_accvgpr_read_b32 v54, a42
    v_accvgpr_read_b32 v55, a43
    v_accvgpr_read_b32 v56, a44
    v_accvgpr_read_b32 v57, a45
    v_accvgpr_read_b32 v58, a46
    v_accvgpr_read_b32 v59, a47
    v_mul_f32 v52, v52, v49
    v_mul_f32 v53, v53, v49
    v_mul_f32 v54, v54, v49
    v_mul_f32 v55, v55, v49
    v_mul_f32 v56, v56, v49
    v_mul_f32 v57, v57, v49
    v_mul_f32 v58, v58, v49
    v_mul_f32 v59, v59, v49
    v_accvgpr_write_b32 a40, v52
    v_accvgpr_write_b32 a41, v53
    v_accvgpr_write_b32 a42, v54
    v_accvgpr_write_b32 a43, v55
    v_accvgpr_write_b32 a44, v56
    v_accvgpr_write_b32 a45, v57
    v_accvgpr_write_b32 a46, v58
    v_accvgpr_write_b32 a47, v59
    v_accvgpr_read_b32 v52, a48
    v_accvgpr_read_b32 v53, a49
    v_accvgpr_read_b32 v54, a50
    v_accvgpr_read_b32 v55, a51
    v_accvgpr_read_b32 v56, a52
    v_accvgpr_read_b32 v57, a53
    v_accvgpr_read_b32 v58, a54
    v_accvgpr_read_b32 v59, a55
    v_mul_f32 v52, v52, v49
    v_mul_f32 v53, v53, v49
    v_mul_f32 v54, v54, v49
    v_mul_f32 v55, v55, v49
    v_mul_f32 v56, v56, v49
    v_mul_f32 v57, v57, v49
    v_mul_f32 v58, v58, v49
    v_mul_f32 v59, v59, v49
    v_accvgpr_write_b32 a48, v52
    v_accvgpr_write_b32 a49, v53
    v_accvgpr_write_b32 a50, v54
    v_accvgpr_write_b32 a51, v55
    v_accvgpr_write_b32 a52, v56
    v_accvgpr_write_b32 a53, v57
    v_accvgpr_write_b32 a54, v58
    v_accvgpr_write_b32 a55, v59
    v_accvgpr_read_b32 v52, a56
    v_accvgpr_read_b32 v53, a57
    v_accvgpr_read_b32 v54, a58
    v_accvgpr_read_b32 v55, a59
    v_accvgpr_read_b32 v56, a60
    v_accvgpr_read_b32 v57, a61
    v_accvgpr_read_b32 v58, a62
    v_accvgpr_read_b32 v59, a63
    v_mul_f32 v52, v52, v49
    v_mul_f32 v53, v53, v49
    v_mul_f32 v54, v54, v49
    v_mul_f32 v55, v55, v49
    v_mul_f32 v56, v56, v49
    v_mul_f32 v57, v57, v49
    v_mul_f32 v58, v58, v49
    v_mul_f32 v59, v59, v49
    v_accvgpr_write_b32 a56, v52
    v_accvgpr_write_b32 a57, v53
    v_accvgpr_write_b32 a58, v54
    v_accvgpr_write_b32 a59, v55
    v_accvgpr_write_b32 a60, v56
    v_accvgpr_write_b32 a61, v57
    v_accvgpr_write_b32 a62, v58
    v_accvgpr_write_b32 a63, v59
    v_exp_f32 v52, v72
    v_exp_f32 v53, v73
    v_exp_f32 v54, v74
    v_exp_f32 v55, v75
    v_exp_f32 v56, v76
    v_exp_f32 v57, v77
    v_exp_f32 v58, v78
    v_exp_f32 v59, v79
    s_nop 0
    v_cvt_pk_bf16_f32 v132, v52, v53
    v_cvt_pk_bf16_f32 v133, v54, v55
    v_cvt_pk_bf16_f32 v134, v56, v57
    v_cvt_pk_bf16_f32 v135, v58, v59
    s_nop 1
    v_mfma_f32_16x16x32_bf16 v[32:35], v[44:47], v[132:135], 0
    v_max3_f32 v48, v80, v81, v82
    v_max3_f32 v48, v48, v83, v84
    v_max3_f32 v48, v48, v85, v86
    v_max3_f32 v48, v48, v87, 0
    v_mov_b32 v49, v48
    s_nop 1
    v_permlane32_swap_b32 v48, v49
    s_nop 1
    v_max_f32 v48, v48, v49
    v_mov_b32 v49, v48
    s_nop 1
    v_permlane16_swap_b32 v48, v49
    s_nop 1
    v_max_f32 v48, v48, v49
    v_exp_f32 v49, -v48
    v_sub_f32 v80, v80, v48
    v_sub_f32 v81, v81, v48
    v_sub_f32 v82, v82, v48
    v_sub_f32 v83, v83, v48
    v_sub_f32 v84, v84, v48
    v_sub_f32 v85, v85, v48
    v_sub_f32 v86, v86, v48
    v_sub_f32 v87, v87, v48
    v_sub_f32 v112, v112, v48
    v_sub_f32 v113, v113, v48
    v_sub_f32 v114, v114, v48
    v_sub_f32 v115, v115, v48
    v_sub_f32 v116, v116, v48
    v_sub_f32 v117, v117, v48
    v_sub_f32 v118, v118, v48
    v_sub_f32 v119, v119, v48
    v_sub_f32 v176, v176, v48
    v_sub_f32 v177, v177, v48
    v_sub_f32 v178, v178, v48
    v_sub_f32 v179, v179, v48
    v_sub_f32 v180, v180, v48
    v_sub_f32 v181, v181, v48
    v_sub_f32 v182, v182, v48
    v_sub_f32 v183, v183, v48
    v_mul_f32 v14, v14, v49
    v_accvgpr_read_b32 v52, a64
    v_accvgpr_read_b32 v53, a65
    v_accvgpr_read_b32 v54, a66
    v_accvgpr_read_b32 v55, a67
    v_accvgpr_read_b32 v56, a68
    v_accvgpr_read_b32 v57, a69
    v_accvgpr_read_b32 v58, a70
    v_accvgpr_read_b32 v59, a71
    v_mul_f32 v52, v52, v49
    v_mul_f32 v53, v53, v49
    v_mul_f32 v54, v54, v49
    v_mul_f32 v55, v55, v49
    v_mul_f32 v56, v56, v49
    v_mul_f32 v57, v57, v49
    v_mul_f32 v58, v58, v49
    v_mul_f32 v59, v59, v49
    v_accvgpr_write_b32 a64, v52
    v_accvgpr_write_b32 a65, v53
    v_accvgpr_write_b32 a66, v54
    v_accvgpr_write_b32 a67, v55
    v_accvgpr_write_b32 a68, v56
    v_accvgpr_write_b32 a69, v57
    v_accvgpr_write_b32 a70, v58
    v_accvgpr_write_b32 a71, v59
    v_accvgpr_read_b32 v52, a72
    v_accvgpr_read_b32 v53, a73
    v_accvgpr_read_b32 v54, a74
    v_accvgpr_read_b32 v55, a75
    v_accvgpr_read_b32 v56, a76
    v_accvgpr_read_b32 v57, a77
    v_accvgpr_read_b32 v58, a78
    v_accvgpr_read_b32 v59, a79
    v_mul_f32 v52, v52, v49
    v_mul_f32 v53, v53, v49
    v_mul_f32 v54, v54, v49
    v_mul_f32 v55, v55, v49
    v_mul_f32 v56, v56, v49
    v_mul_f32 v57, v57, v49
    v_mul_f32 v58, v58, v49
    v_mul_f32 v59, v59, v49
    v_accvgpr_write_b32 a72, v52
    v_accvgpr_write_b32 a73, v53
    v_accvgpr_write_b32 a74, v54
    v_accvgpr_write_b32 a75, v55
    v_accvgpr_write_b32 a76, v56
    v_accvgpr_write_b32 a77, v57
    v_accvgpr_write_b32 a78, v58
    v_accvgpr_write_b32 a79, v59
    v_accvgpr_read_b32 v52, a80
    v_accvgpr_read_b32 v53, a81
    v_accvgpr_read_b32 v54, a82
    v_accvgpr_read_b32 v55, a83
    v_accvgpr_read_b32 v56, a84
    v_accvgpr_read_b32 v57, a85
    v_accvgpr_read_b32 v58, a86
    v_accvgpr_read_b32 v59, a87
    v_mul_f32 v52, v52, v49
    v_mul_f32 v53, v53, v49
    v_mul_f32 v54, v54, v49
    v_mul_f32 v55, v55, v49
    v_mul_f32 v56, v56, v49
    v_mul_f32 v57, v57, v49
    v_mul_f32 v58, v58, v49
    v_mul_f32 v59, v59, v49
    v_accvgpr_write_b32 a80, v52
    v_accvgpr_write_b32 a81, v53
    v_accvgpr_write_b32 a82, v54
    v_accvgpr_write_b32 a83, v55
    v_accvgpr_write_b32 a84, v56
    v_accvgpr_write_b32 a85, v57
    v_accvgpr_write_b32 a86, v58
    v_accvgpr_write_b32 a87, v59
    v_accvgpr_read_b32 v52, a88
    v_accvgpr_read_b32 v53, a89
    v_accvgpr_read_b32 v54, a90
    v_accvgpr_read_b32 v55, a91
    v_accvgpr_read_b32 v56, a92
    v_accvgpr_read_b32 v57, a93
    v_accvgpr_read_b32 v58, a94
    v_accvgpr_read_b32 v59, a95
    v_mul_f32 v52, v52, v49
    v_mul_f32 v53, v53, v49
    v_mul_f32 v54, v54, v49
    v_mul_f32 v55, v55, v49
    v_mul_f32 v56, v56, v49
    v_mul_f32 v57, v57, v49
    v_mul_f32 v58, v58, v49
    v_mul_f32 v59, v59, v49
    v_accvgpr_write_b32 a88, v52
    v_accvgpr_write_b32 a89, v53
    v_accvgpr_write_b32 a90, v54
    v_accvgpr_write_b32 a91, v55
    v_accvgpr_write_b32 a92, v56
    v_accvgpr_write_b32 a93, v57
    v_accvgpr_write_b32 a94, v58
    v_accvgpr_write_b32 a95, v59
    v_exp_f32 v52, v80
    v_exp_f32 v53, v81
    v_exp_f32 v54, v82
    v_exp_f32 v55, v83
    v_exp_f32 v56, v84
    v_exp_f32 v57, v85
    v_exp_f32 v58, v86
    v_exp_f32 v59, v87
    s_nop 0
    v_cvt_pk_bf16_f32 v136, v52, v53
    v_cvt_pk_bf16_f32 v137, v54, v55
    v_cvt_pk_bf16_f32 v138, v56, v57
    v_cvt_pk_bf16_f32 v139, v58, v59
    s_nop 1
    v_mfma_f32_16x16x32_bf16 v[36:39], v[44:47], v[136:139], 0
    v_max3_f32 v48, v88, v89, v90
    v_max3_f32 v48, v48, v91, v92
    v_max3_f32 v48, v48, v93, v94
    v_max3_f32 v48, v48, v95, 0
    v_mov_b32 v49, v48
    s_nop 1
    v_permlane32_swap_b32 v48, v49
    s_nop 1
    v_max_f32 v48, v48, v49
    v_mov_b32 v49, v48
    s_nop 1
    v_permlane16_swap_b32 v48, v49
    s_nop 1
    v_max_f32 v48, v48, v49
    v_exp_f32 v49, -v48
    v_sub_f32 v88, v88, v48
    v_sub_f32 v89, v89, v48
    v_sub_f32 v90, v90, v48
    v_sub_f32 v91, v91, v48
    v_sub_f32 v92, v92, v48
    v_sub_f32 v93, v93, v48
    v_sub_f32 v94, v94, v48
    v_sub_f32 v95, v95, v48
    v_sub_f32 v120, v120, v48
    v_sub_f32 v121, v121, v48
    v_sub_f32 v122, v122, v48
    v_sub_f32 v123, v123, v48
    v_sub_f32 v124, v124, v48
    v_sub_f32 v125, v125, v48
    v_sub_f32 v126, v126, v48
    v_sub_f32 v127, v127, v48
    v_sub_f32 v184, v184, v48
    v_sub_f32 v185, v185, v48
    v_sub_f32 v186, v186, v48
    v_sub_f32 v187, v187, v48
    v_sub_f32 v188, v188, v48
    v_sub_f32 v189, v189, v48
    v_sub_f32 v190, v190, v48
    v_sub_f32 v191, v191, v48
    v_mul_f32 v15, v15, v49
    v_accvgpr_read_b32 v52, a96
    v_accvgpr_read_b32 v53, a97
    v_accvgpr_read_b32 v54, a98
    v_accvgpr_read_b32 v55, a99
    v_accvgpr_read_b32 v56, a100
    v_accvgpr_read_b32 v57, a101
    v_accvgpr_read_b32 v58, a102
    v_accvgpr_read_b32 v59, a103
    v_mul_f32 v52, v52, v49
    v_mul_f32 v53, v53, v49
    v_mul_f32 v54, v54, v49
    v_mul_f32 v55, v55, v49
    v_mul_f32 v56, v56, v49
    v_mul_f32 v57, v57, v49
    v_mul_f32 v58, v58, v49
    v_mul_f32 v59, v59, v49
    v_accvgpr_write_b32 a96, v52
    v_accvgpr_write_b32 a97, v53
    v_accvgpr_write_b32 a98, v54
    v_accvgpr_write_b32 a99, v55
    v_accvgpr_write_b32 a100, v56
    v_accvgpr_write_b32 a101, v57
    v_accvgpr_write_b32 a102, v58
    v_accvgpr_write_b32 a103, v59
    v_accvgpr_read_b32 v52, a104
    v_accvgpr_read_b32 v53, a105
    v_accvgpr_read_b32 v54, a106
    v_accvgpr_read_b32 v55, a107
    v_accvgpr_read_b32 v56, a108
    v_accvgpr_read_b32 v57, a109
    v_accvgpr_read_b32 v58, a110
    v_accvgpr_read_b32 v59, a111
    v_mul_f32 v52, v52, v49
    v_mul_f32 v53, v53, v49
    v_mul_f32 v54, v54, v49
    v_mul_f32 v55, v55, v49
    v_mul_f32 v56, v56, v49
    v_mul_f32 v57, v57, v49
    v_mul_f32 v58, v58, v49
    v_mul_f32 v59, v59, v49
    v_accvgpr_write_b32 a104, v52
    v_accvgpr_write_b32 a105, v53
    v_accvgpr_write_b32 a106, v54
    v_accvgpr_write_b32 a107, v55
    v_accvgpr_write_b32 a108, v56
    v_accvgpr_write_b32 a109, v57
    v_accvgpr_write_b32 a110, v58
    v_accvgpr_write_b32 a111, v59
    v_accvgpr_read_b32 v52, a112
    v_accvgpr_read_b32 v53, a113
    v_accvgpr_read_b32 v54, a114
    v_accvgpr_read_b32 v55, a115
    v_accvgpr_read_b32 v56, a116
    v_accvgpr_read_b32 v57, a117
    v_accvgpr_read_b32 v58, a118
    v_accvgpr_read_b32 v59, a119
    v_mul_f32 v52, v52, v49
    v_mul_f32 v53, v53, v49
    v_mul_f32 v54, v54, v49
    v_mul_f32 v55, v55, v49
    v_mul_f32 v56, v56, v49
    v_mul_f32 v57, v57, v49
    v_mul_f32 v58, v58, v49
    v_mul_f32 v59, v59, v49
    v_accvgpr_write_b32 a112, v52
    v_accvgpr_write_b32 a113, v53
    v_accvgpr_write_b32 a114, v54
    v_accvgpr_write_b32 a115, v55
    v_accvgpr_write_b32 a116, v56
    v_accvgpr_write_b32 a117, v57
    v_accvgpr_write_b32 a118, v58
    v_accvgpr_write_b32 a119, v59
    v_accvgpr_read_b32 v52, a120
    v_accvgpr_read_b32 v53, a121
    v_accvgpr_read_b32 v54, a122
    v_accvgpr_read_b32 v55, a123
    v_accvgpr_read_b32 v56, a124
    v_accvgpr_read_b32 v57, a125
    v_accvgpr_read_b32 v58, a126
    v_accvgpr_read_b32 v59, a127
    v_mul_f32 v52, v52, v49
    v_mul_f32 v53, v53, v49
    v_mul_f32 v54, v54, v49
    v_mul_f32 v55, v55, v49
    v_mul_f32 v56, v56, v49
    v_mul_f32 v57, v57, v49
    v_mul_f32 v58, v58, v49
    v_mul_f32 v59, v59, v49
    v_accvgpr_write_b32 a120, v52
    v_accvgpr_write_b32 a121, v53
    v_accvgpr_write_b32 a122, v54
    v_accvgpr_write_b32 a123, v55
    v_accvgpr_write_b32 a124, v56
    v_accvgpr_write_b32 a125, v57
    v_accvgpr_write_b32 a126, v58
    v_accvgpr_write_b32 a127, v59
    v_exp_f32 v52, v88
    v_exp_f32 v53, v89
    v_exp_f32 v54, v90
    v_exp_f32 v55, v91
    v_exp_f32 v56, v92
    v_exp_f32 v57, v93
    v_exp_f32 v58, v94
    v_exp_f32 v59, v95
    s_nop 0
    v_cvt_pk_bf16_f32 v140, v52, v53
    v_cvt_pk_bf16_f32 v141, v54, v55
    v_cvt_pk_bf16_f32 v142, v56, v57
    v_cvt_pk_bf16_f32 v143, v58, v59
    s_nop 1
    v_mfma_f32_16x16x32_bf16 v[40:43], v[44:47], v[140:143], 0
    s_nop 7
    s_setpc_b64 s[70:71]
mega_kernel_rs1259:
    s_nop 15
    v_max3_f32 v48, v96, v97, v98
    v_max3_f32 v48, v48, v99, v100
    v_max3_f32 v48, v48, v101, v102
    v_max3_f32 v48, v48, v103, 0
    v_mov_b32 v49, v48
    s_nop 1
    v_permlane32_swap_b32 v48, v49
    s_nop 1
    v_max_f32 v48, v48, v49
    v_mov_b32 v49, v48
    s_nop 1
    v_permlane16_swap_b32 v48, v49
    s_nop 1
    v_max_f32 v48, v48, v49
    v_exp_f32 v49, -v48
    v_sub_f32 v96, v96, v48
    v_sub_f32 v97, v97, v48
    v_sub_f32 v98, v98, v48
    v_sub_f32 v99, v99, v48
    v_sub_f32 v100, v100, v48
    v_sub_f32 v101, v101, v48
    v_sub_f32 v102, v102, v48
    v_sub_f32 v103, v103, v48
    v_sub_f32 v64, v64, v48
    v_sub_f32 v65, v65, v48
    v_sub_f32 v66, v66, v48
    v_sub_f32 v67, v67, v48
    v_sub_f32 v68, v68, v48
    v_sub_f32 v69, v69, v48
    v_sub_f32 v70, v70, v48
    v_sub_f32 v71, v71, v48
    v_sub_f32 v160, v160, v48
    v_sub_f32 v161, v161, v48
    v_sub_f32 v162, v162, v48
    v_sub_f32 v163, v163, v48
    v_sub_f32 v164, v164, v48
    v_sub_f32 v165, v165, v48
    v_sub_f32 v166, v166, v48
    v_sub_f32 v167, v167, v48
    v_mul_f32 v12, v12, v49
    v_accvgpr_read_b32 v52, a0
    v_accvgpr_read_b32 v53, a1
    v_accvgpr_read_b32 v54, a2
    v_accvgpr_read_b32 v55, a3
    v_accvgpr_read_b32 v56, a4
    v_accvgpr_read_b32 v57, a5
    v_accvgpr_read_b32 v58, a6
    v_accvgpr_read_b32 v59, a7
    v_mul_f32 v52, v52, v49
    v_mul_f32 v53, v53, v49
    v_mul_f32 v54, v54, v49
    v_mul_f32 v55, v55, v49
    v_mul_f32 v56, v56, v49
    v_mul_f32 v57, v57, v49
    v_mul_f32 v58, v58, v49
    v_mul_f32 v59, v59, v49
    v_accvgpr_write_b32 a0, v52
    v_accvgpr_write_b32 a1, v53
    v_accvgpr_write_b32 a2, v54
    v_accvgpr_write_b32 a3, v55
    v_accvgpr_write_b32 a4, v56
    v_accvgpr_write_b32 a5, v57
    v_accvgpr_write_b32 a6, v58
    v_accvgpr_write_b32 a7, v59
    v_accvgpr_read_b32 v52, a8
    v_accvgpr_read_b32 v53, a9
    v_accvgpr_read_b32 v54, a10
    v_accvgpr_read_b32 v55, a11
    v_accvgpr_read_b32 v56, a12
    v_accvgpr_read_b32 v57, a13
    v_accvgpr_read_b32 v58, a14
    v_accvgpr_read_b32 v59, a15
    v_mul_f32 v52, v52, v49
    v_mul_f32 v53, v53, v49
    v_mul_f32 v54, v54, v49
    v_mul_f32 v55, v55, v49
    v_mul_f32 v56, v56, v49
    v_mul_f32 v57, v57, v49
    v_mul_f32 v58, v58, v49
    v_mul_f32 v59, v59, v49
    v_accvgpr_write_b32 a8, v52
    v_accvgpr_write_b32 a9, v53
    v_accvgpr_write_b32 a10, v54
    v_accvgpr_write_b32 a11, v55
    v_accvgpr_write_b32 a12, v56
    v_accvgpr_write_b32 a13, v57
    v_accvgpr_write_b32 a14, v58
    v_accvgpr_write_b32 a15, v59
    v_accvgpr_read_b32 v52, a16
    v_accvgpr_read_b32 v53, a17
    v_accvgpr_read_b32 v54, a18
    v_accvgpr_read_b32 v55, a19
    v_accvgpr_read_b32 v56, a20
    v_accvgpr_read_b32 v57, a21
    v_accvgpr_read_b32 v58, a22
    v_accvgpr_read_b32 v59, a23
    v_mul_f32 v52, v52, v49
    v_mul_f32 v53, v53, v49
    v_mul_f32 v54, v54, v49
    v_mul_f32 v55, v55, v49
    v_mul_f32 v56, v56, v49
    v_mul_f32 v57, v57, v49
    v_mul_f32 v58, v58, v49
    v_mul_f32 v59, v59, v49
    v_accvgpr_write_b32 a16, v52
    v_accvgpr_write_b32 a17, v53
    v_accvgpr_write_b32 a18, v54
    v_accvgpr_write_b32 a19, v55
    v_accvgpr_write_b32 a20, v56
    v_accvgpr_write_b32 a21, v57
    v_accvgpr_write_b32 a22, v58
    v_accvgpr_write_b32 a23, v59
    v_accvgpr_read_b32 v52, a24
    v_accvgpr_read_b32 v53, a25
    v_accvgpr_read_b32 v54, a26
    v_accvgpr_read_b32 v55, a27
    v_accvgpr_read_b32 v56, a28
    v_accvgpr_read_b32 v57, a29
    v_accvgpr_read_b32 v58, a30
    v_accvgpr_read_b32 v59, a31
    v_mul_f32 v52, v52, v49
    v_mul_f32 v53, v53, v49
    v_mul_f32 v54, v54, v49
    v_mul_f32 v55, v55, v49
    v_mul_f32 v56, v56, v49
    v_mul_f32 v57, v57, v49
    v_mul_f32 v58, v58, v49
    v_mul_f32 v59, v59, v49
    v_accvgpr_write_b32 a24, v52
    v_accvgpr_write_b32 a25, v53
    v_accvgpr_write_b32 a26, v54
    v_accvgpr_write_b32 a27, v55
    v_accvgpr_write_b32 a28, v56
    v_accvgpr_write_b32 a29, v57
    v_accvgpr_write_b32 a30, v58
    v_accvgpr_write_b32 a31, v59
    v_exp_f32 v52, v96
    v_exp_f32 v53, v97
    v_exp_f32 v54, v98
    v_exp_f32 v55, v99
    v_exp_f32 v56, v100
    v_exp_f32 v57, v101
    v_exp_f32 v58, v102
    v_exp_f32 v59, v103
    s_nop 0
    v_cvt_pk_bf16_f32 v144, v52, v53
    v_cvt_pk_bf16_f32 v145, v54, v55
    v_cvt_pk_bf16_f32 v146, v56, v57
    v_cvt_pk_bf16_f32 v147, v58, v59
    s_nop 1
    v_mfma_f32_16x16x32_bf16 v[28:31], v[44:47], v[144:147], 0
    v_max3_f32 v48, v104, v105, v106
    v_max3_f32 v48, v48, v107, v108
    v_max3_f32 v48, v48, v109, v110
    v_max3_f32 v48, v48, v111, 0
    v_mov_b32 v49, v48
    s_nop 1
    v_permlane32_swap_b32 v48, v49
    s_nop 1
    v_max_f32 v48, v48, v49
    v_mov_b32 v49, v48
    s_nop 1
    v_permlane16_swap_b32 v48, v49
    s_nop 1
    v_max_f32 v48, v48, v49
    v_exp_f32 v49, -v48
    v_sub_f32 v104, v104, v48
    v_sub_f32 v105, v105, v48
    v_sub_f32 v106, v106, v48
    v_sub_f32 v107, v107, v48
    v_sub_f32 v108, v108, v48
    v_sub_f32 v109, v109, v48
    v_sub_f32 v110, v110, v48
    v_sub_f32 v111, v111, v48
    v_sub_f32 v72, v72, v48
    v_sub_f32 v73, v73, v48
    v_sub_f32 v74, v74, v48
    v_sub_f32 v75, v75, v48
    v_sub_f32 v76, v76, v48
    v_sub_f32 v77, v77, v48
    v_sub_f32 v78, v78, v48
    v_sub_f32 v79, v79, v48
    v_sub_f32 v168, v168, v48
    v_sub_f32 v169, v169, v48
    v_sub_f32 v170, v170, v48
    v_sub_f32 v171, v171, v48
    v_sub_f32 v172, v172, v48
    v_sub_f32 v173, v173, v48
    v_sub_f32 v174, v174, v48
    v_sub_f32 v175, v175, v48
    v_mul_f32 v13, v13, v49
    v_accvgpr_read_b32 v52, a32
    v_accvgpr_read_b32 v53, a33
    v_accvgpr_read_b32 v54, a34
    v_accvgpr_read_b32 v55, a35
    v_accvgpr_read_b32 v56, a36
    v_accvgpr_read_b32 v57, a37
    v_accvgpr_read_b32 v58, a38
    v_accvgpr_read_b32 v59, a39
    v_mul_f32 v52, v52, v49
    v_mul_f32 v53, v53, v49
    v_mul_f32 v54, v54, v49
    v_mul_f32 v55, v55, v49
    v_mul_f32 v56, v56, v49
    v_mul_f32 v57, v57, v49
    v_mul_f32 v58, v58, v49
    v_mul_f32 v59, v59, v49
    v_accvgpr_write_b32 a32, v52
    v_accvgpr_write_b32 a33, v53
    v_accvgpr_write_b32 a34, v54
    v_accvgpr_write_b32 a35, v55
    v_accvgpr_write_b32 a36, v56
    v_accvgpr_write_b32 a37, v57
    v_accvgpr_write_b32 a38, v58
    v_accvgpr_write_b32 a39, v59
    v_accvgpr_read_b32 v52, a40
    v_accvgpr_read_b32 v53, a41
    v_accvgpr_read_b32 v54, a42
    v_accvgpr_read_b32 v55, a43
    v_accvgpr_read_b32 v56, a44
    v_accvgpr_read_b32 v57, a45
    v_accvgpr_read_b32 v58, a46
    v_accvgpr_read_b32 v59, a47
    v_mul_f32 v52, v52, v49
    v_mul_f32 v53, v53, v49
    v_mul_f32 v54, v54, v49
    v_mul_f32 v55, v55, v49
    v_mul_f32 v56, v56, v49
    v_mul_f32 v57, v57, v49
    v_mul_f32 v58, v58, v49
    v_mul_f32 v59, v59, v49
    v_accvgpr_write_b32 a40, v52
    v_accvgpr_write_b32 a41, v53
    v_accvgpr_write_b32 a42, v54
    v_accvgpr_write_b32 a43, v55
    v_accvgpr_write_b32 a44, v56
    v_accvgpr_write_b32 a45, v57
    v_accvgpr_write_b32 a46, v58
    v_accvgpr_write_b32 a47, v59
    v_accvgpr_read_b32 v52, a48
    v_accvgpr_read_b32 v53, a49
    v_accvgpr_read_b32 v54, a50
    v_accvgpr_read_b32 v55, a51
    v_accvgpr_read_b32 v56, a52
    v_accvgpr_read_b32 v57, a53
    v_accvgpr_read_b32 v58, a54
    v_accvgpr_read_b32 v59, a55
    v_mul_f32 v52, v52, v49
    v_mul_f32 v53, v53, v49
    v_mul_f32 v54, v54, v49
    v_mul_f32 v55, v55, v49
    v_mul_f32 v56, v56, v49
    v_mul_f32 v57, v57, v49
    v_mul_f32 v58, v58, v49
    v_mul_f32 v59, v59, v49
    v_accvgpr_write_b32 a48, v52
    v_accvgpr_write_b32 a49, v53
    v_accvgpr_write_b32 a50, v54
    v_accvgpr_write_b32 a51, v55
    v_accvgpr_write_b32 a52, v56
    v_accvgpr_write_b32 a53, v57
    v_accvgpr_write_b32 a54, v58
    v_accvgpr_write_b32 a55, v59
    v_accvgpr_read_b32 v52, a56
    v_accvgpr_read_b32 v53, a57
    v_accvgpr_read_b32 v54, a58
    v_accvgpr_read_b32 v55, a59
    v_accvgpr_read_b32 v56, a60
    v_accvgpr_read_b32 v57, a61
    v_accvgpr_read_b32 v58, a62
    v_accvgpr_read_b32 v59, a63
    v_mul_f32 v52, v52, v49
    v_mul_f32 v53, v53, v49
    v_mul_f32 v54, v54, v49
    v_mul_f32 v55, v55, v49
    v_mul_f32 v56, v56, v49
    v_mul_f32 v57, v57, v49
    v_mul_f32 v58, v58, v49
    v_mul_f32 v59, v59, v49
    v_accvgpr_write_b32 a56, v52
    v_accvgpr_write_b32 a57, v53
    v_accvgpr_write_b32 a58, v54
    v_accvgpr_write_b32 a59, v55
    v_accvgpr_write_b32 a60, v56
    v_accvgpr_write_b32 a61, v57
    v_accvgpr_write_b32 a62, v58
    v_accvgpr_write_b32 a63, v59
    v_exp_f32 v52, v104
    v_exp_f32 v53, v105
    v_exp_f32 v54, v106
    v_exp_f32 v55, v107
    v_exp_f32 v56, v108
    v_exp_f32 v57, v109
    v_exp_f32 v58, v110
    v_exp_f32 v59, v111
    s_nop 0
    v_cvt_pk_bf16_f32 v148, v52, v53
    v_cvt_pk_bf16_f32 v149, v54, v55
    v_cvt_pk_bf16_f32 v150, v56, v57
    v_cvt_pk_bf16_f32 v151, v58, v59
    s_nop 1
    v_mfma_f32_16x16x32_bf16 v[32:35], v[44:47], v[148:151], 0
    s_nop 7
    s_setpc_b64 s[70:71]
mega_kernel_rs1460:
    s_nop 15
    v_max3_f32 v48, v96, v97, v98
    v_max3_f32 v48, v48, v99, v100
    v_max3_f32 v48, v48, v101, v102
    v_max3_f32 v48, v48, v103, 0
    v_mov_b32 v49, v48
    s_nop 1
    v_permlane32_swap_b32 v48, v49
    s_nop 1
    v_max_f32 v48, v48, v49
    v_mov_b32 v49, v48
    s_nop 1
    v_permlane16_swap_b32 v48, v49
    s_nop 1
    v_max_f32 v48, v48, v49
    v_exp_f32 v49, -v48
    v_sub_f32 v96, v96, v48
    v_sub_f32 v97, v97, v48
    v_sub_f32 v98, v98, v48
    v_sub_f32 v99, v99, v48
    v_sub_f32 v100, v100, v48
    v_sub_f32 v101, v101, v48
    v_sub_f32 v102, v102, v48
    v_sub_f32 v103, v103, v48
    v_sub_f32 v64, v64, v48
    v_sub_f32 v65, v65, v48
    v_sub_f32 v66, v66, v48
    v_sub_f32 v67, v67, v48
    v_sub_f32 v68, v68, v48
    v_sub_f32 v69, v69, v48
    v_sub_f32 v70, v70, v48
    v_sub_f32 v71, v71, v48
    v_sub_f32 v160, v160, v48
    v_sub_f32 v161, v161, v48
    v_sub_f32 v162, v162, v48
    v_sub_f32 v163, v163, v48
    v_sub_f32 v164, v164, v48
    v_sub_f32 v165, v165, v48
    v_sub_f32 v166, v166, v48
    v_sub_f32 v167, v167, v48
    v_mul_f32 v12, v12, v49
    v_accvgpr_read_b32 v52, a0
    v_accvgpr_read_b32 v53, a1
    v_accvgpr_read_b32 v54, a2
    v_accvgpr_read_b32 v55, a3
    v_accvgpr_read_b32 v56, a4
    v_accvgpr_read_b32 v57, a5
    v_accvgpr_read_b32 v58, a6
    v_accvgpr_read_b32 v59, a7
    v_mul_f32 v52, v52, v49
    v_mul_f32 v53, v53, v49
    v_mul_f32 v54, v54, v49
    v_mul_f32 v55, v55, v49
    v_mul_f32 v56, v56, v49
    v_mul_f32 v57, v57, v49
    v_mul_f32 v58, v58, v49
    v_mul_f32 v59, v59, v49
    v_accvgpr_write_b32 a0, v52
    v_accvgpr_write_b32 a1, v53
    v_accvgpr_write_b32 a2, v54
    v_accvgpr_write_b32 a3, v55
    v_accvgpr_write_b32 a4, v56
    v_accvgpr_write_b32 a5, v57
    v_accvgpr_write_b32 a6, v58
    v_accvgpr_write_b32 a7, v59
    v_accvgpr_read_b32 v52, a8
    v_accvgpr_read_b32 v53, a9
    v_accvgpr_read_b32 v54, a10
    v_accvgpr_read_b32 v55, a11
    v_accvgpr_read_b32 v56, a12
    v_accvgpr_read_b32 v57, a13
    v_accvgpr_read_b32 v58, a14
    v_accvgpr_read_b32 v59, a15
    v_mul_f32 v52, v52, v49
    v_mul_f32 v53, v53, v49
    v_mul_f32 v54, v54, v49
    v_mul_f32 v55, v55, v49
    v_mul_f32 v56, v56, v49
    v_mul_f32 v57, v57, v49
    v_mul_f32 v58, v58, v49
    v_mul_f32 v59, v59, v49
    v_accvgpr_write_b32 a8, v52
    v_accvgpr_write_b32 a9, v53
    v_accvgpr_write_b32 a10, v54
    v_accvgpr_write_b32 a11, v55
    v_accvgpr_write_b32 a12, v56
    v_accvgpr_write_b32 a13, v57
    v_accvgpr_write_b32 a14, v58
    v_accvgpr_write_b32 a15, v59
    v_accvgpr_read_b32 v52, a16
    v_accvgpr_read_b32 v53, a17
    v_accvgpr_read_b32 v54, a18
    v_accvgpr_read_b32 v55, a19
    v_accvgpr_read_b32 v56, a20
    v_accvgpr_read_b32 v57, a21
    v_accvgpr_read_b32 v58, a22
    v_accvgpr_read_b32 v59, a23
    v_mul_f32 v52, v52, v49
    v_mul_f32 v53, v53, v49
    v_mul_f32 v54, v54, v49
    v_mul_f32 v55, v55, v49
    v_mul_f32 v56, v56, v49
    v_mul_f32 v57, v57, v49
    v_mul_f32 v58, v58, v49
    v_mul_f32 v59, v59, v49
    v_accvgpr_write_b32 a16, v52
    v_accvgpr_write_b32 a17, v53
    v_accvgpr_write_b32 a18, v54
    v_accvgpr_write_b32 a19, v55
    v_accvgpr_write_b32 a20, v56
    v_accvgpr_write_b32 a21, v57
    v_accvgpr_write_b32 a22, v58
    v_accvgpr_write_b32 a23, v59
    v_accvgpr_read_b32 v52, a24
    v_accvgpr_read_b32 v53, a25
    v_accvgpr_read_b32 v54, a26
    v_accvgpr_read_b32 v55, a27
    v_accvgpr_read_b32 v56, a28
    v_accvgpr_read_b32 v57, a29
    v_accvgpr_read_b32 v58, a30
    v_accvgpr_read_b32 v59, a31
    v_mul_f32 v52, v52, v49
    v_mul_f32 v53, v53, v49
    v_mul_f32 v54, v54, v49
    v_mul_f32 v55, v55, v49
    v_mul_f32 v56, v56, v49
    v_mul_f32 v57, v57, v49
    v_mul_f32 v58, v58, v49
    v_mul_f32 v59, v59, v49
    v_accvgpr_write_b32 a24, v52
    v_accvgpr_write_b32 a25, v53
    v_accvgpr_write_b32 a26, v54
    v_accvgpr_write_b32 a27, v55
    v_accvgpr_write_b32 a28, v56
    v_accvgpr_write_b32 a29, v57
    v_accvgpr_write_b32 a30, v58
    v_accvgpr_write_b32 a31, v59
    v_exp_f32 v52, v96
    v_exp_f32 v53, v97
    v_exp_f32 v54, v98
    v_exp_f32 v55, v99
    v_exp_f32 v56, v100
    v_exp_f32 v57, v101
    v_exp_f32 v58, v102
    v_exp_f32 v59, v103
    s_nop 0
    v_cvt_pk_bf16_f32 v144, v52, v53
    v_cvt_pk_bf16_f32 v145, v54, v55
    v_cvt_pk_bf16_f32 v146, v56, v57
    v_cvt_pk_bf16_f32 v147, v58, v59
    s_nop 1
    v_mfma_f32_16x16x32_bf16 v[28:31], v[44:47], v[144:147], 0
    v_max3_f32 v48, v104, v105, v106
    v_max3_f32 v48, v48, v107, v108
    v_max3_f32 v48, v48, v109, v110
    v_max3_f32 v48, v48, v111, 0
    v_mov_b32 v49, v48
    s_nop 1
    v_permlane32_swap_b32 v48, v49
    s_nop 1
    v_max_f32 v48, v48, v49
    v_mov_b32 v49, v48
    s_nop 1
    v_permlane16_swap_b32 v48, v49
    s_nop 1
    v_max_f32 v48, v48, v49
    v_exp_f32 v49, -v48
    v_sub_f32 v104, v104, v48
    v_sub_f32 v105, v105, v48
    v_sub_f32 v106, v106, v48
    v_sub_f32 v107, v107, v48
    v_sub_f32 v108, v108, v48
    v_sub_f32 v109, v109, v48
    v_sub_f32 v110, v110, v48
    v_sub_f32 v111, v111, v48
    v_sub_f32 v72, v72, v48
    v_sub_f32 v73, v73, v48
    v_sub_f32 v74, v74, v48
    v_sub_f32 v75, v75, v48
    v_sub_f32 v76, v76, v48
    v_sub_f32 v77, v77, v48
    v_sub_f32 v78, v78, v48
    v_sub_f32 v79, v79, v48
    v_sub_f32 v168, v168, v48
    v_sub_f32 v169, v169, v48
    v_sub_f32 v170, v170, v48
    v_sub_f32 v171, v171, v48
    v_sub_f32 v172, v172, v48
    v_sub_f32 v173, v173, v48
    v_sub_f32 v174, v174, v48
    v_sub_f32 v175, v175, v48
    v_mul_f32 v13, v13, v49
    v_accvgpr_read_b32 v52, a32
    v_accvgpr_read_b32 v53, a33
    v_accvgpr_read_b32 v54, a34
    v_accvgpr_read_b32 v55, a35
    v_accvgpr_read_b32 v56, a36
    v_accvgpr_read_b32 v57, a37
    v_accvgpr_read_b32 v58, a38
    v_accvgpr_read_b32 v59, a39
    v_mul_f32 v52, v52, v49
    v_mul_f32 v53, v53, v49
    v_mul_f32 v54, v54, v49
    v_mul_f32 v55, v55, v49
    v_mul_f32 v56, v56, v49
    v_mul_f32 v57, v57, v49
    v_mul_f32 v58, v58, v49
    v_mul_f32 v59, v59, v49
    v_accvgpr_write_b32 a32, v52
    v_accvgpr_write_b32 a33, v53
    v_accvgpr_write_b32 a34, v54
    v_accvgpr_write_b32 a35, v55
    v_accvgpr_write_b32 a36, v56
    v_accvgpr_write_b32 a37, v57
    v_accvgpr_write_b32 a38, v58
    v_accvgpr_write_b32 a39, v59
    v_accvgpr_read_b32 v52, a40
    v_accvgpr_read_b32 v53, a41
    v_accvgpr_read_b32 v54, a42
    v_accvgpr_read_b32 v55, a43
    v_accvgpr_read_b32 v56, a44
    v_accvgpr_read_b32 v57, a45
    v_accvgpr_read_b32 v58, a46
    v_accvgpr_read_b32 v59, a47
    v_mul_f32 v52, v52, v49
    v_mul_f32 v53, v53, v49
    v_mul_f32 v54, v54, v49
    v_mul_f32 v55, v55, v49
    v_mul_f32 v56, v56, v49
    v_mul_f32 v57, v57, v49
    v_mul_f32 v58, v58, v49
    v_mul_f32 v59, v59, v49
    v_accvgpr_write_b32 a40, v52
    v_accvgpr_write_b32 a41, v53
    v_accvgpr_write_b32 a42, v54
    v_accvgpr_write_b32 a43, v55
    v_accvgpr_write_b32 a44, v56
    v_accvgpr_write_b32 a45, v57
    v_accvgpr_write_b32 a46, v58
    v_accvgpr_write_b32 a47, v59
    v_accvgpr_read_b32 v52, a48
    v_accvgpr_read_b32 v53, a49
    v_accvgpr_read_b32 v54, a50
    v_accvgpr_read_b32 v55, a51
    v_accvgpr_read_b32 v56, a52
    v_accvgpr_read_b32 v57, a53
    v_accvgpr_read_b32 v58, a54
    v_accvgpr_read_b32 v59, a55
    v_mul_f32 v52, v52, v49
    v_mul_f32 v53, v53, v49
    v_mul_f32 v54, v54, v49
    v_mul_f32 v55, v55, v49
    v_mul_f32 v56, v56, v49
    v_mul_f32 v57, v57, v49
    v_mul_f32 v58, v58, v49
    v_mul_f32 v59, v59, v49
    v_accvgpr_write_b32 a48, v52
    v_accvgpr_write_b32 a49, v53
    v_accvgpr_write_b32 a50, v54
    v_accvgpr_write_b32 a51, v55
    v_accvgpr_write_b32 a52, v56
    v_accvgpr_write_b32 a53, v57
    v_accvgpr_write_b32 a54, v58
    v_accvgpr_write_b32 a55, v59
    v_accvgpr_read_b32 v52, a56
    v_accvgpr_read_b32 v53, a57
    v_accvgpr_read_b32 v54, a58
    v_accvgpr_read_b32 v55, a59
    v_accvgpr_read_b32 v56, a60
    v_accvgpr_read_b32 v57, a61
    v_accvgpr_read_b32 v58, a62
    v_accvgpr_read_b32 v59, a63
    v_mul_f32 v52, v52, v49
    v_mul_f32 v53, v53, v49
    v_mul_f32 v54, v54, v49
    v_mul_f32 v55, v55, v49
    v_mul_f32 v56, v56, v49
    v_mul_f32 v57, v57, v49
    v_mul_f32 v58, v58, v49
    v_mul_f32 v59, v59, v49
    v_accvgpr_write_b32 a56, v52
    v_accvgpr_write_b32 a57, v53
    v_accvgpr_write_b32 a58, v54
    v_accvgpr_write_b32 a59, v55
    v_accvgpr_write_b32 a60, v56
    v_accvgpr_write_b32 a61, v57
    v_accvgpr_write_b32 a62, v58
    v_accvgpr_write_b32 a63, v59
    v_exp_f32 v52, v104
    v_exp_f32 v53, v105
    v_exp_f32 v54, v106
    v_exp_f32 v55, v107
    v_exp_f32 v56, v108
    v_exp_f32 v57, v109
    v_exp_f32 v58, v110
    v_exp_f32 v59, v111
    s_nop 0
    v_cvt_pk_bf16_f32 v148, v52, v53
    v_cvt_pk_bf16_f32 v149, v54, v55
    v_cvt_pk_bf16_f32 v150, v56, v57
    v_cvt_pk_bf16_f32 v151, v58, v59
    s_nop 1
    v_mfma_f32_16x16x32_bf16 v[32:35], v[44:47], v[148:151], 0
    v_max3_f32 v48, v112, v113, v114
    v_max3_f32 v48, v48, v115, v116
    v_max3_f32 v48, v48, v117, v118
    v_max3_f32 v48, v48, v119, 0
    v_mov_b32 v49, v48
    s_nop 1
    v_permlane32_swap_b32 v48, v49
    s_nop 1
    v_max_f32 v48, v48, v49
    v_mov_b32 v49, v48
    s_nop 1
    v_permlane16_swap_b32 v48, v49
    s_nop 1
    v_max_f32 v48, v48, v49
    v_exp_f32 v49, -v48
    v_sub_f32 v112, v112, v48
    v_sub_f32 v113, v113, v48
    v_sub_f32 v114, v114, v48
    v_sub_f32 v115, v115, v48
    v_sub_f32 v116, v116, v48
    v_sub_f32 v117, v117, v48
    v_sub_f32 v118, v118, v48
    v_sub_f32 v119, v119, v48
    v_sub_f32 v80, v80, v48
    v_sub_f32 v81, v81, v48
    v_sub_f32 v82, v82, v48
    v_sub_f32 v83, v83, v48
    v_sub_f32 v84, v84, v48
    v_sub_f32 v85, v85, v48
    v_sub_f32 v86, v86, v48
    v_sub_f32 v87, v87, v48
    v_sub_f32 v176, v176, v48
    v_sub_f32 v177, v177, v48
    v_sub_f32 v178, v178, v48
    v_sub_f32 v179, v179, v48
    v_sub_f32 v180, v180, v48
    v_sub_f32 v181, v181, v48
    v_sub_f32 v182, v182, v48
    v_sub_f32 v183, v183, v48
    v_mul_f32 v14, v14, v49
    v_accvgpr_read_b32 v52, a64
    v_accvgpr_read_b32 v53, a65
    v_accvgpr_read_b32 v54, a66
    v_accvgpr_read_b32 v55, a67
    v_accvgpr_read_b32 v56, a68
    v_accvgpr_read_b32 v57, a69
    v_accvgpr_read_b32 v58, a70
    v_accvgpr_read_b32 v59, a71
    v_mul_f32 v52, v52, v49
    v_mul_f32 v53, v53, v49
    v_mul_f32 v54, v54, v49
    v_mul_f32 v55, v55, v49
    v_mul_f32 v56, v56, v49
    v_mul_f32 v57, v57, v49
    v_mul_f32 v58, v58, v49
    v_mul_f32 v59, v59, v49
    v_accvgpr_write_b32 a64, v52
    v_accvgpr_write_b32 a65, v53
    v_accvgpr_write_b32 a66, v54
    v_accvgpr_write_b32 a67, v55
    v_accvgpr_write_b32 a68, v56
    v_accvgpr_write_b32 a69, v57
    v_accvgpr_write_b32 a70, v58
    v_accvgpr_write_b32 a71, v59
    v_accvgpr_read_b32 v52, a72
    v_accvgpr_read_b32 v53, a73
    v_accvgpr_read_b32 v54, a74
    v_accvgpr_read_b32 v55, a75
    v_accvgpr_read_b32 v56, a76
    v_accvgpr_read_b32 v57, a77
    v_accvgpr_read_b32 v58, a78
    v_accvgpr_read_b32 v59, a79
    v_mul_f32 v52, v52, v49
    v_mul_f32 v53, v53, v49
    v_mul_f32 v54, v54, v49
    v_mul_f32 v55, v55, v49
    v_mul_f32 v56, v56, v49
    v_mul_f32 v57, v57, v49
    v_mul_f32 v58, v58, v49
    v_mul_f32 v59, v59, v49
    v_accvgpr_write_b32 a72, v52
    v_accvgpr_write_b32 a73, v53
    v_accvgpr_write_b32 a74, v54
    v_accvgpr_write_b32 a75, v55
    v_accvgpr_write_b32 a76, v56
    v_accvgpr_write_b32 a77, v57
    v_accvgpr_write_b32 a78, v58
    v_accvgpr_write_b32 a79, v59
    v_accvgpr_read_b32 v52, a80
    v_accvgpr_read_b32 v53, a81
    v_accvgpr_read_b32 v54, a82
    v_accvgpr_read_b32 v55, a83
    v_accvgpr_read_b32 v56, a84
    v_accvgpr_read_b32 v57, a85
    v_accvgpr_read_b32 v58, a86
    v_accvgpr_read_b32 v59, a87
    v_mul_f32 v52, v52, v49
    v_mul_f32 v53, v53, v49
    v_mul_f32 v54, v54, v49
    v_mul_f32 v55, v55, v49
    v_mul_f32 v56, v56, v49
    v_mul_f32 v57, v57, v49
    v_mul_f32 v58, v58, v49
    v_mul_f32 v59, v59, v49
    v_accvgpr_write_b32 a80, v52
    v_accvgpr_write_b32 a81, v53
    v_accvgpr_write_b32 a82, v54
    v_accvgpr_write_b32 a83, v55
    v_accvgpr_write_b32 a84, v56
    v_accvgpr_write_b32 a85, v57
    v_accvgpr_write_b32 a86, v58
    v_accvgpr_write_b32 a87, v59
    v_accvgpr_read_b32 v52, a88
    v_accvgpr_read_b32 v53, a89
    v_accvgpr_read_b32 v54, a90
    v_accvgpr_read_b32 v55, a91
    v_accvgpr_read_b32 v56, a92
    v_accvgpr_read_b32 v57, a93
    v_accvgpr_read_b32 v58, a94
    v_accvgpr_read_b32 v59, a95
    v_mul_f32 v52, v52, v49
    v_mul_f32 v53, v53, v49
    v_mul_f32 v54, v54, v49
    v_mul_f32 v55, v55, v49
    v_mul_f32 v56, v56, v49
    v_mul_f32 v57, v57, v49
    v_mul_f32 v58, v58, v49
    v_mul_f32 v59, v59, v49
    v_accvgpr_write_b32 a88, v52
    v_accvgpr_write_b32 a89, v53
    v_accvgpr_write_b32 a90, v54
    v_accvgpr_write_b32 a91, v55
    v_accvgpr_write_b32 a92, v56
    v_accvgpr_write_b32 a93, v57
    v_accvgpr_write_b32 a94, v58
    v_accvgpr_write_b32 a95, v59
    v_exp_f32 v52, v112
    v_exp_f32 v53, v113
    v_exp_f32 v54, v114
    v_exp_f32 v55, v115
    v_exp_f32 v56, v116
    v_exp_f32 v57, v117
    v_exp_f32 v58, v118
    v_exp_f32 v59, v119
    s_nop 0
    v_cvt_pk_bf16_f32 v152, v52, v53
    v_cvt_pk_bf16_f32 v153, v54, v55
    v_cvt_pk_bf16_f32 v154, v56, v57
    v_cvt_pk_bf16_f32 v155, v58, v59
    s_nop 1
    v_mfma_f32_16x16x32_bf16 v[36:39], v[44:47], v[152:155], 0
    v_max3_f32 v48, v120, v121, v122
    v_max3_f32 v48, v48, v123, v124
    v_max3_f32 v48, v48, v125, v126
    v_max3_f32 v48, v48, v127, 0
    v_mov_b32 v49, v48
    s_nop 1
    v_permlane32_swap_b32 v48, v49
    s_nop 1
    v_max_f32 v48, v48, v49
    v_mov_b32 v49, v48
    s_nop 1
    v_permlane16_swap_b32 v48, v49
    s_nop 1
    v_max_f32 v48, v48, v49
    v_exp_f32 v49, -v48
    v_sub_f32 v120, v120, v48
    v_sub_f32 v121, v121, v48
    v_sub_f32 v122, v122, v48
    v_sub_f32 v123, v123, v48
    v_sub_f32 v124, v124, v48
    v_sub_f32 v125, v125, v48
    v_sub_f32 v126, v126, v48
    v_sub_f32 v127, v127, v48
    v_sub_f32 v88, v88, v48
    v_sub_f32 v89, v89, v48
    v_sub_f32 v90, v90, v48
    v_sub_f32 v91, v91, v48
    v_sub_f32 v92, v92, v48
    v_sub_f32 v93, v93, v48
    v_sub_f32 v94, v94, v48
    v_sub_f32 v95, v95, v48
    v_sub_f32 v184, v184, v48
    v_sub_f32 v185, v185, v48
    v_sub_f32 v186, v186, v48
    v_sub_f32 v187, v187, v48
    v_sub_f32 v188, v188, v48
    v_sub_f32 v189, v189, v48
    v_sub_f32 v190, v190, v48
    v_sub_f32 v191, v191, v48
    v_mul_f32 v15, v15, v49
    v_accvgpr_read_b32 v52, a96
    v_accvgpr_read_b32 v53, a97
    v_accvgpr_read_b32 v54, a98
    v_accvgpr_read_b32 v55, a99
    v_accvgpr_read_b32 v56, a100
    v_accvgpr_read_b32 v57, a101
    v_accvgpr_read_b32 v58, a102
    v_accvgpr_read_b32 v59, a103
    v_mul_f32 v52, v52, v49
    v_mul_f32 v53, v53, v49
    v_mul_f32 v54, v54, v49
    v_mul_f32 v55, v55, v49
    v_mul_f32 v56, v56, v49
    v_mul_f32 v57, v57, v49
    v_mul_f32 v58, v58, v49
    v_mul_f32 v59, v59, v49
    v_accvgpr_write_b32 a96, v52
    v_accvgpr_write_b32 a97, v53
    v_accvgpr_write_b32 a98, v54
    v_accvgpr_write_b32 a99, v55
    v_accvgpr_write_b32 a100, v56
    v_accvgpr_write_b32 a101, v57
    v_accvgpr_write_b32 a102, v58
    v_accvgpr_write_b32 a103, v59
    v_accvgpr_read_b32 v52, a104
    v_accvgpr_read_b32 v53, a105
    v_accvgpr_read_b32 v54, a106
    v_accvgpr_read_b32 v55, a107
    v_accvgpr_read_b32 v56, a108
    v_accvgpr_read_b32 v57, a109
    v_accvgpr_read_b32 v58, a110
    v_accvgpr_read_b32 v59, a111
    v_mul_f32 v52, v52, v49
    v_mul_f32 v53, v53, v49
    v_mul_f32 v54, v54, v49
    v_mul_f32 v55, v55, v49
    v_mul_f32 v56, v56, v49
    v_mul_f32 v57, v57, v49
    v_mul_f32 v58, v58, v49
    v_mul_f32 v59, v59, v49
    v_accvgpr_write_b32 a104, v52
    v_accvgpr_write_b32 a105, v53
    v_accvgpr_write_b32 a106, v54
    v_accvgpr_write_b32 a107, v55
    v_accvgpr_write_b32 a108, v56
    v_accvgpr_write_b32 a109, v57
    v_accvgpr_write_b32 a110, v58
    v_accvgpr_write_b32 a111, v59
    v_accvgpr_read_b32 v52, a112
    v_accvgpr_read_b32 v53, a113
    v_accvgpr_read_b32 v54, a114
    v_accvgpr_read_b32 v55, a115
    v_accvgpr_read_b32 v56, a116
    v_accvgpr_read_b32 v57, a117
    v_accvgpr_read_b32 v58, a118
    v_accvgpr_read_b32 v59, a119
    v_mul_f32 v52, v52, v49
    v_mul_f32 v53, v53, v49
    v_mul_f32 v54, v54, v49
    v_mul_f32 v55, v55, v49
    v_mul_f32 v56, v56, v49
    v_mul_f32 v57, v57, v49
    v_mul_f32 v58, v58, v49
    v_mul_f32 v59, v59, v49
    v_accvgpr_write_b32 a112, v52
    v_accvgpr_write_b32 a113, v53
    v_accvgpr_write_b32 a114, v54
    v_accvgpr_write_b32 a115, v55
    v_accvgpr_write_b32 a116, v56
    v_accvgpr_write_b32 a117, v57
    v_accvgpr_write_b32 a118, v58
    v_accvgpr_write_b32 a119, v59
    v_accvgpr_read_b32 v52, a120
    v_accvgpr_read_b32 v53, a121
    v_accvgpr_read_b32 v54, a122
    v_accvgpr_read_b32 v55, a123
    v_accvgpr_read_b32 v56, a124
    v_accvgpr_read_b32 v57, a125
    v_accvgpr_read_b32 v58, a126
    v_accvgpr_read_b32 v59, a127
    v_mul_f32 v52, v52, v49
    v_mul_f32 v53, v53, v49
    v_mul_f32 v54, v54, v49
    v_mul_f32 v55, v55, v49
    v_mul_f32 v56, v56, v49
    v_mul_f32 v57, v57, v49
    v_mul_f32 v58, v58, v49
    v_mul_f32 v59, v59, v49
    v_accvgpr_write_b32 a120, v52
    v_accvgpr_write_b32 a121, v53
    v_accvgpr_write_b32 a122, v54
    v_accvgpr_write_b32 a123, v55
    v_accvgpr_write_b32 a124, v56
    v_accvgpr_write_b32 a125, v57
    v_accvgpr_write_b32 a126, v58
    v_accvgpr_write_b32 a127, v59
    v_exp_f32 v52, v120
    v_exp_f32 v53, v121
    v_exp_f32 v54, v122
    v_exp_f32 v55, v123
    v_exp_f32 v56, v124
    v_exp_f32 v57, v125
    v_exp_f32 v58, v126
    v_exp_f32 v59, v127
    s_nop 0
    v_cvt_pk_bf16_f32 v156, v52, v53
    v_cvt_pk_bf16_f32 v157, v54, v55
    v_cvt_pk_bf16_f32 v158, v56, v57
    v_cvt_pk_bf16_f32 v159, v58, v59
    s_nop 1
    v_mfma_f32_16x16x32_bf16 v[40:43], v[44:47], v[156:159], 0
    s_nop 7
    s_setpc_b64 s[70:71]
mega_kernel_dosw16:
    s_cmp_eq_u32 s17, -1
    s_cbranch_scc1 mega_kernel_x34
    s_cmp_lg_u32 s16, 0
    s_cbranch_scc1 mega_kernel_np40
    v_mov_b32 v4, s4
    v_mov_b32 v5, s5
    s_add_u32 s90, s17, 117440512
    s_mov_b64 exec, 1
    buffer_store_dwordx2 v[4:5], off, s[8:11], s90 sc1
    s_mov_b64 exec, -1
mega_kernel_np40:
    s_mov_b32 s17, -1
    s_mov_b32 s67, 3
    s_branch mega_kernel_nosw15
mega_kernel_x34:
    s_cmp_eq_u32 s94, 0
    s_cbranch_scc1 mega_kernel_x35
    s_mov_b32 s42, s73
    s_mov_b32 s46, s76
    s_lshl_b32 s90, s77, 4
    s_lshl_b32 s90, s90, s81
    s_mov_b32 s48, s79
    s_mul_i32 s91, s90, 1
    s_add_u32 s49, s91, s79
    s_sub_u32 s49, s49, 2048
    s_mul_i32 s91, s90, 2
    s_add_u32 s50, s91, s79
    s_mul_i32 s91, s90, 3
    s_add_u32 s51, s91, s79
    s_sub_u32 s51, s51, 2048
    s_mov_b32 s52, s80
    s_lshl_b32 s90, s78, 2
    s_mul_i32 s91, s90, 1
    s_add_u32 s53, s91, s80
    s_sub_u32 s53, s53, 2048
    s_mul_i32 s91, s90, 2
    s_add_u32 s54, s91, s80
    s_mul_i32 s91, s90, 3
    s_add_u32 s55, s91, s80
    s_sub_u32 s55, s55, 2048
    s_lshl_b32 s56, s78, 6
    s_lshl_b32 s90, s58, 7
    s_add_u32 s90, s90, s57
    s_lshl_b32 s91, s16, 6
    s_cmp_eq_u32 s81, 1
    s_cselect_b32 s90, s90, s91
    v_lshrrev_b32 v24, 3, v1
    v_lshlrev_b32 v24, s81, v24
    v_add_u32 v24, s90, v24
    v_mul_lo_u32 v24, v24, s77
    v_lshrrev_b32 v25, 4, v1
    v_and_b32 v26, 7, v1
    v_xor_b32 v25, v25, v26
    v_lshl_add_u32 v16, v25, 4, v24
    v_xor_b32 v25, 4, v25
    v_lshl_add_u32 v17, v25, 4, v24
    s_lshl_b32 s90, s77, 3
    s_lshl_b32 s90, s90, s81
    s_sub_u32 s90, s90, 1024
    v_add_u32 v17, s90, v17
    v_lshrrev_b32 v24, 5, v1
    s_lshl_b32 s90, s16, 4
    v_add_u32 v25, s90, v24
    v_mul_lo_u32 v25, v25, s78
    v_lshlrev_b32 v24, 1, v24
    v_and_b32 v26, 31, v1
    v_xor_b32 v24, v24, v26
    s_lshl_b32 s90, s78, 1
    s_sub_u32 s90, s90, 1024
    v_add_u32 v27, s90, v25
    v_xor_b32 v26, 0, v24
    v_lshl_add_u32 v18, v26, 4, v25
    v_xor_b32 v26, 4, v24
    v_lshl_add_u32 v19, v26, 4, v27
    v_xor_b32 v26, 8, v24
    v_lshl_add_u32 v20, v26, 4, v25
    v_xor_b32 v26, 12, v24
    v_lshl_add_u32 v21, v26, 4, v27
    s_mov_b32 s40, s71
    s_mov_b32 s41, s72
    s_mov_b32 s44, s74
    s_mov_b32 s45, s75
    buffer_load_dwordx2 v[4:5], off, s[12:15], 0 sc1
    s_mov_b32 s67, 0
    s_branch mega_kernel_nosw15
mega_kernel_x35:
    s_cmp_eq_u32 s70, 1
    s_cbranch_scc1 mega_kernel_x39
    s_cmp_lg_u32 s65, 3
    s_cbranch_scc1 mega_kernel_x37
    s_and_b32 s92, s2, 7
    s_lshl_b32 s92, s92, 2
    s_bfe_u32 s93, s2, 0x20003
    s_add_u32 s92, s92, s93
    s_lshr_b32 s93, s2, 5
    s_lshl_b32 s93, s93, 2
    s_or_b32 s93, s93, 0x40000
    s_lshr_b32 s90, s92, 1
    s_lshl_b32 s90, s90, 7
    s_add_u32 s90, s90, 117440512
    s_bfe_u32 s91, 1645237363, s93
    s_lshr_b32 s91, s91, 1
    v_add_u32 v0, 8, v1
    v_mov_b32 v4, s91
    v_cmp_gt_u32 vcc, 6, v1
    s_bfe_u32 s91, 4242446987, s93
    s_lshr_b32 s91, s91, 1
    v_cndmask_b32 v0, v4, v0, vcc
    v_writelane_b32 v0, s91, 6
    v_lshlrev_b32 v0, 3, v0
    buffer_load_dwordx2 v[4:5], v0, s[8:11], s90 offen sc1
    s_branch mega_kernel_nosw15
mega_kernel_x37:
    s_cmp_lg_u32 s65, 2
    s_cbranch_scc1 mega_kernel_x38
    s_waitcnt vmcnt(16)
    s_mov_b32 s3, 1048576
mega_kernel_spin41:
    v_cmp_ne_u64 s[22:23], s[4:5], v[4:5]
    s_nop 3
    s_cmp_eq_u64 s[22:23], 0
    s_cbranch_scc1 mega_kernel_ok42
    s_sub_u32 s3, s3, 1
    s_cbranch_scc1 mega_kernel_ok42
    s_sleep 32
    s_and_b32 s92, s2, 7
    s_lshl_b32 s92, s92, 2
    s_bfe_u32 s93, s2, 0x20003
    s_add_u32 s92, s92, s93
    s_lshr_b32 s93, s2, 5
    s_lshl_b32 s93, s93, 2
    s_or_b32 s93, s93, 0x40000
    s_lshr_b32 s90, s92, 1
    s_lshl_b32 s90, s90, 7
    s_add_u32 s90, s90, 117440512
    s_bfe_u32 s91, 1645237363, s93
    s_lshr_b32 s91, s91, 1
    v_add_u32 v0, 8, v1
    v_mov_b32 v4, s91
    v_cmp_gt_u32 vcc, 6, v1
    s_bfe_u32 s91, 4242446987, s93
    s_lshr_b32 s91, s91, 1
    v_cndmask_b32 v0, v4, v0, vcc
    v_writelane_b32 v0, s91, 6
    v_lshlrev_b32 v0, 3, v0
    buffer_load_dwordx2 v[4:5], v0, s[8:11], s90 offen sc1
    s_waitcnt vmcnt(0)
    s_branch mega_kernel_spin41
mega_kernel_ok42:
    s_and_b32 s92, s2, 7
    s_lshl_b32 s92, s92, 2
    s_bfe_u32 s93, s2, 0x20003
    s_add_u32 s92, s92, s93
    s_lshr_b32 s93, s2, 5
    s_lshl_b32 s93, s93, 2
    s_or_b32 s93, s93, 0x40000
    s_bfe_u32 s90, 4242446987, s93
    s_lshl_b32 s90, s90, 3
    s_lshl_b32 s91, s16, 1
    s_add_u32 s90, s90, s91
    s_lshl_b32 s90, s90, 12
    s_lshl_b32 s91, s92, 19
    s_add_u32 s90, s90, s91
    s_add_u32 s90, s90, 0
    buffer_load_dwordx4 a[128:131], v2, s[8:11], s90 offen offset:0 sc1
    buffer_load_dwordx4 a[132:135], v2, s[8:11], s90 offen offset:1024 sc1
    buffer_load_dwordx4 a[136:139], v2, s[8:11], s90 offen offset:2048 sc1
    buffer_load_dwordx4 a[140:143], v2, s[8:11], s90 offen offset:3072 sc1
    s_bfe_u32 s90, 4242446987, s93
    s_lshl_b32 s90, s90, 3
    s_lshl_b32 s91, s16, 1
    s_add_u32 s90, s90, s91
    s_lshl_b32 s90, s90, 12
    s_lshl_b32 s91, s92, 19
    s_add_u32 s90, s90, s91
    s_add_u32 s90, s90, 4096
    buffer_load_dwordx4 a[144:147], v2, s[8:11], s90 offen offset:0 sc1
    buffer_load_dwordx4 a[148:151], v2, s[8:11], s90 offen offset:1024 sc1
    buffer_load_dwordx4 a[152:155], v2, s[8:11], s90 offen offset:2048 sc1
    buffer_load_dwordx4 a[156:159], v2, s[8:11], s90 offen offset:3072 sc1
mega_kernel_x39:
    s_mov_b32 s42, 0
    s_mov_b32 s46, 0
    s_branch mega_kernel_nosw15
mega_kernel_x38:
    s_and_b32 s92, s2, 7
    s_lshl_b32 s92, s92, 2
    s_bfe_u32 s93, s2, 0x20003
    s_add_u32 s92, s92, s93
    s_lshr_b32 s93, s2, 5
    s_lshl_b32 s93, s93, 2
    s_or_b32 s93, s93, 0x40000
    s_bfe_u32 s90, 1645237363, s93
    s_lshl_b32 s90, s90, 3
    s_lshl_b32 s91, s16, 1
    s_add_u32 s90, s90, s91
    s_lshl_b32 s90, s90, 12
    s_lshl_b32 s91, s92, 19
    s_add_u32 s90, s90, s91
    s_add_u32 s90, s90, 0
    buffer_load_dwordx4 a[160:163], v2, s[8:11], s90 offen offset:0 sc1
    buffer_load_dwordx4 a[164:167], v2, s[8:11], s90 offen offset:1024 sc1
    buffer_load_dwordx4 a[168:171], v2, s[8:11], s90 offen offset:2048 sc1
    buffer_load_dwordx4 a[172:175], v2, s[8:11], s90 offen offset:3072 sc1
    s_bfe_u32 s90, 1645237363, s93
    s_lshl_b32 s90, s90, 3
    s_lshl_b32 s91, s16, 1
    s_add_u32 s90, s90, s91
    s_lshl_b32 s90, s90, 12
    s_lshl_b32 s91, s92, 19
    s_add_u32 s90, s90, s91
    s_add_u32 s90, s90, 4096
    buffer_load_dwordx4 a[176:179], v2, s[8:11], s90 offen offset:0 sc1
    buffer_load_dwordx4 a[180:183], v2, s[8:11], s90 offen offset:1024 sc1
    buffer_load_dwordx4 a[184:187], v2, s[8:11], s90 offen offset:2048 sc1
    buffer_load_dwordx4 a[188:191], v2, s[8:11], s90 offen offset:3072 sc1
    s_branch mega_kernel_nosw15
mega_kernel_dosw20:
    s_cmp_eq_u32 s17, -1
    s_cbranch_scc1 mega_kernel_x43
    s_cmp_lg_u32 s16, 0
    s_cbranch_scc1 mega_kernel_np49
    v_mov_b32 v4, s4
    v_mov_b32 v5, s5
    s_add_u32 s90, s17, 117440512
    s_mov_b64 exec, 1
    buffer_store_dwordx2 v[4:5], off, s[8:11], s90 sc1
    s_mov_b64 exec, -1
mega_kernel_np49:
    s_mov_b32 s17, -1
    s_mov_b32 s67, 3
    s_branch mega_kernel_nosw19
mega_kernel_x43:
    s_cmp_eq_u32 s94, 0
    s_cbranch_scc1 mega_kernel_x44
    s_mov_b32 s42, s73
    s_mov_b32 s46, s76
    s_lshl_b32 s90, s77, 4
    s_lshl_b32 s90, s90, s81
    s_mov_b32 s48, s79
    s_mul_i32 s91, s90, 1
    s_add_u32 s49, s91, s79
    s_sub_u32 s49, s49, 2048
    s_mul_i32 s91, s90, 2
    s_add_u32 s50, s91, s79
    s_mul_i32 s91, s90, 3
    s_add_u32 s51, s91, s79
    s_sub_u32 s51, s51, 2048
    s_mov_b32 s52, s80
    s_lshl_b32 s90, s78, 2
    s_mul_i32 s91, s90, 1
    s_add_u32 s53, s91, s80
    s_sub_u32 s53, s53, 2048
    s_mul_i32 s91, s90, 2
    s_add_u32 s54, s91, s80
    s_mul_i32 s91, s90, 3
    s_add_u32 s55, s91, s80
    s_sub_u32 s55, s55, 2048
    s_lshl_b32 s56, s78, 6
    s_lshl_b32 s90, s58, 7
    s_add_u32 s90, s90, s57
    s_lshl_b32 s91, s16, 6
    s_cmp_eq_u32 s81, 1
    s_cselect_b32 s90, s90, s91
    v_lshrrev_b32 v24, 3, v1
    v_lshlrev_b32 v24, s81, v24
    v_add_u32 v24, s90, v24
    v_mul_lo_u32 v24, v24, s77
    v_lshrrev_b32 v25, 4, v1
    v_and_b32 v26, 7, v1
    v_xor_b32 v25, v25, v26
    v_lshl_add_u32 v16, v25, 4, v24
    v_xor_b32 v25, 4, v25
    v_lshl_add_u32 v17, v25, 4, v24
    s_lshl_b32 s90, s77, 3
    s_lshl_b32 s90, s90, s81
    s_sub_u32 s90, s90, 1024
    v_add_u32 v17, s90, v17
    v_lshrrev_b32 v24, 5, v1
    s_lshl_b32 s90, s16, 4
    v_add_u32 v25, s90, v24
    v_mul_lo_u32 v25, v25, s78
    v_lshlrev_b32 v24, 1, v24
    v_and_b32 v26, 31, v1
    v_xor_b32 v24, v24, v26
    s_lshl_b32 s90, s78, 1
    s_sub_u32 s90, s90, 1024
    v_add_u32 v27, s90, v25
    v_xor_b32 v26, 0, v24
    v_lshl_add_u32 v18, v26, 4, v25
    v_xor_b32 v26, 4, v24
    v_lshl_add_u32 v19, v26, 4, v27
    v_xor_b32 v26, 8, v24
    v_lshl_add_u32 v20, v26, 4, v25
    v_xor_b32 v26, 12, v24
    v_lshl_add_u32 v21, v26, 4, v27
    s_mov_b32 s40, s71
    s_mov_b32 s41, s72
    s_mov_b32 s44, s74
    s_mov_b32 s45, s75
    buffer_load_dwordx2 v[4:5], off, s[12:15], 0 sc1
    s_mov_b32 s67, 0
    s_branch mega_kernel_nosw19
mega_kernel_x44:
    s_cmp_eq_u32 s70, 1
    s_cbranch_scc1 mega_kernel_x48
    s_cmp_lg_u32 s65, 3
    s_cbranch_scc1 mega_kernel_x46
    s_and_b32 s92, s2, 7
    s_lshl_b32 s92, s92, 2
    s_bfe_u32 s93, s2, 0x20003
    s_add_u32 s92, s92, s93
    s_lshr_b32 s93, s2, 5
    s_lshl_b32 s93, s93, 2
    s_or_b32 s93, s93, 0x40000
    s_lshr_b32 s90, s92, 1
    s_lshl_b32 s90, s90, 7
    s_add_u32 s90, s90, 117440512
    s_bfe_u32 s91, 1645237363, s93
    s_lshr_b32 s91, s91, 1
    v_add_u32 v0, 8, v1
    v_mov_b32 v4, s91
    v_cmp_gt_u32 vcc, 6, v1
    s_bfe_u32 s91, 4242446987, s93
    s_lshr_b32 s91, s91, 1
    v_cndmask_b32 v0, v4, v0, vcc
    v_writelane_b32 v0, s91, 6
    v_lshlrev_b32 v0, 3, v0
    buffer_load_dwordx2 v[4:5], v0, s[8:11], s90 offen sc1
    s_branch mega_kernel_nosw19
mega_kernel_x46:
    s_cmp_lg_u32 s65, 2
    s_cbranch_scc1 mega_kernel_x47
    s_waitcnt vmcnt(16)
    s_mov_b32 s3, 1048576
mega_kernel_spin50:
    v_cmp_ne_u64 s[22:23], s[4:5], v[4:5]
    s_nop 3
    s_cmp_eq_u64 s[22:23], 0
    s_cbranch_scc1 mega_kernel_ok51
    s_sub_u32 s3, s3, 1
    s_cbranch_scc1 mega_kernel_ok51
    s_sleep 32
    s_and_b32 s92, s2, 7
    s_lshl_b32 s92, s92, 2
    s_bfe_u32 s93, s2, 0x20003
    s_add_u32 s92, s92, s93
    s_lshr_b32 s93, s2, 5
    s_lshl_b32 s93, s93, 2
    s_or_b32 s93, s93, 0x40000
    s_lshr_b32 s90, s92, 1
    s_lshl_b32 s90, s90, 7
    s_add_u32 s90, s90, 117440512
    s_bfe_u32 s91, 1645237363, s93
    s_lshr_b32 s91, s91, 1
    v_add_u32 v0, 8, v1
    v_mov_b32 v4, s91
    v_cmp_gt_u32 vcc, 6, v1
    s_bfe_u32 s91, 4242446987, s93
    s_lshr_b32 s91, s91, 1
    v_cndmask_b32 v0, v4, v0, vcc
    v_writelane_b32 v0, s91, 6
    v_lshlrev_b32 v0, 3, v0
    buffer_load_dwordx2 v[4:5], v0, s[8:11], s90 offen sc1
    s_waitcnt vmcnt(0)
    s_branch mega_kernel_spin50
mega_kernel_ok51:
    s_and_b32 s92, s2, 7
    s_lshl_b32 s92, s92, 2
    s_bfe_u32 s93, s2, 0x20003
    s_add_u32 s92, s92, s93
    s_lshr_b32 s93, s2, 5
    s_lshl_b32 s93, s93, 2
    s_or_b32 s93, s93, 0x40000
    s_bfe_u32 s90, 4242446987, s93
    s_lshl_b32 s90, s90, 3
    s_lshl_b32 s91, s16, 1
    s_add_u32 s90, s90, s91
    s_lshl_b32 s90, s90, 12
    s_lshl_b32 s91, s92, 19
    s_add_u32 s90, s90, s91
    s_add_u32 s90, s90, 0
    buffer_load_dwordx4 a[128:131], v2, s[8:11], s90 offen offset:0 sc1
    buffer_load_dwordx4 a[132:135], v2, s[8:11], s90 offen offset:1024 sc1
    buffer_load_dwordx4 a[136:139], v2, s[8:11], s90 offen offset:2048 sc1
    buffer_load_dwordx4 a[140:143], v2, s[8:11], s90 offen offset:3072 sc1
    s_bfe_u32 s90, 4242446987, s93
    s_lshl_b32 s90, s90, 3
    s_lshl_b32 s91, s16, 1
    s_add_u32 s90, s90, s91
    s_lshl_b32 s90, s90, 12
    s_lshl_b32 s91, s92, 19
    s_add_u32 s90, s90, s91
    s_add_u32 s90, s90, 4096
    buffer_load_dwordx4 a[144:147], v2, s[8:11], s90 offen offset:0 sc1
    buffer_load_dwordx4 a[148:151], v2, s[8:11], s90 offen offset:1024 sc1
    buffer_load_dwordx4 a[152:155], v2, s[8:11], s90 offen offset:2048 sc1
    buffer_load_dwordx4 a[156:159], v2, s[8:11], s90 offen offset:3072 sc1
mega_kernel_x48:
    s_mov_b32 s42, 0
    s_mov_b32 s46, 0
    s_branch mega_kernel_nosw19
mega_kernel_x47:
    s_and_b32 s92, s2, 7
    s_lshl_b32 s92, s92, 2
    s_bfe_u32 s93, s2, 0x20003
    s_add_u32 s92, s92, s93
    s_lshr_b32 s93, s2, 5
    s_lshl_b32 s93, s93, 2
    s_or_b32 s93, s93, 0x40000
    s_bfe_u32 s90, 1645237363, s93
    s_lshl_b32 s90, s90, 3
    s_lshl_b32 s91, s16, 1
    s_add_u32 s90, s90, s91
    s_lshl_b32 s90, s90, 12
    s_lshl_b32 s91, s92, 19
    s_add_u32 s90, s90, s91
    s_add_u32 s90, s90, 0
    buffer_load_dwordx4 a[160:163], v2, s[8:11], s90 offen offset:0 sc1
    buffer_load_dwordx4 a[164:167], v2, s[8:11], s90 offen offset:1024 sc1
    buffer_load_dwordx4 a[168:171], v2, s[8:11], s90 offen offset:2048 sc1
    buffer_load_dwordx4 a[172:175], v2, s[8:11], s90 offen offset:3072 sc1
    s_bfe_u32 s90, 1645237363, s93
    s_lshl_b32 s90, s90, 3
    s_lshl_b32 s91, s16, 1
    s_add_u32 s90, s90, s91
    s_lshl_b32 s90, s90, 12
    s_lshl_b32 s91, s92, 19
    s_add_u32 s90, s90, s91
    s_add_u32 s90, s90, 4096
    buffer_load_dwordx4 a[176:179], v2, s[8:11], s90 offen offset:0 sc1
    buffer_load_dwordx4 a[180:183], v2, s[8:11], s90 offen offset:1024 sc1
    buffer_load_dwordx4 a[184:187], v2, s[8:11], s90 offen offset:2048 sc1
    buffer_load_dwordx4 a[188:191], v2, s[8:11], s90 offen offset:3072 sc1
    s_branch mega_kernel_nosw19
mega_kernel_epf21:
    s_nop 7
    s_cmp_eq_u32 s97, 0
    s_cbranch_scc1 mega_kernel_noscale52
    s_mov_b32 s91, s98
    s_mov_b32 s92, s97
    s_mov_b32 s93, s97
    s_mov_b32 s90, s91
    v_pk_mul_f32 v[32:33], v[32:33], s[92:93]
    v_pk_mul_f32 v[34:35], v[34:35], s[92:93]
    v_pk_mul_f32 v[36:37], v[36:37], s[92:93]
    v_pk_mul_f32 v[38:39], v[38:39], s[92:93]
    v_cvt_pk_bf16_f32 v32, v32, v33
    v_cvt_pk_bf16_f32 v33, v34, v35
    v_cvt_pk_bf16_f32 v34, v36, v37
    v_cvt_pk_bf16_f32 v35, v38, v39
    buffer_store_dwordx4 v[32:35], v2, s[8:11], s90 offen sc1
    s_add_u32 s90, s90, s100
    v_pk_mul_f32 v[40:41], v[40:41], s[92:93]
    v_pk_mul_f32 v[42:43], v[42:43], s[92:93]
    v_pk_mul_f32 v[44:45], v[44:45], s[92:93]
    v_pk_mul_f32 v[46:47], v[46:47], s[92:93]
    v_cvt_pk_bf16_f32 v40, v40, v41
    v_cvt_pk_bf16_f32 v41, v42, v43
    v_cvt_pk_bf16_f32 v42, v44, v45
    v_cvt_pk_bf16_f32 v43, v46, v47
    buffer_store_dwordx4 v[40:43], v2, s[8:11], s90 offen sc1
    s_add_u32 s90, s90, s100
    v_pk_mul_f32 v[48:49], v[48:49], s[92:93]
    v_pk_mul_f32 v[50:51], v[50:51], s[92:93]
    v_pk_mul_f32 v[52:53], v[52:53], s[92:93]
    v_pk_mul_f32 v[54:55], v[54:55], s[92:93]
    v_cvt_pk_bf16_f32 v48, v48, v49
    v_cvt_pk_bf16_f32 v49, v50, v51
    v_cvt_pk_bf16_f32 v50, v52, v53
    v_cvt_pk_bf16_f32 v51, v54, v55
    buffer_store_dwordx4 v[48:51], v2, s[8:11], s90 offen sc1
    s_add_u32 s90, s90, s100
    v_pk_mul_f32 v[56:57], v[56:57], s[92:93]
    v_pk_mul_f32 v[58:59], v[58:59], s[92:93]
    v_pk_mul_f32 v[60:61], v[60:61], s[92:93]
    v_pk_mul_f32 v[62:63], v[62:63], s[92:93]
    v_cvt_pk_bf16_f32 v56, v56, v57
    v_cvt_pk_bf16_f32 v57, v58, v59
    v_cvt_pk_bf16_f32 v58, v60, v61
    v_cvt_pk_bf16_f32 v59, v62, v63
    buffer_store_dwordx4 v[56:59], v2, s[8:11], s90 offen sc1
    s_add_u32 s90, s90, s100
    v_pk_mul_f32 v[64:65], v[64:65], s[92:93]
    v_pk_mul_f32 v[66:67], v[66:67], s[92:93]
    v_pk_mul_f32 v[68:69], v[68:69], s[92:93]
    v_pk_mul_f32 v[70:71], v[70:71], s[92:93]
    v_cvt_pk_bf16_f32 v64, v64, v65
    v_cvt_pk_bf16_f32 v65, v66, v67
    v_cvt_pk_bf16_f32 v66, v68, v69
    v_cvt_pk_bf16_f32 v67, v70, v71
    buffer_store_dwordx4 v[64:67], v2, s[8:11], s90 offen sc1
    s_add_u32 s90, s90, s100
    v_pk_mul_f32 v[72:73], v[72:73], s[92:93]
    v_pk_mul_f32 v[74:75], v[74:75], s[92:93]
    v_pk_mul_f32 v[76:77], v[76:77], s[92:93]
    v_pk_mul_f32 v[78:79], v[78:79], s[92:93]
    v_cvt_pk_bf16_f32 v72, v72, v73
    v_cvt_pk_bf16_f32 v73, v74, v75
    v_cvt_pk_bf16_f32 v74, v76, v77
    v_cvt_pk_bf16_f32 v75, v78, v79
    buffer_store_dwordx4 v[72:75], v2, s[8:11], s90 offen sc1
    s_add_u32 s90, s90, s100
    v_pk_mul_f32 v[80:81], v[80:81], s[92:93]
    v_pk_mul_f32 v[82:83], v[82:83], s[92:93]
    v_pk_mul_f32 v[84:85], v[84:85], s[92:93]
    v_pk_mul_f32 v[86:87], v[86:87], s[92:93]
    v_cvt_pk_bf16_f32 v80, v80, v81
    v_cvt_pk_bf16_f32 v81, v82, v83
    v_cvt_pk_bf16_f32 v82, v84, v85
    v_cvt_pk_bf16_f32 v83, v86, v87
    buffer_store_dwordx4 v[80:83], v2, s[8:11], s90 offen sc1
    s_add_u32 s90, s90, s100
    v_pk_mul_f32 v[88:89], v[88:89], s[92:93]
    v_pk_mul_f32 v[90:91], v[90:91], s[92:93]
    v_pk_mul_f32 v[92:93], v[92:93], s[92:93]
    v_pk_mul_f32 v[94:95], v[94:95], s[92:93]
    v_cvt_pk_bf16_f32 v88, v88, v89
    v_cvt_pk_bf16_f32 v89, v90, v91
    v_cvt_pk_bf16_f32 v90, v92, v93
    v_cvt_pk_bf16_f32 v91, v94, v95
    buffer_store_dwordx4 v[88:91], v2, s[8:11], s90 offen sc1
    s_add_u32 s90, s90, s100
    s_add_u32 s91, s91, s99
    s_mov_b32 s90, s91
    v_pk_mul_f32 v[96:97], v[96:97], s[92:93]
    v_pk_mul_f32 v[98:99], v[98:99], s[92:93]
    v_pk_mul_f32 v[100:101], v[100:101], s[92:93]
    v_pk_mul_f32 v[102:103], v[102:103], s[92:93]
    v_cvt_pk_bf16_f32 v96, v96, v97
    v_cvt_pk_bf16_f32 v97, v98, v99
    v_cvt_pk_bf16_f32 v98, v100, v101
    v_cvt_pk_bf16_f32 v99, v102, v103
    buffer_store_dwordx4 v[96:99], v2, s[8:11], s90 offen sc1
    s_add_u32 s90, s90, s100
    v_pk_mul_f32 v[104:105], v[104:105], s[92:93]
    v_pk_mul_f32 v[106:107], v[106:107], s[92:93]
    v_pk_mul_f32 v[108:109], v[108:109], s[92:93]
    v_pk_mul_f32 v[110:111], v[110:111], s[92:93]
    v_cvt_pk_bf16_f32 v104, v104, v105
    v_cvt_pk_bf16_f32 v105, v106, v107
    v_cvt_pk_bf16_f32 v106, v108, v109
    v_cvt_pk_bf16_f32 v107, v110, v111
    buffer_store_dwordx4 v[104:107], v2, s[8:11], s90 offen sc1
    s_add_u32 s90, s90, s100
    v_pk_mul_f32 v[112:113], v[112:113], s[92:93]
    v_pk_mul_f32 v[114:115], v[114:115], s[92:93]
    v_pk_mul_f32 v[116:117], v[116:117], s[92:93]
    v_pk_mul_f32 v[118:119], v[118:119], s[92:93]
    v_cvt_pk_bf16_f32 v112, v112, v113
    v_cvt_pk_bf16_f32 v113, v114, v115
    v_cvt_pk_bf16_f32 v114, v116, v117
    v_cvt_pk_bf16_f32 v115, v118, v119
    buffer_store_dwordx4 v[112:115], v2, s[8:11], s90 offen sc1
    s_add_u32 s90, s90, s100
    v_pk_mul_f32 v[120:121], v[120:121], s[92:93]
    v_pk_mul_f32 v[122:123], v[122:123], s[92:93]
    v_pk_mul_f32 v[124:125], v[124:125], s[92:93]
    v_pk_mul_f32 v[126:127], v[126:127], s[92:93]
    v_cvt_pk_bf16_f32 v120, v120, v121
    v_cvt_pk_bf16_f32 v121, v122, v123
    v_cvt_pk_bf16_f32 v122, v124, v125
    v_cvt_pk_bf16_f32 v123, v126, v127
    buffer_store_dwordx4 v[120:123], v2, s[8:11], s90 offen sc1
    s_add_u32 s90, s90, s100
    v_pk_mul_f32 v[128:129], v[128:129], s[92:93]
    v_pk_mul_f32 v[130:131], v[130:131], s[92:93]
    v_pk_mul_f32 v[132:133], v[132:133], s[92:93]
    v_pk_mul_f32 v[134:135], v[134:135], s[92:93]
    v_cvt_pk_bf16_f32 v128, v128, v129
    v_cvt_pk_bf16_f32 v129, v130, v131
    v_cvt_pk_bf16_f32 v130, v132, v133
    v_cvt_pk_bf16_f32 v131, v134, v135
    buffer_store_dwordx4 v[128:131], v2, s[8:11], s90 offen sc1
    s_add_u32 s90, s90, s100
    v_pk_mul_f32 v[136:137], v[136:137], s[92:93]
    v_pk_mul_f32 v[138:139], v[138:139], s[92:93]
    v_pk_mul_f32 v[140:141], v[140:141], s[92:93]
    v_pk_mul_f32 v[142:143], v[142:143], s[92:93]
    v_cvt_pk_bf16_f32 v136, v136, v137
    v_cvt_pk_bf16_f32 v137, v138, v139
    v_cvt_pk_bf16_f32 v138, v140, v141
    v_cvt_pk_bf16_f32 v139, v142, v143
    buffer_store_dwordx4 v[136:139], v2, s[8:11], s90 offen sc1
    s_add_u32 s90, s90, s100
    v_pk_mul_f32 v[144:145], v[144:145], s[92:93]
    v_pk_mul_f32 v[146:147], v[146:147], s[92:93]
    v_pk_mul_f32 v[148:149], v[148:149], s[92:93]
    v_pk_mul_f32 v[150:151], v[150:151], s[92:93]
    v_cvt_pk_bf16_f32 v144, v144, v145
    v_cvt_pk_bf16_f32 v145, v146, v147
    v_cvt_pk_bf16_f32 v146, v148, v149
    v_cvt_pk_bf16_f32 v147, v150, v151
    buffer_store_dwordx4 v[144:147], v2, s[8:11], s90 offen sc1
    s_add_u32 s90, s90, s100
    v_pk_mul_f32 v[152:153], v[152:153], s[92:93]
    v_pk_mul_f32 v[154:155], v[154:155], s[92:93]
    v_pk_mul_f32 v[156:157], v[156:157], s[92:93]
    v_pk_mul_f32 v[158:159], v[158:159], s[92:93]
    v_cvt_pk_bf16_f32 v152, v152, v153
    v_cvt_pk_bf16_f32 v153, v154, v155
    v_cvt_pk_bf16_f32 v154, v156, v157
    v_cvt_pk_bf16_f32 v155, v158, v159
    buffer_store_dwordx4 v[152:155], v2, s[8:11], s90 offen sc1
    s_add_u32 s90, s90, s100
    s_add_u32 s91, s91, s99
    s_mov_b32 s90, s91
    v_pk_mul_f32 v[160:161], v[160:161], s[92:93]
    v_pk_mul_f32 v[162:163], v[162:163], s[92:93]
    v_pk_mul_f32 v[164:165], v[164:165], s[92:93]
    v_pk_mul_f32 v[166:167], v[166:167], s[92:93]
    v_cvt_pk_bf16_f32 v160, v160, v161
    v_cvt_pk_bf16_f32 v161, v162, v163
    v_cvt_pk_bf16_f32 v162, v164, v165
    v_cvt_pk_bf16_f32 v163, v166, v167
    buffer_store_dwordx4 v[160:163], v2, s[8:11], s90 offen sc1
    s_add_u32 s90, s90, s100
    v_pk_mul_f32 v[168:169], v[168:169], s[92:93]
    v_pk_mul_f32 v[170:171], v[170:171], s[92:93]
    v_pk_mul_f32 v[172:173], v[172:173], s[92:93]
    v_pk_mul_f32 v[174:175], v[174:175], s[92:93]
    v_cvt_pk_bf16_f32 v168, v168, v169
    v_cvt_pk_bf16_f32 v169, v170, v171
    v_cvt_pk_bf16_f32 v170, v172, v173
    v_cvt_pk_bf16_f32 v171, v174, v175
    buffer_store_dwordx4 v[168:171], v2, s[8:11], s90 offen sc1
    s_add_u32 s90, s90, s100
    v_pk_mul_f32 v[176:177], v[176:177], s[92:93]
    v_pk_mul_f32 v[178:179], v[178:179], s[92:93]
    v_pk_mul_f32 v[180:181], v[180:181], s[92:93]
    v_pk_mul_f32 v[182:183], v[182:183], s[92:93]
    v_cvt_pk_bf16_f32 v176, v176, v177
    v_cvt_pk_bf16_f32 v177, v178, v179
    v_cvt_pk_bf16_f32 v178, v180, v181
    v_cvt_pk_bf16_f32 v179, v182, v183
    buffer_store_dwordx4 v[176:179], v2, s[8:11], s90 offen sc1
    s_add_u32 s90, s90, s100
    v_pk_mul_f32 v[184:185], v[184:185], s[92:93]
    v_pk_mul_f32 v[186:187], v[186:187], s[92:93]
    v_pk_mul_f32 v[188:189], v[188:189], s[92:93]
    v_pk_mul_f32 v[190:191], v[190:191], s[92:93]
    v_cvt_pk_bf16_f32 v184, v184, v185
    v_cvt_pk_bf16_f32 v185, v186, v187
    v_cvt_pk_bf16_f32 v186, v188, v189
    v_cvt_pk_bf16_f32 v187, v190, v191
    buffer_store_dwordx4 v[184:187], v2, s[8:11], s90 offen sc1
    s_add_u32 s90, s90, s100
    v_pk_mul_f32 v[192:193], v[192:193], s[92:93]
    v_pk_mul_f32 v[194:195], v[194:195], s[92:93]
    v_pk_mul_f32 v[196:197], v[196:197], s[92:93]
    v_pk_mul_f32 v[198:199], v[198:199], s[92:93]
    v_cvt_pk_bf16_f32 v192, v192, v193
    v_cvt_pk_bf16_f32 v193, v194, v195
    v_cvt_pk_bf16_f32 v194, v196, v197
    v_cvt_pk_bf16_f32 v195, v198, v199
    buffer_store_dwordx4 v[192:195], v2, s[8:11], s90 offen sc1
    s_add_u32 s90, s90, s100
    v_pk_mul_f32 v[200:201], v[200:201], s[92:93]
    v_pk_mul_f32 v[202:203], v[202:203], s[92:93]
    v_pk_mul_f32 v[204:205], v[204:205], s[92:93]
    v_pk_mul_f32 v[206:207], v[206:207], s[92:93]
    v_cvt_pk_bf16_f32 v200, v200, v201
    v_cvt_pk_bf16_f32 v201, v202, v203
    v_cvt_pk_bf16_f32 v202, v204, v205
    v_cvt_pk_bf16_f32 v203, v206, v207
    buffer_store_dwordx4 v[200:203], v2, s[8:11], s90 offen sc1
    s_add_u32 s90, s90, s100
    v_pk_mul_f32 v[208:209], v[208:209], s[92:93]
    v_pk_mul_f32 v[210:211], v[210:211], s[92:93]
    v_pk_mul_f32 v[212:213], v[212:213], s[92:93]
    v_pk_mul_f32 v[214:215], v[214:215], s[92:93]
    v_cvt_pk_bf16_f32 v208, v208, v209
    v_cvt_pk_bf16_f32 v209, v210, v211
    v_cvt_pk_bf16_f32 v210, v212, v213
    v_cvt_pk_bf16_f32 v211, v214, v215
    buffer_store_dwordx4 v[208:211], v2, s[8:11], s90 offen sc1
    s_add_u32 s90, s90, s100
    v_pk_mul_f32 v[216:217], v[216:217], s[92:93]
    v_pk_mul_f32 v[218:219], v[218:219], s[92:93]
    v_pk_mul_f32 v[220:221], v[220:221], s[92:93]
    v_pk_mul_f32 v[222:223], v[222:223], s[92:93]
    v_cvt_pk_bf16_f32 v216, v216, v217
    v_cvt_pk_bf16_f32 v217, v218, v219
    v_cvt_pk_bf16_f32 v218, v220, v221
    v_cvt_pk_bf16_f32 v219, v222, v223
    buffer_store_dwordx4 v[216:219], v2, s[8:11], s90 offen sc1
    s_add_u32 s90, s90, s100
    s_add_u32 s91, s91, s99
    s_mov_b32 s90, s91
    v_pk_mul_f32 v[224:225], v[224:225], s[92:93]
    v_pk_mul_f32 v[226:227], v[226:227], s[92:93]
    v_pk_mul_f32 v[228:229], v[228:229], s[92:93]
    v_pk_mul_f32 v[230:231], v[230:231], s[92:93]
    v_cvt_pk_bf16_f32 v224, v224, v225
    v_cvt_pk_bf16_f32 v225, v226, v227
    v_cvt_pk_bf16_f32 v226, v228, v229
    v_cvt_pk_bf16_f32 v227, v230, v231
    buffer_store_dwordx4 v[224:227], v2, s[8:11], s90 offen sc1
    s_add_u32 s90, s90, s100
    v_pk_mul_f32 v[232:233], v[232:233], s[92:93]
    v_pk_mul_f32 v[234:235], v[234:235], s[92:93]
    v_pk_mul_f32 v[236:237], v[236:237], s[92:93]
    v_pk_mul_f32 v[238:239], v[238:239], s[92:93]
    v_cvt_pk_bf16_f32 v232, v232, v233
    v_cvt_pk_bf16_f32 v233, v234, v235
    v_cvt_pk_bf16_f32 v234, v236, v237
    v_cvt_pk_bf16_f32 v235, v238, v239
    buffer_store_dwordx4 v[232:235], v2, s[8:11], s90 offen sc1
    s_add_u32 s90, s90, s100
    v_pk_mul_f32 v[240:241], v[240:241], s[92:93]
    v_pk_mul_f32 v[242:243], v[242:243], s[92:93]
    v_pk_mul_f32 v[244:245], v[244:245], s[92:93]
    v_pk_mul_f32 v[246:247], v[246:247], s[92:93]
    v_cvt_pk_bf16_f32 v240, v240, v241
    v_cvt_pk_bf16_f32 v241, v242, v243
    v_cvt_pk_bf16_f32 v242, v244, v245
    v_cvt_pk_bf16_f32 v243, v246, v247
    buffer_store_dwordx4 v[240:243], v2, s[8:11], s90 offen sc1
    s_add_u32 s90, s90, s100
    v_pk_mul_f32 v[248:249], v[248:249], s[92:93]
    v_pk_mul_f32 v[250:251], v[250:251], s[92:93]
    v_pk_mul_f32 v[252:253], v[252:253], s[92:93]
    v_pk_mul_f32 v[254:255], v[254:255], s[92:93]
    v_cvt_pk_bf16_f32 v248, v248, v249
    v_cvt_pk_bf16_f32 v249, v250, v251
    v_cvt_pk_bf16_f32 v250, v252, v253
    v_cvt_pk_bf16_f32 v251, v254, v255
    buffer_store_dwordx4 v[248:251], v2, s[8:11], s90 offen sc1
    s_add_u32 s90, s90, s100
    v_accvgpr_read_b32 v24, a96
    v_accvgpr_read_b32 v25, a97
    v_accvgpr_read_b32 v26, a98
    v_accvgpr_read_b32 v27, a99
    v_accvgpr_read_b32 v28, a100
    v_accvgpr_read_b32 v29, a101
    v_accvgpr_read_b32 v30, a102
    v_accvgpr_read_b32 v31, a103
    v_pk_mul_f32 v[24:25], v[24:25], s[92:93]
    v_pk_mul_f32 v[26:27], v[26:27], s[92:93]
    v_pk_mul_f32 v[28:29], v[28:29], s[92:93]
    v_pk_mul_f32 v[30:31], v[30:31], s[92:93]
    v_cvt_pk_bf16_f32 v24, v24, v25
    v_cvt_pk_bf16_f32 v25, v26, v27
    v_cvt_pk_bf16_f32 v26, v28, v29
    v_cvt_pk_bf16_f32 v27, v30, v31
    buffer_store_dwordx4 v[24:27], v2, s[8:11], s90 offen sc1
    s_add_u32 s90, s90, s100
    s_nop 1
    v_accvgpr_read_b32 v24, a104
    v_accvgpr_read_b32 v25, a105
    v_accvgpr_read_b32 v26, a106
    v_accvgpr_read_b32 v27, a107
    v_accvgpr_read_b32 v28, a108
    v_accvgpr_read_b32 v29, a109
    v_accvgpr_read_b32 v30, a110
    v_accvgpr_read_b32 v31, a111
    v_pk_mul_f32 v[24:25], v[24:25], s[92:93]
    v_pk_mul_f32 v[26:27], v[26:27], s[92:93]
    v_pk_mul_f32 v[28:29], v[28:29], s[92:93]
    v_pk_mul_f32 v[30:31], v[30:31], s[92:93]
    v_cvt_pk_bf16_f32 v24, v24, v25
    v_cvt_pk_bf16_f32 v25, v26, v27
    v_cvt_pk_bf16_f32 v26, v28, v29
    v_cvt_pk_bf16_f32 v27, v30, v31
    buffer_store_dwordx4 v[24:27], v2, s[8:11], s90 offen sc1
    s_add_u32 s90, s90, s100
    s_nop 1
    v_accvgpr_read_b32 v24, a112
    v_accvgpr_read_b32 v25, a113
    v_accvgpr_read_b32 v26, a114
    v_accvgpr_read_b32 v27, a115
    v_accvgpr_read_b32 v28, a116
    v_accvgpr_read_b32 v29, a117
    v_accvgpr_read_b32 v30, a118
    v_accvgpr_read_b32 v31, a119
    v_pk_mul_f32 v[24:25], v[24:25], s[92:93]
    v_pk_mul_f32 v[26:27], v[26:27], s[92:93]
    v_pk_mul_f32 v[28:29], v[28:29], s[92:93]
    v_pk_mul_f32 v[30:31], v[30:31], s[92:93]
    v_cvt_pk_bf16_f32 v24, v24, v25
    v_cvt_pk_bf16_f32 v25, v26, v27
    v_cvt_pk_bf16_f32 v26, v28, v29
    v_cvt_pk_bf16_f32 v27, v30, v31
    buffer_store_dwordx4 v[24:27], v2, s[8:11], s90 offen sc1
    s_add_u32 s90, s90, s100
    s_nop 1
    v_accvgpr_read_b32 v24, a120
    v_accvgpr_read_b32 v25, a121
    v_accvgpr_read_b32 v26, a122
    v_accvgpr_read_b32 v27, a123
    v_accvgpr_read_b32 v28, a124
    v_accvgpr_read_b32 v29, a125
    v_accvgpr_read_b32 v30, a126
    v_accvgpr_read_b32 v31, a127
    v_pk_mul_f32 v[24:25], v[24:25], s[92:93]
    v_pk_mul_f32 v[26:27], v[26:27], s[92:93]
    v_pk_mul_f32 v[28:29], v[28:29], s[92:93]
    v_pk_mul_f32 v[30:31], v[30:31], s[92:93]
    v_cvt_pk_bf16_f32 v24, v24, v25
    v_cvt_pk_bf16_f32 v25, v26, v27
    v_cvt_pk_bf16_f32 v26, v28, v29
    v_cvt_pk_bf16_f32 v27, v30, v31
    buffer_store_dwordx4 v[24:27], v2, s[8:11], s90 offen sc1
    s_add_u32 s90, s90, s100
    s_nop 1
    s_add_u32 s91, s91, s99
    s_setpc_b64 s[20:21]
mega_kernel_noscale52:
    s_mov_b32 s91, s98
    s_mov_b32 s92, s97
    s_mov_b32 s93, s97
    s_mov_b32 s90, s91
    v_cvt_pk_bf16_f32 v32, v32, v33
    v_cvt_pk_bf16_f32 v33, v34, v35
    v_cvt_pk_bf16_f32 v34, v36, v37
    v_cvt_pk_bf16_f32 v35, v38, v39
    buffer_store_dwordx4 v[32:35], v2, s[8:11], s90 offen sc1
    s_add_u32 s90, s90, s100
    v_cvt_pk_bf16_f32 v40, v40, v41
    v_cvt_pk_bf16_f32 v41, v42, v43
    v_cvt_pk_bf16_f32 v42, v44, v45
    v_cvt_pk_bf16_f32 v43, v46, v47
    buffer_store_dwordx4 v[40:43], v2, s[8:11], s90 offen sc1
    s_add_u32 s90, s90, s100
    v_cvt_pk_bf16_f32 v48, v48, v49
    v_cvt_pk_bf16_f32 v49, v50, v51
    v_cvt_pk_bf16_f32 v50, v52, v53
    v_cvt_pk_bf16_f32 v51, v54, v55
    buffer_store_dwordx4 v[48:51], v2, s[8:11], s90 offen sc1
    s_add_u32 s90, s90, s100
    v_cvt_pk_bf16_f32 v56, v56, v57
    v_cvt_pk_bf16_f32 v57, v58, v59
    v_cvt_pk_bf16_f32 v58, v60, v61
    v_cvt_pk_bf16_f32 v59, v62, v63
    buffer_store_dwordx4 v[56:59], v2, s[8:11], s90 offen sc1
    s_add_u32 s90, s90, s100
    v_cvt_pk_bf16_f32 v64, v64, v65
    v_cvt_pk_bf16_f32 v65, v66, v67
    v_cvt_pk_bf16_f32 v66, v68, v69
    v_cvt_pk_bf16_f32 v67, v70, v71
    buffer_store_dwordx4 v[64:67], v2, s[8:11], s90 offen sc1
    s_add_u32 s90, s90, s100
    v_cvt_pk_bf16_f32 v72, v72, v73
    v_cvt_pk_bf16_f32 v73, v74, v75
    v_cvt_pk_bf16_f32 v74, v76, v77
    v_cvt_pk_bf16_f32 v75, v78, v79
    buffer_store_dwordx4 v[72:75], v2, s[8:11], s90 offen sc1
    s_add_u32 s90, s90, s100
    v_cvt_pk_bf16_f32 v80, v80, v81
    v_cvt_pk_bf16_f32 v81, v82, v83
    v_cvt_pk_bf16_f32 v82, v84, v85
    v_cvt_pk_bf16_f32 v83, v86, v87
    buffer_store_dwordx4 v[80:83], v2, s[8:11], s90 offen sc1
    s_add_u32 s90, s90, s100
    v_cvt_pk_bf16_f32 v88, v88, v89
    v_cvt_pk_bf16_f32 v89, v90, v91
    v_cvt_pk_bf16_f32 v90, v92, v93
    v_cvt_pk_bf16_f32 v91, v94, v95
    buffer_store_dwordx4 v[88:91], v2, s[8:11], s90 offen sc1
    s_add_u32 s90, s90, s100
    s_add_u32 s91, s91, s99
    s_mov_b32 s90, s91
    v_cvt_pk_bf16_f32 v96, v96, v97
    v_cvt_pk_bf16_f32 v97, v98, v99
    v_cvt_pk_bf16_f32 v98, v100, v101
    v_cvt_pk_bf16_f32 v99, v102, v103
    buffer_store_dwordx4 v[96:99], v2, s[8:11], s90 offen sc1
    s_add_u32 s90, s90, s100
    v_cvt_pk_bf16_f32 v104, v104, v105
    v_cvt_pk_bf16_f32 v105, v106, v107
    v_cvt_pk_bf16_f32 v106, v108, v109
    v_cvt_pk_bf16_f32 v107, v110, v111
    buffer_store_dwordx4 v[104:107], v2, s[8:11], s90 offen sc1
    s_add_u32 s90, s90, s100
    v_cvt_pk_bf16_f32 v112, v112, v113
    v_cvt_pk_bf16_f32 v113, v114, v115
    v_cvt_pk_bf16_f32 v114, v116, v117
    v_cvt_pk_bf16_f32 v115, v118, v119
    buffer_store_dwordx4 v[112:115], v2, s[8:11], s90 offen sc1
    s_add_u32 s90, s90, s100
    v_cvt_pk_bf16_f32 v120, v120, v121
    v_cvt_pk_bf16_f32 v121, v122, v123
    v_cvt_pk_bf16_f32 v122, v124, v125
    v_cvt_pk_bf16_f32 v123, v126, v127
    buffer_store_dwordx4 v[120:123], v2, s[8:11], s90 offen sc1
    s_add_u32 s90, s90, s100
    v_cvt_pk_bf16_f32 v128, v128, v129
    v_cvt_pk_bf16_f32 v129, v130, v131
    v_cvt_pk_bf16_f32 v130, v132, v133
    v_cvt_pk_bf16_f32 v131, v134, v135
    buffer_store_dwordx4 v[128:131], v2, s[8:11], s90 offen sc1
    s_add_u32 s90, s90, s100
    v_cvt_pk_bf16_f32 v136, v136, v137
    v_cvt_pk_bf16_f32 v137, v138, v139
    v_cvt_pk_bf16_f32 v138, v140, v141
    v_cvt_pk_bf16_f32 v139, v142, v143
    buffer_store_dwordx4 v[136:139], v2, s[8:11], s90 offen sc1
    s_add_u32 s90, s90, s100
    v_cvt_pk_bf16_f32 v144, v144, v145
    v_cvt_pk_bf16_f32 v145, v146, v147
    v_cvt_pk_bf16_f32 v146, v148, v149
    v_cvt_pk_bf16_f32 v147, v150, v151
    buffer_store_dwordx4 v[144:147], v2, s[8:11], s90 offen sc1
    s_add_u32 s90, s90, s100
    v_cvt_pk_bf16_f32 v152, v152, v153
    v_cvt_pk_bf16_f32 v153, v154, v155
    v_cvt_pk_bf16_f32 v154, v156, v157
    v_cvt_pk_bf16_f32 v155, v158, v159
    buffer_store_dwordx4 v[152:155], v2, s[8:11], s90 offen sc1
    s_add_u32 s90, s90, s100
    s_add_u32 s91, s91, s99
    s_mov_b32 s90, s91
    v_cvt_pk_bf16_f32 v160, v160, v161
    v_cvt_pk_bf16_f32 v161, v162, v163
    v_cvt_pk_bf16_f32 v162, v164, v165
    v_cvt_pk_bf16_f32 v163, v166, v167
    buffer_store_dwordx4 v[160:163], v2, s[8:11], s90 offen sc1
    s_add_u32 s90, s90, s100
    v_cvt_pk_bf16_f32 v168, v168, v169
    v_cvt_pk_bf16_f32 v169, v170, v171
    v_cvt_pk_bf16_f32 v170, v172, v173
    v_cvt_pk_bf16_f32 v171, v174, v175
    buffer_store_dwordx4 v[168:171], v2, s[8:11], s90 offen sc1
    s_add_u32 s90, s90, s100
    v_cvt_pk_bf16_f32 v176, v176, v177
    v_cvt_pk_bf16_f32 v177, v178, v179
    v_cvt_pk_bf16_f32 v178, v180, v181
    v_cvt_pk_bf16_f32 v179, v182, v183
    buffer_store_dwordx4 v[176:179], v2, s[8:11], s90 offen sc1
    s_add_u32 s90, s90, s100
    v_cvt_pk_bf16_f32 v184, v184, v185
    v_cvt_pk_bf16_f32 v185, v186, v187
    v_cvt_pk_bf16_f32 v186, v188, v189
    v_cvt_pk_bf16_f32 v187, v190, v191
    buffer_store_dwordx4 v[184:187], v2, s[8:11], s90 offen sc1
    s_add_u32 s90, s90, s100
    v_cvt_pk_bf16_f32 v192, v192, v193
    v_cvt_pk_bf16_f32 v193, v194, v195
    v_cvt_pk_bf16_f32 v194, v196, v197
    v_cvt_pk_bf16_f32 v195, v198, v199
    buffer_store_dwordx4 v[192:195], v2, s[8:11], s90 offen sc1
    s_add_u32 s90, s90, s100
    v_cvt_pk_bf16_f32 v200, v200, v201
    v_cvt_pk_bf16_f32 v201, v202, v203
    v_cvt_pk_bf16_f32 v202, v204, v205
    v_cvt_pk_bf16_f32 v203, v206, v207
    buffer_store_dwordx4 v[200:203], v2, s[8:11], s90 offen sc1
    s_add_u32 s90, s90, s100
    v_cvt_pk_bf16_f32 v208, v208, v209
    v_cvt_pk_bf16_f32 v209, v210, v211
    v_cvt_pk_bf16_f32 v210, v212, v213
    v_cvt_pk_bf16_f32 v211, v214, v215
    buffer_store_dwordx4 v[208:211], v2, s[8:11], s90 offen sc1
    s_add_u32 s90, s90, s100
    v_cvt_pk_bf16_f32 v216, v216, v217
    v_cvt_pk_bf16_f32 v217, v218, v219
    v_cvt_pk_bf16_f32 v218, v220, v221
    v_cvt_pk_bf16_f32 v219, v222, v223
    buffer_store_dwordx4 v[216:219], v2, s[8:11], s90 offen sc1
    s_add_u32 s90, s90, s100
    s_add_u32 s91, s91, s99
    s_mov_b32 s90, s91
    v_cvt_pk_bf16_f32 v224, v224, v225
    v_cvt_pk_bf16_f32 v225, v226, v227
    v_cvt_pk_bf16_f32 v226, v228, v229
    v_cvt_pk_bf16_f32 v227, v230, v231
    buffer_store_dwordx4 v[224:227], v2, s[8:11], s90 offen sc1
    s_add_u32 s90, s90, s100
    v_cvt_pk_bf16_f32 v232, v232, v233
    v_cvt_pk_bf16_f32 v233, v234, v235
    v_cvt_pk_bf16_f32 v234, v236, v237
    v_cvt_pk_bf16_f32 v235, v238, v239
    buffer_store_dwordx4 v[232:235], v2, s[8:11], s90 offen sc1
    s_add_u32 s90, s90, s100
    v_cvt_pk_bf16_f32 v240, v240, v241
    v_cvt_pk_bf16_f32 v241, v242, v243
    v_cvt_pk_bf16_f32 v242, v244, v245
    v_cvt_pk_bf16_f32 v243, v246, v247
    buffer_store_dwordx4 v[240:243], v2, s[8:11], s90 offen sc1
    s_add_u32 s90, s90, s100
    v_cvt_pk_bf16_f32 v248, v248, v249
    v_cvt_pk_bf16_f32 v249, v250, v251
    v_cvt_pk_bf16_f32 v250, v252, v253
    v_cvt_pk_bf16_f32 v251, v254, v255
    buffer_store_dwordx4 v[248:251], v2, s[8:11], s90 offen sc1
    s_add_u32 s90, s90, s100
    v_accvgpr_read_b32 v24, a96
    v_accvgpr_read_b32 v25, a97
    v_accvgpr_read_b32 v26, a98
    v_accvgpr_read_b32 v27, a99
    v_accvgpr_read_b32 v28, a100
    v_accvgpr_read_b32 v29, a101
    v_accvgpr_read_b32 v30, a102
    v_accvgpr_read_b32 v31, a103
    v_cvt_pk_bf16_f32 v24, v24, v25
    v_cvt_pk_bf16_f32 v25, v26, v27
    v_cvt_pk_bf16_f32 v26, v28, v29
    v_cvt_pk_bf16_f32 v27, v30, v31
    buffer_store_dwordx4 v[24:27], v2, s[8:11], s90 offen sc1
    s_add_u32 s90, s90, s100
    s_nop 1
    v_accvgpr_read_b32 v24, a104
    v_accvgpr_read_b32 v25, a105
    v_accvgpr_read_b32 v26, a106
    v_accvgpr_read_b32 v27, a107
    v_accvgpr_read_b32 v28, a108
    v_accvgpr_read_b32 v29, a109
    v_accvgpr_read_b32 v30, a110
    v_accvgpr_read_b32 v31, a111
    v_cvt_pk_bf16_f32 v24, v24, v25
    v_cvt_pk_bf16_f32 v25, v26, v27
    v_cvt_pk_bf16_f32 v26, v28, v29
    v_cvt_pk_bf16_f32 v27, v30, v31
    buffer_store_dwordx4 v[24:27], v2, s[8:11], s90 offen sc1
    s_add_u32 s90, s90, s100
    s_nop 1
    v_accvgpr_read_b32 v24, a112
    v_accvgpr_read_b32 v25, a113
    v_accvgpr_read_b32 v26, a114
    v_accvgpr_read_b32 v27, a115
    v_accvgpr_read_b32 v28, a116
    v_accvgpr_read_b32 v29, a117
    v_accvgpr_read_b32 v30, a118
    v_accvgpr_read_b32 v31, a119
    v_cvt_pk_bf16_f32 v24, v24, v25
    v_cvt_pk_bf16_f32 v25, v26, v27
    v_cvt_pk_bf16_f32 v26, v28, v29
    v_cvt_pk_bf16_f32 v27, v30, v31
    buffer_store_dwordx4 v[24:27], v2, s[8:11], s90 offen sc1
    s_add_u32 s90, s90, s100
    s_nop 1
    v_accvgpr_read_b32 v24, a120
    v_accvgpr_read_b32 v25, a121
    v_accvgpr_read_b32 v26, a122
    v_accvgpr_read_b32 v27, a123
    v_accvgpr_read_b32 v28, a124
    v_accvgpr_read_b32 v29, a125
    v_accvgpr_read_b32 v30, a126
    v_accvgpr_read_b32 v31, a127
    v_cvt_pk_bf16_f32 v24, v24, v25
    v_cvt_pk_bf16_f32 v25, v26, v27
    v_cvt_pk_bf16_f32 v26, v28, v29
    v_cvt_pk_bf16_f32 v27, v30, v31
    buffer_store_dwordx4 v[24:27], v2, s[8:11], s90 offen sc1
    s_add_u32 s90, s90, s100
    s_nop 1
    s_add_u32 s91, s91, s99
    s_setpc_b64 s[20:21]
mega_kernel_epl53:
    s_mov_b32 s92, s97
    s_mov_b32 s93, s97
    s_cmp_eq_u32 s97, 0
    s_cbranch_scc1 mega_kernel_ns254
    s_mov_b32 s90, s98
    v_pk_mul_f32 v[32:33], v[32:33], s[92:93]
    v_pk_mul_f32 v[34:35], v[34:35], s[92:93]
    v_pk_mul_f32 v[36:37], v[36:37], s[92:93]
    v_pk_mul_f32 v[38:39], v[38:39], s[92:93]
    v_cvt_pk_bf16_f32 v32, v32, v33
    v_cvt_pk_bf16_f32 v33, v34, v35
    v_cvt_pk_bf16_f32 v34, v36, v37
    v_cvt_pk_bf16_f32 v35, v38, v39
    buffer_store_dwordx4 v[32:35], v2, s[8:11], s90 offen sc1
    s_add_u32 s90, s90, s100
    v_pk_mul_f32 v[40:41], v[40:41], s[92:93]
    v_pk_mul_f32 v[42:43], v[42:43], s[92:93]
    v_pk_mul_f32 v[44:45], v[44:45], s[92:93]
    v_pk_mul_f32 v[46:47], v[46:47], s[92:93]
    v_cvt_pk_bf16_f32 v40, v40, v41
    v_cvt_pk_bf16_f32 v41, v42, v43
    v_cvt_pk_bf16_f32 v42, v44, v45
    v_cvt_pk_bf16_f32 v43, v46, v47
    buffer_store_dwordx4 v[40:43], v2, s[8:11], s90 offen sc1
    s_add_u32 s90, s90, s100
    v_pk_mul_f32 v[48:49], v[48:49], s[92:93]
    v_pk_mul_f32 v[50:51], v[50:51], s[92:93]
    v_pk_mul_f32 v[52:53], v[52:53], s[92:93]
    v_pk_mul_f32 v[54:55], v[54:55], s[92:93]
    v_cvt_pk_bf16_f32 v48, v48, v49
    v_cvt_pk_bf16_f32 v49, v50, v51
    v_cvt_pk_bf16_f32 v50, v52, v53
    v_cvt_pk_bf16_f32 v51, v54, v55
    buffer_store_dwordx4 v[48:51], v2, s[8:11], s90 offen sc1
    s_add_u32 s90, s90, s100
    v_pk_mul_f32 v[56:57], v[56:57], s[92:93]
    v_pk_mul_f32 v[58:59], v[58:59], s[92:93]
    v_pk_mul_f32 v[60:61], v[60:61], s[92:93]
    v_pk_mul_f32 v[62:63], v[62:63], s[92:93]
    v_cvt_pk_bf16_f32 v56, v56, v57
    v_cvt_pk_bf16_f32 v57, v58, v59
    v_cvt_pk_bf16_f32 v58, v60, v61
    v_cvt_pk_bf16_f32 v59, v62, v63
    buffer_store_dwordx4 v[56:59], v2, s[8:11], s90 offen sc1
    s_add_u32 s90, s90, s100
    v_pk_mul_f32 v[64:65], v[64:65], s[92:93]
    v_pk_mul_f32 v[66:67], v[66:67], s[92:93]
    v_pk_mul_f32 v[68:69], v[68:69], s[92:93]
    v_pk_mul_f32 v[70:71], v[70:71], s[92:93]
    v_cvt_pk_bf16_f32 v64, v64, v65
    v_cvt_pk_bf16_f32 v65, v66, v67
    v_cvt_pk_bf16_f32 v66, v68, v69
    v_cvt_pk_bf16_f32 v67, v70, v71
    buffer_store_dwordx4 v[64:67], v2, s[8:11], s90 offen sc1
    s_add_u32 s90, s90, s100
    v_pk_mul_f32 v[72:73], v[72:73], s[92:93]
    v_pk_mul_f32 v[74:75], v[74:75], s[92:93]
    v_pk_mul_f32 v[76:77], v[76:77], s[92:93]
    v_pk_mul_f32 v[78:79], v[78:79], s[92:93]
    v_cvt_pk_bf16_f32 v72, v72, v73
    v_cvt_pk_bf16_f32 v73, v74, v75
    v_cvt_pk_bf16_f32 v74, v76, v77
    v_cvt_pk_bf16_f32 v75, v78, v79
    buffer_store_dwordx4 v[72:75], v2, s[8:11], s90 offen sc1
    s_add_u32 s90, s90, s100
    v_pk_mul_f32 v[80:81], v[80:81], s[92:93]
    v_pk_mul_f32 v[82:83], v[82:83], s[92:93]
    v_pk_mul_f32 v[84:85], v[84:85], s[92:93]
    v_pk_mul_f32 v[86:87], v[86:87], s[92:93]
    v_cvt_pk_bf16_f32 v80, v80, v81
    v_cvt_pk_bf16_f32 v81, v82, v83
    v_cvt_pk_bf16_f32 v82, v84, v85
    v_cvt_pk_bf16_f32 v83, v86, v87
    buffer_store_dwordx4 v[80:83], v2, s[8:11], s90 offen sc1
    s_add_u32 s90, s90, s100
    v_pk_mul_f32 v[88:89], v[88:89], s[92:93]
    v_pk_mul_f32 v[90:91], v[90:91], s[92:93]
    v_pk_mul_f32 v[92:93], v[92:93], s[92:93]
    v_pk_mul_f32 v[94:95], v[94:95], s[92:93]
    v_cvt_pk_bf16_f32 v88, v88, v89
    v_cvt_pk_bf16_f32 v89, v90, v91
    v_cvt_pk_bf16_f32 v90, v92, v93
    v_cvt_pk_bf16_f32 v91, v94, v95
    buffer_store_dwordx4 v[88:91], v2, s[8:11], s90 offen sc1
    s_add_u32 s90, s98, s99
    v_pk_mul_f32 v[96:97], v[96:97], s[92:93]
    v_pk_mul_f32 v[98:99], v[98:99], s[92:93]
    v_pk_mul_f32 v[100:101], v[100:101], s[92:93]
    v_pk_mul_f32 v[102:103], v[102:103], s[92:93]
    v_cvt_pk_bf16_f32 v96, v96, v97
    v_cvt_pk_bf16_f32 v97, v98, v99
    v_cvt_pk_bf16_f32 v98, v100, v101
    v_cvt_pk_bf16_f32 v99, v102, v103
    buffer_store_dwordx4 v[96:99], v2, s[8:11], s90 offen sc1
    s_add_u32 s90, s90, s100
    v_pk_mul_f32 v[104:105], v[104:105], s[92:93]
    v_pk_mul_f32 v[106:107], v[106:107], s[92:93]
    v_pk_mul_f32 v[108:109], v[108:109], s[92:93]
    v_pk_mul_f32 v[110:111], v[110:111], s[92:93]
    v_cvt_pk_bf16_f32 v104, v104, v105
    v_cvt_pk_bf16_f32 v105, v106, v107
    v_cvt_pk_bf16_f32 v106, v108, v109
    v_cvt_pk_bf16_f32 v107, v110, v111
    buffer_store_dwordx4 v[104:107], v2, s[8:11], s90 offen sc1
    s_add_u32 s90, s90, s100
    v_pk_mul_f32 v[112:113], v[112:113], s[92:93]
    v_pk_mul_f32 v[114:115], v[114:115], s[92:93]
    v_pk_mul_f32 v[116:117], v[116:117], s[92:93]
    v_pk_mul_f32 v[118:119], v[118:119], s[92:93]
    v_cvt_pk_bf16_f32 v112, v112, v113
    v_cvt_pk_bf16_f32 v113, v114, v115
    v_cvt_pk_bf16_f32 v114, v116, v117
    v_cvt_pk_bf16_f32 v115, v118, v119
    buffer_store_dwordx4 v[112:115], v2, s[8:11], s90 offen sc1
    s_add_u32 s90, s90, s100
    v_pk_mul_f32 v[120:121], v[120:121], s[92:93]
    v_pk_mul_f32 v[122:123], v[122:123], s[92:93]
    v_pk_mul_f32 v[124:125], v[124:125], s[92:93]
    v_pk_mul_f32 v[126:127], v[126:127], s[92:93]
    v_cvt_pk_bf16_f32 v120, v120, v121
    v_cvt_pk_bf16_f32 v121, v122, v123
    v_cvt_pk_bf16_f32 v122, v124, v125
    v_cvt_pk_bf16_f32 v123, v126, v127
    buffer_store_dwordx4 v[120:123], v2, s[8:11], s90 offen sc1
    s_add_u32 s90, s90, s100
    v_pk_mul_f32 v[128:129], v[128:129], s[92:93]
    v_pk_mul_f32 v[130:131], v[130:131], s[92:93]
    v_pk_mul_f32 v[132:133], v[132:133], s[92:93]
    v_pk_mul_f32 v[134:135], v[134:135], s[92:93]
    v_cvt_pk_bf16_f32 v128, v128, v129
    v_cvt_pk_bf16_f32 v129, v130, v131
    v_cvt_pk_bf16_f32 v130, v132, v133
    v_cvt_pk_bf16_f32 v131, v134, v135
    buffer_store_dwordx4 v[128:131], v2, s[8:11], s90 offen sc1
    s_add_u32 s90, s90, s100
    v_pk_mul_f32 v[136:137], v[136:137], s[92:93]
    v_pk_mul_f32 v[138:139], v[138:139], s[92:93]
    v_pk_mul_f32 v[140:141], v[140:141], s[92:93]
    v_pk_mul_f32 v[142:143], v[142:143], s[92:93]
    v_cvt_pk_bf16_f32 v136, v136, v137
    v_cvt_pk_bf16_f32 v137, v138, v139
    v_cvt_pk_bf16_f32 v138, v140, v141
    v_cvt_pk_bf16_f32 v139, v142, v143
    buffer_store_dwordx4 v[136:139], v2, s[8:11], s90 offen sc1
    s_add_u32 s90, s90, s100
    v_pk_mul_f32 v[144:145], v[144:145], s[92:93]
    v_pk_mul_f32 v[146:147], v[146:147], s[92:93]
    v_pk_mul_f32 v[148:149], v[148:149], s[92:93]
    v_pk_mul_f32 v[150:151], v[150:151], s[92:93]
    v_cvt_pk_bf16_f32 v144, v144, v145
    v_cvt_pk_bf16_f32 v145, v146, v147
    v_cvt_pk_bf16_f32 v146, v148, v149
    v_cvt_pk_bf16_f32 v147, v150, v151
    buffer_store_dwordx4 v[144:147], v2, s[8:11], s90 offen sc1
    s_add_u32 s90, s90, s100
    v_pk_mul_f32 v[152:153], v[152:153], s[92:93]
    v_pk_mul_f32 v[154:155], v[154:155], s[92:93]
    v_pk_mul_f32 v[156:157], v[156:157], s[92:93]
    v_pk_mul_f32 v[158:159], v[158:159], s[92:93]
    v_cvt_pk_bf16_f32 v152, v152, v153
    v_cvt_pk_bf16_f32 v153, v154, v155
    v_cvt_pk_bf16_f32 v154, v156, v157
    v_cvt_pk_bf16_f32 v155, v158, v159
    buffer_store_dwordx4 v[152:155], v2, s[8:11], s90 offen sc1
    s_add_u32 s90, s90, s100
    v_pk_mul_f32 v[192:193], v[192:193], s[92:93]
    v_pk_mul_f32 v[194:195], v[194:195], s[92:93]
    v_pk_mul_f32 v[196:197], v[196:197], s[92:93]
    v_pk_mul_f32 v[198:199], v[198:199], s[92:93]
    v_cvt_pk_bf16_f32 v192, v192, v193
    v_cvt_pk_bf16_f32 v193, v194, v195
    v_cvt_pk_bf16_f32 v194, v196, v197
    v_cvt_pk_bf16_f32 v195, v198, v199
    v_pk_mul_f32 v[200:201], v[200:201], s[92:93]
    v_pk_mul_f32 v[202:203], v[202:203], s[92:93]
    v_pk_mul_f32 v[204:205], v[204:205], s[92:93]
    v_pk_mul_f32 v[206:207], v[206:207], s[92:93]
    v_cvt_pk_bf16_f32 v196, v200, v201
    v_cvt_pk_bf16_f32 v197, v202, v203
    v_cvt_pk_bf16_f32 v198, v204, v205
    v_cvt_pk_bf16_f32 v199, v206, v207
    v_pk_mul_f32 v[208:209], v[208:209], s[92:93]
    v_pk_mul_f32 v[210:211], v[210:211], s[92:93]
    v_pk_mul_f32 v[212:213], v[212:213], s[92:93]
    v_pk_mul_f32 v[214:215], v[214:215], s[92:93]
    v_cvt_pk_bf16_f32 v200, v208, v209
    v_cvt_pk_bf16_f32 v201, v210, v211
    v_cvt_pk_bf16_f32 v202, v212, v213
    v_cvt_pk_bf16_f32 v203, v214, v215
    v_pk_mul_f32 v[216:217], v[216:217], s[92:93]
    v_pk_mul_f32 v[218:219], v[218:219], s[92:93]
    v_pk_mul_f32 v[220:221], v[220:221], s[92:93]
    v_pk_mul_f32 v[222:223], v[222:223], s[92:93]
    v_cvt_pk_bf16_f32 v204, v216, v217
    v_cvt_pk_bf16_f32 v205, v218, v219
    v_cvt_pk_bf16_f32 v206, v220, v221
    v_cvt_pk_bf16_f32 v207, v222, v223
    v_pk_mul_f32 v[224:225], v[224:225], s[92:93]
    v_pk_mul_f32 v[226:227], v[226:227], s[92:93]
    v_pk_mul_f32 v[228:229], v[228:229], s[92:93]
    v_pk_mul_f32 v[230:231], v[230:231], s[92:93]
    v_cvt_pk_bf16_f32 v208, v224, v225
    v_cvt_pk_bf16_f32 v209, v226, v227
    v_cvt_pk_bf16_f32 v210, v228, v229
    v_cvt_pk_bf16_f32 v211, v230, v231
    v_pk_mul_f32 v[232:233], v[232:233], s[92:93]
    v_pk_mul_f32 v[234:235], v[234:235], s[92:93]
    v_pk_mul_f32 v[236:237], v[236:237], s[92:93]
    v_pk_mul_f32 v[238:239], v[238:239], s[92:93]
    v_cvt_pk_bf16_f32 v212, v232, v233
    v_cvt_pk_bf16_f32 v213, v234, v235
    v_cvt_pk_bf16_f32 v214, v236, v237
    v_cvt_pk_bf16_f32 v215, v238, v239
    v_pk_mul_f32 v[240:241], v[240:241], s[92:93]
    v_pk_mul_f32 v[242:243], v[242:243], s[92:93]
    v_pk_mul_f32 v[244:245], v[244:245], s[92:93]
    v_pk_mul_f32 v[246:247], v[246:247], s[92:93]
    v_cvt_pk_bf16_f32 v216, v240, v241
    v_cvt_pk_bf16_f32 v217, v242, v243
    v_cvt_pk_bf16_f32 v218, v244, v245
    v_cvt_pk_bf16_f32 v219, v246, v247
    v_pk_mul_f32 v[248:249], v[248:249], s[92:93]
    v_pk_mul_f32 v[250:251], v[250:251], s[92:93]
    v_pk_mul_f32 v[252:253], v[252:253], s[92:93]
    v_pk_mul_f32 v[254:255], v[254:255], s[92:93]
    v_cvt_pk_bf16_f32 v220, v248, v249
    v_cvt_pk_bf16_f32 v221, v250, v251
    v_cvt_pk_bf16_f32 v222, v252, v253
    v_cvt_pk_bf16_f32 v223, v254, v255
    v_accvgpr_read_b32 v24, a96
    v_accvgpr_read_b32 v25, a97
    v_accvgpr_read_b32 v26, a98
    v_accvgpr_read_b32 v27, a99
    v_accvgpr_read_b32 v28, a100
    v_accvgpr_read_b32 v29, a101
    v_accvgpr_read_b32 v30, a102
    v_accvgpr_read_b32 v31, a103
    v_pk_mul_f32 v[24:25], v[24:25], s[92:93]
    v_pk_mul_f32 v[26:27], v[26:27], s[92:93]
    v_pk_mul_f32 v[28:29], v[28:29], s[92:93]
    v_pk_mul_f32 v[30:31], v[30:31], s[92:93]
    v_cvt_pk_bf16_f32 v224, v24, v25
    v_cvt_pk_bf16_f32 v225, v26, v27
    v_cvt_pk_bf16_f32 v226, v28, v29
    v_cvt_pk_bf16_f32 v227, v30, v31
    v_accvgpr_read_b32 v24, a104
    v_accvgpr_read_b32 v25, a105
    v_accvgpr_read_b32 v26, a106
    v_accvgpr_read_b32 v27, a107
    v_accvgpr_read_b32 v28, a108
    v_accvgpr_read_b32 v29, a109
    v_accvgpr_read_b32 v30, a110
    v_accvgpr_read_b32 v31, a111
    v_pk_mul_f32 v[24:25], v[24:25], s[92:93]
    v_pk_mul_f32 v[26:27], v[26:27], s[92:93]
    v_pk_mul_f32 v[28:29], v[28:29], s[92:93]
    v_pk_mul_f32 v[30:31], v[30:31], s[92:93]
    v_cvt_pk_bf16_f32 v228, v24, v25
    v_cvt_pk_bf16_f32 v229, v26, v27
    v_cvt_pk_bf16_f32 v230, v28, v29
    v_cvt_pk_bf16_f32 v231, v30, v31
    v_accvgpr_read_b32 v24, a112
    v_accvgpr_read_b32 v25, a113
    v_accvgpr_read_b32 v26, a114
    v_accvgpr_read_b32 v27, a115
    v_accvgpr_read_b32 v28, a116
    v_accvgpr_read_b32 v29, a117
    v_accvgpr_read_b32 v30, a118
    v_accvgpr_read_b32 v31, a119
    v_pk_mul_f32 v[24:25], v[24:25], s[92:93]
    v_pk_mul_f32 v[26:27], v[26:27], s[92:93]
    v_pk_mul_f32 v[28:29], v[28:29], s[92:93]
    v_pk_mul_f32 v[30:31], v[30:31], s[92:93]
    v_cvt_pk_bf16_f32 v232, v24, v25
    v_cvt_pk_bf16_f32 v233, v26, v27
    v_cvt_pk_bf16_f32 v234, v28, v29
    v_cvt_pk_bf16_f32 v235, v30, v31
    v_accvgpr_read_b32 v24, a120
    v_accvgpr_read_b32 v25, a121
    v_accvgpr_read_b32 v26, a122
    v_accvgpr_read_b32 v27, a123
    v_accvgpr_read_b32 v28, a124
    v_accvgpr_read_b32 v29, a125
    v_accvgpr_read_b32 v30, a126
    v_accvgpr_read_b32 v31, a127
    v_pk_mul_f32 v[24:25], v[24:25], s[92:93]
    v_pk_mul_f32 v[26:27], v[26:27], s[92:93]
    v_pk_mul_f32 v[28:29], v[28:29], s[92:93]
    v_pk_mul_f32 v[30:31], v[30:31], s[92:93]
    v_cvt_pk_bf16_f32 v236, v24, v25
    v_cvt_pk_bf16_f32 v237, v26, v27
    v_cvt_pk_bf16_f32 v238, v28, v29
    v_cvt_pk_bf16_f32 v239, v30, v31
    v_pk_mul_f32 v[160:161], v[160:161], s[92:93]
    v_pk_mul_f32 v[162:163], v[162:163], s[92:93]
    v_pk_mul_f32 v[164:165], v[164:165], s[92:93]
    v_pk_mul_f32 v[166:167], v[166:167], s[92:93]
    v_cvt_pk_bf16_f32 v240, v160, v161
    v_cvt_pk_bf16_f32 v241, v162, v163
    v_cvt_pk_bf16_f32 v242, v164, v165
    v_cvt_pk_bf16_f32 v243, v166, v167
    v_pk_mul_f32 v[168:169], v[168:169], s[92:93]
    v_pk_mul_f32 v[170:171], v[170:171], s[92:93]
    v_pk_mul_f32 v[172:173], v[172:173], s[92:93]
    v_pk_mul_f32 v[174:175], v[174:175], s[92:93]
    v_cvt_pk_bf16_f32 v244, v168, v169
    v_cvt_pk_bf16_f32 v245, v170, v171
    v_cvt_pk_bf16_f32 v246, v172, v173
    v_cvt_pk_bf16_f32 v247, v174, v175
    v_pk_mul_f32 v[176:177], v[176:177], s[92:93]
    v_pk_mul_f32 v[178:179], v[178:179], s[92:93]
    v_pk_mul_f32 v[180:181], v[180:181], s[92:93]
    v_pk_mul_f32 v[182:183], v[182:183], s[92:93]
    v_cvt_pk_bf16_f32 v248, v176, v177
    v_cvt_pk_bf16_f32 v249, v178, v179
    v_cvt_pk_bf16_f32 v250, v180, v181
    v_cvt_pk_bf16_f32 v251, v182, v183
    v_pk_mul_f32 v[184:185], v[184:185], s[92:93]
    v_pk_mul_f32 v[186:187], v[186:187], s[92:93]
    v_pk_mul_f32 v[188:189], v[188:189], s[92:93]
    v_pk_mul_f32 v[190:191], v[190:191], s[92:93]
    v_cvt_pk_bf16_f32 v252, v184, v185
    v_cvt_pk_bf16_f32 v253, v186, v187
    v_cvt_pk_bf16_f32 v254, v188, v189
    v_cvt_pk_bf16_f32 v255, v190, v191
    s_setpc_b64 s[20:21]
mega_kernel_ns254:
    s_mov_b32 s90, s98
    v_cvt_pk_bf16_f32 v32, v32, v33
    v_cvt_pk_bf16_f32 v33, v34, v35
    v_cvt_pk_bf16_f32 v34, v36, v37
    v_cvt_pk_bf16_f32 v35, v38, v39
    buffer_store_dwordx4 v[32:35], v2, s[8:11], s90 offen sc1
    s_add_u32 s90, s90, s100
    v_cvt_pk_bf16_f32 v40, v40, v41
    v_cvt_pk_bf16_f32 v41, v42, v43
    v_cvt_pk_bf16_f32 v42, v44, v45
    v_cvt_pk_bf16_f32 v43, v46, v47
    buffer_store_dwordx4 v[40:43], v2, s[8:11], s90 offen sc1
    s_add_u32 s90, s90, s100
    v_cvt_pk_bf16_f32 v48, v48, v49
    v_cvt_pk_bf16_f32 v49, v50, v51
    v_cvt_pk_bf16_f32 v50, v52, v53
    v_cvt_pk_bf16_f32 v51, v54, v55
    buffer_store_dwordx4 v[48:51], v2, s[8:11], s90 offen sc1
    s_add_u32 s90, s90, s100
    v_cvt_pk_bf16_f32 v56, v56, v57
    v_cvt_pk_bf16_f32 v57, v58, v59
    v_cvt_pk_bf16_f32 v58, v60, v61
    v_cvt_pk_bf16_f32 v59, v62, v63
    buffer_store_dwordx4 v[56:59], v2, s[8:11], s90 offen sc1
    s_add_u32 s90, s90, s100
    v_cvt_pk_bf16_f32 v64, v64, v65
    v_cvt_pk_bf16_f32 v65, v66, v67
    v_cvt_pk_bf16_f32 v66, v68, v69
    v_cvt_pk_bf16_f32 v67, v70, v71
    buffer_store_dwordx4 v[64:67], v2, s[8:11], s90 offen sc1
    s_add_u32 s90, s90, s100
    v_cvt_pk_bf16_f32 v72, v72, v73
    v_cvt_pk_bf16_f32 v73, v74, v75
    v_cvt_pk_bf16_f32 v74, v76, v77
    v_cvt_pk_bf16_f32 v75, v78, v79
    buffer_store_dwordx4 v[72:75], v2, s[8:11], s90 offen sc1
    s_add_u32 s90, s90, s100
    v_cvt_pk_bf16_f32 v80, v80, v81
    v_cvt_pk_bf16_f32 v81, v82, v83
    v_cvt_pk_bf16_f32 v82, v84, v85
    v_cvt_pk_bf16_f32 v83, v86, v87
    buffer_store_dwordx4 v[80:83], v2, s[8:11], s90 offen sc1
    s_add_u32 s90, s90, s100
    v_cvt_pk_bf16_f32 v88, v88, v89
    v_cvt_pk_bf16_f32 v89, v90, v91
    v_cvt_pk_bf16_f32 v90, v92, v93
    v_cvt_pk_bf16_f32 v91, v94, v95
    buffer_store_dwordx4 v[88:91], v2, s[8:11], s90 offen sc1
    s_add_u32 s90, s98, s99
    v_cvt_pk_bf16_f32 v96, v96, v97
    v_cvt_pk_bf16_f32 v97, v98, v99
    v_cvt_pk_bf16_f32 v98, v100, v101
    v_cvt_pk_bf16_f32 v99, v102, v103
    buffer_store_dwordx4 v[96:99], v2, s[8:11], s90 offen sc1
    s_add_u32 s90, s90, s100
    v_cvt_pk_bf16_f32 v104, v104, v105
    v_cvt_pk_bf16_f32 v105, v106, v107
    v_cvt_pk_bf16_f32 v106, v108, v109
    v_cvt_pk_bf16_f32 v107, v110, v111
    buffer_store_dwordx4 v[104:107], v2, s[8:11], s90 offen sc1
    s_add_u32 s90, s90, s100
    v_cvt_pk_bf16_f32 v112, v112, v113
    v_cvt_pk_bf16_f32 v113, v114, v115
    v_cvt_pk_bf16_f32 v114, v116, v117
    v_cvt_pk_bf16_f32 v115, v118, v119
    buffer_store_dwordx4 v[112:115], v2, s[8:11], s90 offen sc1
    s_add_u32 s90, s90, s100
    v_cvt_pk_bf16_f32 v120, v120, v121
    v_cvt_pk_bf16_f32 v121, v122, v123
    v_cvt_pk_bf16_f32 v122, v124, v125
    v_cvt_pk_bf16_f32 v123, v126, v127
    buffer_store_dwordx4 v[120:123], v2, s[8:11], s90 offen sc1
    s_add_u32 s90, s90, s100
    v_cvt_pk_bf16_f32 v128, v128, v129
    v_cvt_pk_bf16_f32 v129, v130, v131
    v_cvt_pk_bf16_f32 v130, v132, v133
    v_cvt_pk_bf16_f32 v131, v134, v135
    buffer_store_dwordx4 v[128:131], v2, s[8:11], s90 offen sc1
    s_add_u32 s90, s90, s100
    v_cvt_pk_bf16_f32 v136, v136, v137
    v_cvt_pk_bf16_f32 v137, v138, v139
    v_cvt_pk_bf16_f32 v138, v140, v141
    v_cvt_pk_bf16_f32 v139, v142, v143
    buffer_store_dwordx4 v[136:139], v2, s[8:11], s90 offen sc1
    s_add_u32 s90, s90, s100
    v_cvt_pk_bf16_f32 v144, v144, v145
    v_cvt_pk_bf16_f32 v145, v146, v147
    v_cvt_pk_bf16_f32 v146, v148, v149
    v_cvt_pk_bf16_f32 v147, v150, v151
    buffer_store_dwordx4 v[144:147], v2, s[8:11], s90 offen sc1
    s_add_u32 s90, s90, s100
    v_cvt_pk_bf16_f32 v152, v152, v153
    v_cvt_pk_bf16_f32 v153, v154, v155
    v_cvt_pk_bf16_f32 v154, v156, v157
    v_cvt_pk_bf16_f32 v155, v158, v159
    buffer_store_dwordx4 v[152:155], v2, s[8:11], s90 offen sc1
    s_add_u32 s90, s90, s100
    v_cvt_pk_bf16_f32 v192, v192, v193
    v_cvt_pk_bf16_f32 v193, v194, v195
    v_cvt_pk_bf16_f32 v194, v196, v197
    v_cvt_pk_bf16_f32 v195, v198, v199
    v_cvt_pk_bf16_f32 v196, v200, v201
    v_cvt_pk_bf16_f32 v197, v202, v203
    v_cvt_pk_bf16_f32 v198, v204, v205
    v_cvt_pk_bf16_f32 v199, v206, v207
    v_cvt_pk_bf16_f32 v200, v208, v209
    v_cvt_pk_bf16_f32 v201, v210, v211
    v_cvt_pk_bf16_f32 v202, v212, v213
    v_cvt_pk_bf16_f32 v203, v214, v215
    v_cvt_pk_bf16_f32 v204, v216, v217
    v_cvt_pk_bf16_f32 v205, v218, v219
    v_cvt_pk_bf16_f32 v206, v220, v221
    v_cvt_pk_bf16_f32 v207, v222, v223
    v_cvt_pk_bf16_f32 v208, v224, v225
    v_cvt_pk_bf16_f32 v209, v226, v227
    v_cvt_pk_bf16_f32 v210, v228, v229
    v_cvt_pk_bf16_f32 v211, v230, v231
    v_cvt_pk_bf16_f32 v212, v232, v233
    v_cvt_pk_bf16_f32 v213, v234, v235
    v_cvt_pk_bf16_f32 v214, v236, v237
    v_cvt_pk_bf16_f32 v215, v238, v239
    v_cvt_pk_bf16_f32 v216, v240, v241
    v_cvt_pk_bf16_f32 v217, v242, v243
    v_cvt_pk_bf16_f32 v218, v244, v245
    v_cvt_pk_bf16_f32 v219, v246, v247
    v_cvt_pk_bf16_f32 v220, v248, v249
    v_cvt_pk_bf16_f32 v221, v250, v251
    v_cvt_pk_bf16_f32 v222, v252, v253
    v_cvt_pk_bf16_f32 v223, v254, v255
    v_accvgpr_read_b32 v24, a96
    v_accvgpr_read_b32 v25, a97
    v_accvgpr_read_b32 v26, a98
    v_accvgpr_read_b32 v27, a99
    v_accvgpr_read_b32 v28, a100
    v_accvgpr_read_b32 v29, a101
    v_accvgpr_read_b32 v30, a102
    v_accvgpr_read_b32 v31, a103
    v_cvt_pk_bf16_f32 v224, v24, v25
    v_cvt_pk_bf16_f32 v225, v26, v27
    v_cvt_pk_bf16_f32 v226, v28, v29
    v_cvt_pk_bf16_f32 v227, v30, v31
    v_accvgpr_read_b32 v24, a104
    v_accvgpr_read_b32 v25, a105
    v_accvgpr_read_b32 v26, a106
    v_accvgpr_read_b32 v27, a107
    v_accvgpr_read_b32 v28, a108
    v_accvgpr_read_b32 v29, a109
    v_accvgpr_read_b32 v30, a110
    v_accvgpr_read_b32 v31, a111
    v_cvt_pk_bf16_f32 v228, v24, v25
    v_cvt_pk_bf16_f32 v229, v26, v27
    v_cvt_pk_bf16_f32 v230, v28, v29
    v_cvt_pk_bf16_f32 v231, v30, v31
    v_accvgpr_read_b32 v24, a112
    v_accvgpr_read_b32 v25, a113
    v_accvgpr_read_b32 v26, a114
    v_accvgpr_read_b32 v27, a115
    v_accvgpr_read_b32 v28, a116
    v_accvgpr_read_b32 v29, a117
    v_accvgpr_read_b32 v30, a118
    v_accvgpr_read_b32 v31, a119
    v_cvt_pk_bf16_f32 v232, v24, v25
    v_cvt_pk_bf16_f32 v233, v26, v27
    v_cvt_pk_bf16_f32 v234, v28, v29
    v_cvt_pk_bf16_f32 v235, v30, v31
    v_accvgpr_read_b32 v24, a120
    v_accvgpr_read_b32 v25, a121
    v_accvgpr_read_b32 v26, a122
    v_accvgpr_read_b32 v27, a123
    v_accvgpr_read_b32 v28, a124
    v_accvgpr_read_b32 v29, a125
    v_accvgpr_read_b32 v30, a126
    v_accvgpr_read_b32 v31, a127
    v_cvt_pk_bf16_f32 v236, v24, v25
    v_cvt_pk_bf16_f32 v237, v26, v27
    v_cvt_pk_bf16_f32 v238, v28, v29
    v_cvt_pk_bf16_f32 v239, v30, v31
    v_cvt_pk_bf16_f32 v240, v160, v161
    v_cvt_pk_bf16_f32 v241, v162, v163
    v_cvt_pk_bf16_f32 v242, v164, v165
    v_cvt_pk_bf16_f32 v243, v166, v167
    v_cvt_pk_bf16_f32 v244, v168, v169
    v_cvt_pk_bf16_f32 v245, v170, v171
    v_cvt_pk_bf16_f32 v246, v172, v173
    v_cvt_pk_bf16_f32 v247, v174, v175
    v_cvt_pk_bf16_f32 v248, v176, v177
    v_cvt_pk_bf16_f32 v249, v178, v179
    v_cvt_pk_bf16_f32 v250, v180, v181
    v_cvt_pk_bf16_f32 v251, v182, v183
    v_cvt_pk_bf16_f32 v252, v184, v185
    v_cvt_pk_bf16_f32 v253, v186, v187
    v_cvt_pk_bf16_f32 v254, v188, v189
    v_cvt_pk_bf16_f32 v255, v190, v191
    s_setpc_b64 s[20:21]
mega_kernel_end:
.text
.globl gemm3_kernel
.p2align 8
.type gemm3_kernel,@function
gemm3_kernel:
    s_cmp_ge_u32 s2, 256
    s_cbranch_scc1 gemm3_kernel_end1
    s_load_dwordx8 s[4:11], s[0:1], 64
    s_load_dwordx2 s[12:13], s[0:1], 16
    v_and_b32 v1, 63, v0
    v_lshrrev_b32 v16, 6, v0
    s_nop 0
    v_readfirstlane_b32 s32, v16
    s_nop 3
    s_lshr_b32 s36, s32, 2
    s_and_b32 s32, s32, 3
    s_bfe_u32 s35, s2, 0x10002
    s_xor_b32 s35, s35, 1
    s_bfe_u32 s48, s2, 0x10001
    s_lshl_b32 s48, s48, 3
    s_bfe_u32 s49, s2, 0x30003
    s_add_u32 s37, s48, s49
    s_and_b32 s48, s2, 1
    s_lshl_b32 s48, s48, 2
    s_lshr_b32 s49, s2, 6
    s_add_u32 s38, s48, s49
    s_lshr_b32 s33, s32, 1
    s_and_b32 s34, s32, 1
    v_lshlrev_b32 v7, 4, v1
    s_cmp_eq_u32 s36, 1
    s_cbranch_scc1 gemm3_kernel_load2
    s_lshl_b32 s39, s37, 3
    s_add_u32 s39, s39, s38
    s_lshl_b32 s48, s33, 12
    v_add_u32 v2, s48, v7
    v_lshrrev_b32 v16, 2, v1
    v_lshlrev_b32 v16, 8, v16
    v_and_b32 v17, 3, v1
    v_lshl_add_u32 v16, v17, 3, v16
    v_add_u32 v16, 16384, v16
    v_bfe_u32 v17, v1, 2, 3
    s_lshl_b32 s48, s34, 2
    v_xor_b32 v17, s48, v17
    v_xor_b32 v18, 0, v17
    v_lshl_add_u32 v3, v18, 5, v16
    v_xor_b32 v18, 1, v17
    v_lshl_add_u32 v4, v18, 5, v16
    v_xor_b32 v18, 2, v17
    v_lshl_add_u32 v5, v18, 5, v16
    v_xor_b32 v18, 3, v17
    v_lshl_add_u32 v6, v18, 5, v16
    s_mov_b32 s43, 0
    s_mov_b32 s56, 32768
    s_cmp_eq_u32 s35, 1
    s_cselect_b32 s47, 38, 40
    v_mov_b32 v32, 0
    v_mov_b32 v33, 0
    v_mov_b32 v34, 0
    v_mov_b32 v35, 0
    v_mov_b32 v36, 0
    v_mov_b32 v37, 0
    v_mov_b32 v38, 0
    v_mov_b32 v39, 0
    v_mov_b32 v40, 0
    v_mov_b32 v41, 0
    v_mov_b32 v42, 0
    v_mov_b32 v43, 0
    v_mov_b32 v44, 0
    v_mov_b32 v45, 0
    v_mov_b32 v46, 0
    v_mov_b32 v47, 0
    v_mov_b32 v48, 0
    v_mov_b32 v49, 0
    v_mov_b32 v50, 0
    v_mov_b32 v51, 0
    v_mov_b32 v52, 0
    v_mov_b32 v53, 0
    v_mov_b32 v54, 0
    v_mov_b32 v55, 0
    v_mov_b32 v56, 0
    v_mov_b32 v57, 0
    v_mov_b32 v58, 0
    v_mov_b32 v59, 0
    v_mov_b32 v60, 0
    v_mov_b32 v61, 0
    v_mov_b32 v62, 0
    v_mov_b32 v63, 0
    v_mov_b32 v64, 0
    v_mov_b32 v65, 0
    v_mov_b32 v66, 0
    v_mov_b32 v67, 0
    v_mov_b32 v68, 0
    v_mov_b32 v69, 0
    v_mov_b32 v70, 0
    v_mov_b32 v71, 0
    v_mov_b32 v72, 0
    v_mov_b32 v73, 0
    v_mov_b32 v74, 0
    v_mov_b32 v75, 0
    v_mov_b32 v76, 0
    v_mov_b32 v77, 0
    v_mov_b32 v78, 0
    v_mov_b32 v79, 0
    v_mov_b32 v80, 0
    v_mov_b32 v81, 0
    v_mov_b32 v82, 0
    v_mov_b32 v83, 0
    v_mov_b32 v84, 0
    v_mov_b32 v85, 0
    v_mov_b32 v86, 0
    v_mov_b32 v87, 0
    v_mov_b32 v88, 0
    v_mov_b32 v89, 0
    v_mov_b32 v90, 0
    v_mov_b32 v91, 0
    v_mov_b32 v92, 0
    v_mov_b32 v93, 0
    v_mov_b32 v94, 0
    v_mov_b32 v95, 0
    v_and_b32 v16, 15, v1
    v_lshlrev_b32 v16, 12, v16
    v_lshlrev_b32 v16, s35, v16
    v_bfe_u32 v17, v1, 4, 1
    v_lshl_add_u32 v16, v17, 5, v16
    v_lshrrev_b32 v17, 5, v1
    v_lshl_add_u32 v12, v17, 4, v16
    s_lshl_b32 s48, s37, 3
    s_lshl_b32 s49, s33, 2
    s_add_u32 s48, s48, s49
    s_lshl_b32 s49, s48, 16
    s_add_u32 s49, s49, 2048
    s_and_b32 s50, s48, 63
    s_lshl_b32 s50, s50, 17
    s_lshr_b32 s51, s48, 6
    s_lshl_b32 s51, s51, 12
    s_add_u32 s50, s50, s51
    s_cmp_eq_u32 s35, 1
    s_cselect_b32 s41, s50, s49
    s_lshl_b32 s42, 0x10000, s35
    s_lshl_b32 s50, s38, 8
    s_lshl_b32 s51, s34, 7
    s_add_u32 s41, s41, s50
    s_add_u32 s41, s41, s51
    s_cmp_eq_u32 s35, 1
    s_cselect_b32 s57, 23, 35
    s_cselect_b32 s58, 0, 16
    s_waitcnt lgkmcnt(0)
    s_mov_b32 s24, s6
    s_mov_b32 s25, s7
    s_mov_b32 s27, 0x20000
    s_mov_b32 s26, 8388608
    s_mov_b32 s28, s10
    s_mov_b32 s29, s11
    s_mov_b32 s31, 0x20000
    s_mov_b32 s30, 268435456
    s_setprio 1
    s_barrier
    ds_read_b128 v[96:99], v2 offset:0
    ds_read_b64_tr_b16 v[112:113], v3 offset:0
    ds_read_b64_tr_b16 v[114:115], v3 offset:4096
    ds_read_b128 v[100:103], v2 offset:1024
    ds_read_b128 v[104:107], v2 offset:2048
    ds_read_b128 v[108:111], v2 offset:3072
    ds_read_b64_tr_b16 v[116:117], v4 offset:0
    ds_read_b64_tr_b16 v[118:119], v4 offset:4096
    ds_read_b64_tr_b16 v[120:121], v5 offset:0
    ds_read_b64_tr_b16 v[122:123], v5 offset:4096
    ds_read_b64_tr_b16 v[124:125], v6 offset:0
    ds_read_b64_tr_b16 v[126:127], v6 offset:4096
gemm3_kernel_loop3:
    s_sub_u32 s57, s57, 1
    s_cbranch_scc1 gemm3_kernel_ev4
gemm3_kernel_back5:
    s_waitcnt lgkmcnt(9)
    v_mfma_f32_16x16x32_bf16 v[32:35], v[112:115], v[96:99], v[32:35]
    ds_read_b128 v[128:131], v2 offset:8192
    s_waitcnt lgkmcnt(9)
    v_mfma_f32_16x16x32_bf16 v[40:43], v[112:115], v[100:103], v[40:43]
    ds_read_b64_tr_b16 v[144:145], v3 offset:8192
    s_waitcnt lgkmcnt(9)
    v_mfma_f32_16x16x32_bf16 v[48:51], v[112:115], v[104:107], v[48:51]
    ds_read_b64_tr_b16 v[146:147], v3 offset:12288
    s_waitcnt lgkmcnt(9)
    v_mfma_f32_16x16x32_bf16 v[56:59], v[112:115], v[108:111], v[56:59]
    ds_read_b128 v[132:135], v2 offset:9216
    s_waitcnt lgkmcnt(8)
    v_mfma_f32_16x16x32_bf16 v[36:39], v[116:119], v[96:99], v[36:39]
    ds_read_b128 v[136:139], v2 offset:10240
    v_mfma_f32_16x16x32_bf16 v[44:47], v[116:119], v[100:103], v[44:47]
    ds_read_b128 v[140:143], v2 offset:11264
    v_mfma_f32_16x16x32_bf16 v[52:55], v[116:119], v[104:107], v[52:55]
    ds_read_b64_tr_b16 v[148:149], v4 offset:8192
    v_mfma_f32_16x16x32_bf16 v[60:63], v[116:119], v[108:111], v[60:63]
    ds_read_b64_tr_b16 v[150:151], v4 offset:12288
    s_waitcnt lgkmcnt(10)
    v_mfma_f32_16x16x32_bf16 v[64:67], v[120:123], v[96:99], v[64:67]
    s_add_u32 s43, s43, 32768
    ds_read_b64_tr_b16 v[152:153], v5 offset:8192
    v_mfma_f32_16x16x32_bf16 v[72:75], v[120:123], v[100:103], v[72:75]
    s_cmp_ge_u32 s43, 163840
    ds_read_b64_tr_b16 v[154:155], v5 offset:12288
    v_mfma_f32_16x16x32_bf16 v[80:83], v[120:123], v[104:107], v[80:83]
    s_cselect_b32 s46, 4294836224, s56
    ds_read_b64_tr_b16 v[156:157], v6 offset:8192
    v_mfma_f32_16x16x32_bf16 v[88:91], v[120:123], v[108:111], v[88:91]
    s_cselect_b32 s43, 0, s43
    ds_read_b64_tr_b16 v[158:159], v6 offset:12288
    s_waitcnt lgkmcnt(12)
    v_mfma_f32_16x16x32_bf16 v[68:71], v[124:127], v[96:99], v[68:71]
    v_add_u32 v2, s46, v2
    v_add_u32 v3, s46, v3
    v_mfma_f32_16x16x32_bf16 v[76:79], v[124:127], v[100:103], v[76:79]
    v_add_u32 v4, s46, v4
    v_add_u32 v5, s46, v5
    v_mfma_f32_16x16x32_bf16 v[84:87], v[124:127], v[104:107], v[84:87]
    v_add_u32 v6, s46, v6
    v_mfma_f32_16x16x32_bf16 v[92:95], v[124:127], v[108:111], v[92:95]
    s_waitcnt lgkmcnt(0)
    v_mfma_f32_16x16x32_bf16 v[32:35], v[144:147], v[128:131], v[32:35]
    s_barrier
    v_mfma_f32_16x16x32_bf16 v[40:43], v[144:147], v[132:135], v[40:43]
    ds_read_b128 v[96:99], v2 offset:0
    v_mfma_f32_16x16x32_bf16 v[48:51], v[144:147], v[136:139], v[48:51]
    ds_read_b64_tr_b16 v[112:113], v3 offset:0
    v_mfma_f32_16x16x32_bf16 v[56:59], v[144:147], v[140:143], v[56:59]
    ds_read_b64_tr_b16 v[114:115], v3 offset:4096
    v_mfma_f32_16x16x32_bf16 v[36:39], v[148:151], v[128:131], v[36:39]
    ds_read_b128 v[100:103], v2 offset:1024
    v_mfma_f32_16x16x32_bf16 v[44:47], v[148:151], v[132:135], v[44:47]
    ds_read_b128 v[104:107], v2 offset:2048
    v_mfma_f32_16x16x32_bf16 v[52:55], v[148:151], v[136:139], v[52:55]
    ds_read_b128 v[108:111], v2 offset:3072
    v_mfma_f32_16x16x32_bf16 v[60:63], v[148:151], v[140:143], v[60:63]
    ds_read_b64_tr_b16 v[116:117], v4 offset:0
    v_mfma_f32_16x16x32_bf16 v[64:67], v[152:155], v[128:131], v[64:67]
    ds_read_b64_tr_b16 v[118:119], v4 offset:4096
    v_mfma_f32_16x16x32_bf16 v[72:75], v[152:155], v[132:135], v[72:75]
    ds_read_b64_tr_b16 v[120:121], v5 offset:0
    v_mfma_f32_16x16x32_bf16 v[80:83], v[152:155], v[136:139], v[80:83]
    ds_read_b64_tr_b16 v[122:123], v5 offset:4096
    v_mfma_f32_16x16x32_bf16 v[88:91], v[152:155], v[140:143], v[88:91]
    ds_read_b64_tr_b16 v[124:125], v6 offset:0
    v_mfma_f32_16x16x32_bf16 v[68:71], v[156:159], v[128:131], v[68:71]
    ds_read_b64_tr_b16 v[126:127], v6 offset:4096
    v_mfma_f32_16x16x32_bf16 v[76:79], v[156:159], v[132:135], v[76:79]
    v_mfma_f32_16x16x32_bf16 v[84:87], v[156:159], v[136:139], v[84:87]
    s_sub_u32 s47, s47, 1
    v_mfma_f32_16x16x32_bf16 v[92:95], v[156:159], v[140:143], v[92:95]
    s_cbranch_scc0 gemm3_kernel_loop3
    s_nop 5
    s_cmp_eq_u32 s35, 1
    s_cbranch_scc1 gemm3_kernel_noadd7
    s_waitcnt vmcnt(0) lgkmcnt(0)
    v_lshlrev_b32 v96, 16, v160
    v_and_b32 v97, 0xffff0000, v160
    v_lshlrev_b32 v98, 16, v161
    v_and_b32 v99, 0xffff0000, v161
    v_lshlrev_b32 v100, 16, v162
    v_and_b32 v101, 0xffff0000, v162
    v_lshlrev_b32 v102, 16, v163
    v_and_b32 v103, 0xffff0000, v163
    v_lshlrev_b32 v104, 16, v164
    v_and_b32 v105, 0xffff0000, v164
    v_lshlrev_b32 v106, 16, v165
    v_and_b32 v107, 0xffff0000, v165
    v_lshlrev_b32 v108, 16, v166
    v_and_b32 v109, 0xffff0000, v166
    v_lshlrev_b32 v110, 16, v167
    v_and_b32 v111, 0xffff0000, v167
    v_lshlrev_b32 v112, 16, v168
    v_and_b32 v113, 0xffff0000, v168
    v_lshlrev_b32 v114, 16, v169
    v_and_b32 v115, 0xffff0000, v169
    v_lshlrev_b32 v116, 16, v170
    v_and_b32 v117, 0xffff0000, v170
    v_lshlrev_b32 v118, 16, v171
    v_and_b32 v119, 0xffff0000, v171
    v_lshlrev_b32 v120, 16, v172
    v_and_b32 v121, 0xffff0000, v172
    v_lshlrev_b32 v122, 16, v173
    v_and_b32 v123, 0xffff0000, v173
    v_lshlrev_b32 v124, 16, v174
    v_and_b32 v125, 0xffff0000, v174
    v_lshlrev_b32 v126, 16, v175
    v_and_b32 v127, 0xffff0000, v175
    v_lshlrev_b32 v128, 16, v176
    v_and_b32 v129, 0xffff0000, v176
    v_lshlrev_b32 v130, 16, v177
    v_and_b32 v131, 0xffff0000, v177
    v_lshlrev_b32 v132, 16, v178
    v_and_b32 v133, 0xffff0000, v178
    v_lshlrev_b32 v134, 16, v179
    v_and_b32 v135, 0xffff0000, v179
    v_lshlrev_b32 v136, 16, v180
    v_and_b32 v137, 0xffff0000, v180
    v_lshlrev_b32 v138, 16, v181
    v_and_b32 v139, 0xffff0000, v181
    v_lshlrev_b32 v140, 16, v182
    v_and_b32 v141, 0xffff0000, v182
    v_lshlrev_b32 v142, 16, v183
    v_and_b32 v143, 0xffff0000, v183
    v_lshlrev_b32 v144, 16, v184
    v_and_b32 v145, 0xffff0000, v184
    v_lshlrev_b32 v146, 16, v185
    v_and_b32 v147, 0xffff0000, v185
    v_lshlrev_b32 v148, 16, v186
    v_and_b32 v149, 0xffff0000, v186
    v_lshlrev_b32 v150, 16, v187
    v_and_b32 v151, 0xffff0000, v187
    v_lshlrev_b32 v152, 16, v188
    v_and_b32 v153, 0xffff0000, v188
    v_lshlrev_b32 v154, 16, v189
    v_and_b32 v155, 0xffff0000, v189
    v_lshlrev_b32 v156, 16, v190
    v_and_b32 v157, 0xffff0000, v190
    v_lshlrev_b32 v158, 16, v191
    v_and_b32 v159, 0xffff0000, v191
    v_pk_add_f32 v[32:33], v[32:33], v[96:97]
    v_pk_add_f32 v[34:35], v[34:35], v[98:99]
    v_pk_add_f32 v[36:37], v[36:37], v[100:101]
    v_pk_add_f32 v[38:39], v[38:39], v[102:103]
    v_pk_add_f32 v[40:41], v[40:41], v[104:105]
    v_pk_add_f32 v[42:43], v[42:43], v[106:107]
    v_pk_add_f32 v[44:45], v[44:45], v[108:109]
    v_pk_add_f32 v[46:47], v[46:47], v[110:111]
    v_pk_add_f32 v[48:49], v[48:49], v[112:113]
    v_pk_add_f32 v[50:51], v[50:51], v[114:115]
    v_pk_add_f32 v[52:53], v[52:53], v[116:117]
    v_pk_add_f32 v[54:55], v[54:55], v[118:119]
    v_pk_add_f32 v[56:57], v[56:57], v[120:121]
    v_pk_add_f32 v[58:59], v[58:59], v[122:123]
    v_pk_add_f32 v[60:61], v[60:61], v[124:125]
    v_pk_add_f32 v[62:63], v[62:63], v[126:127]
    v_pk_add_f32 v[64:65], v[64:65], v[128:129]
    v_pk_add_f32 v[66:67], v[66:67], v[130:131]
    v_pk_add_f32 v[68:69], v[68:69], v[132:133]
    v_pk_add_f32 v[70:71], v[70:71], v[134:135]
    v_pk_add_f32 v[72:73], v[72:73], v[136:137]
    v_pk_add_f32 v[74:75], v[74:75], v[138:139]
    v_pk_add_f32 v[76:77], v[76:77], v[140:141]
    v_pk_add_f32 v[78:79], v[78:79], v[142:143]
    v_pk_add_f32 v[80:81], v[80:81], v[144:145]
    v_pk_add_f32 v[82:83], v[82:83], v[146:147]
    v_pk_add_f32 v[84:85], v[84:85], v[148:149]
    v_pk_add_f32 v[86:87], v[86:87], v[150:151]
    v_pk_add_f32 v[88:89], v[88:89], v[152:153]
    v_pk_add_f32 v[90:91], v[90:91], v[154:155]
    v_pk_add_f32 v[92:93], v[92:93], v[156:157]
    v_pk_add_f32 v[94:95], v[94:95], v[158:159]
gemm3_kernel_noadd7:
    v_cvt_pk_bf16_f32 v32, v32, v33
    v_cvt_pk_bf16_f32 v33, v34, v35
    v_cvt_pk_bf16_f32 v34, v36, v37
    v_cvt_pk_bf16_f32 v35, v38, v39
    v_cvt_pk_bf16_f32 v64, v64, v65
    v_cvt_pk_bf16_f32 v65, v66, v67
    v_cvt_pk_bf16_f32 v66, v68, v69
    v_cvt_pk_bf16_f32 v67, v70, v71
    s_nop 1
    v_permlane16_swap_b32 v32, v34
    v_permlane16_swap_b32 v33, v35
    v_permlane16_swap_b32 v64, v66
    v_permlane16_swap_b32 v65, v67
    buffer_store_dwordx4 v[32:35], v12, s[24:27], s41 offen offset:0
    buffer_store_dwordx4 v[64:67], v12, s[24:27], s41 offen offset:64
    s_add_u32 s41, s41, s42
    v_cvt_pk_bf16_f32 v40, v40, v41
    v_cvt_pk_bf16_f32 v41, v42, v43
    v_cvt_pk_bf16_f32 v42, v44, v45
    v_cvt_pk_bf16_f32 v43, v46, v47
    v_cvt_pk_bf16_f32 v72, v72, v73
    v_cvt_pk_bf16_f32 v73, v74, v75
    v_cvt_pk_bf16_f32 v74, v76, v77
    v_cvt_pk_bf16_f32 v75, v78, v79
    s_nop 1
    v_permlane16_swap_b32 v40, v42
    v_permlane16_swap_b32 v41, v43
    v_permlane16_swap_b32 v72, v74
    v_permlane16_swap_b32 v73, v75
    buffer_store_dwordx4 v[40:43], v12, s[24:27], s41 offen offset:0
    buffer_store_dwordx4 v[72:75], v12, s[24:27], s41 offen offset:64
    s_add_u32 s41, s41, s42
    v_cvt_pk_bf16_f32 v48, v48, v49
    v_cvt_pk_bf16_f32 v49, v50, v51
    v_cvt_pk_bf16_f32 v50, v52, v53
    v_cvt_pk_bf16_f32 v51, v54, v55
    v_cvt_pk_bf16_f32 v80, v80, v81
    v_cvt_pk_bf16_f32 v81, v82, v83
    v_cvt_pk_bf16_f32 v82, v84, v85
    v_cvt_pk_bf16_f32 v83, v86, v87
    s_nop 1
    v_permlane16_swap_b32 v48, v50
    v_permlane16_swap_b32 v49, v51
    v_permlane16_swap_b32 v80, v82
    v_permlane16_swap_b32 v81, v83
    buffer_store_dwordx4 v[48:51], v12, s[24:27], s41 offen offset:0
    buffer_store_dwordx4 v[80:83], v12, s[24:27], s41 offen offset:64
    s_add_u32 s41, s41, s42
    v_cvt_pk_bf16_f32 v56, v56, v57
    v_cvt_pk_bf16_f32 v57, v58, v59
    v_cvt_pk_bf16_f32 v58, v60, v61
    v_cvt_pk_bf16_f32 v59, v62, v63
    v_cvt_pk_bf16_f32 v88, v88, v89
    v_cvt_pk_bf16_f32 v89, v90, v91
    v_cvt_pk_bf16_f32 v90, v92, v93
    v_cvt_pk_bf16_f32 v91, v94, v95
    s_nop 1
    v_permlane16_swap_b32 v56, v58
    v_permlane16_swap_b32 v57, v59
    v_permlane16_swap_b32 v88, v90
    v_permlane16_swap_b32 v89, v91
    buffer_store_dwordx4 v[56:59], v12, s[24:27], s41 offen offset:0
    buffer_store_dwordx4 v[88:91], v12, s[24:27], s41 offen offset:64
    s_add_u32 s41, s41, s42
gemm3_kernel_end1:
    s_endpgm
gemm3_kernel_ev4:
    s_cmp_lg_u32 s58, 16
    s_cbranch_scc1 gemm3_kernel_n8
    s_lshl_b32 s48, s39, 7
    s_add_u32 s48, s48, 117506048
    buffer_load_dword v14, off, s[28:31], s48 sc1
    s_mov_b32 s57, 1
    s_mov_b32 s58, 17
    s_branch gemm3_kernel_back5
gemm3_kernel_n8:
    s_cmp_lg_u32 s58, 17
    s_cbranch_scc1 gemm3_kernel_n9
    s_waitcnt vmcnt(0)
    s_mov_b32 s3, 1048576
gemm3_kernel_spin10:
    v_readfirstlane_b32 s49, v14
    s_nop 3
    s_cmp_lg_u32 s49, 0
    s_cbranch_scc1 gemm3_kernel_ok11
    s_sub_u32 s3, s3, 1
    s_cbranch_scc1 gemm3_kernel_ok11
    s_sleep 8
    s_lshl_b32 s48, s39, 7
    s_add_u32 s48, s48, 117506048
    buffer_load_dword v14, off, s[28:31], s48 sc1
    s_waitcnt vmcnt(0)
    s_branch gemm3_kernel_spin10
gemm3_kernel_ok11:
    s_lshl_b32 s48, s39, 16
    s_lshl_b32 s49, s32, 14
    s_add_u32 s48, s48, s49
    s_add_u32 s48, s48, 100663296
    buffer_load_dwordx4 v[160:163], v7, s[28:31], s48 offen offset:0 sc1
    buffer_load_dwordx4 v[164:167], v7, s[28:31], s48 offen offset:1024 sc1
    buffer_load_dwordx4 v[168:171], v7, s[28:31], s48 offen offset:2048 sc1
    buffer_load_dwordx4 v[172:175], v7, s[28:31], s48 offen offset:3072 sc1
    s_add_u32 s48, s48, 4096
    buffer_load_dwordx4 v[176:179], v7, s[28:31], s48 offen offset:0 sc1
    buffer_load_dwordx4 v[180:183], v7, s[28:31], s48 offen offset:1024 sc1
    buffer_load_dwordx4 v[184:187], v7, s[28:31], s48 offen offset:2048 sc1
    buffer_load_dwordx4 v[188:191], v7, s[28:31], s48 offen offset:3072 sc1
    s_add_u32 s48, s48, 4096
    s_mov_b32 s57, 1000
    s_mov_b32 s58, 18
    s_branch gemm3_kernel_back5
gemm3_kernel_n9:
    s_cmp_lg_u32 s58, 0
    s_cbranch_scc1 gemm3_kernel_n12
    s_lshl_b32 s48, s39, 16
    s_lshl_b32 s49, s32, 14
    s_add_u32 s48, s48, s49
    s_add_u32 s48, s48, 100663296
    s_mov_b32 s59, s48
    s_nop 3
    v_cvt_pk_bf16_f32 v160, v32, v33
    v_cvt_pk_bf16_f32 v161, v34, v35
    v_cvt_pk_bf16_f32 v162, v36, v37
    v_cvt_pk_bf16_f32 v163, v38, v39
    v_cvt_pk_bf16_f32 v164, v40, v41
    v_cvt_pk_bf16_f32 v165, v42, v43
    v_cvt_pk_bf16_f32 v166, v44, v45
    v_cvt_pk_bf16_f32 v167, v46, v47
    v_cvt_pk_bf16_f32 v168, v48, v49
    v_cvt_pk_bf16_f32 v169, v50, v51
    v_cvt_pk_bf16_f32 v170, v52, v53
    v_cvt_pk_bf16_f32 v171, v54, v55
    v_cvt_pk_bf16_f32 v172, v56, v57
    v_cvt_pk_bf16_f32 v173, v58, v59
    v_cvt_pk_bf16_f32 v174, v60, v61
    v_cvt_pk_bf16_f32 v175, v62, v63
    v_cvt_pk_bf16_f32 v176, v64, v65
    v_cvt_pk_bf16_f32 v177, v66, v67
    v_cvt_pk_bf16_f32 v178, v68, v69
    v_cvt_pk_bf16_f32 v179, v70, v71
    v_cvt_pk_bf16_f32 v180, v72, v73
    v_cvt_pk_bf16_f32 v181, v74, v75
    v_cvt_pk_bf16_f32 v182, v76, v77
    v_cvt_pk_bf16_f32 v183, v78, v79
    v_cvt_pk_bf16_f32 v184, v80, v81
    v_cvt_pk_bf16_f32 v185, v82, v83
    v_cvt_pk_bf16_f32 v186, v84, v85
    v_cvt_pk_bf16_f32 v187, v86, v87
    v_cvt_pk_bf16_f32 v188, v88, v89
    v_cvt_pk_bf16_f32 v189, v90, v91
    v_cvt_pk_bf16_f32 v190, v92, v93
    v_cvt_pk_bf16_f32 v191, v94, v95
    v_mov_b64 v[32:33], 0
    v_mov_b64 v[34:35], 0
    v_mov_b64 v[36:37], 0
    v_mov_b64 v[38:39], 0
    v_mov_b64 v[40:41], 0
    v_mov_b64 v[42:43], 0
    v_mov_b64 v[44:45], 0
    v_mov_b64 v[46:47], 0
    v_mov_b64 v[48:49], 0
    v_mov_b64 v[50:51], 0
    v_mov_b64 v[52:53], 0
    v_mov_b64 v[54:55], 0
    v_mov_b64 v[56:57], 0
    v_mov_b64 v[58:59], 0
    v_mov_b64 v[60:61], 0
    v_mov_b64 v[62:63], 0
    v_mov_b64 v[64:65], 0
    v_mov_b64 v[66:67], 0
    v_mov_b64 v[68:69], 0
    v_mov_b64 v[70:71], 0
    v_mov_b64 v[72:73], 0
    v_mov_b64 v[74:75], 0
    v_mov_b64 v[76:77], 0
    v_mov_b64 v[78:79], 0
    v_mov_b64 v[80:81], 0
    v_mov_b64 v[82:83], 0
    v_mov_b64 v[84:85], 0
    v_mov_b64 v[86:87], 0
    v_mov_b64 v[88:89], 0
    v_mov_b64 v[90:91], 0
    v_mov_b64 v[92:93], 0
    v_mov_b64 v[94:95], 0
    s_nop 1
    s_waitcnt lgkmcnt(9)
    v_mfma_f32_16x16x32_bf16 v[32:35], v[112:115], v[96:99], v[32:35]
    ds_read_b128 v[128:131], v2 offset:8192
    s_waitcnt lgkmcnt(9)
    v_mfma_f32_16x16x32_bf16 v[40:43], v[112:115], v[100:103], v[40:43]
    ds_read_b64_tr_b16 v[144:145], v3 offset:8192
    s_waitcnt lgkmcnt(9)
    v_mfma_f32_16x16x32_bf16 v[48:51], v[112:115], v[104:107], v[48:51]
    ds_read_b64_tr_b16 v[146:147], v3 offset:12288
    s_waitcnt lgkmcnt(9)
    v_mfma_f32_16x16x32_bf16 v[56:59], v[112:115], v[108:111], v[56:59]
    ds_read_b128 v[132:135], v2 offset:9216
    s_waitcnt lgkmcnt(8)
    v_mfma_f32_16x16x32_bf16 v[36:39], v[116:119], v[96:99], v[36:39]
    ds_read_b128 v[136:139], v2 offset:10240
    v_mfma_f32_16x16x32_bf16 v[44:47], v[116:119], v[100:103], v[44:47]
    ds_read_b128 v[140:143], v2 offset:11264
    v_mfma_f32_16x16x32_bf16 v[52:55], v[116:119], v[104:107], v[52:55]
    ds_read_b64_tr_b16 v[148:149], v4 offset:8192
    v_mfma_f32_16x16x32_bf16 v[60:63], v[116:119], v[108:111], v[60:63]
    ds_read_b64_tr_b16 v[150:151], v4 offset:12288
    s_waitcnt lgkmcnt(10)
    v_mfma_f32_16x16x32_bf16 v[64:67], v[120:123], v[96:99], v[64:67]
    s_add_u32 s43, s43, 32768
    ds_read_b64_tr_b16 v[152:153], v5 offset:8192
    v_mfma_f32_16x16x32_bf16 v[72:75], v[120:123], v[100:103], v[72:75]
    s_cmp_ge_u32 s43, 163840
    ds_read_b64_tr_b16 v[154:155], v5 offset:12288
    v_mfma_f32_16x16x32_bf16 v[80:83], v[120:123], v[104:107], v[80:83]
    s_cselect_b32 s46, 4294836224, s56
    ds_read_b64_tr_b16 v[156:157], v6 offset:8192
    v_mfma_f32_16x16x32_bf16 v[88:91], v[120:123], v[108:111], v[88:91]
    s_cselect_b32 s43, 0, s43
    ds_read_b64_tr_b16 v[158:159], v6 offset:12288
    s_waitcnt lgkmcnt(12)
    v_mfma_f32_16x16x32_bf16 v[68:71], v[124:127], v[96:99], v[68:71]
    v_add_u32 v2, s46, v2
    v_add_u32 v3, s46, v3
    v_mfma_f32_16x16x32_bf16 v[76:79], v[124:127], v[100:103], v[76:79]
    v_add_u32 v4, s46, v4
    v_add_u32 v5, s46, v5
    v_mfma_f32_16x16x32_bf16 v[84:87], v[124:127], v[104:107], v[84:87]
    v_add_u32 v6, s46, v6
    v_mfma_f32_16x16x32_bf16 v[92:95], v[124:127], v[108:111], v[92:95]
    buffer_store_dwordx4 v[160:163], v7, s[28:31], s59 offen offset:0 sc1
    s_waitcnt lgkmcnt(0)
    v_mfma_f32_16x16x32_bf16 v[32:35], v[144:147], v[128:131], v[32:35]
    s_barrier
    v_mfma_f32_16x16x32_bf16 v[40:43], v[144:147], v[132:135], v[40:43]
    ds_read_b128 v[96:99], v2 offset:0
    v_mfma_f32_16x16x32_bf16 v[48:51], v[144:147], v[136:139], v[48:51]
    ds_read_b64_tr_b16 v[112:113], v3 offset:0
    v_mfma_f32_16x16x32_bf16 v[56:59], v[144:147], v[140:143], v[56:59]
    ds_read_b64_tr_b16 v[114:115], v3 offset:4096
    v_mfma_f32_16x16x32_bf16 v[36:39], v[148:151], v[128:131], v[36:39]
    ds_read_b128 v[100:103], v2 offset:1024
    v_mfma_f32_16x16x32_bf16 v[44:47], v[148:151], v[132:135], v[44:47]
    ds_read_b128 v[104:107], v2 offset:2048
    v_mfma_f32_16x16x32_bf16 v[52:55], v[148:151], v[136:139], v[52:55]
    ds_read_b128 v[108:111], v2 offset:3072
    v_mfma_f32_16x16x32_bf16 v[60:63], v[148:151], v[140:143], v[60:63]
    ds_read_b64_tr_b16 v[116:117], v4 offset:0
    v_mfma_f32_16x16x32_bf16 v[64:67], v[152:155], v[128:131], v[64:67]
    ds_read_b64_tr_b16 v[118:119], v4 offset:4096
    v_mfma_f32_16x16x32_bf16 v[72:75], v[152:155], v[132:135], v[72:75]
    ds_read_b64_tr_b16 v[120:121], v5 offset:0
    v_mfma_f32_16x16x32_bf16 v[80:83], v[152:155], v[136:139], v[80:83]
    ds_read_b64_tr_b16 v[122:123], v5 offset:4096
    v_mfma_f32_16x16x32_bf16 v[88:91], v[152:155], v[140:143], v[88:91]
    ds_read_b64_tr_b16 v[124:125], v6 offset:0
    v_mfma_f32_16x16x32_bf16 v[68:71], v[156:159], v[128:131], v[68:71]
    ds_read_b64_tr_b16 v[126:127], v6 offset:4096
    v_mfma_f32_16x16x32_bf16 v[76:79], v[156:159], v[132:135], v[76:79]
    buffer_store_dwordx4 v[164:167], v7, s[28:31], s59 offen offset:1024 sc1
    v_mfma_f32_16x16x32_bf16 v[84:87], v[156:159], v[136:139], v[84:87]
    s_sub_u32 s47, s47, 1
    v_mfma_f32_16x16x32_bf16 v[92:95], v[156:159], v[140:143], v[92:95]
    s_waitcnt lgkmcnt(9)
    v_mfma_f32_16x16x32_bf16 v[32:35], v[112:115], v[96:99], v[32:35]
    ds_read_b128 v[128:131], v2 offset:8192
    s_waitcnt lgkmcnt(9)
    v_mfma_f32_16x16x32_bf16 v[40:43], v[112:115], v[100:103], v[40:43]
    ds_read_b64_tr_b16 v[144:145], v3 offset:8192
    s_waitcnt lgkmcnt(9)
    v_mfma_f32_16x16x32_bf16 v[48:51], v[112:115], v[104:107], v[48:51]
    ds_read_b64_tr_b16 v[146:147], v3 offset:12288
    s_waitcnt lgkmcnt(9)
    v_mfma_f32_16x16x32_bf16 v[56:59], v[112:115], v[108:111], v[56:59]
    ds_read_b128 v[132:135], v2 offset:9216
    s_waitcnt lgkmcnt(8)
    v_mfma_f32_16x16x32_bf16 v[36:39], v[116:119], v[96:99], v[36:39]
    ds_read_b128 v[136:139], v2 offset:10240
    v_mfma_f32_16x16x32_bf16 v[44:47], v[116:119], v[100:103], v[44:47]
    ds_read_b128 v[140:143], v2 offset:11264
    v_mfma_f32_16x16x32_bf16 v[52:55], v[116:119], v[104:107], v[52:55]
    ds_read_b64_tr_b16 v[148:149], v4 offset:8192
    v_mfma_f32_16x16x32_bf16 v[60:63], v[116:119], v[108:111], v[60:63]
    ds_read_b64_tr_b16 v[150:151], v4 offset:12288
    s_waitcnt lgkmcnt(10)
    v_mfma_f32_16x16x32_bf16 v[64:67], v[120:123], v[96:99], v[64:67]
    s_add_u32 s43, s43, 32768
    ds_read_b64_tr_b16 v[152:153], v5 offset:8192
    v_mfma_f32_16x16x32_bf16 v[72:75], v[120:123], v[100:103], v[72:75]
    s_cmp_ge_u32 s43, 163840
    ds_read_b64_tr_b16 v[154:155], v5 offset:12288
    v_mfma_f32_16x16x32_bf16 v[80:83], v[120:123], v[104:107], v[80:83]
    s_cselect_b32 s46, 4294836224, s56
    ds_read_b64_tr_b16 v[156:157], v6 offset:8192
    v_mfma_f32_16x16x32_bf16 v[88:91], v[120:123], v[108:111], v[88:91]
    s_cselect_b32 s43, 0, s43
    ds_read_b64_tr_b16 v[158:159], v6 offset:12288
    s_waitcnt lgkmcnt(12)
    v_mfma_f32_16x16x32_bf16 v[68:71], v[124:127], v[96:99], v[68:71]
    v_add_u32 v2, s46, v2
    v_add_u32 v3, s46, v3
    v_mfma_f32_16x16x32_bf16 v[76:79], v[124:127], v[100:103], v[76:79]
    v_add_u32 v4, s46, v4
    v_add_u32 v5, s46, v5
    v_mfma_f32_16x16x32_bf16 v[84:87], v[124:127], v[104:107], v[84:87]
    v_add_u32 v6, s46, v6
    v_mfma_f32_16x16x32_bf16 v[92:95], v[124:127], v[108:111], v[92:95]
    buffer_store_dwordx4 v[168:171], v7, s[28:31], s59 offen offset:2048 sc1
    s_waitcnt lgkmcnt(0)
    v_mfma_f32_16x16x32_bf16 v[32:35], v[144:147], v[128:131], v[32:35]
    s_barrier
    v_mfma_f32_16x16x32_bf16 v[40:43], v[144:147], v[132:135], v[40:43]
    ds_read_b128 v[96:99], v2 offset:0
    v_mfma_f32_16x16x32_bf16 v[48:51], v[144:147], v[136:139], v[48:51]
    ds_read_b64_tr_b16 v[112:113], v3 offset:0
    v_mfma_f32_16x16x32_bf16 v[56:59], v[144:147], v[140:143], v[56:59]
    ds_read_b64_tr_b16 v[114:115], v3 offset:4096
    v_mfma_f32_16x16x32_bf16 v[36:39], v[148:151], v[128:131], v[36:39]
    ds_read_b128 v[100:103], v2 offset:1024
    v_mfma_f32_16x16x32_bf16 v[44:47], v[148:151], v[132:135], v[44:47]
    ds_read_b128 v[104:107], v2 offset:2048
    v_mfma_f32_16x16x32_bf16 v[52:55], v[148:151], v[136:139], v[52:55]
    ds_read_b128 v[108:111], v2 offset:3072
    v_mfma_f32_16x16x32_bf16 v[60:63], v[148:151], v[140:143], v[60:63]
    ds_read_b64_tr_b16 v[116:117], v4 offset:0
    v_mfma_f32_16x16x32_bf16 v[64:67], v[152:155], v[128:131], v[64:67]
    ds_read_b64_tr_b16 v[118:119], v4 offset:4096
    v_mfma_f32_16x16x32_bf16 v[72:75], v[152:155], v[132:135], v[72:75]
    ds_read_b64_tr_b16 v[120:121], v5 offset:0
    v_mfma_f32_16x16x32_bf16 v[80:83], v[152:155], v[136:139], v[80:83]
    ds_read_b64_tr_b16 v[122:123], v5 offset:4096
    v_mfma_f32_16x16x32_bf16 v[88:91], v[152:155], v[140:143], v[88:91]
    ds_read_b64_tr_b16 v[124:125], v6 offset:0
    v_mfma_f32_16x16x32_bf16 v[68:71], v[156:159], v[128:131], v[68:71]
    ds_read_b64_tr_b16 v[126:127], v6 offset:4096
    v_mfma_f32_16x16x32_bf16 v[76:79], v[156:159], v[132:135], v[76:79]
    buffer_store_dwordx4 v[172:175], v7, s[28:31], s59 offen offset:3072 sc1
    s_add_u32 s59, s59, 4096
    v_mfma_f32_16x16x32_bf16 v[84:87], v[156:159], v[136:139], v[84:87]
    s_sub_u32 s47, s47, 1
    v_mfma_f32_16x16x32_bf16 v[92:95], v[156:159], v[140:143], v[92:95]
    s_waitcnt lgkmcnt(9)
    v_mfma_f32_16x16x32_bf16 v[32:35], v[112:115], v[96:99], v[32:35]
    ds_read_b128 v[128:131], v2 offset:8192
    s_waitcnt lgkmcnt(9)
    v_mfma_f32_16x16x32_bf16 v[40:43], v[112:115], v[100:103], v[40:43]
    ds_read_b64_tr_b16 v[144:145], v3 offset:8192
    s_waitcnt lgkmcnt(9)
    v_mfma_f32_16x16x32_bf16 v[48:51], v[112:115], v[104:107], v[48:51]
    ds_read_b64_tr_b16 v[146:147], v3 offset:12288
    s_waitcnt lgkmcnt(9)
    v_mfma_f32_16x16x32_bf16 v[56:59], v[112:115], v[108:111], v[56:59]
    ds_read_b128 v[132:135], v2 offset:9216
    s_waitcnt lgkmcnt(8)
    v_mfma_f32_16x16x32_bf16 v[36:39], v[116:119], v[96:99], v[36:39]
    ds_read_b128 v[136:139], v2 offset:10240
    v_mfma_f32_16x16x32_bf16 v[44:47], v[116:119], v[100:103], v[44:47]
    ds_read_b128 v[140:143], v2 offset:11264
    v_mfma_f32_16x16x32_bf16 v[52:55], v[116:119], v[104:107], v[52:55]
    ds_read_b64_tr_b16 v[148:149], v4 offset:8192
    v_mfma_f32_16x16x32_bf16 v[60:63], v[116:119], v[108:111], v[60:63]
    ds_read_b64_tr_b16 v[150:151], v4 offset:12288
    s_waitcnt lgkmcnt(10)
    v_mfma_f32_16x16x32_bf16 v[64:67], v[120:123], v[96:99], v[64:67]
    s_add_u32 s43, s43, 32768
    ds_read_b64_tr_b16 v[152:153], v5 offset:8192
    v_mfma_f32_16x16x32_bf16 v[72:75], v[120:123], v[100:103], v[72:75]
    s_cmp_ge_u32 s43, 163840
    ds_read_b64_tr_b16 v[154:155], v5 offset:12288
    v_mfma_f32_16x16x32_bf16 v[80:83], v[120:123], v[104:107], v[80:83]
    s_cselect_b32 s46, 4294836224, s56
    ds_read_b64_tr_b16 v[156:157], v6 offset:8192
    v_mfma_f32_16x16x32_bf16 v[88:91], v[120:123], v[108:111], v[88:91]
    s_cselect_b32 s43, 0, s43
    ds_read_b64_tr_b16 v[158:159], v6 offset:12288
    s_waitcnt lgkmcnt(12)
    v_mfma_f32_16x16x32_bf16 v[68:71], v[124:127], v[96:99], v[68:71]
    v_add_u32 v2, s46, v2
    v_add_u32 v3, s46, v3
    v_mfma_f32_16x16x32_bf16 v[76:79], v[124:127], v[100:103], v[76:79]
    v_add_u32 v4, s46, v4
    v_add_u32 v5, s46, v5
    v_mfma_f32_16x16x32_bf16 v[84:87], v[124:127], v[104:107], v[84:87]
    v_add_u32 v6, s46, v6
    v_mfma_f32_16x16x32_bf16 v[92:95], v[124:127], v[108:111], v[92:95]
    buffer_store_dwordx4 v[176:179], v7, s[28:31], s59 offen offset:0 sc1
    s_waitcnt lgkmcnt(0)
    v_mfma_f32_16x16x32_bf16 v[32:35], v[144:147], v[128:131], v[32:35]
    s_barrier
    v_mfma_f32_16x16x32_bf16 v[40:43], v[144:147], v[132:135], v[40:43]
    ds_read_b128 v[96:99], v2 offset:0
    v_mfma_f32_16x16x32_bf16 v[48:51], v[144:147], v[136:139], v[48:51]
    ds_read_b64_tr_b16 v[112:113], v3 offset:0
    v_mfma_f32_16x16x32_bf16 v[56:59], v[144:147], v[140:143], v[56:59]
    ds_read_b64_tr_b16 v[114:115], v3 offset:4096
    v_mfma_f32_16x16x32_bf16 v[36:39], v[148:151], v[128:131], v[36:39]
    ds_read_b128 v[100:103], v2 offset:1024
    v_mfma_f32_16x16x32_bf16 v[44:47], v[148:151], v[132:135], v[44:47]
    ds_read_b128 v[104:107], v2 offset:2048
    v_mfma_f32_16x16x32_bf16 v[52:55], v[148:151], v[136:139], v[52:55]
    ds_read_b128 v[108:111], v2 offset:3072
    v_mfma_f32_16x16x32_bf16 v[60:63], v[148:151], v[140:143], v[60:63]
    ds_read_b64_tr_b16 v[116:117], v4 offset:0
    v_mfma_f32_16x16x32_bf16 v[64:67], v[152:155], v[128:131], v[64:67]
    ds_read_b64_tr_b16 v[118:119], v4 offset:4096
    v_mfma_f32_16x16x32_bf16 v[72:75], v[152:155], v[132:135], v[72:75]
    ds_read_b64_tr_b16 v[120:121], v5 offset:0
    v_mfma_f32_16x16x32_bf16 v[80:83], v[152:155], v[136:139], v[80:83]
    ds_read_b64_tr_b16 v[122:123], v5 offset:4096
    v_mfma_f32_16x16x32_bf16 v[88:91], v[152:155], v[140:143], v[88:91]
    ds_read_b64_tr_b16 v[124:125], v6 offset:0
    v_mfma_f32_16x16x32_bf16 v[68:71], v[156:159], v[128:131], v[68:71]
    ds_read_b64_tr_b16 v[126:127], v6 offset:4096
    v_mfma_f32_16x16x32_bf16 v[76:79], v[156:159], v[132:135], v[76:79]
    buffer_store_dwordx4 v[180:183], v7, s[28:31], s59 offen offset:1024 sc1
    v_mfma_f32_16x16x32_bf16 v[84:87], v[156:159], v[136:139], v[84:87]
    s_sub_u32 s47, s47, 1
    v_mfma_f32_16x16x32_bf16 v[92:95], v[156:159], v[140:143], v[92:95]
    s_waitcnt lgkmcnt(9)
    v_mfma_f32_16x16x32_bf16 v[32:35], v[112:115], v[96:99], v[32:35]
    ds_read_b128 v[128:131], v2 offset:8192
    s_waitcnt lgkmcnt(9)
    v_mfma_f32_16x16x32_bf16 v[40:43], v[112:115], v[100:103], v[40:43]
    ds_read_b64_tr_b16 v[144:145], v3 offset:8192
    s_waitcnt lgkmcnt(9)
    v_mfma_f32_16x16x32_bf16 v[48:51], v[112:115], v[104:107], v[48:51]
    ds_read_b64_tr_b16 v[146:147], v3 offset:12288
    s_waitcnt lgkmcnt(9)
    v_mfma_f32_16x16x32_bf16 v[56:59], v[112:115], v[108:111], v[56:59]
    ds_read_b128 v[132:135], v2 offset:9216
    s_waitcnt lgkmcnt(8)
    v_mfma_f32_16x16x32_bf16 v[36:39], v[116:119], v[96:99], v[36:39]
    ds_read_b128 v[136:139], v2 offset:10240
    v_mfma_f32_16x16x32_bf16 v[44:47], v[116:119], v[100:103], v[44:47]
    ds_read_b128 v[140:143], v2 offset:11264
    v_mfma_f32_16x16x32_bf16 v[52:55], v[116:119], v[104:107], v[52:55]
    ds_read_b64_tr_b16 v[148:149], v4 offset:8192
    v_mfma_f32_16x16x32_bf16 v[60:63], v[116:119], v[108:111], v[60:63]
    ds_read_b64_tr_b16 v[150:151], v4 offset:12288
    s_waitcnt lgkmcnt(10)
    v_mfma_f32_16x16x32_bf16 v[64:67], v[120:123], v[96:99], v[64:67]
    s_add_u32 s43, s43, 32768
    ds_read_b64_tr_b16 v[152:153], v5 offset:8192
    v_mfma_f32_16x16x32_bf16 v[72:75], v[120:123], v[100:103], v[72:75]
    s_cmp_ge_u32 s43, 163840
    ds_read_b64_tr_b16 v[154:155], v5 offset:12288
    v_mfma_f32_16x16x32_bf16 v[80:83], v[120:123], v[104:107], v[80:83]
    s_cselect_b32 s46, 4294836224, s56
    ds_read_b64_tr_b16 v[156:157], v6 offset:8192
    v_mfma_f32_16x16x32_bf16 v[88:91], v[120:123], v[108:111], v[88:91]
    s_cselect_b32 s43, 0, s43
    ds_read_b64_tr_b16 v[158:159], v6 offset:12288
    s_waitcnt lgkmcnt(12)
    v_mfma_f32_16x16x32_bf16 v[68:71], v[124:127], v[96:99], v[68:71]
    v_add_u32 v2, s46, v2
    v_add_u32 v3, s46, v3
    v_mfma_f32_16x16x32_bf16 v[76:79], v[124:127], v[100:103], v[76:79]
    v_add_u32 v4, s46, v4
    v_add_u32 v5, s46, v5
    v_mfma_f32_16x16x32_bf16 v[84:87], v[124:127], v[104:107], v[84:87]
    v_add_u32 v6, s46, v6
    v_mfma_f32_16x16x32_bf16 v[92:95], v[124:127], v[108:111], v[92:95]
    buffer_store_dwordx4 v[184:187], v7, s[28:31], s59 offen offset:2048 sc1
    s_waitcnt lgkmcnt(0)
    v_mfma_f32_16x16x32_bf16 v[32:35], v[144:147], v[128:131], v[32:35]
    s_barrier
    v_mfma_f32_16x16x32_bf16 v[40:43], v[144:147], v[132:135], v[40:43]
    ds_read_b128 v[96:99], v2 offset:0
    v_mfma_f32_16x16x32_bf16 v[48:51], v[144:147], v[136:139], v[48:51]
    ds_read_b64_tr_b16 v[112:113], v3 offset:0
    v_mfma_f32_16x16x32_bf16 v[56:59], v[144:147], v[140:143], v[56:59]
    ds_read_b64_tr_b16 v[114:115], v3 offset:4096
    v_mfma_f32_16x16x32_bf16 v[36:39], v[148:151], v[128:131], v[36:39]
    ds_read_b128 v[100:103], v2 offset:1024
    v_mfma_f32_16x16x32_bf16 v[44:47], v[148:151], v[132:135], v[44:47]
    ds_read_b128 v[104:107], v2 offset:2048
    v_mfma_f32_16x16x32_bf16 v[52:55], v[148:151], v[136:139], v[52:55]
    ds_read_b128 v[108:111], v2 offset:3072
    v_mfma_f32_16x16x32_bf16 v[60:63], v[148:151], v[140:143], v[60:63]
    ds_read_b64_tr_b16 v[116:117], v4 offset:0
    v_mfma_f32_16x16x32_bf16 v[64:67], v[152:155], v[128:131], v[64:67]
    ds_read_b64_tr_b16 v[118:119], v4 offset:4096
    v_mfma_f32_16x16x32_bf16 v[72:75], v[152:155], v[132:135], v[72:75]
    ds_read_b64_tr_b16 v[120:121], v5 offset:0
    v_mfma_f32_16x16x32_bf16 v[80:83], v[152:155], v[136:139], v[80:83]
    ds_read_b64_tr_b16 v[122:123], v5 offset:4096
    v_mfma_f32_16x16x32_bf16 v[88:91], v[152:155], v[140:143], v[88:91]
    ds_read_b64_tr_b16 v[124:125], v6 offset:0
    v_mfma_f32_16x16x32_bf16 v[68:71], v[156:159], v[128:131], v[68:71]
    ds_read_b64_tr_b16 v[126:127], v6 offset:4096
    v_mfma_f32_16x16x32_bf16 v[76:79], v[156:159], v[132:135], v[76:79]
    buffer_store_dwordx4 v[188:191], v7, s[28:31], s59 offen offset:3072 sc1
    s_add_u32 s59, s59, 4096
    v_mfma_f32_16x16x32_bf16 v[84:87], v[156:159], v[136:139], v[84:87]
    s_sub_u32 s47, s47, 1
    v_mfma_f32_16x16x32_bf16 v[92:95], v[156:159], v[140:143], v[92:95]
    s_mov_b32 s57, 0
    s_mov_b32 s58, 1
    s_branch gemm3_kernel_back5
gemm3_kernel_n12:
    s_cmp_lg_u32 s58, 1
    s_cbranch_scc1 gemm3_kernel_n13
    s_waitcnt vmcnt(0)
    s_mov_b32 s57, 0
    s_mov_b32 s58, 2
    s_branch gemm3_kernel_back5
gemm3_kernel_n13:
    s_cmp_lg_u32 s58, 2
    s_cbranch_scc1 gemm3_kernel_n14
    s_cmp_lg_u32 s32, 0
    s_cbranch_scc1 gemm3_kernel_np15
    s_lshl_b32 s48, s39, 7
    s_add_u32 s48, s48, 117506048
    v_mov_b32 v16, 1
    s_mov_b64 exec, 1
    buffer_store_dword v16, off, s[28:31], s48 sc1
    s_mov_b64 exec, -1
gemm3_kernel_np15:
    s_mov_b32 s57, 1000
    s_mov_b32 s58, 3
    s_branch gemm3_kernel_back5
gemm3_kernel_n14:
    s_mov_b32 s57, 1000
    s_branch gemm3_kernel_back5
gemm3_kernel_load2:
    s_lshl_b32 s45, s32, 12
    s_lshl_b32 s48, s37, 13
    s_lshl_b32 s49, s34, 12
    s_add_u32 s48, s48, s49
    s_lshl_b32 s49, s33, 17
    s_add_u32 s40, s48, s49
    s_mul_i32 s48, s35, 10747904
    s_add_u32 s41, s40, s48
    s_add_u32 s41, s41, 67108864
    s_add_u32 s40, s40, 83886080
    s_mul_i32 s48, s35, 5373952
    s_lshl_b32 s46, s38, 8
    s_add_u32 s42, s46, s48
    v_lshrrev_b32 v16, 4, v1
    s_lshl_b32 s48, s32, 4
    v_add_u32 v17, s48, v16
    v_lshlrev_b32 v17, 11, v17
    v_lshlrev_b32 v16, 1, v16
    v_and_b32 v18, 15, v1
    v_xor_b32 v16, v16, v18
    v_xor_b32 v18, 0, v16
    v_lshl_add_u32 v8, v18, 4, v17
    v_xor_b32 v18, 8, v16
    v_lshl_add_u32 v9, v18, 4, v17
    v_add_u32 v9, 7168, v9
    v_xor_b32 v18, 0, v16
    v_lshl_add_u32 v10, v18, 4, v17
    v_add_u32 v10, 14336, v10
    v_xor_b32 v18, 8, v16
    v_lshl_add_u32 v11, v18, 4, v17
    v_add_u32 v11, 21504, v11
    s_mov_b32 s18, 268435456
    s_mov_b32 s19, 0x20000
    s_mov_b32 s23, 0x20000
    s_mov_b32 s22, 8388608
    s_mov_b32 s44, s45
    s_cmp_eq_u32 s35, 1
    s_cselect_b32 s57, 23, 1000
    s_cselect_b32 s58, 39, 41
    s_add_u32 s56, s45, 163840
    s_waitcnt lgkmcnt(0)
    s_mov_b32 s20, s4
    s_mov_b32 s21, s5
    s_mov_b32 s16, s10
    s_mov_b32 s17, s11
    s_mov_b32 m0, s44
    s_nop 0
    buffer_load_dwordx4 v7, s[16:19], s41 offen offset:0 lds
    buffer_load_dwordx4 v7, s[16:19], s41 offen offset:1024 lds
    buffer_load_dwordx4 v7, s[16:19], s41 offen offset:2048 lds
    buffer_load_dwordx4 v7, s[16:19], s41 offen offset:3072 lds
    s_add_u32 m0, s44, 16384
    s_add_u32 s41, s41, 262144
    buffer_load_dwordx4 v8, s[20:23], s42 offen offset:0 lds
    buffer_load_dwordx4 v9, s[20:23], s42 offen offset:1024 lds
    buffer_load_dwordx4 v10, s[20:23], s42 offen offset:2048 lds
    buffer_load_dwordx4 v11, s[20:23], s42 offen offset:3072 lds
    s_add_u32 s42, s42, 131072
    s_add_u32 s44, s44, 32768
    s_cmp_ge_u32 s44, s56
    s_cselect_b32 s44, s45, s44
    s_mov_b32 m0, s44
    s_nop 0
    buffer_load_dwordx4 v7, s[16:19], s41 offen offset:0 lds
    buffer_load_dwordx4 v7, s[16:19], s41 offen offset:1024 lds
    buffer_load_dwordx4 v7, s[16:19], s41 offen offset:2048 lds
    buffer_load_dwordx4 v7, s[16:19], s41 offen offset:3072 lds
    s_add_u32 m0, s44, 16384
    s_add_u32 s41, s41, 262144
    buffer_load_dwordx4 v8, s[20:23], s42 offen offset:0 lds
    buffer_load_dwordx4 v9, s[20:23], s42 offen offset:1024 lds
    buffer_load_dwordx4 v10, s[20:23], s42 offen offset:2048 lds
    buffer_load_dwordx4 v11, s[20:23], s42 offen offset:3072 lds
    s_add_u32 s42, s42, 131072
    s_add_u32 s44, s44, 32768
    s_cmp_ge_u32 s44, s56
    s_cselect_b32 s44, s45, s44
    s_waitcnt vmcnt(8)
    s_barrier
    s_mov_b32 m0, s44
    s_nop 0
    buffer_load_dwordx4 v7, s[16:19], s41 offen offset:0 lds
    buffer_load_dwordx4 v7, s[16:19], s41 offen offset:1024 lds
    buffer_load_dwordx4 v7, s[16:19], s41 offen offset:2048 lds
    buffer_load_dwordx4 v7, s[16:19], s41 offen offset:3072 lds
    s_add_u32 m0, s44, 16384
    s_add_u32 s41, s41, 262144
    buffer_load_dwordx4 v8, s[20:23], s42 offen offset:0 lds
    buffer_load_dwordx4 v9, s[20:23], s42 offen offset:1024 lds
    buffer_load_dwordx4 v10, s[20:23], s42 offen offset:2048 lds
    buffer_load_dwordx4 v11, s[20:23], s42 offen offset:3072 lds
    s_add_u32 s42, s42, 131072
    s_add_u32 s44, s44, 32768
    s_cmp_ge_u32 s44, s56
    s_cselect_b32 s44, s45, s44
    s_mov_b32 m0, s44
    s_nop 0
    buffer_load_dwordx4 v7, s[16:19], s41 offen offset:0 lds
    buffer_load_dwordx4 v7, s[16:19], s41 offen offset:1024 lds
    buffer_load_dwordx4 v7, s[16:19], s41 offen offset:2048 lds
    buffer_load_dwordx4 v7, s[16:19], s41 offen offset:3072 lds
    s_add_u32 m0, s44, 16384
    s_add_u32 s41, s41, 262144
    buffer_load_dwordx4 v8, s[20:23], s42 offen offset:0 lds
    buffer_load_dwordx4 v9, s[20:23], s42 offen offset:1024 lds
    buffer_load_dwordx4 v10, s[20:23], s42 offen offset:2048 lds
    buffer_load_dwordx4 v11, s[20:23], s42 offen offset:3072 lds
    s_add_u32 s42, s42, 131072
    s_add_u32 s44, s44, 32768
    s_cmp_ge_u32 s44, s56
    s_cselect_b32 s44, s45, s44
    s_mov_b32 m0, s44
    s_nop 0
    buffer_load_dwordx4 v7, s[16:19], s41 offen offset:0 lds
    buffer_load_dwordx4 v7, s[16:19], s41 offen offset:1024 lds
    buffer_load_dwordx4 v7, s[16:19], s41 offen offset:2048 lds
    buffer_load_dwordx4 v7, s[16:19], s41 offen offset:3072 lds
    s_add_u32 m0, s44, 16384
    s_add_u32 s41, s41, 262144
    buffer_load_dwordx4 v8, s[20:23], s42 offen offset:0 lds
    buffer_load_dwordx4 v9, s[20:23], s42 offen offset:1024 lds
    buffer_load_dwordx4 v10, s[20:23], s42 offen offset:2048 lds
    buffer_load_dwordx4 v11, s[20:23], s42 offen offset:3072 lds
    s_add_u32 s42, s42, 131072
    s_add_u32 s44, s44, 32768
    s_cmp_ge_u32 s44, s56
    s_cselect_b32 s44, s45, s44
    s_mov_b32 s47, 5
gemm3_kernel_ll16:
    s_waitcnt vmcnt(24)
    s_barrier
    s_cmp_eq_u32 s47, s57
    s_cselect_b32 s41, s40, s41
    s_cselect_b32 s42, s46, s42
    s_cselect_b32 s20, s12, s20
    s_cselect_b32 s21, s13, s21
    s_cselect_b32 s22, 2097152, s22
    s_mov_b32 m0, s44
    s_nop 0
    buffer_load_dwordx4 v7, s[16:19], s41 offen offset:0 lds
    buffer_load_dwordx4 v7, s[16:19], s41 offen offset:1024 lds
    buffer_load_dwordx4 v7, s[16:19], s41 offen offset:2048 lds
    buffer_load_dwordx4 v7, s[16:19], s41 offen offset:3072 lds
    s_add_u32 m0, s44, 16384
    s_add_u32 s41, s41, 262144
    buffer_load_dwordx4 v8, s[20:23], s42 offen offset:0 lds
    buffer_load_dwordx4 v9, s[20:23], s42 offen offset:1024 lds
    buffer_load_dwordx4 v10, s[20:23], s42 offen offset:2048 lds
    buffer_load_dwordx4 v11, s[20:23], s42 offen offset:3072 lds
    s_add_u32 s42, s42, 131072
    s_add_u32 s44, s44, 32768
    s_cmp_ge_u32 s44, s56
    s_cselect_b32 s44, s45, s44
    s_add_u32 s47, s47, 1
    s_cmp_lt_u32 s47, s58
    s_cbranch_scc1 gemm3_kernel_ll16
    s_waitcnt vmcnt(24)
    s_barrier
    s_waitcnt vmcnt(16)
    s_barrier
    s_waitcnt vmcnt(8)
    s_barrier
    s_waitcnt vmcnt(0)
    s_barrier
    s_endpgm
gemm3_kernel_end:
.section .rodata,"a"
.p2align 6
.amdhsa_kernel mega_kernel
  .amdhsa_next_free_vgpr 512
  .amdhsa_next_free_sgpr 102
  .amdhsa_accum_offset 256
  .amdhsa_group_segment_fixed_size 0
  .amdhsa_kernarg_size 96
  .amdhsa_user_sgpr_count 2
  .amdhsa_user_sgpr_kernarg_segment_ptr 1
  .amdhsa_system_sgpr_workgroup_id_x 1
.end_amdhsa_kernel
.section .rodata,"a"
.p2align 6
.amdhsa_kernel gemm3_kernel
  .amdhsa_next_free_vgpr 224
  .amdhsa_next_free_sgpr 102
  .amdhsa_accum_offset 224
  .amdhsa_group_segment_fixed_size 0
  .amdhsa_kernarg_size 96
  .amdhsa_user_sgpr_count 2
  .amdhsa_user_sgpr_kernarg_segment_ptr 1
  .amdhsa_system_sgpr_workgroup_id_x 1
.end_amdhsa_kernel
```

```asm
; @launch kernel=mega_kernel grid=(256,1,1) block=(256,1,1) lds=163840
; @launch kernel=gemm3_kernel grid=(256,1,1) block=(512,1,1) lds=163840
.amdgcn_target "amdgcn-amd-amdhsa--gfx950"
.text
.globl mega_kernel
.p2align 8
.type mega_kernel,@function
mega_kernel:
    s_cmp_ge_u32 s2, 256
    s_cbranch_scc1 mega_kernel_end1
    s_load_dwordx16 s[24:39], s[0:1], 0
    s_load_dwordx4 s[4:7], s[0:1], 80
    v_and_b32 v1, 63, v0
    v_lshrrev_b32 v24, 6, v0
    s_nop 0
    v_readfirstlane_b32 s16, v24
    s_lshr_b32 s68, s2, 3
    s_lshr_b32 s57, s16, 1
    s_and_b32 s58, s16, 1
    s_mov_b32 s43, 0x20000
    s_mov_b32 s47, 0x20000
    s_cmp_lt_u32 s68, 29
    s_cbranch_scc1 mega_kernel_ncp2
    s_sub_u32 s91, s68, 29
    s_lshl_b32 s91, s91, 2
    s_add_u32 s91, s91, s16
    s_getpc_b64 s[8:9]
mega_kernel_pc3:
    s_sub_u32 s8, s8, mega_kernel_pc3-mega_kernel
    s_subb_u32 s9, s9, 0
    s_mov_b32 s10, gemm3_kernel_end-mega_kernel
    s_mov_b32 s11, 0x20000
    s_lshl_b32 s90, s91, 13
    v_lshlrev_b32 v24, 7, v1
    buffer_load_dword v22, v24, s[8:11], s90 offen
mega_kernel_ncp2:
    v_and_b32 v24, 15, v1
    v_lshrrev_b32 v25, 4, v1
    v_bfe_u32 v26, v1, 1, 3
    v_xor_b32 v26, v26, v25
    s_lshl_b32 s90, s57, 14
    v_lshlrev_b32 v27, 7, v24
    v_add_u32 v27, s90, v27
    v_xor_b32 v28, 0, v26
    v_lshl_add_u32 v6, v28, 4, v27
    v_xor_b32 v28, 4, v26
    v_lshl_add_u32 v7, v28, 4, v27
    v_bfe_u32 v26, v1, 2, 2
    v_lshl_add_u32 v27, v25, 3, v26
    v_lshlrev_b32 v27, 9, v27
    v_and_b32 v28, 3, v1
    v_lshlrev_b32 v28, 3, v28
    v_add_u32 v27, v27, v28
    s_lshl_b32 s90, s58, 8
    s_add_u32 s90, s90, 98304
    v_add_u32 v27, s90, v27
    v_bfe_u32 v26, v1, 2, 3
    v_xor_b32 v28, 0, v26
    v_lshl_add_u32 v8, v28, 5, v27
    v_xor_b32 v28, 1, v26
    v_lshl_add_u32 v9, v28, 5, v27
    v_xor_b32 v28, 2, v26
    v_lshl_add_u32 v10, v28, 5, v27
    v_xor_b32 v28, 3, v26
    v_lshl_add_u32 v11, v28, 5, v27
    v_xor_b32 v28, 4, v26
    v_lshl_add_u32 v12, v28, 5, v27
    v_xor_b32 v28, 5, v26
    v_lshl_add_u32 v13, v28, 5, v27
    v_xor_b32 v28, 6, v26
    v_lshl_add_u32 v14, v28, 5, v27
    v_xor_b32 v28, 7, v26
    v_lshl_add_u32 v15, v28, 5, v27
    v_lshlrev_b32 v2, 4, v1
    s_lshl_b32 s61, s16, 13
    s_add_u32 s62, s61, 98304
    s_mov_b32 s64, 0
    s_mov_b32 s59, 32768
    s_mov_b32 s60, 229376
    s_waitcnt lgkmcnt(0)
    s_mov_b32 s8, s6
    s_mov_b32 s9, s7
    s_mov_b32 s10, 268435456
    s_mov_b32 s11, 0x20000
    s_mov_b32 s70, 0
    s_cmp_ge_u32 s68, 16
    s_cbranch_scc1 mega_kernel_typea4
    s_and_b32 s69, s68, 3
    s_and_b32 s90, s2, 1
    s_lshl_b32 s90, s90, 2
    s_add_u32 s69, s69, s90
    s_bfe_u32 s90, s2, 0x20001
    s_mul_i32 s90, s90, 4
    s_bfe_u32 s91, s68, 0x20002
    s_add_u32 s90, s90, s91
    s_mov_b32 s76, 8388608
    s_mov_b32 s78, 8192
    s_mov_b32 s81, 0
    s_mov_b32 s73, 4194304
    s_mov_b32 s77, 2048
    s_mov_b32 s82, 16
    s_lshl_b32 s80, s90, 9
    s_lshl_b32 s79, s69, 19
    s_lshl_b32 s88, s90, 4
    s_add_u32 s88, s88, s69
    s_lshl_b32 s88, s88, 3
    s_mov_b32 s83, 0
    s_mov_b32 s84, 1040356334
    s_lshl_b32 s91, s90, 1
    s_add_u32 s91, s91, s58
    s_lshl_b32 s91, s91, 19
    s_lshl_b32 s92, s69, 1
    s_add_u32 s92, s92, s57
    s_lshl_b32 s92, s92, 15
    s_add_u32 s85, s91, s92
    s_add_u32 s85, s85, 0
    s_mov_b32 s86, 1024
    s_mov_b32 s87, 4096
    s_mov_b32 s71, s30
    s_mov_b32 s72, s31
    s_mov_b32 s74, s34
    s_mov_b32 s75, s35
    s_branch mega_kernel_go15
mega_kernel_typea4:
    s_cmp_lt_u32 s68, 28
    s_cbranch_scc1 mega_kernel_nopf6
    s_mov_b32 s70, 1
    s_sub_u32 s93, s2, 224
    s_lshl_b32 s93, s93, 2
    s_add_u32 s93, s93, s16
    v_lshlrev_b32 v24, 7, v1
    v_lshrrev_b32 v25, 3, v1
    v_lshlrev_b32 v25, 11, v25
    v_and_b32 v26, 7, v1
    v_lshl_add_u32 v25, v26, 7, v25
    s_lshl_b32 s92, s93, 13
    s_lshl_b32 s93, s93, 14
    s_add_u32 s93, s93, 1024
    s_mov_b32 s40, s26
    s_mov_b32 s41, s27
    s_mov_b32 s42, 6291456
    s_add_u32 s90, s92, 0
    buffer_load_dword v22, v24, s[40:43], s90 offen
    s_add_u32 s90, s92, 1048576
    buffer_load_dword v22, v24, s[40:43], s90 offen
    s_mov_b32 s40, s24
    s_mov_b32 s41, s25
    s_mov_b32 s42, 4194304
    s_add_u32 s90, s92, 0
    buffer_load_dword v22, v24, s[40:43], s90 offen
    s_add_u32 s90, s92, 1048576
    buffer_load_dword v22, v24, s[40:43], s90 offen
    s_add_u32 s90, s92, 2097152
    buffer_load_dword v22, v24, s[40:43], s90 offen
    s_add_u32 s90, s92, 3145728
    buffer_load_dword v22, v24, s[40:43], s90 offen
    s_mov_b32 s40, s34
    s_mov_b32 s41, s35
    s_mov_b32 s42, 8388608
    s_add_u32 s90, s92, 4194304
    buffer_load_dword v22, v24, s[40:43], s90 offen
    s_add_u32 s90, s92, 5242880
    buffer_load_dword v22, v24, s[40:43], s90 offen
    s_mov_b32 s40, s30
    s_mov_b32 s41, s31
    s_mov_b32 s42, 4194304
    s_add_u32 s90, s93, 0
    buffer_load_dword v22, v25, s[40:43], s90 offen
    s_add_u32 s90, s93, 2097152
    buffer_load_dword v22, v25, s[40:43], s90 offen
    s_mov_b32 s40, s26
    s_mov_b32 s41, s27
    s_mov_b32 s42, 6291456
    s_add_u32 s90, s92, 2097152
    buffer_load_dword v22, v24, s[40:43], s90 offen
    s_mov_b32 s40, s34
    s_mov_b32 s41, s35
    s_mov_b32 s42, 8388608
    s_add_u32 s90, s92, 6291456
    buffer_load_dword v22, v24, s[40:43], s90 offen
    s_add_u32 s90, s92, 7340032
    buffer_load_dword v22, v24, s[40:43], s90 offen
    s_mov_b32 s40, s26
    s_mov_b32 s41, s27
    s_mov_b32 s42, 6291456
    s_add_u32 s90, s92, 3145728
    buffer_load_dword v22, v24, s[40:43], s90 offen
    s_add_u32 s90, s92, 4194304
    buffer_load_dword v22, v24, s[40:43], s90 offen
    s_add_u32 s90, s92, 5242880
    buffer_load_dword v22, v24, s[40:43], s90 offen
    s_mov_b32 s40, s32
    s_mov_b32 s41, s33
    s_mov_b32 s42, 2097152
    s_add_u32 s90, s92, 1048576
    buffer_load_dword v22, v24, s[40:43], s90 offen
mega_kernel_nopf6:
    s_bfe_u32 s69, s68, 0x20002
    s_add_u32 s69, s69, 0
    s_and_b32 s90, s2, 7
    s_lshl_b32 s90, s90, 2
    s_and_b32 s91, s68, 3
    s_add_u32 s90, s90, s91
    s_cmp_lt_u32 s90, 16
    s_cselect_b32 s83, 0, 1
    s_mov_b32 s91, 33554432
    s_cselect_b32 s85, 16777216, s91
    s_mov_b32 s91, 8192
    s_cselect_b32 s86, 1024, s91
    s_mov_b32 s91, 1024
    s_cselect_b32 s87, 4096, s91
    s_cselect_b32 s74, s36, s38
    s_cselect_b32 s75, s37, s39
    s_mov_b32 s71, s32
    s_mov_b32 s72, s33
    s_mov_b32 s73, 2097152
    s_mov_b32 s77, 1024
    s_mov_b32 s82, 8
    s_mov_b32 s81, 0
    s_mov_b32 s76, 4194304
    s_mov_b32 s78, 8192
    s_mov_b32 s84, 0
    s_and_b32 s90, s90, 15
    s_lshl_b32 s80, s90, 9
    s_lshl_b32 s79, s69, 18
    s_lshl_b32 s91, s83, 2
    s_add_u32 s91, s91, s69
    s_cmp_ge_u32 s69, 4
    s_cselect_b32 s92, 508, 8
    s_add_u32 s91, s91, s92
    s_lshl_b32 s88, s90, 4
    s_add_u32 s88, s88, s91
    s_lshl_b32 s88, s88, 3
    s_lshl_b32 s91, s90, 1
    s_add_u32 s91, s91, s58
    s_lshl_b32 s91, s91, 19
    s_lshl_b32 s92, s69, 1
    s_add_u32 s92, s92, s57
    s_lshl_b32 s92, s92, 15
    s_add_u32 s85, s85, s91
    s_add_u32 s85, s85, s92
mega_kernel_go15:
    s_mov_b32 s42, s73
    s_mov_b32 s46, s76
    s_lshl_b32 s90, s77, 4
    s_lshl_b32 s90, s90, s81
    s_mov_b32 s48, s79
    s_mul_i32 s91, s90, 1
    s_add_u32 s49, s91, s79
    s_sub_u32 s49, s49, 2048
    s_mul_i32 s91, s90, 2
    s_add_u32 s50, s91, s79
    s_mul_i32 s91, s90, 3
    s_add_u32 s51, s91, s79
    s_sub_u32 s51, s51, 2048
    s_mov_b32 s52, s80
    s_lshl_b32 s90, s78, 2
    s_mul_i32 s91, s90, 1
    s_add_u32 s53, s91, s80
    s_sub_u32 s53, s53, 2048
    s_mul_i32 s91, s90, 2
    s_add_u32 s54, s91, s80
    s_mul_i32 s91, s90, 3
    s_add_u32 s55, s91, s80
    s_sub_u32 s55, s55, 2048
    s_lshl_b32 s56, s78, 6
    s_lshl_b32 s90, s58, 7
    s_add_u32 s90, s90, s57
    s_lshl_b32 s91, s16, 6
    s_cmp_eq_u32 s81, 1
    s_cselect_b32 s90, s90, s91
    v_lshrrev_b32 v24, 3, v1
    v_lshlrev_b32 v24, s81, v24
    v_add_u32 v24, s90, v24
    v_mul_lo_u32 v24, v24, s77
    v_lshrrev_b32 v25, 4, v1
    v_and_b32 v26, 7, v1
    v_xor_b32 v25, v25, v26
    v_lshl_add_u32 v16, v25, 4, v24
    v_xor_b32 v25, 4, v25
    v_lshl_add_u32 v17, v25, 4, v24
    s_lshl_b32 s90, s77, 3
    s_lshl_b32 s90, s90, s81
    s_sub_u32 s90, s90, 1024
    v_add_u32 v17, s90, v17
    v_lshrrev_b32 v24, 5, v1
    s_lshl_b32 s90, s16, 4
    v_add_u32 v25, s90, v24
    v_mul_lo_u32 v25, v25, s78
    v_lshlrev_b32 v24, 1, v24
    v_and_b32 v26, 31, v1
    v_xor_b32 v24, v24, v26
    s_lshl_b32 s90, s78, 1
    s_sub_u32 s90, s90, 1024
    v_add_u32 v27, s90, v25
    v_xor_b32 v26, 0, v24
    v_lshl_add_u32 v18, v26, 4, v25
    v_xor_b32 v26, 4, v24
    v_lshl_add_u32 v19, v26, 4, v27
    v_xor_b32 v26, 8, v24
    v_lshl_add_u32 v20, v26, 4, v25
    v_xor_b32 v26, 12, v24
    v_lshl_add_u32 v21, v26, 4, v27
    s_mov_b32 s40, s71
    s_mov_b32 s41, s72
    s_mov_b32 s44, s74
    s_mov_b32 s45, s75
    s_mov_b32 s95, s82
    s_mov_b32 s96, s83
    s_mov_b32 s97, s84
    s_mov_b32 s98, s85
    s_mov_b32 s99, s86
    s_mov_b32 s100, s87
    s_mov_b32 s101, s88
    s_add_u32 m0, s61, 0
    s_nop 0
    buffer_load_dwordx4 v16, s[40:43], s48 offen offset:0 lds
    buffer_load_dwordx4 v17, s[40:43], s48 offen offset:1024 lds
    s_add_u32 s48, s48, 128
    buffer_load_dwordx4 v16, s[40:43], s49 offen offset:2048 lds
    buffer_load_dwordx4 v17, s[40:43], s49 offen offset:3072 lds
    s_add_u32 s49, s49, 128
    s_add_u32 m0, s61, 4096
    s_nop 0
    buffer_load_dwordx4 v16, s[40:43], s50 offen offset:0 lds
    buffer_load_dwordx4 v17, s[40:43], s50 offen offset:1024 lds
    s_add_u32 s50, s50, 128
    buffer_load_dwordx4 v16, s[40:43], s51 offen offset:2048 lds
    buffer_load_dwordx4 v17, s[40:43], s51 offen offset:3072 lds
    s_add_u32 s51, s51, 128
    s_add_u32 s61, s61, 32768
    s_cmp_ge_u32 s61, 98304
    s_cselect_b32 s90, 98304, 0
    s_sub_u32 s61, s61, s90
    s_add_u32 m0, s62, 0
    s_nop 0
    buffer_load_dwordx4 v18, s[44:47], s52 offen offset:0 lds
    buffer_load_dwordx4 v19, s[44:47], s52 offen offset:1024 lds
    s_add_u32 s52, s52, s56
    buffer_load_dwordx4 v18, s[44:47], s53 offen offset:2048 lds
    buffer_load_dwordx4 v19, s[44:47], s53 offen offset:3072 lds
    s_add_u32 s53, s53, s56
    s_add_u32 m0, s62, 4096
    s_nop 0
    buffer_load_dwordx4 v20, s[44:47], s54 offen offset:0 lds
    buffer_load_dwordx4 v21, s[44:47], s54 offen offset:1024 lds
    s_add_u32 s54, s54, s56
    buffer_load_dwordx4 v20, s[44:47], s55 offen offset:2048 lds
    buffer_load_dwordx4 v21, s[44:47], s55 offen offset:3072 lds
    s_add_u32 s55, s55, s56
    s_xor_b32 s62, s62, 229376
    s_cmp_ge_u32 s68, 16
    s_cbranch_scc1 mega_kernel_typea7
    s_bfe_u32 s69, s68, 0x20002
    s_add_u32 s69, s69, 4
    s_and_b32 s90, s2, 7
    s_lshl_b32 s90, s90, 2
    s_and_b32 s91, s68, 3
    s_add_u32 s90, s90, s91
    s_cmp_lt_u32 s90, 16
    s_cselect_b32 s83, 0, 1
    s_mov_b32 s91, 33554432
    s_cselect_b32 s85, 16777216, s91
    s_mov_b32 s91, 8192
    s_cselect_b32 s86, 1024, s91
    s_mov_b32 s91, 1024
    s_cselect_b32 s87, 4096, s91
    s_cselect_b32 s74, s36, s38
    s_cselect_b32 s75, s37, s39
    s_mov_b32 s71, s32
    s_mov_b32 s72, s33
    s_mov_b32 s73, 2097152
    s_mov_b32 s77, 1024
    s_mov_b32 s82, 8
    s_mov_b32 s81, 0
    s_mov_b32 s76, 4194304
    s_mov_b32 s78, 8192
    s_mov_b32 s84, 0
    s_and_b32 s90, s90, 15
    s_lshl_b32 s80, s90, 9
    s_lshl_b32 s79, s69, 18
    s_lshl_b32 s91, s83, 2
    s_add_u32 s91, s91, s69
    s_cmp_ge_u32 s69, 4
    s_cselect_b32 s92, 508, 8
    s_add_u32 s91, s91, s92
    s_lshl_b32 s88, s90, 4
    s_add_u32 s88, s88, s91
    s_lshl_b32 s88, s88, 3
    s_lshl_b32 s91, s90, 1
    s_add_u32 s91, s91, s58
    s_lshl_b32 s91, s91, 19
    s_lshl_b32 s92, s69, 1
    s_add_u32 s92, s92, s57
    s_lshl_b32 s92, s92, 15
    s_add_u32 s85, s85, s91
    s_add_u32 s85, s85, s92
    s_branch mega_kernel_go28
mega_kernel_typea7:
    s_and_b32 s69, s68, 3
    s_and_b32 s90, s2, 1
    s_lshl_b32 s90, s90, 2
    s_add_u32 s69, s69, s90
    s_bfe_u32 s90, s2, 0x20001
    s_mul_i32 s90, s90, 3
    s_bfe_u32 s91, s68, 0x20002
    s_add_u32 s90, s90, s91
    s_mov_b32 s76, 6291456
    s_mov_b32 s78, 6144
    s_mov_b32 s81, 1
    s_mov_b32 s73, 4194304
    s_mov_b32 s77, 2048
    s_mov_b32 s82, 16
    s_lshl_b32 s80, s90, 9
    s_lshl_b32 s79, s69, 19
    s_and_b32 s92, s90, 3
    s_lshr_b32 s91, s90, 2
    s_lshl_b32 s88, s92, 2
    s_add_u32 s88, s88, s91
    s_lshl_b32 s88, s88, 3
    s_add_u32 s88, s88, s69
    s_lshl_b32 s88, s88, 3
    s_add_u32 s88, s88, 6144
    s_cmp_eq_u32 s91, 0
    s_cselect_b32 s84, 1048744942, 0
    s_lshl_b32 s93, s91, 22
    s_add_u32 s85, s93, 50331648
    s_lshl_b32 s92, s92, 1
    s_add_u32 s92, s92, s58
    s_lshl_b32 s92, s92, 19
    s_add_u32 s85, s85, s92
    s_lshl_b32 s92, s57, 3
    s_add_u32 s92, s92, s69
    s_cmp_eq_u32 s91, 2
    s_cselect_b32 s83, 1, 0
    s_cselect_b32 s93, 12, 13
    s_mov_b32 s91, 131072
    s_cselect_b32 s86, 1024, s91
    s_mov_b32 s91, 1024
    s_cselect_b32 s87, 65536, s91
    s_lshl_b32 s92, s92, s93
    s_add_u32 s85, s85, s92
    s_mov_b32 s71, s24
    s_mov_b32 s72, s25
    s_mov_b32 s74, s26
    s_mov_b32 s75, s27
mega_kernel_go28:
    s_xor_b32 s94, s70, 1
    s_mov_b32 s67, 2
    s_mov_b32 s17, -1
    s_mov_b32 s12, s4
    s_mov_b32 s13, s5
    s_mov_b32 s14, 256
    s_mov_b32 s15, 0x20000
    s_lshl_b32 s90, s2, 2
    s_add_u32 s90, s90, s16
    s_cmp_lg_u32 s90, 0
    s_cbranch_scc1 mega_kernel_tok9
    s_memrealtime s[92:93]
    s_waitcnt lgkmcnt(0)
    s_or_b32 s92, s92, 1
    v_mov_b32 v4, s92
    v_mov_b32 v5, s93
    s_mov_b64 exec, 1
    buffer_store_dwordx2 v[4:5], off, s[12:15], 0 sc1
    s_mov_b64 exec, -1
mega_kernel_tok9:
    s_add_u32 m0, s61, 0
    s_nop 0
    buffer_load_dwordx4 v16, s[40:43], s48 offen offset:0 lds
    buffer_load_dwordx4 v17, s[40:43], s48 offen offset:1024 lds
    s_add_u32 s48, s48, 128
    buffer_load_dwordx4 v16, s[40:43], s49 offen offset:2048 lds
    buffer_load_dwordx4 v17, s[40:43], s49 offen offset:3072 lds
    s_add_u32 s49, s49, 128
    s_add_u32 m0, s61, 4096
    s_nop 0
    buffer_load_dwordx4 v16, s[40:43], s50 offen offset:0 lds
    buffer_load_dwordx4 v17, s[40:43], s50 offen offset:1024 lds
    s_add_u32 s50, s50, 128
    buffer_load_dwordx4 v16, s[40:43], s51 offen offset:2048 lds
    buffer_load_dwordx4 v17, s[40:43], s51 offen offset:3072 lds
    s_add_u32 s51, s51, 128
    s_add_u32 s61, s61, 32768
    s_cmp_ge_u32 s61, 98304
    s_cselect_b32 s90, 98304, 0
    s_sub_u32 s61, s61, s90
    s_add_u32 m0, s62, 0
    s_nop 0
    buffer_load_dwordx4 v18, s[44:47], s52 offen offset:0 lds
    buffer_load_dwordx4 v19, s[44:47], s52 offen offset:1024 lds
    s_add_u32 s52, s52, s56
    buffer_load_dwordx4 v18, s[44:47], s53 offen offset:2048 lds
    buffer_load_dwordx4 v19, s[44:47], s53 offen offset:3072 lds
    s_add_u32 s53, s53, s56
    s_add_u32 m0, s62, 4096
    s_nop 0
    buffer_load_dwordx4 v20, s[44:47], s54 offen offset:0 lds
    buffer_load_dwordx4 v21, s[44:47], s54 offen offset:1024 lds
    s_add_u32 s54, s54, s56
    buffer_load_dwordx4 v20, s[44:47], s55 offen offset:2048 lds
    buffer_load_dwordx4 v21, s[44:47], s55 offen offset:3072 lds
    s_add_u32 s55, s55, s56
    s_xor_b32 s62, s62, 229376
    s_waitcnt vmcnt(16)
    s_barrier
    ds_read_b64_tr_b16 a[64:65], v8 offset:0
    ds_read_b64_tr_b16 a[66:67], v8 offset:2048
    ds_read_b128 a[0:3], v6 offset:0
    ds_read_b128 a[4:7], v6 offset:2048
    ds_read_b64_tr_b16 a[68:69], v9 offset:0
    ds_read_b64_tr_b16 a[70:71], v9 offset:2048
    ds_read_b128 a[8:11], v6 offset:4096
    ds_read_b128 a[12:15], v6 offset:6144
    ds_read_b64_tr_b16 a[72:73], v10 offset:0
    ds_read_b64_tr_b16 a[74:75], v10 offset:2048
    ds_read_b128 a[16:19], v6 offset:8192
    ds_read_b128 a[20:23], v6 offset:10240
    ds_read_b64_tr_b16 a[76:77], v11 offset:0
    ds_read_b64_tr_b16 a[78:79], v11 offset:2048
    ds_read_b128 a[24:27], v6 offset:12288
    ds_read_b128 a[28:31], v6 offset:14336
    ds_read_b64_tr_b16 a[80:81], v12 offset:0
    ds_read_b64_tr_b16 a[82:83], v12 offset:2048
    ds_read_b64_tr_b16 a[84:85], v13 offset:0
    ds_read_b64_tr_b16 a[86:87], v13 offset:2048
    ds_read_b64_tr_b16 a[88:89], v14 offset:0
    ds_read_b64_tr_b16 a[90:91], v14 offset:2048
    ds_read_b64_tr_b16 a[92:93], v15 offset:0
    ds_read_b64_tr_b16 a[94:95], v15 offset:2048
    s_mov_b32 s66, 1
    s_mov_b32 s24, s6
    s_mov_b32 s25, s7
    s_mov_b32 s26, 0
    s_mov_b32 s27, 0x20000
    s_mov_b32 s28, 0
    s_mov_b32 s29, 0
    s_mov_b32 s30, 0
    s_mov_b32 s31, 0
mega_kernel_tile10:
    s_mov_b32 s65, s95
    s_cmp_eq_u32 s96, 1
    s_cbranch_scc1 mega_kernel_swp12
    s_waitcnt lgkmcnt(15)
    v_mfma_f32_16x16x32_bf16 v[32:35], a[64:67], a[0:3], 0
    v_mfma_f32_16x16x32_bf16 v[40:43], a[64:67], a[4:7], 0
    v_mfma_f32_16x16x32_bf16 v[48:51], a[64:67], a[8:11], 0
    v_mfma_f32_16x16x32_bf16 v[56:59], a[64:67], a[12:15], 0
    s_add_u32 m0, s61, 0
    s_waitcnt lgkmcnt(13)
    v_mfma_f32_16x16x32_bf16 v[64:67], a[64:67], a[16:19], 0
    buffer_load_dwordx4 v16, s[40:43], s48 offen offset:0 lds
    s_waitcnt lgkmcnt(12)
    v_mfma_f32_16x16x32_bf16 v[72:75], a[64:67], a[20:23], 0
    s_waitcnt lgkmcnt(9)
    v_mfma_f32_16x16x32_bf16 v[80:83], a[64:67], a[24:27], 0
    s_waitcnt lgkmcnt(8)
    v_mfma_f32_16x16x32_bf16 v[88:91], a[64:67], a[28:31], 0
    ds_read_b64_tr_b16 a[64:65], v8 offset:16384
    v_mfma_f32_16x16x32_bf16 v[36:39], a[68:71], a[0:3], 0
    ds_read_b64_tr_b16 a[66:67], v8 offset:18432
    v_mfma_f32_16x16x32_bf16 v[44:47], a[68:71], a[4:7], 0
    v_mfma_f32_16x16x32_bf16 v[52:55], a[68:71], a[8:11], 0
    ds_read_b128 a[32:35], v7 offset:0
    v_mfma_f32_16x16x32_bf16 v[60:63], a[68:71], a[12:15], 0
    v_mfma_f32_16x16x32_bf16 v[68:71], a[68:71], a[16:19], 0
    buffer_load_dwordx4 v17, s[40:43], s48 offen offset:1024 lds
    v_mfma_f32_16x16x32_bf16 v[76:79], a[68:71], a[20:23], 0
    s_add_u32 s48, s48, 128
    v_mfma_f32_16x16x32_bf16 v[84:87], a[68:71], a[24:27], 0
    ds_read_b128 a[36:39], v7 offset:2048
    v_mfma_f32_16x16x32_bf16 v[92:95], a[68:71], a[28:31], 0
    ds_read_b64_tr_b16 a[68:69], v9 offset:16384
    v_mfma_f32_16x16x32_bf16 v[96:99], a[72:75], a[0:3], 0
    ds_read_b64_tr_b16 a[70:71], v9 offset:18432
    v_mfma_f32_16x16x32_bf16 v[104:107], a[72:75], a[4:7], 0
    v_mfma_f32_16x16x32_bf16 v[112:115], a[72:75], a[8:11], 0
    ds_read_b128 a[40:43], v7 offset:4096
    v_mfma_f32_16x16x32_bf16 v[120:123], a[72:75], a[12:15], 0
    v_mfma_f32_16x16x32_bf16 v[128:131], a[72:75], a[16:19], 0
    buffer_load_dwordx4 v16, s[40:43], s49 offen offset:2048 lds
    v_mfma_f32_16x16x32_bf16 v[136:139], a[72:75], a[20:23], 0
    v_mfma_f32_16x16x32_bf16 v[144:147], a[72:75], a[24:27], 0
    ds_read_b128 a[44:47], v7 offset:6144
    v_mfma_f32_16x16x32_bf16 v[152:155], a[72:75], a[28:31], 0
    ds_read_b64_tr_b16 a[72:73], v10 offset:16384
    v_mfma_f32_16x16x32_bf16 v[100:103], a[76:79], a[0:3], 0
    ds_read_b64_tr_b16 a[74:75], v10 offset:18432
    v_mfma_f32_16x16x32_bf16 v[108:111], a[76:79], a[4:7], 0
    v_mfma_f32_16x16x32_bf16 v[116:119], a[76:79], a[8:11], 0
    ds_read_b128 a[48:51], v7 offset:8192
    v_mfma_f32_16x16x32_bf16 v[124:127], a[76:79], a[12:15], 0
    v_mfma_f32_16x16x32_bf16 v[132:135], a[76:79], a[16:19], 0
    buffer_load_dwordx4 v17, s[40:43], s49 offen offset:3072 lds
    v_mfma_f32_16x16x32_bf16 v[140:143], a[76:79], a[20:23], 0
    s_add_u32 s49, s49, 128
    v_mfma_f32_16x16x32_bf16 v[148:151], a[76:79], a[24:27], 0
    ds_read_b128 a[52:55], v7 offset:10240
    v_mfma_f32_16x16x32_bf16 v[156:159], a[76:79], a[28:31], 0
    ds_read_b64_tr_b16 a[76:77], v11 offset:16384
    s_waitcnt lgkmcnt(15)
    v_mfma_f32_16x16x32_bf16 v[160:163], a[80:83], a[0:3], 0
    ds_read_b64_tr_b16 a[78:79], v11 offset:18432
    v_mfma_f32_16x16x32_bf16 v[168:171], a[80:83], a[4:7], 0
    v_mfma_f32_16x16x32_bf16 v[176:179], a[80:83], a[8:11], 0
    ds_read_b128 a[56:59], v7 offset:12288
    v_mfma_f32_16x16x32_bf16 v[184:187], a[80:83], a[12:15], 0
    s_add_u32 m0, s61, 4096
    v_mfma_f32_16x16x32_bf16 v[192:195], a[80:83], a[16:19], 0
    buffer_load_dwordx4 v16, s[40:43], s50 offen offset:0 lds
    v_mfma_f32_16x16x32_bf16 v[200:203], a[80:83], a[20:23], 0
    v_mfma_f32_16x16x32_bf16 v[208:211], a[80:83], a[24:27], 0
    s_add_u32 s61, s61, 32768
    ds_read_b128 a[60:63], v7 offset:14336
    v_mfma_f32_16x16x32_bf16 v[216:219], a[80:83], a[28:31], 0
    s_cmp_ge_u32 s61, 98304
    s_cselect_b32 s90, 98304, 0
    ds_read_b64_tr_b16 a[80:81], v12 offset:16384
    v_mfma_f32_16x16x32_bf16 v[164:167], a[84:87], a[0:3], 0
    s_sub_u32 s61, s61, s90
    ds_read_b64_tr_b16 a[82:83], v12 offset:18432
    v_mfma_f32_16x16x32_bf16 v[172:175], a[84:87], a[4:7], 0
    s_add_u32 s64, s64, 32768
    v_mfma_f32_16x16x32_bf16 v[180:183], a[84:87], a[8:11], 0
    buffer_store_dwordx4 a[128:131], v2, s[24:27], s28 offen sc1
    v_mfma_f32_16x16x32_bf16 v[188:191], a[84:87], a[12:15], 0
    s_add_u32 s28, s28, s31
    v_mfma_f32_16x16x32_bf16 v[196:199], a[84:87], a[16:19], 0
    buffer_load_dwordx4 v17, s[40:43], s50 offen offset:1024 lds
    v_mfma_f32_16x16x32_bf16 v[204:207], a[84:87], a[20:23], 0
    s_add_u32 s50, s50, 128
    v_mfma_f32_16x16x32_bf16 v[212:215], a[84:87], a[24:27], 0
    s_cmp_ge_u32 s64, 98304
    s_cselect_b32 s63, 4294901760, s59
    s_cselect_b32 s64, 0, s64
    v_mfma_f32_16x16x32_bf16 v[220:223], a[84:87], a[28:31], 0
    ds_read_b64_tr_b16 a[84:85], v13 offset:16384
    v_mfma_f32_16x16x32_bf16 v[224:227], a[88:91], a[0:3], 0
    ds_read_b64_tr_b16 a[86:87], v13 offset:18432
    v_mfma_f32_16x16x32_bf16 v[232:235], a[88:91], a[4:7], 0
    v_mfma_f32_16x16x32_bf16 v[240:243], a[88:91], a[8:11], 0
    buffer_store_dwordx4 a[132:135], v2, s[24:27], s28 offen sc1
    v_mfma_f32_16x16x32_bf16 v[248:251], a[88:91], a[12:15], 0
    s_add_u32 s28, s28, s31
    v_mfma_f32_16x16x32_bf16 a[96:99], a[88:91], a[16:19], 0
    buffer_load_dwordx4 v16, s[40:43], s51 offen offset:2048 lds
    v_mfma_f32_16x16x32_bf16 a[104:107], a[88:91], a[20:23], 0
    v_mfma_f32_16x16x32_bf16 a[112:115], a[88:91], a[24:27], 0
    v_mfma_f32_16x16x32_bf16 a[120:123], a[88:91], a[28:31], 0
    ds_read_b64_tr_b16 a[88:89], v14 offset:16384
    s_waitcnt lgkmcnt(15)
    v_mfma_f32_16x16x32_bf16 v[228:231], a[92:95], a[0:3], 0
    ds_read_b64_tr_b16 a[90:91], v14 offset:18432
    v_mfma_f32_16x16x32_bf16 v[236:239], a[92:95], a[4:7], 0
    v_add_u32 v6, s63, v6
    v_add_u32 v7, s63, v7
    v_mfma_f32_16x16x32_bf16 v[244:247], a[92:95], a[8:11], 0
    buffer_store_dwordx4 a[136:139], v2, s[24:27], s28 offen sc1
    v_mfma_f32_16x16x32_bf16 v[252:255], a[92:95], a[12:15], 0
    s_add_u32 s28, s28, s31
    v_mfma_f32_16x16x32_bf16 a[100:103], a[92:95], a[16:19], 0
    buffer_load_dwordx4 v17, s[40:43], s51 offen offset:3072 lds
    v_mfma_f32_16x16x32_bf16 a[108:111], a[92:95], a[20:23], 0
    s_add_u32 s51, s51, 128
    v_mfma_f32_16x16x32_bf16 a[116:119], a[92:95], a[24:27], 0
    v_mfma_f32_16x16x32_bf16 a[124:127], a[92:95], a[28:31], 0
    ds_read_b64_tr_b16 a[92:93], v15 offset:16384
    ds_read_b64_tr_b16 a[94:95], v15 offset:18432
    v_mfma_f32_16x16x32_bf16 v[32:35], a[64:67], a[32:35], v[32:35]
    v_xor_b32 v8, s60, v8
    v_xor_b32 v9, s60, v9
    v_mfma_f32_16x16x32_bf16 v[40:43], a[64:67], a[36:39], v[40:43]
    v_xor_b32 v10, s60, v10
    v_xor_b32 v11, s60, v11
    s_waitcnt lgkmcnt(15)
    v_mfma_f32_16x16x32_bf16 v[48:51], a[64:67], a[40:43], v[48:51]
    v_xor_b32 v12, s60, v12
    v_xor_b32 v13, s60, v13
    v_mfma_f32_16x16x32_bf16 v[56:59], a[64:67], a[44:47], v[56:59]
    v_xor_b32 v14, s60, v14
    v_xor_b32 v15, s60, v15
    s_waitcnt lgkmcnt(13)
    v_mfma_f32_16x16x32_bf16 v[64:67], a[64:67], a[48:51], v[64:67]
    s_waitcnt lgkmcnt(12)
    v_mfma_f32_16x16x32_bf16 v[72:75], a[64:67], a[52:55], v[72:75]
    s_waitcnt lgkmcnt(9)
    v_mfma_f32_16x16x32_bf16 v[80:83], a[64:67], a[56:59], v[80:83]
    s_waitcnt vmcnt(11) lgkmcnt(0)
    v_mfma_f32_16x16x32_bf16 v[88:91], a[64:67], a[60:63], v[88:91]
    s_barrier
    ds_read_b64_tr_b16 a[64:65], v8 offset:0
    v_mfma_f32_16x16x32_bf16 v[36:39], a[68:71], a[32:35], v[36:39]
    s_add_u32 m0, s62, 0
    ds_read_b64_tr_b16 a[66:67], v8 offset:2048
    v_mfma_f32_16x16x32_bf16 v[44:47], a[68:71], a[36:39], v[44:47]
    buffer_load_dwordx4 v18, s[44:47], s52 offen offset:0 lds
    v_mfma_f32_16x16x32_bf16 v[52:55], a[68:71], a[40:43], v[52:55]
    ds_read_b128 a[0:3], v6 offset:0
    v_mfma_f32_16x16x32_bf16 v[60:63], a[68:71], a[44:47], v[60:63]
    v_mfma_f32_16x16x32_bf16 v[68:71], a[68:71], a[48:51], v[68:71]
    v_mfma_f32_16x16x32_bf16 v[76:79], a[68:71], a[52:55], v[76:79]
    buffer_load_dwordx4 v19, s[44:47], s52 offen offset:1024 lds
    v_mfma_f32_16x16x32_bf16 v[84:87], a[68:71], a[56:59], v[84:87]
    s_add_u32 s52, s52, s56
    ds_read_b128 a[4:7], v6 offset:2048
    v_mfma_f32_16x16x32_bf16 v[92:95], a[68:71], a[60:63], v[92:95]
    ds_read_b64_tr_b16 a[68:69], v9 offset:0
    v_mfma_f32_16x16x32_bf16 v[96:99], a[72:75], a[32:35], v[96:99]
    ds_read_b64_tr_b16 a[70:71], v9 offset:2048
    v_mfma_f32_16x16x32_bf16 v[104:107], a[72:75], a[36:39], v[104:107]
    buffer_load_dwordx4 v18, s[44:47], s53 offen offset:2048 lds
    v_mfma_f32_16x16x32_bf16 v[112:115], a[72:75], a[40:43], v[112:115]
    ds_read_b128 a[8:11], v6 offset:4096
    v_mfma_f32_16x16x32_bf16 v[120:123], a[72:75], a[44:47], v[120:123]
    v_mfma_f32_16x16x32_bf16 v[128:131], a[72:75], a[48:51], v[128:131]
    v_mfma_f32_16x16x32_bf16 v[136:139], a[72:75], a[52:55], v[136:139]
    buffer_load_dwordx4 v19, s[44:47], s53 offen offset:3072 lds
    v_mfma_f32_16x16x32_bf16 v[144:147], a[72:75], a[56:59], v[144:147]
    s_add_u32 s53, s53, s56
    ds_read_b128 a[12:15], v6 offset:6144
    v_mfma_f32_16x16x32_bf16 v[152:155], a[72:75], a[60:63], v[152:155]
    ds_read_b64_tr_b16 a[72:73], v10 offset:0
    v_mfma_f32_16x16x32_bf16 v[100:103], a[76:79], a[32:35], v[100:103]
    s_add_u32 m0, s62, 4096
    ds_read_b64_tr_b16 a[74:75], v10 offset:2048
    v_mfma_f32_16x16x32_bf16 v[108:111], a[76:79], a[36:39], v[108:111]
    buffer_load_dwordx4 v20, s[44:47], s54 offen offset:0 lds
    v_mfma_f32_16x16x32_bf16 v[116:119], a[76:79], a[40:43], v[116:119]
    ds_read_b128 a[16:19], v6 offset:8192
    v_mfma_f32_16x16x32_bf16 v[124:127], a[76:79], a[44:47], v[124:127]
    s_xor_b32 s62, s62, 229376
    v_mfma_f32_16x16x32_bf16 v[132:135], a[76:79], a[48:51], v[132:135]
    v_mfma_f32_16x16x32_bf16 v[140:143], a[76:79], a[52:55], v[140:143]
    buffer_load_dwordx4 v21, s[44:47], s54 offen offset:1024 lds
    v_mfma_f32_16x16x32_bf16 v[148:151], a[76:79], a[56:59], v[148:151]
    s_add_u32 s54, s54, s56
    ds_read_b128 a[20:23], v6 offset:10240
    v_mfma_f32_16x16x32_bf16 v[156:159], a[76:79], a[60:63], v[156:159]
    ds_read_b64_tr_b16 a[76:77], v11 offset:0
    v_mfma_f32_16x16x32_bf16 v[160:163], a[80:83], a[32:35], v[160:163]
    ds_read_b64_tr_b16 a[78:79], v11 offset:2048
    v_mfma_f32_16x16x32_bf16 v[168:171], a[80:83], a[36:39], v[168:171]
    buffer_load_dwordx4 v20, s[44:47], s55 offen offset:2048 lds
    v_mfma_f32_16x16x32_bf16 v[176:179], a[80:83], a[40:43], v[176:179]
    ds_read_b128 a[24:27], v6 offset:12288
    v_mfma_f32_16x16x32_bf16 v[184:187], a[80:83], a[44:47], v[184:187]
    v_mfma_f32_16x16x32_bf16 v[192:195], a[80:83], a[48:51], v[192:195]
    v_mfma_f32_16x16x32_bf16 v[200:203], a[80:83], a[52:55], v[200:203]
    buffer_load_dwordx4 v21, s[44:47], s55 offen offset:3072 lds
    v_mfma_f32_16x16x32_bf16 v[208:211], a[80:83], a[56:59], v[208:211]
    s_add_u32 s55, s55, s56
    ds_read_b128 a[28:31], v6 offset:14336
    v_mfma_f32_16x16x32_bf16 v[216:219], a[80:83], a[60:63], v[216:219]
    ds_read_b64_tr_b16 a[80:81], v12 offset:0
    v_mfma_f32_16x16x32_bf16 v[164:167], a[84:87], a[32:35], v[164:167]
    ds_read_b64_tr_b16 a[82:83], v12 offset:2048
    v_mfma_f32_16x16x32_bf16 v[172:175], a[84:87], a[36:39], v[172:175]
    v_mfma_f32_16x16x32_bf16 v[180:183], a[84:87], a[40:43], v[180:183]
    buffer_store_dwordx4 a[140:143], v2, s[24:27], s28 offen sc1
    v_mfma_f32_16x16x32_bf16 v[188:191], a[84:87], a[44:47], v[188:191]
    s_add_u32 s28, s28, s31
    v_mfma_f32_16x16x32_bf16 v[196:199], a[84:87], a[48:51], v[196:199]
    v_mfma_f32_16x16x32_bf16 v[204:207], a[84:87], a[52:55], v[204:207]
    v_mfma_f32_16x16x32_bf16 v[212:215], a[84:87], a[56:59], v[212:215]
    buffer_store_dwordx4 a[144:147], v2, s[24:27], s28 offen sc1
    v_mfma_f32_16x16x32_bf16 v[220:223], a[84:87], a[60:63], v[220:223]
    s_add_u32 s28, s28, s31
    ds_read_b64_tr_b16 a[84:85], v13 offset:0
    v_mfma_f32_16x16x32_bf16 v[224:227], a[88:91], a[32:35], v[224:227]
    ds_read_b64_tr_b16 a[86:87], v13 offset:2048
    v_mfma_f32_16x16x32_bf16 v[232:235], a[88:91], a[36:39], v[232:235]
    v_mfma_f32_16x16x32_bf16 v[240:243], a[88:91], a[40:43], v[240:243]
    buffer_store_dwordx4 a[148:151], v2, s[24:27], s28 offen sc1
    v_mfma_f32_16x16x32_bf16 v[248:251], a[88:91], a[44:47], v[248:251]
    s_add_u32 s28, s28, s31
    v_mfma_f32_16x16x32_bf16 a[96:99], a[88:91], a[48:51], a[96:99]
    v_mfma_f32_16x16x32_bf16 a[104:107], a[88:91], a[52:55], a[104:107]
    v_mfma_f32_16x16x32_bf16 a[112:115], a[88:91], a[56:59], a[112:115]
    buffer_store_dwordx4 a[152:155], v2, s[24:27], s28 offen sc1
    v_mfma_f32_16x16x32_bf16 a[120:123], a[88:91], a[60:63], a[120:123]
    s_add_u32 s28, s28, s31
    ds_read_b64_tr_b16 a[88:89], v14 offset:0
    v_mfma_f32_16x16x32_bf16 v[228:231], a[92:95], a[32:35], v[228:231]
    ds_read_b64_tr_b16 a[90:91], v14 offset:2048
    v_mfma_f32_16x16x32_bf16 v[236:239], a[92:95], a[36:39], v[236:239]
    v_mfma_f32_16x16x32_bf16 v[244:247], a[92:95], a[40:43], v[244:247]
    buffer_store_dwordx4 a[156:159], v2, s[24:27], s28 offen sc1
    v_mfma_f32_16x16x32_bf16 v[252:255], a[92:95], a[44:47], v[252:255]
    s_add_u32 s29, s29, s30
    s_mov_b32 s28, s29
    v_mfma_f32_16x16x32_bf16 a[100:103], a[92:95], a[48:51], a[100:103]
    s_sub_u32 s65, s65, 1
    v_mfma_f32_16x16x32_bf16 a[108:111], a[92:95], a[52:55], a[108:111]
    v_mfma_f32_16x16x32_bf16 a[116:119], a[92:95], a[56:59], a[116:119]
    v_mfma_f32_16x16x32_bf16 a[124:127], a[92:95], a[60:63], a[124:127]
    ds_read_b64_tr_b16 a[92:93], v15 offset:0
    ds_read_b64_tr_b16 a[94:95], v15 offset:2048
    s_waitcnt lgkmcnt(15)
    v_mfma_f32_16x16x32_bf16 v[32:35], a[64:67], a[0:3], v[32:35]
    v_mfma_f32_16x16x32_bf16 v[40:43], a[64:67], a[4:7], v[40:43]
    v_mfma_f32_16x16x32_bf16 v[48:51], a[64:67], a[8:11], v[48:51]
    v_mfma_f32_16x16x32_bf16 v[56:59], a[64:67], a[12:15], v[56:59]
    s_add_u32 m0, s61, 0
    s_waitcnt lgkmcnt(13)
    v_mfma_f32_16x16x32_bf16 v[64:67], a[64:67], a[16:19], v[64:67]
    buffer_load_dwordx4 v16, s[40:43], s48 offen offset:0 lds
    s_waitcnt lgkmcnt(12)
    v_mfma_f32_16x16x32_bf16 v[72:75], a[64:67], a[20:23], v[72:75]
    s_waitcnt lgkmcnt(9)
    v_mfma_f32_16x16x32_bf16 v[80:83], a[64:67], a[24:27], v[80:83]
    s_waitcnt lgkmcnt(8)
    v_mfma_f32_16x16x32_bf16 v[88:91], a[64:67], a[28:31], v[88:91]
    ds_read_b64_tr_b16 a[64:65], v8 offset:16384
    v_mfma_f32_16x16x32_bf16 v[36:39], a[68:71], a[0:3], v[36:39]
    ds_read_b64_tr_b16 a[66:67], v8 offset:18432
    v_mfma_f32_16x16x32_bf16 v[44:47], a[68:71], a[4:7], v[44:47]
    v_mfma_f32_16x16x32_bf16 v[52:55], a[68:71], a[8:11], v[52:55]
    ds_read_b128 a[32:35], v7 offset:0
    v_mfma_f32_16x16x32_bf16 v[60:63], a[68:71], a[12:15], v[60:63]
    v_mfma_f32_16x16x32_bf16 v[68:71], a[68:71], a[16:19], v[68:71]
    buffer_load_dwordx4 v17, s[40:43], s48 offen offset:1024 lds
    v_mfma_f32_16x16x32_bf16 v[76:79], a[68:71], a[20:23], v[76:79]
    s_add_u32 s48, s48, 128
    v_mfma_f32_16x16x32_bf16 v[84:87], a[68:71], a[24:27], v[84:87]
    ds_read_b128 a[36:39], v7 offset:2048
    v_mfma_f32_16x16x32_bf16 v[92:95], a[68:71], a[28:31], v[92:95]
    ds_read_b64_tr_b16 a[68:69], v9 offset:16384
    v_mfma_f32_16x16x32_bf16 v[96:99], a[72:75], a[0:3], v[96:99]
    ds_read_b64_tr_b16 a[70:71], v9 offset:18432
    v_mfma_f32_16x16x32_bf16 v[104:107], a[72:75], a[4:7], v[104:107]
    v_mfma_f32_16x16x32_bf16 v[112:115], a[72:75], a[8:11], v[112:115]
    ds_read_b128 a[40:43], v7 offset:4096
    v_mfma_f32_16x16x32_bf16 v[120:123], a[72:75], a[12:15], v[120:123]
    v_mfma_f32_16x16x32_bf16 v[128:131], a[72:75], a[16:19], v[128:131]
    buffer_load_dwordx4 v16, s[40:43], s49 offen offset:2048 lds
    v_mfma_f32_16x16x32_bf16 v[136:139], a[72:75], a[20:23], v[136:139]
    v_mfma_f32_16x16x32_bf16 v[144:147], a[72:75], a[24:27], v[144:147]
    ds_read_b128 a[44:47], v7 offset:6144
    v_mfma_f32_16x16x32_bf16 v[152:155], a[72:75], a[28:31], v[152:155]
    ds_read_b64_tr_b16 a[72:73], v10 offset:16384
    v_mfma_f32_16x16x32_bf16 v[100:103], a[76:79], a[0:3], v[100:103]
    ds_read_b64_tr_b16 a[74:75], v10 offset:18432
    v_mfma_f32_16x16x32_bf16 v[108:111], a[76:79], a[4:7], v[108:111]
    v_mfma_f32_16x16x32_bf16 v[116:119], a[76:79], a[8:11], v[116:119]
    ds_read_b128 a[48:51], v7 offset:8192
    v_mfma_f32_16x16x32_bf16 v[124:127], a[76:79], a[12:15], v[124:127]
    v_mfma_f32_16x16x32_bf16 v[132:135], a[76:79], a[16:19], v[132:135]
    buffer_load_dwordx4 v17, s[40:43], s49 offen offset:3072 lds
    v_mfma_f32_16x16x32_bf16 v[140:143], a[76:79], a[20:23], v[140:143]
    s_add_u32 s49, s49, 128
    v_mfma_f32_16x16x32_bf16 v[148:151], a[76:79], a[24:27], v[148:151]
    ds_read_b128 a[52:55], v7 offset:10240
    v_mfma_f32_16x16x32_bf16 v[156:159], a[76:79], a[28:31], v[156:159]
    ds_read_b64_tr_b16 a[76:77], v11 offset:16384
    s_waitcnt lgkmcnt(15)
    v_mfma_f32_16x16x32_bf16 v[160:163], a[80:83], a[0:3], v[160:163]
    ds_read_b64_tr_b16 a[78:79], v11 offset:18432
    v_mfma_f32_16x16x32_bf16 v[168:171], a[80:83], a[4:7], v[168:171]
    v_mfma_f32_16x16x32_bf16 v[176:179], a[80:83], a[8:11], v[176:179]
    ds_read_b128 a[56:59], v7 offset:12288
    v_mfma_f32_16x16x32_bf16 v[184:187], a[80:83], a[12:15], v[184:187]
    s_add_u32 m0, s61, 4096
    v_mfma_f32_16x16x32_bf16 v[192:195], a[80:83], a[16:19], v[192:195]
    buffer_load_dwordx4 v16, s[40:43], s50 offen offset:0 lds
    v_mfma_f32_16x16x32_bf16 v[200:203], a[80:83], a[20:23], v[200:203]
    v_mfma_f32_16x16x32_bf16 v[208:211], a[80:83], a[24:27], v[208:211]
    s_add_u32 s61, s61, 32768
    ds_read_b128 a[60:63], v7 offset:14336
    v_mfma_f32_16x16x32_bf16 v[216:219], a[80:83], a[28:31], v[216:219]
    s_cmp_ge_u32 s61, 98304
    s_cselect_b32 s90, 98304, 0
    ds_read_b64_tr_b16 a[80:81], v12 offset:16384
    v_mfma_f32_16x16x32_bf16 v[164:167], a[84:87], a[0:3], v[164:167]
    s_sub_u32 s61, s61, s90
    ds_read_b64_tr_b16 a[82:83], v12 offset:18432
    v_mfma_f32_16x16x32_bf16 v[172:175], a[84:87], a[4:7], v[172:175]
    s_add_u32 s64, s64, 32768
    v_mfma_f32_16x16x32_bf16 v[180:183], a[84:87], a[8:11], v[180:183]
    buffer_store_dwordx4 a[160:163], v2, s[24:27], s28 offen sc1
    v_mfma_f32_16x16x32_bf16 v[188:191], a[84:87], a[12:15], v[188:191]
    s_add_u32 s28, s28, s31
    v_mfma_f32_16x16x32_bf16 v[196:199], a[84:87], a[16:19], v[196:199]
    buffer_load_dwordx4 v17, s[40:43], s50 offen offset:1024 lds
    v_mfma_f32_16x16x32_bf16 v[204:207], a[84:87], a[20:23], v[204:207]
    s_add_u32 s50, s50, 128
    v_mfma_f32_16x16x32_bf16 v[212:215], a[84:87], a[24:27], v[212:215]
    s_cmp_ge_u32 s64, 98304
    s_cselect_b32 s63, 4294901760, s59
    s_cselect_b32 s64, 0, s64
    v_mfma_f32_16x16x32_bf16 v[220:223], a[84:87], a[28:31], v[220:223]
    ds_read_b64_tr_b16 a[84:85], v13 offset:16384
    v_mfma_f32_16x16x32_bf16 v[224:227], a[88:91], a[0:3], v[224:227]
    ds_read_b64_tr_b16 a[86:87], v13 offset:18432
    v_mfma_f32_16x16x32_bf16 v[232:235], a[88:91], a[4:7], v[232:235]
    v_mfma_f32_16x16x32_bf16 v[240:243], a[88:91], a[8:11], v[240:243]
    buffer_store_dwordx4 a[164:167], v2, s[24:27], s28 offen sc1
    v_mfma_f32_16x16x32_bf16 v[248:251], a[88:91], a[12:15], v[248:251]
    s_add_u32 s28, s28, s31
    v_mfma_f32_16x16x32_bf16 a[96:99], a[88:91], a[16:19], a[96:99]
    buffer_load_dwordx4 v16, s[40:43], s51 offen offset:2048 lds
    v_mfma_f32_16x16x32_bf16 a[104:107], a[88:91], a[20:23], a[104:107]
    v_mfma_f32_16x16x32_bf16 a[112:115], a[88:91], a[24:27], a[112:115]
    v_mfma_f32_16x16x32_bf16 a[120:123], a[88:91], a[28:31], a[120:123]
    ds_read_b64_tr_b16 a[88:89], v14 offset:16384
    s_waitcnt lgkmcnt(15)
    v_mfma_f32_16x16x32_bf16 v[228:231], a[92:95], a[0:3], v[228:231]
    ds_read_b64_tr_b16 a[90:91], v14 offset:18432
    v_mfma_f32_16x16x32_bf16 v[236:239], a[92:95], a[4:7], v[236:239]
    v_add_u32 v6, s63, v6
    v_add_u32 v7, s63, v7
    v_mfma_f32_16x16x32_bf16 v[244:247], a[92:95], a[8:11], v[244:247]
    buffer_store_dwordx4 a[168:171], v2, s[24:27], s28 offen sc1
    v_mfma_f32_16x16x32_bf16 v[252:255], a[92:95], a[12:15], v[252:255]
    s_add_u32 s28, s28, s31
    v_mfma_f32_16x16x32_bf16 a[100:103], a[92:95], a[16:19], a[100:103]
    buffer_load_dwordx4 v17, s[40:43], s51 offen offset:3072 lds
    v_mfma_f32_16x16x32_bf16 a[108:111], a[92:95], a[20:23], a[108:111]
    s_add_u32 s51, s51, 128
    v_mfma_f32_16x16x32_bf16 a[116:119], a[92:95], a[24:27], a[116:119]
    v_mfma_f32_16x16x32_bf16 a[124:127], a[92:95], a[28:31], a[124:127]
    ds_read_b64_tr_b16 a[92:93], v15 offset:16384
    ds_read_b64_tr_b16 a[94:95], v15 offset:18432
    v_mfma_f32_16x16x32_bf16 v[32:35], a[64:67], a[32:35], v[32:35]
    v_xor_b32 v8, s60, v8
    v_xor_b32 v9, s60, v9
    v_mfma_f32_16x16x32_bf16 v[40:43], a[64:67], a[36:39], v[40:43]
    v_xor_b32 v10, s60, v10
    v_xor_b32 v11, s60, v11
    s_waitcnt lgkmcnt(15)
    v_mfma_f32_16x16x32_bf16 v[48:51], a[64:67], a[40:43], v[48:51]
    v_xor_b32 v12, s60, v12
    v_xor_b32 v13, s60, v13
    v_mfma_f32_16x16x32_bf16 v[56:59], a[64:67], a[44:47], v[56:59]
    v_xor_b32 v14, s60, v14
    v_xor_b32 v15, s60, v15
    s_waitcnt lgkmcnt(13)
    v_mfma_f32_16x16x32_bf16 v[64:67], a[64:67], a[48:51], v[64:67]
    s_waitcnt lgkmcnt(12)
    v_mfma_f32_16x16x32_bf16 v[72:75], a[64:67], a[52:55], v[72:75]
    s_waitcnt lgkmcnt(9)
    v_mfma_f32_16x16x32_bf16 v[80:83], a[64:67], a[56:59], v[80:83]
    s_waitcnt vmcnt(16) lgkmcnt(0)
    v_mfma_f32_16x16x32_bf16 v[88:91], a[64:67], a[60:63], v[88:91]
    s_barrier
    ds_read_b64_tr_b16 a[64:65], v8 offset:0
    v_mfma_f32_16x16x32_bf16 v[36:39], a[68:71], a[32:35], v[36:39]
    s_add_u32 m0, s62, 0
    ds_read_b64_tr_b16 a[66:67], v8 offset:2048
    v_mfma_f32_16x16x32_bf16 v[44:47], a[68:71], a[36:39], v[44:47]
    buffer_load_dwordx4 v18, s[44:47], s52 offen offset:0 lds
    v_mfma_f32_16x16x32_bf16 v[52:55], a[68:71], a[40:43], v[52:55]
    ds_read_b128 a[0:3], v6 offset:0
    v_mfma_f32_16x16x32_bf16 v[60:63], a[68:71], a[44:47], v[60:63]
    v_mfma_f32_16x16x32_bf16 v[68:71], a[68:71], a[48:51], v[68:71]
    v_mfma_f32_16x16x32_bf16 v[76:79], a[68:71], a[52:55], v[76:79]
    buffer_load_dwordx4 v19, s[44:47], s52 offen offset:1024 lds
    v_mfma_f32_16x16x32_bf16 v[84:87], a[68:71], a[56:59], v[84:87]
    s_add_u32 s52, s52, s56
    ds_read_b128 a[4:7], v6 offset:2048
    v_mfma_f32_16x16x32_bf16 v[92:95], a[68:71], a[60:63], v[92:95]
    ds_read_b64_tr_b16 a[68:69], v9 offset:0
    v_mfma_f32_16x16x32_bf16 v[96:99], a[72:75], a[32:35], v[96:99]
    ds_read_b64_tr_b16 a[70:71], v9 offset:2048
    v_mfma_f32_16x16x32_bf16 v[104:107], a[72:75], a[36:39], v[104:107]
    buffer_load_dwordx4 v18, s[44:47], s53 offen offset:2048 lds
    v_mfma_f32_16x16x32_bf16 v[112:115], a[72:75], a[40:43], v[112:115]
    ds_read_b128 a[8:11], v6 offset:4096
    v_mfma_f32_16x16x32_bf16 v[120:123], a[72:75], a[44:47], v[120:123]
    v_mfma_f32_16x16x32_bf16 v[128:131], a[72:75], a[48:51], v[128:131]
    v_mfma_f32_16x16x32_bf16 v[136:139], a[72:75], a[52:55], v[136:139]
    buffer_load_dwordx4 v19, s[44:47], s53 offen offset:3072 lds
    v_mfma_f32_16x16x32_bf16 v[144:147], a[72:75], a[56:59], v[144:147]
    s_add_u32 s53, s53, s56
    ds_read_b128 a[12:15], v6 offset:6144
    v_mfma_f32_16x16x32_bf16 v[152:155], a[72:75], a[60:63], v[152:155]
    ds_read_b64_tr_b16 a[72:73], v10 offset:0
    v_mfma_f32_16x16x32_bf16 v[100:103], a[76:79], a[32:35], v[100:103]
    s_add_u32 m0, s62, 4096
    ds_read_b64_tr_b16 a[74:75], v10 offset:2048
    v_mfma_f32_16x16x32_bf16 v[108:111], a[76:79], a[36:39], v[108:111]
    buffer_load_dwordx4 v20, s[44:47], s54 offen offset:0 lds
    v_mfma_f32_16x16x32_bf16 v[116:119], a[76:79], a[40:43], v[116:119]
    ds_read_b128 a[16:19], v6 offset:8192
    v_mfma_f32_16x16x32_bf16 v[124:127], a[76:79], a[44:47], v[124:127]
    s_xor_b32 s62, s62, 229376
    v_mfma_f32_16x16x32_bf16 v[132:135], a[76:79], a[48:51], v[132:135]
    v_mfma_f32_16x16x32_bf16 v[140:143], a[76:79], a[52:55], v[140:143]
    buffer_load_dwordx4 v21, s[44:47], s54 offen offset:1024 lds
    v_mfma_f32_16x16x32_bf16 v[148:151], a[76:79], a[56:59], v[148:151]
    s_add_u32 s54, s54, s56
    ds_read_b128 a[20:23], v6 offset:10240
    v_mfma_f32_16x16x32_bf16 v[156:159], a[76:79], a[60:63], v[156:159]
    ds_read_b64_tr_b16 a[76:77], v11 offset:0
    v_mfma_f32_16x16x32_bf16 v[160:163], a[80:83], a[32:35], v[160:163]
    ds_read_b64_tr_b16 a[78:79], v11 offset:2048
    v_mfma_f32_16x16x32_bf16 v[168:171], a[80:83], a[36:39], v[168:171]
    buffer_load_dwordx4 v20, s[44:47], s55 offen offset:2048 lds
    v_mfma_f32_16x16x32_bf16 v[176:179], a[80:83], a[40:43], v[176:179]
    ds_read_b128 a[24:27], v6 offset:12288
    v_mfma_f32_16x16x32_bf16 v[184:187], a[80:83], a[44:47], v[184:187]
    v_mfma_f32_16x16x32_bf16 v[192:195], a[80:83], a[48:51], v[192:195]
    v_mfma_f32_16x16x32_bf16 v[200:203], a[80:83], a[52:55], v[200:203]
    buffer_load_dwordx4 v21, s[44:47], s55 offen offset:3072 lds
    v_mfma_f32_16x16x32_bf16 v[208:211], a[80:83], a[56:59], v[208:211]
    s_add_u32 s55, s55, s56
    ds_read_b128 a[28:31], v6 offset:14336
    v_mfma_f32_16x16x32_bf16 v[216:219], a[80:83], a[60:63], v[216:219]
    ds_read_b64_tr_b16 a[80:81], v12 offset:0
    v_mfma_f32_16x16x32_bf16 v[164:167], a[84:87], a[32:35], v[164:167]
    ds_read_b64_tr_b16 a[82:83], v12 offset:2048
    v_mfma_f32_16x16x32_bf16 v[172:175], a[84:87], a[36:39], v[172:175]
    v_mfma_f32_16x16x32_bf16 v[180:183], a[84:87], a[40:43], v[180:183]
    buffer_store_dwordx4 a[172:175], v2, s[24:27], s28 offen sc1
    v_mfma_f32_16x16x32_bf16 v[188:191], a[84:87], a[44:47], v[188:191]
    s_add_u32 s28, s28, s31
    v_mfma_f32_16x16x32_bf16 v[196:199], a[84:87], a[48:51], v[196:199]
    v_mfma_f32_16x16x32_bf16 v[204:207], a[84:87], a[52:55], v[204:207]
    v_mfma_f32_16x16x32_bf16 v[212:215], a[84:87], a[56:59], v[212:215]
    buffer_store_dwordx4 a[176:179], v2, s[24:27], s28 offen sc1
    v_mfma_f32_16x16x32_bf16 v[220:223], a[84:87], a[60:63], v[220:223]
    s_add_u32 s28, s28, s31
    ds_read_b64_tr_b16 a[84:85], v13 offset:0
    v_mfma_f32_16x16x32_bf16 v[224:227], a[88:91], a[32:35], v[224:227]
    ds_read_b64_tr_b16 a[86:87], v13 offset:2048
    v_mfma_f32_16x16x32_bf16 v[232:235], a[88:91], a[36:39], v[232:235]
    v_mfma_f32_16x16x32_bf16 v[240:243], a[88:91], a[40:43], v[240:243]
    buffer_store_dwordx4 a[180:183], v2, s[24:27], s28 offen sc1
    v_mfma_f32_16x16x32_bf16 v[248:251], a[88:91], a[44:47], v[248:251]
    s_add_u32 s28, s28, s31
    v_mfma_f32_16x16x32_bf16 a[96:99], a[88:91], a[48:51], a[96:99]
    v_mfma_f32_16x16x32_bf16 a[104:107], a[88:91], a[52:55], a[104:107]
    v_mfma_f32_16x16x32_bf16 a[112:115], a[88:91], a[56:59], a[112:115]
    buffer_store_dwordx4 a[184:187], v2, s[24:27], s28 offen sc1
    v_mfma_f32_16x16x32_bf16 a[120:123], a[88:91], a[60:63], a[120:123]
    s_add_u32 s28, s28, s31
    ds_read_b64_tr_b16 a[88:89], v14 offset:0
    v_mfma_f32_16x16x32_bf16 v[228:231], a[92:95], a[32:35], v[228:231]
    ds_read_b64_tr_b16 a[90:91], v14 offset:2048
    v_mfma_f32_16x16x32_bf16 v[236:239], a[92:95], a[36:39], v[236:239]
    v_mfma_f32_16x16x32_bf16 v[244:247], a[92:95], a[40:43], v[244:247]
    buffer_store_dwordx4 a[188:191], v2, s[24:27], s28 offen sc1
    v_mfma_f32_16x16x32_bf16 v[252:255], a[92:95], a[44:47], v[252:255]
    s_add_u32 s29, s29, s30
    s_mov_b32 s28, s29
    v_mfma_f32_16x16x32_bf16 a[100:103], a[92:95], a[48:51], a[100:103]
    s_sub_u32 s65, s65, 1
    v_mfma_f32_16x16x32_bf16 a[108:111], a[92:95], a[52:55], a[108:111]
    v_mfma_f32_16x16x32_bf16 a[116:119], a[92:95], a[56:59], a[116:119]
    v_mfma_f32_16x16x32_bf16 a[124:127], a[92:95], a[60:63], a[124:127]
    ds_read_b64_tr_b16 a[92:93], v15 offset:0
    ds_read_b64_tr_b16 a[94:95], v15 offset:2048
    s_waitcnt lgkmcnt(15)
    v_mfma_f32_16x16x32_bf16 v[32:35], a[64:67], a[0:3], v[32:35]
    v_mfma_f32_16x16x32_bf16 v[40:43], a[64:67], a[4:7], v[40:43]
    v_mfma_f32_16x16x32_bf16 v[48:51], a[64:67], a[8:11], v[48:51]
    v_mfma_f32_16x16x32_bf16 v[56:59], a[64:67], a[12:15], v[56:59]
    s_add_u32 m0, s61, 0
    s_waitcnt lgkmcnt(13)
    v_mfma_f32_16x16x32_bf16 v[64:67], a[64:67], a[16:19], v[64:67]
    buffer_load_dwordx4 v16, s[40:43], s48 offen offset:0 lds
    s_waitcnt lgkmcnt(12)
    v_mfma_f32_16x16x32_bf16 v[72:75], a[64:67], a[20:23], v[72:75]
    s_waitcnt lgkmcnt(9)
    v_mfma_f32_16x16x32_bf16 v[80:83], a[64:67], a[24:27], v[80:83]
    s_waitcnt lgkmcnt(8)
    v_mfma_f32_16x16x32_bf16 v[88:91], a[64:67], a[28:31], v[88:91]
    ds_read_b64_tr_b16 a[64:65], v8 offset:16384
    v_mfma_f32_16x16x32_bf16 v[36:39], a[68:71], a[0:3], v[36:39]
    ds_read_b64_tr_b16 a[66:67], v8 offset:18432
    v_mfma_f32_16x16x32_bf16 v[44:47], a[68:71], a[4:7], v[44:47]
    v_mfma_f32_16x16x32_bf16 v[52:55], a[68:71], a[8:11], v[52:55]
    ds_read_b128 a[32:35], v7 offset:0
    v_mfma_f32_16x16x32_bf16 v[60:63], a[68:71], a[12:15], v[60:63]
    v_mfma_f32_16x16x32_bf16 v[68:71], a[68:71], a[16:19], v[68:71]
    buffer_load_dwordx4 v17, s[40:43], s48 offen offset:1024 lds
    v_mfma_f32_16x16x32_bf16 v[76:79], a[68:71], a[20:23], v[76:79]
    s_add_u32 s48, s48, 128
    v_mfma_f32_16x16x32_bf16 v[84:87], a[68:71], a[24:27], v[84:87]
    ds_read_b128 a[36:39], v7 offset:2048
    v_mfma_f32_16x16x32_bf16 v[92:95], a[68:71], a[28:31], v[92:95]
    ds_read_b64_tr_b16 a[68:69], v9 offset:16384
    v_mfma_f32_16x16x32_bf16 v[96:99], a[72:75], a[0:3], v[96:99]
    ds_read_b64_tr_b16 a[70:71], v9 offset:18432
    v_mfma_f32_16x16x32_bf16 v[104:107], a[72:75], a[4:7], v[104:107]
    v_mfma_f32_16x16x32_bf16 v[112:115], a[72:75], a[8:11], v[112:115]
    ds_read_b128 a[40:43], v7 offset:4096
    v_mfma_f32_16x16x32_bf16 v[120:123], a[72:75], a[12:15], v[120:123]
    v_mfma_f32_16x16x32_bf16 v[128:131], a[72:75], a[16:19], v[128:131]
    buffer_load_dwordx4 v16, s[40:43], s49 offen offset:2048 lds
    v_mfma_f32_16x16x32_bf16 v[136:139], a[72:75], a[20:23], v[136:139]
    v_mfma_f32_16x16x32_bf16 v[144:147], a[72:75], a[24:27], v[144:147]
    ds_read_b128 a[44:47], v7 offset:6144
    v_mfma_f32_16x16x32_bf16 v[152:155], a[72:75], a[28:31], v[152:155]
    ds_read_b64_tr_b16 a[72:73], v10 offset:16384
    v_mfma_f32_16x16x32_bf16 v[100:103], a[76:79], a[0:3], v[100:103]
    ds_read_b64_tr_b16 a[74:75], v10 offset:18432
    v_mfma_f32_16x16x32_bf16 v[108:111], a[76:79], a[4:7], v[108:111]
    v_mfma_f32_16x16x32_bf16 v[116:119], a[76:79], a[8:11], v[116:119]
    ds_read_b128 a[48:51], v7 offset:8192
    v_mfma_f32_16x16x32_bf16 v[124:127], a[76:79], a[12:15], v[124:127]
    v_mfma_f32_16x16x32_bf16 v[132:135], a[76:79], a[16:19], v[132:135]
    buffer_load_dwordx4 v17, s[40:43], s49 offen offset:3072 lds
    v_mfma_f32_16x16x32_bf16 v[140:143], a[76:79], a[20:23], v[140:143]
    s_add_u32 s49, s49, 128
    v_mfma_f32_16x16x32_bf16 v[148:151], a[76:79], a[24:27], v[148:151]
    ds_read_b128 a[52:55], v7 offset:10240
    v_mfma_f32_16x16x32_bf16 v[156:159], a[76:79], a[28:31], v[156:159]
    ds_read_b64_tr_b16 a[76:77], v11 offset:16384
    s_waitcnt lgkmcnt(15)
    v_mfma_f32_16x16x32_bf16 v[160:163], a[80:83], a[0:3], v[160:163]
    ds_read_b64_tr_b16 a[78:79], v11 offset:18432
    v_mfma_f32_16x16x32_bf16 v[168:171], a[80:83], a[4:7], v[168:171]
    v_mfma_f32_16x16x32_bf16 v[176:179], a[80:83], a[8:11], v[176:179]
    ds_read_b128 a[56:59], v7 offset:12288
    v_mfma_f32_16x16x32_bf16 v[184:187], a[80:83], a[12:15], v[184:187]
    s_add_u32 m0, s61, 4096
    v_mfma_f32_16x16x32_bf16 v[192:195], a[80:83], a[16:19], v[192:195]
    buffer_load_dwordx4 v16, s[40:43], s50 offen offset:0 lds
    v_mfma_f32_16x16x32_bf16 v[200:203], a[80:83], a[20:23], v[200:203]
    v_mfma_f32_16x16x32_bf16 v[208:211], a[80:83], a[24:27], v[208:211]
    s_add_u32 s61, s61, 32768
    ds_read_b128 a[60:63], v7 offset:14336
    v_mfma_f32_16x16x32_bf16 v[216:219], a[80:83], a[28:31], v[216:219]
    s_cmp_ge_u32 s61, 98304
    s_cselect_b32 s90, 98304, 0
    ds_read_b64_tr_b16 a[80:81], v12 offset:16384
    v_mfma_f32_16x16x32_bf16 v[164:167], a[84:87], a[0:3], v[164:167]
    s_sub_u32 s61, s61, s90
    ds_read_b64_tr_b16 a[82:83], v12 offset:18432
    v_mfma_f32_16x16x32_bf16 v[172:175], a[84:87], a[4:7], v[172:175]
    s_add_u32 s64, s64, 32768
    v_mfma_f32_16x16x32_bf16 v[180:183], a[84:87], a[8:11], v[180:183]
    buffer_store_dwordx4 a[192:195], v2, s[24:27], s28 offen sc1
    v_mfma_f32_16x16x32_bf16 v[188:191], a[84:87], a[12:15], v[188:191]
    s_add_u32 s28, s28, s31
    v_mfma_f32_16x16x32_bf16 v[196:199], a[84:87], a[16:19], v[196:199]
    buffer_load_dwordx4 v17, s[40:43], s50 offen offset:1024 lds
    v_mfma_f32_16x16x32_bf16 v[204:207], a[84:87], a[20:23], v[204:207]
    s_add_u32 s50, s50, 128
    v_mfma_f32_16x16x32_bf16 v[212:215], a[84:87], a[24:27], v[212:215]
    s_cmp_ge_u32 s64, 98304
    s_cselect_b32 s63, 4294901760, s59
    s_cselect_b32 s64, 0, s64
    v_mfma_f32_16x16x32_bf16 v[220:223], a[84:87], a[28:31], v[220:223]
    ds_read_b64_tr_b16 a[84:85], v13 offset:16384
    v_mfma_f32_16x16x32_bf16 v[224:227], a[88:91], a[0:3], v[224:227]
    ds_read_b64_tr_b16 a[86:87], v13 offset:18432
    v_mfma_f32_16x16x32_bf16 v[232:235], a[88:91], a[4:7], v[232:235]
    v_mfma_f32_16x16x32_bf16 v[240:243], a[88:91], a[8:11], v[240:243]
    buffer_store_dwordx4 a[196:199], v2, s[24:27], s28 offen sc1
    v_mfma_f32_16x16x32_bf16 v[248:251], a[88:91], a[12:15], v[248:251]
    s_add_u32 s28, s28, s31
    v_mfma_f32_16x16x32_bf16 a[96:99], a[88:91], a[16:19], a[96:99]
    buffer_load_dwordx4 v16, s[40:43], s51 offen offset:2048 lds
    v_mfma_f32_16x16x32_bf16 a[104:107], a[88:91], a[20:23], a[104:107]
    v_mfma_f32_16x16x32_bf16 a[112:115], a[88:91], a[24:27], a[112:115]
    v_mfma_f32_16x16x32_bf16 a[120:123], a[88:91], a[28:31], a[120:123]
    ds_read_b64_tr_b16 a[88:89], v14 offset:16384
    s_waitcnt lgkmcnt(15)
    v_mfma_f32_16x16x32_bf16 v[228:231], a[92:95], a[0:3], v[228:231]
    ds_read_b64_tr_b16 a[90:91], v14 offset:18432
    v_mfma_f32_16x16x32_bf16 v[236:239], a[92:95], a[4:7], v[236:239]
    v_add_u32 v6, s63, v6
    v_add_u32 v7, s63, v7
    v_mfma_f32_16x16x32_bf16 v[244:247], a[92:95], a[8:11], v[244:247]
    buffer_store_dwordx4 a[200:203], v2, s[24:27], s28 offen sc1
    v_mfma_f32_16x16x32_bf16 v[252:255], a[92:95], a[12:15], v[252:255]
    s_add_u32 s28, s28, s31
    v_mfma_f32_16x16x32_bf16 a[100:103], a[92:95], a[16:19], a[100:103]
    buffer_load_dwordx4 v17, s[40:43], s51 offen offset:3072 lds
    v_mfma_f32_16x16x32_bf16 a[108:111], a[92:95], a[20:23], a[108:111]
    s_add_u32 s51, s51, 128
    v_mfma_f32_16x16x32_bf16 a[116:119], a[92:95], a[24:27], a[116:119]
    v_mfma_f32_16x16x32_bf16 a[124:127], a[92:95], a[28:31], a[124:127]
    ds_read_b64_tr_b16 a[92:93], v15 offset:16384
    ds_read_b64_tr_b16 a[94:95], v15 offset:18432
    v_mfma_f32_16x16x32_bf16 v[32:35], a[64:67], a[32:35], v[32:35]
    v_xor_b32 v8, s60, v8
    v_xor_b32 v9, s60, v9
    v_mfma_f32_16x16x32_bf16 v[40:43], a[64:67], a[36:39], v[40:43]
    v_xor_b32 v10, s60, v10
    v_xor_b32 v11, s60, v11
    s_waitcnt lgkmcnt(15)
    v_mfma_f32_16x16x32_bf16 v[48:51], a[64:67], a[40:43], v[48:51]
    v_xor_b32 v12, s60, v12
    v_xor_b32 v13, s60, v13
    v_mfma_f32_16x16x32_bf16 v[56:59], a[64:67], a[44:47], v[56:59]
    v_xor_b32 v14, s60, v14
    v_xor_b32 v15, s60, v15
    s_waitcnt lgkmcnt(13)
    v_mfma_f32_16x16x32_bf16 v[64:67], a[64:67], a[48:51], v[64:67]
    s_waitcnt lgkmcnt(12)
    v_mfma_f32_16x16x32_bf16 v[72:75], a[64:67], a[52:55], v[72:75]
    s_waitcnt lgkmcnt(9)
    v_mfma_f32_16x16x32_bf16 v[80:83], a[64:67], a[56:59], v[80:83]
    s_waitcnt vmcnt(16) lgkmcnt(0)
    v_mfma_f32_16x16x32_bf16 v[88:91], a[64:67], a[60:63], v[88:91]
    s_barrier
    ds_read_b64_tr_b16 a[64:65], v8 offset:0
    v_mfma_f32_16x16x32_bf16 v[36:39], a[68:71], a[32:35], v[36:39]
    s_add_u32 m0, s62, 0
    ds_read_b64_tr_b16 a[66:67], v8 offset:2048
    v_mfma_f32_16x16x32_bf16 v[44:47], a[68:71], a[36:39], v[44:47]
    buffer_load_dwordx4 v18, s[44:47], s52 offen offset:0 lds
    v_mfma_f32_16x16x32_bf16 v[52:55], a[68:71], a[40:43], v[52:55]
    ds_read_b128 a[0:3], v6 offset:0
    v_mfma_f32_16x16x32_bf16 v[60:63], a[68:71], a[44:47], v[60:63]
    v_mfma_f32_16x16x32_bf16 v[68:71], a[68:71], a[48:51], v[68:71]
    v_mfma_f32_16x16x32_bf16 v[76:79], a[68:71], a[52:55], v[76:79]
    buffer_load_dwordx4 v19, s[44:47], s52 offen offset:1024 lds
    v_mfma_f32_16x16x32_bf16 v[84:87], a[68:71], a[56:59], v[84:87]
    s_add_u32 s52, s52, s56
    ds_read_b128 a[4:7], v6 offset:2048
    v_mfma_f32_16x16x32_bf16 v[92:95], a[68:71], a[60:63], v[92:95]
    ds_read_b64_tr_b16 a[68:69], v9 offset:0
    v_mfma_f32_16x16x32_bf16 v[96:99], a[72:75], a[32:35], v[96:99]
    ds_read_b64_tr_b16 a[70:71], v9 offset:2048
    v_mfma_f32_16x16x32_bf16 v[104:107], a[72:75], a[36:39], v[104:107]
    buffer_load_dwordx4 v18, s[44:47], s53 offen offset:2048 lds
    v_mfma_f32_16x16x32_bf16 v[112:115], a[72:75], a[40:43], v[112:115]
    ds_read_b128 a[8:11], v6 offset:4096
    v_mfma_f32_16x16x32_bf16 v[120:123], a[72:75], a[44:47], v[120:123]
    v_mfma_f32_16x16x32_bf16 v[128:131], a[72:75], a[48:51], v[128:131]
    v_mfma_f32_16x16x32_bf16 v[136:139], a[72:75], a[52:55], v[136:139]
    buffer_load_dwordx4 v19, s[44:47], s53 offen offset:3072 lds
    v_mfma_f32_16x16x32_bf16 v[144:147], a[72:75], a[56:59], v[144:147]
    s_add_u32 s53, s53, s56
    ds_read_b128 a[12:15], v6 offset:6144
    v_mfma_f32_16x16x32_bf16 v[152:155], a[72:75], a[60:63], v[152:155]
    ds_read_b64_tr_b16 a[72:73], v10 offset:0
    v_mfma_f32_16x16x32_bf16 v[100:103], a[76:79], a[32:35], v[100:103]
    s_add_u32 m0, s62, 4096
    ds_read_b64_tr_b16 a[74:75], v10 offset:2048
    v_mfma_f32_16x16x32_bf16 v[108:111], a[76:79], a[36:39], v[108:111]
    buffer_load_dwordx4 v20, s[44:47], s54 offen offset:0 lds
    v_mfma_f32_16x16x32_bf16 v[116:119], a[76:79], a[40:43], v[116:119]
    ds_read_b128 a[16:19], v6 offset:8192
    v_mfma_f32_16x16x32_bf16 v[124:127], a[76:79], a[44:47], v[124:127]
    s_xor_b32 s62, s62, 229376
    v_mfma_f32_16x16x32_bf16 v[132:135], a[76:79], a[48:51], v[132:135]
    v_mfma_f32_16x16x32_bf16 v[140:143], a[76:79], a[52:55], v[140:143]
    buffer_load_dwordx4 v21, s[44:47], s54 offen offset:1024 lds
    v_mfma_f32_16x16x32_bf16 v[148:151], a[76:79], a[56:59], v[148:151]
    s_add_u32 s54, s54, s56
    ds_read_b128 a[20:23], v6 offset:10240
    v_mfma_f32_16x16x32_bf16 v[156:159], a[76:79], a[60:63], v[156:159]
    ds_read_b64_tr_b16 a[76:77], v11 offset:0
    v_mfma_f32_16x16x32_bf16 v[160:163], a[80:83], a[32:35], v[160:163]
    ds_read_b64_tr_b16 a[78:79], v11 offset:2048
    v_mfma_f32_16x16x32_bf16 v[168:171], a[80:83], a[36:39], v[168:171]
    buffer_load_dwordx4 v20, s[44:47], s55 offen offset:2048 lds
    v_mfma_f32_16x16x32_bf16 v[176:179], a[80:83], a[40:43], v[176:179]
    ds_read_b128 a[24:27], v6 offset:12288
    v_mfma_f32_16x16x32_bf16 v[184:187], a[80:83], a[44:47], v[184:187]
    v_mfma_f32_16x16x32_bf16 v[192:195], a[80:83], a[48:51], v[192:195]
    v_mfma_f32_16x16x32_bf16 v[200:203], a[80:83], a[52:55], v[200:203]
    buffer_load_dwordx4 v21, s[44:47], s55 offen offset:3072 lds
    v_mfma_f32_16x16x32_bf16 v[208:211], a[80:83], a[56:59], v[208:211]
    s_add_u32 s55, s55, s56
    ds_read_b128 a[28:31], v6 offset:14336
    v_mfma_f32_16x16x32_bf16 v[216:219], a[80:83], a[60:63], v[216:219]
    ds_read_b64_tr_b16 a[80:81], v12 offset:0
    v_mfma_f32_16x16x32_bf16 v[164:167], a[84:87], a[32:35], v[164:167]
    ds_read_b64_tr_b16 a[82:83], v12 offset:2048
    v_mfma_f32_16x16x32_bf16 v[172:175], a[84:87], a[36:39], v[172:175]
    v_mfma_f32_16x16x32_bf16 v[180:183], a[84:87], a[40:43], v[180:183]
    buffer_store_dwordx4 a[204:207], v2, s[24:27], s28 offen sc1
    v_mfma_f32_16x16x32_bf16 v[188:191], a[84:87], a[44:47], v[188:191]
    s_add_u32 s28, s28, s31
    v_mfma_f32_16x16x32_bf16 v[196:199], a[84:87], a[48:51], v[196:199]
    v_mfma_f32_16x16x32_bf16 v[204:207], a[84:87], a[52:55], v[204:207]
    v_mfma_f32_16x16x32_bf16 v[212:215], a[84:87], a[56:59], v[212:215]
    buffer_store_dwordx4 a[208:211], v2, s[24:27], s28 offen sc1
    v_mfma_f32_16x16x32_bf16 v[220:223], a[84:87], a[60:63], v[220:223]
    s_add_u32 s28, s28, s31
    ds_read_b64_tr_b16 a[84:85], v13 offset:0
    v_mfma_f32_16x16x32_bf16 v[224:227], a[88:91], a[32:35], v[224:227]
    ds_read_b64_tr_b16 a[86:87], v13 offset:2048
    v_mfma_f32_16x16x32_bf16 v[232:235], a[88:91], a[36:39], v[232:235]
    v_mfma_f32_16x16x32_bf16 v[240:243], a[88:91], a[40:43], v[240:243]
    buffer_store_dwordx4 a[212:215], v2, s[24:27], s28 offen sc1
    v_mfma_f32_16x16x32_bf16 v[248:251], a[88:91], a[44:47], v[248:251]
    s_add_u32 s28, s28, s31
    v_mfma_f32_16x16x32_bf16 a[96:99], a[88:91], a[48:51], a[96:99]
    v_mfma_f32_16x16x32_bf16 a[104:107], a[88:91], a[52:55], a[104:107]
    v_mfma_f32_16x16x32_bf16 a[112:115], a[88:91], a[56:59], a[112:115]
    buffer_store_dwordx4 a[216:219], v2, s[24:27], s28 offen sc1
    v_mfma_f32_16x16x32_bf16 a[120:123], a[88:91], a[60:63], a[120:123]
    s_add_u32 s28, s28, s31
    ds_read_b64_tr_b16 a[88:89], v14 offset:0
    v_mfma_f32_16x16x32_bf16 v[228:231], a[92:95], a[32:35], v[228:231]
    ds_read_b64_tr_b16 a[90:91], v14 offset:2048
    v_mfma_f32_16x16x32_bf16 v[236:239], a[92:95], a[36:39], v[236:239]
    v_mfma_f32_16x16x32_bf16 v[244:247], a[92:95], a[40:43], v[244:247]
    buffer_store_dwordx4 a[220:223], v2, s[24:27], s28 offen sc1
    v_mfma_f32_16x16x32_bf16 v[252:255], a[92:95], a[44:47], v[252:255]
    s_add_u32 s29, s29, s30
    s_mov_b32 s28, s29
    v_mfma_f32_16x16x32_bf16 a[100:103], a[92:95], a[48:51], a[100:103]
    s_sub_u32 s65, s65, 1
    v_mfma_f32_16x16x32_bf16 a[108:111], a[92:95], a[52:55], a[108:111]
    v_mfma_f32_16x16x32_bf16 a[116:119], a[92:95], a[56:59], a[116:119]
    v_mfma_f32_16x16x32_bf16 a[124:127], a[92:95], a[60:63], a[124:127]
    ds_read_b64_tr_b16 a[92:93], v15 offset:0
    ds_read_b64_tr_b16 a[94:95], v15 offset:2048
    s_waitcnt lgkmcnt(15)
    v_mfma_f32_16x16x32_bf16 v[32:35], a[64:67], a[0:3], v[32:35]
    v_mfma_f32_16x16x32_bf16 v[40:43], a[64:67], a[4:7], v[40:43]
    v_mfma_f32_16x16x32_bf16 v[48:51], a[64:67], a[8:11], v[48:51]
    v_mfma_f32_16x16x32_bf16 v[56:59], a[64:67], a[12:15], v[56:59]
    s_add_u32 m0, s61, 0
    s_waitcnt lgkmcnt(13)
    v_mfma_f32_16x16x32_bf16 v[64:67], a[64:67], a[16:19], v[64:67]
    buffer_load_dwordx4 v16, s[40:43], s48 offen offset:0 lds
    s_waitcnt lgkmcnt(12)
    v_mfma_f32_16x16x32_bf16 v[72:75], a[64:67], a[20:23], v[72:75]
    s_waitcnt lgkmcnt(9)
    v_mfma_f32_16x16x32_bf16 v[80:83], a[64:67], a[24:27], v[80:83]
    s_waitcnt lgkmcnt(8)
    v_mfma_f32_16x16x32_bf16 v[88:91], a[64:67], a[28:31], v[88:91]
    ds_read_b64_tr_b16 a[64:65], v8 offset:16384
    v_mfma_f32_16x16x32_bf16 v[36:39], a[68:71], a[0:3], v[36:39]
    ds_read_b64_tr_b16 a[66:67], v8 offset:18432
    v_mfma_f32_16x16x32_bf16 v[44:47], a[68:71], a[4:7], v[44:47]
    v_mfma_f32_16x16x32_bf16 v[52:55], a[68:71], a[8:11], v[52:55]
    ds_read_b128 a[32:35], v7 offset:0
    v_mfma_f32_16x16x32_bf16 v[60:63], a[68:71], a[12:15], v[60:63]
    v_mfma_f32_16x16x32_bf16 v[68:71], a[68:71], a[16:19], v[68:71]
    buffer_load_dwordx4 v17, s[40:43], s48 offen offset:1024 lds
    v_mfma_f32_16x16x32_bf16 v[76:79], a[68:71], a[20:23], v[76:79]
    s_add_u32 s48, s48, 128
    v_mfma_f32_16x16x32_bf16 v[84:87], a[68:71], a[24:27], v[84:87]
    ds_read_b128 a[36:39], v7 offset:2048
    v_mfma_f32_16x16x32_bf16 v[92:95], a[68:71], a[28:31], v[92:95]
    ds_read_b64_tr_b16 a[68:69], v9 offset:16384
    v_mfma_f32_16x16x32_bf16 v[96:99], a[72:75], a[0:3], v[96:99]
    ds_read_b64_tr_b16 a[70:71], v9 offset:18432
    v_mfma_f32_16x16x32_bf16 v[104:107], a[72:75], a[4:7], v[104:107]
    v_mfma_f32_16x16x32_bf16 v[112:115], a[72:75], a[8:11], v[112:115]
    ds_read_b128 a[40:43], v7 offset:4096
    v_mfma_f32_16x16x32_bf16 v[120:123], a[72:75], a[12:15], v[120:123]
    v_mfma_f32_16x16x32_bf16 v[128:131], a[72:75], a[16:19], v[128:131]
    buffer_load_dwordx4 v16, s[40:43], s49 offen offset:2048 lds
    v_mfma_f32_16x16x32_bf16 v[136:139], a[72:75], a[20:23], v[136:139]
    v_mfma_f32_16x16x32_bf16 v[144:147], a[72:75], a[24:27], v[144:147]
    ds_read_b128 a[44:47], v7 offset:6144
    v_mfma_f32_16x16x32_bf16 v[152:155], a[72:75], a[28:31], v[152:155]
    ds_read_b64_tr_b16 a[72:73], v10 offset:16384
    v_mfma_f32_16x16x32_bf16 v[100:103], a[76:79], a[0:3], v[100:103]
    ds_read_b64_tr_b16 a[74:75], v10 offset:18432
    v_mfma_f32_16x16x32_bf16 v[108:111], a[76:79], a[4:7], v[108:111]
    v_mfma_f32_16x16x32_bf16 v[116:119], a[76:79], a[8:11], v[116:119]
    ds_read_b128 a[48:51], v7 offset:8192
    v_mfma_f32_16x16x32_bf16 v[124:127], a[76:79], a[12:15], v[124:127]
    v_mfma_f32_16x16x32_bf16 v[132:135], a[76:79], a[16:19], v[132:135]
    buffer_load_dwordx4 v17, s[40:43], s49 offen offset:3072 lds
    v_mfma_f32_16x16x32_bf16 v[140:143], a[76:79], a[20:23], v[140:143]
    s_add_u32 s49, s49, 128
    v_mfma_f32_16x16x32_bf16 v[148:151], a[76:79], a[24:27], v[148:151]
    ds_read_b128 a[52:55], v7 offset:10240
    v_mfma_f32_16x16x32_bf16 v[156:159], a[76:79], a[28:31], v[156:159]
    ds_read_b64_tr_b16 a[76:77], v11 offset:16384
    s_waitcnt lgkmcnt(15)
    v_mfma_f32_16x16x32_bf16 v[160:163], a[80:83], a[0:3], v[160:163]
    ds_read_b64_tr_b16 a[78:79], v11 offset:18432
    v_mfma_f32_16x16x32_bf16 v[168:171], a[80:83], a[4:7], v[168:171]
    v_mfma_f32_16x16x32_bf16 v[176:179], a[80:83], a[8:11], v[176:179]
    ds_read_b128 a[56:59], v7 offset:12288
    v_mfma_f32_16x16x32_bf16 v[184:187], a[80:83], a[12:15], v[184:187]
    s_add_u32 m0, s61, 4096
    v_mfma_f32_16x16x32_bf16 v[192:195], a[80:83], a[16:19], v[192:195]
    buffer_load_dwordx4 v16, s[40:43], s50 offen offset:0 lds
    v_mfma_f32_16x16x32_bf16 v[200:203], a[80:83], a[20:23], v[200:203]
    v_mfma_f32_16x16x32_bf16 v[208:211], a[80:83], a[24:27], v[208:211]
    s_add_u32 s61, s61, 32768
    ds_read_b128 a[60:63], v7 offset:14336
    v_mfma_f32_16x16x32_bf16 v[216:219], a[80:83], a[28:31], v[216:219]
    s_cmp_ge_u32 s61, 98304
    s_cselect_b32 s90, 98304, 0
    ds_read_b64_tr_b16 a[80:81], v12 offset:16384
    v_mfma_f32_16x16x32_bf16 v[164:167], a[84:87], a[0:3], v[164:167]
    s_sub_u32 s61, s61, s90
    ds_read_b64_tr_b16 a[82:83], v12 offset:18432
    v_mfma_f32_16x16x32_bf16 v[172:175], a[84:87], a[4:7], v[172:175]
    s_add_u32 s64, s64, 32768
    v_mfma_f32_16x16x32_bf16 v[180:183], a[84:87], a[8:11], v[180:183]
    buffer_store_dwordx4 a[224:227], v2, s[24:27], s28 offen sc1
    v_mfma_f32_16x16x32_bf16 v[188:191], a[84:87], a[12:15], v[188:191]
    s_add_u32 s28, s28, s31
    v_mfma_f32_16x16x32_bf16 v[196:199], a[84:87], a[16:19], v[196:199]
    buffer_load_dwordx4 v17, s[40:43], s50 offen offset:1024 lds
    v_mfma_f32_16x16x32_bf16 v[204:207], a[84:87], a[20:23], v[204:207]
    s_add_u32 s50, s50, 128
    v_mfma_f32_16x16x32_bf16 v[212:215], a[84:87], a[24:27], v[212:215]
    s_cmp_ge_u32 s64, 98304
    s_cselect_b32 s63, 4294901760, s59
    s_cselect_b32 s64, 0, s64
    v_mfma_f32_16x16x32_bf16 v[220:223], a[84:87], a[28:31], v[220:223]
    ds_read_b64_tr_b16 a[84:85], v13 offset:16384
    v_mfma_f32_16x16x32_bf16 v[224:227], a[88:91], a[0:3], v[224:227]
    ds_read_b64_tr_b16 a[86:87], v13 offset:18432
    v_mfma_f32_16x16x32_bf16 v[232:235], a[88:91], a[4:7], v[232:235]
    v_mfma_f32_16x16x32_bf16 v[240:243], a[88:91], a[8:11], v[240:243]
    buffer_store_dwordx4 a[228:231], v2, s[24:27], s28 offen sc1
    v_mfma_f32_16x16x32_bf16 v[248:251], a[88:91], a[12:15], v[248:251]
    s_add_u32 s28, s28, s31
    v_mfma_f32_16x16x32_bf16 a[96:99], a[88:91], a[16:19], a[96:99]
    buffer_load_dwordx4 v16, s[40:43], s51 offen offset:2048 lds
    v_mfma_f32_16x16x32_bf16 a[104:107], a[88:91], a[20:23], a[104:107]
    v_mfma_f32_16x16x32_bf16 a[112:115], a[88:91], a[24:27], a[112:115]
    v_mfma_f32_16x16x32_bf16 a[120:123], a[88:91], a[28:31], a[120:123]
    ds_read_b64_tr_b16 a[88:89], v14 offset:16384
    s_waitcnt lgkmcnt(15)
    v_mfma_f32_16x16x32_bf16 v[228:231], a[92:95], a[0:3], v[228:231]
    ds_read_b64_tr_b16 a[90:91], v14 offset:18432
    v_mfma_f32_16x16x32_bf16 v[236:239], a[92:95], a[4:7], v[236:239]
    v_add_u32 v6, s63, v6
    v_add_u32 v7, s63, v7
    v_mfma_f32_16x16x32_bf16 v[244:247], a[92:95], a[8:11], v[244:247]
    buffer_store_dwordx4 a[232:235], v2, s[24:27], s28 offen sc1
    v_mfma_f32_16x16x32_bf16 v[252:255], a[92:95], a[12:15], v[252:255]
    s_add_u32 s28, s28, s31
    v_mfma_f32_16x16x32_bf16 a[100:103], a[92:95], a[16:19], a[100:103]
    buffer_load_dwordx4 v17, s[40:43], s51 offen offset:3072 lds
    v_mfma_f32_16x16x32_bf16 a[108:111], a[92:95], a[20:23], a[108:111]
    s_add_u32 s51, s51, 128
    v_mfma_f32_16x16x32_bf16 a[116:119], a[92:95], a[24:27], a[116:119]
    v_mfma_f32_16x16x32_bf16 a[124:127], a[92:95], a[28:31], a[124:127]
    ds_read_b64_tr_b16 a[92:93], v15 offset:16384
    ds_read_b64_tr_b16 a[94:95], v15 offset:18432
    v_mfma_f32_16x16x32_bf16 v[32:35], a[64:67], a[32:35], v[32:35]
    v_xor_b32 v8, s60, v8
    v_xor_b32 v9, s60, v9
    v_mfma_f32_16x16x32_bf16 v[40:43], a[64:67], a[36:39], v[40:43]
    v_xor_b32 v10, s60, v10
    v_xor_b32 v11, s60, v11
    s_waitcnt lgkmcnt(15)
    v_mfma_f32_16x16x32_bf16 v[48:51], a[64:67], a[40:43], v[48:51]
    v_xor_b32 v12, s60, v12
    v_xor_b32 v13, s60, v13
    v_mfma_f32_16x16x32_bf16 v[56:59], a[64:67], a[44:47], v[56:59]
    v_xor_b32 v14, s60, v14
    v_xor_b32 v15, s60, v15
    s_waitcnt lgkmcnt(13)
    v_mfma_f32_16x16x32_bf16 v[64:67], a[64:67], a[48:51], v[64:67]
    s_waitcnt lgkmcnt(12)
    v_mfma_f32_16x16x32_bf16 v[72:75], a[64:67], a[52:55], v[72:75]
    s_waitcnt lgkmcnt(9)
    v_mfma_f32_16x16x32_bf16 v[80:83], a[64:67], a[56:59], v[80:83]
    s_waitcnt vmcnt(16) lgkmcnt(0)
    v_mfma_f32_16x16x32_bf16 v[88:91], a[64:67], a[60:63], v[88:91]
    s_barrier
    ds_read_b64_tr_b16 a[64:65], v8 offset:0
    v_mfma_f32_16x16x32_bf16 v[36:39], a[68:71], a[32:35], v[36:39]
    s_add_u32 m0, s62, 0
    ds_read_b64_tr_b16 a[66:67], v8 offset:2048
    v_mfma_f32_16x16x32_bf16 v[44:47], a[68:71], a[36:39], v[44:47]
    buffer_load_dwordx4 v18, s[44:47], s52 offen offset:0 lds
    v_mfma_f32_16x16x32_bf16 v[52:55], a[68:71], a[40:43], v[52:55]
    ds_read_b128 a[0:3], v6 offset:0
    v_mfma_f32_16x16x32_bf16 v[60:63], a[68:71], a[44:47], v[60:63]
    v_mfma_f32_16x16x32_bf16 v[68:71], a[68:71], a[48:51], v[68:71]
    v_mfma_f32_16x16x32_bf16 v[76:79], a[68:71], a[52:55], v[76:79]
    buffer_load_dwordx4 v19, s[44:47], s52 offen offset:1024 lds
    v_mfma_f32_16x16x32_bf16 v[84:87], a[68:71], a[56:59], v[84:87]
    s_add_u32 s52, s52, s56
    ds_read_b128 a[4:7], v6 offset:2048
    v_mfma_f32_16x16x32_bf16 v[92:95], a[68:71], a[60:63], v[92:95]
    ds_read_b64_tr_b16 a[68:69], v9 offset:0
    v_mfma_f32_16x16x32_bf16 v[96:99], a[72:75], a[32:35], v[96:99]
    ds_read_b64_tr_b16 a[70:71], v9 offset:2048
    v_mfma_f32_16x16x32_bf16 v[104:107], a[72:75], a[36:39], v[104:107]
    buffer_load_dwordx4 v18, s[44:47], s53 offen offset:2048 lds
    v_mfma_f32_16x16x32_bf16 v[112:115], a[72:75], a[40:43], v[112:115]
    ds_read_b128 a[8:11], v6 offset:4096
    v_mfma_f32_16x16x32_bf16 v[120:123], a[72:75], a[44:47], v[120:123]
    v_mfma_f32_16x16x32_bf16 v[128:131], a[72:75], a[48:51], v[128:131]
    v_mfma_f32_16x16x32_bf16 v[136:139], a[72:75], a[52:55], v[136:139]
    buffer_load_dwordx4 v19, s[44:47], s53 offen offset:3072 lds
    v_mfma_f32_16x16x32_bf16 v[144:147], a[72:75], a[56:59], v[144:147]
    s_add_u32 s53, s53, s56
    ds_read_b128 a[12:15], v6 offset:6144
    v_mfma_f32_16x16x32_bf16 v[152:155], a[72:75], a[60:63], v[152:155]
    ds_read_b64_tr_b16 a[72:73], v10 offset:0
    v_mfma_f32_16x16x32_bf16 v[100:103], a[76:79], a[32:35], v[100:103]
    s_add_u32 m0, s62, 4096
    ds_read_b64_tr_b16 a[74:75], v10 offset:2048
    v_mfma_f32_16x16x32_bf16 v[108:111], a[76:79], a[36:39], v[108:111]
    buffer_load_dwordx4 v20, s[44:47], s54 offen offset:0 lds
    v_mfma_f32_16x16x32_bf16 v[116:119], a[76:79], a[40:43], v[116:119]
    ds_read_b128 a[16:19], v6 offset:8192
    v_mfma_f32_16x16x32_bf16 v[124:127], a[76:79], a[44:47], v[124:127]
    s_xor_b32 s62, s62, 229376
    v_mfma_f32_16x16x32_bf16 v[132:135], a[76:79], a[48:51], v[132:135]
    v_mfma_f32_16x16x32_bf16 v[140:143], a[76:79], a[52:55], v[140:143]
    buffer_load_dwordx4 v21, s[44:47], s54 offen offset:1024 lds
    v_mfma_f32_16x16x32_bf16 v[148:151], a[76:79], a[56:59], v[148:151]
    s_add_u32 s54, s54, s56
    ds_read_b128 a[20:23], v6 offset:10240
    v_mfma_f32_16x16x32_bf16 v[156:159], a[76:79], a[60:63], v[156:159]
    ds_read_b64_tr_b16 a[76:77], v11 offset:0
    v_mfma_f32_16x16x32_bf16 v[160:163], a[80:83], a[32:35], v[160:163]
    ds_read_b64_tr_b16 a[78:79], v11 offset:2048
    v_mfma_f32_16x16x32_bf16 v[168:171], a[80:83], a[36:39], v[168:171]
    buffer_load_dwordx4 v20, s[44:47], s55 offen offset:2048 lds
    v_mfma_f32_16x16x32_bf16 v[176:179], a[80:83], a[40:43], v[176:179]
    ds_read_b128 a[24:27], v6 offset:12288
    v_mfma_f32_16x16x32_bf16 v[184:187], a[80:83], a[44:47], v[184:187]
    v_mfma_f32_16x16x32_bf16 v[192:195], a[80:83], a[48:51], v[192:195]
    v_mfma_f32_16x16x32_bf16 v[200:203], a[80:83], a[52:55], v[200:203]
    buffer_load_dwordx4 v21, s[44:47], s55 offen offset:3072 lds
    v_mfma_f32_16x16x32_bf16 v[208:211], a[80:83], a[56:59], v[208:211]
    s_add_u32 s55, s55, s56
    ds_read_b128 a[28:31], v6 offset:14336
    v_mfma_f32_16x16x32_bf16 v[216:219], a[80:83], a[60:63], v[216:219]
    ds_read_b64_tr_b16 a[80:81], v12 offset:0
    v_mfma_f32_16x16x32_bf16 v[164:167], a[84:87], a[32:35], v[164:167]
    ds_read_b64_tr_b16 a[82:83], v12 offset:2048
    v_mfma_f32_16x16x32_bf16 v[172:175], a[84:87], a[36:39], v[172:175]
    v_mfma_f32_16x16x32_bf16 v[180:183], a[84:87], a[40:43], v[180:183]
    buffer_store_dwordx4 a[236:239], v2, s[24:27], s28 offen sc1
    v_mfma_f32_16x16x32_bf16 v[188:191], a[84:87], a[44:47], v[188:191]
    s_add_u32 s28, s28, s31
    v_mfma_f32_16x16x32_bf16 v[196:199], a[84:87], a[48:51], v[196:199]
    v_mfma_f32_16x16x32_bf16 v[204:207], a[84:87], a[52:55], v[204:207]
    v_mfma_f32_16x16x32_bf16 v[212:215], a[84:87], a[56:59], v[212:215]
    buffer_store_dwordx4 a[240:243], v2, s[24:27], s28 offen sc1
    v_mfma_f32_16x16x32_bf16 v[220:223], a[84:87], a[60:63], v[220:223]
    s_add_u32 s28, s28, s31
    ds_read_b64_tr_b16 a[84:85], v13 offset:0
    v_mfma_f32_16x16x32_bf16 v[224:227], a[88:91], a[32:35], v[224:227]
    ds_read_b64_tr_b16 a[86:87], v13 offset:2048
    v_mfma_f32_16x16x32_bf16 v[232:235], a[88:91], a[36:39], v[232:235]
    v_mfma_f32_16x16x32_bf16 v[240:243], a[88:91], a[40:43], v[240:243]
    buffer_store_dwordx4 a[244:247], v2, s[24:27], s28 offen sc1
    v_mfma_f32_16x16x32_bf16 v[248:251], a[88:91], a[44:47], v[248:251]
    s_add_u32 s28, s28, s31
    v_mfma_f32_16x16x32_bf16 a[96:99], a[88:91], a[48:51], a[96:99]
    v_mfma_f32_16x16x32_bf16 a[104:107], a[88:91], a[52:55], a[104:107]
    v_mfma_f32_16x16x32_bf16 a[112:115], a[88:91], a[56:59], a[112:115]
    buffer_store_dwordx4 a[248:251], v2, s[24:27], s28 offen sc1
    v_mfma_f32_16x16x32_bf16 a[120:123], a[88:91], a[60:63], a[120:123]
    s_add_u32 s28, s28, s31
    ds_read_b64_tr_b16 a[88:89], v14 offset:0
    v_mfma_f32_16x16x32_bf16 v[228:231], a[92:95], a[32:35], v[228:231]
    ds_read_b64_tr_b16 a[90:91], v14 offset:2048
    v_mfma_f32_16x16x32_bf16 v[236:239], a[92:95], a[36:39], v[236:239]
    v_mfma_f32_16x16x32_bf16 v[244:247], a[92:95], a[40:43], v[244:247]
    buffer_store_dwordx4 a[252:255], v2, s[24:27], s28 offen sc1
    v_mfma_f32_16x16x32_bf16 v[252:255], a[92:95], a[44:47], v[252:255]
    s_add_u32 s29, s29, s30
    s_mov_b32 s28, s29
    v_mfma_f32_16x16x32_bf16 a[100:103], a[92:95], a[48:51], a[100:103]
    s_sub_u32 s65, s65, 1
    v_mfma_f32_16x16x32_bf16 a[108:111], a[92:95], a[52:55], a[108:111]
    v_mfma_f32_16x16x32_bf16 a[116:119], a[92:95], a[56:59], a[116:119]
    v_mfma_f32_16x16x32_bf16 a[124:127], a[92:95], a[60:63], a[124:127]
    ds_read_b64_tr_b16 a[92:93], v15 offset:0
    ds_read_b64_tr_b16 a[94:95], v15 offset:2048
mega_kernel_loop13:
    s_waitcnt lgkmcnt(15)
    v_mfma_f32_16x16x32_bf16 v[32:35], a[64:67], a[0:3], v[32:35]
    v_mfma_f32_16x16x32_bf16 v[40:43], a[64:67], a[4:7], v[40:43]
    v_mfma_f32_16x16x32_bf16 v[48:51], a[64:67], a[8:11], v[48:51]
    v_mfma_f32_16x16x32_bf16 v[56:59], a[64:67], a[12:15], v[56:59]
    s_add_u32 m0, s61, 0
    s_waitcnt lgkmcnt(13)
    v_mfma_f32_16x16x32_bf16 v[64:67], a[64:67], a[16:19], v[64:67]
    buffer_load_dwordx4 v16, s[40:43], s48 offen offset:0 lds
    s_waitcnt lgkmcnt(12)
    v_mfma_f32_16x16x32_bf16 v[72:75], a[64:67], a[20:23], v[72:75]
    s_waitcnt lgkmcnt(9)
    v_mfma_f32_16x16x32_bf16 v[80:83], a[64:67], a[24:27], v[80:83]
    s_waitcnt lgkmcnt(8)
    v_mfma_f32_16x16x32_bf16 v[88:91], a[64:67], a[28:31], v[88:91]
    ds_read_b64_tr_b16 a[64:65], v8 offset:16384
    v_mfma_f32_16x16x32_bf16 v[36:39], a[68:71], a[0:3], v[36:39]
    ds_read_b64_tr_b16 a[66:67], v8 offset:18432
    v_mfma_f32_16x16x32_bf16 v[44:47], a[68:71], a[4:7], v[44:47]
    v_mfma_f32_16x16x32_bf16 v[52:55], a[68:71], a[8:11], v[52:55]
    ds_read_b128 a[32:35], v7 offset:0
    v_mfma_f32_16x16x32_bf16 v[60:63], a[68:71], a[12:15], v[60:63]
    v_mfma_f32_16x16x32_bf16 v[68:71], a[68:71], a[16:19], v[68:71]
    buffer_load_dwordx4 v17, s[40:43], s48 offen offset:1024 lds
    v_mfma_f32_16x16x32_bf16 v[76:79], a[68:71], a[20:23], v[76:79]
    s_add_u32 s48, s48, 128
    v_mfma_f32_16x16x32_bf16 v[84:87], a[68:71], a[24:27], v[84:87]
    ds_read_b128 a[36:39], v7 offset:2048
    v_mfma_f32_16x16x32_bf16 v[92:95], a[68:71], a[28:31], v[92:95]
    ds_read_b64_tr_b16 a[68:69], v9 offset:16384
    v_mfma_f32_16x16x32_bf16 v[96:99], a[72:75], a[0:3], v[96:99]
    ds_read_b64_tr_b16 a[70:71], v9 offset:18432
    v_mfma_f32_16x16x32_bf16 v[104:107], a[72:75], a[4:7], v[104:107]
    v_mfma_f32_16x16x32_bf16 v[112:115], a[72:75], a[8:11], v[112:115]
    ds_read_b128 a[40:43], v7 offset:4096
    v_mfma_f32_16x16x32_bf16 v[120:123], a[72:75], a[12:15], v[120:123]
    v_mfma_f32_16x16x32_bf16 v[128:131], a[72:75], a[16:19], v[128:131]
    buffer_load_dwordx4 v16, s[40:43], s49 offen offset:2048 lds
    v_mfma_f32_16x16x32_bf16 v[136:139], a[72:75], a[20:23], v[136:139]
    v_mfma_f32_16x16x32_bf16 v[144:147], a[72:75], a[24:27], v[144:147]
    ds_read_b128 a[44:47], v7 offset:6144
    v_mfma_f32_16x16x32_bf16 v[152:155], a[72:75], a[28:31], v[152:155]
    ds_read_b64_tr_b16 a[72:73], v10 offset:16384
    v_mfma_f32_16x16x32_bf16 v[100:103], a[76:79], a[0:3], v[100:103]
    ds_read_b64_tr_b16 a[74:75], v10 offset:18432
    v_mfma_f32_16x16x32_bf16 v[108:111], a[76:79], a[4:7], v[108:111]
    v_mfma_f32_16x16x32_bf16 v[116:119], a[76:79], a[8:11], v[116:119]
    ds_read_b128 a[48:51], v7 offset:8192
    v_mfma_f32_16x16x32_bf16 v[124:127], a[76:79], a[12:15], v[124:127]
    v_mfma_f32_16x16x32_bf16 v[132:135], a[76:79], a[16:19], v[132:135]
    buffer_load_dwordx4 v17, s[40:43], s49 offen offset:3072 lds
    v_mfma_f32_16x16x32_bf16 v[140:143], a[76:79], a[20:23], v[140:143]
    s_add_u32 s49, s49, 128
    v_mfma_f32_16x16x32_bf16 v[148:151], a[76:79], a[24:27], v[148:151]
    ds_read_b128 a[52:55], v7 offset:10240
    v_mfma_f32_16x16x32_bf16 v[156:159], a[76:79], a[28:31], v[156:159]
    ds_read_b64_tr_b16 a[76:77], v11 offset:16384
    s_waitcnt lgkmcnt(15)
    v_mfma_f32_16x16x32_bf16 v[160:163], a[80:83], a[0:3], v[160:163]
    ds_read_b64_tr_b16 a[78:79], v11 offset:18432
    v_mfma_f32_16x16x32_bf16 v[168:171], a[80:83], a[4:7], v[168:171]
    v_mfma_f32_16x16x32_bf16 v[176:179], a[80:83], a[8:11], v[176:179]
    ds_read_b128 a[56:59], v7 offset:12288
    v_mfma_f32_16x16x32_bf16 v[184:187], a[80:83], a[12:15], v[184:187]
    s_add_u32 m0, s61, 4096
    v_mfma_f32_16x16x32_bf16 v[192:195], a[80:83], a[16:19], v[192:195]
    buffer_load_dwordx4 v16, s[40:43], s50 offen offset:0 lds
    v_mfma_f32_16x16x32_bf16 v[200:203], a[80:83], a[20:23], v[200:203]
    v_mfma_f32_16x16x32_bf16 v[208:211], a[80:83], a[24:27], v[208:211]
    s_add_u32 s61, s61, 32768
    ds_read_b128 a[60:63], v7 offset:14336
    v_mfma_f32_16x16x32_bf16 v[216:219], a[80:83], a[28:31], v[216:219]
    s_cmp_ge_u32 s61, 98304
    s_cselect_b32 s90, 98304, 0
    ds_read_b64_tr_b16 a[80:81], v12 offset:16384
    v_mfma_f32_16x16x32_bf16 v[164:167], a[84:87], a[0:3], v[164:167]
    s_sub_u32 s61, s61, s90
    ds_read_b64_tr_b16 a[82:83], v12 offset:18432
    v_mfma_f32_16x16x32_bf16 v[172:175], a[84:87], a[4:7], v[172:175]
    s_add_u32 s64, s64, 32768
    v_mfma_f32_16x16x32_bf16 v[180:183], a[84:87], a[8:11], v[180:183]
    s_cmp_ge_u32 s64, 98304
    s_cselect_b32 s63, 4294901760, s59
    s_cselect_b32 s64, 0, s64
    v_mfma_f32_16x16x32_bf16 v[188:191], a[84:87], a[12:15], v[188:191]
    v_mfma_f32_16x16x32_bf16 v[196:199], a[84:87], a[16:19], v[196:199]
    buffer_load_dwordx4 v17, s[40:43], s50 offen offset:1024 lds
    v_mfma_f32_16x16x32_bf16 v[204:207], a[84:87], a[20:23], v[204:207]
    s_add_u32 s50, s50, 128
    v_mfma_f32_16x16x32_bf16 v[212:215], a[84:87], a[24:27], v[212:215]
    v_mfma_f32_16x16x32_bf16 v[220:223], a[84:87], a[28:31], v[220:223]
    ds_read_b64_tr_b16 a[84:85], v13 offset:16384
    v_mfma_f32_16x16x32_bf16 v[224:227], a[88:91], a[0:3], v[224:227]
    ds_read_b64_tr_b16 a[86:87], v13 offset:18432
    v_mfma_f32_16x16x32_bf16 v[232:235], a[88:91], a[4:7], v[232:235]
    v_mfma_f32_16x16x32_bf16 v[240:243], a[88:91], a[8:11], v[240:243]
    v_mfma_f32_16x16x32_bf16 v[248:251], a[88:91], a[12:15], v[248:251]
    v_mfma_f32_16x16x32_bf16 a[96:99], a[88:91], a[16:19], a[96:99]
    buffer_load_dwordx4 v16, s[40:43], s51 offen offset:2048 lds
    v_mfma_f32_16x16x32_bf16 a[104:107], a[88:91], a[20:23], a[104:107]
    v_mfma_f32_16x16x32_bf16 a[112:115], a[88:91], a[24:27], a[112:115]
    v_mfma_f32_16x16x32_bf16 a[120:123], a[88:91], a[28:31], a[120:123]
    ds_read_b64_tr_b16 a[88:89], v14 offset:16384
    s_waitcnt lgkmcnt(15)
    v_mfma_f32_16x16x32_bf16 v[228:231], a[92:95], a[0:3], v[228:231]
    ds_read_b64_tr_b16 a[90:91], v14 offset:18432
    v_mfma_f32_16x16x32_bf16 v[236:239], a[92:95], a[4:7], v[236:239]
    v_add_u32 v6, s63, v6
    v_add_u32 v7, s63, v7
    v_mfma_f32_16x16x32_bf16 v[244:247], a[92:95], a[8:11], v[244:247]
    v_mfma_f32_16x16x32_bf16 v[252:255], a[92:95], a[12:15], v[252:255]
    v_mfma_f32_16x16x32_bf16 a[100:103], a[92:95], a[16:19], a[100:103]
    buffer_load_dwordx4 v17, s[40:43], s51 offen offset:3072 lds
    v_mfma_f32_16x16x32_bf16 a[108:111], a[92:95], a[20:23], a[108:111]
    s_add_u32 s51, s51, 128
    v_mfma_f32_16x16x32_bf16 a[116:119], a[92:95], a[24:27], a[116:119]
    v_mfma_f32_16x16x32_bf16 a[124:127], a[92:95], a[28:31], a[124:127]
    ds_read_b64_tr_b16 a[92:93], v15 offset:16384
    ds_read_b64_tr_b16 a[94:95], v15 offset:18432
    v_mfma_f32_16x16x32_bf16 v[32:35], a[64:67], a[32:35], v[32:35]
    v_xor_b32 v8, s60, v8
    v_xor_b32 v9, s60, v9
    v_mfma_f32_16x16x32_bf16 v[40:43], a[64:67], a[36:39], v[40:43]
    v_xor_b32 v10, s60, v10
    v_xor_b32 v11, s60, v11
    s_waitcnt lgkmcnt(15)
    v_mfma_f32_16x16x32_bf16 v[48:51], a[64:67], a[40:43], v[48:51]
    v_xor_b32 v12, s60, v12
    v_xor_b32 v13, s60, v13
    v_mfma_f32_16x16x32_bf16 v[56:59], a[64:67], a[44:47], v[56:59]
    v_xor_b32 v14, s60, v14
    v_xor_b32 v15, s60, v15
    s_waitcnt lgkmcnt(13)
    v_mfma_f32_16x16x32_bf16 v[64:67], a[64:67], a[48:51], v[64:67]
    s_waitcnt lgkmcnt(12)
    v_mfma_f32_16x16x32_bf16 v[72:75], a[64:67], a[52:55], v[72:75]
    s_waitcnt lgkmcnt(9)
    v_mfma_f32_16x16x32_bf16 v[80:83], a[64:67], a[56:59], v[80:83]
    s_waitcnt vmcnt(8) lgkmcnt(0)
    v_mfma_f32_16x16x32_bf16 v[88:91], a[64:67], a[60:63], v[88:91]
    s_barrier
    ds_read_b64_tr_b16 a[64:65], v8 offset:0
    v_mfma_f32_16x16x32_bf16 v[36:39], a[68:71], a[32:35], v[36:39]
    s_add_u32 m0, s62, 0
    ds_read_b64_tr_b16 a[66:67], v8 offset:2048
    v_mfma_f32_16x16x32_bf16 v[44:47], a[68:71], a[36:39], v[44:47]
    buffer_load_dwordx4 v18, s[44:47], s52 offen offset:0 lds
    v_mfma_f32_16x16x32_bf16 v[52:55], a[68:71], a[40:43], v[52:55]
    ds_read_b128 a[0:3], v6 offset:0
    v_mfma_f32_16x16x32_bf16 v[60:63], a[68:71], a[44:47], v[60:63]
    v_mfma_f32_16x16x32_bf16 v[68:71], a[68:71], a[48:51], v[68:71]
    v_mfma_f32_16x16x32_bf16 v[76:79], a[68:71], a[52:55], v[76:79]
    buffer_load_dwordx4 v19, s[44:47], s52 offen offset:1024 lds
    v_mfma_f32_16x16x32_bf16 v[84:87], a[68:71], a[56:59], v[84:87]
    s_add_u32 s52, s52, s56
    ds_read_b128 a[4:7], v6 offset:2048
    v_mfma_f32_16x16x32_bf16 v[92:95], a[68:71], a[60:63], v[92:95]
    ds_read_b64_tr_b16 a[68:69], v9 offset:0
    v_mfma_f32_16x16x32_bf16 v[96:99], a[72:75], a[32:35], v[96:99]
    ds_read_b64_tr_b16 a[70:71], v9 offset:2048
    v_mfma_f32_16x16x32_bf16 v[104:107], a[72:75], a[36:39], v[104:107]
    buffer_load_dwordx4 v18, s[44:47], s53 offen offset:2048 lds
    v_mfma_f32_16x16x32_bf16 v[112:115], a[72:75], a[40:43], v[112:115]
    ds_read_b128 a[8:11], v6 offset:4096
    v_mfma_f32_16x16x32_bf16 v[120:123], a[72:75], a[44:47], v[120:123]
    v_mfma_f32_16x16x32_bf16 v[128:131], a[72:75], a[48:51], v[128:131]
    v_mfma_f32_16x16x32_bf16 v[136:139], a[72:75], a[52:55], v[136:139]
    buffer_load_dwordx4 v19, s[44:47], s53 offen offset:3072 lds
    v_mfma_f32_16x16x32_bf16 v[144:147], a[72:75], a[56:59], v[144:147]
    s_add_u32 s53, s53, s56
    ds_read_b128 a[12:15], v6 offset:6144
    v_mfma_f32_16x16x32_bf16 v[152:155], a[72:75], a[60:63], v[152:155]
    ds_read_b64_tr_b16 a[72:73], v10 offset:0
    v_mfma_f32_16x16x32_bf16 v[100:103], a[76:79], a[32:35], v[100:103]
    s_add_u32 m0, s62, 4096
    ds_read_b64_tr_b16 a[74:75], v10 offset:2048
    v_mfma_f32_16x16x32_bf16 v[108:111], a[76:79], a[36:39], v[108:111]
    buffer_load_dwordx4 v20, s[44:47], s54 offen offset:0 lds
    v_mfma_f32_16x16x32_bf16 v[116:119], a[76:79], a[40:43], v[116:119]
    ds_read_b128 a[16:19], v6 offset:8192
    v_mfma_f32_16x16x32_bf16 v[124:127], a[76:79], a[44:47], v[124:127]
    s_xor_b32 s62, s62, 229376
    v_mfma_f32_16x16x32_bf16 v[132:135], a[76:79], a[48:51], v[132:135]
    v_mfma_f32_16x16x32_bf16 v[140:143], a[76:79], a[52:55], v[140:143]
    buffer_load_dwordx4 v21, s[44:47], s54 offen offset:1024 lds
    v_mfma_f32_16x16x32_bf16 v[148:151], a[76:79], a[56:59], v[148:151]
    s_add_u32 s54, s54, s56
    ds_read_b128 a[20:23], v6 offset:10240
    v_mfma_f32_16x16x32_bf16 v[156:159], a[76:79], a[60:63], v[156:159]
    ds_read_b64_tr_b16 a[76:77], v11 offset:0
    v_mfma_f32_16x16x32_bf16 v[160:163], a[80:83], a[32:35], v[160:163]
    ds_read_b64_tr_b16 a[78:79], v11 offset:2048
    v_mfma_f32_16x16x32_bf16 v[168:171], a[80:83], a[36:39], v[168:171]
    buffer_load_dwordx4 v20, s[44:47], s55 offen offset:2048 lds
    v_mfma_f32_16x16x32_bf16 v[176:179], a[80:83], a[40:43], v[176:179]
    ds_read_b128 a[24:27], v6 offset:12288
    v_mfma_f32_16x16x32_bf16 v[184:187], a[80:83], a[44:47], v[184:187]
    v_mfma_f32_16x16x32_bf16 v[192:195], a[80:83], a[48:51], v[192:195]
    v_mfma_f32_16x16x32_bf16 v[200:203], a[80:83], a[52:55], v[200:203]
    buffer_load_dwordx4 v21, s[44:47], s55 offen offset:3072 lds
    v_mfma_f32_16x16x32_bf16 v[208:211], a[80:83], a[56:59], v[208:211]
    s_add_u32 s55, s55, s56
    ds_read_b128 a[28:31], v6 offset:14336
    v_mfma_f32_16x16x32_bf16 v[216:219], a[80:83], a[60:63], v[216:219]
    ds_read_b64_tr_b16 a[80:81], v12 offset:0
    v_mfma_f32_16x16x32_bf16 v[164:167], a[84:87], a[32:35], v[164:167]
    ds_read_b64_tr_b16 a[82:83], v12 offset:2048
    v_mfma_f32_16x16x32_bf16 v[172:175], a[84:87], a[36:39], v[172:175]
    v_mfma_f32_16x16x32_bf16 v[180:183], a[84:87], a[40:43], v[180:183]
    v_mfma_f32_16x16x32_bf16 v[188:191], a[84:87], a[44:47], v[188:191]
    v_mfma_f32_16x16x32_bf16 v[196:199], a[84:87], a[48:51], v[196:199]
    v_mfma_f32_16x16x32_bf16 v[204:207], a[84:87], a[52:55], v[204:207]
    v_mfma_f32_16x16x32_bf16 v[212:215], a[84:87], a[56:59], v[212:215]
    v_mfma_f32_16x16x32_bf16 v[220:223], a[84:87], a[60:63], v[220:223]
    ds_read_b64_tr_b16 a[84:85], v13 offset:0
    v_mfma_f32_16x16x32_bf16 v[224:227], a[88:91], a[32:35], v[224:227]
    ds_read_b64_tr_b16 a[86:87], v13 offset:2048
    v_mfma_f32_16x16x32_bf16 v[232:235], a[88:91], a[36:39], v[232:235]
    v_mfma_f32_16x16x32_bf16 v[240:243], a[88:91], a[40:43], v[240:243]
    v_mfma_f32_16x16x32_bf16 v[248:251], a[88:91], a[44:47], v[248:251]
    v_mfma_f32_16x16x32_bf16 a[96:99], a[88:91], a[48:51], a[96:99]
    v_mfma_f32_16x16x32_bf16 a[104:107], a[88:91], a[52:55], a[104:107]
    v_mfma_f32_16x16x32_bf16 a[112:115], a[88:91], a[56:59], a[112:115]
    v_mfma_f32_16x16x32_bf16 a[120:123], a[88:91], a[60:63], a[120:123]
    ds_read_b64_tr_b16 a[88:89], v14 offset:0
    v_mfma_f32_16x16x32_bf16 v[228:231], a[92:95], a[32:35], v[228:231]
    ds_read_b64_tr_b16 a[90:91], v14 offset:2048
    v_mfma_f32_16x16x32_bf16 v[236:239], a[92:95], a[36:39], v[236:239]
    v_mfma_f32_16x16x32_bf16 v[244:247], a[92:95], a[40:43], v[244:247]
    v_mfma_f32_16x16x32_bf16 v[252:255], a[92:95], a[44:47], v[252:255]
    v_mfma_f32_16x16x32_bf16 a[100:103], a[92:95], a[48:51], a[100:103]
    s_sub_u32 s65, s65, 1
    v_mfma_f32_16x16x32_bf16 a[108:111], a[92:95], a[52:55], a[108:111]
    v_mfma_f32_16x16x32_bf16 a[116:119], a[92:95], a[56:59], a[116:119]
    s_cmp_gt_u32 s65, s67
    v_mfma_f32_16x16x32_bf16 a[124:127], a[92:95], a[60:63], a[124:127]
    ds_read_b64_tr_b16 a[92:93], v15 offset:0
    ds_read_b64_tr_b16 a[94:95], v15 offset:2048
    s_cbranch_scc1 mega_kernel_loop13
    s_cmp_lg_u32 s65, 0
    s_cbranch_scc1 mega_kernel_dosw14
    s_branch mega_kernel_epi11
mega_kernel_swp12:
    s_waitcnt lgkmcnt(15)
    v_mfma_f32_16x16x32_bf16 v[32:35], a[0:3], a[64:67], 0
    v_mfma_f32_16x16x32_bf16 v[36:39], a[4:7], a[64:67], 0
    v_mfma_f32_16x16x32_bf16 v[96:99], a[8:11], a[64:67], 0
    v_mfma_f32_16x16x32_bf16 v[100:103], a[12:15], a[64:67], 0
    s_add_u32 m0, s61, 0
    s_waitcnt lgkmcnt(13)
    v_mfma_f32_16x16x32_bf16 v[160:163], a[16:19], a[64:67], 0
    buffer_load_dwordx4 v16, s[40:43], s48 offen offset:0 lds
    s_waitcnt lgkmcnt(12)
    v_mfma_f32_16x16x32_bf16 v[164:167], a[20:23], a[64:67], 0
    s_waitcnt lgkmcnt(9)
    v_mfma_f32_16x16x32_bf16 v[224:227], a[24:27], a[64:67], 0
    s_waitcnt lgkmcnt(8)
    v_mfma_f32_16x16x32_bf16 v[228:231], a[28:31], a[64:67], 0
    ds_read_b64_tr_b16 a[64:65], v8 offset:16384
    v_mfma_f32_16x16x32_bf16 v[40:43], a[0:3], a[68:71], 0
    ds_read_b64_tr_b16 a[66:67], v8 offset:18432
    v_mfma_f32_16x16x32_bf16 v[44:47], a[4:7], a[68:71], 0
    v_mfma_f32_16x16x32_bf16 v[104:107], a[8:11], a[68:71], 0
    ds_read_b128 a[32:35], v7 offset:0
    v_mfma_f32_16x16x32_bf16 v[108:111], a[12:15], a[68:71], 0
    v_mfma_f32_16x16x32_bf16 v[168:171], a[16:19], a[68:71], 0
    buffer_load_dwordx4 v17, s[40:43], s48 offen offset:1024 lds
    v_mfma_f32_16x16x32_bf16 v[172:175], a[20:23], a[68:71], 0
    s_add_u32 s48, s48, 128
    v_mfma_f32_16x16x32_bf16 v[232:235], a[24:27], a[68:71], 0
    ds_read_b128 a[36:39], v7 offset:2048
    v_mfma_f32_16x16x32_bf16 v[236:239], a[28:31], a[68:71], 0
    ds_read_b64_tr_b16 a[68:69], v9 offset:16384
    v_mfma_f32_16x16x32_bf16 v[48:51], a[0:3], a[72:75], 0
    ds_read_b64_tr_b16 a[70:71], v9 offset:18432
    v_mfma_f32_16x16x32_bf16 v[52:55], a[4:7], a[72:75], 0
    v_mfma_f32_16x16x32_bf16 v[112:115], a[8:11], a[72:75], 0
    ds_read_b128 a[40:43], v7 offset:4096
    v_mfma_f32_16x16x32_bf16 v[116:119], a[12:15], a[72:75], 0
    v_mfma_f32_16x16x32_bf16 v[176:179], a[16:19], a[72:75], 0
    buffer_load_dwordx4 v16, s[40:43], s49 offen offset:2048 lds
    v_mfma_f32_16x16x32_bf16 v[180:183], a[20:23], a[72:75], 0
    v_mfma_f32_16x16x32_bf16 v[240:243], a[24:27], a[72:75], 0
    ds_read_b128 a[44:47], v7 offset:6144
    v_mfma_f32_16x16x32_bf16 v[244:247], a[28:31], a[72:75], 0
    ds_read_b64_tr_b16 a[72:73], v10 offset:16384
    v_mfma_f32_16x16x32_bf16 v[56:59], a[0:3], a[76:79], 0
    ds_read_b64_tr_b16 a[74:75], v10 offset:18432
    v_mfma_f32_16x16x32_bf16 v[60:63], a[4:7], a[76:79], 0
    v_mfma_f32_16x16x32_bf16 v[120:123], a[8:11], a[76:79], 0
    ds_read_b128 a[48:51], v7 offset:8192
    v_mfma_f32_16x16x32_bf16 v[124:127], a[12:15], a[76:79], 0
    v_mfma_f32_16x16x32_bf16 v[184:187], a[16:19], a[76:79], 0
    buffer_load_dwordx4 v17, s[40:43], s49 offen offset:3072 lds
    v_mfma_f32_16x16x32_bf16 v[188:191], a[20:23], a[76:79], 0
    s_add_u32 s49, s49, 128
    v_mfma_f32_16x16x32_bf16 v[248:251], a[24:27], a[76:79], 0
    ds_read_b128 a[52:55], v7 offset:10240
    v_mfma_f32_16x16x32_bf16 v[252:255], a[28:31], a[76:79], 0
    ds_read_b64_tr_b16 a[76:77], v11 offset:16384
    s_waitcnt lgkmcnt(15)
    v_mfma_f32_16x16x32_bf16 v[64:67], a[0:3], a[80:83], 0
    ds_read_b64_tr_b16 a[78:79], v11 offset:18432
    v_mfma_f32_16x16x32_bf16 v[68:71], a[4:7], a[80:83], 0
    v_mfma_f32_16x16x32_bf16 v[128:131], a[8:11], a[80:83], 0
    ds_read_b128 a[56:59], v7 offset:12288
    v_mfma_f32_16x16x32_bf16 v[132:135], a[12:15], a[80:83], 0
    s_add_u32 m0, s61, 4096
    v_mfma_f32_16x16x32_bf16 v[192:195], a[16:19], a[80:83], 0
    buffer_load_dwordx4 v16, s[40:43], s50 offen offset:0 lds
    v_mfma_f32_16x16x32_bf16 v[196:199], a[20:23], a[80:83], 0
    v_mfma_f32_16x16x32_bf16 a[96:99], a[24:27], a[80:83], 0
    s_add_u32 s61, s61, 32768
    ds_read_b128 a[60:63], v7 offset:14336
    v_mfma_f32_16x16x32_bf16 a[100:103], a[28:31], a[80:83], 0
    s_cmp_ge_u32 s61, 98304
    s_cselect_b32 s90, 98304, 0
    ds_read_b64_tr_b16 a[80:81], v12 offset:16384
    v_mfma_f32_16x16x32_bf16 v[72:75], a[0:3], a[84:87], 0
    s_sub_u32 s61, s61, s90
    ds_read_b64_tr_b16 a[82:83], v12 offset:18432
    v_mfma_f32_16x16x32_bf16 v[76:79], a[4:7], a[84:87], 0
    s_add_u32 s64, s64, 32768
    v_mfma_f32_16x16x32_bf16 v[136:139], a[8:11], a[84:87], 0
    buffer_store_dwordx4 a[128:131], v2, s[24:27], s28 offen sc1
    v_mfma_f32_16x16x32_bf16 v[140:143], a[12:15], a[84:87], 0
    s_add_u32 s28, s28, s31
    v_mfma_f32_16x16x32_bf16 v[200:203], a[16:19], a[84:87], 0
    buffer_load_dwordx4 v17, s[40:43], s50 offen offset:1024 lds
    v_mfma_f32_16x16x32_bf16 v[204:207], a[20:23], a[84:87], 0
    s_add_u32 s50, s50, 128
    v_mfma_f32_16x16x32_bf16 a[104:107], a[24:27], a[84:87], 0
    s_cmp_ge_u32 s64, 98304
    s_cselect_b32 s63, 4294901760, s59
    s_cselect_b32 s64, 0, s64
    v_mfma_f32_16x16x32_bf16 a[108:111], a[28:31], a[84:87], 0
    ds_read_b64_tr_b16 a[84:85], v13 offset:16384
    v_mfma_f32_16x16x32_bf16 v[80:83], a[0:3], a[88:91], 0
    ds_read_b64_tr_b16 a[86:87], v13 offset:18432
    v_mfma_f32_16x16x32_bf16 v[84:87], a[4:7], a[88:91], 0
    v_mfma_f32_16x16x32_bf16 v[144:147], a[8:11], a[88:91], 0
    buffer_store_dwordx4 a[132:135], v2, s[24:27], s28 offen sc1
    v_mfma_f32_16x16x32_bf16 v[148:151], a[12:15], a[88:91], 0
    s_add_u32 s28, s28, s31
    v_mfma_f32_16x16x32_bf16 v[208:211], a[16:19], a[88:91], 0
    buffer_load_dwordx4 v16, s[40:43], s51 offen offset:2048 lds
    v_mfma_f32_16x16x32_bf16 v[212:215], a[20:23], a[88:91], 0
    v_mfma_f32_16x16x32_bf16 a[112:115], a[24:27], a[88:91], 0
    v_mfma_f32_16x16x32_bf16 a[116:119], a[28:31], a[88:91], 0
    ds_read_b64_tr_b16 a[88:89], v14 offset:16384
    s_waitcnt lgkmcnt(15)
    v_mfma_f32_16x16x32_bf16 v[88:91], a[0:3], a[92:95], 0
    ds_read_b64_tr_b16 a[90:91], v14 offset:18432
    v_mfma_f32_16x16x32_bf16 v[92:95], a[4:7], a[92:95], 0
    v_add_u32 v6, s63, v6
    v_add_u32 v7, s63, v7
    v_mfma_f32_16x16x32_bf16 v[152:155], a[8:11], a[92:95], 0
    buffer_store_dwordx4 a[136:139], v2, s[24:27], s28 offen sc1
    v_mfma_f32_16x16x32_bf16 v[156:159], a[12:15], a[92:95], 0
    s_add_u32 s28, s28, s31
    v_mfma_f32_16x16x32_bf16 v[216:219], a[16:19], a[92:95], 0
    buffer_load_dwordx4 v17, s[40:43], s51 offen offset:3072 lds
    v_mfma_f32_16x16x32_bf16 v[220:223], a[20:23], a[92:95], 0
    s_add_u32 s51, s51, 128
    v_mfma_f32_16x16x32_bf16 a[120:123], a[24:27], a[92:95], 0
    v_mfma_f32_16x16x32_bf16 a[124:127], a[28:31], a[92:95], 0
    ds_read_b64_tr_b16 a[92:93], v15 offset:16384
    ds_read_b64_tr_b16 a[94:95], v15 offset:18432
    v_mfma_f32_16x16x32_bf16 v[32:35], a[32:35], a[64:67], v[32:35]
    v_xor_b32 v8, s60, v8
    v_xor_b32 v9, s60, v9
    v_mfma_f32_16x16x32_bf16 v[36:39], a[36:39], a[64:67], v[36:39]
    v_xor_b32 v10, s60, v10
    v_xor_b32 v11, s60, v11
    s_waitcnt lgkmcnt(15)
    v_mfma_f32_16x16x32_bf16 v[96:99], a[40:43], a[64:67], v[96:99]
    v_xor_b32 v12, s60, v12
    v_xor_b32 v13, s60, v13
    v_mfma_f32_16x16x32_bf16 v[100:103], a[44:47], a[64:67], v[100:103]
    v_xor_b32 v14, s60, v14
    v_xor_b32 v15, s60, v15
    s_waitcnt lgkmcnt(13)
    v_mfma_f32_16x16x32_bf16 v[160:163], a[48:51], a[64:67], v[160:163]
    s_waitcnt lgkmcnt(12)
    v_mfma_f32_16x16x32_bf16 v[164:167], a[52:55], a[64:67], v[164:167]
    s_waitcnt lgkmcnt(9)
    v_mfma_f32_16x16x32_bf16 v[224:227], a[56:59], a[64:67], v[224:227]
    s_waitcnt vmcnt(11) lgkmcnt(0)
    v_mfma_f32_16x16x32_bf16 v[228:231], a[60:63], a[64:67], v[228:231]
    s_barrier
    ds_read_b64_tr_b16 a[64:65], v8 offset:0
    v_mfma_f32_16x16x32_bf16 v[40:43], a[32:35], a[68:71], v[40:43]
    s_add_u32 m0, s62, 0
    ds_read_b64_tr_b16 a[66:67], v8 offset:2048
    v_mfma_f32_16x16x32_bf16 v[44:47], a[36:39], a[68:71], v[44:47]
    buffer_load_dwordx4 v18, s[44:47], s52 offen offset:0 lds
    v_mfma_f32_16x16x32_bf16 v[104:107], a[40:43], a[68:71], v[104:107]
    ds_read_b128 a[0:3], v6 offset:0
    v_mfma_f32_16x16x32_bf16 v[108:111], a[44:47], a[68:71], v[108:111]
    v_mfma_f32_16x16x32_bf16 v[168:171], a[48:51], a[68:71], v[168:171]
    v_mfma_f32_16x16x32_bf16 v[172:175], a[52:55], a[68:71], v[172:175]
    buffer_load_dwordx4 v19, s[44:47], s52 offen offset:1024 lds
    v_mfma_f32_16x16x32_bf16 v[232:235], a[56:59], a[68:71], v[232:235]
    s_add_u32 s52, s52, s56
    ds_read_b128 a[4:7], v6 offset:2048
    v_mfma_f32_16x16x32_bf16 v[236:239], a[60:63], a[68:71], v[236:239]
    ds_read_b64_tr_b16 a[68:69], v9 offset:0
    v_mfma_f32_16x16x32_bf16 v[48:51], a[32:35], a[72:75], v[48:51]
    ds_read_b64_tr_b16 a[70:71], v9 offset:2048
    v_mfma_f32_16x16x32_bf16 v[52:55], a[36:39], a[72:75], v[52:55]
    buffer_load_dwordx4 v18, s[44:47], s53 offen offset:2048 lds
    v_mfma_f32_16x16x32_bf16 v[112:115], a[40:43], a[72:75], v[112:115]
    ds_read_b128 a[8:11], v6 offset:4096
    v_mfma_f32_16x16x32_bf16 v[116:119], a[44:47], a[72:75], v[116:119]
    v_mfma_f32_16x16x32_bf16 v[176:179], a[48:51], a[72:75], v[176:179]
    v_mfma_f32_16x16x32_bf16 v[180:183], a[52:55], a[72:75], v[180:183]
    buffer_load_dwordx4 v19, s[44:47], s53 offen offset:3072 lds
    v_mfma_f32_16x16x32_bf16 v[240:243], a[56:59], a[72:75], v[240:243]
    s_add_u32 s53, s53, s56
    ds_read_b128 a[12:15], v6 offset:6144
    v_mfma_f32_16x16x32_bf16 v[244:247], a[60:63], a[72:75], v[244:247]
    ds_read_b64_tr_b16 a[72:73], v10 offset:0
    v_mfma_f32_16x16x32_bf16 v[56:59], a[32:35], a[76:79], v[56:59]
    s_add_u32 m0, s62, 4096
    ds_read_b64_tr_b16 a[74:75], v10 offset:2048
    v_mfma_f32_16x16x32_bf16 v[60:63], a[36:39], a[76:79], v[60:63]
    buffer_load_dwordx4 v20, s[44:47], s54 offen offset:0 lds
    v_mfma_f32_16x16x32_bf16 v[120:123], a[40:43], a[76:79], v[120:123]
    ds_read_b128 a[16:19], v6 offset:8192
    v_mfma_f32_16x16x32_bf16 v[124:127], a[44:47], a[76:79], v[124:127]
    s_xor_b32 s62, s62, 229376
    v_mfma_f32_16x16x32_bf16 v[184:187], a[48:51], a[76:79], v[184:187]
    v_mfma_f32_16x16x32_bf16 v[188:191], a[52:55], a[76:79], v[188:191]
    buffer_load_dwordx4 v21, s[44:47], s54 offen offset:1024 lds
    v_mfma_f32_16x16x32_bf16 v[248:251], a[56:59], a[76:79], v[248:251]
    s_add_u32 s54, s54, s56
    ds_read_b128 a[20:23], v6 offset:10240
    v_mfma_f32_16x16x32_bf16 v[252:255], a[60:63], a[76:79], v[252:255]
    ds_read_b64_tr_b16 a[76:77], v11 offset:0
    v_mfma_f32_16x16x32_bf16 v[64:67], a[32:35], a[80:83], v[64:67]
    ds_read_b64_tr_b16 a[78:79], v11 offset:2048
    v_mfma_f32_16x16x32_bf16 v[68:71], a[36:39], a[80:83], v[68:71]
    buffer_load_dwordx4 v20, s[44:47], s55 offen offset:2048 lds
    v_mfma_f32_16x16x32_bf16 v[128:131], a[40:43], a[80:83], v[128:131]
    ds_read_b128 a[24:27], v6 offset:12288
    v_mfma_f32_16x16x32_bf16 v[132:135], a[44:47], a[80:83], v[132:135]
    v_mfma_f32_16x16x32_bf16 v[192:195], a[48:51], a[80:83], v[192:195]
    v_mfma_f32_16x16x32_bf16 v[196:199], a[52:55], a[80:83], v[196:199]
    buffer_load_dwordx4 v21, s[44:47], s55 offen offset:3072 lds
    v_mfma_f32_16x16x32_bf16 a[96:99], a[56:59], a[80:83], a[96:99]
    s_add_u32 s55, s55, s56
    ds_read_b128 a[28:31], v6 offset:14336
    v_mfma_f32_16x16x32_bf16 a[100:103], a[60:63], a[80:83], a[100:103]
    ds_read_b64_tr_b16 a[80:81], v12 offset:0
    v_mfma_f32_16x16x32_bf16 v[72:75], a[32:35], a[84:87], v[72:75]
    ds_read_b64_tr_b16 a[82:83], v12 offset:2048
    v_mfma_f32_16x16x32_bf16 v[76:79], a[36:39], a[84:87], v[76:79]
    v_mfma_f32_16x16x32_bf16 v[136:139], a[40:43], a[84:87], v[136:139]
    buffer_store_dwordx4 a[140:143], v2, s[24:27], s28 offen sc1
    v_mfma_f32_16x16x32_bf16 v[140:143], a[44:47], a[84:87], v[140:143]
    s_add_u32 s28, s28, s31
    v_mfma_f32_16x16x32_bf16 v[200:203], a[48:51], a[84:87], v[200:203]
    v_mfma_f32_16x16x32_bf16 v[204:207], a[52:55], a[84:87], v[204:207]
    v_mfma_f32_16x16x32_bf16 a[104:107], a[56:59], a[84:87], a[104:107]
    buffer_store_dwordx4 a[144:147], v2, s[24:27], s28 offen sc1
    v_mfma_f32_16x16x32_bf16 a[108:111], a[60:63], a[84:87], a[108:111]
    s_add_u32 s28, s28, s31
    ds_read_b64_tr_b16 a[84:85], v13 offset:0
    v_mfma_f32_16x16x32_bf16 v[80:83], a[32:35], a[88:91], v[80:83]
    ds_read_b64_tr_b16 a[86:87], v13 offset:2048
    v_mfma_f32_16x16x32_bf16 v[84:87], a[36:39], a[88:91], v[84:87]
    v_mfma_f32_16x16x32_bf16 v[144:147], a[40:43], a[88:91], v[144:147]
    buffer_store_dwordx4 a[148:151], v2, s[24:27], s28 offen sc1
    v_mfma_f32_16x16x32_bf16 v[148:151], a[44:47], a[88:91], v[148:151]
    s_add_u32 s28, s28, s31
    v_mfma_f32_16x16x32_bf16 v[208:211], a[48:51], a[88:91], v[208:211]
    v_mfma_f32_16x16x32_bf16 v[212:215], a[52:55], a[88:91], v[212:215]
    v_mfma_f32_16x16x32_bf16 a[112:115], a[56:59], a[88:91], a[112:115]
    buffer_store_dwordx4 a[152:155], v2, s[24:27], s28 offen sc1
    v_mfma_f32_16x16x32_bf16 a[116:119], a[60:63], a[88:91], a[116:119]
    s_add_u32 s28, s28, s31
    ds_read_b64_tr_b16 a[88:89], v14 offset:0
    v_mfma_f32_16x16x32_bf16 v[88:91], a[32:35], a[92:95], v[88:91]
    ds_read_b64_tr_b16 a[90:91], v14 offset:2048
    v_mfma_f32_16x16x32_bf16 v[92:95], a[36:39], a[92:95], v[92:95]
    v_mfma_f32_16x16x32_bf16 v[152:155], a[40:43], a[92:95], v[152:155]
    buffer_store_dwordx4 a[156:159], v2, s[24:27], s28 offen sc1
    v_mfma_f32_16x16x32_bf16 v[156:159], a[44:47], a[92:95], v[156:159]
    s_add_u32 s29, s29, s30
    s_mov_b32 s28, s29
    v_mfma_f32_16x16x32_bf16 v[216:219], a[48:51], a[92:95], v[216:219]
    s_sub_u32 s65, s65, 1
    v_mfma_f32_16x16x32_bf16 v[220:223], a[52:55], a[92:95], v[220:223]
    v_mfma_f32_16x16x32_bf16 a[120:123], a[56:59], a[92:95], a[120:123]
    v_mfma_f32_16x16x32_bf16 a[124:127], a[60:63], a[92:95], a[124:127]
    ds_read_b64_tr_b16 a[92:93], v15 offset:0
    ds_read_b64_tr_b16 a[94:95], v15 offset:2048
    s_waitcnt lgkmcnt(15)
    v_mfma_f32_16x16x32_bf16 v[32:35], a[0:3], a[64:67], v[32:35]
    v_mfma_f32_16x16x32_bf16 v[36:39], a[4:7], a[64:67], v[36:39]
    v_mfma_f32_16x16x32_bf16 v[96:99], a[8:11], a[64:67], v[96:99]
    v_mfma_f32_16x16x32_bf16 v[100:103], a[12:15], a[64:67], v[100:103]
    s_add_u32 m0, s61, 0
    s_waitcnt lgkmcnt(13)
    v_mfma_f32_16x16x32_bf16 v[160:163], a[16:19], a[64:67], v[160:163]
    buffer_load_dwordx4 v16, s[40:43], s48 offen offset:0 lds
    s_waitcnt lgkmcnt(12)
    v_mfma_f32_16x16x32_bf16 v[164:167], a[20:23], a[64:67], v[164:167]
    s_waitcnt lgkmcnt(9)
    v_mfma_f32_16x16x32_bf16 v[224:227], a[24:27], a[64:67], v[224:227]
    s_waitcnt lgkmcnt(8)
    v_mfma_f32_16x16x32_bf16 v[228:231], a[28:31], a[64:67], v[228:231]
    ds_read_b64_tr_b16 a[64:65], v8 offset:16384
    v_mfma_f32_16x16x32_bf16 v[40:43], a[0:3], a[68:71], v[40:43]
    ds_read_b64_tr_b16 a[66:67], v8 offset:18432
    v_mfma_f32_16x16x32_bf16 v[44:47], a[4:7], a[68:71], v[44:47]
    v_mfma_f32_16x16x32_bf16 v[104:107], a[8:11], a[68:71], v[104:107]
    ds_read_b128 a[32:35], v7 offset:0
    v_mfma_f32_16x16x32_bf16 v[108:111], a[12:15], a[68:71], v[108:111]
    v_mfma_f32_16x16x32_bf16 v[168:171], a[16:19], a[68:71], v[168:171]
    buffer_load_dwordx4 v17, s[40:43], s48 offen offset:1024 lds
    v_mfma_f32_16x16x32_bf16 v[172:175], a[20:23], a[68:71], v[172:175]
    s_add_u32 s48, s48, 128
    v_mfma_f32_16x16x32_bf16 v[232:235], a[24:27], a[68:71], v[232:235]
    ds_read_b128 a[36:39], v7 offset:2048
    v_mfma_f32_16x16x32_bf16 v[236:239], a[28:31], a[68:71], v[236:239]
    ds_read_b64_tr_b16 a[68:69], v9 offset:16384
    v_mfma_f32_16x16x32_bf16 v[48:51], a[0:3], a[72:75], v[48:51]
    ds_read_b64_tr_b16 a[70:71], v9 offset:18432
    v_mfma_f32_16x16x32_bf16 v[52:55], a[4:7], a[72:75], v[52:55]
    v_mfma_f32_16x16x32_bf16 v[112:115], a[8:11], a[72:75], v[112:115]
    ds_read_b128 a[40:43], v7 offset:4096
    v_mfma_f32_16x16x32_bf16 v[116:119], a[12:15], a[72:75], v[116:119]
    v_mfma_f32_16x16x32_bf16 v[176:179], a[16:19], a[72:75], v[176:179]
    buffer_load_dwordx4 v16, s[40:43], s49 offen offset:2048 lds
    v_mfma_f32_16x16x32_bf16 v[180:183], a[20:23], a[72:75], v[180:183]
    v_mfma_f32_16x16x32_bf16 v[240:243], a[24:27], a[72:75], v[240:243]
    ds_read_b128 a[44:47], v7 offset:6144
    v_mfma_f32_16x16x32_bf16 v[244:247], a[28:31], a[72:75], v[244:247]
    ds_read_b64_tr_b16 a[72:73], v10 offset:16384
    v_mfma_f32_16x16x32_bf16 v[56:59], a[0:3], a[76:79], v[56:59]
    ds_read_b64_tr_b16 a[74:75], v10 offset:18432
    v_mfma_f32_16x16x32_bf16 v[60:63], a[4:7], a[76:79], v[60:63]
    v_mfma_f32_16x16x32_bf16 v[120:123], a[8:11], a[76:79], v[120:123]
    ds_read_b128 a[48:51], v7 offset:8192
    v_mfma_f32_16x16x32_bf16 v[124:127], a[12:15], a[76:79], v[124:127]
    v_mfma_f32_16x16x32_bf16 v[184:187], a[16:19], a[76:79], v[184:187]
    buffer_load_dwordx4 v17, s[40:43], s49 offen offset:3072 lds
    v_mfma_f32_16x16x32_bf16 v[188:191], a[20:23], a[76:79], v[188:191]
    s_add_u32 s49, s49, 128
    v_mfma_f32_16x16x32_bf16 v[248:251], a[24:27], a[76:79], v[248:251]
    ds_read_b128 a[52:55], v7 offset:10240
    v_mfma_f32_16x16x32_bf16 v[252:255], a[28:31], a[76:79], v[252:255]
    ds_read_b64_tr_b16 a[76:77], v11 offset:16384
    s_waitcnt lgkmcnt(15)
    v_mfma_f32_16x16x32_bf16 v[64:67], a[0:3], a[80:83], v[64:67]
    ds_read_b64_tr_b16 a[78:79], v11 offset:18432
    v_mfma_f32_16x16x32_bf16 v[68:71], a[4:7], a[80:83], v[68:71]
    v_mfma_f32_16x16x32_bf16 v[128:131], a[8:11], a[80:83], v[128:131]
    ds_read_b128 a[56:59], v7 offset:12288
    v_mfma_f32_16x16x32_bf16 v[132:135], a[12:15], a[80:83], v[132:135]
    s_add_u32 m0, s61, 4096
    v_mfma_f32_16x16x32_bf16 v[192:195], a[16:19], a[80:83], v[192:195]
    buffer_load_dwordx4 v16, s[40:43], s50 offen offset:0 lds
    v_mfma_f32_16x16x32_bf16 v[196:199], a[20:23], a[80:83], v[196:199]
    v_mfma_f32_16x16x32_bf16 a[96:99], a[24:27], a[80:83], a[96:99]
    s_add_u32 s61, s61, 32768
    ds_read_b128 a[60:63], v7 offset:14336
    v_mfma_f32_16x16x32_bf16 a[100:103], a[28:31], a[80:83], a[100:103]
    s_cmp_ge_u32 s61, 98304
    s_cselect_b32 s90, 98304, 0
    ds_read_b64_tr_b16 a[80:81], v12 offset:16384
    v_mfma_f32_16x16x32_bf16 v[72:75], a[0:3], a[84:87], v[72:75]
    s_sub_u32 s61, s61, s90
    ds_read_b64_tr_b16 a[82:83], v12 offset:18432
    v_mfma_f32_16x16x32_bf16 v[76:79], a[4:7], a[84:87], v[76:79]
    s_add_u32 s64, s64, 32768
    v_mfma_f32_16x16x32_bf16 v[136:139], a[8:11], a[84:87], v[136:139]
    buffer_store_dwordx4 a[160:163], v2, s[24:27], s28 offen sc1
    v_mfma_f32_16x16x32_bf16 v[140:143], a[12:15], a[84:87], v[140:143]
    s_add_u32 s28, s28, s31
    v_mfma_f32_16x16x32_bf16 v[200:203], a[16:19], a[84:87], v[200:203]
    buffer_load_dwordx4 v17, s[40:43], s50 offen offset:1024 lds
    v_mfma_f32_16x16x32_bf16 v[204:207], a[20:23], a[84:87], v[204:207]
    s_add_u32 s50, s50, 128
    v_mfma_f32_16x16x32_bf16 a[104:107], a[24:27], a[84:87], a[104:107]
    s_cmp_ge_u32 s64, 98304
    s_cselect_b32 s63, 4294901760, s59
    s_cselect_b32 s64, 0, s64
    v_mfma_f32_16x16x32_bf16 a[108:111], a[28:31], a[84:87], a[108:111]
    ds_read_b64_tr_b16 a[84:85], v13 offset:16384
    v_mfma_f32_16x16x32_bf16 v[80:83], a[0:3], a[88:91], v[80:83]
    ds_read_b64_tr_b16 a[86:87], v13 offset:18432
    v_mfma_f32_16x16x32_bf16 v[84:87], a[4:7], a[88:91], v[84:87]
    v_mfma_f32_16x16x32_bf16 v[144:147], a[8:11], a[88:91], v[144:147]
    buffer_store_dwordx4 a[164:167], v2, s[24:27], s28 offen sc1
    v_mfma_f32_16x16x32_bf16 v[148:151], a[12:15], a[88:91], v[148:151]
    s_add_u32 s28, s28, s31
    v_mfma_f32_16x16x32_bf16 v[208:211], a[16:19], a[88:91], v[208:211]
    buffer_load_dwordx4 v16, s[40:43], s51 offen offset:2048 lds
    v_mfma_f32_16x16x32_bf16 v[212:215], a[20:23], a[88:91], v[212:215]
    v_mfma_f32_16x16x32_bf16 a[112:115], a[24:27], a[88:91], a[112:115]
    v_mfma_f32_16x16x32_bf16 a[116:119], a[28:31], a[88:91], a[116:119]
    ds_read_b64_tr_b16 a[88:89], v14 offset:16384
    s_waitcnt lgkmcnt(15)
    v_mfma_f32_16x16x32_bf16 v[88:91], a[0:3], a[92:95], v[88:91]
    ds_read_b64_tr_b16 a[90:91], v14 offset:18432
    v_mfma_f32_16x16x32_bf16 v[92:95], a[4:7], a[92:95], v[92:95]
    v_add_u32 v6, s63, v6
    v_add_u32 v7, s63, v7
    v_mfma_f32_16x16x32_bf16 v[152:155], a[8:11], a[92:95], v[152:155]
    buffer_store_dwordx4 a[168:171], v2, s[24:27], s28 offen sc1
    v_mfma_f32_16x16x32_bf16 v[156:159], a[12:15], a[92:95], v[156:159]
    s_add_u32 s28, s28, s31
    v_mfma_f32_16x16x32_bf16 v[216:219], a[16:19], a[92:95], v[216:219]
    buffer_load_dwordx4 v17, s[40:43], s51 offen offset:3072 lds
    v_mfma_f32_16x16x32_bf16 v[220:223], a[20:23], a[92:95], v[220:223]
    s_add_u32 s51, s51, 128
    v_mfma_f32_16x16x32_bf16 a[120:123], a[24:27], a[92:95], a[120:123]
    v_mfma_f32_16x16x32_bf16 a[124:127], a[28:31], a[92:95], a[124:127]
    ds_read_b64_tr_b16 a[92:93], v15 offset:16384
    ds_read_b64_tr_b16 a[94:95], v15 offset:18432
    v_mfma_f32_16x16x32_bf16 v[32:35], a[32:35], a[64:67], v[32:35]
    v_xor_b32 v8, s60, v8
    v_xor_b32 v9, s60, v9
    v_mfma_f32_16x16x32_bf16 v[36:39], a[36:39], a[64:67], v[36:39]
    v_xor_b32 v10, s60, v10
    v_xor_b32 v11, s60, v11
    s_waitcnt lgkmcnt(15)
    v_mfma_f32_16x16x32_bf16 v[96:99], a[40:43], a[64:67], v[96:99]
    v_xor_b32 v12, s60, v12
    v_xor_b32 v13, s60, v13
    v_mfma_f32_16x16x32_bf16 v[100:103], a[44:47], a[64:67], v[100:103]
    v_xor_b32 v14, s60, v14
    v_xor_b32 v15, s60, v15
    s_waitcnt lgkmcnt(13)
    v_mfma_f32_16x16x32_bf16 v[160:163], a[48:51], a[64:67], v[160:163]
    s_waitcnt lgkmcnt(12)
    v_mfma_f32_16x16x32_bf16 v[164:167], a[52:55], a[64:67], v[164:167]
    s_waitcnt lgkmcnt(9)
    v_mfma_f32_16x16x32_bf16 v[224:227], a[56:59], a[64:67], v[224:227]
    s_waitcnt vmcnt(16) lgkmcnt(0)
    v_mfma_f32_16x16x32_bf16 v[228:231], a[60:63], a[64:67], v[228:231]
    s_barrier
    ds_read_b64_tr_b16 a[64:65], v8 offset:0
    v_mfma_f32_16x16x32_bf16 v[40:43], a[32:35], a[68:71], v[40:43]
    s_add_u32 m0, s62, 0
    ds_read_b64_tr_b16 a[66:67], v8 offset:2048
    v_mfma_f32_16x16x32_bf16 v[44:47], a[36:39], a[68:71], v[44:47]
    buffer_load_dwordx4 v18, s[44:47], s52 offen offset:0 lds
    v_mfma_f32_16x16x32_bf16 v[104:107], a[40:43], a[68:71], v[104:107]
    ds_read_b128 a[0:3], v6 offset:0
    v_mfma_f32_16x16x32_bf16 v[108:111], a[44:47], a[68:71], v[108:111]
    v_mfma_f32_16x16x32_bf16 v[168:171], a[48:51], a[68:71], v[168:171]
    v_mfma_f32_16x16x32_bf16 v[172:175], a[52:55], a[68:71], v[172:175]
    buffer_load_dwordx4 v19, s[44:47], s52 offen offset:1024 lds
    v_mfma_f32_16x16x32_bf16 v[232:235], a[56:59], a[68:71], v[232:235]
    s_add_u32 s52, s52, s56
    ds_read_b128 a[4:7], v6 offset:2048
    v_mfma_f32_16x16x32_bf16 v[236:239], a[60:63], a[68:71], v[236:239]
    ds_read_b64_tr_b16 a[68:69], v9 offset:0
    v_mfma_f32_16x16x32_bf16 v[48:51], a[32:35], a[72:75], v[48:51]
    ds_read_b64_tr_b16 a[70:71], v9 offset:2048
    v_mfma_f32_16x16x32_bf16 v[52:55], a[36:39], a[72:75], v[52:55]
    buffer_load_dwordx4 v18, s[44:47], s53 offen offset:2048 lds
    v_mfma_f32_16x16x32_bf16 v[112:115], a[40:43], a[72:75], v[112:115]
    ds_read_b128 a[8:11], v6 offset:4096
    v_mfma_f32_16x16x32_bf16 v[116:119], a[44:47], a[72:75], v[116:119]
    v_mfma_f32_16x16x32_bf16 v[176:179], a[48:51], a[72:75], v[176:179]
    v_mfma_f32_16x16x32_bf16 v[180:183], a[52:55], a[72:75], v[180:183]
    buffer_load_dwordx4 v19, s[44:47], s53 offen offset:3072 lds
    v_mfma_f32_16x16x32_bf16 v[240:243], a[56:59], a[72:75], v[240:243]
    s_add_u32 s53, s53, s56
    ds_read_b128 a[12:15], v6 offset:6144
    v_mfma_f32_16x16x32_bf16 v[244:247], a[60:63], a[72:75], v[244:247]
    ds_read_b64_tr_b16 a[72:73], v10 offset:0
    v_mfma_f32_16x16x32_bf16 v[56:59], a[32:35], a[76:79], v[56:59]
    s_add_u32 m0, s62, 4096
    ds_read_b64_tr_b16 a[74:75], v10 offset:2048
    v_mfma_f32_16x16x32_bf16 v[60:63], a[36:39], a[76:79], v[60:63]
    buffer_load_dwordx4 v20, s[44:47], s54 offen offset:0 lds
    v_mfma_f32_16x16x32_bf16 v[120:123], a[40:43], a[76:79], v[120:123]
    ds_read_b128 a[16:19], v6 offset:8192
    v_mfma_f32_16x16x32_bf16 v[124:127], a[44:47], a[76:79], v[124:127]
    s_xor_b32 s62, s62, 229376
    v_mfma_f32_16x16x32_bf16 v[184:187], a[48:51], a[76:79], v[184:187]
    v_mfma_f32_16x16x32_bf16 v[188:191], a[52:55], a[76:79], v[188:191]
    buffer_load_dwordx4 v21, s[44:47], s54 offen offset:1024 lds
    v_mfma_f32_16x16x32_bf16 v[248:251], a[56:59], a[76:79], v[248:251]
    s_add_u32 s54, s54, s56
    ds_read_b128 a[20:23], v6 offset:10240
    v_mfma_f32_16x16x32_bf16 v[252:255], a[60:63], a[76:79], v[252:255]
    ds_read_b64_tr_b16 a[76:77], v11 offset:0
    v_mfma_f32_16x16x32_bf16 v[64:67], a[32:35], a[80:83], v[64:67]
    ds_read_b64_tr_b16 a[78:79], v11 offset:2048
    v_mfma_f32_16x16x32_bf16 v[68:71], a[36:39], a[80:83], v[68:71]
    buffer_load_dwordx4 v20, s[44:47], s55 offen offset:2048 lds
    v_mfma_f32_16x16x32_bf16 v[128:131], a[40:43], a[80:83], v[128:131]
    ds_read_b128 a[24:27], v6 offset:12288
    v_mfma_f32_16x16x32_bf16 v[132:135], a[44:47], a[80:83], v[132:135]
    v_mfma_f32_16x16x32_bf16 v[192:195], a[48:51], a[80:83], v[192:195]
    v_mfma_f32_16x16x32_bf16 v[196:199], a[52:55], a[80:83], v[196:199]
    buffer_load_dwordx4 v21, s[44:47], s55 offen offset:3072 lds
    v_mfma_f32_16x16x32_bf16 a[96:99], a[56:59], a[80:83], a[96:99]
    s_add_u32 s55, s55, s56
    ds_read_b128 a[28:31], v6 offset:14336
    v_mfma_f32_16x16x32_bf16 a[100:103], a[60:63], a[80:83], a[100:103]
    ds_read_b64_tr_b16 a[80:81], v12 offset:0
    v_mfma_f32_16x16x32_bf16 v[72:75], a[32:35], a[84:87], v[72:75]
    ds_read_b64_tr_b16 a[82:83], v12 offset:2048
    v_mfma_f32_16x16x32_bf16 v[76:79], a[36:39], a[84:87], v[76:79]
    v_mfma_f32_16x16x32_bf16 v[136:139], a[40:43], a[84:87], v[136:139]
    buffer_store_dwordx4 a[172:175], v2, s[24:27], s28 offen sc1
    v_mfma_f32_16x16x32_bf16 v[140:143], a[44:47], a[84:87], v[140:143]
    s_add_u32 s28, s28, s31
    v_mfma_f32_16x16x32_bf16 v[200:203], a[48:51], a[84:87], v[200:203]
    v_mfma_f32_16x16x32_bf16 v[204:207], a[52:55], a[84:87], v[204:207]
    v_mfma_f32_16x16x32_bf16 a[104:107], a[56:59], a[84:87], a[104:107]
    buffer_store_dwordx4 a[176:179], v2, s[24:27], s28 offen sc1
    v_mfma_f32_16x16x32_bf16 a[108:111], a[60:63], a[84:87], a[108:111]
    s_add_u32 s28, s28, s31
    ds_read_b64_tr_b16 a[84:85], v13 offset:0
    v_mfma_f32_16x16x32_bf16 v[80:83], a[32:35], a[88:91], v[80:83]
    ds_read_b64_tr_b16 a[86:87], v13 offset:2048
    v_mfma_f32_16x16x32_bf16 v[84:87], a[36:39], a[88:91], v[84:87]
    v_mfma_f32_16x16x32_bf16 v[144:147], a[40:43], a[88:91], v[144:147]
    buffer_store_dwordx4 a[180:183], v2, s[24:27], s28 offen sc1
    v_mfma_f32_16x16x32_bf16 v[148:151], a[44:47], a[88:91], v[148:151]
    s_add_u32 s28, s28, s31
    v_mfma_f32_16x16x32_bf16 v[208:211], a[48:51], a[88:91], v[208:211]
    v_mfma_f32_16x16x32_bf16 v[212:215], a[52:55], a[88:91], v[212:215]
    v_mfma_f32_16x16x32_bf16 a[112:115], a[56:59], a[88:91], a[112:115]
    buffer_store_dwordx4 a[184:187], v2, s[24:27], s28 offen sc1
    v_mfma_f32_16x16x32_bf16 a[116:119], a[60:63], a[88:91], a[116:119]
    s_add_u32 s28, s28, s31
    ds_read_b64_tr_b16 a[88:89], v14 offset:0
    v_mfma_f32_16x16x32_bf16 v[88:91], a[32:35], a[92:95], v[88:91]
    ds_read_b64_tr_b16 a[90:91], v14 offset:2048
    v_mfma_f32_16x16x32_bf16 v[92:95], a[36:39], a[92:95], v[92:95]
    v_mfma_f32_16x16x32_bf16 v[152:155], a[40:43], a[92:95], v[152:155]
    buffer_store_dwordx4 a[188:191], v2, s[24:27], s28 offen sc1
    v_mfma_f32_16x16x32_bf16 v[156:159], a[44:47], a[92:95], v[156:159]
    s_add_u32 s29, s29, s30
    s_mov_b32 s28, s29
    v_mfma_f32_16x16x32_bf16 v[216:219], a[48:51], a[92:95], v[216:219]
    s_sub_u32 s65, s65, 1
    v_mfma_f32_16x16x32_bf16 v[220:223], a[52:55], a[92:95], v[220:223]
    v_mfma_f32_16x16x32_bf16 a[120:123], a[56:59], a[92:95], a[120:123]
    v_mfma_f32_16x16x32_bf16 a[124:127], a[60:63], a[92:95], a[124:127]
    ds_read_b64_tr_b16 a[92:93], v15 offset:0
    ds_read_b64_tr_b16 a[94:95], v15 offset:2048
    s_waitcnt lgkmcnt(15)
    v_mfma_f32_16x16x32_bf16 v[32:35], a[0:3], a[64:67], v[32:35]
    v_mfma_f32_16x16x32_bf16 v[36:39], a[4:7], a[64:67], v[36:39]
    v_mfma_f32_16x16x32_bf16 v[96:99], a[8:11], a[64:67], v[96:99]
    v_mfma_f32_16x16x32_bf16 v[100:103], a[12:15], a[64:67], v[100:103]
    s_add_u32 m0, s61, 0
    s_waitcnt lgkmcnt(13)
    v_mfma_f32_16x16x32_bf16 v[160:163], a[16:19], a[64:67], v[160:163]
    buffer_load_dwordx4 v16, s[40:43], s48 offen offset:0 lds
    s_waitcnt lgkmcnt(12)
    v_mfma_f32_16x16x32_bf16 v[164:167], a[20:23], a[64:67], v[164:167]
    s_waitcnt lgkmcnt(9)
    v_mfma_f32_16x16x32_bf16 v[224:227], a[24:27], a[64:67], v[224:227]
    s_waitcnt lgkmcnt(8)
    v_mfma_f32_16x16x32_bf16 v[228:231], a[28:31], a[64:67], v[228:231]
    ds_read_b64_tr_b16 a[64:65], v8 offset:16384
    v_mfma_f32_16x16x32_bf16 v[40:43], a[0:3], a[68:71], v[40:43]
    ds_read_b64_tr_b16 a[66:67], v8 offset:18432
    v_mfma_f32_16x16x32_bf16 v[44:47], a[4:7], a[68:71], v[44:47]
    v_mfma_f32_16x16x32_bf16 v[104:107], a[8:11], a[68:71], v[104:107]
    ds_read_b128 a[32:35], v7 offset:0
    v_mfma_f32_16x16x32_bf16 v[108:111], a[12:15], a[68:71], v[108:111]
    v_mfma_f32_16x16x32_bf16 v[168:171], a[16:19], a[68:71], v[168:171]
    buffer_load_dwordx4 v17, s[40:43], s48 offen offset:1024 lds
    v_mfma_f32_16x16x32_bf16 v[172:175], a[20:23], a[68:71], v[172:175]
    s_add_u32 s48, s48, 128
    v_mfma_f32_16x16x32_bf16 v[232:235], a[24:27], a[68:71], v[232:235]
    ds_read_b128 a[36:39], v7 offset:2048
    v_mfma_f32_16x16x32_bf16 v[236:239], a[28:31], a[68:71], v[236:239]
    ds_read_b64_tr_b16 a[68:69], v9 offset:16384
    v_mfma_f32_16x16x32_bf16 v[48:51], a[0:3], a[72:75], v[48:51]
    ds_read_b64_tr_b16 a[70:71], v9 offset:18432
    v_mfma_f32_16x16x32_bf16 v[52:55], a[4:7], a[72:75], v[52:55]
    v_mfma_f32_16x16x32_bf16 v[112:115], a[8:11], a[72:75], v[112:115]
    ds_read_b128 a[40:43], v7 offset:4096
    v_mfma_f32_16x16x32_bf16 v[116:119], a[12:15], a[72:75], v[116:119]
    v_mfma_f32_16x16x32_bf16 v[176:179], a[16:19], a[72:75], v[176:179]
    buffer_load_dwordx4 v16, s[40:43], s49 offen offset:2048 lds
    v_mfma_f32_16x16x32_bf16 v[180:183], a[20:23], a[72:75], v[180:183]
    v_mfma_f32_16x16x32_bf16 v[240:243], a[24:27], a[72:75], v[240:243]
    ds_read_b128 a[44:47], v7 offset:6144
    v_mfma_f32_16x16x32_bf16 v[244:247], a[28:31], a[72:75], v[244:247]
    ds_read_b64_tr_b16 a[72:73], v10 offset:16384
    v_mfma_f32_16x16x32_bf16 v[56:59], a[0:3], a[76:79], v[56:59]
    ds_read_b64_tr_b16 a[74:75], v10 offset:18432
    v_mfma_f32_16x16x32_bf16 v[60:63], a[4:7], a[76:79], v[60:63]
    v_mfma_f32_16x16x32_bf16 v[120:123], a[8:11], a[76:79], v[120:123]
    ds_read_b128 a[48:51], v7 offset:8192
    v_mfma_f32_16x16x32_bf16 v[124:127], a[12:15], a[76:79], v[124:127]
    v_mfma_f32_16x16x32_bf16 v[184:187], a[16:19], a[76:79], v[184:187]
    buffer_load_dwordx4 v17, s[40:43], s49 offen offset:3072 lds
    v_mfma_f32_16x16x32_bf16 v[188:191], a[20:23], a[76:79], v[188:191]
    s_add_u32 s49, s49, 128
    v_mfma_f32_16x16x32_bf16 v[248:251], a[24:27], a[76:79], v[248:251]
    ds_read_b128 a[52:55], v7 offset:10240
    v_mfma_f32_16x16x32_bf16 v[252:255], a[28:31], a[76:79], v[252:255]
    ds_read_b64_tr_b16 a[76:77], v11 offset:16384
    s_waitcnt lgkmcnt(15)
    v_mfma_f32_16x16x32_bf16 v[64:67], a[0:3], a[80:83], v[64:67]
    ds_read_b64_tr_b16 a[78:79], v11 offset:18432
    v_mfma_f32_16x16x32_bf16 v[68:71], a[4:7], a[80:83], v[68:71]
    v_mfma_f32_16x16x32_bf16 v[128:131], a[8:11], a[80:83], v[128:131]
    ds_read_b128 a[56:59], v7 offset:12288
    v_mfma_f32_16x16x32_bf16 v[132:135], a[12:15], a[80:83], v[132:135]
    s_add_u32 m0, s61, 4096
    v_mfma_f32_16x16x32_bf16 v[192:195], a[16:19], a[80:83], v[192:195]
    buffer_load_dwordx4 v16, s[40:43], s50 offen offset:0 lds
    v_mfma_f32_16x16x32_bf16 v[196:199], a[20:23], a[80:83], v[196:199]
    v_mfma_f32_16x16x32_bf16 a[96:99], a[24:27], a[80:83], a[96:99]
    s_add_u32 s61, s61, 32768
    ds_read_b128 a[60:63], v7 offset:14336
    v_mfma_f32_16x16x32_bf16 a[100:103], a[28:31], a[80:83], a[100:103]
    s_cmp_ge_u32 s61, 98304
    s_cselect_b32 s90, 98304, 0
    ds_read_b64_tr_b16 a[80:81], v12 offset:16384
    v_mfma_f32_16x16x32_bf16 v[72:75], a[0:3], a[84:87], v[72:75]
    s_sub_u32 s61, s61, s90
    ds_read_b64_tr_b16 a[82:83], v12 offset:18432
    v_mfma_f32_16x16x32_bf16 v[76:79], a[4:7], a[84:87], v[76:79]
    s_add_u32 s64, s64, 32768
    v_mfma_f32_16x16x32_bf16 v[136:139], a[8:11], a[84:87], v[136:139]
    buffer_store_dwordx4 a[192:195], v2, s[24:27], s28 offen sc1
    v_mfma_f32_16x16x32_bf16 v[140:143], a[12:15], a[84:87], v[140:143]
    s_add_u32 s28, s28, s31
    v_mfma_f32_16x16x32_bf16 v[200:203], a[16:19], a[84:87], v[200:203]
    buffer_load_dwordx4 v17, s[40:43], s50 offen offset:1024 lds
    v_mfma_f32_16x16x32_bf16 v[204:207], a[20:23], a[84:87], v[204:207]
    s_add_u32 s50, s50, 128
    v_mfma_f32_16x16x32_bf16 a[104:107], a[24:27], a[84:87], a[104:107]
    s_cmp_ge_u32 s64, 98304
    s_cselect_b32 s63, 4294901760, s59
    s_cselect_b32 s64, 0, s64
    v_mfma_f32_16x16x32_bf16 a[108:111], a[28:31], a[84:87], a[108:111]
    ds_read_b64_tr_b16 a[84:85], v13 offset:16384
    v_mfma_f32_16x16x32_bf16 v[80:83], a[0:3], a[88:91], v[80:83]
    ds_read_b64_tr_b16 a[86:87], v13 offset:18432
    v_mfma_f32_16x16x32_bf16 v[84:87], a[4:7], a[88:91], v[84:87]
    v_mfma_f32_16x16x32_bf16 v[144:147], a[8:11], a[88:91], v[144:147]
    buffer_store_dwordx4 a[196:199], v2, s[24:27], s28 offen sc1
    v_mfma_f32_16x16x32_bf16 v[148:151], a[12:15], a[88:91], v[148:151]
    s_add_u32 s28, s28, s31
    v_mfma_f32_16x16x32_bf16 v[208:211], a[16:19], a[88:91], v[208:211]
    buffer_load_dwordx4 v16, s[40:43], s51 offen offset:2048 lds
    v_mfma_f32_16x16x32_bf16 v[212:215], a[20:23], a[88:91], v[212:215]
    v_mfma_f32_16x16x32_bf16 a[112:115], a[24:27], a[88:91], a[112:115]
    v_mfma_f32_16x16x32_bf16 a[116:119], a[28:31], a[88:91], a[116:119]
    ds_read_b64_tr_b16 a[88:89], v14 offset:16384
    s_waitcnt lgkmcnt(15)
    v_mfma_f32_16x16x32_bf16 v[88:91], a[0:3], a[92:95], v[88:91]
    ds_read_b64_tr_b16 a[90:91], v14 offset:18432
    v_mfma_f32_16x16x32_bf16 v[92:95], a[4:7], a[92:95], v[92:95]
    v_add_u32 v6, s63, v6
    v_add_u32 v7, s63, v7
    v_mfma_f32_16x16x32_bf16 v[152:155], a[8:11], a[92:95], v[152:155]
    buffer_store_dwordx4 a[200:203], v2, s[24:27], s28 offen sc1
    v_mfma_f32_16x16x32_bf16 v[156:159], a[12:15], a[92:95], v[156:159]
    s_add_u32 s28, s28, s31
    v_mfma_f32_16x16x32_bf16 v[216:219], a[16:19], a[92:95], v[216:219]
    buffer_load_dwordx4 v17, s[40:43], s51 offen offset:3072 lds
    v_mfma_f32_16x16x32_bf16 v[220:223], a[20:23], a[92:95], v[220:223]
    s_add_u32 s51, s51, 128
    v_mfma_f32_16x16x32_bf16 a[120:123], a[24:27], a[92:95], a[120:123]
    v_mfma_f32_16x16x32_bf16 a[124:127], a[28:31], a[92:95], a[124:127]
    ds_read_b64_tr_b16 a[92:93], v15 offset:16384
    ds_read_b64_tr_b16 a[94:95], v15 offset:18432
    v_mfma_f32_16x16x32_bf16 v[32:35], a[32:35], a[64:67], v[32:35]
    v_xor_b32 v8, s60, v8
    v_xor_b32 v9, s60, v9
    v_mfma_f32_16x16x32_bf16 v[36:39], a[36:39], a[64:67], v[36:39]
    v_xor_b32 v10, s60, v10
    v_xor_b32 v11, s60, v11
    s_waitcnt lgkmcnt(15)
    v_mfma_f32_16x16x32_bf16 v[96:99], a[40:43], a[64:67], v[96:99]
    v_xor_b32 v12, s60, v12
    v_xor_b32 v13, s60, v13
    v_mfma_f32_16x16x32_bf16 v[100:103], a[44:47], a[64:67], v[100:103]
    v_xor_b32 v14, s60, v14
    v_xor_b32 v15, s60, v15
    s_waitcnt lgkmcnt(13)
    v_mfma_f32_16x16x32_bf16 v[160:163], a[48:51], a[64:67], v[160:163]
    s_waitcnt lgkmcnt(12)
    v_mfma_f32_16x16x32_bf16 v[164:167], a[52:55], a[64:67], v[164:167]
    s_waitcnt lgkmcnt(9)
    v_mfma_f32_16x16x32_bf16 v[224:227], a[56:59], a[64:67], v[224:227]
    s_waitcnt vmcnt(16) lgkmcnt(0)
    v_mfma_f32_16x16x32_bf16 v[228:231], a[60:63], a[64:67], v[228:231]
    s_barrier
    ds_read_b64_tr_b16 a[64:65], v8 offset:0
    v_mfma_f32_16x16x32_bf16 v[40:43], a[32:35], a[68:71], v[40:43]
    s_add_u32 m0, s62, 0
    ds_read_b64_tr_b16 a[66:67], v8 offset:2048
    v_mfma_f32_16x16x32_bf16 v[44:47], a[36:39], a[68:71], v[44:47]
    buffer_load_dwordx4 v18, s[44:47], s52 offen offset:0 lds
    v_mfma_f32_16x16x32_bf16 v[104:107], a[40:43], a[68:71], v[104:107]
    ds_read_b128 a[0:3], v6 offset:0
    v_mfma_f32_16x16x32_bf16 v[108:111], a[44:47], a[68:71], v[108:111]
    v_mfma_f32_16x16x32_bf16 v[168:171], a[48:51], a[68:71], v[168:171]
    v_mfma_f32_16x16x32_bf16 v[172:175], a[52:55], a[68:71], v[172:175]
    buffer_load_dwordx4 v19, s[44:47], s52 offen offset:1024 lds
    v_mfma_f32_16x16x32_bf16 v[232:235], a[56:59], a[68:71], v[232:235]
    s_add_u32 s52, s52, s56
    ds_read_b128 a[4:7], v6 offset:2048
    v_mfma_f32_16x16x32_bf16 v[236:239], a[60:63], a[68:71], v[236:239]
    ds_read_b64_tr_b16 a[68:69], v9 offset:0
    v_mfma_f32_16x16x32_bf16 v[48:51], a[32:35], a[72:75], v[48:51]
    ds_read_b64_tr_b16 a[70:71], v9 offset:2048
    v_mfma_f32_16x16x32_bf16 v[52:55], a[36:39], a[72:75], v[52:55]
    buffer_load_dwordx4 v18, s[44:47], s53 offen offset:2048 lds
    v_mfma_f32_16x16x32_bf16 v[112:115], a[40:43], a[72:75], v[112:115]
    ds_read_b128 a[8:11], v6 offset:4096
    v_mfma_f32_16x16x32_bf16 v[116:119], a[44:47], a[72:75], v[116:119]
    v_mfma_f32_16x16x32_bf16 v[176:179], a[48:51], a[72:75], v[176:179]
    v_mfma_f32_16x16x32_bf16 v[180:183], a[52:55], a[72:75], v[180:183]
    buffer_load_dwordx4 v19, s[44:47], s53 offen offset:3072 lds
    v_mfma_f32_16x16x32_bf16 v[240:243], a[56:59], a[72:75], v[240:243]
    s_add_u32 s53, s53, s56
    ds_read_b128 a[12:15], v6 offset:6144
    v_mfma_f32_16x16x32_bf16 v[244:247], a[60:63], a[72:75], v[244:247]
    ds_read_b64_tr_b16 a[72:73], v10 offset:0
    v_mfma_f32_16x16x32_bf16 v[56:59], a[32:35], a[76:79], v[56:59]
    s_add_u32 m0, s62, 4096
    ds_read_b64_tr_b16 a[74:75], v10 offset:2048
    v_mfma_f32_16x16x32_bf16 v[60:63], a[36:39], a[76:79], v[60:63]
    buffer_load_dwordx4 v20, s[44:47], s54 offen offset:0 lds
    v_mfma_f32_16x16x32_bf16 v[120:123], a[40:43], a[76:79], v[120:123]
    ds_read_b128 a[16:19], v6 offset:8192
    v_mfma_f32_16x16x32_bf16 v[124:127], a[44:47], a[76:79], v[124:127]
    s_xor_b32 s62, s62, 229376
    v_mfma_f32_16x16x32_bf16 v[184:187], a[48:51], a[76:79], v[184:187]
    v_mfma_f32_16x16x32_bf16 v[188:191], a[52:55], a[76:79], v[188:191]
    buffer_load_dwordx4 v21, s[44:47], s54 offen offset:1024 lds
    v_mfma_f32_16x16x32_bf16 v[248:251], a[56:59], a[76:79], v[248:251]
    s_add_u32 s54, s54, s56
    ds_read_b128 a[20:23], v6 offset:10240
    v_mfma_f32_16x16x32_bf16 v[252:255], a[60:63], a[76:79], v[252:255]
    ds_read_b64_tr_b16 a[76:77], v11 offset:0
    v_mfma_f32_16x16x32_bf16 v[64:67], a[32:35], a[80:83], v[64:67]
    ds_read_b64_tr_b16 a[78:79], v11 offset:2048
    v_mfma_f32_16x16x32_bf16 v[68:71], a[36:39], a[80:83], v[68:71]
    buffer_load_dwordx4 v20, s[44:47], s55 offen offset:2048 lds
    v_mfma_f32_16x16x32_bf16 v[128:131], a[40:43], a[80:83], v[128:131]
    ds_read_b128 a[24:27], v6 offset:12288
    v_mfma_f32_16x16x32_bf16 v[132:135], a[44:47], a[80:83], v[132:135]
    v_mfma_f32_16x16x32_bf16 v[192:195], a[48:51], a[80:83], v[192:195]
    v_mfma_f32_16x16x32_bf16 v[196:199], a[52:55], a[80:83], v[196:199]
    buffer_load_dwordx4 v21, s[44:47], s55 offen offset:3072 lds
    v_mfma_f32_16x16x32_bf16 a[96:99], a[56:59], a[80:83], a[96:99]
    s_add_u32 s55, s55, s56
    ds_read_b128 a[28:31], v6 offset:14336
    v_mfma_f32_16x16x32_bf16 a[100:103], a[60:63], a[80:83], a[100:103]
    ds_read_b64_tr_b16 a[80:81], v12 offset:0
    v_mfma_f32_16x16x32_bf16 v[72:75], a[32:35], a[84:87], v[72:75]
    ds_read_b64_tr_b16 a[82:83], v12 offset:2048
    v_mfma_f32_16x16x32_bf16 v[76:79], a[36:39], a[84:87], v[76:79]
    v_mfma_f32_16x16x32_bf16 v[136:139], a[40:43], a[84:87], v[136:139]
    buffer_store_dwordx4 a[204:207], v2, s[24:27], s28 offen sc1
    v_mfma_f32_16x16x32_bf16 v[140:143], a[44:47], a[84:87], v[140:143]
    s_add_u32 s28, s28, s31
    v_mfma_f32_16x16x32_bf16 v[200:203], a[48:51], a[84:87], v[200:203]
    v_mfma_f32_16x16x32_bf16 v[204:207], a[52:55], a[84:87], v[204:207]
    v_mfma_f32_16x16x32_bf16 a[104:107], a[56:59], a[84:87], a[104:107]
    buffer_store_dwordx4 a[208:211], v2, s[24:27], s28 offen sc1
    v_mfma_f32_16x16x32_bf16 a[108:111], a[60:63], a[84:87], a[108:111]
    s_add_u32 s28, s28, s31
    ds_read_b64_tr_b16 a[84:85], v13 offset:0
    v_mfma_f32_16x16x32_bf16 v[80:83], a[32:35], a[88:91], v[80:83]
    ds_read_b64_tr_b16 a[86:87], v13 offset:2048
    v_mfma_f32_16x16x32_bf16 v[84:87], a[36:39], a[88:91], v[84:87]
    v_mfma_f32_16x16x32_bf16 v[144:147], a[40:43], a[88:91], v[144:147]
    buffer_store_dwordx4 a[212:215], v2, s[24:27], s28 offen sc1
    v_mfma_f32_16x16x32_bf16 v[148:151], a[44:47], a[88:91], v[148:151]
    s_add_u32 s28, s28, s31
    v_mfma_f32_16x16x32_bf16 v[208:211], a[48:51], a[88:91], v[208:211]
    v_mfma_f32_16x16x32_bf16 v[212:215], a[52:55], a[88:91], v[212:215]
    v_mfma_f32_16x16x32_bf16 a[112:115], a[56:59], a[88:91], a[112:115]
    buffer_store_dwordx4 a[216:219], v2, s[24:27], s28 offen sc1
    v_mfma_f32_16x16x32_bf16 a[116:119], a[60:63], a[88:91], a[116:119]
    s_add_u32 s28, s28, s31
    ds_read_b64_tr_b16 a[88:89], v14 offset:0
    v_mfma_f32_16x16x32_bf16 v[88:91], a[32:35], a[92:95], v[88:91]
    ds_read_b64_tr_b16 a[90:91], v14 offset:2048
    v_mfma_f32_16x16x32_bf16 v[92:95], a[36:39], a[92:95], v[92:95]
    v_mfma_f32_16x16x32_bf16 v[152:155], a[40:43], a[92:95], v[152:155]
    buffer_store_dwordx4 a[220:223], v2, s[24:27], s28 offen sc1
    v_mfma_f32_16x16x32_bf16 v[156:159], a[44:47], a[92:95], v[156:159]
    s_add_u32 s29, s29, s30
    s_mov_b32 s28, s29
    v_mfma_f32_16x16x32_bf16 v[216:219], a[48:51], a[92:95], v[216:219]
    s_sub_u32 s65, s65, 1
    v_mfma_f32_16x16x32_bf16 v[220:223], a[52:55], a[92:95], v[220:223]
    v_mfma_f32_16x16x32_bf16 a[120:123], a[56:59], a[92:95], a[120:123]
    v_mfma_f32_16x16x32_bf16 a[124:127], a[60:63], a[92:95], a[124:127]
    ds_read_b64_tr_b16 a[92:93], v15 offset:0
    ds_read_b64_tr_b16 a[94:95], v15 offset:2048
    s_waitcnt lgkmcnt(15)
    v_mfma_f32_16x16x32_bf16 v[32:35], a[0:3], a[64:67], v[32:35]
    v_mfma_f32_16x16x32_bf16 v[36:39], a[4:7], a[64:67], v[36:39]
    v_mfma_f32_16x16x32_bf16 v[96:99], a[8:11], a[64:67], v[96:99]
    v_mfma_f32_16x16x32_bf16 v[100:103], a[12:15], a[64:67], v[100:103]
    s_add_u32 m0, s61, 0
    s_waitcnt lgkmcnt(13)
    v_mfma_f32_16x16x32_bf16 v[160:163], a[16:19], a[64:67], v[160:163]
    buffer_load_dwordx4 v16, s[40:43], s48 offen offset:0 lds
    s_waitcnt lgkmcnt(12)
    v_mfma_f32_16x16x32_bf16 v[164:167], a[20:23], a[64:67], v[164:167]
    s_waitcnt lgkmcnt(9)
    v_mfma_f32_16x16x32_bf16 v[224:227], a[24:27], a[64:67], v[224:227]
    s_waitcnt lgkmcnt(8)
    v_mfma_f32_16x16x32_bf16 v[228:231], a[28:31], a[64:67], v[228:231]
    ds_read_b64_tr_b16 a[64:65], v8 offset:16384
    v_mfma_f32_16x16x32_bf16 v[40:43], a[0:3], a[68:71], v[40:43]
    ds_read_b64_tr_b16 a[66:67], v8 offset:18432
    v_mfma_f32_16x16x32_bf16 v[44:47], a[4:7], a[68:71], v[44:47]
    v_mfma_f32_16x16x32_bf16 v[104:107], a[8:11], a[68:71], v[104:107]
    ds_read_b128 a[32:35], v7 offset:0
    v_mfma_f32_16x16x32_bf16 v[108:111], a[12:15], a[68:71], v[108:111]
    v_mfma_f32_16x16x32_bf16 v[168:171], a[16:19], a[68:71], v[168:171]
    buffer_load_dwordx4 v17, s[40:43], s48 offen offset:1024 lds
    v_mfma_f32_16x16x32_bf16 v[172:175], a[20:23], a[68:71], v[172:175]
    s_add_u32 s48, s48, 128
    v_mfma_f32_16x16x32_bf16 v[232:235], a[24:27], a[68:71], v[232:235]
    ds_read_b128 a[36:39], v7 offset:2048
    v_mfma_f32_16x16x32_bf16 v[236:239], a[28:31], a[68:71], v[236:239]
    ds_read_b64_tr_b16 a[68:69], v9 offset:16384
    v_mfma_f32_16x16x32_bf16 v[48:51], a[0:3], a[72:75], v[48:51]
    ds_read_b64_tr_b16 a[70:71], v9 offset:18432
    v_mfma_f32_16x16x32_bf16 v[52:55], a[4:7], a[72:75], v[52:55]
    v_mfma_f32_16x16x32_bf16 v[112:115], a[8:11], a[72:75], v[112:115]
    ds_read_b128 a[40:43], v7 offset:4096
    v_mfma_f32_16x16x32_bf16 v[116:119], a[12:15], a[72:75], v[116:119]
    v_mfma_f32_16x16x32_bf16 v[176:179], a[16:19], a[72:75], v[176:179]
    buffer_load_dwordx4 v16, s[40:43], s49 offen offset:2048 lds
    v_mfma_f32_16x16x32_bf16 v[180:183], a[20:23], a[72:75], v[180:183]
    v_mfma_f32_16x16x32_bf16 v[240:243], a[24:27], a[72:75], v[240:243]
    ds_read_b128 a[44:47], v7 offset:6144
    v_mfma_f32_16x16x32_bf16 v[244:247], a[28:31], a[72:75], v[244:247]
    ds_read_b64_tr_b16 a[72:73], v10 offset:16384
    v_mfma_f32_16x16x32_bf16 v[56:59], a[0:3], a[76:79], v[56:59]
    ds_read_b64_tr_b16 a[74:75], v10 offset:18432
    v_mfma_f32_16x16x32_bf16 v[60:63], a[4:7], a[76:79], v[60:63]
    v_mfma_f32_16x16x32_bf16 v[120:123], a[8:11], a[76:79], v[120:123]
    ds_read_b128 a[48:51], v7 offset:8192
    v_mfma_f32_16x16x32_bf16 v[124:127], a[12:15], a[76:79], v[124:127]
    v_mfma_f32_16x16x32_bf16 v[184:187], a[16:19], a[76:79], v[184:187]
    buffer_load_dwordx4 v17, s[40:43], s49 offen offset:3072 lds
    v_mfma_f32_16x16x32_bf16 v[188:191], a[20:23], a[76:79], v[188:191]
    s_add_u32 s49, s49, 128
    v_mfma_f32_16x16x32_bf16 v[248:251], a[24:27], a[76:79], v[248:251]
    ds_read_b128 a[52:55], v7 offset:10240
    v_mfma_f32_16x16x32_bf16 v[252:255], a[28:31], a[76:79], v[252:255]
    ds_read_b64_tr_b16 a[76:77], v11 offset:16384
    s_waitcnt lgkmcnt(15)
    v_mfma_f32_16x16x32_bf16 v[64:67], a[0:3], a[80:83], v[64:67]
    ds_read_b64_tr_b16 a[78:79], v11 offset:18432
    v_mfma_f32_16x16x32_bf16 v[68:71], a[4:7], a[80:83], v[68:71]
    v_mfma_f32_16x16x32_bf16 v[128:131], a[8:11], a[80:83], v[128:131]
    ds_read_b128 a[56:59], v7 offset:12288
    v_mfma_f32_16x16x32_bf16 v[132:135], a[12:15], a[80:83], v[132:135]
    s_add_u32 m0, s61, 4096
    v_mfma_f32_16x16x32_bf16 v[192:195], a[16:19], a[80:83], v[192:195]
    buffer_load_dwordx4 v16, s[40:43], s50 offen offset:0 lds
    v_mfma_f32_16x16x32_bf16 v[196:199], a[20:23], a[80:83], v[196:199]
    v_mfma_f32_16x16x32_bf16 a[96:99], a[24:27], a[80:83], a[96:99]
    s_add_u32 s61, s61, 32768
    ds_read_b128 a[60:63], v7 offset:14336
    v_mfma_f32_16x16x32_bf16 a[100:103], a[28:31], a[80:83], a[100:103]
    s_cmp_ge_u32 s61, 98304
    s_cselect_b32 s90, 98304, 0
    ds_read_b64_tr_b16 a[80:81], v12 offset:16384
    v_mfma_f32_16x16x32_bf16 v[72:75], a[0:3], a[84:87], v[72:75]
    s_sub_u32 s61, s61, s90
    ds_read_b64_tr_b16 a[82:83], v12 offset:18432
    v_mfma_f32_16x16x32_bf16 v[76:79], a[4:7], a[84:87], v[76:79]
    s_add_u32 s64, s64, 32768
    v_mfma_f32_16x16x32_bf16 v[136:139], a[8:11], a[84:87], v[136:139]
    buffer_store_dwordx4 a[224:227], v2, s[24:27], s28 offen sc1
    v_mfma_f32_16x16x32_bf16 v[140:143], a[12:15], a[84:87], v[140:143]
    s_add_u32 s28, s28, s31
    v_mfma_f32_16x16x32_bf16 v[200:203], a[16:19], a[84:87], v[200:203]
    buffer_load_dwordx4 v17, s[40:43], s50 offen offset:1024 lds
    v_mfma_f32_16x16x32_bf16 v[204:207], a[20:23], a[84:87], v[204:207]
    s_add_u32 s50, s50, 128
    v_mfma_f32_16x16x32_bf16 a[104:107], a[24:27], a[84:87], a[104:107]
    s_cmp_ge_u32 s64, 98304
    s_cselect_b32 s63, 4294901760, s59
    s_cselect_b32 s64, 0, s64
    v_mfma_f32_16x16x32_bf16 a[108:111], a[28:31], a[84:87], a[108:111]
    ds_read_b64_tr_b16 a[84:85], v13 offset:16384
    v_mfma_f32_16x16x32_bf16 v[80:83], a[0:3], a[88:91], v[80:83]
    ds_read_b64_tr_b16 a[86:87], v13 offset:18432
    v_mfma_f32_16x16x32_bf16 v[84:87], a[4:7], a[88:91], v[84:87]
    v_mfma_f32_16x16x32_bf16 v[144:147], a[8:11], a[88:91], v[144:147]
    buffer_store_dwordx4 a[228:231], v2, s[24:27], s28 offen sc1
    v_mfma_f32_16x16x32_bf16 v[148:151], a[12:15], a[88:91], v[148:151]
    s_add_u32 s28, s28, s31
    v_mfma_f32_16x16x32_bf16 v[208:211], a[16:19], a[88:91], v[208:211]
    buffer_load_dwordx4 v16, s[40:43], s51 offen offset:2048 lds
    v_mfma_f32_16x16x32_bf16 v[212:215], a[20:23], a[88:91], v[212:215]
    v_mfma_f32_16x16x32_bf16 a[112:115], a[24:27], a[88:91], a[112:115]
    v_mfma_f32_16x16x32_bf16 a[116:119], a[28:31], a[88:91], a[116:119]
    ds_read_b64_tr_b16 a[88:89], v14 offset:16384
    s_waitcnt lgkmcnt(15)
    v_mfma_f32_16x16x32_bf16 v[88:91], a[0:3], a[92:95], v[88:91]
    ds_read_b64_tr_b16 a[90:91], v14 offset:18432
    v_mfma_f32_16x16x32_bf16 v[92:95], a[4:7], a[92:95], v[92:95]
    v_add_u32 v6, s63, v6
    v_add_u32 v7, s63, v7
    v_mfma_f32_16x16x32_bf16 v[152:155], a[8:11], a[92:95], v[152:155]
    buffer_store_dwordx4 a[232:235], v2, s[24:27], s28 offen sc1
    v_mfma_f32_16x16x32_bf16 v[156:159], a[12:15], a[92:95], v[156:159]
    s_add_u32 s28, s28, s31
    v_mfma_f32_16x16x32_bf16 v[216:219], a[16:19], a[92:95], v[216:219]
    buffer_load_dwordx4 v17, s[40:43], s51 offen offset:3072 lds
    v_mfma_f32_16x16x32_bf16 v[220:223], a[20:23], a[92:95], v[220:223]
    s_add_u32 s51, s51, 128
    v_mfma_f32_16x16x32_bf16 a[120:123], a[24:27], a[92:95], a[120:123]
    v_mfma_f32_16x16x32_bf16 a[124:127], a[28:31], a[92:95], a[124:127]
    ds_read_b64_tr_b16 a[92:93], v15 offset:16384
    ds_read_b64_tr_b16 a[94:95], v15 offset:18432
    v_mfma_f32_16x16x32_bf16 v[32:35], a[32:35], a[64:67], v[32:35]
    v_xor_b32 v8, s60, v8
    v_xor_b32 v9, s60, v9
    v_mfma_f32_16x16x32_bf16 v[36:39], a[36:39], a[64:67], v[36:39]
    v_xor_b32 v10, s60, v10
    v_xor_b32 v11, s60, v11
    s_waitcnt lgkmcnt(15)
    v_mfma_f32_16x16x32_bf16 v[96:99], a[40:43], a[64:67], v[96:99]
    v_xor_b32 v12, s60, v12
    v_xor_b32 v13, s60, v13
    v_mfma_f32_16x16x32_bf16 v[100:103], a[44:47], a[64:67], v[100:103]
    v_xor_b32 v14, s60, v14
    v_xor_b32 v15, s60, v15
    s_waitcnt lgkmcnt(13)
    v_mfma_f32_16x16x32_bf16 v[160:163], a[48:51], a[64:67], v[160:163]
    s_waitcnt lgkmcnt(12)
    v_mfma_f32_16x16x32_bf16 v[164:167], a[52:55], a[64:67], v[164:167]
    s_waitcnt lgkmcnt(9)
    v_mfma_f32_16x16x32_bf16 v[224:227], a[56:59], a[64:67], v[224:227]
    s_waitcnt vmcnt(16) lgkmcnt(0)
    v_mfma_f32_16x16x32_bf16 v[228:231], a[60:63], a[64:67], v[228:231]
    s_barrier
    ds_read_b64_tr_b16 a[64:65], v8 offset:0
    v_mfma_f32_16x16x32_bf16 v[40:43], a[32:35], a[68:71], v[40:43]
    s_add_u32 m0, s62, 0
    ds_read_b64_tr_b16 a[66:67], v8 offset:2048
    v_mfma_f32_16x16x32_bf16 v[44:47], a[36:39], a[68:71], v[44:47]
    buffer_load_dwordx4 v18, s[44:47], s52 offen offset:0 lds
    v_mfma_f32_16x16x32_bf16 v[104:107], a[40:43], a[68:71], v[104:107]
    ds_read_b128 a[0:3], v6 offset:0
    v_mfma_f32_16x16x32_bf16 v[108:111], a[44:47], a[68:71], v[108:111]
    v_mfma_f32_16x16x32_bf16 v[168:171], a[48:51], a[68:71], v[168:171]
    v_mfma_f32_16x16x32_bf16 v[172:175], a[52:55], a[68:71], v[172:175]
    buffer_load_dwordx4 v19, s[44:47], s52 offen offset:1024 lds
    v_mfma_f32_16x16x32_bf16 v[232:235], a[56:59], a[68:71], v[232:235]
    s_add_u32 s52, s52, s56
    ds_read_b128 a[4:7], v6 offset:2048
    v_mfma_f32_16x16x32_bf16 v[236:239], a[60:63], a[68:71], v[236:239]
    ds_read_b64_tr_b16 a[68:69], v9 offset:0
    v_mfma_f32_16x16x32_bf16 v[48:51], a[32:35], a[72:75], v[48:51]
    ds_read_b64_tr_b16 a[70:71], v9 offset:2048
    v_mfma_f32_16x16x32_bf16 v[52:55], a[36:39], a[72:75], v[52:55]
    buffer_load_dwordx4 v18, s[44:47], s53 offen offset:2048 lds
    v_mfma_f32_16x16x32_bf16 v[112:115], a[40:43], a[72:75], v[112:115]
    ds_read_b128 a[8:11], v6 offset:4096
    v_mfma_f32_16x16x32_bf16 v[116:119], a[44:47], a[72:75], v[116:119]
    v_mfma_f32_16x16x32_bf16 v[176:179], a[48:51], a[72:75], v[176:179]
    v_mfma_f32_16x16x32_bf16 v[180:183], a[52:55], a[72:75], v[180:183]
    buffer_load_dwordx4 v19, s[44:47], s53 offen offset:3072 lds
    v_mfma_f32_16x16x32_bf16 v[240:243], a[56:59], a[72:75], v[240:243]
    s_add_u32 s53, s53, s56
    ds_read_b128 a[12:15], v6 offset:6144
    v_mfma_f32_16x16x32_bf16 v[244:247], a[60:63], a[72:75], v[244:247]
    ds_read_b64_tr_b16 a[72:73], v10 offset:0
    v_mfma_f32_16x16x32_bf16 v[56:59], a[32:35], a[76:79], v[56:59]
    s_add_u32 m0, s62, 4096
    ds_read_b64_tr_b16 a[74:75], v10 offset:2048
    v_mfma_f32_16x16x32_bf16 v[60:63], a[36:39], a[76:79], v[60:63]
    buffer_load_dwordx4 v20, s[44:47], s54 offen offset:0 lds
    v_mfma_f32_16x16x32_bf16 v[120:123], a[40:43], a[76:79], v[120:123]
    ds_read_b128 a[16:19], v6 offset:8192
    v_mfma_f32_16x16x32_bf16 v[124:127], a[44:47], a[76:79], v[124:127]
    s_xor_b32 s62, s62, 229376
    v_mfma_f32_16x16x32_bf16 v[184:187], a[48:51], a[76:79], v[184:187]
    v_mfma_f32_16x16x32_bf16 v[188:191], a[52:55], a[76:79], v[188:191]
    buffer_load_dwordx4 v21, s[44:47], s54 offen offset:1024 lds
    v_mfma_f32_16x16x32_bf16 v[248:251], a[56:59], a[76:79], v[248:251]
    s_add_u32 s54, s54, s56
    ds_read_b128 a[20:23], v6 offset:10240
    v_mfma_f32_16x16x32_bf16 v[252:255], a[60:63], a[76:79], v[252:255]
    ds_read_b64_tr_b16 a[76:77], v11 offset:0
    v_mfma_f32_16x16x32_bf16 v[64:67], a[32:35], a[80:83], v[64:67]
    ds_read_b64_tr_b16 a[78:79], v11 offset:2048
    v_mfma_f32_16x16x32_bf16 v[68:71], a[36:39], a[80:83], v[68:71]
    buffer_load_dwordx4 v20, s[44:47], s55 offen offset:2048 lds
    v_mfma_f32_16x16x32_bf16 v[128:131], a[40:43], a[80:83], v[128:131]
    ds_read_b128 a[24:27], v6 offset:12288
    v_mfma_f32_16x16x32_bf16 v[132:135], a[44:47], a[80:83], v[132:135]
    v_mfma_f32_16x16x32_bf16 v[192:195], a[48:51], a[80:83], v[192:195]
    v_mfma_f32_16x16x32_bf16 v[196:199], a[52:55], a[80:83], v[196:199]
    buffer_load_dwordx4 v21, s[44:47], s55 offen offset:3072 lds
    v_mfma_f32_16x16x32_bf16 a[96:99], a[56:59], a[80:83], a[96:99]
    s_add_u32 s55, s55, s56
    ds_read_b128 a[28:31], v6 offset:14336
    v_mfma_f32_16x16x32_bf16 a[100:103], a[60:63], a[80:83], a[100:103]
    ds_read_b64_tr_b16 a[80:81], v12 offset:0
    v_mfma_f32_16x16x32_bf16 v[72:75], a[32:35], a[84:87], v[72:75]
    ds_read_b64_tr_b16 a[82:83], v12 offset:2048
    v_mfma_f32_16x16x32_bf16 v[76:79], a[36:39], a[84:87], v[76:79]
    v_mfma_f32_16x16x32_bf16 v[136:139], a[40:43], a[84:87], v[136:139]
    buffer_store_dwordx4 a[236:239], v2, s[24:27], s28 offen sc1
    v_mfma_f32_16x16x32_bf16 v[140:143], a[44:47], a[84:87], v[140:143]
    s_add_u32 s28, s28, s31
    v_mfma_f32_16x16x32_bf16 v[200:203], a[48:51], a[84:87], v[200:203]
    v_mfma_f32_16x16x32_bf16 v[204:207], a[52:55], a[84:87], v[204:207]
    v_mfma_f32_16x16x32_bf16 a[104:107], a[56:59], a[84:87], a[104:107]
    buffer_store_dwordx4 a[240:243], v2, s[24:27], s28 offen sc1
    v_mfma_f32_16x16x32_bf16 a[108:111], a[60:63], a[84:87], a[108:111]
    s_add_u32 s28, s28, s31
    ds_read_b64_tr_b16 a[84:85], v13 offset:0
    v_mfma_f32_16x16x32_bf16 v[80:83], a[32:35], a[88:91], v[80:83]
    ds_read_b64_tr_b16 a[86:87], v13 offset:2048
    v_mfma_f32_16x16x32_bf16 v[84:87], a[36:39], a[88:91], v[84:87]
    v_mfma_f32_16x16x32_bf16 v[144:147], a[40:43], a[88:91], v[144:147]
    buffer_store_dwordx4 a[244:247], v2, s[24:27], s28 offen sc1
    v_mfma_f32_16x16x32_bf16 v[148:151], a[44:47], a[88:91], v[148:151]
    s_add_u32 s28, s28, s31
    v_mfma_f32_16x16x32_bf16 v[208:211], a[48:51], a[88:91], v[208:211]
    v_mfma_f32_16x16x32_bf16 v[212:215], a[52:55], a[88:91], v[212:215]
    v_mfma_f32_16x16x32_bf16 a[112:115], a[56:59], a[88:91], a[112:115]
    buffer_store_dwordx4 a[248:251], v2, s[24:27], s28 offen sc1
    v_mfma_f32_16x16x32_bf16 a[116:119], a[60:63], a[88:91], a[116:119]
    s_add_u32 s28, s28, s31
    ds_read_b64_tr_b16 a[88:89], v14 offset:0
    v_mfma_f32_16x16x32_bf16 v[88:91], a[32:35], a[92:95], v[88:91]
    ds_read_b64_tr_b16 a[90:91], v14 offset:2048
    v_mfma_f32_16x16x32_bf16 v[92:95], a[36:39], a[92:95], v[92:95]
    v_mfma_f32_16x16x32_bf16 v[152:155], a[40:43], a[92:95], v[152:155]
    buffer_store_dwordx4 a[252:255], v2, s[24:27], s28 offen sc1
    v_mfma_f32_16x16x32_bf16 v[156:159], a[44:47], a[92:95], v[156:159]
    s_add_u32 s29, s29, s30
    s_mov_b32 s28, s29
    v_mfma_f32_16x16x32_bf16 v[216:219], a[48:51], a[92:95], v[216:219]
    s_sub_u32 s65, s65, 1
    v_mfma_f32_16x16x32_bf16 v[220:223], a[52:55], a[92:95], v[220:223]
    v_mfma_f32_16x16x32_bf16 a[120:123], a[56:59], a[92:95], a[120:123]
    v_mfma_f32_16x16x32_bf16 a[124:127], a[60:63], a[92:95], a[124:127]
    ds_read_b64_tr_b16 a[92:93], v15 offset:0
    ds_read_b64_tr_b16 a[94:95], v15 offset:2048
mega_kernel_loop15:
    s_waitcnt lgkmcnt(15)
    v_mfma_f32_16x16x32_bf16 v[32:35], a[0:3], a[64:67], v[32:35]
    v_mfma_f32_16x16x32_bf16 v[36:39], a[4:7], a[64:67], v[36:39]
    v_mfma_f32_16x16x32_bf16 v[96:99], a[8:11], a[64:67], v[96:99]
    v_mfma_f32_16x16x32_bf16 v[100:103], a[12:15], a[64:67], v[100:103]
    s_add_u32 m0, s61, 0
    s_waitcnt lgkmcnt(13)
    v_mfma_f32_16x16x32_bf16 v[160:163], a[16:19], a[64:67], v[160:163]
    buffer_load_dwordx4 v16, s[40:43], s48 offen offset:0 lds
    s_waitcnt lgkmcnt(12)
    v_mfma_f32_16x16x32_bf16 v[164:167], a[20:23], a[64:67], v[164:167]
    s_waitcnt lgkmcnt(9)
    v_mfma_f32_16x16x32_bf16 v[224:227], a[24:27], a[64:67], v[224:227]
    s_waitcnt lgkmcnt(8)
    v_mfma_f32_16x16x32_bf16 v[228:231], a[28:31], a[64:67], v[228:231]
    ds_read_b64_tr_b16 a[64:65], v8 offset:16384
    v_mfma_f32_16x16x32_bf16 v[40:43], a[0:3], a[68:71], v[40:43]
    ds_read_b64_tr_b16 a[66:67], v8 offset:18432
    v_mfma_f32_16x16x32_bf16 v[44:47], a[4:7], a[68:71], v[44:47]
    v_mfma_f32_16x16x32_bf16 v[104:107], a[8:11], a[68:71], v[104:107]
    ds_read_b128 a[32:35], v7 offset:0
    v_mfma_f32_16x16x32_bf16 v[108:111], a[12:15], a[68:71], v[108:111]
    v_mfma_f32_16x16x32_bf16 v[168:171], a[16:19], a[68:71], v[168:171]
    buffer_load_dwordx4 v17, s[40:43], s48 offen offset:1024 lds
    v_mfma_f32_16x16x32_bf16 v[172:175], a[20:23], a[68:71], v[172:175]
    s_add_u32 s48, s48, 128
    v_mfma_f32_16x16x32_bf16 v[232:235], a[24:27], a[68:71], v[232:235]
    ds_read_b128 a[36:39], v7 offset:2048
    v_mfma_f32_16x16x32_bf16 v[236:239], a[28:31], a[68:71], v[236:239]
    ds_read_b64_tr_b16 a[68:69], v9 offset:16384
    v_mfma_f32_16x16x32_bf16 v[48:51], a[0:3], a[72:75], v[48:51]
    ds_read_b64_tr_b16 a[70:71], v9 offset:18432
    v_mfma_f32_16x16x32_bf16 v[52:55], a[4:7], a[72:75], v[52:55]
    v_mfma_f32_16x16x32_bf16 v[112:115], a[8:11], a[72:75], v[112:115]
    ds_read_b128 a[40:43], v7 offset:4096
    v_mfma_f32_16x16x32_bf16 v[116:119], a[12:15], a[72:75], v[116:119]
    v_mfma_f32_16x16x32_bf16 v[176:179], a[16:19], a[72:75], v[176:179]
    buffer_load_dwordx4 v16, s[40:43], s49 offen offset:2048 lds
    v_mfma_f32_16x16x32_bf16 v[180:183], a[20:23], a[72:75], v[180:183]
    v_mfma_f32_16x16x32_bf16 v[240:243], a[24:27], a[72:75], v[240:243]
    ds_read_b128 a[44:47], v7 offset:6144
    v_mfma_f32_16x16x32_bf16 v[244:247], a[28:31], a[72:75], v[244:247]
    ds_read_b64_tr_b16 a[72:73], v10 offset:16384
    v_mfma_f32_16x16x32_bf16 v[56:59], a[0:3], a[76:79], v[56:59]
    ds_read_b64_tr_b16 a[74:75], v10 offset:18432
    v_mfma_f32_16x16x32_bf16 v[60:63], a[4:7], a[76:79], v[60:63]
    v_mfma_f32_16x16x32_bf16 v[120:123], a[8:11], a[76:79], v[120:123]
    ds_read_b128 a[48:51], v7 offset:8192
    v_mfma_f32_16x16x32_bf16 v[124:127], a[12:15], a[76:79], v[124:127]
    v_mfma_f32_16x16x32_bf16 v[184:187], a[16:19], a[76:79], v[184:187]
    buffer_load_dwordx4 v17, s[40:43], s49 offen offset:3072 lds
    v_mfma_f32_16x16x32_bf16 v[188:191], a[20:23], a[76:79], v[188:191]
    s_add_u32 s49, s49, 128
    v_mfma_f32_16x16x32_bf16 v[248:251], a[24:27], a[76:79], v[248:251]
    ds_read_b128 a[52:55], v7 offset:10240
    v_mfma_f32_16x16x32_bf16 v[252:255], a[28:31], a[76:79], v[252:255]
    ds_read_b64_tr_b16 a[76:77], v11 offset:16384
    s_waitcnt lgkmcnt(15)
    v_mfma_f32_16x16x32_bf16 v[64:67], a[0:3], a[80:83], v[64:67]
    ds_read_b64_tr_b16 a[78:79], v11 offset:18432
    v_mfma_f32_16x16x32_bf16 v[68:71], a[4:7], a[80:83], v[68:71]
    v_mfma_f32_16x16x32_bf16 v[128:131], a[8:11], a[80:83], v[128:131]
    ds_read_b128 a[56:59], v7 offset:12288
    v_mfma_f32_16x16x32_bf16 v[132:135], a[12:15], a[80:83], v[132:135]
    s_add_u32 m0, s61, 4096
    v_mfma_f32_16x16x32_bf16 v[192:195], a[16:19], a[80:83], v[192:195]
    buffer_load_dwordx4 v16, s[40:43], s50 offen offset:0 lds
    v_mfma_f32_16x16x32_bf16 v[196:199], a[20:23], a[80:83], v[196:199]
    v_mfma_f32_16x16x32_bf16 a[96:99], a[24:27], a[80:83], a[96:99]
    s_add_u32 s61, s61, 32768
    ds_read_b128 a[60:63], v7 offset:14336
    v_mfma_f32_16x16x32_bf16 a[100:103], a[28:31], a[80:83], a[100:103]
    s_cmp_ge_u32 s61, 98304
    s_cselect_b32 s90, 98304, 0
    ds_read_b64_tr_b16 a[80:81], v12 offset:16384
    v_mfma_f32_16x16x32_bf16 v[72:75], a[0:3], a[84:87], v[72:75]
    s_sub_u32 s61, s61, s90
    ds_read_b64_tr_b16 a[82:83], v12 offset:18432
    v_mfma_f32_16x16x32_bf16 v[76:79], a[4:7], a[84:87], v[76:79]
    s_add_u32 s64, s64, 32768
    v_mfma_f32_16x16x32_bf16 v[136:139], a[8:11], a[84:87], v[136:139]
    s_cmp_ge_u32 s64, 98304
    s_cselect_b32 s63, 4294901760, s59
    s_cselect_b32 s64, 0, s64
    v_mfma_f32_16x16x32_bf16 v[140:143], a[12:15], a[84:87], v[140:143]
    v_mfma_f32_16x16x32_bf16 v[200:203], a[16:19], a[84:87], v[200:203]
    buffer_load_dwordx4 v17, s[40:43], s50 offen offset:1024 lds
    v_mfma_f32_16x16x32_bf16 v[204:207], a[20:23], a[84:87], v[204:207]
    s_add_u32 s50, s50, 128
    v_mfma_f32_16x16x32_bf16 a[104:107], a[24:27], a[84:87], a[104:107]
    v_mfma_f32_16x16x32_bf16 a[108:111], a[28:31], a[84:87], a[108:111]
    ds_read_b64_tr_b16 a[84:85], v13 offset:16384
    v_mfma_f32_16x16x32_bf16 v[80:83], a[0:3], a[88:91], v[80:83]
    ds_read_b64_tr_b16 a[86:87], v13 offset:18432
    v_mfma_f32_16x16x32_bf16 v[84:87], a[4:7], a[88:91], v[84:87]
    v_mfma_f32_16x16x32_bf16 v[144:147], a[8:11], a[88:91], v[144:147]
    v_mfma_f32_16x16x32_bf16 v[148:151], a[12:15], a[88:91], v[148:151]
    v_mfma_f32_16x16x32_bf16 v[208:211], a[16:19], a[88:91], v[208:211]
    buffer_load_dwordx4 v16, s[40:43], s51 offen offset:2048 lds
    v_mfma_f32_16x16x32_bf16 v[212:215], a[20:23], a[88:91], v[212:215]
    v_mfma_f32_16x16x32_bf16 a[112:115], a[24:27], a[88:91], a[112:115]
    v_mfma_f32_16x16x32_bf16 a[116:119], a[28:31], a[88:91], a[116:119]
    ds_read_b64_tr_b16 a[88:89], v14 offset:16384
    s_waitcnt lgkmcnt(15)
    v_mfma_f32_16x16x32_bf16 v[88:91], a[0:3], a[92:95], v[88:91]
    ds_read_b64_tr_b16 a[90:91], v14 offset:18432
    v_mfma_f32_16x16x32_bf16 v[92:95], a[4:7], a[92:95], v[92:95]
    v_add_u32 v6, s63, v6
    v_add_u32 v7, s63, v7
    v_mfma_f32_16x16x32_bf16 v[152:155], a[8:11], a[92:95], v[152:155]
    v_mfma_f32_16x16x32_bf16 v[156:159], a[12:15], a[92:95], v[156:159]
    v_mfma_f32_16x16x32_bf16 v[216:219], a[16:19], a[92:95], v[216:219]
    buffer_load_dwordx4 v17, s[40:43], s51 offen offset:3072 lds
    v_mfma_f32_16x16x32_bf16 v[220:223], a[20:23], a[92:95], v[220:223]
    s_add_u32 s51, s51, 128
    v_mfma_f32_16x16x32_bf16 a[120:123], a[24:27], a[92:95], a[120:123]
    v_mfma_f32_16x16x32_bf16 a[124:127], a[28:31], a[92:95], a[124:127]
    ds_read_b64_tr_b16 a[92:93], v15 offset:16384
    ds_read_b64_tr_b16 a[94:95], v15 offset:18432
    v_mfma_f32_16x16x32_bf16 v[32:35], a[32:35], a[64:67], v[32:35]
    v_xor_b32 v8, s60, v8
    v_xor_b32 v9, s60, v9
    v_mfma_f32_16x16x32_bf16 v[36:39], a[36:39], a[64:67], v[36:39]
    v_xor_b32 v10, s60, v10
    v_xor_b32 v11, s60, v11
    s_waitcnt lgkmcnt(15)
    v_mfma_f32_16x16x32_bf16 v[96:99], a[40:43], a[64:67], v[96:99]
    v_xor_b32 v12, s60, v12
    v_xor_b32 v13, s60, v13
    v_mfma_f32_16x16x32_bf16 v[100:103], a[44:47], a[64:67], v[100:103]
    v_xor_b32 v14, s60, v14
    v_xor_b32 v15, s60, v15
    s_waitcnt lgkmcnt(13)
    v_mfma_f32_16x16x32_bf16 v[160:163], a[48:51], a[64:67], v[160:163]
    s_waitcnt lgkmcnt(12)
    v_mfma_f32_16x16x32_bf16 v[164:167], a[52:55], a[64:67], v[164:167]
    s_waitcnt lgkmcnt(9)
    v_mfma_f32_16x16x32_bf16 v[224:227], a[56:59], a[64:67], v[224:227]
    s_waitcnt vmcnt(8) lgkmcnt(0)
    v_mfma_f32_16x16x32_bf16 v[228:231], a[60:63], a[64:67], v[228:231]
    s_barrier
    ds_read_b64_tr_b16 a[64:65], v8 offset:0
    v_mfma_f32_16x16x32_bf16 v[40:43], a[32:35], a[68:71], v[40:43]
    s_add_u32 m0, s62, 0
    ds_read_b64_tr_b16 a[66:67], v8 offset:2048
    v_mfma_f32_16x16x32_bf16 v[44:47], a[36:39], a[68:71], v[44:47]
    buffer_load_dwordx4 v18, s[44:47], s52 offen offset:0 lds
    v_mfma_f32_16x16x32_bf16 v[104:107], a[40:43], a[68:71], v[104:107]
    ds_read_b128 a[0:3], v6 offset:0
    v_mfma_f32_16x16x32_bf16 v[108:111], a[44:47], a[68:71], v[108:111]
    v_mfma_f32_16x16x32_bf16 v[168:171], a[48:51], a[68:71], v[168:171]
    v_mfma_f32_16x16x32_bf16 v[172:175], a[52:55], a[68:71], v[172:175]
    buffer_load_dwordx4 v19, s[44:47], s52 offen offset:1024 lds
    v_mfma_f32_16x16x32_bf16 v[232:235], a[56:59], a[68:71], v[232:235]
    s_add_u32 s52, s52, s56
    ds_read_b128 a[4:7], v6 offset:2048
    v_mfma_f32_16x16x32_bf16 v[236:239], a[60:63], a[68:71], v[236:239]
    ds_read_b64_tr_b16 a[68:69], v9 offset:0
    v_mfma_f32_16x16x32_bf16 v[48:51], a[32:35], a[72:75], v[48:51]
    ds_read_b64_tr_b16 a[70:71], v9 offset:2048
    v_mfma_f32_16x16x32_bf16 v[52:55], a[36:39], a[72:75], v[52:55]
    buffer_load_dwordx4 v18, s[44:47], s53 offen offset:2048 lds
    v_mfma_f32_16x16x32_bf16 v[112:115], a[40:43], a[72:75], v[112:115]
    ds_read_b128 a[8:11], v6 offset:4096
    v_mfma_f32_16x16x32_bf16 v[116:119], a[44:47], a[72:75], v[116:119]
    v_mfma_f32_16x16x32_bf16 v[176:179], a[48:51], a[72:75], v[176:179]
    v_mfma_f32_16x16x32_bf16 v[180:183], a[52:55], a[72:75], v[180:183]
    buffer_load_dwordx4 v19, s[44:47], s53 offen offset:3072 lds
    v_mfma_f32_16x16x32_bf16 v[240:243], a[56:59], a[72:75], v[240:243]
    s_add_u32 s53, s53, s56
    ds_read_b128 a[12:15], v6 offset:6144
    v_mfma_f32_16x16x32_bf16 v[244:247], a[60:63], a[72:75], v[244:247]
    ds_read_b64_tr_b16 a[72:73], v10 offset:0
    v_mfma_f32_16x16x32_bf16 v[56:59], a[32:35], a[76:79], v[56:59]
    s_add_u32 m0, s62, 4096
    ds_read_b64_tr_b16 a[74:75], v10 offset:2048
    v_mfma_f32_16x16x32_bf16 v[60:63], a[36:39], a[76:79], v[60:63]
    buffer_load_dwordx4 v20, s[44:47], s54 offen offset:0 lds
    v_mfma_f32_16x16x32_bf16 v[120:123], a[40:43], a[76:79], v[120:123]
    ds_read_b128 a[16:19], v6 offset:8192
    v_mfma_f32_16x16x32_bf16 v[124:127], a[44:47], a[76:79], v[124:127]
    s_xor_b32 s62, s62, 229376
    v_mfma_f32_16x16x32_bf16 v[184:187], a[48:51], a[76:79], v[184:187]
    v_mfma_f32_16x16x32_bf16 v[188:191], a[52:55], a[76:79], v[188:191]
    buffer_load_dwordx4 v21, s[44:47], s54 offen offset:1024 lds
    v_mfma_f32_16x16x32_bf16 v[248:251], a[56:59], a[76:79], v[248:251]
    s_add_u32 s54, s54, s56
    ds_read_b128 a[20:23], v6 offset:10240
    v_mfma_f32_16x16x32_bf16 v[252:255], a[60:63], a[76:79], v[252:255]
    ds_read_b64_tr_b16 a[76:77], v11 offset:0
    v_mfma_f32_16x16x32_bf16 v[64:67], a[32:35], a[80:83], v[64:67]
    ds_read_b64_tr_b16 a[78:79], v11 offset:2048
    v_mfma_f32_16x16x32_bf16 v[68:71], a[36:39], a[80:83], v[68:71]
    buffer_load_dwordx4 v20, s[44:47], s55 offen offset:2048 lds
    v_mfma_f32_16x16x32_bf16 v[128:131], a[40:43], a[80:83], v[128:131]
    ds_read_b128 a[24:27], v6 offset:12288
    v_mfma_f32_16x16x32_bf16 v[132:135], a[44:47], a[80:83], v[132:135]
    v_mfma_f32_16x16x32_bf16 v[192:195], a[48:51], a[80:83], v[192:195]
    v_mfma_f32_16x16x32_bf16 v[196:199], a[52:55], a[80:83], v[196:199]
    buffer_load_dwordx4 v21, s[44:47], s55 offen offset:3072 lds
    v_mfma_f32_16x16x32_bf16 a[96:99], a[56:59], a[80:83], a[96:99]
    s_add_u32 s55, s55, s56
    ds_read_b128 a[28:31], v6 offset:14336
    v_mfma_f32_16x16x32_bf16 a[100:103], a[60:63], a[80:83], a[100:103]
    ds_read_b64_tr_b16 a[80:81], v12 offset:0
    v_mfma_f32_16x16x32_bf16 v[72:75], a[32:35], a[84:87], v[72:75]
    ds_read_b64_tr_b16 a[82:83], v12 offset:2048
    v_mfma_f32_16x16x32_bf16 v[76:79], a[36:39], a[84:87], v[76:79]
    v_mfma_f32_16x16x32_bf16 v[136:139], a[40:43], a[84:87], v[136:139]
    v_mfma_f32_16x16x32_bf16 v[140:143], a[44:47], a[84:87], v[140:143]
    v_mfma_f32_16x16x32_bf16 v[200:203], a[48:51], a[84:87], v[200:203]
    v_mfma_f32_16x16x32_bf16 v[204:207], a[52:55], a[84:87], v[204:207]
    v_mfma_f32_16x16x32_bf16 a[104:107], a[56:59], a[84:87], a[104:107]
    v_mfma_f32_16x16x32_bf16 a[108:111], a[60:63], a[84:87], a[108:111]
    ds_read_b64_tr_b16 a[84:85], v13 offset:0
    v_mfma_f32_16x16x32_bf16 v[80:83], a[32:35], a[88:91], v[80:83]
    ds_read_b64_tr_b16 a[86:87], v13 offset:2048
    v_mfma_f32_16x16x32_bf16 v[84:87], a[36:39], a[88:91], v[84:87]
    v_mfma_f32_16x16x32_bf16 v[144:147], a[40:43], a[88:91], v[144:147]
    v_mfma_f32_16x16x32_bf16 v[148:151], a[44:47], a[88:91], v[148:151]
    v_mfma_f32_16x16x32_bf16 v[208:211], a[48:51], a[88:91], v[208:211]
    v_mfma_f32_16x16x32_bf16 v[212:215], a[52:55], a[88:91], v[212:215]
    v_mfma_f32_16x16x32_bf16 a[112:115], a[56:59], a[88:91], a[112:115]
    v_mfma_f32_16x16x32_bf16 a[116:119], a[60:63], a[88:91], a[116:119]
    ds_read_b64_tr_b16 a[88:89], v14 offset:0
    v_mfma_f32_16x16x32_bf16 v[88:91], a[32:35], a[92:95], v[88:91]
    ds_read_b64_tr_b16 a[90:91], v14 offset:2048
    v_mfma_f32_16x16x32_bf16 v[92:95], a[36:39], a[92:95], v[92:95]
    v_mfma_f32_16x16x32_bf16 v[152:155], a[40:43], a[92:95], v[152:155]
    v_mfma_f32_16x16x32_bf16 v[156:159], a[44:47], a[92:95], v[156:159]
    v_mfma_f32_16x16x32_bf16 v[216:219], a[48:51], a[92:95], v[216:219]
    s_sub_u32 s65, s65, 1
    v_mfma_f32_16x16x32_bf16 v[220:223], a[52:55], a[92:95], v[220:223]
    v_mfma_f32_16x16x32_bf16 a[120:123], a[56:59], a[92:95], a[120:123]
    s_cmp_gt_u32 s65, s67
    v_mfma_f32_16x16x32_bf16 a[124:127], a[60:63], a[92:95], a[124:127]
    ds_read_b64_tr_b16 a[92:93], v15 offset:0
    ds_read_b64_tr_b16 a[94:95], v15 offset:2048
    s_cbranch_scc1 mega_kernel_loop15
    s_cmp_lg_u32 s65, 0
    s_cbranch_scc1 mega_kernel_dosw16
mega_kernel_epi11:
    s_cmp_eq_u32 s94, 0
    s_cbranch_scc1 mega_kernel_last19
    s_mov_b32 s3, 1048576
mega_kernel_spin23:
    v_readfirstlane_b32 s4, v4
    v_readfirstlane_b32 s5, v5
    s_nop 3
    s_cmp_lg_u32 s4, 0
    s_cbranch_scc1 mega_kernel_ok24
    s_sub_u32 s3, s3, 1
    s_cbranch_scc1 mega_kernel_ok24
    s_sleep 32
    buffer_load_dwordx2 v[4:5], off, s[12:15], 0 sc1
    s_waitcnt vmcnt(0)
    s_branch mega_kernel_spin23
mega_kernel_ok24:
    s_call_b64 s[20:21], mega_kernel_eps18
    s_mov_b32 s17, s101
    s_mov_b32 s28, s98
    s_mov_b32 s29, s98
    s_mov_b32 s30, s99
    s_mov_b32 s31, s100
    s_mov_b32 s26, 268435456
    s_mov_b32 s95, s82
    s_mov_b32 s96, s83
    s_mov_b32 s97, s84
    s_mov_b32 s98, s85
    s_mov_b32 s99, s86
    s_mov_b32 s100, s87
    s_mov_b32 s101, s88
    s_sub_u32 s67, s95, 5
    s_mov_b32 s94, 0
    s_branch mega_kernel_tile10
mega_kernel_last19:
    s_cmp_eq_u32 s70, 0
    s_cbranch_scc1 mega_kernel_kvl22
    buffer_load_dwordx2 v[4:5], off, s[12:15], 0 sc1
    s_call_b64 s[20:21], mega_kernel_epf17
    s_waitcnt vmcnt(0)
    s_barrier
    s_mov_b32 s3, 1048576
mega_kernel_spin25:
    v_readfirstlane_b32 s4, v4
    v_readfirstlane_b32 s5, v5
    s_nop 3
    s_cmp_lg_u32 s4, 0
    s_cbranch_scc1 mega_kernel_ok26
    s_sub_u32 s3, s3, 1
    s_cbranch_scc1 mega_kernel_ok26
    s_sleep 32
    buffer_load_dwordx2 v[4:5], off, s[12:15], 0 sc1
    s_waitcnt vmcnt(0)
    s_branch mega_kernel_spin25
mega_kernel_ok26:
    s_cmp_lg_u32 s16, 0
    s_cbranch_scc1 mega_kernel_np27
    v_mov_b32 v4, s4
    v_mov_b32 v5, s5
    s_add_u32 s90, s101, 117440512
    s_mov_b64 exec, 1
    buffer_store_dwordx2 v[4:5], off, s[8:11], s90 sc1
    s_mov_b64 exec, -1
mega_kernel_np27:
    s_cmp_lg_u32 s16, 0
    s_cbranch_scc1 mega_kernel_pw28
    s_and_b32 s92, s2, 7
    s_lshl_b32 s92, s92, 2
    s_bfe_u32 s93, s2, 0x20003
    s_add_u32 s92, s92, s93
    s_lshr_b32 s93, s2, 5
    s_lshl_b32 s93, s93, 2
    s_or_b32 s93, s93, 0x40000
    s_lshr_b32 s90, s92, 1
    s_lshl_b32 s90, s90, 7
    s_add_u32 s90, s90, 117440512
    s_bfe_u32 s91, 1108370803, s93
    s_lshr_b32 s91, s91, 1
    v_mov_b32 v0, s91
    v_add_u32 v4, 8, v1
    v_cmp_gt_u32 vcc, 8, v1
    s_nop 1
    v_cndmask_b32 v0, v0, v4, vcc
    s_bfe_u32 s91, 4242446987, s93
    s_lshr_b32 s91, s91, 1
    v_writelane_b32 v0, s91, 8
    v_lshlrev_b32 v0, 3, v0
    buffer_load_dwordx2 v[4:5], v0, s[8:11], s90 offen sc1
    s_waitcnt vmcnt(0)
    s_mov_b32 s3, 1048576
mega_kernel_spin29:
    v_cmp_ne_u64 s[22:23], s[4:5], v[4:5]
    s_nop 3
    s_cmp_eq_u64 s[22:23], 0
    s_cbranch_scc1 mega_kernel_ok30
    s_sub_u32 s3, s3, 1
    s_cbranch_scc1 mega_kernel_ok30
    s_sleep 16
    s_and_b32 s92, s2, 7
    s_lshl_b32 s92, s92, 2
    s_bfe_u32 s93, s2, 0x20003
    s_add_u32 s92, s92, s93
    s_lshr_b32 s93, s2, 5
    s_lshl_b32 s93, s93, 2
    s_or_b32 s93, s93, 0x40000
    s_lshr_b32 s90, s92, 1
    s_lshl_b32 s90, s90, 7
    s_add_u32 s90, s90, 117440512
    s_bfe_u32 s91, 1108370803, s93
    s_lshr_b32 s91, s91, 1
    v_mov_b32 v0, s91
    v_add_u32 v4, 8, v1
    v_cmp_gt_u32 vcc, 8, v1
    s_nop 1
    v_cndmask_b32 v0, v0, v4, vcc
    s_bfe_u32 s91, 4242446987, s93
    s_lshr_b32 s91, s91, 1
    v_writelane_b32 v0, s91, 8
    v_lshlrev_b32 v0, 3, v0
    buffer_load_dwordx2 v[4:5], v0, s[8:11], s90 offen sc1
    s_waitcnt vmcnt(0)
    s_branch mega_kernel_spin29
mega_kernel_ok30:
mega_kernel_pw28:
    s_barrier
    s_and_b32 s92, s2, 7
    s_lshl_b32 s92, s92, 2
    s_bfe_u32 s93, s2, 0x20003
    s_add_u32 s92, s92, s93
    s_lshr_b32 s93, s2, 5
    s_lshl_b32 s93, s93, 2
    s_or_b32 s93, s93, 0x40000
    s_bfe_u32 s90, 4242446987, s93
    s_lshl_b32 s90, s90, 3
    s_lshl_b32 s91, s16, 1
    s_add_u32 s90, s90, s91
    s_lshl_b32 s90, s90, 12
    s_lshl_b32 s91, s92, 19
    s_add_u32 s90, s90, s91
    s_add_u32 s90, s90, 0
    buffer_load_dwordx4 a[128:131], v2, s[8:11], s90 offen offset:0 sc1
    buffer_load_dwordx4 a[132:135], v2, s[8:11], s90 offen offset:1024 sc1
    buffer_load_dwordx4 a[136:139], v2, s[8:11], s90 offen offset:2048 sc1
    buffer_load_dwordx4 a[140:143], v2, s[8:11], s90 offen offset:3072 sc1
    s_bfe_u32 s90, 4242446987, s93
    s_lshl_b32 s90, s90, 3
    s_lshl_b32 s91, s16, 1
    s_add_u32 s90, s90, s91
    s_lshl_b32 s90, s90, 12
    s_lshl_b32 s91, s92, 19
    s_add_u32 s90, s90, s91
    s_add_u32 s90, s90, 4096
    buffer_load_dwordx4 a[144:147], v2, s[8:11], s90 offen offset:0 sc1
    buffer_load_dwordx4 a[148:151], v2, s[8:11], s90 offen offset:1024 sc1
    buffer_load_dwordx4 a[152:155], v2, s[8:11], s90 offen offset:2048 sc1
    buffer_load_dwordx4 a[156:159], v2, s[8:11], s90 offen offset:3072 sc1
    s_bfe_u32 s90, 1108370803, s93
    s_lshl_b32 s90, s90, 3
    s_lshl_b32 s91, s16, 1
    s_add_u32 s90, s90, s91
    s_lshl_b32 s90, s90, 12
    s_lshl_b32 s91, s92, 19
    s_add_u32 s90, s90, s91
    s_add_u32 s90, s90, 0
    buffer_load_dwordx4 a[160:163], v2, s[8:11], s90 offen offset:0 sc1
    buffer_load_dwordx4 a[164:167], v2, s[8:11], s90 offen offset:1024 sc1
    buffer_load_dwordx4 a[168:171], v2, s[8:11], s90 offen offset:2048 sc1
    buffer_load_dwordx4 a[172:175], v2, s[8:11], s90 offen offset:3072 sc1
    s_bfe_u32 s90, 1108370803, s93
    s_lshl_b32 s90, s90, 3
    s_lshl_b32 s91, s16, 1
    s_add_u32 s90, s90, s91
    s_lshl_b32 s90, s90, 12
    s_lshl_b32 s91, s92, 19
    s_add_u32 s90, s90, s91
    s_add_u32 s90, s90, 4096
    buffer_load_dwordx4 a[176:179], v2, s[8:11], s90 offen offset:0 sc1
    buffer_load_dwordx4 a[180:183], v2, s[8:11], s90 offen offset:1024 sc1
    buffer_load_dwordx4 a[184:187], v2, s[8:11], s90 offen offset:2048 sc1
    buffer_load_dwordx4 a[188:191], v2, s[8:11], s90 offen offset:3072 sc1
    s_mov_b32 s94, 1
mega_kernel_kvl22:
    s_waitcnt lgkmcnt(0)
    s_barrier
    s_and_b32 s92, s2, 7
    s_lshl_b32 s92, s92, 2
    s_bfe_u32 s93, s2, 0x20003
    s_add_u32 s92, s92, s93
    s_lshr_b32 s93, s2, 5
    s_lshl_b32 s93, s93, 2
    s_or_b32 s93, s93, 0x40000
    s_mov_b32 s32, s92
    s_bfe_u32 s33, 4242446987, s93
    s_add_u32 s33, s33, 1
    s_bfe_u32 s34, 1108370803, s93
    s_add_u32 s34, s34, 1
    s_lshl_b32 s56, s16, 12
    v_add_u32 v7, s56, v2
    s_lshl_b32 s90, s34, 2
    s_lshl_b32 s91, s33, 2
    s_lshl_b32 s26, s91, 13
    s_mov_b32 s30, s26
    s_sub_u32 s63, s90, 4
    s_add_u32 s63, s63, s16
    s_add_u32 s64, s63, 1
    s_mov_b32 s65, s90
    s_sub_u32 s66, s91, 4
    s_add_u32 s66, s66, s16
    s_add_u32 s67, s66, 1
    s_mov_b32 s68, s91
    s_mov_b32 s27, 0x20000
    s_mov_b32 s31, 0x20000
    s_lshl_b32 s78, s32, 19
    s_add_u32 s90, s78, 16777216
    s_add_u32 s24, s6, s90
    s_addc_u32 s25, s7, 0
    s_add_u32 s90, s78, 33554432
    s_add_u32 s28, s6, s90
    s_addc_u32 s29, s7, 0
    s_cmp_eq_u32 s94, 1
    s_cbranch_scc1 mega_kernel_w055
    s_mov_b32 s52, 32768
    s_mov_b32 s53, 16384
    s_add_u32 s55, s56, 65536
    s_mov_b32 m0, s55
    s_nop 0
    buffer_load_dwordx4 v7, s[24:27], s52 offen offset:0 sc1 lds
    buffer_load_dwordx4 v7, s[24:27], s52 offen offset:1024 sc1 lds
    buffer_load_dwordx4 v7, s[24:27], s52 offen offset:2048 sc1 lds
    buffer_load_dwordx4 v7, s[24:27], s52 offen offset:3072 sc1 lds
    s_add_u32 s52, s52, 16384
    s_add_u32 m0, s55, 16384
    s_nop 0
    buffer_load_dwordx4 v7, s[28:31], s53 offen offset:0 sc1 lds
    buffer_load_dwordx4 v7, s[28:31], s53 offen offset:1024 sc1 lds
    buffer_load_dwordx4 v7, s[28:31], s53 offen offset:2048 sc1 lds
    buffer_load_dwordx4 v7, s[28:31], s53 offen offset:3072 sc1 lds
    s_add_u32 s53, s53, 16384
    s_call_b64 s[20:21], mega_kernel_epl53
    s_mov_b32 s17, s101
    s_mov_b32 s38, 268435456
    s_branch mega_kernel_init21
mega_kernel_w055:
    s_mov_b32 s52, 0
    s_mov_b32 s53, 0
    s_mov_b32 m0, s56
    s_nop 0
    buffer_load_dwordx4 v7, s[24:27], s52 offen offset:0 sc1 lds
    buffer_load_dwordx4 v7, s[24:27], s52 offen offset:1024 sc1 lds
    buffer_load_dwordx4 v7, s[24:27], s52 offen offset:2048 sc1 lds
    buffer_load_dwordx4 v7, s[24:27], s52 offen offset:3072 sc1 lds
    s_mov_b32 s52, 16384
    s_add_u32 s55, s56, 32768
    s_mov_b32 m0, s55
    s_nop 0
    buffer_load_dwordx4 v7, s[24:27], s52 offen offset:0 sc1 lds
    buffer_load_dwordx4 v7, s[24:27], s52 offen offset:1024 sc1 lds
    buffer_load_dwordx4 v7, s[24:27], s52 offen offset:2048 sc1 lds
    buffer_load_dwordx4 v7, s[24:27], s52 offen offset:3072 sc1 lds
    s_add_u32 s52, s52, 16384
    s_add_u32 m0, s55, 16384
    s_nop 0
    buffer_load_dwordx4 v7, s[28:31], s53 offen offset:0 sc1 lds
    buffer_load_dwordx4 v7, s[28:31], s53 offen offset:1024 sc1 lds
    buffer_load_dwordx4 v7, s[28:31], s53 offen offset:2048 sc1 lds
    buffer_load_dwordx4 v7, s[28:31], s53 offen offset:3072 sc1 lds
    s_add_u32 s53, s53, 16384
    s_add_u32 s55, s55, 32768
    s_mov_b32 m0, s55
    s_nop 0
    buffer_load_dwordx4 v7, s[24:27], s52 offen offset:0 sc1 lds
    buffer_load_dwordx4 v7, s[24:27], s52 offen offset:1024 sc1 lds
    buffer_load_dwordx4 v7, s[24:27], s52 offen offset:2048 sc1 lds
    buffer_load_dwordx4 v7, s[24:27], s52 offen offset:3072 sc1 lds
    s_add_u32 s52, s52, 16384
    s_add_u32 m0, s55, 16384
    s_nop 0
    buffer_load_dwordx4 v7, s[28:31], s53 offen offset:0 sc1 lds
    buffer_load_dwordx4 v7, s[28:31], s53 offen offset:1024 sc1 lds
    buffer_load_dwordx4 v7, s[28:31], s53 offen offset:2048 sc1 lds
    buffer_load_dwordx4 v7, s[28:31], s53 offen offset:3072 sc1 lds
    s_add_u32 s53, s53, 16384
    s_add_u32 s55, s55, 32768
    s_mov_b32 m0, s55
    s_nop 0
    buffer_load_dwordx4 v7, s[24:27], s52 offen offset:0 sc1 lds
    buffer_load_dwordx4 v7, s[24:27], s52 offen offset:1024 sc1 lds
    buffer_load_dwordx4 v7, s[24:27], s52 offen offset:2048 sc1 lds
    buffer_load_dwordx4 v7, s[24:27], s52 offen offset:3072 sc1 lds
    s_add_u32 s52, s52, 16384
    s_add_u32 m0, s55, 16384
    s_nop 0
    buffer_load_dwordx4 v7, s[28:31], s53 offen offset:0 sc1 lds
    buffer_load_dwordx4 v7, s[28:31], s53 offen offset:1024 sc1 lds
    buffer_load_dwordx4 v7, s[28:31], s53 offen offset:2048 sc1 lds
    buffer_load_dwordx4 v7, s[28:31], s53 offen offset:3072 sc1 lds
    s_add_u32 s53, s53, 16384
    s_add_u32 s55, s55, 32768
    s_waitcnt vmcnt(0)
    s_mov_b32 s38, 0
mega_kernel_init21:
    s_mov_b32 s52, 65536
    s_mov_b32 s53, 49152
    s_nop 1
    v_mov_b32 v9, 0xff800000
    s_mov_b32 s61, 1233125376
    s_lshl_b32 s91, s16, 1
    s_sub_u32 s91, s91, 8
    s_lshl_b32 s74, s33, 3
    s_add_u32 s74, s74, s91
    s_lshl_b32 s75, s34, 3
    s_add_u32 s75, s75, s91
    s_mov_b32 s36, s6
    s_mov_b32 s37, s7
    s_mov_b32 s39, 0x20000
    s_load_dwordx2 s[48:49], s[0:1], 64
    s_load_dwordx2 s[50:51], s[0:1], 16
    s_mov_b32 s47, 0x20000
    s_lshl_b32 s90, s99, 1
    s_add_u32 s98, s98, s90
    s_lshl_b32 s90, s100, 2
    s_add_u32 s40, s98, s90
    s_lshr_b32 s90, s32, 1
    s_lshl_b32 s90, s90, 7
    s_add_u32 s90, s90, 117444608
    s_lshr_b32 s91, s2, 6
    s_lshl_b32 s91, s91, 8
    s_add_u32 s91, s91, 117446592
    v_min_u32 v10, 31, v1
    v_lshlrev_b32 v10, 3, v10
    v_mov_b32 v11, s90
    v_mov_b32 v8, s91
    v_cmp_gt_u32 vcc, 8, v1
    s_nop 1
    v_cndmask_b32 v11, v8, v11, vcc
    v_add_u32 v10, v10, v11
    s_lshl_b32 s90, s16, 8
    s_add_u32 s90, s90, s2
    s_cmp_ge_u32 s90, 128
    s_cbranch_scc1 mega_kernel_c356
    s_lshl_b32 s90, s90, 7
    s_add_u32 s90, s90, 117506048
    v_mov_b32 v8, 0
    s_mov_b64 exec, 1
    buffer_store_dword v8, off, s[8:11], s90 sc1
    s_mov_b64 exec, -1
mega_kernel_c356:
    s_mov_b32 s54, 0
    v_mov_b32 v6, v2
    v_accvgpr_write_b32 a0, 0
    v_accvgpr_write_b32 a1, 0
    v_accvgpr_write_b32 a2, 0
    v_accvgpr_write_b32 a3, 0
    v_accvgpr_write_b32 a4, 0
    v_accvgpr_write_b32 a5, 0
    v_accvgpr_write_b32 a6, 0
    v_accvgpr_write_b32 a7, 0
    v_accvgpr_write_b32 a8, 0
    v_accvgpr_write_b32 a9, 0
    v_accvgpr_write_b32 a10, 0
    v_accvgpr_write_b32 a11, 0
    v_accvgpr_write_b32 a12, 0
    v_accvgpr_write_b32 a13, 0
    v_accvgpr_write_b32 a14, 0
    v_accvgpr_write_b32 a15, 0
    v_accvgpr_write_b32 a16, 0
    v_accvgpr_write_b32 a17, 0
    v_accvgpr_write_b32 a18, 0
    v_accvgpr_write_b32 a19, 0
    v_accvgpr_write_b32 a20, 0
    v_accvgpr_write_b32 a21, 0
    v_accvgpr_write_b32 a22, 0
    v_accvgpr_write_b32 a23, 0
    v_accvgpr_write_b32 a24, 0
    v_accvgpr_write_b32 a25, 0
    v_accvgpr_write_b32 a26, 0
    v_accvgpr_write_b32 a27, 0
    v_accvgpr_write_b32 a28, 0
    v_accvgpr_write_b32 a29, 0
    v_accvgpr_write_b32 a30, 0
    v_accvgpr_write_b32 a31, 0
    v_accvgpr_write_b32 a32, 0
    v_accvgpr_write_b32 a33, 0
    v_accvgpr_write_b32 a34, 0
    v_accvgpr_write_b32 a35, 0
    v_accvgpr_write_b32 a36, 0
    v_accvgpr_write_b32 a37, 0
    v_accvgpr_write_b32 a38, 0
    v_accvgpr_write_b32 a39, 0
    v_accvgpr_write_b32 a40, 0
    v_accvgpr_write_b32 a41, 0
    v_accvgpr_write_b32 a42, 0
    v_accvgpr_write_b32 a43, 0
    v_accvgpr_write_b32 a44, 0
    v_accvgpr_write_b32 a45, 0
    v_accvgpr_write_b32 a46, 0
    v_accvgpr_write_b32 a47, 0
    v_accvgpr_write_b32 a48, 0
    v_accvgpr_write_b32 a49, 0
    v_accvgpr_write_b32 a50, 0
    v_accvgpr_write_b32 a51, 0
    v_accvgpr_write_b32 a52, 0
    v_accvgpr_write_b32 a53, 0
    v_accvgpr_write_b32 a54, 0
    v_accvgpr_write_b32 a55, 0
    v_accvgpr_write_b32 a56, 0
    v_accvgpr_write_b32 a57, 0
    v_accvgpr_write_b32 a58, 0
    v_accvgpr_write_b32 a59, 0
    v_accvgpr_write_b32 a60, 0
    v_accvgpr_write_b32 a61, 0
    v_accvgpr_write_b32 a62, 0
    v_accvgpr_write_b32 a63, 0
    v_accvgpr_write_b32 a64, 0
    v_accvgpr_write_b32 a65, 0
    v_accvgpr_write_b32 a66, 0
    v_accvgpr_write_b32 a67, 0
    v_accvgpr_write_b32 a68, 0
    v_accvgpr_write_b32 a69, 0
    v_accvgpr_write_b32 a70, 0
    v_accvgpr_write_b32 a71, 0
    v_accvgpr_write_b32 a72, 0
    v_accvgpr_write_b32 a73, 0
    v_accvgpr_write_b32 a74, 0
    v_accvgpr_write_b32 a75, 0
    v_accvgpr_write_b32 a76, 0
    v_accvgpr_write_b32 a77, 0
    v_accvgpr_write_b32 a78, 0
    v_accvgpr_write_b32 a79, 0
    v_accvgpr_write_b32 a80, 0
    v_accvgpr_write_b32 a81, 0
    v_accvgpr_write_b32 a82, 0
    v_accvgpr_write_b32 a83, 0
    v_accvgpr_write_b32 a84, 0
    v_accvgpr_write_b32 a85, 0
    v_accvgpr_write_b32 a86, 0
    v_accvgpr_write_b32 a87, 0
    v_accvgpr_write_b32 a88, 0
    v_accvgpr_write_b32 a89, 0
    v_accvgpr_write_b32 a90, 0
    v_accvgpr_write_b32 a91, 0
    v_accvgpr_write_b32 a92, 0
    v_accvgpr_write_b32 a93, 0
    v_accvgpr_write_b32 a94, 0
    v_accvgpr_write_b32 a95, 0
    v_accvgpr_write_b32 a96, 0
    v_accvgpr_write_b32 a97, 0
    v_accvgpr_write_b32 a98, 0
    v_accvgpr_write_b32 a99, 0
    v_accvgpr_write_b32 a100, 0
    v_accvgpr_write_b32 a101, 0
    v_accvgpr_write_b32 a102, 0
    v_accvgpr_write_b32 a103, 0
    v_accvgpr_write_b32 a104, 0
    v_accvgpr_write_b32 a105, 0
    v_accvgpr_write_b32 a106, 0
    v_accvgpr_write_b32 a107, 0
    v_accvgpr_write_b32 a108, 0
    v_accvgpr_write_b32 a109, 0
    v_accvgpr_write_b32 a110, 0
    v_accvgpr_write_b32 a111, 0
    v_accvgpr_write_b32 a112, 0
    v_accvgpr_write_b32 a113, 0
    v_accvgpr_write_b32 a114, 0
    v_accvgpr_write_b32 a115, 0
    v_accvgpr_write_b32 a116, 0
    v_accvgpr_write_b32 a117, 0
    v_accvgpr_write_b32 a118, 0
    v_accvgpr_write_b32 a119, 0
    v_accvgpr_write_b32 a120, 0
    v_accvgpr_write_b32 a121, 0
    v_accvgpr_write_b32 a122, 0
    v_accvgpr_write_b32 a123, 0
    v_accvgpr_write_b32 a124, 0
    v_accvgpr_write_b32 a125, 0
    v_accvgpr_write_b32 a126, 0
    v_accvgpr_write_b32 a127, 0
    v_mov_b32 v160, 0
    v_mov_b32 v161, 0
    v_mov_b32 v162, 0
    v_mov_b32 v163, 0
    v_mov_b32 v164, 0
    v_mov_b32 v165, 0
    v_mov_b32 v166, 0
    v_mov_b32 v167, 0
    v_mov_b32 v168, 0
    v_mov_b32 v169, 0
    v_mov_b32 v170, 0
    v_mov_b32 v171, 0
    v_mov_b32 v172, 0
    v_mov_b32 v173, 0
    v_mov_b32 v174, 0
    v_mov_b32 v175, 0
    v_mov_b32 v176, 0
    v_mov_b32 v177, 0
    v_mov_b32 v178, 0
    v_mov_b32 v179, 0
    v_mov_b32 v180, 0
    v_mov_b32 v181, 0
    v_mov_b32 v182, 0
    v_mov_b32 v183, 0
    v_mov_b32 v184, 0
    v_mov_b32 v185, 0
    v_mov_b32 v186, 0
    v_mov_b32 v187, 0
    v_mov_b32 v188, 0
    v_mov_b32 v189, 0
    v_mov_b32 v190, 0
    v_mov_b32 v191, 0
    v_mov_b32 v12, 0
    v_mov_b32 v28, 0
    v_mov_b32 v44, 0x3f803f80
    v_mov_b32 v13, 0
    v_mov_b32 v32, 0
    v_mov_b32 v45, 0x3f803f80
    v_mov_b32 v14, 0
    v_mov_b32 v36, 0
    v_mov_b32 v46, 0x3f803f80
    v_mov_b32 v15, 0
    v_mov_b32 v40, 0
    v_mov_b32 v47, 0x3f803f80
    s_and_b32 s90, s2, 7
    s_lshl_b32 s90, s90, 4
    s_lshl_b32 s91, s16, 2
    s_add_u32 s76, s90, s91
    s_lshr_b32 s92, s2, 3
    s_lshl_b32 s92, s92, 17
    s_lshl_b32 s90, s76, 10
    s_add_u32 s90, s90, s92
    s_add_u32 s79, s90, 50331648
    s_add_u32 s80, s90, 54525952
    s_and_b32 s77, s76, 63
    s_cmp_eq_u32 s77, 0
    s_cselect_b32 s93, 0, 1024
    s_sub_u32 s81, s80, s93
    s_lshl_b32 s90, s76, 9
    s_add_u32 s90, s90, s92
    s_add_u32 s82, s90, 58720256
    s_sub_u32 s83, s82, s93
    s_add_u32 s84, s82, 65536
    s_add_u32 s85, s83, 65536
    v_and_b32 v48, 15, v1
    v_lshrrev_b32 v49, 4, v1
    v_lshlrev_b32 v49, 2, v49
    v_sub_u32 v48, v48, v49
    v_cmp_le_i32 vcc, 0, v48
    s_nop 1
    v_cndmask_b32 v16, v9, 0, vcc
    v_cmp_le_i32 vcc, 1, v48
    s_nop 1
    v_cndmask_b32 v17, v9, 0, vcc
    v_cmp_le_i32 vcc, 2, v48
    s_nop 1
    v_cndmask_b32 v18, v9, 0, vcc
    v_cmp_le_i32 vcc, 3, v48
    s_nop 1
    v_cndmask_b32 v19, v9, 0, vcc
    s_mov_b32 s58, 35651616
    s_mov_b32 s59, 0
    s_sub_u32 s90, s63, 1
    s_bitset1_b64 s[58:59], s90
    s_sub_u32 s90, s64, 1
    s_bitset1_b64 s[58:59], s90
    s_sub_u32 s90, s65, 1
    s_bitset1_b64 s[58:59], s90
    s_sub_u32 s90, s66, 1
    s_bitset1_b64 s[58:59], s90
    s_sub_u32 s90, s67, 1
    s_bitset1_b64 s[58:59], s90
    s_sub_u32 s90, s68, 1
    s_bitset1_b64 s[58:59], s90
    s_mov_b32 s60, 0
    s_cmp_lg_u32 s60, s63
    s_cbranch_scc1 mega_kernel_e61
    v_add_f32 v176, v176, v16
    v_mov_b32 v180, v9
    v_add_f32 v188, v188, v16
    v_add_f32 v177, v177, v17
    v_mov_b32 v181, v9
    v_add_f32 v189, v189, v17
    v_add_f32 v178, v178, v18
    v_mov_b32 v182, v9
    v_add_f32 v190, v190, v18
    v_add_f32 v179, v179, v19
    v_mov_b32 v183, v9
    v_add_f32 v191, v191, v19
    s_nop 0
mega_kernel_e61:
    s_waitcnt vmcnt(24) lgkmcnt(0)
    s_barrier
    ds_read_b128 a[192:195], v6 offset:0
    ds_read_b128 a[196:199], v6 offset:1024
    ds_read_b128 a[200:203], v6 offset:2048
    ds_read_b128 a[204:207], v6 offset:3072
    ds_read_b128 a[208:211], v6 offset:4096
    ds_read_b128 a[212:215], v6 offset:5120
    ds_read_b128 a[216:219], v6 offset:6144
    ds_read_b128 a[220:223], v6 offset:7168
    s_waitcnt lgkmcnt(0)
    v_mfma_f32_16x16x32_bf16 v[64:67], a[192:195], a[128:131], v[160:163]
    v_mfma_f32_16x16x32_bf16 v[64:67], a[196:199], a[132:135], v[64:67]
    buffer_store_dwordx4 v[192:195], v2, s[36:39], s40 offen sc1
    s_add_u32 s40, s40, s100
    v_mfma_f32_16x16x32_bf16 v[64:67], a[200:203], a[136:139], v[64:67]
    v_mfma_f32_16x16x32_bf16 v[64:67], a[204:207], a[140:143], v[64:67]
    v_mfma_f32_16x16x32_bf16 v[72:75], a[192:195], a[144:147], v[168:171]
    v_mfma_f32_16x16x32_bf16 v[72:75], a[196:199], a[148:151], v[72:75]
    buffer_store_dwordx4 v[196:199], v2, s[36:39], s40 offen sc1
    s_add_u32 s40, s40, s100
    v_mfma_f32_16x16x32_bf16 v[72:75], a[200:203], a[152:155], v[72:75]
    v_mfma_f32_16x16x32_bf16 v[72:75], a[204:207], a[156:159], v[72:75]
    v_mfma_f32_16x16x32_bf16 v[80:83], a[192:195], a[160:163], v[176:179]
    v_mfma_f32_16x16x32_bf16 v[80:83], a[196:199], a[164:167], v[80:83]
    buffer_store_dwordx4 v[200:203], v2, s[36:39], s40 offen sc1
    s_add_u32 s40, s40, s100
    v_mfma_f32_16x16x32_bf16 v[80:83], a[200:203], a[168:171], v[80:83]
    v_mfma_f32_16x16x32_bf16 v[80:83], a[204:207], a[172:175], v[80:83]
    v_mfma_f32_16x16x32_bf16 v[88:91], a[192:195], a[176:179], v[184:187]
    v_mfma_f32_16x16x32_bf16 v[88:91], a[196:199], a[180:183], v[88:91]
    buffer_store_dwordx4 v[204:207], v2, s[36:39], s40 offen sc1
    s_add_u32 s40, s98, s99
    v_mfma_f32_16x16x32_bf16 v[88:91], a[200:203], a[184:187], v[88:91]
    v_mfma_f32_16x16x32_bf16 v[88:91], a[204:207], a[188:191], v[88:91]
    v_mfma_f32_16x16x32_bf16 v[68:71], a[208:211], a[128:131], v[164:167]
    ds_read_b128 a[192:195], v6 offset:8192
    v_mfma_f32_16x16x32_bf16 v[68:71], a[212:215], a[132:135], v[68:71]
    buffer_store_dwordx4 v[208:211], v2, s[36:39], s40 offen sc1
    s_add_u32 s40, s40, s100
    ds_read_b128 a[196:199], v6 offset:9216
    v_mfma_f32_16x16x32_bf16 v[68:71], a[216:219], a[136:139], v[68:71]
    ds_read_b128 a[200:203], v6 offset:10240
    v_mfma_f32_16x16x32_bf16 v[68:71], a[220:223], a[140:143], v[68:71]
    ds_read_b128 a[204:207], v6 offset:11264
    v_mfma_f32_16x16x32_bf16 v[76:79], a[208:211], a[144:147], v[172:175]
    v_mfma_f32_16x16x32_bf16 v[76:79], a[212:215], a[148:151], v[76:79]
    buffer_store_dwordx4 v[212:215], v2, s[36:39], s40 offen sc1
    s_add_u32 s40, s40, s100
    v_mfma_f32_16x16x32_bf16 v[76:79], a[216:219], a[152:155], v[76:79]
    v_mfma_f32_16x16x32_bf16 v[76:79], a[220:223], a[156:159], v[76:79]
    v_mfma_f32_16x16x32_bf16 v[84:87], a[208:211], a[160:163], v[180:183]
    v_mfma_f32_16x16x32_bf16 v[84:87], a[212:215], a[164:167], v[84:87]
    buffer_store_dwordx4 v[216:219], v2, s[36:39], s40 offen sc1
    s_add_u32 s40, s40, s100
    v_mfma_f32_16x16x32_bf16 v[84:87], a[216:219], a[168:171], v[84:87]
    v_mfma_f32_16x16x32_bf16 v[84:87], a[220:223], a[172:175], v[84:87]
    v_mfma_f32_16x16x32_bf16 v[92:95], a[208:211], a[176:179], v[188:191]
    v_mfma_f32_16x16x32_bf16 v[92:95], a[212:215], a[180:183], v[92:95]
    buffer_store_dwordx4 v[220:223], v2, s[36:39], s40 offen sc1
    s_add_u32 s40, s40, s100
    v_mfma_f32_16x16x32_bf16 v[92:95], a[216:219], a[184:187], v[92:95]
    v_mfma_f32_16x16x32_bf16 v[92:95], a[220:223], a[188:191], v[92:95]
    ds_read_b128 a[208:211], v6 offset:12288
    ds_read_b128 a[212:215], v6 offset:13312
    ds_read_b128 a[216:219], v6 offset:14336
    ds_read_b128 a[220:223], v6 offset:15360
    s_mov_b32 s60, 1
    s_nop 0
    s_nop 3
    v_max3_f32 v48, v64, v65, v66
    v_max3_f32 v49, v72, v73, v74
    v_max3_f32 v50, v80, v81, v82
    v_max3_f32 v51, v88, v89, v90
    v_max3_f32 v48, v48, v67, v68
    v_max3_f32 v49, v49, v75, v76
    v_max3_f32 v50, v50, v83, v84
    v_max3_f32 v51, v51, v91, v92
    v_max3_f32 v48, v48, v69, v70
    v_max3_f32 v49, v49, v77, v78
    v_max3_f32 v50, v50, v85, v86
    v_max3_f32 v51, v51, v93, v94
    v_max_f32 v48, v48, v71
    v_max_f32 v49, v49, v79
    v_max_f32 v50, v50, v87
    v_max_f32 v51, v51, v95
    v_mov_b32 v52, v48
    v_mov_b32 v53, v49
    v_mov_b32 v54, v50
    v_mov_b32 v55, v51
    s_nop 1
    v_permlane32_swap_b32 v48, v52
    v_permlane32_swap_b32 v49, v53
    v_permlane32_swap_b32 v50, v54
    v_permlane32_swap_b32 v51, v55
    s_nop 1
    v_max_f32 v48, v48, v52
    v_max_f32 v49, v49, v53
    v_max_f32 v50, v50, v54
    v_max_f32 v51, v51, v55
    v_mov_b32 v52, v48
    v_mov_b32 v53, v49
    v_mov_b32 v54, v50
    v_mov_b32 v55, v51
    s_nop 1
    v_permlane16_swap_b32 v48, v52
    v_permlane16_swap_b32 v49, v53
    v_permlane16_swap_b32 v50, v54
    v_permlane16_swap_b32 v51, v55
    s_nop 1
    v_max_f32 v48, v48, v52
    v_max_f32 v49, v49, v53
    v_max_f32 v50, v50, v54
    v_max_f32 v51, v51, v55
    v_sub_f32 v160, v160, v48
    v_sub_f32 v161, v161, v48
    v_sub_f32 v162, v162, v48
    v_sub_f32 v163, v163, v48
    v_sub_f32 v164, v164, v48
    v_sub_f32 v165, v165, v48
    v_sub_f32 v166, v166, v48
    v_sub_f32 v167, v167, v48
    v_sub_f32 v168, v168, v49
    v_sub_f32 v169, v169, v49
    v_sub_f32 v170, v170, v49
    v_sub_f32 v171, v171, v49
    v_sub_f32 v172, v172, v49
    v_sub_f32 v173, v173, v49
    v_sub_f32 v174, v174, v49
    v_sub_f32 v175, v175, v49
    v_sub_f32 v176, v176, v50
    v_sub_f32 v177, v177, v50
    v_sub_f32 v178, v178, v50
    v_sub_f32 v179, v179, v50
    v_sub_f32 v180, v180, v50
    v_sub_f32 v181, v181, v50
    v_sub_f32 v182, v182, v50
    v_sub_f32 v183, v183, v50
    v_sub_f32 v184, v184, v51
    v_sub_f32 v185, v185, v51
    v_sub_f32 v186, v186, v51
    v_sub_f32 v187, v187, v51
    v_sub_f32 v188, v188, v51
    v_sub_f32 v189, v189, v51
    v_sub_f32 v190, v190, v51
    v_sub_f32 v191, v191, v51
    v_sub_f32 v64, v64, v48
    v_sub_f32 v65, v65, v48
    v_sub_f32 v66, v66, v48
    v_sub_f32 v67, v67, v48
    v_sub_f32 v68, v68, v48
    v_sub_f32 v69, v69, v48
    v_sub_f32 v70, v70, v48
    v_sub_f32 v71, v71, v48
    v_sub_f32 v72, v72, v49
    v_sub_f32 v73, v73, v49
    v_sub_f32 v74, v74, v49
    v_sub_f32 v75, v75, v49
    v_sub_f32 v76, v76, v49
    v_sub_f32 v77, v77, v49
    v_sub_f32 v78, v78, v49
    v_sub_f32 v79, v79, v49
    v_sub_f32 v80, v80, v50
    v_sub_f32 v81, v81, v50
    v_sub_f32 v82, v82, v50
    v_sub_f32 v83, v83, v50
    v_sub_f32 v84, v84, v50
    v_sub_f32 v85, v85, v50
    v_sub_f32 v86, v86, v50
    v_sub_f32 v87, v87, v50
    v_sub_f32 v88, v88, v51
    v_sub_f32 v89, v89, v51
    v_sub_f32 v90, v90, v51
    v_sub_f32 v91, v91, v51
    v_sub_f32 v92, v92, v51
    v_sub_f32 v93, v93, v51
    v_sub_f32 v94, v94, v51
    v_sub_f32 v95, v95, v51
    s_cmp_lg_u32 s60, s63
    s_cbranch_scc1 mega_kernel_e62
    v_add_f32 v176, v176, v16
    v_mov_b32 v180, v9
    v_add_f32 v188, v188, v16
    v_add_f32 v177, v177, v17
    v_mov_b32 v181, v9
    v_add_f32 v189, v189, v17
    v_add_f32 v178, v178, v18
    v_mov_b32 v182, v9
    v_add_f32 v190, v190, v18
    v_add_f32 v179, v179, v19
    v_mov_b32 v183, v9
    v_add_f32 v191, v191, v19
    s_nop 0
mega_kernel_e62:
    s_cmp_lg_u32 s60, s64
    s_cbranch_scc1 mega_kernel_e63
    v_mov_b32 v176, v9
    v_mov_b32 v184, v9
    v_mov_b32 v188, v9
    v_mov_b32 v177, v9
    v_mov_b32 v185, v9
    v_mov_b32 v189, v9
    v_mov_b32 v178, v9
    v_mov_b32 v186, v9
    v_mov_b32 v190, v9
    v_mov_b32 v179, v9
    v_mov_b32 v187, v9
    v_mov_b32 v191, v9
    s_nop 0
mega_kernel_e63:
    s_waitcnt lgkmcnt(0)
    v_mfma_f32_16x16x32_bf16 v[96:99], a[192:195], a[128:131], v[160:163]
    s_bitcmp1_b64 s[58:59], s60
    s_cselect_b32 s62, -1.0, s61
    v_exp_f32 v20, v64
    v_mfma_f32_16x16x32_bf16 v[96:99], a[196:199], a[132:135], v[96:99]
    s_add_u32 s60, s60, 1
    v_exp_f32 v21, v65
    v_exp_f32 v22, v66
    v_mfma_f32_16x16x32_bf16 v[96:99], a[200:203], a[136:139], v[96:99]
    buffer_store_dwordx4 v[224:227], v2, s[36:39], s40 offen sc1
    v_cvt_pk_bf16_f32 v128, v20, v21
    v_mfma_f32_16x16x32_bf16 v[96:99], a[204:207], a[140:143], v[96:99]
    s_add_u32 s40, s40, s100
    v_add_f32 v12, v12, v28
    v_exp_f32 v23, v67
    v_mfma_f32_16x16x32_bf16 v[104:107], a[192:195], a[144:147], v[168:171]
    v_exp_f32 v24, v68
    v_cvt_pk_bf16_f32 v129, v22, v23
    v_mfma_f32_16x16x32_bf16 v[104:107], a[196:199], a[148:151], v[104:107]
    buffer_store_dwordx4 v[228:231], v2, s[36:39], s40 offen sc1
    v_exp_f32 v25, v69
    v_mfma_f32_16x16x32_bf16 v[104:107], a[200:203], a[152:155], v[104:107]
    s_add_u32 s40, s40, s100
    v_exp_f32 v26, v70
    v_cvt_pk_bf16_f32 v130, v24, v25
    v_mfma_f32_16x16x32_bf16 v[104:107], a[204:207], a[156:159], v[104:107]
    v_exp_f32 v27, v71
    v_add_f32 v13, v13, v32
    v_mfma_f32_16x16x32_bf16 v[112:115], a[192:195], a[160:163], v[176:179]
    v_exp_f32 v20, v72
    v_cvt_pk_bf16_f32 v131, v26, v27
    v_mfma_f32_16x16x32_bf16 v[112:115], a[196:199], a[164:167], v[112:115]
    buffer_store_dwordx4 v[232:235], v2, s[36:39], s40 offen sc1
    v_exp_f32 v21, v73
    v_mfma_f32_16x16x32_bf16 v[28:31], v[44:47], v[128:131], 0
    v_exp_f32 v22, v74
    v_cvt_pk_bf16_f32 v132, v20, v21
    v_mfma_f32_16x16x32_bf16 v[112:115], a[200:203], a[168:171], v[112:115]
    s_add_u32 s40, s40, s100
    v_exp_f32 v23, v75
    v_add_f32 v14, v14, v36
    v_mfma_f32_16x16x32_bf16 v[112:115], a[204:207], a[172:175], v[112:115]
    v_exp_f32 v24, v76
    v_cvt_pk_bf16_f32 v133, v22, v23
    v_mfma_f32_16x16x32_bf16 v[120:123], a[192:195], a[176:179], v[184:187]
    buffer_store_dwordx4 v[236:239], v2, s[36:39], s40 offen sc1
    v_exp_f32 v25, v77
    v_mfma_f32_16x16x32_bf16 v[120:123], a[196:199], a[180:183], v[120:123]
    s_mov_b32 s40, s98
    v_exp_f32 v26, v78
    v_cvt_pk_bf16_f32 v134, v24, v25
    v_mfma_f32_16x16x32_bf16 v[120:123], a[200:203], a[184:187], v[120:123]
    v_exp_f32 v27, v79
    v_add_f32 v15, v15, v40
    v_mfma_f32_16x16x32_bf16 v[120:123], a[204:207], a[188:191], v[120:123]
    s_waitcnt lgkmcnt(0)
    v_exp_f32 v20, v80
    v_cvt_pk_bf16_f32 v135, v26, v27
    v_mfma_f32_16x16x32_bf16 v[100:103], a[208:211], a[128:131], v[164:167]
    v_exp_f32 v21, v81
    v_exp_f32 v22, v82
    v_mfma_f32_16x16x32_bf16 v[32:35], v[44:47], v[132:135], 0
    v_cvt_pk_bf16_f32 v136, v20, v21
    v_exp_f32 v23, v83
    v_mfma_f32_16x16x32_bf16 v[100:103], a[212:215], a[132:135], v[100:103]
    buffer_store_dwordx4 v[240:243], v2, s[36:39], s40 offen sc1
    v_cvt_pk_bf16_f32 v137, v22, v23
    v_mfma_f32_16x16x32_bf16 v[100:103], a[216:219], a[136:139], v[100:103]
    s_add_u32 s40, s40, s100
    v_exp_f32 v24, v84
    v_mfma_f32_16x16x32_bf16 v[100:103], a[220:223], a[140:143], v[100:103]
    v_exp_f32 v25, v85
    v_exp_f32 v26, v86
    v_cvt_pk_bf16_f32 v138, v24, v25
    v_mfma_f32_16x16x32_bf16 v[108:111], a[208:211], a[144:147], v[172:175]
    buffer_store_dwordx4 v[244:247], v2, s[36:39], s40 offen sc1
    v_mfma_f32_16x16x32_bf16 v[108:111], a[212:215], a[148:151], v[108:111]
    s_add_u32 s40, s40, s100
    v_exp_f32 v27, v87
    v_exp_f32 v20, v88
    v_mfma_f32_16x16x32_bf16 v[108:111], a[216:219], a[152:155], v[108:111]
    v_cvt_pk_bf16_f32 v139, v26, v27
    v_exp_f32 v21, v89
    v_mfma_f32_16x16x32_bf16 v[108:111], a[220:223], a[156:159], v[108:111]
    buffer_store_dwordx4 v[248:251], v2, s[36:39], s40 offen sc1
    v_exp_f32 v22, v90
    v_mfma_f32_16x16x32_bf16 v[36:39], v[44:47], v[136:139], 0
    v_cvt_pk_bf16_f32 v140, v20, v21
    v_exp_f32 v23, v91
    v_mfma_f32_16x16x32_bf16 v[116:119], a[208:211], a[160:163], v[180:183]
    s_add_u32 s40, s40, s100
    v_exp_f32 v24, v92
    v_cvt_pk_bf16_f32 v141, v22, v23
    v_mfma_f32_16x16x32_bf16 v[116:119], a[212:215], a[164:167], v[116:119]
    v_exp_f32 v25, v93
    v_mfma_f32_16x16x32_bf16 v[116:119], a[216:219], a[168:171], v[116:119]
    buffer_store_dwordx4 v[252:255], v2, s[36:39], s40 offen sc1
    v_exp_f32 v26, v94
    v_cvt_pk_bf16_f32 v142, v24, v25
    v_mfma_f32_16x16x32_bf16 v[116:119], a[220:223], a[172:175], v[116:119]
    s_add_u32 s40, s40, s100
    v_exp_f32 v27, v95
    s_nop 0
    v_cvt_pk_bf16_f32 v143, v26, v27
    s_nop 1
    v_mfma_f32_16x16x32_bf16 v[40:43], v[44:47], v[140:143], 0
    s_nop 2
    v_mfma_f32_16x16x32_bf16 v[124:127], a[208:211], a[176:179], v[188:191]
    s_nop 2
    v_mfma_f32_16x16x32_bf16 v[124:127], a[212:215], a[180:183], v[124:127]
    v_max3_f32 v8, v28, v32, v36
    v_max_f32 v8, v8, v40
    v_mfma_f32_16x16x32_bf16 v[124:127], a[216:219], a[184:187], v[124:127]
    v_cmp_nge_f32 vcc, s62, v8
    v_mfma_f32_16x16x32_bf16 v[124:127], a[220:223], a[188:191], v[124:127]
    s_waitcnt vmcnt(40) lgkmcnt(0)
    s_barrier
    s_add_u32 s55, s54, s56
    s_add_u32 s54, s54, 32768
    s_and_b32 s54, s54, 0x1ffff
    v_add_u32 v6, s54, v2
    ds_read_b128 a[192:195], v6 offset:0
    ds_read_b128 a[196:199], v6 offset:1024
    ds_read_b128 a[200:203], v6 offset:2048
    ds_read_b128 a[204:207], v6 offset:3072
    ds_read_b128 a[208:211], v6 offset:4096
    ds_read_b128 a[212:215], v6 offset:5120
    ds_read_b128 a[216:219], v6 offset:6144
    ds_read_b128 a[220:223], v6 offset:7168
    s_waitcnt lgkmcnt(0)
    s_cbranch_vccnz mega_kernel_stub64
mega_kernel_ret65:
mega_kernel_dual66:
    v_mfma_f32_16x16x32_bf16 v[64:67], a[192:195], a[128:131], v[160:163]
    s_bitcmp1_b64 s[58:59], s60
    s_cselect_b32 s62, -1.0, s61
    v_add_f32 v12, v12, v28
    v_mfma_f32_16x16x32_bf16 v[64:67], a[196:199], a[132:135], v[64:67]
    s_add_u32 s60, s60, 1
    ds_read_b128 a[224:227], v6 offset:16384
    v_add_f32 v13, v13, v32
    v_mfma_f32_16x16x32_bf16 v[64:67], a[200:203], a[136:139], v[64:67]
    v_exp_f32 v20, v96
    v_mfma_f32_16x16x32_bf16 v[64:67], a[204:207], a[140:143], v[64:67]
    v_exp_f32 v21, v97
    v_mfma_f32_16x16x32_bf16 v[72:75], a[192:195], a[144:147], v[168:171]
    s_mov_b32 m0, s55
    ds_read_b128 a[228:231], v6 offset:17408
    v_cvt_pk_bf16_f32 v144, v20, v21
    v_mfma_f32_16x16x32_bf16 v[72:75], a[196:199], a[148:151], v[72:75]
    buffer_load_dwordx4 v7, s[24:27], s52 offen offset:0 sc1 lds
    v_mfma_f32_16x16x32_bf16 v[72:75], a[200:203], a[152:155], v[72:75]
    v_exp_f32 v22, v98
    v_mfma_f32_16x16x32_bf16 v[72:75], a[204:207], a[156:159], v[72:75]
    ds_read_b128 a[232:235], v6 offset:18432
    v_add_f32 v14, v14, v36
    v_mfma_f32_16x16x32_bf16 v[80:83], a[192:195], a[160:163], v[176:179]
    v_exp_f32 v23, v99
    v_mfma_f32_16x16x32_bf16 v[80:83], a[196:199], a[164:167], v[80:83]
    v_exp_f32 v24, v100
    v_mfma_f32_16x16x32_bf16 v[80:83], a[200:203], a[168:171], v[80:83]
    ds_read_b128 a[236:239], v6 offset:19456
    v_cvt_pk_bf16_f32 v145, v22, v23
    v_mfma_f32_16x16x32_bf16 v[80:83], a[204:207], a[172:175], v[80:83]
    v_exp_f32 v25, v101
    v_mfma_f32_16x16x32_bf16 v[88:91], a[192:195], a[176:179], v[184:187]
    v_exp_f32 v26, v102
    v_mfma_f32_16x16x32_bf16 v[88:91], a[196:199], a[180:183], v[88:91]
    ds_read_b128 a[240:243], v6 offset:20480
    v_cvt_pk_bf16_f32 v146, v24, v25
    v_mfma_f32_16x16x32_bf16 v[88:91], a[200:203], a[184:187], v[88:91]
    v_exp_f32 v27, v103
    v_mfma_f32_16x16x32_bf16 v[88:91], a[204:207], a[188:191], v[88:91]
    s_waitcnt lgkmcnt(5)
    v_exp_f32 v20, v104
    v_mfma_f32_16x16x32_bf16 v[68:71], a[208:211], a[128:131], v[164:167]
    ds_read_b128 a[244:247], v6 offset:21504
    v_cvt_pk_bf16_f32 v147, v26, v27
    v_mfma_f32_16x16x32_bf16 v[68:71], a[212:215], a[132:135], v[68:71]
    v_exp_f32 v21, v105
    v_mfma_f32_16x16x32_bf16 v[28:31], v[44:47], v[144:147], 0
    v_exp_f32 v22, v106
    v_mfma_f32_16x16x32_bf16 v[68:71], a[216:219], a[136:139], v[68:71]
    buffer_load_dwordx4 v7, s[24:27], s52 offen offset:1024 sc1 lds
    v_mfma_f32_16x16x32_bf16 v[68:71], a[220:223], a[140:143], v[68:71]
    ds_read_b128 a[248:251], v6 offset:22528
    v_cvt_pk_bf16_f32 v148, v20, v21
    v_mfma_f32_16x16x32_bf16 v[76:79], a[208:211], a[144:147], v[172:175]
    v_exp_f32 v23, v107
    v_mfma_f32_16x16x32_bf16 v[76:79], a[212:215], a[148:151], v[76:79]
    v_exp_f32 v24, v108
    v_mfma_f32_16x16x32_bf16 v[76:79], a[216:219], a[152:155], v[76:79]
    ds_read_b128 a[252:255], v6 offset:23552
    v_cvt_pk_bf16_f32 v149, v22, v23
    v_mfma_f32_16x16x32_bf16 v[76:79], a[220:223], a[156:159], v[76:79]
    v_exp_f32 v25, v109
    v_mfma_f32_16x16x32_bf16 v[84:87], a[208:211], a[160:163], v[180:183]
    v_exp_f32 v26, v110
    v_mfma_f32_16x16x32_bf16 v[84:87], a[212:215], a[164:167], v[84:87]
    v_cvt_pk_bf16_f32 v150, v24, v25
    v_add_f32 v15, v15, v40
    v_mfma_f32_16x16x32_bf16 v[84:87], a[216:219], a[168:171], v[84:87]
    v_exp_f32 v27, v111
    v_mfma_f32_16x16x32_bf16 v[84:87], a[220:223], a[172:175], v[84:87]
    buffer_load_dwordx4 v7, s[24:27], s52 offen offset:2048 sc1 lds
    v_mfma_f32_16x16x32_bf16 v[92:95], a[208:211], a[176:179], v[188:191]
    v_exp_f32 v20, v112
    v_mfma_f32_16x16x32_bf16 v[92:95], a[212:215], a[180:183], v[92:95]
    v_cvt_pk_bf16_f32 v151, v26, v27
    v_mfma_f32_16x16x32_bf16 v[92:95], a[216:219], a[184:187], v[92:95]
    v_exp_f32 v21, v113
    v_mfma_f32_16x16x32_bf16 v[32:35], v[44:47], v[148:151], 0
    v_exp_f32 v22, v114
    v_mfma_f32_16x16x32_bf16 v[92:95], a[220:223], a[188:191], v[92:95]
    s_waitcnt lgkmcnt(0)
    v_cvt_pk_bf16_f32 v152, v20, v21
    v_mfma_f32_16x16x32_bf16 a[0:3], a[224:227], v[128:131], a[0:3]
    ds_read_b128 a[192:195], v6 offset:8192
    v_mfma_f32_16x16x32_bf16 a[32:35], a[224:227], v[132:135], a[32:35]
    v_exp_f32 v23, v115
    v_mfma_f32_16x16x32_bf16 a[64:67], a[224:227], v[136:139], a[64:67]
    v_exp_f32 v24, v116
    v_mfma_f32_16x16x32_bf16 a[96:99], a[224:227], v[140:143], a[96:99]
    ds_read_b128 a[196:199], v6 offset:9216
    v_cvt_pk_bf16_f32 v153, v22, v23
    v_mfma_f32_16x16x32_bf16 a[4:7], a[228:231], v[128:131], a[4:7]
    v_exp_f32 v25, v117
    v_mfma_f32_16x16x32_bf16 a[36:39], a[228:231], v[132:135], a[36:39]
    v_exp_f32 v26, v118
    v_mfma_f32_16x16x32_bf16 a[68:71], a[228:231], v[136:139], a[68:71]
    ds_read_b128 a[200:203], v6 offset:10240
    v_cvt_pk_bf16_f32 v154, v24, v25
    v_mfma_f32_16x16x32_bf16 a[100:103], a[228:231], v[140:143], a[100:103]
    v_exp_f32 v27, v119
    v_mfma_f32_16x16x32_bf16 a[8:11], a[232:235], v[128:131], a[8:11]
    v_exp_f32 v20, v120
    v_mfma_f32_16x16x32_bf16 a[40:43], a[232:235], v[132:135], a[40:43]
    ds_read_b128 a[204:207], v6 offset:11264
    v_cvt_pk_bf16_f32 v155, v26, v27
    v_mfma_f32_16x16x32_bf16 a[72:75], a[232:235], v[136:139], a[72:75]
    v_exp_f32 v21, v121
    v_mfma_f32_16x16x32_bf16 v[36:39], v[44:47], v[152:155], 0
    v_exp_f32 v22, v122
    v_mfma_f32_16x16x32_bf16 a[104:107], a[232:235], v[140:143], a[104:107]
    buffer_load_dwordx4 v7, s[24:27], s52 offen offset:3072 sc1 lds
    v_mfma_f32_16x16x32_bf16 a[12:15], a[236:239], v[128:131], a[12:15]
    s_add_u32 s52, s52, 16384
    v_cvt_pk_bf16_f32 v156, v20, v21
    v_mfma_f32_16x16x32_bf16 a[44:47], a[236:239], v[132:135], a[44:47]
    v_exp_f32 v23, v123
    v_mfma_f32_16x16x32_bf16 a[76:79], a[236:239], v[136:139], a[76:79]
    v_exp_f32 v24, v124
    v_mfma_f32_16x16x32_bf16 a[108:111], a[236:239], v[140:143], a[108:111]
    v_cvt_pk_bf16_f32 v157, v22, v23
    v_mfma_f32_16x16x32_bf16 a[16:19], a[240:243], v[128:131], a[16:19]
    v_exp_f32 v25, v125
    v_mfma_f32_16x16x32_bf16 a[48:51], a[240:243], v[132:135], a[48:51]
    v_exp_f32 v26, v126
    v_mfma_f32_16x16x32_bf16 a[80:83], a[240:243], v[136:139], a[80:83]
    v_cvt_pk_bf16_f32 v158, v24, v25
    v_mfma_f32_16x16x32_bf16 a[112:115], a[240:243], v[140:143], a[112:115]
    s_add_u32 m0, s55, 16384
    v_exp_f32 v27, v127
    v_mfma_f32_16x16x32_bf16 a[20:23], a[244:247], v[128:131], a[20:23]
    buffer_load_dwordx4 v7, s[28:31], s53 offen offset:0 sc1 lds
    v_mfma_f32_16x16x32_bf16 a[52:55], a[244:247], v[132:135], a[52:55]
    v_cvt_pk_bf16_f32 v159, v26, v27
    v_mfma_f32_16x16x32_bf16 a[84:87], a[244:247], v[136:139], a[84:87]
    v_mfma_f32_16x16x32_bf16 a[116:119], a[244:247], v[140:143], a[116:119]
    v_mfma_f32_16x16x32_bf16 v[40:43], v[44:47], v[156:159], 0
    s_nop 2
    v_mfma_f32_16x16x32_bf16 a[24:27], a[248:251], v[128:131], a[24:27]
    s_nop 2
    v_mfma_f32_16x16x32_bf16 a[56:59], a[248:251], v[132:135], a[56:59]
    v_max3_f32 v8, v28, v32, v36
    v_max_f32 v8, v8, v40
    v_mfma_f32_16x16x32_bf16 a[88:91], a[248:251], v[136:139], a[88:91]
    v_cmp_nge_f32 vcc, s62, v8
    v_mfma_f32_16x16x32_bf16 a[120:123], a[248:251], v[140:143], a[120:123]
    ds_read_b128 a[208:211], v6 offset:12288
    v_mfma_f32_16x16x32_bf16 a[28:31], a[252:255], v[128:131], a[28:31]
    ds_read_b128 a[212:215], v6 offset:13312
    v_mfma_f32_16x16x32_bf16 a[60:63], a[252:255], v[132:135], a[60:63]
    ds_read_b128 a[216:219], v6 offset:14336
    v_mfma_f32_16x16x32_bf16 a[92:95], a[252:255], v[136:139], a[92:95]
    ds_read_b128 a[220:223], v6 offset:15360
    v_mfma_f32_16x16x32_bf16 a[124:127], a[252:255], v[140:143], a[124:127]
    s_waitcnt lgkmcnt(4)
    s_cbranch_vccnz mega_kernel_stub67
mega_kernel_ret68:
    v_mfma_f32_16x16x32_bf16 v[96:99], a[192:195], a[128:131], v[160:163]
    s_add_u32 s55, s54, s56
    v_exp_f32 v20, v64
    v_mfma_f32_16x16x32_bf16 v[96:99], a[196:199], a[132:135], v[96:99]
    s_add_u32 s54, s54, 32768
    ds_read_b128 a[224:227], v6 offset:24576
    v_add_f32 v12, v12, v28
    v_mfma_f32_16x16x32_bf16 v[96:99], a[200:203], a[136:139], v[96:99]
    s_and_b32 s54, s54, 0x1ffff
    v_exp_f32 v21, v65
    v_mfma_f32_16x16x32_bf16 v[96:99], a[204:207], a[140:143], v[96:99]
    s_bitcmp1_b64 s[58:59], s60
    s_cselect_b32 s62, -1.0, s61
    v_cvt_pk_bf16_f32 v128, v20, v21
    v_mfma_f32_16x16x32_bf16 v[104:107], a[192:195], a[144:147], v[168:171]
    s_add_u32 s60, s60, 1
    ds_read_b128 a[228:231], v6 offset:25600
    v_add_f32 v13, v13, v32
    v_mfma_f32_16x16x32_bf16 v[104:107], a[196:199], a[148:151], v[104:107]
    v_exp_f32 v22, v66
    v_mfma_f32_16x16x32_bf16 v[104:107], a[200:203], a[152:155], v[104:107]
    buffer_load_dwordx4 v7, s[28:31], s53 offen offset:1024 sc1 lds
    v_mfma_f32_16x16x32_bf16 v[104:107], a[204:207], a[156:159], v[104:107]
    ds_read_b128 a[232:235], v6 offset:26624
    v_add_f32 v14, v14, v36
    v_mfma_f32_16x16x32_bf16 v[112:115], a[192:195], a[160:163], v[176:179]
    v_exp_f32 v23, v67
    v_mfma_f32_16x16x32_bf16 v[112:115], a[196:199], a[164:167], v[112:115]
    v_exp_f32 v24, v68
    v_mfma_f32_16x16x32_bf16 v[112:115], a[200:203], a[168:171], v[112:115]
    ds_read_b128 a[236:239], v6 offset:27648
    v_cvt_pk_bf16_f32 v129, v22, v23
    v_mfma_f32_16x16x32_bf16 v[112:115], a[204:207], a[172:175], v[112:115]
    v_exp_f32 v25, v69
    v_mfma_f32_16x16x32_bf16 v[120:123], a[192:195], a[176:179], v[184:187]
    v_exp_f32 v26, v70
    v_mfma_f32_16x16x32_bf16 v[120:123], a[196:199], a[180:183], v[120:123]
    ds_read_b128 a[240:243], v6 offset:28672
    v_cvt_pk_bf16_f32 v130, v24, v25
    v_mfma_f32_16x16x32_bf16 v[120:123], a[200:203], a[184:187], v[120:123]
    v_exp_f32 v27, v71
    v_mfma_f32_16x16x32_bf16 v[120:123], a[204:207], a[188:191], v[120:123]
    s_waitcnt lgkmcnt(5)
    v_exp_f32 v20, v72
    v_mfma_f32_16x16x32_bf16 v[100:103], a[208:211], a[128:131], v[164:167]
    ds_read_b128 a[244:247], v6 offset:29696
    v_cvt_pk_bf16_f32 v131, v26, v27
    v_mfma_f32_16x16x32_bf16 v[100:103], a[212:215], a[132:135], v[100:103]
    v_exp_f32 v21, v73
    v_mfma_f32_16x16x32_bf16 v[28:31], v[44:47], v[128:131], 0
    v_exp_f32 v22, v74
    v_mfma_f32_16x16x32_bf16 v[100:103], a[216:219], a[136:139], v[100:103]
    buffer_load_dwordx4 v7, s[28:31], s53 offen offset:2048 sc1 lds
    v_mfma_f32_16x16x32_bf16 v[100:103], a[220:223], a[140:143], v[100:103]
    ds_read_b128 a[248:251], v6 offset:30720
    v_cvt_pk_bf16_f32 v132, v20, v21
    v_mfma_f32_16x16x32_bf16 v[108:111], a[208:211], a[144:147], v[172:175]
    v_exp_f32 v23, v75
    v_mfma_f32_16x16x32_bf16 v[108:111], a[212:215], a[148:151], v[108:111]
    v_exp_f32 v24, v76
    v_mfma_f32_16x16x32_bf16 v[108:111], a[216:219], a[152:155], v[108:111]
    ds_read_b128 a[252:255], v6 offset:31744
    v_cvt_pk_bf16_f32 v133, v22, v23
    v_mfma_f32_16x16x32_bf16 v[108:111], a[220:223], a[156:159], v[108:111]
    v_exp_f32 v25, v77
    v_mfma_f32_16x16x32_bf16 v[116:119], a[208:211], a[160:163], v[180:183]
    v_exp_f32 v26, v78
    v_mfma_f32_16x16x32_bf16 v[116:119], a[212:215], a[164:167], v[116:119]
    v_cvt_pk_bf16_f32 v134, v24, v25
    v_add_f32 v15, v15, v40
    v_mfma_f32_16x16x32_bf16 v[116:119], a[216:219], a[168:171], v[116:119]
    v_exp_f32 v27, v79
    v_mfma_f32_16x16x32_bf16 v[116:119], a[220:223], a[172:175], v[116:119]
    buffer_load_dwordx4 v7, s[28:31], s53 offen offset:3072 sc1 lds
    v_mfma_f32_16x16x32_bf16 v[124:127], a[208:211], a[176:179], v[188:191]
    s_add_u32 s53, s53, 16384
    v_exp_f32 v20, v80
    v_mfma_f32_16x16x32_bf16 v[124:127], a[212:215], a[180:183], v[124:127]
    v_cvt_pk_bf16_f32 v135, v26, v27
    v_mfma_f32_16x16x32_bf16 v[124:127], a[216:219], a[184:187], v[124:127]
    v_exp_f32 v21, v81
    v_mfma_f32_16x16x32_bf16 v[32:35], v[44:47], v[132:135], 0
    v_exp_f32 v22, v82
    v_mfma_f32_16x16x32_bf16 v[124:127], a[220:223], a[188:191], v[124:127]
    s_waitcnt vmcnt(16) lgkmcnt(0)
    v_add_u32 v6, s54, v2
    v_cvt_pk_bf16_f32 v136, v20, v21
    v_mfma_f32_16x16x32_bf16 a[0:3], a[224:227], v[144:147], a[0:3]
    s_barrier
    v_mfma_f32_16x16x32_bf16 a[32:35], a[224:227], v[148:151], a[32:35]
    ds_read_b128 a[192:195], v6 offset:0
    v_mfma_f32_16x16x32_bf16 a[64:67], a[224:227], v[152:155], a[64:67]
    v_exp_f32 v23, v83
    v_mfma_f32_16x16x32_bf16 a[96:99], a[224:227], v[156:159], a[96:99]
    v_exp_f32 v24, v84
    v_mfma_f32_16x16x32_bf16 a[4:7], a[228:231], v[144:147], a[4:7]
    ds_read_b128 a[196:199], v6 offset:1024
    v_cvt_pk_bf16_f32 v137, v22, v23
    v_mfma_f32_16x16x32_bf16 a[36:39], a[228:231], v[148:151], a[36:39]
    v_exp_f32 v25, v85
    v_mfma_f32_16x16x32_bf16 a[68:71], a[228:231], v[152:155], a[68:71]
    v_exp_f32 v26, v86
    v_mfma_f32_16x16x32_bf16 a[100:103], a[228:231], v[156:159], a[100:103]
    ds_read_b128 a[200:203], v6 offset:2048
    v_cvt_pk_bf16_f32 v138, v24, v25
    v_mfma_f32_16x16x32_bf16 a[8:11], a[232:235], v[144:147], a[8:11]
    v_exp_f32 v27, v87
    v_mfma_f32_16x16x32_bf16 a[40:43], a[232:235], v[148:151], a[40:43]
    v_exp_f32 v20, v88
    v_mfma_f32_16x16x32_bf16 a[72:75], a[232:235], v[152:155], a[72:75]
    ds_read_b128 a[204:207], v6 offset:3072
    v_cvt_pk_bf16_f32 v139, v26, v27
    v_mfma_f32_16x16x32_bf16 a[104:107], a[232:235], v[156:159], a[104:107]
    v_exp_f32 v21, v89
    v_mfma_f32_16x16x32_bf16 v[36:39], v[44:47], v[136:139], 0
    v_exp_f32 v22, v90
    v_mfma_f32_16x16x32_bf16 a[12:15], a[236:239], v[144:147], a[12:15]
    v_cvt_pk_bf16_f32 v140, v20, v21
    v_mfma_f32_16x16x32_bf16 a[44:47], a[236:239], v[148:151], a[44:47]
    v_exp_f32 v23, v91
    v_mfma_f32_16x16x32_bf16 a[76:79], a[236:239], v[152:155], a[76:79]
    v_exp_f32 v24, v92
    v_mfma_f32_16x16x32_bf16 a[108:111], a[236:239], v[156:159], a[108:111]
    v_cvt_pk_bf16_f32 v141, v22, v23
    v_mfma_f32_16x16x32_bf16 a[16:19], a[240:243], v[144:147], a[16:19]
    v_exp_f32 v25, v93
    v_mfma_f32_16x16x32_bf16 a[48:51], a[240:243], v[148:151], a[48:51]
    v_exp_f32 v26, v94
    v_mfma_f32_16x16x32_bf16 a[80:83], a[240:243], v[152:155], a[80:83]
    v_cvt_pk_bf16_f32 v142, v24, v25
    v_mfma_f32_16x16x32_bf16 a[112:115], a[240:243], v[156:159], a[112:115]
    v_exp_f32 v27, v95
    v_mfma_f32_16x16x32_bf16 a[20:23], a[244:247], v[144:147], a[20:23]
    v_cvt_pk_bf16_f32 v143, v26, v27
    v_mfma_f32_16x16x32_bf16 a[52:55], a[244:247], v[148:151], a[52:55]
    v_mfma_f32_16x16x32_bf16 a[84:87], a[244:247], v[152:155], a[84:87]
    v_mfma_f32_16x16x32_bf16 v[40:43], v[44:47], v[140:143], 0
    s_nop 2
    v_mfma_f32_16x16x32_bf16 a[116:119], a[244:247], v[156:159], a[116:119]
    s_nop 2
    v_mfma_f32_16x16x32_bf16 a[24:27], a[248:251], v[144:147], a[24:27]
    v_max3_f32 v8, v28, v32, v36
    v_max_f32 v8, v8, v40
    v_mfma_f32_16x16x32_bf16 a[56:59], a[248:251], v[148:151], a[56:59]
    v_cmp_nge_f32 vcc, s62, v8
    v_mfma_f32_16x16x32_bf16 a[88:91], a[248:251], v[152:155], a[88:91]
    v_mfma_f32_16x16x32_bf16 a[120:123], a[248:251], v[156:159], a[120:123]
    ds_read_b128 a[208:211], v6 offset:4096
    v_mfma_f32_16x16x32_bf16 a[28:31], a[252:255], v[144:147], a[28:31]
    ds_read_b128 a[212:215], v6 offset:5120
    v_mfma_f32_16x16x32_bf16 a[60:63], a[252:255], v[148:151], a[60:63]
    ds_read_b128 a[216:219], v6 offset:6144
    v_mfma_f32_16x16x32_bf16 a[92:95], a[252:255], v[152:155], a[92:95]
    ds_read_b128 a[220:223], v6 offset:7168
    v_mfma_f32_16x16x32_bf16 a[124:127], a[252:255], v[156:159], a[124:127]
    s_waitcnt lgkmcnt(4)
    s_cbranch_vccz mega_kernel_dual66
    v_cmp_lt_f32 vcc, s61, v8
    s_cmp_lg_u32 s60, s63
    s_cbranch_scc1 mega_kernel_e70
    v_add_f32 v176, v176, v16
    v_mov_b32 v180, v9
    v_add_f32 v188, v188, v16
    v_add_f32 v177, v177, v17
    v_mov_b32 v181, v9
    v_add_f32 v189, v189, v17
    v_add_f32 v178, v178, v18
    v_mov_b32 v182, v9
    v_add_f32 v190, v190, v18
    v_add_f32 v179, v179, v19
    v_mov_b32 v183, v9
    v_add_f32 v191, v191, v19
    s_nop 0
mega_kernel_e70:
    s_cmp_lg_u32 s60, s64
    s_cbranch_scc1 mega_kernel_e71
    v_mov_b32 v176, v9
    v_mov_b32 v184, v9
    v_mov_b32 v188, v9
    v_mov_b32 v177, v9
    v_mov_b32 v185, v9
    v_mov_b32 v189, v9
    v_mov_b32 v178, v9
    v_mov_b32 v186, v9
    v_mov_b32 v190, v9
    v_mov_b32 v179, v9
    v_mov_b32 v187, v9
    v_mov_b32 v191, v9
    s_nop 0
mega_kernel_e71:
    s_cmp_lg_u32 s60, s66
    s_cbranch_scc1 mega_kernel_e72
    v_add_f32 v160, v160, v16
    v_mov_b32 v164, v9
    v_add_f32 v172, v172, v16
    v_add_f32 v161, v161, v17
    v_mov_b32 v165, v9
    v_add_f32 v173, v173, v17
    v_add_f32 v162, v162, v18
    v_mov_b32 v166, v9
    v_add_f32 v174, v174, v18
    v_add_f32 v163, v163, v19
    v_mov_b32 v167, v9
    v_add_f32 v175, v175, v19
    s_nop 0
mega_kernel_e72:
    s_cmp_gt_u32 s60, 26
    s_cbranch_scc1 mega_kernel_e73
    s_cmp_lg_u32 s60, 6
    s_cbranch_scc1 mega_kernel_e75
    s_cmp_eq_u32 s17, -1
    s_cbranch_scc1 mega_kernel_e73
    s_cmp_lg_u32 s16, 0
    s_cbranch_scc1 mega_kernel_np76
    v_mov_b32 v4, s4
    v_mov_b32 v5, s5
    s_add_u32 s90, s17, 117440512
    s_mov_b64 exec, 1
    buffer_store_dwordx2 v[4:5], off, s[8:11], s90 sc1
    s_mov_b64 exec, -1
mega_kernel_np76:
    s_branch mega_kernel_e73
mega_kernel_e75:
    s_cmp_lg_u32 s60, 22
    s_cbranch_scc1 mega_kernel_e77
    buffer_load_dwordx2 v[4:5], v10, s[8:11], 0 offen sc1
    s_mov_b32 s44, s48
    s_mov_b32 s45, s49
    s_mov_b32 s46, 8388608
    s_lshl_b32 s90, s2, 2
    s_add_u32 s90, s90, s16
    s_lshl_b32 s90, s90, 13
    v_lshlrev_b32 v62, 7, v1
    buffer_load_dword v255, v62, s[44:47], s90 offen
    s_branch mega_kernel_e73
mega_kernel_e77:
    s_cmp_lg_u32 s60, 26
    s_cbranch_scc1 mega_kernel_e78
    s_mov_b32 s44, s50
    s_mov_b32 s45, s51
    s_mov_b32 s46, 2097152
    s_lshl_b32 s90, s2, 2
    s_add_u32 s90, s90, s16
    s_lshl_b32 s90, s90, 13
    v_lshlrev_b32 v62, 7, v1
    buffer_load_dword v255, v62, s[44:47], s90 offen
    s_waitcnt vmcnt(18)
    s_mov_b32 s3, 1048576
mega_kernel_spin79:
    v_cmp_ne_u64 s[72:73], s[4:5], v[4:5]
    s_nop 3
    s_cmp_eq_u64 s[72:73], 0
    s_cbranch_scc1 mega_kernel_e73
    s_sub_u32 s3, s3, 1
    s_cbranch_scc1 mega_kernel_e73
    s_sleep 32
    buffer_load_dwordx2 v[4:5], v10, s[8:11], 0 offen sc1
    s_waitcnt vmcnt(0)
    s_branch mega_kernel_spin79
    s_branch mega_kernel_e73
mega_kernel_e78:
mega_kernel_e73:
    s_cbranch_vccnz mega_kernel_rc80
mega_kernel_sp69:
    s_cmp_lg_u32 s60, s65
    s_cbranch_scc1 mega_kernel_dual66
    v_mfma_f32_16x16x32_bf16 v[64:67], a[192:195], a[128:131], v[160:163]
    s_bitcmp1_b64 s[58:59], s60
    s_cselect_b32 s62, -1.0, s61
    v_add_f32 v12, v12, v28
    v_mfma_f32_16x16x32_bf16 v[64:67], a[196:199], a[132:135], v[64:67]
    s_add_u32 s60, s60, 1
    ds_read_b128 a[224:227], v6 offset:16384
    v_exp_f32 v20, v96
    v_mfma_f32_16x16x32_bf16 v[64:67], a[200:203], a[136:139], v[64:67]
    s_mov_b32 m0, s55
    ds_read_b128 a[228:231], v6 offset:17408
    v_add_f32 v13, v13, v32
    v_mfma_f32_16x16x32_bf16 v[64:67], a[204:207], a[140:143], v[64:67]
    buffer_load_dwordx4 v7, s[24:27], s52 offen offset:0 sc1 lds
    v_mfma_f32_16x16x32_bf16 v[72:75], a[192:195], a[144:147], v[168:171]
    ds_read_b128 a[232:235], v6 offset:18432
    v_add_f32 v14, v14, v36
    v_mfma_f32_16x16x32_bf16 v[72:75], a[196:199], a[148:151], v[72:75]
    ds_read_b128 a[236:239], v6 offset:19456
    v_exp_f32 v21, v97
    v_mfma_f32_16x16x32_bf16 v[72:75], a[200:203], a[152:155], v[72:75]
    ds_read_b128 a[240:243], v6 offset:20480
    v_cvt_pk_bf16_f32 v144, v20, v21
    v_mfma_f32_16x16x32_bf16 v[72:75], a[204:207], a[156:159], v[72:75]
    s_waitcnt lgkmcnt(5)
    ds_read_b128 a[244:247], v6 offset:21504
    v_add_f32 v15, v15, v40
    v_mfma_f32_16x16x32_bf16 v[68:71], a[208:211], a[128:131], v[164:167]
    ds_read_b128 a[248:251], v6 offset:22528
    v_exp_f32 v22, v98
    v_mfma_f32_16x16x32_bf16 v[68:71], a[212:215], a[132:135], v[68:71]
    ds_read_b128 a[252:255], v6 offset:23552
    v_exp_f32 v23, v99
    v_mfma_f32_16x16x32_bf16 v[68:71], a[216:219], a[136:139], v[68:71]
    v_exp_f32 v24, v100
    v_mfma_f32_16x16x32_bf16 v[68:71], a[220:223], a[140:143], v[68:71]
    buffer_load_dwordx4 v7, s[24:27], s52 offen offset:1024 sc1 lds
    v_mfma_f32_16x16x32_bf16 v[76:79], a[208:211], a[144:147], v[172:175]
    v_cvt_pk_bf16_f32 v145, v22, v23
    v_exp_f32 v25, v101
    v_mfma_f32_16x16x32_bf16 v[76:79], a[212:215], a[148:151], v[76:79]
    v_exp_f32 v26, v102
    v_mfma_f32_16x16x32_bf16 v[76:79], a[216:219], a[152:155], v[76:79]
    v_cvt_pk_bf16_f32 v146, v24, v25
    v_exp_f32 v27, v103
    v_mfma_f32_16x16x32_bf16 v[76:79], a[220:223], a[156:159], v[76:79]
    s_waitcnt lgkmcnt(0)
    v_exp_f32 v20, v104
    v_mfma_f32_16x16x32_bf16 a[0:3], a[224:227], v[128:131], a[0:3]
    ds_read_b128 a[192:195], v6 offset:8192
    v_cvt_pk_bf16_f32 v147, v26, v27
    v_mfma_f32_16x16x32_bf16 a[32:35], a[224:227], v[132:135], a[32:35]
    v_exp_f32 v21, v105
    v_mfma_f32_16x16x32_bf16 v[28:31], v[44:47], v[144:147], 0
    v_exp_f32 v22, v106
    v_mfma_f32_16x16x32_bf16 a[64:67], a[224:227], v[136:139], a[64:67]
    v_cvt_pk_bf16_f32 v148, v20, v21
    v_exp_f32 v23, v107
    v_mfma_f32_16x16x32_bf16 a[96:99], a[224:227], v[140:143], a[96:99]
    ds_read_b128 a[196:199], v6 offset:9216
    v_cvt_pk_bf16_f32 v149, v22, v23
    v_mfma_f32_16x16x32_bf16 a[4:7], a[228:231], v[128:131], a[4:7]
    v_exp_f32 v24, v108
    v_mfma_f32_16x16x32_bf16 a[36:39], a[228:231], v[132:135], a[36:39]
    buffer_load_dwordx4 v7, s[24:27], s52 offen offset:2048 sc1 lds
    v_mfma_f32_16x16x32_bf16 a[68:71], a[228:231], v[136:139], a[68:71]
    ds_read_b128 a[200:203], v6 offset:10240
    v_exp_f32 v25, v109
    v_mfma_f32_16x16x32_bf16 a[100:103], a[228:231], v[140:143], a[100:103]
    v_exp_f32 v26, v110
    v_mfma_f32_16x16x32_bf16 a[8:11], a[232:235], v[128:131], a[8:11]
    v_cvt_pk_bf16_f32 v150, v24, v25
    v_exp_f32 v27, v111
    v_mfma_f32_16x16x32_bf16 a[40:43], a[232:235], v[132:135], a[40:43]
    ds_read_b128 a[204:207], v6 offset:11264
    v_cvt_pk_bf16_f32 v151, v26, v27
    v_mfma_f32_16x16x32_bf16 a[72:75], a[232:235], v[136:139], a[72:75]
    v_exp_f32 v20, v112
    v_mfma_f32_16x16x32_bf16 v[32:35], v[44:47], v[148:151], 0
    v_exp_f32 v21, v113
    v_mfma_f32_16x16x32_bf16 a[104:107], a[232:235], v[140:143], a[104:107]
    v_exp_f32 v22, v114
    v_mfma_f32_16x16x32_bf16 a[12:15], a[236:239], v[128:131], a[12:15]
    v_cvt_pk_bf16_f32 v152, v20, v21
    v_exp_f32 v23, v115
    v_mfma_f32_16x16x32_bf16 a[44:47], a[236:239], v[132:135], a[44:47]
    v_exp_f32 v24, v116
    v_mfma_f32_16x16x32_bf16 a[76:79], a[236:239], v[136:139], a[76:79]
    v_cvt_pk_bf16_f32 v153, v22, v23
    v_exp_f32 v25, v117
    v_mfma_f32_16x16x32_bf16 a[108:111], a[236:239], v[140:143], a[108:111]
    buffer_load_dwordx4 v7, s[24:27], s52 offen offset:3072 sc1 lds
    v_mfma_f32_16x16x32_bf16 a[16:19], a[240:243], v[128:131], a[16:19]
    s_add_u32 s52, s52, 16384
    v_exp_f32 v26, v118
    v_mfma_f32_16x16x32_bf16 a[48:51], a[240:243], v[132:135], a[48:51]
    v_cvt_pk_bf16_f32 v154, v24, v25
    v_exp_f32 v27, v119
    v_mfma_f32_16x16x32_bf16 a[80:83], a[240:243], v[136:139], a[80:83]
    v_exp_f32 v20, v120
    v_mfma_f32_16x16x32_bf16 a[112:115], a[240:243], v[140:143], a[112:115]
    v_cvt_pk_bf16_f32 v155, v26, v27
    v_exp_f32 v21, v121
    v_mfma_f32_16x16x32_bf16 a[20:23], a[244:247], v[128:131], a[20:23]
    v_exp_f32 v22, v122
    v_mfma_f32_16x16x32_bf16 v[36:39], v[44:47], v[152:155], 0
    v_cvt_pk_bf16_f32 v156, v20, v21
    v_mfma_f32_16x16x32_bf16 a[52:55], a[244:247], v[132:135], a[52:55]
    v_exp_f32 v23, v123
    v_mfma_f32_16x16x32_bf16 a[84:87], a[244:247], v[136:139], a[84:87]
    v_exp_f32 v24, v124
    v_cvt_pk_bf16_f32 v157, v22, v23
    v_mfma_f32_16x16x32_bf16 a[116:119], a[244:247], v[140:143], a[116:119]
    v_exp_f32 v25, v125
    v_mfma_f32_16x16x32_bf16 a[24:27], a[248:251], v[128:131], a[24:27]
    s_add_u32 m0, s55, 16384
    v_exp_f32 v26, v126
    v_mfma_f32_16x16x32_bf16 a[56:59], a[248:251], v[132:135], a[56:59]
    buffer_load_dwordx4 v7, s[28:31], s53 offen offset:0 sc1 lds
    v_mfma_f32_16x16x32_bf16 a[88:91], a[248:251], v[136:139], a[88:91]
    v_cvt_pk_bf16_f32 v158, v24, v25
    v_exp_f32 v27, v127
    v_mfma_f32_16x16x32_bf16 a[120:123], a[248:251], v[140:143], a[120:123]
    ds_read_b128 a[208:211], v6 offset:12288
    v_cvt_pk_bf16_f32 v159, v26, v27
    s_nop 1
    v_mfma_f32_16x16x32_bf16 v[40:43], v[44:47], v[156:159], 0
    s_nop 2
    v_mfma_f32_16x16x32_bf16 a[28:31], a[252:255], v[128:131], a[28:31]
    ds_read_b128 a[212:215], v6 offset:13312
    s_nop 0
    v_mfma_f32_16x16x32_bf16 a[60:63], a[252:255], v[132:135], a[60:63]
    ds_read_b128 a[216:219], v6 offset:14336
    v_max3_f32 v8, v28, v32, v36
    v_mfma_f32_16x16x32_bf16 a[92:95], a[252:255], v[136:139], a[92:95]
    ds_read_b128 a[220:223], v6 offset:15360
    v_max_f32 v8, v8, v40
    v_cmp_nge_f32 vcc, s62, v8
    v_mfma_f32_16x16x32_bf16 a[124:127], a[252:255], v[140:143], a[124:127]
    s_waitcnt lgkmcnt(4)
    s_cbranch_vccnz mega_kernel_stub81
mega_kernel_ret82:
    v_mfma_f32_16x16x32_bf16 v[96:99], a[192:195], a[128:131], v[160:163]
    s_add_u32 s55, s54, s56
    v_exp_f32 v20, v64
    v_mfma_f32_16x16x32_bf16 v[96:99], a[196:199], a[132:135], v[96:99]
    s_add_u32 s54, s54, 32768
    ds_read_b128 a[224:227], v6 offset:24576
    v_add_f32 v12, v12, v28
    v_mfma_f32_16x16x32_bf16 v[96:99], a[200:203], a[136:139], v[96:99]
    s_and_b32 s54, s54, 0x1ffff
    ds_read_b128 a[228:231], v6 offset:25600
    v_add_f32 v13, v13, v32
    v_mfma_f32_16x16x32_bf16 v[96:99], a[204:207], a[140:143], v[96:99]
    buffer_load_dwordx4 v7, s[28:31], s53 offen offset:1024 sc1 lds
    v_mfma_f32_16x16x32_bf16 v[104:107], a[192:195], a[144:147], v[168:171]
    s_bitcmp1_b64 s[58:59], s60
    s_cselect_b32 s62, -1.0, s61
    ds_read_b128 a[232:235], v6 offset:26624
    v_mfma_f32_16x16x32_bf16 v[104:107], a[196:199], a[148:151], v[104:107]
    s_add_u32 s60, s60, 1
    ds_read_b128 a[236:239], v6 offset:27648
    v_mfma_f32_16x16x32_bf16 v[104:107], a[200:203], a[152:155], v[104:107]
    ds_read_b128 a[240:243], v6 offset:28672
    v_mfma_f32_16x16x32_bf16 v[104:107], a[204:207], a[156:159], v[104:107]
    s_waitcnt lgkmcnt(5)
    ds_read_b128 a[244:247], v6 offset:29696
    v_mfma_f32_16x16x32_bf16 v[100:103], a[208:211], a[128:131], v[164:167]
    buffer_load_dwordx4 v7, s[28:31], s53 offen offset:2048 sc1 lds
    v_mfma_f32_16x16x32_bf16 v[100:103], a[212:215], a[132:135], v[100:103]
    ds_read_b128 a[248:251], v6 offset:30720
    v_mfma_f32_16x16x32_bf16 v[100:103], a[216:219], a[136:139], v[100:103]
    ds_read_b128 a[252:255], v6 offset:31744
    v_mfma_f32_16x16x32_bf16 v[100:103], a[220:223], a[140:143], v[100:103]
    v_exp_f32 v21, v65
    v_mfma_f32_16x16x32_bf16 v[108:111], a[208:211], a[144:147], v[172:175]
    v_exp_f32 v22, v66
    v_mfma_f32_16x16x32_bf16 v[108:111], a[212:215], a[148:151], v[108:111]
    buffer_load_dwordx4 v7, s[28:31], s53 offen offset:3072 sc1 lds
    v_mfma_f32_16x16x32_bf16 v[108:111], a[216:219], a[152:155], v[108:111]
    s_add_u32 s53, s53, 16384
    v_cvt_pk_bf16_f32 v128, v20, v21
    v_mfma_f32_16x16x32_bf16 v[108:111], a[220:223], a[156:159], v[108:111]
    s_waitcnt vmcnt(16) lgkmcnt(0)
    v_add_u32 v6, s54, v2
    v_mfma_f32_16x16x32_bf16 a[0:3], a[224:227], v[144:147], a[0:3]
    s_barrier
    v_mfma_f32_16x16x32_bf16 a[32:35], a[224:227], v[148:151], a[32:35]
    ds_read_b128 a[192:195], v6 offset:0
    v_mfma_f32_16x16x32_bf16 a[64:67], a[224:227], v[152:155], a[64:67]
    v_exp_f32 v23, v67
    v_mfma_f32_16x16x32_bf16 a[96:99], a[224:227], v[156:159], a[96:99]
    v_exp_f32 v24, v68
    v_mfma_f32_16x16x32_bf16 a[4:7], a[228:231], v[144:147], a[4:7]
    ds_read_b128 a[196:199], v6 offset:1024
    v_cvt_pk_bf16_f32 v129, v22, v23
    v_mfma_f32_16x16x32_bf16 a[36:39], a[228:231], v[148:151], a[36:39]
    v_exp_f32 v25, v69
    v_mfma_f32_16x16x32_bf16 a[68:71], a[228:231], v[152:155], a[68:71]
    v_exp_f32 v26, v70
    v_mfma_f32_16x16x32_bf16 a[100:103], a[228:231], v[156:159], a[100:103]
    ds_read_b128 a[200:203], v6 offset:2048
    v_cvt_pk_bf16_f32 v130, v24, v25
    v_mfma_f32_16x16x32_bf16 a[8:11], a[232:235], v[144:147], a[8:11]
    v_exp_f32 v27, v71
    v_mfma_f32_16x16x32_bf16 a[40:43], a[232:235], v[148:151], a[40:43]
    v_exp_f32 v20, v72
    v_mfma_f32_16x16x32_bf16 a[72:75], a[232:235], v[152:155], a[72:75]
    ds_read_b128 a[204:207], v6 offset:3072
    v_cvt_pk_bf16_f32 v131, v26, v27
    v_mfma_f32_16x16x32_bf16 a[104:107], a[232:235], v[156:159], a[104:107]
    v_exp_f32 v21, v73
    v_mfma_f32_16x16x32_bf16 v[28:31], v[44:47], v[128:131], 0
    v_exp_f32 v22, v74
    v_mfma_f32_16x16x32_bf16 a[12:15], a[236:239], v[144:147], a[12:15]
    v_cvt_pk_bf16_f32 v132, v20, v21
    v_mfma_f32_16x16x32_bf16 a[44:47], a[236:239], v[148:151], a[44:47]
    v_exp_f32 v23, v75
    v_mfma_f32_16x16x32_bf16 a[76:79], a[236:239], v[152:155], a[76:79]
    v_exp_f32 v24, v76
    v_mfma_f32_16x16x32_bf16 a[108:111], a[236:239], v[156:159], a[108:111]
    v_cvt_pk_bf16_f32 v133, v22, v23
    v_mfma_f32_16x16x32_bf16 a[16:19], a[240:243], v[144:147], a[16:19]
    v_exp_f32 v25, v77
    v_mfma_f32_16x16x32_bf16 a[48:51], a[240:243], v[148:151], a[48:51]
    v_exp_f32 v26, v78
    v_mfma_f32_16x16x32_bf16 a[80:83], a[240:243], v[152:155], a[80:83]
    v_cvt_pk_bf16_f32 v134, v24, v25
    v_mfma_f32_16x16x32_bf16 a[112:115], a[240:243], v[156:159], a[112:115]
    v_exp_f32 v27, v79
    v_mfma_f32_16x16x32_bf16 a[20:23], a[244:247], v[144:147], a[20:23]
    v_cvt_pk_bf16_f32 v135, v26, v27
    v_mfma_f32_16x16x32_bf16 a[52:55], a[244:247], v[148:151], a[52:55]
    v_mfma_f32_16x16x32_bf16 a[84:87], a[244:247], v[152:155], a[84:87]
    v_mfma_f32_16x16x32_bf16 v[32:35], v[44:47], v[132:135], 0
    s_nop 2
    v_mfma_f32_16x16x32_bf16 a[116:119], a[244:247], v[156:159], a[116:119]
    s_nop 2
    v_mfma_f32_16x16x32_bf16 a[24:27], a[248:251], v[144:147], a[24:27]
    v_max_f32 v8, v28, v32
    v_cmp_nge_f32 vcc, s62, v8
    v_mfma_f32_16x16x32_bf16 a[56:59], a[248:251], v[148:151], a[56:59]
    v_mfma_f32_16x16x32_bf16 a[88:91], a[248:251], v[152:155], a[88:91]
    v_mfma_f32_16x16x32_bf16 a[120:123], a[248:251], v[156:159], a[120:123]
    ds_read_b128 a[208:211], v6 offset:4096
    v_mfma_f32_16x16x32_bf16 a[28:31], a[252:255], v[144:147], a[28:31]
    ds_read_b128 a[212:215], v6 offset:5120
    v_mfma_f32_16x16x32_bf16 a[60:63], a[252:255], v[148:151], a[60:63]
    ds_read_b128 a[216:219], v6 offset:6144
    v_mfma_f32_16x16x32_bf16 a[92:95], a[252:255], v[152:155], a[92:95]
    ds_read_b128 a[220:223], v6 offset:7168
    v_mfma_f32_16x16x32_bf16 a[124:127], a[252:255], v[156:159], a[124:127]
    s_waitcnt lgkmcnt(4)
    s_cbranch_vccnz mega_kernel_stub83
mega_kernel_ret84:
    v_add_f32 v20, v14, v36
    v_add_f32 v21, v15, v40
    s_nop 3
    v_rcp_f32 v20, v20
    v_rcp_f32 v21, v21
    s_lshl_b32 s90, s75, 10
    s_add_u32 s90, s90, s78
    s_add_u32 s90, s90, 67108864
    v_accvgpr_read_b32 v48, a64
    v_accvgpr_read_b32 v49, a65
    v_accvgpr_read_b32 v50, a66
    v_accvgpr_read_b32 v51, a67
    v_accvgpr_read_b32 v52, a68
    v_accvgpr_read_b32 v53, a69
    v_accvgpr_read_b32 v54, a70
    v_accvgpr_read_b32 v55, a71
    v_mul_f32 v48, v20, v48
    v_mul_f32 v49, v20, v49
    v_mul_f32 v50, v20, v50
    v_mul_f32 v51, v20, v51
    v_mul_f32 v52, v20, v52
    v_mul_f32 v53, v20, v53
    v_mul_f32 v54, v20, v54
    v_mul_f32 v55, v20, v55
    v_cvt_pk_bf16_f32 v48, v48, v49
    v_cvt_pk_bf16_f32 v49, v50, v51
    v_cvt_pk_bf16_f32 v50, v52, v53
    v_cvt_pk_bf16_f32 v51, v54, v55
    buffer_store_dwordx4 v[48:51], v2, s[8:11], s90 offen offset:0 sc1
    v_accvgpr_read_b32 v56, a96
    v_accvgpr_read_b32 v57, a97
    v_accvgpr_read_b32 v58, a98
    v_accvgpr_read_b32 v59, a99
    v_accvgpr_read_b32 v60, a100
    v_accvgpr_read_b32 v61, a101
    v_accvgpr_read_b32 v62, a102
    v_accvgpr_read_b32 v63, a103
    v_mul_f32 v56, v21, v56
    v_mul_f32 v57, v21, v57
    v_mul_f32 v58, v21, v58
    v_mul_f32 v59, v21, v59
    v_mul_f32 v60, v21, v60
    v_mul_f32 v61, v21, v61
    v_mul_f32 v62, v21, v62
    v_mul_f32 v63, v21, v63
    v_cvt_pk_bf16_f32 v56, v56, v57
    v_cvt_pk_bf16_f32 v57, v58, v59
    v_cvt_pk_bf16_f32 v58, v60, v61
    v_cvt_pk_bf16_f32 v59, v62, v63
    buffer_store_dwordx4 v[56:59], v2, s[8:11], s90 offen offset:1024 sc1
    s_add_u32 s90, s90, 131072
    v_accvgpr_read_b32 v48, a72
    v_accvgpr_read_b32 v49, a73
    v_accvgpr_read_b32 v50, a74
    v_accvgpr_read_b32 v51, a75
    v_accvgpr_read_b32 v52, a76
    v_accvgpr_read_b32 v53, a77
    v_accvgpr_read_b32 v54, a78
    v_accvgpr_read_b32 v55, a79
    v_mul_f32 v48, v20, v48
    v_mul_f32 v49, v20, v49
    v_mul_f32 v50, v20, v50
    v_mul_f32 v51, v20, v51
    v_mul_f32 v52, v20, v52
    v_mul_f32 v53, v20, v53
    v_mul_f32 v54, v20, v54
    v_mul_f32 v55, v20, v55
    v_cvt_pk_bf16_f32 v48, v48, v49
    v_cvt_pk_bf16_f32 v49, v50, v51
    v_cvt_pk_bf16_f32 v50, v52, v53
    v_cvt_pk_bf16_f32 v51, v54, v55
    buffer_store_dwordx4 v[48:51], v2, s[8:11], s90 offen offset:0 sc1
    v_accvgpr_read_b32 v56, a104
    v_accvgpr_read_b32 v57, a105
    v_accvgpr_read_b32 v58, a106
    v_accvgpr_read_b32 v59, a107
    v_accvgpr_read_b32 v60, a108
    v_accvgpr_read_b32 v61, a109
    v_accvgpr_read_b32 v62, a110
    v_accvgpr_read_b32 v63, a111
    v_mul_f32 v56, v21, v56
    v_mul_f32 v57, v21, v57
    v_mul_f32 v58, v21, v58
    v_mul_f32 v59, v21, v59
    v_mul_f32 v60, v21, v60
    v_mul_f32 v61, v21, v61
    v_mul_f32 v62, v21, v62
    v_mul_f32 v63, v21, v63
    v_cvt_pk_bf16_f32 v56, v56, v57
    v_cvt_pk_bf16_f32 v57, v58, v59
    v_cvt_pk_bf16_f32 v58, v60, v61
    v_cvt_pk_bf16_f32 v59, v62, v63
    buffer_store_dwordx4 v[56:59], v2, s[8:11], s90 offen offset:1024 sc1
    s_add_u32 s90, s90, 131072
    v_accvgpr_read_b32 v48, a80
    v_accvgpr_read_b32 v49, a81
    v_accvgpr_read_b32 v50, a82
    v_accvgpr_read_b32 v51, a83
    v_accvgpr_read_b32 v52, a84
    v_accvgpr_read_b32 v53, a85
    v_accvgpr_read_b32 v54, a86
    v_accvgpr_read_b32 v55, a87
    v_mul_f32 v48, v20, v48
    v_mul_f32 v49, v20, v49
    v_mul_f32 v50, v20, v50
    v_mul_f32 v51, v20, v51
    v_mul_f32 v52, v20, v52
    v_mul_f32 v53, v20, v53
    v_mul_f32 v54, v20, v54
    v_mul_f32 v55, v20, v55
    v_cvt_pk_bf16_f32 v48, v48, v49
    v_cvt_pk_bf16_f32 v49, v50, v51
    v_cvt_pk_bf16_f32 v50, v52, v53
    v_cvt_pk_bf16_f32 v51, v54, v55
    buffer_store_dwordx4 v[48:51], v2, s[8:11], s90 offen offset:0 sc1
    v_accvgpr_read_b32 v56, a112
    v_accvgpr_read_b32 v57, a113
    v_accvgpr_read_b32 v58, a114
    v_accvgpr_read_b32 v59, a115
    v_accvgpr_read_b32 v60, a116
    v_accvgpr_read_b32 v61, a117
    v_accvgpr_read_b32 v62, a118
    v_accvgpr_read_b32 v63, a119
    v_mul_f32 v56, v21, v56
    v_mul_f32 v57, v21, v57
    v_mul_f32 v58, v21, v58
    v_mul_f32 v59, v21, v59
    v_mul_f32 v60, v21, v60
    v_mul_f32 v61, v21, v61
    v_mul_f32 v62, v21, v62
    v_mul_f32 v63, v21, v63
    v_cvt_pk_bf16_f32 v56, v56, v57
    v_cvt_pk_bf16_f32 v57, v58, v59
    v_cvt_pk_bf16_f32 v58, v60, v61
    v_cvt_pk_bf16_f32 v59, v62, v63
    buffer_store_dwordx4 v[56:59], v2, s[8:11], s90 offen offset:1024 sc1
    s_add_u32 s90, s90, 131072
    v_accvgpr_read_b32 v48, a88
    v_accvgpr_read_b32 v49, a89
    v_accvgpr_read_b32 v50, a90
    v_accvgpr_read_b32 v51, a91
    v_accvgpr_read_b32 v52, a92
    v_accvgpr_read_b32 v53, a93
    v_accvgpr_read_b32 v54, a94
    v_accvgpr_read_b32 v55, a95
    v_mul_f32 v48, v20, v48
    v_mul_f32 v49, v20, v49
    v_mul_f32 v50, v20, v50
    v_mul_f32 v51, v20, v51
    v_mul_f32 v52, v20, v52
    v_mul_f32 v53, v20, v53
    v_mul_f32 v54, v20, v54
    v_mul_f32 v55, v20, v55
    v_cvt_pk_bf16_f32 v48, v48, v49
    v_cvt_pk_bf16_f32 v49, v50, v51
    v_cvt_pk_bf16_f32 v50, v52, v53
    v_cvt_pk_bf16_f32 v51, v54, v55
    buffer_store_dwordx4 v[48:51], v2, s[8:11], s90 offen offset:0 sc1
    v_accvgpr_read_b32 v56, a120
    v_accvgpr_read_b32 v57, a121
    v_accvgpr_read_b32 v58, a122
    v_accvgpr_read_b32 v59, a123
    v_accvgpr_read_b32 v60, a124
    v_accvgpr_read_b32 v61, a125
    v_accvgpr_read_b32 v62, a126
    v_accvgpr_read_b32 v63, a127
    v_mul_f32 v56, v21, v56
    v_mul_f32 v57, v21, v57
    v_mul_f32 v58, v21, v58
    v_mul_f32 v59, v21, v59
    v_mul_f32 v60, v21, v60
    v_mul_f32 v61, v21, v61
    v_mul_f32 v62, v21, v62
    v_mul_f32 v63, v21, v63
    v_cvt_pk_bf16_f32 v56, v56, v57
    v_cvt_pk_bf16_f32 v57, v58, v59
    v_cvt_pk_bf16_f32 v58, v60, v61
    v_cvt_pk_bf16_f32 v59, v62, v63
    buffer_store_dwordx4 v[56:59], v2, s[8:11], s90 offen offset:1024 sc1
    s_add_u32 s90, s90, 131072
mega_kernel_single85:
    v_mfma_f32_16x16x32_bf16 v[64:67], a[192:195], a[128:131], v[160:163]
    s_bitcmp1_b64 s[58:59], s60
    s_cselect_b32 s62, -1.0, s61
    v_add_f32 v12, v12, v28
    v_mfma_f32_16x16x32_bf16 v[64:67], a[196:199], a[132:135], v[64:67]
    s_mov_b32 m0, s55
    ds_read_b128 a[224:227], v6 offset:16384
    v_add_f32 v13, v13, v32
    v_mfma_f32_16x16x32_bf16 v[64:67], a[200:203], a[136:139], v[64:67]
    buffer_load_dwordx4 v7, s[24:27], s52 offen offset:0 sc1 lds
    v_mfma_f32_16x16x32_bf16 v[64:67], a[204:207], a[140:143], v[64:67]
    s_add_u32 s60, s60, 1
    ds_read_b128 a[228:231], v6 offset:17408
    v_exp_f32 v20, v96
    v_mfma_f32_16x16x32_bf16 v[72:75], a[192:195], a[144:147], v[168:171]
    ds_read_b128 a[232:235], v6 offset:18432
    v_exp_f32 v21, v97
    v_mfma_f32_16x16x32_bf16 v[72:75], a[196:199], a[148:151], v[72:75]
    ds_read_b128 a[236:239], v6 offset:19456
    v_cvt_pk_bf16_f32 v144, v20, v21
    v_mfma_f32_16x16x32_bf16 v[72:75], a[200:203], a[152:155], v[72:75]
    ds_read_b128 a[240:243], v6 offset:20480
    v_exp_f32 v22, v98
    v_mfma_f32_16x16x32_bf16 v[72:75], a[204:207], a[156:159], v[72:75]
    s_waitcnt lgkmcnt(5)
    ds_read_b128 a[244:247], v6 offset:21504
    v_mfma_f32_16x16x32_bf16 v[68:71], a[208:211], a[128:131], v[164:167]
    ds_read_b128 a[248:251], v6 offset:22528
    v_exp_f32 v23, v99
    v_mfma_f32_16x16x32_bf16 v[68:71], a[212:215], a[132:135], v[68:71]
    ds_read_b128 a[252:255], v6 offset:23552
    v_cvt_pk_bf16_f32 v145, v22, v23
    v_mfma_f32_16x16x32_bf16 v[68:71], a[216:219], a[136:139], v[68:71]
    buffer_load_dwordx4 v7, s[24:27], s52 offen offset:1024 sc1 lds
    v_mfma_f32_16x16x32_bf16 v[68:71], a[220:223], a[140:143], v[68:71]
    v_exp_f32 v24, v100
    v_mfma_f32_16x16x32_bf16 v[76:79], a[208:211], a[144:147], v[172:175]
    v_exp_f32 v25, v101
    v_mfma_f32_16x16x32_bf16 v[76:79], a[212:215], a[148:151], v[76:79]
    v_exp_f32 v26, v102
    v_mfma_f32_16x16x32_bf16 v[76:79], a[216:219], a[152:155], v[76:79]
    buffer_load_dwordx4 v7, s[24:27], s52 offen offset:2048 sc1 lds
    v_cvt_pk_bf16_f32 v146, v24, v25
    v_mfma_f32_16x16x32_bf16 v[76:79], a[220:223], a[156:159], v[76:79]
    s_waitcnt lgkmcnt(0)
    v_exp_f32 v27, v103
    v_mfma_f32_16x16x32_bf16 a[0:3], a[224:227], v[128:131], a[0:3]
    ds_read_b128 a[192:195], v6 offset:8192
    v_cvt_pk_bf16_f32 v147, v26, v27
    v_mfma_f32_16x16x32_bf16 a[32:35], a[224:227], v[132:135], a[32:35]
    v_exp_f32 v20, v104
    v_mfma_f32_16x16x32_bf16 v[28:31], v[44:47], v[144:147], 0
    v_exp_f32 v21, v105
    v_mfma_f32_16x16x32_bf16 a[4:7], a[228:231], v[128:131], a[4:7]
    ds_read_b128 a[196:199], v6 offset:9216
    v_exp_f32 v22, v106
    v_mfma_f32_16x16x32_bf16 a[36:39], a[228:231], v[132:135], a[36:39]
    buffer_load_dwordx4 v7, s[24:27], s52 offen offset:3072 sc1 lds
    v_mfma_f32_16x16x32_bf16 a[8:11], a[232:235], v[128:131], a[8:11]
    s_add_u32 s52, s52, 16384
    ds_read_b128 a[200:203], v6 offset:10240
    v_cvt_pk_bf16_f32 v148, v20, v21
    v_mfma_f32_16x16x32_bf16 a[40:43], a[232:235], v[132:135], a[40:43]
    v_exp_f32 v23, v107
    v_mfma_f32_16x16x32_bf16 a[12:15], a[236:239], v[128:131], a[12:15]
    ds_read_b128 a[204:207], v6 offset:11264
    v_exp_f32 v24, v108
    v_mfma_f32_16x16x32_bf16 a[44:47], a[236:239], v[132:135], a[44:47]
    v_cvt_pk_bf16_f32 v149, v22, v23
    v_exp_f32 v25, v109
    v_mfma_f32_16x16x32_bf16 a[16:19], a[240:243], v[128:131], a[16:19]
    v_exp_f32 v26, v110
    v_mfma_f32_16x16x32_bf16 a[48:51], a[240:243], v[132:135], a[48:51]
    v_cvt_pk_bf16_f32 v150, v24, v25
    v_exp_f32 v27, v111
    v_mfma_f32_16x16x32_bf16 a[20:23], a[244:247], v[128:131], a[20:23]
    ds_read_b128 a[208:211], v6 offset:12288
    v_cvt_pk_bf16_f32 v151, v26, v27
    v_mfma_f32_16x16x32_bf16 a[52:55], a[244:247], v[132:135], a[52:55]
    s_add_u32 m0, s55, 16384
    ds_read_b128 a[212:215], v6 offset:13312
    v_mfma_f32_16x16x32_bf16 v[32:35], v[44:47], v[148:151], 0
    s_nop 2
    v_mfma_f32_16x16x32_bf16 a[24:27], a[248:251], v[128:131], a[24:27]
    buffer_load_dwordx4 v7, s[28:31], s53 offen offset:0 sc1 lds
    v_mfma_f32_16x16x32_bf16 a[56:59], a[248:251], v[132:135], a[56:59]
    ds_read_b128 a[216:219], v6 offset:14336
    s_nop 0
    v_mfma_f32_16x16x32_bf16 a[28:31], a[252:255], v[128:131], a[28:31]
    ds_read_b128 a[220:223], v6 offset:15360
    v_max_f32 v8, v28, v32
    v_cmp_nge_f32 vcc, s62, v8
    v_mfma_f32_16x16x32_bf16 a[60:63], a[252:255], v[132:135], a[60:63]
    s_waitcnt lgkmcnt(4)
    s_cbranch_vccnz mega_kernel_stub86
mega_kernel_ret87:
    v_mfma_f32_16x16x32_bf16 v[96:99], a[192:195], a[128:131], v[160:163]
    s_add_u32 s55, s54, s56
    v_exp_f32 v20, v64
    v_mfma_f32_16x16x32_bf16 v[96:99], a[196:199], a[132:135], v[96:99]
    s_add_u32 s54, s54, 32768
    ds_read_b128 a[224:227], v6 offset:24576
    v_add_f32 v12, v12, v28
    v_mfma_f32_16x16x32_bf16 v[96:99], a[200:203], a[136:139], v[96:99]
    s_and_b32 s54, s54, 0x1ffff
    ds_read_b128 a[228:231], v6 offset:25600
    v_exp_f32 v21, v65
    v_mfma_f32_16x16x32_bf16 v[96:99], a[204:207], a[140:143], v[96:99]
    s_bitcmp1_b64 s[58:59], s60
    s_cselect_b32 s62, -1.0, s61
    ds_read_b128 a[232:235], v6 offset:26624
    v_mfma_f32_16x16x32_bf16 v[104:107], a[192:195], a[144:147], v[168:171]
    buffer_load_dwordx4 v7, s[28:31], s53 offen offset:1024 sc1 lds
    v_mfma_f32_16x16x32_bf16 v[104:107], a[196:199], a[148:151], v[104:107]
    s_add_u32 s60, s60, 1
    ds_read_b128 a[236:239], v6 offset:27648
    v_cvt_pk_bf16_f32 v128, v20, v21
    v_mfma_f32_16x16x32_bf16 v[104:107], a[200:203], a[152:155], v[104:107]
    ds_read_b128 a[240:243], v6 offset:28672
    v_exp_f32 v22, v66
    v_mfma_f32_16x16x32_bf16 v[104:107], a[204:207], a[156:159], v[104:107]
    s_waitcnt lgkmcnt(5)
    ds_read_b128 a[244:247], v6 offset:29696
    v_add_f32 v13, v13, v32
    v_mfma_f32_16x16x32_bf16 v[100:103], a[208:211], a[128:131], v[164:167]
    ds_read_b128 a[248:251], v6 offset:30720
    v_exp_f32 v23, v67
    v_mfma_f32_16x16x32_bf16 v[100:103], a[212:215], a[132:135], v[100:103]
    buffer_load_dwordx4 v7, s[28:31], s53 offen offset:2048 sc1 lds
    v_mfma_f32_16x16x32_bf16 v[100:103], a[216:219], a[136:139], v[100:103]
    ds_read_b128 a[252:255], v6 offset:31744
    v_cvt_pk_bf16_f32 v129, v22, v23
    v_mfma_f32_16x16x32_bf16 v[100:103], a[220:223], a[140:143], v[100:103]
    v_exp_f32 v24, v68
    v_mfma_f32_16x16x32_bf16 v[108:111], a[208:211], a[144:147], v[172:175]
    v_exp_f32 v25, v69
    v_mfma_f32_16x16x32_bf16 v[108:111], a[212:215], a[148:151], v[108:111]
    buffer_load_dwordx4 v7, s[28:31], s53 offen offset:3072 sc1 lds
    v_mfma_f32_16x16x32_bf16 v[108:111], a[216:219], a[152:155], v[108:111]
    s_add_u32 s53, s53, 16384
    v_exp_f32 v26, v70
    v_cvt_pk_bf16_f32 v130, v24, v25
    v_mfma_f32_16x16x32_bf16 v[108:111], a[220:223], a[156:159], v[108:111]
    s_waitcnt vmcnt(16) lgkmcnt(0)
    v_add_u32 v6, s54, v2
    v_exp_f32 v27, v71
    v_mfma_f32_16x16x32_bf16 a[0:3], a[224:227], v[144:147], a[0:3]
    s_barrier
    v_mfma_f32_16x16x32_bf16 a[32:35], a[224:227], v[148:151], a[32:35]
    ds_read_b128 a[192:195], v6 offset:0
    v_cvt_pk_bf16_f32 v131, v26, v27
    v_mfma_f32_16x16x32_bf16 a[4:7], a[228:231], v[144:147], a[4:7]
    v_exp_f32 v20, v72
    v_mfma_f32_16x16x32_bf16 v[28:31], v[44:47], v[128:131], 0
    v_exp_f32 v21, v73
    v_mfma_f32_16x16x32_bf16 a[36:39], a[228:231], v[148:151], a[36:39]
    ds_read_b128 a[196:199], v6 offset:1024
    v_cvt_pk_bf16_f32 v132, v20, v21
    v_mfma_f32_16x16x32_bf16 a[8:11], a[232:235], v[144:147], a[8:11]
    v_exp_f32 v22, v74
    v_mfma_f32_16x16x32_bf16 a[40:43], a[232:235], v[148:151], a[40:43]
    ds_read_b128 a[200:203], v6 offset:2048
    v_exp_f32 v23, v75
    v_mfma_f32_16x16x32_bf16 a[12:15], a[236:239], v[144:147], a[12:15]
    v_exp_f32 v24, v76
    v_mfma_f32_16x16x32_bf16 a[44:47], a[236:239], v[148:151], a[44:47]
    ds_read_b128 a[204:207], v6 offset:3072
    v_cvt_pk_bf16_f32 v133, v22, v23
    v_mfma_f32_16x16x32_bf16 a[16:19], a[240:243], v[144:147], a[16:19]
    v_exp_f32 v25, v77
    v_mfma_f32_16x16x32_bf16 a[48:51], a[240:243], v[148:151], a[48:51]
    v_exp_f32 v26, v78
    v_cvt_pk_bf16_f32 v134, v24, v25
    v_mfma_f32_16x16x32_bf16 a[20:23], a[244:247], v[144:147], a[20:23]
    v_exp_f32 v27, v79
    v_mfma_f32_16x16x32_bf16 a[52:55], a[244:247], v[148:151], a[52:55]
    ds_read_b128 a[208:211], v6 offset:4096
    v_cvt_pk_bf16_f32 v135, v26, v27
    s_nop 1
    v_mfma_f32_16x16x32_bf16 v[32:35], v[44:47], v[132:135], 0
    s_nop 2
    v_mfma_f32_16x16x32_bf16 a[24:27], a[248:251], v[144:147], a[24:27]
    ds_read_b128 a[212:215], v6 offset:5120
    s_nop 0
    v_mfma_f32_16x16x32_bf16 a[56:59], a[248:251], v[148:151], a[56:59]
    ds_read_b128 a[216:219], v6 offset:6144
    v_max_f32 v8, v28, v32
    v_mfma_f32_16x16x32_bf16 a[28:31], a[252:255], v[144:147], a[28:31]
    ds_read_b128 a[220:223], v6 offset:7168
    v_cmp_nge_f32 vcc, s62, v8
    v_mfma_f32_16x16x32_bf16 a[60:63], a[252:255], v[148:151], a[60:63]
    s_waitcnt lgkmcnt(4)
    s_cbranch_vccz mega_kernel_single85
    v_cmp_lt_f32 vcc, s61, v8
    s_cmp_lg_u32 s60, s66
    s_cbranch_scc1 mega_kernel_e89
    v_add_f32 v160, v160, v16
    v_mov_b32 v164, v9
    v_add_f32 v172, v172, v16
    v_add_f32 v161, v161, v17
    v_mov_b32 v165, v9
    v_add_f32 v173, v173, v17
    v_add_f32 v162, v162, v18
    v_mov_b32 v166, v9
    v_add_f32 v174, v174, v18
    v_add_f32 v163, v163, v19
    v_mov_b32 v167, v9
    v_add_f32 v175, v175, v19
    s_nop 0
mega_kernel_e89:
    s_cmp_lg_u32 s60, s67
    s_cbranch_scc1 mega_kernel_e90
    v_mov_b32 v160, v9
    v_mov_b32 v168, v9
    v_mov_b32 v172, v9
    v_mov_b32 v161, v9
    v_mov_b32 v169, v9
    v_mov_b32 v173, v9
    v_mov_b32 v162, v9
    v_mov_b32 v170, v9
    v_mov_b32 v174, v9
    v_mov_b32 v163, v9
    v_mov_b32 v171, v9
    v_mov_b32 v175, v9
    s_nop 0
mega_kernel_e90:
    s_cmp_gt_u32 s60, 26
    s_cbranch_scc1 mega_kernel_e91
    s_cmp_lg_u32 s60, 6
    s_cbranch_scc1 mega_kernel_e93
    s_cmp_eq_u32 s17, -1
    s_cbranch_scc1 mega_kernel_e91
    s_cmp_lg_u32 s16, 0
    s_cbranch_scc1 mega_kernel_np94
    v_mov_b32 v4, s4
    v_mov_b32 v5, s5
    s_add_u32 s90, s17, 117440512
    s_mov_b64 exec, 1
    buffer_store_dwordx2 v[4:5], off, s[8:11], s90 sc1
    s_mov_b64 exec, -1
mega_kernel_np94:
    s_branch mega_kernel_e91
mega_kernel_e93:
    s_cmp_lg_u32 s60, 22
    s_cbranch_scc1 mega_kernel_e95
    buffer_load_dwordx2 v[4:5], v10, s[8:11], 0 offen sc1
    s_mov_b32 s44, s48
    s_mov_b32 s45, s49
    s_mov_b32 s46, 8388608
    s_lshl_b32 s90, s2, 2
    s_add_u32 s90, s90, s16
    s_lshl_b32 s90, s90, 13
    v_lshlrev_b32 v62, 7, v1
    buffer_load_dword v255, v62, s[44:47], s90 offen
    s_branch mega_kernel_e91
mega_kernel_e95:
    s_cmp_lg_u32 s60, 26
    s_cbranch_scc1 mega_kernel_e96
    s_mov_b32 s44, s50
    s_mov_b32 s45, s51
    s_mov_b32 s46, 2097152
    s_lshl_b32 s90, s2, 2
    s_add_u32 s90, s90, s16
    s_lshl_b32 s90, s90, 13
    v_lshlrev_b32 v62, 7, v1
    buffer_load_dword v255, v62, s[44:47], s90 offen
    s_waitcnt vmcnt(18)
    s_mov_b32 s3, 1048576
mega_kernel_spin97:
    v_cmp_ne_u64 s[72:73], s[4:5], v[4:5]
    s_nop 3
    s_cmp_eq_u64 s[72:73], 0
    s_cbranch_scc1 mega_kernel_e91
    s_sub_u32 s3, s3, 1
    s_cbranch_scc1 mega_kernel_e91
    s_sleep 32
    buffer_load_dwordx2 v[4:5], v10, s[8:11], 0 offen sc1
    s_waitcnt vmcnt(0)
    s_branch mega_kernel_spin97
    s_branch mega_kernel_e91
mega_kernel_e96:
mega_kernel_e91:
    s_cbranch_vccnz mega_kernel_rc98
mega_kernel_sp88:
    s_cmp_lg_u32 s60, s68
    s_cbranch_scc1 mega_kernel_single85
    ds_read_b128 a[224:227], v6 offset:16384
    ds_read_b128 a[228:231], v6 offset:17408
    ds_read_b128 a[232:235], v6 offset:18432
    ds_read_b128 a[236:239], v6 offset:19456
    ds_read_b128 a[240:243], v6 offset:20480
    ds_read_b128 a[244:247], v6 offset:21504
    ds_read_b128 a[248:251], v6 offset:22528
    ds_read_b128 a[252:255], v6 offset:23552
    s_waitcnt lgkmcnt(0)
    v_mfma_f32_16x16x32_bf16 a[0:3], a[224:227], v[128:131], a[0:3]
    buffer_load_dwordx4 v[192:195], v2, s[8:11], s79 offen offset:0 sc1
    v_exp_f32 v20, v96
    v_mfma_f32_16x16x32_bf16 a[32:35], a[224:227], v[132:135], a[32:35]
    v_exp_f32 v21, v97
    v_exp_f32 v22, v98
    v_mfma_f32_16x16x32_bf16 a[4:7], a[228:231], v[128:131], a[4:7]
    buffer_load_dwordx4 v[196:199], v2, s[8:11], s79 offen offset:1024 sc1
    v_cvt_pk_bf16_f32 v144, v20, v21
    v_add_f32 v12, v12, v28
    v_mfma_f32_16x16x32_bf16 a[36:39], a[228:231], v[132:135], a[36:39]
    v_exp_f32 v23, v99
    v_exp_f32 v24, v100
    v_cvt_pk_bf16_f32 v145, v22, v23
    v_mfma_f32_16x16x32_bf16 a[8:11], a[232:235], v[128:131], a[8:11]
    buffer_load_dwordx4 v[200:203], v2, s[8:11], s79 offen offset:2048 sc1
    v_exp_f32 v25, v101
    v_mfma_f32_16x16x32_bf16 a[40:43], a[232:235], v[132:135], a[40:43]
    v_exp_f32 v26, v102
    v_cvt_pk_bf16_f32 v146, v24, v25
    v_add_f32 v13, v13, v32
    v_mfma_f32_16x16x32_bf16 a[12:15], a[236:239], v[128:131], a[12:15]
    buffer_load_dwordx4 v[204:207], v2, s[8:11], s79 offen offset:3072 sc1
    v_exp_f32 v27, v103
    v_mfma_f32_16x16x32_bf16 a[44:47], a[236:239], v[132:135], a[44:47]
    v_exp_f32 v20, v104
    v_cvt_pk_bf16_f32 v147, v26, v27
    v_mfma_f32_16x16x32_bf16 a[16:19], a[240:243], v[128:131], a[16:19]
    buffer_load_dwordx4 v[212:215], v2, s[8:11], s80 offen offset:0 sc1
    v_exp_f32 v21, v105
    v_mfma_f32_16x16x32_bf16 v[28:31], v[44:47], v[144:147], 0
    v_exp_f32 v22, v106
    v_cvt_pk_bf16_f32 v148, v20, v21
    v_exp_f32 v23, v107
    v_mfma_f32_16x16x32_bf16 a[48:51], a[240:243], v[132:135], a[48:51]
    v_exp_f32 v24, v108
    v_cvt_pk_bf16_f32 v149, v22, v23
    v_exp_f32 v25, v109
    v_mfma_f32_16x16x32_bf16 a[20:23], a[244:247], v[128:131], a[20:23]
    buffer_load_dwordx4 v[216:219], v2, s[8:11], s80 offen offset:1024 sc1
    v_exp_f32 v26, v110
    v_mfma_f32_16x16x32_bf16 a[52:55], a[244:247], v[132:135], a[52:55]
    v_cvt_pk_bf16_f32 v150, v24, v25
    v_exp_f32 v27, v111
    s_nop 0
    v_cvt_pk_bf16_f32 v151, v26, v27
    s_nop 1
    v_mfma_f32_16x16x32_bf16 v[32:35], v[44:47], v[148:151], 0
    s_nop 2
    v_mfma_f32_16x16x32_bf16 a[24:27], a[248:251], v[128:131], a[24:27]
    buffer_load_dwordx4 v[220:223], v2, s[8:11], s80 offen offset:2048 sc1
    v_mfma_f32_16x16x32_bf16 a[56:59], a[248:251], v[132:135], a[56:59]
    s_nop 2
    v_mfma_f32_16x16x32_bf16 a[28:31], a[252:255], v[128:131], a[28:31]
    v_max_f32 v8, v28, v32
    v_cmp_nge_f32 vcc, s61, v8
    v_mfma_f32_16x16x32_bf16 a[60:63], a[252:255], v[132:135], a[60:63]
    s_cbranch_vccnz mega_kernel_stub99
mega_kernel_ret100:
    s_nop 1
    ds_read_b128 a[224:227], v6 offset:24576
    ds_read_b128 a[228:231], v6 offset:25600
    ds_read_b128 a[232:235], v6 offset:26624
    ds_read_b128 a[236:239], v6 offset:27648
    ds_read_b128 a[240:243], v6 offset:28672
    ds_read_b128 a[244:247], v6 offset:29696
    ds_read_b128 a[248:251], v6 offset:30720
    ds_read_b128 a[252:255], v6 offset:31744
    s_waitcnt lgkmcnt(0)
    v_mfma_f32_16x16x32_bf16 a[0:3], a[224:227], v[144:147], a[0:3]
    buffer_load_dwordx4 v[224:227], v2, s[8:11], s80 offen offset:3072 sc1
    v_mfma_f32_16x16x32_bf16 a[32:35], a[224:227], v[148:151], a[32:35]
    v_mfma_f32_16x16x32_bf16 a[4:7], a[228:231], v[144:147], a[4:7]
    buffer_load_dwordx4 v[208:211], v2, s[8:11], s81 offen offset:0 sc1
    v_mfma_f32_16x16x32_bf16 a[36:39], a[228:231], v[148:151], a[36:39]
    v_mfma_f32_16x16x32_bf16 a[8:11], a[232:235], v[144:147], a[8:11]
    buffer_load_dwordx4 v[232:235], v2, s[8:11], s82 offen offset:0 sc1
    v_mfma_f32_16x16x32_bf16 a[40:43], a[232:235], v[148:151], a[40:43]
    v_mfma_f32_16x16x32_bf16 a[12:15], a[236:239], v[144:147], a[12:15]
    buffer_load_dwordx4 v[236:239], v2, s[8:11], s82 offen offset:1024 sc1
    v_mfma_f32_16x16x32_bf16 a[44:47], a[236:239], v[148:151], a[44:47]
    v_mfma_f32_16x16x32_bf16 a[16:19], a[240:243], v[144:147], a[16:19]
    buffer_load_dwordx4 v[228:231], v2, s[8:11], s83 offen offset:0 sc1
    v_mfma_f32_16x16x32_bf16 a[48:51], a[240:243], v[148:151], a[48:51]
    v_mfma_f32_16x16x32_bf16 a[20:23], a[244:247], v[144:147], a[20:23]
    buffer_load_dwordx4 v[244:247], v2, s[8:11], s84 offen offset:0 sc1
    v_mfma_f32_16x16x32_bf16 a[52:55], a[244:247], v[148:151], a[52:55]
    v_mfma_f32_16x16x32_bf16 a[24:27], a[248:251], v[144:147], a[24:27]
    buffer_load_dwordx4 v[248:251], v2, s[8:11], s84 offen offset:1024 sc1
    v_mfma_f32_16x16x32_bf16 a[56:59], a[248:251], v[148:151], a[56:59]
    v_mfma_f32_16x16x32_bf16 a[28:31], a[252:255], v[144:147], a[28:31]
    buffer_load_dwordx4 v[240:243], v2, s[8:11], s85 offen offset:0 sc1
    v_mfma_f32_16x16x32_bf16 a[60:63], a[252:255], v[148:151], a[60:63]
    v_add_f32 v20, v12, v28
    v_add_f32 v21, v13, v32
    s_nop 3
    v_rcp_f32 v20, v20
    v_rcp_f32 v21, v21
    s_lshl_b32 s90, s74, 10
    s_add_u32 s90, s90, s78
    s_add_u32 s90, s90, 67108864
    v_accvgpr_read_b32 v48, a0
    v_accvgpr_read_b32 v49, a1
    v_accvgpr_read_b32 v50, a2
    v_accvgpr_read_b32 v51, a3
    v_accvgpr_read_b32 v52, a4
    v_accvgpr_read_b32 v53, a5
    v_accvgpr_read_b32 v54, a6
    v_accvgpr_read_b32 v55, a7
    v_mul_f32 v48, v20, v48
    v_mul_f32 v49, v20, v49
    v_mul_f32 v50, v20, v50
    v_mul_f32 v51, v20, v51
    v_mul_f32 v52, v20, v52
    v_mul_f32 v53, v20, v53
    v_mul_f32 v54, v20, v54
    v_mul_f32 v55, v20, v55
    v_cvt_pk_bf16_f32 v48, v48, v49
    v_cvt_pk_bf16_f32 v49, v50, v51
    v_cvt_pk_bf16_f32 v50, v52, v53
    v_cvt_pk_bf16_f32 v51, v54, v55
    buffer_store_dwordx4 v[48:51], v2, s[8:11], s90 offen offset:0 sc1
    v_accvgpr_read_b32 v56, a32
    v_accvgpr_read_b32 v57, a33
    v_accvgpr_read_b32 v58, a34
    v_accvgpr_read_b32 v59, a35
    v_accvgpr_read_b32 v60, a36
    v_accvgpr_read_b32 v61, a37
    v_accvgpr_read_b32 v62, a38
    v_accvgpr_read_b32 v63, a39
    v_mul_f32 v56, v21, v56
    v_mul_f32 v57, v21, v57
    v_mul_f32 v58, v21, v58
    v_mul_f32 v59, v21, v59
    v_mul_f32 v60, v21, v60
    v_mul_f32 v61, v21, v61
    v_mul_f32 v62, v21, v62
    v_mul_f32 v63, v21, v63
    v_cvt_pk_bf16_f32 v56, v56, v57
    v_cvt_pk_bf16_f32 v57, v58, v59
    v_cvt_pk_bf16_f32 v58, v60, v61
    v_cvt_pk_bf16_f32 v59, v62, v63
    buffer_store_dwordx4 v[56:59], v2, s[8:11], s90 offen offset:1024 sc1
    s_add_u32 s90, s90, 131072
    v_accvgpr_read_b32 v48, a8
    v_accvgpr_read_b32 v49, a9
    v_accvgpr_read_b32 v50, a10
    v_accvgpr_read_b32 v51, a11
    v_accvgpr_read_b32 v52, a12
    v_accvgpr_read_b32 v53, a13
    v_accvgpr_read_b32 v54, a14
    v_accvgpr_read_b32 v55, a15
    v_mul_f32 v48, v20, v48
    v_mul_f32 v49, v20, v49
    v_mul_f32 v50, v20, v50
    v_mul_f32 v51, v20, v51
    v_mul_f32 v52, v20, v52
    v_mul_f32 v53, v20, v53
    v_mul_f32 v54, v20, v54
    v_mul_f32 v55, v20, v55
    v_cvt_pk_bf16_f32 v48, v48, v49
    v_cvt_pk_bf16_f32 v49, v50, v51
    v_cvt_pk_bf16_f32 v50, v52, v53
    v_cvt_pk_bf16_f32 v51, v54, v55
    buffer_store_dwordx4 v[48:51], v2, s[8:11], s90 offen offset:0 sc1
    v_accvgpr_read_b32 v56, a40
    v_accvgpr_read_b32 v57, a41
    v_accvgpr_read_b32 v58, a42
    v_accvgpr_read_b32 v59, a43
    v_accvgpr_read_b32 v60, a44
    v_accvgpr_read_b32 v61, a45
    v_accvgpr_read_b32 v62, a46
    v_accvgpr_read_b32 v63, a47
    v_mul_f32 v56, v21, v56
    v_mul_f32 v57, v21, v57
    v_mul_f32 v58, v21, v58
    v_mul_f32 v59, v21, v59
    v_mul_f32 v60, v21, v60
    v_mul_f32 v61, v21, v61
    v_mul_f32 v62, v21, v62
    v_mul_f32 v63, v21, v63
    v_cvt_pk_bf16_f32 v56, v56, v57
    v_cvt_pk_bf16_f32 v57, v58, v59
    v_cvt_pk_bf16_f32 v58, v60, v61
    v_cvt_pk_bf16_f32 v59, v62, v63
    buffer_store_dwordx4 v[56:59], v2, s[8:11], s90 offen offset:1024 sc1
    s_add_u32 s90, s90, 131072
    v_accvgpr_read_b32 v48, a16
    v_accvgpr_read_b32 v49, a17
    v_accvgpr_read_b32 v50, a18
    v_accvgpr_read_b32 v51, a19
    v_accvgpr_read_b32 v52, a20
    v_accvgpr_read_b32 v53, a21
    v_accvgpr_read_b32 v54, a22
    v_accvgpr_read_b32 v55, a23
    v_mul_f32 v48, v20, v48
    v_mul_f32 v49, v20, v49
    v_mul_f32 v50, v20, v50
    v_mul_f32 v51, v20, v51
    v_mul_f32 v52, v20, v52
    v_mul_f32 v53, v20, v53
    v_mul_f32 v54, v20, v54
    v_mul_f32 v55, v20, v55
    v_cvt_pk_bf16_f32 v48, v48, v49
    v_cvt_pk_bf16_f32 v49, v50, v51
    v_cvt_pk_bf16_f32 v50, v52, v53
    v_cvt_pk_bf16_f32 v51, v54, v55
    buffer_store_dwordx4 v[48:51], v2, s[8:11], s90 offen offset:0 sc1
    v_accvgpr_read_b32 v56, a48
    v_accvgpr_read_b32 v57, a49
    v_accvgpr_read_b32 v58, a50
    v_accvgpr_read_b32 v59, a51
    v_accvgpr_read_b32 v60, a52
    v_accvgpr_read_b32 v61, a53
    v_accvgpr_read_b32 v62, a54
    v_accvgpr_read_b32 v63, a55
    v_mul_f32 v56, v21, v56
    v_mul_f32 v57, v21, v57
    v_mul_f32 v58, v21, v58
    v_mul_f32 v59, v21, v59
    v_mul_f32 v60, v21, v60
    v_mul_f32 v61, v21, v61
    v_mul_f32 v62, v21, v62
    v_mul_f32 v63, v21, v63
    v_cvt_pk_bf16_f32 v56, v56, v57
    v_cvt_pk_bf16_f32 v57, v58, v59
    v_cvt_pk_bf16_f32 v58, v60, v61
    v_cvt_pk_bf16_f32 v59, v62, v63
    buffer_store_dwordx4 v[56:59], v2, s[8:11], s90 offen offset:1024 sc1
    s_add_u32 s90, s90, 131072
    v_accvgpr_read_b32 v48, a24
    v_accvgpr_read_b32 v49, a25
    v_accvgpr_read_b32 v50, a26
    v_accvgpr_read_b32 v51, a27
    v_accvgpr_read_b32 v52, a28
    v_accvgpr_read_b32 v53, a29
    v_accvgpr_read_b32 v54, a30
    v_accvgpr_read_b32 v55, a31
    v_mul_f32 v48, v20, v48
    v_mul_f32 v49, v20, v49
    v_mul_f32 v50, v20, v50
    v_mul_f32 v51, v20, v51
    v_mul_f32 v52, v20, v52
    v_mul_f32 v53, v20, v53
    v_mul_f32 v54, v20, v54
    v_mul_f32 v55, v20, v55
    v_cvt_pk_bf16_f32 v48, v48, v49
    v_cvt_pk_bf16_f32 v49, v50, v51
    v_cvt_pk_bf16_f32 v50, v52, v53
    v_cvt_pk_bf16_f32 v51, v54, v55
    buffer_store_dwordx4 v[48:51], v2, s[8:11], s90 offen offset:0 sc1
    v_accvgpr_read_b32 v56, a56
    v_accvgpr_read_b32 v57, a57
    v_accvgpr_read_b32 v58, a58
    v_accvgpr_read_b32 v59, a59
    v_accvgpr_read_b32 v60, a60
    v_accvgpr_read_b32 v61, a61
    v_accvgpr_read_b32 v62, a62
    v_accvgpr_read_b32 v63, a63
    v_mul_f32 v56, v21, v56
    v_mul_f32 v57, v21, v57
    v_mul_f32 v58, v21, v58
    v_mul_f32 v59, v21, v59
    v_mul_f32 v60, v21, v60
    v_mul_f32 v61, v21, v61
    v_mul_f32 v62, v21, v62
    v_mul_f32 v63, v21, v63
    v_cvt_pk_bf16_f32 v56, v56, v57
    v_cvt_pk_bf16_f32 v57, v58, v59
    v_cvt_pk_bf16_f32 v58, v60, v61
    v_cvt_pk_bf16_f32 v59, v62, v63
    buffer_store_dwordx4 v[56:59], v2, s[8:11], s90 offen offset:1024 sc1
    s_add_u32 s90, s90, 131072
    v_and_b32 v48, 15, v1
    v_lshrrev_b32 v49, 4, v1
    v_lshlrev_b32 v49, 2, v49
    v_sub_u32 v48, v48, v49
    v_cmp_ge_i32 vcc, -9, v48
    v_subrev_u32 v50, 0, v48
    v_cmp_ge_u32 s[72:73], 7, v50
    s_nop 0
    v_cndmask_b32 v64, v9, 0, vcc
    v_cndmask_b32 v68, v9, 0, s[72:73]
    v_cmp_ge_i32 vcc, -8, v48
    v_subrev_u32 v50, 1, v48
    v_cmp_ge_u32 s[72:73], 7, v50
    s_nop 0
    v_cndmask_b32 v65, v9, 0, vcc
    v_cndmask_b32 v69, v9, 0, s[72:73]
    v_cmp_ge_i32 vcc, -7, v48
    v_subrev_u32 v50, 2, v48
    v_cmp_ge_u32 s[72:73], 7, v50
    s_nop 0
    v_cndmask_b32 v66, v9, 0, vcc
    v_cndmask_b32 v70, v9, 0, s[72:73]
    v_cmp_ge_i32 vcc, -6, v48
    v_subrev_u32 v50, 3, v48
    v_cmp_ge_u32 s[72:73], 7, v50
    s_nop 0
    v_cndmask_b32 v67, v9, 0, vcc
    v_cndmask_b32 v71, v9, 0, s[72:73]
    s_cmp_eq_u32 s77, 0
    s_cselect_b64 vcc, -1, 0
    s_nop 0
    v_cndmask_b32 v72, v64, v9, vcc
    v_cndmask_b32 v73, v65, v9, vcc
    v_cndmask_b32 v74, v66, v9, vcc
    v_cndmask_b32 v75, v67, v9, vcc
    s_waitcnt vmcnt(8)
    s_nop 0
    v_mfma_f32_16x16x32_bf16 v[80:83], v[208:211], v[192:195], v[72:75]
    v_mfma_f32_16x16x32_bf16 v[84:87], v[212:215], v[192:195], v[68:71]
    v_mfma_f32_16x16x32_bf16 v[88:91], v[212:215], v[196:199], v[64:67]
    v_mfma_f32_16x16x32_bf16 v[92:95], v[216:219], v[196:199], v[68:71]
    v_mfma_f32_16x16x32_bf16 v[96:99], v[216:219], v[200:203], v[64:67]
    v_mfma_f32_16x16x32_bf16 v[100:103], v[220:223], v[200:203], v[68:71]
    v_mfma_f32_16x16x32_bf16 v[104:107], v[220:223], v[204:207], v[64:67]
    v_mfma_f32_16x16x32_bf16 v[108:111], v[224:227], v[204:207], v[68:71]
    s_nop 7
    v_max3_f32 v112, v80, v81, v82
    v_max3_f32 v113, v88, v89, v90
    v_max3_f32 v114, v96, v97, v98
    v_max3_f32 v115, v104, v105, v106
    v_max3_f32 v112, v112, v83, v84
    v_max3_f32 v113, v113, v91, v92
    v_max3_f32 v114, v114, v99, v100
    v_max3_f32 v115, v115, v107, v108
    v_max3_f32 v112, v112, v85, v86
    v_max3_f32 v113, v113, v93, v94
    v_max3_f32 v114, v114, v101, v102
    v_max3_f32 v115, v115, v109, v110
    v_max_f32 v112, v112, v87
    v_max_f32 v113, v113, v95
    v_max_f32 v114, v114, v103
    v_max_f32 v115, v115, v111
    v_mov_b32 v116, v112
    v_mov_b32 v117, v113
    v_mov_b32 v118, v114
    v_mov_b32 v119, v115
    s_nop 1
    v_permlane32_swap_b32 v112, v116
    v_permlane32_swap_b32 v113, v117
    v_permlane32_swap_b32 v114, v118
    v_permlane32_swap_b32 v115, v119
    s_nop 1
    v_max_f32 v112, v112, v116
    v_max_f32 v113, v113, v117
    v_max_f32 v114, v114, v118
    v_max_f32 v115, v115, v119
    v_mov_b32 v116, v112
    v_mov_b32 v117, v113
    v_mov_b32 v118, v114
    v_mov_b32 v119, v115
    s_nop 1
    v_permlane16_swap_b32 v112, v116
    v_permlane16_swap_b32 v113, v117
    v_permlane16_swap_b32 v114, v118
    v_permlane16_swap_b32 v115, v119
    s_nop 1
    v_max_f32 v112, v112, v116
    v_max_f32 v113, v113, v117
    v_max_f32 v114, v114, v118
    v_max_f32 v115, v115, v119
    v_sub_f32 v80, v80, v112
    v_sub_f32 v81, v81, v112
    v_sub_f32 v82, v82, v112
    v_sub_f32 v83, v83, v112
    v_sub_f32 v84, v84, v112
    v_sub_f32 v85, v85, v112
    v_sub_f32 v86, v86, v112
    v_sub_f32 v87, v87, v112
    v_sub_f32 v88, v88, v113
    v_sub_f32 v89, v89, v113
    v_sub_f32 v90, v90, v113
    v_sub_f32 v91, v91, v113
    v_sub_f32 v92, v92, v113
    v_sub_f32 v93, v93, v113
    v_sub_f32 v94, v94, v113
    v_sub_f32 v95, v95, v113
    v_sub_f32 v96, v96, v114
    v_sub_f32 v97, v97, v114
    v_sub_f32 v98, v98, v114
    v_sub_f32 v99, v99, v114
    v_sub_f32 v100, v100, v114
    v_sub_f32 v101, v101, v114
    v_sub_f32 v102, v102, v114
    v_sub_f32 v103, v103, v114
    v_sub_f32 v104, v104, v115
    v_sub_f32 v105, v105, v115
    v_sub_f32 v106, v106, v115
    v_sub_f32 v107, v107, v115
    v_sub_f32 v108, v108, v115
    v_sub_f32 v109, v109, v115
    v_sub_f32 v110, v110, v115
    v_sub_f32 v111, v111, v115
    v_exp_f32 v80, v80
    v_exp_f32 v81, v81
    v_exp_f32 v82, v82
    v_exp_f32 v83, v83
    v_exp_f32 v84, v84
    v_exp_f32 v85, v85
    v_exp_f32 v86, v86
    v_exp_f32 v87, v87
    v_exp_f32 v88, v88
    v_exp_f32 v89, v89
    v_exp_f32 v90, v90
    v_exp_f32 v91, v91
    v_exp_f32 v92, v92
    v_exp_f32 v93, v93
    v_exp_f32 v94, v94
    v_exp_f32 v95, v95
    v_exp_f32 v96, v96
    v_exp_f32 v97, v97
    v_exp_f32 v98, v98
    v_exp_f32 v99, v99
    v_exp_f32 v100, v100
    v_exp_f32 v101, v101
    v_exp_f32 v102, v102
    v_exp_f32 v103, v103
    v_exp_f32 v104, v104
    v_exp_f32 v105, v105
    v_exp_f32 v106, v106
    v_exp_f32 v107, v107
    v_exp_f32 v108, v108
    v_exp_f32 v109, v109
    v_exp_f32 v110, v110
    v_exp_f32 v111, v111
    v_cvt_pk_bf16_f32 v192, v80, v81
    v_cvt_pk_bf16_f32 v193, v82, v83
    v_cvt_pk_bf16_f32 v194, v84, v85
    v_cvt_pk_bf16_f32 v195, v86, v87
    v_cvt_pk_bf16_f32 v196, v88, v89
    v_cvt_pk_bf16_f32 v197, v90, v91
    v_cvt_pk_bf16_f32 v198, v92, v93
    v_cvt_pk_bf16_f32 v199, v94, v95
    v_cvt_pk_bf16_f32 v200, v96, v97
    v_cvt_pk_bf16_f32 v201, v98, v99
    v_cvt_pk_bf16_f32 v202, v100, v101
    v_cvt_pk_bf16_f32 v203, v102, v103
    v_cvt_pk_bf16_f32 v204, v104, v105
    v_cvt_pk_bf16_f32 v205, v106, v107
    v_cvt_pk_bf16_f32 v206, v108, v109
    v_cvt_pk_bf16_f32 v207, v110, v111
    v_add_f32 v112, v80, v81
    v_add_f32 v113, v88, v89
    v_add_f32 v114, v96, v97
    v_add_f32 v115, v104, v105
    v_mfma_f32_16x16x32_bf16 v[128:131], v[230:233], v[192:195], 0
    v_mfma_f32_16x16x32_bf16 v[132:135], v[242:245], v[192:195], 0
    v_mfma_f32_16x16x32_bf16 v[136:139], v[232:235], v[196:199], 0
    v_mfma_f32_16x16x32_bf16 v[140:143], v[244:247], v[196:199], 0
    v_mfma_f32_16x16x32_bf16 v[144:147], v[234:237], v[200:203], 0
    v_mfma_f32_16x16x32_bf16 v[148:151], v[246:249], v[200:203], 0
    v_mfma_f32_16x16x32_bf16 v[152:155], v[236:239], v[204:207], 0
    v_mfma_f32_16x16x32_bf16 v[156:159], v[248:251], v[204:207], 0
    v_add_f32 v112, v112, v82
    v_add_f32 v113, v113, v90
    v_add_f32 v114, v114, v98
    v_add_f32 v115, v115, v106
    v_add_f32 v112, v112, v83
    v_add_f32 v113, v113, v91
    v_add_f32 v114, v114, v99
    v_add_f32 v115, v115, v107
    v_add_f32 v112, v112, v84
    v_add_f32 v113, v113, v92
    v_add_f32 v114, v114, v100
    v_add_f32 v115, v115, v108
    v_add_f32 v112, v112, v85
    v_add_f32 v113, v113, v93
    v_add_f32 v114, v114, v101
    v_add_f32 v115, v115, v109
    v_add_f32 v112, v112, v86
    v_add_f32 v113, v113, v94
    v_add_f32 v114, v114, v102
    v_add_f32 v115, v115, v110
    v_add_f32 v112, v112, v87
    v_add_f32 v113, v113, v95
    v_add_f32 v114, v114, v103
    v_add_f32 v115, v115, v111
    v_mov_b32 v116, v112
    v_mov_b32 v117, v113
    v_mov_b32 v118, v114
    v_mov_b32 v119, v115
    s_nop 1
    v_permlane32_swap_b32 v112, v116
    v_permlane32_swap_b32 v113, v117
    v_permlane32_swap_b32 v114, v118
    v_permlane32_swap_b32 v115, v119
    s_nop 1
    v_add_f32 v112, v112, v116
    v_add_f32 v113, v113, v117
    v_add_f32 v114, v114, v118
    v_add_f32 v115, v115, v119
    v_mov_b32 v116, v112
    v_mov_b32 v117, v113
    v_mov_b32 v118, v114
    v_mov_b32 v119, v115
    s_nop 1
    v_permlane16_swap_b32 v112, v116
    v_permlane16_swap_b32 v113, v117
    v_permlane16_swap_b32 v114, v118
    v_permlane16_swap_b32 v115, v119
    s_nop 1
    v_add_f32 v112, v112, v116
    v_add_f32 v113, v113, v117
    v_add_f32 v114, v114, v118
    v_add_f32 v115, v115, v119
    v_rcp_f32 v112, v112
    v_rcp_f32 v113, v113
    v_rcp_f32 v114, v114
    v_rcp_f32 v115, v115
    s_lshl_b32 s90, s76, 10
    s_lshr_b32 s91, s2, 3
    s_lshl_b32 s91, s91, 17
    s_add_u32 s90, s90, s91
    s_add_u32 s90, s90, 83886080
    v_mul_f32 v128, v128, v112
    v_mul_f32 v129, v129, v112
    v_mul_f32 v130, v130, v112
    v_mul_f32 v131, v131, v112
    v_mul_f32 v132, v132, v112
    v_mul_f32 v133, v133, v112
    v_mul_f32 v134, v134, v112
    v_mul_f32 v135, v135, v112
    v_cvt_pk_bf16_f32 v128, v128, v129
    v_cvt_pk_bf16_f32 v129, v130, v131
    v_cvt_pk_bf16_f32 v130, v132, v133
    v_cvt_pk_bf16_f32 v131, v134, v135
    buffer_store_dwordx4 v[128:131], v2, s[8:11], s90 offen offset:0 sc1
    v_mul_f32 v136, v136, v113
    v_mul_f32 v137, v137, v113
    v_mul_f32 v138, v138, v113
    v_mul_f32 v139, v139, v113
    v_mul_f32 v140, v140, v113
    v_mul_f32 v141, v141, v113
    v_mul_f32 v142, v142, v113
    v_mul_f32 v143, v143, v113
    v_cvt_pk_bf16_f32 v136, v136, v137
    v_cvt_pk_bf16_f32 v137, v138, v139
    v_cvt_pk_bf16_f32 v138, v140, v141
    v_cvt_pk_bf16_f32 v139, v142, v143
    buffer_store_dwordx4 v[136:139], v2, s[8:11], s90 offen offset:1024 sc1
    v_mul_f32 v144, v144, v114
    v_mul_f32 v145, v145, v114
    v_mul_f32 v146, v146, v114
    v_mul_f32 v147, v147, v114
    v_mul_f32 v148, v148, v114
    v_mul_f32 v149, v149, v114
    v_mul_f32 v150, v150, v114
    v_mul_f32 v151, v151, v114
    v_cvt_pk_bf16_f32 v144, v144, v145
    v_cvt_pk_bf16_f32 v145, v146, v147
    v_cvt_pk_bf16_f32 v146, v148, v149
    v_cvt_pk_bf16_f32 v147, v150, v151
    buffer_store_dwordx4 v[144:147], v2, s[8:11], s90 offen offset:2048 sc1
    v_mul_f32 v152, v152, v115
    v_mul_f32 v153, v153, v115
    v_mul_f32 v154, v154, v115
    v_mul_f32 v155, v155, v115
    v_mul_f32 v156, v156, v115
    v_mul_f32 v157, v157, v115
    v_mul_f32 v158, v158, v115
    v_mul_f32 v159, v159, v115
    v_cvt_pk_bf16_f32 v152, v152, v153
    v_cvt_pk_bf16_f32 v153, v154, v155
    v_cvt_pk_bf16_f32 v154, v156, v157
    v_cvt_pk_bf16_f32 v155, v158, v159
    buffer_store_dwordx4 v[152:155], v2, s[8:11], s90 offen offset:3072 sc1
mega_kernel_end1:
    s_endpgm
mega_kernel_stub64:
    v_cmp_lt_f32 vcc, s61, v8
    s_cmp_lg_u32 s60, s63
    s_cbranch_scc1 mega_kernel_e102
    v_add_f32 v176, v176, v16
    v_mov_b32 v180, v9
    v_add_f32 v188, v188, v16
    v_add_f32 v177, v177, v17
    v_mov_b32 v181, v9
    v_add_f32 v189, v189, v17
    v_add_f32 v178, v178, v18
    v_mov_b32 v182, v9
    v_add_f32 v190, v190, v18
    v_add_f32 v179, v179, v19
    v_mov_b32 v183, v9
    v_add_f32 v191, v191, v19
    s_nop 0
mega_kernel_e102:
    s_cmp_lg_u32 s60, s64
    s_cbranch_scc1 mega_kernel_e103
    v_mov_b32 v176, v9
    v_mov_b32 v184, v9
    v_mov_b32 v188, v9
    v_mov_b32 v177, v9
    v_mov_b32 v185, v9
    v_mov_b32 v189, v9
    v_mov_b32 v178, v9
    v_mov_b32 v186, v9
    v_mov_b32 v190, v9
    v_mov_b32 v179, v9
    v_mov_b32 v187, v9
    v_mov_b32 v191, v9
    s_nop 0
mega_kernel_e103:
    s_cbranch_vccnz mega_kernel_rc104
mega_kernel_sp101:
    s_branch mega_kernel_ret65
mega_kernel_stub67:
    v_cmp_lt_f32 vcc, s61, v8
    s_cmp_lg_u32 s60, s63
    s_cbranch_scc1 mega_kernel_e106
    v_add_f32 v176, v176, v16
    v_mov_b32 v180, v9
    v_add_f32 v188, v188, v16
    v_add_f32 v177, v177, v17
    v_mov_b32 v181, v9
    v_add_f32 v189, v189, v17
    v_add_f32 v178, v178, v18
    v_mov_b32 v182, v9
    v_add_f32 v190, v190, v18
    v_add_f32 v179, v179, v19
    v_mov_b32 v183, v9
    v_add_f32 v191, v191, v19
    s_nop 0
mega_kernel_e106:
    s_cmp_lg_u32 s60, s64
    s_cbranch_scc1 mega_kernel_e107
    v_mov_b32 v176, v9
    v_mov_b32 v184, v9
    v_mov_b32 v188, v9
    v_mov_b32 v177, v9
    v_mov_b32 v185, v9
    v_mov_b32 v189, v9
    v_mov_b32 v178, v9
    v_mov_b32 v186, v9
    v_mov_b32 v190, v9
    v_mov_b32 v179, v9
    v_mov_b32 v187, v9
    v_mov_b32 v191, v9
    s_nop 0
mega_kernel_e107:
    s_cbranch_vccnz mega_kernel_rc108
mega_kernel_sp105:
    s_branch mega_kernel_ret68
mega_kernel_stub81:
    v_cmp_lt_f32 vcc, s61, v8
    s_cmp_lg_u32 s60, s66
    s_cbranch_scc1 mega_kernel_e110
    v_add_f32 v160, v160, v16
    v_mov_b32 v164, v9
    v_add_f32 v172, v172, v16
    v_add_f32 v161, v161, v17
    v_mov_b32 v165, v9
    v_add_f32 v173, v173, v17
    v_add_f32 v162, v162, v18
    v_mov_b32 v166, v9
    v_add_f32 v174, v174, v18
    v_add_f32 v163, v163, v19
    v_mov_b32 v167, v9
    v_add_f32 v175, v175, v19
    s_nop 0
mega_kernel_e110:
    s_cmp_lg_u32 s60, s67
    s_cbranch_scc1 mega_kernel_e111
    v_mov_b32 v160, v9
    v_mov_b32 v168, v9
    v_mov_b32 v172, v9
    v_mov_b32 v161, v9
    v_mov_b32 v169, v9
    v_mov_b32 v173, v9
    v_mov_b32 v162, v9
    v_mov_b32 v170, v9
    v_mov_b32 v174, v9
    v_mov_b32 v163, v9
    v_mov_b32 v171, v9
    v_mov_b32 v175, v9
    s_nop 0
mega_kernel_e111:
    s_cbranch_vccnz mega_kernel_rc112
mega_kernel_sp109:
    s_branch mega_kernel_ret82
mega_kernel_stub83:
    v_cmp_lt_f32 vcc, s61, v8
    s_cmp_lg_u32 s60, s66
    s_cbranch_scc1 mega_kernel_e114
    v_add_f32 v160, v160, v16
    v_mov_b32 v164, v9
    v_add_f32 v172, v172, v16
    v_add_f32 v161, v161, v17
    v_mov_b32 v165, v9
    v_add_f32 v173, v173, v17
    v_add_f32 v162, v162, v18
    v_mov_b32 v166, v9
    v_add_f32 v174, v174, v18
    v_add_f32 v163, v163, v19
    v_mov_b32 v167, v9
    v_add_f32 v175, v175, v19
    s_nop 0
mega_kernel_e114:
    s_cmp_lg_u32 s60, s67
    s_cbranch_scc1 mega_kernel_e115
    v_mov_b32 v160, v9
    v_mov_b32 v168, v9
    v_mov_b32 v172, v9
    v_mov_b32 v161, v9
    v_mov_b32 v169, v9
    v_mov_b32 v173, v9
    v_mov_b32 v162, v9
    v_mov_b32 v170, v9
    v_mov_b32 v174, v9
    v_mov_b32 v163, v9
    v_mov_b32 v171, v9
    v_mov_b32 v175, v9
    s_nop 0
mega_kernel_e115:
    s_cmp_gt_u32 s60, 26
    s_cbranch_scc1 mega_kernel_e116
    s_cmp_lg_u32 s60, 6
    s_cbranch_scc1 mega_kernel_e118
    s_cmp_eq_u32 s17, -1
    s_cbranch_scc1 mega_kernel_e116
    s_cmp_lg_u32 s16, 0
    s_cbranch_scc1 mega_kernel_np119
    v_mov_b32 v4, s4
    v_mov_b32 v5, s5
    s_add_u32 s90, s17, 117440512
    s_mov_b64 exec, 1
    buffer_store_dwordx2 v[4:5], off, s[8:11], s90 sc1
    s_mov_b64 exec, -1
mega_kernel_np119:
    s_branch mega_kernel_e116
mega_kernel_e118:
    s_cmp_lg_u32 s60, 22
    s_cbranch_scc1 mega_kernel_e120
    buffer_load_dwordx2 v[4:5], v10, s[8:11], 0 offen sc1
    s_mov_b32 s44, s48
    s_mov_b32 s45, s49
    s_mov_b32 s46, 8388608
    s_lshl_b32 s90, s2, 2
    s_add_u32 s90, s90, s16
    s_lshl_b32 s90, s90, 13
    v_lshlrev_b32 v62, 7, v1
    buffer_load_dword v255, v62, s[44:47], s90 offen
    s_branch mega_kernel_e116
mega_kernel_e120:
    s_cmp_lg_u32 s60, 26
    s_cbranch_scc1 mega_kernel_e121
    s_mov_b32 s44, s50
    s_mov_b32 s45, s51
    s_mov_b32 s46, 2097152
    s_lshl_b32 s90, s2, 2
    s_add_u32 s90, s90, s16
    s_lshl_b32 s90, s90, 13
    v_lshlrev_b32 v62, 7, v1
    buffer_load_dword v255, v62, s[44:47], s90 offen
    s_waitcnt vmcnt(18)
    s_mov_b32 s3, 1048576
mega_kernel_spin122:
    v_cmp_ne_u64 s[72:73], s[4:5], v[4:5]
    s_nop 3
    s_cmp_eq_u64 s[72:73], 0
    s_cbranch_scc1 mega_kernel_e116
    s_sub_u32 s3, s3, 1
    s_cbranch_scc1 mega_kernel_e116
    s_sleep 32
    buffer_load_dwordx2 v[4:5], v10, s[8:11], 0 offen sc1
    s_waitcnt vmcnt(0)
    s_branch mega_kernel_spin122
    s_branch mega_kernel_e116
mega_kernel_e121:
mega_kernel_e116:
    s_cbranch_vccnz mega_kernel_rc123
mega_kernel_sp113:
    s_branch mega_kernel_ret84
mega_kernel_stub86:
    v_cmp_lt_f32 vcc, s61, v8
    s_cmp_lg_u32 s60, s66
    s_cbranch_scc1 mega_kernel_e125
    v_add_f32 v160, v160, v16
    v_mov_b32 v164, v9
    v_add_f32 v172, v172, v16
    v_add_f32 v161, v161, v17
    v_mov_b32 v165, v9
    v_add_f32 v173, v173, v17
    v_add_f32 v162, v162, v18
    v_mov_b32 v166, v9
    v_add_f32 v174, v174, v18
    v_add_f32 v163, v163, v19
    v_mov_b32 v167, v9
    v_add_f32 v175, v175, v19
    s_nop 0
mega_kernel_e125:
    s_cmp_lg_u32 s60, s67
    s_cbranch_scc1 mega_kernel_e126
    v_mov_b32 v160, v9
    v_mov_b32 v168, v9
    v_mov_b32 v172, v9
    v_mov_b32 v161, v9
    v_mov_b32 v169, v9
    v_mov_b32 v173, v9
    v_mov_b32 v162, v9
    v_mov_b32 v170, v9
    v_mov_b32 v174, v9
    v_mov_b32 v163, v9
    v_mov_b32 v171, v9
    v_mov_b32 v175, v9
    s_nop 0
mega_kernel_e126:
    s_cbranch_vccnz mega_kernel_rc127
mega_kernel_sp124:
    s_branch mega_kernel_ret87
mega_kernel_stub99:
    v_cmp_lt_f32 vcc, s61, v8
    s_cbranch_vccnz mega_kernel_rc129
mega_kernel_sp128:
    s_branch mega_kernel_ret100
mega_kernel_rc80:
    s_call_b64 s[70:71], mega_kernel_rs0458
    s_branch mega_kernel_sp69
mega_kernel_rc98:
    s_call_b64 s[70:71], mega_kernel_rs0257
    s_branch mega_kernel_sp88
mega_kernel_rc104:
    s_call_b64 s[70:71], mega_kernel_rs0458
    s_branch mega_kernel_sp101
mega_kernel_rc108:
    s_call_b64 s[70:71], mega_kernel_rs1460
    s_branch mega_kernel_sp105
mega_kernel_rc112:
    s_call_b64 s[70:71], mega_kernel_rs1460
    s_branch mega_kernel_sp109
mega_kernel_rc123:
    s_call_b64 s[70:71], mega_kernel_rs0257
    s_branch mega_kernel_sp113
mega_kernel_rc127:
    s_call_b64 s[70:71], mega_kernel_rs1259
    s_branch mega_kernel_sp124
mega_kernel_rc129:
    s_call_b64 s[70:71], mega_kernel_rs1259
    s_branch mega_kernel_sp128
mega_kernel_rs0257:
    s_nop 15
    v_max3_f32 v48, v64, v65, v66
    v_max3_f32 v48, v48, v67, v68
    v_max3_f32 v48, v48, v69, v70
    v_max3_f32 v48, v48, v71, 0
    v_mov_b32 v49, v48
    s_nop 1
    v_permlane32_swap_b32 v48, v49
    s_nop 1
    v_max_f32 v48, v48, v49
    v_mov_b32 v49, v48
    s_nop 1
    v_permlane16_swap_b32 v48, v49
    s_nop 1
    v_max_f32 v48, v48, v49
    v_exp_f32 v49, -v48
    v_sub_f32 v64, v64, v48
    v_sub_f32 v65, v65, v48
    v_sub_f32 v66, v66, v48
    v_sub_f32 v67, v67, v48
    v_sub_f32 v68, v68, v48
    v_sub_f32 v69, v69, v48
    v_sub_f32 v70, v70, v48
    v_sub_f32 v71, v71, v48
    v_sub_f32 v96, v96, v48
    v_sub_f32 v97, v97, v48
    v_sub_f32 v98, v98, v48
    v_sub_f32 v99, v99, v48
    v_sub_f32 v100, v100, v48
    v_sub_f32 v101, v101, v48
    v_sub_f32 v102, v102, v48
    v_sub_f32 v103, v103, v48
    v_sub_f32 v160, v160, v48
    v_sub_f32 v161, v161, v48
    v_sub_f32 v162, v162, v48
    v_sub_f32 v163, v163, v48
    v_sub_f32 v164, v164, v48
    v_sub_f32 v165, v165, v48
    v_sub_f32 v166, v166, v48
    v_sub_f32 v167, v167, v48
    v_mul_f32 v12, v12, v49
    v_accvgpr_read_b32 v52, a0
    v_accvgpr_read_b32 v53, a1
    v_accvgpr_read_b32 v54, a2
    v_accvgpr_read_b32 v55, a3
    v_accvgpr_read_b32 v56, a4
    v_accvgpr_read_b32 v57, a5
    v_accvgpr_read_b32 v58, a6
    v_accvgpr_read_b32 v59, a7
    v_mul_f32 v52, v52, v49
    v_mul_f32 v53, v53, v49
    v_mul_f32 v54, v54, v49
    v_mul_f32 v55, v55, v49
    v_mul_f32 v56, v56, v49
    v_mul_f32 v57, v57, v49
    v_mul_f32 v58, v58, v49
    v_mul_f32 v59, v59, v49
    v_accvgpr_write_b32 a0, v52
    v_accvgpr_write_b32 a1, v53
    v_accvgpr_write_b32 a2, v54
    v_accvgpr_write_b32 a3, v55
    v_accvgpr_write_b32 a4, v56
    v_accvgpr_write_b32 a5, v57
    v_accvgpr_write_b32 a6, v58
    v_accvgpr_write_b32 a7, v59
    v_accvgpr_read_b32 v52, a8
    v_accvgpr_read_b32 v53, a9
    v_accvgpr_read_b32 v54, a10
    v_accvgpr_read_b32 v55, a11
    v_accvgpr_read_b32 v56, a12
    v_accvgpr_read_b32 v57, a13
    v_accvgpr_read_b32 v58, a14
    v_accvgpr_read_b32 v59, a15
    v_mul_f32 v52, v52, v49
    v_mul_f32 v53, v53, v49
    v_mul_f32 v54, v54, v49
    v_mul_f32 v55, v55, v49
    v_mul_f32 v56, v56, v49
    v_mul_f32 v57, v57, v49
    v_mul_f32 v58, v58, v49
    v_mul_f32 v59, v59, v49
    v_accvgpr_write_b32 a8, v52
    v_accvgpr_write_b32 a9, v53
    v_accvgpr_write_b32 a10, v54
    v_accvgpr_write_b32 a11, v55
    v_accvgpr_write_b32 a12, v56
    v_accvgpr_write_b32 a13, v57
    v_accvgpr_write_b32 a14, v58
    v_accvgpr_write_b32 a15, v59
    v_accvgpr_read_b32 v52, a16
    v_accvgpr_read_b32 v53, a17
    v_accvgpr_read_b32 v54, a18
    v_accvgpr_read_b32 v55, a19
    v_accvgpr_read_b32 v56, a20
    v_accvgpr_read_b32 v57, a21
    v_accvgpr_read_b32 v58, a22
    v_accvgpr_read_b32 v59, a23
    v_mul_f32 v52, v52, v49
    v_mul_f32 v53, v53, v49
    v_mul_f32 v54, v54, v49
    v_mul_f32 v55, v55, v49
    v_mul_f32 v56, v56, v49
    v_mul_f32 v57, v57, v49
    v_mul_f32 v58, v58, v49
    v_mul_f32 v59, v59, v49
    v_accvgpr_write_b32 a16, v52
    v_accvgpr_write_b32 a17, v53
    v_accvgpr_write_b32 a18, v54
    v_accvgpr_write_b32 a19, v55
    v_accvgpr_write_b32 a20, v56
    v_accvgpr_write_b32 a21, v57
    v_accvgpr_write_b32 a22, v58
    v_accvgpr_write_b32 a23, v59
    v_accvgpr_read_b32 v52, a24
    v_accvgpr_read_b32 v53, a25
    v_accvgpr_read_b32 v54, a26
    v_accvgpr_read_b32 v55, a27
    v_accvgpr_read_b32 v56, a28
    v_accvgpr_read_b32 v57, a29
    v_accvgpr_read_b32 v58, a30
    v_accvgpr_read_b32 v59, a31
    v_mul_f32 v52, v52, v49
    v_mul_f32 v53, v53, v49
    v_mul_f32 v54, v54, v49
    v_mul_f32 v55, v55, v49
    v_mul_f32 v56, v56, v49
    v_mul_f32 v57, v57, v49
    v_mul_f32 v58, v58, v49
    v_mul_f32 v59, v59, v49
    v_accvgpr_write_b32 a24, v52
    v_accvgpr_write_b32 a25, v53
    v_accvgpr_write_b32 a26, v54
    v_accvgpr_write_b32 a27, v55
    v_accvgpr_write_b32 a28, v56
    v_accvgpr_write_b32 a29, v57
    v_accvgpr_write_b32 a30, v58
    v_accvgpr_write_b32 a31, v59
    v_exp_f32 v52, v64
    v_exp_f32 v53, v65
    v_exp_f32 v54, v66
    v_exp_f32 v55, v67
    v_exp_f32 v56, v68
    v_exp_f32 v57, v69
    v_exp_f32 v58, v70
    v_exp_f32 v59, v71
    s_nop 0
    v_cvt_pk_bf16_f32 v128, v52, v53
    v_cvt_pk_bf16_f32 v129, v54, v55
    v_cvt_pk_bf16_f32 v130, v56, v57
    v_cvt_pk_bf16_f32 v131, v58, v59
    s_nop 1
    v_mfma_f32_16x16x32_bf16 v[28:31], v[44:47], v[128:131], 0
    v_max3_f32 v48, v72, v73, v74
    v_max3_f32 v48, v48, v75, v76
    v_max3_f32 v48, v48, v77, v78
    v_max3_f32 v48, v48, v79, 0
    v_mov_b32 v49, v48
    s_nop 1
    v_permlane32_swap_b32 v48, v49
    s_nop 1
    v_max_f32 v48, v48, v49
    v_mov_b32 v49, v48
    s_nop 1
    v_permlane16_swap_b32 v48, v49
    s_nop 1
    v_max_f32 v48, v48, v49
    v_exp_f32 v49, -v48
    v_sub_f32 v72, v72, v48
    v_sub_f32 v73, v73, v48
    v_sub_f32 v74, v74, v48
    v_sub_f32 v75, v75, v48
    v_sub_f32 v76, v76, v48
    v_sub_f32 v77, v77, v48
    v_sub_f32 v78, v78, v48
    v_sub_f32 v79, v79, v48
    v_sub_f32 v104, v104, v48
    v_sub_f32 v105, v105, v48
    v_sub_f32 v106, v106, v48
    v_sub_f32 v107, v107, v48
    v_sub_f32 v108, v108, v48
    v_sub_f32 v109, v109, v48
    v_sub_f32 v110, v110, v48
    v_sub_f32 v111, v111, v48
    v_sub_f32 v168, v168, v48
    v_sub_f32 v169, v169, v48
    v_sub_f32 v170, v170, v48
    v_sub_f32 v171, v171, v48
    v_sub_f32 v172, v172, v48
    v_sub_f32 v173, v173, v48
    v_sub_f32 v174, v174, v48
    v_sub_f32 v175, v175, v48
    v_mul_f32 v13, v13, v49
    v_accvgpr_read_b32 v52, a32
    v_accvgpr_read_b32 v53, a33
    v_accvgpr_read_b32 v54, a34
    v_accvgpr_read_b32 v55, a35
    v_accvgpr_read_b32 v56, a36
    v_accvgpr_read_b32 v57, a37
    v_accvgpr_read_b32 v58, a38
    v_accvgpr_read_b32 v59, a39
    v_mul_f32 v52, v52, v49
    v_mul_f32 v53, v53, v49
    v_mul_f32 v54, v54, v49
    v_mul_f32 v55, v55, v49
    v_mul_f32 v56, v56, v49
    v_mul_f32 v57, v57, v49
    v_mul_f32 v58, v58, v49
    v_mul_f32 v59, v59, v49
    v_accvgpr_write_b32 a32, v52
    v_accvgpr_write_b32 a33, v53
    v_accvgpr_write_b32 a34, v54
    v_accvgpr_write_b32 a35, v55
    v_accvgpr_write_b32 a36, v56
    v_accvgpr_write_b32 a37, v57
    v_accvgpr_write_b32 a38, v58
    v_accvgpr_write_b32 a39, v59
    v_accvgpr_read_b32 v52, a40
    v_accvgpr_read_b32 v53, a41
    v_accvgpr_read_b32 v54, a42
    v_accvgpr_read_b32 v55, a43
    v_accvgpr_read_b32 v56, a44
    v_accvgpr_read_b32 v57, a45
    v_accvgpr_read_b32 v58, a46
    v_accvgpr_read_b32 v59, a47
    v_mul_f32 v52, v52, v49
    v_mul_f32 v53, v53, v49
    v_mul_f32 v54, v54, v49
    v_mul_f32 v55, v55, v49
    v_mul_f32 v56, v56, v49
    v_mul_f32 v57, v57, v49
    v_mul_f32 v58, v58, v49
    v_mul_f32 v59, v59, v49
    v_accvgpr_write_b32 a40, v52
    v_accvgpr_write_b32 a41, v53
    v_accvgpr_write_b32 a42, v54
    v_accvgpr_write_b32 a43, v55
    v_accvgpr_write_b32 a44, v56
    v_accvgpr_write_b32 a45, v57
    v_accvgpr_write_b32 a46, v58
    v_accvgpr_write_b32 a47, v59
    v_accvgpr_read_b32 v52, a48
    v_accvgpr_read_b32 v53, a49
    v_accvgpr_read_b32 v54, a50
    v_accvgpr_read_b32 v55, a51
    v_accvgpr_read_b32 v56, a52
    v_accvgpr_read_b32 v57, a53
    v_accvgpr_read_b32 v58, a54
    v_accvgpr_read_b32 v59, a55
    v_mul_f32 v52, v52, v49
    v_mul_f32 v53, v53, v49
    v_mul_f32 v54, v54, v49
    v_mul_f32 v55, v55, v49
    v_mul_f32 v56, v56, v49
    v_mul_f32 v57, v57, v49
    v_mul_f32 v58, v58, v49
    v_mul_f32 v59, v59, v49
    v_accvgpr_write_b32 a48, v52
    v_accvgpr_write_b32 a49, v53
    v_accvgpr_write_b32 a50, v54
    v_accvgpr_write_b32 a51, v55
    v_accvgpr_write_b32 a52, v56
    v_accvgpr_write_b32 a53, v57
    v_accvgpr_write_b32 a54, v58
    v_accvgpr_write_b32 a55, v59
    v_accvgpr_read_b32 v52, a56
    v_accvgpr_read_b32 v53, a57
    v_accvgpr_read_b32 v54, a58
    v_accvgpr_read_b32 v55, a59
    v_accvgpr_read_b32 v56, a60
    v_accvgpr_read_b32 v57, a61
    v_accvgpr_read_b32 v58, a62
    v_accvgpr_read_b32 v59, a63
    v_mul_f32 v52, v52, v49
    v_mul_f32 v53, v53, v49
    v_mul_f32 v54, v54, v49
    v_mul_f32 v55, v55, v49
    v_mul_f32 v56, v56, v49
    v_mul_f32 v57, v57, v49
    v_mul_f32 v58, v58, v49
    v_mul_f32 v59, v59, v49
    v_accvgpr_write_b32 a56, v52
    v_accvgpr_write_b32 a57, v53
    v_accvgpr_write_b32 a58, v54
    v_accvgpr_write_b32 a59, v55
    v_accvgpr_write_b32 a60, v56
    v_accvgpr_write_b32 a61, v57
    v_accvgpr_write_b32 a62, v58
    v_accvgpr_write_b32 a63, v59
    v_exp_f32 v52, v72
    v_exp_f32 v53, v73
    v_exp_f32 v54, v74
    v_exp_f32 v55, v75
    v_exp_f32 v56, v76
    v_exp_f32 v57, v77
    v_exp_f32 v58, v78
    v_exp_f32 v59, v79
    s_nop 0
    v_cvt_pk_bf16_f32 v132, v52, v53
    v_cvt_pk_bf16_f32 v133, v54, v55
    v_cvt_pk_bf16_f32 v134, v56, v57
    v_cvt_pk_bf16_f32 v135, v58, v59
    s_nop 1
    v_mfma_f32_16x16x32_bf16 v[32:35], v[44:47], v[132:135], 0
    s_nop 7
    s_setpc_b64 s[70:71]
mega_kernel_rs0458:
    s_nop 15
    v_max3_f32 v48, v64, v65, v66
    v_max3_f32 v48, v48, v67, v68
    v_max3_f32 v48, v48, v69, v70
    v_max3_f32 v48, v48, v71, 0
    v_mov_b32 v49, v48
    s_nop 1
    v_permlane32_swap_b32 v48, v49
    s_nop 1
    v_max_f32 v48, v48, v49
    v_mov_b32 v49, v48
    s_nop 1
    v_permlane16_swap_b32 v48, v49
    s_nop 1
    v_max_f32 v48, v48, v49
    v_exp_f32 v49, -v48
    v_sub_f32 v64, v64, v48
    v_sub_f32 v65, v65, v48
    v_sub_f32 v66, v66, v48
    v_sub_f32 v67, v67, v48
    v_sub_f32 v68, v68, v48
    v_sub_f32 v69, v69, v48
    v_sub_f32 v70, v70, v48
    v_sub_f32 v71, v71, v48
    v_sub_f32 v96, v96, v48
    v_sub_f32 v97, v97, v48
    v_sub_f32 v98, v98, v48
    v_sub_f32 v99, v99, v48
    v_sub_f32 v100, v100, v48
    v_sub_f32 v101, v101, v48
    v_sub_f32 v102, v102, v48
    v_sub_f32 v103, v103, v48
    v_sub_f32 v160, v160, v48
    v_sub_f32 v161, v161, v48
    v_sub_f32 v162, v162, v48
    v_sub_f32 v163, v163, v48
    v_sub_f32 v164, v164, v48
    v_sub_f32 v165, v165, v48
    v_sub_f32 v166, v166, v48
    v_sub_f32 v167, v167, v48
    v_mul_f32 v12, v12, v49
    v_accvgpr_read_b32 v52, a0
    v_accvgpr_read_b32 v53, a1
    v_accvgpr_read_b32 v54, a2
    v_accvgpr_read_b32 v55, a3
    v_accvgpr_read_b32 v56, a4
    v_accvgpr_read_b32 v57, a5
    v_accvgpr_read_b32 v58, a6
    v_accvgpr_read_b32 v59, a7
    v_mul_f32 v52, v52, v49
    v_mul_f32 v53, v53, v49
    v_mul_f32 v54, v54, v49
    v_mul_f32 v55, v55, v49
    v_mul_f32 v56, v56, v49
    v_mul_f32 v57, v57, v49
    v_mul_f32 v58, v58, v49
    v_mul_f32 v59, v59, v49
    v_accvgpr_write_b32 a0, v52
    v_accvgpr_write_b32 a1, v53
    v_accvgpr_write_b32 a2, v54
    v_accvgpr_write_b32 a3, v55
    v_accvgpr_write_b32 a4, v56
    v_accvgpr_write_b32 a5, v57
    v_accvgpr_write_b32 a6, v58
    v_accvgpr_write_b32 a7, v59
    v_accvgpr_read_b32 v52, a8
    v_accvgpr_read_b32 v53, a9
    v_accvgpr_read_b32 v54, a10
    v_accvgpr_read_b32 v55, a11
    v_accvgpr_read_b32 v56, a12
    v_accvgpr_read_b32 v57, a13
    v_accvgpr_read_b32 v58, a14
    v_accvgpr_read_b32 v59, a15
    v_mul_f32 v52, v52, v49
    v_mul_f32 v53, v53, v49
    v_mul_f32 v54, v54, v49
    v_mul_f32 v55, v55, v49
    v_mul_f32 v56, v56, v49
    v_mul_f32 v57, v57, v49
    v_mul_f32 v58, v58, v49
    v_mul_f32 v59, v59, v49
    v_accvgpr_write_b32 a8, v52
    v_accvgpr_write_b32 a9, v53
    v_accvgpr_write_b32 a10, v54
    v_accvgpr_write_b32 a11, v55
    v_accvgpr_write_b32 a12, v56
    v_accvgpr_write_b32 a13, v57
    v_accvgpr_write_b32 a14, v58
    v_accvgpr_write_b32 a15, v59
    v_accvgpr_read_b32 v52, a16
    v_accvgpr_read_b32 v53, a17
    v_accvgpr_read_b32 v54, a18
    v_accvgpr_read_b32 v55, a19
    v_accvgpr_read_b32 v56, a20
    v_accvgpr_read_b32 v57, a21
    v_accvgpr_read_b32 v58, a22
    v_accvgpr_read_b32 v59, a23
    v_mul_f32 v52, v52, v49
    v_mul_f32 v53, v53, v49
    v_mul_f32 v54, v54, v49
    v_mul_f32 v55, v55, v49
    v_mul_f32 v56, v56, v49
    v_mul_f32 v57, v57, v49
    v_mul_f32 v58, v58, v49
    v_mul_f32 v59, v59, v49
    v_accvgpr_write_b32 a16, v52
    v_accvgpr_write_b32 a17, v53
    v_accvgpr_write_b32 a18, v54
    v_accvgpr_write_b32 a19, v55
    v_accvgpr_write_b32 a20, v56
    v_accvgpr_write_b32 a21, v57
    v_accvgpr_write_b32 a22, v58
    v_accvgpr_write_b32 a23, v59
    v_accvgpr_read_b32 v52, a24
    v_accvgpr_read_b32 v53, a25
    v_accvgpr_read_b32 v54, a26
    v_accvgpr_read_b32 v55, a27
    v_accvgpr_read_b32 v56, a28
    v_accvgpr_read_b32 v57, a29
    v_accvgpr_read_b32 v58, a30
    v_accvgpr_read_b32 v59, a31
    v_mul_f32 v52, v52, v49
    v_mul_f32 v53, v53, v49
    v_mul_f32 v54, v54, v49
    v_mul_f32 v55, v55, v49
    v_mul_f32 v56, v56, v49
    v_mul_f32 v57, v57, v49
    v_mul_f32 v58, v58, v49
    v_mul_f32 v59, v59, v49
    v_accvgpr_write_b32 a24, v52
    v_accvgpr_write_b32 a25, v53
    v_accvgpr_write_b32 a26, v54
    v_accvgpr_write_b32 a27, v55
    v_accvgpr_write_b32 a28, v56
    v_accvgpr_write_b32 a29, v57
    v_accvgpr_write_b32 a30, v58
    v_accvgpr_write_b32 a31, v59
    v_exp_f32 v52, v64
    v_exp_f32 v53, v65
    v_exp_f32 v54, v66
    v_exp_f32 v55, v67
    v_exp_f32 v56, v68
    v_exp_f32 v57, v69
    v_exp_f32 v58, v70
    v_exp_f32 v59, v71
    s_nop 0
    v_cvt_pk_bf16_f32 v128, v52, v53
    v_cvt_pk_bf16_f32 v129, v54, v55
    v_cvt_pk_bf16_f32 v130, v56, v57
    v_cvt_pk_bf16_f32 v131, v58, v59
    s_nop 1
    v_mfma_f32_16x16x32_bf16 v[28:31], v[44:47], v[128:131], 0
    v_max3_f32 v48, v72, v73, v74
    v_max3_f32 v48, v48, v75, v76
    v_max3_f32 v48, v48, v77, v78
    v_max3_f32 v48, v48, v79, 0
    v_mov_b32 v49, v48
    s_nop 1
    v_permlane32_swap_b32 v48, v49
    s_nop 1
    v_max_f32 v48, v48, v49
    v_mov_b32 v49, v48
    s_nop 1
    v_permlane16_swap_b32 v48, v49
    s_nop 1
    v_max_f32 v48, v48, v49
    v_exp_f32 v49, -v48
    v_sub_f32 v72, v72, v48
    v_sub_f32 v73, v73, v48
    v_sub_f32 v74, v74, v48
    v_sub_f32 v75, v75, v48
    v_sub_f32 v76, v76, v48
    v_sub_f32 v77, v77, v48
    v_sub_f32 v78, v78, v48
    v_sub_f32 v79, v79, v48
    v_sub_f32 v104, v104, v48
    v_sub_f32 v105, v105, v48
    v_sub_f32 v106, v106, v48
    v_sub_f32 v107, v107, v48
    v_sub_f32 v108, v108, v48
    v_sub_f32 v109, v109, v48
    v_sub_f32 v110, v110, v48
    v_sub_f32 v111, v111, v48
    v_sub_f32 v168, v168, v48
    v_sub_f32 v169, v169, v48
    v_sub_f32 v170, v170, v48
    v_sub_f32 v171, v171, v48
    v_sub_f32 v172, v172, v48
    v_sub_f32 v173, v173, v48
    v_sub_f32 v174, v174, v48
    v_sub_f32 v175, v175, v48
    v_mul_f32 v13, v13, v49
    v_accvgpr_read_b32 v52, a32
    v_accvgpr_read_b32 v53, a33
    v_accvgpr_read_b32 v54, a34
    v_accvgpr_read_b32 v55, a35
    v_accvgpr_read_b32 v56, a36
    v_accvgpr_read_b32 v57, a37
    v_accvgpr_read_b32 v58, a38
    v_accvgpr_read_b32 v59, a39
    v_mul_f32 v52, v52, v49
    v_mul_f32 v53, v53, v49
    v_mul_f32 v54, v54, v49
    v_mul_f32 v55, v55, v49
    v_mul_f32 v56, v56, v49
    v_mul_f32 v57, v57, v49
    v_mul_f32 v58, v58, v49
    v_mul_f32 v59, v59, v49
    v_accvgpr_write_b32 a32, v52
    v_accvgpr_write_b32 a33, v53
    v_accvgpr_write_b32 a34, v54
    v_accvgpr_write_b32 a35, v55
    v_accvgpr_write_b32 a36, v56
    v_accvgpr_write_b32 a37, v57
    v_accvgpr_write_b32 a38, v58
    v_accvgpr_write_b32 a39, v59
    v_accvgpr_read_b32 v52, a40
    v_accvgpr_read_b32 v53, a41
    v_accvgpr_read_b32 v54, a42
    v_accvgpr_read_b32 v55, a43
    v_accvgpr_read_b32 v56, a44
    v_accvgpr_read_b32 v57, a45
    v_accvgpr_read_b32 v58, a46
    v_accvgpr_read_b32 v59, a47
    v_mul_f32 v52, v52, v49
    v_mul_f32 v53, v53, v49
    v_mul_f32 v54, v54, v49
    v_mul_f32 v55, v55, v49
    v_mul_f32 v56, v56, v49
    v_mul_f32 v57, v57, v49
    v_mul_f32 v58, v58, v49
    v_mul_f32 v59, v59, v49
    v_accvgpr_write_b32 a40, v52
    v_accvgpr_write_b32 a41, v53
    v_accvgpr_write_b32 a42, v54
    v_accvgpr_write_b32 a43, v55
    v_accvgpr_write_b32 a44, v56
    v_accvgpr_write_b32 a45, v57
    v_accvgpr_write_b32 a46, v58
    v_accvgpr_write_b32 a47, v59
    v_accvgpr_read_b32 v52, a48
    v_accvgpr_read_b32 v53, a49
    v_accvgpr_read_b32 v54, a50
    v_accvgpr_read_b32 v55, a51
    v_accvgpr_read_b32 v56, a52
    v_accvgpr_read_b32 v57, a53
    v_accvgpr_read_b32 v58, a54
    v_accvgpr_read_b32 v59, a55
    v_mul_f32 v52, v52, v49
    v_mul_f32 v53, v53, v49
    v_mul_f32 v54, v54, v49
    v_mul_f32 v55, v55, v49
    v_mul_f32 v56, v56, v49
    v_mul_f32 v57, v57, v49
    v_mul_f32 v58, v58, v49
    v_mul_f32 v59, v59, v49
    v_accvgpr_write_b32 a48, v52
    v_accvgpr_write_b32 a49, v53
    v_accvgpr_write_b32 a50, v54
    v_accvgpr_write_b32 a51, v55
    v_accvgpr_write_b32 a52, v56
    v_accvgpr_write_b32 a53, v57
    v_accvgpr_write_b32 a54, v58
    v_accvgpr_write_b32 a55, v59
    v_accvgpr_read_b32 v52, a56
    v_accvgpr_read_b32 v53, a57
    v_accvgpr_read_b32 v54, a58
    v_accvgpr_read_b32 v55, a59
    v_accvgpr_read_b32 v56, a60
    v_accvgpr_read_b32 v57, a61
    v_accvgpr_read_b32 v58, a62
    v_accvgpr_read_b32 v59, a63
    v_mul_f32 v52, v52, v49
    v_mul_f32 v53, v53, v49
    v_mul_f32 v54, v54, v49
    v_mul_f32 v55, v55, v49
    v_mul_f32 v56, v56, v49
    v_mul_f32 v57, v57, v49
    v_mul_f32 v58, v58, v49
    v_mul_f32 v59, v59, v49
    v_accvgpr_write_b32 a56, v52
    v_accvgpr_write_b32 a57, v53
    v_accvgpr_write_b32 a58, v54
    v_accvgpr_write_b32 a59, v55
    v_accvgpr_write_b32 a60, v56
    v_accvgpr_write_b32 a61, v57
    v_accvgpr_write_b32 a62, v58
    v_accvgpr_write_b32 a63, v59
    v_exp_f32 v52, v72
    v_exp_f32 v53, v73
    v_exp_f32 v54, v74
    v_exp_f32 v55, v75
    v_exp_f32 v56, v76
    v_exp_f32 v57, v77
    v_exp_f32 v58, v78
    v_exp_f32 v59, v79
    s_nop 0
    v_cvt_pk_bf16_f32 v132, v52, v53
    v_cvt_pk_bf16_f32 v133, v54, v55
    v_cvt_pk_bf16_f32 v134, v56, v57
    v_cvt_pk_bf16_f32 v135, v58, v59
    s_nop 1
    v_mfma_f32_16x16x32_bf16 v[32:35], v[44:47], v[132:135], 0
    v_max3_f32 v48, v80, v81, v82
    v_max3_f32 v48, v48, v83, v84
    v_max3_f32 v48, v48, v85, v86
    v_max3_f32 v48, v48, v87, 0
    v_mov_b32 v49, v48
    s_nop 1
    v_permlane32_swap_b32 v48, v49
    s_nop 1
    v_max_f32 v48, v48, v49
    v_mov_b32 v49, v48
    s_nop 1
    v_permlane16_swap_b32 v48, v49
    s_nop 1
    v_max_f32 v48, v48, v49
    v_exp_f32 v49, -v48
    v_sub_f32 v80, v80, v48
    v_sub_f32 v81, v81, v48
    v_sub_f32 v82, v82, v48
    v_sub_f32 v83, v83, v48
    v_sub_f32 v84, v84, v48
    v_sub_f32 v85, v85, v48
    v_sub_f32 v86, v86, v48
    v_sub_f32 v87, v87, v48
    v_sub_f32 v112, v112, v48
    v_sub_f32 v113, v113, v48
    v_sub_f32 v114, v114, v48
    v_sub_f32 v115, v115, v48
    v_sub_f32 v116, v116, v48
    v_sub_f32 v117, v117, v48
    v_sub_f32 v118, v118, v48
    v_sub_f32 v119, v119, v48
    v_sub_f32 v176, v176, v48
    v_sub_f32 v177, v177, v48
    v_sub_f32 v178, v178, v48
    v_sub_f32 v179, v179, v48
    v_sub_f32 v180, v180, v48
    v_sub_f32 v181, v181, v48
    v_sub_f32 v182, v182, v48
    v_sub_f32 v183, v183, v48
    v_mul_f32 v14, v14, v49
    v_accvgpr_read_b32 v52, a64
    v_accvgpr_read_b32 v53, a65
    v_accvgpr_read_b32 v54, a66
    v_accvgpr_read_b32 v55, a67
    v_accvgpr_read_b32 v56, a68
    v_accvgpr_read_b32 v57, a69
    v_accvgpr_read_b32 v58, a70
    v_accvgpr_read_b32 v59, a71
    v_mul_f32 v52, v52, v49
    v_mul_f32 v53, v53, v49
    v_mul_f32 v54, v54, v49
    v_mul_f32 v55, v55, v49
    v_mul_f32 v56, v56, v49
    v_mul_f32 v57, v57, v49
    v_mul_f32 v58, v58, v49
    v_mul_f32 v59, v59, v49
    v_accvgpr_write_b32 a64, v52
    v_accvgpr_write_b32 a65, v53
    v_accvgpr_write_b32 a66, v54
    v_accvgpr_write_b32 a67, v55
    v_accvgpr_write_b32 a68, v56
    v_accvgpr_write_b32 a69, v57
    v_accvgpr_write_b32 a70, v58
    v_accvgpr_write_b32 a71, v59
    v_accvgpr_read_b32 v52, a72
    v_accvgpr_read_b32 v53, a73
    v_accvgpr_read_b32 v54, a74
    v_accvgpr_read_b32 v55, a75
    v_accvgpr_read_b32 v56, a76
    v_accvgpr_read_b32 v57, a77
    v_accvgpr_read_b32 v58, a78
    v_accvgpr_read_b32 v59, a79
    v_mul_f32 v52, v52, v49
    v_mul_f32 v53, v53, v49
    v_mul_f32 v54, v54, v49
    v_mul_f32 v55, v55, v49
    v_mul_f32 v56, v56, v49
    v_mul_f32 v57, v57, v49
    v_mul_f32 v58, v58, v49
    v_mul_f32 v59, v59, v49
    v_accvgpr_write_b32 a72, v52
    v_accvgpr_write_b32 a73, v53
    v_accvgpr_write_b32 a74, v54
    v_accvgpr_write_b32 a75, v55
    v_accvgpr_write_b32 a76, v56
    v_accvgpr_write_b32 a77, v57
    v_accvgpr_write_b32 a78, v58
    v_accvgpr_write_b32 a79, v59
    v_accvgpr_read_b32 v52, a80
    v_accvgpr_read_b32 v53, a81
    v_accvgpr_read_b32 v54, a82
    v_accvgpr_read_b32 v55, a83
    v_accvgpr_read_b32 v56, a84
    v_accvgpr_read_b32 v57, a85
    v_accvgpr_read_b32 v58, a86
    v_accvgpr_read_b32 v59, a87
    v_mul_f32 v52, v52, v49
    v_mul_f32 v53, v53, v49
    v_mul_f32 v54, v54, v49
    v_mul_f32 v55, v55, v49
    v_mul_f32 v56, v56, v49
    v_mul_f32 v57, v57, v49
    v_mul_f32 v58, v58, v49
    v_mul_f32 v59, v59, v49
    v_accvgpr_write_b32 a80, v52
    v_accvgpr_write_b32 a81, v53
    v_accvgpr_write_b32 a82, v54
    v_accvgpr_write_b32 a83, v55
    v_accvgpr_write_b32 a84, v56
    v_accvgpr_write_b32 a85, v57
    v_accvgpr_write_b32 a86, v58
    v_accvgpr_write_b32 a87, v59
    v_accvgpr_read_b32 v52, a88
    v_accvgpr_read_b32 v53, a89
    v_accvgpr_read_b32 v54, a90
    v_accvgpr_read_b32 v55, a91
    v_accvgpr_read_b32 v56, a92
    v_accvgpr_read_b32 v57, a93
    v_accvgpr_read_b32 v58, a94
    v_accvgpr_read_b32 v59, a95
    v_mul_f32 v52, v52, v49
    v_mul_f32 v53, v53, v49
    v_mul_f32 v54, v54, v49
    v_mul_f32 v55, v55, v49
    v_mul_f32 v56, v56, v49
    v_mul_f32 v57, v57, v49
    v_mul_f32 v58, v58, v49
    v_mul_f32 v59, v59, v49
    v_accvgpr_write_b32 a88, v52
    v_accvgpr_write_b32 a89, v53
    v_accvgpr_write_b32 a90, v54
    v_accvgpr_write_b32 a91, v55
    v_accvgpr_write_b32 a92, v56
    v_accvgpr_write_b32 a93, v57
    v_accvgpr_write_b32 a94, v58
    v_accvgpr_write_b32 a95, v59
    v_exp_f32 v52, v80
    v_exp_f32 v53, v81
    v_exp_f32 v54, v82
    v_exp_f32 v55, v83
    v_exp_f32 v56, v84
    v_exp_f32 v57, v85
    v_exp_f32 v58, v86
    v_exp_f32 v59, v87
    s_nop 0
    v_cvt_pk_bf16_f32 v136, v52, v53
    v_cvt_pk_bf16_f32 v137, v54, v55
    v_cvt_pk_bf16_f32 v138, v56, v57
    v_cvt_pk_bf16_f32 v139, v58, v59
    s_nop 1
    v_mfma_f32_16x16x32_bf16 v[36:39], v[44:47], v[136:139], 0
    v_max3_f32 v48, v88, v89, v90
    v_max3_f32 v48, v48, v91, v92
    v_max3_f32 v48, v48, v93, v94
    v_max3_f32 v48, v48, v95, 0
    v_mov_b32 v49, v48
    s_nop 1
    v_permlane32_swap_b32 v48, v49
    s_nop 1
    v_max_f32 v48, v48, v49
    v_mov_b32 v49, v48
    s_nop 1
    v_permlane16_swap_b32 v48, v49
    s_nop 1
    v_max_f32 v48, v48, v49
    v_exp_f32 v49, -v48
    v_sub_f32 v88, v88, v48
    v_sub_f32 v89, v89, v48
    v_sub_f32 v90, v90, v48
    v_sub_f32 v91, v91, v48
    v_sub_f32 v92, v92, v48
    v_sub_f32 v93, v93, v48
    v_sub_f32 v94, v94, v48
    v_sub_f32 v95, v95, v48
    v_sub_f32 v120, v120, v48
    v_sub_f32 v121, v121, v48
    v_sub_f32 v122, v122, v48
    v_sub_f32 v123, v123, v48
    v_sub_f32 v124, v124, v48
    v_sub_f32 v125, v125, v48
    v_sub_f32 v126, v126, v48
    v_sub_f32 v127, v127, v48
    v_sub_f32 v184, v184, v48
    v_sub_f32 v185, v185, v48
    v_sub_f32 v186, v186, v48
    v_sub_f32 v187, v187, v48
    v_sub_f32 v188, v188, v48
    v_sub_f32 v189, v189, v48
    v_sub_f32 v190, v190, v48
    v_sub_f32 v191, v191, v48
    v_mul_f32 v15, v15, v49
    v_accvgpr_read_b32 v52, a96
    v_accvgpr_read_b32 v53, a97
    v_accvgpr_read_b32 v54, a98
    v_accvgpr_read_b32 v55, a99
    v_accvgpr_read_b32 v56, a100
    v_accvgpr_read_b32 v57, a101
    v_accvgpr_read_b32 v58, a102
    v_accvgpr_read_b32 v59, a103
    v_mul_f32 v52, v52, v49
    v_mul_f32 v53, v53, v49
    v_mul_f32 v54, v54, v49
    v_mul_f32 v55, v55, v49
    v_mul_f32 v56, v56, v49
    v_mul_f32 v57, v57, v49
    v_mul_f32 v58, v58, v49
    v_mul_f32 v59, v59, v49
    v_accvgpr_write_b32 a96, v52
    v_accvgpr_write_b32 a97, v53
    v_accvgpr_write_b32 a98, v54
    v_accvgpr_write_b32 a99, v55
    v_accvgpr_write_b32 a100, v56
    v_accvgpr_write_b32 a101, v57
    v_accvgpr_write_b32 a102, v58
    v_accvgpr_write_b32 a103, v59
    v_accvgpr_read_b32 v52, a104
    v_accvgpr_read_b32 v53, a105
    v_accvgpr_read_b32 v54, a106
    v_accvgpr_read_b32 v55, a107
    v_accvgpr_read_b32 v56, a108
    v_accvgpr_read_b32 v57, a109
    v_accvgpr_read_b32 v58, a110
    v_accvgpr_read_b32 v59, a111
    v_mul_f32 v52, v52, v49
    v_mul_f32 v53, v53, v49
    v_mul_f32 v54, v54, v49
    v_mul_f32 v55, v55, v49
    v_mul_f32 v56, v56, v49
    v_mul_f32 v57, v57, v49
    v_mul_f32 v58, v58, v49
    v_mul_f32 v59, v59, v49
    v_accvgpr_write_b32 a104, v52
    v_accvgpr_write_b32 a105, v53
    v_accvgpr_write_b32 a106, v54
    v_accvgpr_write_b32 a107, v55
    v_accvgpr_write_b32 a108, v56
    v_accvgpr_write_b32 a109, v57
    v_accvgpr_write_b32 a110, v58
    v_accvgpr_write_b32 a111, v59
    v_accvgpr_read_b32 v52, a112
    v_accvgpr_read_b32 v53, a113
    v_accvgpr_read_b32 v54, a114
    v_accvgpr_read_b32 v55, a115
    v_accvgpr_read_b32 v56, a116
    v_accvgpr_read_b32 v57, a117
    v_accvgpr_read_b32 v58, a118
    v_accvgpr_read_b32 v59, a119
    v_mul_f32 v52, v52, v49
    v_mul_f32 v53, v53, v49
    v_mul_f32 v54, v54, v49
    v_mul_f32 v55, v55, v49
    v_mul_f32 v56, v56, v49
    v_mul_f32 v57, v57, v49
    v_mul_f32 v58, v58, v49
    v_mul_f32 v59, v59, v49
    v_accvgpr_write_b32 a112, v52
    v_accvgpr_write_b32 a113, v53
    v_accvgpr_write_b32 a114, v54
    v_accvgpr_write_b32 a115, v55
    v_accvgpr_write_b32 a116, v56
    v_accvgpr_write_b32 a117, v57
    v_accvgpr_write_b32 a118, v58
    v_accvgpr_write_b32 a119, v59
    v_accvgpr_read_b32 v52, a120
    v_accvgpr_read_b32 v53, a121
    v_accvgpr_read_b32 v54, a122
    v_accvgpr_read_b32 v55, a123
    v_accvgpr_read_b32 v56, a124
    v_accvgpr_read_b32 v57, a125
    v_accvgpr_read_b32 v58, a126
    v_accvgpr_read_b32 v59, a127
    v_mul_f32 v52, v52, v49
    v_mul_f32 v53, v53, v49
    v_mul_f32 v54, v54, v49
    v_mul_f32 v55, v55, v49
    v_mul_f32 v56, v56, v49
    v_mul_f32 v57, v57, v49
    v_mul_f32 v58, v58, v49
    v_mul_f32 v59, v59, v49
    v_accvgpr_write_b32 a120, v52
    v_accvgpr_write_b32 a121, v53
    v_accvgpr_write_b32 a122, v54
    v_accvgpr_write_b32 a123, v55
    v_accvgpr_write_b32 a124, v56
    v_accvgpr_write_b32 a125, v57
    v_accvgpr_write_b32 a126, v58
    v_accvgpr_write_b32 a127, v59
    v_exp_f32 v52, v88
    v_exp_f32 v53, v89
    v_exp_f32 v54, v90
    v_exp_f32 v55, v91
    v_exp_f32 v56, v92
    v_exp_f32 v57, v93
    v_exp_f32 v58, v94
    v_exp_f32 v59, v95
    s_nop 0
    v_cvt_pk_bf16_f32 v140, v52, v53
    v_cvt_pk_bf16_f32 v141, v54, v55
    v_cvt_pk_bf16_f32 v142, v56, v57
    v_cvt_pk_bf16_f32 v143, v58, v59
    s_nop 1
    v_mfma_f32_16x16x32_bf16 v[40:43], v[44:47], v[140:143], 0
    s_nop 7
    s_setpc_b64 s[70:71]
mega_kernel_rs1259:
    s_nop 15
    v_max3_f32 v48, v96, v97, v98
    v_max3_f32 v48, v48, v99, v100
    v_max3_f32 v48, v48, v101, v102
    v_max3_f32 v48, v48, v103, 0
    v_mov_b32 v49, v48
    s_nop 1
    v_permlane32_swap_b32 v48, v49
    s_nop 1
    v_max_f32 v48, v48, v49
    v_mov_b32 v49, v48
    s_nop 1
    v_permlane16_swap_b32 v48, v49
    s_nop 1
    v_max_f32 v48, v48, v49
    v_exp_f32 v49, -v48
    v_sub_f32 v96, v96, v48
    v_sub_f32 v97, v97, v48
    v_sub_f32 v98, v98, v48
    v_sub_f32 v99, v99, v48
    v_sub_f32 v100, v100, v48
    v_sub_f32 v101, v101, v48
    v_sub_f32 v102, v102, v48
    v_sub_f32 v103, v103, v48
    v_sub_f32 v64, v64, v48
    v_sub_f32 v65, v65, v48
    v_sub_f32 v66, v66, v48
    v_sub_f32 v67, v67, v48
    v_sub_f32 v68, v68, v48
    v_sub_f32 v69, v69, v48
    v_sub_f32 v70, v70, v48
    v_sub_f32 v71, v71, v48
    v_sub_f32 v160, v160, v48
    v_sub_f32 v161, v161, v48
    v_sub_f32 v162, v162, v48
    v_sub_f32 v163, v163, v48
    v_sub_f32 v164, v164, v48
    v_sub_f32 v165, v165, v48
    v_sub_f32 v166, v166, v48
    v_sub_f32 v167, v167, v48
    v_mul_f32 v12, v12, v49
    v_accvgpr_read_b32 v52, a0
    v_accvgpr_read_b32 v53, a1
    v_accvgpr_read_b32 v54, a2
    v_accvgpr_read_b32 v55, a3
    v_accvgpr_read_b32 v56, a4
    v_accvgpr_read_b32 v57, a5
    v_accvgpr_read_b32 v58, a6
    v_accvgpr_read_b32 v59, a7
    v_mul_f32 v52, v52, v49
    v_mul_f32 v53, v53, v49
    v_mul_f32 v54, v54, v49
    v_mul_f32 v55, v55, v49
    v_mul_f32 v56, v56, v49
    v_mul_f32 v57, v57, v49
    v_mul_f32 v58, v58, v49
    v_mul_f32 v59, v59, v49
    v_accvgpr_write_b32 a0, v52
    v_accvgpr_write_b32 a1, v53
    v_accvgpr_write_b32 a2, v54
    v_accvgpr_write_b32 a3, v55
    v_accvgpr_write_b32 a4, v56
    v_accvgpr_write_b32 a5, v57
    v_accvgpr_write_b32 a6, v58
    v_accvgpr_write_b32 a7, v59
    v_accvgpr_read_b32 v52, a8
    v_accvgpr_read_b32 v53, a9
    v_accvgpr_read_b32 v54, a10
    v_accvgpr_read_b32 v55, a11
    v_accvgpr_read_b32 v56, a12
    v_accvgpr_read_b32 v57, a13
    v_accvgpr_read_b32 v58, a14
    v_accvgpr_read_b32 v59, a15
    v_mul_f32 v52, v52, v49
    v_mul_f32 v53, v53, v49
    v_mul_f32 v54, v54, v49
    v_mul_f32 v55, v55, v49
    v_mul_f32 v56, v56, v49
    v_mul_f32 v57, v57, v49
    v_mul_f32 v58, v58, v49
    v_mul_f32 v59, v59, v49
    v_accvgpr_write_b32 a8, v52
    v_accvgpr_write_b32 a9, v53
    v_accvgpr_write_b32 a10, v54
    v_accvgpr_write_b32 a11, v55
    v_accvgpr_write_b32 a12, v56
    v_accvgpr_write_b32 a13, v57
    v_accvgpr_write_b32 a14, v58
    v_accvgpr_write_b32 a15, v59
    v_accvgpr_read_b32 v52, a16
    v_accvgpr_read_b32 v53, a17
    v_accvgpr_read_b32 v54, a18
    v_accvgpr_read_b32 v55, a19
    v_accvgpr_read_b32 v56, a20
    v_accvgpr_read_b32 v57, a21
    v_accvgpr_read_b32 v58, a22
    v_accvgpr_read_b32 v59, a23
    v_mul_f32 v52, v52, v49
    v_mul_f32 v53, v53, v49
    v_mul_f32 v54, v54, v49
    v_mul_f32 v55, v55, v49
    v_mul_f32 v56, v56, v49
    v_mul_f32 v57, v57, v49
    v_mul_f32 v58, v58, v49
    v_mul_f32 v59, v59, v49
    v_accvgpr_write_b32 a16, v52
    v_accvgpr_write_b32 a17, v53
    v_accvgpr_write_b32 a18, v54
    v_accvgpr_write_b32 a19, v55
    v_accvgpr_write_b32 a20, v56
    v_accvgpr_write_b32 a21, v57
    v_accvgpr_write_b32 a22, v58
    v_accvgpr_write_b32 a23, v59
    v_accvgpr_read_b32 v52, a24
    v_accvgpr_read_b32 v53, a25
    v_accvgpr_read_b32 v54, a26
    v_accvgpr_read_b32 v55, a27
    v_accvgpr_read_b32 v56, a28
    v_accvgpr_read_b32 v57, a29
    v_accvgpr_read_b32 v58, a30
    v_accvgpr_read_b32 v59, a31
    v_mul_f32 v52, v52, v49
    v_mul_f32 v53, v53, v49
    v_mul_f32 v54, v54, v49
    v_mul_f32 v55, v55, v49
    v_mul_f32 v56, v56, v49
    v_mul_f32 v57, v57, v49
    v_mul_f32 v58, v58, v49
    v_mul_f32 v59, v59, v49
    v_accvgpr_write_b32 a24, v52
    v_accvgpr_write_b32 a25, v53
    v_accvgpr_write_b32 a26, v54
    v_accvgpr_write_b32 a27, v55
    v_accvgpr_write_b32 a28, v56
    v_accvgpr_write_b32 a29, v57
    v_accvgpr_write_b32 a30, v58
    v_accvgpr_write_b32 a31, v59
    v_exp_f32 v52, v96
    v_exp_f32 v53, v97
    v_exp_f32 v54, v98
    v_exp_f32 v55, v99
    v_exp_f32 v56, v100
    v_exp_f32 v57, v101
    v_exp_f32 v58, v102
    v_exp_f32 v59, v103
    s_nop 0
    v_cvt_pk_bf16_f32 v144, v52, v53
    v_cvt_pk_bf16_f32 v145, v54, v55
    v_cvt_pk_bf16_f32 v146, v56, v57
    v_cvt_pk_bf16_f32 v147, v58, v59
    s_nop 1
    v_mfma_f32_16x16x32_bf16 v[28:31], v[44:47], v[144:147], 0
    v_max3_f32 v48, v104, v105, v106
    v_max3_f32 v48, v48, v107, v108
    v_max3_f32 v48, v48, v109, v110
    v_max3_f32 v48, v48, v111, 0
    v_mov_b32 v49, v48
    s_nop 1
    v_permlane32_swap_b32 v48, v49
    s_nop 1
    v_max_f32 v48, v48, v49
    v_mov_b32 v49, v48
    s_nop 1
    v_permlane16_swap_b32 v48, v49
    s_nop 1
    v_max_f32 v48, v48, v49
    v_exp_f32 v49, -v48
    v_sub_f32 v104, v104, v48
    v_sub_f32 v105, v105, v48
    v_sub_f32 v106, v106, v48
    v_sub_f32 v107, v107, v48
    v_sub_f32 v108, v108, v48
    v_sub_f32 v109, v109, v48
    v_sub_f32 v110, v110, v48
    v_sub_f32 v111, v111, v48
    v_sub_f32 v72, v72, v48
    v_sub_f32 v73, v73, v48
    v_sub_f32 v74, v74, v48
    v_sub_f32 v75, v75, v48
    v_sub_f32 v76, v76, v48
    v_sub_f32 v77, v77, v48
    v_sub_f32 v78, v78, v48
    v_sub_f32 v79, v79, v48
    v_sub_f32 v168, v168, v48
    v_sub_f32 v169, v169, v48
    v_sub_f32 v170, v170, v48
    v_sub_f32 v171, v171, v48
    v_sub_f32 v172, v172, v48
    v_sub_f32 v173, v173, v48
    v_sub_f32 v174, v174, v48
    v_sub_f32 v175, v175, v48
    v_mul_f32 v13, v13, v49
    v_accvgpr_read_b32 v52, a32
    v_accvgpr_read_b32 v53, a33
    v_accvgpr_read_b32 v54, a34
    v_accvgpr_read_b32 v55, a35
    v_accvgpr_read_b32 v56, a36
    v_accvgpr_read_b32 v57, a37
    v_accvgpr_read_b32 v58, a38
    v_accvgpr_read_b32 v59, a39
    v_mul_f32 v52, v52, v49
    v_mul_f32 v53, v53, v49
    v_mul_f32 v54, v54, v49
    v_mul_f32 v55, v55, v49
    v_mul_f32 v56, v56, v49
    v_mul_f32 v57, v57, v49
    v_mul_f32 v58, v58, v49
    v_mul_f32 v59, v59, v49
    v_accvgpr_write_b32 a32, v52
    v_accvgpr_write_b32 a33, v53
    v_accvgpr_write_b32 a34, v54
    v_accvgpr_write_b32 a35, v55
    v_accvgpr_write_b32 a36, v56
    v_accvgpr_write_b32 a37, v57
    v_accvgpr_write_b32 a38, v58
    v_accvgpr_write_b32 a39, v59
    v_accvgpr_read_b32 v52, a40
    v_accvgpr_read_b32 v53, a41
    v_accvgpr_read_b32 v54, a42
    v_accvgpr_read_b32 v55, a43
    v_accvgpr_read_b32 v56, a44
    v_accvgpr_read_b32 v57, a45
    v_accvgpr_read_b32 v58, a46
    v_accvgpr_read_b32 v59, a47
    v_mul_f32 v52, v52, v49
    v_mul_f32 v53, v53, v49
    v_mul_f32 v54, v54, v49
    v_mul_f32 v55, v55, v49
    v_mul_f32 v56, v56, v49
    v_mul_f32 v57, v57, v49
    v_mul_f32 v58, v58, v49
    v_mul_f32 v59, v59, v49
    v_accvgpr_write_b32 a40, v52
    v_accvgpr_write_b32 a41, v53
    v_accvgpr_write_b32 a42, v54
    v_accvgpr_write_b32 a43, v55
    v_accvgpr_write_b32 a44, v56
    v_accvgpr_write_b32 a45, v57
    v_accvgpr_write_b32 a46, v58
    v_accvgpr_write_b32 a47, v59
    v_accvgpr_read_b32 v52, a48
    v_accvgpr_read_b32 v53, a49
    v_accvgpr_read_b32 v54, a50
    v_accvgpr_read_b32 v55, a51
    v_accvgpr_read_b32 v56, a52
    v_accvgpr_read_b32 v57, a53
    v_accvgpr_read_b32 v58, a54
    v_accvgpr_read_b32 v59, a55
    v_mul_f32 v52, v52, v49
    v_mul_f32 v53, v53, v49
    v_mul_f32 v54, v54, v49
    v_mul_f32 v55, v55, v49
    v_mul_f32 v56, v56, v49
    v_mul_f32 v57, v57, v49
    v_mul_f32 v58, v58, v49
    v_mul_f32 v59, v59, v49
    v_accvgpr_write_b32 a48, v52
    v_accvgpr_write_b32 a49, v53
    v_accvgpr_write_b32 a50, v54
    v_accvgpr_write_b32 a51, v55
    v_accvgpr_write_b32 a52, v56
    v_accvgpr_write_b32 a53, v57
    v_accvgpr_write_b32 a54, v58
    v_accvgpr_write_b32 a55, v59
    v_accvgpr_read_b32 v52, a56
    v_accvgpr_read_b32 v53, a57
    v_accvgpr_read_b32 v54, a58
    v_accvgpr_read_b32 v55, a59
    v_accvgpr_read_b32 v56, a60
    v_accvgpr_read_b32 v57, a61
    v_accvgpr_read_b32 v58, a62
    v_accvgpr_read_b32 v59, a63
    v_mul_f32 v52, v52, v49
    v_mul_f32 v53, v53, v49
    v_mul_f32 v54, v54, v49
    v_mul_f32 v55, v55, v49
    v_mul_f32 v56, v56, v49
    v_mul_f32 v57, v57, v49
    v_mul_f32 v58, v58, v49
    v_mul_f32 v59, v59, v49
    v_accvgpr_write_b32 a56, v52
    v_accvgpr_write_b32 a57, v53
    v_accvgpr_write_b32 a58, v54
    v_accvgpr_write_b32 a59, v55
    v_accvgpr_write_b32 a60, v56
    v_accvgpr_write_b32 a61, v57
    v_accvgpr_write_b32 a62, v58
    v_accvgpr_write_b32 a63, v59
    v_exp_f32 v52, v104
    v_exp_f32 v53, v105
    v_exp_f32 v54, v106
    v_exp_f32 v55, v107
    v_exp_f32 v56, v108
    v_exp_f32 v57, v109
    v_exp_f32 v58, v110
    v_exp_f32 v59, v111
    s_nop 0
    v_cvt_pk_bf16_f32 v148, v52, v53
    v_cvt_pk_bf16_f32 v149, v54, v55
    v_cvt_pk_bf16_f32 v150, v56, v57
    v_cvt_pk_bf16_f32 v151, v58, v59
    s_nop 1
    v_mfma_f32_16x16x32_bf16 v[32:35], v[44:47], v[148:151], 0
    s_nop 7
    s_setpc_b64 s[70:71]
mega_kernel_rs1460:
    s_nop 15
    v_max3_f32 v48, v96, v97, v98
    v_max3_f32 v48, v48, v99, v100
    v_max3_f32 v48, v48, v101, v102
    v_max3_f32 v48, v48, v103, 0
    v_mov_b32 v49, v48
    s_nop 1
    v_permlane32_swap_b32 v48, v49
    s_nop 1
    v_max_f32 v48, v48, v49
    v_mov_b32 v49, v48
    s_nop 1
    v_permlane16_swap_b32 v48, v49
    s_nop 1
    v_max_f32 v48, v48, v49
    v_exp_f32 v49, -v48
    v_sub_f32 v96, v96, v48
    v_sub_f32 v97, v97, v48
    v_sub_f32 v98, v98, v48
    v_sub_f32 v99, v99, v48
    v_sub_f32 v100, v100, v48
    v_sub_f32 v101, v101, v48
    v_sub_f32 v102, v102, v48
    v_sub_f32 v103, v103, v48
    v_sub_f32 v64, v64, v48
    v_sub_f32 v65, v65, v48
    v_sub_f32 v66, v66, v48
    v_sub_f32 v67, v67, v48
    v_sub_f32 v68, v68, v48
    v_sub_f32 v69, v69, v48
    v_sub_f32 v70, v70, v48
    v_sub_f32 v71, v71, v48
    v_sub_f32 v160, v160, v48
    v_sub_f32 v161, v161, v48
    v_sub_f32 v162, v162, v48
    v_sub_f32 v163, v163, v48
    v_sub_f32 v164, v164, v48
    v_sub_f32 v165, v165, v48
    v_sub_f32 v166, v166, v48
    v_sub_f32 v167, v167, v48
    v_mul_f32 v12, v12, v49
    v_accvgpr_read_b32 v52, a0
    v_accvgpr_read_b32 v53, a1
    v_accvgpr_read_b32 v54, a2
    v_accvgpr_read_b32 v55, a3
    v_accvgpr_read_b32 v56, a4
    v_accvgpr_read_b32 v57, a5
    v_accvgpr_read_b32 v58, a6
    v_accvgpr_read_b32 v59, a7
    v_mul_f32 v52, v52, v49
    v_mul_f32 v53, v53, v49
    v_mul_f32 v54, v54, v49
    v_mul_f32 v55, v55, v49
    v_mul_f32 v56, v56, v49
    v_mul_f32 v57, v57, v49
    v_mul_f32 v58, v58, v49
    v_mul_f32 v59, v59, v49
    v_accvgpr_write_b32 a0, v52
    v_accvgpr_write_b32 a1, v53
    v_accvgpr_write_b32 a2, v54
    v_accvgpr_write_b32 a3, v55
    v_accvgpr_write_b32 a4, v56
    v_accvgpr_write_b32 a5, v57
    v_accvgpr_write_b32 a6, v58
    v_accvgpr_write_b32 a7, v59
    v_accvgpr_read_b32 v52, a8
    v_accvgpr_read_b32 v53, a9
    v_accvgpr_read_b32 v54, a10
    v_accvgpr_read_b32 v55, a11
    v_accvgpr_read_b32 v56, a12
    v_accvgpr_read_b32 v57, a13
    v_accvgpr_read_b32 v58, a14
    v_accvgpr_read_b32 v59, a15
    v_mul_f32 v52, v52, v49
    v_mul_f32 v53, v53, v49
    v_mul_f32 v54, v54, v49
    v_mul_f32 v55, v55, v49
    v_mul_f32 v56, v56, v49
    v_mul_f32 v57, v57, v49
    v_mul_f32 v58, v58, v49
    v_mul_f32 v59, v59, v49
    v_accvgpr_write_b32 a8, v52
    v_accvgpr_write_b32 a9, v53
    v_accvgpr_write_b32 a10, v54
    v_accvgpr_write_b32 a11, v55
    v_accvgpr_write_b32 a12, v56
    v_accvgpr_write_b32 a13, v57
    v_accvgpr_write_b32 a14, v58
    v_accvgpr_write_b32 a15, v59
    v_accvgpr_read_b32 v52, a16
    v_accvgpr_read_b32 v53, a17
    v_accvgpr_read_b32 v54, a18
    v_accvgpr_read_b32 v55, a19
    v_accvgpr_read_b32 v56, a20
    v_accvgpr_read_b32 v57, a21
    v_accvgpr_read_b32 v58, a22
    v_accvgpr_read_b32 v59, a23
    v_mul_f32 v52, v52, v49
    v_mul_f32 v53, v53, v49
    v_mul_f32 v54, v54, v49
    v_mul_f32 v55, v55, v49
    v_mul_f32 v56, v56, v49
    v_mul_f32 v57, v57, v49
    v_mul_f32 v58, v58, v49
    v_mul_f32 v59, v59, v49
    v_accvgpr_write_b32 a16, v52
    v_accvgpr_write_b32 a17, v53
    v_accvgpr_write_b32 a18, v54
    v_accvgpr_write_b32 a19, v55
    v_accvgpr_write_b32 a20, v56
    v_accvgpr_write_b32 a21, v57
    v_accvgpr_write_b32 a22, v58
    v_accvgpr_write_b32 a23, v59
    v_accvgpr_read_b32 v52, a24
    v_accvgpr_read_b32 v53, a25
    v_accvgpr_read_b32 v54, a26
    v_accvgpr_read_b32 v55, a27
    v_accvgpr_read_b32 v56, a28
    v_accvgpr_read_b32 v57, a29
    v_accvgpr_read_b32 v58, a30
    v_accvgpr_read_b32 v59, a31
    v_mul_f32 v52, v52, v49
    v_mul_f32 v53, v53, v49
    v_mul_f32 v54, v54, v49
    v_mul_f32 v55, v55, v49
    v_mul_f32 v56, v56, v49
    v_mul_f32 v57, v57, v49
    v_mul_f32 v58, v58, v49
    v_mul_f32 v59, v59, v49
    v_accvgpr_write_b32 a24, v52
    v_accvgpr_write_b32 a25, v53
    v_accvgpr_write_b32 a26, v54
    v_accvgpr_write_b32 a27, v55
    v_accvgpr_write_b32 a28, v56
    v_accvgpr_write_b32 a29, v57
    v_accvgpr_write_b32 a30, v58
    v_accvgpr_write_b32 a31, v59
    v_exp_f32 v52, v96
    v_exp_f32 v53, v97
    v_exp_f32 v54, v98
    v_exp_f32 v55, v99
    v_exp_f32 v56, v100
    v_exp_f32 v57, v101
    v_exp_f32 v58, v102
    v_exp_f32 v59, v103
    s_nop 0
    v_cvt_pk_bf16_f32 v144, v52, v53
    v_cvt_pk_bf16_f32 v145, v54, v55
    v_cvt_pk_bf16_f32 v146, v56, v57
    v_cvt_pk_bf16_f32 v147, v58, v59
    s_nop 1
    v_mfma_f32_16x16x32_bf16 v[28:31], v[44:47], v[144:147], 0
    v_max3_f32 v48, v104, v105, v106
    v_max3_f32 v48, v48, v107, v108
    v_max3_f32 v48, v48, v109, v110
    v_max3_f32 v48, v48, v111, 0
    v_mov_b32 v49, v48
    s_nop 1
    v_permlane32_swap_b32 v48, v49
    s_nop 1
    v_max_f32 v48, v48, v49
    v_mov_b32 v49, v48
    s_nop 1
    v_permlane16_swap_b32 v48, v49
    s_nop 1
    v_max_f32 v48, v48, v49
    v_exp_f32 v49, -v48
    v_sub_f32 v104, v104, v48
    v_sub_f32 v105, v105, v48
    v_sub_f32 v106, v106, v48
    v_sub_f32 v107, v107, v48
    v_sub_f32 v108, v108, v48
    v_sub_f32 v109, v109, v48
    v_sub_f32 v110, v110, v48
    v_sub_f32 v111, v111, v48
    v_sub_f32 v72, v72, v48
    v_sub_f32 v73, v73, v48
    v_sub_f32 v74, v74, v48
    v_sub_f32 v75, v75, v48
    v_sub_f32 v76, v76, v48
    v_sub_f32 v77, v77, v48
    v_sub_f32 v78, v78, v48
    v_sub_f32 v79, v79, v48
    v_sub_f32 v168, v168, v48
    v_sub_f32 v169, v169, v48
    v_sub_f32 v170, v170, v48
    v_sub_f32 v171, v171, v48
    v_sub_f32 v172, v172, v48
    v_sub_f32 v173, v173, v48
    v_sub_f32 v174, v174, v48
    v_sub_f32 v175, v175, v48
    v_mul_f32 v13, v13, v49
    v_accvgpr_read_b32 v52, a32
    v_accvgpr_read_b32 v53, a33
    v_accvgpr_read_b32 v54, a34
    v_accvgpr_read_b32 v55, a35
    v_accvgpr_read_b32 v56, a36
    v_accvgpr_read_b32 v57, a37
    v_accvgpr_read_b32 v58, a38
    v_accvgpr_read_b32 v59, a39
    v_mul_f32 v52, v52, v49
    v_mul_f32 v53, v53, v49
    v_mul_f32 v54, v54, v49
    v_mul_f32 v55, v55, v49
    v_mul_f32 v56, v56, v49
    v_mul_f32 v57, v57, v49
    v_mul_f32 v58, v58, v49
    v_mul_f32 v59, v59, v49
    v_accvgpr_write_b32 a32, v52
    v_accvgpr_write_b32 a33, v53
    v_accvgpr_write_b32 a34, v54
    v_accvgpr_write_b32 a35, v55
    v_accvgpr_write_b32 a36, v56
    v_accvgpr_write_b32 a37, v57
    v_accvgpr_write_b32 a38, v58
    v_accvgpr_write_b32 a39, v59
    v_accvgpr_read_b32 v52, a40
    v_accvgpr_read_b32 v53, a41
    v_accvgpr_read_b32 v54, a42
    v_accvgpr_read_b32 v55, a43
    v_accvgpr_read_b32 v56, a44
    v_accvgpr_read_b32 v57, a45
    v_accvgpr_read_b32 v58, a46
    v_accvgpr_read_b32 v59, a47
    v_mul_f32 v52, v52, v49
    v_mul_f32 v53, v53, v49
    v_mul_f32 v54, v54, v49
    v_mul_f32 v55, v55, v49
    v_mul_f32 v56, v56, v49
    v_mul_f32 v57, v57, v49
    v_mul_f32 v58, v58, v49
    v_mul_f32 v59, v59, v49
    v_accvgpr_write_b32 a40, v52
    v_accvgpr_write_b32 a41, v53
    v_accvgpr_write_b32 a42, v54
    v_accvgpr_write_b32 a43, v55
    v_accvgpr_write_b32 a44, v56
    v_accvgpr_write_b32 a45, v57
    v_accvgpr_write_b32 a46, v58
    v_accvgpr_write_b32 a47, v59
    v_accvgpr_read_b32 v52, a48
    v_accvgpr_read_b32 v53, a49
    v_accvgpr_read_b32 v54, a50
    v_accvgpr_read_b32 v55, a51
    v_accvgpr_read_b32 v56, a52
    v_accvgpr_read_b32 v57, a53
    v_accvgpr_read_b32 v58, a54
    v_accvgpr_read_b32 v59, a55
    v_mul_f32 v52, v52, v49
    v_mul_f32 v53, v53, v49
    v_mul_f32 v54, v54, v49
    v_mul_f32 v55, v55, v49
    v_mul_f32 v56, v56, v49
    v_mul_f32 v57, v57, v49
    v_mul_f32 v58, v58, v49
    v_mul_f32 v59, v59, v49
    v_accvgpr_write_b32 a48, v52
    v_accvgpr_write_b32 a49, v53
    v_accvgpr_write_b32 a50, v54
    v_accvgpr_write_b32 a51, v55
    v_accvgpr_write_b32 a52, v56
    v_accvgpr_write_b32 a53, v57
    v_accvgpr_write_b32 a54, v58
    v_accvgpr_write_b32 a55, v59
    v_accvgpr_read_b32 v52, a56
    v_accvgpr_read_b32 v53, a57
    v_accvgpr_read_b32 v54, a58
    v_accvgpr_read_b32 v55, a59
    v_accvgpr_read_b32 v56, a60
    v_accvgpr_read_b32 v57, a61
    v_accvgpr_read_b32 v58, a62
    v_accvgpr_read_b32 v59, a63
    v_mul_f32 v52, v52, v49
    v_mul_f32 v53, v53, v49
    v_mul_f32 v54, v54, v49
    v_mul_f32 v55, v55, v49
    v_mul_f32 v56, v56, v49
    v_mul_f32 v57, v57, v49
    v_mul_f32 v58, v58, v49
    v_mul_f32 v59, v59, v49
    v_accvgpr_write_b32 a56, v52
    v_accvgpr_write_b32 a57, v53
    v_accvgpr_write_b32 a58, v54
    v_accvgpr_write_b32 a59, v55
    v_accvgpr_write_b32 a60, v56
    v_accvgpr_write_b32 a61, v57
    v_accvgpr_write_b32 a62, v58
    v_accvgpr_write_b32 a63, v59
    v_exp_f32 v52, v104
    v_exp_f32 v53, v105
    v_exp_f32 v54, v106
    v_exp_f32 v55, v107
    v_exp_f32 v56, v108
    v_exp_f32 v57, v109
    v_exp_f32 v58, v110
    v_exp_f32 v59, v111
    s_nop 0
    v_cvt_pk_bf16_f32 v148, v52, v53
    v_cvt_pk_bf16_f32 v149, v54, v55
    v_cvt_pk_bf16_f32 v150, v56, v57
    v_cvt_pk_bf16_f32 v151, v58, v59
    s_nop 1
    v_mfma_f32_16x16x32_bf16 v[32:35], v[44:47], v[148:151], 0
    v_max3_f32 v48, v112, v113, v114
    v_max3_f32 v48, v48, v115, v116
    v_max3_f32 v48, v48, v117, v118
    v_max3_f32 v48, v48, v119, 0
    v_mov_b32 v49, v48
    s_nop 1
    v_permlane32_swap_b32 v48, v49
    s_nop 1
    v_max_f32 v48, v48, v49
    v_mov_b32 v49, v48
    s_nop 1
    v_permlane16_swap_b32 v48, v49
    s_nop 1
    v_max_f32 v48, v48, v49
    v_exp_f32 v49, -v48
    v_sub_f32 v112, v112, v48
    v_sub_f32 v113, v113, v48
    v_sub_f32 v114, v114, v48
    v_sub_f32 v115, v115, v48
    v_sub_f32 v116, v116, v48
    v_sub_f32 v117, v117, v48
    v_sub_f32 v118, v118, v48
    v_sub_f32 v119, v119, v48
    v_sub_f32 v80, v80, v48
    v_sub_f32 v81, v81, v48
    v_sub_f32 v82, v82, v48
    v_sub_f32 v83, v83, v48
    v_sub_f32 v84, v84, v48
    v_sub_f32 v85, v85, v48
    v_sub_f32 v86, v86, v48
    v_sub_f32 v87, v87, v48
    v_sub_f32 v176, v176, v48
    v_sub_f32 v177, v177, v48
    v_sub_f32 v178, v178, v48
    v_sub_f32 v179, v179, v48
    v_sub_f32 v180, v180, v48
    v_sub_f32 v181, v181, v48
    v_sub_f32 v182, v182, v48
    v_sub_f32 v183, v183, v48
    v_mul_f32 v14, v14, v49
    v_accvgpr_read_b32 v52, a64
    v_accvgpr_read_b32 v53, a65
    v_accvgpr_read_b32 v54, a66
    v_accvgpr_read_b32 v55, a67
    v_accvgpr_read_b32 v56, a68
    v_accvgpr_read_b32 v57, a69
    v_accvgpr_read_b32 v58, a70
    v_accvgpr_read_b32 v59, a71
    v_mul_f32 v52, v52, v49
    v_mul_f32 v53, v53, v49
    v_mul_f32 v54, v54, v49
    v_mul_f32 v55, v55, v49
    v_mul_f32 v56, v56, v49
    v_mul_f32 v57, v57, v49
    v_mul_f32 v58, v58, v49
    v_mul_f32 v59, v59, v49
    v_accvgpr_write_b32 a64, v52
    v_accvgpr_write_b32 a65, v53
    v_accvgpr_write_b32 a66, v54
    v_accvgpr_write_b32 a67, v55
    v_accvgpr_write_b32 a68, v56
    v_accvgpr_write_b32 a69, v57
    v_accvgpr_write_b32 a70, v58
    v_accvgpr_write_b32 a71, v59
    v_accvgpr_read_b32 v52, a72
    v_accvgpr_read_b32 v53, a73
    v_accvgpr_read_b32 v54, a74
    v_accvgpr_read_b32 v55, a75
    v_accvgpr_read_b32 v56, a76
    v_accvgpr_read_b32 v57, a77
    v_accvgpr_read_b32 v58, a78
    v_accvgpr_read_b32 v59, a79
    v_mul_f32 v52, v52, v49
    v_mul_f32 v53, v53, v49
    v_mul_f32 v54, v54, v49
    v_mul_f32 v55, v55, v49
    v_mul_f32 v56, v56, v49
    v_mul_f32 v57, v57, v49
    v_mul_f32 v58, v58, v49
    v_mul_f32 v59, v59, v49
    v_accvgpr_write_b32 a72, v52
    v_accvgpr_write_b32 a73, v53
    v_accvgpr_write_b32 a74, v54
    v_accvgpr_write_b32 a75, v55
    v_accvgpr_write_b32 a76, v56
    v_accvgpr_write_b32 a77, v57
    v_accvgpr_write_b32 a78, v58
    v_accvgpr_write_b32 a79, v59
    v_accvgpr_read_b32 v52, a80
    v_accvgpr_read_b32 v53, a81
    v_accvgpr_read_b32 v54, a82
    v_accvgpr_read_b32 v55, a83
    v_accvgpr_read_b32 v56, a84
    v_accvgpr_read_b32 v57, a85
    v_accvgpr_read_b32 v58, a86
    v_accvgpr_read_b32 v59, a87
    v_mul_f32 v52, v52, v49
    v_mul_f32 v53, v53, v49
    v_mul_f32 v54, v54, v49
    v_mul_f32 v55, v55, v49
    v_mul_f32 v56, v56, v49
    v_mul_f32 v57, v57, v49
    v_mul_f32 v58, v58, v49
    v_mul_f32 v59, v59, v49
    v_accvgpr_write_b32 a80, v52
    v_accvgpr_write_b32 a81, v53
    v_accvgpr_write_b32 a82, v54
    v_accvgpr_write_b32 a83, v55
    v_accvgpr_write_b32 a84, v56
    v_accvgpr_write_b32 a85, v57
    v_accvgpr_write_b32 a86, v58
    v_accvgpr_write_b32 a87, v59
    v_accvgpr_read_b32 v52, a88
    v_accvgpr_read_b32 v53, a89
    v_accvgpr_read_b32 v54, a90
    v_accvgpr_read_b32 v55, a91
    v_accvgpr_read_b32 v56, a92
    v_accvgpr_read_b32 v57, a93
    v_accvgpr_read_b32 v58, a94
    v_accvgpr_read_b32 v59, a95
    v_mul_f32 v52, v52, v49
    v_mul_f32 v53, v53, v49
    v_mul_f32 v54, v54, v49
    v_mul_f32 v55, v55, v49
    v_mul_f32 v56, v56, v49
    v_mul_f32 v57, v57, v49
    v_mul_f32 v58, v58, v49
    v_mul_f32 v59, v59, v49
    v_accvgpr_write_b32 a88, v52
    v_accvgpr_write_b32 a89, v53
    v_accvgpr_write_b32 a90, v54
    v_accvgpr_write_b32 a91, v55
    v_accvgpr_write_b32 a92, v56
    v_accvgpr_write_b32 a93, v57
    v_accvgpr_write_b32 a94, v58
    v_accvgpr_write_b32 a95, v59
    v_exp_f32 v52, v112
    v_exp_f32 v53, v113
    v_exp_f32 v54, v114
    v_exp_f32 v55, v115
    v_exp_f32 v56, v116
    v_exp_f32 v57, v117
    v_exp_f32 v58, v118
    v_exp_f32 v59, v119
    s_nop 0
    v_cvt_pk_bf16_f32 v152, v52, v53
    v_cvt_pk_bf16_f32 v153, v54, v55
    v_cvt_pk_bf16_f32 v154, v56, v57
    v_cvt_pk_bf16_f32 v155, v58, v59
    s_nop 1
    v_mfma_f32_16x16x32_bf16 v[36:39], v[44:47], v[152:155], 0
    v_max3_f32 v48, v120, v121, v122
    v_max3_f32 v48, v48, v123, v124
    v_max3_f32 v48, v48, v125, v126
    v_max3_f32 v48, v48, v127, 0
    v_mov_b32 v49, v48
    s_nop 1
    v_permlane32_swap_b32 v48, v49
    s_nop 1
    v_max_f32 v48, v48, v49
    v_mov_b32 v49, v48
    s_nop 1
    v_permlane16_swap_b32 v48, v49
    s_nop 1
    v_max_f32 v48, v48, v49
    v_exp_f32 v49, -v48
    v_sub_f32 v120, v120, v48
    v_sub_f32 v121, v121, v48
    v_sub_f32 v122, v122, v48
    v_sub_f32 v123, v123, v48
    v_sub_f32 v124, v124, v48
    v_sub_f32 v125, v125, v48
    v_sub_f32 v126, v126, v48
    v_sub_f32 v127, v127, v48
    v_sub_f32 v88, v88, v48
    v_sub_f32 v89, v89, v48
    v_sub_f32 v90, v90, v48
    v_sub_f32 v91, v91, v48
    v_sub_f32 v92, v92, v48
    v_sub_f32 v93, v93, v48
    v_sub_f32 v94, v94, v48
    v_sub_f32 v95, v95, v48
    v_sub_f32 v184, v184, v48
    v_sub_f32 v185, v185, v48
    v_sub_f32 v186, v186, v48
    v_sub_f32 v187, v187, v48
    v_sub_f32 v188, v188, v48
    v_sub_f32 v189, v189, v48
    v_sub_f32 v190, v190, v48
    v_sub_f32 v191, v191, v48
    v_mul_f32 v15, v15, v49
    v_accvgpr_read_b32 v52, a96
    v_accvgpr_read_b32 v53, a97
    v_accvgpr_read_b32 v54, a98
    v_accvgpr_read_b32 v55, a99
    v_accvgpr_read_b32 v56, a100
    v_accvgpr_read_b32 v57, a101
    v_accvgpr_read_b32 v58, a102
    v_accvgpr_read_b32 v59, a103
    v_mul_f32 v52, v52, v49
    v_mul_f32 v53, v53, v49
    v_mul_f32 v54, v54, v49
    v_mul_f32 v55, v55, v49
    v_mul_f32 v56, v56, v49
    v_mul_f32 v57, v57, v49
    v_mul_f32 v58, v58, v49
    v_mul_f32 v59, v59, v49
    v_accvgpr_write_b32 a96, v52
    v_accvgpr_write_b32 a97, v53
    v_accvgpr_write_b32 a98, v54
    v_accvgpr_write_b32 a99, v55
    v_accvgpr_write_b32 a100, v56
    v_accvgpr_write_b32 a101, v57
    v_accvgpr_write_b32 a102, v58
    v_accvgpr_write_b32 a103, v59
    v_accvgpr_read_b32 v52, a104
    v_accvgpr_read_b32 v53, a105
    v_accvgpr_read_b32 v54, a106
    v_accvgpr_read_b32 v55, a107
    v_accvgpr_read_b32 v56, a108
    v_accvgpr_read_b32 v57, a109
    v_accvgpr_read_b32 v58, a110
    v_accvgpr_read_b32 v59, a111
    v_mul_f32 v52, v52, v49
    v_mul_f32 v53, v53, v49
    v_mul_f32 v54, v54, v49
    v_mul_f32 v55, v55, v49
    v_mul_f32 v56, v56, v49
    v_mul_f32 v57, v57, v49
    v_mul_f32 v58, v58, v49
    v_mul_f32 v59, v59, v49
    v_accvgpr_write_b32 a104, v52
    v_accvgpr_write_b32 a105, v53
    v_accvgpr_write_b32 a106, v54
    v_accvgpr_write_b32 a107, v55
    v_accvgpr_write_b32 a108, v56
    v_accvgpr_write_b32 a109, v57
    v_accvgpr_write_b32 a110, v58
    v_accvgpr_write_b32 a111, v59
    v_accvgpr_read_b32 v52, a112
    v_accvgpr_read_b32 v53, a113
    v_accvgpr_read_b32 v54, a114
    v_accvgpr_read_b32 v55, a115
    v_accvgpr_read_b32 v56, a116
    v_accvgpr_read_b32 v57, a117
    v_accvgpr_read_b32 v58, a118
    v_accvgpr_read_b32 v59, a119
    v_mul_f32 v52, v52, v49
    v_mul_f32 v53, v53, v49
    v_mul_f32 v54, v54, v49
    v_mul_f32 v55, v55, v49
    v_mul_f32 v56, v56, v49
    v_mul_f32 v57, v57, v49
    v_mul_f32 v58, v58, v49
    v_mul_f32 v59, v59, v49
    v_accvgpr_write_b32 a112, v52
    v_accvgpr_write_b32 a113, v53
    v_accvgpr_write_b32 a114, v54
    v_accvgpr_write_b32 a115, v55
    v_accvgpr_write_b32 a116, v56
    v_accvgpr_write_b32 a117, v57
    v_accvgpr_write_b32 a118, v58
    v_accvgpr_write_b32 a119, v59
    v_accvgpr_read_b32 v52, a120
    v_accvgpr_read_b32 v53, a121
    v_accvgpr_read_b32 v54, a122
    v_accvgpr_read_b32 v55, a123
    v_accvgpr_read_b32 v56, a124
    v_accvgpr_read_b32 v57, a125
    v_accvgpr_read_b32 v58, a126
    v_accvgpr_read_b32 v59, a127
    v_mul_f32 v52, v52, v49
    v_mul_f32 v53, v53, v49
    v_mul_f32 v54, v54, v49
    v_mul_f32 v55, v55, v49
    v_mul_f32 v56, v56, v49
    v_mul_f32 v57, v57, v49
    v_mul_f32 v58, v58, v49
    v_mul_f32 v59, v59, v49
    v_accvgpr_write_b32 a120, v52
    v_accvgpr_write_b32 a121, v53
    v_accvgpr_write_b32 a122, v54
    v_accvgpr_write_b32 a123, v55
    v_accvgpr_write_b32 a124, v56
    v_accvgpr_write_b32 a125, v57
    v_accvgpr_write_b32 a126, v58
    v_accvgpr_write_b32 a127, v59
    v_exp_f32 v52, v120
    v_exp_f32 v53, v121
    v_exp_f32 v54, v122
    v_exp_f32 v55, v123
    v_exp_f32 v56, v124
    v_exp_f32 v57, v125
    v_exp_f32 v58, v126
    v_exp_f32 v59, v127
    s_nop 0
    v_cvt_pk_bf16_f32 v156, v52, v53
    v_cvt_pk_bf16_f32 v157, v54, v55
    v_cvt_pk_bf16_f32 v158, v56, v57
    v_cvt_pk_bf16_f32 v159, v58, v59
    s_nop 1
    v_mfma_f32_16x16x32_bf16 v[40:43], v[44:47], v[156:159], 0
    s_nop 7
    s_setpc_b64 s[70:71]
mega_kernel_dosw14:
    s_cmp_eq_u32 s17, -1
    s_cbranch_scc1 mega_kernel_x31
    s_cmp_lg_u32 s16, 0
    s_cbranch_scc1 mega_kernel_np36
    v_mov_b32 v4, s4
    v_mov_b32 v5, s5
    s_add_u32 s90, s17, 117440512
    s_mov_b64 exec, 1
    buffer_store_dwordx2 v[4:5], off, s[8:11], s90 sc1
    s_mov_b64 exec, -1
mega_kernel_np36:
    s_mov_b32 s17, -1
    s_mov_b32 s67, 3
    s_cmp_gt_u32 s65, 3
    s_cbranch_scc1 mega_kernel_loop13
mega_kernel_x31:
    s_cmp_eq_u32 s94, 0
    s_cbranch_scc1 mega_kernel_x32
    s_mov_b32 s42, s73
    s_mov_b32 s46, s76
    s_lshl_b32 s90, s77, 4
    s_lshl_b32 s90, s90, s81
    s_mov_b32 s48, s79
    s_mul_i32 s91, s90, 1
    s_add_u32 s49, s91, s79
    s_sub_u32 s49, s49, 2048
    s_mul_i32 s91, s90, 2
    s_add_u32 s50, s91, s79
    s_mul_i32 s91, s90, 3
    s_add_u32 s51, s91, s79
    s_sub_u32 s51, s51, 2048
    s_mov_b32 s52, s80
    s_lshl_b32 s90, s78, 2
    s_mul_i32 s91, s90, 1
    s_add_u32 s53, s91, s80
    s_sub_u32 s53, s53, 2048
    s_mul_i32 s91, s90, 2
    s_add_u32 s54, s91, s80
    s_mul_i32 s91, s90, 3
    s_add_u32 s55, s91, s80
    s_sub_u32 s55, s55, 2048
    s_lshl_b32 s56, s78, 6
    s_lshl_b32 s90, s58, 7
    s_add_u32 s90, s90, s57
    s_lshl_b32 s91, s16, 6
    s_cmp_eq_u32 s81, 1
    s_cselect_b32 s90, s90, s91
    v_lshrrev_b32 v24, 3, v1
    v_lshlrev_b32 v24, s81, v24
    v_add_u32 v24, s90, v24
    v_mul_lo_u32 v24, v24, s77
    v_lshrrev_b32 v25, 4, v1
    v_and_b32 v26, 7, v1
    v_xor_b32 v25, v25, v26
    v_lshl_add_u32 v16, v25, 4, v24
    v_xor_b32 v25, 4, v25
    v_lshl_add_u32 v17, v25, 4, v24
    s_lshl_b32 s90, s77, 3
    s_lshl_b32 s90, s90, s81
    s_sub_u32 s90, s90, 1024
    v_add_u32 v17, s90, v17
    v_lshrrev_b32 v24, 5, v1
    s_lshl_b32 s90, s16, 4
    v_add_u32 v25, s90, v24
    v_mul_lo_u32 v25, v25, s78
    v_lshlrev_b32 v24, 1, v24
    v_and_b32 v26, 31, v1
    v_xor_b32 v24, v24, v26
    s_lshl_b32 s90, s78, 1
    s_sub_u32 s90, s90, 1024
    v_add_u32 v27, s90, v25
    v_xor_b32 v26, 0, v24
    v_lshl_add_u32 v18, v26, 4, v25
    v_xor_b32 v26, 4, v24
    v_lshl_add_u32 v19, v26, 4, v27
    v_xor_b32 v26, 8, v24
    v_lshl_add_u32 v20, v26, 4, v25
    v_xor_b32 v26, 12, v24
    v_lshl_add_u32 v21, v26, 4, v27
    s_mov_b32 s40, s71
    s_mov_b32 s41, s72
    s_mov_b32 s44, s74
    s_mov_b32 s45, s75
    buffer_load_dwordx2 v[4:5], off, s[12:15], 0 sc1
    s_mov_b32 s67, 0
    s_branch mega_kernel_loop13
mega_kernel_x32:
    s_cmp_eq_u32 s70, 1
    s_cbranch_scc1 mega_kernel_x35
    s_cmp_lg_u32 s65, 3
    s_cbranch_scc1 mega_kernel_x33
    s_and_b32 s92, s2, 7
    s_lshl_b32 s92, s92, 2
    s_bfe_u32 s93, s2, 0x20003
    s_add_u32 s92, s92, s93
    s_lshr_b32 s93, s2, 5
    s_lshl_b32 s93, s93, 2
    s_or_b32 s93, s93, 0x40000
    s_lshr_b32 s90, s92, 1
    s_lshl_b32 s90, s90, 7
    s_add_u32 s90, s90, 117440512
    v_min_u32 v0, 7, v1
    v_add_u32 v0, 8, v0
    v_lshlrev_b32 v0, 3, v0
    buffer_load_dwordx2 v[4:5], v0, s[8:11], s90 offen sc1
    s_branch mega_kernel_loop13
mega_kernel_x33:
    s_waitcnt vmcnt(16)
    s_cmp_lg_u32 s65, 2
    s_cbranch_scc1 mega_kernel_x34
    s_mov_b32 s3, 1048576
mega_kernel_spin37:
    v_cmp_ne_u64 s[22:23], s[4:5], v[4:5]
    s_nop 3
    s_cmp_eq_u64 s[22:23], 0
    s_cbranch_scc1 mega_kernel_ok38
    s_sub_u32 s3, s3, 1
    s_cbranch_scc1 mega_kernel_ok38
    s_sleep 16
    s_and_b32 s92, s2, 7
    s_lshl_b32 s92, s92, 2
    s_bfe_u32 s93, s2, 0x20003
    s_add_u32 s92, s92, s93
    s_lshr_b32 s93, s2, 5
    s_lshl_b32 s93, s93, 2
    s_or_b32 s93, s93, 0x40000
    s_lshr_b32 s90, s92, 1
    s_lshl_b32 s90, s90, 7
    s_add_u32 s90, s90, 117440512
    v_min_u32 v0, 7, v1
    v_add_u32 v0, 8, v0
    v_lshlrev_b32 v0, 3, v0
    buffer_load_dwordx2 v[4:5], v0, s[8:11], s90 offen sc1
    s_waitcnt vmcnt(0)
    s_branch mega_kernel_spin37
mega_kernel_ok38:
    s_and_b32 s92, s2, 7
    s_lshl_b32 s92, s92, 2
    s_bfe_u32 s93, s2, 0x20003
    s_add_u32 s92, s92, s93
    s_lshr_b32 s93, s2, 5
    s_lshl_b32 s93, s93, 2
    s_or_b32 s93, s93, 0x40000
    s_lshr_b32 s90, s92, 1
    s_lshl_b32 s90, s90, 7
    s_add_u32 s90, s90, 117440512
    s_bfe_u32 s91, 1108370803, s93
    s_lshr_b32 s91, s91, 1
    v_mov_b32 v0, s91
    s_bfe_u32 s91, 4242446987, s93
    s_lshr_b32 s91, s91, 1
    v_writelane_b32 v0, s91, 8
    v_lshlrev_b32 v0, 3, v0
    buffer_load_dwordx2 v[4:5], v0, s[8:11], s90 offen sc1
    s_lshl_b32 s90, s92, 19
    s_lshl_b32 s91, s58, 13
    s_add_u32 s90, s90, s91
    s_cmp_eq_u32 s57, 0
    s_mov_b32 s91, 33554432
    s_cselect_b32 s91, 16777216, s91
    s_mov_b32 s42, 0
    s_cselect_b32 s42, 268435456, s42
    s_add_u32 s48, s90, s91
    s_mov_b32 s49, s48
    s_add_u32 s50, s48, 4096
    s_mov_b32 s51, s50
    s_mov_b32 s40, s6
    s_mov_b32 s41, s7
    s_lshl_b32 s90, s92, 19
    s_lshl_b32 s91, s58, 13
    s_add_u32 s90, s90, s91
    s_cmp_eq_u32 s57, 0
    s_mov_b32 s91, 33587200
    s_cselect_b32 s91, 16826368, s91
    s_mov_b32 s46, 268435456
    s_cselect_b32 s46, 268435456, s46
    s_add_u32 s52, s90, s91
    s_mov_b32 s53, s52
    s_add_u32 s54, s52, 4096
    s_mov_b32 s55, s54
    s_mov_b32 s44, s6
    s_mov_b32 s45, s7
    v_mov_b32 v16, v2
    v_mov_b32 v17, v2
    v_mov_b32 v18, v2
    v_mov_b32 v19, v2
    v_mov_b32 v20, v2
    v_mov_b32 v21, v2
    s_branch mega_kernel_loop13
mega_kernel_x34:
    s_mov_b32 s3, 1048576
mega_kernel_spin39:
    v_cmp_ne_u64 s[22:23], s[4:5], v[4:5]
    s_nop 3
    s_cmp_eq_u64 s[22:23], 0
    s_cbranch_scc1 mega_kernel_ok40
    s_sub_u32 s3, s3, 1
    s_cbranch_scc1 mega_kernel_ok40
    s_sleep 16
    s_and_b32 s92, s2, 7
    s_lshl_b32 s92, s92, 2
    s_bfe_u32 s93, s2, 0x20003
    s_add_u32 s92, s92, s93
    s_lshr_b32 s93, s2, 5
    s_lshl_b32 s93, s93, 2
    s_or_b32 s93, s93, 0x40000
    s_lshr_b32 s90, s92, 1
    s_lshl_b32 s90, s90, 7
    s_add_u32 s90, s90, 117440512
    s_bfe_u32 s91, 1108370803, s93
    s_lshr_b32 s91, s91, 1
    v_mov_b32 v0, s91
    s_bfe_u32 s91, 4242446987, s93
    s_lshr_b32 s91, s91, 1
    v_writelane_b32 v0, s91, 8
    v_lshlrev_b32 v0, 3, v0
    buffer_load_dwordx2 v[4:5], v0, s[8:11], s90 offen sc1
    s_waitcnt vmcnt(0)
    s_branch mega_kernel_spin39
mega_kernel_ok40:
    s_and_b32 s92, s2, 7
    s_lshl_b32 s92, s92, 2
    s_bfe_u32 s93, s2, 0x20003
    s_add_u32 s92, s92, s93
    s_lshr_b32 s93, s2, 5
    s_lshl_b32 s93, s93, 2
    s_or_b32 s93, s93, 0x40000
    s_bfe_u32 s90, 4242446987, s93
    s_lshl_b32 s90, s90, 3
    s_lshl_b32 s91, s16, 1
    s_add_u32 s90, s90, s91
    s_lshl_b32 s90, s90, 12
    s_lshl_b32 s91, s92, 19
    s_add_u32 s90, s90, s91
    s_add_u32 s90, s90, 0
    buffer_load_dwordx4 a[128:131], v2, s[8:11], s90 offen offset:0 sc1
    buffer_load_dwordx4 a[132:135], v2, s[8:11], s90 offen offset:1024 sc1
    buffer_load_dwordx4 a[136:139], v2, s[8:11], s90 offen offset:2048 sc1
    buffer_load_dwordx4 a[140:143], v2, s[8:11], s90 offen offset:3072 sc1
    s_bfe_u32 s90, 4242446987, s93
    s_lshl_b32 s90, s90, 3
    s_lshl_b32 s91, s16, 1
    s_add_u32 s90, s90, s91
    s_lshl_b32 s90, s90, 12
    s_lshl_b32 s91, s92, 19
    s_add_u32 s90, s90, s91
    s_add_u32 s90, s90, 4096
    buffer_load_dwordx4 a[144:147], v2, s[8:11], s90 offen offset:0 sc1
    buffer_load_dwordx4 a[148:151], v2, s[8:11], s90 offen offset:1024 sc1
    buffer_load_dwordx4 a[152:155], v2, s[8:11], s90 offen offset:2048 sc1
    buffer_load_dwordx4 a[156:159], v2, s[8:11], s90 offen offset:3072 sc1
    s_bfe_u32 s90, 1108370803, s93
    s_lshl_b32 s90, s90, 3
    s_lshl_b32 s91, s16, 1
    s_add_u32 s90, s90, s91
    s_lshl_b32 s90, s90, 12
    s_lshl_b32 s91, s92, 19
    s_add_u32 s90, s90, s91
    s_add_u32 s90, s90, 0
    buffer_load_dwordx4 a[160:163], v2, s[8:11], s90 offen offset:0 sc1
    buffer_load_dwordx4 a[164:167], v2, s[8:11], s90 offen offset:1024 sc1
    buffer_load_dwordx4 a[168:171], v2, s[8:11], s90 offen offset:2048 sc1
    buffer_load_dwordx4 a[172:175], v2, s[8:11], s90 offen offset:3072 sc1
    s_bfe_u32 s90, 1108370803, s93
    s_lshl_b32 s90, s90, 3
    s_lshl_b32 s91, s16, 1
    s_add_u32 s90, s90, s91
    s_lshl_b32 s90, s90, 12
    s_lshl_b32 s91, s92, 19
    s_add_u32 s90, s90, s91
    s_add_u32 s90, s90, 4096
    buffer_load_dwordx4 a[176:179], v2, s[8:11], s90 offen offset:0 sc1
    buffer_load_dwordx4 a[180:183], v2, s[8:11], s90 offen offset:1024 sc1
    buffer_load_dwordx4 a[184:187], v2, s[8:11], s90 offen offset:2048 sc1
    buffer_load_dwordx4 a[188:191], v2, s[8:11], s90 offen offset:3072 sc1
    s_lshl_b32 s90, s92, 19
    s_lshl_b32 s91, s58, 13
    s_add_u32 s90, s90, s91
    s_cmp_eq_u32 s57, 0
    s_mov_b32 s91, 33554432
    s_cselect_b32 s91, 16793600, s91
    s_mov_b32 s42, 268435456
    s_cselect_b32 s42, 268435456, s42
    s_add_u32 s48, s90, s91
    s_mov_b32 s49, s48
    s_add_u32 s50, s48, 4096
    s_mov_b32 s51, s50
    s_mov_b32 s40, s6
    s_mov_b32 s41, s7
    s_mov_b32 s46, 0
    s_branch mega_kernel_loop13
mega_kernel_x35:
    s_mov_b32 s42, 0
    s_mov_b32 s46, 0
    s_branch mega_kernel_loop13
mega_kernel_dosw16:
    s_cmp_eq_u32 s17, -1
    s_cbranch_scc1 mega_kernel_x41
    s_cmp_lg_u32 s16, 0
    s_cbranch_scc1 mega_kernel_np46
    v_mov_b32 v4, s4
    v_mov_b32 v5, s5
    s_add_u32 s90, s17, 117440512
    s_mov_b64 exec, 1
    buffer_store_dwordx2 v[4:5], off, s[8:11], s90 sc1
    s_mov_b64 exec, -1
mega_kernel_np46:
    s_mov_b32 s17, -1
    s_mov_b32 s67, 3
    s_cmp_gt_u32 s65, 3
    s_cbranch_scc1 mega_kernel_loop15
mega_kernel_x41:
    s_cmp_eq_u32 s94, 0
    s_cbranch_scc1 mega_kernel_x42
    s_mov_b32 s42, s73
    s_mov_b32 s46, s76
    s_lshl_b32 s90, s77, 4
    s_lshl_b32 s90, s90, s81
    s_mov_b32 s48, s79
    s_mul_i32 s91, s90, 1
    s_add_u32 s49, s91, s79
    s_sub_u32 s49, s49, 2048
    s_mul_i32 s91, s90, 2
    s_add_u32 s50, s91, s79
    s_mul_i32 s91, s90, 3
    s_add_u32 s51, s91, s79
    s_sub_u32 s51, s51, 2048
    s_mov_b32 s52, s80
    s_lshl_b32 s90, s78, 2
    s_mul_i32 s91, s90, 1
    s_add_u32 s53, s91, s80
    s_sub_u32 s53, s53, 2048
    s_mul_i32 s91, s90, 2
    s_add_u32 s54, s91, s80
    s_mul_i32 s91, s90, 3
    s_add_u32 s55, s91, s80
    s_sub_u32 s55, s55, 2048
    s_lshl_b32 s56, s78, 6
    s_lshl_b32 s90, s58, 7
    s_add_u32 s90, s90, s57
    s_lshl_b32 s91, s16, 6
    s_cmp_eq_u32 s81, 1
    s_cselect_b32 s90, s90, s91
    v_lshrrev_b32 v24, 3, v1
    v_lshlrev_b32 v24, s81, v24
    v_add_u32 v24, s90, v24
    v_mul_lo_u32 v24, v24, s77
    v_lshrrev_b32 v25, 4, v1
    v_and_b32 v26, 7, v1
    v_xor_b32 v25, v25, v26
    v_lshl_add_u32 v16, v25, 4, v24
    v_xor_b32 v25, 4, v25
    v_lshl_add_u32 v17, v25, 4, v24
    s_lshl_b32 s90, s77, 3
    s_lshl_b32 s90, s90, s81
    s_sub_u32 s90, s90, 1024
    v_add_u32 v17, s90, v17
    v_lshrrev_b32 v24, 5, v1
    s_lshl_b32 s90, s16, 4
    v_add_u32 v25, s90, v24
    v_mul_lo_u32 v25, v25, s78
    v_lshlrev_b32 v24, 1, v24
    v_and_b32 v26, 31, v1
    v_xor_b32 v24, v24, v26
    s_lshl_b32 s90, s78, 1
    s_sub_u32 s90, s90, 1024
    v_add_u32 v27, s90, v25
    v_xor_b32 v26, 0, v24
    v_lshl_add_u32 v18, v26, 4, v25
    v_xor_b32 v26, 4, v24
    v_lshl_add_u32 v19, v26, 4, v27
    v_xor_b32 v26, 8, v24
    v_lshl_add_u32 v20, v26, 4, v25
    v_xor_b32 v26, 12, v24
    v_lshl_add_u32 v21, v26, 4, v27
    s_mov_b32 s40, s71
    s_mov_b32 s41, s72
    s_mov_b32 s44, s74
    s_mov_b32 s45, s75
    buffer_load_dwordx2 v[4:5], off, s[12:15], 0 sc1
    s_mov_b32 s67, 0
    s_branch mega_kernel_loop15
mega_kernel_x42:
    s_cmp_eq_u32 s70, 1
    s_cbranch_scc1 mega_kernel_x45
    s_cmp_lg_u32 s65, 3
    s_cbranch_scc1 mega_kernel_x43
    s_and_b32 s92, s2, 7
    s_lshl_b32 s92, s92, 2
    s_bfe_u32 s93, s2, 0x20003
    s_add_u32 s92, s92, s93
    s_lshr_b32 s93, s2, 5
    s_lshl_b32 s93, s93, 2
    s_or_b32 s93, s93, 0x40000
    s_lshr_b32 s90, s92, 1
    s_lshl_b32 s90, s90, 7
    s_add_u32 s90, s90, 117440512
    v_min_u32 v0, 7, v1
    v_add_u32 v0, 8, v0
    v_lshlrev_b32 v0, 3, v0
    buffer_load_dwordx2 v[4:5], v0, s[8:11], s90 offen sc1
    s_branch mega_kernel_loop15
mega_kernel_x43:
    s_waitcnt vmcnt(16)
    s_cmp_lg_u32 s65, 2
    s_cbranch_scc1 mega_kernel_x44
    s_mov_b32 s3, 1048576
mega_kernel_spin47:
    v_cmp_ne_u64 s[22:23], s[4:5], v[4:5]
    s_nop 3
    s_cmp_eq_u64 s[22:23], 0
    s_cbranch_scc1 mega_kernel_ok48
    s_sub_u32 s3, s3, 1
    s_cbranch_scc1 mega_kernel_ok48
    s_sleep 16
    s_and_b32 s92, s2, 7
    s_lshl_b32 s92, s92, 2
    s_bfe_u32 s93, s2, 0x20003
    s_add_u32 s92, s92, s93
    s_lshr_b32 s93, s2, 5
    s_lshl_b32 s93, s93, 2
    s_or_b32 s93, s93, 0x40000
    s_lshr_b32 s90, s92, 1
    s_lshl_b32 s90, s90, 7
    s_add_u32 s90, s90, 117440512
    v_min_u32 v0, 7, v1
    v_add_u32 v0, 8, v0
    v_lshlrev_b32 v0, 3, v0
    buffer_load_dwordx2 v[4:5], v0, s[8:11], s90 offen sc1
    s_waitcnt vmcnt(0)
    s_branch mega_kernel_spin47
mega_kernel_ok48:
    s_and_b32 s92, s2, 7
    s_lshl_b32 s92, s92, 2
    s_bfe_u32 s93, s2, 0x20003
    s_add_u32 s92, s92, s93
    s_lshr_b32 s93, s2, 5
    s_lshl_b32 s93, s93, 2
    s_or_b32 s93, s93, 0x40000
    s_lshr_b32 s90, s92, 1
    s_lshl_b32 s90, s90, 7
    s_add_u32 s90, s90, 117440512
    s_bfe_u32 s91, 1108370803, s93
    s_lshr_b32 s91, s91, 1
    v_mov_b32 v0, s91
    s_bfe_u32 s91, 4242446987, s93
    s_lshr_b32 s91, s91, 1
    v_writelane_b32 v0, s91, 8
    v_lshlrev_b32 v0, 3, v0
    buffer_load_dwordx2 v[4:5], v0, s[8:11], s90 offen sc1
    s_lshl_b32 s90, s92, 19
    s_lshl_b32 s91, s58, 13
    s_add_u32 s90, s90, s91
    s_cmp_eq_u32 s57, 0
    s_mov_b32 s91, 33554432
    s_cselect_b32 s91, 16777216, s91
    s_mov_b32 s42, 0
    s_cselect_b32 s42, 268435456, s42
    s_add_u32 s48, s90, s91
    s_mov_b32 s49, s48
    s_add_u32 s50, s48, 4096
    s_mov_b32 s51, s50
    s_mov_b32 s40, s6
    s_mov_b32 s41, s7
    s_lshl_b32 s90, s92, 19
    s_lshl_b32 s91, s58, 13
    s_add_u32 s90, s90, s91
    s_cmp_eq_u32 s57, 0
    s_mov_b32 s91, 33587200
    s_cselect_b32 s91, 16826368, s91
    s_mov_b32 s46, 268435456
    s_cselect_b32 s46, 268435456, s46
    s_add_u32 s52, s90, s91
    s_mov_b32 s53, s52
    s_add_u32 s54, s52, 4096
    s_mov_b32 s55, s54
    s_mov_b32 s44, s6
    s_mov_b32 s45, s7
    v_mov_b32 v16, v2
    v_mov_b32 v17, v2
    v_mov_b32 v18, v2
    v_mov_b32 v19, v2
    v_mov_b32 v20, v2
    v_mov_b32 v21, v2
    s_branch mega_kernel_loop15
mega_kernel_x44:
    s_mov_b32 s3, 1048576
mega_kernel_spin49:
    v_cmp_ne_u64 s[22:23], s[4:5], v[4:5]
    s_nop 3
    s_cmp_eq_u64 s[22:23], 0
    s_cbranch_scc1 mega_kernel_ok50
    s_sub_u32 s3, s3, 1
    s_cbranch_scc1 mega_kernel_ok50
    s_sleep 16
    s_and_b32 s92, s2, 7
    s_lshl_b32 s92, s92, 2
    s_bfe_u32 s93, s2, 0x20003
    s_add_u32 s92, s92, s93
    s_lshr_b32 s93, s2, 5
    s_lshl_b32 s93, s93, 2
    s_or_b32 s93, s93, 0x40000
    s_lshr_b32 s90, s92, 1
    s_lshl_b32 s90, s90, 7
    s_add_u32 s90, s90, 117440512
    s_bfe_u32 s91, 1108370803, s93
    s_lshr_b32 s91, s91, 1
    v_mov_b32 v0, s91
    s_bfe_u32 s91, 4242446987, s93
    s_lshr_b32 s91, s91, 1
    v_writelane_b32 v0, s91, 8
    v_lshlrev_b32 v0, 3, v0
    buffer_load_dwordx2 v[4:5], v0, s[8:11], s90 offen sc1
    s_waitcnt vmcnt(0)
    s_branch mega_kernel_spin49
mega_kernel_ok50:
    s_and_b32 s92, s2, 7
    s_lshl_b32 s92, s92, 2
    s_bfe_u32 s93, s2, 0x20003
    s_add_u32 s92, s92, s93
    s_lshr_b32 s93, s2, 5
    s_lshl_b32 s93, s93, 2
    s_or_b32 s93, s93, 0x40000
    s_bfe_u32 s90, 4242446987, s93
    s_lshl_b32 s90, s90, 3
    s_lshl_b32 s91, s16, 1
    s_add_u32 s90, s90, s91
    s_lshl_b32 s90, s90, 12
    s_lshl_b32 s91, s92, 19
    s_add_u32 s90, s90, s91
    s_add_u32 s90, s90, 0
    buffer_load_dwordx4 a[128:131], v2, s[8:11], s90 offen offset:0 sc1
    buffer_load_dwordx4 a[132:135], v2, s[8:11], s90 offen offset:1024 sc1
    buffer_load_dwordx4 a[136:139], v2, s[8:11], s90 offen offset:2048 sc1
    buffer_load_dwordx4 a[140:143], v2, s[8:11], s90 offen offset:3072 sc1
    s_bfe_u32 s90, 4242446987, s93
    s_lshl_b32 s90, s90, 3
    s_lshl_b32 s91, s16, 1
    s_add_u32 s90, s90, s91
    s_lshl_b32 s90, s90, 12
    s_lshl_b32 s91, s92, 19
    s_add_u32 s90, s90, s91
    s_add_u32 s90, s90, 4096
    buffer_load_dwordx4 a[144:147], v2, s[8:11], s90 offen offset:0 sc1
    buffer_load_dwordx4 a[148:151], v2, s[8:11], s90 offen offset:1024 sc1
    buffer_load_dwordx4 a[152:155], v2, s[8:11], s90 offen offset:2048 sc1
    buffer_load_dwordx4 a[156:159], v2, s[8:11], s90 offen offset:3072 sc1
    s_bfe_u32 s90, 1108370803, s93
    s_lshl_b32 s90, s90, 3
    s_lshl_b32 s91, s16, 1
    s_add_u32 s90, s90, s91
    s_lshl_b32 s90, s90, 12
    s_lshl_b32 s91, s92, 19
    s_add_u32 s90, s90, s91
    s_add_u32 s90, s90, 0
    buffer_load_dwordx4 a[160:163], v2, s[8:11], s90 offen offset:0 sc1
    buffer_load_dwordx4 a[164:167], v2, s[8:11], s90 offen offset:1024 sc1
    buffer_load_dwordx4 a[168:171], v2, s[8:11], s90 offen offset:2048 sc1
    buffer_load_dwordx4 a[172:175], v2, s[8:11], s90 offen offset:3072 sc1
    s_bfe_u32 s90, 1108370803, s93
    s_lshl_b32 s90, s90, 3
    s_lshl_b32 s91, s16, 1
    s_add_u32 s90, s90, s91
    s_lshl_b32 s90, s90, 12
    s_lshl_b32 s91, s92, 19
    s_add_u32 s90, s90, s91
    s_add_u32 s90, s90, 4096
    buffer_load_dwordx4 a[176:179], v2, s[8:11], s90 offen offset:0 sc1
    buffer_load_dwordx4 a[180:183], v2, s[8:11], s90 offen offset:1024 sc1
    buffer_load_dwordx4 a[184:187], v2, s[8:11], s90 offen offset:2048 sc1
    buffer_load_dwordx4 a[188:191], v2, s[8:11], s90 offen offset:3072 sc1
    s_lshl_b32 s90, s92, 19
    s_lshl_b32 s91, s58, 13
    s_add_u32 s90, s90, s91
    s_cmp_eq_u32 s57, 0
    s_mov_b32 s91, 33554432
    s_cselect_b32 s91, 16793600, s91
    s_mov_b32 s42, 268435456
    s_cselect_b32 s42, 268435456, s42
    s_add_u32 s48, s90, s91
    s_mov_b32 s49, s48
    s_add_u32 s50, s48, 4096
    s_mov_b32 s51, s50
    s_mov_b32 s40, s6
    s_mov_b32 s41, s7
    s_mov_b32 s46, 0
    s_branch mega_kernel_loop15
mega_kernel_x45:
    s_mov_b32 s42, 0
    s_mov_b32 s46, 0
    s_branch mega_kernel_loop15
mega_kernel_eps18:
    s_mov_b32 s92, s97
    s_mov_b32 s93, s97
    s_cmp_eq_u32 s97, 0
    s_cbranch_scc1 mega_kernel_ns351
    v_pk_mul_f32 v[32:33], v[32:33], s[92:93]
    v_pk_mul_f32 v[34:35], v[34:35], s[92:93]
    v_pk_mul_f32 v[36:37], v[36:37], s[92:93]
    v_pk_mul_f32 v[38:39], v[38:39], s[92:93]
    v_cvt_pk_bf16_f32 v32, v32, v33
    v_cvt_pk_bf16_f32 v33, v34, v35
    v_cvt_pk_bf16_f32 v34, v36, v37
    v_cvt_pk_bf16_f32 v35, v38, v39
    v_accvgpr_write_b32 a128, v32
    v_accvgpr_write_b32 a129, v33
    v_accvgpr_write_b32 a130, v34
    v_accvgpr_write_b32 a131, v35
    v_pk_mul_f32 v[40:41], v[40:41], s[92:93]
    v_pk_mul_f32 v[42:43], v[42:43], s[92:93]
    v_pk_mul_f32 v[44:45], v[44:45], s[92:93]
    v_pk_mul_f32 v[46:47], v[46:47], s[92:93]
    v_cvt_pk_bf16_f32 v40, v40, v41
    v_cvt_pk_bf16_f32 v41, v42, v43
    v_cvt_pk_bf16_f32 v42, v44, v45
    v_cvt_pk_bf16_f32 v43, v46, v47
    v_accvgpr_write_b32 a132, v40
    v_accvgpr_write_b32 a133, v41
    v_accvgpr_write_b32 a134, v42
    v_accvgpr_write_b32 a135, v43
    v_pk_mul_f32 v[48:49], v[48:49], s[92:93]
    v_pk_mul_f32 v[50:51], v[50:51], s[92:93]
    v_pk_mul_f32 v[52:53], v[52:53], s[92:93]
    v_pk_mul_f32 v[54:55], v[54:55], s[92:93]
    v_cvt_pk_bf16_f32 v48, v48, v49
    v_cvt_pk_bf16_f32 v49, v50, v51
    v_cvt_pk_bf16_f32 v50, v52, v53
    v_cvt_pk_bf16_f32 v51, v54, v55
    v_accvgpr_write_b32 a136, v48
    v_accvgpr_write_b32 a137, v49
    v_accvgpr_write_b32 a138, v50
    v_accvgpr_write_b32 a139, v51
    v_pk_mul_f32 v[56:57], v[56:57], s[92:93]
    v_pk_mul_f32 v[58:59], v[58:59], s[92:93]
    v_pk_mul_f32 v[60:61], v[60:61], s[92:93]
    v_pk_mul_f32 v[62:63], v[62:63], s[92:93]
    v_cvt_pk_bf16_f32 v56, v56, v57
    v_cvt_pk_bf16_f32 v57, v58, v59
    v_cvt_pk_bf16_f32 v58, v60, v61
    v_cvt_pk_bf16_f32 v59, v62, v63
    v_accvgpr_write_b32 a140, v56
    v_accvgpr_write_b32 a141, v57
    v_accvgpr_write_b32 a142, v58
    v_accvgpr_write_b32 a143, v59
    v_pk_mul_f32 v[64:65], v[64:65], s[92:93]
    v_pk_mul_f32 v[66:67], v[66:67], s[92:93]
    v_pk_mul_f32 v[68:69], v[68:69], s[92:93]
    v_pk_mul_f32 v[70:71], v[70:71], s[92:93]
    v_cvt_pk_bf16_f32 v64, v64, v65
    v_cvt_pk_bf16_f32 v65, v66, v67
    v_cvt_pk_bf16_f32 v66, v68, v69
    v_cvt_pk_bf16_f32 v67, v70, v71
    v_accvgpr_write_b32 a144, v64
    v_accvgpr_write_b32 a145, v65
    v_accvgpr_write_b32 a146, v66
    v_accvgpr_write_b32 a147, v67
    v_pk_mul_f32 v[72:73], v[72:73], s[92:93]
    v_pk_mul_f32 v[74:75], v[74:75], s[92:93]
    v_pk_mul_f32 v[76:77], v[76:77], s[92:93]
    v_pk_mul_f32 v[78:79], v[78:79], s[92:93]
    v_cvt_pk_bf16_f32 v72, v72, v73
    v_cvt_pk_bf16_f32 v73, v74, v75
    v_cvt_pk_bf16_f32 v74, v76, v77
    v_cvt_pk_bf16_f32 v75, v78, v79
    v_accvgpr_write_b32 a148, v72
    v_accvgpr_write_b32 a149, v73
    v_accvgpr_write_b32 a150, v74
    v_accvgpr_write_b32 a151, v75
    v_pk_mul_f32 v[80:81], v[80:81], s[92:93]
    v_pk_mul_f32 v[82:83], v[82:83], s[92:93]
    v_pk_mul_f32 v[84:85], v[84:85], s[92:93]
    v_pk_mul_f32 v[86:87], v[86:87], s[92:93]
    v_cvt_pk_bf16_f32 v80, v80, v81
    v_cvt_pk_bf16_f32 v81, v82, v83
    v_cvt_pk_bf16_f32 v82, v84, v85
    v_cvt_pk_bf16_f32 v83, v86, v87
    v_accvgpr_write_b32 a152, v80
    v_accvgpr_write_b32 a153, v81
    v_accvgpr_write_b32 a154, v82
    v_accvgpr_write_b32 a155, v83
    v_pk_mul_f32 v[88:89], v[88:89], s[92:93]
    v_pk_mul_f32 v[90:91], v[90:91], s[92:93]
    v_pk_mul_f32 v[92:93], v[92:93], s[92:93]
    v_pk_mul_f32 v[94:95], v[94:95], s[92:93]
    v_cvt_pk_bf16_f32 v88, v88, v89
    v_cvt_pk_bf16_f32 v89, v90, v91
    v_cvt_pk_bf16_f32 v90, v92, v93
    v_cvt_pk_bf16_f32 v91, v94, v95
    v_accvgpr_write_b32 a156, v88
    v_accvgpr_write_b32 a157, v89
    v_accvgpr_write_b32 a158, v90
    v_accvgpr_write_b32 a159, v91
    v_pk_mul_f32 v[96:97], v[96:97], s[92:93]
    v_pk_mul_f32 v[98:99], v[98:99], s[92:93]
    v_pk_mul_f32 v[100:101], v[100:101], s[92:93]
    v_pk_mul_f32 v[102:103], v[102:103], s[92:93]
    v_cvt_pk_bf16_f32 v96, v96, v97
    v_cvt_pk_bf16_f32 v97, v98, v99
    v_cvt_pk_bf16_f32 v98, v100, v101
    v_cvt_pk_bf16_f32 v99, v102, v103
    v_accvgpr_write_b32 a160, v96
    v_accvgpr_write_b32 a161, v97
    v_accvgpr_write_b32 a162, v98
    v_accvgpr_write_b32 a163, v99
    v_pk_mul_f32 v[104:105], v[104:105], s[92:93]
    v_pk_mul_f32 v[106:107], v[106:107], s[92:93]
    v_pk_mul_f32 v[108:109], v[108:109], s[92:93]
    v_pk_mul_f32 v[110:111], v[110:111], s[92:93]
    v_cvt_pk_bf16_f32 v104, v104, v105
    v_cvt_pk_bf16_f32 v105, v106, v107
    v_cvt_pk_bf16_f32 v106, v108, v109
    v_cvt_pk_bf16_f32 v107, v110, v111
    v_accvgpr_write_b32 a164, v104
    v_accvgpr_write_b32 a165, v105
    v_accvgpr_write_b32 a166, v106
    v_accvgpr_write_b32 a167, v107
    v_pk_mul_f32 v[112:113], v[112:113], s[92:93]
    v_pk_mul_f32 v[114:115], v[114:115], s[92:93]
    v_pk_mul_f32 v[116:117], v[116:117], s[92:93]
    v_pk_mul_f32 v[118:119], v[118:119], s[92:93]
    v_cvt_pk_bf16_f32 v112, v112, v113
    v_cvt_pk_bf16_f32 v113, v114, v115
    v_cvt_pk_bf16_f32 v114, v116, v117
    v_cvt_pk_bf16_f32 v115, v118, v119
    v_accvgpr_write_b32 a168, v112
    v_accvgpr_write_b32 a169, v113
    v_accvgpr_write_b32 a170, v114
    v_accvgpr_write_b32 a171, v115
    v_pk_mul_f32 v[120:121], v[120:121], s[92:93]
    v_pk_mul_f32 v[122:123], v[122:123], s[92:93]
    v_pk_mul_f32 v[124:125], v[124:125], s[92:93]
    v_pk_mul_f32 v[126:127], v[126:127], s[92:93]
    v_cvt_pk_bf16_f32 v120, v120, v121
    v_cvt_pk_bf16_f32 v121, v122, v123
    v_cvt_pk_bf16_f32 v122, v124, v125
    v_cvt_pk_bf16_f32 v123, v126, v127
    v_accvgpr_write_b32 a172, v120
    v_accvgpr_write_b32 a173, v121
    v_accvgpr_write_b32 a174, v122
    v_accvgpr_write_b32 a175, v123
    v_pk_mul_f32 v[128:129], v[128:129], s[92:93]
    v_pk_mul_f32 v[130:131], v[130:131], s[92:93]
    v_pk_mul_f32 v[132:133], v[132:133], s[92:93]
    v_pk_mul_f32 v[134:135], v[134:135], s[92:93]
    v_cvt_pk_bf16_f32 v128, v128, v129
    v_cvt_pk_bf16_f32 v129, v130, v131
    v_cvt_pk_bf16_f32 v130, v132, v133
    v_cvt_pk_bf16_f32 v131, v134, v135
    v_accvgpr_write_b32 a176, v128
    v_accvgpr_write_b32 a177, v129
    v_accvgpr_write_b32 a178, v130
    v_accvgpr_write_b32 a179, v131
    v_pk_mul_f32 v[136:137], v[136:137], s[92:93]
    v_pk_mul_f32 v[138:139], v[138:139], s[92:93]
    v_pk_mul_f32 v[140:141], v[140:141], s[92:93]
    v_pk_mul_f32 v[142:143], v[142:143], s[92:93]
    v_cvt_pk_bf16_f32 v136, v136, v137
    v_cvt_pk_bf16_f32 v137, v138, v139
    v_cvt_pk_bf16_f32 v138, v140, v141
    v_cvt_pk_bf16_f32 v139, v142, v143
    v_accvgpr_write_b32 a180, v136
    v_accvgpr_write_b32 a181, v137
    v_accvgpr_write_b32 a182, v138
    v_accvgpr_write_b32 a183, v139
    v_pk_mul_f32 v[144:145], v[144:145], s[92:93]
    v_pk_mul_f32 v[146:147], v[146:147], s[92:93]
    v_pk_mul_f32 v[148:149], v[148:149], s[92:93]
    v_pk_mul_f32 v[150:151], v[150:151], s[92:93]
    v_cvt_pk_bf16_f32 v144, v144, v145
    v_cvt_pk_bf16_f32 v145, v146, v147
    v_cvt_pk_bf16_f32 v146, v148, v149
    v_cvt_pk_bf16_f32 v147, v150, v151
    v_accvgpr_write_b32 a184, v144
    v_accvgpr_write_b32 a185, v145
    v_accvgpr_write_b32 a186, v146
    v_accvgpr_write_b32 a187, v147
    v_pk_mul_f32 v[152:153], v[152:153], s[92:93]
    v_pk_mul_f32 v[154:155], v[154:155], s[92:93]
    v_pk_mul_f32 v[156:157], v[156:157], s[92:93]
    v_pk_mul_f32 v[158:159], v[158:159], s[92:93]
    v_cvt_pk_bf16_f32 v152, v152, v153
    v_cvt_pk_bf16_f32 v153, v154, v155
    v_cvt_pk_bf16_f32 v154, v156, v157
    v_cvt_pk_bf16_f32 v155, v158, v159
    v_accvgpr_write_b32 a188, v152
    v_accvgpr_write_b32 a189, v153
    v_accvgpr_write_b32 a190, v154
    v_accvgpr_write_b32 a191, v155
    v_pk_mul_f32 v[160:161], v[160:161], s[92:93]
    v_pk_mul_f32 v[162:163], v[162:163], s[92:93]
    v_pk_mul_f32 v[164:165], v[164:165], s[92:93]
    v_pk_mul_f32 v[166:167], v[166:167], s[92:93]
    v_cvt_pk_bf16_f32 v160, v160, v161
    v_cvt_pk_bf16_f32 v161, v162, v163
    v_cvt_pk_bf16_f32 v162, v164, v165
    v_cvt_pk_bf16_f32 v163, v166, v167
    v_accvgpr_write_b32 a192, v160
    v_accvgpr_write_b32 a193, v161
    v_accvgpr_write_b32 a194, v162
    v_accvgpr_write_b32 a195, v163
    v_pk_mul_f32 v[168:169], v[168:169], s[92:93]
    v_pk_mul_f32 v[170:171], v[170:171], s[92:93]
    v_pk_mul_f32 v[172:173], v[172:173], s[92:93]
    v_pk_mul_f32 v[174:175], v[174:175], s[92:93]
    v_cvt_pk_bf16_f32 v168, v168, v169
    v_cvt_pk_bf16_f32 v169, v170, v171
    v_cvt_pk_bf16_f32 v170, v172, v173
    v_cvt_pk_bf16_f32 v171, v174, v175
    v_accvgpr_write_b32 a196, v168
    v_accvgpr_write_b32 a197, v169
    v_accvgpr_write_b32 a198, v170
    v_accvgpr_write_b32 a199, v171
    v_pk_mul_f32 v[176:177], v[176:177], s[92:93]
    v_pk_mul_f32 v[178:179], v[178:179], s[92:93]
    v_pk_mul_f32 v[180:181], v[180:181], s[92:93]
    v_pk_mul_f32 v[182:183], v[182:183], s[92:93]
    v_cvt_pk_bf16_f32 v176, v176, v177
    v_cvt_pk_bf16_f32 v177, v178, v179
    v_cvt_pk_bf16_f32 v178, v180, v181
    v_cvt_pk_bf16_f32 v179, v182, v183
    v_accvgpr_write_b32 a200, v176
    v_accvgpr_write_b32 a201, v177
    v_accvgpr_write_b32 a202, v178
    v_accvgpr_write_b32 a203, v179
    v_pk_mul_f32 v[184:185], v[184:185], s[92:93]
    v_pk_mul_f32 v[186:187], v[186:187], s[92:93]
    v_pk_mul_f32 v[188:189], v[188:189], s[92:93]
    v_pk_mul_f32 v[190:191], v[190:191], s[92:93]
    v_cvt_pk_bf16_f32 v184, v184, v185
    v_cvt_pk_bf16_f32 v185, v186, v187
    v_cvt_pk_bf16_f32 v186, v188, v189
    v_cvt_pk_bf16_f32 v187, v190, v191
    v_accvgpr_write_b32 a204, v184
    v_accvgpr_write_b32 a205, v185
    v_accvgpr_write_b32 a206, v186
    v_accvgpr_write_b32 a207, v187
    v_pk_mul_f32 v[192:193], v[192:193], s[92:93]
    v_pk_mul_f32 v[194:195], v[194:195], s[92:93]
    v_pk_mul_f32 v[196:197], v[196:197], s[92:93]
    v_pk_mul_f32 v[198:199], v[198:199], s[92:93]
    v_cvt_pk_bf16_f32 v192, v192, v193
    v_cvt_pk_bf16_f32 v193, v194, v195
    v_cvt_pk_bf16_f32 v194, v196, v197
    v_cvt_pk_bf16_f32 v195, v198, v199
    v_accvgpr_write_b32 a208, v192
    v_accvgpr_write_b32 a209, v193
    v_accvgpr_write_b32 a210, v194
    v_accvgpr_write_b32 a211, v195
    v_pk_mul_f32 v[200:201], v[200:201], s[92:93]
    v_pk_mul_f32 v[202:203], v[202:203], s[92:93]
    v_pk_mul_f32 v[204:205], v[204:205], s[92:93]
    v_pk_mul_f32 v[206:207], v[206:207], s[92:93]
    v_cvt_pk_bf16_f32 v200, v200, v201
    v_cvt_pk_bf16_f32 v201, v202, v203
    v_cvt_pk_bf16_f32 v202, v204, v205
    v_cvt_pk_bf16_f32 v203, v206, v207
    v_accvgpr_write_b32 a212, v200
    v_accvgpr_write_b32 a213, v201
    v_accvgpr_write_b32 a214, v202
    v_accvgpr_write_b32 a215, v203
    v_pk_mul_f32 v[208:209], v[208:209], s[92:93]
    v_pk_mul_f32 v[210:211], v[210:211], s[92:93]
    v_pk_mul_f32 v[212:213], v[212:213], s[92:93]
    v_pk_mul_f32 v[214:215], v[214:215], s[92:93]
    v_cvt_pk_bf16_f32 v208, v208, v209
    v_cvt_pk_bf16_f32 v209, v210, v211
    v_cvt_pk_bf16_f32 v210, v212, v213
    v_cvt_pk_bf16_f32 v211, v214, v215
    v_accvgpr_write_b32 a216, v208
    v_accvgpr_write_b32 a217, v209
    v_accvgpr_write_b32 a218, v210
    v_accvgpr_write_b32 a219, v211
    v_pk_mul_f32 v[216:217], v[216:217], s[92:93]
    v_pk_mul_f32 v[218:219], v[218:219], s[92:93]
    v_pk_mul_f32 v[220:221], v[220:221], s[92:93]
    v_pk_mul_f32 v[222:223], v[222:223], s[92:93]
    v_cvt_pk_bf16_f32 v216, v216, v217
    v_cvt_pk_bf16_f32 v217, v218, v219
    v_cvt_pk_bf16_f32 v218, v220, v221
    v_cvt_pk_bf16_f32 v219, v222, v223
    v_accvgpr_write_b32 a220, v216
    v_accvgpr_write_b32 a221, v217
    v_accvgpr_write_b32 a222, v218
    v_accvgpr_write_b32 a223, v219
    v_pk_mul_f32 v[224:225], v[224:225], s[92:93]
    v_pk_mul_f32 v[226:227], v[226:227], s[92:93]
    v_pk_mul_f32 v[228:229], v[228:229], s[92:93]
    v_pk_mul_f32 v[230:231], v[230:231], s[92:93]
    v_cvt_pk_bf16_f32 v224, v224, v225
    v_cvt_pk_bf16_f32 v225, v226, v227
    v_cvt_pk_bf16_f32 v226, v228, v229
    v_cvt_pk_bf16_f32 v227, v230, v231
    v_accvgpr_write_b32 a224, v224
    v_accvgpr_write_b32 a225, v225
    v_accvgpr_write_b32 a226, v226
    v_accvgpr_write_b32 a227, v227
    v_pk_mul_f32 v[232:233], v[232:233], s[92:93]
    v_pk_mul_f32 v[234:235], v[234:235], s[92:93]
    v_pk_mul_f32 v[236:237], v[236:237], s[92:93]
    v_pk_mul_f32 v[238:239], v[238:239], s[92:93]
    v_cvt_pk_bf16_f32 v232, v232, v233
    v_cvt_pk_bf16_f32 v233, v234, v235
    v_cvt_pk_bf16_f32 v234, v236, v237
    v_cvt_pk_bf16_f32 v235, v238, v239
    v_accvgpr_write_b32 a228, v232
    v_accvgpr_write_b32 a229, v233
    v_accvgpr_write_b32 a230, v234
    v_accvgpr_write_b32 a231, v235
    v_pk_mul_f32 v[240:241], v[240:241], s[92:93]
    v_pk_mul_f32 v[242:243], v[242:243], s[92:93]
    v_pk_mul_f32 v[244:245], v[244:245], s[92:93]
    v_pk_mul_f32 v[246:247], v[246:247], s[92:93]
    v_cvt_pk_bf16_f32 v240, v240, v241
    v_cvt_pk_bf16_f32 v241, v242, v243
    v_cvt_pk_bf16_f32 v242, v244, v245
    v_cvt_pk_bf16_f32 v243, v246, v247
    v_accvgpr_write_b32 a232, v240
    v_accvgpr_write_b32 a233, v241
    v_accvgpr_write_b32 a234, v242
    v_accvgpr_write_b32 a235, v243
    v_pk_mul_f32 v[248:249], v[248:249], s[92:93]
    v_pk_mul_f32 v[250:251], v[250:251], s[92:93]
    v_pk_mul_f32 v[252:253], v[252:253], s[92:93]
    v_pk_mul_f32 v[254:255], v[254:255], s[92:93]
    v_cvt_pk_bf16_f32 v248, v248, v249
    v_cvt_pk_bf16_f32 v249, v250, v251
    v_cvt_pk_bf16_f32 v250, v252, v253
    v_cvt_pk_bf16_f32 v251, v254, v255
    v_accvgpr_write_b32 a236, v248
    v_accvgpr_write_b32 a237, v249
    v_accvgpr_write_b32 a238, v250
    v_accvgpr_write_b32 a239, v251
    v_accvgpr_read_b32 v24, a96
    v_accvgpr_read_b32 v25, a97
    v_accvgpr_read_b32 v26, a98
    v_accvgpr_read_b32 v27, a99
    v_accvgpr_read_b32 v28, a100
    v_accvgpr_read_b32 v29, a101
    v_accvgpr_read_b32 v30, a102
    v_accvgpr_read_b32 v31, a103
    v_pk_mul_f32 v[24:25], v[24:25], s[92:93]
    v_pk_mul_f32 v[26:27], v[26:27], s[92:93]
    v_pk_mul_f32 v[28:29], v[28:29], s[92:93]
    v_pk_mul_f32 v[30:31], v[30:31], s[92:93]
    v_cvt_pk_bf16_f32 v24, v24, v25
    v_cvt_pk_bf16_f32 v25, v26, v27
    v_cvt_pk_bf16_f32 v26, v28, v29
    v_cvt_pk_bf16_f32 v27, v30, v31
    v_accvgpr_write_b32 a240, v24
    v_accvgpr_write_b32 a241, v25
    v_accvgpr_write_b32 a242, v26
    v_accvgpr_write_b32 a243, v27
    v_accvgpr_read_b32 v24, a104
    v_accvgpr_read_b32 v25, a105
    v_accvgpr_read_b32 v26, a106
    v_accvgpr_read_b32 v27, a107
    v_accvgpr_read_b32 v28, a108
    v_accvgpr_read_b32 v29, a109
    v_accvgpr_read_b32 v30, a110
    v_accvgpr_read_b32 v31, a111
    v_pk_mul_f32 v[24:25], v[24:25], s[92:93]
    v_pk_mul_f32 v[26:27], v[26:27], s[92:93]
    v_pk_mul_f32 v[28:29], v[28:29], s[92:93]
    v_pk_mul_f32 v[30:31], v[30:31], s[92:93]
    v_cvt_pk_bf16_f32 v24, v24, v25
    v_cvt_pk_bf16_f32 v25, v26, v27
    v_cvt_pk_bf16_f32 v26, v28, v29
    v_cvt_pk_bf16_f32 v27, v30, v31
    v_accvgpr_write_b32 a244, v24
    v_accvgpr_write_b32 a245, v25
    v_accvgpr_write_b32 a246, v26
    v_accvgpr_write_b32 a247, v27
    v_accvgpr_read_b32 v24, a112
    v_accvgpr_read_b32 v25, a113
    v_accvgpr_read_b32 v26, a114
    v_accvgpr_read_b32 v27, a115
    v_accvgpr_read_b32 v28, a116
    v_accvgpr_read_b32 v29, a117
    v_accvgpr_read_b32 v30, a118
    v_accvgpr_read_b32 v31, a119
    v_pk_mul_f32 v[24:25], v[24:25], s[92:93]
    v_pk_mul_f32 v[26:27], v[26:27], s[92:93]
    v_pk_mul_f32 v[28:29], v[28:29], s[92:93]
    v_pk_mul_f32 v[30:31], v[30:31], s[92:93]
    v_cvt_pk_bf16_f32 v24, v24, v25
    v_cvt_pk_bf16_f32 v25, v26, v27
    v_cvt_pk_bf16_f32 v26, v28, v29
    v_cvt_pk_bf16_f32 v27, v30, v31
    v_accvgpr_write_b32 a248, v24
    v_accvgpr_write_b32 a249, v25
    v_accvgpr_write_b32 a250, v26
    v_accvgpr_write_b32 a251, v27
    v_accvgpr_read_b32 v24, a120
    v_accvgpr_read_b32 v25, a121
    v_accvgpr_read_b32 v26, a122
    v_accvgpr_read_b32 v27, a123
    v_accvgpr_read_b32 v28, a124
    v_accvgpr_read_b32 v29, a125
    v_accvgpr_read_b32 v30, a126
    v_accvgpr_read_b32 v31, a127
    v_pk_mul_f32 v[24:25], v[24:25], s[92:93]
    v_pk_mul_f32 v[26:27], v[26:27], s[92:93]
    v_pk_mul_f32 v[28:29], v[28:29], s[92:93]
    v_pk_mul_f32 v[30:31], v[30:31], s[92:93]
    v_cvt_pk_bf16_f32 v24, v24, v25
    v_cvt_pk_bf16_f32 v25, v26, v27
    v_cvt_pk_bf16_f32 v26, v28, v29
    v_cvt_pk_bf16_f32 v27, v30, v31
    v_accvgpr_write_b32 a252, v24
    v_accvgpr_write_b32 a253, v25
    v_accvgpr_write_b32 a254, v26
    v_accvgpr_write_b32 a255, v27
    s_setpc_b64 s[20:21]
mega_kernel_ns351:
    v_cvt_pk_bf16_f32 v32, v32, v33
    v_cvt_pk_bf16_f32 v33, v34, v35
    v_cvt_pk_bf16_f32 v34, v36, v37
    v_cvt_pk_bf16_f32 v35, v38, v39
    v_accvgpr_write_b32 a128, v32
    v_accvgpr_write_b32 a129, v33
    v_accvgpr_write_b32 a130, v34
    v_accvgpr_write_b32 a131, v35
    v_cvt_pk_bf16_f32 v40, v40, v41
    v_cvt_pk_bf16_f32 v41, v42, v43
    v_cvt_pk_bf16_f32 v42, v44, v45
    v_cvt_pk_bf16_f32 v43, v46, v47
    v_accvgpr_write_b32 a132, v40
    v_accvgpr_write_b32 a133, v41
    v_accvgpr_write_b32 a134, v42
    v_accvgpr_write_b32 a135, v43
    v_cvt_pk_bf16_f32 v48, v48, v49
    v_cvt_pk_bf16_f32 v49, v50, v51
    v_cvt_pk_bf16_f32 v50, v52, v53
    v_cvt_pk_bf16_f32 v51, v54, v55
    v_accvgpr_write_b32 a136, v48
    v_accvgpr_write_b32 a137, v49
    v_accvgpr_write_b32 a138, v50
    v_accvgpr_write_b32 a139, v51
    v_cvt_pk_bf16_f32 v56, v56, v57
    v_cvt_pk_bf16_f32 v57, v58, v59
    v_cvt_pk_bf16_f32 v58, v60, v61
    v_cvt_pk_bf16_f32 v59, v62, v63
    v_accvgpr_write_b32 a140, v56
    v_accvgpr_write_b32 a141, v57
    v_accvgpr_write_b32 a142, v58
    v_accvgpr_write_b32 a143, v59
    v_cvt_pk_bf16_f32 v64, v64, v65
    v_cvt_pk_bf16_f32 v65, v66, v67
    v_cvt_pk_bf16_f32 v66, v68, v69
    v_cvt_pk_bf16_f32 v67, v70, v71
    v_accvgpr_write_b32 a144, v64
    v_accvgpr_write_b32 a145, v65
    v_accvgpr_write_b32 a146, v66
    v_accvgpr_write_b32 a147, v67
    v_cvt_pk_bf16_f32 v72, v72, v73
    v_cvt_pk_bf16_f32 v73, v74, v75
    v_cvt_pk_bf16_f32 v74, v76, v77
    v_cvt_pk_bf16_f32 v75, v78, v79
    v_accvgpr_write_b32 a148, v72
    v_accvgpr_write_b32 a149, v73
    v_accvgpr_write_b32 a150, v74
    v_accvgpr_write_b32 a151, v75
    v_cvt_pk_bf16_f32 v80, v80, v81
    v_cvt_pk_bf16_f32 v81, v82, v83
    v_cvt_pk_bf16_f32 v82, v84, v85
    v_cvt_pk_bf16_f32 v83, v86, v87
    v_accvgpr_write_b32 a152, v80
    v_accvgpr_write_b32 a153, v81
    v_accvgpr_write_b32 a154, v82
    v_accvgpr_write_b32 a155, v83
    v_cvt_pk_bf16_f32 v88, v88, v89
    v_cvt_pk_bf16_f32 v89, v90, v91
    v_cvt_pk_bf16_f32 v90, v92, v93
    v_cvt_pk_bf16_f32 v91, v94, v95
    v_accvgpr_write_b32 a156, v88
    v_accvgpr_write_b32 a157, v89
    v_accvgpr_write_b32 a158, v90
    v_accvgpr_write_b32 a159, v91
    v_cvt_pk_bf16_f32 v96, v96, v97
    v_cvt_pk_bf16_f32 v97, v98, v99
    v_cvt_pk_bf16_f32 v98, v100, v101
    v_cvt_pk_bf16_f32 v99, v102, v103
    v_accvgpr_write_b32 a160, v96
    v_accvgpr_write_b32 a161, v97
    v_accvgpr_write_b32 a162, v98
    v_accvgpr_write_b32 a163, v99
    v_cvt_pk_bf16_f32 v104, v104, v105
    v_cvt_pk_bf16_f32 v105, v106, v107
    v_cvt_pk_bf16_f32 v106, v108, v109
    v_cvt_pk_bf16_f32 v107, v110, v111
    v_accvgpr_write_b32 a164, v104
    v_accvgpr_write_b32 a165, v105
    v_accvgpr_write_b32 a166, v106
    v_accvgpr_write_b32 a167, v107
    v_cvt_pk_bf16_f32 v112, v112, v113
    v_cvt_pk_bf16_f32 v113, v114, v115
    v_cvt_pk_bf16_f32 v114, v116, v117
    v_cvt_pk_bf16_f32 v115, v118, v119
    v_accvgpr_write_b32 a168, v112
    v_accvgpr_write_b32 a169, v113
    v_accvgpr_write_b32 a170, v114
    v_accvgpr_write_b32 a171, v115
    v_cvt_pk_bf16_f32 v120, v120, v121
    v_cvt_pk_bf16_f32 v121, v122, v123
    v_cvt_pk_bf16_f32 v122, v124, v125
    v_cvt_pk_bf16_f32 v123, v126, v127
    v_accvgpr_write_b32 a172, v120
    v_accvgpr_write_b32 a173, v121
    v_accvgpr_write_b32 a174, v122
    v_accvgpr_write_b32 a175, v123
    v_cvt_pk_bf16_f32 v128, v128, v129
    v_cvt_pk_bf16_f32 v129, v130, v131
    v_cvt_pk_bf16_f32 v130, v132, v133
    v_cvt_pk_bf16_f32 v131, v134, v135
    v_accvgpr_write_b32 a176, v128
    v_accvgpr_write_b32 a177, v129
    v_accvgpr_write_b32 a178, v130
    v_accvgpr_write_b32 a179, v131
    v_cvt_pk_bf16_f32 v136, v136, v137
    v_cvt_pk_bf16_f32 v137, v138, v139
    v_cvt_pk_bf16_f32 v138, v140, v141
    v_cvt_pk_bf16_f32 v139, v142, v143
    v_accvgpr_write_b32 a180, v136
    v_accvgpr_write_b32 a181, v137
    v_accvgpr_write_b32 a182, v138
    v_accvgpr_write_b32 a183, v139
    v_cvt_pk_bf16_f32 v144, v144, v145
    v_cvt_pk_bf16_f32 v145, v146, v147
    v_cvt_pk_bf16_f32 v146, v148, v149
    v_cvt_pk_bf16_f32 v147, v150, v151
    v_accvgpr_write_b32 a184, v144
    v_accvgpr_write_b32 a185, v145
    v_accvgpr_write_b32 a186, v146
    v_accvgpr_write_b32 a187, v147
    v_cvt_pk_bf16_f32 v152, v152, v153
    v_cvt_pk_bf16_f32 v153, v154, v155
    v_cvt_pk_bf16_f32 v154, v156, v157
    v_cvt_pk_bf16_f32 v155, v158, v159
    v_accvgpr_write_b32 a188, v152
    v_accvgpr_write_b32 a189, v153
    v_accvgpr_write_b32 a190, v154
    v_accvgpr_write_b32 a191, v155
    v_cvt_pk_bf16_f32 v160, v160, v161
    v_cvt_pk_bf16_f32 v161, v162, v163
    v_cvt_pk_bf16_f32 v162, v164, v165
    v_cvt_pk_bf16_f32 v163, v166, v167
    v_accvgpr_write_b32 a192, v160
    v_accvgpr_write_b32 a193, v161
    v_accvgpr_write_b32 a194, v162
    v_accvgpr_write_b32 a195, v163
    v_cvt_pk_bf16_f32 v168, v168, v169
    v_cvt_pk_bf16_f32 v169, v170, v171
    v_cvt_pk_bf16_f32 v170, v172, v173
    v_cvt_pk_bf16_f32 v171, v174, v175
    v_accvgpr_write_b32 a196, v168
    v_accvgpr_write_b32 a197, v169
    v_accvgpr_write_b32 a198, v170
    v_accvgpr_write_b32 a199, v171
    v_cvt_pk_bf16_f32 v176, v176, v177
    v_cvt_pk_bf16_f32 v177, v178, v179
    v_cvt_pk_bf16_f32 v178, v180, v181
    v_cvt_pk_bf16_f32 v179, v182, v183
    v_accvgpr_write_b32 a200, v176
    v_accvgpr_write_b32 a201, v177
    v_accvgpr_write_b32 a202, v178
    v_accvgpr_write_b32 a203, v179
    v_cvt_pk_bf16_f32 v184, v184, v185
    v_cvt_pk_bf16_f32 v185, v186, v187
    v_cvt_pk_bf16_f32 v186, v188, v189
    v_cvt_pk_bf16_f32 v187, v190, v191
    v_accvgpr_write_b32 a204, v184
    v_accvgpr_write_b32 a205, v185
    v_accvgpr_write_b32 a206, v186
    v_accvgpr_write_b32 a207, v187
    v_cvt_pk_bf16_f32 v192, v192, v193
    v_cvt_pk_bf16_f32 v193, v194, v195
    v_cvt_pk_bf16_f32 v194, v196, v197
    v_cvt_pk_bf16_f32 v195, v198, v199
    v_accvgpr_write_b32 a208, v192
    v_accvgpr_write_b32 a209, v193
    v_accvgpr_write_b32 a210, v194
    v_accvgpr_write_b32 a211, v195
    v_cvt_pk_bf16_f32 v200, v200, v201
    v_cvt_pk_bf16_f32 v201, v202, v203
    v_cvt_pk_bf16_f32 v202, v204, v205
    v_cvt_pk_bf16_f32 v203, v206, v207
    v_accvgpr_write_b32 a212, v200
    v_accvgpr_write_b32 a213, v201
    v_accvgpr_write_b32 a214, v202
    v_accvgpr_write_b32 a215, v203
    v_cvt_pk_bf16_f32 v208, v208, v209
    v_cvt_pk_bf16_f32 v209, v210, v211
    v_cvt_pk_bf16_f32 v210, v212, v213
    v_cvt_pk_bf16_f32 v211, v214, v215
    v_accvgpr_write_b32 a216, v208
    v_accvgpr_write_b32 a217, v209
    v_accvgpr_write_b32 a218, v210
    v_accvgpr_write_b32 a219, v211
    v_cvt_pk_bf16_f32 v216, v216, v217
    v_cvt_pk_bf16_f32 v217, v218, v219
    v_cvt_pk_bf16_f32 v218, v220, v221
    v_cvt_pk_bf16_f32 v219, v222, v223
    v_accvgpr_write_b32 a220, v216
    v_accvgpr_write_b32 a221, v217
    v_accvgpr_write_b32 a222, v218
    v_accvgpr_write_b32 a223, v219
    v_cvt_pk_bf16_f32 v224, v224, v225
    v_cvt_pk_bf16_f32 v225, v226, v227
    v_cvt_pk_bf16_f32 v226, v228, v229
    v_cvt_pk_bf16_f32 v227, v230, v231
    v_accvgpr_write_b32 a224, v224
    v_accvgpr_write_b32 a225, v225
    v_accvgpr_write_b32 a226, v226
    v_accvgpr_write_b32 a227, v227
    v_cvt_pk_bf16_f32 v232, v232, v233
    v_cvt_pk_bf16_f32 v233, v234, v235
    v_cvt_pk_bf16_f32 v234, v236, v237
    v_cvt_pk_bf16_f32 v235, v238, v239
    v_accvgpr_write_b32 a228, v232
    v_accvgpr_write_b32 a229, v233
    v_accvgpr_write_b32 a230, v234
    v_accvgpr_write_b32 a231, v235
    v_cvt_pk_bf16_f32 v240, v240, v241
    v_cvt_pk_bf16_f32 v241, v242, v243
    v_cvt_pk_bf16_f32 v242, v244, v245
    v_cvt_pk_bf16_f32 v243, v246, v247
    v_accvgpr_write_b32 a232, v240
    v_accvgpr_write_b32 a233, v241
    v_accvgpr_write_b32 a234, v242
    v_accvgpr_write_b32 a235, v243
    v_cvt_pk_bf16_f32 v248, v248, v249
    v_cvt_pk_bf16_f32 v249, v250, v251
    v_cvt_pk_bf16_f32 v250, v252, v253
    v_cvt_pk_bf16_f32 v251, v254, v255
    v_accvgpr_write_b32 a236, v248
    v_accvgpr_write_b32 a237, v249
    v_accvgpr_write_b32 a238, v250
    v_accvgpr_write_b32 a239, v251
    v_accvgpr_read_b32 v24, a96
    v_accvgpr_read_b32 v25, a97
    v_accvgpr_read_b32 v26, a98
    v_accvgpr_read_b32 v27, a99
    v_accvgpr_read_b32 v28, a100
    v_accvgpr_read_b32 v29, a101
    v_accvgpr_read_b32 v30, a102
    v_accvgpr_read_b32 v31, a103
    v_cvt_pk_bf16_f32 v24, v24, v25
    v_cvt_pk_bf16_f32 v25, v26, v27
    v_cvt_pk_bf16_f32 v26, v28, v29
    v_cvt_pk_bf16_f32 v27, v30, v31
    v_accvgpr_write_b32 a240, v24
    v_accvgpr_write_b32 a241, v25
    v_accvgpr_write_b32 a242, v26
    v_accvgpr_write_b32 a243, v27
    v_accvgpr_read_b32 v24, a104
    v_accvgpr_read_b32 v25, a105
    v_accvgpr_read_b32 v26, a106
    v_accvgpr_read_b32 v27, a107
    v_accvgpr_read_b32 v28, a108
    v_accvgpr_read_b32 v29, a109
    v_accvgpr_read_b32 v30, a110
    v_accvgpr_read_b32 v31, a111
    v_cvt_pk_bf16_f32 v24, v24, v25
    v_cvt_pk_bf16_f32 v25, v26, v27
    v_cvt_pk_bf16_f32 v26, v28, v29
    v_cvt_pk_bf16_f32 v27, v30, v31
    v_accvgpr_write_b32 a244, v24
    v_accvgpr_write_b32 a245, v25
    v_accvgpr_write_b32 a246, v26
    v_accvgpr_write_b32 a247, v27
    v_accvgpr_read_b32 v24, a112
    v_accvgpr_read_b32 v25, a113
    v_accvgpr_read_b32 v26, a114
    v_accvgpr_read_b32 v27, a115
    v_accvgpr_read_b32 v28, a116
    v_accvgpr_read_b32 v29, a117
    v_accvgpr_read_b32 v30, a118
    v_accvgpr_read_b32 v31, a119
    v_cvt_pk_bf16_f32 v24, v24, v25
    v_cvt_pk_bf16_f32 v25, v26, v27
    v_cvt_pk_bf16_f32 v26, v28, v29
    v_cvt_pk_bf16_f32 v27, v30, v31
    v_accvgpr_write_b32 a248, v24
    v_accvgpr_write_b32 a249, v25
    v_accvgpr_write_b32 a250, v26
    v_accvgpr_write_b32 a251, v27
    v_accvgpr_read_b32 v24, a120
    v_accvgpr_read_b32 v25, a121
    v_accvgpr_read_b32 v26, a122
    v_accvgpr_read_b32 v27, a123
    v_accvgpr_read_b32 v28, a124
    v_accvgpr_read_b32 v29, a125
    v_accvgpr_read_b32 v30, a126
    v_accvgpr_read_b32 v31, a127
    v_cvt_pk_bf16_f32 v24, v24, v25
    v_cvt_pk_bf16_f32 v25, v26, v27
    v_cvt_pk_bf16_f32 v26, v28, v29
    v_cvt_pk_bf16_f32 v27, v30, v31
    v_accvgpr_write_b32 a252, v24
    v_accvgpr_write_b32 a253, v25
    v_accvgpr_write_b32 a254, v26
    v_accvgpr_write_b32 a255, v27
    s_setpc_b64 s[20:21]
mega_kernel_epf17:
    s_nop 7
    s_mov_b32 s91, s98
    s_mov_b32 s92, s97
    s_mov_b32 s93, s97
    s_mov_b32 s90, s91
    v_cvt_pk_bf16_f32 v32, v32, v33
    v_cvt_pk_bf16_f32 v33, v34, v35
    v_cvt_pk_bf16_f32 v34, v36, v37
    v_cvt_pk_bf16_f32 v35, v38, v39
    buffer_store_dwordx4 v[32:35], v2, s[8:11], s90 offen sc1
    s_add_u32 s90, s90, s100
    v_cvt_pk_bf16_f32 v40, v40, v41
    v_cvt_pk_bf16_f32 v41, v42, v43
    v_cvt_pk_bf16_f32 v42, v44, v45
    v_cvt_pk_bf16_f32 v43, v46, v47
    buffer_store_dwordx4 v[40:43], v2, s[8:11], s90 offen sc1
    s_add_u32 s90, s90, s100
    v_cvt_pk_bf16_f32 v48, v48, v49
    v_cvt_pk_bf16_f32 v49, v50, v51
    v_cvt_pk_bf16_f32 v50, v52, v53
    v_cvt_pk_bf16_f32 v51, v54, v55
    buffer_store_dwordx4 v[48:51], v2, s[8:11], s90 offen sc1
    s_add_u32 s90, s90, s100
    v_cvt_pk_bf16_f32 v56, v56, v57
    v_cvt_pk_bf16_f32 v57, v58, v59
    v_cvt_pk_bf16_f32 v58, v60, v61
    v_cvt_pk_bf16_f32 v59, v62, v63
    buffer_store_dwordx4 v[56:59], v2, s[8:11], s90 offen sc1
    s_add_u32 s90, s90, s100
    v_cvt_pk_bf16_f32 v64, v64, v65
    v_cvt_pk_bf16_f32 v65, v66, v67
    v_cvt_pk_bf16_f32 v66, v68, v69
    v_cvt_pk_bf16_f32 v67, v70, v71
    buffer_store_dwordx4 v[64:67], v2, s[8:11], s90 offen sc1
    s_add_u32 s90, s90, s100
    v_cvt_pk_bf16_f32 v72, v72, v73
    v_cvt_pk_bf16_f32 v73, v74, v75
    v_cvt_pk_bf16_f32 v74, v76, v77
    v_cvt_pk_bf16_f32 v75, v78, v79
    buffer_store_dwordx4 v[72:75], v2, s[8:11], s90 offen sc1
    s_add_u32 s90, s90, s100
    v_cvt_pk_bf16_f32 v80, v80, v81
    v_cvt_pk_bf16_f32 v81, v82, v83
    v_cvt_pk_bf16_f32 v82, v84, v85
    v_cvt_pk_bf16_f32 v83, v86, v87
    buffer_store_dwordx4 v[80:83], v2, s[8:11], s90 offen sc1
    s_add_u32 s90, s90, s100
    v_cvt_pk_bf16_f32 v88, v88, v89
    v_cvt_pk_bf16_f32 v89, v90, v91
    v_cvt_pk_bf16_f32 v90, v92, v93
    v_cvt_pk_bf16_f32 v91, v94, v95
    buffer_store_dwordx4 v[88:91], v2, s[8:11], s90 offen sc1
    s_add_u32 s90, s90, s100
    s_add_u32 s91, s91, s99
    s_mov_b32 s90, s91
    v_cvt_pk_bf16_f32 v96, v96, v97
    v_cvt_pk_bf16_f32 v97, v98, v99
    v_cvt_pk_bf16_f32 v98, v100, v101
    v_cvt_pk_bf16_f32 v99, v102, v103
    buffer_store_dwordx4 v[96:99], v2, s[8:11], s90 offen sc1
    s_add_u32 s90, s90, s100
    v_cvt_pk_bf16_f32 v104, v104, v105
    v_cvt_pk_bf16_f32 v105, v106, v107
    v_cvt_pk_bf16_f32 v106, v108, v109
    v_cvt_pk_bf16_f32 v107, v110, v111
    buffer_store_dwordx4 v[104:107], v2, s[8:11], s90 offen sc1
    s_add_u32 s90, s90, s100
    v_cvt_pk_bf16_f32 v112, v112, v113
    v_cvt_pk_bf16_f32 v113, v114, v115
    v_cvt_pk_bf16_f32 v114, v116, v117
    v_cvt_pk_bf16_f32 v115, v118, v119
    buffer_store_dwordx4 v[112:115], v2, s[8:11], s90 offen sc1
    s_add_u32 s90, s90, s100
    v_cvt_pk_bf16_f32 v120, v120, v121
    v_cvt_pk_bf16_f32 v121, v122, v123
    v_cvt_pk_bf16_f32 v122, v124, v125
    v_cvt_pk_bf16_f32 v123, v126, v127
    buffer_store_dwordx4 v[120:123], v2, s[8:11], s90 offen sc1
    s_add_u32 s90, s90, s100
    v_cvt_pk_bf16_f32 v128, v128, v129
    v_cvt_pk_bf16_f32 v129, v130, v131
    v_cvt_pk_bf16_f32 v130, v132, v133
    v_cvt_pk_bf16_f32 v131, v134, v135
    buffer_store_dwordx4 v[128:131], v2, s[8:11], s90 offen sc1
    s_add_u32 s90, s90, s100
    v_cvt_pk_bf16_f32 v136, v136, v137
    v_cvt_pk_bf16_f32 v137, v138, v139
    v_cvt_pk_bf16_f32 v138, v140, v141
    v_cvt_pk_bf16_f32 v139, v142, v143
    buffer_store_dwordx4 v[136:139], v2, s[8:11], s90 offen sc1
    s_add_u32 s90, s90, s100
    v_cvt_pk_bf16_f32 v144, v144, v145
    v_cvt_pk_bf16_f32 v145, v146, v147
    v_cvt_pk_bf16_f32 v146, v148, v149
    v_cvt_pk_bf16_f32 v147, v150, v151
    buffer_store_dwordx4 v[144:147], v2, s[8:11], s90 offen sc1
    s_add_u32 s90, s90, s100
    v_cvt_pk_bf16_f32 v152, v152, v153
    v_cvt_pk_bf16_f32 v153, v154, v155
    v_cvt_pk_bf16_f32 v154, v156, v157
    v_cvt_pk_bf16_f32 v155, v158, v159
    buffer_store_dwordx4 v[152:155], v2, s[8:11], s90 offen sc1
    s_add_u32 s90, s90, s100
    s_add_u32 s91, s91, s99
    s_mov_b32 s90, s91
    v_cvt_pk_bf16_f32 v160, v160, v161
    v_cvt_pk_bf16_f32 v161, v162, v163
    v_cvt_pk_bf16_f32 v162, v164, v165
    v_cvt_pk_bf16_f32 v163, v166, v167
    buffer_store_dwordx4 v[160:163], v2, s[8:11], s90 offen sc1
    s_add_u32 s90, s90, s100
    v_cvt_pk_bf16_f32 v168, v168, v169
    v_cvt_pk_bf16_f32 v169, v170, v171
    v_cvt_pk_bf16_f32 v170, v172, v173
    v_cvt_pk_bf16_f32 v171, v174, v175
    buffer_store_dwordx4 v[168:171], v2, s[8:11], s90 offen sc1
    s_add_u32 s90, s90, s100
    v_cvt_pk_bf16_f32 v176, v176, v177
    v_cvt_pk_bf16_f32 v177, v178, v179
    v_cvt_pk_bf16_f32 v178, v180, v181
    v_cvt_pk_bf16_f32 v179, v182, v183
    buffer_store_dwordx4 v[176:179], v2, s[8:11], s90 offen sc1
    s_add_u32 s90, s90, s100
    v_cvt_pk_bf16_f32 v184, v184, v185
    v_cvt_pk_bf16_f32 v185, v186, v187
    v_cvt_pk_bf16_f32 v186, v188, v189
    v_cvt_pk_bf16_f32 v187, v190, v191
    buffer_store_dwordx4 v[184:187], v2, s[8:11], s90 offen sc1
    s_add_u32 s90, s90, s100
    v_cvt_pk_bf16_f32 v192, v192, v193
    v_cvt_pk_bf16_f32 v193, v194, v195
    v_cvt_pk_bf16_f32 v194, v196, v197
    v_cvt_pk_bf16_f32 v195, v198, v199
    buffer_store_dwordx4 v[192:195], v2, s[8:11], s90 offen sc1
    s_add_u32 s90, s90, s100
    v_cvt_pk_bf16_f32 v200, v200, v201
    v_cvt_pk_bf16_f32 v201, v202, v203
    v_cvt_pk_bf16_f32 v202, v204, v205
    v_cvt_pk_bf16_f32 v203, v206, v207
    buffer_store_dwordx4 v[200:203], v2, s[8:11], s90 offen sc1
    s_add_u32 s90, s90, s100
    v_cvt_pk_bf16_f32 v208, v208, v209
    v_cvt_pk_bf16_f32 v209, v210, v211
    v_cvt_pk_bf16_f32 v210, v212, v213
    v_cvt_pk_bf16_f32 v211, v214, v215
    buffer_store_dwordx4 v[208:211], v2, s[8:11], s90 offen sc1
    s_add_u32 s90, s90, s100
    v_cvt_pk_bf16_f32 v216, v216, v217
    v_cvt_pk_bf16_f32 v217, v218, v219
    v_cvt_pk_bf16_f32 v218, v220, v221
    v_cvt_pk_bf16_f32 v219, v222, v223
    buffer_store_dwordx4 v[216:219], v2, s[8:11], s90 offen sc1
    s_add_u32 s90, s90, s100
    s_add_u32 s91, s91, s99
    s_mov_b32 s90, s91
    v_cvt_pk_bf16_f32 v224, v224, v225
    v_cvt_pk_bf16_f32 v225, v226, v227
    v_cvt_pk_bf16_f32 v226, v228, v229
    v_cvt_pk_bf16_f32 v227, v230, v231
    buffer_store_dwordx4 v[224:227], v2, s[8:11], s90 offen sc1
    s_add_u32 s90, s90, s100
    v_cvt_pk_bf16_f32 v232, v232, v233
    v_cvt_pk_bf16_f32 v233, v234, v235
    v_cvt_pk_bf16_f32 v234, v236, v237
    v_cvt_pk_bf16_f32 v235, v238, v239
    buffer_store_dwordx4 v[232:235], v2, s[8:11], s90 offen sc1
    s_add_u32 s90, s90, s100
    v_cvt_pk_bf16_f32 v240, v240, v241
    v_cvt_pk_bf16_f32 v241, v242, v243
    v_cvt_pk_bf16_f32 v242, v244, v245
    v_cvt_pk_bf16_f32 v243, v246, v247
    buffer_store_dwordx4 v[240:243], v2, s[8:11], s90 offen sc1
    s_add_u32 s90, s90, s100
    v_cvt_pk_bf16_f32 v248, v248, v249
    v_cvt_pk_bf16_f32 v249, v250, v251
    v_cvt_pk_bf16_f32 v250, v252, v253
    v_cvt_pk_bf16_f32 v251, v254, v255
    buffer_store_dwordx4 v[248:251], v2, s[8:11], s90 offen sc1
    s_add_u32 s90, s90, s100
    v_accvgpr_read_b32 v24, a96
    v_accvgpr_read_b32 v25, a97
    v_accvgpr_read_b32 v26, a98
    v_accvgpr_read_b32 v27, a99
    v_accvgpr_read_b32 v28, a100
    v_accvgpr_read_b32 v29, a101
    v_accvgpr_read_b32 v30, a102
    v_accvgpr_read_b32 v31, a103
    v_cvt_pk_bf16_f32 v24, v24, v25
    v_cvt_pk_bf16_f32 v25, v26, v27
    v_cvt_pk_bf16_f32 v26, v28, v29
    v_cvt_pk_bf16_f32 v27, v30, v31
    buffer_store_dwordx4 v[24:27], v2, s[8:11], s90 offen sc1
    s_add_u32 s90, s90, s100
    s_nop 1
    v_accvgpr_read_b32 v24, a104
    v_accvgpr_read_b32 v25, a105
    v_accvgpr_read_b32 v26, a106
    v_accvgpr_read_b32 v27, a107
    v_accvgpr_read_b32 v28, a108
    v_accvgpr_read_b32 v29, a109
    v_accvgpr_read_b32 v30, a110
    v_accvgpr_read_b32 v31, a111
    v_cvt_pk_bf16_f32 v24, v24, v25
    v_cvt_pk_bf16_f32 v25, v26, v27
    v_cvt_pk_bf16_f32 v26, v28, v29
    v_cvt_pk_bf16_f32 v27, v30, v31
    buffer_store_dwordx4 v[24:27], v2, s[8:11], s90 offen sc1
    s_add_u32 s90, s90, s100
    s_nop 1
    v_accvgpr_read_b32 v24, a112
    v_accvgpr_read_b32 v25, a113
    v_accvgpr_read_b32 v26, a114
    v_accvgpr_read_b32 v27, a115
    v_accvgpr_read_b32 v28, a116
    v_accvgpr_read_b32 v29, a117
    v_accvgpr_read_b32 v30, a118
    v_accvgpr_read_b32 v31, a119
    v_cvt_pk_bf16_f32 v24, v24, v25
    v_cvt_pk_bf16_f32 v25, v26, v27
    v_cvt_pk_bf16_f32 v26, v28, v29
    v_cvt_pk_bf16_f32 v27, v30, v31
    buffer_store_dwordx4 v[24:27], v2, s[8:11], s90 offen sc1
    s_add_u32 s90, s90, s100
    s_nop 1
    v_accvgpr_read_b32 v24, a120
    v_accvgpr_read_b32 v25, a121
    v_accvgpr_read_b32 v26, a122
    v_accvgpr_read_b32 v27, a123
    v_accvgpr_read_b32 v28, a124
    v_accvgpr_read_b32 v29, a125
    v_accvgpr_read_b32 v30, a126
    v_accvgpr_read_b32 v31, a127
    v_cvt_pk_bf16_f32 v24, v24, v25
    v_cvt_pk_bf16_f32 v25, v26, v27
    v_cvt_pk_bf16_f32 v26, v28, v29
    v_cvt_pk_bf16_f32 v27, v30, v31
    buffer_store_dwordx4 v[24:27], v2, s[8:11], s90 offen sc1
    s_add_u32 s90, s90, s100
    s_nop 1
    s_add_u32 s91, s91, s99
    s_setpc_b64 s[20:21]
mega_kernel_epl53:
    s_mov_b32 s92, s97
    s_mov_b32 s93, s97
    s_cmp_eq_u32 s97, 0
    s_cbranch_scc1 mega_kernel_ns254
    s_mov_b32 s90, s98
    v_pk_mul_f32 v[32:33], v[32:33], s[92:93]
    v_pk_mul_f32 v[34:35], v[34:35], s[92:93]
    v_pk_mul_f32 v[36:37], v[36:37], s[92:93]
    v_pk_mul_f32 v[38:39], v[38:39], s[92:93]
    v_cvt_pk_bf16_f32 v32, v32, v33
    v_cvt_pk_bf16_f32 v33, v34, v35
    v_cvt_pk_bf16_f32 v34, v36, v37
    v_cvt_pk_bf16_f32 v35, v38, v39
    buffer_store_dwordx4 v[32:35], v2, s[8:11], s90 offen sc1
    s_add_u32 s90, s90, s100
    v_pk_mul_f32 v[40:41], v[40:41], s[92:93]
    v_pk_mul_f32 v[42:43], v[42:43], s[92:93]
    v_pk_mul_f32 v[44:45], v[44:45], s[92:93]
    v_pk_mul_f32 v[46:47], v[46:47], s[92:93]
    v_cvt_pk_bf16_f32 v40, v40, v41
    v_cvt_pk_bf16_f32 v41, v42, v43
    v_cvt_pk_bf16_f32 v42, v44, v45
    v_cvt_pk_bf16_f32 v43, v46, v47
    buffer_store_dwordx4 v[40:43], v2, s[8:11], s90 offen sc1
    s_add_u32 s90, s90, s100
    v_pk_mul_f32 v[48:49], v[48:49], s[92:93]
    v_pk_mul_f32 v[50:51], v[50:51], s[92:93]
    v_pk_mul_f32 v[52:53], v[52:53], s[92:93]
    v_pk_mul_f32 v[54:55], v[54:55], s[92:93]
    v_cvt_pk_bf16_f32 v48, v48, v49
    v_cvt_pk_bf16_f32 v49, v50, v51
    v_cvt_pk_bf16_f32 v50, v52, v53
    v_cvt_pk_bf16_f32 v51, v54, v55
    buffer_store_dwordx4 v[48:51], v2, s[8:11], s90 offen sc1
    s_add_u32 s90, s90, s100
    v_pk_mul_f32 v[56:57], v[56:57], s[92:93]
    v_pk_mul_f32 v[58:59], v[58:59], s[92:93]
    v_pk_mul_f32 v[60:61], v[60:61], s[92:93]
    v_pk_mul_f32 v[62:63], v[62:63], s[92:93]
    v_cvt_pk_bf16_f32 v56, v56, v57
    v_cvt_pk_bf16_f32 v57, v58, v59
    v_cvt_pk_bf16_f32 v58, v60, v61
    v_cvt_pk_bf16_f32 v59, v62, v63
    buffer_store_dwordx4 v[56:59], v2, s[8:11], s90 offen sc1
    s_add_u32 s90, s90, s100
    v_pk_mul_f32 v[64:65], v[64:65], s[92:93]
    v_pk_mul_f32 v[66:67], v[66:67], s[92:93]
    v_pk_mul_f32 v[68:69], v[68:69], s[92:93]
    v_pk_mul_f32 v[70:71], v[70:71], s[92:93]
    v_cvt_pk_bf16_f32 v64, v64, v65
    v_cvt_pk_bf16_f32 v65, v66, v67
    v_cvt_pk_bf16_f32 v66, v68, v69
    v_cvt_pk_bf16_f32 v67, v70, v71
    buffer_store_dwordx4 v[64:67], v2, s[8:11], s90 offen sc1
    s_add_u32 s90, s90, s100
    v_pk_mul_f32 v[72:73], v[72:73], s[92:93]
    v_pk_mul_f32 v[74:75], v[74:75], s[92:93]
    v_pk_mul_f32 v[76:77], v[76:77], s[92:93]
    v_pk_mul_f32 v[78:79], v[78:79], s[92:93]
    v_cvt_pk_bf16_f32 v72, v72, v73
    v_cvt_pk_bf16_f32 v73, v74, v75
    v_cvt_pk_bf16_f32 v74, v76, v77
    v_cvt_pk_bf16_f32 v75, v78, v79
    buffer_store_dwordx4 v[72:75], v2, s[8:11], s90 offen sc1
    s_add_u32 s90, s90, s100
    v_pk_mul_f32 v[80:81], v[80:81], s[92:93]
    v_pk_mul_f32 v[82:83], v[82:83], s[92:93]
    v_pk_mul_f32 v[84:85], v[84:85], s[92:93]
    v_pk_mul_f32 v[86:87], v[86:87], s[92:93]
    v_cvt_pk_bf16_f32 v80, v80, v81
    v_cvt_pk_bf16_f32 v81, v82, v83
    v_cvt_pk_bf16_f32 v82, v84, v85
    v_cvt_pk_bf16_f32 v83, v86, v87
    buffer_store_dwordx4 v[80:83], v2, s[8:11], s90 offen sc1
    s_add_u32 s90, s90, s100
    v_pk_mul_f32 v[88:89], v[88:89], s[92:93]
    v_pk_mul_f32 v[90:91], v[90:91], s[92:93]
    v_pk_mul_f32 v[92:93], v[92:93], s[92:93]
    v_pk_mul_f32 v[94:95], v[94:95], s[92:93]
    v_cvt_pk_bf16_f32 v88, v88, v89
    v_cvt_pk_bf16_f32 v89, v90, v91
    v_cvt_pk_bf16_f32 v90, v92, v93
    v_cvt_pk_bf16_f32 v91, v94, v95
    buffer_store_dwordx4 v[88:91], v2, s[8:11], s90 offen sc1
    s_add_u32 s90, s98, s99
    v_pk_mul_f32 v[96:97], v[96:97], s[92:93]
    v_pk_mul_f32 v[98:99], v[98:99], s[92:93]
    v_pk_mul_f32 v[100:101], v[100:101], s[92:93]
    v_pk_mul_f32 v[102:103], v[102:103], s[92:93]
    v_cvt_pk_bf16_f32 v96, v96, v97
    v_cvt_pk_bf16_f32 v97, v98, v99
    v_cvt_pk_bf16_f32 v98, v100, v101
    v_cvt_pk_bf16_f32 v99, v102, v103
    buffer_store_dwordx4 v[96:99], v2, s[8:11], s90 offen sc1
    s_add_u32 s90, s90, s100
    v_pk_mul_f32 v[104:105], v[104:105], s[92:93]
    v_pk_mul_f32 v[106:107], v[106:107], s[92:93]
    v_pk_mul_f32 v[108:109], v[108:109], s[92:93]
    v_pk_mul_f32 v[110:111], v[110:111], s[92:93]
    v_cvt_pk_bf16_f32 v104, v104, v105
    v_cvt_pk_bf16_f32 v105, v106, v107
    v_cvt_pk_bf16_f32 v106, v108, v109
    v_cvt_pk_bf16_f32 v107, v110, v111
    buffer_store_dwordx4 v[104:107], v2, s[8:11], s90 offen sc1
    s_add_u32 s90, s90, s100
    v_pk_mul_f32 v[112:113], v[112:113], s[92:93]
    v_pk_mul_f32 v[114:115], v[114:115], s[92:93]
    v_pk_mul_f32 v[116:117], v[116:117], s[92:93]
    v_pk_mul_f32 v[118:119], v[118:119], s[92:93]
    v_cvt_pk_bf16_f32 v112, v112, v113
    v_cvt_pk_bf16_f32 v113, v114, v115
    v_cvt_pk_bf16_f32 v114, v116, v117
    v_cvt_pk_bf16_f32 v115, v118, v119
    buffer_store_dwordx4 v[112:115], v2, s[8:11], s90 offen sc1
    s_add_u32 s90, s90, s100
    v_pk_mul_f32 v[120:121], v[120:121], s[92:93]
    v_pk_mul_f32 v[122:123], v[122:123], s[92:93]
    v_pk_mul_f32 v[124:125], v[124:125], s[92:93]
    v_pk_mul_f32 v[126:127], v[126:127], s[92:93]
    v_cvt_pk_bf16_f32 v120, v120, v121
    v_cvt_pk_bf16_f32 v121, v122, v123
    v_cvt_pk_bf16_f32 v122, v124, v125
    v_cvt_pk_bf16_f32 v123, v126, v127
    buffer_store_dwordx4 v[120:123], v2, s[8:11], s90 offen sc1
    s_add_u32 s90, s90, s100
    v_pk_mul_f32 v[128:129], v[128:129], s[92:93]
    v_pk_mul_f32 v[130:131], v[130:131], s[92:93]
    v_pk_mul_f32 v[132:133], v[132:133], s[92:93]
    v_pk_mul_f32 v[134:135], v[134:135], s[92:93]
    v_cvt_pk_bf16_f32 v128, v128, v129
    v_cvt_pk_bf16_f32 v129, v130, v131
    v_cvt_pk_bf16_f32 v130, v132, v133
    v_cvt_pk_bf16_f32 v131, v134, v135
    buffer_store_dwordx4 v[128:131], v2, s[8:11], s90 offen sc1
    s_add_u32 s90, s90, s100
    v_pk_mul_f32 v[136:137], v[136:137], s[92:93]
    v_pk_mul_f32 v[138:139], v[138:139], s[92:93]
    v_pk_mul_f32 v[140:141], v[140:141], s[92:93]
    v_pk_mul_f32 v[142:143], v[142:143], s[92:93]
    v_cvt_pk_bf16_f32 v136, v136, v137
    v_cvt_pk_bf16_f32 v137, v138, v139
    v_cvt_pk_bf16_f32 v138, v140, v141
    v_cvt_pk_bf16_f32 v139, v142, v143
    buffer_store_dwordx4 v[136:139], v2, s[8:11], s90 offen sc1
    s_add_u32 s90, s90, s100
    v_pk_mul_f32 v[144:145], v[144:145], s[92:93]
    v_pk_mul_f32 v[146:147], v[146:147], s[92:93]
    v_pk_mul_f32 v[148:149], v[148:149], s[92:93]
    v_pk_mul_f32 v[150:151], v[150:151], s[92:93]
    v_cvt_pk_bf16_f32 v144, v144, v145
    v_cvt_pk_bf16_f32 v145, v146, v147
    v_cvt_pk_bf16_f32 v146, v148, v149
    v_cvt_pk_bf16_f32 v147, v150, v151
    buffer_store_dwordx4 v[144:147], v2, s[8:11], s90 offen sc1
    s_add_u32 s90, s90, s100
    v_pk_mul_f32 v[152:153], v[152:153], s[92:93]
    v_pk_mul_f32 v[154:155], v[154:155], s[92:93]
    v_pk_mul_f32 v[156:157], v[156:157], s[92:93]
    v_pk_mul_f32 v[158:159], v[158:159], s[92:93]
    v_cvt_pk_bf16_f32 v152, v152, v153
    v_cvt_pk_bf16_f32 v153, v154, v155
    v_cvt_pk_bf16_f32 v154, v156, v157
    v_cvt_pk_bf16_f32 v155, v158, v159
    buffer_store_dwordx4 v[152:155], v2, s[8:11], s90 offen sc1
    s_add_u32 s90, s90, s100
    v_pk_mul_f32 v[192:193], v[192:193], s[92:93]
    v_pk_mul_f32 v[194:195], v[194:195], s[92:93]
    v_pk_mul_f32 v[196:197], v[196:197], s[92:93]
    v_pk_mul_f32 v[198:199], v[198:199], s[92:93]
    v_cvt_pk_bf16_f32 v192, v192, v193
    v_cvt_pk_bf16_f32 v193, v194, v195
    v_cvt_pk_bf16_f32 v194, v196, v197
    v_cvt_pk_bf16_f32 v195, v198, v199
    v_pk_mul_f32 v[200:201], v[200:201], s[92:93]
    v_pk_mul_f32 v[202:203], v[202:203], s[92:93]
    v_pk_mul_f32 v[204:205], v[204:205], s[92:93]
    v_pk_mul_f32 v[206:207], v[206:207], s[92:93]
    v_cvt_pk_bf16_f32 v196, v200, v201
    v_cvt_pk_bf16_f32 v197, v202, v203
    v_cvt_pk_bf16_f32 v198, v204, v205
    v_cvt_pk_bf16_f32 v199, v206, v207
    v_pk_mul_f32 v[208:209], v[208:209], s[92:93]
    v_pk_mul_f32 v[210:211], v[210:211], s[92:93]
    v_pk_mul_f32 v[212:213], v[212:213], s[92:93]
    v_pk_mul_f32 v[214:215], v[214:215], s[92:93]
    v_cvt_pk_bf16_f32 v200, v208, v209
    v_cvt_pk_bf16_f32 v201, v210, v211
    v_cvt_pk_bf16_f32 v202, v212, v213
    v_cvt_pk_bf16_f32 v203, v214, v215
    v_pk_mul_f32 v[216:217], v[216:217], s[92:93]
    v_pk_mul_f32 v[218:219], v[218:219], s[92:93]
    v_pk_mul_f32 v[220:221], v[220:221], s[92:93]
    v_pk_mul_f32 v[222:223], v[222:223], s[92:93]
    v_cvt_pk_bf16_f32 v204, v216, v217
    v_cvt_pk_bf16_f32 v205, v218, v219
    v_cvt_pk_bf16_f32 v206, v220, v221
    v_cvt_pk_bf16_f32 v207, v222, v223
    v_pk_mul_f32 v[224:225], v[224:225], s[92:93]
    v_pk_mul_f32 v[226:227], v[226:227], s[92:93]
    v_pk_mul_f32 v[228:229], v[228:229], s[92:93]
    v_pk_mul_f32 v[230:231], v[230:231], s[92:93]
    v_cvt_pk_bf16_f32 v208, v224, v225
    v_cvt_pk_bf16_f32 v209, v226, v227
    v_cvt_pk_bf16_f32 v210, v228, v229
    v_cvt_pk_bf16_f32 v211, v230, v231
    v_pk_mul_f32 v[232:233], v[232:233], s[92:93]
    v_pk_mul_f32 v[234:235], v[234:235], s[92:93]
    v_pk_mul_f32 v[236:237], v[236:237], s[92:93]
    v_pk_mul_f32 v[238:239], v[238:239], s[92:93]
    v_cvt_pk_bf16_f32 v212, v232, v233
    v_cvt_pk_bf16_f32 v213, v234, v235
    v_cvt_pk_bf16_f32 v214, v236, v237
    v_cvt_pk_bf16_f32 v215, v238, v239
    v_pk_mul_f32 v[240:241], v[240:241], s[92:93]
    v_pk_mul_f32 v[242:243], v[242:243], s[92:93]
    v_pk_mul_f32 v[244:245], v[244:245], s[92:93]
    v_pk_mul_f32 v[246:247], v[246:247], s[92:93]
    v_cvt_pk_bf16_f32 v216, v240, v241
    v_cvt_pk_bf16_f32 v217, v242, v243
    v_cvt_pk_bf16_f32 v218, v244, v245
    v_cvt_pk_bf16_f32 v219, v246, v247
    v_pk_mul_f32 v[248:249], v[248:249], s[92:93]
    v_pk_mul_f32 v[250:251], v[250:251], s[92:93]
    v_pk_mul_f32 v[252:253], v[252:253], s[92:93]
    v_pk_mul_f32 v[254:255], v[254:255], s[92:93]
    v_cvt_pk_bf16_f32 v220, v248, v249
    v_cvt_pk_bf16_f32 v221, v250, v251
    v_cvt_pk_bf16_f32 v222, v252, v253
    v_cvt_pk_bf16_f32 v223, v254, v255
    v_accvgpr_read_b32 v24, a96
    v_accvgpr_read_b32 v25, a97
    v_accvgpr_read_b32 v26, a98
    v_accvgpr_read_b32 v27, a99
    v_accvgpr_read_b32 v28, a100
    v_accvgpr_read_b32 v29, a101
    v_accvgpr_read_b32 v30, a102
    v_accvgpr_read_b32 v31, a103
    v_pk_mul_f32 v[24:25], v[24:25], s[92:93]
    v_pk_mul_f32 v[26:27], v[26:27], s[92:93]
    v_pk_mul_f32 v[28:29], v[28:29], s[92:93]
    v_pk_mul_f32 v[30:31], v[30:31], s[92:93]
    v_cvt_pk_bf16_f32 v224, v24, v25
    v_cvt_pk_bf16_f32 v225, v26, v27
    v_cvt_pk_bf16_f32 v226, v28, v29
    v_cvt_pk_bf16_f32 v227, v30, v31
    v_accvgpr_read_b32 v24, a104
    v_accvgpr_read_b32 v25, a105
    v_accvgpr_read_b32 v26, a106
    v_accvgpr_read_b32 v27, a107
    v_accvgpr_read_b32 v28, a108
    v_accvgpr_read_b32 v29, a109
    v_accvgpr_read_b32 v30, a110
    v_accvgpr_read_b32 v31, a111
    v_pk_mul_f32 v[24:25], v[24:25], s[92:93]
    v_pk_mul_f32 v[26:27], v[26:27], s[92:93]
    v_pk_mul_f32 v[28:29], v[28:29], s[92:93]
    v_pk_mul_f32 v[30:31], v[30:31], s[92:93]
    v_cvt_pk_bf16_f32 v228, v24, v25
    v_cvt_pk_bf16_f32 v229, v26, v27
    v_cvt_pk_bf16_f32 v230, v28, v29
    v_cvt_pk_bf16_f32 v231, v30, v31
    v_accvgpr_read_b32 v24, a112
    v_accvgpr_read_b32 v25, a113
    v_accvgpr_read_b32 v26, a114
    v_accvgpr_read_b32 v27, a115
    v_accvgpr_read_b32 v28, a116
    v_accvgpr_read_b32 v29, a117
    v_accvgpr_read_b32 v30, a118
    v_accvgpr_read_b32 v31, a119
    v_pk_mul_f32 v[24:25], v[24:25], s[92:93]
    v_pk_mul_f32 v[26:27], v[26:27], s[92:93]
    v_pk_mul_f32 v[28:29], v[28:29], s[92:93]
    v_pk_mul_f32 v[30:31], v[30:31], s[92:93]
    v_cvt_pk_bf16_f32 v232, v24, v25
    v_cvt_pk_bf16_f32 v233, v26, v27
    v_cvt_pk_bf16_f32 v234, v28, v29
    v_cvt_pk_bf16_f32 v235, v30, v31
    v_accvgpr_read_b32 v24, a120
    v_accvgpr_read_b32 v25, a121
    v_accvgpr_read_b32 v26, a122
    v_accvgpr_read_b32 v27, a123
    v_accvgpr_read_b32 v28, a124
    v_accvgpr_read_b32 v29, a125
    v_accvgpr_read_b32 v30, a126
    v_accvgpr_read_b32 v31, a127
    v_pk_mul_f32 v[24:25], v[24:25], s[92:93]
    v_pk_mul_f32 v[26:27], v[26:27], s[92:93]
    v_pk_mul_f32 v[28:29], v[28:29], s[92:93]
    v_pk_mul_f32 v[30:31], v[30:31], s[92:93]
    v_cvt_pk_bf16_f32 v236, v24, v25
    v_cvt_pk_bf16_f32 v237, v26, v27
    v_cvt_pk_bf16_f32 v238, v28, v29
    v_cvt_pk_bf16_f32 v239, v30, v31
    v_pk_mul_f32 v[160:161], v[160:161], s[92:93]
    v_pk_mul_f32 v[162:163], v[162:163], s[92:93]
    v_pk_mul_f32 v[164:165], v[164:165], s[92:93]
    v_pk_mul_f32 v[166:167], v[166:167], s[92:93]
    v_cvt_pk_bf16_f32 v240, v160, v161
    v_cvt_pk_bf16_f32 v241, v162, v163
    v_cvt_pk_bf16_f32 v242, v164, v165
    v_cvt_pk_bf16_f32 v243, v166, v167
    v_pk_mul_f32 v[168:169], v[168:169], s[92:93]
    v_pk_mul_f32 v[170:171], v[170:171], s[92:93]
    v_pk_mul_f32 v[172:173], v[172:173], s[92:93]
    v_pk_mul_f32 v[174:175], v[174:175], s[92:93]
    v_cvt_pk_bf16_f32 v244, v168, v169
    v_cvt_pk_bf16_f32 v245, v170, v171
    v_cvt_pk_bf16_f32 v246, v172, v173
    v_cvt_pk_bf16_f32 v247, v174, v175
    v_pk_mul_f32 v[176:177], v[176:177], s[92:93]
    v_pk_mul_f32 v[178:179], v[178:179], s[92:93]
    v_pk_mul_f32 v[180:181], v[180:181], s[92:93]
    v_pk_mul_f32 v[182:183], v[182:183], s[92:93]
    v_cvt_pk_bf16_f32 v248, v176, v177
    v_cvt_pk_bf16_f32 v249, v178, v179
    v_cvt_pk_bf16_f32 v250, v180, v181
    v_cvt_pk_bf16_f32 v251, v182, v183
    v_pk_mul_f32 v[184:185], v[184:185], s[92:93]
    v_pk_mul_f32 v[186:187], v[186:187], s[92:93]
    v_pk_mul_f32 v[188:189], v[188:189], s[92:93]
    v_pk_mul_f32 v[190:191], v[190:191], s[92:93]
    v_cvt_pk_bf16_f32 v252, v184, v185
    v_cvt_pk_bf16_f32 v253, v186, v187
    v_cvt_pk_bf16_f32 v254, v188, v189
    v_cvt_pk_bf16_f32 v255, v190, v191
    s_setpc_b64 s[20:21]
mega_kernel_ns254:
    s_mov_b32 s90, s98
    v_cvt_pk_bf16_f32 v32, v32, v33
    v_cvt_pk_bf16_f32 v33, v34, v35
    v_cvt_pk_bf16_f32 v34, v36, v37
    v_cvt_pk_bf16_f32 v35, v38, v39
    buffer_store_dwordx4 v[32:35], v2, s[8:11], s90 offen sc1
    s_add_u32 s90, s90, s100
    v_cvt_pk_bf16_f32 v40, v40, v41
    v_cvt_pk_bf16_f32 v41, v42, v43
    v_cvt_pk_bf16_f32 v42, v44, v45
    v_cvt_pk_bf16_f32 v43, v46, v47
    buffer_store_dwordx4 v[40:43], v2, s[8:11], s90 offen sc1
    s_add_u32 s90, s90, s100
    v_cvt_pk_bf16_f32 v48, v48, v49
    v_cvt_pk_bf16_f32 v49, v50, v51
    v_cvt_pk_bf16_f32 v50, v52, v53
    v_cvt_pk_bf16_f32 v51, v54, v55
    buffer_store_dwordx4 v[48:51], v2, s[8:11], s90 offen sc1
    s_add_u32 s90, s90, s100
    v_cvt_pk_bf16_f32 v56, v56, v57
    v_cvt_pk_bf16_f32 v57, v58, v59
    v_cvt_pk_bf16_f32 v58, v60, v61
    v_cvt_pk_bf16_f32 v59, v62, v63
    buffer_store_dwordx4 v[56:59], v2, s[8:11], s90 offen sc1
    s_add_u32 s90, s90, s100
    v_cvt_pk_bf16_f32 v64, v64, v65
    v_cvt_pk_bf16_f32 v65, v66, v67
    v_cvt_pk_bf16_f32 v66, v68, v69
    v_cvt_pk_bf16_f32 v67, v70, v71
    buffer_store_dwordx4 v[64:67], v2, s[8:11], s90 offen sc1
    s_add_u32 s90, s90, s100
    v_cvt_pk_bf16_f32 v72, v72, v73
    v_cvt_pk_bf16_f32 v73, v74, v75
    v_cvt_pk_bf16_f32 v74, v76, v77
    v_cvt_pk_bf16_f32 v75, v78, v79
    buffer_store_dwordx4 v[72:75], v2, s[8:11], s90 offen sc1
    s_add_u32 s90, s90, s100
    v_cvt_pk_bf16_f32 v80, v80, v81
    v_cvt_pk_bf16_f32 v81, v82, v83
    v_cvt_pk_bf16_f32 v82, v84, v85
    v_cvt_pk_bf16_f32 v83, v86, v87
    buffer_store_dwordx4 v[80:83], v2, s[8:11], s90 offen sc1
    s_add_u32 s90, s90, s100
    v_cvt_pk_bf16_f32 v88, v88, v89
    v_cvt_pk_bf16_f32 v89, v90, v91
    v_cvt_pk_bf16_f32 v90, v92, v93
    v_cvt_pk_bf16_f32 v91, v94, v95
    buffer_store_dwordx4 v[88:91], v2, s[8:11], s90 offen sc1
    s_add_u32 s90, s98, s99
    v_cvt_pk_bf16_f32 v96, v96, v97
    v_cvt_pk_bf16_f32 v97, v98, v99
    v_cvt_pk_bf16_f32 v98, v100, v101
    v_cvt_pk_bf16_f32 v99, v102, v103
    buffer_store_dwordx4 v[96:99], v2, s[8:11], s90 offen sc1
    s_add_u32 s90, s90, s100
    v_cvt_pk_bf16_f32 v104, v104, v105
    v_cvt_pk_bf16_f32 v105, v106, v107
    v_cvt_pk_bf16_f32 v106, v108, v109
    v_cvt_pk_bf16_f32 v107, v110, v111
    buffer_store_dwordx4 v[104:107], v2, s[8:11], s90 offen sc1
    s_add_u32 s90, s90, s100
    v_cvt_pk_bf16_f32 v112, v112, v113
    v_cvt_pk_bf16_f32 v113, v114, v115
    v_cvt_pk_bf16_f32 v114, v116, v117
    v_cvt_pk_bf16_f32 v115, v118, v119
    buffer_store_dwordx4 v[112:115], v2, s[8:11], s90 offen sc1
    s_add_u32 s90, s90, s100
    v_cvt_pk_bf16_f32 v120, v120, v121
    v_cvt_pk_bf16_f32 v121, v122, v123
    v_cvt_pk_bf16_f32 v122, v124, v125
    v_cvt_pk_bf16_f32 v123, v126, v127
    buffer_store_dwordx4 v[120:123], v2, s[8:11], s90 offen sc1
    s_add_u32 s90, s90, s100
    v_cvt_pk_bf16_f32 v128, v128, v129
    v_cvt_pk_bf16_f32 v129, v130, v131
    v_cvt_pk_bf16_f32 v130, v132, v133
    v_cvt_pk_bf16_f32 v131, v134, v135
    buffer_store_dwordx4 v[128:131], v2, s[8:11], s90 offen sc1
    s_add_u32 s90, s90, s100
    v_cvt_pk_bf16_f32 v136, v136, v137
    v_cvt_pk_bf16_f32 v137, v138, v139
    v_cvt_pk_bf16_f32 v138, v140, v141
    v_cvt_pk_bf16_f32 v139, v142, v143
    buffer_store_dwordx4 v[136:139], v2, s[8:11], s90 offen sc1
    s_add_u32 s90, s90, s100
    v_cvt_pk_bf16_f32 v144, v144, v145
    v_cvt_pk_bf16_f32 v145, v146, v147
    v_cvt_pk_bf16_f32 v146, v148, v149
    v_cvt_pk_bf16_f32 v147, v150, v151
    buffer_store_dwordx4 v[144:147], v2, s[8:11], s90 offen sc1
    s_add_u32 s90, s90, s100
    v_cvt_pk_bf16_f32 v152, v152, v153
    v_cvt_pk_bf16_f32 v153, v154, v155
    v_cvt_pk_bf16_f32 v154, v156, v157
    v_cvt_pk_bf16_f32 v155, v158, v159
    buffer_store_dwordx4 v[152:155], v2, s[8:11], s90 offen sc1
    s_add_u32 s90, s90, s100
    v_cvt_pk_bf16_f32 v192, v192, v193
    v_cvt_pk_bf16_f32 v193, v194, v195
    v_cvt_pk_bf16_f32 v194, v196, v197
    v_cvt_pk_bf16_f32 v195, v198, v199
    v_cvt_pk_bf16_f32 v196, v200, v201
    v_cvt_pk_bf16_f32 v197, v202, v203
    v_cvt_pk_bf16_f32 v198, v204, v205
    v_cvt_pk_bf16_f32 v199, v206, v207
    v_cvt_pk_bf16_f32 v200, v208, v209
    v_cvt_pk_bf16_f32 v201, v210, v211
    v_cvt_pk_bf16_f32 v202, v212, v213
    v_cvt_pk_bf16_f32 v203, v214, v215
    v_cvt_pk_bf16_f32 v204, v216, v217
    v_cvt_pk_bf16_f32 v205, v218, v219
    v_cvt_pk_bf16_f32 v206, v220, v221
    v_cvt_pk_bf16_f32 v207, v222, v223
    v_cvt_pk_bf16_f32 v208, v224, v225
    v_cvt_pk_bf16_f32 v209, v226, v227
    v_cvt_pk_bf16_f32 v210, v228, v229
    v_cvt_pk_bf16_f32 v211, v230, v231
    v_cvt_pk_bf16_f32 v212, v232, v233
    v_cvt_pk_bf16_f32 v213, v234, v235
    v_cvt_pk_bf16_f32 v214, v236, v237
    v_cvt_pk_bf16_f32 v215, v238, v239
    v_cvt_pk_bf16_f32 v216, v240, v241
    v_cvt_pk_bf16_f32 v217, v242, v243
    v_cvt_pk_bf16_f32 v218, v244, v245
    v_cvt_pk_bf16_f32 v219, v246, v247
    v_cvt_pk_bf16_f32 v220, v248, v249
    v_cvt_pk_bf16_f32 v221, v250, v251
    v_cvt_pk_bf16_f32 v222, v252, v253
    v_cvt_pk_bf16_f32 v223, v254, v255
    v_accvgpr_read_b32 v24, a96
    v_accvgpr_read_b32 v25, a97
    v_accvgpr_read_b32 v26, a98
    v_accvgpr_read_b32 v27, a99
    v_accvgpr_read_b32 v28, a100
    v_accvgpr_read_b32 v29, a101
    v_accvgpr_read_b32 v30, a102
    v_accvgpr_read_b32 v31, a103
    v_cvt_pk_bf16_f32 v224, v24, v25
    v_cvt_pk_bf16_f32 v225, v26, v27
    v_cvt_pk_bf16_f32 v226, v28, v29
    v_cvt_pk_bf16_f32 v227, v30, v31
    v_accvgpr_read_b32 v24, a104
    v_accvgpr_read_b32 v25, a105
    v_accvgpr_read_b32 v26, a106
    v_accvgpr_read_b32 v27, a107
    v_accvgpr_read_b32 v28, a108
    v_accvgpr_read_b32 v29, a109
    v_accvgpr_read_b32 v30, a110
    v_accvgpr_read_b32 v31, a111
    v_cvt_pk_bf16_f32 v228, v24, v25
    v_cvt_pk_bf16_f32 v229, v26, v27
    v_cvt_pk_bf16_f32 v230, v28, v29
    v_cvt_pk_bf16_f32 v231, v30, v31
    v_accvgpr_read_b32 v24, a112
    v_accvgpr_read_b32 v25, a113
    v_accvgpr_read_b32 v26, a114
    v_accvgpr_read_b32 v27, a115
    v_accvgpr_read_b32 v28, a116
    v_accvgpr_read_b32 v29, a117
    v_accvgpr_read_b32 v30, a118
    v_accvgpr_read_b32 v31, a119
    v_cvt_pk_bf16_f32 v232, v24, v25
    v_cvt_pk_bf16_f32 v233, v26, v27
    v_cvt_pk_bf16_f32 v234, v28, v29
    v_cvt_pk_bf16_f32 v235, v30, v31
    v_accvgpr_read_b32 v24, a120
    v_accvgpr_read_b32 v25, a121
    v_accvgpr_read_b32 v26, a122
    v_accvgpr_read_b32 v27, a123
    v_accvgpr_read_b32 v28, a124
    v_accvgpr_read_b32 v29, a125
    v_accvgpr_read_b32 v30, a126
    v_accvgpr_read_b32 v31, a127
    v_cvt_pk_bf16_f32 v236, v24, v25
    v_cvt_pk_bf16_f32 v237, v26, v27
    v_cvt_pk_bf16_f32 v238, v28, v29
    v_cvt_pk_bf16_f32 v239, v30, v31
    v_cvt_pk_bf16_f32 v240, v160, v161
    v_cvt_pk_bf16_f32 v241, v162, v163
    v_cvt_pk_bf16_f32 v242, v164, v165
    v_cvt_pk_bf16_f32 v243, v166, v167
    v_cvt_pk_bf16_f32 v244, v168, v169
    v_cvt_pk_bf16_f32 v245, v170, v171
    v_cvt_pk_bf16_f32 v246, v172, v173
    v_cvt_pk_bf16_f32 v247, v174, v175
    v_cvt_pk_bf16_f32 v248, v176, v177
    v_cvt_pk_bf16_f32 v249, v178, v179
    v_cvt_pk_bf16_f32 v250, v180, v181
    v_cvt_pk_bf16_f32 v251, v182, v183
    v_cvt_pk_bf16_f32 v252, v184, v185
    v_cvt_pk_bf16_f32 v253, v186, v187
    v_cvt_pk_bf16_f32 v254, v188, v189
    v_cvt_pk_bf16_f32 v255, v190, v191
    s_setpc_b64 s[20:21]
mega_kernel_end:
.text
.globl gemm3_kernel
.p2align 8
.type gemm3_kernel,@function
gemm3_kernel:
    s_cmp_ge_u32 s2, 256
    s_cbranch_scc1 gemm3_kernel_end1
    s_load_dwordx8 s[4:11], s[0:1], 64
    s_load_dwordx2 s[12:13], s[0:1], 16
    v_and_b32 v1, 63, v0
    v_lshrrev_b32 v16, 6, v0
    s_nop 0
    v_readfirstlane_b32 s32, v16
    s_nop 3
    s_lshr_b32 s36, s32, 2
    s_and_b32 s32, s32, 3
    s_bfe_u32 s35, s2, 0x10002
    s_xor_b32 s35, s35, 1
    s_bfe_u32 s48, s2, 0x10001
    s_lshl_b32 s48, s48, 3
    s_bfe_u32 s49, s2, 0x30003
    s_add_u32 s37, s48, s49
    s_and_b32 s48, s2, 1
    s_lshl_b32 s48, s48, 2
    s_lshr_b32 s49, s2, 6
    s_add_u32 s38, s48, s49
    s_lshr_b32 s33, s32, 1
    s_and_b32 s34, s32, 1
    v_lshlrev_b32 v7, 4, v1
    s_cmp_eq_u32 s36, 1
    s_cbranch_scc1 gemm3_kernel_load2
    s_lshl_b32 s39, s37, 3
    s_add_u32 s39, s39, s38
    s_lshl_b32 s48, s33, 12
    v_add_u32 v2, s48, v7
    v_lshrrev_b32 v16, 2, v1
    v_lshlrev_b32 v16, 8, v16
    v_and_b32 v17, 3, v1
    v_lshl_add_u32 v16, v17, 3, v16
    v_add_u32 v16, 16384, v16
    v_bfe_u32 v17, v1, 2, 3
    s_lshl_b32 s48, s34, 2
    v_xor_b32 v17, s48, v17
    v_xor_b32 v18, 0, v17
    v_lshl_add_u32 v3, v18, 5, v16
    v_xor_b32 v18, 1, v17
    v_lshl_add_u32 v4, v18, 5, v16
    v_xor_b32 v18, 2, v17
    v_lshl_add_u32 v5, v18, 5, v16
    v_xor_b32 v18, 3, v17
    v_lshl_add_u32 v6, v18, 5, v16
    s_mov_b32 s43, 0
    s_mov_b32 s56, 32768
    s_cmp_eq_u32 s35, 1
    s_cselect_b32 s47, 38, 40
    v_mov_b32 v32, 0
    v_mov_b32 v33, 0
    v_mov_b32 v34, 0
    v_mov_b32 v35, 0
    v_mov_b32 v36, 0
    v_mov_b32 v37, 0
    v_mov_b32 v38, 0
    v_mov_b32 v39, 0
    v_mov_b32 v40, 0
    v_mov_b32 v41, 0
    v_mov_b32 v42, 0
    v_mov_b32 v43, 0
    v_mov_b32 v44, 0
    v_mov_b32 v45, 0
    v_mov_b32 v46, 0
    v_mov_b32 v47, 0
    v_mov_b32 v48, 0
    v_mov_b32 v49, 0
    v_mov_b32 v50, 0
    v_mov_b32 v51, 0
    v_mov_b32 v52, 0
    v_mov_b32 v53, 0
    v_mov_b32 v54, 0
    v_mov_b32 v55, 0
    v_mov_b32 v56, 0
    v_mov_b32 v57, 0
    v_mov_b32 v58, 0
    v_mov_b32 v59, 0
    v_mov_b32 v60, 0
    v_mov_b32 v61, 0
    v_mov_b32 v62, 0
    v_mov_b32 v63, 0
    v_mov_b32 v64, 0
    v_mov_b32 v65, 0
    v_mov_b32 v66, 0
    v_mov_b32 v67, 0
    v_mov_b32 v68, 0
    v_mov_b32 v69, 0
    v_mov_b32 v70, 0
    v_mov_b32 v71, 0
    v_mov_b32 v72, 0
    v_mov_b32 v73, 0
    v_mov_b32 v74, 0
    v_mov_b32 v75, 0
    v_mov_b32 v76, 0
    v_mov_b32 v77, 0
    v_mov_b32 v78, 0
    v_mov_b32 v79, 0
    v_mov_b32 v80, 0
    v_mov_b32 v81, 0
    v_mov_b32 v82, 0
    v_mov_b32 v83, 0
    v_mov_b32 v84, 0
    v_mov_b32 v85, 0
    v_mov_b32 v86, 0
    v_mov_b32 v87, 0
    v_mov_b32 v88, 0
    v_mov_b32 v89, 0
    v_mov_b32 v90, 0
    v_mov_b32 v91, 0
    v_mov_b32 v92, 0
    v_mov_b32 v93, 0
    v_mov_b32 v94, 0
    v_mov_b32 v95, 0
    v_and_b32 v16, 15, v1
    v_lshlrev_b32 v16, 12, v16
    v_lshlrev_b32 v16, s35, v16
    v_bfe_u32 v17, v1, 4, 1
    v_lshl_add_u32 v16, v17, 5, v16
    v_lshrrev_b32 v17, 5, v1
    v_lshl_add_u32 v12, v17, 4, v16
    s_lshl_b32 s48, s37, 3
    s_lshl_b32 s49, s33, 2
    s_add_u32 s48, s48, s49
    s_lshl_b32 s49, s48, 16
    s_add_u32 s49, s49, 2048
    s_and_b32 s50, s48, 63
    s_lshl_b32 s50, s50, 17
    s_lshr_b32 s51, s48, 6
    s_lshl_b32 s51, s51, 12
    s_add_u32 s50, s50, s51
    s_cmp_eq_u32 s35, 1
    s_cselect_b32 s41, s50, s49
    s_lshl_b32 s42, 0x10000, s35
    s_lshl_b32 s50, s38, 8
    s_lshl_b32 s51, s34, 7
    s_add_u32 s41, s41, s50
    s_add_u32 s41, s41, s51
    s_cmp_eq_u32 s35, 1
    s_cselect_b32 s57, 23, 35
    s_cselect_b32 s58, 0, 16
    s_waitcnt lgkmcnt(0)
    s_mov_b32 s24, s6
    s_mov_b32 s25, s7
    s_mov_b32 s27, 0x20000
    s_mov_b32 s26, 8388608
    s_mov_b32 s28, s10
    s_mov_b32 s29, s11
    s_mov_b32 s31, 0x20000
    s_mov_b32 s30, 268435456
    s_setprio 1
    s_barrier
    ds_read_b128 v[96:99], v2 offset:0
    ds_read_b64_tr_b16 v[112:113], v3 offset:0
    ds_read_b64_tr_b16 v[114:115], v3 offset:4096
    ds_read_b128 v[100:103], v2 offset:1024
    ds_read_b128 v[104:107], v2 offset:2048
    ds_read_b128 v[108:111], v2 offset:3072
    ds_read_b64_tr_b16 v[116:117], v4 offset:0
    ds_read_b64_tr_b16 v[118:119], v4 offset:4096
    ds_read_b64_tr_b16 v[120:121], v5 offset:0
    ds_read_b64_tr_b16 v[122:123], v5 offset:4096
    ds_read_b64_tr_b16 v[124:125], v6 offset:0
    ds_read_b64_tr_b16 v[126:127], v6 offset:4096
gemm3_kernel_loop3:
    s_sub_u32 s57, s57, 1
    s_cbranch_scc1 gemm3_kernel_ev4
gemm3_kernel_back5:
    s_waitcnt lgkmcnt(9)
    v_mfma_f32_16x16x32_bf16 v[32:35], v[112:115], v[96:99], v[32:35]
    ds_read_b128 v[128:131], v2 offset:8192
    s_waitcnt lgkmcnt(9)
    v_mfma_f32_16x16x32_bf16 v[40:43], v[112:115], v[100:103], v[40:43]
    ds_read_b64_tr_b16 v[144:145], v3 offset:8192
    s_waitcnt lgkmcnt(9)
    v_mfma_f32_16x16x32_bf16 v[48:51], v[112:115], v[104:107], v[48:51]
    ds_read_b64_tr_b16 v[146:147], v3 offset:12288
    s_waitcnt lgkmcnt(9)
    v_mfma_f32_16x16x32_bf16 v[56:59], v[112:115], v[108:111], v[56:59]
    ds_read_b128 v[132:135], v2 offset:9216
    s_waitcnt lgkmcnt(8)
    v_mfma_f32_16x16x32_bf16 v[36:39], v[116:119], v[96:99], v[36:39]
    ds_read_b128 v[136:139], v2 offset:10240
    v_mfma_f32_16x16x32_bf16 v[44:47], v[116:119], v[100:103], v[44:47]
    ds_read_b128 v[140:143], v2 offset:11264
    v_mfma_f32_16x16x32_bf16 v[52:55], v[116:119], v[104:107], v[52:55]
    ds_read_b64_tr_b16 v[148:149], v4 offset:8192
    v_mfma_f32_16x16x32_bf16 v[60:63], v[116:119], v[108:111], v[60:63]
    ds_read_b64_tr_b16 v[150:151], v4 offset:12288
    s_waitcnt lgkmcnt(10)
    v_mfma_f32_16x16x32_bf16 v[64:67], v[120:123], v[96:99], v[64:67]
    s_add_u32 s43, s43, 32768
    ds_read_b64_tr_b16 v[152:153], v5 offset:8192
    v_mfma_f32_16x16x32_bf16 v[72:75], v[120:123], v[100:103], v[72:75]
    s_cmp_ge_u32 s43, 163840
    ds_read_b64_tr_b16 v[154:155], v5 offset:12288
    v_mfma_f32_16x16x32_bf16 v[80:83], v[120:123], v[104:107], v[80:83]
    s_cselect_b32 s46, 4294836224, s56
    ds_read_b64_tr_b16 v[156:157], v6 offset:8192
    v_mfma_f32_16x16x32_bf16 v[88:91], v[120:123], v[108:111], v[88:91]
    s_cselect_b32 s43, 0, s43
    ds_read_b64_tr_b16 v[158:159], v6 offset:12288
    s_waitcnt lgkmcnt(12)
    v_mfma_f32_16x16x32_bf16 v[68:71], v[124:127], v[96:99], v[68:71]
    v_add_u32 v2, s46, v2
    v_add_u32 v3, s46, v3
    v_mfma_f32_16x16x32_bf16 v[76:79], v[124:127], v[100:103], v[76:79]
    v_add_u32 v4, s46, v4
    v_add_u32 v5, s46, v5
    v_mfma_f32_16x16x32_bf16 v[84:87], v[124:127], v[104:107], v[84:87]
    v_add_u32 v6, s46, v6
    v_mfma_f32_16x16x32_bf16 v[92:95], v[124:127], v[108:111], v[92:95]
    s_waitcnt lgkmcnt(0)
    v_mfma_f32_16x16x32_bf16 v[32:35], v[144:147], v[128:131], v[32:35]
    s_barrier
    v_mfma_f32_16x16x32_bf16 v[40:43], v[144:147], v[132:135], v[40:43]
    ds_read_b128 v[96:99], v2 offset:0
    v_mfma_f32_16x16x32_bf16 v[48:51], v[144:147], v[136:139], v[48:51]
    ds_read_b64_tr_b16 v[112:113], v3 offset:0
    v_mfma_f32_16x16x32_bf16 v[56:59], v[144:147], v[140:143], v[56:59]
    ds_read_b64_tr_b16 v[114:115], v3 offset:4096
    v_mfma_f32_16x16x32_bf16 v[36:39], v[148:151], v[128:131], v[36:39]
    ds_read_b128 v[100:103], v2 offset:1024
    v_mfma_f32_16x16x32_bf16 v[44:47], v[148:151], v[132:135], v[44:47]
    ds_read_b128 v[104:107], v2 offset:2048
    v_mfma_f32_16x16x32_bf16 v[52:55], v[148:151], v[136:139], v[52:55]
    ds_read_b128 v[108:111], v2 offset:3072
    v_mfma_f32_16x16x32_bf16 v[60:63], v[148:151], v[140:143], v[60:63]
    ds_read_b64_tr_b16 v[116:117], v4 offset:0
    v_mfma_f32_16x16x32_bf16 v[64:67], v[152:155], v[128:131], v[64:67]
    ds_read_b64_tr_b16 v[118:119], v4 offset:4096
    v_mfma_f32_16x16x32_bf16 v[72:75], v[152:155], v[132:135], v[72:75]
    ds_read_b64_tr_b16 v[120:121], v5 offset:0
    v_mfma_f32_16x16x32_bf16 v[80:83], v[152:155], v[136:139], v[80:83]
    ds_read_b64_tr_b16 v[122:123], v5 offset:4096
    v_mfma_f32_16x16x32_bf16 v[88:91], v[152:155], v[140:143], v[88:91]
    ds_read_b64_tr_b16 v[124:125], v6 offset:0
    v_mfma_f32_16x16x32_bf16 v[68:71], v[156:159], v[128:131], v[68:71]
    ds_read_b64_tr_b16 v[126:127], v6 offset:4096
    v_mfma_f32_16x16x32_bf16 v[76:79], v[156:159], v[132:135], v[76:79]
    v_mfma_f32_16x16x32_bf16 v[84:87], v[156:159], v[136:139], v[84:87]
    s_sub_u32 s47, s47, 1
    v_mfma_f32_16x16x32_bf16 v[92:95], v[156:159], v[140:143], v[92:95]
    s_cbranch_scc0 gemm3_kernel_loop3
    s_nop 5
    s_cmp_eq_u32 s35, 1
    s_cbranch_scc1 gemm3_kernel_noadd7
    s_waitcnt vmcnt(0) lgkmcnt(0)
    v_lshlrev_b32 v96, 16, v160
    v_and_b32 v97, 0xffff0000, v160
    v_lshlrev_b32 v98, 16, v161
    v_and_b32 v99, 0xffff0000, v161
    v_lshlrev_b32 v100, 16, v162
    v_and_b32 v101, 0xffff0000, v162
    v_lshlrev_b32 v102, 16, v163
    v_and_b32 v103, 0xffff0000, v163
    v_lshlrev_b32 v104, 16, v164
    v_and_b32 v105, 0xffff0000, v164
    v_lshlrev_b32 v106, 16, v165
    v_and_b32 v107, 0xffff0000, v165
    v_lshlrev_b32 v108, 16, v166
    v_and_b32 v109, 0xffff0000, v166
    v_lshlrev_b32 v110, 16, v167
    v_and_b32 v111, 0xffff0000, v167
    v_lshlrev_b32 v112, 16, v168
    v_and_b32 v113, 0xffff0000, v168
    v_lshlrev_b32 v114, 16, v169
    v_and_b32 v115, 0xffff0000, v169
    v_lshlrev_b32 v116, 16, v170
    v_and_b32 v117, 0xffff0000, v170
    v_lshlrev_b32 v118, 16, v171
    v_and_b32 v119, 0xffff0000, v171
    v_lshlrev_b32 v120, 16, v172
    v_and_b32 v121, 0xffff0000, v172
    v_lshlrev_b32 v122, 16, v173
    v_and_b32 v123, 0xffff0000, v173
    v_lshlrev_b32 v124, 16, v174
    v_and_b32 v125, 0xffff0000, v174
    v_lshlrev_b32 v126, 16, v175
    v_and_b32 v127, 0xffff0000, v175
    v_lshlrev_b32 v128, 16, v176
    v_and_b32 v129, 0xffff0000, v176
    v_lshlrev_b32 v130, 16, v177
    v_and_b32 v131, 0xffff0000, v177
    v_lshlrev_b32 v132, 16, v178
    v_and_b32 v133, 0xffff0000, v178
    v_lshlrev_b32 v134, 16, v179
    v_and_b32 v135, 0xffff0000, v179
    v_lshlrev_b32 v136, 16, v180
    v_and_b32 v137, 0xffff0000, v180
    v_lshlrev_b32 v138, 16, v181
    v_and_b32 v139, 0xffff0000, v181
    v_lshlrev_b32 v140, 16, v182
    v_and_b32 v141, 0xffff0000, v182
    v_lshlrev_b32 v142, 16, v183
    v_and_b32 v143, 0xffff0000, v183
    v_lshlrev_b32 v144, 16, v184
    v_and_b32 v145, 0xffff0000, v184
    v_lshlrev_b32 v146, 16, v185
    v_and_b32 v147, 0xffff0000, v185
    v_lshlrev_b32 v148, 16, v186
    v_and_b32 v149, 0xffff0000, v186
    v_lshlrev_b32 v150, 16, v187
    v_and_b32 v151, 0xffff0000, v187
    v_lshlrev_b32 v152, 16, v188
    v_and_b32 v153, 0xffff0000, v188
    v_lshlrev_b32 v154, 16, v189
    v_and_b32 v155, 0xffff0000, v189
    v_lshlrev_b32 v156, 16, v190
    v_and_b32 v157, 0xffff0000, v190
    v_lshlrev_b32 v158, 16, v191
    v_and_b32 v159, 0xffff0000, v191
    v_pk_add_f32 v[32:33], v[32:33], v[96:97]
    v_pk_add_f32 v[34:35], v[34:35], v[98:99]
    v_pk_add_f32 v[36:37], v[36:37], v[100:101]
    v_pk_add_f32 v[38:39], v[38:39], v[102:103]
    v_pk_add_f32 v[40:41], v[40:41], v[104:105]
    v_pk_add_f32 v[42:43], v[42:43], v[106:107]
    v_pk_add_f32 v[44:45], v[44:45], v[108:109]
    v_pk_add_f32 v[46:47], v[46:47], v[110:111]
    v_pk_add_f32 v[48:49], v[48:49], v[112:113]
    v_pk_add_f32 v[50:51], v[50:51], v[114:115]
    v_pk_add_f32 v[52:53], v[52:53], v[116:117]
    v_pk_add_f32 v[54:55], v[54:55], v[118:119]
    v_pk_add_f32 v[56:57], v[56:57], v[120:121]
    v_pk_add_f32 v[58:59], v[58:59], v[122:123]
    v_pk_add_f32 v[60:61], v[60:61], v[124:125]
    v_pk_add_f32 v[62:63], v[62:63], v[126:127]
    v_pk_add_f32 v[64:65], v[64:65], v[128:129]
    v_pk_add_f32 v[66:67], v[66:67], v[130:131]
    v_pk_add_f32 v[68:69], v[68:69], v[132:133]
    v_pk_add_f32 v[70:71], v[70:71], v[134:135]
    v_pk_add_f32 v[72:73], v[72:73], v[136:137]
    v_pk_add_f32 v[74:75], v[74:75], v[138:139]
    v_pk_add_f32 v[76:77], v[76:77], v[140:141]
    v_pk_add_f32 v[78:79], v[78:79], v[142:143]
    v_pk_add_f32 v[80:81], v[80:81], v[144:145]
    v_pk_add_f32 v[82:83], v[82:83], v[146:147]
    v_pk_add_f32 v[84:85], v[84:85], v[148:149]
    v_pk_add_f32 v[86:87], v[86:87], v[150:151]
    v_pk_add_f32 v[88:89], v[88:89], v[152:153]
    v_pk_add_f32 v[90:91], v[90:91], v[154:155]
    v_pk_add_f32 v[92:93], v[92:93], v[156:157]
    v_pk_add_f32 v[94:95], v[94:95], v[158:159]
gemm3_kernel_noadd7:
    v_cvt_pk_bf16_f32 v32, v32, v33
    v_cvt_pk_bf16_f32 v33, v34, v35
    v_cvt_pk_bf16_f32 v34, v36, v37
    v_cvt_pk_bf16_f32 v35, v38, v39
    v_cvt_pk_bf16_f32 v64, v64, v65
    v_cvt_pk_bf16_f32 v65, v66, v67
    v_cvt_pk_bf16_f32 v66, v68, v69
    v_cvt_pk_bf16_f32 v67, v70, v71
    s_nop 1
    v_permlane16_swap_b32 v32, v34
    v_permlane16_swap_b32 v33, v35
    v_permlane16_swap_b32 v64, v66
    v_permlane16_swap_b32 v65, v67
    buffer_store_dwordx4 v[32:35], v12, s[24:27], s41 offen offset:0 sc1
    buffer_store_dwordx4 v[64:67], v12, s[24:27], s41 offen offset:64 sc1
    s_add_u32 s41, s41, s42
    v_cvt_pk_bf16_f32 v40, v40, v41
    v_cvt_pk_bf16_f32 v41, v42, v43
    v_cvt_pk_bf16_f32 v42, v44, v45
    v_cvt_pk_bf16_f32 v43, v46, v47
    v_cvt_pk_bf16_f32 v72, v72, v73
    v_cvt_pk_bf16_f32 v73, v74, v75
    v_cvt_pk_bf16_f32 v74, v76, v77
    v_cvt_pk_bf16_f32 v75, v78, v79
    s_nop 1
    v_permlane16_swap_b32 v40, v42
    v_permlane16_swap_b32 v41, v43
    v_permlane16_swap_b32 v72, v74
    v_permlane16_swap_b32 v73, v75
    buffer_store_dwordx4 v[40:43], v12, s[24:27], s41 offen offset:0 sc1
    buffer_store_dwordx4 v[72:75], v12, s[24:27], s41 offen offset:64 sc1
    s_add_u32 s41, s41, s42
    v_cvt_pk_bf16_f32 v48, v48, v49
    v_cvt_pk_bf16_f32 v49, v50, v51
    v_cvt_pk_bf16_f32 v50, v52, v53
    v_cvt_pk_bf16_f32 v51, v54, v55
    v_cvt_pk_bf16_f32 v80, v80, v81
    v_cvt_pk_bf16_f32 v81, v82, v83
    v_cvt_pk_bf16_f32 v82, v84, v85
    v_cvt_pk_bf16_f32 v83, v86, v87
    s_nop 1
    v_permlane16_swap_b32 v48, v50
    v_permlane16_swap_b32 v49, v51
    v_permlane16_swap_b32 v80, v82
    v_permlane16_swap_b32 v81, v83
    buffer_store_dwordx4 v[48:51], v12, s[24:27], s41 offen offset:0 sc1
    buffer_store_dwordx4 v[80:83], v12, s[24:27], s41 offen offset:64 sc1
    s_add_u32 s41, s41, s42
    v_cvt_pk_bf16_f32 v56, v56, v57
    v_cvt_pk_bf16_f32 v57, v58, v59
    v_cvt_pk_bf16_f32 v58, v60, v61
    v_cvt_pk_bf16_f32 v59, v62, v63
    v_cvt_pk_bf16_f32 v88, v88, v89
    v_cvt_pk_bf16_f32 v89, v90, v91
    v_cvt_pk_bf16_f32 v90, v92, v93
    v_cvt_pk_bf16_f32 v91, v94, v95
    s_nop 1
    v_permlane16_swap_b32 v56, v58
    v_permlane16_swap_b32 v57, v59
    v_permlane16_swap_b32 v88, v90
    v_permlane16_swap_b32 v89, v91
    buffer_store_dwordx4 v[56:59], v12, s[24:27], s41 offen offset:0 sc1
    buffer_store_dwordx4 v[88:91], v12, s[24:27], s41 offen offset:64 sc1
    s_add_u32 s41, s41, s42
gemm3_kernel_end1:
    s_endpgm
gemm3_kernel_ev4:
    s_cmp_lg_u32 s58, 16
    s_cbranch_scc1 gemm3_kernel_n8
    s_lshl_b32 s48, s39, 7
    s_add_u32 s48, s48, 117506048
    buffer_load_dword v14, off, s[28:31], s48 sc1
    s_mov_b32 s57, 1
    s_mov_b32 s58, 17
    s_branch gemm3_kernel_back5
gemm3_kernel_n8:
    s_cmp_lg_u32 s58, 17
    s_cbranch_scc1 gemm3_kernel_n9
    s_waitcnt vmcnt(0)
    s_mov_b32 s3, 1048576
gemm3_kernel_spin10:
    v_readfirstlane_b32 s49, v14
    s_nop 3
    s_cmp_lg_u32 s49, 0
    s_cbranch_scc1 gemm3_kernel_ok11
    s_sub_u32 s3, s3, 1
    s_cbranch_scc1 gemm3_kernel_ok11
    s_sleep 8
    s_lshl_b32 s48, s39, 7
    s_add_u32 s48, s48, 117506048
    buffer_load_dword v14, off, s[28:31], s48 sc1
    s_waitcnt vmcnt(0)
    s_branch gemm3_kernel_spin10
gemm3_kernel_ok11:
    s_lshl_b32 s48, s39, 16
    s_lshl_b32 s49, s32, 14
    s_add_u32 s48, s48, s49
    s_add_u32 s48, s48, 100663296
    buffer_load_dwordx4 v[160:163], v7, s[28:31], s48 offen offset:0 sc1
    buffer_load_dwordx4 v[164:167], v7, s[28:31], s48 offen offset:1024 sc1
    buffer_load_dwordx4 v[168:171], v7, s[28:31], s48 offen offset:2048 sc1
    buffer_load_dwordx4 v[172:175], v7, s[28:31], s48 offen offset:3072 sc1
    s_add_u32 s48, s48, 4096
    buffer_load_dwordx4 v[176:179], v7, s[28:31], s48 offen offset:0 sc1
    buffer_load_dwordx4 v[180:183], v7, s[28:31], s48 offen offset:1024 sc1
    buffer_load_dwordx4 v[184:187], v7, s[28:31], s48 offen offset:2048 sc1
    buffer_load_dwordx4 v[188:191], v7, s[28:31], s48 offen offset:3072 sc1
    s_add_u32 s48, s48, 4096
    s_mov_b32 s57, 1000
    s_mov_b32 s58, 18
    s_branch gemm3_kernel_back5
gemm3_kernel_n9:
    s_cmp_lg_u32 s58, 0
    s_cbranch_scc1 gemm3_kernel_n12
    s_lshl_b32 s48, s39, 16
    s_lshl_b32 s49, s32, 14
    s_add_u32 s48, s48, s49
    s_add_u32 s48, s48, 100663296
    s_mov_b32 s59, s48
    s_nop 3
    v_cvt_pk_bf16_f32 v160, v32, v33
    v_cvt_pk_bf16_f32 v161, v34, v35
    v_cvt_pk_bf16_f32 v162, v36, v37
    v_cvt_pk_bf16_f32 v163, v38, v39
    v_cvt_pk_bf16_f32 v164, v40, v41
    v_cvt_pk_bf16_f32 v165, v42, v43
    v_cvt_pk_bf16_f32 v166, v44, v45
    v_cvt_pk_bf16_f32 v167, v46, v47
    v_cvt_pk_bf16_f32 v168, v48, v49
    v_cvt_pk_bf16_f32 v169, v50, v51
    v_cvt_pk_bf16_f32 v170, v52, v53
    v_cvt_pk_bf16_f32 v171, v54, v55
    v_cvt_pk_bf16_f32 v172, v56, v57
    v_cvt_pk_bf16_f32 v173, v58, v59
    v_cvt_pk_bf16_f32 v174, v60, v61
    v_cvt_pk_bf16_f32 v175, v62, v63
    v_cvt_pk_bf16_f32 v176, v64, v65
    v_cvt_pk_bf16_f32 v177, v66, v67
    v_cvt_pk_bf16_f32 v178, v68, v69
    v_cvt_pk_bf16_f32 v179, v70, v71
    v_cvt_pk_bf16_f32 v180, v72, v73
    v_cvt_pk_bf16_f32 v181, v74, v75
    v_cvt_pk_bf16_f32 v182, v76, v77
    v_cvt_pk_bf16_f32 v183, v78, v79
    v_cvt_pk_bf16_f32 v184, v80, v81
    v_cvt_pk_bf16_f32 v185, v82, v83
    v_cvt_pk_bf16_f32 v186, v84, v85
    v_cvt_pk_bf16_f32 v187, v86, v87
    v_cvt_pk_bf16_f32 v188, v88, v89
    v_cvt_pk_bf16_f32 v189, v90, v91
    v_cvt_pk_bf16_f32 v190, v92, v93
    v_cvt_pk_bf16_f32 v191, v94, v95
    v_mov_b64 v[32:33], 0
    v_mov_b64 v[34:35], 0
    v_mov_b64 v[36:37], 0
    v_mov_b64 v[38:39], 0
    v_mov_b64 v[40:41], 0
    v_mov_b64 v[42:43], 0
    v_mov_b64 v[44:45], 0
    v_mov_b64 v[46:47], 0
    v_mov_b64 v[48:49], 0
    v_mov_b64 v[50:51], 0
    v_mov_b64 v[52:53], 0
    v_mov_b64 v[54:55], 0
    v_mov_b64 v[56:57], 0
    v_mov_b64 v[58:59], 0
    v_mov_b64 v[60:61], 0
    v_mov_b64 v[62:63], 0
    v_mov_b64 v[64:65], 0
    v_mov_b64 v[66:67], 0
    v_mov_b64 v[68:69], 0
    v_mov_b64 v[70:71], 0
    v_mov_b64 v[72:73], 0
    v_mov_b64 v[74:75], 0
    v_mov_b64 v[76:77], 0
    v_mov_b64 v[78:79], 0
    v_mov_b64 v[80:81], 0
    v_mov_b64 v[82:83], 0
    v_mov_b64 v[84:85], 0
    v_mov_b64 v[86:87], 0
    v_mov_b64 v[88:89], 0
    v_mov_b64 v[90:91], 0
    v_mov_b64 v[92:93], 0
    v_mov_b64 v[94:95], 0
    s_nop 1
    s_waitcnt lgkmcnt(9)
    v_mfma_f32_16x16x32_bf16 v[32:35], v[112:115], v[96:99], v[32:35]
    ds_read_b128 v[128:131], v2 offset:8192
    s_waitcnt lgkmcnt(9)
    v_mfma_f32_16x16x32_bf16 v[40:43], v[112:115], v[100:103], v[40:43]
    ds_read_b64_tr_b16 v[144:145], v3 offset:8192
    s_waitcnt lgkmcnt(9)
    v_mfma_f32_16x16x32_bf16 v[48:51], v[112:115], v[104:107], v[48:51]
    ds_read_b64_tr_b16 v[146:147], v3 offset:12288
    s_waitcnt lgkmcnt(9)
    v_mfma_f32_16x16x32_bf16 v[56:59], v[112:115], v[108:111], v[56:59]
    ds_read_b128 v[132:135], v2 offset:9216
    s_waitcnt lgkmcnt(8)
    v_mfma_f32_16x16x32_bf16 v[36:39], v[116:119], v[96:99], v[36:39]
    ds_read_b128 v[136:139], v2 offset:10240
    v_mfma_f32_16x16x32_bf16 v[44:47], v[116:119], v[100:103], v[44:47]
    ds_read_b128 v[140:143], v2 offset:11264
    v_mfma_f32_16x16x32_bf16 v[52:55], v[116:119], v[104:107], v[52:55]
    ds_read_b64_tr_b16 v[148:149], v4 offset:8192
    v_mfma_f32_16x16x32_bf16 v[60:63], v[116:119], v[108:111], v[60:63]
    ds_read_b64_tr_b16 v[150:151], v4 offset:12288
    s_waitcnt lgkmcnt(10)
    v_mfma_f32_16x16x32_bf16 v[64:67], v[120:123], v[96:99], v[64:67]
    s_add_u32 s43, s43, 32768
    ds_read_b64_tr_b16 v[152:153], v5 offset:8192
    v_mfma_f32_16x16x32_bf16 v[72:75], v[120:123], v[100:103], v[72:75]
    s_cmp_ge_u32 s43, 163840
    ds_read_b64_tr_b16 v[154:155], v5 offset:12288
    v_mfma_f32_16x16x32_bf16 v[80:83], v[120:123], v[104:107], v[80:83]
    s_cselect_b32 s46, 4294836224, s56
    ds_read_b64_tr_b16 v[156:157], v6 offset:8192
    v_mfma_f32_16x16x32_bf16 v[88:91], v[120:123], v[108:111], v[88:91]
    s_cselect_b32 s43, 0, s43
    ds_read_b64_tr_b16 v[158:159], v6 offset:12288
    s_waitcnt lgkmcnt(12)
    v_mfma_f32_16x16x32_bf16 v[68:71], v[124:127], v[96:99], v[68:71]
    v_add_u32 v2, s46, v2
    v_add_u32 v3, s46, v3
    v_mfma_f32_16x16x32_bf16 v[76:79], v[124:127], v[100:103], v[76:79]
    v_add_u32 v4, s46, v4
    v_add_u32 v5, s46, v5
    v_mfma_f32_16x16x32_bf16 v[84:87], v[124:127], v[104:107], v[84:87]
    v_add_u32 v6, s46, v6
    v_mfma_f32_16x16x32_bf16 v[92:95], v[124:127], v[108:111], v[92:95]
    buffer_store_dwordx4 v[160:163], v7, s[28:31], s59 offen offset:0 sc1
    s_waitcnt lgkmcnt(0)
    v_mfma_f32_16x16x32_bf16 v[32:35], v[144:147], v[128:131], v[32:35]
    s_barrier
    v_mfma_f32_16x16x32_bf16 v[40:43], v[144:147], v[132:135], v[40:43]
    ds_read_b128 v[96:99], v2 offset:0
    v_mfma_f32_16x16x32_bf16 v[48:51], v[144:147], v[136:139], v[48:51]
    ds_read_b64_tr_b16 v[112:113], v3 offset:0
    v_mfma_f32_16x16x32_bf16 v[56:59], v[144:147], v[140:143], v[56:59]
    ds_read_b64_tr_b16 v[114:115], v3 offset:4096
    v_mfma_f32_16x16x32_bf16 v[36:39], v[148:151], v[128:131], v[36:39]
    ds_read_b128 v[100:103], v2 offset:1024
    v_mfma_f32_16x16x32_bf16 v[44:47], v[148:151], v[132:135], v[44:47]
    ds_read_b128 v[104:107], v2 offset:2048
    v_mfma_f32_16x16x32_bf16 v[52:55], v[148:151], v[136:139], v[52:55]
    ds_read_b128 v[108:111], v2 offset:3072
    v_mfma_f32_16x16x32_bf16 v[60:63], v[148:151], v[140:143], v[60:63]
    ds_read_b64_tr_b16 v[116:117], v4 offset:0
    v_mfma_f32_16x16x32_bf16 v[64:67], v[152:155], v[128:131], v[64:67]
    ds_read_b64_tr_b16 v[118:119], v4 offset:4096
    v_mfma_f32_16x16x32_bf16 v[72:75], v[152:155], v[132:135], v[72:75]
    ds_read_b64_tr_b16 v[120:121], v5 offset:0
    v_mfma_f32_16x16x32_bf16 v[80:83], v[152:155], v[136:139], v[80:83]
    ds_read_b64_tr_b16 v[122:123], v5 offset:4096
    v_mfma_f32_16x16x32_bf16 v[88:91], v[152:155], v[140:143], v[88:91]
    ds_read_b64_tr_b16 v[124:125], v6 offset:0
    v_mfma_f32_16x16x32_bf16 v[68:71], v[156:159], v[128:131], v[68:71]
    ds_read_b64_tr_b16 v[126:127], v6 offset:4096
    v_mfma_f32_16x16x32_bf16 v[76:79], v[156:159], v[132:135], v[76:79]
    buffer_store_dwordx4 v[164:167], v7, s[28:31], s59 offen offset:1024 sc1
    v_mfma_f32_16x16x32_bf16 v[84:87], v[156:159], v[136:139], v[84:87]
    s_sub_u32 s47, s47, 1
    v_mfma_f32_16x16x32_bf16 v[92:95], v[156:159], v[140:143], v[92:95]
    s_waitcnt lgkmcnt(9)
    v_mfma_f32_16x16x32_bf16 v[32:35], v[112:115], v[96:99], v[32:35]
    ds_read_b128 v[128:131], v2 offset:8192
    s_waitcnt lgkmcnt(9)
    v_mfma_f32_16x16x32_bf16 v[40:43], v[112:115], v[100:103], v[40:43]
    ds_read_b64_tr_b16 v[144:145], v3 offset:8192
    s_waitcnt lgkmcnt(9)
    v_mfma_f32_16x16x32_bf16 v[48:51], v[112:115], v[104:107], v[48:51]
    ds_read_b64_tr_b16 v[146:147], v3 offset:12288
    s_waitcnt lgkmcnt(9)
    v_mfma_f32_16x16x32_bf16 v[56:59], v[112:115], v[108:111], v[56:59]
    ds_read_b128 v[132:135], v2 offset:9216
    s_waitcnt lgkmcnt(8)
    v_mfma_f32_16x16x32_bf16 v[36:39], v[116:119], v[96:99], v[36:39]
    ds_read_b128 v[136:139], v2 offset:10240
    v_mfma_f32_16x16x32_bf16 v[44:47], v[116:119], v[100:103], v[44:47]
    ds_read_b128 v[140:143], v2 offset:11264
    v_mfma_f32_16x16x32_bf16 v[52:55], v[116:119], v[104:107], v[52:55]
    ds_read_b64_tr_b16 v[148:149], v4 offset:8192
    v_mfma_f32_16x16x32_bf16 v[60:63], v[116:119], v[108:111], v[60:63]
    ds_read_b64_tr_b16 v[150:151], v4 offset:12288
    s_waitcnt lgkmcnt(10)
    v_mfma_f32_16x16x32_bf16 v[64:67], v[120:123], v[96:99], v[64:67]
    s_add_u32 s43, s43, 32768
    ds_read_b64_tr_b16 v[152:153], v5 offset:8192
    v_mfma_f32_16x16x32_bf16 v[72:75], v[120:123], v[100:103], v[72:75]
    s_cmp_ge_u32 s43, 163840
    ds_read_b64_tr_b16 v[154:155], v5 offset:12288
    v_mfma_f32_16x16x32_bf16 v[80:83], v[120:123], v[104:107], v[80:83]
    s_cselect_b32 s46, 4294836224, s56
    ds_read_b64_tr_b16 v[156:157], v6 offset:8192
    v_mfma_f32_16x16x32_bf16 v[88:91], v[120:123], v[108:111], v[88:91]
    s_cselect_b32 s43, 0, s43
    ds_read_b64_tr_b16 v[158:159], v6 offset:12288
    s_waitcnt lgkmcnt(12)
    v_mfma_f32_16x16x32_bf16 v[68:71], v[124:127], v[96:99], v[68:71]
    v_add_u32 v2, s46, v2
    v_add_u32 v3, s46, v3
    v_mfma_f32_16x16x32_bf16 v[76:79], v[124:127], v[100:103], v[76:79]
    v_add_u32 v4, s46, v4
    v_add_u32 v5, s46, v5
    v_mfma_f32_16x16x32_bf16 v[84:87], v[124:127], v[104:107], v[84:87]
    v_add_u32 v6, s46, v6
    v_mfma_f32_16x16x32_bf16 v[92:95], v[124:127], v[108:111], v[92:95]
    buffer_store_dwordx4 v[168:171], v7, s[28:31], s59 offen offset:2048 sc1
    s_waitcnt lgkmcnt(0)
    v_mfma_f32_16x16x32_bf16 v[32:35], v[144:147], v[128:131], v[32:35]
    s_barrier
    v_mfma_f32_16x16x32_bf16 v[40:43], v[144:147], v[132:135], v[40:43]
    ds_read_b128 v[96:99], v2 offset:0
    v_mfma_f32_16x16x32_bf16 v[48:51], v[144:147], v[136:139], v[48:51]
    ds_read_b64_tr_b16 v[112:113], v3 offset:0
    v_mfma_f32_16x16x32_bf16 v[56:59], v[144:147], v[140:143], v[56:59]
    ds_read_b64_tr_b16 v[114:115], v3 offset:4096
    v_mfma_f32_16x16x32_bf16 v[36:39], v[148:151], v[128:131], v[36:39]
    ds_read_b128 v[100:103], v2 offset:1024
    v_mfma_f32_16x16x32_bf16 v[44:47], v[148:151], v[132:135], v[44:47]
    ds_read_b128 v[104:107], v2 offset:2048
    v_mfma_f32_16x16x32_bf16 v[52:55], v[148:151], v[136:139], v[52:55]
    ds_read_b128 v[108:111], v2 offset:3072
    v_mfma_f32_16x16x32_bf16 v[60:63], v[148:151], v[140:143], v[60:63]
    ds_read_b64_tr_b16 v[116:117], v4 offset:0
    v_mfma_f32_16x16x32_bf16 v[64:67], v[152:155], v[128:131], v[64:67]
    ds_read_b64_tr_b16 v[118:119], v4 offset:4096
    v_mfma_f32_16x16x32_bf16 v[72:75], v[152:155], v[132:135], v[72:75]
    ds_read_b64_tr_b16 v[120:121], v5 offset:0
    v_mfma_f32_16x16x32_bf16 v[80:83], v[152:155], v[136:139], v[80:83]
    ds_read_b64_tr_b16 v[122:123], v5 offset:4096
    v_mfma_f32_16x16x32_bf16 v[88:91], v[152:155], v[140:143], v[88:91]
    ds_read_b64_tr_b16 v[124:125], v6 offset:0
    v_mfma_f32_16x16x32_bf16 v[68:71], v[156:159], v[128:131], v[68:71]
    ds_read_b64_tr_b16 v[126:127], v6 offset:4096
    v_mfma_f32_16x16x32_bf16 v[76:79], v[156:159], v[132:135], v[76:79]
    buffer_store_dwordx4 v[172:175], v7, s[28:31], s59 offen offset:3072 sc1
    s_add_u32 s59, s59, 4096
    v_mfma_f32_16x16x32_bf16 v[84:87], v[156:159], v[136:139], v[84:87]
    s_sub_u32 s47, s47, 1
    v_mfma_f32_16x16x32_bf16 v[92:95], v[156:159], v[140:143], v[92:95]
    s_waitcnt lgkmcnt(9)
    v_mfma_f32_16x16x32_bf16 v[32:35], v[112:115], v[96:99], v[32:35]
    ds_read_b128 v[128:131], v2 offset:8192
    s_waitcnt lgkmcnt(9)
    v_mfma_f32_16x16x32_bf16 v[40:43], v[112:115], v[100:103], v[40:43]
    ds_read_b64_tr_b16 v[144:145], v3 offset:8192
    s_waitcnt lgkmcnt(9)
    v_mfma_f32_16x16x32_bf16 v[48:51], v[112:115], v[104:107], v[48:51]
    ds_read_b64_tr_b16 v[146:147], v3 offset:12288
    s_waitcnt lgkmcnt(9)
    v_mfma_f32_16x16x32_bf16 v[56:59], v[112:115], v[108:111], v[56:59]
    ds_read_b128 v[132:135], v2 offset:9216
    s_waitcnt lgkmcnt(8)
    v_mfma_f32_16x16x32_bf16 v[36:39], v[116:119], v[96:99], v[36:39]
    ds_read_b128 v[136:139], v2 offset:10240
    v_mfma_f32_16x16x32_bf16 v[44:47], v[116:119], v[100:103], v[44:47]
    ds_read_b128 v[140:143], v2 offset:11264
    v_mfma_f32_16x16x32_bf16 v[52:55], v[116:119], v[104:107], v[52:55]
    ds_read_b64_tr_b16 v[148:149], v4 offset:8192
    v_mfma_f32_16x16x32_bf16 v[60:63], v[116:119], v[108:111], v[60:63]
    ds_read_b64_tr_b16 v[150:151], v4 offset:12288
    s_waitcnt lgkmcnt(10)
    v_mfma_f32_16x16x32_bf16 v[64:67], v[120:123], v[96:99], v[64:67]
    s_add_u32 s43, s43, 32768
    ds_read_b64_tr_b16 v[152:153], v5 offset:8192
    v_mfma_f32_16x16x32_bf16 v[72:75], v[120:123], v[100:103], v[72:75]
    s_cmp_ge_u32 s43, 163840
    ds_read_b64_tr_b16 v[154:155], v5 offset:12288
    v_mfma_f32_16x16x32_bf16 v[80:83], v[120:123], v[104:107], v[80:83]
    s_cselect_b32 s46, 4294836224, s56
    ds_read_b64_tr_b16 v[156:157], v6 offset:8192
    v_mfma_f32_16x16x32_bf16 v[88:91], v[120:123], v[108:111], v[88:91]
    s_cselect_b32 s43, 0, s43
    ds_read_b64_tr_b16 v[158:159], v6 offset:12288
    s_waitcnt lgkmcnt(12)
    v_mfma_f32_16x16x32_bf16 v[68:71], v[124:127], v[96:99], v[68:71]
    v_add_u32 v2, s46, v2
    v_add_u32 v3, s46, v3
    v_mfma_f32_16x16x32_bf16 v[76:79], v[124:127], v[100:103], v[76:79]
    v_add_u32 v4, s46, v4
    v_add_u32 v5, s46, v5
    v_mfma_f32_16x16x32_bf16 v[84:87], v[124:127], v[104:107], v[84:87]
    v_add_u32 v6, s46, v6
    v_mfma_f32_16x16x32_bf16 v[92:95], v[124:127], v[108:111], v[92:95]
    buffer_store_dwordx4 v[176:179], v7, s[28:31], s59 offen offset:0 sc1
    s_waitcnt lgkmcnt(0)
    v_mfma_f32_16x16x32_bf16 v[32:35], v[144:147], v[128:131], v[32:35]
    s_barrier
    v_mfma_f32_16x16x32_bf16 v[40:43], v[144:147], v[132:135], v[40:43]
    ds_read_b128 v[96:99], v2 offset:0
    v_mfma_f32_16x16x32_bf16 v[48:51], v[144:147], v[136:139], v[48:51]
    ds_read_b64_tr_b16 v[112:113], v3 offset:0
    v_mfma_f32_16x16x32_bf16 v[56:59], v[144:147], v[140:143], v[56:59]
    ds_read_b64_tr_b16 v[114:115], v3 offset:4096
    v_mfma_f32_16x16x32_bf16 v[36:39], v[148:151], v[128:131], v[36:39]
    ds_read_b128 v[100:103], v2 offset:1024
    v_mfma_f32_16x16x32_bf16 v[44:47], v[148:151], v[132:135], v[44:47]
    ds_read_b128 v[104:107], v2 offset:2048
    v_mfma_f32_16x16x32_bf16 v[52:55], v[148:151], v[136:139], v[52:55]
    ds_read_b128 v[108:111], v2 offset:3072
    v_mfma_f32_16x16x32_bf16 v[60:63], v[148:151], v[140:143], v[60:63]
    ds_read_b64_tr_b16 v[116:117], v4 offset:0
    v_mfma_f32_16x16x32_bf16 v[64:67], v[152:155], v[128:131], v[64:67]
    ds_read_b64_tr_b16 v[118:119], v4 offset:4096
    v_mfma_f32_16x16x32_bf16 v[72:75], v[152:155], v[132:135], v[72:75]
    ds_read_b64_tr_b16 v[120:121], v5 offset:0
    v_mfma_f32_16x16x32_bf16 v[80:83], v[152:155], v[136:139], v[80:83]
    ds_read_b64_tr_b16 v[122:123], v5 offset:4096
    v_mfma_f32_16x16x32_bf16 v[88:91], v[152:155], v[140:143], v[88:91]
    ds_read_b64_tr_b16 v[124:125], v6 offset:0
    v_mfma_f32_16x16x32_bf16 v[68:71], v[156:159], v[128:131], v[68:71]
    ds_read_b64_tr_b16 v[126:127], v6 offset:4096
    v_mfma_f32_16x16x32_bf16 v[76:79], v[156:159], v[132:135], v[76:79]
    buffer_store_dwordx4 v[180:183], v7, s[28:31], s59 offen offset:1024 sc1
    v_mfma_f32_16x16x32_bf16 v[84:87], v[156:159], v[136:139], v[84:87]
    s_sub_u32 s47, s47, 1
    v_mfma_f32_16x16x32_bf16 v[92:95], v[156:159], v[140:143], v[92:95]
    s_waitcnt lgkmcnt(9)
    v_mfma_f32_16x16x32_bf16 v[32:35], v[112:115], v[96:99], v[32:35]
    ds_read_b128 v[128:131], v2 offset:8192
    s_waitcnt lgkmcnt(9)
    v_mfma_f32_16x16x32_bf16 v[40:43], v[112:115], v[100:103], v[40:43]
    ds_read_b64_tr_b16 v[144:145], v3 offset:8192
    s_waitcnt lgkmcnt(9)
    v_mfma_f32_16x16x32_bf16 v[48:51], v[112:115], v[104:107], v[48:51]
    ds_read_b64_tr_b16 v[146:147], v3 offset:12288
    s_waitcnt lgkmcnt(9)
    v_mfma_f32_16x16x32_bf16 v[56:59], v[112:115], v[108:111], v[56:59]
    ds_read_b128 v[132:135], v2 offset:9216
    s_waitcnt lgkmcnt(8)
    v_mfma_f32_16x16x32_bf16 v[36:39], v[116:119], v[96:99], v[36:39]
    ds_read_b128 v[136:139], v2 offset:10240
    v_mfma_f32_16x16x32_bf16 v[44:47], v[116:119], v[100:103], v[44:47]
    ds_read_b128 v[140:143], v2 offset:11264
    v_mfma_f32_16x16x32_bf16 v[52:55], v[116:119], v[104:107], v[52:55]
    ds_read_b64_tr_b16 v[148:149], v4 offset:8192
    v_mfma_f32_16x16x32_bf16 v[60:63], v[116:119], v[108:111], v[60:63]
    ds_read_b64_tr_b16 v[150:151], v4 offset:12288
    s_waitcnt lgkmcnt(10)
    v_mfma_f32_16x16x32_bf16 v[64:67], v[120:123], v[96:99], v[64:67]
    s_add_u32 s43, s43, 32768
    ds_read_b64_tr_b16 v[152:153], v5 offset:8192
    v_mfma_f32_16x16x32_bf16 v[72:75], v[120:123], v[100:103], v[72:75]
    s_cmp_ge_u32 s43, 163840
    ds_read_b64_tr_b16 v[154:155], v5 offset:12288
    v_mfma_f32_16x16x32_bf16 v[80:83], v[120:123], v[104:107], v[80:83]
    s_cselect_b32 s46, 4294836224, s56
    ds_read_b64_tr_b16 v[156:157], v6 offset:8192
    v_mfma_f32_16x16x32_bf16 v[88:91], v[120:123], v[108:111], v[88:91]
    s_cselect_b32 s43, 0, s43
    ds_read_b64_tr_b16 v[158:159], v6 offset:12288
    s_waitcnt lgkmcnt(12)
    v_mfma_f32_16x16x32_bf16 v[68:71], v[124:127], v[96:99], v[68:71]
    v_add_u32 v2, s46, v2
    v_add_u32 v3, s46, v3
    v_mfma_f32_16x16x32_bf16 v[76:79], v[124:127], v[100:103], v[76:79]
    v_add_u32 v4, s46, v4
    v_add_u32 v5, s46, v5
    v_mfma_f32_16x16x32_bf16 v[84:87], v[124:127], v[104:107], v[84:87]
    v_add_u32 v6, s46, v6
    v_mfma_f32_16x16x32_bf16 v[92:95], v[124:127], v[108:111], v[92:95]
    buffer_store_dwordx4 v[184:187], v7, s[28:31], s59 offen offset:2048 sc1
    s_waitcnt lgkmcnt(0)
    v_mfma_f32_16x16x32_bf16 v[32:35], v[144:147], v[128:131], v[32:35]
    s_barrier
    v_mfma_f32_16x16x32_bf16 v[40:43], v[144:147], v[132:135], v[40:43]
    ds_read_b128 v[96:99], v2 offset:0
    v_mfma_f32_16x16x32_bf16 v[48:51], v[144:147], v[136:139], v[48:51]
    ds_read_b64_tr_b16 v[112:113], v3 offset:0
    v_mfma_f32_16x16x32_bf16 v[56:59], v[144:147], v[140:143], v[56:59]
    ds_read_b64_tr_b16 v[114:115], v3 offset:4096
    v_mfma_f32_16x16x32_bf16 v[36:39], v[148:151], v[128:131], v[36:39]
    ds_read_b128 v[100:103], v2 offset:1024
    v_mfma_f32_16x16x32_bf16 v[44:47], v[148:151], v[132:135], v[44:47]
    ds_read_b128 v[104:107], v2 offset:2048
    v_mfma_f32_16x16x32_bf16 v[52:55], v[148:151], v[136:139], v[52:55]
    ds_read_b128 v[108:111], v2 offset:3072
    v_mfma_f32_16x16x32_bf16 v[60:63], v[148:151], v[140:143], v[60:63]
    ds_read_b64_tr_b16 v[116:117], v4 offset:0
    v_mfma_f32_16x16x32_bf16 v[64:67], v[152:155], v[128:131], v[64:67]
    ds_read_b64_tr_b16 v[118:119], v4 offset:4096
    v_mfma_f32_16x16x32_bf16 v[72:75], v[152:155], v[132:135], v[72:75]
    ds_read_b64_tr_b16 v[120:121], v5 offset:0
    v_mfma_f32_16x16x32_bf16 v[80:83], v[152:155], v[136:139], v[80:83]
    ds_read_b64_tr_b16 v[122:123], v5 offset:4096
    v_mfma_f32_16x16x32_bf16 v[88:91], v[152:155], v[140:143], v[88:91]
    ds_read_b64_tr_b16 v[124:125], v6 offset:0
    v_mfma_f32_16x16x32_bf16 v[68:71], v[156:159], v[128:131], v[68:71]
    ds_read_b64_tr_b16 v[126:127], v6 offset:4096
    v_mfma_f32_16x16x32_bf16 v[76:79], v[156:159], v[132:135], v[76:79]
    buffer_store_dwordx4 v[188:191], v7, s[28:31], s59 offen offset:3072 sc1
    s_add_u32 s59, s59, 4096
    v_mfma_f32_16x16x32_bf16 v[84:87], v[156:159], v[136:139], v[84:87]
    s_sub_u32 s47, s47, 1
    v_mfma_f32_16x16x32_bf16 v[92:95], v[156:159], v[140:143], v[92:95]
    s_mov_b32 s57, 0
    s_mov_b32 s58, 1
    s_branch gemm3_kernel_back5
gemm3_kernel_n12:
    s_cmp_lg_u32 s58, 1
    s_cbranch_scc1 gemm3_kernel_n13
    s_waitcnt vmcnt(0)
    s_mov_b32 s57, 0
    s_mov_b32 s58, 2
    s_branch gemm3_kernel_back5
gemm3_kernel_n13:
    s_cmp_lg_u32 s58, 2
    s_cbranch_scc1 gemm3_kernel_n14
    s_cmp_lg_u32 s32, 0
    s_cbranch_scc1 gemm3_kernel_np15
    s_lshl_b32 s48, s39, 7
    s_add_u32 s48, s48, 117506048
    v_mov_b32 v16, 1
    s_mov_b64 exec, 1
    buffer_store_dword v16, off, s[28:31], s48 sc1
    s_mov_b64 exec, -1
gemm3_kernel_np15:
    s_mov_b32 s57, 1000
    s_mov_b32 s58, 3
    s_branch gemm3_kernel_back5
gemm3_kernel_n14:
    s_mov_b32 s57, 1000
    s_branch gemm3_kernel_back5
gemm3_kernel_load2:
    s_lshl_b32 s45, s32, 12
    s_lshl_b32 s48, s37, 13
    s_lshl_b32 s49, s34, 12
    s_add_u32 s48, s48, s49
    s_lshl_b32 s49, s33, 17
    s_add_u32 s40, s48, s49
    s_mul_i32 s48, s35, 10747904
    s_add_u32 s41, s40, s48
    s_add_u32 s41, s41, 67108864
    s_add_u32 s40, s40, 83886080
    s_mul_i32 s48, s35, 5373952
    s_lshl_b32 s46, s38, 8
    s_add_u32 s42, s46, s48
    v_lshrrev_b32 v16, 4, v1
    s_lshl_b32 s48, s32, 4
    v_add_u32 v17, s48, v16
    v_lshlrev_b32 v17, 11, v17
    v_lshlrev_b32 v16, 1, v16
    v_and_b32 v18, 15, v1
    v_xor_b32 v16, v16, v18
    v_xor_b32 v18, 0, v16
    v_lshl_add_u32 v8, v18, 4, v17
    v_xor_b32 v18, 8, v16
    v_lshl_add_u32 v9, v18, 4, v17
    v_add_u32 v9, 7168, v9
    v_xor_b32 v18, 0, v16
    v_lshl_add_u32 v10, v18, 4, v17
    v_add_u32 v10, 14336, v10
    v_xor_b32 v18, 8, v16
    v_lshl_add_u32 v11, v18, 4, v17
    v_add_u32 v11, 21504, v11
    s_mov_b32 s18, 268435456
    s_mov_b32 s19, 0x20000
    s_mov_b32 s23, 0x20000
    s_mov_b32 s22, 8388608
    s_mov_b32 s44, s45
    s_cmp_eq_u32 s35, 1
    s_cselect_b32 s57, 23, 1000
    s_cselect_b32 s58, 39, 41
    s_add_u32 s56, s45, 163840
    s_waitcnt lgkmcnt(0)
    s_mov_b32 s20, s4
    s_mov_b32 s21, s5
    s_mov_b32 s16, s10
    s_mov_b32 s17, s11
    s_mov_b32 m0, s44
    s_nop 0
    buffer_load_dwordx4 v7, s[16:19], s41 offen offset:0 lds
    buffer_load_dwordx4 v7, s[16:19], s41 offen offset:1024 lds
    buffer_load_dwordx4 v7, s[16:19], s41 offen offset:2048 lds
    buffer_load_dwordx4 v7, s[16:19], s41 offen offset:3072 lds
    s_add_u32 m0, s44, 16384
    s_add_u32 s41, s41, 262144
    buffer_load_dwordx4 v8, s[20:23], s42 offen offset:0 lds
    buffer_load_dwordx4 v9, s[20:23], s42 offen offset:1024 lds
    buffer_load_dwordx4 v10, s[20:23], s42 offen offset:2048 lds
    buffer_load_dwordx4 v11, s[20:23], s42 offen offset:3072 lds
    s_add_u32 s42, s42, 131072
    s_add_u32 s44, s44, 32768
    s_cmp_ge_u32 s44, s56
    s_cselect_b32 s44, s45, s44
    s_mov_b32 m0, s44
    s_nop 0
    buffer_load_dwordx4 v7, s[16:19], s41 offen offset:0 lds
    buffer_load_dwordx4 v7, s[16:19], s41 offen offset:1024 lds
    buffer_load_dwordx4 v7, s[16:19], s41 offen offset:2048 lds
    buffer_load_dwordx4 v7, s[16:19], s41 offen offset:3072 lds
    s_add_u32 m0, s44, 16384
    s_add_u32 s41, s41, 262144
    buffer_load_dwordx4 v8, s[20:23], s42 offen offset:0 lds
    buffer_load_dwordx4 v9, s[20:23], s42 offen offset:1024 lds
    buffer_load_dwordx4 v10, s[20:23], s42 offen offset:2048 lds
    buffer_load_dwordx4 v11, s[20:23], s42 offen offset:3072 lds
    s_add_u32 s42, s42, 131072
    s_add_u32 s44, s44, 32768
    s_cmp_ge_u32 s44, s56
    s_cselect_b32 s44, s45, s44
    s_waitcnt vmcnt(8)
    s_barrier
    s_mov_b32 m0, s44
    s_nop 0
    buffer_load_dwordx4 v7, s[16:19], s41 offen offset:0 lds
    buffer_load_dwordx4 v7, s[16:19], s41 offen offset:1024 lds
    buffer_load_dwordx4 v7, s[16:19], s41 offen offset:2048 lds
    buffer_load_dwordx4 v7, s[16:19], s41 offen offset:3072 lds
    s_add_u32 m0, s44, 16384
    s_add_u32 s41, s41, 262144
    buffer_load_dwordx4 v8, s[20:23], s42 offen offset:0 lds
    buffer_load_dwordx4 v9, s[20:23], s42 offen offset:1024 lds
    buffer_load_dwordx4 v10, s[20:23], s42 offen offset:2048 lds
    buffer_load_dwordx4 v11, s[20:23], s42 offen offset:3072 lds
    s_add_u32 s42, s42, 131072
    s_add_u32 s44, s44, 32768
    s_cmp_ge_u32 s44, s56
    s_cselect_b32 s44, s45, s44
    s_mov_b32 m0, s44
    s_nop 0
    buffer_load_dwordx4 v7, s[16:19], s41 offen offset:0 lds
    buffer_load_dwordx4 v7, s[16:19], s41 offen offset:1024 lds
    buffer_load_dwordx4 v7, s[16:19], s41 offen offset:2048 lds
    buffer_load_dwordx4 v7, s[16:19], s41 offen offset:3072 lds
    s_add_u32 m0, s44, 16384
    s_add_u32 s41, s41, 262144
    buffer_load_dwordx4 v8, s[20:23], s42 offen offset:0 lds
    buffer_load_dwordx4 v9, s[20:23], s42 offen offset:1024 lds
    buffer_load_dwordx4 v10, s[20:23], s42 offen offset:2048 lds
    buffer_load_dwordx4 v11, s[20:23], s42 offen offset:3072 lds
    s_add_u32 s42, s42, 131072
    s_add_u32 s44, s44, 32768
    s_cmp_ge_u32 s44, s56
    s_cselect_b32 s44, s45, s44
    s_mov_b32 m0, s44
    s_nop 0
    buffer_load_dwordx4 v7, s[16:19], s41 offen offset:0 lds
    buffer_load_dwordx4 v7, s[16:19], s41 offen offset:1024 lds
    buffer_load_dwordx4 v7, s[16:19], s41 offen offset:2048 lds
    buffer_load_dwordx4 v7, s[16:19], s41 offen offset:3072 lds
    s_add_u32 m0, s44, 16384
    s_add_u32 s41, s41, 262144
    buffer_load_dwordx4 v8, s[20:23], s42 offen offset:0 lds
    buffer_load_dwordx4 v9, s[20:23], s42 offen offset:1024 lds
    buffer_load_dwordx4 v10, s[20:23], s42 offen offset:2048 lds
    buffer_load_dwordx4 v11, s[20:23], s42 offen offset:3072 lds
    s_add_u32 s42, s42, 131072
    s_add_u32 s44, s44, 32768
    s_cmp_ge_u32 s44, s56
    s_cselect_b32 s44, s45, s44
    s_mov_b32 s47, 5
gemm3_kernel_ll16:
    s_waitcnt vmcnt(24)
    s_barrier
    s_cmp_eq_u32 s47, s57
    s_cselect_b32 s41, s40, s41
    s_cselect_b32 s42, s46, s42
    s_cselect_b32 s20, s12, s20
    s_cselect_b32 s21, s13, s21
    s_cselect_b32 s22, 2097152, s22
    s_mov_b32 m0, s44
    s_nop 0
    buffer_load_dwordx4 v7, s[16:19], s41 offen offset:0 lds
    buffer_load_dwordx4 v7, s[16:19], s41 offen offset:1024 lds
    buffer_load_dwordx4 v7, s[16:19], s41 offen offset:2048 lds
    buffer_load_dwordx4 v7, s[16:19], s41 offen offset:3072 lds
    s_add_u32 m0, s44, 16384
    s_add_u32 s41, s41, 262144
    buffer_load_dwordx4 v8, s[20:23], s42 offen offset:0 lds
    buffer_load_dwordx4 v9, s[20:23], s42 offen offset:1024 lds
    buffer_load_dwordx4 v10, s[20:23], s42 offen offset:2048 lds
    buffer_load_dwordx4 v11, s[20:23], s42 offen offset:3072 lds
    s_add_u32 s42, s42, 131072
    s_add_u32 s44, s44, 32768
    s_cmp_ge_u32 s44, s56
    s_cselect_b32 s44, s45, s44
    s_add_u32 s47, s47, 1
    s_cmp_lt_u32 s47, s58
    s_cbranch_scc1 gemm3_kernel_ll16
    s_waitcnt vmcnt(24)
    s_barrier
    s_waitcnt vmcnt(16)
    s_barrier
    s_waitcnt vmcnt(8)
    s_barrier
    s_waitcnt vmcnt(0)
    s_barrier
    s_endpgm
gemm3_kernel_end:
.section .rodata,"a"
.p2align 6
.amdhsa_kernel mega_kernel
  .amdhsa_next_free_vgpr 512
  .amdhsa_next_free_sgpr 102
  .amdhsa_accum_offset 256
  .amdhsa_group_segment_fixed_size 0
  .amdhsa_kernarg_size 96
  .amdhsa_user_sgpr_count 2
  .amdhsa_user_sgpr_kernarg_segment_ptr 1
  .amdhsa_system_sgpr_workgroup_id_x 1
.end_amdhsa_kernel
.section .rodata,"a"
.p2align 6
.amdhsa_kernel gemm3_kernel
  .amdhsa_next_free_vgpr 224
  .amdhsa_next_free_sgpr 102
  .amdhsa_accum_offset 224
  .amdhsa_group_segment_fixed_size 0
  .amdhsa_kernarg_size 96
  .amdhsa_user_sgpr_count 2
  .amdhsa_user_sgpr_kernarg_segment_ptr 1
  .amdhsa_system_sgpr_workgroup_id_x 1
.end_amdhsa_kernel
```

```asm
; @launch kernel=mega_kernel grid=(256,1,1) block=(256,1,1) lds=163840
; @launch kernel=gemm3_kernel grid=(256,1,1) block=(512,1,1) lds=163840
.amdgcn_target "amdgcn-amd-amdhsa--gfx950"
.text
.globl mega_kernel
.p2align 8
.type mega_kernel,@function
mega_kernel:
    s_cmp_ge_u32 s2, 256
    s_cbranch_scc1 mega_kernel_end1
    s_load_dwordx16 s[24:39], s[0:1], 0
    s_load_dwordx4 s[4:7], s[0:1], 80
    v_and_b32 v1, 63, v0
    v_lshrrev_b32 v24, 6, v0
    s_nop 0
    v_readfirstlane_b32 s16, v24
    s_lshr_b32 s68, s2, 3
    s_lshr_b32 s57, s16, 1
    s_and_b32 s58, s16, 1
    s_mov_b32 s43, 0x20000
    s_mov_b32 s47, 0x20000
    s_cmp_lt_u32 s68, 29
    s_cbranch_scc1 mega_kernel_ncp2
    s_sub_u32 s91, s68, 29
    s_lshl_b32 s91, s91, 2
    s_add_u32 s91, s91, s16
    s_getpc_b64 s[8:9]
mega_kernel_pc3:
    s_sub_u32 s8, s8, mega_kernel_pc3-mega_kernel
    s_subb_u32 s9, s9, 0
    s_mov_b32 s10, gemm3_kernel_end-mega_kernel
    s_mov_b32 s11, 0x20000
    s_lshl_b32 s90, s91, 13
    v_lshlrev_b32 v24, 7, v1
    buffer_load_dword v22, v24, s[8:11], s90 offen
mega_kernel_ncp2:
    v_and_b32 v24, 15, v1
    v_lshrrev_b32 v25, 4, v1
    v_bfe_u32 v26, v1, 1, 3
    v_xor_b32 v26, v26, v25
    s_lshl_b32 s90, s57, 14
    v_lshlrev_b32 v27, 7, v24
    v_add_u32 v27, s90, v27
    v_xor_b32 v28, 0, v26
    v_lshl_add_u32 v6, v28, 4, v27
    v_xor_b32 v28, 4, v26
    v_lshl_add_u32 v7, v28, 4, v27
    v_bfe_u32 v26, v1, 2, 2
    v_lshl_add_u32 v27, v25, 3, v26
    v_lshlrev_b32 v27, 9, v27
    v_and_b32 v28, 3, v1
    v_lshlrev_b32 v28, 3, v28
    v_add_u32 v27, v27, v28
    s_lshl_b32 s90, s58, 8
    s_add_u32 s90, s90, 98304
    v_add_u32 v27, s90, v27
    v_bfe_u32 v26, v1, 2, 3
    v_xor_b32 v28, 0, v26
    v_lshl_add_u32 v8, v28, 5, v27
    v_xor_b32 v28, 1, v26
    v_lshl_add_u32 v9, v28, 5, v27
    v_xor_b32 v28, 2, v26
    v_lshl_add_u32 v10, v28, 5, v27
    v_xor_b32 v28, 3, v26
    v_lshl_add_u32 v11, v28, 5, v27
    v_xor_b32 v28, 4, v26
    v_lshl_add_u32 v12, v28, 5, v27
    v_xor_b32 v28, 5, v26
    v_lshl_add_u32 v13, v28, 5, v27
    v_xor_b32 v28, 6, v26
    v_lshl_add_u32 v14, v28, 5, v27
    v_xor_b32 v28, 7, v26
    v_lshl_add_u32 v15, v28, 5, v27
    v_lshlrev_b32 v2, 4, v1
    s_lshl_b32 s61, s16, 13
    s_add_u32 s62, s61, 98304
    s_mov_b32 s64, 0
    s_mov_b32 s59, 32768
    s_mov_b32 s60, 229376
    s_waitcnt lgkmcnt(0)
    s_mov_b32 s8, s6
    s_mov_b32 s9, s7
    s_mov_b32 s10, 268435456
    s_mov_b32 s11, 0x20000
    s_mov_b32 s70, 0
    s_cmp_ge_u32 s68, 16
    s_cbranch_scc1 mega_kernel_typea4
    s_and_b32 s69, s68, 3
    s_and_b32 s90, s2, 1
    s_lshl_b32 s90, s90, 2
    s_add_u32 s69, s69, s90
    s_bfe_u32 s90, s2, 0x20001
    s_mul_i32 s90, s90, 4
    s_bfe_u32 s91, s68, 0x20002
    s_add_u32 s90, s90, s91
    s_mov_b32 s76, 8388608
    s_mov_b32 s78, 8192
    s_mov_b32 s81, 0
    s_mov_b32 s73, 4194304
    s_mov_b32 s77, 2048
    s_mov_b32 s82, 16
    s_lshl_b32 s80, s90, 9
    s_lshl_b32 s79, s69, 19
    s_lshl_b32 s88, s90, 4
    s_add_u32 s88, s88, s69
    s_lshl_b32 s88, s88, 3
    s_mov_b32 s83, 0
    s_mov_b32 s84, 1040356334
    s_lshl_b32 s91, s90, 1
    s_add_u32 s91, s91, s58
    s_lshl_b32 s91, s91, 19
    s_lshl_b32 s92, s69, 1
    s_add_u32 s92, s92, s57
    s_lshl_b32 s92, s92, 15
    s_add_u32 s85, s91, s92
    s_add_u32 s85, s85, 0
    s_mov_b32 s86, 1024
    s_mov_b32 s87, 4096
    s_mov_b32 s71, s30
    s_mov_b32 s72, s31
    s_mov_b32 s74, s34
    s_mov_b32 s75, s35
    s_branch mega_kernel_go15
mega_kernel_typea4:
    s_cmp_lt_u32 s68, 28
    s_cbranch_scc1 mega_kernel_nopf6
    s_mov_b32 s70, 1
    s_sub_u32 s93, s2, 224
    s_lshl_b32 s93, s93, 2
    s_add_u32 s93, s93, s16
    v_lshlrev_b32 v24, 7, v1
    v_lshrrev_b32 v25, 3, v1
    v_lshlrev_b32 v25, 11, v25
    v_and_b32 v26, 7, v1
    v_lshl_add_u32 v25, v26, 7, v25
    s_lshl_b32 s92, s93, 13
    s_lshl_b32 s93, s93, 14
    s_add_u32 s93, s93, 1024
    s_mov_b32 s40, s26
    s_mov_b32 s41, s27
    s_mov_b32 s42, 6291456
    s_add_u32 s90, s92, 0
    buffer_load_dword v22, v24, s[40:43], s90 offen
    s_add_u32 s90, s92, 1048576
    buffer_load_dword v22, v24, s[40:43], s90 offen
    s_mov_b32 s40, s24
    s_mov_b32 s41, s25
    s_mov_b32 s42, 4194304
    s_add_u32 s90, s92, 0
    buffer_load_dword v22, v24, s[40:43], s90 offen
    s_add_u32 s90, s92, 1048576
    buffer_load_dword v22, v24, s[40:43], s90 offen
    s_add_u32 s90, s92, 2097152
    buffer_load_dword v22, v24, s[40:43], s90 offen
    s_add_u32 s90, s92, 3145728
    buffer_load_dword v22, v24, s[40:43], s90 offen
    s_mov_b32 s40, s34
    s_mov_b32 s41, s35
    s_mov_b32 s42, 8388608
    s_add_u32 s90, s92, 4194304
    buffer_load_dword v22, v24, s[40:43], s90 offen
    s_add_u32 s90, s92, 5242880
    buffer_load_dword v22, v24, s[40:43], s90 offen
    s_mov_b32 s40, s30
    s_mov_b32 s41, s31
    s_mov_b32 s42, 4194304
    s_add_u32 s90, s93, 0
    buffer_load_dword v22, v25, s[40:43], s90 offen
    s_add_u32 s90, s93, 2097152
    buffer_load_dword v22, v25, s[40:43], s90 offen
    s_mov_b32 s40, s26
    s_mov_b32 s41, s27
    s_mov_b32 s42, 6291456
    s_add_u32 s90, s92, 2097152
    buffer_load_dword v22, v24, s[40:43], s90 offen
    s_mov_b32 s40, s34
    s_mov_b32 s41, s35
    s_mov_b32 s42, 8388608
    s_add_u32 s90, s92, 6291456
    buffer_load_dword v22, v24, s[40:43], s90 offen
    s_add_u32 s90, s92, 7340032
    buffer_load_dword v22, v24, s[40:43], s90 offen
    s_mov_b32 s40, s26
    s_mov_b32 s41, s27
    s_mov_b32 s42, 6291456
    s_add_u32 s90, s92, 3145728
    buffer_load_dword v22, v24, s[40:43], s90 offen
    s_add_u32 s90, s92, 4194304
    buffer_load_dword v22, v24, s[40:43], s90 offen
    s_add_u32 s90, s92, 5242880
    buffer_load_dword v22, v24, s[40:43], s90 offen
    s_mov_b32 s40, s32
    s_mov_b32 s41, s33
    s_mov_b32 s42, 2097152
    s_add_u32 s90, s92, 1048576
    buffer_load_dword v22, v24, s[40:43], s90 offen
mega_kernel_nopf6:
    s_bfe_u32 s69, s68, 0x20002
    s_add_u32 s69, s69, 0
    s_and_b32 s90, s2, 7
    s_lshl_b32 s90, s90, 2
    s_and_b32 s91, s68, 3
    s_add_u32 s90, s90, s91
    s_cmp_lt_u32 s90, 16
    s_cselect_b32 s83, 0, 1
    s_mov_b32 s91, 33554432
    s_cselect_b32 s85, 16777216, s91
    s_mov_b32 s91, 8192
    s_cselect_b32 s86, 1024, s91
    s_mov_b32 s91, 1024
    s_cselect_b32 s87, 4096, s91
    s_cselect_b32 s74, s36, s38
    s_cselect_b32 s75, s37, s39
    s_mov_b32 s71, s32
    s_mov_b32 s72, s33
    s_mov_b32 s73, 2097152
    s_mov_b32 s77, 1024
    s_mov_b32 s82, 8
    s_mov_b32 s81, 0
    s_mov_b32 s76, 4194304
    s_mov_b32 s78, 8192
    s_mov_b32 s84, 0
    s_and_b32 s90, s90, 15
    s_lshl_b32 s80, s90, 9
    s_lshl_b32 s79, s69, 18
    s_lshl_b32 s91, s83, 2
    s_add_u32 s91, s91, s69
    s_cmp_ge_u32 s69, 4
    s_cselect_b32 s92, 508, 8
    s_add_u32 s91, s91, s92
    s_lshl_b32 s88, s90, 4
    s_add_u32 s88, s88, s91
    s_lshl_b32 s88, s88, 3
    s_lshl_b32 s91, s90, 1
    s_add_u32 s91, s91, s58
    s_lshl_b32 s91, s91, 19
    s_lshl_b32 s92, s69, 1
    s_add_u32 s92, s92, s57
    s_lshl_b32 s92, s92, 15
    s_add_u32 s85, s85, s91
    s_add_u32 s85, s85, s92
mega_kernel_go15:
    s_mov_b32 s42, s73
    s_mov_b32 s46, s76
    s_lshl_b32 s90, s77, 4
    s_lshl_b32 s90, s90, s81
    s_mov_b32 s48, s79
    s_mul_i32 s91, s90, 1
    s_add_u32 s49, s91, s79
    s_sub_u32 s49, s49, 2048
    s_mul_i32 s91, s90, 2
    s_add_u32 s50, s91, s79
    s_mul_i32 s91, s90, 3
    s_add_u32 s51, s91, s79
    s_sub_u32 s51, s51, 2048
    s_mov_b32 s52, s80
    s_lshl_b32 s90, s78, 2
    s_mul_i32 s91, s90, 1
    s_add_u32 s53, s91, s80
    s_sub_u32 s53, s53, 2048
    s_mul_i32 s91, s90, 2
    s_add_u32 s54, s91, s80
    s_mul_i32 s91, s90, 3
    s_add_u32 s55, s91, s80
    s_sub_u32 s55, s55, 2048
    s_lshl_b32 s56, s78, 6
    s_lshl_b32 s90, s58, 7
    s_add_u32 s90, s90, s57
    s_lshl_b32 s91, s16, 6
    s_cmp_eq_u32 s81, 1
    s_cselect_b32 s90, s90, s91
    v_lshrrev_b32 v24, 3, v1
    v_lshlrev_b32 v24, s81, v24
    v_add_u32 v24, s90, v24
    v_mul_lo_u32 v24, v24, s77
    v_lshrrev_b32 v25, 4, v1
    v_and_b32 v26, 7, v1
    v_xor_b32 v25, v25, v26
    v_lshl_add_u32 v16, v25, 4, v24
    v_xor_b32 v25, 4, v25
    v_lshl_add_u32 v17, v25, 4, v24
    s_lshl_b32 s90, s77, 3
    s_lshl_b32 s90, s90, s81
    s_sub_u32 s90, s90, 1024
    v_add_u32 v17, s90, v17
    v_lshrrev_b32 v24, 5, v1
    s_lshl_b32 s90, s16, 4
    v_add_u32 v25, s90, v24
    v_mul_lo_u32 v25, v25, s78
    v_lshlrev_b32 v24, 1, v24
    v_and_b32 v26, 31, v1
    v_xor_b32 v24, v24, v26
    s_lshl_b32 s90, s78, 1
    s_sub_u32 s90, s90, 1024
    v_add_u32 v27, s90, v25
    v_xor_b32 v26, 0, v24
    v_lshl_add_u32 v18, v26, 4, v25
    v_xor_b32 v26, 4, v24
    v_lshl_add_u32 v19, v26, 4, v27
    v_xor_b32 v26, 8, v24
    v_lshl_add_u32 v20, v26, 4, v25
    v_xor_b32 v26, 12, v24
    v_lshl_add_u32 v21, v26, 4, v27
    s_mov_b32 s40, s71
    s_mov_b32 s41, s72
    s_mov_b32 s44, s74
    s_mov_b32 s45, s75
    s_mov_b32 s95, s82
    s_mov_b32 s96, s83
    s_mov_b32 s97, s84
    s_mov_b32 s98, s85
    s_mov_b32 s99, s86
    s_mov_b32 s100, s87
    s_mov_b32 s101, s88
    s_add_u32 m0, s61, 0
    s_nop 0
    buffer_load_dwordx4 v16, s[40:43], s48 offen offset:0 lds
    buffer_load_dwordx4 v17, s[40:43], s48 offen offset:1024 lds
    s_add_u32 s48, s48, 128
    buffer_load_dwordx4 v16, s[40:43], s49 offen offset:2048 lds
    buffer_load_dwordx4 v17, s[40:43], s49 offen offset:3072 lds
    s_add_u32 s49, s49, 128
    s_add_u32 m0, s61, 4096
    s_nop 0
    buffer_load_dwordx4 v16, s[40:43], s50 offen offset:0 lds
    buffer_load_dwordx4 v17, s[40:43], s50 offen offset:1024 lds
    s_add_u32 s50, s50, 128
    buffer_load_dwordx4 v16, s[40:43], s51 offen offset:2048 lds
    buffer_load_dwordx4 v17, s[40:43], s51 offen offset:3072 lds
    s_add_u32 s51, s51, 128
    s_add_u32 s61, s61, 32768
    s_cmp_ge_u32 s61, 98304
    s_cselect_b32 s90, 98304, 0
    s_sub_u32 s61, s61, s90
    s_add_u32 m0, s62, 0
    s_nop 0
    buffer_load_dwordx4 v18, s[44:47], s52 offen offset:0 lds
    buffer_load_dwordx4 v19, s[44:47], s52 offen offset:1024 lds
    s_add_u32 s52, s52, s56
    buffer_load_dwordx4 v18, s[44:47], s53 offen offset:2048 lds
    buffer_load_dwordx4 v19, s[44:47], s53 offen offset:3072 lds
    s_add_u32 s53, s53, s56
    s_add_u32 m0, s62, 4096
    s_nop 0
    buffer_load_dwordx4 v20, s[44:47], s54 offen offset:0 lds
    buffer_load_dwordx4 v21, s[44:47], s54 offen offset:1024 lds
    s_add_u32 s54, s54, s56
    buffer_load_dwordx4 v20, s[44:47], s55 offen offset:2048 lds
    buffer_load_dwordx4 v21, s[44:47], s55 offen offset:3072 lds
    s_add_u32 s55, s55, s56
    s_xor_b32 s62, s62, 229376
    s_cmp_ge_u32 s68, 16
    s_cbranch_scc1 mega_kernel_typea7
    s_bfe_u32 s69, s68, 0x20002
    s_add_u32 s69, s69, 4
    s_and_b32 s90, s2, 7
    s_lshl_b32 s90, s90, 2
    s_and_b32 s91, s68, 3
    s_add_u32 s90, s90, s91
    s_cmp_lt_u32 s90, 16
    s_cselect_b32 s83, 0, 1
    s_mov_b32 s91, 33554432
    s_cselect_b32 s85, 16777216, s91
    s_mov_b32 s91, 8192
    s_cselect_b32 s86, 1024, s91
    s_mov_b32 s91, 1024
    s_cselect_b32 s87, 4096, s91
    s_cselect_b32 s74, s36, s38
    s_cselect_b32 s75, s37, s39
    s_mov_b32 s71, s32
    s_mov_b32 s72, s33
    s_mov_b32 s73, 2097152
    s_mov_b32 s77, 1024
    s_mov_b32 s82, 8
    s_mov_b32 s81, 0
    s_mov_b32 s76, 4194304
    s_mov_b32 s78, 8192
    s_mov_b32 s84, 0
    s_and_b32 s90, s90, 15
    s_lshl_b32 s80, s90, 9
    s_lshl_b32 s79, s69, 18
    s_lshl_b32 s91, s83, 2
    s_add_u32 s91, s91, s69
    s_cmp_ge_u32 s69, 4
    s_cselect_b32 s92, 508, 8
    s_add_u32 s91, s91, s92
    s_lshl_b32 s88, s90, 4
    s_add_u32 s88, s88, s91
    s_lshl_b32 s88, s88, 3
    s_lshl_b32 s91, s90, 1
    s_add_u32 s91, s91, s58
    s_lshl_b32 s91, s91, 19
    s_lshl_b32 s92, s69, 1
    s_add_u32 s92, s92, s57
    s_lshl_b32 s92, s92, 15
    s_add_u32 s85, s85, s91
    s_add_u32 s85, s85, s92
    s_branch mega_kernel_go28
mega_kernel_typea7:
    s_and_b32 s69, s68, 3
    s_and_b32 s90, s2, 1
    s_lshl_b32 s90, s90, 2
    s_add_u32 s69, s69, s90
    s_bfe_u32 s90, s2, 0x20001
    s_mul_i32 s90, s90, 3
    s_bfe_u32 s91, s68, 0x20002
    s_add_u32 s90, s90, s91
    s_mov_b32 s76, 6291456
    s_mov_b32 s78, 6144
    s_mov_b32 s81, 1
    s_mov_b32 s73, 4194304
    s_mov_b32 s77, 2048
    s_mov_b32 s82, 16
    s_lshl_b32 s80, s90, 9
    s_lshl_b32 s79, s69, 19
    s_and_b32 s92, s90, 3
    s_lshr_b32 s91, s90, 2
    s_lshl_b32 s88, s92, 2
    s_add_u32 s88, s88, s91
    s_lshl_b32 s88, s88, 3
    s_add_u32 s88, s88, s69
    s_lshl_b32 s88, s88, 3
    s_add_u32 s88, s88, 6144
    s_cmp_eq_u32 s91, 0
    s_cselect_b32 s84, 1048744942, 0
    s_lshl_b32 s93, s91, 22
    s_add_u32 s85, s93, 50331648
    s_lshl_b32 s92, s92, 1
    s_add_u32 s92, s92, s58
    s_lshl_b32 s92, s92, 19
    s_add_u32 s85, s85, s92
    s_lshl_b32 s92, s57, 3
    s_add_u32 s92, s92, s69
    s_cmp_eq_u32 s91, 2
    s_cselect_b32 s83, 1, 0
    s_cselect_b32 s93, 12, 13
    s_mov_b32 s91, 131072
    s_cselect_b32 s86, 1024, s91
    s_mov_b32 s91, 1024
    s_cselect_b32 s87, 65536, s91
    s_lshl_b32 s92, s92, s93
    s_add_u32 s85, s85, s92
    s_mov_b32 s71, s24
    s_mov_b32 s72, s25
    s_mov_b32 s74, s26
    s_mov_b32 s75, s27
mega_kernel_go28:
    s_xor_b32 s94, s70, 1
    s_mov_b32 s67, 2
    s_mov_b32 s17, -1
    s_mov_b32 s12, s4
    s_mov_b32 s13, s5
    s_mov_b32 s14, 256
    s_mov_b32 s15, 0x20000
    s_lshl_b32 s90, s2, 2
    s_add_u32 s90, s90, s16
    s_cmp_lg_u32 s90, 0
    s_cbranch_scc1 mega_kernel_tok9
    s_memrealtime s[92:93]
    s_waitcnt lgkmcnt(0)
    s_or_b32 s92, s92, 1
    v_mov_b32 v4, s92
    v_mov_b32 v5, s93
    s_mov_b64 exec, 1
    buffer_store_dwordx2 v[4:5], off, s[12:15], 0 sc1
    s_mov_b64 exec, -1
mega_kernel_tok9:
    s_add_u32 m0, s61, 0
    s_nop 0
    buffer_load_dwordx4 v16, s[40:43], s48 offen offset:0 lds
    buffer_load_dwordx4 v17, s[40:43], s48 offen offset:1024 lds
    s_add_u32 s48, s48, 128
    buffer_load_dwordx4 v16, s[40:43], s49 offen offset:2048 lds
    buffer_load_dwordx4 v17, s[40:43], s49 offen offset:3072 lds
    s_add_u32 s49, s49, 128
    s_add_u32 m0, s61, 4096
    s_nop 0
    buffer_load_dwordx4 v16, s[40:43], s50 offen offset:0 lds
    buffer_load_dwordx4 v17, s[40:43], s50 offen offset:1024 lds
    s_add_u32 s50, s50, 128
    buffer_load_dwordx4 v16, s[40:43], s51 offen offset:2048 lds
    buffer_load_dwordx4 v17, s[40:43], s51 offen offset:3072 lds
    s_add_u32 s51, s51, 128
    s_add_u32 s61, s61, 32768
    s_cmp_ge_u32 s61, 98304
    s_cselect_b32 s90, 98304, 0
    s_sub_u32 s61, s61, s90
    s_add_u32 m0, s62, 0
    s_nop 0
    buffer_load_dwordx4 v18, s[44:47], s52 offen offset:0 lds
    buffer_load_dwordx4 v19, s[44:47], s52 offen offset:1024 lds
    s_add_u32 s52, s52, s56
    buffer_load_dwordx4 v18, s[44:47], s53 offen offset:2048 lds
    buffer_load_dwordx4 v19, s[44:47], s53 offen offset:3072 lds
    s_add_u32 s53, s53, s56
    s_add_u32 m0, s62, 4096
    s_nop 0
    buffer_load_dwordx4 v20, s[44:47], s54 offen offset:0 lds
    buffer_load_dwordx4 v21, s[44:47], s54 offen offset:1024 lds
    s_add_u32 s54, s54, s56
    buffer_load_dwordx4 v20, s[44:47], s55 offen offset:2048 lds
    buffer_load_dwordx4 v21, s[44:47], s55 offen offset:3072 lds
    s_add_u32 s55, s55, s56
    s_xor_b32 s62, s62, 229376
    s_waitcnt vmcnt(16)
    s_barrier
    ds_read_b64_tr_b16 a[64:65], v8 offset:0
    ds_read_b64_tr_b16 a[66:67], v8 offset:2048
    ds_read_b128 a[0:3], v6 offset:0
    ds_read_b128 a[4:7], v6 offset:2048
    ds_read_b64_tr_b16 a[68:69], v9 offset:0
    ds_read_b64_tr_b16 a[70:71], v9 offset:2048
    ds_read_b128 a[8:11], v6 offset:4096
    ds_read_b128 a[12:15], v6 offset:6144
    ds_read_b64_tr_b16 a[72:73], v10 offset:0
    ds_read_b64_tr_b16 a[74:75], v10 offset:2048
    ds_read_b128 a[16:19], v6 offset:8192
    ds_read_b128 a[20:23], v6 offset:10240
    ds_read_b64_tr_b16 a[76:77], v11 offset:0
    ds_read_b64_tr_b16 a[78:79], v11 offset:2048
    ds_read_b128 a[24:27], v6 offset:12288
    ds_read_b128 a[28:31], v6 offset:14336
    ds_read_b64_tr_b16 a[80:81], v12 offset:0
    ds_read_b64_tr_b16 a[82:83], v12 offset:2048
    ds_read_b64_tr_b16 a[84:85], v13 offset:0
    ds_read_b64_tr_b16 a[86:87], v13 offset:2048
    ds_read_b64_tr_b16 a[88:89], v14 offset:0
    ds_read_b64_tr_b16 a[90:91], v14 offset:2048
    ds_read_b64_tr_b16 a[92:93], v15 offset:0
    ds_read_b64_tr_b16 a[94:95], v15 offset:2048
    s_mov_b32 s66, 1
    s_mov_b32 s24, s6
    s_mov_b32 s25, s7
    s_mov_b32 s26, 0
    s_mov_b32 s27, 0x20000
    s_mov_b32 s28, 0
    s_mov_b32 s29, 0
    s_mov_b32 s30, 0
    s_mov_b32 s31, 0
mega_kernel_tile10:
    s_mov_b32 s65, s95
    s_cmp_eq_u32 s96, 1
    s_cbranch_scc1 mega_kernel_swp12
    s_waitcnt lgkmcnt(15)
    v_mfma_f32_16x16x32_bf16 v[32:35], a[64:67], a[0:3], 0
    v_mfma_f32_16x16x32_bf16 v[40:43], a[64:67], a[4:7], 0
    v_mfma_f32_16x16x32_bf16 v[48:51], a[64:67], a[8:11], 0
    v_mfma_f32_16x16x32_bf16 v[56:59], a[64:67], a[12:15], 0
    s_add_u32 m0, s61, 0
    s_waitcnt lgkmcnt(13)
    v_mfma_f32_16x16x32_bf16 v[64:67], a[64:67], a[16:19], 0
    buffer_load_dwordx4 v16, s[40:43], s48 offen offset:0 lds
    s_waitcnt lgkmcnt(12)
    v_mfma_f32_16x16x32_bf16 v[72:75], a[64:67], a[20:23], 0
    s_waitcnt lgkmcnt(9)
    v_mfma_f32_16x16x32_bf16 v[80:83], a[64:67], a[24:27], 0
    s_waitcnt lgkmcnt(8)
    v_mfma_f32_16x16x32_bf16 v[88:91], a[64:67], a[28:31], 0
    ds_read_b64_tr_b16 a[64:65], v8 offset:16384
    v_mfma_f32_16x16x32_bf16 v[36:39], a[68:71], a[0:3], 0
    ds_read_b64_tr_b16 a[66:67], v8 offset:18432
    v_mfma_f32_16x16x32_bf16 v[44:47], a[68:71], a[4:7], 0
    v_mfma_f32_16x16x32_bf16 v[52:55], a[68:71], a[8:11], 0
    ds_read_b128 a[32:35], v7 offset:0
    v_mfma_f32_16x16x32_bf16 v[60:63], a[68:71], a[12:15], 0
    v_mfma_f32_16x16x32_bf16 v[68:71], a[68:71], a[16:19], 0
    buffer_load_dwordx4 v17, s[40:43], s48 offen offset:1024 lds
    v_mfma_f32_16x16x32_bf16 v[76:79], a[68:71], a[20:23], 0
    s_add_u32 s48, s48, 128
    v_mfma_f32_16x16x32_bf16 v[84:87], a[68:71], a[24:27], 0
    ds_read_b128 a[36:39], v7 offset:2048
    v_mfma_f32_16x16x32_bf16 v[92:95], a[68:71], a[28:31], 0
    ds_read_b64_tr_b16 a[68:69], v9 offset:16384
    v_mfma_f32_16x16x32_bf16 v[96:99], a[72:75], a[0:3], 0
    ds_read_b64_tr_b16 a[70:71], v9 offset:18432
    v_mfma_f32_16x16x32_bf16 v[104:107], a[72:75], a[4:7], 0
    v_mfma_f32_16x16x32_bf16 v[112:115], a[72:75], a[8:11], 0
    ds_read_b128 a[40:43], v7 offset:4096
    v_mfma_f32_16x16x32_bf16 v[120:123], a[72:75], a[12:15], 0
    v_mfma_f32_16x16x32_bf16 v[128:131], a[72:75], a[16:19], 0
    buffer_load_dwordx4 v16, s[40:43], s49 offen offset:2048 lds
    v_mfma_f32_16x16x32_bf16 v[136:139], a[72:75], a[20:23], 0
    v_mfma_f32_16x16x32_bf16 v[144:147], a[72:75], a[24:27], 0
    ds_read_b128 a[44:47], v7 offset:6144
    v_mfma_f32_16x16x32_bf16 v[152:155], a[72:75], a[28:31], 0
    ds_read_b64_tr_b16 a[72:73], v10 offset:16384
    v_mfma_f32_16x16x32_bf16 v[100:103], a[76:79], a[0:3], 0
    ds_read_b64_tr_b16 a[74:75], v10 offset:18432
    v_mfma_f32_16x16x32_bf16 v[108:111], a[76:79], a[4:7], 0
    v_mfma_f32_16x16x32_bf16 v[116:119], a[76:79], a[8:11], 0
    ds_read_b128 a[48:51], v7 offset:8192
    v_mfma_f32_16x16x32_bf16 v[124:127], a[76:79], a[12:15], 0
    v_mfma_f32_16x16x32_bf16 v[132:135], a[76:79], a[16:19], 0
    buffer_load_dwordx4 v17, s[40:43], s49 offen offset:3072 lds
    v_mfma_f32_16x16x32_bf16 v[140:143], a[76:79], a[20:23], 0
    s_add_u32 s49, s49, 128
    v_mfma_f32_16x16x32_bf16 v[148:151], a[76:79], a[24:27], 0
    ds_read_b128 a[52:55], v7 offset:10240
    v_mfma_f32_16x16x32_bf16 v[156:159], a[76:79], a[28:31], 0
    ds_read_b64_tr_b16 a[76:77], v11 offset:16384
    s_waitcnt lgkmcnt(15)
    v_mfma_f32_16x16x32_bf16 v[160:163], a[80:83], a[0:3], 0
    ds_read_b64_tr_b16 a[78:79], v11 offset:18432
    v_mfma_f32_16x16x32_bf16 v[168:171], a[80:83], a[4:7], 0
    v_mfma_f32_16x16x32_bf16 v[176:179], a[80:83], a[8:11], 0
    ds_read_b128 a[56:59], v7 offset:12288
    v_mfma_f32_16x16x32_bf16 v[184:187], a[80:83], a[12:15], 0
    s_add_u32 m0, s61, 4096
    v_mfma_f32_16x16x32_bf16 v[192:195], a[80:83], a[16:19], 0
    buffer_load_dwordx4 v16, s[40:43], s50 offen offset:0 lds
    v_mfma_f32_16x16x32_bf16 v[200:203], a[80:83], a[20:23], 0
    v_mfma_f32_16x16x32_bf16 v[208:211], a[80:83], a[24:27], 0
    s_add_u32 s61, s61, 32768
    ds_read_b128 a[60:63], v7 offset:14336
    v_mfma_f32_16x16x32_bf16 v[216:219], a[80:83], a[28:31], 0
    s_cmp_ge_u32 s61, 98304
    s_cselect_b32 s90, 98304, 0
    ds_read_b64_tr_b16 a[80:81], v12 offset:16384
    v_mfma_f32_16x16x32_bf16 v[164:167], a[84:87], a[0:3], 0
    s_sub_u32 s61, s61, s90
    ds_read_b64_tr_b16 a[82:83], v12 offset:18432
    v_mfma_f32_16x16x32_bf16 v[172:175], a[84:87], a[4:7], 0
    s_add_u32 s64, s64, 32768
    v_mfma_f32_16x16x32_bf16 v[180:183], a[84:87], a[8:11], 0
    buffer_store_dwordx4 a[128:131], v2, s[24:27], s28 offen sc1
    v_mfma_f32_16x16x32_bf16 v[188:191], a[84:87], a[12:15], 0
    s_add_u32 s28, s28, s31
    v_mfma_f32_16x16x32_bf16 v[196:199], a[84:87], a[16:19], 0
    buffer_load_dwordx4 v17, s[40:43], s50 offen offset:1024 lds
    v_mfma_f32_16x16x32_bf16 v[204:207], a[84:87], a[20:23], 0
    s_add_u32 s50, s50, 128
    v_mfma_f32_16x16x32_bf16 v[212:215], a[84:87], a[24:27], 0
    s_cmp_ge_u32 s64, 98304
    s_cselect_b32 s63, 4294901760, s59
    s_cselect_b32 s64, 0, s64
    v_mfma_f32_16x16x32_bf16 v[220:223], a[84:87], a[28:31], 0
    ds_read_b64_tr_b16 a[84:85], v13 offset:16384
    v_mfma_f32_16x16x32_bf16 v[224:227], a[88:91], a[0:3], 0
    ds_read_b64_tr_b16 a[86:87], v13 offset:18432
    v_mfma_f32_16x16x32_bf16 v[232:235], a[88:91], a[4:7], 0
    v_mfma_f32_16x16x32_bf16 v[240:243], a[88:91], a[8:11], 0
    buffer_store_dwordx4 a[132:135], v2, s[24:27], s28 offen sc1
    v_mfma_f32_16x16x32_bf16 v[248:251], a[88:91], a[12:15], 0
    s_add_u32 s28, s28, s31
    v_mfma_f32_16x16x32_bf16 a[96:99], a[88:91], a[16:19], 0
    buffer_load_dwordx4 v16, s[40:43], s51 offen offset:2048 lds
    v_mfma_f32_16x16x32_bf16 a[104:107], a[88:91], a[20:23], 0
    v_mfma_f32_16x16x32_bf16 a[112:115], a[88:91], a[24:27], 0
    v_mfma_f32_16x16x32_bf16 a[120:123], a[88:91], a[28:31], 0
    ds_read_b64_tr_b16 a[88:89], v14 offset:16384
    s_waitcnt lgkmcnt(15)
    v_mfma_f32_16x16x32_bf16 v[228:231], a[92:95], a[0:3], 0
    ds_read_b64_tr_b16 a[90:91], v14 offset:18432
    v_mfma_f32_16x16x32_bf16 v[236:239], a[92:95], a[4:7], 0
    v_add_u32 v6, s63, v6
    v_add_u32 v7, s63, v7
    v_mfma_f32_16x16x32_bf16 v[244:247], a[92:95], a[8:11], 0
    buffer_store_dwordx4 a[136:139], v2, s[24:27], s28 offen sc1
    v_mfma_f32_16x16x32_bf16 v[252:255], a[92:95], a[12:15], 0
    s_add_u32 s28, s28, s31
    v_mfma_f32_16x16x32_bf16 a[100:103], a[92:95], a[16:19], 0
    buffer_load_dwordx4 v17, s[40:43], s51 offen offset:3072 lds
    v_mfma_f32_16x16x32_bf16 a[108:111], a[92:95], a[20:23], 0
    s_add_u32 s51, s51, 128
    v_mfma_f32_16x16x32_bf16 a[116:119], a[92:95], a[24:27], 0
    v_mfma_f32_16x16x32_bf16 a[124:127], a[92:95], a[28:31], 0
    ds_read_b64_tr_b16 a[92:93], v15 offset:16384
    ds_read_b64_tr_b16 a[94:95], v15 offset:18432
    v_mfma_f32_16x16x32_bf16 v[32:35], a[64:67], a[32:35], v[32:35]
    v_xor_b32 v8, s60, v8
    v_xor_b32 v9, s60, v9
    v_mfma_f32_16x16x32_bf16 v[40:43], a[64:67], a[36:39], v[40:43]
    v_xor_b32 v10, s60, v10
    v_xor_b32 v11, s60, v11
    s_waitcnt lgkmcnt(15)
    v_mfma_f32_16x16x32_bf16 v[48:51], a[64:67], a[40:43], v[48:51]
    v_xor_b32 v12, s60, v12
    v_xor_b32 v13, s60, v13
    v_mfma_f32_16x16x32_bf16 v[56:59], a[64:67], a[44:47], v[56:59]
    v_xor_b32 v14, s60, v14
    v_xor_b32 v15, s60, v15
    s_waitcnt lgkmcnt(13)
    v_mfma_f32_16x16x32_bf16 v[64:67], a[64:67], a[48:51], v[64:67]
    s_waitcnt lgkmcnt(12)
    v_mfma_f32_16x16x32_bf16 v[72:75], a[64:67], a[52:55], v[72:75]
    s_waitcnt lgkmcnt(9)
    v_mfma_f32_16x16x32_bf16 v[80:83], a[64:67], a[56:59], v[80:83]
    s_waitcnt vmcnt(11) lgkmcnt(0)
    v_mfma_f32_16x16x32_bf16 v[88:91], a[64:67], a[60:63], v[88:91]
    s_barrier
    ds_read_b64_tr_b16 a[64:65], v8 offset:0
    v_mfma_f32_16x16x32_bf16 v[36:39], a[68:71], a[32:35], v[36:39]
    s_add_u32 m0, s62, 0
    ds_read_b64_tr_b16 a[66:67], v8 offset:2048
    v_mfma_f32_16x16x32_bf16 v[44:47], a[68:71], a[36:39], v[44:47]
    buffer_load_dwordx4 v18, s[44:47], s52 offen offset:0 lds
    v_mfma_f32_16x16x32_bf16 v[52:55], a[68:71], a[40:43], v[52:55]
    ds_read_b128 a[0:3], v6 offset:0
    v_mfma_f32_16x16x32_bf16 v[60:63], a[68:71], a[44:47], v[60:63]
    v_mfma_f32_16x16x32_bf16 v[68:71], a[68:71], a[48:51], v[68:71]
    v_mfma_f32_16x16x32_bf16 v[76:79], a[68:71], a[52:55], v[76:79]
    buffer_load_dwordx4 v19, s[44:47], s52 offen offset:1024 lds
    v_mfma_f32_16x16x32_bf16 v[84:87], a[68:71], a[56:59], v[84:87]
    s_add_u32 s52, s52, s56
    ds_read_b128 a[4:7], v6 offset:2048
    v_mfma_f32_16x16x32_bf16 v[92:95], a[68:71], a[60:63], v[92:95]
    ds_read_b64_tr_b16 a[68:69], v9 offset:0
    v_mfma_f32_16x16x32_bf16 v[96:99], a[72:75], a[32:35], v[96:99]
    ds_read_b64_tr_b16 a[70:71], v9 offset:2048
    v_mfma_f32_16x16x32_bf16 v[104:107], a[72:75], a[36:39], v[104:107]
    buffer_load_dwordx4 v18, s[44:47], s53 offen offset:2048 lds
    v_mfma_f32_16x16x32_bf16 v[112:115], a[72:75], a[40:43], v[112:115]
    ds_read_b128 a[8:11], v6 offset:4096
    v_mfma_f32_16x16x32_bf16 v[120:123], a[72:75], a[44:47], v[120:123]
    v_mfma_f32_16x16x32_bf16 v[128:131], a[72:75], a[48:51], v[128:131]
    v_mfma_f32_16x16x32_bf16 v[136:139], a[72:75], a[52:55], v[136:139]
    buffer_load_dwordx4 v19, s[44:47], s53 offen offset:3072 lds
    v_mfma_f32_16x16x32_bf16 v[144:147], a[72:75], a[56:59], v[144:147]
    s_add_u32 s53, s53, s56
    ds_read_b128 a[12:15], v6 offset:6144
    v_mfma_f32_16x16x32_bf16 v[152:155], a[72:75], a[60:63], v[152:155]
    ds_read_b64_tr_b16 a[72:73], v10 offset:0
    v_mfma_f32_16x16x32_bf16 v[100:103], a[76:79], a[32:35], v[100:103]
    s_add_u32 m0, s62, 4096
    ds_read_b64_tr_b16 a[74:75], v10 offset:2048
    v_mfma_f32_16x16x32_bf16 v[108:111], a[76:79], a[36:39], v[108:111]
    buffer_load_dwordx4 v20, s[44:47], s54 offen offset:0 lds
    v_mfma_f32_16x16x32_bf16 v[116:119], a[76:79], a[40:43], v[116:119]
    ds_read_b128 a[16:19], v6 offset:8192
    v_mfma_f32_16x16x32_bf16 v[124:127], a[76:79], a[44:47], v[124:127]
    s_xor_b32 s62, s62, 229376
    v_mfma_f32_16x16x32_bf16 v[132:135], a[76:79], a[48:51], v[132:135]
    v_mfma_f32_16x16x32_bf16 v[140:143], a[76:79], a[52:55], v[140:143]
    buffer_load_dwordx4 v21, s[44:47], s54 offen offset:1024 lds
    v_mfma_f32_16x16x32_bf16 v[148:151], a[76:79], a[56:59], v[148:151]
    s_add_u32 s54, s54, s56
    ds_read_b128 a[20:23], v6 offset:10240
    v_mfma_f32_16x16x32_bf16 v[156:159], a[76:79], a[60:63], v[156:159]
    ds_read_b64_tr_b16 a[76:77], v11 offset:0
    v_mfma_f32_16x16x32_bf16 v[160:163], a[80:83], a[32:35], v[160:163]
    ds_read_b64_tr_b16 a[78:79], v11 offset:2048
    v_mfma_f32_16x16x32_bf16 v[168:171], a[80:83], a[36:39], v[168:171]
    buffer_load_dwordx4 v20, s[44:47], s55 offen offset:2048 lds
    v_mfma_f32_16x16x32_bf16 v[176:179], a[80:83], a[40:43], v[176:179]
    ds_read_b128 a[24:27], v6 offset:12288
    v_mfma_f32_16x16x32_bf16 v[184:187], a[80:83], a[44:47], v[184:187]
    v_mfma_f32_16x16x32_bf16 v[192:195], a[80:83], a[48:51], v[192:195]
    v_mfma_f32_16x16x32_bf16 v[200:203], a[80:83], a[52:55], v[200:203]
    buffer_load_dwordx4 v21, s[44:47], s55 offen offset:3072 lds
    v_mfma_f32_16x16x32_bf16 v[208:211], a[80:83], a[56:59], v[208:211]
    s_add_u32 s55, s55, s56
    ds_read_b128 a[28:31], v6 offset:14336
    v_mfma_f32_16x16x32_bf16 v[216:219], a[80:83], a[60:63], v[216:219]
    ds_read_b64_tr_b16 a[80:81], v12 offset:0
    v_mfma_f32_16x16x32_bf16 v[164:167], a[84:87], a[32:35], v[164:167]
    ds_read_b64_tr_b16 a[82:83], v12 offset:2048
    v_mfma_f32_16x16x32_bf16 v[172:175], a[84:87], a[36:39], v[172:175]
    v_mfma_f32_16x16x32_bf16 v[180:183], a[84:87], a[40:43], v[180:183]
    buffer_store_dwordx4 a[140:143], v2, s[24:27], s28 offen sc1
    v_mfma_f32_16x16x32_bf16 v[188:191], a[84:87], a[44:47], v[188:191]
    s_add_u32 s28, s28, s31
    v_mfma_f32_16x16x32_bf16 v[196:199], a[84:87], a[48:51], v[196:199]
    v_mfma_f32_16x16x32_bf16 v[204:207], a[84:87], a[52:55], v[204:207]
    v_mfma_f32_16x16x32_bf16 v[212:215], a[84:87], a[56:59], v[212:215]
    buffer_store_dwordx4 a[144:147], v2, s[24:27], s28 offen sc1
    v_mfma_f32_16x16x32_bf16 v[220:223], a[84:87], a[60:63], v[220:223]
    s_add_u32 s28, s28, s31
    ds_read_b64_tr_b16 a[84:85], v13 offset:0
    v_mfma_f32_16x16x32_bf16 v[224:227], a[88:91], a[32:35], v[224:227]
    ds_read_b64_tr_b16 a[86:87], v13 offset:2048
    v_mfma_f32_16x16x32_bf16 v[232:235], a[88:91], a[36:39], v[232:235]
    v_mfma_f32_16x16x32_bf16 v[240:243], a[88:91], a[40:43], v[240:243]
    buffer_store_dwordx4 a[148:151], v2, s[24:27], s28 offen sc1
    v_mfma_f32_16x16x32_bf16 v[248:251], a[88:91], a[44:47], v[248:251]
    s_add_u32 s28, s28, s31
    v_mfma_f32_16x16x32_bf16 a[96:99], a[88:91], a[48:51], a[96:99]
    v_mfma_f32_16x16x32_bf16 a[104:107], a[88:91], a[52:55], a[104:107]
    v_mfma_f32_16x16x32_bf16 a[112:115], a[88:91], a[56:59], a[112:115]
    buffer_store_dwordx4 a[152:155], v2, s[24:27], s28 offen sc1
    v_mfma_f32_16x16x32_bf16 a[120:123], a[88:91], a[60:63], a[120:123]
    s_add_u32 s28, s28, s31
    ds_read_b64_tr_b16 a[88:89], v14 offset:0
    v_mfma_f32_16x16x32_bf16 v[228:231], a[92:95], a[32:35], v[228:231]
    ds_read_b64_tr_b16 a[90:91], v14 offset:2048
    v_mfma_f32_16x16x32_bf16 v[236:239], a[92:95], a[36:39], v[236:239]
    v_mfma_f32_16x16x32_bf16 v[244:247], a[92:95], a[40:43], v[244:247]
    buffer_store_dwordx4 a[156:159], v2, s[24:27], s28 offen sc1
    v_mfma_f32_16x16x32_bf16 v[252:255], a[92:95], a[44:47], v[252:255]
    s_add_u32 s29, s29, s30
    s_mov_b32 s28, s29
    v_mfma_f32_16x16x32_bf16 a[100:103], a[92:95], a[48:51], a[100:103]
    s_sub_u32 s65, s65, 1
    v_mfma_f32_16x16x32_bf16 a[108:111], a[92:95], a[52:55], a[108:111]
    v_mfma_f32_16x16x32_bf16 a[116:119], a[92:95], a[56:59], a[116:119]
    v_mfma_f32_16x16x32_bf16 a[124:127], a[92:95], a[60:63], a[124:127]
    ds_read_b64_tr_b16 a[92:93], v15 offset:0
    ds_read_b64_tr_b16 a[94:95], v15 offset:2048
    s_waitcnt lgkmcnt(15)
    v_mfma_f32_16x16x32_bf16 v[32:35], a[64:67], a[0:3], v[32:35]
    v_mfma_f32_16x16x32_bf16 v[40:43], a[64:67], a[4:7], v[40:43]
    v_mfma_f32_16x16x32_bf16 v[48:51], a[64:67], a[8:11], v[48:51]
    v_mfma_f32_16x16x32_bf16 v[56:59], a[64:67], a[12:15], v[56:59]
    s_add_u32 m0, s61, 0
    s_waitcnt lgkmcnt(13)
    v_mfma_f32_16x16x32_bf16 v[64:67], a[64:67], a[16:19], v[64:67]
    buffer_load_dwordx4 v16, s[40:43], s48 offen offset:0 lds
    s_waitcnt lgkmcnt(12)
    v_mfma_f32_16x16x32_bf16 v[72:75], a[64:67], a[20:23], v[72:75]
    s_waitcnt lgkmcnt(9)
    v_mfma_f32_16x16x32_bf16 v[80:83], a[64:67], a[24:27], v[80:83]
    s_waitcnt lgkmcnt(8)
    v_mfma_f32_16x16x32_bf16 v[88:91], a[64:67], a[28:31], v[88:91]
    ds_read_b64_tr_b16 a[64:65], v8 offset:16384
    v_mfma_f32_16x16x32_bf16 v[36:39], a[68:71], a[0:3], v[36:39]
    ds_read_b64_tr_b16 a[66:67], v8 offset:18432
    v_mfma_f32_16x16x32_bf16 v[44:47], a[68:71], a[4:7], v[44:47]
    v_mfma_f32_16x16x32_bf16 v[52:55], a[68:71], a[8:11], v[52:55]
    ds_read_b128 a[32:35], v7 offset:0
    v_mfma_f32_16x16x32_bf16 v[60:63], a[68:71], a[12:15], v[60:63]
    v_mfma_f32_16x16x32_bf16 v[68:71], a[68:71], a[16:19], v[68:71]
    buffer_load_dwordx4 v17, s[40:43], s48 offen offset:1024 lds
    v_mfma_f32_16x16x32_bf16 v[76:79], a[68:71], a[20:23], v[76:79]
    s_add_u32 s48, s48, 128
    v_mfma_f32_16x16x32_bf16 v[84:87], a[68:71], a[24:27], v[84:87]
    ds_read_b128 a[36:39], v7 offset:2048
    v_mfma_f32_16x16x32_bf16 v[92:95], a[68:71], a[28:31], v[92:95]
    ds_read_b64_tr_b16 a[68:69], v9 offset:16384
    v_mfma_f32_16x16x32_bf16 v[96:99], a[72:75], a[0:3], v[96:99]
    ds_read_b64_tr_b16 a[70:71], v9 offset:18432
    v_mfma_f32_16x16x32_bf16 v[104:107], a[72:75], a[4:7], v[104:107]
    v_mfma_f32_16x16x32_bf16 v[112:115], a[72:75], a[8:11], v[112:115]
    ds_read_b128 a[40:43], v7 offset:4096
    v_mfma_f32_16x16x32_bf16 v[120:123], a[72:75], a[12:15], v[120:123]
    v_mfma_f32_16x16x32_bf16 v[128:131], a[72:75], a[16:19], v[128:131]
    buffer_load_dwordx4 v16, s[40:43], s49 offen offset:2048 lds
    v_mfma_f32_16x16x32_bf16 v[136:139], a[72:75], a[20:23], v[136:139]
    v_mfma_f32_16x16x32_bf16 v[144:147], a[72:75], a[24:27], v[144:147]
    ds_read_b128 a[44:47], v7 offset:6144
    v_mfma_f32_16x16x32_bf16 v[152:155], a[72:75], a[28:31], v[152:155]
    ds_read_b64_tr_b16 a[72:73], v10 offset:16384
    v_mfma_f32_16x16x32_bf16 v[100:103], a[76:79], a[0:3], v[100:103]
    ds_read_b64_tr_b16 a[74:75], v10 offset:18432
    v_mfma_f32_16x16x32_bf16 v[108:111], a[76:79], a[4:7], v[108:111]
    v_mfma_f32_16x16x32_bf16 v[116:119], a[76:79], a[8:11], v[116:119]
    ds_read_b128 a[48:51], v7 offset:8192
    v_mfma_f32_16x16x32_bf16 v[124:127], a[76:79], a[12:15], v[124:127]
    v_mfma_f32_16x16x32_bf16 v[132:135], a[76:79], a[16:19], v[132:135]
    buffer_load_dwordx4 v17, s[40:43], s49 offen offset:3072 lds
    v_mfma_f32_16x16x32_bf16 v[140:143], a[76:79], a[20:23], v[140:143]
    s_add_u32 s49, s49, 128
    v_mfma_f32_16x16x32_bf16 v[148:151], a[76:79], a[24:27], v[148:151]
    ds_read_b128 a[52:55], v7 offset:10240
    v_mfma_f32_16x16x32_bf16 v[156:159], a[76:79], a[28:31], v[156:159]
    ds_read_b64_tr_b16 a[76:77], v11 offset:16384
    s_waitcnt lgkmcnt(15)
    v_mfma_f32_16x16x32_bf16 v[160:163], a[80:83], a[0:3], v[160:163]
    ds_read_b64_tr_b16 a[78:79], v11 offset:18432
    v_mfma_f32_16x16x32_bf16 v[168:171], a[80:83], a[4:7], v[168:171]
    v_mfma_f32_16x16x32_bf16 v[176:179], a[80:83], a[8:11], v[176:179]
    ds_read_b128 a[56:59], v7 offset:12288
    v_mfma_f32_16x16x32_bf16 v[184:187], a[80:83], a[12:15], v[184:187]
    s_add_u32 m0, s61, 4096
    v_mfma_f32_16x16x32_bf16 v[192:195], a[80:83], a[16:19], v[192:195]
    buffer_load_dwordx4 v16, s[40:43], s50 offen offset:0 lds
    v_mfma_f32_16x16x32_bf16 v[200:203], a[80:83], a[20:23], v[200:203]
    v_mfma_f32_16x16x32_bf16 v[208:211], a[80:83], a[24:27], v[208:211]
    s_add_u32 s61, s61, 32768
    ds_read_b128 a[60:63], v7 offset:14336
    v_mfma_f32_16x16x32_bf16 v[216:219], a[80:83], a[28:31], v[216:219]
    s_cmp_ge_u32 s61, 98304
    s_cselect_b32 s90, 98304, 0
    ds_read_b64_tr_b16 a[80:81], v12 offset:16384
    v_mfma_f32_16x16x32_bf16 v[164:167], a[84:87], a[0:3], v[164:167]
    s_sub_u32 s61, s61, s90
    ds_read_b64_tr_b16 a[82:83], v12 offset:18432
    v_mfma_f32_16x16x32_bf16 v[172:175], a[84:87], a[4:7], v[172:175]
    s_add_u32 s64, s64, 32768
    v_mfma_f32_16x16x32_bf16 v[180:183], a[84:87], a[8:11], v[180:183]
    buffer_store_dwordx4 a[160:163], v2, s[24:27], s28 offen sc1
    v_mfma_f32_16x16x32_bf16 v[188:191], a[84:87], a[12:15], v[188:191]
    s_add_u32 s28, s28, s31
    v_mfma_f32_16x16x32_bf16 v[196:199], a[84:87], a[16:19], v[196:199]
    buffer_load_dwordx4 v17, s[40:43], s50 offen offset:1024 lds
    v_mfma_f32_16x16x32_bf16 v[204:207], a[84:87], a[20:23], v[204:207]
    s_add_u32 s50, s50, 128
    v_mfma_f32_16x16x32_bf16 v[212:215], a[84:87], a[24:27], v[212:215]
    s_cmp_ge_u32 s64, 98304
    s_cselect_b32 s63, 4294901760, s59
    s_cselect_b32 s64, 0, s64
    v_mfma_f32_16x16x32_bf16 v[220:223], a[84:87], a[28:31], v[220:223]
    ds_read_b64_tr_b16 a[84:85], v13 offset:16384
    v_mfma_f32_16x16x32_bf16 v[224:227], a[88:91], a[0:3], v[224:227]
    ds_read_b64_tr_b16 a[86:87], v13 offset:18432
    v_mfma_f32_16x16x32_bf16 v[232:235], a[88:91], a[4:7], v[232:235]
    v_mfma_f32_16x16x32_bf16 v[240:243], a[88:91], a[8:11], v[240:243]
    buffer_store_dwordx4 a[164:167], v2, s[24:27], s28 offen sc1
    v_mfma_f32_16x16x32_bf16 v[248:251], a[88:91], a[12:15], v[248:251]
    s_add_u32 s28, s28, s31
    v_mfma_f32_16x16x32_bf16 a[96:99], a[88:91], a[16:19], a[96:99]
    buffer_load_dwordx4 v16, s[40:43], s51 offen offset:2048 lds
    v_mfma_f32_16x16x32_bf16 a[104:107], a[88:91], a[20:23], a[104:107]
    v_mfma_f32_16x16x32_bf16 a[112:115], a[88:91], a[24:27], a[112:115]
    v_mfma_f32_16x16x32_bf16 a[120:123], a[88:91], a[28:31], a[120:123]
    ds_read_b64_tr_b16 a[88:89], v14 offset:16384
    s_waitcnt lgkmcnt(15)
    v_mfma_f32_16x16x32_bf16 v[228:231], a[92:95], a[0:3], v[228:231]
    ds_read_b64_tr_b16 a[90:91], v14 offset:18432
    v_mfma_f32_16x16x32_bf16 v[236:239], a[92:95], a[4:7], v[236:239]
    v_add_u32 v6, s63, v6
    v_add_u32 v7, s63, v7
    v_mfma_f32_16x16x32_bf16 v[244:247], a[92:95], a[8:11], v[244:247]
    buffer_store_dwordx4 a[168:171], v2, s[24:27], s28 offen sc1
    v_mfma_f32_16x16x32_bf16 v[252:255], a[92:95], a[12:15], v[252:255]
    s_add_u32 s28, s28, s31
    v_mfma_f32_16x16x32_bf16 a[100:103], a[92:95], a[16:19], a[100:103]
    buffer_load_dwordx4 v17, s[40:43], s51 offen offset:3072 lds
    v_mfma_f32_16x16x32_bf16 a[108:111], a[92:95], a[20:23], a[108:111]
    s_add_u32 s51, s51, 128
    v_mfma_f32_16x16x32_bf16 a[116:119], a[92:95], a[24:27], a[116:119]
    v_mfma_f32_16x16x32_bf16 a[124:127], a[92:95], a[28:31], a[124:127]
    ds_read_b64_tr_b16 a[92:93], v15 offset:16384
    ds_read_b64_tr_b16 a[94:95], v15 offset:18432
    v_mfma_f32_16x16x32_bf16 v[32:35], a[64:67], a[32:35], v[32:35]
    v_xor_b32 v8, s60, v8
    v_xor_b32 v9, s60, v9
    v_mfma_f32_16x16x32_bf16 v[40:43], a[64:67], a[36:39], v[40:43]
    v_xor_b32 v10, s60, v10
    v_xor_b32 v11, s60, v11
    s_waitcnt lgkmcnt(15)
    v_mfma_f32_16x16x32_bf16 v[48:51], a[64:67], a[40:43], v[48:51]
    v_xor_b32 v12, s60, v12
    v_xor_b32 v13, s60, v13
    v_mfma_f32_16x16x32_bf16 v[56:59], a[64:67], a[44:47], v[56:59]
    v_xor_b32 v14, s60, v14
    v_xor_b32 v15, s60, v15
    s_waitcnt lgkmcnt(13)
    v_mfma_f32_16x16x32_bf16 v[64:67], a[64:67], a[48:51], v[64:67]
    s_waitcnt lgkmcnt(12)
    v_mfma_f32_16x16x32_bf16 v[72:75], a[64:67], a[52:55], v[72:75]
    s_waitcnt lgkmcnt(9)
    v_mfma_f32_16x16x32_bf16 v[80:83], a[64:67], a[56:59], v[80:83]
    s_waitcnt vmcnt(16) lgkmcnt(0)
    v_mfma_f32_16x16x32_bf16 v[88:91], a[64:67], a[60:63], v[88:91]
    s_barrier
    ds_read_b64_tr_b16 a[64:65], v8 offset:0
    v_mfma_f32_16x16x32_bf16 v[36:39], a[68:71], a[32:35], v[36:39]
    s_add_u32 m0, s62, 0
    ds_read_b64_tr_b16 a[66:67], v8 offset:2048
    v_mfma_f32_16x16x32_bf16 v[44:47], a[68:71], a[36:39], v[44:47]
    buffer_load_dwordx4 v18, s[44:47], s52 offen offset:0 lds
    v_mfma_f32_16x16x32_bf16 v[52:55], a[68:71], a[40:43], v[52:55]
    ds_read_b128 a[0:3], v6 offset:0
    v_mfma_f32_16x16x32_bf16 v[60:63], a[68:71], a[44:47], v[60:63]
    v_mfma_f32_16x16x32_bf16 v[68:71], a[68:71], a[48:51], v[68:71]
    v_mfma_f32_16x16x32_bf16 v[76:79], a[68:71], a[52:55], v[76:79]
    buffer_load_dwordx4 v19, s[44:47], s52 offen offset:1024 lds
    v_mfma_f32_16x16x32_bf16 v[84:87], a[68:71], a[56:59], v[84:87]
    s_add_u32 s52, s52, s56
    ds_read_b128 a[4:7], v6 offset:2048
    v_mfma_f32_16x16x32_bf16 v[92:95], a[68:71], a[60:63], v[92:95]
    ds_read_b64_tr_b16 a[68:69], v9 offset:0
    v_mfma_f32_16x16x32_bf16 v[96:99], a[72:75], a[32:35], v[96:99]
    ds_read_b64_tr_b16 a[70:71], v9 offset:2048
    v_mfma_f32_16x16x32_bf16 v[104:107], a[72:75], a[36:39], v[104:107]
    buffer_load_dwordx4 v18, s[44:47], s53 offen offset:2048 lds
    v_mfma_f32_16x16x32_bf16 v[112:115], a[72:75], a[40:43], v[112:115]
    ds_read_b128 a[8:11], v6 offset:4096
    v_mfma_f32_16x16x32_bf16 v[120:123], a[72:75], a[44:47], v[120:123]
    v_mfma_f32_16x16x32_bf16 v[128:131], a[72:75], a[48:51], v[128:131]
    v_mfma_f32_16x16x32_bf16 v[136:139], a[72:75], a[52:55], v[136:139]
    buffer_load_dwordx4 v19, s[44:47], s53 offen offset:3072 lds
    v_mfma_f32_16x16x32_bf16 v[144:147], a[72:75], a[56:59], v[144:147]
    s_add_u32 s53, s53, s56
    ds_read_b128 a[12:15], v6 offset:6144
    v_mfma_f32_16x16x32_bf16 v[152:155], a[72:75], a[60:63], v[152:155]
    ds_read_b64_tr_b16 a[72:73], v10 offset:0
    v_mfma_f32_16x16x32_bf16 v[100:103], a[76:79], a[32:35], v[100:103]
    s_add_u32 m0, s62, 4096
    ds_read_b64_tr_b16 a[74:75], v10 offset:2048
    v_mfma_f32_16x16x32_bf16 v[108:111], a[76:79], a[36:39], v[108:111]
    buffer_load_dwordx4 v20, s[44:47], s54 offen offset:0 lds
    v_mfma_f32_16x16x32_bf16 v[116:119], a[76:79], a[40:43], v[116:119]
    ds_read_b128 a[16:19], v6 offset:8192
    v_mfma_f32_16x16x32_bf16 v[124:127], a[76:79], a[44:47], v[124:127]
    s_xor_b32 s62, s62, 229376
    v_mfma_f32_16x16x32_bf16 v[132:135], a[76:79], a[48:51], v[132:135]
    v_mfma_f32_16x16x32_bf16 v[140:143], a[76:79], a[52:55], v[140:143]
    buffer_load_dwordx4 v21, s[44:47], s54 offen offset:1024 lds
    v_mfma_f32_16x16x32_bf16 v[148:151], a[76:79], a[56:59], v[148:151]
    s_add_u32 s54, s54, s56
    ds_read_b128 a[20:23], v6 offset:10240
    v_mfma_f32_16x16x32_bf16 v[156:159], a[76:79], a[60:63], v[156:159]
    ds_read_b64_tr_b16 a[76:77], v11 offset:0
    v_mfma_f32_16x16x32_bf16 v[160:163], a[80:83], a[32:35], v[160:163]
    ds_read_b64_tr_b16 a[78:79], v11 offset:2048
    v_mfma_f32_16x16x32_bf16 v[168:171], a[80:83], a[36:39], v[168:171]
    buffer_load_dwordx4 v20, s[44:47], s55 offen offset:2048 lds
    v_mfma_f32_16x16x32_bf16 v[176:179], a[80:83], a[40:43], v[176:179]
    ds_read_b128 a[24:27], v6 offset:12288
    v_mfma_f32_16x16x32_bf16 v[184:187], a[80:83], a[44:47], v[184:187]
    v_mfma_f32_16x16x32_bf16 v[192:195], a[80:83], a[48:51], v[192:195]
    v_mfma_f32_16x16x32_bf16 v[200:203], a[80:83], a[52:55], v[200:203]
    buffer_load_dwordx4 v21, s[44:47], s55 offen offset:3072 lds
    v_mfma_f32_16x16x32_bf16 v[208:211], a[80:83], a[56:59], v[208:211]
    s_add_u32 s55, s55, s56
    ds_read_b128 a[28:31], v6 offset:14336
    v_mfma_f32_16x16x32_bf16 v[216:219], a[80:83], a[60:63], v[216:219]
    ds_read_b64_tr_b16 a[80:81], v12 offset:0
    v_mfma_f32_16x16x32_bf16 v[164:167], a[84:87], a[32:35], v[164:167]
    ds_read_b64_tr_b16 a[82:83], v12 offset:2048
    v_mfma_f32_16x16x32_bf16 v[172:175], a[84:87], a[36:39], v[172:175]
    v_mfma_f32_16x16x32_bf16 v[180:183], a[84:87], a[40:43], v[180:183]
    buffer_store_dwordx4 a[172:175], v2, s[24:27], s28 offen sc1
    v_mfma_f32_16x16x32_bf16 v[188:191], a[84:87], a[44:47], v[188:191]
    s_add_u32 s28, s28, s31
    v_mfma_f32_16x16x32_bf16 v[196:199], a[84:87], a[48:51], v[196:199]
    v_mfma_f32_16x16x32_bf16 v[204:207], a[84:87], a[52:55], v[204:207]
    v_mfma_f32_16x16x32_bf16 v[212:215], a[84:87], a[56:59], v[212:215]
    buffer_store_dwordx4 a[176:179], v2, s[24:27], s28 offen sc1
    v_mfma_f32_16x16x32_bf16 v[220:223], a[84:87], a[60:63], v[220:223]
    s_add_u32 s28, s28, s31
    ds_read_b64_tr_b16 a[84:85], v13 offset:0
    v_mfma_f32_16x16x32_bf16 v[224:227], a[88:91], a[32:35], v[224:227]
    ds_read_b64_tr_b16 a[86:87], v13 offset:2048
    v_mfma_f32_16x16x32_bf16 v[232:235], a[88:91], a[36:39], v[232:235]
    v_mfma_f32_16x16x32_bf16 v[240:243], a[88:91], a[40:43], v[240:243]
    buffer_store_dwordx4 a[180:183], v2, s[24:27], s28 offen sc1
    v_mfma_f32_16x16x32_bf16 v[248:251], a[88:91], a[44:47], v[248:251]
    s_add_u32 s28, s28, s31
    v_mfma_f32_16x16x32_bf16 a[96:99], a[88:91], a[48:51], a[96:99]
    v_mfma_f32_16x16x32_bf16 a[104:107], a[88:91], a[52:55], a[104:107]
    v_mfma_f32_16x16x32_bf16 a[112:115], a[88:91], a[56:59], a[112:115]
    buffer_store_dwordx4 a[184:187], v2, s[24:27], s28 offen sc1
    v_mfma_f32_16x16x32_bf16 a[120:123], a[88:91], a[60:63], a[120:123]
    s_add_u32 s28, s28, s31
    ds_read_b64_tr_b16 a[88:89], v14 offset:0
    v_mfma_f32_16x16x32_bf16 v[228:231], a[92:95], a[32:35], v[228:231]
    ds_read_b64_tr_b16 a[90:91], v14 offset:2048
    v_mfma_f32_16x16x32_bf16 v[236:239], a[92:95], a[36:39], v[236:239]
    v_mfma_f32_16x16x32_bf16 v[244:247], a[92:95], a[40:43], v[244:247]
    buffer_store_dwordx4 a[188:191], v2, s[24:27], s28 offen sc1
    v_mfma_f32_16x16x32_bf16 v[252:255], a[92:95], a[44:47], v[252:255]
    s_add_u32 s29, s29, s30
    s_mov_b32 s28, s29
    v_mfma_f32_16x16x32_bf16 a[100:103], a[92:95], a[48:51], a[100:103]
    s_sub_u32 s65, s65, 1
    v_mfma_f32_16x16x32_bf16 a[108:111], a[92:95], a[52:55], a[108:111]
    v_mfma_f32_16x16x32_bf16 a[116:119], a[92:95], a[56:59], a[116:119]
    v_mfma_f32_16x16x32_bf16 a[124:127], a[92:95], a[60:63], a[124:127]
    ds_read_b64_tr_b16 a[92:93], v15 offset:0
    ds_read_b64_tr_b16 a[94:95], v15 offset:2048
    s_cmp_eq_u32 s66, 2
    s_cbranch_scc1 mega_kernel_hook13
mega_kernel_hookr14:
    s_waitcnt lgkmcnt(15)
    v_mfma_f32_16x16x32_bf16 v[32:35], a[64:67], a[0:3], v[32:35]
    v_mfma_f32_16x16x32_bf16 v[40:43], a[64:67], a[4:7], v[40:43]
    v_mfma_f32_16x16x32_bf16 v[48:51], a[64:67], a[8:11], v[48:51]
    v_mfma_f32_16x16x32_bf16 v[56:59], a[64:67], a[12:15], v[56:59]
    s_add_u32 m0, s61, 0
    s_waitcnt lgkmcnt(13)
    v_mfma_f32_16x16x32_bf16 v[64:67], a[64:67], a[16:19], v[64:67]
    buffer_load_dwordx4 v16, s[40:43], s48 offen offset:0 lds
    s_waitcnt lgkmcnt(12)
    v_mfma_f32_16x16x32_bf16 v[72:75], a[64:67], a[20:23], v[72:75]
    s_waitcnt lgkmcnt(9)
    v_mfma_f32_16x16x32_bf16 v[80:83], a[64:67], a[24:27], v[80:83]
    s_waitcnt lgkmcnt(8)
    v_mfma_f32_16x16x32_bf16 v[88:91], a[64:67], a[28:31], v[88:91]
    ds_read_b64_tr_b16 a[64:65], v8 offset:16384
    v_mfma_f32_16x16x32_bf16 v[36:39], a[68:71], a[0:3], v[36:39]
    ds_read_b64_tr_b16 a[66:67], v8 offset:18432
    v_mfma_f32_16x16x32_bf16 v[44:47], a[68:71], a[4:7], v[44:47]
    v_mfma_f32_16x16x32_bf16 v[52:55], a[68:71], a[8:11], v[52:55]
    ds_read_b128 a[32:35], v7 offset:0
    v_mfma_f32_16x16x32_bf16 v[60:63], a[68:71], a[12:15], v[60:63]
    v_mfma_f32_16x16x32_bf16 v[68:71], a[68:71], a[16:19], v[68:71]
    buffer_load_dwordx4 v17, s[40:43], s48 offen offset:1024 lds
    v_mfma_f32_16x16x32_bf16 v[76:79], a[68:71], a[20:23], v[76:79]
    s_add_u32 s48, s48, 128
    v_mfma_f32_16x16x32_bf16 v[84:87], a[68:71], a[24:27], v[84:87]
    ds_read_b128 a[36:39], v7 offset:2048
    v_mfma_f32_16x16x32_bf16 v[92:95], a[68:71], a[28:31], v[92:95]
    ds_read_b64_tr_b16 a[68:69], v9 offset:16384
    v_mfma_f32_16x16x32_bf16 v[96:99], a[72:75], a[0:3], v[96:99]
    ds_read_b64_tr_b16 a[70:71], v9 offset:18432
    v_mfma_f32_16x16x32_bf16 v[104:107], a[72:75], a[4:7], v[104:107]
    v_mfma_f32_16x16x32_bf16 v[112:115], a[72:75], a[8:11], v[112:115]
    ds_read_b128 a[40:43], v7 offset:4096
    v_mfma_f32_16x16x32_bf16 v[120:123], a[72:75], a[12:15], v[120:123]
    v_mfma_f32_16x16x32_bf16 v[128:131], a[72:75], a[16:19], v[128:131]
    buffer_load_dwordx4 v16, s[40:43], s49 offen offset:2048 lds
    v_mfma_f32_16x16x32_bf16 v[136:139], a[72:75], a[20:23], v[136:139]
    v_mfma_f32_16x16x32_bf16 v[144:147], a[72:75], a[24:27], v[144:147]
    ds_read_b128 a[44:47], v7 offset:6144
    v_mfma_f32_16x16x32_bf16 v[152:155], a[72:75], a[28:31], v[152:155]
    ds_read_b64_tr_b16 a[72:73], v10 offset:16384
    v_mfma_f32_16x16x32_bf16 v[100:103], a[76:79], a[0:3], v[100:103]
    ds_read_b64_tr_b16 a[74:75], v10 offset:18432
    v_mfma_f32_16x16x32_bf16 v[108:111], a[76:79], a[4:7], v[108:111]
    v_mfma_f32_16x16x32_bf16 v[116:119], a[76:79], a[8:11], v[116:119]
    ds_read_b128 a[48:51], v7 offset:8192
    v_mfma_f32_16x16x32_bf16 v[124:127], a[76:79], a[12:15], v[124:127]
    v_mfma_f32_16x16x32_bf16 v[132:135], a[76:79], a[16:19], v[132:135]
    buffer_load_dwordx4 v17, s[40:43], s49 offen offset:3072 lds
    v_mfma_f32_16x16x32_bf16 v[140:143], a[76:79], a[20:23], v[140:143]
    s_add_u32 s49, s49, 128
    v_mfma_f32_16x16x32_bf16 v[148:151], a[76:79], a[24:27], v[148:151]
    ds_read_b128 a[52:55], v7 offset:10240
    v_mfma_f32_16x16x32_bf16 v[156:159], a[76:79], a[28:31], v[156:159]
    ds_read_b64_tr_b16 a[76:77], v11 offset:16384
    s_waitcnt lgkmcnt(15)
    v_mfma_f32_16x16x32_bf16 v[160:163], a[80:83], a[0:3], v[160:163]
    ds_read_b64_tr_b16 a[78:79], v11 offset:18432
    v_mfma_f32_16x16x32_bf16 v[168:171], a[80:83], a[4:7], v[168:171]
    v_mfma_f32_16x16x32_bf16 v[176:179], a[80:83], a[8:11], v[176:179]
    ds_read_b128 a[56:59], v7 offset:12288
    v_mfma_f32_16x16x32_bf16 v[184:187], a[80:83], a[12:15], v[184:187]
    s_add_u32 m0, s61, 4096
    v_mfma_f32_16x16x32_bf16 v[192:195], a[80:83], a[16:19], v[192:195]
    buffer_load_dwordx4 v16, s[40:43], s50 offen offset:0 lds
    v_mfma_f32_16x16x32_bf16 v[200:203], a[80:83], a[20:23], v[200:203]
    v_mfma_f32_16x16x32_bf16 v[208:211], a[80:83], a[24:27], v[208:211]
    s_add_u32 s61, s61, 32768
    ds_read_b128 a[60:63], v7 offset:14336
    v_mfma_f32_16x16x32_bf16 v[216:219], a[80:83], a[28:31], v[216:219]
    s_cmp_ge_u32 s61, 98304
    s_cselect_b32 s90, 98304, 0
    ds_read_b64_tr_b16 a[80:81], v12 offset:16384
    v_mfma_f32_16x16x32_bf16 v[164:167], a[84:87], a[0:3], v[164:167]
    s_sub_u32 s61, s61, s90
    ds_read_b64_tr_b16 a[82:83], v12 offset:18432
    v_mfma_f32_16x16x32_bf16 v[172:175], a[84:87], a[4:7], v[172:175]
    s_add_u32 s64, s64, 32768
    v_mfma_f32_16x16x32_bf16 v[180:183], a[84:87], a[8:11], v[180:183]
    buffer_store_dwordx4 a[192:195], v2, s[24:27], s28 offen sc1
    v_mfma_f32_16x16x32_bf16 v[188:191], a[84:87], a[12:15], v[188:191]
    s_add_u32 s28, s28, s31
    v_mfma_f32_16x16x32_bf16 v[196:199], a[84:87], a[16:19], v[196:199]
    buffer_load_dwordx4 v17, s[40:43], s50 offen offset:1024 lds
    v_mfma_f32_16x16x32_bf16 v[204:207], a[84:87], a[20:23], v[204:207]
    s_add_u32 s50, s50, 128
    v_mfma_f32_16x16x32_bf16 v[212:215], a[84:87], a[24:27], v[212:215]
    s_cmp_ge_u32 s64, 98304
    s_cselect_b32 s63, 4294901760, s59
    s_cselect_b32 s64, 0, s64
    v_mfma_f32_16x16x32_bf16 v[220:223], a[84:87], a[28:31], v[220:223]
    ds_read_b64_tr_b16 a[84:85], v13 offset:16384
    v_mfma_f32_16x16x32_bf16 v[224:227], a[88:91], a[0:3], v[224:227]
    ds_read_b64_tr_b16 a[86:87], v13 offset:18432
    v_mfma_f32_16x16x32_bf16 v[232:235], a[88:91], a[4:7], v[232:235]
    v_mfma_f32_16x16x32_bf16 v[240:243], a[88:91], a[8:11], v[240:243]
    buffer_store_dwordx4 a[196:199], v2, s[24:27], s28 offen sc1
    v_mfma_f32_16x16x32_bf16 v[248:251], a[88:91], a[12:15], v[248:251]
    s_add_u32 s28, s28, s31
    v_mfma_f32_16x16x32_bf16 a[96:99], a[88:91], a[16:19], a[96:99]
    buffer_load_dwordx4 v16, s[40:43], s51 offen offset:2048 lds
    v_mfma_f32_16x16x32_bf16 a[104:107], a[88:91], a[20:23], a[104:107]
    v_mfma_f32_16x16x32_bf16 a[112:115], a[88:91], a[24:27], a[112:115]
    v_mfma_f32_16x16x32_bf16 a[120:123], a[88:91], a[28:31], a[120:123]
    ds_read_b64_tr_b16 a[88:89], v14 offset:16384
    s_waitcnt lgkmcnt(15)
    v_mfma_f32_16x16x32_bf16 v[228:231], a[92:95], a[0:3], v[228:231]
    ds_read_b64_tr_b16 a[90:91], v14 offset:18432
    v_mfma_f32_16x16x32_bf16 v[236:239], a[92:95], a[4:7], v[236:239]
    v_add_u32 v6, s63, v6
    v_add_u32 v7, s63, v7
    v_mfma_f32_16x16x32_bf16 v[244:247], a[92:95], a[8:11], v[244:247]
    buffer_store_dwordx4 a[200:203], v2, s[24:27], s28 offen sc1
    v_mfma_f32_16x16x32_bf16 v[252:255], a[92:95], a[12:15], v[252:255]
    s_add_u32 s28, s28, s31
    v_mfma_f32_16x16x32_bf16 a[100:103], a[92:95], a[16:19], a[100:103]
    buffer_load_dwordx4 v17, s[40:43], s51 offen offset:3072 lds
    v_mfma_f32_16x16x32_bf16 a[108:111], a[92:95], a[20:23], a[108:111]
    s_add_u32 s51, s51, 128
    v_mfma_f32_16x16x32_bf16 a[116:119], a[92:95], a[24:27], a[116:119]
    v_mfma_f32_16x16x32_bf16 a[124:127], a[92:95], a[28:31], a[124:127]
    ds_read_b64_tr_b16 a[92:93], v15 offset:16384
    ds_read_b64_tr_b16 a[94:95], v15 offset:18432
    v_mfma_f32_16x16x32_bf16 v[32:35], a[64:67], a[32:35], v[32:35]
    v_xor_b32 v8, s60, v8
    v_xor_b32 v9, s60, v9
    v_mfma_f32_16x16x32_bf16 v[40:43], a[64:67], a[36:39], v[40:43]
    v_xor_b32 v10, s60, v10
    v_xor_b32 v11, s60, v11
    s_waitcnt lgkmcnt(15)
    v_mfma_f32_16x16x32_bf16 v[48:51], a[64:67], a[40:43], v[48:51]
    v_xor_b32 v12, s60, v12
    v_xor_b32 v13, s60, v13
    v_mfma_f32_16x16x32_bf16 v[56:59], a[64:67], a[44:47], v[56:59]
    v_xor_b32 v14, s60, v14
    v_xor_b32 v15, s60, v15
    s_waitcnt lgkmcnt(13)
    v_mfma_f32_16x16x32_bf16 v[64:67], a[64:67], a[48:51], v[64:67]
    s_waitcnt lgkmcnt(12)
    v_mfma_f32_16x16x32_bf16 v[72:75], a[64:67], a[52:55], v[72:75]
    s_waitcnt lgkmcnt(9)
    v_mfma_f32_16x16x32_bf16 v[80:83], a[64:67], a[56:59], v[80:83]
    s_waitcnt vmcnt(16) lgkmcnt(0)
    v_mfma_f32_16x16x32_bf16 v[88:91], a[64:67], a[60:63], v[88:91]
    s_barrier
    ds_read_b64_tr_b16 a[64:65], v8 offset:0
    v_mfma_f32_16x16x32_bf16 v[36:39], a[68:71], a[32:35], v[36:39]
    s_add_u32 m0, s62, 0
    ds_read_b64_tr_b16 a[66:67], v8 offset:2048
    v_mfma_f32_16x16x32_bf16 v[44:47], a[68:71], a[36:39], v[44:47]
    buffer_load_dwordx4 v18, s[44:47], s52 offen offset:0 lds
    v_mfma_f32_16x16x32_bf16 v[52:55], a[68:71], a[40:43], v[52:55]
    ds_read_b128 a[0:3], v6 offset:0
    v_mfma_f32_16x16x32_bf16 v[60:63], a[68:71], a[44:47], v[60:63]
    v_mfma_f32_16x16x32_bf16 v[68:71], a[68:71], a[48:51], v[68:71]
    v_mfma_f32_16x16x32_bf16 v[76:79], a[68:71], a[52:55], v[76:79]
    buffer_load_dwordx4 v19, s[44:47], s52 offen offset:1024 lds
    v_mfma_f32_16x16x32_bf16 v[84:87], a[68:71], a[56:59], v[84:87]
    s_add_u32 s52, s52, s56
    ds_read_b128 a[4:7], v6 offset:2048
    v_mfma_f32_16x16x32_bf16 v[92:95], a[68:71], a[60:63], v[92:95]
    ds_read_b64_tr_b16 a[68:69], v9 offset:0
    v_mfma_f32_16x16x32_bf16 v[96:99], a[72:75], a[32:35], v[96:99]
    ds_read_b64_tr_b16 a[70:71], v9 offset:2048
    v_mfma_f32_16x16x32_bf16 v[104:107], a[72:75], a[36:39], v[104:107]
    buffer_load_dwordx4 v18, s[44:47], s53 offen offset:2048 lds
    v_mfma_f32_16x16x32_bf16 v[112:115], a[72:75], a[40:43], v[112:115]
    ds_read_b128 a[8:11], v6 offset:4096
    v_mfma_f32_16x16x32_bf16 v[120:123], a[72:75], a[44:47], v[120:123]
    v_mfma_f32_16x16x32_bf16 v[128:131], a[72:75], a[48:51], v[128:131]
    v_mfma_f32_16x16x32_bf16 v[136:139], a[72:75], a[52:55], v[136:139]
    buffer_load_dwordx4 v19, s[44:47], s53 offen offset:3072 lds
    v_mfma_f32_16x16x32_bf16 v[144:147], a[72:75], a[56:59], v[144:147]
    s_add_u32 s53, s53, s56
    ds_read_b128 a[12:15], v6 offset:6144
    v_mfma_f32_16x16x32_bf16 v[152:155], a[72:75], a[60:63], v[152:155]
    ds_read_b64_tr_b16 a[72:73], v10 offset:0
    v_mfma_f32_16x16x32_bf16 v[100:103], a[76:79], a[32:35], v[100:103]
    s_add_u32 m0, s62, 4096
    ds_read_b64_tr_b16 a[74:75], v10 offset:2048
    v_mfma_f32_16x16x32_bf16 v[108:111], a[76:79], a[36:39], v[108:111]
    buffer_load_dwordx4 v20, s[44:47], s54 offen offset:0 lds
    v_mfma_f32_16x16x32_bf16 v[116:119], a[76:79], a[40:43], v[116:119]
    ds_read_b128 a[16:19], v6 offset:8192
    v_mfma_f32_16x16x32_bf16 v[124:127], a[76:79], a[44:47], v[124:127]
    s_xor_b32 s62, s62, 229376
    v_mfma_f32_16x16x32_bf16 v[132:135], a[76:79], a[48:51], v[132:135]
    v_mfma_f32_16x16x32_bf16 v[140:143], a[76:79], a[52:55], v[140:143]
    buffer_load_dwordx4 v21, s[44:47], s54 offen offset:1024 lds
    v_mfma_f32_16x16x32_bf16 v[148:151], a[76:79], a[56:59], v[148:151]
    s_add_u32 s54, s54, s56
    ds_read_b128 a[20:23], v6 offset:10240
    v_mfma_f32_16x16x32_bf16 v[156:159], a[76:79], a[60:63], v[156:159]
    ds_read_b64_tr_b16 a[76:77], v11 offset:0
    v_mfma_f32_16x16x32_bf16 v[160:163], a[80:83], a[32:35], v[160:163]
    ds_read_b64_tr_b16 a[78:79], v11 offset:2048
    v_mfma_f32_16x16x32_bf16 v[168:171], a[80:83], a[36:39], v[168:171]
    buffer_load_dwordx4 v20, s[44:47], s55 offen offset:2048 lds
    v_mfma_f32_16x16x32_bf16 v[176:179], a[80:83], a[40:43], v[176:179]
    ds_read_b128 a[24:27], v6 offset:12288
    v_mfma_f32_16x16x32_bf16 v[184:187], a[80:83], a[44:47], v[184:187]
    v_mfma_f32_16x16x32_bf16 v[192:195], a[80:83], a[48:51], v[192:195]
    v_mfma_f32_16x16x32_bf16 v[200:203], a[80:83], a[52:55], v[200:203]
    buffer_load_dwordx4 v21, s[44:47], s55 offen offset:3072 lds
    v_mfma_f32_16x16x32_bf16 v[208:211], a[80:83], a[56:59], v[208:211]
    s_add_u32 s55, s55, s56
    ds_read_b128 a[28:31], v6 offset:14336
    v_mfma_f32_16x16x32_bf16 v[216:219], a[80:83], a[60:63], v[216:219]
    ds_read_b64_tr_b16 a[80:81], v12 offset:0
    v_mfma_f32_16x16x32_bf16 v[164:167], a[84:87], a[32:35], v[164:167]
    ds_read_b64_tr_b16 a[82:83], v12 offset:2048
    v_mfma_f32_16x16x32_bf16 v[172:175], a[84:87], a[36:39], v[172:175]
    v_mfma_f32_16x16x32_bf16 v[180:183], a[84:87], a[40:43], v[180:183]
    buffer_store_dwordx4 a[204:207], v2, s[24:27], s28 offen sc1
    v_mfma_f32_16x16x32_bf16 v[188:191], a[84:87], a[44:47], v[188:191]
    s_add_u32 s28, s28, s31
    v_mfma_f32_16x16x32_bf16 v[196:199], a[84:87], a[48:51], v[196:199]
    v_mfma_f32_16x16x32_bf16 v[204:207], a[84:87], a[52:55], v[204:207]
    v_mfma_f32_16x16x32_bf16 v[212:215], a[84:87], a[56:59], v[212:215]
    buffer_store_dwordx4 a[208:211], v2, s[24:27], s28 offen sc1
    v_mfma_f32_16x16x32_bf16 v[220:223], a[84:87], a[60:63], v[220:223]
    s_add_u32 s28, s28, s31
    ds_read_b64_tr_b16 a[84:85], v13 offset:0
    v_mfma_f32_16x16x32_bf16 v[224:227], a[88:91], a[32:35], v[224:227]
    ds_read_b64_tr_b16 a[86:87], v13 offset:2048
    v_mfma_f32_16x16x32_bf16 v[232:235], a[88:91], a[36:39], v[232:235]
    v_mfma_f32_16x16x32_bf16 v[240:243], a[88:91], a[40:43], v[240:243]
    buffer_store_dwordx4 a[212:215], v2, s[24:27], s28 offen sc1
    v_mfma_f32_16x16x32_bf16 v[248:251], a[88:91], a[44:47], v[248:251]
    s_add_u32 s28, s28, s31
    v_mfma_f32_16x16x32_bf16 a[96:99], a[88:91], a[48:51], a[96:99]
    v_mfma_f32_16x16x32_bf16 a[104:107], a[88:91], a[52:55], a[104:107]
    v_mfma_f32_16x16x32_bf16 a[112:115], a[88:91], a[56:59], a[112:115]
    buffer_store_dwordx4 a[216:219], v2, s[24:27], s28 offen sc1
    v_mfma_f32_16x16x32_bf16 a[120:123], a[88:91], a[60:63], a[120:123]
    s_add_u32 s28, s28, s31
    ds_read_b64_tr_b16 a[88:89], v14 offset:0
    v_mfma_f32_16x16x32_bf16 v[228:231], a[92:95], a[32:35], v[228:231]
    ds_read_b64_tr_b16 a[90:91], v14 offset:2048
    v_mfma_f32_16x16x32_bf16 v[236:239], a[92:95], a[36:39], v[236:239]
    v_mfma_f32_16x16x32_bf16 v[244:247], a[92:95], a[40:43], v[244:247]
    buffer_store_dwordx4 a[220:223], v2, s[24:27], s28 offen sc1
    v_mfma_f32_16x16x32_bf16 v[252:255], a[92:95], a[44:47], v[252:255]
    s_add_u32 s29, s29, s30
    s_mov_b32 s28, s29
    v_mfma_f32_16x16x32_bf16 a[100:103], a[92:95], a[48:51], a[100:103]
    s_sub_u32 s65, s65, 1
    v_mfma_f32_16x16x32_bf16 a[108:111], a[92:95], a[52:55], a[108:111]
    v_mfma_f32_16x16x32_bf16 a[116:119], a[92:95], a[56:59], a[116:119]
    v_mfma_f32_16x16x32_bf16 a[124:127], a[92:95], a[60:63], a[124:127]
    ds_read_b64_tr_b16 a[92:93], v15 offset:0
    ds_read_b64_tr_b16 a[94:95], v15 offset:2048
    s_waitcnt lgkmcnt(15)
    v_mfma_f32_16x16x32_bf16 v[32:35], a[64:67], a[0:3], v[32:35]
    v_mfma_f32_16x16x32_bf16 v[40:43], a[64:67], a[4:7], v[40:43]
    v_mfma_f32_16x16x32_bf16 v[48:51], a[64:67], a[8:11], v[48:51]
    v_mfma_f32_16x16x32_bf16 v[56:59], a[64:67], a[12:15], v[56:59]
    s_add_u32 m0, s61, 0
    s_waitcnt lgkmcnt(13)
    v_mfma_f32_16x16x32_bf16 v[64:67], a[64:67], a[16:19], v[64:67]
    buffer_load_dwordx4 v16, s[40:43], s48 offen offset:0 lds
    s_waitcnt lgkmcnt(12)
    v_mfma_f32_16x16x32_bf16 v[72:75], a[64:67], a[20:23], v[72:75]
    s_waitcnt lgkmcnt(9)
    v_mfma_f32_16x16x32_bf16 v[80:83], a[64:67], a[24:27], v[80:83]
    s_waitcnt lgkmcnt(8)
    v_mfma_f32_16x16x32_bf16 v[88:91], a[64:67], a[28:31], v[88:91]
    ds_read_b64_tr_b16 a[64:65], v8 offset:16384
    v_mfma_f32_16x16x32_bf16 v[36:39], a[68:71], a[0:3], v[36:39]
    ds_read_b64_tr_b16 a[66:67], v8 offset:18432
    v_mfma_f32_16x16x32_bf16 v[44:47], a[68:71], a[4:7], v[44:47]
    v_mfma_f32_16x16x32_bf16 v[52:55], a[68:71], a[8:11], v[52:55]
    ds_read_b128 a[32:35], v7 offset:0
    v_mfma_f32_16x16x32_bf16 v[60:63], a[68:71], a[12:15], v[60:63]
    v_mfma_f32_16x16x32_bf16 v[68:71], a[68:71], a[16:19], v[68:71]
    buffer_load_dwordx4 v17, s[40:43], s48 offen offset:1024 lds
    v_mfma_f32_16x16x32_bf16 v[76:79], a[68:71], a[20:23], v[76:79]
    s_add_u32 s48, s48, 128
    v_mfma_f32_16x16x32_bf16 v[84:87], a[68:71], a[24:27], v[84:87]
    ds_read_b128 a[36:39], v7 offset:2048
    v_mfma_f32_16x16x32_bf16 v[92:95], a[68:71], a[28:31], v[92:95]
    ds_read_b64_tr_b16 a[68:69], v9 offset:16384
    v_mfma_f32_16x16x32_bf16 v[96:99], a[72:75], a[0:3], v[96:99]
    ds_read_b64_tr_b16 a[70:71], v9 offset:18432
    v_mfma_f32_16x16x32_bf16 v[104:107], a[72:75], a[4:7], v[104:107]
    v_mfma_f32_16x16x32_bf16 v[112:115], a[72:75], a[8:11], v[112:115]
    ds_read_b128 a[40:43], v7 offset:4096
    v_mfma_f32_16x16x32_bf16 v[120:123], a[72:75], a[12:15], v[120:123]
    v_mfma_f32_16x16x32_bf16 v[128:131], a[72:75], a[16:19], v[128:131]
    buffer_load_dwordx4 v16, s[40:43], s49 offen offset:2048 lds
    v_mfma_f32_16x16x32_bf16 v[136:139], a[72:75], a[20:23], v[136:139]
    v_mfma_f32_16x16x32_bf16 v[144:147], a[72:75], a[24:27], v[144:147]
    ds_read_b128 a[44:47], v7 offset:6144
    v_mfma_f32_16x16x32_bf16 v[152:155], a[72:75], a[28:31], v[152:155]
    ds_read_b64_tr_b16 a[72:73], v10 offset:16384
    v_mfma_f32_16x16x32_bf16 v[100:103], a[76:79], a[0:3], v[100:103]
    ds_read_b64_tr_b16 a[74:75], v10 offset:18432
    v_mfma_f32_16x16x32_bf16 v[108:111], a[76:79], a[4:7], v[108:111]
    v_mfma_f32_16x16x32_bf16 v[116:119], a[76:79], a[8:11], v[116:119]
    ds_read_b128 a[48:51], v7 offset:8192
    v_mfma_f32_16x16x32_bf16 v[124:127], a[76:79], a[12:15], v[124:127]
    v_mfma_f32_16x16x32_bf16 v[132:135], a[76:79], a[16:19], v[132:135]
    buffer_load_dwordx4 v17, s[40:43], s49 offen offset:3072 lds
    v_mfma_f32_16x16x32_bf16 v[140:143], a[76:79], a[20:23], v[140:143]
    s_add_u32 s49, s49, 128
    v_mfma_f32_16x16x32_bf16 v[148:151], a[76:79], a[24:27], v[148:151]
    ds_read_b128 a[52:55], v7 offset:10240
    v_mfma_f32_16x16x32_bf16 v[156:159], a[76:79], a[28:31], v[156:159]
    ds_read_b64_tr_b16 a[76:77], v11 offset:16384
    s_waitcnt lgkmcnt(15)
    v_mfma_f32_16x16x32_bf16 v[160:163], a[80:83], a[0:3], v[160:163]
    ds_read_b64_tr_b16 a[78:79], v11 offset:18432
    v_mfma_f32_16x16x32_bf16 v[168:171], a[80:83], a[4:7], v[168:171]
    v_mfma_f32_16x16x32_bf16 v[176:179], a[80:83], a[8:11], v[176:179]
    ds_read_b128 a[56:59], v7 offset:12288
    v_mfma_f32_16x16x32_bf16 v[184:187], a[80:83], a[12:15], v[184:187]
    s_add_u32 m0, s61, 4096
    v_mfma_f32_16x16x32_bf16 v[192:195], a[80:83], a[16:19], v[192:195]
    buffer_load_dwordx4 v16, s[40:43], s50 offen offset:0 lds
    v_mfma_f32_16x16x32_bf16 v[200:203], a[80:83], a[20:23], v[200:203]
    v_mfma_f32_16x16x32_bf16 v[208:211], a[80:83], a[24:27], v[208:211]
    s_add_u32 s61, s61, 32768
    ds_read_b128 a[60:63], v7 offset:14336
    v_mfma_f32_16x16x32_bf16 v[216:219], a[80:83], a[28:31], v[216:219]
    s_cmp_ge_u32 s61, 98304
    s_cselect_b32 s90, 98304, 0
    ds_read_b64_tr_b16 a[80:81], v12 offset:16384
    v_mfma_f32_16x16x32_bf16 v[164:167], a[84:87], a[0:3], v[164:167]
    s_sub_u32 s61, s61, s90
    ds_read_b64_tr_b16 a[82:83], v12 offset:18432
    v_mfma_f32_16x16x32_bf16 v[172:175], a[84:87], a[4:7], v[172:175]
    s_add_u32 s64, s64, 32768
    v_mfma_f32_16x16x32_bf16 v[180:183], a[84:87], a[8:11], v[180:183]
    buffer_store_dwordx4 a[224:227], v2, s[24:27], s28 offen sc1
    v_mfma_f32_16x16x32_bf16 v[188:191], a[84:87], a[12:15], v[188:191]
    s_add_u32 s28, s28, s31
    v_mfma_f32_16x16x32_bf16 v[196:199], a[84:87], a[16:19], v[196:199]
    buffer_load_dwordx4 v17, s[40:43], s50 offen offset:1024 lds
    v_mfma_f32_16x16x32_bf16 v[204:207], a[84:87], a[20:23], v[204:207]
    s_add_u32 s50, s50, 128
    v_mfma_f32_16x16x32_bf16 v[212:215], a[84:87], a[24:27], v[212:215]
    s_cmp_ge_u32 s64, 98304
    s_cselect_b32 s63, 4294901760, s59
    s_cselect_b32 s64, 0, s64
    v_mfma_f32_16x16x32_bf16 v[220:223], a[84:87], a[28:31], v[220:223]
    ds_read_b64_tr_b16 a[84:85], v13 offset:16384
    v_mfma_f32_16x16x32_bf16 v[224:227], a[88:91], a[0:3], v[224:227]
    ds_read_b64_tr_b16 a[86:87], v13 offset:18432
    v_mfma_f32_16x16x32_bf16 v[232:235], a[88:91], a[4:7], v[232:235]
    v_mfma_f32_16x16x32_bf16 v[240:243], a[88:91], a[8:11], v[240:243]
    buffer_store_dwordx4 a[228:231], v2, s[24:27], s28 offen sc1
    v_mfma_f32_16x16x32_bf16 v[248:251], a[88:91], a[12:15], v[248:251]
    s_add_u32 s28, s28, s31
    v_mfma_f32_16x16x32_bf16 a[96:99], a[88:91], a[16:19], a[96:99]
    buffer_load_dwordx4 v16, s[40:43], s51 offen offset:2048 lds
    v_mfma_f32_16x16x32_bf16 a[104:107], a[88:91], a[20:23], a[104:107]
    v_mfma_f32_16x16x32_bf16 a[112:115], a[88:91], a[24:27], a[112:115]
    v_mfma_f32_16x16x32_bf16 a[120:123], a[88:91], a[28:31], a[120:123]
    ds_read_b64_tr_b16 a[88:89], v14 offset:16384
    s_waitcnt lgkmcnt(15)
    v_mfma_f32_16x16x32_bf16 v[228:231], a[92:95], a[0:3], v[228:231]
    ds_read_b64_tr_b16 a[90:91], v14 offset:18432
    v_mfma_f32_16x16x32_bf16 v[236:239], a[92:95], a[4:7], v[236:239]
    v_add_u32 v6, s63, v6
    v_add_u32 v7, s63, v7
    v_mfma_f32_16x16x32_bf16 v[244:247], a[92:95], a[8:11], v[244:247]
    buffer_store_dwordx4 a[232:235], v2, s[24:27], s28 offen sc1
    v_mfma_f32_16x16x32_bf16 v[252:255], a[92:95], a[12:15], v[252:255]
    s_add_u32 s28, s28, s31
    v_mfma_f32_16x16x32_bf16 a[100:103], a[92:95], a[16:19], a[100:103]
    buffer_load_dwordx4 v17, s[40:43], s51 offen offset:3072 lds
    v_mfma_f32_16x16x32_bf16 a[108:111], a[92:95], a[20:23], a[108:111]
    s_add_u32 s51, s51, 128
    v_mfma_f32_16x16x32_bf16 a[116:119], a[92:95], a[24:27], a[116:119]
    v_mfma_f32_16x16x32_bf16 a[124:127], a[92:95], a[28:31], a[124:127]
    ds_read_b64_tr_b16 a[92:93], v15 offset:16384
    ds_read_b64_tr_b16 a[94:95], v15 offset:18432
    v_mfma_f32_16x16x32_bf16 v[32:35], a[64:67], a[32:35], v[32:35]
    v_xor_b32 v8, s60, v8
    v_xor_b32 v9, s60, v9
    v_mfma_f32_16x16x32_bf16 v[40:43], a[64:67], a[36:39], v[40:43]
    v_xor_b32 v10, s60, v10
    v_xor_b32 v11, s60, v11
    s_waitcnt lgkmcnt(15)
    v_mfma_f32_16x16x32_bf16 v[48:51], a[64:67], a[40:43], v[48:51]
    v_xor_b32 v12, s60, v12
    v_xor_b32 v13, s60, v13
    v_mfma_f32_16x16x32_bf16 v[56:59], a[64:67], a[44:47], v[56:59]
    v_xor_b32 v14, s60, v14
    v_xor_b32 v15, s60, v15
    s_waitcnt lgkmcnt(13)
    v_mfma_f32_16x16x32_bf16 v[64:67], a[64:67], a[48:51], v[64:67]
    s_waitcnt lgkmcnt(12)
    v_mfma_f32_16x16x32_bf16 v[72:75], a[64:67], a[52:55], v[72:75]
    s_waitcnt lgkmcnt(9)
    v_mfma_f32_16x16x32_bf16 v[80:83], a[64:67], a[56:59], v[80:83]
    s_waitcnt vmcnt(16) lgkmcnt(0)
    v_mfma_f32_16x16x32_bf16 v[88:91], a[64:67], a[60:63], v[88:91]
    s_barrier
    ds_read_b64_tr_b16 a[64:65], v8 offset:0
    v_mfma_f32_16x16x32_bf16 v[36:39], a[68:71], a[32:35], v[36:39]
    s_add_u32 m0, s62, 0
    ds_read_b64_tr_b16 a[66:67], v8 offset:2048
    v_mfma_f32_16x16x32_bf16 v[44:47], a[68:71], a[36:39], v[44:47]
    buffer_load_dwordx4 v18, s[44:47], s52 offen offset:0 lds
    v_mfma_f32_16x16x32_bf16 v[52:55], a[68:71], a[40:43], v[52:55]
    ds_read_b128 a[0:3], v6 offset:0
    v_mfma_f32_16x16x32_bf16 v[60:63], a[68:71], a[44:47], v[60:63]
    v_mfma_f32_16x16x32_bf16 v[68:71], a[68:71], a[48:51], v[68:71]
    v_mfma_f32_16x16x32_bf16 v[76:79], a[68:71], a[52:55], v[76:79]
    buffer_load_dwordx4 v19, s[44:47], s52 offen offset:1024 lds
    v_mfma_f32_16x16x32_bf16 v[84:87], a[68:71], a[56:59], v[84:87]
    s_add_u32 s52, s52, s56
    ds_read_b128 a[4:7], v6 offset:2048
    v_mfma_f32_16x16x32_bf16 v[92:95], a[68:71], a[60:63], v[92:95]
    ds_read_b64_tr_b16 a[68:69], v9 offset:0
    v_mfma_f32_16x16x32_bf16 v[96:99], a[72:75], a[32:35], v[96:99]
    ds_read_b64_tr_b16 a[70:71], v9 offset:2048
    v_mfma_f32_16x16x32_bf16 v[104:107], a[72:75], a[36:39], v[104:107]
    buffer_load_dwordx4 v18, s[44:47], s53 offen offset:2048 lds
    v_mfma_f32_16x16x32_bf16 v[112:115], a[72:75], a[40:43], v[112:115]
    ds_read_b128 a[8:11], v6 offset:4096
    v_mfma_f32_16x16x32_bf16 v[120:123], a[72:75], a[44:47], v[120:123]
    v_mfma_f32_16x16x32_bf16 v[128:131], a[72:75], a[48:51], v[128:131]
    v_mfma_f32_16x16x32_bf16 v[136:139], a[72:75], a[52:55], v[136:139]
    buffer_load_dwordx4 v19, s[44:47], s53 offen offset:3072 lds
    v_mfma_f32_16x16x32_bf16 v[144:147], a[72:75], a[56:59], v[144:147]
    s_add_u32 s53, s53, s56
    ds_read_b128 a[12:15], v6 offset:6144
    v_mfma_f32_16x16x32_bf16 v[152:155], a[72:75], a[60:63], v[152:155]
    ds_read_b64_tr_b16 a[72:73], v10 offset:0
    v_mfma_f32_16x16x32_bf16 v[100:103], a[76:79], a[32:35], v[100:103]
    s_add_u32 m0, s62, 4096
    ds_read_b64_tr_b16 a[74:75], v10 offset:2048
    v_mfma_f32_16x16x32_bf16 v[108:111], a[76:79], a[36:39], v[108:111]
    buffer_load_dwordx4 v20, s[44:47], s54 offen offset:0 lds
    v_mfma_f32_16x16x32_bf16 v[116:119], a[76:79], a[40:43], v[116:119]
    ds_read_b128 a[16:19], v6 offset:8192
    v_mfma_f32_16x16x32_bf16 v[124:127], a[76:79], a[44:47], v[124:127]
    s_xor_b32 s62, s62, 229376
    v_mfma_f32_16x16x32_bf16 v[132:135], a[76:79], a[48:51], v[132:135]
    v_mfma_f32_16x16x32_bf16 v[140:143], a[76:79], a[52:55], v[140:143]
    buffer_load_dwordx4 v21, s[44:47], s54 offen offset:1024 lds
    v_mfma_f32_16x16x32_bf16 v[148:151], a[76:79], a[56:59], v[148:151]
    s_add_u32 s54, s54, s56
    ds_read_b128 a[20:23], v6 offset:10240
    v_mfma_f32_16x16x32_bf16 v[156:159], a[76:79], a[60:63], v[156:159]
    ds_read_b64_tr_b16 a[76:77], v11 offset:0
    v_mfma_f32_16x16x32_bf16 v[160:163], a[80:83], a[32:35], v[160:163]
    ds_read_b64_tr_b16 a[78:79], v11 offset:2048
    v_mfma_f32_16x16x32_bf16 v[168:171], a[80:83], a[36:39], v[168:171]
    buffer_load_dwordx4 v20, s[44:47], s55 offen offset:2048 lds
    v_mfma_f32_16x16x32_bf16 v[176:179], a[80:83], a[40:43], v[176:179]
    ds_read_b128 a[24:27], v6 offset:12288
    v_mfma_f32_16x16x32_bf16 v[184:187], a[80:83], a[44:47], v[184:187]
    v_mfma_f32_16x16x32_bf16 v[192:195], a[80:83], a[48:51], v[192:195]
    v_mfma_f32_16x16x32_bf16 v[200:203], a[80:83], a[52:55], v[200:203]
    buffer_load_dwordx4 v21, s[44:47], s55 offen offset:3072 lds
    v_mfma_f32_16x16x32_bf16 v[208:211], a[80:83], a[56:59], v[208:211]
    s_add_u32 s55, s55, s56
    ds_read_b128 a[28:31], v6 offset:14336
    v_mfma_f32_16x16x32_bf16 v[216:219], a[80:83], a[60:63], v[216:219]
    ds_read_b64_tr_b16 a[80:81], v12 offset:0
    v_mfma_f32_16x16x32_bf16 v[164:167], a[84:87], a[32:35], v[164:167]
    ds_read_b64_tr_b16 a[82:83], v12 offset:2048
    v_mfma_f32_16x16x32_bf16 v[172:175], a[84:87], a[36:39], v[172:175]
    v_mfma_f32_16x16x32_bf16 v[180:183], a[84:87], a[40:43], v[180:183]
    buffer_store_dwordx4 a[236:239], v2, s[24:27], s28 offen sc1
    v_mfma_f32_16x16x32_bf16 v[188:191], a[84:87], a[44:47], v[188:191]
    s_add_u32 s28, s28, s31
    v_mfma_f32_16x16x32_bf16 v[196:199], a[84:87], a[48:51], v[196:199]
    v_mfma_f32_16x16x32_bf16 v[204:207], a[84:87], a[52:55], v[204:207]
    v_mfma_f32_16x16x32_bf16 v[212:215], a[84:87], a[56:59], v[212:215]
    buffer_store_dwordx4 a[240:243], v2, s[24:27], s28 offen sc1
    v_mfma_f32_16x16x32_bf16 v[220:223], a[84:87], a[60:63], v[220:223]
    s_add_u32 s28, s28, s31
    ds_read_b64_tr_b16 a[84:85], v13 offset:0
    v_mfma_f32_16x16x32_bf16 v[224:227], a[88:91], a[32:35], v[224:227]
    ds_read_b64_tr_b16 a[86:87], v13 offset:2048
    v_mfma_f32_16x16x32_bf16 v[232:235], a[88:91], a[36:39], v[232:235]
    v_mfma_f32_16x16x32_bf16 v[240:243], a[88:91], a[40:43], v[240:243]
    buffer_store_dwordx4 a[244:247], v2, s[24:27], s28 offen sc1
    v_mfma_f32_16x16x32_bf16 v[248:251], a[88:91], a[44:47], v[248:251]
    s_add_u32 s28, s28, s31
    v_mfma_f32_16x16x32_bf16 a[96:99], a[88:91], a[48:51], a[96:99]
    v_mfma_f32_16x16x32_bf16 a[104:107], a[88:91], a[52:55], a[104:107]
    v_mfma_f32_16x16x32_bf16 a[112:115], a[88:91], a[56:59], a[112:115]
    buffer_store_dwordx4 a[248:251], v2, s[24:27], s28 offen sc1
    v_mfma_f32_16x16x32_bf16 a[120:123], a[88:91], a[60:63], a[120:123]
    s_add_u32 s28, s28, s31
    ds_read_b64_tr_b16 a[88:89], v14 offset:0
    v_mfma_f32_16x16x32_bf16 v[228:231], a[92:95], a[32:35], v[228:231]
    ds_read_b64_tr_b16 a[90:91], v14 offset:2048
    v_mfma_f32_16x16x32_bf16 v[236:239], a[92:95], a[36:39], v[236:239]
    v_mfma_f32_16x16x32_bf16 v[244:247], a[92:95], a[40:43], v[244:247]
    buffer_store_dwordx4 a[252:255], v2, s[24:27], s28 offen sc1
    v_mfma_f32_16x16x32_bf16 v[252:255], a[92:95], a[44:47], v[252:255]
    s_add_u32 s29, s29, s30
    s_mov_b32 s28, s29
    v_mfma_f32_16x16x32_bf16 a[100:103], a[92:95], a[48:51], a[100:103]
    s_sub_u32 s65, s65, 1
    v_mfma_f32_16x16x32_bf16 a[108:111], a[92:95], a[52:55], a[108:111]
    v_mfma_f32_16x16x32_bf16 a[116:119], a[92:95], a[56:59], a[116:119]
    v_mfma_f32_16x16x32_bf16 a[124:127], a[92:95], a[60:63], a[124:127]
    ds_read_b64_tr_b16 a[92:93], v15 offset:0
    ds_read_b64_tr_b16 a[94:95], v15 offset:2048
mega_kernel_loop15:
    s_waitcnt lgkmcnt(15)
    v_mfma_f32_16x16x32_bf16 v[32:35], a[64:67], a[0:3], v[32:35]
    v_mfma_f32_16x16x32_bf16 v[40:43], a[64:67], a[4:7], v[40:43]
    v_mfma_f32_16x16x32_bf16 v[48:51], a[64:67], a[8:11], v[48:51]
    v_mfma_f32_16x16x32_bf16 v[56:59], a[64:67], a[12:15], v[56:59]
    s_add_u32 m0, s61, 0
    s_waitcnt lgkmcnt(13)
    v_mfma_f32_16x16x32_bf16 v[64:67], a[64:67], a[16:19], v[64:67]
    buffer_load_dwordx4 v16, s[40:43], s48 offen offset:0 lds
    s_waitcnt lgkmcnt(12)
    v_mfma_f32_16x16x32_bf16 v[72:75], a[64:67], a[20:23], v[72:75]
    s_waitcnt lgkmcnt(9)
    v_mfma_f32_16x16x32_bf16 v[80:83], a[64:67], a[24:27], v[80:83]
    s_waitcnt lgkmcnt(8)
    v_mfma_f32_16x16x32_bf16 v[88:91], a[64:67], a[28:31], v[88:91]
    ds_read_b64_tr_b16 a[64:65], v8 offset:16384
    v_mfma_f32_16x16x32_bf16 v[36:39], a[68:71], a[0:3], v[36:39]
    ds_read_b64_tr_b16 a[66:67], v8 offset:18432
    v_mfma_f32_16x16x32_bf16 v[44:47], a[68:71], a[4:7], v[44:47]
    v_mfma_f32_16x16x32_bf16 v[52:55], a[68:71], a[8:11], v[52:55]
    ds_read_b128 a[32:35], v7 offset:0
    v_mfma_f32_16x16x32_bf16 v[60:63], a[68:71], a[12:15], v[60:63]
    v_mfma_f32_16x16x32_bf16 v[68:71], a[68:71], a[16:19], v[68:71]
    buffer_load_dwordx4 v17, s[40:43], s48 offen offset:1024 lds
    v_mfma_f32_16x16x32_bf16 v[76:79], a[68:71], a[20:23], v[76:79]
    s_add_u32 s48, s48, 128
    v_mfma_f32_16x16x32_bf16 v[84:87], a[68:71], a[24:27], v[84:87]
    ds_read_b128 a[36:39], v7 offset:2048
    v_mfma_f32_16x16x32_bf16 v[92:95], a[68:71], a[28:31], v[92:95]
    ds_read_b64_tr_b16 a[68:69], v9 offset:16384
    v_mfma_f32_16x16x32_bf16 v[96:99], a[72:75], a[0:3], v[96:99]
    ds_read_b64_tr_b16 a[70:71], v9 offset:18432
    v_mfma_f32_16x16x32_bf16 v[104:107], a[72:75], a[4:7], v[104:107]
    v_mfma_f32_16x16x32_bf16 v[112:115], a[72:75], a[8:11], v[112:115]
    ds_read_b128 a[40:43], v7 offset:4096
    v_mfma_f32_16x16x32_bf16 v[120:123], a[72:75], a[12:15], v[120:123]
    v_mfma_f32_16x16x32_bf16 v[128:131], a[72:75], a[16:19], v[128:131]
    buffer_load_dwordx4 v16, s[40:43], s49 offen offset:2048 lds
    v_mfma_f32_16x16x32_bf16 v[136:139], a[72:75], a[20:23], v[136:139]
    v_mfma_f32_16x16x32_bf16 v[144:147], a[72:75], a[24:27], v[144:147]
    ds_read_b128 a[44:47], v7 offset:6144
    v_mfma_f32_16x16x32_bf16 v[152:155], a[72:75], a[28:31], v[152:155]
    ds_read_b64_tr_b16 a[72:73], v10 offset:16384
    v_mfma_f32_16x16x32_bf16 v[100:103], a[76:79], a[0:3], v[100:103]
    ds_read_b64_tr_b16 a[74:75], v10 offset:18432
    v_mfma_f32_16x16x32_bf16 v[108:111], a[76:79], a[4:7], v[108:111]
    v_mfma_f32_16x16x32_bf16 v[116:119], a[76:79], a[8:11], v[116:119]
    ds_read_b128 a[48:51], v7 offset:8192
    v_mfma_f32_16x16x32_bf16 v[124:127], a[76:79], a[12:15], v[124:127]
    v_mfma_f32_16x16x32_bf16 v[132:135], a[76:79], a[16:19], v[132:135]
    buffer_load_dwordx4 v17, s[40:43], s49 offen offset:3072 lds
    v_mfma_f32_16x16x32_bf16 v[140:143], a[76:79], a[20:23], v[140:143]
    s_add_u32 s49, s49, 128
    v_mfma_f32_16x16x32_bf16 v[148:151], a[76:79], a[24:27], v[148:151]
    ds_read_b128 a[52:55], v7 offset:10240
    v_mfma_f32_16x16x32_bf16 v[156:159], a[76:79], a[28:31], v[156:159]
    ds_read_b64_tr_b16 a[76:77], v11 offset:16384
    s_waitcnt lgkmcnt(15)
    v_mfma_f32_16x16x32_bf16 v[160:163], a[80:83], a[0:3], v[160:163]
    ds_read_b64_tr_b16 a[78:79], v11 offset:18432
    v_mfma_f32_16x16x32_bf16 v[168:171], a[80:83], a[4:7], v[168:171]
    v_mfma_f32_16x16x32_bf16 v[176:179], a[80:83], a[8:11], v[176:179]
    ds_read_b128 a[56:59], v7 offset:12288
    v_mfma_f32_16x16x32_bf16 v[184:187], a[80:83], a[12:15], v[184:187]
    s_add_u32 m0, s61, 4096
    v_mfma_f32_16x16x32_bf16 v[192:195], a[80:83], a[16:19], v[192:195]
    buffer_load_dwordx4 v16, s[40:43], s50 offen offset:0 lds
    v_mfma_f32_16x16x32_bf16 v[200:203], a[80:83], a[20:23], v[200:203]
    v_mfma_f32_16x16x32_bf16 v[208:211], a[80:83], a[24:27], v[208:211]
    s_add_u32 s61, s61, 32768
    ds_read_b128 a[60:63], v7 offset:14336
    v_mfma_f32_16x16x32_bf16 v[216:219], a[80:83], a[28:31], v[216:219]
    s_cmp_ge_u32 s61, 98304
    s_cselect_b32 s90, 98304, 0
    ds_read_b64_tr_b16 a[80:81], v12 offset:16384
    v_mfma_f32_16x16x32_bf16 v[164:167], a[84:87], a[0:3], v[164:167]
    s_sub_u32 s61, s61, s90
    ds_read_b64_tr_b16 a[82:83], v12 offset:18432
    v_mfma_f32_16x16x32_bf16 v[172:175], a[84:87], a[4:7], v[172:175]
    s_add_u32 s64, s64, 32768
    v_mfma_f32_16x16x32_bf16 v[180:183], a[84:87], a[8:11], v[180:183]
    s_cmp_ge_u32 s64, 98304
    s_cselect_b32 s63, 4294901760, s59
    s_cselect_b32 s64, 0, s64
    v_mfma_f32_16x16x32_bf16 v[188:191], a[84:87], a[12:15], v[188:191]
    v_mfma_f32_16x16x32_bf16 v[196:199], a[84:87], a[16:19], v[196:199]
    buffer_load_dwordx4 v17, s[40:43], s50 offen offset:1024 lds
    v_mfma_f32_16x16x32_bf16 v[204:207], a[84:87], a[20:23], v[204:207]
    s_add_u32 s50, s50, 128
    v_mfma_f32_16x16x32_bf16 v[212:215], a[84:87], a[24:27], v[212:215]
    v_mfma_f32_16x16x32_bf16 v[220:223], a[84:87], a[28:31], v[220:223]
    ds_read_b64_tr_b16 a[84:85], v13 offset:16384
    v_mfma_f32_16x16x32_bf16 v[224:227], a[88:91], a[0:3], v[224:227]
    ds_read_b64_tr_b16 a[86:87], v13 offset:18432
    v_mfma_f32_16x16x32_bf16 v[232:235], a[88:91], a[4:7], v[232:235]
    v_mfma_f32_16x16x32_bf16 v[240:243], a[88:91], a[8:11], v[240:243]
    v_mfma_f32_16x16x32_bf16 v[248:251], a[88:91], a[12:15], v[248:251]
    v_mfma_f32_16x16x32_bf16 a[96:99], a[88:91], a[16:19], a[96:99]
    buffer_load_dwordx4 v16, s[40:43], s51 offen offset:2048 lds
    v_mfma_f32_16x16x32_bf16 a[104:107], a[88:91], a[20:23], a[104:107]
    v_mfma_f32_16x16x32_bf16 a[112:115], a[88:91], a[24:27], a[112:115]
    v_mfma_f32_16x16x32_bf16 a[120:123], a[88:91], a[28:31], a[120:123]
    ds_read_b64_tr_b16 a[88:89], v14 offset:16384
    s_waitcnt lgkmcnt(15)
    v_mfma_f32_16x16x32_bf16 v[228:231], a[92:95], a[0:3], v[228:231]
    ds_read_b64_tr_b16 a[90:91], v14 offset:18432
    v_mfma_f32_16x16x32_bf16 v[236:239], a[92:95], a[4:7], v[236:239]
    v_add_u32 v6, s63, v6
    v_add_u32 v7, s63, v7
    v_mfma_f32_16x16x32_bf16 v[244:247], a[92:95], a[8:11], v[244:247]
    v_mfma_f32_16x16x32_bf16 v[252:255], a[92:95], a[12:15], v[252:255]
    v_mfma_f32_16x16x32_bf16 a[100:103], a[92:95], a[16:19], a[100:103]
    buffer_load_dwordx4 v17, s[40:43], s51 offen offset:3072 lds
    v_mfma_f32_16x16x32_bf16 a[108:111], a[92:95], a[20:23], a[108:111]
    s_add_u32 s51, s51, 128
    v_mfma_f32_16x16x32_bf16 a[116:119], a[92:95], a[24:27], a[116:119]
    v_mfma_f32_16x16x32_bf16 a[124:127], a[92:95], a[28:31], a[124:127]
    ds_read_b64_tr_b16 a[92:93], v15 offset:16384
    ds_read_b64_tr_b16 a[94:95], v15 offset:18432
    v_mfma_f32_16x16x32_bf16 v[32:35], a[64:67], a[32:35], v[32:35]
    v_xor_b32 v8, s60, v8
    v_xor_b32 v9, s60, v9
    v_mfma_f32_16x16x32_bf16 v[40:43], a[64:67], a[36:39], v[40:43]
    v_xor_b32 v10, s60, v10
    v_xor_b32 v11, s60, v11
    s_waitcnt lgkmcnt(15)
    v_mfma_f32_16x16x32_bf16 v[48:51], a[64:67], a[40:43], v[48:51]
    v_xor_b32 v12, s60, v12
    v_xor_b32 v13, s60, v13
    v_mfma_f32_16x16x32_bf16 v[56:59], a[64:67], a[44:47], v[56:59]
    v_xor_b32 v14, s60, v14
    v_xor_b32 v15, s60, v15
    s_waitcnt lgkmcnt(13)
    v_mfma_f32_16x16x32_bf16 v[64:67], a[64:67], a[48:51], v[64:67]
    s_waitcnt lgkmcnt(12)
    v_mfma_f32_16x16x32_bf16 v[72:75], a[64:67], a[52:55], v[72:75]
    s_waitcnt lgkmcnt(9)
    v_mfma_f32_16x16x32_bf16 v[80:83], a[64:67], a[56:59], v[80:83]
    s_waitcnt vmcnt(8) lgkmcnt(0)
    v_mfma_f32_16x16x32_bf16 v[88:91], a[64:67], a[60:63], v[88:91]
    s_barrier
    ds_read_b64_tr_b16 a[64:65], v8 offset:0
    v_mfma_f32_16x16x32_bf16 v[36:39], a[68:71], a[32:35], v[36:39]
    s_add_u32 m0, s62, 0
    ds_read_b64_tr_b16 a[66:67], v8 offset:2048
    v_mfma_f32_16x16x32_bf16 v[44:47], a[68:71], a[36:39], v[44:47]
    buffer_load_dwordx4 v18, s[44:47], s52 offen offset:0 lds
    v_mfma_f32_16x16x32_bf16 v[52:55], a[68:71], a[40:43], v[52:55]
    ds_read_b128 a[0:3], v6 offset:0
    v_mfma_f32_16x16x32_bf16 v[60:63], a[68:71], a[44:47], v[60:63]
    v_mfma_f32_16x16x32_bf16 v[68:71], a[68:71], a[48:51], v[68:71]
    v_mfma_f32_16x16x32_bf16 v[76:79], a[68:71], a[52:55], v[76:79]
    buffer_load_dwordx4 v19, s[44:47], s52 offen offset:1024 lds
    v_mfma_f32_16x16x32_bf16 v[84:87], a[68:71], a[56:59], v[84:87]
    s_add_u32 s52, s52, s56
    ds_read_b128 a[4:7], v6 offset:2048
    v_mfma_f32_16x16x32_bf16 v[92:95], a[68:71], a[60:63], v[92:95]
    ds_read_b64_tr_b16 a[68:69], v9 offset:0
    v_mfma_f32_16x16x32_bf16 v[96:99], a[72:75], a[32:35], v[96:99]
    ds_read_b64_tr_b16 a[70:71], v9 offset:2048
    v_mfma_f32_16x16x32_bf16 v[104:107], a[72:75], a[36:39], v[104:107]
    buffer_load_dwordx4 v18, s[44:47], s53 offen offset:2048 lds
    v_mfma_f32_16x16x32_bf16 v[112:115], a[72:75], a[40:43], v[112:115]
    ds_read_b128 a[8:11], v6 offset:4096
    v_mfma_f32_16x16x32_bf16 v[120:123], a[72:75], a[44:47], v[120:123]
    v_mfma_f32_16x16x32_bf16 v[128:131], a[72:75], a[48:51], v[128:131]
    v_mfma_f32_16x16x32_bf16 v[136:139], a[72:75], a[52:55], v[136:139]
    buffer_load_dwordx4 v19, s[44:47], s53 offen offset:3072 lds
    v_mfma_f32_16x16x32_bf16 v[144:147], a[72:75], a[56:59], v[144:147]
    s_add_u32 s53, s53, s56
    ds_read_b128 a[12:15], v6 offset:6144
    v_mfma_f32_16x16x32_bf16 v[152:155], a[72:75], a[60:63], v[152:155]
    ds_read_b64_tr_b16 a[72:73], v10 offset:0
    v_mfma_f32_16x16x32_bf16 v[100:103], a[76:79], a[32:35], v[100:103]
    s_add_u32 m0, s62, 4096
    ds_read_b64_tr_b16 a[74:75], v10 offset:2048
    v_mfma_f32_16x16x32_bf16 v[108:111], a[76:79], a[36:39], v[108:111]
    buffer_load_dwordx4 v20, s[44:47], s54 offen offset:0 lds
    v_mfma_f32_16x16x32_bf16 v[116:119], a[76:79], a[40:43], v[116:119]
    ds_read_b128 a[16:19], v6 offset:8192
    v_mfma_f32_16x16x32_bf16 v[124:127], a[76:79], a[44:47], v[124:127]
    s_xor_b32 s62, s62, 229376
    v_mfma_f32_16x16x32_bf16 v[132:135], a[76:79], a[48:51], v[132:135]
    v_mfma_f32_16x16x32_bf16 v[140:143], a[76:79], a[52:55], v[140:143]
    buffer_load_dwordx4 v21, s[44:47], s54 offen offset:1024 lds
    v_mfma_f32_16x16x32_bf16 v[148:151], a[76:79], a[56:59], v[148:151]
    s_add_u32 s54, s54, s56
    ds_read_b128 a[20:23], v6 offset:10240
    v_mfma_f32_16x16x32_bf16 v[156:159], a[76:79], a[60:63], v[156:159]
    ds_read_b64_tr_b16 a[76:77], v11 offset:0
    v_mfma_f32_16x16x32_bf16 v[160:163], a[80:83], a[32:35], v[160:163]
    ds_read_b64_tr_b16 a[78:79], v11 offset:2048
    v_mfma_f32_16x16x32_bf16 v[168:171], a[80:83], a[36:39], v[168:171]
    buffer_load_dwordx4 v20, s[44:47], s55 offen offset:2048 lds
    v_mfma_f32_16x16x32_bf16 v[176:179], a[80:83], a[40:43], v[176:179]
    ds_read_b128 a[24:27], v6 offset:12288
    v_mfma_f32_16x16x32_bf16 v[184:187], a[80:83], a[44:47], v[184:187]
    v_mfma_f32_16x16x32_bf16 v[192:195], a[80:83], a[48:51], v[192:195]
    v_mfma_f32_16x16x32_bf16 v[200:203], a[80:83], a[52:55], v[200:203]
    buffer_load_dwordx4 v21, s[44:47], s55 offen offset:3072 lds
    v_mfma_f32_16x16x32_bf16 v[208:211], a[80:83], a[56:59], v[208:211]
    s_add_u32 s55, s55, s56
    ds_read_b128 a[28:31], v6 offset:14336
    v_mfma_f32_16x16x32_bf16 v[216:219], a[80:83], a[60:63], v[216:219]
    ds_read_b64_tr_b16 a[80:81], v12 offset:0
    v_mfma_f32_16x16x32_bf16 v[164:167], a[84:87], a[32:35], v[164:167]
    ds_read_b64_tr_b16 a[82:83], v12 offset:2048
    v_mfma_f32_16x16x32_bf16 v[172:175], a[84:87], a[36:39], v[172:175]
    v_mfma_f32_16x16x32_bf16 v[180:183], a[84:87], a[40:43], v[180:183]
    v_mfma_f32_16x16x32_bf16 v[188:191], a[84:87], a[44:47], v[188:191]
    v_mfma_f32_16x16x32_bf16 v[196:199], a[84:87], a[48:51], v[196:199]
    v_mfma_f32_16x16x32_bf16 v[204:207], a[84:87], a[52:55], v[204:207]
    v_mfma_f32_16x16x32_bf16 v[212:215], a[84:87], a[56:59], v[212:215]
    v_mfma_f32_16x16x32_bf16 v[220:223], a[84:87], a[60:63], v[220:223]
    ds_read_b64_tr_b16 a[84:85], v13 offset:0
    v_mfma_f32_16x16x32_bf16 v[224:227], a[88:91], a[32:35], v[224:227]
    ds_read_b64_tr_b16 a[86:87], v13 offset:2048
    v_mfma_f32_16x16x32_bf16 v[232:235], a[88:91], a[36:39], v[232:235]
    v_mfma_f32_16x16x32_bf16 v[240:243], a[88:91], a[40:43], v[240:243]
    v_mfma_f32_16x16x32_bf16 v[248:251], a[88:91], a[44:47], v[248:251]
    v_mfma_f32_16x16x32_bf16 a[96:99], a[88:91], a[48:51], a[96:99]
    v_mfma_f32_16x16x32_bf16 a[104:107], a[88:91], a[52:55], a[104:107]
    v_mfma_f32_16x16x32_bf16 a[112:115], a[88:91], a[56:59], a[112:115]
    v_mfma_f32_16x16x32_bf16 a[120:123], a[88:91], a[60:63], a[120:123]
    ds_read_b64_tr_b16 a[88:89], v14 offset:0
    v_mfma_f32_16x16x32_bf16 v[228:231], a[92:95], a[32:35], v[228:231]
    ds_read_b64_tr_b16 a[90:91], v14 offset:2048
    v_mfma_f32_16x16x32_bf16 v[236:239], a[92:95], a[36:39], v[236:239]
    v_mfma_f32_16x16x32_bf16 v[244:247], a[92:95], a[40:43], v[244:247]
    v_mfma_f32_16x16x32_bf16 v[252:255], a[92:95], a[44:47], v[252:255]
    v_mfma_f32_16x16x32_bf16 a[100:103], a[92:95], a[48:51], a[100:103]
    s_sub_u32 s65, s65, 1
    v_mfma_f32_16x16x32_bf16 a[108:111], a[92:95], a[52:55], a[108:111]
    v_mfma_f32_16x16x32_bf16 a[116:119], a[92:95], a[56:59], a[116:119]
    s_cmp_gt_u32 s65, s67
    v_mfma_f32_16x16x32_bf16 a[124:127], a[92:95], a[60:63], a[124:127]
    ds_read_b64_tr_b16 a[92:93], v15 offset:0
    ds_read_b64_tr_b16 a[94:95], v15 offset:2048
    s_cbranch_scc1 mega_kernel_loop15
    s_cmp_lg_u32 s65, 0
    s_cbranch_scc1 mega_kernel_dosw16
    s_branch mega_kernel_epi11
mega_kernel_swp12:
    s_waitcnt lgkmcnt(15)
    v_mfma_f32_16x16x32_bf16 v[32:35], a[0:3], a[64:67], 0
    v_mfma_f32_16x16x32_bf16 v[36:39], a[4:7], a[64:67], 0
    v_mfma_f32_16x16x32_bf16 v[96:99], a[8:11], a[64:67], 0
    v_mfma_f32_16x16x32_bf16 v[100:103], a[12:15], a[64:67], 0
    s_add_u32 m0, s61, 0
    s_waitcnt lgkmcnt(13)
    v_mfma_f32_16x16x32_bf16 v[160:163], a[16:19], a[64:67], 0
    buffer_load_dwordx4 v16, s[40:43], s48 offen offset:0 lds
    s_waitcnt lgkmcnt(12)
    v_mfma_f32_16x16x32_bf16 v[164:167], a[20:23], a[64:67], 0
    s_waitcnt lgkmcnt(9)
    v_mfma_f32_16x16x32_bf16 v[224:227], a[24:27], a[64:67], 0
    s_waitcnt lgkmcnt(8)
    v_mfma_f32_16x16x32_bf16 v[228:231], a[28:31], a[64:67], 0
    ds_read_b64_tr_b16 a[64:65], v8 offset:16384
    v_mfma_f32_16x16x32_bf16 v[40:43], a[0:3], a[68:71], 0
    ds_read_b64_tr_b16 a[66:67], v8 offset:18432
    v_mfma_f32_16x16x32_bf16 v[44:47], a[4:7], a[68:71], 0
    v_mfma_f32_16x16x32_bf16 v[104:107], a[8:11], a[68:71], 0
    ds_read_b128 a[32:35], v7 offset:0
    v_mfma_f32_16x16x32_bf16 v[108:111], a[12:15], a[68:71], 0
    v_mfma_f32_16x16x32_bf16 v[168:171], a[16:19], a[68:71], 0
    buffer_load_dwordx4 v17, s[40:43], s48 offen offset:1024 lds
    v_mfma_f32_16x16x32_bf16 v[172:175], a[20:23], a[68:71], 0
    s_add_u32 s48, s48, 128
    v_mfma_f32_16x16x32_bf16 v[232:235], a[24:27], a[68:71], 0
    ds_read_b128 a[36:39], v7 offset:2048
    v_mfma_f32_16x16x32_bf16 v[236:239], a[28:31], a[68:71], 0
    ds_read_b64_tr_b16 a[68:69], v9 offset:16384
    v_mfma_f32_16x16x32_bf16 v[48:51], a[0:3], a[72:75], 0
    ds_read_b64_tr_b16 a[70:71], v9 offset:18432
    v_mfma_f32_16x16x32_bf16 v[52:55], a[4:7], a[72:75], 0
    v_mfma_f32_16x16x32_bf16 v[112:115], a[8:11], a[72:75], 0
    ds_read_b128 a[40:43], v7 offset:4096
    v_mfma_f32_16x16x32_bf16 v[116:119], a[12:15], a[72:75], 0
    v_mfma_f32_16x16x32_bf16 v[176:179], a[16:19], a[72:75], 0
    buffer_load_dwordx4 v16, s[40:43], s49 offen offset:2048 lds
    v_mfma_f32_16x16x32_bf16 v[180:183], a[20:23], a[72:75], 0
    v_mfma_f32_16x16x32_bf16 v[240:243], a[24:27], a[72:75], 0
    ds_read_b128 a[44:47], v7 offset:6144
    v_mfma_f32_16x16x32_bf16 v[244:247], a[28:31], a[72:75], 0
    ds_read_b64_tr_b16 a[72:73], v10 offset:16384
    v_mfma_f32_16x16x32_bf16 v[56:59], a[0:3], a[76:79], 0
    ds_read_b64_tr_b16 a[74:75], v10 offset:18432
    v_mfma_f32_16x16x32_bf16 v[60:63], a[4:7], a[76:79], 0
    v_mfma_f32_16x16x32_bf16 v[120:123], a[8:11], a[76:79], 0
    ds_read_b128 a[48:51], v7 offset:8192
    v_mfma_f32_16x16x32_bf16 v[124:127], a[12:15], a[76:79], 0
    v_mfma_f32_16x16x32_bf16 v[184:187], a[16:19], a[76:79], 0
    buffer_load_dwordx4 v17, s[40:43], s49 offen offset:3072 lds
    v_mfma_f32_16x16x32_bf16 v[188:191], a[20:23], a[76:79], 0
    s_add_u32 s49, s49, 128
    v_mfma_f32_16x16x32_bf16 v[248:251], a[24:27], a[76:79], 0
    ds_read_b128 a[52:55], v7 offset:10240
    v_mfma_f32_16x16x32_bf16 v[252:255], a[28:31], a[76:79], 0
    ds_read_b64_tr_b16 a[76:77], v11 offset:16384
    s_waitcnt lgkmcnt(15)
    v_mfma_f32_16x16x32_bf16 v[64:67], a[0:3], a[80:83], 0
    ds_read_b64_tr_b16 a[78:79], v11 offset:18432
    v_mfma_f32_16x16x32_bf16 v[68:71], a[4:7], a[80:83], 0
    v_mfma_f32_16x16x32_bf16 v[128:131], a[8:11], a[80:83], 0
    ds_read_b128 a[56:59], v7 offset:12288
    v_mfma_f32_16x16x32_bf16 v[132:135], a[12:15], a[80:83], 0
    s_add_u32 m0, s61, 4096
    v_mfma_f32_16x16x32_bf16 v[192:195], a[16:19], a[80:83], 0
    buffer_load_dwordx4 v16, s[40:43], s50 offen offset:0 lds
    v_mfma_f32_16x16x32_bf16 v[196:199], a[20:23], a[80:83], 0
    v_mfma_f32_16x16x32_bf16 a[96:99], a[24:27], a[80:83], 0
    s_add_u32 s61, s61, 32768
    ds_read_b128 a[60:63], v7 offset:14336
    v_mfma_f32_16x16x32_bf16 a[100:103], a[28:31], a[80:83], 0
    s_cmp_ge_u32 s61, 98304
    s_cselect_b32 s90, 98304, 0
    ds_read_b64_tr_b16 a[80:81], v12 offset:16384
    v_mfma_f32_16x16x32_bf16 v[72:75], a[0:3], a[84:87], 0
    s_sub_u32 s61, s61, s90
    ds_read_b64_tr_b16 a[82:83], v12 offset:18432
    v_mfma_f32_16x16x32_bf16 v[76:79], a[4:7], a[84:87], 0
    s_add_u32 s64, s64, 32768
    v_mfma_f32_16x16x32_bf16 v[136:139], a[8:11], a[84:87], 0
    buffer_store_dwordx4 a[128:131], v2, s[24:27], s28 offen sc1
    v_mfma_f32_16x16x32_bf16 v[140:143], a[12:15], a[84:87], 0
    s_add_u32 s28, s28, s31
    v_mfma_f32_16x16x32_bf16 v[200:203], a[16:19], a[84:87], 0
    buffer_load_dwordx4 v17, s[40:43], s50 offen offset:1024 lds
    v_mfma_f32_16x16x32_bf16 v[204:207], a[20:23], a[84:87], 0
    s_add_u32 s50, s50, 128
    v_mfma_f32_16x16x32_bf16 a[104:107], a[24:27], a[84:87], 0
    s_cmp_ge_u32 s64, 98304
    s_cselect_b32 s63, 4294901760, s59
    s_cselect_b32 s64, 0, s64
    v_mfma_f32_16x16x32_bf16 a[108:111], a[28:31], a[84:87], 0
    ds_read_b64_tr_b16 a[84:85], v13 offset:16384
    v_mfma_f32_16x16x32_bf16 v[80:83], a[0:3], a[88:91], 0
    ds_read_b64_tr_b16 a[86:87], v13 offset:18432
    v_mfma_f32_16x16x32_bf16 v[84:87], a[4:7], a[88:91], 0
    v_mfma_f32_16x16x32_bf16 v[144:147], a[8:11], a[88:91], 0
    buffer_store_dwordx4 a[132:135], v2, s[24:27], s28 offen sc1
    v_mfma_f32_16x16x32_bf16 v[148:151], a[12:15], a[88:91], 0
    s_add_u32 s28, s28, s31
    v_mfma_f32_16x16x32_bf16 v[208:211], a[16:19], a[88:91], 0
    buffer_load_dwordx4 v16, s[40:43], s51 offen offset:2048 lds
    v_mfma_f32_16x16x32_bf16 v[212:215], a[20:23], a[88:91], 0
    v_mfma_f32_16x16x32_bf16 a[112:115], a[24:27], a[88:91], 0
    v_mfma_f32_16x16x32_bf16 a[116:119], a[28:31], a[88:91], 0
    ds_read_b64_tr_b16 a[88:89], v14 offset:16384
    s_waitcnt lgkmcnt(15)
    v_mfma_f32_16x16x32_bf16 v[88:91], a[0:3], a[92:95], 0
    ds_read_b64_tr_b16 a[90:91], v14 offset:18432
    v_mfma_f32_16x16x32_bf16 v[92:95], a[4:7], a[92:95], 0
    v_add_u32 v6, s63, v6
    v_add_u32 v7, s63, v7
    v_mfma_f32_16x16x32_bf16 v[152:155], a[8:11], a[92:95], 0
    buffer_store_dwordx4 a[136:139], v2, s[24:27], s28 offen sc1
    v_mfma_f32_16x16x32_bf16 v[156:159], a[12:15], a[92:95], 0
    s_add_u32 s28, s28, s31
    v_mfma_f32_16x16x32_bf16 v[216:219], a[16:19], a[92:95], 0
    buffer_load_dwordx4 v17, s[40:43], s51 offen offset:3072 lds
    v_mfma_f32_16x16x32_bf16 v[220:223], a[20:23], a[92:95], 0
    s_add_u32 s51, s51, 128
    v_mfma_f32_16x16x32_bf16 a[120:123], a[24:27], a[92:95], 0
    v_mfma_f32_16x16x32_bf16 a[124:127], a[28:31], a[92:95], 0
    ds_read_b64_tr_b16 a[92:93], v15 offset:16384
    ds_read_b64_tr_b16 a[94:95], v15 offset:18432
    v_mfma_f32_16x16x32_bf16 v[32:35], a[32:35], a[64:67], v[32:35]
    v_xor_b32 v8, s60, v8
    v_xor_b32 v9, s60, v9
    v_mfma_f32_16x16x32_bf16 v[36:39], a[36:39], a[64:67], v[36:39]
    v_xor_b32 v10, s60, v10
    v_xor_b32 v11, s60, v11
    s_waitcnt lgkmcnt(15)
    v_mfma_f32_16x16x32_bf16 v[96:99], a[40:43], a[64:67], v[96:99]
    v_xor_b32 v12, s60, v12
    v_xor_b32 v13, s60, v13
    v_mfma_f32_16x16x32_bf16 v[100:103], a[44:47], a[64:67], v[100:103]
    v_xor_b32 v14, s60, v14
    v_xor_b32 v15, s60, v15
    s_waitcnt lgkmcnt(13)
    v_mfma_f32_16x16x32_bf16 v[160:163], a[48:51], a[64:67], v[160:163]
    s_waitcnt lgkmcnt(12)
    v_mfma_f32_16x16x32_bf16 v[164:167], a[52:55], a[64:67], v[164:167]
    s_waitcnt lgkmcnt(9)
    v_mfma_f32_16x16x32_bf16 v[224:227], a[56:59], a[64:67], v[224:227]
    s_waitcnt vmcnt(11) lgkmcnt(0)
    v_mfma_f32_16x16x32_bf16 v[228:231], a[60:63], a[64:67], v[228:231]
    s_barrier
    ds_read_b64_tr_b16 a[64:65], v8 offset:0
    v_mfma_f32_16x16x32_bf16 v[40:43], a[32:35], a[68:71], v[40:43]
    s_add_u32 m0, s62, 0
    ds_read_b64_tr_b16 a[66:67], v8 offset:2048
    v_mfma_f32_16x16x32_bf16 v[44:47], a[36:39], a[68:71], v[44:47]
    buffer_load_dwordx4 v18, s[44:47], s52 offen offset:0 lds
    v_mfma_f32_16x16x32_bf16 v[104:107], a[40:43], a[68:71], v[104:107]
    ds_read_b128 a[0:3], v6 offset:0
    v_mfma_f32_16x16x32_bf16 v[108:111], a[44:47], a[68:71], v[108:111]
    v_mfma_f32_16x16x32_bf16 v[168:171], a[48:51], a[68:71], v[168:171]
    v_mfma_f32_16x16x32_bf16 v[172:175], a[52:55], a[68:71], v[172:175]
    buffer_load_dwordx4 v19, s[44:47], s52 offen offset:1024 lds
    v_mfma_f32_16x16x32_bf16 v[232:235], a[56:59], a[68:71], v[232:235]
    s_add_u32 s52, s52, s56
    ds_read_b128 a[4:7], v6 offset:2048
    v_mfma_f32_16x16x32_bf16 v[236:239], a[60:63], a[68:71], v[236:239]
    ds_read_b64_tr_b16 a[68:69], v9 offset:0
    v_mfma_f32_16x16x32_bf16 v[48:51], a[32:35], a[72:75], v[48:51]
    ds_read_b64_tr_b16 a[70:71], v9 offset:2048
    v_mfma_f32_16x16x32_bf16 v[52:55], a[36:39], a[72:75], v[52:55]
    buffer_load_dwordx4 v18, s[44:47], s53 offen offset:2048 lds
    v_mfma_f32_16x16x32_bf16 v[112:115], a[40:43], a[72:75], v[112:115]
    ds_read_b128 a[8:11], v6 offset:4096
    v_mfma_f32_16x16x32_bf16 v[116:119], a[44:47], a[72:75], v[116:119]
    v_mfma_f32_16x16x32_bf16 v[176:179], a[48:51], a[72:75], v[176:179]
    v_mfma_f32_16x16x32_bf16 v[180:183], a[52:55], a[72:75], v[180:183]
    buffer_load_dwordx4 v19, s[44:47], s53 offen offset:3072 lds
    v_mfma_f32_16x16x32_bf16 v[240:243], a[56:59], a[72:75], v[240:243]
    s_add_u32 s53, s53, s56
    ds_read_b128 a[12:15], v6 offset:6144
    v_mfma_f32_16x16x32_bf16 v[244:247], a[60:63], a[72:75], v[244:247]
    ds_read_b64_tr_b16 a[72:73], v10 offset:0
    v_mfma_f32_16x16x32_bf16 v[56:59], a[32:35], a[76:79], v[56:59]
    s_add_u32 m0, s62, 4096
    ds_read_b64_tr_b16 a[74:75], v10 offset:2048
    v_mfma_f32_16x16x32_bf16 v[60:63], a[36:39], a[76:79], v[60:63]
    buffer_load_dwordx4 v20, s[44:47], s54 offen offset:0 lds
    v_mfma_f32_16x16x32_bf16 v[120:123], a[40:43], a[76:79], v[120:123]
    ds_read_b128 a[16:19], v6 offset:8192
    v_mfma_f32_16x16x32_bf16 v[124:127], a[44:47], a[76:79], v[124:127]
    s_xor_b32 s62, s62, 229376
    v_mfma_f32_16x16x32_bf16 v[184:187], a[48:51], a[76:79], v[184:187]
    v_mfma_f32_16x16x32_bf16 v[188:191], a[52:55], a[76:79], v[188:191]
    buffer_load_dwordx4 v21, s[44:47], s54 offen offset:1024 lds
    v_mfma_f32_16x16x32_bf16 v[248:251], a[56:59], a[76:79], v[248:251]
    s_add_u32 s54, s54, s56
    ds_read_b128 a[20:23], v6 offset:10240
    v_mfma_f32_16x16x32_bf16 v[252:255], a[60:63], a[76:79], v[252:255]
    ds_read_b64_tr_b16 a[76:77], v11 offset:0
    v_mfma_f32_16x16x32_bf16 v[64:67], a[32:35], a[80:83], v[64:67]
    ds_read_b64_tr_b16 a[78:79], v11 offset:2048
    v_mfma_f32_16x16x32_bf16 v[68:71], a[36:39], a[80:83], v[68:71]
    buffer_load_dwordx4 v20, s[44:47], s55 offen offset:2048 lds
    v_mfma_f32_16x16x32_bf16 v[128:131], a[40:43], a[80:83], v[128:131]
    ds_read_b128 a[24:27], v6 offset:12288
    v_mfma_f32_16x16x32_bf16 v[132:135], a[44:47], a[80:83], v[132:135]
    v_mfma_f32_16x16x32_bf16 v[192:195], a[48:51], a[80:83], v[192:195]
    v_mfma_f32_16x16x32_bf16 v[196:199], a[52:55], a[80:83], v[196:199]
    buffer_load_dwordx4 v21, s[44:47], s55 offen offset:3072 lds
    v_mfma_f32_16x16x32_bf16 a[96:99], a[56:59], a[80:83], a[96:99]
    s_add_u32 s55, s55, s56
    ds_read_b128 a[28:31], v6 offset:14336
    v_mfma_f32_16x16x32_bf16 a[100:103], a[60:63], a[80:83], a[100:103]
    ds_read_b64_tr_b16 a[80:81], v12 offset:0
    v_mfma_f32_16x16x32_bf16 v[72:75], a[32:35], a[84:87], v[72:75]
    ds_read_b64_tr_b16 a[82:83], v12 offset:2048
    v_mfma_f32_16x16x32_bf16 v[76:79], a[36:39], a[84:87], v[76:79]
    v_mfma_f32_16x16x32_bf16 v[136:139], a[40:43], a[84:87], v[136:139]
    buffer_store_dwordx4 a[140:143], v2, s[24:27], s28 offen sc1
    v_mfma_f32_16x16x32_bf16 v[140:143], a[44:47], a[84:87], v[140:143]
    s_add_u32 s28, s28, s31
    v_mfma_f32_16x16x32_bf16 v[200:203], a[48:51], a[84:87], v[200:203]
    v_mfma_f32_16x16x32_bf16 v[204:207], a[52:55], a[84:87], v[204:207]
    v_mfma_f32_16x16x32_bf16 a[104:107], a[56:59], a[84:87], a[104:107]
    buffer_store_dwordx4 a[144:147], v2, s[24:27], s28 offen sc1
    v_mfma_f32_16x16x32_bf16 a[108:111], a[60:63], a[84:87], a[108:111]
    s_add_u32 s28, s28, s31
    ds_read_b64_tr_b16 a[84:85], v13 offset:0
    v_mfma_f32_16x16x32_bf16 v[80:83], a[32:35], a[88:91], v[80:83]
    ds_read_b64_tr_b16 a[86:87], v13 offset:2048
    v_mfma_f32_16x16x32_bf16 v[84:87], a[36:39], a[88:91], v[84:87]
    v_mfma_f32_16x16x32_bf16 v[144:147], a[40:43], a[88:91], v[144:147]
    buffer_store_dwordx4 a[148:151], v2, s[24:27], s28 offen sc1
    v_mfma_f32_16x16x32_bf16 v[148:151], a[44:47], a[88:91], v[148:151]
    s_add_u32 s28, s28, s31
    v_mfma_f32_16x16x32_bf16 v[208:211], a[48:51], a[88:91], v[208:211]
    v_mfma_f32_16x16x32_bf16 v[212:215], a[52:55], a[88:91], v[212:215]
    v_mfma_f32_16x16x32_bf16 a[112:115], a[56:59], a[88:91], a[112:115]
    buffer_store_dwordx4 a[152:155], v2, s[24:27], s28 offen sc1
    v_mfma_f32_16x16x32_bf16 a[116:119], a[60:63], a[88:91], a[116:119]
    s_add_u32 s28, s28, s31
    ds_read_b64_tr_b16 a[88:89], v14 offset:0
    v_mfma_f32_16x16x32_bf16 v[88:91], a[32:35], a[92:95], v[88:91]
    ds_read_b64_tr_b16 a[90:91], v14 offset:2048
    v_mfma_f32_16x16x32_bf16 v[92:95], a[36:39], a[92:95], v[92:95]
    v_mfma_f32_16x16x32_bf16 v[152:155], a[40:43], a[92:95], v[152:155]
    buffer_store_dwordx4 a[156:159], v2, s[24:27], s28 offen sc1
    v_mfma_f32_16x16x32_bf16 v[156:159], a[44:47], a[92:95], v[156:159]
    s_add_u32 s29, s29, s30
    s_mov_b32 s28, s29
    v_mfma_f32_16x16x32_bf16 v[216:219], a[48:51], a[92:95], v[216:219]
    s_sub_u32 s65, s65, 1
    v_mfma_f32_16x16x32_bf16 v[220:223], a[52:55], a[92:95], v[220:223]
    v_mfma_f32_16x16x32_bf16 a[120:123], a[56:59], a[92:95], a[120:123]
    v_mfma_f32_16x16x32_bf16 a[124:127], a[60:63], a[92:95], a[124:127]
    ds_read_b64_tr_b16 a[92:93], v15 offset:0
    ds_read_b64_tr_b16 a[94:95], v15 offset:2048
    s_waitcnt lgkmcnt(15)
    v_mfma_f32_16x16x32_bf16 v[32:35], a[0:3], a[64:67], v[32:35]
    v_mfma_f32_16x16x32_bf16 v[36:39], a[4:7], a[64:67], v[36:39]
    v_mfma_f32_16x16x32_bf16 v[96:99], a[8:11], a[64:67], v[96:99]
    v_mfma_f32_16x16x32_bf16 v[100:103], a[12:15], a[64:67], v[100:103]
    s_add_u32 m0, s61, 0
    s_waitcnt lgkmcnt(13)
    v_mfma_f32_16x16x32_bf16 v[160:163], a[16:19], a[64:67], v[160:163]
    buffer_load_dwordx4 v16, s[40:43], s48 offen offset:0 lds
    s_waitcnt lgkmcnt(12)
    v_mfma_f32_16x16x32_bf16 v[164:167], a[20:23], a[64:67], v[164:167]
    s_waitcnt lgkmcnt(9)
    v_mfma_f32_16x16x32_bf16 v[224:227], a[24:27], a[64:67], v[224:227]
    s_waitcnt lgkmcnt(8)
    v_mfma_f32_16x16x32_bf16 v[228:231], a[28:31], a[64:67], v[228:231]
    ds_read_b64_tr_b16 a[64:65], v8 offset:16384
    v_mfma_f32_16x16x32_bf16 v[40:43], a[0:3], a[68:71], v[40:43]
    ds_read_b64_tr_b16 a[66:67], v8 offset:18432
    v_mfma_f32_16x16x32_bf16 v[44:47], a[4:7], a[68:71], v[44:47]
    v_mfma_f32_16x16x32_bf16 v[104:107], a[8:11], a[68:71], v[104:107]
    ds_read_b128 a[32:35], v7 offset:0
    v_mfma_f32_16x16x32_bf16 v[108:111], a[12:15], a[68:71], v[108:111]
    v_mfma_f32_16x16x32_bf16 v[168:171], a[16:19], a[68:71], v[168:171]
    buffer_load_dwordx4 v17, s[40:43], s48 offen offset:1024 lds
    v_mfma_f32_16x16x32_bf16 v[172:175], a[20:23], a[68:71], v[172:175]
    s_add_u32 s48, s48, 128
    v_mfma_f32_16x16x32_bf16 v[232:235], a[24:27], a[68:71], v[232:235]
    ds_read_b128 a[36:39], v7 offset:2048
    v_mfma_f32_16x16x32_bf16 v[236:239], a[28:31], a[68:71], v[236:239]
    ds_read_b64_tr_b16 a[68:69], v9 offset:16384
    v_mfma_f32_16x16x32_bf16 v[48:51], a[0:3], a[72:75], v[48:51]
    ds_read_b64_tr_b16 a[70:71], v9 offset:18432
    v_mfma_f32_16x16x32_bf16 v[52:55], a[4:7], a[72:75], v[52:55]
    v_mfma_f32_16x16x32_bf16 v[112:115], a[8:11], a[72:75], v[112:115]
    ds_read_b128 a[40:43], v7 offset:4096
    v_mfma_f32_16x16x32_bf16 v[116:119], a[12:15], a[72:75], v[116:119]
    v_mfma_f32_16x16x32_bf16 v[176:179], a[16:19], a[72:75], v[176:179]
    buffer_load_dwordx4 v16, s[40:43], s49 offen offset:2048 lds
    v_mfma_f32_16x16x32_bf16 v[180:183], a[20:23], a[72:75], v[180:183]
    v_mfma_f32_16x16x32_bf16 v[240:243], a[24:27], a[72:75], v[240:243]
    ds_read_b128 a[44:47], v7 offset:6144
    v_mfma_f32_16x16x32_bf16 v[244:247], a[28:31], a[72:75], v[244:247]
    ds_read_b64_tr_b16 a[72:73], v10 offset:16384
    v_mfma_f32_16x16x32_bf16 v[56:59], a[0:3], a[76:79], v[56:59]
    ds_read_b64_tr_b16 a[74:75], v10 offset:18432
    v_mfma_f32_16x16x32_bf16 v[60:63], a[4:7], a[76:79], v[60:63]
    v_mfma_f32_16x16x32_bf16 v[120:123], a[8:11], a[76:79], v[120:123]
    ds_read_b128 a[48:51], v7 offset:8192
    v_mfma_f32_16x16x32_bf16 v[124:127], a[12:15], a[76:79], v[124:127]
    v_mfma_f32_16x16x32_bf16 v[184:187], a[16:19], a[76:79], v[184:187]
    buffer_load_dwordx4 v17, s[40:43], s49 offen offset:3072 lds
    v_mfma_f32_16x16x32_bf16 v[188:191], a[20:23], a[76:79], v[188:191]
    s_add_u32 s49, s49, 128
    v_mfma_f32_16x16x32_bf16 v[248:251], a[24:27], a[76:79], v[248:251]
    ds_read_b128 a[52:55], v7 offset:10240
    v_mfma_f32_16x16x32_bf16 v[252:255], a[28:31], a[76:79], v[252:255]
    ds_read_b64_tr_b16 a[76:77], v11 offset:16384
    s_waitcnt lgkmcnt(15)
    v_mfma_f32_16x16x32_bf16 v[64:67], a[0:3], a[80:83], v[64:67]
    ds_read_b64_tr_b16 a[78:79], v11 offset:18432
    v_mfma_f32_16x16x32_bf16 v[68:71], a[4:7], a[80:83], v[68:71]
    v_mfma_f32_16x16x32_bf16 v[128:131], a[8:11], a[80:83], v[128:131]
    ds_read_b128 a[56:59], v7 offset:12288
    v_mfma_f32_16x16x32_bf16 v[132:135], a[12:15], a[80:83], v[132:135]
    s_add_u32 m0, s61, 4096
    v_mfma_f32_16x16x32_bf16 v[192:195], a[16:19], a[80:83], v[192:195]
    buffer_load_dwordx4 v16, s[40:43], s50 offen offset:0 lds
    v_mfma_f32_16x16x32_bf16 v[196:199], a[20:23], a[80:83], v[196:199]
    v_mfma_f32_16x16x32_bf16 a[96:99], a[24:27], a[80:83], a[96:99]
    s_add_u32 s61, s61, 32768
    ds_read_b128 a[60:63], v7 offset:14336
    v_mfma_f32_16x16x32_bf16 a[100:103], a[28:31], a[80:83], a[100:103]
    s_cmp_ge_u32 s61, 98304
    s_cselect_b32 s90, 98304, 0
    ds_read_b64_tr_b16 a[80:81], v12 offset:16384
    v_mfma_f32_16x16x32_bf16 v[72:75], a[0:3], a[84:87], v[72:75]
    s_sub_u32 s61, s61, s90
    ds_read_b64_tr_b16 a[82:83], v12 offset:18432
    v_mfma_f32_16x16x32_bf16 v[76:79], a[4:7], a[84:87], v[76:79]
    s_add_u32 s64, s64, 32768
    v_mfma_f32_16x16x32_bf16 v[136:139], a[8:11], a[84:87], v[136:139]
    buffer_store_dwordx4 a[160:163], v2, s[24:27], s28 offen sc1
    v_mfma_f32_16x16x32_bf16 v[140:143], a[12:15], a[84:87], v[140:143]
    s_add_u32 s28, s28, s31
    v_mfma_f32_16x16x32_bf16 v[200:203], a[16:19], a[84:87], v[200:203]
    buffer_load_dwordx4 v17, s[40:43], s50 offen offset:1024 lds
    v_mfma_f32_16x16x32_bf16 v[204:207], a[20:23], a[84:87], v[204:207]
    s_add_u32 s50, s50, 128
    v_mfma_f32_16x16x32_bf16 a[104:107], a[24:27], a[84:87], a[104:107]
    s_cmp_ge_u32 s64, 98304
    s_cselect_b32 s63, 4294901760, s59
    s_cselect_b32 s64, 0, s64
    v_mfma_f32_16x16x32_bf16 a[108:111], a[28:31], a[84:87], a[108:111]
    ds_read_b64_tr_b16 a[84:85], v13 offset:16384
    v_mfma_f32_16x16x32_bf16 v[80:83], a[0:3], a[88:91], v[80:83]
    ds_read_b64_tr_b16 a[86:87], v13 offset:18432
    v_mfma_f32_16x16x32_bf16 v[84:87], a[4:7], a[88:91], v[84:87]
    v_mfma_f32_16x16x32_bf16 v[144:147], a[8:11], a[88:91], v[144:147]
    buffer_store_dwordx4 a[164:167], v2, s[24:27], s28 offen sc1
    v_mfma_f32_16x16x32_bf16 v[148:151], a[12:15], a[88:91], v[148:151]
    s_add_u32 s28, s28, s31
    v_mfma_f32_16x16x32_bf16 v[208:211], a[16:19], a[88:91], v[208:211]
    buffer_load_dwordx4 v16, s[40:43], s51 offen offset:2048 lds
    v_mfma_f32_16x16x32_bf16 v[212:215], a[20:23], a[88:91], v[212:215]
    v_mfma_f32_16x16x32_bf16 a[112:115], a[24:27], a[88:91], a[112:115]
    v_mfma_f32_16x16x32_bf16 a[116:119], a[28:31], a[88:91], a[116:119]
    ds_read_b64_tr_b16 a[88:89], v14 offset:16384
    s_waitcnt lgkmcnt(15)
    v_mfma_f32_16x16x32_bf16 v[88:91], a[0:3], a[92:95], v[88:91]
    ds_read_b64_tr_b16 a[90:91], v14 offset:18432
    v_mfma_f32_16x16x32_bf16 v[92:95], a[4:7], a[92:95], v[92:95]
    v_add_u32 v6, s63, v6
    v_add_u32 v7, s63, v7
    v_mfma_f32_16x16x32_bf16 v[152:155], a[8:11], a[92:95], v[152:155]
    buffer_store_dwordx4 a[168:171], v2, s[24:27], s28 offen sc1
    v_mfma_f32_16x16x32_bf16 v[156:159], a[12:15], a[92:95], v[156:159]
    s_add_u32 s28, s28, s31
    v_mfma_f32_16x16x32_bf16 v[216:219], a[16:19], a[92:95], v[216:219]
    buffer_load_dwordx4 v17, s[40:43], s51 offen offset:3072 lds
    v_mfma_f32_16x16x32_bf16 v[220:223], a[20:23], a[92:95], v[220:223]
    s_add_u32 s51, s51, 128
    v_mfma_f32_16x16x32_bf16 a[120:123], a[24:27], a[92:95], a[120:123]
    v_mfma_f32_16x16x32_bf16 a[124:127], a[28:31], a[92:95], a[124:127]
    ds_read_b64_tr_b16 a[92:93], v15 offset:16384
    ds_read_b64_tr_b16 a[94:95], v15 offset:18432
    v_mfma_f32_16x16x32_bf16 v[32:35], a[32:35], a[64:67], v[32:35]
    v_xor_b32 v8, s60, v8
    v_xor_b32 v9, s60, v9
    v_mfma_f32_16x16x32_bf16 v[36:39], a[36:39], a[64:67], v[36:39]
    v_xor_b32 v10, s60, v10
    v_xor_b32 v11, s60, v11
    s_waitcnt lgkmcnt(15)
    v_mfma_f32_16x16x32_bf16 v[96:99], a[40:43], a[64:67], v[96:99]
    v_xor_b32 v12, s60, v12
    v_xor_b32 v13, s60, v13
    v_mfma_f32_16x16x32_bf16 v[100:103], a[44:47], a[64:67], v[100:103]
    v_xor_b32 v14, s60, v14
    v_xor_b32 v15, s60, v15
    s_waitcnt lgkmcnt(13)
    v_mfma_f32_16x16x32_bf16 v[160:163], a[48:51], a[64:67], v[160:163]
    s_waitcnt lgkmcnt(12)
    v_mfma_f32_16x16x32_bf16 v[164:167], a[52:55], a[64:67], v[164:167]
    s_waitcnt lgkmcnt(9)
    v_mfma_f32_16x16x32_bf16 v[224:227], a[56:59], a[64:67], v[224:227]
    s_waitcnt vmcnt(16) lgkmcnt(0)
    v_mfma_f32_16x16x32_bf16 v[228:231], a[60:63], a[64:67], v[228:231]
    s_barrier
    ds_read_b64_tr_b16 a[64:65], v8 offset:0
    v_mfma_f32_16x16x32_bf16 v[40:43], a[32:35], a[68:71], v[40:43]
    s_add_u32 m0, s62, 0
    ds_read_b64_tr_b16 a[66:67], v8 offset:2048
    v_mfma_f32_16x16x32_bf16 v[44:47], a[36:39], a[68:71], v[44:47]
    buffer_load_dwordx4 v18, s[44:47], s52 offen offset:0 lds
    v_mfma_f32_16x16x32_bf16 v[104:107], a[40:43], a[68:71], v[104:107]
    ds_read_b128 a[0:3], v6 offset:0
    v_mfma_f32_16x16x32_bf16 v[108:111], a[44:47], a[68:71], v[108:111]
    v_mfma_f32_16x16x32_bf16 v[168:171], a[48:51], a[68:71], v[168:171]
    v_mfma_f32_16x16x32_bf16 v[172:175], a[52:55], a[68:71], v[172:175]
    buffer_load_dwordx4 v19, s[44:47], s52 offen offset:1024 lds
    v_mfma_f32_16x16x32_bf16 v[232:235], a[56:59], a[68:71], v[232:235]
    s_add_u32 s52, s52, s56
    ds_read_b128 a[4:7], v6 offset:2048
    v_mfma_f32_16x16x32_bf16 v[236:239], a[60:63], a[68:71], v[236:239]
    ds_read_b64_tr_b16 a[68:69], v9 offset:0
    v_mfma_f32_16x16x32_bf16 v[48:51], a[32:35], a[72:75], v[48:51]
    ds_read_b64_tr_b16 a[70:71], v9 offset:2048
    v_mfma_f32_16x16x32_bf16 v[52:55], a[36:39], a[72:75], v[52:55]
    buffer_load_dwordx4 v18, s[44:47], s53 offen offset:2048 lds
    v_mfma_f32_16x16x32_bf16 v[112:115], a[40:43], a[72:75], v[112:115]
    ds_read_b128 a[8:11], v6 offset:4096
    v_mfma_f32_16x16x32_bf16 v[116:119], a[44:47], a[72:75], v[116:119]
    v_mfma_f32_16x16x32_bf16 v[176:179], a[48:51], a[72:75], v[176:179]
    v_mfma_f32_16x16x32_bf16 v[180:183], a[52:55], a[72:75], v[180:183]
    buffer_load_dwordx4 v19, s[44:47], s53 offen offset:3072 lds
    v_mfma_f32_16x16x32_bf16 v[240:243], a[56:59], a[72:75], v[240:243]
    s_add_u32 s53, s53, s56
    ds_read_b128 a[12:15], v6 offset:6144
    v_mfma_f32_16x16x32_bf16 v[244:247], a[60:63], a[72:75], v[244:247]
    ds_read_b64_tr_b16 a[72:73], v10 offset:0
    v_mfma_f32_16x16x32_bf16 v[56:59], a[32:35], a[76:79], v[56:59]
    s_add_u32 m0, s62, 4096
    ds_read_b64_tr_b16 a[74:75], v10 offset:2048
    v_mfma_f32_16x16x32_bf16 v[60:63], a[36:39], a[76:79], v[60:63]
    buffer_load_dwordx4 v20, s[44:47], s54 offen offset:0 lds
    v_mfma_f32_16x16x32_bf16 v[120:123], a[40:43], a[76:79], v[120:123]
    ds_read_b128 a[16:19], v6 offset:8192
    v_mfma_f32_16x16x32_bf16 v[124:127], a[44:47], a[76:79], v[124:127]
    s_xor_b32 s62, s62, 229376
    v_mfma_f32_16x16x32_bf16 v[184:187], a[48:51], a[76:79], v[184:187]
    v_mfma_f32_16x16x32_bf16 v[188:191], a[52:55], a[76:79], v[188:191]
    buffer_load_dwordx4 v21, s[44:47], s54 offen offset:1024 lds
    v_mfma_f32_16x16x32_bf16 v[248:251], a[56:59], a[76:79], v[248:251]
    s_add_u32 s54, s54, s56
    ds_read_b128 a[20:23], v6 offset:10240
    v_mfma_f32_16x16x32_bf16 v[252:255], a[60:63], a[76:79], v[252:255]
    ds_read_b64_tr_b16 a[76:77], v11 offset:0
    v_mfma_f32_16x16x32_bf16 v[64:67], a[32:35], a[80:83], v[64:67]
    ds_read_b64_tr_b16 a[78:79], v11 offset:2048
    v_mfma_f32_16x16x32_bf16 v[68:71], a[36:39], a[80:83], v[68:71]
    buffer_load_dwordx4 v20, s[44:47], s55 offen offset:2048 lds
    v_mfma_f32_16x16x32_bf16 v[128:131], a[40:43], a[80:83], v[128:131]
    ds_read_b128 a[24:27], v6 offset:12288
    v_mfma_f32_16x16x32_bf16 v[132:135], a[44:47], a[80:83], v[132:135]
    v_mfma_f32_16x16x32_bf16 v[192:195], a[48:51], a[80:83], v[192:195]
    v_mfma_f32_16x16x32_bf16 v[196:199], a[52:55], a[80:83], v[196:199]
    buffer_load_dwordx4 v21, s[44:47], s55 offen offset:3072 lds
    v_mfma_f32_16x16x32_bf16 a[96:99], a[56:59], a[80:83], a[96:99]
    s_add_u32 s55, s55, s56
    ds_read_b128 a[28:31], v6 offset:14336
    v_mfma_f32_16x16x32_bf16 a[100:103], a[60:63], a[80:83], a[100:103]
    ds_read_b64_tr_b16 a[80:81], v12 offset:0
    v_mfma_f32_16x16x32_bf16 v[72:75], a[32:35], a[84:87], v[72:75]
    ds_read_b64_tr_b16 a[82:83], v12 offset:2048
    v_mfma_f32_16x16x32_bf16 v[76:79], a[36:39], a[84:87], v[76:79]
    v_mfma_f32_16x16x32_bf16 v[136:139], a[40:43], a[84:87], v[136:139]
    buffer_store_dwordx4 a[172:175], v2, s[24:27], s28 offen sc1
    v_mfma_f32_16x16x32_bf16 v[140:143], a[44:47], a[84:87], v[140:143]
    s_add_u32 s28, s28, s31
    v_mfma_f32_16x16x32_bf16 v[200:203], a[48:51], a[84:87], v[200:203]
    v_mfma_f32_16x16x32_bf16 v[204:207], a[52:55], a[84:87], v[204:207]
    v_mfma_f32_16x16x32_bf16 a[104:107], a[56:59], a[84:87], a[104:107]
    buffer_store_dwordx4 a[176:179], v2, s[24:27], s28 offen sc1
    v_mfma_f32_16x16x32_bf16 a[108:111], a[60:63], a[84:87], a[108:111]
    s_add_u32 s28, s28, s31
    ds_read_b64_tr_b16 a[84:85], v13 offset:0
    v_mfma_f32_16x16x32_bf16 v[80:83], a[32:35], a[88:91], v[80:83]
    ds_read_b64_tr_b16 a[86:87], v13 offset:2048
    v_mfma_f32_16x16x32_bf16 v[84:87], a[36:39], a[88:91], v[84:87]
    v_mfma_f32_16x16x32_bf16 v[144:147], a[40:43], a[88:91], v[144:147]
    buffer_store_dwordx4 a[180:183], v2, s[24:27], s28 offen sc1
    v_mfma_f32_16x16x32_bf16 v[148:151], a[44:47], a[88:91], v[148:151]
    s_add_u32 s28, s28, s31
    v_mfma_f32_16x16x32_bf16 v[208:211], a[48:51], a[88:91], v[208:211]
    v_mfma_f32_16x16x32_bf16 v[212:215], a[52:55], a[88:91], v[212:215]
    v_mfma_f32_16x16x32_bf16 a[112:115], a[56:59], a[88:91], a[112:115]
    buffer_store_dwordx4 a[184:187], v2, s[24:27], s28 offen sc1
    v_mfma_f32_16x16x32_bf16 a[116:119], a[60:63], a[88:91], a[116:119]
    s_add_u32 s28, s28, s31
    ds_read_b64_tr_b16 a[88:89], v14 offset:0
    v_mfma_f32_16x16x32_bf16 v[88:91], a[32:35], a[92:95], v[88:91]
    ds_read_b64_tr_b16 a[90:91], v14 offset:2048
    v_mfma_f32_16x16x32_bf16 v[92:95], a[36:39], a[92:95], v[92:95]
    v_mfma_f32_16x16x32_bf16 v[152:155], a[40:43], a[92:95], v[152:155]
    buffer_store_dwordx4 a[188:191], v2, s[24:27], s28 offen sc1
    v_mfma_f32_16x16x32_bf16 v[156:159], a[44:47], a[92:95], v[156:159]
    s_add_u32 s29, s29, s30
    s_mov_b32 s28, s29
    v_mfma_f32_16x16x32_bf16 v[216:219], a[48:51], a[92:95], v[216:219]
    s_sub_u32 s65, s65, 1
    v_mfma_f32_16x16x32_bf16 v[220:223], a[52:55], a[92:95], v[220:223]
    v_mfma_f32_16x16x32_bf16 a[120:123], a[56:59], a[92:95], a[120:123]
    v_mfma_f32_16x16x32_bf16 a[124:127], a[60:63], a[92:95], a[124:127]
    ds_read_b64_tr_b16 a[92:93], v15 offset:0
    ds_read_b64_tr_b16 a[94:95], v15 offset:2048
    s_cmp_eq_u32 s66, 2
    s_cbranch_scc1 mega_kernel_hook17
mega_kernel_hookr18:
    s_waitcnt lgkmcnt(15)
    v_mfma_f32_16x16x32_bf16 v[32:35], a[0:3], a[64:67], v[32:35]
    v_mfma_f32_16x16x32_bf16 v[36:39], a[4:7], a[64:67], v[36:39]
    v_mfma_f32_16x16x32_bf16 v[96:99], a[8:11], a[64:67], v[96:99]
    v_mfma_f32_16x16x32_bf16 v[100:103], a[12:15], a[64:67], v[100:103]
    s_add_u32 m0, s61, 0
    s_waitcnt lgkmcnt(13)
    v_mfma_f32_16x16x32_bf16 v[160:163], a[16:19], a[64:67], v[160:163]
    buffer_load_dwordx4 v16, s[40:43], s48 offen offset:0 lds
    s_waitcnt lgkmcnt(12)
    v_mfma_f32_16x16x32_bf16 v[164:167], a[20:23], a[64:67], v[164:167]
    s_waitcnt lgkmcnt(9)
    v_mfma_f32_16x16x32_bf16 v[224:227], a[24:27], a[64:67], v[224:227]
    s_waitcnt lgkmcnt(8)
    v_mfma_f32_16x16x32_bf16 v[228:231], a[28:31], a[64:67], v[228:231]
    ds_read_b64_tr_b16 a[64:65], v8 offset:16384
    v_mfma_f32_16x16x32_bf16 v[40:43], a[0:3], a[68:71], v[40:43]
    ds_read_b64_tr_b16 a[66:67], v8 offset:18432
    v_mfma_f32_16x16x32_bf16 v[44:47], a[4:7], a[68:71], v[44:47]
    v_mfma_f32_16x16x32_bf16 v[104:107], a[8:11], a[68:71], v[104:107]
    ds_read_b128 a[32:35], v7 offset:0
    v_mfma_f32_16x16x32_bf16 v[108:111], a[12:15], a[68:71], v[108:111]
    v_mfma_f32_16x16x32_bf16 v[168:171], a[16:19], a[68:71], v[168:171]
    buffer_load_dwordx4 v17, s[40:43], s48 offen offset:1024 lds
    v_mfma_f32_16x16x32_bf16 v[172:175], a[20:23], a[68:71], v[172:175]
    s_add_u32 s48, s48, 128
    v_mfma_f32_16x16x32_bf16 v[232:235], a[24:27], a[68:71], v[232:235]
    ds_read_b128 a[36:39], v7 offset:2048
    v_mfma_f32_16x16x32_bf16 v[236:239], a[28:31], a[68:71], v[236:239]
    ds_read_b64_tr_b16 a[68:69], v9 offset:16384
    v_mfma_f32_16x16x32_bf16 v[48:51], a[0:3], a[72:75], v[48:51]
    ds_read_b64_tr_b16 a[70:71], v9 offset:18432
    v_mfma_f32_16x16x32_bf16 v[52:55], a[4:7], a[72:75], v[52:55]
    v_mfma_f32_16x16x32_bf16 v[112:115], a[8:11], a[72:75], v[112:115]
    ds_read_b128 a[40:43], v7 offset:4096
    v_mfma_f32_16x16x32_bf16 v[116:119], a[12:15], a[72:75], v[116:119]
    v_mfma_f32_16x16x32_bf16 v[176:179], a[16:19], a[72:75], v[176:179]
    buffer_load_dwordx4 v16, s[40:43], s49 offen offset:2048 lds
    v_mfma_f32_16x16x32_bf16 v[180:183], a[20:23], a[72:75], v[180:183]
    v_mfma_f32_16x16x32_bf16 v[240:243], a[24:27], a[72:75], v[240:243]
    ds_read_b128 a[44:47], v7 offset:6144
    v_mfma_f32_16x16x32_bf16 v[244:247], a[28:31], a[72:75], v[244:247]
    ds_read_b64_tr_b16 a[72:73], v10 offset:16384
    v_mfma_f32_16x16x32_bf16 v[56:59], a[0:3], a[76:79], v[56:59]
    ds_read_b64_tr_b16 a[74:75], v10 offset:18432
    v_mfma_f32_16x16x32_bf16 v[60:63], a[4:7], a[76:79], v[60:63]
    v_mfma_f32_16x16x32_bf16 v[120:123], a[8:11], a[76:79], v[120:123]
    ds_read_b128 a[48:51], v7 offset:8192
    v_mfma_f32_16x16x32_bf16 v[124:127], a[12:15], a[76:79], v[124:127]
    v_mfma_f32_16x16x32_bf16 v[184:187], a[16:19], a[76:79], v[184:187]
    buffer_load_dwordx4 v17, s[40:43], s49 offen offset:3072 lds
    v_mfma_f32_16x16x32_bf16 v[188:191], a[20:23], a[76:79], v[188:191]
    s_add_u32 s49, s49, 128
    v_mfma_f32_16x16x32_bf16 v[248:251], a[24:27], a[76:79], v[248:251]
    ds_read_b128 a[52:55], v7 offset:10240
    v_mfma_f32_16x16x32_bf16 v[252:255], a[28:31], a[76:79], v[252:255]
    ds_read_b64_tr_b16 a[76:77], v11 offset:16384
    s_waitcnt lgkmcnt(15)
    v_mfma_f32_16x16x32_bf16 v[64:67], a[0:3], a[80:83], v[64:67]
    ds_read_b64_tr_b16 a[78:79], v11 offset:18432
    v_mfma_f32_16x16x32_bf16 v[68:71], a[4:7], a[80:83], v[68:71]
    v_mfma_f32_16x16x32_bf16 v[128:131], a[8:11], a[80:83], v[128:131]
    ds_read_b128 a[56:59], v7 offset:12288
    v_mfma_f32_16x16x32_bf16 v[132:135], a[12:15], a[80:83], v[132:135]
    s_add_u32 m0, s61, 4096
    v_mfma_f32_16x16x32_bf16 v[192:195], a[16:19], a[80:83], v[192:195]
    buffer_load_dwordx4 v16, s[40:43], s50 offen offset:0 lds
    v_mfma_f32_16x16x32_bf16 v[196:199], a[20:23], a[80:83], v[196:199]
    v_mfma_f32_16x16x32_bf16 a[96:99], a[24:27], a[80:83], a[96:99]
    s_add_u32 s61, s61, 32768
    ds_read_b128 a[60:63], v7 offset:14336
    v_mfma_f32_16x16x32_bf16 a[100:103], a[28:31], a[80:83], a[100:103]
    s_cmp_ge_u32 s61, 98304
    s_cselect_b32 s90, 98304, 0
    ds_read_b64_tr_b16 a[80:81], v12 offset:16384
    v_mfma_f32_16x16x32_bf16 v[72:75], a[0:3], a[84:87], v[72:75]
    s_sub_u32 s61, s61, s90
    ds_read_b64_tr_b16 a[82:83], v12 offset:18432
    v_mfma_f32_16x16x32_bf16 v[76:79], a[4:7], a[84:87], v[76:79]
    s_add_u32 s64, s64, 32768
    v_mfma_f32_16x16x32_bf16 v[136:139], a[8:11], a[84:87], v[136:139]
    buffer_store_dwordx4 a[192:195], v2, s[24:27], s28 offen sc1
    v_mfma_f32_16x16x32_bf16 v[140:143], a[12:15], a[84:87], v[140:143]
    s_add_u32 s28, s28, s31
    v_mfma_f32_16x16x32_bf16 v[200:203], a[16:19], a[84:87], v[200:203]
    buffer_load_dwordx4 v17, s[40:43], s50 offen offset:1024 lds
    v_mfma_f32_16x16x32_bf16 v[204:207], a[20:23], a[84:87], v[204:207]
    s_add_u32 s50, s50, 128
    v_mfma_f32_16x16x32_bf16 a[104:107], a[24:27], a[84:87], a[104:107]
    s_cmp_ge_u32 s64, 98304
    s_cselect_b32 s63, 4294901760, s59
    s_cselect_b32 s64, 0, s64
    v_mfma_f32_16x16x32_bf16 a[108:111], a[28:31], a[84:87], a[108:111]
    ds_read_b64_tr_b16 a[84:85], v13 offset:16384
    v_mfma_f32_16x16x32_bf16 v[80:83], a[0:3], a[88:91], v[80:83]
    ds_read_b64_tr_b16 a[86:87], v13 offset:18432
    v_mfma_f32_16x16x32_bf16 v[84:87], a[4:7], a[88:91], v[84:87]
    v_mfma_f32_16x16x32_bf16 v[144:147], a[8:11], a[88:91], v[144:147]
    buffer_store_dwordx4 a[196:199], v2, s[24:27], s28 offen sc1
    v_mfma_f32_16x16x32_bf16 v[148:151], a[12:15], a[88:91], v[148:151]
    s_add_u32 s28, s28, s31
    v_mfma_f32_16x16x32_bf16 v[208:211], a[16:19], a[88:91], v[208:211]
    buffer_load_dwordx4 v16, s[40:43], s51 offen offset:2048 lds
    v_mfma_f32_16x16x32_bf16 v[212:215], a[20:23], a[88:91], v[212:215]
    v_mfma_f32_16x16x32_bf16 a[112:115], a[24:27], a[88:91], a[112:115]
    v_mfma_f32_16x16x32_bf16 a[116:119], a[28:31], a[88:91], a[116:119]
    ds_read_b64_tr_b16 a[88:89], v14 offset:16384
    s_waitcnt lgkmcnt(15)
    v_mfma_f32_16x16x32_bf16 v[88:91], a[0:3], a[92:95], v[88:91]
    ds_read_b64_tr_b16 a[90:91], v14 offset:18432
    v_mfma_f32_16x16x32_bf16 v[92:95], a[4:7], a[92:95], v[92:95]
    v_add_u32 v6, s63, v6
    v_add_u32 v7, s63, v7
    v_mfma_f32_16x16x32_bf16 v[152:155], a[8:11], a[92:95], v[152:155]
    buffer_store_dwordx4 a[200:203], v2, s[24:27], s28 offen sc1
    v_mfma_f32_16x16x32_bf16 v[156:159], a[12:15], a[92:95], v[156:159]
    s_add_u32 s28, s28, s31
    v_mfma_f32_16x16x32_bf16 v[216:219], a[16:19], a[92:95], v[216:219]
    buffer_load_dwordx4 v17, s[40:43], s51 offen offset:3072 lds
    v_mfma_f32_16x16x32_bf16 v[220:223], a[20:23], a[92:95], v[220:223]
    s_add_u32 s51, s51, 128
    v_mfma_f32_16x16x32_bf16 a[120:123], a[24:27], a[92:95], a[120:123]
    v_mfma_f32_16x16x32_bf16 a[124:127], a[28:31], a[92:95], a[124:127]
    ds_read_b64_tr_b16 a[92:93], v15 offset:16384
    ds_read_b64_tr_b16 a[94:95], v15 offset:18432
    v_mfma_f32_16x16x32_bf16 v[32:35], a[32:35], a[64:67], v[32:35]
    v_xor_b32 v8, s60, v8
    v_xor_b32 v9, s60, v9
    v_mfma_f32_16x16x32_bf16 v[36:39], a[36:39], a[64:67], v[36:39]
    v_xor_b32 v10, s60, v10
    v_xor_b32 v11, s60, v11
    s_waitcnt lgkmcnt(15)
    v_mfma_f32_16x16x32_bf16 v[96:99], a[40:43], a[64:67], v[96:99]
    v_xor_b32 v12, s60, v12
    v_xor_b32 v13, s60, v13
    v_mfma_f32_16x16x32_bf16 v[100:103], a[44:47], a[64:67], v[100:103]
    v_xor_b32 v14, s60, v14
    v_xor_b32 v15, s60, v15
    s_waitcnt lgkmcnt(13)
    v_mfma_f32_16x16x32_bf16 v[160:163], a[48:51], a[64:67], v[160:163]
    s_waitcnt lgkmcnt(12)
    v_mfma_f32_16x16x32_bf16 v[164:167], a[52:55], a[64:67], v[164:167]
    s_waitcnt lgkmcnt(9)
    v_mfma_f32_16x16x32_bf16 v[224:227], a[56:59], a[64:67], v[224:227]
    s_waitcnt vmcnt(16) lgkmcnt(0)
    v_mfma_f32_16x16x32_bf16 v[228:231], a[60:63], a[64:67], v[228:231]
    s_barrier
    ds_read_b64_tr_b16 a[64:65], v8 offset:0
    v_mfma_f32_16x16x32_bf16 v[40:43], a[32:35], a[68:71], v[40:43]
    s_add_u32 m0, s62, 0
    ds_read_b64_tr_b16 a[66:67], v8 offset:2048
    v_mfma_f32_16x16x32_bf16 v[44:47], a[36:39], a[68:71], v[44:47]
    buffer_load_dwordx4 v18, s[44:47], s52 offen offset:0 lds
    v_mfma_f32_16x16x32_bf16 v[104:107], a[40:43], a[68:71], v[104:107]
    ds_read_b128 a[0:3], v6 offset:0
    v_mfma_f32_16x16x32_bf16 v[108:111], a[44:47], a[68:71], v[108:111]
    v_mfma_f32_16x16x32_bf16 v[168:171], a[48:51], a[68:71], v[168:171]
    v_mfma_f32_16x16x32_bf16 v[172:175], a[52:55], a[68:71], v[172:175]
    buffer_load_dwordx4 v19, s[44:47], s52 offen offset:1024 lds
    v_mfma_f32_16x16x32_bf16 v[232:235], a[56:59], a[68:71], v[232:235]
    s_add_u32 s52, s52, s56
    ds_read_b128 a[4:7], v6 offset:2048
    v_mfma_f32_16x16x32_bf16 v[236:239], a[60:63], a[68:71], v[236:239]
    ds_read_b64_tr_b16 a[68:69], v9 offset:0
    v_mfma_f32_16x16x32_bf16 v[48:51], a[32:35], a[72:75], v[48:51]
    ds_read_b64_tr_b16 a[70:71], v9 offset:2048
    v_mfma_f32_16x16x32_bf16 v[52:55], a[36:39], a[72:75], v[52:55]
    buffer_load_dwordx4 v18, s[44:47], s53 offen offset:2048 lds
    v_mfma_f32_16x16x32_bf16 v[112:115], a[40:43], a[72:75], v[112:115]
    ds_read_b128 a[8:11], v6 offset:4096
    v_mfma_f32_16x16x32_bf16 v[116:119], a[44:47], a[72:75], v[116:119]
    v_mfma_f32_16x16x32_bf16 v[176:179], a[48:51], a[72:75], v[176:179]
    v_mfma_f32_16x16x32_bf16 v[180:183], a[52:55], a[72:75], v[180:183]
    buffer_load_dwordx4 v19, s[44:47], s53 offen offset:3072 lds
    v_mfma_f32_16x16x32_bf16 v[240:243], a[56:59], a[72:75], v[240:243]
    s_add_u32 s53, s53, s56
    ds_read_b128 a[12:15], v6 offset:6144
    v_mfma_f32_16x16x32_bf16 v[244:247], a[60:63], a[72:75], v[244:247]
    ds_read_b64_tr_b16 a[72:73], v10 offset:0
    v_mfma_f32_16x16x32_bf16 v[56:59], a[32:35], a[76:79], v[56:59]
    s_add_u32 m0, s62, 4096
    ds_read_b64_tr_b16 a[74:75], v10 offset:2048
    v_mfma_f32_16x16x32_bf16 v[60:63], a[36:39], a[76:79], v[60:63]
    buffer_load_dwordx4 v20, s[44:47], s54 offen offset:0 lds
    v_mfma_f32_16x16x32_bf16 v[120:123], a[40:43], a[76:79], v[120:123]
    ds_read_b128 a[16:19], v6 offset:8192
    v_mfma_f32_16x16x32_bf16 v[124:127], a[44:47], a[76:79], v[124:127]
    s_xor_b32 s62, s62, 229376
    v_mfma_f32_16x16x32_bf16 v[184:187], a[48:51], a[76:79], v[184:187]
    v_mfma_f32_16x16x32_bf16 v[188:191], a[52:55], a[76:79], v[188:191]
    buffer_load_dwordx4 v21, s[44:47], s54 offen offset:1024 lds
    v_mfma_f32_16x16x32_bf16 v[248:251], a[56:59], a[76:79], v[248:251]
    s_add_u32 s54, s54, s56
    ds_read_b128 a[20:23], v6 offset:10240
    v_mfma_f32_16x16x32_bf16 v[252:255], a[60:63], a[76:79], v[252:255]
    ds_read_b64_tr_b16 a[76:77], v11 offset:0
    v_mfma_f32_16x16x32_bf16 v[64:67], a[32:35], a[80:83], v[64:67]
    ds_read_b64_tr_b16 a[78:79], v11 offset:2048
    v_mfma_f32_16x16x32_bf16 v[68:71], a[36:39], a[80:83], v[68:71]
    buffer_load_dwordx4 v20, s[44:47], s55 offen offset:2048 lds
    v_mfma_f32_16x16x32_bf16 v[128:131], a[40:43], a[80:83], v[128:131]
    ds_read_b128 a[24:27], v6 offset:12288
    v_mfma_f32_16x16x32_bf16 v[132:135], a[44:47], a[80:83], v[132:135]
    v_mfma_f32_16x16x32_bf16 v[192:195], a[48:51], a[80:83], v[192:195]
    v_mfma_f32_16x16x32_bf16 v[196:199], a[52:55], a[80:83], v[196:199]
    buffer_load_dwordx4 v21, s[44:47], s55 offen offset:3072 lds
    v_mfma_f32_16x16x32_bf16 a[96:99], a[56:59], a[80:83], a[96:99]
    s_add_u32 s55, s55, s56
    ds_read_b128 a[28:31], v6 offset:14336
    v_mfma_f32_16x16x32_bf16 a[100:103], a[60:63], a[80:83], a[100:103]
    ds_read_b64_tr_b16 a[80:81], v12 offset:0
    v_mfma_f32_16x16x32_bf16 v[72:75], a[32:35], a[84:87], v[72:75]
    ds_read_b64_tr_b16 a[82:83], v12 offset:2048
    v_mfma_f32_16x16x32_bf16 v[76:79], a[36:39], a[84:87], v[76:79]
    v_mfma_f32_16x16x32_bf16 v[136:139], a[40:43], a[84:87], v[136:139]
    buffer_store_dwordx4 a[204:207], v2, s[24:27], s28 offen sc1
    v_mfma_f32_16x16x32_bf16 v[140:143], a[44:47], a[84:87], v[140:143]
    s_add_u32 s28, s28, s31
    v_mfma_f32_16x16x32_bf16 v[200:203], a[48:51], a[84:87], v[200:203]
    v_mfma_f32_16x16x32_bf16 v[204:207], a[52:55], a[84:87], v[204:207]
    v_mfma_f32_16x16x32_bf16 a[104:107], a[56:59], a[84:87], a[104:107]
    buffer_store_dwordx4 a[208:211], v2, s[24:27], s28 offen sc1
    v_mfma_f32_16x16x32_bf16 a[108:111], a[60:63], a[84:87], a[108:111]
    s_add_u32 s28, s28, s31
    ds_read_b64_tr_b16 a[84:85], v13 offset:0
    v_mfma_f32_16x16x32_bf16 v[80:83], a[32:35], a[88:91], v[80:83]
    ds_read_b64_tr_b16 a[86:87], v13 offset:2048
    v_mfma_f32_16x16x32_bf16 v[84:87], a[36:39], a[88:91], v[84:87]
    v_mfma_f32_16x16x32_bf16 v[144:147], a[40:43], a[88:91], v[144:147]
    buffer_store_dwordx4 a[212:215], v2, s[24:27], s28 offen sc1
    v_mfma_f32_16x16x32_bf16 v[148:151], a[44:47], a[88:91], v[148:151]
    s_add_u32 s28, s28, s31
    v_mfma_f32_16x16x32_bf16 v[208:211], a[48:51], a[88:91], v[208:211]
    v_mfma_f32_16x16x32_bf16 v[212:215], a[52:55], a[88:91], v[212:215]
    v_mfma_f32_16x16x32_bf16 a[112:115], a[56:59], a[88:91], a[112:115]
    buffer_store_dwordx4 a[216:219], v2, s[24:27], s28 offen sc1
    v_mfma_f32_16x16x32_bf16 a[116:119], a[60:63], a[88:91], a[116:119]
    s_add_u32 s28, s28, s31
    ds_read_b64_tr_b16 a[88:89], v14 offset:0
    v_mfma_f32_16x16x32_bf16 v[88:91], a[32:35], a[92:95], v[88:91]
    ds_read_b64_tr_b16 a[90:91], v14 offset:2048
    v_mfma_f32_16x16x32_bf16 v[92:95], a[36:39], a[92:95], v[92:95]
    v_mfma_f32_16x16x32_bf16 v[152:155], a[40:43], a[92:95], v[152:155]
    buffer_store_dwordx4 a[220:223], v2, s[24:27], s28 offen sc1
    v_mfma_f32_16x16x32_bf16 v[156:159], a[44:47], a[92:95], v[156:159]
    s_add_u32 s29, s29, s30
    s_mov_b32 s28, s29
    v_mfma_f32_16x16x32_bf16 v[216:219], a[48:51], a[92:95], v[216:219]
    s_sub_u32 s65, s65, 1
    v_mfma_f32_16x16x32_bf16 v[220:223], a[52:55], a[92:95], v[220:223]
    v_mfma_f32_16x16x32_bf16 a[120:123], a[56:59], a[92:95], a[120:123]
    v_mfma_f32_16x16x32_bf16 a[124:127], a[60:63], a[92:95], a[124:127]
    ds_read_b64_tr_b16 a[92:93], v15 offset:0
    ds_read_b64_tr_b16 a[94:95], v15 offset:2048
    s_waitcnt lgkmcnt(15)
    v_mfma_f32_16x16x32_bf16 v[32:35], a[0:3], a[64:67], v[32:35]
    v_mfma_f32_16x16x32_bf16 v[36:39], a[4:7], a[64:67], v[36:39]
    v_mfma_f32_16x16x32_bf16 v[96:99], a[8:11], a[64:67], v[96:99]
    v_mfma_f32_16x16x32_bf16 v[100:103], a[12:15], a[64:67], v[100:103]
    s_add_u32 m0, s61, 0
    s_waitcnt lgkmcnt(13)
    v_mfma_f32_16x16x32_bf16 v[160:163], a[16:19], a[64:67], v[160:163]
    buffer_load_dwordx4 v16, s[40:43], s48 offen offset:0 lds
    s_waitcnt lgkmcnt(12)
    v_mfma_f32_16x16x32_bf16 v[164:167], a[20:23], a[64:67], v[164:167]
    s_waitcnt lgkmcnt(9)
    v_mfma_f32_16x16x32_bf16 v[224:227], a[24:27], a[64:67], v[224:227]
    s_waitcnt lgkmcnt(8)
    v_mfma_f32_16x16x32_bf16 v[228:231], a[28:31], a[64:67], v[228:231]
    ds_read_b64_tr_b16 a[64:65], v8 offset:16384
    v_mfma_f32_16x16x32_bf16 v[40:43], a[0:3], a[68:71], v[40:43]
    ds_read_b64_tr_b16 a[66:67], v8 offset:18432
    v_mfma_f32_16x16x32_bf16 v[44:47], a[4:7], a[68:71], v[44:47]
    v_mfma_f32_16x16x32_bf16 v[104:107], a[8:11], a[68:71], v[104:107]
    ds_read_b128 a[32:35], v7 offset:0
    v_mfma_f32_16x16x32_bf16 v[108:111], a[12:15], a[68:71], v[108:111]
    v_mfma_f32_16x16x32_bf16 v[168:171], a[16:19], a[68:71], v[168:171]
    buffer_load_dwordx4 v17, s[40:43], s48 offen offset:1024 lds
    v_mfma_f32_16x16x32_bf16 v[172:175], a[20:23], a[68:71], v[172:175]
    s_add_u32 s48, s48, 128
    v_mfma_f32_16x16x32_bf16 v[232:235], a[24:27], a[68:71], v[232:235]
    ds_read_b128 a[36:39], v7 offset:2048
    v_mfma_f32_16x16x32_bf16 v[236:239], a[28:31], a[68:71], v[236:239]
    ds_read_b64_tr_b16 a[68:69], v9 offset:16384
    v_mfma_f32_16x16x32_bf16 v[48:51], a[0:3], a[72:75], v[48:51]
    ds_read_b64_tr_b16 a[70:71], v9 offset:18432
    v_mfma_f32_16x16x32_bf16 v[52:55], a[4:7], a[72:75], v[52:55]
    v_mfma_f32_16x16x32_bf16 v[112:115], a[8:11], a[72:75], v[112:115]
    ds_read_b128 a[40:43], v7 offset:4096
    v_mfma_f32_16x16x32_bf16 v[116:119], a[12:15], a[72:75], v[116:119]
    v_mfma_f32_16x16x32_bf16 v[176:179], a[16:19], a[72:75], v[176:179]
    buffer_load_dwordx4 v16, s[40:43], s49 offen offset:2048 lds
    v_mfma_f32_16x16x32_bf16 v[180:183], a[20:23], a[72:75], v[180:183]
    v_mfma_f32_16x16x32_bf16 v[240:243], a[24:27], a[72:75], v[240:243]
    ds_read_b128 a[44:47], v7 offset:6144
    v_mfma_f32_16x16x32_bf16 v[244:247], a[28:31], a[72:75], v[244:247]
    ds_read_b64_tr_b16 a[72:73], v10 offset:16384
    v_mfma_f32_16x16x32_bf16 v[56:59], a[0:3], a[76:79], v[56:59]
    ds_read_b64_tr_b16 a[74:75], v10 offset:18432
    v_mfma_f32_16x16x32_bf16 v[60:63], a[4:7], a[76:79], v[60:63]
    v_mfma_f32_16x16x32_bf16 v[120:123], a[8:11], a[76:79], v[120:123]
    ds_read_b128 a[48:51], v7 offset:8192
    v_mfma_f32_16x16x32_bf16 v[124:127], a[12:15], a[76:79], v[124:127]
    v_mfma_f32_16x16x32_bf16 v[184:187], a[16:19], a[76:79], v[184:187]
    buffer_load_dwordx4 v17, s[40:43], s49 offen offset:3072 lds
    v_mfma_f32_16x16x32_bf16 v[188:191], a[20:23], a[76:79], v[188:191]
    s_add_u32 s49, s49, 128
    v_mfma_f32_16x16x32_bf16 v[248:251], a[24:27], a[76:79], v[248:251]
    ds_read_b128 a[52:55], v7 offset:10240
    v_mfma_f32_16x16x32_bf16 v[252:255], a[28:31], a[76:79], v[252:255]
    ds_read_b64_tr_b16 a[76:77], v11 offset:16384
    s_waitcnt lgkmcnt(15)
    v_mfma_f32_16x16x32_bf16 v[64:67], a[0:3], a[80:83], v[64:67]
    ds_read_b64_tr_b16 a[78:79], v11 offset:18432
    v_mfma_f32_16x16x32_bf16 v[68:71], a[4:7], a[80:83], v[68:71]
    v_mfma_f32_16x16x32_bf16 v[128:131], a[8:11], a[80:83], v[128:131]
    ds_read_b128 a[56:59], v7 offset:12288
    v_mfma_f32_16x16x32_bf16 v[132:135], a[12:15], a[80:83], v[132:135]
    s_add_u32 m0, s61, 4096
    v_mfma_f32_16x16x32_bf16 v[192:195], a[16:19], a[80:83], v[192:195]
    buffer_load_dwordx4 v16, s[40:43], s50 offen offset:0 lds
    v_mfma_f32_16x16x32_bf16 v[196:199], a[20:23], a[80:83], v[196:199]
    v_mfma_f32_16x16x32_bf16 a[96:99], a[24:27], a[80:83], a[96:99]
    s_add_u32 s61, s61, 32768
    ds_read_b128 a[60:63], v7 offset:14336
    v_mfma_f32_16x16x32_bf16 a[100:103], a[28:31], a[80:83], a[100:103]
    s_cmp_ge_u32 s61, 98304
    s_cselect_b32 s90, 98304, 0
    ds_read_b64_tr_b16 a[80:81], v12 offset:16384
    v_mfma_f32_16x16x32_bf16 v[72:75], a[0:3], a[84:87], v[72:75]
    s_sub_u32 s61, s61, s90
    ds_read_b64_tr_b16 a[82:83], v12 offset:18432
    v_mfma_f32_16x16x32_bf16 v[76:79], a[4:7], a[84:87], v[76:79]
    s_add_u32 s64, s64, 32768
    v_mfma_f32_16x16x32_bf16 v[136:139], a[8:11], a[84:87], v[136:139]
    buffer_store_dwordx4 a[224:227], v2, s[24:27], s28 offen sc1
    v_mfma_f32_16x16x32_bf16 v[140:143], a[12:15], a[84:87], v[140:143]
    s_add_u32 s28, s28, s31
    v_mfma_f32_16x16x32_bf16 v[200:203], a[16:19], a[84:87], v[200:203]
    buffer_load_dwordx4 v17, s[40:43], s50 offen offset:1024 lds
    v_mfma_f32_16x16x32_bf16 v[204:207], a[20:23], a[84:87], v[204:207]
    s_add_u32 s50, s50, 128
    v_mfma_f32_16x16x32_bf16 a[104:107], a[24:27], a[84:87], a[104:107]
    s_cmp_ge_u32 s64, 98304
    s_cselect_b32 s63, 4294901760, s59
    s_cselect_b32 s64, 0, s64
    v_mfma_f32_16x16x32_bf16 a[108:111], a[28:31], a[84:87], a[108:111]
    ds_read_b64_tr_b16 a[84:85], v13 offset:16384
    v_mfma_f32_16x16x32_bf16 v[80:83], a[0:3], a[88:91], v[80:83]
    ds_read_b64_tr_b16 a[86:87], v13 offset:18432
    v_mfma_f32_16x16x32_bf16 v[84:87], a[4:7], a[88:91], v[84:87]
    v_mfma_f32_16x16x32_bf16 v[144:147], a[8:11], a[88:91], v[144:147]
    buffer_store_dwordx4 a[228:231], v2, s[24:27], s28 offen sc1
    v_mfma_f32_16x16x32_bf16 v[148:151], a[12:15], a[88:91], v[148:151]
    s_add_u32 s28, s28, s31
    v_mfma_f32_16x16x32_bf16 v[208:211], a[16:19], a[88:91], v[208:211]
    buffer_load_dwordx4 v16, s[40:43], s51 offen offset:2048 lds
    v_mfma_f32_16x16x32_bf16 v[212:215], a[20:23], a[88:91], v[212:215]
    v_mfma_f32_16x16x32_bf16 a[112:115], a[24:27], a[88:91], a[112:115]
    v_mfma_f32_16x16x32_bf16 a[116:119], a[28:31], a[88:91], a[116:119]
    ds_read_b64_tr_b16 a[88:89], v14 offset:16384
    s_waitcnt lgkmcnt(15)
    v_mfma_f32_16x16x32_bf16 v[88:91], a[0:3], a[92:95], v[88:91]
    ds_read_b64_tr_b16 a[90:91], v14 offset:18432
    v_mfma_f32_16x16x32_bf16 v[92:95], a[4:7], a[92:95], v[92:95]
    v_add_u32 v6, s63, v6
    v_add_u32 v7, s63, v7
    v_mfma_f32_16x16x32_bf16 v[152:155], a[8:11], a[92:95], v[152:155]
    buffer_store_dwordx4 a[232:235], v2, s[24:27], s28 offen sc1
    v_mfma_f32_16x16x32_bf16 v[156:159], a[12:15], a[92:95], v[156:159]
    s_add_u32 s28, s28, s31
    v_mfma_f32_16x16x32_bf16 v[216:219], a[16:19], a[92:95], v[216:219]
    buffer_load_dwordx4 v17, s[40:43], s51 offen offset:3072 lds
    v_mfma_f32_16x16x32_bf16 v[220:223], a[20:23], a[92:95], v[220:223]
    s_add_u32 s51, s51, 128
    v_mfma_f32_16x16x32_bf16 a[120:123], a[24:27], a[92:95], a[120:123]
    v_mfma_f32_16x16x32_bf16 a[124:127], a[28:31], a[92:95], a[124:127]
    ds_read_b64_tr_b16 a[92:93], v15 offset:16384
    ds_read_b64_tr_b16 a[94:95], v15 offset:18432
    v_mfma_f32_16x16x32_bf16 v[32:35], a[32:35], a[64:67], v[32:35]
    v_xor_b32 v8, s60, v8
    v_xor_b32 v9, s60, v9
    v_mfma_f32_16x16x32_bf16 v[36:39], a[36:39], a[64:67], v[36:39]
    v_xor_b32 v10, s60, v10
    v_xor_b32 v11, s60, v11
    s_waitcnt lgkmcnt(15)
    v_mfma_f32_16x16x32_bf16 v[96:99], a[40:43], a[64:67], v[96:99]
    v_xor_b32 v12, s60, v12
    v_xor_b32 v13, s60, v13
    v_mfma_f32_16x16x32_bf16 v[100:103], a[44:47], a[64:67], v[100:103]
    v_xor_b32 v14, s60, v14
    v_xor_b32 v15, s60, v15
    s_waitcnt lgkmcnt(13)
    v_mfma_f32_16x16x32_bf16 v[160:163], a[48:51], a[64:67], v[160:163]
    s_waitcnt lgkmcnt(12)
    v_mfma_f32_16x16x32_bf16 v[164:167], a[52:55], a[64:67], v[164:167]
    s_waitcnt lgkmcnt(9)
    v_mfma_f32_16x16x32_bf16 v[224:227], a[56:59], a[64:67], v[224:227]
    s_waitcnt vmcnt(16) lgkmcnt(0)
    v_mfma_f32_16x16x32_bf16 v[228:231], a[60:63], a[64:67], v[228:231]
    s_barrier
    ds_read_b64_tr_b16 a[64:65], v8 offset:0
    v_mfma_f32_16x16x32_bf16 v[40:43], a[32:35], a[68:71], v[40:43]
    s_add_u32 m0, s62, 0
    ds_read_b64_tr_b16 a[66:67], v8 offset:2048
    v_mfma_f32_16x16x32_bf16 v[44:47], a[36:39], a[68:71], v[44:47]
    buffer_load_dwordx4 v18, s[44:47], s52 offen offset:0 lds
    v_mfma_f32_16x16x32_bf16 v[104:107], a[40:43], a[68:71], v[104:107]
    ds_read_b128 a[0:3], v6 offset:0
    v_mfma_f32_16x16x32_bf16 v[108:111], a[44:47], a[68:71], v[108:111]
    v_mfma_f32_16x16x32_bf16 v[168:171], a[48:51], a[68:71], v[168:171]
    v_mfma_f32_16x16x32_bf16 v[172:175], a[52:55], a[68:71], v[172:175]
    buffer_load_dwordx4 v19, s[44:47], s52 offen offset:1024 lds
    v_mfma_f32_16x16x32_bf16 v[232:235], a[56:59], a[68:71], v[232:235]
    s_add_u32 s52, s52, s56
    ds_read_b128 a[4:7], v6 offset:2048
    v_mfma_f32_16x16x32_bf16 v[236:239], a[60:63], a[68:71], v[236:239]
    ds_read_b64_tr_b16 a[68:69], v9 offset:0
    v_mfma_f32_16x16x32_bf16 v[48:51], a[32:35], a[72:75], v[48:51]
    ds_read_b64_tr_b16 a[70:71], v9 offset:2048
    v_mfma_f32_16x16x32_bf16 v[52:55], a[36:39], a[72:75], v[52:55]
    buffer_load_dwordx4 v18, s[44:47], s53 offen offset:2048 lds
    v_mfma_f32_16x16x32_bf16 v[112:115], a[40:43], a[72:75], v[112:115]
    ds_read_b128 a[8:11], v6 offset:4096
    v_mfma_f32_16x16x32_bf16 v[116:119], a[44:47], a[72:75], v[116:119]
    v_mfma_f32_16x16x32_bf16 v[176:179], a[48:51], a[72:75], v[176:179]
    v_mfma_f32_16x16x32_bf16 v[180:183], a[52:55], a[72:75], v[180:183]
    buffer_load_dwordx4 v19, s[44:47], s53 offen offset:3072 lds
    v_mfma_f32_16x16x32_bf16 v[240:243], a[56:59], a[72:75], v[240:243]
    s_add_u32 s53, s53, s56
    ds_read_b128 a[12:15], v6 offset:6144
    v_mfma_f32_16x16x32_bf16 v[244:247], a[60:63], a[72:75], v[244:247]
    ds_read_b64_tr_b16 a[72:73], v10 offset:0
    v_mfma_f32_16x16x32_bf16 v[56:59], a[32:35], a[76:79], v[56:59]
    s_add_u32 m0, s62, 4096
    ds_read_b64_tr_b16 a[74:75], v10 offset:2048
    v_mfma_f32_16x16x32_bf16 v[60:63], a[36:39], a[76:79], v[60:63]
    buffer_load_dwordx4 v20, s[44:47], s54 offen offset:0 lds
    v_mfma_f32_16x16x32_bf16 v[120:123], a[40:43], a[76:79], v[120:123]
    ds_read_b128 a[16:19], v6 offset:8192
    v_mfma_f32_16x16x32_bf16 v[124:127], a[44:47], a[76:79], v[124:127]
    s_xor_b32 s62, s62, 229376
    v_mfma_f32_16x16x32_bf16 v[184:187], a[48:51], a[76:79], v[184:187]
    v_mfma_f32_16x16x32_bf16 v[188:191], a[52:55], a[76:79], v[188:191]
    buffer_load_dwordx4 v21, s[44:47], s54 offen offset:1024 lds
    v_mfma_f32_16x16x32_bf16 v[248:251], a[56:59], a[76:79], v[248:251]
    s_add_u32 s54, s54, s56
    ds_read_b128 a[20:23], v6 offset:10240
    v_mfma_f32_16x16x32_bf16 v[252:255], a[60:63], a[76:79], v[252:255]
    ds_read_b64_tr_b16 a[76:77], v11 offset:0
    v_mfma_f32_16x16x32_bf16 v[64:67], a[32:35], a[80:83], v[64:67]
    ds_read_b64_tr_b16 a[78:79], v11 offset:2048
    v_mfma_f32_16x16x32_bf16 v[68:71], a[36:39], a[80:83], v[68:71]
    buffer_load_dwordx4 v20, s[44:47], s55 offen offset:2048 lds
    v_mfma_f32_16x16x32_bf16 v[128:131], a[40:43], a[80:83], v[128:131]
    ds_read_b128 a[24:27], v6 offset:12288
    v_mfma_f32_16x16x32_bf16 v[132:135], a[44:47], a[80:83], v[132:135]
    v_mfma_f32_16x16x32_bf16 v[192:195], a[48:51], a[80:83], v[192:195]
    v_mfma_f32_16x16x32_bf16 v[196:199], a[52:55], a[80:83], v[196:199]
    buffer_load_dwordx4 v21, s[44:47], s55 offen offset:3072 lds
    v_mfma_f32_16x16x32_bf16 a[96:99], a[56:59], a[80:83], a[96:99]
    s_add_u32 s55, s55, s56
    ds_read_b128 a[28:31], v6 offset:14336
    v_mfma_f32_16x16x32_bf16 a[100:103], a[60:63], a[80:83], a[100:103]
    ds_read_b64_tr_b16 a[80:81], v12 offset:0
    v_mfma_f32_16x16x32_bf16 v[72:75], a[32:35], a[84:87], v[72:75]
    ds_read_b64_tr_b16 a[82:83], v12 offset:2048
    v_mfma_f32_16x16x32_bf16 v[76:79], a[36:39], a[84:87], v[76:79]
    v_mfma_f32_16x16x32_bf16 v[136:139], a[40:43], a[84:87], v[136:139]
    buffer_store_dwordx4 a[236:239], v2, s[24:27], s28 offen sc1
    v_mfma_f32_16x16x32_bf16 v[140:143], a[44:47], a[84:87], v[140:143]
    s_add_u32 s28, s28, s31
    v_mfma_f32_16x16x32_bf16 v[200:203], a[48:51], a[84:87], v[200:203]
    v_mfma_f32_16x16x32_bf16 v[204:207], a[52:55], a[84:87], v[204:207]
    v_mfma_f32_16x16x32_bf16 a[104:107], a[56:59], a[84:87], a[104:107]
    buffer_store_dwordx4 a[240:243], v2, s[24:27], s28 offen sc1
    v_mfma_f32_16x16x32_bf16 a[108:111], a[60:63], a[84:87], a[108:111]
    s_add_u32 s28, s28, s31
    ds_read_b64_tr_b16 a[84:85], v13 offset:0
    v_mfma_f32_16x16x32_bf16 v[80:83], a[32:35], a[88:91], v[80:83]
    ds_read_b64_tr_b16 a[86:87], v13 offset:2048
    v_mfma_f32_16x16x32_bf16 v[84:87], a[36:39], a[88:91], v[84:87]
    v_mfma_f32_16x16x32_bf16 v[144:147], a[40:43], a[88:91], v[144:147]
    buffer_store_dwordx4 a[244:247], v2, s[24:27], s28 offen sc1
    v_mfma_f32_16x16x32_bf16 v[148:151], a[44:47], a[88:91], v[148:151]
    s_add_u32 s28, s28, s31
    v_mfma_f32_16x16x32_bf16 v[208:211], a[48:51], a[88:91], v[208:211]
    v_mfma_f32_16x16x32_bf16 v[212:215], a[52:55], a[88:91], v[212:215]
    v_mfma_f32_16x16x32_bf16 a[112:115], a[56:59], a[88:91], a[112:115]
    buffer_store_dwordx4 a[248:251], v2, s[24:27], s28 offen sc1
    v_mfma_f32_16x16x32_bf16 a[116:119], a[60:63], a[88:91], a[116:119]
    s_add_u32 s28, s28, s31
    ds_read_b64_tr_b16 a[88:89], v14 offset:0
    v_mfma_f32_16x16x32_bf16 v[88:91], a[32:35], a[92:95], v[88:91]
    ds_read_b64_tr_b16 a[90:91], v14 offset:2048
    v_mfma_f32_16x16x32_bf16 v[92:95], a[36:39], a[92:95], v[92:95]
    v_mfma_f32_16x16x32_bf16 v[152:155], a[40:43], a[92:95], v[152:155]
    buffer_store_dwordx4 a[252:255], v2, s[24:27], s28 offen sc1
    v_mfma_f32_16x16x32_bf16 v[156:159], a[44:47], a[92:95], v[156:159]
    s_add_u32 s29, s29, s30
    s_mov_b32 s28, s29
    v_mfma_f32_16x16x32_bf16 v[216:219], a[48:51], a[92:95], v[216:219]
    s_sub_u32 s65, s65, 1
    v_mfma_f32_16x16x32_bf16 v[220:223], a[52:55], a[92:95], v[220:223]
    v_mfma_f32_16x16x32_bf16 a[120:123], a[56:59], a[92:95], a[120:123]
    v_mfma_f32_16x16x32_bf16 a[124:127], a[60:63], a[92:95], a[124:127]
    ds_read_b64_tr_b16 a[92:93], v15 offset:0
    ds_read_b64_tr_b16 a[94:95], v15 offset:2048
mega_kernel_loop19:
    s_waitcnt lgkmcnt(15)
    v_mfma_f32_16x16x32_bf16 v[32:35], a[0:3], a[64:67], v[32:35]
    v_mfma_f32_16x16x32_bf16 v[36:39], a[4:7], a[64:67], v[36:39]
    v_mfma_f32_16x16x32_bf16 v[96:99], a[8:11], a[64:67], v[96:99]
    v_mfma_f32_16x16x32_bf16 v[100:103], a[12:15], a[64:67], v[100:103]
    s_add_u32 m0, s61, 0
    s_waitcnt lgkmcnt(13)
    v_mfma_f32_16x16x32_bf16 v[160:163], a[16:19], a[64:67], v[160:163]
    buffer_load_dwordx4 v16, s[40:43], s48 offen offset:0 lds
    s_waitcnt lgkmcnt(12)
    v_mfma_f32_16x16x32_bf16 v[164:167], a[20:23], a[64:67], v[164:167]
    s_waitcnt lgkmcnt(9)
    v_mfma_f32_16x16x32_bf16 v[224:227], a[24:27], a[64:67], v[224:227]
    s_waitcnt lgkmcnt(8)
    v_mfma_f32_16x16x32_bf16 v[228:231], a[28:31], a[64:67], v[228:231]
    ds_read_b64_tr_b16 a[64:65], v8 offset:16384
    v_mfma_f32_16x16x32_bf16 v[40:43], a[0:3], a[68:71], v[40:43]
    ds_read_b64_tr_b16 a[66:67], v8 offset:18432
    v_mfma_f32_16x16x32_bf16 v[44:47], a[4:7], a[68:71], v[44:47]
    v_mfma_f32_16x16x32_bf16 v[104:107], a[8:11], a[68:71], v[104:107]
    ds_read_b128 a[32:35], v7 offset:0
    v_mfma_f32_16x16x32_bf16 v[108:111], a[12:15], a[68:71], v[108:111]
    v_mfma_f32_16x16x32_bf16 v[168:171], a[16:19], a[68:71], v[168:171]
    buffer_load_dwordx4 v17, s[40:43], s48 offen offset:1024 lds
    v_mfma_f32_16x16x32_bf16 v[172:175], a[20:23], a[68:71], v[172:175]
    s_add_u32 s48, s48, 128
    v_mfma_f32_16x16x32_bf16 v[232:235], a[24:27], a[68:71], v[232:235]
    ds_read_b128 a[36:39], v7 offset:2048
    v_mfma_f32_16x16x32_bf16 v[236:239], a[28:31], a[68:71], v[236:239]
    ds_read_b64_tr_b16 a[68:69], v9 offset:16384
    v_mfma_f32_16x16x32_bf16 v[48:51], a[0:3], a[72:75], v[48:51]
    ds_read_b64_tr_b16 a[70:71], v9 offset:18432
    v_mfma_f32_16x16x32_bf16 v[52:55], a[4:7], a[72:75], v[52:55]
    v_mfma_f32_16x16x32_bf16 v[112:115], a[8:11], a[72:75], v[112:115]
    ds_read_b128 a[40:43], v7 offset:4096
    v_mfma_f32_16x16x32_bf16 v[116:119], a[12:15], a[72:75], v[116:119]
    v_mfma_f32_16x16x32_bf16 v[176:179], a[16:19], a[72:75], v[176:179]
    buffer_load_dwordx4 v16, s[40:43], s49 offen offset:2048 lds
    v_mfma_f32_16x16x32_bf16 v[180:183], a[20:23], a[72:75], v[180:183]
    v_mfma_f32_16x16x32_bf16 v[240:243], a[24:27], a[72:75], v[240:243]
    ds_read_b128 a[44:47], v7 offset:6144
    v_mfma_f32_16x16x32_bf16 v[244:247], a[28:31], a[72:75], v[244:247]
    ds_read_b64_tr_b16 a[72:73], v10 offset:16384
    v_mfma_f32_16x16x32_bf16 v[56:59], a[0:3], a[76:79], v[56:59]
    ds_read_b64_tr_b16 a[74:75], v10 offset:18432
    v_mfma_f32_16x16x32_bf16 v[60:63], a[4:7], a[76:79], v[60:63]
    v_mfma_f32_16x16x32_bf16 v[120:123], a[8:11], a[76:79], v[120:123]
    ds_read_b128 a[48:51], v7 offset:8192
    v_mfma_f32_16x16x32_bf16 v[124:127], a[12:15], a[76:79], v[124:127]
    v_mfma_f32_16x16x32_bf16 v[184:187], a[16:19], a[76:79], v[184:187]
    buffer_load_dwordx4 v17, s[40:43], s49 offen offset:3072 lds
    v_mfma_f32_16x16x32_bf16 v[188:191], a[20:23], a[76:79], v[188:191]
    s_add_u32 s49, s49, 128
    v_mfma_f32_16x16x32_bf16 v[248:251], a[24:27], a[76:79], v[248:251]
    ds_read_b128 a[52:55], v7 offset:10240
    v_mfma_f32_16x16x32_bf16 v[252:255], a[28:31], a[76:79], v[252:255]
    ds_read_b64_tr_b16 a[76:77], v11 offset:16384
    s_waitcnt lgkmcnt(15)
    v_mfma_f32_16x16x32_bf16 v[64:67], a[0:3], a[80:83], v[64:67]
    ds_read_b64_tr_b16 a[78:79], v11 offset:18432
    v_mfma_f32_16x16x32_bf16 v[68:71], a[4:7], a[80:83], v[68:71]
    v_mfma_f32_16x16x32_bf16 v[128:131], a[8:11], a[80:83], v[128:131]
    ds_read_b128 a[56:59], v7 offset:12288
    v_mfma_f32_16x16x32_bf16 v[132:135], a[12:15], a[80:83], v[132:135]
    s_add_u32 m0, s61, 4096
    v_mfma_f32_16x16x32_bf16 v[192:195], a[16:19], a[80:83], v[192:195]
    buffer_load_dwordx4 v16, s[40:43], s50 offen offset:0 lds
    v_mfma_f32_16x16x32_bf16 v[196:199], a[20:23], a[80:83], v[196:199]
    v_mfma_f32_16x16x32_bf16 a[96:99], a[24:27], a[80:83], a[96:99]
    s_add_u32 s61, s61, 32768
    ds_read_b128 a[60:63], v7 offset:14336
    v_mfma_f32_16x16x32_bf16 a[100:103], a[28:31], a[80:83], a[100:103]
    s_cmp_ge_u32 s61, 98304
    s_cselect_b32 s90, 98304, 0
    ds_read_b64_tr_b16 a[80:81], v12 offset:16384
    v_mfma_f32_16x16x32_bf16 v[72:75], a[0:3], a[84:87], v[72:75]
    s_sub_u32 s61, s61, s90
    ds_read_b64_tr_b16 a[82:83], v12 offset:18432
    v_mfma_f32_16x16x32_bf16 v[76:79], a[4:7], a[84:87], v[76:79]
    s_add_u32 s64, s64, 32768
    v_mfma_f32_16x16x32_bf16 v[136:139], a[8:11], a[84:87], v[136:139]
    s_cmp_ge_u32 s64, 98304
    s_cselect_b32 s63, 4294901760, s59
    s_cselect_b32 s64, 0, s64
    v_mfma_f32_16x16x32_bf16 v[140:143], a[12:15], a[84:87], v[140:143]
    v_mfma_f32_16x16x32_bf16 v[200:203], a[16:19], a[84:87], v[200:203]
    buffer_load_dwordx4 v17, s[40:43], s50 offen offset:1024 lds
    v_mfma_f32_16x16x32_bf16 v[204:207], a[20:23], a[84:87], v[204:207]
    s_add_u32 s50, s50, 128
    v_mfma_f32_16x16x32_bf16 a[104:107], a[24:27], a[84:87], a[104:107]
    v_mfma_f32_16x16x32_bf16 a[108:111], a[28:31], a[84:87], a[108:111]
    ds_read_b64_tr_b16 a[84:85], v13 offset:16384
    v_mfma_f32_16x16x32_bf16 v[80:83], a[0:3], a[88:91], v[80:83]
    ds_read_b64_tr_b16 a[86:87], v13 offset:18432
    v_mfma_f32_16x16x32_bf16 v[84:87], a[4:7], a[88:91], v[84:87]
    v_mfma_f32_16x16x32_bf16 v[144:147], a[8:11], a[88:91], v[144:147]
    v_mfma_f32_16x16x32_bf16 v[148:151], a[12:15], a[88:91], v[148:151]
    v_mfma_f32_16x16x32_bf16 v[208:211], a[16:19], a[88:91], v[208:211]
    buffer_load_dwordx4 v16, s[40:43], s51 offen offset:2048 lds
    v_mfma_f32_16x16x32_bf16 v[212:215], a[20:23], a[88:91], v[212:215]
    v_mfma_f32_16x16x32_bf16 a[112:115], a[24:27], a[88:91], a[112:115]
    v_mfma_f32_16x16x32_bf16 a[116:119], a[28:31], a[88:91], a[116:119]
    ds_read_b64_tr_b16 a[88:89], v14 offset:16384
    s_waitcnt lgkmcnt(15)
    v_mfma_f32_16x16x32_bf16 v[88:91], a[0:3], a[92:95], v[88:91]
    ds_read_b64_tr_b16 a[90:91], v14 offset:18432
    v_mfma_f32_16x16x32_bf16 v[92:95], a[4:7], a[92:95], v[92:95]
    v_add_u32 v6, s63, v6
    v_add_u32 v7, s63, v7
    v_mfma_f32_16x16x32_bf16 v[152:155], a[8:11], a[92:95], v[152:155]
    v_mfma_f32_16x16x32_bf16 v[156:159], a[12:15], a[92:95], v[156:159]
    v_mfma_f32_16x16x32_bf16 v[216:219], a[16:19], a[92:95], v[216:219]
    buffer_load_dwordx4 v17, s[40:43], s51 offen offset:3072 lds
    v_mfma_f32_16x16x32_bf16 v[220:223], a[20:23], a[92:95], v[220:223]
    s_add_u32 s51, s51, 128
    v_mfma_f32_16x16x32_bf16 a[120:123], a[24:27], a[92:95], a[120:123]
    v_mfma_f32_16x16x32_bf16 a[124:127], a[28:31], a[92:95], a[124:127]
    ds_read_b64_tr_b16 a[92:93], v15 offset:16384
    ds_read_b64_tr_b16 a[94:95], v15 offset:18432
    v_mfma_f32_16x16x32_bf16 v[32:35], a[32:35], a[64:67], v[32:35]
    v_xor_b32 v8, s60, v8
    v_xor_b32 v9, s60, v9
    v_mfma_f32_16x16x32_bf16 v[36:39], a[36:39], a[64:67], v[36:39]
    v_xor_b32 v10, s60, v10
    v_xor_b32 v11, s60, v11
    s_waitcnt lgkmcnt(15)
    v_mfma_f32_16x16x32_bf16 v[96:99], a[40:43], a[64:67], v[96:99]
    v_xor_b32 v12, s60, v12
    v_xor_b32 v13, s60, v13
    v_mfma_f32_16x16x32_bf16 v[100:103], a[44:47], a[64:67], v[100:103]
    v_xor_b32 v14, s60, v14
    v_xor_b32 v15, s60, v15
    s_waitcnt lgkmcnt(13)
    v_mfma_f32_16x16x32_bf16 v[160:163], a[48:51], a[64:67], v[160:163]
    s_waitcnt lgkmcnt(12)
    v_mfma_f32_16x16x32_bf16 v[164:167], a[52:55], a[64:67], v[164:167]
    s_waitcnt lgkmcnt(9)
    v_mfma_f32_16x16x32_bf16 v[224:227], a[56:59], a[64:67], v[224:227]
    s_waitcnt vmcnt(8) lgkmcnt(0)
    v_mfma_f32_16x16x32_bf16 v[228:231], a[60:63], a[64:67], v[228:231]
    s_barrier
    ds_read_b64_tr_b16 a[64:65], v8 offset:0
    v_mfma_f32_16x16x32_bf16 v[40:43], a[32:35], a[68:71], v[40:43]
    s_add_u32 m0, s62, 0
    ds_read_b64_tr_b16 a[66:67], v8 offset:2048
    v_mfma_f32_16x16x32_bf16 v[44:47], a[36:39], a[68:71], v[44:47]
    buffer_load_dwordx4 v18, s[44:47], s52 offen offset:0 lds
    v_mfma_f32_16x16x32_bf16 v[104:107], a[40:43], a[68:71], v[104:107]
    ds_read_b128 a[0:3], v6 offset:0
    v_mfma_f32_16x16x32_bf16 v[108:111], a[44:47], a[68:71], v[108:111]
    v_mfma_f32_16x16x32_bf16 v[168:171], a[48:51], a[68:71], v[168:171]
    v_mfma_f32_16x16x32_bf16 v[172:175], a[52:55], a[68:71], v[172:175]
    buffer_load_dwordx4 v19, s[44:47], s52 offen offset:1024 lds
    v_mfma_f32_16x16x32_bf16 v[232:235], a[56:59], a[68:71], v[232:235]
    s_add_u32 s52, s52, s56
    ds_read_b128 a[4:7], v6 offset:2048
    v_mfma_f32_16x16x32_bf16 v[236:239], a[60:63], a[68:71], v[236:239]
    ds_read_b64_tr_b16 a[68:69], v9 offset:0
    v_mfma_f32_16x16x32_bf16 v[48:51], a[32:35], a[72:75], v[48:51]
    ds_read_b64_tr_b16 a[70:71], v9 offset:2048
    v_mfma_f32_16x16x32_bf16 v[52:55], a[36:39], a[72:75], v[52:55]
    buffer_load_dwordx4 v18, s[44:47], s53 offen offset:2048 lds
    v_mfma_f32_16x16x32_bf16 v[112:115], a[40:43], a[72:75], v[112:115]
    ds_read_b128 a[8:11], v6 offset:4096
    v_mfma_f32_16x16x32_bf16 v[116:119], a[44:47], a[72:75], v[116:119]
    v_mfma_f32_16x16x32_bf16 v[176:179], a[48:51], a[72:75], v[176:179]
    v_mfma_f32_16x16x32_bf16 v[180:183], a[52:55], a[72:75], v[180:183]
    buffer_load_dwordx4 v19, s[44:47], s53 offen offset:3072 lds
    v_mfma_f32_16x16x32_bf16 v[240:243], a[56:59], a[72:75], v[240:243]
    s_add_u32 s53, s53, s56
    ds_read_b128 a[12:15], v6 offset:6144
    v_mfma_f32_16x16x32_bf16 v[244:247], a[60:63], a[72:75], v[244:247]
    ds_read_b64_tr_b16 a[72:73], v10 offset:0
    v_mfma_f32_16x16x32_bf16 v[56:59], a[32:35], a[76:79], v[56:59]
    s_add_u32 m0, s62, 4096
    ds_read_b64_tr_b16 a[74:75], v10 offset:2048
    v_mfma_f32_16x16x32_bf16 v[60:63], a[36:39], a[76:79], v[60:63]
    buffer_load_dwordx4 v20, s[44:47], s54 offen offset:0 lds
    v_mfma_f32_16x16x32_bf16 v[120:123], a[40:43], a[76:79], v[120:123]
    ds_read_b128 a[16:19], v6 offset:8192
    v_mfma_f32_16x16x32_bf16 v[124:127], a[44:47], a[76:79], v[124:127]
    s_xor_b32 s62, s62, 229376
    v_mfma_f32_16x16x32_bf16 v[184:187], a[48:51], a[76:79], v[184:187]
    v_mfma_f32_16x16x32_bf16 v[188:191], a[52:55], a[76:79], v[188:191]
    buffer_load_dwordx4 v21, s[44:47], s54 offen offset:1024 lds
    v_mfma_f32_16x16x32_bf16 v[248:251], a[56:59], a[76:79], v[248:251]
    s_add_u32 s54, s54, s56
    ds_read_b128 a[20:23], v6 offset:10240
    v_mfma_f32_16x16x32_bf16 v[252:255], a[60:63], a[76:79], v[252:255]
    ds_read_b64_tr_b16 a[76:77], v11 offset:0
    v_mfma_f32_16x16x32_bf16 v[64:67], a[32:35], a[80:83], v[64:67]
    ds_read_b64_tr_b16 a[78:79], v11 offset:2048
    v_mfma_f32_16x16x32_bf16 v[68:71], a[36:39], a[80:83], v[68:71]
    buffer_load_dwordx4 v20, s[44:47], s55 offen offset:2048 lds
    v_mfma_f32_16x16x32_bf16 v[128:131], a[40:43], a[80:83], v[128:131]
    ds_read_b128 a[24:27], v6 offset:12288
    v_mfma_f32_16x16x32_bf16 v[132:135], a[44:47], a[80:83], v[132:135]
    v_mfma_f32_16x16x32_bf16 v[192:195], a[48:51], a[80:83], v[192:195]
    v_mfma_f32_16x16x32_bf16 v[196:199], a[52:55], a[80:83], v[196:199]
    buffer_load_dwordx4 v21, s[44:47], s55 offen offset:3072 lds
    v_mfma_f32_16x16x32_bf16 a[96:99], a[56:59], a[80:83], a[96:99]
    s_add_u32 s55, s55, s56
    ds_read_b128 a[28:31], v6 offset:14336
    v_mfma_f32_16x16x32_bf16 a[100:103], a[60:63], a[80:83], a[100:103]
    ds_read_b64_tr_b16 a[80:81], v12 offset:0
    v_mfma_f32_16x16x32_bf16 v[72:75], a[32:35], a[84:87], v[72:75]
    ds_read_b64_tr_b16 a[82:83], v12 offset:2048
    v_mfma_f32_16x16x32_bf16 v[76:79], a[36:39], a[84:87], v[76:79]
    v_mfma_f32_16x16x32_bf16 v[136:139], a[40:43], a[84:87], v[136:139]
    v_mfma_f32_16x16x32_bf16 v[140:143], a[44:47], a[84:87], v[140:143]
    v_mfma_f32_16x16x32_bf16 v[200:203], a[48:51], a[84:87], v[200:203]
    v_mfma_f32_16x16x32_bf16 v[204:207], a[52:55], a[84:87], v[204:207]
    v_mfma_f32_16x16x32_bf16 a[104:107], a[56:59], a[84:87], a[104:107]
    v_mfma_f32_16x16x32_bf16 a[108:111], a[60:63], a[84:87], a[108:111]
    ds_read_b64_tr_b16 a[84:85], v13 offset:0
    v_mfma_f32_16x16x32_bf16 v[80:83], a[32:35], a[88:91], v[80:83]
    ds_read_b64_tr_b16 a[86:87], v13 offset:2048
    v_mfma_f32_16x16x32_bf16 v[84:87], a[36:39], a[88:91], v[84:87]
    v_mfma_f32_16x16x32_bf16 v[144:147], a[40:43], a[88:91], v[144:147]
    v_mfma_f32_16x16x32_bf16 v[148:151], a[44:47], a[88:91], v[148:151]
    v_mfma_f32_16x16x32_bf16 v[208:211], a[48:51], a[88:91], v[208:211]
    v_mfma_f32_16x16x32_bf16 v[212:215], a[52:55], a[88:91], v[212:215]
    v_mfma_f32_16x16x32_bf16 a[112:115], a[56:59], a[88:91], a[112:115]
    v_mfma_f32_16x16x32_bf16 a[116:119], a[60:63], a[88:91], a[116:119]
    ds_read_b64_tr_b16 a[88:89], v14 offset:0
    v_mfma_f32_16x16x32_bf16 v[88:91], a[32:35], a[92:95], v[88:91]
    ds_read_b64_tr_b16 a[90:91], v14 offset:2048
    v_mfma_f32_16x16x32_bf16 v[92:95], a[36:39], a[92:95], v[92:95]
    v_mfma_f32_16x16x32_bf16 v[152:155], a[40:43], a[92:95], v[152:155]
    v_mfma_f32_16x16x32_bf16 v[156:159], a[44:47], a[92:95], v[156:159]
    v_mfma_f32_16x16x32_bf16 v[216:219], a[48:51], a[92:95], v[216:219]
    s_sub_u32 s65, s65, 1
    v_mfma_f32_16x16x32_bf16 v[220:223], a[52:55], a[92:95], v[220:223]
    v_mfma_f32_16x16x32_bf16 a[120:123], a[56:59], a[92:95], a[120:123]
    s_cmp_gt_u32 s65, s67
    v_mfma_f32_16x16x32_bf16 a[124:127], a[60:63], a[92:95], a[124:127]
    ds_read_b64_tr_b16 a[92:93], v15 offset:0
    ds_read_b64_tr_b16 a[94:95], v15 offset:2048
    s_cbranch_scc1 mega_kernel_loop19
    s_cmp_lg_u32 s65, 0
    s_cbranch_scc1 mega_kernel_dosw20
mega_kernel_epi11:
    s_cmp_eq_u32 s94, 0
    s_cbranch_scc1 mega_kernel_last23
    s_mov_b32 s3, 1048576
mega_kernel_spin27:
    v_readfirstlane_b32 s4, v4
    v_readfirstlane_b32 s5, v5
    s_nop 3
    s_cmp_lg_u32 s4, 0
    s_cbranch_scc1 mega_kernel_ok28
    s_sub_u32 s3, s3, 1
    s_cbranch_scc1 mega_kernel_ok28
    s_sleep 32
    buffer_load_dwordx2 v[4:5], off, s[12:15], 0 sc1
    s_waitcnt vmcnt(0)
    s_branch mega_kernel_spin27
mega_kernel_ok28:
    s_cmp_ge_u32 s68, 16
    s_cbranch_scc1 mega_kernel_q030
    s_call_b64 s[20:21], mega_kernel_epf21
    s_mov_b32 s17, s101
    s_mov_b32 s66, 2
    s_branch mega_kernel_q129
mega_kernel_q030:
    s_call_b64 s[20:21], mega_kernel_eps22
    s_mov_b32 s17, s101
    s_mov_b32 s28, s98
    s_mov_b32 s29, s98
    s_mov_b32 s30, s99
    s_mov_b32 s31, s100
    s_mov_b32 s26, 268435456
mega_kernel_q129:
    s_mov_b32 s95, s82
    s_mov_b32 s96, s83
    s_mov_b32 s97, s84
    s_mov_b32 s98, s85
    s_mov_b32 s99, s86
    s_mov_b32 s100, s87
    s_mov_b32 s101, s88
    s_sub_u32 s67, s95, 5
    s_mov_b32 s94, 0
    s_branch mega_kernel_tile10
mega_kernel_last23:
    s_cmp_eq_u32 s70, 0
    s_cbranch_scc1 mega_kernel_kvl26
    buffer_load_dwordx2 v[4:5], off, s[12:15], 0 sc1
    s_call_b64 s[20:21], mega_kernel_epf21
    s_waitcnt vmcnt(0)
    s_barrier
    s_mov_b32 s3, 1048576
mega_kernel_spin31:
    v_readfirstlane_b32 s4, v4
    v_readfirstlane_b32 s5, v5
    s_nop 3
    s_cmp_lg_u32 s4, 0
    s_cbranch_scc1 mega_kernel_ok32
    s_sub_u32 s3, s3, 1
    s_cbranch_scc1 mega_kernel_ok32
    s_sleep 32
    buffer_load_dwordx2 v[4:5], off, s[12:15], 0 sc1
    s_waitcnt vmcnt(0)
    s_branch mega_kernel_spin31
mega_kernel_ok32:
    s_cmp_lg_u32 s16, 0
    s_cbranch_scc1 mega_kernel_np33
    v_mov_b32 v4, s4
    v_mov_b32 v5, s5
    s_add_u32 s90, s101, 117440512
    s_mov_b64 exec, 1
    buffer_store_dwordx2 v[4:5], off, s[8:11], s90 sc1
    s_mov_b64 exec, -1
mega_kernel_np33:
    s_cmp_lg_u32 s16, 0
    s_cbranch_scc1 mega_kernel_pw34
    s_and_b32 s92, s2, 7
    s_lshl_b32 s92, s92, 2
    s_bfe_u32 s93, s2, 0x20003
    s_add_u32 s92, s92, s93
    s_lshr_b32 s93, s2, 5
    s_lshl_b32 s93, s93, 2
    s_or_b32 s93, s93, 0x40000
    s_lshr_b32 s90, s92, 1
    s_lshl_b32 s90, s90, 7
    s_add_u32 s90, s90, 117440512
    s_bfe_u32 s91, 1376806003, s93
    s_lshr_b32 s91, s91, 1
    v_mov_b32 v0, s91
    v_add_u32 v4, 8, v1
    v_cmp_gt_u32 vcc, 8, v1
    s_nop 1
    v_cndmask_b32 v0, v0, v4, vcc
    s_bfe_u32 s91, 4242446987, s93
    s_lshr_b32 s91, s91, 1
    v_writelane_b32 v0, s91, 8
    v_lshlrev_b32 v0, 3, v0
    buffer_load_dwordx2 v[4:5], v0, s[8:11], s90 offen sc1
    s_waitcnt vmcnt(0)
    s_mov_b32 s3, 1048576
mega_kernel_spin35:
    v_cmp_ne_u64 s[22:23], s[4:5], v[4:5]
    s_nop 3
    s_cmp_eq_u64 s[22:23], 0
    s_cbranch_scc1 mega_kernel_ok36
    s_sub_u32 s3, s3, 1
    s_cbranch_scc1 mega_kernel_ok36
    s_sleep 16
    s_and_b32 s92, s2, 7
    s_lshl_b32 s92, s92, 2
    s_bfe_u32 s93, s2, 0x20003
    s_add_u32 s92, s92, s93
    s_lshr_b32 s93, s2, 5
    s_lshl_b32 s93, s93, 2
    s_or_b32 s93, s93, 0x40000
    s_lshr_b32 s90, s92, 1
    s_lshl_b32 s90, s90, 7
    s_add_u32 s90, s90, 117440512
    s_bfe_u32 s91, 1376806003, s93
    s_lshr_b32 s91, s91, 1
    v_mov_b32 v0, s91
    v_add_u32 v4, 8, v1
    v_cmp_gt_u32 vcc, 8, v1
    s_nop 1
    v_cndmask_b32 v0, v0, v4, vcc
    s_bfe_u32 s91, 4242446987, s93
    s_lshr_b32 s91, s91, 1
    v_writelane_b32 v0, s91, 8
    v_lshlrev_b32 v0, 3, v0
    buffer_load_dwordx2 v[4:5], v0, s[8:11], s90 offen sc1
    s_waitcnt vmcnt(0)
    s_branch mega_kernel_spin35
mega_kernel_ok36:
mega_kernel_pw34:
    s_barrier
    s_and_b32 s92, s2, 7
    s_lshl_b32 s92, s92, 2
    s_bfe_u32 s93, s2, 0x20003
    s_add_u32 s92, s92, s93
    s_lshr_b32 s93, s2, 5
    s_lshl_b32 s93, s93, 2
    s_or_b32 s93, s93, 0x40000
    s_bfe_u32 s90, 4242446987, s93
    s_lshl_b32 s90, s90, 3
    s_lshl_b32 s91, s16, 1
    s_add_u32 s90, s90, s91
    s_lshl_b32 s90, s90, 12
    s_lshl_b32 s91, s92, 19
    s_add_u32 s90, s90, s91
    s_add_u32 s90, s90, 0
    buffer_load_dwordx4 a[128:131], v2, s[8:11], s90 offen offset:0 sc1
    buffer_load_dwordx4 a[132:135], v2, s[8:11], s90 offen offset:1024 sc1
    buffer_load_dwordx4 a[136:139], v2, s[8:11], s90 offen offset:2048 sc1
    buffer_load_dwordx4 a[140:143], v2, s[8:11], s90 offen offset:3072 sc1
    s_bfe_u32 s90, 4242446987, s93
    s_lshl_b32 s90, s90, 3
    s_lshl_b32 s91, s16, 1
    s_add_u32 s90, s90, s91
    s_lshl_b32 s90, s90, 12
    s_lshl_b32 s91, s92, 19
    s_add_u32 s90, s90, s91
    s_add_u32 s90, s90, 4096
    buffer_load_dwordx4 a[144:147], v2, s[8:11], s90 offen offset:0 sc1
    buffer_load_dwordx4 a[148:151], v2, s[8:11], s90 offen offset:1024 sc1
    buffer_load_dwordx4 a[152:155], v2, s[8:11], s90 offen offset:2048 sc1
    buffer_load_dwordx4 a[156:159], v2, s[8:11], s90 offen offset:3072 sc1
    s_bfe_u32 s90, 1376806003, s93
    s_lshl_b32 s90, s90, 3
    s_lshl_b32 s91, s16, 1
    s_add_u32 s90, s90, s91
    s_lshl_b32 s90, s90, 12
    s_lshl_b32 s91, s92, 19
    s_add_u32 s90, s90, s91
    s_add_u32 s90, s90, 0
    buffer_load_dwordx4 a[160:163], v2, s[8:11], s90 offen offset:0 sc1
    buffer_load_dwordx4 a[164:167], v2, s[8:11], s90 offen offset:1024 sc1
    buffer_load_dwordx4 a[168:171], v2, s[8:11], s90 offen offset:2048 sc1
    buffer_load_dwordx4 a[172:175], v2, s[8:11], s90 offen offset:3072 sc1
    s_bfe_u32 s90, 1376806003, s93
    s_lshl_b32 s90, s90, 3
    s_lshl_b32 s91, s16, 1
    s_add_u32 s90, s90, s91
    s_lshl_b32 s90, s90, 12
    s_lshl_b32 s91, s92, 19
    s_add_u32 s90, s90, s91
    s_add_u32 s90, s90, 4096
    buffer_load_dwordx4 a[176:179], v2, s[8:11], s90 offen offset:0 sc1
    buffer_load_dwordx4 a[180:183], v2, s[8:11], s90 offen offset:1024 sc1
    buffer_load_dwordx4 a[184:187], v2, s[8:11], s90 offen offset:2048 sc1
    buffer_load_dwordx4 a[188:191], v2, s[8:11], s90 offen offset:3072 sc1
    s_mov_b32 s94, 1
mega_kernel_kvl26:
    s_waitcnt lgkmcnt(0)
    s_barrier
    s_and_b32 s92, s2, 7
    s_lshl_b32 s92, s92, 2
    s_bfe_u32 s93, s2, 0x20003
    s_add_u32 s92, s92, s93
    s_lshr_b32 s93, s2, 5
    s_lshl_b32 s93, s93, 2
    s_or_b32 s93, s93, 0x40000
    s_mov_b32 s32, s92
    s_bfe_u32 s33, 4242446987, s93
    s_add_u32 s33, s33, 1
    s_bfe_u32 s34, 1376806003, s93
    s_add_u32 s34, s34, 1
    s_lshl_b32 s57, s16, 12
    v_add_u32 v7, s57, v2
    s_lshl_b32 s90, s34, 2
    s_lshl_b32 s91, s33, 2
    s_lshl_b32 s26, s91, 13
    s_mov_b32 s30, s26
    s_sub_u32 s63, s90, 4
    s_add_u32 s63, s63, s16
    s_add_u32 s64, s63, 1
    s_mov_b32 s65, s90
    s_sub_u32 s66, s91, 4
    s_add_u32 s66, s66, s16
    s_add_u32 s67, s66, 1
    s_mov_b32 s68, s91
    s_mov_b32 s27, 0x20000
    s_mov_b32 s31, 0x20000
    s_lshl_b32 s78, s32, 19
    s_add_u32 s90, s78, 16777216
    s_add_u32 s24, s6, s90
    s_addc_u32 s25, s7, 0
    s_add_u32 s90, s78, 33554432
    s_add_u32 s28, s6, s90
    s_addc_u32 s29, s7, 0
    s_cmp_eq_u32 s94, 1
    s_cbranch_scc1 mega_kernel_w063
    s_mov_b32 s53, 32768
    s_mov_b32 s54, 16384
    s_add_u32 s56, s57, 65536
    s_mov_b32 m0, s56
    s_nop 0
    buffer_load_dwordx4 v7, s[24:27], s53 offen offset:0 sc1 lds
    buffer_load_dwordx4 v7, s[24:27], s53 offen offset:1024 sc1 lds
    buffer_load_dwordx4 v7, s[24:27], s53 offen offset:2048 sc1 lds
    buffer_load_dwordx4 v7, s[24:27], s53 offen offset:3072 sc1 lds
    s_add_u32 s53, s53, 16384
    s_add_u32 m0, s56, 16384
    s_nop 0
    buffer_load_dwordx4 v7, s[28:31], s54 offen offset:0 sc1 lds
    buffer_load_dwordx4 v7, s[28:31], s54 offen offset:1024 sc1 lds
    buffer_load_dwordx4 v7, s[28:31], s54 offen offset:2048 sc1 lds
    buffer_load_dwordx4 v7, s[28:31], s54 offen offset:3072 sc1 lds
    s_add_u32 s54, s54, 16384
    s_call_b64 s[20:21], mega_kernel_epl61
    s_mov_b32 s17, s101
    s_mov_b32 s38, 268435456
    s_branch mega_kernel_init25
mega_kernel_w063:
    s_mov_b32 s53, 0
    s_mov_b32 s54, 0
    s_mov_b32 m0, s57
    s_nop 0
    buffer_load_dwordx4 v7, s[24:27], s53 offen offset:0 sc1 lds
    buffer_load_dwordx4 v7, s[24:27], s53 offen offset:1024 sc1 lds
    buffer_load_dwordx4 v7, s[24:27], s53 offen offset:2048 sc1 lds
    buffer_load_dwordx4 v7, s[24:27], s53 offen offset:3072 sc1 lds
    s_mov_b32 s53, 16384
    s_add_u32 s56, s57, 32768
    s_mov_b32 m0, s56
    s_nop 0
    buffer_load_dwordx4 v7, s[24:27], s53 offen offset:0 sc1 lds
    buffer_load_dwordx4 v7, s[24:27], s53 offen offset:1024 sc1 lds
    buffer_load_dwordx4 v7, s[24:27], s53 offen offset:2048 sc1 lds
    buffer_load_dwordx4 v7, s[24:27], s53 offen offset:3072 sc1 lds
    s_add_u32 s53, s53, 16384
    s_add_u32 m0, s56, 16384
    s_nop 0
    buffer_load_dwordx4 v7, s[28:31], s54 offen offset:0 sc1 lds
    buffer_load_dwordx4 v7, s[28:31], s54 offen offset:1024 sc1 lds
    buffer_load_dwordx4 v7, s[28:31], s54 offen offset:2048 sc1 lds
    buffer_load_dwordx4 v7, s[28:31], s54 offen offset:3072 sc1 lds
    s_add_u32 s54, s54, 16384
    s_add_u32 s56, s56, 32768
    s_mov_b32 m0, s56
    s_nop 0
    buffer_load_dwordx4 v7, s[24:27], s53 offen offset:0 sc1 lds
    buffer_load_dwordx4 v7, s[24:27], s53 offen offset:1024 sc1 lds
    buffer_load_dwordx4 v7, s[24:27], s53 offen offset:2048 sc1 lds
    buffer_load_dwordx4 v7, s[24:27], s53 offen offset:3072 sc1 lds
    s_add_u32 s53, s53, 16384
    s_add_u32 m0, s56, 16384
    s_nop 0
    buffer_load_dwordx4 v7, s[28:31], s54 offen offset:0 sc1 lds
    buffer_load_dwordx4 v7, s[28:31], s54 offen offset:1024 sc1 lds
    buffer_load_dwordx4 v7, s[28:31], s54 offen offset:2048 sc1 lds
    buffer_load_dwordx4 v7, s[28:31], s54 offen offset:3072 sc1 lds
    s_add_u32 s54, s54, 16384
    s_add_u32 s56, s56, 32768
    s_mov_b32 m0, s56
    s_nop 0
    buffer_load_dwordx4 v7, s[24:27], s53 offen offset:0 sc1 lds
    buffer_load_dwordx4 v7, s[24:27], s53 offen offset:1024 sc1 lds
    buffer_load_dwordx4 v7, s[24:27], s53 offen offset:2048 sc1 lds
    buffer_load_dwordx4 v7, s[24:27], s53 offen offset:3072 sc1 lds
    s_add_u32 s53, s53, 16384
    s_add_u32 m0, s56, 16384
    s_nop 0
    buffer_load_dwordx4 v7, s[28:31], s54 offen offset:0 sc1 lds
    buffer_load_dwordx4 v7, s[28:31], s54 offen offset:1024 sc1 lds
    buffer_load_dwordx4 v7, s[28:31], s54 offen offset:2048 sc1 lds
    buffer_load_dwordx4 v7, s[28:31], s54 offen offset:3072 sc1 lds
    s_add_u32 s54, s54, 16384
    s_add_u32 s56, s56, 32768
    s_waitcnt vmcnt(0)
    s_mov_b32 s38, 0
mega_kernel_init25:
    s_mov_b32 s53, 65536
    s_mov_b32 s54, 49152
    s_nop 1
    v_mov_b32 v9, 0xff800000
    s_mov_b32 s61, 1233125376
    s_lshl_b32 s91, s16, 1
    s_sub_u32 s91, s91, 8
    s_lshl_b32 s74, s33, 3
    s_add_u32 s74, s74, s91
    s_lshl_b32 s75, s34, 3
    s_add_u32 s75, s75, s91
    s_mov_b32 s36, s6
    s_mov_b32 s37, s7
    s_mov_b32 s39, 0x20000
    s_load_dwordx2 s[48:49], s[0:1], 64
    s_load_dwordx2 s[50:51], s[0:1], 16
    s_mov_b32 s47, 0x20000
    s_lshl_b32 s90, s99, 1
    s_add_u32 s98, s98, s90
    s_lshl_b32 s90, s100, 2
    s_add_u32 s40, s98, s90
    s_lshr_b32 s90, s32, 1
    s_lshl_b32 s90, s90, 7
    s_add_u32 s90, s90, 117444608
    s_lshr_b32 s91, s2, 6
    s_lshl_b32 s91, s91, 8
    s_add_u32 s91, s91, 117446592
    v_min_u32 v10, 31, v1
    v_lshlrev_b32 v10, 3, v10
    v_mov_b32 v11, s90
    v_mov_b32 v8, s91
    v_cmp_gt_u32 vcc, 8, v1
    s_nop 1
    v_cndmask_b32 v11, v8, v11, vcc
    v_add_u32 v10, v10, v11
    s_lshl_b32 s90, s16, 8
    s_add_u32 s90, s90, s2
    s_cmp_ge_u32 s90, 128
    s_cbranch_scc1 mega_kernel_c364
    s_lshl_b32 s90, s90, 7
    s_add_u32 s90, s90, 117506048
    v_mov_b32 v8, 0
    s_mov_b64 exec, 1
    buffer_store_dword v8, off, s[8:11], s90 sc1
    s_mov_b64 exec, -1
mega_kernel_c364:
    s_mov_b32 s55, 0
    v_mov_b32 v6, v2
    v_accvgpr_write_b32 a0, 0
    v_accvgpr_write_b32 a1, 0
    v_accvgpr_write_b32 a2, 0
    v_accvgpr_write_b32 a3, 0
    v_accvgpr_write_b32 a4, 0
    v_accvgpr_write_b32 a5, 0
    v_accvgpr_write_b32 a6, 0
    v_accvgpr_write_b32 a7, 0
    v_accvgpr_write_b32 a8, 0
    v_accvgpr_write_b32 a9, 0
    v_accvgpr_write_b32 a10, 0
    v_accvgpr_write_b32 a11, 0
    v_accvgpr_write_b32 a12, 0
    v_accvgpr_write_b32 a13, 0
    v_accvgpr_write_b32 a14, 0
    v_accvgpr_write_b32 a15, 0
    v_accvgpr_write_b32 a16, 0
    v_accvgpr_write_b32 a17, 0
    v_accvgpr_write_b32 a18, 0
    v_accvgpr_write_b32 a19, 0
    v_accvgpr_write_b32 a20, 0
    v_accvgpr_write_b32 a21, 0
    v_accvgpr_write_b32 a22, 0
    v_accvgpr_write_b32 a23, 0
    v_accvgpr_write_b32 a24, 0
    v_accvgpr_write_b32 a25, 0
    v_accvgpr_write_b32 a26, 0
    v_accvgpr_write_b32 a27, 0
    v_accvgpr_write_b32 a28, 0
    v_accvgpr_write_b32 a29, 0
    v_accvgpr_write_b32 a30, 0
    v_accvgpr_write_b32 a31, 0
    v_accvgpr_write_b32 a32, 0
    v_accvgpr_write_b32 a33, 0
    v_accvgpr_write_b32 a34, 0
    v_accvgpr_write_b32 a35, 0
    v_accvgpr_write_b32 a36, 0
    v_accvgpr_write_b32 a37, 0
    v_accvgpr_write_b32 a38, 0
    v_accvgpr_write_b32 a39, 0
    v_accvgpr_write_b32 a40, 0
    v_accvgpr_write_b32 a41, 0
    v_accvgpr_write_b32 a42, 0
    v_accvgpr_write_b32 a43, 0
    v_accvgpr_write_b32 a44, 0
    v_accvgpr_write_b32 a45, 0
    v_accvgpr_write_b32 a46, 0
    v_accvgpr_write_b32 a47, 0
    v_accvgpr_write_b32 a48, 0
    v_accvgpr_write_b32 a49, 0
    v_accvgpr_write_b32 a50, 0
    v_accvgpr_write_b32 a51, 0
    v_accvgpr_write_b32 a52, 0
    v_accvgpr_write_b32 a53, 0
    v_accvgpr_write_b32 a54, 0
    v_accvgpr_write_b32 a55, 0
    v_accvgpr_write_b32 a56, 0
    v_accvgpr_write_b32 a57, 0
    v_accvgpr_write_b32 a58, 0
    v_accvgpr_write_b32 a59, 0
    v_accvgpr_write_b32 a60, 0
    v_accvgpr_write_b32 a61, 0
    v_accvgpr_write_b32 a62, 0
    v_accvgpr_write_b32 a63, 0
    v_accvgpr_write_b32 a64, 0
    v_accvgpr_write_b32 a65, 0
    v_accvgpr_write_b32 a66, 0
    v_accvgpr_write_b32 a67, 0
    v_accvgpr_write_b32 a68, 0
    v_accvgpr_write_b32 a69, 0
    v_accvgpr_write_b32 a70, 0
    v_accvgpr_write_b32 a71, 0
    v_accvgpr_write_b32 a72, 0
    v_accvgpr_write_b32 a73, 0
    v_accvgpr_write_b32 a74, 0
    v_accvgpr_write_b32 a75, 0
    v_accvgpr_write_b32 a76, 0
    v_accvgpr_write_b32 a77, 0
    v_accvgpr_write_b32 a78, 0
    v_accvgpr_write_b32 a79, 0
    v_accvgpr_write_b32 a80, 0
    v_accvgpr_write_b32 a81, 0
    v_accvgpr_write_b32 a82, 0
    v_accvgpr_write_b32 a83, 0
    v_accvgpr_write_b32 a84, 0
    v_accvgpr_write_b32 a85, 0
    v_accvgpr_write_b32 a86, 0
    v_accvgpr_write_b32 a87, 0
    v_accvgpr_write_b32 a88, 0
    v_accvgpr_write_b32 a89, 0
    v_accvgpr_write_b32 a90, 0
    v_accvgpr_write_b32 a91, 0
    v_accvgpr_write_b32 a92, 0
    v_accvgpr_write_b32 a93, 0
    v_accvgpr_write_b32 a94, 0
    v_accvgpr_write_b32 a95, 0
    v_accvgpr_write_b32 a96, 0
    v_accvgpr_write_b32 a97, 0
    v_accvgpr_write_b32 a98, 0
    v_accvgpr_write_b32 a99, 0
    v_accvgpr_write_b32 a100, 0
    v_accvgpr_write_b32 a101, 0
    v_accvgpr_write_b32 a102, 0
    v_accvgpr_write_b32 a103, 0
    v_accvgpr_write_b32 a104, 0
    v_accvgpr_write_b32 a105, 0
    v_accvgpr_write_b32 a106, 0
    v_accvgpr_write_b32 a107, 0
    v_accvgpr_write_b32 a108, 0
    v_accvgpr_write_b32 a109, 0
    v_accvgpr_write_b32 a110, 0
    v_accvgpr_write_b32 a111, 0
    v_accvgpr_write_b32 a112, 0
    v_accvgpr_write_b32 a113, 0
    v_accvgpr_write_b32 a114, 0
    v_accvgpr_write_b32 a115, 0
    v_accvgpr_write_b32 a116, 0
    v_accvgpr_write_b32 a117, 0
    v_accvgpr_write_b32 a118, 0
    v_accvgpr_write_b32 a119, 0
    v_accvgpr_write_b32 a120, 0
    v_accvgpr_write_b32 a121, 0
    v_accvgpr_write_b32 a122, 0
    v_accvgpr_write_b32 a123, 0
    v_accvgpr_write_b32 a124, 0
    v_accvgpr_write_b32 a125, 0
    v_accvgpr_write_b32 a126, 0
    v_accvgpr_write_b32 a127, 0
    v_mov_b32 v160, 0
    v_mov_b32 v161, 0
    v_mov_b32 v162, 0
    v_mov_b32 v163, 0
    v_mov_b32 v164, 0
    v_mov_b32 v165, 0
    v_mov_b32 v166, 0
    v_mov_b32 v167, 0
    v_mov_b32 v168, 0
    v_mov_b32 v169, 0
    v_mov_b32 v170, 0
    v_mov_b32 v171, 0
    v_mov_b32 v172, 0
    v_mov_b32 v173, 0
    v_mov_b32 v174, 0
    v_mov_b32 v175, 0
    v_mov_b32 v176, 0
    v_mov_b32 v177, 0
    v_mov_b32 v178, 0
    v_mov_b32 v179, 0
    v_mov_b32 v180, 0
    v_mov_b32 v181, 0
    v_mov_b32 v182, 0
    v_mov_b32 v183, 0
    v_mov_b32 v184, 0
    v_mov_b32 v185, 0
    v_mov_b32 v186, 0
    v_mov_b32 v187, 0
    v_mov_b32 v188, 0
    v_mov_b32 v189, 0
    v_mov_b32 v190, 0
    v_mov_b32 v191, 0
    v_mov_b32 v12, 0
    v_mov_b32 v28, 0
    v_mov_b32 v44, 0x3f803f80
    v_mov_b32 v13, 0
    v_mov_b32 v32, 0
    v_mov_b32 v45, 0x3f803f80
    v_mov_b32 v14, 0
    v_mov_b32 v36, 0
    v_mov_b32 v46, 0x3f803f80
    v_mov_b32 v15, 0
    v_mov_b32 v40, 0
    v_mov_b32 v47, 0x3f803f80
    s_and_b32 s90, s2, 7
    s_lshl_b32 s90, s90, 4
    s_lshl_b32 s91, s16, 2
    s_add_u32 s76, s90, s91
    s_lshr_b32 s92, s2, 3
    s_lshl_b32 s92, s92, 17
    s_lshl_b32 s90, s76, 10
    s_add_u32 s90, s90, s92
    s_add_u32 s79, s90, 50331648
    s_add_u32 s80, s90, 54525952
    s_and_b32 s77, s76, 63
    s_cmp_eq_u32 s77, 0
    s_cselect_b32 s93, 0, 1024
    s_sub_u32 s81, s80, s93
    s_lshl_b32 s90, s76, 9
    s_add_u32 s90, s90, s92
    s_add_u32 s82, s90, 58720256
    s_sub_u32 s83, s82, s93
    s_add_u32 s84, s82, 65536
    s_add_u32 s85, s83, 65536
    v_and_b32 v48, 15, v1
    v_lshrrev_b32 v49, 4, v1
    v_lshlrev_b32 v49, 2, v49
    v_sub_u32 v48, v48, v49
    v_cmp_le_i32 vcc, 0, v48
    s_nop 1
    v_cndmask_b32 v16, v9, 0, vcc
    v_cmp_le_i32 vcc, 1, v48
    s_nop 1
    v_cndmask_b32 v17, v9, 0, vcc
    v_cmp_le_i32 vcc, 2, v48
    s_nop 1
    v_cndmask_b32 v18, v9, 0, vcc
    v_cmp_le_i32 vcc, 3, v48
    s_nop 1
    v_cndmask_b32 v19, v9, 0, vcc
    s_mov_b32 s58, 35651616
    s_mov_b32 s59, 0
    s_sub_u32 s90, s63, 1
    s_bitset1_b64 s[58:59], s90
    s_sub_u32 s90, s64, 1
    s_bitset1_b64 s[58:59], s90
    s_sub_u32 s90, s65, 1
    s_bitset1_b64 s[58:59], s90
    s_sub_u32 s90, s66, 1
    s_bitset1_b64 s[58:59], s90
    s_sub_u32 s90, s67, 1
    s_bitset1_b64 s[58:59], s90
    s_sub_u32 s90, s68, 1
    s_bitset1_b64 s[58:59], s90
    s_sub_u32 s52, s68, 6
    s_sub_u32 s90, s52, 1
    s_bitset1_b64 s[58:59], s90
    s_mov_b32 s60, 0
    s_cmp_lg_u32 s60, s63
    s_cbranch_scc1 mega_kernel_e69
    v_add_f32 v176, v176, v16
    v_mov_b32 v180, v9
    v_add_f32 v188, v188, v16
    v_add_f32 v177, v177, v17
    v_mov_b32 v181, v9
    v_add_f32 v189, v189, v17
    v_add_f32 v178, v178, v18
    v_mov_b32 v182, v9
    v_add_f32 v190, v190, v18
    v_add_f32 v179, v179, v19
    v_mov_b32 v183, v9
    v_add_f32 v191, v191, v19
    s_nop 0
mega_kernel_e69:
    s_waitcnt vmcnt(24) lgkmcnt(0)
    s_barrier
    ds_read_b128 a[192:195], v6 offset:0
    ds_read_b128 a[196:199], v6 offset:1024
    ds_read_b128 a[200:203], v6 offset:2048
    ds_read_b128 a[204:207], v6 offset:3072
    ds_read_b128 a[208:211], v6 offset:4096
    ds_read_b128 a[212:215], v6 offset:5120
    ds_read_b128 a[216:219], v6 offset:6144
    ds_read_b128 a[220:223], v6 offset:7168
    s_waitcnt lgkmcnt(0)
    v_mfma_f32_16x16x32_bf16 v[64:67], a[192:195], a[128:131], v[160:163]
    v_mfma_f32_16x16x32_bf16 v[64:67], a[196:199], a[132:135], v[64:67]
    buffer_store_dwordx4 v[192:195], v2, s[36:39], s40 offen sc1
    s_add_u32 s40, s40, s100
    v_mfma_f32_16x16x32_bf16 v[64:67], a[200:203], a[136:139], v[64:67]
    v_mfma_f32_16x16x32_bf16 v[64:67], a[204:207], a[140:143], v[64:67]
    v_mfma_f32_16x16x32_bf16 v[72:75], a[192:195], a[144:147], v[168:171]
    v_mfma_f32_16x16x32_bf16 v[72:75], a[196:199], a[148:151], v[72:75]
    buffer_store_dwordx4 v[196:199], v2, s[36:39], s40 offen sc1
    s_add_u32 s40, s40, s100
    v_mfma_f32_16x16x32_bf16 v[72:75], a[200:203], a[152:155], v[72:75]
    v_mfma_f32_16x16x32_bf16 v[72:75], a[204:207], a[156:159], v[72:75]
    v_mfma_f32_16x16x32_bf16 v[80:83], a[192:195], a[160:163], v[176:179]
    v_mfma_f32_16x16x32_bf16 v[80:83], a[196:199], a[164:167], v[80:83]
    buffer_store_dwordx4 v[200:203], v2, s[36:39], s40 offen sc1
    s_add_u32 s40, s40, s100
    v_mfma_f32_16x16x32_bf16 v[80:83], a[200:203], a[168:171], v[80:83]
    v_mfma_f32_16x16x32_bf16 v[80:83], a[204:207], a[172:175], v[80:83]
    v_mfma_f32_16x16x32_bf16 v[88:91], a[192:195], a[176:179], v[184:187]
    v_mfma_f32_16x16x32_bf16 v[88:91], a[196:199], a[180:183], v[88:91]
    buffer_store_dwordx4 v[204:207], v2, s[36:39], s40 offen sc1
    s_add_u32 s40, s98, s99
    v_mfma_f32_16x16x32_bf16 v[88:91], a[200:203], a[184:187], v[88:91]
    v_mfma_f32_16x16x32_bf16 v[88:91], a[204:207], a[188:191], v[88:91]
    v_mfma_f32_16x16x32_bf16 v[68:71], a[208:211], a[128:131], v[164:167]
    ds_read_b128 a[192:195], v6 offset:8192
    v_mfma_f32_16x16x32_bf16 v[68:71], a[212:215], a[132:135], v[68:71]
    buffer_store_dwordx4 v[208:211], v2, s[36:39], s40 offen sc1
    s_add_u32 s40, s40, s100
    ds_read_b128 a[196:199], v6 offset:9216
    v_mfma_f32_16x16x32_bf16 v[68:71], a[216:219], a[136:139], v[68:71]
    ds_read_b128 a[200:203], v6 offset:10240
    v_mfma_f32_16x16x32_bf16 v[68:71], a[220:223], a[140:143], v[68:71]
    ds_read_b128 a[204:207], v6 offset:11264
    v_mfma_f32_16x16x32_bf16 v[76:79], a[208:211], a[144:147], v[172:175]
    v_mfma_f32_16x16x32_bf16 v[76:79], a[212:215], a[148:151], v[76:79]
    buffer_store_dwordx4 v[212:215], v2, s[36:39], s40 offen sc1
    s_add_u32 s40, s40, s100
    v_mfma_f32_16x16x32_bf16 v[76:79], a[216:219], a[152:155], v[76:79]
    v_mfma_f32_16x16x32_bf16 v[76:79], a[220:223], a[156:159], v[76:79]
    v_mfma_f32_16x16x32_bf16 v[84:87], a[208:211], a[160:163], v[180:183]
    v_mfma_f32_16x16x32_bf16 v[84:87], a[212:215], a[164:167], v[84:87]
    buffer_store_dwordx4 v[216:219], v2, s[36:39], s40 offen sc1
    s_add_u32 s40, s40, s100
    v_mfma_f32_16x16x32_bf16 v[84:87], a[216:219], a[168:171], v[84:87]
    v_mfma_f32_16x16x32_bf16 v[84:87], a[220:223], a[172:175], v[84:87]
    v_mfma_f32_16x16x32_bf16 v[92:95], a[208:211], a[176:179], v[188:191]
    v_mfma_f32_16x16x32_bf16 v[92:95], a[212:215], a[180:183], v[92:95]
    buffer_store_dwordx4 v[220:223], v2, s[36:39], s40 offen sc1
    s_add_u32 s40, s40, s100
    v_mfma_f32_16x16x32_bf16 v[92:95], a[216:219], a[184:187], v[92:95]
    v_mfma_f32_16x16x32_bf16 v[92:95], a[220:223], a[188:191], v[92:95]
    ds_read_b128 a[208:211], v6 offset:12288
    ds_read_b128 a[212:215], v6 offset:13312
    ds_read_b128 a[216:219], v6 offset:14336
    ds_read_b128 a[220:223], v6 offset:15360
    s_mov_b32 s60, 1
    s_nop 0
    s_nop 3
    v_max3_f32 v48, v64, v65, v66
    v_max3_f32 v49, v72, v73, v74
    v_max3_f32 v50, v80, v81, v82
    v_max3_f32 v51, v88, v89, v90
    v_max3_f32 v48, v48, v67, v68
    v_max3_f32 v49, v49, v75, v76
    v_max3_f32 v50, v50, v83, v84
    v_max3_f32 v51, v51, v91, v92
    v_max3_f32 v48, v48, v69, v70
    v_max3_f32 v49, v49, v77, v78
    v_max3_f32 v50, v50, v85, v86
    v_max3_f32 v51, v51, v93, v94
    v_max_f32 v48, v48, v71
    v_max_f32 v49, v49, v79
    v_max_f32 v50, v50, v87
    v_max_f32 v51, v51, v95
    v_mov_b32 v52, v48
    v_mov_b32 v53, v49
    v_mov_b32 v54, v50
    v_mov_b32 v55, v51
    s_nop 1
    v_permlane32_swap_b32 v48, v52
    v_permlane32_swap_b32 v49, v53
    v_permlane32_swap_b32 v50, v54
    v_permlane32_swap_b32 v51, v55
    s_nop 1
    v_max_f32 v48, v48, v52
    v_max_f32 v49, v49, v53
    v_max_f32 v50, v50, v54
    v_max_f32 v51, v51, v55
    v_mov_b32 v52, v48
    v_mov_b32 v53, v49
    v_mov_b32 v54, v50
    v_mov_b32 v55, v51
    s_nop 1
    v_permlane16_swap_b32 v48, v52
    v_permlane16_swap_b32 v49, v53
    v_permlane16_swap_b32 v50, v54
    v_permlane16_swap_b32 v51, v55
    s_nop 1
    v_max_f32 v48, v48, v52
    v_max_f32 v49, v49, v53
    v_max_f32 v50, v50, v54
    v_max_f32 v51, v51, v55
    v_sub_f32 v160, v160, v48
    v_sub_f32 v161, v161, v48
    v_sub_f32 v162, v162, v48
    v_sub_f32 v163, v163, v48
    v_sub_f32 v164, v164, v48
    v_sub_f32 v165, v165, v48
    v_sub_f32 v166, v166, v48
    v_sub_f32 v167, v167, v48
    v_sub_f32 v168, v168, v49
    v_sub_f32 v169, v169, v49
    v_sub_f32 v170, v170, v49
    v_sub_f32 v171, v171, v49
    v_sub_f32 v172, v172, v49
    v_sub_f32 v173, v173, v49
    v_sub_f32 v174, v174, v49
    v_sub_f32 v175, v175, v49
    v_sub_f32 v176, v176, v50
    v_sub_f32 v177, v177, v50
    v_sub_f32 v178, v178, v50
    v_sub_f32 v179, v179, v50
    v_sub_f32 v180, v180, v50
    v_sub_f32 v181, v181, v50
    v_sub_f32 v182, v182, v50
    v_sub_f32 v183, v183, v50
    v_sub_f32 v184, v184, v51
    v_sub_f32 v185, v185, v51
    v_sub_f32 v186, v186, v51
    v_sub_f32 v187, v187, v51
    v_sub_f32 v188, v188, v51
    v_sub_f32 v189, v189, v51
    v_sub_f32 v190, v190, v51
    v_sub_f32 v191, v191, v51
    v_sub_f32 v64, v64, v48
    v_sub_f32 v65, v65, v48
    v_sub_f32 v66, v66, v48
    v_sub_f32 v67, v67, v48
    v_sub_f32 v68, v68, v48
    v_sub_f32 v69, v69, v48
    v_sub_f32 v70, v70, v48
    v_sub_f32 v71, v71, v48
    v_sub_f32 v72, v72, v49
    v_sub_f32 v73, v73, v49
    v_sub_f32 v74, v74, v49
    v_sub_f32 v75, v75, v49
    v_sub_f32 v76, v76, v49
    v_sub_f32 v77, v77, v49
    v_sub_f32 v78, v78, v49
    v_sub_f32 v79, v79, v49
    v_sub_f32 v80, v80, v50
    v_sub_f32 v81, v81, v50
    v_sub_f32 v82, v82, v50
    v_sub_f32 v83, v83, v50
    v_sub_f32 v84, v84, v50
    v_sub_f32 v85, v85, v50
    v_sub_f32 v86, v86, v50
    v_sub_f32 v87, v87, v50
    v_sub_f32 v88, v88, v51
    v_sub_f32 v89, v89, v51
    v_sub_f32 v90, v90, v51
    v_sub_f32 v91, v91, v51
    v_sub_f32 v92, v92, v51
    v_sub_f32 v93, v93, v51
    v_sub_f32 v94, v94, v51
    v_sub_f32 v95, v95, v51
    s_cmp_lg_u32 s60, s63
    s_cbranch_scc1 mega_kernel_e70
    v_add_f32 v176, v176, v16
    v_mov_b32 v180, v9
    v_add_f32 v188, v188, v16
    v_add_f32 v177, v177, v17
    v_mov_b32 v181, v9
    v_add_f32 v189, v189, v17
    v_add_f32 v178, v178, v18
    v_mov_b32 v182, v9
    v_add_f32 v190, v190, v18
    v_add_f32 v179, v179, v19
    v_mov_b32 v183, v9
    v_add_f32 v191, v191, v19
    s_nop 0
mega_kernel_e70:
    s_cmp_lg_u32 s60, s64
    s_cbranch_scc1 mega_kernel_e71
    v_mov_b32 v176, v9
    v_mov_b32 v184, v9
    v_mov_b32 v188, v9
    v_mov_b32 v177, v9
    v_mov_b32 v185, v9
    v_mov_b32 v189, v9
    v_mov_b32 v178, v9
    v_mov_b32 v186, v9
    v_mov_b32 v190, v9
    v_mov_b32 v179, v9
    v_mov_b32 v187, v9
    v_mov_b32 v191, v9
    s_nop 0
mega_kernel_e71:
    s_waitcnt lgkmcnt(0)
    v_mfma_f32_16x16x32_bf16 v[96:99], a[192:195], a[128:131], v[160:163]
    s_bitcmp1_b64 s[58:59], s60
    s_cselect_b32 s62, -1.0, s61
    v_exp_f32 v20, v64
    v_mfma_f32_16x16x32_bf16 v[96:99], a[196:199], a[132:135], v[96:99]
    s_add_u32 s60, s60, 1
    v_exp_f32 v21, v65
    v_exp_f32 v22, v66
    v_mfma_f32_16x16x32_bf16 v[96:99], a[200:203], a[136:139], v[96:99]
    buffer_store_dwordx4 v[224:227], v2, s[36:39], s40 offen sc1
    v_cvt_pk_bf16_f32 v128, v20, v21
    v_mfma_f32_16x16x32_bf16 v[96:99], a[204:207], a[140:143], v[96:99]
    s_add_u32 s40, s40, s100
    v_add_f32 v12, v12, v28
    v_exp_f32 v23, v67
    v_mfma_f32_16x16x32_bf16 v[104:107], a[192:195], a[144:147], v[168:171]
    v_exp_f32 v24, v68
    v_cvt_pk_bf16_f32 v129, v22, v23
    v_mfma_f32_16x16x32_bf16 v[104:107], a[196:199], a[148:151], v[104:107]
    buffer_store_dwordx4 v[228:231], v2, s[36:39], s40 offen sc1
    v_exp_f32 v25, v69
    v_mfma_f32_16x16x32_bf16 v[104:107], a[200:203], a[152:155], v[104:107]
    s_add_u32 s40, s40, s100
    v_exp_f32 v26, v70
    v_cvt_pk_bf16_f32 v130, v24, v25
    v_mfma_f32_16x16x32_bf16 v[104:107], a[204:207], a[156:159], v[104:107]
    v_exp_f32 v27, v71
    v_add_f32 v13, v13, v32
    v_mfma_f32_16x16x32_bf16 v[112:115], a[192:195], a[160:163], v[176:179]
    v_exp_f32 v20, v72
    v_cvt_pk_bf16_f32 v131, v26, v27
    v_mfma_f32_16x16x32_bf16 v[112:115], a[196:199], a[164:167], v[112:115]
    buffer_store_dwordx4 v[232:235], v2, s[36:39], s40 offen sc1
    v_exp_f32 v21, v73
    v_mfma_f32_16x16x32_bf16 v[28:31], v[44:47], v[128:131], 0
    v_exp_f32 v22, v74
    v_cvt_pk_bf16_f32 v132, v20, v21
    v_mfma_f32_16x16x32_bf16 v[112:115], a[200:203], a[168:171], v[112:115]
    s_add_u32 s40, s40, s100
    v_exp_f32 v23, v75
    v_add_f32 v14, v14, v36
    v_mfma_f32_16x16x32_bf16 v[112:115], a[204:207], a[172:175], v[112:115]
    v_exp_f32 v24, v76
    v_cvt_pk_bf16_f32 v133, v22, v23
    v_mfma_f32_16x16x32_bf16 v[120:123], a[192:195], a[176:179], v[184:187]
    buffer_store_dwordx4 v[236:239], v2, s[36:39], s40 offen sc1
    v_exp_f32 v25, v77
    v_mfma_f32_16x16x32_bf16 v[120:123], a[196:199], a[180:183], v[120:123]
    s_mov_b32 s40, s98
    v_exp_f32 v26, v78
    v_cvt_pk_bf16_f32 v134, v24, v25
    v_mfma_f32_16x16x32_bf16 v[120:123], a[200:203], a[184:187], v[120:123]
    v_exp_f32 v27, v79
    v_add_f32 v15, v15, v40
    v_mfma_f32_16x16x32_bf16 v[120:123], a[204:207], a[188:191], v[120:123]
    s_waitcnt lgkmcnt(0)
    v_exp_f32 v20, v80
    v_cvt_pk_bf16_f32 v135, v26, v27
    v_mfma_f32_16x16x32_bf16 v[100:103], a[208:211], a[128:131], v[164:167]
    v_exp_f32 v21, v81
    v_exp_f32 v22, v82
    v_mfma_f32_16x16x32_bf16 v[32:35], v[44:47], v[132:135], 0
    v_cvt_pk_bf16_f32 v136, v20, v21
    v_exp_f32 v23, v83
    v_mfma_f32_16x16x32_bf16 v[100:103], a[212:215], a[132:135], v[100:103]
    buffer_store_dwordx4 v[240:243], v2, s[36:39], s40 offen sc1
    v_cvt_pk_bf16_f32 v137, v22, v23
    v_mfma_f32_16x16x32_bf16 v[100:103], a[216:219], a[136:139], v[100:103]
    s_add_u32 s40, s40, s100
    v_exp_f32 v24, v84
    v_mfma_f32_16x16x32_bf16 v[100:103], a[220:223], a[140:143], v[100:103]
    v_exp_f32 v25, v85
    v_exp_f32 v26, v86
    v_cvt_pk_bf16_f32 v138, v24, v25
    v_mfma_f32_16x16x32_bf16 v[108:111], a[208:211], a[144:147], v[172:175]
    buffer_store_dwordx4 v[244:247], v2, s[36:39], s40 offen sc1
    v_mfma_f32_16x16x32_bf16 v[108:111], a[212:215], a[148:151], v[108:111]
    s_add_u32 s40, s40, s100
    v_exp_f32 v27, v87
    v_exp_f32 v20, v88
    v_mfma_f32_16x16x32_bf16 v[108:111], a[216:219], a[152:155], v[108:111]
    v_cvt_pk_bf16_f32 v139, v26, v27
    v_exp_f32 v21, v89
    v_mfma_f32_16x16x32_bf16 v[108:111], a[220:223], a[156:159], v[108:111]
    buffer_store_dwordx4 v[248:251], v2, s[36:39], s40 offen sc1
    v_exp_f32 v22, v90
    v_mfma_f32_16x16x32_bf16 v[36:39], v[44:47], v[136:139], 0
    v_cvt_pk_bf16_f32 v140, v20, v21
    v_exp_f32 v23, v91
    v_mfma_f32_16x16x32_bf16 v[116:119], a[208:211], a[160:163], v[180:183]
    s_add_u32 s40, s40, s100
    v_exp_f32 v24, v92
    v_cvt_pk_bf16_f32 v141, v22, v23
    v_mfma_f32_16x16x32_bf16 v[116:119], a[212:215], a[164:167], v[116:119]
    v_exp_f32 v25, v93
    v_mfma_f32_16x16x32_bf16 v[116:119], a[216:219], a[168:171], v[116:119]
    buffer_store_dwordx4 v[252:255], v2, s[36:39], s40 offen sc1
    v_exp_f32 v26, v94
    v_cvt_pk_bf16_f32 v142, v24, v25
    v_mfma_f32_16x16x32_bf16 v[116:119], a[220:223], a[172:175], v[116:119]
    s_add_u32 s40, s40, s100
    v_exp_f32 v27, v95
    s_nop 0
    v_cvt_pk_bf16_f32 v143, v26, v27
    s_nop 1
    v_mfma_f32_16x16x32_bf16 v[40:43], v[44:47], v[140:143], 0
    s_nop 2
    v_mfma_f32_16x16x32_bf16 v[124:127], a[208:211], a[176:179], v[188:191]
    s_nop 2
    v_mfma_f32_16x16x32_bf16 v[124:127], a[212:215], a[180:183], v[124:127]
    v_max3_f32 v8, v28, v32, v36
    v_max_f32 v8, v8, v40
    v_mfma_f32_16x16x32_bf16 v[124:127], a[216:219], a[184:187], v[124:127]
    v_cmp_nge_f32 vcc, s62, v8
    v_mfma_f32_16x16x32_bf16 v[124:127], a[220:223], a[188:191], v[124:127]
    s_waitcnt vmcnt(40) lgkmcnt(0)
    s_barrier
    s_add_u32 s56, s55, s57
    s_add_u32 s55, s55, 32768
    s_and_b32 s55, s55, 0x1ffff
    v_add_u32 v6, s55, v2
    ds_read_b128 a[192:195], v6 offset:0
    ds_read_b128 a[196:199], v6 offset:1024
    ds_read_b128 a[200:203], v6 offset:2048
    ds_read_b128 a[204:207], v6 offset:3072
    ds_read_b128 a[208:211], v6 offset:4096
    ds_read_b128 a[212:215], v6 offset:5120
    ds_read_b128 a[216:219], v6 offset:6144
    ds_read_b128 a[220:223], v6 offset:7168
    s_waitcnt lgkmcnt(0)
    s_cbranch_vccnz mega_kernel_stub72
mega_kernel_ret73:
mega_kernel_dual74:
    v_mfma_f32_16x16x32_bf16 v[64:67], a[192:195], a[128:131], v[160:163]
    s_bitcmp1_b64 s[58:59], s60
    s_cselect_b32 s62, -1.0, s61
    v_add_f32 v12, v12, v28
    v_mfma_f32_16x16x32_bf16 v[64:67], a[196:199], a[132:135], v[64:67]
    s_add_u32 s60, s60, 1
    ds_read_b128 a[224:227], v6 offset:16384
    v_add_f32 v13, v13, v32
    v_mfma_f32_16x16x32_bf16 v[64:67], a[200:203], a[136:139], v[64:67]
    v_exp_f32 v20, v96
    v_mfma_f32_16x16x32_bf16 v[64:67], a[204:207], a[140:143], v[64:67]
    v_exp_f32 v21, v97
    v_mfma_f32_16x16x32_bf16 v[72:75], a[192:195], a[144:147], v[168:171]
    s_mov_b32 m0, s56
    ds_read_b128 a[228:231], v6 offset:17408
    v_cvt_pk_bf16_f32 v144, v20, v21
    v_mfma_f32_16x16x32_bf16 v[72:75], a[196:199], a[148:151], v[72:75]
    buffer_load_dwordx4 v7, s[24:27], s53 offen offset:0 sc1 lds
    v_mfma_f32_16x16x32_bf16 v[72:75], a[200:203], a[152:155], v[72:75]
    v_exp_f32 v22, v98
    v_mfma_f32_16x16x32_bf16 v[72:75], a[204:207], a[156:159], v[72:75]
    ds_read_b128 a[232:235], v6 offset:18432
    v_add_f32 v14, v14, v36
    v_mfma_f32_16x16x32_bf16 v[80:83], a[192:195], a[160:163], v[176:179]
    v_exp_f32 v23, v99
    v_mfma_f32_16x16x32_bf16 v[80:83], a[196:199], a[164:167], v[80:83]
    v_exp_f32 v24, v100
    v_mfma_f32_16x16x32_bf16 v[80:83], a[200:203], a[168:171], v[80:83]
    ds_read_b128 a[236:239], v6 offset:19456
    v_cvt_pk_bf16_f32 v145, v22, v23
    v_mfma_f32_16x16x32_bf16 v[80:83], a[204:207], a[172:175], v[80:83]
    v_exp_f32 v25, v101
    v_mfma_f32_16x16x32_bf16 v[88:91], a[192:195], a[176:179], v[184:187]
    v_exp_f32 v26, v102
    v_mfma_f32_16x16x32_bf16 v[88:91], a[196:199], a[180:183], v[88:91]
    ds_read_b128 a[240:243], v6 offset:20480
    v_cvt_pk_bf16_f32 v146, v24, v25
    v_mfma_f32_16x16x32_bf16 v[88:91], a[200:203], a[184:187], v[88:91]
    v_exp_f32 v27, v103
    v_mfma_f32_16x16x32_bf16 v[88:91], a[204:207], a[188:191], v[88:91]
    s_waitcnt lgkmcnt(5)
    v_exp_f32 v20, v104
    v_mfma_f32_16x16x32_bf16 v[68:71], a[208:211], a[128:131], v[164:167]
    ds_read_b128 a[244:247], v6 offset:21504
    v_cvt_pk_bf16_f32 v147, v26, v27
    v_mfma_f32_16x16x32_bf16 v[68:71], a[212:215], a[132:135], v[68:71]
    v_exp_f32 v21, v105
    v_mfma_f32_16x16x32_bf16 v[28:31], v[44:47], v[144:147], 0
    v_exp_f32 v22, v106
    v_mfma_f32_16x16x32_bf16 v[68:71], a[216:219], a[136:139], v[68:71]
    buffer_load_dwordx4 v7, s[24:27], s53 offen offset:1024 sc1 lds
    v_mfma_f32_16x16x32_bf16 v[68:71], a[220:223], a[140:143], v[68:71]
    ds_read_b128 a[248:251], v6 offset:22528
    v_cvt_pk_bf16_f32 v148, v20, v21
    v_mfma_f32_16x16x32_bf16 v[76:79], a[208:211], a[144:147], v[172:175]
    v_exp_f32 v23, v107
    v_mfma_f32_16x16x32_bf16 v[76:79], a[212:215], a[148:151], v[76:79]
    v_exp_f32 v24, v108
    v_mfma_f32_16x16x32_bf16 v[76:79], a[216:219], a[152:155], v[76:79]
    ds_read_b128 a[252:255], v6 offset:23552
    v_cvt_pk_bf16_f32 v149, v22, v23
    v_mfma_f32_16x16x32_bf16 v[76:79], a[220:223], a[156:159], v[76:79]
    v_exp_f32 v25, v109
    v_mfma_f32_16x16x32_bf16 v[84:87], a[208:211], a[160:163], v[180:183]
    v_exp_f32 v26, v110
    v_mfma_f32_16x16x32_bf16 v[84:87], a[212:215], a[164:167], v[84:87]
    v_cvt_pk_bf16_f32 v150, v24, v25
    v_add_f32 v15, v15, v40
    v_mfma_f32_16x16x32_bf16 v[84:87], a[216:219], a[168:171], v[84:87]
    v_exp_f32 v27, v111
    v_mfma_f32_16x16x32_bf16 v[84:87], a[220:223], a[172:175], v[84:87]
    buffer_load_dwordx4 v7, s[24:27], s53 offen offset:2048 sc1 lds
    v_mfma_f32_16x16x32_bf16 v[92:95], a[208:211], a[176:179], v[188:191]
    v_exp_f32 v20, v112
    v_mfma_f32_16x16x32_bf16 v[92:95], a[212:215], a[180:183], v[92:95]
    v_cvt_pk_bf16_f32 v151, v26, v27
    v_mfma_f32_16x16x32_bf16 v[92:95], a[216:219], a[184:187], v[92:95]
    v_exp_f32 v21, v113
    v_mfma_f32_16x16x32_bf16 v[32:35], v[44:47], v[148:151], 0
    v_exp_f32 v22, v114
    v_mfma_f32_16x16x32_bf16 v[92:95], a[220:223], a[188:191], v[92:95]
    s_waitcnt lgkmcnt(0)
    v_cvt_pk_bf16_f32 v152, v20, v21
    v_mfma_f32_16x16x32_bf16 a[0:3], a[224:227], v[128:131], a[0:3]
    ds_read_b128 a[192:195], v6 offset:8192
    v_mfma_f32_16x16x32_bf16 a[32:35], a[224:227], v[132:135], a[32:35]
    v_exp_f32 v23, v115
    v_mfma_f32_16x16x32_bf16 a[64:67], a[224:227], v[136:139], a[64:67]
    v_exp_f32 v24, v116
    v_mfma_f32_16x16x32_bf16 a[96:99], a[224:227], v[140:143], a[96:99]
    ds_read_b128 a[196:199], v6 offset:9216
    v_cvt_pk_bf16_f32 v153, v22, v23
    v_mfma_f32_16x16x32_bf16 a[4:7], a[228:231], v[128:131], a[4:7]
    v_exp_f32 v25, v117
    v_mfma_f32_16x16x32_bf16 a[36:39], a[228:231], v[132:135], a[36:39]
    v_exp_f32 v26, v118
    v_mfma_f32_16x16x32_bf16 a[68:71], a[228:231], v[136:139], a[68:71]
    ds_read_b128 a[200:203], v6 offset:10240
    v_cvt_pk_bf16_f32 v154, v24, v25
    v_mfma_f32_16x16x32_bf16 a[100:103], a[228:231], v[140:143], a[100:103]
    v_exp_f32 v27, v119
    v_mfma_f32_16x16x32_bf16 a[8:11], a[232:235], v[128:131], a[8:11]
    v_exp_f32 v20, v120
    v_mfma_f32_16x16x32_bf16 a[40:43], a[232:235], v[132:135], a[40:43]
    ds_read_b128 a[204:207], v6 offset:11264
    v_cvt_pk_bf16_f32 v155, v26, v27
    v_mfma_f32_16x16x32_bf16 a[72:75], a[232:235], v[136:139], a[72:75]
    v_exp_f32 v21, v121
    v_mfma_f32_16x16x32_bf16 v[36:39], v[44:47], v[152:155], 0
    v_exp_f32 v22, v122
    v_mfma_f32_16x16x32_bf16 a[104:107], a[232:235], v[140:143], a[104:107]
    buffer_load_dwordx4 v7, s[24:27], s53 offen offset:3072 sc1 lds
    v_mfma_f32_16x16x32_bf16 a[12:15], a[236:239], v[128:131], a[12:15]
    s_add_u32 s53, s53, 16384
    v_cvt_pk_bf16_f32 v156, v20, v21
    v_mfma_f32_16x16x32_bf16 a[44:47], a[236:239], v[132:135], a[44:47]
    v_exp_f32 v23, v123
    v_mfma_f32_16x16x32_bf16 a[76:79], a[236:239], v[136:139], a[76:79]
    v_exp_f32 v24, v124
    v_mfma_f32_16x16x32_bf16 a[108:111], a[236:239], v[140:143], a[108:111]
    v_cvt_pk_bf16_f32 v157, v22, v23
    v_mfma_f32_16x16x32_bf16 a[16:19], a[240:243], v[128:131], a[16:19]
    v_exp_f32 v25, v125
    v_mfma_f32_16x16x32_bf16 a[48:51], a[240:243], v[132:135], a[48:51]
    v_exp_f32 v26, v126
    v_mfma_f32_16x16x32_bf16 a[80:83], a[240:243], v[136:139], a[80:83]
    v_cvt_pk_bf16_f32 v158, v24, v25
    v_mfma_f32_16x16x32_bf16 a[112:115], a[240:243], v[140:143], a[112:115]
    s_add_u32 m0, s56, 16384
    v_exp_f32 v27, v127
    v_mfma_f32_16x16x32_bf16 a[20:23], a[244:247], v[128:131], a[20:23]
    buffer_load_dwordx4 v7, s[28:31], s54 offen offset:0 sc1 lds
    v_mfma_f32_16x16x32_bf16 a[52:55], a[244:247], v[132:135], a[52:55]
    v_cvt_pk_bf16_f32 v159, v26, v27
    v_mfma_f32_16x16x32_bf16 a[84:87], a[244:247], v[136:139], a[84:87]
    v_mfma_f32_16x16x32_bf16 a[116:119], a[244:247], v[140:143], a[116:119]
    v_mfma_f32_16x16x32_bf16 v[40:43], v[44:47], v[156:159], 0
    s_nop 2
    v_mfma_f32_16x16x32_bf16 a[24:27], a[248:251], v[128:131], a[24:27]
    s_nop 2
    v_mfma_f32_16x16x32_bf16 a[56:59], a[248:251], v[132:135], a[56:59]
    v_max3_f32 v8, v28, v32, v36
    v_max_f32 v8, v8, v40
    v_mfma_f32_16x16x32_bf16 a[88:91], a[248:251], v[136:139], a[88:91]
    v_cmp_nge_f32 vcc, s62, v8
    v_mfma_f32_16x16x32_bf16 a[120:123], a[248:251], v[140:143], a[120:123]
    ds_read_b128 a[208:211], v6 offset:12288
    v_mfma_f32_16x16x32_bf16 a[28:31], a[252:255], v[128:131], a[28:31]
    ds_read_b128 a[212:215], v6 offset:13312
    v_mfma_f32_16x16x32_bf16 a[60:63], a[252:255], v[132:135], a[60:63]
    ds_read_b128 a[216:219], v6 offset:14336
    v_mfma_f32_16x16x32_bf16 a[92:95], a[252:255], v[136:139], a[92:95]
    ds_read_b128 a[220:223], v6 offset:15360
    v_mfma_f32_16x16x32_bf16 a[124:127], a[252:255], v[140:143], a[124:127]
    s_waitcnt lgkmcnt(4)
    s_cbranch_vccnz mega_kernel_stub75
mega_kernel_ret76:
    v_mfma_f32_16x16x32_bf16 v[96:99], a[192:195], a[128:131], v[160:163]
    s_add_u32 s56, s55, s57
    v_exp_f32 v20, v64
    v_mfma_f32_16x16x32_bf16 v[96:99], a[196:199], a[132:135], v[96:99]
    s_add_u32 s55, s55, 32768
    ds_read_b128 a[224:227], v6 offset:24576
    v_add_f32 v12, v12, v28
    v_mfma_f32_16x16x32_bf16 v[96:99], a[200:203], a[136:139], v[96:99]
    s_and_b32 s55, s55, 0x1ffff
    v_exp_f32 v21, v65
    v_mfma_f32_16x16x32_bf16 v[96:99], a[204:207], a[140:143], v[96:99]
    s_bitcmp1_b64 s[58:59], s60
    s_cselect_b32 s62, -1.0, s61
    v_cvt_pk_bf16_f32 v128, v20, v21
    v_mfma_f32_16x16x32_bf16 v[104:107], a[192:195], a[144:147], v[168:171]
    s_add_u32 s60, s60, 1
    ds_read_b128 a[228:231], v6 offset:25600
    v_add_f32 v13, v13, v32
    v_mfma_f32_16x16x32_bf16 v[104:107], a[196:199], a[148:151], v[104:107]
    v_exp_f32 v22, v66
    v_mfma_f32_16x16x32_bf16 v[104:107], a[200:203], a[152:155], v[104:107]
    buffer_load_dwordx4 v7, s[28:31], s54 offen offset:1024 sc1 lds
    v_mfma_f32_16x16x32_bf16 v[104:107], a[204:207], a[156:159], v[104:107]
    ds_read_b128 a[232:235], v6 offset:26624
    v_add_f32 v14, v14, v36
    v_mfma_f32_16x16x32_bf16 v[112:115], a[192:195], a[160:163], v[176:179]
    v_exp_f32 v23, v67
    v_mfma_f32_16x16x32_bf16 v[112:115], a[196:199], a[164:167], v[112:115]
    v_exp_f32 v24, v68
    v_mfma_f32_16x16x32_bf16 v[112:115], a[200:203], a[168:171], v[112:115]
    ds_read_b128 a[236:239], v6 offset:27648
    v_cvt_pk_bf16_f32 v129, v22, v23
    v_mfma_f32_16x16x32_bf16 v[112:115], a[204:207], a[172:175], v[112:115]
    v_exp_f32 v25, v69
    v_mfma_f32_16x16x32_bf16 v[120:123], a[192:195], a[176:179], v[184:187]
    v_exp_f32 v26, v70
    v_mfma_f32_16x16x32_bf16 v[120:123], a[196:199], a[180:183], v[120:123]
    ds_read_b128 a[240:243], v6 offset:28672
    v_cvt_pk_bf16_f32 v130, v24, v25
    v_mfma_f32_16x16x32_bf16 v[120:123], a[200:203], a[184:187], v[120:123]
    v_exp_f32 v27, v71
    v_mfma_f32_16x16x32_bf16 v[120:123], a[204:207], a[188:191], v[120:123]
    s_waitcnt lgkmcnt(5)
    v_exp_f32 v20, v72
    v_mfma_f32_16x16x32_bf16 v[100:103], a[208:211], a[128:131], v[164:167]
    ds_read_b128 a[244:247], v6 offset:29696
    v_cvt_pk_bf16_f32 v131, v26, v27
    v_mfma_f32_16x16x32_bf16 v[100:103], a[212:215], a[132:135], v[100:103]
    v_exp_f32 v21, v73
    v_mfma_f32_16x16x32_bf16 v[28:31], v[44:47], v[128:131], 0
    v_exp_f32 v22, v74
    v_mfma_f32_16x16x32_bf16 v[100:103], a[216:219], a[136:139], v[100:103]
    buffer_load_dwordx4 v7, s[28:31], s54 offen offset:2048 sc1 lds
    v_mfma_f32_16x16x32_bf16 v[100:103], a[220:223], a[140:143], v[100:103]
    ds_read_b128 a[248:251], v6 offset:30720
    v_cvt_pk_bf16_f32 v132, v20, v21
    v_mfma_f32_16x16x32_bf16 v[108:111], a[208:211], a[144:147], v[172:175]
    v_exp_f32 v23, v75
    v_mfma_f32_16x16x32_bf16 v[108:111], a[212:215], a[148:151], v[108:111]
    v_exp_f32 v24, v76
    v_mfma_f32_16x16x32_bf16 v[108:111], a[216:219], a[152:155], v[108:111]
    ds_read_b128 a[252:255], v6 offset:31744
    v_cvt_pk_bf16_f32 v133, v22, v23
    v_mfma_f32_16x16x32_bf16 v[108:111], a[220:223], a[156:159], v[108:111]
    v_exp_f32 v25, v77
    v_mfma_f32_16x16x32_bf16 v[116:119], a[208:211], a[160:163], v[180:183]
    v_exp_f32 v26, v78
    v_mfma_f32_16x16x32_bf16 v[116:119], a[212:215], a[164:167], v[116:119]
    v_cvt_pk_bf16_f32 v134, v24, v25
    v_add_f32 v15, v15, v40
    v_mfma_f32_16x16x32_bf16 v[116:119], a[216:219], a[168:171], v[116:119]
    v_exp_f32 v27, v79
    v_mfma_f32_16x16x32_bf16 v[116:119], a[220:223], a[172:175], v[116:119]
    buffer_load_dwordx4 v7, s[28:31], s54 offen offset:3072 sc1 lds
    v_mfma_f32_16x16x32_bf16 v[124:127], a[208:211], a[176:179], v[188:191]
    s_add_u32 s54, s54, 16384
    v_exp_f32 v20, v80
    v_mfma_f32_16x16x32_bf16 v[124:127], a[212:215], a[180:183], v[124:127]
    v_cvt_pk_bf16_f32 v135, v26, v27
    v_mfma_f32_16x16x32_bf16 v[124:127], a[216:219], a[184:187], v[124:127]
    v_exp_f32 v21, v81
    v_mfma_f32_16x16x32_bf16 v[32:35], v[44:47], v[132:135], 0
    v_exp_f32 v22, v82
    v_mfma_f32_16x16x32_bf16 v[124:127], a[220:223], a[188:191], v[124:127]
    s_waitcnt vmcnt(16) lgkmcnt(0)
    v_add_u32 v6, s55, v2
    v_cvt_pk_bf16_f32 v136, v20, v21
    v_mfma_f32_16x16x32_bf16 a[0:3], a[224:227], v[144:147], a[0:3]
    s_barrier
    v_mfma_f32_16x16x32_bf16 a[32:35], a[224:227], v[148:151], a[32:35]
    ds_read_b128 a[192:195], v6 offset:0
    v_mfma_f32_16x16x32_bf16 a[64:67], a[224:227], v[152:155], a[64:67]
    v_exp_f32 v23, v83
    v_mfma_f32_16x16x32_bf16 a[96:99], a[224:227], v[156:159], a[96:99]
    v_exp_f32 v24, v84
    v_mfma_f32_16x16x32_bf16 a[4:7], a[228:231], v[144:147], a[4:7]
    ds_read_b128 a[196:199], v6 offset:1024
    v_cvt_pk_bf16_f32 v137, v22, v23
    v_mfma_f32_16x16x32_bf16 a[36:39], a[228:231], v[148:151], a[36:39]
    v_exp_f32 v25, v85
    v_mfma_f32_16x16x32_bf16 a[68:71], a[228:231], v[152:155], a[68:71]
    v_exp_f32 v26, v86
    v_mfma_f32_16x16x32_bf16 a[100:103], a[228:231], v[156:159], a[100:103]
    ds_read_b128 a[200:203], v6 offset:2048
    v_cvt_pk_bf16_f32 v138, v24, v25
    v_mfma_f32_16x16x32_bf16 a[8:11], a[232:235], v[144:147], a[8:11]
    v_exp_f32 v27, v87
    v_mfma_f32_16x16x32_bf16 a[40:43], a[232:235], v[148:151], a[40:43]
    v_exp_f32 v20, v88
    v_mfma_f32_16x16x32_bf16 a[72:75], a[232:235], v[152:155], a[72:75]
    ds_read_b128 a[204:207], v6 offset:3072
    v_cvt_pk_bf16_f32 v139, v26, v27
    v_mfma_f32_16x16x32_bf16 a[104:107], a[232:235], v[156:159], a[104:107]
    v_exp_f32 v21, v89
    v_mfma_f32_16x16x32_bf16 v[36:39], v[44:47], v[136:139], 0
    v_exp_f32 v22, v90
    v_mfma_f32_16x16x32_bf16 a[12:15], a[236:239], v[144:147], a[12:15]
    v_cvt_pk_bf16_f32 v140, v20, v21
    v_mfma_f32_16x16x32_bf16 a[44:47], a[236:239], v[148:151], a[44:47]
    v_exp_f32 v23, v91
    v_mfma_f32_16x16x32_bf16 a[76:79], a[236:239], v[152:155], a[76:79]
    v_exp_f32 v24, v92
    v_mfma_f32_16x16x32_bf16 a[108:111], a[236:239], v[156:159], a[108:111]
    v_cvt_pk_bf16_f32 v141, v22, v23
    v_mfma_f32_16x16x32_bf16 a[16:19], a[240:243], v[144:147], a[16:19]
    v_exp_f32 v25, v93
    v_mfma_f32_16x16x32_bf16 a[48:51], a[240:243], v[148:151], a[48:51]
    v_exp_f32 v26, v94
    v_mfma_f32_16x16x32_bf16 a[80:83], a[240:243], v[152:155], a[80:83]
    v_cvt_pk_bf16_f32 v142, v24, v25
    v_mfma_f32_16x16x32_bf16 a[112:115], a[240:243], v[156:159], a[112:115]
    v_exp_f32 v27, v95
    v_mfma_f32_16x16x32_bf16 a[20:23], a[244:247], v[144:147], a[20:23]
    v_cvt_pk_bf16_f32 v143, v26, v27
    v_mfma_f32_16x16x32_bf16 a[52:55], a[244:247], v[148:151], a[52:55]
    v_mfma_f32_16x16x32_bf16 a[84:87], a[244:247], v[152:155], a[84:87]
    v_mfma_f32_16x16x32_bf16 v[40:43], v[44:47], v[140:143], 0
    s_nop 2
    v_mfma_f32_16x16x32_bf16 a[116:119], a[244:247], v[156:159], a[116:119]
    s_nop 2
    v_mfma_f32_16x16x32_bf16 a[24:27], a[248:251], v[144:147], a[24:27]
    v_max3_f32 v8, v28, v32, v36
    v_max_f32 v8, v8, v40
    v_mfma_f32_16x16x32_bf16 a[56:59], a[248:251], v[148:151], a[56:59]
    v_cmp_nge_f32 vcc, s62, v8
    v_mfma_f32_16x16x32_bf16 a[88:91], a[248:251], v[152:155], a[88:91]
    v_mfma_f32_16x16x32_bf16 a[120:123], a[248:251], v[156:159], a[120:123]
    ds_read_b128 a[208:211], v6 offset:4096
    v_mfma_f32_16x16x32_bf16 a[28:31], a[252:255], v[144:147], a[28:31]
    ds_read_b128 a[212:215], v6 offset:5120
    v_mfma_f32_16x16x32_bf16 a[60:63], a[252:255], v[148:151], a[60:63]
    ds_read_b128 a[216:219], v6 offset:6144
    v_mfma_f32_16x16x32_bf16 a[92:95], a[252:255], v[152:155], a[92:95]
    ds_read_b128 a[220:223], v6 offset:7168
    v_mfma_f32_16x16x32_bf16 a[124:127], a[252:255], v[156:159], a[124:127]
    s_waitcnt lgkmcnt(4)
    s_cbranch_vccz mega_kernel_dual74
    v_cmp_lt_f32 vcc, s61, v8
    s_cmp_lg_u32 s60, s63
    s_cbranch_scc1 mega_kernel_e78
    v_add_f32 v176, v176, v16
    v_mov_b32 v180, v9
    v_add_f32 v188, v188, v16
    v_add_f32 v177, v177, v17
    v_mov_b32 v181, v9
    v_add_f32 v189, v189, v17
    v_add_f32 v178, v178, v18
    v_mov_b32 v182, v9
    v_add_f32 v190, v190, v18
    v_add_f32 v179, v179, v19
    v_mov_b32 v183, v9
    v_add_f32 v191, v191, v19
    s_nop 0
mega_kernel_e78:
    s_cmp_lg_u32 s60, s64
    s_cbranch_scc1 mega_kernel_e79
    v_mov_b32 v176, v9
    v_mov_b32 v184, v9
    v_mov_b32 v188, v9
    v_mov_b32 v177, v9
    v_mov_b32 v185, v9
    v_mov_b32 v189, v9
    v_mov_b32 v178, v9
    v_mov_b32 v186, v9
    v_mov_b32 v190, v9
    v_mov_b32 v179, v9
    v_mov_b32 v187, v9
    v_mov_b32 v191, v9
    s_nop 0
mega_kernel_e79:
    s_cmp_lg_u32 s60, s66
    s_cbranch_scc1 mega_kernel_e80
    v_add_f32 v160, v160, v16
    v_mov_b32 v164, v9
    v_add_f32 v172, v172, v16
    v_add_f32 v161, v161, v17
    v_mov_b32 v165, v9
    v_add_f32 v173, v173, v17
    v_add_f32 v162, v162, v18
    v_mov_b32 v166, v9
    v_add_f32 v174, v174, v18
    v_add_f32 v163, v163, v19
    v_mov_b32 v167, v9
    v_add_f32 v175, v175, v19
    s_nop 0
mega_kernel_e80:
    s_cmp_lg_u32 s60, s52
    s_cbranch_scc1 mega_kernel_e82
    v_lshrrev_b32 v62, 3, v1
    v_lshlrev_b32 v62, 11, v62
    v_and_b32 v61, 7, v1
    v_lshl_add_u32 v62, v61, 7, v62
    s_lshr_b32 s90, s2, 3
    s_lshl_b32 s90, s90, 2
    s_add_u32 s90, s90, s16
    s_lshl_b32 s90, s90, 14
    s_and_b32 s91, s2, 1
    s_lshl_b32 s91, s91, 10
    s_add_u32 s90, s90, s91
    s_bitcmp1_b32 s2, 2
    s_cselect_b32 s91, 0, 5373952
    s_mov_b32 s92, 8388608
    s_cselect_b32 s46, 5373952, s92
    s_cselect_b32 s93, 0, 2097152
    s_add_u32 s91, s91, s90
    s_mov_b32 s44, s48
    s_mov_b32 s45, s49
    s_add_u32 s92, s91, 0
    buffer_load_dword v255, v62, s[44:47], s92 offen
    s_add_u32 s92, s91, 2097152
    buffer_load_dword v255, v62, s[44:47], s92 offen
    s_add_u32 s92, s91, 4194304
    buffer_load_dword v255, v62, s[44:47], s92 offen
    s_mov_b32 s44, s50
    s_mov_b32 s45, s51
    s_mov_b32 s46, s93
    buffer_load_dword v255, v62, s[44:47], s90 offen
mega_kernel_e82:
    s_cmp_gt_u32 s60, 26
    s_cbranch_scc1 mega_kernel_e81
    s_cmp_lg_u32 s60, 6
    s_cbranch_scc1 mega_kernel_e83
    s_cmp_eq_u32 s17, -1
    s_cbranch_scc1 mega_kernel_e81
    s_cmp_lg_u32 s16, 0
    s_cbranch_scc1 mega_kernel_np84
    v_mov_b32 v4, s4
    v_mov_b32 v5, s5
    s_add_u32 s90, s17, 117440512
    s_mov_b64 exec, 1
    buffer_store_dwordx2 v[4:5], off, s[8:11], s90 sc1
    s_mov_b64 exec, -1
mega_kernel_np84:
    s_branch mega_kernel_e81
mega_kernel_e83:
    s_cmp_lg_u32 s60, 22
    s_cbranch_scc1 mega_kernel_e85
    buffer_load_dwordx2 v[4:5], v10, s[8:11], 0 offen sc1
    s_mov_b32 s44, s48
    s_mov_b32 s45, s49
    s_mov_b32 s46, 8388608
    s_lshl_b32 s90, s2, 2
    s_add_u32 s90, s90, s16
    s_lshl_b32 s90, s90, 13
    v_lshlrev_b32 v62, 7, v1
    buffer_load_dword v255, v62, s[44:47], s90 offen
    s_branch mega_kernel_e81
mega_kernel_e85:
    s_cmp_lg_u32 s60, 26
    s_cbranch_scc1 mega_kernel_e86
    s_mov_b32 s44, s50
    s_mov_b32 s45, s51
    s_mov_b32 s46, 2097152
    s_lshl_b32 s90, s2, 2
    s_add_u32 s90, s90, s16
    s_lshl_b32 s90, s90, 13
    v_lshlrev_b32 v62, 7, v1
    buffer_load_dword v255, v62, s[44:47], s90 offen
    s_waitcnt vmcnt(18)
    s_mov_b32 s3, 1048576
mega_kernel_spin87:
    v_cmp_ne_u64 s[72:73], s[4:5], v[4:5]
    s_nop 3
    s_cmp_eq_u64 s[72:73], 0
    s_cbranch_scc1 mega_kernel_e81
    s_sub_u32 s3, s3, 1
    s_cbranch_scc1 mega_kernel_e81
    s_sleep 32
    buffer_load_dwordx2 v[4:5], v10, s[8:11], 0 offen sc1
    s_waitcnt vmcnt(0)
    s_branch mega_kernel_spin87
    s_branch mega_kernel_e81
mega_kernel_e86:
mega_kernel_e81:
    s_cbranch_vccnz mega_kernel_rc88
mega_kernel_sp77:
    s_cmp_lg_u32 s60, s65
    s_cbranch_scc1 mega_kernel_dual74
    v_mfma_f32_16x16x32_bf16 v[64:67], a[192:195], a[128:131], v[160:163]
    s_bitcmp1_b64 s[58:59], s60
    s_cselect_b32 s62, -1.0, s61
    v_add_f32 v12, v12, v28
    v_mfma_f32_16x16x32_bf16 v[64:67], a[196:199], a[132:135], v[64:67]
    s_add_u32 s60, s60, 1
    ds_read_b128 a[224:227], v6 offset:16384
    v_exp_f32 v20, v96
    v_mfma_f32_16x16x32_bf16 v[64:67], a[200:203], a[136:139], v[64:67]
    s_mov_b32 m0, s56
    ds_read_b128 a[228:231], v6 offset:17408
    v_add_f32 v13, v13, v32
    v_mfma_f32_16x16x32_bf16 v[64:67], a[204:207], a[140:143], v[64:67]
    buffer_load_dwordx4 v7, s[24:27], s53 offen offset:0 sc1 lds
    v_mfma_f32_16x16x32_bf16 v[72:75], a[192:195], a[144:147], v[168:171]
    ds_read_b128 a[232:235], v6 offset:18432
    v_add_f32 v14, v14, v36
    v_mfma_f32_16x16x32_bf16 v[72:75], a[196:199], a[148:151], v[72:75]
    ds_read_b128 a[236:239], v6 offset:19456
    v_exp_f32 v21, v97
    v_mfma_f32_16x16x32_bf16 v[72:75], a[200:203], a[152:155], v[72:75]
    ds_read_b128 a[240:243], v6 offset:20480
    v_cvt_pk_bf16_f32 v144, v20, v21
    v_mfma_f32_16x16x32_bf16 v[72:75], a[204:207], a[156:159], v[72:75]
    s_waitcnt lgkmcnt(5)
    ds_read_b128 a[244:247], v6 offset:21504
    v_add_f32 v15, v15, v40
    v_mfma_f32_16x16x32_bf16 v[68:71], a[208:211], a[128:131], v[164:167]
    ds_read_b128 a[248:251], v6 offset:22528
    v_exp_f32 v22, v98
    v_mfma_f32_16x16x32_bf16 v[68:71], a[212:215], a[132:135], v[68:71]
    ds_read_b128 a[252:255], v6 offset:23552
    v_exp_f32 v23, v99
    v_mfma_f32_16x16x32_bf16 v[68:71], a[216:219], a[136:139], v[68:71]
    v_exp_f32 v24, v100
    v_mfma_f32_16x16x32_bf16 v[68:71], a[220:223], a[140:143], v[68:71]
    buffer_load_dwordx4 v7, s[24:27], s53 offen offset:1024 sc1 lds
    v_mfma_f32_16x16x32_bf16 v[76:79], a[208:211], a[144:147], v[172:175]
    v_cvt_pk_bf16_f32 v145, v22, v23
    v_exp_f32 v25, v101
    v_mfma_f32_16x16x32_bf16 v[76:79], a[212:215], a[148:151], v[76:79]
    v_exp_f32 v26, v102
    v_mfma_f32_16x16x32_bf16 v[76:79], a[216:219], a[152:155], v[76:79]
    v_cvt_pk_bf16_f32 v146, v24, v25
    v_exp_f32 v27, v103
    v_mfma_f32_16x16x32_bf16 v[76:79], a[220:223], a[156:159], v[76:79]
    s_waitcnt lgkmcnt(0)
    v_exp_f32 v20, v104
    v_mfma_f32_16x16x32_bf16 a[0:3], a[224:227], v[128:131], a[0:3]
    ds_read_b128 a[192:195], v6 offset:8192
    v_cvt_pk_bf16_f32 v147, v26, v27
    v_mfma_f32_16x16x32_bf16 a[32:35], a[224:227], v[132:135], a[32:35]
    v_exp_f32 v21, v105
    v_mfma_f32_16x16x32_bf16 v[28:31], v[44:47], v[144:147], 0
    v_exp_f32 v22, v106
    v_mfma_f32_16x16x32_bf16 a[64:67], a[224:227], v[136:139], a[64:67]
    v_cvt_pk_bf16_f32 v148, v20, v21
    v_exp_f32 v23, v107
    v_mfma_f32_16x16x32_bf16 a[96:99], a[224:227], v[140:143], a[96:99]
    ds_read_b128 a[196:199], v6 offset:9216
    v_cvt_pk_bf16_f32 v149, v22, v23
    v_mfma_f32_16x16x32_bf16 a[4:7], a[228:231], v[128:131], a[4:7]
    v_exp_f32 v24, v108
    v_mfma_f32_16x16x32_bf16 a[36:39], a[228:231], v[132:135], a[36:39]
    buffer_load_dwordx4 v7, s[24:27], s53 offen offset:2048 sc1 lds
    v_mfma_f32_16x16x32_bf16 a[68:71], a[228:231], v[136:139], a[68:71]
    ds_read_b128 a[200:203], v6 offset:10240
    v_exp_f32 v25, v109
    v_mfma_f32_16x16x32_bf16 a[100:103], a[228:231], v[140:143], a[100:103]
    v_exp_f32 v26, v110
    v_mfma_f32_16x16x32_bf16 a[8:11], a[232:235], v[128:131], a[8:11]
    v_cvt_pk_bf16_f32 v150, v24, v25
    v_exp_f32 v27, v111
    v_mfma_f32_16x16x32_bf16 a[40:43], a[232:235], v[132:135], a[40:43]
    ds_read_b128 a[204:207], v6 offset:11264
    v_cvt_pk_bf16_f32 v151, v26, v27
    v_mfma_f32_16x16x32_bf16 a[72:75], a[232:235], v[136:139], a[72:75]
    v_exp_f32 v20, v112
    v_mfma_f32_16x16x32_bf16 v[32:35], v[44:47], v[148:151], 0
    v_exp_f32 v21, v113
    v_mfma_f32_16x16x32_bf16 a[104:107], a[232:235], v[140:143], a[104:107]
    v_exp_f32 v22, v114
    v_mfma_f32_16x16x32_bf16 a[12:15], a[236:239], v[128:131], a[12:15]
    v_cvt_pk_bf16_f32 v152, v20, v21
    v_exp_f32 v23, v115
    v_mfma_f32_16x16x32_bf16 a[44:47], a[236:239], v[132:135], a[44:47]
    v_exp_f32 v24, v116
    v_mfma_f32_16x16x32_bf16 a[76:79], a[236:239], v[136:139], a[76:79]
    v_cvt_pk_bf16_f32 v153, v22, v23
    v_exp_f32 v25, v117
    v_mfma_f32_16x16x32_bf16 a[108:111], a[236:239], v[140:143], a[108:111]
    buffer_load_dwordx4 v7, s[24:27], s53 offen offset:3072 sc1 lds
    v_mfma_f32_16x16x32_bf16 a[16:19], a[240:243], v[128:131], a[16:19]
    s_add_u32 s53, s53, 16384
    v_exp_f32 v26, v118
    v_mfma_f32_16x16x32_bf16 a[48:51], a[240:243], v[132:135], a[48:51]
    v_cvt_pk_bf16_f32 v154, v24, v25
    v_exp_f32 v27, v119
    v_mfma_f32_16x16x32_bf16 a[80:83], a[240:243], v[136:139], a[80:83]
    v_exp_f32 v20, v120
    v_mfma_f32_16x16x32_bf16 a[112:115], a[240:243], v[140:143], a[112:115]
    v_cvt_pk_bf16_f32 v155, v26, v27
    v_exp_f32 v21, v121
    v_mfma_f32_16x16x32_bf16 a[20:23], a[244:247], v[128:131], a[20:23]
    v_exp_f32 v22, v122
    v_mfma_f32_16x16x32_bf16 v[36:39], v[44:47], v[152:155], 0
    v_cvt_pk_bf16_f32 v156, v20, v21
    v_mfma_f32_16x16x32_bf16 a[52:55], a[244:247], v[132:135], a[52:55]
    v_exp_f32 v23, v123
    v_mfma_f32_16x16x32_bf16 a[84:87], a[244:247], v[136:139], a[84:87]
    v_exp_f32 v24, v124
    v_cvt_pk_bf16_f32 v157, v22, v23
    v_mfma_f32_16x16x32_bf16 a[116:119], a[244:247], v[140:143], a[116:119]
    v_exp_f32 v25, v125
    v_mfma_f32_16x16x32_bf16 a[24:27], a[248:251], v[128:131], a[24:27]
    s_add_u32 m0, s56, 16384
    v_exp_f32 v26, v126
    v_mfma_f32_16x16x32_bf16 a[56:59], a[248:251], v[132:135], a[56:59]
    buffer_load_dwordx4 v7, s[28:31], s54 offen offset:0 sc1 lds
    v_mfma_f32_16x16x32_bf16 a[88:91], a[248:251], v[136:139], a[88:91]
    v_cvt_pk_bf16_f32 v158, v24, v25
    v_exp_f32 v27, v127
    v_mfma_f32_16x16x32_bf16 a[120:123], a[248:251], v[140:143], a[120:123]
    ds_read_b128 a[208:211], v6 offset:12288
    v_cvt_pk_bf16_f32 v159, v26, v27
    s_nop 1
    v_mfma_f32_16x16x32_bf16 v[40:43], v[44:47], v[156:159], 0
    s_nop 2
    v_mfma_f32_16x16x32_bf16 a[28:31], a[252:255], v[128:131], a[28:31]
    ds_read_b128 a[212:215], v6 offset:13312
    s_nop 0
    v_mfma_f32_16x16x32_bf16 a[60:63], a[252:255], v[132:135], a[60:63]
    ds_read_b128 a[216:219], v6 offset:14336
    v_max3_f32 v8, v28, v32, v36
    v_mfma_f32_16x16x32_bf16 a[92:95], a[252:255], v[136:139], a[92:95]
    ds_read_b128 a[220:223], v6 offset:15360
    v_max_f32 v8, v8, v40
    v_cmp_nge_f32 vcc, s62, v8
    v_mfma_f32_16x16x32_bf16 a[124:127], a[252:255], v[140:143], a[124:127]
    s_waitcnt lgkmcnt(4)
    s_cbranch_vccnz mega_kernel_stub89
mega_kernel_ret90:
    v_mfma_f32_16x16x32_bf16 v[96:99], a[192:195], a[128:131], v[160:163]
    s_add_u32 s56, s55, s57
    v_exp_f32 v20, v64
    v_mfma_f32_16x16x32_bf16 v[96:99], a[196:199], a[132:135], v[96:99]
    s_add_u32 s55, s55, 32768
    ds_read_b128 a[224:227], v6 offset:24576
    v_add_f32 v12, v12, v28
    v_mfma_f32_16x16x32_bf16 v[96:99], a[200:203], a[136:139], v[96:99]
    s_and_b32 s55, s55, 0x1ffff
    ds_read_b128 a[228:231], v6 offset:25600
    v_add_f32 v13, v13, v32
    v_mfma_f32_16x16x32_bf16 v[96:99], a[204:207], a[140:143], v[96:99]
    buffer_load_dwordx4 v7, s[28:31], s54 offen offset:1024 sc1 lds
    v_mfma_f32_16x16x32_bf16 v[104:107], a[192:195], a[144:147], v[168:171]
    s_bitcmp1_b64 s[58:59], s60
    s_cselect_b32 s62, -1.0, s61
    ds_read_b128 a[232:235], v6 offset:26624
    v_mfma_f32_16x16x32_bf16 v[104:107], a[196:199], a[148:151], v[104:107]
    s_add_u32 s60, s60, 1
    ds_read_b128 a[236:239], v6 offset:27648
    v_mfma_f32_16x16x32_bf16 v[104:107], a[200:203], a[152:155], v[104:107]
    ds_read_b128 a[240:243], v6 offset:28672
    v_mfma_f32_16x16x32_bf16 v[104:107], a[204:207], a[156:159], v[104:107]
    s_waitcnt lgkmcnt(5)
    ds_read_b128 a[244:247], v6 offset:29696
    v_mfma_f32_16x16x32_bf16 v[100:103], a[208:211], a[128:131], v[164:167]
    buffer_load_dwordx4 v7, s[28:31], s54 offen offset:2048 sc1 lds
    v_mfma_f32_16x16x32_bf16 v[100:103], a[212:215], a[132:135], v[100:103]
    ds_read_b128 a[248:251], v6 offset:30720
    v_mfma_f32_16x16x32_bf16 v[100:103], a[216:219], a[136:139], v[100:103]
    ds_read_b128 a[252:255], v6 offset:31744
    v_mfma_f32_16x16x32_bf16 v[100:103], a[220:223], a[140:143], v[100:103]
    v_exp_f32 v21, v65
    v_mfma_f32_16x16x32_bf16 v[108:111], a[208:211], a[144:147], v[172:175]
    v_exp_f32 v22, v66
    v_mfma_f32_16x16x32_bf16 v[108:111], a[212:215], a[148:151], v[108:111]
    buffer_load_dwordx4 v7, s[28:31], s54 offen offset:3072 sc1 lds
    v_mfma_f32_16x16x32_bf16 v[108:111], a[216:219], a[152:155], v[108:111]
    s_add_u32 s54, s54, 16384
    v_cvt_pk_bf16_f32 v128, v20, v21
    v_mfma_f32_16x16x32_bf16 v[108:111], a[220:223], a[156:159], v[108:111]
    s_waitcnt vmcnt(16) lgkmcnt(0)
    v_add_u32 v6, s55, v2
    v_mfma_f32_16x16x32_bf16 a[0:3], a[224:227], v[144:147], a[0:3]
    s_barrier
    v_mfma_f32_16x16x32_bf16 a[32:35], a[224:227], v[148:151], a[32:35]
    ds_read_b128 a[192:195], v6 offset:0
    v_mfma_f32_16x16x32_bf16 a[64:67], a[224:227], v[152:155], a[64:67]
    v_exp_f32 v23, v67
    v_mfma_f32_16x16x32_bf16 a[96:99], a[224:227], v[156:159], a[96:99]
    v_exp_f32 v24, v68
    v_mfma_f32_16x16x32_bf16 a[4:7], a[228:231], v[144:147], a[4:7]
    ds_read_b128 a[196:199], v6 offset:1024
    v_cvt_pk_bf16_f32 v129, v22, v23
    v_mfma_f32_16x16x32_bf16 a[36:39], a[228:231], v[148:151], a[36:39]
    v_exp_f32 v25, v69
    v_mfma_f32_16x16x32_bf16 a[68:71], a[228:231], v[152:155], a[68:71]
    v_exp_f32 v26, v70
    v_mfma_f32_16x16x32_bf16 a[100:103], a[228:231], v[156:159], a[100:103]
    ds_read_b128 a[200:203], v6 offset:2048
    v_cvt_pk_bf16_f32 v130, v24, v25
    v_mfma_f32_16x16x32_bf16 a[8:11], a[232:235], v[144:147], a[8:11]
    v_exp_f32 v27, v71
    v_mfma_f32_16x16x32_bf16 a[40:43], a[232:235], v[148:151], a[40:43]
    v_exp_f32 v20, v72
    v_mfma_f32_16x16x32_bf16 a[72:75], a[232:235], v[152:155], a[72:75]
    ds_read_b128 a[204:207], v6 offset:3072
    v_cvt_pk_bf16_f32 v131, v26, v27
    v_mfma_f32_16x16x32_bf16 a[104:107], a[232:235], v[156:159], a[104:107]
    v_exp_f32 v21, v73
    v_mfma_f32_16x16x32_bf16 v[28:31], v[44:47], v[128:131], 0
    v_exp_f32 v22, v74
    v_mfma_f32_16x16x32_bf16 a[12:15], a[236:239], v[144:147], a[12:15]
    v_cvt_pk_bf16_f32 v132, v20, v21
    v_mfma_f32_16x16x32_bf16 a[44:47], a[236:239], v[148:151], a[44:47]
    v_exp_f32 v23, v75
    v_mfma_f32_16x16x32_bf16 a[76:79], a[236:239], v[152:155], a[76:79]
    v_exp_f32 v24, v76
    v_mfma_f32_16x16x32_bf16 a[108:111], a[236:239], v[156:159], a[108:111]
    v_cvt_pk_bf16_f32 v133, v22, v23
    v_mfma_f32_16x16x32_bf16 a[16:19], a[240:243], v[144:147], a[16:19]
    v_exp_f32 v25, v77
    v_mfma_f32_16x16x32_bf16 a[48:51], a[240:243], v[148:151], a[48:51]
    v_exp_f32 v26, v78
    v_mfma_f32_16x16x32_bf16 a[80:83], a[240:243], v[152:155], a[80:83]
    v_cvt_pk_bf16_f32 v134, v24, v25
    v_mfma_f32_16x16x32_bf16 a[112:115], a[240:243], v[156:159], a[112:115]
    v_exp_f32 v27, v79
    v_mfma_f32_16x16x32_bf16 a[20:23], a[244:247], v[144:147], a[20:23]
    v_cvt_pk_bf16_f32 v135, v26, v27
    v_mfma_f32_16x16x32_bf16 a[52:55], a[244:247], v[148:151], a[52:55]
    v_mfma_f32_16x16x32_bf16 a[84:87], a[244:247], v[152:155], a[84:87]
    v_mfma_f32_16x16x32_bf16 v[32:35], v[44:47], v[132:135], 0
    s_nop 2
    v_mfma_f32_16x16x32_bf16 a[116:119], a[244:247], v[156:159], a[116:119]
    s_nop 2
    v_mfma_f32_16x16x32_bf16 a[24:27], a[248:251], v[144:147], a[24:27]
    v_max_f32 v8, v28, v32
    v_cmp_nge_f32 vcc, s62, v8
    v_mfma_f32_16x16x32_bf16 a[56:59], a[248:251], v[148:151], a[56:59]
    v_mfma_f32_16x16x32_bf16 a[88:91], a[248:251], v[152:155], a[88:91]
    v_mfma_f32_16x16x32_bf16 a[120:123], a[248:251], v[156:159], a[120:123]
    ds_read_b128 a[208:211], v6 offset:4096
    v_mfma_f32_16x16x32_bf16 a[28:31], a[252:255], v[144:147], a[28:31]
    ds_read_b128 a[212:215], v6 offset:5120
    v_mfma_f32_16x16x32_bf16 a[60:63], a[252:255], v[148:151], a[60:63]
    ds_read_b128 a[216:219], v6 offset:6144
    v_mfma_f32_16x16x32_bf16 a[92:95], a[252:255], v[152:155], a[92:95]
    ds_read_b128 a[220:223], v6 offset:7168
    v_mfma_f32_16x16x32_bf16 a[124:127], a[252:255], v[156:159], a[124:127]
    s_waitcnt lgkmcnt(4)
    s_cbranch_vccnz mega_kernel_stub91
mega_kernel_ret92:
    v_add_f32 v20, v14, v36
    v_add_f32 v21, v15, v40
    s_nop 3
    v_rcp_f32 v20, v20
    v_rcp_f32 v21, v21
    s_lshl_b32 s90, s75, 10
    s_add_u32 s90, s90, s78
    s_add_u32 s90, s90, 67108864
    v_accvgpr_read_b32 v48, a64
    v_accvgpr_read_b32 v49, a65
    v_accvgpr_read_b32 v50, a66
    v_accvgpr_read_b32 v51, a67
    v_accvgpr_read_b32 v52, a68
    v_accvgpr_read_b32 v53, a69
    v_accvgpr_read_b32 v54, a70
    v_accvgpr_read_b32 v55, a71
    v_mul_f32 v48, v20, v48
    v_mul_f32 v49, v20, v49
    v_mul_f32 v50, v20, v50
    v_mul_f32 v51, v20, v51
    v_mul_f32 v52, v20, v52
    v_mul_f32 v53, v20, v53
    v_mul_f32 v54, v20, v54
    v_mul_f32 v55, v20, v55
    v_cvt_pk_bf16_f32 v48, v48, v49
    v_cvt_pk_bf16_f32 v49, v50, v51
    v_cvt_pk_bf16_f32 v50, v52, v53
    v_cvt_pk_bf16_f32 v51, v54, v55
    buffer_store_dwordx4 v[48:51], v2, s[8:11], s90 offen offset:0 sc1
    v_accvgpr_read_b32 v56, a96
    v_accvgpr_read_b32 v57, a97
    v_accvgpr_read_b32 v58, a98
    v_accvgpr_read_b32 v59, a99
    v_accvgpr_read_b32 v60, a100
    v_accvgpr_read_b32 v61, a101
    v_accvgpr_read_b32 v62, a102
    v_accvgpr_read_b32 v63, a103
    v_mul_f32 v56, v21, v56
    v_mul_f32 v57, v21, v57
    v_mul_f32 v58, v21, v58
    v_mul_f32 v59, v21, v59
    v_mul_f32 v60, v21, v60
    v_mul_f32 v61, v21, v61
    v_mul_f32 v62, v21, v62
    v_mul_f32 v63, v21, v63
    v_cvt_pk_bf16_f32 v56, v56, v57
    v_cvt_pk_bf16_f32 v57, v58, v59
    v_cvt_pk_bf16_f32 v58, v60, v61
    v_cvt_pk_bf16_f32 v59, v62, v63
    buffer_store_dwordx4 v[56:59], v2, s[8:11], s90 offen offset:1024 sc1
    s_add_u32 s90, s90, 131072
    v_accvgpr_read_b32 v48, a72
    v_accvgpr_read_b32 v49, a73
    v_accvgpr_read_b32 v50, a74
    v_accvgpr_read_b32 v51, a75
    v_accvgpr_read_b32 v52, a76
    v_accvgpr_read_b32 v53, a77
    v_accvgpr_read_b32 v54, a78
    v_accvgpr_read_b32 v55, a79
    v_mul_f32 v48, v20, v48
    v_mul_f32 v49, v20, v49
    v_mul_f32 v50, v20, v50
    v_mul_f32 v51, v20, v51
    v_mul_f32 v52, v20, v52
    v_mul_f32 v53, v20, v53
    v_mul_f32 v54, v20, v54
    v_mul_f32 v55, v20, v55
    v_cvt_pk_bf16_f32 v48, v48, v49
    v_cvt_pk_bf16_f32 v49, v50, v51
    v_cvt_pk_bf16_f32 v50, v52, v53
    v_cvt_pk_bf16_f32 v51, v54, v55
    buffer_store_dwordx4 v[48:51], v2, s[8:11], s90 offen offset:0 sc1
    v_accvgpr_read_b32 v56, a104
    v_accvgpr_read_b32 v57, a105
    v_accvgpr_read_b32 v58, a106
    v_accvgpr_read_b32 v59, a107
    v_accvgpr_read_b32 v60, a108
    v_accvgpr_read_b32 v61, a109
    v_accvgpr_read_b32 v62, a110
    v_accvgpr_read_b32 v63, a111
    v_mul_f32 v56, v21, v56
    v_mul_f32 v57, v21, v57
    v_mul_f32 v58, v21, v58
    v_mul_f32 v59, v21, v59
    v_mul_f32 v60, v21, v60
    v_mul_f32 v61, v21, v61
    v_mul_f32 v62, v21, v62
    v_mul_f32 v63, v21, v63
    v_cvt_pk_bf16_f32 v56, v56, v57
    v_cvt_pk_bf16_f32 v57, v58, v59
    v_cvt_pk_bf16_f32 v58, v60, v61
    v_cvt_pk_bf16_f32 v59, v62, v63
    buffer_store_dwordx4 v[56:59], v2, s[8:11], s90 offen offset:1024 sc1
    s_add_u32 s90, s90, 131072
    v_accvgpr_read_b32 v48, a80
    v_accvgpr_read_b32 v49, a81
    v_accvgpr_read_b32 v50, a82
    v_accvgpr_read_b32 v51, a83
    v_accvgpr_read_b32 v52, a84
    v_accvgpr_read_b32 v53, a85
    v_accvgpr_read_b32 v54, a86
    v_accvgpr_read_b32 v55, a87
    v_mul_f32 v48, v20, v48
    v_mul_f32 v49, v20, v49
    v_mul_f32 v50, v20, v50
    v_mul_f32 v51, v20, v51
    v_mul_f32 v52, v20, v52
    v_mul_f32 v53, v20, v53
    v_mul_f32 v54, v20, v54
    v_mul_f32 v55, v20, v55
    v_cvt_pk_bf16_f32 v48, v48, v49
    v_cvt_pk_bf16_f32 v49, v50, v51
    v_cvt_pk_bf16_f32 v50, v52, v53
    v_cvt_pk_bf16_f32 v51, v54, v55
    buffer_store_dwordx4 v[48:51], v2, s[8:11], s90 offen offset:0 sc1
    v_accvgpr_read_b32 v56, a112
    v_accvgpr_read_b32 v57, a113
    v_accvgpr_read_b32 v58, a114
    v_accvgpr_read_b32 v59, a115
    v_accvgpr_read_b32 v60, a116
    v_accvgpr_read_b32 v61, a117
    v_accvgpr_read_b32 v62, a118
    v_accvgpr_read_b32 v63, a119
    v_mul_f32 v56, v21, v56
    v_mul_f32 v57, v21, v57
    v_mul_f32 v58, v21, v58
    v_mul_f32 v59, v21, v59
    v_mul_f32 v60, v21, v60
    v_mul_f32 v61, v21, v61
    v_mul_f32 v62, v21, v62
    v_mul_f32 v63, v21, v63
    v_cvt_pk_bf16_f32 v56, v56, v57
    v_cvt_pk_bf16_f32 v57, v58, v59
    v_cvt_pk_bf16_f32 v58, v60, v61
    v_cvt_pk_bf16_f32 v59, v62, v63
    buffer_store_dwordx4 v[56:59], v2, s[8:11], s90 offen offset:1024 sc1
    s_add_u32 s90, s90, 131072
    v_accvgpr_read_b32 v48, a88
    v_accvgpr_read_b32 v49, a89
    v_accvgpr_read_b32 v50, a90
    v_accvgpr_read_b32 v51, a91
    v_accvgpr_read_b32 v52, a92
    v_accvgpr_read_b32 v53, a93
    v_accvgpr_read_b32 v54, a94
    v_accvgpr_read_b32 v55, a95
    v_mul_f32 v48, v20, v48
    v_mul_f32 v49, v20, v49
    v_mul_f32 v50, v20, v50
    v_mul_f32 v51, v20, v51
    v_mul_f32 v52, v20, v52
    v_mul_f32 v53, v20, v53
    v_mul_f32 v54, v20, v54
    v_mul_f32 v55, v20, v55
    v_cvt_pk_bf16_f32 v48, v48, v49
    v_cvt_pk_bf16_f32 v49, v50, v51
    v_cvt_pk_bf16_f32 v50, v52, v53
    v_cvt_pk_bf16_f32 v51, v54, v55
    buffer_store_dwordx4 v[48:51], v2, s[8:11], s90 offen offset:0 sc1
    v_accvgpr_read_b32 v56, a120
    v_accvgpr_read_b32 v57, a121
    v_accvgpr_read_b32 v58, a122
    v_accvgpr_read_b32 v59, a123
    v_accvgpr_read_b32 v60, a124
    v_accvgpr_read_b32 v61, a125
    v_accvgpr_read_b32 v62, a126
    v_accvgpr_read_b32 v63, a127
    v_mul_f32 v56, v21, v56
    v_mul_f32 v57, v21, v57
    v_mul_f32 v58, v21, v58
    v_mul_f32 v59, v21, v59
    v_mul_f32 v60, v21, v60
    v_mul_f32 v61, v21, v61
    v_mul_f32 v62, v21, v62
    v_mul_f32 v63, v21, v63
    v_cvt_pk_bf16_f32 v56, v56, v57
    v_cvt_pk_bf16_f32 v57, v58, v59
    v_cvt_pk_bf16_f32 v58, v60, v61
    v_cvt_pk_bf16_f32 v59, v62, v63
    buffer_store_dwordx4 v[56:59], v2, s[8:11], s90 offen offset:1024 sc1
    s_add_u32 s90, s90, 131072
mega_kernel_single93:
    v_mfma_f32_16x16x32_bf16 v[64:67], a[192:195], a[128:131], v[160:163]
    s_bitcmp1_b64 s[58:59], s60
    s_cselect_b32 s62, -1.0, s61
    v_add_f32 v12, v12, v28
    v_mfma_f32_16x16x32_bf16 v[64:67], a[196:199], a[132:135], v[64:67]
    s_mov_b32 m0, s56
    ds_read_b128 a[224:227], v6 offset:16384
    v_add_f32 v13, v13, v32
    v_mfma_f32_16x16x32_bf16 v[64:67], a[200:203], a[136:139], v[64:67]
    buffer_load_dwordx4 v7, s[24:27], s53 offen offset:0 sc1 lds
    v_mfma_f32_16x16x32_bf16 v[64:67], a[204:207], a[140:143], v[64:67]
    s_add_u32 s60, s60, 1
    ds_read_b128 a[228:231], v6 offset:17408
    v_exp_f32 v20, v96
    v_mfma_f32_16x16x32_bf16 v[72:75], a[192:195], a[144:147], v[168:171]
    ds_read_b128 a[232:235], v6 offset:18432
    v_exp_f32 v21, v97
    v_mfma_f32_16x16x32_bf16 v[72:75], a[196:199], a[148:151], v[72:75]
    ds_read_b128 a[236:239], v6 offset:19456
    v_cvt_pk_bf16_f32 v144, v20, v21
    v_mfma_f32_16x16x32_bf16 v[72:75], a[200:203], a[152:155], v[72:75]
    ds_read_b128 a[240:243], v6 offset:20480
    v_exp_f32 v22, v98
    v_mfma_f32_16x16x32_bf16 v[72:75], a[204:207], a[156:159], v[72:75]
    s_waitcnt lgkmcnt(5)
    ds_read_b128 a[244:247], v6 offset:21504
    v_mfma_f32_16x16x32_bf16 v[68:71], a[208:211], a[128:131], v[164:167]
    ds_read_b128 a[248:251], v6 offset:22528
    v_exp_f32 v23, v99
    v_mfma_f32_16x16x32_bf16 v[68:71], a[212:215], a[132:135], v[68:71]
    ds_read_b128 a[252:255], v6 offset:23552
    v_cvt_pk_bf16_f32 v145, v22, v23
    v_mfma_f32_16x16x32_bf16 v[68:71], a[216:219], a[136:139], v[68:71]
    buffer_load_dwordx4 v7, s[24:27], s53 offen offset:1024 sc1 lds
    v_mfma_f32_16x16x32_bf16 v[68:71], a[220:223], a[140:143], v[68:71]
    v_exp_f32 v24, v100
    v_mfma_f32_16x16x32_bf16 v[76:79], a[208:211], a[144:147], v[172:175]
    v_exp_f32 v25, v101
    v_mfma_f32_16x16x32_bf16 v[76:79], a[212:215], a[148:151], v[76:79]
    v_exp_f32 v26, v102
    v_mfma_f32_16x16x32_bf16 v[76:79], a[216:219], a[152:155], v[76:79]
    buffer_load_dwordx4 v7, s[24:27], s53 offen offset:2048 sc1 lds
    v_cvt_pk_bf16_f32 v146, v24, v25
    v_mfma_f32_16x16x32_bf16 v[76:79], a[220:223], a[156:159], v[76:79]
    s_waitcnt lgkmcnt(0)
    v_exp_f32 v27, v103
    v_mfma_f32_16x16x32_bf16 a[0:3], a[224:227], v[128:131], a[0:3]
    ds_read_b128 a[192:195], v6 offset:8192
    v_cvt_pk_bf16_f32 v147, v26, v27
    v_mfma_f32_16x16x32_bf16 a[32:35], a[224:227], v[132:135], a[32:35]
    v_exp_f32 v20, v104
    v_mfma_f32_16x16x32_bf16 v[28:31], v[44:47], v[144:147], 0
    v_exp_f32 v21, v105
    v_mfma_f32_16x16x32_bf16 a[4:7], a[228:231], v[128:131], a[4:7]
    ds_read_b128 a[196:199], v6 offset:9216
    v_exp_f32 v22, v106
    v_mfma_f32_16x16x32_bf16 a[36:39], a[228:231], v[132:135], a[36:39]
    buffer_load_dwordx4 v7, s[24:27], s53 offen offset:3072 sc1 lds
    v_mfma_f32_16x16x32_bf16 a[8:11], a[232:235], v[128:131], a[8:11]
    s_add_u32 s53, s53, 16384
    ds_read_b128 a[200:203], v6 offset:10240
    v_cvt_pk_bf16_f32 v148, v20, v21
    v_mfma_f32_16x16x32_bf16 a[40:43], a[232:235], v[132:135], a[40:43]
    v_exp_f32 v23, v107
    v_mfma_f32_16x16x32_bf16 a[12:15], a[236:239], v[128:131], a[12:15]
    ds_read_b128 a[204:207], v6 offset:11264
    v_exp_f32 v24, v108
    v_mfma_f32_16x16x32_bf16 a[44:47], a[236:239], v[132:135], a[44:47]
    v_cvt_pk_bf16_f32 v149, v22, v23
    v_exp_f32 v25, v109
    v_mfma_f32_16x16x32_bf16 a[16:19], a[240:243], v[128:131], a[16:19]
    v_exp_f32 v26, v110
    v_mfma_f32_16x16x32_bf16 a[48:51], a[240:243], v[132:135], a[48:51]
    v_cvt_pk_bf16_f32 v150, v24, v25
    v_exp_f32 v27, v111
    v_mfma_f32_16x16x32_bf16 a[20:23], a[244:247], v[128:131], a[20:23]
    ds_read_b128 a[208:211], v6 offset:12288
    v_cvt_pk_bf16_f32 v151, v26, v27
    v_mfma_f32_16x16x32_bf16 a[52:55], a[244:247], v[132:135], a[52:55]
    s_add_u32 m0, s56, 16384
    ds_read_b128 a[212:215], v6 offset:13312
    v_mfma_f32_16x16x32_bf16 v[32:35], v[44:47], v[148:151], 0
    s_nop 2
    v_mfma_f32_16x16x32_bf16 a[24:27], a[248:251], v[128:131], a[24:27]
    buffer_load_dwordx4 v7, s[28:31], s54 offen offset:0 sc1 lds
    v_mfma_f32_16x16x32_bf16 a[56:59], a[248:251], v[132:135], a[56:59]
    ds_read_b128 a[216:219], v6 offset:14336
    s_nop 0
    v_mfma_f32_16x16x32_bf16 a[28:31], a[252:255], v[128:131], a[28:31]
    ds_read_b128 a[220:223], v6 offset:15360
    v_max_f32 v8, v28, v32
    v_cmp_nge_f32 vcc, s62, v8
    v_mfma_f32_16x16x32_bf16 a[60:63], a[252:255], v[132:135], a[60:63]
    s_waitcnt lgkmcnt(4)
    s_cbranch_vccnz mega_kernel_stub94
mega_kernel_ret95:
    v_mfma_f32_16x16x32_bf16 v[96:99], a[192:195], a[128:131], v[160:163]
    s_add_u32 s56, s55, s57
    v_exp_f32 v20, v64
    v_mfma_f32_16x16x32_bf16 v[96:99], a[196:199], a[132:135], v[96:99]
    s_add_u32 s55, s55, 32768
    ds_read_b128 a[224:227], v6 offset:24576
    v_add_f32 v12, v12, v28
    v_mfma_f32_16x16x32_bf16 v[96:99], a[200:203], a[136:139], v[96:99]
    s_and_b32 s55, s55, 0x1ffff
    ds_read_b128 a[228:231], v6 offset:25600
    v_exp_f32 v21, v65
    v_mfma_f32_16x16x32_bf16 v[96:99], a[204:207], a[140:143], v[96:99]
    s_bitcmp1_b64 s[58:59], s60
    s_cselect_b32 s62, -1.0, s61
    ds_read_b128 a[232:235], v6 offset:26624
    v_mfma_f32_16x16x32_bf16 v[104:107], a[192:195], a[144:147], v[168:171]
    buffer_load_dwordx4 v7, s[28:31], s54 offen offset:1024 sc1 lds
    v_mfma_f32_16x16x32_bf16 v[104:107], a[196:199], a[148:151], v[104:107]
    s_add_u32 s60, s60, 1
    ds_read_b128 a[236:239], v6 offset:27648
    v_cvt_pk_bf16_f32 v128, v20, v21
    v_mfma_f32_16x16x32_bf16 v[104:107], a[200:203], a[152:155], v[104:107]
    ds_read_b128 a[240:243], v6 offset:28672
    v_exp_f32 v22, v66
    v_mfma_f32_16x16x32_bf16 v[104:107], a[204:207], a[156:159], v[104:107]
    s_waitcnt lgkmcnt(5)
    ds_read_b128 a[244:247], v6 offset:29696
    v_add_f32 v13, v13, v32
    v_mfma_f32_16x16x32_bf16 v[100:103], a[208:211], a[128:131], v[164:167]
    ds_read_b128 a[248:251], v6 offset:30720
    v_exp_f32 v23, v67
    v_mfma_f32_16x16x32_bf16 v[100:103], a[212:215], a[132:135], v[100:103]
    buffer_load_dwordx4 v7, s[28:31], s54 offen offset:2048 sc1 lds
    v_mfma_f32_16x16x32_bf16 v[100:103], a[216:219], a[136:139], v[100:103]
    ds_read_b128 a[252:255], v6 offset:31744
    v_cvt_pk_bf16_f32 v129, v22, v23
    v_mfma_f32_16x16x32_bf16 v[100:103], a[220:223], a[140:143], v[100:103]
    v_exp_f32 v24, v68
    v_mfma_f32_16x16x32_bf16 v[108:111], a[208:211], a[144:147], v[172:175]
    v_exp_f32 v25, v69
    v_mfma_f32_16x16x32_bf16 v[108:111], a[212:215], a[148:151], v[108:111]
    buffer_load_dwordx4 v7, s[28:31], s54 offen offset:3072 sc1 lds
    v_mfma_f32_16x16x32_bf16 v[108:111], a[216:219], a[152:155], v[108:111]
    s_add_u32 s54, s54, 16384
    v_exp_f32 v26, v70
    v_cvt_pk_bf16_f32 v130, v24, v25
    v_mfma_f32_16x16x32_bf16 v[108:111], a[220:223], a[156:159], v[108:111]
    s_waitcnt vmcnt(16) lgkmcnt(0)
    v_add_u32 v6, s55, v2
    v_exp_f32 v27, v71
    v_mfma_f32_16x16x32_bf16 a[0:3], a[224:227], v[144:147], a[0:3]
    s_barrier
    v_mfma_f32_16x16x32_bf16 a[32:35], a[224:227], v[148:151], a[32:35]
    ds_read_b128 a[192:195], v6 offset:0
    v_cvt_pk_bf16_f32 v131, v26, v27
    v_mfma_f32_16x16x32_bf16 a[4:7], a[228:231], v[144:147], a[4:7]
    v_exp_f32 v20, v72
    v_mfma_f32_16x16x32_bf16 v[28:31], v[44:47], v[128:131], 0
    v_exp_f32 v21, v73
    v_mfma_f32_16x16x32_bf16 a[36:39], a[228:231], v[148:151], a[36:39]
    ds_read_b128 a[196:199], v6 offset:1024
    v_cvt_pk_bf16_f32 v132, v20, v21
    v_mfma_f32_16x16x32_bf16 a[8:11], a[232:235], v[144:147], a[8:11]
    v_exp_f32 v22, v74
    v_mfma_f32_16x16x32_bf16 a[40:43], a[232:235], v[148:151], a[40:43]
    ds_read_b128 a[200:203], v6 offset:2048
    v_exp_f32 v23, v75
    v_mfma_f32_16x16x32_bf16 a[12:15], a[236:239], v[144:147], a[12:15]
    v_exp_f32 v24, v76
    v_mfma_f32_16x16x32_bf16 a[44:47], a[236:239], v[148:151], a[44:47]
    ds_read_b128 a[204:207], v6 offset:3072
    v_cvt_pk_bf16_f32 v133, v22, v23
    v_mfma_f32_16x16x32_bf16 a[16:19], a[240:243], v[144:147], a[16:19]
    v_exp_f32 v25, v77
    v_mfma_f32_16x16x32_bf16 a[48:51], a[240:243], v[148:151], a[48:51]
    v_exp_f32 v26, v78
    v_cvt_pk_bf16_f32 v134, v24, v25
    v_mfma_f32_16x16x32_bf16 a[20:23], a[244:247], v[144:147], a[20:23]
    v_exp_f32 v27, v79
    v_mfma_f32_16x16x32_bf16 a[52:55], a[244:247], v[148:151], a[52:55]
    ds_read_b128 a[208:211], v6 offset:4096
    v_cvt_pk_bf16_f32 v135, v26, v27
    s_nop 1
    v_mfma_f32_16x16x32_bf16 v[32:35], v[44:47], v[132:135], 0
    s_nop 2
    v_mfma_f32_16x16x32_bf16 a[24:27], a[248:251], v[144:147], a[24:27]
    ds_read_b128 a[212:215], v6 offset:5120
    s_nop 0
    v_mfma_f32_16x16x32_bf16 a[56:59], a[248:251], v[148:151], a[56:59]
    ds_read_b128 a[216:219], v6 offset:6144
    v_max_f32 v8, v28, v32
    v_mfma_f32_16x16x32_bf16 a[28:31], a[252:255], v[144:147], a[28:31]
    ds_read_b128 a[220:223], v6 offset:7168
    v_cmp_nge_f32 vcc, s62, v8
    v_mfma_f32_16x16x32_bf16 a[60:63], a[252:255], v[148:151], a[60:63]
    s_waitcnt lgkmcnt(4)
    s_cbranch_vccz mega_kernel_single93
    v_cmp_lt_f32 vcc, s61, v8
    s_cmp_lg_u32 s60, s66
    s_cbranch_scc1 mega_kernel_e97
    v_add_f32 v160, v160, v16
    v_mov_b32 v164, v9
    v_add_f32 v172, v172, v16
    v_add_f32 v161, v161, v17
    v_mov_b32 v165, v9
    v_add_f32 v173, v173, v17
    v_add_f32 v162, v162, v18
    v_mov_b32 v166, v9
    v_add_f32 v174, v174, v18
    v_add_f32 v163, v163, v19
    v_mov_b32 v167, v9
    v_add_f32 v175, v175, v19
    s_nop 0
mega_kernel_e97:
    s_cmp_lg_u32 s60, s67
    s_cbranch_scc1 mega_kernel_e98
    v_mov_b32 v160, v9
    v_mov_b32 v168, v9
    v_mov_b32 v172, v9
    v_mov_b32 v161, v9
    v_mov_b32 v169, v9
    v_mov_b32 v173, v9
    v_mov_b32 v162, v9
    v_mov_b32 v170, v9
    v_mov_b32 v174, v9
    v_mov_b32 v163, v9
    v_mov_b32 v171, v9
    v_mov_b32 v175, v9
    s_nop 0
mega_kernel_e98:
    s_cmp_lg_u32 s60, s52
    s_cbranch_scc1 mega_kernel_e100
    v_lshrrev_b32 v62, 3, v1
    v_lshlrev_b32 v62, 11, v62
    v_and_b32 v61, 7, v1
    v_lshl_add_u32 v62, v61, 7, v62
    s_lshr_b32 s90, s2, 3
    s_lshl_b32 s90, s90, 2
    s_add_u32 s90, s90, s16
    s_lshl_b32 s90, s90, 14
    s_and_b32 s91, s2, 1
    s_lshl_b32 s91, s91, 10
    s_add_u32 s90, s90, s91
    s_bitcmp1_b32 s2, 2
    s_cselect_b32 s91, 0, 5373952
    s_mov_b32 s92, 8388608
    s_cselect_b32 s46, 5373952, s92
    s_cselect_b32 s93, 0, 2097152
    s_add_u32 s91, s91, s90
    s_mov_b32 s44, s48
    s_mov_b32 s45, s49
    s_add_u32 s92, s91, 0
    buffer_load_dword v255, v62, s[44:47], s92 offen
    s_add_u32 s92, s91, 2097152
    buffer_load_dword v255, v62, s[44:47], s92 offen
    s_add_u32 s92, s91, 4194304
    buffer_load_dword v255, v62, s[44:47], s92 offen
    s_mov_b32 s44, s50
    s_mov_b32 s45, s51
    s_mov_b32 s46, s93
    buffer_load_dword v255, v62, s[44:47], s90 offen
mega_kernel_e100:
    s_cmp_gt_u32 s60, 26
    s_cbranch_scc1 mega_kernel_e99
    s_cmp_lg_u32 s60, 6
    s_cbranch_scc1 mega_kernel_e101
    s_cmp_eq_u32 s17, -1
    s_cbranch_scc1 mega_kernel_e99
    s_cmp_lg_u32 s16, 0
    s_cbranch_scc1 mega_kernel_np102
    v_mov_b32 v4, s4
    v_mov_b32 v5, s5
    s_add_u32 s90, s17, 117440512
    s_mov_b64 exec, 1
    buffer_store_dwordx2 v[4:5], off, s[8:11], s90 sc1
    s_mov_b64 exec, -1
mega_kernel_np102:
    s_branch mega_kernel_e99
mega_kernel_e101:
    s_cmp_lg_u32 s60, 22
    s_cbranch_scc1 mega_kernel_e103
    buffer_load_dwordx2 v[4:5], v10, s[8:11], 0 offen sc1
    s_mov_b32 s44, s48
    s_mov_b32 s45, s49
    s_mov_b32 s46, 8388608
    s_lshl_b32 s90, s2, 2
    s_add_u32 s90, s90, s16
    s_lshl_b32 s90, s90, 13
    v_lshlrev_b32 v62, 7, v1
    buffer_load_dword v255, v62, s[44:47], s90 offen
    s_branch mega_kernel_e99
mega_kernel_e103:
    s_cmp_lg_u32 s60, 26
    s_cbranch_scc1 mega_kernel_e104
    s_mov_b32 s44, s50
    s_mov_b32 s45, s51
    s_mov_b32 s46, 2097152
    s_lshl_b32 s90, s2, 2
    s_add_u32 s90, s90, s16
    s_lshl_b32 s90, s90, 13
    v_lshlrev_b32 v62, 7, v1
    buffer_load_dword v255, v62, s[44:47], s90 offen
    s_waitcnt vmcnt(18)
    s_mov_b32 s3, 1048576
mega_kernel_spin105:
    v_cmp_ne_u64 s[72:73], s[4:5], v[4:5]
    s_nop 3
    s_cmp_eq_u64 s[72:73], 0
    s_cbranch_scc1 mega_kernel_e99
    s_sub_u32 s3, s3, 1
    s_cbranch_scc1 mega_kernel_e99
    s_sleep 32
    buffer_load_dwordx2 v[4:5], v10, s[8:11], 0 offen sc1
    s_waitcnt vmcnt(0)
    s_branch mega_kernel_spin105
    s_branch mega_kernel_e99
mega_kernel_e104:
mega_kernel_e99:
    s_cbranch_vccnz mega_kernel_rc106
mega_kernel_sp96:
    s_cmp_lg_u32 s60, s68
    s_cbranch_scc1 mega_kernel_single93
    ds_read_b128 a[224:227], v6 offset:16384
    ds_read_b128 a[228:231], v6 offset:17408
    ds_read_b128 a[232:235], v6 offset:18432
    ds_read_b128 a[236:239], v6 offset:19456
    ds_read_b128 a[240:243], v6 offset:20480
    ds_read_b128 a[244:247], v6 offset:21504
    ds_read_b128 a[248:251], v6 offset:22528
    ds_read_b128 a[252:255], v6 offset:23552
    s_waitcnt lgkmcnt(0)
    v_mfma_f32_16x16x32_bf16 a[0:3], a[224:227], v[128:131], a[0:3]
    buffer_load_dwordx4 v[192:195], v2, s[8:11], s79 offen offset:0 sc1
    v_exp_f32 v20, v96
    v_mfma_f32_16x16x32_bf16 a[32:35], a[224:227], v[132:135], a[32:35]
    v_exp_f32 v21, v97
    v_exp_f32 v22, v98
    v_mfma_f32_16x16x32_bf16 a[4:7], a[228:231], v[128:131], a[4:7]
    buffer_load_dwordx4 v[196:199], v2, s[8:11], s79 offen offset:1024 sc1
    v_cvt_pk_bf16_f32 v144, v20, v21
    v_add_f32 v12, v12, v28
    v_mfma_f32_16x16x32_bf16 a[36:39], a[228:231], v[132:135], a[36:39]
    v_exp_f32 v23, v99
    v_exp_f32 v24, v100
    v_cvt_pk_bf16_f32 v145, v22, v23
    v_mfma_f32_16x16x32_bf16 a[8:11], a[232:235], v[128:131], a[8:11]
    buffer_load_dwordx4 v[200:203], v2, s[8:11], s79 offen offset:2048 sc1
    v_exp_f32 v25, v101
    v_mfma_f32_16x16x32_bf16 a[40:43], a[232:235], v[132:135], a[40:43]
    v_exp_f32 v26, v102
    v_cvt_pk_bf16_f32 v146, v24, v25
    v_add_f32 v13, v13, v32
    v_mfma_f32_16x16x32_bf16 a[12:15], a[236:239], v[128:131], a[12:15]
    buffer_load_dwordx4 v[204:207], v2, s[8:11], s79 offen offset:3072 sc1
    v_exp_f32 v27, v103
    v_mfma_f32_16x16x32_bf16 a[44:47], a[236:239], v[132:135], a[44:47]
    v_exp_f32 v20, v104
    v_cvt_pk_bf16_f32 v147, v26, v27
    v_mfma_f32_16x16x32_bf16 a[16:19], a[240:243], v[128:131], a[16:19]
    buffer_load_dwordx4 v[212:215], v2, s[8:11], s80 offen offset:0 sc1
    v_exp_f32 v21, v105
    v_mfma_f32_16x16x32_bf16 v[28:31], v[44:47], v[144:147], 0
    v_exp_f32 v22, v106
    v_cvt_pk_bf16_f32 v148, v20, v21
    v_exp_f32 v23, v107
    v_mfma_f32_16x16x32_bf16 a[48:51], a[240:243], v[132:135], a[48:51]
    v_exp_f32 v24, v108
    v_cvt_pk_bf16_f32 v149, v22, v23
    v_exp_f32 v25, v109
    v_mfma_f32_16x16x32_bf16 a[20:23], a[244:247], v[128:131], a[20:23]
    buffer_load_dwordx4 v[216:219], v2, s[8:11], s80 offen offset:1024 sc1
    v_exp_f32 v26, v110
    v_mfma_f32_16x16x32_bf16 a[52:55], a[244:247], v[132:135], a[52:55]
    v_cvt_pk_bf16_f32 v150, v24, v25
    v_exp_f32 v27, v111
    s_nop 0
    v_cvt_pk_bf16_f32 v151, v26, v27
    s_nop 1
    v_mfma_f32_16x16x32_bf16 v[32:35], v[44:47], v[148:151], 0
    s_nop 2
    v_mfma_f32_16x16x32_bf16 a[24:27], a[248:251], v[128:131], a[24:27]
    buffer_load_dwordx4 v[220:223], v2, s[8:11], s80 offen offset:2048 sc1
    v_mfma_f32_16x16x32_bf16 a[56:59], a[248:251], v[132:135], a[56:59]
    s_nop 2
    v_mfma_f32_16x16x32_bf16 a[28:31], a[252:255], v[128:131], a[28:31]
    v_max_f32 v8, v28, v32
    v_cmp_nge_f32 vcc, s61, v8
    v_mfma_f32_16x16x32_bf16 a[60:63], a[252:255], v[132:135], a[60:63]
    s_cbranch_vccnz mega_kernel_stub107
mega_kernel_ret108:
    s_nop 1
    ds_read_b128 a[224:227], v6 offset:24576
    ds_read_b128 a[228:231], v6 offset:25600
    ds_read_b128 a[232:235], v6 offset:26624
    ds_read_b128 a[236:239], v6 offset:27648
    ds_read_b128 a[240:243], v6 offset:28672
    ds_read_b128 a[244:247], v6 offset:29696
    ds_read_b128 a[248:251], v6 offset:30720
    ds_read_b128 a[252:255], v6 offset:31744
    s_waitcnt lgkmcnt(0)
    v_mfma_f32_16x16x32_bf16 a[0:3], a[224:227], v[144:147], a[0:3]
    buffer_load_dwordx4 v[224:227], v2, s[8:11], s80 offen offset:3072 sc1
    v_mfma_f32_16x16x32_bf16 a[32:35], a[224:227], v[148:151], a[32:35]
    v_mfma_f32_16x16x32_bf16 a[4:7], a[228:231], v[144:147], a[4:7]
    buffer_load_dwordx4 v[208:211], v2, s[8:11], s81 offen offset:0 sc1
    v_mfma_f32_16x16x32_bf16 a[36:39], a[228:231], v[148:151], a[36:39]
    v_mfma_f32_16x16x32_bf16 a[8:11], a[232:235], v[144:147], a[8:11]
    buffer_load_dwordx4 v[232:235], v2, s[8:11], s82 offen offset:0 sc1
    v_mfma_f32_16x16x32_bf16 a[40:43], a[232:235], v[148:151], a[40:43]
    v_mfma_f32_16x16x32_bf16 a[12:15], a[236:239], v[144:147], a[12:15]
    buffer_load_dwordx4 v[236:239], v2, s[8:11], s82 offen offset:1024 sc1
    v_mfma_f32_16x16x32_bf16 a[44:47], a[236:239], v[148:151], a[44:47]
    v_mfma_f32_16x16x32_bf16 a[16:19], a[240:243], v[144:147], a[16:19]
    buffer_load_dwordx4 v[228:231], v2, s[8:11], s83 offen offset:0 sc1
    v_mfma_f32_16x16x32_bf16 a[48:51], a[240:243], v[148:151], a[48:51]
    v_mfma_f32_16x16x32_bf16 a[20:23], a[244:247], v[144:147], a[20:23]
    buffer_load_dwordx4 v[244:247], v2, s[8:11], s84 offen offset:0 sc1
    v_mfma_f32_16x16x32_bf16 a[52:55], a[244:247], v[148:151], a[52:55]
    v_mfma_f32_16x16x32_bf16 a[24:27], a[248:251], v[144:147], a[24:27]
    buffer_load_dwordx4 v[248:251], v2, s[8:11], s84 offen offset:1024 sc1
    v_mfma_f32_16x16x32_bf16 a[56:59], a[248:251], v[148:151], a[56:59]
    v_mfma_f32_16x16x32_bf16 a[28:31], a[252:255], v[144:147], a[28:31]
    buffer_load_dwordx4 v[240:243], v2, s[8:11], s85 offen offset:0 sc1
    v_mfma_f32_16x16x32_bf16 a[60:63], a[252:255], v[148:151], a[60:63]
    v_add_f32 v20, v12, v28
    v_add_f32 v21, v13, v32
    s_nop 3
    v_rcp_f32 v20, v20
    v_rcp_f32 v21, v21
    s_lshl_b32 s90, s74, 10
    s_add_u32 s90, s90, s78
    s_add_u32 s90, s90, 67108864
    v_accvgpr_read_b32 v48, a0
    v_accvgpr_read_b32 v49, a1
    v_accvgpr_read_b32 v50, a2
    v_accvgpr_read_b32 v51, a3
    v_accvgpr_read_b32 v52, a4
    v_accvgpr_read_b32 v53, a5
    v_accvgpr_read_b32 v54, a6
    v_accvgpr_read_b32 v55, a7
    v_mul_f32 v48, v20, v48
    v_mul_f32 v49, v20, v49
    v_mul_f32 v50, v20, v50
    v_mul_f32 v51, v20, v51
    v_mul_f32 v52, v20, v52
    v_mul_f32 v53, v20, v53
    v_mul_f32 v54, v20, v54
    v_mul_f32 v55, v20, v55
    v_cvt_pk_bf16_f32 v48, v48, v49
    v_cvt_pk_bf16_f32 v49, v50, v51
    v_cvt_pk_bf16_f32 v50, v52, v53
    v_cvt_pk_bf16_f32 v51, v54, v55
    buffer_store_dwordx4 v[48:51], v2, s[8:11], s90 offen offset:0 sc1
    v_accvgpr_read_b32 v56, a32
    v_accvgpr_read_b32 v57, a33
    v_accvgpr_read_b32 v58, a34
    v_accvgpr_read_b32 v59, a35
    v_accvgpr_read_b32 v60, a36
    v_accvgpr_read_b32 v61, a37
    v_accvgpr_read_b32 v62, a38
    v_accvgpr_read_b32 v63, a39
    v_mul_f32 v56, v21, v56
    v_mul_f32 v57, v21, v57
    v_mul_f32 v58, v21, v58
    v_mul_f32 v59, v21, v59
    v_mul_f32 v60, v21, v60
    v_mul_f32 v61, v21, v61
    v_mul_f32 v62, v21, v62
    v_mul_f32 v63, v21, v63
    v_cvt_pk_bf16_f32 v56, v56, v57
    v_cvt_pk_bf16_f32 v57, v58, v59
    v_cvt_pk_bf16_f32 v58, v60, v61
    v_cvt_pk_bf16_f32 v59, v62, v63
    buffer_store_dwordx4 v[56:59], v2, s[8:11], s90 offen offset:1024 sc1
    s_add_u32 s90, s90, 131072
    v_accvgpr_read_b32 v48, a8
    v_accvgpr_read_b32 v49, a9
    v_accvgpr_read_b32 v50, a10
    v_accvgpr_read_b32 v51, a11
    v_accvgpr_read_b32 v52, a12
    v_accvgpr_read_b32 v53, a13
    v_accvgpr_read_b32 v54, a14
    v_accvgpr_read_b32 v55, a15
    v_mul_f32 v48, v20, v48
    v_mul_f32 v49, v20, v49
    v_mul_f32 v50, v20, v50
    v_mul_f32 v51, v20, v51
    v_mul_f32 v52, v20, v52
    v_mul_f32 v53, v20, v53
    v_mul_f32 v54, v20, v54
    v_mul_f32 v55, v20, v55
    v_cvt_pk_bf16_f32 v48, v48, v49
    v_cvt_pk_bf16_f32 v49, v50, v51
    v_cvt_pk_bf16_f32 v50, v52, v53
    v_cvt_pk_bf16_f32 v51, v54, v55
    buffer_store_dwordx4 v[48:51], v2, s[8:11], s90 offen offset:0 sc1
    v_accvgpr_read_b32 v56, a40
    v_accvgpr_read_b32 v57, a41
    v_accvgpr_read_b32 v58, a42
    v_accvgpr_read_b32 v59, a43
    v_accvgpr_read_b32 v60, a44
    v_accvgpr_read_b32 v61, a45
    v_accvgpr_read_b32 v62, a46
    v_accvgpr_read_b32 v63, a47
    v_mul_f32 v56, v21, v56
    v_mul_f32 v57, v21, v57
    v_mul_f32 v58, v21, v58
    v_mul_f32 v59, v21, v59
    v_mul_f32 v60, v21, v60
    v_mul_f32 v61, v21, v61
    v_mul_f32 v62, v21, v62
    v_mul_f32 v63, v21, v63
    v_cvt_pk_bf16_f32 v56, v56, v57
    v_cvt_pk_bf16_f32 v57, v58, v59
    v_cvt_pk_bf16_f32 v58, v60, v61
    v_cvt_pk_bf16_f32 v59, v62, v63
    buffer_store_dwordx4 v[56:59], v2, s[8:11], s90 offen offset:1024 sc1
    s_add_u32 s90, s90, 131072
    v_accvgpr_read_b32 v48, a16
    v_accvgpr_read_b32 v49, a17
    v_accvgpr_read_b32 v50, a18
    v_accvgpr_read_b32 v51, a19
    v_accvgpr_read_b32 v52, a20
    v_accvgpr_read_b32 v53, a21
    v_accvgpr_read_b32 v54, a22
    v_accvgpr_read_b32 v55, a23
    v_mul_f32 v48, v20, v48
    v_mul_f32 v49, v20, v49
    v_mul_f32 v50, v20, v50
    v_mul_f32 v51, v20, v51
    v_mul_f32 v52, v20, v52
    v_mul_f32 v53, v20, v53
    v_mul_f32 v54, v20, v54
    v_mul_f32 v55, v20, v55
    v_cvt_pk_bf16_f32 v48, v48, v49
    v_cvt_pk_bf16_f32 v49, v50, v51
    v_cvt_pk_bf16_f32 v50, v52, v53
    v_cvt_pk_bf16_f32 v51, v54, v55
    buffer_store_dwordx4 v[48:51], v2, s[8:11], s90 offen offset:0 sc1
    v_accvgpr_read_b32 v56, a48
    v_accvgpr_read_b32 v57, a49
    v_accvgpr_read_b32 v58, a50
    v_accvgpr_read_b32 v59, a51
    v_accvgpr_read_b32 v60, a52
    v_accvgpr_read_b32 v61, a53
    v_accvgpr_read_b32 v62, a54
    v_accvgpr_read_b32 v63, a55
    v_mul_f32 v56, v21, v56
    v_mul_f32 v57, v21, v57
    v_mul_f32 v58, v21, v58
    v_mul_f32 v59, v21, v59
    v_mul_f32 v60, v21, v60
    v_mul_f32 v61, v21, v61
    v_mul_f32 v62, v21, v62
    v_mul_f32 v63, v21, v63
    v_cvt_pk_bf16_f32 v56, v56, v57
    v_cvt_pk_bf16_f32 v57, v58, v59
    v_cvt_pk_bf16_f32 v58, v60, v61
    v_cvt_pk_bf16_f32 v59, v62, v63
    buffer_store_dwordx4 v[56:59], v2, s[8:11], s90 offen offset:1024 sc1
    s_add_u32 s90, s90, 131072
    v_accvgpr_read_b32 v48, a24
    v_accvgpr_read_b32 v49, a25
    v_accvgpr_read_b32 v50, a26
    v_accvgpr_read_b32 v51, a27
    v_accvgpr_read_b32 v52, a28
    v_accvgpr_read_b32 v53, a29
    v_accvgpr_read_b32 v54, a30
    v_accvgpr_read_b32 v55, a31
    v_mul_f32 v48, v20, v48
    v_mul_f32 v49, v20, v49
    v_mul_f32 v50, v20, v50
    v_mul_f32 v51, v20, v51
    v_mul_f32 v52, v20, v52
    v_mul_f32 v53, v20, v53
    v_mul_f32 v54, v20, v54
    v_mul_f32 v55, v20, v55
    v_cvt_pk_bf16_f32 v48, v48, v49
    v_cvt_pk_bf16_f32 v49, v50, v51
    v_cvt_pk_bf16_f32 v50, v52, v53
    v_cvt_pk_bf16_f32 v51, v54, v55
    buffer_store_dwordx4 v[48:51], v2, s[8:11], s90 offen offset:0 sc1
    v_accvgpr_read_b32 v56, a56
    v_accvgpr_read_b32 v57, a57
    v_accvgpr_read_b32 v58, a58
    v_accvgpr_read_b32 v59, a59
    v_accvgpr_read_b32 v60, a60
    v_accvgpr_read_b32 v61, a61
    v_accvgpr_read_b32 v62, a62
    v_accvgpr_read_b32 v63, a63
    v_mul_f32 v56, v21, v56
    v_mul_f32 v57, v21, v57
    v_mul_f32 v58, v21, v58
    v_mul_f32 v59, v21, v59
    v_mul_f32 v60, v21, v60
    v_mul_f32 v61, v21, v61
    v_mul_f32 v62, v21, v62
    v_mul_f32 v63, v21, v63
    v_cvt_pk_bf16_f32 v56, v56, v57
    v_cvt_pk_bf16_f32 v57, v58, v59
    v_cvt_pk_bf16_f32 v58, v60, v61
    v_cvt_pk_bf16_f32 v59, v62, v63
    buffer_store_dwordx4 v[56:59], v2, s[8:11], s90 offen offset:1024 sc1
    s_add_u32 s90, s90, 131072
    v_and_b32 v48, 15, v1
    v_lshrrev_b32 v49, 4, v1
    v_lshlrev_b32 v49, 2, v49
    v_sub_u32 v48, v48, v49
    v_cmp_ge_i32 vcc, -9, v48
    v_subrev_u32 v50, 0, v48
    v_cmp_ge_u32 s[72:73], 7, v50
    s_nop 0
    v_cndmask_b32 v64, v9, 0, vcc
    v_cndmask_b32 v68, v9, 0, s[72:73]
    v_cmp_ge_i32 vcc, -8, v48
    v_subrev_u32 v50, 1, v48
    v_cmp_ge_u32 s[72:73], 7, v50
    s_nop 0
    v_cndmask_b32 v65, v9, 0, vcc
    v_cndmask_b32 v69, v9, 0, s[72:73]
    v_cmp_ge_i32 vcc, -7, v48
    v_subrev_u32 v50, 2, v48
    v_cmp_ge_u32 s[72:73], 7, v50
    s_nop 0
    v_cndmask_b32 v66, v9, 0, vcc
    v_cndmask_b32 v70, v9, 0, s[72:73]
    v_cmp_ge_i32 vcc, -6, v48
    v_subrev_u32 v50, 3, v48
    v_cmp_ge_u32 s[72:73], 7, v50
    s_nop 0
    v_cndmask_b32 v67, v9, 0, vcc
    v_cndmask_b32 v71, v9, 0, s[72:73]
    s_cmp_eq_u32 s77, 0
    s_cselect_b64 vcc, -1, 0
    s_nop 0
    v_cndmask_b32 v72, v64, v9, vcc
    v_cndmask_b32 v73, v65, v9, vcc
    v_cndmask_b32 v74, v66, v9, vcc
    v_cndmask_b32 v75, v67, v9, vcc
    s_waitcnt vmcnt(8)
    s_nop 0
    v_mfma_f32_16x16x32_bf16 v[80:83], v[208:211], v[192:195], v[72:75]
    v_mfma_f32_16x16x32_bf16 v[84:87], v[212:215], v[192:195], v[68:71]
    v_mfma_f32_16x16x32_bf16 v[88:91], v[212:215], v[196:199], v[64:67]
    v_mfma_f32_16x16x32_bf16 v[92:95], v[216:219], v[196:199], v[68:71]
    v_mfma_f32_16x16x32_bf16 v[96:99], v[216:219], v[200:203], v[64:67]
    v_mfma_f32_16x16x32_bf16 v[100:103], v[220:223], v[200:203], v[68:71]
    v_mfma_f32_16x16x32_bf16 v[104:107], v[220:223], v[204:207], v[64:67]
    v_mfma_f32_16x16x32_bf16 v[108:111], v[224:227], v[204:207], v[68:71]
    s_nop 7
    v_max3_f32 v112, v80, v81, v82
    v_max3_f32 v113, v88, v89, v90
    v_max3_f32 v114, v96, v97, v98
    v_max3_f32 v115, v104, v105, v106
    v_max3_f32 v112, v112, v83, v84
    v_max3_f32 v113, v113, v91, v92
    v_max3_f32 v114, v114, v99, v100
    v_max3_f32 v115, v115, v107, v108
    v_max3_f32 v112, v112, v85, v86
    v_max3_f32 v113, v113, v93, v94
    v_max3_f32 v114, v114, v101, v102
    v_max3_f32 v115, v115, v109, v110
    v_max_f32 v112, v112, v87
    v_max_f32 v113, v113, v95
    v_max_f32 v114, v114, v103
    v_max_f32 v115, v115, v111
    v_mov_b32 v116, v112
    v_mov_b32 v117, v113
    v_mov_b32 v118, v114
    v_mov_b32 v119, v115
    s_nop 1
    v_permlane32_swap_b32 v112, v116
    v_permlane32_swap_b32 v113, v117
    v_permlane32_swap_b32 v114, v118
    v_permlane32_swap_b32 v115, v119
    s_nop 1
    v_max_f32 v112, v112, v116
    v_max_f32 v113, v113, v117
    v_max_f32 v114, v114, v118
    v_max_f32 v115, v115, v119
    v_mov_b32 v116, v112
    v_mov_b32 v117, v113
    v_mov_b32 v118, v114
    v_mov_b32 v119, v115
    s_nop 1
    v_permlane16_swap_b32 v112, v116
    v_permlane16_swap_b32 v113, v117
    v_permlane16_swap_b32 v114, v118
    v_permlane16_swap_b32 v115, v119
    s_nop 1
    v_max_f32 v112, v112, v116
    v_max_f32 v113, v113, v117
    v_max_f32 v114, v114, v118
    v_max_f32 v115, v115, v119
    v_sub_f32 v80, v80, v112
    v_sub_f32 v81, v81, v112
    v_sub_f32 v82, v82, v112
    v_sub_f32 v83, v83, v112
    v_sub_f32 v84, v84, v112
    v_sub_f32 v85, v85, v112
    v_sub_f32 v86, v86, v112
    v_sub_f32 v87, v87, v112
    v_sub_f32 v88, v88, v113
    v_sub_f32 v89, v89, v113
    v_sub_f32 v90, v90, v113
    v_sub_f32 v91, v91, v113
    v_sub_f32 v92, v92, v113
    v_sub_f32 v93, v93, v113
    v_sub_f32 v94, v94, v113
    v_sub_f32 v95, v95, v113
    v_sub_f32 v96, v96, v114
    v_sub_f32 v97, v97, v114
    v_sub_f32 v98, v98, v114
    v_sub_f32 v99, v99, v114
    v_sub_f32 v100, v100, v114
    v_sub_f32 v101, v101, v114
    v_sub_f32 v102, v102, v114
    v_sub_f32 v103, v103, v114
    v_sub_f32 v104, v104, v115
    v_sub_f32 v105, v105, v115
    v_sub_f32 v106, v106, v115
    v_sub_f32 v107, v107, v115
    v_sub_f32 v108, v108, v115
    v_sub_f32 v109, v109, v115
    v_sub_f32 v110, v110, v115
    v_sub_f32 v111, v111, v115
    v_exp_f32 v80, v80
    v_exp_f32 v81, v81
    v_exp_f32 v82, v82
    v_exp_f32 v83, v83
    v_exp_f32 v84, v84
    v_exp_f32 v85, v85
    v_exp_f32 v86, v86
    v_exp_f32 v87, v87
    v_exp_f32 v88, v88
    v_exp_f32 v89, v89
    v_exp_f32 v90, v90
    v_exp_f32 v91, v91
    v_exp_f32 v92, v92
    v_exp_f32 v93, v93
    v_exp_f32 v94, v94
    v_exp_f32 v95, v95
    v_exp_f32 v96, v96
    v_exp_f32 v97, v97
    v_exp_f32 v98, v98
    v_exp_f32 v99, v99
    v_exp_f32 v100, v100
    v_exp_f32 v101, v101
    v_exp_f32 v102, v102
    v_exp_f32 v103, v103
    v_exp_f32 v104, v104
    v_exp_f32 v105, v105
    v_exp_f32 v106, v106
    v_exp_f32 v107, v107
    v_exp_f32 v108, v108
    v_exp_f32 v109, v109
    v_exp_f32 v110, v110
    v_exp_f32 v111, v111
    v_cvt_pk_bf16_f32 v192, v80, v81
    v_cvt_pk_bf16_f32 v193, v82, v83
    v_cvt_pk_bf16_f32 v194, v84, v85
    v_cvt_pk_bf16_f32 v195, v86, v87
    v_cvt_pk_bf16_f32 v196, v88, v89
    v_cvt_pk_bf16_f32 v197, v90, v91
    v_cvt_pk_bf16_f32 v198, v92, v93
    v_cvt_pk_bf16_f32 v199, v94, v95
    v_cvt_pk_bf16_f32 v200, v96, v97
    v_cvt_pk_bf16_f32 v201, v98, v99
    v_cvt_pk_bf16_f32 v202, v100, v101
    v_cvt_pk_bf16_f32 v203, v102, v103
    v_cvt_pk_bf16_f32 v204, v104, v105
    v_cvt_pk_bf16_f32 v205, v106, v107
    v_cvt_pk_bf16_f32 v206, v108, v109
    v_cvt_pk_bf16_f32 v207, v110, v111
    v_add_f32 v112, v80, v81
    v_add_f32 v113, v88, v89
    v_add_f32 v114, v96, v97
    v_add_f32 v115, v104, v105
    v_mfma_f32_16x16x32_bf16 v[128:131], v[230:233], v[192:195], 0
    v_mfma_f32_16x16x32_bf16 v[132:135], v[242:245], v[192:195], 0
    v_mfma_f32_16x16x32_bf16 v[136:139], v[232:235], v[196:199], 0
    v_mfma_f32_16x16x32_bf16 v[140:143], v[244:247], v[196:199], 0
    v_mfma_f32_16x16x32_bf16 v[144:147], v[234:237], v[200:203], 0
    v_mfma_f32_16x16x32_bf16 v[148:151], v[246:249], v[200:203], 0
    v_mfma_f32_16x16x32_bf16 v[152:155], v[236:239], v[204:207], 0
    v_mfma_f32_16x16x32_bf16 v[156:159], v[248:251], v[204:207], 0
    v_add_f32 v112, v112, v82
    v_add_f32 v113, v113, v90
    v_add_f32 v114, v114, v98
    v_add_f32 v115, v115, v106
    v_add_f32 v112, v112, v83
    v_add_f32 v113, v113, v91
    v_add_f32 v114, v114, v99
    v_add_f32 v115, v115, v107
    v_add_f32 v112, v112, v84
    v_add_f32 v113, v113, v92
    v_add_f32 v114, v114, v100
    v_add_f32 v115, v115, v108
    v_add_f32 v112, v112, v85
    v_add_f32 v113, v113, v93
    v_add_f32 v114, v114, v101
    v_add_f32 v115, v115, v109
    v_add_f32 v112, v112, v86
    v_add_f32 v113, v113, v94
    v_add_f32 v114, v114, v102
    v_add_f32 v115, v115, v110
    v_add_f32 v112, v112, v87
    v_add_f32 v113, v113, v95
    v_add_f32 v114, v114, v103
    v_add_f32 v115, v115, v111
    v_mov_b32 v116, v112
    v_mov_b32 v117, v113
    v_mov_b32 v118, v114
    v_mov_b32 v119, v115
    s_nop 1
    v_permlane32_swap_b32 v112, v116
    v_permlane32_swap_b32 v113, v117
    v_permlane32_swap_b32 v114, v118
    v_permlane32_swap_b32 v115, v119
    s_nop 1
    v_add_f32 v112, v112, v116
    v_add_f32 v113, v113, v117
    v_add_f32 v114, v114, v118
    v_add_f32 v115, v115, v119
    v_mov_b32 v116, v112
    v_mov_b32 v117, v113
    v_mov_b32 v118, v114
    v_mov_b32 v119, v115
    s_nop 1
    v_permlane16_swap_b32 v112, v116
    v_permlane16_swap_b32 v113, v117
    v_permlane16_swap_b32 v114, v118
    v_permlane16_swap_b32 v115, v119
    s_nop 1
    v_add_f32 v112, v112, v116
    v_add_f32 v113, v113, v117
    v_add_f32 v114, v114, v118
    v_add_f32 v115, v115, v119
    v_rcp_f32 v112, v112
    v_rcp_f32 v113, v113
    v_rcp_f32 v114, v114
    v_rcp_f32 v115, v115
    s_lshl_b32 s90, s76, 10
    s_lshr_b32 s91, s2, 3
    s_lshl_b32 s91, s91, 17
    s_add_u32 s90, s90, s91
    s_add_u32 s90, s90, 83886080
    v_mul_f32 v128, v128, v112
    v_mul_f32 v129, v129, v112
    v_mul_f32 v130, v130, v112
    v_mul_f32 v131, v131, v112
    v_mul_f32 v132, v132, v112
    v_mul_f32 v133, v133, v112
    v_mul_f32 v134, v134, v112
    v_mul_f32 v135, v135, v112
    v_cvt_pk_bf16_f32 v128, v128, v129
    v_cvt_pk_bf16_f32 v129, v130, v131
    v_cvt_pk_bf16_f32 v130, v132, v133
    v_cvt_pk_bf16_f32 v131, v134, v135
    buffer_store_dwordx4 v[128:131], v2, s[8:11], s90 offen offset:0 sc1
    v_mul_f32 v136, v136, v113
    v_mul_f32 v137, v137, v113
    v_mul_f32 v138, v138, v113
    v_mul_f32 v139, v139, v113
    v_mul_f32 v140, v140, v113
    v_mul_f32 v141, v141, v113
    v_mul_f32 v142, v142, v113
    v_mul_f32 v143, v143, v113
    v_cvt_pk_bf16_f32 v136, v136, v137
    v_cvt_pk_bf16_f32 v137, v138, v139
    v_cvt_pk_bf16_f32 v138, v140, v141
    v_cvt_pk_bf16_f32 v139, v142, v143
    buffer_store_dwordx4 v[136:139], v2, s[8:11], s90 offen offset:1024 sc1
    v_mul_f32 v144, v144, v114
    v_mul_f32 v145, v145, v114
    v_mul_f32 v146, v146, v114
    v_mul_f32 v147, v147, v114
    v_mul_f32 v148, v148, v114
    v_mul_f32 v149, v149, v114
    v_mul_f32 v150, v150, v114
    v_mul_f32 v151, v151, v114
    v_cvt_pk_bf16_f32 v144, v144, v145
    v_cvt_pk_bf16_f32 v145, v146, v147
    v_cvt_pk_bf16_f32 v146, v148, v149
    v_cvt_pk_bf16_f32 v147, v150, v151
    buffer_store_dwordx4 v[144:147], v2, s[8:11], s90 offen offset:2048 sc1
    v_mul_f32 v152, v152, v115
    v_mul_f32 v153, v153, v115
    v_mul_f32 v154, v154, v115
    v_mul_f32 v155, v155, v115
    v_mul_f32 v156, v156, v115
    v_mul_f32 v157, v157, v115
    v_mul_f32 v158, v158, v115
    v_mul_f32 v159, v159, v115
    v_cvt_pk_bf16_f32 v152, v152, v153
    v_cvt_pk_bf16_f32 v153, v154, v155
    v_cvt_pk_bf16_f32 v154, v156, v157
    v_cvt_pk_bf16_f32 v155, v158, v159
    buffer_store_dwordx4 v[152:155], v2, s[8:11], s90 offen offset:3072 sc1
mega_kernel_end1:
    s_endpgm
mega_kernel_stub72:
    v_cmp_lt_f32 vcc, s61, v8
    s_cmp_lg_u32 s60, s63
    s_cbranch_scc1 mega_kernel_e110
    v_add_f32 v176, v176, v16
    v_mov_b32 v180, v9
    v_add_f32 v188, v188, v16
    v_add_f32 v177, v177, v17
    v_mov_b32 v181, v9
    v_add_f32 v189, v189, v17
    v_add_f32 v178, v178, v18
    v_mov_b32 v182, v9
    v_add_f32 v190, v190, v18
    v_add_f32 v179, v179, v19
    v_mov_b32 v183, v9
    v_add_f32 v191, v191, v19
    s_nop 0
mega_kernel_e110:
    s_cmp_lg_u32 s60, s64
    s_cbranch_scc1 mega_kernel_e111
    v_mov_b32 v176, v9
    v_mov_b32 v184, v9
    v_mov_b32 v188, v9
    v_mov_b32 v177, v9
    v_mov_b32 v185, v9
    v_mov_b32 v189, v9
    v_mov_b32 v178, v9
    v_mov_b32 v186, v9
    v_mov_b32 v190, v9
    v_mov_b32 v179, v9
    v_mov_b32 v187, v9
    v_mov_b32 v191, v9
    s_nop 0
mega_kernel_e111:
    s_cbranch_vccnz mega_kernel_rc112
mega_kernel_sp109:
    s_branch mega_kernel_ret73
mega_kernel_stub75:
    v_cmp_lt_f32 vcc, s61, v8
    s_cmp_lg_u32 s60, s63
    s_cbranch_scc1 mega_kernel_e114
    v_add_f32 v176, v176, v16
    v_mov_b32 v180, v9
    v_add_f32 v188, v188, v16
    v_add_f32 v177, v177, v17
    v_mov_b32 v181, v9
    v_add_f32 v189, v189, v17
    v_add_f32 v178, v178, v18
    v_mov_b32 v182, v9
    v_add_f32 v190, v190, v18
    v_add_f32 v179, v179, v19
    v_mov_b32 v183, v9
    v_add_f32 v191, v191, v19
    s_nop 0
mega_kernel_e114:
    s_cmp_lg_u32 s60, s64
    s_cbranch_scc1 mega_kernel_e115
    v_mov_b32 v176, v9
    v_mov_b32 v184, v9
    v_mov_b32 v188, v9
    v_mov_b32 v177, v9
    v_mov_b32 v185, v9
    v_mov_b32 v189, v9
    v_mov_b32 v178, v9
    v_mov_b32 v186, v9
    v_mov_b32 v190, v9
    v_mov_b32 v179, v9
    v_mov_b32 v187, v9
    v_mov_b32 v191, v9
    s_nop 0
mega_kernel_e115:
    s_cbranch_vccnz mega_kernel_rc116
mega_kernel_sp113:
    s_branch mega_kernel_ret76
mega_kernel_stub89:
    v_cmp_lt_f32 vcc, s61, v8
    s_cmp_lg_u32 s60, s66
    s_cbranch_scc1 mega_kernel_e118
    v_add_f32 v160, v160, v16
    v_mov_b32 v164, v9
    v_add_f32 v172, v172, v16
    v_add_f32 v161, v161, v17
    v_mov_b32 v165, v9
    v_add_f32 v173, v173, v17
    v_add_f32 v162, v162, v18
    v_mov_b32 v166, v9
    v_add_f32 v174, v174, v18
    v_add_f32 v163, v163, v19
    v_mov_b32 v167, v9
    v_add_f32 v175, v175, v19
    s_nop 0
mega_kernel_e118:
    s_cmp_lg_u32 s60, s67
    s_cbranch_scc1 mega_kernel_e119
    v_mov_b32 v160, v9
    v_mov_b32 v168, v9
    v_mov_b32 v172, v9
    v_mov_b32 v161, v9
    v_mov_b32 v169, v9
    v_mov_b32 v173, v9
    v_mov_b32 v162, v9
    v_mov_b32 v170, v9
    v_mov_b32 v174, v9
    v_mov_b32 v163, v9
    v_mov_b32 v171, v9
    v_mov_b32 v175, v9
    s_nop 0
mega_kernel_e119:
    s_cbranch_vccnz mega_kernel_rc120
mega_kernel_sp117:
    s_branch mega_kernel_ret90
mega_kernel_stub91:
    v_cmp_lt_f32 vcc, s61, v8
    s_cmp_lg_u32 s60, s66
    s_cbranch_scc1 mega_kernel_e122
    v_add_f32 v160, v160, v16
    v_mov_b32 v164, v9
    v_add_f32 v172, v172, v16
    v_add_f32 v161, v161, v17
    v_mov_b32 v165, v9
    v_add_f32 v173, v173, v17
    v_add_f32 v162, v162, v18
    v_mov_b32 v166, v9
    v_add_f32 v174, v174, v18
    v_add_f32 v163, v163, v19
    v_mov_b32 v167, v9
    v_add_f32 v175, v175, v19
    s_nop 0
mega_kernel_e122:
    s_cmp_lg_u32 s60, s67
    s_cbranch_scc1 mega_kernel_e123
    v_mov_b32 v160, v9
    v_mov_b32 v168, v9
    v_mov_b32 v172, v9
    v_mov_b32 v161, v9
    v_mov_b32 v169, v9
    v_mov_b32 v173, v9
    v_mov_b32 v162, v9
    v_mov_b32 v170, v9
    v_mov_b32 v174, v9
    v_mov_b32 v163, v9
    v_mov_b32 v171, v9
    v_mov_b32 v175, v9
    s_nop 0
mega_kernel_e123:
    s_cmp_lg_u32 s60, s52
    s_cbranch_scc1 mega_kernel_e125
    v_lshrrev_b32 v62, 3, v1
    v_lshlrev_b32 v62, 11, v62
    v_and_b32 v61, 7, v1
    v_lshl_add_u32 v62, v61, 7, v62
    s_lshr_b32 s90, s2, 3
    s_lshl_b32 s90, s90, 2
    s_add_u32 s90, s90, s16
    s_lshl_b32 s90, s90, 14
    s_and_b32 s91, s2, 1
    s_lshl_b32 s91, s91, 10
    s_add_u32 s90, s90, s91
    s_bitcmp1_b32 s2, 2
    s_cselect_b32 s91, 0, 5373952
    s_mov_b32 s92, 8388608
    s_cselect_b32 s46, 5373952, s92
    s_cselect_b32 s93, 0, 2097152
    s_add_u32 s91, s91, s90
    s_mov_b32 s44, s48
    s_mov_b32 s45, s49
    s_add_u32 s92, s91, 0
    buffer_load_dword v255, v62, s[44:47], s92 offen
    s_add_u32 s92, s91, 2097152
    buffer_load_dword v255, v62, s[44:47], s92 offen
    s_add_u32 s92, s91, 4194304
    buffer_load_dword v255, v62, s[44:47], s92 offen
    s_mov_b32 s44, s50
    s_mov_b32 s45, s51
    s_mov_b32 s46, s93
    buffer_load_dword v255, v62, s[44:47], s90 offen
mega_kernel_e125:
    s_cmp_gt_u32 s60, 26
    s_cbranch_scc1 mega_kernel_e124
    s_cmp_lg_u32 s60, 6
    s_cbranch_scc1 mega_kernel_e126
    s_cmp_eq_u32 s17, -1
    s_cbranch_scc1 mega_kernel_e124
    s_cmp_lg_u32 s16, 0
    s_cbranch_scc1 mega_kernel_np127
    v_mov_b32 v4, s4
    v_mov_b32 v5, s5
    s_add_u32 s90, s17, 117440512
    s_mov_b64 exec, 1
    buffer_store_dwordx2 v[4:5], off, s[8:11], s90 sc1
    s_mov_b64 exec, -1
mega_kernel_np127:
    s_branch mega_kernel_e124
mega_kernel_e126:
    s_cmp_lg_u32 s60, 22
    s_cbranch_scc1 mega_kernel_e128
    buffer_load_dwordx2 v[4:5], v10, s[8:11], 0 offen sc1
    s_mov_b32 s44, s48
    s_mov_b32 s45, s49
    s_mov_b32 s46, 8388608
    s_lshl_b32 s90, s2, 2
    s_add_u32 s90, s90, s16
    s_lshl_b32 s90, s90, 13
    v_lshlrev_b32 v62, 7, v1
    buffer_load_dword v255, v62, s[44:47], s90 offen
    s_branch mega_kernel_e124
mega_kernel_e128:
    s_cmp_lg_u32 s60, 26
    s_cbranch_scc1 mega_kernel_e129
    s_mov_b32 s44, s50
    s_mov_b32 s45, s51
    s_mov_b32 s46, 2097152
    s_lshl_b32 s90, s2, 2
    s_add_u32 s90, s90, s16
    s_lshl_b32 s90, s90, 13
    v_lshlrev_b32 v62, 7, v1
    buffer_load_dword v255, v62, s[44:47], s90 offen
    s_waitcnt vmcnt(18)
    s_mov_b32 s3, 1048576
mega_kernel_spin130:
    v_cmp_ne_u64 s[72:73], s[4:5], v[4:5]
    s_nop 3
    s_cmp_eq_u64 s[72:73], 0
    s_cbranch_scc1 mega_kernel_e124
    s_sub_u32 s3, s3, 1
    s_cbranch_scc1 mega_kernel_e124
    s_sleep 32
    buffer_load_dwordx2 v[4:5], v10, s[8:11], 0 offen sc1
    s_waitcnt vmcnt(0)
    s_branch mega_kernel_spin130
    s_branch mega_kernel_e124
mega_kernel_e129:
mega_kernel_e124:
    s_cbranch_vccnz mega_kernel_rc131
mega_kernel_sp121:
    s_branch mega_kernel_ret92
mega_kernel_stub94:
    v_cmp_lt_f32 vcc, s61, v8
    s_cmp_lg_u32 s60, s66
    s_cbranch_scc1 mega_kernel_e133
    v_add_f32 v160, v160, v16
    v_mov_b32 v164, v9
    v_add_f32 v172, v172, v16
    v_add_f32 v161, v161, v17
    v_mov_b32 v165, v9
    v_add_f32 v173, v173, v17
    v_add_f32 v162, v162, v18
    v_mov_b32 v166, v9
    v_add_f32 v174, v174, v18
    v_add_f32 v163, v163, v19
    v_mov_b32 v167, v9
    v_add_f32 v175, v175, v19
    s_nop 0
mega_kernel_e133:
    s_cmp_lg_u32 s60, s67
    s_cbranch_scc1 mega_kernel_e134
    v_mov_b32 v160, v9
    v_mov_b32 v168, v9
    v_mov_b32 v172, v9
    v_mov_b32 v161, v9
    v_mov_b32 v169, v9
    v_mov_b32 v173, v9
    v_mov_b32 v162, v9
    v_mov_b32 v170, v9
    v_mov_b32 v174, v9
    v_mov_b32 v163, v9
    v_mov_b32 v171, v9
    v_mov_b32 v175, v9
    s_nop 0
mega_kernel_e134:
    s_cbranch_vccnz mega_kernel_rc135
mega_kernel_sp132:
    s_branch mega_kernel_ret95
mega_kernel_stub107:
    v_cmp_lt_f32 vcc, s61, v8
    s_cbranch_vccnz mega_kernel_rc137
mega_kernel_sp136:
    s_branch mega_kernel_ret108
mega_kernel_rc88:
    s_call_b64 s[70:71], mega_kernel_rs0466
    s_branch mega_kernel_sp77
mega_kernel_rc106:
    s_call_b64 s[70:71], mega_kernel_rs0265
    s_branch mega_kernel_sp96
mega_kernel_rc112:
    s_call_b64 s[70:71], mega_kernel_rs0466
    s_branch mega_kernel_sp109
mega_kernel_rc116:
    s_call_b64 s[70:71], mega_kernel_rs1468
    s_branch mega_kernel_sp113
mega_kernel_rc120:
    s_call_b64 s[70:71], mega_kernel_rs1468
    s_branch mega_kernel_sp117
mega_kernel_rc131:
    s_call_b64 s[70:71], mega_kernel_rs0265
    s_branch mega_kernel_sp121
mega_kernel_rc135:
    s_call_b64 s[70:71], mega_kernel_rs1267
    s_branch mega_kernel_sp132
mega_kernel_rc137:
    s_call_b64 s[70:71], mega_kernel_rs1267
    s_branch mega_kernel_sp136
mega_kernel_rs0265:
    s_nop 15
    v_max3_f32 v48, v64, v65, v66
    v_max3_f32 v48, v48, v67, v68
    v_max3_f32 v48, v48, v69, v70
    v_max3_f32 v48, v48, v71, 0
    v_mov_b32 v49, v48
    s_nop 1
    v_permlane32_swap_b32 v48, v49
    s_nop 1
    v_max_f32 v48, v48, v49
    v_mov_b32 v49, v48
    s_nop 1
    v_permlane16_swap_b32 v48, v49
    s_nop 1
    v_max_f32 v48, v48, v49
    v_exp_f32 v49, -v48
    v_sub_f32 v64, v64, v48
    v_sub_f32 v65, v65, v48
    v_sub_f32 v66, v66, v48
    v_sub_f32 v67, v67, v48
    v_sub_f32 v68, v68, v48
    v_sub_f32 v69, v69, v48
    v_sub_f32 v70, v70, v48
    v_sub_f32 v71, v71, v48
    v_sub_f32 v96, v96, v48
    v_sub_f32 v97, v97, v48
    v_sub_f32 v98, v98, v48
    v_sub_f32 v99, v99, v48
    v_sub_f32 v100, v100, v48
    v_sub_f32 v101, v101, v48
    v_sub_f32 v102, v102, v48
    v_sub_f32 v103, v103, v48
    v_sub_f32 v160, v160, v48
    v_sub_f32 v161, v161, v48
    v_sub_f32 v162, v162, v48
    v_sub_f32 v163, v163, v48
    v_sub_f32 v164, v164, v48
    v_sub_f32 v165, v165, v48
    v_sub_f32 v166, v166, v48
    v_sub_f32 v167, v167, v48
    v_mul_f32 v12, v12, v49
    v_accvgpr_read_b32 v52, a0
    v_accvgpr_read_b32 v53, a1
    v_accvgpr_read_b32 v54, a2
    v_accvgpr_read_b32 v55, a3
    v_accvgpr_read_b32 v56, a4
    v_accvgpr_read_b32 v57, a5
    v_accvgpr_read_b32 v58, a6
    v_accvgpr_read_b32 v59, a7
    v_mul_f32 v52, v52, v49
    v_mul_f32 v53, v53, v49
    v_mul_f32 v54, v54, v49
    v_mul_f32 v55, v55, v49
    v_mul_f32 v56, v56, v49
    v_mul_f32 v57, v57, v49
    v_mul_f32 v58, v58, v49
    v_mul_f32 v59, v59, v49
    v_accvgpr_write_b32 a0, v52
    v_accvgpr_write_b32 a1, v53
    v_accvgpr_write_b32 a2, v54
    v_accvgpr_write_b32 a3, v55
    v_accvgpr_write_b32 a4, v56
    v_accvgpr_write_b32 a5, v57
    v_accvgpr_write_b32 a6, v58
    v_accvgpr_write_b32 a7, v59
    v_accvgpr_read_b32 v52, a8
    v_accvgpr_read_b32 v53, a9
    v_accvgpr_read_b32 v54, a10
    v_accvgpr_read_b32 v55, a11
    v_accvgpr_read_b32 v56, a12
    v_accvgpr_read_b32 v57, a13
    v_accvgpr_read_b32 v58, a14
    v_accvgpr_read_b32 v59, a15
    v_mul_f32 v52, v52, v49
    v_mul_f32 v53, v53, v49
    v_mul_f32 v54, v54, v49
    v_mul_f32 v55, v55, v49
    v_mul_f32 v56, v56, v49
    v_mul_f32 v57, v57, v49
    v_mul_f32 v58, v58, v49
    v_mul_f32 v59, v59, v49
    v_accvgpr_write_b32 a8, v52
    v_accvgpr_write_b32 a9, v53
    v_accvgpr_write_b32 a10, v54
    v_accvgpr_write_b32 a11, v55
    v_accvgpr_write_b32 a12, v56
    v_accvgpr_write_b32 a13, v57
    v_accvgpr_write_b32 a14, v58
    v_accvgpr_write_b32 a15, v59
    v_accvgpr_read_b32 v52, a16
    v_accvgpr_read_b32 v53, a17
    v_accvgpr_read_b32 v54, a18
    v_accvgpr_read_b32 v55, a19
    v_accvgpr_read_b32 v56, a20
    v_accvgpr_read_b32 v57, a21
    v_accvgpr_read_b32 v58, a22
    v_accvgpr_read_b32 v59, a23
    v_mul_f32 v52, v52, v49
    v_mul_f32 v53, v53, v49
    v_mul_f32 v54, v54, v49
    v_mul_f32 v55, v55, v49
    v_mul_f32 v56, v56, v49
    v_mul_f32 v57, v57, v49
    v_mul_f32 v58, v58, v49
    v_mul_f32 v59, v59, v49
    v_accvgpr_write_b32 a16, v52
    v_accvgpr_write_b32 a17, v53
    v_accvgpr_write_b32 a18, v54
    v_accvgpr_write_b32 a19, v55
    v_accvgpr_write_b32 a20, v56
    v_accvgpr_write_b32 a21, v57
    v_accvgpr_write_b32 a22, v58
    v_accvgpr_write_b32 a23, v59
    v_accvgpr_read_b32 v52, a24
    v_accvgpr_read_b32 v53, a25
    v_accvgpr_read_b32 v54, a26
    v_accvgpr_read_b32 v55, a27
    v_accvgpr_read_b32 v56, a28
    v_accvgpr_read_b32 v57, a29
    v_accvgpr_read_b32 v58, a30
    v_accvgpr_read_b32 v59, a31
    v_mul_f32 v52, v52, v49
    v_mul_f32 v53, v53, v49
    v_mul_f32 v54, v54, v49
    v_mul_f32 v55, v55, v49
    v_mul_f32 v56, v56, v49
    v_mul_f32 v57, v57, v49
    v_mul_f32 v58, v58, v49
    v_mul_f32 v59, v59, v49
    v_accvgpr_write_b32 a24, v52
    v_accvgpr_write_b32 a25, v53
    v_accvgpr_write_b32 a26, v54
    v_accvgpr_write_b32 a27, v55
    v_accvgpr_write_b32 a28, v56
    v_accvgpr_write_b32 a29, v57
    v_accvgpr_write_b32 a30, v58
    v_accvgpr_write_b32 a31, v59
    v_exp_f32 v52, v64
    v_exp_f32 v53, v65
    v_exp_f32 v54, v66
    v_exp_f32 v55, v67
    v_exp_f32 v56, v68
    v_exp_f32 v57, v69
    v_exp_f32 v58, v70
    v_exp_f32 v59, v71
    s_nop 0
    v_cvt_pk_bf16_f32 v128, v52, v53
    v_cvt_pk_bf16_f32 v129, v54, v55
    v_cvt_pk_bf16_f32 v130, v56, v57
    v_cvt_pk_bf16_f32 v131, v58, v59
    s_nop 1
    v_mfma_f32_16x16x32_bf16 v[28:31], v[44:47], v[128:131], 0
    v_max3_f32 v48, v72, v73, v74
    v_max3_f32 v48, v48, v75, v76
    v_max3_f32 v48, v48, v77, v78
    v_max3_f32 v48, v48, v79, 0
    v_mov_b32 v49, v48
    s_nop 1
    v_permlane32_swap_b32 v48, v49
    s_nop 1
    v_max_f32 v48, v48, v49
    v_mov_b32 v49, v48
    s_nop 1
    v_permlane16_swap_b32 v48, v49
    s_nop 1
    v_max_f32 v48, v48, v49
    v_exp_f32 v49, -v48
    v_sub_f32 v72, v72, v48
    v_sub_f32 v73, v73, v48
    v_sub_f32 v74, v74, v48
    v_sub_f32 v75, v75, v48
    v_sub_f32 v76, v76, v48
    v_sub_f32 v77, v77, v48
    v_sub_f32 v78, v78, v48
    v_sub_f32 v79, v79, v48
    v_sub_f32 v104, v104, v48
    v_sub_f32 v105, v105, v48
    v_sub_f32 v106, v106, v48
    v_sub_f32 v107, v107, v48
    v_sub_f32 v108, v108, v48
    v_sub_f32 v109, v109, v48
    v_sub_f32 v110, v110, v48
    v_sub_f32 v111, v111, v48
    v_sub_f32 v168, v168, v48
    v_sub_f32 v169, v169, v48
    v_sub_f32 v170, v170, v48
    v_sub_f32 v171, v171, v48
    v_sub_f32 v172, v172, v48
    v_sub_f32 v173, v173, v48
    v_sub_f32 v174, v174, v48
    v_sub_f32 v175, v175, v48
    v_mul_f32 v13, v13, v49
    v_accvgpr_read_b32 v52, a32
    v_accvgpr_read_b32 v53, a33
    v_accvgpr_read_b32 v54, a34
    v_accvgpr_read_b32 v55, a35
    v_accvgpr_read_b32 v56, a36
    v_accvgpr_read_b32 v57, a37
    v_accvgpr_read_b32 v58, a38
    v_accvgpr_read_b32 v59, a39
    v_mul_f32 v52, v52, v49
    v_mul_f32 v53, v53, v49
    v_mul_f32 v54, v54, v49
    v_mul_f32 v55, v55, v49
    v_mul_f32 v56, v56, v49
    v_mul_f32 v57, v57, v49
    v_mul_f32 v58, v58, v49
    v_mul_f32 v59, v59, v49
    v_accvgpr_write_b32 a32, v52
    v_accvgpr_write_b32 a33, v53
    v_accvgpr_write_b32 a34, v54
    v_accvgpr_write_b32 a35, v55
    v_accvgpr_write_b32 a36, v56
    v_accvgpr_write_b32 a37, v57
    v_accvgpr_write_b32 a38, v58
    v_accvgpr_write_b32 a39, v59
    v_accvgpr_read_b32 v52, a40
    v_accvgpr_read_b32 v53, a41
    v_accvgpr_read_b32 v54, a42
    v_accvgpr_read_b32 v55, a43
    v_accvgpr_read_b32 v56, a44
    v_accvgpr_read_b32 v57, a45
    v_accvgpr_read_b32 v58, a46
    v_accvgpr_read_b32 v59, a47
    v_mul_f32 v52, v52, v49
    v_mul_f32 v53, v53, v49
    v_mul_f32 v54, v54, v49
    v_mul_f32 v55, v55, v49
    v_mul_f32 v56, v56, v49
    v_mul_f32 v57, v57, v49
    v_mul_f32 v58, v58, v49
    v_mul_f32 v59, v59, v49
    v_accvgpr_write_b32 a40, v52
    v_accvgpr_write_b32 a41, v53
    v_accvgpr_write_b32 a42, v54
    v_accvgpr_write_b32 a43, v55
    v_accvgpr_write_b32 a44, v56
    v_accvgpr_write_b32 a45, v57
    v_accvgpr_write_b32 a46, v58
    v_accvgpr_write_b32 a47, v59
    v_accvgpr_read_b32 v52, a48
    v_accvgpr_read_b32 v53, a49
    v_accvgpr_read_b32 v54, a50
    v_accvgpr_read_b32 v55, a51
    v_accvgpr_read_b32 v56, a52
    v_accvgpr_read_b32 v57, a53
    v_accvgpr_read_b32 v58, a54
    v_accvgpr_read_b32 v59, a55
    v_mul_f32 v52, v52, v49
    v_mul_f32 v53, v53, v49
    v_mul_f32 v54, v54, v49
    v_mul_f32 v55, v55, v49
    v_mul_f32 v56, v56, v49
    v_mul_f32 v57, v57, v49
    v_mul_f32 v58, v58, v49
    v_mul_f32 v59, v59, v49
    v_accvgpr_write_b32 a48, v52
    v_accvgpr_write_b32 a49, v53
    v_accvgpr_write_b32 a50, v54
    v_accvgpr_write_b32 a51, v55
    v_accvgpr_write_b32 a52, v56
    v_accvgpr_write_b32 a53, v57
    v_accvgpr_write_b32 a54, v58
    v_accvgpr_write_b32 a55, v59
    v_accvgpr_read_b32 v52, a56
    v_accvgpr_read_b32 v53, a57
    v_accvgpr_read_b32 v54, a58
    v_accvgpr_read_b32 v55, a59
    v_accvgpr_read_b32 v56, a60
    v_accvgpr_read_b32 v57, a61
    v_accvgpr_read_b32 v58, a62
    v_accvgpr_read_b32 v59, a63
    v_mul_f32 v52, v52, v49
    v_mul_f32 v53, v53, v49
    v_mul_f32 v54, v54, v49
    v_mul_f32 v55, v55, v49
    v_mul_f32 v56, v56, v49
    v_mul_f32 v57, v57, v49
    v_mul_f32 v58, v58, v49
    v_mul_f32 v59, v59, v49
    v_accvgpr_write_b32 a56, v52
    v_accvgpr_write_b32 a57, v53
    v_accvgpr_write_b32 a58, v54
    v_accvgpr_write_b32 a59, v55
    v_accvgpr_write_b32 a60, v56
    v_accvgpr_write_b32 a61, v57
    v_accvgpr_write_b32 a62, v58
    v_accvgpr_write_b32 a63, v59
    v_exp_f32 v52, v72
    v_exp_f32 v53, v73
    v_exp_f32 v54, v74
    v_exp_f32 v55, v75
    v_exp_f32 v56, v76
    v_exp_f32 v57, v77
    v_exp_f32 v58, v78
    v_exp_f32 v59, v79
    s_nop 0
    v_cvt_pk_bf16_f32 v132, v52, v53
    v_cvt_pk_bf16_f32 v133, v54, v55
    v_cvt_pk_bf16_f32 v134, v56, v57
    v_cvt_pk_bf16_f32 v135, v58, v59
    s_nop 1
    v_mfma_f32_16x16x32_bf16 v[32:35], v[44:47], v[132:135], 0
    s_nop 7
    s_setpc_b64 s[70:71]
mega_kernel_rs0466:
    s_nop 15
    v_max3_f32 v48, v64, v65, v66
    v_max3_f32 v48, v48, v67, v68
    v_max3_f32 v48, v48, v69, v70
    v_max3_f32 v48, v48, v71, 0
    v_mov_b32 v49, v48
    s_nop 1
    v_permlane32_swap_b32 v48, v49
    s_nop 1
    v_max_f32 v48, v48, v49
    v_mov_b32 v49, v48
    s_nop 1
    v_permlane16_swap_b32 v48, v49
    s_nop 1
    v_max_f32 v48, v48, v49
    v_exp_f32 v49, -v48
    v_sub_f32 v64, v64, v48
    v_sub_f32 v65, v65, v48
    v_sub_f32 v66, v66, v48
    v_sub_f32 v67, v67, v48
    v_sub_f32 v68, v68, v48
    v_sub_f32 v69, v69, v48
    v_sub_f32 v70, v70, v48
    v_sub_f32 v71, v71, v48
    v_sub_f32 v96, v96, v48
    v_sub_f32 v97, v97, v48
    v_sub_f32 v98, v98, v48
    v_sub_f32 v99, v99, v48
    v_sub_f32 v100, v100, v48
    v_sub_f32 v101, v101, v48
    v_sub_f32 v102, v102, v48
    v_sub_f32 v103, v103, v48
    v_sub_f32 v160, v160, v48
    v_sub_f32 v161, v161, v48
    v_sub_f32 v162, v162, v48
    v_sub_f32 v163, v163, v48
    v_sub_f32 v164, v164, v48
    v_sub_f32 v165, v165, v48
    v_sub_f32 v166, v166, v48
    v_sub_f32 v167, v167, v48
    v_mul_f32 v12, v12, v49
    v_accvgpr_read_b32 v52, a0
    v_accvgpr_read_b32 v53, a1
    v_accvgpr_read_b32 v54, a2
    v_accvgpr_read_b32 v55, a3
    v_accvgpr_read_b32 v56, a4
    v_accvgpr_read_b32 v57, a5
    v_accvgpr_read_b32 v58, a6
    v_accvgpr_read_b32 v59, a7
    v_mul_f32 v52, v52, v49
    v_mul_f32 v53, v53, v49
    v_mul_f32 v54, v54, v49
    v_mul_f32 v55, v55, v49
    v_mul_f32 v56, v56, v49
    v_mul_f32 v57, v57, v49
    v_mul_f32 v58, v58, v49
    v_mul_f32 v59, v59, v49
    v_accvgpr_write_b32 a0, v52
    v_accvgpr_write_b32 a1, v53
    v_accvgpr_write_b32 a2, v54
    v_accvgpr_write_b32 a3, v55
    v_accvgpr_write_b32 a4, v56
    v_accvgpr_write_b32 a5, v57
    v_accvgpr_write_b32 a6, v58
    v_accvgpr_write_b32 a7, v59
    v_accvgpr_read_b32 v52, a8
    v_accvgpr_read_b32 v53, a9
    v_accvgpr_read_b32 v54, a10
    v_accvgpr_read_b32 v55, a11
    v_accvgpr_read_b32 v56, a12
    v_accvgpr_read_b32 v57, a13
    v_accvgpr_read_b32 v58, a14
    v_accvgpr_read_b32 v59, a15
    v_mul_f32 v52, v52, v49
    v_mul_f32 v53, v53, v49
    v_mul_f32 v54, v54, v49
    v_mul_f32 v55, v55, v49
    v_mul_f32 v56, v56, v49
    v_mul_f32 v57, v57, v49
    v_mul_f32 v58, v58, v49
    v_mul_f32 v59, v59, v49
    v_accvgpr_write_b32 a8, v52
    v_accvgpr_write_b32 a9, v53
    v_accvgpr_write_b32 a10, v54
    v_accvgpr_write_b32 a11, v55
    v_accvgpr_write_b32 a12, v56
    v_accvgpr_write_b32 a13, v57
    v_accvgpr_write_b32 a14, v58
    v_accvgpr_write_b32 a15, v59
    v_accvgpr_read_b32 v52, a16
    v_accvgpr_read_b32 v53, a17
    v_accvgpr_read_b32 v54, a18
    v_accvgpr_read_b32 v55, a19
    v_accvgpr_read_b32 v56, a20
    v_accvgpr_read_b32 v57, a21
    v_accvgpr_read_b32 v58, a22
    v_accvgpr_read_b32 v59, a23
    v_mul_f32 v52, v52, v49
    v_mul_f32 v53, v53, v49
    v_mul_f32 v54, v54, v49
    v_mul_f32 v55, v55, v49
    v_mul_f32 v56, v56, v49
    v_mul_f32 v57, v57, v49
    v_mul_f32 v58, v58, v49
    v_mul_f32 v59, v59, v49
    v_accvgpr_write_b32 a16, v52
    v_accvgpr_write_b32 a17, v53
    v_accvgpr_write_b32 a18, v54
    v_accvgpr_write_b32 a19, v55
    v_accvgpr_write_b32 a20, v56
    v_accvgpr_write_b32 a21, v57
    v_accvgpr_write_b32 a22, v58
    v_accvgpr_write_b32 a23, v59
    v_accvgpr_read_b32 v52, a24
    v_accvgpr_read_b32 v53, a25
    v_accvgpr_read_b32 v54, a26
    v_accvgpr_read_b32 v55, a27
    v_accvgpr_read_b32 v56, a28
    v_accvgpr_read_b32 v57, a29
    v_accvgpr_read_b32 v58, a30
    v_accvgpr_read_b32 v59, a31
    v_mul_f32 v52, v52, v49
    v_mul_f32 v53, v53, v49
    v_mul_f32 v54, v54, v49
    v_mul_f32 v55, v55, v49
    v_mul_f32 v56, v56, v49
    v_mul_f32 v57, v57, v49
    v_mul_f32 v58, v58, v49
    v_mul_f32 v59, v59, v49
    v_accvgpr_write_b32 a24, v52
    v_accvgpr_write_b32 a25, v53
    v_accvgpr_write_b32 a26, v54
    v_accvgpr_write_b32 a27, v55
    v_accvgpr_write_b32 a28, v56
    v_accvgpr_write_b32 a29, v57
    v_accvgpr_write_b32 a30, v58
    v_accvgpr_write_b32 a31, v59
    v_exp_f32 v52, v64
    v_exp_f32 v53, v65
    v_exp_f32 v54, v66
    v_exp_f32 v55, v67
    v_exp_f32 v56, v68
    v_exp_f32 v57, v69
    v_exp_f32 v58, v70
    v_exp_f32 v59, v71
    s_nop 0
    v_cvt_pk_bf16_f32 v128, v52, v53
    v_cvt_pk_bf16_f32 v129, v54, v55
    v_cvt_pk_bf16_f32 v130, v56, v57
    v_cvt_pk_bf16_f32 v131, v58, v59
    s_nop 1
    v_mfma_f32_16x16x32_bf16 v[28:31], v[44:47], v[128:131], 0
    v_max3_f32 v48, v72, v73, v74
    v_max3_f32 v48, v48, v75, v76
    v_max3_f32 v48, v48, v77, v78
    v_max3_f32 v48, v48, v79, 0
    v_mov_b32 v49, v48
    s_nop 1
    v_permlane32_swap_b32 v48, v49
    s_nop 1
    v_max_f32 v48, v48, v49
    v_mov_b32 v49, v48
    s_nop 1
    v_permlane16_swap_b32 v48, v49
    s_nop 1
    v_max_f32 v48, v48, v49
    v_exp_f32 v49, -v48
    v_sub_f32 v72, v72, v48
    v_sub_f32 v73, v73, v48
    v_sub_f32 v74, v74, v48
    v_sub_f32 v75, v75, v48
    v_sub_f32 v76, v76, v48
    v_sub_f32 v77, v77, v48
    v_sub_f32 v78, v78, v48
    v_sub_f32 v79, v79, v48
    v_sub_f32 v104, v104, v48
    v_sub_f32 v105, v105, v48
    v_sub_f32 v106, v106, v48
    v_sub_f32 v107, v107, v48
    v_sub_f32 v108, v108, v48
    v_sub_f32 v109, v109, v48
    v_sub_f32 v110, v110, v48
    v_sub_f32 v111, v111, v48
    v_sub_f32 v168, v168, v48
    v_sub_f32 v169, v169, v48
    v_sub_f32 v170, v170, v48
    v_sub_f32 v171, v171, v48
    v_sub_f32 v172, v172, v48
    v_sub_f32 v173, v173, v48
    v_sub_f32 v174, v174, v48
    v_sub_f32 v175, v175, v48
    v_mul_f32 v13, v13, v49
    v_accvgpr_read_b32 v52, a32
    v_accvgpr_read_b32 v53, a33
    v_accvgpr_read_b32 v54, a34
    v_accvgpr_read_b32 v55, a35
    v_accvgpr_read_b32 v56, a36
    v_accvgpr_read_b32 v57, a37
    v_accvgpr_read_b32 v58, a38
    v_accvgpr_read_b32 v59, a39
    v_mul_f32 v52, v52, v49
    v_mul_f32 v53, v53, v49
    v_mul_f32 v54, v54, v49
    v_mul_f32 v55, v55, v49
    v_mul_f32 v56, v56, v49
    v_mul_f32 v57, v57, v49
    v_mul_f32 v58, v58, v49
    v_mul_f32 v59, v59, v49
    v_accvgpr_write_b32 a32, v52
    v_accvgpr_write_b32 a33, v53
    v_accvgpr_write_b32 a34, v54
    v_accvgpr_write_b32 a35, v55
    v_accvgpr_write_b32 a36, v56
    v_accvgpr_write_b32 a37, v57
    v_accvgpr_write_b32 a38, v58
    v_accvgpr_write_b32 a39, v59
    v_accvgpr_read_b32 v52, a40
    v_accvgpr_read_b32 v53, a41
    v_accvgpr_read_b32 v54, a42
    v_accvgpr_read_b32 v55, a43
    v_accvgpr_read_b32 v56, a44
    v_accvgpr_read_b32 v57, a45
    v_accvgpr_read_b32 v58, a46
    v_accvgpr_read_b32 v59, a47
    v_mul_f32 v52, v52, v49
    v_mul_f32 v53, v53, v49
    v_mul_f32 v54, v54, v49
    v_mul_f32 v55, v55, v49
    v_mul_f32 v56, v56, v49
    v_mul_f32 v57, v57, v49
    v_mul_f32 v58, v58, v49
    v_mul_f32 v59, v59, v49
    v_accvgpr_write_b32 a40, v52
    v_accvgpr_write_b32 a41, v53
    v_accvgpr_write_b32 a42, v54
    v_accvgpr_write_b32 a43, v55
    v_accvgpr_write_b32 a44, v56
    v_accvgpr_write_b32 a45, v57
    v_accvgpr_write_b32 a46, v58
    v_accvgpr_write_b32 a47, v59
    v_accvgpr_read_b32 v52, a48
    v_accvgpr_read_b32 v53, a49
    v_accvgpr_read_b32 v54, a50
    v_accvgpr_read_b32 v55, a51
    v_accvgpr_read_b32 v56, a52
    v_accvgpr_read_b32 v57, a53
    v_accvgpr_read_b32 v58, a54
    v_accvgpr_read_b32 v59, a55
    v_mul_f32 v52, v52, v49
    v_mul_f32 v53, v53, v49
    v_mul_f32 v54, v54, v49
    v_mul_f32 v55, v55, v49
    v_mul_f32 v56, v56, v49
    v_mul_f32 v57, v57, v49
    v_mul_f32 v58, v58, v49
    v_mul_f32 v59, v59, v49
    v_accvgpr_write_b32 a48, v52
    v_accvgpr_write_b32 a49, v53
    v_accvgpr_write_b32 a50, v54
    v_accvgpr_write_b32 a51, v55
    v_accvgpr_write_b32 a52, v56
    v_accvgpr_write_b32 a53, v57
    v_accvgpr_write_b32 a54, v58
    v_accvgpr_write_b32 a55, v59
    v_accvgpr_read_b32 v52, a56
    v_accvgpr_read_b32 v53, a57
    v_accvgpr_read_b32 v54, a58
    v_accvgpr_read_b32 v55, a59
    v_accvgpr_read_b32 v56, a60
    v_accvgpr_read_b32 v57, a61
    v_accvgpr_read_b32 v58, a62
    v_accvgpr_read_b32 v59, a63
    v_mul_f32 v52, v52, v49
    v_mul_f32 v53, v53, v49
    v_mul_f32 v54, v54, v49
    v_mul_f32 v55, v55, v49
    v_mul_f32 v56, v56, v49
    v_mul_f32 v57, v57, v49
    v_mul_f32 v58, v58, v49
    v_mul_f32 v59, v59, v49
    v_accvgpr_write_b32 a56, v52
    v_accvgpr_write_b32 a57, v53
    v_accvgpr_write_b32 a58, v54
    v_accvgpr_write_b32 a59, v55
    v_accvgpr_write_b32 a60, v56
    v_accvgpr_write_b32 a61, v57
    v_accvgpr_write_b32 a62, v58
    v_accvgpr_write_b32 a63, v59
    v_exp_f32 v52, v72
    v_exp_f32 v53, v73
    v_exp_f32 v54, v74
    v_exp_f32 v55, v75
    v_exp_f32 v56, v76
    v_exp_f32 v57, v77
    v_exp_f32 v58, v78
    v_exp_f32 v59, v79
    s_nop 0
    v_cvt_pk_bf16_f32 v132, v52, v53
    v_cvt_pk_bf16_f32 v133, v54, v55
    v_cvt_pk_bf16_f32 v134, v56, v57
    v_cvt_pk_bf16_f32 v135, v58, v59
    s_nop 1
    v_mfma_f32_16x16x32_bf16 v[32:35], v[44:47], v[132:135], 0
    v_max3_f32 v48, v80, v81, v82
    v_max3_f32 v48, v48, v83, v84
    v_max3_f32 v48, v48, v85, v86
    v_max3_f32 v48, v48, v87, 0
    v_mov_b32 v49, v48
    s_nop 1
    v_permlane32_swap_b32 v48, v49
    s_nop 1
    v_max_f32 v48, v48, v49
    v_mov_b32 v49, v48
    s_nop 1
    v_permlane16_swap_b32 v48, v49
    s_nop 1
    v_max_f32 v48, v48, v49
    v_exp_f32 v49, -v48
    v_sub_f32 v80, v80, v48
    v_sub_f32 v81, v81, v48
    v_sub_f32 v82, v82, v48
    v_sub_f32 v83, v83, v48
    v_sub_f32 v84, v84, v48
    v_sub_f32 v85, v85, v48
    v_sub_f32 v86, v86, v48
    v_sub_f32 v87, v87, v48
    v_sub_f32 v112, v112, v48
    v_sub_f32 v113, v113, v48
    v_sub_f32 v114, v114, v48
    v_sub_f32 v115, v115, v48
    v_sub_f32 v116, v116, v48
    v_sub_f32 v117, v117, v48
    v_sub_f32 v118, v118, v48
    v_sub_f32 v119, v119, v48
    v_sub_f32 v176, v176, v48
    v_sub_f32 v177, v177, v48
    v_sub_f32 v178, v178, v48
    v_sub_f32 v179, v179, v48
    v_sub_f32 v180, v180, v48
    v_sub_f32 v181, v181, v48
    v_sub_f32 v182, v182, v48
    v_sub_f32 v183, v183, v48
    v_mul_f32 v14, v14, v49
    v_accvgpr_read_b32 v52, a64
    v_accvgpr_read_b32 v53, a65
    v_accvgpr_read_b32 v54, a66
    v_accvgpr_read_b32 v55, a67
    v_accvgpr_read_b32 v56, a68
    v_accvgpr_read_b32 v57, a69
    v_accvgpr_read_b32 v58, a70
    v_accvgpr_read_b32 v59, a71
    v_mul_f32 v52, v52, v49
    v_mul_f32 v53, v53, v49
    v_mul_f32 v54, v54, v49
    v_mul_f32 v55, v55, v49
    v_mul_f32 v56, v56, v49
    v_mul_f32 v57, v57, v49
    v_mul_f32 v58, v58, v49
    v_mul_f32 v59, v59, v49
    v_accvgpr_write_b32 a64, v52
    v_accvgpr_write_b32 a65, v53
    v_accvgpr_write_b32 a66, v54
    v_accvgpr_write_b32 a67, v55
    v_accvgpr_write_b32 a68, v56
    v_accvgpr_write_b32 a69, v57
    v_accvgpr_write_b32 a70, v58
    v_accvgpr_write_b32 a71, v59
    v_accvgpr_read_b32 v52, a72
    v_accvgpr_read_b32 v53, a73
    v_accvgpr_read_b32 v54, a74
    v_accvgpr_read_b32 v55, a75
    v_accvgpr_read_b32 v56, a76
    v_accvgpr_read_b32 v57, a77
    v_accvgpr_read_b32 v58, a78
    v_accvgpr_read_b32 v59, a79
    v_mul_f32 v52, v52, v49
    v_mul_f32 v53, v53, v49
    v_mul_f32 v54, v54, v49
    v_mul_f32 v55, v55, v49
    v_mul_f32 v56, v56, v49
    v_mul_f32 v57, v57, v49
    v_mul_f32 v58, v58, v49
    v_mul_f32 v59, v59, v49
    v_accvgpr_write_b32 a72, v52
    v_accvgpr_write_b32 a73, v53
    v_accvgpr_write_b32 a74, v54
    v_accvgpr_write_b32 a75, v55
    v_accvgpr_write_b32 a76, v56
    v_accvgpr_write_b32 a77, v57
    v_accvgpr_write_b32 a78, v58
    v_accvgpr_write_b32 a79, v59
    v_accvgpr_read_b32 v52, a80
    v_accvgpr_read_b32 v53, a81
    v_accvgpr_read_b32 v54, a82
    v_accvgpr_read_b32 v55, a83
    v_accvgpr_read_b32 v56, a84
    v_accvgpr_read_b32 v57, a85
    v_accvgpr_read_b32 v58, a86
    v_accvgpr_read_b32 v59, a87
    v_mul_f32 v52, v52, v49
    v_mul_f32 v53, v53, v49
    v_mul_f32 v54, v54, v49
    v_mul_f32 v55, v55, v49
    v_mul_f32 v56, v56, v49
    v_mul_f32 v57, v57, v49
    v_mul_f32 v58, v58, v49
    v_mul_f32 v59, v59, v49
    v_accvgpr_write_b32 a80, v52
    v_accvgpr_write_b32 a81, v53
    v_accvgpr_write_b32 a82, v54
    v_accvgpr_write_b32 a83, v55
    v_accvgpr_write_b32 a84, v56
    v_accvgpr_write_b32 a85, v57
    v_accvgpr_write_b32 a86, v58
    v_accvgpr_write_b32 a87, v59
    v_accvgpr_read_b32 v52, a88
    v_accvgpr_read_b32 v53, a89
    v_accvgpr_read_b32 v54, a90
    v_accvgpr_read_b32 v55, a91
    v_accvgpr_read_b32 v56, a92
    v_accvgpr_read_b32 v57, a93
    v_accvgpr_read_b32 v58, a94
    v_accvgpr_read_b32 v59, a95
    v_mul_f32 v52, v52, v49
    v_mul_f32 v53, v53, v49
    v_mul_f32 v54, v54, v49
    v_mul_f32 v55, v55, v49
    v_mul_f32 v56, v56, v49
    v_mul_f32 v57, v57, v49
    v_mul_f32 v58, v58, v49
    v_mul_f32 v59, v59, v49
    v_accvgpr_write_b32 a88, v52
    v_accvgpr_write_b32 a89, v53
    v_accvgpr_write_b32 a90, v54
    v_accvgpr_write_b32 a91, v55
    v_accvgpr_write_b32 a92, v56
    v_accvgpr_write_b32 a93, v57
    v_accvgpr_write_b32 a94, v58
    v_accvgpr_write_b32 a95, v59
    v_exp_f32 v52, v80
    v_exp_f32 v53, v81
    v_exp_f32 v54, v82
    v_exp_f32 v55, v83
    v_exp_f32 v56, v84
    v_exp_f32 v57, v85
    v_exp_f32 v58, v86
    v_exp_f32 v59, v87
    s_nop 0
    v_cvt_pk_bf16_f32 v136, v52, v53
    v_cvt_pk_bf16_f32 v137, v54, v55
    v_cvt_pk_bf16_f32 v138, v56, v57
    v_cvt_pk_bf16_f32 v139, v58, v59
    s_nop 1
    v_mfma_f32_16x16x32_bf16 v[36:39], v[44:47], v[136:139], 0
    v_max3_f32 v48, v88, v89, v90
    v_max3_f32 v48, v48, v91, v92
    v_max3_f32 v48, v48, v93, v94
    v_max3_f32 v48, v48, v95, 0
    v_mov_b32 v49, v48
    s_nop 1
    v_permlane32_swap_b32 v48, v49
    s_nop 1
    v_max_f32 v48, v48, v49
    v_mov_b32 v49, v48
    s_nop 1
    v_permlane16_swap_b32 v48, v49
    s_nop 1
    v_max_f32 v48, v48, v49
    v_exp_f32 v49, -v48
    v_sub_f32 v88, v88, v48
    v_sub_f32 v89, v89, v48
    v_sub_f32 v90, v90, v48
    v_sub_f32 v91, v91, v48
    v_sub_f32 v92, v92, v48
    v_sub_f32 v93, v93, v48
    v_sub_f32 v94, v94, v48
    v_sub_f32 v95, v95, v48
    v_sub_f32 v120, v120, v48
    v_sub_f32 v121, v121, v48
    v_sub_f32 v122, v122, v48
    v_sub_f32 v123, v123, v48
    v_sub_f32 v124, v124, v48
    v_sub_f32 v125, v125, v48
    v_sub_f32 v126, v126, v48
    v_sub_f32 v127, v127, v48
    v_sub_f32 v184, v184, v48
    v_sub_f32 v185, v185, v48
    v_sub_f32 v186, v186, v48
    v_sub_f32 v187, v187, v48
    v_sub_f32 v188, v188, v48
    v_sub_f32 v189, v189, v48
    v_sub_f32 v190, v190, v48
    v_sub_f32 v191, v191, v48
    v_mul_f32 v15, v15, v49
    v_accvgpr_read_b32 v52, a96
    v_accvgpr_read_b32 v53, a97
    v_accvgpr_read_b32 v54, a98
    v_accvgpr_read_b32 v55, a99
    v_accvgpr_read_b32 v56, a100
    v_accvgpr_read_b32 v57, a101
    v_accvgpr_read_b32 v58, a102
    v_accvgpr_read_b32 v59, a103
    v_mul_f32 v52, v52, v49
    v_mul_f32 v53, v53, v49
    v_mul_f32 v54, v54, v49
    v_mul_f32 v55, v55, v49
    v_mul_f32 v56, v56, v49
    v_mul_f32 v57, v57, v49
    v_mul_f32 v58, v58, v49
    v_mul_f32 v59, v59, v49
    v_accvgpr_write_b32 a96, v52
    v_accvgpr_write_b32 a97, v53
    v_accvgpr_write_b32 a98, v54
    v_accvgpr_write_b32 a99, v55
    v_accvgpr_write_b32 a100, v56
    v_accvgpr_write_b32 a101, v57
    v_accvgpr_write_b32 a102, v58
    v_accvgpr_write_b32 a103, v59
    v_accvgpr_read_b32 v52, a104
    v_accvgpr_read_b32 v53, a105
    v_accvgpr_read_b32 v54, a106
    v_accvgpr_read_b32 v55, a107
    v_accvgpr_read_b32 v56, a108
    v_accvgpr_read_b32 v57, a109
    v_accvgpr_read_b32 v58, a110
    v_accvgpr_read_b32 v59, a111
    v_mul_f32 v52, v52, v49
    v_mul_f32 v53, v53, v49
    v_mul_f32 v54, v54, v49
    v_mul_f32 v55, v55, v49
    v_mul_f32 v56, v56, v49
    v_mul_f32 v57, v57, v49
    v_mul_f32 v58, v58, v49
    v_mul_f32 v59, v59, v49
    v_accvgpr_write_b32 a104, v52
    v_accvgpr_write_b32 a105, v53
    v_accvgpr_write_b32 a106, v54
    v_accvgpr_write_b32 a107, v55
    v_accvgpr_write_b32 a108, v56
    v_accvgpr_write_b32 a109, v57
    v_accvgpr_write_b32 a110, v58
    v_accvgpr_write_b32 a111, v59
    v_accvgpr_read_b32 v52, a112
    v_accvgpr_read_b32 v53, a113
    v_accvgpr_read_b32 v54, a114
    v_accvgpr_read_b32 v55, a115
    v_accvgpr_read_b32 v56, a116
    v_accvgpr_read_b32 v57, a117
    v_accvgpr_read_b32 v58, a118
    v_accvgpr_read_b32 v59, a119
    v_mul_f32 v52, v52, v49
    v_mul_f32 v53, v53, v49
    v_mul_f32 v54, v54, v49
    v_mul_f32 v55, v55, v49
    v_mul_f32 v56, v56, v49
    v_mul_f32 v57, v57, v49
    v_mul_f32 v58, v58, v49
    v_mul_f32 v59, v59, v49
    v_accvgpr_write_b32 a112, v52
    v_accvgpr_write_b32 a113, v53
    v_accvgpr_write_b32 a114, v54
    v_accvgpr_write_b32 a115, v55
    v_accvgpr_write_b32 a116, v56
    v_accvgpr_write_b32 a117, v57
    v_accvgpr_write_b32 a118, v58
    v_accvgpr_write_b32 a119, v59
    v_accvgpr_read_b32 v52, a120
    v_accvgpr_read_b32 v53, a121
    v_accvgpr_read_b32 v54, a122
    v_accvgpr_read_b32 v55, a123
    v_accvgpr_read_b32 v56, a124
    v_accvgpr_read_b32 v57, a125
    v_accvgpr_read_b32 v58, a126
    v_accvgpr_read_b32 v59, a127
    v_mul_f32 v52, v52, v49
    v_mul_f32 v53, v53, v49
    v_mul_f32 v54, v54, v49
    v_mul_f32 v55, v55, v49
    v_mul_f32 v56, v56, v49
    v_mul_f32 v57, v57, v49
    v_mul_f32 v58, v58, v49
    v_mul_f32 v59, v59, v49
    v_accvgpr_write_b32 a120, v52
    v_accvgpr_write_b32 a121, v53
    v_accvgpr_write_b32 a122, v54
    v_accvgpr_write_b32 a123, v55
    v_accvgpr_write_b32 a124, v56
    v_accvgpr_write_b32 a125, v57
    v_accvgpr_write_b32 a126, v58
    v_accvgpr_write_b32 a127, v59
    v_exp_f32 v52, v88
    v_exp_f32 v53, v89
    v_exp_f32 v54, v90
    v_exp_f32 v55, v91
    v_exp_f32 v56, v92
    v_exp_f32 v57, v93
    v_exp_f32 v58, v94
    v_exp_f32 v59, v95
    s_nop 0
    v_cvt_pk_bf16_f32 v140, v52, v53
    v_cvt_pk_bf16_f32 v141, v54, v55
    v_cvt_pk_bf16_f32 v142, v56, v57
    v_cvt_pk_bf16_f32 v143, v58, v59
    s_nop 1
    v_mfma_f32_16x16x32_bf16 v[40:43], v[44:47], v[140:143], 0
    s_nop 7
    s_setpc_b64 s[70:71]
mega_kernel_rs1267:
    s_nop 15
    v_max3_f32 v48, v96, v97, v98
    v_max3_f32 v48, v48, v99, v100
    v_max3_f32 v48, v48, v101, v102
    v_max3_f32 v48, v48, v103, 0
    v_mov_b32 v49, v48
    s_nop 1
    v_permlane32_swap_b32 v48, v49
    s_nop 1
    v_max_f32 v48, v48, v49
    v_mov_b32 v49, v48
    s_nop 1
    v_permlane16_swap_b32 v48, v49
    s_nop 1
    v_max_f32 v48, v48, v49
    v_exp_f32 v49, -v48
    v_sub_f32 v96, v96, v48
    v_sub_f32 v97, v97, v48
    v_sub_f32 v98, v98, v48
    v_sub_f32 v99, v99, v48
    v_sub_f32 v100, v100, v48
    v_sub_f32 v101, v101, v48
    v_sub_f32 v102, v102, v48
    v_sub_f32 v103, v103, v48
    v_sub_f32 v64, v64, v48
    v_sub_f32 v65, v65, v48
    v_sub_f32 v66, v66, v48
    v_sub_f32 v67, v67, v48
    v_sub_f32 v68, v68, v48
    v_sub_f32 v69, v69, v48
    v_sub_f32 v70, v70, v48
    v_sub_f32 v71, v71, v48
    v_sub_f32 v160, v160, v48
    v_sub_f32 v161, v161, v48
    v_sub_f32 v162, v162, v48
    v_sub_f32 v163, v163, v48
    v_sub_f32 v164, v164, v48
    v_sub_f32 v165, v165, v48
    v_sub_f32 v166, v166, v48
    v_sub_f32 v167, v167, v48
    v_mul_f32 v12, v12, v49
    v_accvgpr_read_b32 v52, a0
    v_accvgpr_read_b32 v53, a1
    v_accvgpr_read_b32 v54, a2
    v_accvgpr_read_b32 v55, a3
    v_accvgpr_read_b32 v56, a4
    v_accvgpr_read_b32 v57, a5
    v_accvgpr_read_b32 v58, a6
    v_accvgpr_read_b32 v59, a7
    v_mul_f32 v52, v52, v49
    v_mul_f32 v53, v53, v49
    v_mul_f32 v54, v54, v49
    v_mul_f32 v55, v55, v49
    v_mul_f32 v56, v56, v49
    v_mul_f32 v57, v57, v49
    v_mul_f32 v58, v58, v49
    v_mul_f32 v59, v59, v49
    v_accvgpr_write_b32 a0, v52
    v_accvgpr_write_b32 a1, v53
    v_accvgpr_write_b32 a2, v54
    v_accvgpr_write_b32 a3, v55
    v_accvgpr_write_b32 a4, v56
    v_accvgpr_write_b32 a5, v57
    v_accvgpr_write_b32 a6, v58
    v_accvgpr_write_b32 a7, v59
    v_accvgpr_read_b32 v52, a8
    v_accvgpr_read_b32 v53, a9
    v_accvgpr_read_b32 v54, a10
    v_accvgpr_read_b32 v55, a11
    v_accvgpr_read_b32 v56, a12
    v_accvgpr_read_b32 v57, a13
    v_accvgpr_read_b32 v58, a14
    v_accvgpr_read_b32 v59, a15
    v_mul_f32 v52, v52, v49
    v_mul_f32 v53, v53, v49
    v_mul_f32 v54, v54, v49
    v_mul_f32 v55, v55, v49
    v_mul_f32 v56, v56, v49
    v_mul_f32 v57, v57, v49
    v_mul_f32 v58, v58, v49
    v_mul_f32 v59, v59, v49
    v_accvgpr_write_b32 a8, v52
    v_accvgpr_write_b32 a9, v53
    v_accvgpr_write_b32 a10, v54
    v_accvgpr_write_b32 a11, v55
    v_accvgpr_write_b32 a12, v56
    v_accvgpr_write_b32 a13, v57
    v_accvgpr_write_b32 a14, v58
    v_accvgpr_write_b32 a15, v59
    v_accvgpr_read_b32 v52, a16
    v_accvgpr_read_b32 v53, a17
    v_accvgpr_read_b32 v54, a18
    v_accvgpr_read_b32 v55, a19
    v_accvgpr_read_b32 v56, a20
    v_accvgpr_read_b32 v57, a21
    v_accvgpr_read_b32 v58, a22
    v_accvgpr_read_b32 v59, a23
    v_mul_f32 v52, v52, v49
    v_mul_f32 v53, v53, v49
    v_mul_f32 v54, v54, v49
    v_mul_f32 v55, v55, v49
    v_mul_f32 v56, v56, v49
    v_mul_f32 v57, v57, v49
    v_mul_f32 v58, v58, v49
    v_mul_f32 v59, v59, v49
    v_accvgpr_write_b32 a16, v52
    v_accvgpr_write_b32 a17, v53
    v_accvgpr_write_b32 a18, v54
    v_accvgpr_write_b32 a19, v55
    v_accvgpr_write_b32 a20, v56
    v_accvgpr_write_b32 a21, v57
    v_accvgpr_write_b32 a22, v58
    v_accvgpr_write_b32 a23, v59
    v_accvgpr_read_b32 v52, a24
    v_accvgpr_read_b32 v53, a25
    v_accvgpr_read_b32 v54, a26
    v_accvgpr_read_b32 v55, a27
    v_accvgpr_read_b32 v56, a28
    v_accvgpr_read_b32 v57, a29
    v_accvgpr_read_b32 v58, a30
    v_accvgpr_read_b32 v59, a31
    v_mul_f32 v52, v52, v49
    v_mul_f32 v53, v53, v49
    v_mul_f32 v54, v54, v49
    v_mul_f32 v55, v55, v49
    v_mul_f32 v56, v56, v49
    v_mul_f32 v57, v57, v49
    v_mul_f32 v58, v58, v49
    v_mul_f32 v59, v59, v49
    v_accvgpr_write_b32 a24, v52
    v_accvgpr_write_b32 a25, v53
    v_accvgpr_write_b32 a26, v54
    v_accvgpr_write_b32 a27, v55
    v_accvgpr_write_b32 a28, v56
    v_accvgpr_write_b32 a29, v57
    v_accvgpr_write_b32 a30, v58
    v_accvgpr_write_b32 a31, v59
    v_exp_f32 v52, v96
    v_exp_f32 v53, v97
    v_exp_f32 v54, v98
    v_exp_f32 v55, v99
    v_exp_f32 v56, v100
    v_exp_f32 v57, v101
    v_exp_f32 v58, v102
    v_exp_f32 v59, v103
    s_nop 0
    v_cvt_pk_bf16_f32 v144, v52, v53
    v_cvt_pk_bf16_f32 v145, v54, v55
    v_cvt_pk_bf16_f32 v146, v56, v57
    v_cvt_pk_bf16_f32 v147, v58, v59
    s_nop 1
    v_mfma_f32_16x16x32_bf16 v[28:31], v[44:47], v[144:147], 0
    v_max3_f32 v48, v104, v105, v106
    v_max3_f32 v48, v48, v107, v108
    v_max3_f32 v48, v48, v109, v110
    v_max3_f32 v48, v48, v111, 0
    v_mov_b32 v49, v48
    s_nop 1
    v_permlane32_swap_b32 v48, v49
    s_nop 1
    v_max_f32 v48, v48, v49
    v_mov_b32 v49, v48
    s_nop 1
    v_permlane16_swap_b32 v48, v49
    s_nop 1
    v_max_f32 v48, v48, v49
    v_exp_f32 v49, -v48
    v_sub_f32 v104, v104, v48
    v_sub_f32 v105, v105, v48
    v_sub_f32 v106, v106, v48
    v_sub_f32 v107, v107, v48
    v_sub_f32 v108, v108, v48
    v_sub_f32 v109, v109, v48
    v_sub_f32 v110, v110, v48
    v_sub_f32 v111, v111, v48
    v_sub_f32 v72, v72, v48
    v_sub_f32 v73, v73, v48
    v_sub_f32 v74, v74, v48
    v_sub_f32 v75, v75, v48
    v_sub_f32 v76, v76, v48
    v_sub_f32 v77, v77, v48
    v_sub_f32 v78, v78, v48
    v_sub_f32 v79, v79, v48
    v_sub_f32 v168, v168, v48
    v_sub_f32 v169, v169, v48
    v_sub_f32 v170, v170, v48
    v_sub_f32 v171, v171, v48
    v_sub_f32 v172, v172, v48
    v_sub_f32 v173, v173, v48
    v_sub_f32 v174, v174, v48
    v_sub_f32 v175, v175, v48
    v_mul_f32 v13, v13, v49
    v_accvgpr_read_b32 v52, a32
    v_accvgpr_read_b32 v53, a33
    v_accvgpr_read_b32 v54, a34
    v_accvgpr_read_b32 v55, a35
    v_accvgpr_read_b32 v56, a36
    v_accvgpr_read_b32 v57, a37
    v_accvgpr_read_b32 v58, a38
    v_accvgpr_read_b32 v59, a39
    v_mul_f32 v52, v52, v49
    v_mul_f32 v53, v53, v49
    v_mul_f32 v54, v54, v49
    v_mul_f32 v55, v55, v49
    v_mul_f32 v56, v56, v49
    v_mul_f32 v57, v57, v49
    v_mul_f32 v58, v58, v49
    v_mul_f32 v59, v59, v49
    v_accvgpr_write_b32 a32, v52
    v_accvgpr_write_b32 a33, v53
    v_accvgpr_write_b32 a34, v54
    v_accvgpr_write_b32 a35, v55
    v_accvgpr_write_b32 a36, v56
    v_accvgpr_write_b32 a37, v57
    v_accvgpr_write_b32 a38, v58
    v_accvgpr_write_b32 a39, v59
    v_accvgpr_read_b32 v52, a40
    v_accvgpr_read_b32 v53, a41
    v_accvgpr_read_b32 v54, a42
    v_accvgpr_read_b32 v55, a43
    v_accvgpr_read_b32 v56, a44
    v_accvgpr_read_b32 v57, a45
    v_accvgpr_read_b32 v58, a46
    v_accvgpr_read_b32 v59, a47
    v_mul_f32 v52, v52, v49
    v_mul_f32 v53, v53, v49
    v_mul_f32 v54, v54, v49
    v_mul_f32 v55, v55, v49
    v_mul_f32 v56, v56, v49
    v_mul_f32 v57, v57, v49
    v_mul_f32 v58, v58, v49
    v_mul_f32 v59, v59, v49
    v_accvgpr_write_b32 a40, v52
    v_accvgpr_write_b32 a41, v53
    v_accvgpr_write_b32 a42, v54
    v_accvgpr_write_b32 a43, v55
    v_accvgpr_write_b32 a44, v56
    v_accvgpr_write_b32 a45, v57
    v_accvgpr_write_b32 a46, v58
    v_accvgpr_write_b32 a47, v59
    v_accvgpr_read_b32 v52, a48
    v_accvgpr_read_b32 v53, a49
    v_accvgpr_read_b32 v54, a50
    v_accvgpr_read_b32 v55, a51
    v_accvgpr_read_b32 v56, a52
    v_accvgpr_read_b32 v57, a53
    v_accvgpr_read_b32 v58, a54
    v_accvgpr_read_b32 v59, a55
    v_mul_f32 v52, v52, v49
    v_mul_f32 v53, v53, v49
    v_mul_f32 v54, v54, v49
    v_mul_f32 v55, v55, v49
    v_mul_f32 v56, v56, v49
    v_mul_f32 v57, v57, v49
    v_mul_f32 v58, v58, v49
    v_mul_f32 v59, v59, v49
    v_accvgpr_write_b32 a48, v52
    v_accvgpr_write_b32 a49, v53
    v_accvgpr_write_b32 a50, v54
    v_accvgpr_write_b32 a51, v55
    v_accvgpr_write_b32 a52, v56
    v_accvgpr_write_b32 a53, v57
    v_accvgpr_write_b32 a54, v58
    v_accvgpr_write_b32 a55, v59
    v_accvgpr_read_b32 v52, a56
    v_accvgpr_read_b32 v53, a57
    v_accvgpr_read_b32 v54, a58
    v_accvgpr_read_b32 v55, a59
    v_accvgpr_read_b32 v56, a60
    v_accvgpr_read_b32 v57, a61
    v_accvgpr_read_b32 v58, a62
    v_accvgpr_read_b32 v59, a63
    v_mul_f32 v52, v52, v49
    v_mul_f32 v53, v53, v49
    v_mul_f32 v54, v54, v49
    v_mul_f32 v55, v55, v49
    v_mul_f32 v56, v56, v49
    v_mul_f32 v57, v57, v49
    v_mul_f32 v58, v58, v49
    v_mul_f32 v59, v59, v49
    v_accvgpr_write_b32 a56, v52
    v_accvgpr_write_b32 a57, v53
    v_accvgpr_write_b32 a58, v54
    v_accvgpr_write_b32 a59, v55
    v_accvgpr_write_b32 a60, v56
    v_accvgpr_write_b32 a61, v57
    v_accvgpr_write_b32 a62, v58
    v_accvgpr_write_b32 a63, v59
    v_exp_f32 v52, v104
    v_exp_f32 v53, v105
    v_exp_f32 v54, v106
    v_exp_f32 v55, v107
    v_exp_f32 v56, v108
    v_exp_f32 v57, v109
    v_exp_f32 v58, v110
    v_exp_f32 v59, v111
    s_nop 0
    v_cvt_pk_bf16_f32 v148, v52, v53
    v_cvt_pk_bf16_f32 v149, v54, v55
    v_cvt_pk_bf16_f32 v150, v56, v57
    v_cvt_pk_bf16_f32 v151, v58, v59
    s_nop 1
    v_mfma_f32_16x16x32_bf16 v[32:35], v[44:47], v[148:151], 0
    s_nop 7
    s_setpc_b64 s[70:71]
mega_kernel_rs1468:
    s_nop 15
    v_max3_f32 v48, v96, v97, v98
    v_max3_f32 v48, v48, v99, v100
    v_max3_f32 v48, v48, v101, v102
    v_max3_f32 v48, v48, v103, 0
    v_mov_b32 v49, v48
    s_nop 1
    v_permlane32_swap_b32 v48, v49
    s_nop 1
    v_max_f32 v48, v48, v49
    v_mov_b32 v49, v48
    s_nop 1
    v_permlane16_swap_b32 v48, v49
    s_nop 1
    v_max_f32 v48, v48, v49
    v_exp_f32 v49, -v48
    v_sub_f32 v96, v96, v48
    v_sub_f32 v97, v97, v48
    v_sub_f32 v98, v98, v48
    v_sub_f32 v99, v99, v48
    v_sub_f32 v100, v100, v48
    v_sub_f32 v101, v101, v48
    v_sub_f32 v102, v102, v48
    v_sub_f32 v103, v103, v48
    v_sub_f32 v64, v64, v48
    v_sub_f32 v65, v65, v48
    v_sub_f32 v66, v66, v48
    v_sub_f32 v67, v67, v48
    v_sub_f32 v68, v68, v48
    v_sub_f32 v69, v69, v48
    v_sub_f32 v70, v70, v48
    v_sub_f32 v71, v71, v48
    v_sub_f32 v160, v160, v48
    v_sub_f32 v161, v161, v48
    v_sub_f32 v162, v162, v48
    v_sub_f32 v163, v163, v48
    v_sub_f32 v164, v164, v48
    v_sub_f32 v165, v165, v48
    v_sub_f32 v166, v166, v48
    v_sub_f32 v167, v167, v48
    v_mul_f32 v12, v12, v49
    v_accvgpr_read_b32 v52, a0
    v_accvgpr_read_b32 v53, a1
    v_accvgpr_read_b32 v54, a2
    v_accvgpr_read_b32 v55, a3
    v_accvgpr_read_b32 v56, a4
    v_accvgpr_read_b32 v57, a5
    v_accvgpr_read_b32 v58, a6
    v_accvgpr_read_b32 v59, a7
    v_mul_f32 v52, v52, v49
    v_mul_f32 v53, v53, v49
    v_mul_f32 v54, v54, v49
    v_mul_f32 v55, v55, v49
    v_mul_f32 v56, v56, v49
    v_mul_f32 v57, v57, v49
    v_mul_f32 v58, v58, v49
    v_mul_f32 v59, v59, v49
    v_accvgpr_write_b32 a0, v52
    v_accvgpr_write_b32 a1, v53
    v_accvgpr_write_b32 a2, v54
    v_accvgpr_write_b32 a3, v55
    v_accvgpr_write_b32 a4, v56
    v_accvgpr_write_b32 a5, v57
    v_accvgpr_write_b32 a6, v58
    v_accvgpr_write_b32 a7, v59
    v_accvgpr_read_b32 v52, a8
    v_accvgpr_read_b32 v53, a9
    v_accvgpr_read_b32 v54, a10
    v_accvgpr_read_b32 v55, a11
    v_accvgpr_read_b32 v56, a12
    v_accvgpr_read_b32 v57, a13
    v_accvgpr_read_b32 v58, a14
    v_accvgpr_read_b32 v59, a15
    v_mul_f32 v52, v52, v49
    v_mul_f32 v53, v53, v49
    v_mul_f32 v54, v54, v49
    v_mul_f32 v55, v55, v49
    v_mul_f32 v56, v56, v49
    v_mul_f32 v57, v57, v49
    v_mul_f32 v58, v58, v49
    v_mul_f32 v59, v59, v49
    v_accvgpr_write_b32 a8, v52
    v_accvgpr_write_b32 a9, v53
    v_accvgpr_write_b32 a10, v54
    v_accvgpr_write_b32 a11, v55
    v_accvgpr_write_b32 a12, v56
    v_accvgpr_write_b32 a13, v57
    v_accvgpr_write_b32 a14, v58
    v_accvgpr_write_b32 a15, v59
    v_accvgpr_read_b32 v52, a16
    v_accvgpr_read_b32 v53, a17
    v_accvgpr_read_b32 v54, a18
    v_accvgpr_read_b32 v55, a19
    v_accvgpr_read_b32 v56, a20
    v_accvgpr_read_b32 v57, a21
    v_accvgpr_read_b32 v58, a22
    v_accvgpr_read_b32 v59, a23
    v_mul_f32 v52, v52, v49
    v_mul_f32 v53, v53, v49
    v_mul_f32 v54, v54, v49
    v_mul_f32 v55, v55, v49
    v_mul_f32 v56, v56, v49
    v_mul_f32 v57, v57, v49
    v_mul_f32 v58, v58, v49
    v_mul_f32 v59, v59, v49
    v_accvgpr_write_b32 a16, v52
    v_accvgpr_write_b32 a17, v53
    v_accvgpr_write_b32 a18, v54
    v_accvgpr_write_b32 a19, v55
    v_accvgpr_write_b32 a20, v56
    v_accvgpr_write_b32 a21, v57
    v_accvgpr_write_b32 a22, v58
    v_accvgpr_write_b32 a23, v59
    v_accvgpr_read_b32 v52, a24
    v_accvgpr_read_b32 v53, a25
    v_accvgpr_read_b32 v54, a26
    v_accvgpr_read_b32 v55, a27
    v_accvgpr_read_b32 v56, a28
    v_accvgpr_read_b32 v57, a29
    v_accvgpr_read_b32 v58, a30
    v_accvgpr_read_b32 v59, a31
    v_mul_f32 v52, v52, v49
    v_mul_f32 v53, v53, v49
    v_mul_f32 v54, v54, v49
    v_mul_f32 v55, v55, v49
    v_mul_f32 v56, v56, v49
    v_mul_f32 v57, v57, v49
    v_mul_f32 v58, v58, v49
    v_mul_f32 v59, v59, v49
    v_accvgpr_write_b32 a24, v52
    v_accvgpr_write_b32 a25, v53
    v_accvgpr_write_b32 a26, v54
    v_accvgpr_write_b32 a27, v55
    v_accvgpr_write_b32 a28, v56
    v_accvgpr_write_b32 a29, v57
    v_accvgpr_write_b32 a30, v58
    v_accvgpr_write_b32 a31, v59
    v_exp_f32 v52, v96
    v_exp_f32 v53, v97
    v_exp_f32 v54, v98
    v_exp_f32 v55, v99
    v_exp_f32 v56, v100
    v_exp_f32 v57, v101
    v_exp_f32 v58, v102
    v_exp_f32 v59, v103
    s_nop 0
    v_cvt_pk_bf16_f32 v144, v52, v53
    v_cvt_pk_bf16_f32 v145, v54, v55
    v_cvt_pk_bf16_f32 v146, v56, v57
    v_cvt_pk_bf16_f32 v147, v58, v59
    s_nop 1
    v_mfma_f32_16x16x32_bf16 v[28:31], v[44:47], v[144:147], 0
    v_max3_f32 v48, v104, v105, v106
    v_max3_f32 v48, v48, v107, v108
    v_max3_f32 v48, v48, v109, v110
    v_max3_f32 v48, v48, v111, 0
    v_mov_b32 v49, v48
    s_nop 1
    v_permlane32_swap_b32 v48, v49
    s_nop 1
    v_max_f32 v48, v48, v49
    v_mov_b32 v49, v48
    s_nop 1
    v_permlane16_swap_b32 v48, v49
    s_nop 1
    v_max_f32 v48, v48, v49
    v_exp_f32 v49, -v48
    v_sub_f32 v104, v104, v48
    v_sub_f32 v105, v105, v48
    v_sub_f32 v106, v106, v48
    v_sub_f32 v107, v107, v48
    v_sub_f32 v108, v108, v48
    v_sub_f32 v109, v109, v48
    v_sub_f32 v110, v110, v48
    v_sub_f32 v111, v111, v48
    v_sub_f32 v72, v72, v48
    v_sub_f32 v73, v73, v48
    v_sub_f32 v74, v74, v48
    v_sub_f32 v75, v75, v48
    v_sub_f32 v76, v76, v48
    v_sub_f32 v77, v77, v48
    v_sub_f32 v78, v78, v48
    v_sub_f32 v79, v79, v48
    v_sub_f32 v168, v168, v48
    v_sub_f32 v169, v169, v48
    v_sub_f32 v170, v170, v48
    v_sub_f32 v171, v171, v48
    v_sub_f32 v172, v172, v48
    v_sub_f32 v173, v173, v48
    v_sub_f32 v174, v174, v48
    v_sub_f32 v175, v175, v48
    v_mul_f32 v13, v13, v49
    v_accvgpr_read_b32 v52, a32
    v_accvgpr_read_b32 v53, a33
    v_accvgpr_read_b32 v54, a34
    v_accvgpr_read_b32 v55, a35
    v_accvgpr_read_b32 v56, a36
    v_accvgpr_read_b32 v57, a37
    v_accvgpr_read_b32 v58, a38
    v_accvgpr_read_b32 v59, a39
    v_mul_f32 v52, v52, v49
    v_mul_f32 v53, v53, v49
    v_mul_f32 v54, v54, v49
    v_mul_f32 v55, v55, v49
    v_mul_f32 v56, v56, v49
    v_mul_f32 v57, v57, v49
    v_mul_f32 v58, v58, v49
    v_mul_f32 v59, v59, v49
    v_accvgpr_write_b32 a32, v52
    v_accvgpr_write_b32 a33, v53
    v_accvgpr_write_b32 a34, v54
    v_accvgpr_write_b32 a35, v55
    v_accvgpr_write_b32 a36, v56
    v_accvgpr_write_b32 a37, v57
    v_accvgpr_write_b32 a38, v58
    v_accvgpr_write_b32 a39, v59
    v_accvgpr_read_b32 v52, a40
    v_accvgpr_read_b32 v53, a41
    v_accvgpr_read_b32 v54, a42
    v_accvgpr_read_b32 v55, a43
    v_accvgpr_read_b32 v56, a44
    v_accvgpr_read_b32 v57, a45
    v_accvgpr_read_b32 v58, a46
    v_accvgpr_read_b32 v59, a47
    v_mul_f32 v52, v52, v49
    v_mul_f32 v53, v53, v49
    v_mul_f32 v54, v54, v49
    v_mul_f32 v55, v55, v49
    v_mul_f32 v56, v56, v49
    v_mul_f32 v57, v57, v49
    v_mul_f32 v58, v58, v49
    v_mul_f32 v59, v59, v49
    v_accvgpr_write_b32 a40, v52
    v_accvgpr_write_b32 a41, v53
    v_accvgpr_write_b32 a42, v54
    v_accvgpr_write_b32 a43, v55
    v_accvgpr_write_b32 a44, v56
    v_accvgpr_write_b32 a45, v57
    v_accvgpr_write_b32 a46, v58
    v_accvgpr_write_b32 a47, v59
    v_accvgpr_read_b32 v52, a48
    v_accvgpr_read_b32 v53, a49
    v_accvgpr_read_b32 v54, a50
    v_accvgpr_read_b32 v55, a51
    v_accvgpr_read_b32 v56, a52
    v_accvgpr_read_b32 v57, a53
    v_accvgpr_read_b32 v58, a54
    v_accvgpr_read_b32 v59, a55
    v_mul_f32 v52, v52, v49
    v_mul_f32 v53, v53, v49
    v_mul_f32 v54, v54, v49
    v_mul_f32 v55, v55, v49
    v_mul_f32 v56, v56, v49
    v_mul_f32 v57, v57, v49
    v_mul_f32 v58, v58, v49
    v_mul_f32 v59, v59, v49
    v_accvgpr_write_b32 a48, v52
    v_accvgpr_write_b32 a49, v53
    v_accvgpr_write_b32 a50, v54
    v_accvgpr_write_b32 a51, v55
    v_accvgpr_write_b32 a52, v56
    v_accvgpr_write_b32 a53, v57
    v_accvgpr_write_b32 a54, v58
    v_accvgpr_write_b32 a55, v59
    v_accvgpr_read_b32 v52, a56
    v_accvgpr_read_b32 v53, a57
    v_accvgpr_read_b32 v54, a58
    v_accvgpr_read_b32 v55, a59
    v_accvgpr_read_b32 v56, a60
    v_accvgpr_read_b32 v57, a61
    v_accvgpr_read_b32 v58, a62
    v_accvgpr_read_b32 v59, a63
    v_mul_f32 v52, v52, v49
    v_mul_f32 v53, v53, v49
    v_mul_f32 v54, v54, v49
    v_mul_f32 v55, v55, v49
    v_mul_f32 v56, v56, v49
    v_mul_f32 v57, v57, v49
    v_mul_f32 v58, v58, v49
    v_mul_f32 v59, v59, v49
    v_accvgpr_write_b32 a56, v52
    v_accvgpr_write_b32 a57, v53
    v_accvgpr_write_b32 a58, v54
    v_accvgpr_write_b32 a59, v55
    v_accvgpr_write_b32 a60, v56
    v_accvgpr_write_b32 a61, v57
    v_accvgpr_write_b32 a62, v58
    v_accvgpr_write_b32 a63, v59
    v_exp_f32 v52, v104
    v_exp_f32 v53, v105
    v_exp_f32 v54, v106
    v_exp_f32 v55, v107
    v_exp_f32 v56, v108
    v_exp_f32 v57, v109
    v_exp_f32 v58, v110
    v_exp_f32 v59, v111
    s_nop 0
    v_cvt_pk_bf16_f32 v148, v52, v53
    v_cvt_pk_bf16_f32 v149, v54, v55
    v_cvt_pk_bf16_f32 v150, v56, v57
    v_cvt_pk_bf16_f32 v151, v58, v59
    s_nop 1
    v_mfma_f32_16x16x32_bf16 v[32:35], v[44:47], v[148:151], 0
    v_max3_f32 v48, v112, v113, v114
    v_max3_f32 v48, v48, v115, v116
    v_max3_f32 v48, v48, v117, v118
    v_max3_f32 v48, v48, v119, 0
    v_mov_b32 v49, v48
    s_nop 1
    v_permlane32_swap_b32 v48, v49
    s_nop 1
    v_max_f32 v48, v48, v49
    v_mov_b32 v49, v48
    s_nop 1
    v_permlane16_swap_b32 v48, v49
    s_nop 1
    v_max_f32 v48, v48, v49
    v_exp_f32 v49, -v48
    v_sub_f32 v112, v112, v48
    v_sub_f32 v113, v113, v48
    v_sub_f32 v114, v114, v48
    v_sub_f32 v115, v115, v48
    v_sub_f32 v116, v116, v48
    v_sub_f32 v117, v117, v48
    v_sub_f32 v118, v118, v48
    v_sub_f32 v119, v119, v48
    v_sub_f32 v80, v80, v48
    v_sub_f32 v81, v81, v48
    v_sub_f32 v82, v82, v48
    v_sub_f32 v83, v83, v48
    v_sub_f32 v84, v84, v48
    v_sub_f32 v85, v85, v48
    v_sub_f32 v86, v86, v48
    v_sub_f32 v87, v87, v48
    v_sub_f32 v176, v176, v48
    v_sub_f32 v177, v177, v48
    v_sub_f32 v178, v178, v48
    v_sub_f32 v179, v179, v48
    v_sub_f32 v180, v180, v48
    v_sub_f32 v181, v181, v48
    v_sub_f32 v182, v182, v48
    v_sub_f32 v183, v183, v48
    v_mul_f32 v14, v14, v49
    v_accvgpr_read_b32 v52, a64
    v_accvgpr_read_b32 v53, a65
    v_accvgpr_read_b32 v54, a66
    v_accvgpr_read_b32 v55, a67
    v_accvgpr_read_b32 v56, a68
    v_accvgpr_read_b32 v57, a69
    v_accvgpr_read_b32 v58, a70
    v_accvgpr_read_b32 v59, a71
    v_mul_f32 v52, v52, v49
    v_mul_f32 v53, v53, v49
    v_mul_f32 v54, v54, v49
    v_mul_f32 v55, v55, v49
    v_mul_f32 v56, v56, v49
    v_mul_f32 v57, v57, v49
    v_mul_f32 v58, v58, v49
    v_mul_f32 v59, v59, v49
    v_accvgpr_write_b32 a64, v52
    v_accvgpr_write_b32 a65, v53
    v_accvgpr_write_b32 a66, v54
    v_accvgpr_write_b32 a67, v55
    v_accvgpr_write_b32 a68, v56
    v_accvgpr_write_b32 a69, v57
    v_accvgpr_write_b32 a70, v58
    v_accvgpr_write_b32 a71, v59
    v_accvgpr_read_b32 v52, a72
    v_accvgpr_read_b32 v53, a73
    v_accvgpr_read_b32 v54, a74
    v_accvgpr_read_b32 v55, a75
    v_accvgpr_read_b32 v56, a76
    v_accvgpr_read_b32 v57, a77
    v_accvgpr_read_b32 v58, a78
    v_accvgpr_read_b32 v59, a79
    v_mul_f32 v52, v52, v49
    v_mul_f32 v53, v53, v49
    v_mul_f32 v54, v54, v49
    v_mul_f32 v55, v55, v49
    v_mul_f32 v56, v56, v49
    v_mul_f32 v57, v57, v49
    v_mul_f32 v58, v58, v49
    v_mul_f32 v59, v59, v49
    v_accvgpr_write_b32 a72, v52
    v_accvgpr_write_b32 a73, v53
    v_accvgpr_write_b32 a74, v54
    v_accvgpr_write_b32 a75, v55
    v_accvgpr_write_b32 a76, v56
    v_accvgpr_write_b32 a77, v57
    v_accvgpr_write_b32 a78, v58
    v_accvgpr_write_b32 a79, v59
    v_accvgpr_read_b32 v52, a80
    v_accvgpr_read_b32 v53, a81
    v_accvgpr_read_b32 v54, a82
    v_accvgpr_read_b32 v55, a83
    v_accvgpr_read_b32 v56, a84
    v_accvgpr_read_b32 v57, a85
    v_accvgpr_read_b32 v58, a86
    v_accvgpr_read_b32 v59, a87
    v_mul_f32 v52, v52, v49
    v_mul_f32 v53, v53, v49
    v_mul_f32 v54, v54, v49
    v_mul_f32 v55, v55, v49
    v_mul_f32 v56, v56, v49
    v_mul_f32 v57, v57, v49
    v_mul_f32 v58, v58, v49
    v_mul_f32 v59, v59, v49
    v_accvgpr_write_b32 a80, v52
    v_accvgpr_write_b32 a81, v53
    v_accvgpr_write_b32 a82, v54
    v_accvgpr_write_b32 a83, v55
    v_accvgpr_write_b32 a84, v56
    v_accvgpr_write_b32 a85, v57
    v_accvgpr_write_b32 a86, v58
    v_accvgpr_write_b32 a87, v59
    v_accvgpr_read_b32 v52, a88
    v_accvgpr_read_b32 v53, a89
    v_accvgpr_read_b32 v54, a90
    v_accvgpr_read_b32 v55, a91
    v_accvgpr_read_b32 v56, a92
    v_accvgpr_read_b32 v57, a93
    v_accvgpr_read_b32 v58, a94
    v_accvgpr_read_b32 v59, a95
    v_mul_f32 v52, v52, v49
    v_mul_f32 v53, v53, v49
    v_mul_f32 v54, v54, v49
    v_mul_f32 v55, v55, v49
    v_mul_f32 v56, v56, v49
    v_mul_f32 v57, v57, v49
    v_mul_f32 v58, v58, v49
    v_mul_f32 v59, v59, v49
    v_accvgpr_write_b32 a88, v52
    v_accvgpr_write_b32 a89, v53
    v_accvgpr_write_b32 a90, v54
    v_accvgpr_write_b32 a91, v55
    v_accvgpr_write_b32 a92, v56
    v_accvgpr_write_b32 a93, v57
    v_accvgpr_write_b32 a94, v58
    v_accvgpr_write_b32 a95, v59
    v_exp_f32 v52, v112
    v_exp_f32 v53, v113
    v_exp_f32 v54, v114
    v_exp_f32 v55, v115
    v_exp_f32 v56, v116
    v_exp_f32 v57, v117
    v_exp_f32 v58, v118
    v_exp_f32 v59, v119
    s_nop 0
    v_cvt_pk_bf16_f32 v152, v52, v53
    v_cvt_pk_bf16_f32 v153, v54, v55
    v_cvt_pk_bf16_f32 v154, v56, v57
    v_cvt_pk_bf16_f32 v155, v58, v59
    s_nop 1
    v_mfma_f32_16x16x32_bf16 v[36:39], v[44:47], v[152:155], 0
    v_max3_f32 v48, v120, v121, v122
    v_max3_f32 v48, v48, v123, v124
    v_max3_f32 v48, v48, v125, v126
    v_max3_f32 v48, v48, v127, 0
    v_mov_b32 v49, v48
    s_nop 1
    v_permlane32_swap_b32 v48, v49
    s_nop 1
    v_max_f32 v48, v48, v49
    v_mov_b32 v49, v48
    s_nop 1
    v_permlane16_swap_b32 v48, v49
    s_nop 1
    v_max_f32 v48, v48, v49
    v_exp_f32 v49, -v48
    v_sub_f32 v120, v120, v48
    v_sub_f32 v121, v121, v48
    v_sub_f32 v122, v122, v48
    v_sub_f32 v123, v123, v48
    v_sub_f32 v124, v124, v48
    v_sub_f32 v125, v125, v48
    v_sub_f32 v126, v126, v48
    v_sub_f32 v127, v127, v48
    v_sub_f32 v88, v88, v48
    v_sub_f32 v89, v89, v48
    v_sub_f32 v90, v90, v48
    v_sub_f32 v91, v91, v48
    v_sub_f32 v92, v92, v48
    v_sub_f32 v93, v93, v48
    v_sub_f32 v94, v94, v48
    v_sub_f32 v95, v95, v48
    v_sub_f32 v184, v184, v48
    v_sub_f32 v185, v185, v48
    v_sub_f32 v186, v186, v48
    v_sub_f32 v187, v187, v48
    v_sub_f32 v188, v188, v48
    v_sub_f32 v189, v189, v48
    v_sub_f32 v190, v190, v48
    v_sub_f32 v191, v191, v48
    v_mul_f32 v15, v15, v49
    v_accvgpr_read_b32 v52, a96
    v_accvgpr_read_b32 v53, a97
    v_accvgpr_read_b32 v54, a98
    v_accvgpr_read_b32 v55, a99
    v_accvgpr_read_b32 v56, a100
    v_accvgpr_read_b32 v57, a101
    v_accvgpr_read_b32 v58, a102
    v_accvgpr_read_b32 v59, a103
    v_mul_f32 v52, v52, v49
    v_mul_f32 v53, v53, v49
    v_mul_f32 v54, v54, v49
    v_mul_f32 v55, v55, v49
    v_mul_f32 v56, v56, v49
    v_mul_f32 v57, v57, v49
    v_mul_f32 v58, v58, v49
    v_mul_f32 v59, v59, v49
    v_accvgpr_write_b32 a96, v52
    v_accvgpr_write_b32 a97, v53
    v_accvgpr_write_b32 a98, v54
    v_accvgpr_write_b32 a99, v55
    v_accvgpr_write_b32 a100, v56
    v_accvgpr_write_b32 a101, v57
    v_accvgpr_write_b32 a102, v58
    v_accvgpr_write_b32 a103, v59
    v_accvgpr_read_b32 v52, a104
    v_accvgpr_read_b32 v53, a105
    v_accvgpr_read_b32 v54, a106
    v_accvgpr_read_b32 v55, a107
    v_accvgpr_read_b32 v56, a108
    v_accvgpr_read_b32 v57, a109
    v_accvgpr_read_b32 v58, a110
    v_accvgpr_read_b32 v59, a111
    v_mul_f32 v52, v52, v49
    v_mul_f32 v53, v53, v49
    v_mul_f32 v54, v54, v49
    v_mul_f32 v55, v55, v49
    v_mul_f32 v56, v56, v49
    v_mul_f32 v57, v57, v49
    v_mul_f32 v58, v58, v49
    v_mul_f32 v59, v59, v49
    v_accvgpr_write_b32 a104, v52
    v_accvgpr_write_b32 a105, v53
    v_accvgpr_write_b32 a106, v54
    v_accvgpr_write_b32 a107, v55
    v_accvgpr_write_b32 a108, v56
    v_accvgpr_write_b32 a109, v57
    v_accvgpr_write_b32 a110, v58
    v_accvgpr_write_b32 a111, v59
    v_accvgpr_read_b32 v52, a112
    v_accvgpr_read_b32 v53, a113
    v_accvgpr_read_b32 v54, a114
    v_accvgpr_read_b32 v55, a115
    v_accvgpr_read_b32 v56, a116
    v_accvgpr_read_b32 v57, a117
    v_accvgpr_read_b32 v58, a118
    v_accvgpr_read_b32 v59, a119
    v_mul_f32 v52, v52, v49
    v_mul_f32 v53, v53, v49
    v_mul_f32 v54, v54, v49
    v_mul_f32 v55, v55, v49
    v_mul_f32 v56, v56, v49
    v_mul_f32 v57, v57, v49
    v_mul_f32 v58, v58, v49
    v_mul_f32 v59, v59, v49
    v_accvgpr_write_b32 a112, v52
    v_accvgpr_write_b32 a113, v53
    v_accvgpr_write_b32 a114, v54
    v_accvgpr_write_b32 a115, v55
    v_accvgpr_write_b32 a116, v56
    v_accvgpr_write_b32 a117, v57
    v_accvgpr_write_b32 a118, v58
    v_accvgpr_write_b32 a119, v59
    v_accvgpr_read_b32 v52, a120
    v_accvgpr_read_b32 v53, a121
    v_accvgpr_read_b32 v54, a122
    v_accvgpr_read_b32 v55, a123
    v_accvgpr_read_b32 v56, a124
    v_accvgpr_read_b32 v57, a125
    v_accvgpr_read_b32 v58, a126
    v_accvgpr_read_b32 v59, a127
    v_mul_f32 v52, v52, v49
    v_mul_f32 v53, v53, v49
    v_mul_f32 v54, v54, v49
    v_mul_f32 v55, v55, v49
    v_mul_f32 v56, v56, v49
    v_mul_f32 v57, v57, v49
    v_mul_f32 v58, v58, v49
    v_mul_f32 v59, v59, v49
    v_accvgpr_write_b32 a120, v52
    v_accvgpr_write_b32 a121, v53
    v_accvgpr_write_b32 a122, v54
    v_accvgpr_write_b32 a123, v55
    v_accvgpr_write_b32 a124, v56
    v_accvgpr_write_b32 a125, v57
    v_accvgpr_write_b32 a126, v58
    v_accvgpr_write_b32 a127, v59
    v_exp_f32 v52, v120
    v_exp_f32 v53, v121
    v_exp_f32 v54, v122
    v_exp_f32 v55, v123
    v_exp_f32 v56, v124
    v_exp_f32 v57, v125
    v_exp_f32 v58, v126
    v_exp_f32 v59, v127
    s_nop 0
    v_cvt_pk_bf16_f32 v156, v52, v53
    v_cvt_pk_bf16_f32 v157, v54, v55
    v_cvt_pk_bf16_f32 v158, v56, v57
    v_cvt_pk_bf16_f32 v159, v58, v59
    s_nop 1
    v_mfma_f32_16x16x32_bf16 v[40:43], v[44:47], v[156:159], 0
    s_nop 7
    s_setpc_b64 s[70:71]
mega_kernel_hook13:
    s_cmp_lg_u32 s16, 0
    s_cbranch_scc1 mega_kernel_np37
    v_mov_b32 v4, s4
    v_mov_b32 v5, s5
    s_add_u32 s90, s17, 117440512
    s_mov_b64 exec, 1
    buffer_store_dwordx2 v[4:5], off, s[8:11], s90 sc1
    s_mov_b64 exec, -1
mega_kernel_np37:
    s_mov_b32 s17, -1
    s_branch mega_kernel_hookr14
mega_kernel_hook17:
    s_cmp_lg_u32 s16, 0
    s_cbranch_scc1 mega_kernel_np38
    v_mov_b32 v4, s4
    v_mov_b32 v5, s5
    s_add_u32 s90, s17, 117440512
    s_mov_b64 exec, 1
    buffer_store_dwordx2 v[4:5], off, s[8:11], s90 sc1
    s_mov_b64 exec, -1
mega_kernel_np38:
    s_mov_b32 s17, -1
    s_branch mega_kernel_hookr18
mega_kernel_dosw16:
    s_cmp_eq_u32 s17, -1
    s_cbranch_scc1 mega_kernel_x39
    s_cmp_lg_u32 s16, 0
    s_cbranch_scc1 mega_kernel_np44
    v_mov_b32 v4, s4
    v_mov_b32 v5, s5
    s_add_u32 s90, s17, 117440512
    s_mov_b64 exec, 1
    buffer_store_dwordx2 v[4:5], off, s[8:11], s90 sc1
    s_mov_b64 exec, -1
mega_kernel_np44:
    s_mov_b32 s17, -1
    s_mov_b32 s67, 3
    s_cmp_gt_u32 s65, 3
    s_cbranch_scc1 mega_kernel_loop15
mega_kernel_x39:
    s_cmp_eq_u32 s94, 0
    s_cbranch_scc1 mega_kernel_x40
    s_mov_b32 s42, s73
    s_mov_b32 s46, s76
    s_lshl_b32 s90, s77, 4
    s_lshl_b32 s90, s90, s81
    s_mov_b32 s48, s79
    s_mul_i32 s91, s90, 1
    s_add_u32 s49, s91, s79
    s_sub_u32 s49, s49, 2048
    s_mul_i32 s91, s90, 2
    s_add_u32 s50, s91, s79
    s_mul_i32 s91, s90, 3
    s_add_u32 s51, s91, s79
    s_sub_u32 s51, s51, 2048
    s_mov_b32 s52, s80
    s_lshl_b32 s90, s78, 2
    s_mul_i32 s91, s90, 1
    s_add_u32 s53, s91, s80
    s_sub_u32 s53, s53, 2048
    s_mul_i32 s91, s90, 2
    s_add_u32 s54, s91, s80
    s_mul_i32 s91, s90, 3
    s_add_u32 s55, s91, s80
    s_sub_u32 s55, s55, 2048
    s_lshl_b32 s56, s78, 6
    s_lshl_b32 s90, s58, 7
    s_add_u32 s90, s90, s57
    s_lshl_b32 s91, s16, 6
    s_cmp_eq_u32 s81, 1
    s_cselect_b32 s90, s90, s91
    v_lshrrev_b32 v24, 3, v1
    v_lshlrev_b32 v24, s81, v24
    v_add_u32 v24, s90, v24
    v_mul_lo_u32 v24, v24, s77
    v_lshrrev_b32 v25, 4, v1
    v_and_b32 v26, 7, v1
    v_xor_b32 v25, v25, v26
    v_lshl_add_u32 v16, v25, 4, v24
    v_xor_b32 v25, 4, v25
    v_lshl_add_u32 v17, v25, 4, v24
    s_lshl_b32 s90, s77, 3
    s_lshl_b32 s90, s90, s81
    s_sub_u32 s90, s90, 1024
    v_add_u32 v17, s90, v17
    v_lshrrev_b32 v24, 5, v1
    s_lshl_b32 s90, s16, 4
    v_add_u32 v25, s90, v24
    v_mul_lo_u32 v25, v25, s78
    v_lshlrev_b32 v24, 1, v24
    v_and_b32 v26, 31, v1
    v_xor_b32 v24, v24, v26
    s_lshl_b32 s90, s78, 1
    s_sub_u32 s90, s90, 1024
    v_add_u32 v27, s90, v25
    v_xor_b32 v26, 0, v24
    v_lshl_add_u32 v18, v26, 4, v25
    v_xor_b32 v26, 4, v24
    v_lshl_add_u32 v19, v26, 4, v27
    v_xor_b32 v26, 8, v24
    v_lshl_add_u32 v20, v26, 4, v25
    v_xor_b32 v26, 12, v24
    v_lshl_add_u32 v21, v26, 4, v27
    s_mov_b32 s40, s71
    s_mov_b32 s41, s72
    s_mov_b32 s44, s74
    s_mov_b32 s45, s75
    buffer_load_dwordx2 v[4:5], off, s[12:15], 0 sc1
    s_mov_b32 s67, 0
    s_branch mega_kernel_loop15
mega_kernel_x40:
    s_cmp_eq_u32 s70, 1
    s_cbranch_scc1 mega_kernel_x43
    s_cmp_lg_u32 s65, 3
    s_cbranch_scc1 mega_kernel_x41
    s_and_b32 s92, s2, 7
    s_lshl_b32 s92, s92, 2
    s_bfe_u32 s93, s2, 0x20003
    s_add_u32 s92, s92, s93
    s_lshr_b32 s93, s2, 5
    s_lshl_b32 s93, s93, 2
    s_or_b32 s93, s93, 0x40000
    s_lshr_b32 s90, s92, 1
    s_lshl_b32 s90, s90, 7
    s_add_u32 s90, s90, 117440512
    v_min_u32 v0, 7, v1
    v_add_u32 v0, 8, v0
    v_lshlrev_b32 v0, 3, v0
    buffer_load_dwordx2 v[4:5], v0, s[8:11], s90 offen sc1
    s_branch mega_kernel_loop15
mega_kernel_x41:
    s_waitcnt vmcnt(16)
    s_cmp_lg_u32 s65, 2
    s_cbranch_scc1 mega_kernel_x42
    s_mov_b32 s3, 1048576
mega_kernel_spin45:
    v_cmp_ne_u64 s[22:23], s[4:5], v[4:5]
    s_nop 3
    s_cmp_eq_u64 s[22:23], 0
    s_cbranch_scc1 mega_kernel_ok46
    s_sub_u32 s3, s3, 1
    s_cbranch_scc1 mega_kernel_ok46
    s_sleep 16
    s_and_b32 s92, s2, 7
    s_lshl_b32 s92, s92, 2
    s_bfe_u32 s93, s2, 0x20003
    s_add_u32 s92, s92, s93
    s_lshr_b32 s93, s2, 5
    s_lshl_b32 s93, s93, 2
    s_or_b32 s93, s93, 0x40000
    s_lshr_b32 s90, s92, 1
    s_lshl_b32 s90, s90, 7
    s_add_u32 s90, s90, 117440512
    v_min_u32 v0, 7, v1
    v_add_u32 v0, 8, v0
    v_lshlrev_b32 v0, 3, v0
    buffer_load_dwordx2 v[4:5], v0, s[8:11], s90 offen sc1
    s_waitcnt vmcnt(0)
    s_branch mega_kernel_spin45
mega_kernel_ok46:
    s_and_b32 s92, s2, 7
    s_lshl_b32 s92, s92, 2
    s_bfe_u32 s93, s2, 0x20003
    s_add_u32 s92, s92, s93
    s_lshr_b32 s93, s2, 5
    s_lshl_b32 s93, s93, 2
    s_or_b32 s93, s93, 0x40000
    s_lshr_b32 s90, s92, 1
    s_lshl_b32 s90, s90, 7
    s_add_u32 s90, s90, 117440512
    s_bfe_u32 s91, 1376806003, s93
    s_lshr_b32 s91, s91, 1
    v_mov_b32 v0, s91
    s_bfe_u32 s91, 4242446987, s93
    s_lshr_b32 s91, s91, 1
    v_writelane_b32 v0, s91, 8
    v_lshlrev_b32 v0, 3, v0
    buffer_load_dwordx2 v[4:5], v0, s[8:11], s90 offen sc1
    s_lshl_b32 s90, s92, 19
    s_lshl_b32 s91, s58, 13
    s_add_u32 s90, s90, s91
    s_cmp_eq_u32 s57, 0
    s_mov_b32 s91, 33554432
    s_cselect_b32 s91, 16777216, s91
    s_mov_b32 s42, 0
    s_cselect_b32 s42, 268435456, s42
    s_add_u32 s48, s90, s91
    s_mov_b32 s49, s48
    s_add_u32 s50, s48, 4096
    s_mov_b32 s51, s50
    s_mov_b32 s40, s6
    s_mov_b32 s41, s7
    s_lshl_b32 s90, s92, 19
    s_lshl_b32 s91, s58, 13
    s_add_u32 s90, s90, s91
    s_cmp_eq_u32 s57, 0
    s_mov_b32 s91, 33587200
    s_cselect_b32 s91, 16826368, s91
    s_mov_b32 s46, 268435456
    s_cselect_b32 s46, 268435456, s46
    s_add_u32 s52, s90, s91
    s_mov_b32 s53, s52
    s_add_u32 s54, s52, 4096
    s_mov_b32 s55, s54
    s_mov_b32 s44, s6
    s_mov_b32 s45, s7
    v_mov_b32 v16, v2
    v_mov_b32 v17, v2
    v_mov_b32 v18, v2
    v_mov_b32 v19, v2
    v_mov_b32 v20, v2
    v_mov_b32 v21, v2
    s_branch mega_kernel_loop15
mega_kernel_x42:
    s_mov_b32 s3, 1048576
mega_kernel_spin47:
    v_cmp_ne_u64 s[22:23], s[4:5], v[4:5]
    s_nop 3
    s_cmp_eq_u64 s[22:23], 0
    s_cbranch_scc1 mega_kernel_ok48
    s_sub_u32 s3, s3, 1
    s_cbranch_scc1 mega_kernel_ok48
    s_sleep 16
    s_and_b32 s92, s2, 7
    s_lshl_b32 s92, s92, 2
    s_bfe_u32 s93, s2, 0x20003
    s_add_u32 s92, s92, s93
    s_lshr_b32 s93, s2, 5
    s_lshl_b32 s93, s93, 2
    s_or_b32 s93, s93, 0x40000
    s_lshr_b32 s90, s92, 1
    s_lshl_b32 s90, s90, 7
    s_add_u32 s90, s90, 117440512
    s_bfe_u32 s91, 1376806003, s93
    s_lshr_b32 s91, s91, 1
    v_mov_b32 v0, s91
    s_bfe_u32 s91, 4242446987, s93
    s_lshr_b32 s91, s91, 1
    v_writelane_b32 v0, s91, 8
    v_lshlrev_b32 v0, 3, v0
    buffer_load_dwordx2 v[4:5], v0, s[8:11], s90 offen sc1
    s_waitcnt vmcnt(0)
    s_branch mega_kernel_spin47
mega_kernel_ok48:
    s_and_b32 s92, s2, 7
    s_lshl_b32 s92, s92, 2
    s_bfe_u32 s93, s2, 0x20003
    s_add_u32 s92, s92, s93
    s_lshr_b32 s93, s2, 5
    s_lshl_b32 s93, s93, 2
    s_or_b32 s93, s93, 0x40000
    s_bfe_u32 s90, 4242446987, s93
    s_lshl_b32 s90, s90, 3
    s_lshl_b32 s91, s16, 1
    s_add_u32 s90, s90, s91
    s_lshl_b32 s90, s90, 12
    s_lshl_b32 s91, s92, 19
    s_add_u32 s90, s90, s91
    s_add_u32 s90, s90, 0
    buffer_load_dwordx4 a[128:131], v2, s[8:11], s90 offen offset:0 sc1
    buffer_load_dwordx4 a[132:135], v2, s[8:11], s90 offen offset:1024 sc1
    buffer_load_dwordx4 a[136:139], v2, s[8:11], s90 offen offset:2048 sc1
    buffer_load_dwordx4 a[140:143], v2, s[8:11], s90 offen offset:3072 sc1
    s_bfe_u32 s90, 4242446987, s93
    s_lshl_b32 s90, s90, 3
    s_lshl_b32 s91, s16, 1
    s_add_u32 s90, s90, s91
    s_lshl_b32 s90, s90, 12
    s_lshl_b32 s91, s92, 19
    s_add_u32 s90, s90, s91
    s_add_u32 s90, s90, 4096
    buffer_load_dwordx4 a[144:147], v2, s[8:11], s90 offen offset:0 sc1
    buffer_load_dwordx4 a[148:151], v2, s[8:11], s90 offen offset:1024 sc1
    buffer_load_dwordx4 a[152:155], v2, s[8:11], s90 offen offset:2048 sc1
    buffer_load_dwordx4 a[156:159], v2, s[8:11], s90 offen offset:3072 sc1
    s_bfe_u32 s90, 1376806003, s93
    s_lshl_b32 s90, s90, 3
    s_lshl_b32 s91, s16, 1
    s_add_u32 s90, s90, s91
    s_lshl_b32 s90, s90, 12
    s_lshl_b32 s91, s92, 19
    s_add_u32 s90, s90, s91
    s_add_u32 s90, s90, 0
    buffer_load_dwordx4 a[160:163], v2, s[8:11], s90 offen offset:0 sc1
    buffer_load_dwordx4 a[164:167], v2, s[8:11], s90 offen offset:1024 sc1
    buffer_load_dwordx4 a[168:171], v2, s[8:11], s90 offen offset:2048 sc1
    buffer_load_dwordx4 a[172:175], v2, s[8:11], s90 offen offset:3072 sc1
    s_bfe_u32 s90, 1376806003, s93
    s_lshl_b32 s90, s90, 3
    s_lshl_b32 s91, s16, 1
    s_add_u32 s90, s90, s91
    s_lshl_b32 s90, s90, 12
    s_lshl_b32 s91, s92, 19
    s_add_u32 s90, s90, s91
    s_add_u32 s90, s90, 4096
    buffer_load_dwordx4 a[176:179], v2, s[8:11], s90 offen offset:0 sc1
    buffer_load_dwordx4 a[180:183], v2, s[8:11], s90 offen offset:1024 sc1
    buffer_load_dwordx4 a[184:187], v2, s[8:11], s90 offen offset:2048 sc1
    buffer_load_dwordx4 a[188:191], v2, s[8:11], s90 offen offset:3072 sc1
    s_lshl_b32 s90, s92, 19
    s_lshl_b32 s91, s58, 13
    s_add_u32 s90, s90, s91
    s_cmp_eq_u32 s57, 0
    s_mov_b32 s91, 33554432
    s_cselect_b32 s91, 16793600, s91
    s_mov_b32 s42, 268435456
    s_cselect_b32 s42, 268435456, s42
    s_add_u32 s48, s90, s91
    s_mov_b32 s49, s48
    s_add_u32 s50, s48, 4096
    s_mov_b32 s51, s50
    s_mov_b32 s40, s6
    s_mov_b32 s41, s7
    s_mov_b32 s46, 0
    s_branch mega_kernel_loop15
mega_kernel_x43:
    s_mov_b32 s42, 0
    s_mov_b32 s46, 0
    s_branch mega_kernel_loop15
mega_kernel_dosw20:
    s_cmp_eq_u32 s17, -1
    s_cbranch_scc1 mega_kernel_x49
    s_cmp_lg_u32 s16, 0
    s_cbranch_scc1 mega_kernel_np54
    v_mov_b32 v4, s4
    v_mov_b32 v5, s5
    s_add_u32 s90, s17, 117440512
    s_mov_b64 exec, 1
    buffer_store_dwordx2 v[4:5], off, s[8:11], s90 sc1
    s_mov_b64 exec, -1
mega_kernel_np54:
    s_mov_b32 s17, -1
    s_mov_b32 s67, 3
    s_cmp_gt_u32 s65, 3
    s_cbranch_scc1 mega_kernel_loop19
mega_kernel_x49:
    s_cmp_eq_u32 s94, 0
    s_cbranch_scc1 mega_kernel_x50
    s_mov_b32 s42, s73
    s_mov_b32 s46, s76
    s_lshl_b32 s90, s77, 4
    s_lshl_b32 s90, s90, s81
    s_mov_b32 s48, s79
    s_mul_i32 s91, s90, 1
    s_add_u32 s49, s91, s79
    s_sub_u32 s49, s49, 2048
    s_mul_i32 s91, s90, 2
    s_add_u32 s50, s91, s79
    s_mul_i32 s91, s90, 3
    s_add_u32 s51, s91, s79
    s_sub_u32 s51, s51, 2048
    s_mov_b32 s52, s80
    s_lshl_b32 s90, s78, 2
    s_mul_i32 s91, s90, 1
    s_add_u32 s53, s91, s80
    s_sub_u32 s53, s53, 2048
    s_mul_i32 s91, s90, 2
    s_add_u32 s54, s91, s80
    s_mul_i32 s91, s90, 3
    s_add_u32 s55, s91, s80
    s_sub_u32 s55, s55, 2048
    s_lshl_b32 s56, s78, 6
    s_lshl_b32 s90, s58, 7
    s_add_u32 s90, s90, s57
    s_lshl_b32 s91, s16, 6
    s_cmp_eq_u32 s81, 1
    s_cselect_b32 s90, s90, s91
    v_lshrrev_b32 v24, 3, v1
    v_lshlrev_b32 v24, s81, v24
    v_add_u32 v24, s90, v24
    v_mul_lo_u32 v24, v24, s77
    v_lshrrev_b32 v25, 4, v1
    v_and_b32 v26, 7, v1
    v_xor_b32 v25, v25, v26
    v_lshl_add_u32 v16, v25, 4, v24
    v_xor_b32 v25, 4, v25
    v_lshl_add_u32 v17, v25, 4, v24
    s_lshl_b32 s90, s77, 3
    s_lshl_b32 s90, s90, s81
    s_sub_u32 s90, s90, 1024
    v_add_u32 v17, s90, v17
    v_lshrrev_b32 v24, 5, v1
    s_lshl_b32 s90, s16, 4
    v_add_u32 v25, s90, v24
    v_mul_lo_u32 v25, v25, s78
    v_lshlrev_b32 v24, 1, v24
    v_and_b32 v26, 31, v1
    v_xor_b32 v24, v24, v26
    s_lshl_b32 s90, s78, 1
    s_sub_u32 s90, s90, 1024
    v_add_u32 v27, s90, v25
    v_xor_b32 v26, 0, v24
    v_lshl_add_u32 v18, v26, 4, v25
    v_xor_b32 v26, 4, v24
    v_lshl_add_u32 v19, v26, 4, v27
    v_xor_b32 v26, 8, v24
    v_lshl_add_u32 v20, v26, 4, v25
    v_xor_b32 v26, 12, v24
    v_lshl_add_u32 v21, v26, 4, v27
    s_mov_b32 s40, s71
    s_mov_b32 s41, s72
    s_mov_b32 s44, s74
    s_mov_b32 s45, s75
    buffer_load_dwordx2 v[4:5], off, s[12:15], 0 sc1
    s_mov_b32 s67, 0
    s_branch mega_kernel_loop19
mega_kernel_x50:
    s_cmp_eq_u32 s70, 1
    s_cbranch_scc1 mega_kernel_x53
    s_cmp_lg_u32 s65, 3
    s_cbranch_scc1 mega_kernel_x51
    s_and_b32 s92, s2, 7
    s_lshl_b32 s92, s92, 2
    s_bfe_u32 s93, s2, 0x20003
    s_add_u32 s92, s92, s93
    s_lshr_b32 s93, s2, 5
    s_lshl_b32 s93, s93, 2
    s_or_b32 s93, s93, 0x40000
    s_lshr_b32 s90, s92, 1
    s_lshl_b32 s90, s90, 7
    s_add_u32 s90, s90, 117440512
    v_min_u32 v0, 7, v1
    v_add_u32 v0, 8, v0
    v_lshlrev_b32 v0, 3, v0
    buffer_load_dwordx2 v[4:5], v0, s[8:11], s90 offen sc1
    s_branch mega_kernel_loop19
mega_kernel_x51:
    s_waitcnt vmcnt(16)
    s_cmp_lg_u32 s65, 2
    s_cbranch_scc1 mega_kernel_x52
    s_mov_b32 s3, 1048576
mega_kernel_spin55:
    v_cmp_ne_u64 s[22:23], s[4:5], v[4:5]
    s_nop 3
    s_cmp_eq_u64 s[22:23], 0
    s_cbranch_scc1 mega_kernel_ok56
    s_sub_u32 s3, s3, 1
    s_cbranch_scc1 mega_kernel_ok56
    s_sleep 16
    s_and_b32 s92, s2, 7
    s_lshl_b32 s92, s92, 2
    s_bfe_u32 s93, s2, 0x20003
    s_add_u32 s92, s92, s93
    s_lshr_b32 s93, s2, 5
    s_lshl_b32 s93, s93, 2
    s_or_b32 s93, s93, 0x40000
    s_lshr_b32 s90, s92, 1
    s_lshl_b32 s90, s90, 7
    s_add_u32 s90, s90, 117440512
    v_min_u32 v0, 7, v1
    v_add_u32 v0, 8, v0
    v_lshlrev_b32 v0, 3, v0
    buffer_load_dwordx2 v[4:5], v0, s[8:11], s90 offen sc1
    s_waitcnt vmcnt(0)
    s_branch mega_kernel_spin55
mega_kernel_ok56:
    s_and_b32 s92, s2, 7
    s_lshl_b32 s92, s92, 2
    s_bfe_u32 s93, s2, 0x20003
    s_add_u32 s92, s92, s93
    s_lshr_b32 s93, s2, 5
    s_lshl_b32 s93, s93, 2
    s_or_b32 s93, s93, 0x40000
    s_lshr_b32 s90, s92, 1
    s_lshl_b32 s90, s90, 7
    s_add_u32 s90, s90, 117440512
    s_bfe_u32 s91, 1376806003, s93
    s_lshr_b32 s91, s91, 1
    v_mov_b32 v0, s91
    s_bfe_u32 s91, 4242446987, s93
    s_lshr_b32 s91, s91, 1
    v_writelane_b32 v0, s91, 8
    v_lshlrev_b32 v0, 3, v0
    buffer_load_dwordx2 v[4:5], v0, s[8:11], s90 offen sc1
    s_lshl_b32 s90, s92, 19
    s_lshl_b32 s91, s58, 13
    s_add_u32 s90, s90, s91
    s_cmp_eq_u32 s57, 0
    s_mov_b32 s91, 33554432
    s_cselect_b32 s91, 16777216, s91
    s_mov_b32 s42, 0
    s_cselect_b32 s42, 268435456, s42
    s_add_u32 s48, s90, s91
    s_mov_b32 s49, s48
    s_add_u32 s50, s48, 4096
    s_mov_b32 s51, s50
    s_mov_b32 s40, s6
    s_mov_b32 s41, s7
    s_lshl_b32 s90, s92, 19
    s_lshl_b32 s91, s58, 13
    s_add_u32 s90, s90, s91
    s_cmp_eq_u32 s57, 0
    s_mov_b32 s91, 33587200
    s_cselect_b32 s91, 16826368, s91
    s_mov_b32 s46, 268435456
    s_cselect_b32 s46, 268435456, s46
    s_add_u32 s52, s90, s91
    s_mov_b32 s53, s52
    s_add_u32 s54, s52, 4096
    s_mov_b32 s55, s54
    s_mov_b32 s44, s6
    s_mov_b32 s45, s7
    v_mov_b32 v16, v2
    v_mov_b32 v17, v2
    v_mov_b32 v18, v2
    v_mov_b32 v19, v2
    v_mov_b32 v20, v2
    v_mov_b32 v21, v2
    s_branch mega_kernel_loop19
mega_kernel_x52:
    s_mov_b32 s3, 1048576
mega_kernel_spin57:
    v_cmp_ne_u64 s[22:23], s[4:5], v[4:5]
    s_nop 3
    s_cmp_eq_u64 s[22:23], 0
    s_cbranch_scc1 mega_kernel_ok58
    s_sub_u32 s3, s3, 1
    s_cbranch_scc1 mega_kernel_ok58
    s_sleep 16
    s_and_b32 s92, s2, 7
    s_lshl_b32 s92, s92, 2
    s_bfe_u32 s93, s2, 0x20003
    s_add_u32 s92, s92, s93
    s_lshr_b32 s93, s2, 5
    s_lshl_b32 s93, s93, 2
    s_or_b32 s93, s93, 0x40000
    s_lshr_b32 s90, s92, 1
    s_lshl_b32 s90, s90, 7
    s_add_u32 s90, s90, 117440512
    s_bfe_u32 s91, 1376806003, s93
    s_lshr_b32 s91, s91, 1
    v_mov_b32 v0, s91
    s_bfe_u32 s91, 4242446987, s93
    s_lshr_b32 s91, s91, 1
    v_writelane_b32 v0, s91, 8
    v_lshlrev_b32 v0, 3, v0
    buffer_load_dwordx2 v[4:5], v0, s[8:11], s90 offen sc1
    s_waitcnt vmcnt(0)
    s_branch mega_kernel_spin57
mega_kernel_ok58:
    s_and_b32 s92, s2, 7
    s_lshl_b32 s92, s92, 2
    s_bfe_u32 s93, s2, 0x20003
    s_add_u32 s92, s92, s93
    s_lshr_b32 s93, s2, 5
    s_lshl_b32 s93, s93, 2
    s_or_b32 s93, s93, 0x40000
    s_bfe_u32 s90, 4242446987, s93
    s_lshl_b32 s90, s90, 3
    s_lshl_b32 s91, s16, 1
    s_add_u32 s90, s90, s91
    s_lshl_b32 s90, s90, 12
    s_lshl_b32 s91, s92, 19
    s_add_u32 s90, s90, s91
    s_add_u32 s90, s90, 0
    buffer_load_dwordx4 a[128:131], v2, s[8:11], s90 offen offset:0 sc1
    buffer_load_dwordx4 a[132:135], v2, s[8:11], s90 offen offset:1024 sc1
    buffer_load_dwordx4 a[136:139], v2, s[8:11], s90 offen offset:2048 sc1
    buffer_load_dwordx4 a[140:143], v2, s[8:11], s90 offen offset:3072 sc1
    s_bfe_u32 s90, 4242446987, s93
    s_lshl_b32 s90, s90, 3
    s_lshl_b32 s91, s16, 1
    s_add_u32 s90, s90, s91
    s_lshl_b32 s90, s90, 12
    s_lshl_b32 s91, s92, 19
    s_add_u32 s90, s90, s91
    s_add_u32 s90, s90, 4096
    buffer_load_dwordx4 a[144:147], v2, s[8:11], s90 offen offset:0 sc1
    buffer_load_dwordx4 a[148:151], v2, s[8:11], s90 offen offset:1024 sc1
    buffer_load_dwordx4 a[152:155], v2, s[8:11], s90 offen offset:2048 sc1
    buffer_load_dwordx4 a[156:159], v2, s[8:11], s90 offen offset:3072 sc1
    s_bfe_u32 s90, 1376806003, s93
    s_lshl_b32 s90, s90, 3
    s_lshl_b32 s91, s16, 1
    s_add_u32 s90, s90, s91
    s_lshl_b32 s90, s90, 12
    s_lshl_b32 s91, s92, 19
    s_add_u32 s90, s90, s91
    s_add_u32 s90, s90, 0
    buffer_load_dwordx4 a[160:163], v2, s[8:11], s90 offen offset:0 sc1
    buffer_load_dwordx4 a[164:167], v2, s[8:11], s90 offen offset:1024 sc1
    buffer_load_dwordx4 a[168:171], v2, s[8:11], s90 offen offset:2048 sc1
    buffer_load_dwordx4 a[172:175], v2, s[8:11], s90 offen offset:3072 sc1
    s_bfe_u32 s90, 1376806003, s93
    s_lshl_b32 s90, s90, 3
    s_lshl_b32 s91, s16, 1
    s_add_u32 s90, s90, s91
    s_lshl_b32 s90, s90, 12
    s_lshl_b32 s91, s92, 19
    s_add_u32 s90, s90, s91
    s_add_u32 s90, s90, 4096
    buffer_load_dwordx4 a[176:179], v2, s[8:11], s90 offen offset:0 sc1
    buffer_load_dwordx4 a[180:183], v2, s[8:11], s90 offen offset:1024 sc1
    buffer_load_dwordx4 a[184:187], v2, s[8:11], s90 offen offset:2048 sc1
    buffer_load_dwordx4 a[188:191], v2, s[8:11], s90 offen offset:3072 sc1
    s_lshl_b32 s90, s92, 19
    s_lshl_b32 s91, s58, 13
    s_add_u32 s90, s90, s91
    s_cmp_eq_u32 s57, 0
    s_mov_b32 s91, 33554432
    s_cselect_b32 s91, 16793600, s91
    s_mov_b32 s42, 268435456
    s_cselect_b32 s42, 268435456, s42
    s_add_u32 s48, s90, s91
    s_mov_b32 s49, s48
    s_add_u32 s50, s48, 4096
    s_mov_b32 s51, s50
    s_mov_b32 s40, s6
    s_mov_b32 s41, s7
    s_mov_b32 s46, 0
    s_branch mega_kernel_loop19
mega_kernel_x53:
    s_mov_b32 s42, 0
    s_mov_b32 s46, 0
    s_branch mega_kernel_loop19
mega_kernel_eps22:
    s_mov_b32 s92, s97
    s_mov_b32 s93, s97
    s_cmp_eq_u32 s97, 0
    s_cbranch_scc1 mega_kernel_ns359
    v_pk_mul_f32 v[32:33], v[32:33], s[92:93]
    v_pk_mul_f32 v[34:35], v[34:35], s[92:93]
    v_pk_mul_f32 v[36:37], v[36:37], s[92:93]
    v_pk_mul_f32 v[38:39], v[38:39], s[92:93]
    v_cvt_pk_bf16_f32 v32, v32, v33
    v_cvt_pk_bf16_f32 v33, v34, v35
    v_cvt_pk_bf16_f32 v34, v36, v37
    v_cvt_pk_bf16_f32 v35, v38, v39
    v_accvgpr_write_b32 a128, v32
    v_accvgpr_write_b32 a129, v33
    v_accvgpr_write_b32 a130, v34
    v_accvgpr_write_b32 a131, v35
    v_pk_mul_f32 v[40:41], v[40:41], s[92:93]
    v_pk_mul_f32 v[42:43], v[42:43], s[92:93]
    v_pk_mul_f32 v[44:45], v[44:45], s[92:93]
    v_pk_mul_f32 v[46:47], v[46:47], s[92:93]
    v_cvt_pk_bf16_f32 v40, v40, v41
    v_cvt_pk_bf16_f32 v41, v42, v43
    v_cvt_pk_bf16_f32 v42, v44, v45
    v_cvt_pk_bf16_f32 v43, v46, v47
    v_accvgpr_write_b32 a132, v40
    v_accvgpr_write_b32 a133, v41
    v_accvgpr_write_b32 a134, v42
    v_accvgpr_write_b32 a135, v43
    v_pk_mul_f32 v[48:49], v[48:49], s[92:93]
    v_pk_mul_f32 v[50:51], v[50:51], s[92:93]
    v_pk_mul_f32 v[52:53], v[52:53], s[92:93]
    v_pk_mul_f32 v[54:55], v[54:55], s[92:93]
    v_cvt_pk_bf16_f32 v48, v48, v49
    v_cvt_pk_bf16_f32 v49, v50, v51
    v_cvt_pk_bf16_f32 v50, v52, v53
    v_cvt_pk_bf16_f32 v51, v54, v55
    v_accvgpr_write_b32 a136, v48
    v_accvgpr_write_b32 a137, v49
    v_accvgpr_write_b32 a138, v50
    v_accvgpr_write_b32 a139, v51
    v_pk_mul_f32 v[56:57], v[56:57], s[92:93]
    v_pk_mul_f32 v[58:59], v[58:59], s[92:93]
    v_pk_mul_f32 v[60:61], v[60:61], s[92:93]
    v_pk_mul_f32 v[62:63], v[62:63], s[92:93]
    v_cvt_pk_bf16_f32 v56, v56, v57
    v_cvt_pk_bf16_f32 v57, v58, v59
    v_cvt_pk_bf16_f32 v58, v60, v61
    v_cvt_pk_bf16_f32 v59, v62, v63
    v_accvgpr_write_b32 a140, v56
    v_accvgpr_write_b32 a141, v57
    v_accvgpr_write_b32 a142, v58
    v_accvgpr_write_b32 a143, v59
    v_pk_mul_f32 v[64:65], v[64:65], s[92:93]
    v_pk_mul_f32 v[66:67], v[66:67], s[92:93]
    v_pk_mul_f32 v[68:69], v[68:69], s[92:93]
    v_pk_mul_f32 v[70:71], v[70:71], s[92:93]
    v_cvt_pk_bf16_f32 v64, v64, v65
    v_cvt_pk_bf16_f32 v65, v66, v67
    v_cvt_pk_bf16_f32 v66, v68, v69
    v_cvt_pk_bf16_f32 v67, v70, v71
    v_accvgpr_write_b32 a144, v64
    v_accvgpr_write_b32 a145, v65
    v_accvgpr_write_b32 a146, v66
    v_accvgpr_write_b32 a147, v67
    v_pk_mul_f32 v[72:73], v[72:73], s[92:93]
    v_pk_mul_f32 v[74:75], v[74:75], s[92:93]
    v_pk_mul_f32 v[76:77], v[76:77], s[92:93]
    v_pk_mul_f32 v[78:79], v[78:79], s[92:93]
    v_cvt_pk_bf16_f32 v72, v72, v73
    v_cvt_pk_bf16_f32 v73, v74, v75
    v_cvt_pk_bf16_f32 v74, v76, v77
    v_cvt_pk_bf16_f32 v75, v78, v79
    v_accvgpr_write_b32 a148, v72
    v_accvgpr_write_b32 a149, v73
    v_accvgpr_write_b32 a150, v74
    v_accvgpr_write_b32 a151, v75
    v_pk_mul_f32 v[80:81], v[80:81], s[92:93]
    v_pk_mul_f32 v[82:83], v[82:83], s[92:93]
    v_pk_mul_f32 v[84:85], v[84:85], s[92:93]
    v_pk_mul_f32 v[86:87], v[86:87], s[92:93]
    v_cvt_pk_bf16_f32 v80, v80, v81
    v_cvt_pk_bf16_f32 v81, v82, v83
    v_cvt_pk_bf16_f32 v82, v84, v85
    v_cvt_pk_bf16_f32 v83, v86, v87
    v_accvgpr_write_b32 a152, v80
    v_accvgpr_write_b32 a153, v81
    v_accvgpr_write_b32 a154, v82
    v_accvgpr_write_b32 a155, v83
    v_pk_mul_f32 v[88:89], v[88:89], s[92:93]
    v_pk_mul_f32 v[90:91], v[90:91], s[92:93]
    v_pk_mul_f32 v[92:93], v[92:93], s[92:93]
    v_pk_mul_f32 v[94:95], v[94:95], s[92:93]
    v_cvt_pk_bf16_f32 v88, v88, v89
    v_cvt_pk_bf16_f32 v89, v90, v91
    v_cvt_pk_bf16_f32 v90, v92, v93
    v_cvt_pk_bf16_f32 v91, v94, v95
    v_accvgpr_write_b32 a156, v88
    v_accvgpr_write_b32 a157, v89
    v_accvgpr_write_b32 a158, v90
    v_accvgpr_write_b32 a159, v91
    v_pk_mul_f32 v[96:97], v[96:97], s[92:93]
    v_pk_mul_f32 v[98:99], v[98:99], s[92:93]
    v_pk_mul_f32 v[100:101], v[100:101], s[92:93]
    v_pk_mul_f32 v[102:103], v[102:103], s[92:93]
    v_cvt_pk_bf16_f32 v96, v96, v97
    v_cvt_pk_bf16_f32 v97, v98, v99
    v_cvt_pk_bf16_f32 v98, v100, v101
    v_cvt_pk_bf16_f32 v99, v102, v103
    v_accvgpr_write_b32 a160, v96
    v_accvgpr_write_b32 a161, v97
    v_accvgpr_write_b32 a162, v98
    v_accvgpr_write_b32 a163, v99
    v_pk_mul_f32 v[104:105], v[104:105], s[92:93]
    v_pk_mul_f32 v[106:107], v[106:107], s[92:93]
    v_pk_mul_f32 v[108:109], v[108:109], s[92:93]
    v_pk_mul_f32 v[110:111], v[110:111], s[92:93]
    v_cvt_pk_bf16_f32 v104, v104, v105
    v_cvt_pk_bf16_f32 v105, v106, v107
    v_cvt_pk_bf16_f32 v106, v108, v109
    v_cvt_pk_bf16_f32 v107, v110, v111
    v_accvgpr_write_b32 a164, v104
    v_accvgpr_write_b32 a165, v105
    v_accvgpr_write_b32 a166, v106
    v_accvgpr_write_b32 a167, v107
    v_pk_mul_f32 v[112:113], v[112:113], s[92:93]
    v_pk_mul_f32 v[114:115], v[114:115], s[92:93]
    v_pk_mul_f32 v[116:117], v[116:117], s[92:93]
    v_pk_mul_f32 v[118:119], v[118:119], s[92:93]
    v_cvt_pk_bf16_f32 v112, v112, v113
    v_cvt_pk_bf16_f32 v113, v114, v115
    v_cvt_pk_bf16_f32 v114, v116, v117
    v_cvt_pk_bf16_f32 v115, v118, v119
    v_accvgpr_write_b32 a168, v112
    v_accvgpr_write_b32 a169, v113
    v_accvgpr_write_b32 a170, v114
    v_accvgpr_write_b32 a171, v115
    v_pk_mul_f32 v[120:121], v[120:121], s[92:93]
    v_pk_mul_f32 v[122:123], v[122:123], s[92:93]
    v_pk_mul_f32 v[124:125], v[124:125], s[92:93]
    v_pk_mul_f32 v[126:127], v[126:127], s[92:93]
    v_cvt_pk_bf16_f32 v120, v120, v121
    v_cvt_pk_bf16_f32 v121, v122, v123
    v_cvt_pk_bf16_f32 v122, v124, v125
    v_cvt_pk_bf16_f32 v123, v126, v127
    v_accvgpr_write_b32 a172, v120
    v_accvgpr_write_b32 a173, v121
    v_accvgpr_write_b32 a174, v122
    v_accvgpr_write_b32 a175, v123
    v_pk_mul_f32 v[128:129], v[128:129], s[92:93]
    v_pk_mul_f32 v[130:131], v[130:131], s[92:93]
    v_pk_mul_f32 v[132:133], v[132:133], s[92:93]
    v_pk_mul_f32 v[134:135], v[134:135], s[92:93]
    v_cvt_pk_bf16_f32 v128, v128, v129
    v_cvt_pk_bf16_f32 v129, v130, v131
    v_cvt_pk_bf16_f32 v130, v132, v133
    v_cvt_pk_bf16_f32 v131, v134, v135
    v_accvgpr_write_b32 a176, v128
    v_accvgpr_write_b32 a177, v129
    v_accvgpr_write_b32 a178, v130
    v_accvgpr_write_b32 a179, v131
    v_pk_mul_f32 v[136:137], v[136:137], s[92:93]
    v_pk_mul_f32 v[138:139], v[138:139], s[92:93]
    v_pk_mul_f32 v[140:141], v[140:141], s[92:93]
    v_pk_mul_f32 v[142:143], v[142:143], s[92:93]
    v_cvt_pk_bf16_f32 v136, v136, v137
    v_cvt_pk_bf16_f32 v137, v138, v139
    v_cvt_pk_bf16_f32 v138, v140, v141
    v_cvt_pk_bf16_f32 v139, v142, v143
    v_accvgpr_write_b32 a180, v136
    v_accvgpr_write_b32 a181, v137
    v_accvgpr_write_b32 a182, v138
    v_accvgpr_write_b32 a183, v139
    v_pk_mul_f32 v[144:145], v[144:145], s[92:93]
    v_pk_mul_f32 v[146:147], v[146:147], s[92:93]
    v_pk_mul_f32 v[148:149], v[148:149], s[92:93]
    v_pk_mul_f32 v[150:151], v[150:151], s[92:93]
    v_cvt_pk_bf16_f32 v144, v144, v145
    v_cvt_pk_bf16_f32 v145, v146, v147
    v_cvt_pk_bf16_f32 v146, v148, v149
    v_cvt_pk_bf16_f32 v147, v150, v151
    v_accvgpr_write_b32 a184, v144
    v_accvgpr_write_b32 a185, v145
    v_accvgpr_write_b32 a186, v146
    v_accvgpr_write_b32 a187, v147
    v_pk_mul_f32 v[152:153], v[152:153], s[92:93]
    v_pk_mul_f32 v[154:155], v[154:155], s[92:93]
    v_pk_mul_f32 v[156:157], v[156:157], s[92:93]
    v_pk_mul_f32 v[158:159], v[158:159], s[92:93]
    v_cvt_pk_bf16_f32 v152, v152, v153
    v_cvt_pk_bf16_f32 v153, v154, v155
    v_cvt_pk_bf16_f32 v154, v156, v157
    v_cvt_pk_bf16_f32 v155, v158, v159
    v_accvgpr_write_b32 a188, v152
    v_accvgpr_write_b32 a189, v153
    v_accvgpr_write_b32 a190, v154
    v_accvgpr_write_b32 a191, v155
    v_pk_mul_f32 v[160:161], v[160:161], s[92:93]
    v_pk_mul_f32 v[162:163], v[162:163], s[92:93]
    v_pk_mul_f32 v[164:165], v[164:165], s[92:93]
    v_pk_mul_f32 v[166:167], v[166:167], s[92:93]
    v_cvt_pk_bf16_f32 v160, v160, v161
    v_cvt_pk_bf16_f32 v161, v162, v163
    v_cvt_pk_bf16_f32 v162, v164, v165
    v_cvt_pk_bf16_f32 v163, v166, v167
    v_accvgpr_write_b32 a192, v160
    v_accvgpr_write_b32 a193, v161
    v_accvgpr_write_b32 a194, v162
    v_accvgpr_write_b32 a195, v163
    v_pk_mul_f32 v[168:169], v[168:169], s[92:93]
    v_pk_mul_f32 v[170:171], v[170:171], s[92:93]
    v_pk_mul_f32 v[172:173], v[172:173], s[92:93]
    v_pk_mul_f32 v[174:175], v[174:175], s[92:93]
    v_cvt_pk_bf16_f32 v168, v168, v169
    v_cvt_pk_bf16_f32 v169, v170, v171
    v_cvt_pk_bf16_f32 v170, v172, v173
    v_cvt_pk_bf16_f32 v171, v174, v175
    v_accvgpr_write_b32 a196, v168
    v_accvgpr_write_b32 a197, v169
    v_accvgpr_write_b32 a198, v170
    v_accvgpr_write_b32 a199, v171
    v_pk_mul_f32 v[176:177], v[176:177], s[92:93]
    v_pk_mul_f32 v[178:179], v[178:179], s[92:93]
    v_pk_mul_f32 v[180:181], v[180:181], s[92:93]
    v_pk_mul_f32 v[182:183], v[182:183], s[92:93]
    v_cvt_pk_bf16_f32 v176, v176, v177
    v_cvt_pk_bf16_f32 v177, v178, v179
    v_cvt_pk_bf16_f32 v178, v180, v181
    v_cvt_pk_bf16_f32 v179, v182, v183
    v_accvgpr_write_b32 a200, v176
    v_accvgpr_write_b32 a201, v177
    v_accvgpr_write_b32 a202, v178
    v_accvgpr_write_b32 a203, v179
    v_pk_mul_f32 v[184:185], v[184:185], s[92:93]
    v_pk_mul_f32 v[186:187], v[186:187], s[92:93]
    v_pk_mul_f32 v[188:189], v[188:189], s[92:93]
    v_pk_mul_f32 v[190:191], v[190:191], s[92:93]
    v_cvt_pk_bf16_f32 v184, v184, v185
    v_cvt_pk_bf16_f32 v185, v186, v187
    v_cvt_pk_bf16_f32 v186, v188, v189
    v_cvt_pk_bf16_f32 v187, v190, v191
    v_accvgpr_write_b32 a204, v184
    v_accvgpr_write_b32 a205, v185
    v_accvgpr_write_b32 a206, v186
    v_accvgpr_write_b32 a207, v187
    v_pk_mul_f32 v[192:193], v[192:193], s[92:93]
    v_pk_mul_f32 v[194:195], v[194:195], s[92:93]
    v_pk_mul_f32 v[196:197], v[196:197], s[92:93]
    v_pk_mul_f32 v[198:199], v[198:199], s[92:93]
    v_cvt_pk_bf16_f32 v192, v192, v193
    v_cvt_pk_bf16_f32 v193, v194, v195
    v_cvt_pk_bf16_f32 v194, v196, v197
    v_cvt_pk_bf16_f32 v195, v198, v199
    v_accvgpr_write_b32 a208, v192
    v_accvgpr_write_b32 a209, v193
    v_accvgpr_write_b32 a210, v194
    v_accvgpr_write_b32 a211, v195
    v_pk_mul_f32 v[200:201], v[200:201], s[92:93]
    v_pk_mul_f32 v[202:203], v[202:203], s[92:93]
    v_pk_mul_f32 v[204:205], v[204:205], s[92:93]
    v_pk_mul_f32 v[206:207], v[206:207], s[92:93]
    v_cvt_pk_bf16_f32 v200, v200, v201
    v_cvt_pk_bf16_f32 v201, v202, v203
    v_cvt_pk_bf16_f32 v202, v204, v205
    v_cvt_pk_bf16_f32 v203, v206, v207
    v_accvgpr_write_b32 a212, v200
    v_accvgpr_write_b32 a213, v201
    v_accvgpr_write_b32 a214, v202
    v_accvgpr_write_b32 a215, v203
    v_pk_mul_f32 v[208:209], v[208:209], s[92:93]
    v_pk_mul_f32 v[210:211], v[210:211], s[92:93]
    v_pk_mul_f32 v[212:213], v[212:213], s[92:93]
    v_pk_mul_f32 v[214:215], v[214:215], s[92:93]
    v_cvt_pk_bf16_f32 v208, v208, v209
    v_cvt_pk_bf16_f32 v209, v210, v211
    v_cvt_pk_bf16_f32 v210, v212, v213
    v_cvt_pk_bf16_f32 v211, v214, v215
    v_accvgpr_write_b32 a216, v208
    v_accvgpr_write_b32 a217, v209
    v_accvgpr_write_b32 a218, v210
    v_accvgpr_write_b32 a219, v211
    v_pk_mul_f32 v[216:217], v[216:217], s[92:93]
    v_pk_mul_f32 v[218:219], v[218:219], s[92:93]
    v_pk_mul_f32 v[220:221], v[220:221], s[92:93]
    v_pk_mul_f32 v[222:223], v[222:223], s[92:93]
    v_cvt_pk_bf16_f32 v216, v216, v217
    v_cvt_pk_bf16_f32 v217, v218, v219
    v_cvt_pk_bf16_f32 v218, v220, v221
    v_cvt_pk_bf16_f32 v219, v222, v223
    v_accvgpr_write_b32 a220, v216
    v_accvgpr_write_b32 a221, v217
    v_accvgpr_write_b32 a222, v218
    v_accvgpr_write_b32 a223, v219
    v_pk_mul_f32 v[224:225], v[224:225], s[92:93]
    v_pk_mul_f32 v[226:227], v[226:227], s[92:93]
    v_pk_mul_f32 v[228:229], v[228:229], s[92:93]
    v_pk_mul_f32 v[230:231], v[230:231], s[92:93]
    v_cvt_pk_bf16_f32 v224, v224, v225
    v_cvt_pk_bf16_f32 v225, v226, v227
    v_cvt_pk_bf16_f32 v226, v228, v229
    v_cvt_pk_bf16_f32 v227, v230, v231
    v_accvgpr_write_b32 a224, v224
    v_accvgpr_write_b32 a225, v225
    v_accvgpr_write_b32 a226, v226
    v_accvgpr_write_b32 a227, v227
    v_pk_mul_f32 v[232:233], v[232:233], s[92:93]
    v_pk_mul_f32 v[234:235], v[234:235], s[92:93]
    v_pk_mul_f32 v[236:237], v[236:237], s[92:93]
    v_pk_mul_f32 v[238:239], v[238:239], s[92:93]
    v_cvt_pk_bf16_f32 v232, v232, v233
    v_cvt_pk_bf16_f32 v233, v234, v235
    v_cvt_pk_bf16_f32 v234, v236, v237
    v_cvt_pk_bf16_f32 v235, v238, v239
    v_accvgpr_write_b32 a228, v232
    v_accvgpr_write_b32 a229, v233
    v_accvgpr_write_b32 a230, v234
    v_accvgpr_write_b32 a231, v235
    v_pk_mul_f32 v[240:241], v[240:241], s[92:93]
    v_pk_mul_f32 v[242:243], v[242:243], s[92:93]
    v_pk_mul_f32 v[244:245], v[244:245], s[92:93]
    v_pk_mul_f32 v[246:247], v[246:247], s[92:93]
    v_cvt_pk_bf16_f32 v240, v240, v241
    v_cvt_pk_bf16_f32 v241, v242, v243
    v_cvt_pk_bf16_f32 v242, v244, v245
    v_cvt_pk_bf16_f32 v243, v246, v247
    v_accvgpr_write_b32 a232, v240
    v_accvgpr_write_b32 a233, v241
    v_accvgpr_write_b32 a234, v242
    v_accvgpr_write_b32 a235, v243
    v_pk_mul_f32 v[248:249], v[248:249], s[92:93]
    v_pk_mul_f32 v[250:251], v[250:251], s[92:93]
    v_pk_mul_f32 v[252:253], v[252:253], s[92:93]
    v_pk_mul_f32 v[254:255], v[254:255], s[92:93]
    v_cvt_pk_bf16_f32 v248, v248, v249
    v_cvt_pk_bf16_f32 v249, v250, v251
    v_cvt_pk_bf16_f32 v250, v252, v253
    v_cvt_pk_bf16_f32 v251, v254, v255
    v_accvgpr_write_b32 a236, v248
    v_accvgpr_write_b32 a237, v249
    v_accvgpr_write_b32 a238, v250
    v_accvgpr_write_b32 a239, v251
    v_accvgpr_read_b32 v24, a96
    v_accvgpr_read_b32 v25, a97
    v_accvgpr_read_b32 v26, a98
    v_accvgpr_read_b32 v27, a99
    v_accvgpr_read_b32 v28, a100
    v_accvgpr_read_b32 v29, a101
    v_accvgpr_read_b32 v30, a102
    v_accvgpr_read_b32 v31, a103
    v_pk_mul_f32 v[24:25], v[24:25], s[92:93]
    v_pk_mul_f32 v[26:27], v[26:27], s[92:93]
    v_pk_mul_f32 v[28:29], v[28:29], s[92:93]
    v_pk_mul_f32 v[30:31], v[30:31], s[92:93]
    v_cvt_pk_bf16_f32 v24, v24, v25
    v_cvt_pk_bf16_f32 v25, v26, v27
    v_cvt_pk_bf16_f32 v26, v28, v29
    v_cvt_pk_bf16_f32 v27, v30, v31
    v_accvgpr_write_b32 a240, v24
    v_accvgpr_write_b32 a241, v25
    v_accvgpr_write_b32 a242, v26
    v_accvgpr_write_b32 a243, v27
    v_accvgpr_read_b32 v24, a104
    v_accvgpr_read_b32 v25, a105
    v_accvgpr_read_b32 v26, a106
    v_accvgpr_read_b32 v27, a107
    v_accvgpr_read_b32 v28, a108
    v_accvgpr_read_b32 v29, a109
    v_accvgpr_read_b32 v30, a110
    v_accvgpr_read_b32 v31, a111
    v_pk_mul_f32 v[24:25], v[24:25], s[92:93]
    v_pk_mul_f32 v[26:27], v[26:27], s[92:93]
    v_pk_mul_f32 v[28:29], v[28:29], s[92:93]
    v_pk_mul_f32 v[30:31], v[30:31], s[92:93]
    v_cvt_pk_bf16_f32 v24, v24, v25
    v_cvt_pk_bf16_f32 v25, v26, v27
    v_cvt_pk_bf16_f32 v26, v28, v29
    v_cvt_pk_bf16_f32 v27, v30, v31
    v_accvgpr_write_b32 a244, v24
    v_accvgpr_write_b32 a245, v25
    v_accvgpr_write_b32 a246, v26
    v_accvgpr_write_b32 a247, v27
    v_accvgpr_read_b32 v24, a112
    v_accvgpr_read_b32 v25, a113
    v_accvgpr_read_b32 v26, a114
    v_accvgpr_read_b32 v27, a115
    v_accvgpr_read_b32 v28, a116
    v_accvgpr_read_b32 v29, a117
    v_accvgpr_read_b32 v30, a118
    v_accvgpr_read_b32 v31, a119
    v_pk_mul_f32 v[24:25], v[24:25], s[92:93]
    v_pk_mul_f32 v[26:27], v[26:27], s[92:93]
    v_pk_mul_f32 v[28:29], v[28:29], s[92:93]
    v_pk_mul_f32 v[30:31], v[30:31], s[92:93]
    v_cvt_pk_bf16_f32 v24, v24, v25
    v_cvt_pk_bf16_f32 v25, v26, v27
    v_cvt_pk_bf16_f32 v26, v28, v29
    v_cvt_pk_bf16_f32 v27, v30, v31
    v_accvgpr_write_b32 a248, v24
    v_accvgpr_write_b32 a249, v25
    v_accvgpr_write_b32 a250, v26
    v_accvgpr_write_b32 a251, v27
    v_accvgpr_read_b32 v24, a120
    v_accvgpr_read_b32 v25, a121
    v_accvgpr_read_b32 v26, a122
    v_accvgpr_read_b32 v27, a123
    v_accvgpr_read_b32 v28, a124
    v_accvgpr_read_b32 v29, a125
    v_accvgpr_read_b32 v30, a126
    v_accvgpr_read_b32 v31, a127
    v_pk_mul_f32 v[24:25], v[24:25], s[92:93]
    v_pk_mul_f32 v[26:27], v[26:27], s[92:93]
    v_pk_mul_f32 v[28:29], v[28:29], s[92:93]
    v_pk_mul_f32 v[30:31], v[30:31], s[92:93]
    v_cvt_pk_bf16_f32 v24, v24, v25
    v_cvt_pk_bf16_f32 v25, v26, v27
    v_cvt_pk_bf16_f32 v26, v28, v29
    v_cvt_pk_bf16_f32 v27, v30, v31
    v_accvgpr_write_b32 a252, v24
    v_accvgpr_write_b32 a253, v25
    v_accvgpr_write_b32 a254, v26
    v_accvgpr_write_b32 a255, v27
    s_setpc_b64 s[20:21]
mega_kernel_ns359:
    v_cvt_pk_bf16_f32 v32, v32, v33
    v_cvt_pk_bf16_f32 v33, v34, v35
    v_cvt_pk_bf16_f32 v34, v36, v37
    v_cvt_pk_bf16_f32 v35, v38, v39
    v_accvgpr_write_b32 a128, v32
    v_accvgpr_write_b32 a129, v33
    v_accvgpr_write_b32 a130, v34
    v_accvgpr_write_b32 a131, v35
    v_cvt_pk_bf16_f32 v40, v40, v41
    v_cvt_pk_bf16_f32 v41, v42, v43
    v_cvt_pk_bf16_f32 v42, v44, v45
    v_cvt_pk_bf16_f32 v43, v46, v47
    v_accvgpr_write_b32 a132, v40
    v_accvgpr_write_b32 a133, v41
    v_accvgpr_write_b32 a134, v42
    v_accvgpr_write_b32 a135, v43
    v_cvt_pk_bf16_f32 v48, v48, v49
    v_cvt_pk_bf16_f32 v49, v50, v51
    v_cvt_pk_bf16_f32 v50, v52, v53
    v_cvt_pk_bf16_f32 v51, v54, v55
    v_accvgpr_write_b32 a136, v48
    v_accvgpr_write_b32 a137, v49
    v_accvgpr_write_b32 a138, v50
    v_accvgpr_write_b32 a139, v51
    v_cvt_pk_bf16_f32 v56, v56, v57
    v_cvt_pk_bf16_f32 v57, v58, v59
    v_cvt_pk_bf16_f32 v58, v60, v61
    v_cvt_pk_bf16_f32 v59, v62, v63
    v_accvgpr_write_b32 a140, v56
    v_accvgpr_write_b32 a141, v57
    v_accvgpr_write_b32 a142, v58
    v_accvgpr_write_b32 a143, v59
    v_cvt_pk_bf16_f32 v64, v64, v65
    v_cvt_pk_bf16_f32 v65, v66, v67
    v_cvt_pk_bf16_f32 v66, v68, v69
    v_cvt_pk_bf16_f32 v67, v70, v71
    v_accvgpr_write_b32 a144, v64
    v_accvgpr_write_b32 a145, v65
    v_accvgpr_write_b32 a146, v66
    v_accvgpr_write_b32 a147, v67
    v_cvt_pk_bf16_f32 v72, v72, v73
    v_cvt_pk_bf16_f32 v73, v74, v75
    v_cvt_pk_bf16_f32 v74, v76, v77
    v_cvt_pk_bf16_f32 v75, v78, v79
    v_accvgpr_write_b32 a148, v72
    v_accvgpr_write_b32 a149, v73
    v_accvgpr_write_b32 a150, v74
    v_accvgpr_write_b32 a151, v75
    v_cvt_pk_bf16_f32 v80, v80, v81
    v_cvt_pk_bf16_f32 v81, v82, v83
    v_cvt_pk_bf16_f32 v82, v84, v85
    v_cvt_pk_bf16_f32 v83, v86, v87
    v_accvgpr_write_b32 a152, v80
    v_accvgpr_write_b32 a153, v81
    v_accvgpr_write_b32 a154, v82
    v_accvgpr_write_b32 a155, v83
    v_cvt_pk_bf16_f32 v88, v88, v89
    v_cvt_pk_bf16_f32 v89, v90, v91
    v_cvt_pk_bf16_f32 v90, v92, v93
    v_cvt_pk_bf16_f32 v91, v94, v95
    v_accvgpr_write_b32 a156, v88
    v_accvgpr_write_b32 a157, v89
    v_accvgpr_write_b32 a158, v90
    v_accvgpr_write_b32 a159, v91
    v_cvt_pk_bf16_f32 v96, v96, v97
    v_cvt_pk_bf16_f32 v97, v98, v99
    v_cvt_pk_bf16_f32 v98, v100, v101
    v_cvt_pk_bf16_f32 v99, v102, v103
    v_accvgpr_write_b32 a160, v96
    v_accvgpr_write_b32 a161, v97
    v_accvgpr_write_b32 a162, v98
    v_accvgpr_write_b32 a163, v99
    v_cvt_pk_bf16_f32 v104, v104, v105
    v_cvt_pk_bf16_f32 v105, v106, v107
    v_cvt_pk_bf16_f32 v106, v108, v109
    v_cvt_pk_bf16_f32 v107, v110, v111
    v_accvgpr_write_b32 a164, v104
    v_accvgpr_write_b32 a165, v105
    v_accvgpr_write_b32 a166, v106
    v_accvgpr_write_b32 a167, v107
    v_cvt_pk_bf16_f32 v112, v112, v113
    v_cvt_pk_bf16_f32 v113, v114, v115
    v_cvt_pk_bf16_f32 v114, v116, v117
    v_cvt_pk_bf16_f32 v115, v118, v119
    v_accvgpr_write_b32 a168, v112
    v_accvgpr_write_b32 a169, v113
    v_accvgpr_write_b32 a170, v114
    v_accvgpr_write_b32 a171, v115
    v_cvt_pk_bf16_f32 v120, v120, v121
    v_cvt_pk_bf16_f32 v121, v122, v123
    v_cvt_pk_bf16_f32 v122, v124, v125
    v_cvt_pk_bf16_f32 v123, v126, v127
    v_accvgpr_write_b32 a172, v120
    v_accvgpr_write_b32 a173, v121
    v_accvgpr_write_b32 a174, v122
    v_accvgpr_write_b32 a175, v123
    v_cvt_pk_bf16_f32 v128, v128, v129
    v_cvt_pk_bf16_f32 v129, v130, v131
    v_cvt_pk_bf16_f32 v130, v132, v133
    v_cvt_pk_bf16_f32 v131, v134, v135
    v_accvgpr_write_b32 a176, v128
    v_accvgpr_write_b32 a177, v129
    v_accvgpr_write_b32 a178, v130
    v_accvgpr_write_b32 a179, v131
    v_cvt_pk_bf16_f32 v136, v136, v137
    v_cvt_pk_bf16_f32 v137, v138, v139
    v_cvt_pk_bf16_f32 v138, v140, v141
    v_cvt_pk_bf16_f32 v139, v142, v143
    v_accvgpr_write_b32 a180, v136
    v_accvgpr_write_b32 a181, v137
    v_accvgpr_write_b32 a182, v138
    v_accvgpr_write_b32 a183, v139
    v_cvt_pk_bf16_f32 v144, v144, v145
    v_cvt_pk_bf16_f32 v145, v146, v147
    v_cvt_pk_bf16_f32 v146, v148, v149
    v_cvt_pk_bf16_f32 v147, v150, v151
    v_accvgpr_write_b32 a184, v144
    v_accvgpr_write_b32 a185, v145
    v_accvgpr_write_b32 a186, v146
    v_accvgpr_write_b32 a187, v147
    v_cvt_pk_bf16_f32 v152, v152, v153
    v_cvt_pk_bf16_f32 v153, v154, v155
    v_cvt_pk_bf16_f32 v154, v156, v157
    v_cvt_pk_bf16_f32 v155, v158, v159
    v_accvgpr_write_b32 a188, v152
    v_accvgpr_write_b32 a189, v153
    v_accvgpr_write_b32 a190, v154
    v_accvgpr_write_b32 a191, v155
    v_cvt_pk_bf16_f32 v160, v160, v161
    v_cvt_pk_bf16_f32 v161, v162, v163
    v_cvt_pk_bf16_f32 v162, v164, v165
    v_cvt_pk_bf16_f32 v163, v166, v167
    v_accvgpr_write_b32 a192, v160
    v_accvgpr_write_b32 a193, v161
    v_accvgpr_write_b32 a194, v162
    v_accvgpr_write_b32 a195, v163
    v_cvt_pk_bf16_f32 v168, v168, v169
    v_cvt_pk_bf16_f32 v169, v170, v171
    v_cvt_pk_bf16_f32 v170, v172, v173
    v_cvt_pk_bf16_f32 v171, v174, v175
    v_accvgpr_write_b32 a196, v168
    v_accvgpr_write_b32 a197, v169
    v_accvgpr_write_b32 a198, v170
    v_accvgpr_write_b32 a199, v171
    v_cvt_pk_bf16_f32 v176, v176, v177
    v_cvt_pk_bf16_f32 v177, v178, v179
    v_cvt_pk_bf16_f32 v178, v180, v181
    v_cvt_pk_bf16_f32 v179, v182, v183
    v_accvgpr_write_b32 a200, v176
    v_accvgpr_write_b32 a201, v177
    v_accvgpr_write_b32 a202, v178
    v_accvgpr_write_b32 a203, v179
    v_cvt_pk_bf16_f32 v184, v184, v185
    v_cvt_pk_bf16_f32 v185, v186, v187
    v_cvt_pk_bf16_f32 v186, v188, v189
    v_cvt_pk_bf16_f32 v187, v190, v191
    v_accvgpr_write_b32 a204, v184
    v_accvgpr_write_b32 a205, v185
    v_accvgpr_write_b32 a206, v186
    v_accvgpr_write_b32 a207, v187
    v_cvt_pk_bf16_f32 v192, v192, v193
    v_cvt_pk_bf16_f32 v193, v194, v195
    v_cvt_pk_bf16_f32 v194, v196, v197
    v_cvt_pk_bf16_f32 v195, v198, v199
    v_accvgpr_write_b32 a208, v192
    v_accvgpr_write_b32 a209, v193
    v_accvgpr_write_b32 a210, v194
    v_accvgpr_write_b32 a211, v195
    v_cvt_pk_bf16_f32 v200, v200, v201
    v_cvt_pk_bf16_f32 v201, v202, v203
    v_cvt_pk_bf16_f32 v202, v204, v205
    v_cvt_pk_bf16_f32 v203, v206, v207
    v_accvgpr_write_b32 a212, v200
    v_accvgpr_write_b32 a213, v201
    v_accvgpr_write_b32 a214, v202
    v_accvgpr_write_b32 a215, v203
    v_cvt_pk_bf16_f32 v208, v208, v209
    v_cvt_pk_bf16_f32 v209, v210, v211
    v_cvt_pk_bf16_f32 v210, v212, v213
    v_cvt_pk_bf16_f32 v211, v214, v215
    v_accvgpr_write_b32 a216, v208
    v_accvgpr_write_b32 a217, v209
    v_accvgpr_write_b32 a218, v210
    v_accvgpr_write_b32 a219, v211
    v_cvt_pk_bf16_f32 v216, v216, v217
    v_cvt_pk_bf16_f32 v217, v218, v219
    v_cvt_pk_bf16_f32 v218, v220, v221
    v_cvt_pk_bf16_f32 v219, v222, v223
    v_accvgpr_write_b32 a220, v216
    v_accvgpr_write_b32 a221, v217
    v_accvgpr_write_b32 a222, v218
    v_accvgpr_write_b32 a223, v219
    v_cvt_pk_bf16_f32 v224, v224, v225
    v_cvt_pk_bf16_f32 v225, v226, v227
    v_cvt_pk_bf16_f32 v226, v228, v229
    v_cvt_pk_bf16_f32 v227, v230, v231
    v_accvgpr_write_b32 a224, v224
    v_accvgpr_write_b32 a225, v225
    v_accvgpr_write_b32 a226, v226
    v_accvgpr_write_b32 a227, v227
    v_cvt_pk_bf16_f32 v232, v232, v233
    v_cvt_pk_bf16_f32 v233, v234, v235
    v_cvt_pk_bf16_f32 v234, v236, v237
    v_cvt_pk_bf16_f32 v235, v238, v239
    v_accvgpr_write_b32 a228, v232
    v_accvgpr_write_b32 a229, v233
    v_accvgpr_write_b32 a230, v234
    v_accvgpr_write_b32 a231, v235
    v_cvt_pk_bf16_f32 v240, v240, v241
    v_cvt_pk_bf16_f32 v241, v242, v243
    v_cvt_pk_bf16_f32 v242, v244, v245
    v_cvt_pk_bf16_f32 v243, v246, v247
    v_accvgpr_write_b32 a232, v240
    v_accvgpr_write_b32 a233, v241
    v_accvgpr_write_b32 a234, v242
    v_accvgpr_write_b32 a235, v243
    v_cvt_pk_bf16_f32 v248, v248, v249
    v_cvt_pk_bf16_f32 v249, v250, v251
    v_cvt_pk_bf16_f32 v250, v252, v253
    v_cvt_pk_bf16_f32 v251, v254, v255
    v_accvgpr_write_b32 a236, v248
    v_accvgpr_write_b32 a237, v249
    v_accvgpr_write_b32 a238, v250
    v_accvgpr_write_b32 a239, v251
    v_accvgpr_read_b32 v24, a96
    v_accvgpr_read_b32 v25, a97
    v_accvgpr_read_b32 v26, a98
    v_accvgpr_read_b32 v27, a99
    v_accvgpr_read_b32 v28, a100
    v_accvgpr_read_b32 v29, a101
    v_accvgpr_read_b32 v30, a102
    v_accvgpr_read_b32 v31, a103
    v_cvt_pk_bf16_f32 v24, v24, v25
    v_cvt_pk_bf16_f32 v25, v26, v27
    v_cvt_pk_bf16_f32 v26, v28, v29
    v_cvt_pk_bf16_f32 v27, v30, v31
    v_accvgpr_write_b32 a240, v24
    v_accvgpr_write_b32 a241, v25
    v_accvgpr_write_b32 a242, v26
    v_accvgpr_write_b32 a243, v27
    v_accvgpr_read_b32 v24, a104
    v_accvgpr_read_b32 v25, a105
    v_accvgpr_read_b32 v26, a106
    v_accvgpr_read_b32 v27, a107
    v_accvgpr_read_b32 v28, a108
    v_accvgpr_read_b32 v29, a109
    v_accvgpr_read_b32 v30, a110
    v_accvgpr_read_b32 v31, a111
    v_cvt_pk_bf16_f32 v24, v24, v25
    v_cvt_pk_bf16_f32 v25, v26, v27
    v_cvt_pk_bf16_f32 v26, v28, v29
    v_cvt_pk_bf16_f32 v27, v30, v31
    v_accvgpr_write_b32 a244, v24
    v_accvgpr_write_b32 a245, v25
    v_accvgpr_write_b32 a246, v26
    v_accvgpr_write_b32 a247, v27
    v_accvgpr_read_b32 v24, a112
    v_accvgpr_read_b32 v25, a113
    v_accvgpr_read_b32 v26, a114
    v_accvgpr_read_b32 v27, a115
    v_accvgpr_read_b32 v28, a116
    v_accvgpr_read_b32 v29, a117
    v_accvgpr_read_b32 v30, a118
    v_accvgpr_read_b32 v31, a119
    v_cvt_pk_bf16_f32 v24, v24, v25
    v_cvt_pk_bf16_f32 v25, v26, v27
    v_cvt_pk_bf16_f32 v26, v28, v29
    v_cvt_pk_bf16_f32 v27, v30, v31
    v_accvgpr_write_b32 a248, v24
    v_accvgpr_write_b32 a249, v25
    v_accvgpr_write_b32 a250, v26
    v_accvgpr_write_b32 a251, v27
    v_accvgpr_read_b32 v24, a120
    v_accvgpr_read_b32 v25, a121
    v_accvgpr_read_b32 v26, a122
    v_accvgpr_read_b32 v27, a123
    v_accvgpr_read_b32 v28, a124
    v_accvgpr_read_b32 v29, a125
    v_accvgpr_read_b32 v30, a126
    v_accvgpr_read_b32 v31, a127
    v_cvt_pk_bf16_f32 v24, v24, v25
    v_cvt_pk_bf16_f32 v25, v26, v27
    v_cvt_pk_bf16_f32 v26, v28, v29
    v_cvt_pk_bf16_f32 v27, v30, v31
    v_accvgpr_write_b32 a252, v24
    v_accvgpr_write_b32 a253, v25
    v_accvgpr_write_b32 a254, v26
    v_accvgpr_write_b32 a255, v27
    s_setpc_b64 s[20:21]
mega_kernel_epf21:
    s_nop 7
    s_cmp_eq_u32 s97, 0
    s_cbranch_scc1 mega_kernel_noscale60
    s_mov_b32 s91, s98
    s_mov_b32 s92, s97
    s_mov_b32 s93, s97
    s_mov_b32 s90, s91
    v_pk_mul_f32 v[32:33], v[32:33], s[92:93]
    v_pk_mul_f32 v[34:35], v[34:35], s[92:93]
    v_pk_mul_f32 v[36:37], v[36:37], s[92:93]
    v_pk_mul_f32 v[38:39], v[38:39], s[92:93]
    v_cvt_pk_bf16_f32 v32, v32, v33
    v_cvt_pk_bf16_f32 v33, v34, v35
    v_cvt_pk_bf16_f32 v34, v36, v37
    v_cvt_pk_bf16_f32 v35, v38, v39
    buffer_store_dwordx4 v[32:35], v2, s[8:11], s90 offen sc1
    s_add_u32 s90, s90, s100
    v_pk_mul_f32 v[40:41], v[40:41], s[92:93]
    v_pk_mul_f32 v[42:43], v[42:43], s[92:93]
    v_pk_mul_f32 v[44:45], v[44:45], s[92:93]
    v_pk_mul_f32 v[46:47], v[46:47], s[92:93]
    v_cvt_pk_bf16_f32 v40, v40, v41
    v_cvt_pk_bf16_f32 v41, v42, v43
    v_cvt_pk_bf16_f32 v42, v44, v45
    v_cvt_pk_bf16_f32 v43, v46, v47
    buffer_store_dwordx4 v[40:43], v2, s[8:11], s90 offen sc1
    s_add_u32 s90, s90, s100
    v_pk_mul_f32 v[48:49], v[48:49], s[92:93]
    v_pk_mul_f32 v[50:51], v[50:51], s[92:93]
    v_pk_mul_f32 v[52:53], v[52:53], s[92:93]
    v_pk_mul_f32 v[54:55], v[54:55], s[92:93]
    v_cvt_pk_bf16_f32 v48, v48, v49
    v_cvt_pk_bf16_f32 v49, v50, v51
    v_cvt_pk_bf16_f32 v50, v52, v53
    v_cvt_pk_bf16_f32 v51, v54, v55
    buffer_store_dwordx4 v[48:51], v2, s[8:11], s90 offen sc1
    s_add_u32 s90, s90, s100
    v_pk_mul_f32 v[56:57], v[56:57], s[92:93]
    v_pk_mul_f32 v[58:59], v[58:59], s[92:93]
    v_pk_mul_f32 v[60:61], v[60:61], s[92:93]
    v_pk_mul_f32 v[62:63], v[62:63], s[92:93]
    v_cvt_pk_bf16_f32 v56, v56, v57
    v_cvt_pk_bf16_f32 v57, v58, v59
    v_cvt_pk_bf16_f32 v58, v60, v61
    v_cvt_pk_bf16_f32 v59, v62, v63
    buffer_store_dwordx4 v[56:59], v2, s[8:11], s90 offen sc1
    s_add_u32 s90, s90, s100
    v_pk_mul_f32 v[64:65], v[64:65], s[92:93]
    v_pk_mul_f32 v[66:67], v[66:67], s[92:93]
    v_pk_mul_f32 v[68:69], v[68:69], s[92:93]
    v_pk_mul_f32 v[70:71], v[70:71], s[92:93]
    v_cvt_pk_bf16_f32 v64, v64, v65
    v_cvt_pk_bf16_f32 v65, v66, v67
    v_cvt_pk_bf16_f32 v66, v68, v69
    v_cvt_pk_bf16_f32 v67, v70, v71
    buffer_store_dwordx4 v[64:67], v2, s[8:11], s90 offen sc1
    s_add_u32 s90, s90, s100
    v_pk_mul_f32 v[72:73], v[72:73], s[92:93]
    v_pk_mul_f32 v[74:75], v[74:75], s[92:93]
    v_pk_mul_f32 v[76:77], v[76:77], s[92:93]
    v_pk_mul_f32 v[78:79], v[78:79], s[92:93]
    v_cvt_pk_bf16_f32 v72, v72, v73
    v_cvt_pk_bf16_f32 v73, v74, v75
    v_cvt_pk_bf16_f32 v74, v76, v77
    v_cvt_pk_bf16_f32 v75, v78, v79
    buffer_store_dwordx4 v[72:75], v2, s[8:11], s90 offen sc1
    s_add_u32 s90, s90, s100
    v_pk_mul_f32 v[80:81], v[80:81], s[92:93]
    v_pk_mul_f32 v[82:83], v[82:83], s[92:93]
    v_pk_mul_f32 v[84:85], v[84:85], s[92:93]
    v_pk_mul_f32 v[86:87], v[86:87], s[92:93]
    v_cvt_pk_bf16_f32 v80, v80, v81
    v_cvt_pk_bf16_f32 v81, v82, v83
    v_cvt_pk_bf16_f32 v82, v84, v85
    v_cvt_pk_bf16_f32 v83, v86, v87
    buffer_store_dwordx4 v[80:83], v2, s[8:11], s90 offen sc1
    s_add_u32 s90, s90, s100
    v_pk_mul_f32 v[88:89], v[88:89], s[92:93]
    v_pk_mul_f32 v[90:91], v[90:91], s[92:93]
    v_pk_mul_f32 v[92:93], v[92:93], s[92:93]
    v_pk_mul_f32 v[94:95], v[94:95], s[92:93]
    v_cvt_pk_bf16_f32 v88, v88, v89
    v_cvt_pk_bf16_f32 v89, v90, v91
    v_cvt_pk_bf16_f32 v90, v92, v93
    v_cvt_pk_bf16_f32 v91, v94, v95
    buffer_store_dwordx4 v[88:91], v2, s[8:11], s90 offen sc1
    s_add_u32 s90, s90, s100
    s_add_u32 s91, s91, s99
    s_mov_b32 s90, s91
    v_pk_mul_f32 v[96:97], v[96:97], s[92:93]
    v_pk_mul_f32 v[98:99], v[98:99], s[92:93]
    v_pk_mul_f32 v[100:101], v[100:101], s[92:93]
    v_pk_mul_f32 v[102:103], v[102:103], s[92:93]
    v_cvt_pk_bf16_f32 v96, v96, v97
    v_cvt_pk_bf16_f32 v97, v98, v99
    v_cvt_pk_bf16_f32 v98, v100, v101
    v_cvt_pk_bf16_f32 v99, v102, v103
    buffer_store_dwordx4 v[96:99], v2, s[8:11], s90 offen sc1
    s_add_u32 s90, s90, s100
    v_pk_mul_f32 v[104:105], v[104:105], s[92:93]
    v_pk_mul_f32 v[106:107], v[106:107], s[92:93]
    v_pk_mul_f32 v[108:109], v[108:109], s[92:93]
    v_pk_mul_f32 v[110:111], v[110:111], s[92:93]
    v_cvt_pk_bf16_f32 v104, v104, v105
    v_cvt_pk_bf16_f32 v105, v106, v107
    v_cvt_pk_bf16_f32 v106, v108, v109
    v_cvt_pk_bf16_f32 v107, v110, v111
    buffer_store_dwordx4 v[104:107], v2, s[8:11], s90 offen sc1
    s_add_u32 s90, s90, s100
    v_pk_mul_f32 v[112:113], v[112:113], s[92:93]
    v_pk_mul_f32 v[114:115], v[114:115], s[92:93]
    v_pk_mul_f32 v[116:117], v[116:117], s[92:93]
    v_pk_mul_f32 v[118:119], v[118:119], s[92:93]
    v_cvt_pk_bf16_f32 v112, v112, v113
    v_cvt_pk_bf16_f32 v113, v114, v115
    v_cvt_pk_bf16_f32 v114, v116, v117
    v_cvt_pk_bf16_f32 v115, v118, v119
    buffer_store_dwordx4 v[112:115], v2, s[8:11], s90 offen sc1
    s_add_u32 s90, s90, s100
    v_pk_mul_f32 v[120:121], v[120:121], s[92:93]
    v_pk_mul_f32 v[122:123], v[122:123], s[92:93]
    v_pk_mul_f32 v[124:125], v[124:125], s[92:93]
    v_pk_mul_f32 v[126:127], v[126:127], s[92:93]
    v_cvt_pk_bf16_f32 v120, v120, v121
    v_cvt_pk_bf16_f32 v121, v122, v123
    v_cvt_pk_bf16_f32 v122, v124, v125
    v_cvt_pk_bf16_f32 v123, v126, v127
    buffer_store_dwordx4 v[120:123], v2, s[8:11], s90 offen sc1
    s_add_u32 s90, s90, s100
    v_pk_mul_f32 v[128:129], v[128:129], s[92:93]
    v_pk_mul_f32 v[130:131], v[130:131], s[92:93]
    v_pk_mul_f32 v[132:133], v[132:133], s[92:93]
    v_pk_mul_f32 v[134:135], v[134:135], s[92:93]
    v_cvt_pk_bf16_f32 v128, v128, v129
    v_cvt_pk_bf16_f32 v129, v130, v131
    v_cvt_pk_bf16_f32 v130, v132, v133
    v_cvt_pk_bf16_f32 v131, v134, v135
    buffer_store_dwordx4 v[128:131], v2, s[8:11], s90 offen sc1
    s_add_u32 s90, s90, s100
    v_pk_mul_f32 v[136:137], v[136:137], s[92:93]
    v_pk_mul_f32 v[138:139], v[138:139], s[92:93]
    v_pk_mul_f32 v[140:141], v[140:141], s[92:93]
    v_pk_mul_f32 v[142:143], v[142:143], s[92:93]
    v_cvt_pk_bf16_f32 v136, v136, v137
    v_cvt_pk_bf16_f32 v137, v138, v139
    v_cvt_pk_bf16_f32 v138, v140, v141
    v_cvt_pk_bf16_f32 v139, v142, v143
    buffer_store_dwordx4 v[136:139], v2, s[8:11], s90 offen sc1
    s_add_u32 s90, s90, s100
    v_pk_mul_f32 v[144:145], v[144:145], s[92:93]
    v_pk_mul_f32 v[146:147], v[146:147], s[92:93]
    v_pk_mul_f32 v[148:149], v[148:149], s[92:93]
    v_pk_mul_f32 v[150:151], v[150:151], s[92:93]
    v_cvt_pk_bf16_f32 v144, v144, v145
    v_cvt_pk_bf16_f32 v145, v146, v147
    v_cvt_pk_bf16_f32 v146, v148, v149
    v_cvt_pk_bf16_f32 v147, v150, v151
    buffer_store_dwordx4 v[144:147], v2, s[8:11], s90 offen sc1
    s_add_u32 s90, s90, s100
    v_pk_mul_f32 v[152:153], v[152:153], s[92:93]
    v_pk_mul_f32 v[154:155], v[154:155], s[92:93]
    v_pk_mul_f32 v[156:157], v[156:157], s[92:93]
    v_pk_mul_f32 v[158:159], v[158:159], s[92:93]
    v_cvt_pk_bf16_f32 v152, v152, v153
    v_cvt_pk_bf16_f32 v153, v154, v155
    v_cvt_pk_bf16_f32 v154, v156, v157
    v_cvt_pk_bf16_f32 v155, v158, v159
    buffer_store_dwordx4 v[152:155], v2, s[8:11], s90 offen sc1
    s_add_u32 s90, s90, s100
    s_add_u32 s91, s91, s99
    s_mov_b32 s90, s91
    v_pk_mul_f32 v[160:161], v[160:161], s[92:93]
    v_pk_mul_f32 v[162:163], v[162:163], s[92:93]
    v_pk_mul_f32 v[164:165], v[164:165], s[92:93]
    v_pk_mul_f32 v[166:167], v[166:167], s[92:93]
    v_cvt_pk_bf16_f32 v160, v160, v161
    v_cvt_pk_bf16_f32 v161, v162, v163
    v_cvt_pk_bf16_f32 v162, v164, v165
    v_cvt_pk_bf16_f32 v163, v166, v167
    buffer_store_dwordx4 v[160:163], v2, s[8:11], s90 offen sc1
    s_add_u32 s90, s90, s100
    v_pk_mul_f32 v[168:169], v[168:169], s[92:93]
    v_pk_mul_f32 v[170:171], v[170:171], s[92:93]
    v_pk_mul_f32 v[172:173], v[172:173], s[92:93]
    v_pk_mul_f32 v[174:175], v[174:175], s[92:93]
    v_cvt_pk_bf16_f32 v168, v168, v169
    v_cvt_pk_bf16_f32 v169, v170, v171
    v_cvt_pk_bf16_f32 v170, v172, v173
    v_cvt_pk_bf16_f32 v171, v174, v175
    buffer_store_dwordx4 v[168:171], v2, s[8:11], s90 offen sc1
    s_add_u32 s90, s90, s100
    v_pk_mul_f32 v[176:177], v[176:177], s[92:93]
    v_pk_mul_f32 v[178:179], v[178:179], s[92:93]
    v_pk_mul_f32 v[180:181], v[180:181], s[92:93]
    v_pk_mul_f32 v[182:183], v[182:183], s[92:93]
    v_cvt_pk_bf16_f32 v176, v176, v177
    v_cvt_pk_bf16_f32 v177, v178, v179
    v_cvt_pk_bf16_f32 v178, v180, v181
    v_cvt_pk_bf16_f32 v179, v182, v183
    buffer_store_dwordx4 v[176:179], v2, s[8:11], s90 offen sc1
    s_add_u32 s90, s90, s100
    v_pk_mul_f32 v[184:185], v[184:185], s[92:93]
    v_pk_mul_f32 v[186:187], v[186:187], s[92:93]
    v_pk_mul_f32 v[188:189], v[188:189], s[92:93]
    v_pk_mul_f32 v[190:191], v[190:191], s[92:93]
    v_cvt_pk_bf16_f32 v184, v184, v185
    v_cvt_pk_bf16_f32 v185, v186, v187
    v_cvt_pk_bf16_f32 v186, v188, v189
    v_cvt_pk_bf16_f32 v187, v190, v191
    buffer_store_dwordx4 v[184:187], v2, s[8:11], s90 offen sc1
    s_add_u32 s90, s90, s100
    v_pk_mul_f32 v[192:193], v[192:193], s[92:93]
    v_pk_mul_f32 v[194:195], v[194:195], s[92:93]
    v_pk_mul_f32 v[196:197], v[196:197], s[92:93]
    v_pk_mul_f32 v[198:199], v[198:199], s[92:93]
    v_cvt_pk_bf16_f32 v192, v192, v193
    v_cvt_pk_bf16_f32 v193, v194, v195
    v_cvt_pk_bf16_f32 v194, v196, v197
    v_cvt_pk_bf16_f32 v195, v198, v199
    buffer_store_dwordx4 v[192:195], v2, s[8:11], s90 offen sc1
    s_add_u32 s90, s90, s100
    v_pk_mul_f32 v[200:201], v[200:201], s[92:93]
    v_pk_mul_f32 v[202:203], v[202:203], s[92:93]
    v_pk_mul_f32 v[204:205], v[204:205], s[92:93]
    v_pk_mul_f32 v[206:207], v[206:207], s[92:93]
    v_cvt_pk_bf16_f32 v200, v200, v201
    v_cvt_pk_bf16_f32 v201, v202, v203
    v_cvt_pk_bf16_f32 v202, v204, v205
    v_cvt_pk_bf16_f32 v203, v206, v207
    buffer_store_dwordx4 v[200:203], v2, s[8:11], s90 offen sc1
    s_add_u32 s90, s90, s100
    v_pk_mul_f32 v[208:209], v[208:209], s[92:93]
    v_pk_mul_f32 v[210:211], v[210:211], s[92:93]
    v_pk_mul_f32 v[212:213], v[212:213], s[92:93]
    v_pk_mul_f32 v[214:215], v[214:215], s[92:93]
    v_cvt_pk_bf16_f32 v208, v208, v209
    v_cvt_pk_bf16_f32 v209, v210, v211
    v_cvt_pk_bf16_f32 v210, v212, v213
    v_cvt_pk_bf16_f32 v211, v214, v215
    buffer_store_dwordx4 v[208:211], v2, s[8:11], s90 offen sc1
    s_add_u32 s90, s90, s100
    v_pk_mul_f32 v[216:217], v[216:217], s[92:93]
    v_pk_mul_f32 v[218:219], v[218:219], s[92:93]
    v_pk_mul_f32 v[220:221], v[220:221], s[92:93]
    v_pk_mul_f32 v[222:223], v[222:223], s[92:93]
    v_cvt_pk_bf16_f32 v216, v216, v217
    v_cvt_pk_bf16_f32 v217, v218, v219
    v_cvt_pk_bf16_f32 v218, v220, v221
    v_cvt_pk_bf16_f32 v219, v222, v223
    buffer_store_dwordx4 v[216:219], v2, s[8:11], s90 offen sc1
    s_add_u32 s90, s90, s100
    s_add_u32 s91, s91, s99
    s_mov_b32 s90, s91
    v_pk_mul_f32 v[224:225], v[224:225], s[92:93]
    v_pk_mul_f32 v[226:227], v[226:227], s[92:93]
    v_pk_mul_f32 v[228:229], v[228:229], s[92:93]
    v_pk_mul_f32 v[230:231], v[230:231], s[92:93]
    v_cvt_pk_bf16_f32 v224, v224, v225
    v_cvt_pk_bf16_f32 v225, v226, v227
    v_cvt_pk_bf16_f32 v226, v228, v229
    v_cvt_pk_bf16_f32 v227, v230, v231
    buffer_store_dwordx4 v[224:227], v2, s[8:11], s90 offen sc1
    s_add_u32 s90, s90, s100
    v_pk_mul_f32 v[232:233], v[232:233], s[92:93]
    v_pk_mul_f32 v[234:235], v[234:235], s[92:93]
    v_pk_mul_f32 v[236:237], v[236:237], s[92:93]
    v_pk_mul_f32 v[238:239], v[238:239], s[92:93]
    v_cvt_pk_bf16_f32 v232, v232, v233
    v_cvt_pk_bf16_f32 v233, v234, v235
    v_cvt_pk_bf16_f32 v234, v236, v237
    v_cvt_pk_bf16_f32 v235, v238, v239
    buffer_store_dwordx4 v[232:235], v2, s[8:11], s90 offen sc1
    s_add_u32 s90, s90, s100
    v_pk_mul_f32 v[240:241], v[240:241], s[92:93]
    v_pk_mul_f32 v[242:243], v[242:243], s[92:93]
    v_pk_mul_f32 v[244:245], v[244:245], s[92:93]
    v_pk_mul_f32 v[246:247], v[246:247], s[92:93]
    v_cvt_pk_bf16_f32 v240, v240, v241
    v_cvt_pk_bf16_f32 v241, v242, v243
    v_cvt_pk_bf16_f32 v242, v244, v245
    v_cvt_pk_bf16_f32 v243, v246, v247
    buffer_store_dwordx4 v[240:243], v2, s[8:11], s90 offen sc1
    s_add_u32 s90, s90, s100
    v_pk_mul_f32 v[248:249], v[248:249], s[92:93]
    v_pk_mul_f32 v[250:251], v[250:251], s[92:93]
    v_pk_mul_f32 v[252:253], v[252:253], s[92:93]
    v_pk_mul_f32 v[254:255], v[254:255], s[92:93]
    v_cvt_pk_bf16_f32 v248, v248, v249
    v_cvt_pk_bf16_f32 v249, v250, v251
    v_cvt_pk_bf16_f32 v250, v252, v253
    v_cvt_pk_bf16_f32 v251, v254, v255
    buffer_store_dwordx4 v[248:251], v2, s[8:11], s90 offen sc1
    s_add_u32 s90, s90, s100
    v_accvgpr_read_b32 v24, a96
    v_accvgpr_read_b32 v25, a97
    v_accvgpr_read_b32 v26, a98
    v_accvgpr_read_b32 v27, a99
    v_accvgpr_read_b32 v28, a100
    v_accvgpr_read_b32 v29, a101
    v_accvgpr_read_b32 v30, a102
    v_accvgpr_read_b32 v31, a103
    v_pk_mul_f32 v[24:25], v[24:25], s[92:93]
    v_pk_mul_f32 v[26:27], v[26:27], s[92:93]
    v_pk_mul_f32 v[28:29], v[28:29], s[92:93]
    v_pk_mul_f32 v[30:31], v[30:31], s[92:93]
    v_cvt_pk_bf16_f32 v24, v24, v25
    v_cvt_pk_bf16_f32 v25, v26, v27
    v_cvt_pk_bf16_f32 v26, v28, v29
    v_cvt_pk_bf16_f32 v27, v30, v31
    buffer_store_dwordx4 v[24:27], v2, s[8:11], s90 offen sc1
    s_add_u32 s90, s90, s100
    s_nop 1
    v_accvgpr_read_b32 v24, a104
    v_accvgpr_read_b32 v25, a105
    v_accvgpr_read_b32 v26, a106
    v_accvgpr_read_b32 v27, a107
    v_accvgpr_read_b32 v28, a108
    v_accvgpr_read_b32 v29, a109
    v_accvgpr_read_b32 v30, a110
    v_accvgpr_read_b32 v31, a111
    v_pk_mul_f32 v[24:25], v[24:25], s[92:93]
    v_pk_mul_f32 v[26:27], v[26:27], s[92:93]
    v_pk_mul_f32 v[28:29], v[28:29], s[92:93]
    v_pk_mul_f32 v[30:31], v[30:31], s[92:93]
    v_cvt_pk_bf16_f32 v24, v24, v25
    v_cvt_pk_bf16_f32 v25, v26, v27
    v_cvt_pk_bf16_f32 v26, v28, v29
    v_cvt_pk_bf16_f32 v27, v30, v31
    buffer_store_dwordx4 v[24:27], v2, s[8:11], s90 offen sc1
    s_add_u32 s90, s90, s100
    s_nop 1
    v_accvgpr_read_b32 v24, a112
    v_accvgpr_read_b32 v25, a113
    v_accvgpr_read_b32 v26, a114
    v_accvgpr_read_b32 v27, a115
    v_accvgpr_read_b32 v28, a116
    v_accvgpr_read_b32 v29, a117
    v_accvgpr_read_b32 v30, a118
    v_accvgpr_read_b32 v31, a119
    v_pk_mul_f32 v[24:25], v[24:25], s[92:93]
    v_pk_mul_f32 v[26:27], v[26:27], s[92:93]
    v_pk_mul_f32 v[28:29], v[28:29], s[92:93]
    v_pk_mul_f32 v[30:31], v[30:31], s[92:93]
    v_cvt_pk_bf16_f32 v24, v24, v25
    v_cvt_pk_bf16_f32 v25, v26, v27
    v_cvt_pk_bf16_f32 v26, v28, v29
    v_cvt_pk_bf16_f32 v27, v30, v31
    buffer_store_dwordx4 v[24:27], v2, s[8:11], s90 offen sc1
    s_add_u32 s90, s90, s100
    s_nop 1
    v_accvgpr_read_b32 v24, a120
    v_accvgpr_read_b32 v25, a121
    v_accvgpr_read_b32 v26, a122
    v_accvgpr_read_b32 v27, a123
    v_accvgpr_read_b32 v28, a124
    v_accvgpr_read_b32 v29, a125
    v_accvgpr_read_b32 v30, a126
    v_accvgpr_read_b32 v31, a127
    v_pk_mul_f32 v[24:25], v[24:25], s[92:93]
    v_pk_mul_f32 v[26:27], v[26:27], s[92:93]
    v_pk_mul_f32 v[28:29], v[28:29], s[92:93]
    v_pk_mul_f32 v[30:31], v[30:31], s[92:93]
    v_cvt_pk_bf16_f32 v24, v24, v25
    v_cvt_pk_bf16_f32 v25, v26, v27
    v_cvt_pk_bf16_f32 v26, v28, v29
    v_cvt_pk_bf16_f32 v27, v30, v31
    buffer_store_dwordx4 v[24:27], v2, s[8:11], s90 offen sc1
    s_add_u32 s90, s90, s100
    s_nop 1
    s_add_u32 s91, s91, s99
    s_setpc_b64 s[20:21]
mega_kernel_noscale60:
    s_mov_b32 s91, s98
    s_mov_b32 s92, s97
    s_mov_b32 s93, s97
    s_mov_b32 s90, s91
    v_cvt_pk_bf16_f32 v32, v32, v33
    v_cvt_pk_bf16_f32 v33, v34, v35
    v_cvt_pk_bf16_f32 v34, v36, v37
    v_cvt_pk_bf16_f32 v35, v38, v39
    buffer_store_dwordx4 v[32:35], v2, s[8:11], s90 offen sc1
    s_add_u32 s90, s90, s100
    v_cvt_pk_bf16_f32 v40, v40, v41
    v_cvt_pk_bf16_f32 v41, v42, v43
    v_cvt_pk_bf16_f32 v42, v44, v45
    v_cvt_pk_bf16_f32 v43, v46, v47
    buffer_store_dwordx4 v[40:43], v2, s[8:11], s90 offen sc1
    s_add_u32 s90, s90, s100
    v_cvt_pk_bf16_f32 v48, v48, v49
    v_cvt_pk_bf16_f32 v49, v50, v51
    v_cvt_pk_bf16_f32 v50, v52, v53
    v_cvt_pk_bf16_f32 v51, v54, v55
    buffer_store_dwordx4 v[48:51], v2, s[8:11], s90 offen sc1
    s_add_u32 s90, s90, s100
    v_cvt_pk_bf16_f32 v56, v56, v57
    v_cvt_pk_bf16_f32 v57, v58, v59
    v_cvt_pk_bf16_f32 v58, v60, v61
    v_cvt_pk_bf16_f32 v59, v62, v63
    buffer_store_dwordx4 v[56:59], v2, s[8:11], s90 offen sc1
    s_add_u32 s90, s90, s100
    v_cvt_pk_bf16_f32 v64, v64, v65
    v_cvt_pk_bf16_f32 v65, v66, v67
    v_cvt_pk_bf16_f32 v66, v68, v69
    v_cvt_pk_bf16_f32 v67, v70, v71
    buffer_store_dwordx4 v[64:67], v2, s[8:11], s90 offen sc1
    s_add_u32 s90, s90, s100
    v_cvt_pk_bf16_f32 v72, v72, v73
    v_cvt_pk_bf16_f32 v73, v74, v75
    v_cvt_pk_bf16_f32 v74, v76, v77
    v_cvt_pk_bf16_f32 v75, v78, v79
    buffer_store_dwordx4 v[72:75], v2, s[8:11], s90 offen sc1
    s_add_u32 s90, s90, s100
    v_cvt_pk_bf16_f32 v80, v80, v81
    v_cvt_pk_bf16_f32 v81, v82, v83
    v_cvt_pk_bf16_f32 v82, v84, v85
    v_cvt_pk_bf16_f32 v83, v86, v87
    buffer_store_dwordx4 v[80:83], v2, s[8:11], s90 offen sc1
    s_add_u32 s90, s90, s100
    v_cvt_pk_bf16_f32 v88, v88, v89
    v_cvt_pk_bf16_f32 v89, v90, v91
    v_cvt_pk_bf16_f32 v90, v92, v93
    v_cvt_pk_bf16_f32 v91, v94, v95
    buffer_store_dwordx4 v[88:91], v2, s[8:11], s90 offen sc1
    s_add_u32 s90, s90, s100
    s_add_u32 s91, s91, s99
    s_mov_b32 s90, s91
    v_cvt_pk_bf16_f32 v96, v96, v97
    v_cvt_pk_bf16_f32 v97, v98, v99
    v_cvt_pk_bf16_f32 v98, v100, v101
    v_cvt_pk_bf16_f32 v99, v102, v103
    buffer_store_dwordx4 v[96:99], v2, s[8:11], s90 offen sc1
    s_add_u32 s90, s90, s100
    v_cvt_pk_bf16_f32 v104, v104, v105
    v_cvt_pk_bf16_f32 v105, v106, v107
    v_cvt_pk_bf16_f32 v106, v108, v109
    v_cvt_pk_bf16_f32 v107, v110, v111
    buffer_store_dwordx4 v[104:107], v2, s[8:11], s90 offen sc1
    s_add_u32 s90, s90, s100
    v_cvt_pk_bf16_f32 v112, v112, v113
    v_cvt_pk_bf16_f32 v113, v114, v115
    v_cvt_pk_bf16_f32 v114, v116, v117
    v_cvt_pk_bf16_f32 v115, v118, v119
    buffer_store_dwordx4 v[112:115], v2, s[8:11], s90 offen sc1
    s_add_u32 s90, s90, s100
    v_cvt_pk_bf16_f32 v120, v120, v121
    v_cvt_pk_bf16_f32 v121, v122, v123
    v_cvt_pk_bf16_f32 v122, v124, v125
    v_cvt_pk_bf16_f32 v123, v126, v127
    buffer_store_dwordx4 v[120:123], v2, s[8:11], s90 offen sc1
    s_add_u32 s90, s90, s100
    v_cvt_pk_bf16_f32 v128, v128, v129
    v_cvt_pk_bf16_f32 v129, v130, v131
    v_cvt_pk_bf16_f32 v130, v132, v133
    v_cvt_pk_bf16_f32 v131, v134, v135
    buffer_store_dwordx4 v[128:131], v2, s[8:11], s90 offen sc1
    s_add_u32 s90, s90, s100
    v_cvt_pk_bf16_f32 v136, v136, v137
    v_cvt_pk_bf16_f32 v137, v138, v139
    v_cvt_pk_bf16_f32 v138, v140, v141
    v_cvt_pk_bf16_f32 v139, v142, v143
    buffer_store_dwordx4 v[136:139], v2, s[8:11], s90 offen sc1
    s_add_u32 s90, s90, s100
    v_cvt_pk_bf16_f32 v144, v144, v145
    v_cvt_pk_bf16_f32 v145, v146, v147
    v_cvt_pk_bf16_f32 v146, v148, v149
    v_cvt_pk_bf16_f32 v147, v150, v151
    buffer_store_dwordx4 v[144:147], v2, s[8:11], s90 offen sc1
    s_add_u32 s90, s90, s100
    v_cvt_pk_bf16_f32 v152, v152, v153
    v_cvt_pk_bf16_f32 v153, v154, v155
    v_cvt_pk_bf16_f32 v154, v156, v157
    v_cvt_pk_bf16_f32 v155, v158, v159
    buffer_store_dwordx4 v[152:155], v2, s[8:11], s90 offen sc1
    s_add_u32 s90, s90, s100
    s_add_u32 s91, s91, s99
    s_mov_b32 s90, s91
    v_cvt_pk_bf16_f32 v160, v160, v161
    v_cvt_pk_bf16_f32 v161, v162, v163
    v_cvt_pk_bf16_f32 v162, v164, v165
    v_cvt_pk_bf16_f32 v163, v166, v167
    buffer_store_dwordx4 v[160:163], v2, s[8:11], s90 offen sc1
    s_add_u32 s90, s90, s100
    v_cvt_pk_bf16_f32 v168, v168, v169
    v_cvt_pk_bf16_f32 v169, v170, v171
    v_cvt_pk_bf16_f32 v170, v172, v173
    v_cvt_pk_bf16_f32 v171, v174, v175
    buffer_store_dwordx4 v[168:171], v2, s[8:11], s90 offen sc1
    s_add_u32 s90, s90, s100
    v_cvt_pk_bf16_f32 v176, v176, v177
    v_cvt_pk_bf16_f32 v177, v178, v179
    v_cvt_pk_bf16_f32 v178, v180, v181
    v_cvt_pk_bf16_f32 v179, v182, v183
    buffer_store_dwordx4 v[176:179], v2, s[8:11], s90 offen sc1
    s_add_u32 s90, s90, s100
    v_cvt_pk_bf16_f32 v184, v184, v185
    v_cvt_pk_bf16_f32 v185, v186, v187
    v_cvt_pk_bf16_f32 v186, v188, v189
    v_cvt_pk_bf16_f32 v187, v190, v191
    buffer_store_dwordx4 v[184:187], v2, s[8:11], s90 offen sc1
    s_add_u32 s90, s90, s100
    v_cvt_pk_bf16_f32 v192, v192, v193
    v_cvt_pk_bf16_f32 v193, v194, v195
    v_cvt_pk_bf16_f32 v194, v196, v197
    v_cvt_pk_bf16_f32 v195, v198, v199
    buffer_store_dwordx4 v[192:195], v2, s[8:11], s90 offen sc1
    s_add_u32 s90, s90, s100
    v_cvt_pk_bf16_f32 v200, v200, v201
    v_cvt_pk_bf16_f32 v201, v202, v203
    v_cvt_pk_bf16_f32 v202, v204, v205
    v_cvt_pk_bf16_f32 v203, v206, v207
    buffer_store_dwordx4 v[200:203], v2, s[8:11], s90 offen sc1
    s_add_u32 s90, s90, s100
    v_cvt_pk_bf16_f32 v208, v208, v209
    v_cvt_pk_bf16_f32 v209, v210, v211
    v_cvt_pk_bf16_f32 v210, v212, v213
    v_cvt_pk_bf16_f32 v211, v214, v215
    buffer_store_dwordx4 v[208:211], v2, s[8:11], s90 offen sc1
    s_add_u32 s90, s90, s100
    v_cvt_pk_bf16_f32 v216, v216, v217
    v_cvt_pk_bf16_f32 v217, v218, v219
    v_cvt_pk_bf16_f32 v218, v220, v221
    v_cvt_pk_bf16_f32 v219, v222, v223
    buffer_store_dwordx4 v[216:219], v2, s[8:11], s90 offen sc1
    s_add_u32 s90, s90, s100
    s_add_u32 s91, s91, s99
    s_mov_b32 s90, s91
    v_cvt_pk_bf16_f32 v224, v224, v225
    v_cvt_pk_bf16_f32 v225, v226, v227
    v_cvt_pk_bf16_f32 v226, v228, v229
    v_cvt_pk_bf16_f32 v227, v230, v231
    buffer_store_dwordx4 v[224:227], v2, s[8:11], s90 offen sc1
    s_add_u32 s90, s90, s100
    v_cvt_pk_bf16_f32 v232, v232, v233
    v_cvt_pk_bf16_f32 v233, v234, v235
    v_cvt_pk_bf16_f32 v234, v236, v237
    v_cvt_pk_bf16_f32 v235, v238, v239
    buffer_store_dwordx4 v[232:235], v2, s[8:11], s90 offen sc1
    s_add_u32 s90, s90, s100
    v_cvt_pk_bf16_f32 v240, v240, v241
    v_cvt_pk_bf16_f32 v241, v242, v243
    v_cvt_pk_bf16_f32 v242, v244, v245
    v_cvt_pk_bf16_f32 v243, v246, v247
    buffer_store_dwordx4 v[240:243], v2, s[8:11], s90 offen sc1
    s_add_u32 s90, s90, s100
    v_cvt_pk_bf16_f32 v248, v248, v249
    v_cvt_pk_bf16_f32 v249, v250, v251
    v_cvt_pk_bf16_f32 v250, v252, v253
    v_cvt_pk_bf16_f32 v251, v254, v255
    buffer_store_dwordx4 v[248:251], v2, s[8:11], s90 offen sc1
    s_add_u32 s90, s90, s100
    v_accvgpr_read_b32 v24, a96
    v_accvgpr_read_b32 v25, a97
    v_accvgpr_read_b32 v26, a98
    v_accvgpr_read_b32 v27, a99
    v_accvgpr_read_b32 v28, a100
    v_accvgpr_read_b32 v29, a101
    v_accvgpr_read_b32 v30, a102
    v_accvgpr_read_b32 v31, a103
    v_cvt_pk_bf16_f32 v24, v24, v25
    v_cvt_pk_bf16_f32 v25, v26, v27
    v_cvt_pk_bf16_f32 v26, v28, v29
    v_cvt_pk_bf16_f32 v27, v30, v31
    buffer_store_dwordx4 v[24:27], v2, s[8:11], s90 offen sc1
    s_add_u32 s90, s90, s100
    s_nop 1
    v_accvgpr_read_b32 v24, a104
    v_accvgpr_read_b32 v25, a105
    v_accvgpr_read_b32 v26, a106
    v_accvgpr_read_b32 v27, a107
    v_accvgpr_read_b32 v28, a108
    v_accvgpr_read_b32 v29, a109
    v_accvgpr_read_b32 v30, a110
    v_accvgpr_read_b32 v31, a111
    v_cvt_pk_bf16_f32 v24, v24, v25
    v_cvt_pk_bf16_f32 v25, v26, v27
    v_cvt_pk_bf16_f32 v26, v28, v29
    v_cvt_pk_bf16_f32 v27, v30, v31
    buffer_store_dwordx4 v[24:27], v2, s[8:11], s90 offen sc1
    s_add_u32 s90, s90, s100
    s_nop 1
    v_accvgpr_read_b32 v24, a112
    v_accvgpr_read_b32 v25, a113
    v_accvgpr_read_b32 v26, a114
    v_accvgpr_read_b32 v27, a115
    v_accvgpr_read_b32 v28, a116
    v_accvgpr_read_b32 v29, a117
    v_accvgpr_read_b32 v30, a118
    v_accvgpr_read_b32 v31, a119
    v_cvt_pk_bf16_f32 v24, v24, v25
    v_cvt_pk_bf16_f32 v25, v26, v27
    v_cvt_pk_bf16_f32 v26, v28, v29
    v_cvt_pk_bf16_f32 v27, v30, v31
    buffer_store_dwordx4 v[24:27], v2, s[8:11], s90 offen sc1
    s_add_u32 s90, s90, s100
    s_nop 1
    v_accvgpr_read_b32 v24, a120
    v_accvgpr_read_b32 v25, a121
    v_accvgpr_read_b32 v26, a122
    v_accvgpr_read_b32 v27, a123
    v_accvgpr_read_b32 v28, a124
    v_accvgpr_read_b32 v29, a125
    v_accvgpr_read_b32 v30, a126
    v_accvgpr_read_b32 v31, a127
    v_cvt_pk_bf16_f32 v24, v24, v25
    v_cvt_pk_bf16_f32 v25, v26, v27
    v_cvt_pk_bf16_f32 v26, v28, v29
    v_cvt_pk_bf16_f32 v27, v30, v31
    buffer_store_dwordx4 v[24:27], v2, s[8:11], s90 offen sc1
    s_add_u32 s90, s90, s100
    s_nop 1
    s_add_u32 s91, s91, s99
    s_setpc_b64 s[20:21]
mega_kernel_epl61:
    s_mov_b32 s92, s97
    s_mov_b32 s93, s97
    s_cmp_eq_u32 s97, 0
    s_cbranch_scc1 mega_kernel_ns262
    s_mov_b32 s90, s98
    v_pk_mul_f32 v[32:33], v[32:33], s[92:93]
    v_pk_mul_f32 v[34:35], v[34:35], s[92:93]
    v_pk_mul_f32 v[36:37], v[36:37], s[92:93]
    v_pk_mul_f32 v[38:39], v[38:39], s[92:93]
    v_cvt_pk_bf16_f32 v32, v32, v33
    v_cvt_pk_bf16_f32 v33, v34, v35
    v_cvt_pk_bf16_f32 v34, v36, v37
    v_cvt_pk_bf16_f32 v35, v38, v39
    buffer_store_dwordx4 v[32:35], v2, s[8:11], s90 offen sc1
    s_add_u32 s90, s90, s100
    v_pk_mul_f32 v[40:41], v[40:41], s[92:93]
    v_pk_mul_f32 v[42:43], v[42:43], s[92:93]
    v_pk_mul_f32 v[44:45], v[44:45], s[92:93]
    v_pk_mul_f32 v[46:47], v[46:47], s[92:93]
    v_cvt_pk_bf16_f32 v40, v40, v41
    v_cvt_pk_bf16_f32 v41, v42, v43
    v_cvt_pk_bf16_f32 v42, v44, v45
    v_cvt_pk_bf16_f32 v43, v46, v47
    buffer_store_dwordx4 v[40:43], v2, s[8:11], s90 offen sc1
    s_add_u32 s90, s90, s100
    v_pk_mul_f32 v[48:49], v[48:49], s[92:93]
    v_pk_mul_f32 v[50:51], v[50:51], s[92:93]
    v_pk_mul_f32 v[52:53], v[52:53], s[92:93]
    v_pk_mul_f32 v[54:55], v[54:55], s[92:93]
    v_cvt_pk_bf16_f32 v48, v48, v49
    v_cvt_pk_bf16_f32 v49, v50, v51
    v_cvt_pk_bf16_f32 v50, v52, v53
    v_cvt_pk_bf16_f32 v51, v54, v55
    buffer_store_dwordx4 v[48:51], v2, s[8:11], s90 offen sc1
    s_add_u32 s90, s90, s100
    v_pk_mul_f32 v[56:57], v[56:57], s[92:93]
    v_pk_mul_f32 v[58:59], v[58:59], s[92:93]
    v_pk_mul_f32 v[60:61], v[60:61], s[92:93]
    v_pk_mul_f32 v[62:63], v[62:63], s[92:93]
    v_cvt_pk_bf16_f32 v56, v56, v57
    v_cvt_pk_bf16_f32 v57, v58, v59
    v_cvt_pk_bf16_f32 v58, v60, v61
    v_cvt_pk_bf16_f32 v59, v62, v63
    buffer_store_dwordx4 v[56:59], v2, s[8:11], s90 offen sc1
    s_add_u32 s90, s90, s100
    v_pk_mul_f32 v[64:65], v[64:65], s[92:93]
    v_pk_mul_f32 v[66:67], v[66:67], s[92:93]
    v_pk_mul_f32 v[68:69], v[68:69], s[92:93]
    v_pk_mul_f32 v[70:71], v[70:71], s[92:93]
    v_cvt_pk_bf16_f32 v64, v64, v65
    v_cvt_pk_bf16_f32 v65, v66, v67
    v_cvt_pk_bf16_f32 v66, v68, v69
    v_cvt_pk_bf16_f32 v67, v70, v71
    buffer_store_dwordx4 v[64:67], v2, s[8:11], s90 offen sc1
    s_add_u32 s90, s90, s100
    v_pk_mul_f32 v[72:73], v[72:73], s[92:93]
    v_pk_mul_f32 v[74:75], v[74:75], s[92:93]
    v_pk_mul_f32 v[76:77], v[76:77], s[92:93]
    v_pk_mul_f32 v[78:79], v[78:79], s[92:93]
    v_cvt_pk_bf16_f32 v72, v72, v73
    v_cvt_pk_bf16_f32 v73, v74, v75
    v_cvt_pk_bf16_f32 v74, v76, v77
    v_cvt_pk_bf16_f32 v75, v78, v79
    buffer_store_dwordx4 v[72:75], v2, s[8:11], s90 offen sc1
    s_add_u32 s90, s90, s100
    v_pk_mul_f32 v[80:81], v[80:81], s[92:93]
    v_pk_mul_f32 v[82:83], v[82:83], s[92:93]
    v_pk_mul_f32 v[84:85], v[84:85], s[92:93]
    v_pk_mul_f32 v[86:87], v[86:87], s[92:93]
    v_cvt_pk_bf16_f32 v80, v80, v81
    v_cvt_pk_bf16_f32 v81, v82, v83
    v_cvt_pk_bf16_f32 v82, v84, v85
    v_cvt_pk_bf16_f32 v83, v86, v87
    buffer_store_dwordx4 v[80:83], v2, s[8:11], s90 offen sc1
    s_add_u32 s90, s90, s100
    v_pk_mul_f32 v[88:89], v[88:89], s[92:93]
    v_pk_mul_f32 v[90:91], v[90:91], s[92:93]
    v_pk_mul_f32 v[92:93], v[92:93], s[92:93]
    v_pk_mul_f32 v[94:95], v[94:95], s[92:93]
    v_cvt_pk_bf16_f32 v88, v88, v89
    v_cvt_pk_bf16_f32 v89, v90, v91
    v_cvt_pk_bf16_f32 v90, v92, v93
    v_cvt_pk_bf16_f32 v91, v94, v95
    buffer_store_dwordx4 v[88:91], v2, s[8:11], s90 offen sc1
    s_add_u32 s90, s98, s99
    v_pk_mul_f32 v[96:97], v[96:97], s[92:93]
    v_pk_mul_f32 v[98:99], v[98:99], s[92:93]
    v_pk_mul_f32 v[100:101], v[100:101], s[92:93]
    v_pk_mul_f32 v[102:103], v[102:103], s[92:93]
    v_cvt_pk_bf16_f32 v96, v96, v97
    v_cvt_pk_bf16_f32 v97, v98, v99
    v_cvt_pk_bf16_f32 v98, v100, v101
    v_cvt_pk_bf16_f32 v99, v102, v103
    buffer_store_dwordx4 v[96:99], v2, s[8:11], s90 offen sc1
    s_add_u32 s90, s90, s100
    v_pk_mul_f32 v[104:105], v[104:105], s[92:93]
    v_pk_mul_f32 v[106:107], v[106:107], s[92:93]
    v_pk_mul_f32 v[108:109], v[108:109], s[92:93]
    v_pk_mul_f32 v[110:111], v[110:111], s[92:93]
    v_cvt_pk_bf16_f32 v104, v104, v105
    v_cvt_pk_bf16_f32 v105, v106, v107
    v_cvt_pk_bf16_f32 v106, v108, v109
    v_cvt_pk_bf16_f32 v107, v110, v111
    buffer_store_dwordx4 v[104:107], v2, s[8:11], s90 offen sc1
    s_add_u32 s90, s90, s100
    v_pk_mul_f32 v[112:113], v[112:113], s[92:93]
    v_pk_mul_f32 v[114:115], v[114:115], s[92:93]
    v_pk_mul_f32 v[116:117], v[116:117], s[92:93]
    v_pk_mul_f32 v[118:119], v[118:119], s[92:93]
    v_cvt_pk_bf16_f32 v112, v112, v113
    v_cvt_pk_bf16_f32 v113, v114, v115
    v_cvt_pk_bf16_f32 v114, v116, v117
    v_cvt_pk_bf16_f32 v115, v118, v119
    buffer_store_dwordx4 v[112:115], v2, s[8:11], s90 offen sc1
    s_add_u32 s90, s90, s100
    v_pk_mul_f32 v[120:121], v[120:121], s[92:93]
    v_pk_mul_f32 v[122:123], v[122:123], s[92:93]
    v_pk_mul_f32 v[124:125], v[124:125], s[92:93]
    v_pk_mul_f32 v[126:127], v[126:127], s[92:93]
    v_cvt_pk_bf16_f32 v120, v120, v121
    v_cvt_pk_bf16_f32 v121, v122, v123
    v_cvt_pk_bf16_f32 v122, v124, v125
    v_cvt_pk_bf16_f32 v123, v126, v127
    buffer_store_dwordx4 v[120:123], v2, s[8:11], s90 offen sc1
    s_add_u32 s90, s90, s100
    v_pk_mul_f32 v[128:129], v[128:129], s[92:93]
    v_pk_mul_f32 v[130:131], v[130:131], s[92:93]
    v_pk_mul_f32 v[132:133], v[132:133], s[92:93]
    v_pk_mul_f32 v[134:135], v[134:135], s[92:93]
    v_cvt_pk_bf16_f32 v128, v128, v129
    v_cvt_pk_bf16_f32 v129, v130, v131
    v_cvt_pk_bf16_f32 v130, v132, v133
    v_cvt_pk_bf16_f32 v131, v134, v135
    buffer_store_dwordx4 v[128:131], v2, s[8:11], s90 offen sc1
    s_add_u32 s90, s90, s100
    v_pk_mul_f32 v[136:137], v[136:137], s[92:93]
    v_pk_mul_f32 v[138:139], v[138:139], s[92:93]
    v_pk_mul_f32 v[140:141], v[140:141], s[92:93]
    v_pk_mul_f32 v[142:143], v[142:143], s[92:93]
    v_cvt_pk_bf16_f32 v136, v136, v137
    v_cvt_pk_bf16_f32 v137, v138, v139
    v_cvt_pk_bf16_f32 v138, v140, v141
    v_cvt_pk_bf16_f32 v139, v142, v143
    buffer_store_dwordx4 v[136:139], v2, s[8:11], s90 offen sc1
    s_add_u32 s90, s90, s100
    v_pk_mul_f32 v[144:145], v[144:145], s[92:93]
    v_pk_mul_f32 v[146:147], v[146:147], s[92:93]
    v_pk_mul_f32 v[148:149], v[148:149], s[92:93]
    v_pk_mul_f32 v[150:151], v[150:151], s[92:93]
    v_cvt_pk_bf16_f32 v144, v144, v145
    v_cvt_pk_bf16_f32 v145, v146, v147
    v_cvt_pk_bf16_f32 v146, v148, v149
    v_cvt_pk_bf16_f32 v147, v150, v151
    buffer_store_dwordx4 v[144:147], v2, s[8:11], s90 offen sc1
    s_add_u32 s90, s90, s100
    v_pk_mul_f32 v[152:153], v[152:153], s[92:93]
    v_pk_mul_f32 v[154:155], v[154:155], s[92:93]
    v_pk_mul_f32 v[156:157], v[156:157], s[92:93]
    v_pk_mul_f32 v[158:159], v[158:159], s[92:93]
    v_cvt_pk_bf16_f32 v152, v152, v153
    v_cvt_pk_bf16_f32 v153, v154, v155
    v_cvt_pk_bf16_f32 v154, v156, v157
    v_cvt_pk_bf16_f32 v155, v158, v159
    buffer_store_dwordx4 v[152:155], v2, s[8:11], s90 offen sc1
    s_add_u32 s90, s90, s100
    v_pk_mul_f32 v[192:193], v[192:193], s[92:93]
    v_pk_mul_f32 v[194:195], v[194:195], s[92:93]
    v_pk_mul_f32 v[196:197], v[196:197], s[92:93]
    v_pk_mul_f32 v[198:199], v[198:199], s[92:93]
    v_cvt_pk_bf16_f32 v192, v192, v193
    v_cvt_pk_bf16_f32 v193, v194, v195
    v_cvt_pk_bf16_f32 v194, v196, v197
    v_cvt_pk_bf16_f32 v195, v198, v199
    v_pk_mul_f32 v[200:201], v[200:201], s[92:93]
    v_pk_mul_f32 v[202:203], v[202:203], s[92:93]
    v_pk_mul_f32 v[204:205], v[204:205], s[92:93]
    v_pk_mul_f32 v[206:207], v[206:207], s[92:93]
    v_cvt_pk_bf16_f32 v196, v200, v201
    v_cvt_pk_bf16_f32 v197, v202, v203
    v_cvt_pk_bf16_f32 v198, v204, v205
    v_cvt_pk_bf16_f32 v199, v206, v207
    v_pk_mul_f32 v[208:209], v[208:209], s[92:93]
    v_pk_mul_f32 v[210:211], v[210:211], s[92:93]
    v_pk_mul_f32 v[212:213], v[212:213], s[92:93]
    v_pk_mul_f32 v[214:215], v[214:215], s[92:93]
    v_cvt_pk_bf16_f32 v200, v208, v209
    v_cvt_pk_bf16_f32 v201, v210, v211
    v_cvt_pk_bf16_f32 v202, v212, v213
    v_cvt_pk_bf16_f32 v203, v214, v215
    v_pk_mul_f32 v[216:217], v[216:217], s[92:93]
    v_pk_mul_f32 v[218:219], v[218:219], s[92:93]
    v_pk_mul_f32 v[220:221], v[220:221], s[92:93]
    v_pk_mul_f32 v[222:223], v[222:223], s[92:93]
    v_cvt_pk_bf16_f32 v204, v216, v217
    v_cvt_pk_bf16_f32 v205, v218, v219
    v_cvt_pk_bf16_f32 v206, v220, v221
    v_cvt_pk_bf16_f32 v207, v222, v223
    v_pk_mul_f32 v[224:225], v[224:225], s[92:93]
    v_pk_mul_f32 v[226:227], v[226:227], s[92:93]
    v_pk_mul_f32 v[228:229], v[228:229], s[92:93]
    v_pk_mul_f32 v[230:231], v[230:231], s[92:93]
    v_cvt_pk_bf16_f32 v208, v224, v225
    v_cvt_pk_bf16_f32 v209, v226, v227
    v_cvt_pk_bf16_f32 v210, v228, v229
    v_cvt_pk_bf16_f32 v211, v230, v231
    v_pk_mul_f32 v[232:233], v[232:233], s[92:93]
    v_pk_mul_f32 v[234:235], v[234:235], s[92:93]
    v_pk_mul_f32 v[236:237], v[236:237], s[92:93]
    v_pk_mul_f32 v[238:239], v[238:239], s[92:93]
    v_cvt_pk_bf16_f32 v212, v232, v233
    v_cvt_pk_bf16_f32 v213, v234, v235
    v_cvt_pk_bf16_f32 v214, v236, v237
    v_cvt_pk_bf16_f32 v215, v238, v239
    v_pk_mul_f32 v[240:241], v[240:241], s[92:93]
    v_pk_mul_f32 v[242:243], v[242:243], s[92:93]
    v_pk_mul_f32 v[244:245], v[244:245], s[92:93]
    v_pk_mul_f32 v[246:247], v[246:247], s[92:93]
    v_cvt_pk_bf16_f32 v216, v240, v241
    v_cvt_pk_bf16_f32 v217, v242, v243
    v_cvt_pk_bf16_f32 v218, v244, v245
    v_cvt_pk_bf16_f32 v219, v246, v247
    v_pk_mul_f32 v[248:249], v[248:249], s[92:93]
    v_pk_mul_f32 v[250:251], v[250:251], s[92:93]
    v_pk_mul_f32 v[252:253], v[252:253], s[92:93]
    v_pk_mul_f32 v[254:255], v[254:255], s[92:93]
    v_cvt_pk_bf16_f32 v220, v248, v249
    v_cvt_pk_bf16_f32 v221, v250, v251
    v_cvt_pk_bf16_f32 v222, v252, v253
    v_cvt_pk_bf16_f32 v223, v254, v255
    v_accvgpr_read_b32 v24, a96
    v_accvgpr_read_b32 v25, a97
    v_accvgpr_read_b32 v26, a98
    v_accvgpr_read_b32 v27, a99
    v_accvgpr_read_b32 v28, a100
    v_accvgpr_read_b32 v29, a101
    v_accvgpr_read_b32 v30, a102
    v_accvgpr_read_b32 v31, a103
    v_pk_mul_f32 v[24:25], v[24:25], s[92:93]
    v_pk_mul_f32 v[26:27], v[26:27], s[92:93]
    v_pk_mul_f32 v[28:29], v[28:29], s[92:93]
    v_pk_mul_f32 v[30:31], v[30:31], s[92:93]
    v_cvt_pk_bf16_f32 v224, v24, v25
    v_cvt_pk_bf16_f32 v225, v26, v27
    v_cvt_pk_bf16_f32 v226, v28, v29
    v_cvt_pk_bf16_f32 v227, v30, v31
    v_accvgpr_read_b32 v24, a104
    v_accvgpr_read_b32 v25, a105
    v_accvgpr_read_b32 v26, a106
    v_accvgpr_read_b32 v27, a107
    v_accvgpr_read_b32 v28, a108
    v_accvgpr_read_b32 v29, a109
    v_accvgpr_read_b32 v30, a110
    v_accvgpr_read_b32 v31, a111
    v_pk_mul_f32 v[24:25], v[24:25], s[92:93]
    v_pk_mul_f32 v[26:27], v[26:27], s[92:93]
    v_pk_mul_f32 v[28:29], v[28:29], s[92:93]
    v_pk_mul_f32 v[30:31], v[30:31], s[92:93]
    v_cvt_pk_bf16_f32 v228, v24, v25
    v_cvt_pk_bf16_f32 v229, v26, v27
    v_cvt_pk_bf16_f32 v230, v28, v29
    v_cvt_pk_bf16_f32 v231, v30, v31
    v_accvgpr_read_b32 v24, a112
    v_accvgpr_read_b32 v25, a113
    v_accvgpr_read_b32 v26, a114
    v_accvgpr_read_b32 v27, a115
    v_accvgpr_read_b32 v28, a116
    v_accvgpr_read_b32 v29, a117
    v_accvgpr_read_b32 v30, a118
    v_accvgpr_read_b32 v31, a119
    v_pk_mul_f32 v[24:25], v[24:25], s[92:93]
    v_pk_mul_f32 v[26:27], v[26:27], s[92:93]
    v_pk_mul_f32 v[28:29], v[28:29], s[92:93]
    v_pk_mul_f32 v[30:31], v[30:31], s[92:93]
    v_cvt_pk_bf16_f32 v232, v24, v25
    v_cvt_pk_bf16_f32 v233, v26, v27
    v_cvt_pk_bf16_f32 v234, v28, v29
    v_cvt_pk_bf16_f32 v235, v30, v31
    v_accvgpr_read_b32 v24, a120
    v_accvgpr_read_b32 v25, a121
    v_accvgpr_read_b32 v26, a122
    v_accvgpr_read_b32 v27, a123
    v_accvgpr_read_b32 v28, a124
    v_accvgpr_read_b32 v29, a125
    v_accvgpr_read_b32 v30, a126
    v_accvgpr_read_b32 v31, a127
    v_pk_mul_f32 v[24:25], v[24:25], s[92:93]
    v_pk_mul_f32 v[26:27], v[26:27], s[92:93]
    v_pk_mul_f32 v[28:29], v[28:29], s[92:93]
    v_pk_mul_f32 v[30:31], v[30:31], s[92:93]
    v_cvt_pk_bf16_f32 v236, v24, v25
    v_cvt_pk_bf16_f32 v237, v26, v27
    v_cvt_pk_bf16_f32 v238, v28, v29
    v_cvt_pk_bf16_f32 v239, v30, v31
    v_pk_mul_f32 v[160:161], v[160:161], s[92:93]
    v_pk_mul_f32 v[162:163], v[162:163], s[92:93]
    v_pk_mul_f32 v[164:165], v[164:165], s[92:93]
    v_pk_mul_f32 v[166:167], v[166:167], s[92:93]
    v_cvt_pk_bf16_f32 v240, v160, v161
    v_cvt_pk_bf16_f32 v241, v162, v163
    v_cvt_pk_bf16_f32 v242, v164, v165
    v_cvt_pk_bf16_f32 v243, v166, v167
    v_pk_mul_f32 v[168:169], v[168:169], s[92:93]
    v_pk_mul_f32 v[170:171], v[170:171], s[92:93]
    v_pk_mul_f32 v[172:173], v[172:173], s[92:93]
    v_pk_mul_f32 v[174:175], v[174:175], s[92:93]
    v_cvt_pk_bf16_f32 v244, v168, v169
    v_cvt_pk_bf16_f32 v245, v170, v171
    v_cvt_pk_bf16_f32 v246, v172, v173
    v_cvt_pk_bf16_f32 v247, v174, v175
    v_pk_mul_f32 v[176:177], v[176:177], s[92:93]
    v_pk_mul_f32 v[178:179], v[178:179], s[92:93]
    v_pk_mul_f32 v[180:181], v[180:181], s[92:93]
    v_pk_mul_f32 v[182:183], v[182:183], s[92:93]
    v_cvt_pk_bf16_f32 v248, v176, v177
    v_cvt_pk_bf16_f32 v249, v178, v179
    v_cvt_pk_bf16_f32 v250, v180, v181
    v_cvt_pk_bf16_f32 v251, v182, v183
    v_pk_mul_f32 v[184:185], v[184:185], s[92:93]
    v_pk_mul_f32 v[186:187], v[186:187], s[92:93]
    v_pk_mul_f32 v[188:189], v[188:189], s[92:93]
    v_pk_mul_f32 v[190:191], v[190:191], s[92:93]
    v_cvt_pk_bf16_f32 v252, v184, v185
    v_cvt_pk_bf16_f32 v253, v186, v187
    v_cvt_pk_bf16_f32 v254, v188, v189
    v_cvt_pk_bf16_f32 v255, v190, v191
    s_setpc_b64 s[20:21]
mega_kernel_ns262:
    s_mov_b32 s90, s98
    v_cvt_pk_bf16_f32 v32, v32, v33
    v_cvt_pk_bf16_f32 v33, v34, v35
    v_cvt_pk_bf16_f32 v34, v36, v37
    v_cvt_pk_bf16_f32 v35, v38, v39
    buffer_store_dwordx4 v[32:35], v2, s[8:11], s90 offen sc1
    s_add_u32 s90, s90, s100
    v_cvt_pk_bf16_f32 v40, v40, v41
    v_cvt_pk_bf16_f32 v41, v42, v43
    v_cvt_pk_bf16_f32 v42, v44, v45
    v_cvt_pk_bf16_f32 v43, v46, v47
    buffer_store_dwordx4 v[40:43], v2, s[8:11], s90 offen sc1
    s_add_u32 s90, s90, s100
    v_cvt_pk_bf16_f32 v48, v48, v49
    v_cvt_pk_bf16_f32 v49, v50, v51
    v_cvt_pk_bf16_f32 v50, v52, v53
    v_cvt_pk_bf16_f32 v51, v54, v55
    buffer_store_dwordx4 v[48:51], v2, s[8:11], s90 offen sc1
    s_add_u32 s90, s90, s100
    v_cvt_pk_bf16_f32 v56, v56, v57
    v_cvt_pk_bf16_f32 v57, v58, v59
    v_cvt_pk_bf16_f32 v58, v60, v61
    v_cvt_pk_bf16_f32 v59, v62, v63
    buffer_store_dwordx4 v[56:59], v2, s[8:11], s90 offen sc1
    s_add_u32 s90, s90, s100
    v_cvt_pk_bf16_f32 v64, v64, v65
    v_cvt_pk_bf16_f32 v65, v66, v67
    v_cvt_pk_bf16_f32 v66, v68, v69
    v_cvt_pk_bf16_f32 v67, v70, v71
    buffer_store_dwordx4 v[64:67], v2, s[8:11], s90 offen sc1
    s_add_u32 s90, s90, s100
    v_cvt_pk_bf16_f32 v72, v72, v73
    v_cvt_pk_bf16_f32 v73, v74, v75
    v_cvt_pk_bf16_f32 v74, v76, v77
    v_cvt_pk_bf16_f32 v75, v78, v79
    buffer_store_dwordx4 v[72:75], v2, s[8:11], s90 offen sc1
    s_add_u32 s90, s90, s100
    v_cvt_pk_bf16_f32 v80, v80, v81
    v_cvt_pk_bf16_f32 v81, v82, v83
    v_cvt_pk_bf16_f32 v82, v84, v85
    v_cvt_pk_bf16_f32 v83, v86, v87
    buffer_store_dwordx4 v[80:83], v2, s[8:11], s90 offen sc1
    s_add_u32 s90, s90, s100
    v_cvt_pk_bf16_f32 v88, v88, v89
    v_cvt_pk_bf16_f32 v89, v90, v91
    v_cvt_pk_bf16_f32 v90, v92, v93
    v_cvt_pk_bf16_f32 v91, v94, v95
    buffer_store_dwordx4 v[88:91], v2, s[8:11], s90 offen sc1
    s_add_u32 s90, s98, s99
    v_cvt_pk_bf16_f32 v96, v96, v97
    v_cvt_pk_bf16_f32 v97, v98, v99
    v_cvt_pk_bf16_f32 v98, v100, v101
    v_cvt_pk_bf16_f32 v99, v102, v103
    buffer_store_dwordx4 v[96:99], v2, s[8:11], s90 offen sc1
    s_add_u32 s90, s90, s100
    v_cvt_pk_bf16_f32 v104, v104, v105
    v_cvt_pk_bf16_f32 v105, v106, v107
    v_cvt_pk_bf16_f32 v106, v108, v109
    v_cvt_pk_bf16_f32 v107, v110, v111
    buffer_store_dwordx4 v[104:107], v2, s[8:11], s90 offen sc1
    s_add_u32 s90, s90, s100
    v_cvt_pk_bf16_f32 v112, v112, v113
    v_cvt_pk_bf16_f32 v113, v114, v115
    v_cvt_pk_bf16_f32 v114, v116, v117
    v_cvt_pk_bf16_f32 v115, v118, v119
    buffer_store_dwordx4 v[112:115], v2, s[8:11], s90 offen sc1
    s_add_u32 s90, s90, s100
    v_cvt_pk_bf16_f32 v120, v120, v121
    v_cvt_pk_bf16_f32 v121, v122, v123
    v_cvt_pk_bf16_f32 v122, v124, v125
    v_cvt_pk_bf16_f32 v123, v126, v127
    buffer_store_dwordx4 v[120:123], v2, s[8:11], s90 offen sc1
    s_add_u32 s90, s90, s100
    v_cvt_pk_bf16_f32 v128, v128, v129
    v_cvt_pk_bf16_f32 v129, v130, v131
    v_cvt_pk_bf16_f32 v130, v132, v133
    v_cvt_pk_bf16_f32 v131, v134, v135
    buffer_store_dwordx4 v[128:131], v2, s[8:11], s90 offen sc1
    s_add_u32 s90, s90, s100
    v_cvt_pk_bf16_f32 v136, v136, v137
    v_cvt_pk_bf16_f32 v137, v138, v139
    v_cvt_pk_bf16_f32 v138, v140, v141
    v_cvt_pk_bf16_f32 v139, v142, v143
    buffer_store_dwordx4 v[136:139], v2, s[8:11], s90 offen sc1
    s_add_u32 s90, s90, s100
    v_cvt_pk_bf16_f32 v144, v144, v145
    v_cvt_pk_bf16_f32 v145, v146, v147
    v_cvt_pk_bf16_f32 v146, v148, v149
    v_cvt_pk_bf16_f32 v147, v150, v151
    buffer_store_dwordx4 v[144:147], v2, s[8:11], s90 offen sc1
    s_add_u32 s90, s90, s100
    v_cvt_pk_bf16_f32 v152, v152, v153
    v_cvt_pk_bf16_f32 v153, v154, v155
    v_cvt_pk_bf16_f32 v154, v156, v157
    v_cvt_pk_bf16_f32 v155, v158, v159
    buffer_store_dwordx4 v[152:155], v2, s[8:11], s90 offen sc1
    s_add_u32 s90, s90, s100
    v_cvt_pk_bf16_f32 v192, v192, v193
    v_cvt_pk_bf16_f32 v193, v194, v195
    v_cvt_pk_bf16_f32 v194, v196, v197
    v_cvt_pk_bf16_f32 v195, v198, v199
    v_cvt_pk_bf16_f32 v196, v200, v201
    v_cvt_pk_bf16_f32 v197, v202, v203
    v_cvt_pk_bf16_f32 v198, v204, v205
    v_cvt_pk_bf16_f32 v199, v206, v207
    v_cvt_pk_bf16_f32 v200, v208, v209
    v_cvt_pk_bf16_f32 v201, v210, v211
    v_cvt_pk_bf16_f32 v202, v212, v213
    v_cvt_pk_bf16_f32 v203, v214, v215
    v_cvt_pk_bf16_f32 v204, v216, v217
    v_cvt_pk_bf16_f32 v205, v218, v219
    v_cvt_pk_bf16_f32 v206, v220, v221
    v_cvt_pk_bf16_f32 v207, v222, v223
    v_cvt_pk_bf16_f32 v208, v224, v225
    v_cvt_pk_bf16_f32 v209, v226, v227
    v_cvt_pk_bf16_f32 v210, v228, v229
    v_cvt_pk_bf16_f32 v211, v230, v231
    v_cvt_pk_bf16_f32 v212, v232, v233
    v_cvt_pk_bf16_f32 v213, v234, v235
    v_cvt_pk_bf16_f32 v214, v236, v237
    v_cvt_pk_bf16_f32 v215, v238, v239
    v_cvt_pk_bf16_f32 v216, v240, v241
    v_cvt_pk_bf16_f32 v217, v242, v243
    v_cvt_pk_bf16_f32 v218, v244, v245
    v_cvt_pk_bf16_f32 v219, v246, v247
    v_cvt_pk_bf16_f32 v220, v248, v249
    v_cvt_pk_bf16_f32 v221, v250, v251
    v_cvt_pk_bf16_f32 v222, v252, v253
    v_cvt_pk_bf16_f32 v223, v254, v255
    v_accvgpr_read_b32 v24, a96
    v_accvgpr_read_b32 v25, a97
    v_accvgpr_read_b32 v26, a98
    v_accvgpr_read_b32 v27, a99
    v_accvgpr_read_b32 v28, a100
    v_accvgpr_read_b32 v29, a101
    v_accvgpr_read_b32 v30, a102
    v_accvgpr_read_b32 v31, a103
    v_cvt_pk_bf16_f32 v224, v24, v25
    v_cvt_pk_bf16_f32 v225, v26, v27
    v_cvt_pk_bf16_f32 v226, v28, v29
    v_cvt_pk_bf16_f32 v227, v30, v31
    v_accvgpr_read_b32 v24, a104
    v_accvgpr_read_b32 v25, a105
    v_accvgpr_read_b32 v26, a106
    v_accvgpr_read_b32 v27, a107
    v_accvgpr_read_b32 v28, a108
    v_accvgpr_read_b32 v29, a109
    v_accvgpr_read_b32 v30, a110
    v_accvgpr_read_b32 v31, a111
    v_cvt_pk_bf16_f32 v228, v24, v25
    v_cvt_pk_bf16_f32 v229, v26, v27
    v_cvt_pk_bf16_f32 v230, v28, v29
    v_cvt_pk_bf16_f32 v231, v30, v31
    v_accvgpr_read_b32 v24, a112
    v_accvgpr_read_b32 v25, a113
    v_accvgpr_read_b32 v26, a114
    v_accvgpr_read_b32 v27, a115
    v_accvgpr_read_b32 v28, a116
    v_accvgpr_read_b32 v29, a117
    v_accvgpr_read_b32 v30, a118
    v_accvgpr_read_b32 v31, a119
    v_cvt_pk_bf16_f32 v232, v24, v25
    v_cvt_pk_bf16_f32 v233, v26, v27
    v_cvt_pk_bf16_f32 v234, v28, v29
    v_cvt_pk_bf16_f32 v235, v30, v31
    v_accvgpr_read_b32 v24, a120
    v_accvgpr_read_b32 v25, a121
    v_accvgpr_read_b32 v26, a122
    v_accvgpr_read_b32 v27, a123
    v_accvgpr_read_b32 v28, a124
    v_accvgpr_read_b32 v29, a125
    v_accvgpr_read_b32 v30, a126
    v_accvgpr_read_b32 v31, a127
    v_cvt_pk_bf16_f32 v236, v24, v25
    v_cvt_pk_bf16_f32 v237, v26, v27
    v_cvt_pk_bf16_f32 v238, v28, v29
    v_cvt_pk_bf16_f32 v239, v30, v31
    v_cvt_pk_bf16_f32 v240, v160, v161
    v_cvt_pk_bf16_f32 v241, v162, v163
    v_cvt_pk_bf16_f32 v242, v164, v165
    v_cvt_pk_bf16_f32 v243, v166, v167
    v_cvt_pk_bf16_f32 v244, v168, v169
    v_cvt_pk_bf16_f32 v245, v170, v171
    v_cvt_pk_bf16_f32 v246, v172, v173
    v_cvt_pk_bf16_f32 v247, v174, v175
    v_cvt_pk_bf16_f32 v248, v176, v177
    v_cvt_pk_bf16_f32 v249, v178, v179
    v_cvt_pk_bf16_f32 v250, v180, v181
    v_cvt_pk_bf16_f32 v251, v182, v183
    v_cvt_pk_bf16_f32 v252, v184, v185
    v_cvt_pk_bf16_f32 v253, v186, v187
    v_cvt_pk_bf16_f32 v254, v188, v189
    v_cvt_pk_bf16_f32 v255, v190, v191
    s_setpc_b64 s[20:21]
mega_kernel_end:
.text
.globl gemm3_kernel
.p2align 8
.type gemm3_kernel,@function
gemm3_kernel:
    s_cmp_ge_u32 s2, 256
    s_cbranch_scc1 gemm3_kernel_end1
    s_load_dwordx8 s[4:11], s[0:1], 64
    s_load_dwordx2 s[12:13], s[0:1], 16
    v_and_b32 v1, 63, v0
    v_lshrrev_b32 v16, 6, v0
    s_nop 0
    v_readfirstlane_b32 s32, v16
    s_nop 3
    s_lshr_b32 s36, s32, 2
    s_and_b32 s32, s32, 3
    s_bfe_u32 s35, s2, 0x10002
    s_xor_b32 s35, s35, 1
    s_bfe_u32 s48, s2, 0x10001
    s_lshl_b32 s48, s48, 3
    s_bfe_u32 s49, s2, 0x30003
    s_add_u32 s37, s48, s49
    s_and_b32 s48, s2, 1
    s_lshl_b32 s48, s48, 2
    s_lshr_b32 s49, s2, 6
    s_add_u32 s38, s48, s49
    s_lshr_b32 s33, s32, 1
    s_and_b32 s34, s32, 1
    v_lshlrev_b32 v7, 4, v1
    s_cmp_eq_u32 s36, 1
    s_cbranch_scc1 gemm3_kernel_load2
    s_lshl_b32 s39, s37, 3
    s_add_u32 s39, s39, s38
    s_lshl_b32 s48, s33, 12
    v_add_u32 v2, s48, v7
    v_lshrrev_b32 v16, 2, v1
    v_lshlrev_b32 v16, 8, v16
    v_and_b32 v17, 3, v1
    v_lshl_add_u32 v16, v17, 3, v16
    v_add_u32 v16, 16384, v16
    v_bfe_u32 v17, v1, 2, 3
    s_lshl_b32 s48, s34, 2
    v_xor_b32 v17, s48, v17
    v_xor_b32 v18, 0, v17
    v_lshl_add_u32 v3, v18, 5, v16
    v_xor_b32 v18, 1, v17
    v_lshl_add_u32 v4, v18, 5, v16
    v_xor_b32 v18, 2, v17
    v_lshl_add_u32 v5, v18, 5, v16
    v_xor_b32 v18, 3, v17
    v_lshl_add_u32 v6, v18, 5, v16
    s_mov_b32 s43, 0
    s_mov_b32 s56, 32768
    s_cmp_eq_u32 s35, 1
    s_cselect_b32 s47, 38, 40
    v_mov_b32 v32, 0
    v_mov_b32 v33, 0
    v_mov_b32 v34, 0
    v_mov_b32 v35, 0
    v_mov_b32 v36, 0
    v_mov_b32 v37, 0
    v_mov_b32 v38, 0
    v_mov_b32 v39, 0
    v_mov_b32 v40, 0
    v_mov_b32 v41, 0
    v_mov_b32 v42, 0
    v_mov_b32 v43, 0
    v_mov_b32 v44, 0
    v_mov_b32 v45, 0
    v_mov_b32 v46, 0
    v_mov_b32 v47, 0
    v_mov_b32 v48, 0
    v_mov_b32 v49, 0
    v_mov_b32 v50, 0
    v_mov_b32 v51, 0
    v_mov_b32 v52, 0
    v_mov_b32 v53, 0
    v_mov_b32 v54, 0
    v_mov_b32 v55, 0
    v_mov_b32 v56, 0
    v_mov_b32 v57, 0
    v_mov_b32 v58, 0
    v_mov_b32 v59, 0
    v_mov_b32 v60, 0
    v_mov_b32 v61, 0
    v_mov_b32 v62, 0
    v_mov_b32 v63, 0
    v_mov_b32 v64, 0
    v_mov_b32 v65, 0
    v_mov_b32 v66, 0
    v_mov_b32 v67, 0
    v_mov_b32 v68, 0
    v_mov_b32 v69, 0
    v_mov_b32 v70, 0
    v_mov_b32 v71, 0
    v_mov_b32 v72, 0
    v_mov_b32 v73, 0
    v_mov_b32 v74, 0
    v_mov_b32 v75, 0
    v_mov_b32 v76, 0
    v_mov_b32 v77, 0
    v_mov_b32 v78, 0
    v_mov_b32 v79, 0
    v_mov_b32 v80, 0
    v_mov_b32 v81, 0
    v_mov_b32 v82, 0
    v_mov_b32 v83, 0
    v_mov_b32 v84, 0
    v_mov_b32 v85, 0
    v_mov_b32 v86, 0
    v_mov_b32 v87, 0
    v_mov_b32 v88, 0
    v_mov_b32 v89, 0
    v_mov_b32 v90, 0
    v_mov_b32 v91, 0
    v_mov_b32 v92, 0
    v_mov_b32 v93, 0
    v_mov_b32 v94, 0
    v_mov_b32 v95, 0
    v_and_b32 v16, 15, v1
    v_lshlrev_b32 v16, 12, v16
    v_lshlrev_b32 v16, s35, v16
    v_bfe_u32 v17, v1, 4, 1
    v_lshl_add_u32 v16, v17, 5, v16
    v_lshrrev_b32 v17, 5, v1
    v_lshl_add_u32 v12, v17, 4, v16
    s_lshl_b32 s48, s37, 3
    s_lshl_b32 s49, s33, 2
    s_add_u32 s48, s48, s49
    s_lshl_b32 s49, s48, 16
    s_add_u32 s49, s49, 2048
    s_and_b32 s50, s48, 63
    s_lshl_b32 s50, s50, 17
    s_lshr_b32 s51, s48, 6
    s_lshl_b32 s51, s51, 12
    s_add_u32 s50, s50, s51
    s_cmp_eq_u32 s35, 1
    s_cselect_b32 s41, s50, s49
    s_lshl_b32 s42, 0x10000, s35
    s_lshl_b32 s50, s38, 8
    s_lshl_b32 s51, s34, 7
    s_add_u32 s41, s41, s50
    s_add_u32 s41, s41, s51
    s_cmp_eq_u32 s35, 1
    s_cselect_b32 s57, 23, 35
    s_cselect_b32 s58, 0, 16
    s_waitcnt lgkmcnt(0)
    s_mov_b32 s24, s6
    s_mov_b32 s25, s7
    s_mov_b32 s27, 0x20000
    s_mov_b32 s26, 8388608
    s_mov_b32 s28, s10
    s_mov_b32 s29, s11
    s_mov_b32 s31, 0x20000
    s_mov_b32 s30, 268435456
    s_setprio 1
    s_barrier
    ds_read_b128 v[96:99], v2 offset:0
    ds_read_b64_tr_b16 v[112:113], v3 offset:0
    ds_read_b64_tr_b16 v[114:115], v3 offset:4096
    ds_read_b128 v[100:103], v2 offset:1024
    ds_read_b128 v[104:107], v2 offset:2048
    ds_read_b128 v[108:111], v2 offset:3072
    ds_read_b64_tr_b16 v[116:117], v4 offset:0
    ds_read_b64_tr_b16 v[118:119], v4 offset:4096
    ds_read_b64_tr_b16 v[120:121], v5 offset:0
    ds_read_b64_tr_b16 v[122:123], v5 offset:4096
    ds_read_b64_tr_b16 v[124:125], v6 offset:0
    ds_read_b64_tr_b16 v[126:127], v6 offset:4096
gemm3_kernel_loop3:
    s_sub_u32 s57, s57, 1
    s_cbranch_scc1 gemm3_kernel_ev4
gemm3_kernel_back5:
    s_waitcnt lgkmcnt(9)
    v_mfma_f32_16x16x32_bf16 v[32:35], v[112:115], v[96:99], v[32:35]
    ds_read_b128 v[128:131], v2 offset:8192
    s_waitcnt lgkmcnt(9)
    v_mfma_f32_16x16x32_bf16 v[40:43], v[112:115], v[100:103], v[40:43]
    ds_read_b64_tr_b16 v[144:145], v3 offset:8192
    s_waitcnt lgkmcnt(9)
    v_mfma_f32_16x16x32_bf16 v[48:51], v[112:115], v[104:107], v[48:51]
    ds_read_b64_tr_b16 v[146:147], v3 offset:12288
    s_waitcnt lgkmcnt(9)
    v_mfma_f32_16x16x32_bf16 v[56:59], v[112:115], v[108:111], v[56:59]
    ds_read_b128 v[132:135], v2 offset:9216
    s_waitcnt lgkmcnt(8)
    v_mfma_f32_16x16x32_bf16 v[36:39], v[116:119], v[96:99], v[36:39]
    ds_read_b128 v[136:139], v2 offset:10240
    v_mfma_f32_16x16x32_bf16 v[44:47], v[116:119], v[100:103], v[44:47]
    ds_read_b128 v[140:143], v2 offset:11264
    v_mfma_f32_16x16x32_bf16 v[52:55], v[116:119], v[104:107], v[52:55]
    ds_read_b64_tr_b16 v[148:149], v4 offset:8192
    v_mfma_f32_16x16x32_bf16 v[60:63], v[116:119], v[108:111], v[60:63]
    ds_read_b64_tr_b16 v[150:151], v4 offset:12288
    s_waitcnt lgkmcnt(10)
    v_mfma_f32_16x16x32_bf16 v[64:67], v[120:123], v[96:99], v[64:67]
    s_add_u32 s43, s43, 32768
    ds_read_b64_tr_b16 v[152:153], v5 offset:8192
    v_mfma_f32_16x16x32_bf16 v[72:75], v[120:123], v[100:103], v[72:75]
    s_cmp_ge_u32 s43, 163840
    ds_read_b64_tr_b16 v[154:155], v5 offset:12288
    v_mfma_f32_16x16x32_bf16 v[80:83], v[120:123], v[104:107], v[80:83]
    s_cselect_b32 s46, 4294836224, s56
    ds_read_b64_tr_b16 v[156:157], v6 offset:8192
    v_mfma_f32_16x16x32_bf16 v[88:91], v[120:123], v[108:111], v[88:91]
    s_cselect_b32 s43, 0, s43
    ds_read_b64_tr_b16 v[158:159], v6 offset:12288
    s_waitcnt lgkmcnt(12)
    v_mfma_f32_16x16x32_bf16 v[68:71], v[124:127], v[96:99], v[68:71]
    v_add_u32 v2, s46, v2
    v_add_u32 v3, s46, v3
    v_mfma_f32_16x16x32_bf16 v[76:79], v[124:127], v[100:103], v[76:79]
    v_add_u32 v4, s46, v4
    v_add_u32 v5, s46, v5
    v_mfma_f32_16x16x32_bf16 v[84:87], v[124:127], v[104:107], v[84:87]
    v_add_u32 v6, s46, v6
    v_mfma_f32_16x16x32_bf16 v[92:95], v[124:127], v[108:111], v[92:95]
    s_waitcnt lgkmcnt(0)
    v_mfma_f32_16x16x32_bf16 v[32:35], v[144:147], v[128:131], v[32:35]
    s_barrier
    v_mfma_f32_16x16x32_bf16 v[40:43], v[144:147], v[132:135], v[40:43]
    ds_read_b128 v[96:99], v2 offset:0
    v_mfma_f32_16x16x32_bf16 v[48:51], v[144:147], v[136:139], v[48:51]
    ds_read_b64_tr_b16 v[112:113], v3 offset:0
    v_mfma_f32_16x16x32_bf16 v[56:59], v[144:147], v[140:143], v[56:59]
    ds_read_b64_tr_b16 v[114:115], v3 offset:4096
    v_mfma_f32_16x16x32_bf16 v[36:39], v[148:151], v[128:131], v[36:39]
    ds_read_b128 v[100:103], v2 offset:1024
    v_mfma_f32_16x16x32_bf16 v[44:47], v[148:151], v[132:135], v[44:47]
    ds_read_b128 v[104:107], v2 offset:2048
    v_mfma_f32_16x16x32_bf16 v[52:55], v[148:151], v[136:139], v[52:55]
    ds_read_b128 v[108:111], v2 offset:3072
    v_mfma_f32_16x16x32_bf16 v[60:63], v[148:151], v[140:143], v[60:63]
    ds_read_b64_tr_b16 v[116:117], v4 offset:0
    v_mfma_f32_16x16x32_bf16 v[64:67], v[152:155], v[128:131], v[64:67]
    ds_read_b64_tr_b16 v[118:119], v4 offset:4096
    v_mfma_f32_16x16x32_bf16 v[72:75], v[152:155], v[132:135], v[72:75]
    ds_read_b64_tr_b16 v[120:121], v5 offset:0
    v_mfma_f32_16x16x32_bf16 v[80:83], v[152:155], v[136:139], v[80:83]
    ds_read_b64_tr_b16 v[122:123], v5 offset:4096
    v_mfma_f32_16x16x32_bf16 v[88:91], v[152:155], v[140:143], v[88:91]
    ds_read_b64_tr_b16 v[124:125], v6 offset:0
    v_mfma_f32_16x16x32_bf16 v[68:71], v[156:159], v[128:131], v[68:71]
    ds_read_b64_tr_b16 v[126:127], v6 offset:4096
    v_mfma_f32_16x16x32_bf16 v[76:79], v[156:159], v[132:135], v[76:79]
    v_mfma_f32_16x16x32_bf16 v[84:87], v[156:159], v[136:139], v[84:87]
    s_sub_u32 s47, s47, 1
    v_mfma_f32_16x16x32_bf16 v[92:95], v[156:159], v[140:143], v[92:95]
    s_cbranch_scc0 gemm3_kernel_loop3
    s_nop 5
    s_cmp_eq_u32 s35, 1
    s_cbranch_scc1 gemm3_kernel_noadd7
    s_waitcnt vmcnt(0) lgkmcnt(0)
    v_lshlrev_b32 v96, 16, v160
    v_and_b32 v97, 0xffff0000, v160
    v_lshlrev_b32 v98, 16, v161
    v_and_b32 v99, 0xffff0000, v161
    v_lshlrev_b32 v100, 16, v162
    v_and_b32 v101, 0xffff0000, v162
    v_lshlrev_b32 v102, 16, v163
    v_and_b32 v103, 0xffff0000, v163
    v_lshlrev_b32 v104, 16, v164
    v_and_b32 v105, 0xffff0000, v164
    v_lshlrev_b32 v106, 16, v165
    v_and_b32 v107, 0xffff0000, v165
    v_lshlrev_b32 v108, 16, v166
    v_and_b32 v109, 0xffff0000, v166
    v_lshlrev_b32 v110, 16, v167
    v_and_b32 v111, 0xffff0000, v167
    v_lshlrev_b32 v112, 16, v168
    v_and_b32 v113, 0xffff0000, v168
    v_lshlrev_b32 v114, 16, v169
    v_and_b32 v115, 0xffff0000, v169
    v_lshlrev_b32 v116, 16, v170
    v_and_b32 v117, 0xffff0000, v170
    v_lshlrev_b32 v118, 16, v171
    v_and_b32 v119, 0xffff0000, v171
    v_lshlrev_b32 v120, 16, v172
    v_and_b32 v121, 0xffff0000, v172
    v_lshlrev_b32 v122, 16, v173
    v_and_b32 v123, 0xffff0000, v173
    v_lshlrev_b32 v124, 16, v174
    v_and_b32 v125, 0xffff0000, v174
    v_lshlrev_b32 v126, 16, v175
    v_and_b32 v127, 0xffff0000, v175
    v_lshlrev_b32 v128, 16, v176
    v_and_b32 v129, 0xffff0000, v176
    v_lshlrev_b32 v130, 16, v177
    v_and_b32 v131, 0xffff0000, v177
    v_lshlrev_b32 v132, 16, v178
    v_and_b32 v133, 0xffff0000, v178
    v_lshlrev_b32 v134, 16, v179
    v_and_b32 v135, 0xffff0000, v179
    v_lshlrev_b32 v136, 16, v180
    v_and_b32 v137, 0xffff0000, v180
    v_lshlrev_b32 v138, 16, v181
    v_and_b32 v139, 0xffff0000, v181
    v_lshlrev_b32 v140, 16, v182
    v_and_b32 v141, 0xffff0000, v182
    v_lshlrev_b32 v142, 16, v183
    v_and_b32 v143, 0xffff0000, v183
    v_lshlrev_b32 v144, 16, v184
    v_and_b32 v145, 0xffff0000, v184
    v_lshlrev_b32 v146, 16, v185
    v_and_b32 v147, 0xffff0000, v185
    v_lshlrev_b32 v148, 16, v186
    v_and_b32 v149, 0xffff0000, v186
    v_lshlrev_b32 v150, 16, v187
    v_and_b32 v151, 0xffff0000, v187
    v_lshlrev_b32 v152, 16, v188
    v_and_b32 v153, 0xffff0000, v188
    v_lshlrev_b32 v154, 16, v189
    v_and_b32 v155, 0xffff0000, v189
    v_lshlrev_b32 v156, 16, v190
    v_and_b32 v157, 0xffff0000, v190
    v_lshlrev_b32 v158, 16, v191
    v_and_b32 v159, 0xffff0000, v191
    v_pk_add_f32 v[32:33], v[32:33], v[96:97]
    v_pk_add_f32 v[34:35], v[34:35], v[98:99]
    v_pk_add_f32 v[36:37], v[36:37], v[100:101]
    v_pk_add_f32 v[38:39], v[38:39], v[102:103]
    v_pk_add_f32 v[40:41], v[40:41], v[104:105]
    v_pk_add_f32 v[42:43], v[42:43], v[106:107]
    v_pk_add_f32 v[44:45], v[44:45], v[108:109]
    v_pk_add_f32 v[46:47], v[46:47], v[110:111]
    v_pk_add_f32 v[48:49], v[48:49], v[112:113]
    v_pk_add_f32 v[50:51], v[50:51], v[114:115]
    v_pk_add_f32 v[52:53], v[52:53], v[116:117]
    v_pk_add_f32 v[54:55], v[54:55], v[118:119]
    v_pk_add_f32 v[56:57], v[56:57], v[120:121]
    v_pk_add_f32 v[58:59], v[58:59], v[122:123]
    v_pk_add_f32 v[60:61], v[60:61], v[124:125]
    v_pk_add_f32 v[62:63], v[62:63], v[126:127]
    v_pk_add_f32 v[64:65], v[64:65], v[128:129]
    v_pk_add_f32 v[66:67], v[66:67], v[130:131]
    v_pk_add_f32 v[68:69], v[68:69], v[132:133]
    v_pk_add_f32 v[70:71], v[70:71], v[134:135]
    v_pk_add_f32 v[72:73], v[72:73], v[136:137]
    v_pk_add_f32 v[74:75], v[74:75], v[138:139]
    v_pk_add_f32 v[76:77], v[76:77], v[140:141]
    v_pk_add_f32 v[78:79], v[78:79], v[142:143]
    v_pk_add_f32 v[80:81], v[80:81], v[144:145]
    v_pk_add_f32 v[82:83], v[82:83], v[146:147]
    v_pk_add_f32 v[84:85], v[84:85], v[148:149]
    v_pk_add_f32 v[86:87], v[86:87], v[150:151]
    v_pk_add_f32 v[88:89], v[88:89], v[152:153]
    v_pk_add_f32 v[90:91], v[90:91], v[154:155]
    v_pk_add_f32 v[92:93], v[92:93], v[156:157]
    v_pk_add_f32 v[94:95], v[94:95], v[158:159]
gemm3_kernel_noadd7:
    v_cvt_pk_bf16_f32 v32, v32, v33
    v_cvt_pk_bf16_f32 v33, v34, v35
    v_cvt_pk_bf16_f32 v34, v36, v37
    v_cvt_pk_bf16_f32 v35, v38, v39
    v_cvt_pk_bf16_f32 v64, v64, v65
    v_cvt_pk_bf16_f32 v65, v66, v67
    v_cvt_pk_bf16_f32 v66, v68, v69
    v_cvt_pk_bf16_f32 v67, v70, v71
    s_nop 1
    v_permlane16_swap_b32 v32, v34
    v_permlane16_swap_b32 v33, v35
    v_permlane16_swap_b32 v64, v66
    v_permlane16_swap_b32 v65, v67
    buffer_store_dwordx4 v[32:35], v12, s[24:27], s41 offen offset:0 sc1
    buffer_store_dwordx4 v[64:67], v12, s[24:27], s41 offen offset:64 sc1
    s_add_u32 s41, s41, s42
    v_cvt_pk_bf16_f32 v40, v40, v41
    v_cvt_pk_bf16_f32 v41, v42, v43
    v_cvt_pk_bf16_f32 v42, v44, v45
    v_cvt_pk_bf16_f32 v43, v46, v47
    v_cvt_pk_bf16_f32 v72, v72, v73
    v_cvt_pk_bf16_f32 v73, v74, v75
    v_cvt_pk_bf16_f32 v74, v76, v77
    v_cvt_pk_bf16_f32 v75, v78, v79
    s_nop 1
    v_permlane16_swap_b32 v40, v42
    v_permlane16_swap_b32 v41, v43
    v_permlane16_swap_b32 v72, v74
    v_permlane16_swap_b32 v73, v75
    buffer_store_dwordx4 v[40:43], v12, s[24:27], s41 offen offset:0 sc1
    buffer_store_dwordx4 v[72:75], v12, s[24:27], s41 offen offset:64 sc1
    s_add_u32 s41, s41, s42
    v_cvt_pk_bf16_f32 v48, v48, v49
    v_cvt_pk_bf16_f32 v49, v50, v51
    v_cvt_pk_bf16_f32 v50, v52, v53
    v_cvt_pk_bf16_f32 v51, v54, v55
    v_cvt_pk_bf16_f32 v80, v80, v81
    v_cvt_pk_bf16_f32 v81, v82, v83
    v_cvt_pk_bf16_f32 v82, v84, v85
    v_cvt_pk_bf16_f32 v83, v86, v87
    s_nop 1
    v_permlane16_swap_b32 v48, v50
    v_permlane16_swap_b32 v49, v51
    v_permlane16_swap_b32 v80, v82
    v_permlane16_swap_b32 v81, v83
    buffer_store_dwordx4 v[48:51], v12, s[24:27], s41 offen offset:0 sc1
    buffer_store_dwordx4 v[80:83], v12, s[24:27], s41 offen offset:64 sc1
    s_add_u32 s41, s41, s42
    v_cvt_pk_bf16_f32 v56, v56, v57
    v_cvt_pk_bf16_f32 v57, v58, v59
    v_cvt_pk_bf16_f32 v58, v60, v61
    v_cvt_pk_bf16_f32 v59, v62, v63
    v_cvt_pk_bf16_f32 v88, v88, v89
    v_cvt_pk_bf16_f32 v89, v90, v91
    v_cvt_pk_bf16_f32 v90, v92, v93
    v_cvt_pk_bf16_f32 v91, v94, v95
    s_nop 1
    v_permlane16_swap_b32 v56, v58
    v_permlane16_swap_b32 v57, v59
    v_permlane16_swap_b32 v88, v90
    v_permlane16_swap_b32 v89, v91
    buffer_store_dwordx4 v[56:59], v12, s[24:27], s41 offen offset:0 sc1
    buffer_store_dwordx4 v[88:91], v12, s[24:27], s41 offen offset:64 sc1
    s_add_u32 s41, s41, s42
gemm3_kernel_end1:
    s_endpgm
gemm3_kernel_ev4:
    s_cmp_lg_u32 s58, 16
    s_cbranch_scc1 gemm3_kernel_n8
    s_lshl_b32 s48, s39, 7
    s_add_u32 s48, s48, 117506048
    buffer_load_dword v14, off, s[28:31], s48 sc1
    s_mov_b32 s57, 1
    s_mov_b32 s58, 17
    s_branch gemm3_kernel_back5
gemm3_kernel_n8:
    s_cmp_lg_u32 s58, 17
    s_cbranch_scc1 gemm3_kernel_n9
    s_waitcnt vmcnt(0)
    s_mov_b32 s3, 1048576
gemm3_kernel_spin10:
    v_readfirstlane_b32 s49, v14
    s_nop 3
    s_cmp_lg_u32 s49, 0
    s_cbranch_scc1 gemm3_kernel_ok11
    s_sub_u32 s3, s3, 1
    s_cbranch_scc1 gemm3_kernel_ok11
    s_sleep 8
    s_lshl_b32 s48, s39, 7
    s_add_u32 s48, s48, 117506048
    buffer_load_dword v14, off, s[28:31], s48 sc1
    s_waitcnt vmcnt(0)
    s_branch gemm3_kernel_spin10
gemm3_kernel_ok11:
    s_lshl_b32 s48, s39, 16
    s_lshl_b32 s49, s32, 14
    s_add_u32 s48, s48, s49
    s_add_u32 s48, s48, 100663296
    buffer_load_dwordx4 v[160:163], v7, s[28:31], s48 offen offset:0 sc1
    buffer_load_dwordx4 v[164:167], v7, s[28:31], s48 offen offset:1024 sc1
    buffer_load_dwordx4 v[168:171], v7, s[28:31], s48 offen offset:2048 sc1
    buffer_load_dwordx4 v[172:175], v7, s[28:31], s48 offen offset:3072 sc1
    s_add_u32 s48, s48, 4096
    buffer_load_dwordx4 v[176:179], v7, s[28:31], s48 offen offset:0 sc1
    buffer_load_dwordx4 v[180:183], v7, s[28:31], s48 offen offset:1024 sc1
    buffer_load_dwordx4 v[184:187], v7, s[28:31], s48 offen offset:2048 sc1
    buffer_load_dwordx4 v[188:191], v7, s[28:31], s48 offen offset:3072 sc1
    s_add_u32 s48, s48, 4096
    s_mov_b32 s57, 1000
    s_mov_b32 s58, 18
    s_branch gemm3_kernel_back5
gemm3_kernel_n9:
    s_cmp_lg_u32 s58, 0
    s_cbranch_scc1 gemm3_kernel_n12
    s_lshl_b32 s48, s39, 16
    s_lshl_b32 s49, s32, 14
    s_add_u32 s48, s48, s49
    s_add_u32 s48, s48, 100663296
    s_mov_b32 s59, s48
    s_nop 3
    v_cvt_pk_bf16_f32 v160, v32, v33
    v_cvt_pk_bf16_f32 v161, v34, v35
    v_cvt_pk_bf16_f32 v162, v36, v37
    v_cvt_pk_bf16_f32 v163, v38, v39
    v_cvt_pk_bf16_f32 v164, v40, v41
    v_cvt_pk_bf16_f32 v165, v42, v43
    v_cvt_pk_bf16_f32 v166, v44, v45
    v_cvt_pk_bf16_f32 v167, v46, v47
    v_cvt_pk_bf16_f32 v168, v48, v49
    v_cvt_pk_bf16_f32 v169, v50, v51
    v_cvt_pk_bf16_f32 v170, v52, v53
    v_cvt_pk_bf16_f32 v171, v54, v55
    v_cvt_pk_bf16_f32 v172, v56, v57
    v_cvt_pk_bf16_f32 v173, v58, v59
    v_cvt_pk_bf16_f32 v174, v60, v61
    v_cvt_pk_bf16_f32 v175, v62, v63
    v_cvt_pk_bf16_f32 v176, v64, v65
    v_cvt_pk_bf16_f32 v177, v66, v67
    v_cvt_pk_bf16_f32 v178, v68, v69
    v_cvt_pk_bf16_f32 v179, v70, v71
    v_cvt_pk_bf16_f32 v180, v72, v73
    v_cvt_pk_bf16_f32 v181, v74, v75
    v_cvt_pk_bf16_f32 v182, v76, v77
    v_cvt_pk_bf16_f32 v183, v78, v79
    v_cvt_pk_bf16_f32 v184, v80, v81
    v_cvt_pk_bf16_f32 v185, v82, v83
    v_cvt_pk_bf16_f32 v186, v84, v85
    v_cvt_pk_bf16_f32 v187, v86, v87
    v_cvt_pk_bf16_f32 v188, v88, v89
    v_cvt_pk_bf16_f32 v189, v90, v91
    v_cvt_pk_bf16_f32 v190, v92, v93
    v_cvt_pk_bf16_f32 v191, v94, v95
    v_mov_b64 v[32:33], 0
    v_mov_b64 v[34:35], 0
    v_mov_b64 v[36:37], 0
    v_mov_b64 v[38:39], 0
    v_mov_b64 v[40:41], 0
    v_mov_b64 v[42:43], 0
    v_mov_b64 v[44:45], 0
    v_mov_b64 v[46:47], 0
    v_mov_b64 v[48:49], 0
    v_mov_b64 v[50:51], 0
    v_mov_b64 v[52:53], 0
    v_mov_b64 v[54:55], 0
    v_mov_b64 v[56:57], 0
    v_mov_b64 v[58:59], 0
    v_mov_b64 v[60:61], 0
    v_mov_b64 v[62:63], 0
    v_mov_b64 v[64:65], 0
    v_mov_b64 v[66:67], 0
    v_mov_b64 v[68:69], 0
    v_mov_b64 v[70:71], 0
    v_mov_b64 v[72:73], 0
    v_mov_b64 v[74:75], 0
    v_mov_b64 v[76:77], 0
    v_mov_b64 v[78:79], 0
    v_mov_b64 v[80:81], 0
    v_mov_b64 v[82:83], 0
    v_mov_b64 v[84:85], 0
    v_mov_b64 v[86:87], 0
    v_mov_b64 v[88:89], 0
    v_mov_b64 v[90:91], 0
    v_mov_b64 v[92:93], 0
    v_mov_b64 v[94:95], 0
    s_nop 1
    s_waitcnt lgkmcnt(9)
    v_mfma_f32_16x16x32_bf16 v[32:35], v[112:115], v[96:99], v[32:35]
    ds_read_b128 v[128:131], v2 offset:8192
    s_waitcnt lgkmcnt(9)
    v_mfma_f32_16x16x32_bf16 v[40:43], v[112:115], v[100:103], v[40:43]
    ds_read_b64_tr_b16 v[144:145], v3 offset:8192
    s_waitcnt lgkmcnt(9)
    v_mfma_f32_16x16x32_bf16 v[48:51], v[112:115], v[104:107], v[48:51]
    ds_read_b64_tr_b16 v[146:147], v3 offset:12288
    s_waitcnt lgkmcnt(9)
    v_mfma_f32_16x16x32_bf16 v[56:59], v[112:115], v[108:111], v[56:59]
    ds_read_b128 v[132:135], v2 offset:9216
    s_waitcnt lgkmcnt(8)
    v_mfma_f32_16x16x32_bf16 v[36:39], v[116:119], v[96:99], v[36:39]
    ds_read_b128 v[136:139], v2 offset:10240
    v_mfma_f32_16x16x32_bf16 v[44:47], v[116:119], v[100:103], v[44:47]
    ds_read_b128 v[140:143], v2 offset:11264
    v_mfma_f32_16x16x32_bf16 v[52:55], v[116:119], v[104:107], v[52:55]
    ds_read_b64_tr_b16 v[148:149], v4 offset:8192
    v_mfma_f32_16x16x32_bf16 v[60:63], v[116:119], v[108:111], v[60:63]
    ds_read_b64_tr_b16 v[150:151], v4 offset:12288
    s_waitcnt lgkmcnt(10)
    v_mfma_f32_16x16x32_bf16 v[64:67], v[120:123], v[96:99], v[64:67]
    s_add_u32 s43, s43, 32768
    ds_read_b64_tr_b16 v[152:153], v5 offset:8192
    v_mfma_f32_16x16x32_bf16 v[72:75], v[120:123], v[100:103], v[72:75]
    s_cmp_ge_u32 s43, 163840
    ds_read_b64_tr_b16 v[154:155], v5 offset:12288
    v_mfma_f32_16x16x32_bf16 v[80:83], v[120:123], v[104:107], v[80:83]
    s_cselect_b32 s46, 4294836224, s56
    ds_read_b64_tr_b16 v[156:157], v6 offset:8192
    v_mfma_f32_16x16x32_bf16 v[88:91], v[120:123], v[108:111], v[88:91]
    s_cselect_b32 s43, 0, s43
    ds_read_b64_tr_b16 v[158:159], v6 offset:12288
    s_waitcnt lgkmcnt(12)
    v_mfma_f32_16x16x32_bf16 v[68:71], v[124:127], v[96:99], v[68:71]
    v_add_u32 v2, s46, v2
    v_add_u32 v3, s46, v3
    v_mfma_f32_16x16x32_bf16 v[76:79], v[124:127], v[100:103], v[76:79]
    v_add_u32 v4, s46, v4
    v_add_u32 v5, s46, v5
    v_mfma_f32_16x16x32_bf16 v[84:87], v[124:127], v[104:107], v[84:87]
    v_add_u32 v6, s46, v6
    v_mfma_f32_16x16x32_bf16 v[92:95], v[124:127], v[108:111], v[92:95]
    buffer_store_dwordx4 v[160:163], v7, s[28:31], s59 offen offset:0 sc1
    s_waitcnt lgkmcnt(0)
    v_mfma_f32_16x16x32_bf16 v[32:35], v[144:147], v[128:131], v[32:35]
    s_barrier
    v_mfma_f32_16x16x32_bf16 v[40:43], v[144:147], v[132:135], v[40:43]
    ds_read_b128 v[96:99], v2 offset:0
    v_mfma_f32_16x16x32_bf16 v[48:51], v[144:147], v[136:139], v[48:51]
    ds_read_b64_tr_b16 v[112:113], v3 offset:0
    v_mfma_f32_16x16x32_bf16 v[56:59], v[144:147], v[140:143], v[56:59]
    ds_read_b64_tr_b16 v[114:115], v3 offset:4096
    v_mfma_f32_16x16x32_bf16 v[36:39], v[148:151], v[128:131], v[36:39]
    ds_read_b128 v[100:103], v2 offset:1024
    v_mfma_f32_16x16x32_bf16 v[44:47], v[148:151], v[132:135], v[44:47]
    ds_read_b128 v[104:107], v2 offset:2048
    v_mfma_f32_16x16x32_bf16 v[52:55], v[148:151], v[136:139], v[52:55]
    ds_read_b128 v[108:111], v2 offset:3072
    v_mfma_f32_16x16x32_bf16 v[60:63], v[148:151], v[140:143], v[60:63]
    ds_read_b64_tr_b16 v[116:117], v4 offset:0
    v_mfma_f32_16x16x32_bf16 v[64:67], v[152:155], v[128:131], v[64:67]
    ds_read_b64_tr_b16 v[118:119], v4 offset:4096
    v_mfma_f32_16x16x32_bf16 v[72:75], v[152:155], v[132:135], v[72:75]
    ds_read_b64_tr_b16 v[120:121], v5 offset:0
    v_mfma_f32_16x16x32_bf16 v[80:83], v[152:155], v[136:139], v[80:83]
    ds_read_b64_tr_b16 v[122:123], v5 offset:4096
    v_mfma_f32_16x16x32_bf16 v[88:91], v[152:155], v[140:143], v[88:91]
    ds_read_b64_tr_b16 v[124:125], v6 offset:0
    v_mfma_f32_16x16x32_bf16 v[68:71], v[156:159], v[128:131], v[68:71]
    ds_read_b64_tr_b16 v[126:127], v6 offset:4096
    v_mfma_f32_16x16x32_bf16 v[76:79], v[156:159], v[132:135], v[76:79]
    buffer_store_dwordx4 v[164:167], v7, s[28:31], s59 offen offset:1024 sc1
    v_mfma_f32_16x16x32_bf16 v[84:87], v[156:159], v[136:139], v[84:87]
    s_sub_u32 s47, s47, 1
    v_mfma_f32_16x16x32_bf16 v[92:95], v[156:159], v[140:143], v[92:95]
    s_waitcnt lgkmcnt(9)
    v_mfma_f32_16x16x32_bf16 v[32:35], v[112:115], v[96:99], v[32:35]
    ds_read_b128 v[128:131], v2 offset:8192
    s_waitcnt lgkmcnt(9)
    v_mfma_f32_16x16x32_bf16 v[40:43], v[112:115], v[100:103], v[40:43]
    ds_read_b64_tr_b16 v[144:145], v3 offset:8192
    s_waitcnt lgkmcnt(9)
    v_mfma_f32_16x16x32_bf16 v[48:51], v[112:115], v[104:107], v[48:51]
    ds_read_b64_tr_b16 v[146:147], v3 offset:12288
    s_waitcnt lgkmcnt(9)
    v_mfma_f32_16x16x32_bf16 v[56:59], v[112:115], v[108:111], v[56:59]
    ds_read_b128 v[132:135], v2 offset:9216
    s_waitcnt lgkmcnt(8)
    v_mfma_f32_16x16x32_bf16 v[36:39], v[116:119], v[96:99], v[36:39]
    ds_read_b128 v[136:139], v2 offset:10240
    v_mfma_f32_16x16x32_bf16 v[44:47], v[116:119], v[100:103], v[44:47]
    ds_read_b128 v[140:143], v2 offset:11264
    v_mfma_f32_16x16x32_bf16 v[52:55], v[116:119], v[104:107], v[52:55]
    ds_read_b64_tr_b16 v[148:149], v4 offset:8192
    v_mfma_f32_16x16x32_bf16 v[60:63], v[116:119], v[108:111], v[60:63]
    ds_read_b64_tr_b16 v[150:151], v4 offset:12288
    s_waitcnt lgkmcnt(10)
    v_mfma_f32_16x16x32_bf16 v[64:67], v[120:123], v[96:99], v[64:67]
    s_add_u32 s43, s43, 32768
    ds_read_b64_tr_b16 v[152:153], v5 offset:8192
    v_mfma_f32_16x16x32_bf16 v[72:75], v[120:123], v[100:103], v[72:75]
    s_cmp_ge_u32 s43, 163840
    ds_read_b64_tr_b16 v[154:155], v5 offset:12288
    v_mfma_f32_16x16x32_bf16 v[80:83], v[120:123], v[104:107], v[80:83]
    s_cselect_b32 s46, 4294836224, s56
    ds_read_b64_tr_b16 v[156:157], v6 offset:8192
    v_mfma_f32_16x16x32_bf16 v[88:91], v[120:123], v[108:111], v[88:91]
    s_cselect_b32 s43, 0, s43
    ds_read_b64_tr_b16 v[158:159], v6 offset:12288
    s_waitcnt lgkmcnt(12)
    v_mfma_f32_16x16x32_bf16 v[68:71], v[124:127], v[96:99], v[68:71]
    v_add_u32 v2, s46, v2
    v_add_u32 v3, s46, v3
    v_mfma_f32_16x16x32_bf16 v[76:79], v[124:127], v[100:103], v[76:79]
    v_add_u32 v4, s46, v4
    v_add_u32 v5, s46, v5
    v_mfma_f32_16x16x32_bf16 v[84:87], v[124:127], v[104:107], v[84:87]
    v_add_u32 v6, s46, v6
    v_mfma_f32_16x16x32_bf16 v[92:95], v[124:127], v[108:111], v[92:95]
    buffer_store_dwordx4 v[168:171], v7, s[28:31], s59 offen offset:2048 sc1
    s_waitcnt lgkmcnt(0)
    v_mfma_f32_16x16x32_bf16 v[32:35], v[144:147], v[128:131], v[32:35]
    s_barrier
    v_mfma_f32_16x16x32_bf16 v[40:43], v[144:147], v[132:135], v[40:43]
    ds_read_b128 v[96:99], v2 offset:0
    v_mfma_f32_16x16x32_bf16 v[48:51], v[144:147], v[136:139], v[48:51]
    ds_read_b64_tr_b16 v[112:113], v3 offset:0
    v_mfma_f32_16x16x32_bf16 v[56:59], v[144:147], v[140:143], v[56:59]
    ds_read_b64_tr_b16 v[114:115], v3 offset:4096
    v_mfma_f32_16x16x32_bf16 v[36:39], v[148:151], v[128:131], v[36:39]
    ds_read_b128 v[100:103], v2 offset:1024
    v_mfma_f32_16x16x32_bf16 v[44:47], v[148:151], v[132:135], v[44:47]
    ds_read_b128 v[104:107], v2 offset:2048
    v_mfma_f32_16x16x32_bf16 v[52:55], v[148:151], v[136:139], v[52:55]
    ds_read_b128 v[108:111], v2 offset:3072
    v_mfma_f32_16x16x32_bf16 v[60:63], v[148:151], v[140:143], v[60:63]
    ds_read_b64_tr_b16 v[116:117], v4 offset:0
    v_mfma_f32_16x16x32_bf16 v[64:67], v[152:155], v[128:131], v[64:67]
    ds_read_b64_tr_b16 v[118:119], v4 offset:4096
    v_mfma_f32_16x16x32_bf16 v[72:75], v[152:155], v[132:135], v[72:75]
    ds_read_b64_tr_b16 v[120:121], v5 offset:0
    v_mfma_f32_16x16x32_bf16 v[80:83], v[152:155], v[136:139], v[80:83]
    ds_read_b64_tr_b16 v[122:123], v5 offset:4096
    v_mfma_f32_16x16x32_bf16 v[88:91], v[152:155], v[140:143], v[88:91]
    ds_read_b64_tr_b16 v[124:125], v6 offset:0
    v_mfma_f32_16x16x32_bf16 v[68:71], v[156:159], v[128:131], v[68:71]
    ds_read_b64_tr_b16 v[126:127], v6 offset:4096
    v_mfma_f32_16x16x32_bf16 v[76:79], v[156:159], v[132:135], v[76:79]
    buffer_store_dwordx4 v[172:175], v7, s[28:31], s59 offen offset:3072 sc1
    s_add_u32 s59, s59, 4096
    v_mfma_f32_16x16x32_bf16 v[84:87], v[156:159], v[136:139], v[84:87]
    s_sub_u32 s47, s47, 1
    v_mfma_f32_16x16x32_bf16 v[92:95], v[156:159], v[140:143], v[92:95]
    s_waitcnt lgkmcnt(9)
    v_mfma_f32_16x16x32_bf16 v[32:35], v[112:115], v[96:99], v[32:35]
    ds_read_b128 v[128:131], v2 offset:8192
    s_waitcnt lgkmcnt(9)
    v_mfma_f32_16x16x32_bf16 v[40:43], v[112:115], v[100:103], v[40:43]
    ds_read_b64_tr_b16 v[144:145], v3 offset:8192
    s_waitcnt lgkmcnt(9)
    v_mfma_f32_16x16x32_bf16 v[48:51], v[112:115], v[104:107], v[48:51]
    ds_read_b64_tr_b16 v[146:147], v3 offset:12288
    s_waitcnt lgkmcnt(9)
    v_mfma_f32_16x16x32_bf16 v[56:59], v[112:115], v[108:111], v[56:59]
    ds_read_b128 v[132:135], v2 offset:9216
    s_waitcnt lgkmcnt(8)
    v_mfma_f32_16x16x32_bf16 v[36:39], v[116:119], v[96:99], v[36:39]
    ds_read_b128 v[136:139], v2 offset:10240
    v_mfma_f32_16x16x32_bf16 v[44:47], v[116:119], v[100:103], v[44:47]
    ds_read_b128 v[140:143], v2 offset:11264
    v_mfma_f32_16x16x32_bf16 v[52:55], v[116:119], v[104:107], v[52:55]
    ds_read_b64_tr_b16 v[148:149], v4 offset:8192
    v_mfma_f32_16x16x32_bf16 v[60:63], v[116:119], v[108:111], v[60:63]
    ds_read_b64_tr_b16 v[150:151], v4 offset:12288
    s_waitcnt lgkmcnt(10)
    v_mfma_f32_16x16x32_bf16 v[64:67], v[120:123], v[96:99], v[64:67]
    s_add_u32 s43, s43, 32768
    ds_read_b64_tr_b16 v[152:153], v5 offset:8192
    v_mfma_f32_16x16x32_bf16 v[72:75], v[120:123], v[100:103], v[72:75]
    s_cmp_ge_u32 s43, 163840
    ds_read_b64_tr_b16 v[154:155], v5 offset:12288
    v_mfma_f32_16x16x32_bf16 v[80:83], v[120:123], v[104:107], v[80:83]
    s_cselect_b32 s46, 4294836224, s56
    ds_read_b64_tr_b16 v[156:157], v6 offset:8192
    v_mfma_f32_16x16x32_bf16 v[88:91], v[120:123], v[108:111], v[88:91]
    s_cselect_b32 s43, 0, s43
    ds_read_b64_tr_b16 v[158:159], v6 offset:12288
    s_waitcnt lgkmcnt(12)
    v_mfma_f32_16x16x32_bf16 v[68:71], v[124:127], v[96:99], v[68:71]
    v_add_u32 v2, s46, v2
    v_add_u32 v3, s46, v3
    v_mfma_f32_16x16x32_bf16 v[76:79], v[124:127], v[100:103], v[76:79]
    v_add_u32 v4, s46, v4
    v_add_u32 v5, s46, v5
    v_mfma_f32_16x16x32_bf16 v[84:87], v[124:127], v[104:107], v[84:87]
    v_add_u32 v6, s46, v6
    v_mfma_f32_16x16x32_bf16 v[92:95], v[124:127], v[108:111], v[92:95]
    buffer_store_dwordx4 v[176:179], v7, s[28:31], s59 offen offset:0 sc1
    s_waitcnt lgkmcnt(0)
    v_mfma_f32_16x16x32_bf16 v[32:35], v[144:147], v[128:131], v[32:35]
    s_barrier
    v_mfma_f32_16x16x32_bf16 v[40:43], v[144:147], v[132:135], v[40:43]
    ds_read_b128 v[96:99], v2 offset:0
    v_mfma_f32_16x16x32_bf16 v[48:51], v[144:147], v[136:139], v[48:51]
    ds_read_b64_tr_b16 v[112:113], v3 offset:0
    v_mfma_f32_16x16x32_bf16 v[56:59], v[144:147], v[140:143], v[56:59]
    ds_read_b64_tr_b16 v[114:115], v3 offset:4096
    v_mfma_f32_16x16x32_bf16 v[36:39], v[148:151], v[128:131], v[36:39]
    ds_read_b128 v[100:103], v2 offset:1024
    v_mfma_f32_16x16x32_bf16 v[44:47], v[148:151], v[132:135], v[44:47]
    ds_read_b128 v[104:107], v2 offset:2048
    v_mfma_f32_16x16x32_bf16 v[52:55], v[148:151], v[136:139], v[52:55]
    ds_read_b128 v[108:111], v2 offset:3072
    v_mfma_f32_16x16x32_bf16 v[60:63], v[148:151], v[140:143], v[60:63]
    ds_read_b64_tr_b16 v[116:117], v4 offset:0
    v_mfma_f32_16x16x32_bf16 v[64:67], v[152:155], v[128:131], v[64:67]
    ds_read_b64_tr_b16 v[118:119], v4 offset:4096
    v_mfma_f32_16x16x32_bf16 v[72:75], v[152:155], v[132:135], v[72:75]
    ds_read_b64_tr_b16 v[120:121], v5 offset:0
    v_mfma_f32_16x16x32_bf16 v[80:83], v[152:155], v[136:139], v[80:83]
    ds_read_b64_tr_b16 v[122:123], v5 offset:4096
    v_mfma_f32_16x16x32_bf16 v[88:91], v[152:155], v[140:143], v[88:91]
    ds_read_b64_tr_b16 v[124:125], v6 offset:0
    v_mfma_f32_16x16x32_bf16 v[68:71], v[156:159], v[128:131], v[68:71]
    ds_read_b64_tr_b16 v[126:127], v6 offset:4096
    v_mfma_f32_16x16x32_bf16 v[76:79], v[156:159], v[132:135], v[76:79]
    buffer_store_dwordx4 v[180:183], v7, s[28:31], s59 offen offset:1024 sc1
    v_mfma_f32_16x16x32_bf16 v[84:87], v[156:159], v[136:139], v[84:87]
    s_sub_u32 s47, s47, 1
    v_mfma_f32_16x16x32_bf16 v[92:95], v[156:159], v[140:143], v[92:95]
    s_waitcnt lgkmcnt(9)
    v_mfma_f32_16x16x32_bf16 v[32:35], v[112:115], v[96:99], v[32:35]
    ds_read_b128 v[128:131], v2 offset:8192
    s_waitcnt lgkmcnt(9)
    v_mfma_f32_16x16x32_bf16 v[40:43], v[112:115], v[100:103], v[40:43]
    ds_read_b64_tr_b16 v[144:145], v3 offset:8192
    s_waitcnt lgkmcnt(9)
    v_mfma_f32_16x16x32_bf16 v[48:51], v[112:115], v[104:107], v[48:51]
    ds_read_b64_tr_b16 v[146:147], v3 offset:12288
    s_waitcnt lgkmcnt(9)
    v_mfma_f32_16x16x32_bf16 v[56:59], v[112:115], v[108:111], v[56:59]
    ds_read_b128 v[132:135], v2 offset:9216
    s_waitcnt lgkmcnt(8)
    v_mfma_f32_16x16x32_bf16 v[36:39], v[116:119], v[96:99], v[36:39]
    ds_read_b128 v[136:139], v2 offset:10240
    v_mfma_f32_16x16x32_bf16 v[44:47], v[116:119], v[100:103], v[44:47]
    ds_read_b128 v[140:143], v2 offset:11264
    v_mfma_f32_16x16x32_bf16 v[52:55], v[116:119], v[104:107], v[52:55]
    ds_read_b64_tr_b16 v[148:149], v4 offset:8192
    v_mfma_f32_16x16x32_bf16 v[60:63], v[116:119], v[108:111], v[60:63]
    ds_read_b64_tr_b16 v[150:151], v4 offset:12288
    s_waitcnt lgkmcnt(10)
    v_mfma_f32_16x16x32_bf16 v[64:67], v[120:123], v[96:99], v[64:67]
    s_add_u32 s43, s43, 32768
    ds_read_b64_tr_b16 v[152:153], v5 offset:8192
    v_mfma_f32_16x16x32_bf16 v[72:75], v[120:123], v[100:103], v[72:75]
    s_cmp_ge_u32 s43, 163840
    ds_read_b64_tr_b16 v[154:155], v5 offset:12288
    v_mfma_f32_16x16x32_bf16 v[80:83], v[120:123], v[104:107], v[80:83]
    s_cselect_b32 s46, 4294836224, s56
    ds_read_b64_tr_b16 v[156:157], v6 offset:8192
    v_mfma_f32_16x16x32_bf16 v[88:91], v[120:123], v[108:111], v[88:91]
    s_cselect_b32 s43, 0, s43
    ds_read_b64_tr_b16 v[158:159], v6 offset:12288
    s_waitcnt lgkmcnt(12)
    v_mfma_f32_16x16x32_bf16 v[68:71], v[124:127], v[96:99], v[68:71]
    v_add_u32 v2, s46, v2
    v_add_u32 v3, s46, v3
    v_mfma_f32_16x16x32_bf16 v[76:79], v[124:127], v[100:103], v[76:79]
    v_add_u32 v4, s46, v4
    v_add_u32 v5, s46, v5
    v_mfma_f32_16x16x32_bf16 v[84:87], v[124:127], v[104:107], v[84:87]
    v_add_u32 v6, s46, v6
    v_mfma_f32_16x16x32_bf16 v[92:95], v[124:127], v[108:111], v[92:95]
    buffer_store_dwordx4 v[184:187], v7, s[28:31], s59 offen offset:2048 sc1
    s_waitcnt lgkmcnt(0)
    v_mfma_f32_16x16x32_bf16 v[32:35], v[144:147], v[128:131], v[32:35]
    s_barrier
    v_mfma_f32_16x16x32_bf16 v[40:43], v[144:147], v[132:135], v[40:43]
    ds_read_b128 v[96:99], v2 offset:0
    v_mfma_f32_16x16x32_bf16 v[48:51], v[144:147], v[136:139], v[48:51]
    ds_read_b64_tr_b16 v[112:113], v3 offset:0
    v_mfma_f32_16x16x32_bf16 v[56:59], v[144:147], v[140:143], v[56:59]
    ds_read_b64_tr_b16 v[114:115], v3 offset:4096
    v_mfma_f32_16x16x32_bf16 v[36:39], v[148:151], v[128:131], v[36:39]
    ds_read_b128 v[100:103], v2 offset:1024
    v_mfma_f32_16x16x32_bf16 v[44:47], v[148:151], v[132:135], v[44:47]
    ds_read_b128 v[104:107], v2 offset:2048
    v_mfma_f32_16x16x32_bf16 v[52:55], v[148:151], v[136:139], v[52:55]
    ds_read_b128 v[108:111], v2 offset:3072
    v_mfma_f32_16x16x32_bf16 v[60:63], v[148:151], v[140:143], v[60:63]
    ds_read_b64_tr_b16 v[116:117], v4 offset:0
    v_mfma_f32_16x16x32_bf16 v[64:67], v[152:155], v[128:131], v[64:67]
    ds_read_b64_tr_b16 v[118:119], v4 offset:4096
    v_mfma_f32_16x16x32_bf16 v[72:75], v[152:155], v[132:135], v[72:75]
    ds_read_b64_tr_b16 v[120:121], v5 offset:0
    v_mfma_f32_16x16x32_bf16 v[80:83], v[152:155], v[136:139], v[80:83]
    ds_read_b64_tr_b16 v[122:123], v5 offset:4096
    v_mfma_f32_16x16x32_bf16 v[88:91], v[152:155], v[140:143], v[88:91]
    ds_read_b64_tr_b16 v[124:125], v6 offset:0
    v_mfma_f32_16x16x32_bf16 v[68:71], v[156:159], v[128:131], v[68:71]
    ds_read_b64_tr_b16 v[126:127], v6 offset:4096
    v_mfma_f32_16x16x32_bf16 v[76:79], v[156:159], v[132:135], v[76:79]
    buffer_store_dwordx4 v[188:191], v7, s[28:31], s59 offen offset:3072 sc1
    s_add_u32 s59, s59, 4096
    v_mfma_f32_16x16x32_bf16 v[84:87], v[156:159], v[136:139], v[84:87]
    s_sub_u32 s47, s47, 1
    v_mfma_f32_16x16x32_bf16 v[92:95], v[156:159], v[140:143], v[92:95]
    s_mov_b32 s57, 0
    s_mov_b32 s58, 1
    s_branch gemm3_kernel_back5
gemm3_kernel_n12:
    s_cmp_lg_u32 s58, 1
    s_cbranch_scc1 gemm3_kernel_n13
    s_waitcnt vmcnt(0)
    s_mov_b32 s57, 0
    s_mov_b32 s58, 2
    s_branch gemm3_kernel_back5
gemm3_kernel_n13:
    s_cmp_lg_u32 s58, 2
    s_cbranch_scc1 gemm3_kernel_n14
    s_cmp_lg_u32 s32, 0
    s_cbranch_scc1 gemm3_kernel_np15
    s_lshl_b32 s48, s39, 7
    s_add_u32 s48, s48, 117506048
    v_mov_b32 v16, 1
    s_mov_b64 exec, 1
    buffer_store_dword v16, off, s[28:31], s48 sc1
    s_mov_b64 exec, -1
gemm3_kernel_np15:
    s_mov_b32 s57, 1000
    s_mov_b32 s58, 3
    s_branch gemm3_kernel_back5
gemm3_kernel_n14:
    s_mov_b32 s57, 1000
    s_branch gemm3_kernel_back5
gemm3_kernel_load2:
    s_lshl_b32 s45, s32, 12
    s_lshl_b32 s48, s37, 13
    s_lshl_b32 s49, s34, 12
    s_add_u32 s48, s48, s49
    s_lshl_b32 s49, s33, 17
    s_add_u32 s40, s48, s49
    s_mul_i32 s48, s35, 10747904
    s_add_u32 s41, s40, s48
    s_add_u32 s41, s41, 67108864
    s_add_u32 s40, s40, 83886080
    s_mul_i32 s48, s35, 5373952
    s_lshl_b32 s46, s38, 8
    s_add_u32 s42, s46, s48
    v_lshrrev_b32 v16, 4, v1
    s_lshl_b32 s48, s32, 4
    v_add_u32 v17, s48, v16
    v_lshlrev_b32 v17, 11, v17
    v_lshlrev_b32 v16, 1, v16
    v_and_b32 v18, 15, v1
    v_xor_b32 v16, v16, v18
    v_xor_b32 v18, 0, v16
    v_lshl_add_u32 v8, v18, 4, v17
    v_xor_b32 v18, 8, v16
    v_lshl_add_u32 v9, v18, 4, v17
    v_add_u32 v9, 7168, v9
    v_xor_b32 v18, 0, v16
    v_lshl_add_u32 v10, v18, 4, v17
    v_add_u32 v10, 14336, v10
    v_xor_b32 v18, 8, v16
    v_lshl_add_u32 v11, v18, 4, v17
    v_add_u32 v11, 21504, v11
    s_mov_b32 s18, 268435456
    s_mov_b32 s19, 0x20000
    s_mov_b32 s23, 0x20000
    s_mov_b32 s22, 8388608
    s_mov_b32 s44, s45
    s_cmp_eq_u32 s35, 1
    s_cselect_b32 s57, 23, 1000
    s_cselect_b32 s58, 39, 41
    s_add_u32 s56, s45, 163840
    s_waitcnt lgkmcnt(0)
    s_mov_b32 s20, s4
    s_mov_b32 s21, s5
    s_mov_b32 s16, s10
    s_mov_b32 s17, s11
    s_mov_b32 m0, s44
    s_nop 0
    buffer_load_dwordx4 v7, s[16:19], s41 offen offset:0 lds
    buffer_load_dwordx4 v7, s[16:19], s41 offen offset:1024 lds
    buffer_load_dwordx4 v7, s[16:19], s41 offen offset:2048 lds
    buffer_load_dwordx4 v7, s[16:19], s41 offen offset:3072 lds
    s_add_u32 m0, s44, 16384
    s_add_u32 s41, s41, 262144
    buffer_load_dwordx4 v8, s[20:23], s42 offen offset:0 lds
    buffer_load_dwordx4 v9, s[20:23], s42 offen offset:1024 lds
    buffer_load_dwordx4 v10, s[20:23], s42 offen offset:2048 lds
    buffer_load_dwordx4 v11, s[20:23], s42 offen offset:3072 lds
    s_add_u32 s42, s42, 131072
    s_add_u32 s44, s44, 32768
    s_cmp_ge_u32 s44, s56
    s_cselect_b32 s44, s45, s44
    s_mov_b32 m0, s44
    s_nop 0
    buffer_load_dwordx4 v7, s[16:19], s41 offen offset:0 lds
    buffer_load_dwordx4 v7, s[16:19], s41 offen offset:1024 lds
    buffer_load_dwordx4 v7, s[16:19], s41 offen offset:2048 lds
    buffer_load_dwordx4 v7, s[16:19], s41 offen offset:3072 lds
    s_add_u32 m0, s44, 16384
    s_add_u32 s41, s41, 262144
    buffer_load_dwordx4 v8, s[20:23], s42 offen offset:0 lds
    buffer_load_dwordx4 v9, s[20:23], s42 offen offset:1024 lds
    buffer_load_dwordx4 v10, s[20:23], s42 offen offset:2048 lds
    buffer_load_dwordx4 v11, s[20:23], s42 offen offset:3072 lds
    s_add_u32 s42, s42, 131072
    s_add_u32 s44, s44, 32768
    s_cmp_ge_u32 s44, s56
    s_cselect_b32 s44, s45, s44
    s_waitcnt vmcnt(8)
    s_barrier
    s_mov_b32 m0, s44
    s_nop 0
    buffer_load_dwordx4 v7, s[16:19], s41 offen offset:0 lds
    buffer_load_dwordx4 v7, s[16:19], s41 offen offset:1024 lds
    buffer_load_dwordx4 v7, s[16:19], s41 offen offset:2048 lds
    buffer_load_dwordx4 v7, s[16:19], s41 offen offset:3072 lds
    s_add_u32 m0, s44, 16384
    s_add_u32 s41, s41, 262144
    buffer_load_dwordx4 v8, s[20:23], s42 offen offset:0 lds
    buffer_load_dwordx4 v9, s[20:23], s42 offen offset:1024 lds
    buffer_load_dwordx4 v10, s[20:23], s42 offen offset:2048 lds
    buffer_load_dwordx4 v11, s[20:23], s42 offen offset:3072 lds
    s_add_u32 s42, s42, 131072
    s_add_u32 s44, s44, 32768
    s_cmp_ge_u32 s44, s56
    s_cselect_b32 s44, s45, s44
    s_mov_b32 m0, s44
    s_nop 0
    buffer_load_dwordx4 v7, s[16:19], s41 offen offset:0 lds
    buffer_load_dwordx4 v7, s[16:19], s41 offen offset:1024 lds
    buffer_load_dwordx4 v7, s[16:19], s41 offen offset:2048 lds
    buffer_load_dwordx4 v7, s[16:19], s41 offen offset:3072 lds
    s_add_u32 m0, s44, 16384
    s_add_u32 s41, s41, 262144
    buffer_load_dwordx4 v8, s[20:23], s42 offen offset:0 lds
    buffer_load_dwordx4 v9, s[20:23], s42 offen offset:1024 lds
    buffer_load_dwordx4 v10, s[20:23], s42 offen offset:2048 lds
    buffer_load_dwordx4 v11, s[20:23], s42 offen offset:3072 lds
    s_add_u32 s42, s42, 131072
    s_add_u32 s44, s44, 32768
    s_cmp_ge_u32 s44, s56
    s_cselect_b32 s44, s45, s44
    s_mov_b32 m0, s44
    s_nop 0
    buffer_load_dwordx4 v7, s[16:19], s41 offen offset:0 lds
    buffer_load_dwordx4 v7, s[16:19], s41 offen offset:1024 lds
    buffer_load_dwordx4 v7, s[16:19], s41 offen offset:2048 lds
    buffer_load_dwordx4 v7, s[16:19], s41 offen offset:3072 lds
    s_add_u32 m0, s44, 16384
    s_add_u32 s41, s41, 262144
    buffer_load_dwordx4 v8, s[20:23], s42 offen offset:0 lds
    buffer_load_dwordx4 v9, s[20:23], s42 offen offset:1024 lds
    buffer_load_dwordx4 v10, s[20:23], s42 offen offset:2048 lds
    buffer_load_dwordx4 v11, s[20:23], s42 offen offset:3072 lds
    s_add_u32 s42, s42, 131072
    s_add_u32 s44, s44, 32768
    s_cmp_ge_u32 s44, s56
    s_cselect_b32 s44, s45, s44
    s_mov_b32 s47, 5
gemm3_kernel_ll16:
    s_waitcnt vmcnt(24)
    s_barrier
    s_cmp_eq_u32 s47, s57
    s_cselect_b32 s41, s40, s41
    s_cselect_b32 s42, s46, s42
    s_cselect_b32 s20, s12, s20
    s_cselect_b32 s21, s13, s21
    s_cselect_b32 s22, 2097152, s22
    s_mov_b32 m0, s44
    s_nop 0
    buffer_load_dwordx4 v7, s[16:19], s41 offen offset:0 lds
    buffer_load_dwordx4 v7, s[16:19], s41 offen offset:1024 lds
    buffer_load_dwordx4 v7, s[16:19], s41 offen offset:2048 lds
    buffer_load_dwordx4 v7, s[16:19], s41 offen offset:3072 lds
    s_add_u32 m0, s44, 16384
    s_add_u32 s41, s41, 262144
    buffer_load_dwordx4 v8, s[20:23], s42 offen offset:0 lds
    buffer_load_dwordx4 v9, s[20:23], s42 offen offset:1024 lds
    buffer_load_dwordx4 v10, s[20:23], s42 offen offset:2048 lds
    buffer_load_dwordx4 v11, s[20:23], s42 offen offset:3072 lds
    s_add_u32 s42, s42, 131072
    s_add_u32 s44, s44, 32768
    s_cmp_ge_u32 s44, s56
    s_cselect_b32 s44, s45, s44
    s_add_u32 s47, s47, 1
    s_cmp_lt_u32 s47, s58
    s_cbranch_scc1 gemm3_kernel_ll16
    s_waitcnt vmcnt(24)
    s_barrier
    s_waitcnt vmcnt(16)
    s_barrier
    s_waitcnt vmcnt(8)
    s_barrier
    s_waitcnt vmcnt(0)
    s_barrier
    s_endpgm
gemm3_kernel_end:
.section .rodata,"a"
.p2align 6
.amdhsa_kernel mega_kernel
  .amdhsa_next_free_vgpr 512
  .amdhsa_next_free_sgpr 102
  .amdhsa_accum_offset 256
  .amdhsa_group_segment_fixed_size 0
  .amdhsa_kernarg_size 96
  .amdhsa_user_sgpr_count 2
  .amdhsa_user_sgpr_kernarg_segment_ptr 1
  .amdhsa_system_sgpr_workgroup_id_x 1
.end_amdhsa_kernel
.section .rodata,"a"
.p2align 6
.amdhsa_kernel gemm3_kernel
  .amdhsa_next_free_vgpr 224
  .amdhsa_next_free_sgpr 102
  .amdhsa_accum_offset 224
  .amdhsa_group_segment_fixed_size 0
  .amdhsa_kernarg_size 96
  .amdhsa_user_sgpr_count 2
  .amdhsa_user_sgpr_kernarg_segment_ptr 1
  .amdhsa_system_sgpr_workgroup_id_x 1
.end_amdhsa_kernel
```

```asm
; @launch kernel=mega_kernel grid=(256,1,1) block=(256,1,1) lds=163840
; @launch kernel=gemm3_kernel grid=(256,1,1) block=(512,1,1) lds=163840
.amdgcn_target "amdgcn-amd-amdhsa--gfx950"
.text
.globl mega_kernel
.p2align 8
.type mega_kernel,@function
mega_kernel:
    s_cmp_ge_u32 s2, 256
    s_cbranch_scc1 mega_kernel_end1
    s_load_dwordx16 s[24:39], s[0:1], 0
    s_load_dwordx4 s[4:7], s[0:1], 80
    v_and_b32 v1, 63, v0
    v_lshrrev_b32 v24, 6, v0
    s_nop 0
    v_readfirstlane_b32 s16, v24
    s_lshr_b32 s68, s2, 3
    s_lshr_b32 s57, s16, 1
    s_and_b32 s58, s16, 1
    s_mov_b32 s43, 0x20000
    s_mov_b32 s47, 0x20000
    s_cmp_lt_u32 s68, 29
    s_cbranch_scc1 mega_kernel_ncp2
    s_sub_u32 s91, s68, 29
    s_lshl_b32 s91, s91, 2
    s_add_u32 s91, s91, s16
    s_getpc_b64 s[8:9]
mega_kernel_pc3:
    s_sub_u32 s8, s8, mega_kernel_pc3-mega_kernel
    s_subb_u32 s9, s9, 0
    s_mov_b32 s10, gemm3_kernel_end-mega_kernel
    s_mov_b32 s11, 0x20000
    s_lshl_b32 s90, s91, 13
    v_lshlrev_b32 v24, 7, v1
    buffer_load_dword v22, v24, s[8:11], s90 offen
mega_kernel_ncp2:
    v_and_b32 v24, 15, v1
    v_lshrrev_b32 v25, 4, v1
    v_bfe_u32 v26, v1, 1, 3
    v_xor_b32 v26, v26, v25
    s_lshl_b32 s90, s57, 14
    v_lshlrev_b32 v27, 7, v24
    v_add_u32 v27, s90, v27
    v_xor_b32 v28, 0, v26
    v_lshl_add_u32 v6, v28, 4, v27
    v_xor_b32 v28, 4, v26
    v_lshl_add_u32 v7, v28, 4, v27
    v_bfe_u32 v26, v1, 2, 2
    v_lshl_add_u32 v27, v25, 3, v26
    v_lshlrev_b32 v27, 9, v27
    v_and_b32 v28, 3, v1
    v_lshlrev_b32 v28, 3, v28
    v_add_u32 v27, v27, v28
    s_lshl_b32 s90, s58, 8
    s_add_u32 s90, s90, 98304
    v_add_u32 v27, s90, v27
    v_bfe_u32 v26, v1, 2, 3
    v_xor_b32 v28, 0, v26
    v_lshl_add_u32 v8, v28, 5, v27
    v_xor_b32 v28, 1, v26
    v_lshl_add_u32 v9, v28, 5, v27
    v_xor_b32 v28, 2, v26
    v_lshl_add_u32 v10, v28, 5, v27
    v_xor_b32 v28, 3, v26
    v_lshl_add_u32 v11, v28, 5, v27
    v_xor_b32 v28, 4, v26
    v_lshl_add_u32 v12, v28, 5, v27
    v_xor_b32 v28, 5, v26
    v_lshl_add_u32 v13, v28, 5, v27
    v_xor_b32 v28, 6, v26
    v_lshl_add_u32 v14, v28, 5, v27
    v_xor_b32 v28, 7, v26
    v_lshl_add_u32 v15, v28, 5, v27
    v_lshlrev_b32 v2, 4, v1
    s_lshl_b32 s61, s16, 13
    s_add_u32 s62, s61, 98304
    s_mov_b32 s64, 0
    s_mov_b32 s59, 32768
    s_mov_b32 s60, 229376
    s_waitcnt lgkmcnt(0)
    s_mov_b32 s8, s6
    s_mov_b32 s9, s7
    s_mov_b32 s10, 268435456
    s_mov_b32 s11, 0x20000
    s_mov_b32 s70, 0
    s_cmp_ge_u32 s68, 16
    s_cbranch_scc1 mega_kernel_typea4
    s_and_b32 s69, s68, 3
    s_and_b32 s90, s2, 1
    s_lshl_b32 s90, s90, 2
    s_add_u32 s69, s69, s90
    s_bfe_u32 s90, s2, 0x20001
    s_mul_i32 s90, s90, 4
    s_bfe_u32 s91, s68, 0x20002
    s_add_u32 s90, s90, s91
    s_mov_b32 s76, 8388608
    s_mov_b32 s78, 8192
    s_mov_b32 s81, 0
    s_mov_b32 s73, 4194304
    s_mov_b32 s77, 2048
    s_mov_b32 s82, 16
    s_lshl_b32 s80, s90, 9
    s_lshl_b32 s79, s69, 19
    s_lshl_b32 s88, s90, 4
    s_add_u32 s88, s88, s69
    s_lshl_b32 s88, s88, 3
    s_mov_b32 s83, 0
    s_mov_b32 s84, 1040356334
    s_lshl_b32 s91, s90, 1
    s_add_u32 s91, s91, s58
    s_lshl_b32 s91, s91, 19
    s_lshl_b32 s92, s69, 1
    s_add_u32 s92, s92, s57
    s_lshl_b32 s92, s92, 15
    s_add_u32 s85, s91, s92
    s_add_u32 s85, s85, 0
    s_mov_b32 s86, 1024
    s_mov_b32 s87, 4096
    s_mov_b32 s71, s30
    s_mov_b32 s72, s31
    s_mov_b32 s74, s34
    s_mov_b32 s75, s35
    s_branch mega_kernel_go15
mega_kernel_typea4:
    s_cmp_lt_u32 s68, 28
    s_cbranch_scc1 mega_kernel_nopf6
    s_mov_b32 s70, 1
    s_sub_u32 s93, s2, 224
    s_lshl_b32 s93, s93, 2
    s_add_u32 s93, s93, s16
    v_lshlrev_b32 v24, 7, v1
    v_lshrrev_b32 v25, 3, v1
    v_lshlrev_b32 v25, 11, v25
    v_and_b32 v26, 7, v1
    v_lshl_add_u32 v25, v26, 7, v25
    s_lshl_b32 s92, s93, 13
    s_lshl_b32 s93, s93, 14
    s_add_u32 s93, s93, 1024
    v_lshrrev_b32 v25, 2, v1
    v_lshlrev_b32 v25, 11, v25
    v_and_b32 v26, 3, v1
    v_lshl_add_u32 v25, v26, 7, v25
    s_lshl_b32 s93, s92, 2
    s_mov_b32 s40, s34
    s_mov_b32 s41, s35
    s_mov_b32 s42, 8388608
    s_add_u32 s90, s92, 1048576
    buffer_load_dword v22, v24, s[40:43], s90 offen
    s_add_u32 s90, s92, 2097152
    buffer_load_dword v22, v24, s[40:43], s90 offen
    s_mov_b32 s40, s30
    s_mov_b32 s41, s31
    s_mov_b32 s42, 4194304
    s_add_u32 s90, s93, 512
    buffer_load_dword v22, v25, s[40:43], s90 offen
    s_mov_b32 s40, s34
    s_mov_b32 s41, s35
    s_mov_b32 s42, 8388608
    s_add_u32 s90, s92, 3145728
    buffer_load_dword v22, v24, s[40:43], s90 offen
    s_add_u32 s90, s92, 4194304
    buffer_load_dword v22, v24, s[40:43], s90 offen
    s_mov_b32 s40, s30
    s_mov_b32 s41, s31
    s_mov_b32 s42, 4194304
    s_add_u32 s90, s93, 1024
    buffer_load_dword v22, v25, s[40:43], s90 offen
    s_mov_b32 s40, s34
    s_mov_b32 s41, s35
    s_mov_b32 s42, 8388608
    s_add_u32 s90, s92, 5242880
    buffer_load_dword v22, v24, s[40:43], s90 offen
    s_mov_b32 s40, s26
    s_mov_b32 s41, s27
    s_mov_b32 s42, 6291456
    s_add_u32 s90, s92, 0
    buffer_load_dword v22, v24, s[40:43], s90 offen
    s_mov_b32 s40, s24
    s_mov_b32 s41, s25
    s_mov_b32 s42, 4194304
    s_add_u32 s90, s93, 0
    buffer_load_dword v22, v25, s[40:43], s90 offen
    s_mov_b32 s40, s34
    s_mov_b32 s41, s35
    s_mov_b32 s42, 8388608
    s_add_u32 s90, s92, 6291456
    buffer_load_dword v22, v24, s[40:43], s90 offen
    s_mov_b32 s40, s30
    s_mov_b32 s41, s31
    s_mov_b32 s42, 4194304
    s_add_u32 s90, s93, 1536
    buffer_load_dword v22, v25, s[40:43], s90 offen
    s_mov_b32 s40, s26
    s_mov_b32 s41, s27
    s_mov_b32 s42, 6291456
    s_add_u32 s90, s92, 1048576
    buffer_load_dword v22, v24, s[40:43], s90 offen
    s_mov_b32 s40, s24
    s_mov_b32 s41, s25
    s_mov_b32 s42, 4194304
    s_add_u32 s90, s93, 512
    buffer_load_dword v22, v25, s[40:43], s90 offen
    s_mov_b32 s40, s34
    s_mov_b32 s41, s35
    s_mov_b32 s42, 8388608
    s_add_u32 s90, s92, 7340032
    buffer_load_dword v22, v24, s[40:43], s90 offen
    s_mov_b32 s40, s26
    s_mov_b32 s41, s27
    s_mov_b32 s42, 6291456
    s_add_u32 s90, s92, 2097152
    buffer_load_dword v22, v24, s[40:43], s90 offen
    s_add_u32 s90, s92, 3145728
    buffer_load_dword v22, v24, s[40:43], s90 offen
    s_mov_b32 s40, s24
    s_mov_b32 s41, s25
    s_mov_b32 s42, 4194304
    s_add_u32 s90, s93, 1024
    buffer_load_dword v22, v25, s[40:43], s90 offen
    s_mov_b32 s40, s26
    s_mov_b32 s41, s27
    s_mov_b32 s42, 6291456
    s_add_u32 s90, s92, 4194304
    buffer_load_dword v22, v24, s[40:43], s90 offen
    s_mov_b32 s40, s24
    s_mov_b32 s41, s25
    s_mov_b32 s42, 4194304
    s_add_u32 s90, s93, 1536
    buffer_load_dword v22, v25, s[40:43], s90 offen
    s_mov_b32 s40, s26
    s_mov_b32 s41, s27
    s_mov_b32 s42, 6291456
    s_add_u32 s90, s92, 5242880
    buffer_load_dword v22, v24, s[40:43], s90 offen
    s_mov_b32 s40, s32
    s_mov_b32 s41, s33
    s_mov_b32 s42, 2097152
    s_add_u32 s90, s92, 1048576
    buffer_load_dword v22, v24, s[40:43], s90 offen
mega_kernel_nopf6:
    s_bfe_u32 s69, s68, 0x20002
    s_add_u32 s69, s69, 0
    s_and_b32 s90, s2, 7
    s_lshl_b32 s90, s90, 2
    s_and_b32 s91, s68, 3
    s_add_u32 s90, s90, s91
    s_cmp_lt_u32 s90, 16
    s_cselect_b32 s83, 0, 1
    s_mov_b32 s91, 33554432
    s_cselect_b32 s85, 16777216, s91
    s_mov_b32 s91, 8192
    s_cselect_b32 s86, 1024, s91
    s_mov_b32 s91, 1024
    s_cselect_b32 s87, 4096, s91
    s_cselect_b32 s74, s36, s38
    s_cselect_b32 s75, s37, s39
    s_mov_b32 s71, s32
    s_mov_b32 s72, s33
    s_mov_b32 s73, 2097152
    s_mov_b32 s77, 1024
    s_mov_b32 s82, 8
    s_mov_b32 s81, 0
    s_mov_b32 s76, 4194304
    s_mov_b32 s78, 8192
    s_mov_b32 s84, 0
    s_and_b32 s90, s90, 15
    s_lshl_b32 s80, s90, 9
    s_lshl_b32 s79, s69, 18
    s_lshl_b32 s91, s83, 2
    s_add_u32 s91, s91, s69
    s_cmp_ge_u32 s69, 4
    s_cselect_b32 s92, 508, 8
    s_add_u32 s91, s91, s92
    s_lshl_b32 s88, s90, 4
    s_add_u32 s88, s88, s91
    s_lshl_b32 s88, s88, 3
    s_lshl_b32 s91, s90, 1
    s_add_u32 s91, s91, s58
    s_lshl_b32 s91, s91, 19
    s_lshl_b32 s92, s69, 1
    s_add_u32 s92, s92, s57
    s_lshl_b32 s92, s92, 15
    s_add_u32 s85, s85, s91
    s_add_u32 s85, s85, s92
mega_kernel_go15:
    s_mov_b32 s42, s73
    s_mov_b32 s46, s76
    s_lshl_b32 s90, s77, 4
    s_lshl_b32 s90, s90, s81
    s_mov_b32 s48, s79
    s_mul_i32 s91, s90, 1
    s_add_u32 s49, s91, s79
    s_sub_u32 s49, s49, 2048
    s_mul_i32 s91, s90, 2
    s_add_u32 s50, s91, s79
    s_mul_i32 s91, s90, 3
    s_add_u32 s51, s91, s79
    s_sub_u32 s51, s51, 2048
    s_mov_b32 s52, s80
    s_lshl_b32 s90, s78, 2
    s_mul_i32 s91, s90, 1
    s_add_u32 s53, s91, s80
    s_sub_u32 s53, s53, 2048
    s_mul_i32 s91, s90, 2
    s_add_u32 s54, s91, s80
    s_mul_i32 s91, s90, 3
    s_add_u32 s55, s91, s80
    s_sub_u32 s55, s55, 2048
    s_lshl_b32 s56, s78, 6
    s_lshl_b32 s90, s58, 7
    s_add_u32 s90, s90, s57
    s_lshl_b32 s91, s16, 6
    s_cmp_eq_u32 s81, 1
    s_cselect_b32 s90, s90, s91
    v_lshrrev_b32 v24, 3, v1
    v_lshlrev_b32 v24, s81, v24
    v_add_u32 v24, s90, v24
    v_mul_lo_u32 v24, v24, s77
    v_lshrrev_b32 v25, 4, v1
    v_and_b32 v26, 7, v1
    v_xor_b32 v25, v25, v26
    v_lshl_add_u32 v16, v25, 4, v24
    v_xor_b32 v25, 4, v25
    v_lshl_add_u32 v17, v25, 4, v24
    s_lshl_b32 s90, s77, 3
    s_lshl_b32 s90, s90, s81
    s_sub_u32 s90, s90, 1024
    v_add_u32 v17, s90, v17
    v_lshrrev_b32 v24, 5, v1
    s_lshl_b32 s90, s16, 4
    v_add_u32 v25, s90, v24
    v_mul_lo_u32 v25, v25, s78
    v_lshlrev_b32 v24, 1, v24
    v_and_b32 v26, 31, v1
    v_xor_b32 v24, v24, v26
    s_lshl_b32 s90, s78, 1
    s_sub_u32 s90, s90, 1024
    v_add_u32 v27, s90, v25
    v_xor_b32 v26, 0, v24
    v_lshl_add_u32 v18, v26, 4, v25
    v_xor_b32 v26, 4, v24
    v_lshl_add_u32 v19, v26, 4, v27
    v_xor_b32 v26, 8, v24
    v_lshl_add_u32 v20, v26, 4, v25
    v_xor_b32 v26, 12, v24
    v_lshl_add_u32 v21, v26, 4, v27
    s_mov_b32 s40, s71
    s_mov_b32 s41, s72
    s_mov_b32 s44, s74
    s_mov_b32 s45, s75
    s_mov_b32 s95, s82
    s_mov_b32 s96, s83
    s_mov_b32 s97, s84
    s_mov_b32 s98, s85
    s_mov_b32 s99, s86
    s_mov_b32 s100, s87
    s_mov_b32 s101, s88
    s_add_u32 m0, s61, 0
    s_nop 0
    buffer_load_dwordx4 v16, s[40:43], s48 offen offset:0 lds
    buffer_load_dwordx4 v17, s[40:43], s48 offen offset:1024 lds
    s_add_u32 s48, s48, 128
    buffer_load_dwordx4 v16, s[40:43], s49 offen offset:2048 lds
    buffer_load_dwordx4 v17, s[40:43], s49 offen offset:3072 lds
    s_add_u32 s49, s49, 128
    s_add_u32 m0, s61, 4096
    s_nop 0
    buffer_load_dwordx4 v16, s[40:43], s50 offen offset:0 lds
    buffer_load_dwordx4 v17, s[40:43], s50 offen offset:1024 lds
    s_add_u32 s50, s50, 128
    buffer_load_dwordx4 v16, s[40:43], s51 offen offset:2048 lds
    buffer_load_dwordx4 v17, s[40:43], s51 offen offset:3072 lds
    s_add_u32 s51, s51, 128
    s_add_u32 s61, s61, 32768
    s_cmp_ge_u32 s61, 98304
    s_cselect_b32 s90, 98304, 0
    s_sub_u32 s61, s61, s90
    s_add_u32 m0, s62, 0
    s_nop 0
    buffer_load_dwordx4 v18, s[44:47], s52 offen offset:0 lds
    buffer_load_dwordx4 v19, s[44:47], s52 offen offset:1024 lds
    s_add_u32 s52, s52, s56
    buffer_load_dwordx4 v18, s[44:47], s53 offen offset:2048 lds
    buffer_load_dwordx4 v19, s[44:47], s53 offen offset:3072 lds
    s_add_u32 s53, s53, s56
    s_add_u32 m0, s62, 4096
    s_nop 0
    buffer_load_dwordx4 v20, s[44:47], s54 offen offset:0 lds
    buffer_load_dwordx4 v21, s[44:47], s54 offen offset:1024 lds
    s_add_u32 s54, s54, s56
    buffer_load_dwordx4 v20, s[44:47], s55 offen offset:2048 lds
    buffer_load_dwordx4 v21, s[44:47], s55 offen offset:3072 lds
    s_add_u32 s55, s55, s56
    s_xor_b32 s62, s62, 229376
    s_cmp_ge_u32 s68, 16
    s_cbranch_scc1 mega_kernel_typea7
    s_bfe_u32 s69, s68, 0x20002
    s_add_u32 s69, s69, 4
    s_and_b32 s90, s2, 7
    s_lshl_b32 s90, s90, 2
    s_and_b32 s91, s68, 3
    s_add_u32 s90, s90, s91
    s_cmp_lt_u32 s90, 16
    s_cselect_b32 s83, 0, 1
    s_mov_b32 s91, 33554432
    s_cselect_b32 s85, 16777216, s91
    s_mov_b32 s91, 8192
    s_cselect_b32 s86, 1024, s91
    s_mov_b32 s91, 1024
    s_cselect_b32 s87, 4096, s91
    s_cselect_b32 s74, s36, s38
    s_cselect_b32 s75, s37, s39
    s_mov_b32 s71, s32
    s_mov_b32 s72, s33
    s_mov_b32 s73, 2097152
    s_mov_b32 s77, 1024
    s_mov_b32 s82, 8
    s_mov_b32 s81, 0
    s_mov_b32 s76, 4194304
    s_mov_b32 s78, 8192
    s_mov_b32 s84, 0
    s_and_b32 s90, s90, 15
    s_lshl_b32 s80, s90, 9
    s_lshl_b32 s79, s69, 18
    s_lshl_b32 s91, s83, 2
    s_add_u32 s91, s91, s69
    s_cmp_ge_u32 s69, 4
    s_cselect_b32 s92, 508, 8
    s_add_u32 s91, s91, s92
    s_lshl_b32 s88, s90, 4
    s_add_u32 s88, s88, s91
    s_lshl_b32 s88, s88, 3
    s_lshl_b32 s91, s90, 1
    s_add_u32 s91, s91, s58
    s_lshl_b32 s91, s91, 19
    s_lshl_b32 s92, s69, 1
    s_add_u32 s92, s92, s57
    s_lshl_b32 s92, s92, 15
    s_add_u32 s85, s85, s91
    s_add_u32 s85, s85, s92
    s_branch mega_kernel_go28
mega_kernel_typea7:
    s_and_b32 s69, s68, 3
    s_and_b32 s90, s2, 1
    s_lshl_b32 s90, s90, 2
    s_add_u32 s69, s69, s90
    s_bfe_u32 s90, s2, 0x20001
    s_mul_i32 s90, s90, 3
    s_bfe_u32 s91, s68, 0x20002
    s_add_u32 s90, s90, s91
    s_mov_b32 s76, 6291456
    s_mov_b32 s78, 6144
    s_mov_b32 s81, 1
    s_mov_b32 s73, 4194304
    s_mov_b32 s77, 2048
    s_mov_b32 s82, 16
    s_lshl_b32 s80, s90, 9
    s_lshl_b32 s79, s69, 19
    s_and_b32 s92, s90, 3
    s_lshr_b32 s91, s90, 2
    s_lshl_b32 s88, s92, 2
    s_add_u32 s88, s88, s91
    s_lshl_b32 s88, s88, 3
    s_add_u32 s88, s88, s69
    s_lshl_b32 s88, s88, 3
    s_add_u32 s88, s88, 6144
    s_cmp_eq_u32 s91, 0
    s_cselect_b32 s84, 1048744942, 0
    s_lshl_b32 s93, s91, 22
    s_add_u32 s85, s93, 50331648
    s_lshl_b32 s92, s92, 1
    s_add_u32 s92, s92, s58
    s_lshl_b32 s92, s92, 19
    s_add_u32 s85, s85, s92
    s_lshl_b32 s92, s57, 3
    s_add_u32 s92, s92, s69
    s_cmp_eq_u32 s91, 2
    s_cselect_b32 s83, 1, 0
    s_cselect_b32 s93, 12, 13
    s_mov_b32 s91, 131072
    s_cselect_b32 s86, 1024, s91
    s_mov_b32 s91, 1024
    s_cselect_b32 s87, 65536, s91
    s_lshl_b32 s92, s92, s93
    s_add_u32 s85, s85, s92
    s_mov_b32 s71, s24
    s_mov_b32 s72, s25
    s_mov_b32 s74, s26
    s_mov_b32 s75, s27
mega_kernel_go28:
    s_xor_b32 s94, s70, 1
    s_mov_b32 s67, 2
    s_mov_b32 s17, -1
    s_mov_b32 s12, s4
    s_mov_b32 s13, s5
    s_mov_b32 s14, 256
    s_mov_b32 s15, 0x20000
    s_lshl_b32 s90, s2, 2
    s_add_u32 s90, s90, s16
    s_cmp_lg_u32 s90, 0
    s_cbranch_scc1 mega_kernel_tok9
    s_memrealtime s[92:93]
    s_waitcnt lgkmcnt(0)
    s_or_b32 s92, s92, 1
    v_mov_b32 v4, s92
    v_mov_b32 v5, s93
    s_mov_b64 exec, 1
    buffer_store_dwordx2 v[4:5], off, s[12:15], 0 sc1
    s_mov_b64 exec, -1
mega_kernel_tok9:
    s_add_u32 m0, s61, 0
    s_nop 0
    buffer_load_dwordx4 v16, s[40:43], s48 offen offset:0 lds
    buffer_load_dwordx4 v17, s[40:43], s48 offen offset:1024 lds
    s_add_u32 s48, s48, 128
    buffer_load_dwordx4 v16, s[40:43], s49 offen offset:2048 lds
    buffer_load_dwordx4 v17, s[40:43], s49 offen offset:3072 lds
    s_add_u32 s49, s49, 128
    s_add_u32 m0, s61, 4096
    s_nop 0
    buffer_load_dwordx4 v16, s[40:43], s50 offen offset:0 lds
    buffer_load_dwordx4 v17, s[40:43], s50 offen offset:1024 lds
    s_add_u32 s50, s50, 128
    buffer_load_dwordx4 v16, s[40:43], s51 offen offset:2048 lds
    buffer_load_dwordx4 v17, s[40:43], s51 offen offset:3072 lds
    s_add_u32 s51, s51, 128
    s_add_u32 s61, s61, 32768
    s_cmp_ge_u32 s61, 98304
    s_cselect_b32 s90, 98304, 0
    s_sub_u32 s61, s61, s90
    s_add_u32 m0, s62, 0
    s_nop 0
    buffer_load_dwordx4 v18, s[44:47], s52 offen offset:0 lds
    buffer_load_dwordx4 v19, s[44:47], s52 offen offset:1024 lds
    s_add_u32 s52, s52, s56
    buffer_load_dwordx4 v18, s[44:47], s53 offen offset:2048 lds
    buffer_load_dwordx4 v19, s[44:47], s53 offen offset:3072 lds
    s_add_u32 s53, s53, s56
    s_add_u32 m0, s62, 4096
    s_nop 0
    buffer_load_dwordx4 v20, s[44:47], s54 offen offset:0 lds
    buffer_load_dwordx4 v21, s[44:47], s54 offen offset:1024 lds
    s_add_u32 s54, s54, s56
    buffer_load_dwordx4 v20, s[44:47], s55 offen offset:2048 lds
    buffer_load_dwordx4 v21, s[44:47], s55 offen offset:3072 lds
    s_add_u32 s55, s55, s56
    s_xor_b32 s62, s62, 229376
    s_waitcnt vmcnt(16)
    s_barrier
    ds_read_b64_tr_b16 a[64:65], v8 offset:0
    ds_read_b64_tr_b16 a[66:67], v8 offset:2048
    ds_read_b128 a[0:3], v6 offset:0
    ds_read_b128 a[4:7], v6 offset:2048
    ds_read_b64_tr_b16 a[68:69], v9 offset:0
    ds_read_b64_tr_b16 a[70:71], v9 offset:2048
    ds_read_b128 a[8:11], v6 offset:4096
    ds_read_b128 a[12:15], v6 offset:6144
    ds_read_b64_tr_b16 a[72:73], v10 offset:0
    ds_read_b64_tr_b16 a[74:75], v10 offset:2048
    ds_read_b128 a[16:19], v6 offset:8192
    ds_read_b128 a[20:23], v6 offset:10240
    ds_read_b64_tr_b16 a[76:77], v11 offset:0
    ds_read_b64_tr_b16 a[78:79], v11 offset:2048
    ds_read_b128 a[24:27], v6 offset:12288
    ds_read_b128 a[28:31], v6 offset:14336
    ds_read_b64_tr_b16 a[80:81], v12 offset:0
    ds_read_b64_tr_b16 a[82:83], v12 offset:2048
    ds_read_b64_tr_b16 a[84:85], v13 offset:0
    ds_read_b64_tr_b16 a[86:87], v13 offset:2048
    ds_read_b64_tr_b16 a[88:89], v14 offset:0
    ds_read_b64_tr_b16 a[90:91], v14 offset:2048
    ds_read_b64_tr_b16 a[92:93], v15 offset:0
    ds_read_b64_tr_b16 a[94:95], v15 offset:2048
    s_mov_b32 s66, 1
    s_mov_b32 s24, s6
    s_mov_b32 s25, s7
    s_mov_b32 s26, 0
    s_mov_b32 s27, 0x20000
    s_mov_b32 s28, 0
    s_mov_b32 s29, 0
    s_mov_b32 s30, 0
    s_mov_b32 s31, 0
mega_kernel_tile10:
    s_mov_b32 s65, s95
    s_cmp_eq_u32 s96, 1
    s_cbranch_scc1 mega_kernel_swp12
    s_waitcnt lgkmcnt(15)
    v_mfma_f32_16x16x32_bf16 v[32:35], a[64:67], a[0:3], 0
    v_mfma_f32_16x16x32_bf16 v[40:43], a[64:67], a[4:7], 0
    v_mfma_f32_16x16x32_bf16 v[48:51], a[64:67], a[8:11], 0
    v_mfma_f32_16x16x32_bf16 v[56:59], a[64:67], a[12:15], 0
    s_add_u32 m0, s61, 0
    s_waitcnt lgkmcnt(13)
    v_mfma_f32_16x16x32_bf16 v[64:67], a[64:67], a[16:19], 0
    buffer_load_dwordx4 v16, s[40:43], s48 offen offset:0 lds
    s_waitcnt lgkmcnt(12)
    v_mfma_f32_16x16x32_bf16 v[72:75], a[64:67], a[20:23], 0
    s_waitcnt lgkmcnt(9)
    v_mfma_f32_16x16x32_bf16 v[80:83], a[64:67], a[24:27], 0
    s_waitcnt lgkmcnt(8)
    v_mfma_f32_16x16x32_bf16 v[88:91], a[64:67], a[28:31], 0
    ds_read_b64_tr_b16 a[64:65], v8 offset:16384
    v_mfma_f32_16x16x32_bf16 v[36:39], a[68:71], a[0:3], 0
    ds_read_b64_tr_b16 a[66:67], v8 offset:18432
    v_mfma_f32_16x16x32_bf16 v[44:47], a[68:71], a[4:7], 0
    v_mfma_f32_16x16x32_bf16 v[52:55], a[68:71], a[8:11], 0
    ds_read_b128 a[32:35], v7 offset:0
    v_mfma_f32_16x16x32_bf16 v[60:63], a[68:71], a[12:15], 0
    v_mfma_f32_16x16x32_bf16 v[68:71], a[68:71], a[16:19], 0
    buffer_load_dwordx4 v17, s[40:43], s48 offen offset:1024 lds
    v_mfma_f32_16x16x32_bf16 v[76:79], a[68:71], a[20:23], 0
    s_add_u32 s48, s48, 128
    v_mfma_f32_16x16x32_bf16 v[84:87], a[68:71], a[24:27], 0
    ds_read_b128 a[36:39], v7 offset:2048
    v_mfma_f32_16x16x32_bf16 v[92:95], a[68:71], a[28:31], 0
    ds_read_b64_tr_b16 a[68:69], v9 offset:16384
    v_mfma_f32_16x16x32_bf16 v[96:99], a[72:75], a[0:3], 0
    ds_read_b64_tr_b16 a[70:71], v9 offset:18432
    v_mfma_f32_16x16x32_bf16 v[104:107], a[72:75], a[4:7], 0
    v_mfma_f32_16x16x32_bf16 v[112:115], a[72:75], a[8:11], 0
    ds_read_b128 a[40:43], v7 offset:4096
    v_mfma_f32_16x16x32_bf16 v[120:123], a[72:75], a[12:15], 0
    v_mfma_f32_16x16x32_bf16 v[128:131], a[72:75], a[16:19], 0
    buffer_load_dwordx4 v16, s[40:43], s49 offen offset:2048 lds
    v_mfma_f32_16x16x32_bf16 v[136:139], a[72:75], a[20:23], 0
    v_mfma_f32_16x16x32_bf16 v[144:147], a[72:75], a[24:27], 0
    ds_read_b128 a[44:47], v7 offset:6144
    v_mfma_f32_16x16x32_bf16 v[152:155], a[72:75], a[28:31], 0
    ds_read_b64_tr_b16 a[72:73], v10 offset:16384
    v_mfma_f32_16x16x32_bf16 v[100:103], a[76:79], a[0:3], 0
    ds_read_b64_tr_b16 a[74:75], v10 offset:18432
    v_mfma_f32_16x16x32_bf16 v[108:111], a[76:79], a[4:7], 0
    v_mfma_f32_16x16x32_bf16 v[116:119], a[76:79], a[8:11], 0
    ds_read_b128 a[48:51], v7 offset:8192
    v_mfma_f32_16x16x32_bf16 v[124:127], a[76:79], a[12:15], 0
    v_mfma_f32_16x16x32_bf16 v[132:135], a[76:79], a[16:19], 0
    buffer_load_dwordx4 v17, s[40:43], s49 offen offset:3072 lds
    v_mfma_f32_16x16x32_bf16 v[140:143], a[76:79], a[20:23], 0
    s_add_u32 s49, s49, 128
    v_mfma_f32_16x16x32_bf16 v[148:151], a[76:79], a[24:27], 0
    ds_read_b128 a[52:55], v7 offset:10240
    v_mfma_f32_16x16x32_bf16 v[156:159], a[76:79], a[28:31], 0
    ds_read_b64_tr_b16 a[76:77], v11 offset:16384
    s_waitcnt lgkmcnt(15)
    v_mfma_f32_16x16x32_bf16 v[160:163], a[80:83], a[0:3], 0
    ds_read_b64_tr_b16 a[78:79], v11 offset:18432
    v_mfma_f32_16x16x32_bf16 v[168:171], a[80:83], a[4:7], 0
    v_mfma_f32_16x16x32_bf16 v[176:179], a[80:83], a[8:11], 0
    ds_read_b128 a[56:59], v7 offset:12288
    v_mfma_f32_16x16x32_bf16 v[184:187], a[80:83], a[12:15], 0
    s_add_u32 m0, s61, 4096
    v_mfma_f32_16x16x32_bf16 v[192:195], a[80:83], a[16:19], 0
    buffer_load_dwordx4 v16, s[40:43], s50 offen offset:0 lds
    v_mfma_f32_16x16x32_bf16 v[200:203], a[80:83], a[20:23], 0
    v_mfma_f32_16x16x32_bf16 v[208:211], a[80:83], a[24:27], 0
    s_add_u32 s61, s61, 32768
    ds_read_b128 a[60:63], v7 offset:14336
    v_mfma_f32_16x16x32_bf16 v[216:219], a[80:83], a[28:31], 0
    s_cmp_ge_u32 s61, 98304
    s_cselect_b32 s90, 98304, 0
    ds_read_b64_tr_b16 a[80:81], v12 offset:16384
    v_mfma_f32_16x16x32_bf16 v[164:167], a[84:87], a[0:3], 0
    s_sub_u32 s61, s61, s90
    ds_read_b64_tr_b16 a[82:83], v12 offset:18432
    v_mfma_f32_16x16x32_bf16 v[172:175], a[84:87], a[4:7], 0
    s_add_u32 s64, s64, 32768
    v_mfma_f32_16x16x32_bf16 v[180:183], a[84:87], a[8:11], 0
    buffer_store_dwordx4 a[128:131], v2, s[24:27], s28 offen sc1
    v_mfma_f32_16x16x32_bf16 v[188:191], a[84:87], a[12:15], 0
    s_add_u32 s28, s28, s31
    v_mfma_f32_16x16x32_bf16 v[196:199], a[84:87], a[16:19], 0
    buffer_load_dwordx4 v17, s[40:43], s50 offen offset:1024 lds
    v_mfma_f32_16x16x32_bf16 v[204:207], a[84:87], a[20:23], 0
    s_add_u32 s50, s50, 128
    v_mfma_f32_16x16x32_bf16 v[212:215], a[84:87], a[24:27], 0
    s_cmp_ge_u32 s64, 98304
    s_cselect_b32 s63, 4294901760, s59
    s_cselect_b32 s64, 0, s64
    v_mfma_f32_16x16x32_bf16 v[220:223], a[84:87], a[28:31], 0
    ds_read_b64_tr_b16 a[84:85], v13 offset:16384
    v_mfma_f32_16x16x32_bf16 v[224:227], a[88:91], a[0:3], 0
    ds_read_b64_tr_b16 a[86:87], v13 offset:18432
    v_mfma_f32_16x16x32_bf16 v[232:235], a[88:91], a[4:7], 0
    v_mfma_f32_16x16x32_bf16 v[240:243], a[88:91], a[8:11], 0
    buffer_store_dwordx4 a[132:135], v2, s[24:27], s28 offen sc1
    v_mfma_f32_16x16x32_bf16 v[248:251], a[88:91], a[12:15], 0
    s_add_u32 s28, s28, s31
    v_mfma_f32_16x16x32_bf16 a[96:99], a[88:91], a[16:19], 0
    buffer_load_dwordx4 v16, s[40:43], s51 offen offset:2048 lds
    v_mfma_f32_16x16x32_bf16 a[104:107], a[88:91], a[20:23], 0
    v_mfma_f32_16x16x32_bf16 a[112:115], a[88:91], a[24:27], 0
    v_mfma_f32_16x16x32_bf16 a[120:123], a[88:91], a[28:31], 0
    ds_read_b64_tr_b16 a[88:89], v14 offset:16384
    s_waitcnt lgkmcnt(15)
    v_mfma_f32_16x16x32_bf16 v[228:231], a[92:95], a[0:3], 0
    ds_read_b64_tr_b16 a[90:91], v14 offset:18432
    v_mfma_f32_16x16x32_bf16 v[236:239], a[92:95], a[4:7], 0
    v_add_u32 v6, s63, v6
    v_add_u32 v7, s63, v7
    v_mfma_f32_16x16x32_bf16 v[244:247], a[92:95], a[8:11], 0
    buffer_store_dwordx4 a[136:139], v2, s[24:27], s28 offen sc1
    v_mfma_f32_16x16x32_bf16 v[252:255], a[92:95], a[12:15], 0
    s_add_u32 s28, s28, s31
    v_mfma_f32_16x16x32_bf16 a[100:103], a[92:95], a[16:19], 0
    buffer_load_dwordx4 v17, s[40:43], s51 offen offset:3072 lds
    v_mfma_f32_16x16x32_bf16 a[108:111], a[92:95], a[20:23], 0
    s_add_u32 s51, s51, 128
    v_mfma_f32_16x16x32_bf16 a[116:119], a[92:95], a[24:27], 0
    v_mfma_f32_16x16x32_bf16 a[124:127], a[92:95], a[28:31], 0
    ds_read_b64_tr_b16 a[92:93], v15 offset:16384
    ds_read_b64_tr_b16 a[94:95], v15 offset:18432
    v_mfma_f32_16x16x32_bf16 v[32:35], a[64:67], a[32:35], v[32:35]
    v_xor_b32 v8, s60, v8
    v_xor_b32 v9, s60, v9
    v_mfma_f32_16x16x32_bf16 v[40:43], a[64:67], a[36:39], v[40:43]
    v_xor_b32 v10, s60, v10
    v_xor_b32 v11, s60, v11
    s_waitcnt lgkmcnt(15)
    v_mfma_f32_16x16x32_bf16 v[48:51], a[64:67], a[40:43], v[48:51]
    v_xor_b32 v12, s60, v12
    v_xor_b32 v13, s60, v13
    v_mfma_f32_16x16x32_bf16 v[56:59], a[64:67], a[44:47], v[56:59]
    v_xor_b32 v14, s60, v14
    v_xor_b32 v15, s60, v15
    s_waitcnt lgkmcnt(13)
    v_mfma_f32_16x16x32_bf16 v[64:67], a[64:67], a[48:51], v[64:67]
    s_waitcnt lgkmcnt(12)
    v_mfma_f32_16x16x32_bf16 v[72:75], a[64:67], a[52:55], v[72:75]
    s_waitcnt lgkmcnt(9)
    v_mfma_f32_16x16x32_bf16 v[80:83], a[64:67], a[56:59], v[80:83]
    s_waitcnt vmcnt(11) lgkmcnt(0)
    v_mfma_f32_16x16x32_bf16 v[88:91], a[64:67], a[60:63], v[88:91]
    s_barrier
    ds_read_b64_tr_b16 a[64:65], v8 offset:0
    v_mfma_f32_16x16x32_bf16 v[36:39], a[68:71], a[32:35], v[36:39]
    s_add_u32 m0, s62, 0
    ds_read_b64_tr_b16 a[66:67], v8 offset:2048
    v_mfma_f32_16x16x32_bf16 v[44:47], a[68:71], a[36:39], v[44:47]
    buffer_load_dwordx4 v18, s[44:47], s52 offen offset:0 lds
    v_mfma_f32_16x16x32_bf16 v[52:55], a[68:71], a[40:43], v[52:55]
    ds_read_b128 a[0:3], v6 offset:0
    v_mfma_f32_16x16x32_bf16 v[60:63], a[68:71], a[44:47], v[60:63]
    v_mfma_f32_16x16x32_bf16 v[68:71], a[68:71], a[48:51], v[68:71]
    v_mfma_f32_16x16x32_bf16 v[76:79], a[68:71], a[52:55], v[76:79]
    buffer_load_dwordx4 v19, s[44:47], s52 offen offset:1024 lds
    v_mfma_f32_16x16x32_bf16 v[84:87], a[68:71], a[56:59], v[84:87]
    s_add_u32 s52, s52, s56
    ds_read_b128 a[4:7], v6 offset:2048
    v_mfma_f32_16x16x32_bf16 v[92:95], a[68:71], a[60:63], v[92:95]
    ds_read_b64_tr_b16 a[68:69], v9 offset:0
    v_mfma_f32_16x16x32_bf16 v[96:99], a[72:75], a[32:35], v[96:99]
    ds_read_b64_tr_b16 a[70:71], v9 offset:2048
    v_mfma_f32_16x16x32_bf16 v[104:107], a[72:75], a[36:39], v[104:107]
    buffer_load_dwordx4 v18, s[44:47], s53 offen offset:2048 lds
    v_mfma_f32_16x16x32_bf16 v[112:115], a[72:75], a[40:43], v[112:115]
    ds_read_b128 a[8:11], v6 offset:4096
    v_mfma_f32_16x16x32_bf16 v[120:123], a[72:75], a[44:47], v[120:123]
    v_mfma_f32_16x16x32_bf16 v[128:131], a[72:75], a[48:51], v[128:131]
    v_mfma_f32_16x16x32_bf16 v[136:139], a[72:75], a[52:55], v[136:139]
    buffer_load_dwordx4 v19, s[44:47], s53 offen offset:3072 lds
    v_mfma_f32_16x16x32_bf16 v[144:147], a[72:75], a[56:59], v[144:147]
    s_add_u32 s53, s53, s56
    ds_read_b128 a[12:15], v6 offset:6144
    v_mfma_f32_16x16x32_bf16 v[152:155], a[72:75], a[60:63], v[152:155]
    ds_read_b64_tr_b16 a[72:73], v10 offset:0
    v_mfma_f32_16x16x32_bf16 v[100:103], a[76:79], a[32:35], v[100:103]
    s_add_u32 m0, s62, 4096
    ds_read_b64_tr_b16 a[74:75], v10 offset:2048
    v_mfma_f32_16x16x32_bf16 v[108:111], a[76:79], a[36:39], v[108:111]
    buffer_load_dwordx4 v20, s[44:47], s54 offen offset:0 lds
    v_mfma_f32_16x16x32_bf16 v[116:119], a[76:79], a[40:43], v[116:119]
    ds_read_b128 a[16:19], v6 offset:8192
    v_mfma_f32_16x16x32_bf16 v[124:127], a[76:79], a[44:47], v[124:127]
    s_xor_b32 s62, s62, 229376
    v_mfma_f32_16x16x32_bf16 v[132:135], a[76:79], a[48:51], v[132:135]
    v_mfma_f32_16x16x32_bf16 v[140:143], a[76:79], a[52:55], v[140:143]
    buffer_load_dwordx4 v21, s[44:47], s54 offen offset:1024 lds
    v_mfma_f32_16x16x32_bf16 v[148:151], a[76:79], a[56:59], v[148:151]
    s_add_u32 s54, s54, s56
    ds_read_b128 a[20:23], v6 offset:10240
    v_mfma_f32_16x16x32_bf16 v[156:159], a[76:79], a[60:63], v[156:159]
    ds_read_b64_tr_b16 a[76:77], v11 offset:0
    v_mfma_f32_16x16x32_bf16 v[160:163], a[80:83], a[32:35], v[160:163]
    ds_read_b64_tr_b16 a[78:79], v11 offset:2048
    v_mfma_f32_16x16x32_bf16 v[168:171], a[80:83], a[36:39], v[168:171]
    buffer_load_dwordx4 v20, s[44:47], s55 offen offset:2048 lds
    v_mfma_f32_16x16x32_bf16 v[176:179], a[80:83], a[40:43], v[176:179]
    ds_read_b128 a[24:27], v6 offset:12288
    v_mfma_f32_16x16x32_bf16 v[184:187], a[80:83], a[44:47], v[184:187]
    v_mfma_f32_16x16x32_bf16 v[192:195], a[80:83], a[48:51], v[192:195]
    v_mfma_f32_16x16x32_bf16 v[200:203], a[80:83], a[52:55], v[200:203]
    buffer_load_dwordx4 v21, s[44:47], s55 offen offset:3072 lds
    v_mfma_f32_16x16x32_bf16 v[208:211], a[80:83], a[56:59], v[208:211]
    s_add_u32 s55, s55, s56
    ds_read_b128 a[28:31], v6 offset:14336
    v_mfma_f32_16x16x32_bf16 v[216:219], a[80:83], a[60:63], v[216:219]
    ds_read_b64_tr_b16 a[80:81], v12 offset:0
    v_mfma_f32_16x16x32_bf16 v[164:167], a[84:87], a[32:35], v[164:167]
    ds_read_b64_tr_b16 a[82:83], v12 offset:2048
    v_mfma_f32_16x16x32_bf16 v[172:175], a[84:87], a[36:39], v[172:175]
    v_mfma_f32_16x16x32_bf16 v[180:183], a[84:87], a[40:43], v[180:183]
    buffer_store_dwordx4 a[140:143], v2, s[24:27], s28 offen sc1
    v_mfma_f32_16x16x32_bf16 v[188:191], a[84:87], a[44:47], v[188:191]
    s_add_u32 s28, s28, s31
    v_mfma_f32_16x16x32_bf16 v[196:199], a[84:87], a[48:51], v[196:199]
    v_mfma_f32_16x16x32_bf16 v[204:207], a[84:87], a[52:55], v[204:207]
    v_mfma_f32_16x16x32_bf16 v[212:215], a[84:87], a[56:59], v[212:215]
    buffer_store_dwordx4 a[144:147], v2, s[24:27], s28 offen sc1
    v_mfma_f32_16x16x32_bf16 v[220:223], a[84:87], a[60:63], v[220:223]
    s_add_u32 s28, s28, s31
    ds_read_b64_tr_b16 a[84:85], v13 offset:0
    v_mfma_f32_16x16x32_bf16 v[224:227], a[88:91], a[32:35], v[224:227]
    ds_read_b64_tr_b16 a[86:87], v13 offset:2048
    v_mfma_f32_16x16x32_bf16 v[232:235], a[88:91], a[36:39], v[232:235]
    v_mfma_f32_16x16x32_bf16 v[240:243], a[88:91], a[40:43], v[240:243]
    buffer_store_dwordx4 a[148:151], v2, s[24:27], s28 offen sc1
    v_mfma_f32_16x16x32_bf16 v[248:251], a[88:91], a[44:47], v[248:251]
    s_add_u32 s28, s28, s31
    v_mfma_f32_16x16x32_bf16 a[96:99], a[88:91], a[48:51], a[96:99]
    v_mfma_f32_16x16x32_bf16 a[104:107], a[88:91], a[52:55], a[104:107]
    v_mfma_f32_16x16x32_bf16 a[112:115], a[88:91], a[56:59], a[112:115]
    buffer_store_dwordx4 a[152:155], v2, s[24:27], s28 offen sc1
    v_mfma_f32_16x16x32_bf16 a[120:123], a[88:91], a[60:63], a[120:123]
    s_add_u32 s28, s28, s31
    ds_read_b64_tr_b16 a[88:89], v14 offset:0
    v_mfma_f32_16x16x32_bf16 v[228:231], a[92:95], a[32:35], v[228:231]
    ds_read_b64_tr_b16 a[90:91], v14 offset:2048
    v_mfma_f32_16x16x32_bf16 v[236:239], a[92:95], a[36:39], v[236:239]
    v_mfma_f32_16x16x32_bf16 v[244:247], a[92:95], a[40:43], v[244:247]
    buffer_store_dwordx4 a[156:159], v2, s[24:27], s28 offen sc1
    v_mfma_f32_16x16x32_bf16 v[252:255], a[92:95], a[44:47], v[252:255]
    s_add_u32 s29, s29, s30
    s_mov_b32 s28, s29
    v_mfma_f32_16x16x32_bf16 a[100:103], a[92:95], a[48:51], a[100:103]
    s_sub_u32 s65, s65, 1
    v_mfma_f32_16x16x32_bf16 a[108:111], a[92:95], a[52:55], a[108:111]
    v_mfma_f32_16x16x32_bf16 a[116:119], a[92:95], a[56:59], a[116:119]
    v_mfma_f32_16x16x32_bf16 a[124:127], a[92:95], a[60:63], a[124:127]
    ds_read_b64_tr_b16 a[92:93], v15 offset:0
    ds_read_b64_tr_b16 a[94:95], v15 offset:2048
    s_waitcnt lgkmcnt(15)
    v_mfma_f32_16x16x32_bf16 v[32:35], a[64:67], a[0:3], v[32:35]
    v_mfma_f32_16x16x32_bf16 v[40:43], a[64:67], a[4:7], v[40:43]
    v_mfma_f32_16x16x32_bf16 v[48:51], a[64:67], a[8:11], v[48:51]
    v_mfma_f32_16x16x32_bf16 v[56:59], a[64:67], a[12:15], v[56:59]
    s_add_u32 m0, s61, 0
    s_waitcnt lgkmcnt(13)
    v_mfma_f32_16x16x32_bf16 v[64:67], a[64:67], a[16:19], v[64:67]
    buffer_load_dwordx4 v16, s[40:43], s48 offen offset:0 lds
    s_waitcnt lgkmcnt(12)
    v_mfma_f32_16x16x32_bf16 v[72:75], a[64:67], a[20:23], v[72:75]
    s_waitcnt lgkmcnt(9)
    v_mfma_f32_16x16x32_bf16 v[80:83], a[64:67], a[24:27], v[80:83]
    s_waitcnt lgkmcnt(8)
    v_mfma_f32_16x16x32_bf16 v[88:91], a[64:67], a[28:31], v[88:91]
    ds_read_b64_tr_b16 a[64:65], v8 offset:16384
    v_mfma_f32_16x16x32_bf16 v[36:39], a[68:71], a[0:3], v[36:39]
    ds_read_b64_tr_b16 a[66:67], v8 offset:18432
    v_mfma_f32_16x16x32_bf16 v[44:47], a[68:71], a[4:7], v[44:47]
    v_mfma_f32_16x16x32_bf16 v[52:55], a[68:71], a[8:11], v[52:55]
    ds_read_b128 a[32:35], v7 offset:0
    v_mfma_f32_16x16x32_bf16 v[60:63], a[68:71], a[12:15], v[60:63]
    v_mfma_f32_16x16x32_bf16 v[68:71], a[68:71], a[16:19], v[68:71]
    buffer_load_dwordx4 v17, s[40:43], s48 offen offset:1024 lds
    v_mfma_f32_16x16x32_bf16 v[76:79], a[68:71], a[20:23], v[76:79]
    s_add_u32 s48, s48, 128
    v_mfma_f32_16x16x32_bf16 v[84:87], a[68:71], a[24:27], v[84:87]
    ds_read_b128 a[36:39], v7 offset:2048
    v_mfma_f32_16x16x32_bf16 v[92:95], a[68:71], a[28:31], v[92:95]
    ds_read_b64_tr_b16 a[68:69], v9 offset:16384
    v_mfma_f32_16x16x32_bf16 v[96:99], a[72:75], a[0:3], v[96:99]
    ds_read_b64_tr_b16 a[70:71], v9 offset:18432
    v_mfma_f32_16x16x32_bf16 v[104:107], a[72:75], a[4:7], v[104:107]
    v_mfma_f32_16x16x32_bf16 v[112:115], a[72:75], a[8:11], v[112:115]
    ds_read_b128 a[40:43], v7 offset:4096
    v_mfma_f32_16x16x32_bf16 v[120:123], a[72:75], a[12:15], v[120:123]
    v_mfma_f32_16x16x32_bf16 v[128:131], a[72:75], a[16:19], v[128:131]
    buffer_load_dwordx4 v16, s[40:43], s49 offen offset:2048 lds
    v_mfma_f32_16x16x32_bf16 v[136:139], a[72:75], a[20:23], v[136:139]
    v_mfma_f32_16x16x32_bf16 v[144:147], a[72:75], a[24:27], v[144:147]
    ds_read_b128 a[44:47], v7 offset:6144
    v_mfma_f32_16x16x32_bf16 v[152:155], a[72:75], a[28:31], v[152:155]
    ds_read_b64_tr_b16 a[72:73], v10 offset:16384
    v_mfma_f32_16x16x32_bf16 v[100:103], a[76:79], a[0:3], v[100:103]
    ds_read_b64_tr_b16 a[74:75], v10 offset:18432
    v_mfma_f32_16x16x32_bf16 v[108:111], a[76:79], a[4:7], v[108:111]
    v_mfma_f32_16x16x32_bf16 v[116:119], a[76:79], a[8:11], v[116:119]
    ds_read_b128 a[48:51], v7 offset:8192
    v_mfma_f32_16x16x32_bf16 v[124:127], a[76:79], a[12:15], v[124:127]
    v_mfma_f32_16x16x32_bf16 v[132:135], a[76:79], a[16:19], v[132:135]
    buffer_load_dwordx4 v17, s[40:43], s49 offen offset:3072 lds
    v_mfma_f32_16x16x32_bf16 v[140:143], a[76:79], a[20:23], v[140:143]
    s_add_u32 s49, s49, 128
    v_mfma_f32_16x16x32_bf16 v[148:151], a[76:79], a[24:27], v[148:151]
    ds_read_b128 a[52:55], v7 offset:10240
    v_mfma_f32_16x16x32_bf16 v[156:159], a[76:79], a[28:31], v[156:159]
    ds_read_b64_tr_b16 a[76:77], v11 offset:16384
    s_waitcnt lgkmcnt(15)
    v_mfma_f32_16x16x32_bf16 v[160:163], a[80:83], a[0:3], v[160:163]
    ds_read_b64_tr_b16 a[78:79], v11 offset:18432
    v_mfma_f32_16x16x32_bf16 v[168:171], a[80:83], a[4:7], v[168:171]
    v_mfma_f32_16x16x32_bf16 v[176:179], a[80:83], a[8:11], v[176:179]
    ds_read_b128 a[56:59], v7 offset:12288
    v_mfma_f32_16x16x32_bf16 v[184:187], a[80:83], a[12:15], v[184:187]
    s_add_u32 m0, s61, 4096
    v_mfma_f32_16x16x32_bf16 v[192:195], a[80:83], a[16:19], v[192:195]
    buffer_load_dwordx4 v16, s[40:43], s50 offen offset:0 lds
    v_mfma_f32_16x16x32_bf16 v[200:203], a[80:83], a[20:23], v[200:203]
    v_mfma_f32_16x16x32_bf16 v[208:211], a[80:83], a[24:27], v[208:211]
    s_add_u32 s61, s61, 32768
    ds_read_b128 a[60:63], v7 offset:14336
    v_mfma_f32_16x16x32_bf16 v[216:219], a[80:83], a[28:31], v[216:219]
    s_cmp_ge_u32 s61, 98304
    s_cselect_b32 s90, 98304, 0
    ds_read_b64_tr_b16 a[80:81], v12 offset:16384
    v_mfma_f32_16x16x32_bf16 v[164:167], a[84:87], a[0:3], v[164:167]
    s_sub_u32 s61, s61, s90
    ds_read_b64_tr_b16 a[82:83], v12 offset:18432
    v_mfma_f32_16x16x32_bf16 v[172:175], a[84:87], a[4:7], v[172:175]
    s_add_u32 s64, s64, 32768
    v_mfma_f32_16x16x32_bf16 v[180:183], a[84:87], a[8:11], v[180:183]
    buffer_store_dwordx4 a[160:163], v2, s[24:27], s28 offen sc1
    v_mfma_f32_16x16x32_bf16 v[188:191], a[84:87], a[12:15], v[188:191]
    s_add_u32 s28, s28, s31
    v_mfma_f32_16x16x32_bf16 v[196:199], a[84:87], a[16:19], v[196:199]
    buffer_load_dwordx4 v17, s[40:43], s50 offen offset:1024 lds
    v_mfma_f32_16x16x32_bf16 v[204:207], a[84:87], a[20:23], v[204:207]
    s_add_u32 s50, s50, 128
    v_mfma_f32_16x16x32_bf16 v[212:215], a[84:87], a[24:27], v[212:215]
    s_cmp_ge_u32 s64, 98304
    s_cselect_b32 s63, 4294901760, s59
    s_cselect_b32 s64, 0, s64
    v_mfma_f32_16x16x32_bf16 v[220:223], a[84:87], a[28:31], v[220:223]
    ds_read_b64_tr_b16 a[84:85], v13 offset:16384
    v_mfma_f32_16x16x32_bf16 v[224:227], a[88:91], a[0:3], v[224:227]
    ds_read_b64_tr_b16 a[86:87], v13 offset:18432
    v_mfma_f32_16x16x32_bf16 v[232:235], a[88:91], a[4:7], v[232:235]
    v_mfma_f32_16x16x32_bf16 v[240:243], a[88:91], a[8:11], v[240:243]
    buffer_store_dwordx4 a[164:167], v2, s[24:27], s28 offen sc1
    v_mfma_f32_16x16x32_bf16 v[248:251], a[88:91], a[12:15], v[248:251]
    s_add_u32 s28, s28, s31
    v_mfma_f32_16x16x32_bf16 a[96:99], a[88:91], a[16:19], a[96:99]
    buffer_load_dwordx4 v16, s[40:43], s51 offen offset:2048 lds
    v_mfma_f32_16x16x32_bf16 a[104:107], a[88:91], a[20:23], a[104:107]
    v_mfma_f32_16x16x32_bf16 a[112:115], a[88:91], a[24:27], a[112:115]
    v_mfma_f32_16x16x32_bf16 a[120:123], a[88:91], a[28:31], a[120:123]
    ds_read_b64_tr_b16 a[88:89], v14 offset:16384
    s_waitcnt lgkmcnt(15)
    v_mfma_f32_16x16x32_bf16 v[228:231], a[92:95], a[0:3], v[228:231]
    ds_read_b64_tr_b16 a[90:91], v14 offset:18432
    v_mfma_f32_16x16x32_bf16 v[236:239], a[92:95], a[4:7], v[236:239]
    v_add_u32 v6, s63, v6
    v_add_u32 v7, s63, v7
    v_mfma_f32_16x16x32_bf16 v[244:247], a[92:95], a[8:11], v[244:247]
    buffer_store_dwordx4 a[168:171], v2, s[24:27], s28 offen sc1
    v_mfma_f32_16x16x32_bf16 v[252:255], a[92:95], a[12:15], v[252:255]
    s_add_u32 s28, s28, s31
    v_mfma_f32_16x16x32_bf16 a[100:103], a[92:95], a[16:19], a[100:103]
    buffer_load_dwordx4 v17, s[40:43], s51 offen offset:3072 lds
    v_mfma_f32_16x16x32_bf16 a[108:111], a[92:95], a[20:23], a[108:111]
    s_add_u32 s51, s51, 128
    v_mfma_f32_16x16x32_bf16 a[116:119], a[92:95], a[24:27], a[116:119]
    v_mfma_f32_16x16x32_bf16 a[124:127], a[92:95], a[28:31], a[124:127]
    ds_read_b64_tr_b16 a[92:93], v15 offset:16384
    ds_read_b64_tr_b16 a[94:95], v15 offset:18432
    v_mfma_f32_16x16x32_bf16 v[32:35], a[64:67], a[32:35], v[32:35]
    v_xor_b32 v8, s60, v8
    v_xor_b32 v9, s60, v9
    v_mfma_f32_16x16x32_bf16 v[40:43], a[64:67], a[36:39], v[40:43]
    v_xor_b32 v10, s60, v10
    v_xor_b32 v11, s60, v11
    s_waitcnt lgkmcnt(15)
    v_mfma_f32_16x16x32_bf16 v[48:51], a[64:67], a[40:43], v[48:51]
    v_xor_b32 v12, s60, v12
    v_xor_b32 v13, s60, v13
    v_mfma_f32_16x16x32_bf16 v[56:59], a[64:67], a[44:47], v[56:59]
    v_xor_b32 v14, s60, v14
    v_xor_b32 v15, s60, v15
    s_waitcnt lgkmcnt(13)
    v_mfma_f32_16x16x32_bf16 v[64:67], a[64:67], a[48:51], v[64:67]
    s_waitcnt lgkmcnt(12)
    v_mfma_f32_16x16x32_bf16 v[72:75], a[64:67], a[52:55], v[72:75]
    s_waitcnt lgkmcnt(9)
    v_mfma_f32_16x16x32_bf16 v[80:83], a[64:67], a[56:59], v[80:83]
    s_waitcnt vmcnt(16) lgkmcnt(0)
    v_mfma_f32_16x16x32_bf16 v[88:91], a[64:67], a[60:63], v[88:91]
    s_barrier
    ds_read_b64_tr_b16 a[64:65], v8 offset:0
    v_mfma_f32_16x16x32_bf16 v[36:39], a[68:71], a[32:35], v[36:39]
    s_add_u32 m0, s62, 0
    ds_read_b64_tr_b16 a[66:67], v8 offset:2048
    v_mfma_f32_16x16x32_bf16 v[44:47], a[68:71], a[36:39], v[44:47]
    buffer_load_dwordx4 v18, s[44:47], s52 offen offset:0 lds
    v_mfma_f32_16x16x32_bf16 v[52:55], a[68:71], a[40:43], v[52:55]
    ds_read_b128 a[0:3], v6 offset:0
    v_mfma_f32_16x16x32_bf16 v[60:63], a[68:71], a[44:47], v[60:63]
    v_mfma_f32_16x16x32_bf16 v[68:71], a[68:71], a[48:51], v[68:71]
    v_mfma_f32_16x16x32_bf16 v[76:79], a[68:71], a[52:55], v[76:79]
    buffer_load_dwordx4 v19, s[44:47], s52 offen offset:1024 lds
    v_mfma_f32_16x16x32_bf16 v[84:87], a[68:71], a[56:59], v[84:87]
    s_add_u32 s52, s52, s56
    ds_read_b128 a[4:7], v6 offset:2048
    v_mfma_f32_16x16x32_bf16 v[92:95], a[68:71], a[60:63], v[92:95]
    ds_read_b64_tr_b16 a[68:69], v9 offset:0
    v_mfma_f32_16x16x32_bf16 v[96:99], a[72:75], a[32:35], v[96:99]
    ds_read_b64_tr_b16 a[70:71], v9 offset:2048
    v_mfma_f32_16x16x32_bf16 v[104:107], a[72:75], a[36:39], v[104:107]
    buffer_load_dwordx4 v18, s[44:47], s53 offen offset:2048 lds
    v_mfma_f32_16x16x32_bf16 v[112:115], a[72:75], a[40:43], v[112:115]
    ds_read_b128 a[8:11], v6 offset:4096
    v_mfma_f32_16x16x32_bf16 v[120:123], a[72:75], a[44:47], v[120:123]
    v_mfma_f32_16x16x32_bf16 v[128:131], a[72:75], a[48:51], v[128:131]
    v_mfma_f32_16x16x32_bf16 v[136:139], a[72:75], a[52:55], v[136:139]
    buffer_load_dwordx4 v19, s[44:47], s53 offen offset:3072 lds
    v_mfma_f32_16x16x32_bf16 v[144:147], a[72:75], a[56:59], v[144:147]
    s_add_u32 s53, s53, s56
    ds_read_b128 a[12:15], v6 offset:6144
    v_mfma_f32_16x16x32_bf16 v[152:155], a[72:75], a[60:63], v[152:155]
    ds_read_b64_tr_b16 a[72:73], v10 offset:0
    v_mfma_f32_16x16x32_bf16 v[100:103], a[76:79], a[32:35], v[100:103]
    s_add_u32 m0, s62, 4096
    ds_read_b64_tr_b16 a[74:75], v10 offset:2048
    v_mfma_f32_16x16x32_bf16 v[108:111], a[76:79], a[36:39], v[108:111]
    buffer_load_dwordx4 v20, s[44:47], s54 offen offset:0 lds
    v_mfma_f32_16x16x32_bf16 v[116:119], a[76:79], a[40:43], v[116:119]
    ds_read_b128 a[16:19], v6 offset:8192
    v_mfma_f32_16x16x32_bf16 v[124:127], a[76:79], a[44:47], v[124:127]
    s_xor_b32 s62, s62, 229376
    v_mfma_f32_16x16x32_bf16 v[132:135], a[76:79], a[48:51], v[132:135]
    v_mfma_f32_16x16x32_bf16 v[140:143], a[76:79], a[52:55], v[140:143]
    buffer_load_dwordx4 v21, s[44:47], s54 offen offset:1024 lds
    v_mfma_f32_16x16x32_bf16 v[148:151], a[76:79], a[56:59], v[148:151]
    s_add_u32 s54, s54, s56
    ds_read_b128 a[20:23], v6 offset:10240
    v_mfma_f32_16x16x32_bf16 v[156:159], a[76:79], a[60:63], v[156:159]
    ds_read_b64_tr_b16 a[76:77], v11 offset:0
    v_mfma_f32_16x16x32_bf16 v[160:163], a[80:83], a[32:35], v[160:163]
    ds_read_b64_tr_b16 a[78:79], v11 offset:2048
    v_mfma_f32_16x16x32_bf16 v[168:171], a[80:83], a[36:39], v[168:171]
    buffer_load_dwordx4 v20, s[44:47], s55 offen offset:2048 lds
    v_mfma_f32_16x16x32_bf16 v[176:179], a[80:83], a[40:43], v[176:179]
    ds_read_b128 a[24:27], v6 offset:12288
    v_mfma_f32_16x16x32_bf16 v[184:187], a[80:83], a[44:47], v[184:187]
    v_mfma_f32_16x16x32_bf16 v[192:195], a[80:83], a[48:51], v[192:195]
    v_mfma_f32_16x16x32_bf16 v[200:203], a[80:83], a[52:55], v[200:203]
    buffer_load_dwordx4 v21, s[44:47], s55 offen offset:3072 lds
    v_mfma_f32_16x16x32_bf16 v[208:211], a[80:83], a[56:59], v[208:211]
    s_add_u32 s55, s55, s56
    ds_read_b128 a[28:31], v6 offset:14336
    v_mfma_f32_16x16x32_bf16 v[216:219], a[80:83], a[60:63], v[216:219]
    ds_read_b64_tr_b16 a[80:81], v12 offset:0
    v_mfma_f32_16x16x32_bf16 v[164:167], a[84:87], a[32:35], v[164:167]
    ds_read_b64_tr_b16 a[82:83], v12 offset:2048
    v_mfma_f32_16x16x32_bf16 v[172:175], a[84:87], a[36:39], v[172:175]
    v_mfma_f32_16x16x32_bf16 v[180:183], a[84:87], a[40:43], v[180:183]
    buffer_store_dwordx4 a[172:175], v2, s[24:27], s28 offen sc1
    v_mfma_f32_16x16x32_bf16 v[188:191], a[84:87], a[44:47], v[188:191]
    s_add_u32 s28, s28, s31
    v_mfma_f32_16x16x32_bf16 v[196:199], a[84:87], a[48:51], v[196:199]
    v_mfma_f32_16x16x32_bf16 v[204:207], a[84:87], a[52:55], v[204:207]
    v_mfma_f32_16x16x32_bf16 v[212:215], a[84:87], a[56:59], v[212:215]
    buffer_store_dwordx4 a[176:179], v2, s[24:27], s28 offen sc1
    v_mfma_f32_16x16x32_bf16 v[220:223], a[84:87], a[60:63], v[220:223]
    s_add_u32 s28, s28, s31
    ds_read_b64_tr_b16 a[84:85], v13 offset:0
    v_mfma_f32_16x16x32_bf16 v[224:227], a[88:91], a[32:35], v[224:227]
    ds_read_b64_tr_b16 a[86:87], v13 offset:2048
    v_mfma_f32_16x16x32_bf16 v[232:235], a[88:91], a[36:39], v[232:235]
    v_mfma_f32_16x16x32_bf16 v[240:243], a[88:91], a[40:43], v[240:243]
    buffer_store_dwordx4 a[180:183], v2, s[24:27], s28 offen sc1
    v_mfma_f32_16x16x32_bf16 v[248:251], a[88:91], a[44:47], v[248:251]
    s_add_u32 s28, s28, s31
    v_mfma_f32_16x16x32_bf16 a[96:99], a[88:91], a[48:51], a[96:99]
    v_mfma_f32_16x16x32_bf16 a[104:107], a[88:91], a[52:55], a[104:107]
    v_mfma_f32_16x16x32_bf16 a[112:115], a[88:91], a[56:59], a[112:115]
    buffer_store_dwordx4 a[184:187], v2, s[24:27], s28 offen sc1
    v_mfma_f32_16x16x32_bf16 a[120:123], a[88:91], a[60:63], a[120:123]
    s_add_u32 s28, s28, s31
    ds_read_b64_tr_b16 a[88:89], v14 offset:0
    v_mfma_f32_16x16x32_bf16 v[228:231], a[92:95], a[32:35], v[228:231]
    ds_read_b64_tr_b16 a[90:91], v14 offset:2048
    v_mfma_f32_16x16x32_bf16 v[236:239], a[92:95], a[36:39], v[236:239]
    v_mfma_f32_16x16x32_bf16 v[244:247], a[92:95], a[40:43], v[244:247]
    buffer_store_dwordx4 a[188:191], v2, s[24:27], s28 offen sc1
    v_mfma_f32_16x16x32_bf16 v[252:255], a[92:95], a[44:47], v[252:255]
    s_add_u32 s29, s29, s30
    s_mov_b32 s28, s29
    v_mfma_f32_16x16x32_bf16 a[100:103], a[92:95], a[48:51], a[100:103]
    s_sub_u32 s65, s65, 1
    v_mfma_f32_16x16x32_bf16 a[108:111], a[92:95], a[52:55], a[108:111]
    v_mfma_f32_16x16x32_bf16 a[116:119], a[92:95], a[56:59], a[116:119]
    v_mfma_f32_16x16x32_bf16 a[124:127], a[92:95], a[60:63], a[124:127]
    ds_read_b64_tr_b16 a[92:93], v15 offset:0
    ds_read_b64_tr_b16 a[94:95], v15 offset:2048
    s_cmp_eq_u32 s66, 2
    s_cbranch_scc1 mega_kernel_hook13
mega_kernel_hookr14:
    s_waitcnt lgkmcnt(15)
    v_mfma_f32_16x16x32_bf16 v[32:35], a[64:67], a[0:3], v[32:35]
    v_mfma_f32_16x16x32_bf16 v[40:43], a[64:67], a[4:7], v[40:43]
    v_mfma_f32_16x16x32_bf16 v[48:51], a[64:67], a[8:11], v[48:51]
    v_mfma_f32_16x16x32_bf16 v[56:59], a[64:67], a[12:15], v[56:59]
    s_add_u32 m0, s61, 0
    s_waitcnt lgkmcnt(13)
    v_mfma_f32_16x16x32_bf16 v[64:67], a[64:67], a[16:19], v[64:67]
    buffer_load_dwordx4 v16, s[40:43], s48 offen offset:0 lds
    s_waitcnt lgkmcnt(12)
    v_mfma_f32_16x16x32_bf16 v[72:75], a[64:67], a[20:23], v[72:75]
    s_waitcnt lgkmcnt(9)
    v_mfma_f32_16x16x32_bf16 v[80:83], a[64:67], a[24:27], v[80:83]
    s_waitcnt lgkmcnt(8)
    v_mfma_f32_16x16x32_bf16 v[88:91], a[64:67], a[28:31], v[88:91]
    ds_read_b64_tr_b16 a[64:65], v8 offset:16384
    v_mfma_f32_16x16x32_bf16 v[36:39], a[68:71], a[0:3], v[36:39]
    ds_read_b64_tr_b16 a[66:67], v8 offset:18432
    v_mfma_f32_16x16x32_bf16 v[44:47], a[68:71], a[4:7], v[44:47]
    v_mfma_f32_16x16x32_bf16 v[52:55], a[68:71], a[8:11], v[52:55]
    ds_read_b128 a[32:35], v7 offset:0
    v_mfma_f32_16x16x32_bf16 v[60:63], a[68:71], a[12:15], v[60:63]
    v_mfma_f32_16x16x32_bf16 v[68:71], a[68:71], a[16:19], v[68:71]
    buffer_load_dwordx4 v17, s[40:43], s48 offen offset:1024 lds
    v_mfma_f32_16x16x32_bf16 v[76:79], a[68:71], a[20:23], v[76:79]
    s_add_u32 s48, s48, 128
    v_mfma_f32_16x16x32_bf16 v[84:87], a[68:71], a[24:27], v[84:87]
    ds_read_b128 a[36:39], v7 offset:2048
    v_mfma_f32_16x16x32_bf16 v[92:95], a[68:71], a[28:31], v[92:95]
    ds_read_b64_tr_b16 a[68:69], v9 offset:16384
    v_mfma_f32_16x16x32_bf16 v[96:99], a[72:75], a[0:3], v[96:99]
    ds_read_b64_tr_b16 a[70:71], v9 offset:18432
    v_mfma_f32_16x16x32_bf16 v[104:107], a[72:75], a[4:7], v[104:107]
    v_mfma_f32_16x16x32_bf16 v[112:115], a[72:75], a[8:11], v[112:115]
    ds_read_b128 a[40:43], v7 offset:4096
    v_mfma_f32_16x16x32_bf16 v[120:123], a[72:75], a[12:15], v[120:123]
    v_mfma_f32_16x16x32_bf16 v[128:131], a[72:75], a[16:19], v[128:131]
    buffer_load_dwordx4 v16, s[40:43], s49 offen offset:2048 lds
    v_mfma_f32_16x16x32_bf16 v[136:139], a[72:75], a[20:23], v[136:139]
    v_mfma_f32_16x16x32_bf16 v[144:147], a[72:75], a[24:27], v[144:147]
    ds_read_b128 a[44:47], v7 offset:6144
    v_mfma_f32_16x16x32_bf16 v[152:155], a[72:75], a[28:31], v[152:155]
    ds_read_b64_tr_b16 a[72:73], v10 offset:16384
    v_mfma_f32_16x16x32_bf16 v[100:103], a[76:79], a[0:3], v[100:103]
    ds_read_b64_tr_b16 a[74:75], v10 offset:18432
    v_mfma_f32_16x16x32_bf16 v[108:111], a[76:79], a[4:7], v[108:111]
    v_mfma_f32_16x16x32_bf16 v[116:119], a[76:79], a[8:11], v[116:119]
    ds_read_b128 a[48:51], v7 offset:8192
    v_mfma_f32_16x16x32_bf16 v[124:127], a[76:79], a[12:15], v[124:127]
    v_mfma_f32_16x16x32_bf16 v[132:135], a[76:79], a[16:19], v[132:135]
    buffer_load_dwordx4 v17, s[40:43], s49 offen offset:3072 lds
    v_mfma_f32_16x16x32_bf16 v[140:143], a[76:79], a[20:23], v[140:143]
    s_add_u32 s49, s49, 128
    v_mfma_f32_16x16x32_bf16 v[148:151], a[76:79], a[24:27], v[148:151]
    ds_read_b128 a[52:55], v7 offset:10240
    v_mfma_f32_16x16x32_bf16 v[156:159], a[76:79], a[28:31], v[156:159]
    ds_read_b64_tr_b16 a[76:77], v11 offset:16384
    s_waitcnt lgkmcnt(15)
    v_mfma_f32_16x16x32_bf16 v[160:163], a[80:83], a[0:3], v[160:163]
    ds_read_b64_tr_b16 a[78:79], v11 offset:18432
    v_mfma_f32_16x16x32_bf16 v[168:171], a[80:83], a[4:7], v[168:171]
    v_mfma_f32_16x16x32_bf16 v[176:179], a[80:83], a[8:11], v[176:179]
    ds_read_b128 a[56:59], v7 offset:12288
    v_mfma_f32_16x16x32_bf16 v[184:187], a[80:83], a[12:15], v[184:187]
    s_add_u32 m0, s61, 4096
    v_mfma_f32_16x16x32_bf16 v[192:195], a[80:83], a[16:19], v[192:195]
    buffer_load_dwordx4 v16, s[40:43], s50 offen offset:0 lds
    v_mfma_f32_16x16x32_bf16 v[200:203], a[80:83], a[20:23], v[200:203]
    v_mfma_f32_16x16x32_bf16 v[208:211], a[80:83], a[24:27], v[208:211]
    s_add_u32 s61, s61, 32768
    ds_read_b128 a[60:63], v7 offset:14336
    v_mfma_f32_16x16x32_bf16 v[216:219], a[80:83], a[28:31], v[216:219]
    s_cmp_ge_u32 s61, 98304
    s_cselect_b32 s90, 98304, 0
    ds_read_b64_tr_b16 a[80:81], v12 offset:16384
    v_mfma_f32_16x16x32_bf16 v[164:167], a[84:87], a[0:3], v[164:167]
    s_sub_u32 s61, s61, s90
    ds_read_b64_tr_b16 a[82:83], v12 offset:18432
    v_mfma_f32_16x16x32_bf16 v[172:175], a[84:87], a[4:7], v[172:175]
    s_add_u32 s64, s64, 32768
    v_mfma_f32_16x16x32_bf16 v[180:183], a[84:87], a[8:11], v[180:183]
    buffer_store_dwordx4 a[192:195], v2, s[24:27], s28 offen sc1
    v_mfma_f32_16x16x32_bf16 v[188:191], a[84:87], a[12:15], v[188:191]
    s_add_u32 s28, s28, s31
    v_mfma_f32_16x16x32_bf16 v[196:199], a[84:87], a[16:19], v[196:199]
    buffer_load_dwordx4 v17, s[40:43], s50 offen offset:1024 lds
    v_mfma_f32_16x16x32_bf16 v[204:207], a[84:87], a[20:23], v[204:207]
    s_add_u32 s50, s50, 128
    v_mfma_f32_16x16x32_bf16 v[212:215], a[84:87], a[24:27], v[212:215]
    s_cmp_ge_u32 s64, 98304
    s_cselect_b32 s63, 4294901760, s59
    s_cselect_b32 s64, 0, s64
    v_mfma_f32_16x16x32_bf16 v[220:223], a[84:87], a[28:31], v[220:223]
    ds_read_b64_tr_b16 a[84:85], v13 offset:16384
    v_mfma_f32_16x16x32_bf16 v[224:227], a[88:91], a[0:3], v[224:227]
    ds_read_b64_tr_b16 a[86:87], v13 offset:18432
    v_mfma_f32_16x16x32_bf16 v[232:235], a[88:91], a[4:7], v[232:235]
    v_mfma_f32_16x16x32_bf16 v[240:243], a[88:91], a[8:11], v[240:243]
    buffer_store_dwordx4 a[196:199], v2, s[24:27], s28 offen sc1
    v_mfma_f32_16x16x32_bf16 v[248:251], a[88:91], a[12:15], v[248:251]
    s_add_u32 s28, s28, s31
    v_mfma_f32_16x16x32_bf16 a[96:99], a[88:91], a[16:19], a[96:99]
    buffer_load_dwordx4 v16, s[40:43], s51 offen offset:2048 lds
    v_mfma_f32_16x16x32_bf16 a[104:107], a[88:91], a[20:23], a[104:107]
    v_mfma_f32_16x16x32_bf16 a[112:115], a[88:91], a[24:27], a[112:115]
    v_mfma_f32_16x16x32_bf16 a[120:123], a[88:91], a[28:31], a[120:123]
    ds_read_b64_tr_b16 a[88:89], v14 offset:16384
    s_waitcnt lgkmcnt(15)
    v_mfma_f32_16x16x32_bf16 v[228:231], a[92:95], a[0:3], v[228:231]
    ds_read_b64_tr_b16 a[90:91], v14 offset:18432
    v_mfma_f32_16x16x32_bf16 v[236:239], a[92:95], a[4:7], v[236:239]
    v_add_u32 v6, s63, v6
    v_add_u32 v7, s63, v7
    v_mfma_f32_16x16x32_bf16 v[244:247], a[92:95], a[8:11], v[244:247]
    buffer_store_dwordx4 a[200:203], v2, s[24:27], s28 offen sc1
    v_mfma_f32_16x16x32_bf16 v[252:255], a[92:95], a[12:15], v[252:255]
    s_add_u32 s28, s28, s31
    v_mfma_f32_16x16x32_bf16 a[100:103], a[92:95], a[16:19], a[100:103]
    buffer_load_dwordx4 v17, s[40:43], s51 offen offset:3072 lds
    v_mfma_f32_16x16x32_bf16 a[108:111], a[92:95], a[20:23], a[108:111]
    s_add_u32 s51, s51, 128
    v_mfma_f32_16x16x32_bf16 a[116:119], a[92:95], a[24:27], a[116:119]
    v_mfma_f32_16x16x32_bf16 a[124:127], a[92:95], a[28:31], a[124:127]
    ds_read_b64_tr_b16 a[92:93], v15 offset:16384
    ds_read_b64_tr_b16 a[94:95], v15 offset:18432
    v_mfma_f32_16x16x32_bf16 v[32:35], a[64:67], a[32:35], v[32:35]
    v_xor_b32 v8, s60, v8
    v_xor_b32 v9, s60, v9
    v_mfma_f32_16x16x32_bf16 v[40:43], a[64:67], a[36:39], v[40:43]
    v_xor_b32 v10, s60, v10
    v_xor_b32 v11, s60, v11
    s_waitcnt lgkmcnt(15)
    v_mfma_f32_16x16x32_bf16 v[48:51], a[64:67], a[40:43], v[48:51]
    v_xor_b32 v12, s60, v12
    v_xor_b32 v13, s60, v13
    v_mfma_f32_16x16x32_bf16 v[56:59], a[64:67], a[44:47], v[56:59]
    v_xor_b32 v14, s60, v14
    v_xor_b32 v15, s60, v15
    s_waitcnt lgkmcnt(13)
    v_mfma_f32_16x16x32_bf16 v[64:67], a[64:67], a[48:51], v[64:67]
    s_waitcnt lgkmcnt(12)
    v_mfma_f32_16x16x32_bf16 v[72:75], a[64:67], a[52:55], v[72:75]
    s_waitcnt lgkmcnt(9)
    v_mfma_f32_16x16x32_bf16 v[80:83], a[64:67], a[56:59], v[80:83]
    s_waitcnt vmcnt(16) lgkmcnt(0)
    v_mfma_f32_16x16x32_bf16 v[88:91], a[64:67], a[60:63], v[88:91]
    s_barrier
    ds_read_b64_tr_b16 a[64:65], v8 offset:0
    v_mfma_f32_16x16x32_bf16 v[36:39], a[68:71], a[32:35], v[36:39]
    s_add_u32 m0, s62, 0
    ds_read_b64_tr_b16 a[66:67], v8 offset:2048
    v_mfma_f32_16x16x32_bf16 v[44:47], a[68:71], a[36:39], v[44:47]
    buffer_load_dwordx4 v18, s[44:47], s52 offen offset:0 lds
    v_mfma_f32_16x16x32_bf16 v[52:55], a[68:71], a[40:43], v[52:55]
    ds_read_b128 a[0:3], v6 offset:0
    v_mfma_f32_16x16x32_bf16 v[60:63], a[68:71], a[44:47], v[60:63]
    v_mfma_f32_16x16x32_bf16 v[68:71], a[68:71], a[48:51], v[68:71]
    v_mfma_f32_16x16x32_bf16 v[76:79], a[68:71], a[52:55], v[76:79]
    buffer_load_dwordx4 v19, s[44:47], s52 offen offset:1024 lds
    v_mfma_f32_16x16x32_bf16 v[84:87], a[68:71], a[56:59], v[84:87]
    s_add_u32 s52, s52, s56
    ds_read_b128 a[4:7], v6 offset:2048
    v_mfma_f32_16x16x32_bf16 v[92:95], a[68:71], a[60:63], v[92:95]
    ds_read_b64_tr_b16 a[68:69], v9 offset:0
    v_mfma_f32_16x16x32_bf16 v[96:99], a[72:75], a[32:35], v[96:99]
    ds_read_b64_tr_b16 a[70:71], v9 offset:2048
    v_mfma_f32_16x16x32_bf16 v[104:107], a[72:75], a[36:39], v[104:107]
    buffer_load_dwordx4 v18, s[44:47], s53 offen offset:2048 lds
    v_mfma_f32_16x16x32_bf16 v[112:115], a[72:75], a[40:43], v[112:115]
    ds_read_b128 a[8:11], v6 offset:4096
    v_mfma_f32_16x16x32_bf16 v[120:123], a[72:75], a[44:47], v[120:123]
    v_mfma_f32_16x16x32_bf16 v[128:131], a[72:75], a[48:51], v[128:131]
    v_mfma_f32_16x16x32_bf16 v[136:139], a[72:75], a[52:55], v[136:139]
    buffer_load_dwordx4 v19, s[44:47], s53 offen offset:3072 lds
    v_mfma_f32_16x16x32_bf16 v[144:147], a[72:75], a[56:59], v[144:147]
    s_add_u32 s53, s53, s56
    ds_read_b128 a[12:15], v6 offset:6144
    v_mfma_f32_16x16x32_bf16 v[152:155], a[72:75], a[60:63], v[152:155]
    ds_read_b64_tr_b16 a[72:73], v10 offset:0
    v_mfma_f32_16x16x32_bf16 v[100:103], a[76:79], a[32:35], v[100:103]
    s_add_u32 m0, s62, 4096
    ds_read_b64_tr_b16 a[74:75], v10 offset:2048
    v_mfma_f32_16x16x32_bf16 v[108:111], a[76:79], a[36:39], v[108:111]
    buffer_load_dwordx4 v20, s[44:47], s54 offen offset:0 lds
    v_mfma_f32_16x16x32_bf16 v[116:119], a[76:79], a[40:43], v[116:119]
    ds_read_b128 a[16:19], v6 offset:8192
    v_mfma_f32_16x16x32_bf16 v[124:127], a[76:79], a[44:47], v[124:127]
    s_xor_b32 s62, s62, 229376
    v_mfma_f32_16x16x32_bf16 v[132:135], a[76:79], a[48:51], v[132:135]
    v_mfma_f32_16x16x32_bf16 v[140:143], a[76:79], a[52:55], v[140:143]
    buffer_load_dwordx4 v21, s[44:47], s54 offen offset:1024 lds
    v_mfma_f32_16x16x32_bf16 v[148:151], a[76:79], a[56:59], v[148:151]
    s_add_u32 s54, s54, s56
    ds_read_b128 a[20:23], v6 offset:10240
    v_mfma_f32_16x16x32_bf16 v[156:159], a[76:79], a[60:63], v[156:159]
    ds_read_b64_tr_b16 a[76:77], v11 offset:0
    v_mfma_f32_16x16x32_bf16 v[160:163], a[80:83], a[32:35], v[160:163]
    ds_read_b64_tr_b16 a[78:79], v11 offset:2048
    v_mfma_f32_16x16x32_bf16 v[168:171], a[80:83], a[36:39], v[168:171]
    buffer_load_dwordx4 v20, s[44:47], s55 offen offset:2048 lds
    v_mfma_f32_16x16x32_bf16 v[176:179], a[80:83], a[40:43], v[176:179]
    ds_read_b128 a[24:27], v6 offset:12288
    v_mfma_f32_16x16x32_bf16 v[184:187], a[80:83], a[44:47], v[184:187]
    v_mfma_f32_16x16x32_bf16 v[192:195], a[80:83], a[48:51], v[192:195]
    v_mfma_f32_16x16x32_bf16 v[200:203], a[80:83], a[52:55], v[200:203]
    buffer_load_dwordx4 v21, s[44:47], s55 offen offset:3072 lds
    v_mfma_f32_16x16x32_bf16 v[208:211], a[80:83], a[56:59], v[208:211]
    s_add_u32 s55, s55, s56
    ds_read_b128 a[28:31], v6 offset:14336
    v_mfma_f32_16x16x32_bf16 v[216:219], a[80:83], a[60:63], v[216:219]
    ds_read_b64_tr_b16 a[80:81], v12 offset:0
    v_mfma_f32_16x16x32_bf16 v[164:167], a[84:87], a[32:35], v[164:167]
    ds_read_b64_tr_b16 a[82:83], v12 offset:2048
    v_mfma_f32_16x16x32_bf16 v[172:175], a[84:87], a[36:39], v[172:175]
    v_mfma_f32_16x16x32_bf16 v[180:183], a[84:87], a[40:43], v[180:183]
    buffer_store_dwordx4 a[204:207], v2, s[24:27], s28 offen sc1
    v_mfma_f32_16x16x32_bf16 v[188:191], a[84:87], a[44:47], v[188:191]
    s_add_u32 s28, s28, s31
    v_mfma_f32_16x16x32_bf16 v[196:199], a[84:87], a[48:51], v[196:199]
    v_mfma_f32_16x16x32_bf16 v[204:207], a[84:87], a[52:55], v[204:207]
    v_mfma_f32_16x16x32_bf16 v[212:215], a[84:87], a[56:59], v[212:215]
    buffer_store_dwordx4 a[208:211], v2, s[24:27], s28 offen sc1
    v_mfma_f32_16x16x32_bf16 v[220:223], a[84:87], a[60:63], v[220:223]
    s_add_u32 s28, s28, s31
    ds_read_b64_tr_b16 a[84:85], v13 offset:0
    v_mfma_f32_16x16x32_bf16 v[224:227], a[88:91], a[32:35], v[224:227]
    ds_read_b64_tr_b16 a[86:87], v13 offset:2048
    v_mfma_f32_16x16x32_bf16 v[232:235], a[88:91], a[36:39], v[232:235]
    v_mfma_f32_16x16x32_bf16 v[240:243], a[88:91], a[40:43], v[240:243]
    buffer_store_dwordx4 a[212:215], v2, s[24:27], s28 offen sc1
    v_mfma_f32_16x16x32_bf16 v[248:251], a[88:91], a[44:47], v[248:251]
    s_add_u32 s28, s28, s31
    v_mfma_f32_16x16x32_bf16 a[96:99], a[88:91], a[48:51], a[96:99]
    v_mfma_f32_16x16x32_bf16 a[104:107], a[88:91], a[52:55], a[104:107]
    v_mfma_f32_16x16x32_bf16 a[112:115], a[88:91], a[56:59], a[112:115]
    buffer_store_dwordx4 a[216:219], v2, s[24:27], s28 offen sc1
    v_mfma_f32_16x16x32_bf16 a[120:123], a[88:91], a[60:63], a[120:123]
    s_add_u32 s28, s28, s31
    ds_read_b64_tr_b16 a[88:89], v14 offset:0
    v_mfma_f32_16x16x32_bf16 v[228:231], a[92:95], a[32:35], v[228:231]
    ds_read_b64_tr_b16 a[90:91], v14 offset:2048
    v_mfma_f32_16x16x32_bf16 v[236:239], a[92:95], a[36:39], v[236:239]
    v_mfma_f32_16x16x32_bf16 v[244:247], a[92:95], a[40:43], v[244:247]
    buffer_store_dwordx4 a[220:223], v2, s[24:27], s28 offen sc1
    v_mfma_f32_16x16x32_bf16 v[252:255], a[92:95], a[44:47], v[252:255]
    s_add_u32 s29, s29, s30
    s_mov_b32 s28, s29
    v_mfma_f32_16x16x32_bf16 a[100:103], a[92:95], a[48:51], a[100:103]
    s_sub_u32 s65, s65, 1
    v_mfma_f32_16x16x32_bf16 a[108:111], a[92:95], a[52:55], a[108:111]
    v_mfma_f32_16x16x32_bf16 a[116:119], a[92:95], a[56:59], a[116:119]
    v_mfma_f32_16x16x32_bf16 a[124:127], a[92:95], a[60:63], a[124:127]
    ds_read_b64_tr_b16 a[92:93], v15 offset:0
    ds_read_b64_tr_b16 a[94:95], v15 offset:2048
    s_waitcnt lgkmcnt(15)
    v_mfma_f32_16x16x32_bf16 v[32:35], a[64:67], a[0:3], v[32:35]
    v_mfma_f32_16x16x32_bf16 v[40:43], a[64:67], a[4:7], v[40:43]
    v_mfma_f32_16x16x32_bf16 v[48:51], a[64:67], a[8:11], v[48:51]
    v_mfma_f32_16x16x32_bf16 v[56:59], a[64:67], a[12:15], v[56:59]
    s_add_u32 m0, s61, 0
    s_waitcnt lgkmcnt(13)
    v_mfma_f32_16x16x32_bf16 v[64:67], a[64:67], a[16:19], v[64:67]
    buffer_load_dwordx4 v16, s[40:43], s48 offen offset:0 lds
    s_waitcnt lgkmcnt(12)
    v_mfma_f32_16x16x32_bf16 v[72:75], a[64:67], a[20:23], v[72:75]
    s_waitcnt lgkmcnt(9)
    v_mfma_f32_16x16x32_bf16 v[80:83], a[64:67], a[24:27], v[80:83]
    s_waitcnt lgkmcnt(8)
    v_mfma_f32_16x16x32_bf16 v[88:91], a[64:67], a[28:31], v[88:91]
    ds_read_b64_tr_b16 a[64:65], v8 offset:16384
    v_mfma_f32_16x16x32_bf16 v[36:39], a[68:71], a[0:3], v[36:39]
    ds_read_b64_tr_b16 a[66:67], v8 offset:18432
    v_mfma_f32_16x16x32_bf16 v[44:47], a[68:71], a[4:7], v[44:47]
    v_mfma_f32_16x16x32_bf16 v[52:55], a[68:71], a[8:11], v[52:55]
    ds_read_b128 a[32:35], v7 offset:0
    v_mfma_f32_16x16x32_bf16 v[60:63], a[68:71], a[12:15], v[60:63]
    v_mfma_f32_16x16x32_bf16 v[68:71], a[68:71], a[16:19], v[68:71]
    buffer_load_dwordx4 v17, s[40:43], s48 offen offset:1024 lds
    v_mfma_f32_16x16x32_bf16 v[76:79], a[68:71], a[20:23], v[76:79]
    s_add_u32 s48, s48, 128
    v_mfma_f32_16x16x32_bf16 v[84:87], a[68:71], a[24:27], v[84:87]
    ds_read_b128 a[36:39], v7 offset:2048
    v_mfma_f32_16x16x32_bf16 v[92:95], a[68:71], a[28:31], v[92:95]
    ds_read_b64_tr_b16 a[68:69], v9 offset:16384
    v_mfma_f32_16x16x32_bf16 v[96:99], a[72:75], a[0:3], v[96:99]
    ds_read_b64_tr_b16 a[70:71], v9 offset:18432
    v_mfma_f32_16x16x32_bf16 v[104:107], a[72:75], a[4:7], v[104:107]
    v_mfma_f32_16x16x32_bf16 v[112:115], a[72:75], a[8:11], v[112:115]
    ds_read_b128 a[40:43], v7 offset:4096
    v_mfma_f32_16x16x32_bf16 v[120:123], a[72:75], a[12:15], v[120:123]
    v_mfma_f32_16x16x32_bf16 v[128:131], a[72:75], a[16:19], v[128:131]
    buffer_load_dwordx4 v16, s[40:43], s49 offen offset:2048 lds
    v_mfma_f32_16x16x32_bf16 v[136:139], a[72:75], a[20:23], v[136:139]
    v_mfma_f32_16x16x32_bf16 v[144:147], a[72:75], a[24:27], v[144:147]
    ds_read_b128 a[44:47], v7 offset:6144
    v_mfma_f32_16x16x32_bf16 v[152:155], a[72:75], a[28:31], v[152:155]
    ds_read_b64_tr_b16 a[72:73], v10 offset:16384
    v_mfma_f32_16x16x32_bf16 v[100:103], a[76:79], a[0:3], v[100:103]
    ds_read_b64_tr_b16 a[74:75], v10 offset:18432
    v_mfma_f32_16x16x32_bf16 v[108:111], a[76:79], a[4:7], v[108:111]
    v_mfma_f32_16x16x32_bf16 v[116:119], a[76:79], a[8:11], v[116:119]
    ds_read_b128 a[48:51], v7 offset:8192
    v_mfma_f32_16x16x32_bf16 v[124:127], a[76:79], a[12:15], v[124:127]
    v_mfma_f32_16x16x32_bf16 v[132:135], a[76:79], a[16:19], v[132:135]
    buffer_load_dwordx4 v17, s[40:43], s49 offen offset:3072 lds
    v_mfma_f32_16x16x32_bf16 v[140:143], a[76:79], a[20:23], v[140:143]
    s_add_u32 s49, s49, 128
    v_mfma_f32_16x16x32_bf16 v[148:151], a[76:79], a[24:27], v[148:151]
    ds_read_b128 a[52:55], v7 offset:10240
    v_mfma_f32_16x16x32_bf16 v[156:159], a[76:79], a[28:31], v[156:159]
    ds_read_b64_tr_b16 a[76:77], v11 offset:16384
    s_waitcnt lgkmcnt(15)
    v_mfma_f32_16x16x32_bf16 v[160:163], a[80:83], a[0:3], v[160:163]
    ds_read_b64_tr_b16 a[78:79], v11 offset:18432
    v_mfma_f32_16x16x32_bf16 v[168:171], a[80:83], a[4:7], v[168:171]
    v_mfma_f32_16x16x32_bf16 v[176:179], a[80:83], a[8:11], v[176:179]
    ds_read_b128 a[56:59], v7 offset:12288
    v_mfma_f32_16x16x32_bf16 v[184:187], a[80:83], a[12:15], v[184:187]
    s_add_u32 m0, s61, 4096
    v_mfma_f32_16x16x32_bf16 v[192:195], a[80:83], a[16:19], v[192:195]
    buffer_load_dwordx4 v16, s[40:43], s50 offen offset:0 lds
    v_mfma_f32_16x16x32_bf16 v[200:203], a[80:83], a[20:23], v[200:203]
    v_mfma_f32_16x16x32_bf16 v[208:211], a[80:83], a[24:27], v[208:211]
    s_add_u32 s61, s61, 32768
    ds_read_b128 a[60:63], v7 offset:14336
    v_mfma_f32_16x16x32_bf16 v[216:219], a[80:83], a[28:31], v[216:219]
    s_cmp_ge_u32 s61, 98304
    s_cselect_b32 s90, 98304, 0
    ds_read_b64_tr_b16 a[80:81], v12 offset:16384
    v_mfma_f32_16x16x32_bf16 v[164:167], a[84:87], a[0:3], v[164:167]
    s_sub_u32 s61, s61, s90
    ds_read_b64_tr_b16 a[82:83], v12 offset:18432
    v_mfma_f32_16x16x32_bf16 v[172:175], a[84:87], a[4:7], v[172:175]
    s_add_u32 s64, s64, 32768
    v_mfma_f32_16x16x32_bf16 v[180:183], a[84:87], a[8:11], v[180:183]
    buffer_store_dwordx4 a[224:227], v2, s[24:27], s28 offen sc1
    v_mfma_f32_16x16x32_bf16 v[188:191], a[84:87], a[12:15], v[188:191]
    s_add_u32 s28, s28, s31
    v_mfma_f32_16x16x32_bf16 v[196:199], a[84:87], a[16:19], v[196:199]
    buffer_load_dwordx4 v17, s[40:43], s50 offen offset:1024 lds
    v_mfma_f32_16x16x32_bf16 v[204:207], a[84:87], a[20:23], v[204:207]
    s_add_u32 s50, s50, 128
    v_mfma_f32_16x16x32_bf16 v[212:215], a[84:87], a[24:27], v[212:215]
    s_cmp_ge_u32 s64, 98304
    s_cselect_b32 s63, 4294901760, s59
    s_cselect_b32 s64, 0, s64
    v_mfma_f32_16x16x32_bf16 v[220:223], a[84:87], a[28:31], v[220:223]
    ds_read_b64_tr_b16 a[84:85], v13 offset:16384
    v_mfma_f32_16x16x32_bf16 v[224:227], a[88:91], a[0:3], v[224:227]
    ds_read_b64_tr_b16 a[86:87], v13 offset:18432
    v_mfma_f32_16x16x32_bf16 v[232:235], a[88:91], a[4:7], v[232:235]
    v_mfma_f32_16x16x32_bf16 v[240:243], a[88:91], a[8:11], v[240:243]
    buffer_store_dwordx4 a[228:231], v2, s[24:27], s28 offen sc1
    v_mfma_f32_16x16x32_bf16 v[248:251], a[88:91], a[12:15], v[248:251]
    s_add_u32 s28, s28, s31
    v_mfma_f32_16x16x32_bf16 a[96:99], a[88:91], a[16:19], a[96:99]
    buffer_load_dwordx4 v16, s[40:43], s51 offen offset:2048 lds
    v_mfma_f32_16x16x32_bf16 a[104:107], a[88:91], a[20:23], a[104:107]
    v_mfma_f32_16x16x32_bf16 a[112:115], a[88:91], a[24:27], a[112:115]
    v_mfma_f32_16x16x32_bf16 a[120:123], a[88:91], a[28:31], a[120:123]
    ds_read_b64_tr_b16 a[88:89], v14 offset:16384
    s_waitcnt lgkmcnt(15)
    v_mfma_f32_16x16x32_bf16 v[228:231], a[92:95], a[0:3], v[228:231]
    ds_read_b64_tr_b16 a[90:91], v14 offset:18432
    v_mfma_f32_16x16x32_bf16 v[236:239], a[92:95], a[4:7], v[236:239]
    v_add_u32 v6, s63, v6
    v_add_u32 v7, s63, v7
    v_mfma_f32_16x16x32_bf16 v[244:247], a[92:95], a[8:11], v[244:247]
    buffer_store_dwordx4 a[232:235], v2, s[24:27], s28 offen sc1
    v_mfma_f32_16x16x32_bf16 v[252:255], a[92:95], a[12:15], v[252:255]
    s_add_u32 s28, s28, s31
    v_mfma_f32_16x16x32_bf16 a[100:103], a[92:95], a[16:19], a[100:103]
    buffer_load_dwordx4 v17, s[40:43], s51 offen offset:3072 lds
    v_mfma_f32_16x16x32_bf16 a[108:111], a[92:95], a[20:23], a[108:111]
    s_add_u32 s51, s51, 128
    v_mfma_f32_16x16x32_bf16 a[116:119], a[92:95], a[24:27], a[116:119]
    v_mfma_f32_16x16x32_bf16 a[124:127], a[92:95], a[28:31], a[124:127]
    ds_read_b64_tr_b16 a[92:93], v15 offset:16384
    ds_read_b64_tr_b16 a[94:95], v15 offset:18432
    v_mfma_f32_16x16x32_bf16 v[32:35], a[64:67], a[32:35], v[32:35]
    v_xor_b32 v8, s60, v8
    v_xor_b32 v9, s60, v9
    v_mfma_f32_16x16x32_bf16 v[40:43], a[64:67], a[36:39], v[40:43]
    v_xor_b32 v10, s60, v10
    v_xor_b32 v11, s60, v11
    s_waitcnt lgkmcnt(15)
    v_mfma_f32_16x16x32_bf16 v[48:51], a[64:67], a[40:43], v[48:51]
    v_xor_b32 v12, s60, v12
    v_xor_b32 v13, s60, v13
    v_mfma_f32_16x16x32_bf16 v[56:59], a[64:67], a[44:47], v[56:59]
    v_xor_b32 v14, s60, v14
    v_xor_b32 v15, s60, v15
    s_waitcnt lgkmcnt(13)
    v_mfma_f32_16x16x32_bf16 v[64:67], a[64:67], a[48:51], v[64:67]
    s_waitcnt lgkmcnt(12)
    v_mfma_f32_16x16x32_bf16 v[72:75], a[64:67], a[52:55], v[72:75]
    s_waitcnt lgkmcnt(9)
    v_mfma_f32_16x16x32_bf16 v[80:83], a[64:67], a[56:59], v[80:83]
    s_waitcnt vmcnt(16) lgkmcnt(0)
    v_mfma_f32_16x16x32_bf16 v[88:91], a[64:67], a[60:63], v[88:91]
    s_barrier
    ds_read_b64_tr_b16 a[64:65], v8 offset:0
    v_mfma_f32_16x16x32_bf16 v[36:39], a[68:71], a[32:35], v[36:39]
    s_add_u32 m0, s62, 0
    ds_read_b64_tr_b16 a[66:67], v8 offset:2048
    v_mfma_f32_16x16x32_bf16 v[44:47], a[68:71], a[36:39], v[44:47]
    buffer_load_dwordx4 v18, s[44:47], s52 offen offset:0 lds
    v_mfma_f32_16x16x32_bf16 v[52:55], a[68:71], a[40:43], v[52:55]
    ds_read_b128 a[0:3], v6 offset:0
    v_mfma_f32_16x16x32_bf16 v[60:63], a[68:71], a[44:47], v[60:63]
    v_mfma_f32_16x16x32_bf16 v[68:71], a[68:71], a[48:51], v[68:71]
    v_mfma_f32_16x16x32_bf16 v[76:79], a[68:71], a[52:55], v[76:79]
    buffer_load_dwordx4 v19, s[44:47], s52 offen offset:1024 lds
    v_mfma_f32_16x16x32_bf16 v[84:87], a[68:71], a[56:59], v[84:87]
    s_add_u32 s52, s52, s56
    ds_read_b128 a[4:7], v6 offset:2048
    v_mfma_f32_16x16x32_bf16 v[92:95], a[68:71], a[60:63], v[92:95]
    ds_read_b64_tr_b16 a[68:69], v9 offset:0
    v_mfma_f32_16x16x32_bf16 v[96:99], a[72:75], a[32:35], v[96:99]
    ds_read_b64_tr_b16 a[70:71], v9 offset:2048
    v_mfma_f32_16x16x32_bf16 v[104:107], a[72:75], a[36:39], v[104:107]
    buffer_load_dwordx4 v18, s[44:47], s53 offen offset:2048 lds
    v_mfma_f32_16x16x32_bf16 v[112:115], a[72:75], a[40:43], v[112:115]
    ds_read_b128 a[8:11], v6 offset:4096
    v_mfma_f32_16x16x32_bf16 v[120:123], a[72:75], a[44:47], v[120:123]
    v_mfma_f32_16x16x32_bf16 v[128:131], a[72:75], a[48:51], v[128:131]
    v_mfma_f32_16x16x32_bf16 v[136:139], a[72:75], a[52:55], v[136:139]
    buffer_load_dwordx4 v19, s[44:47], s53 offen offset:3072 lds
    v_mfma_f32_16x16x32_bf16 v[144:147], a[72:75], a[56:59], v[144:147]
    s_add_u32 s53, s53, s56
    ds_read_b128 a[12:15], v6 offset:6144
    v_mfma_f32_16x16x32_bf16 v[152:155], a[72:75], a[60:63], v[152:155]
    ds_read_b64_tr_b16 a[72:73], v10 offset:0
    v_mfma_f32_16x16x32_bf16 v[100:103], a[76:79], a[32:35], v[100:103]
    s_add_u32 m0, s62, 4096
    ds_read_b64_tr_b16 a[74:75], v10 offset:2048
    v_mfma_f32_16x16x32_bf16 v[108:111], a[76:79], a[36:39], v[108:111]
    buffer_load_dwordx4 v20, s[44:47], s54 offen offset:0 lds
    v_mfma_f32_16x16x32_bf16 v[116:119], a[76:79], a[40:43], v[116:119]
    ds_read_b128 a[16:19], v6 offset:8192
    v_mfma_f32_16x16x32_bf16 v[124:127], a[76:79], a[44:47], v[124:127]
    s_xor_b32 s62, s62, 229376
    v_mfma_f32_16x16x32_bf16 v[132:135], a[76:79], a[48:51], v[132:135]
    v_mfma_f32_16x16x32_bf16 v[140:143], a[76:79], a[52:55], v[140:143]
    buffer_load_dwordx4 v21, s[44:47], s54 offen offset:1024 lds
    v_mfma_f32_16x16x32_bf16 v[148:151], a[76:79], a[56:59], v[148:151]
    s_add_u32 s54, s54, s56
    ds_read_b128 a[20:23], v6 offset:10240
    v_mfma_f32_16x16x32_bf16 v[156:159], a[76:79], a[60:63], v[156:159]
    ds_read_b64_tr_b16 a[76:77], v11 offset:0
    v_mfma_f32_16x16x32_bf16 v[160:163], a[80:83], a[32:35], v[160:163]
    ds_read_b64_tr_b16 a[78:79], v11 offset:2048
    v_mfma_f32_16x16x32_bf16 v[168:171], a[80:83], a[36:39], v[168:171]
    buffer_load_dwordx4 v20, s[44:47], s55 offen offset:2048 lds
    v_mfma_f32_16x16x32_bf16 v[176:179], a[80:83], a[40:43], v[176:179]
    ds_read_b128 a[24:27], v6 offset:12288
    v_mfma_f32_16x16x32_bf16 v[184:187], a[80:83], a[44:47], v[184:187]
    v_mfma_f32_16x16x32_bf16 v[192:195], a[80:83], a[48:51], v[192:195]
    v_mfma_f32_16x16x32_bf16 v[200:203], a[80:83], a[52:55], v[200:203]
    buffer_load_dwordx4 v21, s[44:47], s55 offen offset:3072 lds
    v_mfma_f32_16x16x32_bf16 v[208:211], a[80:83], a[56:59], v[208:211]
    s_add_u32 s55, s55, s56
    ds_read_b128 a[28:31], v6 offset:14336
    v_mfma_f32_16x16x32_bf16 v[216:219], a[80:83], a[60:63], v[216:219]
    ds_read_b64_tr_b16 a[80:81], v12 offset:0
    v_mfma_f32_16x16x32_bf16 v[164:167], a[84:87], a[32:35], v[164:167]
    ds_read_b64_tr_b16 a[82:83], v12 offset:2048
    v_mfma_f32_16x16x32_bf16 v[172:175], a[84:87], a[36:39], v[172:175]
    v_mfma_f32_16x16x32_bf16 v[180:183], a[84:87], a[40:43], v[180:183]
    buffer_store_dwordx4 a[236:239], v2, s[24:27], s28 offen sc1
    v_mfma_f32_16x16x32_bf16 v[188:191], a[84:87], a[44:47], v[188:191]
    s_add_u32 s28, s28, s31
    v_mfma_f32_16x16x32_bf16 v[196:199], a[84:87], a[48:51], v[196:199]
    v_mfma_f32_16x16x32_bf16 v[204:207], a[84:87], a[52:55], v[204:207]
    v_mfma_f32_16x16x32_bf16 v[212:215], a[84:87], a[56:59], v[212:215]
    buffer_store_dwordx4 a[240:243], v2, s[24:27], s28 offen sc1
    v_mfma_f32_16x16x32_bf16 v[220:223], a[84:87], a[60:63], v[220:223]
    s_add_u32 s28, s28, s31
    ds_read_b64_tr_b16 a[84:85], v13 offset:0
    v_mfma_f32_16x16x32_bf16 v[224:227], a[88:91], a[32:35], v[224:227]
    ds_read_b64_tr_b16 a[86:87], v13 offset:2048
    v_mfma_f32_16x16x32_bf16 v[232:235], a[88:91], a[36:39], v[232:235]
    v_mfma_f32_16x16x32_bf16 v[240:243], a[88:91], a[40:43], v[240:243]
    buffer_store_dwordx4 a[244:247], v2, s[24:27], s28 offen sc1
    v_mfma_f32_16x16x32_bf16 v[248:251], a[88:91], a[44:47], v[248:251]
    s_add_u32 s28, s28, s31
    v_mfma_f32_16x16x32_bf16 a[96:99], a[88:91], a[48:51], a[96:99]
    v_mfma_f32_16x16x32_bf16 a[104:107], a[88:91], a[52:55], a[104:107]
    v_mfma_f32_16x16x32_bf16 a[112:115], a[88:91], a[56:59], a[112:115]
    buffer_store_dwordx4 a[248:251], v2, s[24:27], s28 offen sc1
    v_mfma_f32_16x16x32_bf16 a[120:123], a[88:91], a[60:63], a[120:123]
    s_add_u32 s28, s28, s31
    ds_read_b64_tr_b16 a[88:89], v14 offset:0
    v_mfma_f32_16x16x32_bf16 v[228:231], a[92:95], a[32:35], v[228:231]
    ds_read_b64_tr_b16 a[90:91], v14 offset:2048
    v_mfma_f32_16x16x32_bf16 v[236:239], a[92:95], a[36:39], v[236:239]
    v_mfma_f32_16x16x32_bf16 v[244:247], a[92:95], a[40:43], v[244:247]
    buffer_store_dwordx4 a[252:255], v2, s[24:27], s28 offen sc1
    v_mfma_f32_16x16x32_bf16 v[252:255], a[92:95], a[44:47], v[252:255]
    s_add_u32 s29, s29, s30
    s_mov_b32 s28, s29
    v_mfma_f32_16x16x32_bf16 a[100:103], a[92:95], a[48:51], a[100:103]
    s_sub_u32 s65, s65, 1
    v_mfma_f32_16x16x32_bf16 a[108:111], a[92:95], a[52:55], a[108:111]
    v_mfma_f32_16x16x32_bf16 a[116:119], a[92:95], a[56:59], a[116:119]
    v_mfma_f32_16x16x32_bf16 a[124:127], a[92:95], a[60:63], a[124:127]
    ds_read_b64_tr_b16 a[92:93], v15 offset:0
    ds_read_b64_tr_b16 a[94:95], v15 offset:2048
mega_kernel_loop15:
    s_waitcnt lgkmcnt(15)
    v_mfma_f32_16x16x32_bf16 v[32:35], a[64:67], a[0:3], v[32:35]
    v_mfma_f32_16x16x32_bf16 v[40:43], a[64:67], a[4:7], v[40:43]
    v_mfma_f32_16x16x32_bf16 v[48:51], a[64:67], a[8:11], v[48:51]
    v_mfma_f32_16x16x32_bf16 v[56:59], a[64:67], a[12:15], v[56:59]
    s_add_u32 m0, s61, 0
    s_waitcnt lgkmcnt(13)
    v_mfma_f32_16x16x32_bf16 v[64:67], a[64:67], a[16:19], v[64:67]
    buffer_load_dwordx4 v16, s[40:43], s48 offen offset:0 lds
    s_waitcnt lgkmcnt(12)
    v_mfma_f32_16x16x32_bf16 v[72:75], a[64:67], a[20:23], v[72:75]
    s_waitcnt lgkmcnt(9)
    v_mfma_f32_16x16x32_bf16 v[80:83], a[64:67], a[24:27], v[80:83]
    s_waitcnt lgkmcnt(8)
    v_mfma_f32_16x16x32_bf16 v[88:91], a[64:67], a[28:31], v[88:91]
    ds_read_b64_tr_b16 a[64:65], v8 offset:16384
    v_mfma_f32_16x16x32_bf16 v[36:39], a[68:71], a[0:3], v[36:39]
    ds_read_b64_tr_b16 a[66:67], v8 offset:18432
    v_mfma_f32_16x16x32_bf16 v[44:47], a[68:71], a[4:7], v[44:47]
    v_mfma_f32_16x16x32_bf16 v[52:55], a[68:71], a[8:11], v[52:55]
    ds_read_b128 a[32:35], v7 offset:0
    v_mfma_f32_16x16x32_bf16 v[60:63], a[68:71], a[12:15], v[60:63]
    v_mfma_f32_16x16x32_bf16 v[68:71], a[68:71], a[16:19], v[68:71]
    buffer_load_dwordx4 v17, s[40:43], s48 offen offset:1024 lds
    v_mfma_f32_16x16x32_bf16 v[76:79], a[68:71], a[20:23], v[76:79]
    s_add_u32 s48, s48, 128
    v_mfma_f32_16x16x32_bf16 v[84:87], a[68:71], a[24:27], v[84:87]
    ds_read_b128 a[36:39], v7 offset:2048
    v_mfma_f32_16x16x32_bf16 v[92:95], a[68:71], a[28:31], v[92:95]
    ds_read_b64_tr_b16 a[68:69], v9 offset:16384
    v_mfma_f32_16x16x32_bf16 v[96:99], a[72:75], a[0:3], v[96:99]
    ds_read_b64_tr_b16 a[70:71], v9 offset:18432
    v_mfma_f32_16x16x32_bf16 v[104:107], a[72:75], a[4:7], v[104:107]
    v_mfma_f32_16x16x32_bf16 v[112:115], a[72:75], a[8:11], v[112:115]
    ds_read_b128 a[40:43], v7 offset:4096
    v_mfma_f32_16x16x32_bf16 v[120:123], a[72:75], a[12:15], v[120:123]
    v_mfma_f32_16x16x32_bf16 v[128:131], a[72:75], a[16:19], v[128:131]
    buffer_load_dwordx4 v16, s[40:43], s49 offen offset:2048 lds
    v_mfma_f32_16x16x32_bf16 v[136:139], a[72:75], a[20:23], v[136:139]
    v_mfma_f32_16x16x32_bf16 v[144:147], a[72:75], a[24:27], v[144:147]
    ds_read_b128 a[44:47], v7 offset:6144
    v_mfma_f32_16x16x32_bf16 v[152:155], a[72:75], a[28:31], v[152:155]
    ds_read_b64_tr_b16 a[72:73], v10 offset:16384
    v_mfma_f32_16x16x32_bf16 v[100:103], a[76:79], a[0:3], v[100:103]
    ds_read_b64_tr_b16 a[74:75], v10 offset:18432
    v_mfma_f32_16x16x32_bf16 v[108:111], a[76:79], a[4:7], v[108:111]
    v_mfma_f32_16x16x32_bf16 v[116:119], a[76:79], a[8:11], v[116:119]
    ds_read_b128 a[48:51], v7 offset:8192
    v_mfma_f32_16x16x32_bf16 v[124:127], a[76:79], a[12:15], v[124:127]
    v_mfma_f32_16x16x32_bf16 v[132:135], a[76:79], a[16:19], v[132:135]
    buffer_load_dwordx4 v17, s[40:43], s49 offen offset:3072 lds
    v_mfma_f32_16x16x32_bf16 v[140:143], a[76:79], a[20:23], v[140:143]
    s_add_u32 s49, s49, 128
    v_mfma_f32_16x16x32_bf16 v[148:151], a[76:79], a[24:27], v[148:151]
    ds_read_b128 a[52:55], v7 offset:10240
    v_mfma_f32_16x16x32_bf16 v[156:159], a[76:79], a[28:31], v[156:159]
    ds_read_b64_tr_b16 a[76:77], v11 offset:16384
    s_waitcnt lgkmcnt(15)
    v_mfma_f32_16x16x32_bf16 v[160:163], a[80:83], a[0:3], v[160:163]
    ds_read_b64_tr_b16 a[78:79], v11 offset:18432
    v_mfma_f32_16x16x32_bf16 v[168:171], a[80:83], a[4:7], v[168:171]
    v_mfma_f32_16x16x32_bf16 v[176:179], a[80:83], a[8:11], v[176:179]
    ds_read_b128 a[56:59], v7 offset:12288
    v_mfma_f32_16x16x32_bf16 v[184:187], a[80:83], a[12:15], v[184:187]
    s_add_u32 m0, s61, 4096
    v_mfma_f32_16x16x32_bf16 v[192:195], a[80:83], a[16:19], v[192:195]
    buffer_load_dwordx4 v16, s[40:43], s50 offen offset:0 lds
    v_mfma_f32_16x16x32_bf16 v[200:203], a[80:83], a[20:23], v[200:203]
    v_mfma_f32_16x16x32_bf16 v[208:211], a[80:83], a[24:27], v[208:211]
    s_add_u32 s61, s61, 32768
    ds_read_b128 a[60:63], v7 offset:14336
    v_mfma_f32_16x16x32_bf16 v[216:219], a[80:83], a[28:31], v[216:219]
    s_cmp_ge_u32 s61, 98304
    s_cselect_b32 s90, 98304, 0
    ds_read_b64_tr_b16 a[80:81], v12 offset:16384
    v_mfma_f32_16x16x32_bf16 v[164:167], a[84:87], a[0:3], v[164:167]
    s_sub_u32 s61, s61, s90
    ds_read_b64_tr_b16 a[82:83], v12 offset:18432
    v_mfma_f32_16x16x32_bf16 v[172:175], a[84:87], a[4:7], v[172:175]
    s_add_u32 s64, s64, 32768
    v_mfma_f32_16x16x32_bf16 v[180:183], a[84:87], a[8:11], v[180:183]
    s_cmp_ge_u32 s64, 98304
    s_cselect_b32 s63, 4294901760, s59
    s_cselect_b32 s64, 0, s64
    v_mfma_f32_16x16x32_bf16 v[188:191], a[84:87], a[12:15], v[188:191]
    v_mfma_f32_16x16x32_bf16 v[196:199], a[84:87], a[16:19], v[196:199]
    buffer_load_dwordx4 v17, s[40:43], s50 offen offset:1024 lds
    v_mfma_f32_16x16x32_bf16 v[204:207], a[84:87], a[20:23], v[204:207]
    s_add_u32 s50, s50, 128
    v_mfma_f32_16x16x32_bf16 v[212:215], a[84:87], a[24:27], v[212:215]
    v_mfma_f32_16x16x32_bf16 v[220:223], a[84:87], a[28:31], v[220:223]
    ds_read_b64_tr_b16 a[84:85], v13 offset:16384
    v_mfma_f32_16x16x32_bf16 v[224:227], a[88:91], a[0:3], v[224:227]
    ds_read_b64_tr_b16 a[86:87], v13 offset:18432
    v_mfma_f32_16x16x32_bf16 v[232:235], a[88:91], a[4:7], v[232:235]
    v_mfma_f32_16x16x32_bf16 v[240:243], a[88:91], a[8:11], v[240:243]
    v_mfma_f32_16x16x32_bf16 v[248:251], a[88:91], a[12:15], v[248:251]
    v_mfma_f32_16x16x32_bf16 a[96:99], a[88:91], a[16:19], a[96:99]
    buffer_load_dwordx4 v16, s[40:43], s51 offen offset:2048 lds
    v_mfma_f32_16x16x32_bf16 a[104:107], a[88:91], a[20:23], a[104:107]
    v_mfma_f32_16x16x32_bf16 a[112:115], a[88:91], a[24:27], a[112:115]
    v_mfma_f32_16x16x32_bf16 a[120:123], a[88:91], a[28:31], a[120:123]
    ds_read_b64_tr_b16 a[88:89], v14 offset:16384
    s_waitcnt lgkmcnt(15)
    v_mfma_f32_16x16x32_bf16 v[228:231], a[92:95], a[0:3], v[228:231]
    ds_read_b64_tr_b16 a[90:91], v14 offset:18432
    v_mfma_f32_16x16x32_bf16 v[236:239], a[92:95], a[4:7], v[236:239]
    v_add_u32 v6, s63, v6
    v_add_u32 v7, s63, v7
    v_mfma_f32_16x16x32_bf16 v[244:247], a[92:95], a[8:11], v[244:247]
    v_mfma_f32_16x16x32_bf16 v[252:255], a[92:95], a[12:15], v[252:255]
    v_mfma_f32_16x16x32_bf16 a[100:103], a[92:95], a[16:19], a[100:103]
    buffer_load_dwordx4 v17, s[40:43], s51 offen offset:3072 lds
    v_mfma_f32_16x16x32_bf16 a[108:111], a[92:95], a[20:23], a[108:111]
    s_add_u32 s51, s51, 128
    v_mfma_f32_16x16x32_bf16 a[116:119], a[92:95], a[24:27], a[116:119]
    v_mfma_f32_16x16x32_bf16 a[124:127], a[92:95], a[28:31], a[124:127]
    ds_read_b64_tr_b16 a[92:93], v15 offset:16384
    ds_read_b64_tr_b16 a[94:95], v15 offset:18432
    v_mfma_f32_16x16x32_bf16 v[32:35], a[64:67], a[32:35], v[32:35]
    v_xor_b32 v8, s60, v8
    v_xor_b32 v9, s60, v9
    v_mfma_f32_16x16x32_bf16 v[40:43], a[64:67], a[36:39], v[40:43]
    v_xor_b32 v10, s60, v10
    v_xor_b32 v11, s60, v11
    s_waitcnt lgkmcnt(15)
    v_mfma_f32_16x16x32_bf16 v[48:51], a[64:67], a[40:43], v[48:51]
    v_xor_b32 v12, s60, v12
    v_xor_b32 v13, s60, v13
    v_mfma_f32_16x16x32_bf16 v[56:59], a[64:67], a[44:47], v[56:59]
    v_xor_b32 v14, s60, v14
    v_xor_b32 v15, s60, v15
    s_waitcnt lgkmcnt(13)
    v_mfma_f32_16x16x32_bf16 v[64:67], a[64:67], a[48:51], v[64:67]
    s_waitcnt lgkmcnt(12)
    v_mfma_f32_16x16x32_bf16 v[72:75], a[64:67], a[52:55], v[72:75]
    s_waitcnt lgkmcnt(9)
    v_mfma_f32_16x16x32_bf16 v[80:83], a[64:67], a[56:59], v[80:83]
    s_waitcnt vmcnt(8) lgkmcnt(0)
    v_mfma_f32_16x16x32_bf16 v[88:91], a[64:67], a[60:63], v[88:91]
    s_barrier
    ds_read_b64_tr_b16 a[64:65], v8 offset:0
    v_mfma_f32_16x16x32_bf16 v[36:39], a[68:71], a[32:35], v[36:39]
    s_add_u32 m0, s62, 0
    ds_read_b64_tr_b16 a[66:67], v8 offset:2048
    v_mfma_f32_16x16x32_bf16 v[44:47], a[68:71], a[36:39], v[44:47]
    buffer_load_dwordx4 v18, s[44:47], s52 offen offset:0 lds
    v_mfma_f32_16x16x32_bf16 v[52:55], a[68:71], a[40:43], v[52:55]
    ds_read_b128 a[0:3], v6 offset:0
    v_mfma_f32_16x16x32_bf16 v[60:63], a[68:71], a[44:47], v[60:63]
    v_mfma_f32_16x16x32_bf16 v[68:71], a[68:71], a[48:51], v[68:71]
    v_mfma_f32_16x16x32_bf16 v[76:79], a[68:71], a[52:55], v[76:79]
    buffer_load_dwordx4 v19, s[44:47], s52 offen offset:1024 lds
    v_mfma_f32_16x16x32_bf16 v[84:87], a[68:71], a[56:59], v[84:87]
    s_add_u32 s52, s52, s56
    ds_read_b128 a[4:7], v6 offset:2048
    v_mfma_f32_16x16x32_bf16 v[92:95], a[68:71], a[60:63], v[92:95]
    ds_read_b64_tr_b16 a[68:69], v9 offset:0
    v_mfma_f32_16x16x32_bf16 v[96:99], a[72:75], a[32:35], v[96:99]
    ds_read_b64_tr_b16 a[70:71], v9 offset:2048
    v_mfma_f32_16x16x32_bf16 v[104:107], a[72:75], a[36:39], v[104:107]
    buffer_load_dwordx4 v18, s[44:47], s53 offen offset:2048 lds
    v_mfma_f32_16x16x32_bf16 v[112:115], a[72:75], a[40:43], v[112:115]
    ds_read_b128 a[8:11], v6 offset:4096
    v_mfma_f32_16x16x32_bf16 v[120:123], a[72:75], a[44:47], v[120:123]
    v_mfma_f32_16x16x32_bf16 v[128:131], a[72:75], a[48:51], v[128:131]
    v_mfma_f32_16x16x32_bf16 v[136:139], a[72:75], a[52:55], v[136:139]
    buffer_load_dwordx4 v19, s[44:47], s53 offen offset:3072 lds
    v_mfma_f32_16x16x32_bf16 v[144:147], a[72:75], a[56:59], v[144:147]
    s_add_u32 s53, s53, s56
    ds_read_b128 a[12:15], v6 offset:6144
    v_mfma_f32_16x16x32_bf16 v[152:155], a[72:75], a[60:63], v[152:155]
    ds_read_b64_tr_b16 a[72:73], v10 offset:0
    v_mfma_f32_16x16x32_bf16 v[100:103], a[76:79], a[32:35], v[100:103]
    s_add_u32 m0, s62, 4096
    ds_read_b64_tr_b16 a[74:75], v10 offset:2048
    v_mfma_f32_16x16x32_bf16 v[108:111], a[76:79], a[36:39], v[108:111]
    buffer_load_dwordx4 v20, s[44:47], s54 offen offset:0 lds
    v_mfma_f32_16x16x32_bf16 v[116:119], a[76:79], a[40:43], v[116:119]
    ds_read_b128 a[16:19], v6 offset:8192
    v_mfma_f32_16x16x32_bf16 v[124:127], a[76:79], a[44:47], v[124:127]
    s_xor_b32 s62, s62, 229376
    v_mfma_f32_16x16x32_bf16 v[132:135], a[76:79], a[48:51], v[132:135]
    v_mfma_f32_16x16x32_bf16 v[140:143], a[76:79], a[52:55], v[140:143]
    buffer_load_dwordx4 v21, s[44:47], s54 offen offset:1024 lds
    v_mfma_f32_16x16x32_bf16 v[148:151], a[76:79], a[56:59], v[148:151]
    s_add_u32 s54, s54, s56
    ds_read_b128 a[20:23], v6 offset:10240
    v_mfma_f32_16x16x32_bf16 v[156:159], a[76:79], a[60:63], v[156:159]
    ds_read_b64_tr_b16 a[76:77], v11 offset:0
    v_mfma_f32_16x16x32_bf16 v[160:163], a[80:83], a[32:35], v[160:163]
    ds_read_b64_tr_b16 a[78:79], v11 offset:2048
    v_mfma_f32_16x16x32_bf16 v[168:171], a[80:83], a[36:39], v[168:171]
    buffer_load_dwordx4 v20, s[44:47], s55 offen offset:2048 lds
    v_mfma_f32_16x16x32_bf16 v[176:179], a[80:83], a[40:43], v[176:179]
    ds_read_b128 a[24:27], v6 offset:12288
    v_mfma_f32_16x16x32_bf16 v[184:187], a[80:83], a[44:47], v[184:187]
    v_mfma_f32_16x16x32_bf16 v[192:195], a[80:83], a[48:51], v[192:195]
    v_mfma_f32_16x16x32_bf16 v[200:203], a[80:83], a[52:55], v[200:203]
    buffer_load_dwordx4 v21, s[44:47], s55 offen offset:3072 lds
    v_mfma_f32_16x16x32_bf16 v[208:211], a[80:83], a[56:59], v[208:211]
    s_add_u32 s55, s55, s56
    ds_read_b128 a[28:31], v6 offset:14336
    v_mfma_f32_16x16x32_bf16 v[216:219], a[80:83], a[60:63], v[216:219]
    ds_read_b64_tr_b16 a[80:81], v12 offset:0
    v_mfma_f32_16x16x32_bf16 v[164:167], a[84:87], a[32:35], v[164:167]
    ds_read_b64_tr_b16 a[82:83], v12 offset:2048
    v_mfma_f32_16x16x32_bf16 v[172:175], a[84:87], a[36:39], v[172:175]
    v_mfma_f32_16x16x32_bf16 v[180:183], a[84:87], a[40:43], v[180:183]
    v_mfma_f32_16x16x32_bf16 v[188:191], a[84:87], a[44:47], v[188:191]
    v_mfma_f32_16x16x32_bf16 v[196:199], a[84:87], a[48:51], v[196:199]
    v_mfma_f32_16x16x32_bf16 v[204:207], a[84:87], a[52:55], v[204:207]
    v_mfma_f32_16x16x32_bf16 v[212:215], a[84:87], a[56:59], v[212:215]
    v_mfma_f32_16x16x32_bf16 v[220:223], a[84:87], a[60:63], v[220:223]
    ds_read_b64_tr_b16 a[84:85], v13 offset:0
    v_mfma_f32_16x16x32_bf16 v[224:227], a[88:91], a[32:35], v[224:227]
    ds_read_b64_tr_b16 a[86:87], v13 offset:2048
    v_mfma_f32_16x16x32_bf16 v[232:235], a[88:91], a[36:39], v[232:235]
    v_mfma_f32_16x16x32_bf16 v[240:243], a[88:91], a[40:43], v[240:243]
    v_mfma_f32_16x16x32_bf16 v[248:251], a[88:91], a[44:47], v[248:251]
    v_mfma_f32_16x16x32_bf16 a[96:99], a[88:91], a[48:51], a[96:99]
    v_mfma_f32_16x16x32_bf16 a[104:107], a[88:91], a[52:55], a[104:107]
    v_mfma_f32_16x16x32_bf16 a[112:115], a[88:91], a[56:59], a[112:115]
    v_mfma_f32_16x16x32_bf16 a[120:123], a[88:91], a[60:63], a[120:123]
    ds_read_b64_tr_b16 a[88:89], v14 offset:0
    v_mfma_f32_16x16x32_bf16 v[228:231], a[92:95], a[32:35], v[228:231]
    ds_read_b64_tr_b16 a[90:91], v14 offset:2048
    v_mfma_f32_16x16x32_bf16 v[236:239], a[92:95], a[36:39], v[236:239]
    v_mfma_f32_16x16x32_bf16 v[244:247], a[92:95], a[40:43], v[244:247]
    v_mfma_f32_16x16x32_bf16 v[252:255], a[92:95], a[44:47], v[252:255]
    v_mfma_f32_16x16x32_bf16 a[100:103], a[92:95], a[48:51], a[100:103]
    s_sub_u32 s65, s65, 1
    v_mfma_f32_16x16x32_bf16 a[108:111], a[92:95], a[52:55], a[108:111]
    v_mfma_f32_16x16x32_bf16 a[116:119], a[92:95], a[56:59], a[116:119]
    s_cmp_gt_u32 s65, s67
    v_mfma_f32_16x16x32_bf16 a[124:127], a[92:95], a[60:63], a[124:127]
    ds_read_b64_tr_b16 a[92:93], v15 offset:0
    ds_read_b64_tr_b16 a[94:95], v15 offset:2048
    s_cbranch_scc1 mega_kernel_loop15
    s_cmp_lg_u32 s65, 0
    s_cbranch_scc1 mega_kernel_dosw16
    s_branch mega_kernel_epi11
mega_kernel_swp12:
    s_waitcnt lgkmcnt(15)
    v_mfma_f32_16x16x32_bf16 v[32:35], a[0:3], a[64:67], 0
    v_mfma_f32_16x16x32_bf16 v[36:39], a[4:7], a[64:67], 0
    v_mfma_f32_16x16x32_bf16 v[96:99], a[8:11], a[64:67], 0
    v_mfma_f32_16x16x32_bf16 v[100:103], a[12:15], a[64:67], 0
    s_add_u32 m0, s61, 0
    s_waitcnt lgkmcnt(13)
    v_mfma_f32_16x16x32_bf16 v[160:163], a[16:19], a[64:67], 0
    buffer_load_dwordx4 v16, s[40:43], s48 offen offset:0 lds
    s_waitcnt lgkmcnt(12)
    v_mfma_f32_16x16x32_bf16 v[164:167], a[20:23], a[64:67], 0
    s_waitcnt lgkmcnt(9)
    v_mfma_f32_16x16x32_bf16 v[224:227], a[24:27], a[64:67], 0
    s_waitcnt lgkmcnt(8)
    v_mfma_f32_16x16x32_bf16 v[228:231], a[28:31], a[64:67], 0
    ds_read_b64_tr_b16 a[64:65], v8 offset:16384
    v_mfma_f32_16x16x32_bf16 v[40:43], a[0:3], a[68:71], 0
    ds_read_b64_tr_b16 a[66:67], v8 offset:18432
    v_mfma_f32_16x16x32_bf16 v[44:47], a[4:7], a[68:71], 0
    v_mfma_f32_16x16x32_bf16 v[104:107], a[8:11], a[68:71], 0
    ds_read_b128 a[32:35], v7 offset:0
    v_mfma_f32_16x16x32_bf16 v[108:111], a[12:15], a[68:71], 0
    v_mfma_f32_16x16x32_bf16 v[168:171], a[16:19], a[68:71], 0
    buffer_load_dwordx4 v17, s[40:43], s48 offen offset:1024 lds
    v_mfma_f32_16x16x32_bf16 v[172:175], a[20:23], a[68:71], 0
    s_add_u32 s48, s48, 128
    v_mfma_f32_16x16x32_bf16 v[232:235], a[24:27], a[68:71], 0
    ds_read_b128 a[36:39], v7 offset:2048
    v_mfma_f32_16x16x32_bf16 v[236:239], a[28:31], a[68:71], 0
    ds_read_b64_tr_b16 a[68:69], v9 offset:16384
    v_mfma_f32_16x16x32_bf16 v[48:51], a[0:3], a[72:75], 0
    ds_read_b64_tr_b16 a[70:71], v9 offset:18432
    v_mfma_f32_16x16x32_bf16 v[52:55], a[4:7], a[72:75], 0
    v_mfma_f32_16x16x32_bf16 v[112:115], a[8:11], a[72:75], 0
    ds_read_b128 a[40:43], v7 offset:4096
    v_mfma_f32_16x16x32_bf16 v[116:119], a[12:15], a[72:75], 0
    v_mfma_f32_16x16x32_bf16 v[176:179], a[16:19], a[72:75], 0
    buffer_load_dwordx4 v16, s[40:43], s49 offen offset:2048 lds
    v_mfma_f32_16x16x32_bf16 v[180:183], a[20:23], a[72:75], 0
    v_mfma_f32_16x16x32_bf16 v[240:243], a[24:27], a[72:75], 0
    ds_read_b128 a[44:47], v7 offset:6144
    v_mfma_f32_16x16x32_bf16 v[244:247], a[28:31], a[72:75], 0
    ds_read_b64_tr_b16 a[72:73], v10 offset:16384
    v_mfma_f32_16x16x32_bf16 v[56:59], a[0:3], a[76:79], 0
    ds_read_b64_tr_b16 a[74:75], v10 offset:18432
    v_mfma_f32_16x16x32_bf16 v[60:63], a[4:7], a[76:79], 0
    v_mfma_f32_16x16x32_bf16 v[120:123], a[8:11], a[76:79], 0
    ds_read_b128 a[48:51], v7 offset:8192
    v_mfma_f32_16x16x32_bf16 v[124:127], a[12:15], a[76:79], 0
    v_mfma_f32_16x16x32_bf16 v[184:187], a[16:19], a[76:79], 0
    buffer_load_dwordx4 v17, s[40:43], s49 offen offset:3072 lds
    v_mfma_f32_16x16x32_bf16 v[188:191], a[20:23], a[76:79], 0
    s_add_u32 s49, s49, 128
    v_mfma_f32_16x16x32_bf16 v[248:251], a[24:27], a[76:79], 0
    ds_read_b128 a[52:55], v7 offset:10240
    v_mfma_f32_16x16x32_bf16 v[252:255], a[28:31], a[76:79], 0
    ds_read_b64_tr_b16 a[76:77], v11 offset:16384
    s_waitcnt lgkmcnt(15)
    v_mfma_f32_16x16x32_bf16 v[64:67], a[0:3], a[80:83], 0
    ds_read_b64_tr_b16 a[78:79], v11 offset:18432
    v_mfma_f32_16x16x32_bf16 v[68:71], a[4:7], a[80:83], 0
    v_mfma_f32_16x16x32_bf16 v[128:131], a[8:11], a[80:83], 0
    ds_read_b128 a[56:59], v7 offset:12288
    v_mfma_f32_16x16x32_bf16 v[132:135], a[12:15], a[80:83], 0
    s_add_u32 m0, s61, 4096
    v_mfma_f32_16x16x32_bf16 v[192:195], a[16:19], a[80:83], 0
    buffer_load_dwordx4 v16, s[40:43], s50 offen offset:0 lds
    v_mfma_f32_16x16x32_bf16 v[196:199], a[20:23], a[80:83], 0
    v_mfma_f32_16x16x32_bf16 a[96:99], a[24:27], a[80:83], 0
    s_add_u32 s61, s61, 32768
    ds_read_b128 a[60:63], v7 offset:14336
    v_mfma_f32_16x16x32_bf16 a[100:103], a[28:31], a[80:83], 0
    s_cmp_ge_u32 s61, 98304
    s_cselect_b32 s90, 98304, 0
    ds_read_b64_tr_b16 a[80:81], v12 offset:16384
    v_mfma_f32_16x16x32_bf16 v[72:75], a[0:3], a[84:87], 0
    s_sub_u32 s61, s61, s90
    ds_read_b64_tr_b16 a[82:83], v12 offset:18432
    v_mfma_f32_16x16x32_bf16 v[76:79], a[4:7], a[84:87], 0
    s_add_u32 s64, s64, 32768
    v_mfma_f32_16x16x32_bf16 v[136:139], a[8:11], a[84:87], 0
    buffer_store_dwordx4 a[128:131], v2, s[24:27], s28 offen sc1
    v_mfma_f32_16x16x32_bf16 v[140:143], a[12:15], a[84:87], 0
    s_add_u32 s28, s28, s31
    v_mfma_f32_16x16x32_bf16 v[200:203], a[16:19], a[84:87], 0
    buffer_load_dwordx4 v17, s[40:43], s50 offen offset:1024 lds
    v_mfma_f32_16x16x32_bf16 v[204:207], a[20:23], a[84:87], 0
    s_add_u32 s50, s50, 128
    v_mfma_f32_16x16x32_bf16 a[104:107], a[24:27], a[84:87], 0
    s_cmp_ge_u32 s64, 98304
    s_cselect_b32 s63, 4294901760, s59
    s_cselect_b32 s64, 0, s64
    v_mfma_f32_16x16x32_bf16 a[108:111], a[28:31], a[84:87], 0
    ds_read_b64_tr_b16 a[84:85], v13 offset:16384
    v_mfma_f32_16x16x32_bf16 v[80:83], a[0:3], a[88:91], 0
    ds_read_b64_tr_b16 a[86:87], v13 offset:18432
    v_mfma_f32_16x16x32_bf16 v[84:87], a[4:7], a[88:91], 0
    v_mfma_f32_16x16x32_bf16 v[144:147], a[8:11], a[88:91], 0
    buffer_store_dwordx4 a[132:135], v2, s[24:27], s28 offen sc1
    v_mfma_f32_16x16x32_bf16 v[148:151], a[12:15], a[88:91], 0
    s_add_u32 s28, s28, s31
    v_mfma_f32_16x16x32_bf16 v[208:211], a[16:19], a[88:91], 0
    buffer_load_dwordx4 v16, s[40:43], s51 offen offset:2048 lds
    v_mfma_f32_16x16x32_bf16 v[212:215], a[20:23], a[88:91], 0
    v_mfma_f32_16x16x32_bf16 a[112:115], a[24:27], a[88:91], 0
    v_mfma_f32_16x16x32_bf16 a[116:119], a[28:31], a[88:91], 0
    ds_read_b64_tr_b16 a[88:89], v14 offset:16384
    s_waitcnt lgkmcnt(15)
    v_mfma_f32_16x16x32_bf16 v[88:91], a[0:3], a[92:95], 0
    ds_read_b64_tr_b16 a[90:91], v14 offset:18432
    v_mfma_f32_16x16x32_bf16 v[92:95], a[4:7], a[92:95], 0
    v_add_u32 v6, s63, v6
    v_add_u32 v7, s63, v7
    v_mfma_f32_16x16x32_bf16 v[152:155], a[8:11], a[92:95], 0
    buffer_store_dwordx4 a[136:139], v2, s[24:27], s28 offen sc1
    v_mfma_f32_16x16x32_bf16 v[156:159], a[12:15], a[92:95], 0
    s_add_u32 s28, s28, s31
    v_mfma_f32_16x16x32_bf16 v[216:219], a[16:19], a[92:95], 0
    buffer_load_dwordx4 v17, s[40:43], s51 offen offset:3072 lds
    v_mfma_f32_16x16x32_bf16 v[220:223], a[20:23], a[92:95], 0
    s_add_u32 s51, s51, 128
    v_mfma_f32_16x16x32_bf16 a[120:123], a[24:27], a[92:95], 0
    v_mfma_f32_16x16x32_bf16 a[124:127], a[28:31], a[92:95], 0
    ds_read_b64_tr_b16 a[92:93], v15 offset:16384
    ds_read_b64_tr_b16 a[94:95], v15 offset:18432
    v_mfma_f32_16x16x32_bf16 v[32:35], a[32:35], a[64:67], v[32:35]
    v_xor_b32 v8, s60, v8
    v_xor_b32 v9, s60, v9
    v_mfma_f32_16x16x32_bf16 v[36:39], a[36:39], a[64:67], v[36:39]
    v_xor_b32 v10, s60, v10
    v_xor_b32 v11, s60, v11
    s_waitcnt lgkmcnt(15)
    v_mfma_f32_16x16x32_bf16 v[96:99], a[40:43], a[64:67], v[96:99]
    v_xor_b32 v12, s60, v12
    v_xor_b32 v13, s60, v13
    v_mfma_f32_16x16x32_bf16 v[100:103], a[44:47], a[64:67], v[100:103]
    v_xor_b32 v14, s60, v14
    v_xor_b32 v15, s60, v15
    s_waitcnt lgkmcnt(13)
    v_mfma_f32_16x16x32_bf16 v[160:163], a[48:51], a[64:67], v[160:163]
    s_waitcnt lgkmcnt(12)
    v_mfma_f32_16x16x32_bf16 v[164:167], a[52:55], a[64:67], v[164:167]
    s_waitcnt lgkmcnt(9)
    v_mfma_f32_16x16x32_bf16 v[224:227], a[56:59], a[64:67], v[224:227]
    s_waitcnt vmcnt(11) lgkmcnt(0)
    v_mfma_f32_16x16x32_bf16 v[228:231], a[60:63], a[64:67], v[228:231]
    s_barrier
    ds_read_b64_tr_b16 a[64:65], v8 offset:0
    v_mfma_f32_16x16x32_bf16 v[40:43], a[32:35], a[68:71], v[40:43]
    s_add_u32 m0, s62, 0
    ds_read_b64_tr_b16 a[66:67], v8 offset:2048
    v_mfma_f32_16x16x32_bf16 v[44:47], a[36:39], a[68:71], v[44:47]
    buffer_load_dwordx4 v18, s[44:47], s52 offen offset:0 lds
    v_mfma_f32_16x16x32_bf16 v[104:107], a[40:43], a[68:71], v[104:107]
    ds_read_b128 a[0:3], v6 offset:0
    v_mfma_f32_16x16x32_bf16 v[108:111], a[44:47], a[68:71], v[108:111]
    v_mfma_f32_16x16x32_bf16 v[168:171], a[48:51], a[68:71], v[168:171]
    v_mfma_f32_16x16x32_bf16 v[172:175], a[52:55], a[68:71], v[172:175]
    buffer_load_dwordx4 v19, s[44:47], s52 offen offset:1024 lds
    v_mfma_f32_16x16x32_bf16 v[232:235], a[56:59], a[68:71], v[232:235]
    s_add_u32 s52, s52, s56
    ds_read_b128 a[4:7], v6 offset:2048
    v_mfma_f32_16x16x32_bf16 v[236:239], a[60:63], a[68:71], v[236:239]
    ds_read_b64_tr_b16 a[68:69], v9 offset:0
    v_mfma_f32_16x16x32_bf16 v[48:51], a[32:35], a[72:75], v[48:51]
    ds_read_b64_tr_b16 a[70:71], v9 offset:2048
    v_mfma_f32_16x16x32_bf16 v[52:55], a[36:39], a[72:75], v[52:55]
    buffer_load_dwordx4 v18, s[44:47], s53 offen offset:2048 lds
    v_mfma_f32_16x16x32_bf16 v[112:115], a[40:43], a[72:75], v[112:115]
    ds_read_b128 a[8:11], v6 offset:4096
    v_mfma_f32_16x16x32_bf16 v[116:119], a[44:47], a[72:75], v[116:119]
    v_mfma_f32_16x16x32_bf16 v[176:179], a[48:51], a[72:75], v[176:179]
    v_mfma_f32_16x16x32_bf16 v[180:183], a[52:55], a[72:75], v[180:183]
    buffer_load_dwordx4 v19, s[44:47], s53 offen offset:3072 lds
    v_mfma_f32_16x16x32_bf16 v[240:243], a[56:59], a[72:75], v[240:243]
    s_add_u32 s53, s53, s56
    ds_read_b128 a[12:15], v6 offset:6144
    v_mfma_f32_16x16x32_bf16 v[244:247], a[60:63], a[72:75], v[244:247]
    ds_read_b64_tr_b16 a[72:73], v10 offset:0
    v_mfma_f32_16x16x32_bf16 v[56:59], a[32:35], a[76:79], v[56:59]
    s_add_u32 m0, s62, 4096
    ds_read_b64_tr_b16 a[74:75], v10 offset:2048
    v_mfma_f32_16x16x32_bf16 v[60:63], a[36:39], a[76:79], v[60:63]
    buffer_load_dwordx4 v20, s[44:47], s54 offen offset:0 lds
    v_mfma_f32_16x16x32_bf16 v[120:123], a[40:43], a[76:79], v[120:123]
    ds_read_b128 a[16:19], v6 offset:8192
    v_mfma_f32_16x16x32_bf16 v[124:127], a[44:47], a[76:79], v[124:127]
    s_xor_b32 s62, s62, 229376
    v_mfma_f32_16x16x32_bf16 v[184:187], a[48:51], a[76:79], v[184:187]
    v_mfma_f32_16x16x32_bf16 v[188:191], a[52:55], a[76:79], v[188:191]
    buffer_load_dwordx4 v21, s[44:47], s54 offen offset:1024 lds
    v_mfma_f32_16x16x32_bf16 v[248:251], a[56:59], a[76:79], v[248:251]
    s_add_u32 s54, s54, s56
    ds_read_b128 a[20:23], v6 offset:10240
    v_mfma_f32_16x16x32_bf16 v[252:255], a[60:63], a[76:79], v[252:255]
    ds_read_b64_tr_b16 a[76:77], v11 offset:0
    v_mfma_f32_16x16x32_bf16 v[64:67], a[32:35], a[80:83], v[64:67]
    ds_read_b64_tr_b16 a[78:79], v11 offset:2048
    v_mfma_f32_16x16x32_bf16 v[68:71], a[36:39], a[80:83], v[68:71]
    buffer_load_dwordx4 v20, s[44:47], s55 offen offset:2048 lds
    v_mfma_f32_16x16x32_bf16 v[128:131], a[40:43], a[80:83], v[128:131]
    ds_read_b128 a[24:27], v6 offset:12288
    v_mfma_f32_16x16x32_bf16 v[132:135], a[44:47], a[80:83], v[132:135]
    v_mfma_f32_16x16x32_bf16 v[192:195], a[48:51], a[80:83], v[192:195]
    v_mfma_f32_16x16x32_bf16 v[196:199], a[52:55], a[80:83], v[196:199]
    buffer_load_dwordx4 v21, s[44:47], s55 offen offset:3072 lds
    v_mfma_f32_16x16x32_bf16 a[96:99], a[56:59], a[80:83], a[96:99]
    s_add_u32 s55, s55, s56
    ds_read_b128 a[28:31], v6 offset:14336
    v_mfma_f32_16x16x32_bf16 a[100:103], a[60:63], a[80:83], a[100:103]
    ds_read_b64_tr_b16 a[80:81], v12 offset:0
    v_mfma_f32_16x16x32_bf16 v[72:75], a[32:35], a[84:87], v[72:75]
    ds_read_b64_tr_b16 a[82:83], v12 offset:2048
    v_mfma_f32_16x16x32_bf16 v[76:79], a[36:39], a[84:87], v[76:79]
    v_mfma_f32_16x16x32_bf16 v[136:139], a[40:43], a[84:87], v[136:139]
    buffer_store_dwordx4 a[140:143], v2, s[24:27], s28 offen sc1
    v_mfma_f32_16x16x32_bf16 v[140:143], a[44:47], a[84:87], v[140:143]
    s_add_u32 s28, s28, s31
    v_mfma_f32_16x16x32_bf16 v[200:203], a[48:51], a[84:87], v[200:203]
    v_mfma_f32_16x16x32_bf16 v[204:207], a[52:55], a[84:87], v[204:207]
    v_mfma_f32_16x16x32_bf16 a[104:107], a[56:59], a[84:87], a[104:107]
    buffer_store_dwordx4 a[144:147], v2, s[24:27], s28 offen sc1
    v_mfma_f32_16x16x32_bf16 a[108:111], a[60:63], a[84:87], a[108:111]
    s_add_u32 s28, s28, s31
    ds_read_b64_tr_b16 a[84:85], v13 offset:0
    v_mfma_f32_16x16x32_bf16 v[80:83], a[32:35], a[88:91], v[80:83]
    ds_read_b64_tr_b16 a[86:87], v13 offset:2048
    v_mfma_f32_16x16x32_bf16 v[84:87], a[36:39], a[88:91], v[84:87]
    v_mfma_f32_16x16x32_bf16 v[144:147], a[40:43], a[88:91], v[144:147]
    buffer_store_dwordx4 a[148:151], v2, s[24:27], s28 offen sc1
    v_mfma_f32_16x16x32_bf16 v[148:151], a[44:47], a[88:91], v[148:151]
    s_add_u32 s28, s28, s31
    v_mfma_f32_16x16x32_bf16 v[208:211], a[48:51], a[88:91], v[208:211]
    v_mfma_f32_16x16x32_bf16 v[212:215], a[52:55], a[88:91], v[212:215]
    v_mfma_f32_16x16x32_bf16 a[112:115], a[56:59], a[88:91], a[112:115]
    buffer_store_dwordx4 a[152:155], v2, s[24:27], s28 offen sc1
    v_mfma_f32_16x16x32_bf16 a[116:119], a[60:63], a[88:91], a[116:119]
    s_add_u32 s28, s28, s31
    ds_read_b64_tr_b16 a[88:89], v14 offset:0
    v_mfma_f32_16x16x32_bf16 v[88:91], a[32:35], a[92:95], v[88:91]
    ds_read_b64_tr_b16 a[90:91], v14 offset:2048
    v_mfma_f32_16x16x32_bf16 v[92:95], a[36:39], a[92:95], v[92:95]
    v_mfma_f32_16x16x32_bf16 v[152:155], a[40:43], a[92:95], v[152:155]
    buffer_store_dwordx4 a[156:159], v2, s[24:27], s28 offen sc1
    v_mfma_f32_16x16x32_bf16 v[156:159], a[44:47], a[92:95], v[156:159]
    s_add_u32 s29, s29, s30
    s_mov_b32 s28, s29
    v_mfma_f32_16x16x32_bf16 v[216:219], a[48:51], a[92:95], v[216:219]
    s_sub_u32 s65, s65, 1
    v_mfma_f32_16x16x32_bf16 v[220:223], a[52:55], a[92:95], v[220:223]
    v_mfma_f32_16x16x32_bf16 a[120:123], a[56:59], a[92:95], a[120:123]
    v_mfma_f32_16x16x32_bf16 a[124:127], a[60:63], a[92:95], a[124:127]
    ds_read_b64_tr_b16 a[92:93], v15 offset:0
    ds_read_b64_tr_b16 a[94:95], v15 offset:2048
    s_waitcnt lgkmcnt(15)
    v_mfma_f32_16x16x32_bf16 v[32:35], a[0:3], a[64:67], v[32:35]
    v_mfma_f32_16x16x32_bf16 v[36:39], a[4:7], a[64:67], v[36:39]
    v_mfma_f32_16x16x32_bf16 v[96:99], a[8:11], a[64:67], v[96:99]
    v_mfma_f32_16x16x32_bf16 v[100:103], a[12:15], a[64:67], v[100:103]
    s_add_u32 m0, s61, 0
    s_waitcnt lgkmcnt(13)
    v_mfma_f32_16x16x32_bf16 v[160:163], a[16:19], a[64:67], v[160:163]
    buffer_load_dwordx4 v16, s[40:43], s48 offen offset:0 lds
    s_waitcnt lgkmcnt(12)
    v_mfma_f32_16x16x32_bf16 v[164:167], a[20:23], a[64:67], v[164:167]
    s_waitcnt lgkmcnt(9)
    v_mfma_f32_16x16x32_bf16 v[224:227], a[24:27], a[64:67], v[224:227]
    s_waitcnt lgkmcnt(8)
    v_mfma_f32_16x16x32_bf16 v[228:231], a[28:31], a[64:67], v[228:231]
    ds_read_b64_tr_b16 a[64:65], v8 offset:16384
    v_mfma_f32_16x16x32_bf16 v[40:43], a[0:3], a[68:71], v[40:43]
    ds_read_b64_tr_b16 a[66:67], v8 offset:18432
    v_mfma_f32_16x16x32_bf16 v[44:47], a[4:7], a[68:71], v[44:47]
    v_mfma_f32_16x16x32_bf16 v[104:107], a[8:11], a[68:71], v[104:107]
    ds_read_b128 a[32:35], v7 offset:0
    v_mfma_f32_16x16x32_bf16 v[108:111], a[12:15], a[68:71], v[108:111]
    v_mfma_f32_16x16x32_bf16 v[168:171], a[16:19], a[68:71], v[168:171]
    buffer_load_dwordx4 v17, s[40:43], s48 offen offset:1024 lds
    v_mfma_f32_16x16x32_bf16 v[172:175], a[20:23], a[68:71], v[172:175]
    s_add_u32 s48, s48, 128
    v_mfma_f32_16x16x32_bf16 v[232:235], a[24:27], a[68:71], v[232:235]
    ds_read_b128 a[36:39], v7 offset:2048
    v_mfma_f32_16x16x32_bf16 v[236:239], a[28:31], a[68:71], v[236:239]
    ds_read_b64_tr_b16 a[68:69], v9 offset:16384
    v_mfma_f32_16x16x32_bf16 v[48:51], a[0:3], a[72:75], v[48:51]
    ds_read_b64_tr_b16 a[70:71], v9 offset:18432
    v_mfma_f32_16x16x32_bf16 v[52:55], a[4:7], a[72:75], v[52:55]
    v_mfma_f32_16x16x32_bf16 v[112:115], a[8:11], a[72:75], v[112:115]
    ds_read_b128 a[40:43], v7 offset:4096
    v_mfma_f32_16x16x32_bf16 v[116:119], a[12:15], a[72:75], v[116:119]
    v_mfma_f32_16x16x32_bf16 v[176:179], a[16:19], a[72:75], v[176:179]
    buffer_load_dwordx4 v16, s[40:43], s49 offen offset:2048 lds
    v_mfma_f32_16x16x32_bf16 v[180:183], a[20:23], a[72:75], v[180:183]
    v_mfma_f32_16x16x32_bf16 v[240:243], a[24:27], a[72:75], v[240:243]
    ds_read_b128 a[44:47], v7 offset:6144
    v_mfma_f32_16x16x32_bf16 v[244:247], a[28:31], a[72:75], v[244:247]
    ds_read_b64_tr_b16 a[72:73], v10 offset:16384
    v_mfma_f32_16x16x32_bf16 v[56:59], a[0:3], a[76:79], v[56:59]
    ds_read_b64_tr_b16 a[74:75], v10 offset:18432
    v_mfma_f32_16x16x32_bf16 v[60:63], a[4:7], a[76:79], v[60:63]
    v_mfma_f32_16x16x32_bf16 v[120:123], a[8:11], a[76:79], v[120:123]
    ds_read_b128 a[48:51], v7 offset:8192
    v_mfma_f32_16x16x32_bf16 v[124:127], a[12:15], a[76:79], v[124:127]
    v_mfma_f32_16x16x32_bf16 v[184:187], a[16:19], a[76:79], v[184:187]
    buffer_load_dwordx4 v17, s[40:43], s49 offen offset:3072 lds
    v_mfma_f32_16x16x32_bf16 v[188:191], a[20:23], a[76:79], v[188:191]
    s_add_u32 s49, s49, 128
    v_mfma_f32_16x16x32_bf16 v[248:251], a[24:27], a[76:79], v[248:251]
    ds_read_b128 a[52:55], v7 offset:10240
    v_mfma_f32_16x16x32_bf16 v[252:255], a[28:31], a[76:79], v[252:255]
    ds_read_b64_tr_b16 a[76:77], v11 offset:16384
    s_waitcnt lgkmcnt(15)
    v_mfma_f32_16x16x32_bf16 v[64:67], a[0:3], a[80:83], v[64:67]
    ds_read_b64_tr_b16 a[78:79], v11 offset:18432
    v_mfma_f32_16x16x32_bf16 v[68:71], a[4:7], a[80:83], v[68:71]
    v_mfma_f32_16x16x32_bf16 v[128:131], a[8:11], a[80:83], v[128:131]
    ds_read_b128 a[56:59], v7 offset:12288
    v_mfma_f32_16x16x32_bf16 v[132:135], a[12:15], a[80:83], v[132:135]
    s_add_u32 m0, s61, 4096
    v_mfma_f32_16x16x32_bf16 v[192:195], a[16:19], a[80:83], v[192:195]
    buffer_load_dwordx4 v16, s[40:43], s50 offen offset:0 lds
    v_mfma_f32_16x16x32_bf16 v[196:199], a[20:23], a[80:83], v[196:199]
    v_mfma_f32_16x16x32_bf16 a[96:99], a[24:27], a[80:83], a[96:99]
    s_add_u32 s61, s61, 32768
    ds_read_b128 a[60:63], v7 offset:14336
    v_mfma_f32_16x16x32_bf16 a[100:103], a[28:31], a[80:83], a[100:103]
    s_cmp_ge_u32 s61, 98304
    s_cselect_b32 s90, 98304, 0
    ds_read_b64_tr_b16 a[80:81], v12 offset:16384
    v_mfma_f32_16x16x32_bf16 v[72:75], a[0:3], a[84:87], v[72:75]
    s_sub_u32 s61, s61, s90
    ds_read_b64_tr_b16 a[82:83], v12 offset:18432
    v_mfma_f32_16x16x32_bf16 v[76:79], a[4:7], a[84:87], v[76:79]
    s_add_u32 s64, s64, 32768
    v_mfma_f32_16x16x32_bf16 v[136:139], a[8:11], a[84:87], v[136:139]
    buffer_store_dwordx4 a[160:163], v2, s[24:27], s28 offen sc1
    v_mfma_f32_16x16x32_bf16 v[140:143], a[12:15], a[84:87], v[140:143]
    s_add_u32 s28, s28, s31
    v_mfma_f32_16x16x32_bf16 v[200:203], a[16:19], a[84:87], v[200:203]
    buffer_load_dwordx4 v17, s[40:43], s50 offen offset:1024 lds
    v_mfma_f32_16x16x32_bf16 v[204:207], a[20:23], a[84:87], v[204:207]
    s_add_u32 s50, s50, 128
    v_mfma_f32_16x16x32_bf16 a[104:107], a[24:27], a[84:87], a[104:107]
    s_cmp_ge_u32 s64, 98304
    s_cselect_b32 s63, 4294901760, s59
    s_cselect_b32 s64, 0, s64
    v_mfma_f32_16x16x32_bf16 a[108:111], a[28:31], a[84:87], a[108:111]
    ds_read_b64_tr_b16 a[84:85], v13 offset:16384
    v_mfma_f32_16x16x32_bf16 v[80:83], a[0:3], a[88:91], v[80:83]
    ds_read_b64_tr_b16 a[86:87], v13 offset:18432
    v_mfma_f32_16x16x32_bf16 v[84:87], a[4:7], a[88:91], v[84:87]
    v_mfma_f32_16x16x32_bf16 v[144:147], a[8:11], a[88:91], v[144:147]
    buffer_store_dwordx4 a[164:167], v2, s[24:27], s28 offen sc1
    v_mfma_f32_16x16x32_bf16 v[148:151], a[12:15], a[88:91], v[148:151]
    s_add_u32 s28, s28, s31
    v_mfma_f32_16x16x32_bf16 v[208:211], a[16:19], a[88:91], v[208:211]
    buffer_load_dwordx4 v16, s[40:43], s51 offen offset:2048 lds
    v_mfma_f32_16x16x32_bf16 v[212:215], a[20:23], a[88:91], v[212:215]
    v_mfma_f32_16x16x32_bf16 a[112:115], a[24:27], a[88:91], a[112:115]
    v_mfma_f32_16x16x32_bf16 a[116:119], a[28:31], a[88:91], a[116:119]
    ds_read_b64_tr_b16 a[88:89], v14 offset:16384
    s_waitcnt lgkmcnt(15)
    v_mfma_f32_16x16x32_bf16 v[88:91], a[0:3], a[92:95], v[88:91]
    ds_read_b64_tr_b16 a[90:91], v14 offset:18432
    v_mfma_f32_16x16x32_bf16 v[92:95], a[4:7], a[92:95], v[92:95]
    v_add_u32 v6, s63, v6
    v_add_u32 v7, s63, v7
    v_mfma_f32_16x16x32_bf16 v[152:155], a[8:11], a[92:95], v[152:155]
    buffer_store_dwordx4 a[168:171], v2, s[24:27], s28 offen sc1
    v_mfma_f32_16x16x32_bf16 v[156:159], a[12:15], a[92:95], v[156:159]
    s_add_u32 s28, s28, s31
    v_mfma_f32_16x16x32_bf16 v[216:219], a[16:19], a[92:95], v[216:219]
    buffer_load_dwordx4 v17, s[40:43], s51 offen offset:3072 lds
    v_mfma_f32_16x16x32_bf16 v[220:223], a[20:23], a[92:95], v[220:223]
    s_add_u32 s51, s51, 128
    v_mfma_f32_16x16x32_bf16 a[120:123], a[24:27], a[92:95], a[120:123]
    v_mfma_f32_16x16x32_bf16 a[124:127], a[28:31], a[92:95], a[124:127]
    ds_read_b64_tr_b16 a[92:93], v15 offset:16384
    ds_read_b64_tr_b16 a[94:95], v15 offset:18432
    v_mfma_f32_16x16x32_bf16 v[32:35], a[32:35], a[64:67], v[32:35]
    v_xor_b32 v8, s60, v8
    v_xor_b32 v9, s60, v9
    v_mfma_f32_16x16x32_bf16 v[36:39], a[36:39], a[64:67], v[36:39]
    v_xor_b32 v10, s60, v10
    v_xor_b32 v11, s60, v11
    s_waitcnt lgkmcnt(15)
    v_mfma_f32_16x16x32_bf16 v[96:99], a[40:43], a[64:67], v[96:99]
    v_xor_b32 v12, s60, v12
    v_xor_b32 v13, s60, v13
    v_mfma_f32_16x16x32_bf16 v[100:103], a[44:47], a[64:67], v[100:103]
    v_xor_b32 v14, s60, v14
    v_xor_b32 v15, s60, v15
    s_waitcnt lgkmcnt(13)
    v_mfma_f32_16x16x32_bf16 v[160:163], a[48:51], a[64:67], v[160:163]
    s_waitcnt lgkmcnt(12)
    v_mfma_f32_16x16x32_bf16 v[164:167], a[52:55], a[64:67], v[164:167]
    s_waitcnt lgkmcnt(9)
    v_mfma_f32_16x16x32_bf16 v[224:227], a[56:59], a[64:67], v[224:227]
    s_waitcnt vmcnt(16) lgkmcnt(0)
    v_mfma_f32_16x16x32_bf16 v[228:231], a[60:63], a[64:67], v[228:231]
    s_barrier
    ds_read_b64_tr_b16 a[64:65], v8 offset:0
    v_mfma_f32_16x16x32_bf16 v[40:43], a[32:35], a[68:71], v[40:43]
    s_add_u32 m0, s62, 0
    ds_read_b64_tr_b16 a[66:67], v8 offset:2048
    v_mfma_f32_16x16x32_bf16 v[44:47], a[36:39], a[68:71], v[44:47]
    buffer_load_dwordx4 v18, s[44:47], s52 offen offset:0 lds
    v_mfma_f32_16x16x32_bf16 v[104:107], a[40:43], a[68:71], v[104:107]
    ds_read_b128 a[0:3], v6 offset:0
    v_mfma_f32_16x16x32_bf16 v[108:111], a[44:47], a[68:71], v[108:111]
    v_mfma_f32_16x16x32_bf16 v[168:171], a[48:51], a[68:71], v[168:171]
    v_mfma_f32_16x16x32_bf16 v[172:175], a[52:55], a[68:71], v[172:175]
    buffer_load_dwordx4 v19, s[44:47], s52 offen offset:1024 lds
    v_mfma_f32_16x16x32_bf16 v[232:235], a[56:59], a[68:71], v[232:235]
    s_add_u32 s52, s52, s56
    ds_read_b128 a[4:7], v6 offset:2048
    v_mfma_f32_16x16x32_bf16 v[236:239], a[60:63], a[68:71], v[236:239]
    ds_read_b64_tr_b16 a[68:69], v9 offset:0
    v_mfma_f32_16x16x32_bf16 v[48:51], a[32:35], a[72:75], v[48:51]
    ds_read_b64_tr_b16 a[70:71], v9 offset:2048
    v_mfma_f32_16x16x32_bf16 v[52:55], a[36:39], a[72:75], v[52:55]
    buffer_load_dwordx4 v18, s[44:47], s53 offen offset:2048 lds
    v_mfma_f32_16x16x32_bf16 v[112:115], a[40:43], a[72:75], v[112:115]
    ds_read_b128 a[8:11], v6 offset:4096
    v_mfma_f32_16x16x32_bf16 v[116:119], a[44:47], a[72:75], v[116:119]
    v_mfma_f32_16x16x32_bf16 v[176:179], a[48:51], a[72:75], v[176:179]
    v_mfma_f32_16x16x32_bf16 v[180:183], a[52:55], a[72:75], v[180:183]
    buffer_load_dwordx4 v19, s[44:47], s53 offen offset:3072 lds
    v_mfma_f32_16x16x32_bf16 v[240:243], a[56:59], a[72:75], v[240:243]
    s_add_u32 s53, s53, s56
    ds_read_b128 a[12:15], v6 offset:6144
    v_mfma_f32_16x16x32_bf16 v[244:247], a[60:63], a[72:75], v[244:247]
    ds_read_b64_tr_b16 a[72:73], v10 offset:0
    v_mfma_f32_16x16x32_bf16 v[56:59], a[32:35], a[76:79], v[56:59]
    s_add_u32 m0, s62, 4096
    ds_read_b64_tr_b16 a[74:75], v10 offset:2048
    v_mfma_f32_16x16x32_bf16 v[60:63], a[36:39], a[76:79], v[60:63]
    buffer_load_dwordx4 v20, s[44:47], s54 offen offset:0 lds
    v_mfma_f32_16x16x32_bf16 v[120:123], a[40:43], a[76:79], v[120:123]
    ds_read_b128 a[16:19], v6 offset:8192
    v_mfma_f32_16x16x32_bf16 v[124:127], a[44:47], a[76:79], v[124:127]
    s_xor_b32 s62, s62, 229376
    v_mfma_f32_16x16x32_bf16 v[184:187], a[48:51], a[76:79], v[184:187]
    v_mfma_f32_16x16x32_bf16 v[188:191], a[52:55], a[76:79], v[188:191]
    buffer_load_dwordx4 v21, s[44:47], s54 offen offset:1024 lds
    v_mfma_f32_16x16x32_bf16 v[248:251], a[56:59], a[76:79], v[248:251]
    s_add_u32 s54, s54, s56
    ds_read_b128 a[20:23], v6 offset:10240
    v_mfma_f32_16x16x32_bf16 v[252:255], a[60:63], a[76:79], v[252:255]
    ds_read_b64_tr_b16 a[76:77], v11 offset:0
    v_mfma_f32_16x16x32_bf16 v[64:67], a[32:35], a[80:83], v[64:67]
    ds_read_b64_tr_b16 a[78:79], v11 offset:2048
    v_mfma_f32_16x16x32_bf16 v[68:71], a[36:39], a[80:83], v[68:71]
    buffer_load_dwordx4 v20, s[44:47], s55 offen offset:2048 lds
    v_mfma_f32_16x16x32_bf16 v[128:131], a[40:43], a[80:83], v[128:131]
    ds_read_b128 a[24:27], v6 offset:12288
    v_mfma_f32_16x16x32_bf16 v[132:135], a[44:47], a[80:83], v[132:135]
    v_mfma_f32_16x16x32_bf16 v[192:195], a[48:51], a[80:83], v[192:195]
    v_mfma_f32_16x16x32_bf16 v[196:199], a[52:55], a[80:83], v[196:199]
    buffer_load_dwordx4 v21, s[44:47], s55 offen offset:3072 lds
    v_mfma_f32_16x16x32_bf16 a[96:99], a[56:59], a[80:83], a[96:99]
    s_add_u32 s55, s55, s56
    ds_read_b128 a[28:31], v6 offset:14336
    v_mfma_f32_16x16x32_bf16 a[100:103], a[60:63], a[80:83], a[100:103]
    ds_read_b64_tr_b16 a[80:81], v12 offset:0
    v_mfma_f32_16x16x32_bf16 v[72:75], a[32:35], a[84:87], v[72:75]
    ds_read_b64_tr_b16 a[82:83], v12 offset:2048
    v_mfma_f32_16x16x32_bf16 v[76:79], a[36:39], a[84:87], v[76:79]
    v_mfma_f32_16x16x32_bf16 v[136:139], a[40:43], a[84:87], v[136:139]
    buffer_store_dwordx4 a[172:175], v2, s[24:27], s28 offen sc1
    v_mfma_f32_16x16x32_bf16 v[140:143], a[44:47], a[84:87], v[140:143]
    s_add_u32 s28, s28, s31
    v_mfma_f32_16x16x32_bf16 v[200:203], a[48:51], a[84:87], v[200:203]
    v_mfma_f32_16x16x32_bf16 v[204:207], a[52:55], a[84:87], v[204:207]
    v_mfma_f32_16x16x32_bf16 a[104:107], a[56:59], a[84:87], a[104:107]
    buffer_store_dwordx4 a[176:179], v2, s[24:27], s28 offen sc1
    v_mfma_f32_16x16x32_bf16 a[108:111], a[60:63], a[84:87], a[108:111]
    s_add_u32 s28, s28, s31
    ds_read_b64_tr_b16 a[84:85], v13 offset:0
    v_mfma_f32_16x16x32_bf16 v[80:83], a[32:35], a[88:91], v[80:83]
    ds_read_b64_tr_b16 a[86:87], v13 offset:2048
    v_mfma_f32_16x16x32_bf16 v[84:87], a[36:39], a[88:91], v[84:87]
    v_mfma_f32_16x16x32_bf16 v[144:147], a[40:43], a[88:91], v[144:147]
    buffer_store_dwordx4 a[180:183], v2, s[24:27], s28 offen sc1
    v_mfma_f32_16x16x32_bf16 v[148:151], a[44:47], a[88:91], v[148:151]
    s_add_u32 s28, s28, s31
    v_mfma_f32_16x16x32_bf16 v[208:211], a[48:51], a[88:91], v[208:211]
    v_mfma_f32_16x16x32_bf16 v[212:215], a[52:55], a[88:91], v[212:215]
    v_mfma_f32_16x16x32_bf16 a[112:115], a[56:59], a[88:91], a[112:115]
    buffer_store_dwordx4 a[184:187], v2, s[24:27], s28 offen sc1
    v_mfma_f32_16x16x32_bf16 a[116:119], a[60:63], a[88:91], a[116:119]
    s_add_u32 s28, s28, s31
    ds_read_b64_tr_b16 a[88:89], v14 offset:0
    v_mfma_f32_16x16x32_bf16 v[88:91], a[32:35], a[92:95], v[88:91]
    ds_read_b64_tr_b16 a[90:91], v14 offset:2048
    v_mfma_f32_16x16x32_bf16 v[92:95], a[36:39], a[92:95], v[92:95]
    v_mfma_f32_16x16x32_bf16 v[152:155], a[40:43], a[92:95], v[152:155]
    buffer_store_dwordx4 a[188:191], v2, s[24:27], s28 offen sc1
    v_mfma_f32_16x16x32_bf16 v[156:159], a[44:47], a[92:95], v[156:159]
    s_add_u32 s29, s29, s30
    s_mov_b32 s28, s29
    v_mfma_f32_16x16x32_bf16 v[216:219], a[48:51], a[92:95], v[216:219]
    s_sub_u32 s65, s65, 1
    v_mfma_f32_16x16x32_bf16 v[220:223], a[52:55], a[92:95], v[220:223]
    v_mfma_f32_16x16x32_bf16 a[120:123], a[56:59], a[92:95], a[120:123]
    v_mfma_f32_16x16x32_bf16 a[124:127], a[60:63], a[92:95], a[124:127]
    ds_read_b64_tr_b16 a[92:93], v15 offset:0
    ds_read_b64_tr_b16 a[94:95], v15 offset:2048
    s_cmp_eq_u32 s66, 2
    s_cbranch_scc1 mega_kernel_hook17
mega_kernel_hookr18:
    s_waitcnt lgkmcnt(15)
    v_mfma_f32_16x16x32_bf16 v[32:35], a[0:3], a[64:67], v[32:35]
    v_mfma_f32_16x16x32_bf16 v[36:39], a[4:7], a[64:67], v[36:39]
    v_mfma_f32_16x16x32_bf16 v[96:99], a[8:11], a[64:67], v[96:99]
    v_mfma_f32_16x16x32_bf16 v[100:103], a[12:15], a[64:67], v[100:103]
    s_add_u32 m0, s61, 0
    s_waitcnt lgkmcnt(13)
    v_mfma_f32_16x16x32_bf16 v[160:163], a[16:19], a[64:67], v[160:163]
    buffer_load_dwordx4 v16, s[40:43], s48 offen offset:0 lds
    s_waitcnt lgkmcnt(12)
    v_mfma_f32_16x16x32_bf16 v[164:167], a[20:23], a[64:67], v[164:167]
    s_waitcnt lgkmcnt(9)
    v_mfma_f32_16x16x32_bf16 v[224:227], a[24:27], a[64:67], v[224:227]
    s_waitcnt lgkmcnt(8)
    v_mfma_f32_16x16x32_bf16 v[228:231], a[28:31], a[64:67], v[228:231]
    ds_read_b64_tr_b16 a[64:65], v8 offset:16384
    v_mfma_f32_16x16x32_bf16 v[40:43], a[0:3], a[68:71], v[40:43]
    ds_read_b64_tr_b16 a[66:67], v8 offset:18432
    v_mfma_f32_16x16x32_bf16 v[44:47], a[4:7], a[68:71], v[44:47]
    v_mfma_f32_16x16x32_bf16 v[104:107], a[8:11], a[68:71], v[104:107]
    ds_read_b128 a[32:35], v7 offset:0
    v_mfma_f32_16x16x32_bf16 v[108:111], a[12:15], a[68:71], v[108:111]
    v_mfma_f32_16x16x32_bf16 v[168:171], a[16:19], a[68:71], v[168:171]
    buffer_load_dwordx4 v17, s[40:43], s48 offen offset:1024 lds
    v_mfma_f32_16x16x32_bf16 v[172:175], a[20:23], a[68:71], v[172:175]
    s_add_u32 s48, s48, 128
    v_mfma_f32_16x16x32_bf16 v[232:235], a[24:27], a[68:71], v[232:235]
    ds_read_b128 a[36:39], v7 offset:2048
    v_mfma_f32_16x16x32_bf16 v[236:239], a[28:31], a[68:71], v[236:239]
    ds_read_b64_tr_b16 a[68:69], v9 offset:16384
    v_mfma_f32_16x16x32_bf16 v[48:51], a[0:3], a[72:75], v[48:51]
    ds_read_b64_tr_b16 a[70:71], v9 offset:18432
    v_mfma_f32_16x16x32_bf16 v[52:55], a[4:7], a[72:75], v[52:55]
    v_mfma_f32_16x16x32_bf16 v[112:115], a[8:11], a[72:75], v[112:115]
    ds_read_b128 a[40:43], v7 offset:4096
    v_mfma_f32_16x16x32_bf16 v[116:119], a[12:15], a[72:75], v[116:119]
    v_mfma_f32_16x16x32_bf16 v[176:179], a[16:19], a[72:75], v[176:179]
    buffer_load_dwordx4 v16, s[40:43], s49 offen offset:2048 lds
    v_mfma_f32_16x16x32_bf16 v[180:183], a[20:23], a[72:75], v[180:183]
    v_mfma_f32_16x16x32_bf16 v[240:243], a[24:27], a[72:75], v[240:243]
    ds_read_b128 a[44:47], v7 offset:6144
    v_mfma_f32_16x16x32_bf16 v[244:247], a[28:31], a[72:75], v[244:247]
    ds_read_b64_tr_b16 a[72:73], v10 offset:16384
    v_mfma_f32_16x16x32_bf16 v[56:59], a[0:3], a[76:79], v[56:59]
    ds_read_b64_tr_b16 a[74:75], v10 offset:18432
    v_mfma_f32_16x16x32_bf16 v[60:63], a[4:7], a[76:79], v[60:63]
    v_mfma_f32_16x16x32_bf16 v[120:123], a[8:11], a[76:79], v[120:123]
    ds_read_b128 a[48:51], v7 offset:8192
    v_mfma_f32_16x16x32_bf16 v[124:127], a[12:15], a[76:79], v[124:127]
    v_mfma_f32_16x16x32_bf16 v[184:187], a[16:19], a[76:79], v[184:187]
    buffer_load_dwordx4 v17, s[40:43], s49 offen offset:3072 lds
    v_mfma_f32_16x16x32_bf16 v[188:191], a[20:23], a[76:79], v[188:191]
    s_add_u32 s49, s49, 128
    v_mfma_f32_16x16x32_bf16 v[248:251], a[24:27], a[76:79], v[248:251]
    ds_read_b128 a[52:55], v7 offset:10240
    v_mfma_f32_16x16x32_bf16 v[252:255], a[28:31], a[76:79], v[252:255]
    ds_read_b64_tr_b16 a[76:77], v11 offset:16384
    s_waitcnt lgkmcnt(15)
    v_mfma_f32_16x16x32_bf16 v[64:67], a[0:3], a[80:83], v[64:67]
    ds_read_b64_tr_b16 a[78:79], v11 offset:18432
    v_mfma_f32_16x16x32_bf16 v[68:71], a[4:7], a[80:83], v[68:71]
    v_mfma_f32_16x16x32_bf16 v[128:131], a[8:11], a[80:83], v[128:131]
    ds_read_b128 a[56:59], v7 offset:12288
    v_mfma_f32_16x16x32_bf16 v[132:135], a[12:15], a[80:83], v[132:135]
    s_add_u32 m0, s61, 4096
    v_mfma_f32_16x16x32_bf16 v[192:195], a[16:19], a[80:83], v[192:195]
    buffer_load_dwordx4 v16, s[40:43], s50 offen offset:0 lds
    v_mfma_f32_16x16x32_bf16 v[196:199], a[20:23], a[80:83], v[196:199]
    v_mfma_f32_16x16x32_bf16 a[96:99], a[24:27], a[80:83], a[96:99]
    s_add_u32 s61, s61, 32768
    ds_read_b128 a[60:63], v7 offset:14336
    v_mfma_f32_16x16x32_bf16 a[100:103], a[28:31], a[80:83], a[100:103]
    s_cmp_ge_u32 s61, 98304
    s_cselect_b32 s90, 98304, 0
    ds_read_b64_tr_b16 a[80:81], v12 offset:16384
    v_mfma_f32_16x16x32_bf16 v[72:75], a[0:3], a[84:87], v[72:75]
    s_sub_u32 s61, s61, s90
    ds_read_b64_tr_b16 a[82:83], v12 offset:18432
    v_mfma_f32_16x16x32_bf16 v[76:79], a[4:7], a[84:87], v[76:79]
    s_add_u32 s64, s64, 32768
    v_mfma_f32_16x16x32_bf16 v[136:139], a[8:11], a[84:87], v[136:139]
    buffer_store_dwordx4 a[192:195], v2, s[24:27], s28 offen sc1
    v_mfma_f32_16x16x32_bf16 v[140:143], a[12:15], a[84:87], v[140:143]
    s_add_u32 s28, s28, s31
    v_mfma_f32_16x16x32_bf16 v[200:203], a[16:19], a[84:87], v[200:203]
    buffer_load_dwordx4 v17, s[40:43], s50 offen offset:1024 lds
    v_mfma_f32_16x16x32_bf16 v[204:207], a[20:23], a[84:87], v[204:207]
    s_add_u32 s50, s50, 128
    v_mfma_f32_16x16x32_bf16 a[104:107], a[24:27], a[84:87], a[104:107]
    s_cmp_ge_u32 s64, 98304
    s_cselect_b32 s63, 4294901760, s59
    s_cselect_b32 s64, 0, s64
    v_mfma_f32_16x16x32_bf16 a[108:111], a[28:31], a[84:87], a[108:111]
    ds_read_b64_tr_b16 a[84:85], v13 offset:16384
    v_mfma_f32_16x16x32_bf16 v[80:83], a[0:3], a[88:91], v[80:83]
    ds_read_b64_tr_b16 a[86:87], v13 offset:18432
    v_mfma_f32_16x16x32_bf16 v[84:87], a[4:7], a[88:91], v[84:87]
    v_mfma_f32_16x16x32_bf16 v[144:147], a[8:11], a[88:91], v[144:147]
    buffer_store_dwordx4 a[196:199], v2, s[24:27], s28 offen sc1
    v_mfma_f32_16x16x32_bf16 v[148:151], a[12:15], a[88:91], v[148:151]
    s_add_u32 s28, s28, s31
    v_mfma_f32_16x16x32_bf16 v[208:211], a[16:19], a[88:91], v[208:211]
    buffer_load_dwordx4 v16, s[40:43], s51 offen offset:2048 lds
    v_mfma_f32_16x16x32_bf16 v[212:215], a[20:23], a[88:91], v[212:215]
    v_mfma_f32_16x16x32_bf16 a[112:115], a[24:27], a[88:91], a[112:115]
    v_mfma_f32_16x16x32_bf16 a[116:119], a[28:31], a[88:91], a[116:119]
    ds_read_b64_tr_b16 a[88:89], v14 offset:16384
    s_waitcnt lgkmcnt(15)
    v_mfma_f32_16x16x32_bf16 v[88:91], a[0:3], a[92:95], v[88:91]
    ds_read_b64_tr_b16 a[90:91], v14 offset:18432
    v_mfma_f32_16x16x32_bf16 v[92:95], a[4:7], a[92:95], v[92:95]
    v_add_u32 v6, s63, v6
    v_add_u32 v7, s63, v7
    v_mfma_f32_16x16x32_bf16 v[152:155], a[8:11], a[92:95], v[152:155]
    buffer_store_dwordx4 a[200:203], v2, s[24:27], s28 offen sc1
    v_mfma_f32_16x16x32_bf16 v[156:159], a[12:15], a[92:95], v[156:159]
    s_add_u32 s28, s28, s31
    v_mfma_f32_16x16x32_bf16 v[216:219], a[16:19], a[92:95], v[216:219]
    buffer_load_dwordx4 v17, s[40:43], s51 offen offset:3072 lds
    v_mfma_f32_16x16x32_bf16 v[220:223], a[20:23], a[92:95], v[220:223]
    s_add_u32 s51, s51, 128
    v_mfma_f32_16x16x32_bf16 a[120:123], a[24:27], a[92:95], a[120:123]
    v_mfma_f32_16x16x32_bf16 a[124:127], a[28:31], a[92:95], a[124:127]
    ds_read_b64_tr_b16 a[92:93], v15 offset:16384
    ds_read_b64_tr_b16 a[94:95], v15 offset:18432
    v_mfma_f32_16x16x32_bf16 v[32:35], a[32:35], a[64:67], v[32:35]
    v_xor_b32 v8, s60, v8
    v_xor_b32 v9, s60, v9
    v_mfma_f32_16x16x32_bf16 v[36:39], a[36:39], a[64:67], v[36:39]
    v_xor_b32 v10, s60, v10
    v_xor_b32 v11, s60, v11
    s_waitcnt lgkmcnt(15)
    v_mfma_f32_16x16x32_bf16 v[96:99], a[40:43], a[64:67], v[96:99]
    v_xor_b32 v12, s60, v12
    v_xor_b32 v13, s60, v13
    v_mfma_f32_16x16x32_bf16 v[100:103], a[44:47], a[64:67], v[100:103]
    v_xor_b32 v14, s60, v14
    v_xor_b32 v15, s60, v15
    s_waitcnt lgkmcnt(13)
    v_mfma_f32_16x16x32_bf16 v[160:163], a[48:51], a[64:67], v[160:163]
    s_waitcnt lgkmcnt(12)
    v_mfma_f32_16x16x32_bf16 v[164:167], a[52:55], a[64:67], v[164:167]
    s_waitcnt lgkmcnt(9)
    v_mfma_f32_16x16x32_bf16 v[224:227], a[56:59], a[64:67], v[224:227]
    s_waitcnt vmcnt(16) lgkmcnt(0)
    v_mfma_f32_16x16x32_bf16 v[228:231], a[60:63], a[64:67], v[228:231]
    s_barrier
    ds_read_b64_tr_b16 a[64:65], v8 offset:0
    v_mfma_f32_16x16x32_bf16 v[40:43], a[32:35], a[68:71], v[40:43]
    s_add_u32 m0, s62, 0
    ds_read_b64_tr_b16 a[66:67], v8 offset:2048
    v_mfma_f32_16x16x32_bf16 v[44:47], a[36:39], a[68:71], v[44:47]
    buffer_load_dwordx4 v18, s[44:47], s52 offen offset:0 lds
    v_mfma_f32_16x16x32_bf16 v[104:107], a[40:43], a[68:71], v[104:107]
    ds_read_b128 a[0:3], v6 offset:0
    v_mfma_f32_16x16x32_bf16 v[108:111], a[44:47], a[68:71], v[108:111]
    v_mfma_f32_16x16x32_bf16 v[168:171], a[48:51], a[68:71], v[168:171]
    v_mfma_f32_16x16x32_bf16 v[172:175], a[52:55], a[68:71], v[172:175]
    buffer_load_dwordx4 v19, s[44:47], s52 offen offset:1024 lds
    v_mfma_f32_16x16x32_bf16 v[232:235], a[56:59], a[68:71], v[232:235]
    s_add_u32 s52, s52, s56
    ds_read_b128 a[4:7], v6 offset:2048
    v_mfma_f32_16x16x32_bf16 v[236:239], a[60:63], a[68:71], v[236:239]
    ds_read_b64_tr_b16 a[68:69], v9 offset:0
    v_mfma_f32_16x16x32_bf16 v[48:51], a[32:35], a[72:75], v[48:51]
    ds_read_b64_tr_b16 a[70:71], v9 offset:2048
    v_mfma_f32_16x16x32_bf16 v[52:55], a[36:39], a[72:75], v[52:55]
    buffer_load_dwordx4 v18, s[44:47], s53 offen offset:2048 lds
    v_mfma_f32_16x16x32_bf16 v[112:115], a[40:43], a[72:75], v[112:115]
    ds_read_b128 a[8:11], v6 offset:4096
    v_mfma_f32_16x16x32_bf16 v[116:119], a[44:47], a[72:75], v[116:119]
    v_mfma_f32_16x16x32_bf16 v[176:179], a[48:51], a[72:75], v[176:179]
    v_mfma_f32_16x16x32_bf16 v[180:183], a[52:55], a[72:75], v[180:183]
    buffer_load_dwordx4 v19, s[44:47], s53 offen offset:3072 lds
    v_mfma_f32_16x16x32_bf16 v[240:243], a[56:59], a[72:75], v[240:243]
    s_add_u32 s53, s53, s56
    ds_read_b128 a[12:15], v6 offset:6144
    v_mfma_f32_16x16x32_bf16 v[244:247], a[60:63], a[72:75], v[244:247]
    ds_read_b64_tr_b16 a[72:73], v10 offset:0
    v_mfma_f32_16x16x32_bf16 v[56:59], a[32:35], a[76:79], v[56:59]
    s_add_u32 m0, s62, 4096
    ds_read_b64_tr_b16 a[74:75], v10 offset:2048
    v_mfma_f32_16x16x32_bf16 v[60:63], a[36:39], a[76:79], v[60:63]
    buffer_load_dwordx4 v20, s[44:47], s54 offen offset:0 lds
    v_mfma_f32_16x16x32_bf16 v[120:123], a[40:43], a[76:79], v[120:123]
    ds_read_b128 a[16:19], v6 offset:8192
    v_mfma_f32_16x16x32_bf16 v[124:127], a[44:47], a[76:79], v[124:127]
    s_xor_b32 s62, s62, 229376
    v_mfma_f32_16x16x32_bf16 v[184:187], a[48:51], a[76:79], v[184:187]
    v_mfma_f32_16x16x32_bf16 v[188:191], a[52:55], a[76:79], v[188:191]
    buffer_load_dwordx4 v21, s[44:47], s54 offen offset:1024 lds
    v_mfma_f32_16x16x32_bf16 v[248:251], a[56:59], a[76:79], v[248:251]
    s_add_u32 s54, s54, s56
    ds_read_b128 a[20:23], v6 offset:10240
    v_mfma_f32_16x16x32_bf16 v[252:255], a[60:63], a[76:79], v[252:255]
    ds_read_b64_tr_b16 a[76:77], v11 offset:0
    v_mfma_f32_16x16x32_bf16 v[64:67], a[32:35], a[80:83], v[64:67]
    ds_read_b64_tr_b16 a[78:79], v11 offset:2048
    v_mfma_f32_16x16x32_bf16 v[68:71], a[36:39], a[80:83], v[68:71]
    buffer_load_dwordx4 v20, s[44:47], s55 offen offset:2048 lds
    v_mfma_f32_16x16x32_bf16 v[128:131], a[40:43], a[80:83], v[128:131]
    ds_read_b128 a[24:27], v6 offset:12288
    v_mfma_f32_16x16x32_bf16 v[132:135], a[44:47], a[80:83], v[132:135]
    v_mfma_f32_16x16x32_bf16 v[192:195], a[48:51], a[80:83], v[192:195]
    v_mfma_f32_16x16x32_bf16 v[196:199], a[52:55], a[80:83], v[196:199]
    buffer_load_dwordx4 v21, s[44:47], s55 offen offset:3072 lds
    v_mfma_f32_16x16x32_bf16 a[96:99], a[56:59], a[80:83], a[96:99]
    s_add_u32 s55, s55, s56
    ds_read_b128 a[28:31], v6 offset:14336
    v_mfma_f32_16x16x32_bf16 a[100:103], a[60:63], a[80:83], a[100:103]
    ds_read_b64_tr_b16 a[80:81], v12 offset:0
    v_mfma_f32_16x16x32_bf16 v[72:75], a[32:35], a[84:87], v[72:75]
    ds_read_b64_tr_b16 a[82:83], v12 offset:2048
    v_mfma_f32_16x16x32_bf16 v[76:79], a[36:39], a[84:87], v[76:79]
    v_mfma_f32_16x16x32_bf16 v[136:139], a[40:43], a[84:87], v[136:139]
    buffer_store_dwordx4 a[204:207], v2, s[24:27], s28 offen sc1
    v_mfma_f32_16x16x32_bf16 v[140:143], a[44:47], a[84:87], v[140:143]
    s_add_u32 s28, s28, s31
    v_mfma_f32_16x16x32_bf16 v[200:203], a[48:51], a[84:87], v[200:203]
    v_mfma_f32_16x16x32_bf16 v[204:207], a[52:55], a[84:87], v[204:207]
    v_mfma_f32_16x16x32_bf16 a[104:107], a[56:59], a[84:87], a[104:107]
    buffer_store_dwordx4 a[208:211], v2, s[24:27], s28 offen sc1
    v_mfma_f32_16x16x32_bf16 a[108:111], a[60:63], a[84:87], a[108:111]
    s_add_u32 s28, s28, s31
    ds_read_b64_tr_b16 a[84:85], v13 offset:0
    v_mfma_f32_16x16x32_bf16 v[80:83], a[32:35], a[88:91], v[80:83]
    ds_read_b64_tr_b16 a[86:87], v13 offset:2048
    v_mfma_f32_16x16x32_bf16 v[84:87], a[36:39], a[88:91], v[84:87]
    v_mfma_f32_16x16x32_bf16 v[144:147], a[40:43], a[88:91], v[144:147]
    buffer_store_dwordx4 a[212:215], v2, s[24:27], s28 offen sc1
    v_mfma_f32_16x16x32_bf16 v[148:151], a[44:47], a[88:91], v[148:151]
    s_add_u32 s28, s28, s31
    v_mfma_f32_16x16x32_bf16 v[208:211], a[48:51], a[88:91], v[208:211]
    v_mfma_f32_16x16x32_bf16 v[212:215], a[52:55], a[88:91], v[212:215]
    v_mfma_f32_16x16x32_bf16 a[112:115], a[56:59], a[88:91], a[112:115]
    buffer_store_dwordx4 a[216:219], v2, s[24:27], s28 offen sc1
    v_mfma_f32_16x16x32_bf16 a[116:119], a[60:63], a[88:91], a[116:119]
    s_add_u32 s28, s28, s31
    ds_read_b64_tr_b16 a[88:89], v14 offset:0
    v_mfma_f32_16x16x32_bf16 v[88:91], a[32:35], a[92:95], v[88:91]
    ds_read_b64_tr_b16 a[90:91], v14 offset:2048
    v_mfma_f32_16x16x32_bf16 v[92:95], a[36:39], a[92:95], v[92:95]
    v_mfma_f32_16x16x32_bf16 v[152:155], a[40:43], a[92:95], v[152:155]
    buffer_store_dwordx4 a[220:223], v2, s[24:27], s28 offen sc1
    v_mfma_f32_16x16x32_bf16 v[156:159], a[44:47], a[92:95], v[156:159]
    s_add_u32 s29, s29, s30
    s_mov_b32 s28, s29
    v_mfma_f32_16x16x32_bf16 v[216:219], a[48:51], a[92:95], v[216:219]
    s_sub_u32 s65, s65, 1
    v_mfma_f32_16x16x32_bf16 v[220:223], a[52:55], a[92:95], v[220:223]
    v_mfma_f32_16x16x32_bf16 a[120:123], a[56:59], a[92:95], a[120:123]
    v_mfma_f32_16x16x32_bf16 a[124:127], a[60:63], a[92:95], a[124:127]
    ds_read_b64_tr_b16 a[92:93], v15 offset:0
    ds_read_b64_tr_b16 a[94:95], v15 offset:2048
    s_waitcnt lgkmcnt(15)
    v_mfma_f32_16x16x32_bf16 v[32:35], a[0:3], a[64:67], v[32:35]
    v_mfma_f32_16x16x32_bf16 v[36:39], a[4:7], a[64:67], v[36:39]
    v_mfma_f32_16x16x32_bf16 v[96:99], a[8:11], a[64:67], v[96:99]
    v_mfma_f32_16x16x32_bf16 v[100:103], a[12:15], a[64:67], v[100:103]
    s_add_u32 m0, s61, 0
    s_waitcnt lgkmcnt(13)
    v_mfma_f32_16x16x32_bf16 v[160:163], a[16:19], a[64:67], v[160:163]
    buffer_load_dwordx4 v16, s[40:43], s48 offen offset:0 lds
    s_waitcnt lgkmcnt(12)
    v_mfma_f32_16x16x32_bf16 v[164:167], a[20:23], a[64:67], v[164:167]
    s_waitcnt lgkmcnt(9)
    v_mfma_f32_16x16x32_bf16 v[224:227], a[24:27], a[64:67], v[224:227]
    s_waitcnt lgkmcnt(8)
    v_mfma_f32_16x16x32_bf16 v[228:231], a[28:31], a[64:67], v[228:231]
    ds_read_b64_tr_b16 a[64:65], v8 offset:16384
    v_mfma_f32_16x16x32_bf16 v[40:43], a[0:3], a[68:71], v[40:43]
    ds_read_b64_tr_b16 a[66:67], v8 offset:18432
    v_mfma_f32_16x16x32_bf16 v[44:47], a[4:7], a[68:71], v[44:47]
    v_mfma_f32_16x16x32_bf16 v[104:107], a[8:11], a[68:71], v[104:107]
    ds_read_b128 a[32:35], v7 offset:0
    v_mfma_f32_16x16x32_bf16 v[108:111], a[12:15], a[68:71], v[108:111]
    v_mfma_f32_16x16x32_bf16 v[168:171], a[16:19], a[68:71], v[168:171]
    buffer_load_dwordx4 v17, s[40:43], s48 offen offset:1024 lds
    v_mfma_f32_16x16x32_bf16 v[172:175], a[20:23], a[68:71], v[172:175]
    s_add_u32 s48, s48, 128
    v_mfma_f32_16x16x32_bf16 v[232:235], a[24:27], a[68:71], v[232:235]
    ds_read_b128 a[36:39], v7 offset:2048
    v_mfma_f32_16x16x32_bf16 v[236:239], a[28:31], a[68:71], v[236:239]
    ds_read_b64_tr_b16 a[68:69], v9 offset:16384
    v_mfma_f32_16x16x32_bf16 v[48:51], a[0:3], a[72:75], v[48:51]
    ds_read_b64_tr_b16 a[70:71], v9 offset:18432
    v_mfma_f32_16x16x32_bf16 v[52:55], a[4:7], a[72:75], v[52:55]
    v_mfma_f32_16x16x32_bf16 v[112:115], a[8:11], a[72:75], v[112:115]
    ds_read_b128 a[40:43], v7 offset:4096
    v_mfma_f32_16x16x32_bf16 v[116:119], a[12:15], a[72:75], v[116:119]
    v_mfma_f32_16x16x32_bf16 v[176:179], a[16:19], a[72:75], v[176:179]
    buffer_load_dwordx4 v16, s[40:43], s49 offen offset:2048 lds
    v_mfma_f32_16x16x32_bf16 v[180:183], a[20:23], a[72:75], v[180:183]
    v_mfma_f32_16x16x32_bf16 v[240:243], a[24:27], a[72:75], v[240:243]
    ds_read_b128 a[44:47], v7 offset:6144
    v_mfma_f32_16x16x32_bf16 v[244:247], a[28:31], a[72:75], v[244:247]
    ds_read_b64_tr_b16 a[72:73], v10 offset:16384
    v_mfma_f32_16x16x32_bf16 v[56:59], a[0:3], a[76:79], v[56:59]
    ds_read_b64_tr_b16 a[74:75], v10 offset:18432
    v_mfma_f32_16x16x32_bf16 v[60:63], a[4:7], a[76:79], v[60:63]
    v_mfma_f32_16x16x32_bf16 v[120:123], a[8:11], a[76:79], v[120:123]
    ds_read_b128 a[48:51], v7 offset:8192
    v_mfma_f32_16x16x32_bf16 v[124:127], a[12:15], a[76:79], v[124:127]
    v_mfma_f32_16x16x32_bf16 v[184:187], a[16:19], a[76:79], v[184:187]
    buffer_load_dwordx4 v17, s[40:43], s49 offen offset:3072 lds
    v_mfma_f32_16x16x32_bf16 v[188:191], a[20:23], a[76:79], v[188:191]
    s_add_u32 s49, s49, 128
    v_mfma_f32_16x16x32_bf16 v[248:251], a[24:27], a[76:79], v[248:251]
    ds_read_b128 a[52:55], v7 offset:10240
    v_mfma_f32_16x16x32_bf16 v[252:255], a[28:31], a[76:79], v[252:255]
    ds_read_b64_tr_b16 a[76:77], v11 offset:16384
    s_waitcnt lgkmcnt(15)
    v_mfma_f32_16x16x32_bf16 v[64:67], a[0:3], a[80:83], v[64:67]
    ds_read_b64_tr_b16 a[78:79], v11 offset:18432
    v_mfma_f32_16x16x32_bf16 v[68:71], a[4:7], a[80:83], v[68:71]
    v_mfma_f32_16x16x32_bf16 v[128:131], a[8:11], a[80:83], v[128:131]
    ds_read_b128 a[56:59], v7 offset:12288
    v_mfma_f32_16x16x32_bf16 v[132:135], a[12:15], a[80:83], v[132:135]
    s_add_u32 m0, s61, 4096
    v_mfma_f32_16x16x32_bf16 v[192:195], a[16:19], a[80:83], v[192:195]
    buffer_load_dwordx4 v16, s[40:43], s50 offen offset:0 lds
    v_mfma_f32_16x16x32_bf16 v[196:199], a[20:23], a[80:83], v[196:199]
    v_mfma_f32_16x16x32_bf16 a[96:99], a[24:27], a[80:83], a[96:99]
    s_add_u32 s61, s61, 32768
    ds_read_b128 a[60:63], v7 offset:14336
    v_mfma_f32_16x16x32_bf16 a[100:103], a[28:31], a[80:83], a[100:103]
    s_cmp_ge_u32 s61, 98304
    s_cselect_b32 s90, 98304, 0
    ds_read_b64_tr_b16 a[80:81], v12 offset:16384
    v_mfma_f32_16x16x32_bf16 v[72:75], a[0:3], a[84:87], v[72:75]
    s_sub_u32 s61, s61, s90
    ds_read_b64_tr_b16 a[82:83], v12 offset:18432
    v_mfma_f32_16x16x32_bf16 v[76:79], a[4:7], a[84:87], v[76:79]
    s_add_u32 s64, s64, 32768
    v_mfma_f32_16x16x32_bf16 v[136:139], a[8:11], a[84:87], v[136:139]
    buffer_store_dwordx4 a[224:227], v2, s[24:27], s28 offen sc1
    v_mfma_f32_16x16x32_bf16 v[140:143], a[12:15], a[84:87], v[140:143]
    s_add_u32 s28, s28, s31
    v_mfma_f32_16x16x32_bf16 v[200:203], a[16:19], a[84:87], v[200:203]
    buffer_load_dwordx4 v17, s[40:43], s50 offen offset:1024 lds
    v_mfma_f32_16x16x32_bf16 v[204:207], a[20:23], a[84:87], v[204:207]
    s_add_u32 s50, s50, 128
    v_mfma_f32_16x16x32_bf16 a[104:107], a[24:27], a[84:87], a[104:107]
    s_cmp_ge_u32 s64, 98304
    s_cselect_b32 s63, 4294901760, s59
    s_cselect_b32 s64, 0, s64
    v_mfma_f32_16x16x32_bf16 a[108:111], a[28:31], a[84:87], a[108:111]
    ds_read_b64_tr_b16 a[84:85], v13 offset:16384
    v_mfma_f32_16x16x32_bf16 v[80:83], a[0:3], a[88:91], v[80:83]
    ds_read_b64_tr_b16 a[86:87], v13 offset:18432
    v_mfma_f32_16x16x32_bf16 v[84:87], a[4:7], a[88:91], v[84:87]
    v_mfma_f32_16x16x32_bf16 v[144:147], a[8:11], a[88:91], v[144:147]
    buffer_store_dwordx4 a[228:231], v2, s[24:27], s28 offen sc1
    v_mfma_f32_16x16x32_bf16 v[148:151], a[12:15], a[88:91], v[148:151]
    s_add_u32 s28, s28, s31
    v_mfma_f32_16x16x32_bf16 v[208:211], a[16:19], a[88:91], v[208:211]
    buffer_load_dwordx4 v16, s[40:43], s51 offen offset:2048 lds
    v_mfma_f32_16x16x32_bf16 v[212:215], a[20:23], a[88:91], v[212:215]
    v_mfma_f32_16x16x32_bf16 a[112:115], a[24:27], a[88:91], a[112:115]
    v_mfma_f32_16x16x32_bf16 a[116:119], a[28:31], a[88:91], a[116:119]
    ds_read_b64_tr_b16 a[88:89], v14 offset:16384
    s_waitcnt lgkmcnt(15)
    v_mfma_f32_16x16x32_bf16 v[88:91], a[0:3], a[92:95], v[88:91]
    ds_read_b64_tr_b16 a[90:91], v14 offset:18432
    v_mfma_f32_16x16x32_bf16 v[92:95], a[4:7], a[92:95], v[92:95]
    v_add_u32 v6, s63, v6
    v_add_u32 v7, s63, v7
    v_mfma_f32_16x16x32_bf16 v[152:155], a[8:11], a[92:95], v[152:155]
    buffer_store_dwordx4 a[232:235], v2, s[24:27], s28 offen sc1
    v_mfma_f32_16x16x32_bf16 v[156:159], a[12:15], a[92:95], v[156:159]
    s_add_u32 s28, s28, s31
    v_mfma_f32_16x16x32_bf16 v[216:219], a[16:19], a[92:95], v[216:219]
    buffer_load_dwordx4 v17, s[40:43], s51 offen offset:3072 lds
    v_mfma_f32_16x16x32_bf16 v[220:223], a[20:23], a[92:95], v[220:223]
    s_add_u32 s51, s51, 128
    v_mfma_f32_16x16x32_bf16 a[120:123], a[24:27], a[92:95], a[120:123]
    v_mfma_f32_16x16x32_bf16 a[124:127], a[28:31], a[92:95], a[124:127]
    ds_read_b64_tr_b16 a[92:93], v15 offset:16384
    ds_read_b64_tr_b16 a[94:95], v15 offset:18432
    v_mfma_f32_16x16x32_bf16 v[32:35], a[32:35], a[64:67], v[32:35]
    v_xor_b32 v8, s60, v8
    v_xor_b32 v9, s60, v9
    v_mfma_f32_16x16x32_bf16 v[36:39], a[36:39], a[64:67], v[36:39]
    v_xor_b32 v10, s60, v10
    v_xor_b32 v11, s60, v11
    s_waitcnt lgkmcnt(15)
    v_mfma_f32_16x16x32_bf16 v[96:99], a[40:43], a[64:67], v[96:99]
    v_xor_b32 v12, s60, v12
    v_xor_b32 v13, s60, v13
    v_mfma_f32_16x16x32_bf16 v[100:103], a[44:47], a[64:67], v[100:103]
    v_xor_b32 v14, s60, v14
    v_xor_b32 v15, s60, v15
    s_waitcnt lgkmcnt(13)
    v_mfma_f32_16x16x32_bf16 v[160:163], a[48:51], a[64:67], v[160:163]
    s_waitcnt lgkmcnt(12)
    v_mfma_f32_16x16x32_bf16 v[164:167], a[52:55], a[64:67], v[164:167]
    s_waitcnt lgkmcnt(9)
    v_mfma_f32_16x16x32_bf16 v[224:227], a[56:59], a[64:67], v[224:227]
    s_waitcnt vmcnt(16) lgkmcnt(0)
    v_mfma_f32_16x16x32_bf16 v[228:231], a[60:63], a[64:67], v[228:231]
    s_barrier
    ds_read_b64_tr_b16 a[64:65], v8 offset:0
    v_mfma_f32_16x16x32_bf16 v[40:43], a[32:35], a[68:71], v[40:43]
    s_add_u32 m0, s62, 0
    ds_read_b64_tr_b16 a[66:67], v8 offset:2048
    v_mfma_f32_16x16x32_bf16 v[44:47], a[36:39], a[68:71], v[44:47]
    buffer_load_dwordx4 v18, s[44:47], s52 offen offset:0 lds
    v_mfma_f32_16x16x32_bf16 v[104:107], a[40:43], a[68:71], v[104:107]
    ds_read_b128 a[0:3], v6 offset:0
    v_mfma_f32_16x16x32_bf16 v[108:111], a[44:47], a[68:71], v[108:111]
    v_mfma_f32_16x16x32_bf16 v[168:171], a[48:51], a[68:71], v[168:171]
    v_mfma_f32_16x16x32_bf16 v[172:175], a[52:55], a[68:71], v[172:175]
    buffer_load_dwordx4 v19, s[44:47], s52 offen offset:1024 lds
    v_mfma_f32_16x16x32_bf16 v[232:235], a[56:59], a[68:71], v[232:235]
    s_add_u32 s52, s52, s56
    ds_read_b128 a[4:7], v6 offset:2048
    v_mfma_f32_16x16x32_bf16 v[236:239], a[60:63], a[68:71], v[236:239]
    ds_read_b64_tr_b16 a[68:69], v9 offset:0
    v_mfma_f32_16x16x32_bf16 v[48:51], a[32:35], a[72:75], v[48:51]
    ds_read_b64_tr_b16 a[70:71], v9 offset:2048
    v_mfma_f32_16x16x32_bf16 v[52:55], a[36:39], a[72:75], v[52:55]
    buffer_load_dwordx4 v18, s[44:47], s53 offen offset:2048 lds
    v_mfma_f32_16x16x32_bf16 v[112:115], a[40:43], a[72:75], v[112:115]
    ds_read_b128 a[8:11], v6 offset:4096
    v_mfma_f32_16x16x32_bf16 v[116:119], a[44:47], a[72:75], v[116:119]
    v_mfma_f32_16x16x32_bf16 v[176:179], a[48:51], a[72:75], v[176:179]
    v_mfma_f32_16x16x32_bf16 v[180:183], a[52:55], a[72:75], v[180:183]
    buffer_load_dwordx4 v19, s[44:47], s53 offen offset:3072 lds
    v_mfma_f32_16x16x32_bf16 v[240:243], a[56:59], a[72:75], v[240:243]
    s_add_u32 s53, s53, s56
    ds_read_b128 a[12:15], v6 offset:6144
    v_mfma_f32_16x16x32_bf16 v[244:247], a[60:63], a[72:75], v[244:247]
    ds_read_b64_tr_b16 a[72:73], v10 offset:0
    v_mfma_f32_16x16x32_bf16 v[56:59], a[32:35], a[76:79], v[56:59]
    s_add_u32 m0, s62, 4096
    ds_read_b64_tr_b16 a[74:75], v10 offset:2048
    v_mfma_f32_16x16x32_bf16 v[60:63], a[36:39], a[76:79], v[60:63]
    buffer_load_dwordx4 v20, s[44:47], s54 offen offset:0 lds
    v_mfma_f32_16x16x32_bf16 v[120:123], a[40:43], a[76:79], v[120:123]
    ds_read_b128 a[16:19], v6 offset:8192
    v_mfma_f32_16x16x32_bf16 v[124:127], a[44:47], a[76:79], v[124:127]
    s_xor_b32 s62, s62, 229376
    v_mfma_f32_16x16x32_bf16 v[184:187], a[48:51], a[76:79], v[184:187]
    v_mfma_f32_16x16x32_bf16 v[188:191], a[52:55], a[76:79], v[188:191]
    buffer_load_dwordx4 v21, s[44:47], s54 offen offset:1024 lds
    v_mfma_f32_16x16x32_bf16 v[248:251], a[56:59], a[76:79], v[248:251]
    s_add_u32 s54, s54, s56
    ds_read_b128 a[20:23], v6 offset:10240
    v_mfma_f32_16x16x32_bf16 v[252:255], a[60:63], a[76:79], v[252:255]
    ds_read_b64_tr_b16 a[76:77], v11 offset:0
    v_mfma_f32_16x16x32_bf16 v[64:67], a[32:35], a[80:83], v[64:67]
    ds_read_b64_tr_b16 a[78:79], v11 offset:2048
    v_mfma_f32_16x16x32_bf16 v[68:71], a[36:39], a[80:83], v[68:71]
    buffer_load_dwordx4 v20, s[44:47], s55 offen offset:2048 lds
    v_mfma_f32_16x16x32_bf16 v[128:131], a[40:43], a[80:83], v[128:131]
    ds_read_b128 a[24:27], v6 offset:12288
    v_mfma_f32_16x16x32_bf16 v[132:135], a[44:47], a[80:83], v[132:135]
    v_mfma_f32_16x16x32_bf16 v[192:195], a[48:51], a[80:83], v[192:195]
    v_mfma_f32_16x16x32_bf16 v[196:199], a[52:55], a[80:83], v[196:199]
    buffer_load_dwordx4 v21, s[44:47], s55 offen offset:3072 lds
    v_mfma_f32_16x16x32_bf16 a[96:99], a[56:59], a[80:83], a[96:99]
    s_add_u32 s55, s55, s56
    ds_read_b128 a[28:31], v6 offset:14336
    v_mfma_f32_16x16x32_bf16 a[100:103], a[60:63], a[80:83], a[100:103]
    ds_read_b64_tr_b16 a[80:81], v12 offset:0
    v_mfma_f32_16x16x32_bf16 v[72:75], a[32:35], a[84:87], v[72:75]
    ds_read_b64_tr_b16 a[82:83], v12 offset:2048
    v_mfma_f32_16x16x32_bf16 v[76:79], a[36:39], a[84:87], v[76:79]
    v_mfma_f32_16x16x32_bf16 v[136:139], a[40:43], a[84:87], v[136:139]
    buffer_store_dwordx4 a[236:239], v2, s[24:27], s28 offen sc1
    v_mfma_f32_16x16x32_bf16 v[140:143], a[44:47], a[84:87], v[140:143]
    s_add_u32 s28, s28, s31
    v_mfma_f32_16x16x32_bf16 v[200:203], a[48:51], a[84:87], v[200:203]
    v_mfma_f32_16x16x32_bf16 v[204:207], a[52:55], a[84:87], v[204:207]
    v_mfma_f32_16x16x32_bf16 a[104:107], a[56:59], a[84:87], a[104:107]
    buffer_store_dwordx4 a[240:243], v2, s[24:27], s28 offen sc1
    v_mfma_f32_16x16x32_bf16 a[108:111], a[60:63], a[84:87], a[108:111]
    s_add_u32 s28, s28, s31
    ds_read_b64_tr_b16 a[84:85], v13 offset:0
    v_mfma_f32_16x16x32_bf16 v[80:83], a[32:35], a[88:91], v[80:83]
    ds_read_b64_tr_b16 a[86:87], v13 offset:2048
    v_mfma_f32_16x16x32_bf16 v[84:87], a[36:39], a[88:91], v[84:87]
    v_mfma_f32_16x16x32_bf16 v[144:147], a[40:43], a[88:91], v[144:147]
    buffer_store_dwordx4 a[244:247], v2, s[24:27], s28 offen sc1
    v_mfma_f32_16x16x32_bf16 v[148:151], a[44:47], a[88:91], v[148:151]
    s_add_u32 s28, s28, s31
    v_mfma_f32_16x16x32_bf16 v[208:211], a[48:51], a[88:91], v[208:211]
    v_mfma_f32_16x16x32_bf16 v[212:215], a[52:55], a[88:91], v[212:215]
    v_mfma_f32_16x16x32_bf16 a[112:115], a[56:59], a[88:91], a[112:115]
    buffer_store_dwordx4 a[248:251], v2, s[24:27], s28 offen sc1
    v_mfma_f32_16x16x32_bf16 a[116:119], a[60:63], a[88:91], a[116:119]
    s_add_u32 s28, s28, s31
    ds_read_b64_tr_b16 a[88:89], v14 offset:0
    v_mfma_f32_16x16x32_bf16 v[88:91], a[32:35], a[92:95], v[88:91]
    ds_read_b64_tr_b16 a[90:91], v14 offset:2048
    v_mfma_f32_16x16x32_bf16 v[92:95], a[36:39], a[92:95], v[92:95]
    v_mfma_f32_16x16x32_bf16 v[152:155], a[40:43], a[92:95], v[152:155]
    buffer_store_dwordx4 a[252:255], v2, s[24:27], s28 offen sc1
    v_mfma_f32_16x16x32_bf16 v[156:159], a[44:47], a[92:95], v[156:159]
    s_add_u32 s29, s29, s30
    s_mov_b32 s28, s29
    v_mfma_f32_16x16x32_bf16 v[216:219], a[48:51], a[92:95], v[216:219]
    s_sub_u32 s65, s65, 1
    v_mfma_f32_16x16x32_bf16 v[220:223], a[52:55], a[92:95], v[220:223]
    v_mfma_f32_16x16x32_bf16 a[120:123], a[56:59], a[92:95], a[120:123]
    v_mfma_f32_16x16x32_bf16 a[124:127], a[60:63], a[92:95], a[124:127]
    ds_read_b64_tr_b16 a[92:93], v15 offset:0
    ds_read_b64_tr_b16 a[94:95], v15 offset:2048
mega_kernel_loop19:
    s_waitcnt lgkmcnt(15)
    v_mfma_f32_16x16x32_bf16 v[32:35], a[0:3], a[64:67], v[32:35]
    v_mfma_f32_16x16x32_bf16 v[36:39], a[4:7], a[64:67], v[36:39]
    v_mfma_f32_16x16x32_bf16 v[96:99], a[8:11], a[64:67], v[96:99]
    v_mfma_f32_16x16x32_bf16 v[100:103], a[12:15], a[64:67], v[100:103]
    s_add_u32 m0, s61, 0
    s_waitcnt lgkmcnt(13)
    v_mfma_f32_16x16x32_bf16 v[160:163], a[16:19], a[64:67], v[160:163]
    buffer_load_dwordx4 v16, s[40:43], s48 offen offset:0 lds
    s_waitcnt lgkmcnt(12)
    v_mfma_f32_16x16x32_bf16 v[164:167], a[20:23], a[64:67], v[164:167]
    s_waitcnt lgkmcnt(9)
    v_mfma_f32_16x16x32_bf16 v[224:227], a[24:27], a[64:67], v[224:227]
    s_waitcnt lgkmcnt(8)
    v_mfma_f32_16x16x32_bf16 v[228:231], a[28:31], a[64:67], v[228:231]
    ds_read_b64_tr_b16 a[64:65], v8 offset:16384
    v_mfma_f32_16x16x32_bf16 v[40:43], a[0:3], a[68:71], v[40:43]
    ds_read_b64_tr_b16 a[66:67], v8 offset:18432
    v_mfma_f32_16x16x32_bf16 v[44:47], a[4:7], a[68:71], v[44:47]
    v_mfma_f32_16x16x32_bf16 v[104:107], a[8:11], a[68:71], v[104:107]
    ds_read_b128 a[32:35], v7 offset:0
    v_mfma_f32_16x16x32_bf16 v[108:111], a[12:15], a[68:71], v[108:111]
    v_mfma_f32_16x16x32_bf16 v[168:171], a[16:19], a[68:71], v[168:171]
    buffer_load_dwordx4 v17, s[40:43], s48 offen offset:1024 lds
    v_mfma_f32_16x16x32_bf16 v[172:175], a[20:23], a[68:71], v[172:175]
    s_add_u32 s48, s48, 128
    v_mfma_f32_16x16x32_bf16 v[232:235], a[24:27], a[68:71], v[232:235]
    ds_read_b128 a[36:39], v7 offset:2048
    v_mfma_f32_16x16x32_bf16 v[236:239], a[28:31], a[68:71], v[236:239]
    ds_read_b64_tr_b16 a[68:69], v9 offset:16384
    v_mfma_f32_16x16x32_bf16 v[48:51], a[0:3], a[72:75], v[48:51]
    ds_read_b64_tr_b16 a[70:71], v9 offset:18432
    v_mfma_f32_16x16x32_bf16 v[52:55], a[4:7], a[72:75], v[52:55]
    v_mfma_f32_16x16x32_bf16 v[112:115], a[8:11], a[72:75], v[112:115]
    ds_read_b128 a[40:43], v7 offset:4096
    v_mfma_f32_16x16x32_bf16 v[116:119], a[12:15], a[72:75], v[116:119]
    v_mfma_f32_16x16x32_bf16 v[176:179], a[16:19], a[72:75], v[176:179]
    buffer_load_dwordx4 v16, s[40:43], s49 offen offset:2048 lds
    v_mfma_f32_16x16x32_bf16 v[180:183], a[20:23], a[72:75], v[180:183]
    v_mfma_f32_16x16x32_bf16 v[240:243], a[24:27], a[72:75], v[240:243]
    ds_read_b128 a[44:47], v7 offset:6144
    v_mfma_f32_16x16x32_bf16 v[244:247], a[28:31], a[72:75], v[244:247]
    ds_read_b64_tr_b16 a[72:73], v10 offset:16384
    v_mfma_f32_16x16x32_bf16 v[56:59], a[0:3], a[76:79], v[56:59]
    ds_read_b64_tr_b16 a[74:75], v10 offset:18432
    v_mfma_f32_16x16x32_bf16 v[60:63], a[4:7], a[76:79], v[60:63]
    v_mfma_f32_16x16x32_bf16 v[120:123], a[8:11], a[76:79], v[120:123]
    ds_read_b128 a[48:51], v7 offset:8192
    v_mfma_f32_16x16x32_bf16 v[124:127], a[12:15], a[76:79], v[124:127]
    v_mfma_f32_16x16x32_bf16 v[184:187], a[16:19], a[76:79], v[184:187]
    buffer_load_dwordx4 v17, s[40:43], s49 offen offset:3072 lds
    v_mfma_f32_16x16x32_bf16 v[188:191], a[20:23], a[76:79], v[188:191]
    s_add_u32 s49, s49, 128
    v_mfma_f32_16x16x32_bf16 v[248:251], a[24:27], a[76:79], v[248:251]
    ds_read_b128 a[52:55], v7 offset:10240
    v_mfma_f32_16x16x32_bf16 v[252:255], a[28:31], a[76:79], v[252:255]
    ds_read_b64_tr_b16 a[76:77], v11 offset:16384
    s_waitcnt lgkmcnt(15)
    v_mfma_f32_16x16x32_bf16 v[64:67], a[0:3], a[80:83], v[64:67]
    ds_read_b64_tr_b16 a[78:79], v11 offset:18432
    v_mfma_f32_16x16x32_bf16 v[68:71], a[4:7], a[80:83], v[68:71]
    v_mfma_f32_16x16x32_bf16 v[128:131], a[8:11], a[80:83], v[128:131]
    ds_read_b128 a[56:59], v7 offset:12288
    v_mfma_f32_16x16x32_bf16 v[132:135], a[12:15], a[80:83], v[132:135]
    s_add_u32 m0, s61, 4096
    v_mfma_f32_16x16x32_bf16 v[192:195], a[16:19], a[80:83], v[192:195]
    buffer_load_dwordx4 v16, s[40:43], s50 offen offset:0 lds
    v_mfma_f32_16x16x32_bf16 v[196:199], a[20:23], a[80:83], v[196:199]
    v_mfma_f32_16x16x32_bf16 a[96:99], a[24:27], a[80:83], a[96:99]
    s_add_u32 s61, s61, 32768
    ds_read_b128 a[60:63], v7 offset:14336
    v_mfma_f32_16x16x32_bf16 a[100:103], a[28:31], a[80:83], a[100:103]
    s_cmp_ge_u32 s61, 98304
    s_cselect_b32 s90, 98304, 0
    ds_read_b64_tr_b16 a[80:81], v12 offset:16384
    v_mfma_f32_16x16x32_bf16 v[72:75], a[0:3], a[84:87], v[72:75]
    s_sub_u32 s61, s61, s90
    ds_read_b64_tr_b16 a[82:83], v12 offset:18432
    v_mfma_f32_16x16x32_bf16 v[76:79], a[4:7], a[84:87], v[76:79]
    s_add_u32 s64, s64, 32768
    v_mfma_f32_16x16x32_bf16 v[136:139], a[8:11], a[84:87], v[136:139]
    s_cmp_ge_u32 s64, 98304
    s_cselect_b32 s63, 4294901760, s59
    s_cselect_b32 s64, 0, s64
    v_mfma_f32_16x16x32_bf16 v[140:143], a[12:15], a[84:87], v[140:143]
    v_mfma_f32_16x16x32_bf16 v[200:203], a[16:19], a[84:87], v[200:203]
    buffer_load_dwordx4 v17, s[40:43], s50 offen offset:1024 lds
    v_mfma_f32_16x16x32_bf16 v[204:207], a[20:23], a[84:87], v[204:207]
    s_add_u32 s50, s50, 128
    v_mfma_f32_16x16x32_bf16 a[104:107], a[24:27], a[84:87], a[104:107]
    v_mfma_f32_16x16x32_bf16 a[108:111], a[28:31], a[84:87], a[108:111]
    ds_read_b64_tr_b16 a[84:85], v13 offset:16384
    v_mfma_f32_16x16x32_bf16 v[80:83], a[0:3], a[88:91], v[80:83]
    ds_read_b64_tr_b16 a[86:87], v13 offset:18432
    v_mfma_f32_16x16x32_bf16 v[84:87], a[4:7], a[88:91], v[84:87]
    v_mfma_f32_16x16x32_bf16 v[144:147], a[8:11], a[88:91], v[144:147]
    v_mfma_f32_16x16x32_bf16 v[148:151], a[12:15], a[88:91], v[148:151]
    v_mfma_f32_16x16x32_bf16 v[208:211], a[16:19], a[88:91], v[208:211]
    buffer_load_dwordx4 v16, s[40:43], s51 offen offset:2048 lds
    v_mfma_f32_16x16x32_bf16 v[212:215], a[20:23], a[88:91], v[212:215]
    v_mfma_f32_16x16x32_bf16 a[112:115], a[24:27], a[88:91], a[112:115]
    v_mfma_f32_16x16x32_bf16 a[116:119], a[28:31], a[88:91], a[116:119]
    ds_read_b64_tr_b16 a[88:89], v14 offset:16384
    s_waitcnt lgkmcnt(15)
    v_mfma_f32_16x16x32_bf16 v[88:91], a[0:3], a[92:95], v[88:91]
    ds_read_b64_tr_b16 a[90:91], v14 offset:18432
    v_mfma_f32_16x16x32_bf16 v[92:95], a[4:7], a[92:95], v[92:95]
    v_add_u32 v6, s63, v6
    v_add_u32 v7, s63, v7
    v_mfma_f32_16x16x32_bf16 v[152:155], a[8:11], a[92:95], v[152:155]
    v_mfma_f32_16x16x32_bf16 v[156:159], a[12:15], a[92:95], v[156:159]
    v_mfma_f32_16x16x32_bf16 v[216:219], a[16:19], a[92:95], v[216:219]
    buffer_load_dwordx4 v17, s[40:43], s51 offen offset:3072 lds
    v_mfma_f32_16x16x32_bf16 v[220:223], a[20:23], a[92:95], v[220:223]
    s_add_u32 s51, s51, 128
    v_mfma_f32_16x16x32_bf16 a[120:123], a[24:27], a[92:95], a[120:123]
    v_mfma_f32_16x16x32_bf16 a[124:127], a[28:31], a[92:95], a[124:127]
    ds_read_b64_tr_b16 a[92:93], v15 offset:16384
    ds_read_b64_tr_b16 a[94:95], v15 offset:18432
    v_mfma_f32_16x16x32_bf16 v[32:35], a[32:35], a[64:67], v[32:35]
    v_xor_b32 v8, s60, v8
    v_xor_b32 v9, s60, v9
    v_mfma_f32_16x16x32_bf16 v[36:39], a[36:39], a[64:67], v[36:39]
    v_xor_b32 v10, s60, v10
    v_xor_b32 v11, s60, v11
    s_waitcnt lgkmcnt(15)
    v_mfma_f32_16x16x32_bf16 v[96:99], a[40:43], a[64:67], v[96:99]
    v_xor_b32 v12, s60, v12
    v_xor_b32 v13, s60, v13
    v_mfma_f32_16x16x32_bf16 v[100:103], a[44:47], a[64:67], v[100:103]
    v_xor_b32 v14, s60, v14
    v_xor_b32 v15, s60, v15
    s_waitcnt lgkmcnt(13)
    v_mfma_f32_16x16x32_bf16 v[160:163], a[48:51], a[64:67], v[160:163]
    s_waitcnt lgkmcnt(12)
    v_mfma_f32_16x16x32_bf16 v[164:167], a[52:55], a[64:67], v[164:167]
    s_waitcnt lgkmcnt(9)
    v_mfma_f32_16x16x32_bf16 v[224:227], a[56:59], a[64:67], v[224:227]
    s_waitcnt vmcnt(8) lgkmcnt(0)
    v_mfma_f32_16x16x32_bf16 v[228:231], a[60:63], a[64:67], v[228:231]
    s_barrier
    ds_read_b64_tr_b16 a[64:65], v8 offset:0
    v_mfma_f32_16x16x32_bf16 v[40:43], a[32:35], a[68:71], v[40:43]
    s_add_u32 m0, s62, 0
    ds_read_b64_tr_b16 a[66:67], v8 offset:2048
    v_mfma_f32_16x16x32_bf16 v[44:47], a[36:39], a[68:71], v[44:47]
    buffer_load_dwordx4 v18, s[44:47], s52 offen offset:0 lds
    v_mfma_f32_16x16x32_bf16 v[104:107], a[40:43], a[68:71], v[104:107]
    ds_read_b128 a[0:3], v6 offset:0
    v_mfma_f32_16x16x32_bf16 v[108:111], a[44:47], a[68:71], v[108:111]
    v_mfma_f32_16x16x32_bf16 v[168:171], a[48:51], a[68:71], v[168:171]
    v_mfma_f32_16x16x32_bf16 v[172:175], a[52:55], a[68:71], v[172:175]
    buffer_load_dwordx4 v19, s[44:47], s52 offen offset:1024 lds
    v_mfma_f32_16x16x32_bf16 v[232:235], a[56:59], a[68:71], v[232:235]
    s_add_u32 s52, s52, s56
    ds_read_b128 a[4:7], v6 offset:2048
    v_mfma_f32_16x16x32_bf16 v[236:239], a[60:63], a[68:71], v[236:239]
    ds_read_b64_tr_b16 a[68:69], v9 offset:0
    v_mfma_f32_16x16x32_bf16 v[48:51], a[32:35], a[72:75], v[48:51]
    ds_read_b64_tr_b16 a[70:71], v9 offset:2048
    v_mfma_f32_16x16x32_bf16 v[52:55], a[36:39], a[72:75], v[52:55]
    buffer_load_dwordx4 v18, s[44:47], s53 offen offset:2048 lds
    v_mfma_f32_16x16x32_bf16 v[112:115], a[40:43], a[72:75], v[112:115]
    ds_read_b128 a[8:11], v6 offset:4096
    v_mfma_f32_16x16x32_bf16 v[116:119], a[44:47], a[72:75], v[116:119]
    v_mfma_f32_16x16x32_bf16 v[176:179], a[48:51], a[72:75], v[176:179]
    v_mfma_f32_16x16x32_bf16 v[180:183], a[52:55], a[72:75], v[180:183]
    buffer_load_dwordx4 v19, s[44:47], s53 offen offset:3072 lds
    v_mfma_f32_16x16x32_bf16 v[240:243], a[56:59], a[72:75], v[240:243]
    s_add_u32 s53, s53, s56
    ds_read_b128 a[12:15], v6 offset:6144
    v_mfma_f32_16x16x32_bf16 v[244:247], a[60:63], a[72:75], v[244:247]
    ds_read_b64_tr_b16 a[72:73], v10 offset:0
    v_mfma_f32_16x16x32_bf16 v[56:59], a[32:35], a[76:79], v[56:59]
    s_add_u32 m0, s62, 4096
    ds_read_b64_tr_b16 a[74:75], v10 offset:2048
    v_mfma_f32_16x16x32_bf16 v[60:63], a[36:39], a[76:79], v[60:63]
    buffer_load_dwordx4 v20, s[44:47], s54 offen offset:0 lds
    v_mfma_f32_16x16x32_bf16 v[120:123], a[40:43], a[76:79], v[120:123]
    ds_read_b128 a[16:19], v6 offset:8192
    v_mfma_f32_16x16x32_bf16 v[124:127], a[44:47], a[76:79], v[124:127]
    s_xor_b32 s62, s62, 229376
    v_mfma_f32_16x16x32_bf16 v[184:187], a[48:51], a[76:79], v[184:187]
    v_mfma_f32_16x16x32_bf16 v[188:191], a[52:55], a[76:79], v[188:191]
    buffer_load_dwordx4 v21, s[44:47], s54 offen offset:1024 lds
    v_mfma_f32_16x16x32_bf16 v[248:251], a[56:59], a[76:79], v[248:251]
    s_add_u32 s54, s54, s56
    ds_read_b128 a[20:23], v6 offset:10240
    v_mfma_f32_16x16x32_bf16 v[252:255], a[60:63], a[76:79], v[252:255]
    ds_read_b64_tr_b16 a[76:77], v11 offset:0
    v_mfma_f32_16x16x32_bf16 v[64:67], a[32:35], a[80:83], v[64:67]
    ds_read_b64_tr_b16 a[78:79], v11 offset:2048
    v_mfma_f32_16x16x32_bf16 v[68:71], a[36:39], a[80:83], v[68:71]
    buffer_load_dwordx4 v20, s[44:47], s55 offen offset:2048 lds
    v_mfma_f32_16x16x32_bf16 v[128:131], a[40:43], a[80:83], v[128:131]
    ds_read_b128 a[24:27], v6 offset:12288
    v_mfma_f32_16x16x32_bf16 v[132:135], a[44:47], a[80:83], v[132:135]
    v_mfma_f32_16x16x32_bf16 v[192:195], a[48:51], a[80:83], v[192:195]
    v_mfma_f32_16x16x32_bf16 v[196:199], a[52:55], a[80:83], v[196:199]
    buffer_load_dwordx4 v21, s[44:47], s55 offen offset:3072 lds
    v_mfma_f32_16x16x32_bf16 a[96:99], a[56:59], a[80:83], a[96:99]
    s_add_u32 s55, s55, s56
    ds_read_b128 a[28:31], v6 offset:14336
    v_mfma_f32_16x16x32_bf16 a[100:103], a[60:63], a[80:83], a[100:103]
    ds_read_b64_tr_b16 a[80:81], v12 offset:0
    v_mfma_f32_16x16x32_bf16 v[72:75], a[32:35], a[84:87], v[72:75]
    ds_read_b64_tr_b16 a[82:83], v12 offset:2048
    v_mfma_f32_16x16x32_bf16 v[76:79], a[36:39], a[84:87], v[76:79]
    v_mfma_f32_16x16x32_bf16 v[136:139], a[40:43], a[84:87], v[136:139]
    v_mfma_f32_16x16x32_bf16 v[140:143], a[44:47], a[84:87], v[140:143]
    v_mfma_f32_16x16x32_bf16 v[200:203], a[48:51], a[84:87], v[200:203]
    v_mfma_f32_16x16x32_bf16 v[204:207], a[52:55], a[84:87], v[204:207]
    v_mfma_f32_16x16x32_bf16 a[104:107], a[56:59], a[84:87], a[104:107]
    v_mfma_f32_16x16x32_bf16 a[108:111], a[60:63], a[84:87], a[108:111]
    ds_read_b64_tr_b16 a[84:85], v13 offset:0
    v_mfma_f32_16x16x32_bf16 v[80:83], a[32:35], a[88:91], v[80:83]
    ds_read_b64_tr_b16 a[86:87], v13 offset:2048
    v_mfma_f32_16x16x32_bf16 v[84:87], a[36:39], a[88:91], v[84:87]
    v_mfma_f32_16x16x32_bf16 v[144:147], a[40:43], a[88:91], v[144:147]
    v_mfma_f32_16x16x32_bf16 v[148:151], a[44:47], a[88:91], v[148:151]
    v_mfma_f32_16x16x32_bf16 v[208:211], a[48:51], a[88:91], v[208:211]
    v_mfma_f32_16x16x32_bf16 v[212:215], a[52:55], a[88:91], v[212:215]
    v_mfma_f32_16x16x32_bf16 a[112:115], a[56:59], a[88:91], a[112:115]
    v_mfma_f32_16x16x32_bf16 a[116:119], a[60:63], a[88:91], a[116:119]
    ds_read_b64_tr_b16 a[88:89], v14 offset:0
    v_mfma_f32_16x16x32_bf16 v[88:91], a[32:35], a[92:95], v[88:91]
    ds_read_b64_tr_b16 a[90:91], v14 offset:2048
    v_mfma_f32_16x16x32_bf16 v[92:95], a[36:39], a[92:95], v[92:95]
    v_mfma_f32_16x16x32_bf16 v[152:155], a[40:43], a[92:95], v[152:155]
    v_mfma_f32_16x16x32_bf16 v[156:159], a[44:47], a[92:95], v[156:159]
    v_mfma_f32_16x16x32_bf16 v[216:219], a[48:51], a[92:95], v[216:219]
    s_sub_u32 s65, s65, 1
    v_mfma_f32_16x16x32_bf16 v[220:223], a[52:55], a[92:95], v[220:223]
    v_mfma_f32_16x16x32_bf16 a[120:123], a[56:59], a[92:95], a[120:123]
    s_cmp_gt_u32 s65, s67
    v_mfma_f32_16x16x32_bf16 a[124:127], a[60:63], a[92:95], a[124:127]
    ds_read_b64_tr_b16 a[92:93], v15 offset:0
    ds_read_b64_tr_b16 a[94:95], v15 offset:2048
    s_cbranch_scc1 mega_kernel_loop19
    s_cmp_lg_u32 s65, 0
    s_cbranch_scc1 mega_kernel_dosw20
mega_kernel_epi11:
    s_cmp_eq_u32 s94, 0
    s_cbranch_scc1 mega_kernel_last23
    s_mov_b32 s3, 1048576
mega_kernel_spin27:
    v_readfirstlane_b32 s4, v4
    v_readfirstlane_b32 s5, v5
    s_nop 3
    s_cmp_lg_u32 s4, 0
    s_cbranch_scc1 mega_kernel_ok28
    s_sub_u32 s3, s3, 1
    s_cbranch_scc1 mega_kernel_ok28
    s_sleep 32
    buffer_load_dwordx2 v[4:5], off, s[12:15], 0 sc1
    s_waitcnt vmcnt(0)
    s_branch mega_kernel_spin27
mega_kernel_ok28:
    s_cmp_ge_u32 s68, 16
    s_cbranch_scc1 mega_kernel_q030
    s_call_b64 s[20:21], mega_kernel_epf21
    s_mov_b32 s17, s101
    s_mov_b32 s66, 2
    s_branch mega_kernel_q129
mega_kernel_q030:
    s_call_b64 s[20:21], mega_kernel_eps22
    s_mov_b32 s17, s101
    s_mov_b32 s28, s98
    s_mov_b32 s29, s98
    s_mov_b32 s30, s99
    s_mov_b32 s31, s100
    s_mov_b32 s26, 268435456
mega_kernel_q129:
    s_mov_b32 s95, s82
    s_mov_b32 s96, s83
    s_mov_b32 s97, s84
    s_mov_b32 s98, s85
    s_mov_b32 s99, s86
    s_mov_b32 s100, s87
    s_mov_b32 s101, s88
    s_sub_u32 s67, s95, 5
    s_mov_b32 s94, 0
    s_branch mega_kernel_tile10
mega_kernel_last23:
    s_cmp_eq_u32 s70, 0
    s_cbranch_scc1 mega_kernel_kvl26
    buffer_load_dwordx2 v[4:5], off, s[12:15], 0 sc1
    s_call_b64 s[20:21], mega_kernel_epf21
    s_waitcnt vmcnt(0)
    s_barrier
    s_mov_b32 s3, 1048576
mega_kernel_spin31:
    v_readfirstlane_b32 s4, v4
    v_readfirstlane_b32 s5, v5
    s_nop 3
    s_cmp_lg_u32 s4, 0
    s_cbranch_scc1 mega_kernel_ok32
    s_sub_u32 s3, s3, 1
    s_cbranch_scc1 mega_kernel_ok32
    s_sleep 32
    buffer_load_dwordx2 v[4:5], off, s[12:15], 0 sc1
    s_waitcnt vmcnt(0)
    s_branch mega_kernel_spin31
mega_kernel_ok32:
    s_cmp_lg_u32 s16, 0
    s_cbranch_scc1 mega_kernel_np33
    v_mov_b32 v4, s4
    v_mov_b32 v5, s5
    s_add_u32 s90, s101, 117440512
    s_mov_b64 exec, 1
    buffer_store_dwordx2 v[4:5], off, s[8:11], s90 sc1
    s_mov_b64 exec, -1
mega_kernel_np33:
    s_cmp_lg_u32 s16, 0
    s_cbranch_scc1 mega_kernel_pw34
    s_and_b32 s92, s2, 7
    s_lshl_b32 s92, s92, 2
    s_bfe_u32 s93, s2, 0x20003
    s_add_u32 s92, s92, s93
    s_lshr_b32 s93, s2, 5
    s_lshl_b32 s93, s93, 2
    s_or_b32 s93, s93, 0x40000
    s_lshr_b32 s90, s92, 1
    s_lshl_b32 s90, s90, 7
    s_add_u32 s90, s90, 117440512
    s_bfe_u32 s91, 1376806003, s93
    s_lshr_b32 s91, s91, 1
    v_mov_b32 v0, s91
    v_add_u32 v4, 8, v1
    v_cmp_gt_u32 vcc, 8, v1
    s_nop 1
    v_cndmask_b32 v0, v0, v4, vcc
    s_bfe_u32 s91, 4242446987, s93
    s_lshr_b32 s91, s91, 1
    v_writelane_b32 v0, s91, 8
    v_lshlrev_b32 v0, 3, v0
    buffer_load_dwordx2 v[4:5], v0, s[8:11], s90 offen sc1
    s_waitcnt vmcnt(0)
    s_mov_b32 s3, 1048576
mega_kernel_spin35:
    v_cmp_ne_u64 s[22:23], s[4:5], v[4:5]
    s_nop 3
    s_cmp_eq_u64 s[22:23], 0
    s_cbranch_scc1 mega_kernel_ok36
    s_sub_u32 s3, s3, 1
    s_cbranch_scc1 mega_kernel_ok36
    s_sleep 16
    s_and_b32 s92, s2, 7
    s_lshl_b32 s92, s92, 2
    s_bfe_u32 s93, s2, 0x20003
    s_add_u32 s92, s92, s93
    s_lshr_b32 s93, s2, 5
    s_lshl_b32 s93, s93, 2
    s_or_b32 s93, s93, 0x40000
    s_lshr_b32 s90, s92, 1
    s_lshl_b32 s90, s90, 7
    s_add_u32 s90, s90, 117440512
    s_bfe_u32 s91, 1376806003, s93
    s_lshr_b32 s91, s91, 1
    v_mov_b32 v0, s91
    v_add_u32 v4, 8, v1
    v_cmp_gt_u32 vcc, 8, v1
    s_nop 1
    v_cndmask_b32 v0, v0, v4, vcc
    s_bfe_u32 s91, 4242446987, s93
    s_lshr_b32 s91, s91, 1
    v_writelane_b32 v0, s91, 8
    v_lshlrev_b32 v0, 3, v0
    buffer_load_dwordx2 v[4:5], v0, s[8:11], s90 offen sc1
    s_waitcnt vmcnt(0)
    s_branch mega_kernel_spin35
mega_kernel_ok36:
mega_kernel_pw34:
    s_barrier
    s_and_b32 s92, s2, 7
    s_lshl_b32 s92, s92, 2
    s_bfe_u32 s93, s2, 0x20003
    s_add_u32 s92, s92, s93
    s_lshr_b32 s93, s2, 5
    s_lshl_b32 s93, s93, 2
    s_or_b32 s93, s93, 0x40000
    s_bfe_u32 s90, 4242446987, s93
    s_lshl_b32 s90, s90, 3
    s_lshl_b32 s91, s16, 1
    s_add_u32 s90, s90, s91
    s_lshl_b32 s90, s90, 12
    s_lshl_b32 s91, s92, 19
    s_add_u32 s90, s90, s91
    s_add_u32 s90, s90, 0
    buffer_load_dwordx4 a[128:131], v2, s[8:11], s90 offen offset:0 sc1
    buffer_load_dwordx4 a[132:135], v2, s[8:11], s90 offen offset:1024 sc1
    buffer_load_dwordx4 a[136:139], v2, s[8:11], s90 offen offset:2048 sc1
    buffer_load_dwordx4 a[140:143], v2, s[8:11], s90 offen offset:3072 sc1
    s_bfe_u32 s90, 4242446987, s93
    s_lshl_b32 s90, s90, 3
    s_lshl_b32 s91, s16, 1
    s_add_u32 s90, s90, s91
    s_lshl_b32 s90, s90, 12
    s_lshl_b32 s91, s92, 19
    s_add_u32 s90, s90, s91
    s_add_u32 s90, s90, 4096
    buffer_load_dwordx4 a[144:147], v2, s[8:11], s90 offen offset:0 sc1
    buffer_load_dwordx4 a[148:151], v2, s[8:11], s90 offen offset:1024 sc1
    buffer_load_dwordx4 a[152:155], v2, s[8:11], s90 offen offset:2048 sc1
    buffer_load_dwordx4 a[156:159], v2, s[8:11], s90 offen offset:3072 sc1
    s_bfe_u32 s90, 1376806003, s93
    s_lshl_b32 s90, s90, 3
    s_lshl_b32 s91, s16, 1
    s_add_u32 s90, s90, s91
    s_lshl_b32 s90, s90, 12
    s_lshl_b32 s91, s92, 19
    s_add_u32 s90, s90, s91
    s_add_u32 s90, s90, 0
    buffer_load_dwordx4 a[160:163], v2, s[8:11], s90 offen offset:0 sc1
    buffer_load_dwordx4 a[164:167], v2, s[8:11], s90 offen offset:1024 sc1
    buffer_load_dwordx4 a[168:171], v2, s[8:11], s90 offen offset:2048 sc1
    buffer_load_dwordx4 a[172:175], v2, s[8:11], s90 offen offset:3072 sc1
    s_bfe_u32 s90, 1376806003, s93
    s_lshl_b32 s90, s90, 3
    s_lshl_b32 s91, s16, 1
    s_add_u32 s90, s90, s91
    s_lshl_b32 s90, s90, 12
    s_lshl_b32 s91, s92, 19
    s_add_u32 s90, s90, s91
    s_add_u32 s90, s90, 4096
    buffer_load_dwordx4 a[176:179], v2, s[8:11], s90 offen offset:0 sc1
    buffer_load_dwordx4 a[180:183], v2, s[8:11], s90 offen offset:1024 sc1
    buffer_load_dwordx4 a[184:187], v2, s[8:11], s90 offen offset:2048 sc1
    buffer_load_dwordx4 a[188:191], v2, s[8:11], s90 offen offset:3072 sc1
    s_mov_b32 s94, 1
mega_kernel_kvl26:
    s_waitcnt lgkmcnt(0)
    s_barrier
    s_and_b32 s92, s2, 7
    s_lshl_b32 s92, s92, 2
    s_bfe_u32 s93, s2, 0x20003
    s_add_u32 s92, s92, s93
    s_lshr_b32 s93, s2, 5
    s_lshl_b32 s93, s93, 2
    s_or_b32 s93, s93, 0x40000
    s_mov_b32 s32, s92
    s_bfe_u32 s33, 4242446987, s93
    s_add_u32 s33, s33, 1
    s_bfe_u32 s34, 1376806003, s93
    s_add_u32 s34, s34, 1
    s_lshl_b32 s57, s16, 12
    v_add_u32 v7, s57, v2
    s_lshl_b32 s90, s34, 2
    s_lshl_b32 s91, s33, 2
    s_lshl_b32 s26, s91, 13
    s_mov_b32 s30, s26
    s_sub_u32 s63, s90, 4
    s_add_u32 s63, s63, s16
    s_add_u32 s64, s63, 1
    s_mov_b32 s65, s90
    s_sub_u32 s66, s91, 4
    s_add_u32 s66, s66, s16
    s_add_u32 s67, s66, 1
    s_mov_b32 s68, s91
    s_mov_b32 s27, 0x20000
    s_mov_b32 s31, 0x20000
    s_lshl_b32 s78, s32, 19
    s_add_u32 s90, s78, 16777216
    s_add_u32 s24, s6, s90
    s_addc_u32 s25, s7, 0
    s_add_u32 s90, s78, 33554432
    s_add_u32 s28, s6, s90
    s_addc_u32 s29, s7, 0
    s_cmp_eq_u32 s94, 1
    s_cbranch_scc1 mega_kernel_w063
    s_mov_b32 s53, 32768
    s_mov_b32 s54, 16384
    s_add_u32 s56, s57, 65536
    s_mov_b32 m0, s56
    s_nop 0
    buffer_load_dwordx4 v7, s[24:27], s53 offen offset:0 sc1 lds
    buffer_load_dwordx4 v7, s[24:27], s53 offen offset:1024 sc1 lds
    buffer_load_dwordx4 v7, s[24:27], s53 offen offset:2048 sc1 lds
    buffer_load_dwordx4 v7, s[24:27], s53 offen offset:3072 sc1 lds
    s_add_u32 s53, s53, 16384
    s_add_u32 m0, s56, 16384
    s_nop 0
    buffer_load_dwordx4 v7, s[28:31], s54 offen offset:0 sc1 lds
    buffer_load_dwordx4 v7, s[28:31], s54 offen offset:1024 sc1 lds
    buffer_load_dwordx4 v7, s[28:31], s54 offen offset:2048 sc1 lds
    buffer_load_dwordx4 v7, s[28:31], s54 offen offset:3072 sc1 lds
    s_add_u32 s54, s54, 16384
    s_call_b64 s[20:21], mega_kernel_epl61
    s_mov_b32 s17, s101
    s_mov_b32 s38, 268435456
    s_branch mega_kernel_init25
mega_kernel_w063:
    s_mov_b32 s53, 0
    s_mov_b32 s54, 0
    s_mov_b32 m0, s57
    s_nop 0
    buffer_load_dwordx4 v7, s[24:27], s53 offen offset:0 sc1 lds
    buffer_load_dwordx4 v7, s[24:27], s53 offen offset:1024 sc1 lds
    buffer_load_dwordx4 v7, s[24:27], s53 offen offset:2048 sc1 lds
    buffer_load_dwordx4 v7, s[24:27], s53 offen offset:3072 sc1 lds
    s_mov_b32 s53, 16384
    s_add_u32 s56, s57, 32768
    s_mov_b32 m0, s56
    s_nop 0
    buffer_load_dwordx4 v7, s[24:27], s53 offen offset:0 sc1 lds
    buffer_load_dwordx4 v7, s[24:27], s53 offen offset:1024 sc1 lds
    buffer_load_dwordx4 v7, s[24:27], s53 offen offset:2048 sc1 lds
    buffer_load_dwordx4 v7, s[24:27], s53 offen offset:3072 sc1 lds
    s_add_u32 s53, s53, 16384
    s_add_u32 m0, s56, 16384
    s_nop 0
    buffer_load_dwordx4 v7, s[28:31], s54 offen offset:0 sc1 lds
    buffer_load_dwordx4 v7, s[28:31], s54 offen offset:1024 sc1 lds
    buffer_load_dwordx4 v7, s[28:31], s54 offen offset:2048 sc1 lds
    buffer_load_dwordx4 v7, s[28:31], s54 offen offset:3072 sc1 lds
    s_add_u32 s54, s54, 16384
    s_add_u32 s56, s56, 32768
    s_mov_b32 m0, s56
    s_nop 0
    buffer_load_dwordx4 v7, s[24:27], s53 offen offset:0 sc1 lds
    buffer_load_dwordx4 v7, s[24:27], s53 offen offset:1024 sc1 lds
    buffer_load_dwordx4 v7, s[24:27], s53 offen offset:2048 sc1 lds
    buffer_load_dwordx4 v7, s[24:27], s53 offen offset:3072 sc1 lds
    s_add_u32 s53, s53, 16384
    s_add_u32 m0, s56, 16384
    s_nop 0
    buffer_load_dwordx4 v7, s[28:31], s54 offen offset:0 sc1 lds
    buffer_load_dwordx4 v7, s[28:31], s54 offen offset:1024 sc1 lds
    buffer_load_dwordx4 v7, s[28:31], s54 offen offset:2048 sc1 lds
    buffer_load_dwordx4 v7, s[28:31], s54 offen offset:3072 sc1 lds
    s_add_u32 s54, s54, 16384
    s_add_u32 s56, s56, 32768
    s_mov_b32 m0, s56
    s_nop 0
    buffer_load_dwordx4 v7, s[24:27], s53 offen offset:0 sc1 lds
    buffer_load_dwordx4 v7, s[24:27], s53 offen offset:1024 sc1 lds
    buffer_load_dwordx4 v7, s[24:27], s53 offen offset:2048 sc1 lds
    buffer_load_dwordx4 v7, s[24:27], s53 offen offset:3072 sc1 lds
    s_add_u32 s53, s53, 16384
    s_add_u32 m0, s56, 16384
    s_nop 0
    buffer_load_dwordx4 v7, s[28:31], s54 offen offset:0 sc1 lds
    buffer_load_dwordx4 v7, s[28:31], s54 offen offset:1024 sc1 lds
    buffer_load_dwordx4 v7, s[28:31], s54 offen offset:2048 sc1 lds
    buffer_load_dwordx4 v7, s[28:31], s54 offen offset:3072 sc1 lds
    s_add_u32 s54, s54, 16384
    s_add_u32 s56, s56, 32768
    s_waitcnt vmcnt(0)
    s_mov_b32 s38, 0
mega_kernel_init25:
    s_mov_b32 s53, 65536
    s_mov_b32 s54, 49152
    s_nop 1
    v_mov_b32 v9, 0xff800000
    s_mov_b32 s61, 1233125376
    s_lshl_b32 s91, s16, 1
    s_sub_u32 s91, s91, 8
    s_lshl_b32 s74, s33, 3
    s_add_u32 s74, s74, s91
    s_lshl_b32 s75, s34, 3
    s_add_u32 s75, s75, s91
    s_mov_b32 s36, s6
    s_mov_b32 s37, s7
    s_mov_b32 s39, 0x20000
    s_load_dwordx2 s[48:49], s[0:1], 64
    s_load_dwordx2 s[50:51], s[0:1], 16
    s_mov_b32 s47, 0x20000
    s_lshl_b32 s90, s99, 1
    s_add_u32 s98, s98, s90
    s_lshl_b32 s90, s100, 2
    s_add_u32 s40, s98, s90
    s_lshr_b32 s90, s32, 1
    s_lshl_b32 s90, s90, 7
    s_add_u32 s90, s90, 117444608
    s_lshr_b32 s91, s2, 6
    s_lshl_b32 s91, s91, 8
    s_add_u32 s91, s91, 117446592
    v_min_u32 v10, 31, v1
    v_lshlrev_b32 v10, 3, v10
    v_mov_b32 v11, s90
    v_mov_b32 v8, s91
    v_cmp_gt_u32 vcc, 8, v1
    s_nop 1
    v_cndmask_b32 v11, v8, v11, vcc
    v_add_u32 v10, v10, v11
    s_lshl_b32 s90, s16, 8
    s_add_u32 s90, s90, s2
    s_cmp_ge_u32 s90, 128
    s_cbranch_scc1 mega_kernel_c364
    s_lshl_b32 s90, s90, 7
    s_add_u32 s90, s90, 117506048
    v_mov_b32 v8, 0
    s_mov_b64 exec, 1
    buffer_store_dword v8, off, s[8:11], s90 sc1
    s_mov_b64 exec, -1
mega_kernel_c364:
    s_mov_b32 s55, 0
    v_mov_b32 v6, v2
    v_accvgpr_write_b32 a0, 0
    v_accvgpr_write_b32 a1, 0
    v_accvgpr_write_b32 a2, 0
    v_accvgpr_write_b32 a3, 0
    v_accvgpr_write_b32 a4, 0
    v_accvgpr_write_b32 a5, 0
    v_accvgpr_write_b32 a6, 0
    v_accvgpr_write_b32 a7, 0
    v_accvgpr_write_b32 a8, 0
    v_accvgpr_write_b32 a9, 0
    v_accvgpr_write_b32 a10, 0
    v_accvgpr_write_b32 a11, 0
    v_accvgpr_write_b32 a12, 0
    v_accvgpr_write_b32 a13, 0
    v_accvgpr_write_b32 a14, 0
    v_accvgpr_write_b32 a15, 0
    v_accvgpr_write_b32 a16, 0
    v_accvgpr_write_b32 a17, 0
    v_accvgpr_write_b32 a18, 0
    v_accvgpr_write_b32 a19, 0
    v_accvgpr_write_b32 a20, 0
    v_accvgpr_write_b32 a21, 0
    v_accvgpr_write_b32 a22, 0
    v_accvgpr_write_b32 a23, 0
    v_accvgpr_write_b32 a24, 0
    v_accvgpr_write_b32 a25, 0
    v_accvgpr_write_b32 a26, 0
    v_accvgpr_write_b32 a27, 0
    v_accvgpr_write_b32 a28, 0
    v_accvgpr_write_b32 a29, 0
    v_accvgpr_write_b32 a30, 0
    v_accvgpr_write_b32 a31, 0
    v_accvgpr_write_b32 a32, 0
    v_accvgpr_write_b32 a33, 0
    v_accvgpr_write_b32 a34, 0
    v_accvgpr_write_b32 a35, 0
    v_accvgpr_write_b32 a36, 0
    v_accvgpr_write_b32 a37, 0
    v_accvgpr_write_b32 a38, 0
    v_accvgpr_write_b32 a39, 0
    v_accvgpr_write_b32 a40, 0
    v_accvgpr_write_b32 a41, 0
    v_accvgpr_write_b32 a42, 0
    v_accvgpr_write_b32 a43, 0
    v_accvgpr_write_b32 a44, 0
    v_accvgpr_write_b32 a45, 0
    v_accvgpr_write_b32 a46, 0
    v_accvgpr_write_b32 a47, 0
    v_accvgpr_write_b32 a48, 0
    v_accvgpr_write_b32 a49, 0
    v_accvgpr_write_b32 a50, 0
    v_accvgpr_write_b32 a51, 0
    v_accvgpr_write_b32 a52, 0
    v_accvgpr_write_b32 a53, 0
    v_accvgpr_write_b32 a54, 0
    v_accvgpr_write_b32 a55, 0
    v_accvgpr_write_b32 a56, 0
    v_accvgpr_write_b32 a57, 0
    v_accvgpr_write_b32 a58, 0
    v_accvgpr_write_b32 a59, 0
    v_accvgpr_write_b32 a60, 0
    v_accvgpr_write_b32 a61, 0
    v_accvgpr_write_b32 a62, 0
    v_accvgpr_write_b32 a63, 0
    v_accvgpr_write_b32 a64, 0
    v_accvgpr_write_b32 a65, 0
    v_accvgpr_write_b32 a66, 0
    v_accvgpr_write_b32 a67, 0
    v_accvgpr_write_b32 a68, 0
    v_accvgpr_write_b32 a69, 0
    v_accvgpr_write_b32 a70, 0
    v_accvgpr_write_b32 a71, 0
    v_accvgpr_write_b32 a72, 0
    v_accvgpr_write_b32 a73, 0
    v_accvgpr_write_b32 a74, 0
    v_accvgpr_write_b32 a75, 0
    v_accvgpr_write_b32 a76, 0
    v_accvgpr_write_b32 a77, 0
    v_accvgpr_write_b32 a78, 0
    v_accvgpr_write_b32 a79, 0
    v_accvgpr_write_b32 a80, 0
    v_accvgpr_write_b32 a81, 0
    v_accvgpr_write_b32 a82, 0
    v_accvgpr_write_b32 a83, 0
    v_accvgpr_write_b32 a84, 0
    v_accvgpr_write_b32 a85, 0
    v_accvgpr_write_b32 a86, 0
    v_accvgpr_write_b32 a87, 0
    v_accvgpr_write_b32 a88, 0
    v_accvgpr_write_b32 a89, 0
    v_accvgpr_write_b32 a90, 0
    v_accvgpr_write_b32 a91, 0
    v_accvgpr_write_b32 a92, 0
    v_accvgpr_write_b32 a93, 0
    v_accvgpr_write_b32 a94, 0
    v_accvgpr_write_b32 a95, 0
    v_accvgpr_write_b32 a96, 0
    v_accvgpr_write_b32 a97, 0
    v_accvgpr_write_b32 a98, 0
    v_accvgpr_write_b32 a99, 0
    v_accvgpr_write_b32 a100, 0
    v_accvgpr_write_b32 a101, 0
    v_accvgpr_write_b32 a102, 0
    v_accvgpr_write_b32 a103, 0
    v_accvgpr_write_b32 a104, 0
    v_accvgpr_write_b32 a105, 0
    v_accvgpr_write_b32 a106, 0
    v_accvgpr_write_b32 a107, 0
    v_accvgpr_write_b32 a108, 0
    v_accvgpr_write_b32 a109, 0
    v_accvgpr_write_b32 a110, 0
    v_accvgpr_write_b32 a111, 0
    v_accvgpr_write_b32 a112, 0
    v_accvgpr_write_b32 a113, 0
    v_accvgpr_write_b32 a114, 0
    v_accvgpr_write_b32 a115, 0
    v_accvgpr_write_b32 a116, 0
    v_accvgpr_write_b32 a117, 0
    v_accvgpr_write_b32 a118, 0
    v_accvgpr_write_b32 a119, 0
    v_accvgpr_write_b32 a120, 0
    v_accvgpr_write_b32 a121, 0
    v_accvgpr_write_b32 a122, 0
    v_accvgpr_write_b32 a123, 0
    v_accvgpr_write_b32 a124, 0
    v_accvgpr_write_b32 a125, 0
    v_accvgpr_write_b32 a126, 0
    v_accvgpr_write_b32 a127, 0
    v_mov_b32 v160, 0
    v_mov_b32 v161, 0
    v_mov_b32 v162, 0
    v_mov_b32 v163, 0
    v_mov_b32 v164, 0
    v_mov_b32 v165, 0
    v_mov_b32 v166, 0
    v_mov_b32 v167, 0
    v_mov_b32 v168, 0
    v_mov_b32 v169, 0
    v_mov_b32 v170, 0
    v_mov_b32 v171, 0
    v_mov_b32 v172, 0
    v_mov_b32 v173, 0
    v_mov_b32 v174, 0
    v_mov_b32 v175, 0
    v_mov_b32 v176, 0
    v_mov_b32 v177, 0
    v_mov_b32 v178, 0
    v_mov_b32 v179, 0
    v_mov_b32 v180, 0
    v_mov_b32 v181, 0
    v_mov_b32 v182, 0
    v_mov_b32 v183, 0
    v_mov_b32 v184, 0
    v_mov_b32 v185, 0
    v_mov_b32 v186, 0
    v_mov_b32 v187, 0
    v_mov_b32 v188, 0
    v_mov_b32 v189, 0
    v_mov_b32 v190, 0
    v_mov_b32 v191, 0
    v_mov_b32 v12, 0
    v_mov_b32 v28, 0
    v_mov_b32 v44, 0x3f803f80
    v_mov_b32 v13, 0
    v_mov_b32 v32, 0
    v_mov_b32 v45, 0x3f803f80
    v_mov_b32 v14, 0
    v_mov_b32 v36, 0
    v_mov_b32 v46, 0x3f803f80
    v_mov_b32 v15, 0
    v_mov_b32 v40, 0
    v_mov_b32 v47, 0x3f803f80
    s_and_b32 s90, s2, 7
    s_lshl_b32 s90, s90, 4
    s_lshl_b32 s91, s16, 2
    s_add_u32 s76, s90, s91
    s_lshr_b32 s92, s2, 3
    s_lshl_b32 s92, s92, 17
    s_lshl_b32 s90, s76, 10
    s_add_u32 s90, s90, s92
    s_add_u32 s79, s90, 50331648
    s_add_u32 s80, s90, 54525952
    s_and_b32 s77, s76, 63
    s_cmp_eq_u32 s77, 0
    s_cselect_b32 s93, 0, 1024
    s_sub_u32 s81, s80, s93
    s_lshl_b32 s90, s76, 9
    s_add_u32 s90, s90, s92
    s_add_u32 s82, s90, 58720256
    s_sub_u32 s83, s82, s93
    s_add_u32 s84, s82, 65536
    s_add_u32 s85, s83, 65536
    v_and_b32 v48, 15, v1
    v_lshrrev_b32 v49, 4, v1
    v_lshlrev_b32 v49, 2, v49
    v_sub_u32 v48, v48, v49
    v_cmp_le_i32 vcc, 0, v48
    s_nop 1
    v_cndmask_b32 v16, v9, 0, vcc
    v_cmp_le_i32 vcc, 1, v48
    s_nop 1
    v_cndmask_b32 v17, v9, 0, vcc
    v_cmp_le_i32 vcc, 2, v48
    s_nop 1
    v_cndmask_b32 v18, v9, 0, vcc
    v_cmp_le_i32 vcc, 3, v48
    s_nop 1
    v_cndmask_b32 v19, v9, 0, vcc
    s_mov_b32 s58, 35651616
    s_mov_b32 s59, 0
    s_sub_u32 s90, s63, 1
    s_bitset1_b64 s[58:59], s90
    s_sub_u32 s90, s64, 1
    s_bitset1_b64 s[58:59], s90
    s_sub_u32 s90, s65, 1
    s_bitset1_b64 s[58:59], s90
    s_sub_u32 s90, s66, 1
    s_bitset1_b64 s[58:59], s90
    s_sub_u32 s90, s67, 1
    s_bitset1_b64 s[58:59], s90
    s_sub_u32 s90, s68, 1
    s_bitset1_b64 s[58:59], s90
    s_sub_u32 s52, s68, 6
    s_sub_u32 s90, s52, 1
    s_bitset1_b64 s[58:59], s90
    s_mov_b32 s60, 0
    s_cmp_lg_u32 s60, s63
    s_cbranch_scc1 mega_kernel_e69
    v_add_f32 v176, v176, v16
    v_mov_b32 v180, v9
    v_add_f32 v188, v188, v16
    v_add_f32 v177, v177, v17
    v_mov_b32 v181, v9
    v_add_f32 v189, v189, v17
    v_add_f32 v178, v178, v18
    v_mov_b32 v182, v9
    v_add_f32 v190, v190, v18
    v_add_f32 v179, v179, v19
    v_mov_b32 v183, v9
    v_add_f32 v191, v191, v19
    s_nop 0
mega_kernel_e69:
    s_waitcnt vmcnt(24) lgkmcnt(0)
    s_barrier
    ds_read_b128 a[192:195], v6 offset:0
    ds_read_b128 a[196:199], v6 offset:1024
    ds_read_b128 a[200:203], v6 offset:2048
    ds_read_b128 a[204:207], v6 offset:3072
    ds_read_b128 a[208:211], v6 offset:4096
    ds_read_b128 a[212:215], v6 offset:5120
    ds_read_b128 a[216:219], v6 offset:6144
    ds_read_b128 a[220:223], v6 offset:7168
    s_waitcnt lgkmcnt(0)
    v_mfma_f32_16x16x32_bf16 v[64:67], a[192:195], a[128:131], v[160:163]
    v_mfma_f32_16x16x32_bf16 v[64:67], a[196:199], a[132:135], v[64:67]
    buffer_store_dwordx4 v[192:195], v2, s[36:39], s40 offen sc1
    s_add_u32 s40, s40, s100
    v_mfma_f32_16x16x32_bf16 v[64:67], a[200:203], a[136:139], v[64:67]
    v_mfma_f32_16x16x32_bf16 v[64:67], a[204:207], a[140:143], v[64:67]
    v_mfma_f32_16x16x32_bf16 v[72:75], a[192:195], a[144:147], v[168:171]
    v_mfma_f32_16x16x32_bf16 v[72:75], a[196:199], a[148:151], v[72:75]
    buffer_store_dwordx4 v[196:199], v2, s[36:39], s40 offen sc1
    s_add_u32 s40, s40, s100
    v_mfma_f32_16x16x32_bf16 v[72:75], a[200:203], a[152:155], v[72:75]
    v_mfma_f32_16x16x32_bf16 v[72:75], a[204:207], a[156:159], v[72:75]
    v_mfma_f32_16x16x32_bf16 v[80:83], a[192:195], a[160:163], v[176:179]
    v_mfma_f32_16x16x32_bf16 v[80:83], a[196:199], a[164:167], v[80:83]
    buffer_store_dwordx4 v[200:203], v2, s[36:39], s40 offen sc1
    s_add_u32 s40, s40, s100
    v_mfma_f32_16x16x32_bf16 v[80:83], a[200:203], a[168:171], v[80:83]
    v_mfma_f32_16x16x32_bf16 v[80:83], a[204:207], a[172:175], v[80:83]
    v_mfma_f32_16x16x32_bf16 v[88:91], a[192:195], a[176:179], v[184:187]
    v_mfma_f32_16x16x32_bf16 v[88:91], a[196:199], a[180:183], v[88:91]
    buffer_store_dwordx4 v[204:207], v2, s[36:39], s40 offen sc1
    s_add_u32 s40, s98, s99
    v_mfma_f32_16x16x32_bf16 v[88:91], a[200:203], a[184:187], v[88:91]
    v_mfma_f32_16x16x32_bf16 v[88:91], a[204:207], a[188:191], v[88:91]
    v_mfma_f32_16x16x32_bf16 v[68:71], a[208:211], a[128:131], v[164:167]
    ds_read_b128 a[192:195], v6 offset:8192
    v_mfma_f32_16x16x32_bf16 v[68:71], a[212:215], a[132:135], v[68:71]
    buffer_store_dwordx4 v[208:211], v2, s[36:39], s40 offen sc1
    s_add_u32 s40, s40, s100
    ds_read_b128 a[196:199], v6 offset:9216
    v_mfma_f32_16x16x32_bf16 v[68:71], a[216:219], a[136:139], v[68:71]
    ds_read_b128 a[200:203], v6 offset:10240
    v_mfma_f32_16x16x32_bf16 v[68:71], a[220:223], a[140:143], v[68:71]
    ds_read_b128 a[204:207], v6 offset:11264
    v_mfma_f32_16x16x32_bf16 v[76:79], a[208:211], a[144:147], v[172:175]
    v_mfma_f32_16x16x32_bf16 v[76:79], a[212:215], a[148:151], v[76:79]
    buffer_store_dwordx4 v[212:215], v2, s[36:39], s40 offen sc1
    s_add_u32 s40, s40, s100
    v_mfma_f32_16x16x32_bf16 v[76:79], a[216:219], a[152:155], v[76:79]
    v_mfma_f32_16x16x32_bf16 v[76:79], a[220:223], a[156:159], v[76:79]
    v_mfma_f32_16x16x32_bf16 v[84:87], a[208:211], a[160:163], v[180:183]
    v_mfma_f32_16x16x32_bf16 v[84:87], a[212:215], a[164:167], v[84:87]
    buffer_store_dwordx4 v[216:219], v2, s[36:39], s40 offen sc1
    s_add_u32 s40, s40, s100
    v_mfma_f32_16x16x32_bf16 v[84:87], a[216:219], a[168:171], v[84:87]
    v_mfma_f32_16x16x32_bf16 v[84:87], a[220:223], a[172:175], v[84:87]
    v_mfma_f32_16x16x32_bf16 v[92:95], a[208:211], a[176:179], v[188:191]
    v_mfma_f32_16x16x32_bf16 v[92:95], a[212:215], a[180:183], v[92:95]
    buffer_store_dwordx4 v[220:223], v2, s[36:39], s40 offen sc1
    s_add_u32 s40, s40, s100
    v_mfma_f32_16x16x32_bf16 v[92:95], a[216:219], a[184:187], v[92:95]
    v_mfma_f32_16x16x32_bf16 v[92:95], a[220:223], a[188:191], v[92:95]
    ds_read_b128 a[208:211], v6 offset:12288
    ds_read_b128 a[212:215], v6 offset:13312
    ds_read_b128 a[216:219], v6 offset:14336
    ds_read_b128 a[220:223], v6 offset:15360
    s_mov_b32 s60, 1
    s_nop 0
    s_nop 3
    v_max3_f32 v48, v64, v65, v66
    v_max3_f32 v49, v72, v73, v74
    v_max3_f32 v50, v80, v81, v82
    v_max3_f32 v51, v88, v89, v90
    v_max3_f32 v48, v48, v67, v68
    v_max3_f32 v49, v49, v75, v76
    v_max3_f32 v50, v50, v83, v84
    v_max3_f32 v51, v51, v91, v92
    v_max3_f32 v48, v48, v69, v70
    v_max3_f32 v49, v49, v77, v78
    v_max3_f32 v50, v50, v85, v86
    v_max3_f32 v51, v51, v93, v94
    v_max_f32 v48, v48, v71
    v_max_f32 v49, v49, v79
    v_max_f32 v50, v50, v87
    v_max_f32 v51, v51, v95
    v_mov_b32 v52, v48
    v_mov_b32 v53, v49
    v_mov_b32 v54, v50
    v_mov_b32 v55, v51
    s_nop 1
    v_permlane32_swap_b32 v48, v52
    v_permlane32_swap_b32 v49, v53
    v_permlane32_swap_b32 v50, v54
    v_permlane32_swap_b32 v51, v55
    s_nop 1
    v_max_f32 v48, v48, v52
    v_max_f32 v49, v49, v53
    v_max_f32 v50, v50, v54
    v_max_f32 v51, v51, v55
    v_mov_b32 v52, v48
    v_mov_b32 v53, v49
    v_mov_b32 v54, v50
    v_mov_b32 v55, v51
    s_nop 1
    v_permlane16_swap_b32 v48, v52
    v_permlane16_swap_b32 v49, v53
    v_permlane16_swap_b32 v50, v54
    v_permlane16_swap_b32 v51, v55
    s_nop 1
    v_max_f32 v48, v48, v52
    v_max_f32 v49, v49, v53
    v_max_f32 v50, v50, v54
    v_max_f32 v51, v51, v55
    v_sub_f32 v160, v160, v48
    v_sub_f32 v161, v161, v48
    v_sub_f32 v162, v162, v48
    v_sub_f32 v163, v163, v48
    v_sub_f32 v164, v164, v48
    v_sub_f32 v165, v165, v48
    v_sub_f32 v166, v166, v48
    v_sub_f32 v167, v167, v48
    v_sub_f32 v168, v168, v49
    v_sub_f32 v169, v169, v49
    v_sub_f32 v170, v170, v49
    v_sub_f32 v171, v171, v49
    v_sub_f32 v172, v172, v49
    v_sub_f32 v173, v173, v49
    v_sub_f32 v174, v174, v49
    v_sub_f32 v175, v175, v49
    v_sub_f32 v176, v176, v50
    v_sub_f32 v177, v177, v50
    v_sub_f32 v178, v178, v50
    v_sub_f32 v179, v179, v50
    v_sub_f32 v180, v180, v50
    v_sub_f32 v181, v181, v50
    v_sub_f32 v182, v182, v50
    v_sub_f32 v183, v183, v50
    v_sub_f32 v184, v184, v51
    v_sub_f32 v185, v185, v51
    v_sub_f32 v186, v186, v51
    v_sub_f32 v187, v187, v51
    v_sub_f32 v188, v188, v51
    v_sub_f32 v189, v189, v51
    v_sub_f32 v190, v190, v51
    v_sub_f32 v191, v191, v51
    v_sub_f32 v64, v64, v48
    v_sub_f32 v65, v65, v48
    v_sub_f32 v66, v66, v48
    v_sub_f32 v67, v67, v48
    v_sub_f32 v68, v68, v48
    v_sub_f32 v69, v69, v48
    v_sub_f32 v70, v70, v48
    v_sub_f32 v71, v71, v48
    v_sub_f32 v72, v72, v49
    v_sub_f32 v73, v73, v49
    v_sub_f32 v74, v74, v49
    v_sub_f32 v75, v75, v49
    v_sub_f32 v76, v76, v49
    v_sub_f32 v77, v77, v49
    v_sub_f32 v78, v78, v49
    v_sub_f32 v79, v79, v49
    v_sub_f32 v80, v80, v50
    v_sub_f32 v81, v81, v50
    v_sub_f32 v82, v82, v50
    v_sub_f32 v83, v83, v50
    v_sub_f32 v84, v84, v50
    v_sub_f32 v85, v85, v50
    v_sub_f32 v86, v86, v50
    v_sub_f32 v87, v87, v50
    v_sub_f32 v88, v88, v51
    v_sub_f32 v89, v89, v51
    v_sub_f32 v90, v90, v51
    v_sub_f32 v91, v91, v51
    v_sub_f32 v92, v92, v51
    v_sub_f32 v93, v93, v51
    v_sub_f32 v94, v94, v51
    v_sub_f32 v95, v95, v51
    s_cmp_lg_u32 s60, s63
    s_cbranch_scc1 mega_kernel_e70
    v_add_f32 v176, v176, v16
    v_mov_b32 v180, v9
    v_add_f32 v188, v188, v16
    v_add_f32 v177, v177, v17
    v_mov_b32 v181, v9
    v_add_f32 v189, v189, v17
    v_add_f32 v178, v178, v18
    v_mov_b32 v182, v9
    v_add_f32 v190, v190, v18
    v_add_f32 v179, v179, v19
    v_mov_b32 v183, v9
    v_add_f32 v191, v191, v19
    s_nop 0
mega_kernel_e70:
    s_cmp_lg_u32 s60, s64
    s_cbranch_scc1 mega_kernel_e71
    v_mov_b32 v176, v9
    v_mov_b32 v184, v9
    v_mov_b32 v188, v9
    v_mov_b32 v177, v9
    v_mov_b32 v185, v9
    v_mov_b32 v189, v9
    v_mov_b32 v178, v9
    v_mov_b32 v186, v9
    v_mov_b32 v190, v9
    v_mov_b32 v179, v9
    v_mov_b32 v187, v9
    v_mov_b32 v191, v9
    s_nop 0
mega_kernel_e71:
    s_waitcnt lgkmcnt(0)
    v_mfma_f32_16x16x32_bf16 v[96:99], a[192:195], a[128:131], v[160:163]
    s_bitcmp1_b64 s[58:59], s60
    s_cselect_b32 s62, -1.0, s61
    v_exp_f32 v20, v64
    v_mfma_f32_16x16x32_bf16 v[96:99], a[196:199], a[132:135], v[96:99]
    s_add_u32 s60, s60, 1
    v_exp_f32 v21, v65
    v_exp_f32 v22, v66
    v_mfma_f32_16x16x32_bf16 v[96:99], a[200:203], a[136:139], v[96:99]
    buffer_store_dwordx4 v[224:227], v2, s[36:39], s40 offen sc1
    v_cvt_pk_bf16_f32 v128, v20, v21
    v_mfma_f32_16x16x32_bf16 v[96:99], a[204:207], a[140:143], v[96:99]
    s_add_u32 s40, s40, s100
    v_add_f32 v12, v12, v28
    v_exp_f32 v23, v67
    v_mfma_f32_16x16x32_bf16 v[104:107], a[192:195], a[144:147], v[168:171]
    v_exp_f32 v24, v68
    v_cvt_pk_bf16_f32 v129, v22, v23
    v_mfma_f32_16x16x32_bf16 v[104:107], a[196:199], a[148:151], v[104:107]
    buffer_store_dwordx4 v[228:231], v2, s[36:39], s40 offen sc1
    v_exp_f32 v25, v69
    v_mfma_f32_16x16x32_bf16 v[104:107], a[200:203], a[152:155], v[104:107]
    s_add_u32 s40, s40, s100
    v_exp_f32 v26, v70
    v_cvt_pk_bf16_f32 v130, v24, v25
    v_mfma_f32_16x16x32_bf16 v[104:107], a[204:207], a[156:159], v[104:107]
    v_exp_f32 v27, v71
    v_add_f32 v13, v13, v32
    v_mfma_f32_16x16x32_bf16 v[112:115], a[192:195], a[160:163], v[176:179]
    v_exp_f32 v20, v72
    v_cvt_pk_bf16_f32 v131, v26, v27
    v_mfma_f32_16x16x32_bf16 v[112:115], a[196:199], a[164:167], v[112:115]
    buffer_store_dwordx4 v[232:235], v2, s[36:39], s40 offen sc1
    v_exp_f32 v21, v73
    v_mfma_f32_16x16x32_bf16 v[28:31], v[44:47], v[128:131], 0
    v_exp_f32 v22, v74
    v_cvt_pk_bf16_f32 v132, v20, v21
    v_mfma_f32_16x16x32_bf16 v[112:115], a[200:203], a[168:171], v[112:115]
    s_add_u32 s40, s40, s100
    v_exp_f32 v23, v75
    v_add_f32 v14, v14, v36
    v_mfma_f32_16x16x32_bf16 v[112:115], a[204:207], a[172:175], v[112:115]
    v_exp_f32 v24, v76
    v_cvt_pk_bf16_f32 v133, v22, v23
    v_mfma_f32_16x16x32_bf16 v[120:123], a[192:195], a[176:179], v[184:187]
    buffer_store_dwordx4 v[236:239], v2, s[36:39], s40 offen sc1
    v_exp_f32 v25, v77
    v_mfma_f32_16x16x32_bf16 v[120:123], a[196:199], a[180:183], v[120:123]
    s_mov_b32 s40, s98
    v_exp_f32 v26, v78
    v_cvt_pk_bf16_f32 v134, v24, v25
    v_mfma_f32_16x16x32_bf16 v[120:123], a[200:203], a[184:187], v[120:123]
    v_exp_f32 v27, v79
    v_add_f32 v15, v15, v40
    v_mfma_f32_16x16x32_bf16 v[120:123], a[204:207], a[188:191], v[120:123]
    s_waitcnt lgkmcnt(0)
    v_exp_f32 v20, v80
    v_cvt_pk_bf16_f32 v135, v26, v27
    v_mfma_f32_16x16x32_bf16 v[100:103], a[208:211], a[128:131], v[164:167]
    v_exp_f32 v21, v81
    v_exp_f32 v22, v82
    v_mfma_f32_16x16x32_bf16 v[32:35], v[44:47], v[132:135], 0
    v_cvt_pk_bf16_f32 v136, v20, v21
    v_exp_f32 v23, v83
    v_mfma_f32_16x16x32_bf16 v[100:103], a[212:215], a[132:135], v[100:103]
    buffer_store_dwordx4 v[240:243], v2, s[36:39], s40 offen sc1
    v_cvt_pk_bf16_f32 v137, v22, v23
    v_mfma_f32_16x16x32_bf16 v[100:103], a[216:219], a[136:139], v[100:103]
    s_add_u32 s40, s40, s100
    v_exp_f32 v24, v84
    v_mfma_f32_16x16x32_bf16 v[100:103], a[220:223], a[140:143], v[100:103]
    v_exp_f32 v25, v85
    v_exp_f32 v26, v86
    v_cvt_pk_bf16_f32 v138, v24, v25
    v_mfma_f32_16x16x32_bf16 v[108:111], a[208:211], a[144:147], v[172:175]
    buffer_store_dwordx4 v[244:247], v2, s[36:39], s40 offen sc1
    v_mfma_f32_16x16x32_bf16 v[108:111], a[212:215], a[148:151], v[108:111]
    s_add_u32 s40, s40, s100
    v_exp_f32 v27, v87
    v_exp_f32 v20, v88
    v_mfma_f32_16x16x32_bf16 v[108:111], a[216:219], a[152:155], v[108:111]
    v_cvt_pk_bf16_f32 v139, v26, v27
    v_exp_f32 v21, v89
    v_mfma_f32_16x16x32_bf16 v[108:111], a[220:223], a[156:159], v[108:111]
    buffer_store_dwordx4 v[248:251], v2, s[36:39], s40 offen sc1
    v_exp_f32 v22, v90
    v_mfma_f32_16x16x32_bf16 v[36:39], v[44:47], v[136:139], 0
    v_cvt_pk_bf16_f32 v140, v20, v21
    v_exp_f32 v23, v91
    v_mfma_f32_16x16x32_bf16 v[116:119], a[208:211], a[160:163], v[180:183]
    s_add_u32 s40, s40, s100
    v_exp_f32 v24, v92
    v_cvt_pk_bf16_f32 v141, v22, v23
    v_mfma_f32_16x16x32_bf16 v[116:119], a[212:215], a[164:167], v[116:119]
    v_exp_f32 v25, v93
    v_mfma_f32_16x16x32_bf16 v[116:119], a[216:219], a[168:171], v[116:119]
    buffer_store_dwordx4 v[252:255], v2, s[36:39], s40 offen sc1
    v_exp_f32 v26, v94
    v_cvt_pk_bf16_f32 v142, v24, v25
    v_mfma_f32_16x16x32_bf16 v[116:119], a[220:223], a[172:175], v[116:119]
    s_add_u32 s40, s40, s100
    v_exp_f32 v27, v95
    s_nop 0
    v_cvt_pk_bf16_f32 v143, v26, v27
    s_nop 1
    v_mfma_f32_16x16x32_bf16 v[40:43], v[44:47], v[140:143], 0
    s_nop 2
    v_mfma_f32_16x16x32_bf16 v[124:127], a[208:211], a[176:179], v[188:191]
    s_nop 2
    v_mfma_f32_16x16x32_bf16 v[124:127], a[212:215], a[180:183], v[124:127]
    v_max3_f32 v8, v28, v32, v36
    v_max_f32 v8, v8, v40
    v_mfma_f32_16x16x32_bf16 v[124:127], a[216:219], a[184:187], v[124:127]
    v_cmp_nge_f32 vcc, s62, v8
    v_mfma_f32_16x16x32_bf16 v[124:127], a[220:223], a[188:191], v[124:127]
    s_waitcnt vmcnt(40) lgkmcnt(0)
    s_barrier
    s_add_u32 s56, s55, s57
    s_add_u32 s55, s55, 32768
    s_and_b32 s55, s55, 0x1ffff
    v_add_u32 v6, s55, v2
    ds_read_b128 a[192:195], v6 offset:0
    ds_read_b128 a[196:199], v6 offset:1024
    ds_read_b128 a[200:203], v6 offset:2048
    ds_read_b128 a[204:207], v6 offset:3072
    ds_read_b128 a[208:211], v6 offset:4096
    ds_read_b128 a[212:215], v6 offset:5120
    ds_read_b128 a[216:219], v6 offset:6144
    ds_read_b128 a[220:223], v6 offset:7168
    s_waitcnt lgkmcnt(0)
    s_cbranch_vccnz mega_kernel_stub72
mega_kernel_ret73:
mega_kernel_dual74:
    v_mfma_f32_16x16x32_bf16 v[64:67], a[192:195], a[128:131], v[160:163]
    s_bitcmp1_b64 s[58:59], s60
    s_cselect_b32 s62, -1.0, s61
    v_add_f32 v12, v12, v28
    v_mfma_f32_16x16x32_bf16 v[64:67], a[196:199], a[132:135], v[64:67]
    s_add_u32 s60, s60, 1
    ds_read_b128 a[224:227], v6 offset:16384
    v_add_f32 v13, v13, v32
    v_mfma_f32_16x16x32_bf16 v[64:67], a[200:203], a[136:139], v[64:67]
    v_exp_f32 v20, v96
    v_mfma_f32_16x16x32_bf16 v[64:67], a[204:207], a[140:143], v[64:67]
    v_exp_f32 v21, v97
    v_mfma_f32_16x16x32_bf16 v[72:75], a[192:195], a[144:147], v[168:171]
    s_mov_b32 m0, s56
    ds_read_b128 a[228:231], v6 offset:17408
    v_cvt_pk_bf16_f32 v144, v20, v21
    v_mfma_f32_16x16x32_bf16 v[72:75], a[196:199], a[148:151], v[72:75]
    buffer_load_dwordx4 v7, s[24:27], s53 offen offset:0 sc1 lds
    v_mfma_f32_16x16x32_bf16 v[72:75], a[200:203], a[152:155], v[72:75]
    v_exp_f32 v22, v98
    v_mfma_f32_16x16x32_bf16 v[72:75], a[204:207], a[156:159], v[72:75]
    ds_read_b128 a[232:235], v6 offset:18432
    v_add_f32 v14, v14, v36
    v_mfma_f32_16x16x32_bf16 v[80:83], a[192:195], a[160:163], v[176:179]
    v_exp_f32 v23, v99
    v_mfma_f32_16x16x32_bf16 v[80:83], a[196:199], a[164:167], v[80:83]
    v_exp_f32 v24, v100
    v_mfma_f32_16x16x32_bf16 v[80:83], a[200:203], a[168:171], v[80:83]
    ds_read_b128 a[236:239], v6 offset:19456
    v_cvt_pk_bf16_f32 v145, v22, v23
    v_mfma_f32_16x16x32_bf16 v[80:83], a[204:207], a[172:175], v[80:83]
    v_exp_f32 v25, v101
    v_mfma_f32_16x16x32_bf16 v[88:91], a[192:195], a[176:179], v[184:187]
    v_exp_f32 v26, v102
    v_mfma_f32_16x16x32_bf16 v[88:91], a[196:199], a[180:183], v[88:91]
    ds_read_b128 a[240:243], v6 offset:20480
    v_cvt_pk_bf16_f32 v146, v24, v25
    v_mfma_f32_16x16x32_bf16 v[88:91], a[200:203], a[184:187], v[88:91]
    v_exp_f32 v27, v103
    v_mfma_f32_16x16x32_bf16 v[88:91], a[204:207], a[188:191], v[88:91]
    s_waitcnt lgkmcnt(5)
    v_exp_f32 v20, v104
    v_mfma_f32_16x16x32_bf16 v[68:71], a[208:211], a[128:131], v[164:167]
    ds_read_b128 a[244:247], v6 offset:21504
    v_cvt_pk_bf16_f32 v147, v26, v27
    v_mfma_f32_16x16x32_bf16 v[68:71], a[212:215], a[132:135], v[68:71]
    v_exp_f32 v21, v105
    v_mfma_f32_16x16x32_bf16 v[28:31], v[44:47], v[144:147], 0
    v_exp_f32 v22, v106
    v_mfma_f32_16x16x32_bf16 v[68:71], a[216:219], a[136:139], v[68:71]
    buffer_load_dwordx4 v7, s[24:27], s53 offen offset:1024 sc1 lds
    v_mfma_f32_16x16x32_bf16 v[68:71], a[220:223], a[140:143], v[68:71]
    ds_read_b128 a[248:251], v6 offset:22528
    v_cvt_pk_bf16_f32 v148, v20, v21
    v_mfma_f32_16x16x32_bf16 v[76:79], a[208:211], a[144:147], v[172:175]
    v_exp_f32 v23, v107
    v_mfma_f32_16x16x32_bf16 v[76:79], a[212:215], a[148:151], v[76:79]
    v_exp_f32 v24, v108
    v_mfma_f32_16x16x32_bf16 v[76:79], a[216:219], a[152:155], v[76:79]
    ds_read_b128 a[252:255], v6 offset:23552
    v_cvt_pk_bf16_f32 v149, v22, v23
    v_mfma_f32_16x16x32_bf16 v[76:79], a[220:223], a[156:159], v[76:79]
    v_exp_f32 v25, v109
    v_mfma_f32_16x16x32_bf16 v[84:87], a[208:211], a[160:163], v[180:183]
    v_exp_f32 v26, v110
    v_mfma_f32_16x16x32_bf16 v[84:87], a[212:215], a[164:167], v[84:87]
    v_cvt_pk_bf16_f32 v150, v24, v25
    v_add_f32 v15, v15, v40
    v_mfma_f32_16x16x32_bf16 v[84:87], a[216:219], a[168:171], v[84:87]
    v_exp_f32 v27, v111
    v_mfma_f32_16x16x32_bf16 v[84:87], a[220:223], a[172:175], v[84:87]
    buffer_load_dwordx4 v7, s[24:27], s53 offen offset:2048 sc1 lds
    v_mfma_f32_16x16x32_bf16 v[92:95], a[208:211], a[176:179], v[188:191]
    v_exp_f32 v20, v112
    v_mfma_f32_16x16x32_bf16 v[92:95], a[212:215], a[180:183], v[92:95]
    v_cvt_pk_bf16_f32 v151, v26, v27
    v_mfma_f32_16x16x32_bf16 v[92:95], a[216:219], a[184:187], v[92:95]
    v_exp_f32 v21, v113
    v_mfma_f32_16x16x32_bf16 v[32:35], v[44:47], v[148:151], 0
    v_exp_f32 v22, v114
    v_mfma_f32_16x16x32_bf16 v[92:95], a[220:223], a[188:191], v[92:95]
    s_waitcnt lgkmcnt(0)
    v_cvt_pk_bf16_f32 v152, v20, v21
    v_mfma_f32_16x16x32_bf16 a[0:3], a[224:227], v[128:131], a[0:3]
    ds_read_b128 a[192:195], v6 offset:8192
    v_mfma_f32_16x16x32_bf16 a[32:35], a[224:227], v[132:135], a[32:35]
    v_exp_f32 v23, v115
    v_mfma_f32_16x16x32_bf16 a[64:67], a[224:227], v[136:139], a[64:67]
    v_exp_f32 v24, v116
    v_mfma_f32_16x16x32_bf16 a[96:99], a[224:227], v[140:143], a[96:99]
    ds_read_b128 a[196:199], v6 offset:9216
    v_cvt_pk_bf16_f32 v153, v22, v23
    v_mfma_f32_16x16x32_bf16 a[4:7], a[228:231], v[128:131], a[4:7]
    v_exp_f32 v25, v117
    v_mfma_f32_16x16x32_bf16 a[36:39], a[228:231], v[132:135], a[36:39]
    v_exp_f32 v26, v118
    v_mfma_f32_16x16x32_bf16 a[68:71], a[228:231], v[136:139], a[68:71]
    ds_read_b128 a[200:203], v6 offset:10240
    v_cvt_pk_bf16_f32 v154, v24, v25
    v_mfma_f32_16x16x32_bf16 a[100:103], a[228:231], v[140:143], a[100:103]
    v_exp_f32 v27, v119
    v_mfma_f32_16x16x32_bf16 a[8:11], a[232:235], v[128:131], a[8:11]
    v_exp_f32 v20, v120
    v_mfma_f32_16x16x32_bf16 a[40:43], a[232:235], v[132:135], a[40:43]
    ds_read_b128 a[204:207], v6 offset:11264
    v_cvt_pk_bf16_f32 v155, v26, v27
    v_mfma_f32_16x16x32_bf16 a[72:75], a[232:235], v[136:139], a[72:75]
    v_exp_f32 v21, v121
    v_mfma_f32_16x16x32_bf16 v[36:39], v[44:47], v[152:155], 0
    v_exp_f32 v22, v122
    v_mfma_f32_16x16x32_bf16 a[104:107], a[232:235], v[140:143], a[104:107]
    buffer_load_dwordx4 v7, s[24:27], s53 offen offset:3072 sc1 lds
    v_mfma_f32_16x16x32_bf16 a[12:15], a[236:239], v[128:131], a[12:15]
    s_add_u32 s53, s53, 16384
    v_cvt_pk_bf16_f32 v156, v20, v21
    v_mfma_f32_16x16x32_bf16 a[44:47], a[236:239], v[132:135], a[44:47]
    v_exp_f32 v23, v123
    v_mfma_f32_16x16x32_bf16 a[76:79], a[236:239], v[136:139], a[76:79]
    v_exp_f32 v24, v124
    v_mfma_f32_16x16x32_bf16 a[108:111], a[236:239], v[140:143], a[108:111]
    v_cvt_pk_bf16_f32 v157, v22, v23
    v_mfma_f32_16x16x32_bf16 a[16:19], a[240:243], v[128:131], a[16:19]
    v_exp_f32 v25, v125
    v_mfma_f32_16x16x32_bf16 a[48:51], a[240:243], v[132:135], a[48:51]
    v_exp_f32 v26, v126
    v_mfma_f32_16x16x32_bf16 a[80:83], a[240:243], v[136:139], a[80:83]
    v_cvt_pk_bf16_f32 v158, v24, v25
    v_mfma_f32_16x16x32_bf16 a[112:115], a[240:243], v[140:143], a[112:115]
    s_add_u32 m0, s56, 16384
    v_exp_f32 v27, v127
    v_mfma_f32_16x16x32_bf16 a[20:23], a[244:247], v[128:131], a[20:23]
    buffer_load_dwordx4 v7, s[28:31], s54 offen offset:0 sc1 lds
    v_mfma_f32_16x16x32_bf16 a[52:55], a[244:247], v[132:135], a[52:55]
    v_cvt_pk_bf16_f32 v159, v26, v27
    v_mfma_f32_16x16x32_bf16 a[84:87], a[244:247], v[136:139], a[84:87]
    v_mfma_f32_16x16x32_bf16 a[116:119], a[244:247], v[140:143], a[116:119]
    v_mfma_f32_16x16x32_bf16 v[40:43], v[44:47], v[156:159], 0
    s_nop 2
    v_mfma_f32_16x16x32_bf16 a[24:27], a[248:251], v[128:131], a[24:27]
    s_nop 2
    v_mfma_f32_16x16x32_bf16 a[56:59], a[248:251], v[132:135], a[56:59]
    v_max3_f32 v8, v28, v32, v36
    v_max_f32 v8, v8, v40
    v_mfma_f32_16x16x32_bf16 a[88:91], a[248:251], v[136:139], a[88:91]
    v_cmp_nge_f32 vcc, s62, v8
    v_mfma_f32_16x16x32_bf16 a[120:123], a[248:251], v[140:143], a[120:123]
    ds_read_b128 a[208:211], v6 offset:12288
    v_mfma_f32_16x16x32_bf16 a[28:31], a[252:255], v[128:131], a[28:31]
    ds_read_b128 a[212:215], v6 offset:13312
    v_mfma_f32_16x16x32_bf16 a[60:63], a[252:255], v[132:135], a[60:63]
    ds_read_b128 a[216:219], v6 offset:14336
    v_mfma_f32_16x16x32_bf16 a[92:95], a[252:255], v[136:139], a[92:95]
    ds_read_b128 a[220:223], v6 offset:15360
    v_mfma_f32_16x16x32_bf16 a[124:127], a[252:255], v[140:143], a[124:127]
    s_waitcnt lgkmcnt(4)
    s_cbranch_vccnz mega_kernel_stub75
mega_kernel_ret76:
    v_mfma_f32_16x16x32_bf16 v[96:99], a[192:195], a[128:131], v[160:163]
    s_add_u32 s56, s55, s57
    v_exp_f32 v20, v64
    v_mfma_f32_16x16x32_bf16 v[96:99], a[196:199], a[132:135], v[96:99]
    s_add_u32 s55, s55, 32768
    ds_read_b128 a[224:227], v6 offset:24576
    v_add_f32 v12, v12, v28
    v_mfma_f32_16x16x32_bf16 v[96:99], a[200:203], a[136:139], v[96:99]
    s_and_b32 s55, s55, 0x1ffff
    v_exp_f32 v21, v65
    v_mfma_f32_16x16x32_bf16 v[96:99], a[204:207], a[140:143], v[96:99]
    s_bitcmp1_b64 s[58:59], s60
    s_cselect_b32 s62, -1.0, s61
    v_cvt_pk_bf16_f32 v128, v20, v21
    v_mfma_f32_16x16x32_bf16 v[104:107], a[192:195], a[144:147], v[168:171]
    s_add_u32 s60, s60, 1
    ds_read_b128 a[228:231], v6 offset:25600
    v_add_f32 v13, v13, v32
    v_mfma_f32_16x16x32_bf16 v[104:107], a[196:199], a[148:151], v[104:107]
    v_exp_f32 v22, v66
    v_mfma_f32_16x16x32_bf16 v[104:107], a[200:203], a[152:155], v[104:107]
    buffer_load_dwordx4 v7, s[28:31], s54 offen offset:1024 sc1 lds
    v_mfma_f32_16x16x32_bf16 v[104:107], a[204:207], a[156:159], v[104:107]
    ds_read_b128 a[232:235], v6 offset:26624
    v_add_f32 v14, v14, v36
    v_mfma_f32_16x16x32_bf16 v[112:115], a[192:195], a[160:163], v[176:179]
    v_exp_f32 v23, v67
    v_mfma_f32_16x16x32_bf16 v[112:115], a[196:199], a[164:167], v[112:115]
    v_exp_f32 v24, v68
    v_mfma_f32_16x16x32_bf16 v[112:115], a[200:203], a[168:171], v[112:115]
    ds_read_b128 a[236:239], v6 offset:27648
    v_cvt_pk_bf16_f32 v129, v22, v23
    v_mfma_f32_16x16x32_bf16 v[112:115], a[204:207], a[172:175], v[112:115]
    v_exp_f32 v25, v69
    v_mfma_f32_16x16x32_bf16 v[120:123], a[192:195], a[176:179], v[184:187]
    v_exp_f32 v26, v70
    v_mfma_f32_16x16x32_bf16 v[120:123], a[196:199], a[180:183], v[120:123]
    ds_read_b128 a[240:243], v6 offset:28672
    v_cvt_pk_bf16_f32 v130, v24, v25
    v_mfma_f32_16x16x32_bf16 v[120:123], a[200:203], a[184:187], v[120:123]
    v_exp_f32 v27, v71
    v_mfma_f32_16x16x32_bf16 v[120:123], a[204:207], a[188:191], v[120:123]
    s_waitcnt lgkmcnt(5)
    v_exp_f32 v20, v72
    v_mfma_f32_16x16x32_bf16 v[100:103], a[208:211], a[128:131], v[164:167]
    ds_read_b128 a[244:247], v6 offset:29696
    v_cvt_pk_bf16_f32 v131, v26, v27
    v_mfma_f32_16x16x32_bf16 v[100:103], a[212:215], a[132:135], v[100:103]
    v_exp_f32 v21, v73
    v_mfma_f32_16x16x32_bf16 v[28:31], v[44:47], v[128:131], 0
    v_exp_f32 v22, v74
    v_mfma_f32_16x16x32_bf16 v[100:103], a[216:219], a[136:139], v[100:103]
    buffer_load_dwordx4 v7, s[28:31], s54 offen offset:2048 sc1 lds
    v_mfma_f32_16x16x32_bf16 v[100:103], a[220:223], a[140:143], v[100:103]
    ds_read_b128 a[248:251], v6 offset:30720
    v_cvt_pk_bf16_f32 v132, v20, v21
    v_mfma_f32_16x16x32_bf16 v[108:111], a[208:211], a[144:147], v[172:175]
    v_exp_f32 v23, v75
    v_mfma_f32_16x16x32_bf16 v[108:111], a[212:215], a[148:151], v[108:111]
    v_exp_f32 v24, v76
    v_mfma_f32_16x16x32_bf16 v[108:111], a[216:219], a[152:155], v[108:111]
    ds_read_b128 a[252:255], v6 offset:31744
    v_cvt_pk_bf16_f32 v133, v22, v23
    v_mfma_f32_16x16x32_bf16 v[108:111], a[220:223], a[156:159], v[108:111]
    v_exp_f32 v25, v77
    v_mfma_f32_16x16x32_bf16 v[116:119], a[208:211], a[160:163], v[180:183]
    v_exp_f32 v26, v78
    v_mfma_f32_16x16x32_bf16 v[116:119], a[212:215], a[164:167], v[116:119]
    v_cvt_pk_bf16_f32 v134, v24, v25
    v_add_f32 v15, v15, v40
    v_mfma_f32_16x16x32_bf16 v[116:119], a[216:219], a[168:171], v[116:119]
    v_exp_f32 v27, v79
    v_mfma_f32_16x16x32_bf16 v[116:119], a[220:223], a[172:175], v[116:119]
    buffer_load_dwordx4 v7, s[28:31], s54 offen offset:3072 sc1 lds
    v_mfma_f32_16x16x32_bf16 v[124:127], a[208:211], a[176:179], v[188:191]
    s_add_u32 s54, s54, 16384
    v_exp_f32 v20, v80
    v_mfma_f32_16x16x32_bf16 v[124:127], a[212:215], a[180:183], v[124:127]
    v_cvt_pk_bf16_f32 v135, v26, v27
    v_mfma_f32_16x16x32_bf16 v[124:127], a[216:219], a[184:187], v[124:127]
    v_exp_f32 v21, v81
    v_mfma_f32_16x16x32_bf16 v[32:35], v[44:47], v[132:135], 0
    v_exp_f32 v22, v82
    v_mfma_f32_16x16x32_bf16 v[124:127], a[220:223], a[188:191], v[124:127]
    s_waitcnt vmcnt(16) lgkmcnt(0)
    v_add_u32 v6, s55, v2
    v_cvt_pk_bf16_f32 v136, v20, v21
    v_mfma_f32_16x16x32_bf16 a[0:3], a[224:227], v[144:147], a[0:3]
    s_barrier
    v_mfma_f32_16x16x32_bf16 a[32:35], a[224:227], v[148:151], a[32:35]
    ds_read_b128 a[192:195], v6 offset:0
    v_mfma_f32_16x16x32_bf16 a[64:67], a[224:227], v[152:155], a[64:67]
    v_exp_f32 v23, v83
    v_mfma_f32_16x16x32_bf16 a[96:99], a[224:227], v[156:159], a[96:99]
    v_exp_f32 v24, v84
    v_mfma_f32_16x16x32_bf16 a[4:7], a[228:231], v[144:147], a[4:7]
    ds_read_b128 a[196:199], v6 offset:1024
    v_cvt_pk_bf16_f32 v137, v22, v23
    v_mfma_f32_16x16x32_bf16 a[36:39], a[228:231], v[148:151], a[36:39]
    v_exp_f32 v25, v85
    v_mfma_f32_16x16x32_bf16 a[68:71], a[228:231], v[152:155], a[68:71]
    v_exp_f32 v26, v86
    v_mfma_f32_16x16x32_bf16 a[100:103], a[228:231], v[156:159], a[100:103]
    ds_read_b128 a[200:203], v6 offset:2048
    v_cvt_pk_bf16_f32 v138, v24, v25
    v_mfma_f32_16x16x32_bf16 a[8:11], a[232:235], v[144:147], a[8:11]
    v_exp_f32 v27, v87
    v_mfma_f32_16x16x32_bf16 a[40:43], a[232:235], v[148:151], a[40:43]
    v_exp_f32 v20, v88
    v_mfma_f32_16x16x32_bf16 a[72:75], a[232:235], v[152:155], a[72:75]
    ds_read_b128 a[204:207], v6 offset:3072
    v_cvt_pk_bf16_f32 v139, v26, v27
    v_mfma_f32_16x16x32_bf16 a[104:107], a[232:235], v[156:159], a[104:107]
    v_exp_f32 v21, v89
    v_mfma_f32_16x16x32_bf16 v[36:39], v[44:47], v[136:139], 0
    v_exp_f32 v22, v90
    v_mfma_f32_16x16x32_bf16 a[12:15], a[236:239], v[144:147], a[12:15]
    v_cvt_pk_bf16_f32 v140, v20, v21
    v_mfma_f32_16x16x32_bf16 a[44:47], a[236:239], v[148:151], a[44:47]
    v_exp_f32 v23, v91
    v_mfma_f32_16x16x32_bf16 a[76:79], a[236:239], v[152:155], a[76:79]
    v_exp_f32 v24, v92
    v_mfma_f32_16x16x32_bf16 a[108:111], a[236:239], v[156:159], a[108:111]
    v_cvt_pk_bf16_f32 v141, v22, v23
    v_mfma_f32_16x16x32_bf16 a[16:19], a[240:243], v[144:147], a[16:19]
    v_exp_f32 v25, v93
    v_mfma_f32_16x16x32_bf16 a[48:51], a[240:243], v[148:151], a[48:51]
    v_exp_f32 v26, v94
    v_mfma_f32_16x16x32_bf16 a[80:83], a[240:243], v[152:155], a[80:83]
    v_cvt_pk_bf16_f32 v142, v24, v25
    v_mfma_f32_16x16x32_bf16 a[112:115], a[240:243], v[156:159], a[112:115]
    v_exp_f32 v27, v95
    v_mfma_f32_16x16x32_bf16 a[20:23], a[244:247], v[144:147], a[20:23]
    v_cvt_pk_bf16_f32 v143, v26, v27
    v_mfma_f32_16x16x32_bf16 a[52:55], a[244:247], v[148:151], a[52:55]
    v_mfma_f32_16x16x32_bf16 a[84:87], a[244:247], v[152:155], a[84:87]
    v_mfma_f32_16x16x32_bf16 v[40:43], v[44:47], v[140:143], 0
    s_nop 2
    v_mfma_f32_16x16x32_bf16 a[116:119], a[244:247], v[156:159], a[116:119]
    s_nop 2
    v_mfma_f32_16x16x32_bf16 a[24:27], a[248:251], v[144:147], a[24:27]
    v_max3_f32 v8, v28, v32, v36
    v_max_f32 v8, v8, v40
    v_mfma_f32_16x16x32_bf16 a[56:59], a[248:251], v[148:151], a[56:59]
    v_cmp_nge_f32 vcc, s62, v8
    v_mfma_f32_16x16x32_bf16 a[88:91], a[248:251], v[152:155], a[88:91]
    v_mfma_f32_16x16x32_bf16 a[120:123], a[248:251], v[156:159], a[120:123]
    ds_read_b128 a[208:211], v6 offset:4096
    v_mfma_f32_16x16x32_bf16 a[28:31], a[252:255], v[144:147], a[28:31]
    ds_read_b128 a[212:215], v6 offset:5120
    v_mfma_f32_16x16x32_bf16 a[60:63], a[252:255], v[148:151], a[60:63]
    ds_read_b128 a[216:219], v6 offset:6144
    v_mfma_f32_16x16x32_bf16 a[92:95], a[252:255], v[152:155], a[92:95]
    ds_read_b128 a[220:223], v6 offset:7168
    v_mfma_f32_16x16x32_bf16 a[124:127], a[252:255], v[156:159], a[124:127]
    s_waitcnt lgkmcnt(4)
    s_cbranch_vccz mega_kernel_dual74
    v_cmp_lt_f32 vcc, s61, v8
    s_cmp_lg_u32 s60, s63
    s_cbranch_scc1 mega_kernel_e78
    v_add_f32 v176, v176, v16
    v_mov_b32 v180, v9
    v_add_f32 v188, v188, v16
    v_add_f32 v177, v177, v17
    v_mov_b32 v181, v9
    v_add_f32 v189, v189, v17
    v_add_f32 v178, v178, v18
    v_mov_b32 v182, v9
    v_add_f32 v190, v190, v18
    v_add_f32 v179, v179, v19
    v_mov_b32 v183, v9
    v_add_f32 v191, v191, v19
    s_nop 0
mega_kernel_e78:
    s_cmp_lg_u32 s60, s64
    s_cbranch_scc1 mega_kernel_e79
    v_mov_b32 v176, v9
    v_mov_b32 v184, v9
    v_mov_b32 v188, v9
    v_mov_b32 v177, v9
    v_mov_b32 v185, v9
    v_mov_b32 v189, v9
    v_mov_b32 v178, v9
    v_mov_b32 v186, v9
    v_mov_b32 v190, v9
    v_mov_b32 v179, v9
    v_mov_b32 v187, v9
    v_mov_b32 v191, v9
    s_nop 0
mega_kernel_e79:
    s_cmp_lg_u32 s60, s66
    s_cbranch_scc1 mega_kernel_e80
    v_add_f32 v160, v160, v16
    v_mov_b32 v164, v9
    v_add_f32 v172, v172, v16
    v_add_f32 v161, v161, v17
    v_mov_b32 v165, v9
    v_add_f32 v173, v173, v17
    v_add_f32 v162, v162, v18
    v_mov_b32 v166, v9
    v_add_f32 v174, v174, v18
    v_add_f32 v163, v163, v19
    v_mov_b32 v167, v9
    v_add_f32 v175, v175, v19
    s_nop 0
mega_kernel_e80:
    s_cmp_lg_u32 s60, s52
    s_cbranch_scc1 mega_kernel_e82
    v_lshrrev_b32 v62, 3, v1
    v_lshlrev_b32 v62, 11, v62
    v_and_b32 v61, 7, v1
    v_lshl_add_u32 v62, v61, 7, v62
    s_lshr_b32 s90, s2, 3
    s_lshl_b32 s90, s90, 2
    s_add_u32 s90, s90, s16
    s_lshl_b32 s90, s90, 14
    s_and_b32 s91, s2, 1
    s_lshl_b32 s91, s91, 10
    s_add_u32 s90, s90, s91
    s_bitcmp1_b32 s2, 2
    s_cselect_b32 s91, 0, 5373952
    s_mov_b32 s92, 8388608
    s_cselect_b32 s46, 5373952, s92
    s_cselect_b32 s93, 0, 2097152
    s_add_u32 s91, s91, s90
    s_mov_b32 s44, s48
    s_mov_b32 s45, s49
    s_add_u32 s92, s91, 0
    buffer_load_dword v255, v62, s[44:47], s92 offen
    s_add_u32 s92, s91, 2097152
    buffer_load_dword v255, v62, s[44:47], s92 offen
    s_add_u32 s92, s91, 4194304
    buffer_load_dword v255, v62, s[44:47], s92 offen
    s_mov_b32 s44, s50
    s_mov_b32 s45, s51
    s_mov_b32 s46, s93
    buffer_load_dword v255, v62, s[44:47], s90 offen
mega_kernel_e82:
    s_cmp_gt_u32 s60, 26
    s_cbranch_scc1 mega_kernel_e81
    s_cmp_lg_u32 s60, 6
    s_cbranch_scc1 mega_kernel_e83
    s_cmp_eq_u32 s17, -1
    s_cbranch_scc1 mega_kernel_e81
    s_cmp_lg_u32 s16, 0
    s_cbranch_scc1 mega_kernel_np84
    v_mov_b32 v4, s4
    v_mov_b32 v5, s5
    s_add_u32 s90, s17, 117440512
    s_mov_b64 exec, 1
    buffer_store_dwordx2 v[4:5], off, s[8:11], s90 sc1
    s_mov_b64 exec, -1
mega_kernel_np84:
    s_branch mega_kernel_e81
mega_kernel_e83:
    s_cmp_lg_u32 s60, 22
    s_cbranch_scc1 mega_kernel_e85
    buffer_load_dwordx2 v[4:5], v10, s[8:11], 0 offen sc1
    s_mov_b32 s44, s48
    s_mov_b32 s45, s49
    s_mov_b32 s46, 8388608
    s_lshl_b32 s90, s2, 2
    s_add_u32 s90, s90, s16
    s_lshl_b32 s90, s90, 13
    v_lshlrev_b32 v62, 7, v1
    buffer_load_dword v255, v62, s[44:47], s90 offen
    s_branch mega_kernel_e81
mega_kernel_e85:
    s_cmp_lg_u32 s60, 26
    s_cbranch_scc1 mega_kernel_e86
    s_mov_b32 s44, s50
    s_mov_b32 s45, s51
    s_mov_b32 s46, 2097152
    s_lshl_b32 s90, s2, 2
    s_add_u32 s90, s90, s16
    s_lshl_b32 s90, s90, 13
    v_lshlrev_b32 v62, 7, v1
    buffer_load_dword v255, v62, s[44:47], s90 offen
    s_waitcnt vmcnt(18)
    s_mov_b32 s3, 1048576
mega_kernel_spin87:
    v_cmp_ne_u64 s[72:73], s[4:5], v[4:5]
    s_nop 3
    s_cmp_eq_u64 s[72:73], 0
    s_cbranch_scc1 mega_kernel_e81
    s_sub_u32 s3, s3, 1
    s_cbranch_scc1 mega_kernel_e81
    s_sleep 32
    buffer_load_dwordx2 v[4:5], v10, s[8:11], 0 offen sc1
    s_waitcnt vmcnt(0)
    s_branch mega_kernel_spin87
    s_branch mega_kernel_e81
mega_kernel_e86:
mega_kernel_e81:
    s_cbranch_vccnz mega_kernel_rc88
mega_kernel_sp77:
    s_cmp_lg_u32 s60, s65
    s_cbranch_scc1 mega_kernel_dual74
    v_mfma_f32_16x16x32_bf16 v[64:67], a[192:195], a[128:131], v[160:163]
    s_bitcmp1_b64 s[58:59], s60
    s_cselect_b32 s62, -1.0, s61
    v_add_f32 v12, v12, v28
    v_mfma_f32_16x16x32_bf16 v[64:67], a[196:199], a[132:135], v[64:67]
    s_add_u32 s60, s60, 1
    ds_read_b128 a[224:227], v6 offset:16384
    v_exp_f32 v20, v96
    v_mfma_f32_16x16x32_bf16 v[64:67], a[200:203], a[136:139], v[64:67]
    s_mov_b32 m0, s56
    ds_read_b128 a[228:231], v6 offset:17408
    v_add_f32 v13, v13, v32
    v_mfma_f32_16x16x32_bf16 v[64:67], a[204:207], a[140:143], v[64:67]
    buffer_load_dwordx4 v7, s[24:27], s53 offen offset:0 sc1 lds
    v_mfma_f32_16x16x32_bf16 v[72:75], a[192:195], a[144:147], v[168:171]
    ds_read_b128 a[232:235], v6 offset:18432
    v_add_f32 v14, v14, v36
    v_mfma_f32_16x16x32_bf16 v[72:75], a[196:199], a[148:151], v[72:75]
    ds_read_b128 a[236:239], v6 offset:19456
    v_exp_f32 v21, v97
    v_mfma_f32_16x16x32_bf16 v[72:75], a[200:203], a[152:155], v[72:75]
    ds_read_b128 a[240:243], v6 offset:20480
    v_cvt_pk_bf16_f32 v144, v20, v21
    v_mfma_f32_16x16x32_bf16 v[72:75], a[204:207], a[156:159], v[72:75]
    s_waitcnt lgkmcnt(5)
    ds_read_b128 a[244:247], v6 offset:21504
    v_add_f32 v15, v15, v40
    v_mfma_f32_16x16x32_bf16 v[68:71], a[208:211], a[128:131], v[164:167]
    ds_read_b128 a[248:251], v6 offset:22528
    v_exp_f32 v22, v98
    v_mfma_f32_16x16x32_bf16 v[68:71], a[212:215], a[132:135], v[68:71]
    ds_read_b128 a[252:255], v6 offset:23552
    v_exp_f32 v23, v99
    v_mfma_f32_16x16x32_bf16 v[68:71], a[216:219], a[136:139], v[68:71]
    v_exp_f32 v24, v100
    v_mfma_f32_16x16x32_bf16 v[68:71], a[220:223], a[140:143], v[68:71]
    buffer_load_dwordx4 v7, s[24:27], s53 offen offset:1024 sc1 lds
    v_mfma_f32_16x16x32_bf16 v[76:79], a[208:211], a[144:147], v[172:175]
    v_cvt_pk_bf16_f32 v145, v22, v23
    v_exp_f32 v25, v101
    v_mfma_f32_16x16x32_bf16 v[76:79], a[212:215], a[148:151], v[76:79]
    v_exp_f32 v26, v102
    v_mfma_f32_16x16x32_bf16 v[76:79], a[216:219], a[152:155], v[76:79]
    v_cvt_pk_bf16_f32 v146, v24, v25
    v_exp_f32 v27, v103
    v_mfma_f32_16x16x32_bf16 v[76:79], a[220:223], a[156:159], v[76:79]
    s_waitcnt lgkmcnt(0)
    v_exp_f32 v20, v104
    v_mfma_f32_16x16x32_bf16 a[0:3], a[224:227], v[128:131], a[0:3]
    ds_read_b128 a[192:195], v6 offset:8192
    v_cvt_pk_bf16_f32 v147, v26, v27
    v_mfma_f32_16x16x32_bf16 a[32:35], a[224:227], v[132:135], a[32:35]
    v_exp_f32 v21, v105
    v_mfma_f32_16x16x32_bf16 v[28:31], v[44:47], v[144:147], 0
    v_exp_f32 v22, v106
    v_mfma_f32_16x16x32_bf16 a[64:67], a[224:227], v[136:139], a[64:67]
    v_cvt_pk_bf16_f32 v148, v20, v21
    v_exp_f32 v23, v107
    v_mfma_f32_16x16x32_bf16 a[96:99], a[224:227], v[140:143], a[96:99]
    ds_read_b128 a[196:199], v6 offset:9216
    v_cvt_pk_bf16_f32 v149, v22, v23
    v_mfma_f32_16x16x32_bf16 a[4:7], a[228:231], v[128:131], a[4:7]
    v_exp_f32 v24, v108
    v_mfma_f32_16x16x32_bf16 a[36:39], a[228:231], v[132:135], a[36:39]
    buffer_load_dwordx4 v7, s[24:27], s53 offen offset:2048 sc1 lds
    v_mfma_f32_16x16x32_bf16 a[68:71], a[228:231], v[136:139], a[68:71]
    ds_read_b128 a[200:203], v6 offset:10240
    v_exp_f32 v25, v109
    v_mfma_f32_16x16x32_bf16 a[100:103], a[228:231], v[140:143], a[100:103]
    v_exp_f32 v26, v110
    v_mfma_f32_16x16x32_bf16 a[8:11], a[232:235], v[128:131], a[8:11]
    v_cvt_pk_bf16_f32 v150, v24, v25
    v_exp_f32 v27, v111
    v_mfma_f32_16x16x32_bf16 a[40:43], a[232:235], v[132:135], a[40:43]
    ds_read_b128 a[204:207], v6 offset:11264
    v_cvt_pk_bf16_f32 v151, v26, v27
    v_mfma_f32_16x16x32_bf16 a[72:75], a[232:235], v[136:139], a[72:75]
    v_exp_f32 v20, v112
    v_mfma_f32_16x16x32_bf16 v[32:35], v[44:47], v[148:151], 0
    v_exp_f32 v21, v113
    v_mfma_f32_16x16x32_bf16 a[104:107], a[232:235], v[140:143], a[104:107]
    v_exp_f32 v22, v114
    v_mfma_f32_16x16x32_bf16 a[12:15], a[236:239], v[128:131], a[12:15]
    v_cvt_pk_bf16_f32 v152, v20, v21
    v_exp_f32 v23, v115
    v_mfma_f32_16x16x32_bf16 a[44:47], a[236:239], v[132:135], a[44:47]
    v_exp_f32 v24, v116
    v_mfma_f32_16x16x32_bf16 a[76:79], a[236:239], v[136:139], a[76:79]
    v_cvt_pk_bf16_f32 v153, v22, v23
    v_exp_f32 v25, v117
    v_mfma_f32_16x16x32_bf16 a[108:111], a[236:239], v[140:143], a[108:111]
    buffer_load_dwordx4 v7, s[24:27], s53 offen offset:3072 sc1 lds
    v_mfma_f32_16x16x32_bf16 a[16:19], a[240:243], v[128:131], a[16:19]
    s_add_u32 s53, s53, 16384
    v_exp_f32 v26, v118
    v_mfma_f32_16x16x32_bf16 a[48:51], a[240:243], v[132:135], a[48:51]
    v_cvt_pk_bf16_f32 v154, v24, v25
    v_exp_f32 v27, v119
    v_mfma_f32_16x16x32_bf16 a[80:83], a[240:243], v[136:139], a[80:83]
    v_exp_f32 v20, v120
    v_mfma_f32_16x16x32_bf16 a[112:115], a[240:243], v[140:143], a[112:115]
    v_cvt_pk_bf16_f32 v155, v26, v27
    v_exp_f32 v21, v121
    v_mfma_f32_16x16x32_bf16 a[20:23], a[244:247], v[128:131], a[20:23]
    v_exp_f32 v22, v122
    v_mfma_f32_16x16x32_bf16 v[36:39], v[44:47], v[152:155], 0
    v_cvt_pk_bf16_f32 v156, v20, v21
    v_mfma_f32_16x16x32_bf16 a[52:55], a[244:247], v[132:135], a[52:55]
    v_exp_f32 v23, v123
    v_mfma_f32_16x16x32_bf16 a[84:87], a[244:247], v[136:139], a[84:87]
    v_exp_f32 v24, v124
    v_cvt_pk_bf16_f32 v157, v22, v23
    v_mfma_f32_16x16x32_bf16 a[116:119], a[244:247], v[140:143], a[116:119]
    v_exp_f32 v25, v125
    v_mfma_f32_16x16x32_bf16 a[24:27], a[248:251], v[128:131], a[24:27]
    s_add_u32 m0, s56, 16384
    v_exp_f32 v26, v126
    v_mfma_f32_16x16x32_bf16 a[56:59], a[248:251], v[132:135], a[56:59]
    buffer_load_dwordx4 v7, s[28:31], s54 offen offset:0 sc1 lds
    v_mfma_f32_16x16x32_bf16 a[88:91], a[248:251], v[136:139], a[88:91]
    v_cvt_pk_bf16_f32 v158, v24, v25
    v_exp_f32 v27, v127
    v_mfma_f32_16x16x32_bf16 a[120:123], a[248:251], v[140:143], a[120:123]
    ds_read_b128 a[208:211], v6 offset:12288
    v_cvt_pk_bf16_f32 v159, v26, v27
    s_nop 1
    v_mfma_f32_16x16x32_bf16 v[40:43], v[44:47], v[156:159], 0
    s_nop 2
    v_mfma_f32_16x16x32_bf16 a[28:31], a[252:255], v[128:131], a[28:31]
    ds_read_b128 a[212:215], v6 offset:13312
    s_nop 0
    v_mfma_f32_16x16x32_bf16 a[60:63], a[252:255], v[132:135], a[60:63]
    ds_read_b128 a[216:219], v6 offset:14336
    v_max3_f32 v8, v28, v32, v36
    v_mfma_f32_16x16x32_bf16 a[92:95], a[252:255], v[136:139], a[92:95]
    ds_read_b128 a[220:223], v6 offset:15360
    v_max_f32 v8, v8, v40
    v_cmp_nge_f32 vcc, s62, v8
    v_mfma_f32_16x16x32_bf16 a[124:127], a[252:255], v[140:143], a[124:127]
    s_waitcnt lgkmcnt(4)
    s_cbranch_vccnz mega_kernel_stub89
mega_kernel_ret90:
    v_mfma_f32_16x16x32_bf16 v[96:99], a[192:195], a[128:131], v[160:163]
    s_add_u32 s56, s55, s57
    v_exp_f32 v20, v64
    v_mfma_f32_16x16x32_bf16 v[96:99], a[196:199], a[132:135], v[96:99]
    s_add_u32 s55, s55, 32768
    ds_read_b128 a[224:227], v6 offset:24576
    v_add_f32 v12, v12, v28
    v_mfma_f32_16x16x32_bf16 v[96:99], a[200:203], a[136:139], v[96:99]
    s_and_b32 s55, s55, 0x1ffff
    ds_read_b128 a[228:231], v6 offset:25600
    v_add_f32 v13, v13, v32
    v_mfma_f32_16x16x32_bf16 v[96:99], a[204:207], a[140:143], v[96:99]
    buffer_load_dwordx4 v7, s[28:31], s54 offen offset:1024 sc1 lds
    v_mfma_f32_16x16x32_bf16 v[104:107], a[192:195], a[144:147], v[168:171]
    s_bitcmp1_b64 s[58:59], s60
    s_cselect_b32 s62, -1.0, s61
    ds_read_b128 a[232:235], v6 offset:26624
    v_mfma_f32_16x16x32_bf16 v[104:107], a[196:199], a[148:151], v[104:107]
    s_add_u32 s60, s60, 1
    ds_read_b128 a[236:239], v6 offset:27648
    v_mfma_f32_16x16x32_bf16 v[104:107], a[200:203], a[152:155], v[104:107]
    ds_read_b128 a[240:243], v6 offset:28672
    v_mfma_f32_16x16x32_bf16 v[104:107], a[204:207], a[156:159], v[104:107]
    s_waitcnt lgkmcnt(5)
    ds_read_b128 a[244:247], v6 offset:29696
    v_mfma_f32_16x16x32_bf16 v[100:103], a[208:211], a[128:131], v[164:167]
    buffer_load_dwordx4 v7, s[28:31], s54 offen offset:2048 sc1 lds
    v_mfma_f32_16x16x32_bf16 v[100:103], a[212:215], a[132:135], v[100:103]
    ds_read_b128 a[248:251], v6 offset:30720
    v_mfma_f32_16x16x32_bf16 v[100:103], a[216:219], a[136:139], v[100:103]
    ds_read_b128 a[252:255], v6 offset:31744
    v_mfma_f32_16x16x32_bf16 v[100:103], a[220:223], a[140:143], v[100:103]
    v_exp_f32 v21, v65
    v_mfma_f32_16x16x32_bf16 v[108:111], a[208:211], a[144:147], v[172:175]
    v_exp_f32 v22, v66
    v_mfma_f32_16x16x32_bf16 v[108:111], a[212:215], a[148:151], v[108:111]
    buffer_load_dwordx4 v7, s[28:31], s54 offen offset:3072 sc1 lds
    v_mfma_f32_16x16x32_bf16 v[108:111], a[216:219], a[152:155], v[108:111]
    s_add_u32 s54, s54, 16384
    v_cvt_pk_bf16_f32 v128, v20, v21
    v_mfma_f32_16x16x32_bf16 v[108:111], a[220:223], a[156:159], v[108:111]
    s_waitcnt vmcnt(16) lgkmcnt(0)
    v_add_u32 v6, s55, v2
    v_mfma_f32_16x16x32_bf16 a[0:3], a[224:227], v[144:147], a[0:3]
    s_barrier
    v_mfma_f32_16x16x32_bf16 a[32:35], a[224:227], v[148:151], a[32:35]
    ds_read_b128 a[192:195], v6 offset:0
    v_mfma_f32_16x16x32_bf16 a[64:67], a[224:227], v[152:155], a[64:67]
    v_exp_f32 v23, v67
    v_mfma_f32_16x16x32_bf16 a[96:99], a[224:227], v[156:159], a[96:99]
    v_exp_f32 v24, v68
    v_mfma_f32_16x16x32_bf16 a[4:7], a[228:231], v[144:147], a[4:7]
    ds_read_b128 a[196:199], v6 offset:1024
    v_cvt_pk_bf16_f32 v129, v22, v23
    v_mfma_f32_16x16x32_bf16 a[36:39], a[228:231], v[148:151], a[36:39]
    v_exp_f32 v25, v69
    v_mfma_f32_16x16x32_bf16 a[68:71], a[228:231], v[152:155], a[68:71]
    v_exp_f32 v26, v70
    v_mfma_f32_16x16x32_bf16 a[100:103], a[228:231], v[156:159], a[100:103]
    ds_read_b128 a[200:203], v6 offset:2048
    v_cvt_pk_bf16_f32 v130, v24, v25
    v_mfma_f32_16x16x32_bf16 a[8:11], a[232:235], v[144:147], a[8:11]
    v_exp_f32 v27, v71
    v_mfma_f32_16x16x32_bf16 a[40:43], a[232:235], v[148:151], a[40:43]
    v_exp_f32 v20, v72
    v_mfma_f32_16x16x32_bf16 a[72:75], a[232:235], v[152:155], a[72:75]
    ds_read_b128 a[204:207], v6 offset:3072
    v_cvt_pk_bf16_f32 v131, v26, v27
    v_mfma_f32_16x16x32_bf16 a[104:107], a[232:235], v[156:159], a[104:107]
    v_exp_f32 v21, v73
    v_mfma_f32_16x16x32_bf16 v[28:31], v[44:47], v[128:131], 0
    v_exp_f32 v22, v74
    v_mfma_f32_16x16x32_bf16 a[12:15], a[236:239], v[144:147], a[12:15]
    v_cvt_pk_bf16_f32 v132, v20, v21
    v_mfma_f32_16x16x32_bf16 a[44:47], a[236:239], v[148:151], a[44:47]
    v_exp_f32 v23, v75
    v_mfma_f32_16x16x32_bf16 a[76:79], a[236:239], v[152:155], a[76:79]
    v_exp_f32 v24, v76
    v_mfma_f32_16x16x32_bf16 a[108:111], a[236:239], v[156:159], a[108:111]
    v_cvt_pk_bf16_f32 v133, v22, v23
    v_mfma_f32_16x16x32_bf16 a[16:19], a[240:243], v[144:147], a[16:19]
    v_exp_f32 v25, v77
    v_mfma_f32_16x16x32_bf16 a[48:51], a[240:243], v[148:151], a[48:51]
    v_exp_f32 v26, v78
    v_mfma_f32_16x16x32_bf16 a[80:83], a[240:243], v[152:155], a[80:83]
    v_cvt_pk_bf16_f32 v134, v24, v25
    v_mfma_f32_16x16x32_bf16 a[112:115], a[240:243], v[156:159], a[112:115]
    v_exp_f32 v27, v79
    v_mfma_f32_16x16x32_bf16 a[20:23], a[244:247], v[144:147], a[20:23]
    v_cvt_pk_bf16_f32 v135, v26, v27
    v_mfma_f32_16x16x32_bf16 a[52:55], a[244:247], v[148:151], a[52:55]
    v_mfma_f32_16x16x32_bf16 a[84:87], a[244:247], v[152:155], a[84:87]
    v_mfma_f32_16x16x32_bf16 v[32:35], v[44:47], v[132:135], 0
    s_nop 2
    v_mfma_f32_16x16x32_bf16 a[116:119], a[244:247], v[156:159], a[116:119]
    s_nop 2
    v_mfma_f32_16x16x32_bf16 a[24:27], a[248:251], v[144:147], a[24:27]
    v_max_f32 v8, v28, v32
    v_cmp_nge_f32 vcc, s62, v8
    v_mfma_f32_16x16x32_bf16 a[56:59], a[248:251], v[148:151], a[56:59]
    v_mfma_f32_16x16x32_bf16 a[88:91], a[248:251], v[152:155], a[88:91]
    v_mfma_f32_16x16x32_bf16 a[120:123], a[248:251], v[156:159], a[120:123]
    ds_read_b128 a[208:211], v6 offset:4096
    v_mfma_f32_16x16x32_bf16 a[28:31], a[252:255], v[144:147], a[28:31]
    ds_read_b128 a[212:215], v6 offset:5120
    v_mfma_f32_16x16x32_bf16 a[60:63], a[252:255], v[148:151], a[60:63]
    ds_read_b128 a[216:219], v6 offset:6144
    v_mfma_f32_16x16x32_bf16 a[92:95], a[252:255], v[152:155], a[92:95]
    ds_read_b128 a[220:223], v6 offset:7168
    v_mfma_f32_16x16x32_bf16 a[124:127], a[252:255], v[156:159], a[124:127]
    s_waitcnt lgkmcnt(4)
    s_cbranch_vccnz mega_kernel_stub91
mega_kernel_ret92:
    v_add_f32 v20, v14, v36
    v_add_f32 v21, v15, v40
    s_nop 3
    v_rcp_f32 v20, v20
    v_rcp_f32 v21, v21
    s_lshl_b32 s90, s75, 10
    s_add_u32 s90, s90, s78
    s_add_u32 s90, s90, 67108864
    v_accvgpr_read_b32 v48, a64
    v_accvgpr_read_b32 v49, a65
    v_accvgpr_read_b32 v50, a66
    v_accvgpr_read_b32 v51, a67
    v_accvgpr_read_b32 v52, a68
    v_accvgpr_read_b32 v53, a69
    v_accvgpr_read_b32 v54, a70
    v_accvgpr_read_b32 v55, a71
    v_mul_f32 v48, v20, v48
    v_mul_f32 v49, v20, v49
    v_mul_f32 v50, v20, v50
    v_mul_f32 v51, v20, v51
    v_mul_f32 v52, v20, v52
    v_mul_f32 v53, v20, v53
    v_mul_f32 v54, v20, v54
    v_mul_f32 v55, v20, v55
    v_cvt_pk_bf16_f32 v48, v48, v49
    v_cvt_pk_bf16_f32 v49, v50, v51
    v_cvt_pk_bf16_f32 v50, v52, v53
    v_cvt_pk_bf16_f32 v51, v54, v55
    buffer_store_dwordx4 v[48:51], v2, s[8:11], s90 offen offset:0 sc1
    v_accvgpr_read_b32 v56, a96
    v_accvgpr_read_b32 v57, a97
    v_accvgpr_read_b32 v58, a98
    v_accvgpr_read_b32 v59, a99
    v_accvgpr_read_b32 v60, a100
    v_accvgpr_read_b32 v61, a101
    v_accvgpr_read_b32 v62, a102
    v_accvgpr_read_b32 v63, a103
    v_mul_f32 v56, v21, v56
    v_mul_f32 v57, v21, v57
    v_mul_f32 v58, v21, v58
    v_mul_f32 v59, v21, v59
    v_mul_f32 v60, v21, v60
    v_mul_f32 v61, v21, v61
    v_mul_f32 v62, v21, v62
    v_mul_f32 v63, v21, v63
    v_cvt_pk_bf16_f32 v56, v56, v57
    v_cvt_pk_bf16_f32 v57, v58, v59
    v_cvt_pk_bf16_f32 v58, v60, v61
    v_cvt_pk_bf16_f32 v59, v62, v63
    buffer_store_dwordx4 v[56:59], v2, s[8:11], s90 offen offset:1024 sc1
    s_add_u32 s90, s90, 131072
    v_accvgpr_read_b32 v48, a72
    v_accvgpr_read_b32 v49, a73
    v_accvgpr_read_b32 v50, a74
    v_accvgpr_read_b32 v51, a75
    v_accvgpr_read_b32 v52, a76
    v_accvgpr_read_b32 v53, a77
    v_accvgpr_read_b32 v54, a78
    v_accvgpr_read_b32 v55, a79
    v_mul_f32 v48, v20, v48
    v_mul_f32 v49, v20, v49
    v_mul_f32 v50, v20, v50
    v_mul_f32 v51, v20, v51
    v_mul_f32 v52, v20, v52
    v_mul_f32 v53, v20, v53
    v_mul_f32 v54, v20, v54
    v_mul_f32 v55, v20, v55
    v_cvt_pk_bf16_f32 v48, v48, v49
    v_cvt_pk_bf16_f32 v49, v50, v51
    v_cvt_pk_bf16_f32 v50, v52, v53
    v_cvt_pk_bf16_f32 v51, v54, v55
    buffer_store_dwordx4 v[48:51], v2, s[8:11], s90 offen offset:0 sc1
    v_accvgpr_read_b32 v56, a104
    v_accvgpr_read_b32 v57, a105
    v_accvgpr_read_b32 v58, a106
    v_accvgpr_read_b32 v59, a107
    v_accvgpr_read_b32 v60, a108
    v_accvgpr_read_b32 v61, a109
    v_accvgpr_read_b32 v62, a110
    v_accvgpr_read_b32 v63, a111
    v_mul_f32 v56, v21, v56
    v_mul_f32 v57, v21, v57
    v_mul_f32 v58, v21, v58
    v_mul_f32 v59, v21, v59
    v_mul_f32 v60, v21, v60
    v_mul_f32 v61, v21, v61
    v_mul_f32 v62, v21, v62
    v_mul_f32 v63, v21, v63
    v_cvt_pk_bf16_f32 v56, v56, v57
    v_cvt_pk_bf16_f32 v57, v58, v59
    v_cvt_pk_bf16_f32 v58, v60, v61
    v_cvt_pk_bf16_f32 v59, v62, v63
    buffer_store_dwordx4 v[56:59], v2, s[8:11], s90 offen offset:1024 sc1
    s_add_u32 s90, s90, 131072
    v_accvgpr_read_b32 v48, a80
    v_accvgpr_read_b32 v49, a81
    v_accvgpr_read_b32 v50, a82
    v_accvgpr_read_b32 v51, a83
    v_accvgpr_read_b32 v52, a84
    v_accvgpr_read_b32 v53, a85
    v_accvgpr_read_b32 v54, a86
    v_accvgpr_read_b32 v55, a87
    v_mul_f32 v48, v20, v48
    v_mul_f32 v49, v20, v49
    v_mul_f32 v50, v20, v50
    v_mul_f32 v51, v20, v51
    v_mul_f32 v52, v20, v52
    v_mul_f32 v53, v20, v53
    v_mul_f32 v54, v20, v54
    v_mul_f32 v55, v20, v55
    v_cvt_pk_bf16_f32 v48, v48, v49
    v_cvt_pk_bf16_f32 v49, v50, v51
    v_cvt_pk_bf16_f32 v50, v52, v53
    v_cvt_pk_bf16_f32 v51, v54, v55
    buffer_store_dwordx4 v[48:51], v2, s[8:11], s90 offen offset:0 sc1
    v_accvgpr_read_b32 v56, a112
    v_accvgpr_read_b32 v57, a113
    v_accvgpr_read_b32 v58, a114
    v_accvgpr_read_b32 v59, a115
    v_accvgpr_read_b32 v60, a116
    v_accvgpr_read_b32 v61, a117
    v_accvgpr_read_b32 v62, a118
    v_accvgpr_read_b32 v63, a119
    v_mul_f32 v56, v21, v56
    v_mul_f32 v57, v21, v57
    v_mul_f32 v58, v21, v58
    v_mul_f32 v59, v21, v59
    v_mul_f32 v60, v21, v60
    v_mul_f32 v61, v21, v61
    v_mul_f32 v62, v21, v62
    v_mul_f32 v63, v21, v63
    v_cvt_pk_bf16_f32 v56, v56, v57
    v_cvt_pk_bf16_f32 v57, v58, v59
    v_cvt_pk_bf16_f32 v58, v60, v61
    v_cvt_pk_bf16_f32 v59, v62, v63
    buffer_store_dwordx4 v[56:59], v2, s[8:11], s90 offen offset:1024 sc1
    s_add_u32 s90, s90, 131072
    v_accvgpr_read_b32 v48, a88
    v_accvgpr_read_b32 v49, a89
    v_accvgpr_read_b32 v50, a90
    v_accvgpr_read_b32 v51, a91
    v_accvgpr_read_b32 v52, a92
    v_accvgpr_read_b32 v53, a93
    v_accvgpr_read_b32 v54, a94
    v_accvgpr_read_b32 v55, a95
    v_mul_f32 v48, v20, v48
    v_mul_f32 v49, v20, v49
    v_mul_f32 v50, v20, v50
    v_mul_f32 v51, v20, v51
    v_mul_f32 v52, v20, v52
    v_mul_f32 v53, v20, v53
    v_mul_f32 v54, v20, v54
    v_mul_f32 v55, v20, v55
    v_cvt_pk_bf16_f32 v48, v48, v49
    v_cvt_pk_bf16_f32 v49, v50, v51
    v_cvt_pk_bf16_f32 v50, v52, v53
    v_cvt_pk_bf16_f32 v51, v54, v55
    buffer_store_dwordx4 v[48:51], v2, s[8:11], s90 offen offset:0 sc1
    v_accvgpr_read_b32 v56, a120
    v_accvgpr_read_b32 v57, a121
    v_accvgpr_read_b32 v58, a122
    v_accvgpr_read_b32 v59, a123
    v_accvgpr_read_b32 v60, a124
    v_accvgpr_read_b32 v61, a125
    v_accvgpr_read_b32 v62, a126
    v_accvgpr_read_b32 v63, a127
    v_mul_f32 v56, v21, v56
    v_mul_f32 v57, v21, v57
    v_mul_f32 v58, v21, v58
    v_mul_f32 v59, v21, v59
    v_mul_f32 v60, v21, v60
    v_mul_f32 v61, v21, v61
    v_mul_f32 v62, v21, v62
    v_mul_f32 v63, v21, v63
    v_cvt_pk_bf16_f32 v56, v56, v57
    v_cvt_pk_bf16_f32 v57, v58, v59
    v_cvt_pk_bf16_f32 v58, v60, v61
    v_cvt_pk_bf16_f32 v59, v62, v63
    buffer_store_dwordx4 v[56:59], v2, s[8:11], s90 offen offset:1024 sc1
    s_add_u32 s90, s90, 131072
mega_kernel_single93:
    v_mfma_f32_16x16x32_bf16 v[64:67], a[192:195], a[128:131], v[160:163]
    s_bitcmp1_b64 s[58:59], s60
    s_cselect_b32 s62, -1.0, s61
    v_add_f32 v12, v12, v28
    v_mfma_f32_16x16x32_bf16 v[64:67], a[196:199], a[132:135], v[64:67]
    s_mov_b32 m0, s56
    ds_read_b128 a[224:227], v6 offset:16384
    v_add_f32 v13, v13, v32
    v_mfma_f32_16x16x32_bf16 v[64:67], a[200:203], a[136:139], v[64:67]
    buffer_load_dwordx4 v7, s[24:27], s53 offen offset:0 sc1 lds
    v_mfma_f32_16x16x32_bf16 v[64:67], a[204:207], a[140:143], v[64:67]
    s_add_u32 s60, s60, 1
    ds_read_b128 a[228:231], v6 offset:17408
    v_exp_f32 v20, v96
    v_mfma_f32_16x16x32_bf16 v[72:75], a[192:195], a[144:147], v[168:171]
    ds_read_b128 a[232:235], v6 offset:18432
    v_exp_f32 v21, v97
    v_mfma_f32_16x16x32_bf16 v[72:75], a[196:199], a[148:151], v[72:75]
    ds_read_b128 a[236:239], v6 offset:19456
    v_cvt_pk_bf16_f32 v144, v20, v21
    v_mfma_f32_16x16x32_bf16 v[72:75], a[200:203], a[152:155], v[72:75]
    ds_read_b128 a[240:243], v6 offset:20480
    v_exp_f32 v22, v98
    v_mfma_f32_16x16x32_bf16 v[72:75], a[204:207], a[156:159], v[72:75]
    s_waitcnt lgkmcnt(5)
    ds_read_b128 a[244:247], v6 offset:21504
    v_mfma_f32_16x16x32_bf16 v[68:71], a[208:211], a[128:131], v[164:167]
    ds_read_b128 a[248:251], v6 offset:22528
    v_exp_f32 v23, v99
    v_mfma_f32_16x16x32_bf16 v[68:71], a[212:215], a[132:135], v[68:71]
    ds_read_b128 a[252:255], v6 offset:23552
    v_cvt_pk_bf16_f32 v145, v22, v23
    v_mfma_f32_16x16x32_bf16 v[68:71], a[216:219], a[136:139], v[68:71]
    buffer_load_dwordx4 v7, s[24:27], s53 offen offset:1024 sc1 lds
    v_mfma_f32_16x16x32_bf16 v[68:71], a[220:223], a[140:143], v[68:71]
    v_exp_f32 v24, v100
    v_mfma_f32_16x16x32_bf16 v[76:79], a[208:211], a[144:147], v[172:175]
    v_exp_f32 v25, v101
    v_mfma_f32_16x16x32_bf16 v[76:79], a[212:215], a[148:151], v[76:79]
    v_exp_f32 v26, v102
    v_mfma_f32_16x16x32_bf16 v[76:79], a[216:219], a[152:155], v[76:79]
    buffer_load_dwordx4 v7, s[24:27], s53 offen offset:2048 sc1 lds
    v_cvt_pk_bf16_f32 v146, v24, v25
    v_mfma_f32_16x16x32_bf16 v[76:79], a[220:223], a[156:159], v[76:79]
    s_waitcnt lgkmcnt(0)
    v_exp_f32 v27, v103
    v_mfma_f32_16x16x32_bf16 a[0:3], a[224:227], v[128:131], a[0:3]
    ds_read_b128 a[192:195], v6 offset:8192
    v_cvt_pk_bf16_f32 v147, v26, v27
    v_mfma_f32_16x16x32_bf16 a[32:35], a[224:227], v[132:135], a[32:35]
    v_exp_f32 v20, v104
    v_mfma_f32_16x16x32_bf16 v[28:31], v[44:47], v[144:147], 0
    v_exp_f32 v21, v105
    v_mfma_f32_16x16x32_bf16 a[4:7], a[228:231], v[128:131], a[4:7]
    ds_read_b128 a[196:199], v6 offset:9216
    v_exp_f32 v22, v106
    v_mfma_f32_16x16x32_bf16 a[36:39], a[228:231], v[132:135], a[36:39]
    buffer_load_dwordx4 v7, s[24:27], s53 offen offset:3072 sc1 lds
    v_mfma_f32_16x16x32_bf16 a[8:11], a[232:235], v[128:131], a[8:11]
    s_add_u32 s53, s53, 16384
    ds_read_b128 a[200:203], v6 offset:10240
    v_cvt_pk_bf16_f32 v148, v20, v21
    v_mfma_f32_16x16x32_bf16 a[40:43], a[232:235], v[132:135], a[40:43]
    v_exp_f32 v23, v107
    v_mfma_f32_16x16x32_bf16 a[12:15], a[236:239], v[128:131], a[12:15]
    ds_read_b128 a[204:207], v6 offset:11264
    v_exp_f32 v24, v108
    v_mfma_f32_16x16x32_bf16 a[44:47], a[236:239], v[132:135], a[44:47]
    v_cvt_pk_bf16_f32 v149, v22, v23
    v_exp_f32 v25, v109
    v_mfma_f32_16x16x32_bf16 a[16:19], a[240:243], v[128:131], a[16:19]
    v_exp_f32 v26, v110
    v_mfma_f32_16x16x32_bf16 a[48:51], a[240:243], v[132:135], a[48:51]
    v_cvt_pk_bf16_f32 v150, v24, v25
    v_exp_f32 v27, v111
    v_mfma_f32_16x16x32_bf16 a[20:23], a[244:247], v[128:131], a[20:23]
    ds_read_b128 a[208:211], v6 offset:12288
    v_cvt_pk_bf16_f32 v151, v26, v27
    v_mfma_f32_16x16x32_bf16 a[52:55], a[244:247], v[132:135], a[52:55]
    s_add_u32 m0, s56, 16384
    ds_read_b128 a[212:215], v6 offset:13312
    v_mfma_f32_16x16x32_bf16 v[32:35], v[44:47], v[148:151], 0
    s_nop 2
    v_mfma_f32_16x16x32_bf16 a[24:27], a[248:251], v[128:131], a[24:27]
    buffer_load_dwordx4 v7, s[28:31], s54 offen offset:0 sc1 lds
    v_mfma_f32_16x16x32_bf16 a[56:59], a[248:251], v[132:135], a[56:59]
    ds_read_b128 a[216:219], v6 offset:14336
    s_nop 0
    v_mfma_f32_16x16x32_bf16 a[28:31], a[252:255], v[128:131], a[28:31]
    ds_read_b128 a[220:223], v6 offset:15360
    v_max_f32 v8, v28, v32
    v_cmp_nge_f32 vcc, s62, v8
    v_mfma_f32_16x16x32_bf16 a[60:63], a[252:255], v[132:135], a[60:63]
    s_waitcnt lgkmcnt(4)
    s_cbranch_vccnz mega_kernel_stub94
mega_kernel_ret95:
    v_mfma_f32_16x16x32_bf16 v[96:99], a[192:195], a[128:131], v[160:163]
    s_add_u32 s56, s55, s57
    v_exp_f32 v20, v64
    v_mfma_f32_16x16x32_bf16 v[96:99], a[196:199], a[132:135], v[96:99]
    s_add_u32 s55, s55, 32768
    ds_read_b128 a[224:227], v6 offset:24576
    v_add_f32 v12, v12, v28
    v_mfma_f32_16x16x32_bf16 v[96:99], a[200:203], a[136:139], v[96:99]
    s_and_b32 s55, s55, 0x1ffff
    ds_read_b128 a[228:231], v6 offset:25600
    v_exp_f32 v21, v65
    v_mfma_f32_16x16x32_bf16 v[96:99], a[204:207], a[140:143], v[96:99]
    s_bitcmp1_b64 s[58:59], s60
    s_cselect_b32 s62, -1.0, s61
    ds_read_b128 a[232:235], v6 offset:26624
    v_mfma_f32_16x16x32_bf16 v[104:107], a[192:195], a[144:147], v[168:171]
    buffer_load_dwordx4 v7, s[28:31], s54 offen offset:1024 sc1 lds
    v_mfma_f32_16x16x32_bf16 v[104:107], a[196:199], a[148:151], v[104:107]
    s_add_u32 s60, s60, 1
    ds_read_b128 a[236:239], v6 offset:27648
    v_cvt_pk_bf16_f32 v128, v20, v21
    v_mfma_f32_16x16x32_bf16 v[104:107], a[200:203], a[152:155], v[104:107]
    ds_read_b128 a[240:243], v6 offset:28672
    v_exp_f32 v22, v66
    v_mfma_f32_16x16x32_bf16 v[104:107], a[204:207], a[156:159], v[104:107]
    s_waitcnt lgkmcnt(5)
    ds_read_b128 a[244:247], v6 offset:29696
    v_add_f32 v13, v13, v32
    v_mfma_f32_16x16x32_bf16 v[100:103], a[208:211], a[128:131], v[164:167]
    ds_read_b128 a[248:251], v6 offset:30720
    v_exp_f32 v23, v67
    v_mfma_f32_16x16x32_bf16 v[100:103], a[212:215], a[132:135], v[100:103]
    buffer_load_dwordx4 v7, s[28:31], s54 offen offset:2048 sc1 lds
    v_mfma_f32_16x16x32_bf16 v[100:103], a[216:219], a[136:139], v[100:103]
    ds_read_b128 a[252:255], v6 offset:31744
    v_cvt_pk_bf16_f32 v129, v22, v23
    v_mfma_f32_16x16x32_bf16 v[100:103], a[220:223], a[140:143], v[100:103]
    v_exp_f32 v24, v68
    v_mfma_f32_16x16x32_bf16 v[108:111], a[208:211], a[144:147], v[172:175]
    v_exp_f32 v25, v69
    v_mfma_f32_16x16x32_bf16 v[108:111], a[212:215], a[148:151], v[108:111]
    buffer_load_dwordx4 v7, s[28:31], s54 offen offset:3072 sc1 lds
    v_mfma_f32_16x16x32_bf16 v[108:111], a[216:219], a[152:155], v[108:111]
    s_add_u32 s54, s54, 16384
    v_exp_f32 v26, v70
    v_cvt_pk_bf16_f32 v130, v24, v25
    v_mfma_f32_16x16x32_bf16 v[108:111], a[220:223], a[156:159], v[108:111]
    s_waitcnt vmcnt(16) lgkmcnt(0)
    v_add_u32 v6, s55, v2
    v_exp_f32 v27, v71
    v_mfma_f32_16x16x32_bf16 a[0:3], a[224:227], v[144:147], a[0:3]
    s_barrier
    v_mfma_f32_16x16x32_bf16 a[32:35], a[224:227], v[148:151], a[32:35]
    ds_read_b128 a[192:195], v6 offset:0
    v_cvt_pk_bf16_f32 v131, v26, v27
    v_mfma_f32_16x16x32_bf16 a[4:7], a[228:231], v[144:147], a[4:7]
    v_exp_f32 v20, v72
    v_mfma_f32_16x16x32_bf16 v[28:31], v[44:47], v[128:131], 0
    v_exp_f32 v21, v73
    v_mfma_f32_16x16x32_bf16 a[36:39], a[228:231], v[148:151], a[36:39]
    ds_read_b128 a[196:199], v6 offset:1024
    v_cvt_pk_bf16_f32 v132, v20, v21
    v_mfma_f32_16x16x32_bf16 a[8:11], a[232:235], v[144:147], a[8:11]
    v_exp_f32 v22, v74
    v_mfma_f32_16x16x32_bf16 a[40:43], a[232:235], v[148:151], a[40:43]
    ds_read_b128 a[200:203], v6 offset:2048
    v_exp_f32 v23, v75
    v_mfma_f32_16x16x32_bf16 a[12:15], a[236:239], v[144:147], a[12:15]
    v_exp_f32 v24, v76
    v_mfma_f32_16x16x32_bf16 a[44:47], a[236:239], v[148:151], a[44:47]
    ds_read_b128 a[204:207], v6 offset:3072
    v_cvt_pk_bf16_f32 v133, v22, v23
    v_mfma_f32_16x16x32_bf16 a[16:19], a[240:243], v[144:147], a[16:19]
    v_exp_f32 v25, v77
    v_mfma_f32_16x16x32_bf16 a[48:51], a[240:243], v[148:151], a[48:51]
    v_exp_f32 v26, v78
    v_cvt_pk_bf16_f32 v134, v24, v25
    v_mfma_f32_16x16x32_bf16 a[20:23], a[244:247], v[144:147], a[20:23]
    v_exp_f32 v27, v79
    v_mfma_f32_16x16x32_bf16 a[52:55], a[244:247], v[148:151], a[52:55]
    ds_read_b128 a[208:211], v6 offset:4096
    v_cvt_pk_bf16_f32 v135, v26, v27
    s_nop 1
    v_mfma_f32_16x16x32_bf16 v[32:35], v[44:47], v[132:135], 0
    s_nop 2
    v_mfma_f32_16x16x32_bf16 a[24:27], a[248:251], v[144:147], a[24:27]
    ds_read_b128 a[212:215], v6 offset:5120
    s_nop 0
    v_mfma_f32_16x16x32_bf16 a[56:59], a[248:251], v[148:151], a[56:59]
    ds_read_b128 a[216:219], v6 offset:6144
    v_max_f32 v8, v28, v32
    v_mfma_f32_16x16x32_bf16 a[28:31], a[252:255], v[144:147], a[28:31]
    ds_read_b128 a[220:223], v6 offset:7168
    v_cmp_nge_f32 vcc, s62, v8
    v_mfma_f32_16x16x32_bf16 a[60:63], a[252:255], v[148:151], a[60:63]
    s_waitcnt lgkmcnt(4)
    s_cbranch_vccz mega_kernel_single93
    v_cmp_lt_f32 vcc, s61, v8
    s_cmp_lg_u32 s60, s66
    s_cbranch_scc1 mega_kernel_e97
    v_add_f32 v160, v160, v16
    v_mov_b32 v164, v9
    v_add_f32 v172, v172, v16
    v_add_f32 v161, v161, v17
    v_mov_b32 v165, v9
    v_add_f32 v173, v173, v17
    v_add_f32 v162, v162, v18
    v_mov_b32 v166, v9
    v_add_f32 v174, v174, v18
    v_add_f32 v163, v163, v19
    v_mov_b32 v167, v9
    v_add_f32 v175, v175, v19
    s_nop 0
mega_kernel_e97:
    s_cmp_lg_u32 s60, s67
    s_cbranch_scc1 mega_kernel_e98
    v_mov_b32 v160, v9
    v_mov_b32 v168, v9
    v_mov_b32 v172, v9
    v_mov_b32 v161, v9
    v_mov_b32 v169, v9
    v_mov_b32 v173, v9
    v_mov_b32 v162, v9
    v_mov_b32 v170, v9
    v_mov_b32 v174, v9
    v_mov_b32 v163, v9
    v_mov_b32 v171, v9
    v_mov_b32 v175, v9
    s_nop 0
mega_kernel_e98:
    s_cmp_lg_u32 s60, s52
    s_cbranch_scc1 mega_kernel_e100
    v_lshrrev_b32 v62, 3, v1
    v_lshlrev_b32 v62, 11, v62
    v_and_b32 v61, 7, v1
    v_lshl_add_u32 v62, v61, 7, v62
    s_lshr_b32 s90, s2, 3
    s_lshl_b32 s90, s90, 2
    s_add_u32 s90, s90, s16
    s_lshl_b32 s90, s90, 14
    s_and_b32 s91, s2, 1
    s_lshl_b32 s91, s91, 10
    s_add_u32 s90, s90, s91
    s_bitcmp1_b32 s2, 2
    s_cselect_b32 s91, 0, 5373952
    s_mov_b32 s92, 8388608
    s_cselect_b32 s46, 5373952, s92
    s_cselect_b32 s93, 0, 2097152
    s_add_u32 s91, s91, s90
    s_mov_b32 s44, s48
    s_mov_b32 s45, s49
    s_add_u32 s92, s91, 0
    buffer_load_dword v255, v62, s[44:47], s92 offen
    s_add_u32 s92, s91, 2097152
    buffer_load_dword v255, v62, s[44:47], s92 offen
    s_add_u32 s92, s91, 4194304
    buffer_load_dword v255, v62, s[44:47], s92 offen
    s_mov_b32 s44, s50
    s_mov_b32 s45, s51
    s_mov_b32 s46, s93
    buffer_load_dword v255, v62, s[44:47], s90 offen
mega_kernel_e100:
    s_cmp_gt_u32 s60, 26
    s_cbranch_scc1 mega_kernel_e99
    s_cmp_lg_u32 s60, 6
    s_cbranch_scc1 mega_kernel_e101
    s_cmp_eq_u32 s17, -1
    s_cbranch_scc1 mega_kernel_e99
    s_cmp_lg_u32 s16, 0
    s_cbranch_scc1 mega_kernel_np102
    v_mov_b32 v4, s4
    v_mov_b32 v5, s5
    s_add_u32 s90, s17, 117440512
    s_mov_b64 exec, 1
    buffer_store_dwordx2 v[4:5], off, s[8:11], s90 sc1
    s_mov_b64 exec, -1
mega_kernel_np102:
    s_branch mega_kernel_e99
mega_kernel_e101:
    s_cmp_lg_u32 s60, 22
    s_cbranch_scc1 mega_kernel_e103
    buffer_load_dwordx2 v[4:5], v10, s[8:11], 0 offen sc1
    s_mov_b32 s44, s48
    s_mov_b32 s45, s49
    s_mov_b32 s46, 8388608
    s_lshl_b32 s90, s2, 2
    s_add_u32 s90, s90, s16
    s_lshl_b32 s90, s90, 13
    v_lshlrev_b32 v62, 7, v1
    buffer_load_dword v255, v62, s[44:47], s90 offen
    s_branch mega_kernel_e99
mega_kernel_e103:
    s_cmp_lg_u32 s60, 26
    s_cbranch_scc1 mega_kernel_e104
    s_mov_b32 s44, s50
    s_mov_b32 s45, s51
    s_mov_b32 s46, 2097152
    s_lshl_b32 s90, s2, 2
    s_add_u32 s90, s90, s16
    s_lshl_b32 s90, s90, 13
    v_lshlrev_b32 v62, 7, v1
    buffer_load_dword v255, v62, s[44:47], s90 offen
    s_waitcnt vmcnt(18)
    s_mov_b32 s3, 1048576
mega_kernel_spin105:
    v_cmp_ne_u64 s[72:73], s[4:5], v[4:5]
    s_nop 3
    s_cmp_eq_u64 s[72:73], 0
    s_cbranch_scc1 mega_kernel_e99
    s_sub_u32 s3, s3, 1
    s_cbranch_scc1 mega_kernel_e99
    s_sleep 32
    buffer_load_dwordx2 v[4:5], v10, s[8:11], 0 offen sc1
    s_waitcnt vmcnt(0)
    s_branch mega_kernel_spin105
    s_branch mega_kernel_e99
mega_kernel_e104:
mega_kernel_e99:
    s_cbranch_vccnz mega_kernel_rc106
mega_kernel_sp96:
    s_cmp_lg_u32 s60, s68
    s_cbranch_scc1 mega_kernel_single93
    ds_read_b128 a[224:227], v6 offset:16384
    ds_read_b128 a[228:231], v6 offset:17408
    ds_read_b128 a[232:235], v6 offset:18432
    ds_read_b128 a[236:239], v6 offset:19456
    ds_read_b128 a[240:243], v6 offset:20480
    ds_read_b128 a[244:247], v6 offset:21504
    ds_read_b128 a[248:251], v6 offset:22528
    ds_read_b128 a[252:255], v6 offset:23552
    s_waitcnt lgkmcnt(0)
    v_mfma_f32_16x16x32_bf16 a[0:3], a[224:227], v[128:131], a[0:3]
    buffer_load_dwordx4 v[192:195], v2, s[8:11], s79 offen offset:0 sc1
    v_exp_f32 v20, v96
    v_mfma_f32_16x16x32_bf16 a[32:35], a[224:227], v[132:135], a[32:35]
    v_exp_f32 v21, v97
    v_exp_f32 v22, v98
    v_mfma_f32_16x16x32_bf16 a[4:7], a[228:231], v[128:131], a[4:7]
    buffer_load_dwordx4 v[196:199], v2, s[8:11], s79 offen offset:1024 sc1
    v_cvt_pk_bf16_f32 v144, v20, v21
    v_add_f32 v12, v12, v28
    v_mfma_f32_16x16x32_bf16 a[36:39], a[228:231], v[132:135], a[36:39]
    v_exp_f32 v23, v99
    v_exp_f32 v24, v100
    v_cvt_pk_bf16_f32 v145, v22, v23
    v_mfma_f32_16x16x32_bf16 a[8:11], a[232:235], v[128:131], a[8:11]
    buffer_load_dwordx4 v[200:203], v2, s[8:11], s79 offen offset:2048 sc1
    v_exp_f32 v25, v101
    v_mfma_f32_16x16x32_bf16 a[40:43], a[232:235], v[132:135], a[40:43]
    v_exp_f32 v26, v102
    v_cvt_pk_bf16_f32 v146, v24, v25
    v_add_f32 v13, v13, v32
    v_mfma_f32_16x16x32_bf16 a[12:15], a[236:239], v[128:131], a[12:15]
    buffer_load_dwordx4 v[204:207], v2, s[8:11], s79 offen offset:3072 sc1
    v_exp_f32 v27, v103
    v_mfma_f32_16x16x32_bf16 a[44:47], a[236:239], v[132:135], a[44:47]
    v_exp_f32 v20, v104
    v_cvt_pk_bf16_f32 v147, v26, v27
    v_mfma_f32_16x16x32_bf16 a[16:19], a[240:243], v[128:131], a[16:19]
    buffer_load_dwordx4 v[212:215], v2, s[8:11], s80 offen offset:0 sc1
    v_exp_f32 v21, v105
    v_mfma_f32_16x16x32_bf16 v[28:31], v[44:47], v[144:147], 0
    v_exp_f32 v22, v106
    v_cvt_pk_bf16_f32 v148, v20, v21
    v_exp_f32 v23, v107
    v_mfma_f32_16x16x32_bf16 a[48:51], a[240:243], v[132:135], a[48:51]
    v_exp_f32 v24, v108
    v_cvt_pk_bf16_f32 v149, v22, v23
    v_exp_f32 v25, v109
    v_mfma_f32_16x16x32_bf16 a[20:23], a[244:247], v[128:131], a[20:23]
    buffer_load_dwordx4 v[216:219], v2, s[8:11], s80 offen offset:1024 sc1
    v_exp_f32 v26, v110
    v_mfma_f32_16x16x32_bf16 a[52:55], a[244:247], v[132:135], a[52:55]
    v_cvt_pk_bf16_f32 v150, v24, v25
    v_exp_f32 v27, v111
    s_nop 0
    v_cvt_pk_bf16_f32 v151, v26, v27
    s_nop 1
    v_mfma_f32_16x16x32_bf16 v[32:35], v[44:47], v[148:151], 0
    s_nop 2
    v_mfma_f32_16x16x32_bf16 a[24:27], a[248:251], v[128:131], a[24:27]
    buffer_load_dwordx4 v[220:223], v2, s[8:11], s80 offen offset:2048 sc1
    v_mfma_f32_16x16x32_bf16 a[56:59], a[248:251], v[132:135], a[56:59]
    s_nop 2
    v_mfma_f32_16x16x32_bf16 a[28:31], a[252:255], v[128:131], a[28:31]
    v_max_f32 v8, v28, v32
    v_cmp_nge_f32 vcc, s61, v8
    v_mfma_f32_16x16x32_bf16 a[60:63], a[252:255], v[132:135], a[60:63]
    s_cbranch_vccnz mega_kernel_stub107
mega_kernel_ret108:
    s_nop 1
    ds_read_b128 a[224:227], v6 offset:24576
    ds_read_b128 a[228:231], v6 offset:25600
    ds_read_b128 a[232:235], v6 offset:26624
    ds_read_b128 a[236:239], v6 offset:27648
    ds_read_b128 a[240:243], v6 offset:28672
    ds_read_b128 a[244:247], v6 offset:29696
    ds_read_b128 a[248:251], v6 offset:30720
    ds_read_b128 a[252:255], v6 offset:31744
    s_waitcnt lgkmcnt(0)
    v_mfma_f32_16x16x32_bf16 a[0:3], a[224:227], v[144:147], a[0:3]
    buffer_load_dwordx4 v[224:227], v2, s[8:11], s80 offen offset:3072 sc1
    v_mfma_f32_16x16x32_bf16 a[32:35], a[224:227], v[148:151], a[32:35]
    v_mfma_f32_16x16x32_bf16 a[4:7], a[228:231], v[144:147], a[4:7]
    buffer_load_dwordx4 v[208:211], v2, s[8:11], s81 offen offset:0 sc1
    v_mfma_f32_16x16x32_bf16 a[36:39], a[228:231], v[148:151], a[36:39]
    v_mfma_f32_16x16x32_bf16 a[8:11], a[232:235], v[144:147], a[8:11]
    buffer_load_dwordx4 v[232:235], v2, s[8:11], s82 offen offset:0 sc1
    v_mfma_f32_16x16x32_bf16 a[40:43], a[232:235], v[148:151], a[40:43]
    v_mfma_f32_16x16x32_bf16 a[12:15], a[236:239], v[144:147], a[12:15]
    buffer_load_dwordx4 v[236:239], v2, s[8:11], s82 offen offset:1024 sc1
    v_mfma_f32_16x16x32_bf16 a[44:47], a[236:239], v[148:151], a[44:47]
    v_mfma_f32_16x16x32_bf16 a[16:19], a[240:243], v[144:147], a[16:19]
    buffer_load_dwordx4 v[228:231], v2, s[8:11], s83 offen offset:0 sc1
    v_mfma_f32_16x16x32_bf16 a[48:51], a[240:243], v[148:151], a[48:51]
    v_mfma_f32_16x16x32_bf16 a[20:23], a[244:247], v[144:147], a[20:23]
    buffer_load_dwordx4 v[244:247], v2, s[8:11], s84 offen offset:0 sc1
    v_mfma_f32_16x16x32_bf16 a[52:55], a[244:247], v[148:151], a[52:55]
    v_mfma_f32_16x16x32_bf16 a[24:27], a[248:251], v[144:147], a[24:27]
    buffer_load_dwordx4 v[248:251], v2, s[8:11], s84 offen offset:1024 sc1
    v_mfma_f32_16x16x32_bf16 a[56:59], a[248:251], v[148:151], a[56:59]
    v_mfma_f32_16x16x32_bf16 a[28:31], a[252:255], v[144:147], a[28:31]
    buffer_load_dwordx4 v[240:243], v2, s[8:11], s85 offen offset:0 sc1
    v_mfma_f32_16x16x32_bf16 a[60:63], a[252:255], v[148:151], a[60:63]
    v_add_f32 v20, v12, v28
    v_add_f32 v21, v13, v32
    s_nop 3
    v_rcp_f32 v20, v20
    v_rcp_f32 v21, v21
    s_lshl_b32 s90, s74, 10
    s_add_u32 s90, s90, s78
    s_add_u32 s90, s90, 67108864
    v_accvgpr_read_b32 v48, a0
    v_accvgpr_read_b32 v49, a1
    v_accvgpr_read_b32 v50, a2
    v_accvgpr_read_b32 v51, a3
    v_accvgpr_read_b32 v52, a4
    v_accvgpr_read_b32 v53, a5
    v_accvgpr_read_b32 v54, a6
    v_accvgpr_read_b32 v55, a7
    v_mul_f32 v48, v20, v48
    v_mul_f32 v49, v20, v49
    v_mul_f32 v50, v20, v50
    v_mul_f32 v51, v20, v51
    v_mul_f32 v52, v20, v52
    v_mul_f32 v53, v20, v53
    v_mul_f32 v54, v20, v54
    v_mul_f32 v55, v20, v55
    v_cvt_pk_bf16_f32 v48, v48, v49
    v_cvt_pk_bf16_f32 v49, v50, v51
    v_cvt_pk_bf16_f32 v50, v52, v53
    v_cvt_pk_bf16_f32 v51, v54, v55
    buffer_store_dwordx4 v[48:51], v2, s[8:11], s90 offen offset:0 sc1
    v_accvgpr_read_b32 v56, a32
    v_accvgpr_read_b32 v57, a33
    v_accvgpr_read_b32 v58, a34
    v_accvgpr_read_b32 v59, a35
    v_accvgpr_read_b32 v60, a36
    v_accvgpr_read_b32 v61, a37
    v_accvgpr_read_b32 v62, a38
    v_accvgpr_read_b32 v63, a39
    v_mul_f32 v56, v21, v56
    v_mul_f32 v57, v21, v57
    v_mul_f32 v58, v21, v58
    v_mul_f32 v59, v21, v59
    v_mul_f32 v60, v21, v60
    v_mul_f32 v61, v21, v61
    v_mul_f32 v62, v21, v62
    v_mul_f32 v63, v21, v63
    v_cvt_pk_bf16_f32 v56, v56, v57
    v_cvt_pk_bf16_f32 v57, v58, v59
    v_cvt_pk_bf16_f32 v58, v60, v61
    v_cvt_pk_bf16_f32 v59, v62, v63
    buffer_store_dwordx4 v[56:59], v2, s[8:11], s90 offen offset:1024 sc1
    s_add_u32 s90, s90, 131072
    v_accvgpr_read_b32 v48, a8
    v_accvgpr_read_b32 v49, a9
    v_accvgpr_read_b32 v50, a10
    v_accvgpr_read_b32 v51, a11
    v_accvgpr_read_b32 v52, a12
    v_accvgpr_read_b32 v53, a13
    v_accvgpr_read_b32 v54, a14
    v_accvgpr_read_b32 v55, a15
    v_mul_f32 v48, v20, v48
    v_mul_f32 v49, v20, v49
    v_mul_f32 v50, v20, v50
    v_mul_f32 v51, v20, v51
    v_mul_f32 v52, v20, v52
    v_mul_f32 v53, v20, v53
    v_mul_f32 v54, v20, v54
    v_mul_f32 v55, v20, v55
    v_cvt_pk_bf16_f32 v48, v48, v49
    v_cvt_pk_bf16_f32 v49, v50, v51
    v_cvt_pk_bf16_f32 v50, v52, v53
    v_cvt_pk_bf16_f32 v51, v54, v55
    buffer_store_dwordx4 v[48:51], v2, s[8:11], s90 offen offset:0 sc1
    v_accvgpr_read_b32 v56, a40
    v_accvgpr_read_b32 v57, a41
    v_accvgpr_read_b32 v58, a42
    v_accvgpr_read_b32 v59, a43
    v_accvgpr_read_b32 v60, a44
    v_accvgpr_read_b32 v61, a45
    v_accvgpr_read_b32 v62, a46
    v_accvgpr_read_b32 v63, a47
    v_mul_f32 v56, v21, v56
    v_mul_f32 v57, v21, v57
    v_mul_f32 v58, v21, v58
    v_mul_f32 v59, v21, v59
    v_mul_f32 v60, v21, v60
    v_mul_f32 v61, v21, v61
    v_mul_f32 v62, v21, v62
    v_mul_f32 v63, v21, v63
    v_cvt_pk_bf16_f32 v56, v56, v57
    v_cvt_pk_bf16_f32 v57, v58, v59
    v_cvt_pk_bf16_f32 v58, v60, v61
    v_cvt_pk_bf16_f32 v59, v62, v63
    buffer_store_dwordx4 v[56:59], v2, s[8:11], s90 offen offset:1024 sc1
    s_add_u32 s90, s90, 131072
    v_accvgpr_read_b32 v48, a16
    v_accvgpr_read_b32 v49, a17
    v_accvgpr_read_b32 v50, a18
    v_accvgpr_read_b32 v51, a19
    v_accvgpr_read_b32 v52, a20
    v_accvgpr_read_b32 v53, a21
    v_accvgpr_read_b32 v54, a22
    v_accvgpr_read_b32 v55, a23
    v_mul_f32 v48, v20, v48
    v_mul_f32 v49, v20, v49
    v_mul_f32 v50, v20, v50
    v_mul_f32 v51, v20, v51
    v_mul_f32 v52, v20, v52
    v_mul_f32 v53, v20, v53
    v_mul_f32 v54, v20, v54
    v_mul_f32 v55, v20, v55
    v_cvt_pk_bf16_f32 v48, v48, v49
    v_cvt_pk_bf16_f32 v49, v50, v51
    v_cvt_pk_bf16_f32 v50, v52, v53
    v_cvt_pk_bf16_f32 v51, v54, v55
    buffer_store_dwordx4 v[48:51], v2, s[8:11], s90 offen offset:0 sc1
    v_accvgpr_read_b32 v56, a48
    v_accvgpr_read_b32 v57, a49
    v_accvgpr_read_b32 v58, a50
    v_accvgpr_read_b32 v59, a51
    v_accvgpr_read_b32 v60, a52
    v_accvgpr_read_b32 v61, a53
    v_accvgpr_read_b32 v62, a54
    v_accvgpr_read_b32 v63, a55
    v_mul_f32 v56, v21, v56
    v_mul_f32 v57, v21, v57
    v_mul_f32 v58, v21, v58
    v_mul_f32 v59, v21, v59
    v_mul_f32 v60, v21, v60
    v_mul_f32 v61, v21, v61
    v_mul_f32 v62, v21, v62
    v_mul_f32 v63, v21, v63
    v_cvt_pk_bf16_f32 v56, v56, v57
    v_cvt_pk_bf16_f32 v57, v58, v59
    v_cvt_pk_bf16_f32 v58, v60, v61
    v_cvt_pk_bf16_f32 v59, v62, v63
    buffer_store_dwordx4 v[56:59], v2, s[8:11], s90 offen offset:1024 sc1
    s_add_u32 s90, s90, 131072
    v_accvgpr_read_b32 v48, a24
    v_accvgpr_read_b32 v49, a25
    v_accvgpr_read_b32 v50, a26
    v_accvgpr_read_b32 v51, a27
    v_accvgpr_read_b32 v52, a28
    v_accvgpr_read_b32 v53, a29
    v_accvgpr_read_b32 v54, a30
    v_accvgpr_read_b32 v55, a31
    v_mul_f32 v48, v20, v48
    v_mul_f32 v49, v20, v49
    v_mul_f32 v50, v20, v50
    v_mul_f32 v51, v20, v51
    v_mul_f32 v52, v20, v52
    v_mul_f32 v53, v20, v53
    v_mul_f32 v54, v20, v54
    v_mul_f32 v55, v20, v55
    v_cvt_pk_bf16_f32 v48, v48, v49
    v_cvt_pk_bf16_f32 v49, v50, v51
    v_cvt_pk_bf16_f32 v50, v52, v53
    v_cvt_pk_bf16_f32 v51, v54, v55
    buffer_store_dwordx4 v[48:51], v2, s[8:11], s90 offen offset:0 sc1
    v_accvgpr_read_b32 v56, a56
    v_accvgpr_read_b32 v57, a57
    v_accvgpr_read_b32 v58, a58
    v_accvgpr_read_b32 v59, a59
    v_accvgpr_read_b32 v60, a60
    v_accvgpr_read_b32 v61, a61
    v_accvgpr_read_b32 v62, a62
    v_accvgpr_read_b32 v63, a63
    v_mul_f32 v56, v21, v56
    v_mul_f32 v57, v21, v57
    v_mul_f32 v58, v21, v58
    v_mul_f32 v59, v21, v59
    v_mul_f32 v60, v21, v60
    v_mul_f32 v61, v21, v61
    v_mul_f32 v62, v21, v62
    v_mul_f32 v63, v21, v63
    v_cvt_pk_bf16_f32 v56, v56, v57
    v_cvt_pk_bf16_f32 v57, v58, v59
    v_cvt_pk_bf16_f32 v58, v60, v61
    v_cvt_pk_bf16_f32 v59, v62, v63
    buffer_store_dwordx4 v[56:59], v2, s[8:11], s90 offen offset:1024 sc1
    s_add_u32 s90, s90, 131072
    v_and_b32 v48, 15, v1
    v_lshrrev_b32 v49, 4, v1
    v_lshlrev_b32 v49, 2, v49
    v_sub_u32 v48, v48, v49
    v_cmp_ge_i32 vcc, -9, v48
    v_subrev_u32 v50, 0, v48
    v_cmp_ge_u32 s[72:73], 7, v50
    s_nop 0
    v_cndmask_b32 v64, v9, 0, vcc
    v_cndmask_b32 v68, v9, 0, s[72:73]
    v_cmp_ge_i32 vcc, -8, v48
    v_subrev_u32 v50, 1, v48
    v_cmp_ge_u32 s[72:73], 7, v50
    s_nop 0
    v_cndmask_b32 v65, v9, 0, vcc
    v_cndmask_b32 v69, v9, 0, s[72:73]
    v_cmp_ge_i32 vcc, -7, v48
    v_subrev_u32 v50, 2, v48
    v_cmp_ge_u32 s[72:73], 7, v50
    s_nop 0
    v_cndmask_b32 v66, v9, 0, vcc
    v_cndmask_b32 v70, v9, 0, s[72:73]
    v_cmp_ge_i32 vcc, -6, v48
    v_subrev_u32 v50, 3, v48
    v_cmp_ge_u32 s[72:73], 7, v50
    s_nop 0
    v_cndmask_b32 v67, v9, 0, vcc
    v_cndmask_b32 v71, v9, 0, s[72:73]
    s_cmp_eq_u32 s77, 0
    s_cselect_b64 vcc, -1, 0
    s_nop 0
    v_cndmask_b32 v72, v64, v9, vcc
    v_cndmask_b32 v73, v65, v9, vcc
    v_cndmask_b32 v74, v66, v9, vcc
    v_cndmask_b32 v75, v67, v9, vcc
    s_waitcnt vmcnt(8)
    s_nop 0
    v_mfma_f32_16x16x32_bf16 v[80:83], v[208:211], v[192:195], v[72:75]
    v_mfma_f32_16x16x32_bf16 v[84:87], v[212:215], v[192:195], v[68:71]
    v_mfma_f32_16x16x32_bf16 v[88:91], v[212:215], v[196:199], v[64:67]
    v_mfma_f32_16x16x32_bf16 v[92:95], v[216:219], v[196:199], v[68:71]
    v_mfma_f32_16x16x32_bf16 v[96:99], v[216:219], v[200:203], v[64:67]
    v_mfma_f32_16x16x32_bf16 v[100:103], v[220:223], v[200:203], v[68:71]
    v_mfma_f32_16x16x32_bf16 v[104:107], v[220:223], v[204:207], v[64:67]
    v_mfma_f32_16x16x32_bf16 v[108:111], v[224:227], v[204:207], v[68:71]
    s_nop 7
    v_max3_f32 v112, v80, v81, v82
    v_max3_f32 v113, v88, v89, v90
    v_max3_f32 v114, v96, v97, v98
    v_max3_f32 v115, v104, v105, v106
    v_max3_f32 v112, v112, v83, v84
    v_max3_f32 v113, v113, v91, v92
    v_max3_f32 v114, v114, v99, v100
    v_max3_f32 v115, v115, v107, v108
    v_max3_f32 v112, v112, v85, v86
    v_max3_f32 v113, v113, v93, v94
    v_max3_f32 v114, v114, v101, v102
    v_max3_f32 v115, v115, v109, v110
    v_max_f32 v112, v112, v87
    v_max_f32 v113, v113, v95
    v_max_f32 v114, v114, v103
    v_max_f32 v115, v115, v111
    v_mov_b32 v116, v112
    v_mov_b32 v117, v113
    v_mov_b32 v118, v114
    v_mov_b32 v119, v115
    s_nop 1
    v_permlane32_swap_b32 v112, v116
    v_permlane32_swap_b32 v113, v117
    v_permlane32_swap_b32 v114, v118
    v_permlane32_swap_b32 v115, v119
    s_nop 1
    v_max_f32 v112, v112, v116
    v_max_f32 v113, v113, v117
    v_max_f32 v114, v114, v118
    v_max_f32 v115, v115, v119
    v_mov_b32 v116, v112
    v_mov_b32 v117, v113
    v_mov_b32 v118, v114
    v_mov_b32 v119, v115
    s_nop 1
    v_permlane16_swap_b32 v112, v116
    v_permlane16_swap_b32 v113, v117
    v_permlane16_swap_b32 v114, v118
    v_permlane16_swap_b32 v115, v119
    s_nop 1
    v_max_f32 v112, v112, v116
    v_max_f32 v113, v113, v117
    v_max_f32 v114, v114, v118
    v_max_f32 v115, v115, v119
    v_sub_f32 v80, v80, v112
    v_sub_f32 v81, v81, v112
    v_sub_f32 v82, v82, v112
    v_sub_f32 v83, v83, v112
    v_sub_f32 v84, v84, v112
    v_sub_f32 v85, v85, v112
    v_sub_f32 v86, v86, v112
    v_sub_f32 v87, v87, v112
    v_sub_f32 v88, v88, v113
    v_sub_f32 v89, v89, v113
    v_sub_f32 v90, v90, v113
    v_sub_f32 v91, v91, v113
    v_sub_f32 v92, v92, v113
    v_sub_f32 v93, v93, v113
    v_sub_f32 v94, v94, v113
    v_sub_f32 v95, v95, v113
    v_sub_f32 v96, v96, v114
    v_sub_f32 v97, v97, v114
    v_sub_f32 v98, v98, v114
    v_sub_f32 v99, v99, v114
    v_sub_f32 v100, v100, v114
    v_sub_f32 v101, v101, v114
    v_sub_f32 v102, v102, v114
    v_sub_f32 v103, v103, v114
    v_sub_f32 v104, v104, v115
    v_sub_f32 v105, v105, v115
    v_sub_f32 v106, v106, v115
    v_sub_f32 v107, v107, v115
    v_sub_f32 v108, v108, v115
    v_sub_f32 v109, v109, v115
    v_sub_f32 v110, v110, v115
    v_sub_f32 v111, v111, v115
    v_exp_f32 v80, v80
    v_exp_f32 v81, v81
    v_exp_f32 v82, v82
    v_exp_f32 v83, v83
    v_exp_f32 v84, v84
    v_exp_f32 v85, v85
    v_exp_f32 v86, v86
    v_exp_f32 v87, v87
    v_exp_f32 v88, v88
    v_exp_f32 v89, v89
    v_exp_f32 v90, v90
    v_exp_f32 v91, v91
    v_exp_f32 v92, v92
    v_exp_f32 v93, v93
    v_exp_f32 v94, v94
    v_exp_f32 v95, v95
    v_exp_f32 v96, v96
    v_exp_f32 v97, v97
    v_exp_f32 v98, v98
    v_exp_f32 v99, v99
    v_exp_f32 v100, v100
    v_exp_f32 v101, v101
    v_exp_f32 v102, v102
    v_exp_f32 v103, v103
    v_exp_f32 v104, v104
    v_exp_f32 v105, v105
    v_exp_f32 v106, v106
    v_exp_f32 v107, v107
    v_exp_f32 v108, v108
    v_exp_f32 v109, v109
    v_exp_f32 v110, v110
    v_exp_f32 v111, v111
    v_cvt_pk_bf16_f32 v192, v80, v81
    v_cvt_pk_bf16_f32 v193, v82, v83
    v_cvt_pk_bf16_f32 v194, v84, v85
    v_cvt_pk_bf16_f32 v195, v86, v87
    v_cvt_pk_bf16_f32 v196, v88, v89
    v_cvt_pk_bf16_f32 v197, v90, v91
    v_cvt_pk_bf16_f32 v198, v92, v93
    v_cvt_pk_bf16_f32 v199, v94, v95
    v_cvt_pk_bf16_f32 v200, v96, v97
    v_cvt_pk_bf16_f32 v201, v98, v99
    v_cvt_pk_bf16_f32 v202, v100, v101
    v_cvt_pk_bf16_f32 v203, v102, v103
    v_cvt_pk_bf16_f32 v204, v104, v105
    v_cvt_pk_bf16_f32 v205, v106, v107
    v_cvt_pk_bf16_f32 v206, v108, v109
    v_cvt_pk_bf16_f32 v207, v110, v111
    v_add_f32 v112, v80, v81
    v_add_f32 v113, v88, v89
    v_add_f32 v114, v96, v97
    v_add_f32 v115, v104, v105
    v_mfma_f32_16x16x32_bf16 v[128:131], v[230:233], v[192:195], 0
    v_mfma_f32_16x16x32_bf16 v[132:135], v[242:245], v[192:195], 0
    v_mfma_f32_16x16x32_bf16 v[136:139], v[232:235], v[196:199], 0
    v_mfma_f32_16x16x32_bf16 v[140:143], v[244:247], v[196:199], 0
    v_mfma_f32_16x16x32_bf16 v[144:147], v[234:237], v[200:203], 0
    v_mfma_f32_16x16x32_bf16 v[148:151], v[246:249], v[200:203], 0
    v_mfma_f32_16x16x32_bf16 v[152:155], v[236:239], v[204:207], 0
    v_mfma_f32_16x16x32_bf16 v[156:159], v[248:251], v[204:207], 0
    v_add_f32 v112, v112, v82
    v_add_f32 v113, v113, v90
    v_add_f32 v114, v114, v98
    v_add_f32 v115, v115, v106
    v_add_f32 v112, v112, v83
    v_add_f32 v113, v113, v91
    v_add_f32 v114, v114, v99
    v_add_f32 v115, v115, v107
    v_add_f32 v112, v112, v84
    v_add_f32 v113, v113, v92
    v_add_f32 v114, v114, v100
    v_add_f32 v115, v115, v108
    v_add_f32 v112, v112, v85
    v_add_f32 v113, v113, v93
    v_add_f32 v114, v114, v101
    v_add_f32 v115, v115, v109
    v_add_f32 v112, v112, v86
    v_add_f32 v113, v113, v94
    v_add_f32 v114, v114, v102
    v_add_f32 v115, v115, v110
    v_add_f32 v112, v112, v87
    v_add_f32 v113, v113, v95
    v_add_f32 v114, v114, v103
    v_add_f32 v115, v115, v111
    v_mov_b32 v116, v112
    v_mov_b32 v117, v113
    v_mov_b32 v118, v114
    v_mov_b32 v119, v115
    s_nop 1
    v_permlane32_swap_b32 v112, v116
    v_permlane32_swap_b32 v113, v117
    v_permlane32_swap_b32 v114, v118
    v_permlane32_swap_b32 v115, v119
    s_nop 1
    v_add_f32 v112, v112, v116
    v_add_f32 v113, v113, v117
    v_add_f32 v114, v114, v118
    v_add_f32 v115, v115, v119
    v_mov_b32 v116, v112
    v_mov_b32 v117, v113
    v_mov_b32 v118, v114
    v_mov_b32 v119, v115
    s_nop 1
    v_permlane16_swap_b32 v112, v116
    v_permlane16_swap_b32 v113, v117
    v_permlane16_swap_b32 v114, v118
    v_permlane16_swap_b32 v115, v119
    s_nop 1
    v_add_f32 v112, v112, v116
    v_add_f32 v113, v113, v117
    v_add_f32 v114, v114, v118
    v_add_f32 v115, v115, v119
    v_rcp_f32 v112, v112
    v_rcp_f32 v113, v113
    v_rcp_f32 v114, v114
    v_rcp_f32 v115, v115
    s_lshl_b32 s90, s76, 10
    s_lshr_b32 s91, s2, 3
    s_lshl_b32 s91, s91, 17
    s_add_u32 s90, s90, s91
    s_add_u32 s90, s90, 83886080
    v_mul_f32 v128, v128, v112
    v_mul_f32 v129, v129, v112
    v_mul_f32 v130, v130, v112
    v_mul_f32 v131, v131, v112
    v_mul_f32 v132, v132, v112
    v_mul_f32 v133, v133, v112
    v_mul_f32 v134, v134, v112
    v_mul_f32 v135, v135, v112
    v_cvt_pk_bf16_f32 v128, v128, v129
    v_cvt_pk_bf16_f32 v129, v130, v131
    v_cvt_pk_bf16_f32 v130, v132, v133
    v_cvt_pk_bf16_f32 v131, v134, v135
    buffer_store_dwordx4 v[128:131], v2, s[8:11], s90 offen offset:0 sc1
    v_mul_f32 v136, v136, v113
    v_mul_f32 v137, v137, v113
    v_mul_f32 v138, v138, v113
    v_mul_f32 v139, v139, v113
    v_mul_f32 v140, v140, v113
    v_mul_f32 v141, v141, v113
    v_mul_f32 v142, v142, v113
    v_mul_f32 v143, v143, v113
    v_cvt_pk_bf16_f32 v136, v136, v137
    v_cvt_pk_bf16_f32 v137, v138, v139
    v_cvt_pk_bf16_f32 v138, v140, v141
    v_cvt_pk_bf16_f32 v139, v142, v143
    buffer_store_dwordx4 v[136:139], v2, s[8:11], s90 offen offset:1024 sc1
    v_mul_f32 v144, v144, v114
    v_mul_f32 v145, v145, v114
    v_mul_f32 v146, v146, v114
    v_mul_f32 v147, v147, v114
    v_mul_f32 v148, v148, v114
    v_mul_f32 v149, v149, v114
    v_mul_f32 v150, v150, v114
    v_mul_f32 v151, v151, v114
    v_cvt_pk_bf16_f32 v144, v144, v145
    v_cvt_pk_bf16_f32 v145, v146, v147
    v_cvt_pk_bf16_f32 v146, v148, v149
    v_cvt_pk_bf16_f32 v147, v150, v151
    buffer_store_dwordx4 v[144:147], v2, s[8:11], s90 offen offset:2048 sc1
    v_mul_f32 v152, v152, v115
    v_mul_f32 v153, v153, v115
    v_mul_f32 v154, v154, v115
    v_mul_f32 v155, v155, v115
    v_mul_f32 v156, v156, v115
    v_mul_f32 v157, v157, v115
    v_mul_f32 v158, v158, v115
    v_mul_f32 v159, v159, v115
    v_cvt_pk_bf16_f32 v152, v152, v153
    v_cvt_pk_bf16_f32 v153, v154, v155
    v_cvt_pk_bf16_f32 v154, v156, v157
    v_cvt_pk_bf16_f32 v155, v158, v159
    buffer_store_dwordx4 v[152:155], v2, s[8:11], s90 offen offset:3072 sc1
mega_kernel_end1:
    s_endpgm
mega_kernel_stub72:
    v_cmp_lt_f32 vcc, s61, v8
    s_cmp_lg_u32 s60, s63
    s_cbranch_scc1 mega_kernel_e110
    v_add_f32 v176, v176, v16
    v_mov_b32 v180, v9
    v_add_f32 v188, v188, v16
    v_add_f32 v177, v177, v17
    v_mov_b32 v181, v9
    v_add_f32 v189, v189, v17
    v_add_f32 v178, v178, v18
    v_mov_b32 v182, v9
    v_add_f32 v190, v190, v18
    v_add_f32 v179, v179, v19
    v_mov_b32 v183, v9
    v_add_f32 v191, v191, v19
    s_nop 0
mega_kernel_e110:
    s_cmp_lg_u32 s60, s64
    s_cbranch_scc1 mega_kernel_e111
    v_mov_b32 v176, v9
    v_mov_b32 v184, v9
    v_mov_b32 v188, v9
    v_mov_b32 v177, v9
    v_mov_b32 v185, v9
    v_mov_b32 v189, v9
    v_mov_b32 v178, v9
    v_mov_b32 v186, v9
    v_mov_b32 v190, v9
    v_mov_b32 v179, v9
    v_mov_b32 v187, v9
    v_mov_b32 v191, v9
    s_nop 0
mega_kernel_e111:
    s_cbranch_vccnz mega_kernel_rc112
mega_kernel_sp109:
    s_branch mega_kernel_ret73
mega_kernel_stub75:
    v_cmp_lt_f32 vcc, s61, v8
    s_cmp_lg_u32 s60, s63
    s_cbranch_scc1 mega_kernel_e114
    v_add_f32 v176, v176, v16
    v_mov_b32 v180, v9
    v_add_f32 v188, v188, v16
    v_add_f32 v177, v177, v17
    v_mov_b32 v181, v9
    v_add_f32 v189, v189, v17
    v_add_f32 v178, v178, v18
    v_mov_b32 v182, v9
    v_add_f32 v190, v190, v18
    v_add_f32 v179, v179, v19
    v_mov_b32 v183, v9
    v_add_f32 v191, v191, v19
    s_nop 0
mega_kernel_e114:
    s_cmp_lg_u32 s60, s64
    s_cbranch_scc1 mega_kernel_e115
    v_mov_b32 v176, v9
    v_mov_b32 v184, v9
    v_mov_b32 v188, v9
    v_mov_b32 v177, v9
    v_mov_b32 v185, v9
    v_mov_b32 v189, v9
    v_mov_b32 v178, v9
    v_mov_b32 v186, v9
    v_mov_b32 v190, v9
    v_mov_b32 v179, v9
    v_mov_b32 v187, v9
    v_mov_b32 v191, v9
    s_nop 0
mega_kernel_e115:
    s_cbranch_vccnz mega_kernel_rc116
mega_kernel_sp113:
    s_branch mega_kernel_ret76
mega_kernel_stub89:
    v_cmp_lt_f32 vcc, s61, v8
    s_cmp_lg_u32 s60, s66
    s_cbranch_scc1 mega_kernel_e118
    v_add_f32 v160, v160, v16
    v_mov_b32 v164, v9
    v_add_f32 v172, v172, v16
    v_add_f32 v161, v161, v17
    v_mov_b32 v165, v9
    v_add_f32 v173, v173, v17
    v_add_f32 v162, v162, v18
    v_mov_b32 v166, v9
    v_add_f32 v174, v174, v18
    v_add_f32 v163, v163, v19
    v_mov_b32 v167, v9
    v_add_f32 v175, v175, v19
    s_nop 0
mega_kernel_e118:
    s_cmp_lg_u32 s60, s67
    s_cbranch_scc1 mega_kernel_e119
    v_mov_b32 v160, v9
    v_mov_b32 v168, v9
    v_mov_b32 v172, v9
    v_mov_b32 v161, v9
    v_mov_b32 v169, v9
    v_mov_b32 v173, v9
    v_mov_b32 v162, v9
    v_mov_b32 v170, v9
    v_mov_b32 v174, v9
    v_mov_b32 v163, v9
    v_mov_b32 v171, v9
    v_mov_b32 v175, v9
    s_nop 0
mega_kernel_e119:
    s_cbranch_vccnz mega_kernel_rc120
mega_kernel_sp117:
    s_branch mega_kernel_ret90
mega_kernel_stub91:
    v_cmp_lt_f32 vcc, s61, v8
    s_cmp_lg_u32 s60, s66
    s_cbranch_scc1 mega_kernel_e122
    v_add_f32 v160, v160, v16
    v_mov_b32 v164, v9
    v_add_f32 v172, v172, v16
    v_add_f32 v161, v161, v17
    v_mov_b32 v165, v9
    v_add_f32 v173, v173, v17
    v_add_f32 v162, v162, v18
    v_mov_b32 v166, v9
    v_add_f32 v174, v174, v18
    v_add_f32 v163, v163, v19
    v_mov_b32 v167, v9
    v_add_f32 v175, v175, v19
    s_nop 0
mega_kernel_e122:
    s_cmp_lg_u32 s60, s67
    s_cbranch_scc1 mega_kernel_e123
    v_mov_b32 v160, v9
    v_mov_b32 v168, v9
    v_mov_b32 v172, v9
    v_mov_b32 v161, v9
    v_mov_b32 v169, v9
    v_mov_b32 v173, v9
    v_mov_b32 v162, v9
    v_mov_b32 v170, v9
    v_mov_b32 v174, v9
    v_mov_b32 v163, v9
    v_mov_b32 v171, v9
    v_mov_b32 v175, v9
    s_nop 0
mega_kernel_e123:
    s_cmp_lg_u32 s60, s52
    s_cbranch_scc1 mega_kernel_e125
    v_lshrrev_b32 v62, 3, v1
    v_lshlrev_b32 v62, 11, v62
    v_and_b32 v61, 7, v1
    v_lshl_add_u32 v62, v61, 7, v62
    s_lshr_b32 s90, s2, 3
    s_lshl_b32 s90, s90, 2
    s_add_u32 s90, s90, s16
    s_lshl_b32 s90, s90, 14
    s_and_b32 s91, s2, 1
    s_lshl_b32 s91, s91, 10
    s_add_u32 s90, s90, s91
    s_bitcmp1_b32 s2, 2
    s_cselect_b32 s91, 0, 5373952
    s_mov_b32 s92, 8388608
    s_cselect_b32 s46, 5373952, s92
    s_cselect_b32 s93, 0, 2097152
    s_add_u32 s91, s91, s90
    s_mov_b32 s44, s48
    s_mov_b32 s45, s49
    s_add_u32 s92, s91, 0
    buffer_load_dword v255, v62, s[44:47], s92 offen
    s_add_u32 s92, s91, 2097152
    buffer_load_dword v255, v62, s[44:47], s92 offen
    s_add_u32 s92, s91, 4194304
    buffer_load_dword v255, v62, s[44:47], s92 offen
    s_mov_b32 s44, s50
    s_mov_b32 s45, s51
    s_mov_b32 s46, s93
    buffer_load_dword v255, v62, s[44:47], s90 offen
mega_kernel_e125:
    s_cmp_gt_u32 s60, 26
    s_cbranch_scc1 mega_kernel_e124
    s_cmp_lg_u32 s60, 6
    s_cbranch_scc1 mega_kernel_e126
    s_cmp_eq_u32 s17, -1
    s_cbranch_scc1 mega_kernel_e124
    s_cmp_lg_u32 s16, 0
    s_cbranch_scc1 mega_kernel_np127
    v_mov_b32 v4, s4
    v_mov_b32 v5, s5
    s_add_u32 s90, s17, 117440512
    s_mov_b64 exec, 1
    buffer_store_dwordx2 v[4:5], off, s[8:11], s90 sc1
    s_mov_b64 exec, -1
mega_kernel_np127:
    s_branch mega_kernel_e124
mega_kernel_e126:
    s_cmp_lg_u32 s60, 22
    s_cbranch_scc1 mega_kernel_e128
    buffer_load_dwordx2 v[4:5], v10, s[8:11], 0 offen sc1
    s_mov_b32 s44, s48
    s_mov_b32 s45, s49
    s_mov_b32 s46, 8388608
    s_lshl_b32 s90, s2, 2
    s_add_u32 s90, s90, s16
    s_lshl_b32 s90, s90, 13
    v_lshlrev_b32 v62, 7, v1
    buffer_load_dword v255, v62, s[44:47], s90 offen
    s_branch mega_kernel_e124
mega_kernel_e128:
    s_cmp_lg_u32 s60, 26
    s_cbranch_scc1 mega_kernel_e129
    s_mov_b32 s44, s50
    s_mov_b32 s45, s51
    s_mov_b32 s46, 2097152
    s_lshl_b32 s90, s2, 2
    s_add_u32 s90, s90, s16
    s_lshl_b32 s90, s90, 13
    v_lshlrev_b32 v62, 7, v1
    buffer_load_dword v255, v62, s[44:47], s90 offen
    s_waitcnt vmcnt(18)
    s_mov_b32 s3, 1048576
mega_kernel_spin130:
    v_cmp_ne_u64 s[72:73], s[4:5], v[4:5]
    s_nop 3
    s_cmp_eq_u64 s[72:73], 0
    s_cbranch_scc1 mega_kernel_e124
    s_sub_u32 s3, s3, 1
    s_cbranch_scc1 mega_kernel_e124
    s_sleep 32
    buffer_load_dwordx2 v[4:5], v10, s[8:11], 0 offen sc1
    s_waitcnt vmcnt(0)
    s_branch mega_kernel_spin130
    s_branch mega_kernel_e124
mega_kernel_e129:
mega_kernel_e124:
    s_cbranch_vccnz mega_kernel_rc131
mega_kernel_sp121:
    s_branch mega_kernel_ret92
mega_kernel_stub94:
    v_cmp_lt_f32 vcc, s61, v8
    s_cmp_lg_u32 s60, s66
    s_cbranch_scc1 mega_kernel_e133
    v_add_f32 v160, v160, v16
    v_mov_b32 v164, v9
    v_add_f32 v172, v172, v16
    v_add_f32 v161, v161, v17
    v_mov_b32 v165, v9
    v_add_f32 v173, v173, v17
    v_add_f32 v162, v162, v18
    v_mov_b32 v166, v9
    v_add_f32 v174, v174, v18
    v_add_f32 v163, v163, v19
    v_mov_b32 v167, v9
    v_add_f32 v175, v175, v19
    s_nop 0
mega_kernel_e133:
    s_cmp_lg_u32 s60, s67
    s_cbranch_scc1 mega_kernel_e134
    v_mov_b32 v160, v9
    v_mov_b32 v168, v9
    v_mov_b32 v172, v9
    v_mov_b32 v161, v9
    v_mov_b32 v169, v9
    v_mov_b32 v173, v9
    v_mov_b32 v162, v9
    v_mov_b32 v170, v9
    v_mov_b32 v174, v9
    v_mov_b32 v163, v9
    v_mov_b32 v171, v9
    v_mov_b32 v175, v9
    s_nop 0
mega_kernel_e134:
    s_cbranch_vccnz mega_kernel_rc135
mega_kernel_sp132:
    s_branch mega_kernel_ret95
mega_kernel_stub107:
    v_cmp_lt_f32 vcc, s61, v8
    s_cbranch_vccnz mega_kernel_rc137
mega_kernel_sp136:
    s_branch mega_kernel_ret108
mega_kernel_rc88:
    s_call_b64 s[70:71], mega_kernel_rs0466
    s_branch mega_kernel_sp77
mega_kernel_rc106:
    s_call_b64 s[70:71], mega_kernel_rs0265
    s_branch mega_kernel_sp96
mega_kernel_rc112:
    s_call_b64 s[70:71], mega_kernel_rs0466
    s_branch mega_kernel_sp109
mega_kernel_rc116:
    s_call_b64 s[70:71], mega_kernel_rs1468
    s_branch mega_kernel_sp113
mega_kernel_rc120:
    s_call_b64 s[70:71], mega_kernel_rs1468
    s_branch mega_kernel_sp117
mega_kernel_rc131:
    s_call_b64 s[70:71], mega_kernel_rs0265
    s_branch mega_kernel_sp121
mega_kernel_rc135:
    s_call_b64 s[70:71], mega_kernel_rs1267
    s_branch mega_kernel_sp132
mega_kernel_rc137:
    s_call_b64 s[70:71], mega_kernel_rs1267
    s_branch mega_kernel_sp136
mega_kernel_rs0265:
    s_nop 15
    v_max3_f32 v48, v64, v65, v66
    v_max3_f32 v48, v48, v67, v68
    v_max3_f32 v48, v48, v69, v70
    v_max3_f32 v48, v48, v71, 0
    v_mov_b32 v49, v48
    s_nop 1
    v_permlane32_swap_b32 v48, v49
    s_nop 1
    v_max_f32 v48, v48, v49
    v_mov_b32 v49, v48
    s_nop 1
    v_permlane16_swap_b32 v48, v49
    s_nop 1
    v_max_f32 v48, v48, v49
    v_exp_f32 v49, -v48
    v_sub_f32 v64, v64, v48
    v_sub_f32 v65, v65, v48
    v_sub_f32 v66, v66, v48
    v_sub_f32 v67, v67, v48
    v_sub_f32 v68, v68, v48
    v_sub_f32 v69, v69, v48
    v_sub_f32 v70, v70, v48
    v_sub_f32 v71, v71, v48
    v_sub_f32 v96, v96, v48
    v_sub_f32 v97, v97, v48
    v_sub_f32 v98, v98, v48
    v_sub_f32 v99, v99, v48
    v_sub_f32 v100, v100, v48
    v_sub_f32 v101, v101, v48
    v_sub_f32 v102, v102, v48
    v_sub_f32 v103, v103, v48
    v_sub_f32 v160, v160, v48
    v_sub_f32 v161, v161, v48
    v_sub_f32 v162, v162, v48
    v_sub_f32 v163, v163, v48
    v_sub_f32 v164, v164, v48
    v_sub_f32 v165, v165, v48
    v_sub_f32 v166, v166, v48
    v_sub_f32 v167, v167, v48
    v_mul_f32 v12, v12, v49
    v_accvgpr_read_b32 v52, a0
    v_accvgpr_read_b32 v53, a1
    v_accvgpr_read_b32 v54, a2
    v_accvgpr_read_b32 v55, a3
    v_accvgpr_read_b32 v56, a4
    v_accvgpr_read_b32 v57, a5
    v_accvgpr_read_b32 v58, a6
    v_accvgpr_read_b32 v59, a7
    v_mul_f32 v52, v52, v49
    v_mul_f32 v53, v53, v49
    v_mul_f32 v54, v54, v49
    v_mul_f32 v55, v55, v49
    v_mul_f32 v56, v56, v49
    v_mul_f32 v57, v57, v49
    v_mul_f32 v58, v58, v49
    v_mul_f32 v59, v59, v49
    v_accvgpr_write_b32 a0, v52
    v_accvgpr_write_b32 a1, v53
    v_accvgpr_write_b32 a2, v54
    v_accvgpr_write_b32 a3, v55
    v_accvgpr_write_b32 a4, v56
    v_accvgpr_write_b32 a5, v57
    v_accvgpr_write_b32 a6, v58
    v_accvgpr_write_b32 a7, v59
    v_accvgpr_read_b32 v52, a8
    v_accvgpr_read_b32 v53, a9
    v_accvgpr_read_b32 v54, a10
    v_accvgpr_read_b32 v55, a11
    v_accvgpr_read_b32 v56, a12
    v_accvgpr_read_b32 v57, a13
    v_accvgpr_read_b32 v58, a14
    v_accvgpr_read_b32 v59, a15
    v_mul_f32 v52, v52, v49
    v_mul_f32 v53, v53, v49
    v_mul_f32 v54, v54, v49
    v_mul_f32 v55, v55, v49
    v_mul_f32 v56, v56, v49
    v_mul_f32 v57, v57, v49
    v_mul_f32 v58, v58, v49
    v_mul_f32 v59, v59, v49
    v_accvgpr_write_b32 a8, v52
    v_accvgpr_write_b32 a9, v53
    v_accvgpr_write_b32 a10, v54
    v_accvgpr_write_b32 a11, v55
    v_accvgpr_write_b32 a12, v56
    v_accvgpr_write_b32 a13, v57
    v_accvgpr_write_b32 a14, v58
    v_accvgpr_write_b32 a15, v59
    v_accvgpr_read_b32 v52, a16
    v_accvgpr_read_b32 v53, a17
    v_accvgpr_read_b32 v54, a18
    v_accvgpr_read_b32 v55, a19
    v_accvgpr_read_b32 v56, a20
    v_accvgpr_read_b32 v57, a21
    v_accvgpr_read_b32 v58, a22
    v_accvgpr_read_b32 v59, a23
    v_mul_f32 v52, v52, v49
    v_mul_f32 v53, v53, v49
    v_mul_f32 v54, v54, v49
    v_mul_f32 v55, v55, v49
    v_mul_f32 v56, v56, v49
    v_mul_f32 v57, v57, v49
    v_mul_f32 v58, v58, v49
    v_mul_f32 v59, v59, v49
    v_accvgpr_write_b32 a16, v52
    v_accvgpr_write_b32 a17, v53
    v_accvgpr_write_b32 a18, v54
    v_accvgpr_write_b32 a19, v55
    v_accvgpr_write_b32 a20, v56
    v_accvgpr_write_b32 a21, v57
    v_accvgpr_write_b32 a22, v58
    v_accvgpr_write_b32 a23, v59
    v_accvgpr_read_b32 v52, a24
    v_accvgpr_read_b32 v53, a25
    v_accvgpr_read_b32 v54, a26
    v_accvgpr_read_b32 v55, a27
    v_accvgpr_read_b32 v56, a28
    v_accvgpr_read_b32 v57, a29
    v_accvgpr_read_b32 v58, a30
    v_accvgpr_read_b32 v59, a31
    v_mul_f32 v52, v52, v49
    v_mul_f32 v53, v53, v49
    v_mul_f32 v54, v54, v49
    v_mul_f32 v55, v55, v49
    v_mul_f32 v56, v56, v49
    v_mul_f32 v57, v57, v49
    v_mul_f32 v58, v58, v49
    v_mul_f32 v59, v59, v49
    v_accvgpr_write_b32 a24, v52
    v_accvgpr_write_b32 a25, v53
    v_accvgpr_write_b32 a26, v54
    v_accvgpr_write_b32 a27, v55
    v_accvgpr_write_b32 a28, v56
    v_accvgpr_write_b32 a29, v57
    v_accvgpr_write_b32 a30, v58
    v_accvgpr_write_b32 a31, v59
    v_exp_f32 v52, v64
    v_exp_f32 v53, v65
    v_exp_f32 v54, v66
    v_exp_f32 v55, v67
    v_exp_f32 v56, v68
    v_exp_f32 v57, v69
    v_exp_f32 v58, v70
    v_exp_f32 v59, v71
    s_nop 0
    v_cvt_pk_bf16_f32 v128, v52, v53
    v_cvt_pk_bf16_f32 v129, v54, v55
    v_cvt_pk_bf16_f32 v130, v56, v57
    v_cvt_pk_bf16_f32 v131, v58, v59
    s_nop 1
    v_mfma_f32_16x16x32_bf16 v[28:31], v[44:47], v[128:131], 0
    v_max3_f32 v48, v72, v73, v74
    v_max3_f32 v48, v48, v75, v76
    v_max3_f32 v48, v48, v77, v78
    v_max3_f32 v48, v48, v79, 0
    v_mov_b32 v49, v48
    s_nop 1
    v_permlane32_swap_b32 v48, v49
    s_nop 1
    v_max_f32 v48, v48, v49
    v_mov_b32 v49, v48
    s_nop 1
    v_permlane16_swap_b32 v48, v49
    s_nop 1
    v_max_f32 v48, v48, v49
    v_exp_f32 v49, -v48
    v_sub_f32 v72, v72, v48
    v_sub_f32 v73, v73, v48
    v_sub_f32 v74, v74, v48
    v_sub_f32 v75, v75, v48
    v_sub_f32 v76, v76, v48
    v_sub_f32 v77, v77, v48
    v_sub_f32 v78, v78, v48
    v_sub_f32 v79, v79, v48
    v_sub_f32 v104, v104, v48
    v_sub_f32 v105, v105, v48
    v_sub_f32 v106, v106, v48
    v_sub_f32 v107, v107, v48
    v_sub_f32 v108, v108, v48
    v_sub_f32 v109, v109, v48
    v_sub_f32 v110, v110, v48
    v_sub_f32 v111, v111, v48
    v_sub_f32 v168, v168, v48
    v_sub_f32 v169, v169, v48
    v_sub_f32 v170, v170, v48
    v_sub_f32 v171, v171, v48
    v_sub_f32 v172, v172, v48
    v_sub_f32 v173, v173, v48
    v_sub_f32 v174, v174, v48
    v_sub_f32 v175, v175, v48
    v_mul_f32 v13, v13, v49
    v_accvgpr_read_b32 v52, a32
    v_accvgpr_read_b32 v53, a33
    v_accvgpr_read_b32 v54, a34
    v_accvgpr_read_b32 v55, a35
    v_accvgpr_read_b32 v56, a36
    v_accvgpr_read_b32 v57, a37
    v_accvgpr_read_b32 v58, a38
    v_accvgpr_read_b32 v59, a39
    v_mul_f32 v52, v52, v49
    v_mul_f32 v53, v53, v49
    v_mul_f32 v54, v54, v49
    v_mul_f32 v55, v55, v49
    v_mul_f32 v56, v56, v49
    v_mul_f32 v57, v57, v49
    v_mul_f32 v58, v58, v49
    v_mul_f32 v59, v59, v49
    v_accvgpr_write_b32 a32, v52
    v_accvgpr_write_b32 a33, v53
    v_accvgpr_write_b32 a34, v54
    v_accvgpr_write_b32 a35, v55
    v_accvgpr_write_b32 a36, v56
    v_accvgpr_write_b32 a37, v57
    v_accvgpr_write_b32 a38, v58
    v_accvgpr_write_b32 a39, v59
    v_accvgpr_read_b32 v52, a40
    v_accvgpr_read_b32 v53, a41
    v_accvgpr_read_b32 v54, a42
    v_accvgpr_read_b32 v55, a43
    v_accvgpr_read_b32 v56, a44
    v_accvgpr_read_b32 v57, a45
    v_accvgpr_read_b32 v58, a46
    v_accvgpr_read_b32 v59, a47
    v_mul_f32 v52, v52, v49
    v_mul_f32 v53, v53, v49
    v_mul_f32 v54, v54, v49
    v_mul_f32 v55, v55, v49
    v_mul_f32 v56, v56, v49
    v_mul_f32 v57, v57, v49
    v_mul_f32 v58, v58, v49
    v_mul_f32 v59, v59, v49
    v_accvgpr_write_b32 a40, v52
    v_accvgpr_write_b32 a41, v53
    v_accvgpr_write_b32 a42, v54
    v_accvgpr_write_b32 a43, v55
    v_accvgpr_write_b32 a44, v56
    v_accvgpr_write_b32 a45, v57
    v_accvgpr_write_b32 a46, v58
    v_accvgpr_write_b32 a47, v59
    v_accvgpr_read_b32 v52, a48
    v_accvgpr_read_b32 v53, a49
    v_accvgpr_read_b32 v54, a50
    v_accvgpr_read_b32 v55, a51
    v_accvgpr_read_b32 v56, a52
    v_accvgpr_read_b32 v57, a53
    v_accvgpr_read_b32 v58, a54
    v_accvgpr_read_b32 v59, a55
    v_mul_f32 v52, v52, v49
    v_mul_f32 v53, v53, v49
    v_mul_f32 v54, v54, v49
    v_mul_f32 v55, v55, v49
    v_mul_f32 v56, v56, v49
    v_mul_f32 v57, v57, v49
    v_mul_f32 v58, v58, v49
    v_mul_f32 v59, v59, v49
    v_accvgpr_write_b32 a48, v52
    v_accvgpr_write_b32 a49, v53
    v_accvgpr_write_b32 a50, v54
    v_accvgpr_write_b32 a51, v55
    v_accvgpr_write_b32 a52, v56
    v_accvgpr_write_b32 a53, v57
    v_accvgpr_write_b32 a54, v58
    v_accvgpr_write_b32 a55, v59
    v_accvgpr_read_b32 v52, a56
    v_accvgpr_read_b32 v53, a57
    v_accvgpr_read_b32 v54, a58
    v_accvgpr_read_b32 v55, a59
    v_accvgpr_read_b32 v56, a60
    v_accvgpr_read_b32 v57, a61
    v_accvgpr_read_b32 v58, a62
    v_accvgpr_read_b32 v59, a63
    v_mul_f32 v52, v52, v49
    v_mul_f32 v53, v53, v49
    v_mul_f32 v54, v54, v49
    v_mul_f32 v55, v55, v49
    v_mul_f32 v56, v56, v49
    v_mul_f32 v57, v57, v49
    v_mul_f32 v58, v58, v49
    v_mul_f32 v59, v59, v49
    v_accvgpr_write_b32 a56, v52
    v_accvgpr_write_b32 a57, v53
    v_accvgpr_write_b32 a58, v54
    v_accvgpr_write_b32 a59, v55
    v_accvgpr_write_b32 a60, v56
    v_accvgpr_write_b32 a61, v57
    v_accvgpr_write_b32 a62, v58
    v_accvgpr_write_b32 a63, v59
    v_exp_f32 v52, v72
    v_exp_f32 v53, v73
    v_exp_f32 v54, v74
    v_exp_f32 v55, v75
    v_exp_f32 v56, v76
    v_exp_f32 v57, v77
    v_exp_f32 v58, v78
    v_exp_f32 v59, v79
    s_nop 0
    v_cvt_pk_bf16_f32 v132, v52, v53
    v_cvt_pk_bf16_f32 v133, v54, v55
    v_cvt_pk_bf16_f32 v134, v56, v57
    v_cvt_pk_bf16_f32 v135, v58, v59
    s_nop 1
    v_mfma_f32_16x16x32_bf16 v[32:35], v[44:47], v[132:135], 0
    s_nop 7
    s_setpc_b64 s[70:71]
mega_kernel_rs0466:
    s_nop 15
    v_max3_f32 v48, v64, v65, v66
    v_max3_f32 v48, v48, v67, v68
    v_max3_f32 v48, v48, v69, v70
    v_max3_f32 v48, v48, v71, 0
    v_mov_b32 v49, v48
    s_nop 1
    v_permlane32_swap_b32 v48, v49
    s_nop 1
    v_max_f32 v48, v48, v49
    v_mov_b32 v49, v48
    s_nop 1
    v_permlane16_swap_b32 v48, v49
    s_nop 1
    v_max_f32 v48, v48, v49
    v_exp_f32 v49, -v48
    v_sub_f32 v64, v64, v48
    v_sub_f32 v65, v65, v48
    v_sub_f32 v66, v66, v48
    v_sub_f32 v67, v67, v48
    v_sub_f32 v68, v68, v48
    v_sub_f32 v69, v69, v48
    v_sub_f32 v70, v70, v48
    v_sub_f32 v71, v71, v48
    v_sub_f32 v96, v96, v48
    v_sub_f32 v97, v97, v48
    v_sub_f32 v98, v98, v48
    v_sub_f32 v99, v99, v48
    v_sub_f32 v100, v100, v48
    v_sub_f32 v101, v101, v48
    v_sub_f32 v102, v102, v48
    v_sub_f32 v103, v103, v48
    v_sub_f32 v160, v160, v48
    v_sub_f32 v161, v161, v48
    v_sub_f32 v162, v162, v48
    v_sub_f32 v163, v163, v48
    v_sub_f32 v164, v164, v48
    v_sub_f32 v165, v165, v48
    v_sub_f32 v166, v166, v48
    v_sub_f32 v167, v167, v48
    v_mul_f32 v12, v12, v49
    v_accvgpr_read_b32 v52, a0
    v_accvgpr_read_b32 v53, a1
    v_accvgpr_read_b32 v54, a2
    v_accvgpr_read_b32 v55, a3
    v_accvgpr_read_b32 v56, a4
    v_accvgpr_read_b32 v57, a5
    v_accvgpr_read_b32 v58, a6
    v_accvgpr_read_b32 v59, a7
    v_mul_f32 v52, v52, v49
    v_mul_f32 v53, v53, v49
    v_mul_f32 v54, v54, v49
    v_mul_f32 v55, v55, v49
    v_mul_f32 v56, v56, v49
    v_mul_f32 v57, v57, v49
    v_mul_f32 v58, v58, v49
    v_mul_f32 v59, v59, v49
    v_accvgpr_write_b32 a0, v52
    v_accvgpr_write_b32 a1, v53
    v_accvgpr_write_b32 a2, v54
    v_accvgpr_write_b32 a3, v55
    v_accvgpr_write_b32 a4, v56
    v_accvgpr_write_b32 a5, v57
    v_accvgpr_write_b32 a6, v58
    v_accvgpr_write_b32 a7, v59
    v_accvgpr_read_b32 v52, a8
    v_accvgpr_read_b32 v53, a9
    v_accvgpr_read_b32 v54, a10
    v_accvgpr_read_b32 v55, a11
    v_accvgpr_read_b32 v56, a12
    v_accvgpr_read_b32 v57, a13
    v_accvgpr_read_b32 v58, a14
    v_accvgpr_read_b32 v59, a15
    v_mul_f32 v52, v52, v49
    v_mul_f32 v53, v53, v49
    v_mul_f32 v54, v54, v49
    v_mul_f32 v55, v55, v49
    v_mul_f32 v56, v56, v49
    v_mul_f32 v57, v57, v49
    v_mul_f32 v58, v58, v49
    v_mul_f32 v59, v59, v49
    v_accvgpr_write_b32 a8, v52
    v_accvgpr_write_b32 a9, v53
    v_accvgpr_write_b32 a10, v54
    v_accvgpr_write_b32 a11, v55
    v_accvgpr_write_b32 a12, v56
    v_accvgpr_write_b32 a13, v57
    v_accvgpr_write_b32 a14, v58
    v_accvgpr_write_b32 a15, v59
    v_accvgpr_read_b32 v52, a16
    v_accvgpr_read_b32 v53, a17
    v_accvgpr_read_b32 v54, a18
    v_accvgpr_read_b32 v55, a19
    v_accvgpr_read_b32 v56, a20
    v_accvgpr_read_b32 v57, a21
    v_accvgpr_read_b32 v58, a22
    v_accvgpr_read_b32 v59, a23
    v_mul_f32 v52, v52, v49
    v_mul_f32 v53, v53, v49
    v_mul_f32 v54, v54, v49
    v_mul_f32 v55, v55, v49
    v_mul_f32 v56, v56, v49
    v_mul_f32 v57, v57, v49
    v_mul_f32 v58, v58, v49
    v_mul_f32 v59, v59, v49
    v_accvgpr_write_b32 a16, v52
    v_accvgpr_write_b32 a17, v53
    v_accvgpr_write_b32 a18, v54
    v_accvgpr_write_b32 a19, v55
    v_accvgpr_write_b32 a20, v56
    v_accvgpr_write_b32 a21, v57
    v_accvgpr_write_b32 a22, v58
    v_accvgpr_write_b32 a23, v59
    v_accvgpr_read_b32 v52, a24
    v_accvgpr_read_b32 v53, a25
    v_accvgpr_read_b32 v54, a26
    v_accvgpr_read_b32 v55, a27
    v_accvgpr_read_b32 v56, a28
    v_accvgpr_read_b32 v57, a29
    v_accvgpr_read_b32 v58, a30
    v_accvgpr_read_b32 v59, a31
    v_mul_f32 v52, v52, v49
    v_mul_f32 v53, v53, v49
    v_mul_f32 v54, v54, v49
    v_mul_f32 v55, v55, v49
    v_mul_f32 v56, v56, v49
    v_mul_f32 v57, v57, v49
    v_mul_f32 v58, v58, v49
    v_mul_f32 v59, v59, v49
    v_accvgpr_write_b32 a24, v52
    v_accvgpr_write_b32 a25, v53
    v_accvgpr_write_b32 a26, v54
    v_accvgpr_write_b32 a27, v55
    v_accvgpr_write_b32 a28, v56
    v_accvgpr_write_b32 a29, v57
    v_accvgpr_write_b32 a30, v58
    v_accvgpr_write_b32 a31, v59
    v_exp_f32 v52, v64
    v_exp_f32 v53, v65
    v_exp_f32 v54, v66
    v_exp_f32 v55, v67
    v_exp_f32 v56, v68
    v_exp_f32 v57, v69
    v_exp_f32 v58, v70
    v_exp_f32 v59, v71
    s_nop 0
    v_cvt_pk_bf16_f32 v128, v52, v53
    v_cvt_pk_bf16_f32 v129, v54, v55
    v_cvt_pk_bf16_f32 v130, v56, v57
    v_cvt_pk_bf16_f32 v131, v58, v59
    s_nop 1
    v_mfma_f32_16x16x32_bf16 v[28:31], v[44:47], v[128:131], 0
    v_max3_f32 v48, v72, v73, v74
    v_max3_f32 v48, v48, v75, v76
    v_max3_f32 v48, v48, v77, v78
    v_max3_f32 v48, v48, v79, 0
    v_mov_b32 v49, v48
    s_nop 1
    v_permlane32_swap_b32 v48, v49
    s_nop 1
    v_max_f32 v48, v48, v49
    v_mov_b32 v49, v48
    s_nop 1
    v_permlane16_swap_b32 v48, v49
    s_nop 1
    v_max_f32 v48, v48, v49
    v_exp_f32 v49, -v48
    v_sub_f32 v72, v72, v48
    v_sub_f32 v73, v73, v48
    v_sub_f32 v74, v74, v48
    v_sub_f32 v75, v75, v48
    v_sub_f32 v76, v76, v48
    v_sub_f32 v77, v77, v48
    v_sub_f32 v78, v78, v48
    v_sub_f32 v79, v79, v48
    v_sub_f32 v104, v104, v48
    v_sub_f32 v105, v105, v48
    v_sub_f32 v106, v106, v48
    v_sub_f32 v107, v107, v48
    v_sub_f32 v108, v108, v48
    v_sub_f32 v109, v109, v48
    v_sub_f32 v110, v110, v48
    v_sub_f32 v111, v111, v48
    v_sub_f32 v168, v168, v48
    v_sub_f32 v169, v169, v48
    v_sub_f32 v170, v170, v48
    v_sub_f32 v171, v171, v48
    v_sub_f32 v172, v172, v48
    v_sub_f32 v173, v173, v48
    v_sub_f32 v174, v174, v48
    v_sub_f32 v175, v175, v48
    v_mul_f32 v13, v13, v49
    v_accvgpr_read_b32 v52, a32
    v_accvgpr_read_b32 v53, a33
    v_accvgpr_read_b32 v54, a34
    v_accvgpr_read_b32 v55, a35
    v_accvgpr_read_b32 v56, a36
    v_accvgpr_read_b32 v57, a37
    v_accvgpr_read_b32 v58, a38
    v_accvgpr_read_b32 v59, a39
    v_mul_f32 v52, v52, v49
    v_mul_f32 v53, v53, v49
    v_mul_f32 v54, v54, v49
    v_mul_f32 v55, v55, v49
    v_mul_f32 v56, v56, v49
    v_mul_f32 v57, v57, v49
    v_mul_f32 v58, v58, v49
    v_mul_f32 v59, v59, v49
    v_accvgpr_write_b32 a32, v52
    v_accvgpr_write_b32 a33, v53
    v_accvgpr_write_b32 a34, v54
    v_accvgpr_write_b32 a35, v55
    v_accvgpr_write_b32 a36, v56
    v_accvgpr_write_b32 a37, v57
    v_accvgpr_write_b32 a38, v58
    v_accvgpr_write_b32 a39, v59
    v_accvgpr_read_b32 v52, a40
    v_accvgpr_read_b32 v53, a41
    v_accvgpr_read_b32 v54, a42
    v_accvgpr_read_b32 v55, a43
    v_accvgpr_read_b32 v56, a44
    v_accvgpr_read_b32 v57, a45
    v_accvgpr_read_b32 v58, a46
    v_accvgpr_read_b32 v59, a47
    v_mul_f32 v52, v52, v49
    v_mul_f32 v53, v53, v49
    v_mul_f32 v54, v54, v49
    v_mul_f32 v55, v55, v49
    v_mul_f32 v56, v56, v49
    v_mul_f32 v57, v57, v49
    v_mul_f32 v58, v58, v49
    v_mul_f32 v59, v59, v49
    v_accvgpr_write_b32 a40, v52
    v_accvgpr_write_b32 a41, v53
    v_accvgpr_write_b32 a42, v54
    v_accvgpr_write_b32 a43, v55
    v_accvgpr_write_b32 a44, v56
    v_accvgpr_write_b32 a45, v57
    v_accvgpr_write_b32 a46, v58
    v_accvgpr_write_b32 a47, v59
    v_accvgpr_read_b32 v52, a48
    v_accvgpr_read_b32 v53, a49
    v_accvgpr_read_b32 v54, a50
    v_accvgpr_read_b32 v55, a51
    v_accvgpr_read_b32 v56, a52
    v_accvgpr_read_b32 v57, a53
    v_accvgpr_read_b32 v58, a54
    v_accvgpr_read_b32 v59, a55
    v_mul_f32 v52, v52, v49
    v_mul_f32 v53, v53, v49
    v_mul_f32 v54, v54, v49
    v_mul_f32 v55, v55, v49
    v_mul_f32 v56, v56, v49
    v_mul_f32 v57, v57, v49
    v_mul_f32 v58, v58, v49
    v_mul_f32 v59, v59, v49
    v_accvgpr_write_b32 a48, v52
    v_accvgpr_write_b32 a49, v53
    v_accvgpr_write_b32 a50, v54
    v_accvgpr_write_b32 a51, v55
    v_accvgpr_write_b32 a52, v56
    v_accvgpr_write_b32 a53, v57
    v_accvgpr_write_b32 a54, v58
    v_accvgpr_write_b32 a55, v59
    v_accvgpr_read_b32 v52, a56
    v_accvgpr_read_b32 v53, a57
    v_accvgpr_read_b32 v54, a58
    v_accvgpr_read_b32 v55, a59
    v_accvgpr_read_b32 v56, a60
    v_accvgpr_read_b32 v57, a61
    v_accvgpr_read_b32 v58, a62
    v_accvgpr_read_b32 v59, a63
    v_mul_f32 v52, v52, v49
    v_mul_f32 v53, v53, v49
    v_mul_f32 v54, v54, v49
    v_mul_f32 v55, v55, v49
    v_mul_f32 v56, v56, v49
    v_mul_f32 v57, v57, v49
    v_mul_f32 v58, v58, v49
    v_mul_f32 v59, v59, v49
    v_accvgpr_write_b32 a56, v52
    v_accvgpr_write_b32 a57, v53
    v_accvgpr_write_b32 a58, v54
    v_accvgpr_write_b32 a59, v55
    v_accvgpr_write_b32 a60, v56
    v_accvgpr_write_b32 a61, v57
    v_accvgpr_write_b32 a62, v58
    v_accvgpr_write_b32 a63, v59
    v_exp_f32 v52, v72
    v_exp_f32 v53, v73
    v_exp_f32 v54, v74
    v_exp_f32 v55, v75
    v_exp_f32 v56, v76
    v_exp_f32 v57, v77
    v_exp_f32 v58, v78
    v_exp_f32 v59, v79
    s_nop 0
    v_cvt_pk_bf16_f32 v132, v52, v53
    v_cvt_pk_bf16_f32 v133, v54, v55
    v_cvt_pk_bf16_f32 v134, v56, v57
    v_cvt_pk_bf16_f32 v135, v58, v59
    s_nop 1
    v_mfma_f32_16x16x32_bf16 v[32:35], v[44:47], v[132:135], 0
    v_max3_f32 v48, v80, v81, v82
    v_max3_f32 v48, v48, v83, v84
    v_max3_f32 v48, v48, v85, v86
    v_max3_f32 v48, v48, v87, 0
    v_mov_b32 v49, v48
    s_nop 1
    v_permlane32_swap_b32 v48, v49
    s_nop 1
    v_max_f32 v48, v48, v49
    v_mov_b32 v49, v48
    s_nop 1
    v_permlane16_swap_b32 v48, v49
    s_nop 1
    v_max_f32 v48, v48, v49
    v_exp_f32 v49, -v48
    v_sub_f32 v80, v80, v48
    v_sub_f32 v81, v81, v48
    v_sub_f32 v82, v82, v48
    v_sub_f32 v83, v83, v48
    v_sub_f32 v84, v84, v48
    v_sub_f32 v85, v85, v48
    v_sub_f32 v86, v86, v48
    v_sub_f32 v87, v87, v48
    v_sub_f32 v112, v112, v48
    v_sub_f32 v113, v113, v48
    v_sub_f32 v114, v114, v48
    v_sub_f32 v115, v115, v48
    v_sub_f32 v116, v116, v48
    v_sub_f32 v117, v117, v48
    v_sub_f32 v118, v118, v48
    v_sub_f32 v119, v119, v48
    v_sub_f32 v176, v176, v48
    v_sub_f32 v177, v177, v48
    v_sub_f32 v178, v178, v48
    v_sub_f32 v179, v179, v48
    v_sub_f32 v180, v180, v48
    v_sub_f32 v181, v181, v48
    v_sub_f32 v182, v182, v48
    v_sub_f32 v183, v183, v48
    v_mul_f32 v14, v14, v49
    v_accvgpr_read_b32 v52, a64
    v_accvgpr_read_b32 v53, a65
    v_accvgpr_read_b32 v54, a66
    v_accvgpr_read_b32 v55, a67
    v_accvgpr_read_b32 v56, a68
    v_accvgpr_read_b32 v57, a69
    v_accvgpr_read_b32 v58, a70
    v_accvgpr_read_b32 v59, a71
    v_mul_f32 v52, v52, v49
    v_mul_f32 v53, v53, v49
    v_mul_f32 v54, v54, v49
    v_mul_f32 v55, v55, v49
    v_mul_f32 v56, v56, v49
    v_mul_f32 v57, v57, v49
    v_mul_f32 v58, v58, v49
    v_mul_f32 v59, v59, v49
    v_accvgpr_write_b32 a64, v52
    v_accvgpr_write_b32 a65, v53
    v_accvgpr_write_b32 a66, v54
    v_accvgpr_write_b32 a67, v55
    v_accvgpr_write_b32 a68, v56
    v_accvgpr_write_b32 a69, v57
    v_accvgpr_write_b32 a70, v58
    v_accvgpr_write_b32 a71, v59
    v_accvgpr_read_b32 v52, a72
    v_accvgpr_read_b32 v53, a73
    v_accvgpr_read_b32 v54, a74
    v_accvgpr_read_b32 v55, a75
    v_accvgpr_read_b32 v56, a76
    v_accvgpr_read_b32 v57, a77
    v_accvgpr_read_b32 v58, a78
    v_accvgpr_read_b32 v59, a79
    v_mul_f32 v52, v52, v49
    v_mul_f32 v53, v53, v49
    v_mul_f32 v54, v54, v49
    v_mul_f32 v55, v55, v49
    v_mul_f32 v56, v56, v49
    v_mul_f32 v57, v57, v49
    v_mul_f32 v58, v58, v49
    v_mul_f32 v59, v59, v49
    v_accvgpr_write_b32 a72, v52
    v_accvgpr_write_b32 a73, v53
    v_accvgpr_write_b32 a74, v54
    v_accvgpr_write_b32 a75, v55
    v_accvgpr_write_b32 a76, v56
    v_accvgpr_write_b32 a77, v57
    v_accvgpr_write_b32 a78, v58
    v_accvgpr_write_b32 a79, v59
    v_accvgpr_read_b32 v52, a80
    v_accvgpr_read_b32 v53, a81
    v_accvgpr_read_b32 v54, a82
    v_accvgpr_read_b32 v55, a83
    v_accvgpr_read_b32 v56, a84
    v_accvgpr_read_b32 v57, a85
    v_accvgpr_read_b32 v58, a86
    v_accvgpr_read_b32 v59, a87
    v_mul_f32 v52, v52, v49
    v_mul_f32 v53, v53, v49
    v_mul_f32 v54, v54, v49
    v_mul_f32 v55, v55, v49
    v_mul_f32 v56, v56, v49
    v_mul_f32 v57, v57, v49
    v_mul_f32 v58, v58, v49
    v_mul_f32 v59, v59, v49
    v_accvgpr_write_b32 a80, v52
    v_accvgpr_write_b32 a81, v53
    v_accvgpr_write_b32 a82, v54
    v_accvgpr_write_b32 a83, v55
    v_accvgpr_write_b32 a84, v56
    v_accvgpr_write_b32 a85, v57
    v_accvgpr_write_b32 a86, v58
    v_accvgpr_write_b32 a87, v59
    v_accvgpr_read_b32 v52, a88
    v_accvgpr_read_b32 v53, a89
    v_accvgpr_read_b32 v54, a90
    v_accvgpr_read_b32 v55, a91
    v_accvgpr_read_b32 v56, a92
    v_accvgpr_read_b32 v57, a93
    v_accvgpr_read_b32 v58, a94
    v_accvgpr_read_b32 v59, a95
    v_mul_f32 v52, v52, v49
    v_mul_f32 v53, v53, v49
    v_mul_f32 v54, v54, v49
    v_mul_f32 v55, v55, v49
    v_mul_f32 v56, v56, v49
    v_mul_f32 v57, v57, v49
    v_mul_f32 v58, v58, v49
    v_mul_f32 v59, v59, v49
    v_accvgpr_write_b32 a88, v52
    v_accvgpr_write_b32 a89, v53
    v_accvgpr_write_b32 a90, v54
    v_accvgpr_write_b32 a91, v55
    v_accvgpr_write_b32 a92, v56
    v_accvgpr_write_b32 a93, v57
    v_accvgpr_write_b32 a94, v58
    v_accvgpr_write_b32 a95, v59
    v_exp_f32 v52, v80
    v_exp_f32 v53, v81
    v_exp_f32 v54, v82
    v_exp_f32 v55, v83
    v_exp_f32 v56, v84
    v_exp_f32 v57, v85
    v_exp_f32 v58, v86
    v_exp_f32 v59, v87
    s_nop 0
    v_cvt_pk_bf16_f32 v136, v52, v53
    v_cvt_pk_bf16_f32 v137, v54, v55
    v_cvt_pk_bf16_f32 v138, v56, v57
    v_cvt_pk_bf16_f32 v139, v58, v59
    s_nop 1
    v_mfma_f32_16x16x32_bf16 v[36:39], v[44:47], v[136:139], 0
    v_max3_f32 v48, v88, v89, v90
    v_max3_f32 v48, v48, v91, v92
    v_max3_f32 v48, v48, v93, v94
    v_max3_f32 v48, v48, v95, 0
    v_mov_b32 v49, v48
    s_nop 1
    v_permlane32_swap_b32 v48, v49
    s_nop 1
    v_max_f32 v48, v48, v49
    v_mov_b32 v49, v48
    s_nop 1
    v_permlane16_swap_b32 v48, v49
    s_nop 1
    v_max_f32 v48, v48, v49
    v_exp_f32 v49, -v48
    v_sub_f32 v88, v88, v48
    v_sub_f32 v89, v89, v48
    v_sub_f32 v90, v90, v48
    v_sub_f32 v91, v91, v48
    v_sub_f32 v92, v92, v48
    v_sub_f32 v93, v93, v48
    v_sub_f32 v94, v94, v48
    v_sub_f32 v95, v95, v48
    v_sub_f32 v120, v120, v48
    v_sub_f32 v121, v121, v48
    v_sub_f32 v122, v122, v48
    v_sub_f32 v123, v123, v48
    v_sub_f32 v124, v124, v48
    v_sub_f32 v125, v125, v48
    v_sub_f32 v126, v126, v48
    v_sub_f32 v127, v127, v48
    v_sub_f32 v184, v184, v48
    v_sub_f32 v185, v185, v48
    v_sub_f32 v186, v186, v48
    v_sub_f32 v187, v187, v48
    v_sub_f32 v188, v188, v48
    v_sub_f32 v189, v189, v48
    v_sub_f32 v190, v190, v48
    v_sub_f32 v191, v191, v48
    v_mul_f32 v15, v15, v49
    v_accvgpr_read_b32 v52, a96
    v_accvgpr_read_b32 v53, a97
    v_accvgpr_read_b32 v54, a98
    v_accvgpr_read_b32 v55, a99
    v_accvgpr_read_b32 v56, a100
    v_accvgpr_read_b32 v57, a101
    v_accvgpr_read_b32 v58, a102
    v_accvgpr_read_b32 v59, a103
    v_mul_f32 v52, v52, v49
    v_mul_f32 v53, v53, v49
    v_mul_f32 v54, v54, v49
    v_mul_f32 v55, v55, v49
    v_mul_f32 v56, v56, v49
    v_mul_f32 v57, v57, v49
    v_mul_f32 v58, v58, v49
    v_mul_f32 v59, v59, v49
    v_accvgpr_write_b32 a96, v52
    v_accvgpr_write_b32 a97, v53
    v_accvgpr_write_b32 a98, v54
    v_accvgpr_write_b32 a99, v55
    v_accvgpr_write_b32 a100, v56
    v_accvgpr_write_b32 a101, v57
    v_accvgpr_write_b32 a102, v58
    v_accvgpr_write_b32 a103, v59
    v_accvgpr_read_b32 v52, a104
    v_accvgpr_read_b32 v53, a105
    v_accvgpr_read_b32 v54, a106
    v_accvgpr_read_b32 v55, a107
    v_accvgpr_read_b32 v56, a108
    v_accvgpr_read_b32 v57, a109
    v_accvgpr_read_b32 v58, a110
    v_accvgpr_read_b32 v59, a111
    v_mul_f32 v52, v52, v49
    v_mul_f32 v53, v53, v49
    v_mul_f32 v54, v54, v49
    v_mul_f32 v55, v55, v49
    v_mul_f32 v56, v56, v49
    v_mul_f32 v57, v57, v49
    v_mul_f32 v58, v58, v49
    v_mul_f32 v59, v59, v49
    v_accvgpr_write_b32 a104, v52
    v_accvgpr_write_b32 a105, v53
    v_accvgpr_write_b32 a106, v54
    v_accvgpr_write_b32 a107, v55
    v_accvgpr_write_b32 a108, v56
    v_accvgpr_write_b32 a109, v57
    v_accvgpr_write_b32 a110, v58
    v_accvgpr_write_b32 a111, v59
    v_accvgpr_read_b32 v52, a112
    v_accvgpr_read_b32 v53, a113
    v_accvgpr_read_b32 v54, a114
    v_accvgpr_read_b32 v55, a115
    v_accvgpr_read_b32 v56, a116
    v_accvgpr_read_b32 v57, a117
    v_accvgpr_read_b32 v58, a118
    v_accvgpr_read_b32 v59, a119
    v_mul_f32 v52, v52, v49
    v_mul_f32 v53, v53, v49
    v_mul_f32 v54, v54, v49
    v_mul_f32 v55, v55, v49
    v_mul_f32 v56, v56, v49
    v_mul_f32 v57, v57, v49
    v_mul_f32 v58, v58, v49
    v_mul_f32 v59, v59, v49
    v_accvgpr_write_b32 a112, v52
    v_accvgpr_write_b32 a113, v53
    v_accvgpr_write_b32 a114, v54
    v_accvgpr_write_b32 a115, v55
    v_accvgpr_write_b32 a116, v56
    v_accvgpr_write_b32 a117, v57
    v_accvgpr_write_b32 a118, v58
    v_accvgpr_write_b32 a119, v59
    v_accvgpr_read_b32 v52, a120
    v_accvgpr_read_b32 v53, a121
    v_accvgpr_read_b32 v54, a122
    v_accvgpr_read_b32 v55, a123
    v_accvgpr_read_b32 v56, a124
    v_accvgpr_read_b32 v57, a125
    v_accvgpr_read_b32 v58, a126
    v_accvgpr_read_b32 v59, a127
    v_mul_f32 v52, v52, v49
    v_mul_f32 v53, v53, v49
    v_mul_f32 v54, v54, v49
    v_mul_f32 v55, v55, v49
    v_mul_f32 v56, v56, v49
    v_mul_f32 v57, v57, v49
    v_mul_f32 v58, v58, v49
    v_mul_f32 v59, v59, v49
    v_accvgpr_write_b32 a120, v52
    v_accvgpr_write_b32 a121, v53
    v_accvgpr_write_b32 a122, v54
    v_accvgpr_write_b32 a123, v55
    v_accvgpr_write_b32 a124, v56
    v_accvgpr_write_b32 a125, v57
    v_accvgpr_write_b32 a126, v58
    v_accvgpr_write_b32 a127, v59
    v_exp_f32 v52, v88
    v_exp_f32 v53, v89
    v_exp_f32 v54, v90
    v_exp_f32 v55, v91
    v_exp_f32 v56, v92
    v_exp_f32 v57, v93
    v_exp_f32 v58, v94
    v_exp_f32 v59, v95
    s_nop 0
    v_cvt_pk_bf16_f32 v140, v52, v53
    v_cvt_pk_bf16_f32 v141, v54, v55
    v_cvt_pk_bf16_f32 v142, v56, v57
    v_cvt_pk_bf16_f32 v143, v58, v59
    s_nop 1
    v_mfma_f32_16x16x32_bf16 v[40:43], v[44:47], v[140:143], 0
    s_nop 7
    s_setpc_b64 s[70:71]
mega_kernel_rs1267:
    s_nop 15
    v_max3_f32 v48, v96, v97, v98
    v_max3_f32 v48, v48, v99, v100
    v_max3_f32 v48, v48, v101, v102
    v_max3_f32 v48, v48, v103, 0
    v_mov_b32 v49, v48
    s_nop 1
    v_permlane32_swap_b32 v48, v49
    s_nop 1
    v_max_f32 v48, v48, v49
    v_mov_b32 v49, v48
    s_nop 1
    v_permlane16_swap_b32 v48, v49
    s_nop 1
    v_max_f32 v48, v48, v49
    v_exp_f32 v49, -v48
    v_sub_f32 v96, v96, v48
    v_sub_f32 v97, v97, v48
    v_sub_f32 v98, v98, v48
    v_sub_f32 v99, v99, v48
    v_sub_f32 v100, v100, v48
    v_sub_f32 v101, v101, v48
    v_sub_f32 v102, v102, v48
    v_sub_f32 v103, v103, v48
    v_sub_f32 v64, v64, v48
    v_sub_f32 v65, v65, v48
    v_sub_f32 v66, v66, v48
    v_sub_f32 v67, v67, v48
    v_sub_f32 v68, v68, v48
    v_sub_f32 v69, v69, v48
    v_sub_f32 v70, v70, v48
    v_sub_f32 v71, v71, v48
    v_sub_f32 v160, v160, v48
    v_sub_f32 v161, v161, v48
    v_sub_f32 v162, v162, v48
    v_sub_f32 v163, v163, v48
    v_sub_f32 v164, v164, v48
    v_sub_f32 v165, v165, v48
    v_sub_f32 v166, v166, v48
    v_sub_f32 v167, v167, v48
    v_mul_f32 v12, v12, v49
    v_accvgpr_read_b32 v52, a0
    v_accvgpr_read_b32 v53, a1
    v_accvgpr_read_b32 v54, a2
    v_accvgpr_read_b32 v55, a3
    v_accvgpr_read_b32 v56, a4
    v_accvgpr_read_b32 v57, a5
    v_accvgpr_read_b32 v58, a6
    v_accvgpr_read_b32 v59, a7
    v_mul_f32 v52, v52, v49
    v_mul_f32 v53, v53, v49
    v_mul_f32 v54, v54, v49
    v_mul_f32 v55, v55, v49
    v_mul_f32 v56, v56, v49
    v_mul_f32 v57, v57, v49
    v_mul_f32 v58, v58, v49
    v_mul_f32 v59, v59, v49
    v_accvgpr_write_b32 a0, v52
    v_accvgpr_write_b32 a1, v53
    v_accvgpr_write_b32 a2, v54
    v_accvgpr_write_b32 a3, v55
    v_accvgpr_write_b32 a4, v56
    v_accvgpr_write_b32 a5, v57
    v_accvgpr_write_b32 a6, v58
    v_accvgpr_write_b32 a7, v59
    v_accvgpr_read_b32 v52, a8
    v_accvgpr_read_b32 v53, a9
    v_accvgpr_read_b32 v54, a10
    v_accvgpr_read_b32 v55, a11
    v_accvgpr_read_b32 v56, a12
    v_accvgpr_read_b32 v57, a13
    v_accvgpr_read_b32 v58, a14
    v_accvgpr_read_b32 v59, a15
    v_mul_f32 v52, v52, v49
    v_mul_f32 v53, v53, v49
    v_mul_f32 v54, v54, v49
    v_mul_f32 v55, v55, v49
    v_mul_f32 v56, v56, v49
    v_mul_f32 v57, v57, v49
    v_mul_f32 v58, v58, v49
    v_mul_f32 v59, v59, v49
    v_accvgpr_write_b32 a8, v52
    v_accvgpr_write_b32 a9, v53
    v_accvgpr_write_b32 a10, v54
    v_accvgpr_write_b32 a11, v55
    v_accvgpr_write_b32 a12, v56
    v_accvgpr_write_b32 a13, v57
    v_accvgpr_write_b32 a14, v58
    v_accvgpr_write_b32 a15, v59
    v_accvgpr_read_b32 v52, a16
    v_accvgpr_read_b32 v53, a17
    v_accvgpr_read_b32 v54, a18
    v_accvgpr_read_b32 v55, a19
    v_accvgpr_read_b32 v56, a20
    v_accvgpr_read_b32 v57, a21
    v_accvgpr_read_b32 v58, a22
    v_accvgpr_read_b32 v59, a23
    v_mul_f32 v52, v52, v49
    v_mul_f32 v53, v53, v49
    v_mul_f32 v54, v54, v49
    v_mul_f32 v55, v55, v49
    v_mul_f32 v56, v56, v49
    v_mul_f32 v57, v57, v49
    v_mul_f32 v58, v58, v49
    v_mul_f32 v59, v59, v49
    v_accvgpr_write_b32 a16, v52
    v_accvgpr_write_b32 a17, v53
    v_accvgpr_write_b32 a18, v54
    v_accvgpr_write_b32 a19, v55
    v_accvgpr_write_b32 a20, v56
    v_accvgpr_write_b32 a21, v57
    v_accvgpr_write_b32 a22, v58
    v_accvgpr_write_b32 a23, v59
    v_accvgpr_read_b32 v52, a24
    v_accvgpr_read_b32 v53, a25
    v_accvgpr_read_b32 v54, a26
    v_accvgpr_read_b32 v55, a27
    v_accvgpr_read_b32 v56, a28
    v_accvgpr_read_b32 v57, a29
    v_accvgpr_read_b32 v58, a30
    v_accvgpr_read_b32 v59, a31
    v_mul_f32 v52, v52, v49
    v_mul_f32 v53, v53, v49
    v_mul_f32 v54, v54, v49
    v_mul_f32 v55, v55, v49
    v_mul_f32 v56, v56, v49
    v_mul_f32 v57, v57, v49
    v_mul_f32 v58, v58, v49
    v_mul_f32 v59, v59, v49
    v_accvgpr_write_b32 a24, v52
    v_accvgpr_write_b32 a25, v53
    v_accvgpr_write_b32 a26, v54
    v_accvgpr_write_b32 a27, v55
    v_accvgpr_write_b32 a28, v56
    v_accvgpr_write_b32 a29, v57
    v_accvgpr_write_b32 a30, v58
    v_accvgpr_write_b32 a31, v59
    v_exp_f32 v52, v96
    v_exp_f32 v53, v97
    v_exp_f32 v54, v98
    v_exp_f32 v55, v99
    v_exp_f32 v56, v100
    v_exp_f32 v57, v101
    v_exp_f32 v58, v102
    v_exp_f32 v59, v103
    s_nop 0
    v_cvt_pk_bf16_f32 v144, v52, v53
    v_cvt_pk_bf16_f32 v145, v54, v55
    v_cvt_pk_bf16_f32 v146, v56, v57
    v_cvt_pk_bf16_f32 v147, v58, v59
    s_nop 1
    v_mfma_f32_16x16x32_bf16 v[28:31], v[44:47], v[144:147], 0
    v_max3_f32 v48, v104, v105, v106
    v_max3_f32 v48, v48, v107, v108
    v_max3_f32 v48, v48, v109, v110
    v_max3_f32 v48, v48, v111, 0
    v_mov_b32 v49, v48
    s_nop 1
    v_permlane32_swap_b32 v48, v49
    s_nop 1
    v_max_f32 v48, v48, v49
    v_mov_b32 v49, v48
    s_nop 1
    v_permlane16_swap_b32 v48, v49
    s_nop 1
    v_max_f32 v48, v48, v49
    v_exp_f32 v49, -v48
    v_sub_f32 v104, v104, v48
    v_sub_f32 v105, v105, v48
    v_sub_f32 v106, v106, v48
    v_sub_f32 v107, v107, v48
    v_sub_f32 v108, v108, v48
    v_sub_f32 v109, v109, v48
    v_sub_f32 v110, v110, v48
    v_sub_f32 v111, v111, v48
    v_sub_f32 v72, v72, v48
    v_sub_f32 v73, v73, v48
    v_sub_f32 v74, v74, v48
    v_sub_f32 v75, v75, v48
    v_sub_f32 v76, v76, v48
    v_sub_f32 v77, v77, v48
    v_sub_f32 v78, v78, v48
    v_sub_f32 v79, v79, v48
    v_sub_f32 v168, v168, v48
    v_sub_f32 v169, v169, v48
    v_sub_f32 v170, v170, v48
    v_sub_f32 v171, v171, v48
    v_sub_f32 v172, v172, v48
    v_sub_f32 v173, v173, v48
    v_sub_f32 v174, v174, v48
    v_sub_f32 v175, v175, v48
    v_mul_f32 v13, v13, v49
    v_accvgpr_read_b32 v52, a32
    v_accvgpr_read_b32 v53, a33
    v_accvgpr_read_b32 v54, a34
    v_accvgpr_read_b32 v55, a35
    v_accvgpr_read_b32 v56, a36
    v_accvgpr_read_b32 v57, a37
    v_accvgpr_read_b32 v58, a38
    v_accvgpr_read_b32 v59, a39
    v_mul_f32 v52, v52, v49
    v_mul_f32 v53, v53, v49
    v_mul_f32 v54, v54, v49
    v_mul_f32 v55, v55, v49
    v_mul_f32 v56, v56, v49
    v_mul_f32 v57, v57, v49
    v_mul_f32 v58, v58, v49
    v_mul_f32 v59, v59, v49
    v_accvgpr_write_b32 a32, v52
    v_accvgpr_write_b32 a33, v53
    v_accvgpr_write_b32 a34, v54
    v_accvgpr_write_b32 a35, v55
    v_accvgpr_write_b32 a36, v56
    v_accvgpr_write_b32 a37, v57
    v_accvgpr_write_b32 a38, v58
    v_accvgpr_write_b32 a39, v59
    v_accvgpr_read_b32 v52, a40
    v_accvgpr_read_b32 v53, a41
    v_accvgpr_read_b32 v54, a42
    v_accvgpr_read_b32 v55, a43
    v_accvgpr_read_b32 v56, a44
    v_accvgpr_read_b32 v57, a45
    v_accvgpr_read_b32 v58, a46
    v_accvgpr_read_b32 v59, a47
    v_mul_f32 v52, v52, v49
    v_mul_f32 v53, v53, v49
    v_mul_f32 v54, v54, v49
    v_mul_f32 v55, v55, v49
    v_mul_f32 v56, v56, v49
    v_mul_f32 v57, v57, v49
    v_mul_f32 v58, v58, v49
    v_mul_f32 v59, v59, v49
    v_accvgpr_write_b32 a40, v52
    v_accvgpr_write_b32 a41, v53
    v_accvgpr_write_b32 a42, v54
    v_accvgpr_write_b32 a43, v55
    v_accvgpr_write_b32 a44, v56
    v_accvgpr_write_b32 a45, v57
    v_accvgpr_write_b32 a46, v58
    v_accvgpr_write_b32 a47, v59
    v_accvgpr_read_b32 v52, a48
    v_accvgpr_read_b32 v53, a49
    v_accvgpr_read_b32 v54, a50
    v_accvgpr_read_b32 v55, a51
    v_accvgpr_read_b32 v56, a52
    v_accvgpr_read_b32 v57, a53
    v_accvgpr_read_b32 v58, a54
    v_accvgpr_read_b32 v59, a55
    v_mul_f32 v52, v52, v49
    v_mul_f32 v53, v53, v49
    v_mul_f32 v54, v54, v49
    v_mul_f32 v55, v55, v49
    v_mul_f32 v56, v56, v49
    v_mul_f32 v57, v57, v49
    v_mul_f32 v58, v58, v49
    v_mul_f32 v59, v59, v49
    v_accvgpr_write_b32 a48, v52
    v_accvgpr_write_b32 a49, v53
    v_accvgpr_write_b32 a50, v54
    v_accvgpr_write_b32 a51, v55
    v_accvgpr_write_b32 a52, v56
    v_accvgpr_write_b32 a53, v57
    v_accvgpr_write_b32 a54, v58
    v_accvgpr_write_b32 a55, v59
    v_accvgpr_read_b32 v52, a56
    v_accvgpr_read_b32 v53, a57
    v_accvgpr_read_b32 v54, a58
    v_accvgpr_read_b32 v55, a59
    v_accvgpr_read_b32 v56, a60
    v_accvgpr_read_b32 v57, a61
    v_accvgpr_read_b32 v58, a62
    v_accvgpr_read_b32 v59, a63
    v_mul_f32 v52, v52, v49
    v_mul_f32 v53, v53, v49
    v_mul_f32 v54, v54, v49
    v_mul_f32 v55, v55, v49
    v_mul_f32 v56, v56, v49
    v_mul_f32 v57, v57, v49
    v_mul_f32 v58, v58, v49
    v_mul_f32 v59, v59, v49
    v_accvgpr_write_b32 a56, v52
    v_accvgpr_write_b32 a57, v53
    v_accvgpr_write_b32 a58, v54
    v_accvgpr_write_b32 a59, v55
    v_accvgpr_write_b32 a60, v56
    v_accvgpr_write_b32 a61, v57
    v_accvgpr_write_b32 a62, v58
    v_accvgpr_write_b32 a63, v59
    v_exp_f32 v52, v104
    v_exp_f32 v53, v105
    v_exp_f32 v54, v106
    v_exp_f32 v55, v107
    v_exp_f32 v56, v108
    v_exp_f32 v57, v109
    v_exp_f32 v58, v110
    v_exp_f32 v59, v111
    s_nop 0
    v_cvt_pk_bf16_f32 v148, v52, v53
    v_cvt_pk_bf16_f32 v149, v54, v55
    v_cvt_pk_bf16_f32 v150, v56, v57
    v_cvt_pk_bf16_f32 v151, v58, v59
    s_nop 1
    v_mfma_f32_16x16x32_bf16 v[32:35], v[44:47], v[148:151], 0
    s_nop 7
    s_setpc_b64 s[70:71]
mega_kernel_rs1468:
    s_nop 15
    v_max3_f32 v48, v96, v97, v98
    v_max3_f32 v48, v48, v99, v100
    v_max3_f32 v48, v48, v101, v102
    v_max3_f32 v48, v48, v103, 0
    v_mov_b32 v49, v48
    s_nop 1
    v_permlane32_swap_b32 v48, v49
    s_nop 1
    v_max_f32 v48, v48, v49
    v_mov_b32 v49, v48
    s_nop 1
    v_permlane16_swap_b32 v48, v49
    s_nop 1
    v_max_f32 v48, v48, v49
    v_exp_f32 v49, -v48
    v_sub_f32 v96, v96, v48
    v_sub_f32 v97, v97, v48
    v_sub_f32 v98, v98, v48
    v_sub_f32 v99, v99, v48
    v_sub_f32 v100, v100, v48
    v_sub_f32 v101, v101, v48
    v_sub_f32 v102, v102, v48
    v_sub_f32 v103, v103, v48
    v_sub_f32 v64, v64, v48
    v_sub_f32 v65, v65, v48
    v_sub_f32 v66, v66, v48
    v_sub_f32 v67, v67, v48
    v_sub_f32 v68, v68, v48
    v_sub_f32 v69, v69, v48
    v_sub_f32 v70, v70, v48
    v_sub_f32 v71, v71, v48
    v_sub_f32 v160, v160, v48
    v_sub_f32 v161, v161, v48
    v_sub_f32 v162, v162, v48
    v_sub_f32 v163, v163, v48
    v_sub_f32 v164, v164, v48
    v_sub_f32 v165, v165, v48
    v_sub_f32 v166, v166, v48
    v_sub_f32 v167, v167, v48
    v_mul_f32 v12, v12, v49
    v_accvgpr_read_b32 v52, a0
    v_accvgpr_read_b32 v53, a1
    v_accvgpr_read_b32 v54, a2
    v_accvgpr_read_b32 v55, a3
    v_accvgpr_read_b32 v56, a4
    v_accvgpr_read_b32 v57, a5
    v_accvgpr_read_b32 v58, a6
    v_accvgpr_read_b32 v59, a7
    v_mul_f32 v52, v52, v49
    v_mul_f32 v53, v53, v49
    v_mul_f32 v54, v54, v49
    v_mul_f32 v55, v55, v49
    v_mul_f32 v56, v56, v49
    v_mul_f32 v57, v57, v49
    v_mul_f32 v58, v58, v49
    v_mul_f32 v59, v59, v49
    v_accvgpr_write_b32 a0, v52
    v_accvgpr_write_b32 a1, v53
    v_accvgpr_write_b32 a2, v54
    v_accvgpr_write_b32 a3, v55
    v_accvgpr_write_b32 a4, v56
    v_accvgpr_write_b32 a5, v57
    v_accvgpr_write_b32 a6, v58
    v_accvgpr_write_b32 a7, v59
    v_accvgpr_read_b32 v52, a8
    v_accvgpr_read_b32 v53, a9
    v_accvgpr_read_b32 v54, a10
    v_accvgpr_read_b32 v55, a11
    v_accvgpr_read_b32 v56, a12
    v_accvgpr_read_b32 v57, a13
    v_accvgpr_read_b32 v58, a14
    v_accvgpr_read_b32 v59, a15
    v_mul_f32 v52, v52, v49
    v_mul_f32 v53, v53, v49
    v_mul_f32 v54, v54, v49
    v_mul_f32 v55, v55, v49
    v_mul_f32 v56, v56, v49
    v_mul_f32 v57, v57, v49
    v_mul_f32 v58, v58, v49
    v_mul_f32 v59, v59, v49
    v_accvgpr_write_b32 a8, v52
    v_accvgpr_write_b32 a9, v53
    v_accvgpr_write_b32 a10, v54
    v_accvgpr_write_b32 a11, v55
    v_accvgpr_write_b32 a12, v56
    v_accvgpr_write_b32 a13, v57
    v_accvgpr_write_b32 a14, v58
    v_accvgpr_write_b32 a15, v59
    v_accvgpr_read_b32 v52, a16
    v_accvgpr_read_b32 v53, a17
    v_accvgpr_read_b32 v54, a18
    v_accvgpr_read_b32 v55, a19
    v_accvgpr_read_b32 v56, a20
    v_accvgpr_read_b32 v57, a21
    v_accvgpr_read_b32 v58, a22
    v_accvgpr_read_b32 v59, a23
    v_mul_f32 v52, v52, v49
    v_mul_f32 v53, v53, v49
    v_mul_f32 v54, v54, v49
    v_mul_f32 v55, v55, v49
    v_mul_f32 v56, v56, v49
    v_mul_f32 v57, v57, v49
    v_mul_f32 v58, v58, v49
    v_mul_f32 v59, v59, v49
    v_accvgpr_write_b32 a16, v52
    v_accvgpr_write_b32 a17, v53
    v_accvgpr_write_b32 a18, v54
    v_accvgpr_write_b32 a19, v55
    v_accvgpr_write_b32 a20, v56
    v_accvgpr_write_b32 a21, v57
    v_accvgpr_write_b32 a22, v58
    v_accvgpr_write_b32 a23, v59
    v_accvgpr_read_b32 v52, a24
    v_accvgpr_read_b32 v53, a25
    v_accvgpr_read_b32 v54, a26
    v_accvgpr_read_b32 v55, a27
    v_accvgpr_read_b32 v56, a28
    v_accvgpr_read_b32 v57, a29
    v_accvgpr_read_b32 v58, a30
    v_accvgpr_read_b32 v59, a31
    v_mul_f32 v52, v52, v49
    v_mul_f32 v53, v53, v49
    v_mul_f32 v54, v54, v49
    v_mul_f32 v55, v55, v49
    v_mul_f32 v56, v56, v49
    v_mul_f32 v57, v57, v49
    v_mul_f32 v58, v58, v49
    v_mul_f32 v59, v59, v49
    v_accvgpr_write_b32 a24, v52
    v_accvgpr_write_b32 a25, v53
    v_accvgpr_write_b32 a26, v54
    v_accvgpr_write_b32 a27, v55
    v_accvgpr_write_b32 a28, v56
    v_accvgpr_write_b32 a29, v57
    v_accvgpr_write_b32 a30, v58
    v_accvgpr_write_b32 a31, v59
    v_exp_f32 v52, v96
    v_exp_f32 v53, v97
    v_exp_f32 v54, v98
    v_exp_f32 v55, v99
    v_exp_f32 v56, v100
    v_exp_f32 v57, v101
    v_exp_f32 v58, v102
    v_exp_f32 v59, v103
    s_nop 0
    v_cvt_pk_bf16_f32 v144, v52, v53
    v_cvt_pk_bf16_f32 v145, v54, v55
    v_cvt_pk_bf16_f32 v146, v56, v57
    v_cvt_pk_bf16_f32 v147, v58, v59
    s_nop 1
    v_mfma_f32_16x16x32_bf16 v[28:31], v[44:47], v[144:147], 0
    v_max3_f32 v48, v104, v105, v106
    v_max3_f32 v48, v48, v107, v108
    v_max3_f32 v48, v48, v109, v110
    v_max3_f32 v48, v48, v111, 0
    v_mov_b32 v49, v48
    s_nop 1
    v_permlane32_swap_b32 v48, v49
    s_nop 1
    v_max_f32 v48, v48, v49
    v_mov_b32 v49, v48
    s_nop 1
    v_permlane16_swap_b32 v48, v49
    s_nop 1
    v_max_f32 v48, v48, v49
    v_exp_f32 v49, -v48
    v_sub_f32 v104, v104, v48
    v_sub_f32 v105, v105, v48
    v_sub_f32 v106, v106, v48
    v_sub_f32 v107, v107, v48
    v_sub_f32 v108, v108, v48
    v_sub_f32 v109, v109, v48
    v_sub_f32 v110, v110, v48
    v_sub_f32 v111, v111, v48
    v_sub_f32 v72, v72, v48
    v_sub_f32 v73, v73, v48
    v_sub_f32 v74, v74, v48
    v_sub_f32 v75, v75, v48
    v_sub_f32 v76, v76, v48
    v_sub_f32 v77, v77, v48
    v_sub_f32 v78, v78, v48
    v_sub_f32 v79, v79, v48
    v_sub_f32 v168, v168, v48
    v_sub_f32 v169, v169, v48
    v_sub_f32 v170, v170, v48
    v_sub_f32 v171, v171, v48
    v_sub_f32 v172, v172, v48
    v_sub_f32 v173, v173, v48
    v_sub_f32 v174, v174, v48
    v_sub_f32 v175, v175, v48
    v_mul_f32 v13, v13, v49
    v_accvgpr_read_b32 v52, a32
    v_accvgpr_read_b32 v53, a33
    v_accvgpr_read_b32 v54, a34
    v_accvgpr_read_b32 v55, a35
    v_accvgpr_read_b32 v56, a36
    v_accvgpr_read_b32 v57, a37
    v_accvgpr_read_b32 v58, a38
    v_accvgpr_read_b32 v59, a39
    v_mul_f32 v52, v52, v49
    v_mul_f32 v53, v53, v49
    v_mul_f32 v54, v54, v49
    v_mul_f32 v55, v55, v49
    v_mul_f32 v56, v56, v49
    v_mul_f32 v57, v57, v49
    v_mul_f32 v58, v58, v49
    v_mul_f32 v59, v59, v49
    v_accvgpr_write_b32 a32, v52
    v_accvgpr_write_b32 a33, v53
    v_accvgpr_write_b32 a34, v54
    v_accvgpr_write_b32 a35, v55
    v_accvgpr_write_b32 a36, v56
    v_accvgpr_write_b32 a37, v57
    v_accvgpr_write_b32 a38, v58
    v_accvgpr_write_b32 a39, v59
    v_accvgpr_read_b32 v52, a40
    v_accvgpr_read_b32 v53, a41
    v_accvgpr_read_b32 v54, a42
    v_accvgpr_read_b32 v55, a43
    v_accvgpr_read_b32 v56, a44
    v_accvgpr_read_b32 v57, a45
    v_accvgpr_read_b32 v58, a46
    v_accvgpr_read_b32 v59, a47
    v_mul_f32 v52, v52, v49
    v_mul_f32 v53, v53, v49
    v_mul_f32 v54, v54, v49
    v_mul_f32 v55, v55, v49
    v_mul_f32 v56, v56, v49
    v_mul_f32 v57, v57, v49
    v_mul_f32 v58, v58, v49
    v_mul_f32 v59, v59, v49
    v_accvgpr_write_b32 a40, v52
    v_accvgpr_write_b32 a41, v53
    v_accvgpr_write_b32 a42, v54
    v_accvgpr_write_b32 a43, v55
    v_accvgpr_write_b32 a44, v56
    v_accvgpr_write_b32 a45, v57
    v_accvgpr_write_b32 a46, v58
    v_accvgpr_write_b32 a47, v59
    v_accvgpr_read_b32 v52, a48
    v_accvgpr_read_b32 v53, a49
    v_accvgpr_read_b32 v54, a50
    v_accvgpr_read_b32 v55, a51
    v_accvgpr_read_b32 v56, a52
    v_accvgpr_read_b32 v57, a53
    v_accvgpr_read_b32 v58, a54
    v_accvgpr_read_b32 v59, a55
    v_mul_f32 v52, v52, v49
    v_mul_f32 v53, v53, v49
    v_mul_f32 v54, v54, v49
    v_mul_f32 v55, v55, v49
    v_mul_f32 v56, v56, v49
    v_mul_f32 v57, v57, v49
    v_mul_f32 v58, v58, v49
    v_mul_f32 v59, v59, v49
    v_accvgpr_write_b32 a48, v52
    v_accvgpr_write_b32 a49, v53
    v_accvgpr_write_b32 a50, v54
    v_accvgpr_write_b32 a51, v55
    v_accvgpr_write_b32 a52, v56
    v_accvgpr_write_b32 a53, v57
    v_accvgpr_write_b32 a54, v58
    v_accvgpr_write_b32 a55, v59
    v_accvgpr_read_b32 v52, a56
    v_accvgpr_read_b32 v53, a57
    v_accvgpr_read_b32 v54, a58
    v_accvgpr_read_b32 v55, a59
    v_accvgpr_read_b32 v56, a60
    v_accvgpr_read_b32 v57, a61
    v_accvgpr_read_b32 v58, a62
    v_accvgpr_read_b32 v59, a63
    v_mul_f32 v52, v52, v49
    v_mul_f32 v53, v53, v49
    v_mul_f32 v54, v54, v49
    v_mul_f32 v55, v55, v49
    v_mul_f32 v56, v56, v49
    v_mul_f32 v57, v57, v49
    v_mul_f32 v58, v58, v49
    v_mul_f32 v59, v59, v49
    v_accvgpr_write_b32 a56, v52
    v_accvgpr_write_b32 a57, v53
    v_accvgpr_write_b32 a58, v54
    v_accvgpr_write_b32 a59, v55
    v_accvgpr_write_b32 a60, v56
    v_accvgpr_write_b32 a61, v57
    v_accvgpr_write_b32 a62, v58
    v_accvgpr_write_b32 a63, v59
    v_exp_f32 v52, v104
    v_exp_f32 v53, v105
    v_exp_f32 v54, v106
    v_exp_f32 v55, v107
    v_exp_f32 v56, v108
    v_exp_f32 v57, v109
    v_exp_f32 v58, v110
    v_exp_f32 v59, v111
    s_nop 0
    v_cvt_pk_bf16_f32 v148, v52, v53
    v_cvt_pk_bf16_f32 v149, v54, v55
    v_cvt_pk_bf16_f32 v150, v56, v57
    v_cvt_pk_bf16_f32 v151, v58, v59
    s_nop 1
    v_mfma_f32_16x16x32_bf16 v[32:35], v[44:47], v[148:151], 0
    v_max3_f32 v48, v112, v113, v114
    v_max3_f32 v48, v48, v115, v116
    v_max3_f32 v48, v48, v117, v118
    v_max3_f32 v48, v48, v119, 0
    v_mov_b32 v49, v48
    s_nop 1
    v_permlane32_swap_b32 v48, v49
    s_nop 1
    v_max_f32 v48, v48, v49
    v_mov_b32 v49, v48
    s_nop 1
    v_permlane16_swap_b32 v48, v49
    s_nop 1
    v_max_f32 v48, v48, v49
    v_exp_f32 v49, -v48
    v_sub_f32 v112, v112, v48
    v_sub_f32 v113, v113, v48
    v_sub_f32 v114, v114, v48
    v_sub_f32 v115, v115, v48
    v_sub_f32 v116, v116, v48
    v_sub_f32 v117, v117, v48
    v_sub_f32 v118, v118, v48
    v_sub_f32 v119, v119, v48
    v_sub_f32 v80, v80, v48
    v_sub_f32 v81, v81, v48
    v_sub_f32 v82, v82, v48
    v_sub_f32 v83, v83, v48
    v_sub_f32 v84, v84, v48
    v_sub_f32 v85, v85, v48
    v_sub_f32 v86, v86, v48
    v_sub_f32 v87, v87, v48
    v_sub_f32 v176, v176, v48
    v_sub_f32 v177, v177, v48
    v_sub_f32 v178, v178, v48
    v_sub_f32 v179, v179, v48
    v_sub_f32 v180, v180, v48
    v_sub_f32 v181, v181, v48
    v_sub_f32 v182, v182, v48
    v_sub_f32 v183, v183, v48
    v_mul_f32 v14, v14, v49
    v_accvgpr_read_b32 v52, a64
    v_accvgpr_read_b32 v53, a65
    v_accvgpr_read_b32 v54, a66
    v_accvgpr_read_b32 v55, a67
    v_accvgpr_read_b32 v56, a68
    v_accvgpr_read_b32 v57, a69
    v_accvgpr_read_b32 v58, a70
    v_accvgpr_read_b32 v59, a71
    v_mul_f32 v52, v52, v49
    v_mul_f32 v53, v53, v49
    v_mul_f32 v54, v54, v49
    v_mul_f32 v55, v55, v49
    v_mul_f32 v56, v56, v49
    v_mul_f32 v57, v57, v49
    v_mul_f32 v58, v58, v49
    v_mul_f32 v59, v59, v49
    v_accvgpr_write_b32 a64, v52
    v_accvgpr_write_b32 a65, v53
    v_accvgpr_write_b32 a66, v54
    v_accvgpr_write_b32 a67, v55
    v_accvgpr_write_b32 a68, v56
    v_accvgpr_write_b32 a69, v57
    v_accvgpr_write_b32 a70, v58
    v_accvgpr_write_b32 a71, v59
    v_accvgpr_read_b32 v52, a72
    v_accvgpr_read_b32 v53, a73
    v_accvgpr_read_b32 v54, a74
    v_accvgpr_read_b32 v55, a75
    v_accvgpr_read_b32 v56, a76
    v_accvgpr_read_b32 v57, a77
    v_accvgpr_read_b32 v58, a78
    v_accvgpr_read_b32 v59, a79
    v_mul_f32 v52, v52, v49
    v_mul_f32 v53, v53, v49
    v_mul_f32 v54, v54, v49
    v_mul_f32 v55, v55, v49
    v_mul_f32 v56, v56, v49
    v_mul_f32 v57, v57, v49
    v_mul_f32 v58, v58, v49
    v_mul_f32 v59, v59, v49
    v_accvgpr_write_b32 a72, v52
    v_accvgpr_write_b32 a73, v53
    v_accvgpr_write_b32 a74, v54
    v_accvgpr_write_b32 a75, v55
    v_accvgpr_write_b32 a76, v56
    v_accvgpr_write_b32 a77, v57
    v_accvgpr_write_b32 a78, v58
    v_accvgpr_write_b32 a79, v59
    v_accvgpr_read_b32 v52, a80
    v_accvgpr_read_b32 v53, a81
    v_accvgpr_read_b32 v54, a82
    v_accvgpr_read_b32 v55, a83
    v_accvgpr_read_b32 v56, a84
    v_accvgpr_read_b32 v57, a85
    v_accvgpr_read_b32 v58, a86
    v_accvgpr_read_b32 v59, a87
    v_mul_f32 v52, v52, v49
    v_mul_f32 v53, v53, v49
    v_mul_f32 v54, v54, v49
    v_mul_f32 v55, v55, v49
    v_mul_f32 v56, v56, v49
    v_mul_f32 v57, v57, v49
    v_mul_f32 v58, v58, v49
    v_mul_f32 v59, v59, v49
    v_accvgpr_write_b32 a80, v52
    v_accvgpr_write_b32 a81, v53
    v_accvgpr_write_b32 a82, v54
    v_accvgpr_write_b32 a83, v55
    v_accvgpr_write_b32 a84, v56
    v_accvgpr_write_b32 a85, v57
    v_accvgpr_write_b32 a86, v58
    v_accvgpr_write_b32 a87, v59
    v_accvgpr_read_b32 v52, a88
    v_accvgpr_read_b32 v53, a89
    v_accvgpr_read_b32 v54, a90
    v_accvgpr_read_b32 v55, a91
    v_accvgpr_read_b32 v56, a92
    v_accvgpr_read_b32 v57, a93
    v_accvgpr_read_b32 v58, a94
    v_accvgpr_read_b32 v59, a95
    v_mul_f32 v52, v52, v49
    v_mul_f32 v53, v53, v49
    v_mul_f32 v54, v54, v49
    v_mul_f32 v55, v55, v49
    v_mul_f32 v56, v56, v49
    v_mul_f32 v57, v57, v49
    v_mul_f32 v58, v58, v49
    v_mul_f32 v59, v59, v49
    v_accvgpr_write_b32 a88, v52
    v_accvgpr_write_b32 a89, v53
    v_accvgpr_write_b32 a90, v54
    v_accvgpr_write_b32 a91, v55
    v_accvgpr_write_b32 a92, v56
    v_accvgpr_write_b32 a93, v57
    v_accvgpr_write_b32 a94, v58
    v_accvgpr_write_b32 a95, v59
    v_exp_f32 v52, v112
    v_exp_f32 v53, v113
    v_exp_f32 v54, v114
    v_exp_f32 v55, v115
    v_exp_f32 v56, v116
    v_exp_f32 v57, v117
    v_exp_f32 v58, v118
    v_exp_f32 v59, v119
    s_nop 0
    v_cvt_pk_bf16_f32 v152, v52, v53
    v_cvt_pk_bf16_f32 v153, v54, v55
    v_cvt_pk_bf16_f32 v154, v56, v57
    v_cvt_pk_bf16_f32 v155, v58, v59
    s_nop 1
    v_mfma_f32_16x16x32_bf16 v[36:39], v[44:47], v[152:155], 0
    v_max3_f32 v48, v120, v121, v122
    v_max3_f32 v48, v48, v123, v124
    v_max3_f32 v48, v48, v125, v126
    v_max3_f32 v48, v48, v127, 0
    v_mov_b32 v49, v48
    s_nop 1
    v_permlane32_swap_b32 v48, v49
    s_nop 1
    v_max_f32 v48, v48, v49
    v_mov_b32 v49, v48
    s_nop 1
    v_permlane16_swap_b32 v48, v49
    s_nop 1
    v_max_f32 v48, v48, v49
    v_exp_f32 v49, -v48
    v_sub_f32 v120, v120, v48
    v_sub_f32 v121, v121, v48
    v_sub_f32 v122, v122, v48
    v_sub_f32 v123, v123, v48
    v_sub_f32 v124, v124, v48
    v_sub_f32 v125, v125, v48
    v_sub_f32 v126, v126, v48
    v_sub_f32 v127, v127, v48
    v_sub_f32 v88, v88, v48
    v_sub_f32 v89, v89, v48
    v_sub_f32 v90, v90, v48
    v_sub_f32 v91, v91, v48
    v_sub_f32 v92, v92, v48
    v_sub_f32 v93, v93, v48
    v_sub_f32 v94, v94, v48
    v_sub_f32 v95, v95, v48
    v_sub_f32 v184, v184, v48
    v_sub_f32 v185, v185, v48
    v_sub_f32 v186, v186, v48
    v_sub_f32 v187, v187, v48
    v_sub_f32 v188, v188, v48
    v_sub_f32 v189, v189, v48
    v_sub_f32 v190, v190, v48
    v_sub_f32 v191, v191, v48
    v_mul_f32 v15, v15, v49
    v_accvgpr_read_b32 v52, a96
    v_accvgpr_read_b32 v53, a97
    v_accvgpr_read_b32 v54, a98
    v_accvgpr_read_b32 v55, a99
    v_accvgpr_read_b32 v56, a100
    v_accvgpr_read_b32 v57, a101
    v_accvgpr_read_b32 v58, a102
    v_accvgpr_read_b32 v59, a103
    v_mul_f32 v52, v52, v49
    v_mul_f32 v53, v53, v49
    v_mul_f32 v54, v54, v49
    v_mul_f32 v55, v55, v49
    v_mul_f32 v56, v56, v49
    v_mul_f32 v57, v57, v49
    v_mul_f32 v58, v58, v49
    v_mul_f32 v59, v59, v49
    v_accvgpr_write_b32 a96, v52
    v_accvgpr_write_b32 a97, v53
    v_accvgpr_write_b32 a98, v54
    v_accvgpr_write_b32 a99, v55
    v_accvgpr_write_b32 a100, v56
    v_accvgpr_write_b32 a101, v57
    v_accvgpr_write_b32 a102, v58
    v_accvgpr_write_b32 a103, v59
    v_accvgpr_read_b32 v52, a104
    v_accvgpr_read_b32 v53, a105
    v_accvgpr_read_b32 v54, a106
    v_accvgpr_read_b32 v55, a107
    v_accvgpr_read_b32 v56, a108
    v_accvgpr_read_b32 v57, a109
    v_accvgpr_read_b32 v58, a110
    v_accvgpr_read_b32 v59, a111
    v_mul_f32 v52, v52, v49
    v_mul_f32 v53, v53, v49
    v_mul_f32 v54, v54, v49
    v_mul_f32 v55, v55, v49
    v_mul_f32 v56, v56, v49
    v_mul_f32 v57, v57, v49
    v_mul_f32 v58, v58, v49
    v_mul_f32 v59, v59, v49
    v_accvgpr_write_b32 a104, v52
    v_accvgpr_write_b32 a105, v53
    v_accvgpr_write_b32 a106, v54
    v_accvgpr_write_b32 a107, v55
    v_accvgpr_write_b32 a108, v56
    v_accvgpr_write_b32 a109, v57
    v_accvgpr_write_b32 a110, v58
    v_accvgpr_write_b32 a111, v59
    v_accvgpr_read_b32 v52, a112
    v_accvgpr_read_b32 v53, a113
    v_accvgpr_read_b32 v54, a114
    v_accvgpr_read_b32 v55, a115
    v_accvgpr_read_b32 v56, a116
    v_accvgpr_read_b32 v57, a117
    v_accvgpr_read_b32 v58, a118
    v_accvgpr_read_b32 v59, a119
    v_mul_f32 v52, v52, v49
    v_mul_f32 v53, v53, v49
    v_mul_f32 v54, v54, v49
    v_mul_f32 v55, v55, v49
    v_mul_f32 v56, v56, v49
    v_mul_f32 v57, v57, v49
    v_mul_f32 v58, v58, v49
    v_mul_f32 v59, v59, v49
    v_accvgpr_write_b32 a112, v52
    v_accvgpr_write_b32 a113, v53
    v_accvgpr_write_b32 a114, v54
    v_accvgpr_write_b32 a115, v55
    v_accvgpr_write_b32 a116, v56
    v_accvgpr_write_b32 a117, v57
    v_accvgpr_write_b32 a118, v58
    v_accvgpr_write_b32 a119, v59
    v_accvgpr_read_b32 v52, a120
    v_accvgpr_read_b32 v53, a121
    v_accvgpr_read_b32 v54, a122
    v_accvgpr_read_b32 v55, a123
    v_accvgpr_read_b32 v56, a124
    v_accvgpr_read_b32 v57, a125
    v_accvgpr_read_b32 v58, a126
    v_accvgpr_read_b32 v59, a127
    v_mul_f32 v52, v52, v49
    v_mul_f32 v53, v53, v49
    v_mul_f32 v54, v54, v49
    v_mul_f32 v55, v55, v49
    v_mul_f32 v56, v56, v49
    v_mul_f32 v57, v57, v49
    v_mul_f32 v58, v58, v49
    v_mul_f32 v59, v59, v49
    v_accvgpr_write_b32 a120, v52
    v_accvgpr_write_b32 a121, v53
    v_accvgpr_write_b32 a122, v54
    v_accvgpr_write_b32 a123, v55
    v_accvgpr_write_b32 a124, v56
    v_accvgpr_write_b32 a125, v57
    v_accvgpr_write_b32 a126, v58
    v_accvgpr_write_b32 a127, v59
    v_exp_f32 v52, v120
    v_exp_f32 v53, v121
    v_exp_f32 v54, v122
    v_exp_f32 v55, v123
    v_exp_f32 v56, v124
    v_exp_f32 v57, v125
    v_exp_f32 v58, v126
    v_exp_f32 v59, v127
    s_nop 0
    v_cvt_pk_bf16_f32 v156, v52, v53
    v_cvt_pk_bf16_f32 v157, v54, v55
    v_cvt_pk_bf16_f32 v158, v56, v57
    v_cvt_pk_bf16_f32 v159, v58, v59
    s_nop 1
    v_mfma_f32_16x16x32_bf16 v[40:43], v[44:47], v[156:159], 0
    s_nop 7
    s_setpc_b64 s[70:71]
mega_kernel_hook13:
    s_cmp_lg_u32 s16, 0
    s_cbranch_scc1 mega_kernel_np37
    v_mov_b32 v4, s4
    v_mov_b32 v5, s5
    s_add_u32 s90, s17, 117440512
    s_mov_b64 exec, 1
    buffer_store_dwordx2 v[4:5], off, s[8:11], s90 sc1
    s_mov_b64 exec, -1
mega_kernel_np37:
    s_mov_b32 s17, -1
    s_branch mega_kernel_hookr14
mega_kernel_hook17:
    s_cmp_lg_u32 s16, 0
    s_cbranch_scc1 mega_kernel_np38
    v_mov_b32 v4, s4
    v_mov_b32 v5, s5
    s_add_u32 s90, s17, 117440512
    s_mov_b64 exec, 1
    buffer_store_dwordx2 v[4:5], off, s[8:11], s90 sc1
    s_mov_b64 exec, -1
mega_kernel_np38:
    s_mov_b32 s17, -1
    s_branch mega_kernel_hookr18
mega_kernel_dosw16:
    s_cmp_eq_u32 s17, -1
    s_cbranch_scc1 mega_kernel_x39
    s_cmp_lg_u32 s16, 0
    s_cbranch_scc1 mega_kernel_np44
    v_mov_b32 v4, s4
    v_mov_b32 v5, s5
    s_add_u32 s90, s17, 117440512
    s_mov_b64 exec, 1
    buffer_store_dwordx2 v[4:5], off, s[8:11], s90 sc1
    s_mov_b64 exec, -1
mega_kernel_np44:
    s_mov_b32 s17, -1
    s_mov_b32 s67, 3
    s_cmp_gt_u32 s65, 3
    s_cbranch_scc1 mega_kernel_loop15
mega_kernel_x39:
    s_cmp_eq_u32 s94, 0
    s_cbranch_scc1 mega_kernel_x40
    s_mov_b32 s42, s73
    s_mov_b32 s46, s76
    s_lshl_b32 s90, s77, 4
    s_lshl_b32 s90, s90, s81
    s_mov_b32 s48, s79
    s_mul_i32 s91, s90, 1
    s_add_u32 s49, s91, s79
    s_sub_u32 s49, s49, 2048
    s_mul_i32 s91, s90, 2
    s_add_u32 s50, s91, s79
    s_mul_i32 s91, s90, 3
    s_add_u32 s51, s91, s79
    s_sub_u32 s51, s51, 2048
    s_mov_b32 s52, s80
    s_lshl_b32 s90, s78, 2
    s_mul_i32 s91, s90, 1
    s_add_u32 s53, s91, s80
    s_sub_u32 s53, s53, 2048
    s_mul_i32 s91, s90, 2
    s_add_u32 s54, s91, s80
    s_mul_i32 s91, s90, 3
    s_add_u32 s55, s91, s80
    s_sub_u32 s55, s55, 2048
    s_lshl_b32 s56, s78, 6
    s_lshl_b32 s90, s58, 7
    s_add_u32 s90, s90, s57
    s_lshl_b32 s91, s16, 6
    s_cmp_eq_u32 s81, 1
    s_cselect_b32 s90, s90, s91
    v_lshrrev_b32 v24, 3, v1
    v_lshlrev_b32 v24, s81, v24
    v_add_u32 v24, s90, v24
    v_mul_lo_u32 v24, v24, s77
    v_lshrrev_b32 v25, 4, v1
    v_and_b32 v26, 7, v1
    v_xor_b32 v25, v25, v26
    v_lshl_add_u32 v16, v25, 4, v24
    v_xor_b32 v25, 4, v25
    v_lshl_add_u32 v17, v25, 4, v24
    s_lshl_b32 s90, s77, 3
    s_lshl_b32 s90, s90, s81
    s_sub_u32 s90, s90, 1024
    v_add_u32 v17, s90, v17
    v_lshrrev_b32 v24, 5, v1
    s_lshl_b32 s90, s16, 4
    v_add_u32 v25, s90, v24
    v_mul_lo_u32 v25, v25, s78
    v_lshlrev_b32 v24, 1, v24
    v_and_b32 v26, 31, v1
    v_xor_b32 v24, v24, v26
    s_lshl_b32 s90, s78, 1
    s_sub_u32 s90, s90, 1024
    v_add_u32 v27, s90, v25
    v_xor_b32 v26, 0, v24
    v_lshl_add_u32 v18, v26, 4, v25
    v_xor_b32 v26, 4, v24
    v_lshl_add_u32 v19, v26, 4, v27
    v_xor_b32 v26, 8, v24
    v_lshl_add_u32 v20, v26, 4, v25
    v_xor_b32 v26, 12, v24
    v_lshl_add_u32 v21, v26, 4, v27
    s_mov_b32 s40, s71
    s_mov_b32 s41, s72
    s_mov_b32 s44, s74
    s_mov_b32 s45, s75
    buffer_load_dwordx2 v[4:5], off, s[12:15], 0 sc1
    s_mov_b32 s67, 0
    s_branch mega_kernel_loop15
mega_kernel_x40:
    s_cmp_eq_u32 s70, 1
    s_cbranch_scc1 mega_kernel_x43
    s_cmp_lg_u32 s65, 3
    s_cbranch_scc1 mega_kernel_x41
    s_and_b32 s92, s2, 7
    s_lshl_b32 s92, s92, 2
    s_bfe_u32 s93, s2, 0x20003
    s_add_u32 s92, s92, s93
    s_lshr_b32 s93, s2, 5
    s_lshl_b32 s93, s93, 2
    s_or_b32 s93, s93, 0x40000
    s_lshr_b32 s90, s92, 1
    s_lshl_b32 s90, s90, 7
    s_add_u32 s90, s90, 117440512
    v_min_u32 v0, 7, v1
    v_add_u32 v0, 8, v0
    v_lshlrev_b32 v0, 3, v0
    buffer_load_dwordx2 v[4:5], v0, s[8:11], s90 offen sc1
    s_branch mega_kernel_loop15
mega_kernel_x41:
    s_waitcnt vmcnt(16)
    s_cmp_lg_u32 s65, 2
    s_cbranch_scc1 mega_kernel_x42
    s_mov_b32 s3, 1048576
mega_kernel_spin45:
    v_cmp_ne_u64 s[22:23], s[4:5], v[4:5]
    s_nop 3
    s_cmp_eq_u64 s[22:23], 0
    s_cbranch_scc1 mega_kernel_ok46
    s_sub_u32 s3, s3, 1
    s_cbranch_scc1 mega_kernel_ok46
    s_sleep 16
    s_and_b32 s92, s2, 7
    s_lshl_b32 s92, s92, 2
    s_bfe_u32 s93, s2, 0x20003
    s_add_u32 s92, s92, s93
    s_lshr_b32 s93, s2, 5
    s_lshl_b32 s93, s93, 2
    s_or_b32 s93, s93, 0x40000
    s_lshr_b32 s90, s92, 1
    s_lshl_b32 s90, s90, 7
    s_add_u32 s90, s90, 117440512
    v_min_u32 v0, 7, v1
    v_add_u32 v0, 8, v0
    v_lshlrev_b32 v0, 3, v0
    buffer_load_dwordx2 v[4:5], v0, s[8:11], s90 offen sc1
    s_waitcnt vmcnt(0)
    s_branch mega_kernel_spin45
mega_kernel_ok46:
    s_and_b32 s92, s2, 7
    s_lshl_b32 s92, s92, 2
    s_bfe_u32 s93, s2, 0x20003
    s_add_u32 s92, s92, s93
    s_lshr_b32 s93, s2, 5
    s_lshl_b32 s93, s93, 2
    s_or_b32 s93, s93, 0x40000
    s_lshr_b32 s90, s92, 1
    s_lshl_b32 s90, s90, 7
    s_add_u32 s90, s90, 117440512
    s_bfe_u32 s91, 1376806003, s93
    s_lshr_b32 s91, s91, 1
    v_mov_b32 v0, s91
    s_bfe_u32 s91, 4242446987, s93
    s_lshr_b32 s91, s91, 1
    v_writelane_b32 v0, s91, 8
    v_lshlrev_b32 v0, 3, v0
    buffer_load_dwordx2 v[4:5], v0, s[8:11], s90 offen sc1
    s_lshl_b32 s90, s92, 19
    s_lshl_b32 s91, s58, 13
    s_add_u32 s90, s90, s91
    s_cmp_eq_u32 s57, 0
    s_mov_b32 s91, 33554432
    s_cselect_b32 s91, 16777216, s91
    s_mov_b32 s42, 0
    s_cselect_b32 s42, 268435456, s42
    s_add_u32 s48, s90, s91
    s_mov_b32 s49, s48
    s_add_u32 s50, s48, 4096
    s_mov_b32 s51, s50
    s_mov_b32 s40, s6
    s_mov_b32 s41, s7
    s_lshl_b32 s90, s92, 19
    s_lshl_b32 s91, s58, 13
    s_add_u32 s90, s90, s91
    s_cmp_eq_u32 s57, 0
    s_mov_b32 s91, 33587200
    s_cselect_b32 s91, 16826368, s91
    s_mov_b32 s46, 268435456
    s_cselect_b32 s46, 268435456, s46
    s_add_u32 s52, s90, s91
    s_mov_b32 s53, s52
    s_add_u32 s54, s52, 4096
    s_mov_b32 s55, s54
    s_mov_b32 s44, s6
    s_mov_b32 s45, s7
    v_mov_b32 v16, v2
    v_mov_b32 v17, v2
    v_mov_b32 v18, v2
    v_mov_b32 v19, v2
    v_mov_b32 v20, v2
    v_mov_b32 v21, v2
    s_branch mega_kernel_loop15
mega_kernel_x42:
    s_mov_b32 s3, 1048576
mega_kernel_spin47:
    v_cmp_ne_u64 s[22:23], s[4:5], v[4:5]
    s_nop 3
    s_cmp_eq_u64 s[22:23], 0
    s_cbranch_scc1 mega_kernel_ok48
    s_sub_u32 s3, s3, 1
    s_cbranch_scc1 mega_kernel_ok48
    s_sleep 16
    s_and_b32 s92, s2, 7
    s_lshl_b32 s92, s92, 2
    s_bfe_u32 s93, s2, 0x20003
    s_add_u32 s92, s92, s93
    s_lshr_b32 s93, s2, 5
    s_lshl_b32 s93, s93, 2
    s_or_b32 s93, s93, 0x40000
    s_lshr_b32 s90, s92, 1
    s_lshl_b32 s90, s90, 7
    s_add_u32 s90, s90, 117440512
    s_bfe_u32 s91, 1376806003, s93
    s_lshr_b32 s91, s91, 1
    v_mov_b32 v0, s91
    s_bfe_u32 s91, 4242446987, s93
    s_lshr_b32 s91, s91, 1
    v_writelane_b32 v0, s91, 8
    v_lshlrev_b32 v0, 3, v0
    buffer_load_dwordx2 v[4:5], v0, s[8:11], s90 offen sc1
    s_waitcnt vmcnt(0)
    s_branch mega_kernel_spin47
mega_kernel_ok48:
    s_and_b32 s92, s2, 7
    s_lshl_b32 s92, s92, 2
    s_bfe_u32 s93, s2, 0x20003
    s_add_u32 s92, s92, s93
    s_lshr_b32 s93, s2, 5
    s_lshl_b32 s93, s93, 2
    s_or_b32 s93, s93, 0x40000
    s_bfe_u32 s90, 4242446987, s93
    s_lshl_b32 s90, s90, 3
    s_lshl_b32 s91, s16, 1
    s_add_u32 s90, s90, s91
    s_lshl_b32 s90, s90, 12
    s_lshl_b32 s91, s92, 19
    s_add_u32 s90, s90, s91
    s_add_u32 s90, s90, 0
    buffer_load_dwordx4 a[128:131], v2, s[8:11], s90 offen offset:0 sc1
    buffer_load_dwordx4 a[132:135], v2, s[8:11], s90 offen offset:1024 sc1
    buffer_load_dwordx4 a[136:139], v2, s[8:11], s90 offen offset:2048 sc1
    buffer_load_dwordx4 a[140:143], v2, s[8:11], s90 offen offset:3072 sc1
    s_bfe_u32 s90, 4242446987, s93
    s_lshl_b32 s90, s90, 3
    s_lshl_b32 s91, s16, 1
    s_add_u32 s90, s90, s91
    s_lshl_b32 s90, s90, 12
    s_lshl_b32 s91, s92, 19
    s_add_u32 s90, s90, s91
    s_add_u32 s90, s90, 4096
    buffer_load_dwordx4 a[144:147], v2, s[8:11], s90 offen offset:0 sc1
    buffer_load_dwordx4 a[148:151], v2, s[8:11], s90 offen offset:1024 sc1
    buffer_load_dwordx4 a[152:155], v2, s[8:11], s90 offen offset:2048 sc1
    buffer_load_dwordx4 a[156:159], v2, s[8:11], s90 offen offset:3072 sc1
    s_bfe_u32 s90, 1376806003, s93
    s_lshl_b32 s90, s90, 3
    s_lshl_b32 s91, s16, 1
    s_add_u32 s90, s90, s91
    s_lshl_b32 s90, s90, 12
    s_lshl_b32 s91, s92, 19
    s_add_u32 s90, s90, s91
    s_add_u32 s90, s90, 0
    buffer_load_dwordx4 a[160:163], v2, s[8:11], s90 offen offset:0 sc1
    buffer_load_dwordx4 a[164:167], v2, s[8:11], s90 offen offset:1024 sc1
    buffer_load_dwordx4 a[168:171], v2, s[8:11], s90 offen offset:2048 sc1
    buffer_load_dwordx4 a[172:175], v2, s[8:11], s90 offen offset:3072 sc1
    s_bfe_u32 s90, 1376806003, s93
    s_lshl_b32 s90, s90, 3
    s_lshl_b32 s91, s16, 1
    s_add_u32 s90, s90, s91
    s_lshl_b32 s90, s90, 12
    s_lshl_b32 s91, s92, 19
    s_add_u32 s90, s90, s91
    s_add_u32 s90, s90, 4096
    buffer_load_dwordx4 a[176:179], v2, s[8:11], s90 offen offset:0 sc1
    buffer_load_dwordx4 a[180:183], v2, s[8:11], s90 offen offset:1024 sc1
    buffer_load_dwordx4 a[184:187], v2, s[8:11], s90 offen offset:2048 sc1
    buffer_load_dwordx4 a[188:191], v2, s[8:11], s90 offen offset:3072 sc1
    s_lshl_b32 s90, s92, 19
    s_lshl_b32 s91, s58, 13
    s_add_u32 s90, s90, s91
    s_cmp_eq_u32 s57, 0
    s_mov_b32 s91, 33554432
    s_cselect_b32 s91, 16793600, s91
    s_mov_b32 s42, 268435456
    s_cselect_b32 s42, 268435456, s42
    s_add_u32 s48, s90, s91
    s_mov_b32 s49, s48
    s_add_u32 s50, s48, 4096
    s_mov_b32 s51, s50
    s_mov_b32 s40, s6
    s_mov_b32 s41, s7
    s_mov_b32 s46, 0
    s_branch mega_kernel_loop15
mega_kernel_x43:
    s_mov_b32 s42, 0
    s_mov_b32 s46, 0
    s_branch mega_kernel_loop15
mega_kernel_dosw20:
    s_cmp_eq_u32 s17, -1
    s_cbranch_scc1 mega_kernel_x49
    s_cmp_lg_u32 s16, 0
    s_cbranch_scc1 mega_kernel_np54
    v_mov_b32 v4, s4
    v_mov_b32 v5, s5
    s_add_u32 s90, s17, 117440512
    s_mov_b64 exec, 1
    buffer_store_dwordx2 v[4:5], off, s[8:11], s90 sc1
    s_mov_b64 exec, -1
mega_kernel_np54:
    s_mov_b32 s17, -1
    s_mov_b32 s67, 3
    s_cmp_gt_u32 s65, 3
    s_cbranch_scc1 mega_kernel_loop19
mega_kernel_x49:
    s_cmp_eq_u32 s94, 0
    s_cbranch_scc1 mega_kernel_x50
    s_mov_b32 s42, s73
    s_mov_b32 s46, s76
    s_lshl_b32 s90, s77, 4
    s_lshl_b32 s90, s90, s81
    s_mov_b32 s48, s79
    s_mul_i32 s91, s90, 1
    s_add_u32 s49, s91, s79
    s_sub_u32 s49, s49, 2048
    s_mul_i32 s91, s90, 2
    s_add_u32 s50, s91, s79
    s_mul_i32 s91, s90, 3
    s_add_u32 s51, s91, s79
    s_sub_u32 s51, s51, 2048
    s_mov_b32 s52, s80
    s_lshl_b32 s90, s78, 2
    s_mul_i32 s91, s90, 1
    s_add_u32 s53, s91, s80
    s_sub_u32 s53, s53, 2048
    s_mul_i32 s91, s90, 2
    s_add_u32 s54, s91, s80
    s_mul_i32 s91, s90, 3
    s_add_u32 s55, s91, s80
    s_sub_u32 s55, s55, 2048
    s_lshl_b32 s56, s78, 6
    s_lshl_b32 s90, s58, 7
    s_add_u32 s90, s90, s57
    s_lshl_b32 s91, s16, 6
    s_cmp_eq_u32 s81, 1
    s_cselect_b32 s90, s90, s91
    v_lshrrev_b32 v24, 3, v1
    v_lshlrev_b32 v24, s81, v24
    v_add_u32 v24, s90, v24
    v_mul_lo_u32 v24, v24, s77
    v_lshrrev_b32 v25, 4, v1
    v_and_b32 v26, 7, v1
    v_xor_b32 v25, v25, v26
    v_lshl_add_u32 v16, v25, 4, v24
    v_xor_b32 v25, 4, v25
    v_lshl_add_u32 v17, v25, 4, v24
    s_lshl_b32 s90, s77, 3
    s_lshl_b32 s90, s90, s81
    s_sub_u32 s90, s90, 1024
    v_add_u32 v17, s90, v17
    v_lshrrev_b32 v24, 5, v1
    s_lshl_b32 s90, s16, 4
    v_add_u32 v25, s90, v24
    v_mul_lo_u32 v25, v25, s78
    v_lshlrev_b32 v24, 1, v24
    v_and_b32 v26, 31, v1
    v_xor_b32 v24, v24, v26
    s_lshl_b32 s90, s78, 1
    s_sub_u32 s90, s90, 1024
    v_add_u32 v27, s90, v25
    v_xor_b32 v26, 0, v24
    v_lshl_add_u32 v18, v26, 4, v25
    v_xor_b32 v26, 4, v24
    v_lshl_add_u32 v19, v26, 4, v27
    v_xor_b32 v26, 8, v24
    v_lshl_add_u32 v20, v26, 4, v25
    v_xor_b32 v26, 12, v24
    v_lshl_add_u32 v21, v26, 4, v27
    s_mov_b32 s40, s71
    s_mov_b32 s41, s72
    s_mov_b32 s44, s74
    s_mov_b32 s45, s75
    buffer_load_dwordx2 v[4:5], off, s[12:15], 0 sc1
    s_mov_b32 s67, 0
    s_branch mega_kernel_loop19
mega_kernel_x50:
    s_cmp_eq_u32 s70, 1
    s_cbranch_scc1 mega_kernel_x53
    s_cmp_lg_u32 s65, 3
    s_cbranch_scc1 mega_kernel_x51
    s_and_b32 s92, s2, 7
    s_lshl_b32 s92, s92, 2
    s_bfe_u32 s93, s2, 0x20003
    s_add_u32 s92, s92, s93
    s_lshr_b32 s93, s2, 5
    s_lshl_b32 s93, s93, 2
    s_or_b32 s93, s93, 0x40000
    s_lshr_b32 s90, s92, 1
    s_lshl_b32 s90, s90, 7
    s_add_u32 s90, s90, 117440512
    v_min_u32 v0, 7, v1
    v_add_u32 v0, 8, v0
    v_lshlrev_b32 v0, 3, v0
    buffer_load_dwordx2 v[4:5], v0, s[8:11], s90 offen sc1
    s_branch mega_kernel_loop19
mega_kernel_x51:
    s_waitcnt vmcnt(16)
    s_cmp_lg_u32 s65, 2
    s_cbranch_scc1 mega_kernel_x52
    s_mov_b32 s3, 1048576
mega_kernel_spin55:
    v_cmp_ne_u64 s[22:23], s[4:5], v[4:5]
    s_nop 3
    s_cmp_eq_u64 s[22:23], 0
    s_cbranch_scc1 mega_kernel_ok56
    s_sub_u32 s3, s3, 1
    s_cbranch_scc1 mega_kernel_ok56
    s_sleep 16
    s_and_b32 s92, s2, 7
    s_lshl_b32 s92, s92, 2
    s_bfe_u32 s93, s2, 0x20003
    s_add_u32 s92, s92, s93
    s_lshr_b32 s93, s2, 5
    s_lshl_b32 s93, s93, 2
    s_or_b32 s93, s93, 0x40000
    s_lshr_b32 s90, s92, 1
    s_lshl_b32 s90, s90, 7
    s_add_u32 s90, s90, 117440512
    v_min_u32 v0, 7, v1
    v_add_u32 v0, 8, v0
    v_lshlrev_b32 v0, 3, v0
    buffer_load_dwordx2 v[4:5], v0, s[8:11], s90 offen sc1
    s_waitcnt vmcnt(0)
    s_branch mega_kernel_spin55
mega_kernel_ok56:
    s_and_b32 s92, s2, 7
    s_lshl_b32 s92, s92, 2
    s_bfe_u32 s93, s2, 0x20003
    s_add_u32 s92, s92, s93
    s_lshr_b32 s93, s2, 5
    s_lshl_b32 s93, s93, 2
    s_or_b32 s93, s93, 0x40000
    s_lshr_b32 s90, s92, 1
    s_lshl_b32 s90, s90, 7
    s_add_u32 s90, s90, 117440512
    s_bfe_u32 s91, 1376806003, s93
    s_lshr_b32 s91, s91, 1
    v_mov_b32 v0, s91
    s_bfe_u32 s91, 4242446987, s93
    s_lshr_b32 s91, s91, 1
    v_writelane_b32 v0, s91, 8
    v_lshlrev_b32 v0, 3, v0
    buffer_load_dwordx2 v[4:5], v0, s[8:11], s90 offen sc1
    s_lshl_b32 s90, s92, 19
    s_lshl_b32 s91, s58, 13
    s_add_u32 s90, s90, s91
    s_cmp_eq_u32 s57, 0
    s_mov_b32 s91, 33554432
    s_cselect_b32 s91, 16777216, s91
    s_mov_b32 s42, 0
    s_cselect_b32 s42, 268435456, s42
    s_add_u32 s48, s90, s91
    s_mov_b32 s49, s48
    s_add_u32 s50, s48, 4096
    s_mov_b32 s51, s50
    s_mov_b32 s40, s6
    s_mov_b32 s41, s7
    s_lshl_b32 s90, s92, 19
    s_lshl_b32 s91, s58, 13
    s_add_u32 s90, s90, s91
    s_cmp_eq_u32 s57, 0
    s_mov_b32 s91, 33587200
    s_cselect_b32 s91, 16826368, s91
    s_mov_b32 s46, 268435456
    s_cselect_b32 s46, 268435456, s46
    s_add_u32 s52, s90, s91
    s_mov_b32 s53, s52
    s_add_u32 s54, s52, 4096
    s_mov_b32 s55, s54
    s_mov_b32 s44, s6
    s_mov_b32 s45, s7
    v_mov_b32 v16, v2
    v_mov_b32 v17, v2
    v_mov_b32 v18, v2
    v_mov_b32 v19, v2
    v_mov_b32 v20, v2
    v_mov_b32 v21, v2
    s_branch mega_kernel_loop19
mega_kernel_x52:
    s_mov_b32 s3, 1048576
mega_kernel_spin57:
    v_cmp_ne_u64 s[22:23], s[4:5], v[4:5]
    s_nop 3
    s_cmp_eq_u64 s[22:23], 0
    s_cbranch_scc1 mega_kernel_ok58
    s_sub_u32 s3, s3, 1
    s_cbranch_scc1 mega_kernel_ok58
    s_sleep 16
    s_and_b32 s92, s2, 7
    s_lshl_b32 s92, s92, 2
    s_bfe_u32 s93, s2, 0x20003
    s_add_u32 s92, s92, s93
    s_lshr_b32 s93, s2, 5
    s_lshl_b32 s93, s93, 2
    s_or_b32 s93, s93, 0x40000
    s_lshr_b32 s90, s92, 1
    s_lshl_b32 s90, s90, 7
    s_add_u32 s90, s90, 117440512
    s_bfe_u32 s91, 1376806003, s93
    s_lshr_b32 s91, s91, 1
    v_mov_b32 v0, s91
    s_bfe_u32 s91, 4242446987, s93
    s_lshr_b32 s91, s91, 1
    v_writelane_b32 v0, s91, 8
    v_lshlrev_b32 v0, 3, v0
    buffer_load_dwordx2 v[4:5], v0, s[8:11], s90 offen sc1
    s_waitcnt vmcnt(0)
    s_branch mega_kernel_spin57
mega_kernel_ok58:
    s_and_b32 s92, s2, 7
    s_lshl_b32 s92, s92, 2
    s_bfe_u32 s93, s2, 0x20003
    s_add_u32 s92, s92, s93
    s_lshr_b32 s93, s2, 5
    s_lshl_b32 s93, s93, 2
    s_or_b32 s93, s93, 0x40000
    s_bfe_u32 s90, 4242446987, s93
    s_lshl_b32 s90, s90, 3
    s_lshl_b32 s91, s16, 1
    s_add_u32 s90, s90, s91
    s_lshl_b32 s90, s90, 12
    s_lshl_b32 s91, s92, 19
    s_add_u32 s90, s90, s91
    s_add_u32 s90, s90, 0
    buffer_load_dwordx4 a[128:131], v2, s[8:11], s90 offen offset:0 sc1
    buffer_load_dwordx4 a[132:135], v2, s[8:11], s90 offen offset:1024 sc1
    buffer_load_dwordx4 a[136:139], v2, s[8:11], s90 offen offset:2048 sc1
    buffer_load_dwordx4 a[140:143], v2, s[8:11], s90 offen offset:3072 sc1
    s_bfe_u32 s90, 4242446987, s93
    s_lshl_b32 s90, s90, 3
    s_lshl_b32 s91, s16, 1
    s_add_u32 s90, s90, s91
    s_lshl_b32 s90, s90, 12
    s_lshl_b32 s91, s92, 19
    s_add_u32 s90, s90, s91
    s_add_u32 s90, s90, 4096
    buffer_load_dwordx4 a[144:147], v2, s[8:11], s90 offen offset:0 sc1
    buffer_load_dwordx4 a[148:151], v2, s[8:11], s90 offen offset:1024 sc1
    buffer_load_dwordx4 a[152:155], v2, s[8:11], s90 offen offset:2048 sc1
    buffer_load_dwordx4 a[156:159], v2, s[8:11], s90 offen offset:3072 sc1
    s_bfe_u32 s90, 1376806003, s93
    s_lshl_b32 s90, s90, 3
    s_lshl_b32 s91, s16, 1
    s_add_u32 s90, s90, s91
    s_lshl_b32 s90, s90, 12
    s_lshl_b32 s91, s92, 19
    s_add_u32 s90, s90, s91
    s_add_u32 s90, s90, 0
    buffer_load_dwordx4 a[160:163], v2, s[8:11], s90 offen offset:0 sc1
    buffer_load_dwordx4 a[164:167], v2, s[8:11], s90 offen offset:1024 sc1
    buffer_load_dwordx4 a[168:171], v2, s[8:11], s90 offen offset:2048 sc1
    buffer_load_dwordx4 a[172:175], v2, s[8:11], s90 offen offset:3072 sc1
    s_bfe_u32 s90, 1376806003, s93
    s_lshl_b32 s90, s90, 3
    s_lshl_b32 s91, s16, 1
    s_add_u32 s90, s90, s91
    s_lshl_b32 s90, s90, 12
    s_lshl_b32 s91, s92, 19
    s_add_u32 s90, s90, s91
    s_add_u32 s90, s90, 4096
    buffer_load_dwordx4 a[176:179], v2, s[8:11], s90 offen offset:0 sc1
    buffer_load_dwordx4 a[180:183], v2, s[8:11], s90 offen offset:1024 sc1
    buffer_load_dwordx4 a[184:187], v2, s[8:11], s90 offen offset:2048 sc1
    buffer_load_dwordx4 a[188:191], v2, s[8:11], s90 offen offset:3072 sc1
    s_lshl_b32 s90, s92, 19
    s_lshl_b32 s91, s58, 13
    s_add_u32 s90, s90, s91
    s_cmp_eq_u32 s57, 0
    s_mov_b32 s91, 33554432
    s_cselect_b32 s91, 16793600, s91
    s_mov_b32 s42, 268435456
    s_cselect_b32 s42, 268435456, s42
    s_add_u32 s48, s90, s91
    s_mov_b32 s49, s48
    s_add_u32 s50, s48, 4096
    s_mov_b32 s51, s50
    s_mov_b32 s40, s6
    s_mov_b32 s41, s7
    s_mov_b32 s46, 0
    s_branch mega_kernel_loop19
mega_kernel_x53:
    s_mov_b32 s42, 0
    s_mov_b32 s46, 0
    s_branch mega_kernel_loop19
mega_kernel_eps22:
    s_mov_b32 s92, s97
    s_mov_b32 s93, s97
    s_cmp_eq_u32 s97, 0
    s_cbranch_scc1 mega_kernel_ns359
    v_pk_mul_f32 v[32:33], v[32:33], s[92:93]
    v_pk_mul_f32 v[34:35], v[34:35], s[92:93]
    v_pk_mul_f32 v[36:37], v[36:37], s[92:93]
    v_pk_mul_f32 v[38:39], v[38:39], s[92:93]
    v_cvt_pk_bf16_f32 v32, v32, v33
    v_cvt_pk_bf16_f32 v33, v34, v35
    v_cvt_pk_bf16_f32 v34, v36, v37
    v_cvt_pk_bf16_f32 v35, v38, v39
    v_accvgpr_write_b32 a128, v32
    v_accvgpr_write_b32 a129, v33
    v_accvgpr_write_b32 a130, v34
    v_accvgpr_write_b32 a131, v35
    v_pk_mul_f32 v[40:41], v[40:41], s[92:93]
    v_pk_mul_f32 v[42:43], v[42:43], s[92:93]
    v_pk_mul_f32 v[44:45], v[44:45], s[92:93]
    v_pk_mul_f32 v[46:47], v[46:47], s[92:93]
    v_cvt_pk_bf16_f32 v40, v40, v41
    v_cvt_pk_bf16_f32 v41, v42, v43
    v_cvt_pk_bf16_f32 v42, v44, v45
    v_cvt_pk_bf16_f32 v43, v46, v47
    v_accvgpr_write_b32 a132, v40
    v_accvgpr_write_b32 a133, v41
    v_accvgpr_write_b32 a134, v42
    v_accvgpr_write_b32 a135, v43
    v_pk_mul_f32 v[48:49], v[48:49], s[92:93]
    v_pk_mul_f32 v[50:51], v[50:51], s[92:93]
    v_pk_mul_f32 v[52:53], v[52:53], s[92:93]
    v_pk_mul_f32 v[54:55], v[54:55], s[92:93]
    v_cvt_pk_bf16_f32 v48, v48, v49
    v_cvt_pk_bf16_f32 v49, v50, v51
    v_cvt_pk_bf16_f32 v50, v52, v53
    v_cvt_pk_bf16_f32 v51, v54, v55
    v_accvgpr_write_b32 a136, v48
    v_accvgpr_write_b32 a137, v49
    v_accvgpr_write_b32 a138, v50
    v_accvgpr_write_b32 a139, v51
    v_pk_mul_f32 v[56:57], v[56:57], s[92:93]
    v_pk_mul_f32 v[58:59], v[58:59], s[92:93]
    v_pk_mul_f32 v[60:61], v[60:61], s[92:93]
    v_pk_mul_f32 v[62:63], v[62:63], s[92:93]
    v_cvt_pk_bf16_f32 v56, v56, v57
    v_cvt_pk_bf16_f32 v57, v58, v59
    v_cvt_pk_bf16_f32 v58, v60, v61
    v_cvt_pk_bf16_f32 v59, v62, v63
    v_accvgpr_write_b32 a140, v56
    v_accvgpr_write_b32 a141, v57
    v_accvgpr_write_b32 a142, v58
    v_accvgpr_write_b32 a143, v59
    v_pk_mul_f32 v[64:65], v[64:65], s[92:93]
    v_pk_mul_f32 v[66:67], v[66:67], s[92:93]
    v_pk_mul_f32 v[68:69], v[68:69], s[92:93]
    v_pk_mul_f32 v[70:71], v[70:71], s[92:93]
    v_cvt_pk_bf16_f32 v64, v64, v65
    v_cvt_pk_bf16_f32 v65, v66, v67
    v_cvt_pk_bf16_f32 v66, v68, v69
    v_cvt_pk_bf16_f32 v67, v70, v71
    v_accvgpr_write_b32 a144, v64
    v_accvgpr_write_b32 a145, v65
    v_accvgpr_write_b32 a146, v66
    v_accvgpr_write_b32 a147, v67
    v_pk_mul_f32 v[72:73], v[72:73], s[92:93]
    v_pk_mul_f32 v[74:75], v[74:75], s[92:93]
    v_pk_mul_f32 v[76:77], v[76:77], s[92:93]
    v_pk_mul_f32 v[78:79], v[78:79], s[92:93]
    v_cvt_pk_bf16_f32 v72, v72, v73
    v_cvt_pk_bf16_f32 v73, v74, v75
    v_cvt_pk_bf16_f32 v74, v76, v77
    v_cvt_pk_bf16_f32 v75, v78, v79
    v_accvgpr_write_b32 a148, v72
    v_accvgpr_write_b32 a149, v73
    v_accvgpr_write_b32 a150, v74
    v_accvgpr_write_b32 a151, v75
    v_pk_mul_f32 v[80:81], v[80:81], s[92:93]
    v_pk_mul_f32 v[82:83], v[82:83], s[92:93]
    v_pk_mul_f32 v[84:85], v[84:85], s[92:93]
    v_pk_mul_f32 v[86:87], v[86:87], s[92:93]
    v_cvt_pk_bf16_f32 v80, v80, v81
    v_cvt_pk_bf16_f32 v81, v82, v83
    v_cvt_pk_bf16_f32 v82, v84, v85
    v_cvt_pk_bf16_f32 v83, v86, v87
    v_accvgpr_write_b32 a152, v80
    v_accvgpr_write_b32 a153, v81
    v_accvgpr_write_b32 a154, v82
    v_accvgpr_write_b32 a155, v83
    v_pk_mul_f32 v[88:89], v[88:89], s[92:93]
    v_pk_mul_f32 v[90:91], v[90:91], s[92:93]
    v_pk_mul_f32 v[92:93], v[92:93], s[92:93]
    v_pk_mul_f32 v[94:95], v[94:95], s[92:93]
    v_cvt_pk_bf16_f32 v88, v88, v89
    v_cvt_pk_bf16_f32 v89, v90, v91
    v_cvt_pk_bf16_f32 v90, v92, v93
    v_cvt_pk_bf16_f32 v91, v94, v95
    v_accvgpr_write_b32 a156, v88
    v_accvgpr_write_b32 a157, v89
    v_accvgpr_write_b32 a158, v90
    v_accvgpr_write_b32 a159, v91
    v_pk_mul_f32 v[96:97], v[96:97], s[92:93]
    v_pk_mul_f32 v[98:99], v[98:99], s[92:93]
    v_pk_mul_f32 v[100:101], v[100:101], s[92:93]
    v_pk_mul_f32 v[102:103], v[102:103], s[92:93]
    v_cvt_pk_bf16_f32 v96, v96, v97
    v_cvt_pk_bf16_f32 v97, v98, v99
    v_cvt_pk_bf16_f32 v98, v100, v101
    v_cvt_pk_bf16_f32 v99, v102, v103
    v_accvgpr_write_b32 a160, v96
    v_accvgpr_write_b32 a161, v97
    v_accvgpr_write_b32 a162, v98
    v_accvgpr_write_b32 a163, v99
    v_pk_mul_f32 v[104:105], v[104:105], s[92:93]
    v_pk_mul_f32 v[106:107], v[106:107], s[92:93]
    v_pk_mul_f32 v[108:109], v[108:109], s[92:93]
    v_pk_mul_f32 v[110:111], v[110:111], s[92:93]
    v_cvt_pk_bf16_f32 v104, v104, v105
    v_cvt_pk_bf16_f32 v105, v106, v107
    v_cvt_pk_bf16_f32 v106, v108, v109
    v_cvt_pk_bf16_f32 v107, v110, v111
    v_accvgpr_write_b32 a164, v104
    v_accvgpr_write_b32 a165, v105
    v_accvgpr_write_b32 a166, v106
    v_accvgpr_write_b32 a167, v107
    v_pk_mul_f32 v[112:113], v[112:113], s[92:93]
    v_pk_mul_f32 v[114:115], v[114:115], s[92:93]
    v_pk_mul_f32 v[116:117], v[116:117], s[92:93]
    v_pk_mul_f32 v[118:119], v[118:119], s[92:93]
    v_cvt_pk_bf16_f32 v112, v112, v113
    v_cvt_pk_bf16_f32 v113, v114, v115
    v_cvt_pk_bf16_f32 v114, v116, v117
    v_cvt_pk_bf16_f32 v115, v118, v119
    v_accvgpr_write_b32 a168, v112
    v_accvgpr_write_b32 a169, v113
    v_accvgpr_write_b32 a170, v114
    v_accvgpr_write_b32 a171, v115
    v_pk_mul_f32 v[120:121], v[120:121], s[92:93]
    v_pk_mul_f32 v[122:123], v[122:123], s[92:93]
    v_pk_mul_f32 v[124:125], v[124:125], s[92:93]
    v_pk_mul_f32 v[126:127], v[126:127], s[92:93]
    v_cvt_pk_bf16_f32 v120, v120, v121
    v_cvt_pk_bf16_f32 v121, v122, v123
    v_cvt_pk_bf16_f32 v122, v124, v125
    v_cvt_pk_bf16_f32 v123, v126, v127
    v_accvgpr_write_b32 a172, v120
    v_accvgpr_write_b32 a173, v121
    v_accvgpr_write_b32 a174, v122
    v_accvgpr_write_b32 a175, v123
    v_pk_mul_f32 v[128:129], v[128:129], s[92:93]
    v_pk_mul_f32 v[130:131], v[130:131], s[92:93]
    v_pk_mul_f32 v[132:133], v[132:133], s[92:93]
    v_pk_mul_f32 v[134:135], v[134:135], s[92:93]
    v_cvt_pk_bf16_f32 v128, v128, v129
    v_cvt_pk_bf16_f32 v129, v130, v131
    v_cvt_pk_bf16_f32 v130, v132, v133
    v_cvt_pk_bf16_f32 v131, v134, v135
    v_accvgpr_write_b32 a176, v128
    v_accvgpr_write_b32 a177, v129
    v_accvgpr_write_b32 a178, v130
    v_accvgpr_write_b32 a179, v131
    v_pk_mul_f32 v[136:137], v[136:137], s[92:93]
    v_pk_mul_f32 v[138:139], v[138:139], s[92:93]
    v_pk_mul_f32 v[140:141], v[140:141], s[92:93]
    v_pk_mul_f32 v[142:143], v[142:143], s[92:93]
    v_cvt_pk_bf16_f32 v136, v136, v137
    v_cvt_pk_bf16_f32 v137, v138, v139
    v_cvt_pk_bf16_f32 v138, v140, v141
    v_cvt_pk_bf16_f32 v139, v142, v143
    v_accvgpr_write_b32 a180, v136
    v_accvgpr_write_b32 a181, v137
    v_accvgpr_write_b32 a182, v138
    v_accvgpr_write_b32 a183, v139
    v_pk_mul_f32 v[144:145], v[144:145], s[92:93]
    v_pk_mul_f32 v[146:147], v[146:147], s[92:93]
    v_pk_mul_f32 v[148:149], v[148:149], s[92:93]
    v_pk_mul_f32 v[150:151], v[150:151], s[92:93]
    v_cvt_pk_bf16_f32 v144, v144, v145
    v_cvt_pk_bf16_f32 v145, v146, v147
    v_cvt_pk_bf16_f32 v146, v148, v149
    v_cvt_pk_bf16_f32 v147, v150, v151
    v_accvgpr_write_b32 a184, v144
    v_accvgpr_write_b32 a185, v145
    v_accvgpr_write_b32 a186, v146
    v_accvgpr_write_b32 a187, v147
    v_pk_mul_f32 v[152:153], v[152:153], s[92:93]
    v_pk_mul_f32 v[154:155], v[154:155], s[92:93]
    v_pk_mul_f32 v[156:157], v[156:157], s[92:93]
    v_pk_mul_f32 v[158:159], v[158:159], s[92:93]
    v_cvt_pk_bf16_f32 v152, v152, v153
    v_cvt_pk_bf16_f32 v153, v154, v155
    v_cvt_pk_bf16_f32 v154, v156, v157
    v_cvt_pk_bf16_f32 v155, v158, v159
    v_accvgpr_write_b32 a188, v152
    v_accvgpr_write_b32 a189, v153
    v_accvgpr_write_b32 a190, v154
    v_accvgpr_write_b32 a191, v155
    v_pk_mul_f32 v[160:161], v[160:161], s[92:93]
    v_pk_mul_f32 v[162:163], v[162:163], s[92:93]
    v_pk_mul_f32 v[164:165], v[164:165], s[92:93]
    v_pk_mul_f32 v[166:167], v[166:167], s[92:93]
    v_cvt_pk_bf16_f32 v160, v160, v161
    v_cvt_pk_bf16_f32 v161, v162, v163
    v_cvt_pk_bf16_f32 v162, v164, v165
    v_cvt_pk_bf16_f32 v163, v166, v167
    v_accvgpr_write_b32 a192, v160
    v_accvgpr_write_b32 a193, v161
    v_accvgpr_write_b32 a194, v162
    v_accvgpr_write_b32 a195, v163
    v_pk_mul_f32 v[168:169], v[168:169], s[92:93]
    v_pk_mul_f32 v[170:171], v[170:171], s[92:93]
    v_pk_mul_f32 v[172:173], v[172:173], s[92:93]
    v_pk_mul_f32 v[174:175], v[174:175], s[92:93]
    v_cvt_pk_bf16_f32 v168, v168, v169
    v_cvt_pk_bf16_f32 v169, v170, v171
    v_cvt_pk_bf16_f32 v170, v172, v173
    v_cvt_pk_bf16_f32 v171, v174, v175
    v_accvgpr_write_b32 a196, v168
    v_accvgpr_write_b32 a197, v169
    v_accvgpr_write_b32 a198, v170
    v_accvgpr_write_b32 a199, v171
    v_pk_mul_f32 v[176:177], v[176:177], s[92:93]
    v_pk_mul_f32 v[178:179], v[178:179], s[92:93]
    v_pk_mul_f32 v[180:181], v[180:181], s[92:93]
    v_pk_mul_f32 v[182:183], v[182:183], s[92:93]
    v_cvt_pk_bf16_f32 v176, v176, v177
    v_cvt_pk_bf16_f32 v177, v178, v179
    v_cvt_pk_bf16_f32 v178, v180, v181
    v_cvt_pk_bf16_f32 v179, v182, v183
    v_accvgpr_write_b32 a200, v176
    v_accvgpr_write_b32 a201, v177
    v_accvgpr_write_b32 a202, v178
    v_accvgpr_write_b32 a203, v179
    v_pk_mul_f32 v[184:185], v[184:185], s[92:93]
    v_pk_mul_f32 v[186:187], v[186:187], s[92:93]
    v_pk_mul_f32 v[188:189], v[188:189], s[92:93]
    v_pk_mul_f32 v[190:191], v[190:191], s[92:93]
    v_cvt_pk_bf16_f32 v184, v184, v185
    v_cvt_pk_bf16_f32 v185, v186, v187
    v_cvt_pk_bf16_f32 v186, v188, v189
    v_cvt_pk_bf16_f32 v187, v190, v191
    v_accvgpr_write_b32 a204, v184
    v_accvgpr_write_b32 a205, v185
    v_accvgpr_write_b32 a206, v186
    v_accvgpr_write_b32 a207, v187
    v_pk_mul_f32 v[192:193], v[192:193], s[92:93]
    v_pk_mul_f32 v[194:195], v[194:195], s[92:93]
    v_pk_mul_f32 v[196:197], v[196:197], s[92:93]
    v_pk_mul_f32 v[198:199], v[198:199], s[92:93]
    v_cvt_pk_bf16_f32 v192, v192, v193
    v_cvt_pk_bf16_f32 v193, v194, v195
    v_cvt_pk_bf16_f32 v194, v196, v197
    v_cvt_pk_bf16_f32 v195, v198, v199
    v_accvgpr_write_b32 a208, v192
    v_accvgpr_write_b32 a209, v193
    v_accvgpr_write_b32 a210, v194
    v_accvgpr_write_b32 a211, v195
    v_pk_mul_f32 v[200:201], v[200:201], s[92:93]
    v_pk_mul_f32 v[202:203], v[202:203], s[92:93]
    v_pk_mul_f32 v[204:205], v[204:205], s[92:93]
    v_pk_mul_f32 v[206:207], v[206:207], s[92:93]
    v_cvt_pk_bf16_f32 v200, v200, v201
    v_cvt_pk_bf16_f32 v201, v202, v203
    v_cvt_pk_bf16_f32 v202, v204, v205
    v_cvt_pk_bf16_f32 v203, v206, v207
    v_accvgpr_write_b32 a212, v200
    v_accvgpr_write_b32 a213, v201
    v_accvgpr_write_b32 a214, v202
    v_accvgpr_write_b32 a215, v203
    v_pk_mul_f32 v[208:209], v[208:209], s[92:93]
    v_pk_mul_f32 v[210:211], v[210:211], s[92:93]
    v_pk_mul_f32 v[212:213], v[212:213], s[92:93]
    v_pk_mul_f32 v[214:215], v[214:215], s[92:93]
    v_cvt_pk_bf16_f32 v208, v208, v209
    v_cvt_pk_bf16_f32 v209, v210, v211
    v_cvt_pk_bf16_f32 v210, v212, v213
    v_cvt_pk_bf16_f32 v211, v214, v215
    v_accvgpr_write_b32 a216, v208
    v_accvgpr_write_b32 a217, v209
    v_accvgpr_write_b32 a218, v210
    v_accvgpr_write_b32 a219, v211
    v_pk_mul_f32 v[216:217], v[216:217], s[92:93]
    v_pk_mul_f32 v[218:219], v[218:219], s[92:93]
    v_pk_mul_f32 v[220:221], v[220:221], s[92:93]
    v_pk_mul_f32 v[222:223], v[222:223], s[92:93]
    v_cvt_pk_bf16_f32 v216, v216, v217
    v_cvt_pk_bf16_f32 v217, v218, v219
    v_cvt_pk_bf16_f32 v218, v220, v221
    v_cvt_pk_bf16_f32 v219, v222, v223
    v_accvgpr_write_b32 a220, v216
    v_accvgpr_write_b32 a221, v217
    v_accvgpr_write_b32 a222, v218
    v_accvgpr_write_b32 a223, v219
    v_pk_mul_f32 v[224:225], v[224:225], s[92:93]
    v_pk_mul_f32 v[226:227], v[226:227], s[92:93]
    v_pk_mul_f32 v[228:229], v[228:229], s[92:93]
    v_pk_mul_f32 v[230:231], v[230:231], s[92:93]
    v_cvt_pk_bf16_f32 v224, v224, v225
    v_cvt_pk_bf16_f32 v225, v226, v227
    v_cvt_pk_bf16_f32 v226, v228, v229
    v_cvt_pk_bf16_f32 v227, v230, v231
    v_accvgpr_write_b32 a224, v224
    v_accvgpr_write_b32 a225, v225
    v_accvgpr_write_b32 a226, v226
    v_accvgpr_write_b32 a227, v227
    v_pk_mul_f32 v[232:233], v[232:233], s[92:93]
    v_pk_mul_f32 v[234:235], v[234:235], s[92:93]
    v_pk_mul_f32 v[236:237], v[236:237], s[92:93]
    v_pk_mul_f32 v[238:239], v[238:239], s[92:93]
    v_cvt_pk_bf16_f32 v232, v232, v233
    v_cvt_pk_bf16_f32 v233, v234, v235
    v_cvt_pk_bf16_f32 v234, v236, v237
    v_cvt_pk_bf16_f32 v235, v238, v239
    v_accvgpr_write_b32 a228, v232
    v_accvgpr_write_b32 a229, v233
    v_accvgpr_write_b32 a230, v234
    v_accvgpr_write_b32 a231, v235
    v_pk_mul_f32 v[240:241], v[240:241], s[92:93]
    v_pk_mul_f32 v[242:243], v[242:243], s[92:93]
    v_pk_mul_f32 v[244:245], v[244:245], s[92:93]
    v_pk_mul_f32 v[246:247], v[246:247], s[92:93]
    v_cvt_pk_bf16_f32 v240, v240, v241
    v_cvt_pk_bf16_f32 v241, v242, v243
    v_cvt_pk_bf16_f32 v242, v244, v245
    v_cvt_pk_bf16_f32 v243, v246, v247
    v_accvgpr_write_b32 a232, v240
    v_accvgpr_write_b32 a233, v241
    v_accvgpr_write_b32 a234, v242
    v_accvgpr_write_b32 a235, v243
    v_pk_mul_f32 v[248:249], v[248:249], s[92:93]
    v_pk_mul_f32 v[250:251], v[250:251], s[92:93]
    v_pk_mul_f32 v[252:253], v[252:253], s[92:93]
    v_pk_mul_f32 v[254:255], v[254:255], s[92:93]
    v_cvt_pk_bf16_f32 v248, v248, v249
    v_cvt_pk_bf16_f32 v249, v250, v251
    v_cvt_pk_bf16_f32 v250, v252, v253
    v_cvt_pk_bf16_f32 v251, v254, v255
    v_accvgpr_write_b32 a236, v248
    v_accvgpr_write_b32 a237, v249
    v_accvgpr_write_b32 a238, v250
    v_accvgpr_write_b32 a239, v251
    v_accvgpr_read_b32 v24, a96
    v_accvgpr_read_b32 v25, a97
    v_accvgpr_read_b32 v26, a98
    v_accvgpr_read_b32 v27, a99
    v_accvgpr_read_b32 v28, a100
    v_accvgpr_read_b32 v29, a101
    v_accvgpr_read_b32 v30, a102
    v_accvgpr_read_b32 v31, a103
    v_pk_mul_f32 v[24:25], v[24:25], s[92:93]
    v_pk_mul_f32 v[26:27], v[26:27], s[92:93]
    v_pk_mul_f32 v[28:29], v[28:29], s[92:93]
    v_pk_mul_f32 v[30:31], v[30:31], s[92:93]
    v_cvt_pk_bf16_f32 v24, v24, v25
    v_cvt_pk_bf16_f32 v25, v26, v27
    v_cvt_pk_bf16_f32 v26, v28, v29
    v_cvt_pk_bf16_f32 v27, v30, v31
    v_accvgpr_write_b32 a240, v24
    v_accvgpr_write_b32 a241, v25
    v_accvgpr_write_b32 a242, v26
    v_accvgpr_write_b32 a243, v27
    v_accvgpr_read_b32 v24, a104
    v_accvgpr_read_b32 v25, a105
    v_accvgpr_read_b32 v26, a106
    v_accvgpr_read_b32 v27, a107
    v_accvgpr_read_b32 v28, a108
    v_accvgpr_read_b32 v29, a109
    v_accvgpr_read_b32 v30, a110
    v_accvgpr_read_b32 v31, a111
    v_pk_mul_f32 v[24:25], v[24:25], s[92:93]
    v_pk_mul_f32 v[26:27], v[26:27], s[92:93]
    v_pk_mul_f32 v[28:29], v[28:29], s[92:93]
    v_pk_mul_f32 v[30:31], v[30:31], s[92:93]
    v_cvt_pk_bf16_f32 v24, v24, v25
    v_cvt_pk_bf16_f32 v25, v26, v27
    v_cvt_pk_bf16_f32 v26, v28, v29
    v_cvt_pk_bf16_f32 v27, v30, v31
    v_accvgpr_write_b32 a244, v24
    v_accvgpr_write_b32 a245, v25
    v_accvgpr_write_b32 a246, v26
    v_accvgpr_write_b32 a247, v27
    v_accvgpr_read_b32 v24, a112
    v_accvgpr_read_b32 v25, a113
    v_accvgpr_read_b32 v26, a114
    v_accvgpr_read_b32 v27, a115
    v_accvgpr_read_b32 v28, a116
    v_accvgpr_read_b32 v29, a117
    v_accvgpr_read_b32 v30, a118
    v_accvgpr_read_b32 v31, a119
    v_pk_mul_f32 v[24:25], v[24:25], s[92:93]
    v_pk_mul_f32 v[26:27], v[26:27], s[92:93]
    v_pk_mul_f32 v[28:29], v[28:29], s[92:93]
    v_pk_mul_f32 v[30:31], v[30:31], s[92:93]
    v_cvt_pk_bf16_f32 v24, v24, v25
    v_cvt_pk_bf16_f32 v25, v26, v27
    v_cvt_pk_bf16_f32 v26, v28, v29
    v_cvt_pk_bf16_f32 v27, v30, v31
    v_accvgpr_write_b32 a248, v24
    v_accvgpr_write_b32 a249, v25
    v_accvgpr_write_b32 a250, v26
    v_accvgpr_write_b32 a251, v27
    v_accvgpr_read_b32 v24, a120
    v_accvgpr_read_b32 v25, a121
    v_accvgpr_read_b32 v26, a122
    v_accvgpr_read_b32 v27, a123
    v_accvgpr_read_b32 v28, a124
    v_accvgpr_read_b32 v29, a125
    v_accvgpr_read_b32 v30, a126
    v_accvgpr_read_b32 v31, a127
    v_pk_mul_f32 v[24:25], v[24:25], s[92:93]
    v_pk_mul_f32 v[26:27], v[26:27], s[92:93]
    v_pk_mul_f32 v[28:29], v[28:29], s[92:93]
    v_pk_mul_f32 v[30:31], v[30:31], s[92:93]
    v_cvt_pk_bf16_f32 v24, v24, v25
    v_cvt_pk_bf16_f32 v25, v26, v27
    v_cvt_pk_bf16_f32 v26, v28, v29
    v_cvt_pk_bf16_f32 v27, v30, v31
    v_accvgpr_write_b32 a252, v24
    v_accvgpr_write_b32 a253, v25
    v_accvgpr_write_b32 a254, v26
    v_accvgpr_write_b32 a255, v27
    s_setpc_b64 s[20:21]
mega_kernel_ns359:
    v_cvt_pk_bf16_f32 v32, v32, v33
    v_cvt_pk_bf16_f32 v33, v34, v35
    v_cvt_pk_bf16_f32 v34, v36, v37
    v_cvt_pk_bf16_f32 v35, v38, v39
    v_accvgpr_write_b32 a128, v32
    v_accvgpr_write_b32 a129, v33
    v_accvgpr_write_b32 a130, v34
    v_accvgpr_write_b32 a131, v35
    v_cvt_pk_bf16_f32 v40, v40, v41
    v_cvt_pk_bf16_f32 v41, v42, v43
    v_cvt_pk_bf16_f32 v42, v44, v45
    v_cvt_pk_bf16_f32 v43, v46, v47
    v_accvgpr_write_b32 a132, v40
    v_accvgpr_write_b32 a133, v41
    v_accvgpr_write_b32 a134, v42
    v_accvgpr_write_b32 a135, v43
    v_cvt_pk_bf16_f32 v48, v48, v49
    v_cvt_pk_bf16_f32 v49, v50, v51
    v_cvt_pk_bf16_f32 v50, v52, v53
    v_cvt_pk_bf16_f32 v51, v54, v55
    v_accvgpr_write_b32 a136, v48
    v_accvgpr_write_b32 a137, v49
    v_accvgpr_write_b32 a138, v50
    v_accvgpr_write_b32 a139, v51
    v_cvt_pk_bf16_f32 v56, v56, v57
    v_cvt_pk_bf16_f32 v57, v58, v59
    v_cvt_pk_bf16_f32 v58, v60, v61
    v_cvt_pk_bf16_f32 v59, v62, v63
    v_accvgpr_write_b32 a140, v56
    v_accvgpr_write_b32 a141, v57
    v_accvgpr_write_b32 a142, v58
    v_accvgpr_write_b32 a143, v59
    v_cvt_pk_bf16_f32 v64, v64, v65
    v_cvt_pk_bf16_f32 v65, v66, v67
    v_cvt_pk_bf16_f32 v66, v68, v69
    v_cvt_pk_bf16_f32 v67, v70, v71
    v_accvgpr_write_b32 a144, v64
    v_accvgpr_write_b32 a145, v65
    v_accvgpr_write_b32 a146, v66
    v_accvgpr_write_b32 a147, v67
    v_cvt_pk_bf16_f32 v72, v72, v73
    v_cvt_pk_bf16_f32 v73, v74, v75
    v_cvt_pk_bf16_f32 v74, v76, v77
    v_cvt_pk_bf16_f32 v75, v78, v79
    v_accvgpr_write_b32 a148, v72
    v_accvgpr_write_b32 a149, v73
    v_accvgpr_write_b32 a150, v74
    v_accvgpr_write_b32 a151, v75
    v_cvt_pk_bf16_f32 v80, v80, v81
    v_cvt_pk_bf16_f32 v81, v82, v83
    v_cvt_pk_bf16_f32 v82, v84, v85
    v_cvt_pk_bf16_f32 v83, v86, v87
    v_accvgpr_write_b32 a152, v80
    v_accvgpr_write_b32 a153, v81
    v_accvgpr_write_b32 a154, v82
    v_accvgpr_write_b32 a155, v83
    v_cvt_pk_bf16_f32 v88, v88, v89
    v_cvt_pk_bf16_f32 v89, v90, v91
    v_cvt_pk_bf16_f32 v90, v92, v93
    v_cvt_pk_bf16_f32 v91, v94, v95
    v_accvgpr_write_b32 a156, v88
    v_accvgpr_write_b32 a157, v89
    v_accvgpr_write_b32 a158, v90
    v_accvgpr_write_b32 a159, v91
    v_cvt_pk_bf16_f32 v96, v96, v97
    v_cvt_pk_bf16_f32 v97, v98, v99
    v_cvt_pk_bf16_f32 v98, v100, v101
    v_cvt_pk_bf16_f32 v99, v102, v103
    v_accvgpr_write_b32 a160, v96
    v_accvgpr_write_b32 a161, v97
    v_accvgpr_write_b32 a162, v98
    v_accvgpr_write_b32 a163, v99
    v_cvt_pk_bf16_f32 v104, v104, v105
    v_cvt_pk_bf16_f32 v105, v106, v107
    v_cvt_pk_bf16_f32 v106, v108, v109
    v_cvt_pk_bf16_f32 v107, v110, v111
    v_accvgpr_write_b32 a164, v104
    v_accvgpr_write_b32 a165, v105
    v_accvgpr_write_b32 a166, v106
    v_accvgpr_write_b32 a167, v107
    v_cvt_pk_bf16_f32 v112, v112, v113
    v_cvt_pk_bf16_f32 v113, v114, v115
    v_cvt_pk_bf16_f32 v114, v116, v117
    v_cvt_pk_bf16_f32 v115, v118, v119
    v_accvgpr_write_b32 a168, v112
    v_accvgpr_write_b32 a169, v113
    v_accvgpr_write_b32 a170, v114
    v_accvgpr_write_b32 a171, v115
    v_cvt_pk_bf16_f32 v120, v120, v121
    v_cvt_pk_bf16_f32 v121, v122, v123
    v_cvt_pk_bf16_f32 v122, v124, v125
    v_cvt_pk_bf16_f32 v123, v126, v127
    v_accvgpr_write_b32 a172, v120
    v_accvgpr_write_b32 a173, v121
    v_accvgpr_write_b32 a174, v122
    v_accvgpr_write_b32 a175, v123
    v_cvt_pk_bf16_f32 v128, v128, v129
    v_cvt_pk_bf16_f32 v129, v130, v131
    v_cvt_pk_bf16_f32 v130, v132, v133
    v_cvt_pk_bf16_f32 v131, v134, v135
    v_accvgpr_write_b32 a176, v128
    v_accvgpr_write_b32 a177, v129
    v_accvgpr_write_b32 a178, v130
    v_accvgpr_write_b32 a179, v131
    v_cvt_pk_bf16_f32 v136, v136, v137
    v_cvt_pk_bf16_f32 v137, v138, v139
    v_cvt_pk_bf16_f32 v138, v140, v141
    v_cvt_pk_bf16_f32 v139, v142, v143
    v_accvgpr_write_b32 a180, v136
    v_accvgpr_write_b32 a181, v137
    v_accvgpr_write_b32 a182, v138
    v_accvgpr_write_b32 a183, v139
    v_cvt_pk_bf16_f32 v144, v144, v145
    v_cvt_pk_bf16_f32 v145, v146, v147
    v_cvt_pk_bf16_f32 v146, v148, v149
    v_cvt_pk_bf16_f32 v147, v150, v151
    v_accvgpr_write_b32 a184, v144
    v_accvgpr_write_b32 a185, v145
    v_accvgpr_write_b32 a186, v146
    v_accvgpr_write_b32 a187, v147
    v_cvt_pk_bf16_f32 v152, v152, v153
    v_cvt_pk_bf16_f32 v153, v154, v155
    v_cvt_pk_bf16_f32 v154, v156, v157
    v_cvt_pk_bf16_f32 v155, v158, v159
    v_accvgpr_write_b32 a188, v152
    v_accvgpr_write_b32 a189, v153
    v_accvgpr_write_b32 a190, v154
    v_accvgpr_write_b32 a191, v155
    v_cvt_pk_bf16_f32 v160, v160, v161
    v_cvt_pk_bf16_f32 v161, v162, v163
    v_cvt_pk_bf16_f32 v162, v164, v165
    v_cvt_pk_bf16_f32 v163, v166, v167
    v_accvgpr_write_b32 a192, v160
    v_accvgpr_write_b32 a193, v161
    v_accvgpr_write_b32 a194, v162
    v_accvgpr_write_b32 a195, v163
    v_cvt_pk_bf16_f32 v168, v168, v169
    v_cvt_pk_bf16_f32 v169, v170, v171
    v_cvt_pk_bf16_f32 v170, v172, v173
    v_cvt_pk_bf16_f32 v171, v174, v175
    v_accvgpr_write_b32 a196, v168
    v_accvgpr_write_b32 a197, v169
    v_accvgpr_write_b32 a198, v170
    v_accvgpr_write_b32 a199, v171
    v_cvt_pk_bf16_f32 v176, v176, v177
    v_cvt_pk_bf16_f32 v177, v178, v179
    v_cvt_pk_bf16_f32 v178, v180, v181
    v_cvt_pk_bf16_f32 v179, v182, v183
    v_accvgpr_write_b32 a200, v176
    v_accvgpr_write_b32 a201, v177
    v_accvgpr_write_b32 a202, v178
    v_accvgpr_write_b32 a203, v179
    v_cvt_pk_bf16_f32 v184, v184, v185
    v_cvt_pk_bf16_f32 v185, v186, v187
    v_cvt_pk_bf16_f32 v186, v188, v189
    v_cvt_pk_bf16_f32 v187, v190, v191
    v_accvgpr_write_b32 a204, v184
    v_accvgpr_write_b32 a205, v185
    v_accvgpr_write_b32 a206, v186
    v_accvgpr_write_b32 a207, v187
    v_cvt_pk_bf16_f32 v192, v192, v193
    v_cvt_pk_bf16_f32 v193, v194, v195
    v_cvt_pk_bf16_f32 v194, v196, v197
    v_cvt_pk_bf16_f32 v195, v198, v199
    v_accvgpr_write_b32 a208, v192
    v_accvgpr_write_b32 a209, v193
    v_accvgpr_write_b32 a210, v194
    v_accvgpr_write_b32 a211, v195
    v_cvt_pk_bf16_f32 v200, v200, v201
    v_cvt_pk_bf16_f32 v201, v202, v203
    v_cvt_pk_bf16_f32 v202, v204, v205
    v_cvt_pk_bf16_f32 v203, v206, v207
    v_accvgpr_write_b32 a212, v200
    v_accvgpr_write_b32 a213, v201
    v_accvgpr_write_b32 a214, v202
    v_accvgpr_write_b32 a215, v203
    v_cvt_pk_bf16_f32 v208, v208, v209
    v_cvt_pk_bf16_f32 v209, v210, v211
    v_cvt_pk_bf16_f32 v210, v212, v213
    v_cvt_pk_bf16_f32 v211, v214, v215
    v_accvgpr_write_b32 a216, v208
    v_accvgpr_write_b32 a217, v209
    v_accvgpr_write_b32 a218, v210
    v_accvgpr_write_b32 a219, v211
    v_cvt_pk_bf16_f32 v216, v216, v217
    v_cvt_pk_bf16_f32 v217, v218, v219
    v_cvt_pk_bf16_f32 v218, v220, v221
    v_cvt_pk_bf16_f32 v219, v222, v223
    v_accvgpr_write_b32 a220, v216
    v_accvgpr_write_b32 a221, v217
    v_accvgpr_write_b32 a222, v218
    v_accvgpr_write_b32 a223, v219
    v_cvt_pk_bf16_f32 v224, v224, v225
    v_cvt_pk_bf16_f32 v225, v226, v227
    v_cvt_pk_bf16_f32 v226, v228, v229
    v_cvt_pk_bf16_f32 v227, v230, v231
    v_accvgpr_write_b32 a224, v224
    v_accvgpr_write_b32 a225, v225
    v_accvgpr_write_b32 a226, v226
    v_accvgpr_write_b32 a227, v227
    v_cvt_pk_bf16_f32 v232, v232, v233
    v_cvt_pk_bf16_f32 v233, v234, v235
    v_cvt_pk_bf16_f32 v234, v236, v237
    v_cvt_pk_bf16_f32 v235, v238, v239
    v_accvgpr_write_b32 a228, v232
    v_accvgpr_write_b32 a229, v233
    v_accvgpr_write_b32 a230, v234
    v_accvgpr_write_b32 a231, v235
    v_cvt_pk_bf16_f32 v240, v240, v241
    v_cvt_pk_bf16_f32 v241, v242, v243
    v_cvt_pk_bf16_f32 v242, v244, v245
    v_cvt_pk_bf16_f32 v243, v246, v247
    v_accvgpr_write_b32 a232, v240
    v_accvgpr_write_b32 a233, v241
    v_accvgpr_write_b32 a234, v242
    v_accvgpr_write_b32 a235, v243
    v_cvt_pk_bf16_f32 v248, v248, v249
    v_cvt_pk_bf16_f32 v249, v250, v251
    v_cvt_pk_bf16_f32 v250, v252, v253
    v_cvt_pk_bf16_f32 v251, v254, v255
    v_accvgpr_write_b32 a236, v248
    v_accvgpr_write_b32 a237, v249
    v_accvgpr_write_b32 a238, v250
    v_accvgpr_write_b32 a239, v251
    v_accvgpr_read_b32 v24, a96
    v_accvgpr_read_b32 v25, a97
    v_accvgpr_read_b32 v26, a98
    v_accvgpr_read_b32 v27, a99
    v_accvgpr_read_b32 v28, a100
    v_accvgpr_read_b32 v29, a101
    v_accvgpr_read_b32 v30, a102
    v_accvgpr_read_b32 v31, a103
    v_cvt_pk_bf16_f32 v24, v24, v25
    v_cvt_pk_bf16_f32 v25, v26, v27
    v_cvt_pk_bf16_f32 v26, v28, v29
    v_cvt_pk_bf16_f32 v27, v30, v31
    v_accvgpr_write_b32 a240, v24
    v_accvgpr_write_b32 a241, v25
    v_accvgpr_write_b32 a242, v26
    v_accvgpr_write_b32 a243, v27
    v_accvgpr_read_b32 v24, a104
    v_accvgpr_read_b32 v25, a105
    v_accvgpr_read_b32 v26, a106
    v_accvgpr_read_b32 v27, a107
    v_accvgpr_read_b32 v28, a108
    v_accvgpr_read_b32 v29, a109
    v_accvgpr_read_b32 v30, a110
    v_accvgpr_read_b32 v31, a111
    v_cvt_pk_bf16_f32 v24, v24, v25
    v_cvt_pk_bf16_f32 v25, v26, v27
    v_cvt_pk_bf16_f32 v26, v28, v29
    v_cvt_pk_bf16_f32 v27, v30, v31
    v_accvgpr_write_b32 a244, v24
    v_accvgpr_write_b32 a245, v25
    v_accvgpr_write_b32 a246, v26
    v_accvgpr_write_b32 a247, v27
    v_accvgpr_read_b32 v24, a112
    v_accvgpr_read_b32 v25, a113
    v_accvgpr_read_b32 v26, a114
    v_accvgpr_read_b32 v27, a115
    v_accvgpr_read_b32 v28, a116
    v_accvgpr_read_b32 v29, a117
    v_accvgpr_read_b32 v30, a118
    v_accvgpr_read_b32 v31, a119
    v_cvt_pk_bf16_f32 v24, v24, v25
    v_cvt_pk_bf16_f32 v25, v26, v27
    v_cvt_pk_bf16_f32 v26, v28, v29
    v_cvt_pk_bf16_f32 v27, v30, v31
    v_accvgpr_write_b32 a248, v24
    v_accvgpr_write_b32 a249, v25
    v_accvgpr_write_b32 a250, v26
    v_accvgpr_write_b32 a251, v27
    v_accvgpr_read_b32 v24, a120
    v_accvgpr_read_b32 v25, a121
    v_accvgpr_read_b32 v26, a122
    v_accvgpr_read_b32 v27, a123
    v_accvgpr_read_b32 v28, a124
    v_accvgpr_read_b32 v29, a125
    v_accvgpr_read_b32 v30, a126
    v_accvgpr_read_b32 v31, a127
    v_cvt_pk_bf16_f32 v24, v24, v25
    v_cvt_pk_bf16_f32 v25, v26, v27
    v_cvt_pk_bf16_f32 v26, v28, v29
    v_cvt_pk_bf16_f32 v27, v30, v31
    v_accvgpr_write_b32 a252, v24
    v_accvgpr_write_b32 a253, v25
    v_accvgpr_write_b32 a254, v26
    v_accvgpr_write_b32 a255, v27
    s_setpc_b64 s[20:21]
mega_kernel_epf21:
    s_nop 7
    s_cmp_eq_u32 s97, 0
    s_cbranch_scc1 mega_kernel_noscale60
    s_mov_b32 s91, s98
    s_mov_b32 s92, s97
    s_mov_b32 s93, s97
    s_mov_b32 s90, s91
    v_pk_mul_f32 v[32:33], v[32:33], s[92:93]
    v_pk_mul_f32 v[34:35], v[34:35], s[92:93]
    v_pk_mul_f32 v[36:37], v[36:37], s[92:93]
    v_pk_mul_f32 v[38:39], v[38:39], s[92:93]
    v_cvt_pk_bf16_f32 v32, v32, v33
    v_cvt_pk_bf16_f32 v33, v34, v35
    v_cvt_pk_bf16_f32 v34, v36, v37
    v_cvt_pk_bf16_f32 v35, v38, v39
    buffer_store_dwordx4 v[32:35], v2, s[8:11], s90 offen sc1
    s_add_u32 s90, s90, s100
    v_pk_mul_f32 v[40:41], v[40:41], s[92:93]
    v_pk_mul_f32 v[42:43], v[42:43], s[92:93]
    v_pk_mul_f32 v[44:45], v[44:45], s[92:93]
    v_pk_mul_f32 v[46:47], v[46:47], s[92:93]
    v_cvt_pk_bf16_f32 v40, v40, v41
    v_cvt_pk_bf16_f32 v41, v42, v43
    v_cvt_pk_bf16_f32 v42, v44, v45
    v_cvt_pk_bf16_f32 v43, v46, v47
    buffer_store_dwordx4 v[40:43], v2, s[8:11], s90 offen sc1
    s_add_u32 s90, s90, s100
    v_pk_mul_f32 v[48:49], v[48:49], s[92:93]
    v_pk_mul_f32 v[50:51], v[50:51], s[92:93]
    v_pk_mul_f32 v[52:53], v[52:53], s[92:93]
    v_pk_mul_f32 v[54:55], v[54:55], s[92:93]
    v_cvt_pk_bf16_f32 v48, v48, v49
    v_cvt_pk_bf16_f32 v49, v50, v51
    v_cvt_pk_bf16_f32 v50, v52, v53
    v_cvt_pk_bf16_f32 v51, v54, v55
    buffer_store_dwordx4 v[48:51], v2, s[8:11], s90 offen sc1
    s_add_u32 s90, s90, s100
    v_pk_mul_f32 v[56:57], v[56:57], s[92:93]
    v_pk_mul_f32 v[58:59], v[58:59], s[92:93]
    v_pk_mul_f32 v[60:61], v[60:61], s[92:93]
    v_pk_mul_f32 v[62:63], v[62:63], s[92:93]
    v_cvt_pk_bf16_f32 v56, v56, v57
    v_cvt_pk_bf16_f32 v57, v58, v59
    v_cvt_pk_bf16_f32 v58, v60, v61
    v_cvt_pk_bf16_f32 v59, v62, v63
    buffer_store_dwordx4 v[56:59], v2, s[8:11], s90 offen sc1
    s_add_u32 s90, s90, s100
    v_pk_mul_f32 v[64:65], v[64:65], s[92:93]
    v_pk_mul_f32 v[66:67], v[66:67], s[92:93]
    v_pk_mul_f32 v[68:69], v[68:69], s[92:93]
    v_pk_mul_f32 v[70:71], v[70:71], s[92:93]
    v_cvt_pk_bf16_f32 v64, v64, v65
    v_cvt_pk_bf16_f32 v65, v66, v67
    v_cvt_pk_bf16_f32 v66, v68, v69
    v_cvt_pk_bf16_f32 v67, v70, v71
    buffer_store_dwordx4 v[64:67], v2, s[8:11], s90 offen sc1
    s_add_u32 s90, s90, s100
    v_pk_mul_f32 v[72:73], v[72:73], s[92:93]
    v_pk_mul_f32 v[74:75], v[74:75], s[92:93]
    v_pk_mul_f32 v[76:77], v[76:77], s[92:93]
    v_pk_mul_f32 v[78:79], v[78:79], s[92:93]
    v_cvt_pk_bf16_f32 v72, v72, v73
    v_cvt_pk_bf16_f32 v73, v74, v75
    v_cvt_pk_bf16_f32 v74, v76, v77
    v_cvt_pk_bf16_f32 v75, v78, v79
    buffer_store_dwordx4 v[72:75], v2, s[8:11], s90 offen sc1
    s_add_u32 s90, s90, s100
    v_pk_mul_f32 v[80:81], v[80:81], s[92:93]
    v_pk_mul_f32 v[82:83], v[82:83], s[92:93]
    v_pk_mul_f32 v[84:85], v[84:85], s[92:93]
    v_pk_mul_f32 v[86:87], v[86:87], s[92:93]
    v_cvt_pk_bf16_f32 v80, v80, v81
    v_cvt_pk_bf16_f32 v81, v82, v83
    v_cvt_pk_bf16_f32 v82, v84, v85
    v_cvt_pk_bf16_f32 v83, v86, v87
    buffer_store_dwordx4 v[80:83], v2, s[8:11], s90 offen sc1
    s_add_u32 s90, s90, s100
    v_pk_mul_f32 v[88:89], v[88:89], s[92:93]
    v_pk_mul_f32 v[90:91], v[90:91], s[92:93]
    v_pk_mul_f32 v[92:93], v[92:93], s[92:93]
    v_pk_mul_f32 v[94:95], v[94:95], s[92:93]
    v_cvt_pk_bf16_f32 v88, v88, v89
    v_cvt_pk_bf16_f32 v89, v90, v91
    v_cvt_pk_bf16_f32 v90, v92, v93
    v_cvt_pk_bf16_f32 v91, v94, v95
    buffer_store_dwordx4 v[88:91], v2, s[8:11], s90 offen sc1
    s_add_u32 s90, s90, s100
    s_add_u32 s91, s91, s99
    s_mov_b32 s90, s91
    v_pk_mul_f32 v[96:97], v[96:97], s[92:93]
    v_pk_mul_f32 v[98:99], v[98:99], s[92:93]
    v_pk_mul_f32 v[100:101], v[100:101], s[92:93]
    v_pk_mul_f32 v[102:103], v[102:103], s[92:93]
    v_cvt_pk_bf16_f32 v96, v96, v97
    v_cvt_pk_bf16_f32 v97, v98, v99
    v_cvt_pk_bf16_f32 v98, v100, v101
    v_cvt_pk_bf16_f32 v99, v102, v103
    buffer_store_dwordx4 v[96:99], v2, s[8:11], s90 offen sc1
    s_add_u32 s90, s90, s100
    v_pk_mul_f32 v[104:105], v[104:105], s[92:93]
    v_pk_mul_f32 v[106:107], v[106:107], s[92:93]
    v_pk_mul_f32 v[108:109], v[108:109], s[92:93]
    v_pk_mul_f32 v[110:111], v[110:111], s[92:93]
    v_cvt_pk_bf16_f32 v104, v104, v105
    v_cvt_pk_bf16_f32 v105, v106, v107
    v_cvt_pk_bf16_f32 v106, v108, v109
    v_cvt_pk_bf16_f32 v107, v110, v111
    buffer_store_dwordx4 v[104:107], v2, s[8:11], s90 offen sc1
    s_add_u32 s90, s90, s100
    v_pk_mul_f32 v[112:113], v[112:113], s[92:93]
    v_pk_mul_f32 v[114:115], v[114:115], s[92:93]
    v_pk_mul_f32 v[116:117], v[116:117], s[92:93]
    v_pk_mul_f32 v[118:119], v[118:119], s[92:93]
    v_cvt_pk_bf16_f32 v112, v112, v113
    v_cvt_pk_bf16_f32 v113, v114, v115
    v_cvt_pk_bf16_f32 v114, v116, v117
    v_cvt_pk_bf16_f32 v115, v118, v119
    buffer_store_dwordx4 v[112:115], v2, s[8:11], s90 offen sc1
    s_add_u32 s90, s90, s100
    v_pk_mul_f32 v[120:121], v[120:121], s[92:93]
    v_pk_mul_f32 v[122:123], v[122:123], s[92:93]
    v_pk_mul_f32 v[124:125], v[124:125], s[92:93]
    v_pk_mul_f32 v[126:127], v[126:127], s[92:93]
    v_cvt_pk_bf16_f32 v120, v120, v121
    v_cvt_pk_bf16_f32 v121, v122, v123
    v_cvt_pk_bf16_f32 v122, v124, v125
    v_cvt_pk_bf16_f32 v123, v126, v127
    buffer_store_dwordx4 v[120:123], v2, s[8:11], s90 offen sc1
    s_add_u32 s90, s90, s100
    v_pk_mul_f32 v[128:129], v[128:129], s[92:93]
    v_pk_mul_f32 v[130:131], v[130:131], s[92:93]
    v_pk_mul_f32 v[132:133], v[132:133], s[92:93]
    v_pk_mul_f32 v[134:135], v[134:135], s[92:93]
    v_cvt_pk_bf16_f32 v128, v128, v129
    v_cvt_pk_bf16_f32 v129, v130, v131
    v_cvt_pk_bf16_f32 v130, v132, v133
    v_cvt_pk_bf16_f32 v131, v134, v135
    buffer_store_dwordx4 v[128:131], v2, s[8:11], s90 offen sc1
    s_add_u32 s90, s90, s100
    v_pk_mul_f32 v[136:137], v[136:137], s[92:93]
    v_pk_mul_f32 v[138:139], v[138:139], s[92:93]
    v_pk_mul_f32 v[140:141], v[140:141], s[92:93]
    v_pk_mul_f32 v[142:143], v[142:143], s[92:93]
    v_cvt_pk_bf16_f32 v136, v136, v137
    v_cvt_pk_bf16_f32 v137, v138, v139
    v_cvt_pk_bf16_f32 v138, v140, v141
    v_cvt_pk_bf16_f32 v139, v142, v143
    buffer_store_dwordx4 v[136:139], v2, s[8:11], s90 offen sc1
    s_add_u32 s90, s90, s100
    v_pk_mul_f32 v[144:145], v[144:145], s[92:93]
    v_pk_mul_f32 v[146:147], v[146:147], s[92:93]
    v_pk_mul_f32 v[148:149], v[148:149], s[92:93]
    v_pk_mul_f32 v[150:151], v[150:151], s[92:93]
    v_cvt_pk_bf16_f32 v144, v144, v145
    v_cvt_pk_bf16_f32 v145, v146, v147
    v_cvt_pk_bf16_f32 v146, v148, v149
    v_cvt_pk_bf16_f32 v147, v150, v151
    buffer_store_dwordx4 v[144:147], v2, s[8:11], s90 offen sc1
    s_add_u32 s90, s90, s100
    v_pk_mul_f32 v[152:153], v[152:153], s[92:93]
    v_pk_mul_f32 v[154:155], v[154:155], s[92:93]
    v_pk_mul_f32 v[156:157], v[156:157], s[92:93]
    v_pk_mul_f32 v[158:159], v[158:159], s[92:93]
    v_cvt_pk_bf16_f32 v152, v152, v153
    v_cvt_pk_bf16_f32 v153, v154, v155
    v_cvt_pk_bf16_f32 v154, v156, v157
    v_cvt_pk_bf16_f32 v155, v158, v159
    buffer_store_dwordx4 v[152:155], v2, s[8:11], s90 offen sc1
    s_add_u32 s90, s90, s100
    s_add_u32 s91, s91, s99
    s_mov_b32 s90, s91
    v_pk_mul_f32 v[160:161], v[160:161], s[92:93]
    v_pk_mul_f32 v[162:163], v[162:163], s[92:93]
    v_pk_mul_f32 v[164:165], v[164:165], s[92:93]
    v_pk_mul_f32 v[166:167], v[166:167], s[92:93]
    v_cvt_pk_bf16_f32 v160, v160, v161
    v_cvt_pk_bf16_f32 v161, v162, v163
    v_cvt_pk_bf16_f32 v162, v164, v165
    v_cvt_pk_bf16_f32 v163, v166, v167
    buffer_store_dwordx4 v[160:163], v2, s[8:11], s90 offen sc1
    s_add_u32 s90, s90, s100
    v_pk_mul_f32 v[168:169], v[168:169], s[92:93]
    v_pk_mul_f32 v[170:171], v[170:171], s[92:93]
    v_pk_mul_f32 v[172:173], v[172:173], s[92:93]
    v_pk_mul_f32 v[174:175], v[174:175], s[92:93]
    v_cvt_pk_bf16_f32 v168, v168, v169
    v_cvt_pk_bf16_f32 v169, v170, v171
    v_cvt_pk_bf16_f32 v170, v172, v173
    v_cvt_pk_bf16_f32 v171, v174, v175
    buffer_store_dwordx4 v[168:171], v2, s[8:11], s90 offen sc1
    s_add_u32 s90, s90, s100
    v_pk_mul_f32 v[176:177], v[176:177], s[92:93]
    v_pk_mul_f32 v[178:179], v[178:179], s[92:93]
    v_pk_mul_f32 v[180:181], v[180:181], s[92:93]
    v_pk_mul_f32 v[182:183], v[182:183], s[92:93]
    v_cvt_pk_bf16_f32 v176, v176, v177
    v_cvt_pk_bf16_f32 v177, v178, v179
    v_cvt_pk_bf16_f32 v178, v180, v181
    v_cvt_pk_bf16_f32 v179, v182, v183
    buffer_store_dwordx4 v[176:179], v2, s[8:11], s90 offen sc1
    s_add_u32 s90, s90, s100
    v_pk_mul_f32 v[184:185], v[184:185], s[92:93]
    v_pk_mul_f32 v[186:187], v[186:187], s[92:93]
    v_pk_mul_f32 v[188:189], v[188:189], s[92:93]
    v_pk_mul_f32 v[190:191], v[190:191], s[92:93]
    v_cvt_pk_bf16_f32 v184, v184, v185
    v_cvt_pk_bf16_f32 v185, v186, v187
    v_cvt_pk_bf16_f32 v186, v188, v189
    v_cvt_pk_bf16_f32 v187, v190, v191
    buffer_store_dwordx4 v[184:187], v2, s[8:11], s90 offen sc1
    s_add_u32 s90, s90, s100
    v_pk_mul_f32 v[192:193], v[192:193], s[92:93]
    v_pk_mul_f32 v[194:195], v[194:195], s[92:93]
    v_pk_mul_f32 v[196:197], v[196:197], s[92:93]
    v_pk_mul_f32 v[198:199], v[198:199], s[92:93]
    v_cvt_pk_bf16_f32 v192, v192, v193
    v_cvt_pk_bf16_f32 v193, v194, v195
    v_cvt_pk_bf16_f32 v194, v196, v197
    v_cvt_pk_bf16_f32 v195, v198, v199
    buffer_store_dwordx4 v[192:195], v2, s[8:11], s90 offen sc1
    s_add_u32 s90, s90, s100
    v_pk_mul_f32 v[200:201], v[200:201], s[92:93]
    v_pk_mul_f32 v[202:203], v[202:203], s[92:93]
    v_pk_mul_f32 v[204:205], v[204:205], s[92:93]
    v_pk_mul_f32 v[206:207], v[206:207], s[92:93]
    v_cvt_pk_bf16_f32 v200, v200, v201
    v_cvt_pk_bf16_f32 v201, v202, v203
    v_cvt_pk_bf16_f32 v202, v204, v205
    v_cvt_pk_bf16_f32 v203, v206, v207
    buffer_store_dwordx4 v[200:203], v2, s[8:11], s90 offen sc1
    s_add_u32 s90, s90, s100
    v_pk_mul_f32 v[208:209], v[208:209], s[92:93]
    v_pk_mul_f32 v[210:211], v[210:211], s[92:93]
    v_pk_mul_f32 v[212:213], v[212:213], s[92:93]
    v_pk_mul_f32 v[214:215], v[214:215], s[92:93]
    v_cvt_pk_bf16_f32 v208, v208, v209
    v_cvt_pk_bf16_f32 v209, v210, v211
    v_cvt_pk_bf16_f32 v210, v212, v213
    v_cvt_pk_bf16_f32 v211, v214, v215
    buffer_store_dwordx4 v[208:211], v2, s[8:11], s90 offen sc1
    s_add_u32 s90, s90, s100
    v_pk_mul_f32 v[216:217], v[216:217], s[92:93]
    v_pk_mul_f32 v[218:219], v[218:219], s[92:93]
    v_pk_mul_f32 v[220:221], v[220:221], s[92:93]
    v_pk_mul_f32 v[222:223], v[222:223], s[92:93]
    v_cvt_pk_bf16_f32 v216, v216, v217
    v_cvt_pk_bf16_f32 v217, v218, v219
    v_cvt_pk_bf16_f32 v218, v220, v221
    v_cvt_pk_bf16_f32 v219, v222, v223
    buffer_store_dwordx4 v[216:219], v2, s[8:11], s90 offen sc1
    s_add_u32 s90, s90, s100
    s_add_u32 s91, s91, s99
    s_mov_b32 s90, s91
    v_pk_mul_f32 v[224:225], v[224:225], s[92:93]
    v_pk_mul_f32 v[226:227], v[226:227], s[92:93]
    v_pk_mul_f32 v[228:229], v[228:229], s[92:93]
    v_pk_mul_f32 v[230:231], v[230:231], s[92:93]
    v_cvt_pk_bf16_f32 v224, v224, v225
    v_cvt_pk_bf16_f32 v225, v226, v227
    v_cvt_pk_bf16_f32 v226, v228, v229
    v_cvt_pk_bf16_f32 v227, v230, v231
    buffer_store_dwordx4 v[224:227], v2, s[8:11], s90 offen sc1
    s_add_u32 s90, s90, s100
    v_pk_mul_f32 v[232:233], v[232:233], s[92:93]
    v_pk_mul_f32 v[234:235], v[234:235], s[92:93]
    v_pk_mul_f32 v[236:237], v[236:237], s[92:93]
    v_pk_mul_f32 v[238:239], v[238:239], s[92:93]
    v_cvt_pk_bf16_f32 v232, v232, v233
    v_cvt_pk_bf16_f32 v233, v234, v235
    v_cvt_pk_bf16_f32 v234, v236, v237
    v_cvt_pk_bf16_f32 v235, v238, v239
    buffer_store_dwordx4 v[232:235], v2, s[8:11], s90 offen sc1
    s_add_u32 s90, s90, s100
    v_pk_mul_f32 v[240:241], v[240:241], s[92:93]
    v_pk_mul_f32 v[242:243], v[242:243], s[92:93]
    v_pk_mul_f32 v[244:245], v[244:245], s[92:93]
    v_pk_mul_f32 v[246:247], v[246:247], s[92:93]
    v_cvt_pk_bf16_f32 v240, v240, v241
    v_cvt_pk_bf16_f32 v241, v242, v243
    v_cvt_pk_bf16_f32 v242, v244, v245
    v_cvt_pk_bf16_f32 v243, v246, v247
    buffer_store_dwordx4 v[240:243], v2, s[8:11], s90 offen sc1
    s_add_u32 s90, s90, s100
    v_pk_mul_f32 v[248:249], v[248:249], s[92:93]
    v_pk_mul_f32 v[250:251], v[250:251], s[92:93]
    v_pk_mul_f32 v[252:253], v[252:253], s[92:93]
    v_pk_mul_f32 v[254:255], v[254:255], s[92:93]
    v_cvt_pk_bf16_f32 v248, v248, v249
    v_cvt_pk_bf16_f32 v249, v250, v251
    v_cvt_pk_bf16_f32 v250, v252, v253
    v_cvt_pk_bf16_f32 v251, v254, v255
    buffer_store_dwordx4 v[248:251], v2, s[8:11], s90 offen sc1
    s_add_u32 s90, s90, s100
    v_accvgpr_read_b32 v24, a96
    v_accvgpr_read_b32 v25, a97
    v_accvgpr_read_b32 v26, a98
    v_accvgpr_read_b32 v27, a99
    v_accvgpr_read_b32 v28, a100
    v_accvgpr_read_b32 v29, a101
    v_accvgpr_read_b32 v30, a102
    v_accvgpr_read_b32 v31, a103
    v_pk_mul_f32 v[24:25], v[24:25], s[92:93]
    v_pk_mul_f32 v[26:27], v[26:27], s[92:93]
    v_pk_mul_f32 v[28:29], v[28:29], s[92:93]
    v_pk_mul_f32 v[30:31], v[30:31], s[92:93]
    v_cvt_pk_bf16_f32 v24, v24, v25
    v_cvt_pk_bf16_f32 v25, v26, v27
    v_cvt_pk_bf16_f32 v26, v28, v29
    v_cvt_pk_bf16_f32 v27, v30, v31
    buffer_store_dwordx4 v[24:27], v2, s[8:11], s90 offen sc1
    s_add_u32 s90, s90, s100
    s_nop 1
    v_accvgpr_read_b32 v24, a104
    v_accvgpr_read_b32 v25, a105
    v_accvgpr_read_b32 v26, a106
    v_accvgpr_read_b32 v27, a107
    v_accvgpr_read_b32 v28, a108
    v_accvgpr_read_b32 v29, a109
    v_accvgpr_read_b32 v30, a110
    v_accvgpr_read_b32 v31, a111
    v_pk_mul_f32 v[24:25], v[24:25], s[92:93]
    v_pk_mul_f32 v[26:27], v[26:27], s[92:93]
    v_pk_mul_f32 v[28:29], v[28:29], s[92:93]
    v_pk_mul_f32 v[30:31], v[30:31], s[92:93]
    v_cvt_pk_bf16_f32 v24, v24, v25
    v_cvt_pk_bf16_f32 v25, v26, v27
    v_cvt_pk_bf16_f32 v26, v28, v29
    v_cvt_pk_bf16_f32 v27, v30, v31
    buffer_store_dwordx4 v[24:27], v2, s[8:11], s90 offen sc1
    s_add_u32 s90, s90, s100
    s_nop 1
    v_accvgpr_read_b32 v24, a112
    v_accvgpr_read_b32 v25, a113
    v_accvgpr_read_b32 v26, a114
    v_accvgpr_read_b32 v27, a115
    v_accvgpr_read_b32 v28, a116
    v_accvgpr_read_b32 v29, a117
    v_accvgpr_read_b32 v30, a118
    v_accvgpr_read_b32 v31, a119
    v_pk_mul_f32 v[24:25], v[24:25], s[92:93]
    v_pk_mul_f32 v[26:27], v[26:27], s[92:93]
    v_pk_mul_f32 v[28:29], v[28:29], s[92:93]
    v_pk_mul_f32 v[30:31], v[30:31], s[92:93]
    v_cvt_pk_bf16_f32 v24, v24, v25
    v_cvt_pk_bf16_f32 v25, v26, v27
    v_cvt_pk_bf16_f32 v26, v28, v29
    v_cvt_pk_bf16_f32 v27, v30, v31
    buffer_store_dwordx4 v[24:27], v2, s[8:11], s90 offen sc1
    s_add_u32 s90, s90, s100
    s_nop 1
    v_accvgpr_read_b32 v24, a120
    v_accvgpr_read_b32 v25, a121
    v_accvgpr_read_b32 v26, a122
    v_accvgpr_read_b32 v27, a123
    v_accvgpr_read_b32 v28, a124
    v_accvgpr_read_b32 v29, a125
    v_accvgpr_read_b32 v30, a126
    v_accvgpr_read_b32 v31, a127
    v_pk_mul_f32 v[24:25], v[24:25], s[92:93]
    v_pk_mul_f32 v[26:27], v[26:27], s[92:93]
    v_pk_mul_f32 v[28:29], v[28:29], s[92:93]
    v_pk_mul_f32 v[30:31], v[30:31], s[92:93]
    v_cvt_pk_bf16_f32 v24, v24, v25
    v_cvt_pk_bf16_f32 v25, v26, v27
    v_cvt_pk_bf16_f32 v26, v28, v29
    v_cvt_pk_bf16_f32 v27, v30, v31
    buffer_store_dwordx4 v[24:27], v2, s[8:11], s90 offen sc1
    s_add_u32 s90, s90, s100
    s_nop 1
    s_add_u32 s91, s91, s99
    s_setpc_b64 s[20:21]
mega_kernel_noscale60:
    s_mov_b32 s91, s98
    s_mov_b32 s92, s97
    s_mov_b32 s93, s97
    s_mov_b32 s90, s91
    v_cvt_pk_bf16_f32 v32, v32, v33
    v_cvt_pk_bf16_f32 v33, v34, v35
    v_cvt_pk_bf16_f32 v34, v36, v37
    v_cvt_pk_bf16_f32 v35, v38, v39
    buffer_store_dwordx4 v[32:35], v2, s[8:11], s90 offen sc1
    s_add_u32 s90, s90, s100
    v_cvt_pk_bf16_f32 v40, v40, v41
    v_cvt_pk_bf16_f32 v41, v42, v43
    v_cvt_pk_bf16_f32 v42, v44, v45
    v_cvt_pk_bf16_f32 v43, v46, v47
    buffer_store_dwordx4 v[40:43], v2, s[8:11], s90 offen sc1
    s_add_u32 s90, s90, s100
    v_cvt_pk_bf16_f32 v48, v48, v49
    v_cvt_pk_bf16_f32 v49, v50, v51
    v_cvt_pk_bf16_f32 v50, v52, v53
    v_cvt_pk_bf16_f32 v51, v54, v55
    buffer_store_dwordx4 v[48:51], v2, s[8:11], s90 offen sc1
    s_add_u32 s90, s90, s100
    v_cvt_pk_bf16_f32 v56, v56, v57
    v_cvt_pk_bf16_f32 v57, v58, v59
    v_cvt_pk_bf16_f32 v58, v60, v61
    v_cvt_pk_bf16_f32 v59, v62, v63
    buffer_store_dwordx4 v[56:59], v2, s[8:11], s90 offen sc1
    s_add_u32 s90, s90, s100
    v_cvt_pk_bf16_f32 v64, v64, v65
    v_cvt_pk_bf16_f32 v65, v66, v67
    v_cvt_pk_bf16_f32 v66, v68, v69
    v_cvt_pk_bf16_f32 v67, v70, v71
    buffer_store_dwordx4 v[64:67], v2, s[8:11], s90 offen sc1
    s_add_u32 s90, s90, s100
    v_cvt_pk_bf16_f32 v72, v72, v73
    v_cvt_pk_bf16_f32 v73, v74, v75
    v_cvt_pk_bf16_f32 v74, v76, v77
    v_cvt_pk_bf16_f32 v75, v78, v79
    buffer_store_dwordx4 v[72:75], v2, s[8:11], s90 offen sc1
    s_add_u32 s90, s90, s100
    v_cvt_pk_bf16_f32 v80, v80, v81
    v_cvt_pk_bf16_f32 v81, v82, v83
    v_cvt_pk_bf16_f32 v82, v84, v85
    v_cvt_pk_bf16_f32 v83, v86, v87
    buffer_store_dwordx4 v[80:83], v2, s[8:11], s90 offen sc1
    s_add_u32 s90, s90, s100
    v_cvt_pk_bf16_f32 v88, v88, v89
    v_cvt_pk_bf16_f32 v89, v90, v91
    v_cvt_pk_bf16_f32 v90, v92, v93
    v_cvt_pk_bf16_f32 v91, v94, v95
    buffer_store_dwordx4 v[88:91], v2, s[8:11], s90 offen sc1
    s_add_u32 s90, s90, s100
    s_add_u32 s91, s91, s99
    s_mov_b32 s90, s91
    v_cvt_pk_bf16_f32 v96, v96, v97
    v_cvt_pk_bf16_f32 v97, v98, v99
    v_cvt_pk_bf16_f32 v98, v100, v101
    v_cvt_pk_bf16_f32 v99, v102, v103
    buffer_store_dwordx4 v[96:99], v2, s[8:11], s90 offen sc1
    s_add_u32 s90, s90, s100
    v_cvt_pk_bf16_f32 v104, v104, v105
    v_cvt_pk_bf16_f32 v105, v106, v107
    v_cvt_pk_bf16_f32 v106, v108, v109
    v_cvt_pk_bf16_f32 v107, v110, v111
    buffer_store_dwordx4 v[104:107], v2, s[8:11], s90 offen sc1
    s_add_u32 s90, s90, s100
    v_cvt_pk_bf16_f32 v112, v112, v113
    v_cvt_pk_bf16_f32 v113, v114, v115
    v_cvt_pk_bf16_f32 v114, v116, v117
    v_cvt_pk_bf16_f32 v115, v118, v119
    buffer_store_dwordx4 v[112:115], v2, s[8:11], s90 offen sc1
    s_add_u32 s90, s90, s100
    v_cvt_pk_bf16_f32 v120, v120, v121
    v_cvt_pk_bf16_f32 v121, v122, v123
    v_cvt_pk_bf16_f32 v122, v124, v125
    v_cvt_pk_bf16_f32 v123, v126, v127
    buffer_store_dwordx4 v[120:123], v2, s[8:11], s90 offen sc1
    s_add_u32 s90, s90, s100
    v_cvt_pk_bf16_f32 v128, v128, v129
    v_cvt_pk_bf16_f32 v129, v130, v131
    v_cvt_pk_bf16_f32 v130, v132, v133
    v_cvt_pk_bf16_f32 v131, v134, v135
    buffer_store_dwordx4 v[128:131], v2, s[8:11], s90 offen sc1
    s_add_u32 s90, s90, s100
    v_cvt_pk_bf16_f32 v136, v136, v137
    v_cvt_pk_bf16_f32 v137, v138, v139
    v_cvt_pk_bf16_f32 v138, v140, v141
    v_cvt_pk_bf16_f32 v139, v142, v143
    buffer_store_dwordx4 v[136:139], v2, s[8:11], s90 offen sc1
    s_add_u32 s90, s90, s100
    v_cvt_pk_bf16_f32 v144, v144, v145
    v_cvt_pk_bf16_f32 v145, v146, v147
    v_cvt_pk_bf16_f32 v146, v148, v149
    v_cvt_pk_bf16_f32 v147, v150, v151
    buffer_store_dwordx4 v[144:147], v2, s[8:11], s90 offen sc1
    s_add_u32 s90, s90, s100
    v_cvt_pk_bf16_f32 v152, v152, v153
    v_cvt_pk_bf16_f32 v153, v154, v155
    v_cvt_pk_bf16_f32 v154, v156, v157
    v_cvt_pk_bf16_f32 v155, v158, v159
    buffer_store_dwordx4 v[152:155], v2, s[8:11], s90 offen sc1
    s_add_u32 s90, s90, s100
    s_add_u32 s91, s91, s99
    s_mov_b32 s90, s91
    v_cvt_pk_bf16_f32 v160, v160, v161
    v_cvt_pk_bf16_f32 v161, v162, v163
    v_cvt_pk_bf16_f32 v162, v164, v165
    v_cvt_pk_bf16_f32 v163, v166, v167
    buffer_store_dwordx4 v[160:163], v2, s[8:11], s90 offen sc1
    s_add_u32 s90, s90, s100
    v_cvt_pk_bf16_f32 v168, v168, v169
    v_cvt_pk_bf16_f32 v169, v170, v171
    v_cvt_pk_bf16_f32 v170, v172, v173
    v_cvt_pk_bf16_f32 v171, v174, v175
    buffer_store_dwordx4 v[168:171], v2, s[8:11], s90 offen sc1
    s_add_u32 s90, s90, s100
    v_cvt_pk_bf16_f32 v176, v176, v177
    v_cvt_pk_bf16_f32 v177, v178, v179
    v_cvt_pk_bf16_f32 v178, v180, v181
    v_cvt_pk_bf16_f32 v179, v182, v183
    buffer_store_dwordx4 v[176:179], v2, s[8:11], s90 offen sc1
    s_add_u32 s90, s90, s100
    v_cvt_pk_bf16_f32 v184, v184, v185
    v_cvt_pk_bf16_f32 v185, v186, v187
    v_cvt_pk_bf16_f32 v186, v188, v189
    v_cvt_pk_bf16_f32 v187, v190, v191
    buffer_store_dwordx4 v[184:187], v2, s[8:11], s90 offen sc1
    s_add_u32 s90, s90, s100
    v_cvt_pk_bf16_f32 v192, v192, v193
    v_cvt_pk_bf16_f32 v193, v194, v195
    v_cvt_pk_bf16_f32 v194, v196, v197
    v_cvt_pk_bf16_f32 v195, v198, v199
    buffer_store_dwordx4 v[192:195], v2, s[8:11], s90 offen sc1
    s_add_u32 s90, s90, s100
    v_cvt_pk_bf16_f32 v200, v200, v201
    v_cvt_pk_bf16_f32 v201, v202, v203
    v_cvt_pk_bf16_f32 v202, v204, v205
    v_cvt_pk_bf16_f32 v203, v206, v207
    buffer_store_dwordx4 v[200:203], v2, s[8:11], s90 offen sc1
    s_add_u32 s90, s90, s100
    v_cvt_pk_bf16_f32 v208, v208, v209
    v_cvt_pk_bf16_f32 v209, v210, v211
    v_cvt_pk_bf16_f32 v210, v212, v213
    v_cvt_pk_bf16_f32 v211, v214, v215
    buffer_store_dwordx4 v[208:211], v2, s[8:11], s90 offen sc1
    s_add_u32 s90, s90, s100
    v_cvt_pk_bf16_f32 v216, v216, v217
    v_cvt_pk_bf16_f32 v217, v218, v219
    v_cvt_pk_bf16_f32 v218, v220, v221
    v_cvt_pk_bf16_f32 v219, v222, v223
    buffer_store_dwordx4 v[216:219], v2, s[8:11], s90 offen sc1
    s_add_u32 s90, s90, s100
    s_add_u32 s91, s91, s99
    s_mov_b32 s90, s91
    v_cvt_pk_bf16_f32 v224, v224, v225
    v_cvt_pk_bf16_f32 v225, v226, v227
    v_cvt_pk_bf16_f32 v226, v228, v229
    v_cvt_pk_bf16_f32 v227, v230, v231
    buffer_store_dwordx4 v[224:227], v2, s[8:11], s90 offen sc1
    s_add_u32 s90, s90, s100
    v_cvt_pk_bf16_f32 v232, v232, v233
    v_cvt_pk_bf16_f32 v233, v234, v235
    v_cvt_pk_bf16_f32 v234, v236, v237
    v_cvt_pk_bf16_f32 v235, v238, v239
    buffer_store_dwordx4 v[232:235], v2, s[8:11], s90 offen sc1
    s_add_u32 s90, s90, s100
    v_cvt_pk_bf16_f32 v240, v240, v241
    v_cvt_pk_bf16_f32 v241, v242, v243
    v_cvt_pk_bf16_f32 v242, v244, v245
    v_cvt_pk_bf16_f32 v243, v246, v247
    buffer_store_dwordx4 v[240:243], v2, s[8:11], s90 offen sc1
    s_add_u32 s90, s90, s100
    v_cvt_pk_bf16_f32 v248, v248, v249
    v_cvt_pk_bf16_f32 v249, v250, v251
    v_cvt_pk_bf16_f32 v250, v252, v253
    v_cvt_pk_bf16_f32 v251, v254, v255
    buffer_store_dwordx4 v[248:251], v2, s[8:11], s90 offen sc1
    s_add_u32 s90, s90, s100
    v_accvgpr_read_b32 v24, a96
    v_accvgpr_read_b32 v25, a97
    v_accvgpr_read_b32 v26, a98
    v_accvgpr_read_b32 v27, a99
    v_accvgpr_read_b32 v28, a100
    v_accvgpr_read_b32 v29, a101
    v_accvgpr_read_b32 v30, a102
    v_accvgpr_read_b32 v31, a103
    v_cvt_pk_bf16_f32 v24, v24, v25
    v_cvt_pk_bf16_f32 v25, v26, v27
    v_cvt_pk_bf16_f32 v26, v28, v29
    v_cvt_pk_bf16_f32 v27, v30, v31
    buffer_store_dwordx4 v[24:27], v2, s[8:11], s90 offen sc1
    s_add_u32 s90, s90, s100
    s_nop 1
    v_accvgpr_read_b32 v24, a104
    v_accvgpr_read_b32 v25, a105
    v_accvgpr_read_b32 v26, a106
    v_accvgpr_read_b32 v27, a107
    v_accvgpr_read_b32 v28, a108
    v_accvgpr_read_b32 v29, a109
    v_accvgpr_read_b32 v30, a110
    v_accvgpr_read_b32 v31, a111
    v_cvt_pk_bf16_f32 v24, v24, v25
    v_cvt_pk_bf16_f32 v25, v26, v27
    v_cvt_pk_bf16_f32 v26, v28, v29
    v_cvt_pk_bf16_f32 v27, v30, v31
    buffer_store_dwordx4 v[24:27], v2, s[8:11], s90 offen sc1
    s_add_u32 s90, s90, s100
    s_nop 1
    v_accvgpr_read_b32 v24, a112
    v_accvgpr_read_b32 v25, a113
    v_accvgpr_read_b32 v26, a114
    v_accvgpr_read_b32 v27, a115
    v_accvgpr_read_b32 v28, a116
    v_accvgpr_read_b32 v29, a117
    v_accvgpr_read_b32 v30, a118
    v_accvgpr_read_b32 v31, a119
    v_cvt_pk_bf16_f32 v24, v24, v25
    v_cvt_pk_bf16_f32 v25, v26, v27
    v_cvt_pk_bf16_f32 v26, v28, v29
    v_cvt_pk_bf16_f32 v27, v30, v31
    buffer_store_dwordx4 v[24:27], v2, s[8:11], s90 offen sc1
    s_add_u32 s90, s90, s100
    s_nop 1
    v_accvgpr_read_b32 v24, a120
    v_accvgpr_read_b32 v25, a121
    v_accvgpr_read_b32 v26, a122
    v_accvgpr_read_b32 v27, a123
    v_accvgpr_read_b32 v28, a124
    v_accvgpr_read_b32 v29, a125
    v_accvgpr_read_b32 v30, a126
    v_accvgpr_read_b32 v31, a127
    v_cvt_pk_bf16_f32 v24, v24, v25
    v_cvt_pk_bf16_f32 v25, v26, v27
    v_cvt_pk_bf16_f32 v26, v28, v29
    v_cvt_pk_bf16_f32 v27, v30, v31
    buffer_store_dwordx4 v[24:27], v2, s[8:11], s90 offen sc1
    s_add_u32 s90, s90, s100
    s_nop 1
    s_add_u32 s91, s91, s99
    s_setpc_b64 s[20:21]
mega_kernel_epl61:
    s_mov_b32 s92, s97
    s_mov_b32 s93, s97
    s_cmp_eq_u32 s97, 0
    s_cbranch_scc1 mega_kernel_ns262
    s_mov_b32 s90, s98
    v_pk_mul_f32 v[32:33], v[32:33], s[92:93]
    v_pk_mul_f32 v[34:35], v[34:35], s[92:93]
    v_pk_mul_f32 v[36:37], v[36:37], s[92:93]
    v_pk_mul_f32 v[38:39], v[38:39], s[92:93]
    v_cvt_pk_bf16_f32 v32, v32, v33
    v_cvt_pk_bf16_f32 v33, v34, v35
    v_cvt_pk_bf16_f32 v34, v36, v37
    v_cvt_pk_bf16_f32 v35, v38, v39
    buffer_store_dwordx4 v[32:35], v2, s[8:11], s90 offen sc1
    s_add_u32 s90, s90, s100
    v_pk_mul_f32 v[40:41], v[40:41], s[92:93]
    v_pk_mul_f32 v[42:43], v[42:43], s[92:93]
    v_pk_mul_f32 v[44:45], v[44:45], s[92:93]
    v_pk_mul_f32 v[46:47], v[46:47], s[92:93]
    v_cvt_pk_bf16_f32 v40, v40, v41
    v_cvt_pk_bf16_f32 v41, v42, v43
    v_cvt_pk_bf16_f32 v42, v44, v45
    v_cvt_pk_bf16_f32 v43, v46, v47
    buffer_store_dwordx4 v[40:43], v2, s[8:11], s90 offen sc1
    s_add_u32 s90, s90, s100
    v_pk_mul_f32 v[48:49], v[48:49], s[92:93]
    v_pk_mul_f32 v[50:51], v[50:51], s[92:93]
    v_pk_mul_f32 v[52:53], v[52:53], s[92:93]
    v_pk_mul_f32 v[54:55], v[54:55], s[92:93]
    v_cvt_pk_bf16_f32 v48, v48, v49
    v_cvt_pk_bf16_f32 v49, v50, v51
    v_cvt_pk_bf16_f32 v50, v52, v53
    v_cvt_pk_bf16_f32 v51, v54, v55
    buffer_store_dwordx4 v[48:51], v2, s[8:11], s90 offen sc1
    s_add_u32 s90, s90, s100
    v_pk_mul_f32 v[56:57], v[56:57], s[92:93]
    v_pk_mul_f32 v[58:59], v[58:59], s[92:93]
    v_pk_mul_f32 v[60:61], v[60:61], s[92:93]
    v_pk_mul_f32 v[62:63], v[62:63], s[92:93]
    v_cvt_pk_bf16_f32 v56, v56, v57
    v_cvt_pk_bf16_f32 v57, v58, v59
    v_cvt_pk_bf16_f32 v58, v60, v61
    v_cvt_pk_bf16_f32 v59, v62, v63
    buffer_store_dwordx4 v[56:59], v2, s[8:11], s90 offen sc1
    s_add_u32 s90, s90, s100
    v_pk_mul_f32 v[64:65], v[64:65], s[92:93]
    v_pk_mul_f32 v[66:67], v[66:67], s[92:93]
    v_pk_mul_f32 v[68:69], v[68:69], s[92:93]
    v_pk_mul_f32 v[70:71], v[70:71], s[92:93]
    v_cvt_pk_bf16_f32 v64, v64, v65
    v_cvt_pk_bf16_f32 v65, v66, v67
    v_cvt_pk_bf16_f32 v66, v68, v69
    v_cvt_pk_bf16_f32 v67, v70, v71
    buffer_store_dwordx4 v[64:67], v2, s[8:11], s90 offen sc1
    s_add_u32 s90, s90, s100
    v_pk_mul_f32 v[72:73], v[72:73], s[92:93]
    v_pk_mul_f32 v[74:75], v[74:75], s[92:93]
    v_pk_mul_f32 v[76:77], v[76:77], s[92:93]
    v_pk_mul_f32 v[78:79], v[78:79], s[92:93]
    v_cvt_pk_bf16_f32 v72, v72, v73
    v_cvt_pk_bf16_f32 v73, v74, v75
    v_cvt_pk_bf16_f32 v74, v76, v77
    v_cvt_pk_bf16_f32 v75, v78, v79
    buffer_store_dwordx4 v[72:75], v2, s[8:11], s90 offen sc1
    s_add_u32 s90, s90, s100
    v_pk_mul_f32 v[80:81], v[80:81], s[92:93]
    v_pk_mul_f32 v[82:83], v[82:83], s[92:93]
    v_pk_mul_f32 v[84:85], v[84:85], s[92:93]
    v_pk_mul_f32 v[86:87], v[86:87], s[92:93]
    v_cvt_pk_bf16_f32 v80, v80, v81
    v_cvt_pk_bf16_f32 v81, v82, v83
    v_cvt_pk_bf16_f32 v82, v84, v85
    v_cvt_pk_bf16_f32 v83, v86, v87
    buffer_store_dwordx4 v[80:83], v2, s[8:11], s90 offen sc1
    s_add_u32 s90, s90, s100
    v_pk_mul_f32 v[88:89], v[88:89], s[92:93]
    v_pk_mul_f32 v[90:91], v[90:91], s[92:93]
    v_pk_mul_f32 v[92:93], v[92:93], s[92:93]
    v_pk_mul_f32 v[94:95], v[94:95], s[92:93]
    v_cvt_pk_bf16_f32 v88, v88, v89
    v_cvt_pk_bf16_f32 v89, v90, v91
    v_cvt_pk_bf16_f32 v90, v92, v93
    v_cvt_pk_bf16_f32 v91, v94, v95
    buffer_store_dwordx4 v[88:91], v2, s[8:11], s90 offen sc1
    s_add_u32 s90, s98, s99
    v_pk_mul_f32 v[96:97], v[96:97], s[92:93]
    v_pk_mul_f32 v[98:99], v[98:99], s[92:93]
    v_pk_mul_f32 v[100:101], v[100:101], s[92:93]
    v_pk_mul_f32 v[102:103], v[102:103], s[92:93]
    v_cvt_pk_bf16_f32 v96, v96, v97
    v_cvt_pk_bf16_f32 v97, v98, v99
    v_cvt_pk_bf16_f32 v98, v100, v101
    v_cvt_pk_bf16_f32 v99, v102, v103
    buffer_store_dwordx4 v[96:99], v2, s[8:11], s90 offen sc1
    s_add_u32 s90, s90, s100
    v_pk_mul_f32 v[104:105], v[104:105], s[92:93]
    v_pk_mul_f32 v[106:107], v[106:107], s[92:93]
    v_pk_mul_f32 v[108:109], v[108:109], s[92:93]
    v_pk_mul_f32 v[110:111], v[110:111], s[92:93]
    v_cvt_pk_bf16_f32 v104, v104, v105
    v_cvt_pk_bf16_f32 v105, v106, v107
    v_cvt_pk_bf16_f32 v106, v108, v109
    v_cvt_pk_bf16_f32 v107, v110, v111
    buffer_store_dwordx4 v[104:107], v2, s[8:11], s90 offen sc1
    s_add_u32 s90, s90, s100
    v_pk_mul_f32 v[112:113], v[112:113], s[92:93]
    v_pk_mul_f32 v[114:115], v[114:115], s[92:93]
    v_pk_mul_f32 v[116:117], v[116:117], s[92:93]
    v_pk_mul_f32 v[118:119], v[118:119], s[92:93]
    v_cvt_pk_bf16_f32 v112, v112, v113
    v_cvt_pk_bf16_f32 v113, v114, v115
    v_cvt_pk_bf16_f32 v114, v116, v117
    v_cvt_pk_bf16_f32 v115, v118, v119
    buffer_store_dwordx4 v[112:115], v2, s[8:11], s90 offen sc1
    s_add_u32 s90, s90, s100
    v_pk_mul_f32 v[120:121], v[120:121], s[92:93]
    v_pk_mul_f32 v[122:123], v[122:123], s[92:93]
    v_pk_mul_f32 v[124:125], v[124:125], s[92:93]
    v_pk_mul_f32 v[126:127], v[126:127], s[92:93]
    v_cvt_pk_bf16_f32 v120, v120, v121
    v_cvt_pk_bf16_f32 v121, v122, v123
    v_cvt_pk_bf16_f32 v122, v124, v125
    v_cvt_pk_bf16_f32 v123, v126, v127
    buffer_store_dwordx4 v[120:123], v2, s[8:11], s90 offen sc1
    s_add_u32 s90, s90, s100
    v_pk_mul_f32 v[128:129], v[128:129], s[92:93]
    v_pk_mul_f32 v[130:131], v[130:131], s[92:93]
    v_pk_mul_f32 v[132:133], v[132:133], s[92:93]
    v_pk_mul_f32 v[134:135], v[134:135], s[92:93]
    v_cvt_pk_bf16_f32 v128, v128, v129
    v_cvt_pk_bf16_f32 v129, v130, v131
    v_cvt_pk_bf16_f32 v130, v132, v133
    v_cvt_pk_bf16_f32 v131, v134, v135
    buffer_store_dwordx4 v[128:131], v2, s[8:11], s90 offen sc1
    s_add_u32 s90, s90, s100
    v_pk_mul_f32 v[136:137], v[136:137], s[92:93]
    v_pk_mul_f32 v[138:139], v[138:139], s[92:93]
    v_pk_mul_f32 v[140:141], v[140:141], s[92:93]
    v_pk_mul_f32 v[142:143], v[142:143], s[92:93]
    v_cvt_pk_bf16_f32 v136, v136, v137
    v_cvt_pk_bf16_f32 v137, v138, v139
    v_cvt_pk_bf16_f32 v138, v140, v141
    v_cvt_pk_bf16_f32 v139, v142, v143
    buffer_store_dwordx4 v[136:139], v2, s[8:11], s90 offen sc1
    s_add_u32 s90, s90, s100
    v_pk_mul_f32 v[144:145], v[144:145], s[92:93]
    v_pk_mul_f32 v[146:147], v[146:147], s[92:93]
    v_pk_mul_f32 v[148:149], v[148:149], s[92:93]
    v_pk_mul_f32 v[150:151], v[150:151], s[92:93]
    v_cvt_pk_bf16_f32 v144, v144, v145
    v_cvt_pk_bf16_f32 v145, v146, v147
    v_cvt_pk_bf16_f32 v146, v148, v149
    v_cvt_pk_bf16_f32 v147, v150, v151
    buffer_store_dwordx4 v[144:147], v2, s[8:11], s90 offen sc1
    s_add_u32 s90, s90, s100
    v_pk_mul_f32 v[152:153], v[152:153], s[92:93]
    v_pk_mul_f32 v[154:155], v[154:155], s[92:93]
    v_pk_mul_f32 v[156:157], v[156:157], s[92:93]
    v_pk_mul_f32 v[158:159], v[158:159], s[92:93]
    v_cvt_pk_bf16_f32 v152, v152, v153
    v_cvt_pk_bf16_f32 v153, v154, v155
    v_cvt_pk_bf16_f32 v154, v156, v157
    v_cvt_pk_bf16_f32 v155, v158, v159
    buffer_store_dwordx4 v[152:155], v2, s[8:11], s90 offen sc1
    s_add_u32 s90, s90, s100
    v_pk_mul_f32 v[192:193], v[192:193], s[92:93]
    v_pk_mul_f32 v[194:195], v[194:195], s[92:93]
    v_pk_mul_f32 v[196:197], v[196:197], s[92:93]
    v_pk_mul_f32 v[198:199], v[198:199], s[92:93]
    v_cvt_pk_bf16_f32 v192, v192, v193
    v_cvt_pk_bf16_f32 v193, v194, v195
    v_cvt_pk_bf16_f32 v194, v196, v197
    v_cvt_pk_bf16_f32 v195, v198, v199
    v_pk_mul_f32 v[200:201], v[200:201], s[92:93]
    v_pk_mul_f32 v[202:203], v[202:203], s[92:93]
    v_pk_mul_f32 v[204:205], v[204:205], s[92:93]
    v_pk_mul_f32 v[206:207], v[206:207], s[92:93]
    v_cvt_pk_bf16_f32 v196, v200, v201
    v_cvt_pk_bf16_f32 v197, v202, v203
    v_cvt_pk_bf16_f32 v198, v204, v205
    v_cvt_pk_bf16_f32 v199, v206, v207
    v_pk_mul_f32 v[208:209], v[208:209], s[92:93]
    v_pk_mul_f32 v[210:211], v[210:211], s[92:93]
    v_pk_mul_f32 v[212:213], v[212:213], s[92:93]
    v_pk_mul_f32 v[214:215], v[214:215], s[92:93]
    v_cvt_pk_bf16_f32 v200, v208, v209
    v_cvt_pk_bf16_f32 v201, v210, v211
    v_cvt_pk_bf16_f32 v202, v212, v213
    v_cvt_pk_bf16_f32 v203, v214, v215
    v_pk_mul_f32 v[216:217], v[216:217], s[92:93]
    v_pk_mul_f32 v[218:219], v[218:219], s[92:93]
    v_pk_mul_f32 v[220:221], v[220:221], s[92:93]
    v_pk_mul_f32 v[222:223], v[222:223], s[92:93]
    v_cvt_pk_bf16_f32 v204, v216, v217
    v_cvt_pk_bf16_f32 v205, v218, v219
    v_cvt_pk_bf16_f32 v206, v220, v221
    v_cvt_pk_bf16_f32 v207, v222, v223
    v_pk_mul_f32 v[224:225], v[224:225], s[92:93]
    v_pk_mul_f32 v[226:227], v[226:227], s[92:93]
    v_pk_mul_f32 v[228:229], v[228:229], s[92:93]
    v_pk_mul_f32 v[230:231], v[230:231], s[92:93]
    v_cvt_pk_bf16_f32 v208, v224, v225
    v_cvt_pk_bf16_f32 v209, v226, v227
    v_cvt_pk_bf16_f32 v210, v228, v229
    v_cvt_pk_bf16_f32 v211, v230, v231
    v_pk_mul_f32 v[232:233], v[232:233], s[92:93]
    v_pk_mul_f32 v[234:235], v[234:235], s[92:93]
    v_pk_mul_f32 v[236:237], v[236:237], s[92:93]
    v_pk_mul_f32 v[238:239], v[238:239], s[92:93]
    v_cvt_pk_bf16_f32 v212, v232, v233
    v_cvt_pk_bf16_f32 v213, v234, v235
    v_cvt_pk_bf16_f32 v214, v236, v237
    v_cvt_pk_bf16_f32 v215, v238, v239
    v_pk_mul_f32 v[240:241], v[240:241], s[92:93]
    v_pk_mul_f32 v[242:243], v[242:243], s[92:93]
    v_pk_mul_f32 v[244:245], v[244:245], s[92:93]
    v_pk_mul_f32 v[246:247], v[246:247], s[92:93]
    v_cvt_pk_bf16_f32 v216, v240, v241
    v_cvt_pk_bf16_f32 v217, v242, v243
    v_cvt_pk_bf16_f32 v218, v244, v245
    v_cvt_pk_bf16_f32 v219, v246, v247
    v_pk_mul_f32 v[248:249], v[248:249], s[92:93]
    v_pk_mul_f32 v[250:251], v[250:251], s[92:93]
    v_pk_mul_f32 v[252:253], v[252:253], s[92:93]
    v_pk_mul_f32 v[254:255], v[254:255], s[92:93]
    v_cvt_pk_bf16_f32 v220, v248, v249
    v_cvt_pk_bf16_f32 v221, v250, v251
    v_cvt_pk_bf16_f32 v222, v252, v253
    v_cvt_pk_bf16_f32 v223, v254, v255
    v_accvgpr_read_b32 v24, a96
    v_accvgpr_read_b32 v25, a97
    v_accvgpr_read_b32 v26, a98
    v_accvgpr_read_b32 v27, a99
    v_accvgpr_read_b32 v28, a100
    v_accvgpr_read_b32 v29, a101
    v_accvgpr_read_b32 v30, a102
    v_accvgpr_read_b32 v31, a103
    v_pk_mul_f32 v[24:25], v[24:25], s[92:93]
    v_pk_mul_f32 v[26:27], v[26:27], s[92:93]
    v_pk_mul_f32 v[28:29], v[28:29], s[92:93]
    v_pk_mul_f32 v[30:31], v[30:31], s[92:93]
    v_cvt_pk_bf16_f32 v224, v24, v25
    v_cvt_pk_bf16_f32 v225, v26, v27
    v_cvt_pk_bf16_f32 v226, v28, v29
    v_cvt_pk_bf16_f32 v227, v30, v31
    v_accvgpr_read_b32 v24, a104
    v_accvgpr_read_b32 v25, a105
    v_accvgpr_read_b32 v26, a106
    v_accvgpr_read_b32 v27, a107
    v_accvgpr_read_b32 v28, a108
    v_accvgpr_read_b32 v29, a109
    v_accvgpr_read_b32 v30, a110
    v_accvgpr_read_b32 v31, a111
    v_pk_mul_f32 v[24:25], v[24:25], s[92:93]
    v_pk_mul_f32 v[26:27], v[26:27], s[92:93]
    v_pk_mul_f32 v[28:29], v[28:29], s[92:93]
    v_pk_mul_f32 v[30:31], v[30:31], s[92:93]
    v_cvt_pk_bf16_f32 v228, v24, v25
    v_cvt_pk_bf16_f32 v229, v26, v27
    v_cvt_pk_bf16_f32 v230, v28, v29
    v_cvt_pk_bf16_f32 v231, v30, v31
    v_accvgpr_read_b32 v24, a112
    v_accvgpr_read_b32 v25, a113
    v_accvgpr_read_b32 v26, a114
    v_accvgpr_read_b32 v27, a115
    v_accvgpr_read_b32 v28, a116
    v_accvgpr_read_b32 v29, a117
    v_accvgpr_read_b32 v30, a118
    v_accvgpr_read_b32 v31, a119
    v_pk_mul_f32 v[24:25], v[24:25], s[92:93]
    v_pk_mul_f32 v[26:27], v[26:27], s[92:93]
    v_pk_mul_f32 v[28:29], v[28:29], s[92:93]
    v_pk_mul_f32 v[30:31], v[30:31], s[92:93]
    v_cvt_pk_bf16_f32 v232, v24, v25
    v_cvt_pk_bf16_f32 v233, v26, v27
    v_cvt_pk_bf16_f32 v234, v28, v29
    v_cvt_pk_bf16_f32 v235, v30, v31
    v_accvgpr_read_b32 v24, a120
    v_accvgpr_read_b32 v25, a121
    v_accvgpr_read_b32 v26, a122
    v_accvgpr_read_b32 v27, a123
    v_accvgpr_read_b32 v28, a124
    v_accvgpr_read_b32 v29, a125
    v_accvgpr_read_b32 v30, a126
    v_accvgpr_read_b32 v31, a127
    v_pk_mul_f32 v[24:25], v[24:25], s[92:93]
    v_pk_mul_f32 v[26:27], v[26:27], s[92:93]
    v_pk_mul_f32 v[28:29], v[28:29], s[92:93]
    v_pk_mul_f32 v[30:31], v[30:31], s[92:93]
    v_cvt_pk_bf16_f32 v236, v24, v25
    v_cvt_pk_bf16_f32 v237, v26, v27
    v_cvt_pk_bf16_f32 v238, v28, v29
    v_cvt_pk_bf16_f32 v239, v30, v31
    v_pk_mul_f32 v[160:161], v[160:161], s[92:93]
    v_pk_mul_f32 v[162:163], v[162:163], s[92:93]
    v_pk_mul_f32 v[164:165], v[164:165], s[92:93]
    v_pk_mul_f32 v[166:167], v[166:167], s[92:93]
    v_cvt_pk_bf16_f32 v240, v160, v161
    v_cvt_pk_bf16_f32 v241, v162, v163
    v_cvt_pk_bf16_f32 v242, v164, v165
    v_cvt_pk_bf16_f32 v243, v166, v167
    v_pk_mul_f32 v[168:169], v[168:169], s[92:93]
    v_pk_mul_f32 v[170:171], v[170:171], s[92:93]
    v_pk_mul_f32 v[172:173], v[172:173], s[92:93]
    v_pk_mul_f32 v[174:175], v[174:175], s[92:93]
    v_cvt_pk_bf16_f32 v244, v168, v169
    v_cvt_pk_bf16_f32 v245, v170, v171
    v_cvt_pk_bf16_f32 v246, v172, v173
    v_cvt_pk_bf16_f32 v247, v174, v175
    v_pk_mul_f32 v[176:177], v[176:177], s[92:93]
    v_pk_mul_f32 v[178:179], v[178:179], s[92:93]
    v_pk_mul_f32 v[180:181], v[180:181], s[92:93]
    v_pk_mul_f32 v[182:183], v[182:183], s[92:93]
    v_cvt_pk_bf16_f32 v248, v176, v177
    v_cvt_pk_bf16_f32 v249, v178, v179
    v_cvt_pk_bf16_f32 v250, v180, v181
    v_cvt_pk_bf16_f32 v251, v182, v183
    v_pk_mul_f32 v[184:185], v[184:185], s[92:93]
    v_pk_mul_f32 v[186:187], v[186:187], s[92:93]
    v_pk_mul_f32 v[188:189], v[188:189], s[92:93]
    v_pk_mul_f32 v[190:191], v[190:191], s[92:93]
    v_cvt_pk_bf16_f32 v252, v184, v185
    v_cvt_pk_bf16_f32 v253, v186, v187
    v_cvt_pk_bf16_f32 v254, v188, v189
    v_cvt_pk_bf16_f32 v255, v190, v191
    s_setpc_b64 s[20:21]
mega_kernel_ns262:
    s_mov_b32 s90, s98
    v_cvt_pk_bf16_f32 v32, v32, v33
    v_cvt_pk_bf16_f32 v33, v34, v35
    v_cvt_pk_bf16_f32 v34, v36, v37
    v_cvt_pk_bf16_f32 v35, v38, v39
    buffer_store_dwordx4 v[32:35], v2, s[8:11], s90 offen sc1
    s_add_u32 s90, s90, s100
    v_cvt_pk_bf16_f32 v40, v40, v41
    v_cvt_pk_bf16_f32 v41, v42, v43
    v_cvt_pk_bf16_f32 v42, v44, v45
    v_cvt_pk_bf16_f32 v43, v46, v47
    buffer_store_dwordx4 v[40:43], v2, s[8:11], s90 offen sc1
    s_add_u32 s90, s90, s100
    v_cvt_pk_bf16_f32 v48, v48, v49
    v_cvt_pk_bf16_f32 v49, v50, v51
    v_cvt_pk_bf16_f32 v50, v52, v53
    v_cvt_pk_bf16_f32 v51, v54, v55
    buffer_store_dwordx4 v[48:51], v2, s[8:11], s90 offen sc1
    s_add_u32 s90, s90, s100
    v_cvt_pk_bf16_f32 v56, v56, v57
    v_cvt_pk_bf16_f32 v57, v58, v59
    v_cvt_pk_bf16_f32 v58, v60, v61
    v_cvt_pk_bf16_f32 v59, v62, v63
    buffer_store_dwordx4 v[56:59], v2, s[8:11], s90 offen sc1
    s_add_u32 s90, s90, s100
    v_cvt_pk_bf16_f32 v64, v64, v65
    v_cvt_pk_bf16_f32 v65, v66, v67
    v_cvt_pk_bf16_f32 v66, v68, v69
    v_cvt_pk_bf16_f32 v67, v70, v71
    buffer_store_dwordx4 v[64:67], v2, s[8:11], s90 offen sc1
    s_add_u32 s90, s90, s100
    v_cvt_pk_bf16_f32 v72, v72, v73
    v_cvt_pk_bf16_f32 v73, v74, v75
    v_cvt_pk_bf16_f32 v74, v76, v77
    v_cvt_pk_bf16_f32 v75, v78, v79
    buffer_store_dwordx4 v[72:75], v2, s[8:11], s90 offen sc1
    s_add_u32 s90, s90, s100
    v_cvt_pk_bf16_f32 v80, v80, v81
    v_cvt_pk_bf16_f32 v81, v82, v83
    v_cvt_pk_bf16_f32 v82, v84, v85
    v_cvt_pk_bf16_f32 v83, v86, v87
    buffer_store_dwordx4 v[80:83], v2, s[8:11], s90 offen sc1
    s_add_u32 s90, s90, s100
    v_cvt_pk_bf16_f32 v88, v88, v89
    v_cvt_pk_bf16_f32 v89, v90, v91
    v_cvt_pk_bf16_f32 v90, v92, v93
    v_cvt_pk_bf16_f32 v91, v94, v95
    buffer_store_dwordx4 v[88:91], v2, s[8:11], s90 offen sc1
    s_add_u32 s90, s98, s99
    v_cvt_pk_bf16_f32 v96, v96, v97
    v_cvt_pk_bf16_f32 v97, v98, v99
    v_cvt_pk_bf16_f32 v98, v100, v101
    v_cvt_pk_bf16_f32 v99, v102, v103
    buffer_store_dwordx4 v[96:99], v2, s[8:11], s90 offen sc1
    s_add_u32 s90, s90, s100
    v_cvt_pk_bf16_f32 v104, v104, v105
    v_cvt_pk_bf16_f32 v105, v106, v107
    v_cvt_pk_bf16_f32 v106, v108, v109
    v_cvt_pk_bf16_f32 v107, v110, v111
    buffer_store_dwordx4 v[104:107], v2, s[8:11], s90 offen sc1
    s_add_u32 s90, s90, s100
    v_cvt_pk_bf16_f32 v112, v112, v113
    v_cvt_pk_bf16_f32 v113, v114, v115
    v_cvt_pk_bf16_f32 v114, v116, v117
    v_cvt_pk_bf16_f32 v115, v118, v119
    buffer_store_dwordx4 v[112:115], v2, s[8:11], s90 offen sc1
    s_add_u32 s90, s90, s100
    v_cvt_pk_bf16_f32 v120, v120, v121
    v_cvt_pk_bf16_f32 v121, v122, v123
    v_cvt_pk_bf16_f32 v122, v124, v125
    v_cvt_pk_bf16_f32 v123, v126, v127
    buffer_store_dwordx4 v[120:123], v2, s[8:11], s90 offen sc1
    s_add_u32 s90, s90, s100
    v_cvt_pk_bf16_f32 v128, v128, v129
    v_cvt_pk_bf16_f32 v129, v130, v131
    v_cvt_pk_bf16_f32 v130, v132, v133
    v_cvt_pk_bf16_f32 v131, v134, v135
    buffer_store_dwordx4 v[128:131], v2, s[8:11], s90 offen sc1
    s_add_u32 s90, s90, s100
    v_cvt_pk_bf16_f32 v136, v136, v137
    v_cvt_pk_bf16_f32 v137, v138, v139
    v_cvt_pk_bf16_f32 v138, v140, v141
    v_cvt_pk_bf16_f32 v139, v142, v143
    buffer_store_dwordx4 v[136:139], v2, s[8:11], s90 offen sc1
    s_add_u32 s90, s90, s100
    v_cvt_pk_bf16_f32 v144, v144, v145
    v_cvt_pk_bf16_f32 v145, v146, v147
    v_cvt_pk_bf16_f32 v146, v148, v149
    v_cvt_pk_bf16_f32 v147, v150, v151
    buffer_store_dwordx4 v[144:147], v2, s[8:11], s90 offen sc1
    s_add_u32 s90, s90, s100
    v_cvt_pk_bf16_f32 v152, v152, v153
    v_cvt_pk_bf16_f32 v153, v154, v155
    v_cvt_pk_bf16_f32 v154, v156, v157
    v_cvt_pk_bf16_f32 v155, v158, v159
    buffer_store_dwordx4 v[152:155], v2, s[8:11], s90 offen sc1
    s_add_u32 s90, s90, s100
    v_cvt_pk_bf16_f32 v192, v192, v193
    v_cvt_pk_bf16_f32 v193, v194, v195
    v_cvt_pk_bf16_f32 v194, v196, v197
    v_cvt_pk_bf16_f32 v195, v198, v199
    v_cvt_pk_bf16_f32 v196, v200, v201
    v_cvt_pk_bf16_f32 v197, v202, v203
    v_cvt_pk_bf16_f32 v198, v204, v205
    v_cvt_pk_bf16_f32 v199, v206, v207
    v_cvt_pk_bf16_f32 v200, v208, v209
    v_cvt_pk_bf16_f32 v201, v210, v211
    v_cvt_pk_bf16_f32 v202, v212, v213
    v_cvt_pk_bf16_f32 v203, v214, v215
    v_cvt_pk_bf16_f32 v204, v216, v217
    v_cvt_pk_bf16_f32 v205, v218, v219
    v_cvt_pk_bf16_f32 v206, v220, v221
    v_cvt_pk_bf16_f32 v207, v222, v223
    v_cvt_pk_bf16_f32 v208, v224, v225
    v_cvt_pk_bf16_f32 v209, v226, v227
    v_cvt_pk_bf16_f32 v210, v228, v229
    v_cvt_pk_bf16_f32 v211, v230, v231
    v_cvt_pk_bf16_f32 v212, v232, v233
    v_cvt_pk_bf16_f32 v213, v234, v235
    v_cvt_pk_bf16_f32 v214, v236, v237
    v_cvt_pk_bf16_f32 v215, v238, v239
    v_cvt_pk_bf16_f32 v216, v240, v241
    v_cvt_pk_bf16_f32 v217, v242, v243
    v_cvt_pk_bf16_f32 v218, v244, v245
    v_cvt_pk_bf16_f32 v219, v246, v247
    v_cvt_pk_bf16_f32 v220, v248, v249
    v_cvt_pk_bf16_f32 v221, v250, v251
    v_cvt_pk_bf16_f32 v222, v252, v253
    v_cvt_pk_bf16_f32 v223, v254, v255
    v_accvgpr_read_b32 v24, a96
    v_accvgpr_read_b32 v25, a97
    v_accvgpr_read_b32 v26, a98
    v_accvgpr_read_b32 v27, a99
    v_accvgpr_read_b32 v28, a100
    v_accvgpr_read_b32 v29, a101
    v_accvgpr_read_b32 v30, a102
    v_accvgpr_read_b32 v31, a103
    v_cvt_pk_bf16_f32 v224, v24, v25
    v_cvt_pk_bf16_f32 v225, v26, v27
    v_cvt_pk_bf16_f32 v226, v28, v29
    v_cvt_pk_bf16_f32 v227, v30, v31
    v_accvgpr_read_b32 v24, a104
    v_accvgpr_read_b32 v25, a105
    v_accvgpr_read_b32 v26, a106
    v_accvgpr_read_b32 v27, a107
    v_accvgpr_read_b32 v28, a108
    v_accvgpr_read_b32 v29, a109
    v_accvgpr_read_b32 v30, a110
    v_accvgpr_read_b32 v31, a111
    v_cvt_pk_bf16_f32 v228, v24, v25
    v_cvt_pk_bf16_f32 v229, v26, v27
    v_cvt_pk_bf16_f32 v230, v28, v29
    v_cvt_pk_bf16_f32 v231, v30, v31
    v_accvgpr_read_b32 v24, a112
    v_accvgpr_read_b32 v25, a113
    v_accvgpr_read_b32 v26, a114
    v_accvgpr_read_b32 v27, a115
    v_accvgpr_read_b32 v28, a116
    v_accvgpr_read_b32 v29, a117
    v_accvgpr_read_b32 v30, a118
    v_accvgpr_read_b32 v31, a119
    v_cvt_pk_bf16_f32 v232, v24, v25
    v_cvt_pk_bf16_f32 v233, v26, v27
    v_cvt_pk_bf16_f32 v234, v28, v29
    v_cvt_pk_bf16_f32 v235, v30, v31
    v_accvgpr_read_b32 v24, a120
    v_accvgpr_read_b32 v25, a121
    v_accvgpr_read_b32 v26, a122
    v_accvgpr_read_b32 v27, a123
    v_accvgpr_read_b32 v28, a124
    v_accvgpr_read_b32 v29, a125
    v_accvgpr_read_b32 v30, a126
    v_accvgpr_read_b32 v31, a127
    v_cvt_pk_bf16_f32 v236, v24, v25
    v_cvt_pk_bf16_f32 v237, v26, v27
    v_cvt_pk_bf16_f32 v238, v28, v29
    v_cvt_pk_bf16_f32 v239, v30, v31
    v_cvt_pk_bf16_f32 v240, v160, v161
    v_cvt_pk_bf16_f32 v241, v162, v163
    v_cvt_pk_bf16_f32 v242, v164, v165
    v_cvt_pk_bf16_f32 v243, v166, v167
    v_cvt_pk_bf16_f32 v244, v168, v169
    v_cvt_pk_bf16_f32 v245, v170, v171
    v_cvt_pk_bf16_f32 v246, v172, v173
    v_cvt_pk_bf16_f32 v247, v174, v175
    v_cvt_pk_bf16_f32 v248, v176, v177
    v_cvt_pk_bf16_f32 v249, v178, v179
    v_cvt_pk_bf16_f32 v250, v180, v181
    v_cvt_pk_bf16_f32 v251, v182, v183
    v_cvt_pk_bf16_f32 v252, v184, v185
    v_cvt_pk_bf16_f32 v253, v186, v187
    v_cvt_pk_bf16_f32 v254, v188, v189
    v_cvt_pk_bf16_f32 v255, v190, v191
    s_setpc_b64 s[20:21]
mega_kernel_end:
.text
.globl gemm3_kernel
.p2align 8
.type gemm3_kernel,@function
gemm3_kernel:
    s_cmp_ge_u32 s2, 256
    s_cbranch_scc1 gemm3_kernel_end1
    s_load_dwordx8 s[4:11], s[0:1], 64
    s_load_dwordx2 s[12:13], s[0:1], 16
    v_and_b32 v1, 63, v0
    v_lshrrev_b32 v16, 6, v0
    s_nop 0
    v_readfirstlane_b32 s32, v16
    s_nop 3
    s_lshr_b32 s36, s32, 2
    s_and_b32 s32, s32, 3
    s_bfe_u32 s35, s2, 0x10002
    s_xor_b32 s35, s35, 1
    s_bfe_u32 s48, s2, 0x10001
    s_lshl_b32 s48, s48, 3
    s_bfe_u32 s49, s2, 0x30003
    s_add_u32 s37, s48, s49
    s_and_b32 s48, s2, 1
    s_lshl_b32 s48, s48, 2
    s_lshr_b32 s49, s2, 6
    s_add_u32 s38, s48, s49
    s_lshr_b32 s33, s32, 1
    s_and_b32 s34, s32, 1
    v_lshlrev_b32 v7, 4, v1
    s_cmp_eq_u32 s36, 1
    s_cbranch_scc1 gemm3_kernel_load2
    s_lshl_b32 s39, s37, 3
    s_add_u32 s39, s39, s38
    s_lshl_b32 s48, s33, 12
    v_add_u32 v2, s48, v7
    v_lshrrev_b32 v16, 2, v1
    v_lshlrev_b32 v16, 8, v16
    v_and_b32 v17, 3, v1
    v_lshl_add_u32 v16, v17, 3, v16
    v_add_u32 v16, 16384, v16
    v_bfe_u32 v17, v1, 2, 3
    s_lshl_b32 s48, s34, 2
    v_xor_b32 v17, s48, v17
    v_xor_b32 v18, 0, v17
    v_lshl_add_u32 v3, v18, 5, v16
    v_xor_b32 v18, 1, v17
    v_lshl_add_u32 v4, v18, 5, v16
    v_xor_b32 v18, 2, v17
    v_lshl_add_u32 v5, v18, 5, v16
    v_xor_b32 v18, 3, v17
    v_lshl_add_u32 v6, v18, 5, v16
    s_mov_b32 s43, 0
    s_mov_b32 s56, 32768
    s_cmp_eq_u32 s35, 1
    s_cselect_b32 s47, 38, 40
    v_mov_b32 v32, 0
    v_mov_b32 v33, 0
    v_mov_b32 v34, 0
    v_mov_b32 v35, 0
    v_mov_b32 v36, 0
    v_mov_b32 v37, 0
    v_mov_b32 v38, 0
    v_mov_b32 v39, 0
    v_mov_b32 v40, 0
    v_mov_b32 v41, 0
    v_mov_b32 v42, 0
    v_mov_b32 v43, 0
    v_mov_b32 v44, 0
    v_mov_b32 v45, 0
    v_mov_b32 v46, 0
    v_mov_b32 v47, 0
    v_mov_b32 v48, 0
    v_mov_b32 v49, 0
    v_mov_b32 v50, 0
    v_mov_b32 v51, 0
    v_mov_b32 v52, 0
    v_mov_b32 v53, 0
    v_mov_b32 v54, 0
    v_mov_b32 v55, 0
    v_mov_b32 v56, 0
    v_mov_b32 v57, 0
    v_mov_b32 v58, 0
    v_mov_b32 v59, 0
    v_mov_b32 v60, 0
    v_mov_b32 v61, 0
    v_mov_b32 v62, 0
    v_mov_b32 v63, 0
    v_mov_b32 v64, 0
    v_mov_b32 v65, 0
    v_mov_b32 v66, 0
    v_mov_b32 v67, 0
    v_mov_b32 v68, 0
    v_mov_b32 v69, 0
    v_mov_b32 v70, 0
    v_mov_b32 v71, 0
    v_mov_b32 v72, 0
    v_mov_b32 v73, 0
    v_mov_b32 v74, 0
    v_mov_b32 v75, 0
    v_mov_b32 v76, 0
    v_mov_b32 v77, 0
    v_mov_b32 v78, 0
    v_mov_b32 v79, 0
    v_mov_b32 v80, 0
    v_mov_b32 v81, 0
    v_mov_b32 v82, 0
    v_mov_b32 v83, 0
    v_mov_b32 v84, 0
    v_mov_b32 v85, 0
    v_mov_b32 v86, 0
    v_mov_b32 v87, 0
    v_mov_b32 v88, 0
    v_mov_b32 v89, 0
    v_mov_b32 v90, 0
    v_mov_b32 v91, 0
    v_mov_b32 v92, 0
    v_mov_b32 v93, 0
    v_mov_b32 v94, 0
    v_mov_b32 v95, 0
    v_and_b32 v16, 15, v1
    v_lshlrev_b32 v16, 12, v16
    v_lshlrev_b32 v16, s35, v16
    v_bfe_u32 v17, v1, 4, 1
    v_lshl_add_u32 v16, v17, 5, v16
    v_lshrrev_b32 v17, 5, v1
    v_lshl_add_u32 v12, v17, 4, v16
    s_lshl_b32 s48, s37, 3
    s_lshl_b32 s49, s33, 2
    s_add_u32 s48, s48, s49
    s_lshl_b32 s49, s48, 16
    s_add_u32 s49, s49, 2048
    s_and_b32 s50, s48, 63
    s_lshl_b32 s50, s50, 17
    s_lshr_b32 s51, s48, 6
    s_lshl_b32 s51, s51, 12
    s_add_u32 s50, s50, s51
    s_cmp_eq_u32 s35, 1
    s_cselect_b32 s41, s50, s49
    s_lshl_b32 s42, 0x10000, s35
    s_lshl_b32 s50, s38, 8
    s_lshl_b32 s51, s34, 7
    s_add_u32 s41, s41, s50
    s_add_u32 s41, s41, s51
    s_cmp_eq_u32 s35, 1
    s_cselect_b32 s57, 23, 35
    s_cselect_b32 s58, 0, 16
    s_waitcnt lgkmcnt(0)
    s_mov_b32 s24, s6
    s_mov_b32 s25, s7
    s_mov_b32 s27, 0x20000
    s_mov_b32 s26, 8388608
    s_mov_b32 s28, s10
    s_mov_b32 s29, s11
    s_mov_b32 s31, 0x20000
    s_mov_b32 s30, 268435456
    s_setprio 1
    s_barrier
    ds_read_b128 v[96:99], v2 offset:0
    ds_read_b64_tr_b16 v[112:113], v3 offset:0
    ds_read_b64_tr_b16 v[114:115], v3 offset:4096
    ds_read_b128 v[100:103], v2 offset:1024
    ds_read_b128 v[104:107], v2 offset:2048
    ds_read_b128 v[108:111], v2 offset:3072
    ds_read_b64_tr_b16 v[116:117], v4 offset:0
    ds_read_b64_tr_b16 v[118:119], v4 offset:4096
    ds_read_b64_tr_b16 v[120:121], v5 offset:0
    ds_read_b64_tr_b16 v[122:123], v5 offset:4096
    ds_read_b64_tr_b16 v[124:125], v6 offset:0
    ds_read_b64_tr_b16 v[126:127], v6 offset:4096
gemm3_kernel_loop3:
    s_sub_u32 s57, s57, 1
    s_cbranch_scc1 gemm3_kernel_ev4
gemm3_kernel_back5:
    s_waitcnt lgkmcnt(9)
    v_mfma_f32_16x16x32_bf16 v[32:35], v[112:115], v[96:99], v[32:35]
    ds_read_b128 v[128:131], v2 offset:8192
    s_waitcnt lgkmcnt(9)
    v_mfma_f32_16x16x32_bf16 v[40:43], v[112:115], v[100:103], v[40:43]
    ds_read_b64_tr_b16 v[144:145], v3 offset:8192
    s_waitcnt lgkmcnt(9)
    v_mfma_f32_16x16x32_bf16 v[48:51], v[112:115], v[104:107], v[48:51]
    ds_read_b64_tr_b16 v[146:147], v3 offset:12288
    s_waitcnt lgkmcnt(9)
    v_mfma_f32_16x16x32_bf16 v[56:59], v[112:115], v[108:111], v[56:59]
    ds_read_b128 v[132:135], v2 offset:9216
    s_waitcnt lgkmcnt(8)
    v_mfma_f32_16x16x32_bf16 v[36:39], v[116:119], v[96:99], v[36:39]
    ds_read_b128 v[136:139], v2 offset:10240
    v_mfma_f32_16x16x32_bf16 v[44:47], v[116:119], v[100:103], v[44:47]
    ds_read_b128 v[140:143], v2 offset:11264
    v_mfma_f32_16x16x32_bf16 v[52:55], v[116:119], v[104:107], v[52:55]
    ds_read_b64_tr_b16 v[148:149], v4 offset:8192
    v_mfma_f32_16x16x32_bf16 v[60:63], v[116:119], v[108:111], v[60:63]
    ds_read_b64_tr_b16 v[150:151], v4 offset:12288
    s_waitcnt lgkmcnt(10)
    v_mfma_f32_16x16x32_bf16 v[64:67], v[120:123], v[96:99], v[64:67]
    s_add_u32 s43, s43, 32768
    ds_read_b64_tr_b16 v[152:153], v5 offset:8192
    v_mfma_f32_16x16x32_bf16 v[72:75], v[120:123], v[100:103], v[72:75]
    s_cmp_ge_u32 s43, 163840
    ds_read_b64_tr_b16 v[154:155], v5 offset:12288
    v_mfma_f32_16x16x32_bf16 v[80:83], v[120:123], v[104:107], v[80:83]
    s_cselect_b32 s46, 4294836224, s56
    ds_read_b64_tr_b16 v[156:157], v6 offset:8192
    v_mfma_f32_16x16x32_bf16 v[88:91], v[120:123], v[108:111], v[88:91]
    s_cselect_b32 s43, 0, s43
    ds_read_b64_tr_b16 v[158:159], v6 offset:12288
    s_waitcnt lgkmcnt(12)
    v_mfma_f32_16x16x32_bf16 v[68:71], v[124:127], v[96:99], v[68:71]
    v_add_u32 v2, s46, v2
    v_add_u32 v3, s46, v3
    v_mfma_f32_16x16x32_bf16 v[76:79], v[124:127], v[100:103], v[76:79]
    v_add_u32 v4, s46, v4
    v_add_u32 v5, s46, v5
    v_mfma_f32_16x16x32_bf16 v[84:87], v[124:127], v[104:107], v[84:87]
    v_add_u32 v6, s46, v6
    v_mfma_f32_16x16x32_bf16 v[92:95], v[124:127], v[108:111], v[92:95]
    s_waitcnt lgkmcnt(0)
    v_mfma_f32_16x16x32_bf16 v[32:35], v[144:147], v[128:131], v[32:35]
    s_barrier
    v_mfma_f32_16x16x32_bf16 v[40:43], v[144:147], v[132:135], v[40:43]
    ds_read_b128 v[96:99], v2 offset:0
    v_mfma_f32_16x16x32_bf16 v[48:51], v[144:147], v[136:139], v[48:51]
    ds_read_b64_tr_b16 v[112:113], v3 offset:0
    v_mfma_f32_16x16x32_bf16 v[56:59], v[144:147], v[140:143], v[56:59]
    ds_read_b64_tr_b16 v[114:115], v3 offset:4096
    v_mfma_f32_16x16x32_bf16 v[36:39], v[148:151], v[128:131], v[36:39]
    ds_read_b128 v[100:103], v2 offset:1024
    v_mfma_f32_16x16x32_bf16 v[44:47], v[148:151], v[132:135], v[44:47]
    ds_read_b128 v[104:107], v2 offset:2048
    v_mfma_f32_16x16x32_bf16 v[52:55], v[148:151], v[136:139], v[52:55]
    ds_read_b128 v[108:111], v2 offset:3072
    v_mfma_f32_16x16x32_bf16 v[60:63], v[148:151], v[140:143], v[60:63]
    ds_read_b64_tr_b16 v[116:117], v4 offset:0
    v_mfma_f32_16x16x32_bf16 v[64:67], v[152:155], v[128:131], v[64:67]
    ds_read_b64_tr_b16 v[118:119], v4 offset:4096
    v_mfma_f32_16x16x32_bf16 v[72:75], v[152:155], v[132:135], v[72:75]
    ds_read_b64_tr_b16 v[120:121], v5 offset:0
    v_mfma_f32_16x16x32_bf16 v[80:83], v[152:155], v[136:139], v[80:83]
    ds_read_b64_tr_b16 v[122:123], v5 offset:4096
    v_mfma_f32_16x16x32_bf16 v[88:91], v[152:155], v[140:143], v[88:91]
    ds_read_b64_tr_b16 v[124:125], v6 offset:0
    v_mfma_f32_16x16x32_bf16 v[68:71], v[156:159], v[128:131], v[68:71]
    ds_read_b64_tr_b16 v[126:127], v6 offset:4096
    v_mfma_f32_16x16x32_bf16 v[76:79], v[156:159], v[132:135], v[76:79]
    v_mfma_f32_16x16x32_bf16 v[84:87], v[156:159], v[136:139], v[84:87]
    s_sub_u32 s47, s47, 1
    v_mfma_f32_16x16x32_bf16 v[92:95], v[156:159], v[140:143], v[92:95]
    s_cbranch_scc0 gemm3_kernel_loop3
    s_nop 5
    s_cmp_eq_u32 s35, 1
    s_cbranch_scc1 gemm3_kernel_noadd7
    s_waitcnt vmcnt(0) lgkmcnt(0)
    v_lshlrev_b32 v96, 16, v160
    v_and_b32 v97, 0xffff0000, v160
    v_lshlrev_b32 v98, 16, v161
    v_and_b32 v99, 0xffff0000, v161
    v_lshlrev_b32 v100, 16, v162
    v_and_b32 v101, 0xffff0000, v162
    v_lshlrev_b32 v102, 16, v163
    v_and_b32 v103, 0xffff0000, v163
    v_lshlrev_b32 v104, 16, v164
    v_and_b32 v105, 0xffff0000, v164
    v_lshlrev_b32 v106, 16, v165
    v_and_b32 v107, 0xffff0000, v165
    v_lshlrev_b32 v108, 16, v166
    v_and_b32 v109, 0xffff0000, v166
    v_lshlrev_b32 v110, 16, v167
    v_and_b32 v111, 0xffff0000, v167
    v_lshlrev_b32 v112, 16, v168
    v_and_b32 v113, 0xffff0000, v168
    v_lshlrev_b32 v114, 16, v169
    v_and_b32 v115, 0xffff0000, v169
    v_lshlrev_b32 v116, 16, v170
    v_and_b32 v117, 0xffff0000, v170
    v_lshlrev_b32 v118, 16, v171
    v_and_b32 v119, 0xffff0000, v171
    v_lshlrev_b32 v120, 16, v172
    v_and_b32 v121, 0xffff0000, v172
    v_lshlrev_b32 v122, 16, v173
    v_and_b32 v123, 0xffff0000, v173
    v_lshlrev_b32 v124, 16, v174
    v_and_b32 v125, 0xffff0000, v174
    v_lshlrev_b32 v126, 16, v175
    v_and_b32 v127, 0xffff0000, v175
    v_lshlrev_b32 v128, 16, v176
    v_and_b32 v129, 0xffff0000, v176
    v_lshlrev_b32 v130, 16, v177
    v_and_b32 v131, 0xffff0000, v177
    v_lshlrev_b32 v132, 16, v178
    v_and_b32 v133, 0xffff0000, v178
    v_lshlrev_b32 v134, 16, v179
    v_and_b32 v135, 0xffff0000, v179
    v_lshlrev_b32 v136, 16, v180
    v_and_b32 v137, 0xffff0000, v180
    v_lshlrev_b32 v138, 16, v181
    v_and_b32 v139, 0xffff0000, v181
    v_lshlrev_b32 v140, 16, v182
    v_and_b32 v141, 0xffff0000, v182
    v_lshlrev_b32 v142, 16, v183
    v_and_b32 v143, 0xffff0000, v183
    v_lshlrev_b32 v144, 16, v184
    v_and_b32 v145, 0xffff0000, v184
    v_lshlrev_b32 v146, 16, v185
    v_and_b32 v147, 0xffff0000, v185
    v_lshlrev_b32 v148, 16, v186
    v_and_b32 v149, 0xffff0000, v186
    v_lshlrev_b32 v150, 16, v187
    v_and_b32 v151, 0xffff0000, v187
    v_lshlrev_b32 v152, 16, v188
    v_and_b32 v153, 0xffff0000, v188
    v_lshlrev_b32 v154, 16, v189
    v_and_b32 v155, 0xffff0000, v189
    v_lshlrev_b32 v156, 16, v190
    v_and_b32 v157, 0xffff0000, v190
    v_lshlrev_b32 v158, 16, v191
    v_and_b32 v159, 0xffff0000, v191
    v_pk_add_f32 v[32:33], v[32:33], v[96:97]
    v_pk_add_f32 v[34:35], v[34:35], v[98:99]
    v_pk_add_f32 v[36:37], v[36:37], v[100:101]
    v_pk_add_f32 v[38:39], v[38:39], v[102:103]
    v_pk_add_f32 v[40:41], v[40:41], v[104:105]
    v_pk_add_f32 v[42:43], v[42:43], v[106:107]
    v_pk_add_f32 v[44:45], v[44:45], v[108:109]
    v_pk_add_f32 v[46:47], v[46:47], v[110:111]
    v_pk_add_f32 v[48:49], v[48:49], v[112:113]
    v_pk_add_f32 v[50:51], v[50:51], v[114:115]
    v_pk_add_f32 v[52:53], v[52:53], v[116:117]
    v_pk_add_f32 v[54:55], v[54:55], v[118:119]
    v_pk_add_f32 v[56:57], v[56:57], v[120:121]
    v_pk_add_f32 v[58:59], v[58:59], v[122:123]
    v_pk_add_f32 v[60:61], v[60:61], v[124:125]
    v_pk_add_f32 v[62:63], v[62:63], v[126:127]
    v_pk_add_f32 v[64:65], v[64:65], v[128:129]
    v_pk_add_f32 v[66:67], v[66:67], v[130:131]
    v_pk_add_f32 v[68:69], v[68:69], v[132:133]
    v_pk_add_f32 v[70:71], v[70:71], v[134:135]
    v_pk_add_f32 v[72:73], v[72:73], v[136:137]
    v_pk_add_f32 v[74:75], v[74:75], v[138:139]
    v_pk_add_f32 v[76:77], v[76:77], v[140:141]
    v_pk_add_f32 v[78:79], v[78:79], v[142:143]
    v_pk_add_f32 v[80:81], v[80:81], v[144:145]
    v_pk_add_f32 v[82:83], v[82:83], v[146:147]
    v_pk_add_f32 v[84:85], v[84:85], v[148:149]
    v_pk_add_f32 v[86:87], v[86:87], v[150:151]
    v_pk_add_f32 v[88:89], v[88:89], v[152:153]
    v_pk_add_f32 v[90:91], v[90:91], v[154:155]
    v_pk_add_f32 v[92:93], v[92:93], v[156:157]
    v_pk_add_f32 v[94:95], v[94:95], v[158:159]
gemm3_kernel_noadd7:
    v_cvt_pk_bf16_f32 v32, v32, v33
    v_cvt_pk_bf16_f32 v33, v34, v35
    v_cvt_pk_bf16_f32 v34, v36, v37
    v_cvt_pk_bf16_f32 v35, v38, v39
    v_cvt_pk_bf16_f32 v64, v64, v65
    v_cvt_pk_bf16_f32 v65, v66, v67
    v_cvt_pk_bf16_f32 v66, v68, v69
    v_cvt_pk_bf16_f32 v67, v70, v71
    s_nop 1
    v_permlane16_swap_b32 v32, v34
    v_permlane16_swap_b32 v33, v35
    v_permlane16_swap_b32 v64, v66
    v_permlane16_swap_b32 v65, v67
    buffer_store_dwordx4 v[32:35], v12, s[24:27], s41 offen offset:0 sc1
    buffer_store_dwordx4 v[64:67], v12, s[24:27], s41 offen offset:64 sc1
    s_add_u32 s41, s41, s42
    v_cvt_pk_bf16_f32 v40, v40, v41
    v_cvt_pk_bf16_f32 v41, v42, v43
    v_cvt_pk_bf16_f32 v42, v44, v45
    v_cvt_pk_bf16_f32 v43, v46, v47
    v_cvt_pk_bf16_f32 v72, v72, v73
    v_cvt_pk_bf16_f32 v73, v74, v75
    v_cvt_pk_bf16_f32 v74, v76, v77
    v_cvt_pk_bf16_f32 v75, v78, v79
    s_nop 1
    v_permlane16_swap_b32 v40, v42
    v_permlane16_swap_b32 v41, v43
    v_permlane16_swap_b32 v72, v74
    v_permlane16_swap_b32 v73, v75
    buffer_store_dwordx4 v[40:43], v12, s[24:27], s41 offen offset:0 sc1
    buffer_store_dwordx4 v[72:75], v12, s[24:27], s41 offen offset:64 sc1
    s_add_u32 s41, s41, s42
    v_cvt_pk_bf16_f32 v48, v48, v49
    v_cvt_pk_bf16_f32 v49, v50, v51
    v_cvt_pk_bf16_f32 v50, v52, v53
    v_cvt_pk_bf16_f32 v51, v54, v55
    v_cvt_pk_bf16_f32 v80, v80, v81
    v_cvt_pk_bf16_f32 v81, v82, v83
    v_cvt_pk_bf16_f32 v82, v84, v85
    v_cvt_pk_bf16_f32 v83, v86, v87
    s_nop 1
    v_permlane16_swap_b32 v48, v50
    v_permlane16_swap_b32 v49, v51
    v_permlane16_swap_b32 v80, v82
    v_permlane16_swap_b32 v81, v83
    buffer_store_dwordx4 v[48:51], v12, s[24:27], s41 offen offset:0 sc1
    buffer_store_dwordx4 v[80:83], v12, s[24:27], s41 offen offset:64 sc1
    s_add_u32 s41, s41, s42
    v_cvt_pk_bf16_f32 v56, v56, v57
    v_cvt_pk_bf16_f32 v57, v58, v59
    v_cvt_pk_bf16_f32 v58, v60, v61
    v_cvt_pk_bf16_f32 v59, v62, v63
    v_cvt_pk_bf16_f32 v88, v88, v89
    v_cvt_pk_bf16_f32 v89, v90, v91
    v_cvt_pk_bf16_f32 v90, v92, v93
    v_cvt_pk_bf16_f32 v91, v94, v95
    s_nop 1
    v_permlane16_swap_b32 v56, v58
    v_permlane16_swap_b32 v57, v59
    v_permlane16_swap_b32 v88, v90
    v_permlane16_swap_b32 v89, v91
    buffer_store_dwordx4 v[56:59], v12, s[24:27], s41 offen offset:0 sc1
    buffer_store_dwordx4 v[88:91], v12, s[24:27], s41 offen offset:64 sc1
    s_add_u32 s41, s41, s42
gemm3_kernel_end1:
    s_endpgm
gemm3_kernel_ev4:
    s_cmp_lg_u32 s58, 16
    s_cbranch_scc1 gemm3_kernel_n8
    s_lshl_b32 s48, s39, 7
    s_add_u32 s48, s48, 117506048
    buffer_load_dword v14, off, s[28:31], s48 sc1
    s_mov_b32 s57, 1
    s_mov_b32 s58, 17
    s_branch gemm3_kernel_back5
gemm3_kernel_n8:
    s_cmp_lg_u32 s58, 17
    s_cbranch_scc1 gemm3_kernel_n9
    s_waitcnt vmcnt(0)
    s_mov_b32 s3, 1048576
gemm3_kernel_spin10:
    v_readfirstlane_b32 s49, v14
    s_nop 3
    s_cmp_lg_u32 s49, 0
    s_cbranch_scc1 gemm3_kernel_ok11
    s_sub_u32 s3, s3, 1
    s_cbranch_scc1 gemm3_kernel_ok11
    s_sleep 8
    s_lshl_b32 s48, s39, 7
    s_add_u32 s48, s48, 117506048
    buffer_load_dword v14, off, s[28:31], s48 sc1
    s_waitcnt vmcnt(0)
    s_branch gemm3_kernel_spin10
gemm3_kernel_ok11:
    s_lshl_b32 s48, s39, 16
    s_lshl_b32 s49, s32, 14
    s_add_u32 s48, s48, s49
    s_add_u32 s48, s48, 100663296
    buffer_load_dwordx4 v[160:163], v7, s[28:31], s48 offen offset:0 sc1
    buffer_load_dwordx4 v[164:167], v7, s[28:31], s48 offen offset:1024 sc1
    buffer_load_dwordx4 v[168:171], v7, s[28:31], s48 offen offset:2048 sc1
    buffer_load_dwordx4 v[172:175], v7, s[28:31], s48 offen offset:3072 sc1
    s_add_u32 s48, s48, 4096
    buffer_load_dwordx4 v[176:179], v7, s[28:31], s48 offen offset:0 sc1
    buffer_load_dwordx4 v[180:183], v7, s[28:31], s48 offen offset:1024 sc1
    buffer_load_dwordx4 v[184:187], v7, s[28:31], s48 offen offset:2048 sc1
    buffer_load_dwordx4 v[188:191], v7, s[28:31], s48 offen offset:3072 sc1
    s_add_u32 s48, s48, 4096
    s_mov_b32 s57, 1000
    s_mov_b32 s58, 18
    s_branch gemm3_kernel_back5
gemm3_kernel_n9:
    s_cmp_lg_u32 s58, 0
    s_cbranch_scc1 gemm3_kernel_n12
    s_lshl_b32 s48, s39, 16
    s_lshl_b32 s49, s32, 14
    s_add_u32 s48, s48, s49
    s_add_u32 s48, s48, 100663296
    s_mov_b32 s59, s48
    s_nop 3
    v_cvt_pk_bf16_f32 v160, v32, v33
    v_cvt_pk_bf16_f32 v161, v34, v35
    v_cvt_pk_bf16_f32 v162, v36, v37
    v_cvt_pk_bf16_f32 v163, v38, v39
    v_cvt_pk_bf16_f32 v164, v40, v41
    v_cvt_pk_bf16_f32 v165, v42, v43
    v_cvt_pk_bf16_f32 v166, v44, v45
    v_cvt_pk_bf16_f32 v167, v46, v47
    v_cvt_pk_bf16_f32 v168, v48, v49
    v_cvt_pk_bf16_f32 v169, v50, v51
    v_cvt_pk_bf16_f32 v170, v52, v53
    v_cvt_pk_bf16_f32 v171, v54, v55
    v_cvt_pk_bf16_f32 v172, v56, v57
    v_cvt_pk_bf16_f32 v173, v58, v59
    v_cvt_pk_bf16_f32 v174, v60, v61
    v_cvt_pk_bf16_f32 v175, v62, v63
    v_cvt_pk_bf16_f32 v176, v64, v65
    v_cvt_pk_bf16_f32 v177, v66, v67
    v_cvt_pk_bf16_f32 v178, v68, v69
    v_cvt_pk_bf16_f32 v179, v70, v71
    v_cvt_pk_bf16_f32 v180, v72, v73
    v_cvt_pk_bf16_f32 v181, v74, v75
    v_cvt_pk_bf16_f32 v182, v76, v77
    v_cvt_pk_bf16_f32 v183, v78, v79
    v_cvt_pk_bf16_f32 v184, v80, v81
    v_cvt_pk_bf16_f32 v185, v82, v83
    v_cvt_pk_bf16_f32 v186, v84, v85
    v_cvt_pk_bf16_f32 v187, v86, v87
    v_cvt_pk_bf16_f32 v188, v88, v89
    v_cvt_pk_bf16_f32 v189, v90, v91
    v_cvt_pk_bf16_f32 v190, v92, v93
    v_cvt_pk_bf16_f32 v191, v94, v95
    v_mov_b64 v[32:33], 0
    v_mov_b64 v[34:35], 0
    v_mov_b64 v[36:37], 0
    v_mov_b64 v[38:39], 0
    v_mov_b64 v[40:41], 0
    v_mov_b64 v[42:43], 0
    v_mov_b64 v[44:45], 0
    v_mov_b64 v[46:47], 0
    v_mov_b64 v[48:49], 0
    v_mov_b64 v[50:51], 0
    v_mov_b64 v[52:53], 0
    v_mov_b64 v[54:55], 0
    v_mov_b64 v[56:57], 0
    v_mov_b64 v[58:59], 0
    v_mov_b64 v[60:61], 0
    v_mov_b64 v[62:63], 0
    v_mov_b64 v[64:65], 0
    v_mov_b64 v[66:67], 0
    v_mov_b64 v[68:69], 0
    v_mov_b64 v[70:71], 0
    v_mov_b64 v[72:73], 0
    v_mov_b64 v[74:75], 0
    v_mov_b64 v[76:77], 0
    v_mov_b64 v[78:79], 0
    v_mov_b64 v[80:81], 0
    v_mov_b64 v[82:83], 0
    v_mov_b64 v[84:85], 0
    v_mov_b64 v[86:87], 0
    v_mov_b64 v[88:89], 0
    v_mov_b64 v[90:91], 0
    v_mov_b64 v[92:93], 0
    v_mov_b64 v[94:95], 0
    s_nop 1
    s_waitcnt lgkmcnt(9)
    v_mfma_f32_16x16x32_bf16 v[32:35], v[112:115], v[96:99], v[32:35]
    ds_read_b128 v[128:131], v2 offset:8192
    s_waitcnt lgkmcnt(9)
    v_mfma_f32_16x16x32_bf16 v[40:43], v[112:115], v[100:103], v[40:43]
    ds_read_b64_tr_b16 v[144:145], v3 offset:8192
    s_waitcnt lgkmcnt(9)
    v_mfma_f32_16x16x32_bf16 v[48:51], v[112:115], v[104:107], v[48:51]
    ds_read_b64_tr_b16 v[146:147], v3 offset:12288
    s_waitcnt lgkmcnt(9)
    v_mfma_f32_16x16x32_bf16 v[56:59], v[112:115], v[108:111], v[56:59]
    ds_read_b128 v[132:135], v2 offset:9216
    s_waitcnt lgkmcnt(8)
    v_mfma_f32_16x16x32_bf16 v[36:39], v[116:119], v[96:99], v[36:39]
    ds_read_b128 v[136:139], v2 offset:10240
    v_mfma_f32_16x16x32_bf16 v[44:47], v[116:119], v[100:103], v[44:47]
    ds_read_b128 v[140:143], v2 offset:11264
    v_mfma_f32_16x16x32_bf16 v[52:55], v[116:119], v[104:107], v[52:55]
    ds_read_b64_tr_b16 v[148:149], v4 offset:8192
    v_mfma_f32_16x16x32_bf16 v[60:63], v[116:119], v[108:111], v[60:63]
    ds_read_b64_tr_b16 v[150:151], v4 offset:12288
    s_waitcnt lgkmcnt(10)
    v_mfma_f32_16x16x32_bf16 v[64:67], v[120:123], v[96:99], v[64:67]
    s_add_u32 s43, s43, 32768
    ds_read_b64_tr_b16 v[152:153], v5 offset:8192
    v_mfma_f32_16x16x32_bf16 v[72:75], v[120:123], v[100:103], v[72:75]
    s_cmp_ge_u32 s43, 163840
    ds_read_b64_tr_b16 v[154:155], v5 offset:12288
    v_mfma_f32_16x16x32_bf16 v[80:83], v[120:123], v[104:107], v[80:83]
    s_cselect_b32 s46, 4294836224, s56
    ds_read_b64_tr_b16 v[156:157], v6 offset:8192
    v_mfma_f32_16x16x32_bf16 v[88:91], v[120:123], v[108:111], v[88:91]
    s_cselect_b32 s43, 0, s43
    ds_read_b64_tr_b16 v[158:159], v6 offset:12288
    s_waitcnt lgkmcnt(12)
    v_mfma_f32_16x16x32_bf16 v[68:71], v[124:127], v[96:99], v[68:71]
    v_add_u32 v2, s46, v2
    v_add_u32 v3, s46, v3
    v_mfma_f32_16x16x32_bf16 v[76:79], v[124:127], v[100:103], v[76:79]
    v_add_u32 v4, s46, v4
    v_add_u32 v5, s46, v5
    v_mfma_f32_16x16x32_bf16 v[84:87], v[124:127], v[104:107], v[84:87]
    v_add_u32 v6, s46, v6
    v_mfma_f32_16x16x32_bf16 v[92:95], v[124:127], v[108:111], v[92:95]
    buffer_store_dwordx4 v[160:163], v7, s[28:31], s59 offen offset:0 sc1
    s_waitcnt lgkmcnt(0)
    v_mfma_f32_16x16x32_bf16 v[32:35], v[144:147], v[128:131], v[32:35]
    s_barrier
    v_mfma_f32_16x16x32_bf16 v[40:43], v[144:147], v[132:135], v[40:43]
    ds_read_b128 v[96:99], v2 offset:0
    v_mfma_f32_16x16x32_bf16 v[48:51], v[144:147], v[136:139], v[48:51]
    ds_read_b64_tr_b16 v[112:113], v3 offset:0
    v_mfma_f32_16x16x32_bf16 v[56:59], v[144:147], v[140:143], v[56:59]
    ds_read_b64_tr_b16 v[114:115], v3 offset:4096
    v_mfma_f32_16x16x32_bf16 v[36:39], v[148:151], v[128:131], v[36:39]
    ds_read_b128 v[100:103], v2 offset:1024
    v_mfma_f32_16x16x32_bf16 v[44:47], v[148:151], v[132:135], v[44:47]
    ds_read_b128 v[104:107], v2 offset:2048
    v_mfma_f32_16x16x32_bf16 v[52:55], v[148:151], v[136:139], v[52:55]
    ds_read_b128 v[108:111], v2 offset:3072
    v_mfma_f32_16x16x32_bf16 v[60:63], v[148:151], v[140:143], v[60:63]
    ds_read_b64_tr_b16 v[116:117], v4 offset:0
    v_mfma_f32_16x16x32_bf16 v[64:67], v[152:155], v[128:131], v[64:67]
    ds_read_b64_tr_b16 v[118:119], v4 offset:4096
    v_mfma_f32_16x16x32_bf16 v[72:75], v[152:155], v[132:135], v[72:75]
    ds_read_b64_tr_b16 v[120:121], v5 offset:0
    v_mfma_f32_16x16x32_bf16 v[80:83], v[152:155], v[136:139], v[80:83]
    ds_read_b64_tr_b16 v[122:123], v5 offset:4096
    v_mfma_f32_16x16x32_bf16 v[88:91], v[152:155], v[140:143], v[88:91]
    ds_read_b64_tr_b16 v[124:125], v6 offset:0
    v_mfma_f32_16x16x32_bf16 v[68:71], v[156:159], v[128:131], v[68:71]
    ds_read_b64_tr_b16 v[126:127], v6 offset:4096
    v_mfma_f32_16x16x32_bf16 v[76:79], v[156:159], v[132:135], v[76:79]
    buffer_store_dwordx4 v[164:167], v7, s[28:31], s59 offen offset:1024 sc1
    v_mfma_f32_16x16x32_bf16 v[84:87], v[156:159], v[136:139], v[84:87]
    s_sub_u32 s47, s47, 1
    v_mfma_f32_16x16x32_bf16 v[92:95], v[156:159], v[140:143], v[92:95]
    s_waitcnt lgkmcnt(9)
    v_mfma_f32_16x16x32_bf16 v[32:35], v[112:115], v[96:99], v[32:35]
    ds_read_b128 v[128:131], v2 offset:8192
    s_waitcnt lgkmcnt(9)
    v_mfma_f32_16x16x32_bf16 v[40:43], v[112:115], v[100:103], v[40:43]
    ds_read_b64_tr_b16 v[144:145], v3 offset:8192
    s_waitcnt lgkmcnt(9)
    v_mfma_f32_16x16x32_bf16 v[48:51], v[112:115], v[104:107], v[48:51]
    ds_read_b64_tr_b16 v[146:147], v3 offset:12288
    s_waitcnt lgkmcnt(9)
    v_mfma_f32_16x16x32_bf16 v[56:59], v[112:115], v[108:111], v[56:59]
    ds_read_b128 v[132:135], v2 offset:9216
    s_waitcnt lgkmcnt(8)
    v_mfma_f32_16x16x32_bf16 v[36:39], v[116:119], v[96:99], v[36:39]
    ds_read_b128 v[136:139], v2 offset:10240
    v_mfma_f32_16x16x32_bf16 v[44:47], v[116:119], v[100:103], v[44:47]
    ds_read_b128 v[140:143], v2 offset:11264
    v_mfma_f32_16x16x32_bf16 v[52:55], v[116:119], v[104:107], v[52:55]
    ds_read_b64_tr_b16 v[148:149], v4 offset:8192
    v_mfma_f32_16x16x32_bf16 v[60:63], v[116:119], v[108:111], v[60:63]
    ds_read_b64_tr_b16 v[150:151], v4 offset:12288
    s_waitcnt lgkmcnt(10)
    v_mfma_f32_16x16x32_bf16 v[64:67], v[120:123], v[96:99], v[64:67]
    s_add_u32 s43, s43, 32768
    ds_read_b64_tr_b16 v[152:153], v5 offset:8192
    v_mfma_f32_16x16x32_bf16 v[72:75], v[120:123], v[100:103], v[72:75]
    s_cmp_ge_u32 s43, 163840
    ds_read_b64_tr_b16 v[154:155], v5 offset:12288
    v_mfma_f32_16x16x32_bf16 v[80:83], v[120:123], v[104:107], v[80:83]
    s_cselect_b32 s46, 4294836224, s56
    ds_read_b64_tr_b16 v[156:157], v6 offset:8192
    v_mfma_f32_16x16x32_bf16 v[88:91], v[120:123], v[108:111], v[88:91]
    s_cselect_b32 s43, 0, s43
    ds_read_b64_tr_b16 v[158:159], v6 offset:12288
    s_waitcnt lgkmcnt(12)
    v_mfma_f32_16x16x32_bf16 v[68:71], v[124:127], v[96:99], v[68:71]
    v_add_u32 v2, s46, v2
    v_add_u32 v3, s46, v3
    v_mfma_f32_16x16x32_bf16 v[76:79], v[124:127], v[100:103], v[76:79]
    v_add_u32 v4, s46, v4
    v_add_u32 v5, s46, v5
    v_mfma_f32_16x16x32_bf16 v[84:87], v[124:127], v[104:107], v[84:87]
    v_add_u32 v6, s46, v6
    v_mfma_f32_16x16x32_bf16 v[92:95], v[124:127], v[108:111], v[92:95]
    buffer_store_dwordx4 v[168:171], v7, s[28:31], s59 offen offset:2048 sc1
    s_waitcnt lgkmcnt(0)
    v_mfma_f32_16x16x32_bf16 v[32:35], v[144:147], v[128:131], v[32:35]
    s_barrier
    v_mfma_f32_16x16x32_bf16 v[40:43], v[144:147], v[132:135], v[40:43]
    ds_read_b128 v[96:99], v2 offset:0
    v_mfma_f32_16x16x32_bf16 v[48:51], v[144:147], v[136:139], v[48:51]
    ds_read_b64_tr_b16 v[112:113], v3 offset:0
    v_mfma_f32_16x16x32_bf16 v[56:59], v[144:147], v[140:143], v[56:59]
    ds_read_b64_tr_b16 v[114:115], v3 offset:4096
    v_mfma_f32_16x16x32_bf16 v[36:39], v[148:151], v[128:131], v[36:39]
    ds_read_b128 v[100:103], v2 offset:1024
    v_mfma_f32_16x16x32_bf16 v[44:47], v[148:151], v[132:135], v[44:47]
    ds_read_b128 v[104:107], v2 offset:2048
    v_mfma_f32_16x16x32_bf16 v[52:55], v[148:151], v[136:139], v[52:55]
    ds_read_b128 v[108:111], v2 offset:3072
    v_mfma_f32_16x16x32_bf16 v[60:63], v[148:151], v[140:143], v[60:63]
    ds_read_b64_tr_b16 v[116:117], v4 offset:0
    v_mfma_f32_16x16x32_bf16 v[64:67], v[152:155], v[128:131], v[64:67]
    ds_read_b64_tr_b16 v[118:119], v4 offset:4096
    v_mfma_f32_16x16x32_bf16 v[72:75], v[152:155], v[132:135], v[72:75]
    ds_read_b64_tr_b16 v[120:121], v5 offset:0
    v_mfma_f32_16x16x32_bf16 v[80:83], v[152:155], v[136:139], v[80:83]
    ds_read_b64_tr_b16 v[122:123], v5 offset:4096
    v_mfma_f32_16x16x32_bf16 v[88:91], v[152:155], v[140:143], v[88:91]
    ds_read_b64_tr_b16 v[124:125], v6 offset:0
    v_mfma_f32_16x16x32_bf16 v[68:71], v[156:159], v[128:131], v[68:71]
    ds_read_b64_tr_b16 v[126:127], v6 offset:4096
    v_mfma_f32_16x16x32_bf16 v[76:79], v[156:159], v[132:135], v[76:79]
    buffer_store_dwordx4 v[172:175], v7, s[28:31], s59 offen offset:3072 sc1
    s_add_u32 s59, s59, 4096
    v_mfma_f32_16x16x32_bf16 v[84:87], v[156:159], v[136:139], v[84:87]
    s_sub_u32 s47, s47, 1
    v_mfma_f32_16x16x32_bf16 v[92:95], v[156:159], v[140:143], v[92:95]
    s_waitcnt lgkmcnt(9)
    v_mfma_f32_16x16x32_bf16 v[32:35], v[112:115], v[96:99], v[32:35]
    ds_read_b128 v[128:131], v2 offset:8192
    s_waitcnt lgkmcnt(9)
    v_mfma_f32_16x16x32_bf16 v[40:43], v[112:115], v[100:103], v[40:43]
    ds_read_b64_tr_b16 v[144:145], v3 offset:8192
    s_waitcnt lgkmcnt(9)
    v_mfma_f32_16x16x32_bf16 v[48:51], v[112:115], v[104:107], v[48:51]
    ds_read_b64_tr_b16 v[146:147], v3 offset:12288
    s_waitcnt lgkmcnt(9)
    v_mfma_f32_16x16x32_bf16 v[56:59], v[112:115], v[108:111], v[56:59]
    ds_read_b128 v[132:135], v2 offset:9216
    s_waitcnt lgkmcnt(8)
    v_mfma_f32_16x16x32_bf16 v[36:39], v[116:119], v[96:99], v[36:39]
    ds_read_b128 v[136:139], v2 offset:10240
    v_mfma_f32_16x16x32_bf16 v[44:47], v[116:119], v[100:103], v[44:47]
    ds_read_b128 v[140:143], v2 offset:11264
    v_mfma_f32_16x16x32_bf16 v[52:55], v[116:119], v[104:107], v[52:55]
    ds_read_b64_tr_b16 v[148:149], v4 offset:8192
    v_mfma_f32_16x16x32_bf16 v[60:63], v[116:119], v[108:111], v[60:63]
    ds_read_b64_tr_b16 v[150:151], v4 offset:12288
    s_waitcnt lgkmcnt(10)
    v_mfma_f32_16x16x32_bf16 v[64:67], v[120:123], v[96:99], v[64:67]
    s_add_u32 s43, s43, 32768
    ds_read_b64_tr_b16 v[152:153], v5 offset:8192
    v_mfma_f32_16x16x32_bf16 v[72:75], v[120:123], v[100:103], v[72:75]
    s_cmp_ge_u32 s43, 163840
    ds_read_b64_tr_b16 v[154:155], v5 offset:12288
    v_mfma_f32_16x16x32_bf16 v[80:83], v[120:123], v[104:107], v[80:83]
    s_cselect_b32 s46, 4294836224, s56
    ds_read_b64_tr_b16 v[156:157], v6 offset:8192
    v_mfma_f32_16x16x32_bf16 v[88:91], v[120:123], v[108:111], v[88:91]
    s_cselect_b32 s43, 0, s43
    ds_read_b64_tr_b16 v[158:159], v6 offset:12288
    s_waitcnt lgkmcnt(12)
    v_mfma_f32_16x16x32_bf16 v[68:71], v[124:127], v[96:99], v[68:71]
    v_add_u32 v2, s46, v2
    v_add_u32 v3, s46, v3
    v_mfma_f32_16x16x32_bf16 v[76:79], v[124:127], v[100:103], v[76:79]
    v_add_u32 v4, s46, v4
    v_add_u32 v5, s46, v5
    v_mfma_f32_16x16x32_bf16 v[84:87], v[124:127], v[104:107], v[84:87]
    v_add_u32 v6, s46, v6
    v_mfma_f32_16x16x32_bf16 v[92:95], v[124:127], v[108:111], v[92:95]
    buffer_store_dwordx4 v[176:179], v7, s[28:31], s59 offen offset:0 sc1
    s_waitcnt lgkmcnt(0)
    v_mfma_f32_16x16x32_bf16 v[32:35], v[144:147], v[128:131], v[32:35]
    s_barrier
    v_mfma_f32_16x16x32_bf16 v[40:43], v[144:147], v[132:135], v[40:43]
    ds_read_b128 v[96:99], v2 offset:0
    v_mfma_f32_16x16x32_bf16 v[48:51], v[144:147], v[136:139], v[48:51]
    ds_read_b64_tr_b16 v[112:113], v3 offset:0
    v_mfma_f32_16x16x32_bf16 v[56:59], v[144:147], v[140:143], v[56:59]
    ds_read_b64_tr_b16 v[114:115], v3 offset:4096
    v_mfma_f32_16x16x32_bf16 v[36:39], v[148:151], v[128:131], v[36:39]
    ds_read_b128 v[100:103], v2 offset:1024
    v_mfma_f32_16x16x32_bf16 v[44:47], v[148:151], v[132:135], v[44:47]
    ds_read_b128 v[104:107], v2 offset:2048
    v_mfma_f32_16x16x32_bf16 v[52:55], v[148:151], v[136:139], v[52:55]
    ds_read_b128 v[108:111], v2 offset:3072
    v_mfma_f32_16x16x32_bf16 v[60:63], v[148:151], v[140:143], v[60:63]
    ds_read_b64_tr_b16 v[116:117], v4 offset:0
    v_mfma_f32_16x16x32_bf16 v[64:67], v[152:155], v[128:131], v[64:67]
    ds_read_b64_tr_b16 v[118:119], v4 offset:4096
    v_mfma_f32_16x16x32_bf16 v[72:75], v[152:155], v[132:135], v[72:75]
    ds_read_b64_tr_b16 v[120:121], v5 offset:0
    v_mfma_f32_16x16x32_bf16 v[80:83], v[152:155], v[136:139], v[80:83]
    ds_read_b64_tr_b16 v[122:123], v5 offset:4096
    v_mfma_f32_16x16x32_bf16 v[88:91], v[152:155], v[140:143], v[88:91]
    ds_read_b64_tr_b16 v[124:125], v6 offset:0
    v_mfma_f32_16x16x32_bf16 v[68:71], v[156:159], v[128:131], v[68:71]
    ds_read_b64_tr_b16 v[126:127], v6 offset:4096
    v_mfma_f32_16x16x32_bf16 v[76:79], v[156:159], v[132:135], v[76:79]
    buffer_store_dwordx4 v[180:183], v7, s[28:31], s59 offen offset:1024 sc1
    v_mfma_f32_16x16x32_bf16 v[84:87], v[156:159], v[136:139], v[84:87]
    s_sub_u32 s47, s47, 1
    v_mfma_f32_16x16x32_bf16 v[92:95], v[156:159], v[140:143], v[92:95]
    s_waitcnt lgkmcnt(9)
    v_mfma_f32_16x16x32_bf16 v[32:35], v[112:115], v[96:99], v[32:35]
    ds_read_b128 v[128:131], v2 offset:8192
    s_waitcnt lgkmcnt(9)
    v_mfma_f32_16x16x32_bf16 v[40:43], v[112:115], v[100:103], v[40:43]
    ds_read_b64_tr_b16 v[144:145], v3 offset:8192
    s_waitcnt lgkmcnt(9)
    v_mfma_f32_16x16x32_bf16 v[48:51], v[112:115], v[104:107], v[48:51]
    ds_read_b64_tr_b16 v[146:147], v3 offset:12288
    s_waitcnt lgkmcnt(9)
    v_mfma_f32_16x16x32_bf16 v[56:59], v[112:115], v[108:111], v[56:59]
    ds_read_b128 v[132:135], v2 offset:9216
    s_waitcnt lgkmcnt(8)
    v_mfma_f32_16x16x32_bf16 v[36:39], v[116:119], v[96:99], v[36:39]
    ds_read_b128 v[136:139], v2 offset:10240
    v_mfma_f32_16x16x32_bf16 v[44:47], v[116:119], v[100:103], v[44:47]
    ds_read_b128 v[140:143], v2 offset:11264
    v_mfma_f32_16x16x32_bf16 v[52:55], v[116:119], v[104:107], v[52:55]
    ds_read_b64_tr_b16 v[148:149], v4 offset:8192
    v_mfma_f32_16x16x32_bf16 v[60:63], v[116:119], v[108:111], v[60:63]
    ds_read_b64_tr_b16 v[150:151], v4 offset:12288
    s_waitcnt lgkmcnt(10)
    v_mfma_f32_16x16x32_bf16 v[64:67], v[120:123], v[96:99], v[64:67]
    s_add_u32 s43, s43, 32768
    ds_read_b64_tr_b16 v[152:153], v5 offset:8192
    v_mfma_f32_16x16x32_bf16 v[72:75], v[120:123], v[100:103], v[72:75]
    s_cmp_ge_u32 s43, 163840
    ds_read_b64_tr_b16 v[154:155], v5 offset:12288
    v_mfma_f32_16x16x32_bf16 v[80:83], v[120:123], v[104:107], v[80:83]
    s_cselect_b32 s46, 4294836224, s56
    ds_read_b64_tr_b16 v[156:157], v6 offset:8192
    v_mfma_f32_16x16x32_bf16 v[88:91], v[120:123], v[108:111], v[88:91]
    s_cselect_b32 s43, 0, s43
    ds_read_b64_tr_b16 v[158:159], v6 offset:12288
    s_waitcnt lgkmcnt(12)
    v_mfma_f32_16x16x32_bf16 v[68:71], v[124:127], v[96:99], v[68:71]
    v_add_u32 v2, s46, v2
    v_add_u32 v3, s46, v3
    v_mfma_f32_16x16x32_bf16 v[76:79], v[124:127], v[100:103], v[76:79]
    v_add_u32 v4, s46, v4
    v_add_u32 v5, s46, v5
    v_mfma_f32_16x16x32_bf16 v[84:87], v[124:127], v[104:107], v[84:87]
    v_add_u32 v6, s46, v6
    v_mfma_f32_16x16x32_bf16 v[92:95], v[124:127], v[108:111], v[92:95]
    buffer_store_dwordx4 v[184:187], v7, s[28:31], s59 offen offset:2048 sc1
    s_waitcnt lgkmcnt(0)
    v_mfma_f32_16x16x32_bf16 v[32:35], v[144:147], v[128:131], v[32:35]
    s_barrier
    v_mfma_f32_16x16x32_bf16 v[40:43], v[144:147], v[132:135], v[40:43]
    ds_read_b128 v[96:99], v2 offset:0
    v_mfma_f32_16x16x32_bf16 v[48:51], v[144:147], v[136:139], v[48:51]
    ds_read_b64_tr_b16 v[112:113], v3 offset:0
    v_mfma_f32_16x16x32_bf16 v[56:59], v[144:147], v[140:143], v[56:59]
    ds_read_b64_tr_b16 v[114:115], v3 offset:4096
    v_mfma_f32_16x16x32_bf16 v[36:39], v[148:151], v[128:131], v[36:39]
    ds_read_b128 v[100:103], v2 offset:1024
    v_mfma_f32_16x16x32_bf16 v[44:47], v[148:151], v[132:135], v[44:47]
    ds_read_b128 v[104:107], v2 offset:2048
    v_mfma_f32_16x16x32_bf16 v[52:55], v[148:151], v[136:139], v[52:55]
    ds_read_b128 v[108:111], v2 offset:3072
    v_mfma_f32_16x16x32_bf16 v[60:63], v[148:151], v[140:143], v[60:63]
    ds_read_b64_tr_b16 v[116:117], v4 offset:0
    v_mfma_f32_16x16x32_bf16 v[64:67], v[152:155], v[128:131], v[64:67]
    ds_read_b64_tr_b16 v[118:119], v4 offset:4096
    v_mfma_f32_16x16x32_bf16 v[72:75], v[152:155], v[132:135], v[72:75]
    ds_read_b64_tr_b16 v[120:121], v5 offset:0
    v_mfma_f32_16x16x32_bf16 v[80:83], v[152:155], v[136:139], v[80:83]
    ds_read_b64_tr_b16 v[122:123], v5 offset:4096
    v_mfma_f32_16x16x32_bf16 v[88:91], v[152:155], v[140:143], v[88:91]
    ds_read_b64_tr_b16 v[124:125], v6 offset:0
    v_mfma_f32_16x16x32_bf16 v[68:71], v[156:159], v[128:131], v[68:71]
    ds_read_b64_tr_b16 v[126:127], v6 offset:4096
    v_mfma_f32_16x16x32_bf16 v[76:79], v[156:159], v[132:135], v[76:79]
    buffer_store_dwordx4 v[188:191], v7, s[28:31], s59 offen offset:3072 sc1
    s_add_u32 s59, s59, 4096
    v_mfma_f32_16x16x32_bf16 v[84:87], v[156:159], v[136:139], v[84:87]
    s_sub_u32 s47, s47, 1
    v_mfma_f32_16x16x32_bf16 v[92:95], v[156:159], v[140:143], v[92:95]
    s_mov_b32 s57, 0
    s_mov_b32 s58, 1
    s_branch gemm3_kernel_back5
gemm3_kernel_n12:
    s_cmp_lg_u32 s58, 1
    s_cbranch_scc1 gemm3_kernel_n13
    s_waitcnt vmcnt(0)
    s_mov_b32 s57, 0
    s_mov_b32 s58, 2
    s_branch gemm3_kernel_back5
gemm3_kernel_n13:
    s_cmp_lg_u32 s58, 2
    s_cbranch_scc1 gemm3_kernel_n14
    s_cmp_lg_u32 s32, 0
    s_cbranch_scc1 gemm3_kernel_np15
    s_lshl_b32 s48, s39, 7
    s_add_u32 s48, s48, 117506048
    v_mov_b32 v16, 1
    s_mov_b64 exec, 1
    buffer_store_dword v16, off, s[28:31], s48 sc1
    s_mov_b64 exec, -1
gemm3_kernel_np15:
    s_mov_b32 s57, 1000
    s_mov_b32 s58, 3
    s_branch gemm3_kernel_back5
gemm3_kernel_n14:
    s_mov_b32 s57, 1000
    s_branch gemm3_kernel_back5
gemm3_kernel_load2:
    s_lshl_b32 s45, s32, 12
    s_lshl_b32 s48, s37, 13
    s_lshl_b32 s49, s34, 12
    s_add_u32 s48, s48, s49
    s_lshl_b32 s49, s33, 17
    s_add_u32 s40, s48, s49
    s_mul_i32 s48, s35, 10747904
    s_add_u32 s41, s40, s48
    s_add_u32 s41, s41, 67108864
    s_add_u32 s40, s40, 83886080
    s_mul_i32 s48, s35, 5373952
    s_lshl_b32 s46, s38, 8
    s_add_u32 s42, s46, s48
    v_lshrrev_b32 v16, 4, v1
    s_lshl_b32 s48, s32, 4
    v_add_u32 v17, s48, v16
    v_lshlrev_b32 v17, 11, v17
    v_lshlrev_b32 v16, 1, v16
    v_and_b32 v18, 15, v1
    v_xor_b32 v16, v16, v18
    v_xor_b32 v18, 0, v16
    v_lshl_add_u32 v8, v18, 4, v17
    v_xor_b32 v18, 8, v16
    v_lshl_add_u32 v9, v18, 4, v17
    v_add_u32 v9, 7168, v9
    v_xor_b32 v18, 0, v16
    v_lshl_add_u32 v10, v18, 4, v17
    v_add_u32 v10, 14336, v10
    v_xor_b32 v18, 8, v16
    v_lshl_add_u32 v11, v18, 4, v17
    v_add_u32 v11, 21504, v11
    s_mov_b32 s18, 268435456
    s_mov_b32 s19, 0x20000
    s_mov_b32 s23, 0x20000
    s_mov_b32 s22, 8388608
    s_mov_b32 s44, s45
    s_cmp_eq_u32 s35, 1
    s_cselect_b32 s57, 23, 1000
    s_cselect_b32 s58, 39, 41
    s_add_u32 s56, s45, 163840
    s_waitcnt lgkmcnt(0)
    s_mov_b32 s20, s4
    s_mov_b32 s21, s5
    s_mov_b32 s16, s10
    s_mov_b32 s17, s11
    s_mov_b32 m0, s44
    s_nop 0
    buffer_load_dwordx4 v7, s[16:19], s41 offen offset:0 lds
    buffer_load_dwordx4 v7, s[16:19], s41 offen offset:1024 lds
    buffer_load_dwordx4 v7, s[16:19], s41 offen offset:2048 lds
    buffer_load_dwordx4 v7, s[16:19], s41 offen offset:3072 lds
    s_add_u32 m0, s44, 16384
    s_add_u32 s41, s41, 262144
    buffer_load_dwordx4 v8, s[20:23], s42 offen offset:0 lds
    buffer_load_dwordx4 v9, s[20:23], s42 offen offset:1024 lds
    buffer_load_dwordx4 v10, s[20:23], s42 offen offset:2048 lds
    buffer_load_dwordx4 v11, s[20:23], s42 offen offset:3072 lds
    s_add_u32 s42, s42, 131072
    s_add_u32 s44, s44, 32768
    s_cmp_ge_u32 s44, s56
    s_cselect_b32 s44, s45, s44
    s_mov_b32 m0, s44
    s_nop 0
    buffer_load_dwordx4 v7, s[16:19], s41 offen offset:0 lds
    buffer_load_dwordx4 v7, s[16:19], s41 offen offset:1024 lds
    buffer_load_dwordx4 v7, s[16:19], s41 offen offset:2048 lds
    buffer_load_dwordx4 v7, s[16:19], s41 offen offset:3072 lds
    s_add_u32 m0, s44, 16384
    s_add_u32 s41, s41, 262144
    buffer_load_dwordx4 v8, s[20:23], s42 offen offset:0 lds
    buffer_load_dwordx4 v9, s[20:23], s42 offen offset:1024 lds
    buffer_load_dwordx4 v10, s[20:23], s42 offen offset:2048 lds
    buffer_load_dwordx4 v11, s[20:23], s42 offen offset:3072 lds
    s_add_u32 s42, s42, 131072
    s_add_u32 s44, s44, 32768
    s_cmp_ge_u32 s44, s56
    s_cselect_b32 s44, s45, s44
    s_waitcnt vmcnt(8)
    s_barrier
    s_mov_b32 m0, s44
    s_nop 0
    buffer_load_dwordx4 v7, s[16:19], s41 offen offset:0 lds
    buffer_load_dwordx4 v7, s[16:19], s41 offen offset:1024 lds
    buffer_load_dwordx4 v7, s[16:19], s41 offen offset:2048 lds
    buffer_load_dwordx4 v7, s[16:19], s41 offen offset:3072 lds
    s_add_u32 m0, s44, 16384
    s_add_u32 s41, s41, 262144
    buffer_load_dwordx4 v8, s[20:23], s42 offen offset:0 lds
    buffer_load_dwordx4 v9, s[20:23], s42 offen offset:1024 lds
    buffer_load_dwordx4 v10, s[20:23], s42 offen offset:2048 lds
    buffer_load_dwordx4 v11, s[20:23], s42 offen offset:3072 lds
    s_add_u32 s42, s42, 131072
    s_add_u32 s44, s44, 32768
    s_cmp_ge_u32 s44, s56
    s_cselect_b32 s44, s45, s44
    s_mov_b32 m0, s44
    s_nop 0
    buffer_load_dwordx4 v7, s[16:19], s41 offen offset:0 lds
    buffer_load_dwordx4 v7, s[16:19], s41 offen offset:1024 lds
    buffer_load_dwordx4 v7, s[16:19], s41 offen offset:2048 lds
    buffer_load_dwordx4 v7, s[16:19], s41 offen offset:3072 lds
    s_add_u32 m0, s44, 16384
    s_add_u32 s41, s41, 262144
    buffer_load_dwordx4 v8, s[20:23], s42 offen offset:0 lds
    buffer_load_dwordx4 v9, s[20:23], s42 offen offset:1024 lds
    buffer_load_dwordx4 v10, s[20:23], s42 offen offset:2048 lds
    buffer_load_dwordx4 v11, s[20:23], s42 offen offset:3072 lds
    s_add_u32 s42, s42, 131072
    s_add_u32 s44, s44, 32768
    s_cmp_ge_u32 s44, s56
    s_cselect_b32 s44, s45, s44
    s_mov_b32 m0, s44
    s_nop 0
    buffer_load_dwordx4 v7, s[16:19], s41 offen offset:0 lds
    buffer_load_dwordx4 v7, s[16:19], s41 offen offset:1024 lds
    buffer_load_dwordx4 v7, s[16:19], s41 offen offset:2048 lds
    buffer_load_dwordx4 v7, s[16:19], s41 offen offset:3072 lds
    s_add_u32 m0, s44, 16384
    s_add_u32 s41, s41, 262144
    buffer_load_dwordx4 v8, s[20:23], s42 offen offset:0 lds
    buffer_load_dwordx4 v9, s[20:23], s42 offen offset:1024 lds
    buffer_load_dwordx4 v10, s[20:23], s42 offen offset:2048 lds
    buffer_load_dwordx4 v11, s[20:23], s42 offen offset:3072 lds
    s_add_u32 s42, s42, 131072
    s_add_u32 s44, s44, 32768
    s_cmp_ge_u32 s44, s56
    s_cselect_b32 s44, s45, s44
    s_mov_b32 s47, 5
gemm3_kernel_ll16:
    s_waitcnt vmcnt(24)
    s_barrier
    s_cmp_eq_u32 s47, s57
    s_cselect_b32 s41, s40, s41
    s_cselect_b32 s42, s46, s42
    s_cselect_b32 s20, s12, s20
    s_cselect_b32 s21, s13, s21
    s_cselect_b32 s22, 2097152, s22
    s_mov_b32 m0, s44
    s_nop 0
    buffer_load_dwordx4 v7, s[16:19], s41 offen offset:0 lds
    buffer_load_dwordx4 v7, s[16:19], s41 offen offset:1024 lds
    buffer_load_dwordx4 v7, s[16:19], s41 offen offset:2048 lds
    buffer_load_dwordx4 v7, s[16:19], s41 offen offset:3072 lds
    s_add_u32 m0, s44, 16384
    s_add_u32 s41, s41, 262144
    buffer_load_dwordx4 v8, s[20:23], s42 offen offset:0 lds
    buffer_load_dwordx4 v9, s[20:23], s42 offen offset:1024 lds
    buffer_load_dwordx4 v10, s[20:23], s42 offen offset:2048 lds
    buffer_load_dwordx4 v11, s[20:23], s42 offen offset:3072 lds
    s_add_u32 s42, s42, 131072
    s_add_u32 s44, s44, 32768
    s_cmp_ge_u32 s44, s56
    s_cselect_b32 s44, s45, s44
    s_add_u32 s47, s47, 1
    s_cmp_lt_u32 s47, s58
    s_cbranch_scc1 gemm3_kernel_ll16
    s_waitcnt vmcnt(24)
    s_barrier
    s_waitcnt vmcnt(16)
    s_barrier
    s_waitcnt vmcnt(8)
    s_barrier
    s_waitcnt vmcnt(0)
    s_barrier
    s_endpgm
gemm3_kernel_end:
.section .rodata,"a"
.p2align 6
.amdhsa_kernel mega_kernel
  .amdhsa_next_free_vgpr 512
  .amdhsa_next_free_sgpr 102
  .amdhsa_accum_offset 256
  .amdhsa_group_segment_fixed_size 0
  .amdhsa_kernarg_size 96
  .amdhsa_user_sgpr_count 2
  .amdhsa_user_sgpr_kernarg_segment_ptr 1
  .amdhsa_system_sgpr_workgroup_id_x 1
.end_amdhsa_kernel
.section .rodata,"a"
.p2align 6
.amdhsa_kernel gemm3_kernel
  .amdhsa_next_free_vgpr 224
  .amdhsa_next_free_sgpr 102
  .amdhsa_accum_offset 224
  .amdhsa_group_segment_fixed_size 0
  .amdhsa_kernarg_size 96
  .amdhsa_user_sgpr_count 2
  .amdhsa_user_sgpr_kernarg_segment_ptr 1
  .amdhsa_system_sgpr_workgroup_id_x 1
.end_amdhsa_kernel
```

```asm
; @launch grid=(256,1,1) block=(256,1,1) lds=163840
.amdgcn_target "amdgcn-amd-amdhsa--gfx950"
.text
.globl concat_heads__sliding_local_dilated__compressed_kv_cla__prompt_kernel
.p2align 8
.type concat_heads__sliding_local_dilated__compressed_kv_cla__prompt_kernel,@function
concat_heads__sliding_local_dilated__compressed_kv_cla__prompt_kernel:
    s_cmp_ge_u32 s2, 256
    s_cbranch_scc1 m_end1
    s_load_dwordx16 s[24:39], s[0:1], 0
    s_load_dwordx4 s[4:7], s[0:1], 80
    v_and_b32 v1, 63, v0
    v_lshrrev_b32 v24, 6, v0
    s_nop 0
    v_readfirstlane_b32 s16, v24
    s_lshr_b32 s68, s2, 3
    s_lshr_b32 s57, s16, 1
    s_and_b32 s58, s16, 1
    s_mov_b32 s43, 0x20000
    s_mov_b32 s47, 0x20000
    s_cmp_lt_u32 s68, 29
    s_cbranch_scc1 m_ncp2
    s_sub_u32 s91, s68, 29
    s_lshl_b32 s91, s91, 2
    s_add_u32 s91, s91, s16
    s_getpc_b64 s[8:9]
m_pc3:
    s_sub_u32 s8, s8, m_pc3-concat_heads__sliding_local_dilated__compressed_kv_cla__prompt_kernel
    s_subb_u32 s9, s9, 0
    s_mov_b32 s10, concat_heads__sliding_local_dilated__compressed_kv_cla__prompt_kernel_end-concat_heads__sliding_local_dilated__compressed_kv_cla__prompt_kernel
    s_mov_b32 s11, 0x20000
    s_lshl_b32 s90, s91, 13
    v_lshlrev_b32 v24, 7, v1
    buffer_load_dword v22, v24, s[8:11], s90 offen
m_ncp2:
    v_and_b32 v24, 15, v1
    v_lshrrev_b32 v25, 4, v1
    v_bfe_u32 v26, v1, 1, 3
    v_xor_b32 v26, v26, v25
    s_lshl_b32 s90, s57, 14
    v_lshlrev_b32 v27, 7, v24
    v_add_u32 v27, s90, v27
    v_xor_b32 v28, 0, v26
    v_lshl_add_u32 v6, v28, 4, v27
    v_xor_b32 v28, 4, v26
    v_lshl_add_u32 v7, v28, 4, v27
    v_bfe_u32 v26, v1, 2, 2
    v_lshl_add_u32 v27, v25, 3, v26
    v_lshlrev_b32 v27, 9, v27
    v_and_b32 v28, 3, v1
    v_lshlrev_b32 v28, 3, v28
    v_add_u32 v27, v27, v28
    s_lshl_b32 s90, s58, 8
    s_add_u32 s90, s90, 98304
    v_add_u32 v27, s90, v27
    v_bfe_u32 v26, v1, 2, 3
    v_xor_b32 v28, 0, v26
    v_lshl_add_u32 v8, v28, 5, v27
    v_xor_b32 v28, 1, v26
    v_lshl_add_u32 v9, v28, 5, v27
    v_xor_b32 v28, 2, v26
    v_lshl_add_u32 v10, v28, 5, v27
    v_xor_b32 v28, 3, v26
    v_lshl_add_u32 v11, v28, 5, v27
    v_xor_b32 v28, 4, v26
    v_lshl_add_u32 v12, v28, 5, v27
    v_xor_b32 v28, 5, v26
    v_lshl_add_u32 v13, v28, 5, v27
    v_xor_b32 v28, 6, v26
    v_lshl_add_u32 v14, v28, 5, v27
    v_xor_b32 v28, 7, v26
    v_lshl_add_u32 v15, v28, 5, v27
    v_lshlrev_b32 v2, 4, v1
    s_lshl_b32 s61, s16, 13
    s_add_u32 s62, s61, 98304
    s_mov_b32 s64, 0
    s_mov_b32 s59, 32768
    s_mov_b32 s60, 229376
    s_waitcnt lgkmcnt(0)
    s_mov_b32 s8, s6
    s_mov_b32 s9, s7
    s_mov_b32 s10, 268435456
    s_mov_b32 s11, 0x20000
    s_mov_b32 s70, 0
    s_cmp_ge_u32 s68, 16
    s_cbranch_scc1 m_typea4
    s_and_b32 s69, s68, 3
    s_and_b32 s90, s2, 1
    s_lshl_b32 s90, s90, 2
    s_add_u32 s69, s69, s90
    s_bfe_u32 s90, s2, 0x20001
    s_mul_i32 s90, s90, 4
    s_bfe_u32 s91, s68, 0x20002
    s_add_u32 s90, s90, s91
    s_mov_b32 s76, 8388608
    s_mov_b32 s78, 8192
    s_mov_b32 s81, 0
    s_mov_b32 s73, 4194304
    s_mov_b32 s77, 2048
    s_mov_b32 s82, 16
    s_lshl_b32 s80, s90, 9
    s_lshl_b32 s79, s69, 19
    s_lshl_b32 s88, s90, 4
    s_add_u32 s88, s88, s69
    s_lshl_b32 s88, s88, 3
    s_mov_b32 s83, 0
    s_mov_b32 s84, 1040356334
    s_lshl_b32 s91, s90, 1
    s_add_u32 s91, s91, s58
    s_lshl_b32 s91, s91, 19
    s_lshl_b32 s92, s69, 1
    s_add_u32 s92, s92, s57
    s_lshl_b32 s92, s92, 15
    s_add_u32 s85, s91, s92
    s_add_u32 s85, s85, 0
    s_mov_b32 s86, 1024
    s_mov_b32 s87, 4096
    s_mov_b32 s71, s30
    s_mov_b32 s72, s31
    s_mov_b32 s74, s34
    s_mov_b32 s75, s35
    s_branch m_go15
m_typea4:
    s_cmp_lt_u32 s68, 28
    s_cbranch_scc1 m_nopf6
    s_mov_b32 s70, 1
    s_sub_u32 s93, s2, 224
    s_lshl_b32 s93, s93, 2
    s_add_u32 s93, s93, s16
    v_lshlrev_b32 v24, 7, v1
    v_lshrrev_b32 v25, 3, v1
    v_lshlrev_b32 v25, 11, v25
    v_and_b32 v26, 7, v1
    v_lshl_add_u32 v25, v26, 7, v25
    s_lshl_b32 s92, s93, 13
    s_lshl_b32 s93, s93, 14
    s_add_u32 s93, s93, 1024
    v_lshrrev_b32 v25, 2, v1
    v_lshlrev_b32 v25, 11, v25
    v_and_b32 v26, 3, v1
    v_lshl_add_u32 v25, v26, 7, v25
    s_lshl_b32 s93, s92, 2
    s_mov_b32 s40, s34
    s_mov_b32 s41, s35
    s_mov_b32 s42, 8388608
    s_add_u32 s90, s92, 1048576
    buffer_load_dword v22, v24, s[40:43], s90 offen
    s_add_u32 s90, s92, 2097152
    buffer_load_dword v22, v24, s[40:43], s90 offen
    s_mov_b32 s40, s30
    s_mov_b32 s41, s31
    s_mov_b32 s42, 4194304
    s_add_u32 s90, s93, 512
    buffer_load_dword v22, v25, s[40:43], s90 offen
    s_mov_b32 s40, s34
    s_mov_b32 s41, s35
    s_mov_b32 s42, 8388608
    s_add_u32 s90, s92, 3145728
    buffer_load_dword v22, v24, s[40:43], s90 offen
    s_add_u32 s90, s92, 4194304
    buffer_load_dword v22, v24, s[40:43], s90 offen
    s_mov_b32 s40, s30
    s_mov_b32 s41, s31
    s_mov_b32 s42, 4194304
    s_add_u32 s90, s93, 1024
    buffer_load_dword v22, v25, s[40:43], s90 offen
    s_mov_b32 s40, s34
    s_mov_b32 s41, s35
    s_mov_b32 s42, 8388608
    s_add_u32 s90, s92, 5242880
    buffer_load_dword v22, v24, s[40:43], s90 offen
    s_mov_b32 s40, s26
    s_mov_b32 s41, s27
    s_mov_b32 s42, 6291456
    s_add_u32 s90, s92, 0
    buffer_load_dword v22, v24, s[40:43], s90 offen
    s_mov_b32 s40, s24
    s_mov_b32 s41, s25
    s_mov_b32 s42, 4194304
    s_add_u32 s90, s93, 0
    buffer_load_dword v22, v25, s[40:43], s90 offen
    s_mov_b32 s40, s34
    s_mov_b32 s41, s35
    s_mov_b32 s42, 8388608
    s_add_u32 s90, s92, 6291456
    buffer_load_dword v22, v24, s[40:43], s90 offen
    s_mov_b32 s40, s30
    s_mov_b32 s41, s31
    s_mov_b32 s42, 4194304
    s_add_u32 s90, s93, 1536
    buffer_load_dword v22, v25, s[40:43], s90 offen
    s_mov_b32 s40, s26
    s_mov_b32 s41, s27
    s_mov_b32 s42, 6291456
    s_add_u32 s90, s92, 1048576
    buffer_load_dword v22, v24, s[40:43], s90 offen
    s_mov_b32 s40, s24
    s_mov_b32 s41, s25
    s_mov_b32 s42, 4194304
    s_add_u32 s90, s93, 512
    buffer_load_dword v22, v25, s[40:43], s90 offen
    s_mov_b32 s40, s34
    s_mov_b32 s41, s35
    s_mov_b32 s42, 8388608
    s_add_u32 s90, s92, 7340032
    buffer_load_dword v22, v24, s[40:43], s90 offen
    s_mov_b32 s40, s26
    s_mov_b32 s41, s27
    s_mov_b32 s42, 6291456
    s_add_u32 s90, s92, 2097152
    buffer_load_dword v22, v24, s[40:43], s90 offen
    s_add_u32 s90, s92, 3145728
    buffer_load_dword v22, v24, s[40:43], s90 offen
    s_mov_b32 s40, s24
    s_mov_b32 s41, s25
    s_mov_b32 s42, 4194304
    s_add_u32 s90, s93, 1024
    buffer_load_dword v22, v25, s[40:43], s90 offen
    s_mov_b32 s40, s26
    s_mov_b32 s41, s27
    s_mov_b32 s42, 6291456
    s_add_u32 s90, s92, 4194304
    buffer_load_dword v22, v24, s[40:43], s90 offen
    s_mov_b32 s40, s24
    s_mov_b32 s41, s25
    s_mov_b32 s42, 4194304
    s_add_u32 s90, s93, 1536
    buffer_load_dword v22, v25, s[40:43], s90 offen
    s_mov_b32 s40, s26
    s_mov_b32 s41, s27
    s_mov_b32 s42, 6291456
    s_add_u32 s90, s92, 5242880
    buffer_load_dword v22, v24, s[40:43], s90 offen
    s_mov_b32 s40, s32
    s_mov_b32 s41, s33
    s_mov_b32 s42, 2097152
    s_add_u32 s90, s92, 1048576
    buffer_load_dword v22, v24, s[40:43], s90 offen
m_nopf6:
    s_bfe_u32 s69, s68, 0x20002
    s_add_u32 s69, s69, 0
    s_and_b32 s90, s2, 7
    s_lshl_b32 s90, s90, 2
    s_and_b32 s91, s68, 3
    s_add_u32 s90, s90, s91
    s_cmp_lt_u32 s90, 16
    s_cselect_b32 s83, 0, 1
    s_mov_b32 s91, 33554432
    s_cselect_b32 s85, 16777216, s91
    s_mov_b32 s91, 8192
    s_cselect_b32 s86, 1024, s91
    s_mov_b32 s91, 1024
    s_cselect_b32 s87, 4096, s91
    s_cselect_b32 s74, s36, s38
    s_cselect_b32 s75, s37, s39
    s_mov_b32 s71, s32
    s_mov_b32 s72, s33
    s_mov_b32 s73, 2097152
    s_mov_b32 s77, 1024
    s_mov_b32 s82, 8
    s_mov_b32 s81, 0
    s_mov_b32 s76, 4194304
    s_mov_b32 s78, 8192
    s_mov_b32 s84, 0
    s_and_b32 s90, s90, 15
    s_lshl_b32 s80, s90, 9
    s_lshl_b32 s79, s69, 18
    s_lshl_b32 s91, s83, 2
    s_add_u32 s91, s91, s69
    s_cmp_ge_u32 s69, 4
    s_cselect_b32 s92, 508, 8
    s_add_u32 s91, s91, s92
    s_lshl_b32 s88, s90, 4
    s_add_u32 s88, s88, s91
    s_lshl_b32 s88, s88, 3
    s_lshl_b32 s91, s90, 1
    s_add_u32 s91, s91, s58
    s_lshl_b32 s91, s91, 19
    s_lshl_b32 s92, s69, 1
    s_add_u32 s92, s92, s57
    s_lshl_b32 s92, s92, 15
    s_add_u32 s85, s85, s91
    s_add_u32 s85, s85, s92
m_go15:
    s_mov_b32 s42, s73
    s_mov_b32 s46, s76
    s_lshl_b32 s90, s77, 4
    s_lshl_b32 s90, s90, s81
    s_mov_b32 s48, s79
    s_mul_i32 s91, s90, 1
    s_add_u32 s49, s91, s79
    s_sub_u32 s49, s49, 2048
    s_mul_i32 s91, s90, 2
    s_add_u32 s50, s91, s79
    s_mul_i32 s91, s90, 3
    s_add_u32 s51, s91, s79
    s_sub_u32 s51, s51, 2048
    s_mov_b32 s52, s80
    s_lshl_b32 s90, s78, 2
    s_mul_i32 s91, s90, 1
    s_add_u32 s53, s91, s80
    s_sub_u32 s53, s53, 2048
    s_mul_i32 s91, s90, 2
    s_add_u32 s54, s91, s80
    s_mul_i32 s91, s90, 3
    s_add_u32 s55, s91, s80
    s_sub_u32 s55, s55, 2048
    s_lshl_b32 s56, s78, 6
    s_lshl_b32 s90, s58, 7
    s_add_u32 s90, s90, s57
    s_lshl_b32 s91, s16, 6
    s_cmp_eq_u32 s81, 1
    s_cselect_b32 s90, s90, s91
    v_lshrrev_b32 v24, 3, v1
    v_lshlrev_b32 v24, s81, v24
    v_add_u32 v24, s90, v24
    v_mul_lo_u32 v24, v24, s77
    v_lshrrev_b32 v25, 4, v1
    v_and_b32 v26, 7, v1
    v_xor_b32 v25, v25, v26
    v_lshl_add_u32 v16, v25, 4, v24
    v_xor_b32 v25, 4, v25
    v_lshl_add_u32 v17, v25, 4, v24
    s_lshl_b32 s90, s77, 3
    s_lshl_b32 s90, s90, s81
    s_sub_u32 s90, s90, 1024
    v_add_u32 v17, s90, v17
    v_lshrrev_b32 v24, 5, v1
    s_lshl_b32 s90, s16, 4
    v_add_u32 v25, s90, v24
    v_mul_lo_u32 v25, v25, s78
    v_lshlrev_b32 v24, 1, v24
    v_and_b32 v26, 31, v1
    v_xor_b32 v24, v24, v26
    s_lshl_b32 s90, s78, 1
    s_sub_u32 s90, s90, 1024
    v_add_u32 v27, s90, v25
    v_xor_b32 v26, 0, v24
    v_lshl_add_u32 v18, v26, 4, v25
    v_xor_b32 v26, 4, v24
    v_lshl_add_u32 v19, v26, 4, v27
    v_xor_b32 v26, 8, v24
    v_lshl_add_u32 v20, v26, 4, v25
    v_xor_b32 v26, 12, v24
    v_lshl_add_u32 v21, v26, 4, v27
    s_mov_b32 s40, s71
    s_mov_b32 s41, s72
    s_mov_b32 s44, s74
    s_mov_b32 s45, s75
    s_mov_b32 s95, s82
    s_mov_b32 s96, s83
    s_mov_b32 s97, s84
    s_mov_b32 s98, s85
    s_mov_b32 s99, s86
    s_mov_b32 s100, s87
    s_mov_b32 s101, s88
    s_add_u32 m0, s61, 0
    s_nop 0
    buffer_load_dwordx4 v16, s[40:43], s48 offen offset:0 lds
    buffer_load_dwordx4 v17, s[40:43], s48 offen offset:1024 lds
    s_add_u32 s48, s48, 128
    buffer_load_dwordx4 v16, s[40:43], s49 offen offset:2048 lds
    buffer_load_dwordx4 v17, s[40:43], s49 offen offset:3072 lds
    s_add_u32 s49, s49, 128
    s_add_u32 m0, s61, 4096
    s_nop 0
    buffer_load_dwordx4 v16, s[40:43], s50 offen offset:0 lds
    buffer_load_dwordx4 v17, s[40:43], s50 offen offset:1024 lds
    s_add_u32 s50, s50, 128
    buffer_load_dwordx4 v16, s[40:43], s51 offen offset:2048 lds
    buffer_load_dwordx4 v17, s[40:43], s51 offen offset:3072 lds
    s_add_u32 s51, s51, 128
    s_add_u32 s61, s61, 32768
    s_cmp_ge_u32 s61, 98304
    s_cselect_b32 s90, 98304, 0
    s_sub_u32 s61, s61, s90
    s_add_u32 m0, s62, 0
    s_nop 0
    buffer_load_dwordx4 v18, s[44:47], s52 offen offset:0 lds
    buffer_load_dwordx4 v19, s[44:47], s52 offen offset:1024 lds
    s_add_u32 s52, s52, s56
    buffer_load_dwordx4 v18, s[44:47], s53 offen offset:2048 lds
    buffer_load_dwordx4 v19, s[44:47], s53 offen offset:3072 lds
    s_add_u32 s53, s53, s56
    s_add_u32 m0, s62, 4096
    s_nop 0
    buffer_load_dwordx4 v20, s[44:47], s54 offen offset:0 lds
    buffer_load_dwordx4 v21, s[44:47], s54 offen offset:1024 lds
    s_add_u32 s54, s54, s56
    buffer_load_dwordx4 v20, s[44:47], s55 offen offset:2048 lds
    buffer_load_dwordx4 v21, s[44:47], s55 offen offset:3072 lds
    s_add_u32 s55, s55, s56
    s_xor_b32 s62, s62, 229376
    s_cmp_ge_u32 s68, 16
    s_cbranch_scc1 m_typea7
    s_bfe_u32 s69, s68, 0x20002
    s_add_u32 s69, s69, 4
    s_and_b32 s90, s2, 7
    s_lshl_b32 s90, s90, 2
    s_and_b32 s91, s68, 3
    s_add_u32 s90, s90, s91
    s_cmp_lt_u32 s90, 16
    s_cselect_b32 s83, 0, 1
    s_mov_b32 s91, 33554432
    s_cselect_b32 s85, 16777216, s91
    s_mov_b32 s91, 8192
    s_cselect_b32 s86, 1024, s91
    s_mov_b32 s91, 1024
    s_cselect_b32 s87, 4096, s91
    s_cselect_b32 s74, s36, s38
    s_cselect_b32 s75, s37, s39
    s_mov_b32 s71, s32
    s_mov_b32 s72, s33
    s_mov_b32 s73, 2097152
    s_mov_b32 s77, 1024
    s_mov_b32 s82, 8
    s_mov_b32 s81, 0
    s_mov_b32 s76, 4194304
    s_mov_b32 s78, 8192
    s_mov_b32 s84, 0
    s_and_b32 s90, s90, 15
    s_lshl_b32 s80, s90, 9
    s_lshl_b32 s79, s69, 18
    s_lshl_b32 s91, s83, 2
    s_add_u32 s91, s91, s69
    s_cmp_ge_u32 s69, 4
    s_cselect_b32 s92, 508, 8
    s_add_u32 s91, s91, s92
    s_lshl_b32 s88, s90, 4
    s_add_u32 s88, s88, s91
    s_lshl_b32 s88, s88, 3
    s_lshl_b32 s91, s90, 1
    s_add_u32 s91, s91, s58
    s_lshl_b32 s91, s91, 19
    s_lshl_b32 s92, s69, 1
    s_add_u32 s92, s92, s57
    s_lshl_b32 s92, s92, 15
    s_add_u32 s85, s85, s91
    s_add_u32 s85, s85, s92
    s_branch m_go28
m_typea7:
    s_and_b32 s69, s68, 3
    s_and_b32 s90, s2, 1
    s_lshl_b32 s90, s90, 2
    s_add_u32 s69, s69, s90
    s_bfe_u32 s90, s2, 0x20001
    s_mul_i32 s90, s90, 3
    s_bfe_u32 s91, s68, 0x20002
    s_add_u32 s90, s90, s91
    s_mov_b32 s76, 6291456
    s_mov_b32 s78, 6144
    s_mov_b32 s81, 1
    s_mov_b32 s73, 4194304
    s_mov_b32 s77, 2048
    s_mov_b32 s82, 16
    s_lshl_b32 s80, s90, 9
    s_lshl_b32 s79, s69, 19
    s_and_b32 s92, s90, 3
    s_lshr_b32 s91, s90, 2
    s_lshl_b32 s88, s92, 2
    s_add_u32 s88, s88, s91
    s_lshl_b32 s88, s88, 3
    s_add_u32 s88, s88, s69
    s_lshl_b32 s88, s88, 3
    s_add_u32 s88, s88, 6144
    s_cmp_eq_u32 s91, 0
    s_cselect_b32 s84, 1048744942, 0
    s_lshl_b32 s93, s91, 22
    s_add_u32 s85, s93, 50331648
    s_lshl_b32 s92, s92, 1
    s_add_u32 s92, s92, s58
    s_lshl_b32 s92, s92, 19
    s_add_u32 s85, s85, s92
    s_lshl_b32 s92, s57, 3
    s_add_u32 s92, s92, s69
    s_cmp_eq_u32 s91, 2
    s_cselect_b32 s83, 1, 0
    s_cselect_b32 s93, 12, 13
    s_mov_b32 s91, 131072
    s_cselect_b32 s86, 1024, s91
    s_mov_b32 s91, 1024
    s_cselect_b32 s87, 65536, s91
    s_lshl_b32 s92, s92, s93
    s_add_u32 s85, s85, s92
    s_mov_b32 s71, s24
    s_mov_b32 s72, s25
    s_mov_b32 s74, s26
    s_mov_b32 s75, s27
m_go28:
    s_xor_b32 s94, s70, 1
    s_mov_b32 s67, 2
    s_mov_b32 s17, -1
    s_mov_b32 s12, s4
    s_mov_b32 s13, s5
    s_mov_b32 s14, 256
    s_mov_b32 s15, 0x20000
    s_lshl_b32 s90, s2, 2
    s_add_u32 s90, s90, s16
    s_cmp_lg_u32 s90, 0
    s_cbranch_scc1 m_tok9
    s_memrealtime s[92:93]
    s_waitcnt lgkmcnt(0)
    s_or_b32 s92, s92, 1
    v_mov_b32 v4, s92
    v_mov_b32 v5, s93
    s_mov_b64 exec, 1
    buffer_store_dwordx2 v[4:5], off, s[12:15], 0 sc1
    s_mov_b64 exec, -1
m_tok9:
    s_add_u32 m0, s61, 0
    s_nop 0
    buffer_load_dwordx4 v16, s[40:43], s48 offen offset:0 lds
    buffer_load_dwordx4 v17, s[40:43], s48 offen offset:1024 lds
    s_add_u32 s48, s48, 128
    buffer_load_dwordx4 v16, s[40:43], s49 offen offset:2048 lds
    buffer_load_dwordx4 v17, s[40:43], s49 offen offset:3072 lds
    s_add_u32 s49, s49, 128
    s_add_u32 m0, s61, 4096
    s_nop 0
    buffer_load_dwordx4 v16, s[40:43], s50 offen offset:0 lds
    buffer_load_dwordx4 v17, s[40:43], s50 offen offset:1024 lds
    s_add_u32 s50, s50, 128
    buffer_load_dwordx4 v16, s[40:43], s51 offen offset:2048 lds
    buffer_load_dwordx4 v17, s[40:43], s51 offen offset:3072 lds
    s_add_u32 s51, s51, 128
    s_add_u32 s61, s61, 32768
    s_cmp_ge_u32 s61, 98304
    s_cselect_b32 s90, 98304, 0
    s_sub_u32 s61, s61, s90
    s_add_u32 m0, s62, 0
    s_nop 0
    buffer_load_dwordx4 v18, s[44:47], s52 offen offset:0 lds
    buffer_load_dwordx4 v19, s[44:47], s52 offen offset:1024 lds
    s_add_u32 s52, s52, s56
    buffer_load_dwordx4 v18, s[44:47], s53 offen offset:2048 lds
    buffer_load_dwordx4 v19, s[44:47], s53 offen offset:3072 lds
    s_add_u32 s53, s53, s56
    s_add_u32 m0, s62, 4096
    s_nop 0
    buffer_load_dwordx4 v20, s[44:47], s54 offen offset:0 lds
    buffer_load_dwordx4 v21, s[44:47], s54 offen offset:1024 lds
    s_add_u32 s54, s54, s56
    buffer_load_dwordx4 v20, s[44:47], s55 offen offset:2048 lds
    buffer_load_dwordx4 v21, s[44:47], s55 offen offset:3072 lds
    s_add_u32 s55, s55, s56
    s_xor_b32 s62, s62, 229376
    s_waitcnt vmcnt(16)
    s_barrier
    ds_read_b64_tr_b16 a[64:65], v8 offset:0
    ds_read_b64_tr_b16 a[66:67], v8 offset:2048
    ds_read_b128 a[0:3], v6 offset:0
    ds_read_b128 a[4:7], v6 offset:2048
    ds_read_b64_tr_b16 a[68:69], v9 offset:0
    ds_read_b64_tr_b16 a[70:71], v9 offset:2048
    ds_read_b128 a[8:11], v6 offset:4096
    ds_read_b128 a[12:15], v6 offset:6144
    ds_read_b64_tr_b16 a[72:73], v10 offset:0
    ds_read_b64_tr_b16 a[74:75], v10 offset:2048
    ds_read_b128 a[16:19], v6 offset:8192
    ds_read_b128 a[20:23], v6 offset:10240
    ds_read_b64_tr_b16 a[76:77], v11 offset:0
    ds_read_b64_tr_b16 a[78:79], v11 offset:2048
    ds_read_b128 a[24:27], v6 offset:12288
    ds_read_b128 a[28:31], v6 offset:14336
    ds_read_b64_tr_b16 a[80:81], v12 offset:0
    ds_read_b64_tr_b16 a[82:83], v12 offset:2048
    ds_read_b64_tr_b16 a[84:85], v13 offset:0
    ds_read_b64_tr_b16 a[86:87], v13 offset:2048
    ds_read_b64_tr_b16 a[88:89], v14 offset:0
    ds_read_b64_tr_b16 a[90:91], v14 offset:2048
    ds_read_b64_tr_b16 a[92:93], v15 offset:0
    ds_read_b64_tr_b16 a[94:95], v15 offset:2048
    s_mov_b32 s66, 1
    s_mov_b32 s24, s6
    s_mov_b32 s25, s7
    s_mov_b32 s26, 0
    s_mov_b32 s27, 0x20000
    s_mov_b32 s28, 0
    s_mov_b32 s29, 0
    s_mov_b32 s30, 0
    s_mov_b32 s31, 0
m_tile10:
    s_mov_b32 s65, s95
    s_cmp_eq_u32 s96, 1
    s_cbranch_scc1 m_swp12
    s_waitcnt lgkmcnt(15)
    v_mfma_f32_16x16x32_bf16 v[32:35], a[64:67], a[0:3], 0
    v_mfma_f32_16x16x32_bf16 v[40:43], a[64:67], a[4:7], 0
    v_mfma_f32_16x16x32_bf16 v[48:51], a[64:67], a[8:11], 0
    v_mfma_f32_16x16x32_bf16 v[56:59], a[64:67], a[12:15], 0
    s_add_u32 m0, s61, 0
    s_waitcnt lgkmcnt(13)
    v_mfma_f32_16x16x32_bf16 v[64:67], a[64:67], a[16:19], 0
    buffer_load_dwordx4 v16, s[40:43], s48 offen offset:0 lds
    s_waitcnt lgkmcnt(12)
    v_mfma_f32_16x16x32_bf16 v[72:75], a[64:67], a[20:23], 0
    s_waitcnt lgkmcnt(9)
    v_mfma_f32_16x16x32_bf16 v[80:83], a[64:67], a[24:27], 0
    s_waitcnt lgkmcnt(8)
    v_mfma_f32_16x16x32_bf16 v[88:91], a[64:67], a[28:31], 0
    ds_read_b64_tr_b16 a[64:65], v8 offset:16384
    v_mfma_f32_16x16x32_bf16 v[36:39], a[68:71], a[0:3], 0
    ds_read_b64_tr_b16 a[66:67], v8 offset:18432
    v_mfma_f32_16x16x32_bf16 v[44:47], a[68:71], a[4:7], 0
    v_mfma_f32_16x16x32_bf16 v[52:55], a[68:71], a[8:11], 0
    ds_read_b128 a[32:35], v7 offset:0
    v_mfma_f32_16x16x32_bf16 v[60:63], a[68:71], a[12:15], 0
    v_mfma_f32_16x16x32_bf16 v[68:71], a[68:71], a[16:19], 0
    buffer_load_dwordx4 v17, s[40:43], s48 offen offset:1024 lds
    v_mfma_f32_16x16x32_bf16 v[76:79], a[68:71], a[20:23], 0
    s_add_u32 s48, s48, 128
    v_mfma_f32_16x16x32_bf16 v[84:87], a[68:71], a[24:27], 0
    ds_read_b128 a[36:39], v7 offset:2048
    v_mfma_f32_16x16x32_bf16 v[92:95], a[68:71], a[28:31], 0
    ds_read_b64_tr_b16 a[68:69], v9 offset:16384
    v_mfma_f32_16x16x32_bf16 v[96:99], a[72:75], a[0:3], 0
    ds_read_b64_tr_b16 a[70:71], v9 offset:18432
    v_mfma_f32_16x16x32_bf16 v[104:107], a[72:75], a[4:7], 0
    v_mfma_f32_16x16x32_bf16 v[112:115], a[72:75], a[8:11], 0
    ds_read_b128 a[40:43], v7 offset:4096
    v_mfma_f32_16x16x32_bf16 v[120:123], a[72:75], a[12:15], 0
    v_mfma_f32_16x16x32_bf16 v[128:131], a[72:75], a[16:19], 0
    buffer_load_dwordx4 v16, s[40:43], s49 offen offset:2048 lds
    v_mfma_f32_16x16x32_bf16 v[136:139], a[72:75], a[20:23], 0
    v_mfma_f32_16x16x32_bf16 v[144:147], a[72:75], a[24:27], 0
    ds_read_b128 a[44:47], v7 offset:6144
    v_mfma_f32_16x16x32_bf16 v[152:155], a[72:75], a[28:31], 0
    ds_read_b64_tr_b16 a[72:73], v10 offset:16384
    v_mfma_f32_16x16x32_bf16 v[100:103], a[76:79], a[0:3], 0
    ds_read_b64_tr_b16 a[74:75], v10 offset:18432
    v_mfma_f32_16x16x32_bf16 v[108:111], a[76:79], a[4:7], 0
    v_mfma_f32_16x16x32_bf16 v[116:119], a[76:79], a[8:11], 0
    ds_read_b128 a[48:51], v7 offset:8192
    v_mfma_f32_16x16x32_bf16 v[124:127], a[76:79], a[12:15], 0
    v_mfma_f32_16x16x32_bf16 v[132:135], a[76:79], a[16:19], 0
    buffer_load_dwordx4 v17, s[40:43], s49 offen offset:3072 lds
    v_mfma_f32_16x16x32_bf16 v[140:143], a[76:79], a[20:23], 0
    s_add_u32 s49, s49, 128
    v_mfma_f32_16x16x32_bf16 v[148:151], a[76:79], a[24:27], 0
    ds_read_b128 a[52:55], v7 offset:10240
    v_mfma_f32_16x16x32_bf16 v[156:159], a[76:79], a[28:31], 0
    ds_read_b64_tr_b16 a[76:77], v11 offset:16384
    s_waitcnt lgkmcnt(15)
    v_mfma_f32_16x16x32_bf16 v[160:163], a[80:83], a[0:3], 0
    ds_read_b64_tr_b16 a[78:79], v11 offset:18432
    v_mfma_f32_16x16x32_bf16 v[168:171], a[80:83], a[4:7], 0
    v_mfma_f32_16x16x32_bf16 v[176:179], a[80:83], a[8:11], 0
    ds_read_b128 a[56:59], v7 offset:12288
    v_mfma_f32_16x16x32_bf16 v[184:187], a[80:83], a[12:15], 0
    s_add_u32 m0, s61, 4096
    v_mfma_f32_16x16x32_bf16 v[192:195], a[80:83], a[16:19], 0
    buffer_load_dwordx4 v16, s[40:43], s50 offen offset:0 lds
    v_mfma_f32_16x16x32_bf16 v[200:203], a[80:83], a[20:23], 0
    v_mfma_f32_16x16x32_bf16 v[208:211], a[80:83], a[24:27], 0
    s_add_u32 s61, s61, 32768
    ds_read_b128 a[60:63], v7 offset:14336
    v_mfma_f32_16x16x32_bf16 v[216:219], a[80:83], a[28:31], 0
    s_cmp_ge_u32 s61, 98304
    s_cselect_b32 s90, 98304, 0
    ds_read_b64_tr_b16 a[80:81], v12 offset:16384
    v_mfma_f32_16x16x32_bf16 v[164:167], a[84:87], a[0:3], 0
    s_sub_u32 s61, s61, s90
    ds_read_b64_tr_b16 a[82:83], v12 offset:18432
    v_mfma_f32_16x16x32_bf16 v[172:175], a[84:87], a[4:7], 0
    s_add_u32 s64, s64, 32768
    v_mfma_f32_16x16x32_bf16 v[180:183], a[84:87], a[8:11], 0
    buffer_store_dwordx4 a[128:131], v2, s[24:27], s28 offen sc1
    v_mfma_f32_16x16x32_bf16 v[188:191], a[84:87], a[12:15], 0
    s_add_u32 s28, s28, s31
    v_mfma_f32_16x16x32_bf16 v[196:199], a[84:87], a[16:19], 0
    buffer_load_dwordx4 v17, s[40:43], s50 offen offset:1024 lds
    v_mfma_f32_16x16x32_bf16 v[204:207], a[84:87], a[20:23], 0
    s_add_u32 s50, s50, 128
    v_mfma_f32_16x16x32_bf16 v[212:215], a[84:87], a[24:27], 0
    s_cmp_ge_u32 s64, 98304
    s_cselect_b32 s63, 4294901760, s59
    s_cselect_b32 s64, 0, s64
    v_mfma_f32_16x16x32_bf16 v[220:223], a[84:87], a[28:31], 0
    ds_read_b64_tr_b16 a[84:85], v13 offset:16384
    v_mfma_f32_16x16x32_bf16 v[224:227], a[88:91], a[0:3], 0
    ds_read_b64_tr_b16 a[86:87], v13 offset:18432
    v_mfma_f32_16x16x32_bf16 v[232:235], a[88:91], a[4:7], 0
    v_mfma_f32_16x16x32_bf16 v[240:243], a[88:91], a[8:11], 0
    buffer_store_dwordx4 a[132:135], v2, s[24:27], s28 offen sc1
    v_mfma_f32_16x16x32_bf16 v[248:251], a[88:91], a[12:15], 0
    s_add_u32 s28, s28, s31
    v_mfma_f32_16x16x32_bf16 a[96:99], a[88:91], a[16:19], 0
    buffer_load_dwordx4 v16, s[40:43], s51 offen offset:2048 lds
    v_mfma_f32_16x16x32_bf16 a[104:107], a[88:91], a[20:23], 0
    v_mfma_f32_16x16x32_bf16 a[112:115], a[88:91], a[24:27], 0
    v_mfma_f32_16x16x32_bf16 a[120:123], a[88:91], a[28:31], 0
    ds_read_b64_tr_b16 a[88:89], v14 offset:16384
    s_waitcnt lgkmcnt(15)
    v_mfma_f32_16x16x32_bf16 v[228:231], a[92:95], a[0:3], 0
    ds_read_b64_tr_b16 a[90:91], v14 offset:18432
    v_mfma_f32_16x16x32_bf16 v[236:239], a[92:95], a[4:7], 0
    v_add_u32 v6, s63, v6
    v_add_u32 v7, s63, v7
    v_mfma_f32_16x16x32_bf16 v[244:247], a[92:95], a[8:11], 0
    buffer_store_dwordx4 a[136:139], v2, s[24:27], s28 offen sc1
    v_mfma_f32_16x16x32_bf16 v[252:255], a[92:95], a[12:15], 0
    s_add_u32 s28, s28, s31
    v_mfma_f32_16x16x32_bf16 a[100:103], a[92:95], a[16:19], 0
    buffer_load_dwordx4 v17, s[40:43], s51 offen offset:3072 lds
    v_mfma_f32_16x16x32_bf16 a[108:111], a[92:95], a[20:23], 0
    s_add_u32 s51, s51, 128
    v_mfma_f32_16x16x32_bf16 a[116:119], a[92:95], a[24:27], 0
    v_mfma_f32_16x16x32_bf16 a[124:127], a[92:95], a[28:31], 0
    ds_read_b64_tr_b16 a[92:93], v15 offset:16384
    ds_read_b64_tr_b16 a[94:95], v15 offset:18432
    v_mfma_f32_16x16x32_bf16 v[32:35], a[64:67], a[32:35], v[32:35]
    v_xor_b32 v8, s60, v8
    v_xor_b32 v9, s60, v9
    v_mfma_f32_16x16x32_bf16 v[40:43], a[64:67], a[36:39], v[40:43]
    v_xor_b32 v10, s60, v10
    v_xor_b32 v11, s60, v11
    s_waitcnt lgkmcnt(15)
    v_mfma_f32_16x16x32_bf16 v[48:51], a[64:67], a[40:43], v[48:51]
    v_xor_b32 v12, s60, v12
    v_xor_b32 v13, s60, v13
    v_mfma_f32_16x16x32_bf16 v[56:59], a[64:67], a[44:47], v[56:59]
    v_xor_b32 v14, s60, v14
    v_xor_b32 v15, s60, v15
    s_waitcnt lgkmcnt(13)
    v_mfma_f32_16x16x32_bf16 v[64:67], a[64:67], a[48:51], v[64:67]
    s_waitcnt lgkmcnt(12)
    v_mfma_f32_16x16x32_bf16 v[72:75], a[64:67], a[52:55], v[72:75]
    s_waitcnt lgkmcnt(9)
    v_mfma_f32_16x16x32_bf16 v[80:83], a[64:67], a[56:59], v[80:83]
    s_waitcnt vmcnt(11) lgkmcnt(0)
    v_mfma_f32_16x16x32_bf16 v[88:91], a[64:67], a[60:63], v[88:91]
    s_barrier
    ds_read_b64_tr_b16 a[64:65], v8 offset:0
    v_mfma_f32_16x16x32_bf16 v[36:39], a[68:71], a[32:35], v[36:39]
    s_add_u32 m0, s62, 0
    ds_read_b64_tr_b16 a[66:67], v8 offset:2048
    v_mfma_f32_16x16x32_bf16 v[44:47], a[68:71], a[36:39], v[44:47]
    buffer_load_dwordx4 v18, s[44:47], s52 offen offset:0 lds
    v_mfma_f32_16x16x32_bf16 v[52:55], a[68:71], a[40:43], v[52:55]
    ds_read_b128 a[0:3], v6 offset:0
    v_mfma_f32_16x16x32_bf16 v[60:63], a[68:71], a[44:47], v[60:63]
    v_mfma_f32_16x16x32_bf16 v[68:71], a[68:71], a[48:51], v[68:71]
    v_mfma_f32_16x16x32_bf16 v[76:79], a[68:71], a[52:55], v[76:79]
    buffer_load_dwordx4 v19, s[44:47], s52 offen offset:1024 lds
    v_mfma_f32_16x16x32_bf16 v[84:87], a[68:71], a[56:59], v[84:87]
    s_add_u32 s52, s52, s56
    ds_read_b128 a[4:7], v6 offset:2048
    v_mfma_f32_16x16x32_bf16 v[92:95], a[68:71], a[60:63], v[92:95]
    ds_read_b64_tr_b16 a[68:69], v9 offset:0
    v_mfma_f32_16x16x32_bf16 v[96:99], a[72:75], a[32:35], v[96:99]
    ds_read_b64_tr_b16 a[70:71], v9 offset:2048
    v_mfma_f32_16x16x32_bf16 v[104:107], a[72:75], a[36:39], v[104:107]
    buffer_load_dwordx4 v18, s[44:47], s53 offen offset:2048 lds
    v_mfma_f32_16x16x32_bf16 v[112:115], a[72:75], a[40:43], v[112:115]
    ds_read_b128 a[8:11], v6 offset:4096
    v_mfma_f32_16x16x32_bf16 v[120:123], a[72:75], a[44:47], v[120:123]
    v_mfma_f32_16x16x32_bf16 v[128:131], a[72:75], a[48:51], v[128:131]
    v_mfma_f32_16x16x32_bf16 v[136:139], a[72:75], a[52:55], v[136:139]
    buffer_load_dwordx4 v19, s[44:47], s53 offen offset:3072 lds
    v_mfma_f32_16x16x32_bf16 v[144:147], a[72:75], a[56:59], v[144:147]
    s_add_u32 s53, s53, s56
    ds_read_b128 a[12:15], v6 offset:6144
    v_mfma_f32_16x16x32_bf16 v[152:155], a[72:75], a[60:63], v[152:155]
    ds_read_b64_tr_b16 a[72:73], v10 offset:0
    v_mfma_f32_16x16x32_bf16 v[100:103], a[76:79], a[32:35], v[100:103]
    s_add_u32 m0, s62, 4096
    ds_read_b64_tr_b16 a[74:75], v10 offset:2048
    v_mfma_f32_16x16x32_bf16 v[108:111], a[76:79], a[36:39], v[108:111]
    buffer_load_dwordx4 v20, s[44:47], s54 offen offset:0 lds
    v_mfma_f32_16x16x32_bf16 v[116:119], a[76:79], a[40:43], v[116:119]
    ds_read_b128 a[16:19], v6 offset:8192
    v_mfma_f32_16x16x32_bf16 v[124:127], a[76:79], a[44:47], v[124:127]
    s_xor_b32 s62, s62, 229376
    v_mfma_f32_16x16x32_bf16 v[132:135], a[76:79], a[48:51], v[132:135]
    v_mfma_f32_16x16x32_bf16 v[140:143], a[76:79], a[52:55], v[140:143]
    buffer_load_dwordx4 v21, s[44:47], s54 offen offset:1024 lds
    v_mfma_f32_16x16x32_bf16 v[148:151], a[76:79], a[56:59], v[148:151]
    s_add_u32 s54, s54, s56
    ds_read_b128 a[20:23], v6 offset:10240
    v_mfma_f32_16x16x32_bf16 v[156:159], a[76:79], a[60:63], v[156:159]
    ds_read_b64_tr_b16 a[76:77], v11 offset:0
    v_mfma_f32_16x16x32_bf16 v[160:163], a[80:83], a[32:35], v[160:163]
    ds_read_b64_tr_b16 a[78:79], v11 offset:2048
    v_mfma_f32_16x16x32_bf16 v[168:171], a[80:83], a[36:39], v[168:171]
    buffer_load_dwordx4 v20, s[44:47], s55 offen offset:2048 lds
    v_mfma_f32_16x16x32_bf16 v[176:179], a[80:83], a[40:43], v[176:179]
    ds_read_b128 a[24:27], v6 offset:12288
    v_mfma_f32_16x16x32_bf16 v[184:187], a[80:83], a[44:47], v[184:187]
    v_mfma_f32_16x16x32_bf16 v[192:195], a[80:83], a[48:51], v[192:195]
    v_mfma_f32_16x16x32_bf16 v[200:203], a[80:83], a[52:55], v[200:203]
    buffer_load_dwordx4 v21, s[44:47], s55 offen offset:3072 lds
    v_mfma_f32_16x16x32_bf16 v[208:211], a[80:83], a[56:59], v[208:211]
    s_add_u32 s55, s55, s56
    ds_read_b128 a[28:31], v6 offset:14336
    v_mfma_f32_16x16x32_bf16 v[216:219], a[80:83], a[60:63], v[216:219]
    ds_read_b64_tr_b16 a[80:81], v12 offset:0
    v_mfma_f32_16x16x32_bf16 v[164:167], a[84:87], a[32:35], v[164:167]
    ds_read_b64_tr_b16 a[82:83], v12 offset:2048
    v_mfma_f32_16x16x32_bf16 v[172:175], a[84:87], a[36:39], v[172:175]
    v_mfma_f32_16x16x32_bf16 v[180:183], a[84:87], a[40:43], v[180:183]
    buffer_store_dwordx4 a[140:143], v2, s[24:27], s28 offen sc1
    v_mfma_f32_16x16x32_bf16 v[188:191], a[84:87], a[44:47], v[188:191]
    s_add_u32 s28, s28, s31
    v_mfma_f32_16x16x32_bf16 v[196:199], a[84:87], a[48:51], v[196:199]
    v_mfma_f32_16x16x32_bf16 v[204:207], a[84:87], a[52:55], v[204:207]
    v_mfma_f32_16x16x32_bf16 v[212:215], a[84:87], a[56:59], v[212:215]
    buffer_store_dwordx4 a[144:147], v2, s[24:27], s28 offen sc1
    v_mfma_f32_16x16x32_bf16 v[220:223], a[84:87], a[60:63], v[220:223]
    s_add_u32 s28, s28, s31
    ds_read_b64_tr_b16 a[84:85], v13 offset:0
    v_mfma_f32_16x16x32_bf16 v[224:227], a[88:91], a[32:35], v[224:227]
    ds_read_b64_tr_b16 a[86:87], v13 offset:2048
    v_mfma_f32_16x16x32_bf16 v[232:235], a[88:91], a[36:39], v[232:235]
    v_mfma_f32_16x16x32_bf16 v[240:243], a[88:91], a[40:43], v[240:243]
    buffer_store_dwordx4 a[148:151], v2, s[24:27], s28 offen sc1
    v_mfma_f32_16x16x32_bf16 v[248:251], a[88:91], a[44:47], v[248:251]
    s_add_u32 s28, s28, s31
    v_mfma_f32_16x16x32_bf16 a[96:99], a[88:91], a[48:51], a[96:99]
    v_mfma_f32_16x16x32_bf16 a[104:107], a[88:91], a[52:55], a[104:107]
    v_mfma_f32_16x16x32_bf16 a[112:115], a[88:91], a[56:59], a[112:115]
    buffer_store_dwordx4 a[152:155], v2, s[24:27], s28 offen sc1
    v_mfma_f32_16x16x32_bf16 a[120:123], a[88:91], a[60:63], a[120:123]
    s_add_u32 s28, s28, s31
    ds_read_b64_tr_b16 a[88:89], v14 offset:0
    v_mfma_f32_16x16x32_bf16 v[228:231], a[92:95], a[32:35], v[228:231]
    ds_read_b64_tr_b16 a[90:91], v14 offset:2048
    v_mfma_f32_16x16x32_bf16 v[236:239], a[92:95], a[36:39], v[236:239]
    v_mfma_f32_16x16x32_bf16 v[244:247], a[92:95], a[40:43], v[244:247]
    buffer_store_dwordx4 a[156:159], v2, s[24:27], s28 offen sc1
    v_mfma_f32_16x16x32_bf16 v[252:255], a[92:95], a[44:47], v[252:255]
    s_add_u32 s29, s29, s30
    s_mov_b32 s28, s29
    v_mfma_f32_16x16x32_bf16 a[100:103], a[92:95], a[48:51], a[100:103]
    s_sub_u32 s65, s65, 1
    v_mfma_f32_16x16x32_bf16 a[108:111], a[92:95], a[52:55], a[108:111]
    v_mfma_f32_16x16x32_bf16 a[116:119], a[92:95], a[56:59], a[116:119]
    v_mfma_f32_16x16x32_bf16 a[124:127], a[92:95], a[60:63], a[124:127]
    ds_read_b64_tr_b16 a[92:93], v15 offset:0
    ds_read_b64_tr_b16 a[94:95], v15 offset:2048
    s_waitcnt lgkmcnt(15)
    v_mfma_f32_16x16x32_bf16 v[32:35], a[64:67], a[0:3], v[32:35]
    v_mfma_f32_16x16x32_bf16 v[40:43], a[64:67], a[4:7], v[40:43]
    v_mfma_f32_16x16x32_bf16 v[48:51], a[64:67], a[8:11], v[48:51]
    v_mfma_f32_16x16x32_bf16 v[56:59], a[64:67], a[12:15], v[56:59]
    s_add_u32 m0, s61, 0
    s_waitcnt lgkmcnt(13)
    v_mfma_f32_16x16x32_bf16 v[64:67], a[64:67], a[16:19], v[64:67]
    buffer_load_dwordx4 v16, s[40:43], s48 offen offset:0 lds
    s_waitcnt lgkmcnt(12)
    v_mfma_f32_16x16x32_bf16 v[72:75], a[64:67], a[20:23], v[72:75]
    s_waitcnt lgkmcnt(9)
    v_mfma_f32_16x16x32_bf16 v[80:83], a[64:67], a[24:27], v[80:83]
    s_waitcnt lgkmcnt(8)
    v_mfma_f32_16x16x32_bf16 v[88:91], a[64:67], a[28:31], v[88:91]
    ds_read_b64_tr_b16 a[64:65], v8 offset:16384
    v_mfma_f32_16x16x32_bf16 v[36:39], a[68:71], a[0:3], v[36:39]
    ds_read_b64_tr_b16 a[66:67], v8 offset:18432
    v_mfma_f32_16x16x32_bf16 v[44:47], a[68:71], a[4:7], v[44:47]
    v_mfma_f32_16x16x32_bf16 v[52:55], a[68:71], a[8:11], v[52:55]
    ds_read_b128 a[32:35], v7 offset:0
    v_mfma_f32_16x16x32_bf16 v[60:63], a[68:71], a[12:15], v[60:63]
    v_mfma_f32_16x16x32_bf16 v[68:71], a[68:71], a[16:19], v[68:71]
    buffer_load_dwordx4 v17, s[40:43], s48 offen offset:1024 lds
    v_mfma_f32_16x16x32_bf16 v[76:79], a[68:71], a[20:23], v[76:79]
    s_add_u32 s48, s48, 128
    v_mfma_f32_16x16x32_bf16 v[84:87], a[68:71], a[24:27], v[84:87]
    ds_read_b128 a[36:39], v7 offset:2048
    v_mfma_f32_16x16x32_bf16 v[92:95], a[68:71], a[28:31], v[92:95]
    ds_read_b64_tr_b16 a[68:69], v9 offset:16384
    v_mfma_f32_16x16x32_bf16 v[96:99], a[72:75], a[0:3], v[96:99]
    ds_read_b64_tr_b16 a[70:71], v9 offset:18432
    v_mfma_f32_16x16x32_bf16 v[104:107], a[72:75], a[4:7], v[104:107]
    v_mfma_f32_16x16x32_bf16 v[112:115], a[72:75], a[8:11], v[112:115]
    ds_read_b128 a[40:43], v7 offset:4096
    v_mfma_f32_16x16x32_bf16 v[120:123], a[72:75], a[12:15], v[120:123]
    v_mfma_f32_16x16x32_bf16 v[128:131], a[72:75], a[16:19], v[128:131]
    buffer_load_dwordx4 v16, s[40:43], s49 offen offset:2048 lds
    v_mfma_f32_16x16x32_bf16 v[136:139], a[72:75], a[20:23], v[136:139]
    v_mfma_f32_16x16x32_bf16 v[144:147], a[72:75], a[24:27], v[144:147]
    ds_read_b128 a[44:47], v7 offset:6144
    v_mfma_f32_16x16x32_bf16 v[152:155], a[72:75], a[28:31], v[152:155]
    ds_read_b64_tr_b16 a[72:73], v10 offset:16384
    v_mfma_f32_16x16x32_bf16 v[100:103], a[76:79], a[0:3], v[100:103]
    ds_read_b64_tr_b16 a[74:75], v10 offset:18432
    v_mfma_f32_16x16x32_bf16 v[108:111], a[76:79], a[4:7], v[108:111]
    v_mfma_f32_16x16x32_bf16 v[116:119], a[76:79], a[8:11], v[116:119]
    ds_read_b128 a[48:51], v7 offset:8192
    v_mfma_f32_16x16x32_bf16 v[124:127], a[76:79], a[12:15], v[124:127]
    v_mfma_f32_16x16x32_bf16 v[132:135], a[76:79], a[16:19], v[132:135]
    buffer_load_dwordx4 v17, s[40:43], s49 offen offset:3072 lds
    v_mfma_f32_16x16x32_bf16 v[140:143], a[76:79], a[20:23], v[140:143]
    s_add_u32 s49, s49, 128
    v_mfma_f32_16x16x32_bf16 v[148:151], a[76:79], a[24:27], v[148:151]
    ds_read_b128 a[52:55], v7 offset:10240
    v_mfma_f32_16x16x32_bf16 v[156:159], a[76:79], a[28:31], v[156:159]
    ds_read_b64_tr_b16 a[76:77], v11 offset:16384
    s_waitcnt lgkmcnt(15)
    v_mfma_f32_16x16x32_bf16 v[160:163], a[80:83], a[0:3], v[160:163]
    ds_read_b64_tr_b16 a[78:79], v11 offset:18432
    v_mfma_f32_16x16x32_bf16 v[168:171], a[80:83], a[4:7], v[168:171]
    v_mfma_f32_16x16x32_bf16 v[176:179], a[80:83], a[8:11], v[176:179]
    ds_read_b128 a[56:59], v7 offset:12288
    v_mfma_f32_16x16x32_bf16 v[184:187], a[80:83], a[12:15], v[184:187]
    s_add_u32 m0, s61, 4096
    v_mfma_f32_16x16x32_bf16 v[192:195], a[80:83], a[16:19], v[192:195]
    buffer_load_dwordx4 v16, s[40:43], s50 offen offset:0 lds
    v_mfma_f32_16x16x32_bf16 v[200:203], a[80:83], a[20:23], v[200:203]
    v_mfma_f32_16x16x32_bf16 v[208:211], a[80:83], a[24:27], v[208:211]
    s_add_u32 s61, s61, 32768
    ds_read_b128 a[60:63], v7 offset:14336
    v_mfma_f32_16x16x32_bf16 v[216:219], a[80:83], a[28:31], v[216:219]
    s_cmp_ge_u32 s61, 98304
    s_cselect_b32 s90, 98304, 0
    ds_read_b64_tr_b16 a[80:81], v12 offset:16384
    v_mfma_f32_16x16x32_bf16 v[164:167], a[84:87], a[0:3], v[164:167]
    s_sub_u32 s61, s61, s90
    ds_read_b64_tr_b16 a[82:83], v12 offset:18432
    v_mfma_f32_16x16x32_bf16 v[172:175], a[84:87], a[4:7], v[172:175]
    s_add_u32 s64, s64, 32768
    v_mfma_f32_16x16x32_bf16 v[180:183], a[84:87], a[8:11], v[180:183]
    buffer_store_dwordx4 a[160:163], v2, s[24:27], s28 offen sc1
    v_mfma_f32_16x16x32_bf16 v[188:191], a[84:87], a[12:15], v[188:191]
    s_add_u32 s28, s28, s31
    v_mfma_f32_16x16x32_bf16 v[196:199], a[84:87], a[16:19], v[196:199]
    buffer_load_dwordx4 v17, s[40:43], s50 offen offset:1024 lds
    v_mfma_f32_16x16x32_bf16 v[204:207], a[84:87], a[20:23], v[204:207]
    s_add_u32 s50, s50, 128
    v_mfma_f32_16x16x32_bf16 v[212:215], a[84:87], a[24:27], v[212:215]
    s_cmp_ge_u32 s64, 98304
    s_cselect_b32 s63, 4294901760, s59
    s_cselect_b32 s64, 0, s64
    v_mfma_f32_16x16x32_bf16 v[220:223], a[84:87], a[28:31], v[220:223]
    ds_read_b64_tr_b16 a[84:85], v13 offset:16384
    v_mfma_f32_16x16x32_bf16 v[224:227], a[88:91], a[0:3], v[224:227]
    ds_read_b64_tr_b16 a[86:87], v13 offset:18432
    v_mfma_f32_16x16x32_bf16 v[232:235], a[88:91], a[4:7], v[232:235]
    v_mfma_f32_16x16x32_bf16 v[240:243], a[88:91], a[8:11], v[240:243]
    buffer_store_dwordx4 a[164:167], v2, s[24:27], s28 offen sc1
    v_mfma_f32_16x16x32_bf16 v[248:251], a[88:91], a[12:15], v[248:251]
    s_add_u32 s28, s28, s31
    v_mfma_f32_16x16x32_bf16 a[96:99], a[88:91], a[16:19], a[96:99]
    buffer_load_dwordx4 v16, s[40:43], s51 offen offset:2048 lds
    v_mfma_f32_16x16x32_bf16 a[104:107], a[88:91], a[20:23], a[104:107]
    v_mfma_f32_16x16x32_bf16 a[112:115], a[88:91], a[24:27], a[112:115]
    v_mfma_f32_16x16x32_bf16 a[120:123], a[88:91], a[28:31], a[120:123]
    ds_read_b64_tr_b16 a[88:89], v14 offset:16384
    s_waitcnt lgkmcnt(15)
    v_mfma_f32_16x16x32_bf16 v[228:231], a[92:95], a[0:3], v[228:231]
    ds_read_b64_tr_b16 a[90:91], v14 offset:18432
    v_mfma_f32_16x16x32_bf16 v[236:239], a[92:95], a[4:7], v[236:239]
    v_add_u32 v6, s63, v6
    v_add_u32 v7, s63, v7
    v_mfma_f32_16x16x32_bf16 v[244:247], a[92:95], a[8:11], v[244:247]
    buffer_store_dwordx4 a[168:171], v2, s[24:27], s28 offen sc1
    v_mfma_f32_16x16x32_bf16 v[252:255], a[92:95], a[12:15], v[252:255]
    s_add_u32 s28, s28, s31
    v_mfma_f32_16x16x32_bf16 a[100:103], a[92:95], a[16:19], a[100:103]
    buffer_load_dwordx4 v17, s[40:43], s51 offen offset:3072 lds
    v_mfma_f32_16x16x32_bf16 a[108:111], a[92:95], a[20:23], a[108:111]
    s_add_u32 s51, s51, 128
    v_mfma_f32_16x16x32_bf16 a[116:119], a[92:95], a[24:27], a[116:119]
    v_mfma_f32_16x16x32_bf16 a[124:127], a[92:95], a[28:31], a[124:127]
    ds_read_b64_tr_b16 a[92:93], v15 offset:16384
    ds_read_b64_tr_b16 a[94:95], v15 offset:18432
    v_mfma_f32_16x16x32_bf16 v[32:35], a[64:67], a[32:35], v[32:35]
    v_xor_b32 v8, s60, v8
    v_xor_b32 v9, s60, v9
    v_mfma_f32_16x16x32_bf16 v[40:43], a[64:67], a[36:39], v[40:43]
    v_xor_b32 v10, s60, v10
    v_xor_b32 v11, s60, v11
    s_waitcnt lgkmcnt(15)
    v_mfma_f32_16x16x32_bf16 v[48:51], a[64:67], a[40:43], v[48:51]
    v_xor_b32 v12, s60, v12
    v_xor_b32 v13, s60, v13
    v_mfma_f32_16x16x32_bf16 v[56:59], a[64:67], a[44:47], v[56:59]
    v_xor_b32 v14, s60, v14
    v_xor_b32 v15, s60, v15
    s_waitcnt lgkmcnt(13)
    v_mfma_f32_16x16x32_bf16 v[64:67], a[64:67], a[48:51], v[64:67]
    s_waitcnt lgkmcnt(12)
    v_mfma_f32_16x16x32_bf16 v[72:75], a[64:67], a[52:55], v[72:75]
    s_waitcnt lgkmcnt(9)
    v_mfma_f32_16x16x32_bf16 v[80:83], a[64:67], a[56:59], v[80:83]
    s_waitcnt vmcnt(16) lgkmcnt(0)
    v_mfma_f32_16x16x32_bf16 v[88:91], a[64:67], a[60:63], v[88:91]
    s_barrier
    ds_read_b64_tr_b16 a[64:65], v8 offset:0
    v_mfma_f32_16x16x32_bf16 v[36:39], a[68:71], a[32:35], v[36:39]
    s_add_u32 m0, s62, 0
    ds_read_b64_tr_b16 a[66:67], v8 offset:2048
    v_mfma_f32_16x16x32_bf16 v[44:47], a[68:71], a[36:39], v[44:47]
    buffer_load_dwordx4 v18, s[44:47], s52 offen offset:0 lds
    v_mfma_f32_16x16x32_bf16 v[52:55], a[68:71], a[40:43], v[52:55]
    ds_read_b128 a[0:3], v6 offset:0
    v_mfma_f32_16x16x32_bf16 v[60:63], a[68:71], a[44:47], v[60:63]
    v_mfma_f32_16x16x32_bf16 v[68:71], a[68:71], a[48:51], v[68:71]
    v_mfma_f32_16x16x32_bf16 v[76:79], a[68:71], a[52:55], v[76:79]
    buffer_load_dwordx4 v19, s[44:47], s52 offen offset:1024 lds
    v_mfma_f32_16x16x32_bf16 v[84:87], a[68:71], a[56:59], v[84:87]
    s_add_u32 s52, s52, s56
    ds_read_b128 a[4:7], v6 offset:2048
    v_mfma_f32_16x16x32_bf16 v[92:95], a[68:71], a[60:63], v[92:95]
    ds_read_b64_tr_b16 a[68:69], v9 offset:0
    v_mfma_f32_16x16x32_bf16 v[96:99], a[72:75], a[32:35], v[96:99]
    ds_read_b64_tr_b16 a[70:71], v9 offset:2048
    v_mfma_f32_16x16x32_bf16 v[104:107], a[72:75], a[36:39], v[104:107]
    buffer_load_dwordx4 v18, s[44:47], s53 offen offset:2048 lds
    v_mfma_f32_16x16x32_bf16 v[112:115], a[72:75], a[40:43], v[112:115]
    ds_read_b128 a[8:11], v6 offset:4096
    v_mfma_f32_16x16x32_bf16 v[120:123], a[72:75], a[44:47], v[120:123]
    v_mfma_f32_16x16x32_bf16 v[128:131], a[72:75], a[48:51], v[128:131]
    v_mfma_f32_16x16x32_bf16 v[136:139], a[72:75], a[52:55], v[136:139]
    buffer_load_dwordx4 v19, s[44:47], s53 offen offset:3072 lds
    v_mfma_f32_16x16x32_bf16 v[144:147], a[72:75], a[56:59], v[144:147]
    s_add_u32 s53, s53, s56
    ds_read_b128 a[12:15], v6 offset:6144
    v_mfma_f32_16x16x32_bf16 v[152:155], a[72:75], a[60:63], v[152:155]
    ds_read_b64_tr_b16 a[72:73], v10 offset:0
    v_mfma_f32_16x16x32_bf16 v[100:103], a[76:79], a[32:35], v[100:103]
    s_add_u32 m0, s62, 4096
    ds_read_b64_tr_b16 a[74:75], v10 offset:2048
    v_mfma_f32_16x16x32_bf16 v[108:111], a[76:79], a[36:39], v[108:111]
    buffer_load_dwordx4 v20, s[44:47], s54 offen offset:0 lds
    v_mfma_f32_16x16x32_bf16 v[116:119], a[76:79], a[40:43], v[116:119]
    ds_read_b128 a[16:19], v6 offset:8192
    v_mfma_f32_16x16x32_bf16 v[124:127], a[76:79], a[44:47], v[124:127]
    s_xor_b32 s62, s62, 229376
    v_mfma_f32_16x16x32_bf16 v[132:135], a[76:79], a[48:51], v[132:135]
    v_mfma_f32_16x16x32_bf16 v[140:143], a[76:79], a[52:55], v[140:143]
    buffer_load_dwordx4 v21, s[44:47], s54 offen offset:1024 lds
    v_mfma_f32_16x16x32_bf16 v[148:151], a[76:79], a[56:59], v[148:151]
    s_add_u32 s54, s54, s56
    ds_read_b128 a[20:23], v6 offset:10240
    v_mfma_f32_16x16x32_bf16 v[156:159], a[76:79], a[60:63], v[156:159]
    ds_read_b64_tr_b16 a[76:77], v11 offset:0
    v_mfma_f32_16x16x32_bf16 v[160:163], a[80:83], a[32:35], v[160:163]
    ds_read_b64_tr_b16 a[78:79], v11 offset:2048
    v_mfma_f32_16x16x32_bf16 v[168:171], a[80:83], a[36:39], v[168:171]
    buffer_load_dwordx4 v20, s[44:47], s55 offen offset:2048 lds
    v_mfma_f32_16x16x32_bf16 v[176:179], a[80:83], a[40:43], v[176:179]
    ds_read_b128 a[24:27], v6 offset:12288
    v_mfma_f32_16x16x32_bf16 v[184:187], a[80:83], a[44:47], v[184:187]
    v_mfma_f32_16x16x32_bf16 v[192:195], a[80:83], a[48:51], v[192:195]
    v_mfma_f32_16x16x32_bf16 v[200:203], a[80:83], a[52:55], v[200:203]
    buffer_load_dwordx4 v21, s[44:47], s55 offen offset:3072 lds
    v_mfma_f32_16x16x32_bf16 v[208:211], a[80:83], a[56:59], v[208:211]
    s_add_u32 s55, s55, s56
    ds_read_b128 a[28:31], v6 offset:14336
    v_mfma_f32_16x16x32_bf16 v[216:219], a[80:83], a[60:63], v[216:219]
    ds_read_b64_tr_b16 a[80:81], v12 offset:0
    v_mfma_f32_16x16x32_bf16 v[164:167], a[84:87], a[32:35], v[164:167]
    ds_read_b64_tr_b16 a[82:83], v12 offset:2048
    v_mfma_f32_16x16x32_bf16 v[172:175], a[84:87], a[36:39], v[172:175]
    v_mfma_f32_16x16x32_bf16 v[180:183], a[84:87], a[40:43], v[180:183]
    buffer_store_dwordx4 a[172:175], v2, s[24:27], s28 offen sc1
    v_mfma_f32_16x16x32_bf16 v[188:191], a[84:87], a[44:47], v[188:191]
    s_add_u32 s28, s28, s31
    v_mfma_f32_16x16x32_bf16 v[196:199], a[84:87], a[48:51], v[196:199]
    v_mfma_f32_16x16x32_bf16 v[204:207], a[84:87], a[52:55], v[204:207]
    v_mfma_f32_16x16x32_bf16 v[212:215], a[84:87], a[56:59], v[212:215]
    buffer_store_dwordx4 a[176:179], v2, s[24:27], s28 offen sc1
    v_mfma_f32_16x16x32_bf16 v[220:223], a[84:87], a[60:63], v[220:223]
    s_add_u32 s28, s28, s31
    ds_read_b64_tr_b16 a[84:85], v13 offset:0
    v_mfma_f32_16x16x32_bf16 v[224:227], a[88:91], a[32:35], v[224:227]
    ds_read_b64_tr_b16 a[86:87], v13 offset:2048
    v_mfma_f32_16x16x32_bf16 v[232:235], a[88:91], a[36:39], v[232:235]
    v_mfma_f32_16x16x32_bf16 v[240:243], a[88:91], a[40:43], v[240:243]
    buffer_store_dwordx4 a[180:183], v2, s[24:27], s28 offen sc1
    v_mfma_f32_16x16x32_bf16 v[248:251], a[88:91], a[44:47], v[248:251]
    s_add_u32 s28, s28, s31
    v_mfma_f32_16x16x32_bf16 a[96:99], a[88:91], a[48:51], a[96:99]
    v_mfma_f32_16x16x32_bf16 a[104:107], a[88:91], a[52:55], a[104:107]
    v_mfma_f32_16x16x32_bf16 a[112:115], a[88:91], a[56:59], a[112:115]
    buffer_store_dwordx4 a[184:187], v2, s[24:27], s28 offen sc1
    v_mfma_f32_16x16x32_bf16 a[120:123], a[88:91], a[60:63], a[120:123]
    s_add_u32 s28, s28, s31
    ds_read_b64_tr_b16 a[88:89], v14 offset:0
    v_mfma_f32_16x16x32_bf16 v[228:231], a[92:95], a[32:35], v[228:231]
    ds_read_b64_tr_b16 a[90:91], v14 offset:2048
    v_mfma_f32_16x16x32_bf16 v[236:239], a[92:95], a[36:39], v[236:239]
    v_mfma_f32_16x16x32_bf16 v[244:247], a[92:95], a[40:43], v[244:247]
    buffer_store_dwordx4 a[188:191], v2, s[24:27], s28 offen sc1
    v_mfma_f32_16x16x32_bf16 v[252:255], a[92:95], a[44:47], v[252:255]
    s_add_u32 s29, s29, s30
    s_mov_b32 s28, s29
    v_mfma_f32_16x16x32_bf16 a[100:103], a[92:95], a[48:51], a[100:103]
    s_sub_u32 s65, s65, 1
    v_mfma_f32_16x16x32_bf16 a[108:111], a[92:95], a[52:55], a[108:111]
    v_mfma_f32_16x16x32_bf16 a[116:119], a[92:95], a[56:59], a[116:119]
    v_mfma_f32_16x16x32_bf16 a[124:127], a[92:95], a[60:63], a[124:127]
    ds_read_b64_tr_b16 a[92:93], v15 offset:0
    ds_read_b64_tr_b16 a[94:95], v15 offset:2048
    s_cmp_eq_u32 s66, 2
    s_cbranch_scc1 m_hook13
m_hookr14:
    s_waitcnt lgkmcnt(15)
    v_mfma_f32_16x16x32_bf16 v[32:35], a[64:67], a[0:3], v[32:35]
    v_mfma_f32_16x16x32_bf16 v[40:43], a[64:67], a[4:7], v[40:43]
    v_mfma_f32_16x16x32_bf16 v[48:51], a[64:67], a[8:11], v[48:51]
    v_mfma_f32_16x16x32_bf16 v[56:59], a[64:67], a[12:15], v[56:59]
    s_add_u32 m0, s61, 0
    s_waitcnt lgkmcnt(13)
    v_mfma_f32_16x16x32_bf16 v[64:67], a[64:67], a[16:19], v[64:67]
    buffer_load_dwordx4 v16, s[40:43], s48 offen offset:0 lds
    s_waitcnt lgkmcnt(12)
    v_mfma_f32_16x16x32_bf16 v[72:75], a[64:67], a[20:23], v[72:75]
    s_waitcnt lgkmcnt(9)
    v_mfma_f32_16x16x32_bf16 v[80:83], a[64:67], a[24:27], v[80:83]
    s_waitcnt lgkmcnt(8)
    v_mfma_f32_16x16x32_bf16 v[88:91], a[64:67], a[28:31], v[88:91]
    ds_read_b64_tr_b16 a[64:65], v8 offset:16384
    v_mfma_f32_16x16x32_bf16 v[36:39], a[68:71], a[0:3], v[36:39]
    ds_read_b64_tr_b16 a[66:67], v8 offset:18432
    v_mfma_f32_16x16x32_bf16 v[44:47], a[68:71], a[4:7], v[44:47]
    v_mfma_f32_16x16x32_bf16 v[52:55], a[68:71], a[8:11], v[52:55]
    ds_read_b128 a[32:35], v7 offset:0
    v_mfma_f32_16x16x32_bf16 v[60:63], a[68:71], a[12:15], v[60:63]
    v_mfma_f32_16x16x32_bf16 v[68:71], a[68:71], a[16:19], v[68:71]
    buffer_load_dwordx4 v17, s[40:43], s48 offen offset:1024 lds
    v_mfma_f32_16x16x32_bf16 v[76:79], a[68:71], a[20:23], v[76:79]
    s_add_u32 s48, s48, 128
    v_mfma_f32_16x16x32_bf16 v[84:87], a[68:71], a[24:27], v[84:87]
    ds_read_b128 a[36:39], v7 offset:2048
    v_mfma_f32_16x16x32_bf16 v[92:95], a[68:71], a[28:31], v[92:95]
    ds_read_b64_tr_b16 a[68:69], v9 offset:16384
    v_mfma_f32_16x16x32_bf16 v[96:99], a[72:75], a[0:3], v[96:99]
    ds_read_b64_tr_b16 a[70:71], v9 offset:18432
    v_mfma_f32_16x16x32_bf16 v[104:107], a[72:75], a[4:7], v[104:107]
    v_mfma_f32_16x16x32_bf16 v[112:115], a[72:75], a[8:11], v[112:115]
    ds_read_b128 a[40:43], v7 offset:4096
    v_mfma_f32_16x16x32_bf16 v[120:123], a[72:75], a[12:15], v[120:123]
    v_mfma_f32_16x16x32_bf16 v[128:131], a[72:75], a[16:19], v[128:131]
    buffer_load_dwordx4 v16, s[40:43], s49 offen offset:2048 lds
    v_mfma_f32_16x16x32_bf16 v[136:139], a[72:75], a[20:23], v[136:139]
    v_mfma_f32_16x16x32_bf16 v[144:147], a[72:75], a[24:27], v[144:147]
    ds_read_b128 a[44:47], v7 offset:6144
    v_mfma_f32_16x16x32_bf16 v[152:155], a[72:75], a[28:31], v[152:155]
    ds_read_b64_tr_b16 a[72:73], v10 offset:16384
    v_mfma_f32_16x16x32_bf16 v[100:103], a[76:79], a[0:3], v[100:103]
    ds_read_b64_tr_b16 a[74:75], v10 offset:18432
    v_mfma_f32_16x16x32_bf16 v[108:111], a[76:79], a[4:7], v[108:111]
    v_mfma_f32_16x16x32_bf16 v[116:119], a[76:79], a[8:11], v[116:119]
    ds_read_b128 a[48:51], v7 offset:8192
    v_mfma_f32_16x16x32_bf16 v[124:127], a[76:79], a[12:15], v[124:127]
    v_mfma_f32_16x16x32_bf16 v[132:135], a[76:79], a[16:19], v[132:135]
    buffer_load_dwordx4 v17, s[40:43], s49 offen offset:3072 lds
    v_mfma_f32_16x16x32_bf16 v[140:143], a[76:79], a[20:23], v[140:143]
    s_add_u32 s49, s49, 128
    v_mfma_f32_16x16x32_bf16 v[148:151], a[76:79], a[24:27], v[148:151]
    ds_read_b128 a[52:55], v7 offset:10240
    v_mfma_f32_16x16x32_bf16 v[156:159], a[76:79], a[28:31], v[156:159]
    ds_read_b64_tr_b16 a[76:77], v11 offset:16384
    s_waitcnt lgkmcnt(15)
    v_mfma_f32_16x16x32_bf16 v[160:163], a[80:83], a[0:3], v[160:163]
    ds_read_b64_tr_b16 a[78:79], v11 offset:18432
    v_mfma_f32_16x16x32_bf16 v[168:171], a[80:83], a[4:7], v[168:171]
    v_mfma_f32_16x16x32_bf16 v[176:179], a[80:83], a[8:11], v[176:179]
    ds_read_b128 a[56:59], v7 offset:12288
    v_mfma_f32_16x16x32_bf16 v[184:187], a[80:83], a[12:15], v[184:187]
    s_add_u32 m0, s61, 4096
    v_mfma_f32_16x16x32_bf16 v[192:195], a[80:83], a[16:19], v[192:195]
    buffer_load_dwordx4 v16, s[40:43], s50 offen offset:0 lds
    v_mfma_f32_16x16x32_bf16 v[200:203], a[80:83], a[20:23], v[200:203]
    v_mfma_f32_16x16x32_bf16 v[208:211], a[80:83], a[24:27], v[208:211]
    s_add_u32 s61, s61, 32768
    ds_read_b128 a[60:63], v7 offset:14336
    v_mfma_f32_16x16x32_bf16 v[216:219], a[80:83], a[28:31], v[216:219]
    s_cmp_ge_u32 s61, 98304
    s_cselect_b32 s90, 98304, 0
    ds_read_b64_tr_b16 a[80:81], v12 offset:16384
    v_mfma_f32_16x16x32_bf16 v[164:167], a[84:87], a[0:3], v[164:167]
    s_sub_u32 s61, s61, s90
    ds_read_b64_tr_b16 a[82:83], v12 offset:18432
    v_mfma_f32_16x16x32_bf16 v[172:175], a[84:87], a[4:7], v[172:175]
    s_add_u32 s64, s64, 32768
    v_mfma_f32_16x16x32_bf16 v[180:183], a[84:87], a[8:11], v[180:183]
    buffer_store_dwordx4 a[192:195], v2, s[24:27], s28 offen sc1
    v_mfma_f32_16x16x32_bf16 v[188:191], a[84:87], a[12:15], v[188:191]
    s_add_u32 s28, s28, s31
    v_mfma_f32_16x16x32_bf16 v[196:199], a[84:87], a[16:19], v[196:199]
    buffer_load_dwordx4 v17, s[40:43], s50 offen offset:1024 lds
    v_mfma_f32_16x16x32_bf16 v[204:207], a[84:87], a[20:23], v[204:207]
    s_add_u32 s50, s50, 128
    v_mfma_f32_16x16x32_bf16 v[212:215], a[84:87], a[24:27], v[212:215]
    s_cmp_ge_u32 s64, 98304
    s_cselect_b32 s63, 4294901760, s59
    s_cselect_b32 s64, 0, s64
    v_mfma_f32_16x16x32_bf16 v[220:223], a[84:87], a[28:31], v[220:223]
    ds_read_b64_tr_b16 a[84:85], v13 offset:16384
    v_mfma_f32_16x16x32_bf16 v[224:227], a[88:91], a[0:3], v[224:227]
    ds_read_b64_tr_b16 a[86:87], v13 offset:18432
    v_mfma_f32_16x16x32_bf16 v[232:235], a[88:91], a[4:7], v[232:235]
    v_mfma_f32_16x16x32_bf16 v[240:243], a[88:91], a[8:11], v[240:243]
    buffer_store_dwordx4 a[196:199], v2, s[24:27], s28 offen sc1
    v_mfma_f32_16x16x32_bf16 v[248:251], a[88:91], a[12:15], v[248:251]
    s_add_u32 s28, s28, s31
    v_mfma_f32_16x16x32_bf16 a[96:99], a[88:91], a[16:19], a[96:99]
    buffer_load_dwordx4 v16, s[40:43], s51 offen offset:2048 lds
    v_mfma_f32_16x16x32_bf16 a[104:107], a[88:91], a[20:23], a[104:107]
    v_mfma_f32_16x16x32_bf16 a[112:115], a[88:91], a[24:27], a[112:115]
    v_mfma_f32_16x16x32_bf16 a[120:123], a[88:91], a[28:31], a[120:123]
    ds_read_b64_tr_b16 a[88:89], v14 offset:16384
    s_waitcnt lgkmcnt(15)
    v_mfma_f32_16x16x32_bf16 v[228:231], a[92:95], a[0:3], v[228:231]
    ds_read_b64_tr_b16 a[90:91], v14 offset:18432
    v_mfma_f32_16x16x32_bf16 v[236:239], a[92:95], a[4:7], v[236:239]
    v_add_u32 v6, s63, v6
    v_add_u32 v7, s63, v7
    v_mfma_f32_16x16x32_bf16 v[244:247], a[92:95], a[8:11], v[244:247]
    buffer_store_dwordx4 a[200:203], v2, s[24:27], s28 offen sc1
    v_mfma_f32_16x16x32_bf16 v[252:255], a[92:95], a[12:15], v[252:255]
    s_add_u32 s28, s28, s31
    v_mfma_f32_16x16x32_bf16 a[100:103], a[92:95], a[16:19], a[100:103]
    buffer_load_dwordx4 v17, s[40:43], s51 offen offset:3072 lds
    v_mfma_f32_16x16x32_bf16 a[108:111], a[92:95], a[20:23], a[108:111]
    s_add_u32 s51, s51, 128
    v_mfma_f32_16x16x32_bf16 a[116:119], a[92:95], a[24:27], a[116:119]
    v_mfma_f32_16x16x32_bf16 a[124:127], a[92:95], a[28:31], a[124:127]
    ds_read_b64_tr_b16 a[92:93], v15 offset:16384
    ds_read_b64_tr_b16 a[94:95], v15 offset:18432
    v_mfma_f32_16x16x32_bf16 v[32:35], a[64:67], a[32:35], v[32:35]
    v_xor_b32 v8, s60, v8
    v_xor_b32 v9, s60, v9
    v_mfma_f32_16x16x32_bf16 v[40:43], a[64:67], a[36:39], v[40:43]
    v_xor_b32 v10, s60, v10
    v_xor_b32 v11, s60, v11
    s_waitcnt lgkmcnt(15)
    v_mfma_f32_16x16x32_bf16 v[48:51], a[64:67], a[40:43], v[48:51]
    v_xor_b32 v12, s60, v12
    v_xor_b32 v13, s60, v13
    v_mfma_f32_16x16x32_bf16 v[56:59], a[64:67], a[44:47], v[56:59]
    v_xor_b32 v14, s60, v14
    v_xor_b32 v15, s60, v15
    s_waitcnt lgkmcnt(13)
    v_mfma_f32_16x16x32_bf16 v[64:67], a[64:67], a[48:51], v[64:67]
    s_waitcnt lgkmcnt(12)
    v_mfma_f32_16x16x32_bf16 v[72:75], a[64:67], a[52:55], v[72:75]
    s_waitcnt lgkmcnt(9)
    v_mfma_f32_16x16x32_bf16 v[80:83], a[64:67], a[56:59], v[80:83]
    s_waitcnt vmcnt(16) lgkmcnt(0)
    v_mfma_f32_16x16x32_bf16 v[88:91], a[64:67], a[60:63], v[88:91]
    s_barrier
    ds_read_b64_tr_b16 a[64:65], v8 offset:0
    v_mfma_f32_16x16x32_bf16 v[36:39], a[68:71], a[32:35], v[36:39]
    s_add_u32 m0, s62, 0
    ds_read_b64_tr_b16 a[66:67], v8 offset:2048
    v_mfma_f32_16x16x32_bf16 v[44:47], a[68:71], a[36:39], v[44:47]
    buffer_load_dwordx4 v18, s[44:47], s52 offen offset:0 lds
    v_mfma_f32_16x16x32_bf16 v[52:55], a[68:71], a[40:43], v[52:55]
    ds_read_b128 a[0:3], v6 offset:0
    v_mfma_f32_16x16x32_bf16 v[60:63], a[68:71], a[44:47], v[60:63]
    v_mfma_f32_16x16x32_bf16 v[68:71], a[68:71], a[48:51], v[68:71]
    v_mfma_f32_16x16x32_bf16 v[76:79], a[68:71], a[52:55], v[76:79]
    buffer_load_dwordx4 v19, s[44:47], s52 offen offset:1024 lds
    v_mfma_f32_16x16x32_bf16 v[84:87], a[68:71], a[56:59], v[84:87]
    s_add_u32 s52, s52, s56
    ds_read_b128 a[4:7], v6 offset:2048
    v_mfma_f32_16x16x32_bf16 v[92:95], a[68:71], a[60:63], v[92:95]
    ds_read_b64_tr_b16 a[68:69], v9 offset:0
    v_mfma_f32_16x16x32_bf16 v[96:99], a[72:75], a[32:35], v[96:99]
    ds_read_b64_tr_b16 a[70:71], v9 offset:2048
    v_mfma_f32_16x16x32_bf16 v[104:107], a[72:75], a[36:39], v[104:107]
    buffer_load_dwordx4 v18, s[44:47], s53 offen offset:2048 lds
    v_mfma_f32_16x16x32_bf16 v[112:115], a[72:75], a[40:43], v[112:115]
    ds_read_b128 a[8:11], v6 offset:4096
    v_mfma_f32_16x16x32_bf16 v[120:123], a[72:75], a[44:47], v[120:123]
    v_mfma_f32_16x16x32_bf16 v[128:131], a[72:75], a[48:51], v[128:131]
    v_mfma_f32_16x16x32_bf16 v[136:139], a[72:75], a[52:55], v[136:139]
    buffer_load_dwordx4 v19, s[44:47], s53 offen offset:3072 lds
    v_mfma_f32_16x16x32_bf16 v[144:147], a[72:75], a[56:59], v[144:147]
    s_add_u32 s53, s53, s56
    ds_read_b128 a[12:15], v6 offset:6144
    v_mfma_f32_16x16x32_bf16 v[152:155], a[72:75], a[60:63], v[152:155]
    ds_read_b64_tr_b16 a[72:73], v10 offset:0
    v_mfma_f32_16x16x32_bf16 v[100:103], a[76:79], a[32:35], v[100:103]
    s_add_u32 m0, s62, 4096
    ds_read_b64_tr_b16 a[74:75], v10 offset:2048
    v_mfma_f32_16x16x32_bf16 v[108:111], a[76:79], a[36:39], v[108:111]
    buffer_load_dwordx4 v20, s[44:47], s54 offen offset:0 lds
    v_mfma_f32_16x16x32_bf16 v[116:119], a[76:79], a[40:43], v[116:119]
    ds_read_b128 a[16:19], v6 offset:8192
    v_mfma_f32_16x16x32_bf16 v[124:127], a[76:79], a[44:47], v[124:127]
    s_xor_b32 s62, s62, 229376
    v_mfma_f32_16x16x32_bf16 v[132:135], a[76:79], a[48:51], v[132:135]
    v_mfma_f32_16x16x32_bf16 v[140:143], a[76:79], a[52:55], v[140:143]
    buffer_load_dwordx4 v21, s[44:47], s54 offen offset:1024 lds
    v_mfma_f32_16x16x32_bf16 v[148:151], a[76:79], a[56:59], v[148:151]
    s_add_u32 s54, s54, s56
    ds_read_b128 a[20:23], v6 offset:10240
    v_mfma_f32_16x16x32_bf16 v[156:159], a[76:79], a[60:63], v[156:159]
    ds_read_b64_tr_b16 a[76:77], v11 offset:0
    v_mfma_f32_16x16x32_bf16 v[160:163], a[80:83], a[32:35], v[160:163]
    ds_read_b64_tr_b16 a[78:79], v11 offset:2048
    v_mfma_f32_16x16x32_bf16 v[168:171], a[80:83], a[36:39], v[168:171]
    buffer_load_dwordx4 v20, s[44:47], s55 offen offset:2048 lds
    v_mfma_f32_16x16x32_bf16 v[176:179], a[80:83], a[40:43], v[176:179]
    ds_read_b128 a[24:27], v6 offset:12288
    v_mfma_f32_16x16x32_bf16 v[184:187], a[80:83], a[44:47], v[184:187]
    v_mfma_f32_16x16x32_bf16 v[192:195], a[80:83], a[48:51], v[192:195]
    v_mfma_f32_16x16x32_bf16 v[200:203], a[80:83], a[52:55], v[200:203]
    buffer_load_dwordx4 v21, s[44:47], s55 offen offset:3072 lds
    v_mfma_f32_16x16x32_bf16 v[208:211], a[80:83], a[56:59], v[208:211]
    s_add_u32 s55, s55, s56
    ds_read_b128 a[28:31], v6 offset:14336
    v_mfma_f32_16x16x32_bf16 v[216:219], a[80:83], a[60:63], v[216:219]
    ds_read_b64_tr_b16 a[80:81], v12 offset:0
    v_mfma_f32_16x16x32_bf16 v[164:167], a[84:87], a[32:35], v[164:167]
    ds_read_b64_tr_b16 a[82:83], v12 offset:2048
    v_mfma_f32_16x16x32_bf16 v[172:175], a[84:87], a[36:39], v[172:175]
    v_mfma_f32_16x16x32_bf16 v[180:183], a[84:87], a[40:43], v[180:183]
    buffer_store_dwordx4 a[204:207], v2, s[24:27], s28 offen sc1
    v_mfma_f32_16x16x32_bf16 v[188:191], a[84:87], a[44:47], v[188:191]
    s_add_u32 s28, s28, s31
    v_mfma_f32_16x16x32_bf16 v[196:199], a[84:87], a[48:51], v[196:199]
    v_mfma_f32_16x16x32_bf16 v[204:207], a[84:87], a[52:55], v[204:207]
    v_mfma_f32_16x16x32_bf16 v[212:215], a[84:87], a[56:59], v[212:215]
    buffer_store_dwordx4 a[208:211], v2, s[24:27], s28 offen sc1
    v_mfma_f32_16x16x32_bf16 v[220:223], a[84:87], a[60:63], v[220:223]
    s_add_u32 s28, s28, s31
    ds_read_b64_tr_b16 a[84:85], v13 offset:0
    v_mfma_f32_16x16x32_bf16 v[224:227], a[88:91], a[32:35], v[224:227]
    ds_read_b64_tr_b16 a[86:87], v13 offset:2048
    v_mfma_f32_16x16x32_bf16 v[232:235], a[88:91], a[36:39], v[232:235]
    v_mfma_f32_16x16x32_bf16 v[240:243], a[88:91], a[40:43], v[240:243]
    buffer_store_dwordx4 a[212:215], v2, s[24:27], s28 offen sc1
    v_mfma_f32_16x16x32_bf16 v[248:251], a[88:91], a[44:47], v[248:251]
    s_add_u32 s28, s28, s31
    v_mfma_f32_16x16x32_bf16 a[96:99], a[88:91], a[48:51], a[96:99]
    v_mfma_f32_16x16x32_bf16 a[104:107], a[88:91], a[52:55], a[104:107]
    v_mfma_f32_16x16x32_bf16 a[112:115], a[88:91], a[56:59], a[112:115]
    buffer_store_dwordx4 a[216:219], v2, s[24:27], s28 offen sc1
    v_mfma_f32_16x16x32_bf16 a[120:123], a[88:91], a[60:63], a[120:123]
    s_add_u32 s28, s28, s31
    ds_read_b64_tr_b16 a[88:89], v14 offset:0
    v_mfma_f32_16x16x32_bf16 v[228:231], a[92:95], a[32:35], v[228:231]
    ds_read_b64_tr_b16 a[90:91], v14 offset:2048
    v_mfma_f32_16x16x32_bf16 v[236:239], a[92:95], a[36:39], v[236:239]
    v_mfma_f32_16x16x32_bf16 v[244:247], a[92:95], a[40:43], v[244:247]
    buffer_store_dwordx4 a[220:223], v2, s[24:27], s28 offen sc1
    v_mfma_f32_16x16x32_bf16 v[252:255], a[92:95], a[44:47], v[252:255]
    s_add_u32 s29, s29, s30
    s_mov_b32 s28, s29
    v_mfma_f32_16x16x32_bf16 a[100:103], a[92:95], a[48:51], a[100:103]
    s_sub_u32 s65, s65, 1
    v_mfma_f32_16x16x32_bf16 a[108:111], a[92:95], a[52:55], a[108:111]
    v_mfma_f32_16x16x32_bf16 a[116:119], a[92:95], a[56:59], a[116:119]
    v_mfma_f32_16x16x32_bf16 a[124:127], a[92:95], a[60:63], a[124:127]
    ds_read_b64_tr_b16 a[92:93], v15 offset:0
    ds_read_b64_tr_b16 a[94:95], v15 offset:2048
    s_waitcnt lgkmcnt(15)
    v_mfma_f32_16x16x32_bf16 v[32:35], a[64:67], a[0:3], v[32:35]
    v_mfma_f32_16x16x32_bf16 v[40:43], a[64:67], a[4:7], v[40:43]
    v_mfma_f32_16x16x32_bf16 v[48:51], a[64:67], a[8:11], v[48:51]
    v_mfma_f32_16x16x32_bf16 v[56:59], a[64:67], a[12:15], v[56:59]
    s_add_u32 m0, s61, 0
    s_waitcnt lgkmcnt(13)
    v_mfma_f32_16x16x32_bf16 v[64:67], a[64:67], a[16:19], v[64:67]
    buffer_load_dwordx4 v16, s[40:43], s48 offen offset:0 lds
    s_waitcnt lgkmcnt(12)
    v_mfma_f32_16x16x32_bf16 v[72:75], a[64:67], a[20:23], v[72:75]
    s_waitcnt lgkmcnt(9)
    v_mfma_f32_16x16x32_bf16 v[80:83], a[64:67], a[24:27], v[80:83]
    s_waitcnt lgkmcnt(8)
    v_mfma_f32_16x16x32_bf16 v[88:91], a[64:67], a[28:31], v[88:91]
    ds_read_b64_tr_b16 a[64:65], v8 offset:16384
    v_mfma_f32_16x16x32_bf16 v[36:39], a[68:71], a[0:3], v[36:39]
    ds_read_b64_tr_b16 a[66:67], v8 offset:18432
    v_mfma_f32_16x16x32_bf16 v[44:47], a[68:71], a[4:7], v[44:47]
    v_mfma_f32_16x16x32_bf16 v[52:55], a[68:71], a[8:11], v[52:55]
    ds_read_b128 a[32:35], v7 offset:0
    v_mfma_f32_16x16x32_bf16 v[60:63], a[68:71], a[12:15], v[60:63]
    v_mfma_f32_16x16x32_bf16 v[68:71], a[68:71], a[16:19], v[68:71]
    buffer_load_dwordx4 v17, s[40:43], s48 offen offset:1024 lds
    v_mfma_f32_16x16x32_bf16 v[76:79], a[68:71], a[20:23], v[76:79]
    s_add_u32 s48, s48, 128
    v_mfma_f32_16x16x32_bf16 v[84:87], a[68:71], a[24:27], v[84:87]
    ds_read_b128 a[36:39], v7 offset:2048
    v_mfma_f32_16x16x32_bf16 v[92:95], a[68:71], a[28:31], v[92:95]
    ds_read_b64_tr_b16 a[68:69], v9 offset:16384
    v_mfma_f32_16x16x32_bf16 v[96:99], a[72:75], a[0:3], v[96:99]
    ds_read_b64_tr_b16 a[70:71], v9 offset:18432
    v_mfma_f32_16x16x32_bf16 v[104:107], a[72:75], a[4:7], v[104:107]
    v_mfma_f32_16x16x32_bf16 v[112:115], a[72:75], a[8:11], v[112:115]
    ds_read_b128 a[40:43], v7 offset:4096
    v_mfma_f32_16x16x32_bf16 v[120:123], a[72:75], a[12:15], v[120:123]
    v_mfma_f32_16x16x32_bf16 v[128:131], a[72:75], a[16:19], v[128:131]
    buffer_load_dwordx4 v16, s[40:43], s49 offen offset:2048 lds
    v_mfma_f32_16x16x32_bf16 v[136:139], a[72:75], a[20:23], v[136:139]
    v_mfma_f32_16x16x32_bf16 v[144:147], a[72:75], a[24:27], v[144:147]
    ds_read_b128 a[44:47], v7 offset:6144
    v_mfma_f32_16x16x32_bf16 v[152:155], a[72:75], a[28:31], v[152:155]
    ds_read_b64_tr_b16 a[72:73], v10 offset:16384
    v_mfma_f32_16x16x32_bf16 v[100:103], a[76:79], a[0:3], v[100:103]
    ds_read_b64_tr_b16 a[74:75], v10 offset:18432
    v_mfma_f32_16x16x32_bf16 v[108:111], a[76:79], a[4:7], v[108:111]
    v_mfma_f32_16x16x32_bf16 v[116:119], a[76:79], a[8:11], v[116:119]
    ds_read_b128 a[48:51], v7 offset:8192
    v_mfma_f32_16x16x32_bf16 v[124:127], a[76:79], a[12:15], v[124:127]
    v_mfma_f32_16x16x32_bf16 v[132:135], a[76:79], a[16:19], v[132:135]
    buffer_load_dwordx4 v17, s[40:43], s49 offen offset:3072 lds
    v_mfma_f32_16x16x32_bf16 v[140:143], a[76:79], a[20:23], v[140:143]
    s_add_u32 s49, s49, 128
    v_mfma_f32_16x16x32_bf16 v[148:151], a[76:79], a[24:27], v[148:151]
    ds_read_b128 a[52:55], v7 offset:10240
    v_mfma_f32_16x16x32_bf16 v[156:159], a[76:79], a[28:31], v[156:159]
    ds_read_b64_tr_b16 a[76:77], v11 offset:16384
    s_waitcnt lgkmcnt(15)
    v_mfma_f32_16x16x32_bf16 v[160:163], a[80:83], a[0:3], v[160:163]
    ds_read_b64_tr_b16 a[78:79], v11 offset:18432
    v_mfma_f32_16x16x32_bf16 v[168:171], a[80:83], a[4:7], v[168:171]
    v_mfma_f32_16x16x32_bf16 v[176:179], a[80:83], a[8:11], v[176:179]
    ds_read_b128 a[56:59], v7 offset:12288
    v_mfma_f32_16x16x32_bf16 v[184:187], a[80:83], a[12:15], v[184:187]
    s_add_u32 m0, s61, 4096
    v_mfma_f32_16x16x32_bf16 v[192:195], a[80:83], a[16:19], v[192:195]
    buffer_load_dwordx4 v16, s[40:43], s50 offen offset:0 lds
    v_mfma_f32_16x16x32_bf16 v[200:203], a[80:83], a[20:23], v[200:203]
    v_mfma_f32_16x16x32_bf16 v[208:211], a[80:83], a[24:27], v[208:211]
    s_add_u32 s61, s61, 32768
    ds_read_b128 a[60:63], v7 offset:14336
    v_mfma_f32_16x16x32_bf16 v[216:219], a[80:83], a[28:31], v[216:219]
    s_cmp_ge_u32 s61, 98304
    s_cselect_b32 s90, 98304, 0
    ds_read_b64_tr_b16 a[80:81], v12 offset:16384
    v_mfma_f32_16x16x32_bf16 v[164:167], a[84:87], a[0:3], v[164:167]
    s_sub_u32 s61, s61, s90
    ds_read_b64_tr_b16 a[82:83], v12 offset:18432
    v_mfma_f32_16x16x32_bf16 v[172:175], a[84:87], a[4:7], v[172:175]
    s_add_u32 s64, s64, 32768
    v_mfma_f32_16x16x32_bf16 v[180:183], a[84:87], a[8:11], v[180:183]
    buffer_store_dwordx4 a[224:227], v2, s[24:27], s28 offen sc1
    v_mfma_f32_16x16x32_bf16 v[188:191], a[84:87], a[12:15], v[188:191]
    s_add_u32 s28, s28, s31
    v_mfma_f32_16x16x32_bf16 v[196:199], a[84:87], a[16:19], v[196:199]
    buffer_load_dwordx4 v17, s[40:43], s50 offen offset:1024 lds
    v_mfma_f32_16x16x32_bf16 v[204:207], a[84:87], a[20:23], v[204:207]
    s_add_u32 s50, s50, 128
    v_mfma_f32_16x16x32_bf16 v[212:215], a[84:87], a[24:27], v[212:215]
    s_cmp_ge_u32 s64, 98304
    s_cselect_b32 s63, 4294901760, s59
    s_cselect_b32 s64, 0, s64
    v_mfma_f32_16x16x32_bf16 v[220:223], a[84:87], a[28:31], v[220:223]
    ds_read_b64_tr_b16 a[84:85], v13 offset:16384
    v_mfma_f32_16x16x32_bf16 v[224:227], a[88:91], a[0:3], v[224:227]
    ds_read_b64_tr_b16 a[86:87], v13 offset:18432
    v_mfma_f32_16x16x32_bf16 v[232:235], a[88:91], a[4:7], v[232:235]
    v_mfma_f32_16x16x32_bf16 v[240:243], a[88:91], a[8:11], v[240:243]
    buffer_store_dwordx4 a[228:231], v2, s[24:27], s28 offen sc1
    v_mfma_f32_16x16x32_bf16 v[248:251], a[88:91], a[12:15], v[248:251]
    s_add_u32 s28, s28, s31
    v_mfma_f32_16x16x32_bf16 a[96:99], a[88:91], a[16:19], a[96:99]
    buffer_load_dwordx4 v16, s[40:43], s51 offen offset:2048 lds
    v_mfma_f32_16x16x32_bf16 a[104:107], a[88:91], a[20:23], a[104:107]
    v_mfma_f32_16x16x32_bf16 a[112:115], a[88:91], a[24:27], a[112:115]
    v_mfma_f32_16x16x32_bf16 a[120:123], a[88:91], a[28:31], a[120:123]
    ds_read_b64_tr_b16 a[88:89], v14 offset:16384
    s_waitcnt lgkmcnt(15)
    v_mfma_f32_16x16x32_bf16 v[228:231], a[92:95], a[0:3], v[228:231]
    ds_read_b64_tr_b16 a[90:91], v14 offset:18432
    v_mfma_f32_16x16x32_bf16 v[236:239], a[92:95], a[4:7], v[236:239]
    v_add_u32 v6, s63, v6
    v_add_u32 v7, s63, v7
    v_mfma_f32_16x16x32_bf16 v[244:247], a[92:95], a[8:11], v[244:247]
    buffer_store_dwordx4 a[232:235], v2, s[24:27], s28 offen sc1
    v_mfma_f32_16x16x32_bf16 v[252:255], a[92:95], a[12:15], v[252:255]
    s_add_u32 s28, s28, s31
    v_mfma_f32_16x16x32_bf16 a[100:103], a[92:95], a[16:19], a[100:103]
    buffer_load_dwordx4 v17, s[40:43], s51 offen offset:3072 lds
    v_mfma_f32_16x16x32_bf16 a[108:111], a[92:95], a[20:23], a[108:111]
    s_add_u32 s51, s51, 128
    v_mfma_f32_16x16x32_bf16 a[116:119], a[92:95], a[24:27], a[116:119]
    v_mfma_f32_16x16x32_bf16 a[124:127], a[92:95], a[28:31], a[124:127]
    ds_read_b64_tr_b16 a[92:93], v15 offset:16384
    ds_read_b64_tr_b16 a[94:95], v15 offset:18432
    v_mfma_f32_16x16x32_bf16 v[32:35], a[64:67], a[32:35], v[32:35]
    v_xor_b32 v8, s60, v8
    v_xor_b32 v9, s60, v9
    v_mfma_f32_16x16x32_bf16 v[40:43], a[64:67], a[36:39], v[40:43]
    v_xor_b32 v10, s60, v10
    v_xor_b32 v11, s60, v11
    s_waitcnt lgkmcnt(15)
    v_mfma_f32_16x16x32_bf16 v[48:51], a[64:67], a[40:43], v[48:51]
    v_xor_b32 v12, s60, v12
    v_xor_b32 v13, s60, v13
    v_mfma_f32_16x16x32_bf16 v[56:59], a[64:67], a[44:47], v[56:59]
    v_xor_b32 v14, s60, v14
    v_xor_b32 v15, s60, v15
    s_waitcnt lgkmcnt(13)
    v_mfma_f32_16x16x32_bf16 v[64:67], a[64:67], a[48:51], v[64:67]
    s_waitcnt lgkmcnt(12)
    v_mfma_f32_16x16x32_bf16 v[72:75], a[64:67], a[52:55], v[72:75]
    s_waitcnt lgkmcnt(9)
    v_mfma_f32_16x16x32_bf16 v[80:83], a[64:67], a[56:59], v[80:83]
    s_waitcnt vmcnt(16) lgkmcnt(0)
    v_mfma_f32_16x16x32_bf16 v[88:91], a[64:67], a[60:63], v[88:91]
    s_barrier
    ds_read_b64_tr_b16 a[64:65], v8 offset:0
    v_mfma_f32_16x16x32_bf16 v[36:39], a[68:71], a[32:35], v[36:39]
    s_add_u32 m0, s62, 0
    ds_read_b64_tr_b16 a[66:67], v8 offset:2048
    v_mfma_f32_16x16x32_bf16 v[44:47], a[68:71], a[36:39], v[44:47]
    buffer_load_dwordx4 v18, s[44:47], s52 offen offset:0 lds
    v_mfma_f32_16x16x32_bf16 v[52:55], a[68:71], a[40:43], v[52:55]
    ds_read_b128 a[0:3], v6 offset:0
    v_mfma_f32_16x16x32_bf16 v[60:63], a[68:71], a[44:47], v[60:63]
    v_mfma_f32_16x16x32_bf16 v[68:71], a[68:71], a[48:51], v[68:71]
    v_mfma_f32_16x16x32_bf16 v[76:79], a[68:71], a[52:55], v[76:79]
    buffer_load_dwordx4 v19, s[44:47], s52 offen offset:1024 lds
    v_mfma_f32_16x16x32_bf16 v[84:87], a[68:71], a[56:59], v[84:87]
    s_add_u32 s52, s52, s56
    ds_read_b128 a[4:7], v6 offset:2048
    v_mfma_f32_16x16x32_bf16 v[92:95], a[68:71], a[60:63], v[92:95]
    ds_read_b64_tr_b16 a[68:69], v9 offset:0
    v_mfma_f32_16x16x32_bf16 v[96:99], a[72:75], a[32:35], v[96:99]
    ds_read_b64_tr_b16 a[70:71], v9 offset:2048
    v_mfma_f32_16x16x32_bf16 v[104:107], a[72:75], a[36:39], v[104:107]
    buffer_load_dwordx4 v18, s[44:47], s53 offen offset:2048 lds
    v_mfma_f32_16x16x32_bf16 v[112:115], a[72:75], a[40:43], v[112:115]
    ds_read_b128 a[8:11], v6 offset:4096
    v_mfma_f32_16x16x32_bf16 v[120:123], a[72:75], a[44:47], v[120:123]
    v_mfma_f32_16x16x32_bf16 v[128:131], a[72:75], a[48:51], v[128:131]
    v_mfma_f32_16x16x32_bf16 v[136:139], a[72:75], a[52:55], v[136:139]
    buffer_load_dwordx4 v19, s[44:47], s53 offen offset:3072 lds
    v_mfma_f32_16x16x32_bf16 v[144:147], a[72:75], a[56:59], v[144:147]
    s_add_u32 s53, s53, s56
    ds_read_b128 a[12:15], v6 offset:6144
    v_mfma_f32_16x16x32_bf16 v[152:155], a[72:75], a[60:63], v[152:155]
    ds_read_b64_tr_b16 a[72:73], v10 offset:0
    v_mfma_f32_16x16x32_bf16 v[100:103], a[76:79], a[32:35], v[100:103]
    s_add_u32 m0, s62, 4096
    ds_read_b64_tr_b16 a[74:75], v10 offset:2048
    v_mfma_f32_16x16x32_bf16 v[108:111], a[76:79], a[36:39], v[108:111]
    buffer_load_dwordx4 v20, s[44:47], s54 offen offset:0 lds
    v_mfma_f32_16x16x32_bf16 v[116:119], a[76:79], a[40:43], v[116:119]
    ds_read_b128 a[16:19], v6 offset:8192
    v_mfma_f32_16x16x32_bf16 v[124:127], a[76:79], a[44:47], v[124:127]
    s_xor_b32 s62, s62, 229376
    v_mfma_f32_16x16x32_bf16 v[132:135], a[76:79], a[48:51], v[132:135]
    v_mfma_f32_16x16x32_bf16 v[140:143], a[76:79], a[52:55], v[140:143]
    buffer_load_dwordx4 v21, s[44:47], s54 offen offset:1024 lds
    v_mfma_f32_16x16x32_bf16 v[148:151], a[76:79], a[56:59], v[148:151]
    s_add_u32 s54, s54, s56
    ds_read_b128 a[20:23], v6 offset:10240
    v_mfma_f32_16x16x32_bf16 v[156:159], a[76:79], a[60:63], v[156:159]
    ds_read_b64_tr_b16 a[76:77], v11 offset:0
    v_mfma_f32_16x16x32_bf16 v[160:163], a[80:83], a[32:35], v[160:163]
    ds_read_b64_tr_b16 a[78:79], v11 offset:2048
    v_mfma_f32_16x16x32_bf16 v[168:171], a[80:83], a[36:39], v[168:171]
    buffer_load_dwordx4 v20, s[44:47], s55 offen offset:2048 lds
    v_mfma_f32_16x16x32_bf16 v[176:179], a[80:83], a[40:43], v[176:179]
    ds_read_b128 a[24:27], v6 offset:12288
    v_mfma_f32_16x16x32_bf16 v[184:187], a[80:83], a[44:47], v[184:187]
    v_mfma_f32_16x16x32_bf16 v[192:195], a[80:83], a[48:51], v[192:195]
    v_mfma_f32_16x16x32_bf16 v[200:203], a[80:83], a[52:55], v[200:203]
    buffer_load_dwordx4 v21, s[44:47], s55 offen offset:3072 lds
    v_mfma_f32_16x16x32_bf16 v[208:211], a[80:83], a[56:59], v[208:211]
    s_add_u32 s55, s55, s56
    ds_read_b128 a[28:31], v6 offset:14336
    v_mfma_f32_16x16x32_bf16 v[216:219], a[80:83], a[60:63], v[216:219]
    ds_read_b64_tr_b16 a[80:81], v12 offset:0
    v_mfma_f32_16x16x32_bf16 v[164:167], a[84:87], a[32:35], v[164:167]
    ds_read_b64_tr_b16 a[82:83], v12 offset:2048
    v_mfma_f32_16x16x32_bf16 v[172:175], a[84:87], a[36:39], v[172:175]
    v_mfma_f32_16x16x32_bf16 v[180:183], a[84:87], a[40:43], v[180:183]
    buffer_store_dwordx4 a[236:239], v2, s[24:27], s28 offen sc1
    v_mfma_f32_16x16x32_bf16 v[188:191], a[84:87], a[44:47], v[188:191]
    s_add_u32 s28, s28, s31
    v_mfma_f32_16x16x32_bf16 v[196:199], a[84:87], a[48:51], v[196:199]
    v_mfma_f32_16x16x32_bf16 v[204:207], a[84:87], a[52:55], v[204:207]
    v_mfma_f32_16x16x32_bf16 v[212:215], a[84:87], a[56:59], v[212:215]
    buffer_store_dwordx4 a[240:243], v2, s[24:27], s28 offen sc1
    v_mfma_f32_16x16x32_bf16 v[220:223], a[84:87], a[60:63], v[220:223]
    s_add_u32 s28, s28, s31
    ds_read_b64_tr_b16 a[84:85], v13 offset:0
    v_mfma_f32_16x16x32_bf16 v[224:227], a[88:91], a[32:35], v[224:227]
    ds_read_b64_tr_b16 a[86:87], v13 offset:2048
    v_mfma_f32_16x16x32_bf16 v[232:235], a[88:91], a[36:39], v[232:235]
    v_mfma_f32_16x16x32_bf16 v[240:243], a[88:91], a[40:43], v[240:243]
    buffer_store_dwordx4 a[244:247], v2, s[24:27], s28 offen sc1
    v_mfma_f32_16x16x32_bf16 v[248:251], a[88:91], a[44:47], v[248:251]
    s_add_u32 s28, s28, s31
    v_mfma_f32_16x16x32_bf16 a[96:99], a[88:91], a[48:51], a[96:99]
    v_mfma_f32_16x16x32_bf16 a[104:107], a[88:91], a[52:55], a[104:107]
    v_mfma_f32_16x16x32_bf16 a[112:115], a[88:91], a[56:59], a[112:115]
    buffer_store_dwordx4 a[248:251], v2, s[24:27], s28 offen sc1
    v_mfma_f32_16x16x32_bf16 a[120:123], a[88:91], a[60:63], a[120:123]
    s_add_u32 s28, s28, s31
    ds_read_b64_tr_b16 a[88:89], v14 offset:0
    v_mfma_f32_16x16x32_bf16 v[228:231], a[92:95], a[32:35], v[228:231]
    ds_read_b64_tr_b16 a[90:91], v14 offset:2048
    v_mfma_f32_16x16x32_bf16 v[236:239], a[92:95], a[36:39], v[236:239]
    v_mfma_f32_16x16x32_bf16 v[244:247], a[92:95], a[40:43], v[244:247]
    buffer_store_dwordx4 a[252:255], v2, s[24:27], s28 offen sc1
    v_mfma_f32_16x16x32_bf16 v[252:255], a[92:95], a[44:47], v[252:255]
    s_add_u32 s29, s29, s30
    s_mov_b32 s28, s29
    v_mfma_f32_16x16x32_bf16 a[100:103], a[92:95], a[48:51], a[100:103]
    s_sub_u32 s65, s65, 1
    v_mfma_f32_16x16x32_bf16 a[108:111], a[92:95], a[52:55], a[108:111]
    v_mfma_f32_16x16x32_bf16 a[116:119], a[92:95], a[56:59], a[116:119]
    v_mfma_f32_16x16x32_bf16 a[124:127], a[92:95], a[60:63], a[124:127]
    ds_read_b64_tr_b16 a[92:93], v15 offset:0
    ds_read_b64_tr_b16 a[94:95], v15 offset:2048
m_loop15:
    s_waitcnt lgkmcnt(15)
    v_mfma_f32_16x16x32_bf16 v[32:35], a[64:67], a[0:3], v[32:35]
    v_mfma_f32_16x16x32_bf16 v[40:43], a[64:67], a[4:7], v[40:43]
    v_mfma_f32_16x16x32_bf16 v[48:51], a[64:67], a[8:11], v[48:51]
    v_mfma_f32_16x16x32_bf16 v[56:59], a[64:67], a[12:15], v[56:59]
    s_add_u32 m0, s61, 0
    s_waitcnt lgkmcnt(13)
    v_mfma_f32_16x16x32_bf16 v[64:67], a[64:67], a[16:19], v[64:67]
    buffer_load_dwordx4 v16, s[40:43], s48 offen offset:0 lds
    s_waitcnt lgkmcnt(12)
    v_mfma_f32_16x16x32_bf16 v[72:75], a[64:67], a[20:23], v[72:75]
    s_waitcnt lgkmcnt(9)
    v_mfma_f32_16x16x32_bf16 v[80:83], a[64:67], a[24:27], v[80:83]
    s_waitcnt lgkmcnt(8)
    v_mfma_f32_16x16x32_bf16 v[88:91], a[64:67], a[28:31], v[88:91]
    ds_read_b64_tr_b16 a[64:65], v8 offset:16384
    v_mfma_f32_16x16x32_bf16 v[36:39], a[68:71], a[0:3], v[36:39]
    ds_read_b64_tr_b16 a[66:67], v8 offset:18432
    v_mfma_f32_16x16x32_bf16 v[44:47], a[68:71], a[4:7], v[44:47]
    v_mfma_f32_16x16x32_bf16 v[52:55], a[68:71], a[8:11], v[52:55]
    ds_read_b128 a[32:35], v7 offset:0
    v_mfma_f32_16x16x32_bf16 v[60:63], a[68:71], a[12:15], v[60:63]
    v_mfma_f32_16x16x32_bf16 v[68:71], a[68:71], a[16:19], v[68:71]
    buffer_load_dwordx4 v17, s[40:43], s48 offen offset:1024 lds
    v_mfma_f32_16x16x32_bf16 v[76:79], a[68:71], a[20:23], v[76:79]
    s_add_u32 s48, s48, 128
    v_mfma_f32_16x16x32_bf16 v[84:87], a[68:71], a[24:27], v[84:87]
    ds_read_b128 a[36:39], v7 offset:2048
    v_mfma_f32_16x16x32_bf16 v[92:95], a[68:71], a[28:31], v[92:95]
    ds_read_b64_tr_b16 a[68:69], v9 offset:16384
    v_mfma_f32_16x16x32_bf16 v[96:99], a[72:75], a[0:3], v[96:99]
    ds_read_b64_tr_b16 a[70:71], v9 offset:18432
    v_mfma_f32_16x16x32_bf16 v[104:107], a[72:75], a[4:7], v[104:107]
    v_mfma_f32_16x16x32_bf16 v[112:115], a[72:75], a[8:11], v[112:115]
    ds_read_b128 a[40:43], v7 offset:4096
    v_mfma_f32_16x16x32_bf16 v[120:123], a[72:75], a[12:15], v[120:123]
    v_mfma_f32_16x16x32_bf16 v[128:131], a[72:75], a[16:19], v[128:131]
    buffer_load_dwordx4 v16, s[40:43], s49 offen offset:2048 lds
    v_mfma_f32_16x16x32_bf16 v[136:139], a[72:75], a[20:23], v[136:139]
    v_mfma_f32_16x16x32_bf16 v[144:147], a[72:75], a[24:27], v[144:147]
    ds_read_b128 a[44:47], v7 offset:6144
    v_mfma_f32_16x16x32_bf16 v[152:155], a[72:75], a[28:31], v[152:155]
    ds_read_b64_tr_b16 a[72:73], v10 offset:16384
    v_mfma_f32_16x16x32_bf16 v[100:103], a[76:79], a[0:3], v[100:103]
    ds_read_b64_tr_b16 a[74:75], v10 offset:18432
    v_mfma_f32_16x16x32_bf16 v[108:111], a[76:79], a[4:7], v[108:111]
    v_mfma_f32_16x16x32_bf16 v[116:119], a[76:79], a[8:11], v[116:119]
    ds_read_b128 a[48:51], v7 offset:8192
    v_mfma_f32_16x16x32_bf16 v[124:127], a[76:79], a[12:15], v[124:127]
    v_mfma_f32_16x16x32_bf16 v[132:135], a[76:79], a[16:19], v[132:135]
    buffer_load_dwordx4 v17, s[40:43], s49 offen offset:3072 lds
    v_mfma_f32_16x16x32_bf16 v[140:143], a[76:79], a[20:23], v[140:143]
    s_add_u32 s49, s49, 128
    v_mfma_f32_16x16x32_bf16 v[148:151], a[76:79], a[24:27], v[148:151]
    ds_read_b128 a[52:55], v7 offset:10240
    v_mfma_f32_16x16x32_bf16 v[156:159], a[76:79], a[28:31], v[156:159]
    ds_read_b64_tr_b16 a[76:77], v11 offset:16384
    s_waitcnt lgkmcnt(15)
    v_mfma_f32_16x16x32_bf16 v[160:163], a[80:83], a[0:3], v[160:163]
    ds_read_b64_tr_b16 a[78:79], v11 offset:18432
    v_mfma_f32_16x16x32_bf16 v[168:171], a[80:83], a[4:7], v[168:171]
    v_mfma_f32_16x16x32_bf16 v[176:179], a[80:83], a[8:11], v[176:179]
    ds_read_b128 a[56:59], v7 offset:12288
    v_mfma_f32_16x16x32_bf16 v[184:187], a[80:83], a[12:15], v[184:187]
    s_add_u32 m0, s61, 4096
    v_mfma_f32_16x16x32_bf16 v[192:195], a[80:83], a[16:19], v[192:195]
    buffer_load_dwordx4 v16, s[40:43], s50 offen offset:0 lds
    v_mfma_f32_16x16x32_bf16 v[200:203], a[80:83], a[20:23], v[200:203]
    v_mfma_f32_16x16x32_bf16 v[208:211], a[80:83], a[24:27], v[208:211]
    s_add_u32 s61, s61, 32768
    ds_read_b128 a[60:63], v7 offset:14336
    v_mfma_f32_16x16x32_bf16 v[216:219], a[80:83], a[28:31], v[216:219]
    s_cmp_ge_u32 s61, 98304
    s_cselect_b32 s90, 98304, 0
    ds_read_b64_tr_b16 a[80:81], v12 offset:16384
    v_mfma_f32_16x16x32_bf16 v[164:167], a[84:87], a[0:3], v[164:167]
    s_sub_u32 s61, s61, s90
    ds_read_b64_tr_b16 a[82:83], v12 offset:18432
    v_mfma_f32_16x16x32_bf16 v[172:175], a[84:87], a[4:7], v[172:175]
    s_add_u32 s64, s64, 32768
    v_mfma_f32_16x16x32_bf16 v[180:183], a[84:87], a[8:11], v[180:183]
    s_cmp_ge_u32 s64, 98304
    s_cselect_b32 s63, 4294901760, s59
    s_cselect_b32 s64, 0, s64
    v_mfma_f32_16x16x32_bf16 v[188:191], a[84:87], a[12:15], v[188:191]
    v_mfma_f32_16x16x32_bf16 v[196:199], a[84:87], a[16:19], v[196:199]
    buffer_load_dwordx4 v17, s[40:43], s50 offen offset:1024 lds
    v_mfma_f32_16x16x32_bf16 v[204:207], a[84:87], a[20:23], v[204:207]
    s_add_u32 s50, s50, 128
    v_mfma_f32_16x16x32_bf16 v[212:215], a[84:87], a[24:27], v[212:215]
    v_mfma_f32_16x16x32_bf16 v[220:223], a[84:87], a[28:31], v[220:223]
    ds_read_b64_tr_b16 a[84:85], v13 offset:16384
    v_mfma_f32_16x16x32_bf16 v[224:227], a[88:91], a[0:3], v[224:227]
    ds_read_b64_tr_b16 a[86:87], v13 offset:18432
    v_mfma_f32_16x16x32_bf16 v[232:235], a[88:91], a[4:7], v[232:235]
    v_mfma_f32_16x16x32_bf16 v[240:243], a[88:91], a[8:11], v[240:243]
    v_mfma_f32_16x16x32_bf16 v[248:251], a[88:91], a[12:15], v[248:251]
    v_mfma_f32_16x16x32_bf16 a[96:99], a[88:91], a[16:19], a[96:99]
    buffer_load_dwordx4 v16, s[40:43], s51 offen offset:2048 lds
    v_mfma_f32_16x16x32_bf16 a[104:107], a[88:91], a[20:23], a[104:107]
    v_mfma_f32_16x16x32_bf16 a[112:115], a[88:91], a[24:27], a[112:115]
    v_mfma_f32_16x16x32_bf16 a[120:123], a[88:91], a[28:31], a[120:123]
    ds_read_b64_tr_b16 a[88:89], v14 offset:16384
    s_waitcnt lgkmcnt(15)
    v_mfma_f32_16x16x32_bf16 v[228:231], a[92:95], a[0:3], v[228:231]
    ds_read_b64_tr_b16 a[90:91], v14 offset:18432
    v_mfma_f32_16x16x32_bf16 v[236:239], a[92:95], a[4:7], v[236:239]
    v_add_u32 v6, s63, v6
    v_add_u32 v7, s63, v7
    v_mfma_f32_16x16x32_bf16 v[244:247], a[92:95], a[8:11], v[244:247]
    v_mfma_f32_16x16x32_bf16 v[252:255], a[92:95], a[12:15], v[252:255]
    v_mfma_f32_16x16x32_bf16 a[100:103], a[92:95], a[16:19], a[100:103]
    buffer_load_dwordx4 v17, s[40:43], s51 offen offset:3072 lds
    v_mfma_f32_16x16x32_bf16 a[108:111], a[92:95], a[20:23], a[108:111]
    s_add_u32 s51, s51, 128
    v_mfma_f32_16x16x32_bf16 a[116:119], a[92:95], a[24:27], a[116:119]
    v_mfma_f32_16x16x32_bf16 a[124:127], a[92:95], a[28:31], a[124:127]
    ds_read_b64_tr_b16 a[92:93], v15 offset:16384
    ds_read_b64_tr_b16 a[94:95], v15 offset:18432
    v_mfma_f32_16x16x32_bf16 v[32:35], a[64:67], a[32:35], v[32:35]
    v_xor_b32 v8, s60, v8
    v_xor_b32 v9, s60, v9
    v_mfma_f32_16x16x32_bf16 v[40:43], a[64:67], a[36:39], v[40:43]
    v_xor_b32 v10, s60, v10
    v_xor_b32 v11, s60, v11
    s_waitcnt lgkmcnt(15)
    v_mfma_f32_16x16x32_bf16 v[48:51], a[64:67], a[40:43], v[48:51]
    v_xor_b32 v12, s60, v12
    v_xor_b32 v13, s60, v13
    v_mfma_f32_16x16x32_bf16 v[56:59], a[64:67], a[44:47], v[56:59]
    v_xor_b32 v14, s60, v14
    v_xor_b32 v15, s60, v15
    s_waitcnt lgkmcnt(13)
    v_mfma_f32_16x16x32_bf16 v[64:67], a[64:67], a[48:51], v[64:67]
    s_waitcnt lgkmcnt(12)
    v_mfma_f32_16x16x32_bf16 v[72:75], a[64:67], a[52:55], v[72:75]
    s_waitcnt lgkmcnt(9)
    v_mfma_f32_16x16x32_bf16 v[80:83], a[64:67], a[56:59], v[80:83]
    s_waitcnt vmcnt(8) lgkmcnt(0)
    v_mfma_f32_16x16x32_bf16 v[88:91], a[64:67], a[60:63], v[88:91]
    s_barrier
    ds_read_b64_tr_b16 a[64:65], v8 offset:0
    v_mfma_f32_16x16x32_bf16 v[36:39], a[68:71], a[32:35], v[36:39]
    s_add_u32 m0, s62, 0
    ds_read_b64_tr_b16 a[66:67], v8 offset:2048
    v_mfma_f32_16x16x32_bf16 v[44:47], a[68:71], a[36:39], v[44:47]
    buffer_load_dwordx4 v18, s[44:47], s52 offen offset:0 lds
    v_mfma_f32_16x16x32_bf16 v[52:55], a[68:71], a[40:43], v[52:55]
    ds_read_b128 a[0:3], v6 offset:0
    v_mfma_f32_16x16x32_bf16 v[60:63], a[68:71], a[44:47], v[60:63]
    v_mfma_f32_16x16x32_bf16 v[68:71], a[68:71], a[48:51], v[68:71]
    v_mfma_f32_16x16x32_bf16 v[76:79], a[68:71], a[52:55], v[76:79]
    buffer_load_dwordx4 v19, s[44:47], s52 offen offset:1024 lds
    v_mfma_f32_16x16x32_bf16 v[84:87], a[68:71], a[56:59], v[84:87]
    s_add_u32 s52, s52, s56
    ds_read_b128 a[4:7], v6 offset:2048
    v_mfma_f32_16x16x32_bf16 v[92:95], a[68:71], a[60:63], v[92:95]
    ds_read_b64_tr_b16 a[68:69], v9 offset:0
    v_mfma_f32_16x16x32_bf16 v[96:99], a[72:75], a[32:35], v[96:99]
    ds_read_b64_tr_b16 a[70:71], v9 offset:2048
    v_mfma_f32_16x16x32_bf16 v[104:107], a[72:75], a[36:39], v[104:107]
    buffer_load_dwordx4 v18, s[44:47], s53 offen offset:2048 lds
    v_mfma_f32_16x16x32_bf16 v[112:115], a[72:75], a[40:43], v[112:115]
    ds_read_b128 a[8:11], v6 offset:4096
    v_mfma_f32_16x16x32_bf16 v[120:123], a[72:75], a[44:47], v[120:123]
    v_mfma_f32_16x16x32_bf16 v[128:131], a[72:75], a[48:51], v[128:131]
    v_mfma_f32_16x16x32_bf16 v[136:139], a[72:75], a[52:55], v[136:139]
    buffer_load_dwordx4 v19, s[44:47], s53 offen offset:3072 lds
    v_mfma_f32_16x16x32_bf16 v[144:147], a[72:75], a[56:59], v[144:147]
    s_add_u32 s53, s53, s56
    ds_read_b128 a[12:15], v6 offset:6144
    v_mfma_f32_16x16x32_bf16 v[152:155], a[72:75], a[60:63], v[152:155]
    ds_read_b64_tr_b16 a[72:73], v10 offset:0
    v_mfma_f32_16x16x32_bf16 v[100:103], a[76:79], a[32:35], v[100:103]
    s_add_u32 m0, s62, 4096
    ds_read_b64_tr_b16 a[74:75], v10 offset:2048
    v_mfma_f32_16x16x32_bf16 v[108:111], a[76:79], a[36:39], v[108:111]
    buffer_load_dwordx4 v20, s[44:47], s54 offen offset:0 lds
    v_mfma_f32_16x16x32_bf16 v[116:119], a[76:79], a[40:43], v[116:119]
    ds_read_b128 a[16:19], v6 offset:8192
    v_mfma_f32_16x16x32_bf16 v[124:127], a[76:79], a[44:47], v[124:127]
    s_xor_b32 s62, s62, 229376
    v_mfma_f32_16x16x32_bf16 v[132:135], a[76:79], a[48:51], v[132:135]
    v_mfma_f32_16x16x32_bf16 v[140:143], a[76:79], a[52:55], v[140:143]
    buffer_load_dwordx4 v21, s[44:47], s54 offen offset:1024 lds
    v_mfma_f32_16x16x32_bf16 v[148:151], a[76:79], a[56:59], v[148:151]
    s_add_u32 s54, s54, s56
    ds_read_b128 a[20:23], v6 offset:10240
    v_mfma_f32_16x16x32_bf16 v[156:159], a[76:79], a[60:63], v[156:159]
    ds_read_b64_tr_b16 a[76:77], v11 offset:0
    v_mfma_f32_16x16x32_bf16 v[160:163], a[80:83], a[32:35], v[160:163]
    ds_read_b64_tr_b16 a[78:79], v11 offset:2048
    v_mfma_f32_16x16x32_bf16 v[168:171], a[80:83], a[36:39], v[168:171]
    buffer_load_dwordx4 v20, s[44:47], s55 offen offset:2048 lds
    v_mfma_f32_16x16x32_bf16 v[176:179], a[80:83], a[40:43], v[176:179]
    ds_read_b128 a[24:27], v6 offset:12288
    v_mfma_f32_16x16x32_bf16 v[184:187], a[80:83], a[44:47], v[184:187]
    v_mfma_f32_16x16x32_bf16 v[192:195], a[80:83], a[48:51], v[192:195]
    v_mfma_f32_16x16x32_bf16 v[200:203], a[80:83], a[52:55], v[200:203]
    buffer_load_dwordx4 v21, s[44:47], s55 offen offset:3072 lds
    v_mfma_f32_16x16x32_bf16 v[208:211], a[80:83], a[56:59], v[208:211]
    s_add_u32 s55, s55, s56
    ds_read_b128 a[28:31], v6 offset:14336
    v_mfma_f32_16x16x32_bf16 v[216:219], a[80:83], a[60:63], v[216:219]
    ds_read_b64_tr_b16 a[80:81], v12 offset:0
    v_mfma_f32_16x16x32_bf16 v[164:167], a[84:87], a[32:35], v[164:167]
    ds_read_b64_tr_b16 a[82:83], v12 offset:2048
    v_mfma_f32_16x16x32_bf16 v[172:175], a[84:87], a[36:39], v[172:175]
    v_mfma_f32_16x16x32_bf16 v[180:183], a[84:87], a[40:43], v[180:183]
    v_mfma_f32_16x16x32_bf16 v[188:191], a[84:87], a[44:47], v[188:191]
    v_mfma_f32_16x16x32_bf16 v[196:199], a[84:87], a[48:51], v[196:199]
    v_mfma_f32_16x16x32_bf16 v[204:207], a[84:87], a[52:55], v[204:207]
    v_mfma_f32_16x16x32_bf16 v[212:215], a[84:87], a[56:59], v[212:215]
    v_mfma_f32_16x16x32_bf16 v[220:223], a[84:87], a[60:63], v[220:223]
    ds_read_b64_tr_b16 a[84:85], v13 offset:0
    v_mfma_f32_16x16x32_bf16 v[224:227], a[88:91], a[32:35], v[224:227]
    ds_read_b64_tr_b16 a[86:87], v13 offset:2048
    v_mfma_f32_16x16x32_bf16 v[232:235], a[88:91], a[36:39], v[232:235]
    v_mfma_f32_16x16x32_bf16 v[240:243], a[88:91], a[40:43], v[240:243]
    v_mfma_f32_16x16x32_bf16 v[248:251], a[88:91], a[44:47], v[248:251]
    v_mfma_f32_16x16x32_bf16 a[96:99], a[88:91], a[48:51], a[96:99]
    v_mfma_f32_16x16x32_bf16 a[104:107], a[88:91], a[52:55], a[104:107]
    v_mfma_f32_16x16x32_bf16 a[112:115], a[88:91], a[56:59], a[112:115]
    v_mfma_f32_16x16x32_bf16 a[120:123], a[88:91], a[60:63], a[120:123]
    ds_read_b64_tr_b16 a[88:89], v14 offset:0
    v_mfma_f32_16x16x32_bf16 v[228:231], a[92:95], a[32:35], v[228:231]
    ds_read_b64_tr_b16 a[90:91], v14 offset:2048
    v_mfma_f32_16x16x32_bf16 v[236:239], a[92:95], a[36:39], v[236:239]
    v_mfma_f32_16x16x32_bf16 v[244:247], a[92:95], a[40:43], v[244:247]
    v_mfma_f32_16x16x32_bf16 v[252:255], a[92:95], a[44:47], v[252:255]
    v_mfma_f32_16x16x32_bf16 a[100:103], a[92:95], a[48:51], a[100:103]
    s_sub_u32 s65, s65, 1
    v_mfma_f32_16x16x32_bf16 a[108:111], a[92:95], a[52:55], a[108:111]
    v_mfma_f32_16x16x32_bf16 a[116:119], a[92:95], a[56:59], a[116:119]
    s_cmp_gt_u32 s65, s67
    v_mfma_f32_16x16x32_bf16 a[124:127], a[92:95], a[60:63], a[124:127]
    ds_read_b64_tr_b16 a[92:93], v15 offset:0
    ds_read_b64_tr_b16 a[94:95], v15 offset:2048
    s_cbranch_scc1 m_loop15
    s_cmp_lg_u32 s65, 0
    s_cbranch_scc1 m_dosw16
    s_branch m_epi11
m_swp12:
    s_waitcnt lgkmcnt(15)
    v_mfma_f32_16x16x32_bf16 v[32:35], a[0:3], a[64:67], 0
    v_mfma_f32_16x16x32_bf16 v[36:39], a[4:7], a[64:67], 0
    v_mfma_f32_16x16x32_bf16 v[96:99], a[8:11], a[64:67], 0
    v_mfma_f32_16x16x32_bf16 v[100:103], a[12:15], a[64:67], 0
    s_add_u32 m0, s61, 0
    s_waitcnt lgkmcnt(13)
    v_mfma_f32_16x16x32_bf16 v[160:163], a[16:19], a[64:67], 0
    buffer_load_dwordx4 v16, s[40:43], s48 offen offset:0 lds
    s_waitcnt lgkmcnt(12)
    v_mfma_f32_16x16x32_bf16 v[164:167], a[20:23], a[64:67], 0
    s_waitcnt lgkmcnt(9)
    v_mfma_f32_16x16x32_bf16 v[224:227], a[24:27], a[64:67], 0
    s_waitcnt lgkmcnt(8)
    v_mfma_f32_16x16x32_bf16 v[228:231], a[28:31], a[64:67], 0
    ds_read_b64_tr_b16 a[64:65], v8 offset:16384
    v_mfma_f32_16x16x32_bf16 v[40:43], a[0:3], a[68:71], 0
    ds_read_b64_tr_b16 a[66:67], v8 offset:18432
    v_mfma_f32_16x16x32_bf16 v[44:47], a[4:7], a[68:71], 0
    v_mfma_f32_16x16x32_bf16 v[104:107], a[8:11], a[68:71], 0
    ds_read_b128 a[32:35], v7 offset:0
    v_mfma_f32_16x16x32_bf16 v[108:111], a[12:15], a[68:71], 0
    v_mfma_f32_16x16x32_bf16 v[168:171], a[16:19], a[68:71], 0
    buffer_load_dwordx4 v17, s[40:43], s48 offen offset:1024 lds
    v_mfma_f32_16x16x32_bf16 v[172:175], a[20:23], a[68:71], 0
    s_add_u32 s48, s48, 128
    v_mfma_f32_16x16x32_bf16 v[232:235], a[24:27], a[68:71], 0
    ds_read_b128 a[36:39], v7 offset:2048
    v_mfma_f32_16x16x32_bf16 v[236:239], a[28:31], a[68:71], 0
    ds_read_b64_tr_b16 a[68:69], v9 offset:16384
    v_mfma_f32_16x16x32_bf16 v[48:51], a[0:3], a[72:75], 0
    ds_read_b64_tr_b16 a[70:71], v9 offset:18432
    v_mfma_f32_16x16x32_bf16 v[52:55], a[4:7], a[72:75], 0
    v_mfma_f32_16x16x32_bf16 v[112:115], a[8:11], a[72:75], 0
    ds_read_b128 a[40:43], v7 offset:4096
    v_mfma_f32_16x16x32_bf16 v[116:119], a[12:15], a[72:75], 0
    v_mfma_f32_16x16x32_bf16 v[176:179], a[16:19], a[72:75], 0
    buffer_load_dwordx4 v16, s[40:43], s49 offen offset:2048 lds
    v_mfma_f32_16x16x32_bf16 v[180:183], a[20:23], a[72:75], 0
    v_mfma_f32_16x16x32_bf16 v[240:243], a[24:27], a[72:75], 0
    ds_read_b128 a[44:47], v7 offset:6144
    v_mfma_f32_16x16x32_bf16 v[244:247], a[28:31], a[72:75], 0
    ds_read_b64_tr_b16 a[72:73], v10 offset:16384
    v_mfma_f32_16x16x32_bf16 v[56:59], a[0:3], a[76:79], 0
    ds_read_b64_tr_b16 a[74:75], v10 offset:18432
    v_mfma_f32_16x16x32_bf16 v[60:63], a[4:7], a[76:79], 0
    v_mfma_f32_16x16x32_bf16 v[120:123], a[8:11], a[76:79], 0
    ds_read_b128 a[48:51], v7 offset:8192
    v_mfma_f32_16x16x32_bf16 v[124:127], a[12:15], a[76:79], 0
    v_mfma_f32_16x16x32_bf16 v[184:187], a[16:19], a[76:79], 0
    buffer_load_dwordx4 v17, s[40:43], s49 offen offset:3072 lds
    v_mfma_f32_16x16x32_bf16 v[188:191], a[20:23], a[76:79], 0
    s_add_u32 s49, s49, 128
    v_mfma_f32_16x16x32_bf16 v[248:251], a[24:27], a[76:79], 0
    ds_read_b128 a[52:55], v7 offset:10240
    v_mfma_f32_16x16x32_bf16 v[252:255], a[28:31], a[76:79], 0
    ds_read_b64_tr_b16 a[76:77], v11 offset:16384
    s_waitcnt lgkmcnt(15)
    v_mfma_f32_16x16x32_bf16 v[64:67], a[0:3], a[80:83], 0
    ds_read_b64_tr_b16 a[78:79], v11 offset:18432
    v_mfma_f32_16x16x32_bf16 v[68:71], a[4:7], a[80:83], 0
    v_mfma_f32_16x16x32_bf16 v[128:131], a[8:11], a[80:83], 0
    ds_read_b128 a[56:59], v7 offset:12288
    v_mfma_f32_16x16x32_bf16 v[132:135], a[12:15], a[80:83], 0
    s_add_u32 m0, s61, 4096
    v_mfma_f32_16x16x32_bf16 v[192:195], a[16:19], a[80:83], 0
    buffer_load_dwordx4 v16, s[40:43], s50 offen offset:0 lds
    v_mfma_f32_16x16x32_bf16 v[196:199], a[20:23], a[80:83], 0
    v_mfma_f32_16x16x32_bf16 a[96:99], a[24:27], a[80:83], 0
    s_add_u32 s61, s61, 32768
    ds_read_b128 a[60:63], v7 offset:14336
    v_mfma_f32_16x16x32_bf16 a[100:103], a[28:31], a[80:83], 0
    s_cmp_ge_u32 s61, 98304
    s_cselect_b32 s90, 98304, 0
    ds_read_b64_tr_b16 a[80:81], v12 offset:16384
    v_mfma_f32_16x16x32_bf16 v[72:75], a[0:3], a[84:87], 0
    s_sub_u32 s61, s61, s90
    ds_read_b64_tr_b16 a[82:83], v12 offset:18432
    v_mfma_f32_16x16x32_bf16 v[76:79], a[4:7], a[84:87], 0
    s_add_u32 s64, s64, 32768
    v_mfma_f32_16x16x32_bf16 v[136:139], a[8:11], a[84:87], 0
    buffer_store_dwordx4 a[128:131], v2, s[24:27], s28 offen sc1
    v_mfma_f32_16x16x32_bf16 v[140:143], a[12:15], a[84:87], 0
    s_add_u32 s28, s28, s31
    v_mfma_f32_16x16x32_bf16 v[200:203], a[16:19], a[84:87], 0
    buffer_load_dwordx4 v17, s[40:43], s50 offen offset:1024 lds
    v_mfma_f32_16x16x32_bf16 v[204:207], a[20:23], a[84:87], 0
    s_add_u32 s50, s50, 128
    v_mfma_f32_16x16x32_bf16 a[104:107], a[24:27], a[84:87], 0
    s_cmp_ge_u32 s64, 98304
    s_cselect_b32 s63, 4294901760, s59
    s_cselect_b32 s64, 0, s64
    v_mfma_f32_16x16x32_bf16 a[108:111], a[28:31], a[84:87], 0
    ds_read_b64_tr_b16 a[84:85], v13 offset:16384
    v_mfma_f32_16x16x32_bf16 v[80:83], a[0:3], a[88:91], 0
    ds_read_b64_tr_b16 a[86:87], v13 offset:18432
    v_mfma_f32_16x16x32_bf16 v[84:87], a[4:7], a[88:91], 0
    v_mfma_f32_16x16x32_bf16 v[144:147], a[8:11], a[88:91], 0
    buffer_store_dwordx4 a[132:135], v2, s[24:27], s28 offen sc1
    v_mfma_f32_16x16x32_bf16 v[148:151], a[12:15], a[88:91], 0
    s_add_u32 s28, s28, s31
    v_mfma_f32_16x16x32_bf16 v[208:211], a[16:19], a[88:91], 0
    buffer_load_dwordx4 v16, s[40:43], s51 offen offset:2048 lds
    v_mfma_f32_16x16x32_bf16 v[212:215], a[20:23], a[88:91], 0
    v_mfma_f32_16x16x32_bf16 a[112:115], a[24:27], a[88:91], 0
    v_mfma_f32_16x16x32_bf16 a[116:119], a[28:31], a[88:91], 0
    ds_read_b64_tr_b16 a[88:89], v14 offset:16384
    s_waitcnt lgkmcnt(15)
    v_mfma_f32_16x16x32_bf16 v[88:91], a[0:3], a[92:95], 0
    ds_read_b64_tr_b16 a[90:91], v14 offset:18432
    v_mfma_f32_16x16x32_bf16 v[92:95], a[4:7], a[92:95], 0
    v_add_u32 v6, s63, v6
    v_add_u32 v7, s63, v7
    v_mfma_f32_16x16x32_bf16 v[152:155], a[8:11], a[92:95], 0
    buffer_store_dwordx4 a[136:139], v2, s[24:27], s28 offen sc1
    v_mfma_f32_16x16x32_bf16 v[156:159], a[12:15], a[92:95], 0
    s_add_u32 s28, s28, s31
    v_mfma_f32_16x16x32_bf16 v[216:219], a[16:19], a[92:95], 0
    buffer_load_dwordx4 v17, s[40:43], s51 offen offset:3072 lds
    v_mfma_f32_16x16x32_bf16 v[220:223], a[20:23], a[92:95], 0
    s_add_u32 s51, s51, 128
    v_mfma_f32_16x16x32_bf16 a[120:123], a[24:27], a[92:95], 0
    v_mfma_f32_16x16x32_bf16 a[124:127], a[28:31], a[92:95], 0
    ds_read_b64_tr_b16 a[92:93], v15 offset:16384
    ds_read_b64_tr_b16 a[94:95], v15 offset:18432
    v_mfma_f32_16x16x32_bf16 v[32:35], a[32:35], a[64:67], v[32:35]
    v_xor_b32 v8, s60, v8
    v_xor_b32 v9, s60, v9
    v_mfma_f32_16x16x32_bf16 v[36:39], a[36:39], a[64:67], v[36:39]
    v_xor_b32 v10, s60, v10
    v_xor_b32 v11, s60, v11
    s_waitcnt lgkmcnt(15)
    v_mfma_f32_16x16x32_bf16 v[96:99], a[40:43], a[64:67], v[96:99]
    v_xor_b32 v12, s60, v12
    v_xor_b32 v13, s60, v13
    v_mfma_f32_16x16x32_bf16 v[100:103], a[44:47], a[64:67], v[100:103]
    v_xor_b32 v14, s60, v14
    v_xor_b32 v15, s60, v15
    s_waitcnt lgkmcnt(13)
    v_mfma_f32_16x16x32_bf16 v[160:163], a[48:51], a[64:67], v[160:163]
    s_waitcnt lgkmcnt(12)
    v_mfma_f32_16x16x32_bf16 v[164:167], a[52:55], a[64:67], v[164:167]
    s_waitcnt lgkmcnt(9)
    v_mfma_f32_16x16x32_bf16 v[224:227], a[56:59], a[64:67], v[224:227]
    s_waitcnt vmcnt(11) lgkmcnt(0)
    v_mfma_f32_16x16x32_bf16 v[228:231], a[60:63], a[64:67], v[228:231]
    s_barrier
    ds_read_b64_tr_b16 a[64:65], v8 offset:0
    v_mfma_f32_16x16x32_bf16 v[40:43], a[32:35], a[68:71], v[40:43]
    s_add_u32 m0, s62, 0
    ds_read_b64_tr_b16 a[66:67], v8 offset:2048
    v_mfma_f32_16x16x32_bf16 v[44:47], a[36:39], a[68:71], v[44:47]
    buffer_load_dwordx4 v18, s[44:47], s52 offen offset:0 lds
    v_mfma_f32_16x16x32_bf16 v[104:107], a[40:43], a[68:71], v[104:107]
    ds_read_b128 a[0:3], v6 offset:0
    v_mfma_f32_16x16x32_bf16 v[108:111], a[44:47], a[68:71], v[108:111]
    v_mfma_f32_16x16x32_bf16 v[168:171], a[48:51], a[68:71], v[168:171]
    v_mfma_f32_16x16x32_bf16 v[172:175], a[52:55], a[68:71], v[172:175]
    buffer_load_dwordx4 v19, s[44:47], s52 offen offset:1024 lds
    v_mfma_f32_16x16x32_bf16 v[232:235], a[56:59], a[68:71], v[232:235]
    s_add_u32 s52, s52, s56
    ds_read_b128 a[4:7], v6 offset:2048
    v_mfma_f32_16x16x32_bf16 v[236:239], a[60:63], a[68:71], v[236:239]
    ds_read_b64_tr_b16 a[68:69], v9 offset:0
    v_mfma_f32_16x16x32_bf16 v[48:51], a[32:35], a[72:75], v[48:51]
    ds_read_b64_tr_b16 a[70:71], v9 offset:2048
    v_mfma_f32_16x16x32_bf16 v[52:55], a[36:39], a[72:75], v[52:55]
    buffer_load_dwordx4 v18, s[44:47], s53 offen offset:2048 lds
    v_mfma_f32_16x16x32_bf16 v[112:115], a[40:43], a[72:75], v[112:115]
    ds_read_b128 a[8:11], v6 offset:4096
    v_mfma_f32_16x16x32_bf16 v[116:119], a[44:47], a[72:75], v[116:119]
    v_mfma_f32_16x16x32_bf16 v[176:179], a[48:51], a[72:75], v[176:179]
    v_mfma_f32_16x16x32_bf16 v[180:183], a[52:55], a[72:75], v[180:183]
    buffer_load_dwordx4 v19, s[44:47], s53 offen offset:3072 lds
    v_mfma_f32_16x16x32_bf16 v[240:243], a[56:59], a[72:75], v[240:243]
    s_add_u32 s53, s53, s56
    ds_read_b128 a[12:15], v6 offset:6144
    v_mfma_f32_16x16x32_bf16 v[244:247], a[60:63], a[72:75], v[244:247]
    ds_read_b64_tr_b16 a[72:73], v10 offset:0
    v_mfma_f32_16x16x32_bf16 v[56:59], a[32:35], a[76:79], v[56:59]
    s_add_u32 m0, s62, 4096
    ds_read_b64_tr_b16 a[74:75], v10 offset:2048
    v_mfma_f32_16x16x32_bf16 v[60:63], a[36:39], a[76:79], v[60:63]
    buffer_load_dwordx4 v20, s[44:47], s54 offen offset:0 lds
    v_mfma_f32_16x16x32_bf16 v[120:123], a[40:43], a[76:79], v[120:123]
    ds_read_b128 a[16:19], v6 offset:8192
    v_mfma_f32_16x16x32_bf16 v[124:127], a[44:47], a[76:79], v[124:127]
    s_xor_b32 s62, s62, 229376
    v_mfma_f32_16x16x32_bf16 v[184:187], a[48:51], a[76:79], v[184:187]
    v_mfma_f32_16x16x32_bf16 v[188:191], a[52:55], a[76:79], v[188:191]
    buffer_load_dwordx4 v21, s[44:47], s54 offen offset:1024 lds
    v_mfma_f32_16x16x32_bf16 v[248:251], a[56:59], a[76:79], v[248:251]
    s_add_u32 s54, s54, s56
    ds_read_b128 a[20:23], v6 offset:10240
    v_mfma_f32_16x16x32_bf16 v[252:255], a[60:63], a[76:79], v[252:255]
    ds_read_b64_tr_b16 a[76:77], v11 offset:0
    v_mfma_f32_16x16x32_bf16 v[64:67], a[32:35], a[80:83], v[64:67]
    ds_read_b64_tr_b16 a[78:79], v11 offset:2048
    v_mfma_f32_16x16x32_bf16 v[68:71], a[36:39], a[80:83], v[68:71]
    buffer_load_dwordx4 v20, s[44:47], s55 offen offset:2048 lds
    v_mfma_f32_16x16x32_bf16 v[128:131], a[40:43], a[80:83], v[128:131]
    ds_read_b128 a[24:27], v6 offset:12288
    v_mfma_f32_16x16x32_bf16 v[132:135], a[44:47], a[80:83], v[132:135]
    v_mfma_f32_16x16x32_bf16 v[192:195], a[48:51], a[80:83], v[192:195]
    v_mfma_f32_16x16x32_bf16 v[196:199], a[52:55], a[80:83], v[196:199]
    buffer_load_dwordx4 v21, s[44:47], s55 offen offset:3072 lds
    v_mfma_f32_16x16x32_bf16 a[96:99], a[56:59], a[80:83], a[96:99]
    s_add_u32 s55, s55, s56
    ds_read_b128 a[28:31], v6 offset:14336
    v_mfma_f32_16x16x32_bf16 a[100:103], a[60:63], a[80:83], a[100:103]
    ds_read_b64_tr_b16 a[80:81], v12 offset:0
    v_mfma_f32_16x16x32_bf16 v[72:75], a[32:35], a[84:87], v[72:75]
    ds_read_b64_tr_b16 a[82:83], v12 offset:2048
    v_mfma_f32_16x16x32_bf16 v[76:79], a[36:39], a[84:87], v[76:79]
    v_mfma_f32_16x16x32_bf16 v[136:139], a[40:43], a[84:87], v[136:139]
    buffer_store_dwordx4 a[140:143], v2, s[24:27], s28 offen sc1
    v_mfma_f32_16x16x32_bf16 v[140:143], a[44:47], a[84:87], v[140:143]
    s_add_u32 s28, s28, s31
    v_mfma_f32_16x16x32_bf16 v[200:203], a[48:51], a[84:87], v[200:203]
    v_mfma_f32_16x16x32_bf16 v[204:207], a[52:55], a[84:87], v[204:207]
    v_mfma_f32_16x16x32_bf16 a[104:107], a[56:59], a[84:87], a[104:107]
    buffer_store_dwordx4 a[144:147], v2, s[24:27], s28 offen sc1
    v_mfma_f32_16x16x32_bf16 a[108:111], a[60:63], a[84:87], a[108:111]
    s_add_u32 s28, s28, s31
    ds_read_b64_tr_b16 a[84:85], v13 offset:0
    v_mfma_f32_16x16x32_bf16 v[80:83], a[32:35], a[88:91], v[80:83]
    ds_read_b64_tr_b16 a[86:87], v13 offset:2048
    v_mfma_f32_16x16x32_bf16 v[84:87], a[36:39], a[88:91], v[84:87]
    v_mfma_f32_16x16x32_bf16 v[144:147], a[40:43], a[88:91], v[144:147]
    buffer_store_dwordx4 a[148:151], v2, s[24:27], s28 offen sc1
    v_mfma_f32_16x16x32_bf16 v[148:151], a[44:47], a[88:91], v[148:151]
    s_add_u32 s28, s28, s31
    v_mfma_f32_16x16x32_bf16 v[208:211], a[48:51], a[88:91], v[208:211]
    v_mfma_f32_16x16x32_bf16 v[212:215], a[52:55], a[88:91], v[212:215]
    v_mfma_f32_16x16x32_bf16 a[112:115], a[56:59], a[88:91], a[112:115]
    buffer_store_dwordx4 a[152:155], v2, s[24:27], s28 offen sc1
    v_mfma_f32_16x16x32_bf16 a[116:119], a[60:63], a[88:91], a[116:119]
    s_add_u32 s28, s28, s31
    ds_read_b64_tr_b16 a[88:89], v14 offset:0
    v_mfma_f32_16x16x32_bf16 v[88:91], a[32:35], a[92:95], v[88:91]
    ds_read_b64_tr_b16 a[90:91], v14 offset:2048
    v_mfma_f32_16x16x32_bf16 v[92:95], a[36:39], a[92:95], v[92:95]
    v_mfma_f32_16x16x32_bf16 v[152:155], a[40:43], a[92:95], v[152:155]
    buffer_store_dwordx4 a[156:159], v2, s[24:27], s28 offen sc1
    v_mfma_f32_16x16x32_bf16 v[156:159], a[44:47], a[92:95], v[156:159]
    s_add_u32 s29, s29, s30
    s_mov_b32 s28, s29
    v_mfma_f32_16x16x32_bf16 v[216:219], a[48:51], a[92:95], v[216:219]
    s_sub_u32 s65, s65, 1
    v_mfma_f32_16x16x32_bf16 v[220:223], a[52:55], a[92:95], v[220:223]
    v_mfma_f32_16x16x32_bf16 a[120:123], a[56:59], a[92:95], a[120:123]
    v_mfma_f32_16x16x32_bf16 a[124:127], a[60:63], a[92:95], a[124:127]
    ds_read_b64_tr_b16 a[92:93], v15 offset:0
    ds_read_b64_tr_b16 a[94:95], v15 offset:2048
    s_waitcnt lgkmcnt(15)
    v_mfma_f32_16x16x32_bf16 v[32:35], a[0:3], a[64:67], v[32:35]
    v_mfma_f32_16x16x32_bf16 v[36:39], a[4:7], a[64:67], v[36:39]
    v_mfma_f32_16x16x32_bf16 v[96:99], a[8:11], a[64:67], v[96:99]
    v_mfma_f32_16x16x32_bf16 v[100:103], a[12:15], a[64:67], v[100:103]
    s_add_u32 m0, s61, 0
    s_waitcnt lgkmcnt(13)
    v_mfma_f32_16x16x32_bf16 v[160:163], a[16:19], a[64:67], v[160:163]
    buffer_load_dwordx4 v16, s[40:43], s48 offen offset:0 lds
    s_waitcnt lgkmcnt(12)
    v_mfma_f32_16x16x32_bf16 v[164:167], a[20:23], a[64:67], v[164:167]
    s_waitcnt lgkmcnt(9)
    v_mfma_f32_16x16x32_bf16 v[224:227], a[24:27], a[64:67], v[224:227]
    s_waitcnt lgkmcnt(8)
    v_mfma_f32_16x16x32_bf16 v[228:231], a[28:31], a[64:67], v[228:231]
    ds_read_b64_tr_b16 a[64:65], v8 offset:16384
    v_mfma_f32_16x16x32_bf16 v[40:43], a[0:3], a[68:71], v[40:43]
    ds_read_b64_tr_b16 a[66:67], v8 offset:18432
    v_mfma_f32_16x16x32_bf16 v[44:47], a[4:7], a[68:71], v[44:47]
    v_mfma_f32_16x16x32_bf16 v[104:107], a[8:11], a[68:71], v[104:107]
    ds_read_b128 a[32:35], v7 offset:0
    v_mfma_f32_16x16x32_bf16 v[108:111], a[12:15], a[68:71], v[108:111]
    v_mfma_f32_16x16x32_bf16 v[168:171], a[16:19], a[68:71], v[168:171]
    buffer_load_dwordx4 v17, s[40:43], s48 offen offset:1024 lds
    v_mfma_f32_16x16x32_bf16 v[172:175], a[20:23], a[68:71], v[172:175]
    s_add_u32 s48, s48, 128
    v_mfma_f32_16x16x32_bf16 v[232:235], a[24:27], a[68:71], v[232:235]
    ds_read_b128 a[36:39], v7 offset:2048
    v_mfma_f32_16x16x32_bf16 v[236:239], a[28:31], a[68:71], v[236:239]
    ds_read_b64_tr_b16 a[68:69], v9 offset:16384
    v_mfma_f32_16x16x32_bf16 v[48:51], a[0:3], a[72:75], v[48:51]
    ds_read_b64_tr_b16 a[70:71], v9 offset:18432
    v_mfma_f32_16x16x32_bf16 v[52:55], a[4:7], a[72:75], v[52:55]
    v_mfma_f32_16x16x32_bf16 v[112:115], a[8:11], a[72:75], v[112:115]
    ds_read_b128 a[40:43], v7 offset:4096
    v_mfma_f32_16x16x32_bf16 v[116:119], a[12:15], a[72:75], v[116:119]
    v_mfma_f32_16x16x32_bf16 v[176:179], a[16:19], a[72:75], v[176:179]
    buffer_load_dwordx4 v16, s[40:43], s49 offen offset:2048 lds
    v_mfma_f32_16x16x32_bf16 v[180:183], a[20:23], a[72:75], v[180:183]
    v_mfma_f32_16x16x32_bf16 v[240:243], a[24:27], a[72:75], v[240:243]
    ds_read_b128 a[44:47], v7 offset:6144
    v_mfma_f32_16x16x32_bf16 v[244:247], a[28:31], a[72:75], v[244:247]
    ds_read_b64_tr_b16 a[72:73], v10 offset:16384
    v_mfma_f32_16x16x32_bf16 v[56:59], a[0:3], a[76:79], v[56:59]
    ds_read_b64_tr_b16 a[74:75], v10 offset:18432
    v_mfma_f32_16x16x32_bf16 v[60:63], a[4:7], a[76:79], v[60:63]
    v_mfma_f32_16x16x32_bf16 v[120:123], a[8:11], a[76:79], v[120:123]
    ds_read_b128 a[48:51], v7 offset:8192
    v_mfma_f32_16x16x32_bf16 v[124:127], a[12:15], a[76:79], v[124:127]
    v_mfma_f32_16x16x32_bf16 v[184:187], a[16:19], a[76:79], v[184:187]
    buffer_load_dwordx4 v17, s[40:43], s49 offen offset:3072 lds
    v_mfma_f32_16x16x32_bf16 v[188:191], a[20:23], a[76:79], v[188:191]
    s_add_u32 s49, s49, 128
    v_mfma_f32_16x16x32_bf16 v[248:251], a[24:27], a[76:79], v[248:251]
    ds_read_b128 a[52:55], v7 offset:10240
    v_mfma_f32_16x16x32_bf16 v[252:255], a[28:31], a[76:79], v[252:255]
    ds_read_b64_tr_b16 a[76:77], v11 offset:16384
    s_waitcnt lgkmcnt(15)
    v_mfma_f32_16x16x32_bf16 v[64:67], a[0:3], a[80:83], v[64:67]
    ds_read_b64_tr_b16 a[78:79], v11 offset:18432
    v_mfma_f32_16x16x32_bf16 v[68:71], a[4:7], a[80:83], v[68:71]
    v_mfma_f32_16x16x32_bf16 v[128:131], a[8:11], a[80:83], v[128:131]
    ds_read_b128 a[56:59], v7 offset:12288
    v_mfma_f32_16x16x32_bf16 v[132:135], a[12:15], a[80:83], v[132:135]
    s_add_u32 m0, s61, 4096
    v_mfma_f32_16x16x32_bf16 v[192:195], a[16:19], a[80:83], v[192:195]
    buffer_load_dwordx4 v16, s[40:43], s50 offen offset:0 lds
    v_mfma_f32_16x16x32_bf16 v[196:199], a[20:23], a[80:83], v[196:199]
    v_mfma_f32_16x16x32_bf16 a[96:99], a[24:27], a[80:83], a[96:99]
    s_add_u32 s61, s61, 32768
    ds_read_b128 a[60:63], v7 offset:14336
    v_mfma_f32_16x16x32_bf16 a[100:103], a[28:31], a[80:83], a[100:103]
    s_cmp_ge_u32 s61, 98304
    s_cselect_b32 s90, 98304, 0
    ds_read_b64_tr_b16 a[80:81], v12 offset:16384
    v_mfma_f32_16x16x32_bf16 v[72:75], a[0:3], a[84:87], v[72:75]
    s_sub_u32 s61, s61, s90
    ds_read_b64_tr_b16 a[82:83], v12 offset:18432
    v_mfma_f32_16x16x32_bf16 v[76:79], a[4:7], a[84:87], v[76:79]
    s_add_u32 s64, s64, 32768
    v_mfma_f32_16x16x32_bf16 v[136:139], a[8:11], a[84:87], v[136:139]
    buffer_store_dwordx4 a[160:163], v2, s[24:27], s28 offen sc1
    v_mfma_f32_16x16x32_bf16 v[140:143], a[12:15], a[84:87], v[140:143]
    s_add_u32 s28, s28, s31
    v_mfma_f32_16x16x32_bf16 v[200:203], a[16:19], a[84:87], v[200:203]
    buffer_load_dwordx4 v17, s[40:43], s50 offen offset:1024 lds
    v_mfma_f32_16x16x32_bf16 v[204:207], a[20:23], a[84:87], v[204:207]
    s_add_u32 s50, s50, 128
    v_mfma_f32_16x16x32_bf16 a[104:107], a[24:27], a[84:87], a[104:107]
    s_cmp_ge_u32 s64, 98304
    s_cselect_b32 s63, 4294901760, s59
    s_cselect_b32 s64, 0, s64
    v_mfma_f32_16x16x32_bf16 a[108:111], a[28:31], a[84:87], a[108:111]
    ds_read_b64_tr_b16 a[84:85], v13 offset:16384
    v_mfma_f32_16x16x32_bf16 v[80:83], a[0:3], a[88:91], v[80:83]
    ds_read_b64_tr_b16 a[86:87], v13 offset:18432
    v_mfma_f32_16x16x32_bf16 v[84:87], a[4:7], a[88:91], v[84:87]
    v_mfma_f32_16x16x32_bf16 v[144:147], a[8:11], a[88:91], v[144:147]
    buffer_store_dwordx4 a[164:167], v2, s[24:27], s28 offen sc1
    v_mfma_f32_16x16x32_bf16 v[148:151], a[12:15], a[88:91], v[148:151]
    s_add_u32 s28, s28, s31
    v_mfma_f32_16x16x32_bf16 v[208:211], a[16:19], a[88:91], v[208:211]
    buffer_load_dwordx4 v16, s[40:43], s51 offen offset:2048 lds
    v_mfma_f32_16x16x32_bf16 v[212:215], a[20:23], a[88:91], v[212:215]
    v_mfma_f32_16x16x32_bf16 a[112:115], a[24:27], a[88:91], a[112:115]
    v_mfma_f32_16x16x32_bf16 a[116:119], a[28:31], a[88:91], a[116:119]
    ds_read_b64_tr_b16 a[88:89], v14 offset:16384
    s_waitcnt lgkmcnt(15)
    v_mfma_f32_16x16x32_bf16 v[88:91], a[0:3], a[92:95], v[88:91]
    ds_read_b64_tr_b16 a[90:91], v14 offset:18432
    v_mfma_f32_16x16x32_bf16 v[92:95], a[4:7], a[92:95], v[92:95]
    v_add_u32 v6, s63, v6
    v_add_u32 v7, s63, v7
    v_mfma_f32_16x16x32_bf16 v[152:155], a[8:11], a[92:95], v[152:155]
    buffer_store_dwordx4 a[168:171], v2, s[24:27], s28 offen sc1
    v_mfma_f32_16x16x32_bf16 v[156:159], a[12:15], a[92:95], v[156:159]
    s_add_u32 s28, s28, s31
    v_mfma_f32_16x16x32_bf16 v[216:219], a[16:19], a[92:95], v[216:219]
    buffer_load_dwordx4 v17, s[40:43], s51 offen offset:3072 lds
    v_mfma_f32_16x16x32_bf16 v[220:223], a[20:23], a[92:95], v[220:223]
    s_add_u32 s51, s51, 128
    v_mfma_f32_16x16x32_bf16 a[120:123], a[24:27], a[92:95], a[120:123]
    v_mfma_f32_16x16x32_bf16 a[124:127], a[28:31], a[92:95], a[124:127]
    ds_read_b64_tr_b16 a[92:93], v15 offset:16384
    ds_read_b64_tr_b16 a[94:95], v15 offset:18432
    v_mfma_f32_16x16x32_bf16 v[32:35], a[32:35], a[64:67], v[32:35]
    v_xor_b32 v8, s60, v8
    v_xor_b32 v9, s60, v9
    v_mfma_f32_16x16x32_bf16 v[36:39], a[36:39], a[64:67], v[36:39]
    v_xor_b32 v10, s60, v10
    v_xor_b32 v11, s60, v11
    s_waitcnt lgkmcnt(15)
    v_mfma_f32_16x16x32_bf16 v[96:99], a[40:43], a[64:67], v[96:99]
    v_xor_b32 v12, s60, v12
    v_xor_b32 v13, s60, v13
    v_mfma_f32_16x16x32_bf16 v[100:103], a[44:47], a[64:67], v[100:103]
    v_xor_b32 v14, s60, v14
    v_xor_b32 v15, s60, v15
    s_waitcnt lgkmcnt(13)
    v_mfma_f32_16x16x32_bf16 v[160:163], a[48:51], a[64:67], v[160:163]
    s_waitcnt lgkmcnt(12)
    v_mfma_f32_16x16x32_bf16 v[164:167], a[52:55], a[64:67], v[164:167]
    s_waitcnt lgkmcnt(9)
    v_mfma_f32_16x16x32_bf16 v[224:227], a[56:59], a[64:67], v[224:227]
    s_waitcnt vmcnt(16) lgkmcnt(0)
    v_mfma_f32_16x16x32_bf16 v[228:231], a[60:63], a[64:67], v[228:231]
    s_barrier
    ds_read_b64_tr_b16 a[64:65], v8 offset:0
    v_mfma_f32_16x16x32_bf16 v[40:43], a[32:35], a[68:71], v[40:43]
    s_add_u32 m0, s62, 0
    ds_read_b64_tr_b16 a[66:67], v8 offset:2048
    v_mfma_f32_16x16x32_bf16 v[44:47], a[36:39], a[68:71], v[44:47]
    buffer_load_dwordx4 v18, s[44:47], s52 offen offset:0 lds
    v_mfma_f32_16x16x32_bf16 v[104:107], a[40:43], a[68:71], v[104:107]
    ds_read_b128 a[0:3], v6 offset:0
    v_mfma_f32_16x16x32_bf16 v[108:111], a[44:47], a[68:71], v[108:111]
    v_mfma_f32_16x16x32_bf16 v[168:171], a[48:51], a[68:71], v[168:171]
    v_mfma_f32_16x16x32_bf16 v[172:175], a[52:55], a[68:71], v[172:175]
    buffer_load_dwordx4 v19, s[44:47], s52 offen offset:1024 lds
    v_mfma_f32_16x16x32_bf16 v[232:235], a[56:59], a[68:71], v[232:235]
    s_add_u32 s52, s52, s56
    ds_read_b128 a[4:7], v6 offset:2048
    v_mfma_f32_16x16x32_bf16 v[236:239], a[60:63], a[68:71], v[236:239]
    ds_read_b64_tr_b16 a[68:69], v9 offset:0
    v_mfma_f32_16x16x32_bf16 v[48:51], a[32:35], a[72:75], v[48:51]
    ds_read_b64_tr_b16 a[70:71], v9 offset:2048
    v_mfma_f32_16x16x32_bf16 v[52:55], a[36:39], a[72:75], v[52:55]
    buffer_load_dwordx4 v18, s[44:47], s53 offen offset:2048 lds
    v_mfma_f32_16x16x32_bf16 v[112:115], a[40:43], a[72:75], v[112:115]
    ds_read_b128 a[8:11], v6 offset:4096
    v_mfma_f32_16x16x32_bf16 v[116:119], a[44:47], a[72:75], v[116:119]
    v_mfma_f32_16x16x32_bf16 v[176:179], a[48:51], a[72:75], v[176:179]
    v_mfma_f32_16x16x32_bf16 v[180:183], a[52:55], a[72:75], v[180:183]
    buffer_load_dwordx4 v19, s[44:47], s53 offen offset:3072 lds
    v_mfma_f32_16x16x32_bf16 v[240:243], a[56:59], a[72:75], v[240:243]
    s_add_u32 s53, s53, s56
    ds_read_b128 a[12:15], v6 offset:6144
    v_mfma_f32_16x16x32_bf16 v[244:247], a[60:63], a[72:75], v[244:247]
    ds_read_b64_tr_b16 a[72:73], v10 offset:0
    v_mfma_f32_16x16x32_bf16 v[56:59], a[32:35], a[76:79], v[56:59]
    s_add_u32 m0, s62, 4096
    ds_read_b64_tr_b16 a[74:75], v10 offset:2048
    v_mfma_f32_16x16x32_bf16 v[60:63], a[36:39], a[76:79], v[60:63]
    buffer_load_dwordx4 v20, s[44:47], s54 offen offset:0 lds
    v_mfma_f32_16x16x32_bf16 v[120:123], a[40:43], a[76:79], v[120:123]
    ds_read_b128 a[16:19], v6 offset:8192
    v_mfma_f32_16x16x32_bf16 v[124:127], a[44:47], a[76:79], v[124:127]
    s_xor_b32 s62, s62, 229376
    v_mfma_f32_16x16x32_bf16 v[184:187], a[48:51], a[76:79], v[184:187]
    v_mfma_f32_16x16x32_bf16 v[188:191], a[52:55], a[76:79], v[188:191]
    buffer_load_dwordx4 v21, s[44:47], s54 offen offset:1024 lds
    v_mfma_f32_16x16x32_bf16 v[248:251], a[56:59], a[76:79], v[248:251]
    s_add_u32 s54, s54, s56
    ds_read_b128 a[20:23], v6 offset:10240
    v_mfma_f32_16x16x32_bf16 v[252:255], a[60:63], a[76:79], v[252:255]
    ds_read_b64_tr_b16 a[76:77], v11 offset:0
    v_mfma_f32_16x16x32_bf16 v[64:67], a[32:35], a[80:83], v[64:67]
    ds_read_b64_tr_b16 a[78:79], v11 offset:2048
    v_mfma_f32_16x16x32_bf16 v[68:71], a[36:39], a[80:83], v[68:71]
    buffer_load_dwordx4 v20, s[44:47], s55 offen offset:2048 lds
    v_mfma_f32_16x16x32_bf16 v[128:131], a[40:43], a[80:83], v[128:131]
    ds_read_b128 a[24:27], v6 offset:12288
    v_mfma_f32_16x16x32_bf16 v[132:135], a[44:47], a[80:83], v[132:135]
    v_mfma_f32_16x16x32_bf16 v[192:195], a[48:51], a[80:83], v[192:195]
    v_mfma_f32_16x16x32_bf16 v[196:199], a[52:55], a[80:83], v[196:199]
    buffer_load_dwordx4 v21, s[44:47], s55 offen offset:3072 lds
    v_mfma_f32_16x16x32_bf16 a[96:99], a[56:59], a[80:83], a[96:99]
    s_add_u32 s55, s55, s56
    ds_read_b128 a[28:31], v6 offset:14336
    v_mfma_f32_16x16x32_bf16 a[100:103], a[60:63], a[80:83], a[100:103]
    ds_read_b64_tr_b16 a[80:81], v12 offset:0
    v_mfma_f32_16x16x32_bf16 v[72:75], a[32:35], a[84:87], v[72:75]
    ds_read_b64_tr_b16 a[82:83], v12 offset:2048
    v_mfma_f32_16x16x32_bf16 v[76:79], a[36:39], a[84:87], v[76:79]
    v_mfma_f32_16x16x32_bf16 v[136:139], a[40:43], a[84:87], v[136:139]
    buffer_store_dwordx4 a[172:175], v2, s[24:27], s28 offen sc1
    v_mfma_f32_16x16x32_bf16 v[140:143], a[44:47], a[84:87], v[140:143]
    s_add_u32 s28, s28, s31
    v_mfma_f32_16x16x32_bf16 v[200:203], a[48:51], a[84:87], v[200:203]
    v_mfma_f32_16x16x32_bf16 v[204:207], a[52:55], a[84:87], v[204:207]
    v_mfma_f32_16x16x32_bf16 a[104:107], a[56:59], a[84:87], a[104:107]
    buffer_store_dwordx4 a[176:179], v2, s[24:27], s28 offen sc1
    v_mfma_f32_16x16x32_bf16 a[108:111], a[60:63], a[84:87], a[108:111]
    s_add_u32 s28, s28, s31
    ds_read_b64_tr_b16 a[84:85], v13 offset:0
    v_mfma_f32_16x16x32_bf16 v[80:83], a[32:35], a[88:91], v[80:83]
    ds_read_b64_tr_b16 a[86:87], v13 offset:2048
    v_mfma_f32_16x16x32_bf16 v[84:87], a[36:39], a[88:91], v[84:87]
    v_mfma_f32_16x16x32_bf16 v[144:147], a[40:43], a[88:91], v[144:147]
    buffer_store_dwordx4 a[180:183], v2, s[24:27], s28 offen sc1
    v_mfma_f32_16x16x32_bf16 v[148:151], a[44:47], a[88:91], v[148:151]
    s_add_u32 s28, s28, s31
    v_mfma_f32_16x16x32_bf16 v[208:211], a[48:51], a[88:91], v[208:211]
    v_mfma_f32_16x16x32_bf16 v[212:215], a[52:55], a[88:91], v[212:215]
    v_mfma_f32_16x16x32_bf16 a[112:115], a[56:59], a[88:91], a[112:115]
    buffer_store_dwordx4 a[184:187], v2, s[24:27], s28 offen sc1
    v_mfma_f32_16x16x32_bf16 a[116:119], a[60:63], a[88:91], a[116:119]
    s_add_u32 s28, s28, s31
    ds_read_b64_tr_b16 a[88:89], v14 offset:0
    v_mfma_f32_16x16x32_bf16 v[88:91], a[32:35], a[92:95], v[88:91]
    ds_read_b64_tr_b16 a[90:91], v14 offset:2048
    v_mfma_f32_16x16x32_bf16 v[92:95], a[36:39], a[92:95], v[92:95]
    v_mfma_f32_16x16x32_bf16 v[152:155], a[40:43], a[92:95], v[152:155]
    buffer_store_dwordx4 a[188:191], v2, s[24:27], s28 offen sc1
    v_mfma_f32_16x16x32_bf16 v[156:159], a[44:47], a[92:95], v[156:159]
    s_add_u32 s29, s29, s30
    s_mov_b32 s28, s29
    v_mfma_f32_16x16x32_bf16 v[216:219], a[48:51], a[92:95], v[216:219]
    s_sub_u32 s65, s65, 1
    v_mfma_f32_16x16x32_bf16 v[220:223], a[52:55], a[92:95], v[220:223]
    v_mfma_f32_16x16x32_bf16 a[120:123], a[56:59], a[92:95], a[120:123]
    v_mfma_f32_16x16x32_bf16 a[124:127], a[60:63], a[92:95], a[124:127]
    ds_read_b64_tr_b16 a[92:93], v15 offset:0
    ds_read_b64_tr_b16 a[94:95], v15 offset:2048
    s_cmp_eq_u32 s66, 2
    s_cbranch_scc1 m_hook17
m_hookr18:
    s_waitcnt lgkmcnt(15)
    v_mfma_f32_16x16x32_bf16 v[32:35], a[0:3], a[64:67], v[32:35]
    v_mfma_f32_16x16x32_bf16 v[36:39], a[4:7], a[64:67], v[36:39]
    v_mfma_f32_16x16x32_bf16 v[96:99], a[8:11], a[64:67], v[96:99]
    v_mfma_f32_16x16x32_bf16 v[100:103], a[12:15], a[64:67], v[100:103]
    s_add_u32 m0, s61, 0
    s_waitcnt lgkmcnt(13)
    v_mfma_f32_16x16x32_bf16 v[160:163], a[16:19], a[64:67], v[160:163]
    buffer_load_dwordx4 v16, s[40:43], s48 offen offset:0 lds
    s_waitcnt lgkmcnt(12)
    v_mfma_f32_16x16x32_bf16 v[164:167], a[20:23], a[64:67], v[164:167]
    s_waitcnt lgkmcnt(9)
    v_mfma_f32_16x16x32_bf16 v[224:227], a[24:27], a[64:67], v[224:227]
    s_waitcnt lgkmcnt(8)
    v_mfma_f32_16x16x32_bf16 v[228:231], a[28:31], a[64:67], v[228:231]
    ds_read_b64_tr_b16 a[64:65], v8 offset:16384
    v_mfma_f32_16x16x32_bf16 v[40:43], a[0:3], a[68:71], v[40:43]
    ds_read_b64_tr_b16 a[66:67], v8 offset:18432
    v_mfma_f32_16x16x32_bf16 v[44:47], a[4:7], a[68:71], v[44:47]
    v_mfma_f32_16x16x32_bf16 v[104:107], a[8:11], a[68:71], v[104:107]
    ds_read_b128 a[32:35], v7 offset:0
    v_mfma_f32_16x16x32_bf16 v[108:111], a[12:15], a[68:71], v[108:111]
    v_mfma_f32_16x16x32_bf16 v[168:171], a[16:19], a[68:71], v[168:171]
    buffer_load_dwordx4 v17, s[40:43], s48 offen offset:1024 lds
    v_mfma_f32_16x16x32_bf16 v[172:175], a[20:23], a[68:71], v[172:175]
    s_add_u32 s48, s48, 128
    v_mfma_f32_16x16x32_bf16 v[232:235], a[24:27], a[68:71], v[232:235]
    ds_read_b128 a[36:39], v7 offset:2048
    v_mfma_f32_16x16x32_bf16 v[236:239], a[28:31], a[68:71], v[236:239]
    ds_read_b64_tr_b16 a[68:69], v9 offset:16384
    v_mfma_f32_16x16x32_bf16 v[48:51], a[0:3], a[72:75], v[48:51]
    ds_read_b64_tr_b16 a[70:71], v9 offset:18432
    v_mfma_f32_16x16x32_bf16 v[52:55], a[4:7], a[72:75], v[52:55]
    v_mfma_f32_16x16x32_bf16 v[112:115], a[8:11], a[72:75], v[112:115]
    ds_read_b128 a[40:43], v7 offset:4096
    v_mfma_f32_16x16x32_bf16 v[116:119], a[12:15], a[72:75], v[116:119]
    v_mfma_f32_16x16x32_bf16 v[176:179], a[16:19], a[72:75], v[176:179]
    buffer_load_dwordx4 v16, s[40:43], s49 offen offset:2048 lds
    v_mfma_f32_16x16x32_bf16 v[180:183], a[20:23], a[72:75], v[180:183]
    v_mfma_f32_16x16x32_bf16 v[240:243], a[24:27], a[72:75], v[240:243]
    ds_read_b128 a[44:47], v7 offset:6144
    v_mfma_f32_16x16x32_bf16 v[244:247], a[28:31], a[72:75], v[244:247]
    ds_read_b64_tr_b16 a[72:73], v10 offset:16384
    v_mfma_f32_16x16x32_bf16 v[56:59], a[0:3], a[76:79], v[56:59]
    ds_read_b64_tr_b16 a[74:75], v10 offset:18432
    v_mfma_f32_16x16x32_bf16 v[60:63], a[4:7], a[76:79], v[60:63]
    v_mfma_f32_16x16x32_bf16 v[120:123], a[8:11], a[76:79], v[120:123]
    ds_read_b128 a[48:51], v7 offset:8192
    v_mfma_f32_16x16x32_bf16 v[124:127], a[12:15], a[76:79], v[124:127]
    v_mfma_f32_16x16x32_bf16 v[184:187], a[16:19], a[76:79], v[184:187]
    buffer_load_dwordx4 v17, s[40:43], s49 offen offset:3072 lds
    v_mfma_f32_16x16x32_bf16 v[188:191], a[20:23], a[76:79], v[188:191]
    s_add_u32 s49, s49, 128
    v_mfma_f32_16x16x32_bf16 v[248:251], a[24:27], a[76:79], v[248:251]
    ds_read_b128 a[52:55], v7 offset:10240
    v_mfma_f32_16x16x32_bf16 v[252:255], a[28:31], a[76:79], v[252:255]
    ds_read_b64_tr_b16 a[76:77], v11 offset:16384
    s_waitcnt lgkmcnt(15)
    v_mfma_f32_16x16x32_bf16 v[64:67], a[0:3], a[80:83], v[64:67]
    ds_read_b64_tr_b16 a[78:79], v11 offset:18432
    v_mfma_f32_16x16x32_bf16 v[68:71], a[4:7], a[80:83], v[68:71]
    v_mfma_f32_16x16x32_bf16 v[128:131], a[8:11], a[80:83], v[128:131]
    ds_read_b128 a[56:59], v7 offset:12288
    v_mfma_f32_16x16x32_bf16 v[132:135], a[12:15], a[80:83], v[132:135]
    s_add_u32 m0, s61, 4096
    v_mfma_f32_16x16x32_bf16 v[192:195], a[16:19], a[80:83], v[192:195]
    buffer_load_dwordx4 v16, s[40:43], s50 offen offset:0 lds
    v_mfma_f32_16x16x32_bf16 v[196:199], a[20:23], a[80:83], v[196:199]
    v_mfma_f32_16x16x32_bf16 a[96:99], a[24:27], a[80:83], a[96:99]
    s_add_u32 s61, s61, 32768
    ds_read_b128 a[60:63], v7 offset:14336
    v_mfma_f32_16x16x32_bf16 a[100:103], a[28:31], a[80:83], a[100:103]
    s_cmp_ge_u32 s61, 98304
    s_cselect_b32 s90, 98304, 0
    ds_read_b64_tr_b16 a[80:81], v12 offset:16384
    v_mfma_f32_16x16x32_bf16 v[72:75], a[0:3], a[84:87], v[72:75]
    s_sub_u32 s61, s61, s90
    ds_read_b64_tr_b16 a[82:83], v12 offset:18432
    v_mfma_f32_16x16x32_bf16 v[76:79], a[4:7], a[84:87], v[76:79]
    s_add_u32 s64, s64, 32768
    v_mfma_f32_16x16x32_bf16 v[136:139], a[8:11], a[84:87], v[136:139]
    buffer_store_dwordx4 a[192:195], v2, s[24:27], s28 offen sc1
    v_mfma_f32_16x16x32_bf16 v[140:143], a[12:15], a[84:87], v[140:143]
    s_add_u32 s28, s28, s31
    v_mfma_f32_16x16x32_bf16 v[200:203], a[16:19], a[84:87], v[200:203]
    buffer_load_dwordx4 v17, s[40:43], s50 offen offset:1024 lds
    v_mfma_f32_16x16x32_bf16 v[204:207], a[20:23], a[84:87], v[204:207]
    s_add_u32 s50, s50, 128
    v_mfma_f32_16x16x32_bf16 a[104:107], a[24:27], a[84:87], a[104:107]
    s_cmp_ge_u32 s64, 98304
    s_cselect_b32 s63, 4294901760, s59
    s_cselect_b32 s64, 0, s64
    v_mfma_f32_16x16x32_bf16 a[108:111], a[28:31], a[84:87], a[108:111]
    ds_read_b64_tr_b16 a[84:85], v13 offset:16384
    v_mfma_f32_16x16x32_bf16 v[80:83], a[0:3], a[88:91], v[80:83]
    ds_read_b64_tr_b16 a[86:87], v13 offset:18432
    v_mfma_f32_16x16x32_bf16 v[84:87], a[4:7], a[88:91], v[84:87]
    v_mfma_f32_16x16x32_bf16 v[144:147], a[8:11], a[88:91], v[144:147]
    buffer_store_dwordx4 a[196:199], v2, s[24:27], s28 offen sc1
    v_mfma_f32_16x16x32_bf16 v[148:151], a[12:15], a[88:91], v[148:151]
    s_add_u32 s28, s28, s31
    v_mfma_f32_16x16x32_bf16 v[208:211], a[16:19], a[88:91], v[208:211]
    buffer_load_dwordx4 v16, s[40:43], s51 offen offset:2048 lds
    v_mfma_f32_16x16x32_bf16 v[212:215], a[20:23], a[88:91], v[212:215]
    v_mfma_f32_16x16x32_bf16 a[112:115], a[24:27], a[88:91], a[112:115]
    v_mfma_f32_16x16x32_bf16 a[116:119], a[28:31], a[88:91], a[116:119]
    ds_read_b64_tr_b16 a[88:89], v14 offset:16384
    s_waitcnt lgkmcnt(15)
    v_mfma_f32_16x16x32_bf16 v[88:91], a[0:3], a[92:95], v[88:91]
    ds_read_b64_tr_b16 a[90:91], v14 offset:18432
    v_mfma_f32_16x16x32_bf16 v[92:95], a[4:7], a[92:95], v[92:95]
    v_add_u32 v6, s63, v6
    v_add_u32 v7, s63, v7
    v_mfma_f32_16x16x32_bf16 v[152:155], a[8:11], a[92:95], v[152:155]
    buffer_store_dwordx4 a[200:203], v2, s[24:27], s28 offen sc1
    v_mfma_f32_16x16x32_bf16 v[156:159], a[12:15], a[92:95], v[156:159]
    s_add_u32 s28, s28, s31
    v_mfma_f32_16x16x32_bf16 v[216:219], a[16:19], a[92:95], v[216:219]
    buffer_load_dwordx4 v17, s[40:43], s51 offen offset:3072 lds
    v_mfma_f32_16x16x32_bf16 v[220:223], a[20:23], a[92:95], v[220:223]
    s_add_u32 s51, s51, 128
    v_mfma_f32_16x16x32_bf16 a[120:123], a[24:27], a[92:95], a[120:123]
    v_mfma_f32_16x16x32_bf16 a[124:127], a[28:31], a[92:95], a[124:127]
    ds_read_b64_tr_b16 a[92:93], v15 offset:16384
    ds_read_b64_tr_b16 a[94:95], v15 offset:18432
    v_mfma_f32_16x16x32_bf16 v[32:35], a[32:35], a[64:67], v[32:35]
    v_xor_b32 v8, s60, v8
    v_xor_b32 v9, s60, v9
    v_mfma_f32_16x16x32_bf16 v[36:39], a[36:39], a[64:67], v[36:39]
    v_xor_b32 v10, s60, v10
    v_xor_b32 v11, s60, v11
    s_waitcnt lgkmcnt(15)
    v_mfma_f32_16x16x32_bf16 v[96:99], a[40:43], a[64:67], v[96:99]
    v_xor_b32 v12, s60, v12
    v_xor_b32 v13, s60, v13
    v_mfma_f32_16x16x32_bf16 v[100:103], a[44:47], a[64:67], v[100:103]
    v_xor_b32 v14, s60, v14
    v_xor_b32 v15, s60, v15
    s_waitcnt lgkmcnt(13)
    v_mfma_f32_16x16x32_bf16 v[160:163], a[48:51], a[64:67], v[160:163]
    s_waitcnt lgkmcnt(12)
    v_mfma_f32_16x16x32_bf16 v[164:167], a[52:55], a[64:67], v[164:167]
    s_waitcnt lgkmcnt(9)
    v_mfma_f32_16x16x32_bf16 v[224:227], a[56:59], a[64:67], v[224:227]
    s_waitcnt vmcnt(16) lgkmcnt(0)
    v_mfma_f32_16x16x32_bf16 v[228:231], a[60:63], a[64:67], v[228:231]
    s_barrier
    ds_read_b64_tr_b16 a[64:65], v8 offset:0
    v_mfma_f32_16x16x32_bf16 v[40:43], a[32:35], a[68:71], v[40:43]
    s_add_u32 m0, s62, 0
    ds_read_b64_tr_b16 a[66:67], v8 offset:2048
    v_mfma_f32_16x16x32_bf16 v[44:47], a[36:39], a[68:71], v[44:47]
    buffer_load_dwordx4 v18, s[44:47], s52 offen offset:0 lds
    v_mfma_f32_16x16x32_bf16 v[104:107], a[40:43], a[68:71], v[104:107]
    ds_read_b128 a[0:3], v6 offset:0
    v_mfma_f32_16x16x32_bf16 v[108:111], a[44:47], a[68:71], v[108:111]
    v_mfma_f32_16x16x32_bf16 v[168:171], a[48:51], a[68:71], v[168:171]
    v_mfma_f32_16x16x32_bf16 v[172:175], a[52:55], a[68:71], v[172:175]
    buffer_load_dwordx4 v19, s[44:47], s52 offen offset:1024 lds
    v_mfma_f32_16x16x32_bf16 v[232:235], a[56:59], a[68:71], v[232:235]
    s_add_u32 s52, s52, s56
    ds_read_b128 a[4:7], v6 offset:2048
    v_mfma_f32_16x16x32_bf16 v[236:239], a[60:63], a[68:71], v[236:239]
    ds_read_b64_tr_b16 a[68:69], v9 offset:0
    v_mfma_f32_16x16x32_bf16 v[48:51], a[32:35], a[72:75], v[48:51]
    ds_read_b64_tr_b16 a[70:71], v9 offset:2048
    v_mfma_f32_16x16x32_bf16 v[52:55], a[36:39], a[72:75], v[52:55]
    buffer_load_dwordx4 v18, s[44:47], s53 offen offset:2048 lds
    v_mfma_f32_16x16x32_bf16 v[112:115], a[40:43], a[72:75], v[112:115]
    ds_read_b128 a[8:11], v6 offset:4096
    v_mfma_f32_16x16x32_bf16 v[116:119], a[44:47], a[72:75], v[116:119]
    v_mfma_f32_16x16x32_bf16 v[176:179], a[48:51], a[72:75], v[176:179]
    v_mfma_f32_16x16x32_bf16 v[180:183], a[52:55], a[72:75], v[180:183]
    buffer_load_dwordx4 v19, s[44:47], s53 offen offset:3072 lds
    v_mfma_f32_16x16x32_bf16 v[240:243], a[56:59], a[72:75], v[240:243]
    s_add_u32 s53, s53, s56
    ds_read_b128 a[12:15], v6 offset:6144
    v_mfma_f32_16x16x32_bf16 v[244:247], a[60:63], a[72:75], v[244:247]
    ds_read_b64_tr_b16 a[72:73], v10 offset:0
    v_mfma_f32_16x16x32_bf16 v[56:59], a[32:35], a[76:79], v[56:59]
    s_add_u32 m0, s62, 4096
    ds_read_b64_tr_b16 a[74:75], v10 offset:2048
    v_mfma_f32_16x16x32_bf16 v[60:63], a[36:39], a[76:79], v[60:63]
    buffer_load_dwordx4 v20, s[44:47], s54 offen offset:0 lds
    v_mfma_f32_16x16x32_bf16 v[120:123], a[40:43], a[76:79], v[120:123]
    ds_read_b128 a[16:19], v6 offset:8192
    v_mfma_f32_16x16x32_bf16 v[124:127], a[44:47], a[76:79], v[124:127]
    s_xor_b32 s62, s62, 229376
    v_mfma_f32_16x16x32_bf16 v[184:187], a[48:51], a[76:79], v[184:187]
    v_mfma_f32_16x16x32_bf16 v[188:191], a[52:55], a[76:79], v[188:191]
    buffer_load_dwordx4 v21, s[44:47], s54 offen offset:1024 lds
    v_mfma_f32_16x16x32_bf16 v[248:251], a[56:59], a[76:79], v[248:251]
    s_add_u32 s54, s54, s56
    ds_read_b128 a[20:23], v6 offset:10240
    v_mfma_f32_16x16x32_bf16 v[252:255], a[60:63], a[76:79], v[252:255]
    ds_read_b64_tr_b16 a[76:77], v11 offset:0
    v_mfma_f32_16x16x32_bf16 v[64:67], a[32:35], a[80:83], v[64:67]
    ds_read_b64_tr_b16 a[78:79], v11 offset:2048
    v_mfma_f32_16x16x32_bf16 v[68:71], a[36:39], a[80:83], v[68:71]
    buffer_load_dwordx4 v20, s[44:47], s55 offen offset:2048 lds
    v_mfma_f32_16x16x32_bf16 v[128:131], a[40:43], a[80:83], v[128:131]
    ds_read_b128 a[24:27], v6 offset:12288
    v_mfma_f32_16x16x32_bf16 v[132:135], a[44:47], a[80:83], v[132:135]
    v_mfma_f32_16x16x32_bf16 v[192:195], a[48:51], a[80:83], v[192:195]
    v_mfma_f32_16x16x32_bf16 v[196:199], a[52:55], a[80:83], v[196:199]
    buffer_load_dwordx4 v21, s[44:47], s55 offen offset:3072 lds
    v_mfma_f32_16x16x32_bf16 a[96:99], a[56:59], a[80:83], a[96:99]
    s_add_u32 s55, s55, s56
    ds_read_b128 a[28:31], v6 offset:14336
    v_mfma_f32_16x16x32_bf16 a[100:103], a[60:63], a[80:83], a[100:103]
    ds_read_b64_tr_b16 a[80:81], v12 offset:0
    v_mfma_f32_16x16x32_bf16 v[72:75], a[32:35], a[84:87], v[72:75]
    ds_read_b64_tr_b16 a[82:83], v12 offset:2048
    v_mfma_f32_16x16x32_bf16 v[76:79], a[36:39], a[84:87], v[76:79]
    v_mfma_f32_16x16x32_bf16 v[136:139], a[40:43], a[84:87], v[136:139]
    buffer_store_dwordx4 a[204:207], v2, s[24:27], s28 offen sc1
    v_mfma_f32_16x16x32_bf16 v[140:143], a[44:47], a[84:87], v[140:143]
    s_add_u32 s28, s28, s31
    v_mfma_f32_16x16x32_bf16 v[200:203], a[48:51], a[84:87], v[200:203]
    v_mfma_f32_16x16x32_bf16 v[204:207], a[52:55], a[84:87], v[204:207]
    v_mfma_f32_16x16x32_bf16 a[104:107], a[56:59], a[84:87], a[104:107]
    buffer_store_dwordx4 a[208:211], v2, s[24:27], s28 offen sc1
    v_mfma_f32_16x16x32_bf16 a[108:111], a[60:63], a[84:87], a[108:111]
    s_add_u32 s28, s28, s31
    ds_read_b64_tr_b16 a[84:85], v13 offset:0
    v_mfma_f32_16x16x32_bf16 v[80:83], a[32:35], a[88:91], v[80:83]
    ds_read_b64_tr_b16 a[86:87], v13 offset:2048
    v_mfma_f32_16x16x32_bf16 v[84:87], a[36:39], a[88:91], v[84:87]
    v_mfma_f32_16x16x32_bf16 v[144:147], a[40:43], a[88:91], v[144:147]
    buffer_store_dwordx4 a[212:215], v2, s[24:27], s28 offen sc1
    v_mfma_f32_16x16x32_bf16 v[148:151], a[44:47], a[88:91], v[148:151]
    s_add_u32 s28, s28, s31
    v_mfma_f32_16x16x32_bf16 v[208:211], a[48:51], a[88:91], v[208:211]
    v_mfma_f32_16x16x32_bf16 v[212:215], a[52:55], a[88:91], v[212:215]
    v_mfma_f32_16x16x32_bf16 a[112:115], a[56:59], a[88:91], a[112:115]
    buffer_store_dwordx4 a[216:219], v2, s[24:27], s28 offen sc1
    v_mfma_f32_16x16x32_bf16 a[116:119], a[60:63], a[88:91], a[116:119]
    s_add_u32 s28, s28, s31
    ds_read_b64_tr_b16 a[88:89], v14 offset:0
    v_mfma_f32_16x16x32_bf16 v[88:91], a[32:35], a[92:95], v[88:91]
    ds_read_b64_tr_b16 a[90:91], v14 offset:2048
    v_mfma_f32_16x16x32_bf16 v[92:95], a[36:39], a[92:95], v[92:95]
    v_mfma_f32_16x16x32_bf16 v[152:155], a[40:43], a[92:95], v[152:155]
    buffer_store_dwordx4 a[220:223], v2, s[24:27], s28 offen sc1
    v_mfma_f32_16x16x32_bf16 v[156:159], a[44:47], a[92:95], v[156:159]
    s_add_u32 s29, s29, s30
    s_mov_b32 s28, s29
    v_mfma_f32_16x16x32_bf16 v[216:219], a[48:51], a[92:95], v[216:219]
    s_sub_u32 s65, s65, 1
    v_mfma_f32_16x16x32_bf16 v[220:223], a[52:55], a[92:95], v[220:223]
    v_mfma_f32_16x16x32_bf16 a[120:123], a[56:59], a[92:95], a[120:123]
    v_mfma_f32_16x16x32_bf16 a[124:127], a[60:63], a[92:95], a[124:127]
    ds_read_b64_tr_b16 a[92:93], v15 offset:0
    ds_read_b64_tr_b16 a[94:95], v15 offset:2048
    s_waitcnt lgkmcnt(15)
    v_mfma_f32_16x16x32_bf16 v[32:35], a[0:3], a[64:67], v[32:35]
    v_mfma_f32_16x16x32_bf16 v[36:39], a[4:7], a[64:67], v[36:39]
    v_mfma_f32_16x16x32_bf16 v[96:99], a[8:11], a[64:67], v[96:99]
    v_mfma_f32_16x16x32_bf16 v[100:103], a[12:15], a[64:67], v[100:103]
    s_add_u32 m0, s61, 0
    s_waitcnt lgkmcnt(13)
    v_mfma_f32_16x16x32_bf16 v[160:163], a[16:19], a[64:67], v[160:163]
    buffer_load_dwordx4 v16, s[40:43], s48 offen offset:0 lds
    s_waitcnt lgkmcnt(12)
    v_mfma_f32_16x16x32_bf16 v[164:167], a[20:23], a[64:67], v[164:167]
    s_waitcnt lgkmcnt(9)
    v_mfma_f32_16x16x32_bf16 v[224:227], a[24:27], a[64:67], v[224:227]
    s_waitcnt lgkmcnt(8)
    v_mfma_f32_16x16x32_bf16 v[228:231], a[28:31], a[64:67], v[228:231]
    ds_read_b64_tr_b16 a[64:65], v8 offset:16384
    v_mfma_f32_16x16x32_bf16 v[40:43], a[0:3], a[68:71], v[40:43]
    ds_read_b64_tr_b16 a[66:67], v8 offset:18432
    v_mfma_f32_16x16x32_bf16 v[44:47], a[4:7], a[68:71], v[44:47]
    v_mfma_f32_16x16x32_bf16 v[104:107], a[8:11], a[68:71], v[104:107]
    ds_read_b128 a[32:35], v7 offset:0
    v_mfma_f32_16x16x32_bf16 v[108:111], a[12:15], a[68:71], v[108:111]
    v_mfma_f32_16x16x32_bf16 v[168:171], a[16:19], a[68:71], v[168:171]
    buffer_load_dwordx4 v17, s[40:43], s48 offen offset:1024 lds
    v_mfma_f32_16x16x32_bf16 v[172:175], a[20:23], a[68:71], v[172:175]
    s_add_u32 s48, s48, 128
    v_mfma_f32_16x16x32_bf16 v[232:235], a[24:27], a[68:71], v[232:235]
    ds_read_b128 a[36:39], v7 offset:2048
    v_mfma_f32_16x16x32_bf16 v[236:239], a[28:31], a[68:71], v[236:239]
    ds_read_b64_tr_b16 a[68:69], v9 offset:16384
    v_mfma_f32_16x16x32_bf16 v[48:51], a[0:3], a[72:75], v[48:51]
    ds_read_b64_tr_b16 a[70:71], v9 offset:18432
    v_mfma_f32_16x16x32_bf16 v[52:55], a[4:7], a[72:75], v[52:55]
    v_mfma_f32_16x16x32_bf16 v[112:115], a[8:11], a[72:75], v[112:115]
    ds_read_b128 a[40:43], v7 offset:4096
    v_mfma_f32_16x16x32_bf16 v[116:119], a[12:15], a[72:75], v[116:119]
    v_mfma_f32_16x16x32_bf16 v[176:179], a[16:19], a[72:75], v[176:179]
    buffer_load_dwordx4 v16, s[40:43], s49 offen offset:2048 lds
    v_mfma_f32_16x16x32_bf16 v[180:183], a[20:23], a[72:75], v[180:183]
    v_mfma_f32_16x16x32_bf16 v[240:243], a[24:27], a[72:75], v[240:243]
    ds_read_b128 a[44:47], v7 offset:6144
    v_mfma_f32_16x16x32_bf16 v[244:247], a[28:31], a[72:75], v[244:247]
    ds_read_b64_tr_b16 a[72:73], v10 offset:16384
    v_mfma_f32_16x16x32_bf16 v[56:59], a[0:3], a[76:79], v[56:59]
    ds_read_b64_tr_b16 a[74:75], v10 offset:18432
    v_mfma_f32_16x16x32_bf16 v[60:63], a[4:7], a[76:79], v[60:63]
    v_mfma_f32_16x16x32_bf16 v[120:123], a[8:11], a[76:79], v[120:123]
    ds_read_b128 a[48:51], v7 offset:8192
    v_mfma_f32_16x16x32_bf16 v[124:127], a[12:15], a[76:79], v[124:127]
    v_mfma_f32_16x16x32_bf16 v[184:187], a[16:19], a[76:79], v[184:187]
    buffer_load_dwordx4 v17, s[40:43], s49 offen offset:3072 lds
    v_mfma_f32_16x16x32_bf16 v[188:191], a[20:23], a[76:79], v[188:191]
    s_add_u32 s49, s49, 128
    v_mfma_f32_16x16x32_bf16 v[248:251], a[24:27], a[76:79], v[248:251]
    ds_read_b128 a[52:55], v7 offset:10240
    v_mfma_f32_16x16x32_bf16 v[252:255], a[28:31], a[76:79], v[252:255]
    ds_read_b64_tr_b16 a[76:77], v11 offset:16384
    s_waitcnt lgkmcnt(15)
    v_mfma_f32_16x16x32_bf16 v[64:67], a[0:3], a[80:83], v[64:67]
    ds_read_b64_tr_b16 a[78:79], v11 offset:18432
    v_mfma_f32_16x16x32_bf16 v[68:71], a[4:7], a[80:83], v[68:71]
    v_mfma_f32_16x16x32_bf16 v[128:131], a[8:11], a[80:83], v[128:131]
    ds_read_b128 a[56:59], v7 offset:12288
    v_mfma_f32_16x16x32_bf16 v[132:135], a[12:15], a[80:83], v[132:135]
    s_add_u32 m0, s61, 4096
    v_mfma_f32_16x16x32_bf16 v[192:195], a[16:19], a[80:83], v[192:195]
    buffer_load_dwordx4 v16, s[40:43], s50 offen offset:0 lds
    v_mfma_f32_16x16x32_bf16 v[196:199], a[20:23], a[80:83], v[196:199]
    v_mfma_f32_16x16x32_bf16 a[96:99], a[24:27], a[80:83], a[96:99]
    s_add_u32 s61, s61, 32768
    ds_read_b128 a[60:63], v7 offset:14336
    v_mfma_f32_16x16x32_bf16 a[100:103], a[28:31], a[80:83], a[100:103]
    s_cmp_ge_u32 s61, 98304
    s_cselect_b32 s90, 98304, 0
    ds_read_b64_tr_b16 a[80:81], v12 offset:16384
    v_mfma_f32_16x16x32_bf16 v[72:75], a[0:3], a[84:87], v[72:75]
    s_sub_u32 s61, s61, s90
    ds_read_b64_tr_b16 a[82:83], v12 offset:18432
    v_mfma_f32_16x16x32_bf16 v[76:79], a[4:7], a[84:87], v[76:79]
    s_add_u32 s64, s64, 32768
    v_mfma_f32_16x16x32_bf16 v[136:139], a[8:11], a[84:87], v[136:139]
    buffer_store_dwordx4 a[224:227], v2, s[24:27], s28 offen sc1
    v_mfma_f32_16x16x32_bf16 v[140:143], a[12:15], a[84:87], v[140:143]
    s_add_u32 s28, s28, s31
    v_mfma_f32_16x16x32_bf16 v[200:203], a[16:19], a[84:87], v[200:203]
    buffer_load_dwordx4 v17, s[40:43], s50 offen offset:1024 lds
    v_mfma_f32_16x16x32_bf16 v[204:207], a[20:23], a[84:87], v[204:207]
    s_add_u32 s50, s50, 128
    v_mfma_f32_16x16x32_bf16 a[104:107], a[24:27], a[84:87], a[104:107]
    s_cmp_ge_u32 s64, 98304
    s_cselect_b32 s63, 4294901760, s59
    s_cselect_b32 s64, 0, s64
    v_mfma_f32_16x16x32_bf16 a[108:111], a[28:31], a[84:87], a[108:111]
    ds_read_b64_tr_b16 a[84:85], v13 offset:16384
    v_mfma_f32_16x16x32_bf16 v[80:83], a[0:3], a[88:91], v[80:83]
    ds_read_b64_tr_b16 a[86:87], v13 offset:18432
    v_mfma_f32_16x16x32_bf16 v[84:87], a[4:7], a[88:91], v[84:87]
    v_mfma_f32_16x16x32_bf16 v[144:147], a[8:11], a[88:91], v[144:147]
    buffer_store_dwordx4 a[228:231], v2, s[24:27], s28 offen sc1
    v_mfma_f32_16x16x32_bf16 v[148:151], a[12:15], a[88:91], v[148:151]
    s_add_u32 s28, s28, s31
    v_mfma_f32_16x16x32_bf16 v[208:211], a[16:19], a[88:91], v[208:211]
    buffer_load_dwordx4 v16, s[40:43], s51 offen offset:2048 lds
    v_mfma_f32_16x16x32_bf16 v[212:215], a[20:23], a[88:91], v[212:215]
    v_mfma_f32_16x16x32_bf16 a[112:115], a[24:27], a[88:91], a[112:115]
    v_mfma_f32_16x16x32_bf16 a[116:119], a[28:31], a[88:91], a[116:119]
    ds_read_b64_tr_b16 a[88:89], v14 offset:16384
    s_waitcnt lgkmcnt(15)
    v_mfma_f32_16x16x32_bf16 v[88:91], a[0:3], a[92:95], v[88:91]
    ds_read_b64_tr_b16 a[90:91], v14 offset:18432
    v_mfma_f32_16x16x32_bf16 v[92:95], a[4:7], a[92:95], v[92:95]
    v_add_u32 v6, s63, v6
    v_add_u32 v7, s63, v7
    v_mfma_f32_16x16x32_bf16 v[152:155], a[8:11], a[92:95], v[152:155]
    buffer_store_dwordx4 a[232:235], v2, s[24:27], s28 offen sc1
    v_mfma_f32_16x16x32_bf16 v[156:159], a[12:15], a[92:95], v[156:159]
    s_add_u32 s28, s28, s31
    v_mfma_f32_16x16x32_bf16 v[216:219], a[16:19], a[92:95], v[216:219]
    buffer_load_dwordx4 v17, s[40:43], s51 offen offset:3072 lds
    v_mfma_f32_16x16x32_bf16 v[220:223], a[20:23], a[92:95], v[220:223]
    s_add_u32 s51, s51, 128
    v_mfma_f32_16x16x32_bf16 a[120:123], a[24:27], a[92:95], a[120:123]
    v_mfma_f32_16x16x32_bf16 a[124:127], a[28:31], a[92:95], a[124:127]
    ds_read_b64_tr_b16 a[92:93], v15 offset:16384
    ds_read_b64_tr_b16 a[94:95], v15 offset:18432
    v_mfma_f32_16x16x32_bf16 v[32:35], a[32:35], a[64:67], v[32:35]
    v_xor_b32 v8, s60, v8
    v_xor_b32 v9, s60, v9
    v_mfma_f32_16x16x32_bf16 v[36:39], a[36:39], a[64:67], v[36:39]
    v_xor_b32 v10, s60, v10
    v_xor_b32 v11, s60, v11
    s_waitcnt lgkmcnt(15)
    v_mfma_f32_16x16x32_bf16 v[96:99], a[40:43], a[64:67], v[96:99]
    v_xor_b32 v12, s60, v12
    v_xor_b32 v13, s60, v13
    v_mfma_f32_16x16x32_bf16 v[100:103], a[44:47], a[64:67], v[100:103]
    v_xor_b32 v14, s60, v14
    v_xor_b32 v15, s60, v15
    s_waitcnt lgkmcnt(13)
    v_mfma_f32_16x16x32_bf16 v[160:163], a[48:51], a[64:67], v[160:163]
    s_waitcnt lgkmcnt(12)
    v_mfma_f32_16x16x32_bf16 v[164:167], a[52:55], a[64:67], v[164:167]
    s_waitcnt lgkmcnt(9)
    v_mfma_f32_16x16x32_bf16 v[224:227], a[56:59], a[64:67], v[224:227]
    s_waitcnt vmcnt(16) lgkmcnt(0)
    v_mfma_f32_16x16x32_bf16 v[228:231], a[60:63], a[64:67], v[228:231]
    s_barrier
    ds_read_b64_tr_b16 a[64:65], v8 offset:0
    v_mfma_f32_16x16x32_bf16 v[40:43], a[32:35], a[68:71], v[40:43]
    s_add_u32 m0, s62, 0
    ds_read_b64_tr_b16 a[66:67], v8 offset:2048
    v_mfma_f32_16x16x32_bf16 v[44:47], a[36:39], a[68:71], v[44:47]
    buffer_load_dwordx4 v18, s[44:47], s52 offen offset:0 lds
    v_mfma_f32_16x16x32_bf16 v[104:107], a[40:43], a[68:71], v[104:107]
    ds_read_b128 a[0:3], v6 offset:0
    v_mfma_f32_16x16x32_bf16 v[108:111], a[44:47], a[68:71], v[108:111]
    v_mfma_f32_16x16x32_bf16 v[168:171], a[48:51], a[68:71], v[168:171]
    v_mfma_f32_16x16x32_bf16 v[172:175], a[52:55], a[68:71], v[172:175]
    buffer_load_dwordx4 v19, s[44:47], s52 offen offset:1024 lds
    v_mfma_f32_16x16x32_bf16 v[232:235], a[56:59], a[68:71], v[232:235]
    s_add_u32 s52, s52, s56
    ds_read_b128 a[4:7], v6 offset:2048
    v_mfma_f32_16x16x32_bf16 v[236:239], a[60:63], a[68:71], v[236:239]
    ds_read_b64_tr_b16 a[68:69], v9 offset:0
    v_mfma_f32_16x16x32_bf16 v[48:51], a[32:35], a[72:75], v[48:51]
    ds_read_b64_tr_b16 a[70:71], v9 offset:2048
    v_mfma_f32_16x16x32_bf16 v[52:55], a[36:39], a[72:75], v[52:55]
    buffer_load_dwordx4 v18, s[44:47], s53 offen offset:2048 lds
    v_mfma_f32_16x16x32_bf16 v[112:115], a[40:43], a[72:75], v[112:115]
    ds_read_b128 a[8:11], v6 offset:4096
    v_mfma_f32_16x16x32_bf16 v[116:119], a[44:47], a[72:75], v[116:119]
    v_mfma_f32_16x16x32_bf16 v[176:179], a[48:51], a[72:75], v[176:179]
    v_mfma_f32_16x16x32_bf16 v[180:183], a[52:55], a[72:75], v[180:183]
    buffer_load_dwordx4 v19, s[44:47], s53 offen offset:3072 lds
    v_mfma_f32_16x16x32_bf16 v[240:243], a[56:59], a[72:75], v[240:243]
    s_add_u32 s53, s53, s56
    ds_read_b128 a[12:15], v6 offset:6144
    v_mfma_f32_16x16x32_bf16 v[244:247], a[60:63], a[72:75], v[244:247]
    ds_read_b64_tr_b16 a[72:73], v10 offset:0
    v_mfma_f32_16x16x32_bf16 v[56:59], a[32:35], a[76:79], v[56:59]
    s_add_u32 m0, s62, 4096
    ds_read_b64_tr_b16 a[74:75], v10 offset:2048
    v_mfma_f32_16x16x32_bf16 v[60:63], a[36:39], a[76:79], v[60:63]
    buffer_load_dwordx4 v20, s[44:47], s54 offen offset:0 lds
    v_mfma_f32_16x16x32_bf16 v[120:123], a[40:43], a[76:79], v[120:123]
    ds_read_b128 a[16:19], v6 offset:8192
    v_mfma_f32_16x16x32_bf16 v[124:127], a[44:47], a[76:79], v[124:127]
    s_xor_b32 s62, s62, 229376
    v_mfma_f32_16x16x32_bf16 v[184:187], a[48:51], a[76:79], v[184:187]
    v_mfma_f32_16x16x32_bf16 v[188:191], a[52:55], a[76:79], v[188:191]
    buffer_load_dwordx4 v21, s[44:47], s54 offen offset:1024 lds
    v_mfma_f32_16x16x32_bf16 v[248:251], a[56:59], a[76:79], v[248:251]
    s_add_u32 s54, s54, s56
    ds_read_b128 a[20:23], v6 offset:10240
    v_mfma_f32_16x16x32_bf16 v[252:255], a[60:63], a[76:79], v[252:255]
    ds_read_b64_tr_b16 a[76:77], v11 offset:0
    v_mfma_f32_16x16x32_bf16 v[64:67], a[32:35], a[80:83], v[64:67]
    ds_read_b64_tr_b16 a[78:79], v11 offset:2048
    v_mfma_f32_16x16x32_bf16 v[68:71], a[36:39], a[80:83], v[68:71]
    buffer_load_dwordx4 v20, s[44:47], s55 offen offset:2048 lds
    v_mfma_f32_16x16x32_bf16 v[128:131], a[40:43], a[80:83], v[128:131]
    ds_read_b128 a[24:27], v6 offset:12288
    v_mfma_f32_16x16x32_bf16 v[132:135], a[44:47], a[80:83], v[132:135]
    v_mfma_f32_16x16x32_bf16 v[192:195], a[48:51], a[80:83], v[192:195]
    v_mfma_f32_16x16x32_bf16 v[196:199], a[52:55], a[80:83], v[196:199]
    buffer_load_dwordx4 v21, s[44:47], s55 offen offset:3072 lds
    v_mfma_f32_16x16x32_bf16 a[96:99], a[56:59], a[80:83], a[96:99]
    s_add_u32 s55, s55, s56
    ds_read_b128 a[28:31], v6 offset:14336
    v_mfma_f32_16x16x32_bf16 a[100:103], a[60:63], a[80:83], a[100:103]
    ds_read_b64_tr_b16 a[80:81], v12 offset:0
    v_mfma_f32_16x16x32_bf16 v[72:75], a[32:35], a[84:87], v[72:75]
    ds_read_b64_tr_b16 a[82:83], v12 offset:2048
    v_mfma_f32_16x16x32_bf16 v[76:79], a[36:39], a[84:87], v[76:79]
    v_mfma_f32_16x16x32_bf16 v[136:139], a[40:43], a[84:87], v[136:139]
    buffer_store_dwordx4 a[236:239], v2, s[24:27], s28 offen sc1
    v_mfma_f32_16x16x32_bf16 v[140:143], a[44:47], a[84:87], v[140:143]
    s_add_u32 s28, s28, s31
    v_mfma_f32_16x16x32_bf16 v[200:203], a[48:51], a[84:87], v[200:203]
    v_mfma_f32_16x16x32_bf16 v[204:207], a[52:55], a[84:87], v[204:207]
    v_mfma_f32_16x16x32_bf16 a[104:107], a[56:59], a[84:87], a[104:107]
    buffer_store_dwordx4 a[240:243], v2, s[24:27], s28 offen sc1
    v_mfma_f32_16x16x32_bf16 a[108:111], a[60:63], a[84:87], a[108:111]
    s_add_u32 s28, s28, s31
    ds_read_b64_tr_b16 a[84:85], v13 offset:0
    v_mfma_f32_16x16x32_bf16 v[80:83], a[32:35], a[88:91], v[80:83]
    ds_read_b64_tr_b16 a[86:87], v13 offset:2048
    v_mfma_f32_16x16x32_bf16 v[84:87], a[36:39], a[88:91], v[84:87]
    v_mfma_f32_16x16x32_bf16 v[144:147], a[40:43], a[88:91], v[144:147]
    buffer_store_dwordx4 a[244:247], v2, s[24:27], s28 offen sc1
    v_mfma_f32_16x16x32_bf16 v[148:151], a[44:47], a[88:91], v[148:151]
    s_add_u32 s28, s28, s31
    v_mfma_f32_16x16x32_bf16 v[208:211], a[48:51], a[88:91], v[208:211]
    v_mfma_f32_16x16x32_bf16 v[212:215], a[52:55], a[88:91], v[212:215]
    v_mfma_f32_16x16x32_bf16 a[112:115], a[56:59], a[88:91], a[112:115]
    buffer_store_dwordx4 a[248:251], v2, s[24:27], s28 offen sc1
    v_mfma_f32_16x16x32_bf16 a[116:119], a[60:63], a[88:91], a[116:119]
    s_add_u32 s28, s28, s31
    ds_read_b64_tr_b16 a[88:89], v14 offset:0
    v_mfma_f32_16x16x32_bf16 v[88:91], a[32:35], a[92:95], v[88:91]
    ds_read_b64_tr_b16 a[90:91], v14 offset:2048
    v_mfma_f32_16x16x32_bf16 v[92:95], a[36:39], a[92:95], v[92:95]
    v_mfma_f32_16x16x32_bf16 v[152:155], a[40:43], a[92:95], v[152:155]
    buffer_store_dwordx4 a[252:255], v2, s[24:27], s28 offen sc1
    v_mfma_f32_16x16x32_bf16 v[156:159], a[44:47], a[92:95], v[156:159]
    s_add_u32 s29, s29, s30
    s_mov_b32 s28, s29
    v_mfma_f32_16x16x32_bf16 v[216:219], a[48:51], a[92:95], v[216:219]
    s_sub_u32 s65, s65, 1
    v_mfma_f32_16x16x32_bf16 v[220:223], a[52:55], a[92:95], v[220:223]
    v_mfma_f32_16x16x32_bf16 a[120:123], a[56:59], a[92:95], a[120:123]
    v_mfma_f32_16x16x32_bf16 a[124:127], a[60:63], a[92:95], a[124:127]
    ds_read_b64_tr_b16 a[92:93], v15 offset:0
    ds_read_b64_tr_b16 a[94:95], v15 offset:2048
m_loop19:
    s_waitcnt lgkmcnt(15)
    v_mfma_f32_16x16x32_bf16 v[32:35], a[0:3], a[64:67], v[32:35]
    v_mfma_f32_16x16x32_bf16 v[36:39], a[4:7], a[64:67], v[36:39]
    v_mfma_f32_16x16x32_bf16 v[96:99], a[8:11], a[64:67], v[96:99]
    v_mfma_f32_16x16x32_bf16 v[100:103], a[12:15], a[64:67], v[100:103]
    s_add_u32 m0, s61, 0
    s_waitcnt lgkmcnt(13)
    v_mfma_f32_16x16x32_bf16 v[160:163], a[16:19], a[64:67], v[160:163]
    buffer_load_dwordx4 v16, s[40:43], s48 offen offset:0 lds
    s_waitcnt lgkmcnt(12)
    v_mfma_f32_16x16x32_bf16 v[164:167], a[20:23], a[64:67], v[164:167]
    s_waitcnt lgkmcnt(9)
    v_mfma_f32_16x16x32_bf16 v[224:227], a[24:27], a[64:67], v[224:227]
    s_waitcnt lgkmcnt(8)
    v_mfma_f32_16x16x32_bf16 v[228:231], a[28:31], a[64:67], v[228:231]
    ds_read_b64_tr_b16 a[64:65], v8 offset:16384
    v_mfma_f32_16x16x32_bf16 v[40:43], a[0:3], a[68:71], v[40:43]
    ds_read_b64_tr_b16 a[66:67], v8 offset:18432
    v_mfma_f32_16x16x32_bf16 v[44:47], a[4:7], a[68:71], v[44:47]
    v_mfma_f32_16x16x32_bf16 v[104:107], a[8:11], a[68:71], v[104:107]
    ds_read_b128 a[32:35], v7 offset:0
    v_mfma_f32_16x16x32_bf16 v[108:111], a[12:15], a[68:71], v[108:111]
    v_mfma_f32_16x16x32_bf16 v[168:171], a[16:19], a[68:71], v[168:171]
    buffer_load_dwordx4 v17, s[40:43], s48 offen offset:1024 lds
    v_mfma_f32_16x16x32_bf16 v[172:175], a[20:23], a[68:71], v[172:175]
    s_add_u32 s48, s48, 128
    v_mfma_f32_16x16x32_bf16 v[232:235], a[24:27], a[68:71], v[232:235]
    ds_read_b128 a[36:39], v7 offset:2048
    v_mfma_f32_16x16x32_bf16 v[236:239], a[28:31], a[68:71], v[236:239]
    ds_read_b64_tr_b16 a[68:69], v9 offset:16384
    v_mfma_f32_16x16x32_bf16 v[48:51], a[0:3], a[72:75], v[48:51]
    ds_read_b64_tr_b16 a[70:71], v9 offset:18432
    v_mfma_f32_16x16x32_bf16 v[52:55], a[4:7], a[72:75], v[52:55]
    v_mfma_f32_16x16x32_bf16 v[112:115], a[8:11], a[72:75], v[112:115]
    ds_read_b128 a[40:43], v7 offset:4096
    v_mfma_f32_16x16x32_bf16 v[116:119], a[12:15], a[72:75], v[116:119]
    v_mfma_f32_16x16x32_bf16 v[176:179], a[16:19], a[72:75], v[176:179]
    buffer_load_dwordx4 v16, s[40:43], s49 offen offset:2048 lds
    v_mfma_f32_16x16x32_bf16 v[180:183], a[20:23], a[72:75], v[180:183]
    v_mfma_f32_16x16x32_bf16 v[240:243], a[24:27], a[72:75], v[240:243]
    ds_read_b128 a[44:47], v7 offset:6144
    v_mfma_f32_16x16x32_bf16 v[244:247], a[28:31], a[72:75], v[244:247]
    ds_read_b64_tr_b16 a[72:73], v10 offset:16384
    v_mfma_f32_16x16x32_bf16 v[56:59], a[0:3], a[76:79], v[56:59]
    ds_read_b64_tr_b16 a[74:75], v10 offset:18432
    v_mfma_f32_16x16x32_bf16 v[60:63], a[4:7], a[76:79], v[60:63]
    v_mfma_f32_16x16x32_bf16 v[120:123], a[8:11], a[76:79], v[120:123]
    ds_read_b128 a[48:51], v7 offset:8192
    v_mfma_f32_16x16x32_bf16 v[124:127], a[12:15], a[76:79], v[124:127]
    v_mfma_f32_16x16x32_bf16 v[184:187], a[16:19], a[76:79], v[184:187]
    buffer_load_dwordx4 v17, s[40:43], s49 offen offset:3072 lds
    v_mfma_f32_16x16x32_bf16 v[188:191], a[20:23], a[76:79], v[188:191]
    s_add_u32 s49, s49, 128
    v_mfma_f32_16x16x32_bf16 v[248:251], a[24:27], a[76:79], v[248:251]
    ds_read_b128 a[52:55], v7 offset:10240
    v_mfma_f32_16x16x32_bf16 v[252:255], a[28:31], a[76:79], v[252:255]
    ds_read_b64_tr_b16 a[76:77], v11 offset:16384
    s_waitcnt lgkmcnt(15)
    v_mfma_f32_16x16x32_bf16 v[64:67], a[0:3], a[80:83], v[64:67]
    ds_read_b64_tr_b16 a[78:79], v11 offset:18432
    v_mfma_f32_16x16x32_bf16 v[68:71], a[4:7], a[80:83], v[68:71]
    v_mfma_f32_16x16x32_bf16 v[128:131], a[8:11], a[80:83], v[128:131]
    ds_read_b128 a[56:59], v7 offset:12288
    v_mfma_f32_16x16x32_bf16 v[132:135], a[12:15], a[80:83], v[132:135]
    s_add_u32 m0, s61, 4096
    v_mfma_f32_16x16x32_bf16 v[192:195], a[16:19], a[80:83], v[192:195]
    buffer_load_dwordx4 v16, s[40:43], s50 offen offset:0 lds
    v_mfma_f32_16x16x32_bf16 v[196:199], a[20:23], a[80:83], v[196:199]
    v_mfma_f32_16x16x32_bf16 a[96:99], a[24:27], a[80:83], a[96:99]
    s_add_u32 s61, s61, 32768
    ds_read_b128 a[60:63], v7 offset:14336
    v_mfma_f32_16x16x32_bf16 a[100:103], a[28:31], a[80:83], a[100:103]
    s_cmp_ge_u32 s61, 98304
    s_cselect_b32 s90, 98304, 0
    ds_read_b64_tr_b16 a[80:81], v12 offset:16384
    v_mfma_f32_16x16x32_bf16 v[72:75], a[0:3], a[84:87], v[72:75]
    s_sub_u32 s61, s61, s90
    ds_read_b64_tr_b16 a[82:83], v12 offset:18432
    v_mfma_f32_16x16x32_bf16 v[76:79], a[4:7], a[84:87], v[76:79]
    s_add_u32 s64, s64, 32768
    v_mfma_f32_16x16x32_bf16 v[136:139], a[8:11], a[84:87], v[136:139]
    s_cmp_ge_u32 s64, 98304
    s_cselect_b32 s63, 4294901760, s59
    s_cselect_b32 s64, 0, s64
    v_mfma_f32_16x16x32_bf16 v[140:143], a[12:15], a[84:87], v[140:143]
    v_mfma_f32_16x16x32_bf16 v[200:203], a[16:19], a[84:87], v[200:203]
    buffer_load_dwordx4 v17, s[40:43], s50 offen offset:1024 lds
    v_mfma_f32_16x16x32_bf16 v[204:207], a[20:23], a[84:87], v[204:207]
    s_add_u32 s50, s50, 128
    v_mfma_f32_16x16x32_bf16 a[104:107], a[24:27], a[84:87], a[104:107]
    v_mfma_f32_16x16x32_bf16 a[108:111], a[28:31], a[84:87], a[108:111]
    ds_read_b64_tr_b16 a[84:85], v13 offset:16384
    v_mfma_f32_16x16x32_bf16 v[80:83], a[0:3], a[88:91], v[80:83]
    ds_read_b64_tr_b16 a[86:87], v13 offset:18432
    v_mfma_f32_16x16x32_bf16 v[84:87], a[4:7], a[88:91], v[84:87]
    v_mfma_f32_16x16x32_bf16 v[144:147], a[8:11], a[88:91], v[144:147]
    v_mfma_f32_16x16x32_bf16 v[148:151], a[12:15], a[88:91], v[148:151]
    v_mfma_f32_16x16x32_bf16 v[208:211], a[16:19], a[88:91], v[208:211]
    buffer_load_dwordx4 v16, s[40:43], s51 offen offset:2048 lds
    v_mfma_f32_16x16x32_bf16 v[212:215], a[20:23], a[88:91], v[212:215]
    v_mfma_f32_16x16x32_bf16 a[112:115], a[24:27], a[88:91], a[112:115]
    v_mfma_f32_16x16x32_bf16 a[116:119], a[28:31], a[88:91], a[116:119]
    ds_read_b64_tr_b16 a[88:89], v14 offset:16384
    s_waitcnt lgkmcnt(15)
    v_mfma_f32_16x16x32_bf16 v[88:91], a[0:3], a[92:95], v[88:91]
    ds_read_b64_tr_b16 a[90:91], v14 offset:18432
    v_mfma_f32_16x16x32_bf16 v[92:95], a[4:7], a[92:95], v[92:95]
    v_add_u32 v6, s63, v6
    v_add_u32 v7, s63, v7
    v_mfma_f32_16x16x32_bf16 v[152:155], a[8:11], a[92:95], v[152:155]
    v_mfma_f32_16x16x32_bf16 v[156:159], a[12:15], a[92:95], v[156:159]
    v_mfma_f32_16x16x32_bf16 v[216:219], a[16:19], a[92:95], v[216:219]
    buffer_load_dwordx4 v17, s[40:43], s51 offen offset:3072 lds
    v_mfma_f32_16x16x32_bf16 v[220:223], a[20:23], a[92:95], v[220:223]
    s_add_u32 s51, s51, 128
    v_mfma_f32_16x16x32_bf16 a[120:123], a[24:27], a[92:95], a[120:123]
    v_mfma_f32_16x16x32_bf16 a[124:127], a[28:31], a[92:95], a[124:127]
    ds_read_b64_tr_b16 a[92:93], v15 offset:16384
    ds_read_b64_tr_b16 a[94:95], v15 offset:18432
    v_mfma_f32_16x16x32_bf16 v[32:35], a[32:35], a[64:67], v[32:35]
    v_xor_b32 v8, s60, v8
    v_xor_b32 v9, s60, v9
    v_mfma_f32_16x16x32_bf16 v[36:39], a[36:39], a[64:67], v[36:39]
    v_xor_b32 v10, s60, v10
    v_xor_b32 v11, s60, v11
    s_waitcnt lgkmcnt(15)
    v_mfma_f32_16x16x32_bf16 v[96:99], a[40:43], a[64:67], v[96:99]
    v_xor_b32 v12, s60, v12
    v_xor_b32 v13, s60, v13
    v_mfma_f32_16x16x32_bf16 v[100:103], a[44:47], a[64:67], v[100:103]
    v_xor_b32 v14, s60, v14
    v_xor_b32 v15, s60, v15
    s_waitcnt lgkmcnt(13)
    v_mfma_f32_16x16x32_bf16 v[160:163], a[48:51], a[64:67], v[160:163]
    s_waitcnt lgkmcnt(12)
    v_mfma_f32_16x16x32_bf16 v[164:167], a[52:55], a[64:67], v[164:167]
    s_waitcnt lgkmcnt(9)
    v_mfma_f32_16x16x32_bf16 v[224:227], a[56:59], a[64:67], v[224:227]
    s_waitcnt vmcnt(8) lgkmcnt(0)
    v_mfma_f32_16x16x32_bf16 v[228:231], a[60:63], a[64:67], v[228:231]
    s_barrier
    ds_read_b64_tr_b16 a[64:65], v8 offset:0
    v_mfma_f32_16x16x32_bf16 v[40:43], a[32:35], a[68:71], v[40:43]
    s_add_u32 m0, s62, 0
    ds_read_b64_tr_b16 a[66:67], v8 offset:2048
    v_mfma_f32_16x16x32_bf16 v[44:47], a[36:39], a[68:71], v[44:47]
    buffer_load_dwordx4 v18, s[44:47], s52 offen offset:0 lds
    v_mfma_f32_16x16x32_bf16 v[104:107], a[40:43], a[68:71], v[104:107]
    ds_read_b128 a[0:3], v6 offset:0
    v_mfma_f32_16x16x32_bf16 v[108:111], a[44:47], a[68:71], v[108:111]
    v_mfma_f32_16x16x32_bf16 v[168:171], a[48:51], a[68:71], v[168:171]
    v_mfma_f32_16x16x32_bf16 v[172:175], a[52:55], a[68:71], v[172:175]
    buffer_load_dwordx4 v19, s[44:47], s52 offen offset:1024 lds
    v_mfma_f32_16x16x32_bf16 v[232:235], a[56:59], a[68:71], v[232:235]
    s_add_u32 s52, s52, s56
    ds_read_b128 a[4:7], v6 offset:2048
    v_mfma_f32_16x16x32_bf16 v[236:239], a[60:63], a[68:71], v[236:239]
    ds_read_b64_tr_b16 a[68:69], v9 offset:0
    v_mfma_f32_16x16x32_bf16 v[48:51], a[32:35], a[72:75], v[48:51]
    ds_read_b64_tr_b16 a[70:71], v9 offset:2048
    v_mfma_f32_16x16x32_bf16 v[52:55], a[36:39], a[72:75], v[52:55]
    buffer_load_dwordx4 v18, s[44:47], s53 offen offset:2048 lds
    v_mfma_f32_16x16x32_bf16 v[112:115], a[40:43], a[72:75], v[112:115]
    ds_read_b128 a[8:11], v6 offset:4096
    v_mfma_f32_16x16x32_bf16 v[116:119], a[44:47], a[72:75], v[116:119]
    v_mfma_f32_16x16x32_bf16 v[176:179], a[48:51], a[72:75], v[176:179]
    v_mfma_f32_16x16x32_bf16 v[180:183], a[52:55], a[72:75], v[180:183]
    buffer_load_dwordx4 v19, s[44:47], s53 offen offset:3072 lds
    v_mfma_f32_16x16x32_bf16 v[240:243], a[56:59], a[72:75], v[240:243]
    s_add_u32 s53, s53, s56
    ds_read_b128 a[12:15], v6 offset:6144
    v_mfma_f32_16x16x32_bf16 v[244:247], a[60:63], a[72:75], v[244:247]
    ds_read_b64_tr_b16 a[72:73], v10 offset:0
    v_mfma_f32_16x16x32_bf16 v[56:59], a[32:35], a[76:79], v[56:59]
    s_add_u32 m0, s62, 4096
    ds_read_b64_tr_b16 a[74:75], v10 offset:2048
    v_mfma_f32_16x16x32_bf16 v[60:63], a[36:39], a[76:79], v[60:63]
    buffer_load_dwordx4 v20, s[44:47], s54 offen offset:0 lds
    v_mfma_f32_16x16x32_bf16 v[120:123], a[40:43], a[76:79], v[120:123]
    ds_read_b128 a[16:19], v6 offset:8192
    v_mfma_f32_16x16x32_bf16 v[124:127], a[44:47], a[76:79], v[124:127]
    s_xor_b32 s62, s62, 229376
    v_mfma_f32_16x16x32_bf16 v[184:187], a[48:51], a[76:79], v[184:187]
    v_mfma_f32_16x16x32_bf16 v[188:191], a[52:55], a[76:79], v[188:191]
    buffer_load_dwordx4 v21, s[44:47], s54 offen offset:1024 lds
    v_mfma_f32_16x16x32_bf16 v[248:251], a[56:59], a[76:79], v[248:251]
    s_add_u32 s54, s54, s56
    ds_read_b128 a[20:23], v6 offset:10240
    v_mfma_f32_16x16x32_bf16 v[252:255], a[60:63], a[76:79], v[252:255]
    ds_read_b64_tr_b16 a[76:77], v11 offset:0
    v_mfma_f32_16x16x32_bf16 v[64:67], a[32:35], a[80:83], v[64:67]
    ds_read_b64_tr_b16 a[78:79], v11 offset:2048
    v_mfma_f32_16x16x32_bf16 v[68:71], a[36:39], a[80:83], v[68:71]
    buffer_load_dwordx4 v20, s[44:47], s55 offen offset:2048 lds
    v_mfma_f32_16x16x32_bf16 v[128:131], a[40:43], a[80:83], v[128:131]
    ds_read_b128 a[24:27], v6 offset:12288
    v_mfma_f32_16x16x32_bf16 v[132:135], a[44:47], a[80:83], v[132:135]
    v_mfma_f32_16x16x32_bf16 v[192:195], a[48:51], a[80:83], v[192:195]
    v_mfma_f32_16x16x32_bf16 v[196:199], a[52:55], a[80:83], v[196:199]
    buffer_load_dwordx4 v21, s[44:47], s55 offen offset:3072 lds
    v_mfma_f32_16x16x32_bf16 a[96:99], a[56:59], a[80:83], a[96:99]
    s_add_u32 s55, s55, s56
    ds_read_b128 a[28:31], v6 offset:14336
    v_mfma_f32_16x16x32_bf16 a[100:103], a[60:63], a[80:83], a[100:103]
    ds_read_b64_tr_b16 a[80:81], v12 offset:0
    v_mfma_f32_16x16x32_bf16 v[72:75], a[32:35], a[84:87], v[72:75]
    ds_read_b64_tr_b16 a[82:83], v12 offset:2048
    v_mfma_f32_16x16x32_bf16 v[76:79], a[36:39], a[84:87], v[76:79]
    v_mfma_f32_16x16x32_bf16 v[136:139], a[40:43], a[84:87], v[136:139]
    v_mfma_f32_16x16x32_bf16 v[140:143], a[44:47], a[84:87], v[140:143]
    v_mfma_f32_16x16x32_bf16 v[200:203], a[48:51], a[84:87], v[200:203]
    v_mfma_f32_16x16x32_bf16 v[204:207], a[52:55], a[84:87], v[204:207]
    v_mfma_f32_16x16x32_bf16 a[104:107], a[56:59], a[84:87], a[104:107]
    v_mfma_f32_16x16x32_bf16 a[108:111], a[60:63], a[84:87], a[108:111]
    ds_read_b64_tr_b16 a[84:85], v13 offset:0
    v_mfma_f32_16x16x32_bf16 v[80:83], a[32:35], a[88:91], v[80:83]
    ds_read_b64_tr_b16 a[86:87], v13 offset:2048
    v_mfma_f32_16x16x32_bf16 v[84:87], a[36:39], a[88:91], v[84:87]
    v_mfma_f32_16x16x32_bf16 v[144:147], a[40:43], a[88:91], v[144:147]
    v_mfma_f32_16x16x32_bf16 v[148:151], a[44:47], a[88:91], v[148:151]
    v_mfma_f32_16x16x32_bf16 v[208:211], a[48:51], a[88:91], v[208:211]
    v_mfma_f32_16x16x32_bf16 v[212:215], a[52:55], a[88:91], v[212:215]
    v_mfma_f32_16x16x32_bf16 a[112:115], a[56:59], a[88:91], a[112:115]
    v_mfma_f32_16x16x32_bf16 a[116:119], a[60:63], a[88:91], a[116:119]
    ds_read_b64_tr_b16 a[88:89], v14 offset:0
    v_mfma_f32_16x16x32_bf16 v[88:91], a[32:35], a[92:95], v[88:91]
    ds_read_b64_tr_b16 a[90:91], v14 offset:2048
    v_mfma_f32_16x16x32_bf16 v[92:95], a[36:39], a[92:95], v[92:95]
    v_mfma_f32_16x16x32_bf16 v[152:155], a[40:43], a[92:95], v[152:155]
    v_mfma_f32_16x16x32_bf16 v[156:159], a[44:47], a[92:95], v[156:159]
    v_mfma_f32_16x16x32_bf16 v[216:219], a[48:51], a[92:95], v[216:219]
    s_sub_u32 s65, s65, 1
    v_mfma_f32_16x16x32_bf16 v[220:223], a[52:55], a[92:95], v[220:223]
    v_mfma_f32_16x16x32_bf16 a[120:123], a[56:59], a[92:95], a[120:123]
    s_cmp_gt_u32 s65, s67
    v_mfma_f32_16x16x32_bf16 a[124:127], a[60:63], a[92:95], a[124:127]
    ds_read_b64_tr_b16 a[92:93], v15 offset:0
    ds_read_b64_tr_b16 a[94:95], v15 offset:2048
    s_cbranch_scc1 m_loop19
    s_cmp_lg_u32 s65, 0
    s_cbranch_scc1 m_dosw20
m_epi11:
    s_cmp_eq_u32 s94, 0
    s_cbranch_scc1 m_last23
    s_mov_b32 s3, 1048576
m_spin27:
    v_readfirstlane_b32 s4, v4
    v_readfirstlane_b32 s5, v5
    s_nop 3
    s_cmp_lg_u32 s4, 0
    s_cbranch_scc1 m_ok28
    s_sub_u32 s3, s3, 1
    s_cbranch_scc1 m_ok28
    s_sleep 32
    buffer_load_dwordx2 v[4:5], off, s[12:15], 0 sc1
    s_waitcnt vmcnt(0)
    s_branch m_spin27
m_ok28:
    s_cmp_ge_u32 s68, 16
    s_cbranch_scc1 m_q030
    s_call_b64 s[20:21], m_epf21
    s_mov_b32 s17, s101
    s_mov_b32 s66, 2
    s_branch m_q129
m_q030:
    s_call_b64 s[20:21], m_eps22
    s_mov_b32 s17, s101
    s_mov_b32 s28, s98
    s_mov_b32 s29, s98
    s_mov_b32 s30, s99
    s_mov_b32 s31, s100
    s_mov_b32 s26, 268435456
m_q129:
    s_mov_b32 s95, s82
    s_mov_b32 s96, s83
    s_mov_b32 s97, s84
    s_mov_b32 s98, s85
    s_mov_b32 s99, s86
    s_mov_b32 s100, s87
    s_mov_b32 s101, s88
    s_sub_u32 s67, s95, 5
    s_mov_b32 s94, 0
    s_branch m_tile10
m_last23:
    s_cmp_eq_u32 s70, 0
    s_cbranch_scc1 m_kvl26
    buffer_load_dwordx2 v[4:5], off, s[12:15], 0 sc1
    s_call_b64 s[20:21], m_epf21
    s_waitcnt vmcnt(0)
    s_barrier
    s_mov_b32 s3, 1048576
m_spin31:
    v_readfirstlane_b32 s4, v4
    v_readfirstlane_b32 s5, v5
    s_nop 3
    s_cmp_lg_u32 s4, 0
    s_cbranch_scc1 m_ok32
    s_sub_u32 s3, s3, 1
    s_cbranch_scc1 m_ok32
    s_sleep 32
    buffer_load_dwordx2 v[4:5], off, s[12:15], 0 sc1
    s_waitcnt vmcnt(0)
    s_branch m_spin31
m_ok32:
    s_cmp_lg_u32 s16, 0
    s_cbranch_scc1 m_np33
    v_mov_b32 v4, s4
    v_mov_b32 v5, s5
    s_add_u32 s90, s101, 117440512
    s_mov_b64 exec, 1
    buffer_store_dwordx2 v[4:5], off, s[8:11], s90 sc1
    s_mov_b64 exec, -1
m_np33:
    s_cmp_lg_u32 s16, 0
    s_cbranch_scc1 m_pw34
    s_and_b32 s92, s2, 7
    s_lshl_b32 s92, s92, 2
    s_bfe_u32 s93, s2, 0x20003
    s_add_u32 s92, s92, s93
    s_lshr_b32 s93, s2, 5
    s_lshl_b32 s93, s93, 2
    s_or_b32 s93, s93, 0x40000
    s_lshr_b32 s90, s92, 1
    s_lshl_b32 s90, s90, 7
    s_add_u32 s90, s90, 117440512
    s_bfe_u32 s91, 873473623, s93
    s_lshr_b32 s91, s91, 1
    v_mov_b32 v0, s91
    v_add_u32 v4, 8, v1
    v_cmp_gt_u32 vcc, 8, v1
    s_nop 1
    v_cndmask_b32 v0, v0, v4, vcc
    s_bfe_u32 s91, 4225681832, s93
    s_lshr_b32 s91, s91, 1
    v_writelane_b32 v0, s91, 8
    v_lshlrev_b32 v0, 3, v0
    buffer_load_dwordx2 v[4:5], v0, s[8:11], s90 offen sc1
    s_waitcnt vmcnt(0)
    s_mov_b32 s3, 1048576
m_spin35:
    v_cmp_ne_u64 s[22:23], s[4:5], v[4:5]
    s_nop 3
    s_cmp_eq_u64 s[22:23], 0
    s_cbranch_scc1 m_ok36
    s_sub_u32 s3, s3, 1
    s_cbranch_scc1 m_ok36
    s_sleep 16
    s_and_b32 s92, s2, 7
    s_lshl_b32 s92, s92, 2
    s_bfe_u32 s93, s2, 0x20003
    s_add_u32 s92, s92, s93
    s_lshr_b32 s93, s2, 5
    s_lshl_b32 s93, s93, 2
    s_or_b32 s93, s93, 0x40000
    s_lshr_b32 s90, s92, 1
    s_lshl_b32 s90, s90, 7
    s_add_u32 s90, s90, 117440512
    s_bfe_u32 s91, 873473623, s93
    s_lshr_b32 s91, s91, 1
    v_mov_b32 v0, s91
    v_add_u32 v4, 8, v1
    v_cmp_gt_u32 vcc, 8, v1
    s_nop 1
    v_cndmask_b32 v0, v0, v4, vcc
    s_bfe_u32 s91, 4225681832, s93
    s_lshr_b32 s91, s91, 1
    v_writelane_b32 v0, s91, 8
    v_lshlrev_b32 v0, 3, v0
    buffer_load_dwordx2 v[4:5], v0, s[8:11], s90 offen sc1
    s_waitcnt vmcnt(0)
    s_branch m_spin35
m_ok36:
m_pw34:
    s_barrier
    s_and_b32 s92, s2, 7
    s_lshl_b32 s92, s92, 2
    s_bfe_u32 s93, s2, 0x20003
    s_add_u32 s92, s92, s93
    s_lshr_b32 s93, s2, 5
    s_lshl_b32 s93, s93, 2
    s_or_b32 s93, s93, 0x40000
    s_bfe_u32 s90, 4225681832, s93
    s_lshl_b32 s90, s90, 3
    s_lshl_b32 s91, s16, 1
    s_add_u32 s90, s90, s91
    s_lshl_b32 s90, s90, 12
    s_lshl_b32 s91, s92, 19
    s_add_u32 s90, s90, s91
    s_add_u32 s90, s90, 0
    buffer_load_dwordx4 a[128:131], v2, s[8:11], s90 offen offset:0 sc1
    buffer_load_dwordx4 a[132:135], v2, s[8:11], s90 offen offset:1024 sc1
    buffer_load_dwordx4 a[136:139], v2, s[8:11], s90 offen offset:2048 sc1
    buffer_load_dwordx4 a[140:143], v2, s[8:11], s90 offen offset:3072 sc1
    s_bfe_u32 s90, 4225681832, s93
    s_lshl_b32 s90, s90, 3
    s_lshl_b32 s91, s16, 1
    s_add_u32 s90, s90, s91
    s_lshl_b32 s90, s90, 12
    s_lshl_b32 s91, s92, 19
    s_add_u32 s90, s90, s91
    s_add_u32 s90, s90, 4096
    buffer_load_dwordx4 a[144:147], v2, s[8:11], s90 offen offset:0 sc1
    buffer_load_dwordx4 a[148:151], v2, s[8:11], s90 offen offset:1024 sc1
    buffer_load_dwordx4 a[152:155], v2, s[8:11], s90 offen offset:2048 sc1
    buffer_load_dwordx4 a[156:159], v2, s[8:11], s90 offen offset:3072 sc1
    s_bfe_u32 s90, 873473623, s93
    s_lshl_b32 s90, s90, 3
    s_lshl_b32 s91, s16, 1
    s_add_u32 s90, s90, s91
    s_lshl_b32 s90, s90, 12
    s_lshl_b32 s91, s92, 19
    s_add_u32 s90, s90, s91
    s_add_u32 s90, s90, 0
    buffer_load_dwordx4 a[160:163], v2, s[8:11], s90 offen offset:0 sc1
    buffer_load_dwordx4 a[164:167], v2, s[8:11], s90 offen offset:1024 sc1
    buffer_load_dwordx4 a[168:171], v2, s[8:11], s90 offen offset:2048 sc1
    buffer_load_dwordx4 a[172:175], v2, s[8:11], s90 offen offset:3072 sc1
    s_bfe_u32 s90, 873473623, s93
    s_lshl_b32 s90, s90, 3
    s_lshl_b32 s91, s16, 1
    s_add_u32 s90, s90, s91
    s_lshl_b32 s90, s90, 12
    s_lshl_b32 s91, s92, 19
    s_add_u32 s90, s90, s91
    s_add_u32 s90, s90, 4096
    buffer_load_dwordx4 a[176:179], v2, s[8:11], s90 offen offset:0 sc1
    buffer_load_dwordx4 a[180:183], v2, s[8:11], s90 offen offset:1024 sc1
    buffer_load_dwordx4 a[184:187], v2, s[8:11], s90 offen offset:2048 sc1
    buffer_load_dwordx4 a[188:191], v2, s[8:11], s90 offen offset:3072 sc1
    s_mov_b32 s94, 1
m_kvl26:
    s_waitcnt lgkmcnt(0)
    s_barrier
    s_and_b32 s92, s2, 7
    s_lshl_b32 s92, s92, 2
    s_bfe_u32 s93, s2, 0x20003
    s_add_u32 s92, s92, s93
    s_lshr_b32 s93, s2, 5
    s_lshl_b32 s93, s93, 2
    s_or_b32 s93, s93, 0x40000
    s_mov_b32 s32, s92
    s_bfe_u32 s33, 4225681832, s93
    s_add_u32 s33, s33, 1
    s_bfe_u32 s34, 873473623, s93
    s_add_u32 s34, s34, 1
    s_lshl_b32 s60, s16, 12
    v_add_u32 v7, s60, v2
    s_lshl_b32 s90, s34, 2
    s_lshl_b32 s91, s33, 2
    s_lshl_b32 s26, s91, 13
    s_mov_b32 s30, s26
    s_sub_u32 s67, s90, 4
    s_add_u32 s67, s67, s16
    s_add_u32 s68, s67, 1
    s_mov_b32 s69, s90
    s_sub_u32 s70, s91, 4
    s_add_u32 s70, s70, s16
    s_add_u32 s71, s70, 1
    s_mov_b32 s72, s91
    s_mov_b32 s27, 0x20000
    s_mov_b32 s31, 0x20000
    s_lshl_b32 s82, s32, 19
    s_add_u32 s90, s82, 16777216
    s_add_u32 s24, s6, s90
    s_addc_u32 s25, s7, 0
    s_add_u32 s90, s82, 33554432
    s_add_u32 s28, s6, s90
    s_addc_u32 s29, s7, 0
    s_cmp_eq_u32 s94, 1
    s_cbranch_scc1 m_w063
    s_mov_b32 s56, 32768
    s_mov_b32 s57, 16384
    s_add_u32 s59, s60, 65536
    s_mov_b32 m0, s59
    s_nop 0
    buffer_load_dwordx4 v7, s[24:27], s56 offen offset:0 sc1 lds
    buffer_load_dwordx4 v7, s[24:27], s56 offen offset:1024 sc1 lds
    buffer_load_dwordx4 v7, s[24:27], s56 offen offset:2048 sc1 lds
    buffer_load_dwordx4 v7, s[24:27], s56 offen offset:3072 sc1 lds
    s_add_u32 s56, s56, 16384
    s_add_u32 m0, s59, 16384
    s_nop 0
    buffer_load_dwordx4 v7, s[28:31], s57 offen offset:0 sc1 lds
    buffer_load_dwordx4 v7, s[28:31], s57 offen offset:1024 sc1 lds
    buffer_load_dwordx4 v7, s[28:31], s57 offen offset:2048 sc1 lds
    buffer_load_dwordx4 v7, s[28:31], s57 offen offset:3072 sc1 lds
    s_add_u32 s57, s57, 16384
    s_call_b64 s[20:21], m_epl61
    s_mov_b32 s17, s101
    s_mov_b32 s38, 268435456
    s_branch m_init25
m_w063:
    s_mov_b32 s56, 0
    s_mov_b32 s57, 0
    s_mov_b32 m0, s60
    s_nop 0
    buffer_load_dwordx4 v7, s[24:27], s56 offen offset:0 sc1 lds
    buffer_load_dwordx4 v7, s[24:27], s56 offen offset:1024 sc1 lds
    buffer_load_dwordx4 v7, s[24:27], s56 offen offset:2048 sc1 lds
    buffer_load_dwordx4 v7, s[24:27], s56 offen offset:3072 sc1 lds
    s_mov_b32 s56, 16384
    s_add_u32 s59, s60, 32768
    s_mov_b32 m0, s59
    s_nop 0
    buffer_load_dwordx4 v7, s[24:27], s56 offen offset:0 sc1 lds
    buffer_load_dwordx4 v7, s[24:27], s56 offen offset:1024 sc1 lds
    buffer_load_dwordx4 v7, s[24:27], s56 offen offset:2048 sc1 lds
    buffer_load_dwordx4 v7, s[24:27], s56 offen offset:3072 sc1 lds
    s_add_u32 s56, s56, 16384
    s_add_u32 m0, s59, 16384
    s_nop 0
    buffer_load_dwordx4 v7, s[28:31], s57 offen offset:0 sc1 lds
    buffer_load_dwordx4 v7, s[28:31], s57 offen offset:1024 sc1 lds
    buffer_load_dwordx4 v7, s[28:31], s57 offen offset:2048 sc1 lds
    buffer_load_dwordx4 v7, s[28:31], s57 offen offset:3072 sc1 lds
    s_add_u32 s57, s57, 16384
    s_add_u32 s59, s59, 32768
    s_mov_b32 m0, s59
    s_nop 0
    buffer_load_dwordx4 v7, s[24:27], s56 offen offset:0 sc1 lds
    buffer_load_dwordx4 v7, s[24:27], s56 offen offset:1024 sc1 lds
    buffer_load_dwordx4 v7, s[24:27], s56 offen offset:2048 sc1 lds
    buffer_load_dwordx4 v7, s[24:27], s56 offen offset:3072 sc1 lds
    s_add_u32 s56, s56, 16384
    s_add_u32 m0, s59, 16384
    s_nop 0
    buffer_load_dwordx4 v7, s[28:31], s57 offen offset:0 sc1 lds
    buffer_load_dwordx4 v7, s[28:31], s57 offen offset:1024 sc1 lds
    buffer_load_dwordx4 v7, s[28:31], s57 offen offset:2048 sc1 lds
    buffer_load_dwordx4 v7, s[28:31], s57 offen offset:3072 sc1 lds
    s_add_u32 s57, s57, 16384
    s_add_u32 s59, s59, 32768
    s_mov_b32 m0, s59
    s_nop 0
    buffer_load_dwordx4 v7, s[24:27], s56 offen offset:0 sc1 lds
    buffer_load_dwordx4 v7, s[24:27], s56 offen offset:1024 sc1 lds
    buffer_load_dwordx4 v7, s[24:27], s56 offen offset:2048 sc1 lds
    buffer_load_dwordx4 v7, s[24:27], s56 offen offset:3072 sc1 lds
    s_add_u32 s56, s56, 16384
    s_add_u32 m0, s59, 16384
    s_nop 0
    buffer_load_dwordx4 v7, s[28:31], s57 offen offset:0 sc1 lds
    buffer_load_dwordx4 v7, s[28:31], s57 offen offset:1024 sc1 lds
    buffer_load_dwordx4 v7, s[28:31], s57 offen offset:2048 sc1 lds
    buffer_load_dwordx4 v7, s[28:31], s57 offen offset:3072 sc1 lds
    s_add_u32 s57, s57, 16384
    s_add_u32 s59, s59, 32768
    s_waitcnt vmcnt(0)
    s_mov_b32 s38, 0
m_init25:
    s_mov_b32 s56, 65536
    s_mov_b32 s57, 49152
    s_nop 1
    v_mov_b32 v9, 0xff800000
    s_mov_b32 s65, 1233125376
    s_lshl_b32 s91, s16, 1
    s_sub_u32 s91, s91, 8
    s_lshl_b32 s78, s33, 3
    s_add_u32 s78, s78, s91
    s_lshl_b32 s79, s34, 3
    s_add_u32 s79, s79, s91
    s_mov_b32 s36, s6
    s_mov_b32 s37, s7
    s_mov_b32 s39, 0x20000
    s_load_dwordx2 s[48:49], s[0:1], 64
    s_load_dwordx2 s[50:51], s[0:1], 16
    s_load_dwordx2 s[54:55], s[0:1], 72
    s_mov_b32 s47, 0x20000
    s_lshl_b32 s90, s99, 1
    s_add_u32 s98, s98, s90
    s_lshl_b32 s90, s100, 2
    s_add_u32 s40, s98, s90
    s_lshr_b32 s90, s32, 1
    s_lshl_b32 s90, s90, 7
    s_add_u32 s90, s90, 117444608
    s_lshr_b32 s91, s2, 6
    s_lshl_b32 s91, s91, 8
    s_add_u32 s91, s91, 117446592
    v_min_u32 v10, 31, v1
    v_lshlrev_b32 v10, 3, v10
    v_mov_b32 v11, s90
    v_mov_b32 v8, s91
    v_cmp_gt_u32 vcc, 8, v1
    s_nop 1
    v_cndmask_b32 v11, v8, v11, vcc
    v_add_u32 v10, v10, v11
    s_mov_b32 s58, 0
    v_mov_b32 v6, v2
    v_accvgpr_write_b32 a0, 0
    v_accvgpr_write_b32 a1, 0
    v_accvgpr_write_b32 a2, 0
    v_accvgpr_write_b32 a3, 0
    v_accvgpr_write_b32 a4, 0
    v_accvgpr_write_b32 a5, 0
    v_accvgpr_write_b32 a6, 0
    v_accvgpr_write_b32 a7, 0
    v_accvgpr_write_b32 a8, 0
    v_accvgpr_write_b32 a9, 0
    v_accvgpr_write_b32 a10, 0
    v_accvgpr_write_b32 a11, 0
    v_accvgpr_write_b32 a12, 0
    v_accvgpr_write_b32 a13, 0
    v_accvgpr_write_b32 a14, 0
    v_accvgpr_write_b32 a15, 0
    v_accvgpr_write_b32 a16, 0
    v_accvgpr_write_b32 a17, 0
    v_accvgpr_write_b32 a18, 0
    v_accvgpr_write_b32 a19, 0
    v_accvgpr_write_b32 a20, 0
    v_accvgpr_write_b32 a21, 0
    v_accvgpr_write_b32 a22, 0
    v_accvgpr_write_b32 a23, 0
    v_accvgpr_write_b32 a24, 0
    v_accvgpr_write_b32 a25, 0
    v_accvgpr_write_b32 a26, 0
    v_accvgpr_write_b32 a27, 0
    v_accvgpr_write_b32 a28, 0
    v_accvgpr_write_b32 a29, 0
    v_accvgpr_write_b32 a30, 0
    v_accvgpr_write_b32 a31, 0
    v_accvgpr_write_b32 a32, 0
    v_accvgpr_write_b32 a33, 0
    v_accvgpr_write_b32 a34, 0
    v_accvgpr_write_b32 a35, 0
    v_accvgpr_write_b32 a36, 0
    v_accvgpr_write_b32 a37, 0
    v_accvgpr_write_b32 a38, 0
    v_accvgpr_write_b32 a39, 0
    v_accvgpr_write_b32 a40, 0
    v_accvgpr_write_b32 a41, 0
    v_accvgpr_write_b32 a42, 0
    v_accvgpr_write_b32 a43, 0
    v_accvgpr_write_b32 a44, 0
    v_accvgpr_write_b32 a45, 0
    v_accvgpr_write_b32 a46, 0
    v_accvgpr_write_b32 a47, 0
    v_accvgpr_write_b32 a48, 0
    v_accvgpr_write_b32 a49, 0
    v_accvgpr_write_b32 a50, 0
    v_accvgpr_write_b32 a51, 0
    v_accvgpr_write_b32 a52, 0
    v_accvgpr_write_b32 a53, 0
    v_accvgpr_write_b32 a54, 0
    v_accvgpr_write_b32 a55, 0
    v_accvgpr_write_b32 a56, 0
    v_accvgpr_write_b32 a57, 0
    v_accvgpr_write_b32 a58, 0
    v_accvgpr_write_b32 a59, 0
    v_accvgpr_write_b32 a60, 0
    v_accvgpr_write_b32 a61, 0
    v_accvgpr_write_b32 a62, 0
    v_accvgpr_write_b32 a63, 0
    v_accvgpr_write_b32 a64, 0
    v_accvgpr_write_b32 a65, 0
    v_accvgpr_write_b32 a66, 0
    v_accvgpr_write_b32 a67, 0
    v_accvgpr_write_b32 a68, 0
    v_accvgpr_write_b32 a69, 0
    v_accvgpr_write_b32 a70, 0
    v_accvgpr_write_b32 a71, 0
    v_accvgpr_write_b32 a72, 0
    v_accvgpr_write_b32 a73, 0
    v_accvgpr_write_b32 a74, 0
    v_accvgpr_write_b32 a75, 0
    v_accvgpr_write_b32 a76, 0
    v_accvgpr_write_b32 a77, 0
    v_accvgpr_write_b32 a78, 0
    v_accvgpr_write_b32 a79, 0
    v_accvgpr_write_b32 a80, 0
    v_accvgpr_write_b32 a81, 0
    v_accvgpr_write_b32 a82, 0
    v_accvgpr_write_b32 a83, 0
    v_accvgpr_write_b32 a84, 0
    v_accvgpr_write_b32 a85, 0
    v_accvgpr_write_b32 a86, 0
    v_accvgpr_write_b32 a87, 0
    v_accvgpr_write_b32 a88, 0
    v_accvgpr_write_b32 a89, 0
    v_accvgpr_write_b32 a90, 0
    v_accvgpr_write_b32 a91, 0
    v_accvgpr_write_b32 a92, 0
    v_accvgpr_write_b32 a93, 0
    v_accvgpr_write_b32 a94, 0
    v_accvgpr_write_b32 a95, 0
    v_accvgpr_write_b32 a96, 0
    v_accvgpr_write_b32 a97, 0
    v_accvgpr_write_b32 a98, 0
    v_accvgpr_write_b32 a99, 0
    v_accvgpr_write_b32 a100, 0
    v_accvgpr_write_b32 a101, 0
    v_accvgpr_write_b32 a102, 0
    v_accvgpr_write_b32 a103, 0
    v_accvgpr_write_b32 a104, 0
    v_accvgpr_write_b32 a105, 0
    v_accvgpr_write_b32 a106, 0
    v_accvgpr_write_b32 a107, 0
    v_accvgpr_write_b32 a108, 0
    v_accvgpr_write_b32 a109, 0
    v_accvgpr_write_b32 a110, 0
    v_accvgpr_write_b32 a111, 0
    v_accvgpr_write_b32 a112, 0
    v_accvgpr_write_b32 a113, 0
    v_accvgpr_write_b32 a114, 0
    v_accvgpr_write_b32 a115, 0
    v_accvgpr_write_b32 a116, 0
    v_accvgpr_write_b32 a117, 0
    v_accvgpr_write_b32 a118, 0
    v_accvgpr_write_b32 a119, 0
    v_accvgpr_write_b32 a120, 0
    v_accvgpr_write_b32 a121, 0
    v_accvgpr_write_b32 a122, 0
    v_accvgpr_write_b32 a123, 0
    v_accvgpr_write_b32 a124, 0
    v_accvgpr_write_b32 a125, 0
    v_accvgpr_write_b32 a126, 0
    v_accvgpr_write_b32 a127, 0
    v_mov_b32 v160, 0
    v_mov_b32 v161, 0
    v_mov_b32 v162, 0
    v_mov_b32 v163, 0
    v_mov_b32 v164, 0
    v_mov_b32 v165, 0
    v_mov_b32 v166, 0
    v_mov_b32 v167, 0
    v_mov_b32 v168, 0
    v_mov_b32 v169, 0
    v_mov_b32 v170, 0
    v_mov_b32 v171, 0
    v_mov_b32 v172, 0
    v_mov_b32 v173, 0
    v_mov_b32 v174, 0
    v_mov_b32 v175, 0
    v_mov_b32 v176, 0
    v_mov_b32 v177, 0
    v_mov_b32 v178, 0
    v_mov_b32 v179, 0
    v_mov_b32 v180, 0
    v_mov_b32 v181, 0
    v_mov_b32 v182, 0
    v_mov_b32 v183, 0
    v_mov_b32 v184, 0
    v_mov_b32 v185, 0
    v_mov_b32 v186, 0
    v_mov_b32 v187, 0
    v_mov_b32 v188, 0
    v_mov_b32 v189, 0
    v_mov_b32 v190, 0
    v_mov_b32 v191, 0
    v_mov_b32 v12, 0
    v_mov_b32 v28, 0
    v_mov_b32 v44, 0x3f803f80
    v_mov_b32 v13, 0
    v_mov_b32 v32, 0
    v_mov_b32 v45, 0x3f803f80
    v_mov_b32 v14, 0
    v_mov_b32 v36, 0
    v_mov_b32 v46, 0x3f803f80
    v_mov_b32 v15, 0
    v_mov_b32 v40, 0
    v_mov_b32 v47, 0x3f803f80
    s_and_b32 s90, s2, 7
    s_lshl_b32 s90, s90, 4
    s_lshl_b32 s91, s16, 2
    s_add_u32 s80, s90, s91
    s_lshr_b32 s92, s2, 3
    s_lshl_b32 s92, s92, 17
    s_lshl_b32 s90, s80, 10
    s_add_u32 s90, s90, s92
    s_add_u32 s83, s90, 50331648
    s_add_u32 s84, s90, 54525952
    s_and_b32 s81, s80, 63
    s_cmp_eq_u32 s81, 0
    s_cselect_b32 s93, 0, 1024
    s_sub_u32 s85, s84, s93
    s_lshl_b32 s90, s80, 9
    s_add_u32 s90, s90, s92
    s_add_u32 s86, s90, 58720256
    s_sub_u32 s87, s86, s93
    s_add_u32 s88, s86, 65536
    s_add_u32 s89, s87, 65536
    v_and_b32 v48, 15, v1
    v_lshrrev_b32 v49, 4, v1
    v_lshlrev_b32 v49, 2, v49
    v_sub_u32 v48, v48, v49
    v_cmp_le_i32 vcc, 0, v48
    s_nop 1
    v_cndmask_b32 v16, v9, 0, vcc
    v_cmp_le_i32 vcc, 1, v48
    s_nop 1
    v_cndmask_b32 v17, v9, 0, vcc
    v_cmp_le_i32 vcc, 2, v48
    s_nop 1
    v_cndmask_b32 v18, v9, 0, vcc
    v_cmp_le_i32 vcc, 3, v48
    s_nop 1
    v_cndmask_b32 v19, v9, 0, vcc
    s_mov_b32 s62, 35782688
    s_mov_b32 s63, 0
    s_sub_u32 s90, s67, 1
    s_bitset1_b64 s[62:63], s90
    s_sub_u32 s90, s68, 1
    s_bitset1_b64 s[62:63], s90
    s_sub_u32 s90, s69, 1
    s_bitset1_b64 s[62:63], s90
    s_sub_u32 s90, s70, 1
    s_bitset1_b64 s[62:63], s90
    s_sub_u32 s90, s71, 1
    s_bitset1_b64 s[62:63], s90
    s_sub_u32 s90, s72, 1
    s_bitset1_b64 s[62:63], s90
    s_sub_u32 s52, s72, 6
    s_sub_u32 s90, s52, 1
    s_bitset1_b64 s[62:63], s90
    s_add_u32 s53, s69, 6
    s_sub_u32 s90, s53, 1
    s_bitset1_b64 s[62:63], s90
    s_mov_b32 s64, 0
    s_cmp_lg_u32 s64, s67
    s_cbranch_scc1 m_e68
    v_add_f32 v176, v176, v16
    v_mov_b32 v180, v9
    v_add_f32 v188, v188, v16
    v_add_f32 v177, v177, v17
    v_mov_b32 v181, v9
    v_add_f32 v189, v189, v17
    v_add_f32 v178, v178, v18
    v_mov_b32 v182, v9
    v_add_f32 v190, v190, v18
    v_add_f32 v179, v179, v19
    v_mov_b32 v183, v9
    v_add_f32 v191, v191, v19
    s_nop 0
m_e68:
    s_waitcnt vmcnt(24) lgkmcnt(0)
    s_barrier
    ds_read_b128 a[192:195], v6 offset:0
    ds_read_b128 a[196:199], v6 offset:1024
    ds_read_b128 a[200:203], v6 offset:2048
    ds_read_b128 a[204:207], v6 offset:3072
    ds_read_b128 a[208:211], v6 offset:4096
    ds_read_b128 a[212:215], v6 offset:5120
    ds_read_b128 a[216:219], v6 offset:6144
    ds_read_b128 a[220:223], v6 offset:7168
    s_waitcnt lgkmcnt(0)
    v_mfma_f32_16x16x32_bf16 v[64:67], a[192:195], a[128:131], v[160:163]
    v_mfma_f32_16x16x32_bf16 v[64:67], a[196:199], a[132:135], v[64:67]
    buffer_store_dwordx4 v[192:195], v2, s[36:39], s40 offen sc1
    s_add_u32 s40, s40, s100
    v_mfma_f32_16x16x32_bf16 v[64:67], a[200:203], a[136:139], v[64:67]
    v_mfma_f32_16x16x32_bf16 v[64:67], a[204:207], a[140:143], v[64:67]
    v_mfma_f32_16x16x32_bf16 v[72:75], a[192:195], a[144:147], v[168:171]
    v_mfma_f32_16x16x32_bf16 v[72:75], a[196:199], a[148:151], v[72:75]
    buffer_store_dwordx4 v[196:199], v2, s[36:39], s40 offen sc1
    s_add_u32 s40, s40, s100
    v_mfma_f32_16x16x32_bf16 v[72:75], a[200:203], a[152:155], v[72:75]
    v_mfma_f32_16x16x32_bf16 v[72:75], a[204:207], a[156:159], v[72:75]
    v_mfma_f32_16x16x32_bf16 v[80:83], a[192:195], a[160:163], v[176:179]
    v_mfma_f32_16x16x32_bf16 v[80:83], a[196:199], a[164:167], v[80:83]
    buffer_store_dwordx4 v[200:203], v2, s[36:39], s40 offen sc1
    s_add_u32 s40, s40, s100
    v_mfma_f32_16x16x32_bf16 v[80:83], a[200:203], a[168:171], v[80:83]
    v_mfma_f32_16x16x32_bf16 v[80:83], a[204:207], a[172:175], v[80:83]
    v_mfma_f32_16x16x32_bf16 v[88:91], a[192:195], a[176:179], v[184:187]
    v_mfma_f32_16x16x32_bf16 v[88:91], a[196:199], a[180:183], v[88:91]
    buffer_store_dwordx4 v[204:207], v2, s[36:39], s40 offen sc1
    s_add_u32 s40, s98, s99
    v_mfma_f32_16x16x32_bf16 v[88:91], a[200:203], a[184:187], v[88:91]
    v_mfma_f32_16x16x32_bf16 v[88:91], a[204:207], a[188:191], v[88:91]
    v_mfma_f32_16x16x32_bf16 v[68:71], a[208:211], a[128:131], v[164:167]
    ds_read_b128 a[192:195], v6 offset:8192
    v_mfma_f32_16x16x32_bf16 v[68:71], a[212:215], a[132:135], v[68:71]
    buffer_store_dwordx4 v[208:211], v2, s[36:39], s40 offen sc1
    s_add_u32 s40, s40, s100
    ds_read_b128 a[196:199], v6 offset:9216
    v_mfma_f32_16x16x32_bf16 v[68:71], a[216:219], a[136:139], v[68:71]
    ds_read_b128 a[200:203], v6 offset:10240
    v_mfma_f32_16x16x32_bf16 v[68:71], a[220:223], a[140:143], v[68:71]
    ds_read_b128 a[204:207], v6 offset:11264
    v_mfma_f32_16x16x32_bf16 v[76:79], a[208:211], a[144:147], v[172:175]
    v_mfma_f32_16x16x32_bf16 v[76:79], a[212:215], a[148:151], v[76:79]
    buffer_store_dwordx4 v[212:215], v2, s[36:39], s40 offen sc1
    s_add_u32 s40, s40, s100
    v_mfma_f32_16x16x32_bf16 v[76:79], a[216:219], a[152:155], v[76:79]
    v_mfma_f32_16x16x32_bf16 v[76:79], a[220:223], a[156:159], v[76:79]
    v_mfma_f32_16x16x32_bf16 v[84:87], a[208:211], a[160:163], v[180:183]
    v_mfma_f32_16x16x32_bf16 v[84:87], a[212:215], a[164:167], v[84:87]
    buffer_store_dwordx4 v[216:219], v2, s[36:39], s40 offen sc1
    s_add_u32 s40, s40, s100
    v_mfma_f32_16x16x32_bf16 v[84:87], a[216:219], a[168:171], v[84:87]
    v_mfma_f32_16x16x32_bf16 v[84:87], a[220:223], a[172:175], v[84:87]
    v_mfma_f32_16x16x32_bf16 v[92:95], a[208:211], a[176:179], v[188:191]
    v_mfma_f32_16x16x32_bf16 v[92:95], a[212:215], a[180:183], v[92:95]
    buffer_store_dwordx4 v[220:223], v2, s[36:39], s40 offen sc1
    s_add_u32 s40, s40, s100
    v_mfma_f32_16x16x32_bf16 v[92:95], a[216:219], a[184:187], v[92:95]
    v_mfma_f32_16x16x32_bf16 v[92:95], a[220:223], a[188:191], v[92:95]
    ds_read_b128 a[208:211], v6 offset:12288
    ds_read_b128 a[212:215], v6 offset:13312
    ds_read_b128 a[216:219], v6 offset:14336
    ds_read_b128 a[220:223], v6 offset:15360
    s_mov_b32 s64, 1
    s_nop 0
    s_nop 3
    v_max3_f32 v48, v64, v65, v66
    v_max3_f32 v49, v72, v73, v74
    v_max3_f32 v50, v80, v81, v82
    v_max3_f32 v51, v88, v89, v90
    v_max3_f32 v48, v48, v67, v68
    v_max3_f32 v49, v49, v75, v76
    v_max3_f32 v50, v50, v83, v84
    v_max3_f32 v51, v51, v91, v92
    v_max3_f32 v48, v48, v69, v70
    v_max3_f32 v49, v49, v77, v78
    v_max3_f32 v50, v50, v85, v86
    v_max3_f32 v51, v51, v93, v94
    v_max_f32 v48, v48, v71
    v_max_f32 v49, v49, v79
    v_max_f32 v50, v50, v87
    v_max_f32 v51, v51, v95
    v_mov_b32 v52, v48
    v_mov_b32 v53, v49
    v_mov_b32 v54, v50
    v_mov_b32 v55, v51
    s_nop 1
    v_permlane32_swap_b32 v48, v52
    v_permlane32_swap_b32 v49, v53
    v_permlane32_swap_b32 v50, v54
    v_permlane32_swap_b32 v51, v55
    s_nop 1
    v_max_f32 v48, v48, v52
    v_max_f32 v49, v49, v53
    v_max_f32 v50, v50, v54
    v_max_f32 v51, v51, v55
    v_mov_b32 v52, v48
    v_mov_b32 v53, v49
    v_mov_b32 v54, v50
    v_mov_b32 v55, v51
    s_nop 1
    v_permlane16_swap_b32 v48, v52
    v_permlane16_swap_b32 v49, v53
    v_permlane16_swap_b32 v50, v54
    v_permlane16_swap_b32 v51, v55
    s_nop 1
    v_max_f32 v48, v48, v52
    v_max_f32 v49, v49, v53
    v_max_f32 v50, v50, v54
    v_max_f32 v51, v51, v55
    v_sub_f32 v160, v160, v48
    v_sub_f32 v161, v161, v48
    v_sub_f32 v162, v162, v48
    v_sub_f32 v163, v163, v48
    v_sub_f32 v164, v164, v48
    v_sub_f32 v165, v165, v48
    v_sub_f32 v166, v166, v48
    v_sub_f32 v167, v167, v48
    v_sub_f32 v168, v168, v49
    v_sub_f32 v169, v169, v49
    v_sub_f32 v170, v170, v49
    v_sub_f32 v171, v171, v49
    v_sub_f32 v172, v172, v49
    v_sub_f32 v173, v173, v49
    v_sub_f32 v174, v174, v49
    v_sub_f32 v175, v175, v49
    v_sub_f32 v176, v176, v50
    v_sub_f32 v177, v177, v50
    v_sub_f32 v178, v178, v50
    v_sub_f32 v179, v179, v50
    v_sub_f32 v180, v180, v50
    v_sub_f32 v181, v181, v50
    v_sub_f32 v182, v182, v50
    v_sub_f32 v183, v183, v50
    v_sub_f32 v184, v184, v51
    v_sub_f32 v185, v185, v51
    v_sub_f32 v186, v186, v51
    v_sub_f32 v187, v187, v51
    v_sub_f32 v188, v188, v51
    v_sub_f32 v189, v189, v51
    v_sub_f32 v190, v190, v51
    v_sub_f32 v191, v191, v51
    v_sub_f32 v64, v64, v48
    v_sub_f32 v65, v65, v48
    v_sub_f32 v66, v66, v48
    v_sub_f32 v67, v67, v48
    v_sub_f32 v68, v68, v48
    v_sub_f32 v69, v69, v48
    v_sub_f32 v70, v70, v48
    v_sub_f32 v71, v71, v48
    v_sub_f32 v72, v72, v49
    v_sub_f32 v73, v73, v49
    v_sub_f32 v74, v74, v49
    v_sub_f32 v75, v75, v49
    v_sub_f32 v76, v76, v49
    v_sub_f32 v77, v77, v49
    v_sub_f32 v78, v78, v49
    v_sub_f32 v79, v79, v49
    v_sub_f32 v80, v80, v50
    v_sub_f32 v81, v81, v50
    v_sub_f32 v82, v82, v50
    v_sub_f32 v83, v83, v50
    v_sub_f32 v84, v84, v50
    v_sub_f32 v85, v85, v50
    v_sub_f32 v86, v86, v50
    v_sub_f32 v87, v87, v50
    v_sub_f32 v88, v88, v51
    v_sub_f32 v89, v89, v51
    v_sub_f32 v90, v90, v51
    v_sub_f32 v91, v91, v51
    v_sub_f32 v92, v92, v51
    v_sub_f32 v93, v93, v51
    v_sub_f32 v94, v94, v51
    v_sub_f32 v95, v95, v51
    s_cmp_lg_u32 s64, s67
    s_cbranch_scc1 m_e69
    v_add_f32 v176, v176, v16
    v_mov_b32 v180, v9
    v_add_f32 v188, v188, v16
    v_add_f32 v177, v177, v17
    v_mov_b32 v181, v9
    v_add_f32 v189, v189, v17
    v_add_f32 v178, v178, v18
    v_mov_b32 v182, v9
    v_add_f32 v190, v190, v18
    v_add_f32 v179, v179, v19
    v_mov_b32 v183, v9
    v_add_f32 v191, v191, v19
    s_nop 0
m_e69:
    s_cmp_lg_u32 s64, s68
    s_cbranch_scc1 m_e70
    v_mov_b32 v176, v9
    v_mov_b32 v184, v9
    v_mov_b32 v188, v9
    v_mov_b32 v177, v9
    v_mov_b32 v185, v9
    v_mov_b32 v189, v9
    v_mov_b32 v178, v9
    v_mov_b32 v186, v9
    v_mov_b32 v190, v9
    v_mov_b32 v179, v9
    v_mov_b32 v187, v9
    v_mov_b32 v191, v9
    s_nop 0
m_e70:
    s_waitcnt lgkmcnt(0)
    v_mfma_f32_16x16x32_bf16 v[96:99], a[192:195], a[128:131], v[160:163]
    s_bitcmp1_b64 s[62:63], s64
    s_cselect_b32 s66, -1.0, s65
    v_exp_f32 v20, v64
    v_mfma_f32_16x16x32_bf16 v[96:99], a[196:199], a[132:135], v[96:99]
    s_add_u32 s64, s64, 1
    v_exp_f32 v21, v65
    v_exp_f32 v22, v66
    v_mfma_f32_16x16x32_bf16 v[96:99], a[200:203], a[136:139], v[96:99]
    buffer_store_dwordx4 v[224:227], v2, s[36:39], s40 offen sc1
    v_cvt_pk_bf16_f32 v128, v20, v21
    v_mfma_f32_16x16x32_bf16 v[96:99], a[204:207], a[140:143], v[96:99]
    s_add_u32 s40, s40, s100
    v_add_f32 v12, v12, v28
    v_exp_f32 v23, v67
    v_mfma_f32_16x16x32_bf16 v[104:107], a[192:195], a[144:147], v[168:171]
    v_exp_f32 v24, v68
    v_cvt_pk_bf16_f32 v129, v22, v23
    v_mfma_f32_16x16x32_bf16 v[104:107], a[196:199], a[148:151], v[104:107]
    buffer_store_dwordx4 v[228:231], v2, s[36:39], s40 offen sc1
    v_exp_f32 v25, v69
    v_mfma_f32_16x16x32_bf16 v[104:107], a[200:203], a[152:155], v[104:107]
    s_add_u32 s40, s40, s100
    v_exp_f32 v26, v70
    v_cvt_pk_bf16_f32 v130, v24, v25
    v_mfma_f32_16x16x32_bf16 v[104:107], a[204:207], a[156:159], v[104:107]
    v_exp_f32 v27, v71
    v_add_f32 v13, v13, v32
    v_mfma_f32_16x16x32_bf16 v[112:115], a[192:195], a[160:163], v[176:179]
    v_exp_f32 v20, v72
    v_cvt_pk_bf16_f32 v131, v26, v27
    v_mfma_f32_16x16x32_bf16 v[112:115], a[196:199], a[164:167], v[112:115]
    buffer_store_dwordx4 v[232:235], v2, s[36:39], s40 offen sc1
    v_exp_f32 v21, v73
    v_mfma_f32_16x16x32_bf16 v[28:31], v[44:47], v[128:131], 0
    v_exp_f32 v22, v74
    v_cvt_pk_bf16_f32 v132, v20, v21
    v_mfma_f32_16x16x32_bf16 v[112:115], a[200:203], a[168:171], v[112:115]
    s_add_u32 s40, s40, s100
    v_exp_f32 v23, v75
    v_add_f32 v14, v14, v36
    v_mfma_f32_16x16x32_bf16 v[112:115], a[204:207], a[172:175], v[112:115]
    v_exp_f32 v24, v76
    v_cvt_pk_bf16_f32 v133, v22, v23
    v_mfma_f32_16x16x32_bf16 v[120:123], a[192:195], a[176:179], v[184:187]
    buffer_store_dwordx4 v[236:239], v2, s[36:39], s40 offen sc1
    v_exp_f32 v25, v77
    v_mfma_f32_16x16x32_bf16 v[120:123], a[196:199], a[180:183], v[120:123]
    s_mov_b32 s40, s98
    v_exp_f32 v26, v78
    v_cvt_pk_bf16_f32 v134, v24, v25
    v_mfma_f32_16x16x32_bf16 v[120:123], a[200:203], a[184:187], v[120:123]
    v_exp_f32 v27, v79
    v_add_f32 v15, v15, v40
    v_mfma_f32_16x16x32_bf16 v[120:123], a[204:207], a[188:191], v[120:123]
    s_waitcnt lgkmcnt(0)
    v_exp_f32 v20, v80
    v_cvt_pk_bf16_f32 v135, v26, v27
    v_mfma_f32_16x16x32_bf16 v[100:103], a[208:211], a[128:131], v[164:167]
    v_exp_f32 v21, v81
    v_exp_f32 v22, v82
    v_mfma_f32_16x16x32_bf16 v[32:35], v[44:47], v[132:135], 0
    v_cvt_pk_bf16_f32 v136, v20, v21
    v_exp_f32 v23, v83
    v_mfma_f32_16x16x32_bf16 v[100:103], a[212:215], a[132:135], v[100:103]
    buffer_store_dwordx4 v[240:243], v2, s[36:39], s40 offen sc1
    v_cvt_pk_bf16_f32 v137, v22, v23
    v_mfma_f32_16x16x32_bf16 v[100:103], a[216:219], a[136:139], v[100:103]
    s_add_u32 s40, s40, s100
    v_exp_f32 v24, v84
    v_mfma_f32_16x16x32_bf16 v[100:103], a[220:223], a[140:143], v[100:103]
    v_exp_f32 v25, v85
    v_exp_f32 v26, v86
    v_cvt_pk_bf16_f32 v138, v24, v25
    v_mfma_f32_16x16x32_bf16 v[108:111], a[208:211], a[144:147], v[172:175]
    buffer_store_dwordx4 v[244:247], v2, s[36:39], s40 offen sc1
    v_mfma_f32_16x16x32_bf16 v[108:111], a[212:215], a[148:151], v[108:111]
    s_add_u32 s40, s40, s100
    v_exp_f32 v27, v87
    v_exp_f32 v20, v88
    v_mfma_f32_16x16x32_bf16 v[108:111], a[216:219], a[152:155], v[108:111]
    v_cvt_pk_bf16_f32 v139, v26, v27
    v_exp_f32 v21, v89
    v_mfma_f32_16x16x32_bf16 v[108:111], a[220:223], a[156:159], v[108:111]
    buffer_store_dwordx4 v[248:251], v2, s[36:39], s40 offen sc1
    v_exp_f32 v22, v90
    v_mfma_f32_16x16x32_bf16 v[36:39], v[44:47], v[136:139], 0
    v_cvt_pk_bf16_f32 v140, v20, v21
    v_exp_f32 v23, v91
    v_mfma_f32_16x16x32_bf16 v[116:119], a[208:211], a[160:163], v[180:183]
    s_add_u32 s40, s40, s100
    v_exp_f32 v24, v92
    v_cvt_pk_bf16_f32 v141, v22, v23
    v_mfma_f32_16x16x32_bf16 v[116:119], a[212:215], a[164:167], v[116:119]
    v_exp_f32 v25, v93
    v_mfma_f32_16x16x32_bf16 v[116:119], a[216:219], a[168:171], v[116:119]
    buffer_store_dwordx4 v[252:255], v2, s[36:39], s40 offen sc1
    v_exp_f32 v26, v94
    v_cvt_pk_bf16_f32 v142, v24, v25
    v_mfma_f32_16x16x32_bf16 v[116:119], a[220:223], a[172:175], v[116:119]
    s_add_u32 s40, s40, s100
    v_exp_f32 v27, v95
    s_nop 0
    v_cvt_pk_bf16_f32 v143, v26, v27
    s_nop 1
    v_mfma_f32_16x16x32_bf16 v[40:43], v[44:47], v[140:143], 0
    s_nop 2
    v_mfma_f32_16x16x32_bf16 v[124:127], a[208:211], a[176:179], v[188:191]
    s_nop 2
    v_mfma_f32_16x16x32_bf16 v[124:127], a[212:215], a[180:183], v[124:127]
    v_max3_f32 v8, v28, v32, v36
    v_max_f32 v8, v8, v40
    v_mfma_f32_16x16x32_bf16 v[124:127], a[216:219], a[184:187], v[124:127]
    v_cmp_nge_f32 vcc, s66, v8
    v_mfma_f32_16x16x32_bf16 v[124:127], a[220:223], a[188:191], v[124:127]
    s_waitcnt vmcnt(40) lgkmcnt(0)
    s_barrier
    s_add_u32 s59, s58, s60
    s_add_u32 s58, s58, 32768
    s_and_b32 s58, s58, 0x1ffff
    v_add_u32 v6, s58, v2
    ds_read_b128 a[192:195], v6 offset:0
    ds_read_b128 a[196:199], v6 offset:1024
    ds_read_b128 a[200:203], v6 offset:2048
    ds_read_b128 a[204:207], v6 offset:3072
    ds_read_b128 a[208:211], v6 offset:4096
    ds_read_b128 a[212:215], v6 offset:5120
    ds_read_b128 a[216:219], v6 offset:6144
    ds_read_b128 a[220:223], v6 offset:7168
    s_waitcnt lgkmcnt(0)
    s_cbranch_vccnz m_stub71
m_ret72:
m_dual73:
    v_mfma_f32_16x16x32_bf16 v[64:67], a[192:195], a[128:131], v[160:163]
    s_bitcmp1_b64 s[62:63], s64
    s_cselect_b32 s66, -1.0, s65
    v_add_f32 v12, v12, v28
    v_mfma_f32_16x16x32_bf16 v[64:67], a[196:199], a[132:135], v[64:67]
    s_add_u32 s64, s64, 1
    ds_read_b128 a[224:227], v6 offset:16384
    v_add_f32 v13, v13, v32
    v_mfma_f32_16x16x32_bf16 v[64:67], a[200:203], a[136:139], v[64:67]
    v_exp_f32 v20, v96
    v_mfma_f32_16x16x32_bf16 v[64:67], a[204:207], a[140:143], v[64:67]
    v_exp_f32 v21, v97
    v_mfma_f32_16x16x32_bf16 v[72:75], a[192:195], a[144:147], v[168:171]
    s_mov_b32 m0, s59
    ds_read_b128 a[228:231], v6 offset:17408
    v_cvt_pk_bf16_f32 v144, v20, v21
    v_mfma_f32_16x16x32_bf16 v[72:75], a[196:199], a[148:151], v[72:75]
    buffer_load_dwordx4 v7, s[24:27], s56 offen offset:0 sc1 lds
    v_mfma_f32_16x16x32_bf16 v[72:75], a[200:203], a[152:155], v[72:75]
    v_exp_f32 v22, v98
    v_mfma_f32_16x16x32_bf16 v[72:75], a[204:207], a[156:159], v[72:75]
    ds_read_b128 a[232:235], v6 offset:18432
    v_add_f32 v14, v14, v36
    v_mfma_f32_16x16x32_bf16 v[80:83], a[192:195], a[160:163], v[176:179]
    v_exp_f32 v23, v99
    v_mfma_f32_16x16x32_bf16 v[80:83], a[196:199], a[164:167], v[80:83]
    v_exp_f32 v24, v100
    v_mfma_f32_16x16x32_bf16 v[80:83], a[200:203], a[168:171], v[80:83]
    ds_read_b128 a[236:239], v6 offset:19456
    v_cvt_pk_bf16_f32 v145, v22, v23
    v_mfma_f32_16x16x32_bf16 v[80:83], a[204:207], a[172:175], v[80:83]
    v_exp_f32 v25, v101
    v_mfma_f32_16x16x32_bf16 v[88:91], a[192:195], a[176:179], v[184:187]
    v_exp_f32 v26, v102
    v_mfma_f32_16x16x32_bf16 v[88:91], a[196:199], a[180:183], v[88:91]
    ds_read_b128 a[240:243], v6 offset:20480
    v_cvt_pk_bf16_f32 v146, v24, v25
    v_mfma_f32_16x16x32_bf16 v[88:91], a[200:203], a[184:187], v[88:91]
    v_exp_f32 v27, v103
    v_mfma_f32_16x16x32_bf16 v[88:91], a[204:207], a[188:191], v[88:91]
    s_waitcnt lgkmcnt(5)
    v_exp_f32 v20, v104
    v_mfma_f32_16x16x32_bf16 v[68:71], a[208:211], a[128:131], v[164:167]
    ds_read_b128 a[244:247], v6 offset:21504
    v_cvt_pk_bf16_f32 v147, v26, v27
    v_mfma_f32_16x16x32_bf16 v[68:71], a[212:215], a[132:135], v[68:71]
    v_exp_f32 v21, v105
    v_mfma_f32_16x16x32_bf16 v[28:31], v[44:47], v[144:147], 0
    v_exp_f32 v22, v106
    v_mfma_f32_16x16x32_bf16 v[68:71], a[216:219], a[136:139], v[68:71]
    buffer_load_dwordx4 v7, s[24:27], s56 offen offset:1024 sc1 lds
    v_mfma_f32_16x16x32_bf16 v[68:71], a[220:223], a[140:143], v[68:71]
    ds_read_b128 a[248:251], v6 offset:22528
    v_cvt_pk_bf16_f32 v148, v20, v21
    v_mfma_f32_16x16x32_bf16 v[76:79], a[208:211], a[144:147], v[172:175]
    v_exp_f32 v23, v107
    v_mfma_f32_16x16x32_bf16 v[76:79], a[212:215], a[148:151], v[76:79]
    v_exp_f32 v24, v108
    v_mfma_f32_16x16x32_bf16 v[76:79], a[216:219], a[152:155], v[76:79]
    ds_read_b128 a[252:255], v6 offset:23552
    v_cvt_pk_bf16_f32 v149, v22, v23
    v_mfma_f32_16x16x32_bf16 v[76:79], a[220:223], a[156:159], v[76:79]
    v_exp_f32 v25, v109
    v_mfma_f32_16x16x32_bf16 v[84:87], a[208:211], a[160:163], v[180:183]
    v_exp_f32 v26, v110
    v_mfma_f32_16x16x32_bf16 v[84:87], a[212:215], a[164:167], v[84:87]
    v_cvt_pk_bf16_f32 v150, v24, v25
    v_add_f32 v15, v15, v40
    v_mfma_f32_16x16x32_bf16 v[84:87], a[216:219], a[168:171], v[84:87]
    v_exp_f32 v27, v111
    v_mfma_f32_16x16x32_bf16 v[84:87], a[220:223], a[172:175], v[84:87]
    buffer_load_dwordx4 v7, s[24:27], s56 offen offset:2048 sc1 lds
    v_mfma_f32_16x16x32_bf16 v[92:95], a[208:211], a[176:179], v[188:191]
    v_exp_f32 v20, v112
    v_mfma_f32_16x16x32_bf16 v[92:95], a[212:215], a[180:183], v[92:95]
    v_cvt_pk_bf16_f32 v151, v26, v27
    v_mfma_f32_16x16x32_bf16 v[92:95], a[216:219], a[184:187], v[92:95]
    v_exp_f32 v21, v113
    v_mfma_f32_16x16x32_bf16 v[32:35], v[44:47], v[148:151], 0
    v_exp_f32 v22, v114
    v_mfma_f32_16x16x32_bf16 v[92:95], a[220:223], a[188:191], v[92:95]
    s_waitcnt lgkmcnt(0)
    v_cvt_pk_bf16_f32 v152, v20, v21
    v_mfma_f32_16x16x32_bf16 a[0:3], a[224:227], v[128:131], a[0:3]
    ds_read_b128 a[192:195], v6 offset:8192
    v_mfma_f32_16x16x32_bf16 a[32:35], a[224:227], v[132:135], a[32:35]
    v_exp_f32 v23, v115
    v_mfma_f32_16x16x32_bf16 a[64:67], a[224:227], v[136:139], a[64:67]
    v_exp_f32 v24, v116
    v_mfma_f32_16x16x32_bf16 a[96:99], a[224:227], v[140:143], a[96:99]
    ds_read_b128 a[196:199], v6 offset:9216
    v_cvt_pk_bf16_f32 v153, v22, v23
    v_mfma_f32_16x16x32_bf16 a[4:7], a[228:231], v[128:131], a[4:7]
    v_exp_f32 v25, v117
    v_mfma_f32_16x16x32_bf16 a[36:39], a[228:231], v[132:135], a[36:39]
    v_exp_f32 v26, v118
    v_mfma_f32_16x16x32_bf16 a[68:71], a[228:231], v[136:139], a[68:71]
    ds_read_b128 a[200:203], v6 offset:10240
    v_cvt_pk_bf16_f32 v154, v24, v25
    v_mfma_f32_16x16x32_bf16 a[100:103], a[228:231], v[140:143], a[100:103]
    v_exp_f32 v27, v119
    v_mfma_f32_16x16x32_bf16 a[8:11], a[232:235], v[128:131], a[8:11]
    v_exp_f32 v20, v120
    v_mfma_f32_16x16x32_bf16 a[40:43], a[232:235], v[132:135], a[40:43]
    ds_read_b128 a[204:207], v6 offset:11264
    v_cvt_pk_bf16_f32 v155, v26, v27
    v_mfma_f32_16x16x32_bf16 a[72:75], a[232:235], v[136:139], a[72:75]
    v_exp_f32 v21, v121
    v_mfma_f32_16x16x32_bf16 v[36:39], v[44:47], v[152:155], 0
    v_exp_f32 v22, v122
    v_mfma_f32_16x16x32_bf16 a[104:107], a[232:235], v[140:143], a[104:107]
    buffer_load_dwordx4 v7, s[24:27], s56 offen offset:3072 sc1 lds
    v_mfma_f32_16x16x32_bf16 a[12:15], a[236:239], v[128:131], a[12:15]
    s_add_u32 s56, s56, 16384
    v_cvt_pk_bf16_f32 v156, v20, v21
    v_mfma_f32_16x16x32_bf16 a[44:47], a[236:239], v[132:135], a[44:47]
    v_exp_f32 v23, v123
    v_mfma_f32_16x16x32_bf16 a[76:79], a[236:239], v[136:139], a[76:79]
    v_exp_f32 v24, v124
    v_mfma_f32_16x16x32_bf16 a[108:111], a[236:239], v[140:143], a[108:111]
    v_cvt_pk_bf16_f32 v157, v22, v23
    v_mfma_f32_16x16x32_bf16 a[16:19], a[240:243], v[128:131], a[16:19]
    v_exp_f32 v25, v125
    v_mfma_f32_16x16x32_bf16 a[48:51], a[240:243], v[132:135], a[48:51]
    v_exp_f32 v26, v126
    v_mfma_f32_16x16x32_bf16 a[80:83], a[240:243], v[136:139], a[80:83]
    v_cvt_pk_bf16_f32 v158, v24, v25
    v_mfma_f32_16x16x32_bf16 a[112:115], a[240:243], v[140:143], a[112:115]
    s_add_u32 m0, s59, 16384
    v_exp_f32 v27, v127
    v_mfma_f32_16x16x32_bf16 a[20:23], a[244:247], v[128:131], a[20:23]
    buffer_load_dwordx4 v7, s[28:31], s57 offen offset:0 sc1 lds
    v_mfma_f32_16x16x32_bf16 a[52:55], a[244:247], v[132:135], a[52:55]
    v_cvt_pk_bf16_f32 v159, v26, v27
    v_mfma_f32_16x16x32_bf16 a[84:87], a[244:247], v[136:139], a[84:87]
    v_mfma_f32_16x16x32_bf16 a[116:119], a[244:247], v[140:143], a[116:119]
    v_mfma_f32_16x16x32_bf16 v[40:43], v[44:47], v[156:159], 0
    s_nop 2
    v_mfma_f32_16x16x32_bf16 a[24:27], a[248:251], v[128:131], a[24:27]
    s_nop 2
    v_mfma_f32_16x16x32_bf16 a[56:59], a[248:251], v[132:135], a[56:59]
    v_max3_f32 v8, v28, v32, v36
    v_max_f32 v8, v8, v40
    v_mfma_f32_16x16x32_bf16 a[88:91], a[248:251], v[136:139], a[88:91]
    v_cmp_nge_f32 vcc, s66, v8
    v_mfma_f32_16x16x32_bf16 a[120:123], a[248:251], v[140:143], a[120:123]
    ds_read_b128 a[208:211], v6 offset:12288
    v_mfma_f32_16x16x32_bf16 a[28:31], a[252:255], v[128:131], a[28:31]
    ds_read_b128 a[212:215], v6 offset:13312
    v_mfma_f32_16x16x32_bf16 a[60:63], a[252:255], v[132:135], a[60:63]
    ds_read_b128 a[216:219], v6 offset:14336
    v_mfma_f32_16x16x32_bf16 a[92:95], a[252:255], v[136:139], a[92:95]
    ds_read_b128 a[220:223], v6 offset:15360
    v_mfma_f32_16x16x32_bf16 a[124:127], a[252:255], v[140:143], a[124:127]
    s_waitcnt lgkmcnt(4)
    s_cbranch_vccnz m_stub74
m_ret75:
    v_mfma_f32_16x16x32_bf16 v[96:99], a[192:195], a[128:131], v[160:163]
    s_add_u32 s59, s58, s60
    v_exp_f32 v20, v64
    v_mfma_f32_16x16x32_bf16 v[96:99], a[196:199], a[132:135], v[96:99]
    s_add_u32 s58, s58, 32768
    ds_read_b128 a[224:227], v6 offset:24576
    v_add_f32 v12, v12, v28
    v_mfma_f32_16x16x32_bf16 v[96:99], a[200:203], a[136:139], v[96:99]
    s_and_b32 s58, s58, 0x1ffff
    v_exp_f32 v21, v65
    v_mfma_f32_16x16x32_bf16 v[96:99], a[204:207], a[140:143], v[96:99]
    s_bitcmp1_b64 s[62:63], s64
    s_cselect_b32 s66, -1.0, s65
    v_cvt_pk_bf16_f32 v128, v20, v21
    v_mfma_f32_16x16x32_bf16 v[104:107], a[192:195], a[144:147], v[168:171]
    s_add_u32 s64, s64, 1
    ds_read_b128 a[228:231], v6 offset:25600
    v_add_f32 v13, v13, v32
    v_mfma_f32_16x16x32_bf16 v[104:107], a[196:199], a[148:151], v[104:107]
    v_exp_f32 v22, v66
    v_mfma_f32_16x16x32_bf16 v[104:107], a[200:203], a[152:155], v[104:107]
    buffer_load_dwordx4 v7, s[28:31], s57 offen offset:1024 sc1 lds
    v_mfma_f32_16x16x32_bf16 v[104:107], a[204:207], a[156:159], v[104:107]
    ds_read_b128 a[232:235], v6 offset:26624
    v_add_f32 v14, v14, v36
    v_mfma_f32_16x16x32_bf16 v[112:115], a[192:195], a[160:163], v[176:179]
    v_exp_f32 v23, v67
    v_mfma_f32_16x16x32_bf16 v[112:115], a[196:199], a[164:167], v[112:115]
    v_exp_f32 v24, v68
    v_mfma_f32_16x16x32_bf16 v[112:115], a[200:203], a[168:171], v[112:115]
    ds_read_b128 a[236:239], v6 offset:27648
    v_cvt_pk_bf16_f32 v129, v22, v23
    v_mfma_f32_16x16x32_bf16 v[112:115], a[204:207], a[172:175], v[112:115]
    v_exp_f32 v25, v69
    v_mfma_f32_16x16x32_bf16 v[120:123], a[192:195], a[176:179], v[184:187]
    v_exp_f32 v26, v70
    v_mfma_f32_16x16x32_bf16 v[120:123], a[196:199], a[180:183], v[120:123]
    ds_read_b128 a[240:243], v6 offset:28672
    v_cvt_pk_bf16_f32 v130, v24, v25
    v_mfma_f32_16x16x32_bf16 v[120:123], a[200:203], a[184:187], v[120:123]
    v_exp_f32 v27, v71
    v_mfma_f32_16x16x32_bf16 v[120:123], a[204:207], a[188:191], v[120:123]
    s_waitcnt lgkmcnt(5)
    v_exp_f32 v20, v72
    v_mfma_f32_16x16x32_bf16 v[100:103], a[208:211], a[128:131], v[164:167]
    ds_read_b128 a[244:247], v6 offset:29696
    v_cvt_pk_bf16_f32 v131, v26, v27
    v_mfma_f32_16x16x32_bf16 v[100:103], a[212:215], a[132:135], v[100:103]
    v_exp_f32 v21, v73
    v_mfma_f32_16x16x32_bf16 v[28:31], v[44:47], v[128:131], 0
    v_exp_f32 v22, v74
    v_mfma_f32_16x16x32_bf16 v[100:103], a[216:219], a[136:139], v[100:103]
    buffer_load_dwordx4 v7, s[28:31], s57 offen offset:2048 sc1 lds
    v_mfma_f32_16x16x32_bf16 v[100:103], a[220:223], a[140:143], v[100:103]
    ds_read_b128 a[248:251], v6 offset:30720
    v_cvt_pk_bf16_f32 v132, v20, v21
    v_mfma_f32_16x16x32_bf16 v[108:111], a[208:211], a[144:147], v[172:175]
    v_exp_f32 v23, v75
    v_mfma_f32_16x16x32_bf16 v[108:111], a[212:215], a[148:151], v[108:111]
    v_exp_f32 v24, v76
    v_mfma_f32_16x16x32_bf16 v[108:111], a[216:219], a[152:155], v[108:111]
    ds_read_b128 a[252:255], v6 offset:31744
    v_cvt_pk_bf16_f32 v133, v22, v23
    v_mfma_f32_16x16x32_bf16 v[108:111], a[220:223], a[156:159], v[108:111]
    v_exp_f32 v25, v77
    v_mfma_f32_16x16x32_bf16 v[116:119], a[208:211], a[160:163], v[180:183]
    v_exp_f32 v26, v78
    v_mfma_f32_16x16x32_bf16 v[116:119], a[212:215], a[164:167], v[116:119]
    v_cvt_pk_bf16_f32 v134, v24, v25
    v_add_f32 v15, v15, v40
    v_mfma_f32_16x16x32_bf16 v[116:119], a[216:219], a[168:171], v[116:119]
    v_exp_f32 v27, v79
    v_mfma_f32_16x16x32_bf16 v[116:119], a[220:223], a[172:175], v[116:119]
    buffer_load_dwordx4 v7, s[28:31], s57 offen offset:3072 sc1 lds
    v_mfma_f32_16x16x32_bf16 v[124:127], a[208:211], a[176:179], v[188:191]
    s_add_u32 s57, s57, 16384
    v_exp_f32 v20, v80
    v_mfma_f32_16x16x32_bf16 v[124:127], a[212:215], a[180:183], v[124:127]
    v_cvt_pk_bf16_f32 v135, v26, v27
    v_mfma_f32_16x16x32_bf16 v[124:127], a[216:219], a[184:187], v[124:127]
    v_exp_f32 v21, v81
    v_mfma_f32_16x16x32_bf16 v[32:35], v[44:47], v[132:135], 0
    v_exp_f32 v22, v82
    v_mfma_f32_16x16x32_bf16 v[124:127], a[220:223], a[188:191], v[124:127]
    s_waitcnt vmcnt(16) lgkmcnt(0)
    v_add_u32 v6, s58, v2
    v_cvt_pk_bf16_f32 v136, v20, v21
    v_mfma_f32_16x16x32_bf16 a[0:3], a[224:227], v[144:147], a[0:3]
    s_barrier
    v_mfma_f32_16x16x32_bf16 a[32:35], a[224:227], v[148:151], a[32:35]
    ds_read_b128 a[192:195], v6 offset:0
    v_mfma_f32_16x16x32_bf16 a[64:67], a[224:227], v[152:155], a[64:67]
    v_exp_f32 v23, v83
    v_mfma_f32_16x16x32_bf16 a[96:99], a[224:227], v[156:159], a[96:99]
    v_exp_f32 v24, v84
    v_mfma_f32_16x16x32_bf16 a[4:7], a[228:231], v[144:147], a[4:7]
    ds_read_b128 a[196:199], v6 offset:1024
    v_cvt_pk_bf16_f32 v137, v22, v23
    v_mfma_f32_16x16x32_bf16 a[36:39], a[228:231], v[148:151], a[36:39]
    v_exp_f32 v25, v85
    v_mfma_f32_16x16x32_bf16 a[68:71], a[228:231], v[152:155], a[68:71]
    v_exp_f32 v26, v86
    v_mfma_f32_16x16x32_bf16 a[100:103], a[228:231], v[156:159], a[100:103]
    ds_read_b128 a[200:203], v6 offset:2048
    v_cvt_pk_bf16_f32 v138, v24, v25
    v_mfma_f32_16x16x32_bf16 a[8:11], a[232:235], v[144:147], a[8:11]
    v_exp_f32 v27, v87
    v_mfma_f32_16x16x32_bf16 a[40:43], a[232:235], v[148:151], a[40:43]
    v_exp_f32 v20, v88
    v_mfma_f32_16x16x32_bf16 a[72:75], a[232:235], v[152:155], a[72:75]
    ds_read_b128 a[204:207], v6 offset:3072
    v_cvt_pk_bf16_f32 v139, v26, v27
    v_mfma_f32_16x16x32_bf16 a[104:107], a[232:235], v[156:159], a[104:107]
    v_exp_f32 v21, v89
    v_mfma_f32_16x16x32_bf16 v[36:39], v[44:47], v[136:139], 0
    v_exp_f32 v22, v90
    v_mfma_f32_16x16x32_bf16 a[12:15], a[236:239], v[144:147], a[12:15]
    v_cvt_pk_bf16_f32 v140, v20, v21
    v_mfma_f32_16x16x32_bf16 a[44:47], a[236:239], v[148:151], a[44:47]
    v_exp_f32 v23, v91
    v_mfma_f32_16x16x32_bf16 a[76:79], a[236:239], v[152:155], a[76:79]
    v_exp_f32 v24, v92
    v_mfma_f32_16x16x32_bf16 a[108:111], a[236:239], v[156:159], a[108:111]
    v_cvt_pk_bf16_f32 v141, v22, v23
    v_mfma_f32_16x16x32_bf16 a[16:19], a[240:243], v[144:147], a[16:19]
    v_exp_f32 v25, v93
    v_mfma_f32_16x16x32_bf16 a[48:51], a[240:243], v[148:151], a[48:51]
    v_exp_f32 v26, v94
    v_mfma_f32_16x16x32_bf16 a[80:83], a[240:243], v[152:155], a[80:83]
    v_cvt_pk_bf16_f32 v142, v24, v25
    v_mfma_f32_16x16x32_bf16 a[112:115], a[240:243], v[156:159], a[112:115]
    v_exp_f32 v27, v95
    v_mfma_f32_16x16x32_bf16 a[20:23], a[244:247], v[144:147], a[20:23]
    v_cvt_pk_bf16_f32 v143, v26, v27
    v_mfma_f32_16x16x32_bf16 a[52:55], a[244:247], v[148:151], a[52:55]
    v_mfma_f32_16x16x32_bf16 a[84:87], a[244:247], v[152:155], a[84:87]
    v_mfma_f32_16x16x32_bf16 v[40:43], v[44:47], v[140:143], 0
    s_nop 2
    v_mfma_f32_16x16x32_bf16 a[116:119], a[244:247], v[156:159], a[116:119]
    s_nop 2
    v_mfma_f32_16x16x32_bf16 a[24:27], a[248:251], v[144:147], a[24:27]
    v_max3_f32 v8, v28, v32, v36
    v_max_f32 v8, v8, v40
    v_mfma_f32_16x16x32_bf16 a[56:59], a[248:251], v[148:151], a[56:59]
    v_cmp_nge_f32 vcc, s66, v8
    v_mfma_f32_16x16x32_bf16 a[88:91], a[248:251], v[152:155], a[88:91]
    v_mfma_f32_16x16x32_bf16 a[120:123], a[248:251], v[156:159], a[120:123]
    ds_read_b128 a[208:211], v6 offset:4096
    v_mfma_f32_16x16x32_bf16 a[28:31], a[252:255], v[144:147], a[28:31]
    ds_read_b128 a[212:215], v6 offset:5120
    v_mfma_f32_16x16x32_bf16 a[60:63], a[252:255], v[148:151], a[60:63]
    ds_read_b128 a[216:219], v6 offset:6144
    v_mfma_f32_16x16x32_bf16 a[92:95], a[252:255], v[152:155], a[92:95]
    ds_read_b128 a[220:223], v6 offset:7168
    v_mfma_f32_16x16x32_bf16 a[124:127], a[252:255], v[156:159], a[124:127]
    s_waitcnt lgkmcnt(4)
    s_cbranch_vccz m_dual73
    v_cmp_lt_f32 vcc, s65, v8
    s_cmp_lg_u32 s64, s67
    s_cbranch_scc1 m_e77
    v_add_f32 v176, v176, v16
    v_mov_b32 v180, v9
    v_add_f32 v188, v188, v16
    v_add_f32 v177, v177, v17
    v_mov_b32 v181, v9
    v_add_f32 v189, v189, v17
    v_add_f32 v178, v178, v18
    v_mov_b32 v182, v9
    v_add_f32 v190, v190, v18
    v_add_f32 v179, v179, v19
    v_mov_b32 v183, v9
    v_add_f32 v191, v191, v19
    s_nop 0
m_e77:
    s_cmp_lg_u32 s64, s68
    s_cbranch_scc1 m_e78
    v_mov_b32 v176, v9
    v_mov_b32 v184, v9
    v_mov_b32 v188, v9
    v_mov_b32 v177, v9
    v_mov_b32 v185, v9
    v_mov_b32 v189, v9
    v_mov_b32 v178, v9
    v_mov_b32 v186, v9
    v_mov_b32 v190, v9
    v_mov_b32 v179, v9
    v_mov_b32 v187, v9
    v_mov_b32 v191, v9
    s_nop 0
m_e78:
    s_cmp_lg_u32 s64, s70
    s_cbranch_scc1 m_e79
    v_add_f32 v160, v160, v16
    v_mov_b32 v164, v9
    v_add_f32 v172, v172, v16
    v_add_f32 v161, v161, v17
    v_mov_b32 v165, v9
    v_add_f32 v173, v173, v17
    v_add_f32 v162, v162, v18
    v_mov_b32 v166, v9
    v_add_f32 v174, v174, v18
    v_add_f32 v163, v163, v19
    v_mov_b32 v167, v9
    v_add_f32 v175, v175, v19
    s_nop 0
m_e79:
    s_cmp_lg_u32 s64, s52
    s_cbranch_scc1 m_e81
    v_lshrrev_b32 v62, 3, v1
    v_lshlrev_b32 v62, 11, v62
    v_and_b32 v61, 7, v1
    v_lshl_add_u32 v62, v61, 7, v62
    s_lshr_b32 s90, s2, 3
    s_lshl_b32 s90, s90, 2
    s_add_u32 s90, s90, s16
    s_lshl_b32 s90, s90, 14
    s_and_b32 s91, s2, 1
    s_lshl_b32 s91, s91, 10
    s_add_u32 s90, s90, s91
    s_bitcmp1_b32 s2, 2
    s_cselect_b32 s91, 0, 5373952
    s_mov_b32 s92, 8388608
    s_cselect_b32 s46, 5373952, s92
    s_cselect_b32 s93, 0, 2097152
    s_add_u32 s91, s91, s90
    s_mov_b32 s44, s48
    s_mov_b32 s45, s49
    s_add_u32 s92, s91, 0
    buffer_load_dword v255, v62, s[44:47], s92 offen
    s_add_u32 s92, s91, 2097152
    buffer_load_dword v255, v62, s[44:47], s92 offen
    s_add_u32 s92, s91, 4194304
    buffer_load_dword v255, v62, s[44:47], s92 offen
    s_mov_b32 s44, s50
    s_mov_b32 s45, s51
    s_mov_b32 s46, s93
    buffer_load_dword v255, v62, s[44:47], s90 offen
m_e81:
    s_cmp_lg_u32 s64, s53
    s_cbranch_scc1 m_e82
    s_cmp_lg_u32 s16, 0
    s_cbranch_scc1 m_np83
    v_mov_b32 v60, s4
    v_mov_b32 v61, s5
    s_add_u32 s90, s17, 117440512
    s_mov_b64 exec, 1
    buffer_store_dwordx2 v[60:61], off, s[8:11], s90 sc1
    s_mov_b64 exec, -1
m_np83:
    s_mov_b32 s17, -1
m_e82:
    s_cmp_gt_u32 s64, 26
    s_cbranch_scc1 m_e80
    s_cmp_lg_u32 s64, 6
    s_cbranch_scc1 m_e84
    s_lshr_b32 s90, s32, 1
    s_lshl_b32 s90, s90, 7
    s_add_u32 s90, s90, 117440600
    v_min_u32 v0, 1, v1
    v_lshlrev_b32 v0, 5, v0
    buffer_load_dwordx2 v[4:5], v0, s[8:11], s90 offen sc1
    s_cmp_eq_u32 s17, -1
    s_cbranch_scc1 m_e80
    s_cmp_lg_u32 s16, 0
    s_cbranch_scc1 m_np85
    v_mov_b32 v60, s4
    v_mov_b32 v61, s5
    s_add_u32 s90, s17, 117440512
    s_mov_b64 exec, 1
    buffer_store_dwordx2 v[60:61], off, s[8:11], s90 sc1
    s_mov_b64 exec, -1
m_np85:
    s_branch m_e80
m_e84:
    s_cmp_lg_u32 s64, 18
    s_cbranch_scc1 m_e86
    s_waitcnt vmcnt(18)
    s_mov_b32 s3, 1048576
m_spin87:
    v_cmp_ne_u64 s[76:77], s[4:5], v[4:5]
    s_nop 3
    s_cmp_eq_u64 s[76:77], 0
    s_cbranch_scc1 m_e80
    s_sub_u32 s3, s3, 1
    s_cbranch_scc1 m_e80
    s_sleep 32
    s_lshr_b32 s90, s32, 1
    s_lshl_b32 s90, s90, 7
    s_add_u32 s90, s90, 117440600
    v_min_u32 v0, 1, v1
    v_lshlrev_b32 v0, 5, v0
    buffer_load_dwordx2 v[4:5], v0, s[8:11], s90 offen sc1
    s_waitcnt vmcnt(0)
    s_branch m_spin87
    s_branch m_e80
m_e86:
    s_cmp_lg_u32 s64, 22
    s_cbranch_scc1 m_e88
    buffer_load_dwordx2 v[4:5], v10, s[8:11], 0 offen sc1
    s_mov_b32 s44, s48
    s_mov_b32 s45, s49
    s_mov_b32 s46, 8388608
    s_lshl_b32 s90, s2, 2
    s_add_u32 s90, s90, s16
    s_lshl_b32 s90, s90, 13
    v_lshlrev_b32 v62, 7, v1
    buffer_load_dword v255, v62, s[44:47], s90 offen
    s_branch m_e80
m_e88:
    s_cmp_lg_u32 s64, 26
    s_cbranch_scc1 m_e89
    s_mov_b32 s44, s50
    s_mov_b32 s45, s51
    s_mov_b32 s46, 2097152
    s_lshl_b32 s90, s2, 2
    s_add_u32 s90, s90, s16
    s_lshl_b32 s90, s90, 13
    v_lshlrev_b32 v62, 7, v1
    buffer_load_dword v255, v62, s[44:47], s90 offen
    s_waitcnt vmcnt(18)
    s_mov_b32 s3, 1048576
m_spin90:
    v_cmp_ne_u64 s[76:77], s[4:5], v[4:5]
    s_nop 3
    s_cmp_eq_u64 s[76:77], 0
    s_cbranch_scc1 m_e80
    s_sub_u32 s3, s3, 1
    s_cbranch_scc1 m_e80
    s_sleep 32
    buffer_load_dwordx2 v[4:5], v10, s[8:11], 0 offen sc1
    s_waitcnt vmcnt(0)
    s_branch m_spin90
    s_branch m_e80
m_e89:
m_e80:
    s_cbranch_vccnz m_rc91
m_sp76:
    s_cmp_lg_u32 s64, s69
    s_cbranch_scc1 m_dual73
    v_mfma_f32_16x16x32_bf16 v[64:67], a[192:195], a[128:131], v[160:163]
    s_bitcmp1_b64 s[62:63], s64
    s_cselect_b32 s66, -1.0, s65
    v_add_f32 v12, v12, v28
    v_mfma_f32_16x16x32_bf16 v[64:67], a[196:199], a[132:135], v[64:67]
    s_add_u32 s64, s64, 1
    ds_read_b128 a[224:227], v6 offset:16384
    v_exp_f32 v20, v96
    v_mfma_f32_16x16x32_bf16 v[64:67], a[200:203], a[136:139], v[64:67]
    s_mov_b32 m0, s59
    ds_read_b128 a[228:231], v6 offset:17408
    v_add_f32 v13, v13, v32
    v_mfma_f32_16x16x32_bf16 v[64:67], a[204:207], a[140:143], v[64:67]
    buffer_load_dwordx4 v7, s[24:27], s56 offen offset:0 sc1 lds
    v_mfma_f32_16x16x32_bf16 v[72:75], a[192:195], a[144:147], v[168:171]
    ds_read_b128 a[232:235], v6 offset:18432
    v_add_f32 v14, v14, v36
    v_mfma_f32_16x16x32_bf16 v[72:75], a[196:199], a[148:151], v[72:75]
    ds_read_b128 a[236:239], v6 offset:19456
    v_exp_f32 v21, v97
    v_mfma_f32_16x16x32_bf16 v[72:75], a[200:203], a[152:155], v[72:75]
    ds_read_b128 a[240:243], v6 offset:20480
    v_cvt_pk_bf16_f32 v144, v20, v21
    v_mfma_f32_16x16x32_bf16 v[72:75], a[204:207], a[156:159], v[72:75]
    s_waitcnt lgkmcnt(5)
    ds_read_b128 a[244:247], v6 offset:21504
    v_add_f32 v15, v15, v40
    v_mfma_f32_16x16x32_bf16 v[68:71], a[208:211], a[128:131], v[164:167]
    ds_read_b128 a[248:251], v6 offset:22528
    v_exp_f32 v22, v98
    v_mfma_f32_16x16x32_bf16 v[68:71], a[212:215], a[132:135], v[68:71]
    ds_read_b128 a[252:255], v6 offset:23552
    v_exp_f32 v23, v99
    v_mfma_f32_16x16x32_bf16 v[68:71], a[216:219], a[136:139], v[68:71]
    v_exp_f32 v24, v100
    v_mfma_f32_16x16x32_bf16 v[68:71], a[220:223], a[140:143], v[68:71]
    buffer_load_dwordx4 v7, s[24:27], s56 offen offset:1024 sc1 lds
    v_mfma_f32_16x16x32_bf16 v[76:79], a[208:211], a[144:147], v[172:175]
    v_cvt_pk_bf16_f32 v145, v22, v23
    v_exp_f32 v25, v101
    v_mfma_f32_16x16x32_bf16 v[76:79], a[212:215], a[148:151], v[76:79]
    v_exp_f32 v26, v102
    v_mfma_f32_16x16x32_bf16 v[76:79], a[216:219], a[152:155], v[76:79]
    v_cvt_pk_bf16_f32 v146, v24, v25
    v_exp_f32 v27, v103
    v_mfma_f32_16x16x32_bf16 v[76:79], a[220:223], a[156:159], v[76:79]
    s_waitcnt lgkmcnt(0)
    v_exp_f32 v20, v104
    v_mfma_f32_16x16x32_bf16 a[0:3], a[224:227], v[128:131], a[0:3]
    ds_read_b128 a[192:195], v6 offset:8192
    v_cvt_pk_bf16_f32 v147, v26, v27
    v_mfma_f32_16x16x32_bf16 a[32:35], a[224:227], v[132:135], a[32:35]
    v_exp_f32 v21, v105
    v_mfma_f32_16x16x32_bf16 v[28:31], v[44:47], v[144:147], 0
    v_exp_f32 v22, v106
    v_mfma_f32_16x16x32_bf16 a[64:67], a[224:227], v[136:139], a[64:67]
    v_cvt_pk_bf16_f32 v148, v20, v21
    v_exp_f32 v23, v107
    v_mfma_f32_16x16x32_bf16 a[96:99], a[224:227], v[140:143], a[96:99]
    ds_read_b128 a[196:199], v6 offset:9216
    v_cvt_pk_bf16_f32 v149, v22, v23
    v_mfma_f32_16x16x32_bf16 a[4:7], a[228:231], v[128:131], a[4:7]
    v_exp_f32 v24, v108
    v_mfma_f32_16x16x32_bf16 a[36:39], a[228:231], v[132:135], a[36:39]
    buffer_load_dwordx4 v7, s[24:27], s56 offen offset:2048 sc1 lds
    v_mfma_f32_16x16x32_bf16 a[68:71], a[228:231], v[136:139], a[68:71]
    ds_read_b128 a[200:203], v6 offset:10240
    v_exp_f32 v25, v109
    v_mfma_f32_16x16x32_bf16 a[100:103], a[228:231], v[140:143], a[100:103]
    v_exp_f32 v26, v110
    v_mfma_f32_16x16x32_bf16 a[8:11], a[232:235], v[128:131], a[8:11]
    v_cvt_pk_bf16_f32 v150, v24, v25
    v_exp_f32 v27, v111
    v_mfma_f32_16x16x32_bf16 a[40:43], a[232:235], v[132:135], a[40:43]
    ds_read_b128 a[204:207], v6 offset:11264
    v_cvt_pk_bf16_f32 v151, v26, v27
    v_mfma_f32_16x16x32_bf16 a[72:75], a[232:235], v[136:139], a[72:75]
    v_exp_f32 v20, v112
    v_mfma_f32_16x16x32_bf16 v[32:35], v[44:47], v[148:151], 0
    v_exp_f32 v21, v113
    v_mfma_f32_16x16x32_bf16 a[104:107], a[232:235], v[140:143], a[104:107]
    v_exp_f32 v22, v114
    v_mfma_f32_16x16x32_bf16 a[12:15], a[236:239], v[128:131], a[12:15]
    v_cvt_pk_bf16_f32 v152, v20, v21
    v_exp_f32 v23, v115
    v_mfma_f32_16x16x32_bf16 a[44:47], a[236:239], v[132:135], a[44:47]
    v_exp_f32 v24, v116
    v_mfma_f32_16x16x32_bf16 a[76:79], a[236:239], v[136:139], a[76:79]
    v_cvt_pk_bf16_f32 v153, v22, v23
    v_exp_f32 v25, v117
    v_mfma_f32_16x16x32_bf16 a[108:111], a[236:239], v[140:143], a[108:111]
    buffer_load_dwordx4 v7, s[24:27], s56 offen offset:3072 sc1 lds
    v_mfma_f32_16x16x32_bf16 a[16:19], a[240:243], v[128:131], a[16:19]
    s_add_u32 s56, s56, 16384
    v_exp_f32 v26, v118
    v_mfma_f32_16x16x32_bf16 a[48:51], a[240:243], v[132:135], a[48:51]
    v_cvt_pk_bf16_f32 v154, v24, v25
    v_exp_f32 v27, v119
    v_mfma_f32_16x16x32_bf16 a[80:83], a[240:243], v[136:139], a[80:83]
    v_exp_f32 v20, v120
    v_mfma_f32_16x16x32_bf16 a[112:115], a[240:243], v[140:143], a[112:115]
    v_cvt_pk_bf16_f32 v155, v26, v27
    v_exp_f32 v21, v121
    v_mfma_f32_16x16x32_bf16 a[20:23], a[244:247], v[128:131], a[20:23]
    v_exp_f32 v22, v122
    v_mfma_f32_16x16x32_bf16 v[36:39], v[44:47], v[152:155], 0
    v_cvt_pk_bf16_f32 v156, v20, v21
    v_mfma_f32_16x16x32_bf16 a[52:55], a[244:247], v[132:135], a[52:55]
    v_exp_f32 v23, v123
    v_mfma_f32_16x16x32_bf16 a[84:87], a[244:247], v[136:139], a[84:87]
    v_exp_f32 v24, v124
    v_cvt_pk_bf16_f32 v157, v22, v23
    v_mfma_f32_16x16x32_bf16 a[116:119], a[244:247], v[140:143], a[116:119]
    v_exp_f32 v25, v125
    v_mfma_f32_16x16x32_bf16 a[24:27], a[248:251], v[128:131], a[24:27]
    s_add_u32 m0, s59, 16384
    v_exp_f32 v26, v126
    v_mfma_f32_16x16x32_bf16 a[56:59], a[248:251], v[132:135], a[56:59]
    buffer_load_dwordx4 v7, s[28:31], s57 offen offset:0 sc1 lds
    v_mfma_f32_16x16x32_bf16 a[88:91], a[248:251], v[136:139], a[88:91]
    v_cvt_pk_bf16_f32 v158, v24, v25
    v_exp_f32 v27, v127
    v_mfma_f32_16x16x32_bf16 a[120:123], a[248:251], v[140:143], a[120:123]
    ds_read_b128 a[208:211], v6 offset:12288
    v_cvt_pk_bf16_f32 v159, v26, v27
    s_nop 1
    v_mfma_f32_16x16x32_bf16 v[40:43], v[44:47], v[156:159], 0
    s_nop 2
    v_mfma_f32_16x16x32_bf16 a[28:31], a[252:255], v[128:131], a[28:31]
    ds_read_b128 a[212:215], v6 offset:13312
    s_nop 0
    v_mfma_f32_16x16x32_bf16 a[60:63], a[252:255], v[132:135], a[60:63]
    ds_read_b128 a[216:219], v6 offset:14336
    v_max3_f32 v8, v28, v32, v36
    v_mfma_f32_16x16x32_bf16 a[92:95], a[252:255], v[136:139], a[92:95]
    ds_read_b128 a[220:223], v6 offset:15360
    v_max_f32 v8, v8, v40
    v_cmp_nge_f32 vcc, s66, v8
    v_mfma_f32_16x16x32_bf16 a[124:127], a[252:255], v[140:143], a[124:127]
    s_waitcnt lgkmcnt(4)
    s_cbranch_vccnz m_stub92
m_ret93:
    v_mfma_f32_16x16x32_bf16 v[96:99], a[192:195], a[128:131], v[160:163]
    s_add_u32 s59, s58, s60
    v_exp_f32 v20, v64
    v_mfma_f32_16x16x32_bf16 v[96:99], a[196:199], a[132:135], v[96:99]
    s_add_u32 s58, s58, 32768
    ds_read_b128 a[224:227], v6 offset:24576
    v_add_f32 v12, v12, v28
    v_mfma_f32_16x16x32_bf16 v[96:99], a[200:203], a[136:139], v[96:99]
    s_and_b32 s58, s58, 0x1ffff
    ds_read_b128 a[228:231], v6 offset:25600
    v_add_f32 v13, v13, v32
    v_mfma_f32_16x16x32_bf16 v[96:99], a[204:207], a[140:143], v[96:99]
    buffer_load_dwordx4 v7, s[28:31], s57 offen offset:1024 sc1 lds
    v_mfma_f32_16x16x32_bf16 v[104:107], a[192:195], a[144:147], v[168:171]
    s_bitcmp1_b64 s[62:63], s64
    s_cselect_b32 s66, -1.0, s65
    ds_read_b128 a[232:235], v6 offset:26624
    v_mfma_f32_16x16x32_bf16 v[104:107], a[196:199], a[148:151], v[104:107]
    s_add_u32 s64, s64, 1
    ds_read_b128 a[236:239], v6 offset:27648
    v_mfma_f32_16x16x32_bf16 v[104:107], a[200:203], a[152:155], v[104:107]
    ds_read_b128 a[240:243], v6 offset:28672
    v_mfma_f32_16x16x32_bf16 v[104:107], a[204:207], a[156:159], v[104:107]
    s_waitcnt lgkmcnt(5)
    ds_read_b128 a[244:247], v6 offset:29696
    v_mfma_f32_16x16x32_bf16 v[100:103], a[208:211], a[128:131], v[164:167]
    buffer_load_dwordx4 v7, s[28:31], s57 offen offset:2048 sc1 lds
    v_mfma_f32_16x16x32_bf16 v[100:103], a[212:215], a[132:135], v[100:103]
    ds_read_b128 a[248:251], v6 offset:30720
    v_mfma_f32_16x16x32_bf16 v[100:103], a[216:219], a[136:139], v[100:103]
    ds_read_b128 a[252:255], v6 offset:31744
    v_mfma_f32_16x16x32_bf16 v[100:103], a[220:223], a[140:143], v[100:103]
    v_exp_f32 v21, v65
    v_mfma_f32_16x16x32_bf16 v[108:111], a[208:211], a[144:147], v[172:175]
    v_exp_f32 v22, v66
    v_mfma_f32_16x16x32_bf16 v[108:111], a[212:215], a[148:151], v[108:111]
    buffer_load_dwordx4 v7, s[28:31], s57 offen offset:3072 sc1 lds
    v_mfma_f32_16x16x32_bf16 v[108:111], a[216:219], a[152:155], v[108:111]
    s_add_u32 s57, s57, 16384
    v_cvt_pk_bf16_f32 v128, v20, v21
    v_mfma_f32_16x16x32_bf16 v[108:111], a[220:223], a[156:159], v[108:111]
    s_waitcnt vmcnt(16) lgkmcnt(0)
    v_add_u32 v6, s58, v2
    v_mfma_f32_16x16x32_bf16 a[0:3], a[224:227], v[144:147], a[0:3]
    s_barrier
    v_mfma_f32_16x16x32_bf16 a[32:35], a[224:227], v[148:151], a[32:35]
    ds_read_b128 a[192:195], v6 offset:0
    v_mfma_f32_16x16x32_bf16 a[64:67], a[224:227], v[152:155], a[64:67]
    v_exp_f32 v23, v67
    v_mfma_f32_16x16x32_bf16 a[96:99], a[224:227], v[156:159], a[96:99]
    v_exp_f32 v24, v68
    v_mfma_f32_16x16x32_bf16 a[4:7], a[228:231], v[144:147], a[4:7]
    ds_read_b128 a[196:199], v6 offset:1024
    v_cvt_pk_bf16_f32 v129, v22, v23
    v_mfma_f32_16x16x32_bf16 a[36:39], a[228:231], v[148:151], a[36:39]
    v_exp_f32 v25, v69
    v_mfma_f32_16x16x32_bf16 a[68:71], a[228:231], v[152:155], a[68:71]
    v_exp_f32 v26, v70
    v_mfma_f32_16x16x32_bf16 a[100:103], a[228:231], v[156:159], a[100:103]
    ds_read_b128 a[200:203], v6 offset:2048
    v_cvt_pk_bf16_f32 v130, v24, v25
    v_mfma_f32_16x16x32_bf16 a[8:11], a[232:235], v[144:147], a[8:11]
    v_exp_f32 v27, v71
    v_mfma_f32_16x16x32_bf16 a[40:43], a[232:235], v[148:151], a[40:43]
    v_exp_f32 v20, v72
    v_mfma_f32_16x16x32_bf16 a[72:75], a[232:235], v[152:155], a[72:75]
    ds_read_b128 a[204:207], v6 offset:3072
    v_cvt_pk_bf16_f32 v131, v26, v27
    v_mfma_f32_16x16x32_bf16 a[104:107], a[232:235], v[156:159], a[104:107]
    v_exp_f32 v21, v73
    v_mfma_f32_16x16x32_bf16 v[28:31], v[44:47], v[128:131], 0
    v_exp_f32 v22, v74
    v_mfma_f32_16x16x32_bf16 a[12:15], a[236:239], v[144:147], a[12:15]
    v_cvt_pk_bf16_f32 v132, v20, v21
    v_mfma_f32_16x16x32_bf16 a[44:47], a[236:239], v[148:151], a[44:47]
    v_exp_f32 v23, v75
    v_mfma_f32_16x16x32_bf16 a[76:79], a[236:239], v[152:155], a[76:79]
    v_exp_f32 v24, v76
    v_mfma_f32_16x16x32_bf16 a[108:111], a[236:239], v[156:159], a[108:111]
    v_cvt_pk_bf16_f32 v133, v22, v23
    v_mfma_f32_16x16x32_bf16 a[16:19], a[240:243], v[144:147], a[16:19]
    v_exp_f32 v25, v77
    v_mfma_f32_16x16x32_bf16 a[48:51], a[240:243], v[148:151], a[48:51]
    v_exp_f32 v26, v78
    v_mfma_f32_16x16x32_bf16 a[80:83], a[240:243], v[152:155], a[80:83]
    v_cvt_pk_bf16_f32 v134, v24, v25
    v_mfma_f32_16x16x32_bf16 a[112:115], a[240:243], v[156:159], a[112:115]
    v_exp_f32 v27, v79
    v_mfma_f32_16x16x32_bf16 a[20:23], a[244:247], v[144:147], a[20:23]
    v_cvt_pk_bf16_f32 v135, v26, v27
    v_mfma_f32_16x16x32_bf16 a[52:55], a[244:247], v[148:151], a[52:55]
    v_mfma_f32_16x16x32_bf16 a[84:87], a[244:247], v[152:155], a[84:87]
    v_mfma_f32_16x16x32_bf16 v[32:35], v[44:47], v[132:135], 0
    s_nop 2
    v_mfma_f32_16x16x32_bf16 a[116:119], a[244:247], v[156:159], a[116:119]
    s_nop 2
    v_mfma_f32_16x16x32_bf16 a[24:27], a[248:251], v[144:147], a[24:27]
    v_max_f32 v8, v28, v32
    v_cmp_nge_f32 vcc, s66, v8
    v_mfma_f32_16x16x32_bf16 a[56:59], a[248:251], v[148:151], a[56:59]
    v_mfma_f32_16x16x32_bf16 a[88:91], a[248:251], v[152:155], a[88:91]
    v_mfma_f32_16x16x32_bf16 a[120:123], a[248:251], v[156:159], a[120:123]
    ds_read_b128 a[208:211], v6 offset:4096
    v_mfma_f32_16x16x32_bf16 a[28:31], a[252:255], v[144:147], a[28:31]
    ds_read_b128 a[212:215], v6 offset:5120
    v_mfma_f32_16x16x32_bf16 a[60:63], a[252:255], v[148:151], a[60:63]
    ds_read_b128 a[216:219], v6 offset:6144
    v_mfma_f32_16x16x32_bf16 a[92:95], a[252:255], v[152:155], a[92:95]
    ds_read_b128 a[220:223], v6 offset:7168
    v_mfma_f32_16x16x32_bf16 a[124:127], a[252:255], v[156:159], a[124:127]
    s_waitcnt lgkmcnt(4)
    s_cbranch_vccnz m_stub94
m_ret95:
    v_add_f32 v20, v14, v36
    v_add_f32 v21, v15, v40
    s_nop 3
    v_rcp_f32 v20, v20
    v_rcp_f32 v21, v21
    s_lshl_b32 s90, s79, 10
    s_add_u32 s90, s90, s82
    s_add_u32 s90, s90, 67108864
    v_accvgpr_read_b32 v48, a64
    v_accvgpr_read_b32 v49, a65
    v_accvgpr_read_b32 v50, a66
    v_accvgpr_read_b32 v51, a67
    v_accvgpr_read_b32 v52, a68
    v_accvgpr_read_b32 v53, a69
    v_accvgpr_read_b32 v54, a70
    v_accvgpr_read_b32 v55, a71
    v_mul_f32 v48, v20, v48
    v_mul_f32 v49, v20, v49
    v_mul_f32 v50, v20, v50
    v_mul_f32 v51, v20, v51
    v_mul_f32 v52, v20, v52
    v_mul_f32 v53, v20, v53
    v_mul_f32 v54, v20, v54
    v_mul_f32 v55, v20, v55
    v_cvt_pk_bf16_f32 v48, v48, v49
    v_cvt_pk_bf16_f32 v49, v50, v51
    v_cvt_pk_bf16_f32 v50, v52, v53
    v_cvt_pk_bf16_f32 v51, v54, v55
    buffer_store_dwordx4 v[48:51], v2, s[8:11], s90 offen offset:0 sc1
    v_accvgpr_read_b32 v56, a96
    v_accvgpr_read_b32 v57, a97
    v_accvgpr_read_b32 v58, a98
    v_accvgpr_read_b32 v59, a99
    v_accvgpr_read_b32 v60, a100
    v_accvgpr_read_b32 v61, a101
    v_accvgpr_read_b32 v62, a102
    v_accvgpr_read_b32 v63, a103
    v_mul_f32 v56, v21, v56
    v_mul_f32 v57, v21, v57
    v_mul_f32 v58, v21, v58
    v_mul_f32 v59, v21, v59
    v_mul_f32 v60, v21, v60
    v_mul_f32 v61, v21, v61
    v_mul_f32 v62, v21, v62
    v_mul_f32 v63, v21, v63
    v_cvt_pk_bf16_f32 v56, v56, v57
    v_cvt_pk_bf16_f32 v57, v58, v59
    v_cvt_pk_bf16_f32 v58, v60, v61
    v_cvt_pk_bf16_f32 v59, v62, v63
    buffer_store_dwordx4 v[56:59], v2, s[8:11], s90 offen offset:1024 sc1
    s_add_u32 s90, s90, 131072
    v_accvgpr_read_b32 v48, a72
    v_accvgpr_read_b32 v49, a73
    v_accvgpr_read_b32 v50, a74
    v_accvgpr_read_b32 v51, a75
    v_accvgpr_read_b32 v52, a76
    v_accvgpr_read_b32 v53, a77
    v_accvgpr_read_b32 v54, a78
    v_accvgpr_read_b32 v55, a79
    v_mul_f32 v48, v20, v48
    v_mul_f32 v49, v20, v49
    v_mul_f32 v50, v20, v50
    v_mul_f32 v51, v20, v51
    v_mul_f32 v52, v20, v52
    v_mul_f32 v53, v20, v53
    v_mul_f32 v54, v20, v54
    v_mul_f32 v55, v20, v55
    v_cvt_pk_bf16_f32 v48, v48, v49
    v_cvt_pk_bf16_f32 v49, v50, v51
    v_cvt_pk_bf16_f32 v50, v52, v53
    v_cvt_pk_bf16_f32 v51, v54, v55
    buffer_store_dwordx4 v[48:51], v2, s[8:11], s90 offen offset:0 sc1
    v_accvgpr_read_b32 v56, a104
    v_accvgpr_read_b32 v57, a105
    v_accvgpr_read_b32 v58, a106
    v_accvgpr_read_b32 v59, a107
    v_accvgpr_read_b32 v60, a108
    v_accvgpr_read_b32 v61, a109
    v_accvgpr_read_b32 v62, a110
    v_accvgpr_read_b32 v63, a111
    v_mul_f32 v56, v21, v56
    v_mul_f32 v57, v21, v57
    v_mul_f32 v58, v21, v58
    v_mul_f32 v59, v21, v59
    v_mul_f32 v60, v21, v60
    v_mul_f32 v61, v21, v61
    v_mul_f32 v62, v21, v62
    v_mul_f32 v63, v21, v63
    v_cvt_pk_bf16_f32 v56, v56, v57
    v_cvt_pk_bf16_f32 v57, v58, v59
    v_cvt_pk_bf16_f32 v58, v60, v61
    v_cvt_pk_bf16_f32 v59, v62, v63
    buffer_store_dwordx4 v[56:59], v2, s[8:11], s90 offen offset:1024 sc1
    s_add_u32 s90, s90, 131072
    v_accvgpr_read_b32 v48, a80
    v_accvgpr_read_b32 v49, a81
    v_accvgpr_read_b32 v50, a82
    v_accvgpr_read_b32 v51, a83
    v_accvgpr_read_b32 v52, a84
    v_accvgpr_read_b32 v53, a85
    v_accvgpr_read_b32 v54, a86
    v_accvgpr_read_b32 v55, a87
    v_mul_f32 v48, v20, v48
    v_mul_f32 v49, v20, v49
    v_mul_f32 v50, v20, v50
    v_mul_f32 v51, v20, v51
    v_mul_f32 v52, v20, v52
    v_mul_f32 v53, v20, v53
    v_mul_f32 v54, v20, v54
    v_mul_f32 v55, v20, v55
    v_cvt_pk_bf16_f32 v48, v48, v49
    v_cvt_pk_bf16_f32 v49, v50, v51
    v_cvt_pk_bf16_f32 v50, v52, v53
    v_cvt_pk_bf16_f32 v51, v54, v55
    buffer_store_dwordx4 v[48:51], v2, s[8:11], s90 offen offset:0 sc1
    v_accvgpr_read_b32 v56, a112
    v_accvgpr_read_b32 v57, a113
    v_accvgpr_read_b32 v58, a114
    v_accvgpr_read_b32 v59, a115
    v_accvgpr_read_b32 v60, a116
    v_accvgpr_read_b32 v61, a117
    v_accvgpr_read_b32 v62, a118
    v_accvgpr_read_b32 v63, a119
    v_mul_f32 v56, v21, v56
    v_mul_f32 v57, v21, v57
    v_mul_f32 v58, v21, v58
    v_mul_f32 v59, v21, v59
    v_mul_f32 v60, v21, v60
    v_mul_f32 v61, v21, v61
    v_mul_f32 v62, v21, v62
    v_mul_f32 v63, v21, v63
    v_cvt_pk_bf16_f32 v56, v56, v57
    v_cvt_pk_bf16_f32 v57, v58, v59
    v_cvt_pk_bf16_f32 v58, v60, v61
    v_cvt_pk_bf16_f32 v59, v62, v63
    buffer_store_dwordx4 v[56:59], v2, s[8:11], s90 offen offset:1024 sc1
    s_add_u32 s90, s90, 131072
    v_accvgpr_read_b32 v48, a88
    v_accvgpr_read_b32 v49, a89
    v_accvgpr_read_b32 v50, a90
    v_accvgpr_read_b32 v51, a91
    v_accvgpr_read_b32 v52, a92
    v_accvgpr_read_b32 v53, a93
    v_accvgpr_read_b32 v54, a94
    v_accvgpr_read_b32 v55, a95
    v_mul_f32 v48, v20, v48
    v_mul_f32 v49, v20, v49
    v_mul_f32 v50, v20, v50
    v_mul_f32 v51, v20, v51
    v_mul_f32 v52, v20, v52
    v_mul_f32 v53, v20, v53
    v_mul_f32 v54, v20, v54
    v_mul_f32 v55, v20, v55
    v_cvt_pk_bf16_f32 v48, v48, v49
    v_cvt_pk_bf16_f32 v49, v50, v51
    v_cvt_pk_bf16_f32 v50, v52, v53
    v_cvt_pk_bf16_f32 v51, v54, v55
    buffer_store_dwordx4 v[48:51], v2, s[8:11], s90 offen offset:0 sc1
    v_accvgpr_read_b32 v56, a120
    v_accvgpr_read_b32 v57, a121
    v_accvgpr_read_b32 v58, a122
    v_accvgpr_read_b32 v59, a123
    v_accvgpr_read_b32 v60, a124
    v_accvgpr_read_b32 v61, a125
    v_accvgpr_read_b32 v62, a126
    v_accvgpr_read_b32 v63, a127
    v_mul_f32 v56, v21, v56
    v_mul_f32 v57, v21, v57
    v_mul_f32 v58, v21, v58
    v_mul_f32 v59, v21, v59
    v_mul_f32 v60, v21, v60
    v_mul_f32 v61, v21, v61
    v_mul_f32 v62, v21, v62
    v_mul_f32 v63, v21, v63
    v_cvt_pk_bf16_f32 v56, v56, v57
    v_cvt_pk_bf16_f32 v57, v58, v59
    v_cvt_pk_bf16_f32 v58, v60, v61
    v_cvt_pk_bf16_f32 v59, v62, v63
    buffer_store_dwordx4 v[56:59], v2, s[8:11], s90 offen offset:1024 sc1
    s_add_u32 s90, s90, 131072
    s_lshl_b32 s17, s34, 5
    s_add_u32 s17, s17, s32
    s_lshl_b32 s17, s17, 3
    s_add_u32 s17, s17, 7936
m_single96:
    v_mfma_f32_16x16x32_bf16 v[64:67], a[192:195], a[128:131], v[160:163]
    s_bitcmp1_b64 s[62:63], s64
    s_cselect_b32 s66, -1.0, s65
    v_add_f32 v12, v12, v28
    v_mfma_f32_16x16x32_bf16 v[64:67], a[196:199], a[132:135], v[64:67]
    s_mov_b32 m0, s59
    ds_read_b128 a[224:227], v6 offset:16384
    v_add_f32 v13, v13, v32
    v_mfma_f32_16x16x32_bf16 v[64:67], a[200:203], a[136:139], v[64:67]
    buffer_load_dwordx4 v7, s[24:27], s56 offen offset:0 sc1 lds
    v_mfma_f32_16x16x32_bf16 v[64:67], a[204:207], a[140:143], v[64:67]
    s_add_u32 s64, s64, 1
    ds_read_b128 a[228:231], v6 offset:17408
    v_exp_f32 v20, v96
    v_mfma_f32_16x16x32_bf16 v[72:75], a[192:195], a[144:147], v[168:171]
    ds_read_b128 a[232:235], v6 offset:18432
    v_exp_f32 v21, v97
    v_mfma_f32_16x16x32_bf16 v[72:75], a[196:199], a[148:151], v[72:75]
    ds_read_b128 a[236:239], v6 offset:19456
    v_cvt_pk_bf16_f32 v144, v20, v21
    v_mfma_f32_16x16x32_bf16 v[72:75], a[200:203], a[152:155], v[72:75]
    ds_read_b128 a[240:243], v6 offset:20480
    v_exp_f32 v22, v98
    v_mfma_f32_16x16x32_bf16 v[72:75], a[204:207], a[156:159], v[72:75]
    s_waitcnt lgkmcnt(5)
    ds_read_b128 a[244:247], v6 offset:21504
    v_mfma_f32_16x16x32_bf16 v[68:71], a[208:211], a[128:131], v[164:167]
    ds_read_b128 a[248:251], v6 offset:22528
    v_exp_f32 v23, v99
    v_mfma_f32_16x16x32_bf16 v[68:71], a[212:215], a[132:135], v[68:71]
    ds_read_b128 a[252:255], v6 offset:23552
    v_cvt_pk_bf16_f32 v145, v22, v23
    v_mfma_f32_16x16x32_bf16 v[68:71], a[216:219], a[136:139], v[68:71]
    buffer_load_dwordx4 v7, s[24:27], s56 offen offset:1024 sc1 lds
    v_mfma_f32_16x16x32_bf16 v[68:71], a[220:223], a[140:143], v[68:71]
    v_exp_f32 v24, v100
    v_mfma_f32_16x16x32_bf16 v[76:79], a[208:211], a[144:147], v[172:175]
    v_exp_f32 v25, v101
    v_mfma_f32_16x16x32_bf16 v[76:79], a[212:215], a[148:151], v[76:79]
    v_exp_f32 v26, v102
    v_mfma_f32_16x16x32_bf16 v[76:79], a[216:219], a[152:155], v[76:79]
    buffer_load_dwordx4 v7, s[24:27], s56 offen offset:2048 sc1 lds
    v_cvt_pk_bf16_f32 v146, v24, v25
    v_mfma_f32_16x16x32_bf16 v[76:79], a[220:223], a[156:159], v[76:79]
    s_waitcnt lgkmcnt(0)
    v_exp_f32 v27, v103
    v_mfma_f32_16x16x32_bf16 a[0:3], a[224:227], v[128:131], a[0:3]
    ds_read_b128 a[192:195], v6 offset:8192
    v_cvt_pk_bf16_f32 v147, v26, v27
    v_mfma_f32_16x16x32_bf16 a[32:35], a[224:227], v[132:135], a[32:35]
    v_exp_f32 v20, v104
    v_mfma_f32_16x16x32_bf16 v[28:31], v[44:47], v[144:147], 0
    v_exp_f32 v21, v105
    v_mfma_f32_16x16x32_bf16 a[4:7], a[228:231], v[128:131], a[4:7]
    ds_read_b128 a[196:199], v6 offset:9216
    v_exp_f32 v22, v106
    v_mfma_f32_16x16x32_bf16 a[36:39], a[228:231], v[132:135], a[36:39]
    buffer_load_dwordx4 v7, s[24:27], s56 offen offset:3072 sc1 lds
    v_mfma_f32_16x16x32_bf16 a[8:11], a[232:235], v[128:131], a[8:11]
    s_add_u32 s56, s56, 16384
    ds_read_b128 a[200:203], v6 offset:10240
    v_cvt_pk_bf16_f32 v148, v20, v21
    v_mfma_f32_16x16x32_bf16 a[40:43], a[232:235], v[132:135], a[40:43]
    v_exp_f32 v23, v107
    v_mfma_f32_16x16x32_bf16 a[12:15], a[236:239], v[128:131], a[12:15]
    ds_read_b128 a[204:207], v6 offset:11264
    v_exp_f32 v24, v108
    v_mfma_f32_16x16x32_bf16 a[44:47], a[236:239], v[132:135], a[44:47]
    v_cvt_pk_bf16_f32 v149, v22, v23
    v_exp_f32 v25, v109
    v_mfma_f32_16x16x32_bf16 a[16:19], a[240:243], v[128:131], a[16:19]
    v_exp_f32 v26, v110
    v_mfma_f32_16x16x32_bf16 a[48:51], a[240:243], v[132:135], a[48:51]
    v_cvt_pk_bf16_f32 v150, v24, v25
    v_exp_f32 v27, v111
    v_mfma_f32_16x16x32_bf16 a[20:23], a[244:247], v[128:131], a[20:23]
    ds_read_b128 a[208:211], v6 offset:12288
    v_cvt_pk_bf16_f32 v151, v26, v27
    v_mfma_f32_16x16x32_bf16 a[52:55], a[244:247], v[132:135], a[52:55]
    s_add_u32 m0, s59, 16384
    ds_read_b128 a[212:215], v6 offset:13312
    v_mfma_f32_16x16x32_bf16 v[32:35], v[44:47], v[148:151], 0
    s_nop 2
    v_mfma_f32_16x16x32_bf16 a[24:27], a[248:251], v[128:131], a[24:27]
    buffer_load_dwordx4 v7, s[28:31], s57 offen offset:0 sc1 lds
    v_mfma_f32_16x16x32_bf16 a[56:59], a[248:251], v[132:135], a[56:59]
    ds_read_b128 a[216:219], v6 offset:14336
    s_nop 0
    v_mfma_f32_16x16x32_bf16 a[28:31], a[252:255], v[128:131], a[28:31]
    ds_read_b128 a[220:223], v6 offset:15360
    v_max_f32 v8, v28, v32
    v_cmp_nge_f32 vcc, s66, v8
    v_mfma_f32_16x16x32_bf16 a[60:63], a[252:255], v[132:135], a[60:63]
    s_waitcnt lgkmcnt(4)
    s_cbranch_vccnz m_stub97
m_ret98:
    v_mfma_f32_16x16x32_bf16 v[96:99], a[192:195], a[128:131], v[160:163]
    s_add_u32 s59, s58, s60
    v_exp_f32 v20, v64
    v_mfma_f32_16x16x32_bf16 v[96:99], a[196:199], a[132:135], v[96:99]
    s_add_u32 s58, s58, 32768
    ds_read_b128 a[224:227], v6 offset:24576
    v_add_f32 v12, v12, v28
    v_mfma_f32_16x16x32_bf16 v[96:99], a[200:203], a[136:139], v[96:99]
    s_and_b32 s58, s58, 0x1ffff
    ds_read_b128 a[228:231], v6 offset:25600
    v_exp_f32 v21, v65
    v_mfma_f32_16x16x32_bf16 v[96:99], a[204:207], a[140:143], v[96:99]
    s_bitcmp1_b64 s[62:63], s64
    s_cselect_b32 s66, -1.0, s65
    ds_read_b128 a[232:235], v6 offset:26624
    v_mfma_f32_16x16x32_bf16 v[104:107], a[192:195], a[144:147], v[168:171]
    buffer_load_dwordx4 v7, s[28:31], s57 offen offset:1024 sc1 lds
    v_mfma_f32_16x16x32_bf16 v[104:107], a[196:199], a[148:151], v[104:107]
    s_add_u32 s64, s64, 1
    ds_read_b128 a[236:239], v6 offset:27648
    v_cvt_pk_bf16_f32 v128, v20, v21
    v_mfma_f32_16x16x32_bf16 v[104:107], a[200:203], a[152:155], v[104:107]
    ds_read_b128 a[240:243], v6 offset:28672
    v_exp_f32 v22, v66
    v_mfma_f32_16x16x32_bf16 v[104:107], a[204:207], a[156:159], v[104:107]
    s_waitcnt lgkmcnt(5)
    ds_read_b128 a[244:247], v6 offset:29696
    v_add_f32 v13, v13, v32
    v_mfma_f32_16x16x32_bf16 v[100:103], a[208:211], a[128:131], v[164:167]
    ds_read_b128 a[248:251], v6 offset:30720
    v_exp_f32 v23, v67
    v_mfma_f32_16x16x32_bf16 v[100:103], a[212:215], a[132:135], v[100:103]
    buffer_load_dwordx4 v7, s[28:31], s57 offen offset:2048 sc1 lds
    v_mfma_f32_16x16x32_bf16 v[100:103], a[216:219], a[136:139], v[100:103]
    ds_read_b128 a[252:255], v6 offset:31744
    v_cvt_pk_bf16_f32 v129, v22, v23
    v_mfma_f32_16x16x32_bf16 v[100:103], a[220:223], a[140:143], v[100:103]
    v_exp_f32 v24, v68
    v_mfma_f32_16x16x32_bf16 v[108:111], a[208:211], a[144:147], v[172:175]
    v_exp_f32 v25, v69
    v_mfma_f32_16x16x32_bf16 v[108:111], a[212:215], a[148:151], v[108:111]
    buffer_load_dwordx4 v7, s[28:31], s57 offen offset:3072 sc1 lds
    v_mfma_f32_16x16x32_bf16 v[108:111], a[216:219], a[152:155], v[108:111]
    s_add_u32 s57, s57, 16384
    v_exp_f32 v26, v70
    v_cvt_pk_bf16_f32 v130, v24, v25
    v_mfma_f32_16x16x32_bf16 v[108:111], a[220:223], a[156:159], v[108:111]
    s_waitcnt vmcnt(16) lgkmcnt(0)
    v_add_u32 v6, s58, v2
    v_exp_f32 v27, v71
    v_mfma_f32_16x16x32_bf16 a[0:3], a[224:227], v[144:147], a[0:3]
    s_barrier
    v_mfma_f32_16x16x32_bf16 a[32:35], a[224:227], v[148:151], a[32:35]
    ds_read_b128 a[192:195], v6 offset:0
    v_cvt_pk_bf16_f32 v131, v26, v27
    v_mfma_f32_16x16x32_bf16 a[4:7], a[228:231], v[144:147], a[4:7]
    v_exp_f32 v20, v72
    v_mfma_f32_16x16x32_bf16 v[28:31], v[44:47], v[128:131], 0
    v_exp_f32 v21, v73
    v_mfma_f32_16x16x32_bf16 a[36:39], a[228:231], v[148:151], a[36:39]
    ds_read_b128 a[196:199], v6 offset:1024
    v_cvt_pk_bf16_f32 v132, v20, v21
    v_mfma_f32_16x16x32_bf16 a[8:11], a[232:235], v[144:147], a[8:11]
    v_exp_f32 v22, v74
    v_mfma_f32_16x16x32_bf16 a[40:43], a[232:235], v[148:151], a[40:43]
    ds_read_b128 a[200:203], v6 offset:2048
    v_exp_f32 v23, v75
    v_mfma_f32_16x16x32_bf16 a[12:15], a[236:239], v[144:147], a[12:15]
    v_exp_f32 v24, v76
    v_mfma_f32_16x16x32_bf16 a[44:47], a[236:239], v[148:151], a[44:47]
    ds_read_b128 a[204:207], v6 offset:3072
    v_cvt_pk_bf16_f32 v133, v22, v23
    v_mfma_f32_16x16x32_bf16 a[16:19], a[240:243], v[144:147], a[16:19]
    v_exp_f32 v25, v77
    v_mfma_f32_16x16x32_bf16 a[48:51], a[240:243], v[148:151], a[48:51]
    v_exp_f32 v26, v78
    v_cvt_pk_bf16_f32 v134, v24, v25
    v_mfma_f32_16x16x32_bf16 a[20:23], a[244:247], v[144:147], a[20:23]
    v_exp_f32 v27, v79
    v_mfma_f32_16x16x32_bf16 a[52:55], a[244:247], v[148:151], a[52:55]
    ds_read_b128 a[208:211], v6 offset:4096
    v_cvt_pk_bf16_f32 v135, v26, v27
    s_nop 1
    v_mfma_f32_16x16x32_bf16 v[32:35], v[44:47], v[132:135], 0
    s_nop 2
    v_mfma_f32_16x16x32_bf16 a[24:27], a[248:251], v[144:147], a[24:27]
    ds_read_b128 a[212:215], v6 offset:5120
    s_nop 0
    v_mfma_f32_16x16x32_bf16 a[56:59], a[248:251], v[148:151], a[56:59]
    ds_read_b128 a[216:219], v6 offset:6144
    v_max_f32 v8, v28, v32
    v_mfma_f32_16x16x32_bf16 a[28:31], a[252:255], v[144:147], a[28:31]
    ds_read_b128 a[220:223], v6 offset:7168
    v_cmp_nge_f32 vcc, s66, v8
    v_mfma_f32_16x16x32_bf16 a[60:63], a[252:255], v[148:151], a[60:63]
    s_waitcnt lgkmcnt(4)
    s_cbranch_vccz m_single96
    v_cmp_lt_f32 vcc, s65, v8
    s_cmp_lg_u32 s64, s70
    s_cbranch_scc1 m_e100
    v_add_f32 v160, v160, v16
    v_mov_b32 v164, v9
    v_add_f32 v172, v172, v16
    v_add_f32 v161, v161, v17
    v_mov_b32 v165, v9
    v_add_f32 v173, v173, v17
    v_add_f32 v162, v162, v18
    v_mov_b32 v166, v9
    v_add_f32 v174, v174, v18
    v_add_f32 v163, v163, v19
    v_mov_b32 v167, v9
    v_add_f32 v175, v175, v19
    s_nop 0
m_e100:
    s_cmp_lg_u32 s64, s71
    s_cbranch_scc1 m_e101
    v_mov_b32 v160, v9
    v_mov_b32 v168, v9
    v_mov_b32 v172, v9
    v_mov_b32 v161, v9
    v_mov_b32 v169, v9
    v_mov_b32 v173, v9
    v_mov_b32 v162, v9
    v_mov_b32 v170, v9
    v_mov_b32 v174, v9
    v_mov_b32 v163, v9
    v_mov_b32 v171, v9
    v_mov_b32 v175, v9
    s_nop 0
m_e101:
    s_cmp_lg_u32 s64, s52
    s_cbranch_scc1 m_e103
    v_lshrrev_b32 v62, 3, v1
    v_lshlrev_b32 v62, 11, v62
    v_and_b32 v61, 7, v1
    v_lshl_add_u32 v62, v61, 7, v62
    s_lshr_b32 s90, s2, 3
    s_lshl_b32 s90, s90, 2
    s_add_u32 s90, s90, s16
    s_lshl_b32 s90, s90, 14
    s_and_b32 s91, s2, 1
    s_lshl_b32 s91, s91, 10
    s_add_u32 s90, s90, s91
    s_bitcmp1_b32 s2, 2
    s_cselect_b32 s91, 0, 5373952
    s_mov_b32 s92, 8388608
    s_cselect_b32 s46, 5373952, s92
    s_cselect_b32 s93, 0, 2097152
    s_add_u32 s91, s91, s90
    s_mov_b32 s44, s48
    s_mov_b32 s45, s49
    s_add_u32 s92, s91, 0
    buffer_load_dword v255, v62, s[44:47], s92 offen
    s_add_u32 s92, s91, 2097152
    buffer_load_dword v255, v62, s[44:47], s92 offen
    s_add_u32 s92, s91, 4194304
    buffer_load_dword v255, v62, s[44:47], s92 offen
    s_mov_b32 s44, s50
    s_mov_b32 s45, s51
    s_mov_b32 s46, s93
    buffer_load_dword v255, v62, s[44:47], s90 offen
m_e103:
    s_cmp_lg_u32 s64, s53
    s_cbranch_scc1 m_e104
    s_cmp_lg_u32 s16, 0
    s_cbranch_scc1 m_np105
    v_mov_b32 v60, s4
    v_mov_b32 v61, s5
    s_add_u32 s90, s17, 117440512
    s_mov_b64 exec, 1
    buffer_store_dwordx2 v[60:61], off, s[8:11], s90 sc1
    s_mov_b64 exec, -1
m_np105:
    s_mov_b32 s17, -1
m_e104:
    s_cmp_gt_u32 s64, 26
    s_cbranch_scc1 m_e102
    s_cmp_lg_u32 s64, 6
    s_cbranch_scc1 m_e106
    s_lshr_b32 s90, s32, 1
    s_lshl_b32 s90, s90, 7
    s_add_u32 s90, s90, 117440600
    v_min_u32 v0, 1, v1
    v_lshlrev_b32 v0, 5, v0
    buffer_load_dwordx2 v[4:5], v0, s[8:11], s90 offen sc1
    s_cmp_eq_u32 s17, -1
    s_cbranch_scc1 m_e102
    s_cmp_lg_u32 s16, 0
    s_cbranch_scc1 m_np107
    v_mov_b32 v60, s4
    v_mov_b32 v61, s5
    s_add_u32 s90, s17, 117440512
    s_mov_b64 exec, 1
    buffer_store_dwordx2 v[60:61], off, s[8:11], s90 sc1
    s_mov_b64 exec, -1
m_np107:
    s_branch m_e102
m_e106:
    s_cmp_lg_u32 s64, 18
    s_cbranch_scc1 m_e108
    s_waitcnt vmcnt(18)
    s_mov_b32 s3, 1048576
m_spin109:
    v_cmp_ne_u64 s[76:77], s[4:5], v[4:5]
    s_nop 3
    s_cmp_eq_u64 s[76:77], 0
    s_cbranch_scc1 m_e102
    s_sub_u32 s3, s3, 1
    s_cbranch_scc1 m_e102
    s_sleep 32
    s_lshr_b32 s90, s32, 1
    s_lshl_b32 s90, s90, 7
    s_add_u32 s90, s90, 117440600
    v_min_u32 v0, 1, v1
    v_lshlrev_b32 v0, 5, v0
    buffer_load_dwordx2 v[4:5], v0, s[8:11], s90 offen sc1
    s_waitcnt vmcnt(0)
    s_branch m_spin109
    s_branch m_e102
m_e108:
    s_cmp_lg_u32 s64, 22
    s_cbranch_scc1 m_e110
    buffer_load_dwordx2 v[4:5], v10, s[8:11], 0 offen sc1
    s_mov_b32 s44, s48
    s_mov_b32 s45, s49
    s_mov_b32 s46, 8388608
    s_lshl_b32 s90, s2, 2
    s_add_u32 s90, s90, s16
    s_lshl_b32 s90, s90, 13
    v_lshlrev_b32 v62, 7, v1
    buffer_load_dword v255, v62, s[44:47], s90 offen
    s_branch m_e102
m_e110:
    s_cmp_lg_u32 s64, 26
    s_cbranch_scc1 m_e111
    s_mov_b32 s44, s50
    s_mov_b32 s45, s51
    s_mov_b32 s46, 2097152
    s_lshl_b32 s90, s2, 2
    s_add_u32 s90, s90, s16
    s_lshl_b32 s90, s90, 13
    v_lshlrev_b32 v62, 7, v1
    buffer_load_dword v255, v62, s[44:47], s90 offen
    s_waitcnt vmcnt(18)
    s_mov_b32 s3, 1048576
m_spin112:
    v_cmp_ne_u64 s[76:77], s[4:5], v[4:5]
    s_nop 3
    s_cmp_eq_u64 s[76:77], 0
    s_cbranch_scc1 m_e102
    s_sub_u32 s3, s3, 1
    s_cbranch_scc1 m_e102
    s_sleep 32
    buffer_load_dwordx2 v[4:5], v10, s[8:11], 0 offen sc1
    s_waitcnt vmcnt(0)
    s_branch m_spin112
    s_branch m_e102
m_e111:
m_e102:
    s_cbranch_vccnz m_rc113
m_sp99:
    s_cmp_lg_u32 s64, s72
    s_cbranch_scc1 m_single96
    s_bfe_u32 s95, s2, 0x10002
    s_xor_b32 s95, s95, 1
    s_bitcmp1_b32 s2, 1
    s_cselect_b32 s96, s33, s34
    s_sub_u32 s96, s96, 1
    s_and_b32 s90, s2, 1
    s_lshl_b32 s90, s90, 2
    s_bfe_u32 s91, s2, 0x20003
    s_add_u32 s97, s90, s91
    v_and_b32 v10, 31, v1
    v_lshlrev_b32 v10, 3, v10
    s_lshl_b32 s52, s96, 8
    s_add_u32 s52, s52, 117448704
    buffer_load_dwordx2 v[4:5], v10, s[8:11], s52 offen sc1
    ds_read_b128 a[224:227], v6 offset:16384
    ds_read_b128 a[228:231], v6 offset:17408
    ds_read_b128 a[232:235], v6 offset:18432
    ds_read_b128 a[236:239], v6 offset:19456
    ds_read_b128 a[240:243], v6 offset:20480
    ds_read_b128 a[244:247], v6 offset:21504
    ds_read_b128 a[248:251], v6 offset:22528
    ds_read_b128 a[252:255], v6 offset:23552
    s_waitcnt lgkmcnt(0)
    v_mfma_f32_16x16x32_bf16 a[0:3], a[224:227], v[128:131], a[0:3]
    buffer_load_dwordx4 v[192:195], v2, s[8:11], s83 offen offset:0 sc1
    v_exp_f32 v20, v96
    v_mfma_f32_16x16x32_bf16 a[32:35], a[224:227], v[132:135], a[32:35]
    v_exp_f32 v21, v97
    v_exp_f32 v22, v98
    v_mfma_f32_16x16x32_bf16 a[4:7], a[228:231], v[128:131], a[4:7]
    buffer_load_dwordx4 v[196:199], v2, s[8:11], s83 offen offset:1024 sc1
    v_cvt_pk_bf16_f32 v144, v20, v21
    v_add_f32 v12, v12, v28
    v_mfma_f32_16x16x32_bf16 a[36:39], a[228:231], v[132:135], a[36:39]
    v_exp_f32 v23, v99
    v_exp_f32 v24, v100
    v_cvt_pk_bf16_f32 v145, v22, v23
    v_mfma_f32_16x16x32_bf16 a[8:11], a[232:235], v[128:131], a[8:11]
    buffer_load_dwordx4 v[200:203], v2, s[8:11], s83 offen offset:2048 sc1
    v_exp_f32 v25, v101
    v_mfma_f32_16x16x32_bf16 a[40:43], a[232:235], v[132:135], a[40:43]
    v_exp_f32 v26, v102
    v_cvt_pk_bf16_f32 v146, v24, v25
    v_add_f32 v13, v13, v32
    v_mfma_f32_16x16x32_bf16 a[12:15], a[236:239], v[128:131], a[12:15]
    buffer_load_dwordx4 v[204:207], v2, s[8:11], s83 offen offset:3072 sc1
    v_exp_f32 v27, v103
    v_mfma_f32_16x16x32_bf16 a[44:47], a[236:239], v[132:135], a[44:47]
    v_exp_f32 v20, v104
    v_cvt_pk_bf16_f32 v147, v26, v27
    v_mfma_f32_16x16x32_bf16 a[16:19], a[240:243], v[128:131], a[16:19]
    buffer_load_dwordx4 v[212:215], v2, s[8:11], s84 offen offset:0 sc1
    v_exp_f32 v21, v105
    v_mfma_f32_16x16x32_bf16 v[28:31], v[44:47], v[144:147], 0
    v_exp_f32 v22, v106
    v_cvt_pk_bf16_f32 v148, v20, v21
    v_exp_f32 v23, v107
    v_mfma_f32_16x16x32_bf16 a[48:51], a[240:243], v[132:135], a[48:51]
    v_exp_f32 v24, v108
    v_cvt_pk_bf16_f32 v149, v22, v23
    v_exp_f32 v25, v109
    v_mfma_f32_16x16x32_bf16 a[20:23], a[244:247], v[128:131], a[20:23]
    buffer_load_dwordx4 v[216:219], v2, s[8:11], s84 offen offset:1024 sc1
    v_exp_f32 v26, v110
    v_mfma_f32_16x16x32_bf16 a[52:55], a[244:247], v[132:135], a[52:55]
    v_cvt_pk_bf16_f32 v150, v24, v25
    v_exp_f32 v27, v111
    s_nop 0
    v_cvt_pk_bf16_f32 v151, v26, v27
    s_nop 1
    v_mfma_f32_16x16x32_bf16 v[32:35], v[44:47], v[148:151], 0
    s_nop 2
    v_mfma_f32_16x16x32_bf16 a[24:27], a[248:251], v[128:131], a[24:27]
    buffer_load_dwordx4 v[220:223], v2, s[8:11], s84 offen offset:2048 sc1
    v_mfma_f32_16x16x32_bf16 a[56:59], a[248:251], v[132:135], a[56:59]
    s_nop 2
    v_mfma_f32_16x16x32_bf16 a[28:31], a[252:255], v[128:131], a[28:31]
    v_max_f32 v8, v28, v32
    v_cmp_nge_f32 vcc, s65, v8
    v_mfma_f32_16x16x32_bf16 a[60:63], a[252:255], v[132:135], a[60:63]
    s_cbranch_vccnz m_stub114
m_ret115:
    s_nop 1
    ds_read_b128 a[224:227], v6 offset:24576
    ds_read_b128 a[228:231], v6 offset:25600
    ds_read_b128 a[232:235], v6 offset:26624
    ds_read_b128 a[236:239], v6 offset:27648
    ds_read_b128 a[240:243], v6 offset:28672
    ds_read_b128 a[244:247], v6 offset:29696
    ds_read_b128 a[248:251], v6 offset:30720
    ds_read_b128 a[252:255], v6 offset:31744
    s_waitcnt lgkmcnt(0)
    v_mfma_f32_16x16x32_bf16 a[0:3], a[224:227], v[144:147], a[0:3]
    buffer_load_dwordx4 v[224:227], v2, s[8:11], s84 offen offset:3072 sc1
    v_mfma_f32_16x16x32_bf16 a[32:35], a[224:227], v[148:151], a[32:35]
    v_mfma_f32_16x16x32_bf16 a[4:7], a[228:231], v[144:147], a[4:7]
    buffer_load_dwordx4 v[208:211], v2, s[8:11], s85 offen offset:0 sc1
    v_mfma_f32_16x16x32_bf16 a[36:39], a[228:231], v[148:151], a[36:39]
    v_mfma_f32_16x16x32_bf16 a[8:11], a[232:235], v[144:147], a[8:11]
    buffer_load_dwordx4 v[232:235], v2, s[8:11], s86 offen offset:0 sc1
    v_mfma_f32_16x16x32_bf16 a[40:43], a[232:235], v[148:151], a[40:43]
    v_mfma_f32_16x16x32_bf16 a[12:15], a[236:239], v[144:147], a[12:15]
    buffer_load_dwordx4 v[236:239], v2, s[8:11], s86 offen offset:1024 sc1
    v_mfma_f32_16x16x32_bf16 a[44:47], a[236:239], v[148:151], a[44:47]
    v_mfma_f32_16x16x32_bf16 a[16:19], a[240:243], v[144:147], a[16:19]
    buffer_load_dwordx4 v[228:231], v2, s[8:11], s87 offen offset:0 sc1
    v_mfma_f32_16x16x32_bf16 a[48:51], a[240:243], v[148:151], a[48:51]
    v_mfma_f32_16x16x32_bf16 a[20:23], a[244:247], v[144:147], a[20:23]
    buffer_load_dwordx4 v[244:247], v2, s[8:11], s88 offen offset:0 sc1
    v_mfma_f32_16x16x32_bf16 a[52:55], a[244:247], v[148:151], a[52:55]
    v_mfma_f32_16x16x32_bf16 a[24:27], a[248:251], v[144:147], a[24:27]
    buffer_load_dwordx4 v[248:251], v2, s[8:11], s88 offen offset:1024 sc1
    v_mfma_f32_16x16x32_bf16 a[56:59], a[248:251], v[148:151], a[56:59]
    v_mfma_f32_16x16x32_bf16 a[28:31], a[252:255], v[144:147], a[28:31]
    buffer_load_dwordx4 v[240:243], v2, s[8:11], s89 offen offset:0 sc1
    v_mfma_f32_16x16x32_bf16 a[60:63], a[252:255], v[148:151], a[60:63]
    s_barrier
    v_add_f32 v20, v12, v28
    v_add_f32 v21, v13, v32
    s_nop 3
    v_rcp_f32 v20, v20
    v_rcp_f32 v21, v21
    s_lshl_b32 s90, s78, 10
    s_add_u32 s90, s90, s82
    s_add_u32 s90, s90, 67108864
    v_accvgpr_read_b32 v48, a0
    v_accvgpr_read_b32 v49, a1
    v_accvgpr_read_b32 v50, a2
    v_accvgpr_read_b32 v51, a3
    v_accvgpr_read_b32 v52, a4
    v_accvgpr_read_b32 v53, a5
    v_accvgpr_read_b32 v54, a6
    v_accvgpr_read_b32 v55, a7
    v_mul_f32 v48, v20, v48
    v_mul_f32 v49, v20, v49
    v_mul_f32 v50, v20, v50
    v_mul_f32 v51, v20, v51
    v_mul_f32 v52, v20, v52
    v_mul_f32 v53, v20, v53
    v_mul_f32 v54, v20, v54
    v_mul_f32 v55, v20, v55
    v_cvt_pk_bf16_f32 v48, v48, v49
    v_cvt_pk_bf16_f32 v49, v50, v51
    v_cvt_pk_bf16_f32 v50, v52, v53
    v_cvt_pk_bf16_f32 v51, v54, v55
    buffer_store_dwordx4 v[48:51], v2, s[8:11], s90 offen offset:0 sc1
    v_accvgpr_read_b32 v56, a32
    v_accvgpr_read_b32 v57, a33
    v_accvgpr_read_b32 v58, a34
    v_accvgpr_read_b32 v59, a35
    v_accvgpr_read_b32 v60, a36
    v_accvgpr_read_b32 v61, a37
    v_accvgpr_read_b32 v62, a38
    v_accvgpr_read_b32 v63, a39
    v_mul_f32 v56, v21, v56
    v_mul_f32 v57, v21, v57
    v_mul_f32 v58, v21, v58
    v_mul_f32 v59, v21, v59
    v_mul_f32 v60, v21, v60
    v_mul_f32 v61, v21, v61
    v_mul_f32 v62, v21, v62
    v_mul_f32 v63, v21, v63
    v_cvt_pk_bf16_f32 v56, v56, v57
    v_cvt_pk_bf16_f32 v57, v58, v59
    v_cvt_pk_bf16_f32 v58, v60, v61
    v_cvt_pk_bf16_f32 v59, v62, v63
    buffer_store_dwordx4 v[56:59], v2, s[8:11], s90 offen offset:1024 sc1
    s_add_u32 s90, s90, 131072
    v_accvgpr_read_b32 v48, a8
    v_accvgpr_read_b32 v49, a9
    v_accvgpr_read_b32 v50, a10
    v_accvgpr_read_b32 v51, a11
    v_accvgpr_read_b32 v52, a12
    v_accvgpr_read_b32 v53, a13
    v_accvgpr_read_b32 v54, a14
    v_accvgpr_read_b32 v55, a15
    v_mul_f32 v48, v20, v48
    v_mul_f32 v49, v20, v49
    v_mul_f32 v50, v20, v50
    v_mul_f32 v51, v20, v51
    v_mul_f32 v52, v20, v52
    v_mul_f32 v53, v20, v53
    v_mul_f32 v54, v20, v54
    v_mul_f32 v55, v20, v55
    v_cvt_pk_bf16_f32 v48, v48, v49
    v_cvt_pk_bf16_f32 v49, v50, v51
    v_cvt_pk_bf16_f32 v50, v52, v53
    v_cvt_pk_bf16_f32 v51, v54, v55
    buffer_store_dwordx4 v[48:51], v2, s[8:11], s90 offen offset:0 sc1
    v_accvgpr_read_b32 v56, a40
    v_accvgpr_read_b32 v57, a41
    v_accvgpr_read_b32 v58, a42
    v_accvgpr_read_b32 v59, a43
    v_accvgpr_read_b32 v60, a44
    v_accvgpr_read_b32 v61, a45
    v_accvgpr_read_b32 v62, a46
    v_accvgpr_read_b32 v63, a47
    v_mul_f32 v56, v21, v56
    v_mul_f32 v57, v21, v57
    v_mul_f32 v58, v21, v58
    v_mul_f32 v59, v21, v59
    v_mul_f32 v60, v21, v60
    v_mul_f32 v61, v21, v61
    v_mul_f32 v62, v21, v62
    v_mul_f32 v63, v21, v63
    v_cvt_pk_bf16_f32 v56, v56, v57
    v_cvt_pk_bf16_f32 v57, v58, v59
    v_cvt_pk_bf16_f32 v58, v60, v61
    v_cvt_pk_bf16_f32 v59, v62, v63
    buffer_store_dwordx4 v[56:59], v2, s[8:11], s90 offen offset:1024 sc1
    s_add_u32 s90, s90, 131072
    v_accvgpr_read_b32 v48, a16
    v_accvgpr_read_b32 v49, a17
    v_accvgpr_read_b32 v50, a18
    v_accvgpr_read_b32 v51, a19
    v_accvgpr_read_b32 v52, a20
    v_accvgpr_read_b32 v53, a21
    v_accvgpr_read_b32 v54, a22
    v_accvgpr_read_b32 v55, a23
    v_mul_f32 v48, v20, v48
    v_mul_f32 v49, v20, v49
    v_mul_f32 v50, v20, v50
    v_mul_f32 v51, v20, v51
    v_mul_f32 v52, v20, v52
    v_mul_f32 v53, v20, v53
    v_mul_f32 v54, v20, v54
    v_mul_f32 v55, v20, v55
    v_cvt_pk_bf16_f32 v48, v48, v49
    v_cvt_pk_bf16_f32 v49, v50, v51
    v_cvt_pk_bf16_f32 v50, v52, v53
    v_cvt_pk_bf16_f32 v51, v54, v55
    buffer_store_dwordx4 v[48:51], v2, s[8:11], s90 offen offset:0 sc1
    v_accvgpr_read_b32 v56, a48
    v_accvgpr_read_b32 v57, a49
    v_accvgpr_read_b32 v58, a50
    v_accvgpr_read_b32 v59, a51
    v_accvgpr_read_b32 v60, a52
    v_accvgpr_read_b32 v61, a53
    v_accvgpr_read_b32 v62, a54
    v_accvgpr_read_b32 v63, a55
    v_mul_f32 v56, v21, v56
    v_mul_f32 v57, v21, v57
    v_mul_f32 v58, v21, v58
    v_mul_f32 v59, v21, v59
    v_mul_f32 v60, v21, v60
    v_mul_f32 v61, v21, v61
    v_mul_f32 v62, v21, v62
    v_mul_f32 v63, v21, v63
    v_cvt_pk_bf16_f32 v56, v56, v57
    v_cvt_pk_bf16_f32 v57, v58, v59
    v_cvt_pk_bf16_f32 v58, v60, v61
    v_cvt_pk_bf16_f32 v59, v62, v63
    buffer_store_dwordx4 v[56:59], v2, s[8:11], s90 offen offset:1024 sc1
    s_add_u32 s90, s90, 131072
    v_accvgpr_read_b32 v48, a24
    v_accvgpr_read_b32 v49, a25
    v_accvgpr_read_b32 v50, a26
    v_accvgpr_read_b32 v51, a27
    v_accvgpr_read_b32 v52, a28
    v_accvgpr_read_b32 v53, a29
    v_accvgpr_read_b32 v54, a30
    v_accvgpr_read_b32 v55, a31
    v_mul_f32 v48, v20, v48
    v_mul_f32 v49, v20, v49
    v_mul_f32 v50, v20, v50
    v_mul_f32 v51, v20, v51
    v_mul_f32 v52, v20, v52
    v_mul_f32 v53, v20, v53
    v_mul_f32 v54, v20, v54
    v_mul_f32 v55, v20, v55
    v_cvt_pk_bf16_f32 v48, v48, v49
    v_cvt_pk_bf16_f32 v49, v50, v51
    v_cvt_pk_bf16_f32 v50, v52, v53
    v_cvt_pk_bf16_f32 v51, v54, v55
    buffer_store_dwordx4 v[48:51], v2, s[8:11], s90 offen offset:0 sc1
    v_accvgpr_read_b32 v56, a56
    v_accvgpr_read_b32 v57, a57
    v_accvgpr_read_b32 v58, a58
    v_accvgpr_read_b32 v59, a59
    v_accvgpr_read_b32 v60, a60
    v_accvgpr_read_b32 v61, a61
    v_accvgpr_read_b32 v62, a62
    v_accvgpr_read_b32 v63, a63
    v_mul_f32 v56, v21, v56
    v_mul_f32 v57, v21, v57
    v_mul_f32 v58, v21, v58
    v_mul_f32 v59, v21, v59
    v_mul_f32 v60, v21, v60
    v_mul_f32 v61, v21, v61
    v_mul_f32 v62, v21, v62
    v_mul_f32 v63, v21, v63
    v_cvt_pk_bf16_f32 v56, v56, v57
    v_cvt_pk_bf16_f32 v57, v58, v59
    v_cvt_pk_bf16_f32 v58, v60, v61
    v_cvt_pk_bf16_f32 v59, v62, v63
    buffer_store_dwordx4 v[56:59], v2, s[8:11], s90 offen offset:1024 sc1
    s_add_u32 s90, s90, 131072
    s_lshr_b32 s53, s16, 1
    s_and_b32 s40, s16, 1
    s_mul_i32 s90, s95, 5373952
    s_lshl_b32 s57, s97, 8
    s_add_u32 s57, s57, s90
    v_lshrrev_b32 v20, 4, v1
    s_lshl_b32 s90, s16, 4
    v_add_u32 v21, s90, v20
    v_lshlrev_b32 v21, 11, v21
    v_lshlrev_b32 v20, 1, v20
    v_and_b32 v22, 15, v1
    v_xor_b32 v20, v20, v22
    v_xor_b32 v22, 0, v20
    v_lshl_add_u32 v16, v22, 4, v21
    v_xor_b32 v22, 8, v20
    v_lshl_add_u32 v17, v22, 4, v21
    v_add_u32 v17, 7168, v17
    v_xor_b32 v22, 0, v20
    v_lshl_add_u32 v18, v22, 4, v21
    v_add_u32 v18, 14336, v18
    v_xor_b32 v22, 8, v20
    v_lshl_add_u32 v19, v22, 4, v21
    v_add_u32 v19, 21504, v19
    s_mov_b32 s24, s48
    s_mov_b32 s25, s49
    s_mov_b32 s26, 8388608
    s_mov_b32 s38, 268435456
    s_mov_b32 s28, s54
    s_mov_b32 s29, s55
    s_mov_b32 s30, 8388608
    s_lshl_b32 s90, s96, 13
    s_lshl_b32 s91, s40, 12
    s_add_u32 s90, s90, s91
    s_lshl_b32 s91, s53, 17
    s_add_u32 s69, s90, s91
    s_mul_i32 s90, s95, 10747904
    s_add_u32 s56, s69, s90
    s_add_u32 s56, s56, 67108864
    s_add_u32 s69, s69, 83886080
    s_add_u32 m0, s60, 16384
    s_nop 0
    buffer_load_dwordx4 v16, s[24:27], s57 offen offset:0 lds
    buffer_load_dwordx4 v17, s[24:27], s57 offen offset:1024 lds
    buffer_load_dwordx4 v18, s[24:27], s57 offen offset:2048 lds
    buffer_load_dwordx4 v19, s[24:27], s57 offen offset:3072 lds
    s_add_u32 s57, s57, 131072
    s_add_u32 m0, s60, 49152
    s_nop 0
    buffer_load_dwordx4 v16, s[24:27], s57 offen offset:0 lds
    buffer_load_dwordx4 v17, s[24:27], s57 offen offset:1024 lds
    buffer_load_dwordx4 v18, s[24:27], s57 offen offset:2048 lds
    buffer_load_dwordx4 v19, s[24:27], s57 offen offset:3072 lds
    s_add_u32 s57, s57, 131072
    s_add_u32 m0, s60, 81920
    s_nop 0
    buffer_load_dwordx4 v16, s[24:27], s57 offen offset:0 lds
    buffer_load_dwordx4 v17, s[24:27], s57 offen offset:1024 lds
    buffer_load_dwordx4 v18, s[24:27], s57 offen offset:2048 lds
    buffer_load_dwordx4 v19, s[24:27], s57 offen offset:3072 lds
    s_add_u32 s57, s57, 131072
    s_add_u32 m0, s60, 114688
    s_nop 0
    buffer_load_dwordx4 v16, s[24:27], s57 offen offset:0 lds
    buffer_load_dwordx4 v17, s[24:27], s57 offen offset:1024 lds
    buffer_load_dwordx4 v18, s[24:27], s57 offen offset:2048 lds
    buffer_load_dwordx4 v19, s[24:27], s57 offen offset:3072 lds
    s_add_u32 s57, s57, 131072
    s_waitcnt vmcnt(39)
    v_cmp_ne_u64 s[76:77], s[4:5], v[4:5]
    s_mul_i32 s91, s95, 20
    s_nop 2
    s_lshr_b32 s90, s76, s91
    s_ff1_i32_b32 s90, s90
    s_lshl_b32 s68, s90, 1
    s_mul_i32 s91, s95, 1
    s_sub_i32 s68, s68, s91
    s_cmp_lt_i32 s90, 0
    s_cselect_b32 s68, 1000, s68
    s_mov_b32 s99, 0
    s_cmp_gt_i32 s68, 4
    s_cbranch_scc0 m_x1116
    s_mov_b32 s99, 1
    s_add_u32 m0, s60, 0
    s_nop 0
    buffer_load_dwordx4 v2, s[36:39], s56 offen offset:0 sc1 lds
    buffer_load_dwordx4 v2, s[36:39], s56 offen offset:1024 sc1 lds
    buffer_load_dwordx4 v2, s[36:39], s56 offen offset:2048 sc1 lds
    buffer_load_dwordx4 v2, s[36:39], s56 offen offset:3072 sc1 lds
    s_add_u32 s56, s56, 262144
    s_add_u32 m0, s60, 32768
    s_nop 0
    buffer_load_dwordx4 v2, s[36:39], s56 offen offset:0 sc1 lds
    buffer_load_dwordx4 v2, s[36:39], s56 offen offset:1024 sc1 lds
    buffer_load_dwordx4 v2, s[36:39], s56 offen offset:2048 sc1 lds
    buffer_load_dwordx4 v2, s[36:39], s56 offen offset:3072 sc1 lds
    s_add_u32 s56, s56, 262144
    s_add_u32 m0, s60, 65536
    s_nop 0
    buffer_load_dwordx4 v2, s[36:39], s56 offen offset:0 sc1 lds
    buffer_load_dwordx4 v2, s[36:39], s56 offen offset:1024 sc1 lds
    buffer_load_dwordx4 v2, s[36:39], s56 offen offset:2048 sc1 lds
    buffer_load_dwordx4 v2, s[36:39], s56 offen offset:3072 sc1 lds
    s_add_u32 s56, s56, 262144
    s_add_u32 m0, s60, 98304
    s_nop 0
    buffer_load_dwordx4 v2, s[36:39], s56 offen offset:0 sc1 lds
    buffer_load_dwordx4 v2, s[36:39], s56 offen offset:1024 sc1 lds
    buffer_load_dwordx4 v2, s[36:39], s56 offen offset:2048 sc1 lds
    buffer_load_dwordx4 v2, s[36:39], s56 offen offset:3072 sc1 lds
    s_add_u32 s56, s56, 262144
    s_add_u32 m0, s60, 131072
    s_nop 0
    buffer_load_dwordx4 v2, s[36:39], s56 offen offset:0 sc1 lds
    buffer_load_dwordx4 v2, s[36:39], s56 offen offset:1024 sc1 lds
    buffer_load_dwordx4 v2, s[36:39], s56 offen offset:2048 sc1 lds
    buffer_load_dwordx4 v2, s[36:39], s56 offen offset:3072 sc1 lds
    s_add_u32 s56, s56, 262144
m_x1116:
    s_lshl_b32 s90, s53, 12
    v_add_u32 v6, s90, v2
    v_lshrrev_b32 v48, 2, v1
    v_lshlrev_b32 v48, 8, v48
    v_and_b32 v49, 3, v1
    v_lshl_add_u32 v48, v49, 3, v48
    v_add_u32 v48, 16384, v48
    v_bfe_u32 v49, v1, 2, 3
    s_lshl_b32 s90, s40, 2
    v_xor_b32 v49, s90, v49
    v_xor_b32 v50, 0, v49
    v_lshl_add_u32 v12, v50, 5, v48
    v_xor_b32 v50, 1, v49
    v_lshl_add_u32 v13, v50, 5, v48
    v_xor_b32 v50, 2, v49
    v_lshl_add_u32 v14, v50, 5, v48
    v_xor_b32 v50, 3, v49
    v_lshl_add_u32 v15, v50, 5, v48
    v_and_b32 v48, 15, v1
    v_lshlrev_b32 v48, 12, v48
    v_lshlrev_b32 v48, s95, v48
    v_bfe_u32 v49, v1, 4, 1
    v_lshl_add_u32 v48, v49, 5, v48
    v_lshrrev_b32 v49, 5, v1
    v_lshl_add_u32 v7, v49, 4, v48
    s_lshl_b32 s90, s96, 3
    s_lshl_b32 s91, s53, 2
    s_add_u32 s90, s90, s91
    s_lshl_b32 s91, s90, 16
    s_add_u32 s91, s91, 2048
    s_and_b32 s92, s90, 63
    s_lshl_b32 s92, s92, 17
    s_lshr_b32 s93, s90, 6
    s_lshl_b32 s93, s93, 12
    s_add_u32 s92, s92, s93
    s_cmp_eq_u32 s95, 1
    s_cselect_b32 s71, s92, s91
    s_lshl_b32 s72, 0x10000, s95
    s_lshl_b32 s92, s97, 8
    s_lshl_b32 s93, s40, 7
    s_add_u32 s71, s71, s92
    s_add_u32 s71, s71, s93
    v_mov_b64 v[64:65], 0
    v_mov_b64 v[66:67], 0
    v_mov_b64 v[68:69], 0
    v_mov_b64 v[70:71], 0
    v_mov_b64 v[72:73], 0
    v_mov_b64 v[74:75], 0
    v_mov_b64 v[76:77], 0
    v_mov_b64 v[78:79], 0
    v_mov_b64 v[80:81], 0
    v_mov_b64 v[82:83], 0
    v_mov_b64 v[84:85], 0
    v_mov_b64 v[86:87], 0
    v_mov_b64 v[88:89], 0
    v_mov_b64 v[90:91], 0
    v_mov_b64 v[92:93], 0
    v_mov_b64 v[94:95], 0
    v_mov_b64 v[96:97], 0
    v_mov_b64 v[98:99], 0
    v_mov_b64 v[100:101], 0
    v_mov_b64 v[102:103], 0
    v_mov_b64 v[104:105], 0
    v_mov_b64 v[106:107], 0
    v_mov_b64 v[108:109], 0
    v_mov_b64 v[110:111], 0
    v_mov_b64 v[112:113], 0
    v_mov_b64 v[114:115], 0
    v_mov_b64 v[116:117], 0
    v_mov_b64 v[118:119], 0
    v_mov_b64 v[120:121], 0
    v_mov_b64 v[122:123], 0
    v_mov_b64 v[124:125], 0
    v_mov_b64 v[126:127], 0
    v_and_b32 v48, 15, v1
    v_lshrrev_b32 v49, 4, v1
    v_lshlrev_b32 v49, 2, v49
    v_sub_u32 v48, v48, v49
    v_cmp_ge_i32 vcc, -9, v48
    v_subrev_u32 v50, 0, v48
    v_cmp_ge_u32 s[76:77], 7, v50
    s_nop 0
    v_cndmask_b32 v128, v9, 0, vcc
    v_cndmask_b32 v132, v9, 0, s[76:77]
    v_cmp_ge_i32 vcc, -8, v48
    v_subrev_u32 v50, 1, v48
    v_cmp_ge_u32 s[76:77], 7, v50
    s_nop 0
    v_cndmask_b32 v129, v9, 0, vcc
    v_cndmask_b32 v133, v9, 0, s[76:77]
    v_cmp_ge_i32 vcc, -7, v48
    v_subrev_u32 v50, 2, v48
    v_cmp_ge_u32 s[76:77], 7, v50
    s_nop 0
    v_cndmask_b32 v130, v9, 0, vcc
    v_cndmask_b32 v134, v9, 0, s[76:77]
    v_cmp_ge_i32 vcc, -6, v48
    v_subrev_u32 v50, 3, v48
    v_cmp_ge_u32 s[76:77], 7, v50
    s_nop 0
    v_cndmask_b32 v131, v9, 0, vcc
    v_cndmask_b32 v135, v9, 0, s[76:77]
    s_cmp_eq_u32 s81, 0
    s_cselect_b64 vcc, -1, 0
    s_nop 0
    v_cndmask_b32 v136, v128, v9, vcc
    v_cndmask_b32 v137, v129, v9, vcc
    v_cndmask_b32 v138, v130, v9, vcc
    v_cndmask_b32 v139, v131, v9, vcc
    s_lshl_b32 s90, s80, 10
    s_lshr_b32 s91, s2, 3
    s_lshl_b32 s91, s91, 17
    s_add_u32 s90, s90, s91
    s_add_u32 s80, s90, 83886080
    s_add_u32 s59, s60, 131072
    s_mov_b32 s58, 0
    s_mov_b32 s100, 32768
    s_mov_b32 s64, 0
    s_mov_b32 s67, 0
    s_waitcnt vmcnt(36)
    s_cmp_eq_u32 s99, 1
    s_cbranch_scc1 m_x2117
    s_waitcnt vmcnt(16)
m_x2117:
    s_barrier
    s_lshl_b32 s91, s33, 5
    s_add_u32 s91, s91, s32
    s_lshl_b32 s91, s91, 3
    s_add_u32 s91, s91, 7936
    s_cmp_lg_u32 s16, 0
    s_cbranch_scc1 m_np119
    v_mov_b32 v60, s4
    v_mov_b32 v61, s5
    s_add_u32 s90, s91, 117440512
    s_mov_b64 exec, 1
    buffer_store_dwordx2 v[60:61], off, s[8:11], s90 sc1
    s_mov_b64 exec, -1
m_np119:
    s_cmp_eq_u32 s17, -1
    s_cbranch_scc1 m_pb120
    s_cmp_lg_u32 s16, 0
    s_cbranch_scc1 m_np121
    v_mov_b32 v60, s4
    v_mov_b32 v61, s5
    s_add_u32 s90, s17, 117440512
    s_mov_b64 exec, 1
    buffer_store_dwordx2 v[60:61], off, s[8:11], s90 sc1
    s_mov_b64 exec, -1
m_np121:
m_pb120:
    s_cmp_eq_u32 s99, 1
    s_cbranch_scc1 m_x3118
    s_mov_b32 s3, 1048576
m_spin122:
    buffer_load_dwordx2 v[4:5], v10, s[8:11], s52 offen sc1
    s_waitcnt vmcnt(0)
    v_cmp_ne_u64 s[76:77], s[4:5], v[4:5]
    s_mul_i32 s91, s95, 20
    s_nop 2
    s_lshr_b32 s90, s76, s91
    s_ff1_i32_b32 s90, s90
    s_lshl_b32 s68, s90, 1
    s_mul_i32 s91, s95, 1
    s_sub_i32 s68, s68, s91
    s_cmp_lt_i32 s90, 0
    s_cselect_b32 s68, 1000, s68
    s_cmp_gt_i32 s68, 4
    s_cbranch_scc1 m_ok123
    s_sub_u32 s3, s3, 1
    s_cbranch_scc1 m_ok123
    s_sleep 4
    s_branch m_spin122
m_ok123:
    s_add_u32 m0, s60, 0
    s_nop 0
    buffer_load_dwordx4 v2, s[36:39], s56 offen offset:0 sc1 lds
    buffer_load_dwordx4 v2, s[36:39], s56 offen offset:1024 sc1 lds
    buffer_load_dwordx4 v2, s[36:39], s56 offen offset:2048 sc1 lds
    buffer_load_dwordx4 v2, s[36:39], s56 offen offset:3072 sc1 lds
    s_add_u32 s56, s56, 262144
    s_add_u32 m0, s60, 32768
    s_nop 0
    buffer_load_dwordx4 v2, s[36:39], s56 offen offset:0 sc1 lds
    buffer_load_dwordx4 v2, s[36:39], s56 offen offset:1024 sc1 lds
    buffer_load_dwordx4 v2, s[36:39], s56 offen offset:2048 sc1 lds
    buffer_load_dwordx4 v2, s[36:39], s56 offen offset:3072 sc1 lds
    s_add_u32 s56, s56, 262144
    s_add_u32 m0, s60, 65536
    s_nop 0
    buffer_load_dwordx4 v2, s[36:39], s56 offen offset:0 sc1 lds
    buffer_load_dwordx4 v2, s[36:39], s56 offen offset:1024 sc1 lds
    buffer_load_dwordx4 v2, s[36:39], s56 offen offset:2048 sc1 lds
    buffer_load_dwordx4 v2, s[36:39], s56 offen offset:3072 sc1 lds
    s_add_u32 s56, s56, 262144
    s_add_u32 m0, s60, 98304
    s_nop 0
    buffer_load_dwordx4 v2, s[36:39], s56 offen offset:0 sc1 lds
    buffer_load_dwordx4 v2, s[36:39], s56 offen offset:1024 sc1 lds
    buffer_load_dwordx4 v2, s[36:39], s56 offen offset:2048 sc1 lds
    buffer_load_dwordx4 v2, s[36:39], s56 offen offset:3072 sc1 lds
    s_add_u32 s56, s56, 262144
    s_add_u32 m0, s60, 131072
    s_nop 0
    buffer_load_dwordx4 v2, s[36:39], s56 offen offset:0 sc1 lds
    buffer_load_dwordx4 v2, s[36:39], s56 offen offset:1024 sc1 lds
    buffer_load_dwordx4 v2, s[36:39], s56 offen offset:2048 sc1 lds
    buffer_load_dwordx4 v2, s[36:39], s56 offen offset:3072 sc1 lds
    s_add_u32 s56, s56, 262144
m_x3118:
    s_waitcnt vmcnt(4)
    s_barrier
    ds_read_b128 a[0:3], v6 offset:0
    ds_read_b64_tr_b16 a[16:17], v12 offset:0
    ds_read_b64_tr_b16 a[18:19], v12 offset:4096
    ds_read_b128 a[4:7], v6 offset:1024
    ds_read_b128 a[8:11], v6 offset:2048
    ds_read_b128 a[12:15], v6 offset:3072
    ds_read_b64_tr_b16 a[20:21], v13 offset:0
    ds_read_b64_tr_b16 a[22:23], v13 offset:4096
    ds_read_b64_tr_b16 a[24:25], v14 offset:0
    ds_read_b64_tr_b16 a[26:27], v14 offset:4096
    ds_read_b64_tr_b16 a[28:29], v15 offset:0
    ds_read_b64_tr_b16 a[30:31], v15 offset:4096
    s_cmp_gt_i32 s68, 5
    s_cbranch_scc0 m_lp129
m_lr130:
    s_waitcnt lgkmcnt(9)
    v_mfma_f32_16x16x32_bf16 v[64:67], a[16:19], a[0:3], v[64:67]
    s_add_u32 m0, s59, 16384
    ds_read_b128 a[32:35], v6 offset:8192
    v_mfma_f32_16x16x32_bf16 v[148:151], v[208:211], v[192:195], v[136:139]
    v_mfma_f32_16x16x32_bf16 v[152:155], v[212:215], v[192:195], v[132:135]
    s_waitcnt lgkmcnt(9)
    v_mfma_f32_16x16x32_bf16 v[72:75], a[16:19], a[4:7], v[72:75]
    ds_read_b64_tr_b16 a[48:49], v12 offset:8192
    buffer_load_dwordx4 v16, s[24:27], s57 offen offset:0 lds
    v_mfma_f32_16x16x32_bf16 v[156:159], v[212:215], v[196:199], v[128:131]
    s_waitcnt lgkmcnt(9)
    v_mfma_f32_16x16x32_bf16 v[80:83], a[16:19], a[8:11], v[80:83]
    s_add_u32 s59, s58, s60
    ds_read_b64_tr_b16 a[50:51], v12 offset:12288
    v_mfma_f32_16x16x32_bf16 v[160:163], v[216:219], v[196:199], v[132:135]
    v_mfma_f32_16x16x32_bf16 v[164:167], v[216:219], v[200:203], v[128:131]
    s_waitcnt lgkmcnt(9)
    v_mfma_f32_16x16x32_bf16 v[88:91], a[16:19], a[12:15], v[88:91]
    s_add_u32 s58, s58, 32768
    ds_read_b128 a[36:39], v6 offset:9216
    v_mfma_f32_16x16x32_bf16 v[168:171], v[220:223], v[200:203], v[132:135]
    v_mfma_f32_16x16x32_bf16 v[172:175], v[220:223], v[204:207], v[128:131]
    s_waitcnt lgkmcnt(8)
    v_mfma_f32_16x16x32_bf16 v[68:71], a[20:23], a[0:3], v[68:71]
    s_cmp_ge_u32 s58, 163840
    ds_read_b128 a[40:43], v6 offset:10240
    v_mfma_f32_16x16x32_bf16 v[176:179], v[224:227], v[204:207], v[132:135]
    s_nop 1
    v_mfma_f32_16x16x32_bf16 v[76:79], a[20:23], a[4:7], v[76:79]
    ds_read_b128 a[44:47], v6 offset:11264
    buffer_load_dwordx4 v17, s[24:27], s57 offen offset:1024 lds
    s_nop 1
    v_mfma_f32_16x16x32_bf16 v[84:87], a[20:23], a[8:11], v[84:87]
    s_cselect_b32 s66, 4294836224, s100
    ds_read_b64_tr_b16 a[52:53], v13 offset:8192
    s_nop 1
    s_nop 1
    v_mfma_f32_16x16x32_bf16 v[92:95], a[20:23], a[12:15], v[92:95]
    s_cselect_b32 s58, 0, s58
    ds_read_b64_tr_b16 a[54:55], v13 offset:12288
    v_max3_f32 v140, v148, v149, v150
    v_max3_f32 v141, v156, v157, v158
    s_waitcnt lgkmcnt(10)
    v_mfma_f32_16x16x32_bf16 v[96:99], a[24:27], a[0:3], v[96:99]
    ds_read_b64_tr_b16 a[56:57], v14 offset:8192
    v_max3_f32 v142, v164, v165, v166
    v_max3_f32 v143, v172, v173, v174
    v_mfma_f32_16x16x32_bf16 v[104:107], a[24:27], a[4:7], v[104:107]
    ds_read_b64_tr_b16 a[58:59], v14 offset:12288
    buffer_load_dwordx4 v18, s[24:27], s57 offen offset:2048 lds
    v_max3_f32 v140, v140, v151, v152
    v_mfma_f32_16x16x32_bf16 v[112:115], a[24:27], a[8:11], v[112:115]
    ds_read_b64_tr_b16 a[60:61], v15 offset:8192
    v_max3_f32 v141, v141, v159, v160
    v_max3_f32 v142, v142, v167, v168
    v_mfma_f32_16x16x32_bf16 v[120:123], a[24:27], a[12:15], v[120:123]
    ds_read_b64_tr_b16 a[62:63], v15 offset:12288
    v_max3_f32 v143, v143, v175, v176
    v_max3_f32 v140, v140, v153, v154
    s_waitcnt lgkmcnt(12)
    v_mfma_f32_16x16x32_bf16 v[100:103], a[28:31], a[0:3], v[100:103]
    v_add_u32 v6, s66, v6
    v_add_u32 v12, s66, v12
    v_max3_f32 v141, v141, v161, v162
    v_mfma_f32_16x16x32_bf16 v[108:111], a[28:31], a[4:7], v[108:111]
    buffer_load_dwordx4 v19, s[24:27], s57 offen offset:3072 lds
    v_max3_f32 v142, v142, v169, v170
    v_mfma_f32_16x16x32_bf16 v[116:119], a[28:31], a[8:11], v[116:119]
    s_add_u32 s57, s57, 131072
    v_add_u32 v13, s66, v13
    v_add_u32 v14, s66, v14
    v_max3_f32 v143, v143, v177, v178
    v_mfma_f32_16x16x32_bf16 v[124:127], a[28:31], a[12:15], v[124:127]
    s_mov_b32 m0, s59
    v_add_u32 v15, s66, v15
    v_max_f32 v140, v140, v155
    s_waitcnt vmcnt(24) lgkmcnt(0)
    v_mfma_f32_16x16x32_bf16 v[64:67], a[48:51], a[32:35], v[64:67]
    s_barrier
    v_max_f32 v141, v141, v163
    v_max_f32 v142, v142, v171
    v_mfma_f32_16x16x32_bf16 v[72:75], a[48:51], a[36:39], v[72:75]
    ds_read_b128 a[0:3], v6 offset:0
    buffer_load_dwordx4 v2, s[36:39], s56 offen offset:0 sc1 lds
    v_max_f32 v143, v143, v179
    v_mfma_f32_16x16x32_bf16 v[80:83], a[48:51], a[40:43], v[80:83]
    ds_read_b64_tr_b16 a[16:17], v12 offset:0
    v_mov_b32 v144, v140
    v_mov_b32 v145, v141
    v_mfma_f32_16x16x32_bf16 v[88:91], a[48:51], a[44:47], v[88:91]
    ds_read_b64_tr_b16 a[18:19], v12 offset:4096
    v_mov_b32 v146, v142
    v_mov_b32 v147, v143
    v_mfma_f32_16x16x32_bf16 v[68:71], a[52:55], a[32:35], v[68:71]
    ds_read_b128 a[4:7], v6 offset:1024
    s_nop 1
    v_permlane32_swap_b32 v140, v144
    v_mfma_f32_16x16x32_bf16 v[76:79], a[52:55], a[36:39], v[76:79]
    ds_read_b128 a[8:11], v6 offset:2048
    buffer_load_dwordx4 v2, s[36:39], s56 offen offset:1024 sc1 lds
    v_permlane32_swap_b32 v141, v145
    v_mfma_f32_16x16x32_bf16 v[84:87], a[52:55], a[40:43], v[84:87]
    ds_read_b128 a[12:15], v6 offset:3072
    v_permlane32_swap_b32 v142, v146
    v_permlane32_swap_b32 v143, v147
    v_mfma_f32_16x16x32_bf16 v[92:95], a[52:55], a[44:47], v[92:95]
    ds_read_b64_tr_b16 a[20:21], v13 offset:0
    s_nop 1
    v_max_f32 v140, v140, v144
    v_mfma_f32_16x16x32_bf16 v[96:99], a[56:59], a[32:35], v[96:99]
    ds_read_b64_tr_b16 a[22:23], v13 offset:4096
    v_max_f32 v141, v141, v145
    v_max_f32 v142, v142, v146
    v_mfma_f32_16x16x32_bf16 v[104:107], a[56:59], a[36:39], v[104:107]
    ds_read_b64_tr_b16 a[24:25], v14 offset:0
    buffer_load_dwordx4 v2, s[36:39], s56 offen offset:2048 sc1 lds
    v_max_f32 v143, v143, v147
    v_mfma_f32_16x16x32_bf16 v[112:115], a[56:59], a[40:43], v[112:115]
    ds_read_b64_tr_b16 a[26:27], v14 offset:4096
    v_mov_b32 v144, v140
    v_mov_b32 v145, v141
    v_mfma_f32_16x16x32_bf16 v[120:123], a[56:59], a[44:47], v[120:123]
    ds_read_b64_tr_b16 a[28:29], v15 offset:0
    v_mov_b32 v146, v142
    v_mov_b32 v147, v143
    v_mfma_f32_16x16x32_bf16 v[100:103], a[60:63], a[32:35], v[100:103]
    s_add_u32 s64, s64, 1
    ds_read_b64_tr_b16 a[30:31], v15 offset:4096
    s_nop 1
    v_permlane16_swap_b32 v140, v144
    v_mfma_f32_16x16x32_bf16 v[108:111], a[60:63], a[36:39], v[108:111]
    buffer_load_dwordx4 v2, s[36:39], s56 offen offset:3072 sc1 lds
    v_permlane16_swap_b32 v141, v145
    v_mfma_f32_16x16x32_bf16 v[116:119], a[60:63], a[40:43], v[116:119]
    s_add_u32 s56, s56, 262144
    v_permlane16_swap_b32 v142, v146
    v_permlane16_swap_b32 v143, v147
    v_mfma_f32_16x16x32_bf16 v[124:127], a[60:63], a[44:47], v[124:127]
    s_nop 1
    v_max_f32 v140, v140, v144
    s_cmp_gt_i32 s68, 6
    s_cbranch_scc0 m_lp131
m_lr132:
    s_waitcnt lgkmcnt(9)
    v_mfma_f32_16x16x32_bf16 v[64:67], a[16:19], a[0:3], v[64:67]
    s_add_u32 m0, s59, 16384
    ds_read_b128 a[32:35], v6 offset:8192
    v_max_f32 v141, v141, v145
    v_max_f32 v142, v142, v146
    s_waitcnt lgkmcnt(9)
    v_mfma_f32_16x16x32_bf16 v[72:75], a[16:19], a[4:7], v[72:75]
    ds_read_b64_tr_b16 a[48:49], v12 offset:8192
    buffer_load_dwordx4 v16, s[24:27], s57 offen offset:0 lds
    v_max_f32 v143, v143, v147
    s_waitcnt lgkmcnt(9)
    v_mfma_f32_16x16x32_bf16 v[80:83], a[16:19], a[8:11], v[80:83]
    s_add_u32 s59, s58, s60
    ds_read_b64_tr_b16 a[50:51], v12 offset:12288
    v_sub_f32 v148, v148, v140
    v_sub_f32 v149, v149, v140
    s_waitcnt lgkmcnt(9)
    v_mfma_f32_16x16x32_bf16 v[88:91], a[16:19], a[12:15], v[88:91]
    s_add_u32 s58, s58, 32768
    ds_read_b128 a[36:39], v6 offset:9216
    v_sub_f32 v150, v150, v140
    v_sub_f32 v151, v151, v140
    s_waitcnt lgkmcnt(8)
    v_mfma_f32_16x16x32_bf16 v[68:71], a[20:23], a[0:3], v[68:71]
    s_cmp_ge_u32 s58, 163840
    ds_read_b128 a[40:43], v6 offset:10240
    v_sub_f32 v152, v152, v140
    v_sub_f32 v153, v153, v140
    v_mfma_f32_16x16x32_bf16 v[76:79], a[20:23], a[4:7], v[76:79]
    ds_read_b128 a[44:47], v6 offset:11264
    buffer_load_dwordx4 v17, s[24:27], s57 offen offset:1024 lds
    v_sub_f32 v154, v154, v140
    v_mfma_f32_16x16x32_bf16 v[84:87], a[20:23], a[8:11], v[84:87]
    s_cselect_b32 s66, 4294836224, s100
    ds_read_b64_tr_b16 a[52:53], v13 offset:8192
    v_sub_f32 v155, v155, v140
    v_sub_f32 v156, v156, v141
    v_mfma_f32_16x16x32_bf16 v[92:95], a[20:23], a[12:15], v[92:95]
    s_cselect_b32 s58, 0, s58
    ds_read_b64_tr_b16 a[54:55], v13 offset:12288
    v_sub_f32 v157, v157, v141
    v_sub_f32 v158, v158, v141
    s_waitcnt lgkmcnt(10)
    v_mfma_f32_16x16x32_bf16 v[96:99], a[24:27], a[0:3], v[96:99]
    ds_read_b64_tr_b16 a[56:57], v14 offset:8192
    v_sub_f32 v159, v159, v141
    v_sub_f32 v160, v160, v141
    v_mfma_f32_16x16x32_bf16 v[104:107], a[24:27], a[4:7], v[104:107]
    ds_read_b64_tr_b16 a[58:59], v14 offset:12288
    buffer_load_dwordx4 v18, s[24:27], s57 offen offset:2048 lds
    v_sub_f32 v161, v161, v141
    v_mfma_f32_16x16x32_bf16 v[112:115], a[24:27], a[8:11], v[112:115]
    ds_read_b64_tr_b16 a[60:61], v15 offset:8192
    v_sub_f32 v162, v162, v141
    v_sub_f32 v163, v163, v141
    v_mfma_f32_16x16x32_bf16 v[120:123], a[24:27], a[12:15], v[120:123]
    ds_read_b64_tr_b16 a[62:63], v15 offset:12288
    v_sub_f32 v164, v164, v142
    v_sub_f32 v165, v165, v142
    s_waitcnt lgkmcnt(12)
    v_mfma_f32_16x16x32_bf16 v[100:103], a[28:31], a[0:3], v[100:103]
    v_add_u32 v6, s66, v6
    v_add_u32 v12, s66, v12
    v_sub_f32 v166, v166, v142
    v_mfma_f32_16x16x32_bf16 v[108:111], a[28:31], a[4:7], v[108:111]
    buffer_load_dwordx4 v19, s[24:27], s57 offen offset:3072 lds
    v_sub_f32 v167, v167, v142
    v_mfma_f32_16x16x32_bf16 v[116:119], a[28:31], a[8:11], v[116:119]
    s_add_u32 s57, s57, 131072
    v_add_u32 v13, s66, v13
    v_add_u32 v14, s66, v14
    v_sub_f32 v168, v168, v142
    v_mfma_f32_16x16x32_bf16 v[124:127], a[28:31], a[12:15], v[124:127]
    s_mov_b32 m0, s59
    v_add_u32 v15, s66, v15
    v_sub_f32 v169, v169, v142
    s_waitcnt vmcnt(24) lgkmcnt(0)
    v_mfma_f32_16x16x32_bf16 v[64:67], a[48:51], a[32:35], v[64:67]
    s_barrier
    v_sub_f32 v170, v170, v142
    v_sub_f32 v171, v171, v142
    v_mfma_f32_16x16x32_bf16 v[72:75], a[48:51], a[36:39], v[72:75]
    ds_read_b128 a[0:3], v6 offset:0
    buffer_load_dwordx4 v2, s[36:39], s56 offen offset:0 sc1 lds
    v_sub_f32 v172, v172, v143
    v_mfma_f32_16x16x32_bf16 v[80:83], a[48:51], a[40:43], v[80:83]
    ds_read_b64_tr_b16 a[16:17], v12 offset:0
    v_sub_f32 v173, v173, v143
    v_sub_f32 v174, v174, v143
    v_mfma_f32_16x16x32_bf16 v[88:91], a[48:51], a[44:47], v[88:91]
    ds_read_b64_tr_b16 a[18:19], v12 offset:4096
    v_sub_f32 v175, v175, v143
    v_sub_f32 v176, v176, v143
    v_mfma_f32_16x16x32_bf16 v[68:71], a[52:55], a[32:35], v[68:71]
    ds_read_b128 a[4:7], v6 offset:1024
    v_sub_f32 v177, v177, v143
    v_sub_f32 v178, v178, v143
    v_mfma_f32_16x16x32_bf16 v[76:79], a[52:55], a[36:39], v[76:79]
    ds_read_b128 a[8:11], v6 offset:2048
    buffer_load_dwordx4 v2, s[36:39], s56 offen offset:1024 sc1 lds
    v_sub_f32 v179, v179, v143
    v_mfma_f32_16x16x32_bf16 v[84:87], a[52:55], a[40:43], v[84:87]
    ds_read_b128 a[12:15], v6 offset:3072
    v_exp_f32 v148, v148
    v_exp_f32 v149, v149
    v_mfma_f32_16x16x32_bf16 v[92:95], a[52:55], a[44:47], v[92:95]
    ds_read_b64_tr_b16 a[20:21], v13 offset:0
    v_exp_f32 v150, v150
    v_exp_f32 v151, v151
    v_mfma_f32_16x16x32_bf16 v[96:99], a[56:59], a[32:35], v[96:99]
    ds_read_b64_tr_b16 a[22:23], v13 offset:4096
    v_exp_f32 v152, v152
    v_exp_f32 v153, v153
    v_mfma_f32_16x16x32_bf16 v[104:107], a[56:59], a[36:39], v[104:107]
    ds_read_b64_tr_b16 a[24:25], v14 offset:0
    buffer_load_dwordx4 v2, s[36:39], s56 offen offset:2048 sc1 lds
    v_exp_f32 v154, v154
    v_mfma_f32_16x16x32_bf16 v[112:115], a[56:59], a[40:43], v[112:115]
    ds_read_b64_tr_b16 a[26:27], v14 offset:4096
    v_exp_f32 v155, v155
    v_exp_f32 v156, v156
    v_mfma_f32_16x16x32_bf16 v[120:123], a[56:59], a[44:47], v[120:123]
    ds_read_b64_tr_b16 a[28:29], v15 offset:0
    v_exp_f32 v157, v157
    v_exp_f32 v158, v158
    v_mfma_f32_16x16x32_bf16 v[100:103], a[60:63], a[32:35], v[100:103]
    s_add_u32 s64, s64, 1
    ds_read_b64_tr_b16 a[30:31], v15 offset:4096
    v_exp_f32 v159, v159
    v_exp_f32 v160, v160
    v_mfma_f32_16x16x32_bf16 v[108:111], a[60:63], a[36:39], v[108:111]
    buffer_load_dwordx4 v2, s[36:39], s56 offen offset:3072 sc1 lds
    v_exp_f32 v161, v161
    v_mfma_f32_16x16x32_bf16 v[116:119], a[60:63], a[40:43], v[116:119]
    s_add_u32 s56, s56, 262144
    v_exp_f32 v162, v162
    v_exp_f32 v163, v163
    v_mfma_f32_16x16x32_bf16 v[124:127], a[60:63], a[44:47], v[124:127]
    v_exp_f32 v164, v164
    v_exp_f32 v165, v165
    s_cmp_gt_i32 s68, 7
    s_cbranch_scc0 m_lp133
m_lr134:
    s_waitcnt lgkmcnt(9)
    v_mfma_f32_16x16x32_bf16 v[64:67], a[16:19], a[0:3], v[64:67]
    s_add_u32 m0, s59, 16384
    ds_read_b128 a[32:35], v6 offset:8192
    v_exp_f32 v166, v166
    v_exp_f32 v167, v167
    s_waitcnt lgkmcnt(9)
    v_mfma_f32_16x16x32_bf16 v[72:75], a[16:19], a[4:7], v[72:75]
    ds_read_b64_tr_b16 a[48:49], v12 offset:8192
    buffer_load_dwordx4 v16, s[24:27], s57 offen offset:0 lds
    v_exp_f32 v168, v168
    s_waitcnt lgkmcnt(9)
    v_mfma_f32_16x16x32_bf16 v[80:83], a[16:19], a[8:11], v[80:83]
    s_add_u32 s59, s58, s60
    ds_read_b64_tr_b16 a[50:51], v12 offset:12288
    v_exp_f32 v169, v169
    v_exp_f32 v170, v170
    s_waitcnt lgkmcnt(9)
    v_mfma_f32_16x16x32_bf16 v[88:91], a[16:19], a[12:15], v[88:91]
    s_add_u32 s58, s58, 32768
    ds_read_b128 a[36:39], v6 offset:9216
    v_exp_f32 v171, v171
    v_exp_f32 v172, v172
    s_waitcnt lgkmcnt(8)
    v_mfma_f32_16x16x32_bf16 v[68:71], a[20:23], a[0:3], v[68:71]
    s_cmp_ge_u32 s58, 163840
    ds_read_b128 a[40:43], v6 offset:10240
    v_exp_f32 v173, v173
    v_exp_f32 v174, v174
    v_mfma_f32_16x16x32_bf16 v[76:79], a[20:23], a[4:7], v[76:79]
    ds_read_b128 a[44:47], v6 offset:11264
    buffer_load_dwordx4 v17, s[24:27], s57 offen offset:1024 lds
    v_exp_f32 v175, v175
    v_mfma_f32_16x16x32_bf16 v[84:87], a[20:23], a[8:11], v[84:87]
    s_cselect_b32 s66, 4294836224, s100
    ds_read_b64_tr_b16 a[52:53], v13 offset:8192
    v_exp_f32 v176, v176
    v_exp_f32 v177, v177
    v_mfma_f32_16x16x32_bf16 v[92:95], a[20:23], a[12:15], v[92:95]
    s_cselect_b32 s58, 0, s58
    ds_read_b64_tr_b16 a[54:55], v13 offset:12288
    v_exp_f32 v178, v178
    v_exp_f32 v179, v179
    s_waitcnt lgkmcnt(10)
    v_mfma_f32_16x16x32_bf16 v[96:99], a[24:27], a[0:3], v[96:99]
    ds_read_b64_tr_b16 a[56:57], v14 offset:8192
    v_cvt_pk_bf16_f32 v192, v148, v149
    v_cvt_pk_bf16_f32 v193, v150, v151
    v_mfma_f32_16x16x32_bf16 v[104:107], a[24:27], a[4:7], v[104:107]
    ds_read_b64_tr_b16 a[58:59], v14 offset:12288
    buffer_load_dwordx4 v18, s[24:27], s57 offen offset:2048 lds
    v_cvt_pk_bf16_f32 v194, v152, v153
    v_mfma_f32_16x16x32_bf16 v[112:115], a[24:27], a[8:11], v[112:115]
    ds_read_b64_tr_b16 a[60:61], v15 offset:8192
    v_cvt_pk_bf16_f32 v195, v154, v155
    v_cvt_pk_bf16_f32 v196, v156, v157
    v_mfma_f32_16x16x32_bf16 v[120:123], a[24:27], a[12:15], v[120:123]
    ds_read_b64_tr_b16 a[62:63], v15 offset:12288
    v_cvt_pk_bf16_f32 v197, v158, v159
    v_cvt_pk_bf16_f32 v198, v160, v161
    s_waitcnt lgkmcnt(12)
    v_mfma_f32_16x16x32_bf16 v[100:103], a[28:31], a[0:3], v[100:103]
    v_add_u32 v6, s66, v6
    v_add_u32 v12, s66, v12
    v_cvt_pk_bf16_f32 v199, v162, v163
    v_mfma_f32_16x16x32_bf16 v[108:111], a[28:31], a[4:7], v[108:111]
    buffer_load_dwordx4 v19, s[24:27], s57 offen offset:3072 lds
    v_cvt_pk_bf16_f32 v200, v164, v165
    v_mfma_f32_16x16x32_bf16 v[116:119], a[28:31], a[8:11], v[116:119]
    s_add_u32 s57, s57, 131072
    v_add_u32 v13, s66, v13
    v_add_u32 v14, s66, v14
    v_cvt_pk_bf16_f32 v201, v166, v167
    v_mfma_f32_16x16x32_bf16 v[124:127], a[28:31], a[12:15], v[124:127]
    s_mov_b32 m0, s59
    v_add_u32 v15, s66, v15
    v_cvt_pk_bf16_f32 v202, v168, v169
    s_waitcnt vmcnt(24) lgkmcnt(0)
    v_mfma_f32_16x16x32_bf16 v[64:67], a[48:51], a[32:35], v[64:67]
    s_barrier
    v_cvt_pk_bf16_f32 v203, v170, v171
    v_cvt_pk_bf16_f32 v204, v172, v173
    v_mfma_f32_16x16x32_bf16 v[72:75], a[48:51], a[36:39], v[72:75]
    ds_read_b128 a[0:3], v6 offset:0
    buffer_load_dwordx4 v2, s[36:39], s56 offen offset:0 sc1 lds
    v_cvt_pk_bf16_f32 v205, v174, v175
    v_mfma_f32_16x16x32_bf16 v[80:83], a[48:51], a[40:43], v[80:83]
    ds_read_b64_tr_b16 a[16:17], v12 offset:0
    v_cvt_pk_bf16_f32 v206, v176, v177
    v_cvt_pk_bf16_f32 v207, v178, v179
    v_mfma_f32_16x16x32_bf16 v[88:91], a[48:51], a[44:47], v[88:91]
    ds_read_b64_tr_b16 a[18:19], v12 offset:4096
    s_nop 1
    v_mfma_f32_16x16x32_bf16 v[20:23], v[44:47], v[192:195], 0
    v_mfma_f32_16x16x32_bf16 v[68:71], a[52:55], a[32:35], v[68:71]
    ds_read_b128 a[4:7], v6 offset:1024
    v_mfma_f32_16x16x32_bf16 v[24:27], v[44:47], v[196:199], 0
    v_mfma_f32_16x16x32_bf16 v[28:31], v[44:47], v[200:203], 0
    v_mfma_f32_16x16x32_bf16 v[76:79], a[52:55], a[36:39], v[76:79]
    ds_read_b128 a[8:11], v6 offset:2048
    buffer_load_dwordx4 v2, s[36:39], s56 offen offset:1024 sc1 lds
    v_mfma_f32_16x16x32_bf16 v[32:35], v[44:47], v[204:207], 0
    v_mfma_f32_16x16x32_bf16 v[84:87], a[52:55], a[40:43], v[84:87]
    ds_read_b128 a[12:15], v6 offset:3072
    v_mfma_f32_16x16x32_bf16 v[148:151], v[230:233], v[192:195], 0
    v_mfma_f32_16x16x32_bf16 v[152:155], v[242:245], v[192:195], 0
    v_mfma_f32_16x16x32_bf16 v[92:95], a[52:55], a[44:47], v[92:95]
    ds_read_b64_tr_b16 a[20:21], v13 offset:0
    v_mfma_f32_16x16x32_bf16 v[156:159], v[232:235], v[196:199], 0
    v_mfma_f32_16x16x32_bf16 v[160:163], v[244:247], v[196:199], 0
    v_mfma_f32_16x16x32_bf16 v[96:99], a[56:59], a[32:35], v[96:99]
    ds_read_b64_tr_b16 a[22:23], v13 offset:4096
    v_mfma_f32_16x16x32_bf16 v[164:167], v[234:237], v[200:203], 0
    v_mfma_f32_16x16x32_bf16 v[168:171], v[246:249], v[200:203], 0
    v_mfma_f32_16x16x32_bf16 v[104:107], a[56:59], a[36:39], v[104:107]
    ds_read_b64_tr_b16 a[24:25], v14 offset:0
    buffer_load_dwordx4 v2, s[36:39], s56 offen offset:2048 sc1 lds
    v_mfma_f32_16x16x32_bf16 v[172:175], v[236:239], v[204:207], 0
    v_mfma_f32_16x16x32_bf16 v[112:115], a[56:59], a[40:43], v[112:115]
    ds_read_b64_tr_b16 a[26:27], v14 offset:4096
    v_mfma_f32_16x16x32_bf16 v[176:179], v[248:251], v[204:207], 0
    v_rcp_f32 v140, v20
    v_mfma_f32_16x16x32_bf16 v[120:123], a[56:59], a[44:47], v[120:123]
    ds_read_b64_tr_b16 a[28:29], v15 offset:0
    v_rcp_f32 v141, v24
    v_rcp_f32 v142, v28
    v_mfma_f32_16x16x32_bf16 v[100:103], a[60:63], a[32:35], v[100:103]
    s_add_u32 s64, s64, 1
    ds_read_b64_tr_b16 a[30:31], v15 offset:4096
    v_rcp_f32 v143, v32
    s_nop 1
    v_mfma_f32_16x16x32_bf16 v[108:111], a[60:63], a[36:39], v[108:111]
    buffer_load_dwordx4 v2, s[36:39], s56 offen offset:3072 sc1 lds
    s_nop 1
    v_mfma_f32_16x16x32_bf16 v[116:119], a[60:63], a[40:43], v[116:119]
    s_add_u32 s56, s56, 262144
    v_mul_f32 v148, v148, v140
    v_mul_f32 v149, v149, v140
    v_mfma_f32_16x16x32_bf16 v[124:127], a[60:63], a[44:47], v[124:127]
    v_mul_f32 v150, v150, v140
    v_mul_f32 v151, v151, v140
    s_cmp_gt_i32 s68, 8
    s_cbranch_scc0 m_lp135
m_lr136:
    s_waitcnt lgkmcnt(9)
    v_mfma_f32_16x16x32_bf16 v[64:67], a[16:19], a[0:3], v[64:67]
    s_add_u32 m0, s59, 16384
    ds_read_b128 a[32:35], v6 offset:8192
    v_mul_f32 v152, v152, v140
    v_mul_f32 v153, v153, v140
    s_waitcnt lgkmcnt(9)
    v_mfma_f32_16x16x32_bf16 v[72:75], a[16:19], a[4:7], v[72:75]
    ds_read_b64_tr_b16 a[48:49], v12 offset:8192
    buffer_load_dwordx4 v16, s[24:27], s57 offen offset:0 lds
    v_mul_f32 v154, v154, v140
    s_waitcnt lgkmcnt(9)
    v_mfma_f32_16x16x32_bf16 v[80:83], a[16:19], a[8:11], v[80:83]
    s_add_u32 s59, s58, s60
    ds_read_b64_tr_b16 a[50:51], v12 offset:12288
    v_mul_f32 v155, v155, v140
    v_cvt_pk_bf16_f32 v148, v148, v149
    s_waitcnt lgkmcnt(9)
    v_mfma_f32_16x16x32_bf16 v[88:91], a[16:19], a[12:15], v[88:91]
    s_add_u32 s58, s58, 32768
    ds_read_b128 a[36:39], v6 offset:9216
    v_cvt_pk_bf16_f32 v149, v150, v151
    v_cvt_pk_bf16_f32 v150, v152, v153
    s_waitcnt lgkmcnt(8)
    v_mfma_f32_16x16x32_bf16 v[68:71], a[20:23], a[0:3], v[68:71]
    s_cmp_ge_u32 s58, 163840
    ds_read_b128 a[40:43], v6 offset:10240
    v_cvt_pk_bf16_f32 v151, v154, v155
    buffer_store_dwordx4 v[148:151], v2, s[8:11], s80 offen offset:0 sc1
    v_mfma_f32_16x16x32_bf16 v[76:79], a[20:23], a[4:7], v[76:79]
    ds_read_b128 a[44:47], v6 offset:11264
    buffer_load_dwordx4 v17, s[24:27], s57 offen offset:1024 lds
    v_mul_f32 v156, v156, v141
    v_mfma_f32_16x16x32_bf16 v[84:87], a[20:23], a[8:11], v[84:87]
    s_cselect_b32 s66, 4294836224, s100
    ds_read_b64_tr_b16 a[52:53], v13 offset:8192
    v_mul_f32 v157, v157, v141
    v_mul_f32 v158, v158, v141
    v_mfma_f32_16x16x32_bf16 v[92:95], a[20:23], a[12:15], v[92:95]
    s_cselect_b32 s58, 0, s58
    ds_read_b64_tr_b16 a[54:55], v13 offset:12288
    v_mul_f32 v159, v159, v141
    v_mul_f32 v160, v160, v141
    s_waitcnt lgkmcnt(10)
    v_mfma_f32_16x16x32_bf16 v[96:99], a[24:27], a[0:3], v[96:99]
    ds_read_b64_tr_b16 a[56:57], v14 offset:8192
    v_mul_f32 v161, v161, v141
    v_mul_f32 v162, v162, v141
    v_mfma_f32_16x16x32_bf16 v[104:107], a[24:27], a[4:7], v[104:107]
    ds_read_b64_tr_b16 a[58:59], v14 offset:12288
    buffer_load_dwordx4 v18, s[24:27], s57 offen offset:2048 lds
    v_mul_f32 v163, v163, v141
    v_mfma_f32_16x16x32_bf16 v[112:115], a[24:27], a[8:11], v[112:115]
    ds_read_b64_tr_b16 a[60:61], v15 offset:8192
    v_cvt_pk_bf16_f32 v156, v156, v157
    v_cvt_pk_bf16_f32 v157, v158, v159
    v_mfma_f32_16x16x32_bf16 v[120:123], a[24:27], a[12:15], v[120:123]
    ds_read_b64_tr_b16 a[62:63], v15 offset:12288
    v_cvt_pk_bf16_f32 v158, v160, v161
    v_cvt_pk_bf16_f32 v159, v162, v163
    s_waitcnt lgkmcnt(12)
    v_mfma_f32_16x16x32_bf16 v[100:103], a[28:31], a[0:3], v[100:103]
    v_add_u32 v6, s66, v6
    v_add_u32 v12, s66, v12
    buffer_store_dwordx4 v[156:159], v2, s[8:11], s80 offen offset:1024 sc1
    v_mfma_f32_16x16x32_bf16 v[108:111], a[28:31], a[4:7], v[108:111]
    buffer_load_dwordx4 v19, s[24:27], s57 offen offset:3072 lds
    v_mul_f32 v164, v164, v142
    v_mfma_f32_16x16x32_bf16 v[116:119], a[28:31], a[8:11], v[116:119]
    s_add_u32 s57, s57, 131072
    v_add_u32 v13, s66, v13
    v_add_u32 v14, s66, v14
    v_mul_f32 v165, v165, v142
    v_mfma_f32_16x16x32_bf16 v[124:127], a[28:31], a[12:15], v[124:127]
    s_mov_b32 m0, s59
    v_add_u32 v15, s66, v15
    v_mul_f32 v166, v166, v142
    s_waitcnt vmcnt(24) lgkmcnt(0)
    v_mfma_f32_16x16x32_bf16 v[64:67], a[48:51], a[32:35], v[64:67]
    s_barrier
    v_mul_f32 v167, v167, v142
    v_mul_f32 v168, v168, v142
    v_mfma_f32_16x16x32_bf16 v[72:75], a[48:51], a[36:39], v[72:75]
    ds_read_b128 a[0:3], v6 offset:0
    buffer_load_dwordx4 v2, s[36:39], s56 offen offset:0 sc1 lds
    v_mul_f32 v169, v169, v142
    v_mfma_f32_16x16x32_bf16 v[80:83], a[48:51], a[40:43], v[80:83]
    ds_read_b64_tr_b16 a[16:17], v12 offset:0
    v_mul_f32 v170, v170, v142
    v_mul_f32 v171, v171, v142
    v_mfma_f32_16x16x32_bf16 v[88:91], a[48:51], a[44:47], v[88:91]
    ds_read_b64_tr_b16 a[18:19], v12 offset:4096
    v_cvt_pk_bf16_f32 v164, v164, v165
    v_cvt_pk_bf16_f32 v165, v166, v167
    v_mfma_f32_16x16x32_bf16 v[68:71], a[52:55], a[32:35], v[68:71]
    ds_read_b128 a[4:7], v6 offset:1024
    v_cvt_pk_bf16_f32 v166, v168, v169
    v_cvt_pk_bf16_f32 v167, v170, v171
    v_mfma_f32_16x16x32_bf16 v[76:79], a[52:55], a[36:39], v[76:79]
    ds_read_b128 a[8:11], v6 offset:2048
    buffer_load_dwordx4 v2, s[36:39], s56 offen offset:1024 sc1 lds
    buffer_store_dwordx4 v[164:167], v2, s[8:11], s80 offen offset:2048 sc1
    v_mfma_f32_16x16x32_bf16 v[84:87], a[52:55], a[40:43], v[84:87]
    ds_read_b128 a[12:15], v6 offset:3072
    v_mul_f32 v172, v172, v143
    v_mul_f32 v173, v173, v143
    v_mfma_f32_16x16x32_bf16 v[92:95], a[52:55], a[44:47], v[92:95]
    ds_read_b64_tr_b16 a[20:21], v13 offset:0
    v_mul_f32 v174, v174, v143
    v_mul_f32 v175, v175, v143
    v_mfma_f32_16x16x32_bf16 v[96:99], a[56:59], a[32:35], v[96:99]
    ds_read_b64_tr_b16 a[22:23], v13 offset:4096
    v_mul_f32 v176, v176, v143
    v_mul_f32 v177, v177, v143
    v_mfma_f32_16x16x32_bf16 v[104:107], a[56:59], a[36:39], v[104:107]
    ds_read_b64_tr_b16 a[24:25], v14 offset:0
    buffer_load_dwordx4 v2, s[36:39], s56 offen offset:2048 sc1 lds
    v_mul_f32 v178, v178, v143
    v_mfma_f32_16x16x32_bf16 v[112:115], a[56:59], a[40:43], v[112:115]
    ds_read_b64_tr_b16 a[26:27], v14 offset:4096
    v_mul_f32 v179, v179, v143
    v_cvt_pk_bf16_f32 v172, v172, v173
    v_mfma_f32_16x16x32_bf16 v[120:123], a[56:59], a[44:47], v[120:123]
    ds_read_b64_tr_b16 a[28:29], v15 offset:0
    v_cvt_pk_bf16_f32 v173, v174, v175
    v_cvt_pk_bf16_f32 v174, v176, v177
    v_mfma_f32_16x16x32_bf16 v[100:103], a[60:63], a[32:35], v[100:103]
    s_add_u32 s64, s64, 1
    ds_read_b64_tr_b16 a[30:31], v15 offset:4096
    v_cvt_pk_bf16_f32 v175, v178, v179
    buffer_store_dwordx4 v[172:175], v2, s[8:11], s80 offen offset:3072 sc1
    v_mfma_f32_16x16x32_bf16 v[108:111], a[60:63], a[36:39], v[108:111]
    buffer_load_dwordx4 v2, s[36:39], s56 offen offset:3072 sc1 lds
    v_mfma_f32_16x16x32_bf16 v[116:119], a[60:63], a[40:43], v[116:119]
    s_add_u32 s56, s56, 262144
    v_mfma_f32_16x16x32_bf16 v[124:127], a[60:63], a[44:47], v[124:127]
    s_branch m_l3e125
m_lp129:
    s_mov_b32 s3, 1048576
m_spin137:
    buffer_load_dwordx2 v[4:5], v10, s[8:11], s52 offen sc1
    s_waitcnt vmcnt(0)
    v_cmp_ne_u64 s[76:77], s[4:5], v[4:5]
    s_mul_i32 s91, s95, 20
    s_nop 2
    s_lshr_b32 s90, s76, s91
    s_ff1_i32_b32 s90, s90
    s_lshl_b32 s68, s90, 1
    s_mul_i32 s91, s95, 1
    s_sub_i32 s68, s68, s91
    s_cmp_lt_i32 s90, 0
    s_cselect_b32 s68, 1000, s68
    s_cmp_gt_i32 s68, 5
    s_cbranch_scc1 m_ok138
    s_sub_u32 s3, s3, 1
    s_cbranch_scc1 m_ok138
    s_sleep 4
    s_branch m_spin137
m_ok138:
    s_branch m_lr130
m_lp131:
    s_mov_b32 s3, 1048576
m_spin139:
    buffer_load_dwordx2 v[4:5], v10, s[8:11], s52 offen sc1
    s_waitcnt vmcnt(0)
    v_cmp_ne_u64 s[76:77], s[4:5], v[4:5]
    s_mul_i32 s91, s95, 20
    s_nop 2
    s_lshr_b32 s90, s76, s91
    s_ff1_i32_b32 s90, s90
    s_lshl_b32 s68, s90, 1
    s_mul_i32 s91, s95, 1
    s_sub_i32 s68, s68, s91
    s_cmp_lt_i32 s90, 0
    s_cselect_b32 s68, 1000, s68
    s_cmp_gt_i32 s68, 6
    s_cbranch_scc1 m_ok140
    s_sub_u32 s3, s3, 1
    s_cbranch_scc1 m_ok140
    s_sleep 4
    s_branch m_spin139
m_ok140:
    s_branch m_lr132
m_lp133:
    s_mov_b32 s3, 1048576
m_spin141:
    buffer_load_dwordx2 v[4:5], v10, s[8:11], s52 offen sc1
    s_waitcnt vmcnt(0)
    v_cmp_ne_u64 s[76:77], s[4:5], v[4:5]
    s_mul_i32 s91, s95, 20
    s_nop 2
    s_lshr_b32 s90, s76, s91
    s_ff1_i32_b32 s90, s90
    s_lshl_b32 s68, s90, 1
    s_mul_i32 s91, s95, 1
    s_sub_i32 s68, s68, s91
    s_cmp_lt_i32 s90, 0
    s_cselect_b32 s68, 1000, s68
    s_cmp_gt_i32 s68, 7
    s_cbranch_scc1 m_ok142
    s_sub_u32 s3, s3, 1
    s_cbranch_scc1 m_ok142
    s_sleep 4
    s_branch m_spin141
m_ok142:
    s_branch m_lr134
m_lp135:
    s_mov_b32 s3, 1048576
m_spin143:
    buffer_load_dwordx2 v[4:5], v10, s[8:11], s52 offen sc1
    s_waitcnt vmcnt(0)
    v_cmp_ne_u64 s[76:77], s[4:5], v[4:5]
    s_mul_i32 s91, s95, 20
    s_nop 2
    s_lshr_b32 s90, s76, s91
    s_ff1_i32_b32 s90, s90
    s_lshl_b32 s68, s90, 1
    s_mul_i32 s91, s95, 1
    s_sub_i32 s68, s68, s91
    s_cmp_lt_i32 s90, 0
    s_cselect_b32 s68, 1000, s68
    s_cmp_gt_i32 s68, 8
    s_cbranch_scc1 m_ok144
    s_sub_u32 s3, s3, 1
    s_cbranch_scc1 m_ok144
    s_sleep 4
    s_branch m_spin143
m_ok144:
    s_branch m_lr136
m_l3124:
    s_waitcnt lgkmcnt(9)
    v_mfma_f32_16x16x32_bf16 v[64:67], a[16:19], a[0:3], v[64:67]
    s_add_u32 m0, s59, 16384
    ds_read_b128 a[32:35], v6 offset:8192
    s_waitcnt lgkmcnt(9)
    v_mfma_f32_16x16x32_bf16 v[72:75], a[16:19], a[4:7], v[72:75]
    ds_read_b64_tr_b16 a[48:49], v12 offset:8192
    buffer_load_dwordx4 v16, s[24:27], s57 offen offset:0 lds
    s_waitcnt lgkmcnt(9)
    v_mfma_f32_16x16x32_bf16 v[80:83], a[16:19], a[8:11], v[80:83]
    s_add_u32 s59, s58, s60
    ds_read_b64_tr_b16 a[50:51], v12 offset:12288
    s_waitcnt lgkmcnt(9)
    v_mfma_f32_16x16x32_bf16 v[88:91], a[16:19], a[12:15], v[88:91]
    s_add_u32 s58, s58, 32768
    ds_read_b128 a[36:39], v6 offset:9216
    s_waitcnt lgkmcnt(8)
    v_mfma_f32_16x16x32_bf16 v[68:71], a[20:23], a[0:3], v[68:71]
    s_cmp_ge_u32 s58, 163840
    ds_read_b128 a[40:43], v6 offset:10240
    v_mfma_f32_16x16x32_bf16 v[76:79], a[20:23], a[4:7], v[76:79]
    ds_read_b128 a[44:47], v6 offset:11264
    buffer_load_dwordx4 v17, s[24:27], s57 offen offset:1024 lds
    v_mfma_f32_16x16x32_bf16 v[84:87], a[20:23], a[8:11], v[84:87]
    s_cselect_b32 s66, 4294836224, s100
    ds_read_b64_tr_b16 a[52:53], v13 offset:8192
    v_mfma_f32_16x16x32_bf16 v[92:95], a[20:23], a[12:15], v[92:95]
    s_cselect_b32 s58, 0, s58
    ds_read_b64_tr_b16 a[54:55], v13 offset:12288
    s_waitcnt lgkmcnt(10)
    v_mfma_f32_16x16x32_bf16 v[96:99], a[24:27], a[0:3], v[96:99]
    ds_read_b64_tr_b16 a[56:57], v14 offset:8192
    v_mfma_f32_16x16x32_bf16 v[104:107], a[24:27], a[4:7], v[104:107]
    ds_read_b64_tr_b16 a[58:59], v14 offset:12288
    buffer_load_dwordx4 v18, s[24:27], s57 offen offset:2048 lds
    v_mfma_f32_16x16x32_bf16 v[112:115], a[24:27], a[8:11], v[112:115]
    ds_read_b64_tr_b16 a[60:61], v15 offset:8192
    v_mfma_f32_16x16x32_bf16 v[120:123], a[24:27], a[12:15], v[120:123]
    ds_read_b64_tr_b16 a[62:63], v15 offset:12288
    s_waitcnt lgkmcnt(12)
    v_mfma_f32_16x16x32_bf16 v[100:103], a[28:31], a[0:3], v[100:103]
    v_add_u32 v6, s66, v6
    v_add_u32 v12, s66, v12
    v_mfma_f32_16x16x32_bf16 v[108:111], a[28:31], a[4:7], v[108:111]
    buffer_load_dwordx4 v19, s[24:27], s57 offen offset:3072 lds
    v_mfma_f32_16x16x32_bf16 v[116:119], a[28:31], a[8:11], v[116:119]
    s_add_u32 s57, s57, 131072
    v_add_u32 v13, s66, v13
    v_add_u32 v14, s66, v14
    v_mfma_f32_16x16x32_bf16 v[124:127], a[28:31], a[12:15], v[124:127]
    s_mov_b32 m0, s59
    v_add_u32 v15, s66, v15
    s_waitcnt vmcnt(24) lgkmcnt(0)
    v_mfma_f32_16x16x32_bf16 v[64:67], a[48:51], a[32:35], v[64:67]
    s_barrier
    v_mfma_f32_16x16x32_bf16 v[72:75], a[48:51], a[36:39], v[72:75]
    ds_read_b128 a[0:3], v6 offset:0
    buffer_load_dwordx4 v2, s[36:39], s56 offen offset:0 sc1 lds
    v_mfma_f32_16x16x32_bf16 v[80:83], a[48:51], a[40:43], v[80:83]
    ds_read_b64_tr_b16 a[16:17], v12 offset:0
    v_mfma_f32_16x16x32_bf16 v[88:91], a[48:51], a[44:47], v[88:91]
    ds_read_b64_tr_b16 a[18:19], v12 offset:4096
    v_mfma_f32_16x16x32_bf16 v[68:71], a[52:55], a[32:35], v[68:71]
    ds_read_b128 a[4:7], v6 offset:1024
    v_mfma_f32_16x16x32_bf16 v[76:79], a[52:55], a[36:39], v[76:79]
    ds_read_b128 a[8:11], v6 offset:2048
    buffer_load_dwordx4 v2, s[36:39], s56 offen offset:1024 sc1 lds
    v_mfma_f32_16x16x32_bf16 v[84:87], a[52:55], a[40:43], v[84:87]
    ds_read_b128 a[12:15], v6 offset:3072
    v_mfma_f32_16x16x32_bf16 v[92:95], a[52:55], a[44:47], v[92:95]
    ds_read_b64_tr_b16 a[20:21], v13 offset:0
    v_mfma_f32_16x16x32_bf16 v[96:99], a[56:59], a[32:35], v[96:99]
    ds_read_b64_tr_b16 a[22:23], v13 offset:4096
    v_mfma_f32_16x16x32_bf16 v[104:107], a[56:59], a[36:39], v[104:107]
    ds_read_b64_tr_b16 a[24:25], v14 offset:0
    buffer_load_dwordx4 v2, s[36:39], s56 offen offset:2048 sc1 lds
    v_mfma_f32_16x16x32_bf16 v[112:115], a[56:59], a[40:43], v[112:115]
    ds_read_b64_tr_b16 a[26:27], v14 offset:4096
    v_mfma_f32_16x16x32_bf16 v[120:123], a[56:59], a[44:47], v[120:123]
    ds_read_b64_tr_b16 a[28:29], v15 offset:0
    v_mfma_f32_16x16x32_bf16 v[100:103], a[60:63], a[32:35], v[100:103]
    s_add_u32 s64, s64, 1
    ds_read_b64_tr_b16 a[30:31], v15 offset:4096
    v_mfma_f32_16x16x32_bf16 v[108:111], a[60:63], a[36:39], v[108:111]
    buffer_load_dwordx4 v2, s[36:39], s56 offen offset:3072 sc1 lds
    v_mfma_f32_16x16x32_bf16 v[116:119], a[60:63], a[40:43], v[116:119]
    s_add_u32 s56, s56, 262144
    s_cmp_lt_u32 s64, s67
    v_mfma_f32_16x16x32_bf16 v[124:127], a[60:63], a[44:47], v[124:127]
    s_cbranch_scc1 m_l3124
m_l3e125:
    s_add_u32 s92, s64, 5
    s_cmp_gt_i32 s68, s92
    s_cbranch_scc1 m_rdy145
    s_mov_b32 s3, 1048576
m_spin146:
    buffer_load_dwordx2 v[4:5], v10, s[8:11], s52 offen sc1
    s_waitcnt vmcnt(0)
    v_cmp_ne_u64 s[76:77], s[4:5], v[4:5]
    s_mul_i32 s91, s95, 20
    s_nop 2
    s_lshr_b32 s90, s76, s91
    s_ff1_i32_b32 s90, s90
    s_lshl_b32 s68, s90, 1
    s_mul_i32 s91, s95, 1
    s_sub_i32 s68, s68, s91
    s_cmp_lt_i32 s90, 0
    s_cselect_b32 s68, 1000, s68
    s_cmp_gt_i32 s68, s92
    s_cbranch_scc1 m_ok147
    s_sub_u32 s3, s3, 1
    s_cbranch_scc1 m_ok147
    s_sleep 4
    s_branch m_spin146
m_ok147:
m_rdy145:
    s_mov_b32 s67, 8
    s_cmp_lt_u32 s64, 8
    s_cbranch_scc1 m_l3n128
    s_cmp_eq_u32 s64, 8
    s_cbranch_scc1 m_o1148
m_o2149:
    s_cmp_eq_u32 s95, 0
    s_cbranch_scc1 m_l3c127
    s_mov_b32 s67, 17
    s_cmp_lt_u32 s64, 17
    s_cbranch_scc1 m_l3n128
    s_cmp_lg_u32 s64, 17
    s_cbranch_scc1 m_n150
    s_mov_b32 s68, 1000
    s_lshr_b32 s90, s96, 1
    s_lshl_b32 s90, s90, 8
    s_add_u32 s90, s90, 117452800
    buffer_load_dwordx2 v[4:5], v10, s[8:11], s90 offen sc1
    s_mov_b32 s67, 18
    s_branch m_l3124
m_n150:
    s_cmp_lg_u32 s64, 18
    s_cbranch_scc1 m_n151
    s_waitcnt vmcnt(8)
    s_waitcnt vmcnt(16)
    s_mov_b32 s3, 1048576
m_spin152:
    v_cmp_ne_u64 s[76:77], s[4:5], v[4:5]
    s_nop 3
    s_cmp_eq_u64 s[76:77], 0
    s_cbranch_scc1 m_ok153
    s_sub_u32 s3, s3, 1
    s_cbranch_scc1 m_ok153
    s_sleep 8
    s_lshr_b32 s90, s96, 1
    s_lshl_b32 s90, s90, 8
    s_add_u32 s90, s90, 117452800
    buffer_load_dwordx2 v[4:5], v10, s[8:11], s90 offen sc1
    s_waitcnt vmcnt(0)
    s_branch m_spin152
m_ok153:
    s_mov_b32 s56, s69
    s_mov_b32 s67, 19
    s_branch m_l3124
m_n151:
    s_cmp_lg_u32 s64, 19
    s_cbranch_scc1 m_n154
    s_mov_b32 s24, s50
    s_mov_b32 s25, s51
    s_mov_b32 s26, 2097152
    s_lshl_b32 s57, s97, 8
    s_mov_b32 s67, 23
    s_branch m_l3124
m_n154:
    s_cmp_lg_u32 s64, 23
    s_cbranch_scc1 m_n155
    s_lshl_b32 s90, s96, 3
    s_add_u32 s90, s90, s97
    s_lshl_b32 s90, s90, 15
    s_lshl_b32 s91, s16, 13
    s_add_u32 s90, s90, s91
    s_add_u32 s70, s90, 100663296
    s_nop 3
    v_cvt_pk_bf16_f32 v128, v64, v65
    v_cvt_pk_bf16_f32 v129, v66, v67
    v_cvt_pk_bf16_f32 v130, v68, v69
    v_cvt_pk_bf16_f32 v131, v70, v71
    v_cvt_pk_bf16_f32 v132, v72, v73
    v_cvt_pk_bf16_f32 v133, v74, v75
    v_cvt_pk_bf16_f32 v134, v76, v77
    v_cvt_pk_bf16_f32 v135, v78, v79
    v_cvt_pk_bf16_f32 v136, v80, v81
    v_cvt_pk_bf16_f32 v137, v82, v83
    v_cvt_pk_bf16_f32 v138, v84, v85
    v_cvt_pk_bf16_f32 v139, v86, v87
    v_cvt_pk_bf16_f32 v140, v88, v89
    v_cvt_pk_bf16_f32 v141, v90, v91
    v_cvt_pk_bf16_f32 v142, v92, v93
    v_cvt_pk_bf16_f32 v143, v94, v95
    v_cvt_pk_bf16_f32 v144, v96, v97
    v_cvt_pk_bf16_f32 v145, v98, v99
    v_cvt_pk_bf16_f32 v146, v100, v101
    v_cvt_pk_bf16_f32 v147, v102, v103
    v_cvt_pk_bf16_f32 v148, v104, v105
    v_cvt_pk_bf16_f32 v149, v106, v107
    v_cvt_pk_bf16_f32 v150, v108, v109
    v_cvt_pk_bf16_f32 v151, v110, v111
    v_cvt_pk_bf16_f32 v152, v112, v113
    v_cvt_pk_bf16_f32 v153, v114, v115
    v_cvt_pk_bf16_f32 v154, v116, v117
    v_cvt_pk_bf16_f32 v155, v118, v119
    v_cvt_pk_bf16_f32 v156, v120, v121
    v_cvt_pk_bf16_f32 v157, v122, v123
    v_cvt_pk_bf16_f32 v158, v124, v125
    v_cvt_pk_bf16_f32 v159, v126, v127
    v_mov_b64 v[64:65], 0
    v_mov_b64 v[66:67], 0
    v_mov_b64 v[68:69], 0
    v_mov_b64 v[70:71], 0
    v_mov_b64 v[72:73], 0
    v_mov_b64 v[74:75], 0
    v_mov_b64 v[76:77], 0
    v_mov_b64 v[78:79], 0
    v_mov_b64 v[80:81], 0
    v_mov_b64 v[82:83], 0
    v_mov_b64 v[84:85], 0
    v_mov_b64 v[86:87], 0
    v_mov_b64 v[88:89], 0
    v_mov_b64 v[90:91], 0
    v_mov_b64 v[92:93], 0
    v_mov_b64 v[94:95], 0
    v_mov_b64 v[96:97], 0
    v_mov_b64 v[98:99], 0
    v_mov_b64 v[100:101], 0
    v_mov_b64 v[102:103], 0
    v_mov_b64 v[104:105], 0
    v_mov_b64 v[106:107], 0
    v_mov_b64 v[108:109], 0
    v_mov_b64 v[110:111], 0
    v_mov_b64 v[112:113], 0
    v_mov_b64 v[114:115], 0
    v_mov_b64 v[116:117], 0
    v_mov_b64 v[118:119], 0
    v_mov_b64 v[120:121], 0
    v_mov_b64 v[122:123], 0
    v_mov_b64 v[124:125], 0
    v_mov_b64 v[126:127], 0
    s_nop 1
    s_waitcnt lgkmcnt(9)
    v_mfma_f32_16x16x32_bf16 v[64:67], a[16:19], a[0:3], v[64:67]
    s_add_u32 m0, s59, 16384
    ds_read_b128 a[32:35], v6 offset:8192
    s_waitcnt lgkmcnt(9)
    v_mfma_f32_16x16x32_bf16 v[72:75], a[16:19], a[4:7], v[72:75]
    ds_read_b64_tr_b16 a[48:49], v12 offset:8192
    buffer_load_dwordx4 v16, s[24:27], s57 offen offset:0 lds
    s_waitcnt lgkmcnt(9)
    v_mfma_f32_16x16x32_bf16 v[80:83], a[16:19], a[8:11], v[80:83]
    s_add_u32 s59, s58, s60
    ds_read_b64_tr_b16 a[50:51], v12 offset:12288
    s_waitcnt lgkmcnt(9)
    v_mfma_f32_16x16x32_bf16 v[88:91], a[16:19], a[12:15], v[88:91]
    s_add_u32 s58, s58, 32768
    ds_read_b128 a[36:39], v6 offset:9216
    s_waitcnt lgkmcnt(8)
    v_mfma_f32_16x16x32_bf16 v[68:71], a[20:23], a[0:3], v[68:71]
    s_cmp_ge_u32 s58, 163840
    ds_read_b128 a[40:43], v6 offset:10240
    v_mfma_f32_16x16x32_bf16 v[76:79], a[20:23], a[4:7], v[76:79]
    ds_read_b128 a[44:47], v6 offset:11264
    buffer_load_dwordx4 v17, s[24:27], s57 offen offset:1024 lds
    v_mfma_f32_16x16x32_bf16 v[84:87], a[20:23], a[8:11], v[84:87]
    s_cselect_b32 s66, 4294836224, s100
    ds_read_b64_tr_b16 a[52:53], v13 offset:8192
    v_mfma_f32_16x16x32_bf16 v[92:95], a[20:23], a[12:15], v[92:95]
    s_cselect_b32 s58, 0, s58
    ds_read_b64_tr_b16 a[54:55], v13 offset:12288
    s_waitcnt lgkmcnt(10)
    v_mfma_f32_16x16x32_bf16 v[96:99], a[24:27], a[0:3], v[96:99]
    ds_read_b64_tr_b16 a[56:57], v14 offset:8192
    v_mfma_f32_16x16x32_bf16 v[104:107], a[24:27], a[4:7], v[104:107]
    ds_read_b64_tr_b16 a[58:59], v14 offset:12288
    buffer_load_dwordx4 v18, s[24:27], s57 offen offset:2048 lds
    v_mfma_f32_16x16x32_bf16 v[112:115], a[24:27], a[8:11], v[112:115]
    ds_read_b64_tr_b16 a[60:61], v15 offset:8192
    v_mfma_f32_16x16x32_bf16 v[120:123], a[24:27], a[12:15], v[120:123]
    ds_read_b64_tr_b16 a[62:63], v15 offset:12288
    buffer_store_dwordx4 v[128:131], v2, s[8:11], s70 offen offset:0 sc1
    s_waitcnt lgkmcnt(12)
    v_mfma_f32_16x16x32_bf16 v[100:103], a[28:31], a[0:3], v[100:103]
    v_add_u32 v6, s66, v6
    v_add_u32 v12, s66, v12
    v_mfma_f32_16x16x32_bf16 v[108:111], a[28:31], a[4:7], v[108:111]
    buffer_load_dwordx4 v19, s[24:27], s57 offen offset:3072 lds
    v_mfma_f32_16x16x32_bf16 v[116:119], a[28:31], a[8:11], v[116:119]
    s_add_u32 s57, s57, 131072
    v_add_u32 v13, s66, v13
    v_add_u32 v14, s66, v14
    v_mfma_f32_16x16x32_bf16 v[124:127], a[28:31], a[12:15], v[124:127]
    s_mov_b32 m0, s59
    v_add_u32 v15, s66, v15
    s_waitcnt vmcnt(24) lgkmcnt(0)
    v_mfma_f32_16x16x32_bf16 v[64:67], a[48:51], a[32:35], v[64:67]
    s_barrier
    v_mfma_f32_16x16x32_bf16 v[72:75], a[48:51], a[36:39], v[72:75]
    ds_read_b128 a[0:3], v6 offset:0
    buffer_load_dwordx4 v2, s[36:39], s56 offen offset:0 sc1 lds
    v_mfma_f32_16x16x32_bf16 v[80:83], a[48:51], a[40:43], v[80:83]
    ds_read_b64_tr_b16 a[16:17], v12 offset:0
    v_mfma_f32_16x16x32_bf16 v[88:91], a[48:51], a[44:47], v[88:91]
    ds_read_b64_tr_b16 a[18:19], v12 offset:4096
    v_mfma_f32_16x16x32_bf16 v[68:71], a[52:55], a[32:35], v[68:71]
    ds_read_b128 a[4:7], v6 offset:1024
    v_mfma_f32_16x16x32_bf16 v[76:79], a[52:55], a[36:39], v[76:79]
    ds_read_b128 a[8:11], v6 offset:2048
    buffer_load_dwordx4 v2, s[36:39], s56 offen offset:1024 sc1 lds
    v_mfma_f32_16x16x32_bf16 v[84:87], a[52:55], a[40:43], v[84:87]
    ds_read_b128 a[12:15], v6 offset:3072
    v_mfma_f32_16x16x32_bf16 v[92:95], a[52:55], a[44:47], v[92:95]
    ds_read_b64_tr_b16 a[20:21], v13 offset:0
    v_mfma_f32_16x16x32_bf16 v[96:99], a[56:59], a[32:35], v[96:99]
    ds_read_b64_tr_b16 a[22:23], v13 offset:4096
    v_mfma_f32_16x16x32_bf16 v[104:107], a[56:59], a[36:39], v[104:107]
    ds_read_b64_tr_b16 a[24:25], v14 offset:0
    buffer_load_dwordx4 v2, s[36:39], s56 offen offset:2048 sc1 lds
    v_mfma_f32_16x16x32_bf16 v[112:115], a[56:59], a[40:43], v[112:115]
    ds_read_b64_tr_b16 a[26:27], v14 offset:4096
    v_mfma_f32_16x16x32_bf16 v[120:123], a[56:59], a[44:47], v[120:123]
    ds_read_b64_tr_b16 a[28:29], v15 offset:0
    buffer_store_dwordx4 v[132:135], v2, s[8:11], s70 offen offset:1024 sc1
    v_mfma_f32_16x16x32_bf16 v[100:103], a[60:63], a[32:35], v[100:103]
    s_add_u32 s64, s64, 1
    ds_read_b64_tr_b16 a[30:31], v15 offset:4096
    v_mfma_f32_16x16x32_bf16 v[108:111], a[60:63], a[36:39], v[108:111]
    buffer_load_dwordx4 v2, s[36:39], s56 offen offset:3072 sc1 lds
    v_mfma_f32_16x16x32_bf16 v[116:119], a[60:63], a[40:43], v[116:119]
    s_add_u32 s56, s56, 262144
    v_mfma_f32_16x16x32_bf16 v[124:127], a[60:63], a[44:47], v[124:127]
    s_waitcnt lgkmcnt(9)
    v_mfma_f32_16x16x32_bf16 v[64:67], a[16:19], a[0:3], v[64:67]
    s_add_u32 m0, s59, 16384
    ds_read_b128 a[32:35], v6 offset:8192
    s_waitcnt lgkmcnt(9)
    v_mfma_f32_16x16x32_bf16 v[72:75], a[16:19], a[4:7], v[72:75]
    ds_read_b64_tr_b16 a[48:49], v12 offset:8192
    buffer_load_dwordx4 v16, s[24:27], s57 offen offset:0 lds
    s_waitcnt lgkmcnt(9)
    v_mfma_f32_16x16x32_bf16 v[80:83], a[16:19], a[8:11], v[80:83]
    s_add_u32 s59, s58, s60
    ds_read_b64_tr_b16 a[50:51], v12 offset:12288
    s_waitcnt lgkmcnt(9)
    v_mfma_f32_16x16x32_bf16 v[88:91], a[16:19], a[12:15], v[88:91]
    s_add_u32 s58, s58, 32768
    ds_read_b128 a[36:39], v6 offset:9216
    s_waitcnt lgkmcnt(8)
    v_mfma_f32_16x16x32_bf16 v[68:71], a[20:23], a[0:3], v[68:71]
    s_cmp_ge_u32 s58, 163840
    ds_read_b128 a[40:43], v6 offset:10240
    v_mfma_f32_16x16x32_bf16 v[76:79], a[20:23], a[4:7], v[76:79]
    ds_read_b128 a[44:47], v6 offset:11264
    buffer_load_dwordx4 v17, s[24:27], s57 offen offset:1024 lds
    v_mfma_f32_16x16x32_bf16 v[84:87], a[20:23], a[8:11], v[84:87]
    s_cselect_b32 s66, 4294836224, s100
    ds_read_b64_tr_b16 a[52:53], v13 offset:8192
    v_mfma_f32_16x16x32_bf16 v[92:95], a[20:23], a[12:15], v[92:95]
    s_cselect_b32 s58, 0, s58
    ds_read_b64_tr_b16 a[54:55], v13 offset:12288
    s_waitcnt lgkmcnt(10)
    v_mfma_f32_16x16x32_bf16 v[96:99], a[24:27], a[0:3], v[96:99]
    ds_read_b64_tr_b16 a[56:57], v14 offset:8192
    v_mfma_f32_16x16x32_bf16 v[104:107], a[24:27], a[4:7], v[104:107]
    ds_read_b64_tr_b16 a[58:59], v14 offset:12288
    buffer_load_dwordx4 v18, s[24:27], s57 offen offset:2048 lds
    v_mfma_f32_16x16x32_bf16 v[112:115], a[24:27], a[8:11], v[112:115]
    ds_read_b64_tr_b16 a[60:61], v15 offset:8192
    v_mfma_f32_16x16x32_bf16 v[120:123], a[24:27], a[12:15], v[120:123]
    ds_read_b64_tr_b16 a[62:63], v15 offset:12288
    buffer_store_dwordx4 v[136:139], v2, s[8:11], s70 offen offset:2048 sc1
    s_waitcnt lgkmcnt(12)
    v_mfma_f32_16x16x32_bf16 v[100:103], a[28:31], a[0:3], v[100:103]
    v_add_u32 v6, s66, v6
    v_add_u32 v12, s66, v12
    v_mfma_f32_16x16x32_bf16 v[108:111], a[28:31], a[4:7], v[108:111]
    buffer_load_dwordx4 v19, s[24:27], s57 offen offset:3072 lds
    v_mfma_f32_16x16x32_bf16 v[116:119], a[28:31], a[8:11], v[116:119]
    s_add_u32 s57, s57, 131072
    v_add_u32 v13, s66, v13
    v_add_u32 v14, s66, v14
    v_mfma_f32_16x16x32_bf16 v[124:127], a[28:31], a[12:15], v[124:127]
    s_mov_b32 m0, s59
    v_add_u32 v15, s66, v15
    s_waitcnt vmcnt(24) lgkmcnt(0)
    v_mfma_f32_16x16x32_bf16 v[64:67], a[48:51], a[32:35], v[64:67]
    s_barrier
    v_mfma_f32_16x16x32_bf16 v[72:75], a[48:51], a[36:39], v[72:75]
    ds_read_b128 a[0:3], v6 offset:0
    buffer_load_dwordx4 v2, s[36:39], s56 offen offset:0 sc1 lds
    v_mfma_f32_16x16x32_bf16 v[80:83], a[48:51], a[40:43], v[80:83]
    ds_read_b64_tr_b16 a[16:17], v12 offset:0
    v_mfma_f32_16x16x32_bf16 v[88:91], a[48:51], a[44:47], v[88:91]
    ds_read_b64_tr_b16 a[18:19], v12 offset:4096
    v_mfma_f32_16x16x32_bf16 v[68:71], a[52:55], a[32:35], v[68:71]
    ds_read_b128 a[4:7], v6 offset:1024
    v_mfma_f32_16x16x32_bf16 v[76:79], a[52:55], a[36:39], v[76:79]
    ds_read_b128 a[8:11], v6 offset:2048
    buffer_load_dwordx4 v2, s[36:39], s56 offen offset:1024 sc1 lds
    v_mfma_f32_16x16x32_bf16 v[84:87], a[52:55], a[40:43], v[84:87]
    ds_read_b128 a[12:15], v6 offset:3072
    v_mfma_f32_16x16x32_bf16 v[92:95], a[52:55], a[44:47], v[92:95]
    ds_read_b64_tr_b16 a[20:21], v13 offset:0
    v_mfma_f32_16x16x32_bf16 v[96:99], a[56:59], a[32:35], v[96:99]
    ds_read_b64_tr_b16 a[22:23], v13 offset:4096
    v_mfma_f32_16x16x32_bf16 v[104:107], a[56:59], a[36:39], v[104:107]
    ds_read_b64_tr_b16 a[24:25], v14 offset:0
    buffer_load_dwordx4 v2, s[36:39], s56 offen offset:2048 sc1 lds
    v_mfma_f32_16x16x32_bf16 v[112:115], a[56:59], a[40:43], v[112:115]
    ds_read_b64_tr_b16 a[26:27], v14 offset:4096
    v_mfma_f32_16x16x32_bf16 v[120:123], a[56:59], a[44:47], v[120:123]
    ds_read_b64_tr_b16 a[28:29], v15 offset:0
    buffer_store_dwordx4 v[140:143], v2, s[8:11], s70 offen offset:3072 sc1
    s_add_u32 s70, s70, 4096
    v_mfma_f32_16x16x32_bf16 v[100:103], a[60:63], a[32:35], v[100:103]
    s_add_u32 s64, s64, 1
    ds_read_b64_tr_b16 a[30:31], v15 offset:4096
    v_mfma_f32_16x16x32_bf16 v[108:111], a[60:63], a[36:39], v[108:111]
    buffer_load_dwordx4 v2, s[36:39], s56 offen offset:3072 sc1 lds
    v_mfma_f32_16x16x32_bf16 v[116:119], a[60:63], a[40:43], v[116:119]
    s_add_u32 s56, s56, 262144
    v_mfma_f32_16x16x32_bf16 v[124:127], a[60:63], a[44:47], v[124:127]
    s_waitcnt lgkmcnt(9)
    v_mfma_f32_16x16x32_bf16 v[64:67], a[16:19], a[0:3], v[64:67]
    s_add_u32 m0, s59, 16384
    ds_read_b128 a[32:35], v6 offset:8192
    s_waitcnt lgkmcnt(9)
    v_mfma_f32_16x16x32_bf16 v[72:75], a[16:19], a[4:7], v[72:75]
    ds_read_b64_tr_b16 a[48:49], v12 offset:8192
    buffer_load_dwordx4 v16, s[24:27], s57 offen offset:0 lds
    s_waitcnt lgkmcnt(9)
    v_mfma_f32_16x16x32_bf16 v[80:83], a[16:19], a[8:11], v[80:83]
    s_add_u32 s59, s58, s60
    ds_read_b64_tr_b16 a[50:51], v12 offset:12288
    s_waitcnt lgkmcnt(9)
    v_mfma_f32_16x16x32_bf16 v[88:91], a[16:19], a[12:15], v[88:91]
    s_add_u32 s58, s58, 32768
    ds_read_b128 a[36:39], v6 offset:9216
    s_waitcnt lgkmcnt(8)
    v_mfma_f32_16x16x32_bf16 v[68:71], a[20:23], a[0:3], v[68:71]
    s_cmp_ge_u32 s58, 163840
    ds_read_b128 a[40:43], v6 offset:10240
    v_mfma_f32_16x16x32_bf16 v[76:79], a[20:23], a[4:7], v[76:79]
    ds_read_b128 a[44:47], v6 offset:11264
    buffer_load_dwordx4 v17, s[24:27], s57 offen offset:1024 lds
    v_mfma_f32_16x16x32_bf16 v[84:87], a[20:23], a[8:11], v[84:87]
    s_cselect_b32 s66, 4294836224, s100
    ds_read_b64_tr_b16 a[52:53], v13 offset:8192
    v_mfma_f32_16x16x32_bf16 v[92:95], a[20:23], a[12:15], v[92:95]
    s_cselect_b32 s58, 0, s58
    ds_read_b64_tr_b16 a[54:55], v13 offset:12288
    s_waitcnt lgkmcnt(10)
    v_mfma_f32_16x16x32_bf16 v[96:99], a[24:27], a[0:3], v[96:99]
    ds_read_b64_tr_b16 a[56:57], v14 offset:8192
    v_mfma_f32_16x16x32_bf16 v[104:107], a[24:27], a[4:7], v[104:107]
    ds_read_b64_tr_b16 a[58:59], v14 offset:12288
    buffer_load_dwordx4 v18, s[24:27], s57 offen offset:2048 lds
    v_mfma_f32_16x16x32_bf16 v[112:115], a[24:27], a[8:11], v[112:115]
    ds_read_b64_tr_b16 a[60:61], v15 offset:8192
    v_mfma_f32_16x16x32_bf16 v[120:123], a[24:27], a[12:15], v[120:123]
    ds_read_b64_tr_b16 a[62:63], v15 offset:12288
    buffer_store_dwordx4 v[144:147], v2, s[8:11], s70 offen offset:0 sc1
    s_waitcnt lgkmcnt(12)
    v_mfma_f32_16x16x32_bf16 v[100:103], a[28:31], a[0:3], v[100:103]
    v_add_u32 v6, s66, v6
    v_add_u32 v12, s66, v12
    v_mfma_f32_16x16x32_bf16 v[108:111], a[28:31], a[4:7], v[108:111]
    buffer_load_dwordx4 v19, s[24:27], s57 offen offset:3072 lds
    v_mfma_f32_16x16x32_bf16 v[116:119], a[28:31], a[8:11], v[116:119]
    s_add_u32 s57, s57, 131072
    v_add_u32 v13, s66, v13
    v_add_u32 v14, s66, v14
    v_mfma_f32_16x16x32_bf16 v[124:127], a[28:31], a[12:15], v[124:127]
    s_mov_b32 m0, s59
    v_add_u32 v15, s66, v15
    s_waitcnt vmcnt(24) lgkmcnt(0)
    v_mfma_f32_16x16x32_bf16 v[64:67], a[48:51], a[32:35], v[64:67]
    s_barrier
    v_mfma_f32_16x16x32_bf16 v[72:75], a[48:51], a[36:39], v[72:75]
    ds_read_b128 a[0:3], v6 offset:0
    buffer_load_dwordx4 v2, s[36:39], s56 offen offset:0 sc1 lds
    v_mfma_f32_16x16x32_bf16 v[80:83], a[48:51], a[40:43], v[80:83]
    ds_read_b64_tr_b16 a[16:17], v12 offset:0
    v_mfma_f32_16x16x32_bf16 v[88:91], a[48:51], a[44:47], v[88:91]
    ds_read_b64_tr_b16 a[18:19], v12 offset:4096
    v_mfma_f32_16x16x32_bf16 v[68:71], a[52:55], a[32:35], v[68:71]
    ds_read_b128 a[4:7], v6 offset:1024
    v_mfma_f32_16x16x32_bf16 v[76:79], a[52:55], a[36:39], v[76:79]
    ds_read_b128 a[8:11], v6 offset:2048
    buffer_load_dwordx4 v2, s[36:39], s56 offen offset:1024 sc1 lds
    v_mfma_f32_16x16x32_bf16 v[84:87], a[52:55], a[40:43], v[84:87]
    ds_read_b128 a[12:15], v6 offset:3072
    v_mfma_f32_16x16x32_bf16 v[92:95], a[52:55], a[44:47], v[92:95]
    ds_read_b64_tr_b16 a[20:21], v13 offset:0
    v_mfma_f32_16x16x32_bf16 v[96:99], a[56:59], a[32:35], v[96:99]
    ds_read_b64_tr_b16 a[22:23], v13 offset:4096
    v_mfma_f32_16x16x32_bf16 v[104:107], a[56:59], a[36:39], v[104:107]
    ds_read_b64_tr_b16 a[24:25], v14 offset:0
    buffer_load_dwordx4 v2, s[36:39], s56 offen offset:2048 sc1 lds
    v_mfma_f32_16x16x32_bf16 v[112:115], a[56:59], a[40:43], v[112:115]
    ds_read_b64_tr_b16 a[26:27], v14 offset:4096
    v_mfma_f32_16x16x32_bf16 v[120:123], a[56:59], a[44:47], v[120:123]
    ds_read_b64_tr_b16 a[28:29], v15 offset:0
    buffer_store_dwordx4 v[148:151], v2, s[8:11], s70 offen offset:1024 sc1
    v_mfma_f32_16x16x32_bf16 v[100:103], a[60:63], a[32:35], v[100:103]
    s_add_u32 s64, s64, 1
    ds_read_b64_tr_b16 a[30:31], v15 offset:4096
    v_mfma_f32_16x16x32_bf16 v[108:111], a[60:63], a[36:39], v[108:111]
    buffer_load_dwordx4 v2, s[36:39], s56 offen offset:3072 sc1 lds
    v_mfma_f32_16x16x32_bf16 v[116:119], a[60:63], a[40:43], v[116:119]
    s_add_u32 s56, s56, 262144
    v_mfma_f32_16x16x32_bf16 v[124:127], a[60:63], a[44:47], v[124:127]
    s_waitcnt lgkmcnt(9)
    v_mfma_f32_16x16x32_bf16 v[64:67], a[16:19], a[0:3], v[64:67]
    s_add_u32 m0, s59, 16384
    ds_read_b128 a[32:35], v6 offset:8192
    s_waitcnt lgkmcnt(9)
    v_mfma_f32_16x16x32_bf16 v[72:75], a[16:19], a[4:7], v[72:75]
    ds_read_b64_tr_b16 a[48:49], v12 offset:8192
    buffer_load_dwordx4 v16, s[24:27], s57 offen offset:0 lds
    s_waitcnt lgkmcnt(9)
    v_mfma_f32_16x16x32_bf16 v[80:83], a[16:19], a[8:11], v[80:83]
    s_add_u32 s59, s58, s60
    ds_read_b64_tr_b16 a[50:51], v12 offset:12288
    s_waitcnt lgkmcnt(9)
    v_mfma_f32_16x16x32_bf16 v[88:91], a[16:19], a[12:15], v[88:91]
    s_add_u32 s58, s58, 32768
    ds_read_b128 a[36:39], v6 offset:9216
    s_waitcnt lgkmcnt(8)
    v_mfma_f32_16x16x32_bf16 v[68:71], a[20:23], a[0:3], v[68:71]
    s_cmp_ge_u32 s58, 163840
    ds_read_b128 a[40:43], v6 offset:10240
    v_mfma_f32_16x16x32_bf16 v[76:79], a[20:23], a[4:7], v[76:79]
    ds_read_b128 a[44:47], v6 offset:11264
    buffer_load_dwordx4 v17, s[24:27], s57 offen offset:1024 lds
    v_mfma_f32_16x16x32_bf16 v[84:87], a[20:23], a[8:11], v[84:87]
    s_cselect_b32 s66, 4294836224, s100
    ds_read_b64_tr_b16 a[52:53], v13 offset:8192
    v_mfma_f32_16x16x32_bf16 v[92:95], a[20:23], a[12:15], v[92:95]
    s_cselect_b32 s58, 0, s58
    ds_read_b64_tr_b16 a[54:55], v13 offset:12288
    s_waitcnt lgkmcnt(10)
    v_mfma_f32_16x16x32_bf16 v[96:99], a[24:27], a[0:3], v[96:99]
    ds_read_b64_tr_b16 a[56:57], v14 offset:8192
    v_mfma_f32_16x16x32_bf16 v[104:107], a[24:27], a[4:7], v[104:107]
    ds_read_b64_tr_b16 a[58:59], v14 offset:12288
    buffer_load_dwordx4 v18, s[24:27], s57 offen offset:2048 lds
    v_mfma_f32_16x16x32_bf16 v[112:115], a[24:27], a[8:11], v[112:115]
    ds_read_b64_tr_b16 a[60:61], v15 offset:8192
    v_mfma_f32_16x16x32_bf16 v[120:123], a[24:27], a[12:15], v[120:123]
    ds_read_b64_tr_b16 a[62:63], v15 offset:12288
    buffer_store_dwordx4 v[152:155], v2, s[8:11], s70 offen offset:2048 sc1
    s_waitcnt lgkmcnt(12)
    v_mfma_f32_16x16x32_bf16 v[100:103], a[28:31], a[0:3], v[100:103]
    v_add_u32 v6, s66, v6
    v_add_u32 v12, s66, v12
    v_mfma_f32_16x16x32_bf16 v[108:111], a[28:31], a[4:7], v[108:111]
    buffer_load_dwordx4 v19, s[24:27], s57 offen offset:3072 lds
    v_mfma_f32_16x16x32_bf16 v[116:119], a[28:31], a[8:11], v[116:119]
    s_add_u32 s57, s57, 131072
    v_add_u32 v13, s66, v13
    v_add_u32 v14, s66, v14
    v_mfma_f32_16x16x32_bf16 v[124:127], a[28:31], a[12:15], v[124:127]
    s_mov_b32 m0, s59
    v_add_u32 v15, s66, v15
    s_waitcnt vmcnt(24) lgkmcnt(0)
    v_mfma_f32_16x16x32_bf16 v[64:67], a[48:51], a[32:35], v[64:67]
    s_barrier
    v_mfma_f32_16x16x32_bf16 v[72:75], a[48:51], a[36:39], v[72:75]
    ds_read_b128 a[0:3], v6 offset:0
    buffer_load_dwordx4 v2, s[36:39], s56 offen offset:0 sc1 lds
    v_mfma_f32_16x16x32_bf16 v[80:83], a[48:51], a[40:43], v[80:83]
    ds_read_b64_tr_b16 a[16:17], v12 offset:0
    v_mfma_f32_16x16x32_bf16 v[88:91], a[48:51], a[44:47], v[88:91]
    ds_read_b64_tr_b16 a[18:19], v12 offset:4096
    v_mfma_f32_16x16x32_bf16 v[68:71], a[52:55], a[32:35], v[68:71]
    ds_read_b128 a[4:7], v6 offset:1024
    v_mfma_f32_16x16x32_bf16 v[76:79], a[52:55], a[36:39], v[76:79]
    ds_read_b128 a[8:11], v6 offset:2048
    buffer_load_dwordx4 v2, s[36:39], s56 offen offset:1024 sc1 lds
    v_mfma_f32_16x16x32_bf16 v[84:87], a[52:55], a[40:43], v[84:87]
    ds_read_b128 a[12:15], v6 offset:3072
    v_mfma_f32_16x16x32_bf16 v[92:95], a[52:55], a[44:47], v[92:95]
    ds_read_b64_tr_b16 a[20:21], v13 offset:0
    v_mfma_f32_16x16x32_bf16 v[96:99], a[56:59], a[32:35], v[96:99]
    ds_read_b64_tr_b16 a[22:23], v13 offset:4096
    v_mfma_f32_16x16x32_bf16 v[104:107], a[56:59], a[36:39], v[104:107]
    ds_read_b64_tr_b16 a[24:25], v14 offset:0
    buffer_load_dwordx4 v2, s[36:39], s56 offen offset:2048 sc1 lds
    v_mfma_f32_16x16x32_bf16 v[112:115], a[56:59], a[40:43], v[112:115]
    ds_read_b64_tr_b16 a[26:27], v14 offset:4096
    v_mfma_f32_16x16x32_bf16 v[120:123], a[56:59], a[44:47], v[120:123]
    ds_read_b64_tr_b16 a[28:29], v15 offset:0
    buffer_store_dwordx4 v[156:159], v2, s[8:11], s70 offen offset:3072 sc1
    s_add_u32 s70, s70, 4096
    v_mfma_f32_16x16x32_bf16 v[100:103], a[60:63], a[32:35], v[100:103]
    s_add_u32 s64, s64, 1
    ds_read_b64_tr_b16 a[30:31], v15 offset:4096
    v_mfma_f32_16x16x32_bf16 v[108:111], a[60:63], a[36:39], v[108:111]
    buffer_load_dwordx4 v2, s[36:39], s56 offen offset:3072 sc1 lds
    v_mfma_f32_16x16x32_bf16 v[116:119], a[60:63], a[40:43], v[116:119]
    s_add_u32 s56, s56, 262144
    v_mfma_f32_16x16x32_bf16 v[124:127], a[60:63], a[44:47], v[124:127]
    s_mov_b32 s67, 31
    s_branch m_l3124
m_n155:
    s_cmp_lg_u32 s64, 31
    s_cbranch_scc1 m_n156
    s_lshl_b32 s91, s96, 3
    s_add_u32 s91, s91, s97
    s_lshl_b32 s91, s91, 7
    s_add_u32 s91, s91, 16384
    s_cmp_lg_u32 s16, 0
    s_cbranch_scc1 m_np157
    v_mov_b32 v60, s4
    v_mov_b32 v61, s5
    s_add_u32 s90, s91, 117440512
    s_mov_b64 exec, 1
    buffer_store_dwordx2 v[60:61], off, s[8:11], s90 sc1
    s_mov_b64 exec, -1
m_np157:
    s_mov_b32 s67, 34
    s_branch m_l3124
m_n156:
    s_cmp_lg_u32 s64, 34
    s_cbranch_scc1 m_n158
    s_mov_b32 s38, 0
    s_mov_b32 s67, 39
    s_branch m_l3124
m_n158:
    s_branch m_l3x126
m_l3c127:
    s_mov_b32 s67, 35
    s_cmp_lt_u32 s64, 35
    s_cbranch_scc1 m_l3n128
    s_cmp_lg_u32 s64, 35
    s_cbranch_scc1 m_n160
    s_mov_b32 s68, 1000
    s_mov_b32 s67, 36
    s_branch m_l3124
m_n160:
    s_cmp_lg_u32 s64, 36
    s_cbranch_scc1 m_n161
    s_mov_b32 s38, 0
    s_lshl_b32 s91, s96, 3
    s_add_u32 s91, s91, s97
    s_lshl_b32 s91, s91, 7
    s_add_u32 s91, s91, 16384
    s_add_u32 s52, s91, 117440512
    buffer_load_dwordx2 v[4:5], off, s[8:11], s52 sc1
    s_mov_b32 s67, 37
    s_branch m_l3124
m_n161:
    s_cmp_lg_u32 s64, 37
    s_cbranch_scc1 m_n162
    s_mov_b32 s26, 0
    s_mov_b32 s67, 38
    s_branch m_l3124
m_n162:
    s_cmp_lg_u32 s64, 38
    s_cbranch_scc1 m_n163
    s_waitcnt vmcnt(16)
    s_mov_b32 s3, 1048576
m_spin164:
    v_cmp_ne_u64 s[76:77], s[4:5], v[4:5]
    s_nop 3
    s_cmp_eq_u64 s[76:77], 0
    s_cbranch_scc1 m_ok165
    s_sub_u32 s3, s3, 1
    s_cbranch_scc1 m_ok165
    s_sleep 8
    buffer_load_dwordx2 v[4:5], off, s[8:11], s52 sc1
    s_waitcnt vmcnt(0)
    s_branch m_spin164
m_ok165:
    s_lshl_b32 s90, s96, 3
    s_add_u32 s90, s90, s97
    s_lshl_b32 s90, s90, 15
    s_lshl_b32 s91, s16, 13
    s_add_u32 s90, s90, s91
    s_add_u32 s70, s90, 100663296
    buffer_load_dwordx4 v[128:131], v2, s[8:11], s70 offen offset:0 sc1
    buffer_load_dwordx4 v[132:135], v2, s[8:11], s70 offen offset:1024 sc1
    buffer_load_dwordx4 v[136:139], v2, s[8:11], s70 offen offset:2048 sc1
    buffer_load_dwordx4 v[140:143], v2, s[8:11], s70 offen offset:3072 sc1
    s_add_u32 s70, s70, 4096
    buffer_load_dwordx4 v[144:147], v2, s[8:11], s70 offen offset:0 sc1
    buffer_load_dwordx4 v[148:151], v2, s[8:11], s70 offen offset:1024 sc1
    buffer_load_dwordx4 v[152:155], v2, s[8:11], s70 offen offset:2048 sc1
    buffer_load_dwordx4 v[156:159], v2, s[8:11], s70 offen offset:3072 sc1
    s_mov_b32 s67, 41
    s_branch m_l3124
m_n163:
    s_branch m_l3x126
m_o1148:
    s_and_b32 s91, s2, 7
    s_lshl_b32 s91, s91, 5
    s_lshr_b32 s92, s2, 3
    s_add_u32 s91, s91, s92
    s_lshl_b32 s91, s91, 3
    s_add_u32 s91, s91, 12288
    s_cmp_lg_u32 s16, 0
    s_cbranch_scc1 m_np167
    v_mov_b32 v60, s4
    v_mov_b32 v61, s5
    s_add_u32 s90, s91, 117440512
    s_mov_b64 exec, 1
    buffer_store_dwordx2 v[60:61], off, s[8:11], s90 sc1
    s_mov_b64 exec, -1
m_np167:
    s_branch m_o2149
m_l3n128:
    s_sub_u32 s90, s68, 5
    s_min_u32 s67, s67, s90
    s_branch m_l3124
m_l3x126:
    s_cmp_eq_u32 s95, 1
    s_cbranch_scc1 m_noadd168
    s_waitcnt vmcnt(0)
    v_lshlrev_b32 v160, 16, v128
    v_and_b32 v161, 0xffff0000, v128
    v_lshlrev_b32 v162, 16, v129
    v_and_b32 v163, 0xffff0000, v129
    v_lshlrev_b32 v164, 16, v130
    v_and_b32 v165, 0xffff0000, v130
    v_lshlrev_b32 v166, 16, v131
    v_and_b32 v167, 0xffff0000, v131
    v_lshlrev_b32 v168, 16, v132
    v_and_b32 v169, 0xffff0000, v132
    v_lshlrev_b32 v170, 16, v133
    v_and_b32 v171, 0xffff0000, v133
    v_lshlrev_b32 v172, 16, v134
    v_and_b32 v173, 0xffff0000, v134
    v_lshlrev_b32 v174, 16, v135
    v_and_b32 v175, 0xffff0000, v135
    v_lshlrev_b32 v176, 16, v136
    v_and_b32 v177, 0xffff0000, v136
    v_lshlrev_b32 v178, 16, v137
    v_and_b32 v179, 0xffff0000, v137
    v_lshlrev_b32 v180, 16, v138
    v_and_b32 v181, 0xffff0000, v138
    v_lshlrev_b32 v182, 16, v139
    v_and_b32 v183, 0xffff0000, v139
    v_lshlrev_b32 v184, 16, v140
    v_and_b32 v185, 0xffff0000, v140
    v_lshlrev_b32 v186, 16, v141
    v_and_b32 v187, 0xffff0000, v141
    v_lshlrev_b32 v188, 16, v142
    v_and_b32 v189, 0xffff0000, v142
    v_lshlrev_b32 v190, 16, v143
    v_and_b32 v191, 0xffff0000, v143
    v_lshlrev_b32 v192, 16, v144
    v_and_b32 v193, 0xffff0000, v144
    v_lshlrev_b32 v194, 16, v145
    v_and_b32 v195, 0xffff0000, v145
    v_lshlrev_b32 v196, 16, v146
    v_and_b32 v197, 0xffff0000, v146
    v_lshlrev_b32 v198, 16, v147
    v_and_b32 v199, 0xffff0000, v147
    v_lshlrev_b32 v200, 16, v148
    v_and_b32 v201, 0xffff0000, v148
    v_lshlrev_b32 v202, 16, v149
    v_and_b32 v203, 0xffff0000, v149
    v_lshlrev_b32 v204, 16, v150
    v_and_b32 v205, 0xffff0000, v150
    v_lshlrev_b32 v206, 16, v151
    v_and_b32 v207, 0xffff0000, v151
    v_lshlrev_b32 v208, 16, v152
    v_and_b32 v209, 0xffff0000, v152
    v_lshlrev_b32 v210, 16, v153
    v_and_b32 v211, 0xffff0000, v153
    v_lshlrev_b32 v212, 16, v154
    v_and_b32 v213, 0xffff0000, v154
    v_lshlrev_b32 v214, 16, v155
    v_and_b32 v215, 0xffff0000, v155
    v_lshlrev_b32 v216, 16, v156
    v_and_b32 v217, 0xffff0000, v156
    v_lshlrev_b32 v218, 16, v157
    v_and_b32 v219, 0xffff0000, v157
    v_lshlrev_b32 v220, 16, v158
    v_and_b32 v221, 0xffff0000, v158
    v_lshlrev_b32 v222, 16, v159
    v_and_b32 v223, 0xffff0000, v159
    v_pk_add_f32 v[64:65], v[64:65], v[160:161]
    v_pk_add_f32 v[66:67], v[66:67], v[162:163]
    v_pk_add_f32 v[68:69], v[68:69], v[164:165]
    v_pk_add_f32 v[70:71], v[70:71], v[166:167]
    v_pk_add_f32 v[72:73], v[72:73], v[168:169]
    v_pk_add_f32 v[74:75], v[74:75], v[170:171]
    v_pk_add_f32 v[76:77], v[76:77], v[172:173]
    v_pk_add_f32 v[78:79], v[78:79], v[174:175]
    v_pk_add_f32 v[80:81], v[80:81], v[176:177]
    v_pk_add_f32 v[82:83], v[82:83], v[178:179]
    v_pk_add_f32 v[84:85], v[84:85], v[180:181]
    v_pk_add_f32 v[86:87], v[86:87], v[182:183]
    v_pk_add_f32 v[88:89], v[88:89], v[184:185]
    v_pk_add_f32 v[90:91], v[90:91], v[186:187]
    v_pk_add_f32 v[92:93], v[92:93], v[188:189]
    v_pk_add_f32 v[94:95], v[94:95], v[190:191]
    v_pk_add_f32 v[96:97], v[96:97], v[192:193]
    v_pk_add_f32 v[98:99], v[98:99], v[194:195]
    v_pk_add_f32 v[100:101], v[100:101], v[196:197]
    v_pk_add_f32 v[102:103], v[102:103], v[198:199]
    v_pk_add_f32 v[104:105], v[104:105], v[200:201]
    v_pk_add_f32 v[106:107], v[106:107], v[202:203]
    v_pk_add_f32 v[108:109], v[108:109], v[204:205]
    v_pk_add_f32 v[110:111], v[110:111], v[206:207]
    v_pk_add_f32 v[112:113], v[112:113], v[208:209]
    v_pk_add_f32 v[114:115], v[114:115], v[210:211]
    v_pk_add_f32 v[116:117], v[116:117], v[212:213]
    v_pk_add_f32 v[118:119], v[118:119], v[214:215]
    v_pk_add_f32 v[120:121], v[120:121], v[216:217]
    v_pk_add_f32 v[122:123], v[122:123], v[218:219]
    v_pk_add_f32 v[124:125], v[124:125], v[220:221]
    v_pk_add_f32 v[126:127], v[126:127], v[222:223]
m_noadd168:
    v_cvt_pk_bf16_f32 v64, v64, v65
    v_cvt_pk_bf16_f32 v65, v66, v67
    v_cvt_pk_bf16_f32 v66, v68, v69
    v_cvt_pk_bf16_f32 v67, v70, v71
    v_cvt_pk_bf16_f32 v96, v96, v97
    v_cvt_pk_bf16_f32 v97, v98, v99
    v_cvt_pk_bf16_f32 v98, v100, v101
    v_cvt_pk_bf16_f32 v99, v102, v103
    s_nop 1
    v_permlane16_swap_b32 v64, v66
    v_permlane16_swap_b32 v65, v67
    v_permlane16_swap_b32 v96, v98
    v_permlane16_swap_b32 v97, v99
    buffer_store_dwordx4 v[64:67], v7, s[28:31], s71 offen offset:0 sc1
    buffer_store_dwordx4 v[96:99], v7, s[28:31], s71 offen offset:64 sc1
    s_add_u32 s71, s71, s72
    v_cvt_pk_bf16_f32 v72, v72, v73
    v_cvt_pk_bf16_f32 v73, v74, v75
    v_cvt_pk_bf16_f32 v74, v76, v77
    v_cvt_pk_bf16_f32 v75, v78, v79
    v_cvt_pk_bf16_f32 v104, v104, v105
    v_cvt_pk_bf16_f32 v105, v106, v107
    v_cvt_pk_bf16_f32 v106, v108, v109
    v_cvt_pk_bf16_f32 v107, v110, v111
    s_nop 1
    v_permlane16_swap_b32 v72, v74
    v_permlane16_swap_b32 v73, v75
    v_permlane16_swap_b32 v104, v106
    v_permlane16_swap_b32 v105, v107
    buffer_store_dwordx4 v[72:75], v7, s[28:31], s71 offen offset:0 sc1
    buffer_store_dwordx4 v[104:107], v7, s[28:31], s71 offen offset:64 sc1
    s_add_u32 s71, s71, s72
    v_cvt_pk_bf16_f32 v80, v80, v81
    v_cvt_pk_bf16_f32 v81, v82, v83
    v_cvt_pk_bf16_f32 v82, v84, v85
    v_cvt_pk_bf16_f32 v83, v86, v87
    v_cvt_pk_bf16_f32 v112, v112, v113
    v_cvt_pk_bf16_f32 v113, v114, v115
    v_cvt_pk_bf16_f32 v114, v116, v117
    v_cvt_pk_bf16_f32 v115, v118, v119
    s_nop 1
    v_permlane16_swap_b32 v80, v82
    v_permlane16_swap_b32 v81, v83
    v_permlane16_swap_b32 v112, v114
    v_permlane16_swap_b32 v113, v115
    buffer_store_dwordx4 v[80:83], v7, s[28:31], s71 offen offset:0 sc1
    buffer_store_dwordx4 v[112:115], v7, s[28:31], s71 offen offset:64 sc1
    s_add_u32 s71, s71, s72
    v_cvt_pk_bf16_f32 v88, v88, v89
    v_cvt_pk_bf16_f32 v89, v90, v91
    v_cvt_pk_bf16_f32 v90, v92, v93
    v_cvt_pk_bf16_f32 v91, v94, v95
    v_cvt_pk_bf16_f32 v120, v120, v121
    v_cvt_pk_bf16_f32 v121, v122, v123
    v_cvt_pk_bf16_f32 v122, v124, v125
    v_cvt_pk_bf16_f32 v123, v126, v127
    s_nop 1
    v_permlane16_swap_b32 v88, v90
    v_permlane16_swap_b32 v89, v91
    v_permlane16_swap_b32 v120, v122
    v_permlane16_swap_b32 v121, v123
    buffer_store_dwordx4 v[88:91], v7, s[28:31], s71 offen offset:0 sc1
    buffer_store_dwordx4 v[120:123], v7, s[28:31], s71 offen offset:64 sc1
    s_add_u32 s71, s71, s72
m_end1:
    s_endpgm
m_stub71:
    v_cmp_lt_f32 vcc, s65, v8
    s_cmp_lg_u32 s64, s67
    s_cbranch_scc1 m_e170
    v_add_f32 v176, v176, v16
    v_mov_b32 v180, v9
    v_add_f32 v188, v188, v16
    v_add_f32 v177, v177, v17
    v_mov_b32 v181, v9
    v_add_f32 v189, v189, v17
    v_add_f32 v178, v178, v18
    v_mov_b32 v182, v9
    v_add_f32 v190, v190, v18
    v_add_f32 v179, v179, v19
    v_mov_b32 v183, v9
    v_add_f32 v191, v191, v19
    s_nop 0
m_e170:
    s_cmp_lg_u32 s64, s68
    s_cbranch_scc1 m_e171
    v_mov_b32 v176, v9
    v_mov_b32 v184, v9
    v_mov_b32 v188, v9
    v_mov_b32 v177, v9
    v_mov_b32 v185, v9
    v_mov_b32 v189, v9
    v_mov_b32 v178, v9
    v_mov_b32 v186, v9
    v_mov_b32 v190, v9
    v_mov_b32 v179, v9
    v_mov_b32 v187, v9
    v_mov_b32 v191, v9
    s_nop 0
m_e171:
    s_cbranch_vccnz m_rc172
m_sp169:
    s_branch m_ret72
m_stub74:
    v_cmp_lt_f32 vcc, s65, v8
    s_cmp_lg_u32 s64, s67
    s_cbranch_scc1 m_e174
    v_add_f32 v176, v176, v16
    v_mov_b32 v180, v9
    v_add_f32 v188, v188, v16
    v_add_f32 v177, v177, v17
    v_mov_b32 v181, v9
    v_add_f32 v189, v189, v17
    v_add_f32 v178, v178, v18
    v_mov_b32 v182, v9
    v_add_f32 v190, v190, v18
    v_add_f32 v179, v179, v19
    v_mov_b32 v183, v9
    v_add_f32 v191, v191, v19
    s_nop 0
m_e174:
    s_cmp_lg_u32 s64, s68
    s_cbranch_scc1 m_e175
    v_mov_b32 v176, v9
    v_mov_b32 v184, v9
    v_mov_b32 v188, v9
    v_mov_b32 v177, v9
    v_mov_b32 v185, v9
    v_mov_b32 v189, v9
    v_mov_b32 v178, v9
    v_mov_b32 v186, v9
    v_mov_b32 v190, v9
    v_mov_b32 v179, v9
    v_mov_b32 v187, v9
    v_mov_b32 v191, v9
    s_nop 0
m_e175:
    s_cbranch_vccnz m_rc176
m_sp173:
    s_branch m_ret75
m_stub92:
    v_cmp_lt_f32 vcc, s65, v8
    s_cmp_lg_u32 s64, s70
    s_cbranch_scc1 m_e178
    v_add_f32 v160, v160, v16
    v_mov_b32 v164, v9
    v_add_f32 v172, v172, v16
    v_add_f32 v161, v161, v17
    v_mov_b32 v165, v9
    v_add_f32 v173, v173, v17
    v_add_f32 v162, v162, v18
    v_mov_b32 v166, v9
    v_add_f32 v174, v174, v18
    v_add_f32 v163, v163, v19
    v_mov_b32 v167, v9
    v_add_f32 v175, v175, v19
    s_nop 0
m_e178:
    s_cmp_lg_u32 s64, s71
    s_cbranch_scc1 m_e179
    v_mov_b32 v160, v9
    v_mov_b32 v168, v9
    v_mov_b32 v172, v9
    v_mov_b32 v161, v9
    v_mov_b32 v169, v9
    v_mov_b32 v173, v9
    v_mov_b32 v162, v9
    v_mov_b32 v170, v9
    v_mov_b32 v174, v9
    v_mov_b32 v163, v9
    v_mov_b32 v171, v9
    v_mov_b32 v175, v9
    s_nop 0
m_e179:
    s_cbranch_vccnz m_rc180
m_sp177:
    s_branch m_ret93
m_stub94:
    v_cmp_lt_f32 vcc, s65, v8
    s_cmp_lg_u32 s64, s70
    s_cbranch_scc1 m_e182
    v_add_f32 v160, v160, v16
    v_mov_b32 v164, v9
    v_add_f32 v172, v172, v16
    v_add_f32 v161, v161, v17
    v_mov_b32 v165, v9
    v_add_f32 v173, v173, v17
    v_add_f32 v162, v162, v18
    v_mov_b32 v166, v9
    v_add_f32 v174, v174, v18
    v_add_f32 v163, v163, v19
    v_mov_b32 v167, v9
    v_add_f32 v175, v175, v19
    s_nop 0
m_e182:
    s_cmp_lg_u32 s64, s71
    s_cbranch_scc1 m_e183
    v_mov_b32 v160, v9
    v_mov_b32 v168, v9
    v_mov_b32 v172, v9
    v_mov_b32 v161, v9
    v_mov_b32 v169, v9
    v_mov_b32 v173, v9
    v_mov_b32 v162, v9
    v_mov_b32 v170, v9
    v_mov_b32 v174, v9
    v_mov_b32 v163, v9
    v_mov_b32 v171, v9
    v_mov_b32 v175, v9
    s_nop 0
m_e183:
    s_cmp_lg_u32 s64, s52
    s_cbranch_scc1 m_e185
    v_lshrrev_b32 v62, 3, v1
    v_lshlrev_b32 v62, 11, v62
    v_and_b32 v61, 7, v1
    v_lshl_add_u32 v62, v61, 7, v62
    s_lshr_b32 s90, s2, 3
    s_lshl_b32 s90, s90, 2
    s_add_u32 s90, s90, s16
    s_lshl_b32 s90, s90, 14
    s_and_b32 s91, s2, 1
    s_lshl_b32 s91, s91, 10
    s_add_u32 s90, s90, s91
    s_bitcmp1_b32 s2, 2
    s_cselect_b32 s91, 0, 5373952
    s_mov_b32 s92, 8388608
    s_cselect_b32 s46, 5373952, s92
    s_cselect_b32 s93, 0, 2097152
    s_add_u32 s91, s91, s90
    s_mov_b32 s44, s48
    s_mov_b32 s45, s49
    s_add_u32 s92, s91, 0
    buffer_load_dword v255, v62, s[44:47], s92 offen
    s_add_u32 s92, s91, 2097152
    buffer_load_dword v255, v62, s[44:47], s92 offen
    s_add_u32 s92, s91, 4194304
    buffer_load_dword v255, v62, s[44:47], s92 offen
    s_mov_b32 s44, s50
    s_mov_b32 s45, s51
    s_mov_b32 s46, s93
    buffer_load_dword v255, v62, s[44:47], s90 offen
m_e185:
    s_cmp_lg_u32 s64, s53
    s_cbranch_scc1 m_e186
    s_cmp_lg_u32 s16, 0
    s_cbranch_scc1 m_np187
    v_mov_b32 v60, s4
    v_mov_b32 v61, s5
    s_add_u32 s90, s17, 117440512
    s_mov_b64 exec, 1
    buffer_store_dwordx2 v[60:61], off, s[8:11], s90 sc1
    s_mov_b64 exec, -1
m_np187:
    s_mov_b32 s17, -1
m_e186:
    s_cmp_gt_u32 s64, 26
    s_cbranch_scc1 m_e184
    s_cmp_lg_u32 s64, 6
    s_cbranch_scc1 m_e188
    s_lshr_b32 s90, s32, 1
    s_lshl_b32 s90, s90, 7
    s_add_u32 s90, s90, 117440600
    v_min_u32 v0, 1, v1
    v_lshlrev_b32 v0, 5, v0
    buffer_load_dwordx2 v[4:5], v0, s[8:11], s90 offen sc1
    s_cmp_eq_u32 s17, -1
    s_cbranch_scc1 m_e184
    s_cmp_lg_u32 s16, 0
    s_cbranch_scc1 m_np189
    v_mov_b32 v60, s4
    v_mov_b32 v61, s5
    s_add_u32 s90, s17, 117440512
    s_mov_b64 exec, 1
    buffer_store_dwordx2 v[60:61], off, s[8:11], s90 sc1
    s_mov_b64 exec, -1
m_np189:
    s_branch m_e184
m_e188:
    s_cmp_lg_u32 s64, 18
    s_cbranch_scc1 m_e190
    s_waitcnt vmcnt(18)
    s_mov_b32 s3, 1048576
m_spin191:
    v_cmp_ne_u64 s[76:77], s[4:5], v[4:5]
    s_nop 3
    s_cmp_eq_u64 s[76:77], 0
    s_cbranch_scc1 m_e184
    s_sub_u32 s3, s3, 1
    s_cbranch_scc1 m_e184
    s_sleep 32
    s_lshr_b32 s90, s32, 1
    s_lshl_b32 s90, s90, 7
    s_add_u32 s90, s90, 117440600
    v_min_u32 v0, 1, v1
    v_lshlrev_b32 v0, 5, v0
    buffer_load_dwordx2 v[4:5], v0, s[8:11], s90 offen sc1
    s_waitcnt vmcnt(0)
    s_branch m_spin191
    s_branch m_e184
m_e190:
    s_cmp_lg_u32 s64, 22
    s_cbranch_scc1 m_e192
    buffer_load_dwordx2 v[4:5], v10, s[8:11], 0 offen sc1
    s_mov_b32 s44, s48
    s_mov_b32 s45, s49
    s_mov_b32 s46, 8388608
    s_lshl_b32 s90, s2, 2
    s_add_u32 s90, s90, s16
    s_lshl_b32 s90, s90, 13
    v_lshlrev_b32 v62, 7, v1
    buffer_load_dword v255, v62, s[44:47], s90 offen
    s_branch m_e184
m_e192:
    s_cmp_lg_u32 s64, 26
    s_cbranch_scc1 m_e193
    s_mov_b32 s44, s50
    s_mov_b32 s45, s51
    s_mov_b32 s46, 2097152
    s_lshl_b32 s90, s2, 2
    s_add_u32 s90, s90, s16
    s_lshl_b32 s90, s90, 13
    v_lshlrev_b32 v62, 7, v1
    buffer_load_dword v255, v62, s[44:47], s90 offen
    s_waitcnt vmcnt(18)
    s_mov_b32 s3, 1048576
m_spin194:
    v_cmp_ne_u64 s[76:77], s[4:5], v[4:5]
    s_nop 3
    s_cmp_eq_u64 s[76:77], 0
    s_cbranch_scc1 m_e184
    s_sub_u32 s3, s3, 1
    s_cbranch_scc1 m_e184
    s_sleep 32
    buffer_load_dwordx2 v[4:5], v10, s[8:11], 0 offen sc1
    s_waitcnt vmcnt(0)
    s_branch m_spin194
    s_branch m_e184
m_e193:
m_e184:
    s_cbranch_vccnz m_rc195
m_sp181:
    s_branch m_ret95
m_stub97:
    v_cmp_lt_f32 vcc, s65, v8
    s_cmp_lg_u32 s64, s70
    s_cbranch_scc1 m_e197
    v_add_f32 v160, v160, v16
    v_mov_b32 v164, v9
    v_add_f32 v172, v172, v16
    v_add_f32 v161, v161, v17
    v_mov_b32 v165, v9
    v_add_f32 v173, v173, v17
    v_add_f32 v162, v162, v18
    v_mov_b32 v166, v9
    v_add_f32 v174, v174, v18
    v_add_f32 v163, v163, v19
    v_mov_b32 v167, v9
    v_add_f32 v175, v175, v19
    s_nop 0
m_e197:
    s_cmp_lg_u32 s64, s71
    s_cbranch_scc1 m_e198
    v_mov_b32 v160, v9
    v_mov_b32 v168, v9
    v_mov_b32 v172, v9
    v_mov_b32 v161, v9
    v_mov_b32 v169, v9
    v_mov_b32 v173, v9
    v_mov_b32 v162, v9
    v_mov_b32 v170, v9
    v_mov_b32 v174, v9
    v_mov_b32 v163, v9
    v_mov_b32 v171, v9
    v_mov_b32 v175, v9
    s_nop 0
m_e198:
    s_cbranch_vccnz m_rc199
m_sp196:
    s_branch m_ret98
m_stub114:
    v_cmp_lt_f32 vcc, s65, v8
    s_cbranch_vccnz m_rc201
m_sp200:
    s_branch m_ret115
m_rc91:
    s_call_b64 s[74:75], m_rs0465
    s_branch m_sp76
m_rc113:
    s_call_b64 s[74:75], m_rs0264
    s_branch m_sp99
m_rc172:
    s_call_b64 s[74:75], m_rs0465
    s_branch m_sp169
m_rc176:
    s_call_b64 s[74:75], m_rs1467
    s_branch m_sp173
m_rc180:
    s_call_b64 s[74:75], m_rs1467
    s_branch m_sp177
m_rc195:
    s_call_b64 s[74:75], m_rs0264
    s_branch m_sp181
m_rc199:
    s_call_b64 s[74:75], m_rs1266
    s_branch m_sp196
m_rc201:
    s_call_b64 s[74:75], m_rs1266
    s_branch m_sp200
m_rs0264:
    s_nop 15
    v_max3_f32 v48, v64, v65, v66
    v_max3_f32 v48, v48, v67, v68
    v_max3_f32 v48, v48, v69, v70
    v_max3_f32 v48, v48, v71, 0
    v_mov_b32 v49, v48
    s_nop 1
    v_permlane32_swap_b32 v48, v49
    s_nop 1
    v_max_f32 v48, v48, v49
    v_mov_b32 v49, v48
    s_nop 1
    v_permlane16_swap_b32 v48, v49
    s_nop 1
    v_max_f32 v48, v48, v49
    v_exp_f32 v49, -v48
    v_sub_f32 v64, v64, v48
    v_sub_f32 v65, v65, v48
    v_sub_f32 v66, v66, v48
    v_sub_f32 v67, v67, v48
    v_sub_f32 v68, v68, v48
    v_sub_f32 v69, v69, v48
    v_sub_f32 v70, v70, v48
    v_sub_f32 v71, v71, v48
    v_sub_f32 v96, v96, v48
    v_sub_f32 v97, v97, v48
    v_sub_f32 v98, v98, v48
    v_sub_f32 v99, v99, v48
    v_sub_f32 v100, v100, v48
    v_sub_f32 v101, v101, v48
    v_sub_f32 v102, v102, v48
    v_sub_f32 v103, v103, v48
    v_sub_f32 v160, v160, v48
    v_sub_f32 v161, v161, v48
    v_sub_f32 v162, v162, v48
    v_sub_f32 v163, v163, v48
    v_sub_f32 v164, v164, v48
    v_sub_f32 v165, v165, v48
    v_sub_f32 v166, v166, v48
    v_sub_f32 v167, v167, v48
    v_mul_f32 v12, v12, v49
    v_accvgpr_read_b32 v52, a0
    v_accvgpr_read_b32 v53, a1
    v_accvgpr_read_b32 v54, a2
    v_accvgpr_read_b32 v55, a3
    v_accvgpr_read_b32 v56, a4
    v_accvgpr_read_b32 v57, a5
    v_accvgpr_read_b32 v58, a6
    v_accvgpr_read_b32 v59, a7
    v_mul_f32 v52, v52, v49
    v_mul_f32 v53, v53, v49
    v_mul_f32 v54, v54, v49
    v_mul_f32 v55, v55, v49
    v_mul_f32 v56, v56, v49
    v_mul_f32 v57, v57, v49
    v_mul_f32 v58, v58, v49
    v_mul_f32 v59, v59, v49
    v_accvgpr_write_b32 a0, v52
    v_accvgpr_write_b32 a1, v53
    v_accvgpr_write_b32 a2, v54
    v_accvgpr_write_b32 a3, v55
    v_accvgpr_write_b32 a4, v56
    v_accvgpr_write_b32 a5, v57
    v_accvgpr_write_b32 a6, v58
    v_accvgpr_write_b32 a7, v59
    v_accvgpr_read_b32 v52, a8
    v_accvgpr_read_b32 v53, a9
    v_accvgpr_read_b32 v54, a10
    v_accvgpr_read_b32 v55, a11
    v_accvgpr_read_b32 v56, a12
    v_accvgpr_read_b32 v57, a13
    v_accvgpr_read_b32 v58, a14
    v_accvgpr_read_b32 v59, a15
    v_mul_f32 v52, v52, v49
    v_mul_f32 v53, v53, v49
    v_mul_f32 v54, v54, v49
    v_mul_f32 v55, v55, v49
    v_mul_f32 v56, v56, v49
    v_mul_f32 v57, v57, v49
    v_mul_f32 v58, v58, v49
    v_mul_f32 v59, v59, v49
    v_accvgpr_write_b32 a8, v52
    v_accvgpr_write_b32 a9, v53
    v_accvgpr_write_b32 a10, v54
    v_accvgpr_write_b32 a11, v55
    v_accvgpr_write_b32 a12, v56
    v_accvgpr_write_b32 a13, v57
    v_accvgpr_write_b32 a14, v58
    v_accvgpr_write_b32 a15, v59
    v_accvgpr_read_b32 v52, a16
    v_accvgpr_read_b32 v53, a17
    v_accvgpr_read_b32 v54, a18
    v_accvgpr_read_b32 v55, a19
    v_accvgpr_read_b32 v56, a20
    v_accvgpr_read_b32 v57, a21
    v_accvgpr_read_b32 v58, a22
    v_accvgpr_read_b32 v59, a23
    v_mul_f32 v52, v52, v49
    v_mul_f32 v53, v53, v49
    v_mul_f32 v54, v54, v49
    v_mul_f32 v55, v55, v49
    v_mul_f32 v56, v56, v49
    v_mul_f32 v57, v57, v49
    v_mul_f32 v58, v58, v49
    v_mul_f32 v59, v59, v49
    v_accvgpr_write_b32 a16, v52
    v_accvgpr_write_b32 a17, v53
    v_accvgpr_write_b32 a18, v54
    v_accvgpr_write_b32 a19, v55
    v_accvgpr_write_b32 a20, v56
    v_accvgpr_write_b32 a21, v57
    v_accvgpr_write_b32 a22, v58
    v_accvgpr_write_b32 a23, v59
    v_accvgpr_read_b32 v52, a24
    v_accvgpr_read_b32 v53, a25
    v_accvgpr_read_b32 v54, a26
    v_accvgpr_read_b32 v55, a27
    v_accvgpr_read_b32 v56, a28
    v_accvgpr_read_b32 v57, a29
    v_accvgpr_read_b32 v58, a30
    v_accvgpr_read_b32 v59, a31
    v_mul_f32 v52, v52, v49
    v_mul_f32 v53, v53, v49
    v_mul_f32 v54, v54, v49
    v_mul_f32 v55, v55, v49
    v_mul_f32 v56, v56, v49
    v_mul_f32 v57, v57, v49
    v_mul_f32 v58, v58, v49
    v_mul_f32 v59, v59, v49
    v_accvgpr_write_b32 a24, v52
    v_accvgpr_write_b32 a25, v53
    v_accvgpr_write_b32 a26, v54
    v_accvgpr_write_b32 a27, v55
    v_accvgpr_write_b32 a28, v56
    v_accvgpr_write_b32 a29, v57
    v_accvgpr_write_b32 a30, v58
    v_accvgpr_write_b32 a31, v59
    v_exp_f32 v52, v64
    v_exp_f32 v53, v65
    v_exp_f32 v54, v66
    v_exp_f32 v55, v67
    v_exp_f32 v56, v68
    v_exp_f32 v57, v69
    v_exp_f32 v58, v70
    v_exp_f32 v59, v71
    s_nop 0
    v_cvt_pk_bf16_f32 v128, v52, v53
    v_cvt_pk_bf16_f32 v129, v54, v55
    v_cvt_pk_bf16_f32 v130, v56, v57
    v_cvt_pk_bf16_f32 v131, v58, v59
    s_nop 1
    v_mfma_f32_16x16x32_bf16 v[28:31], v[44:47], v[128:131], 0
    v_max3_f32 v48, v72, v73, v74
    v_max3_f32 v48, v48, v75, v76
    v_max3_f32 v48, v48, v77, v78
    v_max3_f32 v48, v48, v79, 0
    v_mov_b32 v49, v48
    s_nop 1
    v_permlane32_swap_b32 v48, v49
    s_nop 1
    v_max_f32 v48, v48, v49
    v_mov_b32 v49, v48
    s_nop 1
    v_permlane16_swap_b32 v48, v49
    s_nop 1
    v_max_f32 v48, v48, v49
    v_exp_f32 v49, -v48
    v_sub_f32 v72, v72, v48
    v_sub_f32 v73, v73, v48
    v_sub_f32 v74, v74, v48
    v_sub_f32 v75, v75, v48
    v_sub_f32 v76, v76, v48
    v_sub_f32 v77, v77, v48
    v_sub_f32 v78, v78, v48
    v_sub_f32 v79, v79, v48
    v_sub_f32 v104, v104, v48
    v_sub_f32 v105, v105, v48
    v_sub_f32 v106, v106, v48
    v_sub_f32 v107, v107, v48
    v_sub_f32 v108, v108, v48
    v_sub_f32 v109, v109, v48
    v_sub_f32 v110, v110, v48
    v_sub_f32 v111, v111, v48
    v_sub_f32 v168, v168, v48
    v_sub_f32 v169, v169, v48
    v_sub_f32 v170, v170, v48
    v_sub_f32 v171, v171, v48
    v_sub_f32 v172, v172, v48
    v_sub_f32 v173, v173, v48
    v_sub_f32 v174, v174, v48
    v_sub_f32 v175, v175, v48
    v_mul_f32 v13, v13, v49
    v_accvgpr_read_b32 v52, a32
    v_accvgpr_read_b32 v53, a33
    v_accvgpr_read_b32 v54, a34
    v_accvgpr_read_b32 v55, a35
    v_accvgpr_read_b32 v56, a36
    v_accvgpr_read_b32 v57, a37
    v_accvgpr_read_b32 v58, a38
    v_accvgpr_read_b32 v59, a39
    v_mul_f32 v52, v52, v49
    v_mul_f32 v53, v53, v49
    v_mul_f32 v54, v54, v49
    v_mul_f32 v55, v55, v49
    v_mul_f32 v56, v56, v49
    v_mul_f32 v57, v57, v49
    v_mul_f32 v58, v58, v49
    v_mul_f32 v59, v59, v49
    v_accvgpr_write_b32 a32, v52
    v_accvgpr_write_b32 a33, v53
    v_accvgpr_write_b32 a34, v54
    v_accvgpr_write_b32 a35, v55
    v_accvgpr_write_b32 a36, v56
    v_accvgpr_write_b32 a37, v57
    v_accvgpr_write_b32 a38, v58
    v_accvgpr_write_b32 a39, v59
    v_accvgpr_read_b32 v52, a40
    v_accvgpr_read_b32 v53, a41
    v_accvgpr_read_b32 v54, a42
    v_accvgpr_read_b32 v55, a43
    v_accvgpr_read_b32 v56, a44
    v_accvgpr_read_b32 v57, a45
    v_accvgpr_read_b32 v58, a46
    v_accvgpr_read_b32 v59, a47
    v_mul_f32 v52, v52, v49
    v_mul_f32 v53, v53, v49
    v_mul_f32 v54, v54, v49
    v_mul_f32 v55, v55, v49
    v_mul_f32 v56, v56, v49
    v_mul_f32 v57, v57, v49
    v_mul_f32 v58, v58, v49
    v_mul_f32 v59, v59, v49
    v_accvgpr_write_b32 a40, v52
    v_accvgpr_write_b32 a41, v53
    v_accvgpr_write_b32 a42, v54
    v_accvgpr_write_b32 a43, v55
    v_accvgpr_write_b32 a44, v56
    v_accvgpr_write_b32 a45, v57
    v_accvgpr_write_b32 a46, v58
    v_accvgpr_write_b32 a47, v59
    v_accvgpr_read_b32 v52, a48
    v_accvgpr_read_b32 v53, a49
    v_accvgpr_read_b32 v54, a50
    v_accvgpr_read_b32 v55, a51
    v_accvgpr_read_b32 v56, a52
    v_accvgpr_read_b32 v57, a53
    v_accvgpr_read_b32 v58, a54
    v_accvgpr_read_b32 v59, a55
    v_mul_f32 v52, v52, v49
    v_mul_f32 v53, v53, v49
    v_mul_f32 v54, v54, v49
    v_mul_f32 v55, v55, v49
    v_mul_f32 v56, v56, v49
    v_mul_f32 v57, v57, v49
    v_mul_f32 v58, v58, v49
    v_mul_f32 v59, v59, v49
    v_accvgpr_write_b32 a48, v52
    v_accvgpr_write_b32 a49, v53
    v_accvgpr_write_b32 a50, v54
    v_accvgpr_write_b32 a51, v55
    v_accvgpr_write_b32 a52, v56
    v_accvgpr_write_b32 a53, v57
    v_accvgpr_write_b32 a54, v58
    v_accvgpr_write_b32 a55, v59
    v_accvgpr_read_b32 v52, a56
    v_accvgpr_read_b32 v53, a57
    v_accvgpr_read_b32 v54, a58
    v_accvgpr_read_b32 v55, a59
    v_accvgpr_read_b32 v56, a60
    v_accvgpr_read_b32 v57, a61
    v_accvgpr_read_b32 v58, a62
    v_accvgpr_read_b32 v59, a63
    v_mul_f32 v52, v52, v49
    v_mul_f32 v53, v53, v49
    v_mul_f32 v54, v54, v49
    v_mul_f32 v55, v55, v49
    v_mul_f32 v56, v56, v49
    v_mul_f32 v57, v57, v49
    v_mul_f32 v58, v58, v49
    v_mul_f32 v59, v59, v49
    v_accvgpr_write_b32 a56, v52
    v_accvgpr_write_b32 a57, v53
    v_accvgpr_write_b32 a58, v54
    v_accvgpr_write_b32 a59, v55
    v_accvgpr_write_b32 a60, v56
    v_accvgpr_write_b32 a61, v57
    v_accvgpr_write_b32 a62, v58
    v_accvgpr_write_b32 a63, v59
    v_exp_f32 v52, v72
    v_exp_f32 v53, v73
    v_exp_f32 v54, v74
    v_exp_f32 v55, v75
    v_exp_f32 v56, v76
    v_exp_f32 v57, v77
    v_exp_f32 v58, v78
    v_exp_f32 v59, v79
    s_nop 0
    v_cvt_pk_bf16_f32 v132, v52, v53
    v_cvt_pk_bf16_f32 v133, v54, v55
    v_cvt_pk_bf16_f32 v134, v56, v57
    v_cvt_pk_bf16_f32 v135, v58, v59
    s_nop 1
    v_mfma_f32_16x16x32_bf16 v[32:35], v[44:47], v[132:135], 0
    s_nop 7
    s_setpc_b64 s[74:75]
m_rs0465:
    s_nop 15
    v_max3_f32 v48, v64, v65, v66
    v_max3_f32 v48, v48, v67, v68
    v_max3_f32 v48, v48, v69, v70
    v_max3_f32 v48, v48, v71, 0
    v_mov_b32 v49, v48
    s_nop 1
    v_permlane32_swap_b32 v48, v49
    s_nop 1
    v_max_f32 v48, v48, v49
    v_mov_b32 v49, v48
    s_nop 1
    v_permlane16_swap_b32 v48, v49
    s_nop 1
    v_max_f32 v48, v48, v49
    v_exp_f32 v49, -v48
    v_sub_f32 v64, v64, v48
    v_sub_f32 v65, v65, v48
    v_sub_f32 v66, v66, v48
    v_sub_f32 v67, v67, v48
    v_sub_f32 v68, v68, v48
    v_sub_f32 v69, v69, v48
    v_sub_f32 v70, v70, v48
    v_sub_f32 v71, v71, v48
    v_sub_f32 v96, v96, v48
    v_sub_f32 v97, v97, v48
    v_sub_f32 v98, v98, v48
    v_sub_f32 v99, v99, v48
    v_sub_f32 v100, v100, v48
    v_sub_f32 v101, v101, v48
    v_sub_f32 v102, v102, v48
    v_sub_f32 v103, v103, v48
    v_sub_f32 v160, v160, v48
    v_sub_f32 v161, v161, v48
    v_sub_f32 v162, v162, v48
    v_sub_f32 v163, v163, v48
    v_sub_f32 v164, v164, v48
    v_sub_f32 v165, v165, v48
    v_sub_f32 v166, v166, v48
    v_sub_f32 v167, v167, v48
    v_mul_f32 v12, v12, v49
    v_accvgpr_read_b32 v52, a0
    v_accvgpr_read_b32 v53, a1
    v_accvgpr_read_b32 v54, a2
    v_accvgpr_read_b32 v55, a3
    v_accvgpr_read_b32 v56, a4
    v_accvgpr_read_b32 v57, a5
    v_accvgpr_read_b32 v58, a6
    v_accvgpr_read_b32 v59, a7
    v_mul_f32 v52, v52, v49
    v_mul_f32 v53, v53, v49
    v_mul_f32 v54, v54, v49
    v_mul_f32 v55, v55, v49
    v_mul_f32 v56, v56, v49
    v_mul_f32 v57, v57, v49
    v_mul_f32 v58, v58, v49
    v_mul_f32 v59, v59, v49
    v_accvgpr_write_b32 a0, v52
    v_accvgpr_write_b32 a1, v53
    v_accvgpr_write_b32 a2, v54
    v_accvgpr_write_b32 a3, v55
    v_accvgpr_write_b32 a4, v56
    v_accvgpr_write_b32 a5, v57
    v_accvgpr_write_b32 a6, v58
    v_accvgpr_write_b32 a7, v59
    v_accvgpr_read_b32 v52, a8
    v_accvgpr_read_b32 v53, a9
    v_accvgpr_read_b32 v54, a10
    v_accvgpr_read_b32 v55, a11
    v_accvgpr_read_b32 v56, a12
    v_accvgpr_read_b32 v57, a13
    v_accvgpr_read_b32 v58, a14
    v_accvgpr_read_b32 v59, a15
    v_mul_f32 v52, v52, v49
    v_mul_f32 v53, v53, v49
    v_mul_f32 v54, v54, v49
    v_mul_f32 v55, v55, v49
    v_mul_f32 v56, v56, v49
    v_mul_f32 v57, v57, v49
    v_mul_f32 v58, v58, v49
    v_mul_f32 v59, v59, v49
    v_accvgpr_write_b32 a8, v52
    v_accvgpr_write_b32 a9, v53
    v_accvgpr_write_b32 a10, v54
    v_accvgpr_write_b32 a11, v55
    v_accvgpr_write_b32 a12, v56
    v_accvgpr_write_b32 a13, v57
    v_accvgpr_write_b32 a14, v58
    v_accvgpr_write_b32 a15, v59
    v_accvgpr_read_b32 v52, a16
    v_accvgpr_read_b32 v53, a17
    v_accvgpr_read_b32 v54, a18
    v_accvgpr_read_b32 v55, a19
    v_accvgpr_read_b32 v56, a20
    v_accvgpr_read_b32 v57, a21
    v_accvgpr_read_b32 v58, a22
    v_accvgpr_read_b32 v59, a23
    v_mul_f32 v52, v52, v49
    v_mul_f32 v53, v53, v49
    v_mul_f32 v54, v54, v49
    v_mul_f32 v55, v55, v49
    v_mul_f32 v56, v56, v49
    v_mul_f32 v57, v57, v49
    v_mul_f32 v58, v58, v49
    v_mul_f32 v59, v59, v49
    v_accvgpr_write_b32 a16, v52
    v_accvgpr_write_b32 a17, v53
    v_accvgpr_write_b32 a18, v54
    v_accvgpr_write_b32 a19, v55
    v_accvgpr_write_b32 a20, v56
    v_accvgpr_write_b32 a21, v57
    v_accvgpr_write_b32 a22, v58
    v_accvgpr_write_b32 a23, v59
    v_accvgpr_read_b32 v52, a24
    v_accvgpr_read_b32 v53, a25
    v_accvgpr_read_b32 v54, a26
    v_accvgpr_read_b32 v55, a27
    v_accvgpr_read_b32 v56, a28
    v_accvgpr_read_b32 v57, a29
    v_accvgpr_read_b32 v58, a30
    v_accvgpr_read_b32 v59, a31
    v_mul_f32 v52, v52, v49
    v_mul_f32 v53, v53, v49
    v_mul_f32 v54, v54, v49
    v_mul_f32 v55, v55, v49
    v_mul_f32 v56, v56, v49
    v_mul_f32 v57, v57, v49
    v_mul_f32 v58, v58, v49
    v_mul_f32 v59, v59, v49
    v_accvgpr_write_b32 a24, v52
    v_accvgpr_write_b32 a25, v53
    v_accvgpr_write_b32 a26, v54
    v_accvgpr_write_b32 a27, v55
    v_accvgpr_write_b32 a28, v56
    v_accvgpr_write_b32 a29, v57
    v_accvgpr_write_b32 a30, v58
    v_accvgpr_write_b32 a31, v59
    v_exp_f32 v52, v64
    v_exp_f32 v53, v65
    v_exp_f32 v54, v66
    v_exp_f32 v55, v67
    v_exp_f32 v56, v68
    v_exp_f32 v57, v69
    v_exp_f32 v58, v70
    v_exp_f32 v59, v71
    s_nop 0
    v_cvt_pk_bf16_f32 v128, v52, v53
    v_cvt_pk_bf16_f32 v129, v54, v55
    v_cvt_pk_bf16_f32 v130, v56, v57
    v_cvt_pk_bf16_f32 v131, v58, v59
    s_nop 1
    v_mfma_f32_16x16x32_bf16 v[28:31], v[44:47], v[128:131], 0
    v_max3_f32 v48, v72, v73, v74
    v_max3_f32 v48, v48, v75, v76
    v_max3_f32 v48, v48, v77, v78
    v_max3_f32 v48, v48, v79, 0
    v_mov_b32 v49, v48
    s_nop 1
    v_permlane32_swap_b32 v48, v49
    s_nop 1
    v_max_f32 v48, v48, v49
    v_mov_b32 v49, v48
    s_nop 1
    v_permlane16_swap_b32 v48, v49
    s_nop 1
    v_max_f32 v48, v48, v49
    v_exp_f32 v49, -v48
    v_sub_f32 v72, v72, v48
    v_sub_f32 v73, v73, v48
    v_sub_f32 v74, v74, v48
    v_sub_f32 v75, v75, v48
    v_sub_f32 v76, v76, v48
    v_sub_f32 v77, v77, v48
    v_sub_f32 v78, v78, v48
    v_sub_f32 v79, v79, v48
    v_sub_f32 v104, v104, v48
    v_sub_f32 v105, v105, v48
    v_sub_f32 v106, v106, v48
    v_sub_f32 v107, v107, v48
    v_sub_f32 v108, v108, v48
    v_sub_f32 v109, v109, v48
    v_sub_f32 v110, v110, v48
    v_sub_f32 v111, v111, v48
    v_sub_f32 v168, v168, v48
    v_sub_f32 v169, v169, v48
    v_sub_f32 v170, v170, v48
    v_sub_f32 v171, v171, v48
    v_sub_f32 v172, v172, v48
    v_sub_f32 v173, v173, v48
    v_sub_f32 v174, v174, v48
    v_sub_f32 v175, v175, v48
    v_mul_f32 v13, v13, v49
    v_accvgpr_read_b32 v52, a32
    v_accvgpr_read_b32 v53, a33
    v_accvgpr_read_b32 v54, a34
    v_accvgpr_read_b32 v55, a35
    v_accvgpr_read_b32 v56, a36
    v_accvgpr_read_b32 v57, a37
    v_accvgpr_read_b32 v58, a38
    v_accvgpr_read_b32 v59, a39
    v_mul_f32 v52, v52, v49
    v_mul_f32 v53, v53, v49
    v_mul_f32 v54, v54, v49
    v_mul_f32 v55, v55, v49
    v_mul_f32 v56, v56, v49
    v_mul_f32 v57, v57, v49
    v_mul_f32 v58, v58, v49
    v_mul_f32 v59, v59, v49
    v_accvgpr_write_b32 a32, v52
    v_accvgpr_write_b32 a33, v53
    v_accvgpr_write_b32 a34, v54
    v_accvgpr_write_b32 a35, v55
    v_accvgpr_write_b32 a36, v56
    v_accvgpr_write_b32 a37, v57
    v_accvgpr_write_b32 a38, v58
    v_accvgpr_write_b32 a39, v59
    v_accvgpr_read_b32 v52, a40
    v_accvgpr_read_b32 v53, a41
    v_accvgpr_read_b32 v54, a42
    v_accvgpr_read_b32 v55, a43
    v_accvgpr_read_b32 v56, a44
    v_accvgpr_read_b32 v57, a45
    v_accvgpr_read_b32 v58, a46
    v_accvgpr_read_b32 v59, a47
    v_mul_f32 v52, v52, v49
    v_mul_f32 v53, v53, v49
    v_mul_f32 v54, v54, v49
    v_mul_f32 v55, v55, v49
    v_mul_f32 v56, v56, v49
    v_mul_f32 v57, v57, v49
    v_mul_f32 v58, v58, v49
    v_mul_f32 v59, v59, v49
    v_accvgpr_write_b32 a40, v52
    v_accvgpr_write_b32 a41, v53
    v_accvgpr_write_b32 a42, v54
    v_accvgpr_write_b32 a43, v55
    v_accvgpr_write_b32 a44, v56
    v_accvgpr_write_b32 a45, v57
    v_accvgpr_write_b32 a46, v58
    v_accvgpr_write_b32 a47, v59
    v_accvgpr_read_b32 v52, a48
    v_accvgpr_read_b32 v53, a49
    v_accvgpr_read_b32 v54, a50
    v_accvgpr_read_b32 v55, a51
    v_accvgpr_read_b32 v56, a52
    v_accvgpr_read_b32 v57, a53
    v_accvgpr_read_b32 v58, a54
    v_accvgpr_read_b32 v59, a55
    v_mul_f32 v52, v52, v49
    v_mul_f32 v53, v53, v49
    v_mul_f32 v54, v54, v49
    v_mul_f32 v55, v55, v49
    v_mul_f32 v56, v56, v49
    v_mul_f32 v57, v57, v49
    v_mul_f32 v58, v58, v49
    v_mul_f32 v59, v59, v49
    v_accvgpr_write_b32 a48, v52
    v_accvgpr_write_b32 a49, v53
    v_accvgpr_write_b32 a50, v54
    v_accvgpr_write_b32 a51, v55
    v_accvgpr_write_b32 a52, v56
    v_accvgpr_write_b32 a53, v57
    v_accvgpr_write_b32 a54, v58
    v_accvgpr_write_b32 a55, v59
    v_accvgpr_read_b32 v52, a56
    v_accvgpr_read_b32 v53, a57
    v_accvgpr_read_b32 v54, a58
    v_accvgpr_read_b32 v55, a59
    v_accvgpr_read_b32 v56, a60
    v_accvgpr_read_b32 v57, a61
    v_accvgpr_read_b32 v58, a62
    v_accvgpr_read_b32 v59, a63
    v_mul_f32 v52, v52, v49
    v_mul_f32 v53, v53, v49
    v_mul_f32 v54, v54, v49
    v_mul_f32 v55, v55, v49
    v_mul_f32 v56, v56, v49
    v_mul_f32 v57, v57, v49
    v_mul_f32 v58, v58, v49
    v_mul_f32 v59, v59, v49
    v_accvgpr_write_b32 a56, v52
    v_accvgpr_write_b32 a57, v53
    v_accvgpr_write_b32 a58, v54
    v_accvgpr_write_b32 a59, v55
    v_accvgpr_write_b32 a60, v56
    v_accvgpr_write_b32 a61, v57
    v_accvgpr_write_b32 a62, v58
    v_accvgpr_write_b32 a63, v59
    v_exp_f32 v52, v72
    v_exp_f32 v53, v73
    v_exp_f32 v54, v74
    v_exp_f32 v55, v75
    v_exp_f32 v56, v76
    v_exp_f32 v57, v77
    v_exp_f32 v58, v78
    v_exp_f32 v59, v79
    s_nop 0
    v_cvt_pk_bf16_f32 v132, v52, v53
    v_cvt_pk_bf16_f32 v133, v54, v55
    v_cvt_pk_bf16_f32 v134, v56, v57
    v_cvt_pk_bf16_f32 v135, v58, v59
    s_nop 1
    v_mfma_f32_16x16x32_bf16 v[32:35], v[44:47], v[132:135], 0
    v_max3_f32 v48, v80, v81, v82
    v_max3_f32 v48, v48, v83, v84
    v_max3_f32 v48, v48, v85, v86
    v_max3_f32 v48, v48, v87, 0
    v_mov_b32 v49, v48
    s_nop 1
    v_permlane32_swap_b32 v48, v49
    s_nop 1
    v_max_f32 v48, v48, v49
    v_mov_b32 v49, v48
    s_nop 1
    v_permlane16_swap_b32 v48, v49
    s_nop 1
    v_max_f32 v48, v48, v49
    v_exp_f32 v49, -v48
    v_sub_f32 v80, v80, v48
    v_sub_f32 v81, v81, v48
    v_sub_f32 v82, v82, v48
    v_sub_f32 v83, v83, v48
    v_sub_f32 v84, v84, v48
    v_sub_f32 v85, v85, v48
    v_sub_f32 v86, v86, v48
    v_sub_f32 v87, v87, v48
    v_sub_f32 v112, v112, v48
    v_sub_f32 v113, v113, v48
    v_sub_f32 v114, v114, v48
    v_sub_f32 v115, v115, v48
    v_sub_f32 v116, v116, v48
    v_sub_f32 v117, v117, v48
    v_sub_f32 v118, v118, v48
    v_sub_f32 v119, v119, v48
    v_sub_f32 v176, v176, v48
    v_sub_f32 v177, v177, v48
    v_sub_f32 v178, v178, v48
    v_sub_f32 v179, v179, v48
    v_sub_f32 v180, v180, v48
    v_sub_f32 v181, v181, v48
    v_sub_f32 v182, v182, v48
    v_sub_f32 v183, v183, v48
    v_mul_f32 v14, v14, v49
    v_accvgpr_read_b32 v52, a64
    v_accvgpr_read_b32 v53, a65
    v_accvgpr_read_b32 v54, a66
    v_accvgpr_read_b32 v55, a67
    v_accvgpr_read_b32 v56, a68
    v_accvgpr_read_b32 v57, a69
    v_accvgpr_read_b32 v58, a70
    v_accvgpr_read_b32 v59, a71
    v_mul_f32 v52, v52, v49
    v_mul_f32 v53, v53, v49
    v_mul_f32 v54, v54, v49
    v_mul_f32 v55, v55, v49
    v_mul_f32 v56, v56, v49
    v_mul_f32 v57, v57, v49
    v_mul_f32 v58, v58, v49
    v_mul_f32 v59, v59, v49
    v_accvgpr_write_b32 a64, v52
    v_accvgpr_write_b32 a65, v53
    v_accvgpr_write_b32 a66, v54
    v_accvgpr_write_b32 a67, v55
    v_accvgpr_write_b32 a68, v56
    v_accvgpr_write_b32 a69, v57
    v_accvgpr_write_b32 a70, v58
    v_accvgpr_write_b32 a71, v59
    v_accvgpr_read_b32 v52, a72
    v_accvgpr_read_b32 v53, a73
    v_accvgpr_read_b32 v54, a74
    v_accvgpr_read_b32 v55, a75
    v_accvgpr_read_b32 v56, a76
    v_accvgpr_read_b32 v57, a77
    v_accvgpr_read_b32 v58, a78
    v_accvgpr_read_b32 v59, a79
    v_mul_f32 v52, v52, v49
    v_mul_f32 v53, v53, v49
    v_mul_f32 v54, v54, v49
    v_mul_f32 v55, v55, v49
    v_mul_f32 v56, v56, v49
    v_mul_f32 v57, v57, v49
    v_mul_f32 v58, v58, v49
    v_mul_f32 v59, v59, v49
    v_accvgpr_write_b32 a72, v52
    v_accvgpr_write_b32 a73, v53
    v_accvgpr_write_b32 a74, v54
    v_accvgpr_write_b32 a75, v55
    v_accvgpr_write_b32 a76, v56
    v_accvgpr_write_b32 a77, v57
    v_accvgpr_write_b32 a78, v58
    v_accvgpr_write_b32 a79, v59
    v_accvgpr_read_b32 v52, a80
    v_accvgpr_read_b32 v53, a81
    v_accvgpr_read_b32 v54, a82
    v_accvgpr_read_b32 v55, a83
    v_accvgpr_read_b32 v56, a84
    v_accvgpr_read_b32 v57, a85
    v_accvgpr_read_b32 v58, a86
    v_accvgpr_read_b32 v59, a87
    v_mul_f32 v52, v52, v49
    v_mul_f32 v53, v53, v49
    v_mul_f32 v54, v54, v49
    v_mul_f32 v55, v55, v49
    v_mul_f32 v56, v56, v49
    v_mul_f32 v57, v57, v49
    v_mul_f32 v58, v58, v49
    v_mul_f32 v59, v59, v49
    v_accvgpr_write_b32 a80, v52
    v_accvgpr_write_b32 a81, v53
    v_accvgpr_write_b32 a82, v54
    v_accvgpr_write_b32 a83, v55
    v_accvgpr_write_b32 a84, v56
    v_accvgpr_write_b32 a85, v57
    v_accvgpr_write_b32 a86, v58
    v_accvgpr_write_b32 a87, v59
    v_accvgpr_read_b32 v52, a88
    v_accvgpr_read_b32 v53, a89
    v_accvgpr_read_b32 v54, a90
    v_accvgpr_read_b32 v55, a91
    v_accvgpr_read_b32 v56, a92
    v_accvgpr_read_b32 v57, a93
    v_accvgpr_read_b32 v58, a94
    v_accvgpr_read_b32 v59, a95
    v_mul_f32 v52, v52, v49
    v_mul_f32 v53, v53, v49
    v_mul_f32 v54, v54, v49
    v_mul_f32 v55, v55, v49
    v_mul_f32 v56, v56, v49
    v_mul_f32 v57, v57, v49
    v_mul_f32 v58, v58, v49
    v_mul_f32 v59, v59, v49
    v_accvgpr_write_b32 a88, v52
    v_accvgpr_write_b32 a89, v53
    v_accvgpr_write_b32 a90, v54
    v_accvgpr_write_b32 a91, v55
    v_accvgpr_write_b32 a92, v56
    v_accvgpr_write_b32 a93, v57
    v_accvgpr_write_b32 a94, v58
    v_accvgpr_write_b32 a95, v59
    v_exp_f32 v52, v80
    v_exp_f32 v53, v81
    v_exp_f32 v54, v82
    v_exp_f32 v55, v83
    v_exp_f32 v56, v84
    v_exp_f32 v57, v85
    v_exp_f32 v58, v86
    v_exp_f32 v59, v87
    s_nop 0
    v_cvt_pk_bf16_f32 v136, v52, v53
    v_cvt_pk_bf16_f32 v137, v54, v55
    v_cvt_pk_bf16_f32 v138, v56, v57
    v_cvt_pk_bf16_f32 v139, v58, v59
    s_nop 1
    v_mfma_f32_16x16x32_bf16 v[36:39], v[44:47], v[136:139], 0
    v_max3_f32 v48, v88, v89, v90
    v_max3_f32 v48, v48, v91, v92
    v_max3_f32 v48, v48, v93, v94
    v_max3_f32 v48, v48, v95, 0
    v_mov_b32 v49, v48
    s_nop 1
    v_permlane32_swap_b32 v48, v49
    s_nop 1
    v_max_f32 v48, v48, v49
    v_mov_b32 v49, v48
    s_nop 1
    v_permlane16_swap_b32 v48, v49
    s_nop 1
    v_max_f32 v48, v48, v49
    v_exp_f32 v49, -v48
    v_sub_f32 v88, v88, v48
    v_sub_f32 v89, v89, v48
    v_sub_f32 v90, v90, v48
    v_sub_f32 v91, v91, v48
    v_sub_f32 v92, v92, v48
    v_sub_f32 v93, v93, v48
    v_sub_f32 v94, v94, v48
    v_sub_f32 v95, v95, v48
    v_sub_f32 v120, v120, v48
    v_sub_f32 v121, v121, v48
    v_sub_f32 v122, v122, v48
    v_sub_f32 v123, v123, v48
    v_sub_f32 v124, v124, v48
    v_sub_f32 v125, v125, v48
    v_sub_f32 v126, v126, v48
    v_sub_f32 v127, v127, v48
    v_sub_f32 v184, v184, v48
    v_sub_f32 v185, v185, v48
    v_sub_f32 v186, v186, v48
    v_sub_f32 v187, v187, v48
    v_sub_f32 v188, v188, v48
    v_sub_f32 v189, v189, v48
    v_sub_f32 v190, v190, v48
    v_sub_f32 v191, v191, v48
    v_mul_f32 v15, v15, v49
    v_accvgpr_read_b32 v52, a96
    v_accvgpr_read_b32 v53, a97
    v_accvgpr_read_b32 v54, a98
    v_accvgpr_read_b32 v55, a99
    v_accvgpr_read_b32 v56, a100
    v_accvgpr_read_b32 v57, a101
    v_accvgpr_read_b32 v58, a102
    v_accvgpr_read_b32 v59, a103
    v_mul_f32 v52, v52, v49
    v_mul_f32 v53, v53, v49
    v_mul_f32 v54, v54, v49
    v_mul_f32 v55, v55, v49
    v_mul_f32 v56, v56, v49
    v_mul_f32 v57, v57, v49
    v_mul_f32 v58, v58, v49
    v_mul_f32 v59, v59, v49
    v_accvgpr_write_b32 a96, v52
    v_accvgpr_write_b32 a97, v53
    v_accvgpr_write_b32 a98, v54
    v_accvgpr_write_b32 a99, v55
    v_accvgpr_write_b32 a100, v56
    v_accvgpr_write_b32 a101, v57
    v_accvgpr_write_b32 a102, v58
    v_accvgpr_write_b32 a103, v59
    v_accvgpr_read_b32 v52, a104
    v_accvgpr_read_b32 v53, a105
    v_accvgpr_read_b32 v54, a106
    v_accvgpr_read_b32 v55, a107
    v_accvgpr_read_b32 v56, a108
    v_accvgpr_read_b32 v57, a109
    v_accvgpr_read_b32 v58, a110
    v_accvgpr_read_b32 v59, a111
    v_mul_f32 v52, v52, v49
    v_mul_f32 v53, v53, v49
    v_mul_f32 v54, v54, v49
    v_mul_f32 v55, v55, v49
    v_mul_f32 v56, v56, v49
    v_mul_f32 v57, v57, v49
    v_mul_f32 v58, v58, v49
    v_mul_f32 v59, v59, v49
    v_accvgpr_write_b32 a104, v52
    v_accvgpr_write_b32 a105, v53
    v_accvgpr_write_b32 a106, v54
    v_accvgpr_write_b32 a107, v55
    v_accvgpr_write_b32 a108, v56
    v_accvgpr_write_b32 a109, v57
    v_accvgpr_write_b32 a110, v58
    v_accvgpr_write_b32 a111, v59
    v_accvgpr_read_b32 v52, a112
    v_accvgpr_read_b32 v53, a113
    v_accvgpr_read_b32 v54, a114
    v_accvgpr_read_b32 v55, a115
    v_accvgpr_read_b32 v56, a116
    v_accvgpr_read_b32 v57, a117
    v_accvgpr_read_b32 v58, a118
    v_accvgpr_read_b32 v59, a119
    v_mul_f32 v52, v52, v49
    v_mul_f32 v53, v53, v49
    v_mul_f32 v54, v54, v49
    v_mul_f32 v55, v55, v49
    v_mul_f32 v56, v56, v49
    v_mul_f32 v57, v57, v49
    v_mul_f32 v58, v58, v49
    v_mul_f32 v59, v59, v49
    v_accvgpr_write_b32 a112, v52
    v_accvgpr_write_b32 a113, v53
    v_accvgpr_write_b32 a114, v54
    v_accvgpr_write_b32 a115, v55
    v_accvgpr_write_b32 a116, v56
    v_accvgpr_write_b32 a117, v57
    v_accvgpr_write_b32 a118, v58
    v_accvgpr_write_b32 a119, v59
    v_accvgpr_read_b32 v52, a120
    v_accvgpr_read_b32 v53, a121
    v_accvgpr_read_b32 v54, a122
    v_accvgpr_read_b32 v55, a123
    v_accvgpr_read_b32 v56, a124
    v_accvgpr_read_b32 v57, a125
    v_accvgpr_read_b32 v58, a126
    v_accvgpr_read_b32 v59, a127
    v_mul_f32 v52, v52, v49
    v_mul_f32 v53, v53, v49
    v_mul_f32 v54, v54, v49
    v_mul_f32 v55, v55, v49
    v_mul_f32 v56, v56, v49
    v_mul_f32 v57, v57, v49
    v_mul_f32 v58, v58, v49
    v_mul_f32 v59, v59, v49
    v_accvgpr_write_b32 a120, v52
    v_accvgpr_write_b32 a121, v53
    v_accvgpr_write_b32 a122, v54
    v_accvgpr_write_b32 a123, v55
    v_accvgpr_write_b32 a124, v56
    v_accvgpr_write_b32 a125, v57
    v_accvgpr_write_b32 a126, v58
    v_accvgpr_write_b32 a127, v59
    v_exp_f32 v52, v88
    v_exp_f32 v53, v89
    v_exp_f32 v54, v90
    v_exp_f32 v55, v91
    v_exp_f32 v56, v92
    v_exp_f32 v57, v93
    v_exp_f32 v58, v94
    v_exp_f32 v59, v95
    s_nop 0
    v_cvt_pk_bf16_f32 v140, v52, v53
    v_cvt_pk_bf16_f32 v141, v54, v55
    v_cvt_pk_bf16_f32 v142, v56, v57
    v_cvt_pk_bf16_f32 v143, v58, v59
    s_nop 1
    v_mfma_f32_16x16x32_bf16 v[40:43], v[44:47], v[140:143], 0
    s_nop 7
    s_setpc_b64 s[74:75]
m_rs1266:
    s_nop 15
    v_max3_f32 v48, v96, v97, v98
    v_max3_f32 v48, v48, v99, v100
    v_max3_f32 v48, v48, v101, v102
    v_max3_f32 v48, v48, v103, 0
    v_mov_b32 v49, v48
    s_nop 1
    v_permlane32_swap_b32 v48, v49
    s_nop 1
    v_max_f32 v48, v48, v49
    v_mov_b32 v49, v48
    s_nop 1
    v_permlane16_swap_b32 v48, v49
    s_nop 1
    v_max_f32 v48, v48, v49
    v_exp_f32 v49, -v48
    v_sub_f32 v96, v96, v48
    v_sub_f32 v97, v97, v48
    v_sub_f32 v98, v98, v48
    v_sub_f32 v99, v99, v48
    v_sub_f32 v100, v100, v48
    v_sub_f32 v101, v101, v48
    v_sub_f32 v102, v102, v48
    v_sub_f32 v103, v103, v48
    v_sub_f32 v64, v64, v48
    v_sub_f32 v65, v65, v48
    v_sub_f32 v66, v66, v48
    v_sub_f32 v67, v67, v48
    v_sub_f32 v68, v68, v48
    v_sub_f32 v69, v69, v48
    v_sub_f32 v70, v70, v48
    v_sub_f32 v71, v71, v48
    v_sub_f32 v160, v160, v48
    v_sub_f32 v161, v161, v48
    v_sub_f32 v162, v162, v48
    v_sub_f32 v163, v163, v48
    v_sub_f32 v164, v164, v48
    v_sub_f32 v165, v165, v48
    v_sub_f32 v166, v166, v48
    v_sub_f32 v167, v167, v48
    v_mul_f32 v12, v12, v49
    v_accvgpr_read_b32 v52, a0
    v_accvgpr_read_b32 v53, a1
    v_accvgpr_read_b32 v54, a2
    v_accvgpr_read_b32 v55, a3
    v_accvgpr_read_b32 v56, a4
    v_accvgpr_read_b32 v57, a5
    v_accvgpr_read_b32 v58, a6
    v_accvgpr_read_b32 v59, a7
    v_mul_f32 v52, v52, v49
    v_mul_f32 v53, v53, v49
    v_mul_f32 v54, v54, v49
    v_mul_f32 v55, v55, v49
    v_mul_f32 v56, v56, v49
    v_mul_f32 v57, v57, v49
    v_mul_f32 v58, v58, v49
    v_mul_f32 v59, v59, v49
    v_accvgpr_write_b32 a0, v52
    v_accvgpr_write_b32 a1, v53
    v_accvgpr_write_b32 a2, v54
    v_accvgpr_write_b32 a3, v55
    v_accvgpr_write_b32 a4, v56
    v_accvgpr_write_b32 a5, v57
    v_accvgpr_write_b32 a6, v58
    v_accvgpr_write_b32 a7, v59
    v_accvgpr_read_b32 v52, a8
    v_accvgpr_read_b32 v53, a9
    v_accvgpr_read_b32 v54, a10
    v_accvgpr_read_b32 v55, a11
    v_accvgpr_read_b32 v56, a12
    v_accvgpr_read_b32 v57, a13
    v_accvgpr_read_b32 v58, a14
    v_accvgpr_read_b32 v59, a15
    v_mul_f32 v52, v52, v49
    v_mul_f32 v53, v53, v49
    v_mul_f32 v54, v54, v49
    v_mul_f32 v55, v55, v49
    v_mul_f32 v56, v56, v49
    v_mul_f32 v57, v57, v49
    v_mul_f32 v58, v58, v49
    v_mul_f32 v59, v59, v49
    v_accvgpr_write_b32 a8, v52
    v_accvgpr_write_b32 a9, v53
    v_accvgpr_write_b32 a10, v54
    v_accvgpr_write_b32 a11, v55
    v_accvgpr_write_b32 a12, v56
    v_accvgpr_write_b32 a13, v57
    v_accvgpr_write_b32 a14, v58
    v_accvgpr_write_b32 a15, v59
    v_accvgpr_read_b32 v52, a16
    v_accvgpr_read_b32 v53, a17
    v_accvgpr_read_b32 v54, a18
    v_accvgpr_read_b32 v55, a19
    v_accvgpr_read_b32 v56, a20
    v_accvgpr_read_b32 v57, a21
    v_accvgpr_read_b32 v58, a22
    v_accvgpr_read_b32 v59, a23
    v_mul_f32 v52, v52, v49
    v_mul_f32 v53, v53, v49
    v_mul_f32 v54, v54, v49
    v_mul_f32 v55, v55, v49
    v_mul_f32 v56, v56, v49
    v_mul_f32 v57, v57, v49
    v_mul_f32 v58, v58, v49
    v_mul_f32 v59, v59, v49
    v_accvgpr_write_b32 a16, v52
    v_accvgpr_write_b32 a17, v53
    v_accvgpr_write_b32 a18, v54
    v_accvgpr_write_b32 a19, v55
    v_accvgpr_write_b32 a20, v56
    v_accvgpr_write_b32 a21, v57
    v_accvgpr_write_b32 a22, v58
    v_accvgpr_write_b32 a23, v59
    v_accvgpr_read_b32 v52, a24
    v_accvgpr_read_b32 v53, a25
    v_accvgpr_read_b32 v54, a26
    v_accvgpr_read_b32 v55, a27
    v_accvgpr_read_b32 v56, a28
    v_accvgpr_read_b32 v57, a29
    v_accvgpr_read_b32 v58, a30
    v_accvgpr_read_b32 v59, a31
    v_mul_f32 v52, v52, v49
    v_mul_f32 v53, v53, v49
    v_mul_f32 v54, v54, v49
    v_mul_f32 v55, v55, v49
    v_mul_f32 v56, v56, v49
    v_mul_f32 v57, v57, v49
    v_mul_f32 v58, v58, v49
    v_mul_f32 v59, v59, v49
    v_accvgpr_write_b32 a24, v52
    v_accvgpr_write_b32 a25, v53
    v_accvgpr_write_b32 a26, v54
    v_accvgpr_write_b32 a27, v55
    v_accvgpr_write_b32 a28, v56
    v_accvgpr_write_b32 a29, v57
    v_accvgpr_write_b32 a30, v58
    v_accvgpr_write_b32 a31, v59
    v_exp_f32 v52, v96
    v_exp_f32 v53, v97
    v_exp_f32 v54, v98
    v_exp_f32 v55, v99
    v_exp_f32 v56, v100
    v_exp_f32 v57, v101
    v_exp_f32 v58, v102
    v_exp_f32 v59, v103
    s_nop 0
    v_cvt_pk_bf16_f32 v144, v52, v53
    v_cvt_pk_bf16_f32 v145, v54, v55
    v_cvt_pk_bf16_f32 v146, v56, v57
    v_cvt_pk_bf16_f32 v147, v58, v59
    s_nop 1
    v_mfma_f32_16x16x32_bf16 v[28:31], v[44:47], v[144:147], 0
    v_max3_f32 v48, v104, v105, v106
    v_max3_f32 v48, v48, v107, v108
    v_max3_f32 v48, v48, v109, v110
    v_max3_f32 v48, v48, v111, 0
    v_mov_b32 v49, v48
    s_nop 1
    v_permlane32_swap_b32 v48, v49
    s_nop 1
    v_max_f32 v48, v48, v49
    v_mov_b32 v49, v48
    s_nop 1
    v_permlane16_swap_b32 v48, v49
    s_nop 1
    v_max_f32 v48, v48, v49
    v_exp_f32 v49, -v48
    v_sub_f32 v104, v104, v48
    v_sub_f32 v105, v105, v48
    v_sub_f32 v106, v106, v48
    v_sub_f32 v107, v107, v48
    v_sub_f32 v108, v108, v48
    v_sub_f32 v109, v109, v48
    v_sub_f32 v110, v110, v48
    v_sub_f32 v111, v111, v48
    v_sub_f32 v72, v72, v48
    v_sub_f32 v73, v73, v48
    v_sub_f32 v74, v74, v48
    v_sub_f32 v75, v75, v48
    v_sub_f32 v76, v76, v48
    v_sub_f32 v77, v77, v48
    v_sub_f32 v78, v78, v48
    v_sub_f32 v79, v79, v48
    v_sub_f32 v168, v168, v48
    v_sub_f32 v169, v169, v48
    v_sub_f32 v170, v170, v48
    v_sub_f32 v171, v171, v48
    v_sub_f32 v172, v172, v48
    v_sub_f32 v173, v173, v48
    v_sub_f32 v174, v174, v48
    v_sub_f32 v175, v175, v48
    v_mul_f32 v13, v13, v49
    v_accvgpr_read_b32 v52, a32
    v_accvgpr_read_b32 v53, a33
    v_accvgpr_read_b32 v54, a34
    v_accvgpr_read_b32 v55, a35
    v_accvgpr_read_b32 v56, a36
    v_accvgpr_read_b32 v57, a37
    v_accvgpr_read_b32 v58, a38
    v_accvgpr_read_b32 v59, a39
    v_mul_f32 v52, v52, v49
    v_mul_f32 v53, v53, v49
    v_mul_f32 v54, v54, v49
    v_mul_f32 v55, v55, v49
    v_mul_f32 v56, v56, v49
    v_mul_f32 v57, v57, v49
    v_mul_f32 v58, v58, v49
    v_mul_f32 v59, v59, v49
    v_accvgpr_write_b32 a32, v52
    v_accvgpr_write_b32 a33, v53
    v_accvgpr_write_b32 a34, v54
    v_accvgpr_write_b32 a35, v55
    v_accvgpr_write_b32 a36, v56
    v_accvgpr_write_b32 a37, v57
    v_accvgpr_write_b32 a38, v58
    v_accvgpr_write_b32 a39, v59
    v_accvgpr_read_b32 v52, a40
    v_accvgpr_read_b32 v53, a41
    v_accvgpr_read_b32 v54, a42
    v_accvgpr_read_b32 v55, a43
    v_accvgpr_read_b32 v56, a44
    v_accvgpr_read_b32 v57, a45
    v_accvgpr_read_b32 v58, a46
    v_accvgpr_read_b32 v59, a47
    v_mul_f32 v52, v52, v49
    v_mul_f32 v53, v53, v49
    v_mul_f32 v54, v54, v49
    v_mul_f32 v55, v55, v49
    v_mul_f32 v56, v56, v49
    v_mul_f32 v57, v57, v49
    v_mul_f32 v58, v58, v49
    v_mul_f32 v59, v59, v49
    v_accvgpr_write_b32 a40, v52
    v_accvgpr_write_b32 a41, v53
    v_accvgpr_write_b32 a42, v54
    v_accvgpr_write_b32 a43, v55
    v_accvgpr_write_b32 a44, v56
    v_accvgpr_write_b32 a45, v57
    v_accvgpr_write_b32 a46, v58
    v_accvgpr_write_b32 a47, v59
    v_accvgpr_read_b32 v52, a48
    v_accvgpr_read_b32 v53, a49
    v_accvgpr_read_b32 v54, a50
    v_accvgpr_read_b32 v55, a51
    v_accvgpr_read_b32 v56, a52
    v_accvgpr_read_b32 v57, a53
    v_accvgpr_read_b32 v58, a54
    v_accvgpr_read_b32 v59, a55
    v_mul_f32 v52, v52, v49
    v_mul_f32 v53, v53, v49
    v_mul_f32 v54, v54, v49
    v_mul_f32 v55, v55, v49
    v_mul_f32 v56, v56, v49
    v_mul_f32 v57, v57, v49
    v_mul_f32 v58, v58, v49
    v_mul_f32 v59, v59, v49
    v_accvgpr_write_b32 a48, v52
    v_accvgpr_write_b32 a49, v53
    v_accvgpr_write_b32 a50, v54
    v_accvgpr_write_b32 a51, v55
    v_accvgpr_write_b32 a52, v56
    v_accvgpr_write_b32 a53, v57
    v_accvgpr_write_b32 a54, v58
    v_accvgpr_write_b32 a55, v59
    v_accvgpr_read_b32 v52, a56
    v_accvgpr_read_b32 v53, a57
    v_accvgpr_read_b32 v54, a58
    v_accvgpr_read_b32 v55, a59
    v_accvgpr_read_b32 v56, a60
    v_accvgpr_read_b32 v57, a61
    v_accvgpr_read_b32 v58, a62
    v_accvgpr_read_b32 v59, a63
    v_mul_f32 v52, v52, v49
    v_mul_f32 v53, v53, v49
    v_mul_f32 v54, v54, v49
    v_mul_f32 v55, v55, v49
    v_mul_f32 v56, v56, v49
    v_mul_f32 v57, v57, v49
    v_mul_f32 v58, v58, v49
    v_mul_f32 v59, v59, v49
    v_accvgpr_write_b32 a56, v52
    v_accvgpr_write_b32 a57, v53
    v_accvgpr_write_b32 a58, v54
    v_accvgpr_write_b32 a59, v55
    v_accvgpr_write_b32 a60, v56
    v_accvgpr_write_b32 a61, v57
    v_accvgpr_write_b32 a62, v58
    v_accvgpr_write_b32 a63, v59
    v_exp_f32 v52, v104
    v_exp_f32 v53, v105
    v_exp_f32 v54, v106
    v_exp_f32 v55, v107
    v_exp_f32 v56, v108
    v_exp_f32 v57, v109
    v_exp_f32 v58, v110
    v_exp_f32 v59, v111
    s_nop 0
    v_cvt_pk_bf16_f32 v148, v52, v53
    v_cvt_pk_bf16_f32 v149, v54, v55
    v_cvt_pk_bf16_f32 v150, v56, v57
    v_cvt_pk_bf16_f32 v151, v58, v59
    s_nop 1
    v_mfma_f32_16x16x32_bf16 v[32:35], v[44:47], v[148:151], 0
    s_nop 7
    s_setpc_b64 s[74:75]
m_rs1467:
    s_nop 15
    v_max3_f32 v48, v96, v97, v98
    v_max3_f32 v48, v48, v99, v100
    v_max3_f32 v48, v48, v101, v102
    v_max3_f32 v48, v48, v103, 0
    v_mov_b32 v49, v48
    s_nop 1
    v_permlane32_swap_b32 v48, v49
    s_nop 1
    v_max_f32 v48, v48, v49
    v_mov_b32 v49, v48
    s_nop 1
    v_permlane16_swap_b32 v48, v49
    s_nop 1
    v_max_f32 v48, v48, v49
    v_exp_f32 v49, -v48
    v_sub_f32 v96, v96, v48
    v_sub_f32 v97, v97, v48
    v_sub_f32 v98, v98, v48
    v_sub_f32 v99, v99, v48
    v_sub_f32 v100, v100, v48
    v_sub_f32 v101, v101, v48
    v_sub_f32 v102, v102, v48
    v_sub_f32 v103, v103, v48
    v_sub_f32 v64, v64, v48
    v_sub_f32 v65, v65, v48
    v_sub_f32 v66, v66, v48
    v_sub_f32 v67, v67, v48
    v_sub_f32 v68, v68, v48
    v_sub_f32 v69, v69, v48
    v_sub_f32 v70, v70, v48
    v_sub_f32 v71, v71, v48
    v_sub_f32 v160, v160, v48
    v_sub_f32 v161, v161, v48
    v_sub_f32 v162, v162, v48
    v_sub_f32 v163, v163, v48
    v_sub_f32 v164, v164, v48
    v_sub_f32 v165, v165, v48
    v_sub_f32 v166, v166, v48
    v_sub_f32 v167, v167, v48
    v_mul_f32 v12, v12, v49
    v_accvgpr_read_b32 v52, a0
    v_accvgpr_read_b32 v53, a1
    v_accvgpr_read_b32 v54, a2
    v_accvgpr_read_b32 v55, a3
    v_accvgpr_read_b32 v56, a4
    v_accvgpr_read_b32 v57, a5
    v_accvgpr_read_b32 v58, a6
    v_accvgpr_read_b32 v59, a7
    v_mul_f32 v52, v52, v49
    v_mul_f32 v53, v53, v49
    v_mul_f32 v54, v54, v49
    v_mul_f32 v55, v55, v49
    v_mul_f32 v56, v56, v49
    v_mul_f32 v57, v57, v49
    v_mul_f32 v58, v58, v49
    v_mul_f32 v59, v59, v49
    v_accvgpr_write_b32 a0, v52
    v_accvgpr_write_b32 a1, v53
    v_accvgpr_write_b32 a2, v54
    v_accvgpr_write_b32 a3, v55
    v_accvgpr_write_b32 a4, v56
    v_accvgpr_write_b32 a5, v57
    v_accvgpr_write_b32 a6, v58
    v_accvgpr_write_b32 a7, v59
    v_accvgpr_read_b32 v52, a8
    v_accvgpr_read_b32 v53, a9
    v_accvgpr_read_b32 v54, a10
    v_accvgpr_read_b32 v55, a11
    v_accvgpr_read_b32 v56, a12
    v_accvgpr_read_b32 v57, a13
    v_accvgpr_read_b32 v58, a14
    v_accvgpr_read_b32 v59, a15
    v_mul_f32 v52, v52, v49
    v_mul_f32 v53, v53, v49
    v_mul_f32 v54, v54, v49
    v_mul_f32 v55, v55, v49
    v_mul_f32 v56, v56, v49
    v_mul_f32 v57, v57, v49
    v_mul_f32 v58, v58, v49
    v_mul_f32 v59, v59, v49
    v_accvgpr_write_b32 a8, v52
    v_accvgpr_write_b32 a9, v53
    v_accvgpr_write_b32 a10, v54
    v_accvgpr_write_b32 a11, v55
    v_accvgpr_write_b32 a12, v56
    v_accvgpr_write_b32 a13, v57
    v_accvgpr_write_b32 a14, v58
    v_accvgpr_write_b32 a15, v59
    v_accvgpr_read_b32 v52, a16
    v_accvgpr_read_b32 v53, a17
    v_accvgpr_read_b32 v54, a18
    v_accvgpr_read_b32 v55, a19
    v_accvgpr_read_b32 v56, a20
    v_accvgpr_read_b32 v57, a21
    v_accvgpr_read_b32 v58, a22
    v_accvgpr_read_b32 v59, a23
    v_mul_f32 v52, v52, v49
    v_mul_f32 v53, v53, v49
    v_mul_f32 v54, v54, v49
    v_mul_f32 v55, v55, v49
    v_mul_f32 v56, v56, v49
    v_mul_f32 v57, v57, v49
    v_mul_f32 v58, v58, v49
    v_mul_f32 v59, v59, v49
    v_accvgpr_write_b32 a16, v52
    v_accvgpr_write_b32 a17, v53
    v_accvgpr_write_b32 a18, v54
    v_accvgpr_write_b32 a19, v55
    v_accvgpr_write_b32 a20, v56
    v_accvgpr_write_b32 a21, v57
    v_accvgpr_write_b32 a22, v58
    v_accvgpr_write_b32 a23, v59
    v_accvgpr_read_b32 v52, a24
    v_accvgpr_read_b32 v53, a25
    v_accvgpr_read_b32 v54, a26
    v_accvgpr_read_b32 v55, a27
    v_accvgpr_read_b32 v56, a28
    v_accvgpr_read_b32 v57, a29
    v_accvgpr_read_b32 v58, a30
    v_accvgpr_read_b32 v59, a31
    v_mul_f32 v52, v52, v49
    v_mul_f32 v53, v53, v49
    v_mul_f32 v54, v54, v49
    v_mul_f32 v55, v55, v49
    v_mul_f32 v56, v56, v49
    v_mul_f32 v57, v57, v49
    v_mul_f32 v58, v58, v49
    v_mul_f32 v59, v59, v49
    v_accvgpr_write_b32 a24, v52
    v_accvgpr_write_b32 a25, v53
    v_accvgpr_write_b32 a26, v54
    v_accvgpr_write_b32 a27, v55
    v_accvgpr_write_b32 a28, v56
    v_accvgpr_write_b32 a29, v57
    v_accvgpr_write_b32 a30, v58
    v_accvgpr_write_b32 a31, v59
    v_exp_f32 v52, v96
    v_exp_f32 v53, v97
    v_exp_f32 v54, v98
    v_exp_f32 v55, v99
    v_exp_f32 v56, v100
    v_exp_f32 v57, v101
    v_exp_f32 v58, v102
    v_exp_f32 v59, v103
    s_nop 0
    v_cvt_pk_bf16_f32 v144, v52, v53
    v_cvt_pk_bf16_f32 v145, v54, v55
    v_cvt_pk_bf16_f32 v146, v56, v57
    v_cvt_pk_bf16_f32 v147, v58, v59
    s_nop 1
    v_mfma_f32_16x16x32_bf16 v[28:31], v[44:47], v[144:147], 0
    v_max3_f32 v48, v104, v105, v106
    v_max3_f32 v48, v48, v107, v108
    v_max3_f32 v48, v48, v109, v110
    v_max3_f32 v48, v48, v111, 0
    v_mov_b32 v49, v48
    s_nop 1
    v_permlane32_swap_b32 v48, v49
    s_nop 1
    v_max_f32 v48, v48, v49
    v_mov_b32 v49, v48
    s_nop 1
    v_permlane16_swap_b32 v48, v49
    s_nop 1
    v_max_f32 v48, v48, v49
    v_exp_f32 v49, -v48
    v_sub_f32 v104, v104, v48
    v_sub_f32 v105, v105, v48
    v_sub_f32 v106, v106, v48
    v_sub_f32 v107, v107, v48
    v_sub_f32 v108, v108, v48
    v_sub_f32 v109, v109, v48
    v_sub_f32 v110, v110, v48
    v_sub_f32 v111, v111, v48
    v_sub_f32 v72, v72, v48
    v_sub_f32 v73, v73, v48
    v_sub_f32 v74, v74, v48
    v_sub_f32 v75, v75, v48
    v_sub_f32 v76, v76, v48
    v_sub_f32 v77, v77, v48
    v_sub_f32 v78, v78, v48
    v_sub_f32 v79, v79, v48
    v_sub_f32 v168, v168, v48
    v_sub_f32 v169, v169, v48
    v_sub_f32 v170, v170, v48
    v_sub_f32 v171, v171, v48
    v_sub_f32 v172, v172, v48
    v_sub_f32 v173, v173, v48
    v_sub_f32 v174, v174, v48
    v_sub_f32 v175, v175, v48
    v_mul_f32 v13, v13, v49
    v_accvgpr_read_b32 v52, a32
    v_accvgpr_read_b32 v53, a33
    v_accvgpr_read_b32 v54, a34
    v_accvgpr_read_b32 v55, a35
    v_accvgpr_read_b32 v56, a36
    v_accvgpr_read_b32 v57, a37
    v_accvgpr_read_b32 v58, a38
    v_accvgpr_read_b32 v59, a39
    v_mul_f32 v52, v52, v49
    v_mul_f32 v53, v53, v49
    v_mul_f32 v54, v54, v49
    v_mul_f32 v55, v55, v49
    v_mul_f32 v56, v56, v49
    v_mul_f32 v57, v57, v49
    v_mul_f32 v58, v58, v49
    v_mul_f32 v59, v59, v49
    v_accvgpr_write_b32 a32, v52
    v_accvgpr_write_b32 a33, v53
    v_accvgpr_write_b32 a34, v54
    v_accvgpr_write_b32 a35, v55
    v_accvgpr_write_b32 a36, v56
    v_accvgpr_write_b32 a37, v57
    v_accvgpr_write_b32 a38, v58
    v_accvgpr_write_b32 a39, v59
    v_accvgpr_read_b32 v52, a40
    v_accvgpr_read_b32 v53, a41
    v_accvgpr_read_b32 v54, a42
    v_accvgpr_read_b32 v55, a43
    v_accvgpr_read_b32 v56, a44
    v_accvgpr_read_b32 v57, a45
    v_accvgpr_read_b32 v58, a46
    v_accvgpr_read_b32 v59, a47
    v_mul_f32 v52, v52, v49
    v_mul_f32 v53, v53, v49
    v_mul_f32 v54, v54, v49
    v_mul_f32 v55, v55, v49
    v_mul_f32 v56, v56, v49
    v_mul_f32 v57, v57, v49
    v_mul_f32 v58, v58, v49
    v_mul_f32 v59, v59, v49
    v_accvgpr_write_b32 a40, v52
    v_accvgpr_write_b32 a41, v53
    v_accvgpr_write_b32 a42, v54
    v_accvgpr_write_b32 a43, v55
    v_accvgpr_write_b32 a44, v56
    v_accvgpr_write_b32 a45, v57
    v_accvgpr_write_b32 a46, v58
    v_accvgpr_write_b32 a47, v59
    v_accvgpr_read_b32 v52, a48
    v_accvgpr_read_b32 v53, a49
    v_accvgpr_read_b32 v54, a50
    v_accvgpr_read_b32 v55, a51
    v_accvgpr_read_b32 v56, a52
    v_accvgpr_read_b32 v57, a53
    v_accvgpr_read_b32 v58, a54
    v_accvgpr_read_b32 v59, a55
    v_mul_f32 v52, v52, v49
    v_mul_f32 v53, v53, v49
    v_mul_f32 v54, v54, v49
    v_mul_f32 v55, v55, v49
    v_mul_f32 v56, v56, v49
    v_mul_f32 v57, v57, v49
    v_mul_f32 v58, v58, v49
    v_mul_f32 v59, v59, v49
    v_accvgpr_write_b32 a48, v52
    v_accvgpr_write_b32 a49, v53
    v_accvgpr_write_b32 a50, v54
    v_accvgpr_write_b32 a51, v55
    v_accvgpr_write_b32 a52, v56
    v_accvgpr_write_b32 a53, v57
    v_accvgpr_write_b32 a54, v58
    v_accvgpr_write_b32 a55, v59
    v_accvgpr_read_b32 v52, a56
    v_accvgpr_read_b32 v53, a57
    v_accvgpr_read_b32 v54, a58
    v_accvgpr_read_b32 v55, a59
    v_accvgpr_read_b32 v56, a60
    v_accvgpr_read_b32 v57, a61
    v_accvgpr_read_b32 v58, a62
    v_accvgpr_read_b32 v59, a63
    v_mul_f32 v52, v52, v49
    v_mul_f32 v53, v53, v49
    v_mul_f32 v54, v54, v49
    v_mul_f32 v55, v55, v49
    v_mul_f32 v56, v56, v49
    v_mul_f32 v57, v57, v49
    v_mul_f32 v58, v58, v49
    v_mul_f32 v59, v59, v49
    v_accvgpr_write_b32 a56, v52
    v_accvgpr_write_b32 a57, v53
    v_accvgpr_write_b32 a58, v54
    v_accvgpr_write_b32 a59, v55
    v_accvgpr_write_b32 a60, v56
    v_accvgpr_write_b32 a61, v57
    v_accvgpr_write_b32 a62, v58
    v_accvgpr_write_b32 a63, v59
    v_exp_f32 v52, v104
    v_exp_f32 v53, v105
    v_exp_f32 v54, v106
    v_exp_f32 v55, v107
    v_exp_f32 v56, v108
    v_exp_f32 v57, v109
    v_exp_f32 v58, v110
    v_exp_f32 v59, v111
    s_nop 0
    v_cvt_pk_bf16_f32 v148, v52, v53
    v_cvt_pk_bf16_f32 v149, v54, v55
    v_cvt_pk_bf16_f32 v150, v56, v57
    v_cvt_pk_bf16_f32 v151, v58, v59
    s_nop 1
    v_mfma_f32_16x16x32_bf16 v[32:35], v[44:47], v[148:151], 0
    v_max3_f32 v48, v112, v113, v114
    v_max3_f32 v48, v48, v115, v116
    v_max3_f32 v48, v48, v117, v118
    v_max3_f32 v48, v48, v119, 0
    v_mov_b32 v49, v48
    s_nop 1
    v_permlane32_swap_b32 v48, v49
    s_nop 1
    v_max_f32 v48, v48, v49
    v_mov_b32 v49, v48
    s_nop 1
    v_permlane16_swap_b32 v48, v49
    s_nop 1
    v_max_f32 v48, v48, v49
    v_exp_f32 v49, -v48
    v_sub_f32 v112, v112, v48
    v_sub_f32 v113, v113, v48
    v_sub_f32 v114, v114, v48
    v_sub_f32 v115, v115, v48
    v_sub_f32 v116, v116, v48
    v_sub_f32 v117, v117, v48
    v_sub_f32 v118, v118, v48
    v_sub_f32 v119, v119, v48
    v_sub_f32 v80, v80, v48
    v_sub_f32 v81, v81, v48
    v_sub_f32 v82, v82, v48
    v_sub_f32 v83, v83, v48
    v_sub_f32 v84, v84, v48
    v_sub_f32 v85, v85, v48
    v_sub_f32 v86, v86, v48
    v_sub_f32 v87, v87, v48
    v_sub_f32 v176, v176, v48
    v_sub_f32 v177, v177, v48
    v_sub_f32 v178, v178, v48
    v_sub_f32 v179, v179, v48
    v_sub_f32 v180, v180, v48
    v_sub_f32 v181, v181, v48
    v_sub_f32 v182, v182, v48
    v_sub_f32 v183, v183, v48
    v_mul_f32 v14, v14, v49
    v_accvgpr_read_b32 v52, a64
    v_accvgpr_read_b32 v53, a65
    v_accvgpr_read_b32 v54, a66
    v_accvgpr_read_b32 v55, a67
    v_accvgpr_read_b32 v56, a68
    v_accvgpr_read_b32 v57, a69
    v_accvgpr_read_b32 v58, a70
    v_accvgpr_read_b32 v59, a71
    v_mul_f32 v52, v52, v49
    v_mul_f32 v53, v53, v49
    v_mul_f32 v54, v54, v49
    v_mul_f32 v55, v55, v49
    v_mul_f32 v56, v56, v49
    v_mul_f32 v57, v57, v49
    v_mul_f32 v58, v58, v49
    v_mul_f32 v59, v59, v49
    v_accvgpr_write_b32 a64, v52
    v_accvgpr_write_b32 a65, v53
    v_accvgpr_write_b32 a66, v54
    v_accvgpr_write_b32 a67, v55
    v_accvgpr_write_b32 a68, v56
    v_accvgpr_write_b32 a69, v57
    v_accvgpr_write_b32 a70, v58
    v_accvgpr_write_b32 a71, v59
    v_accvgpr_read_b32 v52, a72
    v_accvgpr_read_b32 v53, a73
    v_accvgpr_read_b32 v54, a74
    v_accvgpr_read_b32 v55, a75
    v_accvgpr_read_b32 v56, a76
    v_accvgpr_read_b32 v57, a77
    v_accvgpr_read_b32 v58, a78
    v_accvgpr_read_b32 v59, a79
    v_mul_f32 v52, v52, v49
    v_mul_f32 v53, v53, v49
    v_mul_f32 v54, v54, v49
    v_mul_f32 v55, v55, v49
    v_mul_f32 v56, v56, v49
    v_mul_f32 v57, v57, v49
    v_mul_f32 v58, v58, v49
    v_mul_f32 v59, v59, v49
    v_accvgpr_write_b32 a72, v52
    v_accvgpr_write_b32 a73, v53
    v_accvgpr_write_b32 a74, v54
    v_accvgpr_write_b32 a75, v55
    v_accvgpr_write_b32 a76, v56
    v_accvgpr_write_b32 a77, v57
    v_accvgpr_write_b32 a78, v58
    v_accvgpr_write_b32 a79, v59
    v_accvgpr_read_b32 v52, a80
    v_accvgpr_read_b32 v53, a81
    v_accvgpr_read_b32 v54, a82
    v_accvgpr_read_b32 v55, a83
    v_accvgpr_read_b32 v56, a84
    v_accvgpr_read_b32 v57, a85
    v_accvgpr_read_b32 v58, a86
    v_accvgpr_read_b32 v59, a87
    v_mul_f32 v52, v52, v49
    v_mul_f32 v53, v53, v49
    v_mul_f32 v54, v54, v49
    v_mul_f32 v55, v55, v49
    v_mul_f32 v56, v56, v49
    v_mul_f32 v57, v57, v49
    v_mul_f32 v58, v58, v49
    v_mul_f32 v59, v59, v49
    v_accvgpr_write_b32 a80, v52
    v_accvgpr_write_b32 a81, v53
    v_accvgpr_write_b32 a82, v54
    v_accvgpr_write_b32 a83, v55
    v_accvgpr_write_b32 a84, v56
    v_accvgpr_write_b32 a85, v57
    v_accvgpr_write_b32 a86, v58
    v_accvgpr_write_b32 a87, v59
    v_accvgpr_read_b32 v52, a88
    v_accvgpr_read_b32 v53, a89
    v_accvgpr_read_b32 v54, a90
    v_accvgpr_read_b32 v55, a91
    v_accvgpr_read_b32 v56, a92
    v_accvgpr_read_b32 v57, a93
    v_accvgpr_read_b32 v58, a94
    v_accvgpr_read_b32 v59, a95
    v_mul_f32 v52, v52, v49
    v_mul_f32 v53, v53, v49
    v_mul_f32 v54, v54, v49
    v_mul_f32 v55, v55, v49
    v_mul_f32 v56, v56, v49
    v_mul_f32 v57, v57, v49
    v_mul_f32 v58, v58, v49
    v_mul_f32 v59, v59, v49
    v_accvgpr_write_b32 a88, v52
    v_accvgpr_write_b32 a89, v53
    v_accvgpr_write_b32 a90, v54
    v_accvgpr_write_b32 a91, v55
    v_accvgpr_write_b32 a92, v56
    v_accvgpr_write_b32 a93, v57
    v_accvgpr_write_b32 a94, v58
    v_accvgpr_write_b32 a95, v59
    v_exp_f32 v52, v112
    v_exp_f32 v53, v113
    v_exp_f32 v54, v114
    v_exp_f32 v55, v115
    v_exp_f32 v56, v116
    v_exp_f32 v57, v117
    v_exp_f32 v58, v118
    v_exp_f32 v59, v119
    s_nop 0
    v_cvt_pk_bf16_f32 v152, v52, v53
    v_cvt_pk_bf16_f32 v153, v54, v55
    v_cvt_pk_bf16_f32 v154, v56, v57
    v_cvt_pk_bf16_f32 v155, v58, v59
    s_nop 1
    v_mfma_f32_16x16x32_bf16 v[36:39], v[44:47], v[152:155], 0
    v_max3_f32 v48, v120, v121, v122
    v_max3_f32 v48, v48, v123, v124
    v_max3_f32 v48, v48, v125, v126
    v_max3_f32 v48, v48, v127, 0
    v_mov_b32 v49, v48
    s_nop 1
    v_permlane32_swap_b32 v48, v49
    s_nop 1
    v_max_f32 v48, v48, v49
    v_mov_b32 v49, v48
    s_nop 1
    v_permlane16_swap_b32 v48, v49
    s_nop 1
    v_max_f32 v48, v48, v49
    v_exp_f32 v49, -v48
    v_sub_f32 v120, v120, v48
    v_sub_f32 v121, v121, v48
    v_sub_f32 v122, v122, v48
    v_sub_f32 v123, v123, v48
    v_sub_f32 v124, v124, v48
    v_sub_f32 v125, v125, v48
    v_sub_f32 v126, v126, v48
    v_sub_f32 v127, v127, v48
    v_sub_f32 v88, v88, v48
    v_sub_f32 v89, v89, v48
    v_sub_f32 v90, v90, v48
    v_sub_f32 v91, v91, v48
    v_sub_f32 v92, v92, v48
    v_sub_f32 v93, v93, v48
    v_sub_f32 v94, v94, v48
    v_sub_f32 v95, v95, v48
    v_sub_f32 v184, v184, v48
    v_sub_f32 v185, v185, v48
    v_sub_f32 v186, v186, v48
    v_sub_f32 v187, v187, v48
    v_sub_f32 v188, v188, v48
    v_sub_f32 v189, v189, v48
    v_sub_f32 v190, v190, v48
    v_sub_f32 v191, v191, v48
    v_mul_f32 v15, v15, v49
    v_accvgpr_read_b32 v52, a96
    v_accvgpr_read_b32 v53, a97
    v_accvgpr_read_b32 v54, a98
    v_accvgpr_read_b32 v55, a99
    v_accvgpr_read_b32 v56, a100
    v_accvgpr_read_b32 v57, a101
    v_accvgpr_read_b32 v58, a102
    v_accvgpr_read_b32 v59, a103
    v_mul_f32 v52, v52, v49
    v_mul_f32 v53, v53, v49
    v_mul_f32 v54, v54, v49
    v_mul_f32 v55, v55, v49
    v_mul_f32 v56, v56, v49
    v_mul_f32 v57, v57, v49
    v_mul_f32 v58, v58, v49
    v_mul_f32 v59, v59, v49
    v_accvgpr_write_b32 a96, v52
    v_accvgpr_write_b32 a97, v53
    v_accvgpr_write_b32 a98, v54
    v_accvgpr_write_b32 a99, v55
    v_accvgpr_write_b32 a100, v56
    v_accvgpr_write_b32 a101, v57
    v_accvgpr_write_b32 a102, v58
    v_accvgpr_write_b32 a103, v59
    v_accvgpr_read_b32 v52, a104
    v_accvgpr_read_b32 v53, a105
    v_accvgpr_read_b32 v54, a106
    v_accvgpr_read_b32 v55, a107
    v_accvgpr_read_b32 v56, a108
    v_accvgpr_read_b32 v57, a109
    v_accvgpr_read_b32 v58, a110
    v_accvgpr_read_b32 v59, a111
    v_mul_f32 v52, v52, v49
    v_mul_f32 v53, v53, v49
    v_mul_f32 v54, v54, v49
    v_mul_f32 v55, v55, v49
    v_mul_f32 v56, v56, v49
    v_mul_f32 v57, v57, v49
    v_mul_f32 v58, v58, v49
    v_mul_f32 v59, v59, v49
    v_accvgpr_write_b32 a104, v52
    v_accvgpr_write_b32 a105, v53
    v_accvgpr_write_b32 a106, v54
    v_accvgpr_write_b32 a107, v55
    v_accvgpr_write_b32 a108, v56
    v_accvgpr_write_b32 a109, v57
    v_accvgpr_write_b32 a110, v58
    v_accvgpr_write_b32 a111, v59
    v_accvgpr_read_b32 v52, a112
    v_accvgpr_read_b32 v53, a113
    v_accvgpr_read_b32 v54, a114
    v_accvgpr_read_b32 v55, a115
    v_accvgpr_read_b32 v56, a116
    v_accvgpr_read_b32 v57, a117
    v_accvgpr_read_b32 v58, a118
    v_accvgpr_read_b32 v59, a119
    v_mul_f32 v52, v52, v49
    v_mul_f32 v53, v53, v49
    v_mul_f32 v54, v54, v49
    v_mul_f32 v55, v55, v49
    v_mul_f32 v56, v56, v49
    v_mul_f32 v57, v57, v49
    v_mul_f32 v58, v58, v49
    v_mul_f32 v59, v59, v49
    v_accvgpr_write_b32 a112, v52
    v_accvgpr_write_b32 a113, v53
    v_accvgpr_write_b32 a114, v54
    v_accvgpr_write_b32 a115, v55
    v_accvgpr_write_b32 a116, v56
    v_accvgpr_write_b32 a117, v57
    v_accvgpr_write_b32 a118, v58
    v_accvgpr_write_b32 a119, v59
    v_accvgpr_read_b32 v52, a120
    v_accvgpr_read_b32 v53, a121
    v_accvgpr_read_b32 v54, a122
    v_accvgpr_read_b32 v55, a123
    v_accvgpr_read_b32 v56, a124
    v_accvgpr_read_b32 v57, a125
    v_accvgpr_read_b32 v58, a126
    v_accvgpr_read_b32 v59, a127
    v_mul_f32 v52, v52, v49
    v_mul_f32 v53, v53, v49
    v_mul_f32 v54, v54, v49
    v_mul_f32 v55, v55, v49
    v_mul_f32 v56, v56, v49
    v_mul_f32 v57, v57, v49
    v_mul_f32 v58, v58, v49
    v_mul_f32 v59, v59, v49
    v_accvgpr_write_b32 a120, v52
    v_accvgpr_write_b32 a121, v53
    v_accvgpr_write_b32 a122, v54
    v_accvgpr_write_b32 a123, v55
    v_accvgpr_write_b32 a124, v56
    v_accvgpr_write_b32 a125, v57
    v_accvgpr_write_b32 a126, v58
    v_accvgpr_write_b32 a127, v59
    v_exp_f32 v52, v120
    v_exp_f32 v53, v121
    v_exp_f32 v54, v122
    v_exp_f32 v55, v123
    v_exp_f32 v56, v124
    v_exp_f32 v57, v125
    v_exp_f32 v58, v126
    v_exp_f32 v59, v127
    s_nop 0
    v_cvt_pk_bf16_f32 v156, v52, v53
    v_cvt_pk_bf16_f32 v157, v54, v55
    v_cvt_pk_bf16_f32 v158, v56, v57
    v_cvt_pk_bf16_f32 v159, v58, v59
    s_nop 1
    v_mfma_f32_16x16x32_bf16 v[40:43], v[44:47], v[156:159], 0
    s_nop 7
    s_setpc_b64 s[74:75]
m_hook13:
    s_cmp_lg_u32 s16, 0
    s_cbranch_scc1 m_np37
    v_mov_b32 v4, s4
    v_mov_b32 v5, s5
    s_add_u32 s90, s17, 117440512
    s_mov_b64 exec, 1
    buffer_store_dwordx2 v[4:5], off, s[8:11], s90 sc1
    s_mov_b64 exec, -1
m_np37:
    s_mov_b32 s17, -1
    s_branch m_hookr14
m_hook17:
    s_cmp_lg_u32 s16, 0
    s_cbranch_scc1 m_np38
    v_mov_b32 v4, s4
    v_mov_b32 v5, s5
    s_add_u32 s90, s17, 117440512
    s_mov_b64 exec, 1
    buffer_store_dwordx2 v[4:5], off, s[8:11], s90 sc1
    s_mov_b64 exec, -1
m_np38:
    s_mov_b32 s17, -1
    s_branch m_hookr18
m_dosw16:
    s_cmp_eq_u32 s17, -1
    s_cbranch_scc1 m_x39
    s_cmp_lg_u32 s16, 0
    s_cbranch_scc1 m_np44
    v_mov_b32 v4, s4
    v_mov_b32 v5, s5
    s_add_u32 s90, s17, 117440512
    s_mov_b64 exec, 1
    buffer_store_dwordx2 v[4:5], off, s[8:11], s90 sc1
    s_mov_b64 exec, -1
m_np44:
    s_mov_b32 s17, -1
    s_mov_b32 s67, 3
    s_cmp_gt_u32 s65, 3
    s_cbranch_scc1 m_loop15
m_x39:
    s_cmp_eq_u32 s94, 0
    s_cbranch_scc1 m_x40
    s_mov_b32 s42, s73
    s_mov_b32 s46, s76
    s_lshl_b32 s90, s77, 4
    s_lshl_b32 s90, s90, s81
    s_mov_b32 s48, s79
    s_mul_i32 s91, s90, 1
    s_add_u32 s49, s91, s79
    s_sub_u32 s49, s49, 2048
    s_mul_i32 s91, s90, 2
    s_add_u32 s50, s91, s79
    s_mul_i32 s91, s90, 3
    s_add_u32 s51, s91, s79
    s_sub_u32 s51, s51, 2048
    s_mov_b32 s52, s80
    s_lshl_b32 s90, s78, 2
    s_mul_i32 s91, s90, 1
    s_add_u32 s53, s91, s80
    s_sub_u32 s53, s53, 2048
    s_mul_i32 s91, s90, 2
    s_add_u32 s54, s91, s80
    s_mul_i32 s91, s90, 3
    s_add_u32 s55, s91, s80
    s_sub_u32 s55, s55, 2048
    s_lshl_b32 s56, s78, 6
    s_lshl_b32 s90, s58, 7
    s_add_u32 s90, s90, s57
    s_lshl_b32 s91, s16, 6
    s_cmp_eq_u32 s81, 1
    s_cselect_b32 s90, s90, s91
    v_lshrrev_b32 v24, 3, v1
    v_lshlrev_b32 v24, s81, v24
    v_add_u32 v24, s90, v24
    v_mul_lo_u32 v24, v24, s77
    v_lshrrev_b32 v25, 4, v1
    v_and_b32 v26, 7, v1
    v_xor_b32 v25, v25, v26
    v_lshl_add_u32 v16, v25, 4, v24
    v_xor_b32 v25, 4, v25
    v_lshl_add_u32 v17, v25, 4, v24
    s_lshl_b32 s90, s77, 3
    s_lshl_b32 s90, s90, s81
    s_sub_u32 s90, s90, 1024
    v_add_u32 v17, s90, v17
    v_lshrrev_b32 v24, 5, v1
    s_lshl_b32 s90, s16, 4
    v_add_u32 v25, s90, v24
    v_mul_lo_u32 v25, v25, s78
    v_lshlrev_b32 v24, 1, v24
    v_and_b32 v26, 31, v1
    v_xor_b32 v24, v24, v26
    s_lshl_b32 s90, s78, 1
    s_sub_u32 s90, s90, 1024
    v_add_u32 v27, s90, v25
    v_xor_b32 v26, 0, v24
    v_lshl_add_u32 v18, v26, 4, v25
    v_xor_b32 v26, 4, v24
    v_lshl_add_u32 v19, v26, 4, v27
    v_xor_b32 v26, 8, v24
    v_lshl_add_u32 v20, v26, 4, v25
    v_xor_b32 v26, 12, v24
    v_lshl_add_u32 v21, v26, 4, v27
    s_mov_b32 s40, s71
    s_mov_b32 s41, s72
    s_mov_b32 s44, s74
    s_mov_b32 s45, s75
    buffer_load_dwordx2 v[4:5], off, s[12:15], 0 sc1
    s_mov_b32 s67, 0
    s_branch m_loop15
m_x40:
    s_cmp_eq_u32 s70, 1
    s_cbranch_scc1 m_x43
    s_cmp_lg_u32 s65, 3
    s_cbranch_scc1 m_x41
    s_and_b32 s92, s2, 7
    s_lshl_b32 s92, s92, 2
    s_bfe_u32 s93, s2, 0x20003
    s_add_u32 s92, s92, s93
    s_lshr_b32 s93, s2, 5
    s_lshl_b32 s93, s93, 2
    s_or_b32 s93, s93, 0x40000
    s_lshr_b32 s90, s92, 1
    s_lshl_b32 s90, s90, 7
    s_add_u32 s90, s90, 117440512
    v_and_b32 v0, 3, v1
    v_min_u32 v0, 2, v0
    v_and_b32 v4, 4, v1
    v_add3_u32 v0, v0, v4, 8
    v_lshlrev_b32 v0, 3, v0
    buffer_load_dwordx2 v[4:5], v0, s[8:11], s90 offen sc1
    s_branch m_loop15
m_x41:
    s_waitcnt vmcnt(16)
    s_cmp_lg_u32 s65, 2
    s_cbranch_scc1 m_x42
    s_mov_b32 s3, 1048576
m_spin45:
    v_cmp_ne_u64 s[22:23], s[4:5], v[4:5]
    s_nop 3
    s_cmp_eq_u64 s[22:23], 0
    s_cbranch_scc1 m_ok46
    s_sub_u32 s3, s3, 1
    s_cbranch_scc1 m_ok46
    s_sleep 16
    s_and_b32 s92, s2, 7
    s_lshl_b32 s92, s92, 2
    s_bfe_u32 s93, s2, 0x20003
    s_add_u32 s92, s92, s93
    s_lshr_b32 s93, s2, 5
    s_lshl_b32 s93, s93, 2
    s_or_b32 s93, s93, 0x40000
    s_lshr_b32 s90, s92, 1
    s_lshl_b32 s90, s90, 7
    s_add_u32 s90, s90, 117440512
    v_and_b32 v0, 3, v1
    v_min_u32 v0, 2, v0
    v_and_b32 v4, 4, v1
    v_add3_u32 v0, v0, v4, 8
    v_lshlrev_b32 v0, 3, v0
    buffer_load_dwordx2 v[4:5], v0, s[8:11], s90 offen sc1
    s_waitcnt vmcnt(0)
    s_branch m_spin45
m_ok46:
    s_and_b32 s92, s2, 7
    s_lshl_b32 s92, s92, 2
    s_bfe_u32 s93, s2, 0x20003
    s_add_u32 s92, s92, s93
    s_lshr_b32 s93, s2, 5
    s_lshl_b32 s93, s93, 2
    s_or_b32 s93, s93, 0x40000
    s_lshr_b32 s90, s92, 1
    s_lshl_b32 s90, s90, 7
    s_add_u32 s90, s90, 117440512
    s_bfe_u32 s91, 873473623, s93
    s_lshr_b32 s91, s91, 1
    v_mov_b32 v0, s91
    s_bfe_u32 s91, 4225681832, s93
    s_lshr_b32 s91, s91, 1
    v_writelane_b32 v0, s91, 8
    v_lshlrev_b32 v0, 3, v0
    buffer_load_dwordx2 v[4:5], v0, s[8:11], s90 offen sc1
    s_lshl_b32 s90, s92, 19
    s_lshl_b32 s91, s58, 13
    s_add_u32 s90, s90, s91
    s_cmp_eq_u32 s57, 0
    s_mov_b32 s91, 33554432
    s_cselect_b32 s91, 16777216, s91
    s_mov_b32 s42, 0
    s_cselect_b32 s42, 268435456, s42
    s_add_u32 s48, s90, s91
    s_mov_b32 s49, s48
    s_add_u32 s50, s48, 4096
    s_mov_b32 s51, s50
    s_mov_b32 s40, s6
    s_mov_b32 s41, s7
    s_lshl_b32 s90, s92, 19
    s_lshl_b32 s91, s58, 13
    s_add_u32 s90, s90, s91
    s_cmp_eq_u32 s57, 0
    s_mov_b32 s91, 33587200
    s_cselect_b32 s91, 16826368, s91
    s_mov_b32 s46, 268435456
    s_cselect_b32 s46, 268435456, s46
    s_add_u32 s52, s90, s91
    s_mov_b32 s53, s52
    s_add_u32 s54, s52, 4096
    s_mov_b32 s55, s54
    s_mov_b32 s44, s6
    s_mov_b32 s45, s7
    v_mov_b32 v16, v2
    v_mov_b32 v17, v2
    v_mov_b32 v18, v2
    v_mov_b32 v19, v2
    v_mov_b32 v20, v2
    v_mov_b32 v21, v2
    s_branch m_loop15
m_x42:
    s_mov_b32 s3, 1048576
m_spin47:
    v_cmp_ne_u64 s[22:23], s[4:5], v[4:5]
    s_nop 3
    s_cmp_eq_u64 s[22:23], 0
    s_cbranch_scc1 m_ok48
    s_sub_u32 s3, s3, 1
    s_cbranch_scc1 m_ok48
    s_sleep 16
    s_and_b32 s92, s2, 7
    s_lshl_b32 s92, s92, 2
    s_bfe_u32 s93, s2, 0x20003
    s_add_u32 s92, s92, s93
    s_lshr_b32 s93, s2, 5
    s_lshl_b32 s93, s93, 2
    s_or_b32 s93, s93, 0x40000
    s_lshr_b32 s90, s92, 1
    s_lshl_b32 s90, s90, 7
    s_add_u32 s90, s90, 117440512
    s_bfe_u32 s91, 873473623, s93
    s_lshr_b32 s91, s91, 1
    v_mov_b32 v0, s91
    s_bfe_u32 s91, 4225681832, s93
    s_lshr_b32 s91, s91, 1
    v_writelane_b32 v0, s91, 8
    v_lshlrev_b32 v0, 3, v0
    buffer_load_dwordx2 v[4:5], v0, s[8:11], s90 offen sc1
    s_waitcnt vmcnt(0)
    s_branch m_spin47
m_ok48:
    s_and_b32 s92, s2, 7
    s_lshl_b32 s92, s92, 2
    s_bfe_u32 s93, s2, 0x20003
    s_add_u32 s92, s92, s93
    s_lshr_b32 s93, s2, 5
    s_lshl_b32 s93, s93, 2
    s_or_b32 s93, s93, 0x40000
    s_bfe_u32 s90, 4225681832, s93
    s_lshl_b32 s90, s90, 3
    s_lshl_b32 s91, s16, 1
    s_add_u32 s90, s90, s91
    s_lshl_b32 s90, s90, 12
    s_lshl_b32 s91, s92, 19
    s_add_u32 s90, s90, s91
    s_add_u32 s90, s90, 0
    buffer_load_dwordx4 a[128:131], v2, s[8:11], s90 offen offset:0 sc1
    buffer_load_dwordx4 a[132:135], v2, s[8:11], s90 offen offset:1024 sc1
    buffer_load_dwordx4 a[136:139], v2, s[8:11], s90 offen offset:2048 sc1
    buffer_load_dwordx4 a[140:143], v2, s[8:11], s90 offen offset:3072 sc1
    s_bfe_u32 s90, 4225681832, s93
    s_lshl_b32 s90, s90, 3
    s_lshl_b32 s91, s16, 1
    s_add_u32 s90, s90, s91
    s_lshl_b32 s90, s90, 12
    s_lshl_b32 s91, s92, 19
    s_add_u32 s90, s90, s91
    s_add_u32 s90, s90, 4096
    buffer_load_dwordx4 a[144:147], v2, s[8:11], s90 offen offset:0 sc1
    buffer_load_dwordx4 a[148:151], v2, s[8:11], s90 offen offset:1024 sc1
    buffer_load_dwordx4 a[152:155], v2, s[8:11], s90 offen offset:2048 sc1
    buffer_load_dwordx4 a[156:159], v2, s[8:11], s90 offen offset:3072 sc1
    s_bfe_u32 s90, 873473623, s93
    s_lshl_b32 s90, s90, 3
    s_lshl_b32 s91, s16, 1
    s_add_u32 s90, s90, s91
    s_lshl_b32 s90, s90, 12
    s_lshl_b32 s91, s92, 19
    s_add_u32 s90, s90, s91
    s_add_u32 s90, s90, 0
    buffer_load_dwordx4 a[160:163], v2, s[8:11], s90 offen offset:0 sc1
    buffer_load_dwordx4 a[164:167], v2, s[8:11], s90 offen offset:1024 sc1
    buffer_load_dwordx4 a[168:171], v2, s[8:11], s90 offen offset:2048 sc1
    buffer_load_dwordx4 a[172:175], v2, s[8:11], s90 offen offset:3072 sc1
    s_bfe_u32 s90, 873473623, s93
    s_lshl_b32 s90, s90, 3
    s_lshl_b32 s91, s16, 1
    s_add_u32 s90, s90, s91
    s_lshl_b32 s90, s90, 12
    s_lshl_b32 s91, s92, 19
    s_add_u32 s90, s90, s91
    s_add_u32 s90, s90, 4096
    buffer_load_dwordx4 a[176:179], v2, s[8:11], s90 offen offset:0 sc1
    buffer_load_dwordx4 a[180:183], v2, s[8:11], s90 offen offset:1024 sc1
    buffer_load_dwordx4 a[184:187], v2, s[8:11], s90 offen offset:2048 sc1
    buffer_load_dwordx4 a[188:191], v2, s[8:11], s90 offen offset:3072 sc1
    s_lshl_b32 s90, s92, 19
    s_lshl_b32 s91, s58, 13
    s_add_u32 s90, s90, s91
    s_cmp_eq_u32 s57, 0
    s_mov_b32 s91, 33554432
    s_cselect_b32 s91, 16793600, s91
    s_mov_b32 s42, 268435456
    s_cselect_b32 s42, 268435456, s42
    s_add_u32 s48, s90, s91
    s_mov_b32 s49, s48
    s_add_u32 s50, s48, 4096
    s_mov_b32 s51, s50
    s_mov_b32 s40, s6
    s_mov_b32 s41, s7
    s_mov_b32 s46, 0
    s_branch m_loop15
m_x43:
    s_mov_b32 s42, 0
    s_mov_b32 s46, 0
    s_branch m_loop15
m_dosw20:
    s_cmp_eq_u32 s17, -1
    s_cbranch_scc1 m_x49
    s_cmp_lg_u32 s16, 0
    s_cbranch_scc1 m_np54
    v_mov_b32 v4, s4
    v_mov_b32 v5, s5
    s_add_u32 s90, s17, 117440512
    s_mov_b64 exec, 1
    buffer_store_dwordx2 v[4:5], off, s[8:11], s90 sc1
    s_mov_b64 exec, -1
m_np54:
    s_mov_b32 s17, -1
    s_mov_b32 s67, 3
    s_cmp_gt_u32 s65, 3
    s_cbranch_scc1 m_loop19
m_x49:
    s_cmp_eq_u32 s94, 0
    s_cbranch_scc1 m_x50
    s_mov_b32 s42, s73
    s_mov_b32 s46, s76
    s_lshl_b32 s90, s77, 4
    s_lshl_b32 s90, s90, s81
    s_mov_b32 s48, s79
    s_mul_i32 s91, s90, 1
    s_add_u32 s49, s91, s79
    s_sub_u32 s49, s49, 2048
    s_mul_i32 s91, s90, 2
    s_add_u32 s50, s91, s79
    s_mul_i32 s91, s90, 3
    s_add_u32 s51, s91, s79
    s_sub_u32 s51, s51, 2048
    s_mov_b32 s52, s80
    s_lshl_b32 s90, s78, 2
    s_mul_i32 s91, s90, 1
    s_add_u32 s53, s91, s80
    s_sub_u32 s53, s53, 2048
    s_mul_i32 s91, s90, 2
    s_add_u32 s54, s91, s80
    s_mul_i32 s91, s90, 3
    s_add_u32 s55, s91, s80
    s_sub_u32 s55, s55, 2048
    s_lshl_b32 s56, s78, 6
    s_lshl_b32 s90, s58, 7
    s_add_u32 s90, s90, s57
    s_lshl_b32 s91, s16, 6
    s_cmp_eq_u32 s81, 1
    s_cselect_b32 s90, s90, s91
    v_lshrrev_b32 v24, 3, v1
    v_lshlrev_b32 v24, s81, v24
    v_add_u32 v24, s90, v24
    v_mul_lo_u32 v24, v24, s77
    v_lshrrev_b32 v25, 4, v1
    v_and_b32 v26, 7, v1
    v_xor_b32 v25, v25, v26
    v_lshl_add_u32 v16, v25, 4, v24
    v_xor_b32 v25, 4, v25
    v_lshl_add_u32 v17, v25, 4, v24
    s_lshl_b32 s90, s77, 3
    s_lshl_b32 s90, s90, s81
    s_sub_u32 s90, s90, 1024
    v_add_u32 v17, s90, v17
    v_lshrrev_b32 v24, 5, v1
    s_lshl_b32 s90, s16, 4
    v_add_u32 v25, s90, v24
    v_mul_lo_u32 v25, v25, s78
    v_lshlrev_b32 v24, 1, v24
    v_and_b32 v26, 31, v1
    v_xor_b32 v24, v24, v26
    s_lshl_b32 s90, s78, 1
    s_sub_u32 s90, s90, 1024
    v_add_u32 v27, s90, v25
    v_xor_b32 v26, 0, v24
    v_lshl_add_u32 v18, v26, 4, v25
    v_xor_b32 v26, 4, v24
    v_lshl_add_u32 v19, v26, 4, v27
    v_xor_b32 v26, 8, v24
    v_lshl_add_u32 v20, v26, 4, v25
    v_xor_b32 v26, 12, v24
    v_lshl_add_u32 v21, v26, 4, v27
    s_mov_b32 s40, s71
    s_mov_b32 s41, s72
    s_mov_b32 s44, s74
    s_mov_b32 s45, s75
    buffer_load_dwordx2 v[4:5], off, s[12:15], 0 sc1
    s_mov_b32 s67, 0
    s_branch m_loop19
m_x50:
    s_cmp_eq_u32 s70, 1
    s_cbranch_scc1 m_x53
    s_cmp_lg_u32 s65, 3
    s_cbranch_scc1 m_x51
    s_and_b32 s92, s2, 7
    s_lshl_b32 s92, s92, 2
    s_bfe_u32 s93, s2, 0x20003
    s_add_u32 s92, s92, s93
    s_lshr_b32 s93, s2, 5
    s_lshl_b32 s93, s93, 2
    s_or_b32 s93, s93, 0x40000
    s_lshr_b32 s90, s92, 1
    s_lshl_b32 s90, s90, 7
    s_add_u32 s90, s90, 117440512
    v_and_b32 v0, 3, v1
    v_min_u32 v0, 2, v0
    v_and_b32 v4, 4, v1
    v_add3_u32 v0, v0, v4, 8
    v_lshlrev_b32 v0, 3, v0
    buffer_load_dwordx2 v[4:5], v0, s[8:11], s90 offen sc1
    s_branch m_loop19
m_x51:
    s_waitcnt vmcnt(16)
    s_cmp_lg_u32 s65, 2
    s_cbranch_scc1 m_x52
    s_mov_b32 s3, 1048576
m_spin55:
    v_cmp_ne_u64 s[22:23], s[4:5], v[4:5]
    s_nop 3
    s_cmp_eq_u64 s[22:23], 0
    s_cbranch_scc1 m_ok56
    s_sub_u32 s3, s3, 1
    s_cbranch_scc1 m_ok56
    s_sleep 16
    s_and_b32 s92, s2, 7
    s_lshl_b32 s92, s92, 2
    s_bfe_u32 s93, s2, 0x20003
    s_add_u32 s92, s92, s93
    s_lshr_b32 s93, s2, 5
    s_lshl_b32 s93, s93, 2
    s_or_b32 s93, s93, 0x40000
    s_lshr_b32 s90, s92, 1
    s_lshl_b32 s90, s90, 7
    s_add_u32 s90, s90, 117440512
    v_and_b32 v0, 3, v1
    v_min_u32 v0, 2, v0
    v_and_b32 v4, 4, v1
    v_add3_u32 v0, v0, v4, 8
    v_lshlrev_b32 v0, 3, v0
    buffer_load_dwordx2 v[4:5], v0, s[8:11], s90 offen sc1
    s_waitcnt vmcnt(0)
    s_branch m_spin55
m_ok56:
    s_and_b32 s92, s2, 7
    s_lshl_b32 s92, s92, 2
    s_bfe_u32 s93, s2, 0x20003
    s_add_u32 s92, s92, s93
    s_lshr_b32 s93, s2, 5
    s_lshl_b32 s93, s93, 2
    s_or_b32 s93, s93, 0x40000
    s_lshr_b32 s90, s92, 1
    s_lshl_b32 s90, s90, 7
    s_add_u32 s90, s90, 117440512
    s_bfe_u32 s91, 873473623, s93
    s_lshr_b32 s91, s91, 1
    v_mov_b32 v0, s91
    s_bfe_u32 s91, 4225681832, s93
    s_lshr_b32 s91, s91, 1
    v_writelane_b32 v0, s91, 8
    v_lshlrev_b32 v0, 3, v0
    buffer_load_dwordx2 v[4:5], v0, s[8:11], s90 offen sc1
    s_lshl_b32 s90, s92, 19
    s_lshl_b32 s91, s58, 13
    s_add_u32 s90, s90, s91
    s_cmp_eq_u32 s57, 0
    s_mov_b32 s91, 33554432
    s_cselect_b32 s91, 16777216, s91
    s_mov_b32 s42, 0
    s_cselect_b32 s42, 268435456, s42
    s_add_u32 s48, s90, s91
    s_mov_b32 s49, s48
    s_add_u32 s50, s48, 4096
    s_mov_b32 s51, s50
    s_mov_b32 s40, s6
    s_mov_b32 s41, s7
    s_lshl_b32 s90, s92, 19
    s_lshl_b32 s91, s58, 13
    s_add_u32 s90, s90, s91
    s_cmp_eq_u32 s57, 0
    s_mov_b32 s91, 33587200
    s_cselect_b32 s91, 16826368, s91
    s_mov_b32 s46, 268435456
    s_cselect_b32 s46, 268435456, s46
    s_add_u32 s52, s90, s91
    s_mov_b32 s53, s52
    s_add_u32 s54, s52, 4096
    s_mov_b32 s55, s54
    s_mov_b32 s44, s6
    s_mov_b32 s45, s7
    v_mov_b32 v16, v2
    v_mov_b32 v17, v2
    v_mov_b32 v18, v2
    v_mov_b32 v19, v2
    v_mov_b32 v20, v2
    v_mov_b32 v21, v2
    s_branch m_loop19
m_x52:
    s_mov_b32 s3, 1048576
m_spin57:
    v_cmp_ne_u64 s[22:23], s[4:5], v[4:5]
    s_nop 3
    s_cmp_eq_u64 s[22:23], 0
    s_cbranch_scc1 m_ok58
    s_sub_u32 s3, s3, 1
    s_cbranch_scc1 m_ok58
    s_sleep 16
    s_and_b32 s92, s2, 7
    s_lshl_b32 s92, s92, 2
    s_bfe_u32 s93, s2, 0x20003
    s_add_u32 s92, s92, s93
    s_lshr_b32 s93, s2, 5
    s_lshl_b32 s93, s93, 2
    s_or_b32 s93, s93, 0x40000
    s_lshr_b32 s90, s92, 1
    s_lshl_b32 s90, s90, 7
    s_add_u32 s90, s90, 117440512
    s_bfe_u32 s91, 873473623, s93
    s_lshr_b32 s91, s91, 1
    v_mov_b32 v0, s91
    s_bfe_u32 s91, 4225681832, s93
    s_lshr_b32 s91, s91, 1
    v_writelane_b32 v0, s91, 8
    v_lshlrev_b32 v0, 3, v0
    buffer_load_dwordx2 v[4:5], v0, s[8:11], s90 offen sc1
    s_waitcnt vmcnt(0)
    s_branch m_spin57
m_ok58:
    s_and_b32 s92, s2, 7
    s_lshl_b32 s92, s92, 2
    s_bfe_u32 s93, s2, 0x20003
    s_add_u32 s92, s92, s93
    s_lshr_b32 s93, s2, 5
    s_lshl_b32 s93, s93, 2
    s_or_b32 s93, s93, 0x40000
    s_bfe_u32 s90, 4225681832, s93
    s_lshl_b32 s90, s90, 3
    s_lshl_b32 s91, s16, 1
    s_add_u32 s90, s90, s91
    s_lshl_b32 s90, s90, 12
    s_lshl_b32 s91, s92, 19
    s_add_u32 s90, s90, s91
    s_add_u32 s90, s90, 0
    buffer_load_dwordx4 a[128:131], v2, s[8:11], s90 offen offset:0 sc1
    buffer_load_dwordx4 a[132:135], v2, s[8:11], s90 offen offset:1024 sc1
    buffer_load_dwordx4 a[136:139], v2, s[8:11], s90 offen offset:2048 sc1
    buffer_load_dwordx4 a[140:143], v2, s[8:11], s90 offen offset:3072 sc1
    s_bfe_u32 s90, 4225681832, s93
    s_lshl_b32 s90, s90, 3
    s_lshl_b32 s91, s16, 1
    s_add_u32 s90, s90, s91
    s_lshl_b32 s90, s90, 12
    s_lshl_b32 s91, s92, 19
    s_add_u32 s90, s90, s91
    s_add_u32 s90, s90, 4096
    buffer_load_dwordx4 a[144:147], v2, s[8:11], s90 offen offset:0 sc1
    buffer_load_dwordx4 a[148:151], v2, s[8:11], s90 offen offset:1024 sc1
    buffer_load_dwordx4 a[152:155], v2, s[8:11], s90 offen offset:2048 sc1
    buffer_load_dwordx4 a[156:159], v2, s[8:11], s90 offen offset:3072 sc1
    s_bfe_u32 s90, 873473623, s93
    s_lshl_b32 s90, s90, 3
    s_lshl_b32 s91, s16, 1
    s_add_u32 s90, s90, s91
    s_lshl_b32 s90, s90, 12
    s_lshl_b32 s91, s92, 19
    s_add_u32 s90, s90, s91
    s_add_u32 s90, s90, 0
    buffer_load_dwordx4 a[160:163], v2, s[8:11], s90 offen offset:0 sc1
    buffer_load_dwordx4 a[164:167], v2, s[8:11], s90 offen offset:1024 sc1
    buffer_load_dwordx4 a[168:171], v2, s[8:11], s90 offen offset:2048 sc1
    buffer_load_dwordx4 a[172:175], v2, s[8:11], s90 offen offset:3072 sc1
    s_bfe_u32 s90, 873473623, s93
    s_lshl_b32 s90, s90, 3
    s_lshl_b32 s91, s16, 1
    s_add_u32 s90, s90, s91
    s_lshl_b32 s90, s90, 12
    s_lshl_b32 s91, s92, 19
    s_add_u32 s90, s90, s91
    s_add_u32 s90, s90, 4096
    buffer_load_dwordx4 a[176:179], v2, s[8:11], s90 offen offset:0 sc1
    buffer_load_dwordx4 a[180:183], v2, s[8:11], s90 offen offset:1024 sc1
    buffer_load_dwordx4 a[184:187], v2, s[8:11], s90 offen offset:2048 sc1
    buffer_load_dwordx4 a[188:191], v2, s[8:11], s90 offen offset:3072 sc1
    s_lshl_b32 s90, s92, 19
    s_lshl_b32 s91, s58, 13
    s_add_u32 s90, s90, s91
    s_cmp_eq_u32 s57, 0
    s_mov_b32 s91, 33554432
    s_cselect_b32 s91, 16793600, s91
    s_mov_b32 s42, 268435456
    s_cselect_b32 s42, 268435456, s42
    s_add_u32 s48, s90, s91
    s_mov_b32 s49, s48
    s_add_u32 s50, s48, 4096
    s_mov_b32 s51, s50
    s_mov_b32 s40, s6
    s_mov_b32 s41, s7
    s_mov_b32 s46, 0
    s_branch m_loop19
m_x53:
    s_mov_b32 s42, 0
    s_mov_b32 s46, 0
    s_branch m_loop19
m_eps22:
    s_mov_b32 s92, s97
    s_mov_b32 s93, s97
    s_cmp_eq_u32 s97, 0
    s_cbranch_scc1 m_ns359
    v_pk_mul_f32 v[32:33], v[32:33], s[92:93]
    v_pk_mul_f32 v[34:35], v[34:35], s[92:93]
    v_pk_mul_f32 v[36:37], v[36:37], s[92:93]
    v_pk_mul_f32 v[38:39], v[38:39], s[92:93]
    v_cvt_pk_bf16_f32 v32, v32, v33
    v_cvt_pk_bf16_f32 v33, v34, v35
    v_cvt_pk_bf16_f32 v34, v36, v37
    v_cvt_pk_bf16_f32 v35, v38, v39
    v_accvgpr_write_b32 a128, v32
    v_accvgpr_write_b32 a129, v33
    v_accvgpr_write_b32 a130, v34
    v_accvgpr_write_b32 a131, v35
    v_pk_mul_f32 v[40:41], v[40:41], s[92:93]
    v_pk_mul_f32 v[42:43], v[42:43], s[92:93]
    v_pk_mul_f32 v[44:45], v[44:45], s[92:93]
    v_pk_mul_f32 v[46:47], v[46:47], s[92:93]
    v_cvt_pk_bf16_f32 v40, v40, v41
    v_cvt_pk_bf16_f32 v41, v42, v43
    v_cvt_pk_bf16_f32 v42, v44, v45
    v_cvt_pk_bf16_f32 v43, v46, v47
    v_accvgpr_write_b32 a132, v40
    v_accvgpr_write_b32 a133, v41
    v_accvgpr_write_b32 a134, v42
    v_accvgpr_write_b32 a135, v43
    v_pk_mul_f32 v[48:49], v[48:49], s[92:93]
    v_pk_mul_f32 v[50:51], v[50:51], s[92:93]
    v_pk_mul_f32 v[52:53], v[52:53], s[92:93]
    v_pk_mul_f32 v[54:55], v[54:55], s[92:93]
    v_cvt_pk_bf16_f32 v48, v48, v49
    v_cvt_pk_bf16_f32 v49, v50, v51
    v_cvt_pk_bf16_f32 v50, v52, v53
    v_cvt_pk_bf16_f32 v51, v54, v55
    v_accvgpr_write_b32 a136, v48
    v_accvgpr_write_b32 a137, v49
    v_accvgpr_write_b32 a138, v50
    v_accvgpr_write_b32 a139, v51
    v_pk_mul_f32 v[56:57], v[56:57], s[92:93]
    v_pk_mul_f32 v[58:59], v[58:59], s[92:93]
    v_pk_mul_f32 v[60:61], v[60:61], s[92:93]
    v_pk_mul_f32 v[62:63], v[62:63], s[92:93]
    v_cvt_pk_bf16_f32 v56, v56, v57
    v_cvt_pk_bf16_f32 v57, v58, v59
    v_cvt_pk_bf16_f32 v58, v60, v61
    v_cvt_pk_bf16_f32 v59, v62, v63
    v_accvgpr_write_b32 a140, v56
    v_accvgpr_write_b32 a141, v57
    v_accvgpr_write_b32 a142, v58
    v_accvgpr_write_b32 a143, v59
    v_pk_mul_f32 v[64:65], v[64:65], s[92:93]
    v_pk_mul_f32 v[66:67], v[66:67], s[92:93]
    v_pk_mul_f32 v[68:69], v[68:69], s[92:93]
    v_pk_mul_f32 v[70:71], v[70:71], s[92:93]
    v_cvt_pk_bf16_f32 v64, v64, v65
    v_cvt_pk_bf16_f32 v65, v66, v67
    v_cvt_pk_bf16_f32 v66, v68, v69
    v_cvt_pk_bf16_f32 v67, v70, v71
    v_accvgpr_write_b32 a144, v64
    v_accvgpr_write_b32 a145, v65
    v_accvgpr_write_b32 a146, v66
    v_accvgpr_write_b32 a147, v67
    v_pk_mul_f32 v[72:73], v[72:73], s[92:93]
    v_pk_mul_f32 v[74:75], v[74:75], s[92:93]
    v_pk_mul_f32 v[76:77], v[76:77], s[92:93]
    v_pk_mul_f32 v[78:79], v[78:79], s[92:93]
    v_cvt_pk_bf16_f32 v72, v72, v73
    v_cvt_pk_bf16_f32 v73, v74, v75
    v_cvt_pk_bf16_f32 v74, v76, v77
    v_cvt_pk_bf16_f32 v75, v78, v79
    v_accvgpr_write_b32 a148, v72
    v_accvgpr_write_b32 a149, v73
    v_accvgpr_write_b32 a150, v74
    v_accvgpr_write_b32 a151, v75
    v_pk_mul_f32 v[80:81], v[80:81], s[92:93]
    v_pk_mul_f32 v[82:83], v[82:83], s[92:93]
    v_pk_mul_f32 v[84:85], v[84:85], s[92:93]
    v_pk_mul_f32 v[86:87], v[86:87], s[92:93]
    v_cvt_pk_bf16_f32 v80, v80, v81
    v_cvt_pk_bf16_f32 v81, v82, v83
    v_cvt_pk_bf16_f32 v82, v84, v85
    v_cvt_pk_bf16_f32 v83, v86, v87
    v_accvgpr_write_b32 a152, v80
    v_accvgpr_write_b32 a153, v81
    v_accvgpr_write_b32 a154, v82
    v_accvgpr_write_b32 a155, v83
    v_pk_mul_f32 v[88:89], v[88:89], s[92:93]
    v_pk_mul_f32 v[90:91], v[90:91], s[92:93]
    v_pk_mul_f32 v[92:93], v[92:93], s[92:93]
    v_pk_mul_f32 v[94:95], v[94:95], s[92:93]
    v_cvt_pk_bf16_f32 v88, v88, v89
    v_cvt_pk_bf16_f32 v89, v90, v91
    v_cvt_pk_bf16_f32 v90, v92, v93
    v_cvt_pk_bf16_f32 v91, v94, v95
    v_accvgpr_write_b32 a156, v88
    v_accvgpr_write_b32 a157, v89
    v_accvgpr_write_b32 a158, v90
    v_accvgpr_write_b32 a159, v91
    v_pk_mul_f32 v[96:97], v[96:97], s[92:93]
    v_pk_mul_f32 v[98:99], v[98:99], s[92:93]
    v_pk_mul_f32 v[100:101], v[100:101], s[92:93]
    v_pk_mul_f32 v[102:103], v[102:103], s[92:93]
    v_cvt_pk_bf16_f32 v96, v96, v97
    v_cvt_pk_bf16_f32 v97, v98, v99
    v_cvt_pk_bf16_f32 v98, v100, v101
    v_cvt_pk_bf16_f32 v99, v102, v103
    v_accvgpr_write_b32 a160, v96
    v_accvgpr_write_b32 a161, v97
    v_accvgpr_write_b32 a162, v98
    v_accvgpr_write_b32 a163, v99
    v_pk_mul_f32 v[104:105], v[104:105], s[92:93]
    v_pk_mul_f32 v[106:107], v[106:107], s[92:93]
    v_pk_mul_f32 v[108:109], v[108:109], s[92:93]
    v_pk_mul_f32 v[110:111], v[110:111], s[92:93]
    v_cvt_pk_bf16_f32 v104, v104, v105
    v_cvt_pk_bf16_f32 v105, v106, v107
    v_cvt_pk_bf16_f32 v106, v108, v109
    v_cvt_pk_bf16_f32 v107, v110, v111
    v_accvgpr_write_b32 a164, v104
    v_accvgpr_write_b32 a165, v105
    v_accvgpr_write_b32 a166, v106
    v_accvgpr_write_b32 a167, v107
    v_pk_mul_f32 v[112:113], v[112:113], s[92:93]
    v_pk_mul_f32 v[114:115], v[114:115], s[92:93]
    v_pk_mul_f32 v[116:117], v[116:117], s[92:93]
    v_pk_mul_f32 v[118:119], v[118:119], s[92:93]
    v_cvt_pk_bf16_f32 v112, v112, v113
    v_cvt_pk_bf16_f32 v113, v114, v115
    v_cvt_pk_bf16_f32 v114, v116, v117
    v_cvt_pk_bf16_f32 v115, v118, v119
    v_accvgpr_write_b32 a168, v112
    v_accvgpr_write_b32 a169, v113
    v_accvgpr_write_b32 a170, v114
    v_accvgpr_write_b32 a171, v115
    v_pk_mul_f32 v[120:121], v[120:121], s[92:93]
    v_pk_mul_f32 v[122:123], v[122:123], s[92:93]
    v_pk_mul_f32 v[124:125], v[124:125], s[92:93]
    v_pk_mul_f32 v[126:127], v[126:127], s[92:93]
    v_cvt_pk_bf16_f32 v120, v120, v121
    v_cvt_pk_bf16_f32 v121, v122, v123
    v_cvt_pk_bf16_f32 v122, v124, v125
    v_cvt_pk_bf16_f32 v123, v126, v127
    v_accvgpr_write_b32 a172, v120
    v_accvgpr_write_b32 a173, v121
    v_accvgpr_write_b32 a174, v122
    v_accvgpr_write_b32 a175, v123
    v_pk_mul_f32 v[128:129], v[128:129], s[92:93]
    v_pk_mul_f32 v[130:131], v[130:131], s[92:93]
    v_pk_mul_f32 v[132:133], v[132:133], s[92:93]
    v_pk_mul_f32 v[134:135], v[134:135], s[92:93]
    v_cvt_pk_bf16_f32 v128, v128, v129
    v_cvt_pk_bf16_f32 v129, v130, v131
    v_cvt_pk_bf16_f32 v130, v132, v133
    v_cvt_pk_bf16_f32 v131, v134, v135
    v_accvgpr_write_b32 a176, v128
    v_accvgpr_write_b32 a177, v129
    v_accvgpr_write_b32 a178, v130
    v_accvgpr_write_b32 a179, v131
    v_pk_mul_f32 v[136:137], v[136:137], s[92:93]
    v_pk_mul_f32 v[138:139], v[138:139], s[92:93]
    v_pk_mul_f32 v[140:141], v[140:141], s[92:93]
    v_pk_mul_f32 v[142:143], v[142:143], s[92:93]
    v_cvt_pk_bf16_f32 v136, v136, v137
    v_cvt_pk_bf16_f32 v137, v138, v139
    v_cvt_pk_bf16_f32 v138, v140, v141
    v_cvt_pk_bf16_f32 v139, v142, v143
    v_accvgpr_write_b32 a180, v136
    v_accvgpr_write_b32 a181, v137
    v_accvgpr_write_b32 a182, v138
    v_accvgpr_write_b32 a183, v139
    v_pk_mul_f32 v[144:145], v[144:145], s[92:93]
    v_pk_mul_f32 v[146:147], v[146:147], s[92:93]
    v_pk_mul_f32 v[148:149], v[148:149], s[92:93]
    v_pk_mul_f32 v[150:151], v[150:151], s[92:93]
    v_cvt_pk_bf16_f32 v144, v144, v145
    v_cvt_pk_bf16_f32 v145, v146, v147
    v_cvt_pk_bf16_f32 v146, v148, v149
    v_cvt_pk_bf16_f32 v147, v150, v151
    v_accvgpr_write_b32 a184, v144
    v_accvgpr_write_b32 a185, v145
    v_accvgpr_write_b32 a186, v146
    v_accvgpr_write_b32 a187, v147
    v_pk_mul_f32 v[152:153], v[152:153], s[92:93]
    v_pk_mul_f32 v[154:155], v[154:155], s[92:93]
    v_pk_mul_f32 v[156:157], v[156:157], s[92:93]
    v_pk_mul_f32 v[158:159], v[158:159], s[92:93]
    v_cvt_pk_bf16_f32 v152, v152, v153
    v_cvt_pk_bf16_f32 v153, v154, v155
    v_cvt_pk_bf16_f32 v154, v156, v157
    v_cvt_pk_bf16_f32 v155, v158, v159
    v_accvgpr_write_b32 a188, v152
    v_accvgpr_write_b32 a189, v153
    v_accvgpr_write_b32 a190, v154
    v_accvgpr_write_b32 a191, v155
    v_pk_mul_f32 v[160:161], v[160:161], s[92:93]
    v_pk_mul_f32 v[162:163], v[162:163], s[92:93]
    v_pk_mul_f32 v[164:165], v[164:165], s[92:93]
    v_pk_mul_f32 v[166:167], v[166:167], s[92:93]
    v_cvt_pk_bf16_f32 v160, v160, v161
    v_cvt_pk_bf16_f32 v161, v162, v163
    v_cvt_pk_bf16_f32 v162, v164, v165
    v_cvt_pk_bf16_f32 v163, v166, v167
    v_accvgpr_write_b32 a192, v160
    v_accvgpr_write_b32 a193, v161
    v_accvgpr_write_b32 a194, v162
    v_accvgpr_write_b32 a195, v163
    v_pk_mul_f32 v[168:169], v[168:169], s[92:93]
    v_pk_mul_f32 v[170:171], v[170:171], s[92:93]
    v_pk_mul_f32 v[172:173], v[172:173], s[92:93]
    v_pk_mul_f32 v[174:175], v[174:175], s[92:93]
    v_cvt_pk_bf16_f32 v168, v168, v169
    v_cvt_pk_bf16_f32 v169, v170, v171
    v_cvt_pk_bf16_f32 v170, v172, v173
    v_cvt_pk_bf16_f32 v171, v174, v175
    v_accvgpr_write_b32 a196, v168
    v_accvgpr_write_b32 a197, v169
    v_accvgpr_write_b32 a198, v170
    v_accvgpr_write_b32 a199, v171
    v_pk_mul_f32 v[176:177], v[176:177], s[92:93]
    v_pk_mul_f32 v[178:179], v[178:179], s[92:93]
    v_pk_mul_f32 v[180:181], v[180:181], s[92:93]
    v_pk_mul_f32 v[182:183], v[182:183], s[92:93]
    v_cvt_pk_bf16_f32 v176, v176, v177
    v_cvt_pk_bf16_f32 v177, v178, v179
    v_cvt_pk_bf16_f32 v178, v180, v181
    v_cvt_pk_bf16_f32 v179, v182, v183
    v_accvgpr_write_b32 a200, v176
    v_accvgpr_write_b32 a201, v177
    v_accvgpr_write_b32 a202, v178
    v_accvgpr_write_b32 a203, v179
    v_pk_mul_f32 v[184:185], v[184:185], s[92:93]
    v_pk_mul_f32 v[186:187], v[186:187], s[92:93]
    v_pk_mul_f32 v[188:189], v[188:189], s[92:93]
    v_pk_mul_f32 v[190:191], v[190:191], s[92:93]
    v_cvt_pk_bf16_f32 v184, v184, v185
    v_cvt_pk_bf16_f32 v185, v186, v187
    v_cvt_pk_bf16_f32 v186, v188, v189
    v_cvt_pk_bf16_f32 v187, v190, v191
    v_accvgpr_write_b32 a204, v184
    v_accvgpr_write_b32 a205, v185
    v_accvgpr_write_b32 a206, v186
    v_accvgpr_write_b32 a207, v187
    v_pk_mul_f32 v[192:193], v[192:193], s[92:93]
    v_pk_mul_f32 v[194:195], v[194:195], s[92:93]
    v_pk_mul_f32 v[196:197], v[196:197], s[92:93]
    v_pk_mul_f32 v[198:199], v[198:199], s[92:93]
    v_cvt_pk_bf16_f32 v192, v192, v193
    v_cvt_pk_bf16_f32 v193, v194, v195
    v_cvt_pk_bf16_f32 v194, v196, v197
    v_cvt_pk_bf16_f32 v195, v198, v199
    v_accvgpr_write_b32 a208, v192
    v_accvgpr_write_b32 a209, v193
    v_accvgpr_write_b32 a210, v194
    v_accvgpr_write_b32 a211, v195
    v_pk_mul_f32 v[200:201], v[200:201], s[92:93]
    v_pk_mul_f32 v[202:203], v[202:203], s[92:93]
    v_pk_mul_f32 v[204:205], v[204:205], s[92:93]
    v_pk_mul_f32 v[206:207], v[206:207], s[92:93]
    v_cvt_pk_bf16_f32 v200, v200, v201
    v_cvt_pk_bf16_f32 v201, v202, v203
    v_cvt_pk_bf16_f32 v202, v204, v205
    v_cvt_pk_bf16_f32 v203, v206, v207
    v_accvgpr_write_b32 a212, v200
    v_accvgpr_write_b32 a213, v201
    v_accvgpr_write_b32 a214, v202
    v_accvgpr_write_b32 a215, v203
    v_pk_mul_f32 v[208:209], v[208:209], s[92:93]
    v_pk_mul_f32 v[210:211], v[210:211], s[92:93]
    v_pk_mul_f32 v[212:213], v[212:213], s[92:93]
    v_pk_mul_f32 v[214:215], v[214:215], s[92:93]
    v_cvt_pk_bf16_f32 v208, v208, v209
    v_cvt_pk_bf16_f32 v209, v210, v211
    v_cvt_pk_bf16_f32 v210, v212, v213
    v_cvt_pk_bf16_f32 v211, v214, v215
    v_accvgpr_write_b32 a216, v208
    v_accvgpr_write_b32 a217, v209
    v_accvgpr_write_b32 a218, v210
    v_accvgpr_write_b32 a219, v211
    v_pk_mul_f32 v[216:217], v[216:217], s[92:93]
    v_pk_mul_f32 v[218:219], v[218:219], s[92:93]
    v_pk_mul_f32 v[220:221], v[220:221], s[92:93]
    v_pk_mul_f32 v[222:223], v[222:223], s[92:93]
    v_cvt_pk_bf16_f32 v216, v216, v217
    v_cvt_pk_bf16_f32 v217, v218, v219
    v_cvt_pk_bf16_f32 v218, v220, v221
    v_cvt_pk_bf16_f32 v219, v222, v223
    v_accvgpr_write_b32 a220, v216
    v_accvgpr_write_b32 a221, v217
    v_accvgpr_write_b32 a222, v218
    v_accvgpr_write_b32 a223, v219
    v_pk_mul_f32 v[224:225], v[224:225], s[92:93]
    v_pk_mul_f32 v[226:227], v[226:227], s[92:93]
    v_pk_mul_f32 v[228:229], v[228:229], s[92:93]
    v_pk_mul_f32 v[230:231], v[230:231], s[92:93]
    v_cvt_pk_bf16_f32 v224, v224, v225
    v_cvt_pk_bf16_f32 v225, v226, v227
    v_cvt_pk_bf16_f32 v226, v228, v229
    v_cvt_pk_bf16_f32 v227, v230, v231
    v_accvgpr_write_b32 a224, v224
    v_accvgpr_write_b32 a225, v225
    v_accvgpr_write_b32 a226, v226
    v_accvgpr_write_b32 a227, v227
    v_pk_mul_f32 v[232:233], v[232:233], s[92:93]
    v_pk_mul_f32 v[234:235], v[234:235], s[92:93]
    v_pk_mul_f32 v[236:237], v[236:237], s[92:93]
    v_pk_mul_f32 v[238:239], v[238:239], s[92:93]
    v_cvt_pk_bf16_f32 v232, v232, v233
    v_cvt_pk_bf16_f32 v233, v234, v235
    v_cvt_pk_bf16_f32 v234, v236, v237
    v_cvt_pk_bf16_f32 v235, v238, v239
    v_accvgpr_write_b32 a228, v232
    v_accvgpr_write_b32 a229, v233
    v_accvgpr_write_b32 a230, v234
    v_accvgpr_write_b32 a231, v235
    v_pk_mul_f32 v[240:241], v[240:241], s[92:93]
    v_pk_mul_f32 v[242:243], v[242:243], s[92:93]
    v_pk_mul_f32 v[244:245], v[244:245], s[92:93]
    v_pk_mul_f32 v[246:247], v[246:247], s[92:93]
    v_cvt_pk_bf16_f32 v240, v240, v241
    v_cvt_pk_bf16_f32 v241, v242, v243
    v_cvt_pk_bf16_f32 v242, v244, v245
    v_cvt_pk_bf16_f32 v243, v246, v247
    v_accvgpr_write_b32 a232, v240
    v_accvgpr_write_b32 a233, v241
    v_accvgpr_write_b32 a234, v242
    v_accvgpr_write_b32 a235, v243
    v_pk_mul_f32 v[248:249], v[248:249], s[92:93]
    v_pk_mul_f32 v[250:251], v[250:251], s[92:93]
    v_pk_mul_f32 v[252:253], v[252:253], s[92:93]
    v_pk_mul_f32 v[254:255], v[254:255], s[92:93]
    v_cvt_pk_bf16_f32 v248, v248, v249
    v_cvt_pk_bf16_f32 v249, v250, v251
    v_cvt_pk_bf16_f32 v250, v252, v253
    v_cvt_pk_bf16_f32 v251, v254, v255
    v_accvgpr_write_b32 a236, v248
    v_accvgpr_write_b32 a237, v249
    v_accvgpr_write_b32 a238, v250
    v_accvgpr_write_b32 a239, v251
    v_accvgpr_read_b32 v24, a96
    v_accvgpr_read_b32 v25, a97
    v_accvgpr_read_b32 v26, a98
    v_accvgpr_read_b32 v27, a99
    v_accvgpr_read_b32 v28, a100
    v_accvgpr_read_b32 v29, a101
    v_accvgpr_read_b32 v30, a102
    v_accvgpr_read_b32 v31, a103
    v_pk_mul_f32 v[24:25], v[24:25], s[92:93]
    v_pk_mul_f32 v[26:27], v[26:27], s[92:93]
    v_pk_mul_f32 v[28:29], v[28:29], s[92:93]
    v_pk_mul_f32 v[30:31], v[30:31], s[92:93]
    v_cvt_pk_bf16_f32 v24, v24, v25
    v_cvt_pk_bf16_f32 v25, v26, v27
    v_cvt_pk_bf16_f32 v26, v28, v29
    v_cvt_pk_bf16_f32 v27, v30, v31
    v_accvgpr_write_b32 a240, v24
    v_accvgpr_write_b32 a241, v25
    v_accvgpr_write_b32 a242, v26
    v_accvgpr_write_b32 a243, v27
    v_accvgpr_read_b32 v24, a104
    v_accvgpr_read_b32 v25, a105
    v_accvgpr_read_b32 v26, a106
    v_accvgpr_read_b32 v27, a107
    v_accvgpr_read_b32 v28, a108
    v_accvgpr_read_b32 v29, a109
    v_accvgpr_read_b32 v30, a110
    v_accvgpr_read_b32 v31, a111
    v_pk_mul_f32 v[24:25], v[24:25], s[92:93]
    v_pk_mul_f32 v[26:27], v[26:27], s[92:93]
    v_pk_mul_f32 v[28:29], v[28:29], s[92:93]
    v_pk_mul_f32 v[30:31], v[30:31], s[92:93]
    v_cvt_pk_bf16_f32 v24, v24, v25
    v_cvt_pk_bf16_f32 v25, v26, v27
    v_cvt_pk_bf16_f32 v26, v28, v29
    v_cvt_pk_bf16_f32 v27, v30, v31
    v_accvgpr_write_b32 a244, v24
    v_accvgpr_write_b32 a245, v25
    v_accvgpr_write_b32 a246, v26
    v_accvgpr_write_b32 a247, v27
    v_accvgpr_read_b32 v24, a112
    v_accvgpr_read_b32 v25, a113
    v_accvgpr_read_b32 v26, a114
    v_accvgpr_read_b32 v27, a115
    v_accvgpr_read_b32 v28, a116
    v_accvgpr_read_b32 v29, a117
    v_accvgpr_read_b32 v30, a118
    v_accvgpr_read_b32 v31, a119
    v_pk_mul_f32 v[24:25], v[24:25], s[92:93]
    v_pk_mul_f32 v[26:27], v[26:27], s[92:93]
    v_pk_mul_f32 v[28:29], v[28:29], s[92:93]
    v_pk_mul_f32 v[30:31], v[30:31], s[92:93]
    v_cvt_pk_bf16_f32 v24, v24, v25
    v_cvt_pk_bf16_f32 v25, v26, v27
    v_cvt_pk_bf16_f32 v26, v28, v29
    v_cvt_pk_bf16_f32 v27, v30, v31
    v_accvgpr_write_b32 a248, v24
    v_accvgpr_write_b32 a249, v25
    v_accvgpr_write_b32 a250, v26
    v_accvgpr_write_b32 a251, v27
    v_accvgpr_read_b32 v24, a120
    v_accvgpr_read_b32 v25, a121
    v_accvgpr_read_b32 v26, a122
    v_accvgpr_read_b32 v27, a123
    v_accvgpr_read_b32 v28, a124
    v_accvgpr_read_b32 v29, a125
    v_accvgpr_read_b32 v30, a126
    v_accvgpr_read_b32 v31, a127
    v_pk_mul_f32 v[24:25], v[24:25], s[92:93]
    v_pk_mul_f32 v[26:27], v[26:27], s[92:93]
    v_pk_mul_f32 v[28:29], v[28:29], s[92:93]
    v_pk_mul_f32 v[30:31], v[30:31], s[92:93]
    v_cvt_pk_bf16_f32 v24, v24, v25
    v_cvt_pk_bf16_f32 v25, v26, v27
    v_cvt_pk_bf16_f32 v26, v28, v29
    v_cvt_pk_bf16_f32 v27, v30, v31
    v_accvgpr_write_b32 a252, v24
    v_accvgpr_write_b32 a253, v25
    v_accvgpr_write_b32 a254, v26
    v_accvgpr_write_b32 a255, v27
    s_setpc_b64 s[20:21]
m_ns359:
    v_cvt_pk_bf16_f32 v32, v32, v33
    v_cvt_pk_bf16_f32 v33, v34, v35
    v_cvt_pk_bf16_f32 v34, v36, v37
    v_cvt_pk_bf16_f32 v35, v38, v39
    v_accvgpr_write_b32 a128, v32
    v_accvgpr_write_b32 a129, v33
    v_accvgpr_write_b32 a130, v34
    v_accvgpr_write_b32 a131, v35
    v_cvt_pk_bf16_f32 v40, v40, v41
    v_cvt_pk_bf16_f32 v41, v42, v43
    v_cvt_pk_bf16_f32 v42, v44, v45
    v_cvt_pk_bf16_f32 v43, v46, v47
    v_accvgpr_write_b32 a132, v40
    v_accvgpr_write_b32 a133, v41
    v_accvgpr_write_b32 a134, v42
    v_accvgpr_write_b32 a135, v43
    v_cvt_pk_bf16_f32 v48, v48, v49
    v_cvt_pk_bf16_f32 v49, v50, v51
    v_cvt_pk_bf16_f32 v50, v52, v53
    v_cvt_pk_bf16_f32 v51, v54, v55
    v_accvgpr_write_b32 a136, v48
    v_accvgpr_write_b32 a137, v49
    v_accvgpr_write_b32 a138, v50
    v_accvgpr_write_b32 a139, v51
    v_cvt_pk_bf16_f32 v56, v56, v57
    v_cvt_pk_bf16_f32 v57, v58, v59
    v_cvt_pk_bf16_f32 v58, v60, v61
    v_cvt_pk_bf16_f32 v59, v62, v63
    v_accvgpr_write_b32 a140, v56
    v_accvgpr_write_b32 a141, v57
    v_accvgpr_write_b32 a142, v58
    v_accvgpr_write_b32 a143, v59
    v_cvt_pk_bf16_f32 v64, v64, v65
    v_cvt_pk_bf16_f32 v65, v66, v67
    v_cvt_pk_bf16_f32 v66, v68, v69
    v_cvt_pk_bf16_f32 v67, v70, v71
    v_accvgpr_write_b32 a144, v64
    v_accvgpr_write_b32 a145, v65
    v_accvgpr_write_b32 a146, v66
    v_accvgpr_write_b32 a147, v67
    v_cvt_pk_bf16_f32 v72, v72, v73
    v_cvt_pk_bf16_f32 v73, v74, v75
    v_cvt_pk_bf16_f32 v74, v76, v77
    v_cvt_pk_bf16_f32 v75, v78, v79
    v_accvgpr_write_b32 a148, v72
    v_accvgpr_write_b32 a149, v73
    v_accvgpr_write_b32 a150, v74
    v_accvgpr_write_b32 a151, v75
    v_cvt_pk_bf16_f32 v80, v80, v81
    v_cvt_pk_bf16_f32 v81, v82, v83
    v_cvt_pk_bf16_f32 v82, v84, v85
    v_cvt_pk_bf16_f32 v83, v86, v87
    v_accvgpr_write_b32 a152, v80
    v_accvgpr_write_b32 a153, v81
    v_accvgpr_write_b32 a154, v82
    v_accvgpr_write_b32 a155, v83
    v_cvt_pk_bf16_f32 v88, v88, v89
    v_cvt_pk_bf16_f32 v89, v90, v91
    v_cvt_pk_bf16_f32 v90, v92, v93
    v_cvt_pk_bf16_f32 v91, v94, v95
    v_accvgpr_write_b32 a156, v88
    v_accvgpr_write_b32 a157, v89
    v_accvgpr_write_b32 a158, v90
    v_accvgpr_write_b32 a159, v91
    v_cvt_pk_bf16_f32 v96, v96, v97
    v_cvt_pk_bf16_f32 v97, v98, v99
    v_cvt_pk_bf16_f32 v98, v100, v101
    v_cvt_pk_bf16_f32 v99, v102, v103
    v_accvgpr_write_b32 a160, v96
    v_accvgpr_write_b32 a161, v97
    v_accvgpr_write_b32 a162, v98
    v_accvgpr_write_b32 a163, v99
    v_cvt_pk_bf16_f32 v104, v104, v105
    v_cvt_pk_bf16_f32 v105, v106, v107
    v_cvt_pk_bf16_f32 v106, v108, v109
    v_cvt_pk_bf16_f32 v107, v110, v111
    v_accvgpr_write_b32 a164, v104
    v_accvgpr_write_b32 a165, v105
    v_accvgpr_write_b32 a166, v106
    v_accvgpr_write_b32 a167, v107
    v_cvt_pk_bf16_f32 v112, v112, v113
    v_cvt_pk_bf16_f32 v113, v114, v115
    v_cvt_pk_bf16_f32 v114, v116, v117
    v_cvt_pk_bf16_f32 v115, v118, v119
    v_accvgpr_write_b32 a168, v112
    v_accvgpr_write_b32 a169, v113
    v_accvgpr_write_b32 a170, v114
    v_accvgpr_write_b32 a171, v115
    v_cvt_pk_bf16_f32 v120, v120, v121
    v_cvt_pk_bf16_f32 v121, v122, v123
    v_cvt_pk_bf16_f32 v122, v124, v125
    v_cvt_pk_bf16_f32 v123, v126, v127
    v_accvgpr_write_b32 a172, v120
    v_accvgpr_write_b32 a173, v121
    v_accvgpr_write_b32 a174, v122
    v_accvgpr_write_b32 a175, v123
    v_cvt_pk_bf16_f32 v128, v128, v129
    v_cvt_pk_bf16_f32 v129, v130, v131
    v_cvt_pk_bf16_f32 v130, v132, v133
    v_cvt_pk_bf16_f32 v131, v134, v135
    v_accvgpr_write_b32 a176, v128
    v_accvgpr_write_b32 a177, v129
    v_accvgpr_write_b32 a178, v130
    v_accvgpr_write_b32 a179, v131
    v_cvt_pk_bf16_f32 v136, v136, v137
    v_cvt_pk_bf16_f32 v137, v138, v139
    v_cvt_pk_bf16_f32 v138, v140, v141
    v_cvt_pk_bf16_f32 v139, v142, v143
    v_accvgpr_write_b32 a180, v136
    v_accvgpr_write_b32 a181, v137
    v_accvgpr_write_b32 a182, v138
    v_accvgpr_write_b32 a183, v139
    v_cvt_pk_bf16_f32 v144, v144, v145
    v_cvt_pk_bf16_f32 v145, v146, v147
    v_cvt_pk_bf16_f32 v146, v148, v149
    v_cvt_pk_bf16_f32 v147, v150, v151
    v_accvgpr_write_b32 a184, v144
    v_accvgpr_write_b32 a185, v145
    v_accvgpr_write_b32 a186, v146
    v_accvgpr_write_b32 a187, v147
    v_cvt_pk_bf16_f32 v152, v152, v153
    v_cvt_pk_bf16_f32 v153, v154, v155
    v_cvt_pk_bf16_f32 v154, v156, v157
    v_cvt_pk_bf16_f32 v155, v158, v159
    v_accvgpr_write_b32 a188, v152
    v_accvgpr_write_b32 a189, v153
    v_accvgpr_write_b32 a190, v154
    v_accvgpr_write_b32 a191, v155
    v_cvt_pk_bf16_f32 v160, v160, v161
    v_cvt_pk_bf16_f32 v161, v162, v163
    v_cvt_pk_bf16_f32 v162, v164, v165
    v_cvt_pk_bf16_f32 v163, v166, v167
    v_accvgpr_write_b32 a192, v160
    v_accvgpr_write_b32 a193, v161
    v_accvgpr_write_b32 a194, v162
    v_accvgpr_write_b32 a195, v163
    v_cvt_pk_bf16_f32 v168, v168, v169
    v_cvt_pk_bf16_f32 v169, v170, v171
    v_cvt_pk_bf16_f32 v170, v172, v173
    v_cvt_pk_bf16_f32 v171, v174, v175
    v_accvgpr_write_b32 a196, v168
    v_accvgpr_write_b32 a197, v169
    v_accvgpr_write_b32 a198, v170
    v_accvgpr_write_b32 a199, v171
    v_cvt_pk_bf16_f32 v176, v176, v177
    v_cvt_pk_bf16_f32 v177, v178, v179
    v_cvt_pk_bf16_f32 v178, v180, v181
    v_cvt_pk_bf16_f32 v179, v182, v183
    v_accvgpr_write_b32 a200, v176
    v_accvgpr_write_b32 a201, v177
    v_accvgpr_write_b32 a202, v178
    v_accvgpr_write_b32 a203, v179
    v_cvt_pk_bf16_f32 v184, v184, v185
    v_cvt_pk_bf16_f32 v185, v186, v187
    v_cvt_pk_bf16_f32 v186, v188, v189
    v_cvt_pk_bf16_f32 v187, v190, v191
    v_accvgpr_write_b32 a204, v184
    v_accvgpr_write_b32 a205, v185
    v_accvgpr_write_b32 a206, v186
    v_accvgpr_write_b32 a207, v187
    v_cvt_pk_bf16_f32 v192, v192, v193
    v_cvt_pk_bf16_f32 v193, v194, v195
    v_cvt_pk_bf16_f32 v194, v196, v197
    v_cvt_pk_bf16_f32 v195, v198, v199
    v_accvgpr_write_b32 a208, v192
    v_accvgpr_write_b32 a209, v193
    v_accvgpr_write_b32 a210, v194
    v_accvgpr_write_b32 a211, v195
    v_cvt_pk_bf16_f32 v200, v200, v201
    v_cvt_pk_bf16_f32 v201, v202, v203
    v_cvt_pk_bf16_f32 v202, v204, v205
    v_cvt_pk_bf16_f32 v203, v206, v207
    v_accvgpr_write_b32 a212, v200
    v_accvgpr_write_b32 a213, v201
    v_accvgpr_write_b32 a214, v202
    v_accvgpr_write_b32 a215, v203
    v_cvt_pk_bf16_f32 v208, v208, v209
    v_cvt_pk_bf16_f32 v209, v210, v211
    v_cvt_pk_bf16_f32 v210, v212, v213
    v_cvt_pk_bf16_f32 v211, v214, v215
    v_accvgpr_write_b32 a216, v208
    v_accvgpr_write_b32 a217, v209
    v_accvgpr_write_b32 a218, v210
    v_accvgpr_write_b32 a219, v211
    v_cvt_pk_bf16_f32 v216, v216, v217
    v_cvt_pk_bf16_f32 v217, v218, v219
    v_cvt_pk_bf16_f32 v218, v220, v221
    v_cvt_pk_bf16_f32 v219, v222, v223
    v_accvgpr_write_b32 a220, v216
    v_accvgpr_write_b32 a221, v217
    v_accvgpr_write_b32 a222, v218
    v_accvgpr_write_b32 a223, v219
    v_cvt_pk_bf16_f32 v224, v224, v225
    v_cvt_pk_bf16_f32 v225, v226, v227
    v_cvt_pk_bf16_f32 v226, v228, v229
    v_cvt_pk_bf16_f32 v227, v230, v231
    v_accvgpr_write_b32 a224, v224
    v_accvgpr_write_b32 a225, v225
    v_accvgpr_write_b32 a226, v226
    v_accvgpr_write_b32 a227, v227
    v_cvt_pk_bf16_f32 v232, v232, v233
    v_cvt_pk_bf16_f32 v233, v234, v235
    v_cvt_pk_bf16_f32 v234, v236, v237
    v_cvt_pk_bf16_f32 v235, v238, v239
    v_accvgpr_write_b32 a228, v232
    v_accvgpr_write_b32 a229, v233
    v_accvgpr_write_b32 a230, v234
    v_accvgpr_write_b32 a231, v235
    v_cvt_pk_bf16_f32 v240, v240, v241
    v_cvt_pk_bf16_f32 v241, v242, v243
    v_cvt_pk_bf16_f32 v242, v244, v245
    v_cvt_pk_bf16_f32 v243, v246, v247
    v_accvgpr_write_b32 a232, v240
    v_accvgpr_write_b32 a233, v241
    v_accvgpr_write_b32 a234, v242
    v_accvgpr_write_b32 a235, v243
    v_cvt_pk_bf16_f32 v248, v248, v249
    v_cvt_pk_bf16_f32 v249, v250, v251
    v_cvt_pk_bf16_f32 v250, v252, v253
    v_cvt_pk_bf16_f32 v251, v254, v255
    v_accvgpr_write_b32 a236, v248
    v_accvgpr_write_b32 a237, v249
    v_accvgpr_write_b32 a238, v250
    v_accvgpr_write_b32 a239, v251
    v_accvgpr_read_b32 v24, a96
    v_accvgpr_read_b32 v25, a97
    v_accvgpr_read_b32 v26, a98
    v_accvgpr_read_b32 v27, a99
    v_accvgpr_read_b32 v28, a100
    v_accvgpr_read_b32 v29, a101
    v_accvgpr_read_b32 v30, a102
    v_accvgpr_read_b32 v31, a103
    v_cvt_pk_bf16_f32 v24, v24, v25
    v_cvt_pk_bf16_f32 v25, v26, v27
    v_cvt_pk_bf16_f32 v26, v28, v29
    v_cvt_pk_bf16_f32 v27, v30, v31
    v_accvgpr_write_b32 a240, v24
    v_accvgpr_write_b32 a241, v25
    v_accvgpr_write_b32 a242, v26
    v_accvgpr_write_b32 a243, v27
    v_accvgpr_read_b32 v24, a104
    v_accvgpr_read_b32 v25, a105
    v_accvgpr_read_b32 v26, a106
    v_accvgpr_read_b32 v27, a107
    v_accvgpr_read_b32 v28, a108
    v_accvgpr_read_b32 v29, a109
    v_accvgpr_read_b32 v30, a110
    v_accvgpr_read_b32 v31, a111
    v_cvt_pk_bf16_f32 v24, v24, v25
    v_cvt_pk_bf16_f32 v25, v26, v27
    v_cvt_pk_bf16_f32 v26, v28, v29
    v_cvt_pk_bf16_f32 v27, v30, v31
    v_accvgpr_write_b32 a244, v24
    v_accvgpr_write_b32 a245, v25
    v_accvgpr_write_b32 a246, v26
    v_accvgpr_write_b32 a247, v27
    v_accvgpr_read_b32 v24, a112
    v_accvgpr_read_b32 v25, a113
    v_accvgpr_read_b32 v26, a114
    v_accvgpr_read_b32 v27, a115
    v_accvgpr_read_b32 v28, a116
    v_accvgpr_read_b32 v29, a117
    v_accvgpr_read_b32 v30, a118
    v_accvgpr_read_b32 v31, a119
    v_cvt_pk_bf16_f32 v24, v24, v25
    v_cvt_pk_bf16_f32 v25, v26, v27
    v_cvt_pk_bf16_f32 v26, v28, v29
    v_cvt_pk_bf16_f32 v27, v30, v31
    v_accvgpr_write_b32 a248, v24
    v_accvgpr_write_b32 a249, v25
    v_accvgpr_write_b32 a250, v26
    v_accvgpr_write_b32 a251, v27
    v_accvgpr_read_b32 v24, a120
    v_accvgpr_read_b32 v25, a121
    v_accvgpr_read_b32 v26, a122
    v_accvgpr_read_b32 v27, a123
    v_accvgpr_read_b32 v28, a124
    v_accvgpr_read_b32 v29, a125
    v_accvgpr_read_b32 v30, a126
    v_accvgpr_read_b32 v31, a127
    v_cvt_pk_bf16_f32 v24, v24, v25
    v_cvt_pk_bf16_f32 v25, v26, v27
    v_cvt_pk_bf16_f32 v26, v28, v29
    v_cvt_pk_bf16_f32 v27, v30, v31
    v_accvgpr_write_b32 a252, v24
    v_accvgpr_write_b32 a253, v25
    v_accvgpr_write_b32 a254, v26
    v_accvgpr_write_b32 a255, v27
    s_setpc_b64 s[20:21]
m_epf21:
    s_nop 7
    s_cmp_eq_u32 s97, 0
    s_cbranch_scc1 m_noscale60
    s_mov_b32 s91, s98
    s_mov_b32 s92, s97
    s_mov_b32 s93, s97
    s_mov_b32 s90, s91
    v_pk_mul_f32 v[32:33], v[32:33], s[92:93]
    v_pk_mul_f32 v[34:35], v[34:35], s[92:93]
    v_pk_mul_f32 v[36:37], v[36:37], s[92:93]
    v_pk_mul_f32 v[38:39], v[38:39], s[92:93]
    v_cvt_pk_bf16_f32 v32, v32, v33
    v_cvt_pk_bf16_f32 v33, v34, v35
    v_cvt_pk_bf16_f32 v34, v36, v37
    v_cvt_pk_bf16_f32 v35, v38, v39
    buffer_store_dwordx4 v[32:35], v2, s[8:11], s90 offen sc1
    s_add_u32 s90, s90, s100
    v_pk_mul_f32 v[40:41], v[40:41], s[92:93]
    v_pk_mul_f32 v[42:43], v[42:43], s[92:93]
    v_pk_mul_f32 v[44:45], v[44:45], s[92:93]
    v_pk_mul_f32 v[46:47], v[46:47], s[92:93]
    v_cvt_pk_bf16_f32 v40, v40, v41
    v_cvt_pk_bf16_f32 v41, v42, v43
    v_cvt_pk_bf16_f32 v42, v44, v45
    v_cvt_pk_bf16_f32 v43, v46, v47
    buffer_store_dwordx4 v[40:43], v2, s[8:11], s90 offen sc1
    s_add_u32 s90, s90, s100
    v_pk_mul_f32 v[48:49], v[48:49], s[92:93]
    v_pk_mul_f32 v[50:51], v[50:51], s[92:93]
    v_pk_mul_f32 v[52:53], v[52:53], s[92:93]
    v_pk_mul_f32 v[54:55], v[54:55], s[92:93]
    v_cvt_pk_bf16_f32 v48, v48, v49
    v_cvt_pk_bf16_f32 v49, v50, v51
    v_cvt_pk_bf16_f32 v50, v52, v53
    v_cvt_pk_bf16_f32 v51, v54, v55
    buffer_store_dwordx4 v[48:51], v2, s[8:11], s90 offen sc1
    s_add_u32 s90, s90, s100
    v_pk_mul_f32 v[56:57], v[56:57], s[92:93]
    v_pk_mul_f32 v[58:59], v[58:59], s[92:93]
    v_pk_mul_f32 v[60:61], v[60:61], s[92:93]
    v_pk_mul_f32 v[62:63], v[62:63], s[92:93]
    v_cvt_pk_bf16_f32 v56, v56, v57
    v_cvt_pk_bf16_f32 v57, v58, v59
    v_cvt_pk_bf16_f32 v58, v60, v61
    v_cvt_pk_bf16_f32 v59, v62, v63
    buffer_store_dwordx4 v[56:59], v2, s[8:11], s90 offen sc1
    s_add_u32 s90, s90, s100
    v_pk_mul_f32 v[64:65], v[64:65], s[92:93]
    v_pk_mul_f32 v[66:67], v[66:67], s[92:93]
    v_pk_mul_f32 v[68:69], v[68:69], s[92:93]
    v_pk_mul_f32 v[70:71], v[70:71], s[92:93]
    v_cvt_pk_bf16_f32 v64, v64, v65
    v_cvt_pk_bf16_f32 v65, v66, v67
    v_cvt_pk_bf16_f32 v66, v68, v69
    v_cvt_pk_bf16_f32 v67, v70, v71
    buffer_store_dwordx4 v[64:67], v2, s[8:11], s90 offen sc1
    s_add_u32 s90, s90, s100
    v_pk_mul_f32 v[72:73], v[72:73], s[92:93]
    v_pk_mul_f32 v[74:75], v[74:75], s[92:93]
    v_pk_mul_f32 v[76:77], v[76:77], s[92:93]
    v_pk_mul_f32 v[78:79], v[78:79], s[92:93]
    v_cvt_pk_bf16_f32 v72, v72, v73
    v_cvt_pk_bf16_f32 v73, v74, v75
    v_cvt_pk_bf16_f32 v74, v76, v77
    v_cvt_pk_bf16_f32 v75, v78, v79
    buffer_store_dwordx4 v[72:75], v2, s[8:11], s90 offen sc1
    s_add_u32 s90, s90, s100
    v_pk_mul_f32 v[80:81], v[80:81], s[92:93]
    v_pk_mul_f32 v[82:83], v[82:83], s[92:93]
    v_pk_mul_f32 v[84:85], v[84:85], s[92:93]
    v_pk_mul_f32 v[86:87], v[86:87], s[92:93]
    v_cvt_pk_bf16_f32 v80, v80, v81
    v_cvt_pk_bf16_f32 v81, v82, v83
    v_cvt_pk_bf16_f32 v82, v84, v85
    v_cvt_pk_bf16_f32 v83, v86, v87
    buffer_store_dwordx4 v[80:83], v2, s[8:11], s90 offen sc1
    s_add_u32 s90, s90, s100
    v_pk_mul_f32 v[88:89], v[88:89], s[92:93]
    v_pk_mul_f32 v[90:91], v[90:91], s[92:93]
    v_pk_mul_f32 v[92:93], v[92:93], s[92:93]
    v_pk_mul_f32 v[94:95], v[94:95], s[92:93]
    v_cvt_pk_bf16_f32 v88, v88, v89
    v_cvt_pk_bf16_f32 v89, v90, v91
    v_cvt_pk_bf16_f32 v90, v92, v93
    v_cvt_pk_bf16_f32 v91, v94, v95
    buffer_store_dwordx4 v[88:91], v2, s[8:11], s90 offen sc1
    s_add_u32 s90, s90, s100
    s_add_u32 s91, s91, s99
    s_mov_b32 s90, s91
    v_pk_mul_f32 v[96:97], v[96:97], s[92:93]
    v_pk_mul_f32 v[98:99], v[98:99], s[92:93]
    v_pk_mul_f32 v[100:101], v[100:101], s[92:93]
    v_pk_mul_f32 v[102:103], v[102:103], s[92:93]
    v_cvt_pk_bf16_f32 v96, v96, v97
    v_cvt_pk_bf16_f32 v97, v98, v99
    v_cvt_pk_bf16_f32 v98, v100, v101
    v_cvt_pk_bf16_f32 v99, v102, v103
    buffer_store_dwordx4 v[96:99], v2, s[8:11], s90 offen sc1
    s_add_u32 s90, s90, s100
    v_pk_mul_f32 v[104:105], v[104:105], s[92:93]
    v_pk_mul_f32 v[106:107], v[106:107], s[92:93]
    v_pk_mul_f32 v[108:109], v[108:109], s[92:93]
    v_pk_mul_f32 v[110:111], v[110:111], s[92:93]
    v_cvt_pk_bf16_f32 v104, v104, v105
    v_cvt_pk_bf16_f32 v105, v106, v107
    v_cvt_pk_bf16_f32 v106, v108, v109
    v_cvt_pk_bf16_f32 v107, v110, v111
    buffer_store_dwordx4 v[104:107], v2, s[8:11], s90 offen sc1
    s_add_u32 s90, s90, s100
    v_pk_mul_f32 v[112:113], v[112:113], s[92:93]
    v_pk_mul_f32 v[114:115], v[114:115], s[92:93]
    v_pk_mul_f32 v[116:117], v[116:117], s[92:93]
    v_pk_mul_f32 v[118:119], v[118:119], s[92:93]
    v_cvt_pk_bf16_f32 v112, v112, v113
    v_cvt_pk_bf16_f32 v113, v114, v115
    v_cvt_pk_bf16_f32 v114, v116, v117
    v_cvt_pk_bf16_f32 v115, v118, v119
    buffer_store_dwordx4 v[112:115], v2, s[8:11], s90 offen sc1
    s_add_u32 s90, s90, s100
    v_pk_mul_f32 v[120:121], v[120:121], s[92:93]
    v_pk_mul_f32 v[122:123], v[122:123], s[92:93]
    v_pk_mul_f32 v[124:125], v[124:125], s[92:93]
    v_pk_mul_f32 v[126:127], v[126:127], s[92:93]
    v_cvt_pk_bf16_f32 v120, v120, v121
    v_cvt_pk_bf16_f32 v121, v122, v123
    v_cvt_pk_bf16_f32 v122, v124, v125
    v_cvt_pk_bf16_f32 v123, v126, v127
    buffer_store_dwordx4 v[120:123], v2, s[8:11], s90 offen sc1
    s_add_u32 s90, s90, s100
    v_pk_mul_f32 v[128:129], v[128:129], s[92:93]
    v_pk_mul_f32 v[130:131], v[130:131], s[92:93]
    v_pk_mul_f32 v[132:133], v[132:133], s[92:93]
    v_pk_mul_f32 v[134:135], v[134:135], s[92:93]
    v_cvt_pk_bf16_f32 v128, v128, v129
    v_cvt_pk_bf16_f32 v129, v130, v131
    v_cvt_pk_bf16_f32 v130, v132, v133
    v_cvt_pk_bf16_f32 v131, v134, v135
    buffer_store_dwordx4 v[128:131], v2, s[8:11], s90 offen sc1
    s_add_u32 s90, s90, s100
    v_pk_mul_f32 v[136:137], v[136:137], s[92:93]
    v_pk_mul_f32 v[138:139], v[138:139], s[92:93]
    v_pk_mul_f32 v[140:141], v[140:141], s[92:93]
    v_pk_mul_f32 v[142:143], v[142:143], s[92:93]
    v_cvt_pk_bf16_f32 v136, v136, v137
    v_cvt_pk_bf16_f32 v137, v138, v139
    v_cvt_pk_bf16_f32 v138, v140, v141
    v_cvt_pk_bf16_f32 v139, v142, v143
    buffer_store_dwordx4 v[136:139], v2, s[8:11], s90 offen sc1
    s_add_u32 s90, s90, s100
    v_pk_mul_f32 v[144:145], v[144:145], s[92:93]
    v_pk_mul_f32 v[146:147], v[146:147], s[92:93]
    v_pk_mul_f32 v[148:149], v[148:149], s[92:93]
    v_pk_mul_f32 v[150:151], v[150:151], s[92:93]
    v_cvt_pk_bf16_f32 v144, v144, v145
    v_cvt_pk_bf16_f32 v145, v146, v147
    v_cvt_pk_bf16_f32 v146, v148, v149
    v_cvt_pk_bf16_f32 v147, v150, v151
    buffer_store_dwordx4 v[144:147], v2, s[8:11], s90 offen sc1
    s_add_u32 s90, s90, s100
    v_pk_mul_f32 v[152:153], v[152:153], s[92:93]
    v_pk_mul_f32 v[154:155], v[154:155], s[92:93]
    v_pk_mul_f32 v[156:157], v[156:157], s[92:93]
    v_pk_mul_f32 v[158:159], v[158:159], s[92:93]
    v_cvt_pk_bf16_f32 v152, v152, v153
    v_cvt_pk_bf16_f32 v153, v154, v155
    v_cvt_pk_bf16_f32 v154, v156, v157
    v_cvt_pk_bf16_f32 v155, v158, v159
    buffer_store_dwordx4 v[152:155], v2, s[8:11], s90 offen sc1
    s_add_u32 s90, s90, s100
    s_add_u32 s91, s91, s99
    s_mov_b32 s90, s91
    v_pk_mul_f32 v[160:161], v[160:161], s[92:93]
    v_pk_mul_f32 v[162:163], v[162:163], s[92:93]
    v_pk_mul_f32 v[164:165], v[164:165], s[92:93]
    v_pk_mul_f32 v[166:167], v[166:167], s[92:93]
    v_cvt_pk_bf16_f32 v160, v160, v161
    v_cvt_pk_bf16_f32 v161, v162, v163
    v_cvt_pk_bf16_f32 v162, v164, v165
    v_cvt_pk_bf16_f32 v163, v166, v167
    buffer_store_dwordx4 v[160:163], v2, s[8:11], s90 offen sc1
    s_add_u32 s90, s90, s100
    v_pk_mul_f32 v[168:169], v[168:169], s[92:93]
    v_pk_mul_f32 v[170:171], v[170:171], s[92:93]
    v_pk_mul_f32 v[172:173], v[172:173], s[92:93]
    v_pk_mul_f32 v[174:175], v[174:175], s[92:93]
    v_cvt_pk_bf16_f32 v168, v168, v169
    v_cvt_pk_bf16_f32 v169, v170, v171
    v_cvt_pk_bf16_f32 v170, v172, v173
    v_cvt_pk_bf16_f32 v171, v174, v175
    buffer_store_dwordx4 v[168:171], v2, s[8:11], s90 offen sc1
    s_add_u32 s90, s90, s100
    v_pk_mul_f32 v[176:177], v[176:177], s[92:93]
    v_pk_mul_f32 v[178:179], v[178:179], s[92:93]
    v_pk_mul_f32 v[180:181], v[180:181], s[92:93]
    v_pk_mul_f32 v[182:183], v[182:183], s[92:93]
    v_cvt_pk_bf16_f32 v176, v176, v177
    v_cvt_pk_bf16_f32 v177, v178, v179
    v_cvt_pk_bf16_f32 v178, v180, v181
    v_cvt_pk_bf16_f32 v179, v182, v183
    buffer_store_dwordx4 v[176:179], v2, s[8:11], s90 offen sc1
    s_add_u32 s90, s90, s100
    v_pk_mul_f32 v[184:185], v[184:185], s[92:93]
    v_pk_mul_f32 v[186:187], v[186:187], s[92:93]
    v_pk_mul_f32 v[188:189], v[188:189], s[92:93]
    v_pk_mul_f32 v[190:191], v[190:191], s[92:93]
    v_cvt_pk_bf16_f32 v184, v184, v185
    v_cvt_pk_bf16_f32 v185, v186, v187
    v_cvt_pk_bf16_f32 v186, v188, v189
    v_cvt_pk_bf16_f32 v187, v190, v191
    buffer_store_dwordx4 v[184:187], v2, s[8:11], s90 offen sc1
    s_add_u32 s90, s90, s100
    v_pk_mul_f32 v[192:193], v[192:193], s[92:93]
    v_pk_mul_f32 v[194:195], v[194:195], s[92:93]
    v_pk_mul_f32 v[196:197], v[196:197], s[92:93]
    v_pk_mul_f32 v[198:199], v[198:199], s[92:93]
    v_cvt_pk_bf16_f32 v192, v192, v193
    v_cvt_pk_bf16_f32 v193, v194, v195
    v_cvt_pk_bf16_f32 v194, v196, v197
    v_cvt_pk_bf16_f32 v195, v198, v199
    buffer_store_dwordx4 v[192:195], v2, s[8:11], s90 offen sc1
    s_add_u32 s90, s90, s100
    v_pk_mul_f32 v[200:201], v[200:201], s[92:93]
    v_pk_mul_f32 v[202:203], v[202:203], s[92:93]
    v_pk_mul_f32 v[204:205], v[204:205], s[92:93]
    v_pk_mul_f32 v[206:207], v[206:207], s[92:93]
    v_cvt_pk_bf16_f32 v200, v200, v201
    v_cvt_pk_bf16_f32 v201, v202, v203
    v_cvt_pk_bf16_f32 v202, v204, v205
    v_cvt_pk_bf16_f32 v203, v206, v207
    buffer_store_dwordx4 v[200:203], v2, s[8:11], s90 offen sc1
    s_add_u32 s90, s90, s100
    v_pk_mul_f32 v[208:209], v[208:209], s[92:93]
    v_pk_mul_f32 v[210:211], v[210:211], s[92:93]
    v_pk_mul_f32 v[212:213], v[212:213], s[92:93]
    v_pk_mul_f32 v[214:215], v[214:215], s[92:93]
    v_cvt_pk_bf16_f32 v208, v208, v209
    v_cvt_pk_bf16_f32 v209, v210, v211
    v_cvt_pk_bf16_f32 v210, v212, v213
    v_cvt_pk_bf16_f32 v211, v214, v215
    buffer_store_dwordx4 v[208:211], v2, s[8:11], s90 offen sc1
    s_add_u32 s90, s90, s100
    v_pk_mul_f32 v[216:217], v[216:217], s[92:93]
    v_pk_mul_f32 v[218:219], v[218:219], s[92:93]
    v_pk_mul_f32 v[220:221], v[220:221], s[92:93]
    v_pk_mul_f32 v[222:223], v[222:223], s[92:93]
    v_cvt_pk_bf16_f32 v216, v216, v217
    v_cvt_pk_bf16_f32 v217, v218, v219
    v_cvt_pk_bf16_f32 v218, v220, v221
    v_cvt_pk_bf16_f32 v219, v222, v223
    buffer_store_dwordx4 v[216:219], v2, s[8:11], s90 offen sc1
    s_add_u32 s90, s90, s100
    s_add_u32 s91, s91, s99
    s_mov_b32 s90, s91
    v_pk_mul_f32 v[224:225], v[224:225], s[92:93]
    v_pk_mul_f32 v[226:227], v[226:227], s[92:93]
    v_pk_mul_f32 v[228:229], v[228:229], s[92:93]
    v_pk_mul_f32 v[230:231], v[230:231], s[92:93]
    v_cvt_pk_bf16_f32 v224, v224, v225
    v_cvt_pk_bf16_f32 v225, v226, v227
    v_cvt_pk_bf16_f32 v226, v228, v229
    v_cvt_pk_bf16_f32 v227, v230, v231
    buffer_store_dwordx4 v[224:227], v2, s[8:11], s90 offen sc1
    s_add_u32 s90, s90, s100
    v_pk_mul_f32 v[232:233], v[232:233], s[92:93]
    v_pk_mul_f32 v[234:235], v[234:235], s[92:93]
    v_pk_mul_f32 v[236:237], v[236:237], s[92:93]
    v_pk_mul_f32 v[238:239], v[238:239], s[92:93]
    v_cvt_pk_bf16_f32 v232, v232, v233
    v_cvt_pk_bf16_f32 v233, v234, v235
    v_cvt_pk_bf16_f32 v234, v236, v237
    v_cvt_pk_bf16_f32 v235, v238, v239
    buffer_store_dwordx4 v[232:235], v2, s[8:11], s90 offen sc1
    s_add_u32 s90, s90, s100
    v_pk_mul_f32 v[240:241], v[240:241], s[92:93]
    v_pk_mul_f32 v[242:243], v[242:243], s[92:93]
    v_pk_mul_f32 v[244:245], v[244:245], s[92:93]
    v_pk_mul_f32 v[246:247], v[246:247], s[92:93]
    v_cvt_pk_bf16_f32 v240, v240, v241
    v_cvt_pk_bf16_f32 v241, v242, v243
    v_cvt_pk_bf16_f32 v242, v244, v245
    v_cvt_pk_bf16_f32 v243, v246, v247
    buffer_store_dwordx4 v[240:243], v2, s[8:11], s90 offen sc1
    s_add_u32 s90, s90, s100
    v_pk_mul_f32 v[248:249], v[248:249], s[92:93]
    v_pk_mul_f32 v[250:251], v[250:251], s[92:93]
    v_pk_mul_f32 v[252:253], v[252:253], s[92:93]
    v_pk_mul_f32 v[254:255], v[254:255], s[92:93]
    v_cvt_pk_bf16_f32 v248, v248, v249
    v_cvt_pk_bf16_f32 v249, v250, v251
    v_cvt_pk_bf16_f32 v250, v252, v253
    v_cvt_pk_bf16_f32 v251, v254, v255
    buffer_store_dwordx4 v[248:251], v2, s[8:11], s90 offen sc1
    s_add_u32 s90, s90, s100
    v_accvgpr_read_b32 v24, a96
    v_accvgpr_read_b32 v25, a97
    v_accvgpr_read_b32 v26, a98
    v_accvgpr_read_b32 v27, a99
    v_accvgpr_read_b32 v28, a100
    v_accvgpr_read_b32 v29, a101
    v_accvgpr_read_b32 v30, a102
    v_accvgpr_read_b32 v31, a103
    v_pk_mul_f32 v[24:25], v[24:25], s[92:93]
    v_pk_mul_f32 v[26:27], v[26:27], s[92:93]
    v_pk_mul_f32 v[28:29], v[28:29], s[92:93]
    v_pk_mul_f32 v[30:31], v[30:31], s[92:93]
    v_cvt_pk_bf16_f32 v24, v24, v25
    v_cvt_pk_bf16_f32 v25, v26, v27
    v_cvt_pk_bf16_f32 v26, v28, v29
    v_cvt_pk_bf16_f32 v27, v30, v31
    buffer_store_dwordx4 v[24:27], v2, s[8:11], s90 offen sc1
    s_add_u32 s90, s90, s100
    s_nop 1
    v_accvgpr_read_b32 v24, a104
    v_accvgpr_read_b32 v25, a105
    v_accvgpr_read_b32 v26, a106
    v_accvgpr_read_b32 v27, a107
    v_accvgpr_read_b32 v28, a108
    v_accvgpr_read_b32 v29, a109
    v_accvgpr_read_b32 v30, a110
    v_accvgpr_read_b32 v31, a111
    v_pk_mul_f32 v[24:25], v[24:25], s[92:93]
    v_pk_mul_f32 v[26:27], v[26:27], s[92:93]
    v_pk_mul_f32 v[28:29], v[28:29], s[92:93]
    v_pk_mul_f32 v[30:31], v[30:31], s[92:93]
    v_cvt_pk_bf16_f32 v24, v24, v25
    v_cvt_pk_bf16_f32 v25, v26, v27
    v_cvt_pk_bf16_f32 v26, v28, v29
    v_cvt_pk_bf16_f32 v27, v30, v31
    buffer_store_dwordx4 v[24:27], v2, s[8:11], s90 offen sc1
    s_add_u32 s90, s90, s100
    s_nop 1
    v_accvgpr_read_b32 v24, a112
    v_accvgpr_read_b32 v25, a113
    v_accvgpr_read_b32 v26, a114
    v_accvgpr_read_b32 v27, a115
    v_accvgpr_read_b32 v28, a116
    v_accvgpr_read_b32 v29, a117
    v_accvgpr_read_b32 v30, a118
    v_accvgpr_read_b32 v31, a119
    v_pk_mul_f32 v[24:25], v[24:25], s[92:93]
    v_pk_mul_f32 v[26:27], v[26:27], s[92:93]
    v_pk_mul_f32 v[28:29], v[28:29], s[92:93]
    v_pk_mul_f32 v[30:31], v[30:31], s[92:93]
    v_cvt_pk_bf16_f32 v24, v24, v25
    v_cvt_pk_bf16_f32 v25, v26, v27
    v_cvt_pk_bf16_f32 v26, v28, v29
    v_cvt_pk_bf16_f32 v27, v30, v31
    buffer_store_dwordx4 v[24:27], v2, s[8:11], s90 offen sc1
    s_add_u32 s90, s90, s100
    s_nop 1
    v_accvgpr_read_b32 v24, a120
    v_accvgpr_read_b32 v25, a121
    v_accvgpr_read_b32 v26, a122
    v_accvgpr_read_b32 v27, a123
    v_accvgpr_read_b32 v28, a124
    v_accvgpr_read_b32 v29, a125
    v_accvgpr_read_b32 v30, a126
    v_accvgpr_read_b32 v31, a127
    v_pk_mul_f32 v[24:25], v[24:25], s[92:93]
    v_pk_mul_f32 v[26:27], v[26:27], s[92:93]
    v_pk_mul_f32 v[28:29], v[28:29], s[92:93]
    v_pk_mul_f32 v[30:31], v[30:31], s[92:93]
    v_cvt_pk_bf16_f32 v24, v24, v25
    v_cvt_pk_bf16_f32 v25, v26, v27
    v_cvt_pk_bf16_f32 v26, v28, v29
    v_cvt_pk_bf16_f32 v27, v30, v31
    buffer_store_dwordx4 v[24:27], v2, s[8:11], s90 offen sc1
    s_add_u32 s90, s90, s100
    s_nop 1
    s_add_u32 s91, s91, s99
    s_setpc_b64 s[20:21]
m_noscale60:
    s_mov_b32 s91, s98
    s_mov_b32 s92, s97
    s_mov_b32 s93, s97
    s_mov_b32 s90, s91
    v_cvt_pk_bf16_f32 v32, v32, v33
    v_cvt_pk_bf16_f32 v33, v34, v35
    v_cvt_pk_bf16_f32 v34, v36, v37
    v_cvt_pk_bf16_f32 v35, v38, v39
    buffer_store_dwordx4 v[32:35], v2, s[8:11], s90 offen sc1
    s_add_u32 s90, s90, s100
    v_cvt_pk_bf16_f32 v40, v40, v41
    v_cvt_pk_bf16_f32 v41, v42, v43
    v_cvt_pk_bf16_f32 v42, v44, v45
    v_cvt_pk_bf16_f32 v43, v46, v47
    buffer_store_dwordx4 v[40:43], v2, s[8:11], s90 offen sc1
    s_add_u32 s90, s90, s100
    v_cvt_pk_bf16_f32 v48, v48, v49
    v_cvt_pk_bf16_f32 v49, v50, v51
    v_cvt_pk_bf16_f32 v50, v52, v53
    v_cvt_pk_bf16_f32 v51, v54, v55
    buffer_store_dwordx4 v[48:51], v2, s[8:11], s90 offen sc1
    s_add_u32 s90, s90, s100
    v_cvt_pk_bf16_f32 v56, v56, v57
    v_cvt_pk_bf16_f32 v57, v58, v59
    v_cvt_pk_bf16_f32 v58, v60, v61
    v_cvt_pk_bf16_f32 v59, v62, v63
    buffer_store_dwordx4 v[56:59], v2, s[8:11], s90 offen sc1
    s_add_u32 s90, s90, s100
    v_cvt_pk_bf16_f32 v64, v64, v65
    v_cvt_pk_bf16_f32 v65, v66, v67
    v_cvt_pk_bf16_f32 v66, v68, v69
    v_cvt_pk_bf16_f32 v67, v70, v71
    buffer_store_dwordx4 v[64:67], v2, s[8:11], s90 offen sc1
    s_add_u32 s90, s90, s100
    v_cvt_pk_bf16_f32 v72, v72, v73
    v_cvt_pk_bf16_f32 v73, v74, v75
    v_cvt_pk_bf16_f32 v74, v76, v77
    v_cvt_pk_bf16_f32 v75, v78, v79
    buffer_store_dwordx4 v[72:75], v2, s[8:11], s90 offen sc1
    s_add_u32 s90, s90, s100
    v_cvt_pk_bf16_f32 v80, v80, v81
    v_cvt_pk_bf16_f32 v81, v82, v83
    v_cvt_pk_bf16_f32 v82, v84, v85
    v_cvt_pk_bf16_f32 v83, v86, v87
    buffer_store_dwordx4 v[80:83], v2, s[8:11], s90 offen sc1
    s_add_u32 s90, s90, s100
    v_cvt_pk_bf16_f32 v88, v88, v89
    v_cvt_pk_bf16_f32 v89, v90, v91
    v_cvt_pk_bf16_f32 v90, v92, v93
    v_cvt_pk_bf16_f32 v91, v94, v95
    buffer_store_dwordx4 v[88:91], v2, s[8:11], s90 offen sc1
    s_add_u32 s90, s90, s100
    s_add_u32 s91, s91, s99
    s_mov_b32 s90, s91
    v_cvt_pk_bf16_f32 v96, v96, v97
    v_cvt_pk_bf16_f32 v97, v98, v99
    v_cvt_pk_bf16_f32 v98, v100, v101
    v_cvt_pk_bf16_f32 v99, v102, v103
    buffer_store_dwordx4 v[96:99], v2, s[8:11], s90 offen sc1
    s_add_u32 s90, s90, s100
    v_cvt_pk_bf16_f32 v104, v104, v105
    v_cvt_pk_bf16_f32 v105, v106, v107
    v_cvt_pk_bf16_f32 v106, v108, v109
    v_cvt_pk_bf16_f32 v107, v110, v111
    buffer_store_dwordx4 v[104:107], v2, s[8:11], s90 offen sc1
    s_add_u32 s90, s90, s100
    v_cvt_pk_bf16_f32 v112, v112, v113
    v_cvt_pk_bf16_f32 v113, v114, v115
    v_cvt_pk_bf16_f32 v114, v116, v117
    v_cvt_pk_bf16_f32 v115, v118, v119
    buffer_store_dwordx4 v[112:115], v2, s[8:11], s90 offen sc1
    s_add_u32 s90, s90, s100
    v_cvt_pk_bf16_f32 v120, v120, v121
    v_cvt_pk_bf16_f32 v121, v122, v123
    v_cvt_pk_bf16_f32 v122, v124, v125
    v_cvt_pk_bf16_f32 v123, v126, v127
    buffer_store_dwordx4 v[120:123], v2, s[8:11], s90 offen sc1
    s_add_u32 s90, s90, s100
    v_cvt_pk_bf16_f32 v128, v128, v129
    v_cvt_pk_bf16_f32 v129, v130, v131
    v_cvt_pk_bf16_f32 v130, v132, v133
    v_cvt_pk_bf16_f32 v131, v134, v135
    buffer_store_dwordx4 v[128:131], v2, s[8:11], s90 offen sc1
    s_add_u32 s90, s90, s100
    v_cvt_pk_bf16_f32 v136, v136, v137
    v_cvt_pk_bf16_f32 v137, v138, v139
    v_cvt_pk_bf16_f32 v138, v140, v141
    v_cvt_pk_bf16_f32 v139, v142, v143
    buffer_store_dwordx4 v[136:139], v2, s[8:11], s90 offen sc1
    s_add_u32 s90, s90, s100
    v_cvt_pk_bf16_f32 v144, v144, v145
    v_cvt_pk_bf16_f32 v145, v146, v147
    v_cvt_pk_bf16_f32 v146, v148, v149
    v_cvt_pk_bf16_f32 v147, v150, v151
    buffer_store_dwordx4 v[144:147], v2, s[8:11], s90 offen sc1
    s_add_u32 s90, s90, s100
    v_cvt_pk_bf16_f32 v152, v152, v153
    v_cvt_pk_bf16_f32 v153, v154, v155
    v_cvt_pk_bf16_f32 v154, v156, v157
    v_cvt_pk_bf16_f32 v155, v158, v159
    buffer_store_dwordx4 v[152:155], v2, s[8:11], s90 offen sc1
    s_add_u32 s90, s90, s100
    s_add_u32 s91, s91, s99
    s_mov_b32 s90, s91
    v_cvt_pk_bf16_f32 v160, v160, v161
    v_cvt_pk_bf16_f32 v161, v162, v163
    v_cvt_pk_bf16_f32 v162, v164, v165
    v_cvt_pk_bf16_f32 v163, v166, v167
    buffer_store_dwordx4 v[160:163], v2, s[8:11], s90 offen sc1
    s_add_u32 s90, s90, s100
    v_cvt_pk_bf16_f32 v168, v168, v169
    v_cvt_pk_bf16_f32 v169, v170, v171
    v_cvt_pk_bf16_f32 v170, v172, v173
    v_cvt_pk_bf16_f32 v171, v174, v175
    buffer_store_dwordx4 v[168:171], v2, s[8:11], s90 offen sc1
    s_add_u32 s90, s90, s100
    v_cvt_pk_bf16_f32 v176, v176, v177
    v_cvt_pk_bf16_f32 v177, v178, v179
    v_cvt_pk_bf16_f32 v178, v180, v181
    v_cvt_pk_bf16_f32 v179, v182, v183
    buffer_store_dwordx4 v[176:179], v2, s[8:11], s90 offen sc1
    s_add_u32 s90, s90, s100
    v_cvt_pk_bf16_f32 v184, v184, v185
    v_cvt_pk_bf16_f32 v185, v186, v187
    v_cvt_pk_bf16_f32 v186, v188, v189
    v_cvt_pk_bf16_f32 v187, v190, v191
    buffer_store_dwordx4 v[184:187], v2, s[8:11], s90 offen sc1
    s_add_u32 s90, s90, s100
    v_cvt_pk_bf16_f32 v192, v192, v193
    v_cvt_pk_bf16_f32 v193, v194, v195
    v_cvt_pk_bf16_f32 v194, v196, v197
    v_cvt_pk_bf16_f32 v195, v198, v199
    buffer_store_dwordx4 v[192:195], v2, s[8:11], s90 offen sc1
    s_add_u32 s90, s90, s100
    v_cvt_pk_bf16_f32 v200, v200, v201
    v_cvt_pk_bf16_f32 v201, v202, v203
    v_cvt_pk_bf16_f32 v202, v204, v205
    v_cvt_pk_bf16_f32 v203, v206, v207
    buffer_store_dwordx4 v[200:203], v2, s[8:11], s90 offen sc1
    s_add_u32 s90, s90, s100
    v_cvt_pk_bf16_f32 v208, v208, v209
    v_cvt_pk_bf16_f32 v209, v210, v211
    v_cvt_pk_bf16_f32 v210, v212, v213
    v_cvt_pk_bf16_f32 v211, v214, v215
    buffer_store_dwordx4 v[208:211], v2, s[8:11], s90 offen sc1
    s_add_u32 s90, s90, s100
    v_cvt_pk_bf16_f32 v216, v216, v217
    v_cvt_pk_bf16_f32 v217, v218, v219
    v_cvt_pk_bf16_f32 v218, v220, v221
    v_cvt_pk_bf16_f32 v219, v222, v223
    buffer_store_dwordx4 v[216:219], v2, s[8:11], s90 offen sc1
    s_add_u32 s90, s90, s100
    s_add_u32 s91, s91, s99
    s_mov_b32 s90, s91
    v_cvt_pk_bf16_f32 v224, v224, v225
    v_cvt_pk_bf16_f32 v225, v226, v227
    v_cvt_pk_bf16_f32 v226, v228, v229
    v_cvt_pk_bf16_f32 v227, v230, v231
    buffer_store_dwordx4 v[224:227], v2, s[8:11], s90 offen sc1
    s_add_u32 s90, s90, s100
    v_cvt_pk_bf16_f32 v232, v232, v233
    v_cvt_pk_bf16_f32 v233, v234, v235
    v_cvt_pk_bf16_f32 v234, v236, v237
    v_cvt_pk_bf16_f32 v235, v238, v239
    buffer_store_dwordx4 v[232:235], v2, s[8:11], s90 offen sc1
    s_add_u32 s90, s90, s100
    v_cvt_pk_bf16_f32 v240, v240, v241
    v_cvt_pk_bf16_f32 v241, v242, v243
    v_cvt_pk_bf16_f32 v242, v244, v245
    v_cvt_pk_bf16_f32 v243, v246, v247
    buffer_store_dwordx4 v[240:243], v2, s[8:11], s90 offen sc1
    s_add_u32 s90, s90, s100
    v_cvt_pk_bf16_f32 v248, v248, v249
    v_cvt_pk_bf16_f32 v249, v250, v251
    v_cvt_pk_bf16_f32 v250, v252, v253
    v_cvt_pk_bf16_f32 v251, v254, v255
    buffer_store_dwordx4 v[248:251], v2, s[8:11], s90 offen sc1
    s_add_u32 s90, s90, s100
    v_accvgpr_read_b32 v24, a96
    v_accvgpr_read_b32 v25, a97
    v_accvgpr_read_b32 v26, a98
    v_accvgpr_read_b32 v27, a99
    v_accvgpr_read_b32 v28, a100
    v_accvgpr_read_b32 v29, a101
    v_accvgpr_read_b32 v30, a102
    v_accvgpr_read_b32 v31, a103
    v_cvt_pk_bf16_f32 v24, v24, v25
    v_cvt_pk_bf16_f32 v25, v26, v27
    v_cvt_pk_bf16_f32 v26, v28, v29
    v_cvt_pk_bf16_f32 v27, v30, v31
    buffer_store_dwordx4 v[24:27], v2, s[8:11], s90 offen sc1
    s_add_u32 s90, s90, s100
    s_nop 1
    v_accvgpr_read_b32 v24, a104
    v_accvgpr_read_b32 v25, a105
    v_accvgpr_read_b32 v26, a106
    v_accvgpr_read_b32 v27, a107
    v_accvgpr_read_b32 v28, a108
    v_accvgpr_read_b32 v29, a109
    v_accvgpr_read_b32 v30, a110
    v_accvgpr_read_b32 v31, a111
    v_cvt_pk_bf16_f32 v24, v24, v25
    v_cvt_pk_bf16_f32 v25, v26, v27
    v_cvt_pk_bf16_f32 v26, v28, v29
    v_cvt_pk_bf16_f32 v27, v30, v31
    buffer_store_dwordx4 v[24:27], v2, s[8:11], s90 offen sc1
    s_add_u32 s90, s90, s100
    s_nop 1
    v_accvgpr_read_b32 v24, a112
    v_accvgpr_read_b32 v25, a113
    v_accvgpr_read_b32 v26, a114
    v_accvgpr_read_b32 v27, a115
    v_accvgpr_read_b32 v28, a116
    v_accvgpr_read_b32 v29, a117
    v_accvgpr_read_b32 v30, a118
    v_accvgpr_read_b32 v31, a119
    v_cvt_pk_bf16_f32 v24, v24, v25
    v_cvt_pk_bf16_f32 v25, v26, v27
    v_cvt_pk_bf16_f32 v26, v28, v29
    v_cvt_pk_bf16_f32 v27, v30, v31
    buffer_store_dwordx4 v[24:27], v2, s[8:11], s90 offen sc1
    s_add_u32 s90, s90, s100
    s_nop 1
    v_accvgpr_read_b32 v24, a120
    v_accvgpr_read_b32 v25, a121
    v_accvgpr_read_b32 v26, a122
    v_accvgpr_read_b32 v27, a123
    v_accvgpr_read_b32 v28, a124
    v_accvgpr_read_b32 v29, a125
    v_accvgpr_read_b32 v30, a126
    v_accvgpr_read_b32 v31, a127
    v_cvt_pk_bf16_f32 v24, v24, v25
    v_cvt_pk_bf16_f32 v25, v26, v27
    v_cvt_pk_bf16_f32 v26, v28, v29
    v_cvt_pk_bf16_f32 v27, v30, v31
    buffer_store_dwordx4 v[24:27], v2, s[8:11], s90 offen sc1
    s_add_u32 s90, s90, s100
    s_nop 1
    s_add_u32 s91, s91, s99
    s_setpc_b64 s[20:21]
m_epl61:
    s_mov_b32 s92, s97
    s_mov_b32 s93, s97
    s_cmp_eq_u32 s97, 0
    s_cbranch_scc1 m_ns262
    s_mov_b32 s90, s98
    v_pk_mul_f32 v[32:33], v[32:33], s[92:93]
    v_pk_mul_f32 v[34:35], v[34:35], s[92:93]
    v_pk_mul_f32 v[36:37], v[36:37], s[92:93]
    v_pk_mul_f32 v[38:39], v[38:39], s[92:93]
    v_cvt_pk_bf16_f32 v32, v32, v33
    v_cvt_pk_bf16_f32 v33, v34, v35
    v_cvt_pk_bf16_f32 v34, v36, v37
    v_cvt_pk_bf16_f32 v35, v38, v39
    buffer_store_dwordx4 v[32:35], v2, s[8:11], s90 offen sc1
    s_add_u32 s90, s90, s100
    v_pk_mul_f32 v[40:41], v[40:41], s[92:93]
    v_pk_mul_f32 v[42:43], v[42:43], s[92:93]
    v_pk_mul_f32 v[44:45], v[44:45], s[92:93]
    v_pk_mul_f32 v[46:47], v[46:47], s[92:93]
    v_cvt_pk_bf16_f32 v40, v40, v41
    v_cvt_pk_bf16_f32 v41, v42, v43
    v_cvt_pk_bf16_f32 v42, v44, v45
    v_cvt_pk_bf16_f32 v43, v46, v47
    buffer_store_dwordx4 v[40:43], v2, s[8:11], s90 offen sc1
    s_add_u32 s90, s90, s100
    v_pk_mul_f32 v[48:49], v[48:49], s[92:93]
    v_pk_mul_f32 v[50:51], v[50:51], s[92:93]
    v_pk_mul_f32 v[52:53], v[52:53], s[92:93]
    v_pk_mul_f32 v[54:55], v[54:55], s[92:93]
    v_cvt_pk_bf16_f32 v48, v48, v49
    v_cvt_pk_bf16_f32 v49, v50, v51
    v_cvt_pk_bf16_f32 v50, v52, v53
    v_cvt_pk_bf16_f32 v51, v54, v55
    buffer_store_dwordx4 v[48:51], v2, s[8:11], s90 offen sc1
    s_add_u32 s90, s90, s100
    v_pk_mul_f32 v[56:57], v[56:57], s[92:93]
    v_pk_mul_f32 v[58:59], v[58:59], s[92:93]
    v_pk_mul_f32 v[60:61], v[60:61], s[92:93]
    v_pk_mul_f32 v[62:63], v[62:63], s[92:93]
    v_cvt_pk_bf16_f32 v56, v56, v57
    v_cvt_pk_bf16_f32 v57, v58, v59
    v_cvt_pk_bf16_f32 v58, v60, v61
    v_cvt_pk_bf16_f32 v59, v62, v63
    buffer_store_dwordx4 v[56:59], v2, s[8:11], s90 offen sc1
    s_add_u32 s90, s90, s100
    v_pk_mul_f32 v[64:65], v[64:65], s[92:93]
    v_pk_mul_f32 v[66:67], v[66:67], s[92:93]
    v_pk_mul_f32 v[68:69], v[68:69], s[92:93]
    v_pk_mul_f32 v[70:71], v[70:71], s[92:93]
    v_cvt_pk_bf16_f32 v64, v64, v65
    v_cvt_pk_bf16_f32 v65, v66, v67
    v_cvt_pk_bf16_f32 v66, v68, v69
    v_cvt_pk_bf16_f32 v67, v70, v71
    buffer_store_dwordx4 v[64:67], v2, s[8:11], s90 offen sc1
    s_add_u32 s90, s90, s100
    v_pk_mul_f32 v[72:73], v[72:73], s[92:93]
    v_pk_mul_f32 v[74:75], v[74:75], s[92:93]
    v_pk_mul_f32 v[76:77], v[76:77], s[92:93]
    v_pk_mul_f32 v[78:79], v[78:79], s[92:93]
    v_cvt_pk_bf16_f32 v72, v72, v73
    v_cvt_pk_bf16_f32 v73, v74, v75
    v_cvt_pk_bf16_f32 v74, v76, v77
    v_cvt_pk_bf16_f32 v75, v78, v79
    buffer_store_dwordx4 v[72:75], v2, s[8:11], s90 offen sc1
    s_add_u32 s90, s90, s100
    v_pk_mul_f32 v[80:81], v[80:81], s[92:93]
    v_pk_mul_f32 v[82:83], v[82:83], s[92:93]
    v_pk_mul_f32 v[84:85], v[84:85], s[92:93]
    v_pk_mul_f32 v[86:87], v[86:87], s[92:93]
    v_cvt_pk_bf16_f32 v80, v80, v81
    v_cvt_pk_bf16_f32 v81, v82, v83
    v_cvt_pk_bf16_f32 v82, v84, v85
    v_cvt_pk_bf16_f32 v83, v86, v87
    buffer_store_dwordx4 v[80:83], v2, s[8:11], s90 offen sc1
    s_add_u32 s90, s90, s100
    v_pk_mul_f32 v[88:89], v[88:89], s[92:93]
    v_pk_mul_f32 v[90:91], v[90:91], s[92:93]
    v_pk_mul_f32 v[92:93], v[92:93], s[92:93]
    v_pk_mul_f32 v[94:95], v[94:95], s[92:93]
    v_cvt_pk_bf16_f32 v88, v88, v89
    v_cvt_pk_bf16_f32 v89, v90, v91
    v_cvt_pk_bf16_f32 v90, v92, v93
    v_cvt_pk_bf16_f32 v91, v94, v95
    buffer_store_dwordx4 v[88:91], v2, s[8:11], s90 offen sc1
    s_add_u32 s90, s98, s99
    v_pk_mul_f32 v[96:97], v[96:97], s[92:93]
    v_pk_mul_f32 v[98:99], v[98:99], s[92:93]
    v_pk_mul_f32 v[100:101], v[100:101], s[92:93]
    v_pk_mul_f32 v[102:103], v[102:103], s[92:93]
    v_cvt_pk_bf16_f32 v96, v96, v97
    v_cvt_pk_bf16_f32 v97, v98, v99
    v_cvt_pk_bf16_f32 v98, v100, v101
    v_cvt_pk_bf16_f32 v99, v102, v103
    buffer_store_dwordx4 v[96:99], v2, s[8:11], s90 offen sc1
    s_add_u32 s90, s90, s100
    v_pk_mul_f32 v[104:105], v[104:105], s[92:93]
    v_pk_mul_f32 v[106:107], v[106:107], s[92:93]
    v_pk_mul_f32 v[108:109], v[108:109], s[92:93]
    v_pk_mul_f32 v[110:111], v[110:111], s[92:93]
    v_cvt_pk_bf16_f32 v104, v104, v105
    v_cvt_pk_bf16_f32 v105, v106, v107
    v_cvt_pk_bf16_f32 v106, v108, v109
    v_cvt_pk_bf16_f32 v107, v110, v111
    buffer_store_dwordx4 v[104:107], v2, s[8:11], s90 offen sc1
    s_add_u32 s90, s90, s100
    v_pk_mul_f32 v[112:113], v[112:113], s[92:93]
    v_pk_mul_f32 v[114:115], v[114:115], s[92:93]
    v_pk_mul_f32 v[116:117], v[116:117], s[92:93]
    v_pk_mul_f32 v[118:119], v[118:119], s[92:93]
    v_cvt_pk_bf16_f32 v112, v112, v113
    v_cvt_pk_bf16_f32 v113, v114, v115
    v_cvt_pk_bf16_f32 v114, v116, v117
    v_cvt_pk_bf16_f32 v115, v118, v119
    buffer_store_dwordx4 v[112:115], v2, s[8:11], s90 offen sc1
    s_add_u32 s90, s90, s100
    v_pk_mul_f32 v[120:121], v[120:121], s[92:93]
    v_pk_mul_f32 v[122:123], v[122:123], s[92:93]
    v_pk_mul_f32 v[124:125], v[124:125], s[92:93]
    v_pk_mul_f32 v[126:127], v[126:127], s[92:93]
    v_cvt_pk_bf16_f32 v120, v120, v121
    v_cvt_pk_bf16_f32 v121, v122, v123
    v_cvt_pk_bf16_f32 v122, v124, v125
    v_cvt_pk_bf16_f32 v123, v126, v127
    buffer_store_dwordx4 v[120:123], v2, s[8:11], s90 offen sc1
    s_add_u32 s90, s90, s100
    v_pk_mul_f32 v[128:129], v[128:129], s[92:93]
    v_pk_mul_f32 v[130:131], v[130:131], s[92:93]
    v_pk_mul_f32 v[132:133], v[132:133], s[92:93]
    v_pk_mul_f32 v[134:135], v[134:135], s[92:93]
    v_cvt_pk_bf16_f32 v128, v128, v129
    v_cvt_pk_bf16_f32 v129, v130, v131
    v_cvt_pk_bf16_f32 v130, v132, v133
    v_cvt_pk_bf16_f32 v131, v134, v135
    buffer_store_dwordx4 v[128:131], v2, s[8:11], s90 offen sc1
    s_add_u32 s90, s90, s100
    v_pk_mul_f32 v[136:137], v[136:137], s[92:93]
    v_pk_mul_f32 v[138:139], v[138:139], s[92:93]
    v_pk_mul_f32 v[140:141], v[140:141], s[92:93]
    v_pk_mul_f32 v[142:143], v[142:143], s[92:93]
    v_cvt_pk_bf16_f32 v136, v136, v137
    v_cvt_pk_bf16_f32 v137, v138, v139
    v_cvt_pk_bf16_f32 v138, v140, v141
    v_cvt_pk_bf16_f32 v139, v142, v143
    buffer_store_dwordx4 v[136:139], v2, s[8:11], s90 offen sc1
    s_add_u32 s90, s90, s100
    v_pk_mul_f32 v[144:145], v[144:145], s[92:93]
    v_pk_mul_f32 v[146:147], v[146:147], s[92:93]
    v_pk_mul_f32 v[148:149], v[148:149], s[92:93]
    v_pk_mul_f32 v[150:151], v[150:151], s[92:93]
    v_cvt_pk_bf16_f32 v144, v144, v145
    v_cvt_pk_bf16_f32 v145, v146, v147
    v_cvt_pk_bf16_f32 v146, v148, v149
    v_cvt_pk_bf16_f32 v147, v150, v151
    buffer_store_dwordx4 v[144:147], v2, s[8:11], s90 offen sc1
    s_add_u32 s90, s90, s100
    v_pk_mul_f32 v[152:153], v[152:153], s[92:93]
    v_pk_mul_f32 v[154:155], v[154:155], s[92:93]
    v_pk_mul_f32 v[156:157], v[156:157], s[92:93]
    v_pk_mul_f32 v[158:159], v[158:159], s[92:93]
    v_cvt_pk_bf16_f32 v152, v152, v153
    v_cvt_pk_bf16_f32 v153, v154, v155
    v_cvt_pk_bf16_f32 v154, v156, v157
    v_cvt_pk_bf16_f32 v155, v158, v159
    buffer_store_dwordx4 v[152:155], v2, s[8:11], s90 offen sc1
    s_add_u32 s90, s90, s100
    v_pk_mul_f32 v[192:193], v[192:193], s[92:93]
    v_pk_mul_f32 v[194:195], v[194:195], s[92:93]
    v_pk_mul_f32 v[196:197], v[196:197], s[92:93]
    v_pk_mul_f32 v[198:199], v[198:199], s[92:93]
    v_cvt_pk_bf16_f32 v192, v192, v193
    v_cvt_pk_bf16_f32 v193, v194, v195
    v_cvt_pk_bf16_f32 v194, v196, v197
    v_cvt_pk_bf16_f32 v195, v198, v199
    v_pk_mul_f32 v[200:201], v[200:201], s[92:93]
    v_pk_mul_f32 v[202:203], v[202:203], s[92:93]
    v_pk_mul_f32 v[204:205], v[204:205], s[92:93]
    v_pk_mul_f32 v[206:207], v[206:207], s[92:93]
    v_cvt_pk_bf16_f32 v196, v200, v201
    v_cvt_pk_bf16_f32 v197, v202, v203
    v_cvt_pk_bf16_f32 v198, v204, v205
    v_cvt_pk_bf16_f32 v199, v206, v207
    v_pk_mul_f32 v[208:209], v[208:209], s[92:93]
    v_pk_mul_f32 v[210:211], v[210:211], s[92:93]
    v_pk_mul_f32 v[212:213], v[212:213], s[92:93]
    v_pk_mul_f32 v[214:215], v[214:215], s[92:93]
    v_cvt_pk_bf16_f32 v200, v208, v209
    v_cvt_pk_bf16_f32 v201, v210, v211
    v_cvt_pk_bf16_f32 v202, v212, v213
    v_cvt_pk_bf16_f32 v203, v214, v215
    v_pk_mul_f32 v[216:217], v[216:217], s[92:93]
    v_pk_mul_f32 v[218:219], v[218:219], s[92:93]
    v_pk_mul_f32 v[220:221], v[220:221], s[92:93]
    v_pk_mul_f32 v[222:223], v[222:223], s[92:93]
    v_cvt_pk_bf16_f32 v204, v216, v217
    v_cvt_pk_bf16_f32 v205, v218, v219
    v_cvt_pk_bf16_f32 v206, v220, v221
    v_cvt_pk_bf16_f32 v207, v222, v223
    v_pk_mul_f32 v[224:225], v[224:225], s[92:93]
    v_pk_mul_f32 v[226:227], v[226:227], s[92:93]
    v_pk_mul_f32 v[228:229], v[228:229], s[92:93]
    v_pk_mul_f32 v[230:231], v[230:231], s[92:93]
    v_cvt_pk_bf16_f32 v208, v224, v225
    v_cvt_pk_bf16_f32 v209, v226, v227
    v_cvt_pk_bf16_f32 v210, v228, v229
    v_cvt_pk_bf16_f32 v211, v230, v231
    v_pk_mul_f32 v[232:233], v[232:233], s[92:93]
    v_pk_mul_f32 v[234:235], v[234:235], s[92:93]
    v_pk_mul_f32 v[236:237], v[236:237], s[92:93]
    v_pk_mul_f32 v[238:239], v[238:239], s[92:93]
    v_cvt_pk_bf16_f32 v212, v232, v233
    v_cvt_pk_bf16_f32 v213, v234, v235
    v_cvt_pk_bf16_f32 v214, v236, v237
    v_cvt_pk_bf16_f32 v215, v238, v239
    v_pk_mul_f32 v[240:241], v[240:241], s[92:93]
    v_pk_mul_f32 v[242:243], v[242:243], s[92:93]
    v_pk_mul_f32 v[244:245], v[244:245], s[92:93]
    v_pk_mul_f32 v[246:247], v[246:247], s[92:93]
    v_cvt_pk_bf16_f32 v216, v240, v241
    v_cvt_pk_bf16_f32 v217, v242, v243
    v_cvt_pk_bf16_f32 v218, v244, v245
    v_cvt_pk_bf16_f32 v219, v246, v247
    v_pk_mul_f32 v[248:249], v[248:249], s[92:93]
    v_pk_mul_f32 v[250:251], v[250:251], s[92:93]
    v_pk_mul_f32 v[252:253], v[252:253], s[92:93]
    v_pk_mul_f32 v[254:255], v[254:255], s[92:93]
    v_cvt_pk_bf16_f32 v220, v248, v249
    v_cvt_pk_bf16_f32 v221, v250, v251
    v_cvt_pk_bf16_f32 v222, v252, v253
    v_cvt_pk_bf16_f32 v223, v254, v255
    v_accvgpr_read_b32 v24, a96
    v_accvgpr_read_b32 v25, a97
    v_accvgpr_read_b32 v26, a98
    v_accvgpr_read_b32 v27, a99
    v_accvgpr_read_b32 v28, a100
    v_accvgpr_read_b32 v29, a101
    v_accvgpr_read_b32 v30, a102
    v_accvgpr_read_b32 v31, a103
    v_pk_mul_f32 v[24:25], v[24:25], s[92:93]
    v_pk_mul_f32 v[26:27], v[26:27], s[92:93]
    v_pk_mul_f32 v[28:29], v[28:29], s[92:93]
    v_pk_mul_f32 v[30:31], v[30:31], s[92:93]
    v_cvt_pk_bf16_f32 v224, v24, v25
    v_cvt_pk_bf16_f32 v225, v26, v27
    v_cvt_pk_bf16_f32 v226, v28, v29
    v_cvt_pk_bf16_f32 v227, v30, v31
    v_accvgpr_read_b32 v24, a104
    v_accvgpr_read_b32 v25, a105
    v_accvgpr_read_b32 v26, a106
    v_accvgpr_read_b32 v27, a107
    v_accvgpr_read_b32 v28, a108
    v_accvgpr_read_b32 v29, a109
    v_accvgpr_read_b32 v30, a110
    v_accvgpr_read_b32 v31, a111
    v_pk_mul_f32 v[24:25], v[24:25], s[92:93]
    v_pk_mul_f32 v[26:27], v[26:27], s[92:93]
    v_pk_mul_f32 v[28:29], v[28:29], s[92:93]
    v_pk_mul_f32 v[30:31], v[30:31], s[92:93]
    v_cvt_pk_bf16_f32 v228, v24, v25
    v_cvt_pk_bf16_f32 v229, v26, v27
    v_cvt_pk_bf16_f32 v230, v28, v29
    v_cvt_pk_bf16_f32 v231, v30, v31
    v_accvgpr_read_b32 v24, a112
    v_accvgpr_read_b32 v25, a113
    v_accvgpr_read_b32 v26, a114
    v_accvgpr_read_b32 v27, a115
    v_accvgpr_read_b32 v28, a116
    v_accvgpr_read_b32 v29, a117
    v_accvgpr_read_b32 v30, a118
    v_accvgpr_read_b32 v31, a119
    v_pk_mul_f32 v[24:25], v[24:25], s[92:93]
    v_pk_mul_f32 v[26:27], v[26:27], s[92:93]
    v_pk_mul_f32 v[28:29], v[28:29], s[92:93]
    v_pk_mul_f32 v[30:31], v[30:31], s[92:93]
    v_cvt_pk_bf16_f32 v232, v24, v25
    v_cvt_pk_bf16_f32 v233, v26, v27
    v_cvt_pk_bf16_f32 v234, v28, v29
    v_cvt_pk_bf16_f32 v235, v30, v31
    v_accvgpr_read_b32 v24, a120
    v_accvgpr_read_b32 v25, a121
    v_accvgpr_read_b32 v26, a122
    v_accvgpr_read_b32 v27, a123
    v_accvgpr_read_b32 v28, a124
    v_accvgpr_read_b32 v29, a125
    v_accvgpr_read_b32 v30, a126
    v_accvgpr_read_b32 v31, a127
    v_pk_mul_f32 v[24:25], v[24:25], s[92:93]
    v_pk_mul_f32 v[26:27], v[26:27], s[92:93]
    v_pk_mul_f32 v[28:29], v[28:29], s[92:93]
    v_pk_mul_f32 v[30:31], v[30:31], s[92:93]
    v_cvt_pk_bf16_f32 v236, v24, v25
    v_cvt_pk_bf16_f32 v237, v26, v27
    v_cvt_pk_bf16_f32 v238, v28, v29
    v_cvt_pk_bf16_f32 v239, v30, v31
    v_pk_mul_f32 v[160:161], v[160:161], s[92:93]
    v_pk_mul_f32 v[162:163], v[162:163], s[92:93]
    v_pk_mul_f32 v[164:165], v[164:165], s[92:93]
    v_pk_mul_f32 v[166:167], v[166:167], s[92:93]
    v_cvt_pk_bf16_f32 v240, v160, v161
    v_cvt_pk_bf16_f32 v241, v162, v163
    v_cvt_pk_bf16_f32 v242, v164, v165
    v_cvt_pk_bf16_f32 v243, v166, v167
    v_pk_mul_f32 v[168:169], v[168:169], s[92:93]
    v_pk_mul_f32 v[170:171], v[170:171], s[92:93]
    v_pk_mul_f32 v[172:173], v[172:173], s[92:93]
    v_pk_mul_f32 v[174:175], v[174:175], s[92:93]
    v_cvt_pk_bf16_f32 v244, v168, v169
    v_cvt_pk_bf16_f32 v245, v170, v171
    v_cvt_pk_bf16_f32 v246, v172, v173
    v_cvt_pk_bf16_f32 v247, v174, v175
    v_pk_mul_f32 v[176:177], v[176:177], s[92:93]
    v_pk_mul_f32 v[178:179], v[178:179], s[92:93]
    v_pk_mul_f32 v[180:181], v[180:181], s[92:93]
    v_pk_mul_f32 v[182:183], v[182:183], s[92:93]
    v_cvt_pk_bf16_f32 v248, v176, v177
    v_cvt_pk_bf16_f32 v249, v178, v179
    v_cvt_pk_bf16_f32 v250, v180, v181
    v_cvt_pk_bf16_f32 v251, v182, v183
    v_pk_mul_f32 v[184:185], v[184:185], s[92:93]
    v_pk_mul_f32 v[186:187], v[186:187], s[92:93]
    v_pk_mul_f32 v[188:189], v[188:189], s[92:93]
    v_pk_mul_f32 v[190:191], v[190:191], s[92:93]
    v_cvt_pk_bf16_f32 v252, v184, v185
    v_cvt_pk_bf16_f32 v253, v186, v187
    v_cvt_pk_bf16_f32 v254, v188, v189
    v_cvt_pk_bf16_f32 v255, v190, v191
    s_setpc_b64 s[20:21]
m_ns262:
    s_mov_b32 s90, s98
    v_cvt_pk_bf16_f32 v32, v32, v33
    v_cvt_pk_bf16_f32 v33, v34, v35
    v_cvt_pk_bf16_f32 v34, v36, v37
    v_cvt_pk_bf16_f32 v35, v38, v39
    buffer_store_dwordx4 v[32:35], v2, s[8:11], s90 offen sc1
    s_add_u32 s90, s90, s100
    v_cvt_pk_bf16_f32 v40, v40, v41
    v_cvt_pk_bf16_f32 v41, v42, v43
    v_cvt_pk_bf16_f32 v42, v44, v45
    v_cvt_pk_bf16_f32 v43, v46, v47
    buffer_store_dwordx4 v[40:43], v2, s[8:11], s90 offen sc1
    s_add_u32 s90, s90, s100
    v_cvt_pk_bf16_f32 v48, v48, v49
    v_cvt_pk_bf16_f32 v49, v50, v51
    v_cvt_pk_bf16_f32 v50, v52, v53
    v_cvt_pk_bf16_f32 v51, v54, v55
    buffer_store_dwordx4 v[48:51], v2, s[8:11], s90 offen sc1
    s_add_u32 s90, s90, s100
    v_cvt_pk_bf16_f32 v56, v56, v57
    v_cvt_pk_bf16_f32 v57, v58, v59
    v_cvt_pk_bf16_f32 v58, v60, v61
    v_cvt_pk_bf16_f32 v59, v62, v63
    buffer_store_dwordx4 v[56:59], v2, s[8:11], s90 offen sc1
    s_add_u32 s90, s90, s100
    v_cvt_pk_bf16_f32 v64, v64, v65
    v_cvt_pk_bf16_f32 v65, v66, v67
    v_cvt_pk_bf16_f32 v66, v68, v69
    v_cvt_pk_bf16_f32 v67, v70, v71
    buffer_store_dwordx4 v[64:67], v2, s[8:11], s90 offen sc1
    s_add_u32 s90, s90, s100
    v_cvt_pk_bf16_f32 v72, v72, v73
    v_cvt_pk_bf16_f32 v73, v74, v75
    v_cvt_pk_bf16_f32 v74, v76, v77
    v_cvt_pk_bf16_f32 v75, v78, v79
    buffer_store_dwordx4 v[72:75], v2, s[8:11], s90 offen sc1
    s_add_u32 s90, s90, s100
    v_cvt_pk_bf16_f32 v80, v80, v81
    v_cvt_pk_bf16_f32 v81, v82, v83
    v_cvt_pk_bf16_f32 v82, v84, v85
    v_cvt_pk_bf16_f32 v83, v86, v87
    buffer_store_dwordx4 v[80:83], v2, s[8:11], s90 offen sc1
    s_add_u32 s90, s90, s100
    v_cvt_pk_bf16_f32 v88, v88, v89
    v_cvt_pk_bf16_f32 v89, v90, v91
    v_cvt_pk_bf16_f32 v90, v92, v93
    v_cvt_pk_bf16_f32 v91, v94, v95
    buffer_store_dwordx4 v[88:91], v2, s[8:11], s90 offen sc1
    s_add_u32 s90, s98, s99
    v_cvt_pk_bf16_f32 v96, v96, v97
    v_cvt_pk_bf16_f32 v97, v98, v99
    v_cvt_pk_bf16_f32 v98, v100, v101
    v_cvt_pk_bf16_f32 v99, v102, v103
    buffer_store_dwordx4 v[96:99], v2, s[8:11], s90 offen sc1
    s_add_u32 s90, s90, s100
    v_cvt_pk_bf16_f32 v104, v104, v105
    v_cvt_pk_bf16_f32 v105, v106, v107
    v_cvt_pk_bf16_f32 v106, v108, v109
    v_cvt_pk_bf16_f32 v107, v110, v111
    buffer_store_dwordx4 v[104:107], v2, s[8:11], s90 offen sc1
    s_add_u32 s90, s90, s100
    v_cvt_pk_bf16_f32 v112, v112, v113
    v_cvt_pk_bf16_f32 v113, v114, v115
    v_cvt_pk_bf16_f32 v114, v116, v117
    v_cvt_pk_bf16_f32 v115, v118, v119
    buffer_store_dwordx4 v[112:115], v2, s[8:11], s90 offen sc1
    s_add_u32 s90, s90, s100
    v_cvt_pk_bf16_f32 v120, v120, v121
    v_cvt_pk_bf16_f32 v121, v122, v123
    v_cvt_pk_bf16_f32 v122, v124, v125
    v_cvt_pk_bf16_f32 v123, v126, v127
    buffer_store_dwordx4 v[120:123], v2, s[8:11], s90 offen sc1
    s_add_u32 s90, s90, s100
    v_cvt_pk_bf16_f32 v128, v128, v129
    v_cvt_pk_bf16_f32 v129, v130, v131
    v_cvt_pk_bf16_f32 v130, v132, v133
    v_cvt_pk_bf16_f32 v131, v134, v135
    buffer_store_dwordx4 v[128:131], v2, s[8:11], s90 offen sc1
    s_add_u32 s90, s90, s100
    v_cvt_pk_bf16_f32 v136, v136, v137
    v_cvt_pk_bf16_f32 v137, v138, v139
    v_cvt_pk_bf16_f32 v138, v140, v141
    v_cvt_pk_bf16_f32 v139, v142, v143
    buffer_store_dwordx4 v[136:139], v2, s[8:11], s90 offen sc1
    s_add_u32 s90, s90, s100
    v_cvt_pk_bf16_f32 v144, v144, v145
    v_cvt_pk_bf16_f32 v145, v146, v147
    v_cvt_pk_bf16_f32 v146, v148, v149
    v_cvt_pk_bf16_f32 v147, v150, v151
    buffer_store_dwordx4 v[144:147], v2, s[8:11], s90 offen sc1
    s_add_u32 s90, s90, s100
    v_cvt_pk_bf16_f32 v152, v152, v153
    v_cvt_pk_bf16_f32 v153, v154, v155
    v_cvt_pk_bf16_f32 v154, v156, v157
    v_cvt_pk_bf16_f32 v155, v158, v159
    buffer_store_dwordx4 v[152:155], v2, s[8:11], s90 offen sc1
    s_add_u32 s90, s90, s100
    v_cvt_pk_bf16_f32 v192, v192, v193
    v_cvt_pk_bf16_f32 v193, v194, v195
    v_cvt_pk_bf16_f32 v194, v196, v197
    v_cvt_pk_bf16_f32 v195, v198, v199
    v_cvt_pk_bf16_f32 v196, v200, v201
    v_cvt_pk_bf16_f32 v197, v202, v203
    v_cvt_pk_bf16_f32 v198, v204, v205
    v_cvt_pk_bf16_f32 v199, v206, v207
    v_cvt_pk_bf16_f32 v200, v208, v209
    v_cvt_pk_bf16_f32 v201, v210, v211
    v_cvt_pk_bf16_f32 v202, v212, v213
    v_cvt_pk_bf16_f32 v203, v214, v215
    v_cvt_pk_bf16_f32 v204, v216, v217
    v_cvt_pk_bf16_f32 v205, v218, v219
    v_cvt_pk_bf16_f32 v206, v220, v221
    v_cvt_pk_bf16_f32 v207, v222, v223
    v_cvt_pk_bf16_f32 v208, v224, v225
    v_cvt_pk_bf16_f32 v209, v226, v227
    v_cvt_pk_bf16_f32 v210, v228, v229
    v_cvt_pk_bf16_f32 v211, v230, v231
    v_cvt_pk_bf16_f32 v212, v232, v233
    v_cvt_pk_bf16_f32 v213, v234, v235
    v_cvt_pk_bf16_f32 v214, v236, v237
    v_cvt_pk_bf16_f32 v215, v238, v239
    v_cvt_pk_bf16_f32 v216, v240, v241
    v_cvt_pk_bf16_f32 v217, v242, v243
    v_cvt_pk_bf16_f32 v218, v244, v245
    v_cvt_pk_bf16_f32 v219, v246, v247
    v_cvt_pk_bf16_f32 v220, v248, v249
    v_cvt_pk_bf16_f32 v221, v250, v251
    v_cvt_pk_bf16_f32 v222, v252, v253
    v_cvt_pk_bf16_f32 v223, v254, v255
    v_accvgpr_read_b32 v24, a96
    v_accvgpr_read_b32 v25, a97
    v_accvgpr_read_b32 v26, a98
    v_accvgpr_read_b32 v27, a99
    v_accvgpr_read_b32 v28, a100
    v_accvgpr_read_b32 v29, a101
    v_accvgpr_read_b32 v30, a102
    v_accvgpr_read_b32 v31, a103
    v_cvt_pk_bf16_f32 v224, v24, v25
    v_cvt_pk_bf16_f32 v225, v26, v27
    v_cvt_pk_bf16_f32 v226, v28, v29
    v_cvt_pk_bf16_f32 v227, v30, v31
    v_accvgpr_read_b32 v24, a104
    v_accvgpr_read_b32 v25, a105
    v_accvgpr_read_b32 v26, a106
    v_accvgpr_read_b32 v27, a107
    v_accvgpr_read_b32 v28, a108
    v_accvgpr_read_b32 v29, a109
    v_accvgpr_read_b32 v30, a110
    v_accvgpr_read_b32 v31, a111
    v_cvt_pk_bf16_f32 v228, v24, v25
    v_cvt_pk_bf16_f32 v229, v26, v27
    v_cvt_pk_bf16_f32 v230, v28, v29
    v_cvt_pk_bf16_f32 v231, v30, v31
    v_accvgpr_read_b32 v24, a112
    v_accvgpr_read_b32 v25, a113
    v_accvgpr_read_b32 v26, a114
    v_accvgpr_read_b32 v27, a115
    v_accvgpr_read_b32 v28, a116
    v_accvgpr_read_b32 v29, a117
    v_accvgpr_read_b32 v30, a118
    v_accvgpr_read_b32 v31, a119
    v_cvt_pk_bf16_f32 v232, v24, v25
    v_cvt_pk_bf16_f32 v233, v26, v27
    v_cvt_pk_bf16_f32 v234, v28, v29
    v_cvt_pk_bf16_f32 v235, v30, v31
    v_accvgpr_read_b32 v24, a120
    v_accvgpr_read_b32 v25, a121
    v_accvgpr_read_b32 v26, a122
    v_accvgpr_read_b32 v27, a123
    v_accvgpr_read_b32 v28, a124
    v_accvgpr_read_b32 v29, a125
    v_accvgpr_read_b32 v30, a126
    v_accvgpr_read_b32 v31, a127
    v_cvt_pk_bf16_f32 v236, v24, v25
    v_cvt_pk_bf16_f32 v237, v26, v27
    v_cvt_pk_bf16_f32 v238, v28, v29
    v_cvt_pk_bf16_f32 v239, v30, v31
    v_cvt_pk_bf16_f32 v240, v160, v161
    v_cvt_pk_bf16_f32 v241, v162, v163
    v_cvt_pk_bf16_f32 v242, v164, v165
    v_cvt_pk_bf16_f32 v243, v166, v167
    v_cvt_pk_bf16_f32 v244, v168, v169
    v_cvt_pk_bf16_f32 v245, v170, v171
    v_cvt_pk_bf16_f32 v246, v172, v173
    v_cvt_pk_bf16_f32 v247, v174, v175
    v_cvt_pk_bf16_f32 v248, v176, v177
    v_cvt_pk_bf16_f32 v249, v178, v179
    v_cvt_pk_bf16_f32 v250, v180, v181
    v_cvt_pk_bf16_f32 v251, v182, v183
    v_cvt_pk_bf16_f32 v252, v184, v185
    v_cvt_pk_bf16_f32 v253, v186, v187
    v_cvt_pk_bf16_f32 v254, v188, v189
    v_cvt_pk_bf16_f32 v255, v190, v191
    s_setpc_b64 s[20:21]
concat_heads__sliding_local_dilated__compressed_kv_cla__prompt_kernel_end:
.section .rodata,"a"
.p2align 6
.amdhsa_kernel concat_heads__sliding_local_dilated__compressed_kv_cla__prompt_kernel
  .amdhsa_next_free_vgpr 512
  .amdhsa_next_free_sgpr 102
  .amdhsa_accum_offset 256
  .amdhsa_group_segment_fixed_size 0
  .amdhsa_kernarg_size 96
  .amdhsa_user_sgpr_count 2
  .amdhsa_user_sgpr_kernarg_segment_ptr 1
  .amdhsa_system_sgpr_workgroup_id_x 1
.end_amdhsa_kernel
```

```asm
; @launch grid=(256,1,1) block=(256,1,1) lds=163840
.amdgcn_target "amdgcn-amd-amdhsa--gfx950"
.text
.globl concat_heads__sliding_local_dilated__compressed_kv_cla__prompt_kernel
.p2align 8
.type concat_heads__sliding_local_dilated__compressed_kv_cla__prompt_kernel,@function
concat_heads__sliding_local_dilated__compressed_kv_cla__prompt_kernel:
    s_cmp_ge_u32 s2, 256
    s_cbranch_scc1 m_end1
    s_load_dwordx16 s[24:39], s[0:1], 0
    s_load_dwordx4 s[4:7], s[0:1], 80
    v_and_b32 v1, 63, v0
    v_lshrrev_b32 v24, 6, v0
    s_nop 0
    v_readfirstlane_b32 s16, v24
    s_lshr_b32 s68, s2, 3
    s_lshr_b32 s57, s16, 1
    s_and_b32 s58, s16, 1
    s_mov_b32 s43, 0x20000
    s_mov_b32 s47, 0x20000
    s_cmp_lt_u32 s68, 29
    s_cbranch_scc1 m_ncp2
    s_sub_u32 s91, s68, 29
    s_lshl_b32 s91, s91, 2
    s_add_u32 s91, s91, s16
    s_getpc_b64 s[8:9]
m_pc3:
    s_sub_u32 s8, s8, m_pc3-concat_heads__sliding_local_dilated__compressed_kv_cla__prompt_kernel
    s_subb_u32 s9, s9, 0
    s_mov_b32 s10, concat_heads__sliding_local_dilated__compressed_kv_cla__prompt_kernel_end-concat_heads__sliding_local_dilated__compressed_kv_cla__prompt_kernel
    s_mov_b32 s11, 0x20000
    s_lshl_b32 s90, s91, 13
    v_lshlrev_b32 v24, 7, v1
    buffer_load_dword v22, v24, s[8:11], s90 offen
m_ncp2:
    v_and_b32 v24, 15, v1
    v_lshrrev_b32 v25, 4, v1
    v_bfe_u32 v26, v1, 1, 3
    v_xor_b32 v26, v26, v25
    s_lshl_b32 s90, s57, 14
    v_lshlrev_b32 v27, 7, v24
    v_add_u32 v27, s90, v27
    v_xor_b32 v28, 0, v26
    v_lshl_add_u32 v6, v28, 4, v27
    v_xor_b32 v28, 4, v26
    v_lshl_add_u32 v7, v28, 4, v27
    v_bfe_u32 v26, v1, 2, 2
    v_lshl_add_u32 v27, v25, 3, v26
    v_lshlrev_b32 v27, 9, v27
    v_and_b32 v28, 3, v1
    v_lshlrev_b32 v28, 3, v28
    v_add_u32 v27, v27, v28
    s_lshl_b32 s90, s58, 8
    s_add_u32 s90, s90, 98304
    v_add_u32 v27, s90, v27
    v_bfe_u32 v26, v1, 2, 3
    v_xor_b32 v28, 0, v26
    v_lshl_add_u32 v8, v28, 5, v27
    v_xor_b32 v28, 1, v26
    v_lshl_add_u32 v9, v28, 5, v27
    v_xor_b32 v28, 2, v26
    v_lshl_add_u32 v10, v28, 5, v27
    v_xor_b32 v28, 3, v26
    v_lshl_add_u32 v11, v28, 5, v27
    v_xor_b32 v28, 4, v26
    v_lshl_add_u32 v12, v28, 5, v27
    v_xor_b32 v28, 5, v26
    v_lshl_add_u32 v13, v28, 5, v27
    v_xor_b32 v28, 6, v26
    v_lshl_add_u32 v14, v28, 5, v27
    v_xor_b32 v28, 7, v26
    v_lshl_add_u32 v15, v28, 5, v27
    v_lshlrev_b32 v2, 4, v1
    s_lshl_b32 s61, s16, 13
    s_add_u32 s62, s61, 98304
    s_mov_b32 s64, 0
    s_mov_b32 s59, 32768
    s_mov_b32 s60, 229376
    s_waitcnt lgkmcnt(0)
    s_mov_b32 s8, s6
    s_mov_b32 s9, s7
    s_mov_b32 s10, 268435456
    s_mov_b32 s11, 0x20000
    s_mov_b32 s70, 0
    s_cmp_ge_u32 s68, 16
    s_cbranch_scc1 m_typea4
    s_and_b32 s69, s68, 3
    s_and_b32 s90, s2, 1
    s_lshl_b32 s90, s90, 2
    s_add_u32 s69, s69, s90
    s_bfe_u32 s90, s2, 0x20001
    s_mul_i32 s90, s90, 4
    s_bfe_u32 s91, s68, 0x20002
    s_add_u32 s90, s90, s91
    s_mov_b32 s76, 8388608
    s_mov_b32 s78, 8192
    s_mov_b32 s81, 0
    s_mov_b32 s73, 4194304
    s_mov_b32 s77, 2048
    s_mov_b32 s82, 16
    s_lshl_b32 s80, s90, 9
    s_lshl_b32 s79, s69, 19
    s_lshl_b32 s88, s90, 4
    s_add_u32 s88, s88, s69
    s_lshl_b32 s88, s88, 3
    s_mov_b32 s83, 0
    s_mov_b32 s84, 1040356334
    s_lshl_b32 s91, s90, 1
    s_add_u32 s91, s91, s58
    s_lshl_b32 s91, s91, 19
    s_lshl_b32 s92, s69, 1
    s_add_u32 s92, s92, s57
    s_lshl_b32 s92, s92, 15
    s_add_u32 s85, s91, s92
    s_add_u32 s85, s85, 0
    s_mov_b32 s86, 1024
    s_mov_b32 s87, 4096
    s_mov_b32 s71, s30
    s_mov_b32 s72, s31
    s_mov_b32 s74, s34
    s_mov_b32 s75, s35
    s_branch m_go15
m_typea4:
    s_cmp_lt_u32 s68, 28
    s_cbranch_scc1 m_nopf6
    s_mov_b32 s70, 1
    s_sub_u32 s93, s2, 224
    s_lshl_b32 s93, s93, 2
    s_add_u32 s93, s93, s16
    v_lshlrev_b32 v24, 7, v1
    v_lshrrev_b32 v25, 3, v1
    v_lshlrev_b32 v25, 11, v25
    v_and_b32 v26, 7, v1
    v_lshl_add_u32 v25, v26, 7, v25
    s_lshl_b32 s92, s93, 13
    s_lshl_b32 s93, s93, 14
    s_add_u32 s93, s93, 1024
    v_lshrrev_b32 v25, 2, v1
    v_lshlrev_b32 v25, 11, v25
    v_and_b32 v26, 3, v1
    v_lshl_add_u32 v25, v26, 7, v25
    s_lshl_b32 s93, s92, 2
    s_mov_b32 s40, s34
    s_mov_b32 s41, s35
    s_mov_b32 s42, 8388608
    s_add_u32 s90, s92, 1048576
    buffer_load_dword v22, v24, s[40:43], s90 offen
    s_add_u32 s90, s92, 2097152
    buffer_load_dword v22, v24, s[40:43], s90 offen
    s_mov_b32 s40, s30
    s_mov_b32 s41, s31
    s_mov_b32 s42, 4194304
    s_add_u32 s90, s93, 512
    buffer_load_dword v22, v25, s[40:43], s90 offen
    s_mov_b32 s40, s34
    s_mov_b32 s41, s35
    s_mov_b32 s42, 8388608
    s_add_u32 s90, s92, 3145728
    buffer_load_dword v22, v24, s[40:43], s90 offen
    s_add_u32 s90, s92, 4194304
    buffer_load_dword v22, v24, s[40:43], s90 offen
    s_mov_b32 s40, s30
    s_mov_b32 s41, s31
    s_mov_b32 s42, 4194304
    s_add_u32 s90, s93, 1024
    buffer_load_dword v22, v25, s[40:43], s90 offen
    s_mov_b32 s40, s34
    s_mov_b32 s41, s35
    s_mov_b32 s42, 8388608
    s_add_u32 s90, s92, 5242880
    buffer_load_dword v22, v24, s[40:43], s90 offen
    s_mov_b32 s40, s26
    s_mov_b32 s41, s27
    s_mov_b32 s42, 6291456
    s_add_u32 s90, s92, 0
    buffer_load_dword v22, v24, s[40:43], s90 offen
    s_mov_b32 s40, s24
    s_mov_b32 s41, s25
    s_mov_b32 s42, 4194304
    s_add_u32 s90, s93, 0
    buffer_load_dword v22, v25, s[40:43], s90 offen
    s_mov_b32 s40, s34
    s_mov_b32 s41, s35
    s_mov_b32 s42, 8388608
    s_add_u32 s90, s92, 6291456
    buffer_load_dword v22, v24, s[40:43], s90 offen
    s_mov_b32 s40, s30
    s_mov_b32 s41, s31
    s_mov_b32 s42, 4194304
    s_add_u32 s90, s93, 1536
    buffer_load_dword v22, v25, s[40:43], s90 offen
    s_mov_b32 s40, s26
    s_mov_b32 s41, s27
    s_mov_b32 s42, 6291456
    s_add_u32 s90, s92, 1048576
    buffer_load_dword v22, v24, s[40:43], s90 offen
    s_mov_b32 s40, s24
    s_mov_b32 s41, s25
    s_mov_b32 s42, 4194304
    s_add_u32 s90, s93, 512
    buffer_load_dword v22, v25, s[40:43], s90 offen
    s_mov_b32 s40, s34
    s_mov_b32 s41, s35
    s_mov_b32 s42, 8388608
    s_add_u32 s90, s92, 7340032
    buffer_load_dword v22, v24, s[40:43], s90 offen
    s_mov_b32 s40, s26
    s_mov_b32 s41, s27
    s_mov_b32 s42, 6291456
    s_add_u32 s90, s92, 2097152
    buffer_load_dword v22, v24, s[40:43], s90 offen
    s_add_u32 s90, s92, 3145728
    buffer_load_dword v22, v24, s[40:43], s90 offen
    s_mov_b32 s40, s24
    s_mov_b32 s41, s25
    s_mov_b32 s42, 4194304
    s_add_u32 s90, s93, 1024
    buffer_load_dword v22, v25, s[40:43], s90 offen
    s_mov_b32 s40, s26
    s_mov_b32 s41, s27
    s_mov_b32 s42, 6291456
    s_add_u32 s90, s92, 4194304
    buffer_load_dword v22, v24, s[40:43], s90 offen
    s_mov_b32 s40, s24
    s_mov_b32 s41, s25
    s_mov_b32 s42, 4194304
    s_add_u32 s90, s93, 1536
    buffer_load_dword v22, v25, s[40:43], s90 offen
    s_mov_b32 s40, s26
    s_mov_b32 s41, s27
    s_mov_b32 s42, 6291456
    s_add_u32 s90, s92, 5242880
    buffer_load_dword v22, v24, s[40:43], s90 offen
    s_mov_b32 s40, s32
    s_mov_b32 s41, s33
    s_mov_b32 s42, 2097152
    s_add_u32 s90, s92, 1048576
    buffer_load_dword v22, v24, s[40:43], s90 offen
m_nopf6:
    s_bfe_u32 s69, s68, 0x20002
    s_add_u32 s69, s69, 0
    s_and_b32 s90, s2, 7
    s_lshl_b32 s90, s90, 2
    s_and_b32 s91, s68, 3
    s_add_u32 s90, s90, s91
    s_cmp_lt_u32 s90, 16
    s_cselect_b32 s83, 0, 1
    s_mov_b32 s91, 33554432
    s_cselect_b32 s85, 16777216, s91
    s_mov_b32 s91, 8192
    s_cselect_b32 s86, 1024, s91
    s_mov_b32 s91, 1024
    s_cselect_b32 s87, 4096, s91
    s_cselect_b32 s74, s36, s38
    s_cselect_b32 s75, s37, s39
    s_mov_b32 s71, s32
    s_mov_b32 s72, s33
    s_mov_b32 s73, 2097152
    s_mov_b32 s77, 1024
    s_mov_b32 s82, 8
    s_mov_b32 s81, 0
    s_mov_b32 s76, 4194304
    s_mov_b32 s78, 8192
    s_mov_b32 s84, 0
    s_and_b32 s90, s90, 15
    s_lshl_b32 s80, s90, 9
    s_lshl_b32 s79, s69, 18
    s_lshl_b32 s91, s83, 2
    s_add_u32 s91, s91, s69
    s_cmp_ge_u32 s69, 4
    s_cselect_b32 s92, 508, 8
    s_add_u32 s91, s91, s92
    s_lshl_b32 s88, s90, 4
    s_add_u32 s88, s88, s91
    s_lshl_b32 s88, s88, 3
    s_lshl_b32 s91, s90, 1
    s_add_u32 s91, s91, s58
    s_lshl_b32 s91, s91, 19
    s_lshl_b32 s92, s69, 1
    s_add_u32 s92, s92, s57
    s_lshl_b32 s92, s92, 15
    s_add_u32 s85, s85, s91
    s_add_u32 s85, s85, s92
m_go15:
    s_mov_b32 s42, s73
    s_mov_b32 s46, s76
    s_lshl_b32 s90, s77, 4
    s_lshl_b32 s90, s90, s81
    s_mov_b32 s48, s79
    s_mul_i32 s91, s90, 1
    s_add_u32 s49, s91, s79
    s_sub_u32 s49, s49, 2048
    s_mul_i32 s91, s90, 2
    s_add_u32 s50, s91, s79
    s_mul_i32 s91, s90, 3
    s_add_u32 s51, s91, s79
    s_sub_u32 s51, s51, 2048
    s_mov_b32 s52, s80
    s_lshl_b32 s90, s78, 2
    s_mul_i32 s91, s90, 1
    s_add_u32 s53, s91, s80
    s_sub_u32 s53, s53, 2048
    s_mul_i32 s91, s90, 2
    s_add_u32 s54, s91, s80
    s_mul_i32 s91, s90, 3
    s_add_u32 s55, s91, s80
    s_sub_u32 s55, s55, 2048
    s_lshl_b32 s56, s78, 6
    s_lshl_b32 s90, s58, 7
    s_add_u32 s90, s90, s57
    s_lshl_b32 s91, s16, 6
    s_cmp_eq_u32 s81, 1
    s_cselect_b32 s90, s90, s91
    v_lshrrev_b32 v24, 3, v1
    v_lshlrev_b32 v24, s81, v24
    v_add_u32 v24, s90, v24
    v_mul_lo_u32 v24, v24, s77
    v_lshrrev_b32 v25, 4, v1
    v_and_b32 v26, 7, v1
    v_xor_b32 v25, v25, v26
    v_lshl_add_u32 v16, v25, 4, v24
    v_xor_b32 v25, 4, v25
    v_lshl_add_u32 v17, v25, 4, v24
    s_lshl_b32 s90, s77, 3
    s_lshl_b32 s90, s90, s81
    s_sub_u32 s90, s90, 1024
    v_add_u32 v17, s90, v17
    v_lshrrev_b32 v24, 5, v1
    s_lshl_b32 s90, s16, 4
    v_add_u32 v25, s90, v24
    v_mul_lo_u32 v25, v25, s78
    v_lshlrev_b32 v24, 1, v24
    v_and_b32 v26, 31, v1
    v_xor_b32 v24, v24, v26
    s_lshl_b32 s90, s78, 1
    s_sub_u32 s90, s90, 1024
    v_add_u32 v27, s90, v25
    v_xor_b32 v26, 0, v24
    v_lshl_add_u32 v18, v26, 4, v25
    v_xor_b32 v26, 4, v24
    v_lshl_add_u32 v19, v26, 4, v27
    v_xor_b32 v26, 8, v24
    v_lshl_add_u32 v20, v26, 4, v25
    v_xor_b32 v26, 12, v24
    v_lshl_add_u32 v21, v26, 4, v27
    s_mov_b32 s40, s71
    s_mov_b32 s41, s72
    s_mov_b32 s44, s74
    s_mov_b32 s45, s75
    s_mov_b32 s95, s82
    s_mov_b32 s96, s83
    s_mov_b32 s97, s84
    s_mov_b32 s98, s85
    s_mov_b32 s99, s86
    s_mov_b32 s100, s87
    s_mov_b32 s101, s88
    s_add_u32 m0, s61, 0
    s_nop 0
    buffer_load_dwordx4 v16, s[40:43], s48 offen offset:0 lds
    buffer_load_dwordx4 v17, s[40:43], s48 offen offset:1024 lds
    s_add_u32 s48, s48, 128
    buffer_load_dwordx4 v16, s[40:43], s49 offen offset:2048 lds
    buffer_load_dwordx4 v17, s[40:43], s49 offen offset:3072 lds
    s_add_u32 s49, s49, 128
    s_add_u32 m0, s61, 4096
    s_nop 0
    buffer_load_dwordx4 v16, s[40:43], s50 offen offset:0 lds
    buffer_load_dwordx4 v17, s[40:43], s50 offen offset:1024 lds
    s_add_u32 s50, s50, 128
    buffer_load_dwordx4 v16, s[40:43], s51 offen offset:2048 lds
    buffer_load_dwordx4 v17, s[40:43], s51 offen offset:3072 lds
    s_add_u32 s51, s51, 128
    s_add_u32 s61, s61, 32768
    s_cmp_ge_u32 s61, 98304
    s_cselect_b32 s90, 98304, 0
    s_sub_u32 s61, s61, s90
    s_add_u32 m0, s62, 0
    s_nop 0
    buffer_load_dwordx4 v18, s[44:47], s52 offen offset:0 lds
    buffer_load_dwordx4 v19, s[44:47], s52 offen offset:1024 lds
    s_add_u32 s52, s52, s56
    buffer_load_dwordx4 v18, s[44:47], s53 offen offset:2048 lds
    buffer_load_dwordx4 v19, s[44:47], s53 offen offset:3072 lds
    s_add_u32 s53, s53, s56
    s_add_u32 m0, s62, 4096
    s_nop 0
    buffer_load_dwordx4 v20, s[44:47], s54 offen offset:0 lds
    buffer_load_dwordx4 v21, s[44:47], s54 offen offset:1024 lds
    s_add_u32 s54, s54, s56
    buffer_load_dwordx4 v20, s[44:47], s55 offen offset:2048 lds
    buffer_load_dwordx4 v21, s[44:47], s55 offen offset:3072 lds
    s_add_u32 s55, s55, s56
    s_xor_b32 s62, s62, 229376
    s_cmp_ge_u32 s68, 16
    s_cbranch_scc1 m_typea7
    s_bfe_u32 s69, s68, 0x20002
    s_add_u32 s69, s69, 4
    s_and_b32 s90, s2, 7
    s_lshl_b32 s90, s90, 2
    s_and_b32 s91, s68, 3
    s_add_u32 s90, s90, s91
    s_cmp_lt_u32 s90, 16
    s_cselect_b32 s83, 0, 1
    s_mov_b32 s91, 33554432
    s_cselect_b32 s85, 16777216, s91
    s_mov_b32 s91, 8192
    s_cselect_b32 s86, 1024, s91
    s_mov_b32 s91, 1024
    s_cselect_b32 s87, 4096, s91
    s_cselect_b32 s74, s36, s38
    s_cselect_b32 s75, s37, s39
    s_mov_b32 s71, s32
    s_mov_b32 s72, s33
    s_mov_b32 s73, 2097152
    s_mov_b32 s77, 1024
    s_mov_b32 s82, 8
    s_mov_b32 s81, 0
    s_mov_b32 s76, 4194304
    s_mov_b32 s78, 8192
    s_mov_b32 s84, 0
    s_and_b32 s90, s90, 15
    s_lshl_b32 s80, s90, 9
    s_lshl_b32 s79, s69, 18
    s_lshl_b32 s91, s83, 2
    s_add_u32 s91, s91, s69
    s_cmp_ge_u32 s69, 4
    s_cselect_b32 s92, 508, 8
    s_add_u32 s91, s91, s92
    s_lshl_b32 s88, s90, 4
    s_add_u32 s88, s88, s91
    s_lshl_b32 s88, s88, 3
    s_lshl_b32 s91, s90, 1
    s_add_u32 s91, s91, s58
    s_lshl_b32 s91, s91, 19
    s_lshl_b32 s92, s69, 1
    s_add_u32 s92, s92, s57
    s_lshl_b32 s92, s92, 15
    s_add_u32 s85, s85, s91
    s_add_u32 s85, s85, s92
    s_branch m_go28
m_typea7:
    s_and_b32 s69, s68, 3
    s_and_b32 s90, s2, 1
    s_lshl_b32 s90, s90, 2
    s_add_u32 s69, s69, s90
    s_bfe_u32 s90, s2, 0x20001
    s_mul_i32 s90, s90, 3
    s_bfe_u32 s91, s68, 0x20002
    s_add_u32 s90, s90, s91
    s_mov_b32 s76, 6291456
    s_mov_b32 s78, 6144
    s_mov_b32 s81, 1
    s_mov_b32 s73, 4194304
    s_mov_b32 s77, 2048
    s_mov_b32 s82, 16
    s_lshl_b32 s80, s90, 9
    s_lshl_b32 s79, s69, 19
    s_and_b32 s92, s90, 3
    s_lshr_b32 s91, s90, 2
    s_lshl_b32 s88, s92, 2
    s_add_u32 s88, s88, s91
    s_lshl_b32 s88, s88, 3
    s_add_u32 s88, s88, s69
    s_lshl_b32 s88, s88, 3
    s_add_u32 s88, s88, 6144
    s_cmp_eq_u32 s91, 0
    s_cselect_b32 s84, 1048744942, 0
    s_lshl_b32 s93, s91, 22
    s_add_u32 s85, s93, 50331648
    s_lshl_b32 s92, s92, 1
    s_add_u32 s92, s92, s58
    s_lshl_b32 s92, s92, 19
    s_add_u32 s85, s85, s92
    s_lshl_b32 s92, s57, 3
    s_add_u32 s92, s92, s69
    s_cmp_eq_u32 s91, 2
    s_cselect_b32 s83, 1, 0
    s_cselect_b32 s93, 12, 13
    s_mov_b32 s91, 131072
    s_cselect_b32 s86, 1024, s91
    s_mov_b32 s91, 1024
    s_cselect_b32 s87, 65536, s91
    s_lshl_b32 s92, s92, s93
    s_add_u32 s85, s85, s92
    s_mov_b32 s71, s24
    s_mov_b32 s72, s25
    s_mov_b32 s74, s26
    s_mov_b32 s75, s27
m_go28:
    s_xor_b32 s94, s70, 1
    s_mov_b32 s67, 2
    s_mov_b32 s17, -1
    s_mov_b32 s12, s4
    s_mov_b32 s13, s5
    s_mov_b32 s14, 256
    s_mov_b32 s15, 0x20000
    s_lshl_b32 s90, s2, 2
    s_add_u32 s90, s90, s16
    s_cmp_lg_u32 s90, 0
    s_cbranch_scc1 m_tok9
    s_memrealtime s[92:93]
    s_waitcnt lgkmcnt(0)
    s_or_b32 s92, s92, 1
    v_mov_b32 v4, s92
    v_mov_b32 v5, s93
    s_mov_b64 exec, 1
    buffer_store_dwordx2 v[4:5], off, s[12:15], 0 sc1
    s_mov_b64 exec, -1
m_tok9:
    s_add_u32 m0, s61, 0
    s_nop 0
    buffer_load_dwordx4 v16, s[40:43], s48 offen offset:0 lds
    buffer_load_dwordx4 v17, s[40:43], s48 offen offset:1024 lds
    s_add_u32 s48, s48, 128
    buffer_load_dwordx4 v16, s[40:43], s49 offen offset:2048 lds
    buffer_load_dwordx4 v17, s[40:43], s49 offen offset:3072 lds
    s_add_u32 s49, s49, 128
    s_add_u32 m0, s61, 4096
    s_nop 0
    buffer_load_dwordx4 v16, s[40:43], s50 offen offset:0 lds
    buffer_load_dwordx4 v17, s[40:43], s50 offen offset:1024 lds
    s_add_u32 s50, s50, 128
    buffer_load_dwordx4 v16, s[40:43], s51 offen offset:2048 lds
    buffer_load_dwordx4 v17, s[40:43], s51 offen offset:3072 lds
    s_add_u32 s51, s51, 128
    s_add_u32 s61, s61, 32768
    s_cmp_ge_u32 s61, 98304
    s_cselect_b32 s90, 98304, 0
    s_sub_u32 s61, s61, s90
    s_add_u32 m0, s62, 0
    s_nop 0
    buffer_load_dwordx4 v18, s[44:47], s52 offen offset:0 lds
    buffer_load_dwordx4 v19, s[44:47], s52 offen offset:1024 lds
    s_add_u32 s52, s52, s56
    buffer_load_dwordx4 v18, s[44:47], s53 offen offset:2048 lds
    buffer_load_dwordx4 v19, s[44:47], s53 offen offset:3072 lds
    s_add_u32 s53, s53, s56
    s_add_u32 m0, s62, 4096
    s_nop 0
    buffer_load_dwordx4 v20, s[44:47], s54 offen offset:0 lds
    buffer_load_dwordx4 v21, s[44:47], s54 offen offset:1024 lds
    s_add_u32 s54, s54, s56
    buffer_load_dwordx4 v20, s[44:47], s55 offen offset:2048 lds
    buffer_load_dwordx4 v21, s[44:47], s55 offen offset:3072 lds
    s_add_u32 s55, s55, s56
    s_xor_b32 s62, s62, 229376
    s_waitcnt vmcnt(16)
    s_barrier
    ds_read_b64_tr_b16 a[64:65], v8 offset:0
    ds_read_b64_tr_b16 a[66:67], v8 offset:2048
    ds_read_b128 a[0:3], v6 offset:0
    ds_read_b128 a[4:7], v6 offset:2048
    ds_read_b64_tr_b16 a[68:69], v9 offset:0
    ds_read_b64_tr_b16 a[70:71], v9 offset:2048
    ds_read_b128 a[8:11], v6 offset:4096
    ds_read_b128 a[12:15], v6 offset:6144
    ds_read_b64_tr_b16 a[72:73], v10 offset:0
    ds_read_b64_tr_b16 a[74:75], v10 offset:2048
    ds_read_b128 a[16:19], v6 offset:8192
    ds_read_b128 a[20:23], v6 offset:10240
    ds_read_b64_tr_b16 a[76:77], v11 offset:0
    ds_read_b64_tr_b16 a[78:79], v11 offset:2048
    ds_read_b128 a[24:27], v6 offset:12288
    ds_read_b128 a[28:31], v6 offset:14336
    ds_read_b64_tr_b16 a[80:81], v12 offset:0
    ds_read_b64_tr_b16 a[82:83], v12 offset:2048
    ds_read_b64_tr_b16 a[84:85], v13 offset:0
    ds_read_b64_tr_b16 a[86:87], v13 offset:2048
    ds_read_b64_tr_b16 a[88:89], v14 offset:0
    ds_read_b64_tr_b16 a[90:91], v14 offset:2048
    ds_read_b64_tr_b16 a[92:93], v15 offset:0
    ds_read_b64_tr_b16 a[94:95], v15 offset:2048
    s_mov_b32 s66, 1
    s_mov_b32 s24, s6
    s_mov_b32 s25, s7
    s_mov_b32 s26, 0
    s_mov_b32 s27, 0x20000
    s_mov_b32 s28, 0
    s_mov_b32 s29, 0
    s_mov_b32 s30, 0
    s_mov_b32 s31, 0
m_tile10:
    s_mov_b32 s65, s95
    s_cmp_eq_u32 s96, 1
    s_cbranch_scc1 m_swp12
    s_waitcnt lgkmcnt(15)
    v_mfma_f32_16x16x32_bf16 v[32:35], a[64:67], a[0:3], 0
    v_mfma_f32_16x16x32_bf16 v[40:43], a[64:67], a[4:7], 0
    v_mfma_f32_16x16x32_bf16 v[48:51], a[64:67], a[8:11], 0
    v_mfma_f32_16x16x32_bf16 v[56:59], a[64:67], a[12:15], 0
    s_add_u32 m0, s61, 0
    s_waitcnt lgkmcnt(13)
    v_mfma_f32_16x16x32_bf16 v[64:67], a[64:67], a[16:19], 0
    buffer_load_dwordx4 v16, s[40:43], s48 offen offset:0 lds
    s_waitcnt lgkmcnt(12)
    v_mfma_f32_16x16x32_bf16 v[72:75], a[64:67], a[20:23], 0
    s_waitcnt lgkmcnt(9)
    v_mfma_f32_16x16x32_bf16 v[80:83], a[64:67], a[24:27], 0
    s_waitcnt lgkmcnt(8)
    v_mfma_f32_16x16x32_bf16 v[88:91], a[64:67], a[28:31], 0
    ds_read_b64_tr_b16 a[64:65], v8 offset:16384
    v_mfma_f32_16x16x32_bf16 v[36:39], a[68:71], a[0:3], 0
    ds_read_b64_tr_b16 a[66:67], v8 offset:18432
    v_mfma_f32_16x16x32_bf16 v[44:47], a[68:71], a[4:7], 0
    v_mfma_f32_16x16x32_bf16 v[52:55], a[68:71], a[8:11], 0
    ds_read_b128 a[32:35], v7 offset:0
    v_mfma_f32_16x16x32_bf16 v[60:63], a[68:71], a[12:15], 0
    v_mfma_f32_16x16x32_bf16 v[68:71], a[68:71], a[16:19], 0
    buffer_load_dwordx4 v17, s[40:43], s48 offen offset:1024 lds
    v_mfma_f32_16x16x32_bf16 v[76:79], a[68:71], a[20:23], 0
    s_add_u32 s48, s48, 128
    v_mfma_f32_16x16x32_bf16 v[84:87], a[68:71], a[24:27], 0
    ds_read_b128 a[36:39], v7 offset:2048
    v_mfma_f32_16x16x32_bf16 v[92:95], a[68:71], a[28:31], 0
    ds_read_b64_tr_b16 a[68:69], v9 offset:16384
    v_mfma_f32_16x16x32_bf16 v[96:99], a[72:75], a[0:3], 0
    ds_read_b64_tr_b16 a[70:71], v9 offset:18432
    v_mfma_f32_16x16x32_bf16 v[104:107], a[72:75], a[4:7], 0
    v_mfma_f32_16x16x32_bf16 v[112:115], a[72:75], a[8:11], 0
    ds_read_b128 a[40:43], v7 offset:4096
    v_mfma_f32_16x16x32_bf16 v[120:123], a[72:75], a[12:15], 0
    v_mfma_f32_16x16x32_bf16 v[128:131], a[72:75], a[16:19], 0
    buffer_load_dwordx4 v16, s[40:43], s49 offen offset:2048 lds
    v_mfma_f32_16x16x32_bf16 v[136:139], a[72:75], a[20:23], 0
    v_mfma_f32_16x16x32_bf16 v[144:147], a[72:75], a[24:27], 0
    ds_read_b128 a[44:47], v7 offset:6144
    v_mfma_f32_16x16x32_bf16 v[152:155], a[72:75], a[28:31], 0
    ds_read_b64_tr_b16 a[72:73], v10 offset:16384
    v_mfma_f32_16x16x32_bf16 v[100:103], a[76:79], a[0:3], 0
    ds_read_b64_tr_b16 a[74:75], v10 offset:18432
    v_mfma_f32_16x16x32_bf16 v[108:111], a[76:79], a[4:7], 0
    v_mfma_f32_16x16x32_bf16 v[116:119], a[76:79], a[8:11], 0
    ds_read_b128 a[48:51], v7 offset:8192
    v_mfma_f32_16x16x32_bf16 v[124:127], a[76:79], a[12:15], 0
    v_mfma_f32_16x16x32_bf16 v[132:135], a[76:79], a[16:19], 0
    buffer_load_dwordx4 v17, s[40:43], s49 offen offset:3072 lds
    v_mfma_f32_16x16x32_bf16 v[140:143], a[76:79], a[20:23], 0
    s_add_u32 s49, s49, 128
    v_mfma_f32_16x16x32_bf16 v[148:151], a[76:79], a[24:27], 0
    ds_read_b128 a[52:55], v7 offset:10240
    v_mfma_f32_16x16x32_bf16 v[156:159], a[76:79], a[28:31], 0
    ds_read_b64_tr_b16 a[76:77], v11 offset:16384
    s_waitcnt lgkmcnt(15)
    v_mfma_f32_16x16x32_bf16 v[160:163], a[80:83], a[0:3], 0
    ds_read_b64_tr_b16 a[78:79], v11 offset:18432
    v_mfma_f32_16x16x32_bf16 v[168:171], a[80:83], a[4:7], 0
    v_mfma_f32_16x16x32_bf16 v[176:179], a[80:83], a[8:11], 0
    ds_read_b128 a[56:59], v7 offset:12288
    v_mfma_f32_16x16x32_bf16 v[184:187], a[80:83], a[12:15], 0
    s_add_u32 m0, s61, 4096
    v_mfma_f32_16x16x32_bf16 v[192:195], a[80:83], a[16:19], 0
    buffer_load_dwordx4 v16, s[40:43], s50 offen offset:0 lds
    v_mfma_f32_16x16x32_bf16 v[200:203], a[80:83], a[20:23], 0
    v_mfma_f32_16x16x32_bf16 v[208:211], a[80:83], a[24:27], 0
    s_add_u32 s61, s61, 32768
    ds_read_b128 a[60:63], v7 offset:14336
    v_mfma_f32_16x16x32_bf16 v[216:219], a[80:83], a[28:31], 0
    s_cmp_ge_u32 s61, 98304
    s_cselect_b32 s90, 98304, 0
    ds_read_b64_tr_b16 a[80:81], v12 offset:16384
    v_mfma_f32_16x16x32_bf16 v[164:167], a[84:87], a[0:3], 0
    s_sub_u32 s61, s61, s90
    ds_read_b64_tr_b16 a[82:83], v12 offset:18432
    v_mfma_f32_16x16x32_bf16 v[172:175], a[84:87], a[4:7], 0
    s_add_u32 s64, s64, 32768
    v_mfma_f32_16x16x32_bf16 v[180:183], a[84:87], a[8:11], 0
    buffer_store_dwordx4 a[128:131], v2, s[24:27], s28 offen sc1
    v_mfma_f32_16x16x32_bf16 v[188:191], a[84:87], a[12:15], 0
    s_add_u32 s28, s28, s31
    v_mfma_f32_16x16x32_bf16 v[196:199], a[84:87], a[16:19], 0
    buffer_load_dwordx4 v17, s[40:43], s50 offen offset:1024 lds
    v_mfma_f32_16x16x32_bf16 v[204:207], a[84:87], a[20:23], 0
    s_add_u32 s50, s50, 128
    v_mfma_f32_16x16x32_bf16 v[212:215], a[84:87], a[24:27], 0
    s_cmp_ge_u32 s64, 98304
    s_cselect_b32 s63, 4294901760, s59
    s_cselect_b32 s64, 0, s64
    v_mfma_f32_16x16x32_bf16 v[220:223], a[84:87], a[28:31], 0
    ds_read_b64_tr_b16 a[84:85], v13 offset:16384
    v_mfma_f32_16x16x32_bf16 v[224:227], a[88:91], a[0:3], 0
    ds_read_b64_tr_b16 a[86:87], v13 offset:18432
    v_mfma_f32_16x16x32_bf16 v[232:235], a[88:91], a[4:7], 0
    v_mfma_f32_16x16x32_bf16 v[240:243], a[88:91], a[8:11], 0
    buffer_store_dwordx4 a[132:135], v2, s[24:27], s28 offen sc1
    v_mfma_f32_16x16x32_bf16 v[248:251], a[88:91], a[12:15], 0
    s_add_u32 s28, s28, s31
    v_mfma_f32_16x16x32_bf16 a[96:99], a[88:91], a[16:19], 0
    buffer_load_dwordx4 v16, s[40:43], s51 offen offset:2048 lds
    v_mfma_f32_16x16x32_bf16 a[104:107], a[88:91], a[20:23], 0
    v_mfma_f32_16x16x32_bf16 a[112:115], a[88:91], a[24:27], 0
    v_mfma_f32_16x16x32_bf16 a[120:123], a[88:91], a[28:31], 0
    ds_read_b64_tr_b16 a[88:89], v14 offset:16384
    s_waitcnt lgkmcnt(15)
    v_mfma_f32_16x16x32_bf16 v[228:231], a[92:95], a[0:3], 0
    ds_read_b64_tr_b16 a[90:91], v14 offset:18432
    v_mfma_f32_16x16x32_bf16 v[236:239], a[92:95], a[4:7], 0
    v_add_u32 v6, s63, v6
    v_add_u32 v7, s63, v7
    v_mfma_f32_16x16x32_bf16 v[244:247], a[92:95], a[8:11], 0
    buffer_store_dwordx4 a[136:139], v2, s[24:27], s28 offen sc1
    v_mfma_f32_16x16x32_bf16 v[252:255], a[92:95], a[12:15], 0
    s_add_u32 s28, s28, s31
    v_mfma_f32_16x16x32_bf16 a[100:103], a[92:95], a[16:19], 0
    buffer_load_dwordx4 v17, s[40:43], s51 offen offset:3072 lds
    v_mfma_f32_16x16x32_bf16 a[108:111], a[92:95], a[20:23], 0
    s_add_u32 s51, s51, 128
    v_mfma_f32_16x16x32_bf16 a[116:119], a[92:95], a[24:27], 0
    v_mfma_f32_16x16x32_bf16 a[124:127], a[92:95], a[28:31], 0
    ds_read_b64_tr_b16 a[92:93], v15 offset:16384
    ds_read_b64_tr_b16 a[94:95], v15 offset:18432
    v_mfma_f32_16x16x32_bf16 v[32:35], a[64:67], a[32:35], v[32:35]
    v_xor_b32 v8, s60, v8
    v_xor_b32 v9, s60, v9
    v_mfma_f32_16x16x32_bf16 v[40:43], a[64:67], a[36:39], v[40:43]
    v_xor_b32 v10, s60, v10
    v_xor_b32 v11, s60, v11
    s_waitcnt lgkmcnt(15)
    v_mfma_f32_16x16x32_bf16 v[48:51], a[64:67], a[40:43], v[48:51]
    v_xor_b32 v12, s60, v12
    v_xor_b32 v13, s60, v13
    v_mfma_f32_16x16x32_bf16 v[56:59], a[64:67], a[44:47], v[56:59]
    v_xor_b32 v14, s60, v14
    v_xor_b32 v15, s60, v15
    s_waitcnt lgkmcnt(13)
    v_mfma_f32_16x16x32_bf16 v[64:67], a[64:67], a[48:51], v[64:67]
    s_waitcnt lgkmcnt(12)
    v_mfma_f32_16x16x32_bf16 v[72:75], a[64:67], a[52:55], v[72:75]
    s_waitcnt lgkmcnt(9)
    v_mfma_f32_16x16x32_bf16 v[80:83], a[64:67], a[56:59], v[80:83]
    s_waitcnt vmcnt(11) lgkmcnt(0)
    v_mfma_f32_16x16x32_bf16 v[88:91], a[64:67], a[60:63], v[88:91]
    s_barrier
    ds_read_b64_tr_b16 a[64:65], v8 offset:0
    v_mfma_f32_16x16x32_bf16 v[36:39], a[68:71], a[32:35], v[36:39]
    s_add_u32 m0, s62, 0
    ds_read_b64_tr_b16 a[66:67], v8 offset:2048
    v_mfma_f32_16x16x32_bf16 v[44:47], a[68:71], a[36:39], v[44:47]
    buffer_load_dwordx4 v18, s[44:47], s52 offen offset:0 lds
    v_mfma_f32_16x16x32_bf16 v[52:55], a[68:71], a[40:43], v[52:55]
    ds_read_b128 a[0:3], v6 offset:0
    v_mfma_f32_16x16x32_bf16 v[60:63], a[68:71], a[44:47], v[60:63]
    v_mfma_f32_16x16x32_bf16 v[68:71], a[68:71], a[48:51], v[68:71]
    v_mfma_f32_16x16x32_bf16 v[76:79], a[68:71], a[52:55], v[76:79]
    buffer_load_dwordx4 v19, s[44:47], s52 offen offset:1024 lds
    v_mfma_f32_16x16x32_bf16 v[84:87], a[68:71], a[56:59], v[84:87]
    s_add_u32 s52, s52, s56
    ds_read_b128 a[4:7], v6 offset:2048
    v_mfma_f32_16x16x32_bf16 v[92:95], a[68:71], a[60:63], v[92:95]
    ds_read_b64_tr_b16 a[68:69], v9 offset:0
    v_mfma_f32_16x16x32_bf16 v[96:99], a[72:75], a[32:35], v[96:99]
    ds_read_b64_tr_b16 a[70:71], v9 offset:2048
    v_mfma_f32_16x16x32_bf16 v[104:107], a[72:75], a[36:39], v[104:107]
    buffer_load_dwordx4 v18, s[44:47], s53 offen offset:2048 lds
    v_mfma_f32_16x16x32_bf16 v[112:115], a[72:75], a[40:43], v[112:115]
    ds_read_b128 a[8:11], v6 offset:4096
    v_mfma_f32_16x16x32_bf16 v[120:123], a[72:75], a[44:47], v[120:123]
    v_mfma_f32_16x16x32_bf16 v[128:131], a[72:75], a[48:51], v[128:131]
    v_mfma_f32_16x16x32_bf16 v[136:139], a[72:75], a[52:55], v[136:139]
    buffer_load_dwordx4 v19, s[44:47], s53 offen offset:3072 lds
    v_mfma_f32_16x16x32_bf16 v[144:147], a[72:75], a[56:59], v[144:147]
    s_add_u32 s53, s53, s56
    ds_read_b128 a[12:15], v6 offset:6144
    v_mfma_f32_16x16x32_bf16 v[152:155], a[72:75], a[60:63], v[152:155]
    ds_read_b64_tr_b16 a[72:73], v10 offset:0
    v_mfma_f32_16x16x32_bf16 v[100:103], a[76:79], a[32:35], v[100:103]
    s_add_u32 m0, s62, 4096
    ds_read_b64_tr_b16 a[74:75], v10 offset:2048
    v_mfma_f32_16x16x32_bf16 v[108:111], a[76:79], a[36:39], v[108:111]
    buffer_load_dwordx4 v20, s[44:47], s54 offen offset:0 lds
    v_mfma_f32_16x16x32_bf16 v[116:119], a[76:79], a[40:43], v[116:119]
    ds_read_b128 a[16:19], v6 offset:8192
    v_mfma_f32_16x16x32_bf16 v[124:127], a[76:79], a[44:47], v[124:127]
    s_xor_b32 s62, s62, 229376
    v_mfma_f32_16x16x32_bf16 v[132:135], a[76:79], a[48:51], v[132:135]
    v_mfma_f32_16x16x32_bf16 v[140:143], a[76:79], a[52:55], v[140:143]
    buffer_load_dwordx4 v21, s[44:47], s54 offen offset:1024 lds
    v_mfma_f32_16x16x32_bf16 v[148:151], a[76:79], a[56:59], v[148:151]
    s_add_u32 s54, s54, s56
    ds_read_b128 a[20:23], v6 offset:10240
    v_mfma_f32_16x16x32_bf16 v[156:159], a[76:79], a[60:63], v[156:159]
    ds_read_b64_tr_b16 a[76:77], v11 offset:0
    v_mfma_f32_16x16x32_bf16 v[160:163], a[80:83], a[32:35], v[160:163]
    ds_read_b64_tr_b16 a[78:79], v11 offset:2048
    v_mfma_f32_16x16x32_bf16 v[168:171], a[80:83], a[36:39], v[168:171]
    buffer_load_dwordx4 v20, s[44:47], s55 offen offset:2048 lds
    v_mfma_f32_16x16x32_bf16 v[176:179], a[80:83], a[40:43], v[176:179]
    ds_read_b128 a[24:27], v6 offset:12288
    v_mfma_f32_16x16x32_bf16 v[184:187], a[80:83], a[44:47], v[184:187]
    v_mfma_f32_16x16x32_bf16 v[192:195], a[80:83], a[48:51], v[192:195]
    v_mfma_f32_16x16x32_bf16 v[200:203], a[80:83], a[52:55], v[200:203]
    buffer_load_dwordx4 v21, s[44:47], s55 offen offset:3072 lds
    v_mfma_f32_16x16x32_bf16 v[208:211], a[80:83], a[56:59], v[208:211]
    s_add_u32 s55, s55, s56
    ds_read_b128 a[28:31], v6 offset:14336
    v_mfma_f32_16x16x32_bf16 v[216:219], a[80:83], a[60:63], v[216:219]
    ds_read_b64_tr_b16 a[80:81], v12 offset:0
    v_mfma_f32_16x16x32_bf16 v[164:167], a[84:87], a[32:35], v[164:167]
    ds_read_b64_tr_b16 a[82:83], v12 offset:2048
    v_mfma_f32_16x16x32_bf16 v[172:175], a[84:87], a[36:39], v[172:175]
    v_mfma_f32_16x16x32_bf16 v[180:183], a[84:87], a[40:43], v[180:183]
    buffer_store_dwordx4 a[140:143], v2, s[24:27], s28 offen sc1
    v_mfma_f32_16x16x32_bf16 v[188:191], a[84:87], a[44:47], v[188:191]
    s_add_u32 s28, s28, s31
    v_mfma_f32_16x16x32_bf16 v[196:199], a[84:87], a[48:51], v[196:199]
    v_mfma_f32_16x16x32_bf16 v[204:207], a[84:87], a[52:55], v[204:207]
    v_mfma_f32_16x16x32_bf16 v[212:215], a[84:87], a[56:59], v[212:215]
    buffer_store_dwordx4 a[144:147], v2, s[24:27], s28 offen sc1
    v_mfma_f32_16x16x32_bf16 v[220:223], a[84:87], a[60:63], v[220:223]
    s_add_u32 s28, s28, s31
    ds_read_b64_tr_b16 a[84:85], v13 offset:0
    v_mfma_f32_16x16x32_bf16 v[224:227], a[88:91], a[32:35], v[224:227]
    ds_read_b64_tr_b16 a[86:87], v13 offset:2048
    v_mfma_f32_16x16x32_bf16 v[232:235], a[88:91], a[36:39], v[232:235]
    v_mfma_f32_16x16x32_bf16 v[240:243], a[88:91], a[40:43], v[240:243]
    buffer_store_dwordx4 a[148:151], v2, s[24:27], s28 offen sc1
    v_mfma_f32_16x16x32_bf16 v[248:251], a[88:91], a[44:47], v[248:251]
    s_add_u32 s28, s28, s31
    v_mfma_f32_16x16x32_bf16 a[96:99], a[88:91], a[48:51], a[96:99]
    v_mfma_f32_16x16x32_bf16 a[104:107], a[88:91], a[52:55], a[104:107]
    v_mfma_f32_16x16x32_bf16 a[112:115], a[88:91], a[56:59], a[112:115]
    buffer_store_dwordx4 a[152:155], v2, s[24:27], s28 offen sc1
    v_mfma_f32_16x16x32_bf16 a[120:123], a[88:91], a[60:63], a[120:123]
    s_add_u32 s28, s28, s31
    ds_read_b64_tr_b16 a[88:89], v14 offset:0
    v_mfma_f32_16x16x32_bf16 v[228:231], a[92:95], a[32:35], v[228:231]
    ds_read_b64_tr_b16 a[90:91], v14 offset:2048
    v_mfma_f32_16x16x32_bf16 v[236:239], a[92:95], a[36:39], v[236:239]
    v_mfma_f32_16x16x32_bf16 v[244:247], a[92:95], a[40:43], v[244:247]
    buffer_store_dwordx4 a[156:159], v2, s[24:27], s28 offen sc1
    v_mfma_f32_16x16x32_bf16 v[252:255], a[92:95], a[44:47], v[252:255]
    s_add_u32 s29, s29, s30
    s_mov_b32 s28, s29
    v_mfma_f32_16x16x32_bf16 a[100:103], a[92:95], a[48:51], a[100:103]
    s_sub_u32 s65, s65, 1
    v_mfma_f32_16x16x32_bf16 a[108:111], a[92:95], a[52:55], a[108:111]
    v_mfma_f32_16x16x32_bf16 a[116:119], a[92:95], a[56:59], a[116:119]
    v_mfma_f32_16x16x32_bf16 a[124:127], a[92:95], a[60:63], a[124:127]
    ds_read_b64_tr_b16 a[92:93], v15 offset:0
    ds_read_b64_tr_b16 a[94:95], v15 offset:2048
    s_waitcnt lgkmcnt(15)
    v_mfma_f32_16x16x32_bf16 v[32:35], a[64:67], a[0:3], v[32:35]
    v_mfma_f32_16x16x32_bf16 v[40:43], a[64:67], a[4:7], v[40:43]
    v_mfma_f32_16x16x32_bf16 v[48:51], a[64:67], a[8:11], v[48:51]
    v_mfma_f32_16x16x32_bf16 v[56:59], a[64:67], a[12:15], v[56:59]
    s_add_u32 m0, s61, 0
    s_waitcnt lgkmcnt(13)
    v_mfma_f32_16x16x32_bf16 v[64:67], a[64:67], a[16:19], v[64:67]
    buffer_load_dwordx4 v16, s[40:43], s48 offen offset:0 lds
    s_waitcnt lgkmcnt(12)
    v_mfma_f32_16x16x32_bf16 v[72:75], a[64:67], a[20:23], v[72:75]
    s_waitcnt lgkmcnt(9)
    v_mfma_f32_16x16x32_bf16 v[80:83], a[64:67], a[24:27], v[80:83]
    s_waitcnt lgkmcnt(8)
    v_mfma_f32_16x16x32_bf16 v[88:91], a[64:67], a[28:31], v[88:91]
    ds_read_b64_tr_b16 a[64:65], v8 offset:16384
    v_mfma_f32_16x16x32_bf16 v[36:39], a[68:71], a[0:3], v[36:39]
    ds_read_b64_tr_b16 a[66:67], v8 offset:18432
    v_mfma_f32_16x16x32_bf16 v[44:47], a[68:71], a[4:7], v[44:47]
    v_mfma_f32_16x16x32_bf16 v[52:55], a[68:71], a[8:11], v[52:55]
    ds_read_b128 a[32:35], v7 offset:0
    v_mfma_f32_16x16x32_bf16 v[60:63], a[68:71], a[12:15], v[60:63]
    v_mfma_f32_16x16x32_bf16 v[68:71], a[68:71], a[16:19], v[68:71]
    buffer_load_dwordx4 v17, s[40:43], s48 offen offset:1024 lds
    v_mfma_f32_16x16x32_bf16 v[76:79], a[68:71], a[20:23], v[76:79]
    s_add_u32 s48, s48, 128
    v_mfma_f32_16x16x32_bf16 v[84:87], a[68:71], a[24:27], v[84:87]
    ds_read_b128 a[36:39], v7 offset:2048
    v_mfma_f32_16x16x32_bf16 v[92:95], a[68:71], a[28:31], v[92:95]
    ds_read_b64_tr_b16 a[68:69], v9 offset:16384
    v_mfma_f32_16x16x32_bf16 v[96:99], a[72:75], a[0:3], v[96:99]
    ds_read_b64_tr_b16 a[70:71], v9 offset:18432
    v_mfma_f32_16x16x32_bf16 v[104:107], a[72:75], a[4:7], v[104:107]
    v_mfma_f32_16x16x32_bf16 v[112:115], a[72:75], a[8:11], v[112:115]
    ds_read_b128 a[40:43], v7 offset:4096
    v_mfma_f32_16x16x32_bf16 v[120:123], a[72:75], a[12:15], v[120:123]
    v_mfma_f32_16x16x32_bf16 v[128:131], a[72:75], a[16:19], v[128:131]
    buffer_load_dwordx4 v16, s[40:43], s49 offen offset:2048 lds
    v_mfma_f32_16x16x32_bf16 v[136:139], a[72:75], a[20:23], v[136:139]
    v_mfma_f32_16x16x32_bf16 v[144:147], a[72:75], a[24:27], v[144:147]
    ds_read_b128 a[44:47], v7 offset:6144
    v_mfma_f32_16x16x32_bf16 v[152:155], a[72:75], a[28:31], v[152:155]
    ds_read_b64_tr_b16 a[72:73], v10 offset:16384
    v_mfma_f32_16x16x32_bf16 v[100:103], a[76:79], a[0:3], v[100:103]
    ds_read_b64_tr_b16 a[74:75], v10 offset:18432
    v_mfma_f32_16x16x32_bf16 v[108:111], a[76:79], a[4:7], v[108:111]
    v_mfma_f32_16x16x32_bf16 v[116:119], a[76:79], a[8:11], v[116:119]
    ds_read_b128 a[48:51], v7 offset:8192
    v_mfma_f32_16x16x32_bf16 v[124:127], a[76:79], a[12:15], v[124:127]
    v_mfma_f32_16x16x32_bf16 v[132:135], a[76:79], a[16:19], v[132:135]
    buffer_load_dwordx4 v17, s[40:43], s49 offen offset:3072 lds
    v_mfma_f32_16x16x32_bf16 v[140:143], a[76:79], a[20:23], v[140:143]
    s_add_u32 s49, s49, 128
    v_mfma_f32_16x16x32_bf16 v[148:151], a[76:79], a[24:27], v[148:151]
    ds_read_b128 a[52:55], v7 offset:10240
    v_mfma_f32_16x16x32_bf16 v[156:159], a[76:79], a[28:31], v[156:159]
    ds_read_b64_tr_b16 a[76:77], v11 offset:16384
    s_waitcnt lgkmcnt(15)
    v_mfma_f32_16x16x32_bf16 v[160:163], a[80:83], a[0:3], v[160:163]
    ds_read_b64_tr_b16 a[78:79], v11 offset:18432
    v_mfma_f32_16x16x32_bf16 v[168:171], a[80:83], a[4:7], v[168:171]
    v_mfma_f32_16x16x32_bf16 v[176:179], a[80:83], a[8:11], v[176:179]
    ds_read_b128 a[56:59], v7 offset:12288
    v_mfma_f32_16x16x32_bf16 v[184:187], a[80:83], a[12:15], v[184:187]
    s_add_u32 m0, s61, 4096
    v_mfma_f32_16x16x32_bf16 v[192:195], a[80:83], a[16:19], v[192:195]
    buffer_load_dwordx4 v16, s[40:43], s50 offen offset:0 lds
    v_mfma_f32_16x16x32_bf16 v[200:203], a[80:83], a[20:23], v[200:203]
    v_mfma_f32_16x16x32_bf16 v[208:211], a[80:83], a[24:27], v[208:211]
    s_add_u32 s61, s61, 32768
    ds_read_b128 a[60:63], v7 offset:14336
    v_mfma_f32_16x16x32_bf16 v[216:219], a[80:83], a[28:31], v[216:219]
    s_cmp_ge_u32 s61, 98304
    s_cselect_b32 s90, 98304, 0
    ds_read_b64_tr_b16 a[80:81], v12 offset:16384
    v_mfma_f32_16x16x32_bf16 v[164:167], a[84:87], a[0:3], v[164:167]
    s_sub_u32 s61, s61, s90
    ds_read_b64_tr_b16 a[82:83], v12 offset:18432
    v_mfma_f32_16x16x32_bf16 v[172:175], a[84:87], a[4:7], v[172:175]
    s_add_u32 s64, s64, 32768
    v_mfma_f32_16x16x32_bf16 v[180:183], a[84:87], a[8:11], v[180:183]
    buffer_store_dwordx4 a[160:163], v2, s[24:27], s28 offen sc1
    v_mfma_f32_16x16x32_bf16 v[188:191], a[84:87], a[12:15], v[188:191]
    s_add_u32 s28, s28, s31
    v_mfma_f32_16x16x32_bf16 v[196:199], a[84:87], a[16:19], v[196:199]
    buffer_load_dwordx4 v17, s[40:43], s50 offen offset:1024 lds
    v_mfma_f32_16x16x32_bf16 v[204:207], a[84:87], a[20:23], v[204:207]
    s_add_u32 s50, s50, 128
    v_mfma_f32_16x16x32_bf16 v[212:215], a[84:87], a[24:27], v[212:215]
    s_cmp_ge_u32 s64, 98304
    s_cselect_b32 s63, 4294901760, s59
    s_cselect_b32 s64, 0, s64
    v_mfma_f32_16x16x32_bf16 v[220:223], a[84:87], a[28:31], v[220:223]
    ds_read_b64_tr_b16 a[84:85], v13 offset:16384
    v_mfma_f32_16x16x32_bf16 v[224:227], a[88:91], a[0:3], v[224:227]
    ds_read_b64_tr_b16 a[86:87], v13 offset:18432
    v_mfma_f32_16x16x32_bf16 v[232:235], a[88:91], a[4:7], v[232:235]
    v_mfma_f32_16x16x32_bf16 v[240:243], a[88:91], a[8:11], v[240:243]
    buffer_store_dwordx4 a[164:167], v2, s[24:27], s28 offen sc1
    v_mfma_f32_16x16x32_bf16 v[248:251], a[88:91], a[12:15], v[248:251]
    s_add_u32 s28, s28, s31
    v_mfma_f32_16x16x32_bf16 a[96:99], a[88:91], a[16:19], a[96:99]
    buffer_load_dwordx4 v16, s[40:43], s51 offen offset:2048 lds
    v_mfma_f32_16x16x32_bf16 a[104:107], a[88:91], a[20:23], a[104:107]
    v_mfma_f32_16x16x32_bf16 a[112:115], a[88:91], a[24:27], a[112:115]
    v_mfma_f32_16x16x32_bf16 a[120:123], a[88:91], a[28:31], a[120:123]
    ds_read_b64_tr_b16 a[88:89], v14 offset:16384
    s_waitcnt lgkmcnt(15)
    v_mfma_f32_16x16x32_bf16 v[228:231], a[92:95], a[0:3], v[228:231]
    ds_read_b64_tr_b16 a[90:91], v14 offset:18432
    v_mfma_f32_16x16x32_bf16 v[236:239], a[92:95], a[4:7], v[236:239]
    v_add_u32 v6, s63, v6
    v_add_u32 v7, s63, v7
    v_mfma_f32_16x16x32_bf16 v[244:247], a[92:95], a[8:11], v[244:247]
    buffer_store_dwordx4 a[168:171], v2, s[24:27], s28 offen sc1
    v_mfma_f32_16x16x32_bf16 v[252:255], a[92:95], a[12:15], v[252:255]
    s_add_u32 s28, s28, s31
    v_mfma_f32_16x16x32_bf16 a[100:103], a[92:95], a[16:19], a[100:103]
    buffer_load_dwordx4 v17, s[40:43], s51 offen offset:3072 lds
    v_mfma_f32_16x16x32_bf16 a[108:111], a[92:95], a[20:23], a[108:111]
    s_add_u32 s51, s51, 128
    v_mfma_f32_16x16x32_bf16 a[116:119], a[92:95], a[24:27], a[116:119]
    v_mfma_f32_16x16x32_bf16 a[124:127], a[92:95], a[28:31], a[124:127]
    ds_read_b64_tr_b16 a[92:93], v15 offset:16384
    ds_read_b64_tr_b16 a[94:95], v15 offset:18432
    v_mfma_f32_16x16x32_bf16 v[32:35], a[64:67], a[32:35], v[32:35]
    v_xor_b32 v8, s60, v8
    v_xor_b32 v9, s60, v9
    v_mfma_f32_16x16x32_bf16 v[40:43], a[64:67], a[36:39], v[40:43]
    v_xor_b32 v10, s60, v10
    v_xor_b32 v11, s60, v11
    s_waitcnt lgkmcnt(15)
    v_mfma_f32_16x16x32_bf16 v[48:51], a[64:67], a[40:43], v[48:51]
    v_xor_b32 v12, s60, v12
    v_xor_b32 v13, s60, v13
    v_mfma_f32_16x16x32_bf16 v[56:59], a[64:67], a[44:47], v[56:59]
    v_xor_b32 v14, s60, v14
    v_xor_b32 v15, s60, v15
    s_waitcnt lgkmcnt(13)
    v_mfma_f32_16x16x32_bf16 v[64:67], a[64:67], a[48:51], v[64:67]
    s_waitcnt lgkmcnt(12)
    v_mfma_f32_16x16x32_bf16 v[72:75], a[64:67], a[52:55], v[72:75]
    s_waitcnt lgkmcnt(9)
    v_mfma_f32_16x16x32_bf16 v[80:83], a[64:67], a[56:59], v[80:83]
    s_waitcnt vmcnt(16) lgkmcnt(0)
    v_mfma_f32_16x16x32_bf16 v[88:91], a[64:67], a[60:63], v[88:91]
    s_barrier
    ds_read_b64_tr_b16 a[64:65], v8 offset:0
    v_mfma_f32_16x16x32_bf16 v[36:39], a[68:71], a[32:35], v[36:39]
    s_add_u32 m0, s62, 0
    ds_read_b64_tr_b16 a[66:67], v8 offset:2048
    v_mfma_f32_16x16x32_bf16 v[44:47], a[68:71], a[36:39], v[44:47]
    buffer_load_dwordx4 v18, s[44:47], s52 offen offset:0 lds
    v_mfma_f32_16x16x32_bf16 v[52:55], a[68:71], a[40:43], v[52:55]
    ds_read_b128 a[0:3], v6 offset:0
    v_mfma_f32_16x16x32_bf16 v[60:63], a[68:71], a[44:47], v[60:63]
    v_mfma_f32_16x16x32_bf16 v[68:71], a[68:71], a[48:51], v[68:71]
    v_mfma_f32_16x16x32_bf16 v[76:79], a[68:71], a[52:55], v[76:79]
    buffer_load_dwordx4 v19, s[44:47], s52 offen offset:1024 lds
    v_mfma_f32_16x16x32_bf16 v[84:87], a[68:71], a[56:59], v[84:87]
    s_add_u32 s52, s52, s56
    ds_read_b128 a[4:7], v6 offset:2048
    v_mfma_f32_16x16x32_bf16 v[92:95], a[68:71], a[60:63], v[92:95]
    ds_read_b64_tr_b16 a[68:69], v9 offset:0
    v_mfma_f32_16x16x32_bf16 v[96:99], a[72:75], a[32:35], v[96:99]
    ds_read_b64_tr_b16 a[70:71], v9 offset:2048
    v_mfma_f32_16x16x32_bf16 v[104:107], a[72:75], a[36:39], v[104:107]
    buffer_load_dwordx4 v18, s[44:47], s53 offen offset:2048 lds
    v_mfma_f32_16x16x32_bf16 v[112:115], a[72:75], a[40:43], v[112:115]
    ds_read_b128 a[8:11], v6 offset:4096
    v_mfma_f32_16x16x32_bf16 v[120:123], a[72:75], a[44:47], v[120:123]
    v_mfma_f32_16x16x32_bf16 v[128:131], a[72:75], a[48:51], v[128:131]
    v_mfma_f32_16x16x32_bf16 v[136:139], a[72:75], a[52:55], v[136:139]
    buffer_load_dwordx4 v19, s[44:47], s53 offen offset:3072 lds
    v_mfma_f32_16x16x32_bf16 v[144:147], a[72:75], a[56:59], v[144:147]
    s_add_u32 s53, s53, s56
    ds_read_b128 a[12:15], v6 offset:6144
    v_mfma_f32_16x16x32_bf16 v[152:155], a[72:75], a[60:63], v[152:155]
    ds_read_b64_tr_b16 a[72:73], v10 offset:0
    v_mfma_f32_16x16x32_bf16 v[100:103], a[76:79], a[32:35], v[100:103]
    s_add_u32 m0, s62, 4096
    ds_read_b64_tr_b16 a[74:75], v10 offset:2048
    v_mfma_f32_16x16x32_bf16 v[108:111], a[76:79], a[36:39], v[108:111]
    buffer_load_dwordx4 v20, s[44:47], s54 offen offset:0 lds
    v_mfma_f32_16x16x32_bf16 v[116:119], a[76:79], a[40:43], v[116:119]
    ds_read_b128 a[16:19], v6 offset:8192
    v_mfma_f32_16x16x32_bf16 v[124:127], a[76:79], a[44:47], v[124:127]
    s_xor_b32 s62, s62, 229376
    v_mfma_f32_16x16x32_bf16 v[132:135], a[76:79], a[48:51], v[132:135]
    v_mfma_f32_16x16x32_bf16 v[140:143], a[76:79], a[52:55], v[140:143]
    buffer_load_dwordx4 v21, s[44:47], s54 offen offset:1024 lds
    v_mfma_f32_16x16x32_bf16 v[148:151], a[76:79], a[56:59], v[148:151]
    s_add_u32 s54, s54, s56
    ds_read_b128 a[20:23], v6 offset:10240
    v_mfma_f32_16x16x32_bf16 v[156:159], a[76:79], a[60:63], v[156:159]
    ds_read_b64_tr_b16 a[76:77], v11 offset:0
    v_mfma_f32_16x16x32_bf16 v[160:163], a[80:83], a[32:35], v[160:163]
    ds_read_b64_tr_b16 a[78:79], v11 offset:2048
    v_mfma_f32_16x16x32_bf16 v[168:171], a[80:83], a[36:39], v[168:171]
    buffer_load_dwordx4 v20, s[44:47], s55 offen offset:2048 lds
    v_mfma_f32_16x16x32_bf16 v[176:179], a[80:83], a[40:43], v[176:179]
    ds_read_b128 a[24:27], v6 offset:12288
    v_mfma_f32_16x16x32_bf16 v[184:187], a[80:83], a[44:47], v[184:187]
    v_mfma_f32_16x16x32_bf16 v[192:195], a[80:83], a[48:51], v[192:195]
    v_mfma_f32_16x16x32_bf16 v[200:203], a[80:83], a[52:55], v[200:203]
    buffer_load_dwordx4 v21, s[44:47], s55 offen offset:3072 lds
    v_mfma_f32_16x16x32_bf16 v[208:211], a[80:83], a[56:59], v[208:211]
    s_add_u32 s55, s55, s56
    ds_read_b128 a[28:31], v6 offset:14336
    v_mfma_f32_16x16x32_bf16 v[216:219], a[80:83], a[60:63], v[216:219]
    ds_read_b64_tr_b16 a[80:81], v12 offset:0
    v_mfma_f32_16x16x32_bf16 v[164:167], a[84:87], a[32:35], v[164:167]
    ds_read_b64_tr_b16 a[82:83], v12 offset:2048
    v_mfma_f32_16x16x32_bf16 v[172:175], a[84:87], a[36:39], v[172:175]
    v_mfma_f32_16x16x32_bf16 v[180:183], a[84:87], a[40:43], v[180:183]
    buffer_store_dwordx4 a[172:175], v2, s[24:27], s28 offen sc1
    v_mfma_f32_16x16x32_bf16 v[188:191], a[84:87], a[44:47], v[188:191]
    s_add_u32 s28, s28, s31
    v_mfma_f32_16x16x32_bf16 v[196:199], a[84:87], a[48:51], v[196:199]
    v_mfma_f32_16x16x32_bf16 v[204:207], a[84:87], a[52:55], v[204:207]
    v_mfma_f32_16x16x32_bf16 v[212:215], a[84:87], a[56:59], v[212:215]
    buffer_store_dwordx4 a[176:179], v2, s[24:27], s28 offen sc1
    v_mfma_f32_16x16x32_bf16 v[220:223], a[84:87], a[60:63], v[220:223]
    s_add_u32 s28, s28, s31
    ds_read_b64_tr_b16 a[84:85], v13 offset:0
    v_mfma_f32_16x16x32_bf16 v[224:227], a[88:91], a[32:35], v[224:227]
    ds_read_b64_tr_b16 a[86:87], v13 offset:2048
    v_mfma_f32_16x16x32_bf16 v[232:235], a[88:91], a[36:39], v[232:235]
    v_mfma_f32_16x16x32_bf16 v[240:243], a[88:91], a[40:43], v[240:243]
    buffer_store_dwordx4 a[180:183], v2, s[24:27], s28 offen sc1
    v_mfma_f32_16x16x32_bf16 v[248:251], a[88:91], a[44:47], v[248:251]
    s_add_u32 s28, s28, s31
    v_mfma_f32_16x16x32_bf16 a[96:99], a[88:91], a[48:51], a[96:99]
    v_mfma_f32_16x16x32_bf16 a[104:107], a[88:91], a[52:55], a[104:107]
    v_mfma_f32_16x16x32_bf16 a[112:115], a[88:91], a[56:59], a[112:115]
    buffer_store_dwordx4 a[184:187], v2, s[24:27], s28 offen sc1
    v_mfma_f32_16x16x32_bf16 a[120:123], a[88:91], a[60:63], a[120:123]
    s_add_u32 s28, s28, s31
    ds_read_b64_tr_b16 a[88:89], v14 offset:0
    v_mfma_f32_16x16x32_bf16 v[228:231], a[92:95], a[32:35], v[228:231]
    ds_read_b64_tr_b16 a[90:91], v14 offset:2048
    v_mfma_f32_16x16x32_bf16 v[236:239], a[92:95], a[36:39], v[236:239]
    v_mfma_f32_16x16x32_bf16 v[244:247], a[92:95], a[40:43], v[244:247]
    buffer_store_dwordx4 a[188:191], v2, s[24:27], s28 offen sc1
    v_mfma_f32_16x16x32_bf16 v[252:255], a[92:95], a[44:47], v[252:255]
    s_add_u32 s29, s29, s30
    s_mov_b32 s28, s29
    v_mfma_f32_16x16x32_bf16 a[100:103], a[92:95], a[48:51], a[100:103]
    s_sub_u32 s65, s65, 1
    v_mfma_f32_16x16x32_bf16 a[108:111], a[92:95], a[52:55], a[108:111]
    v_mfma_f32_16x16x32_bf16 a[116:119], a[92:95], a[56:59], a[116:119]
    v_mfma_f32_16x16x32_bf16 a[124:127], a[92:95], a[60:63], a[124:127]
    ds_read_b64_tr_b16 a[92:93], v15 offset:0
    ds_read_b64_tr_b16 a[94:95], v15 offset:2048
    s_cmp_eq_u32 s66, 2
    s_cbranch_scc1 m_hook13
m_hookr14:
    s_waitcnt lgkmcnt(15)
    v_mfma_f32_16x16x32_bf16 v[32:35], a[64:67], a[0:3], v[32:35]
    v_mfma_f32_16x16x32_bf16 v[40:43], a[64:67], a[4:7], v[40:43]
    v_mfma_f32_16x16x32_bf16 v[48:51], a[64:67], a[8:11], v[48:51]
    v_mfma_f32_16x16x32_bf16 v[56:59], a[64:67], a[12:15], v[56:59]
    s_add_u32 m0, s61, 0
    s_waitcnt lgkmcnt(13)
    v_mfma_f32_16x16x32_bf16 v[64:67], a[64:67], a[16:19], v[64:67]
    buffer_load_dwordx4 v16, s[40:43], s48 offen offset:0 lds
    s_waitcnt lgkmcnt(12)
    v_mfma_f32_16x16x32_bf16 v[72:75], a[64:67], a[20:23], v[72:75]
    s_waitcnt lgkmcnt(9)
    v_mfma_f32_16x16x32_bf16 v[80:83], a[64:67], a[24:27], v[80:83]
    s_waitcnt lgkmcnt(8)
    v_mfma_f32_16x16x32_bf16 v[88:91], a[64:67], a[28:31], v[88:91]
    ds_read_b64_tr_b16 a[64:65], v8 offset:16384
    v_mfma_f32_16x16x32_bf16 v[36:39], a[68:71], a[0:3], v[36:39]
    ds_read_b64_tr_b16 a[66:67], v8 offset:18432
    v_mfma_f32_16x16x32_bf16 v[44:47], a[68:71], a[4:7], v[44:47]
    v_mfma_f32_16x16x32_bf16 v[52:55], a[68:71], a[8:11], v[52:55]
    ds_read_b128 a[32:35], v7 offset:0
    v_mfma_f32_16x16x32_bf16 v[60:63], a[68:71], a[12:15], v[60:63]
    v_mfma_f32_16x16x32_bf16 v[68:71], a[68:71], a[16:19], v[68:71]
    buffer_load_dwordx4 v17, s[40:43], s48 offen offset:1024 lds
    v_mfma_f32_16x16x32_bf16 v[76:79], a[68:71], a[20:23], v[76:79]
    s_add_u32 s48, s48, 128
    v_mfma_f32_16x16x32_bf16 v[84:87], a[68:71], a[24:27], v[84:87]
    ds_read_b128 a[36:39], v7 offset:2048
    v_mfma_f32_16x16x32_bf16 v[92:95], a[68:71], a[28:31], v[92:95]
    ds_read_b64_tr_b16 a[68:69], v9 offset:16384
    v_mfma_f32_16x16x32_bf16 v[96:99], a[72:75], a[0:3], v[96:99]
    ds_read_b64_tr_b16 a[70:71], v9 offset:18432
    v_mfma_f32_16x16x32_bf16 v[104:107], a[72:75], a[4:7], v[104:107]
    v_mfma_f32_16x16x32_bf16 v[112:115], a[72:75], a[8:11], v[112:115]
    ds_read_b128 a[40:43], v7 offset:4096
    v_mfma_f32_16x16x32_bf16 v[120:123], a[72:75], a[12:15], v[120:123]
    v_mfma_f32_16x16x32_bf16 v[128:131], a[72:75], a[16:19], v[128:131]
    buffer_load_dwordx4 v16, s[40:43], s49 offen offset:2048 lds
    v_mfma_f32_16x16x32_bf16 v[136:139], a[72:75], a[20:23], v[136:139]
    v_mfma_f32_16x16x32_bf16 v[144:147], a[72:75], a[24:27], v[144:147]
    ds_read_b128 a[44:47], v7 offset:6144
    v_mfma_f32_16x16x32_bf16 v[152:155], a[72:75], a[28:31], v[152:155]
    ds_read_b64_tr_b16 a[72:73], v10 offset:16384
    v_mfma_f32_16x16x32_bf16 v[100:103], a[76:79], a[0:3], v[100:103]
    ds_read_b64_tr_b16 a[74:75], v10 offset:18432
    v_mfma_f32_16x16x32_bf16 v[108:111], a[76:79], a[4:7], v[108:111]
    v_mfma_f32_16x16x32_bf16 v[116:119], a[76:79], a[8:11], v[116:119]
    ds_read_b128 a[48:51], v7 offset:8192
    v_mfma_f32_16x16x32_bf16 v[124:127], a[76:79], a[12:15], v[124:127]
    v_mfma_f32_16x16x32_bf16 v[132:135], a[76:79], a[16:19], v[132:135]
    buffer_load_dwordx4 v17, s[40:43], s49 offen offset:3072 lds
    v_mfma_f32_16x16x32_bf16 v[140:143], a[76:79], a[20:23], v[140:143]
    s_add_u32 s49, s49, 128
    v_mfma_f32_16x16x32_bf16 v[148:151], a[76:79], a[24:27], v[148:151]
    ds_read_b128 a[52:55], v7 offset:10240
    v_mfma_f32_16x16x32_bf16 v[156:159], a[76:79], a[28:31], v[156:159]
    ds_read_b64_tr_b16 a[76:77], v11 offset:16384
    s_waitcnt lgkmcnt(15)
    v_mfma_f32_16x16x32_bf16 v[160:163], a[80:83], a[0:3], v[160:163]
    ds_read_b64_tr_b16 a[78:79], v11 offset:18432
    v_mfma_f32_16x16x32_bf16 v[168:171], a[80:83], a[4:7], v[168:171]
    v_mfma_f32_16x16x32_bf16 v[176:179], a[80:83], a[8:11], v[176:179]
    ds_read_b128 a[56:59], v7 offset:12288
    v_mfma_f32_16x16x32_bf16 v[184:187], a[80:83], a[12:15], v[184:187]
    s_add_u32 m0, s61, 4096
    v_mfma_f32_16x16x32_bf16 v[192:195], a[80:83], a[16:19], v[192:195]
    buffer_load_dwordx4 v16, s[40:43], s50 offen offset:0 lds
    v_mfma_f32_16x16x32_bf16 v[200:203], a[80:83], a[20:23], v[200:203]
    v_mfma_f32_16x16x32_bf16 v[208:211], a[80:83], a[24:27], v[208:211]
    s_add_u32 s61, s61, 32768
    ds_read_b128 a[60:63], v7 offset:14336
    v_mfma_f32_16x16x32_bf16 v[216:219], a[80:83], a[28:31], v[216:219]
    s_cmp_ge_u32 s61, 98304
    s_cselect_b32 s90, 98304, 0
    ds_read_b64_tr_b16 a[80:81], v12 offset:16384
    v_mfma_f32_16x16x32_bf16 v[164:167], a[84:87], a[0:3], v[164:167]
    s_sub_u32 s61, s61, s90
    ds_read_b64_tr_b16 a[82:83], v12 offset:18432
    v_mfma_f32_16x16x32_bf16 v[172:175], a[84:87], a[4:7], v[172:175]
    s_add_u32 s64, s64, 32768
    v_mfma_f32_16x16x32_bf16 v[180:183], a[84:87], a[8:11], v[180:183]
    buffer_store_dwordx4 a[192:195], v2, s[24:27], s28 offen sc1
    v_mfma_f32_16x16x32_bf16 v[188:191], a[84:87], a[12:15], v[188:191]
    s_add_u32 s28, s28, s31
    v_mfma_f32_16x16x32_bf16 v[196:199], a[84:87], a[16:19], v[196:199]
    buffer_load_dwordx4 v17, s[40:43], s50 offen offset:1024 lds
    v_mfma_f32_16x16x32_bf16 v[204:207], a[84:87], a[20:23], v[204:207]
    s_add_u32 s50, s50, 128
    v_mfma_f32_16x16x32_bf16 v[212:215], a[84:87], a[24:27], v[212:215]
    s_cmp_ge_u32 s64, 98304
    s_cselect_b32 s63, 4294901760, s59
    s_cselect_b32 s64, 0, s64
    v_mfma_f32_16x16x32_bf16 v[220:223], a[84:87], a[28:31], v[220:223]
    ds_read_b64_tr_b16 a[84:85], v13 offset:16384
    v_mfma_f32_16x16x32_bf16 v[224:227], a[88:91], a[0:3], v[224:227]
    ds_read_b64_tr_b16 a[86:87], v13 offset:18432
    v_mfma_f32_16x16x32_bf16 v[232:235], a[88:91], a[4:7], v[232:235]
    v_mfma_f32_16x16x32_bf16 v[240:243], a[88:91], a[8:11], v[240:243]
    buffer_store_dwordx4 a[196:199], v2, s[24:27], s28 offen sc1
    v_mfma_f32_16x16x32_bf16 v[248:251], a[88:91], a[12:15], v[248:251]
    s_add_u32 s28, s28, s31
    v_mfma_f32_16x16x32_bf16 a[96:99], a[88:91], a[16:19], a[96:99]
    buffer_load_dwordx4 v16, s[40:43], s51 offen offset:2048 lds
    v_mfma_f32_16x16x32_bf16 a[104:107], a[88:91], a[20:23], a[104:107]
    v_mfma_f32_16x16x32_bf16 a[112:115], a[88:91], a[24:27], a[112:115]
    v_mfma_f32_16x16x32_bf16 a[120:123], a[88:91], a[28:31], a[120:123]
    ds_read_b64_tr_b16 a[88:89], v14 offset:16384
    s_waitcnt lgkmcnt(15)
    v_mfma_f32_16x16x32_bf16 v[228:231], a[92:95], a[0:3], v[228:231]
    ds_read_b64_tr_b16 a[90:91], v14 offset:18432
    v_mfma_f32_16x16x32_bf16 v[236:239], a[92:95], a[4:7], v[236:239]
    v_add_u32 v6, s63, v6
    v_add_u32 v7, s63, v7
    v_mfma_f32_16x16x32_bf16 v[244:247], a[92:95], a[8:11], v[244:247]
    buffer_store_dwordx4 a[200:203], v2, s[24:27], s28 offen sc1
    v_mfma_f32_16x16x32_bf16 v[252:255], a[92:95], a[12:15], v[252:255]
    s_add_u32 s28, s28, s31
    v_mfma_f32_16x16x32_bf16 a[100:103], a[92:95], a[16:19], a[100:103]
    buffer_load_dwordx4 v17, s[40:43], s51 offen offset:3072 lds
    v_mfma_f32_16x16x32_bf16 a[108:111], a[92:95], a[20:23], a[108:111]
    s_add_u32 s51, s51, 128
    v_mfma_f32_16x16x32_bf16 a[116:119], a[92:95], a[24:27], a[116:119]
    v_mfma_f32_16x16x32_bf16 a[124:127], a[92:95], a[28:31], a[124:127]
    ds_read_b64_tr_b16 a[92:93], v15 offset:16384
    ds_read_b64_tr_b16 a[94:95], v15 offset:18432
    v_mfma_f32_16x16x32_bf16 v[32:35], a[64:67], a[32:35], v[32:35]
    v_xor_b32 v8, s60, v8
    v_xor_b32 v9, s60, v9
    v_mfma_f32_16x16x32_bf16 v[40:43], a[64:67], a[36:39], v[40:43]
    v_xor_b32 v10, s60, v10
    v_xor_b32 v11, s60, v11
    s_waitcnt lgkmcnt(15)
    v_mfma_f32_16x16x32_bf16 v[48:51], a[64:67], a[40:43], v[48:51]
    v_xor_b32 v12, s60, v12
    v_xor_b32 v13, s60, v13
    v_mfma_f32_16x16x32_bf16 v[56:59], a[64:67], a[44:47], v[56:59]
    v_xor_b32 v14, s60, v14
    v_xor_b32 v15, s60, v15
    s_waitcnt lgkmcnt(13)
    v_mfma_f32_16x16x32_bf16 v[64:67], a[64:67], a[48:51], v[64:67]
    s_waitcnt lgkmcnt(12)
    v_mfma_f32_16x16x32_bf16 v[72:75], a[64:67], a[52:55], v[72:75]
    s_waitcnt lgkmcnt(9)
    v_mfma_f32_16x16x32_bf16 v[80:83], a[64:67], a[56:59], v[80:83]
    s_waitcnt vmcnt(16) lgkmcnt(0)
    v_mfma_f32_16x16x32_bf16 v[88:91], a[64:67], a[60:63], v[88:91]
    s_barrier
    ds_read_b64_tr_b16 a[64:65], v8 offset:0
    v_mfma_f32_16x16x32_bf16 v[36:39], a[68:71], a[32:35], v[36:39]
    s_add_u32 m0, s62, 0
    ds_read_b64_tr_b16 a[66:67], v8 offset:2048
    v_mfma_f32_16x16x32_bf16 v[44:47], a[68:71], a[36:39], v[44:47]
    buffer_load_dwordx4 v18, s[44:47], s52 offen offset:0 lds
    v_mfma_f32_16x16x32_bf16 v[52:55], a[68:71], a[40:43], v[52:55]
    ds_read_b128 a[0:3], v6 offset:0
    v_mfma_f32_16x16x32_bf16 v[60:63], a[68:71], a[44:47], v[60:63]
    v_mfma_f32_16x16x32_bf16 v[68:71], a[68:71], a[48:51], v[68:71]
    v_mfma_f32_16x16x32_bf16 v[76:79], a[68:71], a[52:55], v[76:79]
    buffer_load_dwordx4 v19, s[44:47], s52 offen offset:1024 lds
    v_mfma_f32_16x16x32_bf16 v[84:87], a[68:71], a[56:59], v[84:87]
    s_add_u32 s52, s52, s56
    ds_read_b128 a[4:7], v6 offset:2048
    v_mfma_f32_16x16x32_bf16 v[92:95], a[68:71], a[60:63], v[92:95]
    ds_read_b64_tr_b16 a[68:69], v9 offset:0
    v_mfma_f32_16x16x32_bf16 v[96:99], a[72:75], a[32:35], v[96:99]
    ds_read_b64_tr_b16 a[70:71], v9 offset:2048
    v_mfma_f32_16x16x32_bf16 v[104:107], a[72:75], a[36:39], v[104:107]
    buffer_load_dwordx4 v18, s[44:47], s53 offen offset:2048 lds
    v_mfma_f32_16x16x32_bf16 v[112:115], a[72:75], a[40:43], v[112:115]
    ds_read_b128 a[8:11], v6 offset:4096
    v_mfma_f32_16x16x32_bf16 v[120:123], a[72:75], a[44:47], v[120:123]
    v_mfma_f32_16x16x32_bf16 v[128:131], a[72:75], a[48:51], v[128:131]
    v_mfma_f32_16x16x32_bf16 v[136:139], a[72:75], a[52:55], v[136:139]
    buffer_load_dwordx4 v19, s[44:47], s53 offen offset:3072 lds
    v_mfma_f32_16x16x32_bf16 v[144:147], a[72:75], a[56:59], v[144:147]
    s_add_u32 s53, s53, s56
    ds_read_b128 a[12:15], v6 offset:6144
    v_mfma_f32_16x16x32_bf16 v[152:155], a[72:75], a[60:63], v[152:155]
    ds_read_b64_tr_b16 a[72:73], v10 offset:0
    v_mfma_f32_16x16x32_bf16 v[100:103], a[76:79], a[32:35], v[100:103]
    s_add_u32 m0, s62, 4096
    ds_read_b64_tr_b16 a[74:75], v10 offset:2048
    v_mfma_f32_16x16x32_bf16 v[108:111], a[76:79], a[36:39], v[108:111]
    buffer_load_dwordx4 v20, s[44:47], s54 offen offset:0 lds
    v_mfma_f32_16x16x32_bf16 v[116:119], a[76:79], a[40:43], v[116:119]
    ds_read_b128 a[16:19], v6 offset:8192
    v_mfma_f32_16x16x32_bf16 v[124:127], a[76:79], a[44:47], v[124:127]
    s_xor_b32 s62, s62, 229376
    v_mfma_f32_16x16x32_bf16 v[132:135], a[76:79], a[48:51], v[132:135]
    v_mfma_f32_16x16x32_bf16 v[140:143], a[76:79], a[52:55], v[140:143]
    buffer_load_dwordx4 v21, s[44:47], s54 offen offset:1024 lds
    v_mfma_f32_16x16x32_bf16 v[148:151], a[76:79], a[56:59], v[148:151]
    s_add_u32 s54, s54, s56
    ds_read_b128 a[20:23], v6 offset:10240
    v_mfma_f32_16x16x32_bf16 v[156:159], a[76:79], a[60:63], v[156:159]
    ds_read_b64_tr_b16 a[76:77], v11 offset:0
    v_mfma_f32_16x16x32_bf16 v[160:163], a[80:83], a[32:35], v[160:163]
    ds_read_b64_tr_b16 a[78:79], v11 offset:2048
    v_mfma_f32_16x16x32_bf16 v[168:171], a[80:83], a[36:39], v[168:171]
    buffer_load_dwordx4 v20, s[44:47], s55 offen offset:2048 lds
    v_mfma_f32_16x16x32_bf16 v[176:179], a[80:83], a[40:43], v[176:179]
    ds_read_b128 a[24:27], v6 offset:12288
    v_mfma_f32_16x16x32_bf16 v[184:187], a[80:83], a[44:47], v[184:187]
    v_mfma_f32_16x16x32_bf16 v[192:195], a[80:83], a[48:51], v[192:195]
    v_mfma_f32_16x16x32_bf16 v[200:203], a[80:83], a[52:55], v[200:203]
    buffer_load_dwordx4 v21, s[44:47], s55 offen offset:3072 lds
    v_mfma_f32_16x16x32_bf16 v[208:211], a[80:83], a[56:59], v[208:211]
    s_add_u32 s55, s55, s56
    ds_read_b128 a[28:31], v6 offset:14336
    v_mfma_f32_16x16x32_bf16 v[216:219], a[80:83], a[60:63], v[216:219]
    ds_read_b64_tr_b16 a[80:81], v12 offset:0
    v_mfma_f32_16x16x32_bf16 v[164:167], a[84:87], a[32:35], v[164:167]
    ds_read_b64_tr_b16 a[82:83], v12 offset:2048
    v_mfma_f32_16x16x32_bf16 v[172:175], a[84:87], a[36:39], v[172:175]
    v_mfma_f32_16x16x32_bf16 v[180:183], a[84:87], a[40:43], v[180:183]
    buffer_store_dwordx4 a[204:207], v2, s[24:27], s28 offen sc1
    v_mfma_f32_16x16x32_bf16 v[188:191], a[84:87], a[44:47], v[188:191]
    s_add_u32 s28, s28, s31
    v_mfma_f32_16x16x32_bf16 v[196:199], a[84:87], a[48:51], v[196:199]
    v_mfma_f32_16x16x32_bf16 v[204:207], a[84:87], a[52:55], v[204:207]
    v_mfma_f32_16x16x32_bf16 v[212:215], a[84:87], a[56:59], v[212:215]
    buffer_store_dwordx4 a[208:211], v2, s[24:27], s28 offen sc1
    v_mfma_f32_16x16x32_bf16 v[220:223], a[84:87], a[60:63], v[220:223]
    s_add_u32 s28, s28, s31
    ds_read_b64_tr_b16 a[84:85], v13 offset:0
    v_mfma_f32_16x16x32_bf16 v[224:227], a[88:91], a[32:35], v[224:227]
    ds_read_b64_tr_b16 a[86:87], v13 offset:2048
    v_mfma_f32_16x16x32_bf16 v[232:235], a[88:91], a[36:39], v[232:235]
    v_mfma_f32_16x16x32_bf16 v[240:243], a[88:91], a[40:43], v[240:243]
    buffer_store_dwordx4 a[212:215], v2, s[24:27], s28 offen sc1
    v_mfma_f32_16x16x32_bf16 v[248:251], a[88:91], a[44:47], v[248:251]
    s_add_u32 s28, s28, s31
    v_mfma_f32_16x16x32_bf16 a[96:99], a[88:91], a[48:51], a[96:99]
    v_mfma_f32_16x16x32_bf16 a[104:107], a[88:91], a[52:55], a[104:107]
    v_mfma_f32_16x16x32_bf16 a[112:115], a[88:91], a[56:59], a[112:115]
    buffer_store_dwordx4 a[216:219], v2, s[24:27], s28 offen sc1
    v_mfma_f32_16x16x32_bf16 a[120:123], a[88:91], a[60:63], a[120:123]
    s_add_u32 s28, s28, s31
    ds_read_b64_tr_b16 a[88:89], v14 offset:0
    v_mfma_f32_16x16x32_bf16 v[228:231], a[92:95], a[32:35], v[228:231]
    ds_read_b64_tr_b16 a[90:91], v14 offset:2048
    v_mfma_f32_16x16x32_bf16 v[236:239], a[92:95], a[36:39], v[236:239]
    v_mfma_f32_16x16x32_bf16 v[244:247], a[92:95], a[40:43], v[244:247]
    buffer_store_dwordx4 a[220:223], v2, s[24:27], s28 offen sc1
    v_mfma_f32_16x16x32_bf16 v[252:255], a[92:95], a[44:47], v[252:255]
    s_add_u32 s29, s29, s30
    s_mov_b32 s28, s29
    v_mfma_f32_16x16x32_bf16 a[100:103], a[92:95], a[48:51], a[100:103]
    s_sub_u32 s65, s65, 1
    v_mfma_f32_16x16x32_bf16 a[108:111], a[92:95], a[52:55], a[108:111]
    v_mfma_f32_16x16x32_bf16 a[116:119], a[92:95], a[56:59], a[116:119]
    v_mfma_f32_16x16x32_bf16 a[124:127], a[92:95], a[60:63], a[124:127]
    ds_read_b64_tr_b16 a[92:93], v15 offset:0
    ds_read_b64_tr_b16 a[94:95], v15 offset:2048
    s_waitcnt lgkmcnt(15)
    v_mfma_f32_16x16x32_bf16 v[32:35], a[64:67], a[0:3], v[32:35]
    v_mfma_f32_16x16x32_bf16 v[40:43], a[64:67], a[4:7], v[40:43]
    v_mfma_f32_16x16x32_bf16 v[48:51], a[64:67], a[8:11], v[48:51]
    v_mfma_f32_16x16x32_bf16 v[56:59], a[64:67], a[12:15], v[56:59]
    s_add_u32 m0, s61, 0
    s_waitcnt lgkmcnt(13)
    v_mfma_f32_16x16x32_bf16 v[64:67], a[64:67], a[16:19], v[64:67]
    buffer_load_dwordx4 v16, s[40:43], s48 offen offset:0 lds
    s_waitcnt lgkmcnt(12)
    v_mfma_f32_16x16x32_bf16 v[72:75], a[64:67], a[20:23], v[72:75]
    s_waitcnt lgkmcnt(9)
    v_mfma_f32_16x16x32_bf16 v[80:83], a[64:67], a[24:27], v[80:83]
    s_waitcnt lgkmcnt(8)
    v_mfma_f32_16x16x32_bf16 v[88:91], a[64:67], a[28:31], v[88:91]
    ds_read_b64_tr_b16 a[64:65], v8 offset:16384
    v_mfma_f32_16x16x32_bf16 v[36:39], a[68:71], a[0:3], v[36:39]
    ds_read_b64_tr_b16 a[66:67], v8 offset:18432
    v_mfma_f32_16x16x32_bf16 v[44:47], a[68:71], a[4:7], v[44:47]
    v_mfma_f32_16x16x32_bf16 v[52:55], a[68:71], a[8:11], v[52:55]
    ds_read_b128 a[32:35], v7 offset:0
    v_mfma_f32_16x16x32_bf16 v[60:63], a[68:71], a[12:15], v[60:63]
    v_mfma_f32_16x16x32_bf16 v[68:71], a[68:71], a[16:19], v[68:71]
    buffer_load_dwordx4 v17, s[40:43], s48 offen offset:1024 lds
    v_mfma_f32_16x16x32_bf16 v[76:79], a[68:71], a[20:23], v[76:79]
    s_add_u32 s48, s48, 128
    v_mfma_f32_16x16x32_bf16 v[84:87], a[68:71], a[24:27], v[84:87]
    ds_read_b128 a[36:39], v7 offset:2048
    v_mfma_f32_16x16x32_bf16 v[92:95], a[68:71], a[28:31], v[92:95]
    ds_read_b64_tr_b16 a[68:69], v9 offset:16384
    v_mfma_f32_16x16x32_bf16 v[96:99], a[72:75], a[0:3], v[96:99]
    ds_read_b64_tr_b16 a[70:71], v9 offset:18432
    v_mfma_f32_16x16x32_bf16 v[104:107], a[72:75], a[4:7], v[104:107]
    v_mfma_f32_16x16x32_bf16 v[112:115], a[72:75], a[8:11], v[112:115]
    ds_read_b128 a[40:43], v7 offset:4096
    v_mfma_f32_16x16x32_bf16 v[120:123], a[72:75], a[12:15], v[120:123]
    v_mfma_f32_16x16x32_bf16 v[128:131], a[72:75], a[16:19], v[128:131]
    buffer_load_dwordx4 v16, s[40:43], s49 offen offset:2048 lds
    v_mfma_f32_16x16x32_bf16 v[136:139], a[72:75], a[20:23], v[136:139]
    v_mfma_f32_16x16x32_bf16 v[144:147], a[72:75], a[24:27], v[144:147]
    ds_read_b128 a[44:47], v7 offset:6144
    v_mfma_f32_16x16x32_bf16 v[152:155], a[72:75], a[28:31], v[152:155]
    ds_read_b64_tr_b16 a[72:73], v10 offset:16384
    v_mfma_f32_16x16x32_bf16 v[100:103], a[76:79], a[0:3], v[100:103]
    ds_read_b64_tr_b16 a[74:75], v10 offset:18432
    v_mfma_f32_16x16x32_bf16 v[108:111], a[76:79], a[4:7], v[108:111]
    v_mfma_f32_16x16x32_bf16 v[116:119], a[76:79], a[8:11], v[116:119]
    ds_read_b128 a[48:51], v7 offset:8192
    v_mfma_f32_16x16x32_bf16 v[124:127], a[76:79], a[12:15], v[124:127]
    v_mfma_f32_16x16x32_bf16 v[132:135], a[76:79], a[16:19], v[132:135]
    buffer_load_dwordx4 v17, s[40:43], s49 offen offset:3072 lds
    v_mfma_f32_16x16x32_bf16 v[140:143], a[76:79], a[20:23], v[140:143]
    s_add_u32 s49, s49, 128
    v_mfma_f32_16x16x32_bf16 v[148:151], a[76:79], a[24:27], v[148:151]
    ds_read_b128 a[52:55], v7 offset:10240
    v_mfma_f32_16x16x32_bf16 v[156:159], a[76:79], a[28:31], v[156:159]
    ds_read_b64_tr_b16 a[76:77], v11 offset:16384
    s_waitcnt lgkmcnt(15)
    v_mfma_f32_16x16x32_bf16 v[160:163], a[80:83], a[0:3], v[160:163]
    ds_read_b64_tr_b16 a[78:79], v11 offset:18432
    v_mfma_f32_16x16x32_bf16 v[168:171], a[80:83], a[4:7], v[168:171]
    v_mfma_f32_16x16x32_bf16 v[176:179], a[80:83], a[8:11], v[176:179]
    ds_read_b128 a[56:59], v7 offset:12288
    v_mfma_f32_16x16x32_bf16 v[184:187], a[80:83], a[12:15], v[184:187]
    s_add_u32 m0, s61, 4096
    v_mfma_f32_16x16x32_bf16 v[192:195], a[80:83], a[16:19], v[192:195]
    buffer_load_dwordx4 v16, s[40:43], s50 offen offset:0 lds
    v_mfma_f32_16x16x32_bf16 v[200:203], a[80:83], a[20:23], v[200:203]
    v_mfma_f32_16x16x32_bf16 v[208:211], a[80:83], a[24:27], v[208:211]
    s_add_u32 s61, s61, 32768
    ds_read_b128 a[60:63], v7 offset:14336
    v_mfma_f32_16x16x32_bf16 v[216:219], a[80:83], a[28:31], v[216:219]
    s_cmp_ge_u32 s61, 98304
    s_cselect_b32 s90, 98304, 0
    ds_read_b64_tr_b16 a[80:81], v12 offset:16384
    v_mfma_f32_16x16x32_bf16 v[164:167], a[84:87], a[0:3], v[164:167]
    s_sub_u32 s61, s61, s90
    ds_read_b64_tr_b16 a[82:83], v12 offset:18432
    v_mfma_f32_16x16x32_bf16 v[172:175], a[84:87], a[4:7], v[172:175]
    s_add_u32 s64, s64, 32768
    v_mfma_f32_16x16x32_bf16 v[180:183], a[84:87], a[8:11], v[180:183]
    buffer_store_dwordx4 a[224:227], v2, s[24:27], s28 offen sc1
    v_mfma_f32_16x16x32_bf16 v[188:191], a[84:87], a[12:15], v[188:191]
    s_add_u32 s28, s28, s31
    v_mfma_f32_16x16x32_bf16 v[196:199], a[84:87], a[16:19], v[196:199]
    buffer_load_dwordx4 v17, s[40:43], s50 offen offset:1024 lds
    v_mfma_f32_16x16x32_bf16 v[204:207], a[84:87], a[20:23], v[204:207]
    s_add_u32 s50, s50, 128
    v_mfma_f32_16x16x32_bf16 v[212:215], a[84:87], a[24:27], v[212:215]
    s_cmp_ge_u32 s64, 98304
    s_cselect_b32 s63, 4294901760, s59
    s_cselect_b32 s64, 0, s64
    v_mfma_f32_16x16x32_bf16 v[220:223], a[84:87], a[28:31], v[220:223]
    ds_read_b64_tr_b16 a[84:85], v13 offset:16384
    v_mfma_f32_16x16x32_bf16 v[224:227], a[88:91], a[0:3], v[224:227]
    ds_read_b64_tr_b16 a[86:87], v13 offset:18432
    v_mfma_f32_16x16x32_bf16 v[232:235], a[88:91], a[4:7], v[232:235]
    v_mfma_f32_16x16x32_bf16 v[240:243], a[88:91], a[8:11], v[240:243]
    buffer_store_dwordx4 a[228:231], v2, s[24:27], s28 offen sc1
    v_mfma_f32_16x16x32_bf16 v[248:251], a[88:91], a[12:15], v[248:251]
    s_add_u32 s28, s28, s31
    v_mfma_f32_16x16x32_bf16 a[96:99], a[88:91], a[16:19], a[96:99]
    buffer_load_dwordx4 v16, s[40:43], s51 offen offset:2048 lds
    v_mfma_f32_16x16x32_bf16 a[104:107], a[88:91], a[20:23], a[104:107]
    v_mfma_f32_16x16x32_bf16 a[112:115], a[88:91], a[24:27], a[112:115]
    v_mfma_f32_16x16x32_bf16 a[120:123], a[88:91], a[28:31], a[120:123]
    ds_read_b64_tr_b16 a[88:89], v14 offset:16384
    s_waitcnt lgkmcnt(15)
    v_mfma_f32_16x16x32_bf16 v[228:231], a[92:95], a[0:3], v[228:231]
    ds_read_b64_tr_b16 a[90:91], v14 offset:18432
    v_mfma_f32_16x16x32_bf16 v[236:239], a[92:95], a[4:7], v[236:239]
    v_add_u32 v6, s63, v6
    v_add_u32 v7, s63, v7
    v_mfma_f32_16x16x32_bf16 v[244:247], a[92:95], a[8:11], v[244:247]
    buffer_store_dwordx4 a[232:235], v2, s[24:27], s28 offen sc1
    v_mfma_f32_16x16x32_bf16 v[252:255], a[92:95], a[12:15], v[252:255]
    s_add_u32 s28, s28, s31
    v_mfma_f32_16x16x32_bf16 a[100:103], a[92:95], a[16:19], a[100:103]
    buffer_load_dwordx4 v17, s[40:43], s51 offen offset:3072 lds
    v_mfma_f32_16x16x32_bf16 a[108:111], a[92:95], a[20:23], a[108:111]
    s_add_u32 s51, s51, 128
    v_mfma_f32_16x16x32_bf16 a[116:119], a[92:95], a[24:27], a[116:119]
    v_mfma_f32_16x16x32_bf16 a[124:127], a[92:95], a[28:31], a[124:127]
    ds_read_b64_tr_b16 a[92:93], v15 offset:16384
    ds_read_b64_tr_b16 a[94:95], v15 offset:18432
    v_mfma_f32_16x16x32_bf16 v[32:35], a[64:67], a[32:35], v[32:35]
    v_xor_b32 v8, s60, v8
    v_xor_b32 v9, s60, v9
    v_mfma_f32_16x16x32_bf16 v[40:43], a[64:67], a[36:39], v[40:43]
    v_xor_b32 v10, s60, v10
    v_xor_b32 v11, s60, v11
    s_waitcnt lgkmcnt(15)
    v_mfma_f32_16x16x32_bf16 v[48:51], a[64:67], a[40:43], v[48:51]
    v_xor_b32 v12, s60, v12
    v_xor_b32 v13, s60, v13
    v_mfma_f32_16x16x32_bf16 v[56:59], a[64:67], a[44:47], v[56:59]
    v_xor_b32 v14, s60, v14
    v_xor_b32 v15, s60, v15
    s_waitcnt lgkmcnt(13)
    v_mfma_f32_16x16x32_bf16 v[64:67], a[64:67], a[48:51], v[64:67]
    s_waitcnt lgkmcnt(12)
    v_mfma_f32_16x16x32_bf16 v[72:75], a[64:67], a[52:55], v[72:75]
    s_waitcnt lgkmcnt(9)
    v_mfma_f32_16x16x32_bf16 v[80:83], a[64:67], a[56:59], v[80:83]
    s_waitcnt vmcnt(16) lgkmcnt(0)
    v_mfma_f32_16x16x32_bf16 v[88:91], a[64:67], a[60:63], v[88:91]
    s_barrier
    ds_read_b64_tr_b16 a[64:65], v8 offset:0
    v_mfma_f32_16x16x32_bf16 v[36:39], a[68:71], a[32:35], v[36:39]
    s_add_u32 m0, s62, 0
    ds_read_b64_tr_b16 a[66:67], v8 offset:2048
    v_mfma_f32_16x16x32_bf16 v[44:47], a[68:71], a[36:39], v[44:47]
    buffer_load_dwordx4 v18, s[44:47], s52 offen offset:0 lds
    v_mfma_f32_16x16x32_bf16 v[52:55], a[68:71], a[40:43], v[52:55]
    ds_read_b128 a[0:3], v6 offset:0
    v_mfma_f32_16x16x32_bf16 v[60:63], a[68:71], a[44:47], v[60:63]
    v_mfma_f32_16x16x32_bf16 v[68:71], a[68:71], a[48:51], v[68:71]
    v_mfma_f32_16x16x32_bf16 v[76:79], a[68:71], a[52:55], v[76:79]
    buffer_load_dwordx4 v19, s[44:47], s52 offen offset:1024 lds
    v_mfma_f32_16x16x32_bf16 v[84:87], a[68:71], a[56:59], v[84:87]
    s_add_u32 s52, s52, s56
    ds_read_b128 a[4:7], v6 offset:2048
    v_mfma_f32_16x16x32_bf16 v[92:95], a[68:71], a[60:63], v[92:95]
    ds_read_b64_tr_b16 a[68:69], v9 offset:0
    v_mfma_f32_16x16x32_bf16 v[96:99], a[72:75], a[32:35], v[96:99]
    ds_read_b64_tr_b16 a[70:71], v9 offset:2048
    v_mfma_f32_16x16x32_bf16 v[104:107], a[72:75], a[36:39], v[104:107]
    buffer_load_dwordx4 v18, s[44:47], s53 offen offset:2048 lds
    v_mfma_f32_16x16x32_bf16 v[112:115], a[72:75], a[40:43], v[112:115]
    ds_read_b128 a[8:11], v6 offset:4096
    v_mfma_f32_16x16x32_bf16 v[120:123], a[72:75], a[44:47], v[120:123]
    v_mfma_f32_16x16x32_bf16 v[128:131], a[72:75], a[48:51], v[128:131]
    v_mfma_f32_16x16x32_bf16 v[136:139], a[72:75], a[52:55], v[136:139]
    buffer_load_dwordx4 v19, s[44:47], s53 offen offset:3072 lds
    v_mfma_f32_16x16x32_bf16 v[144:147], a[72:75], a[56:59], v[144:147]
    s_add_u32 s53, s53, s56
    ds_read_b128 a[12:15], v6 offset:6144
    v_mfma_f32_16x16x32_bf16 v[152:155], a[72:75], a[60:63], v[152:155]
    ds_read_b64_tr_b16 a[72:73], v10 offset:0
    v_mfma_f32_16x16x32_bf16 v[100:103], a[76:79], a[32:35], v[100:103]
    s_add_u32 m0, s62, 4096
    ds_read_b64_tr_b16 a[74:75], v10 offset:2048
    v_mfma_f32_16x16x32_bf16 v[108:111], a[76:79], a[36:39], v[108:111]
    buffer_load_dwordx4 v20, s[44:47], s54 offen offset:0 lds
    v_mfma_f32_16x16x32_bf16 v[116:119], a[76:79], a[40:43], v[116:119]
    ds_read_b128 a[16:19], v6 offset:8192
    v_mfma_f32_16x16x32_bf16 v[124:127], a[76:79], a[44:47], v[124:127]
    s_xor_b32 s62, s62, 229376
    v_mfma_f32_16x16x32_bf16 v[132:135], a[76:79], a[48:51], v[132:135]
    v_mfma_f32_16x16x32_bf16 v[140:143], a[76:79], a[52:55], v[140:143]
    buffer_load_dwordx4 v21, s[44:47], s54 offen offset:1024 lds
    v_mfma_f32_16x16x32_bf16 v[148:151], a[76:79], a[56:59], v[148:151]
    s_add_u32 s54, s54, s56
    ds_read_b128 a[20:23], v6 offset:10240
    v_mfma_f32_16x16x32_bf16 v[156:159], a[76:79], a[60:63], v[156:159]
    ds_read_b64_tr_b16 a[76:77], v11 offset:0
    v_mfma_f32_16x16x32_bf16 v[160:163], a[80:83], a[32:35], v[160:163]
    ds_read_b64_tr_b16 a[78:79], v11 offset:2048
    v_mfma_f32_16x16x32_bf16 v[168:171], a[80:83], a[36:39], v[168:171]
    buffer_load_dwordx4 v20, s[44:47], s55 offen offset:2048 lds
    v_mfma_f32_16x16x32_bf16 v[176:179], a[80:83], a[40:43], v[176:179]
    ds_read_b128 a[24:27], v6 offset:12288
    v_mfma_f32_16x16x32_bf16 v[184:187], a[80:83], a[44:47], v[184:187]
    v_mfma_f32_16x16x32_bf16 v[192:195], a[80:83], a[48:51], v[192:195]
    v_mfma_f32_16x16x32_bf16 v[200:203], a[80:83], a[52:55], v[200:203]
    buffer_load_dwordx4 v21, s[44:47], s55 offen offset:3072 lds
    v_mfma_f32_16x16x32_bf16 v[208:211], a[80:83], a[56:59], v[208:211]
    s_add_u32 s55, s55, s56
    ds_read_b128 a[28:31], v6 offset:14336
    v_mfma_f32_16x16x32_bf16 v[216:219], a[80:83], a[60:63], v[216:219]
    ds_read_b64_tr_b16 a[80:81], v12 offset:0
    v_mfma_f32_16x16x32_bf16 v[164:167], a[84:87], a[32:35], v[164:167]
    ds_read_b64_tr_b16 a[82:83], v12 offset:2048
    v_mfma_f32_16x16x32_bf16 v[172:175], a[84:87], a[36:39], v[172:175]
    v_mfma_f32_16x16x32_bf16 v[180:183], a[84:87], a[40:43], v[180:183]
    buffer_store_dwordx4 a[236:239], v2, s[24:27], s28 offen sc1
    v_mfma_f32_16x16x32_bf16 v[188:191], a[84:87], a[44:47], v[188:191]
    s_add_u32 s28, s28, s31
    v_mfma_f32_16x16x32_bf16 v[196:199], a[84:87], a[48:51], v[196:199]
    v_mfma_f32_16x16x32_bf16 v[204:207], a[84:87], a[52:55], v[204:207]
    v_mfma_f32_16x16x32_bf16 v[212:215], a[84:87], a[56:59], v[212:215]
    buffer_store_dwordx4 a[240:243], v2, s[24:27], s28 offen sc1
    v_mfma_f32_16x16x32_bf16 v[220:223], a[84:87], a[60:63], v[220:223]
    s_add_u32 s28, s28, s31
    ds_read_b64_tr_b16 a[84:85], v13 offset:0
    v_mfma_f32_16x16x32_bf16 v[224:227], a[88:91], a[32:35], v[224:227]
    ds_read_b64_tr_b16 a[86:87], v13 offset:2048
    v_mfma_f32_16x16x32_bf16 v[232:235], a[88:91], a[36:39], v[232:235]
    v_mfma_f32_16x16x32_bf16 v[240:243], a[88:91], a[40:43], v[240:243]
    buffer_store_dwordx4 a[244:247], v2, s[24:27], s28 offen sc1
    v_mfma_f32_16x16x32_bf16 v[248:251], a[88:91], a[44:47], v[248:251]
    s_add_u32 s28, s28, s31
    v_mfma_f32_16x16x32_bf16 a[96:99], a[88:91], a[48:51], a[96:99]
    v_mfma_f32_16x16x32_bf16 a[104:107], a[88:91], a[52:55], a[104:107]
    v_mfma_f32_16x16x32_bf16 a[112:115], a[88:91], a[56:59], a[112:115]
    buffer_store_dwordx4 a[248:251], v2, s[24:27], s28 offen sc1
    v_mfma_f32_16x16x32_bf16 a[120:123], a[88:91], a[60:63], a[120:123]
    s_add_u32 s28, s28, s31
    ds_read_b64_tr_b16 a[88:89], v14 offset:0
    v_mfma_f32_16x16x32_bf16 v[228:231], a[92:95], a[32:35], v[228:231]
    ds_read_b64_tr_b16 a[90:91], v14 offset:2048
    v_mfma_f32_16x16x32_bf16 v[236:239], a[92:95], a[36:39], v[236:239]
    v_mfma_f32_16x16x32_bf16 v[244:247], a[92:95], a[40:43], v[244:247]
    buffer_store_dwordx4 a[252:255], v2, s[24:27], s28 offen sc1
    v_mfma_f32_16x16x32_bf16 v[252:255], a[92:95], a[44:47], v[252:255]
    s_add_u32 s29, s29, s30
    s_mov_b32 s28, s29
    v_mfma_f32_16x16x32_bf16 a[100:103], a[92:95], a[48:51], a[100:103]
    s_sub_u32 s65, s65, 1
    v_mfma_f32_16x16x32_bf16 a[108:111], a[92:95], a[52:55], a[108:111]
    v_mfma_f32_16x16x32_bf16 a[116:119], a[92:95], a[56:59], a[116:119]
    v_mfma_f32_16x16x32_bf16 a[124:127], a[92:95], a[60:63], a[124:127]
    ds_read_b64_tr_b16 a[92:93], v15 offset:0
    ds_read_b64_tr_b16 a[94:95], v15 offset:2048
m_loop15:
    s_waitcnt lgkmcnt(15)
    v_mfma_f32_16x16x32_bf16 v[32:35], a[64:67], a[0:3], v[32:35]
    v_mfma_f32_16x16x32_bf16 v[40:43], a[64:67], a[4:7], v[40:43]
    v_mfma_f32_16x16x32_bf16 v[48:51], a[64:67], a[8:11], v[48:51]
    v_mfma_f32_16x16x32_bf16 v[56:59], a[64:67], a[12:15], v[56:59]
    s_add_u32 m0, s61, 0
    s_waitcnt lgkmcnt(13)
    v_mfma_f32_16x16x32_bf16 v[64:67], a[64:67], a[16:19], v[64:67]
    buffer_load_dwordx4 v16, s[40:43], s48 offen offset:0 lds
    s_waitcnt lgkmcnt(12)
    v_mfma_f32_16x16x32_bf16 v[72:75], a[64:67], a[20:23], v[72:75]
    s_waitcnt lgkmcnt(9)
    v_mfma_f32_16x16x32_bf16 v[80:83], a[64:67], a[24:27], v[80:83]
    s_waitcnt lgkmcnt(8)
    v_mfma_f32_16x16x32_bf16 v[88:91], a[64:67], a[28:31], v[88:91]
    ds_read_b64_tr_b16 a[64:65], v8 offset:16384
    v_mfma_f32_16x16x32_bf16 v[36:39], a[68:71], a[0:3], v[36:39]
    ds_read_b64_tr_b16 a[66:67], v8 offset:18432
    v_mfma_f32_16x16x32_bf16 v[44:47], a[68:71], a[4:7], v[44:47]
    v_mfma_f32_16x16x32_bf16 v[52:55], a[68:71], a[8:11], v[52:55]
    ds_read_b128 a[32:35], v7 offset:0
    v_mfma_f32_16x16x32_bf16 v[60:63], a[68:71], a[12:15], v[60:63]
    v_mfma_f32_16x16x32_bf16 v[68:71], a[68:71], a[16:19], v[68:71]
    buffer_load_dwordx4 v17, s[40:43], s48 offen offset:1024 lds
    v_mfma_f32_16x16x32_bf16 v[76:79], a[68:71], a[20:23], v[76:79]
    s_add_u32 s48, s48, 128
    v_mfma_f32_16x16x32_bf16 v[84:87], a[68:71], a[24:27], v[84:87]
    ds_read_b128 a[36:39], v7 offset:2048
    v_mfma_f32_16x16x32_bf16 v[92:95], a[68:71], a[28:31], v[92:95]
    ds_read_b64_tr_b16 a[68:69], v9 offset:16384
    v_mfma_f32_16x16x32_bf16 v[96:99], a[72:75], a[0:3], v[96:99]
    ds_read_b64_tr_b16 a[70:71], v9 offset:18432
    v_mfma_f32_16x16x32_bf16 v[104:107], a[72:75], a[4:7], v[104:107]
    v_mfma_f32_16x16x32_bf16 v[112:115], a[72:75], a[8:11], v[112:115]
    ds_read_b128 a[40:43], v7 offset:4096
    v_mfma_f32_16x16x32_bf16 v[120:123], a[72:75], a[12:15], v[120:123]
    v_mfma_f32_16x16x32_bf16 v[128:131], a[72:75], a[16:19], v[128:131]
    buffer_load_dwordx4 v16, s[40:43], s49 offen offset:2048 lds
    v_mfma_f32_16x16x32_bf16 v[136:139], a[72:75], a[20:23], v[136:139]
    v_mfma_f32_16x16x32_bf16 v[144:147], a[72:75], a[24:27], v[144:147]
    ds_read_b128 a[44:47], v7 offset:6144
    v_mfma_f32_16x16x32_bf16 v[152:155], a[72:75], a[28:31], v[152:155]
    ds_read_b64_tr_b16 a[72:73], v10 offset:16384
    v_mfma_f32_16x16x32_bf16 v[100:103], a[76:79], a[0:3], v[100:103]
    ds_read_b64_tr_b16 a[74:75], v10 offset:18432
    v_mfma_f32_16x16x32_bf16 v[108:111], a[76:79], a[4:7], v[108:111]
    v_mfma_f32_16x16x32_bf16 v[116:119], a[76:79], a[8:11], v[116:119]
    ds_read_b128 a[48:51], v7 offset:8192
    v_mfma_f32_16x16x32_bf16 v[124:127], a[76:79], a[12:15], v[124:127]
    v_mfma_f32_16x16x32_bf16 v[132:135], a[76:79], a[16:19], v[132:135]
    buffer_load_dwordx4 v17, s[40:43], s49 offen offset:3072 lds
    v_mfma_f32_16x16x32_bf16 v[140:143], a[76:79], a[20:23], v[140:143]
    s_add_u32 s49, s49, 128
    v_mfma_f32_16x16x32_bf16 v[148:151], a[76:79], a[24:27], v[148:151]
    ds_read_b128 a[52:55], v7 offset:10240
    v_mfma_f32_16x16x32_bf16 v[156:159], a[76:79], a[28:31], v[156:159]
    ds_read_b64_tr_b16 a[76:77], v11 offset:16384
    s_waitcnt lgkmcnt(15)
    v_mfma_f32_16x16x32_bf16 v[160:163], a[80:83], a[0:3], v[160:163]
    ds_read_b64_tr_b16 a[78:79], v11 offset:18432
    v_mfma_f32_16x16x32_bf16 v[168:171], a[80:83], a[4:7], v[168:171]
    v_mfma_f32_16x16x32_bf16 v[176:179], a[80:83], a[8:11], v[176:179]
    ds_read_b128 a[56:59], v7 offset:12288
    v_mfma_f32_16x16x32_bf16 v[184:187], a[80:83], a[12:15], v[184:187]
    s_add_u32 m0, s61, 4096
    v_mfma_f32_16x16x32_bf16 v[192:195], a[80:83], a[16:19], v[192:195]
    buffer_load_dwordx4 v16, s[40:43], s50 offen offset:0 lds
    v_mfma_f32_16x16x32_bf16 v[200:203], a[80:83], a[20:23], v[200:203]
    v_mfma_f32_16x16x32_bf16 v[208:211], a[80:83], a[24:27], v[208:211]
    s_add_u32 s61, s61, 32768
    ds_read_b128 a[60:63], v7 offset:14336
    v_mfma_f32_16x16x32_bf16 v[216:219], a[80:83], a[28:31], v[216:219]
    s_cmp_ge_u32 s61, 98304
    s_cselect_b32 s90, 98304, 0
    ds_read_b64_tr_b16 a[80:81], v12 offset:16384
    v_mfma_f32_16x16x32_bf16 v[164:167], a[84:87], a[0:3], v[164:167]
    s_sub_u32 s61, s61, s90
    ds_read_b64_tr_b16 a[82:83], v12 offset:18432
    v_mfma_f32_16x16x32_bf16 v[172:175], a[84:87], a[4:7], v[172:175]
    s_add_u32 s64, s64, 32768
    v_mfma_f32_16x16x32_bf16 v[180:183], a[84:87], a[8:11], v[180:183]
    s_cmp_ge_u32 s64, 98304
    s_cselect_b32 s63, 4294901760, s59
    s_cselect_b32 s64, 0, s64
    v_mfma_f32_16x16x32_bf16 v[188:191], a[84:87], a[12:15], v[188:191]
    v_mfma_f32_16x16x32_bf16 v[196:199], a[84:87], a[16:19], v[196:199]
    buffer_load_dwordx4 v17, s[40:43], s50 offen offset:1024 lds
    v_mfma_f32_16x16x32_bf16 v[204:207], a[84:87], a[20:23], v[204:207]
    s_add_u32 s50, s50, 128
    v_mfma_f32_16x16x32_bf16 v[212:215], a[84:87], a[24:27], v[212:215]
    v_mfma_f32_16x16x32_bf16 v[220:223], a[84:87], a[28:31], v[220:223]
    ds_read_b64_tr_b16 a[84:85], v13 offset:16384
    v_mfma_f32_16x16x32_bf16 v[224:227], a[88:91], a[0:3], v[224:227]
    ds_read_b64_tr_b16 a[86:87], v13 offset:18432
    v_mfma_f32_16x16x32_bf16 v[232:235], a[88:91], a[4:7], v[232:235]
    v_mfma_f32_16x16x32_bf16 v[240:243], a[88:91], a[8:11], v[240:243]
    v_mfma_f32_16x16x32_bf16 v[248:251], a[88:91], a[12:15], v[248:251]
    v_mfma_f32_16x16x32_bf16 a[96:99], a[88:91], a[16:19], a[96:99]
    buffer_load_dwordx4 v16, s[40:43], s51 offen offset:2048 lds
    v_mfma_f32_16x16x32_bf16 a[104:107], a[88:91], a[20:23], a[104:107]
    v_mfma_f32_16x16x32_bf16 a[112:115], a[88:91], a[24:27], a[112:115]
    v_mfma_f32_16x16x32_bf16 a[120:123], a[88:91], a[28:31], a[120:123]
    ds_read_b64_tr_b16 a[88:89], v14 offset:16384
    s_waitcnt lgkmcnt(15)
    v_mfma_f32_16x16x32_bf16 v[228:231], a[92:95], a[0:3], v[228:231]
    ds_read_b64_tr_b16 a[90:91], v14 offset:18432
    v_mfma_f32_16x16x32_bf16 v[236:239], a[92:95], a[4:7], v[236:239]
    v_add_u32 v6, s63, v6
    v_add_u32 v7, s63, v7
    v_mfma_f32_16x16x32_bf16 v[244:247], a[92:95], a[8:11], v[244:247]
    v_mfma_f32_16x16x32_bf16 v[252:255], a[92:95], a[12:15], v[252:255]
    v_mfma_f32_16x16x32_bf16 a[100:103], a[92:95], a[16:19], a[100:103]
    buffer_load_dwordx4 v17, s[40:43], s51 offen offset:3072 lds
    v_mfma_f32_16x16x32_bf16 a[108:111], a[92:95], a[20:23], a[108:111]
    s_add_u32 s51, s51, 128
    v_mfma_f32_16x16x32_bf16 a[116:119], a[92:95], a[24:27], a[116:119]
    v_mfma_f32_16x16x32_bf16 a[124:127], a[92:95], a[28:31], a[124:127]
    ds_read_b64_tr_b16 a[92:93], v15 offset:16384
    ds_read_b64_tr_b16 a[94:95], v15 offset:18432
    v_mfma_f32_16x16x32_bf16 v[32:35], a[64:67], a[32:35], v[32:35]
    v_xor_b32 v8, s60, v8
    v_xor_b32 v9, s60, v9
    v_mfma_f32_16x16x32_bf16 v[40:43], a[64:67], a[36:39], v[40:43]
    v_xor_b32 v10, s60, v10
    v_xor_b32 v11, s60, v11
    s_waitcnt lgkmcnt(15)
    v_mfma_f32_16x16x32_bf16 v[48:51], a[64:67], a[40:43], v[48:51]
    v_xor_b32 v12, s60, v12
    v_xor_b32 v13, s60, v13
    v_mfma_f32_16x16x32_bf16 v[56:59], a[64:67], a[44:47], v[56:59]
    v_xor_b32 v14, s60, v14
    v_xor_b32 v15, s60, v15
    s_waitcnt lgkmcnt(13)
    v_mfma_f32_16x16x32_bf16 v[64:67], a[64:67], a[48:51], v[64:67]
    s_waitcnt lgkmcnt(12)
    v_mfma_f32_16x16x32_bf16 v[72:75], a[64:67], a[52:55], v[72:75]
    s_waitcnt lgkmcnt(9)
    v_mfma_f32_16x16x32_bf16 v[80:83], a[64:67], a[56:59], v[80:83]
    s_waitcnt vmcnt(8) lgkmcnt(0)
    v_mfma_f32_16x16x32_bf16 v[88:91], a[64:67], a[60:63], v[88:91]
    s_barrier
    ds_read_b64_tr_b16 a[64:65], v8 offset:0
    v_mfma_f32_16x16x32_bf16 v[36:39], a[68:71], a[32:35], v[36:39]
    s_add_u32 m0, s62, 0
    ds_read_b64_tr_b16 a[66:67], v8 offset:2048
    v_mfma_f32_16x16x32_bf16 v[44:47], a[68:71], a[36:39], v[44:47]
    buffer_load_dwordx4 v18, s[44:47], s52 offen offset:0 lds
    v_mfma_f32_16x16x32_bf16 v[52:55], a[68:71], a[40:43], v[52:55]
    ds_read_b128 a[0:3], v6 offset:0
    v_mfma_f32_16x16x32_bf16 v[60:63], a[68:71], a[44:47], v[60:63]
    v_mfma_f32_16x16x32_bf16 v[68:71], a[68:71], a[48:51], v[68:71]
    v_mfma_f32_16x16x32_bf16 v[76:79], a[68:71], a[52:55], v[76:79]
    buffer_load_dwordx4 v19, s[44:47], s52 offen offset:1024 lds
    v_mfma_f32_16x16x32_bf16 v[84:87], a[68:71], a[56:59], v[84:87]
    s_add_u32 s52, s52, s56
    ds_read_b128 a[4:7], v6 offset:2048
    v_mfma_f32_16x16x32_bf16 v[92:95], a[68:71], a[60:63], v[92:95]
    ds_read_b64_tr_b16 a[68:69], v9 offset:0
    v_mfma_f32_16x16x32_bf16 v[96:99], a[72:75], a[32:35], v[96:99]
    ds_read_b64_tr_b16 a[70:71], v9 offset:2048
    v_mfma_f32_16x16x32_bf16 v[104:107], a[72:75], a[36:39], v[104:107]
    buffer_load_dwordx4 v18, s[44:47], s53 offen offset:2048 lds
    v_mfma_f32_16x16x32_bf16 v[112:115], a[72:75], a[40:43], v[112:115]
    ds_read_b128 a[8:11], v6 offset:4096
    v_mfma_f32_16x16x32_bf16 v[120:123], a[72:75], a[44:47], v[120:123]
    v_mfma_f32_16x16x32_bf16 v[128:131], a[72:75], a[48:51], v[128:131]
    v_mfma_f32_16x16x32_bf16 v[136:139], a[72:75], a[52:55], v[136:139]
    buffer_load_dwordx4 v19, s[44:47], s53 offen offset:3072 lds
    v_mfma_f32_16x16x32_bf16 v[144:147], a[72:75], a[56:59], v[144:147]
    s_add_u32 s53, s53, s56
    ds_read_b128 a[12:15], v6 offset:6144
    v_mfma_f32_16x16x32_bf16 v[152:155], a[72:75], a[60:63], v[152:155]
    ds_read_b64_tr_b16 a[72:73], v10 offset:0
    v_mfma_f32_16x16x32_bf16 v[100:103], a[76:79], a[32:35], v[100:103]
    s_add_u32 m0, s62, 4096
    ds_read_b64_tr_b16 a[74:75], v10 offset:2048
    v_mfma_f32_16x16x32_bf16 v[108:111], a[76:79], a[36:39], v[108:111]
    buffer_load_dwordx4 v20, s[44:47], s54 offen offset:0 lds
    v_mfma_f32_16x16x32_bf16 v[116:119], a[76:79], a[40:43], v[116:119]
    ds_read_b128 a[16:19], v6 offset:8192
    v_mfma_f32_16x16x32_bf16 v[124:127], a[76:79], a[44:47], v[124:127]
    s_xor_b32 s62, s62, 229376
    v_mfma_f32_16x16x32_bf16 v[132:135], a[76:79], a[48:51], v[132:135]
    v_mfma_f32_16x16x32_bf16 v[140:143], a[76:79], a[52:55], v[140:143]
    buffer_load_dwordx4 v21, s[44:47], s54 offen offset:1024 lds
    v_mfma_f32_16x16x32_bf16 v[148:151], a[76:79], a[56:59], v[148:151]
    s_add_u32 s54, s54, s56
    ds_read_b128 a[20:23], v6 offset:10240
    v_mfma_f32_16x16x32_bf16 v[156:159], a[76:79], a[60:63], v[156:159]
    ds_read_b64_tr_b16 a[76:77], v11 offset:0
    v_mfma_f32_16x16x32_bf16 v[160:163], a[80:83], a[32:35], v[160:163]
    ds_read_b64_tr_b16 a[78:79], v11 offset:2048
    v_mfma_f32_16x16x32_bf16 v[168:171], a[80:83], a[36:39], v[168:171]
    buffer_load_dwordx4 v20, s[44:47], s55 offen offset:2048 lds
    v_mfma_f32_16x16x32_bf16 v[176:179], a[80:83], a[40:43], v[176:179]
    ds_read_b128 a[24:27], v6 offset:12288
    v_mfma_f32_16x16x32_bf16 v[184:187], a[80:83], a[44:47], v[184:187]
    v_mfma_f32_16x16x32_bf16 v[192:195], a[80:83], a[48:51], v[192:195]
    v_mfma_f32_16x16x32_bf16 v[200:203], a[80:83], a[52:55], v[200:203]
    buffer_load_dwordx4 v21, s[44:47], s55 offen offset:3072 lds
    v_mfma_f32_16x16x32_bf16 v[208:211], a[80:83], a[56:59], v[208:211]
    s_add_u32 s55, s55, s56
    ds_read_b128 a[28:31], v6 offset:14336
    v_mfma_f32_16x16x32_bf16 v[216:219], a[80:83], a[60:63], v[216:219]
    ds_read_b64_tr_b16 a[80:81], v12 offset:0
    v_mfma_f32_16x16x32_bf16 v[164:167], a[84:87], a[32:35], v[164:167]
    ds_read_b64_tr_b16 a[82:83], v12 offset:2048
    v_mfma_f32_16x16x32_bf16 v[172:175], a[84:87], a[36:39], v[172:175]
    v_mfma_f32_16x16x32_bf16 v[180:183], a[84:87], a[40:43], v[180:183]
    v_mfma_f32_16x16x32_bf16 v[188:191], a[84:87], a[44:47], v[188:191]
    v_mfma_f32_16x16x32_bf16 v[196:199], a[84:87], a[48:51], v[196:199]
    v_mfma_f32_16x16x32_bf16 v[204:207], a[84:87], a[52:55], v[204:207]
    v_mfma_f32_16x16x32_bf16 v[212:215], a[84:87], a[56:59], v[212:215]
    v_mfma_f32_16x16x32_bf16 v[220:223], a[84:87], a[60:63], v[220:223]
    ds_read_b64_tr_b16 a[84:85], v13 offset:0
    v_mfma_f32_16x16x32_bf16 v[224:227], a[88:91], a[32:35], v[224:227]
    ds_read_b64_tr_b16 a[86:87], v13 offset:2048
    v_mfma_f32_16x16x32_bf16 v[232:235], a[88:91], a[36:39], v[232:235]
    v_mfma_f32_16x16x32_bf16 v[240:243], a[88:91], a[40:43], v[240:243]
    v_mfma_f32_16x16x32_bf16 v[248:251], a[88:91], a[44:47], v[248:251]
    v_mfma_f32_16x16x32_bf16 a[96:99], a[88:91], a[48:51], a[96:99]
    v_mfma_f32_16x16x32_bf16 a[104:107], a[88:91], a[52:55], a[104:107]
    v_mfma_f32_16x16x32_bf16 a[112:115], a[88:91], a[56:59], a[112:115]
    v_mfma_f32_16x16x32_bf16 a[120:123], a[88:91], a[60:63], a[120:123]
    ds_read_b64_tr_b16 a[88:89], v14 offset:0
    v_mfma_f32_16x16x32_bf16 v[228:231], a[92:95], a[32:35], v[228:231]
    ds_read_b64_tr_b16 a[90:91], v14 offset:2048
    v_mfma_f32_16x16x32_bf16 v[236:239], a[92:95], a[36:39], v[236:239]
    v_mfma_f32_16x16x32_bf16 v[244:247], a[92:95], a[40:43], v[244:247]
    v_mfma_f32_16x16x32_bf16 v[252:255], a[92:95], a[44:47], v[252:255]
    v_mfma_f32_16x16x32_bf16 a[100:103], a[92:95], a[48:51], a[100:103]
    s_sub_u32 s65, s65, 1
    v_mfma_f32_16x16x32_bf16 a[108:111], a[92:95], a[52:55], a[108:111]
    v_mfma_f32_16x16x32_bf16 a[116:119], a[92:95], a[56:59], a[116:119]
    s_cmp_gt_u32 s65, s67
    v_mfma_f32_16x16x32_bf16 a[124:127], a[92:95], a[60:63], a[124:127]
    ds_read_b64_tr_b16 a[92:93], v15 offset:0
    ds_read_b64_tr_b16 a[94:95], v15 offset:2048
    s_cbranch_scc1 m_loop15
    s_cmp_lg_u32 s65, 0
    s_cbranch_scc1 m_dosw16
    s_branch m_epi11
m_swp12:
    s_waitcnt lgkmcnt(15)
    v_mfma_f32_16x16x32_bf16 v[32:35], a[0:3], a[64:67], 0
    v_mfma_f32_16x16x32_bf16 v[36:39], a[4:7], a[64:67], 0
    v_mfma_f32_16x16x32_bf16 v[96:99], a[8:11], a[64:67], 0
    v_mfma_f32_16x16x32_bf16 v[100:103], a[12:15], a[64:67], 0
    s_add_u32 m0, s61, 0
    s_waitcnt lgkmcnt(13)
    v_mfma_f32_16x16x32_bf16 v[160:163], a[16:19], a[64:67], 0
    buffer_load_dwordx4 v16, s[40:43], s48 offen offset:0 lds
    s_waitcnt lgkmcnt(12)
    v_mfma_f32_16x16x32_bf16 v[164:167], a[20:23], a[64:67], 0
    s_waitcnt lgkmcnt(9)
    v_mfma_f32_16x16x32_bf16 v[224:227], a[24:27], a[64:67], 0
    s_waitcnt lgkmcnt(8)
    v_mfma_f32_16x16x32_bf16 v[228:231], a[28:31], a[64:67], 0
    ds_read_b64_tr_b16 a[64:65], v8 offset:16384
    v_mfma_f32_16x16x32_bf16 v[40:43], a[0:3], a[68:71], 0
    ds_read_b64_tr_b16 a[66:67], v8 offset:18432
    v_mfma_f32_16x16x32_bf16 v[44:47], a[4:7], a[68:71], 0
    v_mfma_f32_16x16x32_bf16 v[104:107], a[8:11], a[68:71], 0
    ds_read_b128 a[32:35], v7 offset:0
    v_mfma_f32_16x16x32_bf16 v[108:111], a[12:15], a[68:71], 0
    v_mfma_f32_16x16x32_bf16 v[168:171], a[16:19], a[68:71], 0
    buffer_load_dwordx4 v17, s[40:43], s48 offen offset:1024 lds
    v_mfma_f32_16x16x32_bf16 v[172:175], a[20:23], a[68:71], 0
    s_add_u32 s48, s48, 128
    v_mfma_f32_16x16x32_bf16 v[232:235], a[24:27], a[68:71], 0
    ds_read_b128 a[36:39], v7 offset:2048
    v_mfma_f32_16x16x32_bf16 v[236:239], a[28:31], a[68:71], 0
    ds_read_b64_tr_b16 a[68:69], v9 offset:16384
    v_mfma_f32_16x16x32_bf16 v[48:51], a[0:3], a[72:75], 0
    ds_read_b64_tr_b16 a[70:71], v9 offset:18432
    v_mfma_f32_16x16x32_bf16 v[52:55], a[4:7], a[72:75], 0
    v_mfma_f32_16x16x32_bf16 v[112:115], a[8:11], a[72:75], 0
    ds_read_b128 a[40:43], v7 offset:4096
    v_mfma_f32_16x16x32_bf16 v[116:119], a[12:15], a[72:75], 0
    v_mfma_f32_16x16x32_bf16 v[176:179], a[16:19], a[72:75], 0
    buffer_load_dwordx4 v16, s[40:43], s49 offen offset:2048 lds
    v_mfma_f32_16x16x32_bf16 v[180:183], a[20:23], a[72:75], 0
    v_mfma_f32_16x16x32_bf16 v[240:243], a[24:27], a[72:75], 0
    ds_read_b128 a[44:47], v7 offset:6144
    v_mfma_f32_16x16x32_bf16 v[244:247], a[28:31], a[72:75], 0
    ds_read_b64_tr_b16 a[72:73], v10 offset:16384
    v_mfma_f32_16x16x32_bf16 v[56:59], a[0:3], a[76:79], 0
    ds_read_b64_tr_b16 a[74:75], v10 offset:18432
    v_mfma_f32_16x16x32_bf16 v[60:63], a[4:7], a[76:79], 0
    v_mfma_f32_16x16x32_bf16 v[120:123], a[8:11], a[76:79], 0
    ds_read_b128 a[48:51], v7 offset:8192
    v_mfma_f32_16x16x32_bf16 v[124:127], a[12:15], a[76:79], 0
    v_mfma_f32_16x16x32_bf16 v[184:187], a[16:19], a[76:79], 0
    buffer_load_dwordx4 v17, s[40:43], s49 offen offset:3072 lds
    v_mfma_f32_16x16x32_bf16 v[188:191], a[20:23], a[76:79], 0
    s_add_u32 s49, s49, 128
    v_mfma_f32_16x16x32_bf16 v[248:251], a[24:27], a[76:79], 0
    ds_read_b128 a[52:55], v7 offset:10240
    v_mfma_f32_16x16x32_bf16 v[252:255], a[28:31], a[76:79], 0
    ds_read_b64_tr_b16 a[76:77], v11 offset:16384
    s_waitcnt lgkmcnt(15)
    v_mfma_f32_16x16x32_bf16 v[64:67], a[0:3], a[80:83], 0
    ds_read_b64_tr_b16 a[78:79], v11 offset:18432
    v_mfma_f32_16x16x32_bf16 v[68:71], a[4:7], a[80:83], 0
    v_mfma_f32_16x16x32_bf16 v[128:131], a[8:11], a[80:83], 0
    ds_read_b128 a[56:59], v7 offset:12288
    v_mfma_f32_16x16x32_bf16 v[132:135], a[12:15], a[80:83], 0
    s_add_u32 m0, s61, 4096
    v_mfma_f32_16x16x32_bf16 v[192:195], a[16:19], a[80:83], 0
    buffer_load_dwordx4 v16, s[40:43], s50 offen offset:0 lds
    v_mfma_f32_16x16x32_bf16 v[196:199], a[20:23], a[80:83], 0
    v_mfma_f32_16x16x32_bf16 a[96:99], a[24:27], a[80:83], 0
    s_add_u32 s61, s61, 32768
    ds_read_b128 a[60:63], v7 offset:14336
    v_mfma_f32_16x16x32_bf16 a[100:103], a[28:31], a[80:83], 0
    s_cmp_ge_u32 s61, 98304
    s_cselect_b32 s90, 98304, 0
    ds_read_b64_tr_b16 a[80:81], v12 offset:16384
    v_mfma_f32_16x16x32_bf16 v[72:75], a[0:3], a[84:87], 0
    s_sub_u32 s61, s61, s90
    ds_read_b64_tr_b16 a[82:83], v12 offset:18432
    v_mfma_f32_16x16x32_bf16 v[76:79], a[4:7], a[84:87], 0
    s_add_u32 s64, s64, 32768
    v_mfma_f32_16x16x32_bf16 v[136:139], a[8:11], a[84:87], 0
    buffer_store_dwordx4 a[128:131], v2, s[24:27], s28 offen sc1
    v_mfma_f32_16x16x32_bf16 v[140:143], a[12:15], a[84:87], 0
    s_add_u32 s28, s28, s31
    v_mfma_f32_16x16x32_bf16 v[200:203], a[16:19], a[84:87], 0
    buffer_load_dwordx4 v17, s[40:43], s50 offen offset:1024 lds
    v_mfma_f32_16x16x32_bf16 v[204:207], a[20:23], a[84:87], 0
    s_add_u32 s50, s50, 128
    v_mfma_f32_16x16x32_bf16 a[104:107], a[24:27], a[84:87], 0
    s_cmp_ge_u32 s64, 98304
    s_cselect_b32 s63, 4294901760, s59
    s_cselect_b32 s64, 0, s64
    v_mfma_f32_16x16x32_bf16 a[108:111], a[28:31], a[84:87], 0
    ds_read_b64_tr_b16 a[84:85], v13 offset:16384
    v_mfma_f32_16x16x32_bf16 v[80:83], a[0:3], a[88:91], 0
    ds_read_b64_tr_b16 a[86:87], v13 offset:18432
    v_mfma_f32_16x16x32_bf16 v[84:87], a[4:7], a[88:91], 0
    v_mfma_f32_16x16x32_bf16 v[144:147], a[8:11], a[88:91], 0
    buffer_store_dwordx4 a[132:135], v2, s[24:27], s28 offen sc1
    v_mfma_f32_16x16x32_bf16 v[148:151], a[12:15], a[88:91], 0
    s_add_u32 s28, s28, s31
    v_mfma_f32_16x16x32_bf16 v[208:211], a[16:19], a[88:91], 0
    buffer_load_dwordx4 v16, s[40:43], s51 offen offset:2048 lds
    v_mfma_f32_16x16x32_bf16 v[212:215], a[20:23], a[88:91], 0
    v_mfma_f32_16x16x32_bf16 a[112:115], a[24:27], a[88:91], 0
    v_mfma_f32_16x16x32_bf16 a[116:119], a[28:31], a[88:91], 0
    ds_read_b64_tr_b16 a[88:89], v14 offset:16384
    s_waitcnt lgkmcnt(15)
    v_mfma_f32_16x16x32_bf16 v[88:91], a[0:3], a[92:95], 0
    ds_read_b64_tr_b16 a[90:91], v14 offset:18432
    v_mfma_f32_16x16x32_bf16 v[92:95], a[4:7], a[92:95], 0
    v_add_u32 v6, s63, v6
    v_add_u32 v7, s63, v7
    v_mfma_f32_16x16x32_bf16 v[152:155], a[8:11], a[92:95], 0
    buffer_store_dwordx4 a[136:139], v2, s[24:27], s28 offen sc1
    v_mfma_f32_16x16x32_bf16 v[156:159], a[12:15], a[92:95], 0
    s_add_u32 s28, s28, s31
    v_mfma_f32_16x16x32_bf16 v[216:219], a[16:19], a[92:95], 0
    buffer_load_dwordx4 v17, s[40:43], s51 offen offset:3072 lds
    v_mfma_f32_16x16x32_bf16 v[220:223], a[20:23], a[92:95], 0
    s_add_u32 s51, s51, 128
    v_mfma_f32_16x16x32_bf16 a[120:123], a[24:27], a[92:95], 0
    v_mfma_f32_16x16x32_bf16 a[124:127], a[28:31], a[92:95], 0
    ds_read_b64_tr_b16 a[92:93], v15 offset:16384
    ds_read_b64_tr_b16 a[94:95], v15 offset:18432
    v_mfma_f32_16x16x32_bf16 v[32:35], a[32:35], a[64:67], v[32:35]
    v_xor_b32 v8, s60, v8
    v_xor_b32 v9, s60, v9
    v_mfma_f32_16x16x32_bf16 v[36:39], a[36:39], a[64:67], v[36:39]
    v_xor_b32 v10, s60, v10
    v_xor_b32 v11, s60, v11
    s_waitcnt lgkmcnt(15)
    v_mfma_f32_16x16x32_bf16 v[96:99], a[40:43], a[64:67], v[96:99]
    v_xor_b32 v12, s60, v12
    v_xor_b32 v13, s60, v13
    v_mfma_f32_16x16x32_bf16 v[100:103], a[44:47], a[64:67], v[100:103]
    v_xor_b32 v14, s60, v14
    v_xor_b32 v15, s60, v15
    s_waitcnt lgkmcnt(13)
    v_mfma_f32_16x16x32_bf16 v[160:163], a[48:51], a[64:67], v[160:163]
    s_waitcnt lgkmcnt(12)
    v_mfma_f32_16x16x32_bf16 v[164:167], a[52:55], a[64:67], v[164:167]
    s_waitcnt lgkmcnt(9)
    v_mfma_f32_16x16x32_bf16 v[224:227], a[56:59], a[64:67], v[224:227]
    s_waitcnt vmcnt(11) lgkmcnt(0)
    v_mfma_f32_16x16x32_bf16 v[228:231], a[60:63], a[64:67], v[228:231]
    s_barrier
    ds_read_b64_tr_b16 a[64:65], v8 offset:0
    v_mfma_f32_16x16x32_bf16 v[40:43], a[32:35], a[68:71], v[40:43]
    s_add_u32 m0, s62, 0
    ds_read_b64_tr_b16 a[66:67], v8 offset:2048
    v_mfma_f32_16x16x32_bf16 v[44:47], a[36:39], a[68:71], v[44:47]
    buffer_load_dwordx4 v18, s[44:47], s52 offen offset:0 lds
    v_mfma_f32_16x16x32_bf16 v[104:107], a[40:43], a[68:71], v[104:107]
    ds_read_b128 a[0:3], v6 offset:0
    v_mfma_f32_16x16x32_bf16 v[108:111], a[44:47], a[68:71], v[108:111]
    v_mfma_f32_16x16x32_bf16 v[168:171], a[48:51], a[68:71], v[168:171]
    v_mfma_f32_16x16x32_bf16 v[172:175], a[52:55], a[68:71], v[172:175]
    buffer_load_dwordx4 v19, s[44:47], s52 offen offset:1024 lds
    v_mfma_f32_16x16x32_bf16 v[232:235], a[56:59], a[68:71], v[232:235]
    s_add_u32 s52, s52, s56
    ds_read_b128 a[4:7], v6 offset:2048
    v_mfma_f32_16x16x32_bf16 v[236:239], a[60:63], a[68:71], v[236:239]
    ds_read_b64_tr_b16 a[68:69], v9 offset:0
    v_mfma_f32_16x16x32_bf16 v[48:51], a[32:35], a[72:75], v[48:51]
    ds_read_b64_tr_b16 a[70:71], v9 offset:2048
    v_mfma_f32_16x16x32_bf16 v[52:55], a[36:39], a[72:75], v[52:55]
    buffer_load_dwordx4 v18, s[44:47], s53 offen offset:2048 lds
    v_mfma_f32_16x16x32_bf16 v[112:115], a[40:43], a[72:75], v[112:115]
    ds_read_b128 a[8:11], v6 offset:4096
    v_mfma_f32_16x16x32_bf16 v[116:119], a[44:47], a[72:75], v[116:119]
    v_mfma_f32_16x16x32_bf16 v[176:179], a[48:51], a[72:75], v[176:179]
    v_mfma_f32_16x16x32_bf16 v[180:183], a[52:55], a[72:75], v[180:183]
    buffer_load_dwordx4 v19, s[44:47], s53 offen offset:3072 lds
    v_mfma_f32_16x16x32_bf16 v[240:243], a[56:59], a[72:75], v[240:243]
    s_add_u32 s53, s53, s56
    ds_read_b128 a[12:15], v6 offset:6144
    v_mfma_f32_16x16x32_bf16 v[244:247], a[60:63], a[72:75], v[244:247]
    ds_read_b64_tr_b16 a[72:73], v10 offset:0
    v_mfma_f32_16x16x32_bf16 v[56:59], a[32:35], a[76:79], v[56:59]
    s_add_u32 m0, s62, 4096
    ds_read_b64_tr_b16 a[74:75], v10 offset:2048
    v_mfma_f32_16x16x32_bf16 v[60:63], a[36:39], a[76:79], v[60:63]
    buffer_load_dwordx4 v20, s[44:47], s54 offen offset:0 lds
    v_mfma_f32_16x16x32_bf16 v[120:123], a[40:43], a[76:79], v[120:123]
    ds_read_b128 a[16:19], v6 offset:8192
    v_mfma_f32_16x16x32_bf16 v[124:127], a[44:47], a[76:79], v[124:127]
    s_xor_b32 s62, s62, 229376
    v_mfma_f32_16x16x32_bf16 v[184:187], a[48:51], a[76:79], v[184:187]
    v_mfma_f32_16x16x32_bf16 v[188:191], a[52:55], a[76:79], v[188:191]
    buffer_load_dwordx4 v21, s[44:47], s54 offen offset:1024 lds
    v_mfma_f32_16x16x32_bf16 v[248:251], a[56:59], a[76:79], v[248:251]
    s_add_u32 s54, s54, s56
    ds_read_b128 a[20:23], v6 offset:10240
    v_mfma_f32_16x16x32_bf16 v[252:255], a[60:63], a[76:79], v[252:255]
    ds_read_b64_tr_b16 a[76:77], v11 offset:0
    v_mfma_f32_16x16x32_bf16 v[64:67], a[32:35], a[80:83], v[64:67]
    ds_read_b64_tr_b16 a[78:79], v11 offset:2048
    v_mfma_f32_16x16x32_bf16 v[68:71], a[36:39], a[80:83], v[68:71]
    buffer_load_dwordx4 v20, s[44:47], s55 offen offset:2048 lds
    v_mfma_f32_16x16x32_bf16 v[128:131], a[40:43], a[80:83], v[128:131]
    ds_read_b128 a[24:27], v6 offset:12288
    v_mfma_f32_16x16x32_bf16 v[132:135], a[44:47], a[80:83], v[132:135]
    v_mfma_f32_16x16x32_bf16 v[192:195], a[48:51], a[80:83], v[192:195]
    v_mfma_f32_16x16x32_bf16 v[196:199], a[52:55], a[80:83], v[196:199]
    buffer_load_dwordx4 v21, s[44:47], s55 offen offset:3072 lds
    v_mfma_f32_16x16x32_bf16 a[96:99], a[56:59], a[80:83], a[96:99]
    s_add_u32 s55, s55, s56
    ds_read_b128 a[28:31], v6 offset:14336
    v_mfma_f32_16x16x32_bf16 a[100:103], a[60:63], a[80:83], a[100:103]
    ds_read_b64_tr_b16 a[80:81], v12 offset:0
    v_mfma_f32_16x16x32_bf16 v[72:75], a[32:35], a[84:87], v[72:75]
    ds_read_b64_tr_b16 a[82:83], v12 offset:2048
    v_mfma_f32_16x16x32_bf16 v[76:79], a[36:39], a[84:87], v[76:79]
    v_mfma_f32_16x16x32_bf16 v[136:139], a[40:43], a[84:87], v[136:139]
    buffer_store_dwordx4 a[140:143], v2, s[24:27], s28 offen sc1
    v_mfma_f32_16x16x32_bf16 v[140:143], a[44:47], a[84:87], v[140:143]
    s_add_u32 s28, s28, s31
    v_mfma_f32_16x16x32_bf16 v[200:203], a[48:51], a[84:87], v[200:203]
    v_mfma_f32_16x16x32_bf16 v[204:207], a[52:55], a[84:87], v[204:207]
    v_mfma_f32_16x16x32_bf16 a[104:107], a[56:59], a[84:87], a[104:107]
    buffer_store_dwordx4 a[144:147], v2, s[24:27], s28 offen sc1
    v_mfma_f32_16x16x32_bf16 a[108:111], a[60:63], a[84:87], a[108:111]
    s_add_u32 s28, s28, s31
    ds_read_b64_tr_b16 a[84:85], v13 offset:0
    v_mfma_f32_16x16x32_bf16 v[80:83], a[32:35], a[88:91], v[80:83]
    ds_read_b64_tr_b16 a[86:87], v13 offset:2048
    v_mfma_f32_16x16x32_bf16 v[84:87], a[36:39], a[88:91], v[84:87]
    v_mfma_f32_16x16x32_bf16 v[144:147], a[40:43], a[88:91], v[144:147]
    buffer_store_dwordx4 a[148:151], v2, s[24:27], s28 offen sc1
    v_mfma_f32_16x16x32_bf16 v[148:151], a[44:47], a[88:91], v[148:151]
    s_add_u32 s28, s28, s31
    v_mfma_f32_16x16x32_bf16 v[208:211], a[48:51], a[88:91], v[208:211]
    v_mfma_f32_16x16x32_bf16 v[212:215], a[52:55], a[88:91], v[212:215]
    v_mfma_f32_16x16x32_bf16 a[112:115], a[56:59], a[88:91], a[112:115]
    buffer_store_dwordx4 a[152:155], v2, s[24:27], s28 offen sc1
    v_mfma_f32_16x16x32_bf16 a[116:119], a[60:63], a[88:91], a[116:119]
    s_add_u32 s28, s28, s31
    ds_read_b64_tr_b16 a[88:89], v14 offset:0
    v_mfma_f32_16x16x32_bf16 v[88:91], a[32:35], a[92:95], v[88:91]
    ds_read_b64_tr_b16 a[90:91], v14 offset:2048
    v_mfma_f32_16x16x32_bf16 v[92:95], a[36:39], a[92:95], v[92:95]
    v_mfma_f32_16x16x32_bf16 v[152:155], a[40:43], a[92:95], v[152:155]
    buffer_store_dwordx4 a[156:159], v2, s[24:27], s28 offen sc1
    v_mfma_f32_16x16x32_bf16 v[156:159], a[44:47], a[92:95], v[156:159]
    s_add_u32 s29, s29, s30
    s_mov_b32 s28, s29
    v_mfma_f32_16x16x32_bf16 v[216:219], a[48:51], a[92:95], v[216:219]
    s_sub_u32 s65, s65, 1
    v_mfma_f32_16x16x32_bf16 v[220:223], a[52:55], a[92:95], v[220:223]
    v_mfma_f32_16x16x32_bf16 a[120:123], a[56:59], a[92:95], a[120:123]
    v_mfma_f32_16x16x32_bf16 a[124:127], a[60:63], a[92:95], a[124:127]
    ds_read_b64_tr_b16 a[92:93], v15 offset:0
    ds_read_b64_tr_b16 a[94:95], v15 offset:2048
    s_waitcnt lgkmcnt(15)
    v_mfma_f32_16x16x32_bf16 v[32:35], a[0:3], a[64:67], v[32:35]
    v_mfma_f32_16x16x32_bf16 v[36:39], a[4:7], a[64:67], v[36:39]
    v_mfma_f32_16x16x32_bf16 v[96:99], a[8:11], a[64:67], v[96:99]
    v_mfma_f32_16x16x32_bf16 v[100:103], a[12:15], a[64:67], v[100:103]
    s_add_u32 m0, s61, 0
    s_waitcnt lgkmcnt(13)
    v_mfma_f32_16x16x32_bf16 v[160:163], a[16:19], a[64:67], v[160:163]
    buffer_load_dwordx4 v16, s[40:43], s48 offen offset:0 lds
    s_waitcnt lgkmcnt(12)
    v_mfma_f32_16x16x32_bf16 v[164:167], a[20:23], a[64:67], v[164:167]
    s_waitcnt lgkmcnt(9)
    v_mfma_f32_16x16x32_bf16 v[224:227], a[24:27], a[64:67], v[224:227]
    s_waitcnt lgkmcnt(8)
    v_mfma_f32_16x16x32_bf16 v[228:231], a[28:31], a[64:67], v[228:231]
    ds_read_b64_tr_b16 a[64:65], v8 offset:16384
    v_mfma_f32_16x16x32_bf16 v[40:43], a[0:3], a[68:71], v[40:43]
    ds_read_b64_tr_b16 a[66:67], v8 offset:18432
    v_mfma_f32_16x16x32_bf16 v[44:47], a[4:7], a[68:71], v[44:47]
    v_mfma_f32_16x16x32_bf16 v[104:107], a[8:11], a[68:71], v[104:107]
    ds_read_b128 a[32:35], v7 offset:0
    v_mfma_f32_16x16x32_bf16 v[108:111], a[12:15], a[68:71], v[108:111]
    v_mfma_f32_16x16x32_bf16 v[168:171], a[16:19], a[68:71], v[168:171]
    buffer_load_dwordx4 v17, s[40:43], s48 offen offset:1024 lds
    v_mfma_f32_16x16x32_bf16 v[172:175], a[20:23], a[68:71], v[172:175]
    s_add_u32 s48, s48, 128
    v_mfma_f32_16x16x32_bf16 v[232:235], a[24:27], a[68:71], v[232:235]
    ds_read_b128 a[36:39], v7 offset:2048
    v_mfma_f32_16x16x32_bf16 v[236:239], a[28:31], a[68:71], v[236:239]
    ds_read_b64_tr_b16 a[68:69], v9 offset:16384
    v_mfma_f32_16x16x32_bf16 v[48:51], a[0:3], a[72:75], v[48:51]
    ds_read_b64_tr_b16 a[70:71], v9 offset:18432
    v_mfma_f32_16x16x32_bf16 v[52:55], a[4:7], a[72:75], v[52:55]
    v_mfma_f32_16x16x32_bf16 v[112:115], a[8:11], a[72:75], v[112:115]
    ds_read_b128 a[40:43], v7 offset:4096
    v_mfma_f32_16x16x32_bf16 v[116:119], a[12:15], a[72:75], v[116:119]
    v_mfma_f32_16x16x32_bf16 v[176:179], a[16:19], a[72:75], v[176:179]
    buffer_load_dwordx4 v16, s[40:43], s49 offen offset:2048 lds
    v_mfma_f32_16x16x32_bf16 v[180:183], a[20:23], a[72:75], v[180:183]
    v_mfma_f32_16x16x32_bf16 v[240:243], a[24:27], a[72:75], v[240:243]
    ds_read_b128 a[44:47], v7 offset:6144
    v_mfma_f32_16x16x32_bf16 v[244:247], a[28:31], a[72:75], v[244:247]
    ds_read_b64_tr_b16 a[72:73], v10 offset:16384
    v_mfma_f32_16x16x32_bf16 v[56:59], a[0:3], a[76:79], v[56:59]
    ds_read_b64_tr_b16 a[74:75], v10 offset:18432
    v_mfma_f32_16x16x32_bf16 v[60:63], a[4:7], a[76:79], v[60:63]
    v_mfma_f32_16x16x32_bf16 v[120:123], a[8:11], a[76:79], v[120:123]
    ds_read_b128 a[48:51], v7 offset:8192
    v_mfma_f32_16x16x32_bf16 v[124:127], a[12:15], a[76:79], v[124:127]
    v_mfma_f32_16x16x32_bf16 v[184:187], a[16:19], a[76:79], v[184:187]
    buffer_load_dwordx4 v17, s[40:43], s49 offen offset:3072 lds
    v_mfma_f32_16x16x32_bf16 v[188:191], a[20:23], a[76:79], v[188:191]
    s_add_u32 s49, s49, 128
    v_mfma_f32_16x16x32_bf16 v[248:251], a[24:27], a[76:79], v[248:251]
    ds_read_b128 a[52:55], v7 offset:10240
    v_mfma_f32_16x16x32_bf16 v[252:255], a[28:31], a[76:79], v[252:255]
    ds_read_b64_tr_b16 a[76:77], v11 offset:16384
    s_waitcnt lgkmcnt(15)
    v_mfma_f32_16x16x32_bf16 v[64:67], a[0:3], a[80:83], v[64:67]
    ds_read_b64_tr_b16 a[78:79], v11 offset:18432
    v_mfma_f32_16x16x32_bf16 v[68:71], a[4:7], a[80:83], v[68:71]
    v_mfma_f32_16x16x32_bf16 v[128:131], a[8:11], a[80:83], v[128:131]
    ds_read_b128 a[56:59], v7 offset:12288
    v_mfma_f32_16x16x32_bf16 v[132:135], a[12:15], a[80:83], v[132:135]
    s_add_u32 m0, s61, 4096
    v_mfma_f32_16x16x32_bf16 v[192:195], a[16:19], a[80:83], v[192:195]
    buffer_load_dwordx4 v16, s[40:43], s50 offen offset:0 lds
    v_mfma_f32_16x16x32_bf16 v[196:199], a[20:23], a[80:83], v[196:199]
    v_mfma_f32_16x16x32_bf16 a[96:99], a[24:27], a[80:83], a[96:99]
    s_add_u32 s61, s61, 32768
    ds_read_b128 a[60:63], v7 offset:14336
    v_mfma_f32_16x16x32_bf16 a[100:103], a[28:31], a[80:83], a[100:103]
    s_cmp_ge_u32 s61, 98304
    s_cselect_b32 s90, 98304, 0
    ds_read_b64_tr_b16 a[80:81], v12 offset:16384
    v_mfma_f32_16x16x32_bf16 v[72:75], a[0:3], a[84:87], v[72:75]
    s_sub_u32 s61, s61, s90
    ds_read_b64_tr_b16 a[82:83], v12 offset:18432
    v_mfma_f32_16x16x32_bf16 v[76:79], a[4:7], a[84:87], v[76:79]
    s_add_u32 s64, s64, 32768
    v_mfma_f32_16x16x32_bf16 v[136:139], a[8:11], a[84:87], v[136:139]
    buffer_store_dwordx4 a[160:163], v2, s[24:27], s28 offen sc1
    v_mfma_f32_16x16x32_bf16 v[140:143], a[12:15], a[84:87], v[140:143]
    s_add_u32 s28, s28, s31
    v_mfma_f32_16x16x32_bf16 v[200:203], a[16:19], a[84:87], v[200:203]
    buffer_load_dwordx4 v17, s[40:43], s50 offen offset:1024 lds
    v_mfma_f32_16x16x32_bf16 v[204:207], a[20:23], a[84:87], v[204:207]
    s_add_u32 s50, s50, 128
    v_mfma_f32_16x16x32_bf16 a[104:107], a[24:27], a[84:87], a[104:107]
    s_cmp_ge_u32 s64, 98304
    s_cselect_b32 s63, 4294901760, s59
    s_cselect_b32 s64, 0, s64
    v_mfma_f32_16x16x32_bf16 a[108:111], a[28:31], a[84:87], a[108:111]
    ds_read_b64_tr_b16 a[84:85], v13 offset:16384
    v_mfma_f32_16x16x32_bf16 v[80:83], a[0:3], a[88:91], v[80:83]
    ds_read_b64_tr_b16 a[86:87], v13 offset:18432
    v_mfma_f32_16x16x32_bf16 v[84:87], a[4:7], a[88:91], v[84:87]
    v_mfma_f32_16x16x32_bf16 v[144:147], a[8:11], a[88:91], v[144:147]
    buffer_store_dwordx4 a[164:167], v2, s[24:27], s28 offen sc1
    v_mfma_f32_16x16x32_bf16 v[148:151], a[12:15], a[88:91], v[148:151]
    s_add_u32 s28, s28, s31
    v_mfma_f32_16x16x32_bf16 v[208:211], a[16:19], a[88:91], v[208:211]
    buffer_load_dwordx4 v16, s[40:43], s51 offen offset:2048 lds
    v_mfma_f32_16x16x32_bf16 v[212:215], a[20:23], a[88:91], v[212:215]
    v_mfma_f32_16x16x32_bf16 a[112:115], a[24:27], a[88:91], a[112:115]
    v_mfma_f32_16x16x32_bf16 a[116:119], a[28:31], a[88:91], a[116:119]
    ds_read_b64_tr_b16 a[88:89], v14 offset:16384
    s_waitcnt lgkmcnt(15)
    v_mfma_f32_16x16x32_bf16 v[88:91], a[0:3], a[92:95], v[88:91]
    ds_read_b64_tr_b16 a[90:91], v14 offset:18432
    v_mfma_f32_16x16x32_bf16 v[92:95], a[4:7], a[92:95], v[92:95]
    v_add_u32 v6, s63, v6
    v_add_u32 v7, s63, v7
    v_mfma_f32_16x16x32_bf16 v[152:155], a[8:11], a[92:95], v[152:155]
    buffer_store_dwordx4 a[168:171], v2, s[24:27], s28 offen sc1
    v_mfma_f32_16x16x32_bf16 v[156:159], a[12:15], a[92:95], v[156:159]
    s_add_u32 s28, s28, s31
    v_mfma_f32_16x16x32_bf16 v[216:219], a[16:19], a[92:95], v[216:219]
    buffer_load_dwordx4 v17, s[40:43], s51 offen offset:3072 lds
    v_mfma_f32_16x16x32_bf16 v[220:223], a[20:23], a[92:95], v[220:223]
    s_add_u32 s51, s51, 128
    v_mfma_f32_16x16x32_bf16 a[120:123], a[24:27], a[92:95], a[120:123]
    v_mfma_f32_16x16x32_bf16 a[124:127], a[28:31], a[92:95], a[124:127]
    ds_read_b64_tr_b16 a[92:93], v15 offset:16384
    ds_read_b64_tr_b16 a[94:95], v15 offset:18432
    v_mfma_f32_16x16x32_bf16 v[32:35], a[32:35], a[64:67], v[32:35]
    v_xor_b32 v8, s60, v8
    v_xor_b32 v9, s60, v9
    v_mfma_f32_16x16x32_bf16 v[36:39], a[36:39], a[64:67], v[36:39]
    v_xor_b32 v10, s60, v10
    v_xor_b32 v11, s60, v11
    s_waitcnt lgkmcnt(15)
    v_mfma_f32_16x16x32_bf16 v[96:99], a[40:43], a[64:67], v[96:99]
    v_xor_b32 v12, s60, v12
    v_xor_b32 v13, s60, v13
    v_mfma_f32_16x16x32_bf16 v[100:103], a[44:47], a[64:67], v[100:103]
    v_xor_b32 v14, s60, v14
    v_xor_b32 v15, s60, v15
    s_waitcnt lgkmcnt(13)
    v_mfma_f32_16x16x32_bf16 v[160:163], a[48:51], a[64:67], v[160:163]
    s_waitcnt lgkmcnt(12)
    v_mfma_f32_16x16x32_bf16 v[164:167], a[52:55], a[64:67], v[164:167]
    s_waitcnt lgkmcnt(9)
    v_mfma_f32_16x16x32_bf16 v[224:227], a[56:59], a[64:67], v[224:227]
    s_waitcnt vmcnt(16) lgkmcnt(0)
    v_mfma_f32_16x16x32_bf16 v[228:231], a[60:63], a[64:67], v[228:231]
    s_barrier
    ds_read_b64_tr_b16 a[64:65], v8 offset:0
    v_mfma_f32_16x16x32_bf16 v[40:43], a[32:35], a[68:71], v[40:43]
    s_add_u32 m0, s62, 0
    ds_read_b64_tr_b16 a[66:67], v8 offset:2048
    v_mfma_f32_16x16x32_bf16 v[44:47], a[36:39], a[68:71], v[44:47]
    buffer_load_dwordx4 v18, s[44:47], s52 offen offset:0 lds
    v_mfma_f32_16x16x32_bf16 v[104:107], a[40:43], a[68:71], v[104:107]
    ds_read_b128 a[0:3], v6 offset:0
    v_mfma_f32_16x16x32_bf16 v[108:111], a[44:47], a[68:71], v[108:111]
    v_mfma_f32_16x16x32_bf16 v[168:171], a[48:51], a[68:71], v[168:171]
    v_mfma_f32_16x16x32_bf16 v[172:175], a[52:55], a[68:71], v[172:175]
    buffer_load_dwordx4 v19, s[44:47], s52 offen offset:1024 lds
    v_mfma_f32_16x16x32_bf16 v[232:235], a[56:59], a[68:71], v[232:235]
    s_add_u32 s52, s52, s56
    ds_read_b128 a[4:7], v6 offset:2048
    v_mfma_f32_16x16x32_bf16 v[236:239], a[60:63], a[68:71], v[236:239]
    ds_read_b64_tr_b16 a[68:69], v9 offset:0
    v_mfma_f32_16x16x32_bf16 v[48:51], a[32:35], a[72:75], v[48:51]
    ds_read_b64_tr_b16 a[70:71], v9 offset:2048
    v_mfma_f32_16x16x32_bf16 v[52:55], a[36:39], a[72:75], v[52:55]
    buffer_load_dwordx4 v18, s[44:47], s53 offen offset:2048 lds
    v_mfma_f32_16x16x32_bf16 v[112:115], a[40:43], a[72:75], v[112:115]
    ds_read_b128 a[8:11], v6 offset:4096
    v_mfma_f32_16x16x32_bf16 v[116:119], a[44:47], a[72:75], v[116:119]
    v_mfma_f32_16x16x32_bf16 v[176:179], a[48:51], a[72:75], v[176:179]
    v_mfma_f32_16x16x32_bf16 v[180:183], a[52:55], a[72:75], v[180:183]
    buffer_load_dwordx4 v19, s[44:47], s53 offen offset:3072 lds
    v_mfma_f32_16x16x32_bf16 v[240:243], a[56:59], a[72:75], v[240:243]
    s_add_u32 s53, s53, s56
    ds_read_b128 a[12:15], v6 offset:6144
    v_mfma_f32_16x16x32_bf16 v[244:247], a[60:63], a[72:75], v[244:247]
    ds_read_b64_tr_b16 a[72:73], v10 offset:0
    v_mfma_f32_16x16x32_bf16 v[56:59], a[32:35], a[76:79], v[56:59]
    s_add_u32 m0, s62, 4096
    ds_read_b64_tr_b16 a[74:75], v10 offset:2048
    v_mfma_f32_16x16x32_bf16 v[60:63], a[36:39], a[76:79], v[60:63]
    buffer_load_dwordx4 v20, s[44:47], s54 offen offset:0 lds
    v_mfma_f32_16x16x32_bf16 v[120:123], a[40:43], a[76:79], v[120:123]
    ds_read_b128 a[16:19], v6 offset:8192
    v_mfma_f32_16x16x32_bf16 v[124:127], a[44:47], a[76:79], v[124:127]
    s_xor_b32 s62, s62, 229376
    v_mfma_f32_16x16x32_bf16 v[184:187], a[48:51], a[76:79], v[184:187]
    v_mfma_f32_16x16x32_bf16 v[188:191], a[52:55], a[76:79], v[188:191]
    buffer_load_dwordx4 v21, s[44:47], s54 offen offset:1024 lds
    v_mfma_f32_16x16x32_bf16 v[248:251], a[56:59], a[76:79], v[248:251]
    s_add_u32 s54, s54, s56
    ds_read_b128 a[20:23], v6 offset:10240
    v_mfma_f32_16x16x32_bf16 v[252:255], a[60:63], a[76:79], v[252:255]
    ds_read_b64_tr_b16 a[76:77], v11 offset:0
    v_mfma_f32_16x16x32_bf16 v[64:67], a[32:35], a[80:83], v[64:67]
    ds_read_b64_tr_b16 a[78:79], v11 offset:2048
    v_mfma_f32_16x16x32_bf16 v[68:71], a[36:39], a[80:83], v[68:71]
    buffer_load_dwordx4 v20, s[44:47], s55 offen offset:2048 lds
    v_mfma_f32_16x16x32_bf16 v[128:131], a[40:43], a[80:83], v[128:131]
    ds_read_b128 a[24:27], v6 offset:12288
    v_mfma_f32_16x16x32_bf16 v[132:135], a[44:47], a[80:83], v[132:135]
    v_mfma_f32_16x16x32_bf16 v[192:195], a[48:51], a[80:83], v[192:195]
    v_mfma_f32_16x16x32_bf16 v[196:199], a[52:55], a[80:83], v[196:199]
    buffer_load_dwordx4 v21, s[44:47], s55 offen offset:3072 lds
    v_mfma_f32_16x16x32_bf16 a[96:99], a[56:59], a[80:83], a[96:99]
    s_add_u32 s55, s55, s56
    ds_read_b128 a[28:31], v6 offset:14336
    v_mfma_f32_16x16x32_bf16 a[100:103], a[60:63], a[80:83], a[100:103]
    ds_read_b64_tr_b16 a[80:81], v12 offset:0
    v_mfma_f32_16x16x32_bf16 v[72:75], a[32:35], a[84:87], v[72:75]
    ds_read_b64_tr_b16 a[82:83], v12 offset:2048
    v_mfma_f32_16x16x32_bf16 v[76:79], a[36:39], a[84:87], v[76:79]
    v_mfma_f32_16x16x32_bf16 v[136:139], a[40:43], a[84:87], v[136:139]
    buffer_store_dwordx4 a[172:175], v2, s[24:27], s28 offen sc1
    v_mfma_f32_16x16x32_bf16 v[140:143], a[44:47], a[84:87], v[140:143]
    s_add_u32 s28, s28, s31
    v_mfma_f32_16x16x32_bf16 v[200:203], a[48:51], a[84:87], v[200:203]
    v_mfma_f32_16x16x32_bf16 v[204:207], a[52:55], a[84:87], v[204:207]
    v_mfma_f32_16x16x32_bf16 a[104:107], a[56:59], a[84:87], a[104:107]
    buffer_store_dwordx4 a[176:179], v2, s[24:27], s28 offen sc1
    v_mfma_f32_16x16x32_bf16 a[108:111], a[60:63], a[84:87], a[108:111]
    s_add_u32 s28, s28, s31
    ds_read_b64_tr_b16 a[84:85], v13 offset:0
    v_mfma_f32_16x16x32_bf16 v[80:83], a[32:35], a[88:91], v[80:83]
    ds_read_b64_tr_b16 a[86:87], v13 offset:2048
    v_mfma_f32_16x16x32_bf16 v[84:87], a[36:39], a[88:91], v[84:87]
    v_mfma_f32_16x16x32_bf16 v[144:147], a[40:43], a[88:91], v[144:147]
    buffer_store_dwordx4 a[180:183], v2, s[24:27], s28 offen sc1
    v_mfma_f32_16x16x32_bf16 v[148:151], a[44:47], a[88:91], v[148:151]
    s_add_u32 s28, s28, s31
    v_mfma_f32_16x16x32_bf16 v[208:211], a[48:51], a[88:91], v[208:211]
    v_mfma_f32_16x16x32_bf16 v[212:215], a[52:55], a[88:91], v[212:215]
    v_mfma_f32_16x16x32_bf16 a[112:115], a[56:59], a[88:91], a[112:115]
    buffer_store_dwordx4 a[184:187], v2, s[24:27], s28 offen sc1
    v_mfma_f32_16x16x32_bf16 a[116:119], a[60:63], a[88:91], a[116:119]
    s_add_u32 s28, s28, s31
    ds_read_b64_tr_b16 a[88:89], v14 offset:0
    v_mfma_f32_16x16x32_bf16 v[88:91], a[32:35], a[92:95], v[88:91]
    ds_read_b64_tr_b16 a[90:91], v14 offset:2048
    v_mfma_f32_16x16x32_bf16 v[92:95], a[36:39], a[92:95], v[92:95]
    v_mfma_f32_16x16x32_bf16 v[152:155], a[40:43], a[92:95], v[152:155]
    buffer_store_dwordx4 a[188:191], v2, s[24:27], s28 offen sc1
    v_mfma_f32_16x16x32_bf16 v[156:159], a[44:47], a[92:95], v[156:159]
    s_add_u32 s29, s29, s30
    s_mov_b32 s28, s29
    v_mfma_f32_16x16x32_bf16 v[216:219], a[48:51], a[92:95], v[216:219]
    s_sub_u32 s65, s65, 1
    v_mfma_f32_16x16x32_bf16 v[220:223], a[52:55], a[92:95], v[220:223]
    v_mfma_f32_16x16x32_bf16 a[120:123], a[56:59], a[92:95], a[120:123]
    v_mfma_f32_16x16x32_bf16 a[124:127], a[60:63], a[92:95], a[124:127]
    ds_read_b64_tr_b16 a[92:93], v15 offset:0
    ds_read_b64_tr_b16 a[94:95], v15 offset:2048
    s_cmp_eq_u32 s66, 2
    s_cbranch_scc1 m_hook17
m_hookr18:
    s_waitcnt lgkmcnt(15)
    v_mfma_f32_16x16x32_bf16 v[32:35], a[0:3], a[64:67], v[32:35]
    v_mfma_f32_16x16x32_bf16 v[36:39], a[4:7], a[64:67], v[36:39]
    v_mfma_f32_16x16x32_bf16 v[96:99], a[8:11], a[64:67], v[96:99]
    v_mfma_f32_16x16x32_bf16 v[100:103], a[12:15], a[64:67], v[100:103]
    s_add_u32 m0, s61, 0
    s_waitcnt lgkmcnt(13)
    v_mfma_f32_16x16x32_bf16 v[160:163], a[16:19], a[64:67], v[160:163]
    buffer_load_dwordx4 v16, s[40:43], s48 offen offset:0 lds
    s_waitcnt lgkmcnt(12)
    v_mfma_f32_16x16x32_bf16 v[164:167], a[20:23], a[64:67], v[164:167]
    s_waitcnt lgkmcnt(9)
    v_mfma_f32_16x16x32_bf16 v[224:227], a[24:27], a[64:67], v[224:227]
    s_waitcnt lgkmcnt(8)
    v_mfma_f32_16x16x32_bf16 v[228:231], a[28:31], a[64:67], v[228:231]
    ds_read_b64_tr_b16 a[64:65], v8 offset:16384
    v_mfma_f32_16x16x32_bf16 v[40:43], a[0:3], a[68:71], v[40:43]
    ds_read_b64_tr_b16 a[66:67], v8 offset:18432
    v_mfma_f32_16x16x32_bf16 v[44:47], a[4:7], a[68:71], v[44:47]
    v_mfma_f32_16x16x32_bf16 v[104:107], a[8:11], a[68:71], v[104:107]
    ds_read_b128 a[32:35], v7 offset:0
    v_mfma_f32_16x16x32_bf16 v[108:111], a[12:15], a[68:71], v[108:111]
    v_mfma_f32_16x16x32_bf16 v[168:171], a[16:19], a[68:71], v[168:171]
    buffer_load_dwordx4 v17, s[40:43], s48 offen offset:1024 lds
    v_mfma_f32_16x16x32_bf16 v[172:175], a[20:23], a[68:71], v[172:175]
    s_add_u32 s48, s48, 128
    v_mfma_f32_16x16x32_bf16 v[232:235], a[24:27], a[68:71], v[232:235]
    ds_read_b128 a[36:39], v7 offset:2048
    v_mfma_f32_16x16x32_bf16 v[236:239], a[28:31], a[68:71], v[236:239]
    ds_read_b64_tr_b16 a[68:69], v9 offset:16384
    v_mfma_f32_16x16x32_bf16 v[48:51], a[0:3], a[72:75], v[48:51]
    ds_read_b64_tr_b16 a[70:71], v9 offset:18432
    v_mfma_f32_16x16x32_bf16 v[52:55], a[4:7], a[72:75], v[52:55]
    v_mfma_f32_16x16x32_bf16 v[112:115], a[8:11], a[72:75], v[112:115]
    ds_read_b128 a[40:43], v7 offset:4096
    v_mfma_f32_16x16x32_bf16 v[116:119], a[12:15], a[72:75], v[116:119]
    v_mfma_f32_16x16x32_bf16 v[176:179], a[16:19], a[72:75], v[176:179]
    buffer_load_dwordx4 v16, s[40:43], s49 offen offset:2048 lds
    v_mfma_f32_16x16x32_bf16 v[180:183], a[20:23], a[72:75], v[180:183]
    v_mfma_f32_16x16x32_bf16 v[240:243], a[24:27], a[72:75], v[240:243]
    ds_read_b128 a[44:47], v7 offset:6144
    v_mfma_f32_16x16x32_bf16 v[244:247], a[28:31], a[72:75], v[244:247]
    ds_read_b64_tr_b16 a[72:73], v10 offset:16384
    v_mfma_f32_16x16x32_bf16 v[56:59], a[0:3], a[76:79], v[56:59]
    ds_read_b64_tr_b16 a[74:75], v10 offset:18432
    v_mfma_f32_16x16x32_bf16 v[60:63], a[4:7], a[76:79], v[60:63]
    v_mfma_f32_16x16x32_bf16 v[120:123], a[8:11], a[76:79], v[120:123]
    ds_read_b128 a[48:51], v7 offset:8192
    v_mfma_f32_16x16x32_bf16 v[124:127], a[12:15], a[76:79], v[124:127]
    v_mfma_f32_16x16x32_bf16 v[184:187], a[16:19], a[76:79], v[184:187]
    buffer_load_dwordx4 v17, s[40:43], s49 offen offset:3072 lds
    v_mfma_f32_16x16x32_bf16 v[188:191], a[20:23], a[76:79], v[188:191]
    s_add_u32 s49, s49, 128
    v_mfma_f32_16x16x32_bf16 v[248:251], a[24:27], a[76:79], v[248:251]
    ds_read_b128 a[52:55], v7 offset:10240
    v_mfma_f32_16x16x32_bf16 v[252:255], a[28:31], a[76:79], v[252:255]
    ds_read_b64_tr_b16 a[76:77], v11 offset:16384
    s_waitcnt lgkmcnt(15)
    v_mfma_f32_16x16x32_bf16 v[64:67], a[0:3], a[80:83], v[64:67]
    ds_read_b64_tr_b16 a[78:79], v11 offset:18432
    v_mfma_f32_16x16x32_bf16 v[68:71], a[4:7], a[80:83], v[68:71]
    v_mfma_f32_16x16x32_bf16 v[128:131], a[8:11], a[80:83], v[128:131]
    ds_read_b128 a[56:59], v7 offset:12288
    v_mfma_f32_16x16x32_bf16 v[132:135], a[12:15], a[80:83], v[132:135]
    s_add_u32 m0, s61, 4096
    v_mfma_f32_16x16x32_bf16 v[192:195], a[16:19], a[80:83], v[192:195]
    buffer_load_dwordx4 v16, s[40:43], s50 offen offset:0 lds
    v_mfma_f32_16x16x32_bf16 v[196:199], a[20:23], a[80:83], v[196:199]
    v_mfma_f32_16x16x32_bf16 a[96:99], a[24:27], a[80:83], a[96:99]
    s_add_u32 s61, s61, 32768
    ds_read_b128 a[60:63], v7 offset:14336
    v_mfma_f32_16x16x32_bf16 a[100:103], a[28:31], a[80:83], a[100:103]
    s_cmp_ge_u32 s61, 98304
    s_cselect_b32 s90, 98304, 0
    ds_read_b64_tr_b16 a[80:81], v12 offset:16384
    v_mfma_f32_16x16x32_bf16 v[72:75], a[0:3], a[84:87], v[72:75]
    s_sub_u32 s61, s61, s90
    ds_read_b64_tr_b16 a[82:83], v12 offset:18432
    v_mfma_f32_16x16x32_bf16 v[76:79], a[4:7], a[84:87], v[76:79]
    s_add_u32 s64, s64, 32768
    v_mfma_f32_16x16x32_bf16 v[136:139], a[8:11], a[84:87], v[136:139]
    buffer_store_dwordx4 a[192:195], v2, s[24:27], s28 offen sc1
    v_mfma_f32_16x16x32_bf16 v[140:143], a[12:15], a[84:87], v[140:143]
    s_add_u32 s28, s28, s31
    v_mfma_f32_16x16x32_bf16 v[200:203], a[16:19], a[84:87], v[200:203]
    buffer_load_dwordx4 v17, s[40:43], s50 offen offset:1024 lds
    v_mfma_f32_16x16x32_bf16 v[204:207], a[20:23], a[84:87], v[204:207]
    s_add_u32 s50, s50, 128
    v_mfma_f32_16x16x32_bf16 a[104:107], a[24:27], a[84:87], a[104:107]
    s_cmp_ge_u32 s64, 98304
    s_cselect_b32 s63, 4294901760, s59
    s_cselect_b32 s64, 0, s64
    v_mfma_f32_16x16x32_bf16 a[108:111], a[28:31], a[84:87], a[108:111]
    ds_read_b64_tr_b16 a[84:85], v13 offset:16384
    v_mfma_f32_16x16x32_bf16 v[80:83], a[0:3], a[88:91], v[80:83]
    ds_read_b64_tr_b16 a[86:87], v13 offset:18432
    v_mfma_f32_16x16x32_bf16 v[84:87], a[4:7], a[88:91], v[84:87]
    v_mfma_f32_16x16x32_bf16 v[144:147], a[8:11], a[88:91], v[144:147]
    buffer_store_dwordx4 a[196:199], v2, s[24:27], s28 offen sc1
    v_mfma_f32_16x16x32_bf16 v[148:151], a[12:15], a[88:91], v[148:151]
    s_add_u32 s28, s28, s31
    v_mfma_f32_16x16x32_bf16 v[208:211], a[16:19], a[88:91], v[208:211]
    buffer_load_dwordx4 v16, s[40:43], s51 offen offset:2048 lds
    v_mfma_f32_16x16x32_bf16 v[212:215], a[20:23], a[88:91], v[212:215]
    v_mfma_f32_16x16x32_bf16 a[112:115], a[24:27], a[88:91], a[112:115]
    v_mfma_f32_16x16x32_bf16 a[116:119], a[28:31], a[88:91], a[116:119]
    ds_read_b64_tr_b16 a[88:89], v14 offset:16384
    s_waitcnt lgkmcnt(15)
    v_mfma_f32_16x16x32_bf16 v[88:91], a[0:3], a[92:95], v[88:91]
    ds_read_b64_tr_b16 a[90:91], v14 offset:18432
    v_mfma_f32_16x16x32_bf16 v[92:95], a[4:7], a[92:95], v[92:95]
    v_add_u32 v6, s63, v6
    v_add_u32 v7, s63, v7
    v_mfma_f32_16x16x32_bf16 v[152:155], a[8:11], a[92:95], v[152:155]
    buffer_store_dwordx4 a[200:203], v2, s[24:27], s28 offen sc1
    v_mfma_f32_16x16x32_bf16 v[156:159], a[12:15], a[92:95], v[156:159]
    s_add_u32 s28, s28, s31
    v_mfma_f32_16x16x32_bf16 v[216:219], a[16:19], a[92:95], v[216:219]
    buffer_load_dwordx4 v17, s[40:43], s51 offen offset:3072 lds
    v_mfma_f32_16x16x32_bf16 v[220:223], a[20:23], a[92:95], v[220:223]
    s_add_u32 s51, s51, 128
    v_mfma_f32_16x16x32_bf16 a[120:123], a[24:27], a[92:95], a[120:123]
    v_mfma_f32_16x16x32_bf16 a[124:127], a[28:31], a[92:95], a[124:127]
    ds_read_b64_tr_b16 a[92:93], v15 offset:16384
    ds_read_b64_tr_b16 a[94:95], v15 offset:18432
    v_mfma_f32_16x16x32_bf16 v[32:35], a[32:35], a[64:67], v[32:35]
    v_xor_b32 v8, s60, v8
    v_xor_b32 v9, s60, v9
    v_mfma_f32_16x16x32_bf16 v[36:39], a[36:39], a[64:67], v[36:39]
    v_xor_b32 v10, s60, v10
    v_xor_b32 v11, s60, v11
    s_waitcnt lgkmcnt(15)
    v_mfma_f32_16x16x32_bf16 v[96:99], a[40:43], a[64:67], v[96:99]
    v_xor_b32 v12, s60, v12
    v_xor_b32 v13, s60, v13
    v_mfma_f32_16x16x32_bf16 v[100:103], a[44:47], a[64:67], v[100:103]
    v_xor_b32 v14, s60, v14
    v_xor_b32 v15, s60, v15
    s_waitcnt lgkmcnt(13)
    v_mfma_f32_16x16x32_bf16 v[160:163], a[48:51], a[64:67], v[160:163]
    s_waitcnt lgkmcnt(12)
    v_mfma_f32_16x16x32_bf16 v[164:167], a[52:55], a[64:67], v[164:167]
    s_waitcnt lgkmcnt(9)
    v_mfma_f32_16x16x32_bf16 v[224:227], a[56:59], a[64:67], v[224:227]
    s_waitcnt vmcnt(16) lgkmcnt(0)
    v_mfma_f32_16x16x32_bf16 v[228:231], a[60:63], a[64:67], v[228:231]
    s_barrier
    ds_read_b64_tr_b16 a[64:65], v8 offset:0
    v_mfma_f32_16x16x32_bf16 v[40:43], a[32:35], a[68:71], v[40:43]
    s_add_u32 m0, s62, 0
    ds_read_b64_tr_b16 a[66:67], v8 offset:2048
    v_mfma_f32_16x16x32_bf16 v[44:47], a[36:39], a[68:71], v[44:47]
    buffer_load_dwordx4 v18, s[44:47], s52 offen offset:0 lds
    v_mfma_f32_16x16x32_bf16 v[104:107], a[40:43], a[68:71], v[104:107]
    ds_read_b128 a[0:3], v6 offset:0
    v_mfma_f32_16x16x32_bf16 v[108:111], a[44:47], a[68:71], v[108:111]
    v_mfma_f32_16x16x32_bf16 v[168:171], a[48:51], a[68:71], v[168:171]
    v_mfma_f32_16x16x32_bf16 v[172:175], a[52:55], a[68:71], v[172:175]
    buffer_load_dwordx4 v19, s[44:47], s52 offen offset:1024 lds
    v_mfma_f32_16x16x32_bf16 v[232:235], a[56:59], a[68:71], v[232:235]
    s_add_u32 s52, s52, s56
    ds_read_b128 a[4:7], v6 offset:2048
    v_mfma_f32_16x16x32_bf16 v[236:239], a[60:63], a[68:71], v[236:239]
    ds_read_b64_tr_b16 a[68:69], v9 offset:0
    v_mfma_f32_16x16x32_bf16 v[48:51], a[32:35], a[72:75], v[48:51]
    ds_read_b64_tr_b16 a[70:71], v9 offset:2048
    v_mfma_f32_16x16x32_bf16 v[52:55], a[36:39], a[72:75], v[52:55]
    buffer_load_dwordx4 v18, s[44:47], s53 offen offset:2048 lds
    v_mfma_f32_16x16x32_bf16 v[112:115], a[40:43], a[72:75], v[112:115]
    ds_read_b128 a[8:11], v6 offset:4096
    v_mfma_f32_16x16x32_bf16 v[116:119], a[44:47], a[72:75], v[116:119]
    v_mfma_f32_16x16x32_bf16 v[176:179], a[48:51], a[72:75], v[176:179]
    v_mfma_f32_16x16x32_bf16 v[180:183], a[52:55], a[72:75], v[180:183]
    buffer_load_dwordx4 v19, s[44:47], s53 offen offset:3072 lds
    v_mfma_f32_16x16x32_bf16 v[240:243], a[56:59], a[72:75], v[240:243]
    s_add_u32 s53, s53, s56
    ds_read_b128 a[12:15], v6 offset:6144
    v_mfma_f32_16x16x32_bf16 v[244:247], a[60:63], a[72:75], v[244:247]
    ds_read_b64_tr_b16 a[72:73], v10 offset:0
    v_mfma_f32_16x16x32_bf16 v[56:59], a[32:35], a[76:79], v[56:59]
    s_add_u32 m0, s62, 4096
    ds_read_b64_tr_b16 a[74:75], v10 offset:2048
    v_mfma_f32_16x16x32_bf16 v[60:63], a[36:39], a[76:79], v[60:63]
    buffer_load_dwordx4 v20, s[44:47], s54 offen offset:0 lds
    v_mfma_f32_16x16x32_bf16 v[120:123], a[40:43], a[76:79], v[120:123]
    ds_read_b128 a[16:19], v6 offset:8192
    v_mfma_f32_16x16x32_bf16 v[124:127], a[44:47], a[76:79], v[124:127]
    s_xor_b32 s62, s62, 229376
    v_mfma_f32_16x16x32_bf16 v[184:187], a[48:51], a[76:79], v[184:187]
    v_mfma_f32_16x16x32_bf16 v[188:191], a[52:55], a[76:79], v[188:191]
    buffer_load_dwordx4 v21, s[44:47], s54 offen offset:1024 lds
    v_mfma_f32_16x16x32_bf16 v[248:251], a[56:59], a[76:79], v[248:251]
    s_add_u32 s54, s54, s56
    ds_read_b128 a[20:23], v6 offset:10240
    v_mfma_f32_16x16x32_bf16 v[252:255], a[60:63], a[76:79], v[252:255]
    ds_read_b64_tr_b16 a[76:77], v11 offset:0
    v_mfma_f32_16x16x32_bf16 v[64:67], a[32:35], a[80:83], v[64:67]
    ds_read_b64_tr_b16 a[78:79], v11 offset:2048
    v_mfma_f32_16x16x32_bf16 v[68:71], a[36:39], a[80:83], v[68:71]
    buffer_load_dwordx4 v20, s[44:47], s55 offen offset:2048 lds
    v_mfma_f32_16x16x32_bf16 v[128:131], a[40:43], a[80:83], v[128:131]
    ds_read_b128 a[24:27], v6 offset:12288
    v_mfma_f32_16x16x32_bf16 v[132:135], a[44:47], a[80:83], v[132:135]
    v_mfma_f32_16x16x32_bf16 v[192:195], a[48:51], a[80:83], v[192:195]
    v_mfma_f32_16x16x32_bf16 v[196:199], a[52:55], a[80:83], v[196:199]
    buffer_load_dwordx4 v21, s[44:47], s55 offen offset:3072 lds
    v_mfma_f32_16x16x32_bf16 a[96:99], a[56:59], a[80:83], a[96:99]
    s_add_u32 s55, s55, s56
    ds_read_b128 a[28:31], v6 offset:14336
    v_mfma_f32_16x16x32_bf16 a[100:103], a[60:63], a[80:83], a[100:103]
    ds_read_b64_tr_b16 a[80:81], v12 offset:0
    v_mfma_f32_16x16x32_bf16 v[72:75], a[32:35], a[84:87], v[72:75]
    ds_read_b64_tr_b16 a[82:83], v12 offset:2048
    v_mfma_f32_16x16x32_bf16 v[76:79], a[36:39], a[84:87], v[76:79]
    v_mfma_f32_16x16x32_bf16 v[136:139], a[40:43], a[84:87], v[136:139]
    buffer_store_dwordx4 a[204:207], v2, s[24:27], s28 offen sc1
    v_mfma_f32_16x16x32_bf16 v[140:143], a[44:47], a[84:87], v[140:143]
    s_add_u32 s28, s28, s31
    v_mfma_f32_16x16x32_bf16 v[200:203], a[48:51], a[84:87], v[200:203]
    v_mfma_f32_16x16x32_bf16 v[204:207], a[52:55], a[84:87], v[204:207]
    v_mfma_f32_16x16x32_bf16 a[104:107], a[56:59], a[84:87], a[104:107]
    buffer_store_dwordx4 a[208:211], v2, s[24:27], s28 offen sc1
    v_mfma_f32_16x16x32_bf16 a[108:111], a[60:63], a[84:87], a[108:111]
    s_add_u32 s28, s28, s31
    ds_read_b64_tr_b16 a[84:85], v13 offset:0
    v_mfma_f32_16x16x32_bf16 v[80:83], a[32:35], a[88:91], v[80:83]
    ds_read_b64_tr_b16 a[86:87], v13 offset:2048
    v_mfma_f32_16x16x32_bf16 v[84:87], a[36:39], a[88:91], v[84:87]
    v_mfma_f32_16x16x32_bf16 v[144:147], a[40:43], a[88:91], v[144:147]
    buffer_store_dwordx4 a[212:215], v2, s[24:27], s28 offen sc1
    v_mfma_f32_16x16x32_bf16 v[148:151], a[44:47], a[88:91], v[148:151]
    s_add_u32 s28, s28, s31
    v_mfma_f32_16x16x32_bf16 v[208:211], a[48:51], a[88:91], v[208:211]
    v_mfma_f32_16x16x32_bf16 v[212:215], a[52:55], a[88:91], v[212:215]
    v_mfma_f32_16x16x32_bf16 a[112:115], a[56:59], a[88:91], a[112:115]
    buffer_store_dwordx4 a[216:219], v2, s[24:27], s28 offen sc1
    v_mfma_f32_16x16x32_bf16 a[116:119], a[60:63], a[88:91], a[116:119]
    s_add_u32 s28, s28, s31
    ds_read_b64_tr_b16 a[88:89], v14 offset:0
    v_mfma_f32_16x16x32_bf16 v[88:91], a[32:35], a[92:95], v[88:91]
    ds_read_b64_tr_b16 a[90:91], v14 offset:2048
    v_mfma_f32_16x16x32_bf16 v[92:95], a[36:39], a[92:95], v[92:95]
    v_mfma_f32_16x16x32_bf16 v[152:155], a[40:43], a[92:95], v[152:155]
    buffer_store_dwordx4 a[220:223], v2, s[24:27], s28 offen sc1
    v_mfma_f32_16x16x32_bf16 v[156:159], a[44:47], a[92:95], v[156:159]
    s_add_u32 s29, s29, s30
    s_mov_b32 s28, s29
    v_mfma_f32_16x16x32_bf16 v[216:219], a[48:51], a[92:95], v[216:219]
    s_sub_u32 s65, s65, 1
    v_mfma_f32_16x16x32_bf16 v[220:223], a[52:55], a[92:95], v[220:223]
    v_mfma_f32_16x16x32_bf16 a[120:123], a[56:59], a[92:95], a[120:123]
    v_mfma_f32_16x16x32_bf16 a[124:127], a[60:63], a[92:95], a[124:127]
    ds_read_b64_tr_b16 a[92:93], v15 offset:0
    ds_read_b64_tr_b16 a[94:95], v15 offset:2048
    s_waitcnt lgkmcnt(15)
    v_mfma_f32_16x16x32_bf16 v[32:35], a[0:3], a[64:67], v[32:35]
    v_mfma_f32_16x16x32_bf16 v[36:39], a[4:7], a[64:67], v[36:39]
    v_mfma_f32_16x16x32_bf16 v[96:99], a[8:11], a[64:67], v[96:99]
    v_mfma_f32_16x16x32_bf16 v[100:103], a[12:15], a[64:67], v[100:103]
    s_add_u32 m0, s61, 0
    s_waitcnt lgkmcnt(13)
    v_mfma_f32_16x16x32_bf16 v[160:163], a[16:19], a[64:67], v[160:163]
    buffer_load_dwordx4 v16, s[40:43], s48 offen offset:0 lds
    s_waitcnt lgkmcnt(12)
    v_mfma_f32_16x16x32_bf16 v[164:167], a[20:23], a[64:67], v[164:167]
    s_waitcnt lgkmcnt(9)
    v_mfma_f32_16x16x32_bf16 v[224:227], a[24:27], a[64:67], v[224:227]
    s_waitcnt lgkmcnt(8)
    v_mfma_f32_16x16x32_bf16 v[228:231], a[28:31], a[64:67], v[228:231]
    ds_read_b64_tr_b16 a[64:65], v8 offset:16384
    v_mfma_f32_16x16x32_bf16 v[40:43], a[0:3], a[68:71], v[40:43]
    ds_read_b64_tr_b16 a[66:67], v8 offset:18432
    v_mfma_f32_16x16x32_bf16 v[44:47], a[4:7], a[68:71], v[44:47]
    v_mfma_f32_16x16x32_bf16 v[104:107], a[8:11], a[68:71], v[104:107]
    ds_read_b128 a[32:35], v7 offset:0
    v_mfma_f32_16x16x32_bf16 v[108:111], a[12:15], a[68:71], v[108:111]
    v_mfma_f32_16x16x32_bf16 v[168:171], a[16:19], a[68:71], v[168:171]
    buffer_load_dwordx4 v17, s[40:43], s48 offen offset:1024 lds
    v_mfma_f32_16x16x32_bf16 v[172:175], a[20:23], a[68:71], v[172:175]
    s_add_u32 s48, s48, 128
    v_mfma_f32_16x16x32_bf16 v[232:235], a[24:27], a[68:71], v[232:235]
    ds_read_b128 a[36:39], v7 offset:2048
    v_mfma_f32_16x16x32_bf16 v[236:239], a[28:31], a[68:71], v[236:239]
    ds_read_b64_tr_b16 a[68:69], v9 offset:16384
    v_mfma_f32_16x16x32_bf16 v[48:51], a[0:3], a[72:75], v[48:51]
    ds_read_b64_tr_b16 a[70:71], v9 offset:18432
    v_mfma_f32_16x16x32_bf16 v[52:55], a[4:7], a[72:75], v[52:55]
    v_mfma_f32_16x16x32_bf16 v[112:115], a[8:11], a[72:75], v[112:115]
    ds_read_b128 a[40:43], v7 offset:4096
    v_mfma_f32_16x16x32_bf16 v[116:119], a[12:15], a[72:75], v[116:119]
    v_mfma_f32_16x16x32_bf16 v[176:179], a[16:19], a[72:75], v[176:179]
    buffer_load_dwordx4 v16, s[40:43], s49 offen offset:2048 lds
    v_mfma_f32_16x16x32_bf16 v[180:183], a[20:23], a[72:75], v[180:183]
    v_mfma_f32_16x16x32_bf16 v[240:243], a[24:27], a[72:75], v[240:243]
    ds_read_b128 a[44:47], v7 offset:6144
    v_mfma_f32_16x16x32_bf16 v[244:247], a[28:31], a[72:75], v[244:247]
    ds_read_b64_tr_b16 a[72:73], v10 offset:16384
    v_mfma_f32_16x16x32_bf16 v[56:59], a[0:3], a[76:79], v[56:59]
    ds_read_b64_tr_b16 a[74:75], v10 offset:18432
    v_mfma_f32_16x16x32_bf16 v[60:63], a[4:7], a[76:79], v[60:63]
    v_mfma_f32_16x16x32_bf16 v[120:123], a[8:11], a[76:79], v[120:123]
    ds_read_b128 a[48:51], v7 offset:8192
    v_mfma_f32_16x16x32_bf16 v[124:127], a[12:15], a[76:79], v[124:127]
    v_mfma_f32_16x16x32_bf16 v[184:187], a[16:19], a[76:79], v[184:187]
    buffer_load_dwordx4 v17, s[40:43], s49 offen offset:3072 lds
    v_mfma_f32_16x16x32_bf16 v[188:191], a[20:23], a[76:79], v[188:191]
    s_add_u32 s49, s49, 128
    v_mfma_f32_16x16x32_bf16 v[248:251], a[24:27], a[76:79], v[248:251]
    ds_read_b128 a[52:55], v7 offset:10240
    v_mfma_f32_16x16x32_bf16 v[252:255], a[28:31], a[76:79], v[252:255]
    ds_read_b64_tr_b16 a[76:77], v11 offset:16384
    s_waitcnt lgkmcnt(15)
    v_mfma_f32_16x16x32_bf16 v[64:67], a[0:3], a[80:83], v[64:67]
    ds_read_b64_tr_b16 a[78:79], v11 offset:18432
    v_mfma_f32_16x16x32_bf16 v[68:71], a[4:7], a[80:83], v[68:71]
    v_mfma_f32_16x16x32_bf16 v[128:131], a[8:11], a[80:83], v[128:131]
    ds_read_b128 a[56:59], v7 offset:12288
    v_mfma_f32_16x16x32_bf16 v[132:135], a[12:15], a[80:83], v[132:135]
    s_add_u32 m0, s61, 4096
    v_mfma_f32_16x16x32_bf16 v[192:195], a[16:19], a[80:83], v[192:195]
    buffer_load_dwordx4 v16, s[40:43], s50 offen offset:0 lds
    v_mfma_f32_16x16x32_bf16 v[196:199], a[20:23], a[80:83], v[196:199]
    v_mfma_f32_16x16x32_bf16 a[96:99], a[24:27], a[80:83], a[96:99]
    s_add_u32 s61, s61, 32768
    ds_read_b128 a[60:63], v7 offset:14336
    v_mfma_f32_16x16x32_bf16 a[100:103], a[28:31], a[80:83], a[100:103]
    s_cmp_ge_u32 s61, 98304
    s_cselect_b32 s90, 98304, 0
    ds_read_b64_tr_b16 a[80:81], v12 offset:16384
    v_mfma_f32_16x16x32_bf16 v[72:75], a[0:3], a[84:87], v[72:75]
    s_sub_u32 s61, s61, s90
    ds_read_b64_tr_b16 a[82:83], v12 offset:18432
    v_mfma_f32_16x16x32_bf16 v[76:79], a[4:7], a[84:87], v[76:79]
    s_add_u32 s64, s64, 32768
    v_mfma_f32_16x16x32_bf16 v[136:139], a[8:11], a[84:87], v[136:139]
    buffer_store_dwordx4 a[224:227], v2, s[24:27], s28 offen sc1
    v_mfma_f32_16x16x32_bf16 v[140:143], a[12:15], a[84:87], v[140:143]
    s_add_u32 s28, s28, s31
    v_mfma_f32_16x16x32_bf16 v[200:203], a[16:19], a[84:87], v[200:203]
    buffer_load_dwordx4 v17, s[40:43], s50 offen offset:1024 lds
    v_mfma_f32_16x16x32_bf16 v[204:207], a[20:23], a[84:87], v[204:207]
    s_add_u32 s50, s50, 128
    v_mfma_f32_16x16x32_bf16 a[104:107], a[24:27], a[84:87], a[104:107]
    s_cmp_ge_u32 s64, 98304
    s_cselect_b32 s63, 4294901760, s59
    s_cselect_b32 s64, 0, s64
    v_mfma_f32_16x16x32_bf16 a[108:111], a[28:31], a[84:87], a[108:111]
    ds_read_b64_tr_b16 a[84:85], v13 offset:16384
    v_mfma_f32_16x16x32_bf16 v[80:83], a[0:3], a[88:91], v[80:83]
    ds_read_b64_tr_b16 a[86:87], v13 offset:18432
    v_mfma_f32_16x16x32_bf16 v[84:87], a[4:7], a[88:91], v[84:87]
    v_mfma_f32_16x16x32_bf16 v[144:147], a[8:11], a[88:91], v[144:147]
    buffer_store_dwordx4 a[228:231], v2, s[24:27], s28 offen sc1
    v_mfma_f32_16x16x32_bf16 v[148:151], a[12:15], a[88:91], v[148:151]
    s_add_u32 s28, s28, s31
    v_mfma_f32_16x16x32_bf16 v[208:211], a[16:19], a[88:91], v[208:211]
    buffer_load_dwordx4 v16, s[40:43], s51 offen offset:2048 lds
    v_mfma_f32_16x16x32_bf16 v[212:215], a[20:23], a[88:91], v[212:215]
    v_mfma_f32_16x16x32_bf16 a[112:115], a[24:27], a[88:91], a[112:115]
    v_mfma_f32_16x16x32_bf16 a[116:119], a[28:31], a[88:91], a[116:119]
    ds_read_b64_tr_b16 a[88:89], v14 offset:16384
    s_waitcnt lgkmcnt(15)
    v_mfma_f32_16x16x32_bf16 v[88:91], a[0:3], a[92:95], v[88:91]
    ds_read_b64_tr_b16 a[90:91], v14 offset:18432
    v_mfma_f32_16x16x32_bf16 v[92:95], a[4:7], a[92:95], v[92:95]
    v_add_u32 v6, s63, v6
    v_add_u32 v7, s63, v7
    v_mfma_f32_16x16x32_bf16 v[152:155], a[8:11], a[92:95], v[152:155]
    buffer_store_dwordx4 a[232:235], v2, s[24:27], s28 offen sc1
    v_mfma_f32_16x16x32_bf16 v[156:159], a[12:15], a[92:95], v[156:159]
    s_add_u32 s28, s28, s31
    v_mfma_f32_16x16x32_bf16 v[216:219], a[16:19], a[92:95], v[216:219]
    buffer_load_dwordx4 v17, s[40:43], s51 offen offset:3072 lds
    v_mfma_f32_16x16x32_bf16 v[220:223], a[20:23], a[92:95], v[220:223]
    s_add_u32 s51, s51, 128
    v_mfma_f32_16x16x32_bf16 a[120:123], a[24:27], a[92:95], a[120:123]
    v_mfma_f32_16x16x32_bf16 a[124:127], a[28:31], a[92:95], a[124:127]
    ds_read_b64_tr_b16 a[92:93], v15 offset:16384
    ds_read_b64_tr_b16 a[94:95], v15 offset:18432
    v_mfma_f32_16x16x32_bf16 v[32:35], a[32:35], a[64:67], v[32:35]
    v_xor_b32 v8, s60, v8
    v_xor_b32 v9, s60, v9
    v_mfma_f32_16x16x32_bf16 v[36:39], a[36:39], a[64:67], v[36:39]
    v_xor_b32 v10, s60, v10
    v_xor_b32 v11, s60, v11
    s_waitcnt lgkmcnt(15)
    v_mfma_f32_16x16x32_bf16 v[96:99], a[40:43], a[64:67], v[96:99]
    v_xor_b32 v12, s60, v12
    v_xor_b32 v13, s60, v13
    v_mfma_f32_16x16x32_bf16 v[100:103], a[44:47], a[64:67], v[100:103]
    v_xor_b32 v14, s60, v14
    v_xor_b32 v15, s60, v15
    s_waitcnt lgkmcnt(13)
    v_mfma_f32_16x16x32_bf16 v[160:163], a[48:51], a[64:67], v[160:163]
    s_waitcnt lgkmcnt(12)
    v_mfma_f32_16x16x32_bf16 v[164:167], a[52:55], a[64:67], v[164:167]
    s_waitcnt lgkmcnt(9)
    v_mfma_f32_16x16x32_bf16 v[224:227], a[56:59], a[64:67], v[224:227]
    s_waitcnt vmcnt(16) lgkmcnt(0)
    v_mfma_f32_16x16x32_bf16 v[228:231], a[60:63], a[64:67], v[228:231]
    s_barrier
    ds_read_b64_tr_b16 a[64:65], v8 offset:0
    v_mfma_f32_16x16x32_bf16 v[40:43], a[32:35], a[68:71], v[40:43]
    s_add_u32 m0, s62, 0
    ds_read_b64_tr_b16 a[66:67], v8 offset:2048
    v_mfma_f32_16x16x32_bf16 v[44:47], a[36:39], a[68:71], v[44:47]
    buffer_load_dwordx4 v18, s[44:47], s52 offen offset:0 lds
    v_mfma_f32_16x16x32_bf16 v[104:107], a[40:43], a[68:71], v[104:107]
    ds_read_b128 a[0:3], v6 offset:0
    v_mfma_f32_16x16x32_bf16 v[108:111], a[44:47], a[68:71], v[108:111]
    v_mfma_f32_16x16x32_bf16 v[168:171], a[48:51], a[68:71], v[168:171]
    v_mfma_f32_16x16x32_bf16 v[172:175], a[52:55], a[68:71], v[172:175]
    buffer_load_dwordx4 v19, s[44:47], s52 offen offset:1024 lds
    v_mfma_f32_16x16x32_bf16 v[232:235], a[56:59], a[68:71], v[232:235]
    s_add_u32 s52, s52, s56
    ds_read_b128 a[4:7], v6 offset:2048
    v_mfma_f32_16x16x32_bf16 v[236:239], a[60:63], a[68:71], v[236:239]
    ds_read_b64_tr_b16 a[68:69], v9 offset:0
    v_mfma_f32_16x16x32_bf16 v[48:51], a[32:35], a[72:75], v[48:51]
    ds_read_b64_tr_b16 a[70:71], v9 offset:2048
    v_mfma_f32_16x16x32_bf16 v[52:55], a[36:39], a[72:75], v[52:55]
    buffer_load_dwordx4 v18, s[44:47], s53 offen offset:2048 lds
    v_mfma_f32_16x16x32_bf16 v[112:115], a[40:43], a[72:75], v[112:115]
    ds_read_b128 a[8:11], v6 offset:4096
    v_mfma_f32_16x16x32_bf16 v[116:119], a[44:47], a[72:75], v[116:119]
    v_mfma_f32_16x16x32_bf16 v[176:179], a[48:51], a[72:75], v[176:179]
    v_mfma_f32_16x16x32_bf16 v[180:183], a[52:55], a[72:75], v[180:183]
    buffer_load_dwordx4 v19, s[44:47], s53 offen offset:3072 lds
    v_mfma_f32_16x16x32_bf16 v[240:243], a[56:59], a[72:75], v[240:243]
    s_add_u32 s53, s53, s56
    ds_read_b128 a[12:15], v6 offset:6144
    v_mfma_f32_16x16x32_bf16 v[244:247], a[60:63], a[72:75], v[244:247]
    ds_read_b64_tr_b16 a[72:73], v10 offset:0
    v_mfma_f32_16x16x32_bf16 v[56:59], a[32:35], a[76:79], v[56:59]
    s_add_u32 m0, s62, 4096
    ds_read_b64_tr_b16 a[74:75], v10 offset:2048
    v_mfma_f32_16x16x32_bf16 v[60:63], a[36:39], a[76:79], v[60:63]
    buffer_load_dwordx4 v20, s[44:47], s54 offen offset:0 lds
    v_mfma_f32_16x16x32_bf16 v[120:123], a[40:43], a[76:79], v[120:123]
    ds_read_b128 a[16:19], v6 offset:8192
    v_mfma_f32_16x16x32_bf16 v[124:127], a[44:47], a[76:79], v[124:127]
    s_xor_b32 s62, s62, 229376
    v_mfma_f32_16x16x32_bf16 v[184:187], a[48:51], a[76:79], v[184:187]
    v_mfma_f32_16x16x32_bf16 v[188:191], a[52:55], a[76:79], v[188:191]
    buffer_load_dwordx4 v21, s[44:47], s54 offen offset:1024 lds
    v_mfma_f32_16x16x32_bf16 v[248:251], a[56:59], a[76:79], v[248:251]
    s_add_u32 s54, s54, s56
    ds_read_b128 a[20:23], v6 offset:10240
    v_mfma_f32_16x16x32_bf16 v[252:255], a[60:63], a[76:79], v[252:255]
    ds_read_b64_tr_b16 a[76:77], v11 offset:0
    v_mfma_f32_16x16x32_bf16 v[64:67], a[32:35], a[80:83], v[64:67]
    ds_read_b64_tr_b16 a[78:79], v11 offset:2048
    v_mfma_f32_16x16x32_bf16 v[68:71], a[36:39], a[80:83], v[68:71]
    buffer_load_dwordx4 v20, s[44:47], s55 offen offset:2048 lds
    v_mfma_f32_16x16x32_bf16 v[128:131], a[40:43], a[80:83], v[128:131]
    ds_read_b128 a[24:27], v6 offset:12288
    v_mfma_f32_16x16x32_bf16 v[132:135], a[44:47], a[80:83], v[132:135]
    v_mfma_f32_16x16x32_bf16 v[192:195], a[48:51], a[80:83], v[192:195]
    v_mfma_f32_16x16x32_bf16 v[196:199], a[52:55], a[80:83], v[196:199]
    buffer_load_dwordx4 v21, s[44:47], s55 offen offset:3072 lds
    v_mfma_f32_16x16x32_bf16 a[96:99], a[56:59], a[80:83], a[96:99]
    s_add_u32 s55, s55, s56
    ds_read_b128 a[28:31], v6 offset:14336
    v_mfma_f32_16x16x32_bf16 a[100:103], a[60:63], a[80:83], a[100:103]
    ds_read_b64_tr_b16 a[80:81], v12 offset:0
    v_mfma_f32_16x16x32_bf16 v[72:75], a[32:35], a[84:87], v[72:75]
    ds_read_b64_tr_b16 a[82:83], v12 offset:2048
    v_mfma_f32_16x16x32_bf16 v[76:79], a[36:39], a[84:87], v[76:79]
    v_mfma_f32_16x16x32_bf16 v[136:139], a[40:43], a[84:87], v[136:139]
    buffer_store_dwordx4 a[236:239], v2, s[24:27], s28 offen sc1
    v_mfma_f32_16x16x32_bf16 v[140:143], a[44:47], a[84:87], v[140:143]
    s_add_u32 s28, s28, s31
    v_mfma_f32_16x16x32_bf16 v[200:203], a[48:51], a[84:87], v[200:203]
    v_mfma_f32_16x16x32_bf16 v[204:207], a[52:55], a[84:87], v[204:207]
    v_mfma_f32_16x16x32_bf16 a[104:107], a[56:59], a[84:87], a[104:107]
    buffer_store_dwordx4 a[240:243], v2, s[24:27], s28 offen sc1
    v_mfma_f32_16x16x32_bf16 a[108:111], a[60:63], a[84:87], a[108:111]
    s_add_u32 s28, s28, s31
    ds_read_b64_tr_b16 a[84:85], v13 offset:0
    v_mfma_f32_16x16x32_bf16 v[80:83], a[32:35], a[88:91], v[80:83]
    ds_read_b64_tr_b16 a[86:87], v13 offset:2048
    v_mfma_f32_16x16x32_bf16 v[84:87], a[36:39], a[88:91], v[84:87]
    v_mfma_f32_16x16x32_bf16 v[144:147], a[40:43], a[88:91], v[144:147]
    buffer_store_dwordx4 a[244:247], v2, s[24:27], s28 offen sc1
    v_mfma_f32_16x16x32_bf16 v[148:151], a[44:47], a[88:91], v[148:151]
    s_add_u32 s28, s28, s31
    v_mfma_f32_16x16x32_bf16 v[208:211], a[48:51], a[88:91], v[208:211]
    v_mfma_f32_16x16x32_bf16 v[212:215], a[52:55], a[88:91], v[212:215]
    v_mfma_f32_16x16x32_bf16 a[112:115], a[56:59], a[88:91], a[112:115]
    buffer_store_dwordx4 a[248:251], v2, s[24:27], s28 offen sc1
    v_mfma_f32_16x16x32_bf16 a[116:119], a[60:63], a[88:91], a[116:119]
    s_add_u32 s28, s28, s31
    ds_read_b64_tr_b16 a[88:89], v14 offset:0
    v_mfma_f32_16x16x32_bf16 v[88:91], a[32:35], a[92:95], v[88:91]
    ds_read_b64_tr_b16 a[90:91], v14 offset:2048
    v_mfma_f32_16x16x32_bf16 v[92:95], a[36:39], a[92:95], v[92:95]
    v_mfma_f32_16x16x32_bf16 v[152:155], a[40:43], a[92:95], v[152:155]
    buffer_store_dwordx4 a[252:255], v2, s[24:27], s28 offen sc1
    v_mfma_f32_16x16x32_bf16 v[156:159], a[44:47], a[92:95], v[156:159]
    s_add_u32 s29, s29, s30
    s_mov_b32 s28, s29
    v_mfma_f32_16x16x32_bf16 v[216:219], a[48:51], a[92:95], v[216:219]
    s_sub_u32 s65, s65, 1
    v_mfma_f32_16x16x32_bf16 v[220:223], a[52:55], a[92:95], v[220:223]
    v_mfma_f32_16x16x32_bf16 a[120:123], a[56:59], a[92:95], a[120:123]
    v_mfma_f32_16x16x32_bf16 a[124:127], a[60:63], a[92:95], a[124:127]
    ds_read_b64_tr_b16 a[92:93], v15 offset:0
    ds_read_b64_tr_b16 a[94:95], v15 offset:2048
m_loop19:
    s_waitcnt lgkmcnt(15)
    v_mfma_f32_16x16x32_bf16 v[32:35], a[0:3], a[64:67], v[32:35]
    v_mfma_f32_16x16x32_bf16 v[36:39], a[4:7], a[64:67], v[36:39]
    v_mfma_f32_16x16x32_bf16 v[96:99], a[8:11], a[64:67], v[96:99]
    v_mfma_f32_16x16x32_bf16 v[100:103], a[12:15], a[64:67], v[100:103]
    s_add_u32 m0, s61, 0
    s_waitcnt lgkmcnt(13)
    v_mfma_f32_16x16x32_bf16 v[160:163], a[16:19], a[64:67], v[160:163]
    buffer_load_dwordx4 v16, s[40:43], s48 offen offset:0 lds
    s_waitcnt lgkmcnt(12)
    v_mfma_f32_16x16x32_bf16 v[164:167], a[20:23], a[64:67], v[164:167]
    s_waitcnt lgkmcnt(9)
    v_mfma_f32_16x16x32_bf16 v[224:227], a[24:27], a[64:67], v[224:227]
    s_waitcnt lgkmcnt(8)
    v_mfma_f32_16x16x32_bf16 v[228:231], a[28:31], a[64:67], v[228:231]
    ds_read_b64_tr_b16 a[64:65], v8 offset:16384
    v_mfma_f32_16x16x32_bf16 v[40:43], a[0:3], a[68:71], v[40:43]
    ds_read_b64_tr_b16 a[66:67], v8 offset:18432
    v_mfma_f32_16x16x32_bf16 v[44:47], a[4:7], a[68:71], v[44:47]
    v_mfma_f32_16x16x32_bf16 v[104:107], a[8:11], a[68:71], v[104:107]
    ds_read_b128 a[32:35], v7 offset:0
    v_mfma_f32_16x16x32_bf16 v[108:111], a[12:15], a[68:71], v[108:111]
    v_mfma_f32_16x16x32_bf16 v[168:171], a[16:19], a[68:71], v[168:171]
    buffer_load_dwordx4 v17, s[40:43], s48 offen offset:1024 lds
    v_mfma_f32_16x16x32_bf16 v[172:175], a[20:23], a[68:71], v[172:175]
    s_add_u32 s48, s48, 128
    v_mfma_f32_16x16x32_bf16 v[232:235], a[24:27], a[68:71], v[232:235]
    ds_read_b128 a[36:39], v7 offset:2048
    v_mfma_f32_16x16x32_bf16 v[236:239], a[28:31], a[68:71], v[236:239]
    ds_read_b64_tr_b16 a[68:69], v9 offset:16384
    v_mfma_f32_16x16x32_bf16 v[48:51], a[0:3], a[72:75], v[48:51]
    ds_read_b64_tr_b16 a[70:71], v9 offset:18432
    v_mfma_f32_16x16x32_bf16 v[52:55], a[4:7], a[72:75], v[52:55]
    v_mfma_f32_16x16x32_bf16 v[112:115], a[8:11], a[72:75], v[112:115]
    ds_read_b128 a[40:43], v7 offset:4096
    v_mfma_f32_16x16x32_bf16 v[116:119], a[12:15], a[72:75], v[116:119]
    v_mfma_f32_16x16x32_bf16 v[176:179], a[16:19], a[72:75], v[176:179]
    buffer_load_dwordx4 v16, s[40:43], s49 offen offset:2048 lds
    v_mfma_f32_16x16x32_bf16 v[180:183], a[20:23], a[72:75], v[180:183]
    v_mfma_f32_16x16x32_bf16 v[240:243], a[24:27], a[72:75], v[240:243]
    ds_read_b128 a[44:47], v7 offset:6144
    v_mfma_f32_16x16x32_bf16 v[244:247], a[28:31], a[72:75], v[244:247]
    ds_read_b64_tr_b16 a[72:73], v10 offset:16384
    v_mfma_f32_16x16x32_bf16 v[56:59], a[0:3], a[76:79], v[56:59]
    ds_read_b64_tr_b16 a[74:75], v10 offset:18432
    v_mfma_f32_16x16x32_bf16 v[60:63], a[4:7], a[76:79], v[60:63]
    v_mfma_f32_16x16x32_bf16 v[120:123], a[8:11], a[76:79], v[120:123]
    ds_read_b128 a[48:51], v7 offset:8192
    v_mfma_f32_16x16x32_bf16 v[124:127], a[12:15], a[76:79], v[124:127]
    v_mfma_f32_16x16x32_bf16 v[184:187], a[16:19], a[76:79], v[184:187]
    buffer_load_dwordx4 v17, s[40:43], s49 offen offset:3072 lds
    v_mfma_f32_16x16x32_bf16 v[188:191], a[20:23], a[76:79], v[188:191]
    s_add_u32 s49, s49, 128
    v_mfma_f32_16x16x32_bf16 v[248:251], a[24:27], a[76:79], v[248:251]
    ds_read_b128 a[52:55], v7 offset:10240
    v_mfma_f32_16x16x32_bf16 v[252:255], a[28:31], a[76:79], v[252:255]
    ds_read_b64_tr_b16 a[76:77], v11 offset:16384
    s_waitcnt lgkmcnt(15)
    v_mfma_f32_16x16x32_bf16 v[64:67], a[0:3], a[80:83], v[64:67]
    ds_read_b64_tr_b16 a[78:79], v11 offset:18432
    v_mfma_f32_16x16x32_bf16 v[68:71], a[4:7], a[80:83], v[68:71]
    v_mfma_f32_16x16x32_bf16 v[128:131], a[8:11], a[80:83], v[128:131]
    ds_read_b128 a[56:59], v7 offset:12288
    v_mfma_f32_16x16x32_bf16 v[132:135], a[12:15], a[80:83], v[132:135]
    s_add_u32 m0, s61, 4096
    v_mfma_f32_16x16x32_bf16 v[192:195], a[16:19], a[80:83], v[192:195]
    buffer_load_dwordx4 v16, s[40:43], s50 offen offset:0 lds
    v_mfma_f32_16x16x32_bf16 v[196:199], a[20:23], a[80:83], v[196:199]
    v_mfma_f32_16x16x32_bf16 a[96:99], a[24:27], a[80:83], a[96:99]
    s_add_u32 s61, s61, 32768
    ds_read_b128 a[60:63], v7 offset:14336
    v_mfma_f32_16x16x32_bf16 a[100:103], a[28:31], a[80:83], a[100:103]
    s_cmp_ge_u32 s61, 98304
    s_cselect_b32 s90, 98304, 0
    ds_read_b64_tr_b16 a[80:81], v12 offset:16384
    v_mfma_f32_16x16x32_bf16 v[72:75], a[0:3], a[84:87], v[72:75]
    s_sub_u32 s61, s61, s90
    ds_read_b64_tr_b16 a[82:83], v12 offset:18432
    v_mfma_f32_16x16x32_bf16 v[76:79], a[4:7], a[84:87], v[76:79]
    s_add_u32 s64, s64, 32768
    v_mfma_f32_16x16x32_bf16 v[136:139], a[8:11], a[84:87], v[136:139]
    s_cmp_ge_u32 s64, 98304
    s_cselect_b32 s63, 4294901760, s59
    s_cselect_b32 s64, 0, s64
    v_mfma_f32_16x16x32_bf16 v[140:143], a[12:15], a[84:87], v[140:143]
    v_mfma_f32_16x16x32_bf16 v[200:203], a[16:19], a[84:87], v[200:203]
    buffer_load_dwordx4 v17, s[40:43], s50 offen offset:1024 lds
    v_mfma_f32_16x16x32_bf16 v[204:207], a[20:23], a[84:87], v[204:207]
    s_add_u32 s50, s50, 128
    v_mfma_f32_16x16x32_bf16 a[104:107], a[24:27], a[84:87], a[104:107]
    v_mfma_f32_16x16x32_bf16 a[108:111], a[28:31], a[84:87], a[108:111]
    ds_read_b64_tr_b16 a[84:85], v13 offset:16384
    v_mfma_f32_16x16x32_bf16 v[80:83], a[0:3], a[88:91], v[80:83]
    ds_read_b64_tr_b16 a[86:87], v13 offset:18432
    v_mfma_f32_16x16x32_bf16 v[84:87], a[4:7], a[88:91], v[84:87]
    v_mfma_f32_16x16x32_bf16 v[144:147], a[8:11], a[88:91], v[144:147]
    v_mfma_f32_16x16x32_bf16 v[148:151], a[12:15], a[88:91], v[148:151]
    v_mfma_f32_16x16x32_bf16 v[208:211], a[16:19], a[88:91], v[208:211]
    buffer_load_dwordx4 v16, s[40:43], s51 offen offset:2048 lds
    v_mfma_f32_16x16x32_bf16 v[212:215], a[20:23], a[88:91], v[212:215]
    v_mfma_f32_16x16x32_bf16 a[112:115], a[24:27], a[88:91], a[112:115]
    v_mfma_f32_16x16x32_bf16 a[116:119], a[28:31], a[88:91], a[116:119]
    ds_read_b64_tr_b16 a[88:89], v14 offset:16384
    s_waitcnt lgkmcnt(15)
    v_mfma_f32_16x16x32_bf16 v[88:91], a[0:3], a[92:95], v[88:91]
    ds_read_b64_tr_b16 a[90:91], v14 offset:18432
    v_mfma_f32_16x16x32_bf16 v[92:95], a[4:7], a[92:95], v[92:95]
    v_add_u32 v6, s63, v6
    v_add_u32 v7, s63, v7
    v_mfma_f32_16x16x32_bf16 v[152:155], a[8:11], a[92:95], v[152:155]
    v_mfma_f32_16x16x32_bf16 v[156:159], a[12:15], a[92:95], v[156:159]
    v_mfma_f32_16x16x32_bf16 v[216:219], a[16:19], a[92:95], v[216:219]
    buffer_load_dwordx4 v17, s[40:43], s51 offen offset:3072 lds
    v_mfma_f32_16x16x32_bf16 v[220:223], a[20:23], a[92:95], v[220:223]
    s_add_u32 s51, s51, 128
    v_mfma_f32_16x16x32_bf16 a[120:123], a[24:27], a[92:95], a[120:123]
    v_mfma_f32_16x16x32_bf16 a[124:127], a[28:31], a[92:95], a[124:127]
    ds_read_b64_tr_b16 a[92:93], v15 offset:16384
    ds_read_b64_tr_b16 a[94:95], v15 offset:18432
    v_mfma_f32_16x16x32_bf16 v[32:35], a[32:35], a[64:67], v[32:35]
    v_xor_b32 v8, s60, v8
    v_xor_b32 v9, s60, v9
    v_mfma_f32_16x16x32_bf16 v[36:39], a[36:39], a[64:67], v[36:39]
    v_xor_b32 v10, s60, v10
    v_xor_b32 v11, s60, v11
    s_waitcnt lgkmcnt(15)
    v_mfma_f32_16x16x32_bf16 v[96:99], a[40:43], a[64:67], v[96:99]
    v_xor_b32 v12, s60, v12
    v_xor_b32 v13, s60, v13
    v_mfma_f32_16x16x32_bf16 v[100:103], a[44:47], a[64:67], v[100:103]
    v_xor_b32 v14, s60, v14
    v_xor_b32 v15, s60, v15
    s_waitcnt lgkmcnt(13)
    v_mfma_f32_16x16x32_bf16 v[160:163], a[48:51], a[64:67], v[160:163]
    s_waitcnt lgkmcnt(12)
    v_mfma_f32_16x16x32_bf16 v[164:167], a[52:55], a[64:67], v[164:167]
    s_waitcnt lgkmcnt(9)
    v_mfma_f32_16x16x32_bf16 v[224:227], a[56:59], a[64:67], v[224:227]
    s_waitcnt vmcnt(8) lgkmcnt(0)
    v_mfma_f32_16x16x32_bf16 v[228:231], a[60:63], a[64:67], v[228:231]
    s_barrier
    ds_read_b64_tr_b16 a[64:65], v8 offset:0
    v_mfma_f32_16x16x32_bf16 v[40:43], a[32:35], a[68:71], v[40:43]
    s_add_u32 m0, s62, 0
    ds_read_b64_tr_b16 a[66:67], v8 offset:2048
    v_mfma_f32_16x16x32_bf16 v[44:47], a[36:39], a[68:71], v[44:47]
    buffer_load_dwordx4 v18, s[44:47], s52 offen offset:0 lds
    v_mfma_f32_16x16x32_bf16 v[104:107], a[40:43], a[68:71], v[104:107]
    ds_read_b128 a[0:3], v6 offset:0
    v_mfma_f32_16x16x32_bf16 v[108:111], a[44:47], a[68:71], v[108:111]
    v_mfma_f32_16x16x32_bf16 v[168:171], a[48:51], a[68:71], v[168:171]
    v_mfma_f32_16x16x32_bf16 v[172:175], a[52:55], a[68:71], v[172:175]
    buffer_load_dwordx4 v19, s[44:47], s52 offen offset:1024 lds
    v_mfma_f32_16x16x32_bf16 v[232:235], a[56:59], a[68:71], v[232:235]
    s_add_u32 s52, s52, s56
    ds_read_b128 a[4:7], v6 offset:2048
    v_mfma_f32_16x16x32_bf16 v[236:239], a[60:63], a[68:71], v[236:239]
    ds_read_b64_tr_b16 a[68:69], v9 offset:0
    v_mfma_f32_16x16x32_bf16 v[48:51], a[32:35], a[72:75], v[48:51]
    ds_read_b64_tr_b16 a[70:71], v9 offset:2048
    v_mfma_f32_16x16x32_bf16 v[52:55], a[36:39], a[72:75], v[52:55]
    buffer_load_dwordx4 v18, s[44:47], s53 offen offset:2048 lds
    v_mfma_f32_16x16x32_bf16 v[112:115], a[40:43], a[72:75], v[112:115]
    ds_read_b128 a[8:11], v6 offset:4096
    v_mfma_f32_16x16x32_bf16 v[116:119], a[44:47], a[72:75], v[116:119]
    v_mfma_f32_16x16x32_bf16 v[176:179], a[48:51], a[72:75], v[176:179]
    v_mfma_f32_16x16x32_bf16 v[180:183], a[52:55], a[72:75], v[180:183]
    buffer_load_dwordx4 v19, s[44:47], s53 offen offset:3072 lds
    v_mfma_f32_16x16x32_bf16 v[240:243], a[56:59], a[72:75], v[240:243]
    s_add_u32 s53, s53, s56
    ds_read_b128 a[12:15], v6 offset:6144
    v_mfma_f32_16x16x32_bf16 v[244:247], a[60:63], a[72:75], v[244:247]
    ds_read_b64_tr_b16 a[72:73], v10 offset:0
    v_mfma_f32_16x16x32_bf16 v[56:59], a[32:35], a[76:79], v[56:59]
    s_add_u32 m0, s62, 4096
    ds_read_b64_tr_b16 a[74:75], v10 offset:2048
    v_mfma_f32_16x16x32_bf16 v[60:63], a[36:39], a[76:79], v[60:63]
    buffer_load_dwordx4 v20, s[44:47], s54 offen offset:0 lds
    v_mfma_f32_16x16x32_bf16 v[120:123], a[40:43], a[76:79], v[120:123]
    ds_read_b128 a[16:19], v6 offset:8192
    v_mfma_f32_16x16x32_bf16 v[124:127], a[44:47], a[76:79], v[124:127]
    s_xor_b32 s62, s62, 229376
    v_mfma_f32_16x16x32_bf16 v[184:187], a[48:51], a[76:79], v[184:187]
    v_mfma_f32_16x16x32_bf16 v[188:191], a[52:55], a[76:79], v[188:191]
    buffer_load_dwordx4 v21, s[44:47], s54 offen offset:1024 lds
    v_mfma_f32_16x16x32_bf16 v[248:251], a[56:59], a[76:79], v[248:251]
    s_add_u32 s54, s54, s56
    ds_read_b128 a[20:23], v6 offset:10240
    v_mfma_f32_16x16x32_bf16 v[252:255], a[60:63], a[76:79], v[252:255]
    ds_read_b64_tr_b16 a[76:77], v11 offset:0
    v_mfma_f32_16x16x32_bf16 v[64:67], a[32:35], a[80:83], v[64:67]
    ds_read_b64_tr_b16 a[78:79], v11 offset:2048
    v_mfma_f32_16x16x32_bf16 v[68:71], a[36:39], a[80:83], v[68:71]
    buffer_load_dwordx4 v20, s[44:47], s55 offen offset:2048 lds
    v_mfma_f32_16x16x32_bf16 v[128:131], a[40:43], a[80:83], v[128:131]
    ds_read_b128 a[24:27], v6 offset:12288
    v_mfma_f32_16x16x32_bf16 v[132:135], a[44:47], a[80:83], v[132:135]
    v_mfma_f32_16x16x32_bf16 v[192:195], a[48:51], a[80:83], v[192:195]
    v_mfma_f32_16x16x32_bf16 v[196:199], a[52:55], a[80:83], v[196:199]
    buffer_load_dwordx4 v21, s[44:47], s55 offen offset:3072 lds
    v_mfma_f32_16x16x32_bf16 a[96:99], a[56:59], a[80:83], a[96:99]
    s_add_u32 s55, s55, s56
    ds_read_b128 a[28:31], v6 offset:14336
    v_mfma_f32_16x16x32_bf16 a[100:103], a[60:63], a[80:83], a[100:103]
    ds_read_b64_tr_b16 a[80:81], v12 offset:0
    v_mfma_f32_16x16x32_bf16 v[72:75], a[32:35], a[84:87], v[72:75]
    ds_read_b64_tr_b16 a[82:83], v12 offset:2048
    v_mfma_f32_16x16x32_bf16 v[76:79], a[36:39], a[84:87], v[76:79]
    v_mfma_f32_16x16x32_bf16 v[136:139], a[40:43], a[84:87], v[136:139]
    v_mfma_f32_16x16x32_bf16 v[140:143], a[44:47], a[84:87], v[140:143]
    v_mfma_f32_16x16x32_bf16 v[200:203], a[48:51], a[84:87], v[200:203]
    v_mfma_f32_16x16x32_bf16 v[204:207], a[52:55], a[84:87], v[204:207]
    v_mfma_f32_16x16x32_bf16 a[104:107], a[56:59], a[84:87], a[104:107]
    v_mfma_f32_16x16x32_bf16 a[108:111], a[60:63], a[84:87], a[108:111]
    ds_read_b64_tr_b16 a[84:85], v13 offset:0
    v_mfma_f32_16x16x32_bf16 v[80:83], a[32:35], a[88:91], v[80:83]
    ds_read_b64_tr_b16 a[86:87], v13 offset:2048
    v_mfma_f32_16x16x32_bf16 v[84:87], a[36:39], a[88:91], v[84:87]
    v_mfma_f32_16x16x32_bf16 v[144:147], a[40:43], a[88:91], v[144:147]
    v_mfma_f32_16x16x32_bf16 v[148:151], a[44:47], a[88:91], v[148:151]
    v_mfma_f32_16x16x32_bf16 v[208:211], a[48:51], a[88:91], v[208:211]
    v_mfma_f32_16x16x32_bf16 v[212:215], a[52:55], a[88:91], v[212:215]
    v_mfma_f32_16x16x32_bf16 a[112:115], a[56:59], a[88:91], a[112:115]
    v_mfma_f32_16x16x32_bf16 a[116:119], a[60:63], a[88:91], a[116:119]
    ds_read_b64_tr_b16 a[88:89], v14 offset:0
    v_mfma_f32_16x16x32_bf16 v[88:91], a[32:35], a[92:95], v[88:91]
    ds_read_b64_tr_b16 a[90:91], v14 offset:2048
    v_mfma_f32_16x16x32_bf16 v[92:95], a[36:39], a[92:95], v[92:95]
    v_mfma_f32_16x16x32_bf16 v[152:155], a[40:43], a[92:95], v[152:155]
    v_mfma_f32_16x16x32_bf16 v[156:159], a[44:47], a[92:95], v[156:159]
    v_mfma_f32_16x16x32_bf16 v[216:219], a[48:51], a[92:95], v[216:219]
    s_sub_u32 s65, s65, 1
    v_mfma_f32_16x16x32_bf16 v[220:223], a[52:55], a[92:95], v[220:223]
    v_mfma_f32_16x16x32_bf16 a[120:123], a[56:59], a[92:95], a[120:123]
    s_cmp_gt_u32 s65, s67
    v_mfma_f32_16x16x32_bf16 a[124:127], a[60:63], a[92:95], a[124:127]
    ds_read_b64_tr_b16 a[92:93], v15 offset:0
    ds_read_b64_tr_b16 a[94:95], v15 offset:2048
    s_cbranch_scc1 m_loop19
    s_cmp_lg_u32 s65, 0
    s_cbranch_scc1 m_dosw20
m_epi11:
    s_cmp_eq_u32 s94, 0
    s_cbranch_scc1 m_last23
    s_mov_b32 s3, 1048576
m_spin27:
    v_readfirstlane_b32 s4, v4
    v_readfirstlane_b32 s5, v5
    s_nop 3
    s_cmp_lg_u32 s4, 0
    s_cbranch_scc1 m_ok28
    s_sub_u32 s3, s3, 1
    s_cbranch_scc1 m_ok28
    s_sleep 32
    buffer_load_dwordx2 v[4:5], off, s[12:15], 0 sc1
    s_waitcnt vmcnt(0)
    s_branch m_spin27
m_ok28:
    s_cmp_ge_u32 s68, 16
    s_cbranch_scc1 m_q030
    s_call_b64 s[20:21], m_epf21
    s_mov_b32 s17, s101
    s_mov_b32 s66, 2
    s_branch m_q129
m_q030:
    s_call_b64 s[20:21], m_eps22
    s_mov_b32 s17, s101
    s_mov_b32 s28, s98
    s_mov_b32 s29, s98
    s_mov_b32 s30, s99
    s_mov_b32 s31, s100
    s_mov_b32 s26, 268435456
m_q129:
    s_mov_b32 s95, s82
    s_mov_b32 s96, s83
    s_mov_b32 s97, s84
    s_mov_b32 s98, s85
    s_mov_b32 s99, s86
    s_mov_b32 s100, s87
    s_mov_b32 s101, s88
    s_sub_u32 s67, s95, 5
    s_mov_b32 s94, 0
    s_branch m_tile10
m_last23:
    s_cmp_eq_u32 s70, 0
    s_cbranch_scc1 m_kvl26
    buffer_load_dwordx2 v[4:5], off, s[12:15], 0 sc1
    s_call_b64 s[20:21], m_epf21
    s_waitcnt vmcnt(0)
    s_barrier
    s_mov_b32 s3, 1048576
m_spin31:
    v_readfirstlane_b32 s4, v4
    v_readfirstlane_b32 s5, v5
    s_nop 3
    s_cmp_lg_u32 s4, 0
    s_cbranch_scc1 m_ok32
    s_sub_u32 s3, s3, 1
    s_cbranch_scc1 m_ok32
    s_sleep 32
    buffer_load_dwordx2 v[4:5], off, s[12:15], 0 sc1
    s_waitcnt vmcnt(0)
    s_branch m_spin31
m_ok32:
    s_cmp_lg_u32 s16, 0
    s_cbranch_scc1 m_np33
    v_mov_b32 v4, s4
    v_mov_b32 v5, s5
    s_add_u32 s90, s101, 117440512
    s_mov_b64 exec, 1
    buffer_store_dwordx2 v[4:5], off, s[8:11], s90 sc1
    s_mov_b64 exec, -1
m_np33:
    s_cmp_lg_u32 s16, 0
    s_cbranch_scc1 m_pw34
    s_and_b32 s92, s2, 7
    s_lshl_b32 s92, s92, 2
    s_bfe_u32 s93, s2, 0x20003
    s_add_u32 s92, s92, s93
    s_lshr_b32 s93, s2, 5
    s_lshl_b32 s93, s93, 2
    s_or_b32 s93, s93, 0x40000
    s_lshr_b32 s90, s92, 1
    s_lshl_b32 s90, s90, 7
    s_add_u32 s90, s90, 117440512
    s_bfe_u32 s91, 873473623, s93
    s_lshr_b32 s91, s91, 1
    v_mov_b32 v0, s91
    v_add_u32 v4, 8, v1
    v_cmp_gt_u32 vcc, 8, v1
    s_nop 1
    v_cndmask_b32 v0, v0, v4, vcc
    s_bfe_u32 s91, 4225681832, s93
    s_lshr_b32 s91, s91, 1
    v_writelane_b32 v0, s91, 8
    v_lshlrev_b32 v0, 3, v0
    buffer_load_dwordx2 v[4:5], v0, s[8:11], s90 offen sc1
    s_waitcnt vmcnt(0)
    s_mov_b32 s3, 1048576
m_spin35:
    v_cmp_ne_u64 s[22:23], s[4:5], v[4:5]
    s_nop 3
    s_cmp_eq_u64 s[22:23], 0
    s_cbranch_scc1 m_ok36
    s_sub_u32 s3, s3, 1
    s_cbranch_scc1 m_ok36
    s_sleep 16
    s_and_b32 s92, s2, 7
    s_lshl_b32 s92, s92, 2
    s_bfe_u32 s93, s2, 0x20003
    s_add_u32 s92, s92, s93
    s_lshr_b32 s93, s2, 5
    s_lshl_b32 s93, s93, 2
    s_or_b32 s93, s93, 0x40000
    s_lshr_b32 s90, s92, 1
    s_lshl_b32 s90, s90, 7
    s_add_u32 s90, s90, 117440512
    s_bfe_u32 s91, 873473623, s93
    s_lshr_b32 s91, s91, 1
    v_mov_b32 v0, s91
    v_add_u32 v4, 8, v1
    v_cmp_gt_u32 vcc, 8, v1
    s_nop 1
    v_cndmask_b32 v0, v0, v4, vcc
    s_bfe_u32 s91, 4225681832, s93
    s_lshr_b32 s91, s91, 1
    v_writelane_b32 v0, s91, 8
    v_lshlrev_b32 v0, 3, v0
    buffer_load_dwordx2 v[4:5], v0, s[8:11], s90 offen sc1
    s_waitcnt vmcnt(0)
    s_branch m_spin35
m_ok36:
m_pw34:
    s_barrier
    s_and_b32 s92, s2, 7
    s_lshl_b32 s92, s92, 2
    s_bfe_u32 s93, s2, 0x20003
    s_add_u32 s92, s92, s93
    s_lshr_b32 s93, s2, 5
    s_lshl_b32 s93, s93, 2
    s_or_b32 s93, s93, 0x40000
    s_bfe_u32 s90, 4225681832, s93
    s_lshl_b32 s90, s90, 3
    s_lshl_b32 s91, s16, 1
    s_add_u32 s90, s90, s91
    s_lshl_b32 s90, s90, 12
    s_lshl_b32 s91, s92, 19
    s_add_u32 s90, s90, s91
    s_add_u32 s90, s90, 0
    buffer_load_dwordx4 a[128:131], v2, s[8:11], s90 offen offset:0 sc1
    buffer_load_dwordx4 a[132:135], v2, s[8:11], s90 offen offset:1024 sc1
    buffer_load_dwordx4 a[136:139], v2, s[8:11], s90 offen offset:2048 sc1
    buffer_load_dwordx4 a[140:143], v2, s[8:11], s90 offen offset:3072 sc1
    s_bfe_u32 s90, 4225681832, s93
    s_lshl_b32 s90, s90, 3
    s_lshl_b32 s91, s16, 1
    s_add_u32 s90, s90, s91
    s_lshl_b32 s90, s90, 12
    s_lshl_b32 s91, s92, 19
    s_add_u32 s90, s90, s91
    s_add_u32 s90, s90, 4096
    buffer_load_dwordx4 a[144:147], v2, s[8:11], s90 offen offset:0 sc1
    buffer_load_dwordx4 a[148:151], v2, s[8:11], s90 offen offset:1024 sc1
    buffer_load_dwordx4 a[152:155], v2, s[8:11], s90 offen offset:2048 sc1
    buffer_load_dwordx4 a[156:159], v2, s[8:11], s90 offen offset:3072 sc1
    s_bfe_u32 s90, 873473623, s93
    s_lshl_b32 s90, s90, 3
    s_lshl_b32 s91, s16, 1
    s_add_u32 s90, s90, s91
    s_lshl_b32 s90, s90, 12
    s_lshl_b32 s91, s92, 19
    s_add_u32 s90, s90, s91
    s_add_u32 s90, s90, 0
    buffer_load_dwordx4 a[160:163], v2, s[8:11], s90 offen offset:0 sc1
    buffer_load_dwordx4 a[164:167], v2, s[8:11], s90 offen offset:1024 sc1
    buffer_load_dwordx4 a[168:171], v2, s[8:11], s90 offen offset:2048 sc1
    buffer_load_dwordx4 a[172:175], v2, s[8:11], s90 offen offset:3072 sc1
    s_bfe_u32 s90, 873473623, s93
    s_lshl_b32 s90, s90, 3
    s_lshl_b32 s91, s16, 1
    s_add_u32 s90, s90, s91
    s_lshl_b32 s90, s90, 12
    s_lshl_b32 s91, s92, 19
    s_add_u32 s90, s90, s91
    s_add_u32 s90, s90, 4096
    buffer_load_dwordx4 a[176:179], v2, s[8:11], s90 offen offset:0 sc1
    buffer_load_dwordx4 a[180:183], v2, s[8:11], s90 offen offset:1024 sc1
    buffer_load_dwordx4 a[184:187], v2, s[8:11], s90 offen offset:2048 sc1
    buffer_load_dwordx4 a[188:191], v2, s[8:11], s90 offen offset:3072 sc1
    s_mov_b32 s94, 1
m_kvl26:
    s_waitcnt lgkmcnt(0)
    s_barrier
    s_and_b32 s92, s2, 7
    s_lshl_b32 s92, s92, 2
    s_bfe_u32 s93, s2, 0x20003
    s_add_u32 s92, s92, s93
    s_lshr_b32 s93, s2, 5
    s_lshl_b32 s93, s93, 2
    s_or_b32 s93, s93, 0x40000
    s_mov_b32 s32, s92
    s_bfe_u32 s33, 4225681832, s93
    s_add_u32 s33, s33, 1
    s_bfe_u32 s34, 873473623, s93
    s_add_u32 s34, s34, 1
    s_lshl_b32 s60, s16, 12
    v_add_u32 v7, s60, v2
    s_lshl_b32 s90, s34, 2
    s_lshl_b32 s91, s33, 2
    s_lshl_b32 s26, s91, 13
    s_mov_b32 s30, s26
    s_sub_u32 s67, s90, 4
    s_add_u32 s67, s67, s16
    s_add_u32 s68, s67, 1
    s_mov_b32 s69, s90
    s_sub_u32 s70, s91, 4
    s_add_u32 s70, s70, s16
    s_add_u32 s71, s70, 1
    s_mov_b32 s72, s91
    s_mov_b32 s27, 0x20000
    s_mov_b32 s31, 0x20000
    s_lshl_b32 s82, s32, 19
    s_add_u32 s90, s82, 16777216
    s_add_u32 s24, s6, s90
    s_addc_u32 s25, s7, 0
    s_add_u32 s90, s82, 33554432
    s_add_u32 s28, s6, s90
    s_addc_u32 s29, s7, 0
    s_cmp_eq_u32 s94, 1
    s_cbranch_scc1 m_w063
    s_mov_b32 s56, 32768
    s_mov_b32 s57, 16384
    s_add_u32 s59, s60, 65536
    s_mov_b32 m0, s59
    s_nop 0
    buffer_load_dwordx4 v7, s[24:27], s56 offen offset:0 sc1 lds
    buffer_load_dwordx4 v7, s[24:27], s56 offen offset:1024 sc1 lds
    buffer_load_dwordx4 v7, s[24:27], s56 offen offset:2048 sc1 lds
    buffer_load_dwordx4 v7, s[24:27], s56 offen offset:3072 sc1 lds
    s_add_u32 s56, s56, 16384
    s_add_u32 m0, s59, 16384
    s_nop 0
    buffer_load_dwordx4 v7, s[28:31], s57 offen offset:0 sc1 lds
    buffer_load_dwordx4 v7, s[28:31], s57 offen offset:1024 sc1 lds
    buffer_load_dwordx4 v7, s[28:31], s57 offen offset:2048 sc1 lds
    buffer_load_dwordx4 v7, s[28:31], s57 offen offset:3072 sc1 lds
    s_add_u32 s57, s57, 16384
    s_call_b64 s[20:21], m_epl61
    s_mov_b32 s17, s101
    s_mov_b32 s38, 268435456
    s_branch m_init25
m_w063:
    s_mov_b32 s56, 0
    s_mov_b32 s57, 0
    s_mov_b32 m0, s60
    s_nop 0
    buffer_load_dwordx4 v7, s[24:27], s56 offen offset:0 sc1 lds
    buffer_load_dwordx4 v7, s[24:27], s56 offen offset:1024 sc1 lds
    buffer_load_dwordx4 v7, s[24:27], s56 offen offset:2048 sc1 lds
    buffer_load_dwordx4 v7, s[24:27], s56 offen offset:3072 sc1 lds
    s_mov_b32 s56, 16384
    s_add_u32 s59, s60, 32768
    s_mov_b32 m0, s59
    s_nop 0
    buffer_load_dwordx4 v7, s[24:27], s56 offen offset:0 sc1 lds
    buffer_load_dwordx4 v7, s[24:27], s56 offen offset:1024 sc1 lds
    buffer_load_dwordx4 v7, s[24:27], s56 offen offset:2048 sc1 lds
    buffer_load_dwordx4 v7, s[24:27], s56 offen offset:3072 sc1 lds
    s_add_u32 s56, s56, 16384
    s_add_u32 m0, s59, 16384
    s_nop 0
    buffer_load_dwordx4 v7, s[28:31], s57 offen offset:0 sc1 lds
    buffer_load_dwordx4 v7, s[28:31], s57 offen offset:1024 sc1 lds
    buffer_load_dwordx4 v7, s[28:31], s57 offen offset:2048 sc1 lds
    buffer_load_dwordx4 v7, s[28:31], s57 offen offset:3072 sc1 lds
    s_add_u32 s57, s57, 16384
    s_add_u32 s59, s59, 32768
    s_mov_b32 m0, s59
    s_nop 0
    buffer_load_dwordx4 v7, s[24:27], s56 offen offset:0 sc1 lds
    buffer_load_dwordx4 v7, s[24:27], s56 offen offset:1024 sc1 lds
    buffer_load_dwordx4 v7, s[24:27], s56 offen offset:2048 sc1 lds
    buffer_load_dwordx4 v7, s[24:27], s56 offen offset:3072 sc1 lds
    s_add_u32 s56, s56, 16384
    s_add_u32 m0, s59, 16384
    s_nop 0
    buffer_load_dwordx4 v7, s[28:31], s57 offen offset:0 sc1 lds
    buffer_load_dwordx4 v7, s[28:31], s57 offen offset:1024 sc1 lds
    buffer_load_dwordx4 v7, s[28:31], s57 offen offset:2048 sc1 lds
    buffer_load_dwordx4 v7, s[28:31], s57 offen offset:3072 sc1 lds
    s_add_u32 s57, s57, 16384
    s_add_u32 s59, s59, 32768
    s_mov_b32 m0, s59
    s_nop 0
    buffer_load_dwordx4 v7, s[24:27], s56 offen offset:0 sc1 lds
    buffer_load_dwordx4 v7, s[24:27], s56 offen offset:1024 sc1 lds
    buffer_load_dwordx4 v7, s[24:27], s56 offen offset:2048 sc1 lds
    buffer_load_dwordx4 v7, s[24:27], s56 offen offset:3072 sc1 lds
    s_add_u32 s56, s56, 16384
    s_add_u32 m0, s59, 16384
    s_nop 0
    buffer_load_dwordx4 v7, s[28:31], s57 offen offset:0 sc1 lds
    buffer_load_dwordx4 v7, s[28:31], s57 offen offset:1024 sc1 lds
    buffer_load_dwordx4 v7, s[28:31], s57 offen offset:2048 sc1 lds
    buffer_load_dwordx4 v7, s[28:31], s57 offen offset:3072 sc1 lds
    s_add_u32 s57, s57, 16384
    s_add_u32 s59, s59, 32768
    s_waitcnt vmcnt(0)
    s_mov_b32 s38, 0
m_init25:
    s_mov_b32 s56, 65536
    s_mov_b32 s57, 49152
    s_nop 1
    v_mov_b32 v9, 0xff800000
    s_mov_b32 s65, 1233125376
    s_lshl_b32 s91, s16, 1
    s_sub_u32 s91, s91, 8
    s_lshl_b32 s78, s33, 3
    s_add_u32 s78, s78, s91
    s_lshl_b32 s79, s34, 3
    s_add_u32 s79, s79, s91
    s_mov_b32 s36, s6
    s_mov_b32 s37, s7
    s_mov_b32 s39, 0x20000
    s_load_dwordx2 s[48:49], s[0:1], 64
    s_load_dwordx2 s[50:51], s[0:1], 16
    s_load_dwordx2 s[54:55], s[0:1], 72
    s_mov_b32 s47, 0x20000
    s_lshl_b32 s90, s99, 1
    s_add_u32 s98, s98, s90
    s_lshl_b32 s90, s100, 2
    s_add_u32 s40, s98, s90
    s_lshr_b32 s90, s32, 1
    s_lshl_b32 s90, s90, 7
    s_add_u32 s90, s90, 117444608
    s_lshr_b32 s91, s2, 6
    s_lshl_b32 s91, s91, 8
    s_add_u32 s91, s91, 117446592
    v_min_u32 v10, 31, v1
    v_lshlrev_b32 v10, 3, v10
    v_mov_b32 v11, s90
    v_mov_b32 v8, s91
    v_cmp_gt_u32 vcc, 8, v1
    s_nop 1
    v_cndmask_b32 v11, v8, v11, vcc
    v_add_u32 v10, v10, v11
    s_mov_b32 s58, 0
    v_mov_b32 v6, v2
    v_accvgpr_write_b32 a0, 0
    v_accvgpr_write_b32 a1, 0
    v_accvgpr_write_b32 a2, 0
    v_accvgpr_write_b32 a3, 0
    v_accvgpr_write_b32 a4, 0
    v_accvgpr_write_b32 a5, 0
    v_accvgpr_write_b32 a6, 0
    v_accvgpr_write_b32 a7, 0
    v_accvgpr_write_b32 a8, 0
    v_accvgpr_write_b32 a9, 0
    v_accvgpr_write_b32 a10, 0
    v_accvgpr_write_b32 a11, 0
    v_accvgpr_write_b32 a12, 0
    v_accvgpr_write_b32 a13, 0
    v_accvgpr_write_b32 a14, 0
    v_accvgpr_write_b32 a15, 0
    v_accvgpr_write_b32 a16, 0
    v_accvgpr_write_b32 a17, 0
    v_accvgpr_write_b32 a18, 0
    v_accvgpr_write_b32 a19, 0
    v_accvgpr_write_b32 a20, 0
    v_accvgpr_write_b32 a21, 0
    v_accvgpr_write_b32 a22, 0
    v_accvgpr_write_b32 a23, 0
    v_accvgpr_write_b32 a24, 0
    v_accvgpr_write_b32 a25, 0
    v_accvgpr_write_b32 a26, 0
    v_accvgpr_write_b32 a27, 0
    v_accvgpr_write_b32 a28, 0
    v_accvgpr_write_b32 a29, 0
    v_accvgpr_write_b32 a30, 0
    v_accvgpr_write_b32 a31, 0
    v_accvgpr_write_b32 a32, 0
    v_accvgpr_write_b32 a33, 0
    v_accvgpr_write_b32 a34, 0
    v_accvgpr_write_b32 a35, 0
    v_accvgpr_write_b32 a36, 0
    v_accvgpr_write_b32 a37, 0
    v_accvgpr_write_b32 a38, 0
    v_accvgpr_write_b32 a39, 0
    v_accvgpr_write_b32 a40, 0
    v_accvgpr_write_b32 a41, 0
    v_accvgpr_write_b32 a42, 0
    v_accvgpr_write_b32 a43, 0
    v_accvgpr_write_b32 a44, 0
    v_accvgpr_write_b32 a45, 0
    v_accvgpr_write_b32 a46, 0
    v_accvgpr_write_b32 a47, 0
    v_accvgpr_write_b32 a48, 0
    v_accvgpr_write_b32 a49, 0
    v_accvgpr_write_b32 a50, 0
    v_accvgpr_write_b32 a51, 0
    v_accvgpr_write_b32 a52, 0
    v_accvgpr_write_b32 a53, 0
    v_accvgpr_write_b32 a54, 0
    v_accvgpr_write_b32 a55, 0
    v_accvgpr_write_b32 a56, 0
    v_accvgpr_write_b32 a57, 0
    v_accvgpr_write_b32 a58, 0
    v_accvgpr_write_b32 a59, 0
    v_accvgpr_write_b32 a60, 0
    v_accvgpr_write_b32 a61, 0
    v_accvgpr_write_b32 a62, 0
    v_accvgpr_write_b32 a63, 0
    v_accvgpr_write_b32 a64, 0
    v_accvgpr_write_b32 a65, 0
    v_accvgpr_write_b32 a66, 0
    v_accvgpr_write_b32 a67, 0
    v_accvgpr_write_b32 a68, 0
    v_accvgpr_write_b32 a69, 0
    v_accvgpr_write_b32 a70, 0
    v_accvgpr_write_b32 a71, 0
    v_accvgpr_write_b32 a72, 0
    v_accvgpr_write_b32 a73, 0
    v_accvgpr_write_b32 a74, 0
    v_accvgpr_write_b32 a75, 0
    v_accvgpr_write_b32 a76, 0
    v_accvgpr_write_b32 a77, 0
    v_accvgpr_write_b32 a78, 0
    v_accvgpr_write_b32 a79, 0
    v_accvgpr_write_b32 a80, 0
    v_accvgpr_write_b32 a81, 0
    v_accvgpr_write_b32 a82, 0
    v_accvgpr_write_b32 a83, 0
    v_accvgpr_write_b32 a84, 0
    v_accvgpr_write_b32 a85, 0
    v_accvgpr_write_b32 a86, 0
    v_accvgpr_write_b32 a87, 0
    v_accvgpr_write_b32 a88, 0
    v_accvgpr_write_b32 a89, 0
    v_accvgpr_write_b32 a90, 0
    v_accvgpr_write_b32 a91, 0
    v_accvgpr_write_b32 a92, 0
    v_accvgpr_write_b32 a93, 0
    v_accvgpr_write_b32 a94, 0
    v_accvgpr_write_b32 a95, 0
    v_accvgpr_write_b32 a96, 0
    v_accvgpr_write_b32 a97, 0
    v_accvgpr_write_b32 a98, 0
    v_accvgpr_write_b32 a99, 0
    v_accvgpr_write_b32 a100, 0
    v_accvgpr_write_b32 a101, 0
    v_accvgpr_write_b32 a102, 0
    v_accvgpr_write_b32 a103, 0
    v_accvgpr_write_b32 a104, 0
    v_accvgpr_write_b32 a105, 0
    v_accvgpr_write_b32 a106, 0
    v_accvgpr_write_b32 a107, 0
    v_accvgpr_write_b32 a108, 0
    v_accvgpr_write_b32 a109, 0
    v_accvgpr_write_b32 a110, 0
    v_accvgpr_write_b32 a111, 0
    v_accvgpr_write_b32 a112, 0
    v_accvgpr_write_b32 a113, 0
    v_accvgpr_write_b32 a114, 0
    v_accvgpr_write_b32 a115, 0
    v_accvgpr_write_b32 a116, 0
    v_accvgpr_write_b32 a117, 0
    v_accvgpr_write_b32 a118, 0
    v_accvgpr_write_b32 a119, 0
    v_accvgpr_write_b32 a120, 0
    v_accvgpr_write_b32 a121, 0
    v_accvgpr_write_b32 a122, 0
    v_accvgpr_write_b32 a123, 0
    v_accvgpr_write_b32 a124, 0
    v_accvgpr_write_b32 a125, 0
    v_accvgpr_write_b32 a126, 0
    v_accvgpr_write_b32 a127, 0
    v_mov_b32 v160, 0
    v_mov_b32 v161, 0
    v_mov_b32 v162, 0
    v_mov_b32 v163, 0
    v_mov_b32 v164, 0
    v_mov_b32 v165, 0
    v_mov_b32 v166, 0
    v_mov_b32 v167, 0
    v_mov_b32 v168, 0
    v_mov_b32 v169, 0
    v_mov_b32 v170, 0
    v_mov_b32 v171, 0
    v_mov_b32 v172, 0
    v_mov_b32 v173, 0
    v_mov_b32 v174, 0
    v_mov_b32 v175, 0
    v_mov_b32 v176, 0
    v_mov_b32 v177, 0
    v_mov_b32 v178, 0
    v_mov_b32 v179, 0
    v_mov_b32 v180, 0
    v_mov_b32 v181, 0
    v_mov_b32 v182, 0
    v_mov_b32 v183, 0
    v_mov_b32 v184, 0
    v_mov_b32 v185, 0
    v_mov_b32 v186, 0
    v_mov_b32 v187, 0
    v_mov_b32 v188, 0
    v_mov_b32 v189, 0
    v_mov_b32 v190, 0
    v_mov_b32 v191, 0
    v_mov_b32 v12, 0
    v_mov_b32 v28, 0
    v_mov_b32 v44, 0x3f803f80
    v_mov_b32 v13, 0
    v_mov_b32 v32, 0
    v_mov_b32 v45, 0x3f803f80
    v_mov_b32 v14, 0
    v_mov_b32 v36, 0
    v_mov_b32 v46, 0x3f803f80
    v_mov_b32 v15, 0
    v_mov_b32 v40, 0
    v_mov_b32 v47, 0x3f803f80
    s_and_b32 s90, s2, 7
    s_lshl_b32 s90, s90, 4
    s_lshl_b32 s91, s16, 2
    s_add_u32 s80, s90, s91
    s_lshr_b32 s92, s2, 3
    s_lshl_b32 s92, s92, 17
    s_lshl_b32 s90, s80, 10
    s_add_u32 s90, s90, s92
    s_add_u32 s83, s90, 50331648
    s_add_u32 s84, s90, 54525952
    s_and_b32 s81, s80, 63
    s_cmp_eq_u32 s81, 0
    s_cselect_b32 s93, 0, 1024
    s_sub_u32 s85, s84, s93
    s_lshl_b32 s90, s80, 9
    s_add_u32 s90, s90, s92
    s_add_u32 s86, s90, 58720256
    s_sub_u32 s87, s86, s93
    s_add_u32 s88, s86, 65536
    s_add_u32 s89, s87, 65536
    v_and_b32 v48, 15, v1
    v_lshrrev_b32 v49, 4, v1
    v_lshlrev_b32 v49, 2, v49
    v_sub_u32 v48, v48, v49
    v_cmp_le_i32 vcc, 0, v48
    s_nop 1
    v_cndmask_b32 v16, v9, 0, vcc
    v_cmp_le_i32 vcc, 1, v48
    s_nop 1
    v_cndmask_b32 v17, v9, 0, vcc
    v_cmp_le_i32 vcc, 2, v48
    s_nop 1
    v_cndmask_b32 v18, v9, 0, vcc
    v_cmp_le_i32 vcc, 3, v48
    s_nop 1
    v_cndmask_b32 v19, v9, 0, vcc
    s_mov_b32 s62, 35782688
    s_mov_b32 s63, 0
    s_sub_u32 s90, s67, 1
    s_bitset1_b64 s[62:63], s90
    s_sub_u32 s90, s68, 1
    s_bitset1_b64 s[62:63], s90
    s_sub_u32 s90, s69, 1
    s_bitset1_b64 s[62:63], s90
    s_sub_u32 s90, s70, 1
    s_bitset1_b64 s[62:63], s90
    s_sub_u32 s90, s71, 1
    s_bitset1_b64 s[62:63], s90
    s_sub_u32 s90, s72, 1
    s_bitset1_b64 s[62:63], s90
    s_add_u32 s53, s69, 6
    s_sub_u32 s90, s53, 1
    s_bitset1_b64 s[62:63], s90
    s_mov_b32 s64, 0
    s_cmp_lg_u32 s64, s67
    s_cbranch_scc1 m_e68
    v_add_f32 v176, v176, v16
    v_mov_b32 v180, v9
    v_add_f32 v188, v188, v16
    v_add_f32 v177, v177, v17
    v_mov_b32 v181, v9
    v_add_f32 v189, v189, v17
    v_add_f32 v178, v178, v18
    v_mov_b32 v182, v9
    v_add_f32 v190, v190, v18
    v_add_f32 v179, v179, v19
    v_mov_b32 v183, v9
    v_add_f32 v191, v191, v19
    s_nop 0
m_e68:
    s_waitcnt vmcnt(24) lgkmcnt(0)
    s_barrier
    ds_read_b128 a[192:195], v6 offset:0
    ds_read_b128 a[196:199], v6 offset:1024
    ds_read_b128 a[200:203], v6 offset:2048
    ds_read_b128 a[204:207], v6 offset:3072
    ds_read_b128 a[208:211], v6 offset:4096
    ds_read_b128 a[212:215], v6 offset:5120
    ds_read_b128 a[216:219], v6 offset:6144
    ds_read_b128 a[220:223], v6 offset:7168
    s_waitcnt lgkmcnt(0)
    v_mfma_f32_16x16x32_bf16 v[64:67], a[192:195], a[128:131], v[160:163]
    v_mfma_f32_16x16x32_bf16 v[64:67], a[196:199], a[132:135], v[64:67]
    buffer_store_dwordx4 v[192:195], v2, s[36:39], s40 offen sc1
    s_add_u32 s40, s40, s100
    v_mfma_f32_16x16x32_bf16 v[64:67], a[200:203], a[136:139], v[64:67]
    v_mfma_f32_16x16x32_bf16 v[64:67], a[204:207], a[140:143], v[64:67]
    v_mfma_f32_16x16x32_bf16 v[72:75], a[192:195], a[144:147], v[168:171]
    v_mfma_f32_16x16x32_bf16 v[72:75], a[196:199], a[148:151], v[72:75]
    buffer_store_dwordx4 v[196:199], v2, s[36:39], s40 offen sc1
    s_add_u32 s40, s40, s100
    v_mfma_f32_16x16x32_bf16 v[72:75], a[200:203], a[152:155], v[72:75]
    v_mfma_f32_16x16x32_bf16 v[72:75], a[204:207], a[156:159], v[72:75]
    v_mfma_f32_16x16x32_bf16 v[80:83], a[192:195], a[160:163], v[176:179]
    v_mfma_f32_16x16x32_bf16 v[80:83], a[196:199], a[164:167], v[80:83]
    buffer_store_dwordx4 v[200:203], v2, s[36:39], s40 offen sc1
    s_add_u32 s40, s40, s100
    v_mfma_f32_16x16x32_bf16 v[80:83], a[200:203], a[168:171], v[80:83]
    v_mfma_f32_16x16x32_bf16 v[80:83], a[204:207], a[172:175], v[80:83]
    v_mfma_f32_16x16x32_bf16 v[88:91], a[192:195], a[176:179], v[184:187]
    v_mfma_f32_16x16x32_bf16 v[88:91], a[196:199], a[180:183], v[88:91]
    buffer_store_dwordx4 v[204:207], v2, s[36:39], s40 offen sc1
    s_add_u32 s40, s98, s99
    v_mfma_f32_16x16x32_bf16 v[88:91], a[200:203], a[184:187], v[88:91]
    v_mfma_f32_16x16x32_bf16 v[88:91], a[204:207], a[188:191], v[88:91]
    v_mfma_f32_16x16x32_bf16 v[68:71], a[208:211], a[128:131], v[164:167]
    ds_read_b128 a[192:195], v6 offset:8192
    v_mfma_f32_16x16x32_bf16 v[68:71], a[212:215], a[132:135], v[68:71]
    buffer_store_dwordx4 v[208:211], v2, s[36:39], s40 offen sc1
    s_add_u32 s40, s40, s100
    ds_read_b128 a[196:199], v6 offset:9216
    v_mfma_f32_16x16x32_bf16 v[68:71], a[216:219], a[136:139], v[68:71]
    ds_read_b128 a[200:203], v6 offset:10240
    v_mfma_f32_16x16x32_bf16 v[68:71], a[220:223], a[140:143], v[68:71]
    ds_read_b128 a[204:207], v6 offset:11264
    v_mfma_f32_16x16x32_bf16 v[76:79], a[208:211], a[144:147], v[172:175]
    v_mfma_f32_16x16x32_bf16 v[76:79], a[212:215], a[148:151], v[76:79]
    buffer_store_dwordx4 v[212:215], v2, s[36:39], s40 offen sc1
    s_add_u32 s40, s40, s100
    v_mfma_f32_16x16x32_bf16 v[76:79], a[216:219], a[152:155], v[76:79]
    v_mfma_f32_16x16x32_bf16 v[76:79], a[220:223], a[156:159], v[76:79]
    v_mfma_f32_16x16x32_bf16 v[84:87], a[208:211], a[160:163], v[180:183]
    v_mfma_f32_16x16x32_bf16 v[84:87], a[212:215], a[164:167], v[84:87]
    buffer_store_dwordx4 v[216:219], v2, s[36:39], s40 offen sc1
    s_add_u32 s40, s40, s100
    v_mfma_f32_16x16x32_bf16 v[84:87], a[216:219], a[168:171], v[84:87]
    v_mfma_f32_16x16x32_bf16 v[84:87], a[220:223], a[172:175], v[84:87]
    v_mfma_f32_16x16x32_bf16 v[92:95], a[208:211], a[176:179], v[188:191]
    v_mfma_f32_16x16x32_bf16 v[92:95], a[212:215], a[180:183], v[92:95]
    buffer_store_dwordx4 v[220:223], v2, s[36:39], s40 offen sc1
    s_add_u32 s40, s40, s100
    v_mfma_f32_16x16x32_bf16 v[92:95], a[216:219], a[184:187], v[92:95]
    v_mfma_f32_16x16x32_bf16 v[92:95], a[220:223], a[188:191], v[92:95]
    ds_read_b128 a[208:211], v6 offset:12288
    ds_read_b128 a[212:215], v6 offset:13312
    ds_read_b128 a[216:219], v6 offset:14336
    ds_read_b128 a[220:223], v6 offset:15360
    s_mov_b32 s64, 1
    s_nop 0
    s_nop 3
    v_max3_f32 v48, v64, v65, v66
    v_max3_f32 v49, v72, v73, v74
    v_max3_f32 v50, v80, v81, v82
    v_max3_f32 v51, v88, v89, v90
    v_max3_f32 v48, v48, v67, v68
    v_max3_f32 v49, v49, v75, v76
    v_max3_f32 v50, v50, v83, v84
    v_max3_f32 v51, v51, v91, v92
    v_max3_f32 v48, v48, v69, v70
    v_max3_f32 v49, v49, v77, v78
    v_max3_f32 v50, v50, v85, v86
    v_max3_f32 v51, v51, v93, v94
    v_max_f32 v48, v48, v71
    v_max_f32 v49, v49, v79
    v_max_f32 v50, v50, v87
    v_max_f32 v51, v51, v95
    v_mov_b32 v52, v48
    v_mov_b32 v53, v49
    v_mov_b32 v54, v50
    v_mov_b32 v55, v51
    s_nop 1
    v_permlane32_swap_b32 v48, v52
    v_permlane32_swap_b32 v49, v53
    v_permlane32_swap_b32 v50, v54
    v_permlane32_swap_b32 v51, v55
    s_nop 1
    v_max_f32 v48, v48, v52
    v_max_f32 v49, v49, v53
    v_max_f32 v50, v50, v54
    v_max_f32 v51, v51, v55
    v_mov_b32 v52, v48
    v_mov_b32 v53, v49
    v_mov_b32 v54, v50
    v_mov_b32 v55, v51
    s_nop 1
    v_permlane16_swap_b32 v48, v52
    v_permlane16_swap_b32 v49, v53
    v_permlane16_swap_b32 v50, v54
    v_permlane16_swap_b32 v51, v55
    s_nop 1
    v_max_f32 v48, v48, v52
    v_max_f32 v49, v49, v53
    v_max_f32 v50, v50, v54
    v_max_f32 v51, v51, v55
    v_sub_f32 v160, v160, v48
    v_sub_f32 v161, v161, v48
    v_sub_f32 v162, v162, v48
    v_sub_f32 v163, v163, v48
    v_sub_f32 v164, v164, v48
    v_sub_f32 v165, v165, v48
    v_sub_f32 v166, v166, v48
    v_sub_f32 v167, v167, v48
    v_sub_f32 v168, v168, v49
    v_sub_f32 v169, v169, v49
    v_sub_f32 v170, v170, v49
    v_sub_f32 v171, v171, v49
    v_sub_f32 v172, v172, v49
    v_sub_f32 v173, v173, v49
    v_sub_f32 v174, v174, v49
    v_sub_f32 v175, v175, v49
    v_sub_f32 v176, v176, v50
    v_sub_f32 v177, v177, v50
    v_sub_f32 v178, v178, v50
    v_sub_f32 v179, v179, v50
    v_sub_f32 v180, v180, v50
    v_sub_f32 v181, v181, v50
    v_sub_f32 v182, v182, v50
    v_sub_f32 v183, v183, v50
    v_sub_f32 v184, v184, v51
    v_sub_f32 v185, v185, v51
    v_sub_f32 v186, v186, v51
    v_sub_f32 v187, v187, v51
    v_sub_f32 v188, v188, v51
    v_sub_f32 v189, v189, v51
    v_sub_f32 v190, v190, v51
    v_sub_f32 v191, v191, v51
    v_sub_f32 v64, v64, v48
    v_sub_f32 v65, v65, v48
    v_sub_f32 v66, v66, v48
    v_sub_f32 v67, v67, v48
    v_sub_f32 v68, v68, v48
    v_sub_f32 v69, v69, v48
    v_sub_f32 v70, v70, v48
    v_sub_f32 v71, v71, v48
    v_sub_f32 v72, v72, v49
    v_sub_f32 v73, v73, v49
    v_sub_f32 v74, v74, v49
    v_sub_f32 v75, v75, v49
    v_sub_f32 v76, v76, v49
    v_sub_f32 v77, v77, v49
    v_sub_f32 v78, v78, v49
    v_sub_f32 v79, v79, v49
    v_sub_f32 v80, v80, v50
    v_sub_f32 v81, v81, v50
    v_sub_f32 v82, v82, v50
    v_sub_f32 v83, v83, v50
    v_sub_f32 v84, v84, v50
    v_sub_f32 v85, v85, v50
    v_sub_f32 v86, v86, v50
    v_sub_f32 v87, v87, v50
    v_sub_f32 v88, v88, v51
    v_sub_f32 v89, v89, v51
    v_sub_f32 v90, v90, v51
    v_sub_f32 v91, v91, v51
    v_sub_f32 v92, v92, v51
    v_sub_f32 v93, v93, v51
    v_sub_f32 v94, v94, v51
    v_sub_f32 v95, v95, v51
    s_cmp_lg_u32 s64, s67
    s_cbranch_scc1 m_e69
    v_add_f32 v176, v176, v16
    v_mov_b32 v180, v9
    v_add_f32 v188, v188, v16
    v_add_f32 v177, v177, v17
    v_mov_b32 v181, v9
    v_add_f32 v189, v189, v17
    v_add_f32 v178, v178, v18
    v_mov_b32 v182, v9
    v_add_f32 v190, v190, v18
    v_add_f32 v179, v179, v19
    v_mov_b32 v183, v9
    v_add_f32 v191, v191, v19
    s_nop 0
m_e69:
    s_cmp_lg_u32 s64, s68
    s_cbranch_scc1 m_e70
    v_mov_b32 v176, v9
    v_mov_b32 v184, v9
    v_mov_b32 v188, v9
    v_mov_b32 v177, v9
    v_mov_b32 v185, v9
    v_mov_b32 v189, v9
    v_mov_b32 v178, v9
    v_mov_b32 v186, v9
    v_mov_b32 v190, v9
    v_mov_b32 v179, v9
    v_mov_b32 v187, v9
    v_mov_b32 v191, v9
    s_nop 0
m_e70:
    s_waitcnt lgkmcnt(0)
    v_mfma_f32_16x16x32_bf16 v[96:99], a[192:195], a[128:131], v[160:163]
    s_bitcmp1_b64 s[62:63], s64
    s_cselect_b32 s66, -1.0, s65
    v_exp_f32 v20, v64
    v_mfma_f32_16x16x32_bf16 v[96:99], a[196:199], a[132:135], v[96:99]
    s_add_u32 s64, s64, 1
    v_exp_f32 v21, v65
    v_exp_f32 v22, v66
    v_mfma_f32_16x16x32_bf16 v[96:99], a[200:203], a[136:139], v[96:99]
    buffer_store_dwordx4 v[224:227], v2, s[36:39], s40 offen sc1
    v_cvt_pk_bf16_f32 v128, v20, v21
    v_mfma_f32_16x16x32_bf16 v[96:99], a[204:207], a[140:143], v[96:99]
    s_add_u32 s40, s40, s100
    v_add_f32 v12, v12, v28
    v_exp_f32 v23, v67
    v_mfma_f32_16x16x32_bf16 v[104:107], a[192:195], a[144:147], v[168:171]
    v_exp_f32 v24, v68
    v_cvt_pk_bf16_f32 v129, v22, v23
    v_mfma_f32_16x16x32_bf16 v[104:107], a[196:199], a[148:151], v[104:107]
    buffer_store_dwordx4 v[228:231], v2, s[36:39], s40 offen sc1
    v_exp_f32 v25, v69
    v_mfma_f32_16x16x32_bf16 v[104:107], a[200:203], a[152:155], v[104:107]
    s_add_u32 s40, s40, s100
    v_exp_f32 v26, v70
    v_cvt_pk_bf16_f32 v130, v24, v25
    v_mfma_f32_16x16x32_bf16 v[104:107], a[204:207], a[156:159], v[104:107]
    v_exp_f32 v27, v71
    v_add_f32 v13, v13, v32
    v_mfma_f32_16x16x32_bf16 v[112:115], a[192:195], a[160:163], v[176:179]
    v_exp_f32 v20, v72
    v_cvt_pk_bf16_f32 v131, v26, v27
    v_mfma_f32_16x16x32_bf16 v[112:115], a[196:199], a[164:167], v[112:115]
    buffer_store_dwordx4 v[232:235], v2, s[36:39], s40 offen sc1
    v_exp_f32 v21, v73
    v_mfma_f32_16x16x32_bf16 v[28:31], v[44:47], v[128:131], 0
    v_exp_f32 v22, v74
    v_cvt_pk_bf16_f32 v132, v20, v21
    v_mfma_f32_16x16x32_bf16 v[112:115], a[200:203], a[168:171], v[112:115]
    s_add_u32 s40, s40, s100
    v_exp_f32 v23, v75
    v_add_f32 v14, v14, v36
    v_mfma_f32_16x16x32_bf16 v[112:115], a[204:207], a[172:175], v[112:115]
    v_exp_f32 v24, v76
    v_cvt_pk_bf16_f32 v133, v22, v23
    v_mfma_f32_16x16x32_bf16 v[120:123], a[192:195], a[176:179], v[184:187]
    buffer_store_dwordx4 v[236:239], v2, s[36:39], s40 offen sc1
    v_exp_f32 v25, v77
    v_mfma_f32_16x16x32_bf16 v[120:123], a[196:199], a[180:183], v[120:123]
    s_mov_b32 s40, s98
    v_exp_f32 v26, v78
    v_cvt_pk_bf16_f32 v134, v24, v25
    v_mfma_f32_16x16x32_bf16 v[120:123], a[200:203], a[184:187], v[120:123]
    v_exp_f32 v27, v79
    v_add_f32 v15, v15, v40
    v_mfma_f32_16x16x32_bf16 v[120:123], a[204:207], a[188:191], v[120:123]
    s_waitcnt lgkmcnt(0)
    v_exp_f32 v20, v80
    v_cvt_pk_bf16_f32 v135, v26, v27
    v_mfma_f32_16x16x32_bf16 v[100:103], a[208:211], a[128:131], v[164:167]
    v_exp_f32 v21, v81
    v_exp_f32 v22, v82
    v_mfma_f32_16x16x32_bf16 v[32:35], v[44:47], v[132:135], 0
    v_cvt_pk_bf16_f32 v136, v20, v21
    v_exp_f32 v23, v83
    v_mfma_f32_16x16x32_bf16 v[100:103], a[212:215], a[132:135], v[100:103]
    buffer_store_dwordx4 v[240:243], v2, s[36:39], s40 offen sc1
    v_cvt_pk_bf16_f32 v137, v22, v23
    v_mfma_f32_16x16x32_bf16 v[100:103], a[216:219], a[136:139], v[100:103]
    s_add_u32 s40, s40, s100
    v_exp_f32 v24, v84
    v_mfma_f32_16x16x32_bf16 v[100:103], a[220:223], a[140:143], v[100:103]
    v_exp_f32 v25, v85
    v_exp_f32 v26, v86
    v_cvt_pk_bf16_f32 v138, v24, v25
    v_mfma_f32_16x16x32_bf16 v[108:111], a[208:211], a[144:147], v[172:175]
    buffer_store_dwordx4 v[244:247], v2, s[36:39], s40 offen sc1
    v_mfma_f32_16x16x32_bf16 v[108:111], a[212:215], a[148:151], v[108:111]
    s_add_u32 s40, s40, s100
    v_exp_f32 v27, v87
    v_exp_f32 v20, v88
    v_mfma_f32_16x16x32_bf16 v[108:111], a[216:219], a[152:155], v[108:111]
    v_cvt_pk_bf16_f32 v139, v26, v27
    v_exp_f32 v21, v89
    v_mfma_f32_16x16x32_bf16 v[108:111], a[220:223], a[156:159], v[108:111]
    buffer_store_dwordx4 v[248:251], v2, s[36:39], s40 offen sc1
    v_exp_f32 v22, v90
    v_mfma_f32_16x16x32_bf16 v[36:39], v[44:47], v[136:139], 0
    v_cvt_pk_bf16_f32 v140, v20, v21
    v_exp_f32 v23, v91
    v_mfma_f32_16x16x32_bf16 v[116:119], a[208:211], a[160:163], v[180:183]
    s_add_u32 s40, s40, s100
    v_exp_f32 v24, v92
    v_cvt_pk_bf16_f32 v141, v22, v23
    v_mfma_f32_16x16x32_bf16 v[116:119], a[212:215], a[164:167], v[116:119]
    v_exp_f32 v25, v93
    v_mfma_f32_16x16x32_bf16 v[116:119], a[216:219], a[168:171], v[116:119]
    buffer_store_dwordx4 v[252:255], v2, s[36:39], s40 offen sc1
    v_exp_f32 v26, v94
    v_cvt_pk_bf16_f32 v142, v24, v25
    v_mfma_f32_16x16x32_bf16 v[116:119], a[220:223], a[172:175], v[116:119]
    s_add_u32 s40, s40, s100
    v_exp_f32 v27, v95
    s_nop 0
    v_cvt_pk_bf16_f32 v143, v26, v27
    s_nop 1
    v_mfma_f32_16x16x32_bf16 v[40:43], v[44:47], v[140:143], 0
    s_nop 2
    v_mfma_f32_16x16x32_bf16 v[124:127], a[208:211], a[176:179], v[188:191]
    s_nop 2
    v_mfma_f32_16x16x32_bf16 v[124:127], a[212:215], a[180:183], v[124:127]
    v_max3_f32 v8, v28, v32, v36
    v_max_f32 v8, v8, v40
    v_mfma_f32_16x16x32_bf16 v[124:127], a[216:219], a[184:187], v[124:127]
    v_cmp_nge_f32 vcc, s66, v8
    v_mfma_f32_16x16x32_bf16 v[124:127], a[220:223], a[188:191], v[124:127]
    s_waitcnt vmcnt(40) lgkmcnt(0)
    s_barrier
    s_add_u32 s59, s58, s60
    s_add_u32 s58, s58, 32768
    s_and_b32 s58, s58, 0x1ffff
    v_add_u32 v6, s58, v2
    ds_read_b128 a[192:195], v6 offset:0
    ds_read_b128 a[196:199], v6 offset:1024
    ds_read_b128 a[200:203], v6 offset:2048
    ds_read_b128 a[204:207], v6 offset:3072
    ds_read_b128 a[208:211], v6 offset:4096
    ds_read_b128 a[212:215], v6 offset:5120
    ds_read_b128 a[216:219], v6 offset:6144
    ds_read_b128 a[220:223], v6 offset:7168
    s_waitcnt lgkmcnt(0)
    s_cbranch_vccnz m_stub71
m_ret72:
m_dual73:
    v_mfma_f32_16x16x32_bf16 v[64:67], a[192:195], a[128:131], v[160:163]
    s_bitcmp1_b64 s[62:63], s64
    s_cselect_b32 s66, -1.0, s65
    v_add_f32 v12, v12, v28
    v_mfma_f32_16x16x32_bf16 v[64:67], a[196:199], a[132:135], v[64:67]
    s_add_u32 s64, s64, 1
    ds_read_b128 a[224:227], v6 offset:16384
    v_add_f32 v13, v13, v32
    v_mfma_f32_16x16x32_bf16 v[64:67], a[200:203], a[136:139], v[64:67]
    v_exp_f32 v20, v96
    v_mfma_f32_16x16x32_bf16 v[64:67], a[204:207], a[140:143], v[64:67]
    v_exp_f32 v21, v97
    v_mfma_f32_16x16x32_bf16 v[72:75], a[192:195], a[144:147], v[168:171]
    s_mov_b32 m0, s59
    ds_read_b128 a[228:231], v6 offset:17408
    v_cvt_pk_bf16_f32 v144, v20, v21
    v_mfma_f32_16x16x32_bf16 v[72:75], a[196:199], a[148:151], v[72:75]
    buffer_load_dwordx4 v7, s[24:27], s56 offen offset:0 sc1 lds
    v_mfma_f32_16x16x32_bf16 v[72:75], a[200:203], a[152:155], v[72:75]
    v_exp_f32 v22, v98
    v_mfma_f32_16x16x32_bf16 v[72:75], a[204:207], a[156:159], v[72:75]
    ds_read_b128 a[232:235], v6 offset:18432
    v_add_f32 v14, v14, v36
    v_mfma_f32_16x16x32_bf16 v[80:83], a[192:195], a[160:163], v[176:179]
    v_exp_f32 v23, v99
    v_mfma_f32_16x16x32_bf16 v[80:83], a[196:199], a[164:167], v[80:83]
    v_exp_f32 v24, v100
    v_mfma_f32_16x16x32_bf16 v[80:83], a[200:203], a[168:171], v[80:83]
    ds_read_b128 a[236:239], v6 offset:19456
    v_cvt_pk_bf16_f32 v145, v22, v23
    v_mfma_f32_16x16x32_bf16 v[80:83], a[204:207], a[172:175], v[80:83]
    v_exp_f32 v25, v101
    v_mfma_f32_16x16x32_bf16 v[88:91], a[192:195], a[176:179], v[184:187]
    v_exp_f32 v26, v102
    v_mfma_f32_16x16x32_bf16 v[88:91], a[196:199], a[180:183], v[88:91]
    ds_read_b128 a[240:243], v6 offset:20480
    v_cvt_pk_bf16_f32 v146, v24, v25
    v_mfma_f32_16x16x32_bf16 v[88:91], a[200:203], a[184:187], v[88:91]
    v_exp_f32 v27, v103
    v_mfma_f32_16x16x32_bf16 v[88:91], a[204:207], a[188:191], v[88:91]
    s_waitcnt lgkmcnt(5)
    v_exp_f32 v20, v104
    v_mfma_f32_16x16x32_bf16 v[68:71], a[208:211], a[128:131], v[164:167]
    ds_read_b128 a[244:247], v6 offset:21504
    v_cvt_pk_bf16_f32 v147, v26, v27
    v_mfma_f32_16x16x32_bf16 v[68:71], a[212:215], a[132:135], v[68:71]
    v_exp_f32 v21, v105
    v_mfma_f32_16x16x32_bf16 v[28:31], v[44:47], v[144:147], 0
    v_exp_f32 v22, v106
    v_mfma_f32_16x16x32_bf16 v[68:71], a[216:219], a[136:139], v[68:71]
    buffer_load_dwordx4 v7, s[24:27], s56 offen offset:1024 sc1 lds
    v_mfma_f32_16x16x32_bf16 v[68:71], a[220:223], a[140:143], v[68:71]
    ds_read_b128 a[248:251], v6 offset:22528
    v_cvt_pk_bf16_f32 v148, v20, v21
    v_mfma_f32_16x16x32_bf16 v[76:79], a[208:211], a[144:147], v[172:175]
    v_exp_f32 v23, v107
    v_mfma_f32_16x16x32_bf16 v[76:79], a[212:215], a[148:151], v[76:79]
    v_exp_f32 v24, v108
    v_mfma_f32_16x16x32_bf16 v[76:79], a[216:219], a[152:155], v[76:79]
    ds_read_b128 a[252:255], v6 offset:23552
    v_cvt_pk_bf16_f32 v149, v22, v23
    v_mfma_f32_16x16x32_bf16 v[76:79], a[220:223], a[156:159], v[76:79]
    v_exp_f32 v25, v109
    v_mfma_f32_16x16x32_bf16 v[84:87], a[208:211], a[160:163], v[180:183]
    v_exp_f32 v26, v110
    v_mfma_f32_16x16x32_bf16 v[84:87], a[212:215], a[164:167], v[84:87]
    v_cvt_pk_bf16_f32 v150, v24, v25
    v_add_f32 v15, v15, v40
    v_mfma_f32_16x16x32_bf16 v[84:87], a[216:219], a[168:171], v[84:87]
    v_exp_f32 v27, v111
    v_mfma_f32_16x16x32_bf16 v[84:87], a[220:223], a[172:175], v[84:87]
    buffer_load_dwordx4 v7, s[24:27], s56 offen offset:2048 sc1 lds
    v_mfma_f32_16x16x32_bf16 v[92:95], a[208:211], a[176:179], v[188:191]
    v_exp_f32 v20, v112
    v_mfma_f32_16x16x32_bf16 v[92:95], a[212:215], a[180:183], v[92:95]
    v_cvt_pk_bf16_f32 v151, v26, v27
    v_mfma_f32_16x16x32_bf16 v[92:95], a[216:219], a[184:187], v[92:95]
    v_exp_f32 v21, v113
    v_mfma_f32_16x16x32_bf16 v[32:35], v[44:47], v[148:151], 0
    v_exp_f32 v22, v114
    v_mfma_f32_16x16x32_bf16 v[92:95], a[220:223], a[188:191], v[92:95]
    s_waitcnt lgkmcnt(0)
    v_cvt_pk_bf16_f32 v152, v20, v21
    v_mfma_f32_16x16x32_bf16 a[0:3], a[224:227], v[128:131], a[0:3]
    ds_read_b128 a[192:195], v6 offset:8192
    v_mfma_f32_16x16x32_bf16 a[32:35], a[224:227], v[132:135], a[32:35]
    v_exp_f32 v23, v115
    v_mfma_f32_16x16x32_bf16 a[64:67], a[224:227], v[136:139], a[64:67]
    v_exp_f32 v24, v116
    v_mfma_f32_16x16x32_bf16 a[96:99], a[224:227], v[140:143], a[96:99]
    ds_read_b128 a[196:199], v6 offset:9216
    v_cvt_pk_bf16_f32 v153, v22, v23
    v_mfma_f32_16x16x32_bf16 a[4:7], a[228:231], v[128:131], a[4:7]
    v_exp_f32 v25, v117
    v_mfma_f32_16x16x32_bf16 a[36:39], a[228:231], v[132:135], a[36:39]
    v_exp_f32 v26, v118
    v_mfma_f32_16x16x32_bf16 a[68:71], a[228:231], v[136:139], a[68:71]
    ds_read_b128 a[200:203], v6 offset:10240
    v_cvt_pk_bf16_f32 v154, v24, v25
    v_mfma_f32_16x16x32_bf16 a[100:103], a[228:231], v[140:143], a[100:103]
    v_exp_f32 v27, v119
    v_mfma_f32_16x16x32_bf16 a[8:11], a[232:235], v[128:131], a[8:11]
    v_exp_f32 v20, v120
    v_mfma_f32_16x16x32_bf16 a[40:43], a[232:235], v[132:135], a[40:43]
    ds_read_b128 a[204:207], v6 offset:11264
    v_cvt_pk_bf16_f32 v155, v26, v27
    v_mfma_f32_16x16x32_bf16 a[72:75], a[232:235], v[136:139], a[72:75]
    v_exp_f32 v21, v121
    v_mfma_f32_16x16x32_bf16 v[36:39], v[44:47], v[152:155], 0
    v_exp_f32 v22, v122
    v_mfma_f32_16x16x32_bf16 a[104:107], a[232:235], v[140:143], a[104:107]
    buffer_load_dwordx4 v7, s[24:27], s56 offen offset:3072 sc1 lds
    v_mfma_f32_16x16x32_bf16 a[12:15], a[236:239], v[128:131], a[12:15]
    s_add_u32 s56, s56, 16384
    v_cvt_pk_bf16_f32 v156, v20, v21
    v_mfma_f32_16x16x32_bf16 a[44:47], a[236:239], v[132:135], a[44:47]
    v_exp_f32 v23, v123
    v_mfma_f32_16x16x32_bf16 a[76:79], a[236:239], v[136:139], a[76:79]
    v_exp_f32 v24, v124
    v_mfma_f32_16x16x32_bf16 a[108:111], a[236:239], v[140:143], a[108:111]
    v_cvt_pk_bf16_f32 v157, v22, v23
    v_mfma_f32_16x16x32_bf16 a[16:19], a[240:243], v[128:131], a[16:19]
    v_exp_f32 v25, v125
    v_mfma_f32_16x16x32_bf16 a[48:51], a[240:243], v[132:135], a[48:51]
    v_exp_f32 v26, v126
    v_mfma_f32_16x16x32_bf16 a[80:83], a[240:243], v[136:139], a[80:83]
    v_cvt_pk_bf16_f32 v158, v24, v25
    v_mfma_f32_16x16x32_bf16 a[112:115], a[240:243], v[140:143], a[112:115]
    s_add_u32 m0, s59, 16384
    v_exp_f32 v27, v127
    v_mfma_f32_16x16x32_bf16 a[20:23], a[244:247], v[128:131], a[20:23]
    buffer_load_dwordx4 v7, s[28:31], s57 offen offset:0 sc1 lds
    v_mfma_f32_16x16x32_bf16 a[52:55], a[244:247], v[132:135], a[52:55]
    v_cvt_pk_bf16_f32 v159, v26, v27
    v_mfma_f32_16x16x32_bf16 a[84:87], a[244:247], v[136:139], a[84:87]
    v_mfma_f32_16x16x32_bf16 a[116:119], a[244:247], v[140:143], a[116:119]
    v_mfma_f32_16x16x32_bf16 v[40:43], v[44:47], v[156:159], 0
    s_nop 2
    v_mfma_f32_16x16x32_bf16 a[24:27], a[248:251], v[128:131], a[24:27]
    s_nop 2
    v_mfma_f32_16x16x32_bf16 a[56:59], a[248:251], v[132:135], a[56:59]
    v_max3_f32 v8, v28, v32, v36
    v_max_f32 v8, v8, v40
    v_mfma_f32_16x16x32_bf16 a[88:91], a[248:251], v[136:139], a[88:91]
    v_cmp_nge_f32 vcc, s66, v8
    v_mfma_f32_16x16x32_bf16 a[120:123], a[248:251], v[140:143], a[120:123]
    ds_read_b128 a[208:211], v6 offset:12288
    v_mfma_f32_16x16x32_bf16 a[28:31], a[252:255], v[128:131], a[28:31]
    ds_read_b128 a[212:215], v6 offset:13312
    v_mfma_f32_16x16x32_bf16 a[60:63], a[252:255], v[132:135], a[60:63]
    ds_read_b128 a[216:219], v6 offset:14336
    v_mfma_f32_16x16x32_bf16 a[92:95], a[252:255], v[136:139], a[92:95]
    ds_read_b128 a[220:223], v6 offset:15360
    v_mfma_f32_16x16x32_bf16 a[124:127], a[252:255], v[140:143], a[124:127]
    s_waitcnt lgkmcnt(4)
    s_cbranch_vccnz m_stub74
m_ret75:
    v_mfma_f32_16x16x32_bf16 v[96:99], a[192:195], a[128:131], v[160:163]
    s_add_u32 s59, s58, s60
    v_exp_f32 v20, v64
    v_mfma_f32_16x16x32_bf16 v[96:99], a[196:199], a[132:135], v[96:99]
    s_add_u32 s58, s58, 32768
    ds_read_b128 a[224:227], v6 offset:24576
    v_add_f32 v12, v12, v28
    v_mfma_f32_16x16x32_bf16 v[96:99], a[200:203], a[136:139], v[96:99]
    s_and_b32 s58, s58, 0x1ffff
    v_exp_f32 v21, v65
    v_mfma_f32_16x16x32_bf16 v[96:99], a[204:207], a[140:143], v[96:99]
    s_bitcmp1_b64 s[62:63], s64
    s_cselect_b32 s66, -1.0, s65
    v_cvt_pk_bf16_f32 v128, v20, v21
    v_mfma_f32_16x16x32_bf16 v[104:107], a[192:195], a[144:147], v[168:171]
    s_add_u32 s64, s64, 1
    ds_read_b128 a[228:231], v6 offset:25600
    v_add_f32 v13, v13, v32
    v_mfma_f32_16x16x32_bf16 v[104:107], a[196:199], a[148:151], v[104:107]
    v_exp_f32 v22, v66
    v_mfma_f32_16x16x32_bf16 v[104:107], a[200:203], a[152:155], v[104:107]
    buffer_load_dwordx4 v7, s[28:31], s57 offen offset:1024 sc1 lds
    v_mfma_f32_16x16x32_bf16 v[104:107], a[204:207], a[156:159], v[104:107]
    ds_read_b128 a[232:235], v6 offset:26624
    v_add_f32 v14, v14, v36
    v_mfma_f32_16x16x32_bf16 v[112:115], a[192:195], a[160:163], v[176:179]
    v_exp_f32 v23, v67
    v_mfma_f32_16x16x32_bf16 v[112:115], a[196:199], a[164:167], v[112:115]
    v_exp_f32 v24, v68
    v_mfma_f32_16x16x32_bf16 v[112:115], a[200:203], a[168:171], v[112:115]
    ds_read_b128 a[236:239], v6 offset:27648
    v_cvt_pk_bf16_f32 v129, v22, v23
    v_mfma_f32_16x16x32_bf16 v[112:115], a[204:207], a[172:175], v[112:115]
    v_exp_f32 v25, v69
    v_mfma_f32_16x16x32_bf16 v[120:123], a[192:195], a[176:179], v[184:187]
    v_exp_f32 v26, v70
    v_mfma_f32_16x16x32_bf16 v[120:123], a[196:199], a[180:183], v[120:123]
    ds_read_b128 a[240:243], v6 offset:28672
    v_cvt_pk_bf16_f32 v130, v24, v25
    v_mfma_f32_16x16x32_bf16 v[120:123], a[200:203], a[184:187], v[120:123]
    v_exp_f32 v27, v71
    v_mfma_f32_16x16x32_bf16 v[120:123], a[204:207], a[188:191], v[120:123]
    s_waitcnt lgkmcnt(5)
    v_exp_f32 v20, v72
    v_mfma_f32_16x16x32_bf16 v[100:103], a[208:211], a[128:131], v[164:167]
    ds_read_b128 a[244:247], v6 offset:29696
    v_cvt_pk_bf16_f32 v131, v26, v27
    v_mfma_f32_16x16x32_bf16 v[100:103], a[212:215], a[132:135], v[100:103]
    v_exp_f32 v21, v73
    v_mfma_f32_16x16x32_bf16 v[28:31], v[44:47], v[128:131], 0
    v_exp_f32 v22, v74
    v_mfma_f32_16x16x32_bf16 v[100:103], a[216:219], a[136:139], v[100:103]
    buffer_load_dwordx4 v7, s[28:31], s57 offen offset:2048 sc1 lds
    v_mfma_f32_16x16x32_bf16 v[100:103], a[220:223], a[140:143], v[100:103]
    ds_read_b128 a[248:251], v6 offset:30720
    v_cvt_pk_bf16_f32 v132, v20, v21
    v_mfma_f32_16x16x32_bf16 v[108:111], a[208:211], a[144:147], v[172:175]
    v_exp_f32 v23, v75
    v_mfma_f32_16x16x32_bf16 v[108:111], a[212:215], a[148:151], v[108:111]
    v_exp_f32 v24, v76
    v_mfma_f32_16x16x32_bf16 v[108:111], a[216:219], a[152:155], v[108:111]
    ds_read_b128 a[252:255], v6 offset:31744
    v_cvt_pk_bf16_f32 v133, v22, v23
    v_mfma_f32_16x16x32_bf16 v[108:111], a[220:223], a[156:159], v[108:111]
    v_exp_f32 v25, v77
    v_mfma_f32_16x16x32_bf16 v[116:119], a[208:211], a[160:163], v[180:183]
    v_exp_f32 v26, v78
    v_mfma_f32_16x16x32_bf16 v[116:119], a[212:215], a[164:167], v[116:119]
    v_cvt_pk_bf16_f32 v134, v24, v25
    v_add_f32 v15, v15, v40
    v_mfma_f32_16x16x32_bf16 v[116:119], a[216:219], a[168:171], v[116:119]
    v_exp_f32 v27, v79
    v_mfma_f32_16x16x32_bf16 v[116:119], a[220:223], a[172:175], v[116:119]
    buffer_load_dwordx4 v7, s[28:31], s57 offen offset:3072 sc1 lds
    v_mfma_f32_16x16x32_bf16 v[124:127], a[208:211], a[176:179], v[188:191]
    s_add_u32 s57, s57, 16384
    v_exp_f32 v20, v80
    v_mfma_f32_16x16x32_bf16 v[124:127], a[212:215], a[180:183], v[124:127]
    v_cvt_pk_bf16_f32 v135, v26, v27
    v_mfma_f32_16x16x32_bf16 v[124:127], a[216:219], a[184:187], v[124:127]
    v_exp_f32 v21, v81
    v_mfma_f32_16x16x32_bf16 v[32:35], v[44:47], v[132:135], 0
    v_exp_f32 v22, v82
    v_mfma_f32_16x16x32_bf16 v[124:127], a[220:223], a[188:191], v[124:127]
    s_waitcnt vmcnt(16) lgkmcnt(0)
    v_add_u32 v6, s58, v2
    v_cvt_pk_bf16_f32 v136, v20, v21
    v_mfma_f32_16x16x32_bf16 a[0:3], a[224:227], v[144:147], a[0:3]
    s_barrier
    v_mfma_f32_16x16x32_bf16 a[32:35], a[224:227], v[148:151], a[32:35]
    ds_read_b128 a[192:195], v6 offset:0
    v_mfma_f32_16x16x32_bf16 a[64:67], a[224:227], v[152:155], a[64:67]
    v_exp_f32 v23, v83
    v_mfma_f32_16x16x32_bf16 a[96:99], a[224:227], v[156:159], a[96:99]
    v_exp_f32 v24, v84
    v_mfma_f32_16x16x32_bf16 a[4:7], a[228:231], v[144:147], a[4:7]
    ds_read_b128 a[196:199], v6 offset:1024
    v_cvt_pk_bf16_f32 v137, v22, v23
    v_mfma_f32_16x16x32_bf16 a[36:39], a[228:231], v[148:151], a[36:39]
    v_exp_f32 v25, v85
    v_mfma_f32_16x16x32_bf16 a[68:71], a[228:231], v[152:155], a[68:71]
    v_exp_f32 v26, v86
    v_mfma_f32_16x16x32_bf16 a[100:103], a[228:231], v[156:159], a[100:103]
    ds_read_b128 a[200:203], v6 offset:2048
    v_cvt_pk_bf16_f32 v138, v24, v25
    v_mfma_f32_16x16x32_bf16 a[8:11], a[232:235], v[144:147], a[8:11]
    v_exp_f32 v27, v87
    v_mfma_f32_16x16x32_bf16 a[40:43], a[232:235], v[148:151], a[40:43]
    v_exp_f32 v20, v88
    v_mfma_f32_16x16x32_bf16 a[72:75], a[232:235], v[152:155], a[72:75]
    ds_read_b128 a[204:207], v6 offset:3072
    v_cvt_pk_bf16_f32 v139, v26, v27
    v_mfma_f32_16x16x32_bf16 a[104:107], a[232:235], v[156:159], a[104:107]
    v_exp_f32 v21, v89
    v_mfma_f32_16x16x32_bf16 v[36:39], v[44:47], v[136:139], 0
    v_exp_f32 v22, v90
    v_mfma_f32_16x16x32_bf16 a[12:15], a[236:239], v[144:147], a[12:15]
    v_cvt_pk_bf16_f32 v140, v20, v21
    v_mfma_f32_16x16x32_bf16 a[44:47], a[236:239], v[148:151], a[44:47]
    v_exp_f32 v23, v91
    v_mfma_f32_16x16x32_bf16 a[76:79], a[236:239], v[152:155], a[76:79]
    v_exp_f32 v24, v92
    v_mfma_f32_16x16x32_bf16 a[108:111], a[236:239], v[156:159], a[108:111]
    v_cvt_pk_bf16_f32 v141, v22, v23
    v_mfma_f32_16x16x32_bf16 a[16:19], a[240:243], v[144:147], a[16:19]
    v_exp_f32 v25, v93
    v_mfma_f32_16x16x32_bf16 a[48:51], a[240:243], v[148:151], a[48:51]
    v_exp_f32 v26, v94
    v_mfma_f32_16x16x32_bf16 a[80:83], a[240:243], v[152:155], a[80:83]
    v_cvt_pk_bf16_f32 v142, v24, v25
    v_mfma_f32_16x16x32_bf16 a[112:115], a[240:243], v[156:159], a[112:115]
    v_exp_f32 v27, v95
    v_mfma_f32_16x16x32_bf16 a[20:23], a[244:247], v[144:147], a[20:23]
    v_cvt_pk_bf16_f32 v143, v26, v27
    v_mfma_f32_16x16x32_bf16 a[52:55], a[244:247], v[148:151], a[52:55]
    v_mfma_f32_16x16x32_bf16 a[84:87], a[244:247], v[152:155], a[84:87]
    v_mfma_f32_16x16x32_bf16 v[40:43], v[44:47], v[140:143], 0
    s_nop 2
    v_mfma_f32_16x16x32_bf16 a[116:119], a[244:247], v[156:159], a[116:119]
    s_nop 2
    v_mfma_f32_16x16x32_bf16 a[24:27], a[248:251], v[144:147], a[24:27]
    v_max3_f32 v8, v28, v32, v36
    v_max_f32 v8, v8, v40
    v_mfma_f32_16x16x32_bf16 a[56:59], a[248:251], v[148:151], a[56:59]
    v_cmp_nge_f32 vcc, s66, v8
    v_mfma_f32_16x16x32_bf16 a[88:91], a[248:251], v[152:155], a[88:91]
    v_mfma_f32_16x16x32_bf16 a[120:123], a[248:251], v[156:159], a[120:123]
    ds_read_b128 a[208:211], v6 offset:4096
    v_mfma_f32_16x16x32_bf16 a[28:31], a[252:255], v[144:147], a[28:31]
    ds_read_b128 a[212:215], v6 offset:5120
    v_mfma_f32_16x16x32_bf16 a[60:63], a[252:255], v[148:151], a[60:63]
    ds_read_b128 a[216:219], v6 offset:6144
    v_mfma_f32_16x16x32_bf16 a[92:95], a[252:255], v[152:155], a[92:95]
    ds_read_b128 a[220:223], v6 offset:7168
    v_mfma_f32_16x16x32_bf16 a[124:127], a[252:255], v[156:159], a[124:127]
    s_waitcnt lgkmcnt(4)
    s_cbranch_vccz m_dual73
    v_cmp_lt_f32 vcc, s65, v8
    s_cmp_lg_u32 s64, s67
    s_cbranch_scc1 m_e77
    v_add_f32 v176, v176, v16
    v_mov_b32 v180, v9
    v_add_f32 v188, v188, v16
    v_add_f32 v177, v177, v17
    v_mov_b32 v181, v9
    v_add_f32 v189, v189, v17
    v_add_f32 v178, v178, v18
    v_mov_b32 v182, v9
    v_add_f32 v190, v190, v18
    v_add_f32 v179, v179, v19
    v_mov_b32 v183, v9
    v_add_f32 v191, v191, v19
    s_nop 0
m_e77:
    s_cmp_lg_u32 s64, s68
    s_cbranch_scc1 m_e78
    v_mov_b32 v176, v9
    v_mov_b32 v184, v9
    v_mov_b32 v188, v9
    v_mov_b32 v177, v9
    v_mov_b32 v185, v9
    v_mov_b32 v189, v9
    v_mov_b32 v178, v9
    v_mov_b32 v186, v9
    v_mov_b32 v190, v9
    v_mov_b32 v179, v9
    v_mov_b32 v187, v9
    v_mov_b32 v191, v9
    s_nop 0
m_e78:
    s_cmp_lg_u32 s64, s70
    s_cbranch_scc1 m_e79
    v_add_f32 v160, v160, v16
    v_mov_b32 v164, v9
    v_add_f32 v172, v172, v16
    v_add_f32 v161, v161, v17
    v_mov_b32 v165, v9
    v_add_f32 v173, v173, v17
    v_add_f32 v162, v162, v18
    v_mov_b32 v166, v9
    v_add_f32 v174, v174, v18
    v_add_f32 v163, v163, v19
    v_mov_b32 v167, v9
    v_add_f32 v175, v175, v19
    s_nop 0
m_e79:
    s_cmp_lg_u32 s64, s53
    s_cbranch_scc1 m_e82
    s_cmp_lg_u32 s16, 0
    s_cbranch_scc1 m_np83
    v_mov_b32 v60, s4
    v_mov_b32 v61, s5
    s_add_u32 s90, s17, 117440512
    s_mov_b64 exec, 1
    buffer_store_dwordx2 v[60:61], off, s[8:11], s90 sc1
    s_mov_b64 exec, -1
m_np83:
    s_mov_b32 s17, -1
m_e82:
    s_cmp_gt_u32 s64, 26
    s_cbranch_scc1 m_e80
    s_cmp_lg_u32 s64, 6
    s_cbranch_scc1 m_e84
    s_lshr_b32 s90, s32, 1
    s_lshl_b32 s90, s90, 7
    s_add_u32 s90, s90, 117440600
    v_min_u32 v0, 1, v1
    v_lshlrev_b32 v0, 5, v0
    buffer_load_dwordx2 v[4:5], v0, s[8:11], s90 offen sc1
    s_cmp_eq_u32 s17, -1
    s_cbranch_scc1 m_e80
    s_cmp_lg_u32 s16, 0
    s_cbranch_scc1 m_np85
    v_mov_b32 v60, s4
    v_mov_b32 v61, s5
    s_add_u32 s90, s17, 117440512
    s_mov_b64 exec, 1
    buffer_store_dwordx2 v[60:61], off, s[8:11], s90 sc1
    s_mov_b64 exec, -1
m_np85:
    s_branch m_e80
m_e84:
    s_cmp_lg_u32 s64, 18
    s_cbranch_scc1 m_e86
    s_waitcnt vmcnt(18)
    s_mov_b32 s3, 1048576
m_spin87:
    v_cmp_ne_u64 s[76:77], s[4:5], v[4:5]
    s_nop 3
    s_cmp_eq_u64 s[76:77], 0
    s_cbranch_scc1 m_e80
    s_sub_u32 s3, s3, 1
    s_cbranch_scc1 m_e80
    s_sleep 32
    s_lshr_b32 s90, s32, 1
    s_lshl_b32 s90, s90, 7
    s_add_u32 s90, s90, 117440600
    v_min_u32 v0, 1, v1
    v_lshlrev_b32 v0, 5, v0
    buffer_load_dwordx2 v[4:5], v0, s[8:11], s90 offen sc1
    s_waitcnt vmcnt(0)
    s_branch m_spin87
    s_branch m_e80
m_e86:
    s_cmp_lg_u32 s64, 22
    s_cbranch_scc1 m_e88
    buffer_load_dwordx2 v[4:5], v10, s[8:11], 0 offen sc1
    s_mov_b32 s44, s48
    s_mov_b32 s45, s49
    s_mov_b32 s46, 8388608
    s_lshl_b32 s90, s2, 2
    s_add_u32 s90, s90, s16
    s_lshl_b32 s90, s90, 13
    v_lshlrev_b32 v62, 7, v1
    buffer_load_dword v255, v62, s[44:47], s90 offen
    s_branch m_e80
m_e88:
    s_cmp_lg_u32 s64, 26
    s_cbranch_scc1 m_e89
    s_mov_b32 s44, s50
    s_mov_b32 s45, s51
    s_mov_b32 s46, 2097152
    s_lshl_b32 s90, s2, 2
    s_add_u32 s90, s90, s16
    s_lshl_b32 s90, s90, 13
    v_lshlrev_b32 v62, 7, v1
    buffer_load_dword v255, v62, s[44:47], s90 offen
    s_waitcnt vmcnt(18)
    s_mov_b32 s3, 1048576
m_spin90:
    v_cmp_ne_u64 s[76:77], s[4:5], v[4:5]
    s_nop 3
    s_cmp_eq_u64 s[76:77], 0
    s_cbranch_scc1 m_e80
    s_sub_u32 s3, s3, 1
    s_cbranch_scc1 m_e80
    s_sleep 32
    buffer_load_dwordx2 v[4:5], v10, s[8:11], 0 offen sc1
    s_waitcnt vmcnt(0)
    s_branch m_spin90
    s_branch m_e80
m_e89:
m_e80:
    s_cbranch_vccnz m_rc91
m_sp76:
    s_cmp_lg_u32 s64, s69
    s_cbranch_scc1 m_dual73
    v_mfma_f32_16x16x32_bf16 v[64:67], a[192:195], a[128:131], v[160:163]
    s_bitcmp1_b64 s[62:63], s64
    s_cselect_b32 s66, -1.0, s65
    v_add_f32 v12, v12, v28
    v_mfma_f32_16x16x32_bf16 v[64:67], a[196:199], a[132:135], v[64:67]
    s_add_u32 s64, s64, 1
    ds_read_b128 a[224:227], v6 offset:16384
    v_exp_f32 v20, v96
    v_mfma_f32_16x16x32_bf16 v[64:67], a[200:203], a[136:139], v[64:67]
    s_mov_b32 m0, s59
    ds_read_b128 a[228:231], v6 offset:17408
    v_add_f32 v13, v13, v32
    v_mfma_f32_16x16x32_bf16 v[64:67], a[204:207], a[140:143], v[64:67]
    buffer_load_dwordx4 v7, s[24:27], s56 offen offset:0 sc1 lds
    v_mfma_f32_16x16x32_bf16 v[72:75], a[192:195], a[144:147], v[168:171]
    ds_read_b128 a[232:235], v6 offset:18432
    v_add_f32 v14, v14, v36
    v_mfma_f32_16x16x32_bf16 v[72:75], a[196:199], a[148:151], v[72:75]
    ds_read_b128 a[236:239], v6 offset:19456
    v_exp_f32 v21, v97
    v_mfma_f32_16x16x32_bf16 v[72:75], a[200:203], a[152:155], v[72:75]
    ds_read_b128 a[240:243], v6 offset:20480
    v_cvt_pk_bf16_f32 v144, v20, v21
    v_mfma_f32_16x16x32_bf16 v[72:75], a[204:207], a[156:159], v[72:75]
    s_waitcnt lgkmcnt(5)
    ds_read_b128 a[244:247], v6 offset:21504
    v_add_f32 v15, v15, v40
    v_mfma_f32_16x16x32_bf16 v[68:71], a[208:211], a[128:131], v[164:167]
    ds_read_b128 a[248:251], v6 offset:22528
    v_exp_f32 v22, v98
    v_mfma_f32_16x16x32_bf16 v[68:71], a[212:215], a[132:135], v[68:71]
    ds_read_b128 a[252:255], v6 offset:23552
    v_exp_f32 v23, v99
    v_mfma_f32_16x16x32_bf16 v[68:71], a[216:219], a[136:139], v[68:71]
    v_exp_f32 v24, v100
    v_mfma_f32_16x16x32_bf16 v[68:71], a[220:223], a[140:143], v[68:71]
    buffer_load_dwordx4 v7, s[24:27], s56 offen offset:1024 sc1 lds
    v_mfma_f32_16x16x32_bf16 v[76:79], a[208:211], a[144:147], v[172:175]
    v_cvt_pk_bf16_f32 v145, v22, v23
    v_exp_f32 v25, v101
    v_mfma_f32_16x16x32_bf16 v[76:79], a[212:215], a[148:151], v[76:79]
    v_exp_f32 v26, v102
    v_mfma_f32_16x16x32_bf16 v[76:79], a[216:219], a[152:155], v[76:79]
    v_cvt_pk_bf16_f32 v146, v24, v25
    v_exp_f32 v27, v103
    v_mfma_f32_16x16x32_bf16 v[76:79], a[220:223], a[156:159], v[76:79]
    s_waitcnt lgkmcnt(0)
    v_exp_f32 v20, v104
    v_mfma_f32_16x16x32_bf16 a[0:3], a[224:227], v[128:131], a[0:3]
    ds_read_b128 a[192:195], v6 offset:8192
    v_cvt_pk_bf16_f32 v147, v26, v27
    v_mfma_f32_16x16x32_bf16 a[32:35], a[224:227], v[132:135], a[32:35]
    v_exp_f32 v21, v105
    v_mfma_f32_16x16x32_bf16 v[28:31], v[44:47], v[144:147], 0
    v_exp_f32 v22, v106
    v_mfma_f32_16x16x32_bf16 a[64:67], a[224:227], v[136:139], a[64:67]
    v_cvt_pk_bf16_f32 v148, v20, v21
    v_exp_f32 v23, v107
    v_mfma_f32_16x16x32_bf16 a[96:99], a[224:227], v[140:143], a[96:99]
    ds_read_b128 a[196:199], v6 offset:9216
    v_cvt_pk_bf16_f32 v149, v22, v23
    v_mfma_f32_16x16x32_bf16 a[4:7], a[228:231], v[128:131], a[4:7]
    v_exp_f32 v24, v108
    v_mfma_f32_16x16x32_bf16 a[36:39], a[228:231], v[132:135], a[36:39]
    buffer_load_dwordx4 v7, s[24:27], s56 offen offset:2048 sc1 lds
    v_mfma_f32_16x16x32_bf16 a[68:71], a[228:231], v[136:139], a[68:71]
    ds_read_b128 a[200:203], v6 offset:10240
    v_exp_f32 v25, v109
    v_mfma_f32_16x16x32_bf16 a[100:103], a[228:231], v[140:143], a[100:103]
    v_exp_f32 v26, v110
    v_mfma_f32_16x16x32_bf16 a[8:11], a[232:235], v[128:131], a[8:11]
    v_cvt_pk_bf16_f32 v150, v24, v25
    v_exp_f32 v27, v111
    v_mfma_f32_16x16x32_bf16 a[40:43], a[232:235], v[132:135], a[40:43]
    ds_read_b128 a[204:207], v6 offset:11264
    v_cvt_pk_bf16_f32 v151, v26, v27
    v_mfma_f32_16x16x32_bf16 a[72:75], a[232:235], v[136:139], a[72:75]
    v_exp_f32 v20, v112
    v_mfma_f32_16x16x32_bf16 v[32:35], v[44:47], v[148:151], 0
    v_exp_f32 v21, v113
    v_mfma_f32_16x16x32_bf16 a[104:107], a[232:235], v[140:143], a[104:107]
    v_exp_f32 v22, v114
    v_mfma_f32_16x16x32_bf16 a[12:15], a[236:239], v[128:131], a[12:15]
    v_cvt_pk_bf16_f32 v152, v20, v21
    v_exp_f32 v23, v115
    v_mfma_f32_16x16x32_bf16 a[44:47], a[236:239], v[132:135], a[44:47]
    v_exp_f32 v24, v116
    v_mfma_f32_16x16x32_bf16 a[76:79], a[236:239], v[136:139], a[76:79]
    v_cvt_pk_bf16_f32 v153, v22, v23
    v_exp_f32 v25, v117
    v_mfma_f32_16x16x32_bf16 a[108:111], a[236:239], v[140:143], a[108:111]
    buffer_load_dwordx4 v7, s[24:27], s56 offen offset:3072 sc1 lds
    v_mfma_f32_16x16x32_bf16 a[16:19], a[240:243], v[128:131], a[16:19]
    s_add_u32 s56, s56, 16384
    v_exp_f32 v26, v118
    v_mfma_f32_16x16x32_bf16 a[48:51], a[240:243], v[132:135], a[48:51]
    v_cvt_pk_bf16_f32 v154, v24, v25
    v_exp_f32 v27, v119
    v_mfma_f32_16x16x32_bf16 a[80:83], a[240:243], v[136:139], a[80:83]
    v_exp_f32 v20, v120
    v_mfma_f32_16x16x32_bf16 a[112:115], a[240:243], v[140:143], a[112:115]
    v_cvt_pk_bf16_f32 v155, v26, v27
    v_exp_f32 v21, v121
    v_mfma_f32_16x16x32_bf16 a[20:23], a[244:247], v[128:131], a[20:23]
    v_exp_f32 v22, v122
    v_mfma_f32_16x16x32_bf16 v[36:39], v[44:47], v[152:155], 0
    v_cvt_pk_bf16_f32 v156, v20, v21
    v_mfma_f32_16x16x32_bf16 a[52:55], a[244:247], v[132:135], a[52:55]
    v_exp_f32 v23, v123
    v_mfma_f32_16x16x32_bf16 a[84:87], a[244:247], v[136:139], a[84:87]
    v_exp_f32 v24, v124
    v_cvt_pk_bf16_f32 v157, v22, v23
    v_mfma_f32_16x16x32_bf16 a[116:119], a[244:247], v[140:143], a[116:119]
    v_exp_f32 v25, v125
    v_mfma_f32_16x16x32_bf16 a[24:27], a[248:251], v[128:131], a[24:27]
    s_add_u32 m0, s59, 16384
    v_exp_f32 v26, v126
    v_mfma_f32_16x16x32_bf16 a[56:59], a[248:251], v[132:135], a[56:59]
    buffer_load_dwordx4 v7, s[28:31], s57 offen offset:0 sc1 lds
    v_mfma_f32_16x16x32_bf16 a[88:91], a[248:251], v[136:139], a[88:91]
    v_cvt_pk_bf16_f32 v158, v24, v25
    v_exp_f32 v27, v127
    v_mfma_f32_16x16x32_bf16 a[120:123], a[248:251], v[140:143], a[120:123]
    ds_read_b128 a[208:211], v6 offset:12288
    v_cvt_pk_bf16_f32 v159, v26, v27
    s_nop 1
    v_mfma_f32_16x16x32_bf16 v[40:43], v[44:47], v[156:159], 0
    s_nop 2
    v_mfma_f32_16x16x32_bf16 a[28:31], a[252:255], v[128:131], a[28:31]
    ds_read_b128 a[212:215], v6 offset:13312
    s_nop 0
    v_mfma_f32_16x16x32_bf16 a[60:63], a[252:255], v[132:135], a[60:63]
    ds_read_b128 a[216:219], v6 offset:14336
    v_max3_f32 v8, v28, v32, v36
    v_mfma_f32_16x16x32_bf16 a[92:95], a[252:255], v[136:139], a[92:95]
    ds_read_b128 a[220:223], v6 offset:15360
    v_max_f32 v8, v8, v40
    v_cmp_nge_f32 vcc, s66, v8
    v_mfma_f32_16x16x32_bf16 a[124:127], a[252:255], v[140:143], a[124:127]
    s_waitcnt lgkmcnt(4)
    s_cbranch_vccnz m_stub92
m_ret93:
    v_mfma_f32_16x16x32_bf16 v[96:99], a[192:195], a[128:131], v[160:163]
    s_add_u32 s59, s58, s60
    v_exp_f32 v20, v64
    v_mfma_f32_16x16x32_bf16 v[96:99], a[196:199], a[132:135], v[96:99]
    s_add_u32 s58, s58, 32768
    ds_read_b128 a[224:227], v6 offset:24576
    v_add_f32 v12, v12, v28
    v_mfma_f32_16x16x32_bf16 v[96:99], a[200:203], a[136:139], v[96:99]
    s_and_b32 s58, s58, 0x1ffff
    ds_read_b128 a[228:231], v6 offset:25600
    v_add_f32 v13, v13, v32
    v_mfma_f32_16x16x32_bf16 v[96:99], a[204:207], a[140:143], v[96:99]
    buffer_load_dwordx4 v7, s[28:31], s57 offen offset:1024 sc1 lds
    v_mfma_f32_16x16x32_bf16 v[104:107], a[192:195], a[144:147], v[168:171]
    s_bitcmp1_b64 s[62:63], s64
    s_cselect_b32 s66, -1.0, s65
    ds_read_b128 a[232:235], v6 offset:26624
    v_mfma_f32_16x16x32_bf16 v[104:107], a[196:199], a[148:151], v[104:107]
    s_add_u32 s64, s64, 1
    ds_read_b128 a[236:239], v6 offset:27648
    v_mfma_f32_16x16x32_bf16 v[104:107], a[200:203], a[152:155], v[104:107]
    ds_read_b128 a[240:243], v6 offset:28672
    v_mfma_f32_16x16x32_bf16 v[104:107], a[204:207], a[156:159], v[104:107]
    s_waitcnt lgkmcnt(5)
    ds_read_b128 a[244:247], v6 offset:29696
    v_mfma_f32_16x16x32_bf16 v[100:103], a[208:211], a[128:131], v[164:167]
    buffer_load_dwordx4 v7, s[28:31], s57 offen offset:2048 sc1 lds
    v_mfma_f32_16x16x32_bf16 v[100:103], a[212:215], a[132:135], v[100:103]
    ds_read_b128 a[248:251], v6 offset:30720
    v_mfma_f32_16x16x32_bf16 v[100:103], a[216:219], a[136:139], v[100:103]
    ds_read_b128 a[252:255], v6 offset:31744
    v_mfma_f32_16x16x32_bf16 v[100:103], a[220:223], a[140:143], v[100:103]
    v_exp_f32 v21, v65
    v_mfma_f32_16x16x32_bf16 v[108:111], a[208:211], a[144:147], v[172:175]
    v_exp_f32 v22, v66
    v_mfma_f32_16x16x32_bf16 v[108:111], a[212:215], a[148:151], v[108:111]
    buffer_load_dwordx4 v7, s[28:31], s57 offen offset:3072 sc1 lds
    v_mfma_f32_16x16x32_bf16 v[108:111], a[216:219], a[152:155], v[108:111]
    s_add_u32 s57, s57, 16384
    v_cvt_pk_bf16_f32 v128, v20, v21
    v_mfma_f32_16x16x32_bf16 v[108:111], a[220:223], a[156:159], v[108:111]
    s_waitcnt vmcnt(16) lgkmcnt(0)
    v_add_u32 v6, s58, v2
    v_mfma_f32_16x16x32_bf16 a[0:3], a[224:227], v[144:147], a[0:3]
    s_barrier
    v_mfma_f32_16x16x32_bf16 a[32:35], a[224:227], v[148:151], a[32:35]
    ds_read_b128 a[192:195], v6 offset:0
    v_mfma_f32_16x16x32_bf16 a[64:67], a[224:227], v[152:155], a[64:67]
    v_exp_f32 v23, v67
    v_mfma_f32_16x16x32_bf16 a[96:99], a[224:227], v[156:159], a[96:99]
    v_exp_f32 v24, v68
    v_mfma_f32_16x16x32_bf16 a[4:7], a[228:231], v[144:147], a[4:7]
    ds_read_b128 a[196:199], v6 offset:1024
    v_cvt_pk_bf16_f32 v129, v22, v23
    v_mfma_f32_16x16x32_bf16 a[36:39], a[228:231], v[148:151], a[36:39]
    v_exp_f32 v25, v69
    v_mfma_f32_16x16x32_bf16 a[68:71], a[228:231], v[152:155], a[68:71]
    v_exp_f32 v26, v70
    v_mfma_f32_16x16x32_bf16 a[100:103], a[228:231], v[156:159], a[100:103]
    ds_read_b128 a[200:203], v6 offset:2048
    v_cvt_pk_bf16_f32 v130, v24, v25
    v_mfma_f32_16x16x32_bf16 a[8:11], a[232:235], v[144:147], a[8:11]
    v_exp_f32 v27, v71
    v_mfma_f32_16x16x32_bf16 a[40:43], a[232:235], v[148:151], a[40:43]
    v_exp_f32 v20, v72
    v_mfma_f32_16x16x32_bf16 a[72:75], a[232:235], v[152:155], a[72:75]
    ds_read_b128 a[204:207], v6 offset:3072
    v_cvt_pk_bf16_f32 v131, v26, v27
    v_mfma_f32_16x16x32_bf16 a[104:107], a[232:235], v[156:159], a[104:107]
    v_exp_f32 v21, v73
    v_mfma_f32_16x16x32_bf16 v[28:31], v[44:47], v[128:131], 0
    v_exp_f32 v22, v74
    v_mfma_f32_16x16x32_bf16 a[12:15], a[236:239], v[144:147], a[12:15]
    v_cvt_pk_bf16_f32 v132, v20, v21
    v_mfma_f32_16x16x32_bf16 a[44:47], a[236:239], v[148:151], a[44:47]
    v_exp_f32 v23, v75
    v_mfma_f32_16x16x32_bf16 a[76:79], a[236:239], v[152:155], a[76:79]
    v_exp_f32 v24, v76
    v_mfma_f32_16x16x32_bf16 a[108:111], a[236:239], v[156:159], a[108:111]
    v_cvt_pk_bf16_f32 v133, v22, v23
    v_mfma_f32_16x16x32_bf16 a[16:19], a[240:243], v[144:147], a[16:19]
    v_exp_f32 v25, v77
    v_mfma_f32_16x16x32_bf16 a[48:51], a[240:243], v[148:151], a[48:51]
    v_exp_f32 v26, v78
    v_mfma_f32_16x16x32_bf16 a[80:83], a[240:243], v[152:155], a[80:83]
    v_cvt_pk_bf16_f32 v134, v24, v25
    v_mfma_f32_16x16x32_bf16 a[112:115], a[240:243], v[156:159], a[112:115]
    v_exp_f32 v27, v79
    v_mfma_f32_16x16x32_bf16 a[20:23], a[244:247], v[144:147], a[20:23]
    v_cvt_pk_bf16_f32 v135, v26, v27
    v_mfma_f32_16x16x32_bf16 a[52:55], a[244:247], v[148:151], a[52:55]
    v_mfma_f32_16x16x32_bf16 a[84:87], a[244:247], v[152:155], a[84:87]
    v_mfma_f32_16x16x32_bf16 v[32:35], v[44:47], v[132:135], 0
    s_nop 2
    v_mfma_f32_16x16x32_bf16 a[116:119], a[244:247], v[156:159], a[116:119]
    s_nop 2
    v_mfma_f32_16x16x32_bf16 a[24:27], a[248:251], v[144:147], a[24:27]
    v_max_f32 v8, v28, v32
    v_cmp_nge_f32 vcc, s66, v8
    v_mfma_f32_16x16x32_bf16 a[56:59], a[248:251], v[148:151], a[56:59]
    v_mfma_f32_16x16x32_bf16 a[88:91], a[248:251], v[152:155], a[88:91]
    v_mfma_f32_16x16x32_bf16 a[120:123], a[248:251], v[156:159], a[120:123]
    ds_read_b128 a[208:211], v6 offset:4096
    v_mfma_f32_16x16x32_bf16 a[28:31], a[252:255], v[144:147], a[28:31]
    ds_read_b128 a[212:215], v6 offset:5120
    v_mfma_f32_16x16x32_bf16 a[60:63], a[252:255], v[148:151], a[60:63]
    ds_read_b128 a[216:219], v6 offset:6144
    v_mfma_f32_16x16x32_bf16 a[92:95], a[252:255], v[152:155], a[92:95]
    ds_read_b128 a[220:223], v6 offset:7168
    v_mfma_f32_16x16x32_bf16 a[124:127], a[252:255], v[156:159], a[124:127]
    s_waitcnt lgkmcnt(4)
    s_cbranch_vccnz m_stub94
m_ret95:
    v_add_f32 v20, v14, v36
    v_add_f32 v21, v15, v40
    s_nop 3
    v_rcp_f32 v20, v20
    v_rcp_f32 v21, v21
    s_lshl_b32 s90, s79, 10
    s_add_u32 s90, s90, s82
    s_add_u32 s90, s90, 67108864
    v_accvgpr_read_b32 v48, a64
    v_accvgpr_read_b32 v49, a65
    v_accvgpr_read_b32 v50, a66
    v_accvgpr_read_b32 v51, a67
    v_accvgpr_read_b32 v52, a68
    v_accvgpr_read_b32 v53, a69
    v_accvgpr_read_b32 v54, a70
    v_accvgpr_read_b32 v55, a71
    v_mul_f32 v48, v20, v48
    v_mul_f32 v49, v20, v49
    v_mul_f32 v50, v20, v50
    v_mul_f32 v51, v20, v51
    v_mul_f32 v52, v20, v52
    v_mul_f32 v53, v20, v53
    v_mul_f32 v54, v20, v54
    v_mul_f32 v55, v20, v55
    v_cvt_pk_bf16_f32 v48, v48, v49
    v_cvt_pk_bf16_f32 v49, v50, v51
    v_cvt_pk_bf16_f32 v50, v52, v53
    v_cvt_pk_bf16_f32 v51, v54, v55
    buffer_store_dwordx4 v[48:51], v2, s[8:11], s90 offen offset:0 sc1
    v_accvgpr_read_b32 v56, a96
    v_accvgpr_read_b32 v57, a97
    v_accvgpr_read_b32 v58, a98
    v_accvgpr_read_b32 v59, a99
    v_accvgpr_read_b32 v60, a100
    v_accvgpr_read_b32 v61, a101
    v_accvgpr_read_b32 v62, a102
    v_accvgpr_read_b32 v63, a103
    v_mul_f32 v56, v21, v56
    v_mul_f32 v57, v21, v57
    v_mul_f32 v58, v21, v58
    v_mul_f32 v59, v21, v59
    v_mul_f32 v60, v21, v60
    v_mul_f32 v61, v21, v61
    v_mul_f32 v62, v21, v62
    v_mul_f32 v63, v21, v63
    v_cvt_pk_bf16_f32 v56, v56, v57
    v_cvt_pk_bf16_f32 v57, v58, v59
    v_cvt_pk_bf16_f32 v58, v60, v61
    v_cvt_pk_bf16_f32 v59, v62, v63
    buffer_store_dwordx4 v[56:59], v2, s[8:11], s90 offen offset:1024 sc1
    s_add_u32 s90, s90, 131072
    v_accvgpr_read_b32 v48, a72
    v_accvgpr_read_b32 v49, a73
    v_accvgpr_read_b32 v50, a74
    v_accvgpr_read_b32 v51, a75
    v_accvgpr_read_b32 v52, a76
    v_accvgpr_read_b32 v53, a77
    v_accvgpr_read_b32 v54, a78
    v_accvgpr_read_b32 v55, a79
    v_mul_f32 v48, v20, v48
    v_mul_f32 v49, v20, v49
    v_mul_f32 v50, v20, v50
    v_mul_f32 v51, v20, v51
    v_mul_f32 v52, v20, v52
    v_mul_f32 v53, v20, v53
    v_mul_f32 v54, v20, v54
    v_mul_f32 v55, v20, v55
    v_cvt_pk_bf16_f32 v48, v48, v49
    v_cvt_pk_bf16_f32 v49, v50, v51
    v_cvt_pk_bf16_f32 v50, v52, v53
    v_cvt_pk_bf16_f32 v51, v54, v55
    buffer_store_dwordx4 v[48:51], v2, s[8:11], s90 offen offset:0 sc1
    v_accvgpr_read_b32 v56, a104
    v_accvgpr_read_b32 v57, a105
    v_accvgpr_read_b32 v58, a106
    v_accvgpr_read_b32 v59, a107
    v_accvgpr_read_b32 v60, a108
    v_accvgpr_read_b32 v61, a109
    v_accvgpr_read_b32 v62, a110
    v_accvgpr_read_b32 v63, a111
    v_mul_f32 v56, v21, v56
    v_mul_f32 v57, v21, v57
    v_mul_f32 v58, v21, v58
    v_mul_f32 v59, v21, v59
    v_mul_f32 v60, v21, v60
    v_mul_f32 v61, v21, v61
    v_mul_f32 v62, v21, v62
    v_mul_f32 v63, v21, v63
    v_cvt_pk_bf16_f32 v56, v56, v57
    v_cvt_pk_bf16_f32 v57, v58, v59
    v_cvt_pk_bf16_f32 v58, v60, v61
    v_cvt_pk_bf16_f32 v59, v62, v63
    buffer_store_dwordx4 v[56:59], v2, s[8:11], s90 offen offset:1024 sc1
    s_add_u32 s90, s90, 131072
    v_accvgpr_read_b32 v48, a80
    v_accvgpr_read_b32 v49, a81
    v_accvgpr_read_b32 v50, a82
    v_accvgpr_read_b32 v51, a83
    v_accvgpr_read_b32 v52, a84
    v_accvgpr_read_b32 v53, a85
    v_accvgpr_read_b32 v54, a86
    v_accvgpr_read_b32 v55, a87
    v_mul_f32 v48, v20, v48
    v_mul_f32 v49, v20, v49
    v_mul_f32 v50, v20, v50
    v_mul_f32 v51, v20, v51
    v_mul_f32 v52, v20, v52
    v_mul_f32 v53, v20, v53
    v_mul_f32 v54, v20, v54
    v_mul_f32 v55, v20, v55
    v_cvt_pk_bf16_f32 v48, v48, v49
    v_cvt_pk_bf16_f32 v49, v50, v51
    v_cvt_pk_bf16_f32 v50, v52, v53
    v_cvt_pk_bf16_f32 v51, v54, v55
    buffer_store_dwordx4 v[48:51], v2, s[8:11], s90 offen offset:0 sc1
    v_accvgpr_read_b32 v56, a112
    v_accvgpr_read_b32 v57, a113
    v_accvgpr_read_b32 v58, a114
    v_accvgpr_read_b32 v59, a115
    v_accvgpr_read_b32 v60, a116
    v_accvgpr_read_b32 v61, a117
    v_accvgpr_read_b32 v62, a118
    v_accvgpr_read_b32 v63, a119
    v_mul_f32 v56, v21, v56
    v_mul_f32 v57, v21, v57
    v_mul_f32 v58, v21, v58
    v_mul_f32 v59, v21, v59
    v_mul_f32 v60, v21, v60
    v_mul_f32 v61, v21, v61
    v_mul_f32 v62, v21, v62
    v_mul_f32 v63, v21, v63
    v_cvt_pk_bf16_f32 v56, v56, v57
    v_cvt_pk_bf16_f32 v57, v58, v59
    v_cvt_pk_bf16_f32 v58, v60, v61
    v_cvt_pk_bf16_f32 v59, v62, v63
    buffer_store_dwordx4 v[56:59], v2, s[8:11], s90 offen offset:1024 sc1
    s_add_u32 s90, s90, 131072
    v_accvgpr_read_b32 v48, a88
    v_accvgpr_read_b32 v49, a89
    v_accvgpr_read_b32 v50, a90
    v_accvgpr_read_b32 v51, a91
    v_accvgpr_read_b32 v52, a92
    v_accvgpr_read_b32 v53, a93
    v_accvgpr_read_b32 v54, a94
    v_accvgpr_read_b32 v55, a95
    v_mul_f32 v48, v20, v48
    v_mul_f32 v49, v20, v49
    v_mul_f32 v50, v20, v50
    v_mul_f32 v51, v20, v51
    v_mul_f32 v52, v20, v52
    v_mul_f32 v53, v20, v53
    v_mul_f32 v54, v20, v54
    v_mul_f32 v55, v20, v55
    v_cvt_pk_bf16_f32 v48, v48, v49
    v_cvt_pk_bf16_f32 v49, v50, v51
    v_cvt_pk_bf16_f32 v50, v52, v53
    v_cvt_pk_bf16_f32 v51, v54, v55
    buffer_store_dwordx4 v[48:51], v2, s[8:11], s90 offen offset:0 sc1
    v_accvgpr_read_b32 v56, a120
    v_accvgpr_read_b32 v57, a121
    v_accvgpr_read_b32 v58, a122
    v_accvgpr_read_b32 v59, a123
    v_accvgpr_read_b32 v60, a124
    v_accvgpr_read_b32 v61, a125
    v_accvgpr_read_b32 v62, a126
    v_accvgpr_read_b32 v63, a127
    v_mul_f32 v56, v21, v56
    v_mul_f32 v57, v21, v57
    v_mul_f32 v58, v21, v58
    v_mul_f32 v59, v21, v59
    v_mul_f32 v60, v21, v60
    v_mul_f32 v61, v21, v61
    v_mul_f32 v62, v21, v62
    v_mul_f32 v63, v21, v63
    v_cvt_pk_bf16_f32 v56, v56, v57
    v_cvt_pk_bf16_f32 v57, v58, v59
    v_cvt_pk_bf16_f32 v58, v60, v61
    v_cvt_pk_bf16_f32 v59, v62, v63
    buffer_store_dwordx4 v[56:59], v2, s[8:11], s90 offen offset:1024 sc1
    s_add_u32 s90, s90, 131072
    s_lshl_b32 s17, s34, 5
    s_add_u32 s17, s17, s32
    s_lshl_b32 s17, s17, 3
    s_add_u32 s17, s17, 7936
m_single96:
    v_mfma_f32_16x16x32_bf16 v[64:67], a[192:195], a[128:131], v[160:163]
    s_bitcmp1_b64 s[62:63], s64
    s_cselect_b32 s66, -1.0, s65
    v_add_f32 v12, v12, v28
    v_mfma_f32_16x16x32_bf16 v[64:67], a[196:199], a[132:135], v[64:67]
    s_mov_b32 m0, s59
    ds_read_b128 a[224:227], v6 offset:16384
    v_add_f32 v13, v13, v32
    v_mfma_f32_16x16x32_bf16 v[64:67], a[200:203], a[136:139], v[64:67]
    buffer_load_dwordx4 v7, s[24:27], s56 offen offset:0 sc1 lds
    v_mfma_f32_16x16x32_bf16 v[64:67], a[204:207], a[140:143], v[64:67]
    s_add_u32 s64, s64, 1
    ds_read_b128 a[228:231], v6 offset:17408
    v_exp_f32 v20, v96
    v_mfma_f32_16x16x32_bf16 v[72:75], a[192:195], a[144:147], v[168:171]
    ds_read_b128 a[232:235], v6 offset:18432
    v_exp_f32 v21, v97
    v_mfma_f32_16x16x32_bf16 v[72:75], a[196:199], a[148:151], v[72:75]
    ds_read_b128 a[236:239], v6 offset:19456
    v_cvt_pk_bf16_f32 v144, v20, v21
    v_mfma_f32_16x16x32_bf16 v[72:75], a[200:203], a[152:155], v[72:75]
    ds_read_b128 a[240:243], v6 offset:20480
    v_exp_f32 v22, v98
    v_mfma_f32_16x16x32_bf16 v[72:75], a[204:207], a[156:159], v[72:75]
    s_waitcnt lgkmcnt(5)
    ds_read_b128 a[244:247], v6 offset:21504
    v_mfma_f32_16x16x32_bf16 v[68:71], a[208:211], a[128:131], v[164:167]
    ds_read_b128 a[248:251], v6 offset:22528
    v_exp_f32 v23, v99
    v_mfma_f32_16x16x32_bf16 v[68:71], a[212:215], a[132:135], v[68:71]
    ds_read_b128 a[252:255], v6 offset:23552
    v_cvt_pk_bf16_f32 v145, v22, v23
    v_mfma_f32_16x16x32_bf16 v[68:71], a[216:219], a[136:139], v[68:71]
    buffer_load_dwordx4 v7, s[24:27], s56 offen offset:1024 sc1 lds
    v_mfma_f32_16x16x32_bf16 v[68:71], a[220:223], a[140:143], v[68:71]
    v_exp_f32 v24, v100
    v_mfma_f32_16x16x32_bf16 v[76:79], a[208:211], a[144:147], v[172:175]
    v_exp_f32 v25, v101
    v_mfma_f32_16x16x32_bf16 v[76:79], a[212:215], a[148:151], v[76:79]
    v_exp_f32 v26, v102
    v_mfma_f32_16x16x32_bf16 v[76:79], a[216:219], a[152:155], v[76:79]
    buffer_load_dwordx4 v7, s[24:27], s56 offen offset:2048 sc1 lds
    v_cvt_pk_bf16_f32 v146, v24, v25
    v_mfma_f32_16x16x32_bf16 v[76:79], a[220:223], a[156:159], v[76:79]
    s_waitcnt lgkmcnt(0)
    v_exp_f32 v27, v103
    v_mfma_f32_16x16x32_bf16 a[0:3], a[224:227], v[128:131], a[0:3]
    ds_read_b128 a[192:195], v6 offset:8192
    v_cvt_pk_bf16_f32 v147, v26, v27
    v_mfma_f32_16x16x32_bf16 a[32:35], a[224:227], v[132:135], a[32:35]
    v_exp_f32 v20, v104
    v_mfma_f32_16x16x32_bf16 v[28:31], v[44:47], v[144:147], 0
    v_exp_f32 v21, v105
    v_mfma_f32_16x16x32_bf16 a[4:7], a[228:231], v[128:131], a[4:7]
    ds_read_b128 a[196:199], v6 offset:9216
    v_exp_f32 v22, v106
    v_mfma_f32_16x16x32_bf16 a[36:39], a[228:231], v[132:135], a[36:39]
    buffer_load_dwordx4 v7, s[24:27], s56 offen offset:3072 sc1 lds
    v_mfma_f32_16x16x32_bf16 a[8:11], a[232:235], v[128:131], a[8:11]
    s_add_u32 s56, s56, 16384
    ds_read_b128 a[200:203], v6 offset:10240
    v_cvt_pk_bf16_f32 v148, v20, v21
    v_mfma_f32_16x16x32_bf16 a[40:43], a[232:235], v[132:135], a[40:43]
    v_exp_f32 v23, v107
    v_mfma_f32_16x16x32_bf16 a[12:15], a[236:239], v[128:131], a[12:15]
    ds_read_b128 a[204:207], v6 offset:11264
    v_exp_f32 v24, v108
    v_mfma_f32_16x16x32_bf16 a[44:47], a[236:239], v[132:135], a[44:47]
    v_cvt_pk_bf16_f32 v149, v22, v23
    v_exp_f32 v25, v109
    v_mfma_f32_16x16x32_bf16 a[16:19], a[240:243], v[128:131], a[16:19]
    v_exp_f32 v26, v110
    v_mfma_f32_16x16x32_bf16 a[48:51], a[240:243], v[132:135], a[48:51]
    v_cvt_pk_bf16_f32 v150, v24, v25
    v_exp_f32 v27, v111
    v_mfma_f32_16x16x32_bf16 a[20:23], a[244:247], v[128:131], a[20:23]
    ds_read_b128 a[208:211], v6 offset:12288
    v_cvt_pk_bf16_f32 v151, v26, v27
    v_mfma_f32_16x16x32_bf16 a[52:55], a[244:247], v[132:135], a[52:55]
    s_add_u32 m0, s59, 16384
    ds_read_b128 a[212:215], v6 offset:13312
    v_mfma_f32_16x16x32_bf16 v[32:35], v[44:47], v[148:151], 0
    s_nop 2
    v_mfma_f32_16x16x32_bf16 a[24:27], a[248:251], v[128:131], a[24:27]
    buffer_load_dwordx4 v7, s[28:31], s57 offen offset:0 sc1 lds
    v_mfma_f32_16x16x32_bf16 a[56:59], a[248:251], v[132:135], a[56:59]
    ds_read_b128 a[216:219], v6 offset:14336
    s_nop 0
    v_mfma_f32_16x16x32_bf16 a[28:31], a[252:255], v[128:131], a[28:31]
    ds_read_b128 a[220:223], v6 offset:15360
    v_max_f32 v8, v28, v32
    v_cmp_nge_f32 vcc, s66, v8
    v_mfma_f32_16x16x32_bf16 a[60:63], a[252:255], v[132:135], a[60:63]
    s_waitcnt lgkmcnt(4)
    s_cbranch_vccnz m_stub97
m_ret98:
    v_mfma_f32_16x16x32_bf16 v[96:99], a[192:195], a[128:131], v[160:163]
    s_add_u32 s59, s58, s60
    v_exp_f32 v20, v64
    v_mfma_f32_16x16x32_bf16 v[96:99], a[196:199], a[132:135], v[96:99]
    s_add_u32 s58, s58, 32768
    ds_read_b128 a[224:227], v6 offset:24576
    v_add_f32 v12, v12, v28
    v_mfma_f32_16x16x32_bf16 v[96:99], a[200:203], a[136:139], v[96:99]
    s_and_b32 s58, s58, 0x1ffff
    ds_read_b128 a[228:231], v6 offset:25600
    v_exp_f32 v21, v65
    v_mfma_f32_16x16x32_bf16 v[96:99], a[204:207], a[140:143], v[96:99]
    s_bitcmp1_b64 s[62:63], s64
    s_cselect_b32 s66, -1.0, s65
    ds_read_b128 a[232:235], v6 offset:26624
    v_mfma_f32_16x16x32_bf16 v[104:107], a[192:195], a[144:147], v[168:171]
    buffer_load_dwordx4 v7, s[28:31], s57 offen offset:1024 sc1 lds
    v_mfma_f32_16x16x32_bf16 v[104:107], a[196:199], a[148:151], v[104:107]
    s_add_u32 s64, s64, 1
    ds_read_b128 a[236:239], v6 offset:27648
    v_cvt_pk_bf16_f32 v128, v20, v21
    v_mfma_f32_16x16x32_bf16 v[104:107], a[200:203], a[152:155], v[104:107]
    ds_read_b128 a[240:243], v6 offset:28672
    v_exp_f32 v22, v66
    v_mfma_f32_16x16x32_bf16 v[104:107], a[204:207], a[156:159], v[104:107]
    s_waitcnt lgkmcnt(5)
    ds_read_b128 a[244:247], v6 offset:29696
    v_add_f32 v13, v13, v32
    v_mfma_f32_16x16x32_bf16 v[100:103], a[208:211], a[128:131], v[164:167]
    ds_read_b128 a[248:251], v6 offset:30720
    v_exp_f32 v23, v67
    v_mfma_f32_16x16x32_bf16 v[100:103], a[212:215], a[132:135], v[100:103]
    buffer_load_dwordx4 v7, s[28:31], s57 offen offset:2048 sc1 lds
    v_mfma_f32_16x16x32_bf16 v[100:103], a[216:219], a[136:139], v[100:103]
    ds_read_b128 a[252:255], v6 offset:31744
    v_cvt_pk_bf16_f32 v129, v22, v23
    v_mfma_f32_16x16x32_bf16 v[100:103], a[220:223], a[140:143], v[100:103]
    v_exp_f32 v24, v68
    v_mfma_f32_16x16x32_bf16 v[108:111], a[208:211], a[144:147], v[172:175]
    v_exp_f32 v25, v69
    v_mfma_f32_16x16x32_bf16 v[108:111], a[212:215], a[148:151], v[108:111]
    buffer_load_dwordx4 v7, s[28:31], s57 offen offset:3072 sc1 lds
    v_mfma_f32_16x16x32_bf16 v[108:111], a[216:219], a[152:155], v[108:111]
    s_add_u32 s57, s57, 16384
    v_exp_f32 v26, v70
    v_cvt_pk_bf16_f32 v130, v24, v25
    v_mfma_f32_16x16x32_bf16 v[108:111], a[220:223], a[156:159], v[108:111]
    s_waitcnt vmcnt(16) lgkmcnt(0)
    v_add_u32 v6, s58, v2
    v_exp_f32 v27, v71
    v_mfma_f32_16x16x32_bf16 a[0:3], a[224:227], v[144:147], a[0:3]
    s_barrier
    v_mfma_f32_16x16x32_bf16 a[32:35], a[224:227], v[148:151], a[32:35]
    ds_read_b128 a[192:195], v6 offset:0
    v_cvt_pk_bf16_f32 v131, v26, v27
    v_mfma_f32_16x16x32_bf16 a[4:7], a[228:231], v[144:147], a[4:7]
    v_exp_f32 v20, v72
    v_mfma_f32_16x16x32_bf16 v[28:31], v[44:47], v[128:131], 0
    v_exp_f32 v21, v73
    v_mfma_f32_16x16x32_bf16 a[36:39], a[228:231], v[148:151], a[36:39]
    ds_read_b128 a[196:199], v6 offset:1024
    v_cvt_pk_bf16_f32 v132, v20, v21
    v_mfma_f32_16x16x32_bf16 a[8:11], a[232:235], v[144:147], a[8:11]
    v_exp_f32 v22, v74
    v_mfma_f32_16x16x32_bf16 a[40:43], a[232:235], v[148:151], a[40:43]
    ds_read_b128 a[200:203], v6 offset:2048
    v_exp_f32 v23, v75
    v_mfma_f32_16x16x32_bf16 a[12:15], a[236:239], v[144:147], a[12:15]
    v_exp_f32 v24, v76
    v_mfma_f32_16x16x32_bf16 a[44:47], a[236:239], v[148:151], a[44:47]
    ds_read_b128 a[204:207], v6 offset:3072
    v_cvt_pk_bf16_f32 v133, v22, v23
    v_mfma_f32_16x16x32_bf16 a[16:19], a[240:243], v[144:147], a[16:19]
    v_exp_f32 v25, v77
    v_mfma_f32_16x16x32_bf16 a[48:51], a[240:243], v[148:151], a[48:51]
    v_exp_f32 v26, v78
    v_cvt_pk_bf16_f32 v134, v24, v25
    v_mfma_f32_16x16x32_bf16 a[20:23], a[244:247], v[144:147], a[20:23]
    v_exp_f32 v27, v79
    v_mfma_f32_16x16x32_bf16 a[52:55], a[244:247], v[148:151], a[52:55]
    ds_read_b128 a[208:211], v6 offset:4096
    v_cvt_pk_bf16_f32 v135, v26, v27
    s_nop 1
    v_mfma_f32_16x16x32_bf16 v[32:35], v[44:47], v[132:135], 0
    s_nop 2
    v_mfma_f32_16x16x32_bf16 a[24:27], a[248:251], v[144:147], a[24:27]
    ds_read_b128 a[212:215], v6 offset:5120
    s_nop 0
    v_mfma_f32_16x16x32_bf16 a[56:59], a[248:251], v[148:151], a[56:59]
    ds_read_b128 a[216:219], v6 offset:6144
    v_max_f32 v8, v28, v32
    v_mfma_f32_16x16x32_bf16 a[28:31], a[252:255], v[144:147], a[28:31]
    ds_read_b128 a[220:223], v6 offset:7168
    v_cmp_nge_f32 vcc, s66, v8
    v_mfma_f32_16x16x32_bf16 a[60:63], a[252:255], v[148:151], a[60:63]
    s_waitcnt lgkmcnt(4)
    s_cbranch_vccz m_single96
    v_cmp_lt_f32 vcc, s65, v8
    s_cmp_lg_u32 s64, s70
    s_cbranch_scc1 m_e100
    v_add_f32 v160, v160, v16
    v_mov_b32 v164, v9
    v_add_f32 v172, v172, v16
    v_add_f32 v161, v161, v17
    v_mov_b32 v165, v9
    v_add_f32 v173, v173, v17
    v_add_f32 v162, v162, v18
    v_mov_b32 v166, v9
    v_add_f32 v174, v174, v18
    v_add_f32 v163, v163, v19
    v_mov_b32 v167, v9
    v_add_f32 v175, v175, v19
    s_nop 0
m_e100:
    s_cmp_lg_u32 s64, s71
    s_cbranch_scc1 m_e101
    v_mov_b32 v160, v9
    v_mov_b32 v168, v9
    v_mov_b32 v172, v9
    v_mov_b32 v161, v9
    v_mov_b32 v169, v9
    v_mov_b32 v173, v9
    v_mov_b32 v162, v9
    v_mov_b32 v170, v9
    v_mov_b32 v174, v9
    v_mov_b32 v163, v9
    v_mov_b32 v171, v9
    v_mov_b32 v175, v9
    s_nop 0
m_e101:
    s_cmp_lg_u32 s64, s53
    s_cbranch_scc1 m_e104
    s_cmp_lg_u32 s16, 0
    s_cbranch_scc1 m_np105
    v_mov_b32 v60, s4
    v_mov_b32 v61, s5
    s_add_u32 s90, s17, 117440512
    s_mov_b64 exec, 1
    buffer_store_dwordx2 v[60:61], off, s[8:11], s90 sc1
    s_mov_b64 exec, -1
m_np105:
    s_mov_b32 s17, -1
m_e104:
    s_cmp_gt_u32 s64, 26
    s_cbranch_scc1 m_e102
    s_cmp_lg_u32 s64, 6
    s_cbranch_scc1 m_e106
    s_lshr_b32 s90, s32, 1
    s_lshl_b32 s90, s90, 7
    s_add_u32 s90, s90, 117440600
    v_min_u32 v0, 1, v1
    v_lshlrev_b32 v0, 5, v0
    buffer_load_dwordx2 v[4:5], v0, s[8:11], s90 offen sc1
    s_cmp_eq_u32 s17, -1
    s_cbranch_scc1 m_e102
    s_cmp_lg_u32 s16, 0
    s_cbranch_scc1 m_np107
    v_mov_b32 v60, s4
    v_mov_b32 v61, s5
    s_add_u32 s90, s17, 117440512
    s_mov_b64 exec, 1
    buffer_store_dwordx2 v[60:61], off, s[8:11], s90 sc1
    s_mov_b64 exec, -1
m_np107:
    s_branch m_e102
m_e106:
    s_cmp_lg_u32 s64, 18
    s_cbranch_scc1 m_e108
    s_waitcnt vmcnt(18)
    s_mov_b32 s3, 1048576
m_spin109:
    v_cmp_ne_u64 s[76:77], s[4:5], v[4:5]
    s_nop 3
    s_cmp_eq_u64 s[76:77], 0
    s_cbranch_scc1 m_e102
    s_sub_u32 s3, s3, 1
    s_cbranch_scc1 m_e102
    s_sleep 32
    s_lshr_b32 s90, s32, 1
    s_lshl_b32 s90, s90, 7
    s_add_u32 s90, s90, 117440600
    v_min_u32 v0, 1, v1
    v_lshlrev_b32 v0, 5, v0
    buffer_load_dwordx2 v[4:5], v0, s[8:11], s90 offen sc1
    s_waitcnt vmcnt(0)
    s_branch m_spin109
    s_branch m_e102
m_e108:
    s_cmp_lg_u32 s64, 22
    s_cbranch_scc1 m_e110
    buffer_load_dwordx2 v[4:5], v10, s[8:11], 0 offen sc1
    s_mov_b32 s44, s48
    s_mov_b32 s45, s49
    s_mov_b32 s46, 8388608
    s_lshl_b32 s90, s2, 2
    s_add_u32 s90, s90, s16
    s_lshl_b32 s90, s90, 13
    v_lshlrev_b32 v62, 7, v1
    buffer_load_dword v255, v62, s[44:47], s90 offen
    s_branch m_e102
m_e110:
    s_cmp_lg_u32 s64, 26
    s_cbranch_scc1 m_e111
    s_mov_b32 s44, s50
    s_mov_b32 s45, s51
    s_mov_b32 s46, 2097152
    s_lshl_b32 s90, s2, 2
    s_add_u32 s90, s90, s16
    s_lshl_b32 s90, s90, 13
    v_lshlrev_b32 v62, 7, v1
    buffer_load_dword v255, v62, s[44:47], s90 offen
    s_waitcnt vmcnt(18)
    s_mov_b32 s3, 1048576
m_spin112:
    v_cmp_ne_u64 s[76:77], s[4:5], v[4:5]
    s_nop 3
    s_cmp_eq_u64 s[76:77], 0
    s_cbranch_scc1 m_e102
    s_sub_u32 s3, s3, 1
    s_cbranch_scc1 m_e102
    s_sleep 32
    buffer_load_dwordx2 v[4:5], v10, s[8:11], 0 offen sc1
    s_waitcnt vmcnt(0)
    s_branch m_spin112
    s_branch m_e102
m_e111:
m_e102:
    s_cbranch_vccnz m_rc113
m_sp99:
    s_cmp_lg_u32 s64, s72
    s_cbranch_scc1 m_single96
    s_bfe_u32 s95, s2, 0x10002
    s_xor_b32 s95, s95, 1
    s_bitcmp1_b32 s2, 1
    s_cselect_b32 s96, s33, s34
    s_sub_u32 s96, s96, 1
    s_and_b32 s90, s2, 1
    s_lshl_b32 s90, s90, 2
    s_bfe_u32 s91, s2, 0x20003
    s_add_u32 s97, s90, s91
    v_and_b32 v10, 31, v1
    v_lshlrev_b32 v10, 3, v10
    s_lshl_b32 s52, s96, 8
    s_add_u32 s52, s52, 117448704
    buffer_load_dwordx2 v[4:5], v10, s[8:11], s52 offen sc1
    ds_read_b128 a[224:227], v6 offset:16384
    ds_read_b128 a[228:231], v6 offset:17408
    ds_read_b128 a[232:235], v6 offset:18432
    ds_read_b128 a[236:239], v6 offset:19456
    ds_read_b128 a[240:243], v6 offset:20480
    ds_read_b128 a[244:247], v6 offset:21504
    ds_read_b128 a[248:251], v6 offset:22528
    ds_read_b128 a[252:255], v6 offset:23552
    s_waitcnt lgkmcnt(0)
    v_mfma_f32_16x16x32_bf16 a[0:3], a[224:227], v[128:131], a[0:3]
    buffer_load_dwordx4 v[192:195], v2, s[8:11], s83 offen offset:0 sc1
    v_exp_f32 v20, v96
    v_mfma_f32_16x16x32_bf16 a[32:35], a[224:227], v[132:135], a[32:35]
    v_exp_f32 v21, v97
    v_exp_f32 v22, v98
    v_mfma_f32_16x16x32_bf16 a[4:7], a[228:231], v[128:131], a[4:7]
    buffer_load_dwordx4 v[196:199], v2, s[8:11], s83 offen offset:1024 sc1
    v_cvt_pk_bf16_f32 v144, v20, v21
    v_add_f32 v12, v12, v28
    v_mfma_f32_16x16x32_bf16 a[36:39], a[228:231], v[132:135], a[36:39]
    v_exp_f32 v23, v99
    v_exp_f32 v24, v100
    v_cvt_pk_bf16_f32 v145, v22, v23
    v_mfma_f32_16x16x32_bf16 a[8:11], a[232:235], v[128:131], a[8:11]
    buffer_load_dwordx4 v[200:203], v2, s[8:11], s83 offen offset:2048 sc1
    v_exp_f32 v25, v101
    v_mfma_f32_16x16x32_bf16 a[40:43], a[232:235], v[132:135], a[40:43]
    v_exp_f32 v26, v102
    v_cvt_pk_bf16_f32 v146, v24, v25
    v_add_f32 v13, v13, v32
    v_mfma_f32_16x16x32_bf16 a[12:15], a[236:239], v[128:131], a[12:15]
    buffer_load_dwordx4 v[204:207], v2, s[8:11], s83 offen offset:3072 sc1
    v_exp_f32 v27, v103
    v_mfma_f32_16x16x32_bf16 a[44:47], a[236:239], v[132:135], a[44:47]
    v_exp_f32 v20, v104
    v_cvt_pk_bf16_f32 v147, v26, v27
    v_mfma_f32_16x16x32_bf16 a[16:19], a[240:243], v[128:131], a[16:19]
    buffer_load_dwordx4 v[212:215], v2, s[8:11], s84 offen offset:0 sc1
    v_exp_f32 v21, v105
    v_mfma_f32_16x16x32_bf16 v[28:31], v[44:47], v[144:147], 0
    v_exp_f32 v22, v106
    v_cvt_pk_bf16_f32 v148, v20, v21
    v_exp_f32 v23, v107
    v_mfma_f32_16x16x32_bf16 a[48:51], a[240:243], v[132:135], a[48:51]
    v_exp_f32 v24, v108
    v_cvt_pk_bf16_f32 v149, v22, v23
    v_exp_f32 v25, v109
    v_mfma_f32_16x16x32_bf16 a[20:23], a[244:247], v[128:131], a[20:23]
    buffer_load_dwordx4 v[216:219], v2, s[8:11], s84 offen offset:1024 sc1
    v_exp_f32 v26, v110
    v_mfma_f32_16x16x32_bf16 a[52:55], a[244:247], v[132:135], a[52:55]
    v_cvt_pk_bf16_f32 v150, v24, v25
    v_exp_f32 v27, v111
    s_nop 0
    v_cvt_pk_bf16_f32 v151, v26, v27
    s_nop 1
    v_mfma_f32_16x16x32_bf16 v[32:35], v[44:47], v[148:151], 0
    s_nop 2
    v_mfma_f32_16x16x32_bf16 a[24:27], a[248:251], v[128:131], a[24:27]
    buffer_load_dwordx4 v[220:223], v2, s[8:11], s84 offen offset:2048 sc1
    v_mfma_f32_16x16x32_bf16 a[56:59], a[248:251], v[132:135], a[56:59]
    s_nop 2
    v_mfma_f32_16x16x32_bf16 a[28:31], a[252:255], v[128:131], a[28:31]
    v_max_f32 v8, v28, v32
    v_cmp_nge_f32 vcc, s65, v8
    v_mfma_f32_16x16x32_bf16 a[60:63], a[252:255], v[132:135], a[60:63]
    s_cbranch_vccnz m_stub114
m_ret115:
    s_nop 1
    ds_read_b128 a[224:227], v6 offset:24576
    ds_read_b128 a[228:231], v6 offset:25600
    ds_read_b128 a[232:235], v6 offset:26624
    ds_read_b128 a[236:239], v6 offset:27648
    ds_read_b128 a[240:243], v6 offset:28672
    ds_read_b128 a[244:247], v6 offset:29696
    ds_read_b128 a[248:251], v6 offset:30720
    ds_read_b128 a[252:255], v6 offset:31744
    s_waitcnt lgkmcnt(0)
    v_mfma_f32_16x16x32_bf16 a[0:3], a[224:227], v[144:147], a[0:3]
    buffer_load_dwordx4 v[224:227], v2, s[8:11], s84 offen offset:3072 sc1
    v_mfma_f32_16x16x32_bf16 a[32:35], a[224:227], v[148:151], a[32:35]
    v_mfma_f32_16x16x32_bf16 a[4:7], a[228:231], v[144:147], a[4:7]
    buffer_load_dwordx4 v[208:211], v2, s[8:11], s85 offen offset:0 sc1
    v_mfma_f32_16x16x32_bf16 a[36:39], a[228:231], v[148:151], a[36:39]
    v_mfma_f32_16x16x32_bf16 a[8:11], a[232:235], v[144:147], a[8:11]
    buffer_load_dwordx4 v[232:235], v2, s[8:11], s86 offen offset:0 sc1
    v_mfma_f32_16x16x32_bf16 a[40:43], a[232:235], v[148:151], a[40:43]
    v_mfma_f32_16x16x32_bf16 a[12:15], a[236:239], v[144:147], a[12:15]
    buffer_load_dwordx4 v[236:239], v2, s[8:11], s86 offen offset:1024 sc1
    v_mfma_f32_16x16x32_bf16 a[44:47], a[236:239], v[148:151], a[44:47]
    v_mfma_f32_16x16x32_bf16 a[16:19], a[240:243], v[144:147], a[16:19]
    buffer_load_dwordx4 v[228:231], v2, s[8:11], s87 offen offset:0 sc1
    v_mfma_f32_16x16x32_bf16 a[48:51], a[240:243], v[148:151], a[48:51]
    v_mfma_f32_16x16x32_bf16 a[20:23], a[244:247], v[144:147], a[20:23]
    buffer_load_dwordx4 v[244:247], v2, s[8:11], s88 offen offset:0 sc1
    v_mfma_f32_16x16x32_bf16 a[52:55], a[244:247], v[148:151], a[52:55]
    v_mfma_f32_16x16x32_bf16 a[24:27], a[248:251], v[144:147], a[24:27]
    buffer_load_dwordx4 v[248:251], v2, s[8:11], s88 offen offset:1024 sc1
    v_mfma_f32_16x16x32_bf16 a[56:59], a[248:251], v[148:151], a[56:59]
    v_mfma_f32_16x16x32_bf16 a[28:31], a[252:255], v[144:147], a[28:31]
    buffer_load_dwordx4 v[240:243], v2, s[8:11], s89 offen offset:0 sc1
    v_mfma_f32_16x16x32_bf16 a[60:63], a[252:255], v[148:151], a[60:63]
    s_barrier
    v_add_f32 v20, v12, v28
    v_add_f32 v21, v13, v32
    s_nop 3
    v_rcp_f32 v20, v20
    v_rcp_f32 v21, v21
    s_lshl_b32 s90, s78, 10
    s_add_u32 s90, s90, s82
    s_add_u32 s90, s90, 67108864
    v_accvgpr_read_b32 v48, a0
    v_accvgpr_read_b32 v49, a1
    v_accvgpr_read_b32 v50, a2
    v_accvgpr_read_b32 v51, a3
    v_accvgpr_read_b32 v52, a4
    v_accvgpr_read_b32 v53, a5
    v_accvgpr_read_b32 v54, a6
    v_accvgpr_read_b32 v55, a7
    v_mul_f32 v48, v20, v48
    v_mul_f32 v49, v20, v49
    v_mul_f32 v50, v20, v50
    v_mul_f32 v51, v20, v51
    v_mul_f32 v52, v20, v52
    v_mul_f32 v53, v20, v53
    v_mul_f32 v54, v20, v54
    v_mul_f32 v55, v20, v55
    v_cvt_pk_bf16_f32 v48, v48, v49
    v_cvt_pk_bf16_f32 v49, v50, v51
    v_cvt_pk_bf16_f32 v50, v52, v53
    v_cvt_pk_bf16_f32 v51, v54, v55
    buffer_store_dwordx4 v[48:51], v2, s[8:11], s90 offen offset:0 sc1
    v_accvgpr_read_b32 v56, a32
    v_accvgpr_read_b32 v57, a33
    v_accvgpr_read_b32 v58, a34
    v_accvgpr_read_b32 v59, a35
    v_accvgpr_read_b32 v60, a36
    v_accvgpr_read_b32 v61, a37
    v_accvgpr_read_b32 v62, a38
    v_accvgpr_read_b32 v63, a39
    v_mul_f32 v56, v21, v56
    v_mul_f32 v57, v21, v57
    v_mul_f32 v58, v21, v58
    v_mul_f32 v59, v21, v59
    v_mul_f32 v60, v21, v60
    v_mul_f32 v61, v21, v61
    v_mul_f32 v62, v21, v62
    v_mul_f32 v63, v21, v63
    v_cvt_pk_bf16_f32 v56, v56, v57
    v_cvt_pk_bf16_f32 v57, v58, v59
    v_cvt_pk_bf16_f32 v58, v60, v61
    v_cvt_pk_bf16_f32 v59, v62, v63
    buffer_store_dwordx4 v[56:59], v2, s[8:11], s90 offen offset:1024 sc1
    s_add_u32 s90, s90, 131072
    v_accvgpr_read_b32 v48, a8
    v_accvgpr_read_b32 v49, a9
    v_accvgpr_read_b32 v50, a10
    v_accvgpr_read_b32 v51, a11
    v_accvgpr_read_b32 v52, a12
    v_accvgpr_read_b32 v53, a13
    v_accvgpr_read_b32 v54, a14
    v_accvgpr_read_b32 v55, a15
    v_mul_f32 v48, v20, v48
    v_mul_f32 v49, v20, v49
    v_mul_f32 v50, v20, v50
    v_mul_f32 v51, v20, v51
    v_mul_f32 v52, v20, v52
    v_mul_f32 v53, v20, v53
    v_mul_f32 v54, v20, v54
    v_mul_f32 v55, v20, v55
    v_cvt_pk_bf16_f32 v48, v48, v49
    v_cvt_pk_bf16_f32 v49, v50, v51
    v_cvt_pk_bf16_f32 v50, v52, v53
    v_cvt_pk_bf16_f32 v51, v54, v55
    buffer_store_dwordx4 v[48:51], v2, s[8:11], s90 offen offset:0 sc1
    v_accvgpr_read_b32 v56, a40
    v_accvgpr_read_b32 v57, a41
    v_accvgpr_read_b32 v58, a42
    v_accvgpr_read_b32 v59, a43
    v_accvgpr_read_b32 v60, a44
    v_accvgpr_read_b32 v61, a45
    v_accvgpr_read_b32 v62, a46
    v_accvgpr_read_b32 v63, a47
    v_mul_f32 v56, v21, v56
    v_mul_f32 v57, v21, v57
    v_mul_f32 v58, v21, v58
    v_mul_f32 v59, v21, v59
    v_mul_f32 v60, v21, v60
    v_mul_f32 v61, v21, v61
    v_mul_f32 v62, v21, v62
    v_mul_f32 v63, v21, v63
    v_cvt_pk_bf16_f32 v56, v56, v57
    v_cvt_pk_bf16_f32 v57, v58, v59
    v_cvt_pk_bf16_f32 v58, v60, v61
    v_cvt_pk_bf16_f32 v59, v62, v63
    buffer_store_dwordx4 v[56:59], v2, s[8:11], s90 offen offset:1024 sc1
    s_add_u32 s90, s90, 131072
    v_accvgpr_read_b32 v48, a16
    v_accvgpr_read_b32 v49, a17
    v_accvgpr_read_b32 v50, a18
    v_accvgpr_read_b32 v51, a19
    v_accvgpr_read_b32 v52, a20
    v_accvgpr_read_b32 v53, a21
    v_accvgpr_read_b32 v54, a22
    v_accvgpr_read_b32 v55, a23
    v_mul_f32 v48, v20, v48
    v_mul_f32 v49, v20, v49
    v_mul_f32 v50, v20, v50
    v_mul_f32 v51, v20, v51
    v_mul_f32 v52, v20, v52
    v_mul_f32 v53, v20, v53
    v_mul_f32 v54, v20, v54
    v_mul_f32 v55, v20, v55
    v_cvt_pk_bf16_f32 v48, v48, v49
    v_cvt_pk_bf16_f32 v49, v50, v51
    v_cvt_pk_bf16_f32 v50, v52, v53
    v_cvt_pk_bf16_f32 v51, v54, v55
    buffer_store_dwordx4 v[48:51], v2, s[8:11], s90 offen offset:0 sc1
    v_accvgpr_read_b32 v56, a48
    v_accvgpr_read_b32 v57, a49
    v_accvgpr_read_b32 v58, a50
    v_accvgpr_read_b32 v59, a51
    v_accvgpr_read_b32 v60, a52
    v_accvgpr_read_b32 v61, a53
    v_accvgpr_read_b32 v62, a54
    v_accvgpr_read_b32 v63, a55
    v_mul_f32 v56, v21, v56
    v_mul_f32 v57, v21, v57
    v_mul_f32 v58, v21, v58
    v_mul_f32 v59, v21, v59
    v_mul_f32 v60, v21, v60
    v_mul_f32 v61, v21, v61
    v_mul_f32 v62, v21, v62
    v_mul_f32 v63, v21, v63
    v_cvt_pk_bf16_f32 v56, v56, v57
    v_cvt_pk_bf16_f32 v57, v58, v59
    v_cvt_pk_bf16_f32 v58, v60, v61
    v_cvt_pk_bf16_f32 v59, v62, v63
    buffer_store_dwordx4 v[56:59], v2, s[8:11], s90 offen offset:1024 sc1
    s_add_u32 s90, s90, 131072
    v_accvgpr_read_b32 v48, a24
    v_accvgpr_read_b32 v49, a25
    v_accvgpr_read_b32 v50, a26
    v_accvgpr_read_b32 v51, a27
    v_accvgpr_read_b32 v52, a28
    v_accvgpr_read_b32 v53, a29
    v_accvgpr_read_b32 v54, a30
    v_accvgpr_read_b32 v55, a31
    v_mul_f32 v48, v20, v48
    v_mul_f32 v49, v20, v49
    v_mul_f32 v50, v20, v50
    v_mul_f32 v51, v20, v51
    v_mul_f32 v52, v20, v52
    v_mul_f32 v53, v20, v53
    v_mul_f32 v54, v20, v54
    v_mul_f32 v55, v20, v55
    v_cvt_pk_bf16_f32 v48, v48, v49
    v_cvt_pk_bf16_f32 v49, v50, v51
    v_cvt_pk_bf16_f32 v50, v52, v53
    v_cvt_pk_bf16_f32 v51, v54, v55
    buffer_store_dwordx4 v[48:51], v2, s[8:11], s90 offen offset:0 sc1
    v_accvgpr_read_b32 v56, a56
    v_accvgpr_read_b32 v57, a57
    v_accvgpr_read_b32 v58, a58
    v_accvgpr_read_b32 v59, a59
    v_accvgpr_read_b32 v60, a60
    v_accvgpr_read_b32 v61, a61
    v_accvgpr_read_b32 v62, a62
    v_accvgpr_read_b32 v63, a63
    v_mul_f32 v56, v21, v56
    v_mul_f32 v57, v21, v57
    v_mul_f32 v58, v21, v58
    v_mul_f32 v59, v21, v59
    v_mul_f32 v60, v21, v60
    v_mul_f32 v61, v21, v61
    v_mul_f32 v62, v21, v62
    v_mul_f32 v63, v21, v63
    v_cvt_pk_bf16_f32 v56, v56, v57
    v_cvt_pk_bf16_f32 v57, v58, v59
    v_cvt_pk_bf16_f32 v58, v60, v61
    v_cvt_pk_bf16_f32 v59, v62, v63
    buffer_store_dwordx4 v[56:59], v2, s[8:11], s90 offen offset:1024 sc1
    s_add_u32 s90, s90, 131072
    s_lshr_b32 s53, s16, 1
    s_and_b32 s40, s16, 1
    s_mul_i32 s90, s95, 5373952
    s_lshl_b32 s57, s97, 8
    s_add_u32 s57, s57, s90
    v_lshrrev_b32 v20, 4, v1
    s_lshl_b32 s90, s16, 4
    v_add_u32 v21, s90, v20
    v_lshlrev_b32 v21, 11, v21
    v_lshlrev_b32 v20, 1, v20
    v_and_b32 v22, 15, v1
    v_xor_b32 v20, v20, v22
    v_xor_b32 v22, 0, v20
    v_lshl_add_u32 v16, v22, 4, v21
    v_xor_b32 v22, 8, v20
    v_lshl_add_u32 v17, v22, 4, v21
    v_add_u32 v17, 7168, v17
    v_xor_b32 v22, 0, v20
    v_lshl_add_u32 v18, v22, 4, v21
    v_add_u32 v18, 14336, v18
    v_xor_b32 v22, 8, v20
    v_lshl_add_u32 v19, v22, 4, v21
    v_add_u32 v19, 21504, v19
    s_mov_b32 s24, s48
    s_mov_b32 s25, s49
    s_mov_b32 s26, 8388608
    s_mov_b32 s38, 268435456
    s_mov_b32 s28, s54
    s_mov_b32 s29, s55
    s_mov_b32 s30, 8388608
    s_lshl_b32 s90, s96, 13
    s_lshl_b32 s91, s40, 12
    s_add_u32 s90, s90, s91
    s_lshl_b32 s91, s53, 17
    s_add_u32 s69, s90, s91
    s_mul_i32 s90, s95, 10747904
    s_add_u32 s56, s69, s90
    s_add_u32 s56, s56, 67108864
    s_add_u32 s69, s69, 83886080
    s_add_u32 m0, s60, 16384
    s_nop 0
    buffer_load_dwordx4 v16, s[24:27], s57 offen offset:0 lds
    buffer_load_dwordx4 v17, s[24:27], s57 offen offset:1024 lds
    buffer_load_dwordx4 v18, s[24:27], s57 offen offset:2048 lds
    buffer_load_dwordx4 v19, s[24:27], s57 offen offset:3072 lds
    s_add_u32 s57, s57, 131072
    s_add_u32 m0, s60, 49152
    s_nop 0
    buffer_load_dwordx4 v16, s[24:27], s57 offen offset:0 lds
    buffer_load_dwordx4 v17, s[24:27], s57 offen offset:1024 lds
    buffer_load_dwordx4 v18, s[24:27], s57 offen offset:2048 lds
    buffer_load_dwordx4 v19, s[24:27], s57 offen offset:3072 lds
    s_add_u32 s57, s57, 131072
    s_add_u32 m0, s60, 81920
    s_nop 0
    buffer_load_dwordx4 v16, s[24:27], s57 offen offset:0 lds
    buffer_load_dwordx4 v17, s[24:27], s57 offen offset:1024 lds
    buffer_load_dwordx4 v18, s[24:27], s57 offen offset:2048 lds
    buffer_load_dwordx4 v19, s[24:27], s57 offen offset:3072 lds
    s_add_u32 s57, s57, 131072
    s_add_u32 m0, s60, 114688
    s_nop 0
    buffer_load_dwordx4 v16, s[24:27], s57 offen offset:0 lds
    buffer_load_dwordx4 v17, s[24:27], s57 offen offset:1024 lds
    buffer_load_dwordx4 v18, s[24:27], s57 offen offset:2048 lds
    buffer_load_dwordx4 v19, s[24:27], s57 offen offset:3072 lds
    s_add_u32 s57, s57, 131072
    s_waitcnt vmcnt(39)
    v_cmp_ne_u64 s[76:77], s[4:5], v[4:5]
    s_mul_i32 s91, s95, 20
    s_nop 2
    s_lshr_b32 s90, s76, s91
    s_ff1_i32_b32 s90, s90
    s_lshl_b32 s68, s90, 1
    s_mul_i32 s91, s95, 1
    s_sub_i32 s68, s68, s91
    s_cmp_lt_i32 s90, 0
    s_cselect_b32 s68, 1000, s68
    s_mov_b32 s99, 0
    s_cmp_gt_i32 s68, 4
    s_cbranch_scc0 m_x1116
    s_mov_b32 s99, 1
    s_add_u32 m0, s60, 0
    s_nop 0
    buffer_load_dwordx4 v2, s[36:39], s56 offen offset:0 sc1 lds
    buffer_load_dwordx4 v2, s[36:39], s56 offen offset:1024 sc1 lds
    buffer_load_dwordx4 v2, s[36:39], s56 offen offset:2048 sc1 lds
    buffer_load_dwordx4 v2, s[36:39], s56 offen offset:3072 sc1 lds
    s_add_u32 s56, s56, 262144
    s_add_u32 m0, s60, 32768
    s_nop 0
    buffer_load_dwordx4 v2, s[36:39], s56 offen offset:0 sc1 lds
    buffer_load_dwordx4 v2, s[36:39], s56 offen offset:1024 sc1 lds
    buffer_load_dwordx4 v2, s[36:39], s56 offen offset:2048 sc1 lds
    buffer_load_dwordx4 v2, s[36:39], s56 offen offset:3072 sc1 lds
    s_add_u32 s56, s56, 262144
    s_add_u32 m0, s60, 65536
    s_nop 0
    buffer_load_dwordx4 v2, s[36:39], s56 offen offset:0 sc1 lds
    buffer_load_dwordx4 v2, s[36:39], s56 offen offset:1024 sc1 lds
    buffer_load_dwordx4 v2, s[36:39], s56 offen offset:2048 sc1 lds
    buffer_load_dwordx4 v2, s[36:39], s56 offen offset:3072 sc1 lds
    s_add_u32 s56, s56, 262144
    s_add_u32 m0, s60, 98304
    s_nop 0
    buffer_load_dwordx4 v2, s[36:39], s56 offen offset:0 sc1 lds
    buffer_load_dwordx4 v2, s[36:39], s56 offen offset:1024 sc1 lds
    buffer_load_dwordx4 v2, s[36:39], s56 offen offset:2048 sc1 lds
    buffer_load_dwordx4 v2, s[36:39], s56 offen offset:3072 sc1 lds
    s_add_u32 s56, s56, 262144
    s_add_u32 m0, s60, 131072
    s_nop 0
    buffer_load_dwordx4 v2, s[36:39], s56 offen offset:0 sc1 lds
    buffer_load_dwordx4 v2, s[36:39], s56 offen offset:1024 sc1 lds
    buffer_load_dwordx4 v2, s[36:39], s56 offen offset:2048 sc1 lds
    buffer_load_dwordx4 v2, s[36:39], s56 offen offset:3072 sc1 lds
    s_add_u32 s56, s56, 262144
m_x1116:
    s_lshl_b32 s90, s53, 12
    v_add_u32 v6, s90, v2
    v_lshrrev_b32 v48, 2, v1
    v_lshlrev_b32 v48, 8, v48
    v_and_b32 v49, 3, v1
    v_lshl_add_u32 v48, v49, 3, v48
    v_add_u32 v48, 16384, v48
    v_bfe_u32 v49, v1, 2, 3
    s_lshl_b32 s90, s40, 2
    v_xor_b32 v49, s90, v49
    v_xor_b32 v50, 0, v49
    v_lshl_add_u32 v12, v50, 5, v48
    v_xor_b32 v50, 1, v49
    v_lshl_add_u32 v13, v50, 5, v48
    v_xor_b32 v50, 2, v49
    v_lshl_add_u32 v14, v50, 5, v48
    v_xor_b32 v50, 3, v49
    v_lshl_add_u32 v15, v50, 5, v48
    v_and_b32 v48, 15, v1
    v_lshlrev_b32 v48, 12, v48
    v_lshlrev_b32 v48, s95, v48
    v_bfe_u32 v49, v1, 4, 1
    v_lshl_add_u32 v48, v49, 5, v48
    v_lshrrev_b32 v49, 5, v1
    v_lshl_add_u32 v7, v49, 4, v48
    s_lshl_b32 s90, s96, 3
    s_lshl_b32 s91, s53, 2
    s_add_u32 s90, s90, s91
    s_lshl_b32 s91, s90, 16
    s_add_u32 s91, s91, 2048
    s_and_b32 s92, s90, 63
    s_lshl_b32 s92, s92, 17
    s_lshr_b32 s93, s90, 6
    s_lshl_b32 s93, s93, 12
    s_add_u32 s92, s92, s93
    s_cmp_eq_u32 s95, 1
    s_cselect_b32 s71, s92, s91
    s_lshl_b32 s72, 0x10000, s95
    s_lshl_b32 s92, s97, 8
    s_lshl_b32 s93, s40, 7
    s_add_u32 s71, s71, s92
    s_add_u32 s71, s71, s93
    v_mov_b64 v[64:65], 0
    v_mov_b64 v[66:67], 0
    v_mov_b64 v[68:69], 0
    v_mov_b64 v[70:71], 0
    v_mov_b64 v[72:73], 0
    v_mov_b64 v[74:75], 0
    v_mov_b64 v[76:77], 0
    v_mov_b64 v[78:79], 0
    v_mov_b64 v[80:81], 0
    v_mov_b64 v[82:83], 0
    v_mov_b64 v[84:85], 0
    v_mov_b64 v[86:87], 0
    v_mov_b64 v[88:89], 0
    v_mov_b64 v[90:91], 0
    v_mov_b64 v[92:93], 0
    v_mov_b64 v[94:95], 0
    v_mov_b64 v[96:97], 0
    v_mov_b64 v[98:99], 0
    v_mov_b64 v[100:101], 0
    v_mov_b64 v[102:103], 0
    v_mov_b64 v[104:105], 0
    v_mov_b64 v[106:107], 0
    v_mov_b64 v[108:109], 0
    v_mov_b64 v[110:111], 0
    v_mov_b64 v[112:113], 0
    v_mov_b64 v[114:115], 0
    v_mov_b64 v[116:117], 0
    v_mov_b64 v[118:119], 0
    v_mov_b64 v[120:121], 0
    v_mov_b64 v[122:123], 0
    v_mov_b64 v[124:125], 0
    v_mov_b64 v[126:127], 0
    v_and_b32 v48, 15, v1
    v_lshrrev_b32 v49, 4, v1
    v_lshlrev_b32 v49, 2, v49
    v_sub_u32 v48, v48, v49
    v_cmp_ge_i32 vcc, -9, v48
    v_subrev_u32 v50, 0, v48
    v_cmp_ge_u32 s[76:77], 7, v50
    s_nop 0
    v_cndmask_b32 v128, v9, 0, vcc
    v_cndmask_b32 v132, v9, 0, s[76:77]
    v_cmp_ge_i32 vcc, -8, v48
    v_subrev_u32 v50, 1, v48
    v_cmp_ge_u32 s[76:77], 7, v50
    s_nop 0
    v_cndmask_b32 v129, v9, 0, vcc
    v_cndmask_b32 v133, v9, 0, s[76:77]
    v_cmp_ge_i32 vcc, -7, v48
    v_subrev_u32 v50, 2, v48
    v_cmp_ge_u32 s[76:77], 7, v50
    s_nop 0
    v_cndmask_b32 v130, v9, 0, vcc
    v_cndmask_b32 v134, v9, 0, s[76:77]
    v_cmp_ge_i32 vcc, -6, v48
    v_subrev_u32 v50, 3, v48
    v_cmp_ge_u32 s[76:77], 7, v50
    s_nop 0
    v_cndmask_b32 v131, v9, 0, vcc
    v_cndmask_b32 v135, v9, 0, s[76:77]
    s_cmp_eq_u32 s81, 0
    s_cselect_b64 vcc, -1, 0
    s_nop 0
    v_cndmask_b32 v136, v128, v9, vcc
    v_cndmask_b32 v137, v129, v9, vcc
    v_cndmask_b32 v138, v130, v9, vcc
    v_cndmask_b32 v139, v131, v9, vcc
    s_lshl_b32 s90, s80, 10
    s_lshr_b32 s91, s2, 3
    s_lshl_b32 s91, s91, 17
    s_add_u32 s90, s90, s91
    s_add_u32 s80, s90, 83886080
    s_add_u32 s59, s60, 131072
    s_mov_b32 s58, 0
    s_mov_b32 s100, 32768
    s_mov_b32 s64, 0
    s_mov_b32 s67, 0
    s_waitcnt vmcnt(36)
    s_cmp_eq_u32 s99, 1
    s_cbranch_scc1 m_x2117
    s_waitcnt vmcnt(16)
m_x2117:
    s_barrier
    s_lshl_b32 s91, s33, 5
    s_add_u32 s91, s91, s32
    s_lshl_b32 s91, s91, 3
    s_add_u32 s91, s91, 7936
    s_cmp_lg_u32 s16, 0
    s_cbranch_scc1 m_np119
    v_mov_b32 v60, s4
    v_mov_b32 v61, s5
    s_add_u32 s90, s91, 117440512
    s_mov_b64 exec, 1
    buffer_store_dwordx2 v[60:61], off, s[8:11], s90 sc1
    s_mov_b64 exec, -1
m_np119:
    s_cmp_eq_u32 s17, -1
    s_cbranch_scc1 m_pb120
    s_cmp_lg_u32 s16, 0
    s_cbranch_scc1 m_np121
    v_mov_b32 v60, s4
    v_mov_b32 v61, s5
    s_add_u32 s90, s17, 117440512
    s_mov_b64 exec, 1
    buffer_store_dwordx2 v[60:61], off, s[8:11], s90 sc1
    s_mov_b64 exec, -1
m_np121:
m_pb120:
    s_cmp_eq_u32 s99, 1
    s_cbranch_scc1 m_x3118
    s_mov_b32 s3, 1048576
m_spin123:
    buffer_load_dwordx2 v[4:5], v10, s[8:11], s52 offen sc1
    s_waitcnt vmcnt(0)
    v_cmp_ne_u64 s[76:77], s[4:5], v[4:5]
    s_mul_i32 s91, s95, 20
    s_nop 2
    s_lshr_b32 s90, s76, s91
    s_ff1_i32_b32 s90, s90
    s_lshl_b32 s68, s90, 1
    s_mul_i32 s91, s95, 1
    s_sub_i32 s68, s68, s91
    s_cmp_lt_i32 s90, 0
    s_cselect_b32 s68, 1000, s68
    s_cmp_gt_i32 s68, 4
    s_cbranch_scc1 m_ok124
    s_sub_u32 s3, s3, 1
    s_cbranch_scc1 m_ok124
    s_sleep 4
    s_branch m_spin123
m_ok124:
    s_add_u32 m0, s60, 0
    s_nop 0
    buffer_load_dwordx4 v2, s[36:39], s56 offen offset:0 sc1 lds
    buffer_load_dwordx4 v2, s[36:39], s56 offen offset:1024 sc1 lds
    buffer_load_dwordx4 v2, s[36:39], s56 offen offset:2048 sc1 lds
    buffer_load_dwordx4 v2, s[36:39], s56 offen offset:3072 sc1 lds
    s_add_u32 s56, s56, 262144
    s_add_u32 m0, s60, 32768
    s_nop 0
    buffer_load_dwordx4 v2, s[36:39], s56 offen offset:0 sc1 lds
    buffer_load_dwordx4 v2, s[36:39], s56 offen offset:1024 sc1 lds
    buffer_load_dwordx4 v2, s[36:39], s56 offen offset:2048 sc1 lds
    buffer_load_dwordx4 v2, s[36:39], s56 offen offset:3072 sc1 lds
    s_add_u32 s56, s56, 262144
    s_add_u32 m0, s60, 65536
    s_nop 0
    buffer_load_dwordx4 v2, s[36:39], s56 offen offset:0 sc1 lds
    buffer_load_dwordx4 v2, s[36:39], s56 offen offset:1024 sc1 lds
    buffer_load_dwordx4 v2, s[36:39], s56 offen offset:2048 sc1 lds
    buffer_load_dwordx4 v2, s[36:39], s56 offen offset:3072 sc1 lds
    s_add_u32 s56, s56, 262144
    s_add_u32 m0, s60, 98304
    s_nop 0
    buffer_load_dwordx4 v2, s[36:39], s56 offen offset:0 sc1 lds
    buffer_load_dwordx4 v2, s[36:39], s56 offen offset:1024 sc1 lds
    buffer_load_dwordx4 v2, s[36:39], s56 offen offset:2048 sc1 lds
    buffer_load_dwordx4 v2, s[36:39], s56 offen offset:3072 sc1 lds
    s_add_u32 s56, s56, 262144
    s_add_u32 m0, s60, 131072
    s_nop 0
    buffer_load_dwordx4 v2, s[36:39], s56 offen offset:0 sc1 lds
    buffer_load_dwordx4 v2, s[36:39], s56 offen offset:1024 sc1 lds
    buffer_load_dwordx4 v2, s[36:39], s56 offen offset:2048 sc1 lds
    buffer_load_dwordx4 v2, s[36:39], s56 offen offset:3072 sc1 lds
    s_add_u32 s56, s56, 262144
    s_waitcnt vmcnt(4)
    s_branch m_x4122
m_x3118:
    s_waitcnt vmcnt(4)
m_x4122:
    s_barrier
    ds_read_b128 a[0:3], v6 offset:0
    ds_read_b64_tr_b16 a[16:17], v12 offset:0
    ds_read_b64_tr_b16 a[18:19], v12 offset:4096
    ds_read_b128 a[4:7], v6 offset:1024
    ds_read_b128 a[8:11], v6 offset:2048
    ds_read_b128 a[12:15], v6 offset:3072
    ds_read_b64_tr_b16 a[20:21], v13 offset:0
    ds_read_b64_tr_b16 a[22:23], v13 offset:4096
    ds_read_b64_tr_b16 a[24:25], v14 offset:0
    ds_read_b64_tr_b16 a[26:27], v14 offset:4096
    ds_read_b64_tr_b16 a[28:29], v15 offset:0
    ds_read_b64_tr_b16 a[30:31], v15 offset:4096
    s_cmp_gt_i32 s68, 5
    s_cbranch_scc0 m_lp130
m_lr131:
    s_waitcnt lgkmcnt(9)
    v_mfma_f32_16x16x32_bf16 v[64:67], a[16:19], a[0:3], v[64:67]
    s_add_u32 m0, s59, 16384
    ds_read_b128 a[32:35], v6 offset:8192
    v_mfma_f32_16x16x32_bf16 v[148:151], v[208:211], v[192:195], v[136:139]
    v_mfma_f32_16x16x32_bf16 v[152:155], v[212:215], v[192:195], v[132:135]
    s_waitcnt lgkmcnt(9)
    v_mfma_f32_16x16x32_bf16 v[72:75], a[16:19], a[4:7], v[72:75]
    ds_read_b64_tr_b16 a[48:49], v12 offset:8192
    buffer_load_dwordx4 v16, s[24:27], s57 offen offset:0 lds
    v_mfma_f32_16x16x32_bf16 v[156:159], v[212:215], v[196:199], v[128:131]
    s_waitcnt lgkmcnt(9)
    v_mfma_f32_16x16x32_bf16 v[80:83], a[16:19], a[8:11], v[80:83]
    s_add_u32 s59, s58, s60
    ds_read_b64_tr_b16 a[50:51], v12 offset:12288
    v_mfma_f32_16x16x32_bf16 v[160:163], v[216:219], v[196:199], v[132:135]
    v_mfma_f32_16x16x32_bf16 v[164:167], v[216:219], v[200:203], v[128:131]
    s_waitcnt lgkmcnt(9)
    v_mfma_f32_16x16x32_bf16 v[88:91], a[16:19], a[12:15], v[88:91]
    s_add_u32 s58, s58, 32768
    ds_read_b128 a[36:39], v6 offset:9216
    v_mfma_f32_16x16x32_bf16 v[168:171], v[220:223], v[200:203], v[132:135]
    v_mfma_f32_16x16x32_bf16 v[172:175], v[220:223], v[204:207], v[128:131]
    s_waitcnt lgkmcnt(8)
    v_mfma_f32_16x16x32_bf16 v[68:71], a[20:23], a[0:3], v[68:71]
    s_cmp_ge_u32 s58, 163840
    ds_read_b128 a[40:43], v6 offset:10240
    v_mfma_f32_16x16x32_bf16 v[176:179], v[224:227], v[204:207], v[132:135]
    s_nop 1
    v_mfma_f32_16x16x32_bf16 v[76:79], a[20:23], a[4:7], v[76:79]
    ds_read_b128 a[44:47], v6 offset:11264
    buffer_load_dwordx4 v17, s[24:27], s57 offen offset:1024 lds
    s_nop 1
    v_mfma_f32_16x16x32_bf16 v[84:87], a[20:23], a[8:11], v[84:87]
    s_cselect_b32 s66, 4294836224, s100
    ds_read_b64_tr_b16 a[52:53], v13 offset:8192
    s_nop 1
    s_nop 1
    v_mfma_f32_16x16x32_bf16 v[92:95], a[20:23], a[12:15], v[92:95]
    s_cselect_b32 s58, 0, s58
    ds_read_b64_tr_b16 a[54:55], v13 offset:12288
    v_max3_f32 v140, v148, v149, v150
    v_max3_f32 v141, v156, v157, v158
    s_waitcnt lgkmcnt(10)
    v_mfma_f32_16x16x32_bf16 v[96:99], a[24:27], a[0:3], v[96:99]
    ds_read_b64_tr_b16 a[56:57], v14 offset:8192
    v_max3_f32 v142, v164, v165, v166
    v_max3_f32 v143, v172, v173, v174
    v_mfma_f32_16x16x32_bf16 v[104:107], a[24:27], a[4:7], v[104:107]
    ds_read_b64_tr_b16 a[58:59], v14 offset:12288
    buffer_load_dwordx4 v18, s[24:27], s57 offen offset:2048 lds
    v_max3_f32 v140, v140, v151, v152
    v_mfma_f32_16x16x32_bf16 v[112:115], a[24:27], a[8:11], v[112:115]
    ds_read_b64_tr_b16 a[60:61], v15 offset:8192
    v_max3_f32 v141, v141, v159, v160
    v_max3_f32 v142, v142, v167, v168
    v_mfma_f32_16x16x32_bf16 v[120:123], a[24:27], a[12:15], v[120:123]
    ds_read_b64_tr_b16 a[62:63], v15 offset:12288
    v_max3_f32 v143, v143, v175, v176
    v_max3_f32 v140, v140, v153, v154
    s_waitcnt lgkmcnt(12)
    v_mfma_f32_16x16x32_bf16 v[100:103], a[28:31], a[0:3], v[100:103]
    v_add_u32 v6, s66, v6
    v_add_u32 v12, s66, v12
    v_max3_f32 v141, v141, v161, v162
    v_mfma_f32_16x16x32_bf16 v[108:111], a[28:31], a[4:7], v[108:111]
    buffer_load_dwordx4 v19, s[24:27], s57 offen offset:3072 lds
    v_max3_f32 v142, v142, v169, v170
    v_mfma_f32_16x16x32_bf16 v[116:119], a[28:31], a[8:11], v[116:119]
    s_add_u32 s57, s57, 131072
    v_add_u32 v13, s66, v13
    v_add_u32 v14, s66, v14
    v_max3_f32 v143, v143, v177, v178
    v_mfma_f32_16x16x32_bf16 v[124:127], a[28:31], a[12:15], v[124:127]
    s_mov_b32 m0, s59
    v_add_u32 v15, s66, v15
    v_max_f32 v140, v140, v155
    s_waitcnt vmcnt(24) lgkmcnt(0)
    v_mfma_f32_16x16x32_bf16 v[64:67], a[48:51], a[32:35], v[64:67]
    s_barrier
    v_max_f32 v141, v141, v163
    v_max_f32 v142, v142, v171
    v_mfma_f32_16x16x32_bf16 v[72:75], a[48:51], a[36:39], v[72:75]
    ds_read_b128 a[0:3], v6 offset:0
    buffer_load_dwordx4 v2, s[36:39], s56 offen offset:0 sc1 lds
    v_max_f32 v143, v143, v179
    v_mfma_f32_16x16x32_bf16 v[80:83], a[48:51], a[40:43], v[80:83]
    ds_read_b64_tr_b16 a[16:17], v12 offset:0
    v_mov_b32 v144, v140
    v_mov_b32 v145, v141
    v_mfma_f32_16x16x32_bf16 v[88:91], a[48:51], a[44:47], v[88:91]
    ds_read_b64_tr_b16 a[18:19], v12 offset:4096
    v_mov_b32 v146, v142
    v_mov_b32 v147, v143
    v_mfma_f32_16x16x32_bf16 v[68:71], a[52:55], a[32:35], v[68:71]
    ds_read_b128 a[4:7], v6 offset:1024
    s_nop 1
    v_permlane32_swap_b32 v140, v144
    v_mfma_f32_16x16x32_bf16 v[76:79], a[52:55], a[36:39], v[76:79]
    ds_read_b128 a[8:11], v6 offset:2048
    buffer_load_dwordx4 v2, s[36:39], s56 offen offset:1024 sc1 lds
    v_permlane32_swap_b32 v141, v145
    v_mfma_f32_16x16x32_bf16 v[84:87], a[52:55], a[40:43], v[84:87]
    ds_read_b128 a[12:15], v6 offset:3072
    v_permlane32_swap_b32 v142, v146
    v_permlane32_swap_b32 v143, v147
    v_mfma_f32_16x16x32_bf16 v[92:95], a[52:55], a[44:47], v[92:95]
    ds_read_b64_tr_b16 a[20:21], v13 offset:0
    s_nop 1
    v_max_f32 v140, v140, v144
    v_mfma_f32_16x16x32_bf16 v[96:99], a[56:59], a[32:35], v[96:99]
    ds_read_b64_tr_b16 a[22:23], v13 offset:4096
    v_max_f32 v141, v141, v145
    v_max_f32 v142, v142, v146
    v_mfma_f32_16x16x32_bf16 v[104:107], a[56:59], a[36:39], v[104:107]
    ds_read_b64_tr_b16 a[24:25], v14 offset:0
    buffer_load_dwordx4 v2, s[36:39], s56 offen offset:2048 sc1 lds
    v_max_f32 v143, v143, v147
    v_mfma_f32_16x16x32_bf16 v[112:115], a[56:59], a[40:43], v[112:115]
    ds_read_b64_tr_b16 a[26:27], v14 offset:4096
    v_mov_b32 v144, v140
    v_mov_b32 v145, v141
    v_mfma_f32_16x16x32_bf16 v[120:123], a[56:59], a[44:47], v[120:123]
    ds_read_b64_tr_b16 a[28:29], v15 offset:0
    v_mov_b32 v146, v142
    v_mov_b32 v147, v143
    v_mfma_f32_16x16x32_bf16 v[100:103], a[60:63], a[32:35], v[100:103]
    s_add_u32 s64, s64, 1
    ds_read_b64_tr_b16 a[30:31], v15 offset:4096
    s_nop 1
    v_permlane16_swap_b32 v140, v144
    v_mfma_f32_16x16x32_bf16 v[108:111], a[60:63], a[36:39], v[108:111]
    buffer_load_dwordx4 v2, s[36:39], s56 offen offset:3072 sc1 lds
    v_permlane16_swap_b32 v141, v145
    v_mfma_f32_16x16x32_bf16 v[116:119], a[60:63], a[40:43], v[116:119]
    s_add_u32 s56, s56, 262144
    v_permlane16_swap_b32 v142, v146
    v_permlane16_swap_b32 v143, v147
    v_mfma_f32_16x16x32_bf16 v[124:127], a[60:63], a[44:47], v[124:127]
    s_nop 1
    v_max_f32 v140, v140, v144
    s_cmp_gt_i32 s68, 6
    s_cbranch_scc0 m_lp132
m_lr133:
    s_waitcnt lgkmcnt(9)
    v_mfma_f32_16x16x32_bf16 v[64:67], a[16:19], a[0:3], v[64:67]
    s_add_u32 m0, s59, 16384
    ds_read_b128 a[32:35], v6 offset:8192
    v_max_f32 v141, v141, v145
    v_max_f32 v142, v142, v146
    s_waitcnt lgkmcnt(9)
    v_mfma_f32_16x16x32_bf16 v[72:75], a[16:19], a[4:7], v[72:75]
    ds_read_b64_tr_b16 a[48:49], v12 offset:8192
    buffer_load_dwordx4 v16, s[24:27], s57 offen offset:0 lds
    v_max_f32 v143, v143, v147
    s_waitcnt lgkmcnt(9)
    v_mfma_f32_16x16x32_bf16 v[80:83], a[16:19], a[8:11], v[80:83]
    s_add_u32 s59, s58, s60
    ds_read_b64_tr_b16 a[50:51], v12 offset:12288
    v_sub_f32 v148, v148, v140
    v_sub_f32 v149, v149, v140
    s_waitcnt lgkmcnt(9)
    v_mfma_f32_16x16x32_bf16 v[88:91], a[16:19], a[12:15], v[88:91]
    s_add_u32 s58, s58, 32768
    ds_read_b128 a[36:39], v6 offset:9216
    v_sub_f32 v150, v150, v140
    v_sub_f32 v151, v151, v140
    s_waitcnt lgkmcnt(8)
    v_mfma_f32_16x16x32_bf16 v[68:71], a[20:23], a[0:3], v[68:71]
    s_cmp_ge_u32 s58, 163840
    ds_read_b128 a[40:43], v6 offset:10240
    v_sub_f32 v152, v152, v140
    v_sub_f32 v153, v153, v140
    v_mfma_f32_16x16x32_bf16 v[76:79], a[20:23], a[4:7], v[76:79]
    ds_read_b128 a[44:47], v6 offset:11264
    buffer_load_dwordx4 v17, s[24:27], s57 offen offset:1024 lds
    v_sub_f32 v154, v154, v140
    v_mfma_f32_16x16x32_bf16 v[84:87], a[20:23], a[8:11], v[84:87]
    s_cselect_b32 s66, 4294836224, s100
    ds_read_b64_tr_b16 a[52:53], v13 offset:8192
    v_sub_f32 v155, v155, v140
    v_sub_f32 v156, v156, v141
    v_mfma_f32_16x16x32_bf16 v[92:95], a[20:23], a[12:15], v[92:95]
    s_cselect_b32 s58, 0, s58
    ds_read_b64_tr_b16 a[54:55], v13 offset:12288
    v_sub_f32 v157, v157, v141
    v_sub_f32 v158, v158, v141
    s_waitcnt lgkmcnt(10)
    v_mfma_f32_16x16x32_bf16 v[96:99], a[24:27], a[0:3], v[96:99]
    ds_read_b64_tr_b16 a[56:57], v14 offset:8192
    v_sub_f32 v159, v159, v141
    v_sub_f32 v160, v160, v141
    v_mfma_f32_16x16x32_bf16 v[104:107], a[24:27], a[4:7], v[104:107]
    ds_read_b64_tr_b16 a[58:59], v14 offset:12288
    buffer_load_dwordx4 v18, s[24:27], s57 offen offset:2048 lds
    v_sub_f32 v161, v161, v141
    v_mfma_f32_16x16x32_bf16 v[112:115], a[24:27], a[8:11], v[112:115]
    ds_read_b64_tr_b16 a[60:61], v15 offset:8192
    v_sub_f32 v162, v162, v141
    v_sub_f32 v163, v163, v141
    v_mfma_f32_16x16x32_bf16 v[120:123], a[24:27], a[12:15], v[120:123]
    ds_read_b64_tr_b16 a[62:63], v15 offset:12288
    v_sub_f32 v164, v164, v142
    v_sub_f32 v165, v165, v142
    s_waitcnt lgkmcnt(12)
    v_mfma_f32_16x16x32_bf16 v[100:103], a[28:31], a[0:3], v[100:103]
    v_add_u32 v6, s66, v6
    v_add_u32 v12, s66, v12
    v_sub_f32 v166, v166, v142
    v_mfma_f32_16x16x32_bf16 v[108:111], a[28:31], a[4:7], v[108:111]
    buffer_load_dwordx4 v19, s[24:27], s57 offen offset:3072 lds
    v_sub_f32 v167, v167, v142
    v_mfma_f32_16x16x32_bf16 v[116:119], a[28:31], a[8:11], v[116:119]
    s_add_u32 s57, s57, 131072
    v_add_u32 v13, s66, v13
    v_add_u32 v14, s66, v14
    v_sub_f32 v168, v168, v142
    v_mfma_f32_16x16x32_bf16 v[124:127], a[28:31], a[12:15], v[124:127]
    s_mov_b32 m0, s59
    v_add_u32 v15, s66, v15
    v_sub_f32 v169, v169, v142
    s_waitcnt vmcnt(24) lgkmcnt(0)
    v_mfma_f32_16x16x32_bf16 v[64:67], a[48:51], a[32:35], v[64:67]
    s_barrier
    v_sub_f32 v170, v170, v142
    v_sub_f32 v171, v171, v142
    v_mfma_f32_16x16x32_bf16 v[72:75], a[48:51], a[36:39], v[72:75]
    ds_read_b128 a[0:3], v6 offset:0
    buffer_load_dwordx4 v2, s[36:39], s56 offen offset:0 sc1 lds
    v_sub_f32 v172, v172, v143
    v_mfma_f32_16x16x32_bf16 v[80:83], a[48:51], a[40:43], v[80:83]
    ds_read_b64_tr_b16 a[16:17], v12 offset:0
    v_sub_f32 v173, v173, v143
    v_sub_f32 v174, v174, v143
    v_mfma_f32_16x16x32_bf16 v[88:91], a[48:51], a[44:47], v[88:91]
    ds_read_b64_tr_b16 a[18:19], v12 offset:4096
    v_sub_f32 v175, v175, v143
    v_sub_f32 v176, v176, v143
    v_mfma_f32_16x16x32_bf16 v[68:71], a[52:55], a[32:35], v[68:71]
    ds_read_b128 a[4:7], v6 offset:1024
    v_sub_f32 v177, v177, v143
    v_sub_f32 v178, v178, v143
    v_mfma_f32_16x16x32_bf16 v[76:79], a[52:55], a[36:39], v[76:79]
    ds_read_b128 a[8:11], v6 offset:2048
    buffer_load_dwordx4 v2, s[36:39], s56 offen offset:1024 sc1 lds
    v_sub_f32 v179, v179, v143
    v_mfma_f32_16x16x32_bf16 v[84:87], a[52:55], a[40:43], v[84:87]
    ds_read_b128 a[12:15], v6 offset:3072
    v_exp_f32 v148, v148
    v_exp_f32 v149, v149
    v_mfma_f32_16x16x32_bf16 v[92:95], a[52:55], a[44:47], v[92:95]
    ds_read_b64_tr_b16 a[20:21], v13 offset:0
    v_exp_f32 v150, v150
    v_exp_f32 v151, v151
    v_mfma_f32_16x16x32_bf16 v[96:99], a[56:59], a[32:35], v[96:99]
    ds_read_b64_tr_b16 a[22:23], v13 offset:4096
    v_exp_f32 v152, v152
    v_exp_f32 v153, v153
    v_mfma_f32_16x16x32_bf16 v[104:107], a[56:59], a[36:39], v[104:107]
    ds_read_b64_tr_b16 a[24:25], v14 offset:0
    buffer_load_dwordx4 v2, s[36:39], s56 offen offset:2048 sc1 lds
    v_exp_f32 v154, v154
    v_mfma_f32_16x16x32_bf16 v[112:115], a[56:59], a[40:43], v[112:115]
    ds_read_b64_tr_b16 a[26:27], v14 offset:4096
    v_exp_f32 v155, v155
    v_exp_f32 v156, v156
    v_mfma_f32_16x16x32_bf16 v[120:123], a[56:59], a[44:47], v[120:123]
    ds_read_b64_tr_b16 a[28:29], v15 offset:0
    v_exp_f32 v157, v157
    v_exp_f32 v158, v158
    v_mfma_f32_16x16x32_bf16 v[100:103], a[60:63], a[32:35], v[100:103]
    s_add_u32 s64, s64, 1
    ds_read_b64_tr_b16 a[30:31], v15 offset:4096
    v_exp_f32 v159, v159
    v_exp_f32 v160, v160
    v_mfma_f32_16x16x32_bf16 v[108:111], a[60:63], a[36:39], v[108:111]
    buffer_load_dwordx4 v2, s[36:39], s56 offen offset:3072 sc1 lds
    v_exp_f32 v161, v161
    v_mfma_f32_16x16x32_bf16 v[116:119], a[60:63], a[40:43], v[116:119]
    s_add_u32 s56, s56, 262144
    v_exp_f32 v162, v162
    v_exp_f32 v163, v163
    v_mfma_f32_16x16x32_bf16 v[124:127], a[60:63], a[44:47], v[124:127]
    v_exp_f32 v164, v164
    v_exp_f32 v165, v165
    s_cmp_gt_i32 s68, 7
    s_cbranch_scc0 m_lp134
m_lr135:
    s_waitcnt lgkmcnt(9)
    v_mfma_f32_16x16x32_bf16 v[64:67], a[16:19], a[0:3], v[64:67]
    s_add_u32 m0, s59, 16384
    ds_read_b128 a[32:35], v6 offset:8192
    v_exp_f32 v166, v166
    v_exp_f32 v167, v167
    s_waitcnt lgkmcnt(9)
    v_mfma_f32_16x16x32_bf16 v[72:75], a[16:19], a[4:7], v[72:75]
    ds_read_b64_tr_b16 a[48:49], v12 offset:8192
    buffer_load_dwordx4 v16, s[24:27], s57 offen offset:0 lds
    v_exp_f32 v168, v168
    s_waitcnt lgkmcnt(9)
    v_mfma_f32_16x16x32_bf16 v[80:83], a[16:19], a[8:11], v[80:83]
    s_add_u32 s59, s58, s60
    ds_read_b64_tr_b16 a[50:51], v12 offset:12288
    v_exp_f32 v169, v169
    v_exp_f32 v170, v170
    s_waitcnt lgkmcnt(9)
    v_mfma_f32_16x16x32_bf16 v[88:91], a[16:19], a[12:15], v[88:91]
    s_add_u32 s58, s58, 32768
    ds_read_b128 a[36:39], v6 offset:9216
    v_exp_f32 v171, v171
    v_exp_f32 v172, v172
    s_waitcnt lgkmcnt(8)
    v_mfma_f32_16x16x32_bf16 v[68:71], a[20:23], a[0:3], v[68:71]
    s_cmp_ge_u32 s58, 163840
    ds_read_b128 a[40:43], v6 offset:10240
    v_exp_f32 v173, v173
    v_exp_f32 v174, v174
    v_mfma_f32_16x16x32_bf16 v[76:79], a[20:23], a[4:7], v[76:79]
    ds_read_b128 a[44:47], v6 offset:11264
    buffer_load_dwordx4 v17, s[24:27], s57 offen offset:1024 lds
    v_exp_f32 v175, v175
    v_mfma_f32_16x16x32_bf16 v[84:87], a[20:23], a[8:11], v[84:87]
    s_cselect_b32 s66, 4294836224, s100
    ds_read_b64_tr_b16 a[52:53], v13 offset:8192
    v_exp_f32 v176, v176
    v_exp_f32 v177, v177
    v_mfma_f32_16x16x32_bf16 v[92:95], a[20:23], a[12:15], v[92:95]
    s_cselect_b32 s58, 0, s58
    ds_read_b64_tr_b16 a[54:55], v13 offset:12288
    v_exp_f32 v178, v178
    v_exp_f32 v179, v179
    s_waitcnt lgkmcnt(10)
    v_mfma_f32_16x16x32_bf16 v[96:99], a[24:27], a[0:3], v[96:99]
    ds_read_b64_tr_b16 a[56:57], v14 offset:8192
    v_cvt_pk_bf16_f32 v192, v148, v149
    v_cvt_pk_bf16_f32 v193, v150, v151
    v_mfma_f32_16x16x32_bf16 v[104:107], a[24:27], a[4:7], v[104:107]
    ds_read_b64_tr_b16 a[58:59], v14 offset:12288
    buffer_load_dwordx4 v18, s[24:27], s57 offen offset:2048 lds
    v_cvt_pk_bf16_f32 v194, v152, v153
    v_mfma_f32_16x16x32_bf16 v[112:115], a[24:27], a[8:11], v[112:115]
    ds_read_b64_tr_b16 a[60:61], v15 offset:8192
    v_cvt_pk_bf16_f32 v195, v154, v155
    v_cvt_pk_bf16_f32 v196, v156, v157
    v_mfma_f32_16x16x32_bf16 v[120:123], a[24:27], a[12:15], v[120:123]
    ds_read_b64_tr_b16 a[62:63], v15 offset:12288
    v_cvt_pk_bf16_f32 v197, v158, v159
    v_cvt_pk_bf16_f32 v198, v160, v161
    s_waitcnt lgkmcnt(12)
    v_mfma_f32_16x16x32_bf16 v[100:103], a[28:31], a[0:3], v[100:103]
    v_add_u32 v6, s66, v6
    v_add_u32 v12, s66, v12
    v_cvt_pk_bf16_f32 v199, v162, v163
    v_mfma_f32_16x16x32_bf16 v[108:111], a[28:31], a[4:7], v[108:111]
    buffer_load_dwordx4 v19, s[24:27], s57 offen offset:3072 lds
    v_cvt_pk_bf16_f32 v200, v164, v165
    v_mfma_f32_16x16x32_bf16 v[116:119], a[28:31], a[8:11], v[116:119]
    s_add_u32 s57, s57, 131072
    v_add_u32 v13, s66, v13
    v_add_u32 v14, s66, v14
    v_cvt_pk_bf16_f32 v201, v166, v167
    v_mfma_f32_16x16x32_bf16 v[124:127], a[28:31], a[12:15], v[124:127]
    s_mov_b32 m0, s59
    v_add_u32 v15, s66, v15
    v_cvt_pk_bf16_f32 v202, v168, v169
    s_waitcnt vmcnt(24) lgkmcnt(0)
    v_mfma_f32_16x16x32_bf16 v[64:67], a[48:51], a[32:35], v[64:67]
    s_barrier
    v_cvt_pk_bf16_f32 v203, v170, v171
    v_cvt_pk_bf16_f32 v204, v172, v173
    v_mfma_f32_16x16x32_bf16 v[72:75], a[48:51], a[36:39], v[72:75]
    ds_read_b128 a[0:3], v6 offset:0
    buffer_load_dwordx4 v2, s[36:39], s56 offen offset:0 sc1 lds
    v_cvt_pk_bf16_f32 v205, v174, v175
    v_mfma_f32_16x16x32_bf16 v[80:83], a[48:51], a[40:43], v[80:83]
    ds_read_b64_tr_b16 a[16:17], v12 offset:0
    v_cvt_pk_bf16_f32 v206, v176, v177
    v_cvt_pk_bf16_f32 v207, v178, v179
    v_mfma_f32_16x16x32_bf16 v[88:91], a[48:51], a[44:47], v[88:91]
    ds_read_b64_tr_b16 a[18:19], v12 offset:4096
    s_nop 1
    v_mfma_f32_16x16x32_bf16 v[20:23], v[44:47], v[192:195], 0
    v_mfma_f32_16x16x32_bf16 v[68:71], a[52:55], a[32:35], v[68:71]
    ds_read_b128 a[4:7], v6 offset:1024
    v_mfma_f32_16x16x32_bf16 v[24:27], v[44:47], v[196:199], 0
    v_mfma_f32_16x16x32_bf16 v[28:31], v[44:47], v[200:203], 0
    v_mfma_f32_16x16x32_bf16 v[76:79], a[52:55], a[36:39], v[76:79]
    ds_read_b128 a[8:11], v6 offset:2048
    buffer_load_dwordx4 v2, s[36:39], s56 offen offset:1024 sc1 lds
    v_mfma_f32_16x16x32_bf16 v[32:35], v[44:47], v[204:207], 0
    v_mfma_f32_16x16x32_bf16 v[84:87], a[52:55], a[40:43], v[84:87]
    ds_read_b128 a[12:15], v6 offset:3072
    v_mfma_f32_16x16x32_bf16 v[148:151], v[230:233], v[192:195], 0
    v_mfma_f32_16x16x32_bf16 v[152:155], v[242:245], v[192:195], 0
    v_mfma_f32_16x16x32_bf16 v[92:95], a[52:55], a[44:47], v[92:95]
    ds_read_b64_tr_b16 a[20:21], v13 offset:0
    v_mfma_f32_16x16x32_bf16 v[156:159], v[232:235], v[196:199], 0
    v_mfma_f32_16x16x32_bf16 v[160:163], v[244:247], v[196:199], 0
    v_mfma_f32_16x16x32_bf16 v[96:99], a[56:59], a[32:35], v[96:99]
    ds_read_b64_tr_b16 a[22:23], v13 offset:4096
    v_mfma_f32_16x16x32_bf16 v[164:167], v[234:237], v[200:203], 0
    v_mfma_f32_16x16x32_bf16 v[168:171], v[246:249], v[200:203], 0
    v_mfma_f32_16x16x32_bf16 v[104:107], a[56:59], a[36:39], v[104:107]
    ds_read_b64_tr_b16 a[24:25], v14 offset:0
    buffer_load_dwordx4 v2, s[36:39], s56 offen offset:2048 sc1 lds
    v_mfma_f32_16x16x32_bf16 v[172:175], v[236:239], v[204:207], 0
    v_mfma_f32_16x16x32_bf16 v[112:115], a[56:59], a[40:43], v[112:115]
    ds_read_b64_tr_b16 a[26:27], v14 offset:4096
    v_mfma_f32_16x16x32_bf16 v[176:179], v[248:251], v[204:207], 0
    v_rcp_f32 v140, v20
    v_mfma_f32_16x16x32_bf16 v[120:123], a[56:59], a[44:47], v[120:123]
    ds_read_b64_tr_b16 a[28:29], v15 offset:0
    v_rcp_f32 v141, v24
    v_rcp_f32 v142, v28
    v_mfma_f32_16x16x32_bf16 v[100:103], a[60:63], a[32:35], v[100:103]
    s_add_u32 s64, s64, 1
    ds_read_b64_tr_b16 a[30:31], v15 offset:4096
    v_rcp_f32 v143, v32
    s_nop 1
    v_mfma_f32_16x16x32_bf16 v[108:111], a[60:63], a[36:39], v[108:111]
    buffer_load_dwordx4 v2, s[36:39], s56 offen offset:3072 sc1 lds
    s_nop 1
    v_mfma_f32_16x16x32_bf16 v[116:119], a[60:63], a[40:43], v[116:119]
    s_add_u32 s56, s56, 262144
    v_mul_f32 v148, v148, v140
    v_mul_f32 v149, v149, v140
    v_mfma_f32_16x16x32_bf16 v[124:127], a[60:63], a[44:47], v[124:127]
    v_mul_f32 v150, v150, v140
    v_mul_f32 v151, v151, v140
    s_cmp_gt_i32 s68, 8
    s_cbranch_scc0 m_lp136
m_lr137:
    s_waitcnt lgkmcnt(9)
    v_mfma_f32_16x16x32_bf16 v[64:67], a[16:19], a[0:3], v[64:67]
    s_add_u32 m0, s59, 16384
    ds_read_b128 a[32:35], v6 offset:8192
    v_mul_f32 v152, v152, v140
    v_mul_f32 v153, v153, v140
    s_waitcnt lgkmcnt(9)
    v_mfma_f32_16x16x32_bf16 v[72:75], a[16:19], a[4:7], v[72:75]
    ds_read_b64_tr_b16 a[48:49], v12 offset:8192
    buffer_load_dwordx4 v16, s[24:27], s57 offen offset:0 lds
    v_mul_f32 v154, v154, v140
    s_waitcnt lgkmcnt(9)
    v_mfma_f32_16x16x32_bf16 v[80:83], a[16:19], a[8:11], v[80:83]
    s_add_u32 s59, s58, s60
    ds_read_b64_tr_b16 a[50:51], v12 offset:12288
    v_mul_f32 v155, v155, v140
    v_cvt_pk_bf16_f32 v148, v148, v149
    s_waitcnt lgkmcnt(9)
    v_mfma_f32_16x16x32_bf16 v[88:91], a[16:19], a[12:15], v[88:91]
    s_add_u32 s58, s58, 32768
    ds_read_b128 a[36:39], v6 offset:9216
    v_cvt_pk_bf16_f32 v149, v150, v151
    v_cvt_pk_bf16_f32 v150, v152, v153
    s_waitcnt lgkmcnt(8)
    v_mfma_f32_16x16x32_bf16 v[68:71], a[20:23], a[0:3], v[68:71]
    s_cmp_ge_u32 s58, 163840
    ds_read_b128 a[40:43], v6 offset:10240
    v_cvt_pk_bf16_f32 v151, v154, v155
    buffer_store_dwordx4 v[148:151], v2, s[8:11], s80 offen offset:0 sc1
    v_mfma_f32_16x16x32_bf16 v[76:79], a[20:23], a[4:7], v[76:79]
    ds_read_b128 a[44:47], v6 offset:11264
    buffer_load_dwordx4 v17, s[24:27], s57 offen offset:1024 lds
    v_mul_f32 v156, v156, v141
    v_mfma_f32_16x16x32_bf16 v[84:87], a[20:23], a[8:11], v[84:87]
    s_cselect_b32 s66, 4294836224, s100
    ds_read_b64_tr_b16 a[52:53], v13 offset:8192
    v_mul_f32 v157, v157, v141
    v_mul_f32 v158, v158, v141
    v_mfma_f32_16x16x32_bf16 v[92:95], a[20:23], a[12:15], v[92:95]
    s_cselect_b32 s58, 0, s58
    ds_read_b64_tr_b16 a[54:55], v13 offset:12288
    v_mul_f32 v159, v159, v141
    v_mul_f32 v160, v160, v141
    s_waitcnt lgkmcnt(10)
    v_mfma_f32_16x16x32_bf16 v[96:99], a[24:27], a[0:3], v[96:99]
    ds_read_b64_tr_b16 a[56:57], v14 offset:8192
    v_mul_f32 v161, v161, v141
    v_mul_f32 v162, v162, v141
    v_mfma_f32_16x16x32_bf16 v[104:107], a[24:27], a[4:7], v[104:107]
    ds_read_b64_tr_b16 a[58:59], v14 offset:12288
    buffer_load_dwordx4 v18, s[24:27], s57 offen offset:2048 lds
    v_mul_f32 v163, v163, v141
    v_mfma_f32_16x16x32_bf16 v[112:115], a[24:27], a[8:11], v[112:115]
    ds_read_b64_tr_b16 a[60:61], v15 offset:8192
    v_cvt_pk_bf16_f32 v156, v156, v157
    v_cvt_pk_bf16_f32 v157, v158, v159
    v_mfma_f32_16x16x32_bf16 v[120:123], a[24:27], a[12:15], v[120:123]
    ds_read_b64_tr_b16 a[62:63], v15 offset:12288
    v_cvt_pk_bf16_f32 v158, v160, v161
    v_cvt_pk_bf16_f32 v159, v162, v163
    s_waitcnt lgkmcnt(12)
    v_mfma_f32_16x16x32_bf16 v[100:103], a[28:31], a[0:3], v[100:103]
    v_add_u32 v6, s66, v6
    v_add_u32 v12, s66, v12
    buffer_store_dwordx4 v[156:159], v2, s[8:11], s80 offen offset:1024 sc1
    v_mfma_f32_16x16x32_bf16 v[108:111], a[28:31], a[4:7], v[108:111]
    buffer_load_dwordx4 v19, s[24:27], s57 offen offset:3072 lds
    v_mul_f32 v164, v164, v142
    v_mfma_f32_16x16x32_bf16 v[116:119], a[28:31], a[8:11], v[116:119]
    s_add_u32 s57, s57, 131072
    v_add_u32 v13, s66, v13
    v_add_u32 v14, s66, v14
    v_mul_f32 v165, v165, v142
    v_mfma_f32_16x16x32_bf16 v[124:127], a[28:31], a[12:15], v[124:127]
    s_mov_b32 m0, s59
    v_add_u32 v15, s66, v15
    v_mul_f32 v166, v166, v142
    s_waitcnt vmcnt(24) lgkmcnt(0)
    v_mfma_f32_16x16x32_bf16 v[64:67], a[48:51], a[32:35], v[64:67]
    s_barrier
    v_mul_f32 v167, v167, v142
    v_mul_f32 v168, v168, v142
    v_mfma_f32_16x16x32_bf16 v[72:75], a[48:51], a[36:39], v[72:75]
    ds_read_b128 a[0:3], v6 offset:0
    buffer_load_dwordx4 v2, s[36:39], s56 offen offset:0 sc1 lds
    v_mul_f32 v169, v169, v142
    v_mfma_f32_16x16x32_bf16 v[80:83], a[48:51], a[40:43], v[80:83]
    ds_read_b64_tr_b16 a[16:17], v12 offset:0
    v_mul_f32 v170, v170, v142
    v_mul_f32 v171, v171, v142
    v_mfma_f32_16x16x32_bf16 v[88:91], a[48:51], a[44:47], v[88:91]
    ds_read_b64_tr_b16 a[18:19], v12 offset:4096
    v_cvt_pk_bf16_f32 v164, v164, v165
    v_cvt_pk_bf16_f32 v165, v166, v167
    v_mfma_f32_16x16x32_bf16 v[68:71], a[52:55], a[32:35], v[68:71]
    ds_read_b128 a[4:7], v6 offset:1024
    v_cvt_pk_bf16_f32 v166, v168, v169
    v_cvt_pk_bf16_f32 v167, v170, v171
    v_mfma_f32_16x16x32_bf16 v[76:79], a[52:55], a[36:39], v[76:79]
    ds_read_b128 a[8:11], v6 offset:2048
    buffer_load_dwordx4 v2, s[36:39], s56 offen offset:1024 sc1 lds
    buffer_store_dwordx4 v[164:167], v2, s[8:11], s80 offen offset:2048 sc1
    v_mfma_f32_16x16x32_bf16 v[84:87], a[52:55], a[40:43], v[84:87]
    ds_read_b128 a[12:15], v6 offset:3072
    v_mul_f32 v172, v172, v143
    v_mul_f32 v173, v173, v143
    v_mfma_f32_16x16x32_bf16 v[92:95], a[52:55], a[44:47], v[92:95]
    ds_read_b64_tr_b16 a[20:21], v13 offset:0
    v_mul_f32 v174, v174, v143
    v_mul_f32 v175, v175, v143
    v_mfma_f32_16x16x32_bf16 v[96:99], a[56:59], a[32:35], v[96:99]
    ds_read_b64_tr_b16 a[22:23], v13 offset:4096
    v_mul_f32 v176, v176, v143
    v_mul_f32 v177, v177, v143
    v_mfma_f32_16x16x32_bf16 v[104:107], a[56:59], a[36:39], v[104:107]
    ds_read_b64_tr_b16 a[24:25], v14 offset:0
    buffer_load_dwordx4 v2, s[36:39], s56 offen offset:2048 sc1 lds
    v_mul_f32 v178, v178, v143
    v_mfma_f32_16x16x32_bf16 v[112:115], a[56:59], a[40:43], v[112:115]
    ds_read_b64_tr_b16 a[26:27], v14 offset:4096
    v_mul_f32 v179, v179, v143
    v_cvt_pk_bf16_f32 v172, v172, v173
    v_mfma_f32_16x16x32_bf16 v[120:123], a[56:59], a[44:47], v[120:123]
    ds_read_b64_tr_b16 a[28:29], v15 offset:0
    v_cvt_pk_bf16_f32 v173, v174, v175
    v_cvt_pk_bf16_f32 v174, v176, v177
    v_mfma_f32_16x16x32_bf16 v[100:103], a[60:63], a[32:35], v[100:103]
    s_add_u32 s64, s64, 1
    ds_read_b64_tr_b16 a[30:31], v15 offset:4096
    v_cvt_pk_bf16_f32 v175, v178, v179
    buffer_store_dwordx4 v[172:175], v2, s[8:11], s80 offen offset:3072 sc1
    v_mfma_f32_16x16x32_bf16 v[108:111], a[60:63], a[36:39], v[108:111]
    buffer_load_dwordx4 v2, s[36:39], s56 offen offset:3072 sc1 lds
    v_mfma_f32_16x16x32_bf16 v[116:119], a[60:63], a[40:43], v[116:119]
    s_add_u32 s56, s56, 262144
    v_mfma_f32_16x16x32_bf16 v[124:127], a[60:63], a[44:47], v[124:127]
    s_branch m_l3e126
m_lp130:
    s_mov_b32 s3, 1048576
m_spin138:
    buffer_load_dwordx2 v[4:5], v10, s[8:11], s52 offen sc1
    s_waitcnt vmcnt(0)
    v_cmp_ne_u64 s[76:77], s[4:5], v[4:5]
    s_mul_i32 s91, s95, 20
    s_nop 2
    s_lshr_b32 s90, s76, s91
    s_ff1_i32_b32 s90, s90
    s_lshl_b32 s68, s90, 1
    s_mul_i32 s91, s95, 1
    s_sub_i32 s68, s68, s91
    s_cmp_lt_i32 s90, 0
    s_cselect_b32 s68, 1000, s68
    s_cmp_gt_i32 s68, 5
    s_cbranch_scc1 m_ok139
    s_sub_u32 s3, s3, 1
    s_cbranch_scc1 m_ok139
    s_sleep 4
    s_branch m_spin138
m_ok139:
    s_branch m_lr131
m_lp132:
    s_mov_b32 s3, 1048576
m_spin140:
    buffer_load_dwordx2 v[4:5], v10, s[8:11], s52 offen sc1
    s_waitcnt vmcnt(0)
    v_cmp_ne_u64 s[76:77], s[4:5], v[4:5]
    s_mul_i32 s91, s95, 20
    s_nop 2
    s_lshr_b32 s90, s76, s91
    s_ff1_i32_b32 s90, s90
    s_lshl_b32 s68, s90, 1
    s_mul_i32 s91, s95, 1
    s_sub_i32 s68, s68, s91
    s_cmp_lt_i32 s90, 0
    s_cselect_b32 s68, 1000, s68
    s_cmp_gt_i32 s68, 6
    s_cbranch_scc1 m_ok141
    s_sub_u32 s3, s3, 1
    s_cbranch_scc1 m_ok141
    s_sleep 4
    s_branch m_spin140
m_ok141:
    s_branch m_lr133
m_lp134:
    s_mov_b32 s3, 1048576
m_spin142:
    buffer_load_dwordx2 v[4:5], v10, s[8:11], s52 offen sc1
    s_waitcnt vmcnt(0)
    v_cmp_ne_u64 s[76:77], s[4:5], v[4:5]
    s_mul_i32 s91, s95, 20
    s_nop 2
    s_lshr_b32 s90, s76, s91
    s_ff1_i32_b32 s90, s90
    s_lshl_b32 s68, s90, 1
    s_mul_i32 s91, s95, 1
    s_sub_i32 s68, s68, s91
    s_cmp_lt_i32 s90, 0
    s_cselect_b32 s68, 1000, s68
    s_cmp_gt_i32 s68, 7
    s_cbranch_scc1 m_ok143
    s_sub_u32 s3, s3, 1
    s_cbranch_scc1 m_ok143
    s_sleep 4
    s_branch m_spin142
m_ok143:
    s_branch m_lr135
m_lp136:
    s_mov_b32 s3, 1048576
m_spin144:
    buffer_load_dwordx2 v[4:5], v10, s[8:11], s52 offen sc1
    s_waitcnt vmcnt(0)
    v_cmp_ne_u64 s[76:77], s[4:5], v[4:5]
    s_mul_i32 s91, s95, 20
    s_nop 2
    s_lshr_b32 s90, s76, s91
    s_ff1_i32_b32 s90, s90
    s_lshl_b32 s68, s90, 1
    s_mul_i32 s91, s95, 1
    s_sub_i32 s68, s68, s91
    s_cmp_lt_i32 s90, 0
    s_cselect_b32 s68, 1000, s68
    s_cmp_gt_i32 s68, 8
    s_cbranch_scc1 m_ok145
    s_sub_u32 s3, s3, 1
    s_cbranch_scc1 m_ok145
    s_sleep 4
    s_branch m_spin144
m_ok145:
    s_branch m_lr137
m_l3125:
    s_waitcnt lgkmcnt(9)
    v_mfma_f32_16x16x32_bf16 v[64:67], a[16:19], a[0:3], v[64:67]
    s_add_u32 m0, s59, 16384
    ds_read_b128 a[32:35], v6 offset:8192
    s_waitcnt lgkmcnt(9)
    v_mfma_f32_16x16x32_bf16 v[72:75], a[16:19], a[4:7], v[72:75]
    ds_read_b64_tr_b16 a[48:49], v12 offset:8192
    buffer_load_dwordx4 v16, s[24:27], s57 offen offset:0 lds
    s_waitcnt lgkmcnt(9)
    v_mfma_f32_16x16x32_bf16 v[80:83], a[16:19], a[8:11], v[80:83]
    s_add_u32 s59, s58, s60
    ds_read_b64_tr_b16 a[50:51], v12 offset:12288
    s_waitcnt lgkmcnt(9)
    v_mfma_f32_16x16x32_bf16 v[88:91], a[16:19], a[12:15], v[88:91]
    s_add_u32 s58, s58, 32768
    ds_read_b128 a[36:39], v6 offset:9216
    s_waitcnt lgkmcnt(8)
    v_mfma_f32_16x16x32_bf16 v[68:71], a[20:23], a[0:3], v[68:71]
    s_cmp_ge_u32 s58, 163840
    ds_read_b128 a[40:43], v6 offset:10240
    v_mfma_f32_16x16x32_bf16 v[76:79], a[20:23], a[4:7], v[76:79]
    ds_read_b128 a[44:47], v6 offset:11264
    buffer_load_dwordx4 v17, s[24:27], s57 offen offset:1024 lds
    v_mfma_f32_16x16x32_bf16 v[84:87], a[20:23], a[8:11], v[84:87]
    s_cselect_b32 s66, 4294836224, s100
    ds_read_b64_tr_b16 a[52:53], v13 offset:8192
    v_mfma_f32_16x16x32_bf16 v[92:95], a[20:23], a[12:15], v[92:95]
    s_cselect_b32 s58, 0, s58
    ds_read_b64_tr_b16 a[54:55], v13 offset:12288
    s_waitcnt lgkmcnt(10)
    v_mfma_f32_16x16x32_bf16 v[96:99], a[24:27], a[0:3], v[96:99]
    ds_read_b64_tr_b16 a[56:57], v14 offset:8192
    v_mfma_f32_16x16x32_bf16 v[104:107], a[24:27], a[4:7], v[104:107]
    ds_read_b64_tr_b16 a[58:59], v14 offset:12288
    buffer_load_dwordx4 v18, s[24:27], s57 offen offset:2048 lds
    v_mfma_f32_16x16x32_bf16 v[112:115], a[24:27], a[8:11], v[112:115]
    ds_read_b64_tr_b16 a[60:61], v15 offset:8192
    v_mfma_f32_16x16x32_bf16 v[120:123], a[24:27], a[12:15], v[120:123]
    ds_read_b64_tr_b16 a[62:63], v15 offset:12288
    s_waitcnt lgkmcnt(12)
    v_mfma_f32_16x16x32_bf16 v[100:103], a[28:31], a[0:3], v[100:103]
    v_add_u32 v6, s66, v6
    v_add_u32 v12, s66, v12
    v_mfma_f32_16x16x32_bf16 v[108:111], a[28:31], a[4:7], v[108:111]
    buffer_load_dwordx4 v19, s[24:27], s57 offen offset:3072 lds
    v_mfma_f32_16x16x32_bf16 v[116:119], a[28:31], a[8:11], v[116:119]
    s_add_u32 s57, s57, 131072
    v_add_u32 v13, s66, v13
    v_add_u32 v14, s66, v14
    v_mfma_f32_16x16x32_bf16 v[124:127], a[28:31], a[12:15], v[124:127]
    s_mov_b32 m0, s59
    v_add_u32 v15, s66, v15
    s_waitcnt vmcnt(24) lgkmcnt(0)
    v_mfma_f32_16x16x32_bf16 v[64:67], a[48:51], a[32:35], v[64:67]
    s_barrier
    v_mfma_f32_16x16x32_bf16 v[72:75], a[48:51], a[36:39], v[72:75]
    ds_read_b128 a[0:3], v6 offset:0
    buffer_load_dwordx4 v2, s[36:39], s56 offen offset:0 sc1 lds
    v_mfma_f32_16x16x32_bf16 v[80:83], a[48:51], a[40:43], v[80:83]
    ds_read_b64_tr_b16 a[16:17], v12 offset:0
    v_mfma_f32_16x16x32_bf16 v[88:91], a[48:51], a[44:47], v[88:91]
    ds_read_b64_tr_b16 a[18:19], v12 offset:4096
    v_mfma_f32_16x16x32_bf16 v[68:71], a[52:55], a[32:35], v[68:71]
    ds_read_b128 a[4:7], v6 offset:1024
    v_mfma_f32_16x16x32_bf16 v[76:79], a[52:55], a[36:39], v[76:79]
    ds_read_b128 a[8:11], v6 offset:2048
    buffer_load_dwordx4 v2, s[36:39], s56 offen offset:1024 sc1 lds
    v_mfma_f32_16x16x32_bf16 v[84:87], a[52:55], a[40:43], v[84:87]
    ds_read_b128 a[12:15], v6 offset:3072
    v_mfma_f32_16x16x32_bf16 v[92:95], a[52:55], a[44:47], v[92:95]
    ds_read_b64_tr_b16 a[20:21], v13 offset:0
    v_mfma_f32_16x16x32_bf16 v[96:99], a[56:59], a[32:35], v[96:99]
    ds_read_b64_tr_b16 a[22:23], v13 offset:4096
    v_mfma_f32_16x16x32_bf16 v[104:107], a[56:59], a[36:39], v[104:107]
    ds_read_b64_tr_b16 a[24:25], v14 offset:0
    buffer_load_dwordx4 v2, s[36:39], s56 offen offset:2048 sc1 lds
    v_mfma_f32_16x16x32_bf16 v[112:115], a[56:59], a[40:43], v[112:115]
    ds_read_b64_tr_b16 a[26:27], v14 offset:4096
    v_mfma_f32_16x16x32_bf16 v[120:123], a[56:59], a[44:47], v[120:123]
    ds_read_b64_tr_b16 a[28:29], v15 offset:0
    v_mfma_f32_16x16x32_bf16 v[100:103], a[60:63], a[32:35], v[100:103]
    s_add_u32 s64, s64, 1
    ds_read_b64_tr_b16 a[30:31], v15 offset:4096
    v_mfma_f32_16x16x32_bf16 v[108:111], a[60:63], a[36:39], v[108:111]
    buffer_load_dwordx4 v2, s[36:39], s56 offen offset:3072 sc1 lds
    v_mfma_f32_16x16x32_bf16 v[116:119], a[60:63], a[40:43], v[116:119]
    s_add_u32 s56, s56, 262144
    s_cmp_lt_u32 s64, s67
    v_mfma_f32_16x16x32_bf16 v[124:127], a[60:63], a[44:47], v[124:127]
    s_cbranch_scc1 m_l3125
m_l3e126:
    s_add_u32 s92, s64, 5
    s_cmp_gt_i32 s68, s92
    s_cbranch_scc1 m_rdy146
    s_mov_b32 s3, 1048576
m_spin147:
    buffer_load_dwordx2 v[4:5], v10, s[8:11], s52 offen sc1
    s_waitcnt vmcnt(0)
    v_cmp_ne_u64 s[76:77], s[4:5], v[4:5]
    s_mul_i32 s91, s95, 20
    s_nop 2
    s_lshr_b32 s90, s76, s91
    s_ff1_i32_b32 s90, s90
    s_lshl_b32 s68, s90, 1
    s_mul_i32 s91, s95, 1
    s_sub_i32 s68, s68, s91
    s_cmp_lt_i32 s90, 0
    s_cselect_b32 s68, 1000, s68
    s_cmp_gt_i32 s68, s92
    s_cbranch_scc1 m_ok148
    s_sub_u32 s3, s3, 1
    s_cbranch_scc1 m_ok148
    s_sleep 4
    s_branch m_spin147
m_ok148:
m_rdy146:
    s_mov_b32 s67, 8
    s_cmp_lt_u32 s64, 8
    s_cbranch_scc1 m_l3n129
    s_cmp_eq_u32 s64, 8
    s_cbranch_scc1 m_o1149
m_o2150:
    s_cmp_eq_u32 s95, 0
    s_cbranch_scc1 m_l3c128
    s_mov_b32 s67, 17
    s_cmp_lt_u32 s64, 17
    s_cbranch_scc1 m_l3n129
    s_cmp_lg_u32 s64, 17
    s_cbranch_scc1 m_n151
    s_mov_b32 s68, 1000
    s_lshr_b32 s90, s96, 1
    s_lshl_b32 s90, s90, 8
    s_add_u32 s90, s90, 117452800
    buffer_load_dwordx2 v[4:5], v10, s[8:11], s90 offen sc1
    s_mov_b32 s67, 18
    s_branch m_l3125
m_n151:
    s_cmp_lg_u32 s64, 18
    s_cbranch_scc1 m_n152
    s_waitcnt vmcnt(8)
    s_waitcnt vmcnt(16)
    s_mov_b32 s3, 1048576
m_spin153:
    v_cmp_ne_u64 s[76:77], s[4:5], v[4:5]
    s_nop 3
    s_cmp_eq_u64 s[76:77], 0
    s_cbranch_scc1 m_ok154
    s_sub_u32 s3, s3, 1
    s_cbranch_scc1 m_ok154
    s_sleep 8
    s_lshr_b32 s90, s96, 1
    s_lshl_b32 s90, s90, 8
    s_add_u32 s90, s90, 117452800
    buffer_load_dwordx2 v[4:5], v10, s[8:11], s90 offen sc1
    s_waitcnt vmcnt(0)
    s_branch m_spin153
m_ok154:
    s_mov_b32 s56, s69
    s_mov_b32 s67, 19
    s_branch m_l3125
m_n152:
    s_cmp_lg_u32 s64, 19
    s_cbranch_scc1 m_n155
    s_mov_b32 s24, s50
    s_mov_b32 s25, s51
    s_mov_b32 s26, 2097152
    s_lshl_b32 s57, s97, 8
    s_mov_b32 s67, 23
    s_branch m_l3125
m_n155:
    s_cmp_lg_u32 s64, 23
    s_cbranch_scc1 m_n156
    s_lshl_b32 s90, s96, 3
    s_add_u32 s90, s90, s97
    s_lshl_b32 s90, s90, 15
    s_lshl_b32 s91, s16, 13
    s_add_u32 s90, s90, s91
    s_add_u32 s70, s90, 100663296
    s_nop 3
    v_cvt_pk_bf16_f32 v128, v64, v65
    v_cvt_pk_bf16_f32 v129, v66, v67
    v_cvt_pk_bf16_f32 v130, v68, v69
    v_cvt_pk_bf16_f32 v131, v70, v71
    v_cvt_pk_bf16_f32 v132, v72, v73
    v_cvt_pk_bf16_f32 v133, v74, v75
    v_cvt_pk_bf16_f32 v134, v76, v77
    v_cvt_pk_bf16_f32 v135, v78, v79
    v_cvt_pk_bf16_f32 v136, v80, v81
    v_cvt_pk_bf16_f32 v137, v82, v83
    v_cvt_pk_bf16_f32 v138, v84, v85
    v_cvt_pk_bf16_f32 v139, v86, v87
    v_cvt_pk_bf16_f32 v140, v88, v89
    v_cvt_pk_bf16_f32 v141, v90, v91
    v_cvt_pk_bf16_f32 v142, v92, v93
    v_cvt_pk_bf16_f32 v143, v94, v95
    v_cvt_pk_bf16_f32 v144, v96, v97
    v_cvt_pk_bf16_f32 v145, v98, v99
    v_cvt_pk_bf16_f32 v146, v100, v101
    v_cvt_pk_bf16_f32 v147, v102, v103
    v_cvt_pk_bf16_f32 v148, v104, v105
    v_cvt_pk_bf16_f32 v149, v106, v107
    v_cvt_pk_bf16_f32 v150, v108, v109
    v_cvt_pk_bf16_f32 v151, v110, v111
    v_cvt_pk_bf16_f32 v152, v112, v113
    v_cvt_pk_bf16_f32 v153, v114, v115
    v_cvt_pk_bf16_f32 v154, v116, v117
    v_cvt_pk_bf16_f32 v155, v118, v119
    v_cvt_pk_bf16_f32 v156, v120, v121
    v_cvt_pk_bf16_f32 v157, v122, v123
    v_cvt_pk_bf16_f32 v158, v124, v125
    v_cvt_pk_bf16_f32 v159, v126, v127
    v_mov_b64 v[64:65], 0
    v_mov_b64 v[66:67], 0
    v_mov_b64 v[68:69], 0
    v_mov_b64 v[70:71], 0
    v_mov_b64 v[72:73], 0
    v_mov_b64 v[74:75], 0
    v_mov_b64 v[76:77], 0
    v_mov_b64 v[78:79], 0
    v_mov_b64 v[80:81], 0
    v_mov_b64 v[82:83], 0
    v_mov_b64 v[84:85], 0
    v_mov_b64 v[86:87], 0
    v_mov_b64 v[88:89], 0
    v_mov_b64 v[90:91], 0
    v_mov_b64 v[92:93], 0
    v_mov_b64 v[94:95], 0
    v_mov_b64 v[96:97], 0
    v_mov_b64 v[98:99], 0
    v_mov_b64 v[100:101], 0
    v_mov_b64 v[102:103], 0
    v_mov_b64 v[104:105], 0
    v_mov_b64 v[106:107], 0
    v_mov_b64 v[108:109], 0
    v_mov_b64 v[110:111], 0
    v_mov_b64 v[112:113], 0
    v_mov_b64 v[114:115], 0
    v_mov_b64 v[116:117], 0
    v_mov_b64 v[118:119], 0
    v_mov_b64 v[120:121], 0
    v_mov_b64 v[122:123], 0
    v_mov_b64 v[124:125], 0
    v_mov_b64 v[126:127], 0
    s_nop 1
    s_waitcnt lgkmcnt(9)
    v_mfma_f32_16x16x32_bf16 v[64:67], a[16:19], a[0:3], v[64:67]
    s_add_u32 m0, s59, 16384
    ds_read_b128 a[32:35], v6 offset:8192
    s_waitcnt lgkmcnt(9)
    v_mfma_f32_16x16x32_bf16 v[72:75], a[16:19], a[4:7], v[72:75]
    ds_read_b64_tr_b16 a[48:49], v12 offset:8192
    buffer_load_dwordx4 v16, s[24:27], s57 offen offset:0 lds
    s_waitcnt lgkmcnt(9)
    v_mfma_f32_16x16x32_bf16 v[80:83], a[16:19], a[8:11], v[80:83]
    s_add_u32 s59, s58, s60
    ds_read_b64_tr_b16 a[50:51], v12 offset:12288
    s_waitcnt lgkmcnt(9)
    v_mfma_f32_16x16x32_bf16 v[88:91], a[16:19], a[12:15], v[88:91]
    s_add_u32 s58, s58, 32768
    ds_read_b128 a[36:39], v6 offset:9216
    s_waitcnt lgkmcnt(8)
    v_mfma_f32_16x16x32_bf16 v[68:71], a[20:23], a[0:3], v[68:71]
    s_cmp_ge_u32 s58, 163840
    ds_read_b128 a[40:43], v6 offset:10240
    v_mfma_f32_16x16x32_bf16 v[76:79], a[20:23], a[4:7], v[76:79]
    ds_read_b128 a[44:47], v6 offset:11264
    buffer_load_dwordx4 v17, s[24:27], s57 offen offset:1024 lds
    v_mfma_f32_16x16x32_bf16 v[84:87], a[20:23], a[8:11], v[84:87]
    s_cselect_b32 s66, 4294836224, s100
    ds_read_b64_tr_b16 a[52:53], v13 offset:8192
    v_mfma_f32_16x16x32_bf16 v[92:95], a[20:23], a[12:15], v[92:95]
    s_cselect_b32 s58, 0, s58
    ds_read_b64_tr_b16 a[54:55], v13 offset:12288
    s_waitcnt lgkmcnt(10)
    v_mfma_f32_16x16x32_bf16 v[96:99], a[24:27], a[0:3], v[96:99]
    ds_read_b64_tr_b16 a[56:57], v14 offset:8192
    v_mfma_f32_16x16x32_bf16 v[104:107], a[24:27], a[4:7], v[104:107]
    ds_read_b64_tr_b16 a[58:59], v14 offset:12288
    buffer_load_dwordx4 v18, s[24:27], s57 offen offset:2048 lds
    v_mfma_f32_16x16x32_bf16 v[112:115], a[24:27], a[8:11], v[112:115]
    ds_read_b64_tr_b16 a[60:61], v15 offset:8192
    v_mfma_f32_16x16x32_bf16 v[120:123], a[24:27], a[12:15], v[120:123]
    ds_read_b64_tr_b16 a[62:63], v15 offset:12288
    buffer_store_dwordx4 v[128:131], v2, s[8:11], s70 offen offset:0 sc1
    s_waitcnt lgkmcnt(12)
    v_mfma_f32_16x16x32_bf16 v[100:103], a[28:31], a[0:3], v[100:103]
    v_add_u32 v6, s66, v6
    v_add_u32 v12, s66, v12
    v_mfma_f32_16x16x32_bf16 v[108:111], a[28:31], a[4:7], v[108:111]
    buffer_load_dwordx4 v19, s[24:27], s57 offen offset:3072 lds
    v_mfma_f32_16x16x32_bf16 v[116:119], a[28:31], a[8:11], v[116:119]
    s_add_u32 s57, s57, 131072
    v_add_u32 v13, s66, v13
    v_add_u32 v14, s66, v14
    v_mfma_f32_16x16x32_bf16 v[124:127], a[28:31], a[12:15], v[124:127]
    s_mov_b32 m0, s59
    v_add_u32 v15, s66, v15
    s_waitcnt vmcnt(24) lgkmcnt(0)
    v_mfma_f32_16x16x32_bf16 v[64:67], a[48:51], a[32:35], v[64:67]
    s_barrier
    v_mfma_f32_16x16x32_bf16 v[72:75], a[48:51], a[36:39], v[72:75]
    ds_read_b128 a[0:3], v6 offset:0
    buffer_load_dwordx4 v2, s[36:39], s56 offen offset:0 sc1 lds
    v_mfma_f32_16x16x32_bf16 v[80:83], a[48:51], a[40:43], v[80:83]
    ds_read_b64_tr_b16 a[16:17], v12 offset:0
    v_mfma_f32_16x16x32_bf16 v[88:91], a[48:51], a[44:47], v[88:91]
    ds_read_b64_tr_b16 a[18:19], v12 offset:4096
    v_mfma_f32_16x16x32_bf16 v[68:71], a[52:55], a[32:35], v[68:71]
    ds_read_b128 a[4:7], v6 offset:1024
    v_mfma_f32_16x16x32_bf16 v[76:79], a[52:55], a[36:39], v[76:79]
    ds_read_b128 a[8:11], v6 offset:2048
    buffer_load_dwordx4 v2, s[36:39], s56 offen offset:1024 sc1 lds
    v_mfma_f32_16x16x32_bf16 v[84:87], a[52:55], a[40:43], v[84:87]
    ds_read_b128 a[12:15], v6 offset:3072
    v_mfma_f32_16x16x32_bf16 v[92:95], a[52:55], a[44:47], v[92:95]
    ds_read_b64_tr_b16 a[20:21], v13 offset:0
    v_mfma_f32_16x16x32_bf16 v[96:99], a[56:59], a[32:35], v[96:99]
    ds_read_b64_tr_b16 a[22:23], v13 offset:4096
    v_mfma_f32_16x16x32_bf16 v[104:107], a[56:59], a[36:39], v[104:107]
    ds_read_b64_tr_b16 a[24:25], v14 offset:0
    buffer_load_dwordx4 v2, s[36:39], s56 offen offset:2048 sc1 lds
    v_mfma_f32_16x16x32_bf16 v[112:115], a[56:59], a[40:43], v[112:115]
    ds_read_b64_tr_b16 a[26:27], v14 offset:4096
    v_mfma_f32_16x16x32_bf16 v[120:123], a[56:59], a[44:47], v[120:123]
    ds_read_b64_tr_b16 a[28:29], v15 offset:0
    buffer_store_dwordx4 v[132:135], v2, s[8:11], s70 offen offset:1024 sc1
    v_mfma_f32_16x16x32_bf16 v[100:103], a[60:63], a[32:35], v[100:103]
    s_add_u32 s64, s64, 1
    ds_read_b64_tr_b16 a[30:31], v15 offset:4096
    v_mfma_f32_16x16x32_bf16 v[108:111], a[60:63], a[36:39], v[108:111]
    buffer_load_dwordx4 v2, s[36:39], s56 offen offset:3072 sc1 lds
    v_mfma_f32_16x16x32_bf16 v[116:119], a[60:63], a[40:43], v[116:119]
    s_add_u32 s56, s56, 262144
    v_mfma_f32_16x16x32_bf16 v[124:127], a[60:63], a[44:47], v[124:127]
    s_waitcnt lgkmcnt(9)
    v_mfma_f32_16x16x32_bf16 v[64:67], a[16:19], a[0:3], v[64:67]
    s_add_u32 m0, s59, 16384
    ds_read_b128 a[32:35], v6 offset:8192
    s_waitcnt lgkmcnt(9)
    v_mfma_f32_16x16x32_bf16 v[72:75], a[16:19], a[4:7], v[72:75]
    ds_read_b64_tr_b16 a[48:49], v12 offset:8192
    buffer_load_dwordx4 v16, s[24:27], s57 offen offset:0 lds
    s_waitcnt lgkmcnt(9)
    v_mfma_f32_16x16x32_bf16 v[80:83], a[16:19], a[8:11], v[80:83]
    s_add_u32 s59, s58, s60
    ds_read_b64_tr_b16 a[50:51], v12 offset:12288
    s_waitcnt lgkmcnt(9)
    v_mfma_f32_16x16x32_bf16 v[88:91], a[16:19], a[12:15], v[88:91]
    s_add_u32 s58, s58, 32768
    ds_read_b128 a[36:39], v6 offset:9216
    s_waitcnt lgkmcnt(8)
    v_mfma_f32_16x16x32_bf16 v[68:71], a[20:23], a[0:3], v[68:71]
    s_cmp_ge_u32 s58, 163840
    ds_read_b128 a[40:43], v6 offset:10240
    v_mfma_f32_16x16x32_bf16 v[76:79], a[20:23], a[4:7], v[76:79]
    ds_read_b128 a[44:47], v6 offset:11264
    buffer_load_dwordx4 v17, s[24:27], s57 offen offset:1024 lds
    v_mfma_f32_16x16x32_bf16 v[84:87], a[20:23], a[8:11], v[84:87]
    s_cselect_b32 s66, 4294836224, s100
    ds_read_b64_tr_b16 a[52:53], v13 offset:8192
    v_mfma_f32_16x16x32_bf16 v[92:95], a[20:23], a[12:15], v[92:95]
    s_cselect_b32 s58, 0, s58
    ds_read_b64_tr_b16 a[54:55], v13 offset:12288
    s_waitcnt lgkmcnt(10)
    v_mfma_f32_16x16x32_bf16 v[96:99], a[24:27], a[0:3], v[96:99]
    ds_read_b64_tr_b16 a[56:57], v14 offset:8192
    v_mfma_f32_16x16x32_bf16 v[104:107], a[24:27], a[4:7], v[104:107]
    ds_read_b64_tr_b16 a[58:59], v14 offset:12288
    buffer_load_dwordx4 v18, s[24:27], s57 offen offset:2048 lds
    v_mfma_f32_16x16x32_bf16 v[112:115], a[24:27], a[8:11], v[112:115]
    ds_read_b64_tr_b16 a[60:61], v15 offset:8192
    v_mfma_f32_16x16x32_bf16 v[120:123], a[24:27], a[12:15], v[120:123]
    ds_read_b64_tr_b16 a[62:63], v15 offset:12288
    buffer_store_dwordx4 v[136:139], v2, s[8:11], s70 offen offset:2048 sc1
    s_waitcnt lgkmcnt(12)
    v_mfma_f32_16x16x32_bf16 v[100:103], a[28:31], a[0:3], v[100:103]
    v_add_u32 v6, s66, v6
    v_add_u32 v12, s66, v12
    v_mfma_f32_16x16x32_bf16 v[108:111], a[28:31], a[4:7], v[108:111]
    buffer_load_dwordx4 v19, s[24:27], s57 offen offset:3072 lds
    v_mfma_f32_16x16x32_bf16 v[116:119], a[28:31], a[8:11], v[116:119]
    s_add_u32 s57, s57, 131072
    v_add_u32 v13, s66, v13
    v_add_u32 v14, s66, v14
    v_mfma_f32_16x16x32_bf16 v[124:127], a[28:31], a[12:15], v[124:127]
    s_mov_b32 m0, s59
    v_add_u32 v15, s66, v15
    s_waitcnt vmcnt(24) lgkmcnt(0)
    v_mfma_f32_16x16x32_bf16 v[64:67], a[48:51], a[32:35], v[64:67]
    s_barrier
    v_mfma_f32_16x16x32_bf16 v[72:75], a[48:51], a[36:39], v[72:75]
    ds_read_b128 a[0:3], v6 offset:0
    buffer_load_dwordx4 v2, s[36:39], s56 offen offset:0 sc1 lds
    v_mfma_f32_16x16x32_bf16 v[80:83], a[48:51], a[40:43], v[80:83]
    ds_read_b64_tr_b16 a[16:17], v12 offset:0
    v_mfma_f32_16x16x32_bf16 v[88:91], a[48:51], a[44:47], v[88:91]
    ds_read_b64_tr_b16 a[18:19], v12 offset:4096
    v_mfma_f32_16x16x32_bf16 v[68:71], a[52:55], a[32:35], v[68:71]
    ds_read_b128 a[4:7], v6 offset:1024
    v_mfma_f32_16x16x32_bf16 v[76:79], a[52:55], a[36:39], v[76:79]
    ds_read_b128 a[8:11], v6 offset:2048
    buffer_load_dwordx4 v2, s[36:39], s56 offen offset:1024 sc1 lds
    v_mfma_f32_16x16x32_bf16 v[84:87], a[52:55], a[40:43], v[84:87]
    ds_read_b128 a[12:15], v6 offset:3072
    v_mfma_f32_16x16x32_bf16 v[92:95], a[52:55], a[44:47], v[92:95]
    ds_read_b64_tr_b16 a[20:21], v13 offset:0
    v_mfma_f32_16x16x32_bf16 v[96:99], a[56:59], a[32:35], v[96:99]
    ds_read_b64_tr_b16 a[22:23], v13 offset:4096
    v_mfma_f32_16x16x32_bf16 v[104:107], a[56:59], a[36:39], v[104:107]
    ds_read_b64_tr_b16 a[24:25], v14 offset:0
    buffer_load_dwordx4 v2, s[36:39], s56 offen offset:2048 sc1 lds
    v_mfma_f32_16x16x32_bf16 v[112:115], a[56:59], a[40:43], v[112:115]
    ds_read_b64_tr_b16 a[26:27], v14 offset:4096
    v_mfma_f32_16x16x32_bf16 v[120:123], a[56:59], a[44:47], v[120:123]
    ds_read_b64_tr_b16 a[28:29], v15 offset:0
    buffer_store_dwordx4 v[140:143], v2, s[8:11], s70 offen offset:3072 sc1
    s_add_u32 s70, s70, 4096
    v_mfma_f32_16x16x32_bf16 v[100:103], a[60:63], a[32:35], v[100:103]
    s_add_u32 s64, s64, 1
    ds_read_b64_tr_b16 a[30:31], v15 offset:4096
    v_mfma_f32_16x16x32_bf16 v[108:111], a[60:63], a[36:39], v[108:111]
    buffer_load_dwordx4 v2, s[36:39], s56 offen offset:3072 sc1 lds
    v_mfma_f32_16x16x32_bf16 v[116:119], a[60:63], a[40:43], v[116:119]
    s_add_u32 s56, s56, 262144
    v_mfma_f32_16x16x32_bf16 v[124:127], a[60:63], a[44:47], v[124:127]
    s_waitcnt lgkmcnt(9)
    v_mfma_f32_16x16x32_bf16 v[64:67], a[16:19], a[0:3], v[64:67]
    s_add_u32 m0, s59, 16384
    ds_read_b128 a[32:35], v6 offset:8192
    s_waitcnt lgkmcnt(9)
    v_mfma_f32_16x16x32_bf16 v[72:75], a[16:19], a[4:7], v[72:75]
    ds_read_b64_tr_b16 a[48:49], v12 offset:8192
    buffer_load_dwordx4 v16, s[24:27], s57 offen offset:0 lds
    s_waitcnt lgkmcnt(9)
    v_mfma_f32_16x16x32_bf16 v[80:83], a[16:19], a[8:11], v[80:83]
    s_add_u32 s59, s58, s60
    ds_read_b64_tr_b16 a[50:51], v12 offset:12288
    s_waitcnt lgkmcnt(9)
    v_mfma_f32_16x16x32_bf16 v[88:91], a[16:19], a[12:15], v[88:91]
    s_add_u32 s58, s58, 32768
    ds_read_b128 a[36:39], v6 offset:9216
    s_waitcnt lgkmcnt(8)
    v_mfma_f32_16x16x32_bf16 v[68:71], a[20:23], a[0:3], v[68:71]
    s_cmp_ge_u32 s58, 163840
    ds_read_b128 a[40:43], v6 offset:10240
    v_mfma_f32_16x16x32_bf16 v[76:79], a[20:23], a[4:7], v[76:79]
    ds_read_b128 a[44:47], v6 offset:11264
    buffer_load_dwordx4 v17, s[24:27], s57 offen offset:1024 lds
    v_mfma_f32_16x16x32_bf16 v[84:87], a[20:23], a[8:11], v[84:87]
    s_cselect_b32 s66, 4294836224, s100
    ds_read_b64_tr_b16 a[52:53], v13 offset:8192
    v_mfma_f32_16x16x32_bf16 v[92:95], a[20:23], a[12:15], v[92:95]
    s_cselect_b32 s58, 0, s58
    ds_read_b64_tr_b16 a[54:55], v13 offset:12288
    s_waitcnt lgkmcnt(10)
    v_mfma_f32_16x16x32_bf16 v[96:99], a[24:27], a[0:3], v[96:99]
    ds_read_b64_tr_b16 a[56:57], v14 offset:8192
    v_mfma_f32_16x16x32_bf16 v[104:107], a[24:27], a[4:7], v[104:107]
    ds_read_b64_tr_b16 a[58:59], v14 offset:12288
    buffer_load_dwordx4 v18, s[24:27], s57 offen offset:2048 lds
    v_mfma_f32_16x16x32_bf16 v[112:115], a[24:27], a[8:11], v[112:115]
    ds_read_b64_tr_b16 a[60:61], v15 offset:8192
    v_mfma_f32_16x16x32_bf16 v[120:123], a[24:27], a[12:15], v[120:123]
    ds_read_b64_tr_b16 a[62:63], v15 offset:12288
    buffer_store_dwordx4 v[144:147], v2, s[8:11], s70 offen offset:0 sc1
    s_waitcnt lgkmcnt(12)
    v_mfma_f32_16x16x32_bf16 v[100:103], a[28:31], a[0:3], v[100:103]
    v_add_u32 v6, s66, v6
    v_add_u32 v12, s66, v12
    v_mfma_f32_16x16x32_bf16 v[108:111], a[28:31], a[4:7], v[108:111]
    buffer_load_dwordx4 v19, s[24:27], s57 offen offset:3072 lds
    v_mfma_f32_16x16x32_bf16 v[116:119], a[28:31], a[8:11], v[116:119]
    s_add_u32 s57, s57, 131072
    v_add_u32 v13, s66, v13
    v_add_u32 v14, s66, v14
    v_mfma_f32_16x16x32_bf16 v[124:127], a[28:31], a[12:15], v[124:127]
    s_mov_b32 m0, s59
    v_add_u32 v15, s66, v15
    s_waitcnt vmcnt(24) lgkmcnt(0)
    v_mfma_f32_16x16x32_bf16 v[64:67], a[48:51], a[32:35], v[64:67]
    s_barrier
    v_mfma_f32_16x16x32_bf16 v[72:75], a[48:51], a[36:39], v[72:75]
    ds_read_b128 a[0:3], v6 offset:0
    buffer_load_dwordx4 v2, s[36:39], s56 offen offset:0 sc1 lds
    v_mfma_f32_16x16x32_bf16 v[80:83], a[48:51], a[40:43], v[80:83]
    ds_read_b64_tr_b16 a[16:17], v12 offset:0
    v_mfma_f32_16x16x32_bf16 v[88:91], a[48:51], a[44:47], v[88:91]
    ds_read_b64_tr_b16 a[18:19], v12 offset:4096
    v_mfma_f32_16x16x32_bf16 v[68:71], a[52:55], a[32:35], v[68:71]
    ds_read_b128 a[4:7], v6 offset:1024
    v_mfma_f32_16x16x32_bf16 v[76:79], a[52:55], a[36:39], v[76:79]
    ds_read_b128 a[8:11], v6 offset:2048
    buffer_load_dwordx4 v2, s[36:39], s56 offen offset:1024 sc1 lds
    v_mfma_f32_16x16x32_bf16 v[84:87], a[52:55], a[40:43], v[84:87]
    ds_read_b128 a[12:15], v6 offset:3072
    v_mfma_f32_16x16x32_bf16 v[92:95], a[52:55], a[44:47], v[92:95]
    ds_read_b64_tr_b16 a[20:21], v13 offset:0
    v_mfma_f32_16x16x32_bf16 v[96:99], a[56:59], a[32:35], v[96:99]
    ds_read_b64_tr_b16 a[22:23], v13 offset:4096
    v_mfma_f32_16x16x32_bf16 v[104:107], a[56:59], a[36:39], v[104:107]
    ds_read_b64_tr_b16 a[24:25], v14 offset:0
    buffer_load_dwordx4 v2, s[36:39], s56 offen offset:2048 sc1 lds
    v_mfma_f32_16x16x32_bf16 v[112:115], a[56:59], a[40:43], v[112:115]
    ds_read_b64_tr_b16 a[26:27], v14 offset:4096
    v_mfma_f32_16x16x32_bf16 v[120:123], a[56:59], a[44:47], v[120:123]
    ds_read_b64_tr_b16 a[28:29], v15 offset:0
    buffer_store_dwordx4 v[148:151], v2, s[8:11], s70 offen offset:1024 sc1
    v_mfma_f32_16x16x32_bf16 v[100:103], a[60:63], a[32:35], v[100:103]
    s_add_u32 s64, s64, 1
    ds_read_b64_tr_b16 a[30:31], v15 offset:4096
    v_mfma_f32_16x16x32_bf16 v[108:111], a[60:63], a[36:39], v[108:111]
    buffer_load_dwordx4 v2, s[36:39], s56 offen offset:3072 sc1 lds
    v_mfma_f32_16x16x32_bf16 v[116:119], a[60:63], a[40:43], v[116:119]
    s_add_u32 s56, s56, 262144
    v_mfma_f32_16x16x32_bf16 v[124:127], a[60:63], a[44:47], v[124:127]
    s_waitcnt lgkmcnt(9)
    v_mfma_f32_16x16x32_bf16 v[64:67], a[16:19], a[0:3], v[64:67]
    s_add_u32 m0, s59, 16384
    ds_read_b128 a[32:35], v6 offset:8192
    s_waitcnt lgkmcnt(9)
    v_mfma_f32_16x16x32_bf16 v[72:75], a[16:19], a[4:7], v[72:75]
    ds_read_b64_tr_b16 a[48:49], v12 offset:8192
    buffer_load_dwordx4 v16, s[24:27], s57 offen offset:0 lds
    s_waitcnt lgkmcnt(9)
    v_mfma_f32_16x16x32_bf16 v[80:83], a[16:19], a[8:11], v[80:83]
    s_add_u32 s59, s58, s60
    ds_read_b64_tr_b16 a[50:51], v12 offset:12288
    s_waitcnt lgkmcnt(9)
    v_mfma_f32_16x16x32_bf16 v[88:91], a[16:19], a[12:15], v[88:91]
    s_add_u32 s58, s58, 32768
    ds_read_b128 a[36:39], v6 offset:9216
    s_waitcnt lgkmcnt(8)
    v_mfma_f32_16x16x32_bf16 v[68:71], a[20:23], a[0:3], v[68:71]
    s_cmp_ge_u32 s58, 163840
    ds_read_b128 a[40:43], v6 offset:10240
    v_mfma_f32_16x16x32_bf16 v[76:79], a[20:23], a[4:7], v[76:79]
    ds_read_b128 a[44:47], v6 offset:11264
    buffer_load_dwordx4 v17, s[24:27], s57 offen offset:1024 lds
    v_mfma_f32_16x16x32_bf16 v[84:87], a[20:23], a[8:11], v[84:87]
    s_cselect_b32 s66, 4294836224, s100
    ds_read_b64_tr_b16 a[52:53], v13 offset:8192
    v_mfma_f32_16x16x32_bf16 v[92:95], a[20:23], a[12:15], v[92:95]
    s_cselect_b32 s58, 0, s58
    ds_read_b64_tr_b16 a[54:55], v13 offset:12288
    s_waitcnt lgkmcnt(10)
    v_mfma_f32_16x16x32_bf16 v[96:99], a[24:27], a[0:3], v[96:99]
    ds_read_b64_tr_b16 a[56:57], v14 offset:8192
    v_mfma_f32_16x16x32_bf16 v[104:107], a[24:27], a[4:7], v[104:107]
    ds_read_b64_tr_b16 a[58:59], v14 offset:12288
    buffer_load_dwordx4 v18, s[24:27], s57 offen offset:2048 lds
    v_mfma_f32_16x16x32_bf16 v[112:115], a[24:27], a[8:11], v[112:115]
    ds_read_b64_tr_b16 a[60:61], v15 offset:8192
    v_mfma_f32_16x16x32_bf16 v[120:123], a[24:27], a[12:15], v[120:123]
    ds_read_b64_tr_b16 a[62:63], v15 offset:12288
    buffer_store_dwordx4 v[152:155], v2, s[8:11], s70 offen offset:2048 sc1
    s_waitcnt lgkmcnt(12)
    v_mfma_f32_16x16x32_bf16 v[100:103], a[28:31], a[0:3], v[100:103]
    v_add_u32 v6, s66, v6
    v_add_u32 v12, s66, v12
    v_mfma_f32_16x16x32_bf16 v[108:111], a[28:31], a[4:7], v[108:111]
    buffer_load_dwordx4 v19, s[24:27], s57 offen offset:3072 lds
    v_mfma_f32_16x16x32_bf16 v[116:119], a[28:31], a[8:11], v[116:119]
    s_add_u32 s57, s57, 131072
    v_add_u32 v13, s66, v13
    v_add_u32 v14, s66, v14
    v_mfma_f32_16x16x32_bf16 v[124:127], a[28:31], a[12:15], v[124:127]
    s_mov_b32 m0, s59
    v_add_u32 v15, s66, v15
    s_waitcnt vmcnt(24) lgkmcnt(0)
    v_mfma_f32_16x16x32_bf16 v[64:67], a[48:51], a[32:35], v[64:67]
    s_barrier
    v_mfma_f32_16x16x32_bf16 v[72:75], a[48:51], a[36:39], v[72:75]
    ds_read_b128 a[0:3], v6 offset:0
    buffer_load_dwordx4 v2, s[36:39], s56 offen offset:0 sc1 lds
    v_mfma_f32_16x16x32_bf16 v[80:83], a[48:51], a[40:43], v[80:83]
    ds_read_b64_tr_b16 a[16:17], v12 offset:0
    v_mfma_f32_16x16x32_bf16 v[88:91], a[48:51], a[44:47], v[88:91]
    ds_read_b64_tr_b16 a[18:19], v12 offset:4096
    v_mfma_f32_16x16x32_bf16 v[68:71], a[52:55], a[32:35], v[68:71]
    ds_read_b128 a[4:7], v6 offset:1024
    v_mfma_f32_16x16x32_bf16 v[76:79], a[52:55], a[36:39], v[76:79]
    ds_read_b128 a[8:11], v6 offset:2048
    buffer_load_dwordx4 v2, s[36:39], s56 offen offset:1024 sc1 lds
    v_mfma_f32_16x16x32_bf16 v[84:87], a[52:55], a[40:43], v[84:87]
    ds_read_b128 a[12:15], v6 offset:3072
    v_mfma_f32_16x16x32_bf16 v[92:95], a[52:55], a[44:47], v[92:95]
    ds_read_b64_tr_b16 a[20:21], v13 offset:0
    v_mfma_f32_16x16x32_bf16 v[96:99], a[56:59], a[32:35], v[96:99]
    ds_read_b64_tr_b16 a[22:23], v13 offset:4096
    v_mfma_f32_16x16x32_bf16 v[104:107], a[56:59], a[36:39], v[104:107]
    ds_read_b64_tr_b16 a[24:25], v14 offset:0
    buffer_load_dwordx4 v2, s[36:39], s56 offen offset:2048 sc1 lds
    v_mfma_f32_16x16x32_bf16 v[112:115], a[56:59], a[40:43], v[112:115]
    ds_read_b64_tr_b16 a[26:27], v14 offset:4096
    v_mfma_f32_16x16x32_bf16 v[120:123], a[56:59], a[44:47], v[120:123]
    ds_read_b64_tr_b16 a[28:29], v15 offset:0
    buffer_store_dwordx4 v[156:159], v2, s[8:11], s70 offen offset:3072 sc1
    s_add_u32 s70, s70, 4096
    v_mfma_f32_16x16x32_bf16 v[100:103], a[60:63], a[32:35], v[100:103]
    s_add_u32 s64, s64, 1
    ds_read_b64_tr_b16 a[30:31], v15 offset:4096
    v_mfma_f32_16x16x32_bf16 v[108:111], a[60:63], a[36:39], v[108:111]
    buffer_load_dwordx4 v2, s[36:39], s56 offen offset:3072 sc1 lds
    v_mfma_f32_16x16x32_bf16 v[116:119], a[60:63], a[40:43], v[116:119]
    s_add_u32 s56, s56, 262144
    v_mfma_f32_16x16x32_bf16 v[124:127], a[60:63], a[44:47], v[124:127]
    s_mov_b32 s67, 31
    s_branch m_l3125
m_n156:
    s_cmp_lg_u32 s64, 31
    s_cbranch_scc1 m_n157
    s_lshl_b32 s91, s96, 3
    s_add_u32 s91, s91, s97
    s_lshl_b32 s91, s91, 7
    s_add_u32 s91, s91, 16384
    s_cmp_lg_u32 s16, 0
    s_cbranch_scc1 m_np158
    v_mov_b32 v60, s4
    v_mov_b32 v61, s5
    s_add_u32 s90, s91, 117440512
    s_mov_b64 exec, 1
    buffer_store_dwordx2 v[60:61], off, s[8:11], s90 sc1
    s_mov_b64 exec, -1
m_np158:
    s_mov_b32 s67, 34
    s_branch m_l3125
m_n157:
    s_cmp_lg_u32 s64, 34
    s_cbranch_scc1 m_n159
    s_mov_b32 s38, 0
    s_mov_b32 s67, 39
    s_branch m_l3125
m_n159:
    s_branch m_l3x127
m_l3c128:
    s_mov_b32 s67, 35
    s_cmp_lt_u32 s64, 35
    s_cbranch_scc1 m_l3n129
    s_cmp_lg_u32 s64, 35
    s_cbranch_scc1 m_n161
    s_mov_b32 s68, 1000
    s_mov_b32 s67, 36
    s_branch m_l3125
m_n161:
    s_cmp_lg_u32 s64, 36
    s_cbranch_scc1 m_n162
    s_mov_b32 s38, 0
    s_lshl_b32 s91, s96, 3
    s_add_u32 s91, s91, s97
    s_lshl_b32 s91, s91, 7
    s_add_u32 s91, s91, 16384
    s_add_u32 s52, s91, 117440512
    buffer_load_dwordx2 v[4:5], off, s[8:11], s52 sc1
    s_mov_b32 s67, 37
    s_branch m_l3125
m_n162:
    s_cmp_lg_u32 s64, 37
    s_cbranch_scc1 m_n163
    s_mov_b32 s26, 0
    s_mov_b32 s67, 38
    s_branch m_l3125
m_n163:
    s_cmp_lg_u32 s64, 38
    s_cbranch_scc1 m_n164
    s_waitcnt vmcnt(16)
    s_mov_b32 s3, 1048576
m_spin165:
    v_cmp_ne_u64 s[76:77], s[4:5], v[4:5]
    s_nop 3
    s_cmp_eq_u64 s[76:77], 0
    s_cbranch_scc1 m_ok166
    s_sub_u32 s3, s3, 1
    s_cbranch_scc1 m_ok166
    s_sleep 8
    buffer_load_dwordx2 v[4:5], off, s[8:11], s52 sc1
    s_waitcnt vmcnt(0)
    s_branch m_spin165
m_ok166:
    s_lshl_b32 s90, s96, 3
    s_add_u32 s90, s90, s97
    s_lshl_b32 s90, s90, 15
    s_lshl_b32 s91, s16, 13
    s_add_u32 s90, s90, s91
    s_add_u32 s70, s90, 100663296
    buffer_load_dwordx4 v[128:131], v2, s[8:11], s70 offen offset:0 sc1
    buffer_load_dwordx4 v[132:135], v2, s[8:11], s70 offen offset:1024 sc1
    buffer_load_dwordx4 v[136:139], v2, s[8:11], s70 offen offset:2048 sc1
    buffer_load_dwordx4 v[140:143], v2, s[8:11], s70 offen offset:3072 sc1
    s_add_u32 s70, s70, 4096
    buffer_load_dwordx4 v[144:147], v2, s[8:11], s70 offen offset:0 sc1
    buffer_load_dwordx4 v[148:151], v2, s[8:11], s70 offen offset:1024 sc1
    buffer_load_dwordx4 v[152:155], v2, s[8:11], s70 offen offset:2048 sc1
    buffer_load_dwordx4 v[156:159], v2, s[8:11], s70 offen offset:3072 sc1
    s_mov_b32 s67, 41
    s_branch m_l3125
m_n164:
    s_branch m_l3x127
m_o1149:
    s_and_b32 s91, s2, 7
    s_lshl_b32 s91, s91, 5
    s_lshr_b32 s92, s2, 3
    s_add_u32 s91, s91, s92
    s_lshl_b32 s91, s91, 3
    s_add_u32 s91, s91, 12288
    s_cmp_lg_u32 s16, 0
    s_cbranch_scc1 m_np168
    v_mov_b32 v60, s4
    v_mov_b32 v61, s5
    s_add_u32 s90, s91, 117440512
    s_mov_b64 exec, 1
    buffer_store_dwordx2 v[60:61], off, s[8:11], s90 sc1
    s_mov_b64 exec, -1
m_np168:
    s_branch m_o2150
m_l3n129:
    s_sub_u32 s90, s68, 5
    s_min_u32 s67, s67, s90
    s_branch m_l3125
m_l3x127:
    s_cmp_eq_u32 s95, 1
    s_cbranch_scc1 m_noadd169
    s_waitcnt vmcnt(0)
    v_lshlrev_b32 v160, 16, v128
    v_and_b32 v161, 0xffff0000, v128
    v_lshlrev_b32 v162, 16, v129
    v_and_b32 v163, 0xffff0000, v129
    v_lshlrev_b32 v164, 16, v130
    v_and_b32 v165, 0xffff0000, v130
    v_lshlrev_b32 v166, 16, v131
    v_and_b32 v167, 0xffff0000, v131
    v_lshlrev_b32 v168, 16, v132
    v_and_b32 v169, 0xffff0000, v132
    v_lshlrev_b32 v170, 16, v133
    v_and_b32 v171, 0xffff0000, v133
    v_lshlrev_b32 v172, 16, v134
    v_and_b32 v173, 0xffff0000, v134
    v_lshlrev_b32 v174, 16, v135
    v_and_b32 v175, 0xffff0000, v135
    v_lshlrev_b32 v176, 16, v136
    v_and_b32 v177, 0xffff0000, v136
    v_lshlrev_b32 v178, 16, v137
    v_and_b32 v179, 0xffff0000, v137
    v_lshlrev_b32 v180, 16, v138
    v_and_b32 v181, 0xffff0000, v138
    v_lshlrev_b32 v182, 16, v139
    v_and_b32 v183, 0xffff0000, v139
    v_lshlrev_b32 v184, 16, v140
    v_and_b32 v185, 0xffff0000, v140
    v_lshlrev_b32 v186, 16, v141
    v_and_b32 v187, 0xffff0000, v141
    v_lshlrev_b32 v188, 16, v142
    v_and_b32 v189, 0xffff0000, v142
    v_lshlrev_b32 v190, 16, v143
    v_and_b32 v191, 0xffff0000, v143
    v_lshlrev_b32 v192, 16, v144
    v_and_b32 v193, 0xffff0000, v144
    v_lshlrev_b32 v194, 16, v145
    v_and_b32 v195, 0xffff0000, v145
    v_lshlrev_b32 v196, 16, v146
    v_and_b32 v197, 0xffff0000, v146
    v_lshlrev_b32 v198, 16, v147
    v_and_b32 v199, 0xffff0000, v147
    v_lshlrev_b32 v200, 16, v148
    v_and_b32 v201, 0xffff0000, v148
    v_lshlrev_b32 v202, 16, v149
    v_and_b32 v203, 0xffff0000, v149
    v_lshlrev_b32 v204, 16, v150
    v_and_b32 v205, 0xffff0000, v150
    v_lshlrev_b32 v206, 16, v151
    v_and_b32 v207, 0xffff0000, v151
    v_lshlrev_b32 v208, 16, v152
    v_and_b32 v209, 0xffff0000, v152
    v_lshlrev_b32 v210, 16, v153
    v_and_b32 v211, 0xffff0000, v153
    v_lshlrev_b32 v212, 16, v154
    v_and_b32 v213, 0xffff0000, v154
    v_lshlrev_b32 v214, 16, v155
    v_and_b32 v215, 0xffff0000, v155
    v_lshlrev_b32 v216, 16, v156
    v_and_b32 v217, 0xffff0000, v156
    v_lshlrev_b32 v218, 16, v157
    v_and_b32 v219, 0xffff0000, v157
    v_lshlrev_b32 v220, 16, v158
    v_and_b32 v221, 0xffff0000, v158
    v_lshlrev_b32 v222, 16, v159
    v_and_b32 v223, 0xffff0000, v159
    v_pk_add_f32 v[64:65], v[64:65], v[160:161]
    v_pk_add_f32 v[66:67], v[66:67], v[162:163]
    v_pk_add_f32 v[68:69], v[68:69], v[164:165]
    v_pk_add_f32 v[70:71], v[70:71], v[166:167]
    v_pk_add_f32 v[72:73], v[72:73], v[168:169]
    v_pk_add_f32 v[74:75], v[74:75], v[170:171]
    v_pk_add_f32 v[76:77], v[76:77], v[172:173]
    v_pk_add_f32 v[78:79], v[78:79], v[174:175]
    v_pk_add_f32 v[80:81], v[80:81], v[176:177]
    v_pk_add_f32 v[82:83], v[82:83], v[178:179]
    v_pk_add_f32 v[84:85], v[84:85], v[180:181]
    v_pk_add_f32 v[86:87], v[86:87], v[182:183]
    v_pk_add_f32 v[88:89], v[88:89], v[184:185]
    v_pk_add_f32 v[90:91], v[90:91], v[186:187]
    v_pk_add_f32 v[92:93], v[92:93], v[188:189]
    v_pk_add_f32 v[94:95], v[94:95], v[190:191]
    v_pk_add_f32 v[96:97], v[96:97], v[192:193]
    v_pk_add_f32 v[98:99], v[98:99], v[194:195]
    v_pk_add_f32 v[100:101], v[100:101], v[196:197]
    v_pk_add_f32 v[102:103], v[102:103], v[198:199]
    v_pk_add_f32 v[104:105], v[104:105], v[200:201]
    v_pk_add_f32 v[106:107], v[106:107], v[202:203]
    v_pk_add_f32 v[108:109], v[108:109], v[204:205]
    v_pk_add_f32 v[110:111], v[110:111], v[206:207]
    v_pk_add_f32 v[112:113], v[112:113], v[208:209]
    v_pk_add_f32 v[114:115], v[114:115], v[210:211]
    v_pk_add_f32 v[116:117], v[116:117], v[212:213]
    v_pk_add_f32 v[118:119], v[118:119], v[214:215]
    v_pk_add_f32 v[120:121], v[120:121], v[216:217]
    v_pk_add_f32 v[122:123], v[122:123], v[218:219]
    v_pk_add_f32 v[124:125], v[124:125], v[220:221]
    v_pk_add_f32 v[126:127], v[126:127], v[222:223]
m_noadd169:
    v_cvt_pk_bf16_f32 v64, v64, v65
    v_cvt_pk_bf16_f32 v65, v66, v67
    v_cvt_pk_bf16_f32 v66, v68, v69
    v_cvt_pk_bf16_f32 v67, v70, v71
    v_cvt_pk_bf16_f32 v96, v96, v97
    v_cvt_pk_bf16_f32 v97, v98, v99
    v_cvt_pk_bf16_f32 v98, v100, v101
    v_cvt_pk_bf16_f32 v99, v102, v103
    s_nop 1
    v_permlane16_swap_b32 v64, v66
    v_permlane16_swap_b32 v65, v67
    v_permlane16_swap_b32 v96, v98
    v_permlane16_swap_b32 v97, v99
    buffer_store_dwordx4 v[64:67], v7, s[28:31], s71 offen offset:0 sc1
    buffer_store_dwordx4 v[96:99], v7, s[28:31], s71 offen offset:64 sc1
    s_add_u32 s71, s71, s72
    v_cvt_pk_bf16_f32 v72, v72, v73
    v_cvt_pk_bf16_f32 v73, v74, v75
    v_cvt_pk_bf16_f32 v74, v76, v77
    v_cvt_pk_bf16_f32 v75, v78, v79
    v_cvt_pk_bf16_f32 v104, v104, v105
    v_cvt_pk_bf16_f32 v105, v106, v107
    v_cvt_pk_bf16_f32 v106, v108, v109
    v_cvt_pk_bf16_f32 v107, v110, v111
    s_nop 1
    v_permlane16_swap_b32 v72, v74
    v_permlane16_swap_b32 v73, v75
    v_permlane16_swap_b32 v104, v106
    v_permlane16_swap_b32 v105, v107
    buffer_store_dwordx4 v[72:75], v7, s[28:31], s71 offen offset:0 sc1
    buffer_store_dwordx4 v[104:107], v7, s[28:31], s71 offen offset:64 sc1
    s_add_u32 s71, s71, s72
    v_cvt_pk_bf16_f32 v80, v80, v81
    v_cvt_pk_bf16_f32 v81, v82, v83
    v_cvt_pk_bf16_f32 v82, v84, v85
    v_cvt_pk_bf16_f32 v83, v86, v87
    v_cvt_pk_bf16_f32 v112, v112, v113
    v_cvt_pk_bf16_f32 v113, v114, v115
    v_cvt_pk_bf16_f32 v114, v116, v117
    v_cvt_pk_bf16_f32 v115, v118, v119
    s_nop 1
    v_permlane16_swap_b32 v80, v82
    v_permlane16_swap_b32 v81, v83
    v_permlane16_swap_b32 v112, v114
    v_permlane16_swap_b32 v113, v115
    buffer_store_dwordx4 v[80:83], v7, s[28:31], s71 offen offset:0 sc1
    buffer_store_dwordx4 v[112:115], v7, s[28:31], s71 offen offset:64 sc1
    s_add_u32 s71, s71, s72
    v_cvt_pk_bf16_f32 v88, v88, v89
    v_cvt_pk_bf16_f32 v89, v90, v91
    v_cvt_pk_bf16_f32 v90, v92, v93
    v_cvt_pk_bf16_f32 v91, v94, v95
    v_cvt_pk_bf16_f32 v120, v120, v121
    v_cvt_pk_bf16_f32 v121, v122, v123
    v_cvt_pk_bf16_f32 v122, v124, v125
    v_cvt_pk_bf16_f32 v123, v126, v127
    s_nop 1
    v_permlane16_swap_b32 v88, v90
    v_permlane16_swap_b32 v89, v91
    v_permlane16_swap_b32 v120, v122
    v_permlane16_swap_b32 v121, v123
    buffer_store_dwordx4 v[88:91], v7, s[28:31], s71 offen offset:0 sc1
    buffer_store_dwordx4 v[120:123], v7, s[28:31], s71 offen offset:64 sc1
    s_add_u32 s71, s71, s72
m_end1:
    s_endpgm
m_stub71:
    v_cmp_lt_f32 vcc, s65, v8
    s_cmp_lg_u32 s64, s67
    s_cbranch_scc1 m_e171
    v_add_f32 v176, v176, v16
    v_mov_b32 v180, v9
    v_add_f32 v188, v188, v16
    v_add_f32 v177, v177, v17
    v_mov_b32 v181, v9
    v_add_f32 v189, v189, v17
    v_add_f32 v178, v178, v18
    v_mov_b32 v182, v9
    v_add_f32 v190, v190, v18
    v_add_f32 v179, v179, v19
    v_mov_b32 v183, v9
    v_add_f32 v191, v191, v19
    s_nop 0
m_e171:
    s_cmp_lg_u32 s64, s68
    s_cbranch_scc1 m_e172
    v_mov_b32 v176, v9
    v_mov_b32 v184, v9
    v_mov_b32 v188, v9
    v_mov_b32 v177, v9
    v_mov_b32 v185, v9
    v_mov_b32 v189, v9
    v_mov_b32 v178, v9
    v_mov_b32 v186, v9
    v_mov_b32 v190, v9
    v_mov_b32 v179, v9
    v_mov_b32 v187, v9
    v_mov_b32 v191, v9
    s_nop 0
m_e172:
    s_cbranch_vccnz m_rc173
m_sp170:
    s_branch m_ret72
m_stub74:
    v_cmp_lt_f32 vcc, s65, v8
    s_cmp_lg_u32 s64, s67
    s_cbranch_scc1 m_e175
    v_add_f32 v176, v176, v16
    v_mov_b32 v180, v9
    v_add_f32 v188, v188, v16
    v_add_f32 v177, v177, v17
    v_mov_b32 v181, v9
    v_add_f32 v189, v189, v17
    v_add_f32 v178, v178, v18
    v_mov_b32 v182, v9
    v_add_f32 v190, v190, v18
    v_add_f32 v179, v179, v19
    v_mov_b32 v183, v9
    v_add_f32 v191, v191, v19
    s_nop 0
m_e175:
    s_cmp_lg_u32 s64, s68
    s_cbranch_scc1 m_e176
    v_mov_b32 v176, v9
    v_mov_b32 v184, v9
    v_mov_b32 v188, v9
    v_mov_b32 v177, v9
    v_mov_b32 v185, v9
    v_mov_b32 v189, v9
    v_mov_b32 v178, v9
    v_mov_b32 v186, v9
    v_mov_b32 v190, v9
    v_mov_b32 v179, v9
    v_mov_b32 v187, v9
    v_mov_b32 v191, v9
    s_nop 0
m_e176:
    s_cbranch_vccnz m_rc177
m_sp174:
    s_branch m_ret75
m_stub92:
    v_cmp_lt_f32 vcc, s65, v8
    s_cmp_lg_u32 s64, s70
    s_cbranch_scc1 m_e179
    v_add_f32 v160, v160, v16
    v_mov_b32 v164, v9
    v_add_f32 v172, v172, v16
    v_add_f32 v161, v161, v17
    v_mov_b32 v165, v9
    v_add_f32 v173, v173, v17
    v_add_f32 v162, v162, v18
    v_mov_b32 v166, v9
    v_add_f32 v174, v174, v18
    v_add_f32 v163, v163, v19
    v_mov_b32 v167, v9
    v_add_f32 v175, v175, v19
    s_nop 0
m_e179:
    s_cmp_lg_u32 s64, s71
    s_cbranch_scc1 m_e180
    v_mov_b32 v160, v9
    v_mov_b32 v168, v9
    v_mov_b32 v172, v9
    v_mov_b32 v161, v9
    v_mov_b32 v169, v9
    v_mov_b32 v173, v9
    v_mov_b32 v162, v9
    v_mov_b32 v170, v9
    v_mov_b32 v174, v9
    v_mov_b32 v163, v9
    v_mov_b32 v171, v9
    v_mov_b32 v175, v9
    s_nop 0
m_e180:
    s_cbranch_vccnz m_rc181
m_sp178:
    s_branch m_ret93
m_stub94:
    v_cmp_lt_f32 vcc, s65, v8
    s_cmp_lg_u32 s64, s70
    s_cbranch_scc1 m_e183
    v_add_f32 v160, v160, v16
    v_mov_b32 v164, v9
    v_add_f32 v172, v172, v16
    v_add_f32 v161, v161, v17
    v_mov_b32 v165, v9
    v_add_f32 v173, v173, v17
    v_add_f32 v162, v162, v18
    v_mov_b32 v166, v9
    v_add_f32 v174, v174, v18
    v_add_f32 v163, v163, v19
    v_mov_b32 v167, v9
    v_add_f32 v175, v175, v19
    s_nop 0
m_e183:
    s_cmp_lg_u32 s64, s71
    s_cbranch_scc1 m_e184
    v_mov_b32 v160, v9
    v_mov_b32 v168, v9
    v_mov_b32 v172, v9
    v_mov_b32 v161, v9
    v_mov_b32 v169, v9
    v_mov_b32 v173, v9
    v_mov_b32 v162, v9
    v_mov_b32 v170, v9
    v_mov_b32 v174, v9
    v_mov_b32 v163, v9
    v_mov_b32 v171, v9
    v_mov_b32 v175, v9
    s_nop 0
m_e184:
    s_cmp_lg_u32 s64, s53
    s_cbranch_scc1 m_e187
    s_cmp_lg_u32 s16, 0
    s_cbranch_scc1 m_np188
    v_mov_b32 v60, s4
    v_mov_b32 v61, s5
    s_add_u32 s90, s17, 117440512
    s_mov_b64 exec, 1
    buffer_store_dwordx2 v[60:61], off, s[8:11], s90 sc1
    s_mov_b64 exec, -1
m_np188:
    s_mov_b32 s17, -1
m_e187:
    s_cmp_gt_u32 s64, 26
    s_cbranch_scc1 m_e185
    s_cmp_lg_u32 s64, 6
    s_cbranch_scc1 m_e189
    s_lshr_b32 s90, s32, 1
    s_lshl_b32 s90, s90, 7
    s_add_u32 s90, s90, 117440600
    v_min_u32 v0, 1, v1
    v_lshlrev_b32 v0, 5, v0
    buffer_load_dwordx2 v[4:5], v0, s[8:11], s90 offen sc1
    s_cmp_eq_u32 s17, -1
    s_cbranch_scc1 m_e185
    s_cmp_lg_u32 s16, 0
    s_cbranch_scc1 m_np190
    v_mov_b32 v60, s4
    v_mov_b32 v61, s5
    s_add_u32 s90, s17, 117440512
    s_mov_b64 exec, 1
    buffer_store_dwordx2 v[60:61], off, s[8:11], s90 sc1
    s_mov_b64 exec, -1
m_np190:
    s_branch m_e185
m_e189:
    s_cmp_lg_u32 s64, 18
    s_cbranch_scc1 m_e191
    s_waitcnt vmcnt(18)
    s_mov_b32 s3, 1048576
m_spin192:
    v_cmp_ne_u64 s[76:77], s[4:5], v[4:5]
    s_nop 3
    s_cmp_eq_u64 s[76:77], 0
    s_cbranch_scc1 m_e185
    s_sub_u32 s3, s3, 1
    s_cbranch_scc1 m_e185
    s_sleep 32
    s_lshr_b32 s90, s32, 1
    s_lshl_b32 s90, s90, 7
    s_add_u32 s90, s90, 117440600
    v_min_u32 v0, 1, v1
    v_lshlrev_b32 v0, 5, v0
    buffer_load_dwordx2 v[4:5], v0, s[8:11], s90 offen sc1
    s_waitcnt vmcnt(0)
    s_branch m_spin192
    s_branch m_e185
m_e191:
    s_cmp_lg_u32 s64, 22
    s_cbranch_scc1 m_e193
    buffer_load_dwordx2 v[4:5], v10, s[8:11], 0 offen sc1
    s_mov_b32 s44, s48
    s_mov_b32 s45, s49
    s_mov_b32 s46, 8388608
    s_lshl_b32 s90, s2, 2
    s_add_u32 s90, s90, s16
    s_lshl_b32 s90, s90, 13
    v_lshlrev_b32 v62, 7, v1
    buffer_load_dword v255, v62, s[44:47], s90 offen
    s_branch m_e185
m_e193:
    s_cmp_lg_u32 s64, 26
    s_cbranch_scc1 m_e194
    s_mov_b32 s44, s50
    s_mov_b32 s45, s51
    s_mov_b32 s46, 2097152
    s_lshl_b32 s90, s2, 2
    s_add_u32 s90, s90, s16
    s_lshl_b32 s90, s90, 13
    v_lshlrev_b32 v62, 7, v1
    buffer_load_dword v255, v62, s[44:47], s90 offen
    s_waitcnt vmcnt(18)
    s_mov_b32 s3, 1048576
m_spin195:
    v_cmp_ne_u64 s[76:77], s[4:5], v[4:5]
    s_nop 3
    s_cmp_eq_u64 s[76:77], 0
    s_cbranch_scc1 m_e185
    s_sub_u32 s3, s3, 1
    s_cbranch_scc1 m_e185
    s_sleep 32
    buffer_load_dwordx2 v[4:5], v10, s[8:11], 0 offen sc1
    s_waitcnt vmcnt(0)
    s_branch m_spin195
    s_branch m_e185
m_e194:
m_e185:
    s_cbranch_vccnz m_rc196
m_sp182:
    s_branch m_ret95
m_stub97:
    v_cmp_lt_f32 vcc, s65, v8
    s_cmp_lg_u32 s64, s70
    s_cbranch_scc1 m_e198
    v_add_f32 v160, v160, v16
    v_mov_b32 v164, v9
    v_add_f32 v172, v172, v16
    v_add_f32 v161, v161, v17
    v_mov_b32 v165, v9
    v_add_f32 v173, v173, v17
    v_add_f32 v162, v162, v18
    v_mov_b32 v166, v9
    v_add_f32 v174, v174, v18
    v_add_f32 v163, v163, v19
    v_mov_b32 v167, v9
    v_add_f32 v175, v175, v19
    s_nop 0
m_e198:
    s_cmp_lg_u32 s64, s71
    s_cbranch_scc1 m_e199
    v_mov_b32 v160, v9
    v_mov_b32 v168, v9
    v_mov_b32 v172, v9
    v_mov_b32 v161, v9
    v_mov_b32 v169, v9
    v_mov_b32 v173, v9
    v_mov_b32 v162, v9
    v_mov_b32 v170, v9
    v_mov_b32 v174, v9
    v_mov_b32 v163, v9
    v_mov_b32 v171, v9
    v_mov_b32 v175, v9
    s_nop 0
m_e199:
    s_cbranch_vccnz m_rc200
m_sp197:
    s_branch m_ret98
m_stub114:
    v_cmp_lt_f32 vcc, s65, v8
    s_cbranch_vccnz m_rc202
m_sp201:
    s_branch m_ret115
m_rc91:
    s_call_b64 s[74:75], m_rs0465
    s_branch m_sp76
m_rc113:
    s_call_b64 s[74:75], m_rs0264
    s_branch m_sp99
m_rc173:
    s_call_b64 s[74:75], m_rs0465
    s_branch m_sp170
m_rc177:
    s_call_b64 s[74:75], m_rs1467
    s_branch m_sp174
m_rc181:
    s_call_b64 s[74:75], m_rs1467
    s_branch m_sp178
m_rc196:
    s_call_b64 s[74:75], m_rs0264
    s_branch m_sp182
m_rc200:
    s_call_b64 s[74:75], m_rs1266
    s_branch m_sp197
m_rc202:
    s_call_b64 s[74:75], m_rs1266
    s_branch m_sp201
m_rs0264:
    s_nop 15
    v_max3_f32 v48, v64, v65, v66
    v_max3_f32 v48, v48, v67, v68
    v_max3_f32 v48, v48, v69, v70
    v_max3_f32 v48, v48, v71, 0
    v_mov_b32 v49, v48
    s_nop 1
    v_permlane32_swap_b32 v48, v49
    s_nop 1
    v_max_f32 v48, v48, v49
    v_mov_b32 v49, v48
    s_nop 1
    v_permlane16_swap_b32 v48, v49
    s_nop 1
    v_max_f32 v48, v48, v49
    v_exp_f32 v49, -v48
    v_sub_f32 v64, v64, v48
    v_sub_f32 v65, v65, v48
    v_sub_f32 v66, v66, v48
    v_sub_f32 v67, v67, v48
    v_sub_f32 v68, v68, v48
    v_sub_f32 v69, v69, v48
    v_sub_f32 v70, v70, v48
    v_sub_f32 v71, v71, v48
    v_sub_f32 v96, v96, v48
    v_sub_f32 v97, v97, v48
    v_sub_f32 v98, v98, v48
    v_sub_f32 v99, v99, v48
    v_sub_f32 v100, v100, v48
    v_sub_f32 v101, v101, v48
    v_sub_f32 v102, v102, v48
    v_sub_f32 v103, v103, v48
    v_sub_f32 v160, v160, v48
    v_sub_f32 v161, v161, v48
    v_sub_f32 v162, v162, v48
    v_sub_f32 v163, v163, v48
    v_sub_f32 v164, v164, v48
    v_sub_f32 v165, v165, v48
    v_sub_f32 v166, v166, v48
    v_sub_f32 v167, v167, v48
    v_mul_f32 v12, v12, v49
    v_accvgpr_read_b32 v52, a0
    v_accvgpr_read_b32 v53, a1
    v_accvgpr_read_b32 v54, a2
    v_accvgpr_read_b32 v55, a3
    v_accvgpr_read_b32 v56, a4
    v_accvgpr_read_b32 v57, a5
    v_accvgpr_read_b32 v58, a6
    v_accvgpr_read_b32 v59, a7
    v_mul_f32 v52, v52, v49
    v_mul_f32 v53, v53, v49
    v_mul_f32 v54, v54, v49
    v_mul_f32 v55, v55, v49
    v_mul_f32 v56, v56, v49
    v_mul_f32 v57, v57, v49
    v_mul_f32 v58, v58, v49
    v_mul_f32 v59, v59, v49
    v_accvgpr_write_b32 a0, v52
    v_accvgpr_write_b32 a1, v53
    v_accvgpr_write_b32 a2, v54
    v_accvgpr_write_b32 a3, v55
    v_accvgpr_write_b32 a4, v56
    v_accvgpr_write_b32 a5, v57
    v_accvgpr_write_b32 a6, v58
    v_accvgpr_write_b32 a7, v59
    v_accvgpr_read_b32 v52, a8
    v_accvgpr_read_b32 v53, a9
    v_accvgpr_read_b32 v54, a10
    v_accvgpr_read_b32 v55, a11
    v_accvgpr_read_b32 v56, a12
    v_accvgpr_read_b32 v57, a13
    v_accvgpr_read_b32 v58, a14
    v_accvgpr_read_b32 v59, a15
    v_mul_f32 v52, v52, v49
    v_mul_f32 v53, v53, v49
    v_mul_f32 v54, v54, v49
    v_mul_f32 v55, v55, v49
    v_mul_f32 v56, v56, v49
    v_mul_f32 v57, v57, v49
    v_mul_f32 v58, v58, v49
    v_mul_f32 v59, v59, v49
    v_accvgpr_write_b32 a8, v52
    v_accvgpr_write_b32 a9, v53
    v_accvgpr_write_b32 a10, v54
    v_accvgpr_write_b32 a11, v55
    v_accvgpr_write_b32 a12, v56
    v_accvgpr_write_b32 a13, v57
    v_accvgpr_write_b32 a14, v58
    v_accvgpr_write_b32 a15, v59
    v_accvgpr_read_b32 v52, a16
    v_accvgpr_read_b32 v53, a17
    v_accvgpr_read_b32 v54, a18
    v_accvgpr_read_b32 v55, a19
    v_accvgpr_read_b32 v56, a20
    v_accvgpr_read_b32 v57, a21
    v_accvgpr_read_b32 v58, a22
    v_accvgpr_read_b32 v59, a23
    v_mul_f32 v52, v52, v49
    v_mul_f32 v53, v53, v49
    v_mul_f32 v54, v54, v49
    v_mul_f32 v55, v55, v49
    v_mul_f32 v56, v56, v49
    v_mul_f32 v57, v57, v49
    v_mul_f32 v58, v58, v49
    v_mul_f32 v59, v59, v49
    v_accvgpr_write_b32 a16, v52
    v_accvgpr_write_b32 a17, v53
    v_accvgpr_write_b32 a18, v54
    v_accvgpr_write_b32 a19, v55
    v_accvgpr_write_b32 a20, v56
    v_accvgpr_write_b32 a21, v57
    v_accvgpr_write_b32 a22, v58
    v_accvgpr_write_b32 a23, v59
    v_accvgpr_read_b32 v52, a24
    v_accvgpr_read_b32 v53, a25
    v_accvgpr_read_b32 v54, a26
    v_accvgpr_read_b32 v55, a27
    v_accvgpr_read_b32 v56, a28
    v_accvgpr_read_b32 v57, a29
    v_accvgpr_read_b32 v58, a30
    v_accvgpr_read_b32 v59, a31
    v_mul_f32 v52, v52, v49
    v_mul_f32 v53, v53, v49
    v_mul_f32 v54, v54, v49
    v_mul_f32 v55, v55, v49
    v_mul_f32 v56, v56, v49
    v_mul_f32 v57, v57, v49
    v_mul_f32 v58, v58, v49
    v_mul_f32 v59, v59, v49
    v_accvgpr_write_b32 a24, v52
    v_accvgpr_write_b32 a25, v53
    v_accvgpr_write_b32 a26, v54
    v_accvgpr_write_b32 a27, v55
    v_accvgpr_write_b32 a28, v56
    v_accvgpr_write_b32 a29, v57
    v_accvgpr_write_b32 a30, v58
    v_accvgpr_write_b32 a31, v59
    v_exp_f32 v52, v64
    v_exp_f32 v53, v65
    v_exp_f32 v54, v66
    v_exp_f32 v55, v67
    v_exp_f32 v56, v68
    v_exp_f32 v57, v69
    v_exp_f32 v58, v70
    v_exp_f32 v59, v71
    s_nop 0
    v_cvt_pk_bf16_f32 v128, v52, v53
    v_cvt_pk_bf16_f32 v129, v54, v55
    v_cvt_pk_bf16_f32 v130, v56, v57
    v_cvt_pk_bf16_f32 v131, v58, v59
    s_nop 1
    v_mfma_f32_16x16x32_bf16 v[28:31], v[44:47], v[128:131], 0
    v_max3_f32 v48, v72, v73, v74
    v_max3_f32 v48, v48, v75, v76
    v_max3_f32 v48, v48, v77, v78
    v_max3_f32 v48, v48, v79, 0
    v_mov_b32 v49, v48
    s_nop 1
    v_permlane32_swap_b32 v48, v49
    s_nop 1
    v_max_f32 v48, v48, v49
    v_mov_b32 v49, v48
    s_nop 1
    v_permlane16_swap_b32 v48, v49
    s_nop 1
    v_max_f32 v48, v48, v49
    v_exp_f32 v49, -v48
    v_sub_f32 v72, v72, v48
    v_sub_f32 v73, v73, v48
    v_sub_f32 v74, v74, v48
    v_sub_f32 v75, v75, v48
    v_sub_f32 v76, v76, v48
    v_sub_f32 v77, v77, v48
    v_sub_f32 v78, v78, v48
    v_sub_f32 v79, v79, v48
    v_sub_f32 v104, v104, v48
    v_sub_f32 v105, v105, v48
    v_sub_f32 v106, v106, v48
    v_sub_f32 v107, v107, v48
    v_sub_f32 v108, v108, v48
    v_sub_f32 v109, v109, v48
    v_sub_f32 v110, v110, v48
    v_sub_f32 v111, v111, v48
    v_sub_f32 v168, v168, v48
    v_sub_f32 v169, v169, v48
    v_sub_f32 v170, v170, v48
    v_sub_f32 v171, v171, v48
    v_sub_f32 v172, v172, v48
    v_sub_f32 v173, v173, v48
    v_sub_f32 v174, v174, v48
    v_sub_f32 v175, v175, v48
    v_mul_f32 v13, v13, v49
    v_accvgpr_read_b32 v52, a32
    v_accvgpr_read_b32 v53, a33
    v_accvgpr_read_b32 v54, a34
    v_accvgpr_read_b32 v55, a35
    v_accvgpr_read_b32 v56, a36
    v_accvgpr_read_b32 v57, a37
    v_accvgpr_read_b32 v58, a38
    v_accvgpr_read_b32 v59, a39
    v_mul_f32 v52, v52, v49
    v_mul_f32 v53, v53, v49
    v_mul_f32 v54, v54, v49
    v_mul_f32 v55, v55, v49
    v_mul_f32 v56, v56, v49
    v_mul_f32 v57, v57, v49
    v_mul_f32 v58, v58, v49
    v_mul_f32 v59, v59, v49
    v_accvgpr_write_b32 a32, v52
    v_accvgpr_write_b32 a33, v53
    v_accvgpr_write_b32 a34, v54
    v_accvgpr_write_b32 a35, v55
    v_accvgpr_write_b32 a36, v56
    v_accvgpr_write_b32 a37, v57
    v_accvgpr_write_b32 a38, v58
    v_accvgpr_write_b32 a39, v59
    v_accvgpr_read_b32 v52, a40
    v_accvgpr_read_b32 v53, a41
    v_accvgpr_read_b32 v54, a42
    v_accvgpr_read_b32 v55, a43
    v_accvgpr_read_b32 v56, a44
    v_accvgpr_read_b32 v57, a45
    v_accvgpr_read_b32 v58, a46
    v_accvgpr_read_b32 v59, a47
    v_mul_f32 v52, v52, v49
    v_mul_f32 v53, v53, v49
    v_mul_f32 v54, v54, v49
    v_mul_f32 v55, v55, v49
    v_mul_f32 v56, v56, v49
    v_mul_f32 v57, v57, v49
    v_mul_f32 v58, v58, v49
    v_mul_f32 v59, v59, v49
    v_accvgpr_write_b32 a40, v52
    v_accvgpr_write_b32 a41, v53
    v_accvgpr_write_b32 a42, v54
    v_accvgpr_write_b32 a43, v55
    v_accvgpr_write_b32 a44, v56
    v_accvgpr_write_b32 a45, v57
    v_accvgpr_write_b32 a46, v58
    v_accvgpr_write_b32 a47, v59
    v_accvgpr_read_b32 v52, a48
    v_accvgpr_read_b32 v53, a49
    v_accvgpr_read_b32 v54, a50
    v_accvgpr_read_b32 v55, a51
    v_accvgpr_read_b32 v56, a52
    v_accvgpr_read_b32 v57, a53
    v_accvgpr_read_b32 v58, a54
    v_accvgpr_read_b32 v59, a55
    v_mul_f32 v52, v52, v49
    v_mul_f32 v53, v53, v49
    v_mul_f32 v54, v54, v49
    v_mul_f32 v55, v55, v49
    v_mul_f32 v56, v56, v49
    v_mul_f32 v57, v57, v49
    v_mul_f32 v58, v58, v49
    v_mul_f32 v59, v59, v49
    v_accvgpr_write_b32 a48, v52
    v_accvgpr_write_b32 a49, v53
    v_accvgpr_write_b32 a50, v54
    v_accvgpr_write_b32 a51, v55
    v_accvgpr_write_b32 a52, v56
    v_accvgpr_write_b32 a53, v57
    v_accvgpr_write_b32 a54, v58
    v_accvgpr_write_b32 a55, v59
    v_accvgpr_read_b32 v52, a56
    v_accvgpr_read_b32 v53, a57
    v_accvgpr_read_b32 v54, a58
    v_accvgpr_read_b32 v55, a59
    v_accvgpr_read_b32 v56, a60
    v_accvgpr_read_b32 v57, a61
    v_accvgpr_read_b32 v58, a62
    v_accvgpr_read_b32 v59, a63
    v_mul_f32 v52, v52, v49
    v_mul_f32 v53, v53, v49
    v_mul_f32 v54, v54, v49
    v_mul_f32 v55, v55, v49
    v_mul_f32 v56, v56, v49
    v_mul_f32 v57, v57, v49
    v_mul_f32 v58, v58, v49
    v_mul_f32 v59, v59, v49
    v_accvgpr_write_b32 a56, v52
    v_accvgpr_write_b32 a57, v53
    v_accvgpr_write_b32 a58, v54
    v_accvgpr_write_b32 a59, v55
    v_accvgpr_write_b32 a60, v56
    v_accvgpr_write_b32 a61, v57
    v_accvgpr_write_b32 a62, v58
    v_accvgpr_write_b32 a63, v59
    v_exp_f32 v52, v72
    v_exp_f32 v53, v73
    v_exp_f32 v54, v74
    v_exp_f32 v55, v75
    v_exp_f32 v56, v76
    v_exp_f32 v57, v77
    v_exp_f32 v58, v78
    v_exp_f32 v59, v79
    s_nop 0
    v_cvt_pk_bf16_f32 v132, v52, v53
    v_cvt_pk_bf16_f32 v133, v54, v55
    v_cvt_pk_bf16_f32 v134, v56, v57
    v_cvt_pk_bf16_f32 v135, v58, v59
    s_nop 1
    v_mfma_f32_16x16x32_bf16 v[32:35], v[44:47], v[132:135], 0
    s_nop 7
    s_setpc_b64 s[74:75]
m_rs0465:
    s_nop 15
    v_max3_f32 v48, v64, v65, v66
    v_max3_f32 v48, v48, v67, v68
    v_max3_f32 v48, v48, v69, v70
    v_max3_f32 v48, v48, v71, 0
    v_mov_b32 v49, v48
    s_nop 1
    v_permlane32_swap_b32 v48, v49
    s_nop 1
    v_max_f32 v48, v48, v49
    v_mov_b32 v49, v48
    s_nop 1
    v_permlane16_swap_b32 v48, v49
    s_nop 1
    v_max_f32 v48, v48, v49
    v_exp_f32 v49, -v48
    v_sub_f32 v64, v64, v48
    v_sub_f32 v65, v65, v48
    v_sub_f32 v66, v66, v48
    v_sub_f32 v67, v67, v48
    v_sub_f32 v68, v68, v48
    v_sub_f32 v69, v69, v48
    v_sub_f32 v70, v70, v48
    v_sub_f32 v71, v71, v48
    v_sub_f32 v96, v96, v48
    v_sub_f32 v97, v97, v48
    v_sub_f32 v98, v98, v48
    v_sub_f32 v99, v99, v48
    v_sub_f32 v100, v100, v48
    v_sub_f32 v101, v101, v48
    v_sub_f32 v102, v102, v48
    v_sub_f32 v103, v103, v48
    v_sub_f32 v160, v160, v48
    v_sub_f32 v161, v161, v48
    v_sub_f32 v162, v162, v48
    v_sub_f32 v163, v163, v48
    v_sub_f32 v164, v164, v48
    v_sub_f32 v165, v165, v48
    v_sub_f32 v166, v166, v48
    v_sub_f32 v167, v167, v48
    v_mul_f32 v12, v12, v49
    v_accvgpr_read_b32 v52, a0
    v_accvgpr_read_b32 v53, a1
    v_accvgpr_read_b32 v54, a2
    v_accvgpr_read_b32 v55, a3
    v_accvgpr_read_b32 v56, a4
    v_accvgpr_read_b32 v57, a5
    v_accvgpr_read_b32 v58, a6
    v_accvgpr_read_b32 v59, a7
    v_mul_f32 v52, v52, v49
    v_mul_f32 v53, v53, v49
    v_mul_f32 v54, v54, v49
    v_mul_f32 v55, v55, v49
    v_mul_f32 v56, v56, v49
    v_mul_f32 v57, v57, v49
    v_mul_f32 v58, v58, v49
    v_mul_f32 v59, v59, v49
    v_accvgpr_write_b32 a0, v52
    v_accvgpr_write_b32 a1, v53
    v_accvgpr_write_b32 a2, v54
    v_accvgpr_write_b32 a3, v55
    v_accvgpr_write_b32 a4, v56
    v_accvgpr_write_b32 a5, v57
    v_accvgpr_write_b32 a6, v58
    v_accvgpr_write_b32 a7, v59
    v_accvgpr_read_b32 v52, a8
    v_accvgpr_read_b32 v53, a9
    v_accvgpr_read_b32 v54, a10
    v_accvgpr_read_b32 v55, a11
    v_accvgpr_read_b32 v56, a12
    v_accvgpr_read_b32 v57, a13
    v_accvgpr_read_b32 v58, a14
    v_accvgpr_read_b32 v59, a15
    v_mul_f32 v52, v52, v49
    v_mul_f32 v53, v53, v49
    v_mul_f32 v54, v54, v49
    v_mul_f32 v55, v55, v49
    v_mul_f32 v56, v56, v49
    v_mul_f32 v57, v57, v49
    v_mul_f32 v58, v58, v49
    v_mul_f32 v59, v59, v49
    v_accvgpr_write_b32 a8, v52
    v_accvgpr_write_b32 a9, v53
    v_accvgpr_write_b32 a10, v54
    v_accvgpr_write_b32 a11, v55
    v_accvgpr_write_b32 a12, v56
    v_accvgpr_write_b32 a13, v57
    v_accvgpr_write_b32 a14, v58
    v_accvgpr_write_b32 a15, v59
    v_accvgpr_read_b32 v52, a16
    v_accvgpr_read_b32 v53, a17
    v_accvgpr_read_b32 v54, a18
    v_accvgpr_read_b32 v55, a19
    v_accvgpr_read_b32 v56, a20
    v_accvgpr_read_b32 v57, a21
    v_accvgpr_read_b32 v58, a22
    v_accvgpr_read_b32 v59, a23
    v_mul_f32 v52, v52, v49
    v_mul_f32 v53, v53, v49
    v_mul_f32 v54, v54, v49
    v_mul_f32 v55, v55, v49
    v_mul_f32 v56, v56, v49
    v_mul_f32 v57, v57, v49
    v_mul_f32 v58, v58, v49
    v_mul_f32 v59, v59, v49
    v_accvgpr_write_b32 a16, v52
    v_accvgpr_write_b32 a17, v53
    v_accvgpr_write_b32 a18, v54
    v_accvgpr_write_b32 a19, v55
    v_accvgpr_write_b32 a20, v56
    v_accvgpr_write_b32 a21, v57
    v_accvgpr_write_b32 a22, v58
    v_accvgpr_write_b32 a23, v59
    v_accvgpr_read_b32 v52, a24
    v_accvgpr_read_b32 v53, a25
    v_accvgpr_read_b32 v54, a26
    v_accvgpr_read_b32 v55, a27
    v_accvgpr_read_b32 v56, a28
    v_accvgpr_read_b32 v57, a29
    v_accvgpr_read_b32 v58, a30
    v_accvgpr_read_b32 v59, a31
    v_mul_f32 v52, v52, v49
    v_mul_f32 v53, v53, v49
    v_mul_f32 v54, v54, v49
    v_mul_f32 v55, v55, v49
    v_mul_f32 v56, v56, v49
    v_mul_f32 v57, v57, v49
    v_mul_f32 v58, v58, v49
    v_mul_f32 v59, v59, v49
    v_accvgpr_write_b32 a24, v52
    v_accvgpr_write_b32 a25, v53
    v_accvgpr_write_b32 a26, v54
    v_accvgpr_write_b32 a27, v55
    v_accvgpr_write_b32 a28, v56
    v_accvgpr_write_b32 a29, v57
    v_accvgpr_write_b32 a30, v58
    v_accvgpr_write_b32 a31, v59
    v_exp_f32 v52, v64
    v_exp_f32 v53, v65
    v_exp_f32 v54, v66
    v_exp_f32 v55, v67
    v_exp_f32 v56, v68
    v_exp_f32 v57, v69
    v_exp_f32 v58, v70
    v_exp_f32 v59, v71
    s_nop 0
    v_cvt_pk_bf16_f32 v128, v52, v53
    v_cvt_pk_bf16_f32 v129, v54, v55
    v_cvt_pk_bf16_f32 v130, v56, v57
    v_cvt_pk_bf16_f32 v131, v58, v59
    s_nop 1
    v_mfma_f32_16x16x32_bf16 v[28:31], v[44:47], v[128:131], 0
    v_max3_f32 v48, v72, v73, v74
    v_max3_f32 v48, v48, v75, v76
    v_max3_f32 v48, v48, v77, v78
    v_max3_f32 v48, v48, v79, 0
    v_mov_b32 v49, v48
    s_nop 1
    v_permlane32_swap_b32 v48, v49
    s_nop 1
    v_max_f32 v48, v48, v49
    v_mov_b32 v49, v48
    s_nop 1
    v_permlane16_swap_b32 v48, v49
    s_nop 1
    v_max_f32 v48, v48, v49
    v_exp_f32 v49, -v48
    v_sub_f32 v72, v72, v48
    v_sub_f32 v73, v73, v48
    v_sub_f32 v74, v74, v48
    v_sub_f32 v75, v75, v48
    v_sub_f32 v76, v76, v48
    v_sub_f32 v77, v77, v48
    v_sub_f32 v78, v78, v48
    v_sub_f32 v79, v79, v48
    v_sub_f32 v104, v104, v48
    v_sub_f32 v105, v105, v48
    v_sub_f32 v106, v106, v48
    v_sub_f32 v107, v107, v48
    v_sub_f32 v108, v108, v48
    v_sub_f32 v109, v109, v48
    v_sub_f32 v110, v110, v48
    v_sub_f32 v111, v111, v48
    v_sub_f32 v168, v168, v48
    v_sub_f32 v169, v169, v48
    v_sub_f32 v170, v170, v48
    v_sub_f32 v171, v171, v48
    v_sub_f32 v172, v172, v48
    v_sub_f32 v173, v173, v48
    v_sub_f32 v174, v174, v48
    v_sub_f32 v175, v175, v48
    v_mul_f32 v13, v13, v49
    v_accvgpr_read_b32 v52, a32
    v_accvgpr_read_b32 v53, a33
    v_accvgpr_read_b32 v54, a34
    v_accvgpr_read_b32 v55, a35
    v_accvgpr_read_b32 v56, a36
    v_accvgpr_read_b32 v57, a37
    v_accvgpr_read_b32 v58, a38
    v_accvgpr_read_b32 v59, a39
    v_mul_f32 v52, v52, v49
    v_mul_f32 v53, v53, v49
    v_mul_f32 v54, v54, v49
    v_mul_f32 v55, v55, v49
    v_mul_f32 v56, v56, v49
    v_mul_f32 v57, v57, v49
    v_mul_f32 v58, v58, v49
    v_mul_f32 v59, v59, v49
    v_accvgpr_write_b32 a32, v52
    v_accvgpr_write_b32 a33, v53
    v_accvgpr_write_b32 a34, v54
    v_accvgpr_write_b32 a35, v55
    v_accvgpr_write_b32 a36, v56
    v_accvgpr_write_b32 a37, v57
    v_accvgpr_write_b32 a38, v58
    v_accvgpr_write_b32 a39, v59
    v_accvgpr_read_b32 v52, a40
    v_accvgpr_read_b32 v53, a41
    v_accvgpr_read_b32 v54, a42
    v_accvgpr_read_b32 v55, a43
    v_accvgpr_read_b32 v56, a44
    v_accvgpr_read_b32 v57, a45
    v_accvgpr_read_b32 v58, a46
    v_accvgpr_read_b32 v59, a47
    v_mul_f32 v52, v52, v49
    v_mul_f32 v53, v53, v49
    v_mul_f32 v54, v54, v49
    v_mul_f32 v55, v55, v49
    v_mul_f32 v56, v56, v49
    v_mul_f32 v57, v57, v49
    v_mul_f32 v58, v58, v49
    v_mul_f32 v59, v59, v49
    v_accvgpr_write_b32 a40, v52
    v_accvgpr_write_b32 a41, v53
    v_accvgpr_write_b32 a42, v54
    v_accvgpr_write_b32 a43, v55
    v_accvgpr_write_b32 a44, v56
    v_accvgpr_write_b32 a45, v57
    v_accvgpr_write_b32 a46, v58
    v_accvgpr_write_b32 a47, v59
    v_accvgpr_read_b32 v52, a48
    v_accvgpr_read_b32 v53, a49
    v_accvgpr_read_b32 v54, a50
    v_accvgpr_read_b32 v55, a51
    v_accvgpr_read_b32 v56, a52
    v_accvgpr_read_b32 v57, a53
    v_accvgpr_read_b32 v58, a54
    v_accvgpr_read_b32 v59, a55
    v_mul_f32 v52, v52, v49
    v_mul_f32 v53, v53, v49
    v_mul_f32 v54, v54, v49
    v_mul_f32 v55, v55, v49
    v_mul_f32 v56, v56, v49
    v_mul_f32 v57, v57, v49
    v_mul_f32 v58, v58, v49
    v_mul_f32 v59, v59, v49
    v_accvgpr_write_b32 a48, v52
    v_accvgpr_write_b32 a49, v53
    v_accvgpr_write_b32 a50, v54
    v_accvgpr_write_b32 a51, v55
    v_accvgpr_write_b32 a52, v56
    v_accvgpr_write_b32 a53, v57
    v_accvgpr_write_b32 a54, v58
    v_accvgpr_write_b32 a55, v59
    v_accvgpr_read_b32 v52, a56
    v_accvgpr_read_b32 v53, a57
    v_accvgpr_read_b32 v54, a58
    v_accvgpr_read_b32 v55, a59
    v_accvgpr_read_b32 v56, a60
    v_accvgpr_read_b32 v57, a61
    v_accvgpr_read_b32 v58, a62
    v_accvgpr_read_b32 v59, a63
    v_mul_f32 v52, v52, v49
    v_mul_f32 v53, v53, v49
    v_mul_f32 v54, v54, v49
    v_mul_f32 v55, v55, v49
    v_mul_f32 v56, v56, v49
    v_mul_f32 v57, v57, v49
    v_mul_f32 v58, v58, v49
    v_mul_f32 v59, v59, v49
    v_accvgpr_write_b32 a56, v52
    v_accvgpr_write_b32 a57, v53
    v_accvgpr_write_b32 a58, v54
    v_accvgpr_write_b32 a59, v55
    v_accvgpr_write_b32 a60, v56
    v_accvgpr_write_b32 a61, v57
    v_accvgpr_write_b32 a62, v58
    v_accvgpr_write_b32 a63, v59
    v_exp_f32 v52, v72
    v_exp_f32 v53, v73
    v_exp_f32 v54, v74
    v_exp_f32 v55, v75
    v_exp_f32 v56, v76
    v_exp_f32 v57, v77
    v_exp_f32 v58, v78
    v_exp_f32 v59, v79
    s_nop 0
    v_cvt_pk_bf16_f32 v132, v52, v53
    v_cvt_pk_bf16_f32 v133, v54, v55
    v_cvt_pk_bf16_f32 v134, v56, v57
    v_cvt_pk_bf16_f32 v135, v58, v59
    s_nop 1
    v_mfma_f32_16x16x32_bf16 v[32:35], v[44:47], v[132:135], 0
    v_max3_f32 v48, v80, v81, v82
    v_max3_f32 v48, v48, v83, v84
    v_max3_f32 v48, v48, v85, v86
    v_max3_f32 v48, v48, v87, 0
    v_mov_b32 v49, v48
    s_nop 1
    v_permlane32_swap_b32 v48, v49
    s_nop 1
    v_max_f32 v48, v48, v49
    v_mov_b32 v49, v48
    s_nop 1
    v_permlane16_swap_b32 v48, v49
    s_nop 1
    v_max_f32 v48, v48, v49
    v_exp_f32 v49, -v48
    v_sub_f32 v80, v80, v48
    v_sub_f32 v81, v81, v48
    v_sub_f32 v82, v82, v48
    v_sub_f32 v83, v83, v48
    v_sub_f32 v84, v84, v48
    v_sub_f32 v85, v85, v48
    v_sub_f32 v86, v86, v48
    v_sub_f32 v87, v87, v48
    v_sub_f32 v112, v112, v48
    v_sub_f32 v113, v113, v48
    v_sub_f32 v114, v114, v48
    v_sub_f32 v115, v115, v48
    v_sub_f32 v116, v116, v48
    v_sub_f32 v117, v117, v48
    v_sub_f32 v118, v118, v48
    v_sub_f32 v119, v119, v48
    v_sub_f32 v176, v176, v48
    v_sub_f32 v177, v177, v48
    v_sub_f32 v178, v178, v48
    v_sub_f32 v179, v179, v48
    v_sub_f32 v180, v180, v48
    v_sub_f32 v181, v181, v48
    v_sub_f32 v182, v182, v48
    v_sub_f32 v183, v183, v48
    v_mul_f32 v14, v14, v49
    v_accvgpr_read_b32 v52, a64
    v_accvgpr_read_b32 v53, a65
    v_accvgpr_read_b32 v54, a66
    v_accvgpr_read_b32 v55, a67
    v_accvgpr_read_b32 v56, a68
    v_accvgpr_read_b32 v57, a69
    v_accvgpr_read_b32 v58, a70
    v_accvgpr_read_b32 v59, a71
    v_mul_f32 v52, v52, v49
    v_mul_f32 v53, v53, v49
    v_mul_f32 v54, v54, v49
    v_mul_f32 v55, v55, v49
    v_mul_f32 v56, v56, v49
    v_mul_f32 v57, v57, v49
    v_mul_f32 v58, v58, v49
    v_mul_f32 v59, v59, v49
    v_accvgpr_write_b32 a64, v52
    v_accvgpr_write_b32 a65, v53
    v_accvgpr_write_b32 a66, v54
    v_accvgpr_write_b32 a67, v55
    v_accvgpr_write_b32 a68, v56
    v_accvgpr_write_b32 a69, v57
    v_accvgpr_write_b32 a70, v58
    v_accvgpr_write_b32 a71, v59
    v_accvgpr_read_b32 v52, a72
    v_accvgpr_read_b32 v53, a73
    v_accvgpr_read_b32 v54, a74
    v_accvgpr_read_b32 v55, a75
    v_accvgpr_read_b32 v56, a76
    v_accvgpr_read_b32 v57, a77
    v_accvgpr_read_b32 v58, a78
    v_accvgpr_read_b32 v59, a79
    v_mul_f32 v52, v52, v49
    v_mul_f32 v53, v53, v49
    v_mul_f32 v54, v54, v49
    v_mul_f32 v55, v55, v49
    v_mul_f32 v56, v56, v49
    v_mul_f32 v57, v57, v49
    v_mul_f32 v58, v58, v49
    v_mul_f32 v59, v59, v49
    v_accvgpr_write_b32 a72, v52
    v_accvgpr_write_b32 a73, v53
    v_accvgpr_write_b32 a74, v54
    v_accvgpr_write_b32 a75, v55
    v_accvgpr_write_b32 a76, v56
    v_accvgpr_write_b32 a77, v57
    v_accvgpr_write_b32 a78, v58
    v_accvgpr_write_b32 a79, v59
    v_accvgpr_read_b32 v52, a80
    v_accvgpr_read_b32 v53, a81
    v_accvgpr_read_b32 v54, a82
    v_accvgpr_read_b32 v55, a83
    v_accvgpr_read_b32 v56, a84
    v_accvgpr_read_b32 v57, a85
    v_accvgpr_read_b32 v58, a86
    v_accvgpr_read_b32 v59, a87
    v_mul_f32 v52, v52, v49
    v_mul_f32 v53, v53, v49
    v_mul_f32 v54, v54, v49
    v_mul_f32 v55, v55, v49
    v_mul_f32 v56, v56, v49
    v_mul_f32 v57, v57, v49
    v_mul_f32 v58, v58, v49
    v_mul_f32 v59, v59, v49
    v_accvgpr_write_b32 a80, v52
    v_accvgpr_write_b32 a81, v53
    v_accvgpr_write_b32 a82, v54
    v_accvgpr_write_b32 a83, v55
    v_accvgpr_write_b32 a84, v56
    v_accvgpr_write_b32 a85, v57
    v_accvgpr_write_b32 a86, v58
    v_accvgpr_write_b32 a87, v59
    v_accvgpr_read_b32 v52, a88
    v_accvgpr_read_b32 v53, a89
    v_accvgpr_read_b32 v54, a90
    v_accvgpr_read_b32 v55, a91
    v_accvgpr_read_b32 v56, a92
    v_accvgpr_read_b32 v57, a93
    v_accvgpr_read_b32 v58, a94
    v_accvgpr_read_b32 v59, a95
    v_mul_f32 v52, v52, v49
    v_mul_f32 v53, v53, v49
    v_mul_f32 v54, v54, v49
    v_mul_f32 v55, v55, v49
    v_mul_f32 v56, v56, v49
    v_mul_f32 v57, v57, v49
    v_mul_f32 v58, v58, v49
    v_mul_f32 v59, v59, v49
    v_accvgpr_write_b32 a88, v52
    v_accvgpr_write_b32 a89, v53
    v_accvgpr_write_b32 a90, v54
    v_accvgpr_write_b32 a91, v55
    v_accvgpr_write_b32 a92, v56
    v_accvgpr_write_b32 a93, v57
    v_accvgpr_write_b32 a94, v58
    v_accvgpr_write_b32 a95, v59
    v_exp_f32 v52, v80
    v_exp_f32 v53, v81
    v_exp_f32 v54, v82
    v_exp_f32 v55, v83
    v_exp_f32 v56, v84
    v_exp_f32 v57, v85
    v_exp_f32 v58, v86
    v_exp_f32 v59, v87
    s_nop 0
    v_cvt_pk_bf16_f32 v136, v52, v53
    v_cvt_pk_bf16_f32 v137, v54, v55
    v_cvt_pk_bf16_f32 v138, v56, v57
    v_cvt_pk_bf16_f32 v139, v58, v59
    s_nop 1
    v_mfma_f32_16x16x32_bf16 v[36:39], v[44:47], v[136:139], 0
    v_max3_f32 v48, v88, v89, v90
    v_max3_f32 v48, v48, v91, v92
    v_max3_f32 v48, v48, v93, v94
    v_max3_f32 v48, v48, v95, 0
    v_mov_b32 v49, v48
    s_nop 1
    v_permlane32_swap_b32 v48, v49
    s_nop 1
    v_max_f32 v48, v48, v49
    v_mov_b32 v49, v48
    s_nop 1
    v_permlane16_swap_b32 v48, v49
    s_nop 1
    v_max_f32 v48, v48, v49
    v_exp_f32 v49, -v48
    v_sub_f32 v88, v88, v48
    v_sub_f32 v89, v89, v48
    v_sub_f32 v90, v90, v48
    v_sub_f32 v91, v91, v48
    v_sub_f32 v92, v92, v48
    v_sub_f32 v93, v93, v48
    v_sub_f32 v94, v94, v48
    v_sub_f32 v95, v95, v48
    v_sub_f32 v120, v120, v48
    v_sub_f32 v121, v121, v48
    v_sub_f32 v122, v122, v48
    v_sub_f32 v123, v123, v48
    v_sub_f32 v124, v124, v48
    v_sub_f32 v125, v125, v48
    v_sub_f32 v126, v126, v48
    v_sub_f32 v127, v127, v48
    v_sub_f32 v184, v184, v48
    v_sub_f32 v185, v185, v48
    v_sub_f32 v186, v186, v48
    v_sub_f32 v187, v187, v48
    v_sub_f32 v188, v188, v48
    v_sub_f32 v189, v189, v48
    v_sub_f32 v190, v190, v48
    v_sub_f32 v191, v191, v48
    v_mul_f32 v15, v15, v49
    v_accvgpr_read_b32 v52, a96
    v_accvgpr_read_b32 v53, a97
    v_accvgpr_read_b32 v54, a98
    v_accvgpr_read_b32 v55, a99
    v_accvgpr_read_b32 v56, a100
    v_accvgpr_read_b32 v57, a101
    v_accvgpr_read_b32 v58, a102
    v_accvgpr_read_b32 v59, a103
    v_mul_f32 v52, v52, v49
    v_mul_f32 v53, v53, v49
    v_mul_f32 v54, v54, v49
    v_mul_f32 v55, v55, v49
    v_mul_f32 v56, v56, v49
    v_mul_f32 v57, v57, v49
    v_mul_f32 v58, v58, v49
    v_mul_f32 v59, v59, v49
    v_accvgpr_write_b32 a96, v52
    v_accvgpr_write_b32 a97, v53
    v_accvgpr_write_b32 a98, v54
    v_accvgpr_write_b32 a99, v55
    v_accvgpr_write_b32 a100, v56
    v_accvgpr_write_b32 a101, v57
    v_accvgpr_write_b32 a102, v58
    v_accvgpr_write_b32 a103, v59
    v_accvgpr_read_b32 v52, a104
    v_accvgpr_read_b32 v53, a105
    v_accvgpr_read_b32 v54, a106
    v_accvgpr_read_b32 v55, a107
    v_accvgpr_read_b32 v56, a108
    v_accvgpr_read_b32 v57, a109
    v_accvgpr_read_b32 v58, a110
    v_accvgpr_read_b32 v59, a111
    v_mul_f32 v52, v52, v49
    v_mul_f32 v53, v53, v49
    v_mul_f32 v54, v54, v49
    v_mul_f32 v55, v55, v49
    v_mul_f32 v56, v56, v49
    v_mul_f32 v57, v57, v49
    v_mul_f32 v58, v58, v49
    v_mul_f32 v59, v59, v49
    v_accvgpr_write_b32 a104, v52
    v_accvgpr_write_b32 a105, v53
    v_accvgpr_write_b32 a106, v54
    v_accvgpr_write_b32 a107, v55
    v_accvgpr_write_b32 a108, v56
    v_accvgpr_write_b32 a109, v57
    v_accvgpr_write_b32 a110, v58
    v_accvgpr_write_b32 a111, v59
    v_accvgpr_read_b32 v52, a112
    v_accvgpr_read_b32 v53, a113
    v_accvgpr_read_b32 v54, a114
    v_accvgpr_read_b32 v55, a115
    v_accvgpr_read_b32 v56, a116
    v_accvgpr_read_b32 v57, a117
    v_accvgpr_read_b32 v58, a118
    v_accvgpr_read_b32 v59, a119
    v_mul_f32 v52, v52, v49
    v_mul_f32 v53, v53, v49
    v_mul_f32 v54, v54, v49
    v_mul_f32 v55, v55, v49
    v_mul_f32 v56, v56, v49
    v_mul_f32 v57, v57, v49
    v_mul_f32 v58, v58, v49
    v_mul_f32 v59, v59, v49
    v_accvgpr_write_b32 a112, v52
    v_accvgpr_write_b32 a113, v53
    v_accvgpr_write_b32 a114, v54
    v_accvgpr_write_b32 a115, v55
    v_accvgpr_write_b32 a116, v56
    v_accvgpr_write_b32 a117, v57
    v_accvgpr_write_b32 a118, v58
    v_accvgpr_write_b32 a119, v59
    v_accvgpr_read_b32 v52, a120
    v_accvgpr_read_b32 v53, a121
    v_accvgpr_read_b32 v54, a122
    v_accvgpr_read_b32 v55, a123
    v_accvgpr_read_b32 v56, a124
    v_accvgpr_read_b32 v57, a125
    v_accvgpr_read_b32 v58, a126
    v_accvgpr_read_b32 v59, a127
    v_mul_f32 v52, v52, v49
    v_mul_f32 v53, v53, v49
    v_mul_f32 v54, v54, v49
    v_mul_f32 v55, v55, v49
    v_mul_f32 v56, v56, v49
    v_mul_f32 v57, v57, v49
    v_mul_f32 v58, v58, v49
    v_mul_f32 v59, v59, v49
    v_accvgpr_write_b32 a120, v52
    v_accvgpr_write_b32 a121, v53
    v_accvgpr_write_b32 a122, v54
    v_accvgpr_write_b32 a123, v55
    v_accvgpr_write_b32 a124, v56
    v_accvgpr_write_b32 a125, v57
    v_accvgpr_write_b32 a126, v58
    v_accvgpr_write_b32 a127, v59
    v_exp_f32 v52, v88
    v_exp_f32 v53, v89
    v_exp_f32 v54, v90
    v_exp_f32 v55, v91
    v_exp_f32 v56, v92
    v_exp_f32 v57, v93
    v_exp_f32 v58, v94
    v_exp_f32 v59, v95
    s_nop 0
    v_cvt_pk_bf16_f32 v140, v52, v53
    v_cvt_pk_bf16_f32 v141, v54, v55
    v_cvt_pk_bf16_f32 v142, v56, v57
    v_cvt_pk_bf16_f32 v143, v58, v59
    s_nop 1
    v_mfma_f32_16x16x32_bf16 v[40:43], v[44:47], v[140:143], 0
    s_nop 7
    s_setpc_b64 s[74:75]
m_rs1266:
    s_nop 15
    v_max3_f32 v48, v96, v97, v98
    v_max3_f32 v48, v48, v99, v100
    v_max3_f32 v48, v48, v101, v102
    v_max3_f32 v48, v48, v103, 0
    v_mov_b32 v49, v48
    s_nop 1
    v_permlane32_swap_b32 v48, v49
    s_nop 1
    v_max_f32 v48, v48, v49
    v_mov_b32 v49, v48
    s_nop 1
    v_permlane16_swap_b32 v48, v49
    s_nop 1
    v_max_f32 v48, v48, v49
    v_exp_f32 v49, -v48
    v_sub_f32 v96, v96, v48
    v_sub_f32 v97, v97, v48
    v_sub_f32 v98, v98, v48
    v_sub_f32 v99, v99, v48
    v_sub_f32 v100, v100, v48
    v_sub_f32 v101, v101, v48
    v_sub_f32 v102, v102, v48
    v_sub_f32 v103, v103, v48
    v_sub_f32 v64, v64, v48
    v_sub_f32 v65, v65, v48
    v_sub_f32 v66, v66, v48
    v_sub_f32 v67, v67, v48
    v_sub_f32 v68, v68, v48
    v_sub_f32 v69, v69, v48
    v_sub_f32 v70, v70, v48
    v_sub_f32 v71, v71, v48
    v_sub_f32 v160, v160, v48
    v_sub_f32 v161, v161, v48
    v_sub_f32 v162, v162, v48
    v_sub_f32 v163, v163, v48
    v_sub_f32 v164, v164, v48
    v_sub_f32 v165, v165, v48
    v_sub_f32 v166, v166, v48
    v_sub_f32 v167, v167, v48
    v_mul_f32 v12, v12, v49
    v_accvgpr_read_b32 v52, a0
    v_accvgpr_read_b32 v53, a1
    v_accvgpr_read_b32 v54, a2
    v_accvgpr_read_b32 v55, a3
    v_accvgpr_read_b32 v56, a4
    v_accvgpr_read_b32 v57, a5
    v_accvgpr_read_b32 v58, a6
    v_accvgpr_read_b32 v59, a7
    v_mul_f32 v52, v52, v49
    v_mul_f32 v53, v53, v49
    v_mul_f32 v54, v54, v49
    v_mul_f32 v55, v55, v49
    v_mul_f32 v56, v56, v49
    v_mul_f32 v57, v57, v49
    v_mul_f32 v58, v58, v49
    v_mul_f32 v59, v59, v49
    v_accvgpr_write_b32 a0, v52
    v_accvgpr_write_b32 a1, v53
    v_accvgpr_write_b32 a2, v54
    v_accvgpr_write_b32 a3, v55
    v_accvgpr_write_b32 a4, v56
    v_accvgpr_write_b32 a5, v57
    v_accvgpr_write_b32 a6, v58
    v_accvgpr_write_b32 a7, v59
    v_accvgpr_read_b32 v52, a8
    v_accvgpr_read_b32 v53, a9
    v_accvgpr_read_b32 v54, a10
    v_accvgpr_read_b32 v55, a11
    v_accvgpr_read_b32 v56, a12
    v_accvgpr_read_b32 v57, a13
    v_accvgpr_read_b32 v58, a14
    v_accvgpr_read_b32 v59, a15
    v_mul_f32 v52, v52, v49
    v_mul_f32 v53, v53, v49
    v_mul_f32 v54, v54, v49
    v_mul_f32 v55, v55, v49
    v_mul_f32 v56, v56, v49
    v_mul_f32 v57, v57, v49
    v_mul_f32 v58, v58, v49
    v_mul_f32 v59, v59, v49
    v_accvgpr_write_b32 a8, v52
    v_accvgpr_write_b32 a9, v53
    v_accvgpr_write_b32 a10, v54
    v_accvgpr_write_b32 a11, v55
    v_accvgpr_write_b32 a12, v56
    v_accvgpr_write_b32 a13, v57
    v_accvgpr_write_b32 a14, v58
    v_accvgpr_write_b32 a15, v59
    v_accvgpr_read_b32 v52, a16
    v_accvgpr_read_b32 v53, a17
    v_accvgpr_read_b32 v54, a18
    v_accvgpr_read_b32 v55, a19
    v_accvgpr_read_b32 v56, a20
    v_accvgpr_read_b32 v57, a21
    v_accvgpr_read_b32 v58, a22
    v_accvgpr_read_b32 v59, a23
    v_mul_f32 v52, v52, v49
    v_mul_f32 v53, v53, v49
    v_mul_f32 v54, v54, v49
    v_mul_f32 v55, v55, v49
    v_mul_f32 v56, v56, v49
    v_mul_f32 v57, v57, v49
    v_mul_f32 v58, v58, v49
    v_mul_f32 v59, v59, v49
    v_accvgpr_write_b32 a16, v52
    v_accvgpr_write_b32 a17, v53
    v_accvgpr_write_b32 a18, v54
    v_accvgpr_write_b32 a19, v55
    v_accvgpr_write_b32 a20, v56
    v_accvgpr_write_b32 a21, v57
    v_accvgpr_write_b32 a22, v58
    v_accvgpr_write_b32 a23, v59
    v_accvgpr_read_b32 v52, a24
    v_accvgpr_read_b32 v53, a25
    v_accvgpr_read_b32 v54, a26
    v_accvgpr_read_b32 v55, a27
    v_accvgpr_read_b32 v56, a28
    v_accvgpr_read_b32 v57, a29
    v_accvgpr_read_b32 v58, a30
    v_accvgpr_read_b32 v59, a31
    v_mul_f32 v52, v52, v49
    v_mul_f32 v53, v53, v49
    v_mul_f32 v54, v54, v49
    v_mul_f32 v55, v55, v49
    v_mul_f32 v56, v56, v49
    v_mul_f32 v57, v57, v49
    v_mul_f32 v58, v58, v49
    v_mul_f32 v59, v59, v49
    v_accvgpr_write_b32 a24, v52
    v_accvgpr_write_b32 a25, v53
    v_accvgpr_write_b32 a26, v54
    v_accvgpr_write_b32 a27, v55
    v_accvgpr_write_b32 a28, v56
    v_accvgpr_write_b32 a29, v57
    v_accvgpr_write_b32 a30, v58
    v_accvgpr_write_b32 a31, v59
    v_exp_f32 v52, v96
    v_exp_f32 v53, v97
    v_exp_f32 v54, v98
    v_exp_f32 v55, v99
    v_exp_f32 v56, v100
    v_exp_f32 v57, v101
    v_exp_f32 v58, v102
    v_exp_f32 v59, v103
    s_nop 0
    v_cvt_pk_bf16_f32 v144, v52, v53
    v_cvt_pk_bf16_f32 v145, v54, v55
    v_cvt_pk_bf16_f32 v146, v56, v57
    v_cvt_pk_bf16_f32 v147, v58, v59
    s_nop 1
    v_mfma_f32_16x16x32_bf16 v[28:31], v[44:47], v[144:147], 0
    v_max3_f32 v48, v104, v105, v106
    v_max3_f32 v48, v48, v107, v108
    v_max3_f32 v48, v48, v109, v110
    v_max3_f32 v48, v48, v111, 0
    v_mov_b32 v49, v48
    s_nop 1
    v_permlane32_swap_b32 v48, v49
    s_nop 1
    v_max_f32 v48, v48, v49
    v_mov_b32 v49, v48
    s_nop 1
    v_permlane16_swap_b32 v48, v49
    s_nop 1
    v_max_f32 v48, v48, v49
    v_exp_f32 v49, -v48
    v_sub_f32 v104, v104, v48
    v_sub_f32 v105, v105, v48
    v_sub_f32 v106, v106, v48
    v_sub_f32 v107, v107, v48
    v_sub_f32 v108, v108, v48
    v_sub_f32 v109, v109, v48
    v_sub_f32 v110, v110, v48
    v_sub_f32 v111, v111, v48
    v_sub_f32 v72, v72, v48
    v_sub_f32 v73, v73, v48
    v_sub_f32 v74, v74, v48
    v_sub_f32 v75, v75, v48
    v_sub_f32 v76, v76, v48
    v_sub_f32 v77, v77, v48
    v_sub_f32 v78, v78, v48
    v_sub_f32 v79, v79, v48
    v_sub_f32 v168, v168, v48
    v_sub_f32 v169, v169, v48
    v_sub_f32 v170, v170, v48
    v_sub_f32 v171, v171, v48
    v_sub_f32 v172, v172, v48
    v_sub_f32 v173, v173, v48
    v_sub_f32 v174, v174, v48
    v_sub_f32 v175, v175, v48
    v_mul_f32 v13, v13, v49
    v_accvgpr_read_b32 v52, a32
    v_accvgpr_read_b32 v53, a33
    v_accvgpr_read_b32 v54, a34
    v_accvgpr_read_b32 v55, a35
    v_accvgpr_read_b32 v56, a36
    v_accvgpr_read_b32 v57, a37
    v_accvgpr_read_b32 v58, a38
    v_accvgpr_read_b32 v59, a39
    v_mul_f32 v52, v52, v49
    v_mul_f32 v53, v53, v49
    v_mul_f32 v54, v54, v49
    v_mul_f32 v55, v55, v49
    v_mul_f32 v56, v56, v49
    v_mul_f32 v57, v57, v49
    v_mul_f32 v58, v58, v49
    v_mul_f32 v59, v59, v49
    v_accvgpr_write_b32 a32, v52
    v_accvgpr_write_b32 a33, v53
    v_accvgpr_write_b32 a34, v54
    v_accvgpr_write_b32 a35, v55
    v_accvgpr_write_b32 a36, v56
    v_accvgpr_write_b32 a37, v57
    v_accvgpr_write_b32 a38, v58
    v_accvgpr_write_b32 a39, v59
    v_accvgpr_read_b32 v52, a40
    v_accvgpr_read_b32 v53, a41
    v_accvgpr_read_b32 v54, a42
    v_accvgpr_read_b32 v55, a43
    v_accvgpr_read_b32 v56, a44
    v_accvgpr_read_b32 v57, a45
    v_accvgpr_read_b32 v58, a46
    v_accvgpr_read_b32 v59, a47
    v_mul_f32 v52, v52, v49
    v_mul_f32 v53, v53, v49
    v_mul_f32 v54, v54, v49
    v_mul_f32 v55, v55, v49
    v_mul_f32 v56, v56, v49
    v_mul_f32 v57, v57, v49
    v_mul_f32 v58, v58, v49
    v_mul_f32 v59, v59, v49
    v_accvgpr_write_b32 a40, v52
    v_accvgpr_write_b32 a41, v53
    v_accvgpr_write_b32 a42, v54
    v_accvgpr_write_b32 a43, v55
    v_accvgpr_write_b32 a44, v56
    v_accvgpr_write_b32 a45, v57
    v_accvgpr_write_b32 a46, v58
    v_accvgpr_write_b32 a47, v59
    v_accvgpr_read_b32 v52, a48
    v_accvgpr_read_b32 v53, a49
    v_accvgpr_read_b32 v54, a50
    v_accvgpr_read_b32 v55, a51
    v_accvgpr_read_b32 v56, a52
    v_accvgpr_read_b32 v57, a53
    v_accvgpr_read_b32 v58, a54
    v_accvgpr_read_b32 v59, a55
    v_mul_f32 v52, v52, v49
    v_mul_f32 v53, v53, v49
    v_mul_f32 v54, v54, v49
    v_mul_f32 v55, v55, v49
    v_mul_f32 v56, v56, v49
    v_mul_f32 v57, v57, v49
    v_mul_f32 v58, v58, v49
    v_mul_f32 v59, v59, v49
    v_accvgpr_write_b32 a48, v52
    v_accvgpr_write_b32 a49, v53
    v_accvgpr_write_b32 a50, v54
    v_accvgpr_write_b32 a51, v55
    v_accvgpr_write_b32 a52, v56
    v_accvgpr_write_b32 a53, v57
    v_accvgpr_write_b32 a54, v58
    v_accvgpr_write_b32 a55, v59
    v_accvgpr_read_b32 v52, a56
    v_accvgpr_read_b32 v53, a57
    v_accvgpr_read_b32 v54, a58
    v_accvgpr_read_b32 v55, a59
    v_accvgpr_read_b32 v56, a60
    v_accvgpr_read_b32 v57, a61
    v_accvgpr_read_b32 v58, a62
    v_accvgpr_read_b32 v59, a63
    v_mul_f32 v52, v52, v49
    v_mul_f32 v53, v53, v49
    v_mul_f32 v54, v54, v49
    v_mul_f32 v55, v55, v49
    v_mul_f32 v56, v56, v49
    v_mul_f32 v57, v57, v49
    v_mul_f32 v58, v58, v49
    v_mul_f32 v59, v59, v49
    v_accvgpr_write_b32 a56, v52
    v_accvgpr_write_b32 a57, v53
    v_accvgpr_write_b32 a58, v54
    v_accvgpr_write_b32 a59, v55
    v_accvgpr_write_b32 a60, v56
    v_accvgpr_write_b32 a61, v57
    v_accvgpr_write_b32 a62, v58
    v_accvgpr_write_b32 a63, v59
    v_exp_f32 v52, v104
    v_exp_f32 v53, v105
    v_exp_f32 v54, v106
    v_exp_f32 v55, v107
    v_exp_f32 v56, v108
    v_exp_f32 v57, v109
    v_exp_f32 v58, v110
    v_exp_f32 v59, v111
    s_nop 0
    v_cvt_pk_bf16_f32 v148, v52, v53
    v_cvt_pk_bf16_f32 v149, v54, v55
    v_cvt_pk_bf16_f32 v150, v56, v57
    v_cvt_pk_bf16_f32 v151, v58, v59
    s_nop 1
    v_mfma_f32_16x16x32_bf16 v[32:35], v[44:47], v[148:151], 0
    s_nop 7
    s_setpc_b64 s[74:75]
m_rs1467:
    s_nop 15
    v_max3_f32 v48, v96, v97, v98
    v_max3_f32 v48, v48, v99, v100
    v_max3_f32 v48, v48, v101, v102
    v_max3_f32 v48, v48, v103, 0
    v_mov_b32 v49, v48
    s_nop 1
    v_permlane32_swap_b32 v48, v49
    s_nop 1
    v_max_f32 v48, v48, v49
    v_mov_b32 v49, v48
    s_nop 1
    v_permlane16_swap_b32 v48, v49
    s_nop 1
    v_max_f32 v48, v48, v49
    v_exp_f32 v49, -v48
    v_sub_f32 v96, v96, v48
    v_sub_f32 v97, v97, v48
    v_sub_f32 v98, v98, v48
    v_sub_f32 v99, v99, v48
    v_sub_f32 v100, v100, v48
    v_sub_f32 v101, v101, v48
    v_sub_f32 v102, v102, v48
    v_sub_f32 v103, v103, v48
    v_sub_f32 v64, v64, v48
    v_sub_f32 v65, v65, v48
    v_sub_f32 v66, v66, v48
    v_sub_f32 v67, v67, v48
    v_sub_f32 v68, v68, v48
    v_sub_f32 v69, v69, v48
    v_sub_f32 v70, v70, v48
    v_sub_f32 v71, v71, v48
    v_sub_f32 v160, v160, v48
    v_sub_f32 v161, v161, v48
    v_sub_f32 v162, v162, v48
    v_sub_f32 v163, v163, v48
    v_sub_f32 v164, v164, v48
    v_sub_f32 v165, v165, v48
    v_sub_f32 v166, v166, v48
    v_sub_f32 v167, v167, v48
    v_mul_f32 v12, v12, v49
    v_accvgpr_read_b32 v52, a0
    v_accvgpr_read_b32 v53, a1
    v_accvgpr_read_b32 v54, a2
    v_accvgpr_read_b32 v55, a3
    v_accvgpr_read_b32 v56, a4
    v_accvgpr_read_b32 v57, a5
    v_accvgpr_read_b32 v58, a6
    v_accvgpr_read_b32 v59, a7
    v_mul_f32 v52, v52, v49
    v_mul_f32 v53, v53, v49
    v_mul_f32 v54, v54, v49
    v_mul_f32 v55, v55, v49
    v_mul_f32 v56, v56, v49
    v_mul_f32 v57, v57, v49
    v_mul_f32 v58, v58, v49
    v_mul_f32 v59, v59, v49
    v_accvgpr_write_b32 a0, v52
    v_accvgpr_write_b32 a1, v53
    v_accvgpr_write_b32 a2, v54
    v_accvgpr_write_b32 a3, v55
    v_accvgpr_write_b32 a4, v56
    v_accvgpr_write_b32 a5, v57
    v_accvgpr_write_b32 a6, v58
    v_accvgpr_write_b32 a7, v59
    v_accvgpr_read_b32 v52, a8
    v_accvgpr_read_b32 v53, a9
    v_accvgpr_read_b32 v54, a10
    v_accvgpr_read_b32 v55, a11
    v_accvgpr_read_b32 v56, a12
    v_accvgpr_read_b32 v57, a13
    v_accvgpr_read_b32 v58, a14
    v_accvgpr_read_b32 v59, a15
    v_mul_f32 v52, v52, v49
    v_mul_f32 v53, v53, v49
    v_mul_f32 v54, v54, v49
    v_mul_f32 v55, v55, v49
    v_mul_f32 v56, v56, v49
    v_mul_f32 v57, v57, v49
    v_mul_f32 v58, v58, v49
    v_mul_f32 v59, v59, v49
    v_accvgpr_write_b32 a8, v52
    v_accvgpr_write_b32 a9, v53
    v_accvgpr_write_b32 a10, v54
    v_accvgpr_write_b32 a11, v55
    v_accvgpr_write_b32 a12, v56
    v_accvgpr_write_b32 a13, v57
    v_accvgpr_write_b32 a14, v58
    v_accvgpr_write_b32 a15, v59
    v_accvgpr_read_b32 v52, a16
    v_accvgpr_read_b32 v53, a17
    v_accvgpr_read_b32 v54, a18
    v_accvgpr_read_b32 v55, a19
    v_accvgpr_read_b32 v56, a20
    v_accvgpr_read_b32 v57, a21
    v_accvgpr_read_b32 v58, a22
    v_accvgpr_read_b32 v59, a23
    v_mul_f32 v52, v52, v49
    v_mul_f32 v53, v53, v49
    v_mul_f32 v54, v54, v49
    v_mul_f32 v55, v55, v49
    v_mul_f32 v56, v56, v49
    v_mul_f32 v57, v57, v49
    v_mul_f32 v58, v58, v49
    v_mul_f32 v59, v59, v49
    v_accvgpr_write_b32 a16, v52
    v_accvgpr_write_b32 a17, v53
    v_accvgpr_write_b32 a18, v54
    v_accvgpr_write_b32 a19, v55
    v_accvgpr_write_b32 a20, v56
    v_accvgpr_write_b32 a21, v57
    v_accvgpr_write_b32 a22, v58
    v_accvgpr_write_b32 a23, v59
    v_accvgpr_read_b32 v52, a24
    v_accvgpr_read_b32 v53, a25
    v_accvgpr_read_b32 v54, a26
    v_accvgpr_read_b32 v55, a27
    v_accvgpr_read_b32 v56, a28
    v_accvgpr_read_b32 v57, a29
    v_accvgpr_read_b32 v58, a30
    v_accvgpr_read_b32 v59, a31
    v_mul_f32 v52, v52, v49
    v_mul_f32 v53, v53, v49
    v_mul_f32 v54, v54, v49
    v_mul_f32 v55, v55, v49
    v_mul_f32 v56, v56, v49
    v_mul_f32 v57, v57, v49
    v_mul_f32 v58, v58, v49
    v_mul_f32 v59, v59, v49
    v_accvgpr_write_b32 a24, v52
    v_accvgpr_write_b32 a25, v53
    v_accvgpr_write_b32 a26, v54
    v_accvgpr_write_b32 a27, v55
    v_accvgpr_write_b32 a28, v56
    v_accvgpr_write_b32 a29, v57
    v_accvgpr_write_b32 a30, v58
    v_accvgpr_write_b32 a31, v59
    v_exp_f32 v52, v96
    v_exp_f32 v53, v97
    v_exp_f32 v54, v98
    v_exp_f32 v55, v99
    v_exp_f32 v56, v100
    v_exp_f32 v57, v101
    v_exp_f32 v58, v102
    v_exp_f32 v59, v103
    s_nop 0
    v_cvt_pk_bf16_f32 v144, v52, v53
    v_cvt_pk_bf16_f32 v145, v54, v55
    v_cvt_pk_bf16_f32 v146, v56, v57
    v_cvt_pk_bf16_f32 v147, v58, v59
    s_nop 1
    v_mfma_f32_16x16x32_bf16 v[28:31], v[44:47], v[144:147], 0
    v_max3_f32 v48, v104, v105, v106
    v_max3_f32 v48, v48, v107, v108
    v_max3_f32 v48, v48, v109, v110
    v_max3_f32 v48, v48, v111, 0
    v_mov_b32 v49, v48
    s_nop 1
    v_permlane32_swap_b32 v48, v49
    s_nop 1
    v_max_f32 v48, v48, v49
    v_mov_b32 v49, v48
    s_nop 1
    v_permlane16_swap_b32 v48, v49
    s_nop 1
    v_max_f32 v48, v48, v49
    v_exp_f32 v49, -v48
    v_sub_f32 v104, v104, v48
    v_sub_f32 v105, v105, v48
    v_sub_f32 v106, v106, v48
    v_sub_f32 v107, v107, v48
    v_sub_f32 v108, v108, v48
    v_sub_f32 v109, v109, v48
    v_sub_f32 v110, v110, v48
    v_sub_f32 v111, v111, v48
    v_sub_f32 v72, v72, v48
    v_sub_f32 v73, v73, v48
    v_sub_f32 v74, v74, v48
    v_sub_f32 v75, v75, v48
    v_sub_f32 v76, v76, v48
    v_sub_f32 v77, v77, v48
    v_sub_f32 v78, v78, v48
    v_sub_f32 v79, v79, v48
    v_sub_f32 v168, v168, v48
    v_sub_f32 v169, v169, v48
    v_sub_f32 v170, v170, v48
    v_sub_f32 v171, v171, v48
    v_sub_f32 v172, v172, v48
    v_sub_f32 v173, v173, v48
    v_sub_f32 v174, v174, v48
    v_sub_f32 v175, v175, v48
    v_mul_f32 v13, v13, v49
    v_accvgpr_read_b32 v52, a32
    v_accvgpr_read_b32 v53, a33
    v_accvgpr_read_b32 v54, a34
    v_accvgpr_read_b32 v55, a35
    v_accvgpr_read_b32 v56, a36
    v_accvgpr_read_b32 v57, a37
    v_accvgpr_read_b32 v58, a38
    v_accvgpr_read_b32 v59, a39
    v_mul_f32 v52, v52, v49
    v_mul_f32 v53, v53, v49
    v_mul_f32 v54, v54, v49
    v_mul_f32 v55, v55, v49
    v_mul_f32 v56, v56, v49
    v_mul_f32 v57, v57, v49
    v_mul_f32 v58, v58, v49
    v_mul_f32 v59, v59, v49
    v_accvgpr_write_b32 a32, v52
    v_accvgpr_write_b32 a33, v53
    v_accvgpr_write_b32 a34, v54
    v_accvgpr_write_b32 a35, v55
    v_accvgpr_write_b32 a36, v56
    v_accvgpr_write_b32 a37, v57
    v_accvgpr_write_b32 a38, v58
    v_accvgpr_write_b32 a39, v59
    v_accvgpr_read_b32 v52, a40
    v_accvgpr_read_b32 v53, a41
    v_accvgpr_read_b32 v54, a42
    v_accvgpr_read_b32 v55, a43
    v_accvgpr_read_b32 v56, a44
    v_accvgpr_read_b32 v57, a45
    v_accvgpr_read_b32 v58, a46
    v_accvgpr_read_b32 v59, a47
    v_mul_f32 v52, v52, v49
    v_mul_f32 v53, v53, v49
    v_mul_f32 v54, v54, v49
    v_mul_f32 v55, v55, v49
    v_mul_f32 v56, v56, v49
    v_mul_f32 v57, v57, v49
    v_mul_f32 v58, v58, v49
    v_mul_f32 v59, v59, v49
    v_accvgpr_write_b32 a40, v52
    v_accvgpr_write_b32 a41, v53
    v_accvgpr_write_b32 a42, v54
    v_accvgpr_write_b32 a43, v55
    v_accvgpr_write_b32 a44, v56
    v_accvgpr_write_b32 a45, v57
    v_accvgpr_write_b32 a46, v58
    v_accvgpr_write_b32 a47, v59
    v_accvgpr_read_b32 v52, a48
    v_accvgpr_read_b32 v53, a49
    v_accvgpr_read_b32 v54, a50
    v_accvgpr_read_b32 v55, a51
    v_accvgpr_read_b32 v56, a52
    v_accvgpr_read_b32 v57, a53
    v_accvgpr_read_b32 v58, a54
    v_accvgpr_read_b32 v59, a55
    v_mul_f32 v52, v52, v49
    v_mul_f32 v53, v53, v49
    v_mul_f32 v54, v54, v49
    v_mul_f32 v55, v55, v49
    v_mul_f32 v56, v56, v49
    v_mul_f32 v57, v57, v49
    v_mul_f32 v58, v58, v49
    v_mul_f32 v59, v59, v49
    v_accvgpr_write_b32 a48, v52
    v_accvgpr_write_b32 a49, v53
    v_accvgpr_write_b32 a50, v54
    v_accvgpr_write_b32 a51, v55
    v_accvgpr_write_b32 a52, v56
    v_accvgpr_write_b32 a53, v57
    v_accvgpr_write_b32 a54, v58
    v_accvgpr_write_b32 a55, v59
    v_accvgpr_read_b32 v52, a56
    v_accvgpr_read_b32 v53, a57
    v_accvgpr_read_b32 v54, a58
    v_accvgpr_read_b32 v55, a59
    v_accvgpr_read_b32 v56, a60
    v_accvgpr_read_b32 v57, a61
    v_accvgpr_read_b32 v58, a62
    v_accvgpr_read_b32 v59, a63
    v_mul_f32 v52, v52, v49
    v_mul_f32 v53, v53, v49
    v_mul_f32 v54, v54, v49
    v_mul_f32 v55, v55, v49
    v_mul_f32 v56, v56, v49
    v_mul_f32 v57, v57, v49
    v_mul_f32 v58, v58, v49
    v_mul_f32 v59, v59, v49
    v_accvgpr_write_b32 a56, v52
    v_accvgpr_write_b32 a57, v53
    v_accvgpr_write_b32 a58, v54
    v_accvgpr_write_b32 a59, v55
    v_accvgpr_write_b32 a60, v56
    v_accvgpr_write_b32 a61, v57
    v_accvgpr_write_b32 a62, v58
    v_accvgpr_write_b32 a63, v59
    v_exp_f32 v52, v104
    v_exp_f32 v53, v105
    v_exp_f32 v54, v106
    v_exp_f32 v55, v107
    v_exp_f32 v56, v108
    v_exp_f32 v57, v109
    v_exp_f32 v58, v110
    v_exp_f32 v59, v111
    s_nop 0
    v_cvt_pk_bf16_f32 v148, v52, v53
    v_cvt_pk_bf16_f32 v149, v54, v55
    v_cvt_pk_bf16_f32 v150, v56, v57
    v_cvt_pk_bf16_f32 v151, v58, v59
    s_nop 1
    v_mfma_f32_16x16x32_bf16 v[32:35], v[44:47], v[148:151], 0
    v_max3_f32 v48, v112, v113, v114
    v_max3_f32 v48, v48, v115, v116
    v_max3_f32 v48, v48, v117, v118
    v_max3_f32 v48, v48, v119, 0
    v_mov_b32 v49, v48
    s_nop 1
    v_permlane32_swap_b32 v48, v49
    s_nop 1
    v_max_f32 v48, v48, v49
    v_mov_b32 v49, v48
    s_nop 1
    v_permlane16_swap_b32 v48, v49
    s_nop 1
    v_max_f32 v48, v48, v49
    v_exp_f32 v49, -v48
    v_sub_f32 v112, v112, v48
    v_sub_f32 v113, v113, v48
    v_sub_f32 v114, v114, v48
    v_sub_f32 v115, v115, v48
    v_sub_f32 v116, v116, v48
    v_sub_f32 v117, v117, v48
    v_sub_f32 v118, v118, v48
    v_sub_f32 v119, v119, v48
    v_sub_f32 v80, v80, v48
    v_sub_f32 v81, v81, v48
    v_sub_f32 v82, v82, v48
    v_sub_f32 v83, v83, v48
    v_sub_f32 v84, v84, v48
    v_sub_f32 v85, v85, v48
    v_sub_f32 v86, v86, v48
    v_sub_f32 v87, v87, v48
    v_sub_f32 v176, v176, v48
    v_sub_f32 v177, v177, v48
    v_sub_f32 v178, v178, v48
    v_sub_f32 v179, v179, v48
    v_sub_f32 v180, v180, v48
    v_sub_f32 v181, v181, v48
    v_sub_f32 v182, v182, v48
    v_sub_f32 v183, v183, v48
    v_mul_f32 v14, v14, v49
    v_accvgpr_read_b32 v52, a64
    v_accvgpr_read_b32 v53, a65
    v_accvgpr_read_b32 v54, a66
    v_accvgpr_read_b32 v55, a67
    v_accvgpr_read_b32 v56, a68
    v_accvgpr_read_b32 v57, a69
    v_accvgpr_read_b32 v58, a70
    v_accvgpr_read_b32 v59, a71
    v_mul_f32 v52, v52, v49
    v_mul_f32 v53, v53, v49
    v_mul_f32 v54, v54, v49
    v_mul_f32 v55, v55, v49
    v_mul_f32 v56, v56, v49
    v_mul_f32 v57, v57, v49
    v_mul_f32 v58, v58, v49
    v_mul_f32 v59, v59, v49
    v_accvgpr_write_b32 a64, v52
    v_accvgpr_write_b32 a65, v53
    v_accvgpr_write_b32 a66, v54
    v_accvgpr_write_b32 a67, v55
    v_accvgpr_write_b32 a68, v56
    v_accvgpr_write_b32 a69, v57
    v_accvgpr_write_b32 a70, v58
    v_accvgpr_write_b32 a71, v59
    v_accvgpr_read_b32 v52, a72
    v_accvgpr_read_b32 v53, a73
    v_accvgpr_read_b32 v54, a74
    v_accvgpr_read_b32 v55, a75
    v_accvgpr_read_b32 v56, a76
    v_accvgpr_read_b32 v57, a77
    v_accvgpr_read_b32 v58, a78
    v_accvgpr_read_b32 v59, a79
    v_mul_f32 v52, v52, v49
    v_mul_f32 v53, v53, v49
    v_mul_f32 v54, v54, v49
    v_mul_f32 v55, v55, v49
    v_mul_f32 v56, v56, v49
    v_mul_f32 v57, v57, v49
    v_mul_f32 v58, v58, v49
    v_mul_f32 v59, v59, v49
    v_accvgpr_write_b32 a72, v52
    v_accvgpr_write_b32 a73, v53
    v_accvgpr_write_b32 a74, v54
    v_accvgpr_write_b32 a75, v55
    v_accvgpr_write_b32 a76, v56
    v_accvgpr_write_b32 a77, v57
    v_accvgpr_write_b32 a78, v58
    v_accvgpr_write_b32 a79, v59
    v_accvgpr_read_b32 v52, a80
    v_accvgpr_read_b32 v53, a81
    v_accvgpr_read_b32 v54, a82
    v_accvgpr_read_b32 v55, a83
    v_accvgpr_read_b32 v56, a84
    v_accvgpr_read_b32 v57, a85
    v_accvgpr_read_b32 v58, a86
    v_accvgpr_read_b32 v59, a87
    v_mul_f32 v52, v52, v49
    v_mul_f32 v53, v53, v49
    v_mul_f32 v54, v54, v49
    v_mul_f32 v55, v55, v49
    v_mul_f32 v56, v56, v49
    v_mul_f32 v57, v57, v49
    v_mul_f32 v58, v58, v49
    v_mul_f32 v59, v59, v49
    v_accvgpr_write_b32 a80, v52
    v_accvgpr_write_b32 a81, v53
    v_accvgpr_write_b32 a82, v54
    v_accvgpr_write_b32 a83, v55
    v_accvgpr_write_b32 a84, v56
    v_accvgpr_write_b32 a85, v57
    v_accvgpr_write_b32 a86, v58
    v_accvgpr_write_b32 a87, v59
    v_accvgpr_read_b32 v52, a88
    v_accvgpr_read_b32 v53, a89
    v_accvgpr_read_b32 v54, a90
    v_accvgpr_read_b32 v55, a91
    v_accvgpr_read_b32 v56, a92
    v_accvgpr_read_b32 v57, a93
    v_accvgpr_read_b32 v58, a94
    v_accvgpr_read_b32 v59, a95
    v_mul_f32 v52, v52, v49
    v_mul_f32 v53, v53, v49
    v_mul_f32 v54, v54, v49
    v_mul_f32 v55, v55, v49
    v_mul_f32 v56, v56, v49
    v_mul_f32 v57, v57, v49
    v_mul_f32 v58, v58, v49
    v_mul_f32 v59, v59, v49
    v_accvgpr_write_b32 a88, v52
    v_accvgpr_write_b32 a89, v53
    v_accvgpr_write_b32 a90, v54
    v_accvgpr_write_b32 a91, v55
    v_accvgpr_write_b32 a92, v56
    v_accvgpr_write_b32 a93, v57
    v_accvgpr_write_b32 a94, v58
    v_accvgpr_write_b32 a95, v59
    v_exp_f32 v52, v112
    v_exp_f32 v53, v113
    v_exp_f32 v54, v114
    v_exp_f32 v55, v115
    v_exp_f32 v56, v116
    v_exp_f32 v57, v117
    v_exp_f32 v58, v118
    v_exp_f32 v59, v119
    s_nop 0
    v_cvt_pk_bf16_f32 v152, v52, v53
    v_cvt_pk_bf16_f32 v153, v54, v55
    v_cvt_pk_bf16_f32 v154, v56, v57
    v_cvt_pk_bf16_f32 v155, v58, v59
    s_nop 1
    v_mfma_f32_16x16x32_bf16 v[36:39], v[44:47], v[152:155], 0
    v_max3_f32 v48, v120, v121, v122
    v_max3_f32 v48, v48, v123, v124
    v_max3_f32 v48, v48, v125, v126
    v_max3_f32 v48, v48, v127, 0
    v_mov_b32 v49, v48
    s_nop 1
    v_permlane32_swap_b32 v48, v49
    s_nop 1
    v_max_f32 v48, v48, v49
    v_mov_b32 v49, v48
    s_nop 1
    v_permlane16_swap_b32 v48, v49
    s_nop 1
    v_max_f32 v48, v48, v49
    v_exp_f32 v49, -v48
    v_sub_f32 v120, v120, v48
    v_sub_f32 v121, v121, v48
    v_sub_f32 v122, v122, v48
    v_sub_f32 v123, v123, v48
    v_sub_f32 v124, v124, v48
    v_sub_f32 v125, v125, v48
    v_sub_f32 v126, v126, v48
    v_sub_f32 v127, v127, v48
    v_sub_f32 v88, v88, v48
    v_sub_f32 v89, v89, v48
    v_sub_f32 v90, v90, v48
    v_sub_f32 v91, v91, v48
    v_sub_f32 v92, v92, v48
    v_sub_f32 v93, v93, v48
    v_sub_f32 v94, v94, v48
    v_sub_f32 v95, v95, v48
    v_sub_f32 v184, v184, v48
    v_sub_f32 v185, v185, v48
    v_sub_f32 v186, v186, v48
    v_sub_f32 v187, v187, v48
    v_sub_f32 v188, v188, v48
    v_sub_f32 v189, v189, v48
    v_sub_f32 v190, v190, v48
    v_sub_f32 v191, v191, v48
    v_mul_f32 v15, v15, v49
    v_accvgpr_read_b32 v52, a96
    v_accvgpr_read_b32 v53, a97
    v_accvgpr_read_b32 v54, a98
    v_accvgpr_read_b32 v55, a99
    v_accvgpr_read_b32 v56, a100
    v_accvgpr_read_b32 v57, a101
    v_accvgpr_read_b32 v58, a102
    v_accvgpr_read_b32 v59, a103
    v_mul_f32 v52, v52, v49
    v_mul_f32 v53, v53, v49
    v_mul_f32 v54, v54, v49
    v_mul_f32 v55, v55, v49
    v_mul_f32 v56, v56, v49
    v_mul_f32 v57, v57, v49
    v_mul_f32 v58, v58, v49
    v_mul_f32 v59, v59, v49
    v_accvgpr_write_b32 a96, v52
    v_accvgpr_write_b32 a97, v53
    v_accvgpr_write_b32 a98, v54
    v_accvgpr_write_b32 a99, v55
    v_accvgpr_write_b32 a100, v56
    v_accvgpr_write_b32 a101, v57
    v_accvgpr_write_b32 a102, v58
    v_accvgpr_write_b32 a103, v59
    v_accvgpr_read_b32 v52, a104
    v_accvgpr_read_b32 v53, a105
    v_accvgpr_read_b32 v54, a106
    v_accvgpr_read_b32 v55, a107
    v_accvgpr_read_b32 v56, a108
    v_accvgpr_read_b32 v57, a109
    v_accvgpr_read_b32 v58, a110
    v_accvgpr_read_b32 v59, a111
    v_mul_f32 v52, v52, v49
    v_mul_f32 v53, v53, v49
    v_mul_f32 v54, v54, v49
    v_mul_f32 v55, v55, v49
    v_mul_f32 v56, v56, v49
    v_mul_f32 v57, v57, v49
    v_mul_f32 v58, v58, v49
    v_mul_f32 v59, v59, v49
    v_accvgpr_write_b32 a104, v52
    v_accvgpr_write_b32 a105, v53
    v_accvgpr_write_b32 a106, v54
    v_accvgpr_write_b32 a107, v55
    v_accvgpr_write_b32 a108, v56
    v_accvgpr_write_b32 a109, v57
    v_accvgpr_write_b32 a110, v58
    v_accvgpr_write_b32 a111, v59
    v_accvgpr_read_b32 v52, a112
    v_accvgpr_read_b32 v53, a113
    v_accvgpr_read_b32 v54, a114
    v_accvgpr_read_b32 v55, a115
    v_accvgpr_read_b32 v56, a116
    v_accvgpr_read_b32 v57, a117
    v_accvgpr_read_b32 v58, a118
    v_accvgpr_read_b32 v59, a119
    v_mul_f32 v52, v52, v49
    v_mul_f32 v53, v53, v49
    v_mul_f32 v54, v54, v49
    v_mul_f32 v55, v55, v49
    v_mul_f32 v56, v56, v49
    v_mul_f32 v57, v57, v49
    v_mul_f32 v58, v58, v49
    v_mul_f32 v59, v59, v49
    v_accvgpr_write_b32 a112, v52
    v_accvgpr_write_b32 a113, v53
    v_accvgpr_write_b32 a114, v54
    v_accvgpr_write_b32 a115, v55
    v_accvgpr_write_b32 a116, v56
    v_accvgpr_write_b32 a117, v57
    v_accvgpr_write_b32 a118, v58
    v_accvgpr_write_b32 a119, v59
    v_accvgpr_read_b32 v52, a120
    v_accvgpr_read_b32 v53, a121
    v_accvgpr_read_b32 v54, a122
    v_accvgpr_read_b32 v55, a123
    v_accvgpr_read_b32 v56, a124
    v_accvgpr_read_b32 v57, a125
    v_accvgpr_read_b32 v58, a126
    v_accvgpr_read_b32 v59, a127
    v_mul_f32 v52, v52, v49
    v_mul_f32 v53, v53, v49
    v_mul_f32 v54, v54, v49
    v_mul_f32 v55, v55, v49
    v_mul_f32 v56, v56, v49
    v_mul_f32 v57, v57, v49
    v_mul_f32 v58, v58, v49
    v_mul_f32 v59, v59, v49
    v_accvgpr_write_b32 a120, v52
    v_accvgpr_write_b32 a121, v53
    v_accvgpr_write_b32 a122, v54
    v_accvgpr_write_b32 a123, v55
    v_accvgpr_write_b32 a124, v56
    v_accvgpr_write_b32 a125, v57
    v_accvgpr_write_b32 a126, v58
    v_accvgpr_write_b32 a127, v59
    v_exp_f32 v52, v120
    v_exp_f32 v53, v121
    v_exp_f32 v54, v122
    v_exp_f32 v55, v123
    v_exp_f32 v56, v124
    v_exp_f32 v57, v125
    v_exp_f32 v58, v126
    v_exp_f32 v59, v127
    s_nop 0
    v_cvt_pk_bf16_f32 v156, v52, v53
    v_cvt_pk_bf16_f32 v157, v54, v55
    v_cvt_pk_bf16_f32 v158, v56, v57
    v_cvt_pk_bf16_f32 v159, v58, v59
    s_nop 1
    v_mfma_f32_16x16x32_bf16 v[40:43], v[44:47], v[156:159], 0
    s_nop 7
    s_setpc_b64 s[74:75]
m_hook13:
    s_cmp_lg_u32 s16, 0
    s_cbranch_scc1 m_np37
    v_mov_b32 v4, s4
    v_mov_b32 v5, s5
    s_add_u32 s90, s17, 117440512
    s_mov_b64 exec, 1
    buffer_store_dwordx2 v[4:5], off, s[8:11], s90 sc1
    s_mov_b64 exec, -1
m_np37:
    s_mov_b32 s17, -1
    s_branch m_hookr14
m_hook17:
    s_cmp_lg_u32 s16, 0
    s_cbranch_scc1 m_np38
    v_mov_b32 v4, s4
    v_mov_b32 v5, s5
    s_add_u32 s90, s17, 117440512
    s_mov_b64 exec, 1
    buffer_store_dwordx2 v[4:5], off, s[8:11], s90 sc1
    s_mov_b64 exec, -1
m_np38:
    s_mov_b32 s17, -1
    s_branch m_hookr18
m_dosw16:
    s_cmp_eq_u32 s17, -1
    s_cbranch_scc1 m_x39
    s_cmp_lg_u32 s16, 0
    s_cbranch_scc1 m_np44
    v_mov_b32 v4, s4
    v_mov_b32 v5, s5
    s_add_u32 s90, s17, 117440512
    s_mov_b64 exec, 1
    buffer_store_dwordx2 v[4:5], off, s[8:11], s90 sc1
    s_mov_b64 exec, -1
m_np44:
    s_mov_b32 s17, -1
    s_mov_b32 s67, 3
    s_cmp_gt_u32 s65, 3
    s_cbranch_scc1 m_loop15
m_x39:
    s_cmp_eq_u32 s94, 0
    s_cbranch_scc1 m_x40
    s_mov_b32 s42, s73
    s_mov_b32 s46, s76
    s_lshl_b32 s90, s77, 4
    s_lshl_b32 s90, s90, s81
    s_mov_b32 s48, s79
    s_mul_i32 s91, s90, 1
    s_add_u32 s49, s91, s79
    s_sub_u32 s49, s49, 2048
    s_mul_i32 s91, s90, 2
    s_add_u32 s50, s91, s79
    s_mul_i32 s91, s90, 3
    s_add_u32 s51, s91, s79
    s_sub_u32 s51, s51, 2048
    s_mov_b32 s52, s80
    s_lshl_b32 s90, s78, 2
    s_mul_i32 s91, s90, 1
    s_add_u32 s53, s91, s80
    s_sub_u32 s53, s53, 2048
    s_mul_i32 s91, s90, 2
    s_add_u32 s54, s91, s80
    s_mul_i32 s91, s90, 3
    s_add_u32 s55, s91, s80
    s_sub_u32 s55, s55, 2048
    s_lshl_b32 s56, s78, 6
    s_lshl_b32 s90, s58, 7
    s_add_u32 s90, s90, s57
    s_lshl_b32 s91, s16, 6
    s_cmp_eq_u32 s81, 1
    s_cselect_b32 s90, s90, s91
    v_lshrrev_b32 v24, 3, v1
    v_lshlrev_b32 v24, s81, v24
    v_add_u32 v24, s90, v24
    v_mul_lo_u32 v24, v24, s77
    v_lshrrev_b32 v25, 4, v1
    v_and_b32 v26, 7, v1
    v_xor_b32 v25, v25, v26
    v_lshl_add_u32 v16, v25, 4, v24
    v_xor_b32 v25, 4, v25
    v_lshl_add_u32 v17, v25, 4, v24
    s_lshl_b32 s90, s77, 3
    s_lshl_b32 s90, s90, s81
    s_sub_u32 s90, s90, 1024
    v_add_u32 v17, s90, v17
    v_lshrrev_b32 v24, 5, v1
    s_lshl_b32 s90, s16, 4
    v_add_u32 v25, s90, v24
    v_mul_lo_u32 v25, v25, s78
    v_lshlrev_b32 v24, 1, v24
    v_and_b32 v26, 31, v1
    v_xor_b32 v24, v24, v26
    s_lshl_b32 s90, s78, 1
    s_sub_u32 s90, s90, 1024
    v_add_u32 v27, s90, v25
    v_xor_b32 v26, 0, v24
    v_lshl_add_u32 v18, v26, 4, v25
    v_xor_b32 v26, 4, v24
    v_lshl_add_u32 v19, v26, 4, v27
    v_xor_b32 v26, 8, v24
    v_lshl_add_u32 v20, v26, 4, v25
    v_xor_b32 v26, 12, v24
    v_lshl_add_u32 v21, v26, 4, v27
    s_mov_b32 s40, s71
    s_mov_b32 s41, s72
    s_mov_b32 s44, s74
    s_mov_b32 s45, s75
    buffer_load_dwordx2 v[4:5], off, s[12:15], 0 sc1
    s_mov_b32 s67, 0
    s_branch m_loop15
m_x40:
    s_cmp_eq_u32 s70, 1
    s_cbranch_scc1 m_x43
    s_cmp_lg_u32 s65, 3
    s_cbranch_scc1 m_x41
    s_and_b32 s92, s2, 7
    s_lshl_b32 s92, s92, 2
    s_bfe_u32 s93, s2, 0x20003
    s_add_u32 s92, s92, s93
    s_lshr_b32 s93, s2, 5
    s_lshl_b32 s93, s93, 2
    s_or_b32 s93, s93, 0x40000
    s_lshr_b32 s90, s92, 1
    s_lshl_b32 s90, s90, 7
    s_add_u32 s90, s90, 117440512
    v_and_b32 v0, 3, v1
    v_min_u32 v0, 2, v0
    v_and_b32 v4, 4, v1
    v_add3_u32 v0, v0, v4, 8
    v_lshlrev_b32 v0, 3, v0
    buffer_load_dwordx2 v[4:5], v0, s[8:11], s90 offen sc1
    s_branch m_loop15
m_x41:
    s_waitcnt vmcnt(16)
    s_cmp_lg_u32 s65, 2
    s_cbranch_scc1 m_x42
    s_mov_b32 s3, 1048576
m_spin45:
    v_cmp_ne_u64 s[22:23], s[4:5], v[4:5]
    s_nop 3
    s_cmp_eq_u64 s[22:23], 0
    s_cbranch_scc1 m_ok46
    s_sub_u32 s3, s3, 1
    s_cbranch_scc1 m_ok46
    s_sleep 16
    s_and_b32 s92, s2, 7
    s_lshl_b32 s92, s92, 2
    s_bfe_u32 s93, s2, 0x20003
    s_add_u32 s92, s92, s93
    s_lshr_b32 s93, s2, 5
    s_lshl_b32 s93, s93, 2
    s_or_b32 s93, s93, 0x40000
    s_lshr_b32 s90, s92, 1
    s_lshl_b32 s90, s90, 7
    s_add_u32 s90, s90, 117440512
    v_and_b32 v0, 3, v1
    v_min_u32 v0, 2, v0
    v_and_b32 v4, 4, v1
    v_add3_u32 v0, v0, v4, 8
    v_lshlrev_b32 v0, 3, v0
    buffer_load_dwordx2 v[4:5], v0, s[8:11], s90 offen sc1
    s_waitcnt vmcnt(0)
    s_branch m_spin45
m_ok46:
    s_and_b32 s92, s2, 7
    s_lshl_b32 s92, s92, 2
    s_bfe_u32 s93, s2, 0x20003
    s_add_u32 s92, s92, s93
    s_lshr_b32 s93, s2, 5
    s_lshl_b32 s93, s93, 2
    s_or_b32 s93, s93, 0x40000
    s_lshr_b32 s90, s92, 1
    s_lshl_b32 s90, s90, 7
    s_add_u32 s90, s90, 117440512
    s_bfe_u32 s91, 873473623, s93
    s_lshr_b32 s91, s91, 1
    v_mov_b32 v0, s91
    s_bfe_u32 s91, 4225681832, s93
    s_lshr_b32 s91, s91, 1
    v_writelane_b32 v0, s91, 8
    v_lshlrev_b32 v0, 3, v0
    buffer_load_dwordx2 v[4:5], v0, s[8:11], s90 offen sc1
    s_lshl_b32 s90, s92, 19
    s_lshl_b32 s91, s58, 13
    s_add_u32 s90, s90, s91
    s_cmp_eq_u32 s57, 0
    s_mov_b32 s91, 33554432
    s_cselect_b32 s91, 16777216, s91
    s_mov_b32 s42, 0
    s_cselect_b32 s42, 268435456, s42
    s_add_u32 s48, s90, s91
    s_mov_b32 s49, s48
    s_add_u32 s50, s48, 4096
    s_mov_b32 s51, s50
    s_mov_b32 s40, s6
    s_mov_b32 s41, s7
    s_lshl_b32 s90, s92, 19
    s_lshl_b32 s91, s58, 13
    s_add_u32 s90, s90, s91
    s_cmp_eq_u32 s57, 0
    s_mov_b32 s91, 33587200
    s_cselect_b32 s91, 16826368, s91
    s_mov_b32 s46, 268435456
    s_cselect_b32 s46, 268435456, s46
    s_add_u32 s52, s90, s91
    s_mov_b32 s53, s52
    s_add_u32 s54, s52, 4096
    s_mov_b32 s55, s54
    s_mov_b32 s44, s6
    s_mov_b32 s45, s7
    v_mov_b32 v16, v2
    v_mov_b32 v17, v2
    v_mov_b32 v18, v2
    v_mov_b32 v19, v2
    v_mov_b32 v20, v2
    v_mov_b32 v21, v2
    s_branch m_loop15
m_x42:
    s_mov_b32 s3, 1048576
m_spin47:
    v_cmp_ne_u64 s[22:23], s[4:5], v[4:5]
    s_nop 3
    s_cmp_eq_u64 s[22:23], 0
    s_cbranch_scc1 m_ok48
    s_sub_u32 s3, s3, 1
    s_cbranch_scc1 m_ok48
    s_sleep 16
    s_and_b32 s92, s2, 7
    s_lshl_b32 s92, s92, 2
    s_bfe_u32 s93, s2, 0x20003
    s_add_u32 s92, s92, s93
    s_lshr_b32 s93, s2, 5
    s_lshl_b32 s93, s93, 2
    s_or_b32 s93, s93, 0x40000
    s_lshr_b32 s90, s92, 1
    s_lshl_b32 s90, s90, 7
    s_add_u32 s90, s90, 117440512
    s_bfe_u32 s91, 873473623, s93
    s_lshr_b32 s91, s91, 1
    v_mov_b32 v0, s91
    s_bfe_u32 s91, 4225681832, s93
    s_lshr_b32 s91, s91, 1
    v_writelane_b32 v0, s91, 8
    v_lshlrev_b32 v0, 3, v0
    buffer_load_dwordx2 v[4:5], v0, s[8:11], s90 offen sc1
    s_waitcnt vmcnt(0)
    s_branch m_spin47
m_ok48:
    s_and_b32 s92, s2, 7
    s_lshl_b32 s92, s92, 2
    s_bfe_u32 s93, s2, 0x20003
    s_add_u32 s92, s92, s93
    s_lshr_b32 s93, s2, 5
    s_lshl_b32 s93, s93, 2
    s_or_b32 s93, s93, 0x40000
    s_bfe_u32 s90, 4225681832, s93
    s_lshl_b32 s90, s90, 3
    s_lshl_b32 s91, s16, 1
    s_add_u32 s90, s90, s91
    s_lshl_b32 s90, s90, 12
    s_lshl_b32 s91, s92, 19
    s_add_u32 s90, s90, s91
    s_add_u32 s90, s90, 0
    buffer_load_dwordx4 a[128:131], v2, s[8:11], s90 offen offset:0 sc1
    buffer_load_dwordx4 a[132:135], v2, s[8:11], s90 offen offset:1024 sc1
    buffer_load_dwordx4 a[136:139], v2, s[8:11], s90 offen offset:2048 sc1
    buffer_load_dwordx4 a[140:143], v2, s[8:11], s90 offen offset:3072 sc1
    s_bfe_u32 s90, 4225681832, s93
    s_lshl_b32 s90, s90, 3
    s_lshl_b32 s91, s16, 1
    s_add_u32 s90, s90, s91
    s_lshl_b32 s90, s90, 12
    s_lshl_b32 s91, s92, 19
    s_add_u32 s90, s90, s91
    s_add_u32 s90, s90, 4096
    buffer_load_dwordx4 a[144:147], v2, s[8:11], s90 offen offset:0 sc1
    buffer_load_dwordx4 a[148:151], v2, s[8:11], s90 offen offset:1024 sc1
    buffer_load_dwordx4 a[152:155], v2, s[8:11], s90 offen offset:2048 sc1
    buffer_load_dwordx4 a[156:159], v2, s[8:11], s90 offen offset:3072 sc1
    s_bfe_u32 s90, 873473623, s93
    s_lshl_b32 s90, s90, 3
    s_lshl_b32 s91, s16, 1
    s_add_u32 s90, s90, s91
    s_lshl_b32 s90, s90, 12
    s_lshl_b32 s91, s92, 19
    s_add_u32 s90, s90, s91
    s_add_u32 s90, s90, 0
    buffer_load_dwordx4 a[160:163], v2, s[8:11], s90 offen offset:0 sc1
    buffer_load_dwordx4 a[164:167], v2, s[8:11], s90 offen offset:1024 sc1
    buffer_load_dwordx4 a[168:171], v2, s[8:11], s90 offen offset:2048 sc1
    buffer_load_dwordx4 a[172:175], v2, s[8:11], s90 offen offset:3072 sc1
    s_bfe_u32 s90, 873473623, s93
    s_lshl_b32 s90, s90, 3
    s_lshl_b32 s91, s16, 1
    s_add_u32 s90, s90, s91
    s_lshl_b32 s90, s90, 12
    s_lshl_b32 s91, s92, 19
    s_add_u32 s90, s90, s91
    s_add_u32 s90, s90, 4096
    buffer_load_dwordx4 a[176:179], v2, s[8:11], s90 offen offset:0 sc1
    buffer_load_dwordx4 a[180:183], v2, s[8:11], s90 offen offset:1024 sc1
    buffer_load_dwordx4 a[184:187], v2, s[8:11], s90 offen offset:2048 sc1
    buffer_load_dwordx4 a[188:191], v2, s[8:11], s90 offen offset:3072 sc1
    s_lshl_b32 s90, s92, 19
    s_lshl_b32 s91, s58, 13
    s_add_u32 s90, s90, s91
    s_cmp_eq_u32 s57, 0
    s_mov_b32 s91, 33554432
    s_cselect_b32 s91, 16793600, s91
    s_mov_b32 s42, 268435456
    s_cselect_b32 s42, 268435456, s42
    s_add_u32 s48, s90, s91
    s_mov_b32 s49, s48
    s_add_u32 s50, s48, 4096
    s_mov_b32 s51, s50
    s_mov_b32 s40, s6
    s_mov_b32 s41, s7
    s_mov_b32 s46, 0
    s_branch m_loop15
m_x43:
    s_mov_b32 s42, 0
    s_mov_b32 s46, 0
    s_branch m_loop15
m_dosw20:
    s_cmp_eq_u32 s17, -1
    s_cbranch_scc1 m_x49
    s_cmp_lg_u32 s16, 0
    s_cbranch_scc1 m_np54
    v_mov_b32 v4, s4
    v_mov_b32 v5, s5
    s_add_u32 s90, s17, 117440512
    s_mov_b64 exec, 1
    buffer_store_dwordx2 v[4:5], off, s[8:11], s90 sc1
    s_mov_b64 exec, -1
m_np54:
    s_mov_b32 s17, -1
    s_mov_b32 s67, 3
    s_cmp_gt_u32 s65, 3
    s_cbranch_scc1 m_loop19
m_x49:
    s_cmp_eq_u32 s94, 0
    s_cbranch_scc1 m_x50
    s_mov_b32 s42, s73
    s_mov_b32 s46, s76
    s_lshl_b32 s90, s77, 4
    s_lshl_b32 s90, s90, s81
    s_mov_b32 s48, s79
    s_mul_i32 s91, s90, 1
    s_add_u32 s49, s91, s79
    s_sub_u32 s49, s49, 2048
    s_mul_i32 s91, s90, 2
    s_add_u32 s50, s91, s79
    s_mul_i32 s91, s90, 3
    s_add_u32 s51, s91, s79
    s_sub_u32 s51, s51, 2048
    s_mov_b32 s52, s80
    s_lshl_b32 s90, s78, 2
    s_mul_i32 s91, s90, 1
    s_add_u32 s53, s91, s80
    s_sub_u32 s53, s53, 2048
    s_mul_i32 s91, s90, 2
    s_add_u32 s54, s91, s80
    s_mul_i32 s91, s90, 3
    s_add_u32 s55, s91, s80
    s_sub_u32 s55, s55, 2048
    s_lshl_b32 s56, s78, 6
    s_lshl_b32 s90, s58, 7
    s_add_u32 s90, s90, s57
    s_lshl_b32 s91, s16, 6
    s_cmp_eq_u32 s81, 1
    s_cselect_b32 s90, s90, s91
    v_lshrrev_b32 v24, 3, v1
    v_lshlrev_b32 v24, s81, v24
    v_add_u32 v24, s90, v24
    v_mul_lo_u32 v24, v24, s77
    v_lshrrev_b32 v25, 4, v1
    v_and_b32 v26, 7, v1
    v_xor_b32 v25, v25, v26
    v_lshl_add_u32 v16, v25, 4, v24
    v_xor_b32 v25, 4, v25
    v_lshl_add_u32 v17, v25, 4, v24
    s_lshl_b32 s90, s77, 3
    s_lshl_b32 s90, s90, s81
    s_sub_u32 s90, s90, 1024
    v_add_u32 v17, s90, v17
    v_lshrrev_b32 v24, 5, v1
    s_lshl_b32 s90, s16, 4
    v_add_u32 v25, s90, v24
    v_mul_lo_u32 v25, v25, s78
    v_lshlrev_b32 v24, 1, v24
    v_and_b32 v26, 31, v1
    v_xor_b32 v24, v24, v26
    s_lshl_b32 s90, s78, 1
    s_sub_u32 s90, s90, 1024
    v_add_u32 v27, s90, v25
    v_xor_b32 v26, 0, v24
    v_lshl_add_u32 v18, v26, 4, v25
    v_xor_b32 v26, 4, v24
    v_lshl_add_u32 v19, v26, 4, v27
    v_xor_b32 v26, 8, v24
    v_lshl_add_u32 v20, v26, 4, v25
    v_xor_b32 v26, 12, v24
    v_lshl_add_u32 v21, v26, 4, v27
    s_mov_b32 s40, s71
    s_mov_b32 s41, s72
    s_mov_b32 s44, s74
    s_mov_b32 s45, s75
    buffer_load_dwordx2 v[4:5], off, s[12:15], 0 sc1
    s_mov_b32 s67, 0
    s_branch m_loop19
m_x50:
    s_cmp_eq_u32 s70, 1
    s_cbranch_scc1 m_x53
    s_cmp_lg_u32 s65, 3
    s_cbranch_scc1 m_x51
    s_and_b32 s92, s2, 7
    s_lshl_b32 s92, s92, 2
    s_bfe_u32 s93, s2, 0x20003
    s_add_u32 s92, s92, s93
    s_lshr_b32 s93, s2, 5
    s_lshl_b32 s93, s93, 2
    s_or_b32 s93, s93, 0x40000
    s_lshr_b32 s90, s92, 1
    s_lshl_b32 s90, s90, 7
    s_add_u32 s90, s90, 117440512
    v_and_b32 v0, 3, v1
    v_min_u32 v0, 2, v0
    v_and_b32 v4, 4, v1
    v_add3_u32 v0, v0, v4, 8
    v_lshlrev_b32 v0, 3, v0
    buffer_load_dwordx2 v[4:5], v0, s[8:11], s90 offen sc1
    s_branch m_loop19
m_x51:
    s_waitcnt vmcnt(16)
    s_cmp_lg_u32 s65, 2
    s_cbranch_scc1 m_x52
    s_mov_b32 s3, 1048576
m_spin55:
    v_cmp_ne_u64 s[22:23], s[4:5], v[4:5]
    s_nop 3
    s_cmp_eq_u64 s[22:23], 0
    s_cbranch_scc1 m_ok56
    s_sub_u32 s3, s3, 1
    s_cbranch_scc1 m_ok56
    s_sleep 16
    s_and_b32 s92, s2, 7
    s_lshl_b32 s92, s92, 2
    s_bfe_u32 s93, s2, 0x20003
    s_add_u32 s92, s92, s93
    s_lshr_b32 s93, s2, 5
    s_lshl_b32 s93, s93, 2
    s_or_b32 s93, s93, 0x40000
    s_lshr_b32 s90, s92, 1
    s_lshl_b32 s90, s90, 7
    s_add_u32 s90, s90, 117440512
    v_and_b32 v0, 3, v1
    v_min_u32 v0, 2, v0
    v_and_b32 v4, 4, v1
    v_add3_u32 v0, v0, v4, 8
    v_lshlrev_b32 v0, 3, v0
    buffer_load_dwordx2 v[4:5], v0, s[8:11], s90 offen sc1
    s_waitcnt vmcnt(0)
    s_branch m_spin55
m_ok56:
    s_and_b32 s92, s2, 7
    s_lshl_b32 s92, s92, 2
    s_bfe_u32 s93, s2, 0x20003
    s_add_u32 s92, s92, s93
    s_lshr_b32 s93, s2, 5
    s_lshl_b32 s93, s93, 2
    s_or_b32 s93, s93, 0x40000
    s_lshr_b32 s90, s92, 1
    s_lshl_b32 s90, s90, 7
    s_add_u32 s90, s90, 117440512
    s_bfe_u32 s91, 873473623, s93
    s_lshr_b32 s91, s91, 1
    v_mov_b32 v0, s91
    s_bfe_u32 s91, 4225681832, s93
    s_lshr_b32 s91, s91, 1
    v_writelane_b32 v0, s91, 8
    v_lshlrev_b32 v0, 3, v0
    buffer_load_dwordx2 v[4:5], v0, s[8:11], s90 offen sc1
    s_lshl_b32 s90, s92, 19
    s_lshl_b32 s91, s58, 13
    s_add_u32 s90, s90, s91
    s_cmp_eq_u32 s57, 0
    s_mov_b32 s91, 33554432
    s_cselect_b32 s91, 16777216, s91
    s_mov_b32 s42, 0
    s_cselect_b32 s42, 268435456, s42
    s_add_u32 s48, s90, s91
    s_mov_b32 s49, s48
    s_add_u32 s50, s48, 4096
    s_mov_b32 s51, s50
    s_mov_b32 s40, s6
    s_mov_b32 s41, s7
    s_lshl_b32 s90, s92, 19
    s_lshl_b32 s91, s58, 13
    s_add_u32 s90, s90, s91
    s_cmp_eq_u32 s57, 0
    s_mov_b32 s91, 33587200
    s_cselect_b32 s91, 16826368, s91
    s_mov_b32 s46, 268435456
    s_cselect_b32 s46, 268435456, s46
    s_add_u32 s52, s90, s91
    s_mov_b32 s53, s52
    s_add_u32 s54, s52, 4096
    s_mov_b32 s55, s54
    s_mov_b32 s44, s6
    s_mov_b32 s45, s7
    v_mov_b32 v16, v2
    v_mov_b32 v17, v2
    v_mov_b32 v18, v2
    v_mov_b32 v19, v2
    v_mov_b32 v20, v2
    v_mov_b32 v21, v2
    s_branch m_loop19
m_x52:
    s_mov_b32 s3, 1048576
m_spin57:
    v_cmp_ne_u64 s[22:23], s[4:5], v[4:5]
    s_nop 3
    s_cmp_eq_u64 s[22:23], 0
    s_cbranch_scc1 m_ok58
    s_sub_u32 s3, s3, 1
    s_cbranch_scc1 m_ok58
    s_sleep 16
    s_and_b32 s92, s2, 7
    s_lshl_b32 s92, s92, 2
    s_bfe_u32 s93, s2, 0x20003
    s_add_u32 s92, s92, s93
    s_lshr_b32 s93, s2, 5
    s_lshl_b32 s93, s93, 2
    s_or_b32 s93, s93, 0x40000
    s_lshr_b32 s90, s92, 1
    s_lshl_b32 s90, s90, 7
    s_add_u32 s90, s90, 117440512
    s_bfe_u32 s91, 873473623, s93
    s_lshr_b32 s91, s91, 1
    v_mov_b32 v0, s91
    s_bfe_u32 s91, 4225681832, s93
    s_lshr_b32 s91, s91, 1
    v_writelane_b32 v0, s91, 8
    v_lshlrev_b32 v0, 3, v0
    buffer_load_dwordx2 v[4:5], v0, s[8:11], s90 offen sc1
    s_waitcnt vmcnt(0)
    s_branch m_spin57
m_ok58:
    s_and_b32 s92, s2, 7
    s_lshl_b32 s92, s92, 2
    s_bfe_u32 s93, s2, 0x20003
    s_add_u32 s92, s92, s93
    s_lshr_b32 s93, s2, 5
    s_lshl_b32 s93, s93, 2
    s_or_b32 s93, s93, 0x40000
    s_bfe_u32 s90, 4225681832, s93
    s_lshl_b32 s90, s90, 3
    s_lshl_b32 s91, s16, 1
    s_add_u32 s90, s90, s91
    s_lshl_b32 s90, s90, 12
    s_lshl_b32 s91, s92, 19
    s_add_u32 s90, s90, s91
    s_add_u32 s90, s90, 0
    buffer_load_dwordx4 a[128:131], v2, s[8:11], s90 offen offset:0 sc1
    buffer_load_dwordx4 a[132:135], v2, s[8:11], s90 offen offset:1024 sc1
    buffer_load_dwordx4 a[136:139], v2, s[8:11], s90 offen offset:2048 sc1
    buffer_load_dwordx4 a[140:143], v2, s[8:11], s90 offen offset:3072 sc1
    s_bfe_u32 s90, 4225681832, s93
    s_lshl_b32 s90, s90, 3
    s_lshl_b32 s91, s16, 1
    s_add_u32 s90, s90, s91
    s_lshl_b32 s90, s90, 12
    s_lshl_b32 s91, s92, 19
    s_add_u32 s90, s90, s91
    s_add_u32 s90, s90, 4096
    buffer_load_dwordx4 a[144:147], v2, s[8:11], s90 offen offset:0 sc1
    buffer_load_dwordx4 a[148:151], v2, s[8:11], s90 offen offset:1024 sc1
    buffer_load_dwordx4 a[152:155], v2, s[8:11], s90 offen offset:2048 sc1
    buffer_load_dwordx4 a[156:159], v2, s[8:11], s90 offen offset:3072 sc1
    s_bfe_u32 s90, 873473623, s93
    s_lshl_b32 s90, s90, 3
    s_lshl_b32 s91, s16, 1
    s_add_u32 s90, s90, s91
    s_lshl_b32 s90, s90, 12
    s_lshl_b32 s91, s92, 19
    s_add_u32 s90, s90, s91
    s_add_u32 s90, s90, 0
    buffer_load_dwordx4 a[160:163], v2, s[8:11], s90 offen offset:0 sc1
    buffer_load_dwordx4 a[164:167], v2, s[8:11], s90 offen offset:1024 sc1
    buffer_load_dwordx4 a[168:171], v2, s[8:11], s90 offen offset:2048 sc1
    buffer_load_dwordx4 a[172:175], v2, s[8:11], s90 offen offset:3072 sc1
    s_bfe_u32 s90, 873473623, s93
    s_lshl_b32 s90, s90, 3
    s_lshl_b32 s91, s16, 1
    s_add_u32 s90, s90, s91
    s_lshl_b32 s90, s90, 12
    s_lshl_b32 s91, s92, 19
    s_add_u32 s90, s90, s91
    s_add_u32 s90, s90, 4096
    buffer_load_dwordx4 a[176:179], v2, s[8:11], s90 offen offset:0 sc1
    buffer_load_dwordx4 a[180:183], v2, s[8:11], s90 offen offset:1024 sc1
    buffer_load_dwordx4 a[184:187], v2, s[8:11], s90 offen offset:2048 sc1
    buffer_load_dwordx4 a[188:191], v2, s[8:11], s90 offen offset:3072 sc1
    s_lshl_b32 s90, s92, 19
    s_lshl_b32 s91, s58, 13
    s_add_u32 s90, s90, s91
    s_cmp_eq_u32 s57, 0
    s_mov_b32 s91, 33554432
    s_cselect_b32 s91, 16793600, s91
    s_mov_b32 s42, 268435456
    s_cselect_b32 s42, 268435456, s42
    s_add_u32 s48, s90, s91
    s_mov_b32 s49, s48
    s_add_u32 s50, s48, 4096
    s_mov_b32 s51, s50
    s_mov_b32 s40, s6
    s_mov_b32 s41, s7
    s_mov_b32 s46, 0
    s_branch m_loop19
m_x53:
    s_mov_b32 s42, 0
    s_mov_b32 s46, 0
    s_branch m_loop19
m_eps22:
    s_mov_b32 s92, s97
    s_mov_b32 s93, s97
    s_cmp_eq_u32 s97, 0
    s_cbranch_scc1 m_ns359
    v_pk_mul_f32 v[32:33], v[32:33], s[92:93]
    v_pk_mul_f32 v[34:35], v[34:35], s[92:93]
    v_pk_mul_f32 v[36:37], v[36:37], s[92:93]
    v_pk_mul_f32 v[38:39], v[38:39], s[92:93]
    v_cvt_pk_bf16_f32 v32, v32, v33
    v_cvt_pk_bf16_f32 v33, v34, v35
    v_cvt_pk_bf16_f32 v34, v36, v37
    v_cvt_pk_bf16_f32 v35, v38, v39
    v_accvgpr_write_b32 a128, v32
    v_accvgpr_write_b32 a129, v33
    v_accvgpr_write_b32 a130, v34
    v_accvgpr_write_b32 a131, v35
    v_pk_mul_f32 v[40:41], v[40:41], s[92:93]
    v_pk_mul_f32 v[42:43], v[42:43], s[92:93]
    v_pk_mul_f32 v[44:45], v[44:45], s[92:93]
    v_pk_mul_f32 v[46:47], v[46:47], s[92:93]
    v_cvt_pk_bf16_f32 v40, v40, v41
    v_cvt_pk_bf16_f32 v41, v42, v43
    v_cvt_pk_bf16_f32 v42, v44, v45
    v_cvt_pk_bf16_f32 v43, v46, v47
    v_accvgpr_write_b32 a132, v40
    v_accvgpr_write_b32 a133, v41
    v_accvgpr_write_b32 a134, v42
    v_accvgpr_write_b32 a135, v43
    v_pk_mul_f32 v[48:49], v[48:49], s[92:93]
    v_pk_mul_f32 v[50:51], v[50:51], s[92:93]
    v_pk_mul_f32 v[52:53], v[52:53], s[92:93]
    v_pk_mul_f32 v[54:55], v[54:55], s[92:93]
    v_cvt_pk_bf16_f32 v48, v48, v49
    v_cvt_pk_bf16_f32 v49, v50, v51
    v_cvt_pk_bf16_f32 v50, v52, v53
    v_cvt_pk_bf16_f32 v51, v54, v55
    v_accvgpr_write_b32 a136, v48
    v_accvgpr_write_b32 a137, v49
    v_accvgpr_write_b32 a138, v50
    v_accvgpr_write_b32 a139, v51
    v_pk_mul_f32 v[56:57], v[56:57], s[92:93]
    v_pk_mul_f32 v[58:59], v[58:59], s[92:93]
    v_pk_mul_f32 v[60:61], v[60:61], s[92:93]
    v_pk_mul_f32 v[62:63], v[62:63], s[92:93]
    v_cvt_pk_bf16_f32 v56, v56, v57
    v_cvt_pk_bf16_f32 v57, v58, v59
    v_cvt_pk_bf16_f32 v58, v60, v61
    v_cvt_pk_bf16_f32 v59, v62, v63
    v_accvgpr_write_b32 a140, v56
    v_accvgpr_write_b32 a141, v57
    v_accvgpr_write_b32 a142, v58
    v_accvgpr_write_b32 a143, v59
    v_pk_mul_f32 v[64:65], v[64:65], s[92:93]
    v_pk_mul_f32 v[66:67], v[66:67], s[92:93]
    v_pk_mul_f32 v[68:69], v[68:69], s[92:93]
    v_pk_mul_f32 v[70:71], v[70:71], s[92:93]
    v_cvt_pk_bf16_f32 v64, v64, v65
    v_cvt_pk_bf16_f32 v65, v66, v67
    v_cvt_pk_bf16_f32 v66, v68, v69
    v_cvt_pk_bf16_f32 v67, v70, v71
    v_accvgpr_write_b32 a144, v64
    v_accvgpr_write_b32 a145, v65
    v_accvgpr_write_b32 a146, v66
    v_accvgpr_write_b32 a147, v67
    v_pk_mul_f32 v[72:73], v[72:73], s[92:93]
    v_pk_mul_f32 v[74:75], v[74:75], s[92:93]
    v_pk_mul_f32 v[76:77], v[76:77], s[92:93]
    v_pk_mul_f32 v[78:79], v[78:79], s[92:93]
    v_cvt_pk_bf16_f32 v72, v72, v73
    v_cvt_pk_bf16_f32 v73, v74, v75
    v_cvt_pk_bf16_f32 v74, v76, v77
    v_cvt_pk_bf16_f32 v75, v78, v79
    v_accvgpr_write_b32 a148, v72
    v_accvgpr_write_b32 a149, v73
    v_accvgpr_write_b32 a150, v74
    v_accvgpr_write_b32 a151, v75
    v_pk_mul_f32 v[80:81], v[80:81], s[92:93]
    v_pk_mul_f32 v[82:83], v[82:83], s[92:93]
    v_pk_mul_f32 v[84:85], v[84:85], s[92:93]
    v_pk_mul_f32 v[86:87], v[86:87], s[92:93]
    v_cvt_pk_bf16_f32 v80, v80, v81
    v_cvt_pk_bf16_f32 v81, v82, v83
    v_cvt_pk_bf16_f32 v82, v84, v85
    v_cvt_pk_bf16_f32 v83, v86, v87
    v_accvgpr_write_b32 a152, v80
    v_accvgpr_write_b32 a153, v81
    v_accvgpr_write_b32 a154, v82
    v_accvgpr_write_b32 a155, v83
    v_pk_mul_f32 v[88:89], v[88:89], s[92:93]
    v_pk_mul_f32 v[90:91], v[90:91], s[92:93]
    v_pk_mul_f32 v[92:93], v[92:93], s[92:93]
    v_pk_mul_f32 v[94:95], v[94:95], s[92:93]
    v_cvt_pk_bf16_f32 v88, v88, v89
    v_cvt_pk_bf16_f32 v89, v90, v91
    v_cvt_pk_bf16_f32 v90, v92, v93
    v_cvt_pk_bf16_f32 v91, v94, v95
    v_accvgpr_write_b32 a156, v88
    v_accvgpr_write_b32 a157, v89
    v_accvgpr_write_b32 a158, v90
    v_accvgpr_write_b32 a159, v91
    v_pk_mul_f32 v[96:97], v[96:97], s[92:93]
    v_pk_mul_f32 v[98:99], v[98:99], s[92:93]
    v_pk_mul_f32 v[100:101], v[100:101], s[92:93]
    v_pk_mul_f32 v[102:103], v[102:103], s[92:93]
    v_cvt_pk_bf16_f32 v96, v96, v97
    v_cvt_pk_bf16_f32 v97, v98, v99
    v_cvt_pk_bf16_f32 v98, v100, v101
    v_cvt_pk_bf16_f32 v99, v102, v103
    v_accvgpr_write_b32 a160, v96
    v_accvgpr_write_b32 a161, v97
    v_accvgpr_write_b32 a162, v98
    v_accvgpr_write_b32 a163, v99
    v_pk_mul_f32 v[104:105], v[104:105], s[92:93]
    v_pk_mul_f32 v[106:107], v[106:107], s[92:93]
    v_pk_mul_f32 v[108:109], v[108:109], s[92:93]
    v_pk_mul_f32 v[110:111], v[110:111], s[92:93]
    v_cvt_pk_bf16_f32 v104, v104, v105
    v_cvt_pk_bf16_f32 v105, v106, v107
    v_cvt_pk_bf16_f32 v106, v108, v109
    v_cvt_pk_bf16_f32 v107, v110, v111
    v_accvgpr_write_b32 a164, v104
    v_accvgpr_write_b32 a165, v105
    v_accvgpr_write_b32 a166, v106
    v_accvgpr_write_b32 a167, v107
    v_pk_mul_f32 v[112:113], v[112:113], s[92:93]
    v_pk_mul_f32 v[114:115], v[114:115], s[92:93]
    v_pk_mul_f32 v[116:117], v[116:117], s[92:93]
    v_pk_mul_f32 v[118:119], v[118:119], s[92:93]
    v_cvt_pk_bf16_f32 v112, v112, v113
    v_cvt_pk_bf16_f32 v113, v114, v115
    v_cvt_pk_bf16_f32 v114, v116, v117
    v_cvt_pk_bf16_f32 v115, v118, v119
    v_accvgpr_write_b32 a168, v112
    v_accvgpr_write_b32 a169, v113
    v_accvgpr_write_b32 a170, v114
    v_accvgpr_write_b32 a171, v115
    v_pk_mul_f32 v[120:121], v[120:121], s[92:93]
    v_pk_mul_f32 v[122:123], v[122:123], s[92:93]
    v_pk_mul_f32 v[124:125], v[124:125], s[92:93]
    v_pk_mul_f32 v[126:127], v[126:127], s[92:93]
    v_cvt_pk_bf16_f32 v120, v120, v121
    v_cvt_pk_bf16_f32 v121, v122, v123
    v_cvt_pk_bf16_f32 v122, v124, v125
    v_cvt_pk_bf16_f32 v123, v126, v127
    v_accvgpr_write_b32 a172, v120
    v_accvgpr_write_b32 a173, v121
    v_accvgpr_write_b32 a174, v122
    v_accvgpr_write_b32 a175, v123
    v_pk_mul_f32 v[128:129], v[128:129], s[92:93]
    v_pk_mul_f32 v[130:131], v[130:131], s[92:93]
    v_pk_mul_f32 v[132:133], v[132:133], s[92:93]
    v_pk_mul_f32 v[134:135], v[134:135], s[92:93]
    v_cvt_pk_bf16_f32 v128, v128, v129
    v_cvt_pk_bf16_f32 v129, v130, v131
    v_cvt_pk_bf16_f32 v130, v132, v133
    v_cvt_pk_bf16_f32 v131, v134, v135
    v_accvgpr_write_b32 a176, v128
    v_accvgpr_write_b32 a177, v129
    v_accvgpr_write_b32 a178, v130
    v_accvgpr_write_b32 a179, v131
    v_pk_mul_f32 v[136:137], v[136:137], s[92:93]
    v_pk_mul_f32 v[138:139], v[138:139], s[92:93]
    v_pk_mul_f32 v[140:141], v[140:141], s[92:93]
    v_pk_mul_f32 v[142:143], v[142:143], s[92:93]
    v_cvt_pk_bf16_f32 v136, v136, v137
    v_cvt_pk_bf16_f32 v137, v138, v139
    v_cvt_pk_bf16_f32 v138, v140, v141
    v_cvt_pk_bf16_f32 v139, v142, v143
    v_accvgpr_write_b32 a180, v136
    v_accvgpr_write_b32 a181, v137
    v_accvgpr_write_b32 a182, v138
    v_accvgpr_write_b32 a183, v139
    v_pk_mul_f32 v[144:145], v[144:145], s[92:93]
    v_pk_mul_f32 v[146:147], v[146:147], s[92:93]
    v_pk_mul_f32 v[148:149], v[148:149], s[92:93]
    v_pk_mul_f32 v[150:151], v[150:151], s[92:93]
    v_cvt_pk_bf16_f32 v144, v144, v145
    v_cvt_pk_bf16_f32 v145, v146, v147
    v_cvt_pk_bf16_f32 v146, v148, v149
    v_cvt_pk_bf16_f32 v147, v150, v151
    v_accvgpr_write_b32 a184, v144
    v_accvgpr_write_b32 a185, v145
    v_accvgpr_write_b32 a186, v146
    v_accvgpr_write_b32 a187, v147
    v_pk_mul_f32 v[152:153], v[152:153], s[92:93]
    v_pk_mul_f32 v[154:155], v[154:155], s[92:93]
    v_pk_mul_f32 v[156:157], v[156:157], s[92:93]
    v_pk_mul_f32 v[158:159], v[158:159], s[92:93]
    v_cvt_pk_bf16_f32 v152, v152, v153
    v_cvt_pk_bf16_f32 v153, v154, v155
    v_cvt_pk_bf16_f32 v154, v156, v157
    v_cvt_pk_bf16_f32 v155, v158, v159
    v_accvgpr_write_b32 a188, v152
    v_accvgpr_write_b32 a189, v153
    v_accvgpr_write_b32 a190, v154
    v_accvgpr_write_b32 a191, v155
    v_pk_mul_f32 v[160:161], v[160:161], s[92:93]
    v_pk_mul_f32 v[162:163], v[162:163], s[92:93]
    v_pk_mul_f32 v[164:165], v[164:165], s[92:93]
    v_pk_mul_f32 v[166:167], v[166:167], s[92:93]
    v_cvt_pk_bf16_f32 v160, v160, v161
    v_cvt_pk_bf16_f32 v161, v162, v163
    v_cvt_pk_bf16_f32 v162, v164, v165
    v_cvt_pk_bf16_f32 v163, v166, v167
    v_accvgpr_write_b32 a192, v160
    v_accvgpr_write_b32 a193, v161
    v_accvgpr_write_b32 a194, v162
    v_accvgpr_write_b32 a195, v163
    v_pk_mul_f32 v[168:169], v[168:169], s[92:93]
    v_pk_mul_f32 v[170:171], v[170:171], s[92:93]
    v_pk_mul_f32 v[172:173], v[172:173], s[92:93]
    v_pk_mul_f32 v[174:175], v[174:175], s[92:93]
    v_cvt_pk_bf16_f32 v168, v168, v169
    v_cvt_pk_bf16_f32 v169, v170, v171
    v_cvt_pk_bf16_f32 v170, v172, v173
    v_cvt_pk_bf16_f32 v171, v174, v175
    v_accvgpr_write_b32 a196, v168
    v_accvgpr_write_b32 a197, v169
    v_accvgpr_write_b32 a198, v170
    v_accvgpr_write_b32 a199, v171
    v_pk_mul_f32 v[176:177], v[176:177], s[92:93]
    v_pk_mul_f32 v[178:179], v[178:179], s[92:93]
    v_pk_mul_f32 v[180:181], v[180:181], s[92:93]
    v_pk_mul_f32 v[182:183], v[182:183], s[92:93]
    v_cvt_pk_bf16_f32 v176, v176, v177
    v_cvt_pk_bf16_f32 v177, v178, v179
    v_cvt_pk_bf16_f32 v178, v180, v181
    v_cvt_pk_bf16_f32 v179, v182, v183
    v_accvgpr_write_b32 a200, v176
    v_accvgpr_write_b32 a201, v177
    v_accvgpr_write_b32 a202, v178
    v_accvgpr_write_b32 a203, v179
    v_pk_mul_f32 v[184:185], v[184:185], s[92:93]
    v_pk_mul_f32 v[186:187], v[186:187], s[92:93]
    v_pk_mul_f32 v[188:189], v[188:189], s[92:93]
    v_pk_mul_f32 v[190:191], v[190:191], s[92:93]
    v_cvt_pk_bf16_f32 v184, v184, v185
    v_cvt_pk_bf16_f32 v185, v186, v187
    v_cvt_pk_bf16_f32 v186, v188, v189
    v_cvt_pk_bf16_f32 v187, v190, v191
    v_accvgpr_write_b32 a204, v184
    v_accvgpr_write_b32 a205, v185
    v_accvgpr_write_b32 a206, v186
    v_accvgpr_write_b32 a207, v187
    v_pk_mul_f32 v[192:193], v[192:193], s[92:93]
    v_pk_mul_f32 v[194:195], v[194:195], s[92:93]
    v_pk_mul_f32 v[196:197], v[196:197], s[92:93]
    v_pk_mul_f32 v[198:199], v[198:199], s[92:93]
    v_cvt_pk_bf16_f32 v192, v192, v193
    v_cvt_pk_bf16_f32 v193, v194, v195
    v_cvt_pk_bf16_f32 v194, v196, v197
    v_cvt_pk_bf16_f32 v195, v198, v199
    v_accvgpr_write_b32 a208, v192
    v_accvgpr_write_b32 a209, v193
    v_accvgpr_write_b32 a210, v194
    v_accvgpr_write_b32 a211, v195
    v_pk_mul_f32 v[200:201], v[200:201], s[92:93]
    v_pk_mul_f32 v[202:203], v[202:203], s[92:93]
    v_pk_mul_f32 v[204:205], v[204:205], s[92:93]
    v_pk_mul_f32 v[206:207], v[206:207], s[92:93]
    v_cvt_pk_bf16_f32 v200, v200, v201
    v_cvt_pk_bf16_f32 v201, v202, v203
    v_cvt_pk_bf16_f32 v202, v204, v205
    v_cvt_pk_bf16_f32 v203, v206, v207
    v_accvgpr_write_b32 a212, v200
    v_accvgpr_write_b32 a213, v201
    v_accvgpr_write_b32 a214, v202
    v_accvgpr_write_b32 a215, v203
    v_pk_mul_f32 v[208:209], v[208:209], s[92:93]
    v_pk_mul_f32 v[210:211], v[210:211], s[92:93]
    v_pk_mul_f32 v[212:213], v[212:213], s[92:93]
    v_pk_mul_f32 v[214:215], v[214:215], s[92:93]
    v_cvt_pk_bf16_f32 v208, v208, v209
    v_cvt_pk_bf16_f32 v209, v210, v211
    v_cvt_pk_bf16_f32 v210, v212, v213
    v_cvt_pk_bf16_f32 v211, v214, v215
    v_accvgpr_write_b32 a216, v208
    v_accvgpr_write_b32 a217, v209
    v_accvgpr_write_b32 a218, v210
    v_accvgpr_write_b32 a219, v211
    v_pk_mul_f32 v[216:217], v[216:217], s[92:93]
    v_pk_mul_f32 v[218:219], v[218:219], s[92:93]
    v_pk_mul_f32 v[220:221], v[220:221], s[92:93]
    v_pk_mul_f32 v[222:223], v[222:223], s[92:93]
    v_cvt_pk_bf16_f32 v216, v216, v217
    v_cvt_pk_bf16_f32 v217, v218, v219
    v_cvt_pk_bf16_f32 v218, v220, v221
    v_cvt_pk_bf16_f32 v219, v222, v223
    v_accvgpr_write_b32 a220, v216
    v_accvgpr_write_b32 a221, v217
    v_accvgpr_write_b32 a222, v218
    v_accvgpr_write_b32 a223, v219
    v_pk_mul_f32 v[224:225], v[224:225], s[92:93]
    v_pk_mul_f32 v[226:227], v[226:227], s[92:93]
    v_pk_mul_f32 v[228:229], v[228:229], s[92:93]
    v_pk_mul_f32 v[230:231], v[230:231], s[92:93]
    v_cvt_pk_bf16_f32 v224, v224, v225
    v_cvt_pk_bf16_f32 v225, v226, v227
    v_cvt_pk_bf16_f32 v226, v228, v229
    v_cvt_pk_bf16_f32 v227, v230, v231
    v_accvgpr_write_b32 a224, v224
    v_accvgpr_write_b32 a225, v225
    v_accvgpr_write_b32 a226, v226
    v_accvgpr_write_b32 a227, v227
    v_pk_mul_f32 v[232:233], v[232:233], s[92:93]
    v_pk_mul_f32 v[234:235], v[234:235], s[92:93]
    v_pk_mul_f32 v[236:237], v[236:237], s[92:93]
    v_pk_mul_f32 v[238:239], v[238:239], s[92:93]
    v_cvt_pk_bf16_f32 v232, v232, v233
    v_cvt_pk_bf16_f32 v233, v234, v235
    v_cvt_pk_bf16_f32 v234, v236, v237
    v_cvt_pk_bf16_f32 v235, v238, v239
    v_accvgpr_write_b32 a228, v232
    v_accvgpr_write_b32 a229, v233
    v_accvgpr_write_b32 a230, v234
    v_accvgpr_write_b32 a231, v235
    v_pk_mul_f32 v[240:241], v[240:241], s[92:93]
    v_pk_mul_f32 v[242:243], v[242:243], s[92:93]
    v_pk_mul_f32 v[244:245], v[244:245], s[92:93]
    v_pk_mul_f32 v[246:247], v[246:247], s[92:93]
    v_cvt_pk_bf16_f32 v240, v240, v241
    v_cvt_pk_bf16_f32 v241, v242, v243
    v_cvt_pk_bf16_f32 v242, v244, v245
    v_cvt_pk_bf16_f32 v243, v246, v247
    v_accvgpr_write_b32 a232, v240
    v_accvgpr_write_b32 a233, v241
    v_accvgpr_write_b32 a234, v242
    v_accvgpr_write_b32 a235, v243
    v_pk_mul_f32 v[248:249], v[248:249], s[92:93]
    v_pk_mul_f32 v[250:251], v[250:251], s[92:93]
    v_pk_mul_f32 v[252:253], v[252:253], s[92:93]
    v_pk_mul_f32 v[254:255], v[254:255], s[92:93]
    v_cvt_pk_bf16_f32 v248, v248, v249
    v_cvt_pk_bf16_f32 v249, v250, v251
    v_cvt_pk_bf16_f32 v250, v252, v253
    v_cvt_pk_bf16_f32 v251, v254, v255
    v_accvgpr_write_b32 a236, v248
    v_accvgpr_write_b32 a237, v249
    v_accvgpr_write_b32 a238, v250
    v_accvgpr_write_b32 a239, v251
    v_accvgpr_read_b32 v24, a96
    v_accvgpr_read_b32 v25, a97
    v_accvgpr_read_b32 v26, a98
    v_accvgpr_read_b32 v27, a99
    v_accvgpr_read_b32 v28, a100
    v_accvgpr_read_b32 v29, a101
    v_accvgpr_read_b32 v30, a102
    v_accvgpr_read_b32 v31, a103
    v_pk_mul_f32 v[24:25], v[24:25], s[92:93]
    v_pk_mul_f32 v[26:27], v[26:27], s[92:93]
    v_pk_mul_f32 v[28:29], v[28:29], s[92:93]
    v_pk_mul_f32 v[30:31], v[30:31], s[92:93]
    v_cvt_pk_bf16_f32 v24, v24, v25
    v_cvt_pk_bf16_f32 v25, v26, v27
    v_cvt_pk_bf16_f32 v26, v28, v29
    v_cvt_pk_bf16_f32 v27, v30, v31
    v_accvgpr_write_b32 a240, v24
    v_accvgpr_write_b32 a241, v25
    v_accvgpr_write_b32 a242, v26
    v_accvgpr_write_b32 a243, v27
    v_accvgpr_read_b32 v24, a104
    v_accvgpr_read_b32 v25, a105
    v_accvgpr_read_b32 v26, a106
    v_accvgpr_read_b32 v27, a107
    v_accvgpr_read_b32 v28, a108
    v_accvgpr_read_b32 v29, a109
    v_accvgpr_read_b32 v30, a110
    v_accvgpr_read_b32 v31, a111
    v_pk_mul_f32 v[24:25], v[24:25], s[92:93]
    v_pk_mul_f32 v[26:27], v[26:27], s[92:93]
    v_pk_mul_f32 v[28:29], v[28:29], s[92:93]
    v_pk_mul_f32 v[30:31], v[30:31], s[92:93]
    v_cvt_pk_bf16_f32 v24, v24, v25
    v_cvt_pk_bf16_f32 v25, v26, v27
    v_cvt_pk_bf16_f32 v26, v28, v29
    v_cvt_pk_bf16_f32 v27, v30, v31
    v_accvgpr_write_b32 a244, v24
    v_accvgpr_write_b32 a245, v25
    v_accvgpr_write_b32 a246, v26
    v_accvgpr_write_b32 a247, v27
    v_accvgpr_read_b32 v24, a112
    v_accvgpr_read_b32 v25, a113
    v_accvgpr_read_b32 v26, a114
    v_accvgpr_read_b32 v27, a115
    v_accvgpr_read_b32 v28, a116
    v_accvgpr_read_b32 v29, a117
    v_accvgpr_read_b32 v30, a118
    v_accvgpr_read_b32 v31, a119
    v_pk_mul_f32 v[24:25], v[24:25], s[92:93]
    v_pk_mul_f32 v[26:27], v[26:27], s[92:93]
    v_pk_mul_f32 v[28:29], v[28:29], s[92:93]
    v_pk_mul_f32 v[30:31], v[30:31], s[92:93]
    v_cvt_pk_bf16_f32 v24, v24, v25
    v_cvt_pk_bf16_f32 v25, v26, v27
    v_cvt_pk_bf16_f32 v26, v28, v29
    v_cvt_pk_bf16_f32 v27, v30, v31
    v_accvgpr_write_b32 a248, v24
    v_accvgpr_write_b32 a249, v25
    v_accvgpr_write_b32 a250, v26
    v_accvgpr_write_b32 a251, v27
    v_accvgpr_read_b32 v24, a120
    v_accvgpr_read_b32 v25, a121
    v_accvgpr_read_b32 v26, a122
    v_accvgpr_read_b32 v27, a123
    v_accvgpr_read_b32 v28, a124
    v_accvgpr_read_b32 v29, a125
    v_accvgpr_read_b32 v30, a126
    v_accvgpr_read_b32 v31, a127
    v_pk_mul_f32 v[24:25], v[24:25], s[92:93]
    v_pk_mul_f32 v[26:27], v[26:27], s[92:93]
    v_pk_mul_f32 v[28:29], v[28:29], s[92:93]
    v_pk_mul_f32 v[30:31], v[30:31], s[92:93]
    v_cvt_pk_bf16_f32 v24, v24, v25
    v_cvt_pk_bf16_f32 v25, v26, v27
    v_cvt_pk_bf16_f32 v26, v28, v29
    v_cvt_pk_bf16_f32 v27, v30, v31
    v_accvgpr_write_b32 a252, v24
    v_accvgpr_write_b32 a253, v25
    v_accvgpr_write_b32 a254, v26
    v_accvgpr_write_b32 a255, v27
    s_setpc_b64 s[20:21]
m_ns359:
    v_cvt_pk_bf16_f32 v32, v32, v33
    v_cvt_pk_bf16_f32 v33, v34, v35
    v_cvt_pk_bf16_f32 v34, v36, v37
    v_cvt_pk_bf16_f32 v35, v38, v39
    v_accvgpr_write_b32 a128, v32
    v_accvgpr_write_b32 a129, v33
    v_accvgpr_write_b32 a130, v34
    v_accvgpr_write_b32 a131, v35
    v_cvt_pk_bf16_f32 v40, v40, v41
    v_cvt_pk_bf16_f32 v41, v42, v43
    v_cvt_pk_bf16_f32 v42, v44, v45
    v_cvt_pk_bf16_f32 v43, v46, v47
    v_accvgpr_write_b32 a132, v40
    v_accvgpr_write_b32 a133, v41
    v_accvgpr_write_b32 a134, v42
    v_accvgpr_write_b32 a135, v43
    v_cvt_pk_bf16_f32 v48, v48, v49
    v_cvt_pk_bf16_f32 v49, v50, v51
    v_cvt_pk_bf16_f32 v50, v52, v53
    v_cvt_pk_bf16_f32 v51, v54, v55
    v_accvgpr_write_b32 a136, v48
    v_accvgpr_write_b32 a137, v49
    v_accvgpr_write_b32 a138, v50
    v_accvgpr_write_b32 a139, v51
    v_cvt_pk_bf16_f32 v56, v56, v57
    v_cvt_pk_bf16_f32 v57, v58, v59
    v_cvt_pk_bf16_f32 v58, v60, v61
    v_cvt_pk_bf16_f32 v59, v62, v63
    v_accvgpr_write_b32 a140, v56
    v_accvgpr_write_b32 a141, v57
    v_accvgpr_write_b32 a142, v58
    v_accvgpr_write_b32 a143, v59
    v_cvt_pk_bf16_f32 v64, v64, v65
    v_cvt_pk_bf16_f32 v65, v66, v67
    v_cvt_pk_bf16_f32 v66, v68, v69
    v_cvt_pk_bf16_f32 v67, v70, v71
    v_accvgpr_write_b32 a144, v64
    v_accvgpr_write_b32 a145, v65
    v_accvgpr_write_b32 a146, v66
    v_accvgpr_write_b32 a147, v67
    v_cvt_pk_bf16_f32 v72, v72, v73
    v_cvt_pk_bf16_f32 v73, v74, v75
    v_cvt_pk_bf16_f32 v74, v76, v77
    v_cvt_pk_bf16_f32 v75, v78, v79
    v_accvgpr_write_b32 a148, v72
    v_accvgpr_write_b32 a149, v73
    v_accvgpr_write_b32 a150, v74
    v_accvgpr_write_b32 a151, v75
    v_cvt_pk_bf16_f32 v80, v80, v81
    v_cvt_pk_bf16_f32 v81, v82, v83
    v_cvt_pk_bf16_f32 v82, v84, v85
    v_cvt_pk_bf16_f32 v83, v86, v87
    v_accvgpr_write_b32 a152, v80
    v_accvgpr_write_b32 a153, v81
    v_accvgpr_write_b32 a154, v82
    v_accvgpr_write_b32 a155, v83
    v_cvt_pk_bf16_f32 v88, v88, v89
    v_cvt_pk_bf16_f32 v89, v90, v91
    v_cvt_pk_bf16_f32 v90, v92, v93
    v_cvt_pk_bf16_f32 v91, v94, v95
    v_accvgpr_write_b32 a156, v88
    v_accvgpr_write_b32 a157, v89
    v_accvgpr_write_b32 a158, v90
    v_accvgpr_write_b32 a159, v91
    v_cvt_pk_bf16_f32 v96, v96, v97
    v_cvt_pk_bf16_f32 v97, v98, v99
    v_cvt_pk_bf16_f32 v98, v100, v101
    v_cvt_pk_bf16_f32 v99, v102, v103
    v_accvgpr_write_b32 a160, v96
    v_accvgpr_write_b32 a161, v97
    v_accvgpr_write_b32 a162, v98
    v_accvgpr_write_b32 a163, v99
    v_cvt_pk_bf16_f32 v104, v104, v105
    v_cvt_pk_bf16_f32 v105, v106, v107
    v_cvt_pk_bf16_f32 v106, v108, v109
    v_cvt_pk_bf16_f32 v107, v110, v111
    v_accvgpr_write_b32 a164, v104
    v_accvgpr_write_b32 a165, v105
    v_accvgpr_write_b32 a166, v106
    v_accvgpr_write_b32 a167, v107
    v_cvt_pk_bf16_f32 v112, v112, v113
    v_cvt_pk_bf16_f32 v113, v114, v115
    v_cvt_pk_bf16_f32 v114, v116, v117
    v_cvt_pk_bf16_f32 v115, v118, v119
    v_accvgpr_write_b32 a168, v112
    v_accvgpr_write_b32 a169, v113
    v_accvgpr_write_b32 a170, v114
    v_accvgpr_write_b32 a171, v115
    v_cvt_pk_bf16_f32 v120, v120, v121
    v_cvt_pk_bf16_f32 v121, v122, v123
    v_cvt_pk_bf16_f32 v122, v124, v125
    v_cvt_pk_bf16_f32 v123, v126, v127
    v_accvgpr_write_b32 a172, v120
    v_accvgpr_write_b32 a173, v121
    v_accvgpr_write_b32 a174, v122
    v_accvgpr_write_b32 a175, v123
    v_cvt_pk_bf16_f32 v128, v128, v129
    v_cvt_pk_bf16_f32 v129, v130, v131
    v_cvt_pk_bf16_f32 v130, v132, v133
    v_cvt_pk_bf16_f32 v131, v134, v135
    v_accvgpr_write_b32 a176, v128
    v_accvgpr_write_b32 a177, v129
    v_accvgpr_write_b32 a178, v130
    v_accvgpr_write_b32 a179, v131
    v_cvt_pk_bf16_f32 v136, v136, v137
    v_cvt_pk_bf16_f32 v137, v138, v139
    v_cvt_pk_bf16_f32 v138, v140, v141
    v_cvt_pk_bf16_f32 v139, v142, v143
    v_accvgpr_write_b32 a180, v136
    v_accvgpr_write_b32 a181, v137
    v_accvgpr_write_b32 a182, v138
    v_accvgpr_write_b32 a183, v139
    v_cvt_pk_bf16_f32 v144, v144, v145
    v_cvt_pk_bf16_f32 v145, v146, v147
    v_cvt_pk_bf16_f32 v146, v148, v149
    v_cvt_pk_bf16_f32 v147, v150, v151
    v_accvgpr_write_b32 a184, v144
    v_accvgpr_write_b32 a185, v145
    v_accvgpr_write_b32 a186, v146
    v_accvgpr_write_b32 a187, v147
    v_cvt_pk_bf16_f32 v152, v152, v153
    v_cvt_pk_bf16_f32 v153, v154, v155
    v_cvt_pk_bf16_f32 v154, v156, v157
    v_cvt_pk_bf16_f32 v155, v158, v159
    v_accvgpr_write_b32 a188, v152
    v_accvgpr_write_b32 a189, v153
    v_accvgpr_write_b32 a190, v154
    v_accvgpr_write_b32 a191, v155
    v_cvt_pk_bf16_f32 v160, v160, v161
    v_cvt_pk_bf16_f32 v161, v162, v163
    v_cvt_pk_bf16_f32 v162, v164, v165
    v_cvt_pk_bf16_f32 v163, v166, v167
    v_accvgpr_write_b32 a192, v160
    v_accvgpr_write_b32 a193, v161
    v_accvgpr_write_b32 a194, v162
    v_accvgpr_write_b32 a195, v163
    v_cvt_pk_bf16_f32 v168, v168, v169
    v_cvt_pk_bf16_f32 v169, v170, v171
    v_cvt_pk_bf16_f32 v170, v172, v173
    v_cvt_pk_bf16_f32 v171, v174, v175
    v_accvgpr_write_b32 a196, v168
    v_accvgpr_write_b32 a197, v169
    v_accvgpr_write_b32 a198, v170
    v_accvgpr_write_b32 a199, v171
    v_cvt_pk_bf16_f32 v176, v176, v177
    v_cvt_pk_bf16_f32 v177, v178, v179
    v_cvt_pk_bf16_f32 v178, v180, v181
    v_cvt_pk_bf16_f32 v179, v182, v183
    v_accvgpr_write_b32 a200, v176
    v_accvgpr_write_b32 a201, v177
    v_accvgpr_write_b32 a202, v178
    v_accvgpr_write_b32 a203, v179
    v_cvt_pk_bf16_f32 v184, v184, v185
    v_cvt_pk_bf16_f32 v185, v186, v187
    v_cvt_pk_bf16_f32 v186, v188, v189
    v_cvt_pk_bf16_f32 v187, v190, v191
    v_accvgpr_write_b32 a204, v184
    v_accvgpr_write_b32 a205, v185
    v_accvgpr_write_b32 a206, v186
    v_accvgpr_write_b32 a207, v187
    v_cvt_pk_bf16_f32 v192, v192, v193
    v_cvt_pk_bf16_f32 v193, v194, v195
    v_cvt_pk_bf16_f32 v194, v196, v197
    v_cvt_pk_bf16_f32 v195, v198, v199
    v_accvgpr_write_b32 a208, v192
    v_accvgpr_write_b32 a209, v193
    v_accvgpr_write_b32 a210, v194
    v_accvgpr_write_b32 a211, v195
    v_cvt_pk_bf16_f32 v200, v200, v201
    v_cvt_pk_bf16_f32 v201, v202, v203
    v_cvt_pk_bf16_f32 v202, v204, v205
    v_cvt_pk_bf16_f32 v203, v206, v207
    v_accvgpr_write_b32 a212, v200
    v_accvgpr_write_b32 a213, v201
    v_accvgpr_write_b32 a214, v202
    v_accvgpr_write_b32 a215, v203
    v_cvt_pk_bf16_f32 v208, v208, v209
    v_cvt_pk_bf16_f32 v209, v210, v211
    v_cvt_pk_bf16_f32 v210, v212, v213
    v_cvt_pk_bf16_f32 v211, v214, v215
    v_accvgpr_write_b32 a216, v208
    v_accvgpr_write_b32 a217, v209
    v_accvgpr_write_b32 a218, v210
    v_accvgpr_write_b32 a219, v211
    v_cvt_pk_bf16_f32 v216, v216, v217
    v_cvt_pk_bf16_f32 v217, v218, v219
    v_cvt_pk_bf16_f32 v218, v220, v221
    v_cvt_pk_bf16_f32 v219, v222, v223
    v_accvgpr_write_b32 a220, v216
    v_accvgpr_write_b32 a221, v217
    v_accvgpr_write_b32 a222, v218
    v_accvgpr_write_b32 a223, v219
    v_cvt_pk_bf16_f32 v224, v224, v225
    v_cvt_pk_bf16_f32 v225, v226, v227
    v_cvt_pk_bf16_f32 v226, v228, v229
    v_cvt_pk_bf16_f32 v227, v230, v231
    v_accvgpr_write_b32 a224, v224
    v_accvgpr_write_b32 a225, v225
    v_accvgpr_write_b32 a226, v226
    v_accvgpr_write_b32 a227, v227
    v_cvt_pk_bf16_f32 v232, v232, v233
    v_cvt_pk_bf16_f32 v233, v234, v235
    v_cvt_pk_bf16_f32 v234, v236, v237
    v_cvt_pk_bf16_f32 v235, v238, v239
    v_accvgpr_write_b32 a228, v232
    v_accvgpr_write_b32 a229, v233
    v_accvgpr_write_b32 a230, v234
    v_accvgpr_write_b32 a231, v235
    v_cvt_pk_bf16_f32 v240, v240, v241
    v_cvt_pk_bf16_f32 v241, v242, v243
    v_cvt_pk_bf16_f32 v242, v244, v245
    v_cvt_pk_bf16_f32 v243, v246, v247
    v_accvgpr_write_b32 a232, v240
    v_accvgpr_write_b32 a233, v241
    v_accvgpr_write_b32 a234, v242
    v_accvgpr_write_b32 a235, v243
    v_cvt_pk_bf16_f32 v248, v248, v249
    v_cvt_pk_bf16_f32 v249, v250, v251
    v_cvt_pk_bf16_f32 v250, v252, v253
    v_cvt_pk_bf16_f32 v251, v254, v255
    v_accvgpr_write_b32 a236, v248
    v_accvgpr_write_b32 a237, v249
    v_accvgpr_write_b32 a238, v250
    v_accvgpr_write_b32 a239, v251
    v_accvgpr_read_b32 v24, a96
    v_accvgpr_read_b32 v25, a97
    v_accvgpr_read_b32 v26, a98
    v_accvgpr_read_b32 v27, a99
    v_accvgpr_read_b32 v28, a100
    v_accvgpr_read_b32 v29, a101
    v_accvgpr_read_b32 v30, a102
    v_accvgpr_read_b32 v31, a103
    v_cvt_pk_bf16_f32 v24, v24, v25
    v_cvt_pk_bf16_f32 v25, v26, v27
    v_cvt_pk_bf16_f32 v26, v28, v29
    v_cvt_pk_bf16_f32 v27, v30, v31
    v_accvgpr_write_b32 a240, v24
    v_accvgpr_write_b32 a241, v25
    v_accvgpr_write_b32 a242, v26
    v_accvgpr_write_b32 a243, v27
    v_accvgpr_read_b32 v24, a104
    v_accvgpr_read_b32 v25, a105
    v_accvgpr_read_b32 v26, a106
    v_accvgpr_read_b32 v27, a107
    v_accvgpr_read_b32 v28, a108
    v_accvgpr_read_b32 v29, a109
    v_accvgpr_read_b32 v30, a110
    v_accvgpr_read_b32 v31, a111
    v_cvt_pk_bf16_f32 v24, v24, v25
    v_cvt_pk_bf16_f32 v25, v26, v27
    v_cvt_pk_bf16_f32 v26, v28, v29
    v_cvt_pk_bf16_f32 v27, v30, v31
    v_accvgpr_write_b32 a244, v24
    v_accvgpr_write_b32 a245, v25
    v_accvgpr_write_b32 a246, v26
    v_accvgpr_write_b32 a247, v27
    v_accvgpr_read_b32 v24, a112
    v_accvgpr_read_b32 v25, a113
    v_accvgpr_read_b32 v26, a114
    v_accvgpr_read_b32 v27, a115
    v_accvgpr_read_b32 v28, a116
    v_accvgpr_read_b32 v29, a117
    v_accvgpr_read_b32 v30, a118
    v_accvgpr_read_b32 v31, a119
    v_cvt_pk_bf16_f32 v24, v24, v25
    v_cvt_pk_bf16_f32 v25, v26, v27
    v_cvt_pk_bf16_f32 v26, v28, v29
    v_cvt_pk_bf16_f32 v27, v30, v31
    v_accvgpr_write_b32 a248, v24
    v_accvgpr_write_b32 a249, v25
    v_accvgpr_write_b32 a250, v26
    v_accvgpr_write_b32 a251, v27
    v_accvgpr_read_b32 v24, a120
    v_accvgpr_read_b32 v25, a121
    v_accvgpr_read_b32 v26, a122
    v_accvgpr_read_b32 v27, a123
    v_accvgpr_read_b32 v28, a124
    v_accvgpr_read_b32 v29, a125
    v_accvgpr_read_b32 v30, a126
    v_accvgpr_read_b32 v31, a127
    v_cvt_pk_bf16_f32 v24, v24, v25
    v_cvt_pk_bf16_f32 v25, v26, v27
    v_cvt_pk_bf16_f32 v26, v28, v29
    v_cvt_pk_bf16_f32 v27, v30, v31
    v_accvgpr_write_b32 a252, v24
    v_accvgpr_write_b32 a253, v25
    v_accvgpr_write_b32 a254, v26
    v_accvgpr_write_b32 a255, v27
    s_setpc_b64 s[20:21]
m_epf21:
    s_nop 7
    s_cmp_eq_u32 s97, 0
    s_cbranch_scc1 m_noscale60
    s_mov_b32 s91, s98
    s_mov_b32 s92, s97
    s_mov_b32 s93, s97
    s_mov_b32 s90, s91
    v_pk_mul_f32 v[32:33], v[32:33], s[92:93]
    v_pk_mul_f32 v[34:35], v[34:35], s[92:93]
    v_pk_mul_f32 v[36:37], v[36:37], s[92:93]
    v_pk_mul_f32 v[38:39], v[38:39], s[92:93]
    v_cvt_pk_bf16_f32 v32, v32, v33
    v_cvt_pk_bf16_f32 v33, v34, v35
    v_cvt_pk_bf16_f32 v34, v36, v37
    v_cvt_pk_bf16_f32 v35, v38, v39
    buffer_store_dwordx4 v[32:35], v2, s[8:11], s90 offen sc1
    s_add_u32 s90, s90, s100
    v_pk_mul_f32 v[40:41], v[40:41], s[92:93]
    v_pk_mul_f32 v[42:43], v[42:43], s[92:93]
    v_pk_mul_f32 v[44:45], v[44:45], s[92:93]
    v_pk_mul_f32 v[46:47], v[46:47], s[92:93]
    v_cvt_pk_bf16_f32 v40, v40, v41
    v_cvt_pk_bf16_f32 v41, v42, v43
    v_cvt_pk_bf16_f32 v42, v44, v45
    v_cvt_pk_bf16_f32 v43, v46, v47
    buffer_store_dwordx4 v[40:43], v2, s[8:11], s90 offen sc1
    s_add_u32 s90, s90, s100
    v_pk_mul_f32 v[48:49], v[48:49], s[92:93]
    v_pk_mul_f32 v[50:51], v[50:51], s[92:93]
    v_pk_mul_f32 v[52:53], v[52:53], s[92:93]
    v_pk_mul_f32 v[54:55], v[54:55], s[92:93]
    v_cvt_pk_bf16_f32 v48, v48, v49
    v_cvt_pk_bf16_f32 v49, v50, v51
    v_cvt_pk_bf16_f32 v50, v52, v53
    v_cvt_pk_bf16_f32 v51, v54, v55
    buffer_store_dwordx4 v[48:51], v2, s[8:11], s90 offen sc1
    s_add_u32 s90, s90, s100
    v_pk_mul_f32 v[56:57], v[56:57], s[92:93]
    v_pk_mul_f32 v[58:59], v[58:59], s[92:93]
    v_pk_mul_f32 v[60:61], v[60:61], s[92:93]
    v_pk_mul_f32 v[62:63], v[62:63], s[92:93]
    v_cvt_pk_bf16_f32 v56, v56, v57
    v_cvt_pk_bf16_f32 v57, v58, v59
    v_cvt_pk_bf16_f32 v58, v60, v61
    v_cvt_pk_bf16_f32 v59, v62, v63
    buffer_store_dwordx4 v[56:59], v2, s[8:11], s90 offen sc1
    s_add_u32 s90, s90, s100
    v_pk_mul_f32 v[64:65], v[64:65], s[92:93]
    v_pk_mul_f32 v[66:67], v[66:67], s[92:93]
    v_pk_mul_f32 v[68:69], v[68:69], s[92:93]
    v_pk_mul_f32 v[70:71], v[70:71], s[92:93]
    v_cvt_pk_bf16_f32 v64, v64, v65
    v_cvt_pk_bf16_f32 v65, v66, v67
    v_cvt_pk_bf16_f32 v66, v68, v69
    v_cvt_pk_bf16_f32 v67, v70, v71
    buffer_store_dwordx4 v[64:67], v2, s[8:11], s90 offen sc1
    s_add_u32 s90, s90, s100
    v_pk_mul_f32 v[72:73], v[72:73], s[92:93]
    v_pk_mul_f32 v[74:75], v[74:75], s[92:93]
    v_pk_mul_f32 v[76:77], v[76:77], s[92:93]
    v_pk_mul_f32 v[78:79], v[78:79], s[92:93]
    v_cvt_pk_bf16_f32 v72, v72, v73
    v_cvt_pk_bf16_f32 v73, v74, v75
    v_cvt_pk_bf16_f32 v74, v76, v77
    v_cvt_pk_bf16_f32 v75, v78, v79
    buffer_store_dwordx4 v[72:75], v2, s[8:11], s90 offen sc1
    s_add_u32 s90, s90, s100
    v_pk_mul_f32 v[80:81], v[80:81], s[92:93]
    v_pk_mul_f32 v[82:83], v[82:83], s[92:93]
    v_pk_mul_f32 v[84:85], v[84:85], s[92:93]
    v_pk_mul_f32 v[86:87], v[86:87], s[92:93]
    v_cvt_pk_bf16_f32 v80, v80, v81
    v_cvt_pk_bf16_f32 v81, v82, v83
    v_cvt_pk_bf16_f32 v82, v84, v85
    v_cvt_pk_bf16_f32 v83, v86, v87
    buffer_store_dwordx4 v[80:83], v2, s[8:11], s90 offen sc1
    s_add_u32 s90, s90, s100
    v_pk_mul_f32 v[88:89], v[88:89], s[92:93]
    v_pk_mul_f32 v[90:91], v[90:91], s[92:93]
    v_pk_mul_f32 v[92:93], v[92:93], s[92:93]
    v_pk_mul_f32 v[94:95], v[94:95], s[92:93]
    v_cvt_pk_bf16_f32 v88, v88, v89
    v_cvt_pk_bf16_f32 v89, v90, v91
    v_cvt_pk_bf16_f32 v90, v92, v93
    v_cvt_pk_bf16_f32 v91, v94, v95
    buffer_store_dwordx4 v[88:91], v2, s[8:11], s90 offen sc1
    s_add_u32 s90, s90, s100
    s_add_u32 s91, s91, s99
    s_mov_b32 s90, s91
    v_pk_mul_f32 v[96:97], v[96:97], s[92:93]
    v_pk_mul_f32 v[98:99], v[98:99], s[92:93]
    v_pk_mul_f32 v[100:101], v[100:101], s[92:93]
    v_pk_mul_f32 v[102:103], v[102:103], s[92:93]
    v_cvt_pk_bf16_f32 v96, v96, v97
    v_cvt_pk_bf16_f32 v97, v98, v99
    v_cvt_pk_bf16_f32 v98, v100, v101
    v_cvt_pk_bf16_f32 v99, v102, v103
    buffer_store_dwordx4 v[96:99], v2, s[8:11], s90 offen sc1
    s_add_u32 s90, s90, s100
    v_pk_mul_f32 v[104:105], v[104:105], s[92:93]
    v_pk_mul_f32 v[106:107], v[106:107], s[92:93]
    v_pk_mul_f32 v[108:109], v[108:109], s[92:93]
    v_pk_mul_f32 v[110:111], v[110:111], s[92:93]
    v_cvt_pk_bf16_f32 v104, v104, v105
    v_cvt_pk_bf16_f32 v105, v106, v107
    v_cvt_pk_bf16_f32 v106, v108, v109
    v_cvt_pk_bf16_f32 v107, v110, v111
    buffer_store_dwordx4 v[104:107], v2, s[8:11], s90 offen sc1
    s_add_u32 s90, s90, s100
    v_pk_mul_f32 v[112:113], v[112:113], s[92:93]
    v_pk_mul_f32 v[114:115], v[114:115], s[92:93]
    v_pk_mul_f32 v[116:117], v[116:117], s[92:93]
    v_pk_mul_f32 v[118:119], v[118:119], s[92:93]
    v_cvt_pk_bf16_f32 v112, v112, v113
    v_cvt_pk_bf16_f32 v113, v114, v115
    v_cvt_pk_bf16_f32 v114, v116, v117
    v_cvt_pk_bf16_f32 v115, v118, v119
    buffer_store_dwordx4 v[112:115], v2, s[8:11], s90 offen sc1
    s_add_u32 s90, s90, s100
    v_pk_mul_f32 v[120:121], v[120:121], s[92:93]
    v_pk_mul_f32 v[122:123], v[122:123], s[92:93]
    v_pk_mul_f32 v[124:125], v[124:125], s[92:93]
    v_pk_mul_f32 v[126:127], v[126:127], s[92:93]
    v_cvt_pk_bf16_f32 v120, v120, v121
    v_cvt_pk_bf16_f32 v121, v122, v123
    v_cvt_pk_bf16_f32 v122, v124, v125
    v_cvt_pk_bf16_f32 v123, v126, v127
    buffer_store_dwordx4 v[120:123], v2, s[8:11], s90 offen sc1
    s_add_u32 s90, s90, s100
    v_pk_mul_f32 v[128:129], v[128:129], s[92:93]
    v_pk_mul_f32 v[130:131], v[130:131], s[92:93]
    v_pk_mul_f32 v[132:133], v[132:133], s[92:93]
    v_pk_mul_f32 v[134:135], v[134:135], s[92:93]
    v_cvt_pk_bf16_f32 v128, v128, v129
    v_cvt_pk_bf16_f32 v129, v130, v131
    v_cvt_pk_bf16_f32 v130, v132, v133
    v_cvt_pk_bf16_f32 v131, v134, v135
    buffer_store_dwordx4 v[128:131], v2, s[8:11], s90 offen sc1
    s_add_u32 s90, s90, s100
    v_pk_mul_f32 v[136:137], v[136:137], s[92:93]
    v_pk_mul_f32 v[138:139], v[138:139], s[92:93]
    v_pk_mul_f32 v[140:141], v[140:141], s[92:93]
    v_pk_mul_f32 v[142:143], v[142:143], s[92:93]
    v_cvt_pk_bf16_f32 v136, v136, v137
    v_cvt_pk_bf16_f32 v137, v138, v139
    v_cvt_pk_bf16_f32 v138, v140, v141
    v_cvt_pk_bf16_f32 v139, v142, v143
    buffer_store_dwordx4 v[136:139], v2, s[8:11], s90 offen sc1
    s_add_u32 s90, s90, s100
    v_pk_mul_f32 v[144:145], v[144:145], s[92:93]
    v_pk_mul_f32 v[146:147], v[146:147], s[92:93]
    v_pk_mul_f32 v[148:149], v[148:149], s[92:93]
    v_pk_mul_f32 v[150:151], v[150:151], s[92:93]
    v_cvt_pk_bf16_f32 v144, v144, v145
    v_cvt_pk_bf16_f32 v145, v146, v147
    v_cvt_pk_bf16_f32 v146, v148, v149
    v_cvt_pk_bf16_f32 v147, v150, v151
    buffer_store_dwordx4 v[144:147], v2, s[8:11], s90 offen sc1
    s_add_u32 s90, s90, s100
    v_pk_mul_f32 v[152:153], v[152:153], s[92:93]
    v_pk_mul_f32 v[154:155], v[154:155], s[92:93]
    v_pk_mul_f32 v[156:157], v[156:157], s[92:93]
    v_pk_mul_f32 v[158:159], v[158:159], s[92:93]
    v_cvt_pk_bf16_f32 v152, v152, v153
    v_cvt_pk_bf16_f32 v153, v154, v155
    v_cvt_pk_bf16_f32 v154, v156, v157
    v_cvt_pk_bf16_f32 v155, v158, v159
    buffer_store_dwordx4 v[152:155], v2, s[8:11], s90 offen sc1
    s_add_u32 s90, s90, s100
    s_add_u32 s91, s91, s99
    s_mov_b32 s90, s91
    v_pk_mul_f32 v[160:161], v[160:161], s[92:93]
    v_pk_mul_f32 v[162:163], v[162:163], s[92:93]
    v_pk_mul_f32 v[164:165], v[164:165], s[92:93]
    v_pk_mul_f32 v[166:167], v[166:167], s[92:93]
    v_cvt_pk_bf16_f32 v160, v160, v161
    v_cvt_pk_bf16_f32 v161, v162, v163
    v_cvt_pk_bf16_f32 v162, v164, v165
    v_cvt_pk_bf16_f32 v163, v166, v167
    buffer_store_dwordx4 v[160:163], v2, s[8:11], s90 offen sc1
    s_add_u32 s90, s90, s100
    v_pk_mul_f32 v[168:169], v[168:169], s[92:93]
    v_pk_mul_f32 v[170:171], v[170:171], s[92:93]
    v_pk_mul_f32 v[172:173], v[172:173], s[92:93]
    v_pk_mul_f32 v[174:175], v[174:175], s[92:93]
    v_cvt_pk_bf16_f32 v168, v168, v169
    v_cvt_pk_bf16_f32 v169, v170, v171
    v_cvt_pk_bf16_f32 v170, v172, v173
    v_cvt_pk_bf16_f32 v171, v174, v175
    buffer_store_dwordx4 v[168:171], v2, s[8:11], s90 offen sc1
    s_add_u32 s90, s90, s100
    v_pk_mul_f32 v[176:177], v[176:177], s[92:93]
    v_pk_mul_f32 v[178:179], v[178:179], s[92:93]
    v_pk_mul_f32 v[180:181], v[180:181], s[92:93]
    v_pk_mul_f32 v[182:183], v[182:183], s[92:93]
    v_cvt_pk_bf16_f32 v176, v176, v177
    v_cvt_pk_bf16_f32 v177, v178, v179
    v_cvt_pk_bf16_f32 v178, v180, v181
    v_cvt_pk_bf16_f32 v179, v182, v183
    buffer_store_dwordx4 v[176:179], v2, s[8:11], s90 offen sc1
    s_add_u32 s90, s90, s100
    v_pk_mul_f32 v[184:185], v[184:185], s[92:93]
    v_pk_mul_f32 v[186:187], v[186:187], s[92:93]
    v_pk_mul_f32 v[188:189], v[188:189], s[92:93]
    v_pk_mul_f32 v[190:191], v[190:191], s[92:93]
    v_cvt_pk_bf16_f32 v184, v184, v185
    v_cvt_pk_bf16_f32 v185, v186, v187
    v_cvt_pk_bf16_f32 v186, v188, v189
    v_cvt_pk_bf16_f32 v187, v190, v191
    buffer_store_dwordx4 v[184:187], v2, s[8:11], s90 offen sc1
    s_add_u32 s90, s90, s100
    v_pk_mul_f32 v[192:193], v[192:193], s[92:93]
    v_pk_mul_f32 v[194:195], v[194:195], s[92:93]
    v_pk_mul_f32 v[196:197], v[196:197], s[92:93]
    v_pk_mul_f32 v[198:199], v[198:199], s[92:93]
    v_cvt_pk_bf16_f32 v192, v192, v193
    v_cvt_pk_bf16_f32 v193, v194, v195
    v_cvt_pk_bf16_f32 v194, v196, v197
    v_cvt_pk_bf16_f32 v195, v198, v199
    buffer_store_dwordx4 v[192:195], v2, s[8:11], s90 offen sc1
    s_add_u32 s90, s90, s100
    v_pk_mul_f32 v[200:201], v[200:201], s[92:93]
    v_pk_mul_f32 v[202:203], v[202:203], s[92:93]
    v_pk_mul_f32 v[204:205], v[204:205], s[92:93]
    v_pk_mul_f32 v[206:207], v[206:207], s[92:93]
    v_cvt_pk_bf16_f32 v200, v200, v201
    v_cvt_pk_bf16_f32 v201, v202, v203
    v_cvt_pk_bf16_f32 v202, v204, v205
    v_cvt_pk_bf16_f32 v203, v206, v207
    buffer_store_dwordx4 v[200:203], v2, s[8:11], s90 offen sc1
    s_add_u32 s90, s90, s100
    v_pk_mul_f32 v[208:209], v[208:209], s[92:93]
    v_pk_mul_f32 v[210:211], v[210:211], s[92:93]
    v_pk_mul_f32 v[212:213], v[212:213], s[92:93]
    v_pk_mul_f32 v[214:215], v[214:215], s[92:93]
    v_cvt_pk_bf16_f32 v208, v208, v209
    v_cvt_pk_bf16_f32 v209, v210, v211
    v_cvt_pk_bf16_f32 v210, v212, v213
    v_cvt_pk_bf16_f32 v211, v214, v215
    buffer_store_dwordx4 v[208:211], v2, s[8:11], s90 offen sc1
    s_add_u32 s90, s90, s100
    v_pk_mul_f32 v[216:217], v[216:217], s[92:93]
    v_pk_mul_f32 v[218:219], v[218:219], s[92:93]
    v_pk_mul_f32 v[220:221], v[220:221], s[92:93]
    v_pk_mul_f32 v[222:223], v[222:223], s[92:93]
    v_cvt_pk_bf16_f32 v216, v216, v217
    v_cvt_pk_bf16_f32 v217, v218, v219
    v_cvt_pk_bf16_f32 v218, v220, v221
    v_cvt_pk_bf16_f32 v219, v222, v223
    buffer_store_dwordx4 v[216:219], v2, s[8:11], s90 offen sc1
    s_add_u32 s90, s90, s100
    s_add_u32 s91, s91, s99
    s_mov_b32 s90, s91
    v_pk_mul_f32 v[224:225], v[224:225], s[92:93]
    v_pk_mul_f32 v[226:227], v[226:227], s[92:93]
    v_pk_mul_f32 v[228:229], v[228:229], s[92:93]
    v_pk_mul_f32 v[230:231], v[230:231], s[92:93]
    v_cvt_pk_bf16_f32 v224, v224, v225
    v_cvt_pk_bf16_f32 v225, v226, v227
    v_cvt_pk_bf16_f32 v226, v228, v229
    v_cvt_pk_bf16_f32 v227, v230, v231
    buffer_store_dwordx4 v[224:227], v2, s[8:11], s90 offen sc1
    s_add_u32 s90, s90, s100
    v_pk_mul_f32 v[232:233], v[232:233], s[92:93]
    v_pk_mul_f32 v[234:235], v[234:235], s[92:93]
    v_pk_mul_f32 v[236:237], v[236:237], s[92:93]
    v_pk_mul_f32 v[238:239], v[238:239], s[92:93]
    v_cvt_pk_bf16_f32 v232, v232, v233
    v_cvt_pk_bf16_f32 v233, v234, v235
    v_cvt_pk_bf16_f32 v234, v236, v237
    v_cvt_pk_bf16_f32 v235, v238, v239
    buffer_store_dwordx4 v[232:235], v2, s[8:11], s90 offen sc1
    s_add_u32 s90, s90, s100
    v_pk_mul_f32 v[240:241], v[240:241], s[92:93]
    v_pk_mul_f32 v[242:243], v[242:243], s[92:93]
    v_pk_mul_f32 v[244:245], v[244:245], s[92:93]
    v_pk_mul_f32 v[246:247], v[246:247], s[92:93]
    v_cvt_pk_bf16_f32 v240, v240, v241
    v_cvt_pk_bf16_f32 v241, v242, v243
    v_cvt_pk_bf16_f32 v242, v244, v245
    v_cvt_pk_bf16_f32 v243, v246, v247
    buffer_store_dwordx4 v[240:243], v2, s[8:11], s90 offen sc1
    s_add_u32 s90, s90, s100
    v_pk_mul_f32 v[248:249], v[248:249], s[92:93]
    v_pk_mul_f32 v[250:251], v[250:251], s[92:93]
    v_pk_mul_f32 v[252:253], v[252:253], s[92:93]
    v_pk_mul_f32 v[254:255], v[254:255], s[92:93]
    v_cvt_pk_bf16_f32 v248, v248, v249
    v_cvt_pk_bf16_f32 v249, v250, v251
    v_cvt_pk_bf16_f32 v250, v252, v253
    v_cvt_pk_bf16_f32 v251, v254, v255
    buffer_store_dwordx4 v[248:251], v2, s[8:11], s90 offen sc1
    s_add_u32 s90, s90, s100
    v_accvgpr_read_b32 v24, a96
    v_accvgpr_read_b32 v25, a97
    v_accvgpr_read_b32 v26, a98
    v_accvgpr_read_b32 v27, a99
    v_accvgpr_read_b32 v28, a100
    v_accvgpr_read_b32 v29, a101
    v_accvgpr_read_b32 v30, a102
    v_accvgpr_read_b32 v31, a103
    v_pk_mul_f32 v[24:25], v[24:25], s[92:93]
    v_pk_mul_f32 v[26:27], v[26:27], s[92:93]
    v_pk_mul_f32 v[28:29], v[28:29], s[92:93]
    v_pk_mul_f32 v[30:31], v[30:31], s[92:93]
    v_cvt_pk_bf16_f32 v24, v24, v25
    v_cvt_pk_bf16_f32 v25, v26, v27
    v_cvt_pk_bf16_f32 v26, v28, v29
    v_cvt_pk_bf16_f32 v27, v30, v31
    buffer_store_dwordx4 v[24:27], v2, s[8:11], s90 offen sc1
    s_add_u32 s90, s90, s100
    s_nop 1
    v_accvgpr_read_b32 v24, a104
    v_accvgpr_read_b32 v25, a105
    v_accvgpr_read_b32 v26, a106
    v_accvgpr_read_b32 v27, a107
    v_accvgpr_read_b32 v28, a108
    v_accvgpr_read_b32 v29, a109
    v_accvgpr_read_b32 v30, a110
    v_accvgpr_read_b32 v31, a111
    v_pk_mul_f32 v[24:25], v[24:25], s[92:93]
    v_pk_mul_f32 v[26:27], v[26:27], s[92:93]
    v_pk_mul_f32 v[28:29], v[28:29], s[92:93]
    v_pk_mul_f32 v[30:31], v[30:31], s[92:93]
    v_cvt_pk_bf16_f32 v24, v24, v25
    v_cvt_pk_bf16_f32 v25, v26, v27
    v_cvt_pk_bf16_f32 v26, v28, v29
    v_cvt_pk_bf16_f32 v27, v30, v31
    buffer_store_dwordx4 v[24:27], v2, s[8:11], s90 offen sc1
    s_add_u32 s90, s90, s100
    s_nop 1
    v_accvgpr_read_b32 v24, a112
    v_accvgpr_read_b32 v25, a113
    v_accvgpr_read_b32 v26, a114
    v_accvgpr_read_b32 v27, a115
    v_accvgpr_read_b32 v28, a116
    v_accvgpr_read_b32 v29, a117
    v_accvgpr_read_b32 v30, a118
    v_accvgpr_read_b32 v31, a119
    v_pk_mul_f32 v[24:25], v[24:25], s[92:93]
    v_pk_mul_f32 v[26:27], v[26:27], s[92:93]
    v_pk_mul_f32 v[28:29], v[28:29], s[92:93]
    v_pk_mul_f32 v[30:31], v[30:31], s[92:93]
    v_cvt_pk_bf16_f32 v24, v24, v25
    v_cvt_pk_bf16_f32 v25, v26, v27
    v_cvt_pk_bf16_f32 v26, v28, v29
    v_cvt_pk_bf16_f32 v27, v30, v31
    buffer_store_dwordx4 v[24:27], v2, s[8:11], s90 offen sc1
    s_add_u32 s90, s90, s100
    s_nop 1
    v_accvgpr_read_b32 v24, a120
    v_accvgpr_read_b32 v25, a121
    v_accvgpr_read_b32 v26, a122
    v_accvgpr_read_b32 v27, a123
    v_accvgpr_read_b32 v28, a124
    v_accvgpr_read_b32 v29, a125
    v_accvgpr_read_b32 v30, a126
    v_accvgpr_read_b32 v31, a127
    v_pk_mul_f32 v[24:25], v[24:25], s[92:93]
    v_pk_mul_f32 v[26:27], v[26:27], s[92:93]
    v_pk_mul_f32 v[28:29], v[28:29], s[92:93]
    v_pk_mul_f32 v[30:31], v[30:31], s[92:93]
    v_cvt_pk_bf16_f32 v24, v24, v25
    v_cvt_pk_bf16_f32 v25, v26, v27
    v_cvt_pk_bf16_f32 v26, v28, v29
    v_cvt_pk_bf16_f32 v27, v30, v31
    buffer_store_dwordx4 v[24:27], v2, s[8:11], s90 offen sc1
    s_add_u32 s90, s90, s100
    s_nop 1
    s_add_u32 s91, s91, s99
    s_setpc_b64 s[20:21]
m_noscale60:
    s_mov_b32 s91, s98
    s_mov_b32 s92, s97
    s_mov_b32 s93, s97
    s_mov_b32 s90, s91
    v_cvt_pk_bf16_f32 v32, v32, v33
    v_cvt_pk_bf16_f32 v33, v34, v35
    v_cvt_pk_bf16_f32 v34, v36, v37
    v_cvt_pk_bf16_f32 v35, v38, v39
    buffer_store_dwordx4 v[32:35], v2, s[8:11], s90 offen sc1
    s_add_u32 s90, s90, s100
    v_cvt_pk_bf16_f32 v40, v40, v41
    v_cvt_pk_bf16_f32 v41, v42, v43
    v_cvt_pk_bf16_f32 v42, v44, v45
    v_cvt_pk_bf16_f32 v43, v46, v47
    buffer_store_dwordx4 v[40:43], v2, s[8:11], s90 offen sc1
    s_add_u32 s90, s90, s100
    v_cvt_pk_bf16_f32 v48, v48, v49
    v_cvt_pk_bf16_f32 v49, v50, v51
    v_cvt_pk_bf16_f32 v50, v52, v53
    v_cvt_pk_bf16_f32 v51, v54, v55
    buffer_store_dwordx4 v[48:51], v2, s[8:11], s90 offen sc1
    s_add_u32 s90, s90, s100
    v_cvt_pk_bf16_f32 v56, v56, v57
    v_cvt_pk_bf16_f32 v57, v58, v59
    v_cvt_pk_bf16_f32 v58, v60, v61
    v_cvt_pk_bf16_f32 v59, v62, v63
    buffer_store_dwordx4 v[56:59], v2, s[8:11], s90 offen sc1
    s_add_u32 s90, s90, s100
    v_cvt_pk_bf16_f32 v64, v64, v65
    v_cvt_pk_bf16_f32 v65, v66, v67
    v_cvt_pk_bf16_f32 v66, v68, v69
    v_cvt_pk_bf16_f32 v67, v70, v71
    buffer_store_dwordx4 v[64:67], v2, s[8:11], s90 offen sc1
    s_add_u32 s90, s90, s100
    v_cvt_pk_bf16_f32 v72, v72, v73
    v_cvt_pk_bf16_f32 v73, v74, v75
    v_cvt_pk_bf16_f32 v74, v76, v77
    v_cvt_pk_bf16_f32 v75, v78, v79
    buffer_store_dwordx4 v[72:75], v2, s[8:11], s90 offen sc1
    s_add_u32 s90, s90, s100
    v_cvt_pk_bf16_f32 v80, v80, v81
    v_cvt_pk_bf16_f32 v81, v82, v83
    v_cvt_pk_bf16_f32 v82, v84, v85
    v_cvt_pk_bf16_f32 v83, v86, v87
    buffer_store_dwordx4 v[80:83], v2, s[8:11], s90 offen sc1
    s_add_u32 s90, s90, s100
    v_cvt_pk_bf16_f32 v88, v88, v89
    v_cvt_pk_bf16_f32 v89, v90, v91
    v_cvt_pk_bf16_f32 v90, v92, v93
    v_cvt_pk_bf16_f32 v91, v94, v95
    buffer_store_dwordx4 v[88:91], v2, s[8:11], s90 offen sc1
    s_add_u32 s90, s90, s100
    s_add_u32 s91, s91, s99
    s_mov_b32 s90, s91
    v_cvt_pk_bf16_f32 v96, v96, v97
    v_cvt_pk_bf16_f32 v97, v98, v99
    v_cvt_pk_bf16_f32 v98, v100, v101
    v_cvt_pk_bf16_f32 v99, v102, v103
    buffer_store_dwordx4 v[96:99], v2, s[8:11], s90 offen sc1
    s_add_u32 s90, s90, s100
    v_cvt_pk_bf16_f32 v104, v104, v105
    v_cvt_pk_bf16_f32 v105, v106, v107
    v_cvt_pk_bf16_f32 v106, v108, v109
    v_cvt_pk_bf16_f32 v107, v110, v111
    buffer_store_dwordx4 v[104:107], v2, s[8:11], s90 offen sc1
    s_add_u32 s90, s90, s100
    v_cvt_pk_bf16_f32 v112, v112, v113
    v_cvt_pk_bf16_f32 v113, v114, v115
    v_cvt_pk_bf16_f32 v114, v116, v117
    v_cvt_pk_bf16_f32 v115, v118, v119
    buffer_store_dwordx4 v[112:115], v2, s[8:11], s90 offen sc1
    s_add_u32 s90, s90, s100
    v_cvt_pk_bf16_f32 v120, v120, v121
    v_cvt_pk_bf16_f32 v121, v122, v123
    v_cvt_pk_bf16_f32 v122, v124, v125
    v_cvt_pk_bf16_f32 v123, v126, v127
    buffer_store_dwordx4 v[120:123], v2, s[8:11], s90 offen sc1
    s_add_u32 s90, s90, s100
    v_cvt_pk_bf16_f32 v128, v128, v129
    v_cvt_pk_bf16_f32 v129, v130, v131
    v_cvt_pk_bf16_f32 v130, v132, v133
    v_cvt_pk_bf16_f32 v131, v134, v135
    buffer_store_dwordx4 v[128:131], v2, s[8:11], s90 offen sc1
    s_add_u32 s90, s90, s100
    v_cvt_pk_bf16_f32 v136, v136, v137
    v_cvt_pk_bf16_f32 v137, v138, v139
    v_cvt_pk_bf16_f32 v138, v140, v141
    v_cvt_pk_bf16_f32 v139, v142, v143
    buffer_store_dwordx4 v[136:139], v2, s[8:11], s90 offen sc1
    s_add_u32 s90, s90, s100
    v_cvt_pk_bf16_f32 v144, v144, v145
    v_cvt_pk_bf16_f32 v145, v146, v147
    v_cvt_pk_bf16_f32 v146, v148, v149
    v_cvt_pk_bf16_f32 v147, v150, v151
    buffer_store_dwordx4 v[144:147], v2, s[8:11], s90 offen sc1
    s_add_u32 s90, s90, s100
    v_cvt_pk_bf16_f32 v152, v152, v153
    v_cvt_pk_bf16_f32 v153, v154, v155
    v_cvt_pk_bf16_f32 v154, v156, v157
    v_cvt_pk_bf16_f32 v155, v158, v159
    buffer_store_dwordx4 v[152:155], v2, s[8:11], s90 offen sc1
    s_add_u32 s90, s90, s100
    s_add_u32 s91, s91, s99
    s_mov_b32 s90, s91
    v_cvt_pk_bf16_f32 v160, v160, v161
    v_cvt_pk_bf16_f32 v161, v162, v163
    v_cvt_pk_bf16_f32 v162, v164, v165
    v_cvt_pk_bf16_f32 v163, v166, v167
    buffer_store_dwordx4 v[160:163], v2, s[8:11], s90 offen sc1
    s_add_u32 s90, s90, s100
    v_cvt_pk_bf16_f32 v168, v168, v169
    v_cvt_pk_bf16_f32 v169, v170, v171
    v_cvt_pk_bf16_f32 v170, v172, v173
    v_cvt_pk_bf16_f32 v171, v174, v175
    buffer_store_dwordx4 v[168:171], v2, s[8:11], s90 offen sc1
    s_add_u32 s90, s90, s100
    v_cvt_pk_bf16_f32 v176, v176, v177
    v_cvt_pk_bf16_f32 v177, v178, v179
    v_cvt_pk_bf16_f32 v178, v180, v181
    v_cvt_pk_bf16_f32 v179, v182, v183
    buffer_store_dwordx4 v[176:179], v2, s[8:11], s90 offen sc1
    s_add_u32 s90, s90, s100
    v_cvt_pk_bf16_f32 v184, v184, v185
    v_cvt_pk_bf16_f32 v185, v186, v187
    v_cvt_pk_bf16_f32 v186, v188, v189
    v_cvt_pk_bf16_f32 v187, v190, v191
    buffer_store_dwordx4 v[184:187], v2, s[8:11], s90 offen sc1
    s_add_u32 s90, s90, s100
    v_cvt_pk_bf16_f32 v192, v192, v193
    v_cvt_pk_bf16_f32 v193, v194, v195
    v_cvt_pk_bf16_f32 v194, v196, v197
    v_cvt_pk_bf16_f32 v195, v198, v199
    buffer_store_dwordx4 v[192:195], v2, s[8:11], s90 offen sc1
    s_add_u32 s90, s90, s100
    v_cvt_pk_bf16_f32 v200, v200, v201
    v_cvt_pk_bf16_f32 v201, v202, v203
    v_cvt_pk_bf16_f32 v202, v204, v205
    v_cvt_pk_bf16_f32 v203, v206, v207
    buffer_store_dwordx4 v[200:203], v2, s[8:11], s90 offen sc1
    s_add_u32 s90, s90, s100
    v_cvt_pk_bf16_f32 v208, v208, v209
    v_cvt_pk_bf16_f32 v209, v210, v211
    v_cvt_pk_bf16_f32 v210, v212, v213
    v_cvt_pk_bf16_f32 v211, v214, v215
    buffer_store_dwordx4 v[208:211], v2, s[8:11], s90 offen sc1
    s_add_u32 s90, s90, s100
    v_cvt_pk_bf16_f32 v216, v216, v217
    v_cvt_pk_bf16_f32 v217, v218, v219
    v_cvt_pk_bf16_f32 v218, v220, v221
    v_cvt_pk_bf16_f32 v219, v222, v223
    buffer_store_dwordx4 v[216:219], v2, s[8:11], s90 offen sc1
    s_add_u32 s90, s90, s100
    s_add_u32 s91, s91, s99
    s_mov_b32 s90, s91
    v_cvt_pk_bf16_f32 v224, v224, v225
    v_cvt_pk_bf16_f32 v225, v226, v227
    v_cvt_pk_bf16_f32 v226, v228, v229
    v_cvt_pk_bf16_f32 v227, v230, v231
    buffer_store_dwordx4 v[224:227], v2, s[8:11], s90 offen sc1
    s_add_u32 s90, s90, s100
    v_cvt_pk_bf16_f32 v232, v232, v233
    v_cvt_pk_bf16_f32 v233, v234, v235
    v_cvt_pk_bf16_f32 v234, v236, v237
    v_cvt_pk_bf16_f32 v235, v238, v239
    buffer_store_dwordx4 v[232:235], v2, s[8:11], s90 offen sc1
    s_add_u32 s90, s90, s100
    v_cvt_pk_bf16_f32 v240, v240, v241
    v_cvt_pk_bf16_f32 v241, v242, v243
    v_cvt_pk_bf16_f32 v242, v244, v245
    v_cvt_pk_bf16_f32 v243, v246, v247
    buffer_store_dwordx4 v[240:243], v2, s[8:11], s90 offen sc1
    s_add_u32 s90, s90, s100
    v_cvt_pk_bf16_f32 v248, v248, v249
    v_cvt_pk_bf16_f32 v249, v250, v251
    v_cvt_pk_bf16_f32 v250, v252, v253
    v_cvt_pk_bf16_f32 v251, v254, v255
    buffer_store_dwordx4 v[248:251], v2, s[8:11], s90 offen sc1
    s_add_u32 s90, s90, s100
    v_accvgpr_read_b32 v24, a96
    v_accvgpr_read_b32 v25, a97
    v_accvgpr_read_b32 v26, a98
    v_accvgpr_read_b32 v27, a99
    v_accvgpr_read_b32 v28, a100
    v_accvgpr_read_b32 v29, a101
    v_accvgpr_read_b32 v30, a102
    v_accvgpr_read_b32 v31, a103
    v_cvt_pk_bf16_f32 v24, v24, v25
    v_cvt_pk_bf16_f32 v25, v26, v27
    v_cvt_pk_bf16_f32 v26, v28, v29
    v_cvt_pk_bf16_f32 v27, v30, v31
    buffer_store_dwordx4 v[24:27], v2, s[8:11], s90 offen sc1
    s_add_u32 s90, s90, s100
    s_nop 1
    v_accvgpr_read_b32 v24, a104
    v_accvgpr_read_b32 v25, a105
    v_accvgpr_read_b32 v26, a106
    v_accvgpr_read_b32 v27, a107
    v_accvgpr_read_b32 v28, a108
    v_accvgpr_read_b32 v29, a109
    v_accvgpr_read_b32 v30, a110
    v_accvgpr_read_b32 v31, a111
    v_cvt_pk_bf16_f32 v24, v24, v25
    v_cvt_pk_bf16_f32 v25, v26, v27
    v_cvt_pk_bf16_f32 v26, v28, v29
    v_cvt_pk_bf16_f32 v27, v30, v31
    buffer_store_dwordx4 v[24:27], v2, s[8:11], s90 offen sc1
    s_add_u32 s90, s90, s100
    s_nop 1
    v_accvgpr_read_b32 v24, a112
    v_accvgpr_read_b32 v25, a113
    v_accvgpr_read_b32 v26, a114
    v_accvgpr_read_b32 v27, a115
    v_accvgpr_read_b32 v28, a116
    v_accvgpr_read_b32 v29, a117
    v_accvgpr_read_b32 v30, a118
    v_accvgpr_read_b32 v31, a119
    v_cvt_pk_bf16_f32 v24, v24, v25
    v_cvt_pk_bf16_f32 v25, v26, v27
    v_cvt_pk_bf16_f32 v26, v28, v29
    v_cvt_pk_bf16_f32 v27, v30, v31
    buffer_store_dwordx4 v[24:27], v2, s[8:11], s90 offen sc1
    s_add_u32 s90, s90, s100
    s_nop 1
    v_accvgpr_read_b32 v24, a120
    v_accvgpr_read_b32 v25, a121
    v_accvgpr_read_b32 v26, a122
    v_accvgpr_read_b32 v27, a123
    v_accvgpr_read_b32 v28, a124
    v_accvgpr_read_b32 v29, a125
    v_accvgpr_read_b32 v30, a126
    v_accvgpr_read_b32 v31, a127
    v_cvt_pk_bf16_f32 v24, v24, v25
    v_cvt_pk_bf16_f32 v25, v26, v27
    v_cvt_pk_bf16_f32 v26, v28, v29
    v_cvt_pk_bf16_f32 v27, v30, v31
    buffer_store_dwordx4 v[24:27], v2, s[8:11], s90 offen sc1
    s_add_u32 s90, s90, s100
    s_nop 1
    s_add_u32 s91, s91, s99
    s_setpc_b64 s[20:21]
m_epl61:
    s_mov_b32 s92, s97
    s_mov_b32 s93, s97
    s_cmp_eq_u32 s97, 0
    s_cbranch_scc1 m_ns262
    s_mov_b32 s90, s98
    v_pk_mul_f32 v[32:33], v[32:33], s[92:93]
    v_pk_mul_f32 v[34:35], v[34:35], s[92:93]
    v_pk_mul_f32 v[36:37], v[36:37], s[92:93]
    v_pk_mul_f32 v[38:39], v[38:39], s[92:93]
    v_cvt_pk_bf16_f32 v32, v32, v33
    v_cvt_pk_bf16_f32 v33, v34, v35
    v_cvt_pk_bf16_f32 v34, v36, v37
    v_cvt_pk_bf16_f32 v35, v38, v39
    buffer_store_dwordx4 v[32:35], v2, s[8:11], s90 offen sc1
    s_add_u32 s90, s90, s100
    v_pk_mul_f32 v[40:41], v[40:41], s[92:93]
    v_pk_mul_f32 v[42:43], v[42:43], s[92:93]
    v_pk_mul_f32 v[44:45], v[44:45], s[92:93]
    v_pk_mul_f32 v[46:47], v[46:47], s[92:93]
    v_cvt_pk_bf16_f32 v40, v40, v41
    v_cvt_pk_bf16_f32 v41, v42, v43
    v_cvt_pk_bf16_f32 v42, v44, v45
    v_cvt_pk_bf16_f32 v43, v46, v47
    buffer_store_dwordx4 v[40:43], v2, s[8:11], s90 offen sc1
    s_add_u32 s90, s90, s100
    v_pk_mul_f32 v[48:49], v[48:49], s[92:93]
    v_pk_mul_f32 v[50:51], v[50:51], s[92:93]
    v_pk_mul_f32 v[52:53], v[52:53], s[92:93]
    v_pk_mul_f32 v[54:55], v[54:55], s[92:93]
    v_cvt_pk_bf16_f32 v48, v48, v49
    v_cvt_pk_bf16_f32 v49, v50, v51
    v_cvt_pk_bf16_f32 v50, v52, v53
    v_cvt_pk_bf16_f32 v51, v54, v55
    buffer_store_dwordx4 v[48:51], v2, s[8:11], s90 offen sc1
    s_add_u32 s90, s90, s100
    v_pk_mul_f32 v[56:57], v[56:57], s[92:93]
    v_pk_mul_f32 v[58:59], v[58:59], s[92:93]
    v_pk_mul_f32 v[60:61], v[60:61], s[92:93]
    v_pk_mul_f32 v[62:63], v[62:63], s[92:93]
    v_cvt_pk_bf16_f32 v56, v56, v57
    v_cvt_pk_bf16_f32 v57, v58, v59
    v_cvt_pk_bf16_f32 v58, v60, v61
    v_cvt_pk_bf16_f32 v59, v62, v63
    buffer_store_dwordx4 v[56:59], v2, s[8:11], s90 offen sc1
    s_add_u32 s90, s90, s100
    v_pk_mul_f32 v[64:65], v[64:65], s[92:93]
    v_pk_mul_f32 v[66:67], v[66:67], s[92:93]
    v_pk_mul_f32 v[68:69], v[68:69], s[92:93]
    v_pk_mul_f32 v[70:71], v[70:71], s[92:93]
    v_cvt_pk_bf16_f32 v64, v64, v65
    v_cvt_pk_bf16_f32 v65, v66, v67
    v_cvt_pk_bf16_f32 v66, v68, v69
    v_cvt_pk_bf16_f32 v67, v70, v71
    buffer_store_dwordx4 v[64:67], v2, s[8:11], s90 offen sc1
    s_add_u32 s90, s90, s100
    v_pk_mul_f32 v[72:73], v[72:73], s[92:93]
    v_pk_mul_f32 v[74:75], v[74:75], s[92:93]
    v_pk_mul_f32 v[76:77], v[76:77], s[92:93]
    v_pk_mul_f32 v[78:79], v[78:79], s[92:93]
    v_cvt_pk_bf16_f32 v72, v72, v73
    v_cvt_pk_bf16_f32 v73, v74, v75
    v_cvt_pk_bf16_f32 v74, v76, v77
    v_cvt_pk_bf16_f32 v75, v78, v79
    buffer_store_dwordx4 v[72:75], v2, s[8:11], s90 offen sc1
    s_add_u32 s90, s90, s100
    v_pk_mul_f32 v[80:81], v[80:81], s[92:93]
    v_pk_mul_f32 v[82:83], v[82:83], s[92:93]
    v_pk_mul_f32 v[84:85], v[84:85], s[92:93]
    v_pk_mul_f32 v[86:87], v[86:87], s[92:93]
    v_cvt_pk_bf16_f32 v80, v80, v81
    v_cvt_pk_bf16_f32 v81, v82, v83
    v_cvt_pk_bf16_f32 v82, v84, v85
    v_cvt_pk_bf16_f32 v83, v86, v87
    buffer_store_dwordx4 v[80:83], v2, s[8:11], s90 offen sc1
    s_add_u32 s90, s90, s100
    v_pk_mul_f32 v[88:89], v[88:89], s[92:93]
    v_pk_mul_f32 v[90:91], v[90:91], s[92:93]
    v_pk_mul_f32 v[92:93], v[92:93], s[92:93]
    v_pk_mul_f32 v[94:95], v[94:95], s[92:93]
    v_cvt_pk_bf16_f32 v88, v88, v89
    v_cvt_pk_bf16_f32 v89, v90, v91
    v_cvt_pk_bf16_f32 v90, v92, v93
    v_cvt_pk_bf16_f32 v91, v94, v95
    buffer_store_dwordx4 v[88:91], v2, s[8:11], s90 offen sc1
    s_add_u32 s90, s98, s99
    v_pk_mul_f32 v[96:97], v[96:97], s[92:93]
    v_pk_mul_f32 v[98:99], v[98:99], s[92:93]
    v_pk_mul_f32 v[100:101], v[100:101], s[92:93]
    v_pk_mul_f32 v[102:103], v[102:103], s[92:93]
    v_cvt_pk_bf16_f32 v96, v96, v97
    v_cvt_pk_bf16_f32 v97, v98, v99
    v_cvt_pk_bf16_f32 v98, v100, v101
    v_cvt_pk_bf16_f32 v99, v102, v103
    buffer_store_dwordx4 v[96:99], v2, s[8:11], s90 offen sc1
    s_add_u32 s90, s90, s100
    v_pk_mul_f32 v[104:105], v[104:105], s[92:93]
    v_pk_mul_f32 v[106:107], v[106:107], s[92:93]
    v_pk_mul_f32 v[108:109], v[108:109], s[92:93]
    v_pk_mul_f32 v[110:111], v[110:111], s[92:93]
    v_cvt_pk_bf16_f32 v104, v104, v105
    v_cvt_pk_bf16_f32 v105, v106, v107
    v_cvt_pk_bf16_f32 v106, v108, v109
    v_cvt_pk_bf16_f32 v107, v110, v111
    buffer_store_dwordx4 v[104:107], v2, s[8:11], s90 offen sc1
    s_add_u32 s90, s90, s100
    v_pk_mul_f32 v[112:113], v[112:113], s[92:93]
    v_pk_mul_f32 v[114:115], v[114:115], s[92:93]
    v_pk_mul_f32 v[116:117], v[116:117], s[92:93]
    v_pk_mul_f32 v[118:119], v[118:119], s[92:93]
    v_cvt_pk_bf16_f32 v112, v112, v113
    v_cvt_pk_bf16_f32 v113, v114, v115
    v_cvt_pk_bf16_f32 v114, v116, v117
    v_cvt_pk_bf16_f32 v115, v118, v119
    buffer_store_dwordx4 v[112:115], v2, s[8:11], s90 offen sc1
    s_add_u32 s90, s90, s100
    v_pk_mul_f32 v[120:121], v[120:121], s[92:93]
    v_pk_mul_f32 v[122:123], v[122:123], s[92:93]
    v_pk_mul_f32 v[124:125], v[124:125], s[92:93]
    v_pk_mul_f32 v[126:127], v[126:127], s[92:93]
    v_cvt_pk_bf16_f32 v120, v120, v121
    v_cvt_pk_bf16_f32 v121, v122, v123
    v_cvt_pk_bf16_f32 v122, v124, v125
    v_cvt_pk_bf16_f32 v123, v126, v127
    buffer_store_dwordx4 v[120:123], v2, s[8:11], s90 offen sc1
    s_add_u32 s90, s90, s100
    v_pk_mul_f32 v[128:129], v[128:129], s[92:93]
    v_pk_mul_f32 v[130:131], v[130:131], s[92:93]
    v_pk_mul_f32 v[132:133], v[132:133], s[92:93]
    v_pk_mul_f32 v[134:135], v[134:135], s[92:93]
    v_cvt_pk_bf16_f32 v128, v128, v129
    v_cvt_pk_bf16_f32 v129, v130, v131
    v_cvt_pk_bf16_f32 v130, v132, v133
    v_cvt_pk_bf16_f32 v131, v134, v135
    buffer_store_dwordx4 v[128:131], v2, s[8:11], s90 offen sc1
    s_add_u32 s90, s90, s100
    v_pk_mul_f32 v[136:137], v[136:137], s[92:93]
    v_pk_mul_f32 v[138:139], v[138:139], s[92:93]
    v_pk_mul_f32 v[140:141], v[140:141], s[92:93]
    v_pk_mul_f32 v[142:143], v[142:143], s[92:93]
    v_cvt_pk_bf16_f32 v136, v136, v137
    v_cvt_pk_bf16_f32 v137, v138, v139
    v_cvt_pk_bf16_f32 v138, v140, v141
    v_cvt_pk_bf16_f32 v139, v142, v143
    buffer_store_dwordx4 v[136:139], v2, s[8:11], s90 offen sc1
    s_add_u32 s90, s90, s100
    v_pk_mul_f32 v[144:145], v[144:145], s[92:93]
    v_pk_mul_f32 v[146:147], v[146:147], s[92:93]
    v_pk_mul_f32 v[148:149], v[148:149], s[92:93]
    v_pk_mul_f32 v[150:151], v[150:151], s[92:93]
    v_cvt_pk_bf16_f32 v144, v144, v145
    v_cvt_pk_bf16_f32 v145, v146, v147
    v_cvt_pk_bf16_f32 v146, v148, v149
    v_cvt_pk_bf16_f32 v147, v150, v151
    buffer_store_dwordx4 v[144:147], v2, s[8:11], s90 offen sc1
    s_add_u32 s90, s90, s100
    v_pk_mul_f32 v[152:153], v[152:153], s[92:93]
    v_pk_mul_f32 v[154:155], v[154:155], s[92:93]
    v_pk_mul_f32 v[156:157], v[156:157], s[92:93]
    v_pk_mul_f32 v[158:159], v[158:159], s[92:93]
    v_cvt_pk_bf16_f32 v152, v152, v153
    v_cvt_pk_bf16_f32 v153, v154, v155
    v_cvt_pk_bf16_f32 v154, v156, v157
    v_cvt_pk_bf16_f32 v155, v158, v159
    buffer_store_dwordx4 v[152:155], v2, s[8:11], s90 offen sc1
    s_add_u32 s90, s90, s100
    v_pk_mul_f32 v[192:193], v[192:193], s[92:93]
    v_pk_mul_f32 v[194:195], v[194:195], s[92:93]
    v_pk_mul_f32 v[196:197], v[196:197], s[92:93]
    v_pk_mul_f32 v[198:199], v[198:199], s[92:93]
    v_cvt_pk_bf16_f32 v192, v192, v193
    v_cvt_pk_bf16_f32 v193, v194, v195
    v_cvt_pk_bf16_f32 v194, v196, v197
    v_cvt_pk_bf16_f32 v195, v198, v199
    v_pk_mul_f32 v[200:201], v[200:201], s[92:93]
    v_pk_mul_f32 v[202:203], v[202:203], s[92:93]
    v_pk_mul_f32 v[204:205], v[204:205], s[92:93]
    v_pk_mul_f32 v[206:207], v[206:207], s[92:93]
    v_cvt_pk_bf16_f32 v196, v200, v201
    v_cvt_pk_bf16_f32 v197, v202, v203
    v_cvt_pk_bf16_f32 v198, v204, v205
    v_cvt_pk_bf16_f32 v199, v206, v207
    v_pk_mul_f32 v[208:209], v[208:209], s[92:93]
    v_pk_mul_f32 v[210:211], v[210:211], s[92:93]
    v_pk_mul_f32 v[212:213], v[212:213], s[92:93]
    v_pk_mul_f32 v[214:215], v[214:215], s[92:93]
    v_cvt_pk_bf16_f32 v200, v208, v209
    v_cvt_pk_bf16_f32 v201, v210, v211
    v_cvt_pk_bf16_f32 v202, v212, v213
    v_cvt_pk_bf16_f32 v203, v214, v215
    v_pk_mul_f32 v[216:217], v[216:217], s[92:93]
    v_pk_mul_f32 v[218:219], v[218:219], s[92:93]
    v_pk_mul_f32 v[220:221], v[220:221], s[92:93]
    v_pk_mul_f32 v[222:223], v[222:223], s[92:93]
    v_cvt_pk_bf16_f32 v204, v216, v217
    v_cvt_pk_bf16_f32 v205, v218, v219
    v_cvt_pk_bf16_f32 v206, v220, v221
    v_cvt_pk_bf16_f32 v207, v222, v223
    v_pk_mul_f32 v[224:225], v[224:225], s[92:93]
    v_pk_mul_f32 v[226:227], v[226:227], s[92:93]
    v_pk_mul_f32 v[228:229], v[228:229], s[92:93]
    v_pk_mul_f32 v[230:231], v[230:231], s[92:93]
    v_cvt_pk_bf16_f32 v208, v224, v225
    v_cvt_pk_bf16_f32 v209, v226, v227
    v_cvt_pk_bf16_f32 v210, v228, v229
    v_cvt_pk_bf16_f32 v211, v230, v231
    v_pk_mul_f32 v[232:233], v[232:233], s[92:93]
    v_pk_mul_f32 v[234:235], v[234:235], s[92:93]
    v_pk_mul_f32 v[236:237], v[236:237], s[92:93]
    v_pk_mul_f32 v[238:239], v[238:239], s[92:93]
    v_cvt_pk_bf16_f32 v212, v232, v233
    v_cvt_pk_bf16_f32 v213, v234, v235
    v_cvt_pk_bf16_f32 v214, v236, v237
    v_cvt_pk_bf16_f32 v215, v238, v239
    v_pk_mul_f32 v[240:241], v[240:241], s[92:93]
    v_pk_mul_f32 v[242:243], v[242:243], s[92:93]
    v_pk_mul_f32 v[244:245], v[244:245], s[92:93]
    v_pk_mul_f32 v[246:247], v[246:247], s[92:93]
    v_cvt_pk_bf16_f32 v216, v240, v241
    v_cvt_pk_bf16_f32 v217, v242, v243
    v_cvt_pk_bf16_f32 v218, v244, v245
    v_cvt_pk_bf16_f32 v219, v246, v247
    v_pk_mul_f32 v[248:249], v[248:249], s[92:93]
    v_pk_mul_f32 v[250:251], v[250:251], s[92:93]
    v_pk_mul_f32 v[252:253], v[252:253], s[92:93]
    v_pk_mul_f32 v[254:255], v[254:255], s[92:93]
    v_cvt_pk_bf16_f32 v220, v248, v249
    v_cvt_pk_bf16_f32 v221, v250, v251
    v_cvt_pk_bf16_f32 v222, v252, v253
    v_cvt_pk_bf16_f32 v223, v254, v255
    v_accvgpr_read_b32 v24, a96
    v_accvgpr_read_b32 v25, a97
    v_accvgpr_read_b32 v26, a98
    v_accvgpr_read_b32 v27, a99
    v_accvgpr_read_b32 v28, a100
    v_accvgpr_read_b32 v29, a101
    v_accvgpr_read_b32 v30, a102
    v_accvgpr_read_b32 v31, a103
    v_pk_mul_f32 v[24:25], v[24:25], s[92:93]
    v_pk_mul_f32 v[26:27], v[26:27], s[92:93]
    v_pk_mul_f32 v[28:29], v[28:29], s[92:93]
    v_pk_mul_f32 v[30:31], v[30:31], s[92:93]
    v_cvt_pk_bf16_f32 v224, v24, v25
    v_cvt_pk_bf16_f32 v225, v26, v27
    v_cvt_pk_bf16_f32 v226, v28, v29
    v_cvt_pk_bf16_f32 v227, v30, v31
    v_accvgpr_read_b32 v24, a104
    v_accvgpr_read_b32 v25, a105
    v_accvgpr_read_b32 v26, a106
    v_accvgpr_read_b32 v27, a107
    v_accvgpr_read_b32 v28, a108
    v_accvgpr_read_b32 v29, a109
    v_accvgpr_read_b32 v30, a110
    v_accvgpr_read_b32 v31, a111
    v_pk_mul_f32 v[24:25], v[24:25], s[92:93]
    v_pk_mul_f32 v[26:27], v[26:27], s[92:93]
    v_pk_mul_f32 v[28:29], v[28:29], s[92:93]
    v_pk_mul_f32 v[30:31], v[30:31], s[92:93]
    v_cvt_pk_bf16_f32 v228, v24, v25
    v_cvt_pk_bf16_f32 v229, v26, v27
    v_cvt_pk_bf16_f32 v230, v28, v29
    v_cvt_pk_bf16_f32 v231, v30, v31
    v_accvgpr_read_b32 v24, a112
    v_accvgpr_read_b32 v25, a113
    v_accvgpr_read_b32 v26, a114
    v_accvgpr_read_b32 v27, a115
    v_accvgpr_read_b32 v28, a116
    v_accvgpr_read_b32 v29, a117
    v_accvgpr_read_b32 v30, a118
    v_accvgpr_read_b32 v31, a119
    v_pk_mul_f32 v[24:25], v[24:25], s[92:93]
    v_pk_mul_f32 v[26:27], v[26:27], s[92:93]
    v_pk_mul_f32 v[28:29], v[28:29], s[92:93]
    v_pk_mul_f32 v[30:31], v[30:31], s[92:93]
    v_cvt_pk_bf16_f32 v232, v24, v25
    v_cvt_pk_bf16_f32 v233, v26, v27
    v_cvt_pk_bf16_f32 v234, v28, v29
    v_cvt_pk_bf16_f32 v235, v30, v31
    v_accvgpr_read_b32 v24, a120
    v_accvgpr_read_b32 v25, a121
    v_accvgpr_read_b32 v26, a122
    v_accvgpr_read_b32 v27, a123
    v_accvgpr_read_b32 v28, a124
    v_accvgpr_read_b32 v29, a125
    v_accvgpr_read_b32 v30, a126
    v_accvgpr_read_b32 v31, a127
    v_pk_mul_f32 v[24:25], v[24:25], s[92:93]
    v_pk_mul_f32 v[26:27], v[26:27], s[92:93]
    v_pk_mul_f32 v[28:29], v[28:29], s[92:93]
    v_pk_mul_f32 v[30:31], v[30:31], s[92:93]
    v_cvt_pk_bf16_f32 v236, v24, v25
    v_cvt_pk_bf16_f32 v237, v26, v27
    v_cvt_pk_bf16_f32 v238, v28, v29
    v_cvt_pk_bf16_f32 v239, v30, v31
    v_pk_mul_f32 v[160:161], v[160:161], s[92:93]
    v_pk_mul_f32 v[162:163], v[162:163], s[92:93]
    v_pk_mul_f32 v[164:165], v[164:165], s[92:93]
    v_pk_mul_f32 v[166:167], v[166:167], s[92:93]
    v_cvt_pk_bf16_f32 v240, v160, v161
    v_cvt_pk_bf16_f32 v241, v162, v163
    v_cvt_pk_bf16_f32 v242, v164, v165
    v_cvt_pk_bf16_f32 v243, v166, v167
    v_pk_mul_f32 v[168:169], v[168:169], s[92:93]
    v_pk_mul_f32 v[170:171], v[170:171], s[92:93]
    v_pk_mul_f32 v[172:173], v[172:173], s[92:93]
    v_pk_mul_f32 v[174:175], v[174:175], s[92:93]
    v_cvt_pk_bf16_f32 v244, v168, v169
    v_cvt_pk_bf16_f32 v245, v170, v171
    v_cvt_pk_bf16_f32 v246, v172, v173
    v_cvt_pk_bf16_f32 v247, v174, v175
    v_pk_mul_f32 v[176:177], v[176:177], s[92:93]
    v_pk_mul_f32 v[178:179], v[178:179], s[92:93]
    v_pk_mul_f32 v[180:181], v[180:181], s[92:93]
    v_pk_mul_f32 v[182:183], v[182:183], s[92:93]
    v_cvt_pk_bf16_f32 v248, v176, v177
    v_cvt_pk_bf16_f32 v249, v178, v179
    v_cvt_pk_bf16_f32 v250, v180, v181
    v_cvt_pk_bf16_f32 v251, v182, v183
    v_pk_mul_f32 v[184:185], v[184:185], s[92:93]
    v_pk_mul_f32 v[186:187], v[186:187], s[92:93]
    v_pk_mul_f32 v[188:189], v[188:189], s[92:93]
    v_pk_mul_f32 v[190:191], v[190:191], s[92:93]
    v_cvt_pk_bf16_f32 v252, v184, v185
    v_cvt_pk_bf16_f32 v253, v186, v187
    v_cvt_pk_bf16_f32 v254, v188, v189
    v_cvt_pk_bf16_f32 v255, v190, v191
    s_setpc_b64 s[20:21]
m_ns262:
    s_mov_b32 s90, s98
    v_cvt_pk_bf16_f32 v32, v32, v33
    v_cvt_pk_bf16_f32 v33, v34, v35
    v_cvt_pk_bf16_f32 v34, v36, v37
    v_cvt_pk_bf16_f32 v35, v38, v39
    buffer_store_dwordx4 v[32:35], v2, s[8:11], s90 offen sc1
    s_add_u32 s90, s90, s100
    v_cvt_pk_bf16_f32 v40, v40, v41
    v_cvt_pk_bf16_f32 v41, v42, v43
    v_cvt_pk_bf16_f32 v42, v44, v45
    v_cvt_pk_bf16_f32 v43, v46, v47
    buffer_store_dwordx4 v[40:43], v2, s[8:11], s90 offen sc1
    s_add_u32 s90, s90, s100
    v_cvt_pk_bf16_f32 v48, v48, v49
    v_cvt_pk_bf16_f32 v49, v50, v51
    v_cvt_pk_bf16_f32 v50, v52, v53
    v_cvt_pk_bf16_f32 v51, v54, v55
    buffer_store_dwordx4 v[48:51], v2, s[8:11], s90 offen sc1
    s_add_u32 s90, s90, s100
    v_cvt_pk_bf16_f32 v56, v56, v57
    v_cvt_pk_bf16_f32 v57, v58, v59
    v_cvt_pk_bf16_f32 v58, v60, v61
    v_cvt_pk_bf16_f32 v59, v62, v63
    buffer_store_dwordx4 v[56:59], v2, s[8:11], s90 offen sc1
    s_add_u32 s90, s90, s100
    v_cvt_pk_bf16_f32 v64, v64, v65
    v_cvt_pk_bf16_f32 v65, v66, v67
    v_cvt_pk_bf16_f32 v66, v68, v69
    v_cvt_pk_bf16_f32 v67, v70, v71
    buffer_store_dwordx4 v[64:67], v2, s[8:11], s90 offen sc1
    s_add_u32 s90, s90, s100
    v_cvt_pk_bf16_f32 v72, v72, v73
    v_cvt_pk_bf16_f32 v73, v74, v75
    v_cvt_pk_bf16_f32 v74, v76, v77
    v_cvt_pk_bf16_f32 v75, v78, v79
    buffer_store_dwordx4 v[72:75], v2, s[8:11], s90 offen sc1
    s_add_u32 s90, s90, s100
    v_cvt_pk_bf16_f32 v80, v80, v81
    v_cvt_pk_bf16_f32 v81, v82, v83
    v_cvt_pk_bf16_f32 v82, v84, v85
    v_cvt_pk_bf16_f32 v83, v86, v87
    buffer_store_dwordx4 v[80:83], v2, s[8:11], s90 offen sc1
    s_add_u32 s90, s90, s100
    v_cvt_pk_bf16_f32 v88, v88, v89
    v_cvt_pk_bf16_f32 v89, v90, v91
    v_cvt_pk_bf16_f32 v90, v92, v93
    v_cvt_pk_bf16_f32 v91, v94, v95
    buffer_store_dwordx4 v[88:91], v2, s[8:11], s90 offen sc1
    s_add_u32 s90, s98, s99
    v_cvt_pk_bf16_f32 v96, v96, v97
    v_cvt_pk_bf16_f32 v97, v98, v99
    v_cvt_pk_bf16_f32 v98, v100, v101
    v_cvt_pk_bf16_f32 v99, v102, v103
    buffer_store_dwordx4 v[96:99], v2, s[8:11], s90 offen sc1
    s_add_u32 s90, s90, s100
    v_cvt_pk_bf16_f32 v104, v104, v105
    v_cvt_pk_bf16_f32 v105, v106, v107
    v_cvt_pk_bf16_f32 v106, v108, v109
    v_cvt_pk_bf16_f32 v107, v110, v111
    buffer_store_dwordx4 v[104:107], v2, s[8:11], s90 offen sc1
    s_add_u32 s90, s90, s100
    v_cvt_pk_bf16_f32 v112, v112, v113
    v_cvt_pk_bf16_f32 v113, v114, v115
    v_cvt_pk_bf16_f32 v114, v116, v117
    v_cvt_pk_bf16_f32 v115, v118, v119
    buffer_store_dwordx4 v[112:115], v2, s[8:11], s90 offen sc1
    s_add_u32 s90, s90, s100
    v_cvt_pk_bf16_f32 v120, v120, v121
    v_cvt_pk_bf16_f32 v121, v122, v123
    v_cvt_pk_bf16_f32 v122, v124, v125
    v_cvt_pk_bf16_f32 v123, v126, v127
    buffer_store_dwordx4 v[120:123], v2, s[8:11], s90 offen sc1
    s_add_u32 s90, s90, s100
    v_cvt_pk_bf16_f32 v128, v128, v129
    v_cvt_pk_bf16_f32 v129, v130, v131
    v_cvt_pk_bf16_f32 v130, v132, v133
    v_cvt_pk_bf16_f32 v131, v134, v135
    buffer_store_dwordx4 v[128:131], v2, s[8:11], s90 offen sc1
    s_add_u32 s90, s90, s100
    v_cvt_pk_bf16_f32 v136, v136, v137
    v_cvt_pk_bf16_f32 v137, v138, v139
    v_cvt_pk_bf16_f32 v138, v140, v141
    v_cvt_pk_bf16_f32 v139, v142, v143
    buffer_store_dwordx4 v[136:139], v2, s[8:11], s90 offen sc1
    s_add_u32 s90, s90, s100
    v_cvt_pk_bf16_f32 v144, v144, v145
    v_cvt_pk_bf16_f32 v145, v146, v147
    v_cvt_pk_bf16_f32 v146, v148, v149
    v_cvt_pk_bf16_f32 v147, v150, v151
    buffer_store_dwordx4 v[144:147], v2, s[8:11], s90 offen sc1
    s_add_u32 s90, s90, s100
    v_cvt_pk_bf16_f32 v152, v152, v153
    v_cvt_pk_bf16_f32 v153, v154, v155
    v_cvt_pk_bf16_f32 v154, v156, v157
    v_cvt_pk_bf16_f32 v155, v158, v159
    buffer_store_dwordx4 v[152:155], v2, s[8:11], s90 offen sc1
    s_add_u32 s90, s90, s100
    v_cvt_pk_bf16_f32 v192, v192, v193
    v_cvt_pk_bf16_f32 v193, v194, v195
    v_cvt_pk_bf16_f32 v194, v196, v197
    v_cvt_pk_bf16_f32 v195, v198, v199
    v_cvt_pk_bf16_f32 v196, v200, v201
    v_cvt_pk_bf16_f32 v197, v202, v203
    v_cvt_pk_bf16_f32 v198, v204, v205
    v_cvt_pk_bf16_f32 v199, v206, v207
    v_cvt_pk_bf16_f32 v200, v208, v209
    v_cvt_pk_bf16_f32 v201, v210, v211
    v_cvt_pk_bf16_f32 v202, v212, v213
    v_cvt_pk_bf16_f32 v203, v214, v215
    v_cvt_pk_bf16_f32 v204, v216, v217
    v_cvt_pk_bf16_f32 v205, v218, v219
    v_cvt_pk_bf16_f32 v206, v220, v221
    v_cvt_pk_bf16_f32 v207, v222, v223
    v_cvt_pk_bf16_f32 v208, v224, v225
    v_cvt_pk_bf16_f32 v209, v226, v227
    v_cvt_pk_bf16_f32 v210, v228, v229
    v_cvt_pk_bf16_f32 v211, v230, v231
    v_cvt_pk_bf16_f32 v212, v232, v233
    v_cvt_pk_bf16_f32 v213, v234, v235
    v_cvt_pk_bf16_f32 v214, v236, v237
    v_cvt_pk_bf16_f32 v215, v238, v239
    v_cvt_pk_bf16_f32 v216, v240, v241
    v_cvt_pk_bf16_f32 v217, v242, v243
    v_cvt_pk_bf16_f32 v218, v244, v245
    v_cvt_pk_bf16_f32 v219, v246, v247
    v_cvt_pk_bf16_f32 v220, v248, v249
    v_cvt_pk_bf16_f32 v221, v250, v251
    v_cvt_pk_bf16_f32 v222, v252, v253
    v_cvt_pk_bf16_f32 v223, v254, v255
    v_accvgpr_read_b32 v24, a96
    v_accvgpr_read_b32 v25, a97
    v_accvgpr_read_b32 v26, a98
    v_accvgpr_read_b32 v27, a99
    v_accvgpr_read_b32 v28, a100
    v_accvgpr_read_b32 v29, a101
    v_accvgpr_read_b32 v30, a102
    v_accvgpr_read_b32 v31, a103
    v_cvt_pk_bf16_f32 v224, v24, v25
    v_cvt_pk_bf16_f32 v225, v26, v27
    v_cvt_pk_bf16_f32 v226, v28, v29
    v_cvt_pk_bf16_f32 v227, v30, v31
    v_accvgpr_read_b32 v24, a104
    v_accvgpr_read_b32 v25, a105
    v_accvgpr_read_b32 v26, a106
    v_accvgpr_read_b32 v27, a107
    v_accvgpr_read_b32 v28, a108
    v_accvgpr_read_b32 v29, a109
    v_accvgpr_read_b32 v30, a110
    v_accvgpr_read_b32 v31, a111
    v_cvt_pk_bf16_f32 v228, v24, v25
    v_cvt_pk_bf16_f32 v229, v26, v27
    v_cvt_pk_bf16_f32 v230, v28, v29
    v_cvt_pk_bf16_f32 v231, v30, v31
    v_accvgpr_read_b32 v24, a112
    v_accvgpr_read_b32 v25, a113
    v_accvgpr_read_b32 v26, a114
    v_accvgpr_read_b32 v27, a115
    v_accvgpr_read_b32 v28, a116
    v_accvgpr_read_b32 v29, a117
    v_accvgpr_read_b32 v30, a118
    v_accvgpr_read_b32 v31, a119
    v_cvt_pk_bf16_f32 v232, v24, v25
    v_cvt_pk_bf16_f32 v233, v26, v27
    v_cvt_pk_bf16_f32 v234, v28, v29
    v_cvt_pk_bf16_f32 v235, v30, v31
    v_accvgpr_read_b32 v24, a120
    v_accvgpr_read_b32 v25, a121
    v_accvgpr_read_b32 v26, a122
    v_accvgpr_read_b32 v27, a123
    v_accvgpr_read_b32 v28, a124
    v_accvgpr_read_b32 v29, a125
    v_accvgpr_read_b32 v30, a126
    v_accvgpr_read_b32 v31, a127
    v_cvt_pk_bf16_f32 v236, v24, v25
    v_cvt_pk_bf16_f32 v237, v26, v27
    v_cvt_pk_bf16_f32 v238, v28, v29
    v_cvt_pk_bf16_f32 v239, v30, v31
    v_cvt_pk_bf16_f32 v240, v160, v161
    v_cvt_pk_bf16_f32 v241, v162, v163
    v_cvt_pk_bf16_f32 v242, v164, v165
    v_cvt_pk_bf16_f32 v243, v166, v167
    v_cvt_pk_bf16_f32 v244, v168, v169
    v_cvt_pk_bf16_f32 v245, v170, v171
    v_cvt_pk_bf16_f32 v246, v172, v173
    v_cvt_pk_bf16_f32 v247, v174, v175
    v_cvt_pk_bf16_f32 v248, v176, v177
    v_cvt_pk_bf16_f32 v249, v178, v179
    v_cvt_pk_bf16_f32 v250, v180, v181
    v_cvt_pk_bf16_f32 v251, v182, v183
    v_cvt_pk_bf16_f32 v252, v184, v185
    v_cvt_pk_bf16_f32 v253, v186, v187
    v_cvt_pk_bf16_f32 v254, v188, v189
    v_cvt_pk_bf16_f32 v255, v190, v191
    s_setpc_b64 s[20:21]
concat_heads__sliding_local_dilated__compressed_kv_cla__prompt_kernel_end:
.section .rodata,"a"
.p2align 6
.amdhsa_kernel concat_heads__sliding_local_dilated__compressed_kv_cla__prompt_kernel
  .amdhsa_next_free_vgpr 512
  .amdhsa_next_free_sgpr 102
  .amdhsa_accum_offset 256
  .amdhsa_group_segment_fixed_size 0
  .amdhsa_kernarg_size 96
  .amdhsa_user_sgpr_count 2
  .amdhsa_user_sgpr_kernarg_segment_ptr 1
  .amdhsa_system_sgpr_workgroup_id_x 1
.end_amdhsa_kernel
```

```asm
; @launch grid=(256,1,1) block=(256,1,1) lds=163840
.amdgcn_target "amdgcn-amd-amdhsa--gfx950"
.text
.globl concat_heads__sliding_local_dilated__compressed_kv_cla__prompt_kernel
.p2align 8
.type concat_heads__sliding_local_dilated__compressed_kv_cla__prompt_kernel,@function
concat_heads__sliding_local_dilated__compressed_kv_cla__prompt_kernel:
    s_cmp_ge_u32 s2, 256
    s_cbranch_scc1 m_end1
    s_load_dwordx16 s[24:39], s[0:1], 0
    s_load_dwordx4 s[4:7], s[0:1], 80
    v_and_b32 v1, 63, v0
    v_lshrrev_b32 v24, 6, v0
    s_nop 0
    v_readfirstlane_b32 s16, v24
    s_lshr_b32 s68, s2, 3
    s_lshr_b32 s57, s16, 1
    s_and_b32 s58, s16, 1
    s_mov_b32 s43, 0x20000
    s_mov_b32 s47, 0x20000
    s_cmp_lt_u32 s68, 28
    s_cbranch_scc1 m_ncp2
    s_sub_u32 s91, s68, 28
    s_lshl_b32 s91, s91, 2
    s_add_u32 s91, s91, s16
    s_getpc_b64 s[8:9]
m_pc3:
    s_sub_u32 s8, s8, m_pc3-concat_heads__sliding_local_dilated__compressed_kv_cla__prompt_kernel
    s_subb_u32 s9, s9, 0
    s_mov_b32 s10, concat_heads__sliding_local_dilated__compressed_kv_cla__prompt_kernel_end-concat_heads__sliding_local_dilated__compressed_kv_cla__prompt_kernel
    s_mov_b32 s11, 0x20000
    s_lshl_b32 s90, s91, 13
    v_lshlrev_b32 v24, 7, v1
    buffer_load_dword v22, v24, s[8:11], s90 offen
m_ncp2:
    s_lshl_b32 s61, s16, 13
    s_add_u32 s62, s61, 98304
    s_cmp_ge_u32 s68, 16
    s_cbranch_scc1 m_typea4
    s_and_b32 s69, s68, 3
    s_and_b32 s90, s2, 1
    s_lshl_b32 s90, s90, 2
    s_add_u32 s69, s69, s90
    s_bfe_u32 s90, s2, 0x20001
    s_mul_i32 s90, s90, 4
    s_bfe_u32 s91, s68, 0x20002
    s_add_u32 s90, s90, s91
    s_mov_b32 s76, 8388608
    s_mov_b32 s78, 8192
    s_mov_b32 s81, 0
    s_mov_b32 s73, 4194304
    s_mov_b32 s77, 2048
    s_mov_b32 s82, 16
    s_lshl_b32 s80, s90, 9
    s_lshl_b32 s79, s69, 19
    s_lshl_b32 s88, s90, 4
    s_add_u32 s88, s88, s69
    s_lshl_b32 s88, s88, 3
    s_mov_b32 s83, 0
    s_mov_b32 s84, 1040356334
    s_lshl_b32 s91, s90, 1
    s_add_u32 s91, s91, s58
    s_lshl_b32 s91, s91, 19
    s_lshl_b32 s92, s69, 1
    s_add_u32 s92, s92, s57
    s_lshl_b32 s92, s92, 15
    s_add_u32 s85, s91, s92
    s_add_u32 s85, s85, 0
    s_mov_b32 s86, 1024
    s_mov_b32 s87, 4096
    s_branch m_go15
m_typea4:
    s_bfe_u32 s69, s68, 0x20002
    s_add_u32 s69, s69, 0
    s_and_b32 s90, s2, 7
    s_lshl_b32 s90, s90, 2
    s_and_b32 s91, s68, 3
    s_add_u32 s90, s90, s91
    s_cmp_lt_u32 s90, 16
    s_cselect_b32 s83, 0, 1
    s_mov_b32 s91, 33554432
    s_cselect_b32 s85, 16777216, s91
    s_mov_b32 s91, 8192
    s_cselect_b32 s86, 1024, s91
    s_mov_b32 s91, 1024
    s_cselect_b32 s87, 4096, s91
    s_mov_b32 s73, 2097152
    s_mov_b32 s77, 1024
    s_mov_b32 s82, 8
    s_mov_b32 s81, 0
    s_mov_b32 s76, 4194304
    s_mov_b32 s78, 8192
    s_mov_b32 s84, 0
    s_and_b32 s90, s90, 15
    s_lshl_b32 s80, s90, 9
    s_lshl_b32 s79, s69, 18
    s_lshl_b32 s91, s83, 2
    s_add_u32 s91, s91, s69
    s_cmp_ge_u32 s69, 4
    s_cselect_b32 s92, 508, 8
    s_add_u32 s91, s91, s92
    s_lshl_b32 s88, s90, 4
    s_add_u32 s88, s88, s91
    s_lshl_b32 s88, s88, 3
    s_lshl_b32 s91, s90, 1
    s_add_u32 s91, s91, s58
    s_lshl_b32 s91, s91, 19
    s_lshl_b32 s92, s69, 1
    s_add_u32 s92, s92, s57
    s_lshl_b32 s92, s92, 15
    s_add_u32 s85, s85, s91
    s_add_u32 s85, s85, s92
m_go15:
    s_mov_b32 s42, s73
    s_mov_b32 s46, s76
    s_lshl_b32 s90, s77, 4
    s_lshl_b32 s90, s90, s81
    s_mov_b32 s48, s79
    s_mul_i32 s91, s90, 1
    s_add_u32 s49, s91, s79
    s_sub_u32 s49, s49, 2048
    s_mul_i32 s91, s90, 2
    s_add_u32 s50, s91, s79
    s_mul_i32 s91, s90, 3
    s_add_u32 s51, s91, s79
    s_sub_u32 s51, s51, 2048
    s_mov_b32 s52, s80
    s_lshl_b32 s90, s78, 2
    s_mul_i32 s91, s90, 1
    s_add_u32 s53, s91, s80
    s_sub_u32 s53, s53, 2048
    s_mul_i32 s91, s90, 2
    s_add_u32 s54, s91, s80
    s_mul_i32 s91, s90, 3
    s_add_u32 s55, s91, s80
    s_sub_u32 s55, s55, 2048
    s_lshl_b32 s56, s78, 6
    s_lshl_b32 s90, s58, 7
    s_add_u32 s90, s90, s57
    s_lshl_b32 s91, s16, 6
    s_cmp_eq_u32 s81, 1
    s_cselect_b32 s90, s90, s91
    v_lshrrev_b32 v24, 3, v1
    v_lshlrev_b32 v24, s81, v24
    v_add_u32 v24, s90, v24
    v_mul_lo_u32 v24, v24, s77
    v_lshrrev_b32 v25, 4, v1
    v_and_b32 v26, 7, v1
    v_xor_b32 v25, v25, v26
    v_lshl_add_u32 v16, v25, 4, v24
    v_xor_b32 v25, 4, v25
    v_lshl_add_u32 v17, v25, 4, v24
    s_lshl_b32 s90, s77, 3
    s_lshl_b32 s90, s90, s81
    s_sub_u32 s90, s90, 1024
    v_add_u32 v17, s90, v17
    v_lshrrev_b32 v24, 5, v1
    s_lshl_b32 s90, s16, 4
    v_add_u32 v25, s90, v24
    v_mul_lo_u32 v25, v25, s78
    v_lshlrev_b32 v24, 1, v24
    v_and_b32 v26, 31, v1
    v_xor_b32 v24, v24, v26
    s_lshl_b32 s90, s78, 1
    s_sub_u32 s90, s90, 1024
    v_add_u32 v27, s90, v25
    v_xor_b32 v26, 0, v24
    v_lshl_add_u32 v18, v26, 4, v25
    v_xor_b32 v26, 4, v24
    v_lshl_add_u32 v19, v26, 4, v27
    v_xor_b32 v26, 8, v24
    v_lshl_add_u32 v20, v26, 4, v25
    v_xor_b32 v26, 12, v24
    v_lshl_add_u32 v21, v26, 4, v27
    s_cmp_eq_u32 s83, 0
    s_waitcnt lgkmcnt(0)
    s_cselect_b32 s44, s36, s38
    s_cselect_b32 s45, s37, s39
    s_cmp_lt_u32 s68, 16
    s_cselect_b32 s44, s34, s44
    s_cselect_b32 s45, s35, s45
    s_cselect_b32 s40, s30, s32
    s_cselect_b32 s41, s31, s33
    s_cmp_ge_u32 s68, 28
    s_cselect_b32 s70, 1, 0
    s_cbranch_scc1 m_pf7
m_nopf6:
    s_add_u32 m0, s61, 0
    s_nop 0
    buffer_load_dwordx4 v16, s[40:43], s48 offen offset:0 lds
    buffer_load_dwordx4 v17, s[40:43], s48 offen offset:1024 lds
    s_add_u32 s48, s48, 128
    buffer_load_dwordx4 v16, s[40:43], s49 offen offset:2048 lds
    buffer_load_dwordx4 v17, s[40:43], s49 offen offset:3072 lds
    s_add_u32 s49, s49, 128
    s_add_u32 m0, s61, 4096
    s_nop 0
    buffer_load_dwordx4 v16, s[40:43], s50 offen offset:0 lds
    buffer_load_dwordx4 v17, s[40:43], s50 offen offset:1024 lds
    s_add_u32 s50, s50, 128
    buffer_load_dwordx4 v16, s[40:43], s51 offen offset:2048 lds
    buffer_load_dwordx4 v17, s[40:43], s51 offen offset:3072 lds
    s_add_u32 s51, s51, 128
    s_add_u32 s61, s61, 32768
    s_cmp_ge_u32 s61, 98304
    s_cselect_b32 s90, 98304, 0
    s_sub_u32 s61, s61, s90
    s_add_u32 m0, s62, 0
    s_nop 0
    buffer_load_dwordx4 v18, s[44:47], s52 offen offset:0 lds
    buffer_load_dwordx4 v19, s[44:47], s52 offen offset:1024 lds
    s_add_u32 s52, s52, s56
    buffer_load_dwordx4 v18, s[44:47], s53 offen offset:2048 lds
    buffer_load_dwordx4 v19, s[44:47], s53 offen offset:3072 lds
    s_add_u32 s53, s53, s56
    s_add_u32 m0, s62, 4096
    s_nop 0
    buffer_load_dwordx4 v20, s[44:47], s54 offen offset:0 lds
    buffer_load_dwordx4 v21, s[44:47], s54 offen offset:1024 lds
    s_add_u32 s54, s54, s56
    buffer_load_dwordx4 v20, s[44:47], s55 offen offset:2048 lds
    buffer_load_dwordx4 v21, s[44:47], s55 offen offset:3072 lds
    s_add_u32 s55, s55, s56
    s_xor_b32 s62, s62, 229376
    s_mov_b32 s95, s82
    s_mov_b32 s96, s83
    s_mov_b32 s97, s84
    s_mov_b32 s98, s85
    s_mov_b32 s99, s86
    s_mov_b32 s100, s87
    s_mov_b32 s101, s88
    v_and_b32 v24, 15, v1
    v_lshrrev_b32 v25, 4, v1
    v_bfe_u32 v26, v1, 1, 3
    v_xor_b32 v26, v26, v25
    s_lshl_b32 s90, s57, 14
    v_lshlrev_b32 v27, 7, v24
    v_add_u32 v27, s90, v27
    v_xor_b32 v28, 0, v26
    v_lshl_add_u32 v6, v28, 4, v27
    v_xor_b32 v28, 4, v26
    v_lshl_add_u32 v7, v28, 4, v27
    v_bfe_u32 v26, v1, 2, 2
    v_lshl_add_u32 v27, v25, 3, v26
    v_lshlrev_b32 v27, 9, v27
    v_and_b32 v28, 3, v1
    v_lshlrev_b32 v28, 3, v28
    v_add_u32 v27, v27, v28
    s_lshl_b32 s90, s58, 8
    s_add_u32 s90, s90, 98304
    v_add_u32 v27, s90, v27
    v_bfe_u32 v26, v1, 2, 3
    v_xor_b32 v28, 0, v26
    v_lshl_add_u32 v8, v28, 5, v27
    v_xor_b32 v28, 1, v26
    v_lshl_add_u32 v9, v28, 5, v27
    v_xor_b32 v28, 2, v26
    v_lshl_add_u32 v10, v28, 5, v27
    v_xor_b32 v28, 3, v26
    v_lshl_add_u32 v11, v28, 5, v27
    v_xor_b32 v28, 4, v26
    v_lshl_add_u32 v12, v28, 5, v27
    v_xor_b32 v28, 5, v26
    v_lshl_add_u32 v13, v28, 5, v27
    v_xor_b32 v28, 6, v26
    v_lshl_add_u32 v14, v28, 5, v27
    v_xor_b32 v28, 7, v26
    v_lshl_add_u32 v15, v28, 5, v27
    v_lshlrev_b32 v2, 4, v1
    s_mov_b32 s64, 0
    s_mov_b32 s59, 32768
    s_mov_b32 s60, 229376
    s_mov_b32 s8, s6
    s_mov_b32 s9, s7
    s_mov_b32 s10, 268435456
    s_mov_b32 s11, 0x20000
    s_cmp_ge_u32 s68, 16
    s_cbranch_scc1 m_typea8
    s_bfe_u32 s69, s68, 0x20002
    s_add_u32 s69, s69, 4
    s_and_b32 s90, s2, 7
    s_lshl_b32 s90, s90, 2
    s_and_b32 s91, s68, 3
    s_add_u32 s90, s90, s91
    s_cmp_lt_u32 s90, 16
    s_cselect_b32 s83, 0, 1
    s_mov_b32 s91, 33554432
    s_cselect_b32 s85, 16777216, s91
    s_mov_b32 s91, 8192
    s_cselect_b32 s86, 1024, s91
    s_mov_b32 s91, 1024
    s_cselect_b32 s87, 4096, s91
    s_cselect_b32 s74, s36, s38
    s_cselect_b32 s75, s37, s39
    s_mov_b32 s71, s32
    s_mov_b32 s72, s33
    s_mov_b32 s73, 2097152
    s_mov_b32 s77, 1024
    s_mov_b32 s82, 8
    s_mov_b32 s81, 0
    s_mov_b32 s76, 4194304
    s_mov_b32 s78, 8192
    s_mov_b32 s84, 0
    s_and_b32 s90, s90, 15
    s_lshl_b32 s80, s90, 9
    s_lshl_b32 s79, s69, 18
    s_lshl_b32 s91, s83, 2
    s_add_u32 s91, s91, s69
    s_cmp_ge_u32 s69, 4
    s_cselect_b32 s92, 508, 8
    s_add_u32 s91, s91, s92
    s_lshl_b32 s88, s90, 4
    s_add_u32 s88, s88, s91
    s_lshl_b32 s88, s88, 3
    s_lshl_b32 s91, s90, 1
    s_add_u32 s91, s91, s58
    s_lshl_b32 s91, s91, 19
    s_lshl_b32 s92, s69, 1
    s_add_u32 s92, s92, s57
    s_lshl_b32 s92, s92, 15
    s_add_u32 s85, s85, s91
    s_add_u32 s85, s85, s92
    s_branch m_go29
m_typea8:
    s_and_b32 s69, s68, 3
    s_and_b32 s90, s2, 1
    s_lshl_b32 s90, s90, 2
    s_add_u32 s69, s69, s90
    s_bfe_u32 s90, s2, 0x20001
    s_mul_i32 s90, s90, 3
    s_bfe_u32 s91, s68, 0x20002
    s_add_u32 s90, s90, s91
    s_mov_b32 s76, 6291456
    s_mov_b32 s78, 6144
    s_mov_b32 s81, 1
    s_mov_b32 s73, 4194304
    s_mov_b32 s77, 2048
    s_mov_b32 s82, 16
    s_lshl_b32 s80, s90, 9
    s_lshl_b32 s79, s69, 19
    s_and_b32 s92, s90, 3
    s_lshr_b32 s91, s90, 2
    s_lshl_b32 s88, s92, 2
    s_add_u32 s88, s88, s91
    s_lshl_b32 s88, s88, 3
    s_add_u32 s88, s88, s69
    s_lshl_b32 s88, s88, 3
    s_add_u32 s88, s88, 6144
    s_cmp_eq_u32 s91, 0
    s_cselect_b32 s84, 1048744942, 0
    s_lshl_b32 s93, s91, 22
    s_add_u32 s85, s93, 50331648
    s_lshl_b32 s92, s92, 1
    s_add_u32 s92, s92, s58
    s_lshl_b32 s92, s92, 19
    s_add_u32 s85, s85, s92
    s_lshl_b32 s92, s57, 3
    s_add_u32 s92, s92, s69
    s_cmp_eq_u32 s91, 2
    s_cselect_b32 s83, 1, 0
    s_cselect_b32 s93, 12, 13
    s_mov_b32 s91, 131072
    s_cselect_b32 s86, 1024, s91
    s_mov_b32 s91, 1024
    s_cselect_b32 s87, 65536, s91
    s_lshl_b32 s92, s92, s93
    s_add_u32 s85, s85, s92
    s_mov_b32 s71, s24
    s_mov_b32 s72, s25
    s_mov_b32 s74, s26
    s_mov_b32 s75, s27
m_go29:
    s_xor_b32 s94, s70, 1
    s_mov_b32 s67, 2
    s_mov_b32 s17, -1
    s_mov_b32 s12, s4
    s_mov_b32 s13, s5
    s_mov_b32 s14, 256
    s_mov_b32 s15, 0x20000
    s_lshl_b32 s90, s2, 2
    s_add_u32 s90, s90, s16
    s_cmp_lg_u32 s90, 0
    s_cbranch_scc1 m_tok10
    s_memrealtime s[92:93]
    s_waitcnt lgkmcnt(0)
    s_or_b32 s92, s92, 1
    v_mov_b32 v4, s92
    v_mov_b32 v5, s93
    s_mov_b64 exec, 1
    buffer_store_dwordx2 v[4:5], off, s[12:15], 0 sc1
    s_mov_b64 exec, -1
m_tok10:
    s_add_u32 m0, s61, 0
    s_nop 0
    buffer_load_dwordx4 v16, s[40:43], s48 offen offset:0 lds
    buffer_load_dwordx4 v17, s[40:43], s48 offen offset:1024 lds
    s_add_u32 s48, s48, 128
    buffer_load_dwordx4 v16, s[40:43], s49 offen offset:2048 lds
    buffer_load_dwordx4 v17, s[40:43], s49 offen offset:3072 lds
    s_add_u32 s49, s49, 128
    s_add_u32 m0, s61, 4096
    s_nop 0
    buffer_load_dwordx4 v16, s[40:43], s50 offen offset:0 lds
    buffer_load_dwordx4 v17, s[40:43], s50 offen offset:1024 lds
    s_add_u32 s50, s50, 128
    buffer_load_dwordx4 v16, s[40:43], s51 offen offset:2048 lds
    buffer_load_dwordx4 v17, s[40:43], s51 offen offset:3072 lds
    s_add_u32 s51, s51, 128
    s_add_u32 s61, s61, 32768
    s_cmp_ge_u32 s61, 98304
    s_cselect_b32 s90, 98304, 0
    s_sub_u32 s61, s61, s90
    s_add_u32 m0, s62, 0
    s_nop 0
    buffer_load_dwordx4 v18, s[44:47], s52 offen offset:0 lds
    buffer_load_dwordx4 v19, s[44:47], s52 offen offset:1024 lds
    s_add_u32 s52, s52, s56
    buffer_load_dwordx4 v18, s[44:47], s53 offen offset:2048 lds
    buffer_load_dwordx4 v19, s[44:47], s53 offen offset:3072 lds
    s_add_u32 s53, s53, s56
    s_add_u32 m0, s62, 4096
    s_nop 0
    buffer_load_dwordx4 v20, s[44:47], s54 offen offset:0 lds
    buffer_load_dwordx4 v21, s[44:47], s54 offen offset:1024 lds
    s_add_u32 s54, s54, s56
    buffer_load_dwordx4 v20, s[44:47], s55 offen offset:2048 lds
    buffer_load_dwordx4 v21, s[44:47], s55 offen offset:3072 lds
    s_add_u32 s55, s55, s56
    s_xor_b32 s62, s62, 229376
    s_waitcnt vmcnt(16)
    s_barrier
    ds_read_b64_tr_b16 a[64:65], v8 offset:0
    ds_read_b64_tr_b16 a[66:67], v8 offset:2048
    ds_read_b128 a[0:3], v6 offset:0
    ds_read_b128 a[4:7], v6 offset:2048
    ds_read_b64_tr_b16 a[68:69], v9 offset:0
    ds_read_b64_tr_b16 a[70:71], v9 offset:2048
    ds_read_b128 a[8:11], v6 offset:4096
    ds_read_b128 a[12:15], v6 offset:6144
    ds_read_b64_tr_b16 a[72:73], v10 offset:0
    ds_read_b64_tr_b16 a[74:75], v10 offset:2048
    ds_read_b128 a[16:19], v6 offset:8192
    ds_read_b128 a[20:23], v6 offset:10240
    ds_read_b64_tr_b16 a[76:77], v11 offset:0
    ds_read_b64_tr_b16 a[78:79], v11 offset:2048
    ds_read_b128 a[24:27], v6 offset:12288
    ds_read_b128 a[28:31], v6 offset:14336
    ds_read_b64_tr_b16 a[80:81], v12 offset:0
    ds_read_b64_tr_b16 a[82:83], v12 offset:2048
    ds_read_b64_tr_b16 a[84:85], v13 offset:0
    ds_read_b64_tr_b16 a[86:87], v13 offset:2048
    ds_read_b64_tr_b16 a[88:89], v14 offset:0
    ds_read_b64_tr_b16 a[90:91], v14 offset:2048
    ds_read_b64_tr_b16 a[92:93], v15 offset:0
    ds_read_b64_tr_b16 a[94:95], v15 offset:2048
    s_mov_b32 s66, 1
    s_mov_b32 s24, s6
    s_mov_b32 s25, s7
    s_mov_b32 s26, 0
    s_mov_b32 s27, 0x20000
    s_mov_b32 s28, 0
    s_mov_b32 s29, 0
    s_mov_b32 s30, 0
    s_mov_b32 s31, 0
m_tile11:
    s_mov_b32 s65, s95
    s_cmp_eq_u32 s96, 1
    s_cbranch_scc1 m_swp13
    s_waitcnt lgkmcnt(15)
    v_mfma_f32_16x16x32_bf16 v[32:35], a[64:67], a[0:3], 0
    v_mfma_f32_16x16x32_bf16 v[40:43], a[64:67], a[4:7], 0
    v_mfma_f32_16x16x32_bf16 v[48:51], a[64:67], a[8:11], 0
    v_mfma_f32_16x16x32_bf16 v[56:59], a[64:67], a[12:15], 0
    s_add_u32 m0, s61, 0
    s_waitcnt lgkmcnt(13)
    v_mfma_f32_16x16x32_bf16 v[64:67], a[64:67], a[16:19], 0
    buffer_load_dwordx4 v16, s[40:43], s48 offen offset:0 lds
    s_waitcnt lgkmcnt(12)
    v_mfma_f32_16x16x32_bf16 v[72:75], a[64:67], a[20:23], 0
    s_waitcnt lgkmcnt(9)
    v_mfma_f32_16x16x32_bf16 v[80:83], a[64:67], a[24:27], 0
    s_waitcnt lgkmcnt(8)
    v_mfma_f32_16x16x32_bf16 v[88:91], a[64:67], a[28:31], 0
    ds_read_b64_tr_b16 a[64:65], v8 offset:16384
    v_mfma_f32_16x16x32_bf16 v[36:39], a[68:71], a[0:3], 0
    ds_read_b64_tr_b16 a[66:67], v8 offset:18432
    v_mfma_f32_16x16x32_bf16 v[44:47], a[68:71], a[4:7], 0
    v_mfma_f32_16x16x32_bf16 v[52:55], a[68:71], a[8:11], 0
    ds_read_b128 a[32:35], v7 offset:0
    v_mfma_f32_16x16x32_bf16 v[60:63], a[68:71], a[12:15], 0
    v_mfma_f32_16x16x32_bf16 v[68:71], a[68:71], a[16:19], 0
    buffer_load_dwordx4 v17, s[40:43], s48 offen offset:1024 lds
    v_mfma_f32_16x16x32_bf16 v[76:79], a[68:71], a[20:23], 0
    s_add_u32 s48, s48, 128
    v_mfma_f32_16x16x32_bf16 v[84:87], a[68:71], a[24:27], 0
    ds_read_b128 a[36:39], v7 offset:2048
    v_mfma_f32_16x16x32_bf16 v[92:95], a[68:71], a[28:31], 0
    ds_read_b64_tr_b16 a[68:69], v9 offset:16384
    v_mfma_f32_16x16x32_bf16 v[96:99], a[72:75], a[0:3], 0
    ds_read_b64_tr_b16 a[70:71], v9 offset:18432
    v_mfma_f32_16x16x32_bf16 v[104:107], a[72:75], a[4:7], 0
    v_mfma_f32_16x16x32_bf16 v[112:115], a[72:75], a[8:11], 0
    ds_read_b128 a[40:43], v7 offset:4096
    v_mfma_f32_16x16x32_bf16 v[120:123], a[72:75], a[12:15], 0
    v_mfma_f32_16x16x32_bf16 v[128:131], a[72:75], a[16:19], 0
    buffer_load_dwordx4 v16, s[40:43], s49 offen offset:2048 lds
    v_mfma_f32_16x16x32_bf16 v[136:139], a[72:75], a[20:23], 0
    v_mfma_f32_16x16x32_bf16 v[144:147], a[72:75], a[24:27], 0
    ds_read_b128 a[44:47], v7 offset:6144
    v_mfma_f32_16x16x32_bf16 v[152:155], a[72:75], a[28:31], 0
    ds_read_b64_tr_b16 a[72:73], v10 offset:16384
    v_mfma_f32_16x16x32_bf16 v[100:103], a[76:79], a[0:3], 0
    ds_read_b64_tr_b16 a[74:75], v10 offset:18432
    v_mfma_f32_16x16x32_bf16 v[108:111], a[76:79], a[4:7], 0
    v_mfma_f32_16x16x32_bf16 v[116:119], a[76:79], a[8:11], 0
    ds_read_b128 a[48:51], v7 offset:8192
    v_mfma_f32_16x16x32_bf16 v[124:127], a[76:79], a[12:15], 0
    v_mfma_f32_16x16x32_bf16 v[132:135], a[76:79], a[16:19], 0
    buffer_load_dwordx4 v17, s[40:43], s49 offen offset:3072 lds
    v_mfma_f32_16x16x32_bf16 v[140:143], a[76:79], a[20:23], 0
    s_add_u32 s49, s49, 128
    v_mfma_f32_16x16x32_bf16 v[148:151], a[76:79], a[24:27], 0
    ds_read_b128 a[52:55], v7 offset:10240
    v_mfma_f32_16x16x32_bf16 v[156:159], a[76:79], a[28:31], 0
    ds_read_b64_tr_b16 a[76:77], v11 offset:16384
    s_waitcnt lgkmcnt(15)
    v_mfma_f32_16x16x32_bf16 v[160:163], a[80:83], a[0:3], 0
    ds_read_b64_tr_b16 a[78:79], v11 offset:18432
    v_mfma_f32_16x16x32_bf16 v[168:171], a[80:83], a[4:7], 0
    v_mfma_f32_16x16x32_bf16 v[176:179], a[80:83], a[8:11], 0
    ds_read_b128 a[56:59], v7 offset:12288
    v_mfma_f32_16x16x32_bf16 v[184:187], a[80:83], a[12:15], 0
    s_add_u32 m0, s61, 4096
    v_mfma_f32_16x16x32_bf16 v[192:195], a[80:83], a[16:19], 0
    buffer_load_dwordx4 v16, s[40:43], s50 offen offset:0 lds
    v_mfma_f32_16x16x32_bf16 v[200:203], a[80:83], a[20:23], 0
    v_mfma_f32_16x16x32_bf16 v[208:211], a[80:83], a[24:27], 0
    s_add_u32 s61, s61, 32768
    ds_read_b128 a[60:63], v7 offset:14336
    v_mfma_f32_16x16x32_bf16 v[216:219], a[80:83], a[28:31], 0
    s_cmp_ge_u32 s61, 98304
    s_cselect_b32 s90, 98304, 0
    ds_read_b64_tr_b16 a[80:81], v12 offset:16384
    v_mfma_f32_16x16x32_bf16 v[164:167], a[84:87], a[0:3], 0
    s_sub_u32 s61, s61, s90
    ds_read_b64_tr_b16 a[82:83], v12 offset:18432
    v_mfma_f32_16x16x32_bf16 v[172:175], a[84:87], a[4:7], 0
    s_add_u32 s64, s64, 32768
    v_mfma_f32_16x16x32_bf16 v[180:183], a[84:87], a[8:11], 0
    buffer_store_dwordx4 a[128:131], v2, s[24:27], s28 offen sc1
    v_mfma_f32_16x16x32_bf16 v[188:191], a[84:87], a[12:15], 0
    s_add_u32 s28, s28, s31
    v_mfma_f32_16x16x32_bf16 v[196:199], a[84:87], a[16:19], 0
    buffer_load_dwordx4 v17, s[40:43], s50 offen offset:1024 lds
    v_mfma_f32_16x16x32_bf16 v[204:207], a[84:87], a[20:23], 0
    s_add_u32 s50, s50, 128
    v_mfma_f32_16x16x32_bf16 v[212:215], a[84:87], a[24:27], 0
    s_cmp_ge_u32 s64, 98304
    s_cselect_b32 s63, 4294901760, s59
    s_cselect_b32 s64, 0, s64
    v_mfma_f32_16x16x32_bf16 v[220:223], a[84:87], a[28:31], 0
    ds_read_b64_tr_b16 a[84:85], v13 offset:16384
    v_mfma_f32_16x16x32_bf16 v[224:227], a[88:91], a[0:3], 0
    ds_read_b64_tr_b16 a[86:87], v13 offset:18432
    v_mfma_f32_16x16x32_bf16 v[232:235], a[88:91], a[4:7], 0
    v_mfma_f32_16x16x32_bf16 v[240:243], a[88:91], a[8:11], 0
    buffer_store_dwordx4 a[132:135], v2, s[24:27], s28 offen sc1
    v_mfma_f32_16x16x32_bf16 v[248:251], a[88:91], a[12:15], 0
    s_add_u32 s28, s28, s31
    v_mfma_f32_16x16x32_bf16 a[96:99], a[88:91], a[16:19], 0
    buffer_load_dwordx4 v16, s[40:43], s51 offen offset:2048 lds
    v_mfma_f32_16x16x32_bf16 a[104:107], a[88:91], a[20:23], 0
    v_mfma_f32_16x16x32_bf16 a[112:115], a[88:91], a[24:27], 0
    v_mfma_f32_16x16x32_bf16 a[120:123], a[88:91], a[28:31], 0
    ds_read_b64_tr_b16 a[88:89], v14 offset:16384
    s_waitcnt lgkmcnt(15)
    v_mfma_f32_16x16x32_bf16 v[228:231], a[92:95], a[0:3], 0
    ds_read_b64_tr_b16 a[90:91], v14 offset:18432
    v_mfma_f32_16x16x32_bf16 v[236:239], a[92:95], a[4:7], 0
    v_add_u32 v6, s63, v6
    v_add_u32 v7, s63, v7
    v_mfma_f32_16x16x32_bf16 v[244:247], a[92:95], a[8:11], 0
    buffer_store_dwordx4 a[136:139], v2, s[24:27], s28 offen sc1
    v_mfma_f32_16x16x32_bf16 v[252:255], a[92:95], a[12:15], 0
    s_add_u32 s28, s28, s31
    v_mfma_f32_16x16x32_bf16 a[100:103], a[92:95], a[16:19], 0
    buffer_load_dwordx4 v17, s[40:43], s51 offen offset:3072 lds
    v_mfma_f32_16x16x32_bf16 a[108:111], a[92:95], a[20:23], 0
    s_add_u32 s51, s51, 128
    v_mfma_f32_16x16x32_bf16 a[116:119], a[92:95], a[24:27], 0
    v_mfma_f32_16x16x32_bf16 a[124:127], a[92:95], a[28:31], 0
    ds_read_b64_tr_b16 a[92:93], v15 offset:16384
    ds_read_b64_tr_b16 a[94:95], v15 offset:18432
    v_mfma_f32_16x16x32_bf16 v[32:35], a[64:67], a[32:35], v[32:35]
    v_xor_b32 v8, s60, v8
    v_xor_b32 v9, s60, v9
    v_mfma_f32_16x16x32_bf16 v[40:43], a[64:67], a[36:39], v[40:43]
    v_xor_b32 v10, s60, v10
    v_xor_b32 v11, s60, v11
    s_waitcnt lgkmcnt(15)
    v_mfma_f32_16x16x32_bf16 v[48:51], a[64:67], a[40:43], v[48:51]
    v_xor_b32 v12, s60, v12
    v_xor_b32 v13, s60, v13
    v_mfma_f32_16x16x32_bf16 v[56:59], a[64:67], a[44:47], v[56:59]
    v_xor_b32 v14, s60, v14
    v_xor_b32 v15, s60, v15
    s_waitcnt lgkmcnt(13)
    v_mfma_f32_16x16x32_bf16 v[64:67], a[64:67], a[48:51], v[64:67]
    s_waitcnt lgkmcnt(12)
    v_mfma_f32_16x16x32_bf16 v[72:75], a[64:67], a[52:55], v[72:75]
    s_waitcnt lgkmcnt(9)
    v_mfma_f32_16x16x32_bf16 v[80:83], a[64:67], a[56:59], v[80:83]
    s_waitcnt vmcnt(11) lgkmcnt(0)
    v_mfma_f32_16x16x32_bf16 v[88:91], a[64:67], a[60:63], v[88:91]
    s_barrier
    ds_read_b64_tr_b16 a[64:65], v8 offset:0
    v_mfma_f32_16x16x32_bf16 v[36:39], a[68:71], a[32:35], v[36:39]
    s_add_u32 m0, s62, 0
    ds_read_b64_tr_b16 a[66:67], v8 offset:2048
    v_mfma_f32_16x16x32_bf16 v[44:47], a[68:71], a[36:39], v[44:47]
    buffer_load_dwordx4 v18, s[44:47], s52 offen offset:0 lds
    v_mfma_f32_16x16x32_bf16 v[52:55], a[68:71], a[40:43], v[52:55]
    ds_read_b128 a[0:3], v6 offset:0
    v_mfma_f32_16x16x32_bf16 v[60:63], a[68:71], a[44:47], v[60:63]
    v_mfma_f32_16x16x32_bf16 v[68:71], a[68:71], a[48:51], v[68:71]
    v_mfma_f32_16x16x32_bf16 v[76:79], a[68:71], a[52:55], v[76:79]
    buffer_load_dwordx4 v19, s[44:47], s52 offen offset:1024 lds
    v_mfma_f32_16x16x32_bf16 v[84:87], a[68:71], a[56:59], v[84:87]
    s_add_u32 s52, s52, s56
    ds_read_b128 a[4:7], v6 offset:2048
    v_mfma_f32_16x16x32_bf16 v[92:95], a[68:71], a[60:63], v[92:95]
    ds_read_b64_tr_b16 a[68:69], v9 offset:0
    v_mfma_f32_16x16x32_bf16 v[96:99], a[72:75], a[32:35], v[96:99]
    ds_read_b64_tr_b16 a[70:71], v9 offset:2048
    v_mfma_f32_16x16x32_bf16 v[104:107], a[72:75], a[36:39], v[104:107]
    buffer_load_dwordx4 v18, s[44:47], s53 offen offset:2048 lds
    v_mfma_f32_16x16x32_bf16 v[112:115], a[72:75], a[40:43], v[112:115]
    ds_read_b128 a[8:11], v6 offset:4096
    v_mfma_f32_16x16x32_bf16 v[120:123], a[72:75], a[44:47], v[120:123]
    v_mfma_f32_16x16x32_bf16 v[128:131], a[72:75], a[48:51], v[128:131]
    v_mfma_f32_16x16x32_bf16 v[136:139], a[72:75], a[52:55], v[136:139]
    buffer_load_dwordx4 v19, s[44:47], s53 offen offset:3072 lds
    v_mfma_f32_16x16x32_bf16 v[144:147], a[72:75], a[56:59], v[144:147]
    s_add_u32 s53, s53, s56
    ds_read_b128 a[12:15], v6 offset:6144
    v_mfma_f32_16x16x32_bf16 v[152:155], a[72:75], a[60:63], v[152:155]
    ds_read_b64_tr_b16 a[72:73], v10 offset:0
    v_mfma_f32_16x16x32_bf16 v[100:103], a[76:79], a[32:35], v[100:103]
    s_add_u32 m0, s62, 4096
    ds_read_b64_tr_b16 a[74:75], v10 offset:2048
    v_mfma_f32_16x16x32_bf16 v[108:111], a[76:79], a[36:39], v[108:111]
    buffer_load_dwordx4 v20, s[44:47], s54 offen offset:0 lds
    v_mfma_f32_16x16x32_bf16 v[116:119], a[76:79], a[40:43], v[116:119]
    ds_read_b128 a[16:19], v6 offset:8192
    v_mfma_f32_16x16x32_bf16 v[124:127], a[76:79], a[44:47], v[124:127]
    s_xor_b32 s62, s62, 229376
    v_mfma_f32_16x16x32_bf16 v[132:135], a[76:79], a[48:51], v[132:135]
    v_mfma_f32_16x16x32_bf16 v[140:143], a[76:79], a[52:55], v[140:143]
    buffer_load_dwordx4 v21, s[44:47], s54 offen offset:1024 lds
    v_mfma_f32_16x16x32_bf16 v[148:151], a[76:79], a[56:59], v[148:151]
    s_add_u32 s54, s54, s56
    ds_read_b128 a[20:23], v6 offset:10240
    v_mfma_f32_16x16x32_bf16 v[156:159], a[76:79], a[60:63], v[156:159]
    ds_read_b64_tr_b16 a[76:77], v11 offset:0
    v_mfma_f32_16x16x32_bf16 v[160:163], a[80:83], a[32:35], v[160:163]
    ds_read_b64_tr_b16 a[78:79], v11 offset:2048
    v_mfma_f32_16x16x32_bf16 v[168:171], a[80:83], a[36:39], v[168:171]
    buffer_load_dwordx4 v20, s[44:47], s55 offen offset:2048 lds
    v_mfma_f32_16x16x32_bf16 v[176:179], a[80:83], a[40:43], v[176:179]
    ds_read_b128 a[24:27], v6 offset:12288
    v_mfma_f32_16x16x32_bf16 v[184:187], a[80:83], a[44:47], v[184:187]
    v_mfma_f32_16x16x32_bf16 v[192:195], a[80:83], a[48:51], v[192:195]
    v_mfma_f32_16x16x32_bf16 v[200:203], a[80:83], a[52:55], v[200:203]
    buffer_load_dwordx4 v21, s[44:47], s55 offen offset:3072 lds
    v_mfma_f32_16x16x32_bf16 v[208:211], a[80:83], a[56:59], v[208:211]
    s_add_u32 s55, s55, s56
    ds_read_b128 a[28:31], v6 offset:14336
    v_mfma_f32_16x16x32_bf16 v[216:219], a[80:83], a[60:63], v[216:219]
    ds_read_b64_tr_b16 a[80:81], v12 offset:0
    v_mfma_f32_16x16x32_bf16 v[164:167], a[84:87], a[32:35], v[164:167]
    ds_read_b64_tr_b16 a[82:83], v12 offset:2048
    v_mfma_f32_16x16x32_bf16 v[172:175], a[84:87], a[36:39], v[172:175]
    v_mfma_f32_16x16x32_bf16 v[180:183], a[84:87], a[40:43], v[180:183]
    buffer_store_dwordx4 a[140:143], v2, s[24:27], s28 offen sc1
    v_mfma_f32_16x16x32_bf16 v[188:191], a[84:87], a[44:47], v[188:191]
    s_add_u32 s28, s28, s31
    v_mfma_f32_16x16x32_bf16 v[196:199], a[84:87], a[48:51], v[196:199]
    v_mfma_f32_16x16x32_bf16 v[204:207], a[84:87], a[52:55], v[204:207]
    v_mfma_f32_16x16x32_bf16 v[212:215], a[84:87], a[56:59], v[212:215]
    buffer_store_dwordx4 a[144:147], v2, s[24:27], s28 offen sc1
    v_mfma_f32_16x16x32_bf16 v[220:223], a[84:87], a[60:63], v[220:223]
    s_add_u32 s28, s28, s31
    ds_read_b64_tr_b16 a[84:85], v13 offset:0
    v_mfma_f32_16x16x32_bf16 v[224:227], a[88:91], a[32:35], v[224:227]
    ds_read_b64_tr_b16 a[86:87], v13 offset:2048
    v_mfma_f32_16x16x32_bf16 v[232:235], a[88:91], a[36:39], v[232:235]
    v_mfma_f32_16x16x32_bf16 v[240:243], a[88:91], a[40:43], v[240:243]
    buffer_store_dwordx4 a[148:151], v2, s[24:27], s28 offen sc1
    v_mfma_f32_16x16x32_bf16 v[248:251], a[88:91], a[44:47], v[248:251]
    s_add_u32 s28, s28, s31
    v_mfma_f32_16x16x32_bf16 a[96:99], a[88:91], a[48:51], a[96:99]
    v_mfma_f32_16x16x32_bf16 a[104:107], a[88:91], a[52:55], a[104:107]
    v_mfma_f32_16x16x32_bf16 a[112:115], a[88:91], a[56:59], a[112:115]
    buffer_store_dwordx4 a[152:155], v2, s[24:27], s28 offen sc1
    v_mfma_f32_16x16x32_bf16 a[120:123], a[88:91], a[60:63], a[120:123]
    s_add_u32 s28, s28, s31
    ds_read_b64_tr_b16 a[88:89], v14 offset:0
    v_mfma_f32_16x16x32_bf16 v[228:231], a[92:95], a[32:35], v[228:231]
    ds_read_b64_tr_b16 a[90:91], v14 offset:2048
    v_mfma_f32_16x16x32_bf16 v[236:239], a[92:95], a[36:39], v[236:239]
    v_mfma_f32_16x16x32_bf16 v[244:247], a[92:95], a[40:43], v[244:247]
    buffer_store_dwordx4 a[156:159], v2, s[24:27], s28 offen sc1
    v_mfma_f32_16x16x32_bf16 v[252:255], a[92:95], a[44:47], v[252:255]
    s_add_u32 s29, s29, s30
    s_mov_b32 s28, s29
    v_mfma_f32_16x16x32_bf16 a[100:103], a[92:95], a[48:51], a[100:103]
    s_sub_u32 s65, s65, 1
    v_mfma_f32_16x16x32_bf16 a[108:111], a[92:95], a[52:55], a[108:111]
    v_mfma_f32_16x16x32_bf16 a[116:119], a[92:95], a[56:59], a[116:119]
    v_mfma_f32_16x16x32_bf16 a[124:127], a[92:95], a[60:63], a[124:127]
    ds_read_b64_tr_b16 a[92:93], v15 offset:0
    ds_read_b64_tr_b16 a[94:95], v15 offset:2048
    s_waitcnt lgkmcnt(15)
    v_mfma_f32_16x16x32_bf16 v[32:35], a[64:67], a[0:3], v[32:35]
    v_mfma_f32_16x16x32_bf16 v[40:43], a[64:67], a[4:7], v[40:43]
    v_mfma_f32_16x16x32_bf16 v[48:51], a[64:67], a[8:11], v[48:51]
    v_mfma_f32_16x16x32_bf16 v[56:59], a[64:67], a[12:15], v[56:59]
    s_add_u32 m0, s61, 0
    s_waitcnt lgkmcnt(13)
    v_mfma_f32_16x16x32_bf16 v[64:67], a[64:67], a[16:19], v[64:67]
    buffer_load_dwordx4 v16, s[40:43], s48 offen offset:0 lds
    s_waitcnt lgkmcnt(12)
    v_mfma_f32_16x16x32_bf16 v[72:75], a[64:67], a[20:23], v[72:75]
    s_waitcnt lgkmcnt(9)
    v_mfma_f32_16x16x32_bf16 v[80:83], a[64:67], a[24:27], v[80:83]
    s_waitcnt lgkmcnt(8)
    v_mfma_f32_16x16x32_bf16 v[88:91], a[64:67], a[28:31], v[88:91]
    ds_read_b64_tr_b16 a[64:65], v8 offset:16384
    v_mfma_f32_16x16x32_bf16 v[36:39], a[68:71], a[0:3], v[36:39]
    ds_read_b64_tr_b16 a[66:67], v8 offset:18432
    v_mfma_f32_16x16x32_bf16 v[44:47], a[68:71], a[4:7], v[44:47]
    v_mfma_f32_16x16x32_bf16 v[52:55], a[68:71], a[8:11], v[52:55]
    ds_read_b128 a[32:35], v7 offset:0
    v_mfma_f32_16x16x32_bf16 v[60:63], a[68:71], a[12:15], v[60:63]
    v_mfma_f32_16x16x32_bf16 v[68:71], a[68:71], a[16:19], v[68:71]
    buffer_load_dwordx4 v17, s[40:43], s48 offen offset:1024 lds
    v_mfma_f32_16x16x32_bf16 v[76:79], a[68:71], a[20:23], v[76:79]
    s_add_u32 s48, s48, 128
    v_mfma_f32_16x16x32_bf16 v[84:87], a[68:71], a[24:27], v[84:87]
    ds_read_b128 a[36:39], v7 offset:2048
    v_mfma_f32_16x16x32_bf16 v[92:95], a[68:71], a[28:31], v[92:95]
    ds_read_b64_tr_b16 a[68:69], v9 offset:16384
    v_mfma_f32_16x16x32_bf16 v[96:99], a[72:75], a[0:3], v[96:99]
    ds_read_b64_tr_b16 a[70:71], v9 offset:18432
    v_mfma_f32_16x16x32_bf16 v[104:107], a[72:75], a[4:7], v[104:107]
    v_mfma_f32_16x16x32_bf16 v[112:115], a[72:75], a[8:11], v[112:115]
    ds_read_b128 a[40:43], v7 offset:4096
    v_mfma_f32_16x16x32_bf16 v[120:123], a[72:75], a[12:15], v[120:123]
    v_mfma_f32_16x16x32_bf16 v[128:131], a[72:75], a[16:19], v[128:131]
    buffer_load_dwordx4 v16, s[40:43], s49 offen offset:2048 lds
    v_mfma_f32_16x16x32_bf16 v[136:139], a[72:75], a[20:23], v[136:139]
    v_mfma_f32_16x16x32_bf16 v[144:147], a[72:75], a[24:27], v[144:147]
    ds_read_b128 a[44:47], v7 offset:6144
    v_mfma_f32_16x16x32_bf16 v[152:155], a[72:75], a[28:31], v[152:155]
    ds_read_b64_tr_b16 a[72:73], v10 offset:16384
    v_mfma_f32_16x16x32_bf16 v[100:103], a[76:79], a[0:3], v[100:103]
    ds_read_b64_tr_b16 a[74:75], v10 offset:18432
    v_mfma_f32_16x16x32_bf16 v[108:111], a[76:79], a[4:7], v[108:111]
    v_mfma_f32_16x16x32_bf16 v[116:119], a[76:79], a[8:11], v[116:119]
    ds_read_b128 a[48:51], v7 offset:8192
    v_mfma_f32_16x16x32_bf16 v[124:127], a[76:79], a[12:15], v[124:127]
    v_mfma_f32_16x16x32_bf16 v[132:135], a[76:79], a[16:19], v[132:135]
    buffer_load_dwordx4 v17, s[40:43], s49 offen offset:3072 lds
    v_mfma_f32_16x16x32_bf16 v[140:143], a[76:79], a[20:23], v[140:143]
    s_add_u32 s49, s49, 128
    v_mfma_f32_16x16x32_bf16 v[148:151], a[76:79], a[24:27], v[148:151]
    ds_read_b128 a[52:55], v7 offset:10240
    v_mfma_f32_16x16x32_bf16 v[156:159], a[76:79], a[28:31], v[156:159]
    ds_read_b64_tr_b16 a[76:77], v11 offset:16384
    s_waitcnt lgkmcnt(15)
    v_mfma_f32_16x16x32_bf16 v[160:163], a[80:83], a[0:3], v[160:163]
    ds_read_b64_tr_b16 a[78:79], v11 offset:18432
    v_mfma_f32_16x16x32_bf16 v[168:171], a[80:83], a[4:7], v[168:171]
    v_mfma_f32_16x16x32_bf16 v[176:179], a[80:83], a[8:11], v[176:179]
    ds_read_b128 a[56:59], v7 offset:12288
    v_mfma_f32_16x16x32_bf16 v[184:187], a[80:83], a[12:15], v[184:187]
    s_add_u32 m0, s61, 4096
    v_mfma_f32_16x16x32_bf16 v[192:195], a[80:83], a[16:19], v[192:195]
    buffer_load_dwordx4 v16, s[40:43], s50 offen offset:0 lds
    v_mfma_f32_16x16x32_bf16 v[200:203], a[80:83], a[20:23], v[200:203]
    v_mfma_f32_16x16x32_bf16 v[208:211], a[80:83], a[24:27], v[208:211]
    s_add_u32 s61, s61, 32768
    ds_read_b128 a[60:63], v7 offset:14336
    v_mfma_f32_16x16x32_bf16 v[216:219], a[80:83], a[28:31], v[216:219]
    s_cmp_ge_u32 s61, 98304
    s_cselect_b32 s90, 98304, 0
    ds_read_b64_tr_b16 a[80:81], v12 offset:16384
    v_mfma_f32_16x16x32_bf16 v[164:167], a[84:87], a[0:3], v[164:167]
    s_sub_u32 s61, s61, s90
    ds_read_b64_tr_b16 a[82:83], v12 offset:18432
    v_mfma_f32_16x16x32_bf16 v[172:175], a[84:87], a[4:7], v[172:175]
    s_add_u32 s64, s64, 32768
    v_mfma_f32_16x16x32_bf16 v[180:183], a[84:87], a[8:11], v[180:183]
    buffer_store_dwordx4 a[160:163], v2, s[24:27], s28 offen sc1
    v_mfma_f32_16x16x32_bf16 v[188:191], a[84:87], a[12:15], v[188:191]
    s_add_u32 s28, s28, s31
    v_mfma_f32_16x16x32_bf16 v[196:199], a[84:87], a[16:19], v[196:199]
    buffer_load_dwordx4 v17, s[40:43], s50 offen offset:1024 lds
    v_mfma_f32_16x16x32_bf16 v[204:207], a[84:87], a[20:23], v[204:207]
    s_add_u32 s50, s50, 128
    v_mfma_f32_16x16x32_bf16 v[212:215], a[84:87], a[24:27], v[212:215]
    s_cmp_ge_u32 s64, 98304
    s_cselect_b32 s63, 4294901760, s59
    s_cselect_b32 s64, 0, s64
    v_mfma_f32_16x16x32_bf16 v[220:223], a[84:87], a[28:31], v[220:223]
    ds_read_b64_tr_b16 a[84:85], v13 offset:16384
    v_mfma_f32_16x16x32_bf16 v[224:227], a[88:91], a[0:3], v[224:227]
    ds_read_b64_tr_b16 a[86:87], v13 offset:18432
    v_mfma_f32_16x16x32_bf16 v[232:235], a[88:91], a[4:7], v[232:235]
    v_mfma_f32_16x16x32_bf16 v[240:243], a[88:91], a[8:11], v[240:243]
    buffer_store_dwordx4 a[164:167], v2, s[24:27], s28 offen sc1
    v_mfma_f32_16x16x32_bf16 v[248:251], a[88:91], a[12:15], v[248:251]
    s_add_u32 s28, s28, s31
    v_mfma_f32_16x16x32_bf16 a[96:99], a[88:91], a[16:19], a[96:99]
    buffer_load_dwordx4 v16, s[40:43], s51 offen offset:2048 lds
    v_mfma_f32_16x16x32_bf16 a[104:107], a[88:91], a[20:23], a[104:107]
    v_mfma_f32_16x16x32_bf16 a[112:115], a[88:91], a[24:27], a[112:115]
    v_mfma_f32_16x16x32_bf16 a[120:123], a[88:91], a[28:31], a[120:123]
    ds_read_b64_tr_b16 a[88:89], v14 offset:16384
    s_waitcnt lgkmcnt(15)
    v_mfma_f32_16x16x32_bf16 v[228:231], a[92:95], a[0:3], v[228:231]
    ds_read_b64_tr_b16 a[90:91], v14 offset:18432
    v_mfma_f32_16x16x32_bf16 v[236:239], a[92:95], a[4:7], v[236:239]
    v_add_u32 v6, s63, v6
    v_add_u32 v7, s63, v7
    v_mfma_f32_16x16x32_bf16 v[244:247], a[92:95], a[8:11], v[244:247]
    buffer_store_dwordx4 a[168:171], v2, s[24:27], s28 offen sc1
    v_mfma_f32_16x16x32_bf16 v[252:255], a[92:95], a[12:15], v[252:255]
    s_add_u32 s28, s28, s31
    v_mfma_f32_16x16x32_bf16 a[100:103], a[92:95], a[16:19], a[100:103]
    buffer_load_dwordx4 v17, s[40:43], s51 offen offset:3072 lds
    v_mfma_f32_16x16x32_bf16 a[108:111], a[92:95], a[20:23], a[108:111]
    s_add_u32 s51, s51, 128
    v_mfma_f32_16x16x32_bf16 a[116:119], a[92:95], a[24:27], a[116:119]
    v_mfma_f32_16x16x32_bf16 a[124:127], a[92:95], a[28:31], a[124:127]
    ds_read_b64_tr_b16 a[92:93], v15 offset:16384
    ds_read_b64_tr_b16 a[94:95], v15 offset:18432
    v_mfma_f32_16x16x32_bf16 v[32:35], a[64:67], a[32:35], v[32:35]
    v_xor_b32 v8, s60, v8
    v_xor_b32 v9, s60, v9
    v_mfma_f32_16x16x32_bf16 v[40:43], a[64:67], a[36:39], v[40:43]
    v_xor_b32 v10, s60, v10
    v_xor_b32 v11, s60, v11
    s_waitcnt lgkmcnt(15)
    v_mfma_f32_16x16x32_bf16 v[48:51], a[64:67], a[40:43], v[48:51]
    v_xor_b32 v12, s60, v12
    v_xor_b32 v13, s60, v13
    v_mfma_f32_16x16x32_bf16 v[56:59], a[64:67], a[44:47], v[56:59]
    v_xor_b32 v14, s60, v14
    v_xor_b32 v15, s60, v15
    s_waitcnt lgkmcnt(13)
    v_mfma_f32_16x16x32_bf16 v[64:67], a[64:67], a[48:51], v[64:67]
    s_waitcnt lgkmcnt(12)
    v_mfma_f32_16x16x32_bf16 v[72:75], a[64:67], a[52:55], v[72:75]
    s_waitcnt lgkmcnt(9)
    v_mfma_f32_16x16x32_bf16 v[80:83], a[64:67], a[56:59], v[80:83]
    s_waitcnt vmcnt(16) lgkmcnt(0)
    v_mfma_f32_16x16x32_bf16 v[88:91], a[64:67], a[60:63], v[88:91]
    s_barrier
    ds_read_b64_tr_b16 a[64:65], v8 offset:0
    v_mfma_f32_16x16x32_bf16 v[36:39], a[68:71], a[32:35], v[36:39]
    s_add_u32 m0, s62, 0
    ds_read_b64_tr_b16 a[66:67], v8 offset:2048
    v_mfma_f32_16x16x32_bf16 v[44:47], a[68:71], a[36:39], v[44:47]
    buffer_load_dwordx4 v18, s[44:47], s52 offen offset:0 lds
    v_mfma_f32_16x16x32_bf16 v[52:55], a[68:71], a[40:43], v[52:55]
    ds_read_b128 a[0:3], v6 offset:0
    v_mfma_f32_16x16x32_bf16 v[60:63], a[68:71], a[44:47], v[60:63]
    v_mfma_f32_16x16x32_bf16 v[68:71], a[68:71], a[48:51], v[68:71]
    v_mfma_f32_16x16x32_bf16 v[76:79], a[68:71], a[52:55], v[76:79]
    buffer_load_dwordx4 v19, s[44:47], s52 offen offset:1024 lds
    v_mfma_f32_16x16x32_bf16 v[84:87], a[68:71], a[56:59], v[84:87]
    s_add_u32 s52, s52, s56
    ds_read_b128 a[4:7], v6 offset:2048
    v_mfma_f32_16x16x32_bf16 v[92:95], a[68:71], a[60:63], v[92:95]
    ds_read_b64_tr_b16 a[68:69], v9 offset:0
    v_mfma_f32_16x16x32_bf16 v[96:99], a[72:75], a[32:35], v[96:99]
    ds_read_b64_tr_b16 a[70:71], v9 offset:2048
    v_mfma_f32_16x16x32_bf16 v[104:107], a[72:75], a[36:39], v[104:107]
    buffer_load_dwordx4 v18, s[44:47], s53 offen offset:2048 lds
    v_mfma_f32_16x16x32_bf16 v[112:115], a[72:75], a[40:43], v[112:115]
    ds_read_b128 a[8:11], v6 offset:4096
    v_mfma_f32_16x16x32_bf16 v[120:123], a[72:75], a[44:47], v[120:123]
    v_mfma_f32_16x16x32_bf16 v[128:131], a[72:75], a[48:51], v[128:131]
    v_mfma_f32_16x16x32_bf16 v[136:139], a[72:75], a[52:55], v[136:139]
    buffer_load_dwordx4 v19, s[44:47], s53 offen offset:3072 lds
    v_mfma_f32_16x16x32_bf16 v[144:147], a[72:75], a[56:59], v[144:147]
    s_add_u32 s53, s53, s56
    ds_read_b128 a[12:15], v6 offset:6144
    v_mfma_f32_16x16x32_bf16 v[152:155], a[72:75], a[60:63], v[152:155]
    ds_read_b64_tr_b16 a[72:73], v10 offset:0
    v_mfma_f32_16x16x32_bf16 v[100:103], a[76:79], a[32:35], v[100:103]
    s_add_u32 m0, s62, 4096
    ds_read_b64_tr_b16 a[74:75], v10 offset:2048
    v_mfma_f32_16x16x32_bf16 v[108:111], a[76:79], a[36:39], v[108:111]
    buffer_load_dwordx4 v20, s[44:47], s54 offen offset:0 lds
    v_mfma_f32_16x16x32_bf16 v[116:119], a[76:79], a[40:43], v[116:119]
    ds_read_b128 a[16:19], v6 offset:8192
    v_mfma_f32_16x16x32_bf16 v[124:127], a[76:79], a[44:47], v[124:127]
    s_xor_b32 s62, s62, 229376
    v_mfma_f32_16x16x32_bf16 v[132:135], a[76:79], a[48:51], v[132:135]
    v_mfma_f32_16x16x32_bf16 v[140:143], a[76:79], a[52:55], v[140:143]
    buffer_load_dwordx4 v21, s[44:47], s54 offen offset:1024 lds
    v_mfma_f32_16x16x32_bf16 v[148:151], a[76:79], a[56:59], v[148:151]
    s_add_u32 s54, s54, s56
    ds_read_b128 a[20:23], v6 offset:10240
    v_mfma_f32_16x16x32_bf16 v[156:159], a[76:79], a[60:63], v[156:159]
    ds_read_b64_tr_b16 a[76:77], v11 offset:0
    v_mfma_f32_16x16x32_bf16 v[160:163], a[80:83], a[32:35], v[160:163]
    ds_read_b64_tr_b16 a[78:79], v11 offset:2048
    v_mfma_f32_16x16x32_bf16 v[168:171], a[80:83], a[36:39], v[168:171]
    buffer_load_dwordx4 v20, s[44:47], s55 offen offset:2048 lds
    v_mfma_f32_16x16x32_bf16 v[176:179], a[80:83], a[40:43], v[176:179]
    ds_read_b128 a[24:27], v6 offset:12288
    v_mfma_f32_16x16x32_bf16 v[184:187], a[80:83], a[44:47], v[184:187]
    v_mfma_f32_16x16x32_bf16 v[192:195], a[80:83], a[48:51], v[192:195]
    v_mfma_f32_16x16x32_bf16 v[200:203], a[80:83], a[52:55], v[200:203]
    buffer_load_dwordx4 v21, s[44:47], s55 offen offset:3072 lds
    v_mfma_f32_16x16x32_bf16 v[208:211], a[80:83], a[56:59], v[208:211]
    s_add_u32 s55, s55, s56
    ds_read_b128 a[28:31], v6 offset:14336
    v_mfma_f32_16x16x32_bf16 v[216:219], a[80:83], a[60:63], v[216:219]
    ds_read_b64_tr_b16 a[80:81], v12 offset:0
    v_mfma_f32_16x16x32_bf16 v[164:167], a[84:87], a[32:35], v[164:167]
    ds_read_b64_tr_b16 a[82:83], v12 offset:2048
    v_mfma_f32_16x16x32_bf16 v[172:175], a[84:87], a[36:39], v[172:175]
    v_mfma_f32_16x16x32_bf16 v[180:183], a[84:87], a[40:43], v[180:183]
    buffer_store_dwordx4 a[172:175], v2, s[24:27], s28 offen sc1
    v_mfma_f32_16x16x32_bf16 v[188:191], a[84:87], a[44:47], v[188:191]
    s_add_u32 s28, s28, s31
    v_mfma_f32_16x16x32_bf16 v[196:199], a[84:87], a[48:51], v[196:199]
    v_mfma_f32_16x16x32_bf16 v[204:207], a[84:87], a[52:55], v[204:207]
    v_mfma_f32_16x16x32_bf16 v[212:215], a[84:87], a[56:59], v[212:215]
    buffer_store_dwordx4 a[176:179], v2, s[24:27], s28 offen sc1
    v_mfma_f32_16x16x32_bf16 v[220:223], a[84:87], a[60:63], v[220:223]
    s_add_u32 s28, s28, s31
    ds_read_b64_tr_b16 a[84:85], v13 offset:0
    v_mfma_f32_16x16x32_bf16 v[224:227], a[88:91], a[32:35], v[224:227]
    ds_read_b64_tr_b16 a[86:87], v13 offset:2048
    v_mfma_f32_16x16x32_bf16 v[232:235], a[88:91], a[36:39], v[232:235]
    v_mfma_f32_16x16x32_bf16 v[240:243], a[88:91], a[40:43], v[240:243]
    buffer_store_dwordx4 a[180:183], v2, s[24:27], s28 offen sc1
    v_mfma_f32_16x16x32_bf16 v[248:251], a[88:91], a[44:47], v[248:251]
    s_add_u32 s28, s28, s31
    v_mfma_f32_16x16x32_bf16 a[96:99], a[88:91], a[48:51], a[96:99]
    v_mfma_f32_16x16x32_bf16 a[104:107], a[88:91], a[52:55], a[104:107]
    v_mfma_f32_16x16x32_bf16 a[112:115], a[88:91], a[56:59], a[112:115]
    buffer_store_dwordx4 a[184:187], v2, s[24:27], s28 offen sc1
    v_mfma_f32_16x16x32_bf16 a[120:123], a[88:91], a[60:63], a[120:123]
    s_add_u32 s28, s28, s31
    ds_read_b64_tr_b16 a[88:89], v14 offset:0
    v_mfma_f32_16x16x32_bf16 v[228:231], a[92:95], a[32:35], v[228:231]
    ds_read_b64_tr_b16 a[90:91], v14 offset:2048
    v_mfma_f32_16x16x32_bf16 v[236:239], a[92:95], a[36:39], v[236:239]
    v_mfma_f32_16x16x32_bf16 v[244:247], a[92:95], a[40:43], v[244:247]
    buffer_store_dwordx4 a[188:191], v2, s[24:27], s28 offen sc1
    v_mfma_f32_16x16x32_bf16 v[252:255], a[92:95], a[44:47], v[252:255]
    s_add_u32 s29, s29, s30
    s_mov_b32 s28, s29
    v_mfma_f32_16x16x32_bf16 a[100:103], a[92:95], a[48:51], a[100:103]
    s_sub_u32 s65, s65, 1
    v_mfma_f32_16x16x32_bf16 a[108:111], a[92:95], a[52:55], a[108:111]
    v_mfma_f32_16x16x32_bf16 a[116:119], a[92:95], a[56:59], a[116:119]
    v_mfma_f32_16x16x32_bf16 a[124:127], a[92:95], a[60:63], a[124:127]
    ds_read_b64_tr_b16 a[92:93], v15 offset:0
    ds_read_b64_tr_b16 a[94:95], v15 offset:2048
    s_cmp_eq_u32 s66, 2
    s_cbranch_scc1 m_hook14
m_hookr15:
    s_waitcnt lgkmcnt(15)
    v_mfma_f32_16x16x32_bf16 v[32:35], a[64:67], a[0:3], v[32:35]
    v_mfma_f32_16x16x32_bf16 v[40:43], a[64:67], a[4:7], v[40:43]
    v_mfma_f32_16x16x32_bf16 v[48:51], a[64:67], a[8:11], v[48:51]
    v_mfma_f32_16x16x32_bf16 v[56:59], a[64:67], a[12:15], v[56:59]
    s_add_u32 m0, s61, 0
    s_waitcnt lgkmcnt(13)
    v_mfma_f32_16x16x32_bf16 v[64:67], a[64:67], a[16:19], v[64:67]
    buffer_load_dwordx4 v16, s[40:43], s48 offen offset:0 lds
    s_waitcnt lgkmcnt(12)
    v_mfma_f32_16x16x32_bf16 v[72:75], a[64:67], a[20:23], v[72:75]
    s_waitcnt lgkmcnt(9)
    v_mfma_f32_16x16x32_bf16 v[80:83], a[64:67], a[24:27], v[80:83]
    s_waitcnt lgkmcnt(8)
    v_mfma_f32_16x16x32_bf16 v[88:91], a[64:67], a[28:31], v[88:91]
    ds_read_b64_tr_b16 a[64:65], v8 offset:16384
    v_mfma_f32_16x16x32_bf16 v[36:39], a[68:71], a[0:3], v[36:39]
    ds_read_b64_tr_b16 a[66:67], v8 offset:18432
    v_mfma_f32_16x16x32_bf16 v[44:47], a[68:71], a[4:7], v[44:47]
    v_mfma_f32_16x16x32_bf16 v[52:55], a[68:71], a[8:11], v[52:55]
    ds_read_b128 a[32:35], v7 offset:0
    v_mfma_f32_16x16x32_bf16 v[60:63], a[68:71], a[12:15], v[60:63]
    v_mfma_f32_16x16x32_bf16 v[68:71], a[68:71], a[16:19], v[68:71]
    buffer_load_dwordx4 v17, s[40:43], s48 offen offset:1024 lds
    v_mfma_f32_16x16x32_bf16 v[76:79], a[68:71], a[20:23], v[76:79]
    s_add_u32 s48, s48, 128
    v_mfma_f32_16x16x32_bf16 v[84:87], a[68:71], a[24:27], v[84:87]
    ds_read_b128 a[36:39], v7 offset:2048
    v_mfma_f32_16x16x32_bf16 v[92:95], a[68:71], a[28:31], v[92:95]
    ds_read_b64_tr_b16 a[68:69], v9 offset:16384
    v_mfma_f32_16x16x32_bf16 v[96:99], a[72:75], a[0:3], v[96:99]
    ds_read_b64_tr_b16 a[70:71], v9 offset:18432
    v_mfma_f32_16x16x32_bf16 v[104:107], a[72:75], a[4:7], v[104:107]
    v_mfma_f32_16x16x32_bf16 v[112:115], a[72:75], a[8:11], v[112:115]
    ds_read_b128 a[40:43], v7 offset:4096
    v_mfma_f32_16x16x32_bf16 v[120:123], a[72:75], a[12:15], v[120:123]
    v_mfma_f32_16x16x32_bf16 v[128:131], a[72:75], a[16:19], v[128:131]
    buffer_load_dwordx4 v16, s[40:43], s49 offen offset:2048 lds
    v_mfma_f32_16x16x32_bf16 v[136:139], a[72:75], a[20:23], v[136:139]
    v_mfma_f32_16x16x32_bf16 v[144:147], a[72:75], a[24:27], v[144:147]
    ds_read_b128 a[44:47], v7 offset:6144
    v_mfma_f32_16x16x32_bf16 v[152:155], a[72:75], a[28:31], v[152:155]
    ds_read_b64_tr_b16 a[72:73], v10 offset:16384
    v_mfma_f32_16x16x32_bf16 v[100:103], a[76:79], a[0:3], v[100:103]
    ds_read_b64_tr_b16 a[74:75], v10 offset:18432
    v_mfma_f32_16x16x32_bf16 v[108:111], a[76:79], a[4:7], v[108:111]
    v_mfma_f32_16x16x32_bf16 v[116:119], a[76:79], a[8:11], v[116:119]
    ds_read_b128 a[48:51], v7 offset:8192
    v_mfma_f32_16x16x32_bf16 v[124:127], a[76:79], a[12:15], v[124:127]
    v_mfma_f32_16x16x32_bf16 v[132:135], a[76:79], a[16:19], v[132:135]
    buffer_load_dwordx4 v17, s[40:43], s49 offen offset:3072 lds
    v_mfma_f32_16x16x32_bf16 v[140:143], a[76:79], a[20:23], v[140:143]
    s_add_u32 s49, s49, 128
    v_mfma_f32_16x16x32_bf16 v[148:151], a[76:79], a[24:27], v[148:151]
    ds_read_b128 a[52:55], v7 offset:10240
    v_mfma_f32_16x16x32_bf16 v[156:159], a[76:79], a[28:31], v[156:159]
    ds_read_b64_tr_b16 a[76:77], v11 offset:16384
    s_waitcnt lgkmcnt(15)
    v_mfma_f32_16x16x32_bf16 v[160:163], a[80:83], a[0:3], v[160:163]
    ds_read_b64_tr_b16 a[78:79], v11 offset:18432
    v_mfma_f32_16x16x32_bf16 v[168:171], a[80:83], a[4:7], v[168:171]
    v_mfma_f32_16x16x32_bf16 v[176:179], a[80:83], a[8:11], v[176:179]
    ds_read_b128 a[56:59], v7 offset:12288
    v_mfma_f32_16x16x32_bf16 v[184:187], a[80:83], a[12:15], v[184:187]
    s_add_u32 m0, s61, 4096
    v_mfma_f32_16x16x32_bf16 v[192:195], a[80:83], a[16:19], v[192:195]
    buffer_load_dwordx4 v16, s[40:43], s50 offen offset:0 lds
    v_mfma_f32_16x16x32_bf16 v[200:203], a[80:83], a[20:23], v[200:203]
    v_mfma_f32_16x16x32_bf16 v[208:211], a[80:83], a[24:27], v[208:211]
    s_add_u32 s61, s61, 32768
    ds_read_b128 a[60:63], v7 offset:14336
    v_mfma_f32_16x16x32_bf16 v[216:219], a[80:83], a[28:31], v[216:219]
    s_cmp_ge_u32 s61, 98304
    s_cselect_b32 s90, 98304, 0
    ds_read_b64_tr_b16 a[80:81], v12 offset:16384
    v_mfma_f32_16x16x32_bf16 v[164:167], a[84:87], a[0:3], v[164:167]
    s_sub_u32 s61, s61, s90
    ds_read_b64_tr_b16 a[82:83], v12 offset:18432
    v_mfma_f32_16x16x32_bf16 v[172:175], a[84:87], a[4:7], v[172:175]
    s_add_u32 s64, s64, 32768
    v_mfma_f32_16x16x32_bf16 v[180:183], a[84:87], a[8:11], v[180:183]
    buffer_store_dwordx4 a[192:195], v2, s[24:27], s28 offen sc1
    v_mfma_f32_16x16x32_bf16 v[188:191], a[84:87], a[12:15], v[188:191]
    s_add_u32 s28, s28, s31
    v_mfma_f32_16x16x32_bf16 v[196:199], a[84:87], a[16:19], v[196:199]
    buffer_load_dwordx4 v17, s[40:43], s50 offen offset:1024 lds
    v_mfma_f32_16x16x32_bf16 v[204:207], a[84:87], a[20:23], v[204:207]
    s_add_u32 s50, s50, 128
    v_mfma_f32_16x16x32_bf16 v[212:215], a[84:87], a[24:27], v[212:215]
    s_cmp_ge_u32 s64, 98304
    s_cselect_b32 s63, 4294901760, s59
    s_cselect_b32 s64, 0, s64
    v_mfma_f32_16x16x32_bf16 v[220:223], a[84:87], a[28:31], v[220:223]
    ds_read_b64_tr_b16 a[84:85], v13 offset:16384
    v_mfma_f32_16x16x32_bf16 v[224:227], a[88:91], a[0:3], v[224:227]
    ds_read_b64_tr_b16 a[86:87], v13 offset:18432
    v_mfma_f32_16x16x32_bf16 v[232:235], a[88:91], a[4:7], v[232:235]
    v_mfma_f32_16x16x32_bf16 v[240:243], a[88:91], a[8:11], v[240:243]
    buffer_store_dwordx4 a[196:199], v2, s[24:27], s28 offen sc1
    v_mfma_f32_16x16x32_bf16 v[248:251], a[88:91], a[12:15], v[248:251]
    s_add_u32 s28, s28, s31
    v_mfma_f32_16x16x32_bf16 a[96:99], a[88:91], a[16:19], a[96:99]
    buffer_load_dwordx4 v16, s[40:43], s51 offen offset:2048 lds
    v_mfma_f32_16x16x32_bf16 a[104:107], a[88:91], a[20:23], a[104:107]
    v_mfma_f32_16x16x32_bf16 a[112:115], a[88:91], a[24:27], a[112:115]
    v_mfma_f32_16x16x32_bf16 a[120:123], a[88:91], a[28:31], a[120:123]
    ds_read_b64_tr_b16 a[88:89], v14 offset:16384
    s_waitcnt lgkmcnt(15)
    v_mfma_f32_16x16x32_bf16 v[228:231], a[92:95], a[0:3], v[228:231]
    ds_read_b64_tr_b16 a[90:91], v14 offset:18432
    v_mfma_f32_16x16x32_bf16 v[236:239], a[92:95], a[4:7], v[236:239]
    v_add_u32 v6, s63, v6
    v_add_u32 v7, s63, v7
    v_mfma_f32_16x16x32_bf16 v[244:247], a[92:95], a[8:11], v[244:247]
    buffer_store_dwordx4 a[200:203], v2, s[24:27], s28 offen sc1
    v_mfma_f32_16x16x32_bf16 v[252:255], a[92:95], a[12:15], v[252:255]
    s_add_u32 s28, s28, s31
    v_mfma_f32_16x16x32_bf16 a[100:103], a[92:95], a[16:19], a[100:103]
    buffer_load_dwordx4 v17, s[40:43], s51 offen offset:3072 lds
    v_mfma_f32_16x16x32_bf16 a[108:111], a[92:95], a[20:23], a[108:111]
    s_add_u32 s51, s51, 128
    v_mfma_f32_16x16x32_bf16 a[116:119], a[92:95], a[24:27], a[116:119]
    v_mfma_f32_16x16x32_bf16 a[124:127], a[92:95], a[28:31], a[124:127]
    ds_read_b64_tr_b16 a[92:93], v15 offset:16384
    ds_read_b64_tr_b16 a[94:95], v15 offset:18432
    v_mfma_f32_16x16x32_bf16 v[32:35], a[64:67], a[32:35], v[32:35]
    v_xor_b32 v8, s60, v8
    v_xor_b32 v9, s60, v9
    v_mfma_f32_16x16x32_bf16 v[40:43], a[64:67], a[36:39], v[40:43]
    v_xor_b32 v10, s60, v10
    v_xor_b32 v11, s60, v11
    s_waitcnt lgkmcnt(15)
    v_mfma_f32_16x16x32_bf16 v[48:51], a[64:67], a[40:43], v[48:51]
    v_xor_b32 v12, s60, v12
    v_xor_b32 v13, s60, v13
    v_mfma_f32_16x16x32_bf16 v[56:59], a[64:67], a[44:47], v[56:59]
    v_xor_b32 v14, s60, v14
    v_xor_b32 v15, s60, v15
    s_waitcnt lgkmcnt(13)
    v_mfma_f32_16x16x32_bf16 v[64:67], a[64:67], a[48:51], v[64:67]
    s_waitcnt lgkmcnt(12)
    v_mfma_f32_16x16x32_bf16 v[72:75], a[64:67], a[52:55], v[72:75]
    s_waitcnt lgkmcnt(9)
    v_mfma_f32_16x16x32_bf16 v[80:83], a[64:67], a[56:59], v[80:83]
    s_waitcnt vmcnt(16) lgkmcnt(0)
    v_mfma_f32_16x16x32_bf16 v[88:91], a[64:67], a[60:63], v[88:91]
    s_barrier
    ds_read_b64_tr_b16 a[64:65], v8 offset:0
    v_mfma_f32_16x16x32_bf16 v[36:39], a[68:71], a[32:35], v[36:39]
    s_add_u32 m0, s62, 0
    ds_read_b64_tr_b16 a[66:67], v8 offset:2048
    v_mfma_f32_16x16x32_bf16 v[44:47], a[68:71], a[36:39], v[44:47]
    buffer_load_dwordx4 v18, s[44:47], s52 offen offset:0 lds
    v_mfma_f32_16x16x32_bf16 v[52:55], a[68:71], a[40:43], v[52:55]
    ds_read_b128 a[0:3], v6 offset:0
    v_mfma_f32_16x16x32_bf16 v[60:63], a[68:71], a[44:47], v[60:63]
    v_mfma_f32_16x16x32_bf16 v[68:71], a[68:71], a[48:51], v[68:71]
    v_mfma_f32_16x16x32_bf16 v[76:79], a[68:71], a[52:55], v[76:79]
    buffer_load_dwordx4 v19, s[44:47], s52 offen offset:1024 lds
    v_mfma_f32_16x16x32_bf16 v[84:87], a[68:71], a[56:59], v[84:87]
    s_add_u32 s52, s52, s56
    ds_read_b128 a[4:7], v6 offset:2048
    v_mfma_f32_16x16x32_bf16 v[92:95], a[68:71], a[60:63], v[92:95]
    ds_read_b64_tr_b16 a[68:69], v9 offset:0
    v_mfma_f32_16x16x32_bf16 v[96:99], a[72:75], a[32:35], v[96:99]
    ds_read_b64_tr_b16 a[70:71], v9 offset:2048
    v_mfma_f32_16x16x32_bf16 v[104:107], a[72:75], a[36:39], v[104:107]
    buffer_load_dwordx4 v18, s[44:47], s53 offen offset:2048 lds
    v_mfma_f32_16x16x32_bf16 v[112:115], a[72:75], a[40:43], v[112:115]
    ds_read_b128 a[8:11], v6 offset:4096
    v_mfma_f32_16x16x32_bf16 v[120:123], a[72:75], a[44:47], v[120:123]
    v_mfma_f32_16x16x32_bf16 v[128:131], a[72:75], a[48:51], v[128:131]
    v_mfma_f32_16x16x32_bf16 v[136:139], a[72:75], a[52:55], v[136:139]
    buffer_load_dwordx4 v19, s[44:47], s53 offen offset:3072 lds
    v_mfma_f32_16x16x32_bf16 v[144:147], a[72:75], a[56:59], v[144:147]
    s_add_u32 s53, s53, s56
    ds_read_b128 a[12:15], v6 offset:6144
    v_mfma_f32_16x16x32_bf16 v[152:155], a[72:75], a[60:63], v[152:155]
    ds_read_b64_tr_b16 a[72:73], v10 offset:0
    v_mfma_f32_16x16x32_bf16 v[100:103], a[76:79], a[32:35], v[100:103]
    s_add_u32 m0, s62, 4096
    ds_read_b64_tr_b16 a[74:75], v10 offset:2048
    v_mfma_f32_16x16x32_bf16 v[108:111], a[76:79], a[36:39], v[108:111]
    buffer_load_dwordx4 v20, s[44:47], s54 offen offset:0 lds
    v_mfma_f32_16x16x32_bf16 v[116:119], a[76:79], a[40:43], v[116:119]
    ds_read_b128 a[16:19], v6 offset:8192
    v_mfma_f32_16x16x32_bf16 v[124:127], a[76:79], a[44:47], v[124:127]
    s_xor_b32 s62, s62, 229376
    v_mfma_f32_16x16x32_bf16 v[132:135], a[76:79], a[48:51], v[132:135]
    v_mfma_f32_16x16x32_bf16 v[140:143], a[76:79], a[52:55], v[140:143]
    buffer_load_dwordx4 v21, s[44:47], s54 offen offset:1024 lds
    v_mfma_f32_16x16x32_bf16 v[148:151], a[76:79], a[56:59], v[148:151]
    s_add_u32 s54, s54, s56
    ds_read_b128 a[20:23], v6 offset:10240
    v_mfma_f32_16x16x32_bf16 v[156:159], a[76:79], a[60:63], v[156:159]
    ds_read_b64_tr_b16 a[76:77], v11 offset:0
    v_mfma_f32_16x16x32_bf16 v[160:163], a[80:83], a[32:35], v[160:163]
    ds_read_b64_tr_b16 a[78:79], v11 offset:2048
    v_mfma_f32_16x16x32_bf16 v[168:171], a[80:83], a[36:39], v[168:171]
    buffer_load_dwordx4 v20, s[44:47], s55 offen offset:2048 lds
    v_mfma_f32_16x16x32_bf16 v[176:179], a[80:83], a[40:43], v[176:179]
    ds_read_b128 a[24:27], v6 offset:12288
    v_mfma_f32_16x16x32_bf16 v[184:187], a[80:83], a[44:47], v[184:187]
    v_mfma_f32_16x16x32_bf16 v[192:195], a[80:83], a[48:51], v[192:195]
    v_mfma_f32_16x16x32_bf16 v[200:203], a[80:83], a[52:55], v[200:203]
    buffer_load_dwordx4 v21, s[44:47], s55 offen offset:3072 lds
    v_mfma_f32_16x16x32_bf16 v[208:211], a[80:83], a[56:59], v[208:211]
    s_add_u32 s55, s55, s56
    ds_read_b128 a[28:31], v6 offset:14336
    v_mfma_f32_16x16x32_bf16 v[216:219], a[80:83], a[60:63], v[216:219]
    ds_read_b64_tr_b16 a[80:81], v12 offset:0
    v_mfma_f32_16x16x32_bf16 v[164:167], a[84:87], a[32:35], v[164:167]
    ds_read_b64_tr_b16 a[82:83], v12 offset:2048
    v_mfma_f32_16x16x32_bf16 v[172:175], a[84:87], a[36:39], v[172:175]
    v_mfma_f32_16x16x32_bf16 v[180:183], a[84:87], a[40:43], v[180:183]
    buffer_store_dwordx4 a[204:207], v2, s[24:27], s28 offen sc1
    v_mfma_f32_16x16x32_bf16 v[188:191], a[84:87], a[44:47], v[188:191]
    s_add_u32 s28, s28, s31
    v_mfma_f32_16x16x32_bf16 v[196:199], a[84:87], a[48:51], v[196:199]
    v_mfma_f32_16x16x32_bf16 v[204:207], a[84:87], a[52:55], v[204:207]
    v_mfma_f32_16x16x32_bf16 v[212:215], a[84:87], a[56:59], v[212:215]
    buffer_store_dwordx4 a[208:211], v2, s[24:27], s28 offen sc1
    v_mfma_f32_16x16x32_bf16 v[220:223], a[84:87], a[60:63], v[220:223]
    s_add_u32 s28, s28, s31
    ds_read_b64_tr_b16 a[84:85], v13 offset:0
    v_mfma_f32_16x16x32_bf16 v[224:227], a[88:91], a[32:35], v[224:227]
    ds_read_b64_tr_b16 a[86:87], v13 offset:2048
    v_mfma_f32_16x16x32_bf16 v[232:235], a[88:91], a[36:39], v[232:235]
    v_mfma_f32_16x16x32_bf16 v[240:243], a[88:91], a[40:43], v[240:243]
    buffer_store_dwordx4 a[212:215], v2, s[24:27], s28 offen sc1
    v_mfma_f32_16x16x32_bf16 v[248:251], a[88:91], a[44:47], v[248:251]
    s_add_u32 s28, s28, s31
    v_mfma_f32_16x16x32_bf16 a[96:99], a[88:91], a[48:51], a[96:99]
    v_mfma_f32_16x16x32_bf16 a[104:107], a[88:91], a[52:55], a[104:107]
    v_mfma_f32_16x16x32_bf16 a[112:115], a[88:91], a[56:59], a[112:115]
    buffer_store_dwordx4 a[216:219], v2, s[24:27], s28 offen sc1
    v_mfma_f32_16x16x32_bf16 a[120:123], a[88:91], a[60:63], a[120:123]
    s_add_u32 s28, s28, s31
    ds_read_b64_tr_b16 a[88:89], v14 offset:0
    v_mfma_f32_16x16x32_bf16 v[228:231], a[92:95], a[32:35], v[228:231]
    ds_read_b64_tr_b16 a[90:91], v14 offset:2048
    v_mfma_f32_16x16x32_bf16 v[236:239], a[92:95], a[36:39], v[236:239]
    v_mfma_f32_16x16x32_bf16 v[244:247], a[92:95], a[40:43], v[244:247]
    buffer_store_dwordx4 a[220:223], v2, s[24:27], s28 offen sc1
    v_mfma_f32_16x16x32_bf16 v[252:255], a[92:95], a[44:47], v[252:255]
    s_add_u32 s29, s29, s30
    s_mov_b32 s28, s29
    v_mfma_f32_16x16x32_bf16 a[100:103], a[92:95], a[48:51], a[100:103]
    s_sub_u32 s65, s65, 1
    v_mfma_f32_16x16x32_bf16 a[108:111], a[92:95], a[52:55], a[108:111]
    v_mfma_f32_16x16x32_bf16 a[116:119], a[92:95], a[56:59], a[116:119]
    v_mfma_f32_16x16x32_bf16 a[124:127], a[92:95], a[60:63], a[124:127]
    ds_read_b64_tr_b16 a[92:93], v15 offset:0
    ds_read_b64_tr_b16 a[94:95], v15 offset:2048
    s_waitcnt lgkmcnt(15)
    v_mfma_f32_16x16x32_bf16 v[32:35], a[64:67], a[0:3], v[32:35]
    v_mfma_f32_16x16x32_bf16 v[40:43], a[64:67], a[4:7], v[40:43]
    v_mfma_f32_16x16x32_bf16 v[48:51], a[64:67], a[8:11], v[48:51]
    v_mfma_f32_16x16x32_bf16 v[56:59], a[64:67], a[12:15], v[56:59]
    s_add_u32 m0, s61, 0
    s_waitcnt lgkmcnt(13)
    v_mfma_f32_16x16x32_bf16 v[64:67], a[64:67], a[16:19], v[64:67]
    buffer_load_dwordx4 v16, s[40:43], s48 offen offset:0 lds
    s_waitcnt lgkmcnt(12)
    v_mfma_f32_16x16x32_bf16 v[72:75], a[64:67], a[20:23], v[72:75]
    s_waitcnt lgkmcnt(9)
    v_mfma_f32_16x16x32_bf16 v[80:83], a[64:67], a[24:27], v[80:83]
    s_waitcnt lgkmcnt(8)
    v_mfma_f32_16x16x32_bf16 v[88:91], a[64:67], a[28:31], v[88:91]
    ds_read_b64_tr_b16 a[64:65], v8 offset:16384
    v_mfma_f32_16x16x32_bf16 v[36:39], a[68:71], a[0:3], v[36:39]
    ds_read_b64_tr_b16 a[66:67], v8 offset:18432
    v_mfma_f32_16x16x32_bf16 v[44:47], a[68:71], a[4:7], v[44:47]
    v_mfma_f32_16x16x32_bf16 v[52:55], a[68:71], a[8:11], v[52:55]
    ds_read_b128 a[32:35], v7 offset:0
    v_mfma_f32_16x16x32_bf16 v[60:63], a[68:71], a[12:15], v[60:63]
    v_mfma_f32_16x16x32_bf16 v[68:71], a[68:71], a[16:19], v[68:71]
    buffer_load_dwordx4 v17, s[40:43], s48 offen offset:1024 lds
    v_mfma_f32_16x16x32_bf16 v[76:79], a[68:71], a[20:23], v[76:79]
    s_add_u32 s48, s48, 128
    v_mfma_f32_16x16x32_bf16 v[84:87], a[68:71], a[24:27], v[84:87]
    ds_read_b128 a[36:39], v7 offset:2048
    v_mfma_f32_16x16x32_bf16 v[92:95], a[68:71], a[28:31], v[92:95]
    ds_read_b64_tr_b16 a[68:69], v9 offset:16384
    v_mfma_f32_16x16x32_bf16 v[96:99], a[72:75], a[0:3], v[96:99]
    ds_read_b64_tr_b16 a[70:71], v9 offset:18432
    v_mfma_f32_16x16x32_bf16 v[104:107], a[72:75], a[4:7], v[104:107]
    v_mfma_f32_16x16x32_bf16 v[112:115], a[72:75], a[8:11], v[112:115]
    ds_read_b128 a[40:43], v7 offset:4096
    v_mfma_f32_16x16x32_bf16 v[120:123], a[72:75], a[12:15], v[120:123]
    v_mfma_f32_16x16x32_bf16 v[128:131], a[72:75], a[16:19], v[128:131]
    buffer_load_dwordx4 v16, s[40:43], s49 offen offset:2048 lds
    v_mfma_f32_16x16x32_bf16 v[136:139], a[72:75], a[20:23], v[136:139]
    v_mfma_f32_16x16x32_bf16 v[144:147], a[72:75], a[24:27], v[144:147]
    ds_read_b128 a[44:47], v7 offset:6144
    v_mfma_f32_16x16x32_bf16 v[152:155], a[72:75], a[28:31], v[152:155]
    ds_read_b64_tr_b16 a[72:73], v10 offset:16384
    v_mfma_f32_16x16x32_bf16 v[100:103], a[76:79], a[0:3], v[100:103]
    ds_read_b64_tr_b16 a[74:75], v10 offset:18432
    v_mfma_f32_16x16x32_bf16 v[108:111], a[76:79], a[4:7], v[108:111]
    v_mfma_f32_16x16x32_bf16 v[116:119], a[76:79], a[8:11], v[116:119]
    ds_read_b128 a[48:51], v7 offset:8192
    v_mfma_f32_16x16x32_bf16 v[124:127], a[76:79], a[12:15], v[124:127]
    v_mfma_f32_16x16x32_bf16 v[132:135], a[76:79], a[16:19], v[132:135]
    buffer_load_dwordx4 v17, s[40:43], s49 offen offset:3072 lds
    v_mfma_f32_16x16x32_bf16 v[140:143], a[76:79], a[20:23], v[140:143]
    s_add_u32 s49, s49, 128
    v_mfma_f32_16x16x32_bf16 v[148:151], a[76:79], a[24:27], v[148:151]
    ds_read_b128 a[52:55], v7 offset:10240
    v_mfma_f32_16x16x32_bf16 v[156:159], a[76:79], a[28:31], v[156:159]
    ds_read_b64_tr_b16 a[76:77], v11 offset:16384
    s_waitcnt lgkmcnt(15)
    v_mfma_f32_16x16x32_bf16 v[160:163], a[80:83], a[0:3], v[160:163]
    ds_read_b64_tr_b16 a[78:79], v11 offset:18432
    v_mfma_f32_16x16x32_bf16 v[168:171], a[80:83], a[4:7], v[168:171]
    v_mfma_f32_16x16x32_bf16 v[176:179], a[80:83], a[8:11], v[176:179]
    ds_read_b128 a[56:59], v7 offset:12288
    v_mfma_f32_16x16x32_bf16 v[184:187], a[80:83], a[12:15], v[184:187]
    s_add_u32 m0, s61, 4096
    v_mfma_f32_16x16x32_bf16 v[192:195], a[80:83], a[16:19], v[192:195]
    buffer_load_dwordx4 v16, s[40:43], s50 offen offset:0 lds
    v_mfma_f32_16x16x32_bf16 v[200:203], a[80:83], a[20:23], v[200:203]
    v_mfma_f32_16x16x32_bf16 v[208:211], a[80:83], a[24:27], v[208:211]
    s_add_u32 s61, s61, 32768
    ds_read_b128 a[60:63], v7 offset:14336
    v_mfma_f32_16x16x32_bf16 v[216:219], a[80:83], a[28:31], v[216:219]
    s_cmp_ge_u32 s61, 98304
    s_cselect_b32 s90, 98304, 0
    ds_read_b64_tr_b16 a[80:81], v12 offset:16384
    v_mfma_f32_16x16x32_bf16 v[164:167], a[84:87], a[0:3], v[164:167]
    s_sub_u32 s61, s61, s90
    ds_read_b64_tr_b16 a[82:83], v12 offset:18432
    v_mfma_f32_16x16x32_bf16 v[172:175], a[84:87], a[4:7], v[172:175]
    s_add_u32 s64, s64, 32768
    v_mfma_f32_16x16x32_bf16 v[180:183], a[84:87], a[8:11], v[180:183]
    buffer_store_dwordx4 a[224:227], v2, s[24:27], s28 offen sc1
    v_mfma_f32_16x16x32_bf16 v[188:191], a[84:87], a[12:15], v[188:191]
    s_add_u32 s28, s28, s31
    v_mfma_f32_16x16x32_bf16 v[196:199], a[84:87], a[16:19], v[196:199]
    buffer_load_dwordx4 v17, s[40:43], s50 offen offset:1024 lds
    v_mfma_f32_16x16x32_bf16 v[204:207], a[84:87], a[20:23], v[204:207]
    s_add_u32 s50, s50, 128
    v_mfma_f32_16x16x32_bf16 v[212:215], a[84:87], a[24:27], v[212:215]
    s_cmp_ge_u32 s64, 98304
    s_cselect_b32 s63, 4294901760, s59
    s_cselect_b32 s64, 0, s64
    v_mfma_f32_16x16x32_bf16 v[220:223], a[84:87], a[28:31], v[220:223]
    ds_read_b64_tr_b16 a[84:85], v13 offset:16384
    v_mfma_f32_16x16x32_bf16 v[224:227], a[88:91], a[0:3], v[224:227]
    ds_read_b64_tr_b16 a[86:87], v13 offset:18432
    v_mfma_f32_16x16x32_bf16 v[232:235], a[88:91], a[4:7], v[232:235]
    v_mfma_f32_16x16x32_bf16 v[240:243], a[88:91], a[8:11], v[240:243]
    buffer_store_dwordx4 a[228:231], v2, s[24:27], s28 offen sc1
    v_mfma_f32_16x16x32_bf16 v[248:251], a[88:91], a[12:15], v[248:251]
    s_add_u32 s28, s28, s31
    v_mfma_f32_16x16x32_bf16 a[96:99], a[88:91], a[16:19], a[96:99]
    buffer_load_dwordx4 v16, s[40:43], s51 offen offset:2048 lds
    v_mfma_f32_16x16x32_bf16 a[104:107], a[88:91], a[20:23], a[104:107]
    v_mfma_f32_16x16x32_bf16 a[112:115], a[88:91], a[24:27], a[112:115]
    v_mfma_f32_16x16x32_bf16 a[120:123], a[88:91], a[28:31], a[120:123]
    ds_read_b64_tr_b16 a[88:89], v14 offset:16384
    s_waitcnt lgkmcnt(15)
    v_mfma_f32_16x16x32_bf16 v[228:231], a[92:95], a[0:3], v[228:231]
    ds_read_b64_tr_b16 a[90:91], v14 offset:18432
    v_mfma_f32_16x16x32_bf16 v[236:239], a[92:95], a[4:7], v[236:239]
    v_add_u32 v6, s63, v6
    v_add_u32 v7, s63, v7
    v_mfma_f32_16x16x32_bf16 v[244:247], a[92:95], a[8:11], v[244:247]
    buffer_store_dwordx4 a[232:235], v2, s[24:27], s28 offen sc1
    v_mfma_f32_16x16x32_bf16 v[252:255], a[92:95], a[12:15], v[252:255]
    s_add_u32 s28, s28, s31
    v_mfma_f32_16x16x32_bf16 a[100:103], a[92:95], a[16:19], a[100:103]
    buffer_load_dwordx4 v17, s[40:43], s51 offen offset:3072 lds
    v_mfma_f32_16x16x32_bf16 a[108:111], a[92:95], a[20:23], a[108:111]
    s_add_u32 s51, s51, 128
    v_mfma_f32_16x16x32_bf16 a[116:119], a[92:95], a[24:27], a[116:119]
    v_mfma_f32_16x16x32_bf16 a[124:127], a[92:95], a[28:31], a[124:127]
    ds_read_b64_tr_b16 a[92:93], v15 offset:16384
    ds_read_b64_tr_b16 a[94:95], v15 offset:18432
    v_mfma_f32_16x16x32_bf16 v[32:35], a[64:67], a[32:35], v[32:35]
    v_xor_b32 v8, s60, v8
    v_xor_b32 v9, s60, v9
    v_mfma_f32_16x16x32_bf16 v[40:43], a[64:67], a[36:39], v[40:43]
    v_xor_b32 v10, s60, v10
    v_xor_b32 v11, s60, v11
    s_waitcnt lgkmcnt(15)
    v_mfma_f32_16x16x32_bf16 v[48:51], a[64:67], a[40:43], v[48:51]
    v_xor_b32 v12, s60, v12
    v_xor_b32 v13, s60, v13
    v_mfma_f32_16x16x32_bf16 v[56:59], a[64:67], a[44:47], v[56:59]
    v_xor_b32 v14, s60, v14
    v_xor_b32 v15, s60, v15
    s_waitcnt lgkmcnt(13)
    v_mfma_f32_16x16x32_bf16 v[64:67], a[64:67], a[48:51], v[64:67]
    s_waitcnt lgkmcnt(12)
    v_mfma_f32_16x16x32_bf16 v[72:75], a[64:67], a[52:55], v[72:75]
    s_waitcnt lgkmcnt(9)
    v_mfma_f32_16x16x32_bf16 v[80:83], a[64:67], a[56:59], v[80:83]
    s_waitcnt vmcnt(16) lgkmcnt(0)
    v_mfma_f32_16x16x32_bf16 v[88:91], a[64:67], a[60:63], v[88:91]
    s_barrier
    ds_read_b64_tr_b16 a[64:65], v8 offset:0
    v_mfma_f32_16x16x32_bf16 v[36:39], a[68:71], a[32:35], v[36:39]
    s_add_u32 m0, s62, 0
    ds_read_b64_tr_b16 a[66:67], v8 offset:2048
    v_mfma_f32_16x16x32_bf16 v[44:47], a[68:71], a[36:39], v[44:47]
    buffer_load_dwordx4 v18, s[44:47], s52 offen offset:0 lds
    v_mfma_f32_16x16x32_bf16 v[52:55], a[68:71], a[40:43], v[52:55]
    ds_read_b128 a[0:3], v6 offset:0
    v_mfma_f32_16x16x32_bf16 v[60:63], a[68:71], a[44:47], v[60:63]
    v_mfma_f32_16x16x32_bf16 v[68:71], a[68:71], a[48:51], v[68:71]
    v_mfma_f32_16x16x32_bf16 v[76:79], a[68:71], a[52:55], v[76:79]
    buffer_load_dwordx4 v19, s[44:47], s52 offen offset:1024 lds
    v_mfma_f32_16x16x32_bf16 v[84:87], a[68:71], a[56:59], v[84:87]
    s_add_u32 s52, s52, s56
    ds_read_b128 a[4:7], v6 offset:2048
    v_mfma_f32_16x16x32_bf16 v[92:95], a[68:71], a[60:63], v[92:95]
    ds_read_b64_tr_b16 a[68:69], v9 offset:0
    v_mfma_f32_16x16x32_bf16 v[96:99], a[72:75], a[32:35], v[96:99]
    ds_read_b64_tr_b16 a[70:71], v9 offset:2048
    v_mfma_f32_16x16x32_bf16 v[104:107], a[72:75], a[36:39], v[104:107]
    buffer_load_dwordx4 v18, s[44:47], s53 offen offset:2048 lds
    v_mfma_f32_16x16x32_bf16 v[112:115], a[72:75], a[40:43], v[112:115]
    ds_read_b128 a[8:11], v6 offset:4096
    v_mfma_f32_16x16x32_bf16 v[120:123], a[72:75], a[44:47], v[120:123]
    v_mfma_f32_16x16x32_bf16 v[128:131], a[72:75], a[48:51], v[128:131]
    v_mfma_f32_16x16x32_bf16 v[136:139], a[72:75], a[52:55], v[136:139]
    buffer_load_dwordx4 v19, s[44:47], s53 offen offset:3072 lds
    v_mfma_f32_16x16x32_bf16 v[144:147], a[72:75], a[56:59], v[144:147]
    s_add_u32 s53, s53, s56
    ds_read_b128 a[12:15], v6 offset:6144
    v_mfma_f32_16x16x32_bf16 v[152:155], a[72:75], a[60:63], v[152:155]
    ds_read_b64_tr_b16 a[72:73], v10 offset:0
    v_mfma_f32_16x16x32_bf16 v[100:103], a[76:79], a[32:35], v[100:103]
    s_add_u32 m0, s62, 4096
    ds_read_b64_tr_b16 a[74:75], v10 offset:2048
    v_mfma_f32_16x16x32_bf16 v[108:111], a[76:79], a[36:39], v[108:111]
    buffer_load_dwordx4 v20, s[44:47], s54 offen offset:0 lds
    v_mfma_f32_16x16x32_bf16 v[116:119], a[76:79], a[40:43], v[116:119]
    ds_read_b128 a[16:19], v6 offset:8192
    v_mfma_f32_16x16x32_bf16 v[124:127], a[76:79], a[44:47], v[124:127]
    s_xor_b32 s62, s62, 229376
    v_mfma_f32_16x16x32_bf16 v[132:135], a[76:79], a[48:51], v[132:135]
    v_mfma_f32_16x16x32_bf16 v[140:143], a[76:79], a[52:55], v[140:143]
    buffer_load_dwordx4 v21, s[44:47], s54 offen offset:1024 lds
    v_mfma_f32_16x16x32_bf16 v[148:151], a[76:79], a[56:59], v[148:151]
    s_add_u32 s54, s54, s56
    ds_read_b128 a[20:23], v6 offset:10240
    v_mfma_f32_16x16x32_bf16 v[156:159], a[76:79], a[60:63], v[156:159]
    ds_read_b64_tr_b16 a[76:77], v11 offset:0
    v_mfma_f32_16x16x32_bf16 v[160:163], a[80:83], a[32:35], v[160:163]
    ds_read_b64_tr_b16 a[78:79], v11 offset:2048
    v_mfma_f32_16x16x32_bf16 v[168:171], a[80:83], a[36:39], v[168:171]
    buffer_load_dwordx4 v20, s[44:47], s55 offen offset:2048 lds
    v_mfma_f32_16x16x32_bf16 v[176:179], a[80:83], a[40:43], v[176:179]
    ds_read_b128 a[24:27], v6 offset:12288
    v_mfma_f32_16x16x32_bf16 v[184:187], a[80:83], a[44:47], v[184:187]
    v_mfma_f32_16x16x32_bf16 v[192:195], a[80:83], a[48:51], v[192:195]
    v_mfma_f32_16x16x32_bf16 v[200:203], a[80:83], a[52:55], v[200:203]
    buffer_load_dwordx4 v21, s[44:47], s55 offen offset:3072 lds
    v_mfma_f32_16x16x32_bf16 v[208:211], a[80:83], a[56:59], v[208:211]
    s_add_u32 s55, s55, s56
    ds_read_b128 a[28:31], v6 offset:14336
    v_mfma_f32_16x16x32_bf16 v[216:219], a[80:83], a[60:63], v[216:219]
    ds_read_b64_tr_b16 a[80:81], v12 offset:0
    v_mfma_f32_16x16x32_bf16 v[164:167], a[84:87], a[32:35], v[164:167]
    ds_read_b64_tr_b16 a[82:83], v12 offset:2048
    v_mfma_f32_16x16x32_bf16 v[172:175], a[84:87], a[36:39], v[172:175]
    v_mfma_f32_16x16x32_bf16 v[180:183], a[84:87], a[40:43], v[180:183]
    buffer_store_dwordx4 a[236:239], v2, s[24:27], s28 offen sc1
    v_mfma_f32_16x16x32_bf16 v[188:191], a[84:87], a[44:47], v[188:191]
    s_add_u32 s28, s28, s31
    v_mfma_f32_16x16x32_bf16 v[196:199], a[84:87], a[48:51], v[196:199]
    v_mfma_f32_16x16x32_bf16 v[204:207], a[84:87], a[52:55], v[204:207]
    v_mfma_f32_16x16x32_bf16 v[212:215], a[84:87], a[56:59], v[212:215]
    buffer_store_dwordx4 a[240:243], v2, s[24:27], s28 offen sc1
    v_mfma_f32_16x16x32_bf16 v[220:223], a[84:87], a[60:63], v[220:223]
    s_add_u32 s28, s28, s31
    ds_read_b64_tr_b16 a[84:85], v13 offset:0
    v_mfma_f32_16x16x32_bf16 v[224:227], a[88:91], a[32:35], v[224:227]
    ds_read_b64_tr_b16 a[86:87], v13 offset:2048
    v_mfma_f32_16x16x32_bf16 v[232:235], a[88:91], a[36:39], v[232:235]
    v_mfma_f32_16x16x32_bf16 v[240:243], a[88:91], a[40:43], v[240:243]
    buffer_store_dwordx4 a[244:247], v2, s[24:27], s28 offen sc1
    v_mfma_f32_16x16x32_bf16 v[248:251], a[88:91], a[44:47], v[248:251]
    s_add_u32 s28, s28, s31
    v_mfma_f32_16x16x32_bf16 a[96:99], a[88:91], a[48:51], a[96:99]
    v_mfma_f32_16x16x32_bf16 a[104:107], a[88:91], a[52:55], a[104:107]
    v_mfma_f32_16x16x32_bf16 a[112:115], a[88:91], a[56:59], a[112:115]
    buffer_store_dwordx4 a[248:251], v2, s[24:27], s28 offen sc1
    v_mfma_f32_16x16x32_bf16 a[120:123], a[88:91], a[60:63], a[120:123]
    s_add_u32 s28, s28, s31
    ds_read_b64_tr_b16 a[88:89], v14 offset:0
    v_mfma_f32_16x16x32_bf16 v[228:231], a[92:95], a[32:35], v[228:231]
    ds_read_b64_tr_b16 a[90:91], v14 offset:2048
    v_mfma_f32_16x16x32_bf16 v[236:239], a[92:95], a[36:39], v[236:239]
    v_mfma_f32_16x16x32_bf16 v[244:247], a[92:95], a[40:43], v[244:247]
    buffer_store_dwordx4 a[252:255], v2, s[24:27], s28 offen sc1
    v_mfma_f32_16x16x32_bf16 v[252:255], a[92:95], a[44:47], v[252:255]
    s_add_u32 s29, s29, s30
    s_mov_b32 s28, s29
    v_mfma_f32_16x16x32_bf16 a[100:103], a[92:95], a[48:51], a[100:103]
    s_sub_u32 s65, s65, 1
    v_mfma_f32_16x16x32_bf16 a[108:111], a[92:95], a[52:55], a[108:111]
    v_mfma_f32_16x16x32_bf16 a[116:119], a[92:95], a[56:59], a[116:119]
    v_mfma_f32_16x16x32_bf16 a[124:127], a[92:95], a[60:63], a[124:127]
    ds_read_b64_tr_b16 a[92:93], v15 offset:0
    ds_read_b64_tr_b16 a[94:95], v15 offset:2048
m_loop16:
    s_waitcnt lgkmcnt(15)
    v_mfma_f32_16x16x32_bf16 v[32:35], a[64:67], a[0:3], v[32:35]
    v_mfma_f32_16x16x32_bf16 v[40:43], a[64:67], a[4:7], v[40:43]
    v_mfma_f32_16x16x32_bf16 v[48:51], a[64:67], a[8:11], v[48:51]
    v_mfma_f32_16x16x32_bf16 v[56:59], a[64:67], a[12:15], v[56:59]
    s_add_u32 m0, s61, 0
    s_waitcnt lgkmcnt(13)
    v_mfma_f32_16x16x32_bf16 v[64:67], a[64:67], a[16:19], v[64:67]
    buffer_load_dwordx4 v16, s[40:43], s48 offen offset:0 lds
    s_waitcnt lgkmcnt(12)
    v_mfma_f32_16x16x32_bf16 v[72:75], a[64:67], a[20:23], v[72:75]
    s_waitcnt lgkmcnt(9)
    v_mfma_f32_16x16x32_bf16 v[80:83], a[64:67], a[24:27], v[80:83]
    s_waitcnt lgkmcnt(8)
    v_mfma_f32_16x16x32_bf16 v[88:91], a[64:67], a[28:31], v[88:91]
    ds_read_b64_tr_b16 a[64:65], v8 offset:16384
    v_mfma_f32_16x16x32_bf16 v[36:39], a[68:71], a[0:3], v[36:39]
    ds_read_b64_tr_b16 a[66:67], v8 offset:18432
    v_mfma_f32_16x16x32_bf16 v[44:47], a[68:71], a[4:7], v[44:47]
    v_mfma_f32_16x16x32_bf16 v[52:55], a[68:71], a[8:11], v[52:55]
    ds_read_b128 a[32:35], v7 offset:0
    v_mfma_f32_16x16x32_bf16 v[60:63], a[68:71], a[12:15], v[60:63]
    v_mfma_f32_16x16x32_bf16 v[68:71], a[68:71], a[16:19], v[68:71]
    buffer_load_dwordx4 v17, s[40:43], s48 offen offset:1024 lds
    v_mfma_f32_16x16x32_bf16 v[76:79], a[68:71], a[20:23], v[76:79]
    s_add_u32 s48, s48, 128
    v_mfma_f32_16x16x32_bf16 v[84:87], a[68:71], a[24:27], v[84:87]
    ds_read_b128 a[36:39], v7 offset:2048
    v_mfma_f32_16x16x32_bf16 v[92:95], a[68:71], a[28:31], v[92:95]
    ds_read_b64_tr_b16 a[68:69], v9 offset:16384
    v_mfma_f32_16x16x32_bf16 v[96:99], a[72:75], a[0:3], v[96:99]
    ds_read_b64_tr_b16 a[70:71], v9 offset:18432
    v_mfma_f32_16x16x32_bf16 v[104:107], a[72:75], a[4:7], v[104:107]
    v_mfma_f32_16x16x32_bf16 v[112:115], a[72:75], a[8:11], v[112:115]
    ds_read_b128 a[40:43], v7 offset:4096
    v_mfma_f32_16x16x32_bf16 v[120:123], a[72:75], a[12:15], v[120:123]
    v_mfma_f32_16x16x32_bf16 v[128:131], a[72:75], a[16:19], v[128:131]
    buffer_load_dwordx4 v16, s[40:43], s49 offen offset:2048 lds
    v_mfma_f32_16x16x32_bf16 v[136:139], a[72:75], a[20:23], v[136:139]
    v_mfma_f32_16x16x32_bf16 v[144:147], a[72:75], a[24:27], v[144:147]
    ds_read_b128 a[44:47], v7 offset:6144
    v_mfma_f32_16x16x32_bf16 v[152:155], a[72:75], a[28:31], v[152:155]
    ds_read_b64_tr_b16 a[72:73], v10 offset:16384
    v_mfma_f32_16x16x32_bf16 v[100:103], a[76:79], a[0:3], v[100:103]
    ds_read_b64_tr_b16 a[74:75], v10 offset:18432
    v_mfma_f32_16x16x32_bf16 v[108:111], a[76:79], a[4:7], v[108:111]
    v_mfma_f32_16x16x32_bf16 v[116:119], a[76:79], a[8:11], v[116:119]
    ds_read_b128 a[48:51], v7 offset:8192
    v_mfma_f32_16x16x32_bf16 v[124:127], a[76:79], a[12:15], v[124:127]
    v_mfma_f32_16x16x32_bf16 v[132:135], a[76:79], a[16:19], v[132:135]
    buffer_load_dwordx4 v17, s[40:43], s49 offen offset:3072 lds
    v_mfma_f32_16x16x32_bf16 v[140:143], a[76:79], a[20:23], v[140:143]
    s_add_u32 s49, s49, 128
    v_mfma_f32_16x16x32_bf16 v[148:151], a[76:79], a[24:27], v[148:151]
    ds_read_b128 a[52:55], v7 offset:10240
    v_mfma_f32_16x16x32_bf16 v[156:159], a[76:79], a[28:31], v[156:159]
    ds_read_b64_tr_b16 a[76:77], v11 offset:16384
    s_waitcnt lgkmcnt(15)
    v_mfma_f32_16x16x32_bf16 v[160:163], a[80:83], a[0:3], v[160:163]
    ds_read_b64_tr_b16 a[78:79], v11 offset:18432
    v_mfma_f32_16x16x32_bf16 v[168:171], a[80:83], a[4:7], v[168:171]
    v_mfma_f32_16x16x32_bf16 v[176:179], a[80:83], a[8:11], v[176:179]
    ds_read_b128 a[56:59], v7 offset:12288
    v_mfma_f32_16x16x32_bf16 v[184:187], a[80:83], a[12:15], v[184:187]
    s_add_u32 m0, s61, 4096
    v_mfma_f32_16x16x32_bf16 v[192:195], a[80:83], a[16:19], v[192:195]
    buffer_load_dwordx4 v16, s[40:43], s50 offen offset:0 lds
    v_mfma_f32_16x16x32_bf16 v[200:203], a[80:83], a[20:23], v[200:203]
    v_mfma_f32_16x16x32_bf16 v[208:211], a[80:83], a[24:27], v[208:211]
    s_add_u32 s61, s61, 32768
    ds_read_b128 a[60:63], v7 offset:14336
    v_mfma_f32_16x16x32_bf16 v[216:219], a[80:83], a[28:31], v[216:219]
    s_cmp_ge_u32 s61, 98304
    s_cselect_b32 s90, 98304, 0
    ds_read_b64_tr_b16 a[80:81], v12 offset:16384
    v_mfma_f32_16x16x32_bf16 v[164:167], a[84:87], a[0:3], v[164:167]
    s_sub_u32 s61, s61, s90
    ds_read_b64_tr_b16 a[82:83], v12 offset:18432
    v_mfma_f32_16x16x32_bf16 v[172:175], a[84:87], a[4:7], v[172:175]
    s_add_u32 s64, s64, 32768
    v_mfma_f32_16x16x32_bf16 v[180:183], a[84:87], a[8:11], v[180:183]
    s_cmp_ge_u32 s64, 98304
    s_cselect_b32 s63, 4294901760, s59
    s_cselect_b32 s64, 0, s64
    v_mfma_f32_16x16x32_bf16 v[188:191], a[84:87], a[12:15], v[188:191]
    v_mfma_f32_16x16x32_bf16 v[196:199], a[84:87], a[16:19], v[196:199]
    buffer_load_dwordx4 v17, s[40:43], s50 offen offset:1024 lds
    v_mfma_f32_16x16x32_bf16 v[204:207], a[84:87], a[20:23], v[204:207]
    s_add_u32 s50, s50, 128
    v_mfma_f32_16x16x32_bf16 v[212:215], a[84:87], a[24:27], v[212:215]
    v_mfma_f32_16x16x32_bf16 v[220:223], a[84:87], a[28:31], v[220:223]
    ds_read_b64_tr_b16 a[84:85], v13 offset:16384
    v_mfma_f32_16x16x32_bf16 v[224:227], a[88:91], a[0:3], v[224:227]
    ds_read_b64_tr_b16 a[86:87], v13 offset:18432
    v_mfma_f32_16x16x32_bf16 v[232:235], a[88:91], a[4:7], v[232:235]
    v_mfma_f32_16x16x32_bf16 v[240:243], a[88:91], a[8:11], v[240:243]
    v_mfma_f32_16x16x32_bf16 v[248:251], a[88:91], a[12:15], v[248:251]
    v_mfma_f32_16x16x32_bf16 a[96:99], a[88:91], a[16:19], a[96:99]
    buffer_load_dwordx4 v16, s[40:43], s51 offen offset:2048 lds
    v_mfma_f32_16x16x32_bf16 a[104:107], a[88:91], a[20:23], a[104:107]
    v_mfma_f32_16x16x32_bf16 a[112:115], a[88:91], a[24:27], a[112:115]
    v_mfma_f32_16x16x32_bf16 a[120:123], a[88:91], a[28:31], a[120:123]
    ds_read_b64_tr_b16 a[88:89], v14 offset:16384
    s_waitcnt lgkmcnt(15)
    v_mfma_f32_16x16x32_bf16 v[228:231], a[92:95], a[0:3], v[228:231]
    ds_read_b64_tr_b16 a[90:91], v14 offset:18432
    v_mfma_f32_16x16x32_bf16 v[236:239], a[92:95], a[4:7], v[236:239]
    v_add_u32 v6, s63, v6
    v_add_u32 v7, s63, v7
    v_mfma_f32_16x16x32_bf16 v[244:247], a[92:95], a[8:11], v[244:247]
    v_mfma_f32_16x16x32_bf16 v[252:255], a[92:95], a[12:15], v[252:255]
    v_mfma_f32_16x16x32_bf16 a[100:103], a[92:95], a[16:19], a[100:103]
    buffer_load_dwordx4 v17, s[40:43], s51 offen offset:3072 lds
    v_mfma_f32_16x16x32_bf16 a[108:111], a[92:95], a[20:23], a[108:111]
    s_add_u32 s51, s51, 128
    v_mfma_f32_16x16x32_bf16 a[116:119], a[92:95], a[24:27], a[116:119]
    v_mfma_f32_16x16x32_bf16 a[124:127], a[92:95], a[28:31], a[124:127]
    ds_read_b64_tr_b16 a[92:93], v15 offset:16384
    ds_read_b64_tr_b16 a[94:95], v15 offset:18432
    v_mfma_f32_16x16x32_bf16 v[32:35], a[64:67], a[32:35], v[32:35]
    v_xor_b32 v8, s60, v8
    v_xor_b32 v9, s60, v9
    v_mfma_f32_16x16x32_bf16 v[40:43], a[64:67], a[36:39], v[40:43]
    v_xor_b32 v10, s60, v10
    v_xor_b32 v11, s60, v11
    s_waitcnt lgkmcnt(15)
    v_mfma_f32_16x16x32_bf16 v[48:51], a[64:67], a[40:43], v[48:51]
    v_xor_b32 v12, s60, v12
    v_xor_b32 v13, s60, v13
    v_mfma_f32_16x16x32_bf16 v[56:59], a[64:67], a[44:47], v[56:59]
    v_xor_b32 v14, s60, v14
    v_xor_b32 v15, s60, v15
    s_waitcnt lgkmcnt(13)
    v_mfma_f32_16x16x32_bf16 v[64:67], a[64:67], a[48:51], v[64:67]
    s_waitcnt lgkmcnt(12)
    v_mfma_f32_16x16x32_bf16 v[72:75], a[64:67], a[52:55], v[72:75]
    s_waitcnt lgkmcnt(9)
    v_mfma_f32_16x16x32_bf16 v[80:83], a[64:67], a[56:59], v[80:83]
    s_waitcnt vmcnt(8) lgkmcnt(0)
    v_mfma_f32_16x16x32_bf16 v[88:91], a[64:67], a[60:63], v[88:91]
    s_barrier
    ds_read_b64_tr_b16 a[64:65], v8 offset:0
    v_mfma_f32_16x16x32_bf16 v[36:39], a[68:71], a[32:35], v[36:39]
    s_add_u32 m0, s62, 0
    ds_read_b64_tr_b16 a[66:67], v8 offset:2048
    v_mfma_f32_16x16x32_bf16 v[44:47], a[68:71], a[36:39], v[44:47]
    buffer_load_dwordx4 v18, s[44:47], s52 offen offset:0 lds
    v_mfma_f32_16x16x32_bf16 v[52:55], a[68:71], a[40:43], v[52:55]
    ds_read_b128 a[0:3], v6 offset:0
    v_mfma_f32_16x16x32_bf16 v[60:63], a[68:71], a[44:47], v[60:63]
    v_mfma_f32_16x16x32_bf16 v[68:71], a[68:71], a[48:51], v[68:71]
    v_mfma_f32_16x16x32_bf16 v[76:79], a[68:71], a[52:55], v[76:79]
    buffer_load_dwordx4 v19, s[44:47], s52 offen offset:1024 lds
    v_mfma_f32_16x16x32_bf16 v[84:87], a[68:71], a[56:59], v[84:87]
    s_add_u32 s52, s52, s56
    ds_read_b128 a[4:7], v6 offset:2048
    v_mfma_f32_16x16x32_bf16 v[92:95], a[68:71], a[60:63], v[92:95]
    ds_read_b64_tr_b16 a[68:69], v9 offset:0
    v_mfma_f32_16x16x32_bf16 v[96:99], a[72:75], a[32:35], v[96:99]
    ds_read_b64_tr_b16 a[70:71], v9 offset:2048
    v_mfma_f32_16x16x32_bf16 v[104:107], a[72:75], a[36:39], v[104:107]
    buffer_load_dwordx4 v18, s[44:47], s53 offen offset:2048 lds
    v_mfma_f32_16x16x32_bf16 v[112:115], a[72:75], a[40:43], v[112:115]
    ds_read_b128 a[8:11], v6 offset:4096
    v_mfma_f32_16x16x32_bf16 v[120:123], a[72:75], a[44:47], v[120:123]
    v_mfma_f32_16x16x32_bf16 v[128:131], a[72:75], a[48:51], v[128:131]
    v_mfma_f32_16x16x32_bf16 v[136:139], a[72:75], a[52:55], v[136:139]
    buffer_load_dwordx4 v19, s[44:47], s53 offen offset:3072 lds
    v_mfma_f32_16x16x32_bf16 v[144:147], a[72:75], a[56:59], v[144:147]
    s_add_u32 s53, s53, s56
    ds_read_b128 a[12:15], v6 offset:6144
    v_mfma_f32_16x16x32_bf16 v[152:155], a[72:75], a[60:63], v[152:155]
    ds_read_b64_tr_b16 a[72:73], v10 offset:0
    v_mfma_f32_16x16x32_bf16 v[100:103], a[76:79], a[32:35], v[100:103]
    s_add_u32 m0, s62, 4096
    ds_read_b64_tr_b16 a[74:75], v10 offset:2048
    v_mfma_f32_16x16x32_bf16 v[108:111], a[76:79], a[36:39], v[108:111]
    buffer_load_dwordx4 v20, s[44:47], s54 offen offset:0 lds
    v_mfma_f32_16x16x32_bf16 v[116:119], a[76:79], a[40:43], v[116:119]
    ds_read_b128 a[16:19], v6 offset:8192
    v_mfma_f32_16x16x32_bf16 v[124:127], a[76:79], a[44:47], v[124:127]
    s_xor_b32 s62, s62, 229376
    v_mfma_f32_16x16x32_bf16 v[132:135], a[76:79], a[48:51], v[132:135]
    v_mfma_f32_16x16x32_bf16 v[140:143], a[76:79], a[52:55], v[140:143]
    buffer_load_dwordx4 v21, s[44:47], s54 offen offset:1024 lds
    v_mfma_f32_16x16x32_bf16 v[148:151], a[76:79], a[56:59], v[148:151]
    s_add_u32 s54, s54, s56
    ds_read_b128 a[20:23], v6 offset:10240
    v_mfma_f32_16x16x32_bf16 v[156:159], a[76:79], a[60:63], v[156:159]
    ds_read_b64_tr_b16 a[76:77], v11 offset:0
    v_mfma_f32_16x16x32_bf16 v[160:163], a[80:83], a[32:35], v[160:163]
    ds_read_b64_tr_b16 a[78:79], v11 offset:2048
    v_mfma_f32_16x16x32_bf16 v[168:171], a[80:83], a[36:39], v[168:171]
    buffer_load_dwordx4 v20, s[44:47], s55 offen offset:2048 lds
    v_mfma_f32_16x16x32_bf16 v[176:179], a[80:83], a[40:43], v[176:179]
    ds_read_b128 a[24:27], v6 offset:12288
    v_mfma_f32_16x16x32_bf16 v[184:187], a[80:83], a[44:47], v[184:187]
    v_mfma_f32_16x16x32_bf16 v[192:195], a[80:83], a[48:51], v[192:195]
    v_mfma_f32_16x16x32_bf16 v[200:203], a[80:83], a[52:55], v[200:203]
    buffer_load_dwordx4 v21, s[44:47], s55 offen offset:3072 lds
    v_mfma_f32_16x16x32_bf16 v[208:211], a[80:83], a[56:59], v[208:211]
    s_add_u32 s55, s55, s56
    ds_read_b128 a[28:31], v6 offset:14336
    v_mfma_f32_16x16x32_bf16 v[216:219], a[80:83], a[60:63], v[216:219]
    ds_read_b64_tr_b16 a[80:81], v12 offset:0
    v_mfma_f32_16x16x32_bf16 v[164:167], a[84:87], a[32:35], v[164:167]
    ds_read_b64_tr_b16 a[82:83], v12 offset:2048
    v_mfma_f32_16x16x32_bf16 v[172:175], a[84:87], a[36:39], v[172:175]
    v_mfma_f32_16x16x32_bf16 v[180:183], a[84:87], a[40:43], v[180:183]
    v_mfma_f32_16x16x32_bf16 v[188:191], a[84:87], a[44:47], v[188:191]
    v_mfma_f32_16x16x32_bf16 v[196:199], a[84:87], a[48:51], v[196:199]
    v_mfma_f32_16x16x32_bf16 v[204:207], a[84:87], a[52:55], v[204:207]
    v_mfma_f32_16x16x32_bf16 v[212:215], a[84:87], a[56:59], v[212:215]
    v_mfma_f32_16x16x32_bf16 v[220:223], a[84:87], a[60:63], v[220:223]
    ds_read_b64_tr_b16 a[84:85], v13 offset:0
    v_mfma_f32_16x16x32_bf16 v[224:227], a[88:91], a[32:35], v[224:227]
    ds_read_b64_tr_b16 a[86:87], v13 offset:2048
    v_mfma_f32_16x16x32_bf16 v[232:235], a[88:91], a[36:39], v[232:235]
    v_mfma_f32_16x16x32_bf16 v[240:243], a[88:91], a[40:43], v[240:243]
    v_mfma_f32_16x16x32_bf16 v[248:251], a[88:91], a[44:47], v[248:251]
    v_mfma_f32_16x16x32_bf16 a[96:99], a[88:91], a[48:51], a[96:99]
    v_mfma_f32_16x16x32_bf16 a[104:107], a[88:91], a[52:55], a[104:107]
    v_mfma_f32_16x16x32_bf16 a[112:115], a[88:91], a[56:59], a[112:115]
    v_mfma_f32_16x16x32_bf16 a[120:123], a[88:91], a[60:63], a[120:123]
    ds_read_b64_tr_b16 a[88:89], v14 offset:0
    v_mfma_f32_16x16x32_bf16 v[228:231], a[92:95], a[32:35], v[228:231]
    ds_read_b64_tr_b16 a[90:91], v14 offset:2048
    v_mfma_f32_16x16x32_bf16 v[236:239], a[92:95], a[36:39], v[236:239]
    v_mfma_f32_16x16x32_bf16 v[244:247], a[92:95], a[40:43], v[244:247]
    v_mfma_f32_16x16x32_bf16 v[252:255], a[92:95], a[44:47], v[252:255]
    v_mfma_f32_16x16x32_bf16 a[100:103], a[92:95], a[48:51], a[100:103]
    s_sub_u32 s65, s65, 1
    v_mfma_f32_16x16x32_bf16 a[108:111], a[92:95], a[52:55], a[108:111]
    v_mfma_f32_16x16x32_bf16 a[116:119], a[92:95], a[56:59], a[116:119]
    s_cmp_gt_u32 s65, s67
    v_mfma_f32_16x16x32_bf16 a[124:127], a[92:95], a[60:63], a[124:127]
    ds_read_b64_tr_b16 a[92:93], v15 offset:0
    ds_read_b64_tr_b16 a[94:95], v15 offset:2048
    s_cbranch_scc1 m_loop16
    s_cmp_lg_u32 s65, 0
    s_cbranch_scc1 m_dosw17
    s_branch m_epi12
m_swp13:
    s_waitcnt lgkmcnt(15)
    v_mfma_f32_16x16x32_bf16 v[32:35], a[0:3], a[64:67], 0
    v_mfma_f32_16x16x32_bf16 v[36:39], a[4:7], a[64:67], 0
    v_mfma_f32_16x16x32_bf16 v[96:99], a[8:11], a[64:67], 0
    v_mfma_f32_16x16x32_bf16 v[100:103], a[12:15], a[64:67], 0
    s_add_u32 m0, s61, 0
    s_waitcnt lgkmcnt(13)
    v_mfma_f32_16x16x32_bf16 v[160:163], a[16:19], a[64:67], 0
    buffer_load_dwordx4 v16, s[40:43], s48 offen offset:0 lds
    s_waitcnt lgkmcnt(12)
    v_mfma_f32_16x16x32_bf16 v[164:167], a[20:23], a[64:67], 0
    s_waitcnt lgkmcnt(9)
    v_mfma_f32_16x16x32_bf16 v[224:227], a[24:27], a[64:67], 0
    s_waitcnt lgkmcnt(8)
    v_mfma_f32_16x16x32_bf16 v[228:231], a[28:31], a[64:67], 0
    ds_read_b64_tr_b16 a[64:65], v8 offset:16384
    v_mfma_f32_16x16x32_bf16 v[40:43], a[0:3], a[68:71], 0
    ds_read_b64_tr_b16 a[66:67], v8 offset:18432
    v_mfma_f32_16x16x32_bf16 v[44:47], a[4:7], a[68:71], 0
    v_mfma_f32_16x16x32_bf16 v[104:107], a[8:11], a[68:71], 0
    ds_read_b128 a[32:35], v7 offset:0
    v_mfma_f32_16x16x32_bf16 v[108:111], a[12:15], a[68:71], 0
    v_mfma_f32_16x16x32_bf16 v[168:171], a[16:19], a[68:71], 0
    buffer_load_dwordx4 v17, s[40:43], s48 offen offset:1024 lds
    v_mfma_f32_16x16x32_bf16 v[172:175], a[20:23], a[68:71], 0
    s_add_u32 s48, s48, 128
    v_mfma_f32_16x16x32_bf16 v[232:235], a[24:27], a[68:71], 0
    ds_read_b128 a[36:39], v7 offset:2048
    v_mfma_f32_16x16x32_bf16 v[236:239], a[28:31], a[68:71], 0
    ds_read_b64_tr_b16 a[68:69], v9 offset:16384
    v_mfma_f32_16x16x32_bf16 v[48:51], a[0:3], a[72:75], 0
    ds_read_b64_tr_b16 a[70:71], v9 offset:18432
    v_mfma_f32_16x16x32_bf16 v[52:55], a[4:7], a[72:75], 0
    v_mfma_f32_16x16x32_bf16 v[112:115], a[8:11], a[72:75], 0
    ds_read_b128 a[40:43], v7 offset:4096
    v_mfma_f32_16x16x32_bf16 v[116:119], a[12:15], a[72:75], 0
    v_mfma_f32_16x16x32_bf16 v[176:179], a[16:19], a[72:75], 0
    buffer_load_dwordx4 v16, s[40:43], s49 offen offset:2048 lds
    v_mfma_f32_16x16x32_bf16 v[180:183], a[20:23], a[72:75], 0
    v_mfma_f32_16x16x32_bf16 v[240:243], a[24:27], a[72:75], 0
    ds_read_b128 a[44:47], v7 offset:6144
    v_mfma_f32_16x16x32_bf16 v[244:247], a[28:31], a[72:75], 0
    ds_read_b64_tr_b16 a[72:73], v10 offset:16384
    v_mfma_f32_16x16x32_bf16 v[56:59], a[0:3], a[76:79], 0
    ds_read_b64_tr_b16 a[74:75], v10 offset:18432
    v_mfma_f32_16x16x32_bf16 v[60:63], a[4:7], a[76:79], 0
    v_mfma_f32_16x16x32_bf16 v[120:123], a[8:11], a[76:79], 0
    ds_read_b128 a[48:51], v7 offset:8192
    v_mfma_f32_16x16x32_bf16 v[124:127], a[12:15], a[76:79], 0
    v_mfma_f32_16x16x32_bf16 v[184:187], a[16:19], a[76:79], 0
    buffer_load_dwordx4 v17, s[40:43], s49 offen offset:3072 lds
    v_mfma_f32_16x16x32_bf16 v[188:191], a[20:23], a[76:79], 0
    s_add_u32 s49, s49, 128
    v_mfma_f32_16x16x32_bf16 v[248:251], a[24:27], a[76:79], 0
    ds_read_b128 a[52:55], v7 offset:10240
    v_mfma_f32_16x16x32_bf16 v[252:255], a[28:31], a[76:79], 0
    ds_read_b64_tr_b16 a[76:77], v11 offset:16384
    s_waitcnt lgkmcnt(15)
    v_mfma_f32_16x16x32_bf16 v[64:67], a[0:3], a[80:83], 0
    ds_read_b64_tr_b16 a[78:79], v11 offset:18432
    v_mfma_f32_16x16x32_bf16 v[68:71], a[4:7], a[80:83], 0
    v_mfma_f32_16x16x32_bf16 v[128:131], a[8:11], a[80:83], 0
    ds_read_b128 a[56:59], v7 offset:12288
    v_mfma_f32_16x16x32_bf16 v[132:135], a[12:15], a[80:83], 0
    s_add_u32 m0, s61, 4096
    v_mfma_f32_16x16x32_bf16 v[192:195], a[16:19], a[80:83], 0
    buffer_load_dwordx4 v16, s[40:43], s50 offen offset:0 lds
    v_mfma_f32_16x16x32_bf16 v[196:199], a[20:23], a[80:83], 0
    v_mfma_f32_16x16x32_bf16 a[96:99], a[24:27], a[80:83], 0
    s_add_u32 s61, s61, 32768
    ds_read_b128 a[60:63], v7 offset:14336
    v_mfma_f32_16x16x32_bf16 a[100:103], a[28:31], a[80:83], 0
    s_cmp_ge_u32 s61, 98304
    s_cselect_b32 s90, 98304, 0
    ds_read_b64_tr_b16 a[80:81], v12 offset:16384
    v_mfma_f32_16x16x32_bf16 v[72:75], a[0:3], a[84:87], 0
    s_sub_u32 s61, s61, s90
    ds_read_b64_tr_b16 a[82:83], v12 offset:18432
    v_mfma_f32_16x16x32_bf16 v[76:79], a[4:7], a[84:87], 0
    s_add_u32 s64, s64, 32768
    v_mfma_f32_16x16x32_bf16 v[136:139], a[8:11], a[84:87], 0
    buffer_store_dwordx4 a[128:131], v2, s[24:27], s28 offen sc1
    v_mfma_f32_16x16x32_bf16 v[140:143], a[12:15], a[84:87], 0
    s_add_u32 s28, s28, s31
    v_mfma_f32_16x16x32_bf16 v[200:203], a[16:19], a[84:87], 0
    buffer_load_dwordx4 v17, s[40:43], s50 offen offset:1024 lds
    v_mfma_f32_16x16x32_bf16 v[204:207], a[20:23], a[84:87], 0
    s_add_u32 s50, s50, 128
    v_mfma_f32_16x16x32_bf16 a[104:107], a[24:27], a[84:87], 0
    s_cmp_ge_u32 s64, 98304
    s_cselect_b32 s63, 4294901760, s59
    s_cselect_b32 s64, 0, s64
    v_mfma_f32_16x16x32_bf16 a[108:111], a[28:31], a[84:87], 0
    ds_read_b64_tr_b16 a[84:85], v13 offset:16384
    v_mfma_f32_16x16x32_bf16 v[80:83], a[0:3], a[88:91], 0
    ds_read_b64_tr_b16 a[86:87], v13 offset:18432
    v_mfma_f32_16x16x32_bf16 v[84:87], a[4:7], a[88:91], 0
    v_mfma_f32_16x16x32_bf16 v[144:147], a[8:11], a[88:91], 0
    buffer_store_dwordx4 a[132:135], v2, s[24:27], s28 offen sc1
    v_mfma_f32_16x16x32_bf16 v[148:151], a[12:15], a[88:91], 0
    s_add_u32 s28, s28, s31
    v_mfma_f32_16x16x32_bf16 v[208:211], a[16:19], a[88:91], 0
    buffer_load_dwordx4 v16, s[40:43], s51 offen offset:2048 lds
    v_mfma_f32_16x16x32_bf16 v[212:215], a[20:23], a[88:91], 0
    v_mfma_f32_16x16x32_bf16 a[112:115], a[24:27], a[88:91], 0
    v_mfma_f32_16x16x32_bf16 a[116:119], a[28:31], a[88:91], 0
    ds_read_b64_tr_b16 a[88:89], v14 offset:16384
    s_waitcnt lgkmcnt(15)
    v_mfma_f32_16x16x32_bf16 v[88:91], a[0:3], a[92:95], 0
    ds_read_b64_tr_b16 a[90:91], v14 offset:18432
    v_mfma_f32_16x16x32_bf16 v[92:95], a[4:7], a[92:95], 0
    v_add_u32 v6, s63, v6
    v_add_u32 v7, s63, v7
    v_mfma_f32_16x16x32_bf16 v[152:155], a[8:11], a[92:95], 0
    buffer_store_dwordx4 a[136:139], v2, s[24:27], s28 offen sc1
    v_mfma_f32_16x16x32_bf16 v[156:159], a[12:15], a[92:95], 0
    s_add_u32 s28, s28, s31
    v_mfma_f32_16x16x32_bf16 v[216:219], a[16:19], a[92:95], 0
    buffer_load_dwordx4 v17, s[40:43], s51 offen offset:3072 lds
    v_mfma_f32_16x16x32_bf16 v[220:223], a[20:23], a[92:95], 0
    s_add_u32 s51, s51, 128
    v_mfma_f32_16x16x32_bf16 a[120:123], a[24:27], a[92:95], 0
    v_mfma_f32_16x16x32_bf16 a[124:127], a[28:31], a[92:95], 0
    ds_read_b64_tr_b16 a[92:93], v15 offset:16384
    ds_read_b64_tr_b16 a[94:95], v15 offset:18432
    v_mfma_f32_16x16x32_bf16 v[32:35], a[32:35], a[64:67], v[32:35]
    v_xor_b32 v8, s60, v8
    v_xor_b32 v9, s60, v9
    v_mfma_f32_16x16x32_bf16 v[36:39], a[36:39], a[64:67], v[36:39]
    v_xor_b32 v10, s60, v10
    v_xor_b32 v11, s60, v11
    s_waitcnt lgkmcnt(15)
    v_mfma_f32_16x16x32_bf16 v[96:99], a[40:43], a[64:67], v[96:99]
    v_xor_b32 v12, s60, v12
    v_xor_b32 v13, s60, v13
    v_mfma_f32_16x16x32_bf16 v[100:103], a[44:47], a[64:67], v[100:103]
    v_xor_b32 v14, s60, v14
    v_xor_b32 v15, s60, v15
    s_waitcnt lgkmcnt(13)
    v_mfma_f32_16x16x32_bf16 v[160:163], a[48:51], a[64:67], v[160:163]
    s_waitcnt lgkmcnt(12)
    v_mfma_f32_16x16x32_bf16 v[164:167], a[52:55], a[64:67], v[164:167]
    s_waitcnt lgkmcnt(9)
    v_mfma_f32_16x16x32_bf16 v[224:227], a[56:59], a[64:67], v[224:227]
    s_waitcnt vmcnt(11) lgkmcnt(0)
    v_mfma_f32_16x16x32_bf16 v[228:231], a[60:63], a[64:67], v[228:231]
    s_barrier
    ds_read_b64_tr_b16 a[64:65], v8 offset:0
    v_mfma_f32_16x16x32_bf16 v[40:43], a[32:35], a[68:71], v[40:43]
    s_add_u32 m0, s62, 0
    ds_read_b64_tr_b16 a[66:67], v8 offset:2048
    v_mfma_f32_16x16x32_bf16 v[44:47], a[36:39], a[68:71], v[44:47]
    buffer_load_dwordx4 v18, s[44:47], s52 offen offset:0 lds
    v_mfma_f32_16x16x32_bf16 v[104:107], a[40:43], a[68:71], v[104:107]
    ds_read_b128 a[0:3], v6 offset:0
    v_mfma_f32_16x16x32_bf16 v[108:111], a[44:47], a[68:71], v[108:111]
    v_mfma_f32_16x16x32_bf16 v[168:171], a[48:51], a[68:71], v[168:171]
    v_mfma_f32_16x16x32_bf16 v[172:175], a[52:55], a[68:71], v[172:175]
    buffer_load_dwordx4 v19, s[44:47], s52 offen offset:1024 lds
    v_mfma_f32_16x16x32_bf16 v[232:235], a[56:59], a[68:71], v[232:235]
    s_add_u32 s52, s52, s56
    ds_read_b128 a[4:7], v6 offset:2048
    v_mfma_f32_16x16x32_bf16 v[236:239], a[60:63], a[68:71], v[236:239]
    ds_read_b64_tr_b16 a[68:69], v9 offset:0
    v_mfma_f32_16x16x32_bf16 v[48:51], a[32:35], a[72:75], v[48:51]
    ds_read_b64_tr_b16 a[70:71], v9 offset:2048
    v_mfma_f32_16x16x32_bf16 v[52:55], a[36:39], a[72:75], v[52:55]
    buffer_load_dwordx4 v18, s[44:47], s53 offen offset:2048 lds
    v_mfma_f32_16x16x32_bf16 v[112:115], a[40:43], a[72:75], v[112:115]
    ds_read_b128 a[8:11], v6 offset:4096
    v_mfma_f32_16x16x32_bf16 v[116:119], a[44:47], a[72:75], v[116:119]
    v_mfma_f32_16x16x32_bf16 v[176:179], a[48:51], a[72:75], v[176:179]
    v_mfma_f32_16x16x32_bf16 v[180:183], a[52:55], a[72:75], v[180:183]
    buffer_load_dwordx4 v19, s[44:47], s53 offen offset:3072 lds
    v_mfma_f32_16x16x32_bf16 v[240:243], a[56:59], a[72:75], v[240:243]
    s_add_u32 s53, s53, s56
    ds_read_b128 a[12:15], v6 offset:6144
    v_mfma_f32_16x16x32_bf16 v[244:247], a[60:63], a[72:75], v[244:247]
    ds_read_b64_tr_b16 a[72:73], v10 offset:0
    v_mfma_f32_16x16x32_bf16 v[56:59], a[32:35], a[76:79], v[56:59]
    s_add_u32 m0, s62, 4096
    ds_read_b64_tr_b16 a[74:75], v10 offset:2048
    v_mfma_f32_16x16x32_bf16 v[60:63], a[36:39], a[76:79], v[60:63]
    buffer_load_dwordx4 v20, s[44:47], s54 offen offset:0 lds
    v_mfma_f32_16x16x32_bf16 v[120:123], a[40:43], a[76:79], v[120:123]
    ds_read_b128 a[16:19], v6 offset:8192
    v_mfma_f32_16x16x32_bf16 v[124:127], a[44:47], a[76:79], v[124:127]
    s_xor_b32 s62, s62, 229376
    v_mfma_f32_16x16x32_bf16 v[184:187], a[48:51], a[76:79], v[184:187]
    v_mfma_f32_16x16x32_bf16 v[188:191], a[52:55], a[76:79], v[188:191]
    buffer_load_dwordx4 v21, s[44:47], s54 offen offset:1024 lds
    v_mfma_f32_16x16x32_bf16 v[248:251], a[56:59], a[76:79], v[248:251]
    s_add_u32 s54, s54, s56
    ds_read_b128 a[20:23], v6 offset:10240
    v_mfma_f32_16x16x32_bf16 v[252:255], a[60:63], a[76:79], v[252:255]
    ds_read_b64_tr_b16 a[76:77], v11 offset:0
    v_mfma_f32_16x16x32_bf16 v[64:67], a[32:35], a[80:83], v[64:67]
    ds_read_b64_tr_b16 a[78:79], v11 offset:2048
    v_mfma_f32_16x16x32_bf16 v[68:71], a[36:39], a[80:83], v[68:71]
    buffer_load_dwordx4 v20, s[44:47], s55 offen offset:2048 lds
    v_mfma_f32_16x16x32_bf16 v[128:131], a[40:43], a[80:83], v[128:131]
    ds_read_b128 a[24:27], v6 offset:12288
    v_mfma_f32_16x16x32_bf16 v[132:135], a[44:47], a[80:83], v[132:135]
    v_mfma_f32_16x16x32_bf16 v[192:195], a[48:51], a[80:83], v[192:195]
    v_mfma_f32_16x16x32_bf16 v[196:199], a[52:55], a[80:83], v[196:199]
    buffer_load_dwordx4 v21, s[44:47], s55 offen offset:3072 lds
    v_mfma_f32_16x16x32_bf16 a[96:99], a[56:59], a[80:83], a[96:99]
    s_add_u32 s55, s55, s56
    ds_read_b128 a[28:31], v6 offset:14336
    v_mfma_f32_16x16x32_bf16 a[100:103], a[60:63], a[80:83], a[100:103]
    ds_read_b64_tr_b16 a[80:81], v12 offset:0
    v_mfma_f32_16x16x32_bf16 v[72:75], a[32:35], a[84:87], v[72:75]
    ds_read_b64_tr_b16 a[82:83], v12 offset:2048
    v_mfma_f32_16x16x32_bf16 v[76:79], a[36:39], a[84:87], v[76:79]
    v_mfma_f32_16x16x32_bf16 v[136:139], a[40:43], a[84:87], v[136:139]
    buffer_store_dwordx4 a[140:143], v2, s[24:27], s28 offen sc1
    v_mfma_f32_16x16x32_bf16 v[140:143], a[44:47], a[84:87], v[140:143]
    s_add_u32 s28, s28, s31
    v_mfma_f32_16x16x32_bf16 v[200:203], a[48:51], a[84:87], v[200:203]
    v_mfma_f32_16x16x32_bf16 v[204:207], a[52:55], a[84:87], v[204:207]
    v_mfma_f32_16x16x32_bf16 a[104:107], a[56:59], a[84:87], a[104:107]
    buffer_store_dwordx4 a[144:147], v2, s[24:27], s28 offen sc1
    v_mfma_f32_16x16x32_bf16 a[108:111], a[60:63], a[84:87], a[108:111]
    s_add_u32 s28, s28, s31
    ds_read_b64_tr_b16 a[84:85], v13 offset:0
    v_mfma_f32_16x16x32_bf16 v[80:83], a[32:35], a[88:91], v[80:83]
    ds_read_b64_tr_b16 a[86:87], v13 offset:2048
    v_mfma_f32_16x16x32_bf16 v[84:87], a[36:39], a[88:91], v[84:87]
    v_mfma_f32_16x16x32_bf16 v[144:147], a[40:43], a[88:91], v[144:147]
    buffer_store_dwordx4 a[148:151], v2, s[24:27], s28 offen sc1
    v_mfma_f32_16x16x32_bf16 v[148:151], a[44:47], a[88:91], v[148:151]
    s_add_u32 s28, s28, s31
    v_mfma_f32_16x16x32_bf16 v[208:211], a[48:51], a[88:91], v[208:211]
    v_mfma_f32_16x16x32_bf16 v[212:215], a[52:55], a[88:91], v[212:215]
    v_mfma_f32_16x16x32_bf16 a[112:115], a[56:59], a[88:91], a[112:115]
    buffer_store_dwordx4 a[152:155], v2, s[24:27], s28 offen sc1
    v_mfma_f32_16x16x32_bf16 a[116:119], a[60:63], a[88:91], a[116:119]
    s_add_u32 s28, s28, s31
    ds_read_b64_tr_b16 a[88:89], v14 offset:0
    v_mfma_f32_16x16x32_bf16 v[88:91], a[32:35], a[92:95], v[88:91]
    ds_read_b64_tr_b16 a[90:91], v14 offset:2048
    v_mfma_f32_16x16x32_bf16 v[92:95], a[36:39], a[92:95], v[92:95]
    v_mfma_f32_16x16x32_bf16 v[152:155], a[40:43], a[92:95], v[152:155]
    buffer_store_dwordx4 a[156:159], v2, s[24:27], s28 offen sc1
    v_mfma_f32_16x16x32_bf16 v[156:159], a[44:47], a[92:95], v[156:159]
    s_add_u32 s29, s29, s30
    s_mov_b32 s28, s29
    v_mfma_f32_16x16x32_bf16 v[216:219], a[48:51], a[92:95], v[216:219]
    s_sub_u32 s65, s65, 1
    v_mfma_f32_16x16x32_bf16 v[220:223], a[52:55], a[92:95], v[220:223]
    v_mfma_f32_16x16x32_bf16 a[120:123], a[56:59], a[92:95], a[120:123]
    v_mfma_f32_16x16x32_bf16 a[124:127], a[60:63], a[92:95], a[124:127]
    ds_read_b64_tr_b16 a[92:93], v15 offset:0
    ds_read_b64_tr_b16 a[94:95], v15 offset:2048
    s_waitcnt lgkmcnt(15)
    v_mfma_f32_16x16x32_bf16 v[32:35], a[0:3], a[64:67], v[32:35]
    v_mfma_f32_16x16x32_bf16 v[36:39], a[4:7], a[64:67], v[36:39]
    v_mfma_f32_16x16x32_bf16 v[96:99], a[8:11], a[64:67], v[96:99]
    v_mfma_f32_16x16x32_bf16 v[100:103], a[12:15], a[64:67], v[100:103]
    s_add_u32 m0, s61, 0
    s_waitcnt lgkmcnt(13)
    v_mfma_f32_16x16x32_bf16 v[160:163], a[16:19], a[64:67], v[160:163]
    buffer_load_dwordx4 v16, s[40:43], s48 offen offset:0 lds
    s_waitcnt lgkmcnt(12)
    v_mfma_f32_16x16x32_bf16 v[164:167], a[20:23], a[64:67], v[164:167]
    s_waitcnt lgkmcnt(9)
    v_mfma_f32_16x16x32_bf16 v[224:227], a[24:27], a[64:67], v[224:227]
    s_waitcnt lgkmcnt(8)
    v_mfma_f32_16x16x32_bf16 v[228:231], a[28:31], a[64:67], v[228:231]
    ds_read_b64_tr_b16 a[64:65], v8 offset:16384
    v_mfma_f32_16x16x32_bf16 v[40:43], a[0:3], a[68:71], v[40:43]
    ds_read_b64_tr_b16 a[66:67], v8 offset:18432
    v_mfma_f32_16x16x32_bf16 v[44:47], a[4:7], a[68:71], v[44:47]
    v_mfma_f32_16x16x32_bf16 v[104:107], a[8:11], a[68:71], v[104:107]
    ds_read_b128 a[32:35], v7 offset:0
    v_mfma_f32_16x16x32_bf16 v[108:111], a[12:15], a[68:71], v[108:111]
    v_mfma_f32_16x16x32_bf16 v[168:171], a[16:19], a[68:71], v[168:171]
    buffer_load_dwordx4 v17, s[40:43], s48 offen offset:1024 lds
    v_mfma_f32_16x16x32_bf16 v[172:175], a[20:23], a[68:71], v[172:175]
    s_add_u32 s48, s48, 128
    v_mfma_f32_16x16x32_bf16 v[232:235], a[24:27], a[68:71], v[232:235]
    ds_read_b128 a[36:39], v7 offset:2048
    v_mfma_f32_16x16x32_bf16 v[236:239], a[28:31], a[68:71], v[236:239]
    ds_read_b64_tr_b16 a[68:69], v9 offset:16384
    v_mfma_f32_16x16x32_bf16 v[48:51], a[0:3], a[72:75], v[48:51]
    ds_read_b64_tr_b16 a[70:71], v9 offset:18432
    v_mfma_f32_16x16x32_bf16 v[52:55], a[4:7], a[72:75], v[52:55]
    v_mfma_f32_16x16x32_bf16 v[112:115], a[8:11], a[72:75], v[112:115]
    ds_read_b128 a[40:43], v7 offset:4096
    v_mfma_f32_16x16x32_bf16 v[116:119], a[12:15], a[72:75], v[116:119]
    v_mfma_f32_16x16x32_bf16 v[176:179], a[16:19], a[72:75], v[176:179]
    buffer_load_dwordx4 v16, s[40:43], s49 offen offset:2048 lds
    v_mfma_f32_16x16x32_bf16 v[180:183], a[20:23], a[72:75], v[180:183]
    v_mfma_f32_16x16x32_bf16 v[240:243], a[24:27], a[72:75], v[240:243]
    ds_read_b128 a[44:47], v7 offset:6144
    v_mfma_f32_16x16x32_bf16 v[244:247], a[28:31], a[72:75], v[244:247]
    ds_read_b64_tr_b16 a[72:73], v10 offset:16384
    v_mfma_f32_16x16x32_bf16 v[56:59], a[0:3], a[76:79], v[56:59]
    ds_read_b64_tr_b16 a[74:75], v10 offset:18432
    v_mfma_f32_16x16x32_bf16 v[60:63], a[4:7], a[76:79], v[60:63]
    v_mfma_f32_16x16x32_bf16 v[120:123], a[8:11], a[76:79], v[120:123]
    ds_read_b128 a[48:51], v7 offset:8192
    v_mfma_f32_16x16x32_bf16 v[124:127], a[12:15], a[76:79], v[124:127]
    v_mfma_f32_16x16x32_bf16 v[184:187], a[16:19], a[76:79], v[184:187]
    buffer_load_dwordx4 v17, s[40:43], s49 offen offset:3072 lds
    v_mfma_f32_16x16x32_bf16 v[188:191], a[20:23], a[76:79], v[188:191]
    s_add_u32 s49, s49, 128
    v_mfma_f32_16x16x32_bf16 v[248:251], a[24:27], a[76:79], v[248:251]
    ds_read_b128 a[52:55], v7 offset:10240
    v_mfma_f32_16x16x32_bf16 v[252:255], a[28:31], a[76:79], v[252:255]
    ds_read_b64_tr_b16 a[76:77], v11 offset:16384
    s_waitcnt lgkmcnt(15)
    v_mfma_f32_16x16x32_bf16 v[64:67], a[0:3], a[80:83], v[64:67]
    ds_read_b64_tr_b16 a[78:79], v11 offset:18432
    v_mfma_f32_16x16x32_bf16 v[68:71], a[4:7], a[80:83], v[68:71]
    v_mfma_f32_16x16x32_bf16 v[128:131], a[8:11], a[80:83], v[128:131]
    ds_read_b128 a[56:59], v7 offset:12288
    v_mfma_f32_16x16x32_bf16 v[132:135], a[12:15], a[80:83], v[132:135]
    s_add_u32 m0, s61, 4096
    v_mfma_f32_16x16x32_bf16 v[192:195], a[16:19], a[80:83], v[192:195]
    buffer_load_dwordx4 v16, s[40:43], s50 offen offset:0 lds
    v_mfma_f32_16x16x32_bf16 v[196:199], a[20:23], a[80:83], v[196:199]
    v_mfma_f32_16x16x32_bf16 a[96:99], a[24:27], a[80:83], a[96:99]
    s_add_u32 s61, s61, 32768
    ds_read_b128 a[60:63], v7 offset:14336
    v_mfma_f32_16x16x32_bf16 a[100:103], a[28:31], a[80:83], a[100:103]
    s_cmp_ge_u32 s61, 98304
    s_cselect_b32 s90, 98304, 0
    ds_read_b64_tr_b16 a[80:81], v12 offset:16384
    v_mfma_f32_16x16x32_bf16 v[72:75], a[0:3], a[84:87], v[72:75]
    s_sub_u32 s61, s61, s90
    ds_read_b64_tr_b16 a[82:83], v12 offset:18432
    v_mfma_f32_16x16x32_bf16 v[76:79], a[4:7], a[84:87], v[76:79]
    s_add_u32 s64, s64, 32768
    v_mfma_f32_16x16x32_bf16 v[136:139], a[8:11], a[84:87], v[136:139]
    buffer_store_dwordx4 a[160:163], v2, s[24:27], s28 offen sc1
    v_mfma_f32_16x16x32_bf16 v[140:143], a[12:15], a[84:87], v[140:143]
    s_add_u32 s28, s28, s31
    v_mfma_f32_16x16x32_bf16 v[200:203], a[16:19], a[84:87], v[200:203]
    buffer_load_dwordx4 v17, s[40:43], s50 offen offset:1024 lds
    v_mfma_f32_16x16x32_bf16 v[204:207], a[20:23], a[84:87], v[204:207]
    s_add_u32 s50, s50, 128
    v_mfma_f32_16x16x32_bf16 a[104:107], a[24:27], a[84:87], a[104:107]
    s_cmp_ge_u32 s64, 98304
    s_cselect_b32 s63, 4294901760, s59
    s_cselect_b32 s64, 0, s64
    v_mfma_f32_16x16x32_bf16 a[108:111], a[28:31], a[84:87], a[108:111]
    ds_read_b64_tr_b16 a[84:85], v13 offset:16384
    v_mfma_f32_16x16x32_bf16 v[80:83], a[0:3], a[88:91], v[80:83]
    ds_read_b64_tr_b16 a[86:87], v13 offset:18432
    v_mfma_f32_16x16x32_bf16 v[84:87], a[4:7], a[88:91], v[84:87]
    v_mfma_f32_16x16x32_bf16 v[144:147], a[8:11], a[88:91], v[144:147]
    buffer_store_dwordx4 a[164:167], v2, s[24:27], s28 offen sc1
    v_mfma_f32_16x16x32_bf16 v[148:151], a[12:15], a[88:91], v[148:151]
    s_add_u32 s28, s28, s31
    v_mfma_f32_16x16x32_bf16 v[208:211], a[16:19], a[88:91], v[208:211]
    buffer_load_dwordx4 v16, s[40:43], s51 offen offset:2048 lds
    v_mfma_f32_16x16x32_bf16 v[212:215], a[20:23], a[88:91], v[212:215]
    v_mfma_f32_16x16x32_bf16 a[112:115], a[24:27], a[88:91], a[112:115]
    v_mfma_f32_16x16x32_bf16 a[116:119], a[28:31], a[88:91], a[116:119]
    ds_read_b64_tr_b16 a[88:89], v14 offset:16384
    s_waitcnt lgkmcnt(15)
    v_mfma_f32_16x16x32_bf16 v[88:91], a[0:3], a[92:95], v[88:91]
    ds_read_b64_tr_b16 a[90:91], v14 offset:18432
    v_mfma_f32_16x16x32_bf16 v[92:95], a[4:7], a[92:95], v[92:95]
    v_add_u32 v6, s63, v6
    v_add_u32 v7, s63, v7
    v_mfma_f32_16x16x32_bf16 v[152:155], a[8:11], a[92:95], v[152:155]
    buffer_store_dwordx4 a[168:171], v2, s[24:27], s28 offen sc1
    v_mfma_f32_16x16x32_bf16 v[156:159], a[12:15], a[92:95], v[156:159]
    s_add_u32 s28, s28, s31
    v_mfma_f32_16x16x32_bf16 v[216:219], a[16:19], a[92:95], v[216:219]
    buffer_load_dwordx4 v17, s[40:43], s51 offen offset:3072 lds
    v_mfma_f32_16x16x32_bf16 v[220:223], a[20:23], a[92:95], v[220:223]
    s_add_u32 s51, s51, 128
    v_mfma_f32_16x16x32_bf16 a[120:123], a[24:27], a[92:95], a[120:123]
    v_mfma_f32_16x16x32_bf16 a[124:127], a[28:31], a[92:95], a[124:127]
    ds_read_b64_tr_b16 a[92:93], v15 offset:16384
    ds_read_b64_tr_b16 a[94:95], v15 offset:18432
    v_mfma_f32_16x16x32_bf16 v[32:35], a[32:35], a[64:67], v[32:35]
    v_xor_b32 v8, s60, v8
    v_xor_b32 v9, s60, v9
    v_mfma_f32_16x16x32_bf16 v[36:39], a[36:39], a[64:67], v[36:39]
    v_xor_b32 v10, s60, v10
    v_xor_b32 v11, s60, v11
    s_waitcnt lgkmcnt(15)
    v_mfma_f32_16x16x32_bf16 v[96:99], a[40:43], a[64:67], v[96:99]
    v_xor_b32 v12, s60, v12
    v_xor_b32 v13, s60, v13
    v_mfma_f32_16x16x32_bf16 v[100:103], a[44:47], a[64:67], v[100:103]
    v_xor_b32 v14, s60, v14
    v_xor_b32 v15, s60, v15
    s_waitcnt lgkmcnt(13)
    v_mfma_f32_16x16x32_bf16 v[160:163], a[48:51], a[64:67], v[160:163]
    s_waitcnt lgkmcnt(12)
    v_mfma_f32_16x16x32_bf16 v[164:167], a[52:55], a[64:67], v[164:167]
    s_waitcnt lgkmcnt(9)
    v_mfma_f32_16x16x32_bf16 v[224:227], a[56:59], a[64:67], v[224:227]
    s_waitcnt vmcnt(16) lgkmcnt(0)
    v_mfma_f32_16x16x32_bf16 v[228:231], a[60:63], a[64:67], v[228:231]
    s_barrier
    ds_read_b64_tr_b16 a[64:65], v8 offset:0
    v_mfma_f32_16x16x32_bf16 v[40:43], a[32:35], a[68:71], v[40:43]
    s_add_u32 m0, s62, 0
    ds_read_b64_tr_b16 a[66:67], v8 offset:2048
    v_mfma_f32_16x16x32_bf16 v[44:47], a[36:39], a[68:71], v[44:47]
    buffer_load_dwordx4 v18, s[44:47], s52 offen offset:0 lds
    v_mfma_f32_16x16x32_bf16 v[104:107], a[40:43], a[68:71], v[104:107]
    ds_read_b128 a[0:3], v6 offset:0
    v_mfma_f32_16x16x32_bf16 v[108:111], a[44:47], a[68:71], v[108:111]
    v_mfma_f32_16x16x32_bf16 v[168:171], a[48:51], a[68:71], v[168:171]
    v_mfma_f32_16x16x32_bf16 v[172:175], a[52:55], a[68:71], v[172:175]
    buffer_load_dwordx4 v19, s[44:47], s52 offen offset:1024 lds
    v_mfma_f32_16x16x32_bf16 v[232:235], a[56:59], a[68:71], v[232:235]
    s_add_u32 s52, s52, s56
    ds_read_b128 a[4:7], v6 offset:2048
    v_mfma_f32_16x16x32_bf16 v[236:239], a[60:63], a[68:71], v[236:239]
    ds_read_b64_tr_b16 a[68:69], v9 offset:0
    v_mfma_f32_16x16x32_bf16 v[48:51], a[32:35], a[72:75], v[48:51]
    ds_read_b64_tr_b16 a[70:71], v9 offset:2048
    v_mfma_f32_16x16x32_bf16 v[52:55], a[36:39], a[72:75], v[52:55]
    buffer_load_dwordx4 v18, s[44:47], s53 offen offset:2048 lds
    v_mfma_f32_16x16x32_bf16 v[112:115], a[40:43], a[72:75], v[112:115]
    ds_read_b128 a[8:11], v6 offset:4096
    v_mfma_f32_16x16x32_bf16 v[116:119], a[44:47], a[72:75], v[116:119]
    v_mfma_f32_16x16x32_bf16 v[176:179], a[48:51], a[72:75], v[176:179]
    v_mfma_f32_16x16x32_bf16 v[180:183], a[52:55], a[72:75], v[180:183]
    buffer_load_dwordx4 v19, s[44:47], s53 offen offset:3072 lds
    v_mfma_f32_16x16x32_bf16 v[240:243], a[56:59], a[72:75], v[240:243]
    s_add_u32 s53, s53, s56
    ds_read_b128 a[12:15], v6 offset:6144
    v_mfma_f32_16x16x32_bf16 v[244:247], a[60:63], a[72:75], v[244:247]
    ds_read_b64_tr_b16 a[72:73], v10 offset:0
    v_mfma_f32_16x16x32_bf16 v[56:59], a[32:35], a[76:79], v[56:59]
    s_add_u32 m0, s62, 4096
    ds_read_b64_tr_b16 a[74:75], v10 offset:2048
    v_mfma_f32_16x16x32_bf16 v[60:63], a[36:39], a[76:79], v[60:63]
    buffer_load_dwordx4 v20, s[44:47], s54 offen offset:0 lds
    v_mfma_f32_16x16x32_bf16 v[120:123], a[40:43], a[76:79], v[120:123]
    ds_read_b128 a[16:19], v6 offset:8192
    v_mfma_f32_16x16x32_bf16 v[124:127], a[44:47], a[76:79], v[124:127]
    s_xor_b32 s62, s62, 229376
    v_mfma_f32_16x16x32_bf16 v[184:187], a[48:51], a[76:79], v[184:187]
    v_mfma_f32_16x16x32_bf16 v[188:191], a[52:55], a[76:79], v[188:191]
    buffer_load_dwordx4 v21, s[44:47], s54 offen offset:1024 lds
    v_mfma_f32_16x16x32_bf16 v[248:251], a[56:59], a[76:79], v[248:251]
    s_add_u32 s54, s54, s56
    ds_read_b128 a[20:23], v6 offset:10240
    v_mfma_f32_16x16x32_bf16 v[252:255], a[60:63], a[76:79], v[252:255]
    ds_read_b64_tr_b16 a[76:77], v11 offset:0
    v_mfma_f32_16x16x32_bf16 v[64:67], a[32:35], a[80:83], v[64:67]
    ds_read_b64_tr_b16 a[78:79], v11 offset:2048
    v_mfma_f32_16x16x32_bf16 v[68:71], a[36:39], a[80:83], v[68:71]
    buffer_load_dwordx4 v20, s[44:47], s55 offen offset:2048 lds
    v_mfma_f32_16x16x32_bf16 v[128:131], a[40:43], a[80:83], v[128:131]
    ds_read_b128 a[24:27], v6 offset:12288
    v_mfma_f32_16x16x32_bf16 v[132:135], a[44:47], a[80:83], v[132:135]
    v_mfma_f32_16x16x32_bf16 v[192:195], a[48:51], a[80:83], v[192:195]
    v_mfma_f32_16x16x32_bf16 v[196:199], a[52:55], a[80:83], v[196:199]
    buffer_load_dwordx4 v21, s[44:47], s55 offen offset:3072 lds
    v_mfma_f32_16x16x32_bf16 a[96:99], a[56:59], a[80:83], a[96:99]
    s_add_u32 s55, s55, s56
    ds_read_b128 a[28:31], v6 offset:14336
    v_mfma_f32_16x16x32_bf16 a[100:103], a[60:63], a[80:83], a[100:103]
    ds_read_b64_tr_b16 a[80:81], v12 offset:0
    v_mfma_f32_16x16x32_bf16 v[72:75], a[32:35], a[84:87], v[72:75]
    ds_read_b64_tr_b16 a[82:83], v12 offset:2048
    v_mfma_f32_16x16x32_bf16 v[76:79], a[36:39], a[84:87], v[76:79]
    v_mfma_f32_16x16x32_bf16 v[136:139], a[40:43], a[84:87], v[136:139]
    buffer_store_dwordx4 a[172:175], v2, s[24:27], s28 offen sc1
    v_mfma_f32_16x16x32_bf16 v[140:143], a[44:47], a[84:87], v[140:143]
    s_add_u32 s28, s28, s31
    v_mfma_f32_16x16x32_bf16 v[200:203], a[48:51], a[84:87], v[200:203]
    v_mfma_f32_16x16x32_bf16 v[204:207], a[52:55], a[84:87], v[204:207]
    v_mfma_f32_16x16x32_bf16 a[104:107], a[56:59], a[84:87], a[104:107]
    buffer_store_dwordx4 a[176:179], v2, s[24:27], s28 offen sc1
    v_mfma_f32_16x16x32_bf16 a[108:111], a[60:63], a[84:87], a[108:111]
    s_add_u32 s28, s28, s31
    ds_read_b64_tr_b16 a[84:85], v13 offset:0
    v_mfma_f32_16x16x32_bf16 v[80:83], a[32:35], a[88:91], v[80:83]
    ds_read_b64_tr_b16 a[86:87], v13 offset:2048
    v_mfma_f32_16x16x32_bf16 v[84:87], a[36:39], a[88:91], v[84:87]
    v_mfma_f32_16x16x32_bf16 v[144:147], a[40:43], a[88:91], v[144:147]
    buffer_store_dwordx4 a[180:183], v2, s[24:27], s28 offen sc1
    v_mfma_f32_16x16x32_bf16 v[148:151], a[44:47], a[88:91], v[148:151]
    s_add_u32 s28, s28, s31
    v_mfma_f32_16x16x32_bf16 v[208:211], a[48:51], a[88:91], v[208:211]
    v_mfma_f32_16x16x32_bf16 v[212:215], a[52:55], a[88:91], v[212:215]
    v_mfma_f32_16x16x32_bf16 a[112:115], a[56:59], a[88:91], a[112:115]
    buffer_store_dwordx4 a[184:187], v2, s[24:27], s28 offen sc1
    v_mfma_f32_16x16x32_bf16 a[116:119], a[60:63], a[88:91], a[116:119]
    s_add_u32 s28, s28, s31
    ds_read_b64_tr_b16 a[88:89], v14 offset:0
    v_mfma_f32_16x16x32_bf16 v[88:91], a[32:35], a[92:95], v[88:91]
    ds_read_b64_tr_b16 a[90:91], v14 offset:2048
    v_mfma_f32_16x16x32_bf16 v[92:95], a[36:39], a[92:95], v[92:95]
    v_mfma_f32_16x16x32_bf16 v[152:155], a[40:43], a[92:95], v[152:155]
    buffer_store_dwordx4 a[188:191], v2, s[24:27], s28 offen sc1
    v_mfma_f32_16x16x32_bf16 v[156:159], a[44:47], a[92:95], v[156:159]
    s_add_u32 s29, s29, s30
    s_mov_b32 s28, s29
    v_mfma_f32_16x16x32_bf16 v[216:219], a[48:51], a[92:95], v[216:219]
    s_sub_u32 s65, s65, 1
    v_mfma_f32_16x16x32_bf16 v[220:223], a[52:55], a[92:95], v[220:223]
    v_mfma_f32_16x16x32_bf16 a[120:123], a[56:59], a[92:95], a[120:123]
    v_mfma_f32_16x16x32_bf16 a[124:127], a[60:63], a[92:95], a[124:127]
    ds_read_b64_tr_b16 a[92:93], v15 offset:0
    ds_read_b64_tr_b16 a[94:95], v15 offset:2048
    s_cmp_eq_u32 s66, 2
    s_cbranch_scc1 m_hook18
m_hookr19:
    s_waitcnt lgkmcnt(15)
    v_mfma_f32_16x16x32_bf16 v[32:35], a[0:3], a[64:67], v[32:35]
    v_mfma_f32_16x16x32_bf16 v[36:39], a[4:7], a[64:67], v[36:39]
    v_mfma_f32_16x16x32_bf16 v[96:99], a[8:11], a[64:67], v[96:99]
    v_mfma_f32_16x16x32_bf16 v[100:103], a[12:15], a[64:67], v[100:103]
    s_add_u32 m0, s61, 0
    s_waitcnt lgkmcnt(13)
    v_mfma_f32_16x16x32_bf16 v[160:163], a[16:19], a[64:67], v[160:163]
    buffer_load_dwordx4 v16, s[40:43], s48 offen offset:0 lds
    s_waitcnt lgkmcnt(12)
    v_mfma_f32_16x16x32_bf16 v[164:167], a[20:23], a[64:67], v[164:167]
    s_waitcnt lgkmcnt(9)
    v_mfma_f32_16x16x32_bf16 v[224:227], a[24:27], a[64:67], v[224:227]
    s_waitcnt lgkmcnt(8)
    v_mfma_f32_16x16x32_bf16 v[228:231], a[28:31], a[64:67], v[228:231]
    ds_read_b64_tr_b16 a[64:65], v8 offset:16384
    v_mfma_f32_16x16x32_bf16 v[40:43], a[0:3], a[68:71], v[40:43]
    ds_read_b64_tr_b16 a[66:67], v8 offset:18432
    v_mfma_f32_16x16x32_bf16 v[44:47], a[4:7], a[68:71], v[44:47]
    v_mfma_f32_16x16x32_bf16 v[104:107], a[8:11], a[68:71], v[104:107]
    ds_read_b128 a[32:35], v7 offset:0
    v_mfma_f32_16x16x32_bf16 v[108:111], a[12:15], a[68:71], v[108:111]
    v_mfma_f32_16x16x32_bf16 v[168:171], a[16:19], a[68:71], v[168:171]
    buffer_load_dwordx4 v17, s[40:43], s48 offen offset:1024 lds
    v_mfma_f32_16x16x32_bf16 v[172:175], a[20:23], a[68:71], v[172:175]
    s_add_u32 s48, s48, 128
    v_mfma_f32_16x16x32_bf16 v[232:235], a[24:27], a[68:71], v[232:235]
    ds_read_b128 a[36:39], v7 offset:2048
    v_mfma_f32_16x16x32_bf16 v[236:239], a[28:31], a[68:71], v[236:239]
    ds_read_b64_tr_b16 a[68:69], v9 offset:16384
    v_mfma_f32_16x16x32_bf16 v[48:51], a[0:3], a[72:75], v[48:51]
    ds_read_b64_tr_b16 a[70:71], v9 offset:18432
    v_mfma_f32_16x16x32_bf16 v[52:55], a[4:7], a[72:75], v[52:55]
    v_mfma_f32_16x16x32_bf16 v[112:115], a[8:11], a[72:75], v[112:115]
    ds_read_b128 a[40:43], v7 offset:4096
    v_mfma_f32_16x16x32_bf16 v[116:119], a[12:15], a[72:75], v[116:119]
    v_mfma_f32_16x16x32_bf16 v[176:179], a[16:19], a[72:75], v[176:179]
    buffer_load_dwordx4 v16, s[40:43], s49 offen offset:2048 lds
    v_mfma_f32_16x16x32_bf16 v[180:183], a[20:23], a[72:75], v[180:183]
    v_mfma_f32_16x16x32_bf16 v[240:243], a[24:27], a[72:75], v[240:243]
    ds_read_b128 a[44:47], v7 offset:6144
    v_mfma_f32_16x16x32_bf16 v[244:247], a[28:31], a[72:75], v[244:247]
    ds_read_b64_tr_b16 a[72:73], v10 offset:16384
    v_mfma_f32_16x16x32_bf16 v[56:59], a[0:3], a[76:79], v[56:59]
    ds_read_b64_tr_b16 a[74:75], v10 offset:18432
    v_mfma_f32_16x16x32_bf16 v[60:63], a[4:7], a[76:79], v[60:63]
    v_mfma_f32_16x16x32_bf16 v[120:123], a[8:11], a[76:79], v[120:123]
    ds_read_b128 a[48:51], v7 offset:8192
    v_mfma_f32_16x16x32_bf16 v[124:127], a[12:15], a[76:79], v[124:127]
    v_mfma_f32_16x16x32_bf16 v[184:187], a[16:19], a[76:79], v[184:187]
    buffer_load_dwordx4 v17, s[40:43], s49 offen offset:3072 lds
    v_mfma_f32_16x16x32_bf16 v[188:191], a[20:23], a[76:79], v[188:191]
    s_add_u32 s49, s49, 128
    v_mfma_f32_16x16x32_bf16 v[248:251], a[24:27], a[76:79], v[248:251]
    ds_read_b128 a[52:55], v7 offset:10240
    v_mfma_f32_16x16x32_bf16 v[252:255], a[28:31], a[76:79], v[252:255]
    ds_read_b64_tr_b16 a[76:77], v11 offset:16384
    s_waitcnt lgkmcnt(15)
    v_mfma_f32_16x16x32_bf16 v[64:67], a[0:3], a[80:83], v[64:67]
    ds_read_b64_tr_b16 a[78:79], v11 offset:18432
    v_mfma_f32_16x16x32_bf16 v[68:71], a[4:7], a[80:83], v[68:71]
    v_mfma_f32_16x16x32_bf16 v[128:131], a[8:11], a[80:83], v[128:131]
    ds_read_b128 a[56:59], v7 offset:12288
    v_mfma_f32_16x16x32_bf16 v[132:135], a[12:15], a[80:83], v[132:135]
    s_add_u32 m0, s61, 4096
    v_mfma_f32_16x16x32_bf16 v[192:195], a[16:19], a[80:83], v[192:195]
    buffer_load_dwordx4 v16, s[40:43], s50 offen offset:0 lds
    v_mfma_f32_16x16x32_bf16 v[196:199], a[20:23], a[80:83], v[196:199]
    v_mfma_f32_16x16x32_bf16 a[96:99], a[24:27], a[80:83], a[96:99]
    s_add_u32 s61, s61, 32768
    ds_read_b128 a[60:63], v7 offset:14336
    v_mfma_f32_16x16x32_bf16 a[100:103], a[28:31], a[80:83], a[100:103]
    s_cmp_ge_u32 s61, 98304
    s_cselect_b32 s90, 98304, 0
    ds_read_b64_tr_b16 a[80:81], v12 offset:16384
    v_mfma_f32_16x16x32_bf16 v[72:75], a[0:3], a[84:87], v[72:75]
    s_sub_u32 s61, s61, s90
    ds_read_b64_tr_b16 a[82:83], v12 offset:18432
    v_mfma_f32_16x16x32_bf16 v[76:79], a[4:7], a[84:87], v[76:79]
    s_add_u32 s64, s64, 32768
    v_mfma_f32_16x16x32_bf16 v[136:139], a[8:11], a[84:87], v[136:139]
    buffer_store_dwordx4 a[192:195], v2, s[24:27], s28 offen sc1
    v_mfma_f32_16x16x32_bf16 v[140:143], a[12:15], a[84:87], v[140:143]
    s_add_u32 s28, s28, s31
    v_mfma_f32_16x16x32_bf16 v[200:203], a[16:19], a[84:87], v[200:203]
    buffer_load_dwordx4 v17, s[40:43], s50 offen offset:1024 lds
    v_mfma_f32_16x16x32_bf16 v[204:207], a[20:23], a[84:87], v[204:207]
    s_add_u32 s50, s50, 128
    v_mfma_f32_16x16x32_bf16 a[104:107], a[24:27], a[84:87], a[104:107]
    s_cmp_ge_u32 s64, 98304
    s_cselect_b32 s63, 4294901760, s59
    s_cselect_b32 s64, 0, s64
    v_mfma_f32_16x16x32_bf16 a[108:111], a[28:31], a[84:87], a[108:111]
    ds_read_b64_tr_b16 a[84:85], v13 offset:16384
    v_mfma_f32_16x16x32_bf16 v[80:83], a[0:3], a[88:91], v[80:83]
    ds_read_b64_tr_b16 a[86:87], v13 offset:18432
    v_mfma_f32_16x16x32_bf16 v[84:87], a[4:7], a[88:91], v[84:87]
    v_mfma_f32_16x16x32_bf16 v[144:147], a[8:11], a[88:91], v[144:147]
    buffer_store_dwordx4 a[196:199], v2, s[24:27], s28 offen sc1
    v_mfma_f32_16x16x32_bf16 v[148:151], a[12:15], a[88:91], v[148:151]
    s_add_u32 s28, s28, s31
    v_mfma_f32_16x16x32_bf16 v[208:211], a[16:19], a[88:91], v[208:211]
    buffer_load_dwordx4 v16, s[40:43], s51 offen offset:2048 lds
    v_mfma_f32_16x16x32_bf16 v[212:215], a[20:23], a[88:91], v[212:215]
    v_mfma_f32_16x16x32_bf16 a[112:115], a[24:27], a[88:91], a[112:115]
    v_mfma_f32_16x16x32_bf16 a[116:119], a[28:31], a[88:91], a[116:119]
    ds_read_b64_tr_b16 a[88:89], v14 offset:16384
    s_waitcnt lgkmcnt(15)
    v_mfma_f32_16x16x32_bf16 v[88:91], a[0:3], a[92:95], v[88:91]
    ds_read_b64_tr_b16 a[90:91], v14 offset:18432
    v_mfma_f32_16x16x32_bf16 v[92:95], a[4:7], a[92:95], v[92:95]
    v_add_u32 v6, s63, v6
    v_add_u32 v7, s63, v7
    v_mfma_f32_16x16x32_bf16 v[152:155], a[8:11], a[92:95], v[152:155]
    buffer_store_dwordx4 a[200:203], v2, s[24:27], s28 offen sc1
    v_mfma_f32_16x16x32_bf16 v[156:159], a[12:15], a[92:95], v[156:159]
    s_add_u32 s28, s28, s31
    v_mfma_f32_16x16x32_bf16 v[216:219], a[16:19], a[92:95], v[216:219]
    buffer_load_dwordx4 v17, s[40:43], s51 offen offset:3072 lds
    v_mfma_f32_16x16x32_bf16 v[220:223], a[20:23], a[92:95], v[220:223]
    s_add_u32 s51, s51, 128
    v_mfma_f32_16x16x32_bf16 a[120:123], a[24:27], a[92:95], a[120:123]
    v_mfma_f32_16x16x32_bf16 a[124:127], a[28:31], a[92:95], a[124:127]
    ds_read_b64_tr_b16 a[92:93], v15 offset:16384
    ds_read_b64_tr_b16 a[94:95], v15 offset:18432
    v_mfma_f32_16x16x32_bf16 v[32:35], a[32:35], a[64:67], v[32:35]
    v_xor_b32 v8, s60, v8
    v_xor_b32 v9, s60, v9
    v_mfma_f32_16x16x32_bf16 v[36:39], a[36:39], a[64:67], v[36:39]
    v_xor_b32 v10, s60, v10
    v_xor_b32 v11, s60, v11
    s_waitcnt lgkmcnt(15)
    v_mfma_f32_16x16x32_bf16 v[96:99], a[40:43], a[64:67], v[96:99]
    v_xor_b32 v12, s60, v12
    v_xor_b32 v13, s60, v13
    v_mfma_f32_16x16x32_bf16 v[100:103], a[44:47], a[64:67], v[100:103]
    v_xor_b32 v14, s60, v14
    v_xor_b32 v15, s60, v15
    s_waitcnt lgkmcnt(13)
    v_mfma_f32_16x16x32_bf16 v[160:163], a[48:51], a[64:67], v[160:163]
    s_waitcnt lgkmcnt(12)
    v_mfma_f32_16x16x32_bf16 v[164:167], a[52:55], a[64:67], v[164:167]
    s_waitcnt lgkmcnt(9)
    v_mfma_f32_16x16x32_bf16 v[224:227], a[56:59], a[64:67], v[224:227]
    s_waitcnt vmcnt(16) lgkmcnt(0)
    v_mfma_f32_16x16x32_bf16 v[228:231], a[60:63], a[64:67], v[228:231]
    s_barrier
    ds_read_b64_tr_b16 a[64:65], v8 offset:0
    v_mfma_f32_16x16x32_bf16 v[40:43], a[32:35], a[68:71], v[40:43]
    s_add_u32 m0, s62, 0
    ds_read_b64_tr_b16 a[66:67], v8 offset:2048
    v_mfma_f32_16x16x32_bf16 v[44:47], a[36:39], a[68:71], v[44:47]
    buffer_load_dwordx4 v18, s[44:47], s52 offen offset:0 lds
    v_mfma_f32_16x16x32_bf16 v[104:107], a[40:43], a[68:71], v[104:107]
    ds_read_b128 a[0:3], v6 offset:0
    v_mfma_f32_16x16x32_bf16 v[108:111], a[44:47], a[68:71], v[108:111]
    v_mfma_f32_16x16x32_bf16 v[168:171], a[48:51], a[68:71], v[168:171]
    v_mfma_f32_16x16x32_bf16 v[172:175], a[52:55], a[68:71], v[172:175]
    buffer_load_dwordx4 v19, s[44:47], s52 offen offset:1024 lds
    v_mfma_f32_16x16x32_bf16 v[232:235], a[56:59], a[68:71], v[232:235]
    s_add_u32 s52, s52, s56
    ds_read_b128 a[4:7], v6 offset:2048
    v_mfma_f32_16x16x32_bf16 v[236:239], a[60:63], a[68:71], v[236:239]
    ds_read_b64_tr_b16 a[68:69], v9 offset:0
    v_mfma_f32_16x16x32_bf16 v[48:51], a[32:35], a[72:75], v[48:51]
    ds_read_b64_tr_b16 a[70:71], v9 offset:2048
    v_mfma_f32_16x16x32_bf16 v[52:55], a[36:39], a[72:75], v[52:55]
    buffer_load_dwordx4 v18, s[44:47], s53 offen offset:2048 lds
    v_mfma_f32_16x16x32_bf16 v[112:115], a[40:43], a[72:75], v[112:115]
    ds_read_b128 a[8:11], v6 offset:4096
    v_mfma_f32_16x16x32_bf16 v[116:119], a[44:47], a[72:75], v[116:119]
    v_mfma_f32_16x16x32_bf16 v[176:179], a[48:51], a[72:75], v[176:179]
    v_mfma_f32_16x16x32_bf16 v[180:183], a[52:55], a[72:75], v[180:183]
    buffer_load_dwordx4 v19, s[44:47], s53 offen offset:3072 lds
    v_mfma_f32_16x16x32_bf16 v[240:243], a[56:59], a[72:75], v[240:243]
    s_add_u32 s53, s53, s56
    ds_read_b128 a[12:15], v6 offset:6144
    v_mfma_f32_16x16x32_bf16 v[244:247], a[60:63], a[72:75], v[244:247]
    ds_read_b64_tr_b16 a[72:73], v10 offset:0
    v_mfma_f32_16x16x32_bf16 v[56:59], a[32:35], a[76:79], v[56:59]
    s_add_u32 m0, s62, 4096
    ds_read_b64_tr_b16 a[74:75], v10 offset:2048
    v_mfma_f32_16x16x32_bf16 v[60:63], a[36:39], a[76:79], v[60:63]
    buffer_load_dwordx4 v20, s[44:47], s54 offen offset:0 lds
    v_mfma_f32_16x16x32_bf16 v[120:123], a[40:43], a[76:79], v[120:123]
    ds_read_b128 a[16:19], v6 offset:8192
    v_mfma_f32_16x16x32_bf16 v[124:127], a[44:47], a[76:79], v[124:127]
    s_xor_b32 s62, s62, 229376
    v_mfma_f32_16x16x32_bf16 v[184:187], a[48:51], a[76:79], v[184:187]
    v_mfma_f32_16x16x32_bf16 v[188:191], a[52:55], a[76:79], v[188:191]
    buffer_load_dwordx4 v21, s[44:47], s54 offen offset:1024 lds
    v_mfma_f32_16x16x32_bf16 v[248:251], a[56:59], a[76:79], v[248:251]
    s_add_u32 s54, s54, s56
    ds_read_b128 a[20:23], v6 offset:10240
    v_mfma_f32_16x16x32_bf16 v[252:255], a[60:63], a[76:79], v[252:255]
    ds_read_b64_tr_b16 a[76:77], v11 offset:0
    v_mfma_f32_16x16x32_bf16 v[64:67], a[32:35], a[80:83], v[64:67]
    ds_read_b64_tr_b16 a[78:79], v11 offset:2048
    v_mfma_f32_16x16x32_bf16 v[68:71], a[36:39], a[80:83], v[68:71]
    buffer_load_dwordx4 v20, s[44:47], s55 offen offset:2048 lds
    v_mfma_f32_16x16x32_bf16 v[128:131], a[40:43], a[80:83], v[128:131]
    ds_read_b128 a[24:27], v6 offset:12288
    v_mfma_f32_16x16x32_bf16 v[132:135], a[44:47], a[80:83], v[132:135]
    v_mfma_f32_16x16x32_bf16 v[192:195], a[48:51], a[80:83], v[192:195]
    v_mfma_f32_16x16x32_bf16 v[196:199], a[52:55], a[80:83], v[196:199]
    buffer_load_dwordx4 v21, s[44:47], s55 offen offset:3072 lds
    v_mfma_f32_16x16x32_bf16 a[96:99], a[56:59], a[80:83], a[96:99]
    s_add_u32 s55, s55, s56
    ds_read_b128 a[28:31], v6 offset:14336
    v_mfma_f32_16x16x32_bf16 a[100:103], a[60:63], a[80:83], a[100:103]
    ds_read_b64_tr_b16 a[80:81], v12 offset:0
    v_mfma_f32_16x16x32_bf16 v[72:75], a[32:35], a[84:87], v[72:75]
    ds_read_b64_tr_b16 a[82:83], v12 offset:2048
    v_mfma_f32_16x16x32_bf16 v[76:79], a[36:39], a[84:87], v[76:79]
    v_mfma_f32_16x16x32_bf16 v[136:139], a[40:43], a[84:87], v[136:139]
    buffer_store_dwordx4 a[204:207], v2, s[24:27], s28 offen sc1
    v_mfma_f32_16x16x32_bf16 v[140:143], a[44:47], a[84:87], v[140:143]
    s_add_u32 s28, s28, s31
    v_mfma_f32_16x16x32_bf16 v[200:203], a[48:51], a[84:87], v[200:203]
    v_mfma_f32_16x16x32_bf16 v[204:207], a[52:55], a[84:87], v[204:207]
    v_mfma_f32_16x16x32_bf16 a[104:107], a[56:59], a[84:87], a[104:107]
    buffer_store_dwordx4 a[208:211], v2, s[24:27], s28 offen sc1
    v_mfma_f32_16x16x32_bf16 a[108:111], a[60:63], a[84:87], a[108:111]
    s_add_u32 s28, s28, s31
    ds_read_b64_tr_b16 a[84:85], v13 offset:0
    v_mfma_f32_16x16x32_bf16 v[80:83], a[32:35], a[88:91], v[80:83]
    ds_read_b64_tr_b16 a[86:87], v13 offset:2048
    v_mfma_f32_16x16x32_bf16 v[84:87], a[36:39], a[88:91], v[84:87]
    v_mfma_f32_16x16x32_bf16 v[144:147], a[40:43], a[88:91], v[144:147]
    buffer_store_dwordx4 a[212:215], v2, s[24:27], s28 offen sc1
    v_mfma_f32_16x16x32_bf16 v[148:151], a[44:47], a[88:91], v[148:151]
    s_add_u32 s28, s28, s31
    v_mfma_f32_16x16x32_bf16 v[208:211], a[48:51], a[88:91], v[208:211]
    v_mfma_f32_16x16x32_bf16 v[212:215], a[52:55], a[88:91], v[212:215]
    v_mfma_f32_16x16x32_bf16 a[112:115], a[56:59], a[88:91], a[112:115]
    buffer_store_dwordx4 a[216:219], v2, s[24:27], s28 offen sc1
    v_mfma_f32_16x16x32_bf16 a[116:119], a[60:63], a[88:91], a[116:119]
    s_add_u32 s28, s28, s31
    ds_read_b64_tr_b16 a[88:89], v14 offset:0
    v_mfma_f32_16x16x32_bf16 v[88:91], a[32:35], a[92:95], v[88:91]
    ds_read_b64_tr_b16 a[90:91], v14 offset:2048
    v_mfma_f32_16x16x32_bf16 v[92:95], a[36:39], a[92:95], v[92:95]
    v_mfma_f32_16x16x32_bf16 v[152:155], a[40:43], a[92:95], v[152:155]
    buffer_store_dwordx4 a[220:223], v2, s[24:27], s28 offen sc1
    v_mfma_f32_16x16x32_bf16 v[156:159], a[44:47], a[92:95], v[156:159]
    s_add_u32 s29, s29, s30
    s_mov_b32 s28, s29
    v_mfma_f32_16x16x32_bf16 v[216:219], a[48:51], a[92:95], v[216:219]
    s_sub_u32 s65, s65, 1
    v_mfma_f32_16x16x32_bf16 v[220:223], a[52:55], a[92:95], v[220:223]
    v_mfma_f32_16x16x32_bf16 a[120:123], a[56:59], a[92:95], a[120:123]
    v_mfma_f32_16x16x32_bf16 a[124:127], a[60:63], a[92:95], a[124:127]
    ds_read_b64_tr_b16 a[92:93], v15 offset:0
    ds_read_b64_tr_b16 a[94:95], v15 offset:2048
    s_waitcnt lgkmcnt(15)
    v_mfma_f32_16x16x32_bf16 v[32:35], a[0:3], a[64:67], v[32:35]
    v_mfma_f32_16x16x32_bf16 v[36:39], a[4:7], a[64:67], v[36:39]
    v_mfma_f32_16x16x32_bf16 v[96:99], a[8:11], a[64:67], v[96:99]
    v_mfma_f32_16x16x32_bf16 v[100:103], a[12:15], a[64:67], v[100:103]
    s_add_u32 m0, s61, 0
    s_waitcnt lgkmcnt(13)
    v_mfma_f32_16x16x32_bf16 v[160:163], a[16:19], a[64:67], v[160:163]
    buffer_load_dwordx4 v16, s[40:43], s48 offen offset:0 lds
    s_waitcnt lgkmcnt(12)
    v_mfma_f32_16x16x32_bf16 v[164:167], a[20:23], a[64:67], v[164:167]
    s_waitcnt lgkmcnt(9)
    v_mfma_f32_16x16x32_bf16 v[224:227], a[24:27], a[64:67], v[224:227]
    s_waitcnt lgkmcnt(8)
    v_mfma_f32_16x16x32_bf16 v[228:231], a[28:31], a[64:67], v[228:231]
    ds_read_b64_tr_b16 a[64:65], v8 offset:16384
    v_mfma_f32_16x16x32_bf16 v[40:43], a[0:3], a[68:71], v[40:43]
    ds_read_b64_tr_b16 a[66:67], v8 offset:18432
    v_mfma_f32_16x16x32_bf16 v[44:47], a[4:7], a[68:71], v[44:47]
    v_mfma_f32_16x16x32_bf16 v[104:107], a[8:11], a[68:71], v[104:107]
    ds_read_b128 a[32:35], v7 offset:0
    v_mfma_f32_16x16x32_bf16 v[108:111], a[12:15], a[68:71], v[108:111]
    v_mfma_f32_16x16x32_bf16 v[168:171], a[16:19], a[68:71], v[168:171]
    buffer_load_dwordx4 v17, s[40:43], s48 offen offset:1024 lds
    v_mfma_f32_16x16x32_bf16 v[172:175], a[20:23], a[68:71], v[172:175]
    s_add_u32 s48, s48, 128
    v_mfma_f32_16x16x32_bf16 v[232:235], a[24:27], a[68:71], v[232:235]
    ds_read_b128 a[36:39], v7 offset:2048
    v_mfma_f32_16x16x32_bf16 v[236:239], a[28:31], a[68:71], v[236:239]
    ds_read_b64_tr_b16 a[68:69], v9 offset:16384
    v_mfma_f32_16x16x32_bf16 v[48:51], a[0:3], a[72:75], v[48:51]
    ds_read_b64_tr_b16 a[70:71], v9 offset:18432
    v_mfma_f32_16x16x32_bf16 v[52:55], a[4:7], a[72:75], v[52:55]
    v_mfma_f32_16x16x32_bf16 v[112:115], a[8:11], a[72:75], v[112:115]
    ds_read_b128 a[40:43], v7 offset:4096
    v_mfma_f32_16x16x32_bf16 v[116:119], a[12:15], a[72:75], v[116:119]
    v_mfma_f32_16x16x32_bf16 v[176:179], a[16:19], a[72:75], v[176:179]
    buffer_load_dwordx4 v16, s[40:43], s49 offen offset:2048 lds
    v_mfma_f32_16x16x32_bf16 v[180:183], a[20:23], a[72:75], v[180:183]
    v_mfma_f32_16x16x32_bf16 v[240:243], a[24:27], a[72:75], v[240:243]
    ds_read_b128 a[44:47], v7 offset:6144
    v_mfma_f32_16x16x32_bf16 v[244:247], a[28:31], a[72:75], v[244:247]
    ds_read_b64_tr_b16 a[72:73], v10 offset:16384
    v_mfma_f32_16x16x32_bf16 v[56:59], a[0:3], a[76:79], v[56:59]
    ds_read_b64_tr_b16 a[74:75], v10 offset:18432
    v_mfma_f32_16x16x32_bf16 v[60:63], a[4:7], a[76:79], v[60:63]
    v_mfma_f32_16x16x32_bf16 v[120:123], a[8:11], a[76:79], v[120:123]
    ds_read_b128 a[48:51], v7 offset:8192
    v_mfma_f32_16x16x32_bf16 v[124:127], a[12:15], a[76:79], v[124:127]
    v_mfma_f32_16x16x32_bf16 v[184:187], a[16:19], a[76:79], v[184:187]
    buffer_load_dwordx4 v17, s[40:43], s49 offen offset:3072 lds
    v_mfma_f32_16x16x32_bf16 v[188:191], a[20:23], a[76:79], v[188:191]
    s_add_u32 s49, s49, 128
    v_mfma_f32_16x16x32_bf16 v[248:251], a[24:27], a[76:79], v[248:251]
    ds_read_b128 a[52:55], v7 offset:10240
    v_mfma_f32_16x16x32_bf16 v[252:255], a[28:31], a[76:79], v[252:255]
    ds_read_b64_tr_b16 a[76:77], v11 offset:16384
    s_waitcnt lgkmcnt(15)
    v_mfma_f32_16x16x32_bf16 v[64:67], a[0:3], a[80:83], v[64:67]
    ds_read_b64_tr_b16 a[78:79], v11 offset:18432
    v_mfma_f32_16x16x32_bf16 v[68:71], a[4:7], a[80:83], v[68:71]
    v_mfma_f32_16x16x32_bf16 v[128:131], a[8:11], a[80:83], v[128:131]
    ds_read_b128 a[56:59], v7 offset:12288
    v_mfma_f32_16x16x32_bf16 v[132:135], a[12:15], a[80:83], v[132:135]
    s_add_u32 m0, s61, 4096
    v_mfma_f32_16x16x32_bf16 v[192:195], a[16:19], a[80:83], v[192:195]
    buffer_load_dwordx4 v16, s[40:43], s50 offen offset:0 lds
    v_mfma_f32_16x16x32_bf16 v[196:199], a[20:23], a[80:83], v[196:199]
    v_mfma_f32_16x16x32_bf16 a[96:99], a[24:27], a[80:83], a[96:99]
    s_add_u32 s61, s61, 32768
    ds_read_b128 a[60:63], v7 offset:14336
    v_mfma_f32_16x16x32_bf16 a[100:103], a[28:31], a[80:83], a[100:103]
    s_cmp_ge_u32 s61, 98304
    s_cselect_b32 s90, 98304, 0
    ds_read_b64_tr_b16 a[80:81], v12 offset:16384
    v_mfma_f32_16x16x32_bf16 v[72:75], a[0:3], a[84:87], v[72:75]
    s_sub_u32 s61, s61, s90
    ds_read_b64_tr_b16 a[82:83], v12 offset:18432
    v_mfma_f32_16x16x32_bf16 v[76:79], a[4:7], a[84:87], v[76:79]
    s_add_u32 s64, s64, 32768
    v_mfma_f32_16x16x32_bf16 v[136:139], a[8:11], a[84:87], v[136:139]
    buffer_store_dwordx4 a[224:227], v2, s[24:27], s28 offen sc1
    v_mfma_f32_16x16x32_bf16 v[140:143], a[12:15], a[84:87], v[140:143]
    s_add_u32 s28, s28, s31
    v_mfma_f32_16x16x32_bf16 v[200:203], a[16:19], a[84:87], v[200:203]
    buffer_load_dwordx4 v17, s[40:43], s50 offen offset:1024 lds
    v_mfma_f32_16x16x32_bf16 v[204:207], a[20:23], a[84:87], v[204:207]
    s_add_u32 s50, s50, 128
    v_mfma_f32_16x16x32_bf16 a[104:107], a[24:27], a[84:87], a[104:107]
    s_cmp_ge_u32 s64, 98304
    s_cselect_b32 s63, 4294901760, s59
    s_cselect_b32 s64, 0, s64
    v_mfma_f32_16x16x32_bf16 a[108:111], a[28:31], a[84:87], a[108:111]
    ds_read_b64_tr_b16 a[84:85], v13 offset:16384
    v_mfma_f32_16x16x32_bf16 v[80:83], a[0:3], a[88:91], v[80:83]
    ds_read_b64_tr_b16 a[86:87], v13 offset:18432
    v_mfma_f32_16x16x32_bf16 v[84:87], a[4:7], a[88:91], v[84:87]
    v_mfma_f32_16x16x32_bf16 v[144:147], a[8:11], a[88:91], v[144:147]
    buffer_store_dwordx4 a[228:231], v2, s[24:27], s28 offen sc1
    v_mfma_f32_16x16x32_bf16 v[148:151], a[12:15], a[88:91], v[148:151]
    s_add_u32 s28, s28, s31
    v_mfma_f32_16x16x32_bf16 v[208:211], a[16:19], a[88:91], v[208:211]
    buffer_load_dwordx4 v16, s[40:43], s51 offen offset:2048 lds
    v_mfma_f32_16x16x32_bf16 v[212:215], a[20:23], a[88:91], v[212:215]
    v_mfma_f32_16x16x32_bf16 a[112:115], a[24:27], a[88:91], a[112:115]
    v_mfma_f32_16x16x32_bf16 a[116:119], a[28:31], a[88:91], a[116:119]
    ds_read_b64_tr_b16 a[88:89], v14 offset:16384
    s_waitcnt lgkmcnt(15)
    v_mfma_f32_16x16x32_bf16 v[88:91], a[0:3], a[92:95], v[88:91]
    ds_read_b64_tr_b16 a[90:91], v14 offset:18432
    v_mfma_f32_16x16x32_bf16 v[92:95], a[4:7], a[92:95], v[92:95]
    v_add_u32 v6, s63, v6
    v_add_u32 v7, s63, v7
    v_mfma_f32_16x16x32_bf16 v[152:155], a[8:11], a[92:95], v[152:155]
    buffer_store_dwordx4 a[232:235], v2, s[24:27], s28 offen sc1
    v_mfma_f32_16x16x32_bf16 v[156:159], a[12:15], a[92:95], v[156:159]
    s_add_u32 s28, s28, s31
    v_mfma_f32_16x16x32_bf16 v[216:219], a[16:19], a[92:95], v[216:219]
    buffer_load_dwordx4 v17, s[40:43], s51 offen offset:3072 lds
    v_mfma_f32_16x16x32_bf16 v[220:223], a[20:23], a[92:95], v[220:223]
    s_add_u32 s51, s51, 128
    v_mfma_f32_16x16x32_bf16 a[120:123], a[24:27], a[92:95], a[120:123]
    v_mfma_f32_16x16x32_bf16 a[124:127], a[28:31], a[92:95], a[124:127]
    ds_read_b64_tr_b16 a[92:93], v15 offset:16384
    ds_read_b64_tr_b16 a[94:95], v15 offset:18432
    v_mfma_f32_16x16x32_bf16 v[32:35], a[32:35], a[64:67], v[32:35]
    v_xor_b32 v8, s60, v8
    v_xor_b32 v9, s60, v9
    v_mfma_f32_16x16x32_bf16 v[36:39], a[36:39], a[64:67], v[36:39]
    v_xor_b32 v10, s60, v10
    v_xor_b32 v11, s60, v11
    s_waitcnt lgkmcnt(15)
    v_mfma_f32_16x16x32_bf16 v[96:99], a[40:43], a[64:67], v[96:99]
    v_xor_b32 v12, s60, v12
    v_xor_b32 v13, s60, v13
    v_mfma_f32_16x16x32_bf16 v[100:103], a[44:47], a[64:67], v[100:103]
    v_xor_b32 v14, s60, v14
    v_xor_b32 v15, s60, v15
    s_waitcnt lgkmcnt(13)
    v_mfma_f32_16x16x32_bf16 v[160:163], a[48:51], a[64:67], v[160:163]
    s_waitcnt lgkmcnt(12)
    v_mfma_f32_16x16x32_bf16 v[164:167], a[52:55], a[64:67], v[164:167]
    s_waitcnt lgkmcnt(9)
    v_mfma_f32_16x16x32_bf16 v[224:227], a[56:59], a[64:67], v[224:227]
    s_waitcnt vmcnt(16) lgkmcnt(0)
    v_mfma_f32_16x16x32_bf16 v[228:231], a[60:63], a[64:67], v[228:231]
    s_barrier
    ds_read_b64_tr_b16 a[64:65], v8 offset:0
    v_mfma_f32_16x16x32_bf16 v[40:43], a[32:35], a[68:71], v[40:43]
    s_add_u32 m0, s62, 0
    ds_read_b64_tr_b16 a[66:67], v8 offset:2048
    v_mfma_f32_16x16x32_bf16 v[44:47], a[36:39], a[68:71], v[44:47]
    buffer_load_dwordx4 v18, s[44:47], s52 offen offset:0 lds
    v_mfma_f32_16x16x32_bf16 v[104:107], a[40:43], a[68:71], v[104:107]
    ds_read_b128 a[0:3], v6 offset:0
    v_mfma_f32_16x16x32_bf16 v[108:111], a[44:47], a[68:71], v[108:111]
    v_mfma_f32_16x16x32_bf16 v[168:171], a[48:51], a[68:71], v[168:171]
    v_mfma_f32_16x16x32_bf16 v[172:175], a[52:55], a[68:71], v[172:175]
    buffer_load_dwordx4 v19, s[44:47], s52 offen offset:1024 lds
    v_mfma_f32_16x16x32_bf16 v[232:235], a[56:59], a[68:71], v[232:235]
    s_add_u32 s52, s52, s56
    ds_read_b128 a[4:7], v6 offset:2048
    v_mfma_f32_16x16x32_bf16 v[236:239], a[60:63], a[68:71], v[236:239]
    ds_read_b64_tr_b16 a[68:69], v9 offset:0
    v_mfma_f32_16x16x32_bf16 v[48:51], a[32:35], a[72:75], v[48:51]
    ds_read_b64_tr_b16 a[70:71], v9 offset:2048
    v_mfma_f32_16x16x32_bf16 v[52:55], a[36:39], a[72:75], v[52:55]
    buffer_load_dwordx4 v18, s[44:47], s53 offen offset:2048 lds
    v_mfma_f32_16x16x32_bf16 v[112:115], a[40:43], a[72:75], v[112:115]
    ds_read_b128 a[8:11], v6 offset:4096
    v_mfma_f32_16x16x32_bf16 v[116:119], a[44:47], a[72:75], v[116:119]
    v_mfma_f32_16x16x32_bf16 v[176:179], a[48:51], a[72:75], v[176:179]
    v_mfma_f32_16x16x32_bf16 v[180:183], a[52:55], a[72:75], v[180:183]
    buffer_load_dwordx4 v19, s[44:47], s53 offen offset:3072 lds
    v_mfma_f32_16x16x32_bf16 v[240:243], a[56:59], a[72:75], v[240:243]
    s_add_u32 s53, s53, s56
    ds_read_b128 a[12:15], v6 offset:6144
    v_mfma_f32_16x16x32_bf16 v[244:247], a[60:63], a[72:75], v[244:247]
    ds_read_b64_tr_b16 a[72:73], v10 offset:0
    v_mfma_f32_16x16x32_bf16 v[56:59], a[32:35], a[76:79], v[56:59]
    s_add_u32 m0, s62, 4096
    ds_read_b64_tr_b16 a[74:75], v10 offset:2048
    v_mfma_f32_16x16x32_bf16 v[60:63], a[36:39], a[76:79], v[60:63]
    buffer_load_dwordx4 v20, s[44:47], s54 offen offset:0 lds
    v_mfma_f32_16x16x32_bf16 v[120:123], a[40:43], a[76:79], v[120:123]
    ds_read_b128 a[16:19], v6 offset:8192
    v_mfma_f32_16x16x32_bf16 v[124:127], a[44:47], a[76:79], v[124:127]
    s_xor_b32 s62, s62, 229376
    v_mfma_f32_16x16x32_bf16 v[184:187], a[48:51], a[76:79], v[184:187]
    v_mfma_f32_16x16x32_bf16 v[188:191], a[52:55], a[76:79], v[188:191]
    buffer_load_dwordx4 v21, s[44:47], s54 offen offset:1024 lds
    v_mfma_f32_16x16x32_bf16 v[248:251], a[56:59], a[76:79], v[248:251]
    s_add_u32 s54, s54, s56
    ds_read_b128 a[20:23], v6 offset:10240
    v_mfma_f32_16x16x32_bf16 v[252:255], a[60:63], a[76:79], v[252:255]
    ds_read_b64_tr_b16 a[76:77], v11 offset:0
    v_mfma_f32_16x16x32_bf16 v[64:67], a[32:35], a[80:83], v[64:67]
    ds_read_b64_tr_b16 a[78:79], v11 offset:2048
    v_mfma_f32_16x16x32_bf16 v[68:71], a[36:39], a[80:83], v[68:71]
    buffer_load_dwordx4 v20, s[44:47], s55 offen offset:2048 lds
    v_mfma_f32_16x16x32_bf16 v[128:131], a[40:43], a[80:83], v[128:131]
    ds_read_b128 a[24:27], v6 offset:12288
    v_mfma_f32_16x16x32_bf16 v[132:135], a[44:47], a[80:83], v[132:135]
    v_mfma_f32_16x16x32_bf16 v[192:195], a[48:51], a[80:83], v[192:195]
    v_mfma_f32_16x16x32_bf16 v[196:199], a[52:55], a[80:83], v[196:199]
    buffer_load_dwordx4 v21, s[44:47], s55 offen offset:3072 lds
    v_mfma_f32_16x16x32_bf16 a[96:99], a[56:59], a[80:83], a[96:99]
    s_add_u32 s55, s55, s56
    ds_read_b128 a[28:31], v6 offset:14336
    v_mfma_f32_16x16x32_bf16 a[100:103], a[60:63], a[80:83], a[100:103]
    ds_read_b64_tr_b16 a[80:81], v12 offset:0
    v_mfma_f32_16x16x32_bf16 v[72:75], a[32:35], a[84:87], v[72:75]
    ds_read_b64_tr_b16 a[82:83], v12 offset:2048
    v_mfma_f32_16x16x32_bf16 v[76:79], a[36:39], a[84:87], v[76:79]
    v_mfma_f32_16x16x32_bf16 v[136:139], a[40:43], a[84:87], v[136:139]
    buffer_store_dwordx4 a[236:239], v2, s[24:27], s28 offen sc1
    v_mfma_f32_16x16x32_bf16 v[140:143], a[44:47], a[84:87], v[140:143]
    s_add_u32 s28, s28, s31
    v_mfma_f32_16x16x32_bf16 v[200:203], a[48:51], a[84:87], v[200:203]
    v_mfma_f32_16x16x32_bf16 v[204:207], a[52:55], a[84:87], v[204:207]
    v_mfma_f32_16x16x32_bf16 a[104:107], a[56:59], a[84:87], a[104:107]
    buffer_store_dwordx4 a[240:243], v2, s[24:27], s28 offen sc1
    v_mfma_f32_16x16x32_bf16 a[108:111], a[60:63], a[84:87], a[108:111]
    s_add_u32 s28, s28, s31
    ds_read_b64_tr_b16 a[84:85], v13 offset:0
    v_mfma_f32_16x16x32_bf16 v[80:83], a[32:35], a[88:91], v[80:83]
    ds_read_b64_tr_b16 a[86:87], v13 offset:2048
    v_mfma_f32_16x16x32_bf16 v[84:87], a[36:39], a[88:91], v[84:87]
    v_mfma_f32_16x16x32_bf16 v[144:147], a[40:43], a[88:91], v[144:147]
    buffer_store_dwordx4 a[244:247], v2, s[24:27], s28 offen sc1
    v_mfma_f32_16x16x32_bf16 v[148:151], a[44:47], a[88:91], v[148:151]
    s_add_u32 s28, s28, s31
    v_mfma_f32_16x16x32_bf16 v[208:211], a[48:51], a[88:91], v[208:211]
    v_mfma_f32_16x16x32_bf16 v[212:215], a[52:55], a[88:91], v[212:215]
    v_mfma_f32_16x16x32_bf16 a[112:115], a[56:59], a[88:91], a[112:115]
    buffer_store_dwordx4 a[248:251], v2, s[24:27], s28 offen sc1
    v_mfma_f32_16x16x32_bf16 a[116:119], a[60:63], a[88:91], a[116:119]
    s_add_u32 s28, s28, s31
    ds_read_b64_tr_b16 a[88:89], v14 offset:0
    v_mfma_f32_16x16x32_bf16 v[88:91], a[32:35], a[92:95], v[88:91]
    ds_read_b64_tr_b16 a[90:91], v14 offset:2048
    v_mfma_f32_16x16x32_bf16 v[92:95], a[36:39], a[92:95], v[92:95]
    v_mfma_f32_16x16x32_bf16 v[152:155], a[40:43], a[92:95], v[152:155]
    buffer_store_dwordx4 a[252:255], v2, s[24:27], s28 offen sc1
    v_mfma_f32_16x16x32_bf16 v[156:159], a[44:47], a[92:95], v[156:159]
    s_add_u32 s29, s29, s30
    s_mov_b32 s28, s29
    v_mfma_f32_16x16x32_bf16 v[216:219], a[48:51], a[92:95], v[216:219]
    s_sub_u32 s65, s65, 1
    v_mfma_f32_16x16x32_bf16 v[220:223], a[52:55], a[92:95], v[220:223]
    v_mfma_f32_16x16x32_bf16 a[120:123], a[56:59], a[92:95], a[120:123]
    v_mfma_f32_16x16x32_bf16 a[124:127], a[60:63], a[92:95], a[124:127]
    ds_read_b64_tr_b16 a[92:93], v15 offset:0
    ds_read_b64_tr_b16 a[94:95], v15 offset:2048
m_loop20:
    s_waitcnt lgkmcnt(15)
    v_mfma_f32_16x16x32_bf16 v[32:35], a[0:3], a[64:67], v[32:35]
    v_mfma_f32_16x16x32_bf16 v[36:39], a[4:7], a[64:67], v[36:39]
    v_mfma_f32_16x16x32_bf16 v[96:99], a[8:11], a[64:67], v[96:99]
    v_mfma_f32_16x16x32_bf16 v[100:103], a[12:15], a[64:67], v[100:103]
    s_add_u32 m0, s61, 0
    s_waitcnt lgkmcnt(13)
    v_mfma_f32_16x16x32_bf16 v[160:163], a[16:19], a[64:67], v[160:163]
    buffer_load_dwordx4 v16, s[40:43], s48 offen offset:0 lds
    s_waitcnt lgkmcnt(12)
    v_mfma_f32_16x16x32_bf16 v[164:167], a[20:23], a[64:67], v[164:167]
    s_waitcnt lgkmcnt(9)
    v_mfma_f32_16x16x32_bf16 v[224:227], a[24:27], a[64:67], v[224:227]
    s_waitcnt lgkmcnt(8)
    v_mfma_f32_16x16x32_bf16 v[228:231], a[28:31], a[64:67], v[228:231]
    ds_read_b64_tr_b16 a[64:65], v8 offset:16384
    v_mfma_f32_16x16x32_bf16 v[40:43], a[0:3], a[68:71], v[40:43]
    ds_read_b64_tr_b16 a[66:67], v8 offset:18432
    v_mfma_f32_16x16x32_bf16 v[44:47], a[4:7], a[68:71], v[44:47]
    v_mfma_f32_16x16x32_bf16 v[104:107], a[8:11], a[68:71], v[104:107]
    ds_read_b128 a[32:35], v7 offset:0
    v_mfma_f32_16x16x32_bf16 v[108:111], a[12:15], a[68:71], v[108:111]
    v_mfma_f32_16x16x32_bf16 v[168:171], a[16:19], a[68:71], v[168:171]
    buffer_load_dwordx4 v17, s[40:43], s48 offen offset:1024 lds
    v_mfma_f32_16x16x32_bf16 v[172:175], a[20:23], a[68:71], v[172:175]
    s_add_u32 s48, s48, 128
    v_mfma_f32_16x16x32_bf16 v[232:235], a[24:27], a[68:71], v[232:235]
    ds_read_b128 a[36:39], v7 offset:2048
    v_mfma_f32_16x16x32_bf16 v[236:239], a[28:31], a[68:71], v[236:239]
    ds_read_b64_tr_b16 a[68:69], v9 offset:16384
    v_mfma_f32_16x16x32_bf16 v[48:51], a[0:3], a[72:75], v[48:51]
    ds_read_b64_tr_b16 a[70:71], v9 offset:18432
    v_mfma_f32_16x16x32_bf16 v[52:55], a[4:7], a[72:75], v[52:55]
    v_mfma_f32_16x16x32_bf16 v[112:115], a[8:11], a[72:75], v[112:115]
    ds_read_b128 a[40:43], v7 offset:4096
    v_mfma_f32_16x16x32_bf16 v[116:119], a[12:15], a[72:75], v[116:119]
    v_mfma_f32_16x16x32_bf16 v[176:179], a[16:19], a[72:75], v[176:179]
    buffer_load_dwordx4 v16, s[40:43], s49 offen offset:2048 lds
    v_mfma_f32_16x16x32_bf16 v[180:183], a[20:23], a[72:75], v[180:183]
    v_mfma_f32_16x16x32_bf16 v[240:243], a[24:27], a[72:75], v[240:243]
    ds_read_b128 a[44:47], v7 offset:6144
    v_mfma_f32_16x16x32_bf16 v[244:247], a[28:31], a[72:75], v[244:247]
    ds_read_b64_tr_b16 a[72:73], v10 offset:16384
    v_mfma_f32_16x16x32_bf16 v[56:59], a[0:3], a[76:79], v[56:59]
    ds_read_b64_tr_b16 a[74:75], v10 offset:18432
    v_mfma_f32_16x16x32_bf16 v[60:63], a[4:7], a[76:79], v[60:63]
    v_mfma_f32_16x16x32_bf16 v[120:123], a[8:11], a[76:79], v[120:123]
    ds_read_b128 a[48:51], v7 offset:8192
    v_mfma_f32_16x16x32_bf16 v[124:127], a[12:15], a[76:79], v[124:127]
    v_mfma_f32_16x16x32_bf16 v[184:187], a[16:19], a[76:79], v[184:187]
    buffer_load_dwordx4 v17, s[40:43], s49 offen offset:3072 lds
    v_mfma_f32_16x16x32_bf16 v[188:191], a[20:23], a[76:79], v[188:191]
    s_add_u32 s49, s49, 128
    v_mfma_f32_16x16x32_bf16 v[248:251], a[24:27], a[76:79], v[248:251]
    ds_read_b128 a[52:55], v7 offset:10240
    v_mfma_f32_16x16x32_bf16 v[252:255], a[28:31], a[76:79], v[252:255]
    ds_read_b64_tr_b16 a[76:77], v11 offset:16384
    s_waitcnt lgkmcnt(15)
    v_mfma_f32_16x16x32_bf16 v[64:67], a[0:3], a[80:83], v[64:67]
    ds_read_b64_tr_b16 a[78:79], v11 offset:18432
    v_mfma_f32_16x16x32_bf16 v[68:71], a[4:7], a[80:83], v[68:71]
    v_mfma_f32_16x16x32_bf16 v[128:131], a[8:11], a[80:83], v[128:131]
    ds_read_b128 a[56:59], v7 offset:12288
    v_mfma_f32_16x16x32_bf16 v[132:135], a[12:15], a[80:83], v[132:135]
    s_add_u32 m0, s61, 4096
    v_mfma_f32_16x16x32_bf16 v[192:195], a[16:19], a[80:83], v[192:195]
    buffer_load_dwordx4 v16, s[40:43], s50 offen offset:0 lds
    v_mfma_f32_16x16x32_bf16 v[196:199], a[20:23], a[80:83], v[196:199]
    v_mfma_f32_16x16x32_bf16 a[96:99], a[24:27], a[80:83], a[96:99]
    s_add_u32 s61, s61, 32768
    ds_read_b128 a[60:63], v7 offset:14336
    v_mfma_f32_16x16x32_bf16 a[100:103], a[28:31], a[80:83], a[100:103]
    s_cmp_ge_u32 s61, 98304
    s_cselect_b32 s90, 98304, 0
    ds_read_b64_tr_b16 a[80:81], v12 offset:16384
    v_mfma_f32_16x16x32_bf16 v[72:75], a[0:3], a[84:87], v[72:75]
    s_sub_u32 s61, s61, s90
    ds_read_b64_tr_b16 a[82:83], v12 offset:18432
    v_mfma_f32_16x16x32_bf16 v[76:79], a[4:7], a[84:87], v[76:79]
    s_add_u32 s64, s64, 32768
    v_mfma_f32_16x16x32_bf16 v[136:139], a[8:11], a[84:87], v[136:139]
    s_cmp_ge_u32 s64, 98304
    s_cselect_b32 s63, 4294901760, s59
    s_cselect_b32 s64, 0, s64
    v_mfma_f32_16x16x32_bf16 v[140:143], a[12:15], a[84:87], v[140:143]
    v_mfma_f32_16x16x32_bf16 v[200:203], a[16:19], a[84:87], v[200:203]
    buffer_load_dwordx4 v17, s[40:43], s50 offen offset:1024 lds
    v_mfma_f32_16x16x32_bf16 v[204:207], a[20:23], a[84:87], v[204:207]
    s_add_u32 s50, s50, 128
    v_mfma_f32_16x16x32_bf16 a[104:107], a[24:27], a[84:87], a[104:107]
    v_mfma_f32_16x16x32_bf16 a[108:111], a[28:31], a[84:87], a[108:111]
    ds_read_b64_tr_b16 a[84:85], v13 offset:16384
    v_mfma_f32_16x16x32_bf16 v[80:83], a[0:3], a[88:91], v[80:83]
    ds_read_b64_tr_b16 a[86:87], v13 offset:18432
    v_mfma_f32_16x16x32_bf16 v[84:87], a[4:7], a[88:91], v[84:87]
    v_mfma_f32_16x16x32_bf16 v[144:147], a[8:11], a[88:91], v[144:147]
    v_mfma_f32_16x16x32_bf16 v[148:151], a[12:15], a[88:91], v[148:151]
    v_mfma_f32_16x16x32_bf16 v[208:211], a[16:19], a[88:91], v[208:211]
    buffer_load_dwordx4 v16, s[40:43], s51 offen offset:2048 lds
    v_mfma_f32_16x16x32_bf16 v[212:215], a[20:23], a[88:91], v[212:215]
    v_mfma_f32_16x16x32_bf16 a[112:115], a[24:27], a[88:91], a[112:115]
    v_mfma_f32_16x16x32_bf16 a[116:119], a[28:31], a[88:91], a[116:119]
    ds_read_b64_tr_b16 a[88:89], v14 offset:16384
    s_waitcnt lgkmcnt(15)
    v_mfma_f32_16x16x32_bf16 v[88:91], a[0:3], a[92:95], v[88:91]
    ds_read_b64_tr_b16 a[90:91], v14 offset:18432
    v_mfma_f32_16x16x32_bf16 v[92:95], a[4:7], a[92:95], v[92:95]
    v_add_u32 v6, s63, v6
    v_add_u32 v7, s63, v7
    v_mfma_f32_16x16x32_bf16 v[152:155], a[8:11], a[92:95], v[152:155]
    v_mfma_f32_16x16x32_bf16 v[156:159], a[12:15], a[92:95], v[156:159]
    v_mfma_f32_16x16x32_bf16 v[216:219], a[16:19], a[92:95], v[216:219]
    buffer_load_dwordx4 v17, s[40:43], s51 offen offset:3072 lds
    v_mfma_f32_16x16x32_bf16 v[220:223], a[20:23], a[92:95], v[220:223]
    s_add_u32 s51, s51, 128
    v_mfma_f32_16x16x32_bf16 a[120:123], a[24:27], a[92:95], a[120:123]
    v_mfma_f32_16x16x32_bf16 a[124:127], a[28:31], a[92:95], a[124:127]
    ds_read_b64_tr_b16 a[92:93], v15 offset:16384
    ds_read_b64_tr_b16 a[94:95], v15 offset:18432
    v_mfma_f32_16x16x32_bf16 v[32:35], a[32:35], a[64:67], v[32:35]
    v_xor_b32 v8, s60, v8
    v_xor_b32 v9, s60, v9
    v_mfma_f32_16x16x32_bf16 v[36:39], a[36:39], a[64:67], v[36:39]
    v_xor_b32 v10, s60, v10
    v_xor_b32 v11, s60, v11
    s_waitcnt lgkmcnt(15)
    v_mfma_f32_16x16x32_bf16 v[96:99], a[40:43], a[64:67], v[96:99]
    v_xor_b32 v12, s60, v12
    v_xor_b32 v13, s60, v13
    v_mfma_f32_16x16x32_bf16 v[100:103], a[44:47], a[64:67], v[100:103]
    v_xor_b32 v14, s60, v14
    v_xor_b32 v15, s60, v15
    s_waitcnt lgkmcnt(13)
    v_mfma_f32_16x16x32_bf16 v[160:163], a[48:51], a[64:67], v[160:163]
    s_waitcnt lgkmcnt(12)
    v_mfma_f32_16x16x32_bf16 v[164:167], a[52:55], a[64:67], v[164:167]
    s_waitcnt lgkmcnt(9)
    v_mfma_f32_16x16x32_bf16 v[224:227], a[56:59], a[64:67], v[224:227]
    s_waitcnt vmcnt(8) lgkmcnt(0)
    v_mfma_f32_16x16x32_bf16 v[228:231], a[60:63], a[64:67], v[228:231]
    s_barrier
    ds_read_b64_tr_b16 a[64:65], v8 offset:0
    v_mfma_f32_16x16x32_bf16 v[40:43], a[32:35], a[68:71], v[40:43]
    s_add_u32 m0, s62, 0
    ds_read_b64_tr_b16 a[66:67], v8 offset:2048
    v_mfma_f32_16x16x32_bf16 v[44:47], a[36:39], a[68:71], v[44:47]
    buffer_load_dwordx4 v18, s[44:47], s52 offen offset:0 lds
    v_mfma_f32_16x16x32_bf16 v[104:107], a[40:43], a[68:71], v[104:107]
    ds_read_b128 a[0:3], v6 offset:0
    v_mfma_f32_16x16x32_bf16 v[108:111], a[44:47], a[68:71], v[108:111]
    v_mfma_f32_16x16x32_bf16 v[168:171], a[48:51], a[68:71], v[168:171]
    v_mfma_f32_16x16x32_bf16 v[172:175], a[52:55], a[68:71], v[172:175]
    buffer_load_dwordx4 v19, s[44:47], s52 offen offset:1024 lds
    v_mfma_f32_16x16x32_bf16 v[232:235], a[56:59], a[68:71], v[232:235]
    s_add_u32 s52, s52, s56
    ds_read_b128 a[4:7], v6 offset:2048
    v_mfma_f32_16x16x32_bf16 v[236:239], a[60:63], a[68:71], v[236:239]
    ds_read_b64_tr_b16 a[68:69], v9 offset:0
    v_mfma_f32_16x16x32_bf16 v[48:51], a[32:35], a[72:75], v[48:51]
    ds_read_b64_tr_b16 a[70:71], v9 offset:2048
    v_mfma_f32_16x16x32_bf16 v[52:55], a[36:39], a[72:75], v[52:55]
    buffer_load_dwordx4 v18, s[44:47], s53 offen offset:2048 lds
    v_mfma_f32_16x16x32_bf16 v[112:115], a[40:43], a[72:75], v[112:115]
    ds_read_b128 a[8:11], v6 offset:4096
    v_mfma_f32_16x16x32_bf16 v[116:119], a[44:47], a[72:75], v[116:119]
    v_mfma_f32_16x16x32_bf16 v[176:179], a[48:51], a[72:75], v[176:179]
    v_mfma_f32_16x16x32_bf16 v[180:183], a[52:55], a[72:75], v[180:183]
    buffer_load_dwordx4 v19, s[44:47], s53 offen offset:3072 lds
    v_mfma_f32_16x16x32_bf16 v[240:243], a[56:59], a[72:75], v[240:243]
    s_add_u32 s53, s53, s56
    ds_read_b128 a[12:15], v6 offset:6144
    v_mfma_f32_16x16x32_bf16 v[244:247], a[60:63], a[72:75], v[244:247]
    ds_read_b64_tr_b16 a[72:73], v10 offset:0
    v_mfma_f32_16x16x32_bf16 v[56:59], a[32:35], a[76:79], v[56:59]
    s_add_u32 m0, s62, 4096
    ds_read_b64_tr_b16 a[74:75], v10 offset:2048
    v_mfma_f32_16x16x32_bf16 v[60:63], a[36:39], a[76:79], v[60:63]
    buffer_load_dwordx4 v20, s[44:47], s54 offen offset:0 lds
    v_mfma_f32_16x16x32_bf16 v[120:123], a[40:43], a[76:79], v[120:123]
    ds_read_b128 a[16:19], v6 offset:8192
    v_mfma_f32_16x16x32_bf16 v[124:127], a[44:47], a[76:79], v[124:127]
    s_xor_b32 s62, s62, 229376
    v_mfma_f32_16x16x32_bf16 v[184:187], a[48:51], a[76:79], v[184:187]
    v_mfma_f32_16x16x32_bf16 v[188:191], a[52:55], a[76:79], v[188:191]
    buffer_load_dwordx4 v21, s[44:47], s54 offen offset:1024 lds
    v_mfma_f32_16x16x32_bf16 v[248:251], a[56:59], a[76:79], v[248:251]
    s_add_u32 s54, s54, s56
    ds_read_b128 a[20:23], v6 offset:10240
    v_mfma_f32_16x16x32_bf16 v[252:255], a[60:63], a[76:79], v[252:255]
    ds_read_b64_tr_b16 a[76:77], v11 offset:0
    v_mfma_f32_16x16x32_bf16 v[64:67], a[32:35], a[80:83], v[64:67]
    ds_read_b64_tr_b16 a[78:79], v11 offset:2048
    v_mfma_f32_16x16x32_bf16 v[68:71], a[36:39], a[80:83], v[68:71]
    buffer_load_dwordx4 v20, s[44:47], s55 offen offset:2048 lds
    v_mfma_f32_16x16x32_bf16 v[128:131], a[40:43], a[80:83], v[128:131]
    ds_read_b128 a[24:27], v6 offset:12288
    v_mfma_f32_16x16x32_bf16 v[132:135], a[44:47], a[80:83], v[132:135]
    v_mfma_f32_16x16x32_bf16 v[192:195], a[48:51], a[80:83], v[192:195]
    v_mfma_f32_16x16x32_bf16 v[196:199], a[52:55], a[80:83], v[196:199]
    buffer_load_dwordx4 v21, s[44:47], s55 offen offset:3072 lds
    v_mfma_f32_16x16x32_bf16 a[96:99], a[56:59], a[80:83], a[96:99]
    s_add_u32 s55, s55, s56
    ds_read_b128 a[28:31], v6 offset:14336
    v_mfma_f32_16x16x32_bf16 a[100:103], a[60:63], a[80:83], a[100:103]
    ds_read_b64_tr_b16 a[80:81], v12 offset:0
    v_mfma_f32_16x16x32_bf16 v[72:75], a[32:35], a[84:87], v[72:75]
    ds_read_b64_tr_b16 a[82:83], v12 offset:2048
    v_mfma_f32_16x16x32_bf16 v[76:79], a[36:39], a[84:87], v[76:79]
    v_mfma_f32_16x16x32_bf16 v[136:139], a[40:43], a[84:87], v[136:139]
    v_mfma_f32_16x16x32_bf16 v[140:143], a[44:47], a[84:87], v[140:143]
    v_mfma_f32_16x16x32_bf16 v[200:203], a[48:51], a[84:87], v[200:203]
    v_mfma_f32_16x16x32_bf16 v[204:207], a[52:55], a[84:87], v[204:207]
    v_mfma_f32_16x16x32_bf16 a[104:107], a[56:59], a[84:87], a[104:107]
    v_mfma_f32_16x16x32_bf16 a[108:111], a[60:63], a[84:87], a[108:111]
    ds_read_b64_tr_b16 a[84:85], v13 offset:0
    v_mfma_f32_16x16x32_bf16 v[80:83], a[32:35], a[88:91], v[80:83]
    ds_read_b64_tr_b16 a[86:87], v13 offset:2048
    v_mfma_f32_16x16x32_bf16 v[84:87], a[36:39], a[88:91], v[84:87]
    v_mfma_f32_16x16x32_bf16 v[144:147], a[40:43], a[88:91], v[144:147]
    v_mfma_f32_16x16x32_bf16 v[148:151], a[44:47], a[88:91], v[148:151]
    v_mfma_f32_16x16x32_bf16 v[208:211], a[48:51], a[88:91], v[208:211]
    v_mfma_f32_16x16x32_bf16 v[212:215], a[52:55], a[88:91], v[212:215]
    v_mfma_f32_16x16x32_bf16 a[112:115], a[56:59], a[88:91], a[112:115]
    v_mfma_f32_16x16x32_bf16 a[116:119], a[60:63], a[88:91], a[116:119]
    ds_read_b64_tr_b16 a[88:89], v14 offset:0
    v_mfma_f32_16x16x32_bf16 v[88:91], a[32:35], a[92:95], v[88:91]
    ds_read_b64_tr_b16 a[90:91], v14 offset:2048
    v_mfma_f32_16x16x32_bf16 v[92:95], a[36:39], a[92:95], v[92:95]
    v_mfma_f32_16x16x32_bf16 v[152:155], a[40:43], a[92:95], v[152:155]
    v_mfma_f32_16x16x32_bf16 v[156:159], a[44:47], a[92:95], v[156:159]
    v_mfma_f32_16x16x32_bf16 v[216:219], a[48:51], a[92:95], v[216:219]
    s_sub_u32 s65, s65, 1
    v_mfma_f32_16x16x32_bf16 v[220:223], a[52:55], a[92:95], v[220:223]
    v_mfma_f32_16x16x32_bf16 a[120:123], a[56:59], a[92:95], a[120:123]
    s_cmp_gt_u32 s65, s67
    v_mfma_f32_16x16x32_bf16 a[124:127], a[60:63], a[92:95], a[124:127]
    ds_read_b64_tr_b16 a[92:93], v15 offset:0
    ds_read_b64_tr_b16 a[94:95], v15 offset:2048
    s_cbranch_scc1 m_loop20
    s_cmp_lg_u32 s65, 0
    s_cbranch_scc1 m_dosw21
m_epi12:
    s_cmp_eq_u32 s94, 0
    s_cbranch_scc1 m_last24
    s_mov_b32 s3, 1048576
m_spin28:
    v_readfirstlane_b32 s4, v4
    v_readfirstlane_b32 s5, v5
    s_nop 3
    s_cmp_lg_u32 s4, 0
    s_cbranch_scc1 m_ok29
    s_sub_u32 s3, s3, 1
    s_cbranch_scc1 m_ok29
    s_sleep 32
    buffer_load_dwordx2 v[4:5], off, s[12:15], 0 sc1
    s_waitcnt vmcnt(0)
    s_branch m_spin28
m_ok29:
    s_cmp_ge_u32 s68, 16
    s_cbranch_scc1 m_q031
    s_call_b64 s[20:21], m_epf22
    s_mov_b32 s17, s101
    s_mov_b32 s66, 2
    s_branch m_q130
m_q031:
    s_call_b64 s[20:21], m_eps23
    s_mov_b32 s17, s101
    s_mov_b32 s28, s98
    s_mov_b32 s29, s98
    s_mov_b32 s30, s99
    s_mov_b32 s31, s100
    s_mov_b32 s26, 268435456
m_q130:
    s_mov_b32 s95, s82
    s_mov_b32 s96, s83
    s_mov_b32 s97, s84
    s_mov_b32 s98, s85
    s_mov_b32 s99, s86
    s_mov_b32 s100, s87
    s_mov_b32 s101, s88
    s_sub_u32 s67, s95, 5
    s_mov_b32 s94, 0
    s_branch m_tile11
m_last24:
    s_cmp_eq_u32 s70, 0
    s_cbranch_scc1 m_kvl27
    buffer_load_dwordx2 v[4:5], off, s[12:15], 0 sc1
    s_call_b64 s[20:21], m_epf22
    s_waitcnt vmcnt(0)
    s_barrier
    s_mov_b32 s3, 1048576
m_spin32:
    v_readfirstlane_b32 s4, v4
    v_readfirstlane_b32 s5, v5
    s_nop 3
    s_cmp_lg_u32 s4, 0
    s_cbranch_scc1 m_ok33
    s_sub_u32 s3, s3, 1
    s_cbranch_scc1 m_ok33
    s_sleep 32
    buffer_load_dwordx2 v[4:5], off, s[12:15], 0 sc1
    s_waitcnt vmcnt(0)
    s_branch m_spin32
m_ok33:
    s_cmp_lg_u32 s16, 0
    s_cbranch_scc1 m_np34
    v_mov_b32 v4, s4
    v_mov_b32 v5, s5
    s_add_u32 s90, s101, 117440512
    s_mov_b64 exec, 1
    buffer_store_dwordx2 v[4:5], off, s[8:11], s90 sc1
    s_mov_b64 exec, -1
m_np34:
    s_cmp_lg_u32 s16, 0
    s_cbranch_scc1 m_pw35
    s_and_b32 s92, s2, 7
    s_lshl_b32 s92, s92, 2
    s_bfe_u32 s93, s2, 0x20003
    s_add_u32 s92, s92, s93
    s_lshr_b32 s93, s2, 5
    s_lshl_b32 s93, s93, 2
    s_or_b32 s93, s93, 0x40000
    s_lshr_b32 s90, s92, 1
    s_lshl_b32 s90, s90, 7
    s_add_u32 s90, s90, 117440512
    s_bfe_u32 s91, 873473623, s93
    s_lshr_b32 s91, s91, 1
    v_mov_b32 v0, s91
    v_add_u32 v4, 8, v1
    v_cmp_gt_u32 vcc, 8, v1
    s_nop 1
    v_cndmask_b32 v0, v0, v4, vcc
    s_bfe_u32 s91, 4225681832, s93
    s_lshr_b32 s91, s91, 1
    v_writelane_b32 v0, s91, 8
    v_lshlrev_b32 v0, 3, v0
    buffer_load_dwordx2 v[4:5], v0, s[8:11], s90 offen sc1
    s_waitcnt vmcnt(0)
    s_mov_b32 s3, 1048576
m_spin36:
    v_cmp_ne_u64 s[22:23], s[4:5], v[4:5]
    s_nop 3
    s_cmp_eq_u64 s[22:23], 0
    s_cbranch_scc1 m_ok37
    s_sub_u32 s3, s3, 1
    s_cbranch_scc1 m_ok37
    s_sleep 16
    s_and_b32 s92, s2, 7
    s_lshl_b32 s92, s92, 2
    s_bfe_u32 s93, s2, 0x20003
    s_add_u32 s92, s92, s93
    s_lshr_b32 s93, s2, 5
    s_lshl_b32 s93, s93, 2
    s_or_b32 s93, s93, 0x40000
    s_lshr_b32 s90, s92, 1
    s_lshl_b32 s90, s90, 7
    s_add_u32 s90, s90, 117440512
    s_bfe_u32 s91, 873473623, s93
    s_lshr_b32 s91, s91, 1
    v_mov_b32 v0, s91
    v_add_u32 v4, 8, v1
    v_cmp_gt_u32 vcc, 8, v1
    s_nop 1
    v_cndmask_b32 v0, v0, v4, vcc
    s_bfe_u32 s91, 4225681832, s93
    s_lshr_b32 s91, s91, 1
    v_writelane_b32 v0, s91, 8
    v_lshlrev_b32 v0, 3, v0
    buffer_load_dwordx2 v[4:5], v0, s[8:11], s90 offen sc1
    s_waitcnt vmcnt(0)
    s_branch m_spin36
m_ok37:
m_pw35:
    s_barrier
    s_and_b32 s92, s2, 7
    s_lshl_b32 s92, s92, 2
    s_bfe_u32 s93, s2, 0x20003
    s_add_u32 s92, s92, s93
    s_lshr_b32 s93, s2, 5
    s_lshl_b32 s93, s93, 2
    s_or_b32 s93, s93, 0x40000
    s_bfe_u32 s90, 4225681832, s93
    s_lshl_b32 s90, s90, 3
    s_lshl_b32 s91, s16, 1
    s_add_u32 s90, s90, s91
    s_lshl_b32 s90, s90, 12
    s_lshl_b32 s91, s92, 19
    s_add_u32 s90, s90, s91
    s_add_u32 s90, s90, 0
    buffer_load_dwordx4 a[128:131], v2, s[8:11], s90 offen offset:0 sc1
    buffer_load_dwordx4 a[132:135], v2, s[8:11], s90 offen offset:1024 sc1
    buffer_load_dwordx4 a[136:139], v2, s[8:11], s90 offen offset:2048 sc1
    buffer_load_dwordx4 a[140:143], v2, s[8:11], s90 offen offset:3072 sc1
    s_bfe_u32 s90, 4225681832, s93
    s_lshl_b32 s90, s90, 3
    s_lshl_b32 s91, s16, 1
    s_add_u32 s90, s90, s91
    s_lshl_b32 s90, s90, 12
    s_lshl_b32 s91, s92, 19
    s_add_u32 s90, s90, s91
    s_add_u32 s90, s90, 4096
    buffer_load_dwordx4 a[144:147], v2, s[8:11], s90 offen offset:0 sc1
    buffer_load_dwordx4 a[148:151], v2, s[8:11], s90 offen offset:1024 sc1
    buffer_load_dwordx4 a[152:155], v2, s[8:11], s90 offen offset:2048 sc1
    buffer_load_dwordx4 a[156:159], v2, s[8:11], s90 offen offset:3072 sc1
    s_bfe_u32 s90, 873473623, s93
    s_lshl_b32 s90, s90, 3
    s_lshl_b32 s91, s16, 1
    s_add_u32 s90, s90, s91
    s_lshl_b32 s90, s90, 12
    s_lshl_b32 s91, s92, 19
    s_add_u32 s90, s90, s91
    s_add_u32 s90, s90, 0
    buffer_load_dwordx4 a[160:163], v2, s[8:11], s90 offen offset:0 sc1
    buffer_load_dwordx4 a[164:167], v2, s[8:11], s90 offen offset:1024 sc1
    buffer_load_dwordx4 a[168:171], v2, s[8:11], s90 offen offset:2048 sc1
    buffer_load_dwordx4 a[172:175], v2, s[8:11], s90 offen offset:3072 sc1
    s_bfe_u32 s90, 873473623, s93
    s_lshl_b32 s90, s90, 3
    s_lshl_b32 s91, s16, 1
    s_add_u32 s90, s90, s91
    s_lshl_b32 s90, s90, 12
    s_lshl_b32 s91, s92, 19
    s_add_u32 s90, s90, s91
    s_add_u32 s90, s90, 4096
    buffer_load_dwordx4 a[176:179], v2, s[8:11], s90 offen offset:0 sc1
    buffer_load_dwordx4 a[180:183], v2, s[8:11], s90 offen offset:1024 sc1
    buffer_load_dwordx4 a[184:187], v2, s[8:11], s90 offen offset:2048 sc1
    buffer_load_dwordx4 a[188:191], v2, s[8:11], s90 offen offset:3072 sc1
    s_mov_b32 s94, 1
m_kvl27:
    s_waitcnt lgkmcnt(0)
    s_barrier
    s_and_b32 s92, s2, 7
    s_lshl_b32 s92, s92, 2
    s_bfe_u32 s93, s2, 0x20003
    s_add_u32 s92, s92, s93
    s_lshr_b32 s93, s2, 5
    s_lshl_b32 s93, s93, 2
    s_or_b32 s93, s93, 0x40000
    s_mov_b32 s32, s92
    s_bfe_u32 s33, 4225681832, s93
    s_add_u32 s33, s33, 1
    s_bfe_u32 s34, 873473623, s93
    s_add_u32 s34, s34, 1
    s_lshl_b32 s60, s16, 12
    v_add_u32 v7, s60, v2
    s_lshl_b32 s90, s34, 2
    s_lshl_b32 s91, s33, 2
    s_lshl_b32 s26, s91, 13
    s_mov_b32 s30, s26
    s_sub_u32 s67, s90, 4
    s_add_u32 s67, s67, s16
    s_add_u32 s68, s67, 1
    s_mov_b32 s69, s90
    s_sub_u32 s70, s91, 4
    s_add_u32 s70, s70, s16
    s_add_u32 s71, s70, 1
    s_mov_b32 s72, s91
    s_mov_b32 s27, 0x20000
    s_mov_b32 s31, 0x20000
    s_lshl_b32 s82, s32, 19
    s_add_u32 s90, s82, 16777216
    s_add_u32 s24, s6, s90
    s_addc_u32 s25, s7, 0
    s_add_u32 s90, s82, 33554432
    s_add_u32 s28, s6, s90
    s_addc_u32 s29, s7, 0
    s_cmp_eq_u32 s94, 1
    s_cbranch_scc1 m_w064
    s_mov_b32 s56, 32768
    s_mov_b32 s57, 16384
    s_add_u32 s59, s60, 65536
    s_mov_b32 m0, s59
    s_nop 0
    buffer_load_dwordx4 v7, s[24:27], s56 offen offset:0 sc1 lds
    buffer_load_dwordx4 v7, s[24:27], s56 offen offset:1024 sc1 lds
    buffer_load_dwordx4 v7, s[24:27], s56 offen offset:2048 sc1 lds
    buffer_load_dwordx4 v7, s[24:27], s56 offen offset:3072 sc1 lds
    s_add_u32 s56, s56, 16384
    s_add_u32 m0, s59, 16384
    s_nop 0
    buffer_load_dwordx4 v7, s[28:31], s57 offen offset:0 sc1 lds
    buffer_load_dwordx4 v7, s[28:31], s57 offen offset:1024 sc1 lds
    buffer_load_dwordx4 v7, s[28:31], s57 offen offset:2048 sc1 lds
    buffer_load_dwordx4 v7, s[28:31], s57 offen offset:3072 sc1 lds
    s_add_u32 s57, s57, 16384
    s_call_b64 s[20:21], m_epl62
    s_mov_b32 s17, s101
    s_mov_b32 s38, 268435456
    s_branch m_init26
m_w064:
    s_mov_b32 s56, 0
    s_mov_b32 s57, 0
    s_mov_b32 m0, s60
    s_nop 0
    buffer_load_dwordx4 v7, s[24:27], s56 offen offset:0 sc1 lds
    buffer_load_dwordx4 v7, s[24:27], s56 offen offset:1024 sc1 lds
    buffer_load_dwordx4 v7, s[24:27], s56 offen offset:2048 sc1 lds
    buffer_load_dwordx4 v7, s[24:27], s56 offen offset:3072 sc1 lds
    s_mov_b32 s56, 16384
    s_add_u32 s59, s60, 32768
    s_mov_b32 m0, s59
    s_nop 0
    buffer_load_dwordx4 v7, s[24:27], s56 offen offset:0 sc1 lds
    buffer_load_dwordx4 v7, s[24:27], s56 offen offset:1024 sc1 lds
    buffer_load_dwordx4 v7, s[24:27], s56 offen offset:2048 sc1 lds
    buffer_load_dwordx4 v7, s[24:27], s56 offen offset:3072 sc1 lds
    s_add_u32 s56, s56, 16384
    s_add_u32 m0, s59, 16384
    s_nop 0
    buffer_load_dwordx4 v7, s[28:31], s57 offen offset:0 sc1 lds
    buffer_load_dwordx4 v7, s[28:31], s57 offen offset:1024 sc1 lds
    buffer_load_dwordx4 v7, s[28:31], s57 offen offset:2048 sc1 lds
    buffer_load_dwordx4 v7, s[28:31], s57 offen offset:3072 sc1 lds
    s_add_u32 s57, s57, 16384
    s_add_u32 s59, s59, 32768
    s_mov_b32 m0, s59
    s_nop 0
    buffer_load_dwordx4 v7, s[24:27], s56 offen offset:0 sc1 lds
    buffer_load_dwordx4 v7, s[24:27], s56 offen offset:1024 sc1 lds
    buffer_load_dwordx4 v7, s[24:27], s56 offen offset:2048 sc1 lds
    buffer_load_dwordx4 v7, s[24:27], s56 offen offset:3072 sc1 lds
    s_add_u32 s56, s56, 16384
    s_add_u32 m0, s59, 16384
    s_nop 0
    buffer_load_dwordx4 v7, s[28:31], s57 offen offset:0 sc1 lds
    buffer_load_dwordx4 v7, s[28:31], s57 offen offset:1024 sc1 lds
    buffer_load_dwordx4 v7, s[28:31], s57 offen offset:2048 sc1 lds
    buffer_load_dwordx4 v7, s[28:31], s57 offen offset:3072 sc1 lds
    s_add_u32 s57, s57, 16384
    s_add_u32 s59, s59, 32768
    s_mov_b32 m0, s59
    s_nop 0
    buffer_load_dwordx4 v7, s[24:27], s56 offen offset:0 sc1 lds
    buffer_load_dwordx4 v7, s[24:27], s56 offen offset:1024 sc1 lds
    buffer_load_dwordx4 v7, s[24:27], s56 offen offset:2048 sc1 lds
    buffer_load_dwordx4 v7, s[24:27], s56 offen offset:3072 sc1 lds
    s_add_u32 s56, s56, 16384
    s_add_u32 m0, s59, 16384
    s_nop 0
    buffer_load_dwordx4 v7, s[28:31], s57 offen offset:0 sc1 lds
    buffer_load_dwordx4 v7, s[28:31], s57 offen offset:1024 sc1 lds
    buffer_load_dwordx4 v7, s[28:31], s57 offen offset:2048 sc1 lds
    buffer_load_dwordx4 v7, s[28:31], s57 offen offset:3072 sc1 lds
    s_add_u32 s57, s57, 16384
    s_add_u32 s59, s59, 32768
    s_waitcnt vmcnt(0)
    s_mov_b32 s38, 0
m_init26:
    s_mov_b32 s56, 65536
    s_mov_b32 s57, 49152
    s_nop 1
    v_mov_b32 v9, 0xff800000
    s_mov_b32 s65, 1233125376
    s_lshl_b32 s91, s16, 1
    s_sub_u32 s91, s91, 8
    s_lshl_b32 s78, s33, 3
    s_add_u32 s78, s78, s91
    s_lshl_b32 s79, s34, 3
    s_add_u32 s79, s79, s91
    s_mov_b32 s36, s6
    s_mov_b32 s37, s7
    s_mov_b32 s39, 0x20000
    s_load_dwordx2 s[48:49], s[0:1], 64
    s_load_dwordx2 s[50:51], s[0:1], 16
    s_load_dwordx2 s[54:55], s[0:1], 72
    s_mov_b32 s47, 0x20000
    s_lshl_b32 s90, s99, 1
    s_add_u32 s98, s98, s90
    s_lshl_b32 s90, s100, 2
    s_add_u32 s40, s98, s90
    s_lshr_b32 s90, s32, 1
    s_lshl_b32 s90, s90, 7
    s_add_u32 s90, s90, 117444608
    s_lshr_b32 s91, s2, 6
    s_lshl_b32 s91, s91, 8
    s_add_u32 s91, s91, 117446592
    v_min_u32 v10, 31, v1
    v_lshlrev_b32 v10, 3, v10
    v_mov_b32 v11, s90
    v_mov_b32 v8, s91
    v_cmp_gt_u32 vcc, 8, v1
    s_nop 1
    v_cndmask_b32 v11, v8, v11, vcc
    v_add_u32 v10, v10, v11
    s_mov_b32 s58, 0
    v_mov_b32 v6, v2
    v_accvgpr_write_b32 a0, 0
    v_accvgpr_write_b32 a1, 0
    v_accvgpr_write_b32 a2, 0
    v_accvgpr_write_b32 a3, 0
    v_accvgpr_write_b32 a4, 0
    v_accvgpr_write_b32 a5, 0
    v_accvgpr_write_b32 a6, 0
    v_accvgpr_write_b32 a7, 0
    v_accvgpr_write_b32 a8, 0
    v_accvgpr_write_b32 a9, 0
    v_accvgpr_write_b32 a10, 0
    v_accvgpr_write_b32 a11, 0
    v_accvgpr_write_b32 a12, 0
    v_accvgpr_write_b32 a13, 0
    v_accvgpr_write_b32 a14, 0
    v_accvgpr_write_b32 a15, 0
    v_accvgpr_write_b32 a16, 0
    v_accvgpr_write_b32 a17, 0
    v_accvgpr_write_b32 a18, 0
    v_accvgpr_write_b32 a19, 0
    v_accvgpr_write_b32 a20, 0
    v_accvgpr_write_b32 a21, 0
    v_accvgpr_write_b32 a22, 0
    v_accvgpr_write_b32 a23, 0
    v_accvgpr_write_b32 a24, 0
    v_accvgpr_write_b32 a25, 0
    v_accvgpr_write_b32 a26, 0
    v_accvgpr_write_b32 a27, 0
    v_accvgpr_write_b32 a28, 0
    v_accvgpr_write_b32 a29, 0
    v_accvgpr_write_b32 a30, 0
    v_accvgpr_write_b32 a31, 0
    v_accvgpr_write_b32 a32, 0
    v_accvgpr_write_b32 a33, 0
    v_accvgpr_write_b32 a34, 0
    v_accvgpr_write_b32 a35, 0
    v_accvgpr_write_b32 a36, 0
    v_accvgpr_write_b32 a37, 0
    v_accvgpr_write_b32 a38, 0
    v_accvgpr_write_b32 a39, 0
    v_accvgpr_write_b32 a40, 0
    v_accvgpr_write_b32 a41, 0
    v_accvgpr_write_b32 a42, 0
    v_accvgpr_write_b32 a43, 0
    v_accvgpr_write_b32 a44, 0
    v_accvgpr_write_b32 a45, 0
    v_accvgpr_write_b32 a46, 0
    v_accvgpr_write_b32 a47, 0
    v_accvgpr_write_b32 a48, 0
    v_accvgpr_write_b32 a49, 0
    v_accvgpr_write_b32 a50, 0
    v_accvgpr_write_b32 a51, 0
    v_accvgpr_write_b32 a52, 0
    v_accvgpr_write_b32 a53, 0
    v_accvgpr_write_b32 a54, 0
    v_accvgpr_write_b32 a55, 0
    v_accvgpr_write_b32 a56, 0
    v_accvgpr_write_b32 a57, 0
    v_accvgpr_write_b32 a58, 0
    v_accvgpr_write_b32 a59, 0
    v_accvgpr_write_b32 a60, 0
    v_accvgpr_write_b32 a61, 0
    v_accvgpr_write_b32 a62, 0
    v_accvgpr_write_b32 a63, 0
    v_accvgpr_write_b32 a64, 0
    v_accvgpr_write_b32 a65, 0
    v_accvgpr_write_b32 a66, 0
    v_accvgpr_write_b32 a67, 0
    v_accvgpr_write_b32 a68, 0
    v_accvgpr_write_b32 a69, 0
    v_accvgpr_write_b32 a70, 0
    v_accvgpr_write_b32 a71, 0
    v_accvgpr_write_b32 a72, 0
    v_accvgpr_write_b32 a73, 0
    v_accvgpr_write_b32 a74, 0
    v_accvgpr_write_b32 a75, 0
    v_accvgpr_write_b32 a76, 0
    v_accvgpr_write_b32 a77, 0
    v_accvgpr_write_b32 a78, 0
    v_accvgpr_write_b32 a79, 0
    v_mov_b64 v[160:161], 0
    v_mov_b64 v[162:163], 0
    v_mov_b64 v[164:165], 0
    v_mov_b64 v[166:167], 0
    v_mov_b64 v[168:169], 0
    v_mov_b64 v[170:171], 0
    v_mov_b64 v[172:173], 0
    v_mov_b64 v[174:175], 0
    v_mov_b64 v[176:177], 0
    v_mov_b64 v[178:179], 0
    v_mov_b64 v[180:181], 0
    v_mov_b64 v[182:183], 0
    v_mov_b64 v[184:185], 0
    v_mov_b64 v[186:187], 0
    v_mov_b64 v[188:189], 0
    v_mov_b64 v[190:191], 0
    v_mov_b32 v12, 0
    v_mov_b32 v28, 0
    v_mov_b32 v44, 0x3f803f80
    v_mov_b32 v13, 0
    v_mov_b32 v32, 0
    v_mov_b32 v45, 0x3f803f80
    v_mov_b32 v14, 0
    v_mov_b32 v36, 0
    v_mov_b32 v46, 0x3f803f80
    v_mov_b32 v15, 0
    v_mov_b32 v40, 0
    v_mov_b32 v47, 0x3f803f80
    s_and_b32 s90, s2, 7
    s_lshl_b32 s90, s90, 4
    s_lshl_b32 s91, s16, 2
    s_add_u32 s80, s90, s91
    s_lshr_b32 s92, s2, 3
    s_lshl_b32 s92, s92, 17
    s_lshl_b32 s90, s80, 10
    s_add_u32 s90, s90, s92
    s_add_u32 s83, s90, 50331648
    s_add_u32 s84, s90, 54525952
    s_and_b32 s81, s80, 63
    s_cmp_eq_u32 s81, 0
    s_cselect_b32 s93, 0, 1024
    s_sub_u32 s85, s84, s93
    s_lshl_b32 s90, s80, 9
    s_add_u32 s90, s90, s92
    s_add_u32 s86, s90, 58720256
    s_sub_u32 s87, s86, s93
    s_add_u32 s88, s86, 65536
    s_add_u32 s89, s87, 65536
    v_and_b32 v48, 15, v1
    v_lshrrev_b32 v49, 4, v1
    v_lshlrev_b32 v49, 2, v49
    v_sub_u32 v48, v48, v49
    v_cmp_le_i32 vcc, 0, v48
    s_nop 1
    v_cndmask_b32 v16, v9, 0, vcc
    v_cmp_le_i32 vcc, 1, v48
    s_nop 1
    v_cndmask_b32 v17, v9, 0, vcc
    v_cmp_le_i32 vcc, 2, v48
    s_nop 1
    v_cndmask_b32 v18, v9, 0, vcc
    v_cmp_le_i32 vcc, 3, v48
    s_nop 1
    v_cndmask_b32 v19, v9, 0, vcc
    s_mov_b32 s62, 35782688
    s_mov_b32 s63, 0
    s_sub_u32 s90, s67, 1
    s_bitset1_b64 s[62:63], s90
    s_sub_u32 s90, s68, 1
    s_bitset1_b64 s[62:63], s90
    s_sub_u32 s90, s69, 1
    s_bitset1_b64 s[62:63], s90
    s_sub_u32 s90, s70, 1
    s_bitset1_b64 s[62:63], s90
    s_sub_u32 s90, s71, 1
    s_bitset1_b64 s[62:63], s90
    s_sub_u32 s90, s72, 1
    s_bitset1_b64 s[62:63], s90
    s_add_u32 s53, s69, 6
    s_sub_u32 s90, s53, 1
    s_bitset1_b64 s[62:63], s90
    s_mov_b32 s64, 0
    s_cmp_lg_u32 s64, s67
    s_cbranch_scc1 m_e69
    v_add_f32 v176, v176, v16
    v_mov_b32 v180, v9
    v_add_f32 v188, v188, v16
    v_add_f32 v177, v177, v17
    v_mov_b32 v181, v9
    v_add_f32 v189, v189, v17
    v_add_f32 v178, v178, v18
    v_mov_b32 v182, v9
    v_add_f32 v190, v190, v18
    v_add_f32 v179, v179, v19
    v_mov_b32 v183, v9
    v_add_f32 v191, v191, v19
    s_nop 0
m_e69:
    s_waitcnt vmcnt(24) lgkmcnt(0)
    s_barrier
    ds_read_b128 a[192:195], v6 offset:0
    ds_read_b128 a[196:199], v6 offset:1024
    ds_read_b128 a[200:203], v6 offset:2048
    ds_read_b128 a[204:207], v6 offset:3072
    ds_read_b128 a[208:211], v6 offset:4096
    ds_read_b128 a[212:215], v6 offset:5120
    ds_read_b128 a[216:219], v6 offset:6144
    ds_read_b128 a[220:223], v6 offset:7168
    s_waitcnt lgkmcnt(0)
    v_mfma_f32_16x16x32_bf16 v[64:67], a[192:195], a[128:131], v[160:163]
    v_accvgpr_write_b32 a80, 0
    v_accvgpr_write_b32 a81, 0
    v_mfma_f32_16x16x32_bf16 v[64:67], a[196:199], a[132:135], v[64:67]
    buffer_store_dwordx4 v[192:195], v2, s[36:39], s40 offen sc1
    s_add_u32 s40, s40, s100
    v_mfma_f32_16x16x32_bf16 v[64:67], a[200:203], a[136:139], v[64:67]
    v_accvgpr_write_b32 a82, 0
    v_accvgpr_write_b32 a83, 0
    v_mfma_f32_16x16x32_bf16 v[64:67], a[204:207], a[140:143], v[64:67]
    v_accvgpr_write_b32 a84, 0
    v_accvgpr_write_b32 a85, 0
    v_mfma_f32_16x16x32_bf16 v[72:75], a[192:195], a[144:147], v[168:171]
    v_accvgpr_write_b32 a86, 0
    v_accvgpr_write_b32 a87, 0
    v_mfma_f32_16x16x32_bf16 v[72:75], a[196:199], a[148:151], v[72:75]
    buffer_store_dwordx4 v[196:199], v2, s[36:39], s40 offen sc1
    s_add_u32 s40, s40, s100
    v_mfma_f32_16x16x32_bf16 v[72:75], a[200:203], a[152:155], v[72:75]
    v_accvgpr_write_b32 a88, 0
    v_accvgpr_write_b32 a89, 0
    v_mfma_f32_16x16x32_bf16 v[72:75], a[204:207], a[156:159], v[72:75]
    v_accvgpr_write_b32 a90, 0
    v_accvgpr_write_b32 a91, 0
    v_mfma_f32_16x16x32_bf16 v[80:83], a[192:195], a[160:163], v[176:179]
    v_accvgpr_write_b32 a92, 0
    v_accvgpr_write_b32 a93, 0
    v_mfma_f32_16x16x32_bf16 v[80:83], a[196:199], a[164:167], v[80:83]
    buffer_store_dwordx4 v[200:203], v2, s[36:39], s40 offen sc1
    s_add_u32 s40, s40, s100
    v_mfma_f32_16x16x32_bf16 v[80:83], a[200:203], a[168:171], v[80:83]
    v_accvgpr_write_b32 a94, 0
    v_accvgpr_write_b32 a95, 0
    v_mfma_f32_16x16x32_bf16 v[80:83], a[204:207], a[172:175], v[80:83]
    v_accvgpr_write_b32 a96, 0
    v_accvgpr_write_b32 a97, 0
    v_mfma_f32_16x16x32_bf16 v[88:91], a[192:195], a[176:179], v[184:187]
    v_accvgpr_write_b32 a98, 0
    v_accvgpr_write_b32 a99, 0
    v_mfma_f32_16x16x32_bf16 v[88:91], a[196:199], a[180:183], v[88:91]
    buffer_store_dwordx4 v[204:207], v2, s[36:39], s40 offen sc1
    s_add_u32 s40, s98, s99
    v_mfma_f32_16x16x32_bf16 v[88:91], a[200:203], a[184:187], v[88:91]
    v_accvgpr_write_b32 a100, 0
    v_accvgpr_write_b32 a101, 0
    v_mfma_f32_16x16x32_bf16 v[88:91], a[204:207], a[188:191], v[88:91]
    v_accvgpr_write_b32 a102, 0
    v_accvgpr_write_b32 a103, 0
    v_mfma_f32_16x16x32_bf16 v[68:71], a[208:211], a[128:131], v[164:167]
    ds_read_b128 a[192:195], v6 offset:8192
    v_accvgpr_write_b32 a104, 0
    v_accvgpr_write_b32 a105, 0
    v_mfma_f32_16x16x32_bf16 v[68:71], a[212:215], a[132:135], v[68:71]
    buffer_store_dwordx4 v[208:211], v2, s[36:39], s40 offen sc1
    s_add_u32 s40, s40, s100
    ds_read_b128 a[196:199], v6 offset:9216
    v_mfma_f32_16x16x32_bf16 v[68:71], a[216:219], a[136:139], v[68:71]
    ds_read_b128 a[200:203], v6 offset:10240
    v_accvgpr_write_b32 a106, 0
    v_accvgpr_write_b32 a107, 0
    v_mfma_f32_16x16x32_bf16 v[68:71], a[220:223], a[140:143], v[68:71]
    ds_read_b128 a[204:207], v6 offset:11264
    v_accvgpr_write_b32 a108, 0
    v_accvgpr_write_b32 a109, 0
    v_mfma_f32_16x16x32_bf16 v[76:79], a[208:211], a[144:147], v[172:175]
    v_accvgpr_write_b32 a110, 0
    v_accvgpr_write_b32 a111, 0
    v_mfma_f32_16x16x32_bf16 v[76:79], a[212:215], a[148:151], v[76:79]
    buffer_store_dwordx4 v[212:215], v2, s[36:39], s40 offen sc1
    s_add_u32 s40, s40, s100
    v_mfma_f32_16x16x32_bf16 v[76:79], a[216:219], a[152:155], v[76:79]
    v_accvgpr_write_b32 a112, 0
    v_accvgpr_write_b32 a113, 0
    v_mfma_f32_16x16x32_bf16 v[76:79], a[220:223], a[156:159], v[76:79]
    v_accvgpr_write_b32 a114, 0
    v_accvgpr_write_b32 a115, 0
    v_mfma_f32_16x16x32_bf16 v[84:87], a[208:211], a[160:163], v[180:183]
    v_accvgpr_write_b32 a116, 0
    v_accvgpr_write_b32 a117, 0
    v_mfma_f32_16x16x32_bf16 v[84:87], a[212:215], a[164:167], v[84:87]
    buffer_store_dwordx4 v[216:219], v2, s[36:39], s40 offen sc1
    s_add_u32 s40, s40, s100
    v_mfma_f32_16x16x32_bf16 v[84:87], a[216:219], a[168:171], v[84:87]
    v_accvgpr_write_b32 a118, 0
    v_accvgpr_write_b32 a119, 0
    v_mfma_f32_16x16x32_bf16 v[84:87], a[220:223], a[172:175], v[84:87]
    v_accvgpr_write_b32 a120, 0
    v_accvgpr_write_b32 a121, 0
    v_mfma_f32_16x16x32_bf16 v[92:95], a[208:211], a[176:179], v[188:191]
    v_accvgpr_write_b32 a122, 0
    v_accvgpr_write_b32 a123, 0
    v_mfma_f32_16x16x32_bf16 v[92:95], a[212:215], a[180:183], v[92:95]
    buffer_store_dwordx4 v[220:223], v2, s[36:39], s40 offen sc1
    s_add_u32 s40, s40, s100
    v_mfma_f32_16x16x32_bf16 v[92:95], a[216:219], a[184:187], v[92:95]
    v_accvgpr_write_b32 a124, 0
    v_accvgpr_write_b32 a125, 0
    v_mfma_f32_16x16x32_bf16 v[92:95], a[220:223], a[188:191], v[92:95]
    v_accvgpr_write_b32 a126, 0
    v_accvgpr_write_b32 a127, 0
    ds_read_b128 a[208:211], v6 offset:12288
    ds_read_b128 a[212:215], v6 offset:13312
    ds_read_b128 a[216:219], v6 offset:14336
    ds_read_b128 a[220:223], v6 offset:15360
    s_mov_b32 s64, 1
    s_nop 0
    s_nop 3
    v_max3_f32 v48, v64, v65, v66
    v_max3_f32 v49, v72, v73, v74
    v_max3_f32 v50, v80, v81, v82
    v_max3_f32 v51, v88, v89, v90
    v_max3_f32 v48, v48, v67, v68
    v_max3_f32 v49, v49, v75, v76
    v_max3_f32 v50, v50, v83, v84
    v_max3_f32 v51, v51, v91, v92
    v_max3_f32 v48, v48, v69, v70
    v_max3_f32 v49, v49, v77, v78
    v_max3_f32 v50, v50, v85, v86
    v_max3_f32 v51, v51, v93, v94
    v_max_f32 v48, v48, v71
    v_max_f32 v49, v49, v79
    v_max_f32 v50, v50, v87
    v_max_f32 v51, v51, v95
    v_mov_b32 v52, v48
    v_mov_b32 v53, v49
    v_mov_b32 v54, v50
    v_mov_b32 v55, v51
    s_nop 1
    v_permlane32_swap_b32 v48, v52
    v_permlane32_swap_b32 v49, v53
    v_permlane32_swap_b32 v50, v54
    v_permlane32_swap_b32 v51, v55
    s_nop 1
    v_max_f32 v48, v48, v52
    v_max_f32 v49, v49, v53
    v_max_f32 v50, v50, v54
    v_max_f32 v51, v51, v55
    v_mov_b32 v52, v48
    v_mov_b32 v53, v49
    v_mov_b32 v54, v50
    v_mov_b32 v55, v51
    s_nop 1
    v_permlane16_swap_b32 v48, v52
    v_permlane16_swap_b32 v49, v53
    v_permlane16_swap_b32 v50, v54
    v_permlane16_swap_b32 v51, v55
    s_nop 1
    v_max_f32 v48, v48, v52
    v_max_f32 v49, v49, v53
    v_max_f32 v50, v50, v54
    v_max_f32 v51, v51, v55
    v_sub_f32 v160, v160, v48
    v_sub_f32 v161, v161, v48
    v_sub_f32 v162, v162, v48
    v_sub_f32 v163, v163, v48
    v_sub_f32 v164, v164, v48
    v_sub_f32 v165, v165, v48
    v_sub_f32 v166, v166, v48
    v_sub_f32 v167, v167, v48
    v_sub_f32 v168, v168, v49
    v_sub_f32 v169, v169, v49
    v_sub_f32 v170, v170, v49
    v_sub_f32 v171, v171, v49
    v_sub_f32 v172, v172, v49
    v_sub_f32 v173, v173, v49
    v_sub_f32 v174, v174, v49
    v_sub_f32 v175, v175, v49
    v_sub_f32 v176, v176, v50
    v_sub_f32 v177, v177, v50
    v_sub_f32 v178, v178, v50
    v_sub_f32 v179, v179, v50
    v_sub_f32 v180, v180, v50
    v_sub_f32 v181, v181, v50
    v_sub_f32 v182, v182, v50
    v_sub_f32 v183, v183, v50
    v_sub_f32 v184, v184, v51
    v_sub_f32 v185, v185, v51
    v_sub_f32 v186, v186, v51
    v_sub_f32 v187, v187, v51
    v_sub_f32 v188, v188, v51
    v_sub_f32 v189, v189, v51
    v_sub_f32 v190, v190, v51
    v_sub_f32 v191, v191, v51
    v_sub_f32 v64, v64, v48
    v_sub_f32 v65, v65, v48
    v_sub_f32 v66, v66, v48
    v_sub_f32 v67, v67, v48
    v_sub_f32 v68, v68, v48
    v_sub_f32 v69, v69, v48
    v_sub_f32 v70, v70, v48
    v_sub_f32 v71, v71, v48
    v_sub_f32 v72, v72, v49
    v_sub_f32 v73, v73, v49
    v_sub_f32 v74, v74, v49
    v_sub_f32 v75, v75, v49
    v_sub_f32 v76, v76, v49
    v_sub_f32 v77, v77, v49
    v_sub_f32 v78, v78, v49
    v_sub_f32 v79, v79, v49
    v_sub_f32 v80, v80, v50
    v_sub_f32 v81, v81, v50
    v_sub_f32 v82, v82, v50
    v_sub_f32 v83, v83, v50
    v_sub_f32 v84, v84, v50
    v_sub_f32 v85, v85, v50
    v_sub_f32 v86, v86, v50
    v_sub_f32 v87, v87, v50
    v_sub_f32 v88, v88, v51
    v_sub_f32 v89, v89, v51
    v_sub_f32 v90, v90, v51
    v_sub_f32 v91, v91, v51
    v_sub_f32 v92, v92, v51
    v_sub_f32 v93, v93, v51
    v_sub_f32 v94, v94, v51
    v_sub_f32 v95, v95, v51
    s_cmp_lg_u32 s64, s67
    s_cbranch_scc1 m_e70
    v_add_f32 v176, v176, v16
    v_mov_b32 v180, v9
    v_add_f32 v188, v188, v16
    v_add_f32 v177, v177, v17
    v_mov_b32 v181, v9
    v_add_f32 v189, v189, v17
    v_add_f32 v178, v178, v18
    v_mov_b32 v182, v9
    v_add_f32 v190, v190, v18
    v_add_f32 v179, v179, v19
    v_mov_b32 v183, v9
    v_add_f32 v191, v191, v19
    s_nop 0
m_e70:
    s_cmp_lg_u32 s64, s68
    s_cbranch_scc1 m_e71
    v_mov_b32 v176, v9
    v_mov_b32 v184, v9
    v_mov_b32 v188, v9
    v_mov_b32 v177, v9
    v_mov_b32 v185, v9
    v_mov_b32 v189, v9
    v_mov_b32 v178, v9
    v_mov_b32 v186, v9
    v_mov_b32 v190, v9
    v_mov_b32 v179, v9
    v_mov_b32 v187, v9
    v_mov_b32 v191, v9
    s_nop 0
m_e71:
    s_waitcnt lgkmcnt(0)
    v_mfma_f32_16x16x32_bf16 v[96:99], a[192:195], a[128:131], v[160:163]
    s_bitcmp1_b64 s[62:63], s64
    s_cselect_b32 s66, -1.0, s65
    v_exp_f32 v20, v64
    v_mfma_f32_16x16x32_bf16 v[96:99], a[196:199], a[132:135], v[96:99]
    s_add_u32 s64, s64, 1
    v_exp_f32 v21, v65
    v_exp_f32 v22, v66
    v_mfma_f32_16x16x32_bf16 v[96:99], a[200:203], a[136:139], v[96:99]
    buffer_store_dwordx4 v[224:227], v2, s[36:39], s40 offen sc1
    v_cvt_pk_bf16_f32 v128, v20, v21
    v_mfma_f32_16x16x32_bf16 v[96:99], a[204:207], a[140:143], v[96:99]
    s_add_u32 s40, s40, s100
    v_add_f32 v12, v12, v28
    v_exp_f32 v23, v67
    v_mfma_f32_16x16x32_bf16 v[104:107], a[192:195], a[144:147], v[168:171]
    v_exp_f32 v24, v68
    v_cvt_pk_bf16_f32 v129, v22, v23
    v_mfma_f32_16x16x32_bf16 v[104:107], a[196:199], a[148:151], v[104:107]
    buffer_store_dwordx4 v[228:231], v2, s[36:39], s40 offen sc1
    v_exp_f32 v25, v69
    v_mfma_f32_16x16x32_bf16 v[104:107], a[200:203], a[152:155], v[104:107]
    s_add_u32 s40, s40, s100
    v_exp_f32 v26, v70
    v_cvt_pk_bf16_f32 v130, v24, v25
    v_mfma_f32_16x16x32_bf16 v[104:107], a[204:207], a[156:159], v[104:107]
    v_exp_f32 v27, v71
    v_add_f32 v13, v13, v32
    v_mfma_f32_16x16x32_bf16 v[112:115], a[192:195], a[160:163], v[176:179]
    v_exp_f32 v20, v72
    v_cvt_pk_bf16_f32 v131, v26, v27
    v_mfma_f32_16x16x32_bf16 v[112:115], a[196:199], a[164:167], v[112:115]
    buffer_store_dwordx4 v[232:235], v2, s[36:39], s40 offen sc1
    v_exp_f32 v21, v73
    v_mfma_f32_16x16x32_bf16 v[28:31], v[44:47], v[128:131], 0
    v_exp_f32 v22, v74
    v_cvt_pk_bf16_f32 v132, v20, v21
    v_mfma_f32_16x16x32_bf16 v[112:115], a[200:203], a[168:171], v[112:115]
    s_add_u32 s40, s40, s100
    v_exp_f32 v23, v75
    v_add_f32 v14, v14, v36
    v_mfma_f32_16x16x32_bf16 v[112:115], a[204:207], a[172:175], v[112:115]
    v_exp_f32 v24, v76
    v_cvt_pk_bf16_f32 v133, v22, v23
    v_mfma_f32_16x16x32_bf16 v[120:123], a[192:195], a[176:179], v[184:187]
    buffer_store_dwordx4 v[236:239], v2, s[36:39], s40 offen sc1
    v_exp_f32 v25, v77
    v_mfma_f32_16x16x32_bf16 v[120:123], a[196:199], a[180:183], v[120:123]
    s_mov_b32 s40, s98
    v_exp_f32 v26, v78
    v_cvt_pk_bf16_f32 v134, v24, v25
    v_mfma_f32_16x16x32_bf16 v[120:123], a[200:203], a[184:187], v[120:123]
    v_exp_f32 v27, v79
    v_add_f32 v15, v15, v40
    v_mfma_f32_16x16x32_bf16 v[120:123], a[204:207], a[188:191], v[120:123]
    s_waitcnt lgkmcnt(0)
    v_exp_f32 v20, v80
    v_cvt_pk_bf16_f32 v135, v26, v27
    v_mfma_f32_16x16x32_bf16 v[100:103], a[208:211], a[128:131], v[164:167]
    v_exp_f32 v21, v81
    v_exp_f32 v22, v82
    v_mfma_f32_16x16x32_bf16 v[32:35], v[44:47], v[132:135], 0
    v_cvt_pk_bf16_f32 v136, v20, v21
    v_exp_f32 v23, v83
    v_mfma_f32_16x16x32_bf16 v[100:103], a[212:215], a[132:135], v[100:103]
    buffer_store_dwordx4 v[240:243], v2, s[36:39], s40 offen sc1
    v_cvt_pk_bf16_f32 v137, v22, v23
    v_mfma_f32_16x16x32_bf16 v[100:103], a[216:219], a[136:139], v[100:103]
    s_add_u32 s40, s40, s100
    v_exp_f32 v24, v84
    v_mfma_f32_16x16x32_bf16 v[100:103], a[220:223], a[140:143], v[100:103]
    v_exp_f32 v25, v85
    v_exp_f32 v26, v86
    v_cvt_pk_bf16_f32 v138, v24, v25
    v_mfma_f32_16x16x32_bf16 v[108:111], a[208:211], a[144:147], v[172:175]
    buffer_store_dwordx4 v[244:247], v2, s[36:39], s40 offen sc1
    v_mfma_f32_16x16x32_bf16 v[108:111], a[212:215], a[148:151], v[108:111]
    s_add_u32 s40, s40, s100
    v_exp_f32 v27, v87
    v_exp_f32 v20, v88
    v_mfma_f32_16x16x32_bf16 v[108:111], a[216:219], a[152:155], v[108:111]
    v_cvt_pk_bf16_f32 v139, v26, v27
    v_exp_f32 v21, v89
    v_mfma_f32_16x16x32_bf16 v[108:111], a[220:223], a[156:159], v[108:111]
    buffer_store_dwordx4 v[248:251], v2, s[36:39], s40 offen sc1
    v_exp_f32 v22, v90
    v_mfma_f32_16x16x32_bf16 v[36:39], v[44:47], v[136:139], 0
    v_cvt_pk_bf16_f32 v140, v20, v21
    v_exp_f32 v23, v91
    v_mfma_f32_16x16x32_bf16 v[116:119], a[208:211], a[160:163], v[180:183]
    s_add_u32 s40, s40, s100
    v_exp_f32 v24, v92
    v_cvt_pk_bf16_f32 v141, v22, v23
    v_mfma_f32_16x16x32_bf16 v[116:119], a[212:215], a[164:167], v[116:119]
    v_exp_f32 v25, v93
    v_mfma_f32_16x16x32_bf16 v[116:119], a[216:219], a[168:171], v[116:119]
    buffer_store_dwordx4 v[252:255], v2, s[36:39], s40 offen sc1
    v_exp_f32 v26, v94
    v_cvt_pk_bf16_f32 v142, v24, v25
    v_mfma_f32_16x16x32_bf16 v[116:119], a[220:223], a[172:175], v[116:119]
    s_add_u32 s40, s40, s100
    v_exp_f32 v27, v95
    s_nop 0
    v_cvt_pk_bf16_f32 v143, v26, v27
    s_nop 1
    v_mfma_f32_16x16x32_bf16 v[40:43], v[44:47], v[140:143], 0
    s_nop 2
    v_mfma_f32_16x16x32_bf16 v[124:127], a[208:211], a[176:179], v[188:191]
    s_nop 2
    v_mfma_f32_16x16x32_bf16 v[124:127], a[212:215], a[180:183], v[124:127]
    v_max3_f32 v8, v28, v32, v36
    v_max_f32 v8, v8, v40
    v_mfma_f32_16x16x32_bf16 v[124:127], a[216:219], a[184:187], v[124:127]
    v_cmp_nge_f32 vcc, s66, v8
    v_mfma_f32_16x16x32_bf16 v[124:127], a[220:223], a[188:191], v[124:127]
    s_waitcnt vmcnt(40) lgkmcnt(0)
    s_barrier
    s_add_u32 s59, s58, s60
    s_add_u32 s58, s58, 32768
    s_and_b32 s58, s58, 0x1ffff
    v_add_u32 v6, s58, v2
    ds_read_b128 a[192:195], v6 offset:0
    ds_read_b128 a[196:199], v6 offset:1024
    ds_read_b128 a[200:203], v6 offset:2048
    ds_read_b128 a[204:207], v6 offset:3072
    ds_read_b128 a[208:211], v6 offset:4096
    ds_read_b128 a[212:215], v6 offset:5120
    ds_read_b128 a[216:219], v6 offset:6144
    ds_read_b128 a[220:223], v6 offset:7168
    s_waitcnt lgkmcnt(0)
    s_cbranch_vccnz m_stub72
m_ret73:
m_dual74:
    v_mfma_f32_16x16x32_bf16 v[64:67], a[192:195], a[128:131], v[160:163]
    s_bitcmp1_b64 s[62:63], s64
    s_cselect_b32 s66, -1.0, s65
    v_add_f32 v12, v12, v28
    v_mfma_f32_16x16x32_bf16 v[64:67], a[196:199], a[132:135], v[64:67]
    s_add_u32 s64, s64, 1
    ds_read_b128 a[224:227], v6 offset:16384
    v_add_f32 v13, v13, v32
    v_mfma_f32_16x16x32_bf16 v[64:67], a[200:203], a[136:139], v[64:67]
    v_exp_f32 v20, v96
    v_mfma_f32_16x16x32_bf16 v[64:67], a[204:207], a[140:143], v[64:67]
    v_exp_f32 v21, v97
    v_mfma_f32_16x16x32_bf16 v[72:75], a[192:195], a[144:147], v[168:171]
    s_mov_b32 m0, s59
    ds_read_b128 a[228:231], v6 offset:17408
    v_cvt_pk_bf16_f32 v144, v20, v21
    v_mfma_f32_16x16x32_bf16 v[72:75], a[196:199], a[148:151], v[72:75]
    buffer_load_dwordx4 v7, s[24:27], s56 offen offset:0 sc1 lds
    v_mfma_f32_16x16x32_bf16 v[72:75], a[200:203], a[152:155], v[72:75]
    v_exp_f32 v22, v98
    v_mfma_f32_16x16x32_bf16 v[72:75], a[204:207], a[156:159], v[72:75]
    ds_read_b128 a[232:235], v6 offset:18432
    v_add_f32 v14, v14, v36
    v_mfma_f32_16x16x32_bf16 v[80:83], a[192:195], a[160:163], v[176:179]
    v_exp_f32 v23, v99
    v_mfma_f32_16x16x32_bf16 v[80:83], a[196:199], a[164:167], v[80:83]
    v_exp_f32 v24, v100
    v_mfma_f32_16x16x32_bf16 v[80:83], a[200:203], a[168:171], v[80:83]
    ds_read_b128 a[236:239], v6 offset:19456
    v_cvt_pk_bf16_f32 v145, v22, v23
    v_mfma_f32_16x16x32_bf16 v[80:83], a[204:207], a[172:175], v[80:83]
    v_exp_f32 v25, v101
    v_mfma_f32_16x16x32_bf16 v[88:91], a[192:195], a[176:179], v[184:187]
    v_exp_f32 v26, v102
    v_mfma_f32_16x16x32_bf16 v[88:91], a[196:199], a[180:183], v[88:91]
    ds_read_b128 a[240:243], v6 offset:20480
    v_cvt_pk_bf16_f32 v146, v24, v25
    v_mfma_f32_16x16x32_bf16 v[88:91], a[200:203], a[184:187], v[88:91]
    v_exp_f32 v27, v103
    v_mfma_f32_16x16x32_bf16 v[88:91], a[204:207], a[188:191], v[88:91]
    s_waitcnt lgkmcnt(5)
    v_exp_f32 v20, v104
    v_mfma_f32_16x16x32_bf16 v[68:71], a[208:211], a[128:131], v[164:167]
    ds_read_b128 a[244:247], v6 offset:21504
    v_cvt_pk_bf16_f32 v147, v26, v27
    v_mfma_f32_16x16x32_bf16 v[68:71], a[212:215], a[132:135], v[68:71]
    v_exp_f32 v21, v105
    v_mfma_f32_16x16x32_bf16 v[28:31], v[44:47], v[144:147], 0
    v_exp_f32 v22, v106
    v_mfma_f32_16x16x32_bf16 v[68:71], a[216:219], a[136:139], v[68:71]
    buffer_load_dwordx4 v7, s[24:27], s56 offen offset:1024 sc1 lds
    v_mfma_f32_16x16x32_bf16 v[68:71], a[220:223], a[140:143], v[68:71]
    ds_read_b128 a[248:251], v6 offset:22528
    v_cvt_pk_bf16_f32 v148, v20, v21
    v_mfma_f32_16x16x32_bf16 v[76:79], a[208:211], a[144:147], v[172:175]
    v_exp_f32 v23, v107
    v_mfma_f32_16x16x32_bf16 v[76:79], a[212:215], a[148:151], v[76:79]
    v_exp_f32 v24, v108
    v_mfma_f32_16x16x32_bf16 v[76:79], a[216:219], a[152:155], v[76:79]
    ds_read_b128 a[252:255], v6 offset:23552
    v_cvt_pk_bf16_f32 v149, v22, v23
    v_mfma_f32_16x16x32_bf16 v[76:79], a[220:223], a[156:159], v[76:79]
    v_exp_f32 v25, v109
    v_mfma_f32_16x16x32_bf16 v[84:87], a[208:211], a[160:163], v[180:183]
    v_exp_f32 v26, v110
    v_mfma_f32_16x16x32_bf16 v[84:87], a[212:215], a[164:167], v[84:87]
    v_cvt_pk_bf16_f32 v150, v24, v25
    v_add_f32 v15, v15, v40
    v_mfma_f32_16x16x32_bf16 v[84:87], a[216:219], a[168:171], v[84:87]
    v_exp_f32 v27, v111
    v_mfma_f32_16x16x32_bf16 v[84:87], a[220:223], a[172:175], v[84:87]
    buffer_load_dwordx4 v7, s[24:27], s56 offen offset:2048 sc1 lds
    v_mfma_f32_16x16x32_bf16 v[92:95], a[208:211], a[176:179], v[188:191]
    v_exp_f32 v20, v112
    v_mfma_f32_16x16x32_bf16 v[92:95], a[212:215], a[180:183], v[92:95]
    v_cvt_pk_bf16_f32 v151, v26, v27
    v_mfma_f32_16x16x32_bf16 v[92:95], a[216:219], a[184:187], v[92:95]
    v_exp_f32 v21, v113
    v_mfma_f32_16x16x32_bf16 v[32:35], v[44:47], v[148:151], 0
    v_exp_f32 v22, v114
    v_mfma_f32_16x16x32_bf16 v[92:95], a[220:223], a[188:191], v[92:95]
    s_waitcnt lgkmcnt(0)
    v_cvt_pk_bf16_f32 v152, v20, v21
    v_mfma_f32_16x16x32_bf16 a[0:3], a[224:227], v[128:131], a[0:3]
    ds_read_b128 a[192:195], v6 offset:8192
    v_mfma_f32_16x16x32_bf16 a[32:35], a[224:227], v[132:135], a[32:35]
    v_exp_f32 v23, v115
    v_mfma_f32_16x16x32_bf16 a[64:67], a[224:227], v[136:139], a[64:67]
    v_exp_f32 v24, v116
    v_mfma_f32_16x16x32_bf16 a[96:99], a[224:227], v[140:143], a[96:99]
    ds_read_b128 a[196:199], v6 offset:9216
    v_cvt_pk_bf16_f32 v153, v22, v23
    v_mfma_f32_16x16x32_bf16 a[4:7], a[228:231], v[128:131], a[4:7]
    v_exp_f32 v25, v117
    v_mfma_f32_16x16x32_bf16 a[36:39], a[228:231], v[132:135], a[36:39]
    v_exp_f32 v26, v118
    v_mfma_f32_16x16x32_bf16 a[68:71], a[228:231], v[136:139], a[68:71]
    ds_read_b128 a[200:203], v6 offset:10240
    v_cvt_pk_bf16_f32 v154, v24, v25
    v_mfma_f32_16x16x32_bf16 a[100:103], a[228:231], v[140:143], a[100:103]
    v_exp_f32 v27, v119
    v_mfma_f32_16x16x32_bf16 a[8:11], a[232:235], v[128:131], a[8:11]
    v_exp_f32 v20, v120
    v_mfma_f32_16x16x32_bf16 a[40:43], a[232:235], v[132:135], a[40:43]
    ds_read_b128 a[204:207], v6 offset:11264
    v_cvt_pk_bf16_f32 v155, v26, v27
    v_mfma_f32_16x16x32_bf16 a[72:75], a[232:235], v[136:139], a[72:75]
    v_exp_f32 v21, v121
    v_mfma_f32_16x16x32_bf16 v[36:39], v[44:47], v[152:155], 0
    v_exp_f32 v22, v122
    v_mfma_f32_16x16x32_bf16 a[104:107], a[232:235], v[140:143], a[104:107]
    buffer_load_dwordx4 v7, s[24:27], s56 offen offset:3072 sc1 lds
    v_mfma_f32_16x16x32_bf16 a[12:15], a[236:239], v[128:131], a[12:15]
    s_add_u32 s56, s56, 16384
    v_cvt_pk_bf16_f32 v156, v20, v21
    v_mfma_f32_16x16x32_bf16 a[44:47], a[236:239], v[132:135], a[44:47]
    v_exp_f32 v23, v123
    v_mfma_f32_16x16x32_bf16 a[76:79], a[236:239], v[136:139], a[76:79]
    v_exp_f32 v24, v124
    v_mfma_f32_16x16x32_bf16 a[108:111], a[236:239], v[140:143], a[108:111]
    v_cvt_pk_bf16_f32 v157, v22, v23
    v_mfma_f32_16x16x32_bf16 a[16:19], a[240:243], v[128:131], a[16:19]
    v_exp_f32 v25, v125
    v_mfma_f32_16x16x32_bf16 a[48:51], a[240:243], v[132:135], a[48:51]
    v_exp_f32 v26, v126
    v_mfma_f32_16x16x32_bf16 a[80:83], a[240:243], v[136:139], a[80:83]
    v_cvt_pk_bf16_f32 v158, v24, v25
    v_mfma_f32_16x16x32_bf16 a[112:115], a[240:243], v[140:143], a[112:115]
    s_add_u32 m0, s59, 16384
    v_exp_f32 v27, v127
    v_mfma_f32_16x16x32_bf16 a[20:23], a[244:247], v[128:131], a[20:23]
    buffer_load_dwordx4 v7, s[28:31], s57 offen offset:0 sc1 lds
    v_mfma_f32_16x16x32_bf16 a[52:55], a[244:247], v[132:135], a[52:55]
    v_cvt_pk_bf16_f32 v159, v26, v27
    v_mfma_f32_16x16x32_bf16 a[84:87], a[244:247], v[136:139], a[84:87]
    v_mfma_f32_16x16x32_bf16 a[116:119], a[244:247], v[140:143], a[116:119]
    v_mfma_f32_16x16x32_bf16 v[40:43], v[44:47], v[156:159], 0
    s_nop 2
    v_mfma_f32_16x16x32_bf16 a[24:27], a[248:251], v[128:131], a[24:27]
    s_nop 2
    v_mfma_f32_16x16x32_bf16 a[56:59], a[248:251], v[132:135], a[56:59]
    v_max3_f32 v8, v28, v32, v36
    v_max_f32 v8, v8, v40
    v_mfma_f32_16x16x32_bf16 a[88:91], a[248:251], v[136:139], a[88:91]
    v_cmp_nge_f32 vcc, s66, v8
    v_mfma_f32_16x16x32_bf16 a[120:123], a[248:251], v[140:143], a[120:123]
    ds_read_b128 a[208:211], v6 offset:12288
    v_mfma_f32_16x16x32_bf16 a[28:31], a[252:255], v[128:131], a[28:31]
    ds_read_b128 a[212:215], v6 offset:13312
    v_mfma_f32_16x16x32_bf16 a[60:63], a[252:255], v[132:135], a[60:63]
    ds_read_b128 a[216:219], v6 offset:14336
    v_mfma_f32_16x16x32_bf16 a[92:95], a[252:255], v[136:139], a[92:95]
    ds_read_b128 a[220:223], v6 offset:15360
    v_mfma_f32_16x16x32_bf16 a[124:127], a[252:255], v[140:143], a[124:127]
    s_waitcnt lgkmcnt(4)
    s_cbranch_vccnz m_stub75
m_ret76:
    v_mfma_f32_16x16x32_bf16 v[96:99], a[192:195], a[128:131], v[160:163]
    s_add_u32 s59, s58, s60
    v_exp_f32 v20, v64
    v_mfma_f32_16x16x32_bf16 v[96:99], a[196:199], a[132:135], v[96:99]
    s_add_u32 s58, s58, 32768
    ds_read_b128 a[224:227], v6 offset:24576
    v_add_f32 v12, v12, v28
    v_mfma_f32_16x16x32_bf16 v[96:99], a[200:203], a[136:139], v[96:99]
    s_and_b32 s58, s58, 0x1ffff
    v_exp_f32 v21, v65
    v_mfma_f32_16x16x32_bf16 v[96:99], a[204:207], a[140:143], v[96:99]
    s_bitcmp1_b64 s[62:63], s64
    s_cselect_b32 s66, -1.0, s65
    v_cvt_pk_bf16_f32 v128, v20, v21
    v_mfma_f32_16x16x32_bf16 v[104:107], a[192:195], a[144:147], v[168:171]
    s_add_u32 s64, s64, 1
    ds_read_b128 a[228:231], v6 offset:25600
    v_add_f32 v13, v13, v32
    v_mfma_f32_16x16x32_bf16 v[104:107], a[196:199], a[148:151], v[104:107]
    v_exp_f32 v22, v66
    v_mfma_f32_16x16x32_bf16 v[104:107], a[200:203], a[152:155], v[104:107]
    buffer_load_dwordx4 v7, s[28:31], s57 offen offset:1024 sc1 lds
    v_mfma_f32_16x16x32_bf16 v[104:107], a[204:207], a[156:159], v[104:107]
    ds_read_b128 a[232:235], v6 offset:26624
    v_add_f32 v14, v14, v36
    v_mfma_f32_16x16x32_bf16 v[112:115], a[192:195], a[160:163], v[176:179]
    v_exp_f32 v23, v67
    v_mfma_f32_16x16x32_bf16 v[112:115], a[196:199], a[164:167], v[112:115]
    v_exp_f32 v24, v68
    v_mfma_f32_16x16x32_bf16 v[112:115], a[200:203], a[168:171], v[112:115]
    ds_read_b128 a[236:239], v6 offset:27648
    v_cvt_pk_bf16_f32 v129, v22, v23
    v_mfma_f32_16x16x32_bf16 v[112:115], a[204:207], a[172:175], v[112:115]
    v_exp_f32 v25, v69
    v_mfma_f32_16x16x32_bf16 v[120:123], a[192:195], a[176:179], v[184:187]
    v_exp_f32 v26, v70
    v_mfma_f32_16x16x32_bf16 v[120:123], a[196:199], a[180:183], v[120:123]
    ds_read_b128 a[240:243], v6 offset:28672
    v_cvt_pk_bf16_f32 v130, v24, v25
    v_mfma_f32_16x16x32_bf16 v[120:123], a[200:203], a[184:187], v[120:123]
    v_exp_f32 v27, v71
    v_mfma_f32_16x16x32_bf16 v[120:123], a[204:207], a[188:191], v[120:123]
    s_waitcnt lgkmcnt(5)
    v_exp_f32 v20, v72
    v_mfma_f32_16x16x32_bf16 v[100:103], a[208:211], a[128:131], v[164:167]
    ds_read_b128 a[244:247], v6 offset:29696
    v_cvt_pk_bf16_f32 v131, v26, v27
    v_mfma_f32_16x16x32_bf16 v[100:103], a[212:215], a[132:135], v[100:103]
    v_exp_f32 v21, v73
    v_mfma_f32_16x16x32_bf16 v[28:31], v[44:47], v[128:131], 0
    v_exp_f32 v22, v74
    v_mfma_f32_16x16x32_bf16 v[100:103], a[216:219], a[136:139], v[100:103]
    buffer_load_dwordx4 v7, s[28:31], s57 offen offset:2048 sc1 lds
    v_mfma_f32_16x16x32_bf16 v[100:103], a[220:223], a[140:143], v[100:103]
    ds_read_b128 a[248:251], v6 offset:30720
    v_cvt_pk_bf16_f32 v132, v20, v21
    v_mfma_f32_16x16x32_bf16 v[108:111], a[208:211], a[144:147], v[172:175]
    v_exp_f32 v23, v75
    v_mfma_f32_16x16x32_bf16 v[108:111], a[212:215], a[148:151], v[108:111]
    v_exp_f32 v24, v76
    v_mfma_f32_16x16x32_bf16 v[108:111], a[216:219], a[152:155], v[108:111]
    ds_read_b128 a[252:255], v6 offset:31744
    v_cvt_pk_bf16_f32 v133, v22, v23
    v_mfma_f32_16x16x32_bf16 v[108:111], a[220:223], a[156:159], v[108:111]
    v_exp_f32 v25, v77
    v_mfma_f32_16x16x32_bf16 v[116:119], a[208:211], a[160:163], v[180:183]
    v_exp_f32 v26, v78
    v_mfma_f32_16x16x32_bf16 v[116:119], a[212:215], a[164:167], v[116:119]
    v_cvt_pk_bf16_f32 v134, v24, v25
    v_add_f32 v15, v15, v40
    v_mfma_f32_16x16x32_bf16 v[116:119], a[216:219], a[168:171], v[116:119]
    v_exp_f32 v27, v79
    v_mfma_f32_16x16x32_bf16 v[116:119], a[220:223], a[172:175], v[116:119]
    buffer_load_dwordx4 v7, s[28:31], s57 offen offset:3072 sc1 lds
    v_mfma_f32_16x16x32_bf16 v[124:127], a[208:211], a[176:179], v[188:191]
    s_add_u32 s57, s57, 16384
    v_exp_f32 v20, v80
    v_mfma_f32_16x16x32_bf16 v[124:127], a[212:215], a[180:183], v[124:127]
    v_cvt_pk_bf16_f32 v135, v26, v27
    v_mfma_f32_16x16x32_bf16 v[124:127], a[216:219], a[184:187], v[124:127]
    v_exp_f32 v21, v81
    v_mfma_f32_16x16x32_bf16 v[32:35], v[44:47], v[132:135], 0
    v_exp_f32 v22, v82
    v_mfma_f32_16x16x32_bf16 v[124:127], a[220:223], a[188:191], v[124:127]
    s_waitcnt vmcnt(16) lgkmcnt(0)
    v_add_u32 v6, s58, v2
    v_cvt_pk_bf16_f32 v136, v20, v21
    v_mfma_f32_16x16x32_bf16 a[0:3], a[224:227], v[144:147], a[0:3]
    s_barrier
    v_mfma_f32_16x16x32_bf16 a[32:35], a[224:227], v[148:151], a[32:35]
    ds_read_b128 a[192:195], v6 offset:0
    v_mfma_f32_16x16x32_bf16 a[64:67], a[224:227], v[152:155], a[64:67]
    v_exp_f32 v23, v83
    v_mfma_f32_16x16x32_bf16 a[96:99], a[224:227], v[156:159], a[96:99]
    v_exp_f32 v24, v84
    v_mfma_f32_16x16x32_bf16 a[4:7], a[228:231], v[144:147], a[4:7]
    ds_read_b128 a[196:199], v6 offset:1024
    v_cvt_pk_bf16_f32 v137, v22, v23
    v_mfma_f32_16x16x32_bf16 a[36:39], a[228:231], v[148:151], a[36:39]
    v_exp_f32 v25, v85
    v_mfma_f32_16x16x32_bf16 a[68:71], a[228:231], v[152:155], a[68:71]
    v_exp_f32 v26, v86
    v_mfma_f32_16x16x32_bf16 a[100:103], a[228:231], v[156:159], a[100:103]
    ds_read_b128 a[200:203], v6 offset:2048
    v_cvt_pk_bf16_f32 v138, v24, v25
    v_mfma_f32_16x16x32_bf16 a[8:11], a[232:235], v[144:147], a[8:11]
    v_exp_f32 v27, v87
    v_mfma_f32_16x16x32_bf16 a[40:43], a[232:235], v[148:151], a[40:43]
    v_exp_f32 v20, v88
    v_mfma_f32_16x16x32_bf16 a[72:75], a[232:235], v[152:155], a[72:75]
    ds_read_b128 a[204:207], v6 offset:3072
    v_cvt_pk_bf16_f32 v139, v26, v27
    v_mfma_f32_16x16x32_bf16 a[104:107], a[232:235], v[156:159], a[104:107]
    v_exp_f32 v21, v89
    v_mfma_f32_16x16x32_bf16 v[36:39], v[44:47], v[136:139], 0
    v_exp_f32 v22, v90
    v_mfma_f32_16x16x32_bf16 a[12:15], a[236:239], v[144:147], a[12:15]
    v_cvt_pk_bf16_f32 v140, v20, v21
    v_mfma_f32_16x16x32_bf16 a[44:47], a[236:239], v[148:151], a[44:47]
    v_exp_f32 v23, v91
    v_mfma_f32_16x16x32_bf16 a[76:79], a[236:239], v[152:155], a[76:79]
    v_exp_f32 v24, v92
    v_mfma_f32_16x16x32_bf16 a[108:111], a[236:239], v[156:159], a[108:111]
    v_cvt_pk_bf16_f32 v141, v22, v23
    v_mfma_f32_16x16x32_bf16 a[16:19], a[240:243], v[144:147], a[16:19]
    v_exp_f32 v25, v93
    v_mfma_f32_16x16x32_bf16 a[48:51], a[240:243], v[148:151], a[48:51]
    v_exp_f32 v26, v94
    v_mfma_f32_16x16x32_bf16 a[80:83], a[240:243], v[152:155], a[80:83]
    v_cvt_pk_bf16_f32 v142, v24, v25
    v_mfma_f32_16x16x32_bf16 a[112:115], a[240:243], v[156:159], a[112:115]
    v_exp_f32 v27, v95
    v_mfma_f32_16x16x32_bf16 a[20:23], a[244:247], v[144:147], a[20:23]
    v_cvt_pk_bf16_f32 v143, v26, v27
    v_mfma_f32_16x16x32_bf16 a[52:55], a[244:247], v[148:151], a[52:55]
    v_mfma_f32_16x16x32_bf16 a[84:87], a[244:247], v[152:155], a[84:87]
    v_mfma_f32_16x16x32_bf16 v[40:43], v[44:47], v[140:143], 0
    s_nop 2
    v_mfma_f32_16x16x32_bf16 a[116:119], a[244:247], v[156:159], a[116:119]
    s_nop 2
    v_mfma_f32_16x16x32_bf16 a[24:27], a[248:251], v[144:147], a[24:27]
    v_max3_f32 v8, v28, v32, v36
    v_max_f32 v8, v8, v40
    v_mfma_f32_16x16x32_bf16 a[56:59], a[248:251], v[148:151], a[56:59]
    v_cmp_nge_f32 vcc, s66, v8
    v_mfma_f32_16x16x32_bf16 a[88:91], a[248:251], v[152:155], a[88:91]
    v_mfma_f32_16x16x32_bf16 a[120:123], a[248:251], v[156:159], a[120:123]
    ds_read_b128 a[208:211], v6 offset:4096
    v_mfma_f32_16x16x32_bf16 a[28:31], a[252:255], v[144:147], a[28:31]
    ds_read_b128 a[212:215], v6 offset:5120
    v_mfma_f32_16x16x32_bf16 a[60:63], a[252:255], v[148:151], a[60:63]
    ds_read_b128 a[216:219], v6 offset:6144
    v_mfma_f32_16x16x32_bf16 a[92:95], a[252:255], v[152:155], a[92:95]
    ds_read_b128 a[220:223], v6 offset:7168
    v_mfma_f32_16x16x32_bf16 a[124:127], a[252:255], v[156:159], a[124:127]
    s_waitcnt lgkmcnt(4)
    s_cbranch_vccz m_dual74
    v_cmp_lt_f32 vcc, s65, v8
    s_cmp_lg_u32 s64, s67
    s_cbranch_scc1 m_e78
    v_add_f32 v176, v176, v16
    v_mov_b32 v180, v9
    v_add_f32 v188, v188, v16
    v_add_f32 v177, v177, v17
    v_mov_b32 v181, v9
    v_add_f32 v189, v189, v17
    v_add_f32 v178, v178, v18
    v_mov_b32 v182, v9
    v_add_f32 v190, v190, v18
    v_add_f32 v179, v179, v19
    v_mov_b32 v183, v9
    v_add_f32 v191, v191, v19
    s_nop 0
m_e78:
    s_cmp_lg_u32 s64, s68
    s_cbranch_scc1 m_e79
    v_mov_b32 v176, v9
    v_mov_b32 v184, v9
    v_mov_b32 v188, v9
    v_mov_b32 v177, v9
    v_mov_b32 v185, v9
    v_mov_b32 v189, v9
    v_mov_b32 v178, v9
    v_mov_b32 v186, v9
    v_mov_b32 v190, v9
    v_mov_b32 v179, v9
    v_mov_b32 v187, v9
    v_mov_b32 v191, v9
    s_nop 0
m_e79:
    s_cmp_lg_u32 s64, s70
    s_cbranch_scc1 m_e80
    v_add_f32 v160, v160, v16
    v_mov_b32 v164, v9
    v_add_f32 v172, v172, v16
    v_add_f32 v161, v161, v17
    v_mov_b32 v165, v9
    v_add_f32 v173, v173, v17
    v_add_f32 v162, v162, v18
    v_mov_b32 v166, v9
    v_add_f32 v174, v174, v18
    v_add_f32 v163, v163, v19
    v_mov_b32 v167, v9
    v_add_f32 v175, v175, v19
    s_nop 0
m_e80:
    s_cmp_lg_u32 s64, s53
    s_cbranch_scc1 m_e83
    s_cmp_lg_u32 s16, 0
    s_cbranch_scc1 m_np84
    v_mov_b32 v60, s4
    v_mov_b32 v61, s5
    s_add_u32 s90, s17, 117440512
    s_mov_b64 exec, 1
    buffer_store_dwordx2 v[60:61], off, s[8:11], s90 sc1
    s_mov_b64 exec, -1
m_np84:
    s_mov_b32 s17, -1
m_e83:
    s_cmp_gt_u32 s64, 26
    s_cbranch_scc1 m_e81
    s_cmp_lg_u32 s64, 6
    s_cbranch_scc1 m_e85
    s_lshr_b32 s90, s32, 1
    s_lshl_b32 s90, s90, 7
    s_add_u32 s90, s90, 117440600
    v_min_u32 v0, 1, v1
    v_lshlrev_b32 v0, 5, v0
    buffer_load_dwordx2 v[4:5], v0, s[8:11], s90 offen sc1
    s_cmp_eq_u32 s17, -1
    s_cbranch_scc1 m_e81
    s_cmp_lg_u32 s16, 0
    s_cbranch_scc1 m_np86
    v_mov_b32 v60, s4
    v_mov_b32 v61, s5
    s_add_u32 s90, s17, 117440512
    s_mov_b64 exec, 1
    buffer_store_dwordx2 v[60:61], off, s[8:11], s90 sc1
    s_mov_b64 exec, -1
m_np86:
    s_branch m_e81
m_e85:
    s_cmp_lg_u32 s64, 18
    s_cbranch_scc1 m_e87
    s_waitcnt vmcnt(18)
    s_mov_b32 s3, 1048576
m_spin88:
    v_cmp_ne_u64 s[76:77], s[4:5], v[4:5]
    s_nop 3
    s_cmp_eq_u64 s[76:77], 0
    s_cbranch_scc1 m_e81
    s_sub_u32 s3, s3, 1
    s_cbranch_scc1 m_e81
    s_sleep 32
    s_lshr_b32 s90, s32, 1
    s_lshl_b32 s90, s90, 7
    s_add_u32 s90, s90, 117440600
    v_min_u32 v0, 1, v1
    v_lshlrev_b32 v0, 5, v0
    buffer_load_dwordx2 v[4:5], v0, s[8:11], s90 offen sc1
    s_waitcnt vmcnt(0)
    s_branch m_spin88
    s_branch m_e81
m_e87:
    s_cmp_lg_u32 s64, 22
    s_cbranch_scc1 m_e89
    buffer_load_dwordx2 v[4:5], v10, s[8:11], 0 offen sc1
    s_mov_b32 s44, s48
    s_mov_b32 s45, s49
    s_mov_b32 s46, 8388608
    s_lshl_b32 s90, s2, 2
    s_add_u32 s90, s90, s16
    s_lshl_b32 s90, s90, 13
    v_lshlrev_b32 v62, 7, v1
    buffer_load_dword v255, v62, s[44:47], s90 offen
    s_branch m_e81
m_e89:
    s_cmp_lg_u32 s64, 26
    s_cbranch_scc1 m_e90
    s_mov_b32 s44, s50
    s_mov_b32 s45, s51
    s_mov_b32 s46, 2097152
    s_lshl_b32 s90, s2, 2
    s_add_u32 s90, s90, s16
    s_lshl_b32 s90, s90, 13
    v_lshlrev_b32 v62, 7, v1
    buffer_load_dword v255, v62, s[44:47], s90 offen
    s_waitcnt vmcnt(18)
    s_mov_b32 s3, 1048576
m_spin91:
    v_cmp_ne_u64 s[76:77], s[4:5], v[4:5]
    s_nop 3
    s_cmp_eq_u64 s[76:77], 0
    s_cbranch_scc1 m_e81
    s_sub_u32 s3, s3, 1
    s_cbranch_scc1 m_e81
    s_sleep 32
    buffer_load_dwordx2 v[4:5], v10, s[8:11], 0 offen sc1
    s_waitcnt vmcnt(0)
    s_branch m_spin91
    s_branch m_e81
m_e90:
m_e81:
    s_cbranch_vccnz m_rc92
m_sp77:
    s_cmp_lg_u32 s64, s69
    s_cbranch_scc1 m_dual74
    v_mfma_f32_16x16x32_bf16 v[64:67], a[192:195], a[128:131], v[160:163]
    s_bitcmp1_b64 s[62:63], s64
    s_cselect_b32 s66, -1.0, s65
    v_add_f32 v12, v12, v28
    v_mfma_f32_16x16x32_bf16 v[64:67], a[196:199], a[132:135], v[64:67]
    s_add_u32 s64, s64, 1
    ds_read_b128 a[224:227], v6 offset:16384
    v_exp_f32 v20, v96
    v_mfma_f32_16x16x32_bf16 v[64:67], a[200:203], a[136:139], v[64:67]
    s_mov_b32 m0, s59
    ds_read_b128 a[228:231], v6 offset:17408
    v_add_f32 v13, v13, v32
    v_mfma_f32_16x16x32_bf16 v[64:67], a[204:207], a[140:143], v[64:67]
    buffer_load_dwordx4 v7, s[24:27], s56 offen offset:0 sc1 lds
    v_mfma_f32_16x16x32_bf16 v[72:75], a[192:195], a[144:147], v[168:171]
    ds_read_b128 a[232:235], v6 offset:18432
    v_add_f32 v14, v14, v36
    v_mfma_f32_16x16x32_bf16 v[72:75], a[196:199], a[148:151], v[72:75]
    ds_read_b128 a[236:239], v6 offset:19456
    v_exp_f32 v21, v97
    v_mfma_f32_16x16x32_bf16 v[72:75], a[200:203], a[152:155], v[72:75]
    ds_read_b128 a[240:243], v6 offset:20480
    v_cvt_pk_bf16_f32 v144, v20, v21
    v_mfma_f32_16x16x32_bf16 v[72:75], a[204:207], a[156:159], v[72:75]
    s_waitcnt lgkmcnt(5)
    ds_read_b128 a[244:247], v6 offset:21504
    v_add_f32 v15, v15, v40
    v_mfma_f32_16x16x32_bf16 v[68:71], a[208:211], a[128:131], v[164:167]
    ds_read_b128 a[248:251], v6 offset:22528
    v_exp_f32 v22, v98
    v_mfma_f32_16x16x32_bf16 v[68:71], a[212:215], a[132:135], v[68:71]
    ds_read_b128 a[252:255], v6 offset:23552
    v_exp_f32 v23, v99
    v_mfma_f32_16x16x32_bf16 v[68:71], a[216:219], a[136:139], v[68:71]
    v_exp_f32 v24, v100
    v_mfma_f32_16x16x32_bf16 v[68:71], a[220:223], a[140:143], v[68:71]
    buffer_load_dwordx4 v7, s[24:27], s56 offen offset:1024 sc1 lds
    v_mfma_f32_16x16x32_bf16 v[76:79], a[208:211], a[144:147], v[172:175]
    v_cvt_pk_bf16_f32 v145, v22, v23
    v_exp_f32 v25, v101
    v_mfma_f32_16x16x32_bf16 v[76:79], a[212:215], a[148:151], v[76:79]
    v_exp_f32 v26, v102
    v_mfma_f32_16x16x32_bf16 v[76:79], a[216:219], a[152:155], v[76:79]
    v_cvt_pk_bf16_f32 v146, v24, v25
    v_exp_f32 v27, v103
    v_mfma_f32_16x16x32_bf16 v[76:79], a[220:223], a[156:159], v[76:79]
    s_waitcnt lgkmcnt(0)
    v_exp_f32 v20, v104
    v_mfma_f32_16x16x32_bf16 a[0:3], a[224:227], v[128:131], a[0:3]
    ds_read_b128 a[192:195], v6 offset:8192
    v_cvt_pk_bf16_f32 v147, v26, v27
    v_mfma_f32_16x16x32_bf16 a[32:35], a[224:227], v[132:135], a[32:35]
    v_exp_f32 v21, v105
    v_mfma_f32_16x16x32_bf16 v[28:31], v[44:47], v[144:147], 0
    v_exp_f32 v22, v106
    v_mfma_f32_16x16x32_bf16 a[64:67], a[224:227], v[136:139], a[64:67]
    v_cvt_pk_bf16_f32 v148, v20, v21
    v_exp_f32 v23, v107
    v_mfma_f32_16x16x32_bf16 a[96:99], a[224:227], v[140:143], a[96:99]
    ds_read_b128 a[196:199], v6 offset:9216
    v_cvt_pk_bf16_f32 v149, v22, v23
    v_mfma_f32_16x16x32_bf16 a[4:7], a[228:231], v[128:131], a[4:7]
    v_exp_f32 v24, v108
    v_mfma_f32_16x16x32_bf16 a[36:39], a[228:231], v[132:135], a[36:39]
    buffer_load_dwordx4 v7, s[24:27], s56 offen offset:2048 sc1 lds
    v_mfma_f32_16x16x32_bf16 a[68:71], a[228:231], v[136:139], a[68:71]
    ds_read_b128 a[200:203], v6 offset:10240
    v_exp_f32 v25, v109
    v_mfma_f32_16x16x32_bf16 a[100:103], a[228:231], v[140:143], a[100:103]
    v_exp_f32 v26, v110
    v_mfma_f32_16x16x32_bf16 a[8:11], a[232:235], v[128:131], a[8:11]
    v_cvt_pk_bf16_f32 v150, v24, v25
    v_exp_f32 v27, v111
    v_mfma_f32_16x16x32_bf16 a[40:43], a[232:235], v[132:135], a[40:43]
    ds_read_b128 a[204:207], v6 offset:11264
    v_cvt_pk_bf16_f32 v151, v26, v27
    v_mfma_f32_16x16x32_bf16 a[72:75], a[232:235], v[136:139], a[72:75]
    v_exp_f32 v20, v112
    v_mfma_f32_16x16x32_bf16 v[32:35], v[44:47], v[148:151], 0
    v_exp_f32 v21, v113
    v_mfma_f32_16x16x32_bf16 a[104:107], a[232:235], v[140:143], a[104:107]
    v_exp_f32 v22, v114
    v_mfma_f32_16x16x32_bf16 a[12:15], a[236:239], v[128:131], a[12:15]
    v_cvt_pk_bf16_f32 v152, v20, v21
    v_exp_f32 v23, v115
    v_mfma_f32_16x16x32_bf16 a[44:47], a[236:239], v[132:135], a[44:47]
    v_exp_f32 v24, v116
    v_mfma_f32_16x16x32_bf16 a[76:79], a[236:239], v[136:139], a[76:79]
    v_cvt_pk_bf16_f32 v153, v22, v23
    v_exp_f32 v25, v117
    v_mfma_f32_16x16x32_bf16 a[108:111], a[236:239], v[140:143], a[108:111]
    buffer_load_dwordx4 v7, s[24:27], s56 offen offset:3072 sc1 lds
    v_mfma_f32_16x16x32_bf16 a[16:19], a[240:243], v[128:131], a[16:19]
    s_add_u32 s56, s56, 16384
    v_exp_f32 v26, v118
    v_mfma_f32_16x16x32_bf16 a[48:51], a[240:243], v[132:135], a[48:51]
    v_cvt_pk_bf16_f32 v154, v24, v25
    v_exp_f32 v27, v119
    v_mfma_f32_16x16x32_bf16 a[80:83], a[240:243], v[136:139], a[80:83]
    v_exp_f32 v20, v120
    v_mfma_f32_16x16x32_bf16 a[112:115], a[240:243], v[140:143], a[112:115]
    v_cvt_pk_bf16_f32 v155, v26, v27
    v_exp_f32 v21, v121
    v_mfma_f32_16x16x32_bf16 a[20:23], a[244:247], v[128:131], a[20:23]
    v_exp_f32 v22, v122
    v_mfma_f32_16x16x32_bf16 v[36:39], v[44:47], v[152:155], 0
    v_cvt_pk_bf16_f32 v156, v20, v21
    v_mfma_f32_16x16x32_bf16 a[52:55], a[244:247], v[132:135], a[52:55]
    v_exp_f32 v23, v123
    v_mfma_f32_16x16x32_bf16 a[84:87], a[244:247], v[136:139], a[84:87]
    v_exp_f32 v24, v124
    v_cvt_pk_bf16_f32 v157, v22, v23
    v_mfma_f32_16x16x32_bf16 a[116:119], a[244:247], v[140:143], a[116:119]
    v_exp_f32 v25, v125
    v_mfma_f32_16x16x32_bf16 a[24:27], a[248:251], v[128:131], a[24:27]
    s_add_u32 m0, s59, 16384
    v_exp_f32 v26, v126
    v_mfma_f32_16x16x32_bf16 a[56:59], a[248:251], v[132:135], a[56:59]
    buffer_load_dwordx4 v7, s[28:31], s57 offen offset:0 sc1 lds
    v_mfma_f32_16x16x32_bf16 a[88:91], a[248:251], v[136:139], a[88:91]
    v_cvt_pk_bf16_f32 v158, v24, v25
    v_exp_f32 v27, v127
    v_mfma_f32_16x16x32_bf16 a[120:123], a[248:251], v[140:143], a[120:123]
    ds_read_b128 a[208:211], v6 offset:12288
    v_cvt_pk_bf16_f32 v159, v26, v27
    s_nop 1
    v_mfma_f32_16x16x32_bf16 v[40:43], v[44:47], v[156:159], 0
    s_nop 2
    v_mfma_f32_16x16x32_bf16 a[28:31], a[252:255], v[128:131], a[28:31]
    ds_read_b128 a[212:215], v6 offset:13312
    s_nop 0
    v_mfma_f32_16x16x32_bf16 a[60:63], a[252:255], v[132:135], a[60:63]
    ds_read_b128 a[216:219], v6 offset:14336
    v_max3_f32 v8, v28, v32, v36
    v_mfma_f32_16x16x32_bf16 a[92:95], a[252:255], v[136:139], a[92:95]
    ds_read_b128 a[220:223], v6 offset:15360
    v_max_f32 v8, v8, v40
    v_cmp_nge_f32 vcc, s66, v8
    v_mfma_f32_16x16x32_bf16 a[124:127], a[252:255], v[140:143], a[124:127]
    s_waitcnt lgkmcnt(4)
    s_cbranch_vccnz m_stub93
m_ret94:
    v_mfma_f32_16x16x32_bf16 v[96:99], a[192:195], a[128:131], v[160:163]
    s_add_u32 s59, s58, s60
    v_exp_f32 v20, v64
    v_mfma_f32_16x16x32_bf16 v[96:99], a[196:199], a[132:135], v[96:99]
    s_add_u32 s58, s58, 32768
    ds_read_b128 a[224:227], v6 offset:24576
    v_add_f32 v12, v12, v28
    v_mfma_f32_16x16x32_bf16 v[96:99], a[200:203], a[136:139], v[96:99]
    s_and_b32 s58, s58, 0x1ffff
    ds_read_b128 a[228:231], v6 offset:25600
    v_add_f32 v13, v13, v32
    v_mfma_f32_16x16x32_bf16 v[96:99], a[204:207], a[140:143], v[96:99]
    buffer_load_dwordx4 v7, s[28:31], s57 offen offset:1024 sc1 lds
    v_mfma_f32_16x16x32_bf16 v[104:107], a[192:195], a[144:147], v[168:171]
    s_bitcmp1_b64 s[62:63], s64
    s_cselect_b32 s66, -1.0, s65
    ds_read_b128 a[232:235], v6 offset:26624
    v_mfma_f32_16x16x32_bf16 v[104:107], a[196:199], a[148:151], v[104:107]
    s_add_u32 s64, s64, 1
    ds_read_b128 a[236:239], v6 offset:27648
    v_mfma_f32_16x16x32_bf16 v[104:107], a[200:203], a[152:155], v[104:107]
    ds_read_b128 a[240:243], v6 offset:28672
    v_mfma_f32_16x16x32_bf16 v[104:107], a[204:207], a[156:159], v[104:107]
    s_waitcnt lgkmcnt(5)
    ds_read_b128 a[244:247], v6 offset:29696
    v_mfma_f32_16x16x32_bf16 v[100:103], a[208:211], a[128:131], v[164:167]
    buffer_load_dwordx4 v7, s[28:31], s57 offen offset:2048 sc1 lds
    v_mfma_f32_16x16x32_bf16 v[100:103], a[212:215], a[132:135], v[100:103]
    ds_read_b128 a[248:251], v6 offset:30720
    v_mfma_f32_16x16x32_bf16 v[100:103], a[216:219], a[136:139], v[100:103]
    ds_read_b128 a[252:255], v6 offset:31744
    v_mfma_f32_16x16x32_bf16 v[100:103], a[220:223], a[140:143], v[100:103]
    v_exp_f32 v21, v65
    v_mfma_f32_16x16x32_bf16 v[108:111], a[208:211], a[144:147], v[172:175]
    v_exp_f32 v22, v66
    v_mfma_f32_16x16x32_bf16 v[108:111], a[212:215], a[148:151], v[108:111]
    buffer_load_dwordx4 v7, s[28:31], s57 offen offset:3072 sc1 lds
    v_mfma_f32_16x16x32_bf16 v[108:111], a[216:219], a[152:155], v[108:111]
    s_add_u32 s57, s57, 16384
    v_cvt_pk_bf16_f32 v128, v20, v21
    v_mfma_f32_16x16x32_bf16 v[108:111], a[220:223], a[156:159], v[108:111]
    s_waitcnt vmcnt(16) lgkmcnt(0)
    v_add_u32 v6, s58, v2
    v_mfma_f32_16x16x32_bf16 a[0:3], a[224:227], v[144:147], a[0:3]
    s_barrier
    v_mfma_f32_16x16x32_bf16 a[32:35], a[224:227], v[148:151], a[32:35]
    ds_read_b128 a[192:195], v6 offset:0
    v_mfma_f32_16x16x32_bf16 a[64:67], a[224:227], v[152:155], a[64:67]
    v_exp_f32 v23, v67
    v_mfma_f32_16x16x32_bf16 a[96:99], a[224:227], v[156:159], a[96:99]
    v_exp_f32 v24, v68
    v_mfma_f32_16x16x32_bf16 a[4:7], a[228:231], v[144:147], a[4:7]
    ds_read_b128 a[196:199], v6 offset:1024
    v_cvt_pk_bf16_f32 v129, v22, v23
    v_mfma_f32_16x16x32_bf16 a[36:39], a[228:231], v[148:151], a[36:39]
    v_exp_f32 v25, v69
    v_mfma_f32_16x16x32_bf16 a[68:71], a[228:231], v[152:155], a[68:71]
    v_exp_f32 v26, v70
    v_mfma_f32_16x16x32_bf16 a[100:103], a[228:231], v[156:159], a[100:103]
    ds_read_b128 a[200:203], v6 offset:2048
    v_cvt_pk_bf16_f32 v130, v24, v25
    v_mfma_f32_16x16x32_bf16 a[8:11], a[232:235], v[144:147], a[8:11]
    v_exp_f32 v27, v71
    v_mfma_f32_16x16x32_bf16 a[40:43], a[232:235], v[148:151], a[40:43]
    v_exp_f32 v20, v72
    v_mfma_f32_16x16x32_bf16 a[72:75], a[232:235], v[152:155], a[72:75]
    ds_read_b128 a[204:207], v6 offset:3072
    v_cvt_pk_bf16_f32 v131, v26, v27
    v_mfma_f32_16x16x32_bf16 a[104:107], a[232:235], v[156:159], a[104:107]
    v_exp_f32 v21, v73
    v_mfma_f32_16x16x32_bf16 v[28:31], v[44:47], v[128:131], 0
    v_exp_f32 v22, v74
    v_mfma_f32_16x16x32_bf16 a[12:15], a[236:239], v[144:147], a[12:15]
    v_cvt_pk_bf16_f32 v132, v20, v21
    v_mfma_f32_16x16x32_bf16 a[44:47], a[236:239], v[148:151], a[44:47]
    v_exp_f32 v23, v75
    v_mfma_f32_16x16x32_bf16 a[76:79], a[236:239], v[152:155], a[76:79]
    v_exp_f32 v24, v76
    v_mfma_f32_16x16x32_bf16 a[108:111], a[236:239], v[156:159], a[108:111]
    v_cvt_pk_bf16_f32 v133, v22, v23
    v_mfma_f32_16x16x32_bf16 a[16:19], a[240:243], v[144:147], a[16:19]
    v_exp_f32 v25, v77
    v_mfma_f32_16x16x32_bf16 a[48:51], a[240:243], v[148:151], a[48:51]
    v_exp_f32 v26, v78
    v_mfma_f32_16x16x32_bf16 a[80:83], a[240:243], v[152:155], a[80:83]
    v_cvt_pk_bf16_f32 v134, v24, v25
    v_mfma_f32_16x16x32_bf16 a[112:115], a[240:243], v[156:159], a[112:115]
    v_exp_f32 v27, v79
    v_mfma_f32_16x16x32_bf16 a[20:23], a[244:247], v[144:147], a[20:23]
    v_cvt_pk_bf16_f32 v135, v26, v27
    v_mfma_f32_16x16x32_bf16 a[52:55], a[244:247], v[148:151], a[52:55]
    v_mfma_f32_16x16x32_bf16 a[84:87], a[244:247], v[152:155], a[84:87]
    v_mfma_f32_16x16x32_bf16 v[32:35], v[44:47], v[132:135], 0
    s_nop 2
    v_mfma_f32_16x16x32_bf16 a[116:119], a[244:247], v[156:159], a[116:119]
    s_nop 2
    v_mfma_f32_16x16x32_bf16 a[24:27], a[248:251], v[144:147], a[24:27]
    v_max_f32 v8, v28, v32
    v_cmp_nge_f32 vcc, s66, v8
    v_mfma_f32_16x16x32_bf16 a[56:59], a[248:251], v[148:151], a[56:59]
    v_mfma_f32_16x16x32_bf16 a[88:91], a[248:251], v[152:155], a[88:91]
    v_mfma_f32_16x16x32_bf16 a[120:123], a[248:251], v[156:159], a[120:123]
    ds_read_b128 a[208:211], v6 offset:4096
    v_mfma_f32_16x16x32_bf16 a[28:31], a[252:255], v[144:147], a[28:31]
    ds_read_b128 a[212:215], v6 offset:5120
    v_mfma_f32_16x16x32_bf16 a[60:63], a[252:255], v[148:151], a[60:63]
    ds_read_b128 a[216:219], v6 offset:6144
    v_mfma_f32_16x16x32_bf16 a[92:95], a[252:255], v[152:155], a[92:95]
    ds_read_b128 a[220:223], v6 offset:7168
    v_mfma_f32_16x16x32_bf16 a[124:127], a[252:255], v[156:159], a[124:127]
    s_waitcnt lgkmcnt(4)
    s_cbranch_vccnz m_stub95
m_ret96:
    v_add_f32 v20, v14, v36
    v_add_f32 v21, v15, v40
    s_nop 3
    v_rcp_f32 v20, v20
    v_rcp_f32 v21, v21
    s_lshl_b32 s90, s79, 10
    s_add_u32 s90, s90, s82
    s_add_u32 s90, s90, 67108864
    v_accvgpr_read_b32 v48, a64
    v_accvgpr_read_b32 v49, a65
    v_accvgpr_read_b32 v50, a66
    v_accvgpr_read_b32 v51, a67
    v_accvgpr_read_b32 v52, a68
    v_accvgpr_read_b32 v53, a69
    v_accvgpr_read_b32 v54, a70
    v_accvgpr_read_b32 v55, a71
    v_mul_f32 v48, v20, v48
    v_mul_f32 v49, v20, v49
    v_mul_f32 v50, v20, v50
    v_mul_f32 v51, v20, v51
    v_mul_f32 v52, v20, v52
    v_mul_f32 v53, v20, v53
    v_mul_f32 v54, v20, v54
    v_mul_f32 v55, v20, v55
    v_cvt_pk_bf16_f32 v48, v48, v49
    v_cvt_pk_bf16_f32 v49, v50, v51
    v_cvt_pk_bf16_f32 v50, v52, v53
    v_cvt_pk_bf16_f32 v51, v54, v55
    buffer_store_dwordx4 v[48:51], v2, s[8:11], s90 offen offset:0 sc1
    v_accvgpr_read_b32 v56, a96
    v_accvgpr_read_b32 v57, a97
    v_accvgpr_read_b32 v58, a98
    v_accvgpr_read_b32 v59, a99
    v_accvgpr_read_b32 v60, a100
    v_accvgpr_read_b32 v61, a101
    v_accvgpr_read_b32 v62, a102
    v_accvgpr_read_b32 v63, a103
    v_mul_f32 v56, v21, v56
    v_mul_f32 v57, v21, v57
    v_mul_f32 v58, v21, v58
    v_mul_f32 v59, v21, v59
    v_mul_f32 v60, v21, v60
    v_mul_f32 v61, v21, v61
    v_mul_f32 v62, v21, v62
    v_mul_f32 v63, v21, v63
    v_cvt_pk_bf16_f32 v56, v56, v57
    v_cvt_pk_bf16_f32 v57, v58, v59
    v_cvt_pk_bf16_f32 v58, v60, v61
    v_cvt_pk_bf16_f32 v59, v62, v63
    buffer_store_dwordx4 v[56:59], v2, s[8:11], s90 offen offset:1024 sc1
    s_add_u32 s90, s90, 131072
    v_accvgpr_read_b32 v48, a72
    v_accvgpr_read_b32 v49, a73
    v_accvgpr_read_b32 v50, a74
    v_accvgpr_read_b32 v51, a75
    v_accvgpr_read_b32 v52, a76
    v_accvgpr_read_b32 v53, a77
    v_accvgpr_read_b32 v54, a78
    v_accvgpr_read_b32 v55, a79
    v_mul_f32 v48, v20, v48
    v_mul_f32 v49, v20, v49
    v_mul_f32 v50, v20, v50
    v_mul_f32 v51, v20, v51
    v_mul_f32 v52, v20, v52
    v_mul_f32 v53, v20, v53
    v_mul_f32 v54, v20, v54
    v_mul_f32 v55, v20, v55
    v_cvt_pk_bf16_f32 v48, v48, v49
    v_cvt_pk_bf16_f32 v49, v50, v51
    v_cvt_pk_bf16_f32 v50, v52, v53
    v_cvt_pk_bf16_f32 v51, v54, v55
    buffer_store_dwordx4 v[48:51], v2, s[8:11], s90 offen offset:0 sc1
    v_accvgpr_read_b32 v56, a104
    v_accvgpr_read_b32 v57, a105
    v_accvgpr_read_b32 v58, a106
    v_accvgpr_read_b32 v59, a107
    v_accvgpr_read_b32 v60, a108
    v_accvgpr_read_b32 v61, a109
    v_accvgpr_read_b32 v62, a110
    v_accvgpr_read_b32 v63, a111
    v_mul_f32 v56, v21, v56
    v_mul_f32 v57, v21, v57
    v_mul_f32 v58, v21, v58
    v_mul_f32 v59, v21, v59
    v_mul_f32 v60, v21, v60
    v_mul_f32 v61, v21, v61
    v_mul_f32 v62, v21, v62
    v_mul_f32 v63, v21, v63
    v_cvt_pk_bf16_f32 v56, v56, v57
    v_cvt_pk_bf16_f32 v57, v58, v59
    v_cvt_pk_bf16_f32 v58, v60, v61
    v_cvt_pk_bf16_f32 v59, v62, v63
    buffer_store_dwordx4 v[56:59], v2, s[8:11], s90 offen offset:1024 sc1
    s_add_u32 s90, s90, 131072
    v_accvgpr_read_b32 v48, a80
    v_accvgpr_read_b32 v49, a81
    v_accvgpr_read_b32 v50, a82
    v_accvgpr_read_b32 v51, a83
    v_accvgpr_read_b32 v52, a84
    v_accvgpr_read_b32 v53, a85
    v_accvgpr_read_b32 v54, a86
    v_accvgpr_read_b32 v55, a87
    v_mul_f32 v48, v20, v48
    v_mul_f32 v49, v20, v49
    v_mul_f32 v50, v20, v50
    v_mul_f32 v51, v20, v51
    v_mul_f32 v52, v20, v52
    v_mul_f32 v53, v20, v53
    v_mul_f32 v54, v20, v54
    v_mul_f32 v55, v20, v55
    v_cvt_pk_bf16_f32 v48, v48, v49
    v_cvt_pk_bf16_f32 v49, v50, v51
    v_cvt_pk_bf16_f32 v50, v52, v53
    v_cvt_pk_bf16_f32 v51, v54, v55
    buffer_store_dwordx4 v[48:51], v2, s[8:11], s90 offen offset:0 sc1
    v_accvgpr_read_b32 v56, a112
    v_accvgpr_read_b32 v57, a113
    v_accvgpr_read_b32 v58, a114
    v_accvgpr_read_b32 v59, a115
    v_accvgpr_read_b32 v60, a116
    v_accvgpr_read_b32 v61, a117
    v_accvgpr_read_b32 v62, a118
    v_accvgpr_read_b32 v63, a119
    v_mul_f32 v56, v21, v56
    v_mul_f32 v57, v21, v57
    v_mul_f32 v58, v21, v58
    v_mul_f32 v59, v21, v59
    v_mul_f32 v60, v21, v60
    v_mul_f32 v61, v21, v61
    v_mul_f32 v62, v21, v62
    v_mul_f32 v63, v21, v63
    v_cvt_pk_bf16_f32 v56, v56, v57
    v_cvt_pk_bf16_f32 v57, v58, v59
    v_cvt_pk_bf16_f32 v58, v60, v61
    v_cvt_pk_bf16_f32 v59, v62, v63
    buffer_store_dwordx4 v[56:59], v2, s[8:11], s90 offen offset:1024 sc1
    s_add_u32 s90, s90, 131072
    v_accvgpr_read_b32 v48, a88
    v_accvgpr_read_b32 v49, a89
    v_accvgpr_read_b32 v50, a90
    v_accvgpr_read_b32 v51, a91
    v_accvgpr_read_b32 v52, a92
    v_accvgpr_read_b32 v53, a93
    v_accvgpr_read_b32 v54, a94
    v_accvgpr_read_b32 v55, a95
    v_mul_f32 v48, v20, v48
    v_mul_f32 v49, v20, v49
    v_mul_f32 v50, v20, v50
    v_mul_f32 v51, v20, v51
    v_mul_f32 v52, v20, v52
    v_mul_f32 v53, v20, v53
    v_mul_f32 v54, v20, v54
    v_mul_f32 v55, v20, v55
    v_cvt_pk_bf16_f32 v48, v48, v49
    v_cvt_pk_bf16_f32 v49, v50, v51
    v_cvt_pk_bf16_f32 v50, v52, v53
    v_cvt_pk_bf16_f32 v51, v54, v55
    buffer_store_dwordx4 v[48:51], v2, s[8:11], s90 offen offset:0 sc1
    v_accvgpr_read_b32 v56, a120
    v_accvgpr_read_b32 v57, a121
    v_accvgpr_read_b32 v58, a122
    v_accvgpr_read_b32 v59, a123
    v_accvgpr_read_b32 v60, a124
    v_accvgpr_read_b32 v61, a125
    v_accvgpr_read_b32 v62, a126
    v_accvgpr_read_b32 v63, a127
    v_mul_f32 v56, v21, v56
    v_mul_f32 v57, v21, v57
    v_mul_f32 v58, v21, v58
    v_mul_f32 v59, v21, v59
    v_mul_f32 v60, v21, v60
    v_mul_f32 v61, v21, v61
    v_mul_f32 v62, v21, v62
    v_mul_f32 v63, v21, v63
    v_cvt_pk_bf16_f32 v56, v56, v57
    v_cvt_pk_bf16_f32 v57, v58, v59
    v_cvt_pk_bf16_f32 v58, v60, v61
    v_cvt_pk_bf16_f32 v59, v62, v63
    buffer_store_dwordx4 v[56:59], v2, s[8:11], s90 offen offset:1024 sc1
    s_add_u32 s90, s90, 131072
    s_lshl_b32 s17, s34, 5
    s_add_u32 s17, s17, s32
    s_lshl_b32 s17, s17, 3
    s_add_u32 s17, s17, 7936
m_single97:
    v_mfma_f32_16x16x32_bf16 v[64:67], a[192:195], a[128:131], v[160:163]
    s_bitcmp1_b64 s[62:63], s64
    s_cselect_b32 s66, -1.0, s65
    v_add_f32 v12, v12, v28
    v_mfma_f32_16x16x32_bf16 v[64:67], a[196:199], a[132:135], v[64:67]
    s_mov_b32 m0, s59
    ds_read_b128 a[224:227], v6 offset:16384
    v_add_f32 v13, v13, v32
    v_mfma_f32_16x16x32_bf16 v[64:67], a[200:203], a[136:139], v[64:67]
    buffer_load_dwordx4 v7, s[24:27], s56 offen offset:0 sc1 lds
    v_mfma_f32_16x16x32_bf16 v[64:67], a[204:207], a[140:143], v[64:67]
    s_add_u32 s64, s64, 1
    ds_read_b128 a[228:231], v6 offset:17408
    v_exp_f32 v20, v96
    v_mfma_f32_16x16x32_bf16 v[72:75], a[192:195], a[144:147], v[168:171]
    ds_read_b128 a[232:235], v6 offset:18432
    v_exp_f32 v21, v97
    v_mfma_f32_16x16x32_bf16 v[72:75], a[196:199], a[148:151], v[72:75]
    ds_read_b128 a[236:239], v6 offset:19456
    v_cvt_pk_bf16_f32 v144, v20, v21
    v_mfma_f32_16x16x32_bf16 v[72:75], a[200:203], a[152:155], v[72:75]
    ds_read_b128 a[240:243], v6 offset:20480
    v_exp_f32 v22, v98
    v_mfma_f32_16x16x32_bf16 v[72:75], a[204:207], a[156:159], v[72:75]
    s_waitcnt lgkmcnt(5)
    ds_read_b128 a[244:247], v6 offset:21504
    v_mfma_f32_16x16x32_bf16 v[68:71], a[208:211], a[128:131], v[164:167]
    ds_read_b128 a[248:251], v6 offset:22528
    v_exp_f32 v23, v99
    v_mfma_f32_16x16x32_bf16 v[68:71], a[212:215], a[132:135], v[68:71]
    ds_read_b128 a[252:255], v6 offset:23552
    v_cvt_pk_bf16_f32 v145, v22, v23
    v_mfma_f32_16x16x32_bf16 v[68:71], a[216:219], a[136:139], v[68:71]
    buffer_load_dwordx4 v7, s[24:27], s56 offen offset:1024 sc1 lds
    v_mfma_f32_16x16x32_bf16 v[68:71], a[220:223], a[140:143], v[68:71]
    v_exp_f32 v24, v100
    v_mfma_f32_16x16x32_bf16 v[76:79], a[208:211], a[144:147], v[172:175]
    v_exp_f32 v25, v101
    v_mfma_f32_16x16x32_bf16 v[76:79], a[212:215], a[148:151], v[76:79]
    v_exp_f32 v26, v102
    v_mfma_f32_16x16x32_bf16 v[76:79], a[216:219], a[152:155], v[76:79]
    buffer_load_dwordx4 v7, s[24:27], s56 offen offset:2048 sc1 lds
    v_cvt_pk_bf16_f32 v146, v24, v25
    v_mfma_f32_16x16x32_bf16 v[76:79], a[220:223], a[156:159], v[76:79]
    s_waitcnt lgkmcnt(0)
    v_exp_f32 v27, v103
    v_mfma_f32_16x16x32_bf16 a[0:3], a[224:227], v[128:131], a[0:3]
    ds_read_b128 a[192:195], v6 offset:8192
    v_cvt_pk_bf16_f32 v147, v26, v27
    v_mfma_f32_16x16x32_bf16 a[32:35], a[224:227], v[132:135], a[32:35]
    v_exp_f32 v20, v104
    v_mfma_f32_16x16x32_bf16 v[28:31], v[44:47], v[144:147], 0
    v_exp_f32 v21, v105
    v_mfma_f32_16x16x32_bf16 a[4:7], a[228:231], v[128:131], a[4:7]
    ds_read_b128 a[196:199], v6 offset:9216
    v_exp_f32 v22, v106
    v_mfma_f32_16x16x32_bf16 a[36:39], a[228:231], v[132:135], a[36:39]
    buffer_load_dwordx4 v7, s[24:27], s56 offen offset:3072 sc1 lds
    v_mfma_f32_16x16x32_bf16 a[8:11], a[232:235], v[128:131], a[8:11]
    s_add_u32 s56, s56, 16384
    ds_read_b128 a[200:203], v6 offset:10240
    v_cvt_pk_bf16_f32 v148, v20, v21
    v_mfma_f32_16x16x32_bf16 a[40:43], a[232:235], v[132:135], a[40:43]
    v_exp_f32 v23, v107
    v_mfma_f32_16x16x32_bf16 a[12:15], a[236:239], v[128:131], a[12:15]
    ds_read_b128 a[204:207], v6 offset:11264
    v_exp_f32 v24, v108
    v_mfma_f32_16x16x32_bf16 a[44:47], a[236:239], v[132:135], a[44:47]
    v_cvt_pk_bf16_f32 v149, v22, v23
    v_exp_f32 v25, v109
    v_mfma_f32_16x16x32_bf16 a[16:19], a[240:243], v[128:131], a[16:19]
    v_exp_f32 v26, v110
    v_mfma_f32_16x16x32_bf16 a[48:51], a[240:243], v[132:135], a[48:51]
    v_cvt_pk_bf16_f32 v150, v24, v25
    v_exp_f32 v27, v111
    v_mfma_f32_16x16x32_bf16 a[20:23], a[244:247], v[128:131], a[20:23]
    ds_read_b128 a[208:211], v6 offset:12288
    v_cvt_pk_bf16_f32 v151, v26, v27
    v_mfma_f32_16x16x32_bf16 a[52:55], a[244:247], v[132:135], a[52:55]
    s_add_u32 m0, s59, 16384
    ds_read_b128 a[212:215], v6 offset:13312
    v_mfma_f32_16x16x32_bf16 v[32:35], v[44:47], v[148:151], 0
    s_nop 2
    v_mfma_f32_16x16x32_bf16 a[24:27], a[248:251], v[128:131], a[24:27]
    buffer_load_dwordx4 v7, s[28:31], s57 offen offset:0 sc1 lds
    v_mfma_f32_16x16x32_bf16 a[56:59], a[248:251], v[132:135], a[56:59]
    ds_read_b128 a[216:219], v6 offset:14336
    s_nop 0
    v_mfma_f32_16x16x32_bf16 a[28:31], a[252:255], v[128:131], a[28:31]
    ds_read_b128 a[220:223], v6 offset:15360
    v_max_f32 v8, v28, v32
    v_cmp_nge_f32 vcc, s66, v8
    v_mfma_f32_16x16x32_bf16 a[60:63], a[252:255], v[132:135], a[60:63]
    s_waitcnt lgkmcnt(4)
    s_cbranch_vccnz m_stub98
m_ret99:
    v_mfma_f32_16x16x32_bf16 v[96:99], a[192:195], a[128:131], v[160:163]
    s_add_u32 s59, s58, s60
    v_exp_f32 v20, v64
    v_mfma_f32_16x16x32_bf16 v[96:99], a[196:199], a[132:135], v[96:99]
    s_add_u32 s58, s58, 32768
    ds_read_b128 a[224:227], v6 offset:24576
    v_add_f32 v12, v12, v28
    v_mfma_f32_16x16x32_bf16 v[96:99], a[200:203], a[136:139], v[96:99]
    s_and_b32 s58, s58, 0x1ffff
    ds_read_b128 a[228:231], v6 offset:25600
    v_exp_f32 v21, v65
    v_mfma_f32_16x16x32_bf16 v[96:99], a[204:207], a[140:143], v[96:99]
    s_bitcmp1_b64 s[62:63], s64
    s_cselect_b32 s66, -1.0, s65
    ds_read_b128 a[232:235], v6 offset:26624
    v_mfma_f32_16x16x32_bf16 v[104:107], a[192:195], a[144:147], v[168:171]
    buffer_load_dwordx4 v7, s[28:31], s57 offen offset:1024 sc1 lds
    v_mfma_f32_16x16x32_bf16 v[104:107], a[196:199], a[148:151], v[104:107]
    s_add_u32 s64, s64, 1
    ds_read_b128 a[236:239], v6 offset:27648
    v_cvt_pk_bf16_f32 v128, v20, v21
    v_mfma_f32_16x16x32_bf16 v[104:107], a[200:203], a[152:155], v[104:107]
    ds_read_b128 a[240:243], v6 offset:28672
    v_exp_f32 v22, v66
    v_mfma_f32_16x16x32_bf16 v[104:107], a[204:207], a[156:159], v[104:107]
    s_waitcnt lgkmcnt(5)
    ds_read_b128 a[244:247], v6 offset:29696
    v_add_f32 v13, v13, v32
    v_mfma_f32_16x16x32_bf16 v[100:103], a[208:211], a[128:131], v[164:167]
    ds_read_b128 a[248:251], v6 offset:30720
    v_exp_f32 v23, v67
    v_mfma_f32_16x16x32_bf16 v[100:103], a[212:215], a[132:135], v[100:103]
    buffer_load_dwordx4 v7, s[28:31], s57 offen offset:2048 sc1 lds
    v_mfma_f32_16x16x32_bf16 v[100:103], a[216:219], a[136:139], v[100:103]
    ds_read_b128 a[252:255], v6 offset:31744
    v_cvt_pk_bf16_f32 v129, v22, v23
    v_mfma_f32_16x16x32_bf16 v[100:103], a[220:223], a[140:143], v[100:103]
    v_exp_f32 v24, v68
    v_mfma_f32_16x16x32_bf16 v[108:111], a[208:211], a[144:147], v[172:175]
    v_exp_f32 v25, v69
    v_mfma_f32_16x16x32_bf16 v[108:111], a[212:215], a[148:151], v[108:111]
    buffer_load_dwordx4 v7, s[28:31], s57 offen offset:3072 sc1 lds
    v_mfma_f32_16x16x32_bf16 v[108:111], a[216:219], a[152:155], v[108:111]
    s_add_u32 s57, s57, 16384
    v_exp_f32 v26, v70
    v_cvt_pk_bf16_f32 v130, v24, v25
    v_mfma_f32_16x16x32_bf16 v[108:111], a[220:223], a[156:159], v[108:111]
    s_waitcnt vmcnt(16) lgkmcnt(0)
    v_add_u32 v6, s58, v2
    v_exp_f32 v27, v71
    v_mfma_f32_16x16x32_bf16 a[0:3], a[224:227], v[144:147], a[0:3]
    s_barrier
    v_mfma_f32_16x16x32_bf16 a[32:35], a[224:227], v[148:151], a[32:35]
    ds_read_b128 a[192:195], v6 offset:0
    v_cvt_pk_bf16_f32 v131, v26, v27
    v_mfma_f32_16x16x32_bf16 a[4:7], a[228:231], v[144:147], a[4:7]
    v_exp_f32 v20, v72
    v_mfma_f32_16x16x32_bf16 v[28:31], v[44:47], v[128:131], 0
    v_exp_f32 v21, v73
    v_mfma_f32_16x16x32_bf16 a[36:39], a[228:231], v[148:151], a[36:39]
    ds_read_b128 a[196:199], v6 offset:1024
    v_cvt_pk_bf16_f32 v132, v20, v21
    v_mfma_f32_16x16x32_bf16 a[8:11], a[232:235], v[144:147], a[8:11]
    v_exp_f32 v22, v74
    v_mfma_f32_16x16x32_bf16 a[40:43], a[232:235], v[148:151], a[40:43]
    ds_read_b128 a[200:203], v6 offset:2048
    v_exp_f32 v23, v75
    v_mfma_f32_16x16x32_bf16 a[12:15], a[236:239], v[144:147], a[12:15]
    v_exp_f32 v24, v76
    v_mfma_f32_16x16x32_bf16 a[44:47], a[236:239], v[148:151], a[44:47]
    ds_read_b128 a[204:207], v6 offset:3072
    v_cvt_pk_bf16_f32 v133, v22, v23
    v_mfma_f32_16x16x32_bf16 a[16:19], a[240:243], v[144:147], a[16:19]
    v_exp_f32 v25, v77
    v_mfma_f32_16x16x32_bf16 a[48:51], a[240:243], v[148:151], a[48:51]
    v_exp_f32 v26, v78
    v_cvt_pk_bf16_f32 v134, v24, v25
    v_mfma_f32_16x16x32_bf16 a[20:23], a[244:247], v[144:147], a[20:23]
    v_exp_f32 v27, v79
    v_mfma_f32_16x16x32_bf16 a[52:55], a[244:247], v[148:151], a[52:55]
    ds_read_b128 a[208:211], v6 offset:4096
    v_cvt_pk_bf16_f32 v135, v26, v27
    s_nop 1
    v_mfma_f32_16x16x32_bf16 v[32:35], v[44:47], v[132:135], 0
    s_nop 2
    v_mfma_f32_16x16x32_bf16 a[24:27], a[248:251], v[144:147], a[24:27]
    ds_read_b128 a[212:215], v6 offset:5120
    s_nop 0
    v_mfma_f32_16x16x32_bf16 a[56:59], a[248:251], v[148:151], a[56:59]
    ds_read_b128 a[216:219], v6 offset:6144
    v_max_f32 v8, v28, v32
    v_mfma_f32_16x16x32_bf16 a[28:31], a[252:255], v[144:147], a[28:31]
    ds_read_b128 a[220:223], v6 offset:7168
    v_cmp_nge_f32 vcc, s66, v8
    v_mfma_f32_16x16x32_bf16 a[60:63], a[252:255], v[148:151], a[60:63]
    s_waitcnt lgkmcnt(4)
    s_cbranch_vccz m_single97
    v_cmp_lt_f32 vcc, s65, v8
    s_cmp_lg_u32 s64, s70
    s_cbranch_scc1 m_e101
    v_add_f32 v160, v160, v16
    v_mov_b32 v164, v9
    v_add_f32 v172, v172, v16
    v_add_f32 v161, v161, v17
    v_mov_b32 v165, v9
    v_add_f32 v173, v173, v17
    v_add_f32 v162, v162, v18
    v_mov_b32 v166, v9
    v_add_f32 v174, v174, v18
    v_add_f32 v163, v163, v19
    v_mov_b32 v167, v9
    v_add_f32 v175, v175, v19
    s_nop 0
m_e101:
    s_cmp_lg_u32 s64, s71
    s_cbranch_scc1 m_e102
    v_mov_b32 v160, v9
    v_mov_b32 v168, v9
    v_mov_b32 v172, v9
    v_mov_b32 v161, v9
    v_mov_b32 v169, v9
    v_mov_b32 v173, v9
    v_mov_b32 v162, v9
    v_mov_b32 v170, v9
    v_mov_b32 v174, v9
    v_mov_b32 v163, v9
    v_mov_b32 v171, v9
    v_mov_b32 v175, v9
    s_nop 0
m_e102:
    s_cmp_lg_u32 s64, s53
    s_cbranch_scc1 m_e105
    s_cmp_lg_u32 s16, 0
    s_cbranch_scc1 m_np106
    v_mov_b32 v60, s4
    v_mov_b32 v61, s5
    s_add_u32 s90, s17, 117440512
    s_mov_b64 exec, 1
    buffer_store_dwordx2 v[60:61], off, s[8:11], s90 sc1
    s_mov_b64 exec, -1
m_np106:
    s_mov_b32 s17, -1
m_e105:
    s_cmp_gt_u32 s64, 26
    s_cbranch_scc1 m_e103
    s_cmp_lg_u32 s64, 6
    s_cbranch_scc1 m_e107
    s_lshr_b32 s90, s32, 1
    s_lshl_b32 s90, s90, 7
    s_add_u32 s90, s90, 117440600
    v_min_u32 v0, 1, v1
    v_lshlrev_b32 v0, 5, v0
    buffer_load_dwordx2 v[4:5], v0, s[8:11], s90 offen sc1
    s_cmp_eq_u32 s17, -1
    s_cbranch_scc1 m_e103
    s_cmp_lg_u32 s16, 0
    s_cbranch_scc1 m_np108
    v_mov_b32 v60, s4
    v_mov_b32 v61, s5
    s_add_u32 s90, s17, 117440512
    s_mov_b64 exec, 1
    buffer_store_dwordx2 v[60:61], off, s[8:11], s90 sc1
    s_mov_b64 exec, -1
m_np108:
    s_branch m_e103
m_e107:
    s_cmp_lg_u32 s64, 18
    s_cbranch_scc1 m_e109
    s_waitcnt vmcnt(18)
    s_mov_b32 s3, 1048576
m_spin110:
    v_cmp_ne_u64 s[76:77], s[4:5], v[4:5]
    s_nop 3
    s_cmp_eq_u64 s[76:77], 0
    s_cbranch_scc1 m_e103
    s_sub_u32 s3, s3, 1
    s_cbranch_scc1 m_e103
    s_sleep 32
    s_lshr_b32 s90, s32, 1
    s_lshl_b32 s90, s90, 7
    s_add_u32 s90, s90, 117440600
    v_min_u32 v0, 1, v1
    v_lshlrev_b32 v0, 5, v0
    buffer_load_dwordx2 v[4:5], v0, s[8:11], s90 offen sc1
    s_waitcnt vmcnt(0)
    s_branch m_spin110
    s_branch m_e103
m_e109:
    s_cmp_lg_u32 s64, 22
    s_cbranch_scc1 m_e111
    buffer_load_dwordx2 v[4:5], v10, s[8:11], 0 offen sc1
    s_mov_b32 s44, s48
    s_mov_b32 s45, s49
    s_mov_b32 s46, 8388608
    s_lshl_b32 s90, s2, 2
    s_add_u32 s90, s90, s16
    s_lshl_b32 s90, s90, 13
    v_lshlrev_b32 v62, 7, v1
    buffer_load_dword v255, v62, s[44:47], s90 offen
    s_branch m_e103
m_e111:
    s_cmp_lg_u32 s64, 26
    s_cbranch_scc1 m_e112
    s_mov_b32 s44, s50
    s_mov_b32 s45, s51
    s_mov_b32 s46, 2097152
    s_lshl_b32 s90, s2, 2
    s_add_u32 s90, s90, s16
    s_lshl_b32 s90, s90, 13
    v_lshlrev_b32 v62, 7, v1
    buffer_load_dword v255, v62, s[44:47], s90 offen
    s_waitcnt vmcnt(18)
    s_mov_b32 s3, 1048576
m_spin113:
    v_cmp_ne_u64 s[76:77], s[4:5], v[4:5]
    s_nop 3
    s_cmp_eq_u64 s[76:77], 0
    s_cbranch_scc1 m_e103
    s_sub_u32 s3, s3, 1
    s_cbranch_scc1 m_e103
    s_sleep 32
    buffer_load_dwordx2 v[4:5], v10, s[8:11], 0 offen sc1
    s_waitcnt vmcnt(0)
    s_branch m_spin113
    s_branch m_e103
m_e112:
m_e103:
    s_cbranch_vccnz m_rc114
m_sp100:
    s_cmp_lg_u32 s64, s72
    s_cbranch_scc1 m_single97
    s_bfe_u32 s95, s2, 0x10002
    s_and_b32 s90, s2, 7
    s_bitcmp1_b32 0x63, s90
    s_cselect_b32 s96, s33, s34
    s_sub_u32 s96, s96, 1
    s_and_b32 s90, s2, 1
    s_lshl_b32 s90, s90, 2
    s_bfe_u32 s91, s2, 0x20003
    s_add_u32 s97, s90, s91
    v_and_b32 v10, 31, v1
    v_lshlrev_b32 v10, 3, v10
    s_lshl_b32 s52, s96, 8
    s_add_u32 s52, s52, 117448704
    buffer_load_dwordx2 v[4:5], v10, s[8:11], s52 offen sc1
    ds_read_b128 a[224:227], v6 offset:16384
    ds_read_b128 a[228:231], v6 offset:17408
    ds_read_b128 a[232:235], v6 offset:18432
    ds_read_b128 a[236:239], v6 offset:19456
    ds_read_b128 a[240:243], v6 offset:20480
    ds_read_b128 a[244:247], v6 offset:21504
    ds_read_b128 a[248:251], v6 offset:22528
    ds_read_b128 a[252:255], v6 offset:23552
    s_waitcnt lgkmcnt(0)
    v_mfma_f32_16x16x32_bf16 a[0:3], a[224:227], v[128:131], a[0:3]
    buffer_load_dwordx4 v[192:195], v2, s[8:11], s83 offen offset:0 sc1
    v_exp_f32 v20, v96
    v_mfma_f32_16x16x32_bf16 a[32:35], a[224:227], v[132:135], a[32:35]
    v_exp_f32 v21, v97
    v_exp_f32 v22, v98
    v_mfma_f32_16x16x32_bf16 a[4:7], a[228:231], v[128:131], a[4:7]
    buffer_load_dwordx4 v[196:199], v2, s[8:11], s83 offen offset:1024 sc1
    v_cvt_pk_bf16_f32 v144, v20, v21
    v_add_f32 v12, v12, v28
    v_mfma_f32_16x16x32_bf16 a[36:39], a[228:231], v[132:135], a[36:39]
    v_exp_f32 v23, v99
    v_exp_f32 v24, v100
    v_cvt_pk_bf16_f32 v145, v22, v23
    v_mfma_f32_16x16x32_bf16 a[8:11], a[232:235], v[128:131], a[8:11]
    buffer_load_dwordx4 v[200:203], v2, s[8:11], s83 offen offset:2048 sc1
    v_exp_f32 v25, v101
    v_mfma_f32_16x16x32_bf16 a[40:43], a[232:235], v[132:135], a[40:43]
    v_exp_f32 v26, v102
    v_cvt_pk_bf16_f32 v146, v24, v25
    v_add_f32 v13, v13, v32
    v_mfma_f32_16x16x32_bf16 a[12:15], a[236:239], v[128:131], a[12:15]
    buffer_load_dwordx4 v[204:207], v2, s[8:11], s83 offen offset:3072 sc1
    v_exp_f32 v27, v103
    v_mfma_f32_16x16x32_bf16 a[44:47], a[236:239], v[132:135], a[44:47]
    v_exp_f32 v20, v104
    v_cvt_pk_bf16_f32 v147, v26, v27
    v_mfma_f32_16x16x32_bf16 a[16:19], a[240:243], v[128:131], a[16:19]
    buffer_load_dwordx4 v[212:215], v2, s[8:11], s84 offen offset:0 sc1
    v_exp_f32 v21, v105
    v_mfma_f32_16x16x32_bf16 v[28:31], v[44:47], v[144:147], 0
    v_exp_f32 v22, v106
    v_cvt_pk_bf16_f32 v148, v20, v21
    v_exp_f32 v23, v107
    v_mfma_f32_16x16x32_bf16 a[48:51], a[240:243], v[132:135], a[48:51]
    v_exp_f32 v24, v108
    v_cvt_pk_bf16_f32 v149, v22, v23
    v_exp_f32 v25, v109
    v_mfma_f32_16x16x32_bf16 a[20:23], a[244:247], v[128:131], a[20:23]
    buffer_load_dwordx4 v[216:219], v2, s[8:11], s84 offen offset:1024 sc1
    v_exp_f32 v26, v110
    v_mfma_f32_16x16x32_bf16 a[52:55], a[244:247], v[132:135], a[52:55]
    v_cvt_pk_bf16_f32 v150, v24, v25
    v_exp_f32 v27, v111
    s_nop 0
    v_cvt_pk_bf16_f32 v151, v26, v27
    s_nop 1
    v_mfma_f32_16x16x32_bf16 v[32:35], v[44:47], v[148:151], 0
    s_nop 2
    v_mfma_f32_16x16x32_bf16 a[24:27], a[248:251], v[128:131], a[24:27]
    buffer_load_dwordx4 v[220:223], v2, s[8:11], s84 offen offset:2048 sc1
    v_mfma_f32_16x16x32_bf16 a[56:59], a[248:251], v[132:135], a[56:59]
    s_nop 2
    v_mfma_f32_16x16x32_bf16 a[28:31], a[252:255], v[128:131], a[28:31]
    v_max_f32 v8, v28, v32
    v_cmp_nge_f32 vcc, s65, v8
    v_mfma_f32_16x16x32_bf16 a[60:63], a[252:255], v[132:135], a[60:63]
    s_cbranch_vccnz m_stub115
m_ret116:
    s_nop 1
    ds_read_b128 a[224:227], v6 offset:24576
    ds_read_b128 a[228:231], v6 offset:25600
    ds_read_b128 a[232:235], v6 offset:26624
    ds_read_b128 a[236:239], v6 offset:27648
    ds_read_b128 a[240:243], v6 offset:28672
    ds_read_b128 a[244:247], v6 offset:29696
    ds_read_b128 a[248:251], v6 offset:30720
    ds_read_b128 a[252:255], v6 offset:31744
    s_waitcnt lgkmcnt(0)
    v_mfma_f32_16x16x32_bf16 a[0:3], a[224:227], v[144:147], a[0:3]
    buffer_load_dwordx4 v[224:227], v2, s[8:11], s84 offen offset:3072 sc1
    v_mfma_f32_16x16x32_bf16 a[32:35], a[224:227], v[148:151], a[32:35]
    v_mfma_f32_16x16x32_bf16 a[4:7], a[228:231], v[144:147], a[4:7]
    buffer_load_dwordx4 v[208:211], v2, s[8:11], s85 offen offset:0 sc1
    v_mfma_f32_16x16x32_bf16 a[36:39], a[228:231], v[148:151], a[36:39]
    v_mfma_f32_16x16x32_bf16 a[8:11], a[232:235], v[144:147], a[8:11]
    buffer_load_dwordx4 v[232:235], v2, s[8:11], s86 offen offset:0 sc1
    v_mfma_f32_16x16x32_bf16 a[40:43], a[232:235], v[148:151], a[40:43]
    v_mfma_f32_16x16x32_bf16 a[12:15], a[236:239], v[144:147], a[12:15]
    buffer_load_dwordx4 v[236:239], v2, s[8:11], s86 offen offset:1024 sc1
    v_mfma_f32_16x16x32_bf16 a[44:47], a[236:239], v[148:151], a[44:47]
    v_mfma_f32_16x16x32_bf16 a[16:19], a[240:243], v[144:147], a[16:19]
    buffer_load_dwordx4 v[228:231], v2, s[8:11], s87 offen offset:0 sc1
    v_mfma_f32_16x16x32_bf16 a[48:51], a[240:243], v[148:151], a[48:51]
    v_mfma_f32_16x16x32_bf16 a[20:23], a[244:247], v[144:147], a[20:23]
    buffer_load_dwordx4 v[244:247], v2, s[8:11], s88 offen offset:0 sc1
    v_mfma_f32_16x16x32_bf16 a[52:55], a[244:247], v[148:151], a[52:55]
    v_mfma_f32_16x16x32_bf16 a[24:27], a[248:251], v[144:147], a[24:27]
    buffer_load_dwordx4 v[248:251], v2, s[8:11], s88 offen offset:1024 sc1
    v_mfma_f32_16x16x32_bf16 a[56:59], a[248:251], v[148:151], a[56:59]
    v_mfma_f32_16x16x32_bf16 a[28:31], a[252:255], v[144:147], a[28:31]
    buffer_load_dwordx4 v[240:243], v2, s[8:11], s89 offen offset:0 sc1
    v_mfma_f32_16x16x32_bf16 a[60:63], a[252:255], v[148:151], a[60:63]
    s_barrier
    v_add_f32 v20, v12, v28
    v_add_f32 v21, v13, v32
    s_nop 3
    v_rcp_f32 v20, v20
    v_rcp_f32 v21, v21
    s_lshl_b32 s90, s78, 10
    s_add_u32 s90, s90, s82
    s_add_u32 s90, s90, 67108864
    v_accvgpr_read_b32 v48, a0
    v_accvgpr_read_b32 v49, a1
    v_accvgpr_read_b32 v50, a2
    v_accvgpr_read_b32 v51, a3
    v_accvgpr_read_b32 v52, a4
    v_accvgpr_read_b32 v53, a5
    v_accvgpr_read_b32 v54, a6
    v_accvgpr_read_b32 v55, a7
    v_mul_f32 v48, v20, v48
    v_mul_f32 v49, v20, v49
    v_mul_f32 v50, v20, v50
    v_mul_f32 v51, v20, v51
    v_mul_f32 v52, v20, v52
    v_mul_f32 v53, v20, v53
    v_mul_f32 v54, v20, v54
    v_mul_f32 v55, v20, v55
    v_cvt_pk_bf16_f32 v48, v48, v49
    v_cvt_pk_bf16_f32 v49, v50, v51
    v_cvt_pk_bf16_f32 v50, v52, v53
    v_cvt_pk_bf16_f32 v51, v54, v55
    buffer_store_dwordx4 v[48:51], v2, s[8:11], s90 offen offset:0 sc1
    v_accvgpr_read_b32 v56, a32
    v_accvgpr_read_b32 v57, a33
    v_accvgpr_read_b32 v58, a34
    v_accvgpr_read_b32 v59, a35
    v_accvgpr_read_b32 v60, a36
    v_accvgpr_read_b32 v61, a37
    v_accvgpr_read_b32 v62, a38
    v_accvgpr_read_b32 v63, a39
    v_mul_f32 v56, v21, v56
    v_mul_f32 v57, v21, v57
    v_mul_f32 v58, v21, v58
    v_mul_f32 v59, v21, v59
    v_mul_f32 v60, v21, v60
    v_mul_f32 v61, v21, v61
    v_mul_f32 v62, v21, v62
    v_mul_f32 v63, v21, v63
    v_cvt_pk_bf16_f32 v56, v56, v57
    v_cvt_pk_bf16_f32 v57, v58, v59
    v_cvt_pk_bf16_f32 v58, v60, v61
    v_cvt_pk_bf16_f32 v59, v62, v63
    buffer_store_dwordx4 v[56:59], v2, s[8:11], s90 offen offset:1024 sc1
    s_add_u32 s90, s90, 131072
    v_accvgpr_read_b32 v48, a8
    v_accvgpr_read_b32 v49, a9
    v_accvgpr_read_b32 v50, a10
    v_accvgpr_read_b32 v51, a11
    v_accvgpr_read_b32 v52, a12
    v_accvgpr_read_b32 v53, a13
    v_accvgpr_read_b32 v54, a14
    v_accvgpr_read_b32 v55, a15
    v_mul_f32 v48, v20, v48
    v_mul_f32 v49, v20, v49
    v_mul_f32 v50, v20, v50
    v_mul_f32 v51, v20, v51
    v_mul_f32 v52, v20, v52
    v_mul_f32 v53, v20, v53
    v_mul_f32 v54, v20, v54
    v_mul_f32 v55, v20, v55
    v_cvt_pk_bf16_f32 v48, v48, v49
    v_cvt_pk_bf16_f32 v49, v50, v51
    v_cvt_pk_bf16_f32 v50, v52, v53
    v_cvt_pk_bf16_f32 v51, v54, v55
    buffer_store_dwordx4 v[48:51], v2, s[8:11], s90 offen offset:0 sc1
    v_accvgpr_read_b32 v56, a40
    v_accvgpr_read_b32 v57, a41
    v_accvgpr_read_b32 v58, a42
    v_accvgpr_read_b32 v59, a43
    v_accvgpr_read_b32 v60, a44
    v_accvgpr_read_b32 v61, a45
    v_accvgpr_read_b32 v62, a46
    v_accvgpr_read_b32 v63, a47
    v_mul_f32 v56, v21, v56
    v_mul_f32 v57, v21, v57
    v_mul_f32 v58, v21, v58
    v_mul_f32 v59, v21, v59
    v_mul_f32 v60, v21, v60
    v_mul_f32 v61, v21, v61
    v_mul_f32 v62, v21, v62
    v_mul_f32 v63, v21, v63
    v_cvt_pk_bf16_f32 v56, v56, v57
    v_cvt_pk_bf16_f32 v57, v58, v59
    v_cvt_pk_bf16_f32 v58, v60, v61
    v_cvt_pk_bf16_f32 v59, v62, v63
    buffer_store_dwordx4 v[56:59], v2, s[8:11], s90 offen offset:1024 sc1
    s_add_u32 s90, s90, 131072
    v_accvgpr_read_b32 v48, a16
    v_accvgpr_read_b32 v49, a17
    v_accvgpr_read_b32 v50, a18
    v_accvgpr_read_b32 v51, a19
    v_accvgpr_read_b32 v52, a20
    v_accvgpr_read_b32 v53, a21
    v_accvgpr_read_b32 v54, a22
    v_accvgpr_read_b32 v55, a23
    v_mul_f32 v48, v20, v48
    v_mul_f32 v49, v20, v49
    v_mul_f32 v50, v20, v50
    v_mul_f32 v51, v20, v51
    v_mul_f32 v52, v20, v52
    v_mul_f32 v53, v20, v53
    v_mul_f32 v54, v20, v54
    v_mul_f32 v55, v20, v55
    v_cvt_pk_bf16_f32 v48, v48, v49
    v_cvt_pk_bf16_f32 v49, v50, v51
    v_cvt_pk_bf16_f32 v50, v52, v53
    v_cvt_pk_bf16_f32 v51, v54, v55
    buffer_store_dwordx4 v[48:51], v2, s[8:11], s90 offen offset:0 sc1
    v_accvgpr_read_b32 v56, a48
    v_accvgpr_read_b32 v57, a49
    v_accvgpr_read_b32 v58, a50
    v_accvgpr_read_b32 v59, a51
    v_accvgpr_read_b32 v60, a52
    v_accvgpr_read_b32 v61, a53
    v_accvgpr_read_b32 v62, a54
    v_accvgpr_read_b32 v63, a55
    v_mul_f32 v56, v21, v56
    v_mul_f32 v57, v21, v57
    v_mul_f32 v58, v21, v58
    v_mul_f32 v59, v21, v59
    v_mul_f32 v60, v21, v60
    v_mul_f32 v61, v21, v61
    v_mul_f32 v62, v21, v62
    v_mul_f32 v63, v21, v63
    v_cvt_pk_bf16_f32 v56, v56, v57
    v_cvt_pk_bf16_f32 v57, v58, v59
    v_cvt_pk_bf16_f32 v58, v60, v61
    v_cvt_pk_bf16_f32 v59, v62, v63
    buffer_store_dwordx4 v[56:59], v2, s[8:11], s90 offen offset:1024 sc1
    s_add_u32 s90, s90, 131072
    v_accvgpr_read_b32 v48, a24
    v_accvgpr_read_b32 v49, a25
    v_accvgpr_read_b32 v50, a26
    v_accvgpr_read_b32 v51, a27
    v_accvgpr_read_b32 v52, a28
    v_accvgpr_read_b32 v53, a29
    v_accvgpr_read_b32 v54, a30
    v_accvgpr_read_b32 v55, a31
    v_mul_f32 v48, v20, v48
    v_mul_f32 v49, v20, v49
    v_mul_f32 v50, v20, v50
    v_mul_f32 v51, v20, v51
    v_mul_f32 v52, v20, v52
    v_mul_f32 v53, v20, v53
    v_mul_f32 v54, v20, v54
    v_mul_f32 v55, v20, v55
    v_cvt_pk_bf16_f32 v48, v48, v49
    v_cvt_pk_bf16_f32 v49, v50, v51
    v_cvt_pk_bf16_f32 v50, v52, v53
    v_cvt_pk_bf16_f32 v51, v54, v55
    buffer_store_dwordx4 v[48:51], v2, s[8:11], s90 offen offset:0 sc1
    v_accvgpr_read_b32 v56, a56
    v_accvgpr_read_b32 v57, a57
    v_accvgpr_read_b32 v58, a58
    v_accvgpr_read_b32 v59, a59
    v_accvgpr_read_b32 v60, a60
    v_accvgpr_read_b32 v61, a61
    v_accvgpr_read_b32 v62, a62
    v_accvgpr_read_b32 v63, a63
    v_mul_f32 v56, v21, v56
    v_mul_f32 v57, v21, v57
    v_mul_f32 v58, v21, v58
    v_mul_f32 v59, v21, v59
    v_mul_f32 v60, v21, v60
    v_mul_f32 v61, v21, v61
    v_mul_f32 v62, v21, v62
    v_mul_f32 v63, v21, v63
    v_cvt_pk_bf16_f32 v56, v56, v57
    v_cvt_pk_bf16_f32 v57, v58, v59
    v_cvt_pk_bf16_f32 v58, v60, v61
    v_cvt_pk_bf16_f32 v59, v62, v63
    buffer_store_dwordx4 v[56:59], v2, s[8:11], s90 offen offset:1024 sc1
    s_add_u32 s90, s90, 131072
    s_lshr_b32 s53, s16, 1
    s_and_b32 s40, s16, 1
    s_mul_i32 s90, s95, 5242880
    s_lshl_b32 s57, s97, 8
    s_add_u32 s57, s57, s90
    v_lshrrev_b32 v20, 4, v1
    s_lshl_b32 s90, s16, 4
    v_add_u32 v21, s90, v20
    v_lshlrev_b32 v21, 11, v21
    v_lshlrev_b32 v20, 1, v20
    v_and_b32 v22, 15, v1
    v_xor_b32 v20, v20, v22
    v_xor_b32 v22, 0, v20
    v_lshl_add_u32 v16, v22, 4, v21
    v_xor_b32 v22, 8, v20
    v_lshl_add_u32 v17, v22, 4, v21
    v_add_u32 v17, 7168, v17
    v_xor_b32 v22, 0, v20
    v_lshl_add_u32 v18, v22, 4, v21
    v_add_u32 v18, 14336, v18
    v_xor_b32 v22, 8, v20
    v_lshl_add_u32 v19, v22, 4, v21
    v_add_u32 v19, 21504, v19
    s_mov_b32 s24, s48
    s_mov_b32 s25, s49
    s_mov_b32 s26, 8388608
    s_mov_b32 s38, 268435456
    s_mov_b32 s28, s54
    s_mov_b32 s29, s55
    s_mov_b32 s30, 8388608
    s_lshl_b32 s90, s96, 13
    s_lshl_b32 s91, s40, 12
    s_add_u32 s90, s90, s91
    s_lshl_b32 s91, s53, 17
    s_add_u32 s69, s90, s91
    s_mul_i32 s90, s95, 10485760
    s_add_u32 s56, s69, s90
    s_add_u32 s56, s56, 67108864
    s_add_u32 s69, s69, 83886080
    s_add_u32 m0, s60, 16384
    s_nop 0
    buffer_load_dwordx4 v16, s[24:27], s57 offen offset:0 lds
    buffer_load_dwordx4 v17, s[24:27], s57 offen offset:1024 lds
    buffer_load_dwordx4 v18, s[24:27], s57 offen offset:2048 lds
    buffer_load_dwordx4 v19, s[24:27], s57 offen offset:3072 lds
    s_add_u32 s57, s57, 131072
    s_add_u32 m0, s60, 49152
    s_nop 0
    buffer_load_dwordx4 v16, s[24:27], s57 offen offset:0 lds
    buffer_load_dwordx4 v17, s[24:27], s57 offen offset:1024 lds
    buffer_load_dwordx4 v18, s[24:27], s57 offen offset:2048 lds
    buffer_load_dwordx4 v19, s[24:27], s57 offen offset:3072 lds
    s_add_u32 s57, s57, 131072
    s_add_u32 m0, s60, 81920
    s_nop 0
    buffer_load_dwordx4 v16, s[24:27], s57 offen offset:0 lds
    buffer_load_dwordx4 v17, s[24:27], s57 offen offset:1024 lds
    buffer_load_dwordx4 v18, s[24:27], s57 offen offset:2048 lds
    buffer_load_dwordx4 v19, s[24:27], s57 offen offset:3072 lds
    s_add_u32 s57, s57, 131072
    s_add_u32 m0, s60, 114688
    s_nop 0
    buffer_load_dwordx4 v16, s[24:27], s57 offen offset:0 lds
    buffer_load_dwordx4 v17, s[24:27], s57 offen offset:1024 lds
    buffer_load_dwordx4 v18, s[24:27], s57 offen offset:2048 lds
    buffer_load_dwordx4 v19, s[24:27], s57 offen offset:3072 lds
    s_add_u32 s57, s57, 131072
    s_waitcnt vmcnt(39)
    v_cmp_ne_u64 s[76:77], s[4:5], v[4:5]
    s_mul_i32 s91, s95, 20
    s_nop 2
    s_lshr_b32 s90, s76, s91
    s_ff1_i32_b32 s90, s90
    s_lshl_b32 s68, s90, 1
    s_mul_i32 s91, s95, 0
    s_sub_i32 s68, s68, s91
    s_cmp_lt_i32 s90, 0
    s_cselect_b32 s68, 1000, s68
    s_mov_b32 s99, 0
    s_cmp_gt_i32 s68, 4
    s_cbranch_scc0 m_x1117
    s_mov_b32 s99, 1
    s_add_u32 m0, s60, 0
    s_nop 0
    buffer_load_dwordx4 v2, s[36:39], s56 offen offset:0 sc1 lds
    buffer_load_dwordx4 v2, s[36:39], s56 offen offset:1024 sc1 lds
    buffer_load_dwordx4 v2, s[36:39], s56 offen offset:2048 sc1 lds
    buffer_load_dwordx4 v2, s[36:39], s56 offen offset:3072 sc1 lds
    s_add_u32 s56, s56, 262144
    s_add_u32 m0, s60, 32768
    s_nop 0
    buffer_load_dwordx4 v2, s[36:39], s56 offen offset:0 sc1 lds
    buffer_load_dwordx4 v2, s[36:39], s56 offen offset:1024 sc1 lds
    buffer_load_dwordx4 v2, s[36:39], s56 offen offset:2048 sc1 lds
    buffer_load_dwordx4 v2, s[36:39], s56 offen offset:3072 sc1 lds
    s_add_u32 s56, s56, 262144
    s_add_u32 m0, s60, 65536
    s_nop 0
    buffer_load_dwordx4 v2, s[36:39], s56 offen offset:0 sc1 lds
    buffer_load_dwordx4 v2, s[36:39], s56 offen offset:1024 sc1 lds
    buffer_load_dwordx4 v2, s[36:39], s56 offen offset:2048 sc1 lds
    buffer_load_dwordx4 v2, s[36:39], s56 offen offset:3072 sc1 lds
    s_add_u32 s56, s56, 262144
    s_add_u32 m0, s60, 98304
    s_nop 0
    buffer_load_dwordx4 v2, s[36:39], s56 offen offset:0 sc1 lds
    buffer_load_dwordx4 v2, s[36:39], s56 offen offset:1024 sc1 lds
    buffer_load_dwordx4 v2, s[36:39], s56 offen offset:2048 sc1 lds
    buffer_load_dwordx4 v2, s[36:39], s56 offen offset:3072 sc1 lds
    s_add_u32 s56, s56, 262144
    s_add_u32 m0, s60, 131072
    s_nop 0
    buffer_load_dwordx4 v2, s[36:39], s56 offen offset:0 sc1 lds
    buffer_load_dwordx4 v2, s[36:39], s56 offen offset:1024 sc1 lds
    buffer_load_dwordx4 v2, s[36:39], s56 offen offset:2048 sc1 lds
    buffer_load_dwordx4 v2, s[36:39], s56 offen offset:3072 sc1 lds
    s_add_u32 s56, s56, 262144
m_x1117:
    s_lshl_b32 s90, s53, 12
    v_add_u32 v6, s90, v2
    v_lshrrev_b32 v48, 2, v1
    v_lshlrev_b32 v48, 8, v48
    v_and_b32 v49, 3, v1
    v_lshl_add_u32 v48, v49, 3, v48
    v_add_u32 v48, 16384, v48
    v_bfe_u32 v49, v1, 2, 3
    s_lshl_b32 s90, s40, 2
    v_xor_b32 v49, s90, v49
    v_xor_b32 v50, 0, v49
    v_lshl_add_u32 v12, v50, 5, v48
    v_xor_b32 v50, 1, v49
    v_lshl_add_u32 v13, v50, 5, v48
    v_xor_b32 v50, 2, v49
    v_lshl_add_u32 v14, v50, 5, v48
    v_xor_b32 v50, 3, v49
    v_lshl_add_u32 v15, v50, 5, v48
    v_and_b32 v48, 15, v1
    v_lshlrev_b32 v48, 12, v48
    v_lshlrev_b32 v48, s95, v48
    v_bfe_u32 v49, v1, 4, 1
    v_lshl_add_u32 v48, v49, 5, v48
    v_lshrrev_b32 v49, 5, v1
    v_lshl_add_u32 v7, v49, 4, v48
    s_lshl_b32 s90, s96, 3
    s_lshl_b32 s91, s53, 2
    s_add_u32 s90, s90, s91
    s_lshl_b32 s91, s90, 16
    s_add_u32 s91, s91, 2048
    s_and_b32 s92, s90, 63
    s_lshl_b32 s92, s92, 17
    s_lshr_b32 s93, s90, 6
    s_lshl_b32 s93, s93, 12
    s_add_u32 s92, s92, s93
    s_cmp_eq_u32 s95, 1
    s_cselect_b32 s71, s92, s91
    s_lshl_b32 s72, 0x10000, s95
    s_lshl_b32 s92, s97, 8
    s_lshl_b32 s93, s40, 7
    s_add_u32 s71, s71, s92
    s_add_u32 s71, s71, s93
    v_mov_b64 v[64:65], 0
    v_mov_b64 v[66:67], 0
    v_mov_b64 v[68:69], 0
    v_mov_b64 v[70:71], 0
    v_mov_b64 v[72:73], 0
    v_mov_b64 v[74:75], 0
    v_mov_b64 v[76:77], 0
    v_mov_b64 v[78:79], 0
    v_mov_b64 v[80:81], 0
    v_mov_b64 v[82:83], 0
    v_mov_b64 v[84:85], 0
    v_mov_b64 v[86:87], 0
    v_mov_b64 v[88:89], 0
    v_mov_b64 v[90:91], 0
    v_mov_b64 v[92:93], 0
    v_mov_b64 v[94:95], 0
    v_mov_b64 v[96:97], 0
    v_mov_b64 v[98:99], 0
    v_mov_b64 v[100:101], 0
    v_mov_b64 v[102:103], 0
    v_mov_b64 v[104:105], 0
    v_mov_b64 v[106:107], 0
    v_mov_b64 v[108:109], 0
    v_mov_b64 v[110:111], 0
    v_mov_b64 v[112:113], 0
    v_mov_b64 v[114:115], 0
    v_mov_b64 v[116:117], 0
    v_mov_b64 v[118:119], 0
    v_mov_b64 v[120:121], 0
    v_mov_b64 v[122:123], 0
    v_mov_b64 v[124:125], 0
    v_mov_b64 v[126:127], 0
    v_and_b32 v48, 15, v1
    v_lshrrev_b32 v49, 4, v1
    v_lshlrev_b32 v49, 2, v49
    v_sub_u32 v48, v48, v49
    v_cmp_ge_i32 vcc, -9, v48
    v_subrev_u32 v50, 0, v48
    v_cmp_ge_u32 s[76:77], 7, v50
    s_nop 0
    v_cndmask_b32 v128, v9, 0, vcc
    v_cndmask_b32 v132, v9, 0, s[76:77]
    v_cmp_ge_i32 vcc, -8, v48
    v_subrev_u32 v50, 1, v48
    v_cmp_ge_u32 s[76:77], 7, v50
    s_nop 0
    v_cndmask_b32 v129, v9, 0, vcc
    v_cndmask_b32 v133, v9, 0, s[76:77]
    v_cmp_ge_i32 vcc, -7, v48
    v_subrev_u32 v50, 2, v48
    v_cmp_ge_u32 s[76:77], 7, v50
    s_nop 0
    v_cndmask_b32 v130, v9, 0, vcc
    v_cndmask_b32 v134, v9, 0, s[76:77]
    v_cmp_ge_i32 vcc, -6, v48
    v_subrev_u32 v50, 3, v48
    v_cmp_ge_u32 s[76:77], 7, v50
    s_nop 0
    v_cndmask_b32 v131, v9, 0, vcc
    v_cndmask_b32 v135, v9, 0, s[76:77]
    s_cmp_eq_u32 s81, 0
    s_cselect_b64 vcc, -1, 0
    s_nop 0
    v_cndmask_b32 v136, v128, v9, vcc
    v_cndmask_b32 v137, v129, v9, vcc
    v_cndmask_b32 v138, v130, v9, vcc
    v_cndmask_b32 v139, v131, v9, vcc
    s_lshl_b32 s90, s80, 10
    s_lshr_b32 s91, s2, 3
    s_lshl_b32 s91, s91, 17
    s_add_u32 s90, s90, s91
    s_add_u32 s80, s90, 83886080
    s_add_u32 s59, s60, 131072
    s_mov_b32 s58, 0
    s_mov_b32 s100, 32768
    s_mov_b32 s64, 0
    s_mov_b32 s67, 0
    s_waitcnt vmcnt(36)
    s_cmp_eq_u32 s99, 1
    s_cbranch_scc1 m_x2118
    s_waitcnt vmcnt(16)
m_x2118:
    s_barrier
    s_lshl_b32 s91, s33, 5
    s_add_u32 s91, s91, s32
    s_lshl_b32 s91, s91, 3
    s_add_u32 s91, s91, 7936
    s_cmp_lg_u32 s16, 0
    s_cbranch_scc1 m_np120
    v_mov_b32 v60, s4
    v_mov_b32 v61, s5
    s_add_u32 s90, s91, 117440512
    s_mov_b64 exec, 1
    buffer_store_dwordx2 v[60:61], off, s[8:11], s90 sc1
    s_mov_b64 exec, -1
m_np120:
    s_cmp_eq_u32 s17, -1
    s_cbranch_scc1 m_pb121
    s_cmp_lg_u32 s16, 0
    s_cbranch_scc1 m_np122
    v_mov_b32 v60, s4
    v_mov_b32 v61, s5
    s_add_u32 s90, s17, 117440512
    s_mov_b64 exec, 1
    buffer_store_dwordx2 v[60:61], off, s[8:11], s90 sc1
    s_mov_b64 exec, -1
m_np122:
m_pb121:
    s_cmp_eq_u32 s99, 1
    s_cbranch_scc1 m_x3119
    s_mov_b32 s3, 1048576
m_spin124:
    buffer_load_dwordx2 v[4:5], v10, s[8:11], s52 offen sc1
    s_waitcnt vmcnt(0)
    v_cmp_ne_u64 s[76:77], s[4:5], v[4:5]
    s_mul_i32 s91, s95, 20
    s_nop 2
    s_lshr_b32 s90, s76, s91
    s_ff1_i32_b32 s90, s90
    s_lshl_b32 s68, s90, 1
    s_mul_i32 s91, s95, 0
    s_sub_i32 s68, s68, s91
    s_cmp_lt_i32 s90, 0
    s_cselect_b32 s68, 1000, s68
    s_cmp_gt_i32 s68, 4
    s_cbranch_scc1 m_ok125
    s_sub_u32 s3, s3, 1
    s_cbranch_scc1 m_ok125
    s_sleep 4
    s_branch m_spin124
m_ok125:
    s_add_u32 m0, s60, 0
    s_nop 0
    buffer_load_dwordx4 v2, s[36:39], s56 offen offset:0 sc1 lds
    buffer_load_dwordx4 v2, s[36:39], s56 offen offset:1024 sc1 lds
    buffer_load_dwordx4 v2, s[36:39], s56 offen offset:2048 sc1 lds
    buffer_load_dwordx4 v2, s[36:39], s56 offen offset:3072 sc1 lds
    s_add_u32 s56, s56, 262144
    s_add_u32 m0, s60, 32768
    s_nop 0
    buffer_load_dwordx4 v2, s[36:39], s56 offen offset:0 sc1 lds
    buffer_load_dwordx4 v2, s[36:39], s56 offen offset:1024 sc1 lds
    buffer_load_dwordx4 v2, s[36:39], s56 offen offset:2048 sc1 lds
    buffer_load_dwordx4 v2, s[36:39], s56 offen offset:3072 sc1 lds
    s_add_u32 s56, s56, 262144
    s_add_u32 m0, s60, 65536
    s_nop 0
    buffer_load_dwordx4 v2, s[36:39], s56 offen offset:0 sc1 lds
    buffer_load_dwordx4 v2, s[36:39], s56 offen offset:1024 sc1 lds
    buffer_load_dwordx4 v2, s[36:39], s56 offen offset:2048 sc1 lds
    buffer_load_dwordx4 v2, s[36:39], s56 offen offset:3072 sc1 lds
    s_add_u32 s56, s56, 262144
    s_add_u32 m0, s60, 98304
    s_nop 0
    buffer_load_dwordx4 v2, s[36:39], s56 offen offset:0 sc1 lds
    buffer_load_dwordx4 v2, s[36:39], s56 offen offset:1024 sc1 lds
    buffer_load_dwordx4 v2, s[36:39], s56 offen offset:2048 sc1 lds
    buffer_load_dwordx4 v2, s[36:39], s56 offen offset:3072 sc1 lds
    s_add_u32 s56, s56, 262144
    s_add_u32 m0, s60, 131072
    s_nop 0
    buffer_load_dwordx4 v2, s[36:39], s56 offen offset:0 sc1 lds
    buffer_load_dwordx4 v2, s[36:39], s56 offen offset:1024 sc1 lds
    buffer_load_dwordx4 v2, s[36:39], s56 offen offset:2048 sc1 lds
    buffer_load_dwordx4 v2, s[36:39], s56 offen offset:3072 sc1 lds
    s_add_u32 s56, s56, 262144
    s_waitcnt vmcnt(4)
    s_branch m_x4123
m_x3119:
    s_waitcnt vmcnt(4)
m_x4123:
    s_barrier
    ds_read_b128 a[0:3], v6 offset:0
    ds_read_b64_tr_b16 a[16:17], v12 offset:0
    ds_read_b64_tr_b16 a[18:19], v12 offset:4096
    ds_read_b128 a[4:7], v6 offset:1024
    ds_read_b128 a[8:11], v6 offset:2048
    ds_read_b128 a[12:15], v6 offset:3072
    ds_read_b64_tr_b16 a[20:21], v13 offset:0
    ds_read_b64_tr_b16 a[22:23], v13 offset:4096
    ds_read_b64_tr_b16 a[24:25], v14 offset:0
    ds_read_b64_tr_b16 a[26:27], v14 offset:4096
    ds_read_b64_tr_b16 a[28:29], v15 offset:0
    ds_read_b64_tr_b16 a[30:31], v15 offset:4096
    s_cmp_gt_i32 s68, 5
    s_cbranch_scc0 m_lp131
m_lr132:
    s_waitcnt lgkmcnt(9)
    v_mfma_f32_16x16x32_bf16 v[64:67], a[16:19], a[0:3], v[64:67]
    s_add_u32 m0, s59, 16384
    ds_read_b128 a[32:35], v6 offset:8192
    v_mfma_f32_16x16x32_bf16 v[148:151], v[208:211], v[192:195], v[136:139]
    v_mfma_f32_16x16x32_bf16 v[152:155], v[212:215], v[192:195], v[132:135]
    s_waitcnt lgkmcnt(9)
    v_mfma_f32_16x16x32_bf16 v[72:75], a[16:19], a[4:7], v[72:75]
    ds_read_b64_tr_b16 a[48:49], v12 offset:8192
    buffer_load_dwordx4 v16, s[24:27], s57 offen offset:0 lds
    v_mfma_f32_16x16x32_bf16 v[156:159], v[212:215], v[196:199], v[128:131]
    s_waitcnt lgkmcnt(9)
    v_mfma_f32_16x16x32_bf16 v[80:83], a[16:19], a[8:11], v[80:83]
    s_add_u32 s59, s58, s60
    ds_read_b64_tr_b16 a[50:51], v12 offset:12288
    v_mfma_f32_16x16x32_bf16 v[160:163], v[216:219], v[196:199], v[132:135]
    v_mfma_f32_16x16x32_bf16 v[164:167], v[216:219], v[200:203], v[128:131]
    s_waitcnt lgkmcnt(9)
    v_mfma_f32_16x16x32_bf16 v[88:91], a[16:19], a[12:15], v[88:91]
    s_add_u32 s58, s58, 32768
    ds_read_b128 a[36:39], v6 offset:9216
    v_mfma_f32_16x16x32_bf16 v[168:171], v[220:223], v[200:203], v[132:135]
    v_mfma_f32_16x16x32_bf16 v[172:175], v[220:223], v[204:207], v[128:131]
    s_waitcnt lgkmcnt(8)
    v_mfma_f32_16x16x32_bf16 v[68:71], a[20:23], a[0:3], v[68:71]
    s_cmp_ge_u32 s58, 163840
    ds_read_b128 a[40:43], v6 offset:10240
    v_mfma_f32_16x16x32_bf16 v[176:179], v[224:227], v[204:207], v[132:135]
    s_nop 1
    v_mfma_f32_16x16x32_bf16 v[76:79], a[20:23], a[4:7], v[76:79]
    ds_read_b128 a[44:47], v6 offset:11264
    buffer_load_dwordx4 v17, s[24:27], s57 offen offset:1024 lds
    s_nop 1
    v_mfma_f32_16x16x32_bf16 v[84:87], a[20:23], a[8:11], v[84:87]
    s_cselect_b32 s66, 4294836224, s100
    ds_read_b64_tr_b16 a[52:53], v13 offset:8192
    s_nop 1
    s_nop 1
    v_mfma_f32_16x16x32_bf16 v[92:95], a[20:23], a[12:15], v[92:95]
    s_cselect_b32 s58, 0, s58
    ds_read_b64_tr_b16 a[54:55], v13 offset:12288
    v_max3_f32 v140, v148, v149, v150
    v_max3_f32 v141, v156, v157, v158
    s_waitcnt lgkmcnt(10)
    v_mfma_f32_16x16x32_bf16 v[96:99], a[24:27], a[0:3], v[96:99]
    ds_read_b64_tr_b16 a[56:57], v14 offset:8192
    v_max3_f32 v142, v164, v165, v166
    v_max3_f32 v143, v172, v173, v174
    v_mfma_f32_16x16x32_bf16 v[104:107], a[24:27], a[4:7], v[104:107]
    ds_read_b64_tr_b16 a[58:59], v14 offset:12288
    buffer_load_dwordx4 v18, s[24:27], s57 offen offset:2048 lds
    v_max3_f32 v140, v140, v151, v152
    v_mfma_f32_16x16x32_bf16 v[112:115], a[24:27], a[8:11], v[112:115]
    ds_read_b64_tr_b16 a[60:61], v15 offset:8192
    v_max3_f32 v141, v141, v159, v160
    v_max3_f32 v142, v142, v167, v168
    v_mfma_f32_16x16x32_bf16 v[120:123], a[24:27], a[12:15], v[120:123]
    ds_read_b64_tr_b16 a[62:63], v15 offset:12288
    v_max3_f32 v143, v143, v175, v176
    v_max3_f32 v140, v140, v153, v154
    s_waitcnt lgkmcnt(12)
    v_mfma_f32_16x16x32_bf16 v[100:103], a[28:31], a[0:3], v[100:103]
    v_add_u32 v6, s66, v6
    v_add_u32 v12, s66, v12
    v_max3_f32 v141, v141, v161, v162
    v_mfma_f32_16x16x32_bf16 v[108:111], a[28:31], a[4:7], v[108:111]
    buffer_load_dwordx4 v19, s[24:27], s57 offen offset:3072 lds
    v_max3_f32 v142, v142, v169, v170
    v_mfma_f32_16x16x32_bf16 v[116:119], a[28:31], a[8:11], v[116:119]
    s_add_u32 s57, s57, 131072
    v_add_u32 v13, s66, v13
    v_add_u32 v14, s66, v14
    v_max3_f32 v143, v143, v177, v178
    v_mfma_f32_16x16x32_bf16 v[124:127], a[28:31], a[12:15], v[124:127]
    s_mov_b32 m0, s59
    v_add_u32 v15, s66, v15
    v_max_f32 v140, v140, v155
    s_waitcnt vmcnt(24) lgkmcnt(0)
    v_mfma_f32_16x16x32_bf16 v[64:67], a[48:51], a[32:35], v[64:67]
    s_barrier
    v_max_f32 v141, v141, v163
    v_max_f32 v142, v142, v171
    v_mfma_f32_16x16x32_bf16 v[72:75], a[48:51], a[36:39], v[72:75]
    ds_read_b128 a[0:3], v6 offset:0
    buffer_load_dwordx4 v2, s[36:39], s56 offen offset:0 sc1 lds
    v_max_f32 v143, v143, v179
    v_mfma_f32_16x16x32_bf16 v[80:83], a[48:51], a[40:43], v[80:83]
    ds_read_b64_tr_b16 a[16:17], v12 offset:0
    v_mov_b32 v144, v140
    v_mov_b32 v145, v141
    v_mfma_f32_16x16x32_bf16 v[88:91], a[48:51], a[44:47], v[88:91]
    ds_read_b64_tr_b16 a[18:19], v12 offset:4096
    v_mov_b32 v146, v142
    v_mov_b32 v147, v143
    v_mfma_f32_16x16x32_bf16 v[68:71], a[52:55], a[32:35], v[68:71]
    ds_read_b128 a[4:7], v6 offset:1024
    s_nop 1
    v_permlane32_swap_b32 v140, v144
    v_mfma_f32_16x16x32_bf16 v[76:79], a[52:55], a[36:39], v[76:79]
    ds_read_b128 a[8:11], v6 offset:2048
    buffer_load_dwordx4 v2, s[36:39], s56 offen offset:1024 sc1 lds
    v_permlane32_swap_b32 v141, v145
    v_mfma_f32_16x16x32_bf16 v[84:87], a[52:55], a[40:43], v[84:87]
    ds_read_b128 a[12:15], v6 offset:3072
    v_permlane32_swap_b32 v142, v146
    v_permlane32_swap_b32 v143, v147
    v_mfma_f32_16x16x32_bf16 v[92:95], a[52:55], a[44:47], v[92:95]
    ds_read_b64_tr_b16 a[20:21], v13 offset:0
    s_nop 1
    v_max_f32 v140, v140, v144
    v_mfma_f32_16x16x32_bf16 v[96:99], a[56:59], a[32:35], v[96:99]
    ds_read_b64_tr_b16 a[22:23], v13 offset:4096
    v_max_f32 v141, v141, v145
    v_max_f32 v142, v142, v146
    v_mfma_f32_16x16x32_bf16 v[104:107], a[56:59], a[36:39], v[104:107]
    ds_read_b64_tr_b16 a[24:25], v14 offset:0
    buffer_load_dwordx4 v2, s[36:39], s56 offen offset:2048 sc1 lds
    v_max_f32 v143, v143, v147
    v_mfma_f32_16x16x32_bf16 v[112:115], a[56:59], a[40:43], v[112:115]
    ds_read_b64_tr_b16 a[26:27], v14 offset:4096
    v_mov_b32 v144, v140
    v_mov_b32 v145, v141
    v_mfma_f32_16x16x32_bf16 v[120:123], a[56:59], a[44:47], v[120:123]
    ds_read_b64_tr_b16 a[28:29], v15 offset:0
    v_mov_b32 v146, v142
    v_mov_b32 v147, v143
    v_mfma_f32_16x16x32_bf16 v[100:103], a[60:63], a[32:35], v[100:103]
    s_add_u32 s64, s64, 1
    ds_read_b64_tr_b16 a[30:31], v15 offset:4096
    s_nop 1
    v_permlane16_swap_b32 v140, v144
    v_mfma_f32_16x16x32_bf16 v[108:111], a[60:63], a[36:39], v[108:111]
    buffer_load_dwordx4 v2, s[36:39], s56 offen offset:3072 sc1 lds
    v_permlane16_swap_b32 v141, v145
    v_mfma_f32_16x16x32_bf16 v[116:119], a[60:63], a[40:43], v[116:119]
    s_add_u32 s56, s56, 262144
    v_permlane16_swap_b32 v142, v146
    v_permlane16_swap_b32 v143, v147
    v_mfma_f32_16x16x32_bf16 v[124:127], a[60:63], a[44:47], v[124:127]
    s_nop 1
    v_max_f32 v140, v140, v144
    s_cmp_gt_i32 s68, 6
    s_cbranch_scc0 m_lp133
m_lr134:
    s_waitcnt lgkmcnt(9)
    v_mfma_f32_16x16x32_bf16 v[64:67], a[16:19], a[0:3], v[64:67]
    s_add_u32 m0, s59, 16384
    ds_read_b128 a[32:35], v6 offset:8192
    v_max_f32 v141, v141, v145
    v_max_f32 v142, v142, v146
    s_waitcnt lgkmcnt(9)
    v_mfma_f32_16x16x32_bf16 v[72:75], a[16:19], a[4:7], v[72:75]
    ds_read_b64_tr_b16 a[48:49], v12 offset:8192
    buffer_load_dwordx4 v16, s[24:27], s57 offen offset:0 lds
    v_max_f32 v143, v143, v147
    s_waitcnt lgkmcnt(9)
    v_mfma_f32_16x16x32_bf16 v[80:83], a[16:19], a[8:11], v[80:83]
    s_add_u32 s59, s58, s60
    ds_read_b64_tr_b16 a[50:51], v12 offset:12288
    v_sub_f32 v148, v148, v140
    v_sub_f32 v149, v149, v140
    s_waitcnt lgkmcnt(9)
    v_mfma_f32_16x16x32_bf16 v[88:91], a[16:19], a[12:15], v[88:91]
    s_add_u32 s58, s58, 32768
    ds_read_b128 a[36:39], v6 offset:9216
    v_sub_f32 v150, v150, v140
    v_sub_f32 v151, v151, v140
    s_waitcnt lgkmcnt(8)
    v_mfma_f32_16x16x32_bf16 v[68:71], a[20:23], a[0:3], v[68:71]
    s_cmp_ge_u32 s58, 163840
    ds_read_b128 a[40:43], v6 offset:10240
    v_sub_f32 v152, v152, v140
    v_sub_f32 v153, v153, v140
    v_mfma_f32_16x16x32_bf16 v[76:79], a[20:23], a[4:7], v[76:79]
    ds_read_b128 a[44:47], v6 offset:11264
    buffer_load_dwordx4 v17, s[24:27], s57 offen offset:1024 lds
    v_sub_f32 v154, v154, v140
    v_mfma_f32_16x16x32_bf16 v[84:87], a[20:23], a[8:11], v[84:87]
    s_cselect_b32 s66, 4294836224, s100
    ds_read_b64_tr_b16 a[52:53], v13 offset:8192
    v_sub_f32 v155, v155, v140
    v_sub_f32 v156, v156, v141
    v_mfma_f32_16x16x32_bf16 v[92:95], a[20:23], a[12:15], v[92:95]
    s_cselect_b32 s58, 0, s58
    ds_read_b64_tr_b16 a[54:55], v13 offset:12288
    v_sub_f32 v157, v157, v141
    v_sub_f32 v158, v158, v141
    s_waitcnt lgkmcnt(10)
    v_mfma_f32_16x16x32_bf16 v[96:99], a[24:27], a[0:3], v[96:99]
    ds_read_b64_tr_b16 a[56:57], v14 offset:8192
    v_sub_f32 v159, v159, v141
    v_sub_f32 v160, v160, v141
    v_mfma_f32_16x16x32_bf16 v[104:107], a[24:27], a[4:7], v[104:107]
    ds_read_b64_tr_b16 a[58:59], v14 offset:12288
    buffer_load_dwordx4 v18, s[24:27], s57 offen offset:2048 lds
    v_sub_f32 v161, v161, v141
    v_mfma_f32_16x16x32_bf16 v[112:115], a[24:27], a[8:11], v[112:115]
    ds_read_b64_tr_b16 a[60:61], v15 offset:8192
    v_sub_f32 v162, v162, v141
    v_sub_f32 v163, v163, v141
    v_mfma_f32_16x16x32_bf16 v[120:123], a[24:27], a[12:15], v[120:123]
    ds_read_b64_tr_b16 a[62:63], v15 offset:12288
    v_sub_f32 v164, v164, v142
    v_sub_f32 v165, v165, v142
    s_waitcnt lgkmcnt(12)
    v_mfma_f32_16x16x32_bf16 v[100:103], a[28:31], a[0:3], v[100:103]
    v_add_u32 v6, s66, v6
    v_add_u32 v12, s66, v12
    v_sub_f32 v166, v166, v142
    v_mfma_f32_16x16x32_bf16 v[108:111], a[28:31], a[4:7], v[108:111]
    buffer_load_dwordx4 v19, s[24:27], s57 offen offset:3072 lds
    v_sub_f32 v167, v167, v142
    v_mfma_f32_16x16x32_bf16 v[116:119], a[28:31], a[8:11], v[116:119]
    s_add_u32 s57, s57, 131072
    v_add_u32 v13, s66, v13
    v_add_u32 v14, s66, v14
    v_sub_f32 v168, v168, v142
    v_mfma_f32_16x16x32_bf16 v[124:127], a[28:31], a[12:15], v[124:127]
    s_mov_b32 m0, s59
    v_add_u32 v15, s66, v15
    v_sub_f32 v169, v169, v142
    s_waitcnt vmcnt(24) lgkmcnt(0)
    v_mfma_f32_16x16x32_bf16 v[64:67], a[48:51], a[32:35], v[64:67]
    s_barrier
    v_sub_f32 v170, v170, v142
    v_sub_f32 v171, v171, v142
    v_mfma_f32_16x16x32_bf16 v[72:75], a[48:51], a[36:39], v[72:75]
    ds_read_b128 a[0:3], v6 offset:0
    buffer_load_dwordx4 v2, s[36:39], s56 offen offset:0 sc1 lds
    v_sub_f32 v172, v172, v143
    v_mfma_f32_16x16x32_bf16 v[80:83], a[48:51], a[40:43], v[80:83]
    ds_read_b64_tr_b16 a[16:17], v12 offset:0
    v_sub_f32 v173, v173, v143
    v_sub_f32 v174, v174, v143
    v_mfma_f32_16x16x32_bf16 v[88:91], a[48:51], a[44:47], v[88:91]
    ds_read_b64_tr_b16 a[18:19], v12 offset:4096
    v_sub_f32 v175, v175, v143
    v_sub_f32 v176, v176, v143
    v_mfma_f32_16x16x32_bf16 v[68:71], a[52:55], a[32:35], v[68:71]
    ds_read_b128 a[4:7], v6 offset:1024
    v_sub_f32 v177, v177, v143
    v_sub_f32 v178, v178, v143
    v_mfma_f32_16x16x32_bf16 v[76:79], a[52:55], a[36:39], v[76:79]
    ds_read_b128 a[8:11], v6 offset:2048
    buffer_load_dwordx4 v2, s[36:39], s56 offen offset:1024 sc1 lds
    v_sub_f32 v179, v179, v143
    v_mfma_f32_16x16x32_bf16 v[84:87], a[52:55], a[40:43], v[84:87]
    ds_read_b128 a[12:15], v6 offset:3072
    v_exp_f32 v148, v148
    v_exp_f32 v149, v149
    v_mfma_f32_16x16x32_bf16 v[92:95], a[52:55], a[44:47], v[92:95]
    ds_read_b64_tr_b16 a[20:21], v13 offset:0
    v_exp_f32 v150, v150
    v_exp_f32 v151, v151
    v_mfma_f32_16x16x32_bf16 v[96:99], a[56:59], a[32:35], v[96:99]
    ds_read_b64_tr_b16 a[22:23], v13 offset:4096
    v_exp_f32 v152, v152
    v_exp_f32 v153, v153
    v_mfma_f32_16x16x32_bf16 v[104:107], a[56:59], a[36:39], v[104:107]
    ds_read_b64_tr_b16 a[24:25], v14 offset:0
    buffer_load_dwordx4 v2, s[36:39], s56 offen offset:2048 sc1 lds
    v_exp_f32 v154, v154
    v_mfma_f32_16x16x32_bf16 v[112:115], a[56:59], a[40:43], v[112:115]
    ds_read_b64_tr_b16 a[26:27], v14 offset:4096
    v_exp_f32 v155, v155
    v_exp_f32 v156, v156
    v_mfma_f32_16x16x32_bf16 v[120:123], a[56:59], a[44:47], v[120:123]
    ds_read_b64_tr_b16 a[28:29], v15 offset:0
    v_exp_f32 v157, v157
    v_exp_f32 v158, v158
    v_mfma_f32_16x16x32_bf16 v[100:103], a[60:63], a[32:35], v[100:103]
    s_add_u32 s64, s64, 1
    ds_read_b64_tr_b16 a[30:31], v15 offset:4096
    v_exp_f32 v159, v159
    v_exp_f32 v160, v160
    v_mfma_f32_16x16x32_bf16 v[108:111], a[60:63], a[36:39], v[108:111]
    buffer_load_dwordx4 v2, s[36:39], s56 offen offset:3072 sc1 lds
    v_exp_f32 v161, v161
    v_mfma_f32_16x16x32_bf16 v[116:119], a[60:63], a[40:43], v[116:119]
    s_add_u32 s56, s56, 262144
    v_exp_f32 v162, v162
    v_exp_f32 v163, v163
    v_mfma_f32_16x16x32_bf16 v[124:127], a[60:63], a[44:47], v[124:127]
    v_exp_f32 v164, v164
    v_exp_f32 v165, v165
    s_cmp_gt_i32 s68, 7
    s_cbranch_scc0 m_lp135
m_lr136:
    s_waitcnt lgkmcnt(9)
    v_mfma_f32_16x16x32_bf16 v[64:67], a[16:19], a[0:3], v[64:67]
    s_add_u32 m0, s59, 16384
    ds_read_b128 a[32:35], v6 offset:8192
    v_exp_f32 v166, v166
    v_exp_f32 v167, v167
    s_waitcnt lgkmcnt(9)
    v_mfma_f32_16x16x32_bf16 v[72:75], a[16:19], a[4:7], v[72:75]
    ds_read_b64_tr_b16 a[48:49], v12 offset:8192
    buffer_load_dwordx4 v16, s[24:27], s57 offen offset:0 lds
    v_exp_f32 v168, v168
    s_waitcnt lgkmcnt(9)
    v_mfma_f32_16x16x32_bf16 v[80:83], a[16:19], a[8:11], v[80:83]
    s_add_u32 s59, s58, s60
    ds_read_b64_tr_b16 a[50:51], v12 offset:12288
    v_exp_f32 v169, v169
    v_exp_f32 v170, v170
    s_waitcnt lgkmcnt(9)
    v_mfma_f32_16x16x32_bf16 v[88:91], a[16:19], a[12:15], v[88:91]
    s_add_u32 s58, s58, 32768
    ds_read_b128 a[36:39], v6 offset:9216
    v_exp_f32 v171, v171
    v_exp_f32 v172, v172
    s_waitcnt lgkmcnt(8)
    v_mfma_f32_16x16x32_bf16 v[68:71], a[20:23], a[0:3], v[68:71]
    s_cmp_ge_u32 s58, 163840
    ds_read_b128 a[40:43], v6 offset:10240
    v_exp_f32 v173, v173
    v_exp_f32 v174, v174
    v_mfma_f32_16x16x32_bf16 v[76:79], a[20:23], a[4:7], v[76:79]
    ds_read_b128 a[44:47], v6 offset:11264
    buffer_load_dwordx4 v17, s[24:27], s57 offen offset:1024 lds
    v_exp_f32 v175, v175
    v_mfma_f32_16x16x32_bf16 v[84:87], a[20:23], a[8:11], v[84:87]
    s_cselect_b32 s66, 4294836224, s100
    ds_read_b64_tr_b16 a[52:53], v13 offset:8192
    v_exp_f32 v176, v176
    v_exp_f32 v177, v177
    v_mfma_f32_16x16x32_bf16 v[92:95], a[20:23], a[12:15], v[92:95]
    s_cselect_b32 s58, 0, s58
    ds_read_b64_tr_b16 a[54:55], v13 offset:12288
    v_exp_f32 v178, v178
    v_exp_f32 v179, v179
    s_waitcnt lgkmcnt(10)
    v_mfma_f32_16x16x32_bf16 v[96:99], a[24:27], a[0:3], v[96:99]
    ds_read_b64_tr_b16 a[56:57], v14 offset:8192
    v_cvt_pk_bf16_f32 v192, v148, v149
    v_cvt_pk_bf16_f32 v193, v150, v151
    v_mfma_f32_16x16x32_bf16 v[104:107], a[24:27], a[4:7], v[104:107]
    ds_read_b64_tr_b16 a[58:59], v14 offset:12288
    buffer_load_dwordx4 v18, s[24:27], s57 offen offset:2048 lds
    v_cvt_pk_bf16_f32 v194, v152, v153
    v_mfma_f32_16x16x32_bf16 v[112:115], a[24:27], a[8:11], v[112:115]
    ds_read_b64_tr_b16 a[60:61], v15 offset:8192
    v_cvt_pk_bf16_f32 v195, v154, v155
    v_cvt_pk_bf16_f32 v196, v156, v157
    v_mfma_f32_16x16x32_bf16 v[120:123], a[24:27], a[12:15], v[120:123]
    ds_read_b64_tr_b16 a[62:63], v15 offset:12288
    v_cvt_pk_bf16_f32 v197, v158, v159
    v_cvt_pk_bf16_f32 v198, v160, v161
    s_waitcnt lgkmcnt(12)
    v_mfma_f32_16x16x32_bf16 v[100:103], a[28:31], a[0:3], v[100:103]
    v_add_u32 v6, s66, v6
    v_add_u32 v12, s66, v12
    v_cvt_pk_bf16_f32 v199, v162, v163
    v_mfma_f32_16x16x32_bf16 v[108:111], a[28:31], a[4:7], v[108:111]
    buffer_load_dwordx4 v19, s[24:27], s57 offen offset:3072 lds
    v_cvt_pk_bf16_f32 v200, v164, v165
    v_mfma_f32_16x16x32_bf16 v[116:119], a[28:31], a[8:11], v[116:119]
    s_add_u32 s57, s57, 131072
    v_add_u32 v13, s66, v13
    v_add_u32 v14, s66, v14
    v_cvt_pk_bf16_f32 v201, v166, v167
    v_mfma_f32_16x16x32_bf16 v[124:127], a[28:31], a[12:15], v[124:127]
    s_mov_b32 m0, s59
    v_add_u32 v15, s66, v15
    v_cvt_pk_bf16_f32 v202, v168, v169
    s_waitcnt vmcnt(24) lgkmcnt(0)
    v_mfma_f32_16x16x32_bf16 v[64:67], a[48:51], a[32:35], v[64:67]
    s_barrier
    v_cvt_pk_bf16_f32 v203, v170, v171
    v_cvt_pk_bf16_f32 v204, v172, v173
    v_mfma_f32_16x16x32_bf16 v[72:75], a[48:51], a[36:39], v[72:75]
    ds_read_b128 a[0:3], v6 offset:0
    buffer_load_dwordx4 v2, s[36:39], s56 offen offset:0 sc1 lds
    v_cvt_pk_bf16_f32 v205, v174, v175
    v_mfma_f32_16x16x32_bf16 v[80:83], a[48:51], a[40:43], v[80:83]
    ds_read_b64_tr_b16 a[16:17], v12 offset:0
    v_cvt_pk_bf16_f32 v206, v176, v177
    v_cvt_pk_bf16_f32 v207, v178, v179
    v_mfma_f32_16x16x32_bf16 v[88:91], a[48:51], a[44:47], v[88:91]
    ds_read_b64_tr_b16 a[18:19], v12 offset:4096
    s_nop 1
    v_mfma_f32_16x16x32_bf16 v[20:23], v[44:47], v[192:195], 0
    v_mfma_f32_16x16x32_bf16 v[68:71], a[52:55], a[32:35], v[68:71]
    ds_read_b128 a[4:7], v6 offset:1024
    v_mfma_f32_16x16x32_bf16 v[24:27], v[44:47], v[196:199], 0
    v_mfma_f32_16x16x32_bf16 v[28:31], v[44:47], v[200:203], 0
    v_mfma_f32_16x16x32_bf16 v[76:79], a[52:55], a[36:39], v[76:79]
    ds_read_b128 a[8:11], v6 offset:2048
    buffer_load_dwordx4 v2, s[36:39], s56 offen offset:1024 sc1 lds
    v_mfma_f32_16x16x32_bf16 v[32:35], v[44:47], v[204:207], 0
    v_mfma_f32_16x16x32_bf16 v[84:87], a[52:55], a[40:43], v[84:87]
    ds_read_b128 a[12:15], v6 offset:3072
    v_mfma_f32_16x16x32_bf16 v[148:151], v[230:233], v[192:195], 0
    v_mfma_f32_16x16x32_bf16 v[152:155], v[242:245], v[192:195], 0
    v_mfma_f32_16x16x32_bf16 v[92:95], a[52:55], a[44:47], v[92:95]
    ds_read_b64_tr_b16 a[20:21], v13 offset:0
    v_mfma_f32_16x16x32_bf16 v[156:159], v[232:235], v[196:199], 0
    v_mfma_f32_16x16x32_bf16 v[160:163], v[244:247], v[196:199], 0
    v_mfma_f32_16x16x32_bf16 v[96:99], a[56:59], a[32:35], v[96:99]
    ds_read_b64_tr_b16 a[22:23], v13 offset:4096
    v_mfma_f32_16x16x32_bf16 v[164:167], v[234:237], v[200:203], 0
    v_mfma_f32_16x16x32_bf16 v[168:171], v[246:249], v[200:203], 0
    v_mfma_f32_16x16x32_bf16 v[104:107], a[56:59], a[36:39], v[104:107]
    ds_read_b64_tr_b16 a[24:25], v14 offset:0
    buffer_load_dwordx4 v2, s[36:39], s56 offen offset:2048 sc1 lds
    v_mfma_f32_16x16x32_bf16 v[172:175], v[236:239], v[204:207], 0
    v_mfma_f32_16x16x32_bf16 v[112:115], a[56:59], a[40:43], v[112:115]
    ds_read_b64_tr_b16 a[26:27], v14 offset:4096
    v_mfma_f32_16x16x32_bf16 v[176:179], v[248:251], v[204:207], 0
    v_rcp_f32 v140, v20
    v_mfma_f32_16x16x32_bf16 v[120:123], a[56:59], a[44:47], v[120:123]
    ds_read_b64_tr_b16 a[28:29], v15 offset:0
    v_rcp_f32 v141, v24
    v_rcp_f32 v142, v28
    v_mfma_f32_16x16x32_bf16 v[100:103], a[60:63], a[32:35], v[100:103]
    s_add_u32 s64, s64, 1
    ds_read_b64_tr_b16 a[30:31], v15 offset:4096
    v_rcp_f32 v143, v32
    s_nop 1
    v_mfma_f32_16x16x32_bf16 v[108:111], a[60:63], a[36:39], v[108:111]
    buffer_load_dwordx4 v2, s[36:39], s56 offen offset:3072 sc1 lds
    s_nop 1
    v_mfma_f32_16x16x32_bf16 v[116:119], a[60:63], a[40:43], v[116:119]
    s_add_u32 s56, s56, 262144
    v_mul_f32 v148, v148, v140
    v_mul_f32 v149, v149, v140
    v_mfma_f32_16x16x32_bf16 v[124:127], a[60:63], a[44:47], v[124:127]
    v_mul_f32 v150, v150, v140
    v_mul_f32 v151, v151, v140
    s_cmp_gt_i32 s68, 8
    s_cbranch_scc0 m_lp137
m_lr138:
    s_waitcnt lgkmcnt(9)
    v_mfma_f32_16x16x32_bf16 v[64:67], a[16:19], a[0:3], v[64:67]
    s_add_u32 m0, s59, 16384
    ds_read_b128 a[32:35], v6 offset:8192
    v_mul_f32 v152, v152, v140
    v_mul_f32 v153, v153, v140
    s_waitcnt lgkmcnt(9)
    v_mfma_f32_16x16x32_bf16 v[72:75], a[16:19], a[4:7], v[72:75]
    ds_read_b64_tr_b16 a[48:49], v12 offset:8192
    buffer_load_dwordx4 v16, s[24:27], s57 offen offset:0 lds
    v_mul_f32 v154, v154, v140
    s_waitcnt lgkmcnt(9)
    v_mfma_f32_16x16x32_bf16 v[80:83], a[16:19], a[8:11], v[80:83]
    s_add_u32 s59, s58, s60
    ds_read_b64_tr_b16 a[50:51], v12 offset:12288
    v_mul_f32 v155, v155, v140
    v_cvt_pk_bf16_f32 v148, v148, v149
    s_waitcnt lgkmcnt(9)
    v_mfma_f32_16x16x32_bf16 v[88:91], a[16:19], a[12:15], v[88:91]
    s_add_u32 s58, s58, 32768
    ds_read_b128 a[36:39], v6 offset:9216
    v_cvt_pk_bf16_f32 v149, v150, v151
    v_cvt_pk_bf16_f32 v150, v152, v153
    s_waitcnt lgkmcnt(8)
    v_mfma_f32_16x16x32_bf16 v[68:71], a[20:23], a[0:3], v[68:71]
    s_cmp_ge_u32 s58, 163840
    ds_read_b128 a[40:43], v6 offset:10240
    v_cvt_pk_bf16_f32 v151, v154, v155
    buffer_store_dwordx4 v[148:151], v2, s[8:11], s80 offen offset:0 sc1
    v_mfma_f32_16x16x32_bf16 v[76:79], a[20:23], a[4:7], v[76:79]
    ds_read_b128 a[44:47], v6 offset:11264
    buffer_load_dwordx4 v17, s[24:27], s57 offen offset:1024 lds
    v_mul_f32 v156, v156, v141
    v_mfma_f32_16x16x32_bf16 v[84:87], a[20:23], a[8:11], v[84:87]
    s_cselect_b32 s66, 4294836224, s100
    ds_read_b64_tr_b16 a[52:53], v13 offset:8192
    v_mul_f32 v157, v157, v141
    v_mul_f32 v158, v158, v141
    v_mfma_f32_16x16x32_bf16 v[92:95], a[20:23], a[12:15], v[92:95]
    s_cselect_b32 s58, 0, s58
    ds_read_b64_tr_b16 a[54:55], v13 offset:12288
    v_mul_f32 v159, v159, v141
    v_mul_f32 v160, v160, v141
    s_waitcnt lgkmcnt(10)
    v_mfma_f32_16x16x32_bf16 v[96:99], a[24:27], a[0:3], v[96:99]
    ds_read_b64_tr_b16 a[56:57], v14 offset:8192
    v_mul_f32 v161, v161, v141
    v_mul_f32 v162, v162, v141
    v_mfma_f32_16x16x32_bf16 v[104:107], a[24:27], a[4:7], v[104:107]
    ds_read_b64_tr_b16 a[58:59], v14 offset:12288
    buffer_load_dwordx4 v18, s[24:27], s57 offen offset:2048 lds
    v_mul_f32 v163, v163, v141
    v_mfma_f32_16x16x32_bf16 v[112:115], a[24:27], a[8:11], v[112:115]
    ds_read_b64_tr_b16 a[60:61], v15 offset:8192
    v_cvt_pk_bf16_f32 v156, v156, v157
    v_cvt_pk_bf16_f32 v157, v158, v159
    v_mfma_f32_16x16x32_bf16 v[120:123], a[24:27], a[12:15], v[120:123]
    ds_read_b64_tr_b16 a[62:63], v15 offset:12288
    v_cvt_pk_bf16_f32 v158, v160, v161
    v_cvt_pk_bf16_f32 v159, v162, v163
    s_waitcnt lgkmcnt(12)
    v_mfma_f32_16x16x32_bf16 v[100:103], a[28:31], a[0:3], v[100:103]
    v_add_u32 v6, s66, v6
    v_add_u32 v12, s66, v12
    buffer_store_dwordx4 v[156:159], v2, s[8:11], s80 offen offset:1024 sc1
    v_mfma_f32_16x16x32_bf16 v[108:111], a[28:31], a[4:7], v[108:111]
    buffer_load_dwordx4 v19, s[24:27], s57 offen offset:3072 lds
    v_mul_f32 v164, v164, v142
    v_mfma_f32_16x16x32_bf16 v[116:119], a[28:31], a[8:11], v[116:119]
    s_add_u32 s57, s57, 131072
    v_add_u32 v13, s66, v13
    v_add_u32 v14, s66, v14
    v_mul_f32 v165, v165, v142
    v_mfma_f32_16x16x32_bf16 v[124:127], a[28:31], a[12:15], v[124:127]
    s_mov_b32 m0, s59
    v_add_u32 v15, s66, v15
    v_mul_f32 v166, v166, v142
    s_waitcnt vmcnt(24) lgkmcnt(0)
    v_mfma_f32_16x16x32_bf16 v[64:67], a[48:51], a[32:35], v[64:67]
    s_barrier
    v_mul_f32 v167, v167, v142
    v_mul_f32 v168, v168, v142
    v_mfma_f32_16x16x32_bf16 v[72:75], a[48:51], a[36:39], v[72:75]
    ds_read_b128 a[0:3], v6 offset:0
    buffer_load_dwordx4 v2, s[36:39], s56 offen offset:0 sc1 lds
    v_mul_f32 v169, v169, v142
    v_mfma_f32_16x16x32_bf16 v[80:83], a[48:51], a[40:43], v[80:83]
    ds_read_b64_tr_b16 a[16:17], v12 offset:0
    v_mul_f32 v170, v170, v142
    v_mul_f32 v171, v171, v142
    v_mfma_f32_16x16x32_bf16 v[88:91], a[48:51], a[44:47], v[88:91]
    ds_read_b64_tr_b16 a[18:19], v12 offset:4096
    v_cvt_pk_bf16_f32 v164, v164, v165
    v_cvt_pk_bf16_f32 v165, v166, v167
    v_mfma_f32_16x16x32_bf16 v[68:71], a[52:55], a[32:35], v[68:71]
    ds_read_b128 a[4:7], v6 offset:1024
    v_cvt_pk_bf16_f32 v166, v168, v169
    v_cvt_pk_bf16_f32 v167, v170, v171
    v_mfma_f32_16x16x32_bf16 v[76:79], a[52:55], a[36:39], v[76:79]
    ds_read_b128 a[8:11], v6 offset:2048
    buffer_load_dwordx4 v2, s[36:39], s56 offen offset:1024 sc1 lds
    buffer_store_dwordx4 v[164:167], v2, s[8:11], s80 offen offset:2048 sc1
    v_mfma_f32_16x16x32_bf16 v[84:87], a[52:55], a[40:43], v[84:87]
    ds_read_b128 a[12:15], v6 offset:3072
    v_mul_f32 v172, v172, v143
    v_mul_f32 v173, v173, v143
    v_mfma_f32_16x16x32_bf16 v[92:95], a[52:55], a[44:47], v[92:95]
    ds_read_b64_tr_b16 a[20:21], v13 offset:0
    v_mul_f32 v174, v174, v143
    v_mul_f32 v175, v175, v143
    v_mfma_f32_16x16x32_bf16 v[96:99], a[56:59], a[32:35], v[96:99]
    ds_read_b64_tr_b16 a[22:23], v13 offset:4096
    v_mul_f32 v176, v176, v143
    v_mul_f32 v177, v177, v143
    v_mfma_f32_16x16x32_bf16 v[104:107], a[56:59], a[36:39], v[104:107]
    ds_read_b64_tr_b16 a[24:25], v14 offset:0
    buffer_load_dwordx4 v2, s[36:39], s56 offen offset:2048 sc1 lds
    v_mul_f32 v178, v178, v143
    v_mfma_f32_16x16x32_bf16 v[112:115], a[56:59], a[40:43], v[112:115]
    ds_read_b64_tr_b16 a[26:27], v14 offset:4096
    v_mul_f32 v179, v179, v143
    v_cvt_pk_bf16_f32 v172, v172, v173
    v_mfma_f32_16x16x32_bf16 v[120:123], a[56:59], a[44:47], v[120:123]
    ds_read_b64_tr_b16 a[28:29], v15 offset:0
    v_cvt_pk_bf16_f32 v173, v174, v175
    v_cvt_pk_bf16_f32 v174, v176, v177
    v_mfma_f32_16x16x32_bf16 v[100:103], a[60:63], a[32:35], v[100:103]
    s_add_u32 s64, s64, 1
    ds_read_b64_tr_b16 a[30:31], v15 offset:4096
    v_cvt_pk_bf16_f32 v175, v178, v179
    buffer_store_dwordx4 v[172:175], v2, s[8:11], s80 offen offset:3072 sc1
    v_mfma_f32_16x16x32_bf16 v[108:111], a[60:63], a[36:39], v[108:111]
    buffer_load_dwordx4 v2, s[36:39], s56 offen offset:3072 sc1 lds
    v_mfma_f32_16x16x32_bf16 v[116:119], a[60:63], a[40:43], v[116:119]
    s_add_u32 s56, s56, 262144
    v_mfma_f32_16x16x32_bf16 v[124:127], a[60:63], a[44:47], v[124:127]
    s_branch m_l3e127
m_lp131:
    s_mov_b32 s3, 1048576
m_spin139:
    buffer_load_dwordx2 v[4:5], v10, s[8:11], s52 offen sc1
    s_waitcnt vmcnt(0)
    v_cmp_ne_u64 s[76:77], s[4:5], v[4:5]
    s_mul_i32 s91, s95, 20
    s_nop 2
    s_lshr_b32 s90, s76, s91
    s_ff1_i32_b32 s90, s90
    s_lshl_b32 s68, s90, 1
    s_mul_i32 s91, s95, 0
    s_sub_i32 s68, s68, s91
    s_cmp_lt_i32 s90, 0
    s_cselect_b32 s68, 1000, s68
    s_cmp_gt_i32 s68, 5
    s_cbranch_scc1 m_ok140
    s_sub_u32 s3, s3, 1
    s_cbranch_scc1 m_ok140
    s_sleep 4
    s_branch m_spin139
m_ok140:
    s_branch m_lr132
m_lp133:
    s_mov_b32 s3, 1048576
m_spin141:
    buffer_load_dwordx2 v[4:5], v10, s[8:11], s52 offen sc1
    s_waitcnt vmcnt(0)
    v_cmp_ne_u64 s[76:77], s[4:5], v[4:5]
    s_mul_i32 s91, s95, 20
    s_nop 2
    s_lshr_b32 s90, s76, s91
    s_ff1_i32_b32 s90, s90
    s_lshl_b32 s68, s90, 1
    s_mul_i32 s91, s95, 0
    s_sub_i32 s68, s68, s91
    s_cmp_lt_i32 s90, 0
    s_cselect_b32 s68, 1000, s68
    s_cmp_gt_i32 s68, 6
    s_cbranch_scc1 m_ok142
    s_sub_u32 s3, s3, 1
    s_cbranch_scc1 m_ok142
    s_sleep 4
    s_branch m_spin141
m_ok142:
    s_branch m_lr134
m_lp135:
    s_mov_b32 s3, 1048576
m_spin143:
    buffer_load_dwordx2 v[4:5], v10, s[8:11], s52 offen sc1
    s_waitcnt vmcnt(0)
    v_cmp_ne_u64 s[76:77], s[4:5], v[4:5]
    s_mul_i32 s91, s95, 20
    s_nop 2
    s_lshr_b32 s90, s76, s91
    s_ff1_i32_b32 s90, s90
    s_lshl_b32 s68, s90, 1
    s_mul_i32 s91, s95, 0
    s_sub_i32 s68, s68, s91
    s_cmp_lt_i32 s90, 0
    s_cselect_b32 s68, 1000, s68
    s_cmp_gt_i32 s68, 7
    s_cbranch_scc1 m_ok144
    s_sub_u32 s3, s3, 1
    s_cbranch_scc1 m_ok144
    s_sleep 4
    s_branch m_spin143
m_ok144:
    s_branch m_lr136
m_lp137:
    s_mov_b32 s3, 1048576
m_spin145:
    buffer_load_dwordx2 v[4:5], v10, s[8:11], s52 offen sc1
    s_waitcnt vmcnt(0)
    v_cmp_ne_u64 s[76:77], s[4:5], v[4:5]
    s_mul_i32 s91, s95, 20
    s_nop 2
    s_lshr_b32 s90, s76, s91
    s_ff1_i32_b32 s90, s90
    s_lshl_b32 s68, s90, 1
    s_mul_i32 s91, s95, 0
    s_sub_i32 s68, s68, s91
    s_cmp_lt_i32 s90, 0
    s_cselect_b32 s68, 1000, s68
    s_cmp_gt_i32 s68, 8
    s_cbranch_scc1 m_ok146
    s_sub_u32 s3, s3, 1
    s_cbranch_scc1 m_ok146
    s_sleep 4
    s_branch m_spin145
m_ok146:
    s_branch m_lr138
m_l3126:
    s_waitcnt lgkmcnt(9)
    v_mfma_f32_16x16x32_bf16 v[64:67], a[16:19], a[0:3], v[64:67]
    s_add_u32 m0, s59, 16384
    ds_read_b128 a[32:35], v6 offset:8192
    s_waitcnt lgkmcnt(9)
    v_mfma_f32_16x16x32_bf16 v[72:75], a[16:19], a[4:7], v[72:75]
    ds_read_b64_tr_b16 a[48:49], v12 offset:8192
    buffer_load_dwordx4 v16, s[24:27], s57 offen offset:0 lds
    s_waitcnt lgkmcnt(9)
    v_mfma_f32_16x16x32_bf16 v[80:83], a[16:19], a[8:11], v[80:83]
    s_add_u32 s59, s58, s60
    ds_read_b64_tr_b16 a[50:51], v12 offset:12288
    s_waitcnt lgkmcnt(9)
    v_mfma_f32_16x16x32_bf16 v[88:91], a[16:19], a[12:15], v[88:91]
    s_add_u32 s58, s58, 32768
    ds_read_b128 a[36:39], v6 offset:9216
    s_waitcnt lgkmcnt(8)
    v_mfma_f32_16x16x32_bf16 v[68:71], a[20:23], a[0:3], v[68:71]
    s_cmp_ge_u32 s58, 163840
    ds_read_b128 a[40:43], v6 offset:10240
    v_mfma_f32_16x16x32_bf16 v[76:79], a[20:23], a[4:7], v[76:79]
    ds_read_b128 a[44:47], v6 offset:11264
    buffer_load_dwordx4 v17, s[24:27], s57 offen offset:1024 lds
    v_mfma_f32_16x16x32_bf16 v[84:87], a[20:23], a[8:11], v[84:87]
    s_cselect_b32 s66, 4294836224, s100
    ds_read_b64_tr_b16 a[52:53], v13 offset:8192
    v_mfma_f32_16x16x32_bf16 v[92:95], a[20:23], a[12:15], v[92:95]
    s_cselect_b32 s58, 0, s58
    ds_read_b64_tr_b16 a[54:55], v13 offset:12288
    s_waitcnt lgkmcnt(10)
    v_mfma_f32_16x16x32_bf16 v[96:99], a[24:27], a[0:3], v[96:99]
    ds_read_b64_tr_b16 a[56:57], v14 offset:8192
    v_mfma_f32_16x16x32_bf16 v[104:107], a[24:27], a[4:7], v[104:107]
    ds_read_b64_tr_b16 a[58:59], v14 offset:12288
    buffer_load_dwordx4 v18, s[24:27], s57 offen offset:2048 lds
    v_mfma_f32_16x16x32_bf16 v[112:115], a[24:27], a[8:11], v[112:115]
    ds_read_b64_tr_b16 a[60:61], v15 offset:8192
    v_mfma_f32_16x16x32_bf16 v[120:123], a[24:27], a[12:15], v[120:123]
    ds_read_b64_tr_b16 a[62:63], v15 offset:12288
    s_waitcnt lgkmcnt(12)
    v_mfma_f32_16x16x32_bf16 v[100:103], a[28:31], a[0:3], v[100:103]
    v_add_u32 v6, s66, v6
    v_add_u32 v12, s66, v12
    v_mfma_f32_16x16x32_bf16 v[108:111], a[28:31], a[4:7], v[108:111]
    buffer_load_dwordx4 v19, s[24:27], s57 offen offset:3072 lds
    v_mfma_f32_16x16x32_bf16 v[116:119], a[28:31], a[8:11], v[116:119]
    s_add_u32 s57, s57, 131072
    v_add_u32 v13, s66, v13
    v_add_u32 v14, s66, v14
    v_mfma_f32_16x16x32_bf16 v[124:127], a[28:31], a[12:15], v[124:127]
    s_mov_b32 m0, s59
    v_add_u32 v15, s66, v15
    s_waitcnt vmcnt(24) lgkmcnt(0)
    v_mfma_f32_16x16x32_bf16 v[64:67], a[48:51], a[32:35], v[64:67]
    s_barrier
    v_mfma_f32_16x16x32_bf16 v[72:75], a[48:51], a[36:39], v[72:75]
    ds_read_b128 a[0:3], v6 offset:0
    buffer_load_dwordx4 v2, s[36:39], s56 offen offset:0 sc1 lds
    v_mfma_f32_16x16x32_bf16 v[80:83], a[48:51], a[40:43], v[80:83]
    ds_read_b64_tr_b16 a[16:17], v12 offset:0
    v_mfma_f32_16x16x32_bf16 v[88:91], a[48:51], a[44:47], v[88:91]
    ds_read_b64_tr_b16 a[18:19], v12 offset:4096
    v_mfma_f32_16x16x32_bf16 v[68:71], a[52:55], a[32:35], v[68:71]
    ds_read_b128 a[4:7], v6 offset:1024
    v_mfma_f32_16x16x32_bf16 v[76:79], a[52:55], a[36:39], v[76:79]
    ds_read_b128 a[8:11], v6 offset:2048
    buffer_load_dwordx4 v2, s[36:39], s56 offen offset:1024 sc1 lds
    v_mfma_f32_16x16x32_bf16 v[84:87], a[52:55], a[40:43], v[84:87]
    ds_read_b128 a[12:15], v6 offset:3072
    v_mfma_f32_16x16x32_bf16 v[92:95], a[52:55], a[44:47], v[92:95]
    ds_read_b64_tr_b16 a[20:21], v13 offset:0
    v_mfma_f32_16x16x32_bf16 v[96:99], a[56:59], a[32:35], v[96:99]
    ds_read_b64_tr_b16 a[22:23], v13 offset:4096
    v_mfma_f32_16x16x32_bf16 v[104:107], a[56:59], a[36:39], v[104:107]
    ds_read_b64_tr_b16 a[24:25], v14 offset:0
    buffer_load_dwordx4 v2, s[36:39], s56 offen offset:2048 sc1 lds
    v_mfma_f32_16x16x32_bf16 v[112:115], a[56:59], a[40:43], v[112:115]
    ds_read_b64_tr_b16 a[26:27], v14 offset:4096
    v_mfma_f32_16x16x32_bf16 v[120:123], a[56:59], a[44:47], v[120:123]
    ds_read_b64_tr_b16 a[28:29], v15 offset:0
    v_mfma_f32_16x16x32_bf16 v[100:103], a[60:63], a[32:35], v[100:103]
    s_add_u32 s64, s64, 1
    ds_read_b64_tr_b16 a[30:31], v15 offset:4096
    v_mfma_f32_16x16x32_bf16 v[108:111], a[60:63], a[36:39], v[108:111]
    buffer_load_dwordx4 v2, s[36:39], s56 offen offset:3072 sc1 lds
    v_mfma_f32_16x16x32_bf16 v[116:119], a[60:63], a[40:43], v[116:119]
    s_add_u32 s56, s56, 262144
    s_cmp_lt_u32 s64, s67
    v_mfma_f32_16x16x32_bf16 v[124:127], a[60:63], a[44:47], v[124:127]
    s_cbranch_scc1 m_l3126
m_l3e127:
    s_add_u32 s92, s64, 5
    s_cmp_gt_i32 s68, s92
    s_cbranch_scc1 m_rdy147
    s_mov_b32 s3, 1048576
m_spin148:
    buffer_load_dwordx2 v[4:5], v10, s[8:11], s52 offen sc1
    s_waitcnt vmcnt(0)
    v_cmp_ne_u64 s[76:77], s[4:5], v[4:5]
    s_mul_i32 s91, s95, 20
    s_nop 2
    s_lshr_b32 s90, s76, s91
    s_ff1_i32_b32 s90, s90
    s_lshl_b32 s68, s90, 1
    s_mul_i32 s91, s95, 0
    s_sub_i32 s68, s68, s91
    s_cmp_lt_i32 s90, 0
    s_cselect_b32 s68, 1000, s68
    s_cmp_gt_i32 s68, s92
    s_cbranch_scc1 m_ok149
    s_sub_u32 s3, s3, 1
    s_cbranch_scc1 m_ok149
    s_sleep 4
    s_branch m_spin148
m_ok149:
m_rdy147:
    s_mov_b32 s67, 8
    s_cmp_lt_u32 s64, 8
    s_cbranch_scc1 m_l3n130
    s_cmp_eq_u32 s64, 8
    s_cbranch_scc1 m_o1150
m_o2151:
    s_cmp_eq_u32 s95, 0
    s_cbranch_scc1 m_l3c129
    s_mov_b32 s67, 18
    s_cmp_lt_u32 s64, 18
    s_cbranch_scc1 m_l3n130
    s_cmp_lg_u32 s64, 18
    s_cbranch_scc1 m_n152
    s_mov_b32 s68, 1000
    s_lshr_b32 s90, s96, 1
    s_lshl_b32 s90, s90, 8
    s_add_u32 s90, s90, 117452800
    buffer_load_dwordx2 v[4:5], v10, s[8:11], s90 offen sc1
    s_mov_b32 s67, 19
    s_branch m_l3126
m_n152:
    s_cmp_lg_u32 s64, 19
    s_cbranch_scc1 m_n153
    s_waitcnt vmcnt(8)
    s_waitcnt vmcnt(16)
    s_mov_b32 s3, 1048576
m_spin154:
    v_cmp_ne_u64 s[76:77], s[4:5], v[4:5]
    s_nop 3
    s_cmp_eq_u64 s[76:77], 0
    s_cbranch_scc1 m_ok155
    s_sub_u32 s3, s3, 1
    s_cbranch_scc1 m_ok155
    s_sleep 8
    s_lshr_b32 s90, s96, 1
    s_lshl_b32 s90, s90, 8
    s_add_u32 s90, s90, 117452800
    buffer_load_dwordx2 v[4:5], v10, s[8:11], s90 offen sc1
    s_waitcnt vmcnt(0)
    s_branch m_spin154
m_ok155:
    s_mov_b32 s56, s69
    s_mov_b32 s67, 20
    s_branch m_l3126
m_n153:
    s_cmp_lg_u32 s64, 20
    s_cbranch_scc1 m_n156
    s_mov_b32 s24, s50
    s_mov_b32 s25, s51
    s_mov_b32 s26, 2097152
    s_lshl_b32 s57, s97, 8
    s_mov_b32 s67, 24
    s_branch m_l3126
m_n156:
    s_cmp_lg_u32 s64, 24
    s_cbranch_scc1 m_n157
    s_lshl_b32 s90, s96, 3
    s_add_u32 s90, s90, s97
    s_lshl_b32 s90, s90, 15
    s_lshl_b32 s91, s16, 13
    s_add_u32 s90, s90, s91
    s_add_u32 s70, s90, 100663296
    s_nop 3
    v_cvt_pk_bf16_f32 v128, v64, v65
    v_cvt_pk_bf16_f32 v129, v66, v67
    v_cvt_pk_bf16_f32 v130, v68, v69
    v_cvt_pk_bf16_f32 v131, v70, v71
    v_cvt_pk_bf16_f32 v132, v72, v73
    v_cvt_pk_bf16_f32 v133, v74, v75
    v_cvt_pk_bf16_f32 v134, v76, v77
    v_cvt_pk_bf16_f32 v135, v78, v79
    v_cvt_pk_bf16_f32 v136, v80, v81
    v_cvt_pk_bf16_f32 v137, v82, v83
    v_cvt_pk_bf16_f32 v138, v84, v85
    v_cvt_pk_bf16_f32 v139, v86, v87
    v_cvt_pk_bf16_f32 v140, v88, v89
    v_cvt_pk_bf16_f32 v141, v90, v91
    v_cvt_pk_bf16_f32 v142, v92, v93
    v_cvt_pk_bf16_f32 v143, v94, v95
    v_cvt_pk_bf16_f32 v144, v96, v97
    v_cvt_pk_bf16_f32 v145, v98, v99
    v_cvt_pk_bf16_f32 v146, v100, v101
    v_cvt_pk_bf16_f32 v147, v102, v103
    v_cvt_pk_bf16_f32 v148, v104, v105
    v_cvt_pk_bf16_f32 v149, v106, v107
    v_cvt_pk_bf16_f32 v150, v108, v109
    v_cvt_pk_bf16_f32 v151, v110, v111
    v_cvt_pk_bf16_f32 v152, v112, v113
    v_cvt_pk_bf16_f32 v153, v114, v115
    v_cvt_pk_bf16_f32 v154, v116, v117
    v_cvt_pk_bf16_f32 v155, v118, v119
    v_cvt_pk_bf16_f32 v156, v120, v121
    v_cvt_pk_bf16_f32 v157, v122, v123
    v_cvt_pk_bf16_f32 v158, v124, v125
    v_cvt_pk_bf16_f32 v159, v126, v127
    v_mov_b64 v[64:65], 0
    v_mov_b64 v[66:67], 0
    v_mov_b64 v[68:69], 0
    v_mov_b64 v[70:71], 0
    v_mov_b64 v[72:73], 0
    v_mov_b64 v[74:75], 0
    v_mov_b64 v[76:77], 0
    v_mov_b64 v[78:79], 0
    v_mov_b64 v[80:81], 0
    v_mov_b64 v[82:83], 0
    v_mov_b64 v[84:85], 0
    v_mov_b64 v[86:87], 0
    v_mov_b64 v[88:89], 0
    v_mov_b64 v[90:91], 0
    v_mov_b64 v[92:93], 0
    v_mov_b64 v[94:95], 0
    v_mov_b64 v[96:97], 0
    v_mov_b64 v[98:99], 0
    v_mov_b64 v[100:101], 0
    v_mov_b64 v[102:103], 0
    v_mov_b64 v[104:105], 0
    v_mov_b64 v[106:107], 0
    v_mov_b64 v[108:109], 0
    v_mov_b64 v[110:111], 0
    v_mov_b64 v[112:113], 0
    v_mov_b64 v[114:115], 0
    v_mov_b64 v[116:117], 0
    v_mov_b64 v[118:119], 0
    v_mov_b64 v[120:121], 0
    v_mov_b64 v[122:123], 0
    v_mov_b64 v[124:125], 0
    v_mov_b64 v[126:127], 0
    s_nop 1
    s_waitcnt lgkmcnt(9)
    v_mfma_f32_16x16x32_bf16 v[64:67], a[16:19], a[0:3], v[64:67]
    s_add_u32 m0, s59, 16384
    ds_read_b128 a[32:35], v6 offset:8192
    s_waitcnt lgkmcnt(9)
    v_mfma_f32_16x16x32_bf16 v[72:75], a[16:19], a[4:7], v[72:75]
    ds_read_b64_tr_b16 a[48:49], v12 offset:8192
    buffer_load_dwordx4 v16, s[24:27], s57 offen offset:0 lds
    s_waitcnt lgkmcnt(9)
    v_mfma_f32_16x16x32_bf16 v[80:83], a[16:19], a[8:11], v[80:83]
    s_add_u32 s59, s58, s60
    ds_read_b64_tr_b16 a[50:51], v12 offset:12288
    s_waitcnt lgkmcnt(9)
    v_mfma_f32_16x16x32_bf16 v[88:91], a[16:19], a[12:15], v[88:91]
    s_add_u32 s58, s58, 32768
    ds_read_b128 a[36:39], v6 offset:9216
    s_waitcnt lgkmcnt(8)
    v_mfma_f32_16x16x32_bf16 v[68:71], a[20:23], a[0:3], v[68:71]
    s_cmp_ge_u32 s58, 163840
    ds_read_b128 a[40:43], v6 offset:10240
    v_mfma_f32_16x16x32_bf16 v[76:79], a[20:23], a[4:7], v[76:79]
    ds_read_b128 a[44:47], v6 offset:11264
    buffer_load_dwordx4 v17, s[24:27], s57 offen offset:1024 lds
    v_mfma_f32_16x16x32_bf16 v[84:87], a[20:23], a[8:11], v[84:87]
    s_cselect_b32 s66, 4294836224, s100
    ds_read_b64_tr_b16 a[52:53], v13 offset:8192
    v_mfma_f32_16x16x32_bf16 v[92:95], a[20:23], a[12:15], v[92:95]
    s_cselect_b32 s58, 0, s58
    ds_read_b64_tr_b16 a[54:55], v13 offset:12288
    s_waitcnt lgkmcnt(10)
    v_mfma_f32_16x16x32_bf16 v[96:99], a[24:27], a[0:3], v[96:99]
    ds_read_b64_tr_b16 a[56:57], v14 offset:8192
    v_mfma_f32_16x16x32_bf16 v[104:107], a[24:27], a[4:7], v[104:107]
    ds_read_b64_tr_b16 a[58:59], v14 offset:12288
    buffer_load_dwordx4 v18, s[24:27], s57 offen offset:2048 lds
    v_mfma_f32_16x16x32_bf16 v[112:115], a[24:27], a[8:11], v[112:115]
    ds_read_b64_tr_b16 a[60:61], v15 offset:8192
    v_mfma_f32_16x16x32_bf16 v[120:123], a[24:27], a[12:15], v[120:123]
    ds_read_b64_tr_b16 a[62:63], v15 offset:12288
    buffer_store_dwordx4 v[128:131], v2, s[8:11], s70 offen offset:0 sc1
    s_waitcnt lgkmcnt(12)
    v_mfma_f32_16x16x32_bf16 v[100:103], a[28:31], a[0:3], v[100:103]
    v_add_u32 v6, s66, v6
    v_add_u32 v12, s66, v12
    v_mfma_f32_16x16x32_bf16 v[108:111], a[28:31], a[4:7], v[108:111]
    buffer_load_dwordx4 v19, s[24:27], s57 offen offset:3072 lds
    v_mfma_f32_16x16x32_bf16 v[116:119], a[28:31], a[8:11], v[116:119]
    s_add_u32 s57, s57, 131072
    v_add_u32 v13, s66, v13
    v_add_u32 v14, s66, v14
    v_mfma_f32_16x16x32_bf16 v[124:127], a[28:31], a[12:15], v[124:127]
    s_mov_b32 m0, s59
    v_add_u32 v15, s66, v15
    s_waitcnt vmcnt(24) lgkmcnt(0)
    v_mfma_f32_16x16x32_bf16 v[64:67], a[48:51], a[32:35], v[64:67]
    s_barrier
    v_mfma_f32_16x16x32_bf16 v[72:75], a[48:51], a[36:39], v[72:75]
    ds_read_b128 a[0:3], v6 offset:0
    buffer_load_dwordx4 v2, s[36:39], s56 offen offset:0 sc1 lds
    v_mfma_f32_16x16x32_bf16 v[80:83], a[48:51], a[40:43], v[80:83]
    ds_read_b64_tr_b16 a[16:17], v12 offset:0
    v_mfma_f32_16x16x32_bf16 v[88:91], a[48:51], a[44:47], v[88:91]
    ds_read_b64_tr_b16 a[18:19], v12 offset:4096
    v_mfma_f32_16x16x32_bf16 v[68:71], a[52:55], a[32:35], v[68:71]
    ds_read_b128 a[4:7], v6 offset:1024
    v_mfma_f32_16x16x32_bf16 v[76:79], a[52:55], a[36:39], v[76:79]
    ds_read_b128 a[8:11], v6 offset:2048
    buffer_load_dwordx4 v2, s[36:39], s56 offen offset:1024 sc1 lds
    v_mfma_f32_16x16x32_bf16 v[84:87], a[52:55], a[40:43], v[84:87]
    ds_read_b128 a[12:15], v6 offset:3072
    v_mfma_f32_16x16x32_bf16 v[92:95], a[52:55], a[44:47], v[92:95]
    ds_read_b64_tr_b16 a[20:21], v13 offset:0
    v_mfma_f32_16x16x32_bf16 v[96:99], a[56:59], a[32:35], v[96:99]
    ds_read_b64_tr_b16 a[22:23], v13 offset:4096
    v_mfma_f32_16x16x32_bf16 v[104:107], a[56:59], a[36:39], v[104:107]
    ds_read_b64_tr_b16 a[24:25], v14 offset:0
    buffer_load_dwordx4 v2, s[36:39], s56 offen offset:2048 sc1 lds
    v_mfma_f32_16x16x32_bf16 v[112:115], a[56:59], a[40:43], v[112:115]
    ds_read_b64_tr_b16 a[26:27], v14 offset:4096
    v_mfma_f32_16x16x32_bf16 v[120:123], a[56:59], a[44:47], v[120:123]
    ds_read_b64_tr_b16 a[28:29], v15 offset:0
    buffer_store_dwordx4 v[132:135], v2, s[8:11], s70 offen offset:1024 sc1
    v_mfma_f32_16x16x32_bf16 v[100:103], a[60:63], a[32:35], v[100:103]
    s_add_u32 s64, s64, 1
    ds_read_b64_tr_b16 a[30:31], v15 offset:4096
    v_mfma_f32_16x16x32_bf16 v[108:111], a[60:63], a[36:39], v[108:111]
    buffer_load_dwordx4 v2, s[36:39], s56 offen offset:3072 sc1 lds
    v_mfma_f32_16x16x32_bf16 v[116:119], a[60:63], a[40:43], v[116:119]
    s_add_u32 s56, s56, 262144
    v_mfma_f32_16x16x32_bf16 v[124:127], a[60:63], a[44:47], v[124:127]
    s_waitcnt lgkmcnt(9)
    v_mfma_f32_16x16x32_bf16 v[64:67], a[16:19], a[0:3], v[64:67]
    s_add_u32 m0, s59, 16384
    ds_read_b128 a[32:35], v6 offset:8192
    s_waitcnt lgkmcnt(9)
    v_mfma_f32_16x16x32_bf16 v[72:75], a[16:19], a[4:7], v[72:75]
    ds_read_b64_tr_b16 a[48:49], v12 offset:8192
    buffer_load_dwordx4 v16, s[24:27], s57 offen offset:0 lds
    s_waitcnt lgkmcnt(9)
    v_mfma_f32_16x16x32_bf16 v[80:83], a[16:19], a[8:11], v[80:83]
    s_add_u32 s59, s58, s60
    ds_read_b64_tr_b16 a[50:51], v12 offset:12288
    s_waitcnt lgkmcnt(9)
    v_mfma_f32_16x16x32_bf16 v[88:91], a[16:19], a[12:15], v[88:91]
    s_add_u32 s58, s58, 32768
    ds_read_b128 a[36:39], v6 offset:9216
    s_waitcnt lgkmcnt(8)
    v_mfma_f32_16x16x32_bf16 v[68:71], a[20:23], a[0:3], v[68:71]
    s_cmp_ge_u32 s58, 163840
    ds_read_b128 a[40:43], v6 offset:10240
    v_mfma_f32_16x16x32_bf16 v[76:79], a[20:23], a[4:7], v[76:79]
    ds_read_b128 a[44:47], v6 offset:11264
    buffer_load_dwordx4 v17, s[24:27], s57 offen offset:1024 lds
    v_mfma_f32_16x16x32_bf16 v[84:87], a[20:23], a[8:11], v[84:87]
    s_cselect_b32 s66, 4294836224, s100
    ds_read_b64_tr_b16 a[52:53], v13 offset:8192
    v_mfma_f32_16x16x32_bf16 v[92:95], a[20:23], a[12:15], v[92:95]
    s_cselect_b32 s58, 0, s58
    ds_read_b64_tr_b16 a[54:55], v13 offset:12288
    s_waitcnt lgkmcnt(10)
    v_mfma_f32_16x16x32_bf16 v[96:99], a[24:27], a[0:3], v[96:99]
    ds_read_b64_tr_b16 a[56:57], v14 offset:8192
    v_mfma_f32_16x16x32_bf16 v[104:107], a[24:27], a[4:7], v[104:107]
    ds_read_b64_tr_b16 a[58:59], v14 offset:12288
    buffer_load_dwordx4 v18, s[24:27], s57 offen offset:2048 lds
    v_mfma_f32_16x16x32_bf16 v[112:115], a[24:27], a[8:11], v[112:115]
    ds_read_b64_tr_b16 a[60:61], v15 offset:8192
    v_mfma_f32_16x16x32_bf16 v[120:123], a[24:27], a[12:15], v[120:123]
    ds_read_b64_tr_b16 a[62:63], v15 offset:12288
    buffer_store_dwordx4 v[136:139], v2, s[8:11], s70 offen offset:2048 sc1
    s_waitcnt lgkmcnt(12)
    v_mfma_f32_16x16x32_bf16 v[100:103], a[28:31], a[0:3], v[100:103]
    v_add_u32 v6, s66, v6
    v_add_u32 v12, s66, v12
    v_mfma_f32_16x16x32_bf16 v[108:111], a[28:31], a[4:7], v[108:111]
    buffer_load_dwordx4 v19, s[24:27], s57 offen offset:3072 lds
    v_mfma_f32_16x16x32_bf16 v[116:119], a[28:31], a[8:11], v[116:119]
    s_add_u32 s57, s57, 131072
    v_add_u32 v13, s66, v13
    v_add_u32 v14, s66, v14
    v_mfma_f32_16x16x32_bf16 v[124:127], a[28:31], a[12:15], v[124:127]
    s_mov_b32 m0, s59
    v_add_u32 v15, s66, v15
    s_waitcnt vmcnt(24) lgkmcnt(0)
    v_mfma_f32_16x16x32_bf16 v[64:67], a[48:51], a[32:35], v[64:67]
    s_barrier
    v_mfma_f32_16x16x32_bf16 v[72:75], a[48:51], a[36:39], v[72:75]
    ds_read_b128 a[0:3], v6 offset:0
    buffer_load_dwordx4 v2, s[36:39], s56 offen offset:0 sc1 lds
    v_mfma_f32_16x16x32_bf16 v[80:83], a[48:51], a[40:43], v[80:83]
    ds_read_b64_tr_b16 a[16:17], v12 offset:0
    v_mfma_f32_16x16x32_bf16 v[88:91], a[48:51], a[44:47], v[88:91]
    ds_read_b64_tr_b16 a[18:19], v12 offset:4096
    v_mfma_f32_16x16x32_bf16 v[68:71], a[52:55], a[32:35], v[68:71]
    ds_read_b128 a[4:7], v6 offset:1024
    v_mfma_f32_16x16x32_bf16 v[76:79], a[52:55], a[36:39], v[76:79]
    ds_read_b128 a[8:11], v6 offset:2048
    buffer_load_dwordx4 v2, s[36:39], s56 offen offset:1024 sc1 lds
    v_mfma_f32_16x16x32_bf16 v[84:87], a[52:55], a[40:43], v[84:87]
    ds_read_b128 a[12:15], v6 offset:3072
    v_mfma_f32_16x16x32_bf16 v[92:95], a[52:55], a[44:47], v[92:95]
    ds_read_b64_tr_b16 a[20:21], v13 offset:0
    v_mfma_f32_16x16x32_bf16 v[96:99], a[56:59], a[32:35], v[96:99]
    ds_read_b64_tr_b16 a[22:23], v13 offset:4096
    v_mfma_f32_16x16x32_bf16 v[104:107], a[56:59], a[36:39], v[104:107]
    ds_read_b64_tr_b16 a[24:25], v14 offset:0
    buffer_load_dwordx4 v2, s[36:39], s56 offen offset:2048 sc1 lds
    v_mfma_f32_16x16x32_bf16 v[112:115], a[56:59], a[40:43], v[112:115]
    ds_read_b64_tr_b16 a[26:27], v14 offset:4096
    v_mfma_f32_16x16x32_bf16 v[120:123], a[56:59], a[44:47], v[120:123]
    ds_read_b64_tr_b16 a[28:29], v15 offset:0
    buffer_store_dwordx4 v[140:143], v2, s[8:11], s70 offen offset:3072 sc1
    s_add_u32 s70, s70, 4096
    v_mfma_f32_16x16x32_bf16 v[100:103], a[60:63], a[32:35], v[100:103]
    s_add_u32 s64, s64, 1
    ds_read_b64_tr_b16 a[30:31], v15 offset:4096
    v_mfma_f32_16x16x32_bf16 v[108:111], a[60:63], a[36:39], v[108:111]
    buffer_load_dwordx4 v2, s[36:39], s56 offen offset:3072 sc1 lds
    v_mfma_f32_16x16x32_bf16 v[116:119], a[60:63], a[40:43], v[116:119]
    s_add_u32 s56, s56, 262144
    v_mfma_f32_16x16x32_bf16 v[124:127], a[60:63], a[44:47], v[124:127]
    s_waitcnt lgkmcnt(9)
    v_mfma_f32_16x16x32_bf16 v[64:67], a[16:19], a[0:3], v[64:67]
    s_add_u32 m0, s59, 16384
    ds_read_b128 a[32:35], v6 offset:8192
    s_waitcnt lgkmcnt(9)
    v_mfma_f32_16x16x32_bf16 v[72:75], a[16:19], a[4:7], v[72:75]
    ds_read_b64_tr_b16 a[48:49], v12 offset:8192
    buffer_load_dwordx4 v16, s[24:27], s57 offen offset:0 lds
    s_waitcnt lgkmcnt(9)
    v_mfma_f32_16x16x32_bf16 v[80:83], a[16:19], a[8:11], v[80:83]
    s_add_u32 s59, s58, s60
    ds_read_b64_tr_b16 a[50:51], v12 offset:12288
    s_waitcnt lgkmcnt(9)
    v_mfma_f32_16x16x32_bf16 v[88:91], a[16:19], a[12:15], v[88:91]
    s_add_u32 s58, s58, 32768
    ds_read_b128 a[36:39], v6 offset:9216
    s_waitcnt lgkmcnt(8)
    v_mfma_f32_16x16x32_bf16 v[68:71], a[20:23], a[0:3], v[68:71]
    s_cmp_ge_u32 s58, 163840
    ds_read_b128 a[40:43], v6 offset:10240
    v_mfma_f32_16x16x32_bf16 v[76:79], a[20:23], a[4:7], v[76:79]
    ds_read_b128 a[44:47], v6 offset:11264
    buffer_load_dwordx4 v17, s[24:27], s57 offen offset:1024 lds
    v_mfma_f32_16x16x32_bf16 v[84:87], a[20:23], a[8:11], v[84:87]
    s_cselect_b32 s66, 4294836224, s100
    ds_read_b64_tr_b16 a[52:53], v13 offset:8192
    v_mfma_f32_16x16x32_bf16 v[92:95], a[20:23], a[12:15], v[92:95]
    s_cselect_b32 s58, 0, s58
    ds_read_b64_tr_b16 a[54:55], v13 offset:12288
    s_waitcnt lgkmcnt(10)
    v_mfma_f32_16x16x32_bf16 v[96:99], a[24:27], a[0:3], v[96:99]
    ds_read_b64_tr_b16 a[56:57], v14 offset:8192
    v_mfma_f32_16x16x32_bf16 v[104:107], a[24:27], a[4:7], v[104:107]
    ds_read_b64_tr_b16 a[58:59], v14 offset:12288
    buffer_load_dwordx4 v18, s[24:27], s57 offen offset:2048 lds
    v_mfma_f32_16x16x32_bf16 v[112:115], a[24:27], a[8:11], v[112:115]
    ds_read_b64_tr_b16 a[60:61], v15 offset:8192
    v_mfma_f32_16x16x32_bf16 v[120:123], a[24:27], a[12:15], v[120:123]
    ds_read_b64_tr_b16 a[62:63], v15 offset:12288
    buffer_store_dwordx4 v[144:147], v2, s[8:11], s70 offen offset:0 sc1
    s_waitcnt lgkmcnt(12)
    v_mfma_f32_16x16x32_bf16 v[100:103], a[28:31], a[0:3], v[100:103]
    v_add_u32 v6, s66, v6
    v_add_u32 v12, s66, v12
    v_mfma_f32_16x16x32_bf16 v[108:111], a[28:31], a[4:7], v[108:111]
    buffer_load_dwordx4 v19, s[24:27], s57 offen offset:3072 lds
    v_mfma_f32_16x16x32_bf16 v[116:119], a[28:31], a[8:11], v[116:119]
    s_add_u32 s57, s57, 131072
    v_add_u32 v13, s66, v13
    v_add_u32 v14, s66, v14
    v_mfma_f32_16x16x32_bf16 v[124:127], a[28:31], a[12:15], v[124:127]
    s_mov_b32 m0, s59
    v_add_u32 v15, s66, v15
    s_waitcnt vmcnt(24) lgkmcnt(0)
    v_mfma_f32_16x16x32_bf16 v[64:67], a[48:51], a[32:35], v[64:67]
    s_barrier
    v_mfma_f32_16x16x32_bf16 v[72:75], a[48:51], a[36:39], v[72:75]
    ds_read_b128 a[0:3], v6 offset:0
    buffer_load_dwordx4 v2, s[36:39], s56 offen offset:0 sc1 lds
    v_mfma_f32_16x16x32_bf16 v[80:83], a[48:51], a[40:43], v[80:83]
    ds_read_b64_tr_b16 a[16:17], v12 offset:0
    v_mfma_f32_16x16x32_bf16 v[88:91], a[48:51], a[44:47], v[88:91]
    ds_read_b64_tr_b16 a[18:19], v12 offset:4096
    v_mfma_f32_16x16x32_bf16 v[68:71], a[52:55], a[32:35], v[68:71]
    ds_read_b128 a[4:7], v6 offset:1024
    v_mfma_f32_16x16x32_bf16 v[76:79], a[52:55], a[36:39], v[76:79]
    ds_read_b128 a[8:11], v6 offset:2048
    buffer_load_dwordx4 v2, s[36:39], s56 offen offset:1024 sc1 lds
    v_mfma_f32_16x16x32_bf16 v[84:87], a[52:55], a[40:43], v[84:87]
    ds_read_b128 a[12:15], v6 offset:3072
    v_mfma_f32_16x16x32_bf16 v[92:95], a[52:55], a[44:47], v[92:95]
    ds_read_b64_tr_b16 a[20:21], v13 offset:0
    v_mfma_f32_16x16x32_bf16 v[96:99], a[56:59], a[32:35], v[96:99]
    ds_read_b64_tr_b16 a[22:23], v13 offset:4096
    v_mfma_f32_16x16x32_bf16 v[104:107], a[56:59], a[36:39], v[104:107]
    ds_read_b64_tr_b16 a[24:25], v14 offset:0
    buffer_load_dwordx4 v2, s[36:39], s56 offen offset:2048 sc1 lds
    v_mfma_f32_16x16x32_bf16 v[112:115], a[56:59], a[40:43], v[112:115]
    ds_read_b64_tr_b16 a[26:27], v14 offset:4096
    v_mfma_f32_16x16x32_bf16 v[120:123], a[56:59], a[44:47], v[120:123]
    ds_read_b64_tr_b16 a[28:29], v15 offset:0
    buffer_store_dwordx4 v[148:151], v2, s[8:11], s70 offen offset:1024 sc1
    v_mfma_f32_16x16x32_bf16 v[100:103], a[60:63], a[32:35], v[100:103]
    s_add_u32 s64, s64, 1
    ds_read_b64_tr_b16 a[30:31], v15 offset:4096
    v_mfma_f32_16x16x32_bf16 v[108:111], a[60:63], a[36:39], v[108:111]
    buffer_load_dwordx4 v2, s[36:39], s56 offen offset:3072 sc1 lds
    v_mfma_f32_16x16x32_bf16 v[116:119], a[60:63], a[40:43], v[116:119]
    s_add_u32 s56, s56, 262144
    v_mfma_f32_16x16x32_bf16 v[124:127], a[60:63], a[44:47], v[124:127]
    s_waitcnt lgkmcnt(9)
    v_mfma_f32_16x16x32_bf16 v[64:67], a[16:19], a[0:3], v[64:67]
    s_add_u32 m0, s59, 16384
    ds_read_b128 a[32:35], v6 offset:8192
    s_waitcnt lgkmcnt(9)
    v_mfma_f32_16x16x32_bf16 v[72:75], a[16:19], a[4:7], v[72:75]
    ds_read_b64_tr_b16 a[48:49], v12 offset:8192
    buffer_load_dwordx4 v16, s[24:27], s57 offen offset:0 lds
    s_waitcnt lgkmcnt(9)
    v_mfma_f32_16x16x32_bf16 v[80:83], a[16:19], a[8:11], v[80:83]
    s_add_u32 s59, s58, s60
    ds_read_b64_tr_b16 a[50:51], v12 offset:12288
    s_waitcnt lgkmcnt(9)
    v_mfma_f32_16x16x32_bf16 v[88:91], a[16:19], a[12:15], v[88:91]
    s_add_u32 s58, s58, 32768
    ds_read_b128 a[36:39], v6 offset:9216
    s_waitcnt lgkmcnt(8)
    v_mfma_f32_16x16x32_bf16 v[68:71], a[20:23], a[0:3], v[68:71]
    s_cmp_ge_u32 s58, 163840
    ds_read_b128 a[40:43], v6 offset:10240
    v_mfma_f32_16x16x32_bf16 v[76:79], a[20:23], a[4:7], v[76:79]
    ds_read_b128 a[44:47], v6 offset:11264
    buffer_load_dwordx4 v17, s[24:27], s57 offen offset:1024 lds
    v_mfma_f32_16x16x32_bf16 v[84:87], a[20:23], a[8:11], v[84:87]
    s_cselect_b32 s66, 4294836224, s100
    ds_read_b64_tr_b16 a[52:53], v13 offset:8192
    v_mfma_f32_16x16x32_bf16 v[92:95], a[20:23], a[12:15], v[92:95]
    s_cselect_b32 s58, 0, s58
    ds_read_b64_tr_b16 a[54:55], v13 offset:12288
    s_waitcnt lgkmcnt(10)
    v_mfma_f32_16x16x32_bf16 v[96:99], a[24:27], a[0:3], v[96:99]
    ds_read_b64_tr_b16 a[56:57], v14 offset:8192
    v_mfma_f32_16x16x32_bf16 v[104:107], a[24:27], a[4:7], v[104:107]
    ds_read_b64_tr_b16 a[58:59], v14 offset:12288
    buffer_load_dwordx4 v18, s[24:27], s57 offen offset:2048 lds
    v_mfma_f32_16x16x32_bf16 v[112:115], a[24:27], a[8:11], v[112:115]
    ds_read_b64_tr_b16 a[60:61], v15 offset:8192
    v_mfma_f32_16x16x32_bf16 v[120:123], a[24:27], a[12:15], v[120:123]
    ds_read_b64_tr_b16 a[62:63], v15 offset:12288
    buffer_store_dwordx4 v[152:155], v2, s[8:11], s70 offen offset:2048 sc1
    s_waitcnt lgkmcnt(12)
    v_mfma_f32_16x16x32_bf16 v[100:103], a[28:31], a[0:3], v[100:103]
    v_add_u32 v6, s66, v6
    v_add_u32 v12, s66, v12
    v_mfma_f32_16x16x32_bf16 v[108:111], a[28:31], a[4:7], v[108:111]
    buffer_load_dwordx4 v19, s[24:27], s57 offen offset:3072 lds
    v_mfma_f32_16x16x32_bf16 v[116:119], a[28:31], a[8:11], v[116:119]
    s_add_u32 s57, s57, 131072
    v_add_u32 v13, s66, v13
    v_add_u32 v14, s66, v14
    v_mfma_f32_16x16x32_bf16 v[124:127], a[28:31], a[12:15], v[124:127]
    s_mov_b32 m0, s59
    v_add_u32 v15, s66, v15
    s_waitcnt vmcnt(24) lgkmcnt(0)
    v_mfma_f32_16x16x32_bf16 v[64:67], a[48:51], a[32:35], v[64:67]
    s_barrier
    v_mfma_f32_16x16x32_bf16 v[72:75], a[48:51], a[36:39], v[72:75]
    ds_read_b128 a[0:3], v6 offset:0
    buffer_load_dwordx4 v2, s[36:39], s56 offen offset:0 sc1 lds
    v_mfma_f32_16x16x32_bf16 v[80:83], a[48:51], a[40:43], v[80:83]
    ds_read_b64_tr_b16 a[16:17], v12 offset:0
    v_mfma_f32_16x16x32_bf16 v[88:91], a[48:51], a[44:47], v[88:91]
    ds_read_b64_tr_b16 a[18:19], v12 offset:4096
    v_mfma_f32_16x16x32_bf16 v[68:71], a[52:55], a[32:35], v[68:71]
    ds_read_b128 a[4:7], v6 offset:1024
    v_mfma_f32_16x16x32_bf16 v[76:79], a[52:55], a[36:39], v[76:79]
    ds_read_b128 a[8:11], v6 offset:2048
    buffer_load_dwordx4 v2, s[36:39], s56 offen offset:1024 sc1 lds
    v_mfma_f32_16x16x32_bf16 v[84:87], a[52:55], a[40:43], v[84:87]
    ds_read_b128 a[12:15], v6 offset:3072
    v_mfma_f32_16x16x32_bf16 v[92:95], a[52:55], a[44:47], v[92:95]
    ds_read_b64_tr_b16 a[20:21], v13 offset:0
    v_mfma_f32_16x16x32_bf16 v[96:99], a[56:59], a[32:35], v[96:99]
    ds_read_b64_tr_b16 a[22:23], v13 offset:4096
    v_mfma_f32_16x16x32_bf16 v[104:107], a[56:59], a[36:39], v[104:107]
    ds_read_b64_tr_b16 a[24:25], v14 offset:0
    buffer_load_dwordx4 v2, s[36:39], s56 offen offset:2048 sc1 lds
    v_mfma_f32_16x16x32_bf16 v[112:115], a[56:59], a[40:43], v[112:115]
    ds_read_b64_tr_b16 a[26:27], v14 offset:4096
    v_mfma_f32_16x16x32_bf16 v[120:123], a[56:59], a[44:47], v[120:123]
    ds_read_b64_tr_b16 a[28:29], v15 offset:0
    buffer_store_dwordx4 v[156:159], v2, s[8:11], s70 offen offset:3072 sc1
    s_add_u32 s70, s70, 4096
    v_mfma_f32_16x16x32_bf16 v[100:103], a[60:63], a[32:35], v[100:103]
    s_add_u32 s64, s64, 1
    ds_read_b64_tr_b16 a[30:31], v15 offset:4096
    v_mfma_f32_16x16x32_bf16 v[108:111], a[60:63], a[36:39], v[108:111]
    buffer_load_dwordx4 v2, s[36:39], s56 offen offset:3072 sc1 lds
    v_mfma_f32_16x16x32_bf16 v[116:119], a[60:63], a[40:43], v[116:119]
    s_add_u32 s56, s56, 262144
    v_mfma_f32_16x16x32_bf16 v[124:127], a[60:63], a[44:47], v[124:127]
    s_mov_b32 s67, 32
    s_branch m_l3126
m_n157:
    s_cmp_lg_u32 s64, 32
    s_cbranch_scc1 m_n158
    s_lshl_b32 s91, s96, 3
    s_add_u32 s91, s91, s97
    s_lshl_b32 s91, s91, 7
    s_add_u32 s91, s91, 16384
    s_cmp_lg_u32 s16, 0
    s_cbranch_scc1 m_np159
    v_mov_b32 v60, s4
    v_mov_b32 v61, s5
    s_add_u32 s90, s91, 117440512
    s_mov_b64 exec, 1
    buffer_store_dwordx2 v[60:61], off, s[8:11], s90 sc1
    s_mov_b64 exec, -1
m_np159:
    s_mov_b32 s67, 35
    s_branch m_l3126
m_n158:
    s_cmp_lg_u32 s64, 35
    s_cbranch_scc1 m_n160
    s_mov_b32 s38, 0
    s_mov_b32 s67, 40
    s_branch m_l3126
m_n160:
    s_branch m_l3x128
m_l3c129:
    s_mov_b32 s67, 34
    s_cmp_lt_u32 s64, 34
    s_cbranch_scc1 m_l3n130
    s_cmp_lg_u32 s64, 34
    s_cbranch_scc1 m_n162
    s_mov_b32 s68, 1000
    s_mov_b32 s67, 35
    s_branch m_l3126
m_n162:
    s_cmp_lg_u32 s64, 35
    s_cbranch_scc1 m_n163
    s_mov_b32 s38, 0
    s_lshl_b32 s91, s96, 3
    s_add_u32 s91, s91, s97
    s_lshl_b32 s91, s91, 7
    s_add_u32 s91, s91, 16384
    s_add_u32 s52, s91, 117440512
    buffer_load_dwordx2 v[4:5], off, s[8:11], s52 sc1
    s_mov_b32 s67, 36
    s_branch m_l3126
m_n163:
    s_cmp_lg_u32 s64, 36
    s_cbranch_scc1 m_n164
    s_mov_b32 s26, 0
    s_mov_b32 s67, 37
    s_branch m_l3126
m_n164:
    s_cmp_lg_u32 s64, 37
    s_cbranch_scc1 m_n165
    s_waitcnt vmcnt(16)
    s_mov_b32 s3, 1048576
m_spin166:
    v_cmp_ne_u64 s[76:77], s[4:5], v[4:5]
    s_nop 3
    s_cmp_eq_u64 s[76:77], 0
    s_cbranch_scc1 m_ok167
    s_sub_u32 s3, s3, 1
    s_cbranch_scc1 m_ok167
    s_sleep 8
    buffer_load_dwordx2 v[4:5], off, s[8:11], s52 sc1
    s_waitcnt vmcnt(0)
    s_branch m_spin166
m_ok167:
    s_lshl_b32 s90, s96, 3
    s_add_u32 s90, s90, s97
    s_lshl_b32 s90, s90, 15
    s_lshl_b32 s91, s16, 13
    s_add_u32 s90, s90, s91
    s_add_u32 s70, s90, 100663296
    buffer_load_dwordx4 v[128:131], v2, s[8:11], s70 offen offset:0 sc1
    buffer_load_dwordx4 v[132:135], v2, s[8:11], s70 offen offset:1024 sc1
    buffer_load_dwordx4 v[136:139], v2, s[8:11], s70 offen offset:2048 sc1
    buffer_load_dwordx4 v[140:143], v2, s[8:11], s70 offen offset:3072 sc1
    s_add_u32 s70, s70, 4096
    buffer_load_dwordx4 v[144:147], v2, s[8:11], s70 offen offset:0 sc1
    buffer_load_dwordx4 v[148:151], v2, s[8:11], s70 offen offset:1024 sc1
    buffer_load_dwordx4 v[152:155], v2, s[8:11], s70 offen offset:2048 sc1
    buffer_load_dwordx4 v[156:159], v2, s[8:11], s70 offen offset:3072 sc1
    s_mov_b32 s67, 40
    s_branch m_l3126
m_n165:
    s_branch m_l3x128
m_o1150:
    s_and_b32 s91, s2, 7
    s_lshl_b32 s91, s91, 5
    s_lshr_b32 s92, s2, 3
    s_add_u32 s91, s91, s92
    s_lshl_b32 s91, s91, 3
    s_add_u32 s91, s91, 12288
    s_cmp_lg_u32 s16, 0
    s_cbranch_scc1 m_np169
    v_mov_b32 v60, s4
    v_mov_b32 v61, s5
    s_add_u32 s90, s91, 117440512
    s_mov_b64 exec, 1
    buffer_store_dwordx2 v[60:61], off, s[8:11], s90 sc1
    s_mov_b64 exec, -1
m_np169:
    s_branch m_o2151
m_l3n130:
    s_sub_u32 s90, s68, 5
    s_min_u32 s67, s67, s90
    s_branch m_l3126
m_l3x128:
    s_cmp_eq_u32 s95, 1
    s_cbranch_scc1 m_noadd170
    s_waitcnt vmcnt(0)
    v_lshlrev_b32 v160, 16, v128
    v_and_b32 v161, 0xffff0000, v128
    v_lshlrev_b32 v162, 16, v129
    v_and_b32 v163, 0xffff0000, v129
    v_lshlrev_b32 v164, 16, v130
    v_and_b32 v165, 0xffff0000, v130
    v_lshlrev_b32 v166, 16, v131
    v_and_b32 v167, 0xffff0000, v131
    v_lshlrev_b32 v168, 16, v132
    v_and_b32 v169, 0xffff0000, v132
    v_lshlrev_b32 v170, 16, v133
    v_and_b32 v171, 0xffff0000, v133
    v_lshlrev_b32 v172, 16, v134
    v_and_b32 v173, 0xffff0000, v134
    v_lshlrev_b32 v174, 16, v135
    v_and_b32 v175, 0xffff0000, v135
    v_lshlrev_b32 v176, 16, v136
    v_and_b32 v177, 0xffff0000, v136
    v_lshlrev_b32 v178, 16, v137
    v_and_b32 v179, 0xffff0000, v137
    v_lshlrev_b32 v180, 16, v138
    v_and_b32 v181, 0xffff0000, v138
    v_lshlrev_b32 v182, 16, v139
    v_and_b32 v183, 0xffff0000, v139
    v_lshlrev_b32 v184, 16, v140
    v_and_b32 v185, 0xffff0000, v140
    v_lshlrev_b32 v186, 16, v141
    v_and_b32 v187, 0xffff0000, v141
    v_lshlrev_b32 v188, 16, v142
    v_and_b32 v189, 0xffff0000, v142
    v_lshlrev_b32 v190, 16, v143
    v_and_b32 v191, 0xffff0000, v143
    v_lshlrev_b32 v192, 16, v144
    v_and_b32 v193, 0xffff0000, v144
    v_lshlrev_b32 v194, 16, v145
    v_and_b32 v195, 0xffff0000, v145
    v_lshlrev_b32 v196, 16, v146
    v_and_b32 v197, 0xffff0000, v146
    v_lshlrev_b32 v198, 16, v147
    v_and_b32 v199, 0xffff0000, v147
    v_lshlrev_b32 v200, 16, v148
    v_and_b32 v201, 0xffff0000, v148
    v_lshlrev_b32 v202, 16, v149
    v_and_b32 v203, 0xffff0000, v149
    v_lshlrev_b32 v204, 16, v150
    v_and_b32 v205, 0xffff0000, v150
    v_lshlrev_b32 v206, 16, v151
    v_and_b32 v207, 0xffff0000, v151
    v_lshlrev_b32 v208, 16, v152
    v_and_b32 v209, 0xffff0000, v152
    v_lshlrev_b32 v210, 16, v153
    v_and_b32 v211, 0xffff0000, v153
    v_lshlrev_b32 v212, 16, v154
    v_and_b32 v213, 0xffff0000, v154
    v_lshlrev_b32 v214, 16, v155
    v_and_b32 v215, 0xffff0000, v155
    v_lshlrev_b32 v216, 16, v156
    v_and_b32 v217, 0xffff0000, v156
    v_lshlrev_b32 v218, 16, v157
    v_and_b32 v219, 0xffff0000, v157
    v_lshlrev_b32 v220, 16, v158
    v_and_b32 v221, 0xffff0000, v158
    v_lshlrev_b32 v222, 16, v159
    v_and_b32 v223, 0xffff0000, v159
    v_pk_add_f32 v[64:65], v[64:65], v[160:161]
    v_pk_add_f32 v[66:67], v[66:67], v[162:163]
    v_pk_add_f32 v[68:69], v[68:69], v[164:165]
    v_pk_add_f32 v[70:71], v[70:71], v[166:167]
    v_pk_add_f32 v[72:73], v[72:73], v[168:169]
    v_pk_add_f32 v[74:75], v[74:75], v[170:171]
    v_pk_add_f32 v[76:77], v[76:77], v[172:173]
    v_pk_add_f32 v[78:79], v[78:79], v[174:175]
    v_pk_add_f32 v[80:81], v[80:81], v[176:177]
    v_pk_add_f32 v[82:83], v[82:83], v[178:179]
    v_pk_add_f32 v[84:85], v[84:85], v[180:181]
    v_pk_add_f32 v[86:87], v[86:87], v[182:183]
    v_pk_add_f32 v[88:89], v[88:89], v[184:185]
    v_pk_add_f32 v[90:91], v[90:91], v[186:187]
    v_pk_add_f32 v[92:93], v[92:93], v[188:189]
    v_pk_add_f32 v[94:95], v[94:95], v[190:191]
    v_pk_add_f32 v[96:97], v[96:97], v[192:193]
    v_pk_add_f32 v[98:99], v[98:99], v[194:195]
    v_pk_add_f32 v[100:101], v[100:101], v[196:197]
    v_pk_add_f32 v[102:103], v[102:103], v[198:199]
    v_pk_add_f32 v[104:105], v[104:105], v[200:201]
    v_pk_add_f32 v[106:107], v[106:107], v[202:203]
    v_pk_add_f32 v[108:109], v[108:109], v[204:205]
    v_pk_add_f32 v[110:111], v[110:111], v[206:207]
    v_pk_add_f32 v[112:113], v[112:113], v[208:209]
    v_pk_add_f32 v[114:115], v[114:115], v[210:211]
    v_pk_add_f32 v[116:117], v[116:117], v[212:213]
    v_pk_add_f32 v[118:119], v[118:119], v[214:215]
    v_pk_add_f32 v[120:121], v[120:121], v[216:217]
    v_pk_add_f32 v[122:123], v[122:123], v[218:219]
    v_pk_add_f32 v[124:125], v[124:125], v[220:221]
    v_pk_add_f32 v[126:127], v[126:127], v[222:223]
m_noadd170:
    v_cvt_pk_bf16_f32 v64, v64, v65
    v_cvt_pk_bf16_f32 v65, v66, v67
    v_cvt_pk_bf16_f32 v66, v68, v69
    v_cvt_pk_bf16_f32 v67, v70, v71
    v_cvt_pk_bf16_f32 v96, v96, v97
    v_cvt_pk_bf16_f32 v97, v98, v99
    v_cvt_pk_bf16_f32 v98, v100, v101
    v_cvt_pk_bf16_f32 v99, v102, v103
    s_nop 1
    v_permlane16_swap_b32 v64, v66
    v_permlane16_swap_b32 v65, v67
    v_permlane16_swap_b32 v96, v98
    v_permlane16_swap_b32 v97, v99
    buffer_store_dwordx4 v[64:67], v7, s[28:31], s71 offen offset:0 sc1
    buffer_store_dwordx4 v[96:99], v7, s[28:31], s71 offen offset:64 sc1
    s_add_u32 s71, s71, s72
    v_cvt_pk_bf16_f32 v72, v72, v73
    v_cvt_pk_bf16_f32 v73, v74, v75
    v_cvt_pk_bf16_f32 v74, v76, v77
    v_cvt_pk_bf16_f32 v75, v78, v79
    v_cvt_pk_bf16_f32 v104, v104, v105
    v_cvt_pk_bf16_f32 v105, v106, v107
    v_cvt_pk_bf16_f32 v106, v108, v109
    v_cvt_pk_bf16_f32 v107, v110, v111
    s_nop 1
    v_permlane16_swap_b32 v72, v74
    v_permlane16_swap_b32 v73, v75
    v_permlane16_swap_b32 v104, v106
    v_permlane16_swap_b32 v105, v107
    buffer_store_dwordx4 v[72:75], v7, s[28:31], s71 offen offset:0 sc1
    buffer_store_dwordx4 v[104:107], v7, s[28:31], s71 offen offset:64 sc1
    s_add_u32 s71, s71, s72
    v_cvt_pk_bf16_f32 v80, v80, v81
    v_cvt_pk_bf16_f32 v81, v82, v83
    v_cvt_pk_bf16_f32 v82, v84, v85
    v_cvt_pk_bf16_f32 v83, v86, v87
    v_cvt_pk_bf16_f32 v112, v112, v113
    v_cvt_pk_bf16_f32 v113, v114, v115
    v_cvt_pk_bf16_f32 v114, v116, v117
    v_cvt_pk_bf16_f32 v115, v118, v119
    s_nop 1
    v_permlane16_swap_b32 v80, v82
    v_permlane16_swap_b32 v81, v83
    v_permlane16_swap_b32 v112, v114
    v_permlane16_swap_b32 v113, v115
    buffer_store_dwordx4 v[80:83], v7, s[28:31], s71 offen offset:0 sc1
    buffer_store_dwordx4 v[112:115], v7, s[28:31], s71 offen offset:64 sc1
    s_add_u32 s71, s71, s72
    v_cvt_pk_bf16_f32 v88, v88, v89
    v_cvt_pk_bf16_f32 v89, v90, v91
    v_cvt_pk_bf16_f32 v90, v92, v93
    v_cvt_pk_bf16_f32 v91, v94, v95
    v_cvt_pk_bf16_f32 v120, v120, v121
    v_cvt_pk_bf16_f32 v121, v122, v123
    v_cvt_pk_bf16_f32 v122, v124, v125
    v_cvt_pk_bf16_f32 v123, v126, v127
    s_nop 1
    v_permlane16_swap_b32 v88, v90
    v_permlane16_swap_b32 v89, v91
    v_permlane16_swap_b32 v120, v122
    v_permlane16_swap_b32 v121, v123
    buffer_store_dwordx4 v[88:91], v7, s[28:31], s71 offen offset:0 sc1
    buffer_store_dwordx4 v[120:123], v7, s[28:31], s71 offen offset:64 sc1
    s_add_u32 s71, s71, s72
m_end1:
    s_endpgm
m_stub72:
    v_cmp_lt_f32 vcc, s65, v8
    s_cmp_lg_u32 s64, s67
    s_cbranch_scc1 m_e172
    v_add_f32 v176, v176, v16
    v_mov_b32 v180, v9
    v_add_f32 v188, v188, v16
    v_add_f32 v177, v177, v17
    v_mov_b32 v181, v9
    v_add_f32 v189, v189, v17
    v_add_f32 v178, v178, v18
    v_mov_b32 v182, v9
    v_add_f32 v190, v190, v18
    v_add_f32 v179, v179, v19
    v_mov_b32 v183, v9
    v_add_f32 v191, v191, v19
    s_nop 0
m_e172:
    s_cmp_lg_u32 s64, s68
    s_cbranch_scc1 m_e173
    v_mov_b32 v176, v9
    v_mov_b32 v184, v9
    v_mov_b32 v188, v9
    v_mov_b32 v177, v9
    v_mov_b32 v185, v9
    v_mov_b32 v189, v9
    v_mov_b32 v178, v9
    v_mov_b32 v186, v9
    v_mov_b32 v190, v9
    v_mov_b32 v179, v9
    v_mov_b32 v187, v9
    v_mov_b32 v191, v9
    s_nop 0
m_e173:
    s_cbranch_vccnz m_rc174
m_sp171:
    s_branch m_ret73
m_stub75:
    v_cmp_lt_f32 vcc, s65, v8
    s_cmp_lg_u32 s64, s67
    s_cbranch_scc1 m_e176
    v_add_f32 v176, v176, v16
    v_mov_b32 v180, v9
    v_add_f32 v188, v188, v16
    v_add_f32 v177, v177, v17
    v_mov_b32 v181, v9
    v_add_f32 v189, v189, v17
    v_add_f32 v178, v178, v18
    v_mov_b32 v182, v9
    v_add_f32 v190, v190, v18
    v_add_f32 v179, v179, v19
    v_mov_b32 v183, v9
    v_add_f32 v191, v191, v19
    s_nop 0
m_e176:
    s_cmp_lg_u32 s64, s68
    s_cbranch_scc1 m_e177
    v_mov_b32 v176, v9
    v_mov_b32 v184, v9
    v_mov_b32 v188, v9
    v_mov_b32 v177, v9
    v_mov_b32 v185, v9
    v_mov_b32 v189, v9
    v_mov_b32 v178, v9
    v_mov_b32 v186, v9
    v_mov_b32 v190, v9
    v_mov_b32 v179, v9
    v_mov_b32 v187, v9
    v_mov_b32 v191, v9
    s_nop 0
m_e177:
    s_cbranch_vccnz m_rc178
m_sp175:
    s_branch m_ret76
m_stub93:
    v_cmp_lt_f32 vcc, s65, v8
    s_cmp_lg_u32 s64, s70
    s_cbranch_scc1 m_e180
    v_add_f32 v160, v160, v16
    v_mov_b32 v164, v9
    v_add_f32 v172, v172, v16
    v_add_f32 v161, v161, v17
    v_mov_b32 v165, v9
    v_add_f32 v173, v173, v17
    v_add_f32 v162, v162, v18
    v_mov_b32 v166, v9
    v_add_f32 v174, v174, v18
    v_add_f32 v163, v163, v19
    v_mov_b32 v167, v9
    v_add_f32 v175, v175, v19
    s_nop 0
m_e180:
    s_cmp_lg_u32 s64, s71
    s_cbranch_scc1 m_e181
    v_mov_b32 v160, v9
    v_mov_b32 v168, v9
    v_mov_b32 v172, v9
    v_mov_b32 v161, v9
    v_mov_b32 v169, v9
    v_mov_b32 v173, v9
    v_mov_b32 v162, v9
    v_mov_b32 v170, v9
    v_mov_b32 v174, v9
    v_mov_b32 v163, v9
    v_mov_b32 v171, v9
    v_mov_b32 v175, v9
    s_nop 0
m_e181:
    s_cbranch_vccnz m_rc182
m_sp179:
    s_branch m_ret94
m_stub95:
    v_cmp_lt_f32 vcc, s65, v8
    s_cmp_lg_u32 s64, s70
    s_cbranch_scc1 m_e184
    v_add_f32 v160, v160, v16
    v_mov_b32 v164, v9
    v_add_f32 v172, v172, v16
    v_add_f32 v161, v161, v17
    v_mov_b32 v165, v9
    v_add_f32 v173, v173, v17
    v_add_f32 v162, v162, v18
    v_mov_b32 v166, v9
    v_add_f32 v174, v174, v18
    v_add_f32 v163, v163, v19
    v_mov_b32 v167, v9
    v_add_f32 v175, v175, v19
    s_nop 0
m_e184:
    s_cmp_lg_u32 s64, s71
    s_cbranch_scc1 m_e185
    v_mov_b32 v160, v9
    v_mov_b32 v168, v9
    v_mov_b32 v172, v9
    v_mov_b32 v161, v9
    v_mov_b32 v169, v9
    v_mov_b32 v173, v9
    v_mov_b32 v162, v9
    v_mov_b32 v170, v9
    v_mov_b32 v174, v9
    v_mov_b32 v163, v9
    v_mov_b32 v171, v9
    v_mov_b32 v175, v9
    s_nop 0
m_e185:
    s_cmp_lg_u32 s64, s53
    s_cbranch_scc1 m_e188
    s_cmp_lg_u32 s16, 0
    s_cbranch_scc1 m_np189
    v_mov_b32 v60, s4
    v_mov_b32 v61, s5
    s_add_u32 s90, s17, 117440512
    s_mov_b64 exec, 1
    buffer_store_dwordx2 v[60:61], off, s[8:11], s90 sc1
    s_mov_b64 exec, -1
m_np189:
    s_mov_b32 s17, -1
m_e188:
    s_cmp_gt_u32 s64, 26
    s_cbranch_scc1 m_e186
    s_cmp_lg_u32 s64, 6
    s_cbranch_scc1 m_e190
    s_lshr_b32 s90, s32, 1
    s_lshl_b32 s90, s90, 7
    s_add_u32 s90, s90, 117440600
    v_min_u32 v0, 1, v1
    v_lshlrev_b32 v0, 5, v0
    buffer_load_dwordx2 v[4:5], v0, s[8:11], s90 offen sc1
    s_cmp_eq_u32 s17, -1
    s_cbranch_scc1 m_e186
    s_cmp_lg_u32 s16, 0
    s_cbranch_scc1 m_np191
    v_mov_b32 v60, s4
    v_mov_b32 v61, s5
    s_add_u32 s90, s17, 117440512
    s_mov_b64 exec, 1
    buffer_store_dwordx2 v[60:61], off, s[8:11], s90 sc1
    s_mov_b64 exec, -1
m_np191:
    s_branch m_e186
m_e190:
    s_cmp_lg_u32 s64, 18
    s_cbranch_scc1 m_e192
    s_waitcnt vmcnt(18)
    s_mov_b32 s3, 1048576
m_spin193:
    v_cmp_ne_u64 s[76:77], s[4:5], v[4:5]
    s_nop 3
    s_cmp_eq_u64 s[76:77], 0
    s_cbranch_scc1 m_e186
    s_sub_u32 s3, s3, 1
    s_cbranch_scc1 m_e186
    s_sleep 32
    s_lshr_b32 s90, s32, 1
    s_lshl_b32 s90, s90, 7
    s_add_u32 s90, s90, 117440600
    v_min_u32 v0, 1, v1
    v_lshlrev_b32 v0, 5, v0
    buffer_load_dwordx2 v[4:5], v0, s[8:11], s90 offen sc1
    s_waitcnt vmcnt(0)
    s_branch m_spin193
    s_branch m_e186
m_e192:
    s_cmp_lg_u32 s64, 22
    s_cbranch_scc1 m_e194
    buffer_load_dwordx2 v[4:5], v10, s[8:11], 0 offen sc1
    s_mov_b32 s44, s48
    s_mov_b32 s45, s49
    s_mov_b32 s46, 8388608
    s_lshl_b32 s90, s2, 2
    s_add_u32 s90, s90, s16
    s_lshl_b32 s90, s90, 13
    v_lshlrev_b32 v62, 7, v1
    buffer_load_dword v255, v62, s[44:47], s90 offen
    s_branch m_e186
m_e194:
    s_cmp_lg_u32 s64, 26
    s_cbranch_scc1 m_e195
    s_mov_b32 s44, s50
    s_mov_b32 s45, s51
    s_mov_b32 s46, 2097152
    s_lshl_b32 s90, s2, 2
    s_add_u32 s90, s90, s16
    s_lshl_b32 s90, s90, 13
    v_lshlrev_b32 v62, 7, v1
    buffer_load_dword v255, v62, s[44:47], s90 offen
    s_waitcnt vmcnt(18)
    s_mov_b32 s3, 1048576
m_spin196:
    v_cmp_ne_u64 s[76:77], s[4:5], v[4:5]
    s_nop 3
    s_cmp_eq_u64 s[76:77], 0
    s_cbranch_scc1 m_e186
    s_sub_u32 s3, s3, 1
    s_cbranch_scc1 m_e186
    s_sleep 32
    buffer_load_dwordx2 v[4:5], v10, s[8:11], 0 offen sc1
    s_waitcnt vmcnt(0)
    s_branch m_spin196
    s_branch m_e186
m_e195:
m_e186:
    s_cbranch_vccnz m_rc197
m_sp183:
    s_branch m_ret96
m_stub98:
    v_cmp_lt_f32 vcc, s65, v8
    s_cmp_lg_u32 s64, s70
    s_cbranch_scc1 m_e199
    v_add_f32 v160, v160, v16
    v_mov_b32 v164, v9
    v_add_f32 v172, v172, v16
    v_add_f32 v161, v161, v17
    v_mov_b32 v165, v9
    v_add_f32 v173, v173, v17
    v_add_f32 v162, v162, v18
    v_mov_b32 v166, v9
    v_add_f32 v174, v174, v18
    v_add_f32 v163, v163, v19
    v_mov_b32 v167, v9
    v_add_f32 v175, v175, v19
    s_nop 0
m_e199:
    s_cmp_lg_u32 s64, s71
    s_cbranch_scc1 m_e200
    v_mov_b32 v160, v9
    v_mov_b32 v168, v9
    v_mov_b32 v172, v9
    v_mov_b32 v161, v9
    v_mov_b32 v169, v9
    v_mov_b32 v173, v9
    v_mov_b32 v162, v9
    v_mov_b32 v170, v9
    v_mov_b32 v174, v9
    v_mov_b32 v163, v9
    v_mov_b32 v171, v9
    v_mov_b32 v175, v9
    s_nop 0
m_e200:
    s_cbranch_vccnz m_rc201
m_sp198:
    s_branch m_ret99
m_stub115:
    v_cmp_lt_f32 vcc, s65, v8
    s_cbranch_vccnz m_rc203
m_sp202:
    s_branch m_ret116
m_rc92:
    s_call_b64 s[74:75], m_rs0466
    s_branch m_sp77
m_rc114:
    s_call_b64 s[74:75], m_rs0265
    s_branch m_sp100
m_rc174:
    s_call_b64 s[74:75], m_rs0466
    s_branch m_sp171
m_rc178:
    s_call_b64 s[74:75], m_rs1468
    s_branch m_sp175
m_rc182:
    s_call_b64 s[74:75], m_rs1468
    s_branch m_sp179
m_rc197:
    s_call_b64 s[74:75], m_rs0265
    s_branch m_sp183
m_rc201:
    s_call_b64 s[74:75], m_rs1267
    s_branch m_sp198
m_rc203:
    s_call_b64 s[74:75], m_rs1267
    s_branch m_sp202
m_rs0265:
    s_nop 15
    v_max3_f32 v48, v64, v65, v66
    v_max3_f32 v48, v48, v67, v68
    v_max3_f32 v48, v48, v69, v70
    v_max3_f32 v48, v48, v71, 0
    v_mov_b32 v49, v48
    s_nop 1
    v_permlane32_swap_b32 v48, v49
    s_nop 1
    v_max_f32 v48, v48, v49
    v_mov_b32 v49, v48
    s_nop 1
    v_permlane16_swap_b32 v48, v49
    s_nop 1
    v_max_f32 v48, v48, v49
    v_exp_f32 v49, -v48
    v_sub_f32 v64, v64, v48
    v_sub_f32 v65, v65, v48
    v_sub_f32 v66, v66, v48
    v_sub_f32 v67, v67, v48
    v_sub_f32 v68, v68, v48
    v_sub_f32 v69, v69, v48
    v_sub_f32 v70, v70, v48
    v_sub_f32 v71, v71, v48
    v_sub_f32 v96, v96, v48
    v_sub_f32 v97, v97, v48
    v_sub_f32 v98, v98, v48
    v_sub_f32 v99, v99, v48
    v_sub_f32 v100, v100, v48
    v_sub_f32 v101, v101, v48
    v_sub_f32 v102, v102, v48
    v_sub_f32 v103, v103, v48
    v_sub_f32 v160, v160, v48
    v_sub_f32 v161, v161, v48
    v_sub_f32 v162, v162, v48
    v_sub_f32 v163, v163, v48
    v_sub_f32 v164, v164, v48
    v_sub_f32 v165, v165, v48
    v_sub_f32 v166, v166, v48
    v_sub_f32 v167, v167, v48
    v_mul_f32 v12, v12, v49
    v_accvgpr_read_b32 v52, a0
    v_accvgpr_read_b32 v53, a1
    v_accvgpr_read_b32 v54, a2
    v_accvgpr_read_b32 v55, a3
    v_accvgpr_read_b32 v56, a4
    v_accvgpr_read_b32 v57, a5
    v_accvgpr_read_b32 v58, a6
    v_accvgpr_read_b32 v59, a7
    v_mul_f32 v52, v52, v49
    v_mul_f32 v53, v53, v49
    v_mul_f32 v54, v54, v49
    v_mul_f32 v55, v55, v49
    v_mul_f32 v56, v56, v49
    v_mul_f32 v57, v57, v49
    v_mul_f32 v58, v58, v49
    v_mul_f32 v59, v59, v49
    v_accvgpr_write_b32 a0, v52
    v_accvgpr_write_b32 a1, v53
    v_accvgpr_write_b32 a2, v54
    v_accvgpr_write_b32 a3, v55
    v_accvgpr_write_b32 a4, v56
    v_accvgpr_write_b32 a5, v57
    v_accvgpr_write_b32 a6, v58
    v_accvgpr_write_b32 a7, v59
    v_accvgpr_read_b32 v52, a8
    v_accvgpr_read_b32 v53, a9
    v_accvgpr_read_b32 v54, a10
    v_accvgpr_read_b32 v55, a11
    v_accvgpr_read_b32 v56, a12
    v_accvgpr_read_b32 v57, a13
    v_accvgpr_read_b32 v58, a14
    v_accvgpr_read_b32 v59, a15
    v_mul_f32 v52, v52, v49
    v_mul_f32 v53, v53, v49
    v_mul_f32 v54, v54, v49
    v_mul_f32 v55, v55, v49
    v_mul_f32 v56, v56, v49
    v_mul_f32 v57, v57, v49
    v_mul_f32 v58, v58, v49
    v_mul_f32 v59, v59, v49
    v_accvgpr_write_b32 a8, v52
    v_accvgpr_write_b32 a9, v53
    v_accvgpr_write_b32 a10, v54
    v_accvgpr_write_b32 a11, v55
    v_accvgpr_write_b32 a12, v56
    v_accvgpr_write_b32 a13, v57
    v_accvgpr_write_b32 a14, v58
    v_accvgpr_write_b32 a15, v59
    v_accvgpr_read_b32 v52, a16
    v_accvgpr_read_b32 v53, a17
    v_accvgpr_read_b32 v54, a18
    v_accvgpr_read_b32 v55, a19
    v_accvgpr_read_b32 v56, a20
    v_accvgpr_read_b32 v57, a21
    v_accvgpr_read_b32 v58, a22
    v_accvgpr_read_b32 v59, a23
    v_mul_f32 v52, v52, v49
    v_mul_f32 v53, v53, v49
    v_mul_f32 v54, v54, v49
    v_mul_f32 v55, v55, v49
    v_mul_f32 v56, v56, v49
    v_mul_f32 v57, v57, v49
    v_mul_f32 v58, v58, v49
    v_mul_f32 v59, v59, v49
    v_accvgpr_write_b32 a16, v52
    v_accvgpr_write_b32 a17, v53
    v_accvgpr_write_b32 a18, v54
    v_accvgpr_write_b32 a19, v55
    v_accvgpr_write_b32 a20, v56
    v_accvgpr_write_b32 a21, v57
    v_accvgpr_write_b32 a22, v58
    v_accvgpr_write_b32 a23, v59
    v_accvgpr_read_b32 v52, a24
    v_accvgpr_read_b32 v53, a25
    v_accvgpr_read_b32 v54, a26
    v_accvgpr_read_b32 v55, a27
    v_accvgpr_read_b32 v56, a28
    v_accvgpr_read_b32 v57, a29
    v_accvgpr_read_b32 v58, a30
    v_accvgpr_read_b32 v59, a31
    v_mul_f32 v52, v52, v49
    v_mul_f32 v53, v53, v49
    v_mul_f32 v54, v54, v49
    v_mul_f32 v55, v55, v49
    v_mul_f32 v56, v56, v49
    v_mul_f32 v57, v57, v49
    v_mul_f32 v58, v58, v49
    v_mul_f32 v59, v59, v49
    v_accvgpr_write_b32 a24, v52
    v_accvgpr_write_b32 a25, v53
    v_accvgpr_write_b32 a26, v54
    v_accvgpr_write_b32 a27, v55
    v_accvgpr_write_b32 a28, v56
    v_accvgpr_write_b32 a29, v57
    v_accvgpr_write_b32 a30, v58
    v_accvgpr_write_b32 a31, v59
    v_exp_f32 v52, v64
    v_exp_f32 v53, v65
    v_exp_f32 v54, v66
    v_exp_f32 v55, v67
    v_exp_f32 v56, v68
    v_exp_f32 v57, v69
    v_exp_f32 v58, v70
    v_exp_f32 v59, v71
    s_nop 0
    v_cvt_pk_bf16_f32 v128, v52, v53
    v_cvt_pk_bf16_f32 v129, v54, v55
    v_cvt_pk_bf16_f32 v130, v56, v57
    v_cvt_pk_bf16_f32 v131, v58, v59
    s_nop 1
    v_mfma_f32_16x16x32_bf16 v[28:31], v[44:47], v[128:131], 0
    v_max3_f32 v48, v72, v73, v74
    v_max3_f32 v48, v48, v75, v76
    v_max3_f32 v48, v48, v77, v78
    v_max3_f32 v48, v48, v79, 0
    v_mov_b32 v49, v48
    s_nop 1
    v_permlane32_swap_b32 v48, v49
    s_nop 1
    v_max_f32 v48, v48, v49
    v_mov_b32 v49, v48
    s_nop 1
    v_permlane16_swap_b32 v48, v49
    s_nop 1
    v_max_f32 v48, v48, v49
    v_exp_f32 v49, -v48
    v_sub_f32 v72, v72, v48
    v_sub_f32 v73, v73, v48
    v_sub_f32 v74, v74, v48
    v_sub_f32 v75, v75, v48
    v_sub_f32 v76, v76, v48
    v_sub_f32 v77, v77, v48
    v_sub_f32 v78, v78, v48
    v_sub_f32 v79, v79, v48
    v_sub_f32 v104, v104, v48
    v_sub_f32 v105, v105, v48
    v_sub_f32 v106, v106, v48
    v_sub_f32 v107, v107, v48
    v_sub_f32 v108, v108, v48
    v_sub_f32 v109, v109, v48
    v_sub_f32 v110, v110, v48
    v_sub_f32 v111, v111, v48
    v_sub_f32 v168, v168, v48
    v_sub_f32 v169, v169, v48
    v_sub_f32 v170, v170, v48
    v_sub_f32 v171, v171, v48
    v_sub_f32 v172, v172, v48
    v_sub_f32 v173, v173, v48
    v_sub_f32 v174, v174, v48
    v_sub_f32 v175, v175, v48
    v_mul_f32 v13, v13, v49
    v_accvgpr_read_b32 v52, a32
    v_accvgpr_read_b32 v53, a33
    v_accvgpr_read_b32 v54, a34
    v_accvgpr_read_b32 v55, a35
    v_accvgpr_read_b32 v56, a36
    v_accvgpr_read_b32 v57, a37
    v_accvgpr_read_b32 v58, a38
    v_accvgpr_read_b32 v59, a39
    v_mul_f32 v52, v52, v49
    v_mul_f32 v53, v53, v49
    v_mul_f32 v54, v54, v49
    v_mul_f32 v55, v55, v49
    v_mul_f32 v56, v56, v49
    v_mul_f32 v57, v57, v49
    v_mul_f32 v58, v58, v49
    v_mul_f32 v59, v59, v49
    v_accvgpr_write_b32 a32, v52
    v_accvgpr_write_b32 a33, v53
    v_accvgpr_write_b32 a34, v54
    v_accvgpr_write_b32 a35, v55
    v_accvgpr_write_b32 a36, v56
    v_accvgpr_write_b32 a37, v57
    v_accvgpr_write_b32 a38, v58
    v_accvgpr_write_b32 a39, v59
    v_accvgpr_read_b32 v52, a40
    v_accvgpr_read_b32 v53, a41
    v_accvgpr_read_b32 v54, a42
    v_accvgpr_read_b32 v55, a43
    v_accvgpr_read_b32 v56, a44
    v_accvgpr_read_b32 v57, a45
    v_accvgpr_read_b32 v58, a46
    v_accvgpr_read_b32 v59, a47
    v_mul_f32 v52, v52, v49
    v_mul_f32 v53, v53, v49
    v_mul_f32 v54, v54, v49
    v_mul_f32 v55, v55, v49
    v_mul_f32 v56, v56, v49
    v_mul_f32 v57, v57, v49
    v_mul_f32 v58, v58, v49
    v_mul_f32 v59, v59, v49
    v_accvgpr_write_b32 a40, v52
    v_accvgpr_write_b32 a41, v53
    v_accvgpr_write_b32 a42, v54
    v_accvgpr_write_b32 a43, v55
    v_accvgpr_write_b32 a44, v56
    v_accvgpr_write_b32 a45, v57
    v_accvgpr_write_b32 a46, v58
    v_accvgpr_write_b32 a47, v59
    v_accvgpr_read_b32 v52, a48
    v_accvgpr_read_b32 v53, a49
    v_accvgpr_read_b32 v54, a50
    v_accvgpr_read_b32 v55, a51
    v_accvgpr_read_b32 v56, a52
    v_accvgpr_read_b32 v57, a53
    v_accvgpr_read_b32 v58, a54
    v_accvgpr_read_b32 v59, a55
    v_mul_f32 v52, v52, v49
    v_mul_f32 v53, v53, v49
    v_mul_f32 v54, v54, v49
    v_mul_f32 v55, v55, v49
    v_mul_f32 v56, v56, v49
    v_mul_f32 v57, v57, v49
    v_mul_f32 v58, v58, v49
    v_mul_f32 v59, v59, v49
    v_accvgpr_write_b32 a48, v52
    v_accvgpr_write_b32 a49, v53
    v_accvgpr_write_b32 a50, v54
    v_accvgpr_write_b32 a51, v55
    v_accvgpr_write_b32 a52, v56
    v_accvgpr_write_b32 a53, v57
    v_accvgpr_write_b32 a54, v58
    v_accvgpr_write_b32 a55, v59
    v_accvgpr_read_b32 v52, a56
    v_accvgpr_read_b32 v53, a57
    v_accvgpr_read_b32 v54, a58
    v_accvgpr_read_b32 v55, a59
    v_accvgpr_read_b32 v56, a60
    v_accvgpr_read_b32 v57, a61
    v_accvgpr_read_b32 v58, a62
    v_accvgpr_read_b32 v59, a63
    v_mul_f32 v52, v52, v49
    v_mul_f32 v53, v53, v49
    v_mul_f32 v54, v54, v49
    v_mul_f32 v55, v55, v49
    v_mul_f32 v56, v56, v49
    v_mul_f32 v57, v57, v49
    v_mul_f32 v58, v58, v49
    v_mul_f32 v59, v59, v49
    v_accvgpr_write_b32 a56, v52
    v_accvgpr_write_b32 a57, v53
    v_accvgpr_write_b32 a58, v54
    v_accvgpr_write_b32 a59, v55
    v_accvgpr_write_b32 a60, v56
    v_accvgpr_write_b32 a61, v57
    v_accvgpr_write_b32 a62, v58
    v_accvgpr_write_b32 a63, v59
    v_exp_f32 v52, v72
    v_exp_f32 v53, v73
    v_exp_f32 v54, v74
    v_exp_f32 v55, v75
    v_exp_f32 v56, v76
    v_exp_f32 v57, v77
    v_exp_f32 v58, v78
    v_exp_f32 v59, v79
    s_nop 0
    v_cvt_pk_bf16_f32 v132, v52, v53
    v_cvt_pk_bf16_f32 v133, v54, v55
    v_cvt_pk_bf16_f32 v134, v56, v57
    v_cvt_pk_bf16_f32 v135, v58, v59
    s_nop 1
    v_mfma_f32_16x16x32_bf16 v[32:35], v[44:47], v[132:135], 0
    s_nop 7
    s_setpc_b64 s[74:75]
m_rs0466:
    s_nop 15
    v_max3_f32 v48, v64, v65, v66
    v_max3_f32 v48, v48, v67, v68
    v_max3_f32 v48, v48, v69, v70
    v_max3_f32 v48, v48, v71, 0
    v_mov_b32 v49, v48
    s_nop 1
    v_permlane32_swap_b32 v48, v49
    s_nop 1
    v_max_f32 v48, v48, v49
    v_mov_b32 v49, v48
    s_nop 1
    v_permlane16_swap_b32 v48, v49
    s_nop 1
    v_max_f32 v48, v48, v49
    v_exp_f32 v49, -v48
    v_sub_f32 v64, v64, v48
    v_sub_f32 v65, v65, v48
    v_sub_f32 v66, v66, v48
    v_sub_f32 v67, v67, v48
    v_sub_f32 v68, v68, v48
    v_sub_f32 v69, v69, v48
    v_sub_f32 v70, v70, v48
    v_sub_f32 v71, v71, v48
    v_sub_f32 v96, v96, v48
    v_sub_f32 v97, v97, v48
    v_sub_f32 v98, v98, v48
    v_sub_f32 v99, v99, v48
    v_sub_f32 v100, v100, v48
    v_sub_f32 v101, v101, v48
    v_sub_f32 v102, v102, v48
    v_sub_f32 v103, v103, v48
    v_sub_f32 v160, v160, v48
    v_sub_f32 v161, v161, v48
    v_sub_f32 v162, v162, v48
    v_sub_f32 v163, v163, v48
    v_sub_f32 v164, v164, v48
    v_sub_f32 v165, v165, v48
    v_sub_f32 v166, v166, v48
    v_sub_f32 v167, v167, v48
    v_mul_f32 v12, v12, v49
    v_accvgpr_read_b32 v52, a0
    v_accvgpr_read_b32 v53, a1
    v_accvgpr_read_b32 v54, a2
    v_accvgpr_read_b32 v55, a3
    v_accvgpr_read_b32 v56, a4
    v_accvgpr_read_b32 v57, a5
    v_accvgpr_read_b32 v58, a6
    v_accvgpr_read_b32 v59, a7
    v_mul_f32 v52, v52, v49
    v_mul_f32 v53, v53, v49
    v_mul_f32 v54, v54, v49
    v_mul_f32 v55, v55, v49
    v_mul_f32 v56, v56, v49
    v_mul_f32 v57, v57, v49
    v_mul_f32 v58, v58, v49
    v_mul_f32 v59, v59, v49
    v_accvgpr_write_b32 a0, v52
    v_accvgpr_write_b32 a1, v53
    v_accvgpr_write_b32 a2, v54
    v_accvgpr_write_b32 a3, v55
    v_accvgpr_write_b32 a4, v56
    v_accvgpr_write_b32 a5, v57
    v_accvgpr_write_b32 a6, v58
    v_accvgpr_write_b32 a7, v59
    v_accvgpr_read_b32 v52, a8
    v_accvgpr_read_b32 v53, a9
    v_accvgpr_read_b32 v54, a10
    v_accvgpr_read_b32 v55, a11
    v_accvgpr_read_b32 v56, a12
    v_accvgpr_read_b32 v57, a13
    v_accvgpr_read_b32 v58, a14
    v_accvgpr_read_b32 v59, a15
    v_mul_f32 v52, v52, v49
    v_mul_f32 v53, v53, v49
    v_mul_f32 v54, v54, v49
    v_mul_f32 v55, v55, v49
    v_mul_f32 v56, v56, v49
    v_mul_f32 v57, v57, v49
    v_mul_f32 v58, v58, v49
    v_mul_f32 v59, v59, v49
    v_accvgpr_write_b32 a8, v52
    v_accvgpr_write_b32 a9, v53
    v_accvgpr_write_b32 a10, v54
    v_accvgpr_write_b32 a11, v55
    v_accvgpr_write_b32 a12, v56
    v_accvgpr_write_b32 a13, v57
    v_accvgpr_write_b32 a14, v58
    v_accvgpr_write_b32 a15, v59
    v_accvgpr_read_b32 v52, a16
    v_accvgpr_read_b32 v53, a17
    v_accvgpr_read_b32 v54, a18
    v_accvgpr_read_b32 v55, a19
    v_accvgpr_read_b32 v56, a20
    v_accvgpr_read_b32 v57, a21
    v_accvgpr_read_b32 v58, a22
    v_accvgpr_read_b32 v59, a23
    v_mul_f32 v52, v52, v49
    v_mul_f32 v53, v53, v49
    v_mul_f32 v54, v54, v49
    v_mul_f32 v55, v55, v49
    v_mul_f32 v56, v56, v49
    v_mul_f32 v57, v57, v49
    v_mul_f32 v58, v58, v49
    v_mul_f32 v59, v59, v49
    v_accvgpr_write_b32 a16, v52
    v_accvgpr_write_b32 a17, v53
    v_accvgpr_write_b32 a18, v54
    v_accvgpr_write_b32 a19, v55
    v_accvgpr_write_b32 a20, v56
    v_accvgpr_write_b32 a21, v57
    v_accvgpr_write_b32 a22, v58
    v_accvgpr_write_b32 a23, v59
    v_accvgpr_read_b32 v52, a24
    v_accvgpr_read_b32 v53, a25
    v_accvgpr_read_b32 v54, a26
    v_accvgpr_read_b32 v55, a27
    v_accvgpr_read_b32 v56, a28
    v_accvgpr_read_b32 v57, a29
    v_accvgpr_read_b32 v58, a30
    v_accvgpr_read_b32 v59, a31
    v_mul_f32 v52, v52, v49
    v_mul_f32 v53, v53, v49
    v_mul_f32 v54, v54, v49
    v_mul_f32 v55, v55, v49
    v_mul_f32 v56, v56, v49
    v_mul_f32 v57, v57, v49
    v_mul_f32 v58, v58, v49
    v_mul_f32 v59, v59, v49
    v_accvgpr_write_b32 a24, v52
    v_accvgpr_write_b32 a25, v53
    v_accvgpr_write_b32 a26, v54
    v_accvgpr_write_b32 a27, v55
    v_accvgpr_write_b32 a28, v56
    v_accvgpr_write_b32 a29, v57
    v_accvgpr_write_b32 a30, v58
    v_accvgpr_write_b32 a31, v59
    v_exp_f32 v52, v64
    v_exp_f32 v53, v65
    v_exp_f32 v54, v66
    v_exp_f32 v55, v67
    v_exp_f32 v56, v68
    v_exp_f32 v57, v69
    v_exp_f32 v58, v70
    v_exp_f32 v59, v71
    s_nop 0
    v_cvt_pk_bf16_f32 v128, v52, v53
    v_cvt_pk_bf16_f32 v129, v54, v55
    v_cvt_pk_bf16_f32 v130, v56, v57
    v_cvt_pk_bf16_f32 v131, v58, v59
    s_nop 1
    v_mfma_f32_16x16x32_bf16 v[28:31], v[44:47], v[128:131], 0
    v_max3_f32 v48, v72, v73, v74
    v_max3_f32 v48, v48, v75, v76
    v_max3_f32 v48, v48, v77, v78
    v_max3_f32 v48, v48, v79, 0
    v_mov_b32 v49, v48
    s_nop 1
    v_permlane32_swap_b32 v48, v49
    s_nop 1
    v_max_f32 v48, v48, v49
    v_mov_b32 v49, v48
    s_nop 1
    v_permlane16_swap_b32 v48, v49
    s_nop 1
    v_max_f32 v48, v48, v49
    v_exp_f32 v49, -v48
    v_sub_f32 v72, v72, v48
    v_sub_f32 v73, v73, v48
    v_sub_f32 v74, v74, v48
    v_sub_f32 v75, v75, v48
    v_sub_f32 v76, v76, v48
    v_sub_f32 v77, v77, v48
    v_sub_f32 v78, v78, v48
    v_sub_f32 v79, v79, v48
    v_sub_f32 v104, v104, v48
    v_sub_f32 v105, v105, v48
    v_sub_f32 v106, v106, v48
    v_sub_f32 v107, v107, v48
    v_sub_f32 v108, v108, v48
    v_sub_f32 v109, v109, v48
    v_sub_f32 v110, v110, v48
    v_sub_f32 v111, v111, v48
    v_sub_f32 v168, v168, v48
    v_sub_f32 v169, v169, v48
    v_sub_f32 v170, v170, v48
    v_sub_f32 v171, v171, v48
    v_sub_f32 v172, v172, v48
    v_sub_f32 v173, v173, v48
    v_sub_f32 v174, v174, v48
    v_sub_f32 v175, v175, v48
    v_mul_f32 v13, v13, v49
    v_accvgpr_read_b32 v52, a32
    v_accvgpr_read_b32 v53, a33
    v_accvgpr_read_b32 v54, a34
    v_accvgpr_read_b32 v55, a35
    v_accvgpr_read_b32 v56, a36
    v_accvgpr_read_b32 v57, a37
    v_accvgpr_read_b32 v58, a38
    v_accvgpr_read_b32 v59, a39
    v_mul_f32 v52, v52, v49
    v_mul_f32 v53, v53, v49
    v_mul_f32 v54, v54, v49
    v_mul_f32 v55, v55, v49
    v_mul_f32 v56, v56, v49
    v_mul_f32 v57, v57, v49
    v_mul_f32 v58, v58, v49
    v_mul_f32 v59, v59, v49
    v_accvgpr_write_b32 a32, v52
    v_accvgpr_write_b32 a33, v53
    v_accvgpr_write_b32 a34, v54
    v_accvgpr_write_b32 a35, v55
    v_accvgpr_write_b32 a36, v56
    v_accvgpr_write_b32 a37, v57
    v_accvgpr_write_b32 a38, v58
    v_accvgpr_write_b32 a39, v59
    v_accvgpr_read_b32 v52, a40
    v_accvgpr_read_b32 v53, a41
    v_accvgpr_read_b32 v54, a42
    v_accvgpr_read_b32 v55, a43
    v_accvgpr_read_b32 v56, a44
    v_accvgpr_read_b32 v57, a45
    v_accvgpr_read_b32 v58, a46
    v_accvgpr_read_b32 v59, a47
    v_mul_f32 v52, v52, v49
    v_mul_f32 v53, v53, v49
    v_mul_f32 v54, v54, v49
    v_mul_f32 v55, v55, v49
    v_mul_f32 v56, v56, v49
    v_mul_f32 v57, v57, v49
    v_mul_f32 v58, v58, v49
    v_mul_f32 v59, v59, v49
    v_accvgpr_write_b32 a40, v52
    v_accvgpr_write_b32 a41, v53
    v_accvgpr_write_b32 a42, v54
    v_accvgpr_write_b32 a43, v55
    v_accvgpr_write_b32 a44, v56
    v_accvgpr_write_b32 a45, v57
    v_accvgpr_write_b32 a46, v58
    v_accvgpr_write_b32 a47, v59
    v_accvgpr_read_b32 v52, a48
    v_accvgpr_read_b32 v53, a49
    v_accvgpr_read_b32 v54, a50
    v_accvgpr_read_b32 v55, a51
    v_accvgpr_read_b32 v56, a52
    v_accvgpr_read_b32 v57, a53
    v_accvgpr_read_b32 v58, a54
    v_accvgpr_read_b32 v59, a55
    v_mul_f32 v52, v52, v49
    v_mul_f32 v53, v53, v49
    v_mul_f32 v54, v54, v49
    v_mul_f32 v55, v55, v49
    v_mul_f32 v56, v56, v49
    v_mul_f32 v57, v57, v49
    v_mul_f32 v58, v58, v49
    v_mul_f32 v59, v59, v49
    v_accvgpr_write_b32 a48, v52
    v_accvgpr_write_b32 a49, v53
    v_accvgpr_write_b32 a50, v54
    v_accvgpr_write_b32 a51, v55
    v_accvgpr_write_b32 a52, v56
    v_accvgpr_write_b32 a53, v57
    v_accvgpr_write_b32 a54, v58
    v_accvgpr_write_b32 a55, v59
    v_accvgpr_read_b32 v52, a56
    v_accvgpr_read_b32 v53, a57
    v_accvgpr_read_b32 v54, a58
    v_accvgpr_read_b32 v55, a59
    v_accvgpr_read_b32 v56, a60
    v_accvgpr_read_b32 v57, a61
    v_accvgpr_read_b32 v58, a62
    v_accvgpr_read_b32 v59, a63
    v_mul_f32 v52, v52, v49
    v_mul_f32 v53, v53, v49
    v_mul_f32 v54, v54, v49
    v_mul_f32 v55, v55, v49
    v_mul_f32 v56, v56, v49
    v_mul_f32 v57, v57, v49
    v_mul_f32 v58, v58, v49
    v_mul_f32 v59, v59, v49
    v_accvgpr_write_b32 a56, v52
    v_accvgpr_write_b32 a57, v53
    v_accvgpr_write_b32 a58, v54
    v_accvgpr_write_b32 a59, v55
    v_accvgpr_write_b32 a60, v56
    v_accvgpr_write_b32 a61, v57
    v_accvgpr_write_b32 a62, v58
    v_accvgpr_write_b32 a63, v59
    v_exp_f32 v52, v72
    v_exp_f32 v53, v73
    v_exp_f32 v54, v74
    v_exp_f32 v55, v75
    v_exp_f32 v56, v76
    v_exp_f32 v57, v77
    v_exp_f32 v58, v78
    v_exp_f32 v59, v79
    s_nop 0
    v_cvt_pk_bf16_f32 v132, v52, v53
    v_cvt_pk_bf16_f32 v133, v54, v55
    v_cvt_pk_bf16_f32 v134, v56, v57
    v_cvt_pk_bf16_f32 v135, v58, v59
    s_nop 1
    v_mfma_f32_16x16x32_bf16 v[32:35], v[44:47], v[132:135], 0
    v_max3_f32 v48, v80, v81, v82
    v_max3_f32 v48, v48, v83, v84
    v_max3_f32 v48, v48, v85, v86
    v_max3_f32 v48, v48, v87, 0
    v_mov_b32 v49, v48
    s_nop 1
    v_permlane32_swap_b32 v48, v49
    s_nop 1
    v_max_f32 v48, v48, v49
    v_mov_b32 v49, v48
    s_nop 1
    v_permlane16_swap_b32 v48, v49
    s_nop 1
    v_max_f32 v48, v48, v49
    v_exp_f32 v49, -v48
    v_sub_f32 v80, v80, v48
    v_sub_f32 v81, v81, v48
    v_sub_f32 v82, v82, v48
    v_sub_f32 v83, v83, v48
    v_sub_f32 v84, v84, v48
    v_sub_f32 v85, v85, v48
    v_sub_f32 v86, v86, v48
    v_sub_f32 v87, v87, v48
    v_sub_f32 v112, v112, v48
    v_sub_f32 v113, v113, v48
    v_sub_f32 v114, v114, v48
    v_sub_f32 v115, v115, v48
    v_sub_f32 v116, v116, v48
    v_sub_f32 v117, v117, v48
    v_sub_f32 v118, v118, v48
    v_sub_f32 v119, v119, v48
    v_sub_f32 v176, v176, v48
    v_sub_f32 v177, v177, v48
    v_sub_f32 v178, v178, v48
    v_sub_f32 v179, v179, v48
    v_sub_f32 v180, v180, v48
    v_sub_f32 v181, v181, v48
    v_sub_f32 v182, v182, v48
    v_sub_f32 v183, v183, v48
    v_mul_f32 v14, v14, v49
    v_accvgpr_read_b32 v52, a64
    v_accvgpr_read_b32 v53, a65
    v_accvgpr_read_b32 v54, a66
    v_accvgpr_read_b32 v55, a67
    v_accvgpr_read_b32 v56, a68
    v_accvgpr_read_b32 v57, a69
    v_accvgpr_read_b32 v58, a70
    v_accvgpr_read_b32 v59, a71
    v_mul_f32 v52, v52, v49
    v_mul_f32 v53, v53, v49
    v_mul_f32 v54, v54, v49
    v_mul_f32 v55, v55, v49
    v_mul_f32 v56, v56, v49
    v_mul_f32 v57, v57, v49
    v_mul_f32 v58, v58, v49
    v_mul_f32 v59, v59, v49
    v_accvgpr_write_b32 a64, v52
    v_accvgpr_write_b32 a65, v53
    v_accvgpr_write_b32 a66, v54
    v_accvgpr_write_b32 a67, v55
    v_accvgpr_write_b32 a68, v56
    v_accvgpr_write_b32 a69, v57
    v_accvgpr_write_b32 a70, v58
    v_accvgpr_write_b32 a71, v59
    v_accvgpr_read_b32 v52, a72
    v_accvgpr_read_b32 v53, a73
    v_accvgpr_read_b32 v54, a74
    v_accvgpr_read_b32 v55, a75
    v_accvgpr_read_b32 v56, a76
    v_accvgpr_read_b32 v57, a77
    v_accvgpr_read_b32 v58, a78
    v_accvgpr_read_b32 v59, a79
    v_mul_f32 v52, v52, v49
    v_mul_f32 v53, v53, v49
    v_mul_f32 v54, v54, v49
    v_mul_f32 v55, v55, v49
    v_mul_f32 v56, v56, v49
    v_mul_f32 v57, v57, v49
    v_mul_f32 v58, v58, v49
    v_mul_f32 v59, v59, v49
    v_accvgpr_write_b32 a72, v52
    v_accvgpr_write_b32 a73, v53
    v_accvgpr_write_b32 a74, v54
    v_accvgpr_write_b32 a75, v55
    v_accvgpr_write_b32 a76, v56
    v_accvgpr_write_b32 a77, v57
    v_accvgpr_write_b32 a78, v58
    v_accvgpr_write_b32 a79, v59
    v_accvgpr_read_b32 v52, a80
    v_accvgpr_read_b32 v53, a81
    v_accvgpr_read_b32 v54, a82
    v_accvgpr_read_b32 v55, a83
    v_accvgpr_read_b32 v56, a84
    v_accvgpr_read_b32 v57, a85
    v_accvgpr_read_b32 v58, a86
    v_accvgpr_read_b32 v59, a87
    v_mul_f32 v52, v52, v49
    v_mul_f32 v53, v53, v49
    v_mul_f32 v54, v54, v49
    v_mul_f32 v55, v55, v49
    v_mul_f32 v56, v56, v49
    v_mul_f32 v57, v57, v49
    v_mul_f32 v58, v58, v49
    v_mul_f32 v59, v59, v49
    v_accvgpr_write_b32 a80, v52
    v_accvgpr_write_b32 a81, v53
    v_accvgpr_write_b32 a82, v54
    v_accvgpr_write_b32 a83, v55
    v_accvgpr_write_b32 a84, v56
    v_accvgpr_write_b32 a85, v57
    v_accvgpr_write_b32 a86, v58
    v_accvgpr_write_b32 a87, v59
    v_accvgpr_read_b32 v52, a88
    v_accvgpr_read_b32 v53, a89
    v_accvgpr_read_b32 v54, a90
    v_accvgpr_read_b32 v55, a91
    v_accvgpr_read_b32 v56, a92
    v_accvgpr_read_b32 v57, a93
    v_accvgpr_read_b32 v58, a94
    v_accvgpr_read_b32 v59, a95
    v_mul_f32 v52, v52, v49
    v_mul_f32 v53, v53, v49
    v_mul_f32 v54, v54, v49
    v_mul_f32 v55, v55, v49
    v_mul_f32 v56, v56, v49
    v_mul_f32 v57, v57, v49
    v_mul_f32 v58, v58, v49
    v_mul_f32 v59, v59, v49
    v_accvgpr_write_b32 a88, v52
    v_accvgpr_write_b32 a89, v53
    v_accvgpr_write_b32 a90, v54
    v_accvgpr_write_b32 a91, v55
    v_accvgpr_write_b32 a92, v56
    v_accvgpr_write_b32 a93, v57
    v_accvgpr_write_b32 a94, v58
    v_accvgpr_write_b32 a95, v59
    v_exp_f32 v52, v80
    v_exp_f32 v53, v81
    v_exp_f32 v54, v82
    v_exp_f32 v55, v83
    v_exp_f32 v56, v84
    v_exp_f32 v57, v85
    v_exp_f32 v58, v86
    v_exp_f32 v59, v87
    s_nop 0
    v_cvt_pk_bf16_f32 v136, v52, v53
    v_cvt_pk_bf16_f32 v137, v54, v55
    v_cvt_pk_bf16_f32 v138, v56, v57
    v_cvt_pk_bf16_f32 v139, v58, v59
    s_nop 1
    v_mfma_f32_16x16x32_bf16 v[36:39], v[44:47], v[136:139], 0
    v_max3_f32 v48, v88, v89, v90
    v_max3_f32 v48, v48, v91, v92
    v_max3_f32 v48, v48, v93, v94
    v_max3_f32 v48, v48, v95, 0
    v_mov_b32 v49, v48
    s_nop 1
    v_permlane32_swap_b32 v48, v49
    s_nop 1
    v_max_f32 v48, v48, v49
    v_mov_b32 v49, v48
    s_nop 1
    v_permlane16_swap_b32 v48, v49
    s_nop 1
    v_max_f32 v48, v48, v49
    v_exp_f32 v49, -v48
    v_sub_f32 v88, v88, v48
    v_sub_f32 v89, v89, v48
    v_sub_f32 v90, v90, v48
    v_sub_f32 v91, v91, v48
    v_sub_f32 v92, v92, v48
    v_sub_f32 v93, v93, v48
    v_sub_f32 v94, v94, v48
    v_sub_f32 v95, v95, v48
    v_sub_f32 v120, v120, v48
    v_sub_f32 v121, v121, v48
    v_sub_f32 v122, v122, v48
    v_sub_f32 v123, v123, v48
    v_sub_f32 v124, v124, v48
    v_sub_f32 v125, v125, v48
    v_sub_f32 v126, v126, v48
    v_sub_f32 v127, v127, v48
    v_sub_f32 v184, v184, v48
    v_sub_f32 v185, v185, v48
    v_sub_f32 v186, v186, v48
    v_sub_f32 v187, v187, v48
    v_sub_f32 v188, v188, v48
    v_sub_f32 v189, v189, v48
    v_sub_f32 v190, v190, v48
    v_sub_f32 v191, v191, v48
    v_mul_f32 v15, v15, v49
    v_accvgpr_read_b32 v52, a96
    v_accvgpr_read_b32 v53, a97
    v_accvgpr_read_b32 v54, a98
    v_accvgpr_read_b32 v55, a99
    v_accvgpr_read_b32 v56, a100
    v_accvgpr_read_b32 v57, a101
    v_accvgpr_read_b32 v58, a102
    v_accvgpr_read_b32 v59, a103
    v_mul_f32 v52, v52, v49
    v_mul_f32 v53, v53, v49
    v_mul_f32 v54, v54, v49
    v_mul_f32 v55, v55, v49
    v_mul_f32 v56, v56, v49
    v_mul_f32 v57, v57, v49
    v_mul_f32 v58, v58, v49
    v_mul_f32 v59, v59, v49
    v_accvgpr_write_b32 a96, v52
    v_accvgpr_write_b32 a97, v53
    v_accvgpr_write_b32 a98, v54
    v_accvgpr_write_b32 a99, v55
    v_accvgpr_write_b32 a100, v56
    v_accvgpr_write_b32 a101, v57
    v_accvgpr_write_b32 a102, v58
    v_accvgpr_write_b32 a103, v59
    v_accvgpr_read_b32 v52, a104
    v_accvgpr_read_b32 v53, a105
    v_accvgpr_read_b32 v54, a106
    v_accvgpr_read_b32 v55, a107
    v_accvgpr_read_b32 v56, a108
    v_accvgpr_read_b32 v57, a109
    v_accvgpr_read_b32 v58, a110
    v_accvgpr_read_b32 v59, a111
    v_mul_f32 v52, v52, v49
    v_mul_f32 v53, v53, v49
    v_mul_f32 v54, v54, v49
    v_mul_f32 v55, v55, v49
    v_mul_f32 v56, v56, v49
    v_mul_f32 v57, v57, v49
    v_mul_f32 v58, v58, v49
    v_mul_f32 v59, v59, v49
    v_accvgpr_write_b32 a104, v52
    v_accvgpr_write_b32 a105, v53
    v_accvgpr_write_b32 a106, v54
    v_accvgpr_write_b32 a107, v55
    v_accvgpr_write_b32 a108, v56
    v_accvgpr_write_b32 a109, v57
    v_accvgpr_write_b32 a110, v58
    v_accvgpr_write_b32 a111, v59
    v_accvgpr_read_b32 v52, a112
    v_accvgpr_read_b32 v53, a113
    v_accvgpr_read_b32 v54, a114
    v_accvgpr_read_b32 v55, a115
    v_accvgpr_read_b32 v56, a116
    v_accvgpr_read_b32 v57, a117
    v_accvgpr_read_b32 v58, a118
    v_accvgpr_read_b32 v59, a119
    v_mul_f32 v52, v52, v49
    v_mul_f32 v53, v53, v49
    v_mul_f32 v54, v54, v49
    v_mul_f32 v55, v55, v49
    v_mul_f32 v56, v56, v49
    v_mul_f32 v57, v57, v49
    v_mul_f32 v58, v58, v49
    v_mul_f32 v59, v59, v49
    v_accvgpr_write_b32 a112, v52
    v_accvgpr_write_b32 a113, v53
    v_accvgpr_write_b32 a114, v54
    v_accvgpr_write_b32 a115, v55
    v_accvgpr_write_b32 a116, v56
    v_accvgpr_write_b32 a117, v57
    v_accvgpr_write_b32 a118, v58
    v_accvgpr_write_b32 a119, v59
    v_accvgpr_read_b32 v52, a120
    v_accvgpr_read_b32 v53, a121
    v_accvgpr_read_b32 v54, a122
    v_accvgpr_read_b32 v55, a123
    v_accvgpr_read_b32 v56, a124
    v_accvgpr_read_b32 v57, a125
    v_accvgpr_read_b32 v58, a126
    v_accvgpr_read_b32 v59, a127
    v_mul_f32 v52, v52, v49
    v_mul_f32 v53, v53, v49
    v_mul_f32 v54, v54, v49
    v_mul_f32 v55, v55, v49
    v_mul_f32 v56, v56, v49
    v_mul_f32 v57, v57, v49
    v_mul_f32 v58, v58, v49
    v_mul_f32 v59, v59, v49
    v_accvgpr_write_b32 a120, v52
    v_accvgpr_write_b32 a121, v53
    v_accvgpr_write_b32 a122, v54
    v_accvgpr_write_b32 a123, v55
    v_accvgpr_write_b32 a124, v56
    v_accvgpr_write_b32 a125, v57
    v_accvgpr_write_b32 a126, v58
    v_accvgpr_write_b32 a127, v59
    v_exp_f32 v52, v88
    v_exp_f32 v53, v89
    v_exp_f32 v54, v90
    v_exp_f32 v55, v91
    v_exp_f32 v56, v92
    v_exp_f32 v57, v93
    v_exp_f32 v58, v94
    v_exp_f32 v59, v95
    s_nop 0
    v_cvt_pk_bf16_f32 v140, v52, v53
    v_cvt_pk_bf16_f32 v141, v54, v55
    v_cvt_pk_bf16_f32 v142, v56, v57
    v_cvt_pk_bf16_f32 v143, v58, v59
    s_nop 1
    v_mfma_f32_16x16x32_bf16 v[40:43], v[44:47], v[140:143], 0
    s_nop 7
    s_setpc_b64 s[74:75]
m_rs1267:
    s_nop 15
    v_max3_f32 v48, v96, v97, v98
    v_max3_f32 v48, v48, v99, v100
    v_max3_f32 v48, v48, v101, v102
    v_max3_f32 v48, v48, v103, 0
    v_mov_b32 v49, v48
    s_nop 1
    v_permlane32_swap_b32 v48, v49
    s_nop 1
    v_max_f32 v48, v48, v49
    v_mov_b32 v49, v48
    s_nop 1
    v_permlane16_swap_b32 v48, v49
    s_nop 1
    v_max_f32 v48, v48, v49
    v_exp_f32 v49, -v48
    v_sub_f32 v96, v96, v48
    v_sub_f32 v97, v97, v48
    v_sub_f32 v98, v98, v48
    v_sub_f32 v99, v99, v48
    v_sub_f32 v100, v100, v48
    v_sub_f32 v101, v101, v48
    v_sub_f32 v102, v102, v48
    v_sub_f32 v103, v103, v48
    v_sub_f32 v64, v64, v48
    v_sub_f32 v65, v65, v48
    v_sub_f32 v66, v66, v48
    v_sub_f32 v67, v67, v48
    v_sub_f32 v68, v68, v48
    v_sub_f32 v69, v69, v48
    v_sub_f32 v70, v70, v48
    v_sub_f32 v71, v71, v48
    v_sub_f32 v160, v160, v48
    v_sub_f32 v161, v161, v48
    v_sub_f32 v162, v162, v48
    v_sub_f32 v163, v163, v48
    v_sub_f32 v164, v164, v48
    v_sub_f32 v165, v165, v48
    v_sub_f32 v166, v166, v48
    v_sub_f32 v167, v167, v48
    v_mul_f32 v12, v12, v49
    v_accvgpr_read_b32 v52, a0
    v_accvgpr_read_b32 v53, a1
    v_accvgpr_read_b32 v54, a2
    v_accvgpr_read_b32 v55, a3
    v_accvgpr_read_b32 v56, a4
    v_accvgpr_read_b32 v57, a5
    v_accvgpr_read_b32 v58, a6
    v_accvgpr_read_b32 v59, a7
    v_mul_f32 v52, v52, v49
    v_mul_f32 v53, v53, v49
    v_mul_f32 v54, v54, v49
    v_mul_f32 v55, v55, v49
    v_mul_f32 v56, v56, v49
    v_mul_f32 v57, v57, v49
    v_mul_f32 v58, v58, v49
    v_mul_f32 v59, v59, v49
    v_accvgpr_write_b32 a0, v52
    v_accvgpr_write_b32 a1, v53
    v_accvgpr_write_b32 a2, v54
    v_accvgpr_write_b32 a3, v55
    v_accvgpr_write_b32 a4, v56
    v_accvgpr_write_b32 a5, v57
    v_accvgpr_write_b32 a6, v58
    v_accvgpr_write_b32 a7, v59
    v_accvgpr_read_b32 v52, a8
    v_accvgpr_read_b32 v53, a9
    v_accvgpr_read_b32 v54, a10
    v_accvgpr_read_b32 v55, a11
    v_accvgpr_read_b32 v56, a12
    v_accvgpr_read_b32 v57, a13
    v_accvgpr_read_b32 v58, a14
    v_accvgpr_read_b32 v59, a15
    v_mul_f32 v52, v52, v49
    v_mul_f32 v53, v53, v49
    v_mul_f32 v54, v54, v49
    v_mul_f32 v55, v55, v49
    v_mul_f32 v56, v56, v49
    v_mul_f32 v57, v57, v49
    v_mul_f32 v58, v58, v49
    v_mul_f32 v59, v59, v49
    v_accvgpr_write_b32 a8, v52
    v_accvgpr_write_b32 a9, v53
    v_accvgpr_write_b32 a10, v54
    v_accvgpr_write_b32 a11, v55
    v_accvgpr_write_b32 a12, v56
    v_accvgpr_write_b32 a13, v57
    v_accvgpr_write_b32 a14, v58
    v_accvgpr_write_b32 a15, v59
    v_accvgpr_read_b32 v52, a16
    v_accvgpr_read_b32 v53, a17
    v_accvgpr_read_b32 v54, a18
    v_accvgpr_read_b32 v55, a19
    v_accvgpr_read_b32 v56, a20
    v_accvgpr_read_b32 v57, a21
    v_accvgpr_read_b32 v58, a22
    v_accvgpr_read_b32 v59, a23
    v_mul_f32 v52, v52, v49
    v_mul_f32 v53, v53, v49
    v_mul_f32 v54, v54, v49
    v_mul_f32 v55, v55, v49
    v_mul_f32 v56, v56, v49
    v_mul_f32 v57, v57, v49
    v_mul_f32 v58, v58, v49
    v_mul_f32 v59, v59, v49
    v_accvgpr_write_b32 a16, v52
    v_accvgpr_write_b32 a17, v53
    v_accvgpr_write_b32 a18, v54
    v_accvgpr_write_b32 a19, v55
    v_accvgpr_write_b32 a20, v56
    v_accvgpr_write_b32 a21, v57
    v_accvgpr_write_b32 a22, v58
    v_accvgpr_write_b32 a23, v59
    v_accvgpr_read_b32 v52, a24
    v_accvgpr_read_b32 v53, a25
    v_accvgpr_read_b32 v54, a26
    v_accvgpr_read_b32 v55, a27
    v_accvgpr_read_b32 v56, a28
    v_accvgpr_read_b32 v57, a29
    v_accvgpr_read_b32 v58, a30
    v_accvgpr_read_b32 v59, a31
    v_mul_f32 v52, v52, v49
    v_mul_f32 v53, v53, v49
    v_mul_f32 v54, v54, v49
    v_mul_f32 v55, v55, v49
    v_mul_f32 v56, v56, v49
    v_mul_f32 v57, v57, v49
    v_mul_f32 v58, v58, v49
    v_mul_f32 v59, v59, v49
    v_accvgpr_write_b32 a24, v52
    v_accvgpr_write_b32 a25, v53
    v_accvgpr_write_b32 a26, v54
    v_accvgpr_write_b32 a27, v55
    v_accvgpr_write_b32 a28, v56
    v_accvgpr_write_b32 a29, v57
    v_accvgpr_write_b32 a30, v58
    v_accvgpr_write_b32 a31, v59
    v_exp_f32 v52, v96
    v_exp_f32 v53, v97
    v_exp_f32 v54, v98
    v_exp_f32 v55, v99
    v_exp_f32 v56, v100
    v_exp_f32 v57, v101
    v_exp_f32 v58, v102
    v_exp_f32 v59, v103
    s_nop 0
    v_cvt_pk_bf16_f32 v144, v52, v53
    v_cvt_pk_bf16_f32 v145, v54, v55
    v_cvt_pk_bf16_f32 v146, v56, v57
    v_cvt_pk_bf16_f32 v147, v58, v59
    s_nop 1
    v_mfma_f32_16x16x32_bf16 v[28:31], v[44:47], v[144:147], 0
    v_max3_f32 v48, v104, v105, v106
    v_max3_f32 v48, v48, v107, v108
    v_max3_f32 v48, v48, v109, v110
    v_max3_f32 v48, v48, v111, 0
    v_mov_b32 v49, v48
    s_nop 1
    v_permlane32_swap_b32 v48, v49
    s_nop 1
    v_max_f32 v48, v48, v49
    v_mov_b32 v49, v48
    s_nop 1
    v_permlane16_swap_b32 v48, v49
    s_nop 1
    v_max_f32 v48, v48, v49
    v_exp_f32 v49, -v48
    v_sub_f32 v104, v104, v48
    v_sub_f32 v105, v105, v48
    v_sub_f32 v106, v106, v48
    v_sub_f32 v107, v107, v48
    v_sub_f32 v108, v108, v48
    v_sub_f32 v109, v109, v48
    v_sub_f32 v110, v110, v48
    v_sub_f32 v111, v111, v48
    v_sub_f32 v72, v72, v48
    v_sub_f32 v73, v73, v48
    v_sub_f32 v74, v74, v48
    v_sub_f32 v75, v75, v48
    v_sub_f32 v76, v76, v48
    v_sub_f32 v77, v77, v48
    v_sub_f32 v78, v78, v48
    v_sub_f32 v79, v79, v48
    v_sub_f32 v168, v168, v48
    v_sub_f32 v169, v169, v48
    v_sub_f32 v170, v170, v48
    v_sub_f32 v171, v171, v48
    v_sub_f32 v172, v172, v48
    v_sub_f32 v173, v173, v48
    v_sub_f32 v174, v174, v48
    v_sub_f32 v175, v175, v48
    v_mul_f32 v13, v13, v49
    v_accvgpr_read_b32 v52, a32
    v_accvgpr_read_b32 v53, a33
    v_accvgpr_read_b32 v54, a34
    v_accvgpr_read_b32 v55, a35
    v_accvgpr_read_b32 v56, a36
    v_accvgpr_read_b32 v57, a37
    v_accvgpr_read_b32 v58, a38
    v_accvgpr_read_b32 v59, a39
    v_mul_f32 v52, v52, v49
    v_mul_f32 v53, v53, v49
    v_mul_f32 v54, v54, v49
    v_mul_f32 v55, v55, v49
    v_mul_f32 v56, v56, v49
    v_mul_f32 v57, v57, v49
    v_mul_f32 v58, v58, v49
    v_mul_f32 v59, v59, v49
    v_accvgpr_write_b32 a32, v52
    v_accvgpr_write_b32 a33, v53
    v_accvgpr_write_b32 a34, v54
    v_accvgpr_write_b32 a35, v55
    v_accvgpr_write_b32 a36, v56
    v_accvgpr_write_b32 a37, v57
    v_accvgpr_write_b32 a38, v58
    v_accvgpr_write_b32 a39, v59
    v_accvgpr_read_b32 v52, a40
    v_accvgpr_read_b32 v53, a41
    v_accvgpr_read_b32 v54, a42
    v_accvgpr_read_b32 v55, a43
    v_accvgpr_read_b32 v56, a44
    v_accvgpr_read_b32 v57, a45
    v_accvgpr_read_b32 v58, a46
    v_accvgpr_read_b32 v59, a47
    v_mul_f32 v52, v52, v49
    v_mul_f32 v53, v53, v49
    v_mul_f32 v54, v54, v49
    v_mul_f32 v55, v55, v49
    v_mul_f32 v56, v56, v49
    v_mul_f32 v57, v57, v49
    v_mul_f32 v58, v58, v49
    v_mul_f32 v59, v59, v49
    v_accvgpr_write_b32 a40, v52
    v_accvgpr_write_b32 a41, v53
    v_accvgpr_write_b32 a42, v54
    v_accvgpr_write_b32 a43, v55
    v_accvgpr_write_b32 a44, v56
    v_accvgpr_write_b32 a45, v57
    v_accvgpr_write_b32 a46, v58
    v_accvgpr_write_b32 a47, v59
    v_accvgpr_read_b32 v52, a48
    v_accvgpr_read_b32 v53, a49
    v_accvgpr_read_b32 v54, a50
    v_accvgpr_read_b32 v55, a51
    v_accvgpr_read_b32 v56, a52
    v_accvgpr_read_b32 v57, a53
    v_accvgpr_read_b32 v58, a54
    v_accvgpr_read_b32 v59, a55
    v_mul_f32 v52, v52, v49
    v_mul_f32 v53, v53, v49
    v_mul_f32 v54, v54, v49
    v_mul_f32 v55, v55, v49
    v_mul_f32 v56, v56, v49
    v_mul_f32 v57, v57, v49
    v_mul_f32 v58, v58, v49
    v_mul_f32 v59, v59, v49
    v_accvgpr_write_b32 a48, v52
    v_accvgpr_write_b32 a49, v53
    v_accvgpr_write_b32 a50, v54
    v_accvgpr_write_b32 a51, v55
    v_accvgpr_write_b32 a52, v56
    v_accvgpr_write_b32 a53, v57
    v_accvgpr_write_b32 a54, v58
    v_accvgpr_write_b32 a55, v59
    v_accvgpr_read_b32 v52, a56
    v_accvgpr_read_b32 v53, a57
    v_accvgpr_read_b32 v54, a58
    v_accvgpr_read_b32 v55, a59
    v_accvgpr_read_b32 v56, a60
    v_accvgpr_read_b32 v57, a61
    v_accvgpr_read_b32 v58, a62
    v_accvgpr_read_b32 v59, a63
    v_mul_f32 v52, v52, v49
    v_mul_f32 v53, v53, v49
    v_mul_f32 v54, v54, v49
    v_mul_f32 v55, v55, v49
    v_mul_f32 v56, v56, v49
    v_mul_f32 v57, v57, v49
    v_mul_f32 v58, v58, v49
    v_mul_f32 v59, v59, v49
    v_accvgpr_write_b32 a56, v52
    v_accvgpr_write_b32 a57, v53
    v_accvgpr_write_b32 a58, v54
    v_accvgpr_write_b32 a59, v55
    v_accvgpr_write_b32 a60, v56
    v_accvgpr_write_b32 a61, v57
    v_accvgpr_write_b32 a62, v58
    v_accvgpr_write_b32 a63, v59
    v_exp_f32 v52, v104
    v_exp_f32 v53, v105
    v_exp_f32 v54, v106
    v_exp_f32 v55, v107
    v_exp_f32 v56, v108
    v_exp_f32 v57, v109
    v_exp_f32 v58, v110
    v_exp_f32 v59, v111
    s_nop 0
    v_cvt_pk_bf16_f32 v148, v52, v53
    v_cvt_pk_bf16_f32 v149, v54, v55
    v_cvt_pk_bf16_f32 v150, v56, v57
    v_cvt_pk_bf16_f32 v151, v58, v59
    s_nop 1
    v_mfma_f32_16x16x32_bf16 v[32:35], v[44:47], v[148:151], 0
    s_nop 7
    s_setpc_b64 s[74:75]
m_rs1468:
    s_nop 15
    v_max3_f32 v48, v96, v97, v98
    v_max3_f32 v48, v48, v99, v100
    v_max3_f32 v48, v48, v101, v102
    v_max3_f32 v48, v48, v103, 0
    v_mov_b32 v49, v48
    s_nop 1
    v_permlane32_swap_b32 v48, v49
    s_nop 1
    v_max_f32 v48, v48, v49
    v_mov_b32 v49, v48
    s_nop 1
    v_permlane16_swap_b32 v48, v49
    s_nop 1
    v_max_f32 v48, v48, v49
    v_exp_f32 v49, -v48
    v_sub_f32 v96, v96, v48
    v_sub_f32 v97, v97, v48
    v_sub_f32 v98, v98, v48
    v_sub_f32 v99, v99, v48
    v_sub_f32 v100, v100, v48
    v_sub_f32 v101, v101, v48
    v_sub_f32 v102, v102, v48
    v_sub_f32 v103, v103, v48
    v_sub_f32 v64, v64, v48
    v_sub_f32 v65, v65, v48
    v_sub_f32 v66, v66, v48
    v_sub_f32 v67, v67, v48
    v_sub_f32 v68, v68, v48
    v_sub_f32 v69, v69, v48
    v_sub_f32 v70, v70, v48
    v_sub_f32 v71, v71, v48
    v_sub_f32 v160, v160, v48
    v_sub_f32 v161, v161, v48
    v_sub_f32 v162, v162, v48
    v_sub_f32 v163, v163, v48
    v_sub_f32 v164, v164, v48
    v_sub_f32 v165, v165, v48
    v_sub_f32 v166, v166, v48
    v_sub_f32 v167, v167, v48
    v_mul_f32 v12, v12, v49
    v_accvgpr_read_b32 v52, a0
    v_accvgpr_read_b32 v53, a1
    v_accvgpr_read_b32 v54, a2
    v_accvgpr_read_b32 v55, a3
    v_accvgpr_read_b32 v56, a4
    v_accvgpr_read_b32 v57, a5
    v_accvgpr_read_b32 v58, a6
    v_accvgpr_read_b32 v59, a7
    v_mul_f32 v52, v52, v49
    v_mul_f32 v53, v53, v49
    v_mul_f32 v54, v54, v49
    v_mul_f32 v55, v55, v49
    v_mul_f32 v56, v56, v49
    v_mul_f32 v57, v57, v49
    v_mul_f32 v58, v58, v49
    v_mul_f32 v59, v59, v49
    v_accvgpr_write_b32 a0, v52
    v_accvgpr_write_b32 a1, v53
    v_accvgpr_write_b32 a2, v54
    v_accvgpr_write_b32 a3, v55
    v_accvgpr_write_b32 a4, v56
    v_accvgpr_write_b32 a5, v57
    v_accvgpr_write_b32 a6, v58
    v_accvgpr_write_b32 a7, v59
    v_accvgpr_read_b32 v52, a8
    v_accvgpr_read_b32 v53, a9
    v_accvgpr_read_b32 v54, a10
    v_accvgpr_read_b32 v55, a11
    v_accvgpr_read_b32 v56, a12
    v_accvgpr_read_b32 v57, a13
    v_accvgpr_read_b32 v58, a14
    v_accvgpr_read_b32 v59, a15
    v_mul_f32 v52, v52, v49
    v_mul_f32 v53, v53, v49
    v_mul_f32 v54, v54, v49
    v_mul_f32 v55, v55, v49
    v_mul_f32 v56, v56, v49
    v_mul_f32 v57, v57, v49
    v_mul_f32 v58, v58, v49
    v_mul_f32 v59, v59, v49
    v_accvgpr_write_b32 a8, v52
    v_accvgpr_write_b32 a9, v53
    v_accvgpr_write_b32 a10, v54
    v_accvgpr_write_b32 a11, v55
    v_accvgpr_write_b32 a12, v56
    v_accvgpr_write_b32 a13, v57
    v_accvgpr_write_b32 a14, v58
    v_accvgpr_write_b32 a15, v59
    v_accvgpr_read_b32 v52, a16
    v_accvgpr_read_b32 v53, a17
    v_accvgpr_read_b32 v54, a18
    v_accvgpr_read_b32 v55, a19
    v_accvgpr_read_b32 v56, a20
    v_accvgpr_read_b32 v57, a21
    v_accvgpr_read_b32 v58, a22
    v_accvgpr_read_b32 v59, a23
    v_mul_f32 v52, v52, v49
    v_mul_f32 v53, v53, v49
    v_mul_f32 v54, v54, v49
    v_mul_f32 v55, v55, v49
    v_mul_f32 v56, v56, v49
    v_mul_f32 v57, v57, v49
    v_mul_f32 v58, v58, v49
    v_mul_f32 v59, v59, v49
    v_accvgpr_write_b32 a16, v52
    v_accvgpr_write_b32 a17, v53
    v_accvgpr_write_b32 a18, v54
    v_accvgpr_write_b32 a19, v55
    v_accvgpr_write_b32 a20, v56
    v_accvgpr_write_b32 a21, v57
    v_accvgpr_write_b32 a22, v58
    v_accvgpr_write_b32 a23, v59
    v_accvgpr_read_b32 v52, a24
    v_accvgpr_read_b32 v53, a25
    v_accvgpr_read_b32 v54, a26
    v_accvgpr_read_b32 v55, a27
    v_accvgpr_read_b32 v56, a28
    v_accvgpr_read_b32 v57, a29
    v_accvgpr_read_b32 v58, a30
    v_accvgpr_read_b32 v59, a31
    v_mul_f32 v52, v52, v49
    v_mul_f32 v53, v53, v49
    v_mul_f32 v54, v54, v49
    v_mul_f32 v55, v55, v49
    v_mul_f32 v56, v56, v49
    v_mul_f32 v57, v57, v49
    v_mul_f32 v58, v58, v49
    v_mul_f32 v59, v59, v49
    v_accvgpr_write_b32 a24, v52
    v_accvgpr_write_b32 a25, v53
    v_accvgpr_write_b32 a26, v54
    v_accvgpr_write_b32 a27, v55
    v_accvgpr_write_b32 a28, v56
    v_accvgpr_write_b32 a29, v57
    v_accvgpr_write_b32 a30, v58
    v_accvgpr_write_b32 a31, v59
    v_exp_f32 v52, v96
    v_exp_f32 v53, v97
    v_exp_f32 v54, v98
    v_exp_f32 v55, v99
    v_exp_f32 v56, v100
    v_exp_f32 v57, v101
    v_exp_f32 v58, v102
    v_exp_f32 v59, v103
    s_nop 0
    v_cvt_pk_bf16_f32 v144, v52, v53
    v_cvt_pk_bf16_f32 v145, v54, v55
    v_cvt_pk_bf16_f32 v146, v56, v57
    v_cvt_pk_bf16_f32 v147, v58, v59
    s_nop 1
    v_mfma_f32_16x16x32_bf16 v[28:31], v[44:47], v[144:147], 0
    v_max3_f32 v48, v104, v105, v106
    v_max3_f32 v48, v48, v107, v108
    v_max3_f32 v48, v48, v109, v110
    v_max3_f32 v48, v48, v111, 0
    v_mov_b32 v49, v48
    s_nop 1
    v_permlane32_swap_b32 v48, v49
    s_nop 1
    v_max_f32 v48, v48, v49
    v_mov_b32 v49, v48
    s_nop 1
    v_permlane16_swap_b32 v48, v49
    s_nop 1
    v_max_f32 v48, v48, v49
    v_exp_f32 v49, -v48
    v_sub_f32 v104, v104, v48
    v_sub_f32 v105, v105, v48
    v_sub_f32 v106, v106, v48
    v_sub_f32 v107, v107, v48
    v_sub_f32 v108, v108, v48
    v_sub_f32 v109, v109, v48
    v_sub_f32 v110, v110, v48
    v_sub_f32 v111, v111, v48
    v_sub_f32 v72, v72, v48
    v_sub_f32 v73, v73, v48
    v_sub_f32 v74, v74, v48
    v_sub_f32 v75, v75, v48
    v_sub_f32 v76, v76, v48
    v_sub_f32 v77, v77, v48
    v_sub_f32 v78, v78, v48
    v_sub_f32 v79, v79, v48
    v_sub_f32 v168, v168, v48
    v_sub_f32 v169, v169, v48
    v_sub_f32 v170, v170, v48
    v_sub_f32 v171, v171, v48
    v_sub_f32 v172, v172, v48
    v_sub_f32 v173, v173, v48
    v_sub_f32 v174, v174, v48
    v_sub_f32 v175, v175, v48
    v_mul_f32 v13, v13, v49
    v_accvgpr_read_b32 v52, a32
    v_accvgpr_read_b32 v53, a33
    v_accvgpr_read_b32 v54, a34
    v_accvgpr_read_b32 v55, a35
    v_accvgpr_read_b32 v56, a36
    v_accvgpr_read_b32 v57, a37
    v_accvgpr_read_b32 v58, a38
    v_accvgpr_read_b32 v59, a39
    v_mul_f32 v52, v52, v49
    v_mul_f32 v53, v53, v49
    v_mul_f32 v54, v54, v49
    v_mul_f32 v55, v55, v49
    v_mul_f32 v56, v56, v49
    v_mul_f32 v57, v57, v49
    v_mul_f32 v58, v58, v49
    v_mul_f32 v59, v59, v49
    v_accvgpr_write_b32 a32, v52
    v_accvgpr_write_b32 a33, v53
    v_accvgpr_write_b32 a34, v54
    v_accvgpr_write_b32 a35, v55
    v_accvgpr_write_b32 a36, v56
    v_accvgpr_write_b32 a37, v57
    v_accvgpr_write_b32 a38, v58
    v_accvgpr_write_b32 a39, v59
    v_accvgpr_read_b32 v52, a40
    v_accvgpr_read_b32 v53, a41
    v_accvgpr_read_b32 v54, a42
    v_accvgpr_read_b32 v55, a43
    v_accvgpr_read_b32 v56, a44
    v_accvgpr_read_b32 v57, a45
    v_accvgpr_read_b32 v58, a46
    v_accvgpr_read_b32 v59, a47
    v_mul_f32 v52, v52, v49
    v_mul_f32 v53, v53, v49
    v_mul_f32 v54, v54, v49
    v_mul_f32 v55, v55, v49
    v_mul_f32 v56, v56, v49
    v_mul_f32 v57, v57, v49
    v_mul_f32 v58, v58, v49
    v_mul_f32 v59, v59, v49
    v_accvgpr_write_b32 a40, v52
    v_accvgpr_write_b32 a41, v53
    v_accvgpr_write_b32 a42, v54
    v_accvgpr_write_b32 a43, v55
    v_accvgpr_write_b32 a44, v56
    v_accvgpr_write_b32 a45, v57
    v_accvgpr_write_b32 a46, v58
    v_accvgpr_write_b32 a47, v59
    v_accvgpr_read_b32 v52, a48
    v_accvgpr_read_b32 v53, a49
    v_accvgpr_read_b32 v54, a50
    v_accvgpr_read_b32 v55, a51
    v_accvgpr_read_b32 v56, a52
    v_accvgpr_read_b32 v57, a53
    v_accvgpr_read_b32 v58, a54
    v_accvgpr_read_b32 v59, a55
    v_mul_f32 v52, v52, v49
    v_mul_f32 v53, v53, v49
    v_mul_f32 v54, v54, v49
    v_mul_f32 v55, v55, v49
    v_mul_f32 v56, v56, v49
    v_mul_f32 v57, v57, v49
    v_mul_f32 v58, v58, v49
    v_mul_f32 v59, v59, v49
    v_accvgpr_write_b32 a48, v52
    v_accvgpr_write_b32 a49, v53
    v_accvgpr_write_b32 a50, v54
    v_accvgpr_write_b32 a51, v55
    v_accvgpr_write_b32 a52, v56
    v_accvgpr_write_b32 a53, v57
    v_accvgpr_write_b32 a54, v58
    v_accvgpr_write_b32 a55, v59
    v_accvgpr_read_b32 v52, a56
    v_accvgpr_read_b32 v53, a57
    v_accvgpr_read_b32 v54, a58
    v_accvgpr_read_b32 v55, a59
    v_accvgpr_read_b32 v56, a60
    v_accvgpr_read_b32 v57, a61
    v_accvgpr_read_b32 v58, a62
    v_accvgpr_read_b32 v59, a63
    v_mul_f32 v52, v52, v49
    v_mul_f32 v53, v53, v49
    v_mul_f32 v54, v54, v49
    v_mul_f32 v55, v55, v49
    v_mul_f32 v56, v56, v49
    v_mul_f32 v57, v57, v49
    v_mul_f32 v58, v58, v49
    v_mul_f32 v59, v59, v49
    v_accvgpr_write_b32 a56, v52
    v_accvgpr_write_b32 a57, v53
    v_accvgpr_write_b32 a58, v54
    v_accvgpr_write_b32 a59, v55
    v_accvgpr_write_b32 a60, v56
    v_accvgpr_write_b32 a61, v57
    v_accvgpr_write_b32 a62, v58
    v_accvgpr_write_b32 a63, v59
    v_exp_f32 v52, v104
    v_exp_f32 v53, v105
    v_exp_f32 v54, v106
    v_exp_f32 v55, v107
    v_exp_f32 v56, v108
    v_exp_f32 v57, v109
    v_exp_f32 v58, v110
    v_exp_f32 v59, v111
    s_nop 0
    v_cvt_pk_bf16_f32 v148, v52, v53
    v_cvt_pk_bf16_f32 v149, v54, v55
    v_cvt_pk_bf16_f32 v150, v56, v57
    v_cvt_pk_bf16_f32 v151, v58, v59
    s_nop 1
    v_mfma_f32_16x16x32_bf16 v[32:35], v[44:47], v[148:151], 0
    v_max3_f32 v48, v112, v113, v114
    v_max3_f32 v48, v48, v115, v116
    v_max3_f32 v48, v48, v117, v118
    v_max3_f32 v48, v48, v119, 0
    v_mov_b32 v49, v48
    s_nop 1
    v_permlane32_swap_b32 v48, v49
    s_nop 1
    v_max_f32 v48, v48, v49
    v_mov_b32 v49, v48
    s_nop 1
    v_permlane16_swap_b32 v48, v49
    s_nop 1
    v_max_f32 v48, v48, v49
    v_exp_f32 v49, -v48
    v_sub_f32 v112, v112, v48
    v_sub_f32 v113, v113, v48
    v_sub_f32 v114, v114, v48
    v_sub_f32 v115, v115, v48
    v_sub_f32 v116, v116, v48
    v_sub_f32 v117, v117, v48
    v_sub_f32 v118, v118, v48
    v_sub_f32 v119, v119, v48
    v_sub_f32 v80, v80, v48
    v_sub_f32 v81, v81, v48
    v_sub_f32 v82, v82, v48
    v_sub_f32 v83, v83, v48
    v_sub_f32 v84, v84, v48
    v_sub_f32 v85, v85, v48
    v_sub_f32 v86, v86, v48
    v_sub_f32 v87, v87, v48
    v_sub_f32 v176, v176, v48
    v_sub_f32 v177, v177, v48
    v_sub_f32 v178, v178, v48
    v_sub_f32 v179, v179, v48
    v_sub_f32 v180, v180, v48
    v_sub_f32 v181, v181, v48
    v_sub_f32 v182, v182, v48
    v_sub_f32 v183, v183, v48
    v_mul_f32 v14, v14, v49
    v_accvgpr_read_b32 v52, a64
    v_accvgpr_read_b32 v53, a65
    v_accvgpr_read_b32 v54, a66
    v_accvgpr_read_b32 v55, a67
    v_accvgpr_read_b32 v56, a68
    v_accvgpr_read_b32 v57, a69
    v_accvgpr_read_b32 v58, a70
    v_accvgpr_read_b32 v59, a71
    v_mul_f32 v52, v52, v49
    v_mul_f32 v53, v53, v49
    v_mul_f32 v54, v54, v49
    v_mul_f32 v55, v55, v49
    v_mul_f32 v56, v56, v49
    v_mul_f32 v57, v57, v49
    v_mul_f32 v58, v58, v49
    v_mul_f32 v59, v59, v49
    v_accvgpr_write_b32 a64, v52
    v_accvgpr_write_b32 a65, v53
    v_accvgpr_write_b32 a66, v54
    v_accvgpr_write_b32 a67, v55
    v_accvgpr_write_b32 a68, v56
    v_accvgpr_write_b32 a69, v57
    v_accvgpr_write_b32 a70, v58
    v_accvgpr_write_b32 a71, v59
    v_accvgpr_read_b32 v52, a72
    v_accvgpr_read_b32 v53, a73
    v_accvgpr_read_b32 v54, a74
    v_accvgpr_read_b32 v55, a75
    v_accvgpr_read_b32 v56, a76
    v_accvgpr_read_b32 v57, a77
    v_accvgpr_read_b32 v58, a78
    v_accvgpr_read_b32 v59, a79
    v_mul_f32 v52, v52, v49
    v_mul_f32 v53, v53, v49
    v_mul_f32 v54, v54, v49
    v_mul_f32 v55, v55, v49
    v_mul_f32 v56, v56, v49
    v_mul_f32 v57, v57, v49
    v_mul_f32 v58, v58, v49
    v_mul_f32 v59, v59, v49
    v_accvgpr_write_b32 a72, v52
    v_accvgpr_write_b32 a73, v53
    v_accvgpr_write_b32 a74, v54
    v_accvgpr_write_b32 a75, v55
    v_accvgpr_write_b32 a76, v56
    v_accvgpr_write_b32 a77, v57
    v_accvgpr_write_b32 a78, v58
    v_accvgpr_write_b32 a79, v59
    v_accvgpr_read_b32 v52, a80
    v_accvgpr_read_b32 v53, a81
    v_accvgpr_read_b32 v54, a82
    v_accvgpr_read_b32 v55, a83
    v_accvgpr_read_b32 v56, a84
    v_accvgpr_read_b32 v57, a85
    v_accvgpr_read_b32 v58, a86
    v_accvgpr_read_b32 v59, a87
    v_mul_f32 v52, v52, v49
    v_mul_f32 v53, v53, v49
    v_mul_f32 v54, v54, v49
    v_mul_f32 v55, v55, v49
    v_mul_f32 v56, v56, v49
    v_mul_f32 v57, v57, v49
    v_mul_f32 v58, v58, v49
    v_mul_f32 v59, v59, v49
    v_accvgpr_write_b32 a80, v52
    v_accvgpr_write_b32 a81, v53
    v_accvgpr_write_b32 a82, v54
    v_accvgpr_write_b32 a83, v55
    v_accvgpr_write_b32 a84, v56
    v_accvgpr_write_b32 a85, v57
    v_accvgpr_write_b32 a86, v58
    v_accvgpr_write_b32 a87, v59
    v_accvgpr_read_b32 v52, a88
    v_accvgpr_read_b32 v53, a89
    v_accvgpr_read_b32 v54, a90
    v_accvgpr_read_b32 v55, a91
    v_accvgpr_read_b32 v56, a92
    v_accvgpr_read_b32 v57, a93
    v_accvgpr_read_b32 v58, a94
    v_accvgpr_read_b32 v59, a95
    v_mul_f32 v52, v52, v49
    v_mul_f32 v53, v53, v49
    v_mul_f32 v54, v54, v49
    v_mul_f32 v55, v55, v49
    v_mul_f32 v56, v56, v49
    v_mul_f32 v57, v57, v49
    v_mul_f32 v58, v58, v49
    v_mul_f32 v59, v59, v49
    v_accvgpr_write_b32 a88, v52
    v_accvgpr_write_b32 a89, v53
    v_accvgpr_write_b32 a90, v54
    v_accvgpr_write_b32 a91, v55
    v_accvgpr_write_b32 a92, v56
    v_accvgpr_write_b32 a93, v57
    v_accvgpr_write_b32 a94, v58
    v_accvgpr_write_b32 a95, v59
    v_exp_f32 v52, v112
    v_exp_f32 v53, v113
    v_exp_f32 v54, v114
    v_exp_f32 v55, v115
    v_exp_f32 v56, v116
    v_exp_f32 v57, v117
    v_exp_f32 v58, v118
    v_exp_f32 v59, v119
    s_nop 0
    v_cvt_pk_bf16_f32 v152, v52, v53
    v_cvt_pk_bf16_f32 v153, v54, v55
    v_cvt_pk_bf16_f32 v154, v56, v57
    v_cvt_pk_bf16_f32 v155, v58, v59
    s_nop 1
    v_mfma_f32_16x16x32_bf16 v[36:39], v[44:47], v[152:155], 0
    v_max3_f32 v48, v120, v121, v122
    v_max3_f32 v48, v48, v123, v124
    v_max3_f32 v48, v48, v125, v126
    v_max3_f32 v48, v48, v127, 0
    v_mov_b32 v49, v48
    s_nop 1
    v_permlane32_swap_b32 v48, v49
    s_nop 1
    v_max_f32 v48, v48, v49
    v_mov_b32 v49, v48
    s_nop 1
    v_permlane16_swap_b32 v48, v49
    s_nop 1
    v_max_f32 v48, v48, v49
    v_exp_f32 v49, -v48
    v_sub_f32 v120, v120, v48
    v_sub_f32 v121, v121, v48
    v_sub_f32 v122, v122, v48
    v_sub_f32 v123, v123, v48
    v_sub_f32 v124, v124, v48
    v_sub_f32 v125, v125, v48
    v_sub_f32 v126, v126, v48
    v_sub_f32 v127, v127, v48
    v_sub_f32 v88, v88, v48
    v_sub_f32 v89, v89, v48
    v_sub_f32 v90, v90, v48
    v_sub_f32 v91, v91, v48
    v_sub_f32 v92, v92, v48
    v_sub_f32 v93, v93, v48
    v_sub_f32 v94, v94, v48
    v_sub_f32 v95, v95, v48
    v_sub_f32 v184, v184, v48
    v_sub_f32 v185, v185, v48
    v_sub_f32 v186, v186, v48
    v_sub_f32 v187, v187, v48
    v_sub_f32 v188, v188, v48
    v_sub_f32 v189, v189, v48
    v_sub_f32 v190, v190, v48
    v_sub_f32 v191, v191, v48
    v_mul_f32 v15, v15, v49
    v_accvgpr_read_b32 v52, a96
    v_accvgpr_read_b32 v53, a97
    v_accvgpr_read_b32 v54, a98
    v_accvgpr_read_b32 v55, a99
    v_accvgpr_read_b32 v56, a100
    v_accvgpr_read_b32 v57, a101
    v_accvgpr_read_b32 v58, a102
    v_accvgpr_read_b32 v59, a103
    v_mul_f32 v52, v52, v49
    v_mul_f32 v53, v53, v49
    v_mul_f32 v54, v54, v49
    v_mul_f32 v55, v55, v49
    v_mul_f32 v56, v56, v49
    v_mul_f32 v57, v57, v49
    v_mul_f32 v58, v58, v49
    v_mul_f32 v59, v59, v49
    v_accvgpr_write_b32 a96, v52
    v_accvgpr_write_b32 a97, v53
    v_accvgpr_write_b32 a98, v54
    v_accvgpr_write_b32 a99, v55
    v_accvgpr_write_b32 a100, v56
    v_accvgpr_write_b32 a101, v57
    v_accvgpr_write_b32 a102, v58
    v_accvgpr_write_b32 a103, v59
    v_accvgpr_read_b32 v52, a104
    v_accvgpr_read_b32 v53, a105
    v_accvgpr_read_b32 v54, a106
    v_accvgpr_read_b32 v55, a107
    v_accvgpr_read_b32 v56, a108
    v_accvgpr_read_b32 v57, a109
    v_accvgpr_read_b32 v58, a110
    v_accvgpr_read_b32 v59, a111
    v_mul_f32 v52, v52, v49
    v_mul_f32 v53, v53, v49
    v_mul_f32 v54, v54, v49
    v_mul_f32 v55, v55, v49
    v_mul_f32 v56, v56, v49
    v_mul_f32 v57, v57, v49
    v_mul_f32 v58, v58, v49
    v_mul_f32 v59, v59, v49
    v_accvgpr_write_b32 a104, v52
    v_accvgpr_write_b32 a105, v53
    v_accvgpr_write_b32 a106, v54
    v_accvgpr_write_b32 a107, v55
    v_accvgpr_write_b32 a108, v56
    v_accvgpr_write_b32 a109, v57
    v_accvgpr_write_b32 a110, v58
    v_accvgpr_write_b32 a111, v59
    v_accvgpr_read_b32 v52, a112
    v_accvgpr_read_b32 v53, a113
    v_accvgpr_read_b32 v54, a114
    v_accvgpr_read_b32 v55, a115
    v_accvgpr_read_b32 v56, a116
    v_accvgpr_read_b32 v57, a117
    v_accvgpr_read_b32 v58, a118
    v_accvgpr_read_b32 v59, a119
    v_mul_f32 v52, v52, v49
    v_mul_f32 v53, v53, v49
    v_mul_f32 v54, v54, v49
    v_mul_f32 v55, v55, v49
    v_mul_f32 v56, v56, v49
    v_mul_f32 v57, v57, v49
    v_mul_f32 v58, v58, v49
    v_mul_f32 v59, v59, v49
    v_accvgpr_write_b32 a112, v52
    v_accvgpr_write_b32 a113, v53
    v_accvgpr_write_b32 a114, v54
    v_accvgpr_write_b32 a115, v55
    v_accvgpr_write_b32 a116, v56
    v_accvgpr_write_b32 a117, v57
    v_accvgpr_write_b32 a118, v58
    v_accvgpr_write_b32 a119, v59
    v_accvgpr_read_b32 v52, a120
    v_accvgpr_read_b32 v53, a121
    v_accvgpr_read_b32 v54, a122
    v_accvgpr_read_b32 v55, a123
    v_accvgpr_read_b32 v56, a124
    v_accvgpr_read_b32 v57, a125
    v_accvgpr_read_b32 v58, a126
    v_accvgpr_read_b32 v59, a127
    v_mul_f32 v52, v52, v49
    v_mul_f32 v53, v53, v49
    v_mul_f32 v54, v54, v49
    v_mul_f32 v55, v55, v49
    v_mul_f32 v56, v56, v49
    v_mul_f32 v57, v57, v49
    v_mul_f32 v58, v58, v49
    v_mul_f32 v59, v59, v49
    v_accvgpr_write_b32 a120, v52
    v_accvgpr_write_b32 a121, v53
    v_accvgpr_write_b32 a122, v54
    v_accvgpr_write_b32 a123, v55
    v_accvgpr_write_b32 a124, v56
    v_accvgpr_write_b32 a125, v57
    v_accvgpr_write_b32 a126, v58
    v_accvgpr_write_b32 a127, v59
    v_exp_f32 v52, v120
    v_exp_f32 v53, v121
    v_exp_f32 v54, v122
    v_exp_f32 v55, v123
    v_exp_f32 v56, v124
    v_exp_f32 v57, v125
    v_exp_f32 v58, v126
    v_exp_f32 v59, v127
    s_nop 0
    v_cvt_pk_bf16_f32 v156, v52, v53
    v_cvt_pk_bf16_f32 v157, v54, v55
    v_cvt_pk_bf16_f32 v158, v56, v57
    v_cvt_pk_bf16_f32 v159, v58, v59
    s_nop 1
    v_mfma_f32_16x16x32_bf16 v[40:43], v[44:47], v[156:159], 0
    s_nop 7
    s_setpc_b64 s[74:75]
m_hook14:
    s_cmp_lg_u32 s16, 0
    s_cbranch_scc1 m_np38
    v_mov_b32 v4, s4
    v_mov_b32 v5, s5
    s_add_u32 s90, s17, 117440512
    s_mov_b64 exec, 1
    buffer_store_dwordx2 v[4:5], off, s[8:11], s90 sc1
    s_mov_b64 exec, -1
m_np38:
    s_mov_b32 s17, -1
    s_branch m_hookr15
m_hook18:
    s_cmp_lg_u32 s16, 0
    s_cbranch_scc1 m_np39
    v_mov_b32 v4, s4
    v_mov_b32 v5, s5
    s_add_u32 s90, s17, 117440512
    s_mov_b64 exec, 1
    buffer_store_dwordx2 v[4:5], off, s[8:11], s90 sc1
    s_mov_b64 exec, -1
m_np39:
    s_mov_b32 s17, -1
    s_branch m_hookr19
m_dosw17:
    s_cmp_eq_u32 s17, -1
    s_cbranch_scc1 m_x40
    s_cmp_lg_u32 s16, 0
    s_cbranch_scc1 m_np45
    v_mov_b32 v4, s4
    v_mov_b32 v5, s5
    s_add_u32 s90, s17, 117440512
    s_mov_b64 exec, 1
    buffer_store_dwordx2 v[4:5], off, s[8:11], s90 sc1
    s_mov_b64 exec, -1
m_np45:
    s_mov_b32 s17, -1
    s_mov_b32 s67, 3
    s_cmp_gt_u32 s65, 3
    s_cbranch_scc1 m_loop16
m_x40:
    s_cmp_eq_u32 s94, 0
    s_cbranch_scc1 m_x41
    s_mov_b32 s42, s73
    s_mov_b32 s46, s76
    s_lshl_b32 s90, s77, 4
    s_lshl_b32 s90, s90, s81
    s_mov_b32 s48, s79
    s_mul_i32 s91, s90, 1
    s_add_u32 s49, s91, s79
    s_sub_u32 s49, s49, 2048
    s_mul_i32 s91, s90, 2
    s_add_u32 s50, s91, s79
    s_mul_i32 s91, s90, 3
    s_add_u32 s51, s91, s79
    s_sub_u32 s51, s51, 2048
    s_mov_b32 s52, s80
    s_lshl_b32 s90, s78, 2
    s_mul_i32 s91, s90, 1
    s_add_u32 s53, s91, s80
    s_sub_u32 s53, s53, 2048
    s_mul_i32 s91, s90, 2
    s_add_u32 s54, s91, s80
    s_mul_i32 s91, s90, 3
    s_add_u32 s55, s91, s80
    s_sub_u32 s55, s55, 2048
    s_lshl_b32 s56, s78, 6
    s_lshl_b32 s90, s58, 7
    s_add_u32 s90, s90, s57
    s_lshl_b32 s91, s16, 6
    s_cmp_eq_u32 s81, 1
    s_cselect_b32 s90, s90, s91
    v_lshrrev_b32 v24, 3, v1
    v_lshlrev_b32 v24, s81, v24
    v_add_u32 v24, s90, v24
    v_mul_lo_u32 v24, v24, s77
    v_lshrrev_b32 v25, 4, v1
    v_and_b32 v26, 7, v1
    v_xor_b32 v25, v25, v26
    v_lshl_add_u32 v16, v25, 4, v24
    v_xor_b32 v25, 4, v25
    v_lshl_add_u32 v17, v25, 4, v24
    s_lshl_b32 s90, s77, 3
    s_lshl_b32 s90, s90, s81
    s_sub_u32 s90, s90, 1024
    v_add_u32 v17, s90, v17
    v_lshrrev_b32 v24, 5, v1
    s_lshl_b32 s90, s16, 4
    v_add_u32 v25, s90, v24
    v_mul_lo_u32 v25, v25, s78
    v_lshlrev_b32 v24, 1, v24
    v_and_b32 v26, 31, v1
    v_xor_b32 v24, v24, v26
    s_lshl_b32 s90, s78, 1
    s_sub_u32 s90, s90, 1024
    v_add_u32 v27, s90, v25
    v_xor_b32 v26, 0, v24
    v_lshl_add_u32 v18, v26, 4, v25
    v_xor_b32 v26, 4, v24
    v_lshl_add_u32 v19, v26, 4, v27
    v_xor_b32 v26, 8, v24
    v_lshl_add_u32 v20, v26, 4, v25
    v_xor_b32 v26, 12, v24
    v_lshl_add_u32 v21, v26, 4, v27
    s_mov_b32 s40, s71
    s_mov_b32 s41, s72
    s_mov_b32 s44, s74
    s_mov_b32 s45, s75
    buffer_load_dwordx2 v[4:5], off, s[12:15], 0 sc1
    s_mov_b32 s67, 0
    s_branch m_loop16
m_x41:
    s_cmp_eq_u32 s70, 1
    s_cbranch_scc1 m_x44
    s_cmp_lg_u32 s65, 3
    s_cbranch_scc1 m_x42
    s_and_b32 s92, s2, 7
    s_lshl_b32 s92, s92, 2
    s_bfe_u32 s93, s2, 0x20003
    s_add_u32 s92, s92, s93
    s_lshr_b32 s93, s2, 5
    s_lshl_b32 s93, s93, 2
    s_or_b32 s93, s93, 0x40000
    s_lshr_b32 s90, s92, 1
    s_lshl_b32 s90, s90, 7
    s_add_u32 s90, s90, 117440512
    v_and_b32 v0, 3, v1
    v_min_u32 v0, 2, v0
    v_and_b32 v4, 4, v1
    v_add3_u32 v0, v0, v4, 8
    v_lshlrev_b32 v0, 3, v0
    buffer_load_dwordx2 v[4:5], v0, s[8:11], s90 offen sc1
    s_branch m_loop16
m_x42:
    s_waitcnt vmcnt(16)
    s_cmp_lg_u32 s65, 2
    s_cbranch_scc1 m_x43
    s_mov_b32 s3, 1048576
m_spin46:
    v_cmp_ne_u64 s[22:23], s[4:5], v[4:5]
    s_nop 3
    s_cmp_eq_u64 s[22:23], 0
    s_cbranch_scc1 m_ok47
    s_sub_u32 s3, s3, 1
    s_cbranch_scc1 m_ok47
    s_sleep 16
    s_and_b32 s92, s2, 7
    s_lshl_b32 s92, s92, 2
    s_bfe_u32 s93, s2, 0x20003
    s_add_u32 s92, s92, s93
    s_lshr_b32 s93, s2, 5
    s_lshl_b32 s93, s93, 2
    s_or_b32 s93, s93, 0x40000
    s_lshr_b32 s90, s92, 1
    s_lshl_b32 s90, s90, 7
    s_add_u32 s90, s90, 117440512
    v_and_b32 v0, 3, v1
    v_min_u32 v0, 2, v0
    v_and_b32 v4, 4, v1
    v_add3_u32 v0, v0, v4, 8
    v_lshlrev_b32 v0, 3, v0
    buffer_load_dwordx2 v[4:5], v0, s[8:11], s90 offen sc1
    s_waitcnt vmcnt(0)
    s_branch m_spin46
m_ok47:
    s_and_b32 s92, s2, 7
    s_lshl_b32 s92, s92, 2
    s_bfe_u32 s93, s2, 0x20003
    s_add_u32 s92, s92, s93
    s_lshr_b32 s93, s2, 5
    s_lshl_b32 s93, s93, 2
    s_or_b32 s93, s93, 0x40000
    s_lshr_b32 s90, s92, 1
    s_lshl_b32 s90, s90, 7
    s_add_u32 s90, s90, 117440512
    s_bfe_u32 s91, 873473623, s93
    s_lshr_b32 s91, s91, 1
    v_mov_b32 v0, s91
    s_bfe_u32 s91, 4225681832, s93
    s_lshr_b32 s91, s91, 1
    v_writelane_b32 v0, s91, 8
    v_lshlrev_b32 v0, 3, v0
    buffer_load_dwordx2 v[4:5], v0, s[8:11], s90 offen sc1
    s_lshl_b32 s90, s92, 19
    s_lshl_b32 s91, s58, 13
    s_add_u32 s90, s90, s91
    s_cmp_eq_u32 s57, 0
    s_mov_b32 s91, 33554432
    s_cselect_b32 s91, 16777216, s91
    s_mov_b32 s42, 0
    s_cselect_b32 s42, 268435456, s42
    s_add_u32 s48, s90, s91
    s_mov_b32 s49, s48
    s_add_u32 s50, s48, 4096
    s_mov_b32 s51, s50
    s_mov_b32 s40, s6
    s_mov_b32 s41, s7
    s_lshl_b32 s90, s92, 19
    s_lshl_b32 s91, s58, 13
    s_add_u32 s90, s90, s91
    s_cmp_eq_u32 s57, 0
    s_mov_b32 s91, 33587200
    s_cselect_b32 s91, 16826368, s91
    s_mov_b32 s46, 268435456
    s_cselect_b32 s46, 268435456, s46
    s_add_u32 s52, s90, s91
    s_mov_b32 s53, s52
    s_add_u32 s54, s52, 4096
    s_mov_b32 s55, s54
    s_mov_b32 s44, s6
    s_mov_b32 s45, s7
    v_mov_b32 v16, v2
    v_mov_b32 v17, v2
    v_mov_b32 v18, v2
    v_mov_b32 v19, v2
    v_mov_b32 v20, v2
    v_mov_b32 v21, v2
    s_branch m_loop16
m_x43:
    s_mov_b32 s3, 1048576
m_spin48:
    v_cmp_ne_u64 s[22:23], s[4:5], v[4:5]
    s_nop 3
    s_cmp_eq_u64 s[22:23], 0
    s_cbranch_scc1 m_ok49
    s_sub_u32 s3, s3, 1
    s_cbranch_scc1 m_ok49
    s_sleep 16
    s_and_b32 s92, s2, 7
    s_lshl_b32 s92, s92, 2
    s_bfe_u32 s93, s2, 0x20003
    s_add_u32 s92, s92, s93
    s_lshr_b32 s93, s2, 5
    s_lshl_b32 s93, s93, 2
    s_or_b32 s93, s93, 0x40000
    s_lshr_b32 s90, s92, 1
    s_lshl_b32 s90, s90, 7
    s_add_u32 s90, s90, 117440512
    s_bfe_u32 s91, 873473623, s93
    s_lshr_b32 s91, s91, 1
    v_mov_b32 v0, s91
    s_bfe_u32 s91, 4225681832, s93
    s_lshr_b32 s91, s91, 1
    v_writelane_b32 v0, s91, 8
    v_lshlrev_b32 v0, 3, v0
    buffer_load_dwordx2 v[4:5], v0, s[8:11], s90 offen sc1
    s_waitcnt vmcnt(0)
    s_branch m_spin48
m_ok49:
    s_and_b32 s92, s2, 7
    s_lshl_b32 s92, s92, 2
    s_bfe_u32 s93, s2, 0x20003
    s_add_u32 s92, s92, s93
    s_lshr_b32 s93, s2, 5
    s_lshl_b32 s93, s93, 2
    s_or_b32 s93, s93, 0x40000
    s_bfe_u32 s90, 4225681832, s93
    s_lshl_b32 s90, s90, 3
    s_lshl_b32 s91, s16, 1
    s_add_u32 s90, s90, s91
    s_lshl_b32 s90, s90, 12
    s_lshl_b32 s91, s92, 19
    s_add_u32 s90, s90, s91
    s_add_u32 s90, s90, 0
    buffer_load_dwordx4 a[128:131], v2, s[8:11], s90 offen offset:0 sc1
    buffer_load_dwordx4 a[132:135], v2, s[8:11], s90 offen offset:1024 sc1
    buffer_load_dwordx4 a[136:139], v2, s[8:11], s90 offen offset:2048 sc1
    buffer_load_dwordx4 a[140:143], v2, s[8:11], s90 offen offset:3072 sc1
    s_bfe_u32 s90, 4225681832, s93
    s_lshl_b32 s90, s90, 3
    s_lshl_b32 s91, s16, 1
    s_add_u32 s90, s90, s91
    s_lshl_b32 s90, s90, 12
    s_lshl_b32 s91, s92, 19
    s_add_u32 s90, s90, s91
    s_add_u32 s90, s90, 4096
    buffer_load_dwordx4 a[144:147], v2, s[8:11], s90 offen offset:0 sc1
    buffer_load_dwordx4 a[148:151], v2, s[8:11], s90 offen offset:1024 sc1
    buffer_load_dwordx4 a[152:155], v2, s[8:11], s90 offen offset:2048 sc1
    buffer_load_dwordx4 a[156:159], v2, s[8:11], s90 offen offset:3072 sc1
    s_bfe_u32 s90, 873473623, s93
    s_lshl_b32 s90, s90, 3
    s_lshl_b32 s91, s16, 1
    s_add_u32 s90, s90, s91
    s_lshl_b32 s90, s90, 12
    s_lshl_b32 s91, s92, 19
    s_add_u32 s90, s90, s91
    s_add_u32 s90, s90, 0
    buffer_load_dwordx4 a[160:163], v2, s[8:11], s90 offen offset:0 sc1
    buffer_load_dwordx4 a[164:167], v2, s[8:11], s90 offen offset:1024 sc1
    buffer_load_dwordx4 a[168:171], v2, s[8:11], s90 offen offset:2048 sc1
    buffer_load_dwordx4 a[172:175], v2, s[8:11], s90 offen offset:3072 sc1
    s_bfe_u32 s90, 873473623, s93
    s_lshl_b32 s90, s90, 3
    s_lshl_b32 s91, s16, 1
    s_add_u32 s90, s90, s91
    s_lshl_b32 s90, s90, 12
    s_lshl_b32 s91, s92, 19
    s_add_u32 s90, s90, s91
    s_add_u32 s90, s90, 4096
    buffer_load_dwordx4 a[176:179], v2, s[8:11], s90 offen offset:0 sc1
    buffer_load_dwordx4 a[180:183], v2, s[8:11], s90 offen offset:1024 sc1
    buffer_load_dwordx4 a[184:187], v2, s[8:11], s90 offen offset:2048 sc1
    buffer_load_dwordx4 a[188:191], v2, s[8:11], s90 offen offset:3072 sc1
    s_lshl_b32 s90, s92, 19
    s_lshl_b32 s91, s58, 13
    s_add_u32 s90, s90, s91
    s_cmp_eq_u32 s57, 0
    s_mov_b32 s91, 33554432
    s_cselect_b32 s91, 16793600, s91
    s_mov_b32 s42, 268435456
    s_cselect_b32 s42, 268435456, s42
    s_add_u32 s48, s90, s91
    s_mov_b32 s49, s48
    s_add_u32 s50, s48, 4096
    s_mov_b32 s51, s50
    s_mov_b32 s40, s6
    s_mov_b32 s41, s7
    s_mov_b32 s46, 0
    s_branch m_loop16
m_x44:
    s_mov_b32 s42, 0
    s_mov_b32 s46, 0
    s_branch m_loop16
m_dosw21:
    s_cmp_eq_u32 s17, -1
    s_cbranch_scc1 m_x50
    s_cmp_lg_u32 s16, 0
    s_cbranch_scc1 m_np55
    v_mov_b32 v4, s4
    v_mov_b32 v5, s5
    s_add_u32 s90, s17, 117440512
    s_mov_b64 exec, 1
    buffer_store_dwordx2 v[4:5], off, s[8:11], s90 sc1
    s_mov_b64 exec, -1
m_np55:
    s_mov_b32 s17, -1
    s_mov_b32 s67, 3
    s_cmp_gt_u32 s65, 3
    s_cbranch_scc1 m_loop20
m_x50:
    s_cmp_eq_u32 s94, 0
    s_cbranch_scc1 m_x51
    s_mov_b32 s42, s73
    s_mov_b32 s46, s76
    s_lshl_b32 s90, s77, 4
    s_lshl_b32 s90, s90, s81
    s_mov_b32 s48, s79
    s_mul_i32 s91, s90, 1
    s_add_u32 s49, s91, s79
    s_sub_u32 s49, s49, 2048
    s_mul_i32 s91, s90, 2
    s_add_u32 s50, s91, s79
    s_mul_i32 s91, s90, 3
    s_add_u32 s51, s91, s79
    s_sub_u32 s51, s51, 2048
    s_mov_b32 s52, s80
    s_lshl_b32 s90, s78, 2
    s_mul_i32 s91, s90, 1
    s_add_u32 s53, s91, s80
    s_sub_u32 s53, s53, 2048
    s_mul_i32 s91, s90, 2
    s_add_u32 s54, s91, s80
    s_mul_i32 s91, s90, 3
    s_add_u32 s55, s91, s80
    s_sub_u32 s55, s55, 2048
    s_lshl_b32 s56, s78, 6
    s_lshl_b32 s90, s58, 7
    s_add_u32 s90, s90, s57
    s_lshl_b32 s91, s16, 6
    s_cmp_eq_u32 s81, 1
    s_cselect_b32 s90, s90, s91
    v_lshrrev_b32 v24, 3, v1
    v_lshlrev_b32 v24, s81, v24
    v_add_u32 v24, s90, v24
    v_mul_lo_u32 v24, v24, s77
    v_lshrrev_b32 v25, 4, v1
    v_and_b32 v26, 7, v1
    v_xor_b32 v25, v25, v26
    v_lshl_add_u32 v16, v25, 4, v24
    v_xor_b32 v25, 4, v25
    v_lshl_add_u32 v17, v25, 4, v24
    s_lshl_b32 s90, s77, 3
    s_lshl_b32 s90, s90, s81
    s_sub_u32 s90, s90, 1024
    v_add_u32 v17, s90, v17
    v_lshrrev_b32 v24, 5, v1
    s_lshl_b32 s90, s16, 4
    v_add_u32 v25, s90, v24
    v_mul_lo_u32 v25, v25, s78
    v_lshlrev_b32 v24, 1, v24
    v_and_b32 v26, 31, v1
    v_xor_b32 v24, v24, v26
    s_lshl_b32 s90, s78, 1
    s_sub_u32 s90, s90, 1024
    v_add_u32 v27, s90, v25
    v_xor_b32 v26, 0, v24
    v_lshl_add_u32 v18, v26, 4, v25
    v_xor_b32 v26, 4, v24
    v_lshl_add_u32 v19, v26, 4, v27
    v_xor_b32 v26, 8, v24
    v_lshl_add_u32 v20, v26, 4, v25
    v_xor_b32 v26, 12, v24
    v_lshl_add_u32 v21, v26, 4, v27
    s_mov_b32 s40, s71
    s_mov_b32 s41, s72
    s_mov_b32 s44, s74
    s_mov_b32 s45, s75
    buffer_load_dwordx2 v[4:5], off, s[12:15], 0 sc1
    s_mov_b32 s67, 0
    s_branch m_loop20
m_x51:
    s_cmp_eq_u32 s70, 1
    s_cbranch_scc1 m_x54
    s_cmp_lg_u32 s65, 3
    s_cbranch_scc1 m_x52
    s_and_b32 s92, s2, 7
    s_lshl_b32 s92, s92, 2
    s_bfe_u32 s93, s2, 0x20003
    s_add_u32 s92, s92, s93
    s_lshr_b32 s93, s2, 5
    s_lshl_b32 s93, s93, 2
    s_or_b32 s93, s93, 0x40000
    s_lshr_b32 s90, s92, 1
    s_lshl_b32 s90, s90, 7
    s_add_u32 s90, s90, 117440512
    v_and_b32 v0, 3, v1
    v_min_u32 v0, 2, v0
    v_and_b32 v4, 4, v1
    v_add3_u32 v0, v0, v4, 8
    v_lshlrev_b32 v0, 3, v0
    buffer_load_dwordx2 v[4:5], v0, s[8:11], s90 offen sc1
    s_branch m_loop20
m_x52:
    s_waitcnt vmcnt(16)
    s_cmp_lg_u32 s65, 2
    s_cbranch_scc1 m_x53
    s_mov_b32 s3, 1048576
m_spin56:
    v_cmp_ne_u64 s[22:23], s[4:5], v[4:5]
    s_nop 3
    s_cmp_eq_u64 s[22:23], 0
    s_cbranch_scc1 m_ok57
    s_sub_u32 s3, s3, 1
    s_cbranch_scc1 m_ok57
    s_sleep 16
    s_and_b32 s92, s2, 7
    s_lshl_b32 s92, s92, 2
    s_bfe_u32 s93, s2, 0x20003
    s_add_u32 s92, s92, s93
    s_lshr_b32 s93, s2, 5
    s_lshl_b32 s93, s93, 2
    s_or_b32 s93, s93, 0x40000
    s_lshr_b32 s90, s92, 1
    s_lshl_b32 s90, s90, 7
    s_add_u32 s90, s90, 117440512
    v_and_b32 v0, 3, v1
    v_min_u32 v0, 2, v0
    v_and_b32 v4, 4, v1
    v_add3_u32 v0, v0, v4, 8
    v_lshlrev_b32 v0, 3, v0
    buffer_load_dwordx2 v[4:5], v0, s[8:11], s90 offen sc1
    s_waitcnt vmcnt(0)
    s_branch m_spin56
m_ok57:
    s_and_b32 s92, s2, 7
    s_lshl_b32 s92, s92, 2
    s_bfe_u32 s93, s2, 0x20003
    s_add_u32 s92, s92, s93
    s_lshr_b32 s93, s2, 5
    s_lshl_b32 s93, s93, 2
    s_or_b32 s93, s93, 0x40000
    s_lshr_b32 s90, s92, 1
    s_lshl_b32 s90, s90, 7
    s_add_u32 s90, s90, 117440512
    s_bfe_u32 s91, 873473623, s93
    s_lshr_b32 s91, s91, 1
    v_mov_b32 v0, s91
    s_bfe_u32 s91, 4225681832, s93
    s_lshr_b32 s91, s91, 1
    v_writelane_b32 v0, s91, 8
    v_lshlrev_b32 v0, 3, v0
    buffer_load_dwordx2 v[4:5], v0, s[8:11], s90 offen sc1
    s_lshl_b32 s90, s92, 19
    s_lshl_b32 s91, s58, 13
    s_add_u32 s90, s90, s91
    s_cmp_eq_u32 s57, 0
    s_mov_b32 s91, 33554432
    s_cselect_b32 s91, 16777216, s91
    s_mov_b32 s42, 0
    s_cselect_b32 s42, 268435456, s42
    s_add_u32 s48, s90, s91
    s_mov_b32 s49, s48
    s_add_u32 s50, s48, 4096
    s_mov_b32 s51, s50
    s_mov_b32 s40, s6
    s_mov_b32 s41, s7
    s_lshl_b32 s90, s92, 19
    s_lshl_b32 s91, s58, 13
    s_add_u32 s90, s90, s91
    s_cmp_eq_u32 s57, 0
    s_mov_b32 s91, 33587200
    s_cselect_b32 s91, 16826368, s91
    s_mov_b32 s46, 268435456
    s_cselect_b32 s46, 268435456, s46
    s_add_u32 s52, s90, s91
    s_mov_b32 s53, s52
    s_add_u32 s54, s52, 4096
    s_mov_b32 s55, s54
    s_mov_b32 s44, s6
    s_mov_b32 s45, s7
    v_mov_b32 v16, v2
    v_mov_b32 v17, v2
    v_mov_b32 v18, v2
    v_mov_b32 v19, v2
    v_mov_b32 v20, v2
    v_mov_b32 v21, v2
    s_branch m_loop20
m_x53:
    s_mov_b32 s3, 1048576
m_spin58:
    v_cmp_ne_u64 s[22:23], s[4:5], v[4:5]
    s_nop 3
    s_cmp_eq_u64 s[22:23], 0
    s_cbranch_scc1 m_ok59
    s_sub_u32 s3, s3, 1
    s_cbranch_scc1 m_ok59
    s_sleep 16
    s_and_b32 s92, s2, 7
    s_lshl_b32 s92, s92, 2
    s_bfe_u32 s93, s2, 0x20003
    s_add_u32 s92, s92, s93
    s_lshr_b32 s93, s2, 5
    s_lshl_b32 s93, s93, 2
    s_or_b32 s93, s93, 0x40000
    s_lshr_b32 s90, s92, 1
    s_lshl_b32 s90, s90, 7
    s_add_u32 s90, s90, 117440512
    s_bfe_u32 s91, 873473623, s93
    s_lshr_b32 s91, s91, 1
    v_mov_b32 v0, s91
    s_bfe_u32 s91, 4225681832, s93
    s_lshr_b32 s91, s91, 1
    v_writelane_b32 v0, s91, 8
    v_lshlrev_b32 v0, 3, v0
    buffer_load_dwordx2 v[4:5], v0, s[8:11], s90 offen sc1
    s_waitcnt vmcnt(0)
    s_branch m_spin58
m_ok59:
    s_and_b32 s92, s2, 7
    s_lshl_b32 s92, s92, 2
    s_bfe_u32 s93, s2, 0x20003
    s_add_u32 s92, s92, s93
    s_lshr_b32 s93, s2, 5
    s_lshl_b32 s93, s93, 2
    s_or_b32 s93, s93, 0x40000
    s_bfe_u32 s90, 4225681832, s93
    s_lshl_b32 s90, s90, 3
    s_lshl_b32 s91, s16, 1
    s_add_u32 s90, s90, s91
    s_lshl_b32 s90, s90, 12
    s_lshl_b32 s91, s92, 19
    s_add_u32 s90, s90, s91
    s_add_u32 s90, s90, 0
    buffer_load_dwordx4 a[128:131], v2, s[8:11], s90 offen offset:0 sc1
    buffer_load_dwordx4 a[132:135], v2, s[8:11], s90 offen offset:1024 sc1
    buffer_load_dwordx4 a[136:139], v2, s[8:11], s90 offen offset:2048 sc1
    buffer_load_dwordx4 a[140:143], v2, s[8:11], s90 offen offset:3072 sc1
    s_bfe_u32 s90, 4225681832, s93
    s_lshl_b32 s90, s90, 3
    s_lshl_b32 s91, s16, 1
    s_add_u32 s90, s90, s91
    s_lshl_b32 s90, s90, 12
    s_lshl_b32 s91, s92, 19
    s_add_u32 s90, s90, s91
    s_add_u32 s90, s90, 4096
    buffer_load_dwordx4 a[144:147], v2, s[8:11], s90 offen offset:0 sc1
    buffer_load_dwordx4 a[148:151], v2, s[8:11], s90 offen offset:1024 sc1
    buffer_load_dwordx4 a[152:155], v2, s[8:11], s90 offen offset:2048 sc1
    buffer_load_dwordx4 a[156:159], v2, s[8:11], s90 offen offset:3072 sc1
    s_bfe_u32 s90, 873473623, s93
    s_lshl_b32 s90, s90, 3
    s_lshl_b32 s91, s16, 1
    s_add_u32 s90, s90, s91
    s_lshl_b32 s90, s90, 12
    s_lshl_b32 s91, s92, 19
    s_add_u32 s90, s90, s91
    s_add_u32 s90, s90, 0
    buffer_load_dwordx4 a[160:163], v2, s[8:11], s90 offen offset:0 sc1
    buffer_load_dwordx4 a[164:167], v2, s[8:11], s90 offen offset:1024 sc1
    buffer_load_dwordx4 a[168:171], v2, s[8:11], s90 offen offset:2048 sc1
    buffer_load_dwordx4 a[172:175], v2, s[8:11], s90 offen offset:3072 sc1
    s_bfe_u32 s90, 873473623, s93
    s_lshl_b32 s90, s90, 3
    s_lshl_b32 s91, s16, 1
    s_add_u32 s90, s90, s91
    s_lshl_b32 s90, s90, 12
    s_lshl_b32 s91, s92, 19
    s_add_u32 s90, s90, s91
    s_add_u32 s90, s90, 4096
    buffer_load_dwordx4 a[176:179], v2, s[8:11], s90 offen offset:0 sc1
    buffer_load_dwordx4 a[180:183], v2, s[8:11], s90 offen offset:1024 sc1
    buffer_load_dwordx4 a[184:187], v2, s[8:11], s90 offen offset:2048 sc1
    buffer_load_dwordx4 a[188:191], v2, s[8:11], s90 offen offset:3072 sc1
    s_lshl_b32 s90, s92, 19
    s_lshl_b32 s91, s58, 13
    s_add_u32 s90, s90, s91
    s_cmp_eq_u32 s57, 0
    s_mov_b32 s91, 33554432
    s_cselect_b32 s91, 16793600, s91
    s_mov_b32 s42, 268435456
    s_cselect_b32 s42, 268435456, s42
    s_add_u32 s48, s90, s91
    s_mov_b32 s49, s48
    s_add_u32 s50, s48, 4096
    s_mov_b32 s51, s50
    s_mov_b32 s40, s6
    s_mov_b32 s41, s7
    s_mov_b32 s46, 0
    s_branch m_loop20
m_x54:
    s_mov_b32 s42, 0
    s_mov_b32 s46, 0
    s_branch m_loop20
m_eps23:
    s_mov_b32 s92, s97
    s_mov_b32 s93, s97
    s_cmp_eq_u32 s97, 0
    s_cbranch_scc1 m_ns360
    v_pk_mul_f32 v[32:33], v[32:33], s[92:93]
    v_pk_mul_f32 v[34:35], v[34:35], s[92:93]
    v_pk_mul_f32 v[36:37], v[36:37], s[92:93]
    v_pk_mul_f32 v[38:39], v[38:39], s[92:93]
    v_cvt_pk_bf16_f32 v32, v32, v33
    v_cvt_pk_bf16_f32 v33, v34, v35
    v_cvt_pk_bf16_f32 v34, v36, v37
    v_cvt_pk_bf16_f32 v35, v38, v39
    v_accvgpr_write_b32 a128, v32
    v_accvgpr_write_b32 a129, v33
    v_accvgpr_write_b32 a130, v34
    v_accvgpr_write_b32 a131, v35
    v_pk_mul_f32 v[40:41], v[40:41], s[92:93]
    v_pk_mul_f32 v[42:43], v[42:43], s[92:93]
    v_pk_mul_f32 v[44:45], v[44:45], s[92:93]
    v_pk_mul_f32 v[46:47], v[46:47], s[92:93]
    v_cvt_pk_bf16_f32 v40, v40, v41
    v_cvt_pk_bf16_f32 v41, v42, v43
    v_cvt_pk_bf16_f32 v42, v44, v45
    v_cvt_pk_bf16_f32 v43, v46, v47
    v_accvgpr_write_b32 a132, v40
    v_accvgpr_write_b32 a133, v41
    v_accvgpr_write_b32 a134, v42
    v_accvgpr_write_b32 a135, v43
    v_pk_mul_f32 v[48:49], v[48:49], s[92:93]
    v_pk_mul_f32 v[50:51], v[50:51], s[92:93]
    v_pk_mul_f32 v[52:53], v[52:53], s[92:93]
    v_pk_mul_f32 v[54:55], v[54:55], s[92:93]
    v_cvt_pk_bf16_f32 v48, v48, v49
    v_cvt_pk_bf16_f32 v49, v50, v51
    v_cvt_pk_bf16_f32 v50, v52, v53
    v_cvt_pk_bf16_f32 v51, v54, v55
    v_accvgpr_write_b32 a136, v48
    v_accvgpr_write_b32 a137, v49
    v_accvgpr_write_b32 a138, v50
    v_accvgpr_write_b32 a139, v51
    v_pk_mul_f32 v[56:57], v[56:57], s[92:93]
    v_pk_mul_f32 v[58:59], v[58:59], s[92:93]
    v_pk_mul_f32 v[60:61], v[60:61], s[92:93]
    v_pk_mul_f32 v[62:63], v[62:63], s[92:93]
    v_cvt_pk_bf16_f32 v56, v56, v57
    v_cvt_pk_bf16_f32 v57, v58, v59
    v_cvt_pk_bf16_f32 v58, v60, v61
    v_cvt_pk_bf16_f32 v59, v62, v63
    v_accvgpr_write_b32 a140, v56
    v_accvgpr_write_b32 a141, v57
    v_accvgpr_write_b32 a142, v58
    v_accvgpr_write_b32 a143, v59
    v_pk_mul_f32 v[64:65], v[64:65], s[92:93]
    v_pk_mul_f32 v[66:67], v[66:67], s[92:93]
    v_pk_mul_f32 v[68:69], v[68:69], s[92:93]
    v_pk_mul_f32 v[70:71], v[70:71], s[92:93]
    v_cvt_pk_bf16_f32 v64, v64, v65
    v_cvt_pk_bf16_f32 v65, v66, v67
    v_cvt_pk_bf16_f32 v66, v68, v69
    v_cvt_pk_bf16_f32 v67, v70, v71
    v_accvgpr_write_b32 a144, v64
    v_accvgpr_write_b32 a145, v65
    v_accvgpr_write_b32 a146, v66
    v_accvgpr_write_b32 a147, v67
    v_pk_mul_f32 v[72:73], v[72:73], s[92:93]
    v_pk_mul_f32 v[74:75], v[74:75], s[92:93]
    v_pk_mul_f32 v[76:77], v[76:77], s[92:93]
    v_pk_mul_f32 v[78:79], v[78:79], s[92:93]
    v_cvt_pk_bf16_f32 v72, v72, v73
    v_cvt_pk_bf16_f32 v73, v74, v75
    v_cvt_pk_bf16_f32 v74, v76, v77
    v_cvt_pk_bf16_f32 v75, v78, v79
    v_accvgpr_write_b32 a148, v72
    v_accvgpr_write_b32 a149, v73
    v_accvgpr_write_b32 a150, v74
    v_accvgpr_write_b32 a151, v75
    v_pk_mul_f32 v[80:81], v[80:81], s[92:93]
    v_pk_mul_f32 v[82:83], v[82:83], s[92:93]
    v_pk_mul_f32 v[84:85], v[84:85], s[92:93]
    v_pk_mul_f32 v[86:87], v[86:87], s[92:93]
    v_cvt_pk_bf16_f32 v80, v80, v81
    v_cvt_pk_bf16_f32 v81, v82, v83
    v_cvt_pk_bf16_f32 v82, v84, v85
    v_cvt_pk_bf16_f32 v83, v86, v87
    v_accvgpr_write_b32 a152, v80
    v_accvgpr_write_b32 a153, v81
    v_accvgpr_write_b32 a154, v82
    v_accvgpr_write_b32 a155, v83
    v_pk_mul_f32 v[88:89], v[88:89], s[92:93]
    v_pk_mul_f32 v[90:91], v[90:91], s[92:93]
    v_pk_mul_f32 v[92:93], v[92:93], s[92:93]
    v_pk_mul_f32 v[94:95], v[94:95], s[92:93]
    v_cvt_pk_bf16_f32 v88, v88, v89
    v_cvt_pk_bf16_f32 v89, v90, v91
    v_cvt_pk_bf16_f32 v90, v92, v93
    v_cvt_pk_bf16_f32 v91, v94, v95
    v_accvgpr_write_b32 a156, v88
    v_accvgpr_write_b32 a157, v89
    v_accvgpr_write_b32 a158, v90
    v_accvgpr_write_b32 a159, v91
    v_pk_mul_f32 v[96:97], v[96:97], s[92:93]
    v_pk_mul_f32 v[98:99], v[98:99], s[92:93]
    v_pk_mul_f32 v[100:101], v[100:101], s[92:93]
    v_pk_mul_f32 v[102:103], v[102:103], s[92:93]
    v_cvt_pk_bf16_f32 v96, v96, v97
    v_cvt_pk_bf16_f32 v97, v98, v99
    v_cvt_pk_bf16_f32 v98, v100, v101
    v_cvt_pk_bf16_f32 v99, v102, v103
    v_accvgpr_write_b32 a160, v96
    v_accvgpr_write_b32 a161, v97
    v_accvgpr_write_b32 a162, v98
    v_accvgpr_write_b32 a163, v99
    v_pk_mul_f32 v[104:105], v[104:105], s[92:93]
    v_pk_mul_f32 v[106:107], v[106:107], s[92:93]
    v_pk_mul_f32 v[108:109], v[108:109], s[92:93]
    v_pk_mul_f32 v[110:111], v[110:111], s[92:93]
    v_cvt_pk_bf16_f32 v104, v104, v105
    v_cvt_pk_bf16_f32 v105, v106, v107
    v_cvt_pk_bf16_f32 v106, v108, v109
    v_cvt_pk_bf16_f32 v107, v110, v111
    v_accvgpr_write_b32 a164, v104
    v_accvgpr_write_b32 a165, v105
    v_accvgpr_write_b32 a166, v106
    v_accvgpr_write_b32 a167, v107
    v_pk_mul_f32 v[112:113], v[112:113], s[92:93]
    v_pk_mul_f32 v[114:115], v[114:115], s[92:93]
    v_pk_mul_f32 v[116:117], v[116:117], s[92:93]
    v_pk_mul_f32 v[118:119], v[118:119], s[92:93]
    v_cvt_pk_bf16_f32 v112, v112, v113
    v_cvt_pk_bf16_f32 v113, v114, v115
    v_cvt_pk_bf16_f32 v114, v116, v117
    v_cvt_pk_bf16_f32 v115, v118, v119
    v_accvgpr_write_b32 a168, v112
    v_accvgpr_write_b32 a169, v113
    v_accvgpr_write_b32 a170, v114
    v_accvgpr_write_b32 a171, v115
    v_pk_mul_f32 v[120:121], v[120:121], s[92:93]
    v_pk_mul_f32 v[122:123], v[122:123], s[92:93]
    v_pk_mul_f32 v[124:125], v[124:125], s[92:93]
    v_pk_mul_f32 v[126:127], v[126:127], s[92:93]
    v_cvt_pk_bf16_f32 v120, v120, v121
    v_cvt_pk_bf16_f32 v121, v122, v123
    v_cvt_pk_bf16_f32 v122, v124, v125
    v_cvt_pk_bf16_f32 v123, v126, v127
    v_accvgpr_write_b32 a172, v120
    v_accvgpr_write_b32 a173, v121
    v_accvgpr_write_b32 a174, v122
    v_accvgpr_write_b32 a175, v123
    v_pk_mul_f32 v[128:129], v[128:129], s[92:93]
    v_pk_mul_f32 v[130:131], v[130:131], s[92:93]
    v_pk_mul_f32 v[132:133], v[132:133], s[92:93]
    v_pk_mul_f32 v[134:135], v[134:135], s[92:93]
    v_cvt_pk_bf16_f32 v128, v128, v129
    v_cvt_pk_bf16_f32 v129, v130, v131
    v_cvt_pk_bf16_f32 v130, v132, v133
    v_cvt_pk_bf16_f32 v131, v134, v135
    v_accvgpr_write_b32 a176, v128
    v_accvgpr_write_b32 a177, v129
    v_accvgpr_write_b32 a178, v130
    v_accvgpr_write_b32 a179, v131
    v_pk_mul_f32 v[136:137], v[136:137], s[92:93]
    v_pk_mul_f32 v[138:139], v[138:139], s[92:93]
    v_pk_mul_f32 v[140:141], v[140:141], s[92:93]
    v_pk_mul_f32 v[142:143], v[142:143], s[92:93]
    v_cvt_pk_bf16_f32 v136, v136, v137
    v_cvt_pk_bf16_f32 v137, v138, v139
    v_cvt_pk_bf16_f32 v138, v140, v141
    v_cvt_pk_bf16_f32 v139, v142, v143
    v_accvgpr_write_b32 a180, v136
    v_accvgpr_write_b32 a181, v137
    v_accvgpr_write_b32 a182, v138
    v_accvgpr_write_b32 a183, v139
    v_pk_mul_f32 v[144:145], v[144:145], s[92:93]
    v_pk_mul_f32 v[146:147], v[146:147], s[92:93]
    v_pk_mul_f32 v[148:149], v[148:149], s[92:93]
    v_pk_mul_f32 v[150:151], v[150:151], s[92:93]
    v_cvt_pk_bf16_f32 v144, v144, v145
    v_cvt_pk_bf16_f32 v145, v146, v147
    v_cvt_pk_bf16_f32 v146, v148, v149
    v_cvt_pk_bf16_f32 v147, v150, v151
    v_accvgpr_write_b32 a184, v144
    v_accvgpr_write_b32 a185, v145
    v_accvgpr_write_b32 a186, v146
    v_accvgpr_write_b32 a187, v147
    v_pk_mul_f32 v[152:153], v[152:153], s[92:93]
    v_pk_mul_f32 v[154:155], v[154:155], s[92:93]
    v_pk_mul_f32 v[156:157], v[156:157], s[92:93]
    v_pk_mul_f32 v[158:159], v[158:159], s[92:93]
    v_cvt_pk_bf16_f32 v152, v152, v153
    v_cvt_pk_bf16_f32 v153, v154, v155
    v_cvt_pk_bf16_f32 v154, v156, v157
    v_cvt_pk_bf16_f32 v155, v158, v159
    v_accvgpr_write_b32 a188, v152
    v_accvgpr_write_b32 a189, v153
    v_accvgpr_write_b32 a190, v154
    v_accvgpr_write_b32 a191, v155
    v_pk_mul_f32 v[160:161], v[160:161], s[92:93]
    v_pk_mul_f32 v[162:163], v[162:163], s[92:93]
    v_pk_mul_f32 v[164:165], v[164:165], s[92:93]
    v_pk_mul_f32 v[166:167], v[166:167], s[92:93]
    v_cvt_pk_bf16_f32 v160, v160, v161
    v_cvt_pk_bf16_f32 v161, v162, v163
    v_cvt_pk_bf16_f32 v162, v164, v165
    v_cvt_pk_bf16_f32 v163, v166, v167
    v_accvgpr_write_b32 a192, v160
    v_accvgpr_write_b32 a193, v161
    v_accvgpr_write_b32 a194, v162
    v_accvgpr_write_b32 a195, v163
    v_pk_mul_f32 v[168:169], v[168:169], s[92:93]
    v_pk_mul_f32 v[170:171], v[170:171], s[92:93]
    v_pk_mul_f32 v[172:173], v[172:173], s[92:93]
    v_pk_mul_f32 v[174:175], v[174:175], s[92:93]
    v_cvt_pk_bf16_f32 v168, v168, v169
    v_cvt_pk_bf16_f32 v169, v170, v171
    v_cvt_pk_bf16_f32 v170, v172, v173
    v_cvt_pk_bf16_f32 v171, v174, v175
    v_accvgpr_write_b32 a196, v168
    v_accvgpr_write_b32 a197, v169
    v_accvgpr_write_b32 a198, v170
    v_accvgpr_write_b32 a199, v171
    v_pk_mul_f32 v[176:177], v[176:177], s[92:93]
    v_pk_mul_f32 v[178:179], v[178:179], s[92:93]
    v_pk_mul_f32 v[180:181], v[180:181], s[92:93]
    v_pk_mul_f32 v[182:183], v[182:183], s[92:93]
    v_cvt_pk_bf16_f32 v176, v176, v177
    v_cvt_pk_bf16_f32 v177, v178, v179
    v_cvt_pk_bf16_f32 v178, v180, v181
    v_cvt_pk_bf16_f32 v179, v182, v183
    v_accvgpr_write_b32 a200, v176
    v_accvgpr_write_b32 a201, v177
    v_accvgpr_write_b32 a202, v178
    v_accvgpr_write_b32 a203, v179
    v_pk_mul_f32 v[184:185], v[184:185], s[92:93]
    v_pk_mul_f32 v[186:187], v[186:187], s[92:93]
    v_pk_mul_f32 v[188:189], v[188:189], s[92:93]
    v_pk_mul_f32 v[190:191], v[190:191], s[92:93]
    v_cvt_pk_bf16_f32 v184, v184, v185
    v_cvt_pk_bf16_f32 v185, v186, v187
    v_cvt_pk_bf16_f32 v186, v188, v189
    v_cvt_pk_bf16_f32 v187, v190, v191
    v_accvgpr_write_b32 a204, v184
    v_accvgpr_write_b32 a205, v185
    v_accvgpr_write_b32 a206, v186
    v_accvgpr_write_b32 a207, v187
    v_pk_mul_f32 v[192:193], v[192:193], s[92:93]
    v_pk_mul_f32 v[194:195], v[194:195], s[92:93]
    v_pk_mul_f32 v[196:197], v[196:197], s[92:93]
    v_pk_mul_f32 v[198:199], v[198:199], s[92:93]
    v_cvt_pk_bf16_f32 v192, v192, v193
    v_cvt_pk_bf16_f32 v193, v194, v195
    v_cvt_pk_bf16_f32 v194, v196, v197
    v_cvt_pk_bf16_f32 v195, v198, v199
    v_accvgpr_write_b32 a208, v192
    v_accvgpr_write_b32 a209, v193
    v_accvgpr_write_b32 a210, v194
    v_accvgpr_write_b32 a211, v195
    v_pk_mul_f32 v[200:201], v[200:201], s[92:93]
    v_pk_mul_f32 v[202:203], v[202:203], s[92:93]
    v_pk_mul_f32 v[204:205], v[204:205], s[92:93]
    v_pk_mul_f32 v[206:207], v[206:207], s[92:93]
    v_cvt_pk_bf16_f32 v200, v200, v201
    v_cvt_pk_bf16_f32 v201, v202, v203
    v_cvt_pk_bf16_f32 v202, v204, v205
    v_cvt_pk_bf16_f32 v203, v206, v207
    v_accvgpr_write_b32 a212, v200
    v_accvgpr_write_b32 a213, v201
    v_accvgpr_write_b32 a214, v202
    v_accvgpr_write_b32 a215, v203
    v_pk_mul_f32 v[208:209], v[208:209], s[92:93]
    v_pk_mul_f32 v[210:211], v[210:211], s[92:93]
    v_pk_mul_f32 v[212:213], v[212:213], s[92:93]
    v_pk_mul_f32 v[214:215], v[214:215], s[92:93]
    v_cvt_pk_bf16_f32 v208, v208, v209
    v_cvt_pk_bf16_f32 v209, v210, v211
    v_cvt_pk_bf16_f32 v210, v212, v213
    v_cvt_pk_bf16_f32 v211, v214, v215
    v_accvgpr_write_b32 a216, v208
    v_accvgpr_write_b32 a217, v209
    v_accvgpr_write_b32 a218, v210
    v_accvgpr_write_b32 a219, v211
    v_pk_mul_f32 v[216:217], v[216:217], s[92:93]
    v_pk_mul_f32 v[218:219], v[218:219], s[92:93]
    v_pk_mul_f32 v[220:221], v[220:221], s[92:93]
    v_pk_mul_f32 v[222:223], v[222:223], s[92:93]
    v_cvt_pk_bf16_f32 v216, v216, v217
    v_cvt_pk_bf16_f32 v217, v218, v219
    v_cvt_pk_bf16_f32 v218, v220, v221
    v_cvt_pk_bf16_f32 v219, v222, v223
    v_accvgpr_write_b32 a220, v216
    v_accvgpr_write_b32 a221, v217
    v_accvgpr_write_b32 a222, v218
    v_accvgpr_write_b32 a223, v219
    v_pk_mul_f32 v[224:225], v[224:225], s[92:93]
    v_pk_mul_f32 v[226:227], v[226:227], s[92:93]
    v_pk_mul_f32 v[228:229], v[228:229], s[92:93]
    v_pk_mul_f32 v[230:231], v[230:231], s[92:93]
    v_cvt_pk_bf16_f32 v224, v224, v225
    v_cvt_pk_bf16_f32 v225, v226, v227
    v_cvt_pk_bf16_f32 v226, v228, v229
    v_cvt_pk_bf16_f32 v227, v230, v231
    v_accvgpr_write_b32 a224, v224
    v_accvgpr_write_b32 a225, v225
    v_accvgpr_write_b32 a226, v226
    v_accvgpr_write_b32 a227, v227
    v_pk_mul_f32 v[232:233], v[232:233], s[92:93]
    v_pk_mul_f32 v[234:235], v[234:235], s[92:93]
    v_pk_mul_f32 v[236:237], v[236:237], s[92:93]
    v_pk_mul_f32 v[238:239], v[238:239], s[92:93]
    v_cvt_pk_bf16_f32 v232, v232, v233
    v_cvt_pk_bf16_f32 v233, v234, v235
    v_cvt_pk_bf16_f32 v234, v236, v237
    v_cvt_pk_bf16_f32 v235, v238, v239
    v_accvgpr_write_b32 a228, v232
    v_accvgpr_write_b32 a229, v233
    v_accvgpr_write_b32 a230, v234
    v_accvgpr_write_b32 a231, v235
    v_pk_mul_f32 v[240:241], v[240:241], s[92:93]
    v_pk_mul_f32 v[242:243], v[242:243], s[92:93]
    v_pk_mul_f32 v[244:245], v[244:245], s[92:93]
    v_pk_mul_f32 v[246:247], v[246:247], s[92:93]
    v_cvt_pk_bf16_f32 v240, v240, v241
    v_cvt_pk_bf16_f32 v241, v242, v243
    v_cvt_pk_bf16_f32 v242, v244, v245
    v_cvt_pk_bf16_f32 v243, v246, v247
    v_accvgpr_write_b32 a232, v240
    v_accvgpr_write_b32 a233, v241
    v_accvgpr_write_b32 a234, v242
    v_accvgpr_write_b32 a235, v243
    v_pk_mul_f32 v[248:249], v[248:249], s[92:93]
    v_pk_mul_f32 v[250:251], v[250:251], s[92:93]
    v_pk_mul_f32 v[252:253], v[252:253], s[92:93]
    v_pk_mul_f32 v[254:255], v[254:255], s[92:93]
    v_cvt_pk_bf16_f32 v248, v248, v249
    v_cvt_pk_bf16_f32 v249, v250, v251
    v_cvt_pk_bf16_f32 v250, v252, v253
    v_cvt_pk_bf16_f32 v251, v254, v255
    v_accvgpr_write_b32 a236, v248
    v_accvgpr_write_b32 a237, v249
    v_accvgpr_write_b32 a238, v250
    v_accvgpr_write_b32 a239, v251
    v_accvgpr_read_b32 v24, a96
    v_accvgpr_read_b32 v25, a97
    v_accvgpr_read_b32 v26, a98
    v_accvgpr_read_b32 v27, a99
    v_accvgpr_read_b32 v28, a100
    v_accvgpr_read_b32 v29, a101
    v_accvgpr_read_b32 v30, a102
    v_accvgpr_read_b32 v31, a103
    v_pk_mul_f32 v[24:25], v[24:25], s[92:93]
    v_pk_mul_f32 v[26:27], v[26:27], s[92:93]
    v_pk_mul_f32 v[28:29], v[28:29], s[92:93]
    v_pk_mul_f32 v[30:31], v[30:31], s[92:93]
    v_cvt_pk_bf16_f32 v24, v24, v25
    v_cvt_pk_bf16_f32 v25, v26, v27
    v_cvt_pk_bf16_f32 v26, v28, v29
    v_cvt_pk_bf16_f32 v27, v30, v31
    v_accvgpr_write_b32 a240, v24
    v_accvgpr_write_b32 a241, v25
    v_accvgpr_write_b32 a242, v26
    v_accvgpr_write_b32 a243, v27
    v_accvgpr_read_b32 v24, a104
    v_accvgpr_read_b32 v25, a105
    v_accvgpr_read_b32 v26, a106
    v_accvgpr_read_b32 v27, a107
    v_accvgpr_read_b32 v28, a108
    v_accvgpr_read_b32 v29, a109
    v_accvgpr_read_b32 v30, a110
    v_accvgpr_read_b32 v31, a111
    v_pk_mul_f32 v[24:25], v[24:25], s[92:93]
    v_pk_mul_f32 v[26:27], v[26:27], s[92:93]
    v_pk_mul_f32 v[28:29], v[28:29], s[92:93]
    v_pk_mul_f32 v[30:31], v[30:31], s[92:93]
    v_cvt_pk_bf16_f32 v24, v24, v25
    v_cvt_pk_bf16_f32 v25, v26, v27
    v_cvt_pk_bf16_f32 v26, v28, v29
    v_cvt_pk_bf16_f32 v27, v30, v31
    v_accvgpr_write_b32 a244, v24
    v_accvgpr_write_b32 a245, v25
    v_accvgpr_write_b32 a246, v26
    v_accvgpr_write_b32 a247, v27
    v_accvgpr_read_b32 v24, a112
    v_accvgpr_read_b32 v25, a113
    v_accvgpr_read_b32 v26, a114
    v_accvgpr_read_b32 v27, a115
    v_accvgpr_read_b32 v28, a116
    v_accvgpr_read_b32 v29, a117
    v_accvgpr_read_b32 v30, a118
    v_accvgpr_read_b32 v31, a119
    v_pk_mul_f32 v[24:25], v[24:25], s[92:93]
    v_pk_mul_f32 v[26:27], v[26:27], s[92:93]
    v_pk_mul_f32 v[28:29], v[28:29], s[92:93]
    v_pk_mul_f32 v[30:31], v[30:31], s[92:93]
    v_cvt_pk_bf16_f32 v24, v24, v25
    v_cvt_pk_bf16_f32 v25, v26, v27
    v_cvt_pk_bf16_f32 v26, v28, v29
    v_cvt_pk_bf16_f32 v27, v30, v31
    v_accvgpr_write_b32 a248, v24
    v_accvgpr_write_b32 a249, v25
    v_accvgpr_write_b32 a250, v26
    v_accvgpr_write_b32 a251, v27
    v_accvgpr_read_b32 v24, a120
    v_accvgpr_read_b32 v25, a121
    v_accvgpr_read_b32 v26, a122
    v_accvgpr_read_b32 v27, a123
    v_accvgpr_read_b32 v28, a124
    v_accvgpr_read_b32 v29, a125
    v_accvgpr_read_b32 v30, a126
    v_accvgpr_read_b32 v31, a127
    v_pk_mul_f32 v[24:25], v[24:25], s[92:93]
    v_pk_mul_f32 v[26:27], v[26:27], s[92:93]
    v_pk_mul_f32 v[28:29], v[28:29], s[92:93]
    v_pk_mul_f32 v[30:31], v[30:31], s[92:93]
    v_cvt_pk_bf16_f32 v24, v24, v25
    v_cvt_pk_bf16_f32 v25, v26, v27
    v_cvt_pk_bf16_f32 v26, v28, v29
    v_cvt_pk_bf16_f32 v27, v30, v31
    v_accvgpr_write_b32 a252, v24
    v_accvgpr_write_b32 a253, v25
    v_accvgpr_write_b32 a254, v26
    v_accvgpr_write_b32 a255, v27
    s_setpc_b64 s[20:21]
m_ns360:
    v_cvt_pk_bf16_f32 v32, v32, v33
    v_cvt_pk_bf16_f32 v33, v34, v35
    v_cvt_pk_bf16_f32 v34, v36, v37
    v_cvt_pk_bf16_f32 v35, v38, v39
    v_accvgpr_write_b32 a128, v32
    v_accvgpr_write_b32 a129, v33
    v_accvgpr_write_b32 a130, v34
    v_accvgpr_write_b32 a131, v35
    v_cvt_pk_bf16_f32 v40, v40, v41
    v_cvt_pk_bf16_f32 v41, v42, v43
    v_cvt_pk_bf16_f32 v42, v44, v45
    v_cvt_pk_bf16_f32 v43, v46, v47
    v_accvgpr_write_b32 a132, v40
    v_accvgpr_write_b32 a133, v41
    v_accvgpr_write_b32 a134, v42
    v_accvgpr_write_b32 a135, v43
    v_cvt_pk_bf16_f32 v48, v48, v49
    v_cvt_pk_bf16_f32 v49, v50, v51
    v_cvt_pk_bf16_f32 v50, v52, v53
    v_cvt_pk_bf16_f32 v51, v54, v55
    v_accvgpr_write_b32 a136, v48
    v_accvgpr_write_b32 a137, v49
    v_accvgpr_write_b32 a138, v50
    v_accvgpr_write_b32 a139, v51
    v_cvt_pk_bf16_f32 v56, v56, v57
    v_cvt_pk_bf16_f32 v57, v58, v59
    v_cvt_pk_bf16_f32 v58, v60, v61
    v_cvt_pk_bf16_f32 v59, v62, v63
    v_accvgpr_write_b32 a140, v56
    v_accvgpr_write_b32 a141, v57
    v_accvgpr_write_b32 a142, v58
    v_accvgpr_write_b32 a143, v59
    v_cvt_pk_bf16_f32 v64, v64, v65
    v_cvt_pk_bf16_f32 v65, v66, v67
    v_cvt_pk_bf16_f32 v66, v68, v69
    v_cvt_pk_bf16_f32 v67, v70, v71
    v_accvgpr_write_b32 a144, v64
    v_accvgpr_write_b32 a145, v65
    v_accvgpr_write_b32 a146, v66
    v_accvgpr_write_b32 a147, v67
    v_cvt_pk_bf16_f32 v72, v72, v73
    v_cvt_pk_bf16_f32 v73, v74, v75
    v_cvt_pk_bf16_f32 v74, v76, v77
    v_cvt_pk_bf16_f32 v75, v78, v79
    v_accvgpr_write_b32 a148, v72
    v_accvgpr_write_b32 a149, v73
    v_accvgpr_write_b32 a150, v74
    v_accvgpr_write_b32 a151, v75
    v_cvt_pk_bf16_f32 v80, v80, v81
    v_cvt_pk_bf16_f32 v81, v82, v83
    v_cvt_pk_bf16_f32 v82, v84, v85
    v_cvt_pk_bf16_f32 v83, v86, v87
    v_accvgpr_write_b32 a152, v80
    v_accvgpr_write_b32 a153, v81
    v_accvgpr_write_b32 a154, v82
    v_accvgpr_write_b32 a155, v83
    v_cvt_pk_bf16_f32 v88, v88, v89
    v_cvt_pk_bf16_f32 v89, v90, v91
    v_cvt_pk_bf16_f32 v90, v92, v93
    v_cvt_pk_bf16_f32 v91, v94, v95
    v_accvgpr_write_b32 a156, v88
    v_accvgpr_write_b32 a157, v89
    v_accvgpr_write_b32 a158, v90
    v_accvgpr_write_b32 a159, v91
    v_cvt_pk_bf16_f32 v96, v96, v97
    v_cvt_pk_bf16_f32 v97, v98, v99
    v_cvt_pk_bf16_f32 v98, v100, v101
    v_cvt_pk_bf16_f32 v99, v102, v103
    v_accvgpr_write_b32 a160, v96
    v_accvgpr_write_b32 a161, v97
    v_accvgpr_write_b32 a162, v98
    v_accvgpr_write_b32 a163, v99
    v_cvt_pk_bf16_f32 v104, v104, v105
    v_cvt_pk_bf16_f32 v105, v106, v107
    v_cvt_pk_bf16_f32 v106, v108, v109
    v_cvt_pk_bf16_f32 v107, v110, v111
    v_accvgpr_write_b32 a164, v104
    v_accvgpr_write_b32 a165, v105
    v_accvgpr_write_b32 a166, v106
    v_accvgpr_write_b32 a167, v107
    v_cvt_pk_bf16_f32 v112, v112, v113
    v_cvt_pk_bf16_f32 v113, v114, v115
    v_cvt_pk_bf16_f32 v114, v116, v117
    v_cvt_pk_bf16_f32 v115, v118, v119
    v_accvgpr_write_b32 a168, v112
    v_accvgpr_write_b32 a169, v113
    v_accvgpr_write_b32 a170, v114
    v_accvgpr_write_b32 a171, v115
    v_cvt_pk_bf16_f32 v120, v120, v121
    v_cvt_pk_bf16_f32 v121, v122, v123
    v_cvt_pk_bf16_f32 v122, v124, v125
    v_cvt_pk_bf16_f32 v123, v126, v127
    v_accvgpr_write_b32 a172, v120
    v_accvgpr_write_b32 a173, v121
    v_accvgpr_write_b32 a174, v122
    v_accvgpr_write_b32 a175, v123
    v_cvt_pk_bf16_f32 v128, v128, v129
    v_cvt_pk_bf16_f32 v129, v130, v131
    v_cvt_pk_bf16_f32 v130, v132, v133
    v_cvt_pk_bf16_f32 v131, v134, v135
    v_accvgpr_write_b32 a176, v128
    v_accvgpr_write_b32 a177, v129
    v_accvgpr_write_b32 a178, v130
    v_accvgpr_write_b32 a179, v131
    v_cvt_pk_bf16_f32 v136, v136, v137
    v_cvt_pk_bf16_f32 v137, v138, v139
    v_cvt_pk_bf16_f32 v138, v140, v141
    v_cvt_pk_bf16_f32 v139, v142, v143
    v_accvgpr_write_b32 a180, v136
    v_accvgpr_write_b32 a181, v137
    v_accvgpr_write_b32 a182, v138
    v_accvgpr_write_b32 a183, v139
    v_cvt_pk_bf16_f32 v144, v144, v145
    v_cvt_pk_bf16_f32 v145, v146, v147
    v_cvt_pk_bf16_f32 v146, v148, v149
    v_cvt_pk_bf16_f32 v147, v150, v151
    v_accvgpr_write_b32 a184, v144
    v_accvgpr_write_b32 a185, v145
    v_accvgpr_write_b32 a186, v146
    v_accvgpr_write_b32 a187, v147
    v_cvt_pk_bf16_f32 v152, v152, v153
    v_cvt_pk_bf16_f32 v153, v154, v155
    v_cvt_pk_bf16_f32 v154, v156, v157
    v_cvt_pk_bf16_f32 v155, v158, v159
    v_accvgpr_write_b32 a188, v152
    v_accvgpr_write_b32 a189, v153
    v_accvgpr_write_b32 a190, v154
    v_accvgpr_write_b32 a191, v155
    v_cvt_pk_bf16_f32 v160, v160, v161
    v_cvt_pk_bf16_f32 v161, v162, v163
    v_cvt_pk_bf16_f32 v162, v164, v165
    v_cvt_pk_bf16_f32 v163, v166, v167
    v_accvgpr_write_b32 a192, v160
    v_accvgpr_write_b32 a193, v161
    v_accvgpr_write_b32 a194, v162
    v_accvgpr_write_b32 a195, v163
    v_cvt_pk_bf16_f32 v168, v168, v169
    v_cvt_pk_bf16_f32 v169, v170, v171
    v_cvt_pk_bf16_f32 v170, v172, v173
    v_cvt_pk_bf16_f32 v171, v174, v175
    v_accvgpr_write_b32 a196, v168
    v_accvgpr_write_b32 a197, v169
    v_accvgpr_write_b32 a198, v170
    v_accvgpr_write_b32 a199, v171
    v_cvt_pk_bf16_f32 v176, v176, v177
    v_cvt_pk_bf16_f32 v177, v178, v179
    v_cvt_pk_bf16_f32 v178, v180, v181
    v_cvt_pk_bf16_f32 v179, v182, v183
    v_accvgpr_write_b32 a200, v176
    v_accvgpr_write_b32 a201, v177
    v_accvgpr_write_b32 a202, v178
    v_accvgpr_write_b32 a203, v179
    v_cvt_pk_bf16_f32 v184, v184, v185
    v_cvt_pk_bf16_f32 v185, v186, v187
    v_cvt_pk_bf16_f32 v186, v188, v189
    v_cvt_pk_bf16_f32 v187, v190, v191
    v_accvgpr_write_b32 a204, v184
    v_accvgpr_write_b32 a205, v185
    v_accvgpr_write_b32 a206, v186
    v_accvgpr_write_b32 a207, v187
    v_cvt_pk_bf16_f32 v192, v192, v193
    v_cvt_pk_bf16_f32 v193, v194, v195
    v_cvt_pk_bf16_f32 v194, v196, v197
    v_cvt_pk_bf16_f32 v195, v198, v199
    v_accvgpr_write_b32 a208, v192
    v_accvgpr_write_b32 a209, v193
    v_accvgpr_write_b32 a210, v194
    v_accvgpr_write_b32 a211, v195
    v_cvt_pk_bf16_f32 v200, v200, v201
    v_cvt_pk_bf16_f32 v201, v202, v203
    v_cvt_pk_bf16_f32 v202, v204, v205
    v_cvt_pk_bf16_f32 v203, v206, v207
    v_accvgpr_write_b32 a212, v200
    v_accvgpr_write_b32 a213, v201
    v_accvgpr_write_b32 a214, v202
    v_accvgpr_write_b32 a215, v203
    v_cvt_pk_bf16_f32 v208, v208, v209
    v_cvt_pk_bf16_f32 v209, v210, v211
    v_cvt_pk_bf16_f32 v210, v212, v213
    v_cvt_pk_bf16_f32 v211, v214, v215
    v_accvgpr_write_b32 a216, v208
    v_accvgpr_write_b32 a217, v209
    v_accvgpr_write_b32 a218, v210
    v_accvgpr_write_b32 a219, v211
    v_cvt_pk_bf16_f32 v216, v216, v217
    v_cvt_pk_bf16_f32 v217, v218, v219
    v_cvt_pk_bf16_f32 v218, v220, v221
    v_cvt_pk_bf16_f32 v219, v222, v223
    v_accvgpr_write_b32 a220, v216
    v_accvgpr_write_b32 a221, v217
    v_accvgpr_write_b32 a222, v218
    v_accvgpr_write_b32 a223, v219
    v_cvt_pk_bf16_f32 v224, v224, v225
    v_cvt_pk_bf16_f32 v225, v226, v227
    v_cvt_pk_bf16_f32 v226, v228, v229
    v_cvt_pk_bf16_f32 v227, v230, v231
    v_accvgpr_write_b32 a224, v224
    v_accvgpr_write_b32 a225, v225
    v_accvgpr_write_b32 a226, v226
    v_accvgpr_write_b32 a227, v227
    v_cvt_pk_bf16_f32 v232, v232, v233
    v_cvt_pk_bf16_f32 v233, v234, v235
    v_cvt_pk_bf16_f32 v234, v236, v237
    v_cvt_pk_bf16_f32 v235, v238, v239
    v_accvgpr_write_b32 a228, v232
    v_accvgpr_write_b32 a229, v233
    v_accvgpr_write_b32 a230, v234
    v_accvgpr_write_b32 a231, v235
    v_cvt_pk_bf16_f32 v240, v240, v241
    v_cvt_pk_bf16_f32 v241, v242, v243
    v_cvt_pk_bf16_f32 v242, v244, v245
    v_cvt_pk_bf16_f32 v243, v246, v247
    v_accvgpr_write_b32 a232, v240
    v_accvgpr_write_b32 a233, v241
    v_accvgpr_write_b32 a234, v242
    v_accvgpr_write_b32 a235, v243
    v_cvt_pk_bf16_f32 v248, v248, v249
    v_cvt_pk_bf16_f32 v249, v250, v251
    v_cvt_pk_bf16_f32 v250, v252, v253
    v_cvt_pk_bf16_f32 v251, v254, v255
    v_accvgpr_write_b32 a236, v248
    v_accvgpr_write_b32 a237, v249
    v_accvgpr_write_b32 a238, v250
    v_accvgpr_write_b32 a239, v251
    v_accvgpr_read_b32 v24, a96
    v_accvgpr_read_b32 v25, a97
    v_accvgpr_read_b32 v26, a98
    v_accvgpr_read_b32 v27, a99
    v_accvgpr_read_b32 v28, a100
    v_accvgpr_read_b32 v29, a101
    v_accvgpr_read_b32 v30, a102
    v_accvgpr_read_b32 v31, a103
    v_cvt_pk_bf16_f32 v24, v24, v25
    v_cvt_pk_bf16_f32 v25, v26, v27
    v_cvt_pk_bf16_f32 v26, v28, v29
    v_cvt_pk_bf16_f32 v27, v30, v31
    v_accvgpr_write_b32 a240, v24
    v_accvgpr_write_b32 a241, v25
    v_accvgpr_write_b32 a242, v26
    v_accvgpr_write_b32 a243, v27
    v_accvgpr_read_b32 v24, a104
    v_accvgpr_read_b32 v25, a105
    v_accvgpr_read_b32 v26, a106
    v_accvgpr_read_b32 v27, a107
    v_accvgpr_read_b32 v28, a108
    v_accvgpr_read_b32 v29, a109
    v_accvgpr_read_b32 v30, a110
    v_accvgpr_read_b32 v31, a111
    v_cvt_pk_bf16_f32 v24, v24, v25
    v_cvt_pk_bf16_f32 v25, v26, v27
    v_cvt_pk_bf16_f32 v26, v28, v29
    v_cvt_pk_bf16_f32 v27, v30, v31
    v_accvgpr_write_b32 a244, v24
    v_accvgpr_write_b32 a245, v25
    v_accvgpr_write_b32 a246, v26
    v_accvgpr_write_b32 a247, v27
    v_accvgpr_read_b32 v24, a112
    v_accvgpr_read_b32 v25, a113
    v_accvgpr_read_b32 v26, a114
    v_accvgpr_read_b32 v27, a115
    v_accvgpr_read_b32 v28, a116
    v_accvgpr_read_b32 v29, a117
    v_accvgpr_read_b32 v30, a118
    v_accvgpr_read_b32 v31, a119
    v_cvt_pk_bf16_f32 v24, v24, v25
    v_cvt_pk_bf16_f32 v25, v26, v27
    v_cvt_pk_bf16_f32 v26, v28, v29
    v_cvt_pk_bf16_f32 v27, v30, v31
    v_accvgpr_write_b32 a248, v24
    v_accvgpr_write_b32 a249, v25
    v_accvgpr_write_b32 a250, v26
    v_accvgpr_write_b32 a251, v27
    v_accvgpr_read_b32 v24, a120
    v_accvgpr_read_b32 v25, a121
    v_accvgpr_read_b32 v26, a122
    v_accvgpr_read_b32 v27, a123
    v_accvgpr_read_b32 v28, a124
    v_accvgpr_read_b32 v29, a125
    v_accvgpr_read_b32 v30, a126
    v_accvgpr_read_b32 v31, a127
    v_cvt_pk_bf16_f32 v24, v24, v25
    v_cvt_pk_bf16_f32 v25, v26, v27
    v_cvt_pk_bf16_f32 v26, v28, v29
    v_cvt_pk_bf16_f32 v27, v30, v31
    v_accvgpr_write_b32 a252, v24
    v_accvgpr_write_b32 a253, v25
    v_accvgpr_write_b32 a254, v26
    v_accvgpr_write_b32 a255, v27
    s_setpc_b64 s[20:21]
m_epf22:
    s_nop 7
    s_cmp_eq_u32 s97, 0
    s_cbranch_scc1 m_noscale61
    s_mov_b32 s91, s98
    s_mov_b32 s92, s97
    s_mov_b32 s93, s97
    s_mov_b32 s90, s91
    v_pk_mul_f32 v[32:33], v[32:33], s[92:93]
    v_pk_mul_f32 v[34:35], v[34:35], s[92:93]
    v_pk_mul_f32 v[36:37], v[36:37], s[92:93]
    v_pk_mul_f32 v[38:39], v[38:39], s[92:93]
    v_cvt_pk_bf16_f32 v32, v32, v33
    v_cvt_pk_bf16_f32 v33, v34, v35
    v_cvt_pk_bf16_f32 v34, v36, v37
    v_cvt_pk_bf16_f32 v35, v38, v39
    buffer_store_dwordx4 v[32:35], v2, s[8:11], s90 offen sc1
    s_add_u32 s90, s90, s100
    v_pk_mul_f32 v[40:41], v[40:41], s[92:93]
    v_pk_mul_f32 v[42:43], v[42:43], s[92:93]
    v_pk_mul_f32 v[44:45], v[44:45], s[92:93]
    v_pk_mul_f32 v[46:47], v[46:47], s[92:93]
    v_cvt_pk_bf16_f32 v40, v40, v41
    v_cvt_pk_bf16_f32 v41, v42, v43
    v_cvt_pk_bf16_f32 v42, v44, v45
    v_cvt_pk_bf16_f32 v43, v46, v47
    buffer_store_dwordx4 v[40:43], v2, s[8:11], s90 offen sc1
    s_add_u32 s90, s90, s100
    v_pk_mul_f32 v[48:49], v[48:49], s[92:93]
    v_pk_mul_f32 v[50:51], v[50:51], s[92:93]
    v_pk_mul_f32 v[52:53], v[52:53], s[92:93]
    v_pk_mul_f32 v[54:55], v[54:55], s[92:93]
    v_cvt_pk_bf16_f32 v48, v48, v49
    v_cvt_pk_bf16_f32 v49, v50, v51
    v_cvt_pk_bf16_f32 v50, v52, v53
    v_cvt_pk_bf16_f32 v51, v54, v55
    buffer_store_dwordx4 v[48:51], v2, s[8:11], s90 offen sc1
    s_add_u32 s90, s90, s100
    v_pk_mul_f32 v[56:57], v[56:57], s[92:93]
    v_pk_mul_f32 v[58:59], v[58:59], s[92:93]
    v_pk_mul_f32 v[60:61], v[60:61], s[92:93]
    v_pk_mul_f32 v[62:63], v[62:63], s[92:93]
    v_cvt_pk_bf16_f32 v56, v56, v57
    v_cvt_pk_bf16_f32 v57, v58, v59
    v_cvt_pk_bf16_f32 v58, v60, v61
    v_cvt_pk_bf16_f32 v59, v62, v63
    buffer_store_dwordx4 v[56:59], v2, s[8:11], s90 offen sc1
    s_add_u32 s90, s90, s100
    v_pk_mul_f32 v[64:65], v[64:65], s[92:93]
    v_pk_mul_f32 v[66:67], v[66:67], s[92:93]
    v_pk_mul_f32 v[68:69], v[68:69], s[92:93]
    v_pk_mul_f32 v[70:71], v[70:71], s[92:93]
    v_cvt_pk_bf16_f32 v64, v64, v65
    v_cvt_pk_bf16_f32 v65, v66, v67
    v_cvt_pk_bf16_f32 v66, v68, v69
    v_cvt_pk_bf16_f32 v67, v70, v71
    buffer_store_dwordx4 v[64:67], v2, s[8:11], s90 offen sc1
    s_add_u32 s90, s90, s100
    v_pk_mul_f32 v[72:73], v[72:73], s[92:93]
    v_pk_mul_f32 v[74:75], v[74:75], s[92:93]
    v_pk_mul_f32 v[76:77], v[76:77], s[92:93]
    v_pk_mul_f32 v[78:79], v[78:79], s[92:93]
    v_cvt_pk_bf16_f32 v72, v72, v73
    v_cvt_pk_bf16_f32 v73, v74, v75
    v_cvt_pk_bf16_f32 v74, v76, v77
    v_cvt_pk_bf16_f32 v75, v78, v79
    buffer_store_dwordx4 v[72:75], v2, s[8:11], s90 offen sc1
    s_add_u32 s90, s90, s100
    v_pk_mul_f32 v[80:81], v[80:81], s[92:93]
    v_pk_mul_f32 v[82:83], v[82:83], s[92:93]
    v_pk_mul_f32 v[84:85], v[84:85], s[92:93]
    v_pk_mul_f32 v[86:87], v[86:87], s[92:93]
    v_cvt_pk_bf16_f32 v80, v80, v81
    v_cvt_pk_bf16_f32 v81, v82, v83
    v_cvt_pk_bf16_f32 v82, v84, v85
    v_cvt_pk_bf16_f32 v83, v86, v87
    buffer_store_dwordx4 v[80:83], v2, s[8:11], s90 offen sc1
    s_add_u32 s90, s90, s100
    v_pk_mul_f32 v[88:89], v[88:89], s[92:93]
    v_pk_mul_f32 v[90:91], v[90:91], s[92:93]
    v_pk_mul_f32 v[92:93], v[92:93], s[92:93]
    v_pk_mul_f32 v[94:95], v[94:95], s[92:93]
    v_cvt_pk_bf16_f32 v88, v88, v89
    v_cvt_pk_bf16_f32 v89, v90, v91
    v_cvt_pk_bf16_f32 v90, v92, v93
    v_cvt_pk_bf16_f32 v91, v94, v95
    buffer_store_dwordx4 v[88:91], v2, s[8:11], s90 offen sc1
    s_add_u32 s90, s90, s100
    s_add_u32 s91, s91, s99
    s_mov_b32 s90, s91
    v_pk_mul_f32 v[96:97], v[96:97], s[92:93]
    v_pk_mul_f32 v[98:99], v[98:99], s[92:93]
    v_pk_mul_f32 v[100:101], v[100:101], s[92:93]
    v_pk_mul_f32 v[102:103], v[102:103], s[92:93]
    v_cvt_pk_bf16_f32 v96, v96, v97
    v_cvt_pk_bf16_f32 v97, v98, v99
    v_cvt_pk_bf16_f32 v98, v100, v101
    v_cvt_pk_bf16_f32 v99, v102, v103
    buffer_store_dwordx4 v[96:99], v2, s[8:11], s90 offen sc1
    s_add_u32 s90, s90, s100
    v_pk_mul_f32 v[104:105], v[104:105], s[92:93]
    v_pk_mul_f32 v[106:107], v[106:107], s[92:93]
    v_pk_mul_f32 v[108:109], v[108:109], s[92:93]
    v_pk_mul_f32 v[110:111], v[110:111], s[92:93]
    v_cvt_pk_bf16_f32 v104, v104, v105
    v_cvt_pk_bf16_f32 v105, v106, v107
    v_cvt_pk_bf16_f32 v106, v108, v109
    v_cvt_pk_bf16_f32 v107, v110, v111
    buffer_store_dwordx4 v[104:107], v2, s[8:11], s90 offen sc1
    s_add_u32 s90, s90, s100
    v_pk_mul_f32 v[112:113], v[112:113], s[92:93]
    v_pk_mul_f32 v[114:115], v[114:115], s[92:93]
    v_pk_mul_f32 v[116:117], v[116:117], s[92:93]
    v_pk_mul_f32 v[118:119], v[118:119], s[92:93]
    v_cvt_pk_bf16_f32 v112, v112, v113
    v_cvt_pk_bf16_f32 v113, v114, v115
    v_cvt_pk_bf16_f32 v114, v116, v117
    v_cvt_pk_bf16_f32 v115, v118, v119
    buffer_store_dwordx4 v[112:115], v2, s[8:11], s90 offen sc1
    s_add_u32 s90, s90, s100
    v_pk_mul_f32 v[120:121], v[120:121], s[92:93]
    v_pk_mul_f32 v[122:123], v[122:123], s[92:93]
    v_pk_mul_f32 v[124:125], v[124:125], s[92:93]
    v_pk_mul_f32 v[126:127], v[126:127], s[92:93]
    v_cvt_pk_bf16_f32 v120, v120, v121
    v_cvt_pk_bf16_f32 v121, v122, v123
    v_cvt_pk_bf16_f32 v122, v124, v125
    v_cvt_pk_bf16_f32 v123, v126, v127
    buffer_store_dwordx4 v[120:123], v2, s[8:11], s90 offen sc1
    s_add_u32 s90, s90, s100
    v_pk_mul_f32 v[128:129], v[128:129], s[92:93]
    v_pk_mul_f32 v[130:131], v[130:131], s[92:93]
    v_pk_mul_f32 v[132:133], v[132:133], s[92:93]
    v_pk_mul_f32 v[134:135], v[134:135], s[92:93]
    v_cvt_pk_bf16_f32 v128, v128, v129
    v_cvt_pk_bf16_f32 v129, v130, v131
    v_cvt_pk_bf16_f32 v130, v132, v133
    v_cvt_pk_bf16_f32 v131, v134, v135
    buffer_store_dwordx4 v[128:131], v2, s[8:11], s90 offen sc1
    s_add_u32 s90, s90, s100
    v_pk_mul_f32 v[136:137], v[136:137], s[92:93]
    v_pk_mul_f32 v[138:139], v[138:139], s[92:93]
    v_pk_mul_f32 v[140:141], v[140:141], s[92:93]
    v_pk_mul_f32 v[142:143], v[142:143], s[92:93]
    v_cvt_pk_bf16_f32 v136, v136, v137
    v_cvt_pk_bf16_f32 v137, v138, v139
    v_cvt_pk_bf16_f32 v138, v140, v141
    v_cvt_pk_bf16_f32 v139, v142, v143
    buffer_store_dwordx4 v[136:139], v2, s[8:11], s90 offen sc1
    s_add_u32 s90, s90, s100
    v_pk_mul_f32 v[144:145], v[144:145], s[92:93]
    v_pk_mul_f32 v[146:147], v[146:147], s[92:93]
    v_pk_mul_f32 v[148:149], v[148:149], s[92:93]
    v_pk_mul_f32 v[150:151], v[150:151], s[92:93]
    v_cvt_pk_bf16_f32 v144, v144, v145
    v_cvt_pk_bf16_f32 v145, v146, v147
    v_cvt_pk_bf16_f32 v146, v148, v149
    v_cvt_pk_bf16_f32 v147, v150, v151
    buffer_store_dwordx4 v[144:147], v2, s[8:11], s90 offen sc1
    s_add_u32 s90, s90, s100
    v_pk_mul_f32 v[152:153], v[152:153], s[92:93]
    v_pk_mul_f32 v[154:155], v[154:155], s[92:93]
    v_pk_mul_f32 v[156:157], v[156:157], s[92:93]
    v_pk_mul_f32 v[158:159], v[158:159], s[92:93]
    v_cvt_pk_bf16_f32 v152, v152, v153
    v_cvt_pk_bf16_f32 v153, v154, v155
    v_cvt_pk_bf16_f32 v154, v156, v157
    v_cvt_pk_bf16_f32 v155, v158, v159
    buffer_store_dwordx4 v[152:155], v2, s[8:11], s90 offen sc1
    s_add_u32 s90, s90, s100
    s_add_u32 s91, s91, s99
    s_mov_b32 s90, s91
    v_pk_mul_f32 v[160:161], v[160:161], s[92:93]
    v_pk_mul_f32 v[162:163], v[162:163], s[92:93]
    v_pk_mul_f32 v[164:165], v[164:165], s[92:93]
    v_pk_mul_f32 v[166:167], v[166:167], s[92:93]
    v_cvt_pk_bf16_f32 v160, v160, v161
    v_cvt_pk_bf16_f32 v161, v162, v163
    v_cvt_pk_bf16_f32 v162, v164, v165
    v_cvt_pk_bf16_f32 v163, v166, v167
    buffer_store_dwordx4 v[160:163], v2, s[8:11], s90 offen sc1
    s_add_u32 s90, s90, s100
    v_pk_mul_f32 v[168:169], v[168:169], s[92:93]
    v_pk_mul_f32 v[170:171], v[170:171], s[92:93]
    v_pk_mul_f32 v[172:173], v[172:173], s[92:93]
    v_pk_mul_f32 v[174:175], v[174:175], s[92:93]
    v_cvt_pk_bf16_f32 v168, v168, v169
    v_cvt_pk_bf16_f32 v169, v170, v171
    v_cvt_pk_bf16_f32 v170, v172, v173
    v_cvt_pk_bf16_f32 v171, v174, v175
    buffer_store_dwordx4 v[168:171], v2, s[8:11], s90 offen sc1
    s_add_u32 s90, s90, s100
    v_pk_mul_f32 v[176:177], v[176:177], s[92:93]
    v_pk_mul_f32 v[178:179], v[178:179], s[92:93]
    v_pk_mul_f32 v[180:181], v[180:181], s[92:93]
    v_pk_mul_f32 v[182:183], v[182:183], s[92:93]
    v_cvt_pk_bf16_f32 v176, v176, v177
    v_cvt_pk_bf16_f32 v177, v178, v179
    v_cvt_pk_bf16_f32 v178, v180, v181
    v_cvt_pk_bf16_f32 v179, v182, v183
    buffer_store_dwordx4 v[176:179], v2, s[8:11], s90 offen sc1
    s_add_u32 s90, s90, s100
    v_pk_mul_f32 v[184:185], v[184:185], s[92:93]
    v_pk_mul_f32 v[186:187], v[186:187], s[92:93]
    v_pk_mul_f32 v[188:189], v[188:189], s[92:93]
    v_pk_mul_f32 v[190:191], v[190:191], s[92:93]
    v_cvt_pk_bf16_f32 v184, v184, v185
    v_cvt_pk_bf16_f32 v185, v186, v187
    v_cvt_pk_bf16_f32 v186, v188, v189
    v_cvt_pk_bf16_f32 v187, v190, v191
    buffer_store_dwordx4 v[184:187], v2, s[8:11], s90 offen sc1
    s_add_u32 s90, s90, s100
    v_pk_mul_f32 v[192:193], v[192:193], s[92:93]
    v_pk_mul_f32 v[194:195], v[194:195], s[92:93]
    v_pk_mul_f32 v[196:197], v[196:197], s[92:93]
    v_pk_mul_f32 v[198:199], v[198:199], s[92:93]
    v_cvt_pk_bf16_f32 v192, v192, v193
    v_cvt_pk_bf16_f32 v193, v194, v195
    v_cvt_pk_bf16_f32 v194, v196, v197
    v_cvt_pk_bf16_f32 v195, v198, v199
    buffer_store_dwordx4 v[192:195], v2, s[8:11], s90 offen sc1
    s_add_u32 s90, s90, s100
    v_pk_mul_f32 v[200:201], v[200:201], s[92:93]
    v_pk_mul_f32 v[202:203], v[202:203], s[92:93]
    v_pk_mul_f32 v[204:205], v[204:205], s[92:93]
    v_pk_mul_f32 v[206:207], v[206:207], s[92:93]
    v_cvt_pk_bf16_f32 v200, v200, v201
    v_cvt_pk_bf16_f32 v201, v202, v203
    v_cvt_pk_bf16_f32 v202, v204, v205
    v_cvt_pk_bf16_f32 v203, v206, v207
    buffer_store_dwordx4 v[200:203], v2, s[8:11], s90 offen sc1
    s_add_u32 s90, s90, s100
    v_pk_mul_f32 v[208:209], v[208:209], s[92:93]
    v_pk_mul_f32 v[210:211], v[210:211], s[92:93]
    v_pk_mul_f32 v[212:213], v[212:213], s[92:93]
    v_pk_mul_f32 v[214:215], v[214:215], s[92:93]
    v_cvt_pk_bf16_f32 v208, v208, v209
    v_cvt_pk_bf16_f32 v209, v210, v211
    v_cvt_pk_bf16_f32 v210, v212, v213
    v_cvt_pk_bf16_f32 v211, v214, v215
    buffer_store_dwordx4 v[208:211], v2, s[8:11], s90 offen sc1
    s_add_u32 s90, s90, s100
    v_pk_mul_f32 v[216:217], v[216:217], s[92:93]
    v_pk_mul_f32 v[218:219], v[218:219], s[92:93]
    v_pk_mul_f32 v[220:221], v[220:221], s[92:93]
    v_pk_mul_f32 v[222:223], v[222:223], s[92:93]
    v_cvt_pk_bf16_f32 v216, v216, v217
    v_cvt_pk_bf16_f32 v217, v218, v219
    v_cvt_pk_bf16_f32 v218, v220, v221
    v_cvt_pk_bf16_f32 v219, v222, v223
    buffer_store_dwordx4 v[216:219], v2, s[8:11], s90 offen sc1
    s_add_u32 s90, s90, s100
    s_add_u32 s91, s91, s99
    s_mov_b32 s90, s91
    v_pk_mul_f32 v[224:225], v[224:225], s[92:93]
    v_pk_mul_f32 v[226:227], v[226:227], s[92:93]
    v_pk_mul_f32 v[228:229], v[228:229], s[92:93]
    v_pk_mul_f32 v[230:231], v[230:231], s[92:93]
    v_cvt_pk_bf16_f32 v224, v224, v225
    v_cvt_pk_bf16_f32 v225, v226, v227
    v_cvt_pk_bf16_f32 v226, v228, v229
    v_cvt_pk_bf16_f32 v227, v230, v231
    buffer_store_dwordx4 v[224:227], v2, s[8:11], s90 offen sc1
    s_add_u32 s90, s90, s100
    v_pk_mul_f32 v[232:233], v[232:233], s[92:93]
    v_pk_mul_f32 v[234:235], v[234:235], s[92:93]
    v_pk_mul_f32 v[236:237], v[236:237], s[92:93]
    v_pk_mul_f32 v[238:239], v[238:239], s[92:93]
    v_cvt_pk_bf16_f32 v232, v232, v233
    v_cvt_pk_bf16_f32 v233, v234, v235
    v_cvt_pk_bf16_f32 v234, v236, v237
    v_cvt_pk_bf16_f32 v235, v238, v239
    buffer_store_dwordx4 v[232:235], v2, s[8:11], s90 offen sc1
    s_add_u32 s90, s90, s100
    v_pk_mul_f32 v[240:241], v[240:241], s[92:93]
    v_pk_mul_f32 v[242:243], v[242:243], s[92:93]
    v_pk_mul_f32 v[244:245], v[244:245], s[92:93]
    v_pk_mul_f32 v[246:247], v[246:247], s[92:93]
    v_cvt_pk_bf16_f32 v240, v240, v241
    v_cvt_pk_bf16_f32 v241, v242, v243
    v_cvt_pk_bf16_f32 v242, v244, v245
    v_cvt_pk_bf16_f32 v243, v246, v247
    buffer_store_dwordx4 v[240:243], v2, s[8:11], s90 offen sc1
    s_add_u32 s90, s90, s100
    v_pk_mul_f32 v[248:249], v[248:249], s[92:93]
    v_pk_mul_f32 v[250:251], v[250:251], s[92:93]
    v_pk_mul_f32 v[252:253], v[252:253], s[92:93]
    v_pk_mul_f32 v[254:255], v[254:255], s[92:93]
    v_cvt_pk_bf16_f32 v248, v248, v249
    v_cvt_pk_bf16_f32 v249, v250, v251
    v_cvt_pk_bf16_f32 v250, v252, v253
    v_cvt_pk_bf16_f32 v251, v254, v255
    buffer_store_dwordx4 v[248:251], v2, s[8:11], s90 offen sc1
    s_add_u32 s90, s90, s100
    v_accvgpr_read_b32 v24, a96
    v_accvgpr_read_b32 v25, a97
    v_accvgpr_read_b32 v26, a98
    v_accvgpr_read_b32 v27, a99
    v_accvgpr_read_b32 v28, a100
    v_accvgpr_read_b32 v29, a101
    v_accvgpr_read_b32 v30, a102
    v_accvgpr_read_b32 v31, a103
    v_pk_mul_f32 v[24:25], v[24:25], s[92:93]
    v_pk_mul_f32 v[26:27], v[26:27], s[92:93]
    v_pk_mul_f32 v[28:29], v[28:29], s[92:93]
    v_pk_mul_f32 v[30:31], v[30:31], s[92:93]
    v_cvt_pk_bf16_f32 v24, v24, v25
    v_cvt_pk_bf16_f32 v25, v26, v27
    v_cvt_pk_bf16_f32 v26, v28, v29
    v_cvt_pk_bf16_f32 v27, v30, v31
    buffer_store_dwordx4 v[24:27], v2, s[8:11], s90 offen sc1
    s_add_u32 s90, s90, s100
    s_nop 1
    v_accvgpr_read_b32 v24, a104
    v_accvgpr_read_b32 v25, a105
    v_accvgpr_read_b32 v26, a106
    v_accvgpr_read_b32 v27, a107
    v_accvgpr_read_b32 v28, a108
    v_accvgpr_read_b32 v29, a109
    v_accvgpr_read_b32 v30, a110
    v_accvgpr_read_b32 v31, a111
    v_pk_mul_f32 v[24:25], v[24:25], s[92:93]
    v_pk_mul_f32 v[26:27], v[26:27], s[92:93]
    v_pk_mul_f32 v[28:29], v[28:29], s[92:93]
    v_pk_mul_f32 v[30:31], v[30:31], s[92:93]
    v_cvt_pk_bf16_f32 v24, v24, v25
    v_cvt_pk_bf16_f32 v25, v26, v27
    v_cvt_pk_bf16_f32 v26, v28, v29
    v_cvt_pk_bf16_f32 v27, v30, v31
    buffer_store_dwordx4 v[24:27], v2, s[8:11], s90 offen sc1
    s_add_u32 s90, s90, s100
    s_nop 1
    v_accvgpr_read_b32 v24, a112
    v_accvgpr_read_b32 v25, a113
    v_accvgpr_read_b32 v26, a114
    v_accvgpr_read_b32 v27, a115
    v_accvgpr_read_b32 v28, a116
    v_accvgpr_read_b32 v29, a117
    v_accvgpr_read_b32 v30, a118
    v_accvgpr_read_b32 v31, a119
    v_pk_mul_f32 v[24:25], v[24:25], s[92:93]
    v_pk_mul_f32 v[26:27], v[26:27], s[92:93]
    v_pk_mul_f32 v[28:29], v[28:29], s[92:93]
    v_pk_mul_f32 v[30:31], v[30:31], s[92:93]
    v_cvt_pk_bf16_f32 v24, v24, v25
    v_cvt_pk_bf16_f32 v25, v26, v27
    v_cvt_pk_bf16_f32 v26, v28, v29
    v_cvt_pk_bf16_f32 v27, v30, v31
    buffer_store_dwordx4 v[24:27], v2, s[8:11], s90 offen sc1
    s_add_u32 s90, s90, s100
    s_nop 1
    v_accvgpr_read_b32 v24, a120
    v_accvgpr_read_b32 v25, a121
    v_accvgpr_read_b32 v26, a122
    v_accvgpr_read_b32 v27, a123
    v_accvgpr_read_b32 v28, a124
    v_accvgpr_read_b32 v29, a125
    v_accvgpr_read_b32 v30, a126
    v_accvgpr_read_b32 v31, a127
    v_pk_mul_f32 v[24:25], v[24:25], s[92:93]
    v_pk_mul_f32 v[26:27], v[26:27], s[92:93]
    v_pk_mul_f32 v[28:29], v[28:29], s[92:93]
    v_pk_mul_f32 v[30:31], v[30:31], s[92:93]
    v_cvt_pk_bf16_f32 v24, v24, v25
    v_cvt_pk_bf16_f32 v25, v26, v27
    v_cvt_pk_bf16_f32 v26, v28, v29
    v_cvt_pk_bf16_f32 v27, v30, v31
    buffer_store_dwordx4 v[24:27], v2, s[8:11], s90 offen sc1
    s_add_u32 s90, s90, s100
    s_nop 1
    s_add_u32 s91, s91, s99
    s_setpc_b64 s[20:21]
m_noscale61:
    s_mov_b32 s91, s98
    s_mov_b32 s92, s97
    s_mov_b32 s93, s97
    s_mov_b32 s90, s91
    v_cvt_pk_bf16_f32 v32, v32, v33
    v_cvt_pk_bf16_f32 v33, v34, v35
    v_cvt_pk_bf16_f32 v34, v36, v37
    v_cvt_pk_bf16_f32 v35, v38, v39
    buffer_store_dwordx4 v[32:35], v2, s[8:11], s90 offen sc1
    s_add_u32 s90, s90, s100
    v_cvt_pk_bf16_f32 v40, v40, v41
    v_cvt_pk_bf16_f32 v41, v42, v43
    v_cvt_pk_bf16_f32 v42, v44, v45
    v_cvt_pk_bf16_f32 v43, v46, v47
    buffer_store_dwordx4 v[40:43], v2, s[8:11], s90 offen sc1
    s_add_u32 s90, s90, s100
    v_cvt_pk_bf16_f32 v48, v48, v49
    v_cvt_pk_bf16_f32 v49, v50, v51
    v_cvt_pk_bf16_f32 v50, v52, v53
    v_cvt_pk_bf16_f32 v51, v54, v55
    buffer_store_dwordx4 v[48:51], v2, s[8:11], s90 offen sc1
    s_add_u32 s90, s90, s100
    v_cvt_pk_bf16_f32 v56, v56, v57
    v_cvt_pk_bf16_f32 v57, v58, v59
    v_cvt_pk_bf16_f32 v58, v60, v61
    v_cvt_pk_bf16_f32 v59, v62, v63
    buffer_store_dwordx4 v[56:59], v2, s[8:11], s90 offen sc1
    s_add_u32 s90, s90, s100
    v_cvt_pk_bf16_f32 v64, v64, v65
    v_cvt_pk_bf16_f32 v65, v66, v67
    v_cvt_pk_bf16_f32 v66, v68, v69
    v_cvt_pk_bf16_f32 v67, v70, v71
    buffer_store_dwordx4 v[64:67], v2, s[8:11], s90 offen sc1
    s_add_u32 s90, s90, s100
    v_cvt_pk_bf16_f32 v72, v72, v73
    v_cvt_pk_bf16_f32 v73, v74, v75
    v_cvt_pk_bf16_f32 v74, v76, v77
    v_cvt_pk_bf16_f32 v75, v78, v79
    buffer_store_dwordx4 v[72:75], v2, s[8:11], s90 offen sc1
    s_add_u32 s90, s90, s100
    v_cvt_pk_bf16_f32 v80, v80, v81
    v_cvt_pk_bf16_f32 v81, v82, v83
    v_cvt_pk_bf16_f32 v82, v84, v85
    v_cvt_pk_bf16_f32 v83, v86, v87
    buffer_store_dwordx4 v[80:83], v2, s[8:11], s90 offen sc1
    s_add_u32 s90, s90, s100
    v_cvt_pk_bf16_f32 v88, v88, v89
    v_cvt_pk_bf16_f32 v89, v90, v91
    v_cvt_pk_bf16_f32 v90, v92, v93
    v_cvt_pk_bf16_f32 v91, v94, v95
    buffer_store_dwordx4 v[88:91], v2, s[8:11], s90 offen sc1
    s_add_u32 s90, s90, s100
    s_add_u32 s91, s91, s99
    s_mov_b32 s90, s91
    v_cvt_pk_bf16_f32 v96, v96, v97
    v_cvt_pk_bf16_f32 v97, v98, v99
    v_cvt_pk_bf16_f32 v98, v100, v101
    v_cvt_pk_bf16_f32 v99, v102, v103
    buffer_store_dwordx4 v[96:99], v2, s[8:11], s90 offen sc1
    s_add_u32 s90, s90, s100
    v_cvt_pk_bf16_f32 v104, v104, v105
    v_cvt_pk_bf16_f32 v105, v106, v107
    v_cvt_pk_bf16_f32 v106, v108, v109
    v_cvt_pk_bf16_f32 v107, v110, v111
    buffer_store_dwordx4 v[104:107], v2, s[8:11], s90 offen sc1
    s_add_u32 s90, s90, s100
    v_cvt_pk_bf16_f32 v112, v112, v113
    v_cvt_pk_bf16_f32 v113, v114, v115
    v_cvt_pk_bf16_f32 v114, v116, v117
    v_cvt_pk_bf16_f32 v115, v118, v119
    buffer_store_dwordx4 v[112:115], v2, s[8:11], s90 offen sc1
    s_add_u32 s90, s90, s100
    v_cvt_pk_bf16_f32 v120, v120, v121
    v_cvt_pk_bf16_f32 v121, v122, v123
    v_cvt_pk_bf16_f32 v122, v124, v125
    v_cvt_pk_bf16_f32 v123, v126, v127
    buffer_store_dwordx4 v[120:123], v2, s[8:11], s90 offen sc1
    s_add_u32 s90, s90, s100
    v_cvt_pk_bf16_f32 v128, v128, v129
    v_cvt_pk_bf16_f32 v129, v130, v131
    v_cvt_pk_bf16_f32 v130, v132, v133
    v_cvt_pk_bf16_f32 v131, v134, v135
    buffer_store_dwordx4 v[128:131], v2, s[8:11], s90 offen sc1
    s_add_u32 s90, s90, s100
    v_cvt_pk_bf16_f32 v136, v136, v137
    v_cvt_pk_bf16_f32 v137, v138, v139
    v_cvt_pk_bf16_f32 v138, v140, v141
    v_cvt_pk_bf16_f32 v139, v142, v143
    buffer_store_dwordx4 v[136:139], v2, s[8:11], s90 offen sc1
    s_add_u32 s90, s90, s100
    v_cvt_pk_bf16_f32 v144, v144, v145
    v_cvt_pk_bf16_f32 v145, v146, v147
    v_cvt_pk_bf16_f32 v146, v148, v149
    v_cvt_pk_bf16_f32 v147, v150, v151
    buffer_store_dwordx4 v[144:147], v2, s[8:11], s90 offen sc1
    s_add_u32 s90, s90, s100
    v_cvt_pk_bf16_f32 v152, v152, v153
    v_cvt_pk_bf16_f32 v153, v154, v155
    v_cvt_pk_bf16_f32 v154, v156, v157
    v_cvt_pk_bf16_f32 v155, v158, v159
    buffer_store_dwordx4 v[152:155], v2, s[8:11], s90 offen sc1
    s_add_u32 s90, s90, s100
    s_add_u32 s91, s91, s99
    s_mov_b32 s90, s91
    v_cvt_pk_bf16_f32 v160, v160, v161
    v_cvt_pk_bf16_f32 v161, v162, v163
    v_cvt_pk_bf16_f32 v162, v164, v165
    v_cvt_pk_bf16_f32 v163, v166, v167
    buffer_store_dwordx4 v[160:163], v2, s[8:11], s90 offen sc1
    s_add_u32 s90, s90, s100
    v_cvt_pk_bf16_f32 v168, v168, v169
    v_cvt_pk_bf16_f32 v169, v170, v171
    v_cvt_pk_bf16_f32 v170, v172, v173
    v_cvt_pk_bf16_f32 v171, v174, v175
    buffer_store_dwordx4 v[168:171], v2, s[8:11], s90 offen sc1
    s_add_u32 s90, s90, s100
    v_cvt_pk_bf16_f32 v176, v176, v177
    v_cvt_pk_bf16_f32 v177, v178, v179
    v_cvt_pk_bf16_f32 v178, v180, v181
    v_cvt_pk_bf16_f32 v179, v182, v183
    buffer_store_dwordx4 v[176:179], v2, s[8:11], s90 offen sc1
    s_add_u32 s90, s90, s100
    v_cvt_pk_bf16_f32 v184, v184, v185
    v_cvt_pk_bf16_f32 v185, v186, v187
    v_cvt_pk_bf16_f32 v186, v188, v189
    v_cvt_pk_bf16_f32 v187, v190, v191
    buffer_store_dwordx4 v[184:187], v2, s[8:11], s90 offen sc1
    s_add_u32 s90, s90, s100
    v_cvt_pk_bf16_f32 v192, v192, v193
    v_cvt_pk_bf16_f32 v193, v194, v195
    v_cvt_pk_bf16_f32 v194, v196, v197
    v_cvt_pk_bf16_f32 v195, v198, v199
    buffer_store_dwordx4 v[192:195], v2, s[8:11], s90 offen sc1
    s_add_u32 s90, s90, s100
    v_cvt_pk_bf16_f32 v200, v200, v201
    v_cvt_pk_bf16_f32 v201, v202, v203
    v_cvt_pk_bf16_f32 v202, v204, v205
    v_cvt_pk_bf16_f32 v203, v206, v207
    buffer_store_dwordx4 v[200:203], v2, s[8:11], s90 offen sc1
    s_add_u32 s90, s90, s100
    v_cvt_pk_bf16_f32 v208, v208, v209
    v_cvt_pk_bf16_f32 v209, v210, v211
    v_cvt_pk_bf16_f32 v210, v212, v213
    v_cvt_pk_bf16_f32 v211, v214, v215
    buffer_store_dwordx4 v[208:211], v2, s[8:11], s90 offen sc1
    s_add_u32 s90, s90, s100
    v_cvt_pk_bf16_f32 v216, v216, v217
    v_cvt_pk_bf16_f32 v217, v218, v219
    v_cvt_pk_bf16_f32 v218, v220, v221
    v_cvt_pk_bf16_f32 v219, v222, v223
    buffer_store_dwordx4 v[216:219], v2, s[8:11], s90 offen sc1
    s_add_u32 s90, s90, s100
    s_add_u32 s91, s91, s99
    s_mov_b32 s90, s91
    v_cvt_pk_bf16_f32 v224, v224, v225
    v_cvt_pk_bf16_f32 v225, v226, v227
    v_cvt_pk_bf16_f32 v226, v228, v229
    v_cvt_pk_bf16_f32 v227, v230, v231
    buffer_store_dwordx4 v[224:227], v2, s[8:11], s90 offen sc1
    s_add_u32 s90, s90, s100
    v_cvt_pk_bf16_f32 v232, v232, v233
    v_cvt_pk_bf16_f32 v233, v234, v235
    v_cvt_pk_bf16_f32 v234, v236, v237
    v_cvt_pk_bf16_f32 v235, v238, v239
    buffer_store_dwordx4 v[232:235], v2, s[8:11], s90 offen sc1
    s_add_u32 s90, s90, s100
    v_cvt_pk_bf16_f32 v240, v240, v241
    v_cvt_pk_bf16_f32 v241, v242, v243
    v_cvt_pk_bf16_f32 v242, v244, v245
    v_cvt_pk_bf16_f32 v243, v246, v247
    buffer_store_dwordx4 v[240:243], v2, s[8:11], s90 offen sc1
    s_add_u32 s90, s90, s100
    v_cvt_pk_bf16_f32 v248, v248, v249
    v_cvt_pk_bf16_f32 v249, v250, v251
    v_cvt_pk_bf16_f32 v250, v252, v253
    v_cvt_pk_bf16_f32 v251, v254, v255
    buffer_store_dwordx4 v[248:251], v2, s[8:11], s90 offen sc1
    s_add_u32 s90, s90, s100
    v_accvgpr_read_b32 v24, a96
    v_accvgpr_read_b32 v25, a97
    v_accvgpr_read_b32 v26, a98
    v_accvgpr_read_b32 v27, a99
    v_accvgpr_read_b32 v28, a100
    v_accvgpr_read_b32 v29, a101
    v_accvgpr_read_b32 v30, a102
    v_accvgpr_read_b32 v31, a103
    v_cvt_pk_bf16_f32 v24, v24, v25
    v_cvt_pk_bf16_f32 v25, v26, v27
    v_cvt_pk_bf16_f32 v26, v28, v29
    v_cvt_pk_bf16_f32 v27, v30, v31
    buffer_store_dwordx4 v[24:27], v2, s[8:11], s90 offen sc1
    s_add_u32 s90, s90, s100
    s_nop 1
    v_accvgpr_read_b32 v24, a104
    v_accvgpr_read_b32 v25, a105
    v_accvgpr_read_b32 v26, a106
    v_accvgpr_read_b32 v27, a107
    v_accvgpr_read_b32 v28, a108
    v_accvgpr_read_b32 v29, a109
    v_accvgpr_read_b32 v30, a110
    v_accvgpr_read_b32 v31, a111
    v_cvt_pk_bf16_f32 v24, v24, v25
    v_cvt_pk_bf16_f32 v25, v26, v27
    v_cvt_pk_bf16_f32 v26, v28, v29
    v_cvt_pk_bf16_f32 v27, v30, v31
    buffer_store_dwordx4 v[24:27], v2, s[8:11], s90 offen sc1
    s_add_u32 s90, s90, s100
    s_nop 1
    v_accvgpr_read_b32 v24, a112
    v_accvgpr_read_b32 v25, a113
    v_accvgpr_read_b32 v26, a114
    v_accvgpr_read_b32 v27, a115
    v_accvgpr_read_b32 v28, a116
    v_accvgpr_read_b32 v29, a117
    v_accvgpr_read_b32 v30, a118
    v_accvgpr_read_b32 v31, a119
    v_cvt_pk_bf16_f32 v24, v24, v25
    v_cvt_pk_bf16_f32 v25, v26, v27
    v_cvt_pk_bf16_f32 v26, v28, v29
    v_cvt_pk_bf16_f32 v27, v30, v31
    buffer_store_dwordx4 v[24:27], v2, s[8:11], s90 offen sc1
    s_add_u32 s90, s90, s100
    s_nop 1
    v_accvgpr_read_b32 v24, a120
    v_accvgpr_read_b32 v25, a121
    v_accvgpr_read_b32 v26, a122
    v_accvgpr_read_b32 v27, a123
    v_accvgpr_read_b32 v28, a124
    v_accvgpr_read_b32 v29, a125
    v_accvgpr_read_b32 v30, a126
    v_accvgpr_read_b32 v31, a127
    v_cvt_pk_bf16_f32 v24, v24, v25
    v_cvt_pk_bf16_f32 v25, v26, v27
    v_cvt_pk_bf16_f32 v26, v28, v29
    v_cvt_pk_bf16_f32 v27, v30, v31
    buffer_store_dwordx4 v[24:27], v2, s[8:11], s90 offen sc1
    s_add_u32 s90, s90, s100
    s_nop 1
    s_add_u32 s91, s91, s99
    s_setpc_b64 s[20:21]
m_epl62:
    s_mov_b32 s92, s97
    s_mov_b32 s93, s97
    s_cmp_eq_u32 s97, 0
    s_cbranch_scc1 m_ns263
    s_mov_b32 s90, s98
    v_pk_mul_f32 v[32:33], v[32:33], s[92:93]
    v_pk_mul_f32 v[34:35], v[34:35], s[92:93]
    v_pk_mul_f32 v[36:37], v[36:37], s[92:93]
    v_pk_mul_f32 v[38:39], v[38:39], s[92:93]
    v_cvt_pk_bf16_f32 v32, v32, v33
    v_cvt_pk_bf16_f32 v33, v34, v35
    v_cvt_pk_bf16_f32 v34, v36, v37
    v_cvt_pk_bf16_f32 v35, v38, v39
    buffer_store_dwordx4 v[32:35], v2, s[8:11], s90 offen sc1
    s_add_u32 s90, s90, s100
    v_pk_mul_f32 v[40:41], v[40:41], s[92:93]
    v_pk_mul_f32 v[42:43], v[42:43], s[92:93]
    v_pk_mul_f32 v[44:45], v[44:45], s[92:93]
    v_pk_mul_f32 v[46:47], v[46:47], s[92:93]
    v_cvt_pk_bf16_f32 v40, v40, v41
    v_cvt_pk_bf16_f32 v41, v42, v43
    v_cvt_pk_bf16_f32 v42, v44, v45
    v_cvt_pk_bf16_f32 v43, v46, v47
    buffer_store_dwordx4 v[40:43], v2, s[8:11], s90 offen sc1
    s_add_u32 s90, s90, s100
    v_pk_mul_f32 v[48:49], v[48:49], s[92:93]
    v_pk_mul_f32 v[50:51], v[50:51], s[92:93]
    v_pk_mul_f32 v[52:53], v[52:53], s[92:93]
    v_pk_mul_f32 v[54:55], v[54:55], s[92:93]
    v_cvt_pk_bf16_f32 v48, v48, v49
    v_cvt_pk_bf16_f32 v49, v50, v51
    v_cvt_pk_bf16_f32 v50, v52, v53
    v_cvt_pk_bf16_f32 v51, v54, v55
    buffer_store_dwordx4 v[48:51], v2, s[8:11], s90 offen sc1
    s_add_u32 s90, s90, s100
    v_pk_mul_f32 v[56:57], v[56:57], s[92:93]
    v_pk_mul_f32 v[58:59], v[58:59], s[92:93]
    v_pk_mul_f32 v[60:61], v[60:61], s[92:93]
    v_pk_mul_f32 v[62:63], v[62:63], s[92:93]
    v_cvt_pk_bf16_f32 v56, v56, v57
    v_cvt_pk_bf16_f32 v57, v58, v59
    v_cvt_pk_bf16_f32 v58, v60, v61
    v_cvt_pk_bf16_f32 v59, v62, v63
    buffer_store_dwordx4 v[56:59], v2, s[8:11], s90 offen sc1
    s_add_u32 s90, s90, s100
    v_pk_mul_f32 v[64:65], v[64:65], s[92:93]
    v_pk_mul_f32 v[66:67], v[66:67], s[92:93]
    v_pk_mul_f32 v[68:69], v[68:69], s[92:93]
    v_pk_mul_f32 v[70:71], v[70:71], s[92:93]
    v_cvt_pk_bf16_f32 v64, v64, v65
    v_cvt_pk_bf16_f32 v65, v66, v67
    v_cvt_pk_bf16_f32 v66, v68, v69
    v_cvt_pk_bf16_f32 v67, v70, v71
    buffer_store_dwordx4 v[64:67], v2, s[8:11], s90 offen sc1
    s_add_u32 s90, s90, s100
    v_pk_mul_f32 v[72:73], v[72:73], s[92:93]
    v_pk_mul_f32 v[74:75], v[74:75], s[92:93]
    v_pk_mul_f32 v[76:77], v[76:77], s[92:93]
    v_pk_mul_f32 v[78:79], v[78:79], s[92:93]
    v_cvt_pk_bf16_f32 v72, v72, v73
    v_cvt_pk_bf16_f32 v73, v74, v75
    v_cvt_pk_bf16_f32 v74, v76, v77
    v_cvt_pk_bf16_f32 v75, v78, v79
    buffer_store_dwordx4 v[72:75], v2, s[8:11], s90 offen sc1
    s_add_u32 s90, s90, s100
    v_pk_mul_f32 v[80:81], v[80:81], s[92:93]
    v_pk_mul_f32 v[82:83], v[82:83], s[92:93]
    v_pk_mul_f32 v[84:85], v[84:85], s[92:93]
    v_pk_mul_f32 v[86:87], v[86:87], s[92:93]
    v_cvt_pk_bf16_f32 v80, v80, v81
    v_cvt_pk_bf16_f32 v81, v82, v83
    v_cvt_pk_bf16_f32 v82, v84, v85
    v_cvt_pk_bf16_f32 v83, v86, v87
    buffer_store_dwordx4 v[80:83], v2, s[8:11], s90 offen sc1
    s_add_u32 s90, s90, s100
    v_pk_mul_f32 v[88:89], v[88:89], s[92:93]
    v_pk_mul_f32 v[90:91], v[90:91], s[92:93]
    v_pk_mul_f32 v[92:93], v[92:93], s[92:93]
    v_pk_mul_f32 v[94:95], v[94:95], s[92:93]
    v_cvt_pk_bf16_f32 v88, v88, v89
    v_cvt_pk_bf16_f32 v89, v90, v91
    v_cvt_pk_bf16_f32 v90, v92, v93
    v_cvt_pk_bf16_f32 v91, v94, v95
    buffer_store_dwordx4 v[88:91], v2, s[8:11], s90 offen sc1
    s_add_u32 s90, s98, s99
    v_pk_mul_f32 v[96:97], v[96:97], s[92:93]
    v_pk_mul_f32 v[98:99], v[98:99], s[92:93]
    v_pk_mul_f32 v[100:101], v[100:101], s[92:93]
    v_pk_mul_f32 v[102:103], v[102:103], s[92:93]
    v_cvt_pk_bf16_f32 v96, v96, v97
    v_cvt_pk_bf16_f32 v97, v98, v99
    v_cvt_pk_bf16_f32 v98, v100, v101
    v_cvt_pk_bf16_f32 v99, v102, v103
    buffer_store_dwordx4 v[96:99], v2, s[8:11], s90 offen sc1
    s_add_u32 s90, s90, s100
    v_pk_mul_f32 v[104:105], v[104:105], s[92:93]
    v_pk_mul_f32 v[106:107], v[106:107], s[92:93]
    v_pk_mul_f32 v[108:109], v[108:109], s[92:93]
    v_pk_mul_f32 v[110:111], v[110:111], s[92:93]
    v_cvt_pk_bf16_f32 v104, v104, v105
    v_cvt_pk_bf16_f32 v105, v106, v107
    v_cvt_pk_bf16_f32 v106, v108, v109
    v_cvt_pk_bf16_f32 v107, v110, v111
    buffer_store_dwordx4 v[104:107], v2, s[8:11], s90 offen sc1
    s_add_u32 s90, s90, s100
    v_pk_mul_f32 v[112:113], v[112:113], s[92:93]
    v_pk_mul_f32 v[114:115], v[114:115], s[92:93]
    v_pk_mul_f32 v[116:117], v[116:117], s[92:93]
    v_pk_mul_f32 v[118:119], v[118:119], s[92:93]
    v_cvt_pk_bf16_f32 v112, v112, v113
    v_cvt_pk_bf16_f32 v113, v114, v115
    v_cvt_pk_bf16_f32 v114, v116, v117
    v_cvt_pk_bf16_f32 v115, v118, v119
    buffer_store_dwordx4 v[112:115], v2, s[8:11], s90 offen sc1
    s_add_u32 s90, s90, s100
    v_pk_mul_f32 v[120:121], v[120:121], s[92:93]
    v_pk_mul_f32 v[122:123], v[122:123], s[92:93]
    v_pk_mul_f32 v[124:125], v[124:125], s[92:93]
    v_pk_mul_f32 v[126:127], v[126:127], s[92:93]
    v_cvt_pk_bf16_f32 v120, v120, v121
    v_cvt_pk_bf16_f32 v121, v122, v123
    v_cvt_pk_bf16_f32 v122, v124, v125
    v_cvt_pk_bf16_f32 v123, v126, v127
    buffer_store_dwordx4 v[120:123], v2, s[8:11], s90 offen sc1
    s_add_u32 s90, s90, s100
    v_pk_mul_f32 v[128:129], v[128:129], s[92:93]
    v_pk_mul_f32 v[130:131], v[130:131], s[92:93]
    v_pk_mul_f32 v[132:133], v[132:133], s[92:93]
    v_pk_mul_f32 v[134:135], v[134:135], s[92:93]
    v_cvt_pk_bf16_f32 v128, v128, v129
    v_cvt_pk_bf16_f32 v129, v130, v131
    v_cvt_pk_bf16_f32 v130, v132, v133
    v_cvt_pk_bf16_f32 v131, v134, v135
    buffer_store_dwordx4 v[128:131], v2, s[8:11], s90 offen sc1
    s_add_u32 s90, s90, s100
    v_pk_mul_f32 v[136:137], v[136:137], s[92:93]
    v_pk_mul_f32 v[138:139], v[138:139], s[92:93]
    v_pk_mul_f32 v[140:141], v[140:141], s[92:93]
    v_pk_mul_f32 v[142:143], v[142:143], s[92:93]
    v_cvt_pk_bf16_f32 v136, v136, v137
    v_cvt_pk_bf16_f32 v137, v138, v139
    v_cvt_pk_bf16_f32 v138, v140, v141
    v_cvt_pk_bf16_f32 v139, v142, v143
    buffer_store_dwordx4 v[136:139], v2, s[8:11], s90 offen sc1
    s_add_u32 s90, s90, s100
    v_pk_mul_f32 v[144:145], v[144:145], s[92:93]
    v_pk_mul_f32 v[146:147], v[146:147], s[92:93]
    v_pk_mul_f32 v[148:149], v[148:149], s[92:93]
    v_pk_mul_f32 v[150:151], v[150:151], s[92:93]
    v_cvt_pk_bf16_f32 v144, v144, v145
    v_cvt_pk_bf16_f32 v145, v146, v147
    v_cvt_pk_bf16_f32 v146, v148, v149
    v_cvt_pk_bf16_f32 v147, v150, v151
    buffer_store_dwordx4 v[144:147], v2, s[8:11], s90 offen sc1
    s_add_u32 s90, s90, s100
    v_pk_mul_f32 v[152:153], v[152:153], s[92:93]
    v_pk_mul_f32 v[154:155], v[154:155], s[92:93]
    v_pk_mul_f32 v[156:157], v[156:157], s[92:93]
    v_pk_mul_f32 v[158:159], v[158:159], s[92:93]
    v_cvt_pk_bf16_f32 v152, v152, v153
    v_cvt_pk_bf16_f32 v153, v154, v155
    v_cvt_pk_bf16_f32 v154, v156, v157
    v_cvt_pk_bf16_f32 v155, v158, v159
    buffer_store_dwordx4 v[152:155], v2, s[8:11], s90 offen sc1
    s_add_u32 s90, s90, s100
    v_pk_mul_f32 v[192:193], v[192:193], s[92:93]
    v_pk_mul_f32 v[194:195], v[194:195], s[92:93]
    v_pk_mul_f32 v[196:197], v[196:197], s[92:93]
    v_pk_mul_f32 v[198:199], v[198:199], s[92:93]
    v_cvt_pk_bf16_f32 v192, v192, v193
    v_cvt_pk_bf16_f32 v193, v194, v195
    v_cvt_pk_bf16_f32 v194, v196, v197
    v_cvt_pk_bf16_f32 v195, v198, v199
    v_pk_mul_f32 v[200:201], v[200:201], s[92:93]
    v_pk_mul_f32 v[202:203], v[202:203], s[92:93]
    v_pk_mul_f32 v[204:205], v[204:205], s[92:93]
    v_pk_mul_f32 v[206:207], v[206:207], s[92:93]
    v_cvt_pk_bf16_f32 v196, v200, v201
    v_cvt_pk_bf16_f32 v197, v202, v203
    v_cvt_pk_bf16_f32 v198, v204, v205
    v_cvt_pk_bf16_f32 v199, v206, v207
    v_pk_mul_f32 v[208:209], v[208:209], s[92:93]
    v_pk_mul_f32 v[210:211], v[210:211], s[92:93]
    v_pk_mul_f32 v[212:213], v[212:213], s[92:93]
    v_pk_mul_f32 v[214:215], v[214:215], s[92:93]
    v_cvt_pk_bf16_f32 v200, v208, v209
    v_cvt_pk_bf16_f32 v201, v210, v211
    v_cvt_pk_bf16_f32 v202, v212, v213
    v_cvt_pk_bf16_f32 v203, v214, v215
    v_pk_mul_f32 v[216:217], v[216:217], s[92:93]
    v_pk_mul_f32 v[218:219], v[218:219], s[92:93]
    v_pk_mul_f32 v[220:221], v[220:221], s[92:93]
    v_pk_mul_f32 v[222:223], v[222:223], s[92:93]
    v_cvt_pk_bf16_f32 v204, v216, v217
    v_cvt_pk_bf16_f32 v205, v218, v219
    v_cvt_pk_bf16_f32 v206, v220, v221
    v_cvt_pk_bf16_f32 v207, v222, v223
    v_pk_mul_f32 v[224:225], v[224:225], s[92:93]
    v_pk_mul_f32 v[226:227], v[226:227], s[92:93]
    v_pk_mul_f32 v[228:229], v[228:229], s[92:93]
    v_pk_mul_f32 v[230:231], v[230:231], s[92:93]
    v_cvt_pk_bf16_f32 v208, v224, v225
    v_cvt_pk_bf16_f32 v209, v226, v227
    v_cvt_pk_bf16_f32 v210, v228, v229
    v_cvt_pk_bf16_f32 v211, v230, v231
    v_pk_mul_f32 v[232:233], v[232:233], s[92:93]
    v_pk_mul_f32 v[234:235], v[234:235], s[92:93]
    v_pk_mul_f32 v[236:237], v[236:237], s[92:93]
    v_pk_mul_f32 v[238:239], v[238:239], s[92:93]
    v_cvt_pk_bf16_f32 v212, v232, v233
    v_cvt_pk_bf16_f32 v213, v234, v235
    v_cvt_pk_bf16_f32 v214, v236, v237
    v_cvt_pk_bf16_f32 v215, v238, v239
    v_pk_mul_f32 v[240:241], v[240:241], s[92:93]
    v_pk_mul_f32 v[242:243], v[242:243], s[92:93]
    v_pk_mul_f32 v[244:245], v[244:245], s[92:93]
    v_pk_mul_f32 v[246:247], v[246:247], s[92:93]
    v_cvt_pk_bf16_f32 v216, v240, v241
    v_cvt_pk_bf16_f32 v217, v242, v243
    v_cvt_pk_bf16_f32 v218, v244, v245
    v_cvt_pk_bf16_f32 v219, v246, v247
    v_pk_mul_f32 v[248:249], v[248:249], s[92:93]
    v_pk_mul_f32 v[250:251], v[250:251], s[92:93]
    v_pk_mul_f32 v[252:253], v[252:253], s[92:93]
    v_pk_mul_f32 v[254:255], v[254:255], s[92:93]
    v_cvt_pk_bf16_f32 v220, v248, v249
    v_cvt_pk_bf16_f32 v221, v250, v251
    v_cvt_pk_bf16_f32 v222, v252, v253
    v_cvt_pk_bf16_f32 v223, v254, v255
    v_accvgpr_read_b32 v24, a96
    v_accvgpr_read_b32 v25, a97
    v_accvgpr_read_b32 v26, a98
    v_accvgpr_read_b32 v27, a99
    v_accvgpr_read_b32 v28, a100
    v_accvgpr_read_b32 v29, a101
    v_accvgpr_read_b32 v30, a102
    v_accvgpr_read_b32 v31, a103
    v_pk_mul_f32 v[24:25], v[24:25], s[92:93]
    v_pk_mul_f32 v[26:27], v[26:27], s[92:93]
    v_pk_mul_f32 v[28:29], v[28:29], s[92:93]
    v_pk_mul_f32 v[30:31], v[30:31], s[92:93]
    v_cvt_pk_bf16_f32 v224, v24, v25
    v_cvt_pk_bf16_f32 v225, v26, v27
    v_cvt_pk_bf16_f32 v226, v28, v29
    v_cvt_pk_bf16_f32 v227, v30, v31
    v_accvgpr_read_b32 v24, a104
    v_accvgpr_read_b32 v25, a105
    v_accvgpr_read_b32 v26, a106
    v_accvgpr_read_b32 v27, a107
    v_accvgpr_read_b32 v28, a108
    v_accvgpr_read_b32 v29, a109
    v_accvgpr_read_b32 v30, a110
    v_accvgpr_read_b32 v31, a111
    v_pk_mul_f32 v[24:25], v[24:25], s[92:93]
    v_pk_mul_f32 v[26:27], v[26:27], s[92:93]
    v_pk_mul_f32 v[28:29], v[28:29], s[92:93]
    v_pk_mul_f32 v[30:31], v[30:31], s[92:93]
    v_cvt_pk_bf16_f32 v228, v24, v25
    v_cvt_pk_bf16_f32 v229, v26, v27
    v_cvt_pk_bf16_f32 v230, v28, v29
    v_cvt_pk_bf16_f32 v231, v30, v31
    v_accvgpr_read_b32 v24, a112
    v_accvgpr_read_b32 v25, a113
    v_accvgpr_read_b32 v26, a114
    v_accvgpr_read_b32 v27, a115
    v_accvgpr_read_b32 v28, a116
    v_accvgpr_read_b32 v29, a117
    v_accvgpr_read_b32 v30, a118
    v_accvgpr_read_b32 v31, a119
    v_pk_mul_f32 v[24:25], v[24:25], s[92:93]
    v_pk_mul_f32 v[26:27], v[26:27], s[92:93]
    v_pk_mul_f32 v[28:29], v[28:29], s[92:93]
    v_pk_mul_f32 v[30:31], v[30:31], s[92:93]
    v_cvt_pk_bf16_f32 v232, v24, v25
    v_cvt_pk_bf16_f32 v233, v26, v27
    v_cvt_pk_bf16_f32 v234, v28, v29
    v_cvt_pk_bf16_f32 v235, v30, v31
    v_accvgpr_read_b32 v24, a120
    v_accvgpr_read_b32 v25, a121
    v_accvgpr_read_b32 v26, a122
    v_accvgpr_read_b32 v27, a123
    v_accvgpr_read_b32 v28, a124
    v_accvgpr_read_b32 v29, a125
    v_accvgpr_read_b32 v30, a126
    v_accvgpr_read_b32 v31, a127
    v_pk_mul_f32 v[24:25], v[24:25], s[92:93]
    v_pk_mul_f32 v[26:27], v[26:27], s[92:93]
    v_pk_mul_f32 v[28:29], v[28:29], s[92:93]
    v_pk_mul_f32 v[30:31], v[30:31], s[92:93]
    v_cvt_pk_bf16_f32 v236, v24, v25
    v_cvt_pk_bf16_f32 v237, v26, v27
    v_cvt_pk_bf16_f32 v238, v28, v29
    v_cvt_pk_bf16_f32 v239, v30, v31
    v_pk_mul_f32 v[160:161], v[160:161], s[92:93]
    v_pk_mul_f32 v[162:163], v[162:163], s[92:93]
    v_pk_mul_f32 v[164:165], v[164:165], s[92:93]
    v_pk_mul_f32 v[166:167], v[166:167], s[92:93]
    v_cvt_pk_bf16_f32 v240, v160, v161
    v_cvt_pk_bf16_f32 v241, v162, v163
    v_cvt_pk_bf16_f32 v242, v164, v165
    v_cvt_pk_bf16_f32 v243, v166, v167
    v_pk_mul_f32 v[168:169], v[168:169], s[92:93]
    v_pk_mul_f32 v[170:171], v[170:171], s[92:93]
    v_pk_mul_f32 v[172:173], v[172:173], s[92:93]
    v_pk_mul_f32 v[174:175], v[174:175], s[92:93]
    v_cvt_pk_bf16_f32 v244, v168, v169
    v_cvt_pk_bf16_f32 v245, v170, v171
    v_cvt_pk_bf16_f32 v246, v172, v173
    v_cvt_pk_bf16_f32 v247, v174, v175
    v_pk_mul_f32 v[176:177], v[176:177], s[92:93]
    v_pk_mul_f32 v[178:179], v[178:179], s[92:93]
    v_pk_mul_f32 v[180:181], v[180:181], s[92:93]
    v_pk_mul_f32 v[182:183], v[182:183], s[92:93]
    v_cvt_pk_bf16_f32 v248, v176, v177
    v_cvt_pk_bf16_f32 v249, v178, v179
    v_cvt_pk_bf16_f32 v250, v180, v181
    v_cvt_pk_bf16_f32 v251, v182, v183
    v_pk_mul_f32 v[184:185], v[184:185], s[92:93]
    v_pk_mul_f32 v[186:187], v[186:187], s[92:93]
    v_pk_mul_f32 v[188:189], v[188:189], s[92:93]
    v_pk_mul_f32 v[190:191], v[190:191], s[92:93]
    v_cvt_pk_bf16_f32 v252, v184, v185
    v_cvt_pk_bf16_f32 v253, v186, v187
    v_cvt_pk_bf16_f32 v254, v188, v189
    v_cvt_pk_bf16_f32 v255, v190, v191
    s_setpc_b64 s[20:21]
m_ns263:
    s_mov_b32 s90, s98
    v_cvt_pk_bf16_f32 v32, v32, v33
    v_cvt_pk_bf16_f32 v33, v34, v35
    v_cvt_pk_bf16_f32 v34, v36, v37
    v_cvt_pk_bf16_f32 v35, v38, v39
    buffer_store_dwordx4 v[32:35], v2, s[8:11], s90 offen sc1
    s_add_u32 s90, s90, s100
    v_cvt_pk_bf16_f32 v40, v40, v41
    v_cvt_pk_bf16_f32 v41, v42, v43
    v_cvt_pk_bf16_f32 v42, v44, v45
    v_cvt_pk_bf16_f32 v43, v46, v47
    buffer_store_dwordx4 v[40:43], v2, s[8:11], s90 offen sc1
    s_add_u32 s90, s90, s100
    v_cvt_pk_bf16_f32 v48, v48, v49
    v_cvt_pk_bf16_f32 v49, v50, v51
    v_cvt_pk_bf16_f32 v50, v52, v53
    v_cvt_pk_bf16_f32 v51, v54, v55
    buffer_store_dwordx4 v[48:51], v2, s[8:11], s90 offen sc1
    s_add_u32 s90, s90, s100
    v_cvt_pk_bf16_f32 v56, v56, v57
    v_cvt_pk_bf16_f32 v57, v58, v59
    v_cvt_pk_bf16_f32 v58, v60, v61
    v_cvt_pk_bf16_f32 v59, v62, v63
    buffer_store_dwordx4 v[56:59], v2, s[8:11], s90 offen sc1
    s_add_u32 s90, s90, s100
    v_cvt_pk_bf16_f32 v64, v64, v65
    v_cvt_pk_bf16_f32 v65, v66, v67
    v_cvt_pk_bf16_f32 v66, v68, v69
    v_cvt_pk_bf16_f32 v67, v70, v71
    buffer_store_dwordx4 v[64:67], v2, s[8:11], s90 offen sc1
    s_add_u32 s90, s90, s100
    v_cvt_pk_bf16_f32 v72, v72, v73
    v_cvt_pk_bf16_f32 v73, v74, v75
    v_cvt_pk_bf16_f32 v74, v76, v77
    v_cvt_pk_bf16_f32 v75, v78, v79
    buffer_store_dwordx4 v[72:75], v2, s[8:11], s90 offen sc1
    s_add_u32 s90, s90, s100
    v_cvt_pk_bf16_f32 v80, v80, v81
    v_cvt_pk_bf16_f32 v81, v82, v83
    v_cvt_pk_bf16_f32 v82, v84, v85
    v_cvt_pk_bf16_f32 v83, v86, v87
    buffer_store_dwordx4 v[80:83], v2, s[8:11], s90 offen sc1
    s_add_u32 s90, s90, s100
    v_cvt_pk_bf16_f32 v88, v88, v89
    v_cvt_pk_bf16_f32 v89, v90, v91
    v_cvt_pk_bf16_f32 v90, v92, v93
    v_cvt_pk_bf16_f32 v91, v94, v95
    buffer_store_dwordx4 v[88:91], v2, s[8:11], s90 offen sc1
    s_add_u32 s90, s98, s99
    v_cvt_pk_bf16_f32 v96, v96, v97
    v_cvt_pk_bf16_f32 v97, v98, v99
    v_cvt_pk_bf16_f32 v98, v100, v101
    v_cvt_pk_bf16_f32 v99, v102, v103
    buffer_store_dwordx4 v[96:99], v2, s[8:11], s90 offen sc1
    s_add_u32 s90, s90, s100
    v_cvt_pk_bf16_f32 v104, v104, v105
    v_cvt_pk_bf16_f32 v105, v106, v107
    v_cvt_pk_bf16_f32 v106, v108, v109
    v_cvt_pk_bf16_f32 v107, v110, v111
    buffer_store_dwordx4 v[104:107], v2, s[8:11], s90 offen sc1
    s_add_u32 s90, s90, s100
    v_cvt_pk_bf16_f32 v112, v112, v113
    v_cvt_pk_bf16_f32 v113, v114, v115
    v_cvt_pk_bf16_f32 v114, v116, v117
    v_cvt_pk_bf16_f32 v115, v118, v119
    buffer_store_dwordx4 v[112:115], v2, s[8:11], s90 offen sc1
    s_add_u32 s90, s90, s100
    v_cvt_pk_bf16_f32 v120, v120, v121
    v_cvt_pk_bf16_f32 v121, v122, v123
    v_cvt_pk_bf16_f32 v122, v124, v125
    v_cvt_pk_bf16_f32 v123, v126, v127
    buffer_store_dwordx4 v[120:123], v2, s[8:11], s90 offen sc1
    s_add_u32 s90, s90, s100
    v_cvt_pk_bf16_f32 v128, v128, v129
    v_cvt_pk_bf16_f32 v129, v130, v131
    v_cvt_pk_bf16_f32 v130, v132, v133
    v_cvt_pk_bf16_f32 v131, v134, v135
    buffer_store_dwordx4 v[128:131], v2, s[8:11], s90 offen sc1
    s_add_u32 s90, s90, s100
    v_cvt_pk_bf16_f32 v136, v136, v137
    v_cvt_pk_bf16_f32 v137, v138, v139
    v_cvt_pk_bf16_f32 v138, v140, v141
    v_cvt_pk_bf16_f32 v139, v142, v143
    buffer_store_dwordx4 v[136:139], v2, s[8:11], s90 offen sc1
    s_add_u32 s90, s90, s100
    v_cvt_pk_bf16_f32 v144, v144, v145
    v_cvt_pk_bf16_f32 v145, v146, v147
    v_cvt_pk_bf16_f32 v146, v148, v149
    v_cvt_pk_bf16_f32 v147, v150, v151
    buffer_store_dwordx4 v[144:147], v2, s[8:11], s90 offen sc1
    s_add_u32 s90, s90, s100
    v_cvt_pk_bf16_f32 v152, v152, v153
    v_cvt_pk_bf16_f32 v153, v154, v155
    v_cvt_pk_bf16_f32 v154, v156, v157
    v_cvt_pk_bf16_f32 v155, v158, v159
    buffer_store_dwordx4 v[152:155], v2, s[8:11], s90 offen sc1
    s_add_u32 s90, s90, s100
    v_cvt_pk_bf16_f32 v192, v192, v193
    v_cvt_pk_bf16_f32 v193, v194, v195
    v_cvt_pk_bf16_f32 v194, v196, v197
    v_cvt_pk_bf16_f32 v195, v198, v199
    v_cvt_pk_bf16_f32 v196, v200, v201
    v_cvt_pk_bf16_f32 v197, v202, v203
    v_cvt_pk_bf16_f32 v198, v204, v205
    v_cvt_pk_bf16_f32 v199, v206, v207
    v_cvt_pk_bf16_f32 v200, v208, v209
    v_cvt_pk_bf16_f32 v201, v210, v211
    v_cvt_pk_bf16_f32 v202, v212, v213
    v_cvt_pk_bf16_f32 v203, v214, v215
    v_cvt_pk_bf16_f32 v204, v216, v217
    v_cvt_pk_bf16_f32 v205, v218, v219
    v_cvt_pk_bf16_f32 v206, v220, v221
    v_cvt_pk_bf16_f32 v207, v222, v223
    v_cvt_pk_bf16_f32 v208, v224, v225
    v_cvt_pk_bf16_f32 v209, v226, v227
    v_cvt_pk_bf16_f32 v210, v228, v229
    v_cvt_pk_bf16_f32 v211, v230, v231
    v_cvt_pk_bf16_f32 v212, v232, v233
    v_cvt_pk_bf16_f32 v213, v234, v235
    v_cvt_pk_bf16_f32 v214, v236, v237
    v_cvt_pk_bf16_f32 v215, v238, v239
    v_cvt_pk_bf16_f32 v216, v240, v241
    v_cvt_pk_bf16_f32 v217, v242, v243
    v_cvt_pk_bf16_f32 v218, v244, v245
    v_cvt_pk_bf16_f32 v219, v246, v247
    v_cvt_pk_bf16_f32 v220, v248, v249
    v_cvt_pk_bf16_f32 v221, v250, v251
    v_cvt_pk_bf16_f32 v222, v252, v253
    v_cvt_pk_bf16_f32 v223, v254, v255
    v_accvgpr_read_b32 v24, a96
    v_accvgpr_read_b32 v25, a97
    v_accvgpr_read_b32 v26, a98
    v_accvgpr_read_b32 v27, a99
    v_accvgpr_read_b32 v28, a100
    v_accvgpr_read_b32 v29, a101
    v_accvgpr_read_b32 v30, a102
    v_accvgpr_read_b32 v31, a103
    v_cvt_pk_bf16_f32 v224, v24, v25
    v_cvt_pk_bf16_f32 v225, v26, v27
    v_cvt_pk_bf16_f32 v226, v28, v29
    v_cvt_pk_bf16_f32 v227, v30, v31
    v_accvgpr_read_b32 v24, a104
    v_accvgpr_read_b32 v25, a105
    v_accvgpr_read_b32 v26, a106
    v_accvgpr_read_b32 v27, a107
    v_accvgpr_read_b32 v28, a108
    v_accvgpr_read_b32 v29, a109
    v_accvgpr_read_b32 v30, a110
    v_accvgpr_read_b32 v31, a111
    v_cvt_pk_bf16_f32 v228, v24, v25
    v_cvt_pk_bf16_f32 v229, v26, v27
    v_cvt_pk_bf16_f32 v230, v28, v29
    v_cvt_pk_bf16_f32 v231, v30, v31
    v_accvgpr_read_b32 v24, a112
    v_accvgpr_read_b32 v25, a113
    v_accvgpr_read_b32 v26, a114
    v_accvgpr_read_b32 v27, a115
    v_accvgpr_read_b32 v28, a116
    v_accvgpr_read_b32 v29, a117
    v_accvgpr_read_b32 v30, a118
    v_accvgpr_read_b32 v31, a119
    v_cvt_pk_bf16_f32 v232, v24, v25
    v_cvt_pk_bf16_f32 v233, v26, v27
    v_cvt_pk_bf16_f32 v234, v28, v29
    v_cvt_pk_bf16_f32 v235, v30, v31
    v_accvgpr_read_b32 v24, a120
    v_accvgpr_read_b32 v25, a121
    v_accvgpr_read_b32 v26, a122
    v_accvgpr_read_b32 v27, a123
    v_accvgpr_read_b32 v28, a124
    v_accvgpr_read_b32 v29, a125
    v_accvgpr_read_b32 v30, a126
    v_accvgpr_read_b32 v31, a127
    v_cvt_pk_bf16_f32 v236, v24, v25
    v_cvt_pk_bf16_f32 v237, v26, v27
    v_cvt_pk_bf16_f32 v238, v28, v29
    v_cvt_pk_bf16_f32 v239, v30, v31
    v_cvt_pk_bf16_f32 v240, v160, v161
    v_cvt_pk_bf16_f32 v241, v162, v163
    v_cvt_pk_bf16_f32 v242, v164, v165
    v_cvt_pk_bf16_f32 v243, v166, v167
    v_cvt_pk_bf16_f32 v244, v168, v169
    v_cvt_pk_bf16_f32 v245, v170, v171
    v_cvt_pk_bf16_f32 v246, v172, v173
    v_cvt_pk_bf16_f32 v247, v174, v175
    v_cvt_pk_bf16_f32 v248, v176, v177
    v_cvt_pk_bf16_f32 v249, v178, v179
    v_cvt_pk_bf16_f32 v250, v180, v181
    v_cvt_pk_bf16_f32 v251, v182, v183
    v_cvt_pk_bf16_f32 v252, v184, v185
    v_cvt_pk_bf16_f32 v253, v186, v187
    v_cvt_pk_bf16_f32 v254, v188, v189
    v_cvt_pk_bf16_f32 v255, v190, v191
    s_setpc_b64 s[20:21]
m_pf7:
    s_mov_b32 s15, 0x20000
    s_sub_u32 s93, s2, 224
    s_lshl_b32 s93, s93, 2
    s_add_u32 s93, s93, s16
    v_lshlrev_b32 v24, 7, v1
    v_lshrrev_b32 v25, 3, v1
    v_lshlrev_b32 v25, 11, v25
    v_and_b32 v26, 7, v1
    v_lshl_add_u32 v25, v26, 7, v25
    s_lshl_b32 s92, s93, 13
    s_lshl_b32 s93, s93, 14
    s_add_u32 s93, s93, 1024
    v_lshrrev_b32 v25, 2, v1
    v_lshlrev_b32 v25, 11, v25
    v_and_b32 v26, 3, v1
    v_lshl_add_u32 v25, v26, 7, v25
    s_lshl_b32 s93, s92, 2
    s_mov_b32 s12, s34
    s_mov_b32 s13, s35
    s_mov_b32 s14, 8388608
    s_add_u32 s90, s92, 1048576
    buffer_load_dword v22, v24, s[12:15], s90 offen
    s_add_u32 s90, s92, 2097152
    buffer_load_dword v22, v24, s[12:15], s90 offen
    s_mov_b32 s12, s30
    s_mov_b32 s13, s31
    s_mov_b32 s14, 4194304
    s_add_u32 s90, s93, 512
    buffer_load_dword v22, v25, s[12:15], s90 offen
    s_mov_b32 s12, s34
    s_mov_b32 s13, s35
    s_mov_b32 s14, 8388608
    s_add_u32 s90, s92, 3145728
    buffer_load_dword v22, v24, s[12:15], s90 offen
    s_add_u32 s90, s92, 4194304
    buffer_load_dword v22, v24, s[12:15], s90 offen
    s_mov_b32 s12, s30
    s_mov_b32 s13, s31
    s_mov_b32 s14, 4194304
    s_add_u32 s90, s93, 1024
    buffer_load_dword v22, v25, s[12:15], s90 offen
    s_mov_b32 s12, s34
    s_mov_b32 s13, s35
    s_mov_b32 s14, 8388608
    s_add_u32 s90, s92, 5242880
    buffer_load_dword v22, v24, s[12:15], s90 offen
    s_mov_b32 s12, s26
    s_mov_b32 s13, s27
    s_mov_b32 s14, 6291456
    s_add_u32 s90, s92, 0
    buffer_load_dword v22, v24, s[12:15], s90 offen
    s_mov_b32 s12, s24
    s_mov_b32 s13, s25
    s_mov_b32 s14, 4194304
    s_add_u32 s90, s93, 0
    buffer_load_dword v22, v25, s[12:15], s90 offen
    s_mov_b32 s12, s34
    s_mov_b32 s13, s35
    s_mov_b32 s14, 8388608
    s_add_u32 s90, s92, 6291456
    buffer_load_dword v22, v24, s[12:15], s90 offen
    s_mov_b32 s12, s30
    s_mov_b32 s13, s31
    s_mov_b32 s14, 4194304
    s_add_u32 s90, s93, 1536
    buffer_load_dword v22, v25, s[12:15], s90 offen
    s_mov_b32 s12, s26
    s_mov_b32 s13, s27
    s_mov_b32 s14, 6291456
    s_add_u32 s90, s92, 1048576
    buffer_load_dword v22, v24, s[12:15], s90 offen
    s_mov_b32 s12, s24
    s_mov_b32 s13, s25
    s_mov_b32 s14, 4194304
    s_add_u32 s90, s93, 512
    buffer_load_dword v22, v25, s[12:15], s90 offen
    s_mov_b32 s12, s34
    s_mov_b32 s13, s35
    s_mov_b32 s14, 8388608
    s_add_u32 s90, s92, 7340032
    buffer_load_dword v22, v24, s[12:15], s90 offen
    s_mov_b32 s12, s26
    s_mov_b32 s13, s27
    s_mov_b32 s14, 6291456
    s_add_u32 s90, s92, 2097152
    buffer_load_dword v22, v24, s[12:15], s90 offen
    s_add_u32 s90, s92, 3145728
    buffer_load_dword v22, v24, s[12:15], s90 offen
    s_mov_b32 s12, s24
    s_mov_b32 s13, s25
    s_mov_b32 s14, 4194304
    s_add_u32 s90, s93, 1024
    buffer_load_dword v22, v25, s[12:15], s90 offen
    s_mov_b32 s12, s26
    s_mov_b32 s13, s27
    s_mov_b32 s14, 6291456
    s_add_u32 s90, s92, 4194304
    buffer_load_dword v22, v24, s[12:15], s90 offen
    s_mov_b32 s12, s24
    s_mov_b32 s13, s25
    s_mov_b32 s14, 4194304
    s_add_u32 s90, s93, 1536
    buffer_load_dword v22, v25, s[12:15], s90 offen
    s_mov_b32 s12, s26
    s_mov_b32 s13, s27
    s_mov_b32 s14, 6291456
    s_add_u32 s90, s92, 5242880
    buffer_load_dword v22, v24, s[12:15], s90 offen
    s_mov_b32 s12, s32
    s_mov_b32 s13, s33
    s_mov_b32 s14, 2097152
    s_add_u32 s90, s92, 1048576
    buffer_load_dword v22, v24, s[12:15], s90 offen
    s_branch m_nopf6
concat_heads__sliding_local_dilated__compressed_kv_cla__prompt_kernel_end:
.section .rodata,"a"
.p2align 6
.amdhsa_kernel concat_heads__sliding_local_dilated__compressed_kv_cla__prompt_kernel
  .amdhsa_next_free_vgpr 512
  .amdhsa_next_free_sgpr 102
  .amdhsa_accum_offset 256
  .amdhsa_group_segment_fixed_size 0
  .amdhsa_kernarg_size 96
  .amdhsa_user_sgpr_count 2
  .amdhsa_user_sgpr_kernarg_segment_ptr 1
  .amdhsa_system_sgpr_workgroup_id_x 1
.end_amdhsa_kernel
```

```asm
; @launch grid=(256,1,1) block=(256,1,1) lds=163840
.amdgcn_target "amdgcn-amd-amdhsa--gfx950"
.text
.globl concat_heads__sliding_local_dilated__compressed_kv_cla__prompt_kernel
.p2align 8
.type concat_heads__sliding_local_dilated__compressed_kv_cla__prompt_kernel,@function
concat_heads__sliding_local_dilated__compressed_kv_cla__prompt_kernel:
    s_cmp_ge_u32 s2, 256
    s_cbranch_scc1 m_end1
    s_load_dwordx16 s[24:39], s[0:1], 0
    s_load_dwordx4 s[4:7], s[0:1], 80
    v_and_b32 v1, 63, v0
    v_lshrrev_b32 v24, 6, v0
    s_nop 0
    v_readfirstlane_b32 s16, v24
    s_lshr_b32 s68, s2, 3
    s_lshr_b32 s57, s16, 1
    s_and_b32 s58, s16, 1
    s_mov_b32 s43, 0x20000
    s_mov_b32 s47, 0x20000
    s_cmp_lt_u32 s68, 28
    s_cbranch_scc1 m_ncp2
    s_sub_u32 s91, s68, 28
    s_lshl_b32 s91, s91, 2
    s_add_u32 s91, s91, s16
    s_getpc_b64 s[8:9]
m_pc3:
    s_sub_u32 s8, s8, m_pc3-concat_heads__sliding_local_dilated__compressed_kv_cla__prompt_kernel
    s_subb_u32 s9, s9, 0
    s_mov_b32 s10, concat_heads__sliding_local_dilated__compressed_kv_cla__prompt_kernel_end-concat_heads__sliding_local_dilated__compressed_kv_cla__prompt_kernel
    s_mov_b32 s11, 0x20000
    s_lshl_b32 s90, s91, 13
    v_lshlrev_b32 v24, 7, v1
    buffer_load_dword v22, v24, s[8:11], s90 offen
m_ncp2:
    s_lshl_b32 s61, s16, 13
    s_add_u32 s62, s61, 98304
    s_cmp_ge_u32 s68, 16
    s_cbranch_scc1 m_typea4
    s_and_b32 s69, s68, 3
    s_and_b32 s90, s2, 1
    s_lshl_b32 s90, s90, 2
    s_add_u32 s69, s69, s90
    s_bfe_u32 s90, s2, 0x20001
    s_mul_i32 s90, s90, 4
    s_bfe_u32 s91, s68, 0x20002
    s_add_u32 s90, s90, s91
    s_mov_b32 s76, 8388608
    s_mov_b32 s78, 8192
    s_mov_b32 s81, 0
    s_mov_b32 s73, 4194304
    s_mov_b32 s77, 2048
    s_mov_b32 s82, 16
    s_lshl_b32 s80, s90, 9
    s_lshl_b32 s79, s69, 19
    s_lshl_b32 s88, s90, 4
    s_add_u32 s88, s88, s69
    s_lshl_b32 s88, s88, 3
    s_mov_b32 s83, 0
    s_mov_b32 s84, 1040356334
    s_lshl_b32 s91, s90, 1
    s_add_u32 s91, s91, s58
    s_lshl_b32 s91, s91, 19
    s_lshl_b32 s92, s69, 1
    s_add_u32 s92, s92, s57
    s_lshl_b32 s92, s92, 15
    s_add_u32 s85, s91, s92
    s_add_u32 s85, s85, 0
    s_mov_b32 s86, 1024
    s_mov_b32 s87, 4096
    s_branch m_go15
m_typea4:
    s_bfe_u32 s69, s68, 0x20002
    s_add_u32 s69, s69, 0
    s_and_b32 s90, s2, 7
    s_lshl_b32 s90, s90, 2
    s_and_b32 s91, s68, 3
    s_add_u32 s90, s90, s91
    s_cmp_lt_u32 s90, 16
    s_cselect_b32 s83, 0, 1
    s_mov_b32 s91, 33554432
    s_cselect_b32 s85, 16777216, s91
    s_mov_b32 s91, 8192
    s_cselect_b32 s86, 1024, s91
    s_mov_b32 s91, 1024
    s_cselect_b32 s87, 4096, s91
    s_mov_b32 s73, 2097152
    s_mov_b32 s77, 1024
    s_mov_b32 s82, 8
    s_mov_b32 s81, 0
    s_mov_b32 s76, 4194304
    s_mov_b32 s78, 8192
    s_mov_b32 s84, 0
    s_and_b32 s90, s90, 15
    s_lshl_b32 s80, s90, 9
    s_lshl_b32 s79, s69, 18
    s_lshl_b32 s91, s83, 2
    s_add_u32 s91, s91, s69
    s_cmp_ge_u32 s69, 4
    s_cselect_b32 s92, 508, 8
    s_add_u32 s91, s91, s92
    s_lshl_b32 s88, s90, 4
    s_add_u32 s88, s88, s91
    s_lshl_b32 s88, s88, 3
    s_lshl_b32 s91, s90, 1
    s_add_u32 s91, s91, s58
    s_lshl_b32 s91, s91, 19
    s_lshl_b32 s92, s69, 1
    s_add_u32 s92, s92, s57
    s_lshl_b32 s92, s92, 15
    s_add_u32 s85, s85, s91
    s_add_u32 s85, s85, s92
m_go15:
    s_mov_b32 s42, s73
    s_mov_b32 s46, s76
    s_lshl_b32 s90, s77, 4
    s_lshl_b32 s90, s90, s81
    s_mov_b32 s48, s79
    s_mul_i32 s91, s90, 1
    s_add_u32 s49, s91, s79
    s_sub_u32 s49, s49, 2048
    s_mul_i32 s91, s90, 2
    s_add_u32 s50, s91, s79
    s_mul_i32 s91, s90, 3
    s_add_u32 s51, s91, s79
    s_sub_u32 s51, s51, 2048
    s_mov_b32 s52, s80
    s_lshl_b32 s90, s78, 2
    s_mul_i32 s91, s90, 1
    s_add_u32 s53, s91, s80
    s_sub_u32 s53, s53, 2048
    s_mul_i32 s91, s90, 2
    s_add_u32 s54, s91, s80
    s_mul_i32 s91, s90, 3
    s_add_u32 s55, s91, s80
    s_sub_u32 s55, s55, 2048
    s_lshl_b32 s56, s78, 6
    s_lshl_b32 s90, s58, 7
    s_add_u32 s90, s90, s57
    s_lshl_b32 s91, s16, 6
    s_cmp_eq_u32 s81, 1
    s_cselect_b32 s90, s90, s91
    v_lshrrev_b32 v24, 3, v1
    v_lshlrev_b32 v24, s81, v24
    v_add_u32 v24, s90, v24
    v_mul_lo_u32 v24, v24, s77
    v_lshrrev_b32 v25, 4, v1
    v_and_b32 v26, 7, v1
    v_xor_b32 v25, v25, v26
    v_lshl_add_u32 v16, v25, 4, v24
    v_xor_b32 v25, 4, v25
    v_lshl_add_u32 v17, v25, 4, v24
    s_lshl_b32 s90, s77, 3
    s_lshl_b32 s90, s90, s81
    s_sub_u32 s90, s90, 1024
    v_add_u32 v17, s90, v17
    v_lshrrev_b32 v24, 5, v1
    s_lshl_b32 s90, s16, 4
    v_add_u32 v25, s90, v24
    v_mul_lo_u32 v25, v25, s78
    v_lshlrev_b32 v24, 1, v24
    v_and_b32 v26, 31, v1
    v_xor_b32 v24, v24, v26
    s_lshl_b32 s90, s78, 1
    s_sub_u32 s90, s90, 1024
    v_add_u32 v27, s90, v25
    v_xor_b32 v26, 0, v24
    v_lshl_add_u32 v18, v26, 4, v25
    v_xor_b32 v26, 4, v24
    v_lshl_add_u32 v19, v26, 4, v27
    v_xor_b32 v26, 8, v24
    v_lshl_add_u32 v20, v26, 4, v25
    v_xor_b32 v26, 12, v24
    v_lshl_add_u32 v21, v26, 4, v27
    s_cmp_eq_u32 s83, 0
    s_waitcnt lgkmcnt(0)
    s_cselect_b32 s44, s36, s38
    s_cselect_b32 s45, s37, s39
    s_cmp_lt_u32 s68, 16
    s_cselect_b32 s44, s34, s44
    s_cselect_b32 s45, s35, s45
    s_cselect_b32 s40, s30, s32
    s_cselect_b32 s41, s31, s33
    s_cmp_ge_u32 s68, 28
    s_cselect_b32 s70, 1, 0
    s_cbranch_scc1 m_pf7
m_nopf6:
    s_add_u32 m0, s61, 0
    s_nop 0
    buffer_load_dwordx4 v16, s[40:43], s48 offen offset:0 sc1 lds
    buffer_load_dwordx4 v17, s[40:43], s48 offen offset:1024 sc1 lds
    s_add_u32 s48, s48, 128
    buffer_load_dwordx4 v16, s[40:43], s49 offen offset:2048 sc1 lds
    buffer_load_dwordx4 v17, s[40:43], s49 offen offset:3072 sc1 lds
    s_add_u32 s49, s49, 128
    s_add_u32 m0, s61, 4096
    s_nop 0
    buffer_load_dwordx4 v16, s[40:43], s50 offen offset:0 sc1 lds
    buffer_load_dwordx4 v17, s[40:43], s50 offen offset:1024 sc1 lds
    s_add_u32 s50, s50, 128
    buffer_load_dwordx4 v16, s[40:43], s51 offen offset:2048 sc1 lds
    buffer_load_dwordx4 v17, s[40:43], s51 offen offset:3072 sc1 lds
    s_add_u32 s51, s51, 128
    s_add_u32 s61, s61, 32768
    s_cmp_ge_u32 s61, 98304
    s_cselect_b32 s90, 98304, 0
    s_sub_u32 s61, s61, s90
    s_add_u32 m0, s62, 0
    s_nop 0
    buffer_load_dwordx4 v18, s[44:47], s52 offen offset:0 sc1 lds
    buffer_load_dwordx4 v19, s[44:47], s52 offen offset:1024 sc1 lds
    s_add_u32 s52, s52, s56
    buffer_load_dwordx4 v18, s[44:47], s53 offen offset:2048 sc1 lds
    buffer_load_dwordx4 v19, s[44:47], s53 offen offset:3072 sc1 lds
    s_add_u32 s53, s53, s56
    s_add_u32 m0, s62, 4096
    s_nop 0
    buffer_load_dwordx4 v20, s[44:47], s54 offen offset:0 sc1 lds
    buffer_load_dwordx4 v21, s[44:47], s54 offen offset:1024 sc1 lds
    s_add_u32 s54, s54, s56
    buffer_load_dwordx4 v20, s[44:47], s55 offen offset:2048 sc1 lds
    buffer_load_dwordx4 v21, s[44:47], s55 offen offset:3072 sc1 lds
    s_add_u32 s55, s55, s56
    s_xor_b32 s62, s62, 229376
    s_mov_b32 s95, s82
    s_mov_b32 s96, s83
    s_mov_b32 s97, s84
    s_mov_b32 s98, s85
    s_mov_b32 s99, s86
    s_mov_b32 s100, s87
    s_mov_b32 s101, s88
    v_and_b32 v24, 15, v1
    v_lshrrev_b32 v25, 4, v1
    v_bfe_u32 v26, v1, 1, 3
    v_xor_b32 v26, v26, v25
    s_lshl_b32 s90, s57, 14
    v_lshlrev_b32 v27, 7, v24
    v_add_u32 v27, s90, v27
    v_xor_b32 v28, 0, v26
    v_lshl_add_u32 v6, v28, 4, v27
    v_xor_b32 v28, 4, v26
    v_lshl_add_u32 v7, v28, 4, v27
    v_bfe_u32 v26, v1, 2, 2
    v_lshl_add_u32 v27, v25, 3, v26
    v_lshlrev_b32 v27, 9, v27
    v_and_b32 v28, 3, v1
    v_lshlrev_b32 v28, 3, v28
    v_add_u32 v27, v27, v28
    s_lshl_b32 s90, s58, 8
    s_add_u32 s90, s90, 98304
    v_add_u32 v27, s90, v27
    v_bfe_u32 v26, v1, 2, 3
    v_xor_b32 v28, 0, v26
    v_lshl_add_u32 v8, v28, 5, v27
    v_xor_b32 v28, 1, v26
    v_lshl_add_u32 v9, v28, 5, v27
    v_xor_b32 v28, 2, v26
    v_lshl_add_u32 v10, v28, 5, v27
    v_xor_b32 v28, 3, v26
    v_lshl_add_u32 v11, v28, 5, v27
    v_xor_b32 v28, 4, v26
    v_lshl_add_u32 v12, v28, 5, v27
    v_xor_b32 v28, 5, v26
    v_lshl_add_u32 v13, v28, 5, v27
    v_xor_b32 v28, 6, v26
    v_lshl_add_u32 v14, v28, 5, v27
    v_xor_b32 v28, 7, v26
    v_lshl_add_u32 v15, v28, 5, v27
    v_lshlrev_b32 v2, 4, v1
    s_mov_b32 s64, 0
    s_mov_b32 s59, 32768
    s_mov_b32 s60, 229376
    s_mov_b32 s8, s6
    s_mov_b32 s9, s7
    s_mov_b32 s10, 268435456
    s_mov_b32 s11, 0x20000
    s_cmp_ge_u32 s68, 16
    s_cbranch_scc1 m_typea8
    s_bfe_u32 s69, s68, 0x20002
    s_add_u32 s69, s69, 4
    s_and_b32 s90, s2, 7
    s_lshl_b32 s90, s90, 2
    s_and_b32 s91, s68, 3
    s_add_u32 s90, s90, s91
    s_cmp_lt_u32 s90, 16
    s_cselect_b32 s83, 0, 1
    s_mov_b32 s91, 33554432
    s_cselect_b32 s85, 16777216, s91
    s_mov_b32 s91, 8192
    s_cselect_b32 s86, 1024, s91
    s_mov_b32 s91, 1024
    s_cselect_b32 s87, 4096, s91
    s_cselect_b32 s74, s36, s38
    s_cselect_b32 s75, s37, s39
    s_mov_b32 s71, s32
    s_mov_b32 s72, s33
    s_mov_b32 s73, 2097152
    s_mov_b32 s77, 1024
    s_mov_b32 s82, 8
    s_mov_b32 s81, 0
    s_mov_b32 s76, 4194304
    s_mov_b32 s78, 8192
    s_mov_b32 s84, 0
    s_and_b32 s90, s90, 15
    s_lshl_b32 s80, s90, 9
    s_lshl_b32 s79, s69, 18
    s_lshl_b32 s91, s83, 2
    s_add_u32 s91, s91, s69
    s_cmp_ge_u32 s69, 4
    s_cselect_b32 s92, 508, 8
    s_add_u32 s91, s91, s92
    s_lshl_b32 s88, s90, 4
    s_add_u32 s88, s88, s91
    s_lshl_b32 s88, s88, 3
    s_lshl_b32 s91, s90, 1
    s_add_u32 s91, s91, s58
    s_lshl_b32 s91, s91, 19
    s_lshl_b32 s92, s69, 1
    s_add_u32 s92, s92, s57
    s_lshl_b32 s92, s92, 15
    s_add_u32 s85, s85, s91
    s_add_u32 s85, s85, s92
    s_branch m_go29
m_typea8:
    s_and_b32 s69, s68, 3
    s_and_b32 s90, s2, 1
    s_lshl_b32 s90, s90, 2
    s_add_u32 s69, s69, s90
    s_bfe_u32 s90, s2, 0x20001
    s_mul_i32 s90, s90, 3
    s_bfe_u32 s91, s68, 0x20002
    s_add_u32 s90, s90, s91
    s_mov_b32 s76, 6291456
    s_mov_b32 s78, 6144
    s_mov_b32 s81, 1
    s_mov_b32 s73, 4194304
    s_mov_b32 s77, 2048
    s_mov_b32 s82, 16
    s_lshl_b32 s80, s90, 9
    s_lshl_b32 s79, s69, 19
    s_and_b32 s92, s90, 3
    s_lshr_b32 s91, s90, 2
    s_lshl_b32 s88, s92, 2
    s_add_u32 s88, s88, s91
    s_lshl_b32 s88, s88, 3
    s_add_u32 s88, s88, s69
    s_lshl_b32 s88, s88, 3
    s_add_u32 s88, s88, 6144
    s_cmp_eq_u32 s91, 0
    s_cselect_b32 s84, 1048744942, 0
    s_lshl_b32 s93, s91, 22
    s_add_u32 s85, s93, 50331648
    s_lshl_b32 s92, s92, 1
    s_add_u32 s92, s92, s58
    s_lshl_b32 s92, s92, 19
    s_add_u32 s85, s85, s92
    s_lshl_b32 s92, s57, 3
    s_add_u32 s92, s92, s69
    s_cmp_eq_u32 s91, 2
    s_cselect_b32 s83, 1, 0
    s_cselect_b32 s93, 12, 13
    s_mov_b32 s91, 131072
    s_cselect_b32 s86, 1024, s91
    s_mov_b32 s91, 1024
    s_cselect_b32 s87, 65536, s91
    s_lshl_b32 s92, s92, s93
    s_add_u32 s85, s85, s92
    s_mov_b32 s71, s24
    s_mov_b32 s72, s25
    s_mov_b32 s74, s26
    s_mov_b32 s75, s27
m_go29:
    s_xor_b32 s94, s70, 1
    s_mov_b32 s67, 2
    s_mov_b32 s17, -1
    s_mov_b32 s12, s4
    s_mov_b32 s13, s5
    s_mov_b32 s14, 256
    s_mov_b32 s15, 0x20000
    s_lshl_b32 s90, s2, 2
    s_add_u32 s90, s90, s16
    s_cmp_lg_u32 s90, 0
    s_cbranch_scc1 m_tok10
    s_memrealtime s[92:93]
    s_waitcnt lgkmcnt(0)
    s_or_b32 s92, s92, 1
    v_mov_b32 v4, s92
    v_mov_b32 v5, s93
    s_mov_b64 exec, 1
    buffer_store_dwordx2 v[4:5], off, s[12:15], 0 sc1
    s_mov_b64 exec, -1
m_tok10:
    s_add_u32 m0, s61, 0
    s_nop 0
    buffer_load_dwordx4 v16, s[40:43], s48 offen offset:0 sc1 lds
    buffer_load_dwordx4 v17, s[40:43], s48 offen offset:1024 sc1 lds
    s_add_u32 s48, s48, 128
    buffer_load_dwordx4 v16, s[40:43], s49 offen offset:2048 sc1 lds
    buffer_load_dwordx4 v17, s[40:43], s49 offen offset:3072 sc1 lds
    s_add_u32 s49, s49, 128
    s_add_u32 m0, s61, 4096
    s_nop 0
    buffer_load_dwordx4 v16, s[40:43], s50 offen offset:0 sc1 lds
    buffer_load_dwordx4 v17, s[40:43], s50 offen offset:1024 sc1 lds
    s_add_u32 s50, s50, 128
    buffer_load_dwordx4 v16, s[40:43], s51 offen offset:2048 sc1 lds
    buffer_load_dwordx4 v17, s[40:43], s51 offen offset:3072 sc1 lds
    s_add_u32 s51, s51, 128
    s_add_u32 s61, s61, 32768
    s_cmp_ge_u32 s61, 98304
    s_cselect_b32 s90, 98304, 0
    s_sub_u32 s61, s61, s90
    s_add_u32 m0, s62, 0
    s_nop 0
    buffer_load_dwordx4 v18, s[44:47], s52 offen offset:0 sc1 lds
    buffer_load_dwordx4 v19, s[44:47], s52 offen offset:1024 sc1 lds
    s_add_u32 s52, s52, s56
    buffer_load_dwordx4 v18, s[44:47], s53 offen offset:2048 sc1 lds
    buffer_load_dwordx4 v19, s[44:47], s53 offen offset:3072 sc1 lds
    s_add_u32 s53, s53, s56
    s_add_u32 m0, s62, 4096
    s_nop 0
    buffer_load_dwordx4 v20, s[44:47], s54 offen offset:0 sc1 lds
    buffer_load_dwordx4 v21, s[44:47], s54 offen offset:1024 sc1 lds
    s_add_u32 s54, s54, s56
    buffer_load_dwordx4 v20, s[44:47], s55 offen offset:2048 sc1 lds
    buffer_load_dwordx4 v21, s[44:47], s55 offen offset:3072 sc1 lds
    s_add_u32 s55, s55, s56
    s_xor_b32 s62, s62, 229376
    s_waitcnt vmcnt(16)
    s_barrier
    ds_read_b64_tr_b16 a[64:65], v8 offset:0
    ds_read_b64_tr_b16 a[66:67], v8 offset:2048
    ds_read_b128 a[0:3], v6 offset:0
    ds_read_b128 a[4:7], v6 offset:2048
    ds_read_b64_tr_b16 a[68:69], v9 offset:0
    ds_read_b64_tr_b16 a[70:71], v9 offset:2048
    ds_read_b128 a[8:11], v6 offset:4096
    ds_read_b128 a[12:15], v6 offset:6144
    ds_read_b64_tr_b16 a[72:73], v10 offset:0
    ds_read_b64_tr_b16 a[74:75], v10 offset:2048
    ds_read_b128 a[16:19], v6 offset:8192
    ds_read_b128 a[20:23], v6 offset:10240
    ds_read_b64_tr_b16 a[76:77], v11 offset:0
    ds_read_b64_tr_b16 a[78:79], v11 offset:2048
    ds_read_b128 a[24:27], v6 offset:12288
    ds_read_b128 a[28:31], v6 offset:14336
    ds_read_b64_tr_b16 a[80:81], v12 offset:0
    ds_read_b64_tr_b16 a[82:83], v12 offset:2048
    ds_read_b64_tr_b16 a[84:85], v13 offset:0
    ds_read_b64_tr_b16 a[86:87], v13 offset:2048
    ds_read_b64_tr_b16 a[88:89], v14 offset:0
    ds_read_b64_tr_b16 a[90:91], v14 offset:2048
    ds_read_b64_tr_b16 a[92:93], v15 offset:0
    ds_read_b64_tr_b16 a[94:95], v15 offset:2048
    s_mov_b32 s66, 1
    s_mov_b32 s24, s6
    s_mov_b32 s25, s7
    s_mov_b32 s26, 0
    s_mov_b32 s27, 0x20000
    s_mov_b32 s28, 0
    s_mov_b32 s29, 0
    s_mov_b32 s30, 0
    s_mov_b32 s31, 0
m_tile11:
    s_mov_b32 s65, s95
    s_cmp_eq_u32 s96, 1
    s_cbranch_scc1 m_swp13
    s_waitcnt lgkmcnt(15)
    v_mfma_f32_16x16x32_bf16 v[32:35], a[64:67], a[0:3], 0
    v_mfma_f32_16x16x32_bf16 v[40:43], a[64:67], a[4:7], 0
    v_mfma_f32_16x16x32_bf16 v[48:51], a[64:67], a[8:11], 0
    v_mfma_f32_16x16x32_bf16 v[56:59], a[64:67], a[12:15], 0
    s_add_u32 m0, s61, 0
    s_waitcnt lgkmcnt(13)
    v_mfma_f32_16x16x32_bf16 v[64:67], a[64:67], a[16:19], 0
    buffer_load_dwordx4 v16, s[40:43], s48 offen offset:0 sc1 lds
    s_waitcnt lgkmcnt(12)
    v_mfma_f32_16x16x32_bf16 v[72:75], a[64:67], a[20:23], 0
    s_waitcnt lgkmcnt(9)
    v_mfma_f32_16x16x32_bf16 v[80:83], a[64:67], a[24:27], 0
    s_waitcnt lgkmcnt(8)
    v_mfma_f32_16x16x32_bf16 v[88:91], a[64:67], a[28:31], 0
    ds_read_b64_tr_b16 a[64:65], v8 offset:16384
    v_mfma_f32_16x16x32_bf16 v[36:39], a[68:71], a[0:3], 0
    ds_read_b64_tr_b16 a[66:67], v8 offset:18432
    v_mfma_f32_16x16x32_bf16 v[44:47], a[68:71], a[4:7], 0
    v_mfma_f32_16x16x32_bf16 v[52:55], a[68:71], a[8:11], 0
    ds_read_b128 a[32:35], v7 offset:0
    v_mfma_f32_16x16x32_bf16 v[60:63], a[68:71], a[12:15], 0
    v_mfma_f32_16x16x32_bf16 v[68:71], a[68:71], a[16:19], 0
    buffer_load_dwordx4 v17, s[40:43], s48 offen offset:1024 sc1 lds
    v_mfma_f32_16x16x32_bf16 v[76:79], a[68:71], a[20:23], 0
    s_add_u32 s48, s48, 128
    v_mfma_f32_16x16x32_bf16 v[84:87], a[68:71], a[24:27], 0
    ds_read_b128 a[36:39], v7 offset:2048
    v_mfma_f32_16x16x32_bf16 v[92:95], a[68:71], a[28:31], 0
    ds_read_b64_tr_b16 a[68:69], v9 offset:16384
    v_mfma_f32_16x16x32_bf16 v[96:99], a[72:75], a[0:3], 0
    ds_read_b64_tr_b16 a[70:71], v9 offset:18432
    v_mfma_f32_16x16x32_bf16 v[104:107], a[72:75], a[4:7], 0
    v_mfma_f32_16x16x32_bf16 v[112:115], a[72:75], a[8:11], 0
    ds_read_b128 a[40:43], v7 offset:4096
    v_mfma_f32_16x16x32_bf16 v[120:123], a[72:75], a[12:15], 0
    v_mfma_f32_16x16x32_bf16 v[128:131], a[72:75], a[16:19], 0
    buffer_load_dwordx4 v16, s[40:43], s49 offen offset:2048 sc1 lds
    v_mfma_f32_16x16x32_bf16 v[136:139], a[72:75], a[20:23], 0
    v_mfma_f32_16x16x32_bf16 v[144:147], a[72:75], a[24:27], 0
    ds_read_b128 a[44:47], v7 offset:6144
    v_mfma_f32_16x16x32_bf16 v[152:155], a[72:75], a[28:31], 0
    ds_read_b64_tr_b16 a[72:73], v10 offset:16384
    v_mfma_f32_16x16x32_bf16 v[100:103], a[76:79], a[0:3], 0
    ds_read_b64_tr_b16 a[74:75], v10 offset:18432
    v_mfma_f32_16x16x32_bf16 v[108:111], a[76:79], a[4:7], 0
    v_mfma_f32_16x16x32_bf16 v[116:119], a[76:79], a[8:11], 0
    ds_read_b128 a[48:51], v7 offset:8192
    v_mfma_f32_16x16x32_bf16 v[124:127], a[76:79], a[12:15], 0
    v_mfma_f32_16x16x32_bf16 v[132:135], a[76:79], a[16:19], 0
    buffer_load_dwordx4 v17, s[40:43], s49 offen offset:3072 sc1 lds
    v_mfma_f32_16x16x32_bf16 v[140:143], a[76:79], a[20:23], 0
    s_add_u32 s49, s49, 128
    v_mfma_f32_16x16x32_bf16 v[148:151], a[76:79], a[24:27], 0
    ds_read_b128 a[52:55], v7 offset:10240
    v_mfma_f32_16x16x32_bf16 v[156:159], a[76:79], a[28:31], 0
    ds_read_b64_tr_b16 a[76:77], v11 offset:16384
    s_waitcnt lgkmcnt(15)
    v_mfma_f32_16x16x32_bf16 v[160:163], a[80:83], a[0:3], 0
    ds_read_b64_tr_b16 a[78:79], v11 offset:18432
    v_mfma_f32_16x16x32_bf16 v[168:171], a[80:83], a[4:7], 0
    v_mfma_f32_16x16x32_bf16 v[176:179], a[80:83], a[8:11], 0
    ds_read_b128 a[56:59], v7 offset:12288
    v_mfma_f32_16x16x32_bf16 v[184:187], a[80:83], a[12:15], 0
    s_add_u32 m0, s61, 4096
    v_mfma_f32_16x16x32_bf16 v[192:195], a[80:83], a[16:19], 0
    buffer_load_dwordx4 v16, s[40:43], s50 offen offset:0 sc1 lds
    v_mfma_f32_16x16x32_bf16 v[200:203], a[80:83], a[20:23], 0
    v_mfma_f32_16x16x32_bf16 v[208:211], a[80:83], a[24:27], 0
    s_add_u32 s61, s61, 32768
    ds_read_b128 a[60:63], v7 offset:14336
    v_mfma_f32_16x16x32_bf16 v[216:219], a[80:83], a[28:31], 0
    s_cmp_ge_u32 s61, 98304
    s_cselect_b32 s90, 98304, 0
    ds_read_b64_tr_b16 a[80:81], v12 offset:16384
    v_mfma_f32_16x16x32_bf16 v[164:167], a[84:87], a[0:3], 0
    s_sub_u32 s61, s61, s90
    ds_read_b64_tr_b16 a[82:83], v12 offset:18432
    v_mfma_f32_16x16x32_bf16 v[172:175], a[84:87], a[4:7], 0
    s_add_u32 s64, s64, 32768
    v_mfma_f32_16x16x32_bf16 v[180:183], a[84:87], a[8:11], 0
    buffer_store_dwordx4 a[128:131], v2, s[24:27], s28 offen sc1
    v_mfma_f32_16x16x32_bf16 v[188:191], a[84:87], a[12:15], 0
    s_add_u32 s28, s28, s31
    v_mfma_f32_16x16x32_bf16 v[196:199], a[84:87], a[16:19], 0
    buffer_load_dwordx4 v17, s[40:43], s50 offen offset:1024 sc1 lds
    v_mfma_f32_16x16x32_bf16 v[204:207], a[84:87], a[20:23], 0
    s_add_u32 s50, s50, 128
    v_mfma_f32_16x16x32_bf16 v[212:215], a[84:87], a[24:27], 0
    s_cmp_ge_u32 s64, 98304
    s_cselect_b32 s63, 4294901760, s59
    s_cselect_b32 s64, 0, s64
    v_mfma_f32_16x16x32_bf16 v[220:223], a[84:87], a[28:31], 0
    ds_read_b64_tr_b16 a[84:85], v13 offset:16384
    v_mfma_f32_16x16x32_bf16 v[224:227], a[88:91], a[0:3], 0
    ds_read_b64_tr_b16 a[86:87], v13 offset:18432
    v_mfma_f32_16x16x32_bf16 v[232:235], a[88:91], a[4:7], 0
    v_mfma_f32_16x16x32_bf16 v[240:243], a[88:91], a[8:11], 0
    buffer_store_dwordx4 a[132:135], v2, s[24:27], s28 offen sc1
    v_mfma_f32_16x16x32_bf16 v[248:251], a[88:91], a[12:15], 0
    s_add_u32 s28, s28, s31
    v_mfma_f32_16x16x32_bf16 a[96:99], a[88:91], a[16:19], 0
    buffer_load_dwordx4 v16, s[40:43], s51 offen offset:2048 sc1 lds
    v_mfma_f32_16x16x32_bf16 a[104:107], a[88:91], a[20:23], 0
    v_mfma_f32_16x16x32_bf16 a[112:115], a[88:91], a[24:27], 0
    v_mfma_f32_16x16x32_bf16 a[120:123], a[88:91], a[28:31], 0
    ds_read_b64_tr_b16 a[88:89], v14 offset:16384
    s_waitcnt lgkmcnt(15)
    v_mfma_f32_16x16x32_bf16 v[228:231], a[92:95], a[0:3], 0
    ds_read_b64_tr_b16 a[90:91], v14 offset:18432
    v_mfma_f32_16x16x32_bf16 v[236:239], a[92:95], a[4:7], 0
    v_add_u32 v6, s63, v6
    v_add_u32 v7, s63, v7
    v_mfma_f32_16x16x32_bf16 v[244:247], a[92:95], a[8:11], 0
    buffer_store_dwordx4 a[136:139], v2, s[24:27], s28 offen sc1
    v_mfma_f32_16x16x32_bf16 v[252:255], a[92:95], a[12:15], 0
    s_add_u32 s28, s28, s31
    v_mfma_f32_16x16x32_bf16 a[100:103], a[92:95], a[16:19], 0
    buffer_load_dwordx4 v17, s[40:43], s51 offen offset:3072 sc1 lds
    v_mfma_f32_16x16x32_bf16 a[108:111], a[92:95], a[20:23], 0
    s_add_u32 s51, s51, 128
    v_mfma_f32_16x16x32_bf16 a[116:119], a[92:95], a[24:27], 0
    v_mfma_f32_16x16x32_bf16 a[124:127], a[92:95], a[28:31], 0
    ds_read_b64_tr_b16 a[92:93], v15 offset:16384
    ds_read_b64_tr_b16 a[94:95], v15 offset:18432
    v_mfma_f32_16x16x32_bf16 v[32:35], a[64:67], a[32:35], v[32:35]
    v_xor_b32 v8, s60, v8
    v_xor_b32 v9, s60, v9
    v_mfma_f32_16x16x32_bf16 v[40:43], a[64:67], a[36:39], v[40:43]
    v_xor_b32 v10, s60, v10
    v_xor_b32 v11, s60, v11
    s_waitcnt lgkmcnt(15)
    v_mfma_f32_16x16x32_bf16 v[48:51], a[64:67], a[40:43], v[48:51]
    v_xor_b32 v12, s60, v12
    v_xor_b32 v13, s60, v13
    v_mfma_f32_16x16x32_bf16 v[56:59], a[64:67], a[44:47], v[56:59]
    v_xor_b32 v14, s60, v14
    v_xor_b32 v15, s60, v15
    s_waitcnt lgkmcnt(13)
    v_mfma_f32_16x16x32_bf16 v[64:67], a[64:67], a[48:51], v[64:67]
    s_waitcnt lgkmcnt(12)
    v_mfma_f32_16x16x32_bf16 v[72:75], a[64:67], a[52:55], v[72:75]
    s_waitcnt lgkmcnt(9)
    v_mfma_f32_16x16x32_bf16 v[80:83], a[64:67], a[56:59], v[80:83]
    s_waitcnt vmcnt(11) lgkmcnt(0)
    v_mfma_f32_16x16x32_bf16 v[88:91], a[64:67], a[60:63], v[88:91]
    s_barrier
    ds_read_b64_tr_b16 a[64:65], v8 offset:0
    v_mfma_f32_16x16x32_bf16 v[36:39], a[68:71], a[32:35], v[36:39]
    s_add_u32 m0, s62, 0
    ds_read_b64_tr_b16 a[66:67], v8 offset:2048
    v_mfma_f32_16x16x32_bf16 v[44:47], a[68:71], a[36:39], v[44:47]
    buffer_load_dwordx4 v18, s[44:47], s52 offen offset:0 sc1 lds
    v_mfma_f32_16x16x32_bf16 v[52:55], a[68:71], a[40:43], v[52:55]
    ds_read_b128 a[0:3], v6 offset:0
    v_mfma_f32_16x16x32_bf16 v[60:63], a[68:71], a[44:47], v[60:63]
    v_mfma_f32_16x16x32_bf16 v[68:71], a[68:71], a[48:51], v[68:71]
    v_mfma_f32_16x16x32_bf16 v[76:79], a[68:71], a[52:55], v[76:79]
    buffer_load_dwordx4 v19, s[44:47], s52 offen offset:1024 sc1 lds
    v_mfma_f32_16x16x32_bf16 v[84:87], a[68:71], a[56:59], v[84:87]
    s_add_u32 s52, s52, s56
    ds_read_b128 a[4:7], v6 offset:2048
    v_mfma_f32_16x16x32_bf16 v[92:95], a[68:71], a[60:63], v[92:95]
    ds_read_b64_tr_b16 a[68:69], v9 offset:0
    v_mfma_f32_16x16x32_bf16 v[96:99], a[72:75], a[32:35], v[96:99]
    ds_read_b64_tr_b16 a[70:71], v9 offset:2048
    v_mfma_f32_16x16x32_bf16 v[104:107], a[72:75], a[36:39], v[104:107]
    buffer_load_dwordx4 v18, s[44:47], s53 offen offset:2048 sc1 lds
    v_mfma_f32_16x16x32_bf16 v[112:115], a[72:75], a[40:43], v[112:115]
    ds_read_b128 a[8:11], v6 offset:4096
    v_mfma_f32_16x16x32_bf16 v[120:123], a[72:75], a[44:47], v[120:123]
    v_mfma_f32_16x16x32_bf16 v[128:131], a[72:75], a[48:51], v[128:131]
    v_mfma_f32_16x16x32_bf16 v[136:139], a[72:75], a[52:55], v[136:139]
    buffer_load_dwordx4 v19, s[44:47], s53 offen offset:3072 sc1 lds
    v_mfma_f32_16x16x32_bf16 v[144:147], a[72:75], a[56:59], v[144:147]
    s_add_u32 s53, s53, s56
    ds_read_b128 a[12:15], v6 offset:6144
    v_mfma_f32_16x16x32_bf16 v[152:155], a[72:75], a[60:63], v[152:155]
    ds_read_b64_tr_b16 a[72:73], v10 offset:0
    v_mfma_f32_16x16x32_bf16 v[100:103], a[76:79], a[32:35], v[100:103]
    s_add_u32 m0, s62, 4096
    ds_read_b64_tr_b16 a[74:75], v10 offset:2048
    v_mfma_f32_16x16x32_bf16 v[108:111], a[76:79], a[36:39], v[108:111]
    buffer_load_dwordx4 v20, s[44:47], s54 offen offset:0 sc1 lds
    v_mfma_f32_16x16x32_bf16 v[116:119], a[76:79], a[40:43], v[116:119]
    ds_read_b128 a[16:19], v6 offset:8192
    v_mfma_f32_16x16x32_bf16 v[124:127], a[76:79], a[44:47], v[124:127]
    s_xor_b32 s62, s62, 229376
    v_mfma_f32_16x16x32_bf16 v[132:135], a[76:79], a[48:51], v[132:135]
    v_mfma_f32_16x16x32_bf16 v[140:143], a[76:79], a[52:55], v[140:143]
    buffer_load_dwordx4 v21, s[44:47], s54 offen offset:1024 sc1 lds
    v_mfma_f32_16x16x32_bf16 v[148:151], a[76:79], a[56:59], v[148:151]
    s_add_u32 s54, s54, s56
    ds_read_b128 a[20:23], v6 offset:10240
    v_mfma_f32_16x16x32_bf16 v[156:159], a[76:79], a[60:63], v[156:159]
    ds_read_b64_tr_b16 a[76:77], v11 offset:0
    v_mfma_f32_16x16x32_bf16 v[160:163], a[80:83], a[32:35], v[160:163]
    ds_read_b64_tr_b16 a[78:79], v11 offset:2048
    v_mfma_f32_16x16x32_bf16 v[168:171], a[80:83], a[36:39], v[168:171]
    buffer_load_dwordx4 v20, s[44:47], s55 offen offset:2048 sc1 lds
    v_mfma_f32_16x16x32_bf16 v[176:179], a[80:83], a[40:43], v[176:179]
    ds_read_b128 a[24:27], v6 offset:12288
    v_mfma_f32_16x16x32_bf16 v[184:187], a[80:83], a[44:47], v[184:187]
    v_mfma_f32_16x16x32_bf16 v[192:195], a[80:83], a[48:51], v[192:195]
    v_mfma_f32_16x16x32_bf16 v[200:203], a[80:83], a[52:55], v[200:203]
    buffer_load_dwordx4 v21, s[44:47], s55 offen offset:3072 sc1 lds
    v_mfma_f32_16x16x32_bf16 v[208:211], a[80:83], a[56:59], v[208:211]
    s_add_u32 s55, s55, s56
    ds_read_b128 a[28:31], v6 offset:14336
    v_mfma_f32_16x16x32_bf16 v[216:219], a[80:83], a[60:63], v[216:219]
    ds_read_b64_tr_b16 a[80:81], v12 offset:0
    v_mfma_f32_16x16x32_bf16 v[164:167], a[84:87], a[32:35], v[164:167]
    ds_read_b64_tr_b16 a[82:83], v12 offset:2048
    v_mfma_f32_16x16x32_bf16 v[172:175], a[84:87], a[36:39], v[172:175]
    v_mfma_f32_16x16x32_bf16 v[180:183], a[84:87], a[40:43], v[180:183]
    buffer_store_dwordx4 a[140:143], v2, s[24:27], s28 offen sc1
    v_mfma_f32_16x16x32_bf16 v[188:191], a[84:87], a[44:47], v[188:191]
    s_add_u32 s28, s28, s31
    v_mfma_f32_16x16x32_bf16 v[196:199], a[84:87], a[48:51], v[196:199]
    v_mfma_f32_16x16x32_bf16 v[204:207], a[84:87], a[52:55], v[204:207]
    v_mfma_f32_16x16x32_bf16 v[212:215], a[84:87], a[56:59], v[212:215]
    buffer_store_dwordx4 a[144:147], v2, s[24:27], s28 offen sc1
    v_mfma_f32_16x16x32_bf16 v[220:223], a[84:87], a[60:63], v[220:223]
    s_add_u32 s28, s28, s31
    ds_read_b64_tr_b16 a[84:85], v13 offset:0
    v_mfma_f32_16x16x32_bf16 v[224:227], a[88:91], a[32:35], v[224:227]
    ds_read_b64_tr_b16 a[86:87], v13 offset:2048
    v_mfma_f32_16x16x32_bf16 v[232:235], a[88:91], a[36:39], v[232:235]
    v_mfma_f32_16x16x32_bf16 v[240:243], a[88:91], a[40:43], v[240:243]
    buffer_store_dwordx4 a[148:151], v2, s[24:27], s28 offen sc1
    v_mfma_f32_16x16x32_bf16 v[248:251], a[88:91], a[44:47], v[248:251]
    s_add_u32 s28, s28, s31
    v_mfma_f32_16x16x32_bf16 a[96:99], a[88:91], a[48:51], a[96:99]
    v_mfma_f32_16x16x32_bf16 a[104:107], a[88:91], a[52:55], a[104:107]
    v_mfma_f32_16x16x32_bf16 a[112:115], a[88:91], a[56:59], a[112:115]
    buffer_store_dwordx4 a[152:155], v2, s[24:27], s28 offen sc1
    v_mfma_f32_16x16x32_bf16 a[120:123], a[88:91], a[60:63], a[120:123]
    s_add_u32 s28, s28, s31
    ds_read_b64_tr_b16 a[88:89], v14 offset:0
    v_mfma_f32_16x16x32_bf16 v[228:231], a[92:95], a[32:35], v[228:231]
    ds_read_b64_tr_b16 a[90:91], v14 offset:2048
    v_mfma_f32_16x16x32_bf16 v[236:239], a[92:95], a[36:39], v[236:239]
    v_mfma_f32_16x16x32_bf16 v[244:247], a[92:95], a[40:43], v[244:247]
    buffer_store_dwordx4 a[156:159], v2, s[24:27], s28 offen sc1
    v_mfma_f32_16x16x32_bf16 v[252:255], a[92:95], a[44:47], v[252:255]
    s_add_u32 s29, s29, s30
    s_mov_b32 s28, s29
    v_mfma_f32_16x16x32_bf16 a[100:103], a[92:95], a[48:51], a[100:103]
    s_sub_u32 s65, s65, 1
    v_mfma_f32_16x16x32_bf16 a[108:111], a[92:95], a[52:55], a[108:111]
    v_mfma_f32_16x16x32_bf16 a[116:119], a[92:95], a[56:59], a[116:119]
    v_mfma_f32_16x16x32_bf16 a[124:127], a[92:95], a[60:63], a[124:127]
    ds_read_b64_tr_b16 a[92:93], v15 offset:0
    ds_read_b64_tr_b16 a[94:95], v15 offset:2048
    s_waitcnt lgkmcnt(15)
    v_mfma_f32_16x16x32_bf16 v[32:35], a[64:67], a[0:3], v[32:35]
    v_mfma_f32_16x16x32_bf16 v[40:43], a[64:67], a[4:7], v[40:43]
    v_mfma_f32_16x16x32_bf16 v[48:51], a[64:67], a[8:11], v[48:51]
    v_mfma_f32_16x16x32_bf16 v[56:59], a[64:67], a[12:15], v[56:59]
    s_add_u32 m0, s61, 0
    s_waitcnt lgkmcnt(13)
    v_mfma_f32_16x16x32_bf16 v[64:67], a[64:67], a[16:19], v[64:67]
    buffer_load_dwordx4 v16, s[40:43], s48 offen offset:0 sc1 lds
    s_waitcnt lgkmcnt(12)
    v_mfma_f32_16x16x32_bf16 v[72:75], a[64:67], a[20:23], v[72:75]
    s_waitcnt lgkmcnt(9)
    v_mfma_f32_16x16x32_bf16 v[80:83], a[64:67], a[24:27], v[80:83]
    s_waitcnt lgkmcnt(8)
    v_mfma_f32_16x16x32_bf16 v[88:91], a[64:67], a[28:31], v[88:91]
    ds_read_b64_tr_b16 a[64:65], v8 offset:16384
    v_mfma_f32_16x16x32_bf16 v[36:39], a[68:71], a[0:3], v[36:39]
    ds_read_b64_tr_b16 a[66:67], v8 offset:18432
    v_mfma_f32_16x16x32_bf16 v[44:47], a[68:71], a[4:7], v[44:47]
    v_mfma_f32_16x16x32_bf16 v[52:55], a[68:71], a[8:11], v[52:55]
    ds_read_b128 a[32:35], v7 offset:0
    v_mfma_f32_16x16x32_bf16 v[60:63], a[68:71], a[12:15], v[60:63]
    v_mfma_f32_16x16x32_bf16 v[68:71], a[68:71], a[16:19], v[68:71]
    buffer_load_dwordx4 v17, s[40:43], s48 offen offset:1024 sc1 lds
    v_mfma_f32_16x16x32_bf16 v[76:79], a[68:71], a[20:23], v[76:79]
    s_add_u32 s48, s48, 128
    v_mfma_f32_16x16x32_bf16 v[84:87], a[68:71], a[24:27], v[84:87]
    ds_read_b128 a[36:39], v7 offset:2048
    v_mfma_f32_16x16x32_bf16 v[92:95], a[68:71], a[28:31], v[92:95]
    ds_read_b64_tr_b16 a[68:69], v9 offset:16384
    v_mfma_f32_16x16x32_bf16 v[96:99], a[72:75], a[0:3], v[96:99]
    ds_read_b64_tr_b16 a[70:71], v9 offset:18432
    v_mfma_f32_16x16x32_bf16 v[104:107], a[72:75], a[4:7], v[104:107]
    v_mfma_f32_16x16x32_bf16 v[112:115], a[72:75], a[8:11], v[112:115]
    ds_read_b128 a[40:43], v7 offset:4096
    v_mfma_f32_16x16x32_bf16 v[120:123], a[72:75], a[12:15], v[120:123]
    v_mfma_f32_16x16x32_bf16 v[128:131], a[72:75], a[16:19], v[128:131]
    buffer_load_dwordx4 v16, s[40:43], s49 offen offset:2048 sc1 lds
    v_mfma_f32_16x16x32_bf16 v[136:139], a[72:75], a[20:23], v[136:139]
    v_mfma_f32_16x16x32_bf16 v[144:147], a[72:75], a[24:27], v[144:147]
    ds_read_b128 a[44:47], v7 offset:6144
    v_mfma_f32_16x16x32_bf16 v[152:155], a[72:75], a[28:31], v[152:155]
    ds_read_b64_tr_b16 a[72:73], v10 offset:16384
    v_mfma_f32_16x16x32_bf16 v[100:103], a[76:79], a[0:3], v[100:103]
    ds_read_b64_tr_b16 a[74:75], v10 offset:18432
    v_mfma_f32_16x16x32_bf16 v[108:111], a[76:79], a[4:7], v[108:111]
    v_mfma_f32_16x16x32_bf16 v[116:119], a[76:79], a[8:11], v[116:119]
    ds_read_b128 a[48:51], v7 offset:8192
    v_mfma_f32_16x16x32_bf16 v[124:127], a[76:79], a[12:15], v[124:127]
    v_mfma_f32_16x16x32_bf16 v[132:135], a[76:79], a[16:19], v[132:135]
    buffer_load_dwordx4 v17, s[40:43], s49 offen offset:3072 sc1 lds
    v_mfma_f32_16x16x32_bf16 v[140:143], a[76:79], a[20:23], v[140:143]
    s_add_u32 s49, s49, 128
    v_mfma_f32_16x16x32_bf16 v[148:151], a[76:79], a[24:27], v[148:151]
    ds_read_b128 a[52:55], v7 offset:10240
    v_mfma_f32_16x16x32_bf16 v[156:159], a[76:79], a[28:31], v[156:159]
    ds_read_b64_tr_b16 a[76:77], v11 offset:16384
    s_waitcnt lgkmcnt(15)
    v_mfma_f32_16x16x32_bf16 v[160:163], a[80:83], a[0:3], v[160:163]
    ds_read_b64_tr_b16 a[78:79], v11 offset:18432
    v_mfma_f32_16x16x32_bf16 v[168:171], a[80:83], a[4:7], v[168:171]
    v_mfma_f32_16x16x32_bf16 v[176:179], a[80:83], a[8:11], v[176:179]
    ds_read_b128 a[56:59], v7 offset:12288
    v_mfma_f32_16x16x32_bf16 v[184:187], a[80:83], a[12:15], v[184:187]
    s_add_u32 m0, s61, 4096
    v_mfma_f32_16x16x32_bf16 v[192:195], a[80:83], a[16:19], v[192:195]
    buffer_load_dwordx4 v16, s[40:43], s50 offen offset:0 sc1 lds
    v_mfma_f32_16x16x32_bf16 v[200:203], a[80:83], a[20:23], v[200:203]
    v_mfma_f32_16x16x32_bf16 v[208:211], a[80:83], a[24:27], v[208:211]
    s_add_u32 s61, s61, 32768
    ds_read_b128 a[60:63], v7 offset:14336
    v_mfma_f32_16x16x32_bf16 v[216:219], a[80:83], a[28:31], v[216:219]
    s_cmp_ge_u32 s61, 98304
    s_cselect_b32 s90, 98304, 0
    ds_read_b64_tr_b16 a[80:81], v12 offset:16384
    v_mfma_f32_16x16x32_bf16 v[164:167], a[84:87], a[0:3], v[164:167]
    s_sub_u32 s61, s61, s90
    ds_read_b64_tr_b16 a[82:83], v12 offset:18432
    v_mfma_f32_16x16x32_bf16 v[172:175], a[84:87], a[4:7], v[172:175]
    s_add_u32 s64, s64, 32768
    v_mfma_f32_16x16x32_bf16 v[180:183], a[84:87], a[8:11], v[180:183]
    buffer_store_dwordx4 a[160:163], v2, s[24:27], s28 offen sc1
    v_mfma_f32_16x16x32_bf16 v[188:191], a[84:87], a[12:15], v[188:191]
    s_add_u32 s28, s28, s31
    v_mfma_f32_16x16x32_bf16 v[196:199], a[84:87], a[16:19], v[196:199]
    buffer_load_dwordx4 v17, s[40:43], s50 offen offset:1024 sc1 lds
    v_mfma_f32_16x16x32_bf16 v[204:207], a[84:87], a[20:23], v[204:207]
    s_add_u32 s50, s50, 128
    v_mfma_f32_16x16x32_bf16 v[212:215], a[84:87], a[24:27], v[212:215]
    s_cmp_ge_u32 s64, 98304
    s_cselect_b32 s63, 4294901760, s59
    s_cselect_b32 s64, 0, s64
    v_mfma_f32_16x16x32_bf16 v[220:223], a[84:87], a[28:31], v[220:223]
    ds_read_b64_tr_b16 a[84:85], v13 offset:16384
    v_mfma_f32_16x16x32_bf16 v[224:227], a[88:91], a[0:3], v[224:227]
    ds_read_b64_tr_b16 a[86:87], v13 offset:18432
    v_mfma_f32_16x16x32_bf16 v[232:235], a[88:91], a[4:7], v[232:235]
    v_mfma_f32_16x16x32_bf16 v[240:243], a[88:91], a[8:11], v[240:243]
    buffer_store_dwordx4 a[164:167], v2, s[24:27], s28 offen sc1
    v_mfma_f32_16x16x32_bf16 v[248:251], a[88:91], a[12:15], v[248:251]
    s_add_u32 s28, s28, s31
    v_mfma_f32_16x16x32_bf16 a[96:99], a[88:91], a[16:19], a[96:99]
    buffer_load_dwordx4 v16, s[40:43], s51 offen offset:2048 sc1 lds
    v_mfma_f32_16x16x32_bf16 a[104:107], a[88:91], a[20:23], a[104:107]
    v_mfma_f32_16x16x32_bf16 a[112:115], a[88:91], a[24:27], a[112:115]
    v_mfma_f32_16x16x32_bf16 a[120:123], a[88:91], a[28:31], a[120:123]
    ds_read_b64_tr_b16 a[88:89], v14 offset:16384
    s_waitcnt lgkmcnt(15)
    v_mfma_f32_16x16x32_bf16 v[228:231], a[92:95], a[0:3], v[228:231]
    ds_read_b64_tr_b16 a[90:91], v14 offset:18432
    v_mfma_f32_16x16x32_bf16 v[236:239], a[92:95], a[4:7], v[236:239]
    v_add_u32 v6, s63, v6
    v_add_u32 v7, s63, v7
    v_mfma_f32_16x16x32_bf16 v[244:247], a[92:95], a[8:11], v[244:247]
    buffer_store_dwordx4 a[168:171], v2, s[24:27], s28 offen sc1
    v_mfma_f32_16x16x32_bf16 v[252:255], a[92:95], a[12:15], v[252:255]
    s_add_u32 s28, s28, s31
    v_mfma_f32_16x16x32_bf16 a[100:103], a[92:95], a[16:19], a[100:103]
    buffer_load_dwordx4 v17, s[40:43], s51 offen offset:3072 sc1 lds
    v_mfma_f32_16x16x32_bf16 a[108:111], a[92:95], a[20:23], a[108:111]
    s_add_u32 s51, s51, 128
    v_mfma_f32_16x16x32_bf16 a[116:119], a[92:95], a[24:27], a[116:119]
    v_mfma_f32_16x16x32_bf16 a[124:127], a[92:95], a[28:31], a[124:127]
    ds_read_b64_tr_b16 a[92:93], v15 offset:16384
    ds_read_b64_tr_b16 a[94:95], v15 offset:18432
    v_mfma_f32_16x16x32_bf16 v[32:35], a[64:67], a[32:35], v[32:35]
    v_xor_b32 v8, s60, v8
    v_xor_b32 v9, s60, v9
    v_mfma_f32_16x16x32_bf16 v[40:43], a[64:67], a[36:39], v[40:43]
    v_xor_b32 v10, s60, v10
    v_xor_b32 v11, s60, v11
    s_waitcnt lgkmcnt(15)
    v_mfma_f32_16x16x32_bf16 v[48:51], a[64:67], a[40:43], v[48:51]
    v_xor_b32 v12, s60, v12
    v_xor_b32 v13, s60, v13
    v_mfma_f32_16x16x32_bf16 v[56:59], a[64:67], a[44:47], v[56:59]
    v_xor_b32 v14, s60, v14
    v_xor_b32 v15, s60, v15
    s_waitcnt lgkmcnt(13)
    v_mfma_f32_16x16x32_bf16 v[64:67], a[64:67], a[48:51], v[64:67]
    s_waitcnt lgkmcnt(12)
    v_mfma_f32_16x16x32_bf16 v[72:75], a[64:67], a[52:55], v[72:75]
    s_waitcnt lgkmcnt(9)
    v_mfma_f32_16x16x32_bf16 v[80:83], a[64:67], a[56:59], v[80:83]
    s_waitcnt vmcnt(16) lgkmcnt(0)
    v_mfma_f32_16x16x32_bf16 v[88:91], a[64:67], a[60:63], v[88:91]
    s_barrier
    ds_read_b64_tr_b16 a[64:65], v8 offset:0
    v_mfma_f32_16x16x32_bf16 v[36:39], a[68:71], a[32:35], v[36:39]
    s_add_u32 m0, s62, 0
    ds_read_b64_tr_b16 a[66:67], v8 offset:2048
    v_mfma_f32_16x16x32_bf16 v[44:47], a[68:71], a[36:39], v[44:47]
    buffer_load_dwordx4 v18, s[44:47], s52 offen offset:0 sc1 lds
    v_mfma_f32_16x16x32_bf16 v[52:55], a[68:71], a[40:43], v[52:55]
    ds_read_b128 a[0:3], v6 offset:0
    v_mfma_f32_16x16x32_bf16 v[60:63], a[68:71], a[44:47], v[60:63]
    v_mfma_f32_16x16x32_bf16 v[68:71], a[68:71], a[48:51], v[68:71]
    v_mfma_f32_16x16x32_bf16 v[76:79], a[68:71], a[52:55], v[76:79]
    buffer_load_dwordx4 v19, s[44:47], s52 offen offset:1024 sc1 lds
    v_mfma_f32_16x16x32_bf16 v[84:87], a[68:71], a[56:59], v[84:87]
    s_add_u32 s52, s52, s56
    ds_read_b128 a[4:7], v6 offset:2048
    v_mfma_f32_16x16x32_bf16 v[92:95], a[68:71], a[60:63], v[92:95]
    ds_read_b64_tr_b16 a[68:69], v9 offset:0
    v_mfma_f32_16x16x32_bf16 v[96:99], a[72:75], a[32:35], v[96:99]
    ds_read_b64_tr_b16 a[70:71], v9 offset:2048
    v_mfma_f32_16x16x32_bf16 v[104:107], a[72:75], a[36:39], v[104:107]
    buffer_load_dwordx4 v18, s[44:47], s53 offen offset:2048 sc1 lds
    v_mfma_f32_16x16x32_bf16 v[112:115], a[72:75], a[40:43], v[112:115]
    ds_read_b128 a[8:11], v6 offset:4096
    v_mfma_f32_16x16x32_bf16 v[120:123], a[72:75], a[44:47], v[120:123]
    v_mfma_f32_16x16x32_bf16 v[128:131], a[72:75], a[48:51], v[128:131]
    v_mfma_f32_16x16x32_bf16 v[136:139], a[72:75], a[52:55], v[136:139]
    buffer_load_dwordx4 v19, s[44:47], s53 offen offset:3072 sc1 lds
    v_mfma_f32_16x16x32_bf16 v[144:147], a[72:75], a[56:59], v[144:147]
    s_add_u32 s53, s53, s56
    ds_read_b128 a[12:15], v6 offset:6144
    v_mfma_f32_16x16x32_bf16 v[152:155], a[72:75], a[60:63], v[152:155]
    ds_read_b64_tr_b16 a[72:73], v10 offset:0
    v_mfma_f32_16x16x32_bf16 v[100:103], a[76:79], a[32:35], v[100:103]
    s_add_u32 m0, s62, 4096
    ds_read_b64_tr_b16 a[74:75], v10 offset:2048
    v_mfma_f32_16x16x32_bf16 v[108:111], a[76:79], a[36:39], v[108:111]
    buffer_load_dwordx4 v20, s[44:47], s54 offen offset:0 sc1 lds
    v_mfma_f32_16x16x32_bf16 v[116:119], a[76:79], a[40:43], v[116:119]
    ds_read_b128 a[16:19], v6 offset:8192
    v_mfma_f32_16x16x32_bf16 v[124:127], a[76:79], a[44:47], v[124:127]
    s_xor_b32 s62, s62, 229376
    v_mfma_f32_16x16x32_bf16 v[132:135], a[76:79], a[48:51], v[132:135]
    v_mfma_f32_16x16x32_bf16 v[140:143], a[76:79], a[52:55], v[140:143]
    buffer_load_dwordx4 v21, s[44:47], s54 offen offset:1024 sc1 lds
    v_mfma_f32_16x16x32_bf16 v[148:151], a[76:79], a[56:59], v[148:151]
    s_add_u32 s54, s54, s56
    ds_read_b128 a[20:23], v6 offset:10240
    v_mfma_f32_16x16x32_bf16 v[156:159], a[76:79], a[60:63], v[156:159]
    ds_read_b64_tr_b16 a[76:77], v11 offset:0
    v_mfma_f32_16x16x32_bf16 v[160:163], a[80:83], a[32:35], v[160:163]
    ds_read_b64_tr_b16 a[78:79], v11 offset:2048
    v_mfma_f32_16x16x32_bf16 v[168:171], a[80:83], a[36:39], v[168:171]
    buffer_load_dwordx4 v20, s[44:47], s55 offen offset:2048 sc1 lds
    v_mfma_f32_16x16x32_bf16 v[176:179], a[80:83], a[40:43], v[176:179]
    ds_read_b128 a[24:27], v6 offset:12288
    v_mfma_f32_16x16x32_bf16 v[184:187], a[80:83], a[44:47], v[184:187]
    v_mfma_f32_16x16x32_bf16 v[192:195], a[80:83], a[48:51], v[192:195]
    v_mfma_f32_16x16x32_bf16 v[200:203], a[80:83], a[52:55], v[200:203]
    buffer_load_dwordx4 v21, s[44:47], s55 offen offset:3072 sc1 lds
    v_mfma_f32_16x16x32_bf16 v[208:211], a[80:83], a[56:59], v[208:211]
    s_add_u32 s55, s55, s56
    ds_read_b128 a[28:31], v6 offset:14336
    v_mfma_f32_16x16x32_bf16 v[216:219], a[80:83], a[60:63], v[216:219]
    ds_read_b64_tr_b16 a[80:81], v12 offset:0
    v_mfma_f32_16x16x32_bf16 v[164:167], a[84:87], a[32:35], v[164:167]
    ds_read_b64_tr_b16 a[82:83], v12 offset:2048
    v_mfma_f32_16x16x32_bf16 v[172:175], a[84:87], a[36:39], v[172:175]
    v_mfma_f32_16x16x32_bf16 v[180:183], a[84:87], a[40:43], v[180:183]
    buffer_store_dwordx4 a[172:175], v2, s[24:27], s28 offen sc1
    v_mfma_f32_16x16x32_bf16 v[188:191], a[84:87], a[44:47], v[188:191]
    s_add_u32 s28, s28, s31
    v_mfma_f32_16x16x32_bf16 v[196:199], a[84:87], a[48:51], v[196:199]
    v_mfma_f32_16x16x32_bf16 v[204:207], a[84:87], a[52:55], v[204:207]
    v_mfma_f32_16x16x32_bf16 v[212:215], a[84:87], a[56:59], v[212:215]
    buffer_store_dwordx4 a[176:179], v2, s[24:27], s28 offen sc1
    v_mfma_f32_16x16x32_bf16 v[220:223], a[84:87], a[60:63], v[220:223]
    s_add_u32 s28, s28, s31
    ds_read_b64_tr_b16 a[84:85], v13 offset:0
    v_mfma_f32_16x16x32_bf16 v[224:227], a[88:91], a[32:35], v[224:227]
    ds_read_b64_tr_b16 a[86:87], v13 offset:2048
    v_mfma_f32_16x16x32_bf16 v[232:235], a[88:91], a[36:39], v[232:235]
    v_mfma_f32_16x16x32_bf16 v[240:243], a[88:91], a[40:43], v[240:243]
    buffer_store_dwordx4 a[180:183], v2, s[24:27], s28 offen sc1
    v_mfma_f32_16x16x32_bf16 v[248:251], a[88:91], a[44:47], v[248:251]
    s_add_u32 s28, s28, s31
    v_mfma_f32_16x16x32_bf16 a[96:99], a[88:91], a[48:51], a[96:99]
    v_mfma_f32_16x16x32_bf16 a[104:107], a[88:91], a[52:55], a[104:107]
    v_mfma_f32_16x16x32_bf16 a[112:115], a[88:91], a[56:59], a[112:115]
    buffer_store_dwordx4 a[184:187], v2, s[24:27], s28 offen sc1
    v_mfma_f32_16x16x32_bf16 a[120:123], a[88:91], a[60:63], a[120:123]
    s_add_u32 s28, s28, s31
    ds_read_b64_tr_b16 a[88:89], v14 offset:0
    v_mfma_f32_16x16x32_bf16 v[228:231], a[92:95], a[32:35], v[228:231]
    ds_read_b64_tr_b16 a[90:91], v14 offset:2048
    v_mfma_f32_16x16x32_bf16 v[236:239], a[92:95], a[36:39], v[236:239]
    v_mfma_f32_16x16x32_bf16 v[244:247], a[92:95], a[40:43], v[244:247]
    buffer_store_dwordx4 a[188:191], v2, s[24:27], s28 offen sc1
    v_mfma_f32_16x16x32_bf16 v[252:255], a[92:95], a[44:47], v[252:255]
    s_add_u32 s29, s29, s30
    s_mov_b32 s28, s29
    v_mfma_f32_16x16x32_bf16 a[100:103], a[92:95], a[48:51], a[100:103]
    s_sub_u32 s65, s65, 1
    v_mfma_f32_16x16x32_bf16 a[108:111], a[92:95], a[52:55], a[108:111]
    v_mfma_f32_16x16x32_bf16 a[116:119], a[92:95], a[56:59], a[116:119]
    v_mfma_f32_16x16x32_bf16 a[124:127], a[92:95], a[60:63], a[124:127]
    ds_read_b64_tr_b16 a[92:93], v15 offset:0
    ds_read_b64_tr_b16 a[94:95], v15 offset:2048
    s_cmp_eq_u32 s66, 2
    s_cbranch_scc1 m_hook14
m_hookr15:
    s_waitcnt lgkmcnt(15)
    v_mfma_f32_16x16x32_bf16 v[32:35], a[64:67], a[0:3], v[32:35]
    v_mfma_f32_16x16x32_bf16 v[40:43], a[64:67], a[4:7], v[40:43]
    v_mfma_f32_16x16x32_bf16 v[48:51], a[64:67], a[8:11], v[48:51]
    v_mfma_f32_16x16x32_bf16 v[56:59], a[64:67], a[12:15], v[56:59]
    s_add_u32 m0, s61, 0
    s_waitcnt lgkmcnt(13)
    v_mfma_f32_16x16x32_bf16 v[64:67], a[64:67], a[16:19], v[64:67]
    buffer_load_dwordx4 v16, s[40:43], s48 offen offset:0 sc1 lds
    s_waitcnt lgkmcnt(12)
    v_mfma_f32_16x16x32_bf16 v[72:75], a[64:67], a[20:23], v[72:75]
    s_waitcnt lgkmcnt(9)
    v_mfma_f32_16x16x32_bf16 v[80:83], a[64:67], a[24:27], v[80:83]
    s_waitcnt lgkmcnt(8)
    v_mfma_f32_16x16x32_bf16 v[88:91], a[64:67], a[28:31], v[88:91]
    ds_read_b64_tr_b16 a[64:65], v8 offset:16384
    v_mfma_f32_16x16x32_bf16 v[36:39], a[68:71], a[0:3], v[36:39]
    ds_read_b64_tr_b16 a[66:67], v8 offset:18432
    v_mfma_f32_16x16x32_bf16 v[44:47], a[68:71], a[4:7], v[44:47]
    v_mfma_f32_16x16x32_bf16 v[52:55], a[68:71], a[8:11], v[52:55]
    ds_read_b128 a[32:35], v7 offset:0
    v_mfma_f32_16x16x32_bf16 v[60:63], a[68:71], a[12:15], v[60:63]
    v_mfma_f32_16x16x32_bf16 v[68:71], a[68:71], a[16:19], v[68:71]
    buffer_load_dwordx4 v17, s[40:43], s48 offen offset:1024 sc1 lds
    v_mfma_f32_16x16x32_bf16 v[76:79], a[68:71], a[20:23], v[76:79]
    s_add_u32 s48, s48, 128
    v_mfma_f32_16x16x32_bf16 v[84:87], a[68:71], a[24:27], v[84:87]
    ds_read_b128 a[36:39], v7 offset:2048
    v_mfma_f32_16x16x32_bf16 v[92:95], a[68:71], a[28:31], v[92:95]
    ds_read_b64_tr_b16 a[68:69], v9 offset:16384
    v_mfma_f32_16x16x32_bf16 v[96:99], a[72:75], a[0:3], v[96:99]
    ds_read_b64_tr_b16 a[70:71], v9 offset:18432
    v_mfma_f32_16x16x32_bf16 v[104:107], a[72:75], a[4:7], v[104:107]
    v_mfma_f32_16x16x32_bf16 v[112:115], a[72:75], a[8:11], v[112:115]
    ds_read_b128 a[40:43], v7 offset:4096
    v_mfma_f32_16x16x32_bf16 v[120:123], a[72:75], a[12:15], v[120:123]
    v_mfma_f32_16x16x32_bf16 v[128:131], a[72:75], a[16:19], v[128:131]
    buffer_load_dwordx4 v16, s[40:43], s49 offen offset:2048 sc1 lds
    v_mfma_f32_16x16x32_bf16 v[136:139], a[72:75], a[20:23], v[136:139]
    v_mfma_f32_16x16x32_bf16 v[144:147], a[72:75], a[24:27], v[144:147]
    ds_read_b128 a[44:47], v7 offset:6144
    v_mfma_f32_16x16x32_bf16 v[152:155], a[72:75], a[28:31], v[152:155]
    ds_read_b64_tr_b16 a[72:73], v10 offset:16384
    v_mfma_f32_16x16x32_bf16 v[100:103], a[76:79], a[0:3], v[100:103]
    ds_read_b64_tr_b16 a[74:75], v10 offset:18432
    v_mfma_f32_16x16x32_bf16 v[108:111], a[76:79], a[4:7], v[108:111]
    v_mfma_f32_16x16x32_bf16 v[116:119], a[76:79], a[8:11], v[116:119]
    ds_read_b128 a[48:51], v7 offset:8192
    v_mfma_f32_16x16x32_bf16 v[124:127], a[76:79], a[12:15], v[124:127]
    v_mfma_f32_16x16x32_bf16 v[132:135], a[76:79], a[16:19], v[132:135]
    buffer_load_dwordx4 v17, s[40:43], s49 offen offset:3072 sc1 lds
    v_mfma_f32_16x16x32_bf16 v[140:143], a[76:79], a[20:23], v[140:143]
    s_add_u32 s49, s49, 128
    v_mfma_f32_16x16x32_bf16 v[148:151], a[76:79], a[24:27], v[148:151]
    ds_read_b128 a[52:55], v7 offset:10240
    v_mfma_f32_16x16x32_bf16 v[156:159], a[76:79], a[28:31], v[156:159]
    ds_read_b64_tr_b16 a[76:77], v11 offset:16384
    s_waitcnt lgkmcnt(15)
    v_mfma_f32_16x16x32_bf16 v[160:163], a[80:83], a[0:3], v[160:163]
    ds_read_b64_tr_b16 a[78:79], v11 offset:18432
    v_mfma_f32_16x16x32_bf16 v[168:171], a[80:83], a[4:7], v[168:171]
    v_mfma_f32_16x16x32_bf16 v[176:179], a[80:83], a[8:11], v[176:179]
    ds_read_b128 a[56:59], v7 offset:12288
    v_mfma_f32_16x16x32_bf16 v[184:187], a[80:83], a[12:15], v[184:187]
    s_add_u32 m0, s61, 4096
    v_mfma_f32_16x16x32_bf16 v[192:195], a[80:83], a[16:19], v[192:195]
    buffer_load_dwordx4 v16, s[40:43], s50 offen offset:0 sc1 lds
    v_mfma_f32_16x16x32_bf16 v[200:203], a[80:83], a[20:23], v[200:203]
    v_mfma_f32_16x16x32_bf16 v[208:211], a[80:83], a[24:27], v[208:211]
    s_add_u32 s61, s61, 32768
    ds_read_b128 a[60:63], v7 offset:14336
    v_mfma_f32_16x16x32_bf16 v[216:219], a[80:83], a[28:31], v[216:219]
    s_cmp_ge_u32 s61, 98304
    s_cselect_b32 s90, 98304, 0
    ds_read_b64_tr_b16 a[80:81], v12 offset:16384
    v_mfma_f32_16x16x32_bf16 v[164:167], a[84:87], a[0:3], v[164:167]
    s_sub_u32 s61, s61, s90
    ds_read_b64_tr_b16 a[82:83], v12 offset:18432
    v_mfma_f32_16x16x32_bf16 v[172:175], a[84:87], a[4:7], v[172:175]
    s_add_u32 s64, s64, 32768
    v_mfma_f32_16x16x32_bf16 v[180:183], a[84:87], a[8:11], v[180:183]
    buffer_store_dwordx4 a[192:195], v2, s[24:27], s28 offen sc1
    v_mfma_f32_16x16x32_bf16 v[188:191], a[84:87], a[12:15], v[188:191]
    s_add_u32 s28, s28, s31
    v_mfma_f32_16x16x32_bf16 v[196:199], a[84:87], a[16:19], v[196:199]
    buffer_load_dwordx4 v17, s[40:43], s50 offen offset:1024 sc1 lds
    v_mfma_f32_16x16x32_bf16 v[204:207], a[84:87], a[20:23], v[204:207]
    s_add_u32 s50, s50, 128
    v_mfma_f32_16x16x32_bf16 v[212:215], a[84:87], a[24:27], v[212:215]
    s_cmp_ge_u32 s64, 98304
    s_cselect_b32 s63, 4294901760, s59
    s_cselect_b32 s64, 0, s64
    v_mfma_f32_16x16x32_bf16 v[220:223], a[84:87], a[28:31], v[220:223]
    ds_read_b64_tr_b16 a[84:85], v13 offset:16384
    v_mfma_f32_16x16x32_bf16 v[224:227], a[88:91], a[0:3], v[224:227]
    ds_read_b64_tr_b16 a[86:87], v13 offset:18432
    v_mfma_f32_16x16x32_bf16 v[232:235], a[88:91], a[4:7], v[232:235]
    v_mfma_f32_16x16x32_bf16 v[240:243], a[88:91], a[8:11], v[240:243]
    buffer_store_dwordx4 a[196:199], v2, s[24:27], s28 offen sc1
    v_mfma_f32_16x16x32_bf16 v[248:251], a[88:91], a[12:15], v[248:251]
    s_add_u32 s28, s28, s31
    v_mfma_f32_16x16x32_bf16 a[96:99], a[88:91], a[16:19], a[96:99]
    buffer_load_dwordx4 v16, s[40:43], s51 offen offset:2048 sc1 lds
    v_mfma_f32_16x16x32_bf16 a[104:107], a[88:91], a[20:23], a[104:107]
    v_mfma_f32_16x16x32_bf16 a[112:115], a[88:91], a[24:27], a[112:115]
    v_mfma_f32_16x16x32_bf16 a[120:123], a[88:91], a[28:31], a[120:123]
    ds_read_b64_tr_b16 a[88:89], v14 offset:16384
    s_waitcnt lgkmcnt(15)
    v_mfma_f32_16x16x32_bf16 v[228:231], a[92:95], a[0:3], v[228:231]
    ds_read_b64_tr_b16 a[90:91], v14 offset:18432
    v_mfma_f32_16x16x32_bf16 v[236:239], a[92:95], a[4:7], v[236:239]
    v_add_u32 v6, s63, v6
    v_add_u32 v7, s63, v7
    v_mfma_f32_16x16x32_bf16 v[244:247], a[92:95], a[8:11], v[244:247]
    buffer_store_dwordx4 a[200:203], v2, s[24:27], s28 offen sc1
    v_mfma_f32_16x16x32_bf16 v[252:255], a[92:95], a[12:15], v[252:255]
    s_add_u32 s28, s28, s31
    v_mfma_f32_16x16x32_bf16 a[100:103], a[92:95], a[16:19], a[100:103]
    buffer_load_dwordx4 v17, s[40:43], s51 offen offset:3072 sc1 lds
    v_mfma_f32_16x16x32_bf16 a[108:111], a[92:95], a[20:23], a[108:111]
    s_add_u32 s51, s51, 128
    v_mfma_f32_16x16x32_bf16 a[116:119], a[92:95], a[24:27], a[116:119]
    v_mfma_f32_16x16x32_bf16 a[124:127], a[92:95], a[28:31], a[124:127]
    ds_read_b64_tr_b16 a[92:93], v15 offset:16384
    ds_read_b64_tr_b16 a[94:95], v15 offset:18432
    v_mfma_f32_16x16x32_bf16 v[32:35], a[64:67], a[32:35], v[32:35]
    v_xor_b32 v8, s60, v8
    v_xor_b32 v9, s60, v9
    v_mfma_f32_16x16x32_bf16 v[40:43], a[64:67], a[36:39], v[40:43]
    v_xor_b32 v10, s60, v10
    v_xor_b32 v11, s60, v11
    s_waitcnt lgkmcnt(15)
    v_mfma_f32_16x16x32_bf16 v[48:51], a[64:67], a[40:43], v[48:51]
    v_xor_b32 v12, s60, v12
    v_xor_b32 v13, s60, v13
    v_mfma_f32_16x16x32_bf16 v[56:59], a[64:67], a[44:47], v[56:59]
    v_xor_b32 v14, s60, v14
    v_xor_b32 v15, s60, v15
    s_waitcnt lgkmcnt(13)
    v_mfma_f32_16x16x32_bf16 v[64:67], a[64:67], a[48:51], v[64:67]
    s_waitcnt lgkmcnt(12)
    v_mfma_f32_16x16x32_bf16 v[72:75], a[64:67], a[52:55], v[72:75]
    s_waitcnt lgkmcnt(9)
    v_mfma_f32_16x16x32_bf16 v[80:83], a[64:67], a[56:59], v[80:83]
    s_waitcnt vmcnt(16) lgkmcnt(0)
    v_mfma_f32_16x16x32_bf16 v[88:91], a[64:67], a[60:63], v[88:91]
    s_barrier
    ds_read_b64_tr_b16 a[64:65], v8 offset:0
    v_mfma_f32_16x16x32_bf16 v[36:39], a[68:71], a[32:35], v[36:39]
    s_add_u32 m0, s62, 0
    ds_read_b64_tr_b16 a[66:67], v8 offset:2048
    v_mfma_f32_16x16x32_bf16 v[44:47], a[68:71], a[36:39], v[44:47]
    buffer_load_dwordx4 v18, s[44:47], s52 offen offset:0 sc1 lds
    v_mfma_f32_16x16x32_bf16 v[52:55], a[68:71], a[40:43], v[52:55]
    ds_read_b128 a[0:3], v6 offset:0
    v_mfma_f32_16x16x32_bf16 v[60:63], a[68:71], a[44:47], v[60:63]
    v_mfma_f32_16x16x32_bf16 v[68:71], a[68:71], a[48:51], v[68:71]
    v_mfma_f32_16x16x32_bf16 v[76:79], a[68:71], a[52:55], v[76:79]
    buffer_load_dwordx4 v19, s[44:47], s52 offen offset:1024 sc1 lds
    v_mfma_f32_16x16x32_bf16 v[84:87], a[68:71], a[56:59], v[84:87]
    s_add_u32 s52, s52, s56
    ds_read_b128 a[4:7], v6 offset:2048
    v_mfma_f32_16x16x32_bf16 v[92:95], a[68:71], a[60:63], v[92:95]
    ds_read_b64_tr_b16 a[68:69], v9 offset:0
    v_mfma_f32_16x16x32_bf16 v[96:99], a[72:75], a[32:35], v[96:99]
    ds_read_b64_tr_b16 a[70:71], v9 offset:2048
    v_mfma_f32_16x16x32_bf16 v[104:107], a[72:75], a[36:39], v[104:107]
    buffer_load_dwordx4 v18, s[44:47], s53 offen offset:2048 sc1 lds
    v_mfma_f32_16x16x32_bf16 v[112:115], a[72:75], a[40:43], v[112:115]
    ds_read_b128 a[8:11], v6 offset:4096
    v_mfma_f32_16x16x32_bf16 v[120:123], a[72:75], a[44:47], v[120:123]
    v_mfma_f32_16x16x32_bf16 v[128:131], a[72:75], a[48:51], v[128:131]
    v_mfma_f32_16x16x32_bf16 v[136:139], a[72:75], a[52:55], v[136:139]
    buffer_load_dwordx4 v19, s[44:47], s53 offen offset:3072 sc1 lds
    v_mfma_f32_16x16x32_bf16 v[144:147], a[72:75], a[56:59], v[144:147]
    s_add_u32 s53, s53, s56
    ds_read_b128 a[12:15], v6 offset:6144
    v_mfma_f32_16x16x32_bf16 v[152:155], a[72:75], a[60:63], v[152:155]
    ds_read_b64_tr_b16 a[72:73], v10 offset:0
    v_mfma_f32_16x16x32_bf16 v[100:103], a[76:79], a[32:35], v[100:103]
    s_add_u32 m0, s62, 4096
    ds_read_b64_tr_b16 a[74:75], v10 offset:2048
    v_mfma_f32_16x16x32_bf16 v[108:111], a[76:79], a[36:39], v[108:111]
    buffer_load_dwordx4 v20, s[44:47], s54 offen offset:0 sc1 lds
    v_mfma_f32_16x16x32_bf16 v[116:119], a[76:79], a[40:43], v[116:119]
    ds_read_b128 a[16:19], v6 offset:8192
    v_mfma_f32_16x16x32_bf16 v[124:127], a[76:79], a[44:47], v[124:127]
    s_xor_b32 s62, s62, 229376
    v_mfma_f32_16x16x32_bf16 v[132:135], a[76:79], a[48:51], v[132:135]
    v_mfma_f32_16x16x32_bf16 v[140:143], a[76:79], a[52:55], v[140:143]
    buffer_load_dwordx4 v21, s[44:47], s54 offen offset:1024 sc1 lds
    v_mfma_f32_16x16x32_bf16 v[148:151], a[76:79], a[56:59], v[148:151]
    s_add_u32 s54, s54, s56
    ds_read_b128 a[20:23], v6 offset:10240
    v_mfma_f32_16x16x32_bf16 v[156:159], a[76:79], a[60:63], v[156:159]
    ds_read_b64_tr_b16 a[76:77], v11 offset:0
    v_mfma_f32_16x16x32_bf16 v[160:163], a[80:83], a[32:35], v[160:163]
    ds_read_b64_tr_b16 a[78:79], v11 offset:2048
    v_mfma_f32_16x16x32_bf16 v[168:171], a[80:83], a[36:39], v[168:171]
    buffer_load_dwordx4 v20, s[44:47], s55 offen offset:2048 sc1 lds
    v_mfma_f32_16x16x32_bf16 v[176:179], a[80:83], a[40:43], v[176:179]
    ds_read_b128 a[24:27], v6 offset:12288
    v_mfma_f32_16x16x32_bf16 v[184:187], a[80:83], a[44:47], v[184:187]
    v_mfma_f32_16x16x32_bf16 v[192:195], a[80:83], a[48:51], v[192:195]
    v_mfma_f32_16x16x32_bf16 v[200:203], a[80:83], a[52:55], v[200:203]
    buffer_load_dwordx4 v21, s[44:47], s55 offen offset:3072 sc1 lds
    v_mfma_f32_16x16x32_bf16 v[208:211], a[80:83], a[56:59], v[208:211]
    s_add_u32 s55, s55, s56
    ds_read_b128 a[28:31], v6 offset:14336
    v_mfma_f32_16x16x32_bf16 v[216:219], a[80:83], a[60:63], v[216:219]
    ds_read_b64_tr_b16 a[80:81], v12 offset:0
    v_mfma_f32_16x16x32_bf16 v[164:167], a[84:87], a[32:35], v[164:167]
    ds_read_b64_tr_b16 a[82:83], v12 offset:2048
    v_mfma_f32_16x16x32_bf16 v[172:175], a[84:87], a[36:39], v[172:175]
    v_mfma_f32_16x16x32_bf16 v[180:183], a[84:87], a[40:43], v[180:183]
    buffer_store_dwordx4 a[204:207], v2, s[24:27], s28 offen sc1
    v_mfma_f32_16x16x32_bf16 v[188:191], a[84:87], a[44:47], v[188:191]
    s_add_u32 s28, s28, s31
    v_mfma_f32_16x16x32_bf16 v[196:199], a[84:87], a[48:51], v[196:199]
    v_mfma_f32_16x16x32_bf16 v[204:207], a[84:87], a[52:55], v[204:207]
    v_mfma_f32_16x16x32_bf16 v[212:215], a[84:87], a[56:59], v[212:215]
    buffer_store_dwordx4 a[208:211], v2, s[24:27], s28 offen sc1
    v_mfma_f32_16x16x32_bf16 v[220:223], a[84:87], a[60:63], v[220:223]
    s_add_u32 s28, s28, s31
    ds_read_b64_tr_b16 a[84:85], v13 offset:0
    v_mfma_f32_16x16x32_bf16 v[224:227], a[88:91], a[32:35], v[224:227]
    ds_read_b64_tr_b16 a[86:87], v13 offset:2048
    v_mfma_f32_16x16x32_bf16 v[232:235], a[88:91], a[36:39], v[232:235]
    v_mfma_f32_16x16x32_bf16 v[240:243], a[88:91], a[40:43], v[240:243]
    buffer_store_dwordx4 a[212:215], v2, s[24:27], s28 offen sc1
    v_mfma_f32_16x16x32_bf16 v[248:251], a[88:91], a[44:47], v[248:251]
    s_add_u32 s28, s28, s31
    v_mfma_f32_16x16x32_bf16 a[96:99], a[88:91], a[48:51], a[96:99]
    v_mfma_f32_16x16x32_bf16 a[104:107], a[88:91], a[52:55], a[104:107]
    v_mfma_f32_16x16x32_bf16 a[112:115], a[88:91], a[56:59], a[112:115]
    buffer_store_dwordx4 a[216:219], v2, s[24:27], s28 offen sc1
    v_mfma_f32_16x16x32_bf16 a[120:123], a[88:91], a[60:63], a[120:123]
    s_add_u32 s28, s28, s31
    ds_read_b64_tr_b16 a[88:89], v14 offset:0
    v_mfma_f32_16x16x32_bf16 v[228:231], a[92:95], a[32:35], v[228:231]
    ds_read_b64_tr_b16 a[90:91], v14 offset:2048
    v_mfma_f32_16x16x32_bf16 v[236:239], a[92:95], a[36:39], v[236:239]
    v_mfma_f32_16x16x32_bf16 v[244:247], a[92:95], a[40:43], v[244:247]
    buffer_store_dwordx4 a[220:223], v2, s[24:27], s28 offen sc1
    v_mfma_f32_16x16x32_bf16 v[252:255], a[92:95], a[44:47], v[252:255]
    s_add_u32 s29, s29, s30
    s_mov_b32 s28, s29
    v_mfma_f32_16x16x32_bf16 a[100:103], a[92:95], a[48:51], a[100:103]
    s_sub_u32 s65, s65, 1
    v_mfma_f32_16x16x32_bf16 a[108:111], a[92:95], a[52:55], a[108:111]
    v_mfma_f32_16x16x32_bf16 a[116:119], a[92:95], a[56:59], a[116:119]
    v_mfma_f32_16x16x32_bf16 a[124:127], a[92:95], a[60:63], a[124:127]
    ds_read_b64_tr_b16 a[92:93], v15 offset:0
    ds_read_b64_tr_b16 a[94:95], v15 offset:2048
    s_waitcnt lgkmcnt(15)
    v_mfma_f32_16x16x32_bf16 v[32:35], a[64:67], a[0:3], v[32:35]
    v_mfma_f32_16x16x32_bf16 v[40:43], a[64:67], a[4:7], v[40:43]
    v_mfma_f32_16x16x32_bf16 v[48:51], a[64:67], a[8:11], v[48:51]
    v_mfma_f32_16x16x32_bf16 v[56:59], a[64:67], a[12:15], v[56:59]
    s_add_u32 m0, s61, 0
    s_waitcnt lgkmcnt(13)
    v_mfma_f32_16x16x32_bf16 v[64:67], a[64:67], a[16:19], v[64:67]
    buffer_load_dwordx4 v16, s[40:43], s48 offen offset:0 sc1 lds
    s_waitcnt lgkmcnt(12)
    v_mfma_f32_16x16x32_bf16 v[72:75], a[64:67], a[20:23], v[72:75]
    s_waitcnt lgkmcnt(9)
    v_mfma_f32_16x16x32_bf16 v[80:83], a[64:67], a[24:27], v[80:83]
    s_waitcnt lgkmcnt(8)
    v_mfma_f32_16x16x32_bf16 v[88:91], a[64:67], a[28:31], v[88:91]
    ds_read_b64_tr_b16 a[64:65], v8 offset:16384
    v_mfma_f32_16x16x32_bf16 v[36:39], a[68:71], a[0:3], v[36:39]
    ds_read_b64_tr_b16 a[66:67], v8 offset:18432
    v_mfma_f32_16x16x32_bf16 v[44:47], a[68:71], a[4:7], v[44:47]
    v_mfma_f32_16x16x32_bf16 v[52:55], a[68:71], a[8:11], v[52:55]
    ds_read_b128 a[32:35], v7 offset:0
    v_mfma_f32_16x16x32_bf16 v[60:63], a[68:71], a[12:15], v[60:63]
    v_mfma_f32_16x16x32_bf16 v[68:71], a[68:71], a[16:19], v[68:71]
    buffer_load_dwordx4 v17, s[40:43], s48 offen offset:1024 sc1 lds
    v_mfma_f32_16x16x32_bf16 v[76:79], a[68:71], a[20:23], v[76:79]
    s_add_u32 s48, s48, 128
    v_mfma_f32_16x16x32_bf16 v[84:87], a[68:71], a[24:27], v[84:87]
    ds_read_b128 a[36:39], v7 offset:2048
    v_mfma_f32_16x16x32_bf16 v[92:95], a[68:71], a[28:31], v[92:95]
    ds_read_b64_tr_b16 a[68:69], v9 offset:16384
    v_mfma_f32_16x16x32_bf16 v[96:99], a[72:75], a[0:3], v[96:99]
    ds_read_b64_tr_b16 a[70:71], v9 offset:18432
    v_mfma_f32_16x16x32_bf16 v[104:107], a[72:75], a[4:7], v[104:107]
    v_mfma_f32_16x16x32_bf16 v[112:115], a[72:75], a[8:11], v[112:115]
    ds_read_b128 a[40:43], v7 offset:4096
    v_mfma_f32_16x16x32_bf16 v[120:123], a[72:75], a[12:15], v[120:123]
    v_mfma_f32_16x16x32_bf16 v[128:131], a[72:75], a[16:19], v[128:131]
    buffer_load_dwordx4 v16, s[40:43], s49 offen offset:2048 sc1 lds
    v_mfma_f32_16x16x32_bf16 v[136:139], a[72:75], a[20:23], v[136:139]
    v_mfma_f32_16x16x32_bf16 v[144:147], a[72:75], a[24:27], v[144:147]
    ds_read_b128 a[44:47], v7 offset:6144
    v_mfma_f32_16x16x32_bf16 v[152:155], a[72:75], a[28:31], v[152:155]
    ds_read_b64_tr_b16 a[72:73], v10 offset:16384
    v_mfma_f32_16x16x32_bf16 v[100:103], a[76:79], a[0:3], v[100:103]
    ds_read_b64_tr_b16 a[74:75], v10 offset:18432
    v_mfma_f32_16x16x32_bf16 v[108:111], a[76:79], a[4:7], v[108:111]
    v_mfma_f32_16x16x32_bf16 v[116:119], a[76:79], a[8:11], v[116:119]
    ds_read_b128 a[48:51], v7 offset:8192
    v_mfma_f32_16x16x32_bf16 v[124:127], a[76:79], a[12:15], v[124:127]
    v_mfma_f32_16x16x32_bf16 v[132:135], a[76:79], a[16:19], v[132:135]
    buffer_load_dwordx4 v17, s[40:43], s49 offen offset:3072 sc1 lds
    v_mfma_f32_16x16x32_bf16 v[140:143], a[76:79], a[20:23], v[140:143]
    s_add_u32 s49, s49, 128
    v_mfma_f32_16x16x32_bf16 v[148:151], a[76:79], a[24:27], v[148:151]
    ds_read_b128 a[52:55], v7 offset:10240
    v_mfma_f32_16x16x32_bf16 v[156:159], a[76:79], a[28:31], v[156:159]
    ds_read_b64_tr_b16 a[76:77], v11 offset:16384
    s_waitcnt lgkmcnt(15)
    v_mfma_f32_16x16x32_bf16 v[160:163], a[80:83], a[0:3], v[160:163]
    ds_read_b64_tr_b16 a[78:79], v11 offset:18432
    v_mfma_f32_16x16x32_bf16 v[168:171], a[80:83], a[4:7], v[168:171]
    v_mfma_f32_16x16x32_bf16 v[176:179], a[80:83], a[8:11], v[176:179]
    ds_read_b128 a[56:59], v7 offset:12288
    v_mfma_f32_16x16x32_bf16 v[184:187], a[80:83], a[12:15], v[184:187]
    s_add_u32 m0, s61, 4096
    v_mfma_f32_16x16x32_bf16 v[192:195], a[80:83], a[16:19], v[192:195]
    buffer_load_dwordx4 v16, s[40:43], s50 offen offset:0 sc1 lds
    v_mfma_f32_16x16x32_bf16 v[200:203], a[80:83], a[20:23], v[200:203]
    v_mfma_f32_16x16x32_bf16 v[208:211], a[80:83], a[24:27], v[208:211]
    s_add_u32 s61, s61, 32768
    ds_read_b128 a[60:63], v7 offset:14336
    v_mfma_f32_16x16x32_bf16 v[216:219], a[80:83], a[28:31], v[216:219]
    s_cmp_ge_u32 s61, 98304
    s_cselect_b32 s90, 98304, 0
    ds_read_b64_tr_b16 a[80:81], v12 offset:16384
    v_mfma_f32_16x16x32_bf16 v[164:167], a[84:87], a[0:3], v[164:167]
    s_sub_u32 s61, s61, s90
    ds_read_b64_tr_b16 a[82:83], v12 offset:18432
    v_mfma_f32_16x16x32_bf16 v[172:175], a[84:87], a[4:7], v[172:175]
    s_add_u32 s64, s64, 32768
    v_mfma_f32_16x16x32_bf16 v[180:183], a[84:87], a[8:11], v[180:183]
    buffer_store_dwordx4 a[224:227], v2, s[24:27], s28 offen sc1
    v_mfma_f32_16x16x32_bf16 v[188:191], a[84:87], a[12:15], v[188:191]
    s_add_u32 s28, s28, s31
    v_mfma_f32_16x16x32_bf16 v[196:199], a[84:87], a[16:19], v[196:199]
    buffer_load_dwordx4 v17, s[40:43], s50 offen offset:1024 sc1 lds
    v_mfma_f32_16x16x32_bf16 v[204:207], a[84:87], a[20:23], v[204:207]
    s_add_u32 s50, s50, 128
    v_mfma_f32_16x16x32_bf16 v[212:215], a[84:87], a[24:27], v[212:215]
    s_cmp_ge_u32 s64, 98304
    s_cselect_b32 s63, 4294901760, s59
    s_cselect_b32 s64, 0, s64
    v_mfma_f32_16x16x32_bf16 v[220:223], a[84:87], a[28:31], v[220:223]
    ds_read_b64_tr_b16 a[84:85], v13 offset:16384
    v_mfma_f32_16x16x32_bf16 v[224:227], a[88:91], a[0:3], v[224:227]
    ds_read_b64_tr_b16 a[86:87], v13 offset:18432
    v_mfma_f32_16x16x32_bf16 v[232:235], a[88:91], a[4:7], v[232:235]
    v_mfma_f32_16x16x32_bf16 v[240:243], a[88:91], a[8:11], v[240:243]
    buffer_store_dwordx4 a[228:231], v2, s[24:27], s28 offen sc1
    v_mfma_f32_16x16x32_bf16 v[248:251], a[88:91], a[12:15], v[248:251]
    s_add_u32 s28, s28, s31
    v_mfma_f32_16x16x32_bf16 a[96:99], a[88:91], a[16:19], a[96:99]
    buffer_load_dwordx4 v16, s[40:43], s51 offen offset:2048 sc1 lds
    v_mfma_f32_16x16x32_bf16 a[104:107], a[88:91], a[20:23], a[104:107]
    v_mfma_f32_16x16x32_bf16 a[112:115], a[88:91], a[24:27], a[112:115]
    v_mfma_f32_16x16x32_bf16 a[120:123], a[88:91], a[28:31], a[120:123]
    ds_read_b64_tr_b16 a[88:89], v14 offset:16384
    s_waitcnt lgkmcnt(15)
    v_mfma_f32_16x16x32_bf16 v[228:231], a[92:95], a[0:3], v[228:231]
    ds_read_b64_tr_b16 a[90:91], v14 offset:18432
    v_mfma_f32_16x16x32_bf16 v[236:239], a[92:95], a[4:7], v[236:239]
    v_add_u32 v6, s63, v6
    v_add_u32 v7, s63, v7
    v_mfma_f32_16x16x32_bf16 v[244:247], a[92:95], a[8:11], v[244:247]
    buffer_store_dwordx4 a[232:235], v2, s[24:27], s28 offen sc1
    v_mfma_f32_16x16x32_bf16 v[252:255], a[92:95], a[12:15], v[252:255]
    s_add_u32 s28, s28, s31
    v_mfma_f32_16x16x32_bf16 a[100:103], a[92:95], a[16:19], a[100:103]
    buffer_load_dwordx4 v17, s[40:43], s51 offen offset:3072 sc1 lds
    v_mfma_f32_16x16x32_bf16 a[108:111], a[92:95], a[20:23], a[108:111]
    s_add_u32 s51, s51, 128
    v_mfma_f32_16x16x32_bf16 a[116:119], a[92:95], a[24:27], a[116:119]
    v_mfma_f32_16x16x32_bf16 a[124:127], a[92:95], a[28:31], a[124:127]
    ds_read_b64_tr_b16 a[92:93], v15 offset:16384
    ds_read_b64_tr_b16 a[94:95], v15 offset:18432
    v_mfma_f32_16x16x32_bf16 v[32:35], a[64:67], a[32:35], v[32:35]
    v_xor_b32 v8, s60, v8
    v_xor_b32 v9, s60, v9
    v_mfma_f32_16x16x32_bf16 v[40:43], a[64:67], a[36:39], v[40:43]
    v_xor_b32 v10, s60, v10
    v_xor_b32 v11, s60, v11
    s_waitcnt lgkmcnt(15)
    v_mfma_f32_16x16x32_bf16 v[48:51], a[64:67], a[40:43], v[48:51]
    v_xor_b32 v12, s60, v12
    v_xor_b32 v13, s60, v13
    v_mfma_f32_16x16x32_bf16 v[56:59], a[64:67], a[44:47], v[56:59]
    v_xor_b32 v14, s60, v14
    v_xor_b32 v15, s60, v15
    s_waitcnt lgkmcnt(13)
    v_mfma_f32_16x16x32_bf16 v[64:67], a[64:67], a[48:51], v[64:67]
    s_waitcnt lgkmcnt(12)
    v_mfma_f32_16x16x32_bf16 v[72:75], a[64:67], a[52:55], v[72:75]
    s_waitcnt lgkmcnt(9)
    v_mfma_f32_16x16x32_bf16 v[80:83], a[64:67], a[56:59], v[80:83]
    s_waitcnt vmcnt(16) lgkmcnt(0)
    v_mfma_f32_16x16x32_bf16 v[88:91], a[64:67], a[60:63], v[88:91]
    s_barrier
    ds_read_b64_tr_b16 a[64:65], v8 offset:0
    v_mfma_f32_16x16x32_bf16 v[36:39], a[68:71], a[32:35], v[36:39]
    s_add_u32 m0, s62, 0
    ds_read_b64_tr_b16 a[66:67], v8 offset:2048
    v_mfma_f32_16x16x32_bf16 v[44:47], a[68:71], a[36:39], v[44:47]
    buffer_load_dwordx4 v18, s[44:47], s52 offen offset:0 sc1 lds
    v_mfma_f32_16x16x32_bf16 v[52:55], a[68:71], a[40:43], v[52:55]
    ds_read_b128 a[0:3], v6 offset:0
    v_mfma_f32_16x16x32_bf16 v[60:63], a[68:71], a[44:47], v[60:63]
    v_mfma_f32_16x16x32_bf16 v[68:71], a[68:71], a[48:51], v[68:71]
    v_mfma_f32_16x16x32_bf16 v[76:79], a[68:71], a[52:55], v[76:79]
    buffer_load_dwordx4 v19, s[44:47], s52 offen offset:1024 sc1 lds
    v_mfma_f32_16x16x32_bf16 v[84:87], a[68:71], a[56:59], v[84:87]
    s_add_u32 s52, s52, s56
    ds_read_b128 a[4:7], v6 offset:2048
    v_mfma_f32_16x16x32_bf16 v[92:95], a[68:71], a[60:63], v[92:95]
    ds_read_b64_tr_b16 a[68:69], v9 offset:0
    v_mfma_f32_16x16x32_bf16 v[96:99], a[72:75], a[32:35], v[96:99]
    ds_read_b64_tr_b16 a[70:71], v9 offset:2048
    v_mfma_f32_16x16x32_bf16 v[104:107], a[72:75], a[36:39], v[104:107]
    buffer_load_dwordx4 v18, s[44:47], s53 offen offset:2048 sc1 lds
    v_mfma_f32_16x16x32_bf16 v[112:115], a[72:75], a[40:43], v[112:115]
    ds_read_b128 a[8:11], v6 offset:4096
    v_mfma_f32_16x16x32_bf16 v[120:123], a[72:75], a[44:47], v[120:123]
    v_mfma_f32_16x16x32_bf16 v[128:131], a[72:75], a[48:51], v[128:131]
    v_mfma_f32_16x16x32_bf16 v[136:139], a[72:75], a[52:55], v[136:139]
    buffer_load_dwordx4 v19, s[44:47], s53 offen offset:3072 sc1 lds
    v_mfma_f32_16x16x32_bf16 v[144:147], a[72:75], a[56:59], v[144:147]
    s_add_u32 s53, s53, s56
    ds_read_b128 a[12:15], v6 offset:6144
    v_mfma_f32_16x16x32_bf16 v[152:155], a[72:75], a[60:63], v[152:155]
    ds_read_b64_tr_b16 a[72:73], v10 offset:0
    v_mfma_f32_16x16x32_bf16 v[100:103], a[76:79], a[32:35], v[100:103]
    s_add_u32 m0, s62, 4096
    ds_read_b64_tr_b16 a[74:75], v10 offset:2048
    v_mfma_f32_16x16x32_bf16 v[108:111], a[76:79], a[36:39], v[108:111]
    buffer_load_dwordx4 v20, s[44:47], s54 offen offset:0 sc1 lds
    v_mfma_f32_16x16x32_bf16 v[116:119], a[76:79], a[40:43], v[116:119]
    ds_read_b128 a[16:19], v6 offset:8192
    v_mfma_f32_16x16x32_bf16 v[124:127], a[76:79], a[44:47], v[124:127]
    s_xor_b32 s62, s62, 229376
    v_mfma_f32_16x16x32_bf16 v[132:135], a[76:79], a[48:51], v[132:135]
    v_mfma_f32_16x16x32_bf16 v[140:143], a[76:79], a[52:55], v[140:143]
    buffer_load_dwordx4 v21, s[44:47], s54 offen offset:1024 sc1 lds
    v_mfma_f32_16x16x32_bf16 v[148:151], a[76:79], a[56:59], v[148:151]
    s_add_u32 s54, s54, s56
    ds_read_b128 a[20:23], v6 offset:10240
    v_mfma_f32_16x16x32_bf16 v[156:159], a[76:79], a[60:63], v[156:159]
    ds_read_b64_tr_b16 a[76:77], v11 offset:0
    v_mfma_f32_16x16x32_bf16 v[160:163], a[80:83], a[32:35], v[160:163]
    ds_read_b64_tr_b16 a[78:79], v11 offset:2048
    v_mfma_f32_16x16x32_bf16 v[168:171], a[80:83], a[36:39], v[168:171]
    buffer_load_dwordx4 v20, s[44:47], s55 offen offset:2048 sc1 lds
    v_mfma_f32_16x16x32_bf16 v[176:179], a[80:83], a[40:43], v[176:179]
    ds_read_b128 a[24:27], v6 offset:12288
    v_mfma_f32_16x16x32_bf16 v[184:187], a[80:83], a[44:47], v[184:187]
    v_mfma_f32_16x16x32_bf16 v[192:195], a[80:83], a[48:51], v[192:195]
    v_mfma_f32_16x16x32_bf16 v[200:203], a[80:83], a[52:55], v[200:203]
    buffer_load_dwordx4 v21, s[44:47], s55 offen offset:3072 sc1 lds
    v_mfma_f32_16x16x32_bf16 v[208:211], a[80:83], a[56:59], v[208:211]
    s_add_u32 s55, s55, s56
    ds_read_b128 a[28:31], v6 offset:14336
    v_mfma_f32_16x16x32_bf16 v[216:219], a[80:83], a[60:63], v[216:219]
    ds_read_b64_tr_b16 a[80:81], v12 offset:0
    v_mfma_f32_16x16x32_bf16 v[164:167], a[84:87], a[32:35], v[164:167]
    ds_read_b64_tr_b16 a[82:83], v12 offset:2048
    v_mfma_f32_16x16x32_bf16 v[172:175], a[84:87], a[36:39], v[172:175]
    v_mfma_f32_16x16x32_bf16 v[180:183], a[84:87], a[40:43], v[180:183]
    buffer_store_dwordx4 a[236:239], v2, s[24:27], s28 offen sc1
    v_mfma_f32_16x16x32_bf16 v[188:191], a[84:87], a[44:47], v[188:191]
    s_add_u32 s28, s28, s31
    v_mfma_f32_16x16x32_bf16 v[196:199], a[84:87], a[48:51], v[196:199]
    v_mfma_f32_16x16x32_bf16 v[204:207], a[84:87], a[52:55], v[204:207]
    v_mfma_f32_16x16x32_bf16 v[212:215], a[84:87], a[56:59], v[212:215]
    buffer_store_dwordx4 a[240:243], v2, s[24:27], s28 offen sc1
    v_mfma_f32_16x16x32_bf16 v[220:223], a[84:87], a[60:63], v[220:223]
    s_add_u32 s28, s28, s31
    ds_read_b64_tr_b16 a[84:85], v13 offset:0
    v_mfma_f32_16x16x32_bf16 v[224:227], a[88:91], a[32:35], v[224:227]
    ds_read_b64_tr_b16 a[86:87], v13 offset:2048
    v_mfma_f32_16x16x32_bf16 v[232:235], a[88:91], a[36:39], v[232:235]
    v_mfma_f32_16x16x32_bf16 v[240:243], a[88:91], a[40:43], v[240:243]
    buffer_store_dwordx4 a[244:247], v2, s[24:27], s28 offen sc1
    v_mfma_f32_16x16x32_bf16 v[248:251], a[88:91], a[44:47], v[248:251]
    s_add_u32 s28, s28, s31
    v_mfma_f32_16x16x32_bf16 a[96:99], a[88:91], a[48:51], a[96:99]
    v_mfma_f32_16x16x32_bf16 a[104:107], a[88:91], a[52:55], a[104:107]
    v_mfma_f32_16x16x32_bf16 a[112:115], a[88:91], a[56:59], a[112:115]
    buffer_store_dwordx4 a[248:251], v2, s[24:27], s28 offen sc1
    v_mfma_f32_16x16x32_bf16 a[120:123], a[88:91], a[60:63], a[120:123]
    s_add_u32 s28, s28, s31
    ds_read_b64_tr_b16 a[88:89], v14 offset:0
    v_mfma_f32_16x16x32_bf16 v[228:231], a[92:95], a[32:35], v[228:231]
    ds_read_b64_tr_b16 a[90:91], v14 offset:2048
    v_mfma_f32_16x16x32_bf16 v[236:239], a[92:95], a[36:39], v[236:239]
    v_mfma_f32_16x16x32_bf16 v[244:247], a[92:95], a[40:43], v[244:247]
    buffer_store_dwordx4 a[252:255], v2, s[24:27], s28 offen sc1
    v_mfma_f32_16x16x32_bf16 v[252:255], a[92:95], a[44:47], v[252:255]
    s_add_u32 s29, s29, s30
    s_mov_b32 s28, s29
    v_mfma_f32_16x16x32_bf16 a[100:103], a[92:95], a[48:51], a[100:103]
    s_sub_u32 s65, s65, 1
    v_mfma_f32_16x16x32_bf16 a[108:111], a[92:95], a[52:55], a[108:111]
    v_mfma_f32_16x16x32_bf16 a[116:119], a[92:95], a[56:59], a[116:119]
    v_mfma_f32_16x16x32_bf16 a[124:127], a[92:95], a[60:63], a[124:127]
    ds_read_b64_tr_b16 a[92:93], v15 offset:0
    ds_read_b64_tr_b16 a[94:95], v15 offset:2048
m_loop16:
    s_waitcnt lgkmcnt(15)
    v_mfma_f32_16x16x32_bf16 v[32:35], a[64:67], a[0:3], v[32:35]
    v_mfma_f32_16x16x32_bf16 v[40:43], a[64:67], a[4:7], v[40:43]
    v_mfma_f32_16x16x32_bf16 v[48:51], a[64:67], a[8:11], v[48:51]
    v_mfma_f32_16x16x32_bf16 v[56:59], a[64:67], a[12:15], v[56:59]
    s_add_u32 m0, s61, 0
    s_waitcnt lgkmcnt(13)
    v_mfma_f32_16x16x32_bf16 v[64:67], a[64:67], a[16:19], v[64:67]
    buffer_load_dwordx4 v16, s[40:43], s48 offen offset:0 sc1 lds
    s_waitcnt lgkmcnt(12)
    v_mfma_f32_16x16x32_bf16 v[72:75], a[64:67], a[20:23], v[72:75]
    s_waitcnt lgkmcnt(9)
    v_mfma_f32_16x16x32_bf16 v[80:83], a[64:67], a[24:27], v[80:83]
    s_waitcnt lgkmcnt(8)
    v_mfma_f32_16x16x32_bf16 v[88:91], a[64:67], a[28:31], v[88:91]
    ds_read_b64_tr_b16 a[64:65], v8 offset:16384
    v_mfma_f32_16x16x32_bf16 v[36:39], a[68:71], a[0:3], v[36:39]
    ds_read_b64_tr_b16 a[66:67], v8 offset:18432
    v_mfma_f32_16x16x32_bf16 v[44:47], a[68:71], a[4:7], v[44:47]
    v_mfma_f32_16x16x32_bf16 v[52:55], a[68:71], a[8:11], v[52:55]
    ds_read_b128 a[32:35], v7 offset:0
    v_mfma_f32_16x16x32_bf16 v[60:63], a[68:71], a[12:15], v[60:63]
    v_mfma_f32_16x16x32_bf16 v[68:71], a[68:71], a[16:19], v[68:71]
    buffer_load_dwordx4 v17, s[40:43], s48 offen offset:1024 sc1 lds
    v_mfma_f32_16x16x32_bf16 v[76:79], a[68:71], a[20:23], v[76:79]
    s_add_u32 s48, s48, 128
    v_mfma_f32_16x16x32_bf16 v[84:87], a[68:71], a[24:27], v[84:87]
    ds_read_b128 a[36:39], v7 offset:2048
    v_mfma_f32_16x16x32_bf16 v[92:95], a[68:71], a[28:31], v[92:95]
    ds_read_b64_tr_b16 a[68:69], v9 offset:16384
    v_mfma_f32_16x16x32_bf16 v[96:99], a[72:75], a[0:3], v[96:99]
    ds_read_b64_tr_b16 a[70:71], v9 offset:18432
    v_mfma_f32_16x16x32_bf16 v[104:107], a[72:75], a[4:7], v[104:107]
    v_mfma_f32_16x16x32_bf16 v[112:115], a[72:75], a[8:11], v[112:115]
    ds_read_b128 a[40:43], v7 offset:4096
    v_mfma_f32_16x16x32_bf16 v[120:123], a[72:75], a[12:15], v[120:123]
    v_mfma_f32_16x16x32_bf16 v[128:131], a[72:75], a[16:19], v[128:131]
    buffer_load_dwordx4 v16, s[40:43], s49 offen offset:2048 sc1 lds
    v_mfma_f32_16x16x32_bf16 v[136:139], a[72:75], a[20:23], v[136:139]
    v_mfma_f32_16x16x32_bf16 v[144:147], a[72:75], a[24:27], v[144:147]
    ds_read_b128 a[44:47], v7 offset:6144
    v_mfma_f32_16x16x32_bf16 v[152:155], a[72:75], a[28:31], v[152:155]
    ds_read_b64_tr_b16 a[72:73], v10 offset:16384
    v_mfma_f32_16x16x32_bf16 v[100:103], a[76:79], a[0:3], v[100:103]
    ds_read_b64_tr_b16 a[74:75], v10 offset:18432
    v_mfma_f32_16x16x32_bf16 v[108:111], a[76:79], a[4:7], v[108:111]
    v_mfma_f32_16x16x32_bf16 v[116:119], a[76:79], a[8:11], v[116:119]
    ds_read_b128 a[48:51], v7 offset:8192
    v_mfma_f32_16x16x32_bf16 v[124:127], a[76:79], a[12:15], v[124:127]
    v_mfma_f32_16x16x32_bf16 v[132:135], a[76:79], a[16:19], v[132:135]
    buffer_load_dwordx4 v17, s[40:43], s49 offen offset:3072 sc1 lds
    v_mfma_f32_16x16x32_bf16 v[140:143], a[76:79], a[20:23], v[140:143]
    s_add_u32 s49, s49, 128
    v_mfma_f32_16x16x32_bf16 v[148:151], a[76:79], a[24:27], v[148:151]
    ds_read_b128 a[52:55], v7 offset:10240
    v_mfma_f32_16x16x32_bf16 v[156:159], a[76:79], a[28:31], v[156:159]
    ds_read_b64_tr_b16 a[76:77], v11 offset:16384
    s_waitcnt lgkmcnt(15)
    v_mfma_f32_16x16x32_bf16 v[160:163], a[80:83], a[0:3], v[160:163]
    ds_read_b64_tr_b16 a[78:79], v11 offset:18432
    v_mfma_f32_16x16x32_bf16 v[168:171], a[80:83], a[4:7], v[168:171]
    v_mfma_f32_16x16x32_bf16 v[176:179], a[80:83], a[8:11], v[176:179]
    ds_read_b128 a[56:59], v7 offset:12288
    v_mfma_f32_16x16x32_bf16 v[184:187], a[80:83], a[12:15], v[184:187]
    s_add_u32 m0, s61, 4096
    v_mfma_f32_16x16x32_bf16 v[192:195], a[80:83], a[16:19], v[192:195]
    buffer_load_dwordx4 v16, s[40:43], s50 offen offset:0 sc1 lds
    v_mfma_f32_16x16x32_bf16 v[200:203], a[80:83], a[20:23], v[200:203]
    v_mfma_f32_16x16x32_bf16 v[208:211], a[80:83], a[24:27], v[208:211]
    s_add_u32 s61, s61, 32768
    ds_read_b128 a[60:63], v7 offset:14336
    v_mfma_f32_16x16x32_bf16 v[216:219], a[80:83], a[28:31], v[216:219]
    s_cmp_ge_u32 s61, 98304
    s_cselect_b32 s90, 98304, 0
    ds_read_b64_tr_b16 a[80:81], v12 offset:16384
    v_mfma_f32_16x16x32_bf16 v[164:167], a[84:87], a[0:3], v[164:167]
    s_sub_u32 s61, s61, s90
    ds_read_b64_tr_b16 a[82:83], v12 offset:18432
    v_mfma_f32_16x16x32_bf16 v[172:175], a[84:87], a[4:7], v[172:175]
    s_add_u32 s64, s64, 32768
    v_mfma_f32_16x16x32_bf16 v[180:183], a[84:87], a[8:11], v[180:183]
    s_cmp_ge_u32 s64, 98304
    s_cselect_b32 s63, 4294901760, s59
    s_cselect_b32 s64, 0, s64
    v_mfma_f32_16x16x32_bf16 v[188:191], a[84:87], a[12:15], v[188:191]
    v_mfma_f32_16x16x32_bf16 v[196:199], a[84:87], a[16:19], v[196:199]
    buffer_load_dwordx4 v17, s[40:43], s50 offen offset:1024 sc1 lds
    v_mfma_f32_16x16x32_bf16 v[204:207], a[84:87], a[20:23], v[204:207]
    s_add_u32 s50, s50, 128
    v_mfma_f32_16x16x32_bf16 v[212:215], a[84:87], a[24:27], v[212:215]
    v_mfma_f32_16x16x32_bf16 v[220:223], a[84:87], a[28:31], v[220:223]
    ds_read_b64_tr_b16 a[84:85], v13 offset:16384
    v_mfma_f32_16x16x32_bf16 v[224:227], a[88:91], a[0:3], v[224:227]
    ds_read_b64_tr_b16 a[86:87], v13 offset:18432
    v_mfma_f32_16x16x32_bf16 v[232:235], a[88:91], a[4:7], v[232:235]
    v_mfma_f32_16x16x32_bf16 v[240:243], a[88:91], a[8:11], v[240:243]
    v_mfma_f32_16x16x32_bf16 v[248:251], a[88:91], a[12:15], v[248:251]
    v_mfma_f32_16x16x32_bf16 a[96:99], a[88:91], a[16:19], a[96:99]
    buffer_load_dwordx4 v16, s[40:43], s51 offen offset:2048 sc1 lds
    v_mfma_f32_16x16x32_bf16 a[104:107], a[88:91], a[20:23], a[104:107]
    v_mfma_f32_16x16x32_bf16 a[112:115], a[88:91], a[24:27], a[112:115]
    v_mfma_f32_16x16x32_bf16 a[120:123], a[88:91], a[28:31], a[120:123]
    ds_read_b64_tr_b16 a[88:89], v14 offset:16384
    s_waitcnt lgkmcnt(15)
    v_mfma_f32_16x16x32_bf16 v[228:231], a[92:95], a[0:3], v[228:231]
    ds_read_b64_tr_b16 a[90:91], v14 offset:18432
    v_mfma_f32_16x16x32_bf16 v[236:239], a[92:95], a[4:7], v[236:239]
    v_add_u32 v6, s63, v6
    v_add_u32 v7, s63, v7
    v_mfma_f32_16x16x32_bf16 v[244:247], a[92:95], a[8:11], v[244:247]
    v_mfma_f32_16x16x32_bf16 v[252:255], a[92:95], a[12:15], v[252:255]
    v_mfma_f32_16x16x32_bf16 a[100:103], a[92:95], a[16:19], a[100:103]
    buffer_load_dwordx4 v17, s[40:43], s51 offen offset:3072 sc1 lds
    v_mfma_f32_16x16x32_bf16 a[108:111], a[92:95], a[20:23], a[108:111]
    s_add_u32 s51, s51, 128
    v_mfma_f32_16x16x32_bf16 a[116:119], a[92:95], a[24:27], a[116:119]
    v_mfma_f32_16x16x32_bf16 a[124:127], a[92:95], a[28:31], a[124:127]
    ds_read_b64_tr_b16 a[92:93], v15 offset:16384
    ds_read_b64_tr_b16 a[94:95], v15 offset:18432
    v_mfma_f32_16x16x32_bf16 v[32:35], a[64:67], a[32:35], v[32:35]
    v_xor_b32 v8, s60, v8
    v_xor_b32 v9, s60, v9
    v_mfma_f32_16x16x32_bf16 v[40:43], a[64:67], a[36:39], v[40:43]
    v_xor_b32 v10, s60, v10
    v_xor_b32 v11, s60, v11
    s_waitcnt lgkmcnt(15)
    v_mfma_f32_16x16x32_bf16 v[48:51], a[64:67], a[40:43], v[48:51]
    v_xor_b32 v12, s60, v12
    v_xor_b32 v13, s60, v13
    v_mfma_f32_16x16x32_bf16 v[56:59], a[64:67], a[44:47], v[56:59]
    v_xor_b32 v14, s60, v14
    v_xor_b32 v15, s60, v15
    s_waitcnt lgkmcnt(13)
    v_mfma_f32_16x16x32_bf16 v[64:67], a[64:67], a[48:51], v[64:67]
    s_waitcnt lgkmcnt(12)
    v_mfma_f32_16x16x32_bf16 v[72:75], a[64:67], a[52:55], v[72:75]
    s_waitcnt lgkmcnt(9)
    v_mfma_f32_16x16x32_bf16 v[80:83], a[64:67], a[56:59], v[80:83]
    s_waitcnt vmcnt(8) lgkmcnt(0)
    v_mfma_f32_16x16x32_bf16 v[88:91], a[64:67], a[60:63], v[88:91]
    s_barrier
    ds_read_b64_tr_b16 a[64:65], v8 offset:0
    v_mfma_f32_16x16x32_bf16 v[36:39], a[68:71], a[32:35], v[36:39]
    s_add_u32 m0, s62, 0
    ds_read_b64_tr_b16 a[66:67], v8 offset:2048
    v_mfma_f32_16x16x32_bf16 v[44:47], a[68:71], a[36:39], v[44:47]
    buffer_load_dwordx4 v18, s[44:47], s52 offen offset:0 sc1 lds
    v_mfma_f32_16x16x32_bf16 v[52:55], a[68:71], a[40:43], v[52:55]
    ds_read_b128 a[0:3], v6 offset:0
    v_mfma_f32_16x16x32_bf16 v[60:63], a[68:71], a[44:47], v[60:63]
    v_mfma_f32_16x16x32_bf16 v[68:71], a[68:71], a[48:51], v[68:71]
    v_mfma_f32_16x16x32_bf16 v[76:79], a[68:71], a[52:55], v[76:79]
    buffer_load_dwordx4 v19, s[44:47], s52 offen offset:1024 sc1 lds
    v_mfma_f32_16x16x32_bf16 v[84:87], a[68:71], a[56:59], v[84:87]
    s_add_u32 s52, s52, s56
    ds_read_b128 a[4:7], v6 offset:2048
    v_mfma_f32_16x16x32_bf16 v[92:95], a[68:71], a[60:63], v[92:95]
    ds_read_b64_tr_b16 a[68:69], v9 offset:0
    v_mfma_f32_16x16x32_bf16 v[96:99], a[72:75], a[32:35], v[96:99]
    ds_read_b64_tr_b16 a[70:71], v9 offset:2048
    v_mfma_f32_16x16x32_bf16 v[104:107], a[72:75], a[36:39], v[104:107]
    buffer_load_dwordx4 v18, s[44:47], s53 offen offset:2048 sc1 lds
    v_mfma_f32_16x16x32_bf16 v[112:115], a[72:75], a[40:43], v[112:115]
    ds_read_b128 a[8:11], v6 offset:4096
    v_mfma_f32_16x16x32_bf16 v[120:123], a[72:75], a[44:47], v[120:123]
    v_mfma_f32_16x16x32_bf16 v[128:131], a[72:75], a[48:51], v[128:131]
    v_mfma_f32_16x16x32_bf16 v[136:139], a[72:75], a[52:55], v[136:139]
    buffer_load_dwordx4 v19, s[44:47], s53 offen offset:3072 sc1 lds
    v_mfma_f32_16x16x32_bf16 v[144:147], a[72:75], a[56:59], v[144:147]
    s_add_u32 s53, s53, s56
    ds_read_b128 a[12:15], v6 offset:6144
    v_mfma_f32_16x16x32_bf16 v[152:155], a[72:75], a[60:63], v[152:155]
    ds_read_b64_tr_b16 a[72:73], v10 offset:0
    v_mfma_f32_16x16x32_bf16 v[100:103], a[76:79], a[32:35], v[100:103]
    s_add_u32 m0, s62, 4096
    ds_read_b64_tr_b16 a[74:75], v10 offset:2048
    v_mfma_f32_16x16x32_bf16 v[108:111], a[76:79], a[36:39], v[108:111]
    buffer_load_dwordx4 v20, s[44:47], s54 offen offset:0 sc1 lds
    v_mfma_f32_16x16x32_bf16 v[116:119], a[76:79], a[40:43], v[116:119]
    ds_read_b128 a[16:19], v6 offset:8192
    v_mfma_f32_16x16x32_bf16 v[124:127], a[76:79], a[44:47], v[124:127]
    s_xor_b32 s62, s62, 229376
    v_mfma_f32_16x16x32_bf16 v[132:135], a[76:79], a[48:51], v[132:135]
    v_mfma_f32_16x16x32_bf16 v[140:143], a[76:79], a[52:55], v[140:143]
    buffer_load_dwordx4 v21, s[44:47], s54 offen offset:1024 sc1 lds
    v_mfma_f32_16x16x32_bf16 v[148:151], a[76:79], a[56:59], v[148:151]
    s_add_u32 s54, s54, s56
    ds_read_b128 a[20:23], v6 offset:10240
    v_mfma_f32_16x16x32_bf16 v[156:159], a[76:79], a[60:63], v[156:159]
    ds_read_b64_tr_b16 a[76:77], v11 offset:0
    v_mfma_f32_16x16x32_bf16 v[160:163], a[80:83], a[32:35], v[160:163]
    ds_read_b64_tr_b16 a[78:79], v11 offset:2048
    v_mfma_f32_16x16x32_bf16 v[168:171], a[80:83], a[36:39], v[168:171]
    buffer_load_dwordx4 v20, s[44:47], s55 offen offset:2048 sc1 lds
    v_mfma_f32_16x16x32_bf16 v[176:179], a[80:83], a[40:43], v[176:179]
    ds_read_b128 a[24:27], v6 offset:12288
    v_mfma_f32_16x16x32_bf16 v[184:187], a[80:83], a[44:47], v[184:187]
    v_mfma_f32_16x16x32_bf16 v[192:195], a[80:83], a[48:51], v[192:195]
    v_mfma_f32_16x16x32_bf16 v[200:203], a[80:83], a[52:55], v[200:203]
    buffer_load_dwordx4 v21, s[44:47], s55 offen offset:3072 sc1 lds
    v_mfma_f32_16x16x32_bf16 v[208:211], a[80:83], a[56:59], v[208:211]
    s_add_u32 s55, s55, s56
    ds_read_b128 a[28:31], v6 offset:14336
    v_mfma_f32_16x16x32_bf16 v[216:219], a[80:83], a[60:63], v[216:219]
    ds_read_b64_tr_b16 a[80:81], v12 offset:0
    v_mfma_f32_16x16x32_bf16 v[164:167], a[84:87], a[32:35], v[164:167]
    ds_read_b64_tr_b16 a[82:83], v12 offset:2048
    v_mfma_f32_16x16x32_bf16 v[172:175], a[84:87], a[36:39], v[172:175]
    v_mfma_f32_16x16x32_bf16 v[180:183], a[84:87], a[40:43], v[180:183]
    v_mfma_f32_16x16x32_bf16 v[188:191], a[84:87], a[44:47], v[188:191]
    v_mfma_f32_16x16x32_bf16 v[196:199], a[84:87], a[48:51], v[196:199]
    v_mfma_f32_16x16x32_bf16 v[204:207], a[84:87], a[52:55], v[204:207]
    v_mfma_f32_16x16x32_bf16 v[212:215], a[84:87], a[56:59], v[212:215]
    v_mfma_f32_16x16x32_bf16 v[220:223], a[84:87], a[60:63], v[220:223]
    ds_read_b64_tr_b16 a[84:85], v13 offset:0
    v_mfma_f32_16x16x32_bf16 v[224:227], a[88:91], a[32:35], v[224:227]
    ds_read_b64_tr_b16 a[86:87], v13 offset:2048
    v_mfma_f32_16x16x32_bf16 v[232:235], a[88:91], a[36:39], v[232:235]
    v_mfma_f32_16x16x32_bf16 v[240:243], a[88:91], a[40:43], v[240:243]
    v_mfma_f32_16x16x32_bf16 v[248:251], a[88:91], a[44:47], v[248:251]
    v_mfma_f32_16x16x32_bf16 a[96:99], a[88:91], a[48:51], a[96:99]
    v_mfma_f32_16x16x32_bf16 a[104:107], a[88:91], a[52:55], a[104:107]
    v_mfma_f32_16x16x32_bf16 a[112:115], a[88:91], a[56:59], a[112:115]
    v_mfma_f32_16x16x32_bf16 a[120:123], a[88:91], a[60:63], a[120:123]
    ds_read_b64_tr_b16 a[88:89], v14 offset:0
    v_mfma_f32_16x16x32_bf16 v[228:231], a[92:95], a[32:35], v[228:231]
    ds_read_b64_tr_b16 a[90:91], v14 offset:2048
    v_mfma_f32_16x16x32_bf16 v[236:239], a[92:95], a[36:39], v[236:239]
    v_mfma_f32_16x16x32_bf16 v[244:247], a[92:95], a[40:43], v[244:247]
    v_mfma_f32_16x16x32_bf16 v[252:255], a[92:95], a[44:47], v[252:255]
    v_mfma_f32_16x16x32_bf16 a[100:103], a[92:95], a[48:51], a[100:103]
    s_sub_u32 s65, s65, 1
    v_mfma_f32_16x16x32_bf16 a[108:111], a[92:95], a[52:55], a[108:111]
    v_mfma_f32_16x16x32_bf16 a[116:119], a[92:95], a[56:59], a[116:119]
    s_cmp_gt_u32 s65, s67
    v_mfma_f32_16x16x32_bf16 a[124:127], a[92:95], a[60:63], a[124:127]
    ds_read_b64_tr_b16 a[92:93], v15 offset:0
    ds_read_b64_tr_b16 a[94:95], v15 offset:2048
    s_cbranch_scc1 m_loop16
    s_cmp_lg_u32 s65, 0
    s_cbranch_scc1 m_dosw17
    s_branch m_epi12
m_swp13:
    s_waitcnt lgkmcnt(15)
    v_mfma_f32_16x16x32_bf16 v[32:35], a[0:3], a[64:67], 0
    v_mfma_f32_16x16x32_bf16 v[36:39], a[4:7], a[64:67], 0
    v_mfma_f32_16x16x32_bf16 v[96:99], a[8:11], a[64:67], 0
    v_mfma_f32_16x16x32_bf16 v[100:103], a[12:15], a[64:67], 0
    s_add_u32 m0, s61, 0
    s_waitcnt lgkmcnt(13)
    v_mfma_f32_16x16x32_bf16 v[160:163], a[16:19], a[64:67], 0
    buffer_load_dwordx4 v16, s[40:43], s48 offen offset:0 sc1 lds
    s_waitcnt lgkmcnt(12)
    v_mfma_f32_16x16x32_bf16 v[164:167], a[20:23], a[64:67], 0
    s_waitcnt lgkmcnt(9)
    v_mfma_f32_16x16x32_bf16 v[224:227], a[24:27], a[64:67], 0
    s_waitcnt lgkmcnt(8)
    v_mfma_f32_16x16x32_bf16 v[228:231], a[28:31], a[64:67], 0
    ds_read_b64_tr_b16 a[64:65], v8 offset:16384
    v_mfma_f32_16x16x32_bf16 v[40:43], a[0:3], a[68:71], 0
    ds_read_b64_tr_b16 a[66:67], v8 offset:18432
    v_mfma_f32_16x16x32_bf16 v[44:47], a[4:7], a[68:71], 0
    v_mfma_f32_16x16x32_bf16 v[104:107], a[8:11], a[68:71], 0
    ds_read_b128 a[32:35], v7 offset:0
    v_mfma_f32_16x16x32_bf16 v[108:111], a[12:15], a[68:71], 0
    v_mfma_f32_16x16x32_bf16 v[168:171], a[16:19], a[68:71], 0
    buffer_load_dwordx4 v17, s[40:43], s48 offen offset:1024 sc1 lds
    v_mfma_f32_16x16x32_bf16 v[172:175], a[20:23], a[68:71], 0
    s_add_u32 s48, s48, 128
    v_mfma_f32_16x16x32_bf16 v[232:235], a[24:27], a[68:71], 0
    ds_read_b128 a[36:39], v7 offset:2048
    v_mfma_f32_16x16x32_bf16 v[236:239], a[28:31], a[68:71], 0
    ds_read_b64_tr_b16 a[68:69], v9 offset:16384
    v_mfma_f32_16x16x32_bf16 v[48:51], a[0:3], a[72:75], 0
    ds_read_b64_tr_b16 a[70:71], v9 offset:18432
    v_mfma_f32_16x16x32_bf16 v[52:55], a[4:7], a[72:75], 0
    v_mfma_f32_16x16x32_bf16 v[112:115], a[8:11], a[72:75], 0
    ds_read_b128 a[40:43], v7 offset:4096
    v_mfma_f32_16x16x32_bf16 v[116:119], a[12:15], a[72:75], 0
    v_mfma_f32_16x16x32_bf16 v[176:179], a[16:19], a[72:75], 0
    buffer_load_dwordx4 v16, s[40:43], s49 offen offset:2048 sc1 lds
    v_mfma_f32_16x16x32_bf16 v[180:183], a[20:23], a[72:75], 0
    v_mfma_f32_16x16x32_bf16 v[240:243], a[24:27], a[72:75], 0
    ds_read_b128 a[44:47], v7 offset:6144
    v_mfma_f32_16x16x32_bf16 v[244:247], a[28:31], a[72:75], 0
    ds_read_b64_tr_b16 a[72:73], v10 offset:16384
    v_mfma_f32_16x16x32_bf16 v[56:59], a[0:3], a[76:79], 0
    ds_read_b64_tr_b16 a[74:75], v10 offset:18432
    v_mfma_f32_16x16x32_bf16 v[60:63], a[4:7], a[76:79], 0
    v_mfma_f32_16x16x32_bf16 v[120:123], a[8:11], a[76:79], 0
    ds_read_b128 a[48:51], v7 offset:8192
    v_mfma_f32_16x16x32_bf16 v[124:127], a[12:15], a[76:79], 0
    v_mfma_f32_16x16x32_bf16 v[184:187], a[16:19], a[76:79], 0
    buffer_load_dwordx4 v17, s[40:43], s49 offen offset:3072 sc1 lds
    v_mfma_f32_16x16x32_bf16 v[188:191], a[20:23], a[76:79], 0
    s_add_u32 s49, s49, 128
    v_mfma_f32_16x16x32_bf16 v[248:251], a[24:27], a[76:79], 0
    ds_read_b128 a[52:55], v7 offset:10240
    v_mfma_f32_16x16x32_bf16 v[252:255], a[28:31], a[76:79], 0
    ds_read_b64_tr_b16 a[76:77], v11 offset:16384
    s_waitcnt lgkmcnt(15)
    v_mfma_f32_16x16x32_bf16 v[64:67], a[0:3], a[80:83], 0
    ds_read_b64_tr_b16 a[78:79], v11 offset:18432
    v_mfma_f32_16x16x32_bf16 v[68:71], a[4:7], a[80:83], 0
    v_mfma_f32_16x16x32_bf16 v[128:131], a[8:11], a[80:83], 0
    ds_read_b128 a[56:59], v7 offset:12288
    v_mfma_f32_16x16x32_bf16 v[132:135], a[12:15], a[80:83], 0
    s_add_u32 m0, s61, 4096
    v_mfma_f32_16x16x32_bf16 v[192:195], a[16:19], a[80:83], 0
    buffer_load_dwordx4 v16, s[40:43], s50 offen offset:0 sc1 lds
    v_mfma_f32_16x16x32_bf16 v[196:199], a[20:23], a[80:83], 0
    v_mfma_f32_16x16x32_bf16 a[96:99], a[24:27], a[80:83], 0
    s_add_u32 s61, s61, 32768
    ds_read_b128 a[60:63], v7 offset:14336
    v_mfma_f32_16x16x32_bf16 a[100:103], a[28:31], a[80:83], 0
    s_cmp_ge_u32 s61, 98304
    s_cselect_b32 s90, 98304, 0
    ds_read_b64_tr_b16 a[80:81], v12 offset:16384
    v_mfma_f32_16x16x32_bf16 v[72:75], a[0:3], a[84:87], 0
    s_sub_u32 s61, s61, s90
    ds_read_b64_tr_b16 a[82:83], v12 offset:18432
    v_mfma_f32_16x16x32_bf16 v[76:79], a[4:7], a[84:87], 0
    s_add_u32 s64, s64, 32768
    v_mfma_f32_16x16x32_bf16 v[136:139], a[8:11], a[84:87], 0
    buffer_store_dwordx4 a[128:131], v2, s[24:27], s28 offen sc1
    v_mfma_f32_16x16x32_bf16 v[140:143], a[12:15], a[84:87], 0
    s_add_u32 s28, s28, s31
    v_mfma_f32_16x16x32_bf16 v[200:203], a[16:19], a[84:87], 0
    buffer_load_dwordx4 v17, s[40:43], s50 offen offset:1024 sc1 lds
    v_mfma_f32_16x16x32_bf16 v[204:207], a[20:23], a[84:87], 0
    s_add_u32 s50, s50, 128
    v_mfma_f32_16x16x32_bf16 a[104:107], a[24:27], a[84:87], 0
    s_cmp_ge_u32 s64, 98304
    s_cselect_b32 s63, 4294901760, s59
    s_cselect_b32 s64, 0, s64
    v_mfma_f32_16x16x32_bf16 a[108:111], a[28:31], a[84:87], 0
    ds_read_b64_tr_b16 a[84:85], v13 offset:16384
    v_mfma_f32_16x16x32_bf16 v[80:83], a[0:3], a[88:91], 0
    ds_read_b64_tr_b16 a[86:87], v13 offset:18432
    v_mfma_f32_16x16x32_bf16 v[84:87], a[4:7], a[88:91], 0
    v_mfma_f32_16x16x32_bf16 v[144:147], a[8:11], a[88:91], 0
    buffer_store_dwordx4 a[132:135], v2, s[24:27], s28 offen sc1
    v_mfma_f32_16x16x32_bf16 v[148:151], a[12:15], a[88:91], 0
    s_add_u32 s28, s28, s31
    v_mfma_f32_16x16x32_bf16 v[208:211], a[16:19], a[88:91], 0
    buffer_load_dwordx4 v16, s[40:43], s51 offen offset:2048 sc1 lds
    v_mfma_f32_16x16x32_bf16 v[212:215], a[20:23], a[88:91], 0
    v_mfma_f32_16x16x32_bf16 a[112:115], a[24:27], a[88:91], 0
    v_mfma_f32_16x16x32_bf16 a[116:119], a[28:31], a[88:91], 0
    ds_read_b64_tr_b16 a[88:89], v14 offset:16384
    s_waitcnt lgkmcnt(15)
    v_mfma_f32_16x16x32_bf16 v[88:91], a[0:3], a[92:95], 0
    ds_read_b64_tr_b16 a[90:91], v14 offset:18432
    v_mfma_f32_16x16x32_bf16 v[92:95], a[4:7], a[92:95], 0
    v_add_u32 v6, s63, v6
    v_add_u32 v7, s63, v7
    v_mfma_f32_16x16x32_bf16 v[152:155], a[8:11], a[92:95], 0
    buffer_store_dwordx4 a[136:139], v2, s[24:27], s28 offen sc1
    v_mfma_f32_16x16x32_bf16 v[156:159], a[12:15], a[92:95], 0
    s_add_u32 s28, s28, s31
    v_mfma_f32_16x16x32_bf16 v[216:219], a[16:19], a[92:95], 0
    buffer_load_dwordx4 v17, s[40:43], s51 offen offset:3072 sc1 lds
    v_mfma_f32_16x16x32_bf16 v[220:223], a[20:23], a[92:95], 0
    s_add_u32 s51, s51, 128
    v_mfma_f32_16x16x32_bf16 a[120:123], a[24:27], a[92:95], 0
    v_mfma_f32_16x16x32_bf16 a[124:127], a[28:31], a[92:95], 0
    ds_read_b64_tr_b16 a[92:93], v15 offset:16384
    ds_read_b64_tr_b16 a[94:95], v15 offset:18432
    v_mfma_f32_16x16x32_bf16 v[32:35], a[32:35], a[64:67], v[32:35]
    v_xor_b32 v8, s60, v8
    v_xor_b32 v9, s60, v9
    v_mfma_f32_16x16x32_bf16 v[36:39], a[36:39], a[64:67], v[36:39]
    v_xor_b32 v10, s60, v10
    v_xor_b32 v11, s60, v11
    s_waitcnt lgkmcnt(15)
    v_mfma_f32_16x16x32_bf16 v[96:99], a[40:43], a[64:67], v[96:99]
    v_xor_b32 v12, s60, v12
    v_xor_b32 v13, s60, v13
    v_mfma_f32_16x16x32_bf16 v[100:103], a[44:47], a[64:67], v[100:103]
    v_xor_b32 v14, s60, v14
    v_xor_b32 v15, s60, v15
    s_waitcnt lgkmcnt(13)
    v_mfma_f32_16x16x32_bf16 v[160:163], a[48:51], a[64:67], v[160:163]
    s_waitcnt lgkmcnt(12)
    v_mfma_f32_16x16x32_bf16 v[164:167], a[52:55], a[64:67], v[164:167]
    s_waitcnt lgkmcnt(9)
    v_mfma_f32_16x16x32_bf16 v[224:227], a[56:59], a[64:67], v[224:227]
    s_waitcnt vmcnt(11) lgkmcnt(0)
    v_mfma_f32_16x16x32_bf16 v[228:231], a[60:63], a[64:67], v[228:231]
    s_barrier
    ds_read_b64_tr_b16 a[64:65], v8 offset:0
    v_mfma_f32_16x16x32_bf16 v[40:43], a[32:35], a[68:71], v[40:43]
    s_add_u32 m0, s62, 0
    ds_read_b64_tr_b16 a[66:67], v8 offset:2048
    v_mfma_f32_16x16x32_bf16 v[44:47], a[36:39], a[68:71], v[44:47]
    buffer_load_dwordx4 v18, s[44:47], s52 offen offset:0 sc1 lds
    v_mfma_f32_16x16x32_bf16 v[104:107], a[40:43], a[68:71], v[104:107]
    ds_read_b128 a[0:3], v6 offset:0
    v_mfma_f32_16x16x32_bf16 v[108:111], a[44:47], a[68:71], v[108:111]
    v_mfma_f32_16x16x32_bf16 v[168:171], a[48:51], a[68:71], v[168:171]
    v_mfma_f32_16x16x32_bf16 v[172:175], a[52:55], a[68:71], v[172:175]
    buffer_load_dwordx4 v19, s[44:47], s52 offen offset:1024 sc1 lds
    v_mfma_f32_16x16x32_bf16 v[232:235], a[56:59], a[68:71], v[232:235]
    s_add_u32 s52, s52, s56
    ds_read_b128 a[4:7], v6 offset:2048
    v_mfma_f32_16x16x32_bf16 v[236:239], a[60:63], a[68:71], v[236:239]
    ds_read_b64_tr_b16 a[68:69], v9 offset:0
    v_mfma_f32_16x16x32_bf16 v[48:51], a[32:35], a[72:75], v[48:51]
    ds_read_b64_tr_b16 a[70:71], v9 offset:2048
    v_mfma_f32_16x16x32_bf16 v[52:55], a[36:39], a[72:75], v[52:55]
    buffer_load_dwordx4 v18, s[44:47], s53 offen offset:2048 sc1 lds
    v_mfma_f32_16x16x32_bf16 v[112:115], a[40:43], a[72:75], v[112:115]
    ds_read_b128 a[8:11], v6 offset:4096
    v_mfma_f32_16x16x32_bf16 v[116:119], a[44:47], a[72:75], v[116:119]
    v_mfma_f32_16x16x32_bf16 v[176:179], a[48:51], a[72:75], v[176:179]
    v_mfma_f32_16x16x32_bf16 v[180:183], a[52:55], a[72:75], v[180:183]
    buffer_load_dwordx4 v19, s[44:47], s53 offen offset:3072 sc1 lds
    v_mfma_f32_16x16x32_bf16 v[240:243], a[56:59], a[72:75], v[240:243]
    s_add_u32 s53, s53, s56
    ds_read_b128 a[12:15], v6 offset:6144
    v_mfma_f32_16x16x32_bf16 v[244:247], a[60:63], a[72:75], v[244:247]
    ds_read_b64_tr_b16 a[72:73], v10 offset:0
    v_mfma_f32_16x16x32_bf16 v[56:59], a[32:35], a[76:79], v[56:59]
    s_add_u32 m0, s62, 4096
    ds_read_b64_tr_b16 a[74:75], v10 offset:2048
    v_mfma_f32_16x16x32_bf16 v[60:63], a[36:39], a[76:79], v[60:63]
    buffer_load_dwordx4 v20, s[44:47], s54 offen offset:0 sc1 lds
    v_mfma_f32_16x16x32_bf16 v[120:123], a[40:43], a[76:79], v[120:123]
    ds_read_b128 a[16:19], v6 offset:8192
    v_mfma_f32_16x16x32_bf16 v[124:127], a[44:47], a[76:79], v[124:127]
    s_xor_b32 s62, s62, 229376
    v_mfma_f32_16x16x32_bf16 v[184:187], a[48:51], a[76:79], v[184:187]
    v_mfma_f32_16x16x32_bf16 v[188:191], a[52:55], a[76:79], v[188:191]
    buffer_load_dwordx4 v21, s[44:47], s54 offen offset:1024 sc1 lds
    v_mfma_f32_16x16x32_bf16 v[248:251], a[56:59], a[76:79], v[248:251]
    s_add_u32 s54, s54, s56
    ds_read_b128 a[20:23], v6 offset:10240
    v_mfma_f32_16x16x32_bf16 v[252:255], a[60:63], a[76:79], v[252:255]
    ds_read_b64_tr_b16 a[76:77], v11 offset:0
    v_mfma_f32_16x16x32_bf16 v[64:67], a[32:35], a[80:83], v[64:67]
    ds_read_b64_tr_b16 a[78:79], v11 offset:2048
    v_mfma_f32_16x16x32_bf16 v[68:71], a[36:39], a[80:83], v[68:71]
    buffer_load_dwordx4 v20, s[44:47], s55 offen offset:2048 sc1 lds
    v_mfma_f32_16x16x32_bf16 v[128:131], a[40:43], a[80:83], v[128:131]
    ds_read_b128 a[24:27], v6 offset:12288
    v_mfma_f32_16x16x32_bf16 v[132:135], a[44:47], a[80:83], v[132:135]
    v_mfma_f32_16x16x32_bf16 v[192:195], a[48:51], a[80:83], v[192:195]
    v_mfma_f32_16x16x32_bf16 v[196:199], a[52:55], a[80:83], v[196:199]
    buffer_load_dwordx4 v21, s[44:47], s55 offen offset:3072 sc1 lds
    v_mfma_f32_16x16x32_bf16 a[96:99], a[56:59], a[80:83], a[96:99]
    s_add_u32 s55, s55, s56
    ds_read_b128 a[28:31], v6 offset:14336
    v_mfma_f32_16x16x32_bf16 a[100:103], a[60:63], a[80:83], a[100:103]
    ds_read_b64_tr_b16 a[80:81], v12 offset:0
    v_mfma_f32_16x16x32_bf16 v[72:75], a[32:35], a[84:87], v[72:75]
    ds_read_b64_tr_b16 a[82:83], v12 offset:2048
    v_mfma_f32_16x16x32_bf16 v[76:79], a[36:39], a[84:87], v[76:79]
    v_mfma_f32_16x16x32_bf16 v[136:139], a[40:43], a[84:87], v[136:139]
    buffer_store_dwordx4 a[140:143], v2, s[24:27], s28 offen sc1
    v_mfma_f32_16x16x32_bf16 v[140:143], a[44:47], a[84:87], v[140:143]
    s_add_u32 s28, s28, s31
    v_mfma_f32_16x16x32_bf16 v[200:203], a[48:51], a[84:87], v[200:203]
    v_mfma_f32_16x16x32_bf16 v[204:207], a[52:55], a[84:87], v[204:207]
    v_mfma_f32_16x16x32_bf16 a[104:107], a[56:59], a[84:87], a[104:107]
    buffer_store_dwordx4 a[144:147], v2, s[24:27], s28 offen sc1
    v_mfma_f32_16x16x32_bf16 a[108:111], a[60:63], a[84:87], a[108:111]
    s_add_u32 s28, s28, s31
    ds_read_b64_tr_b16 a[84:85], v13 offset:0
    v_mfma_f32_16x16x32_bf16 v[80:83], a[32:35], a[88:91], v[80:83]
    ds_read_b64_tr_b16 a[86:87], v13 offset:2048
    v_mfma_f32_16x16x32_bf16 v[84:87], a[36:39], a[88:91], v[84:87]
    v_mfma_f32_16x16x32_bf16 v[144:147], a[40:43], a[88:91], v[144:147]
    buffer_store_dwordx4 a[148:151], v2, s[24:27], s28 offen sc1
    v_mfma_f32_16x16x32_bf16 v[148:151], a[44:47], a[88:91], v[148:151]
    s_add_u32 s28, s28, s31
    v_mfma_f32_16x16x32_bf16 v[208:211], a[48:51], a[88:91], v[208:211]
    v_mfma_f32_16x16x32_bf16 v[212:215], a[52:55], a[88:91], v[212:215]
    v_mfma_f32_16x16x32_bf16 a[112:115], a[56:59], a[88:91], a[112:115]
    buffer_store_dwordx4 a[152:155], v2, s[24:27], s28 offen sc1
    v_mfma_f32_16x16x32_bf16 a[116:119], a[60:63], a[88:91], a[116:119]
    s_add_u32 s28, s28, s31
    ds_read_b64_tr_b16 a[88:89], v14 offset:0
    v_mfma_f32_16x16x32_bf16 v[88:91], a[32:35], a[92:95], v[88:91]
    ds_read_b64_tr_b16 a[90:91], v14 offset:2048
    v_mfma_f32_16x16x32_bf16 v[92:95], a[36:39], a[92:95], v[92:95]
    v_mfma_f32_16x16x32_bf16 v[152:155], a[40:43], a[92:95], v[152:155]
    buffer_store_dwordx4 a[156:159], v2, s[24:27], s28 offen sc1
    v_mfma_f32_16x16x32_bf16 v[156:159], a[44:47], a[92:95], v[156:159]
    s_add_u32 s29, s29, s30
    s_mov_b32 s28, s29
    v_mfma_f32_16x16x32_bf16 v[216:219], a[48:51], a[92:95], v[216:219]
    s_sub_u32 s65, s65, 1
    v_mfma_f32_16x16x32_bf16 v[220:223], a[52:55], a[92:95], v[220:223]
    v_mfma_f32_16x16x32_bf16 a[120:123], a[56:59], a[92:95], a[120:123]
    v_mfma_f32_16x16x32_bf16 a[124:127], a[60:63], a[92:95], a[124:127]
    ds_read_b64_tr_b16 a[92:93], v15 offset:0
    ds_read_b64_tr_b16 a[94:95], v15 offset:2048
    s_waitcnt lgkmcnt(15)
    v_mfma_f32_16x16x32_bf16 v[32:35], a[0:3], a[64:67], v[32:35]
    v_mfma_f32_16x16x32_bf16 v[36:39], a[4:7], a[64:67], v[36:39]
    v_mfma_f32_16x16x32_bf16 v[96:99], a[8:11], a[64:67], v[96:99]
    v_mfma_f32_16x16x32_bf16 v[100:103], a[12:15], a[64:67], v[100:103]
    s_add_u32 m0, s61, 0
    s_waitcnt lgkmcnt(13)
    v_mfma_f32_16x16x32_bf16 v[160:163], a[16:19], a[64:67], v[160:163]
    buffer_load_dwordx4 v16, s[40:43], s48 offen offset:0 sc1 lds
    s_waitcnt lgkmcnt(12)
    v_mfma_f32_16x16x32_bf16 v[164:167], a[20:23], a[64:67], v[164:167]
    s_waitcnt lgkmcnt(9)
    v_mfma_f32_16x16x32_bf16 v[224:227], a[24:27], a[64:67], v[224:227]
    s_waitcnt lgkmcnt(8)
    v_mfma_f32_16x16x32_bf16 v[228:231], a[28:31], a[64:67], v[228:231]
    ds_read_b64_tr_b16 a[64:65], v8 offset:16384
    v_mfma_f32_16x16x32_bf16 v[40:43], a[0:3], a[68:71], v[40:43]
    ds_read_b64_tr_b16 a[66:67], v8 offset:18432
    v_mfma_f32_16x16x32_bf16 v[44:47], a[4:7], a[68:71], v[44:47]
    v_mfma_f32_16x16x32_bf16 v[104:107], a[8:11], a[68:71], v[104:107]
    ds_read_b128 a[32:35], v7 offset:0
    v_mfma_f32_16x16x32_bf16 v[108:111], a[12:15], a[68:71], v[108:111]
    v_mfma_f32_16x16x32_bf16 v[168:171], a[16:19], a[68:71], v[168:171]
    buffer_load_dwordx4 v17, s[40:43], s48 offen offset:1024 sc1 lds
    v_mfma_f32_16x16x32_bf16 v[172:175], a[20:23], a[68:71], v[172:175]
    s_add_u32 s48, s48, 128
    v_mfma_f32_16x16x32_bf16 v[232:235], a[24:27], a[68:71], v[232:235]
    ds_read_b128 a[36:39], v7 offset:2048
    v_mfma_f32_16x16x32_bf16 v[236:239], a[28:31], a[68:71], v[236:239]
    ds_read_b64_tr_b16 a[68:69], v9 offset:16384
    v_mfma_f32_16x16x32_bf16 v[48:51], a[0:3], a[72:75], v[48:51]
    ds_read_b64_tr_b16 a[70:71], v9 offset:18432
    v_mfma_f32_16x16x32_bf16 v[52:55], a[4:7], a[72:75], v[52:55]
    v_mfma_f32_16x16x32_bf16 v[112:115], a[8:11], a[72:75], v[112:115]
    ds_read_b128 a[40:43], v7 offset:4096
    v_mfma_f32_16x16x32_bf16 v[116:119], a[12:15], a[72:75], v[116:119]
    v_mfma_f32_16x16x32_bf16 v[176:179], a[16:19], a[72:75], v[176:179]
    buffer_load_dwordx4 v16, s[40:43], s49 offen offset:2048 sc1 lds
    v_mfma_f32_16x16x32_bf16 v[180:183], a[20:23], a[72:75], v[180:183]
    v_mfma_f32_16x16x32_bf16 v[240:243], a[24:27], a[72:75], v[240:243]
    ds_read_b128 a[44:47], v7 offset:6144
    v_mfma_f32_16x16x32_bf16 v[244:247], a[28:31], a[72:75], v[244:247]
    ds_read_b64_tr_b16 a[72:73], v10 offset:16384
    v_mfma_f32_16x16x32_bf16 v[56:59], a[0:3], a[76:79], v[56:59]
    ds_read_b64_tr_b16 a[74:75], v10 offset:18432
    v_mfma_f32_16x16x32_bf16 v[60:63], a[4:7], a[76:79], v[60:63]
    v_mfma_f32_16x16x32_bf16 v[120:123], a[8:11], a[76:79], v[120:123]
    ds_read_b128 a[48:51], v7 offset:8192
    v_mfma_f32_16x16x32_bf16 v[124:127], a[12:15], a[76:79], v[124:127]
    v_mfma_f32_16x16x32_bf16 v[184:187], a[16:19], a[76:79], v[184:187]
    buffer_load_dwordx4 v17, s[40:43], s49 offen offset:3072 sc1 lds
    v_mfma_f32_16x16x32_bf16 v[188:191], a[20:23], a[76:79], v[188:191]
    s_add_u32 s49, s49, 128
    v_mfma_f32_16x16x32_bf16 v[248:251], a[24:27], a[76:79], v[248:251]
    ds_read_b128 a[52:55], v7 offset:10240
    v_mfma_f32_16x16x32_bf16 v[252:255], a[28:31], a[76:79], v[252:255]
    ds_read_b64_tr_b16 a[76:77], v11 offset:16384
    s_waitcnt lgkmcnt(15)
    v_mfma_f32_16x16x32_bf16 v[64:67], a[0:3], a[80:83], v[64:67]
    ds_read_b64_tr_b16 a[78:79], v11 offset:18432
    v_mfma_f32_16x16x32_bf16 v[68:71], a[4:7], a[80:83], v[68:71]
    v_mfma_f32_16x16x32_bf16 v[128:131], a[8:11], a[80:83], v[128:131]
    ds_read_b128 a[56:59], v7 offset:12288
    v_mfma_f32_16x16x32_bf16 v[132:135], a[12:15], a[80:83], v[132:135]
    s_add_u32 m0, s61, 4096
    v_mfma_f32_16x16x32_bf16 v[192:195], a[16:19], a[80:83], v[192:195]
    buffer_load_dwordx4 v16, s[40:43], s50 offen offset:0 sc1 lds
    v_mfma_f32_16x16x32_bf16 v[196:199], a[20:23], a[80:83], v[196:199]
    v_mfma_f32_16x16x32_bf16 a[96:99], a[24:27], a[80:83], a[96:99]
    s_add_u32 s61, s61, 32768
    ds_read_b128 a[60:63], v7 offset:14336
    v_mfma_f32_16x16x32_bf16 a[100:103], a[28:31], a[80:83], a[100:103]
    s_cmp_ge_u32 s61, 98304
    s_cselect_b32 s90, 98304, 0
    ds_read_b64_tr_b16 a[80:81], v12 offset:16384
    v_mfma_f32_16x16x32_bf16 v[72:75], a[0:3], a[84:87], v[72:75]
    s_sub_u32 s61, s61, s90
    ds_read_b64_tr_b16 a[82:83], v12 offset:18432
    v_mfma_f32_16x16x32_bf16 v[76:79], a[4:7], a[84:87], v[76:79]
    s_add_u32 s64, s64, 32768
    v_mfma_f32_16x16x32_bf16 v[136:139], a[8:11], a[84:87], v[136:139]
    buffer_store_dwordx4 a[160:163], v2, s[24:27], s28 offen sc1
    v_mfma_f32_16x16x32_bf16 v[140:143], a[12:15], a[84:87], v[140:143]
    s_add_u32 s28, s28, s31
    v_mfma_f32_16x16x32_bf16 v[200:203], a[16:19], a[84:87], v[200:203]
    buffer_load_dwordx4 v17, s[40:43], s50 offen offset:1024 sc1 lds
    v_mfma_f32_16x16x32_bf16 v[204:207], a[20:23], a[84:87], v[204:207]
    s_add_u32 s50, s50, 128
    v_mfma_f32_16x16x32_bf16 a[104:107], a[24:27], a[84:87], a[104:107]
    s_cmp_ge_u32 s64, 98304
    s_cselect_b32 s63, 4294901760, s59
    s_cselect_b32 s64, 0, s64
    v_mfma_f32_16x16x32_bf16 a[108:111], a[28:31], a[84:87], a[108:111]
    ds_read_b64_tr_b16 a[84:85], v13 offset:16384
    v_mfma_f32_16x16x32_bf16 v[80:83], a[0:3], a[88:91], v[80:83]
    ds_read_b64_tr_b16 a[86:87], v13 offset:18432
    v_mfma_f32_16x16x32_bf16 v[84:87], a[4:7], a[88:91], v[84:87]
    v_mfma_f32_16x16x32_bf16 v[144:147], a[8:11], a[88:91], v[144:147]
    buffer_store_dwordx4 a[164:167], v2, s[24:27], s28 offen sc1
    v_mfma_f32_16x16x32_bf16 v[148:151], a[12:15], a[88:91], v[148:151]
    s_add_u32 s28, s28, s31
    v_mfma_f32_16x16x32_bf16 v[208:211], a[16:19], a[88:91], v[208:211]
    buffer_load_dwordx4 v16, s[40:43], s51 offen offset:2048 sc1 lds
    v_mfma_f32_16x16x32_bf16 v[212:215], a[20:23], a[88:91], v[212:215]
    v_mfma_f32_16x16x32_bf16 a[112:115], a[24:27], a[88:91], a[112:115]
    v_mfma_f32_16x16x32_bf16 a[116:119], a[28:31], a[88:91], a[116:119]
    ds_read_b64_tr_b16 a[88:89], v14 offset:16384
    s_waitcnt lgkmcnt(15)
    v_mfma_f32_16x16x32_bf16 v[88:91], a[0:3], a[92:95], v[88:91]
    ds_read_b64_tr_b16 a[90:91], v14 offset:18432
    v_mfma_f32_16x16x32_bf16 v[92:95], a[4:7], a[92:95], v[92:95]
    v_add_u32 v6, s63, v6
    v_add_u32 v7, s63, v7
    v_mfma_f32_16x16x32_bf16 v[152:155], a[8:11], a[92:95], v[152:155]
    buffer_store_dwordx4 a[168:171], v2, s[24:27], s28 offen sc1
    v_mfma_f32_16x16x32_bf16 v[156:159], a[12:15], a[92:95], v[156:159]
    s_add_u32 s28, s28, s31
    v_mfma_f32_16x16x32_bf16 v[216:219], a[16:19], a[92:95], v[216:219]
    buffer_load_dwordx4 v17, s[40:43], s51 offen offset:3072 sc1 lds
    v_mfma_f32_16x16x32_bf16 v[220:223], a[20:23], a[92:95], v[220:223]
    s_add_u32 s51, s51, 128
    v_mfma_f32_16x16x32_bf16 a[120:123], a[24:27], a[92:95], a[120:123]
    v_mfma_f32_16x16x32_bf16 a[124:127], a[28:31], a[92:95], a[124:127]
    ds_read_b64_tr_b16 a[92:93], v15 offset:16384
    ds_read_b64_tr_b16 a[94:95], v15 offset:18432
    v_mfma_f32_16x16x32_bf16 v[32:35], a[32:35], a[64:67], v[32:35]
    v_xor_b32 v8, s60, v8
    v_xor_b32 v9, s60, v9
    v_mfma_f32_16x16x32_bf16 v[36:39], a[36:39], a[64:67], v[36:39]
    v_xor_b32 v10, s60, v10
    v_xor_b32 v11, s60, v11
    s_waitcnt lgkmcnt(15)
    v_mfma_f32_16x16x32_bf16 v[96:99], a[40:43], a[64:67], v[96:99]
    v_xor_b32 v12, s60, v12
    v_xor_b32 v13, s60, v13
    v_mfma_f32_16x16x32_bf16 v[100:103], a[44:47], a[64:67], v[100:103]
    v_xor_b32 v14, s60, v14
    v_xor_b32 v15, s60, v15
    s_waitcnt lgkmcnt(13)
    v_mfma_f32_16x16x32_bf16 v[160:163], a[48:51], a[64:67], v[160:163]
    s_waitcnt lgkmcnt(12)
    v_mfma_f32_16x16x32_bf16 v[164:167], a[52:55], a[64:67], v[164:167]
    s_waitcnt lgkmcnt(9)
    v_mfma_f32_16x16x32_bf16 v[224:227], a[56:59], a[64:67], v[224:227]
    s_waitcnt vmcnt(16) lgkmcnt(0)
    v_mfma_f32_16x16x32_bf16 v[228:231], a[60:63], a[64:67], v[228:231]
    s_barrier
    ds_read_b64_tr_b16 a[64:65], v8 offset:0
    v_mfma_f32_16x16x32_bf16 v[40:43], a[32:35], a[68:71], v[40:43]
    s_add_u32 m0, s62, 0
    ds_read_b64_tr_b16 a[66:67], v8 offset:2048
    v_mfma_f32_16x16x32_bf16 v[44:47], a[36:39], a[68:71], v[44:47]
    buffer_load_dwordx4 v18, s[44:47], s52 offen offset:0 sc1 lds
    v_mfma_f32_16x16x32_bf16 v[104:107], a[40:43], a[68:71], v[104:107]
    ds_read_b128 a[0:3], v6 offset:0
    v_mfma_f32_16x16x32_bf16 v[108:111], a[44:47], a[68:71], v[108:111]
    v_mfma_f32_16x16x32_bf16 v[168:171], a[48:51], a[68:71], v[168:171]
    v_mfma_f32_16x16x32_bf16 v[172:175], a[52:55], a[68:71], v[172:175]
    buffer_load_dwordx4 v19, s[44:47], s52 offen offset:1024 sc1 lds
    v_mfma_f32_16x16x32_bf16 v[232:235], a[56:59], a[68:71], v[232:235]
    s_add_u32 s52, s52, s56
    ds_read_b128 a[4:7], v6 offset:2048
    v_mfma_f32_16x16x32_bf16 v[236:239], a[60:63], a[68:71], v[236:239]
    ds_read_b64_tr_b16 a[68:69], v9 offset:0
    v_mfma_f32_16x16x32_bf16 v[48:51], a[32:35], a[72:75], v[48:51]
    ds_read_b64_tr_b16 a[70:71], v9 offset:2048
    v_mfma_f32_16x16x32_bf16 v[52:55], a[36:39], a[72:75], v[52:55]
    buffer_load_dwordx4 v18, s[44:47], s53 offen offset:2048 sc1 lds
    v_mfma_f32_16x16x32_bf16 v[112:115], a[40:43], a[72:75], v[112:115]
    ds_read_b128 a[8:11], v6 offset:4096
    v_mfma_f32_16x16x32_bf16 v[116:119], a[44:47], a[72:75], v[116:119]
    v_mfma_f32_16x16x32_bf16 v[176:179], a[48:51], a[72:75], v[176:179]
    v_mfma_f32_16x16x32_bf16 v[180:183], a[52:55], a[72:75], v[180:183]
    buffer_load_dwordx4 v19, s[44:47], s53 offen offset:3072 sc1 lds
    v_mfma_f32_16x16x32_bf16 v[240:243], a[56:59], a[72:75], v[240:243]
    s_add_u32 s53, s53, s56
    ds_read_b128 a[12:15], v6 offset:6144
    v_mfma_f32_16x16x32_bf16 v[244:247], a[60:63], a[72:75], v[244:247]
    ds_read_b64_tr_b16 a[72:73], v10 offset:0
    v_mfma_f32_16x16x32_bf16 v[56:59], a[32:35], a[76:79], v[56:59]
    s_add_u32 m0, s62, 4096
    ds_read_b64_tr_b16 a[74:75], v10 offset:2048
    v_mfma_f32_16x16x32_bf16 v[60:63], a[36:39], a[76:79], v[60:63]
    buffer_load_dwordx4 v20, s[44:47], s54 offen offset:0 sc1 lds
    v_mfma_f32_16x16x32_bf16 v[120:123], a[40:43], a[76:79], v[120:123]
    ds_read_b128 a[16:19], v6 offset:8192
    v_mfma_f32_16x16x32_bf16 v[124:127], a[44:47], a[76:79], v[124:127]
    s_xor_b32 s62, s62, 229376
    v_mfma_f32_16x16x32_bf16 v[184:187], a[48:51], a[76:79], v[184:187]
    v_mfma_f32_16x16x32_bf16 v[188:191], a[52:55], a[76:79], v[188:191]
    buffer_load_dwordx4 v21, s[44:47], s54 offen offset:1024 sc1 lds
    v_mfma_f32_16x16x32_bf16 v[248:251], a[56:59], a[76:79], v[248:251]
    s_add_u32 s54, s54, s56
    ds_read_b128 a[20:23], v6 offset:10240
    v_mfma_f32_16x16x32_bf16 v[252:255], a[60:63], a[76:79], v[252:255]
    ds_read_b64_tr_b16 a[76:77], v11 offset:0
    v_mfma_f32_16x16x32_bf16 v[64:67], a[32:35], a[80:83], v[64:67]
    ds_read_b64_tr_b16 a[78:79], v11 offset:2048
    v_mfma_f32_16x16x32_bf16 v[68:71], a[36:39], a[80:83], v[68:71]
    buffer_load_dwordx4 v20, s[44:47], s55 offen offset:2048 sc1 lds
    v_mfma_f32_16x16x32_bf16 v[128:131], a[40:43], a[80:83], v[128:131]
    ds_read_b128 a[24:27], v6 offset:12288
    v_mfma_f32_16x16x32_bf16 v[132:135], a[44:47], a[80:83], v[132:135]
    v_mfma_f32_16x16x32_bf16 v[192:195], a[48:51], a[80:83], v[192:195]
    v_mfma_f32_16x16x32_bf16 v[196:199], a[52:55], a[80:83], v[196:199]
    buffer_load_dwordx4 v21, s[44:47], s55 offen offset:3072 sc1 lds
    v_mfma_f32_16x16x32_bf16 a[96:99], a[56:59], a[80:83], a[96:99]
    s_add_u32 s55, s55, s56
    ds_read_b128 a[28:31], v6 offset:14336
    v_mfma_f32_16x16x32_bf16 a[100:103], a[60:63], a[80:83], a[100:103]
    ds_read_b64_tr_b16 a[80:81], v12 offset:0
    v_mfma_f32_16x16x32_bf16 v[72:75], a[32:35], a[84:87], v[72:75]
    ds_read_b64_tr_b16 a[82:83], v12 offset:2048
    v_mfma_f32_16x16x32_bf16 v[76:79], a[36:39], a[84:87], v[76:79]
    v_mfma_f32_16x16x32_bf16 v[136:139], a[40:43], a[84:87], v[136:139]
    buffer_store_dwordx4 a[172:175], v2, s[24:27], s28 offen sc1
    v_mfma_f32_16x16x32_bf16 v[140:143], a[44:47], a[84:87], v[140:143]
    s_add_u32 s28, s28, s31
    v_mfma_f32_16x16x32_bf16 v[200:203], a[48:51], a[84:87], v[200:203]
    v_mfma_f32_16x16x32_bf16 v[204:207], a[52:55], a[84:87], v[204:207]
    v_mfma_f32_16x16x32_bf16 a[104:107], a[56:59], a[84:87], a[104:107]
    buffer_store_dwordx4 a[176:179], v2, s[24:27], s28 offen sc1
    v_mfma_f32_16x16x32_bf16 a[108:111], a[60:63], a[84:87], a[108:111]
    s_add_u32 s28, s28, s31
    ds_read_b64_tr_b16 a[84:85], v13 offset:0
    v_mfma_f32_16x16x32_bf16 v[80:83], a[32:35], a[88:91], v[80:83]
    ds_read_b64_tr_b16 a[86:87], v13 offset:2048
    v_mfma_f32_16x16x32_bf16 v[84:87], a[36:39], a[88:91], v[84:87]
    v_mfma_f32_16x16x32_bf16 v[144:147], a[40:43], a[88:91], v[144:147]
    buffer_store_dwordx4 a[180:183], v2, s[24:27], s28 offen sc1
    v_mfma_f32_16x16x32_bf16 v[148:151], a[44:47], a[88:91], v[148:151]
    s_add_u32 s28, s28, s31
    v_mfma_f32_16x16x32_bf16 v[208:211], a[48:51], a[88:91], v[208:211]
    v_mfma_f32_16x16x32_bf16 v[212:215], a[52:55], a[88:91], v[212:215]
    v_mfma_f32_16x16x32_bf16 a[112:115], a[56:59], a[88:91], a[112:115]
    buffer_store_dwordx4 a[184:187], v2, s[24:27], s28 offen sc1
    v_mfma_f32_16x16x32_bf16 a[116:119], a[60:63], a[88:91], a[116:119]
    s_add_u32 s28, s28, s31
    ds_read_b64_tr_b16 a[88:89], v14 offset:0
    v_mfma_f32_16x16x32_bf16 v[88:91], a[32:35], a[92:95], v[88:91]
    ds_read_b64_tr_b16 a[90:91], v14 offset:2048
    v_mfma_f32_16x16x32_bf16 v[92:95], a[36:39], a[92:95], v[92:95]
    v_mfma_f32_16x16x32_bf16 v[152:155], a[40:43], a[92:95], v[152:155]
    buffer_store_dwordx4 a[188:191], v2, s[24:27], s28 offen sc1
    v_mfma_f32_16x16x32_bf16 v[156:159], a[44:47], a[92:95], v[156:159]
    s_add_u32 s29, s29, s30
    s_mov_b32 s28, s29
    v_mfma_f32_16x16x32_bf16 v[216:219], a[48:51], a[92:95], v[216:219]
    s_sub_u32 s65, s65, 1
    v_mfma_f32_16x16x32_bf16 v[220:223], a[52:55], a[92:95], v[220:223]
    v_mfma_f32_16x16x32_bf16 a[120:123], a[56:59], a[92:95], a[120:123]
    v_mfma_f32_16x16x32_bf16 a[124:127], a[60:63], a[92:95], a[124:127]
    ds_read_b64_tr_b16 a[92:93], v15 offset:0
    ds_read_b64_tr_b16 a[94:95], v15 offset:2048
    s_cmp_eq_u32 s66, 2
    s_cbranch_scc1 m_hook18
m_hookr19:
    s_waitcnt lgkmcnt(15)
    v_mfma_f32_16x16x32_bf16 v[32:35], a[0:3], a[64:67], v[32:35]
    v_mfma_f32_16x16x32_bf16 v[36:39], a[4:7], a[64:67], v[36:39]
    v_mfma_f32_16x16x32_bf16 v[96:99], a[8:11], a[64:67], v[96:99]
    v_mfma_f32_16x16x32_bf16 v[100:103], a[12:15], a[64:67], v[100:103]
    s_add_u32 m0, s61, 0
    s_waitcnt lgkmcnt(13)
    v_mfma_f32_16x16x32_bf16 v[160:163], a[16:19], a[64:67], v[160:163]
    buffer_load_dwordx4 v16, s[40:43], s48 offen offset:0 sc1 lds
    s_waitcnt lgkmcnt(12)
    v_mfma_f32_16x16x32_bf16 v[164:167], a[20:23], a[64:67], v[164:167]
    s_waitcnt lgkmcnt(9)
    v_mfma_f32_16x16x32_bf16 v[224:227], a[24:27], a[64:67], v[224:227]
    s_waitcnt lgkmcnt(8)
    v_mfma_f32_16x16x32_bf16 v[228:231], a[28:31], a[64:67], v[228:231]
    ds_read_b64_tr_b16 a[64:65], v8 offset:16384
    v_mfma_f32_16x16x32_bf16 v[40:43], a[0:3], a[68:71], v[40:43]
    ds_read_b64_tr_b16 a[66:67], v8 offset:18432
    v_mfma_f32_16x16x32_bf16 v[44:47], a[4:7], a[68:71], v[44:47]
    v_mfma_f32_16x16x32_bf16 v[104:107], a[8:11], a[68:71], v[104:107]
    ds_read_b128 a[32:35], v7 offset:0
    v_mfma_f32_16x16x32_bf16 v[108:111], a[12:15], a[68:71], v[108:111]
    v_mfma_f32_16x16x32_bf16 v[168:171], a[16:19], a[68:71], v[168:171]
    buffer_load_dwordx4 v17, s[40:43], s48 offen offset:1024 sc1 lds
    v_mfma_f32_16x16x32_bf16 v[172:175], a[20:23], a[68:71], v[172:175]
    s_add_u32 s48, s48, 128
    v_mfma_f32_16x16x32_bf16 v[232:235], a[24:27], a[68:71], v[232:235]
    ds_read_b128 a[36:39], v7 offset:2048
    v_mfma_f32_16x16x32_bf16 v[236:239], a[28:31], a[68:71], v[236:239]
    ds_read_b64_tr_b16 a[68:69], v9 offset:16384
    v_mfma_f32_16x16x32_bf16 v[48:51], a[0:3], a[72:75], v[48:51]
    ds_read_b64_tr_b16 a[70:71], v9 offset:18432
    v_mfma_f32_16x16x32_bf16 v[52:55], a[4:7], a[72:75], v[52:55]
    v_mfma_f32_16x16x32_bf16 v[112:115], a[8:11], a[72:75], v[112:115]
    ds_read_b128 a[40:43], v7 offset:4096
    v_mfma_f32_16x16x32_bf16 v[116:119], a[12:15], a[72:75], v[116:119]
    v_mfma_f32_16x16x32_bf16 v[176:179], a[16:19], a[72:75], v[176:179]
    buffer_load_dwordx4 v16, s[40:43], s49 offen offset:2048 sc1 lds
    v_mfma_f32_16x16x32_bf16 v[180:183], a[20:23], a[72:75], v[180:183]
    v_mfma_f32_16x16x32_bf16 v[240:243], a[24:27], a[72:75], v[240:243]
    ds_read_b128 a[44:47], v7 offset:6144
    v_mfma_f32_16x16x32_bf16 v[244:247], a[28:31], a[72:75], v[244:247]
    ds_read_b64_tr_b16 a[72:73], v10 offset:16384
    v_mfma_f32_16x16x32_bf16 v[56:59], a[0:3], a[76:79], v[56:59]
    ds_read_b64_tr_b16 a[74:75], v10 offset:18432
    v_mfma_f32_16x16x32_bf16 v[60:63], a[4:7], a[76:79], v[60:63]
    v_mfma_f32_16x16x32_bf16 v[120:123], a[8:11], a[76:79], v[120:123]
    ds_read_b128 a[48:51], v7 offset:8192
    v_mfma_f32_16x16x32_bf16 v[124:127], a[12:15], a[76:79], v[124:127]
    v_mfma_f32_16x16x32_bf16 v[184:187], a[16:19], a[76:79], v[184:187]
    buffer_load_dwordx4 v17, s[40:43], s49 offen offset:3072 sc1 lds
    v_mfma_f32_16x16x32_bf16 v[188:191], a[20:23], a[76:79], v[188:191]
    s_add_u32 s49, s49, 128
    v_mfma_f32_16x16x32_bf16 v[248:251], a[24:27], a[76:79], v[248:251]
    ds_read_b128 a[52:55], v7 offset:10240
    v_mfma_f32_16x16x32_bf16 v[252:255], a[28:31], a[76:79], v[252:255]
    ds_read_b64_tr_b16 a[76:77], v11 offset:16384
    s_waitcnt lgkmcnt(15)
    v_mfma_f32_16x16x32_bf16 v[64:67], a[0:3], a[80:83], v[64:67]
    ds_read_b64_tr_b16 a[78:79], v11 offset:18432
    v_mfma_f32_16x16x32_bf16 v[68:71], a[4:7], a[80:83], v[68:71]
    v_mfma_f32_16x16x32_bf16 v[128:131], a[8:11], a[80:83], v[128:131]
    ds_read_b128 a[56:59], v7 offset:12288
    v_mfma_f32_16x16x32_bf16 v[132:135], a[12:15], a[80:83], v[132:135]
    s_add_u32 m0, s61, 4096
    v_mfma_f32_16x16x32_bf16 v[192:195], a[16:19], a[80:83], v[192:195]
    buffer_load_dwordx4 v16, s[40:43], s50 offen offset:0 sc1 lds
    v_mfma_f32_16x16x32_bf16 v[196:199], a[20:23], a[80:83], v[196:199]
    v_mfma_f32_16x16x32_bf16 a[96:99], a[24:27], a[80:83], a[96:99]
    s_add_u32 s61, s61, 32768
    ds_read_b128 a[60:63], v7 offset:14336
    v_mfma_f32_16x16x32_bf16 a[100:103], a[28:31], a[80:83], a[100:103]
    s_cmp_ge_u32 s61, 98304
    s_cselect_b32 s90, 98304, 0
    ds_read_b64_tr_b16 a[80:81], v12 offset:16384
    v_mfma_f32_16x16x32_bf16 v[72:75], a[0:3], a[84:87], v[72:75]
    s_sub_u32 s61, s61, s90
    ds_read_b64_tr_b16 a[82:83], v12 offset:18432
    v_mfma_f32_16x16x32_bf16 v[76:79], a[4:7], a[84:87], v[76:79]
    s_add_u32 s64, s64, 32768
    v_mfma_f32_16x16x32_bf16 v[136:139], a[8:11], a[84:87], v[136:139]
    buffer_store_dwordx4 a[192:195], v2, s[24:27], s28 offen sc1
    v_mfma_f32_16x16x32_bf16 v[140:143], a[12:15], a[84:87], v[140:143]
    s_add_u32 s28, s28, s31
    v_mfma_f32_16x16x32_bf16 v[200:203], a[16:19], a[84:87], v[200:203]
    buffer_load_dwordx4 v17, s[40:43], s50 offen offset:1024 sc1 lds
    v_mfma_f32_16x16x32_bf16 v[204:207], a[20:23], a[84:87], v[204:207]
    s_add_u32 s50, s50, 128
    v_mfma_f32_16x16x32_bf16 a[104:107], a[24:27], a[84:87], a[104:107]
    s_cmp_ge_u32 s64, 98304
    s_cselect_b32 s63, 4294901760, s59
    s_cselect_b32 s64, 0, s64
    v_mfma_f32_16x16x32_bf16 a[108:111], a[28:31], a[84:87], a[108:111]
    ds_read_b64_tr_b16 a[84:85], v13 offset:16384
    v_mfma_f32_16x16x32_bf16 v[80:83], a[0:3], a[88:91], v[80:83]
    ds_read_b64_tr_b16 a[86:87], v13 offset:18432
    v_mfma_f32_16x16x32_bf16 v[84:87], a[4:7], a[88:91], v[84:87]
    v_mfma_f32_16x16x32_bf16 v[144:147], a[8:11], a[88:91], v[144:147]
    buffer_store_dwordx4 a[196:199], v2, s[24:27], s28 offen sc1
    v_mfma_f32_16x16x32_bf16 v[148:151], a[12:15], a[88:91], v[148:151]
    s_add_u32 s28, s28, s31
    v_mfma_f32_16x16x32_bf16 v[208:211], a[16:19], a[88:91], v[208:211]
    buffer_load_dwordx4 v16, s[40:43], s51 offen offset:2048 sc1 lds
    v_mfma_f32_16x16x32_bf16 v[212:215], a[20:23], a[88:91], v[212:215]
    v_mfma_f32_16x16x32_bf16 a[112:115], a[24:27], a[88:91], a[112:115]
    v_mfma_f32_16x16x32_bf16 a[116:119], a[28:31], a[88:91], a[116:119]
    ds_read_b64_tr_b16 a[88:89], v14 offset:16384
    s_waitcnt lgkmcnt(15)
    v_mfma_f32_16x16x32_bf16 v[88:91], a[0:3], a[92:95], v[88:91]
    ds_read_b64_tr_b16 a[90:91], v14 offset:18432
    v_mfma_f32_16x16x32_bf16 v[92:95], a[4:7], a[92:95], v[92:95]
    v_add_u32 v6, s63, v6
    v_add_u32 v7, s63, v7
    v_mfma_f32_16x16x32_bf16 v[152:155], a[8:11], a[92:95], v[152:155]
    buffer_store_dwordx4 a[200:203], v2, s[24:27], s28 offen sc1
    v_mfma_f32_16x16x32_bf16 v[156:159], a[12:15], a[92:95], v[156:159]
    s_add_u32 s28, s28, s31
    v_mfma_f32_16x16x32_bf16 v[216:219], a[16:19], a[92:95], v[216:219]
    buffer_load_dwordx4 v17, s[40:43], s51 offen offset:3072 sc1 lds
    v_mfma_f32_16x16x32_bf16 v[220:223], a[20:23], a[92:95], v[220:223]
    s_add_u32 s51, s51, 128
    v_mfma_f32_16x16x32_bf16 a[120:123], a[24:27], a[92:95], a[120:123]
    v_mfma_f32_16x16x32_bf16 a[124:127], a[28:31], a[92:95], a[124:127]
    ds_read_b64_tr_b16 a[92:93], v15 offset:16384
    ds_read_b64_tr_b16 a[94:95], v15 offset:18432
    v_mfma_f32_16x16x32_bf16 v[32:35], a[32:35], a[64:67], v[32:35]
    v_xor_b32 v8, s60, v8
    v_xor_b32 v9, s60, v9
    v_mfma_f32_16x16x32_bf16 v[36:39], a[36:39], a[64:67], v[36:39]
    v_xor_b32 v10, s60, v10
    v_xor_b32 v11, s60, v11
    s_waitcnt lgkmcnt(15)
    v_mfma_f32_16x16x32_bf16 v[96:99], a[40:43], a[64:67], v[96:99]
    v_xor_b32 v12, s60, v12
    v_xor_b32 v13, s60, v13
    v_mfma_f32_16x16x32_bf16 v[100:103], a[44:47], a[64:67], v[100:103]
    v_xor_b32 v14, s60, v14
    v_xor_b32 v15, s60, v15
    s_waitcnt lgkmcnt(13)
    v_mfma_f32_16x16x32_bf16 v[160:163], a[48:51], a[64:67], v[160:163]
    s_waitcnt lgkmcnt(12)
    v_mfma_f32_16x16x32_bf16 v[164:167], a[52:55], a[64:67], v[164:167]
    s_waitcnt lgkmcnt(9)
    v_mfma_f32_16x16x32_bf16 v[224:227], a[56:59], a[64:67], v[224:227]
    s_waitcnt vmcnt(16) lgkmcnt(0)
    v_mfma_f32_16x16x32_bf16 v[228:231], a[60:63], a[64:67], v[228:231]
    s_barrier
    ds_read_b64_tr_b16 a[64:65], v8 offset:0
    v_mfma_f32_16x16x32_bf16 v[40:43], a[32:35], a[68:71], v[40:43]
    s_add_u32 m0, s62, 0
    ds_read_b64_tr_b16 a[66:67], v8 offset:2048
    v_mfma_f32_16x16x32_bf16 v[44:47], a[36:39], a[68:71], v[44:47]
    buffer_load_dwordx4 v18, s[44:47], s52 offen offset:0 sc1 lds
    v_mfma_f32_16x16x32_bf16 v[104:107], a[40:43], a[68:71], v[104:107]
    ds_read_b128 a[0:3], v6 offset:0
    v_mfma_f32_16x16x32_bf16 v[108:111], a[44:47], a[68:71], v[108:111]
    v_mfma_f32_16x16x32_bf16 v[168:171], a[48:51], a[68:71], v[168:171]
    v_mfma_f32_16x16x32_bf16 v[172:175], a[52:55], a[68:71], v[172:175]
    buffer_load_dwordx4 v19, s[44:47], s52 offen offset:1024 sc1 lds
    v_mfma_f32_16x16x32_bf16 v[232:235], a[56:59], a[68:71], v[232:235]
    s_add_u32 s52, s52, s56
    ds_read_b128 a[4:7], v6 offset:2048
    v_mfma_f32_16x16x32_bf16 v[236:239], a[60:63], a[68:71], v[236:239]
    ds_read_b64_tr_b16 a[68:69], v9 offset:0
    v_mfma_f32_16x16x32_bf16 v[48:51], a[32:35], a[72:75], v[48:51]
    ds_read_b64_tr_b16 a[70:71], v9 offset:2048
    v_mfma_f32_16x16x32_bf16 v[52:55], a[36:39], a[72:75], v[52:55]
    buffer_load_dwordx4 v18, s[44:47], s53 offen offset:2048 sc1 lds
    v_mfma_f32_16x16x32_bf16 v[112:115], a[40:43], a[72:75], v[112:115]
    ds_read_b128 a[8:11], v6 offset:4096
    v_mfma_f32_16x16x32_bf16 v[116:119], a[44:47], a[72:75], v[116:119]
    v_mfma_f32_16x16x32_bf16 v[176:179], a[48:51], a[72:75], v[176:179]
    v_mfma_f32_16x16x32_bf16 v[180:183], a[52:55], a[72:75], v[180:183]
    buffer_load_dwordx4 v19, s[44:47], s53 offen offset:3072 sc1 lds
    v_mfma_f32_16x16x32_bf16 v[240:243], a[56:59], a[72:75], v[240:243]
    s_add_u32 s53, s53, s56
    ds_read_b128 a[12:15], v6 offset:6144
    v_mfma_f32_16x16x32_bf16 v[244:247], a[60:63], a[72:75], v[244:247]
    ds_read_b64_tr_b16 a[72:73], v10 offset:0
    v_mfma_f32_16x16x32_bf16 v[56:59], a[32:35], a[76:79], v[56:59]
    s_add_u32 m0, s62, 4096
    ds_read_b64_tr_b16 a[74:75], v10 offset:2048
    v_mfma_f32_16x16x32_bf16 v[60:63], a[36:39], a[76:79], v[60:63]
    buffer_load_dwordx4 v20, s[44:47], s54 offen offset:0 sc1 lds
    v_mfma_f32_16x16x32_bf16 v[120:123], a[40:43], a[76:79], v[120:123]
    ds_read_b128 a[16:19], v6 offset:8192
    v_mfma_f32_16x16x32_bf16 v[124:127], a[44:47], a[76:79], v[124:127]
    s_xor_b32 s62, s62, 229376
    v_mfma_f32_16x16x32_bf16 v[184:187], a[48:51], a[76:79], v[184:187]
    v_mfma_f32_16x16x32_bf16 v[188:191], a[52:55], a[76:79], v[188:191]
    buffer_load_dwordx4 v21, s[44:47], s54 offen offset:1024 sc1 lds
    v_mfma_f32_16x16x32_bf16 v[248:251], a[56:59], a[76:79], v[248:251]
    s_add_u32 s54, s54, s56
    ds_read_b128 a[20:23], v6 offset:10240
    v_mfma_f32_16x16x32_bf16 v[252:255], a[60:63], a[76:79], v[252:255]
    ds_read_b64_tr_b16 a[76:77], v11 offset:0
    v_mfma_f32_16x16x32_bf16 v[64:67], a[32:35], a[80:83], v[64:67]
    ds_read_b64_tr_b16 a[78:79], v11 offset:2048
    v_mfma_f32_16x16x32_bf16 v[68:71], a[36:39], a[80:83], v[68:71]
    buffer_load_dwordx4 v20, s[44:47], s55 offen offset:2048 sc1 lds
    v_mfma_f32_16x16x32_bf16 v[128:131], a[40:43], a[80:83], v[128:131]
    ds_read_b128 a[24:27], v6 offset:12288
    v_mfma_f32_16x16x32_bf16 v[132:135], a[44:47], a[80:83], v[132:135]
    v_mfma_f32_16x16x32_bf16 v[192:195], a[48:51], a[80:83], v[192:195]
    v_mfma_f32_16x16x32_bf16 v[196:199], a[52:55], a[80:83], v[196:199]
    buffer_load_dwordx4 v21, s[44:47], s55 offen offset:3072 sc1 lds
    v_mfma_f32_16x16x32_bf16 a[96:99], a[56:59], a[80:83], a[96:99]
    s_add_u32 s55, s55, s56
    ds_read_b128 a[28:31], v6 offset:14336
    v_mfma_f32_16x16x32_bf16 a[100:103], a[60:63], a[80:83], a[100:103]
    ds_read_b64_tr_b16 a[80:81], v12 offset:0
    v_mfma_f32_16x16x32_bf16 v[72:75], a[32:35], a[84:87], v[72:75]
    ds_read_b64_tr_b16 a[82:83], v12 offset:2048
    v_mfma_f32_16x16x32_bf16 v[76:79], a[36:39], a[84:87], v[76:79]
    v_mfma_f32_16x16x32_bf16 v[136:139], a[40:43], a[84:87], v[136:139]
    buffer_store_dwordx4 a[204:207], v2, s[24:27], s28 offen sc1
    v_mfma_f32_16x16x32_bf16 v[140:143], a[44:47], a[84:87], v[140:143]
    s_add_u32 s28, s28, s31
    v_mfma_f32_16x16x32_bf16 v[200:203], a[48:51], a[84:87], v[200:203]
    v_mfma_f32_16x16x32_bf16 v[204:207], a[52:55], a[84:87], v[204:207]
    v_mfma_f32_16x16x32_bf16 a[104:107], a[56:59], a[84:87], a[104:107]
    buffer_store_dwordx4 a[208:211], v2, s[24:27], s28 offen sc1
    v_mfma_f32_16x16x32_bf16 a[108:111], a[60:63], a[84:87], a[108:111]
    s_add_u32 s28, s28, s31
    ds_read_b64_tr_b16 a[84:85], v13 offset:0
    v_mfma_f32_16x16x32_bf16 v[80:83], a[32:35], a[88:91], v[80:83]
    ds_read_b64_tr_b16 a[86:87], v13 offset:2048
    v_mfma_f32_16x16x32_bf16 v[84:87], a[36:39], a[88:91], v[84:87]
    v_mfma_f32_16x16x32_bf16 v[144:147], a[40:43], a[88:91], v[144:147]
    buffer_store_dwordx4 a[212:215], v2, s[24:27], s28 offen sc1
    v_mfma_f32_16x16x32_bf16 v[148:151], a[44:47], a[88:91], v[148:151]
    s_add_u32 s28, s28, s31
    v_mfma_f32_16x16x32_bf16 v[208:211], a[48:51], a[88:91], v[208:211]
    v_mfma_f32_16x16x32_bf16 v[212:215], a[52:55], a[88:91], v[212:215]
    v_mfma_f32_16x16x32_bf16 a[112:115], a[56:59], a[88:91], a[112:115]
    buffer_store_dwordx4 a[216:219], v2, s[24:27], s28 offen sc1
    v_mfma_f32_16x16x32_bf16 a[116:119], a[60:63], a[88:91], a[116:119]
    s_add_u32 s28, s28, s31
    ds_read_b64_tr_b16 a[88:89], v14 offset:0
    v_mfma_f32_16x16x32_bf16 v[88:91], a[32:35], a[92:95], v[88:91]
    ds_read_b64_tr_b16 a[90:91], v14 offset:2048
    v_mfma_f32_16x16x32_bf16 v[92:95], a[36:39], a[92:95], v[92:95]
    v_mfma_f32_16x16x32_bf16 v[152:155], a[40:43], a[92:95], v[152:155]
    buffer_store_dwordx4 a[220:223], v2, s[24:27], s28 offen sc1
    v_mfma_f32_16x16x32_bf16 v[156:159], a[44:47], a[92:95], v[156:159]
    s_add_u32 s29, s29, s30
    s_mov_b32 s28, s29
    v_mfma_f32_16x16x32_bf16 v[216:219], a[48:51], a[92:95], v[216:219]
    s_sub_u32 s65, s65, 1
    v_mfma_f32_16x16x32_bf16 v[220:223], a[52:55], a[92:95], v[220:223]
    v_mfma_f32_16x16x32_bf16 a[120:123], a[56:59], a[92:95], a[120:123]
    v_mfma_f32_16x16x32_bf16 a[124:127], a[60:63], a[92:95], a[124:127]
    ds_read_b64_tr_b16 a[92:93], v15 offset:0
    ds_read_b64_tr_b16 a[94:95], v15 offset:2048
    s_waitcnt lgkmcnt(15)
    v_mfma_f32_16x16x32_bf16 v[32:35], a[0:3], a[64:67], v[32:35]
    v_mfma_f32_16x16x32_bf16 v[36:39], a[4:7], a[64:67], v[36:39]
    v_mfma_f32_16x16x32_bf16 v[96:99], a[8:11], a[64:67], v[96:99]
    v_mfma_f32_16x16x32_bf16 v[100:103], a[12:15], a[64:67], v[100:103]
    s_add_u32 m0, s61, 0
    s_waitcnt lgkmcnt(13)
    v_mfma_f32_16x16x32_bf16 v[160:163], a[16:19], a[64:67], v[160:163]
    buffer_load_dwordx4 v16, s[40:43], s48 offen offset:0 sc1 lds
    s_waitcnt lgkmcnt(12)
    v_mfma_f32_16x16x32_bf16 v[164:167], a[20:23], a[64:67], v[164:167]
    s_waitcnt lgkmcnt(9)
    v_mfma_f32_16x16x32_bf16 v[224:227], a[24:27], a[64:67], v[224:227]
    s_waitcnt lgkmcnt(8)
    v_mfma_f32_16x16x32_bf16 v[228:231], a[28:31], a[64:67], v[228:231]
    ds_read_b64_tr_b16 a[64:65], v8 offset:16384
    v_mfma_f32_16x16x32_bf16 v[40:43], a[0:3], a[68:71], v[40:43]
    ds_read_b64_tr_b16 a[66:67], v8 offset:18432
    v_mfma_f32_16x16x32_bf16 v[44:47], a[4:7], a[68:71], v[44:47]
    v_mfma_f32_16x16x32_bf16 v[104:107], a[8:11], a[68:71], v[104:107]
    ds_read_b128 a[32:35], v7 offset:0
    v_mfma_f32_16x16x32_bf16 v[108:111], a[12:15], a[68:71], v[108:111]
    v_mfma_f32_16x16x32_bf16 v[168:171], a[16:19], a[68:71], v[168:171]
    buffer_load_dwordx4 v17, s[40:43], s48 offen offset:1024 sc1 lds
    v_mfma_f32_16x16x32_bf16 v[172:175], a[20:23], a[68:71], v[172:175]
    s_add_u32 s48, s48, 128
    v_mfma_f32_16x16x32_bf16 v[232:235], a[24:27], a[68:71], v[232:235]
    ds_read_b128 a[36:39], v7 offset:2048
    v_mfma_f32_16x16x32_bf16 v[236:239], a[28:31], a[68:71], v[236:239]
    ds_read_b64_tr_b16 a[68:69], v9 offset:16384
    v_mfma_f32_16x16x32_bf16 v[48:51], a[0:3], a[72:75], v[48:51]
    ds_read_b64_tr_b16 a[70:71], v9 offset:18432
    v_mfma_f32_16x16x32_bf16 v[52:55], a[4:7], a[72:75], v[52:55]
    v_mfma_f32_16x16x32_bf16 v[112:115], a[8:11], a[72:75], v[112:115]
    ds_read_b128 a[40:43], v7 offset:4096
    v_mfma_f32_16x16x32_bf16 v[116:119], a[12:15], a[72:75], v[116:119]
    v_mfma_f32_16x16x32_bf16 v[176:179], a[16:19], a[72:75], v[176:179]
    buffer_load_dwordx4 v16, s[40:43], s49 offen offset:2048 sc1 lds
    v_mfma_f32_16x16x32_bf16 v[180:183], a[20:23], a[72:75], v[180:183]
    v_mfma_f32_16x16x32_bf16 v[240:243], a[24:27], a[72:75], v[240:243]
    ds_read_b128 a[44:47], v7 offset:6144
    v_mfma_f32_16x16x32_bf16 v[244:247], a[28:31], a[72:75], v[244:247]
    ds_read_b64_tr_b16 a[72:73], v10 offset:16384
    v_mfma_f32_16x16x32_bf16 v[56:59], a[0:3], a[76:79], v[56:59]
    ds_read_b64_tr_b16 a[74:75], v10 offset:18432
    v_mfma_f32_16x16x32_bf16 v[60:63], a[4:7], a[76:79], v[60:63]
    v_mfma_f32_16x16x32_bf16 v[120:123], a[8:11], a[76:79], v[120:123]
    ds_read_b128 a[48:51], v7 offset:8192
    v_mfma_f32_16x16x32_bf16 v[124:127], a[12:15], a[76:79], v[124:127]
    v_mfma_f32_16x16x32_bf16 v[184:187], a[16:19], a[76:79], v[184:187]
    buffer_load_dwordx4 v17, s[40:43], s49 offen offset:3072 sc1 lds
    v_mfma_f32_16x16x32_bf16 v[188:191], a[20:23], a[76:79], v[188:191]
    s_add_u32 s49, s49, 128
    v_mfma_f32_16x16x32_bf16 v[248:251], a[24:27], a[76:79], v[248:251]
    ds_read_b128 a[52:55], v7 offset:10240
    v_mfma_f32_16x16x32_bf16 v[252:255], a[28:31], a[76:79], v[252:255]
    ds_read_b64_tr_b16 a[76:77], v11 offset:16384
    s_waitcnt lgkmcnt(15)
    v_mfma_f32_16x16x32_bf16 v[64:67], a[0:3], a[80:83], v[64:67]
    ds_read_b64_tr_b16 a[78:79], v11 offset:18432
    v_mfma_f32_16x16x32_bf16 v[68:71], a[4:7], a[80:83], v[68:71]
    v_mfma_f32_16x16x32_bf16 v[128:131], a[8:11], a[80:83], v[128:131]
    ds_read_b128 a[56:59], v7 offset:12288
    v_mfma_f32_16x16x32_bf16 v[132:135], a[12:15], a[80:83], v[132:135]
    s_add_u32 m0, s61, 4096
    v_mfma_f32_16x16x32_bf16 v[192:195], a[16:19], a[80:83], v[192:195]
    buffer_load_dwordx4 v16, s[40:43], s50 offen offset:0 sc1 lds
    v_mfma_f32_16x16x32_bf16 v[196:199], a[20:23], a[80:83], v[196:199]
    v_mfma_f32_16x16x32_bf16 a[96:99], a[24:27], a[80:83], a[96:99]
    s_add_u32 s61, s61, 32768
    ds_read_b128 a[60:63], v7 offset:14336
    v_mfma_f32_16x16x32_bf16 a[100:103], a[28:31], a[80:83], a[100:103]
    s_cmp_ge_u32 s61, 98304
    s_cselect_b32 s90, 98304, 0
    ds_read_b64_tr_b16 a[80:81], v12 offset:16384
    v_mfma_f32_16x16x32_bf16 v[72:75], a[0:3], a[84:87], v[72:75]
    s_sub_u32 s61, s61, s90
    ds_read_b64_tr_b16 a[82:83], v12 offset:18432
    v_mfma_f32_16x16x32_bf16 v[76:79], a[4:7], a[84:87], v[76:79]
    s_add_u32 s64, s64, 32768
    v_mfma_f32_16x16x32_bf16 v[136:139], a[8:11], a[84:87], v[136:139]
    buffer_store_dwordx4 a[224:227], v2, s[24:27], s28 offen sc1
    v_mfma_f32_16x16x32_bf16 v[140:143], a[12:15], a[84:87], v[140:143]
    s_add_u32 s28, s28, s31
    v_mfma_f32_16x16x32_bf16 v[200:203], a[16:19], a[84:87], v[200:203]
    buffer_load_dwordx4 v17, s[40:43], s50 offen offset:1024 sc1 lds
    v_mfma_f32_16x16x32_bf16 v[204:207], a[20:23], a[84:87], v[204:207]
    s_add_u32 s50, s50, 128
    v_mfma_f32_16x16x32_bf16 a[104:107], a[24:27], a[84:87], a[104:107]
    s_cmp_ge_u32 s64, 98304
    s_cselect_b32 s63, 4294901760, s59
    s_cselect_b32 s64, 0, s64
    v_mfma_f32_16x16x32_bf16 a[108:111], a[28:31], a[84:87], a[108:111]
    ds_read_b64_tr_b16 a[84:85], v13 offset:16384
    v_mfma_f32_16x16x32_bf16 v[80:83], a[0:3], a[88:91], v[80:83]
    ds_read_b64_tr_b16 a[86:87], v13 offset:18432
    v_mfma_f32_16x16x32_bf16 v[84:87], a[4:7], a[88:91], v[84:87]
    v_mfma_f32_16x16x32_bf16 v[144:147], a[8:11], a[88:91], v[144:147]
    buffer_store_dwordx4 a[228:231], v2, s[24:27], s28 offen sc1
    v_mfma_f32_16x16x32_bf16 v[148:151], a[12:15], a[88:91], v[148:151]
    s_add_u32 s28, s28, s31
    v_mfma_f32_16x16x32_bf16 v[208:211], a[16:19], a[88:91], v[208:211]
    buffer_load_dwordx4 v16, s[40:43], s51 offen offset:2048 sc1 lds
    v_mfma_f32_16x16x32_bf16 v[212:215], a[20:23], a[88:91], v[212:215]
    v_mfma_f32_16x16x32_bf16 a[112:115], a[24:27], a[88:91], a[112:115]
    v_mfma_f32_16x16x32_bf16 a[116:119], a[28:31], a[88:91], a[116:119]
    ds_read_b64_tr_b16 a[88:89], v14 offset:16384
    s_waitcnt lgkmcnt(15)
    v_mfma_f32_16x16x32_bf16 v[88:91], a[0:3], a[92:95], v[88:91]
    ds_read_b64_tr_b16 a[90:91], v14 offset:18432
    v_mfma_f32_16x16x32_bf16 v[92:95], a[4:7], a[92:95], v[92:95]
    v_add_u32 v6, s63, v6
    v_add_u32 v7, s63, v7
    v_mfma_f32_16x16x32_bf16 v[152:155], a[8:11], a[92:95], v[152:155]
    buffer_store_dwordx4 a[232:235], v2, s[24:27], s28 offen sc1
    v_mfma_f32_16x16x32_bf16 v[156:159], a[12:15], a[92:95], v[156:159]
    s_add_u32 s28, s28, s31
    v_mfma_f32_16x16x32_bf16 v[216:219], a[16:19], a[92:95], v[216:219]
    buffer_load_dwordx4 v17, s[40:43], s51 offen offset:3072 sc1 lds
    v_mfma_f32_16x16x32_bf16 v[220:223], a[20:23], a[92:95], v[220:223]
    s_add_u32 s51, s51, 128
    v_mfma_f32_16x16x32_bf16 a[120:123], a[24:27], a[92:95], a[120:123]
    v_mfma_f32_16x16x32_bf16 a[124:127], a[28:31], a[92:95], a[124:127]
    ds_read_b64_tr_b16 a[92:93], v15 offset:16384
    ds_read_b64_tr_b16 a[94:95], v15 offset:18432
    v_mfma_f32_16x16x32_bf16 v[32:35], a[32:35], a[64:67], v[32:35]
    v_xor_b32 v8, s60, v8
    v_xor_b32 v9, s60, v9
    v_mfma_f32_16x16x32_bf16 v[36:39], a[36:39], a[64:67], v[36:39]
    v_xor_b32 v10, s60, v10
    v_xor_b32 v11, s60, v11
    s_waitcnt lgkmcnt(15)
    v_mfma_f32_16x16x32_bf16 v[96:99], a[40:43], a[64:67], v[96:99]
    v_xor_b32 v12, s60, v12
    v_xor_b32 v13, s60, v13
    v_mfma_f32_16x16x32_bf16 v[100:103], a[44:47], a[64:67], v[100:103]
    v_xor_b32 v14, s60, v14
    v_xor_b32 v15, s60, v15
    s_waitcnt lgkmcnt(13)
    v_mfma_f32_16x16x32_bf16 v[160:163], a[48:51], a[64:67], v[160:163]
    s_waitcnt lgkmcnt(12)
    v_mfma_f32_16x16x32_bf16 v[164:167], a[52:55], a[64:67], v[164:167]
    s_waitcnt lgkmcnt(9)
    v_mfma_f32_16x16x32_bf16 v[224:227], a[56:59], a[64:67], v[224:227]
    s_waitcnt vmcnt(16) lgkmcnt(0)
    v_mfma_f32_16x16x32_bf16 v[228:231], a[60:63], a[64:67], v[228:231]
    s_barrier
    ds_read_b64_tr_b16 a[64:65], v8 offset:0
    v_mfma_f32_16x16x32_bf16 v[40:43], a[32:35], a[68:71], v[40:43]
    s_add_u32 m0, s62, 0
    ds_read_b64_tr_b16 a[66:67], v8 offset:2048
    v_mfma_f32_16x16x32_bf16 v[44:47], a[36:39], a[68:71], v[44:47]
    buffer_load_dwordx4 v18, s[44:47], s52 offen offset:0 sc1 lds
    v_mfma_f32_16x16x32_bf16 v[104:107], a[40:43], a[68:71], v[104:107]
    ds_read_b128 a[0:3], v6 offset:0
    v_mfma_f32_16x16x32_bf16 v[108:111], a[44:47], a[68:71], v[108:111]
    v_mfma_f32_16x16x32_bf16 v[168:171], a[48:51], a[68:71], v[168:171]
    v_mfma_f32_16x16x32_bf16 v[172:175], a[52:55], a[68:71], v[172:175]
    buffer_load_dwordx4 v19, s[44:47], s52 offen offset:1024 sc1 lds
    v_mfma_f32_16x16x32_bf16 v[232:235], a[56:59], a[68:71], v[232:235]
    s_add_u32 s52, s52, s56
    ds_read_b128 a[4:7], v6 offset:2048
    v_mfma_f32_16x16x32_bf16 v[236:239], a[60:63], a[68:71], v[236:239]
    ds_read_b64_tr_b16 a[68:69], v9 offset:0
    v_mfma_f32_16x16x32_bf16 v[48:51], a[32:35], a[72:75], v[48:51]
    ds_read_b64_tr_b16 a[70:71], v9 offset:2048
    v_mfma_f32_16x16x32_bf16 v[52:55], a[36:39], a[72:75], v[52:55]
    buffer_load_dwordx4 v18, s[44:47], s53 offen offset:2048 sc1 lds
    v_mfma_f32_16x16x32_bf16 v[112:115], a[40:43], a[72:75], v[112:115]
    ds_read_b128 a[8:11], v6 offset:4096
    v_mfma_f32_16x16x32_bf16 v[116:119], a[44:47], a[72:75], v[116:119]
    v_mfma_f32_16x16x32_bf16 v[176:179], a[48:51], a[72:75], v[176:179]
    v_mfma_f32_16x16x32_bf16 v[180:183], a[52:55], a[72:75], v[180:183]
    buffer_load_dwordx4 v19, s[44:47], s53 offen offset:3072 sc1 lds
    v_mfma_f32_16x16x32_bf16 v[240:243], a[56:59], a[72:75], v[240:243]
    s_add_u32 s53, s53, s56
    ds_read_b128 a[12:15], v6 offset:6144
    v_mfma_f32_16x16x32_bf16 v[244:247], a[60:63], a[72:75], v[244:247]
    ds_read_b64_tr_b16 a[72:73], v10 offset:0
    v_mfma_f32_16x16x32_bf16 v[56:59], a[32:35], a[76:79], v[56:59]
    s_add_u32 m0, s62, 4096
    ds_read_b64_tr_b16 a[74:75], v10 offset:2048
    v_mfma_f32_16x16x32_bf16 v[60:63], a[36:39], a[76:79], v[60:63]
    buffer_load_dwordx4 v20, s[44:47], s54 offen offset:0 sc1 lds
    v_mfma_f32_16x16x32_bf16 v[120:123], a[40:43], a[76:79], v[120:123]
    ds_read_b128 a[16:19], v6 offset:8192
    v_mfma_f32_16x16x32_bf16 v[124:127], a[44:47], a[76:79], v[124:127]
    s_xor_b32 s62, s62, 229376
    v_mfma_f32_16x16x32_bf16 v[184:187], a[48:51], a[76:79], v[184:187]
    v_mfma_f32_16x16x32_bf16 v[188:191], a[52:55], a[76:79], v[188:191]
    buffer_load_dwordx4 v21, s[44:47], s54 offen offset:1024 sc1 lds
    v_mfma_f32_16x16x32_bf16 v[248:251], a[56:59], a[76:79], v[248:251]
    s_add_u32 s54, s54, s56
    ds_read_b128 a[20:23], v6 offset:10240
    v_mfma_f32_16x16x32_bf16 v[252:255], a[60:63], a[76:79], v[252:255]
    ds_read_b64_tr_b16 a[76:77], v11 offset:0
    v_mfma_f32_16x16x32_bf16 v[64:67], a[32:35], a[80:83], v[64:67]
    ds_read_b64_tr_b16 a[78:79], v11 offset:2048
    v_mfma_f32_16x16x32_bf16 v[68:71], a[36:39], a[80:83], v[68:71]
    buffer_load_dwordx4 v20, s[44:47], s55 offen offset:2048 sc1 lds
    v_mfma_f32_16x16x32_bf16 v[128:131], a[40:43], a[80:83], v[128:131]
    ds_read_b128 a[24:27], v6 offset:12288
    v_mfma_f32_16x16x32_bf16 v[132:135], a[44:47], a[80:83], v[132:135]
    v_mfma_f32_16x16x32_bf16 v[192:195], a[48:51], a[80:83], v[192:195]
    v_mfma_f32_16x16x32_bf16 v[196:199], a[52:55], a[80:83], v[196:199]
    buffer_load_dwordx4 v21, s[44:47], s55 offen offset:3072 sc1 lds
    v_mfma_f32_16x16x32_bf16 a[96:99], a[56:59], a[80:83], a[96:99]
    s_add_u32 s55, s55, s56
    ds_read_b128 a[28:31], v6 offset:14336
    v_mfma_f32_16x16x32_bf16 a[100:103], a[60:63], a[80:83], a[100:103]
    ds_read_b64_tr_b16 a[80:81], v12 offset:0
    v_mfma_f32_16x16x32_bf16 v[72:75], a[32:35], a[84:87], v[72:75]
    ds_read_b64_tr_b16 a[82:83], v12 offset:2048
    v_mfma_f32_16x16x32_bf16 v[76:79], a[36:39], a[84:87], v[76:79]
    v_mfma_f32_16x16x32_bf16 v[136:139], a[40:43], a[84:87], v[136:139]
    buffer_store_dwordx4 a[236:239], v2, s[24:27], s28 offen sc1
    v_mfma_f32_16x16x32_bf16 v[140:143], a[44:47], a[84:87], v[140:143]
    s_add_u32 s28, s28, s31
    v_mfma_f32_16x16x32_bf16 v[200:203], a[48:51], a[84:87], v[200:203]
    v_mfma_f32_16x16x32_bf16 v[204:207], a[52:55], a[84:87], v[204:207]
    v_mfma_f32_16x16x32_bf16 a[104:107], a[56:59], a[84:87], a[104:107]
    buffer_store_dwordx4 a[240:243], v2, s[24:27], s28 offen sc1
    v_mfma_f32_16x16x32_bf16 a[108:111], a[60:63], a[84:87], a[108:111]
    s_add_u32 s28, s28, s31
    ds_read_b64_tr_b16 a[84:85], v13 offset:0
    v_mfma_f32_16x16x32_bf16 v[80:83], a[32:35], a[88:91], v[80:83]
    ds_read_b64_tr_b16 a[86:87], v13 offset:2048
    v_mfma_f32_16x16x32_bf16 v[84:87], a[36:39], a[88:91], v[84:87]
    v_mfma_f32_16x16x32_bf16 v[144:147], a[40:43], a[88:91], v[144:147]
    buffer_store_dwordx4 a[244:247], v2, s[24:27], s28 offen sc1
    v_mfma_f32_16x16x32_bf16 v[148:151], a[44:47], a[88:91], v[148:151]
    s_add_u32 s28, s28, s31
    v_mfma_f32_16x16x32_bf16 v[208:211], a[48:51], a[88:91], v[208:211]
    v_mfma_f32_16x16x32_bf16 v[212:215], a[52:55], a[88:91], v[212:215]
    v_mfma_f32_16x16x32_bf16 a[112:115], a[56:59], a[88:91], a[112:115]
    buffer_store_dwordx4 a[248:251], v2, s[24:27], s28 offen sc1
    v_mfma_f32_16x16x32_bf16 a[116:119], a[60:63], a[88:91], a[116:119]
    s_add_u32 s28, s28, s31
    ds_read_b64_tr_b16 a[88:89], v14 offset:0
    v_mfma_f32_16x16x32_bf16 v[88:91], a[32:35], a[92:95], v[88:91]
    ds_read_b64_tr_b16 a[90:91], v14 offset:2048
    v_mfma_f32_16x16x32_bf16 v[92:95], a[36:39], a[92:95], v[92:95]
    v_mfma_f32_16x16x32_bf16 v[152:155], a[40:43], a[92:95], v[152:155]
    buffer_store_dwordx4 a[252:255], v2, s[24:27], s28 offen sc1
    v_mfma_f32_16x16x32_bf16 v[156:159], a[44:47], a[92:95], v[156:159]
    s_add_u32 s29, s29, s30
    s_mov_b32 s28, s29
    v_mfma_f32_16x16x32_bf16 v[216:219], a[48:51], a[92:95], v[216:219]
    s_sub_u32 s65, s65, 1
    v_mfma_f32_16x16x32_bf16 v[220:223], a[52:55], a[92:95], v[220:223]
    v_mfma_f32_16x16x32_bf16 a[120:123], a[56:59], a[92:95], a[120:123]
    v_mfma_f32_16x16x32_bf16 a[124:127], a[60:63], a[92:95], a[124:127]
    ds_read_b64_tr_b16 a[92:93], v15 offset:0
    ds_read_b64_tr_b16 a[94:95], v15 offset:2048
m_loop20:
    s_waitcnt lgkmcnt(15)
    v_mfma_f32_16x16x32_bf16 v[32:35], a[0:3], a[64:67], v[32:35]
    v_mfma_f32_16x16x32_bf16 v[36:39], a[4:7], a[64:67], v[36:39]
    v_mfma_f32_16x16x32_bf16 v[96:99], a[8:11], a[64:67], v[96:99]
    v_mfma_f32_16x16x32_bf16 v[100:103], a[12:15], a[64:67], v[100:103]
    s_add_u32 m0, s61, 0
    s_waitcnt lgkmcnt(13)
    v_mfma_f32_16x16x32_bf16 v[160:163], a[16:19], a[64:67], v[160:163]
    buffer_load_dwordx4 v16, s[40:43], s48 offen offset:0 sc1 lds
    s_waitcnt lgkmcnt(12)
    v_mfma_f32_16x16x32_bf16 v[164:167], a[20:23], a[64:67], v[164:167]
    s_waitcnt lgkmcnt(9)
    v_mfma_f32_16x16x32_bf16 v[224:227], a[24:27], a[64:67], v[224:227]
    s_waitcnt lgkmcnt(8)
    v_mfma_f32_16x16x32_bf16 v[228:231], a[28:31], a[64:67], v[228:231]
    ds_read_b64_tr_b16 a[64:65], v8 offset:16384
    v_mfma_f32_16x16x32_bf16 v[40:43], a[0:3], a[68:71], v[40:43]
    ds_read_b64_tr_b16 a[66:67], v8 offset:18432
    v_mfma_f32_16x16x32_bf16 v[44:47], a[4:7], a[68:71], v[44:47]
    v_mfma_f32_16x16x32_bf16 v[104:107], a[8:11], a[68:71], v[104:107]
    ds_read_b128 a[32:35], v7 offset:0
    v_mfma_f32_16x16x32_bf16 v[108:111], a[12:15], a[68:71], v[108:111]
    v_mfma_f32_16x16x32_bf16 v[168:171], a[16:19], a[68:71], v[168:171]
    buffer_load_dwordx4 v17, s[40:43], s48 offen offset:1024 sc1 lds
    v_mfma_f32_16x16x32_bf16 v[172:175], a[20:23], a[68:71], v[172:175]
    s_add_u32 s48, s48, 128
    v_mfma_f32_16x16x32_bf16 v[232:235], a[24:27], a[68:71], v[232:235]
    ds_read_b128 a[36:39], v7 offset:2048
    v_mfma_f32_16x16x32_bf16 v[236:239], a[28:31], a[68:71], v[236:239]
    ds_read_b64_tr_b16 a[68:69], v9 offset:16384
    v_mfma_f32_16x16x32_bf16 v[48:51], a[0:3], a[72:75], v[48:51]
    ds_read_b64_tr_b16 a[70:71], v9 offset:18432
    v_mfma_f32_16x16x32_bf16 v[52:55], a[4:7], a[72:75], v[52:55]
    v_mfma_f32_16x16x32_bf16 v[112:115], a[8:11], a[72:75], v[112:115]
    ds_read_b128 a[40:43], v7 offset:4096
    v_mfma_f32_16x16x32_bf16 v[116:119], a[12:15], a[72:75], v[116:119]
    v_mfma_f32_16x16x32_bf16 v[176:179], a[16:19], a[72:75], v[176:179]
    buffer_load_dwordx4 v16, s[40:43], s49 offen offset:2048 sc1 lds
    v_mfma_f32_16x16x32_bf16 v[180:183], a[20:23], a[72:75], v[180:183]
    v_mfma_f32_16x16x32_bf16 v[240:243], a[24:27], a[72:75], v[240:243]
    ds_read_b128 a[44:47], v7 offset:6144
    v_mfma_f32_16x16x32_bf16 v[244:247], a[28:31], a[72:75], v[244:247]
    ds_read_b64_tr_b16 a[72:73], v10 offset:16384
    v_mfma_f32_16x16x32_bf16 v[56:59], a[0:3], a[76:79], v[56:59]
    ds_read_b64_tr_b16 a[74:75], v10 offset:18432
    v_mfma_f32_16x16x32_bf16 v[60:63], a[4:7], a[76:79], v[60:63]
    v_mfma_f32_16x16x32_bf16 v[120:123], a[8:11], a[76:79], v[120:123]
    ds_read_b128 a[48:51], v7 offset:8192
    v_mfma_f32_16x16x32_bf16 v[124:127], a[12:15], a[76:79], v[124:127]
    v_mfma_f32_16x16x32_bf16 v[184:187], a[16:19], a[76:79], v[184:187]
    buffer_load_dwordx4 v17, s[40:43], s49 offen offset:3072 sc1 lds
    v_mfma_f32_16x16x32_bf16 v[188:191], a[20:23], a[76:79], v[188:191]
    s_add_u32 s49, s49, 128
    v_mfma_f32_16x16x32_bf16 v[248:251], a[24:27], a[76:79], v[248:251]
    ds_read_b128 a[52:55], v7 offset:10240
    v_mfma_f32_16x16x32_bf16 v[252:255], a[28:31], a[76:79], v[252:255]
    ds_read_b64_tr_b16 a[76:77], v11 offset:16384
    s_waitcnt lgkmcnt(15)
    v_mfma_f32_16x16x32_bf16 v[64:67], a[0:3], a[80:83], v[64:67]
    ds_read_b64_tr_b16 a[78:79], v11 offset:18432
    v_mfma_f32_16x16x32_bf16 v[68:71], a[4:7], a[80:83], v[68:71]
    v_mfma_f32_16x16x32_bf16 v[128:131], a[8:11], a[80:83], v[128:131]
    ds_read_b128 a[56:59], v7 offset:12288
    v_mfma_f32_16x16x32_bf16 v[132:135], a[12:15], a[80:83], v[132:135]
    s_add_u32 m0, s61, 4096
    v_mfma_f32_16x16x32_bf16 v[192:195], a[16:19], a[80:83], v[192:195]
    buffer_load_dwordx4 v16, s[40:43], s50 offen offset:0 sc1 lds
    v_mfma_f32_16x16x32_bf16 v[196:199], a[20:23], a[80:83], v[196:199]
    v_mfma_f32_16x16x32_bf16 a[96:99], a[24:27], a[80:83], a[96:99]
    s_add_u32 s61, s61, 32768
    ds_read_b128 a[60:63], v7 offset:14336
    v_mfma_f32_16x16x32_bf16 a[100:103], a[28:31], a[80:83], a[100:103]
    s_cmp_ge_u32 s61, 98304
    s_cselect_b32 s90, 98304, 0
    ds_read_b64_tr_b16 a[80:81], v12 offset:16384
    v_mfma_f32_16x16x32_bf16 v[72:75], a[0:3], a[84:87], v[72:75]
    s_sub_u32 s61, s61, s90
    ds_read_b64_tr_b16 a[82:83], v12 offset:18432
    v_mfma_f32_16x16x32_bf16 v[76:79], a[4:7], a[84:87], v[76:79]
    s_add_u32 s64, s64, 32768
    v_mfma_f32_16x16x32_bf16 v[136:139], a[8:11], a[84:87], v[136:139]
    s_cmp_ge_u32 s64, 98304
    s_cselect_b32 s63, 4294901760, s59
    s_cselect_b32 s64, 0, s64
    v_mfma_f32_16x16x32_bf16 v[140:143], a[12:15], a[84:87], v[140:143]
    v_mfma_f32_16x16x32_bf16 v[200:203], a[16:19], a[84:87], v[200:203]
    buffer_load_dwordx4 v17, s[40:43], s50 offen offset:1024 sc1 lds
    v_mfma_f32_16x16x32_bf16 v[204:207], a[20:23], a[84:87], v[204:207]
    s_add_u32 s50, s50, 128
    v_mfma_f32_16x16x32_bf16 a[104:107], a[24:27], a[84:87], a[104:107]
    v_mfma_f32_16x16x32_bf16 a[108:111], a[28:31], a[84:87], a[108:111]
    ds_read_b64_tr_b16 a[84:85], v13 offset:16384
    v_mfma_f32_16x16x32_bf16 v[80:83], a[0:3], a[88:91], v[80:83]
    ds_read_b64_tr_b16 a[86:87], v13 offset:18432
    v_mfma_f32_16x16x32_bf16 v[84:87], a[4:7], a[88:91], v[84:87]
    v_mfma_f32_16x16x32_bf16 v[144:147], a[8:11], a[88:91], v[144:147]
    v_mfma_f32_16x16x32_bf16 v[148:151], a[12:15], a[88:91], v[148:151]
    v_mfma_f32_16x16x32_bf16 v[208:211], a[16:19], a[88:91], v[208:211]
    buffer_load_dwordx4 v16, s[40:43], s51 offen offset:2048 sc1 lds
    v_mfma_f32_16x16x32_bf16 v[212:215], a[20:23], a[88:91], v[212:215]
    v_mfma_f32_16x16x32_bf16 a[112:115], a[24:27], a[88:91], a[112:115]
    v_mfma_f32_16x16x32_bf16 a[116:119], a[28:31], a[88:91], a[116:119]
    ds_read_b64_tr_b16 a[88:89], v14 offset:16384
    s_waitcnt lgkmcnt(15)
    v_mfma_f32_16x16x32_bf16 v[88:91], a[0:3], a[92:95], v[88:91]
    ds_read_b64_tr_b16 a[90:91], v14 offset:18432
    v_mfma_f32_16x16x32_bf16 v[92:95], a[4:7], a[92:95], v[92:95]
    v_add_u32 v6, s63, v6
    v_add_u32 v7, s63, v7
    v_mfma_f32_16x16x32_bf16 v[152:155], a[8:11], a[92:95], v[152:155]
    v_mfma_f32_16x16x32_bf16 v[156:159], a[12:15], a[92:95], v[156:159]
    v_mfma_f32_16x16x32_bf16 v[216:219], a[16:19], a[92:95], v[216:219]
    buffer_load_dwordx4 v17, s[40:43], s51 offen offset:3072 sc1 lds
    v_mfma_f32_16x16x32_bf16 v[220:223], a[20:23], a[92:95], v[220:223]
    s_add_u32 s51, s51, 128
    v_mfma_f32_16x16x32_bf16 a[120:123], a[24:27], a[92:95], a[120:123]
    v_mfma_f32_16x16x32_bf16 a[124:127], a[28:31], a[92:95], a[124:127]
    ds_read_b64_tr_b16 a[92:93], v15 offset:16384
    ds_read_b64_tr_b16 a[94:95], v15 offset:18432
    v_mfma_f32_16x16x32_bf16 v[32:35], a[32:35], a[64:67], v[32:35]
    v_xor_b32 v8, s60, v8
    v_xor_b32 v9, s60, v9
    v_mfma_f32_16x16x32_bf16 v[36:39], a[36:39], a[64:67], v[36:39]
    v_xor_b32 v10, s60, v10
    v_xor_b32 v11, s60, v11
    s_waitcnt lgkmcnt(15)
    v_mfma_f32_16x16x32_bf16 v[96:99], a[40:43], a[64:67], v[96:99]
    v_xor_b32 v12, s60, v12
    v_xor_b32 v13, s60, v13
    v_mfma_f32_16x16x32_bf16 v[100:103], a[44:47], a[64:67], v[100:103]
    v_xor_b32 v14, s60, v14
    v_xor_b32 v15, s60, v15
    s_waitcnt lgkmcnt(13)
    v_mfma_f32_16x16x32_bf16 v[160:163], a[48:51], a[64:67], v[160:163]
    s_waitcnt lgkmcnt(12)
    v_mfma_f32_16x16x32_bf16 v[164:167], a[52:55], a[64:67], v[164:167]
    s_waitcnt lgkmcnt(9)
    v_mfma_f32_16x16x32_bf16 v[224:227], a[56:59], a[64:67], v[224:227]
    s_waitcnt vmcnt(8) lgkmcnt(0)
    v_mfma_f32_16x16x32_bf16 v[228:231], a[60:63], a[64:67], v[228:231]
    s_barrier
    ds_read_b64_tr_b16 a[64:65], v8 offset:0
    v_mfma_f32_16x16x32_bf16 v[40:43], a[32:35], a[68:71], v[40:43]
    s_add_u32 m0, s62, 0
    ds_read_b64_tr_b16 a[66:67], v8 offset:2048
    v_mfma_f32_16x16x32_bf16 v[44:47], a[36:39], a[68:71], v[44:47]
    buffer_load_dwordx4 v18, s[44:47], s52 offen offset:0 sc1 lds
    v_mfma_f32_16x16x32_bf16 v[104:107], a[40:43], a[68:71], v[104:107]
    ds_read_b128 a[0:3], v6 offset:0
    v_mfma_f32_16x16x32_bf16 v[108:111], a[44:47], a[68:71], v[108:111]
    v_mfma_f32_16x16x32_bf16 v[168:171], a[48:51], a[68:71], v[168:171]
    v_mfma_f32_16x16x32_bf16 v[172:175], a[52:55], a[68:71], v[172:175]
    buffer_load_dwordx4 v19, s[44:47], s52 offen offset:1024 sc1 lds
    v_mfma_f32_16x16x32_bf16 v[232:235], a[56:59], a[68:71], v[232:235]
    s_add_u32 s52, s52, s56
    ds_read_b128 a[4:7], v6 offset:2048
    v_mfma_f32_16x16x32_bf16 v[236:239], a[60:63], a[68:71], v[236:239]
    ds_read_b64_tr_b16 a[68:69], v9 offset:0
    v_mfma_f32_16x16x32_bf16 v[48:51], a[32:35], a[72:75], v[48:51]
    ds_read_b64_tr_b16 a[70:71], v9 offset:2048
    v_mfma_f32_16x16x32_bf16 v[52:55], a[36:39], a[72:75], v[52:55]
    buffer_load_dwordx4 v18, s[44:47], s53 offen offset:2048 sc1 lds
    v_mfma_f32_16x16x32_bf16 v[112:115], a[40:43], a[72:75], v[112:115]
    ds_read_b128 a[8:11], v6 offset:4096
    v_mfma_f32_16x16x32_bf16 v[116:119], a[44:47], a[72:75], v[116:119]
    v_mfma_f32_16x16x32_bf16 v[176:179], a[48:51], a[72:75], v[176:179]
    v_mfma_f32_16x16x32_bf16 v[180:183], a[52:55], a[72:75], v[180:183]
    buffer_load_dwordx4 v19, s[44:47], s53 offen offset:3072 sc1 lds
    v_mfma_f32_16x16x32_bf16 v[240:243], a[56:59], a[72:75], v[240:243]
    s_add_u32 s53, s53, s56
    ds_read_b128 a[12:15], v6 offset:6144
    v_mfma_f32_16x16x32_bf16 v[244:247], a[60:63], a[72:75], v[244:247]
    ds_read_b64_tr_b16 a[72:73], v10 offset:0
    v_mfma_f32_16x16x32_bf16 v[56:59], a[32:35], a[76:79], v[56:59]
    s_add_u32 m0, s62, 4096
    ds_read_b64_tr_b16 a[74:75], v10 offset:2048
    v_mfma_f32_16x16x32_bf16 v[60:63], a[36:39], a[76:79], v[60:63]
    buffer_load_dwordx4 v20, s[44:47], s54 offen offset:0 sc1 lds
    v_mfma_f32_16x16x32_bf16 v[120:123], a[40:43], a[76:79], v[120:123]
    ds_read_b128 a[16:19], v6 offset:8192
    v_mfma_f32_16x16x32_bf16 v[124:127], a[44:47], a[76:79], v[124:127]
    s_xor_b32 s62, s62, 229376
    v_mfma_f32_16x16x32_bf16 v[184:187], a[48:51], a[76:79], v[184:187]
    v_mfma_f32_16x16x32_bf16 v[188:191], a[52:55], a[76:79], v[188:191]
    buffer_load_dwordx4 v21, s[44:47], s54 offen offset:1024 sc1 lds
    v_mfma_f32_16x16x32_bf16 v[248:251], a[56:59], a[76:79], v[248:251]
    s_add_u32 s54, s54, s56
    ds_read_b128 a[20:23], v6 offset:10240
    v_mfma_f32_16x16x32_bf16 v[252:255], a[60:63], a[76:79], v[252:255]
    ds_read_b64_tr_b16 a[76:77], v11 offset:0
    v_mfma_f32_16x16x32_bf16 v[64:67], a[32:35], a[80:83], v[64:67]
    ds_read_b64_tr_b16 a[78:79], v11 offset:2048
    v_mfma_f32_16x16x32_bf16 v[68:71], a[36:39], a[80:83], v[68:71]
    buffer_load_dwordx4 v20, s[44:47], s55 offen offset:2048 sc1 lds
    v_mfma_f32_16x16x32_bf16 v[128:131], a[40:43], a[80:83], v[128:131]
    ds_read_b128 a[24:27], v6 offset:12288
    v_mfma_f32_16x16x32_bf16 v[132:135], a[44:47], a[80:83], v[132:135]
    v_mfma_f32_16x16x32_bf16 v[192:195], a[48:51], a[80:83], v[192:195]
    v_mfma_f32_16x16x32_bf16 v[196:199], a[52:55], a[80:83], v[196:199]
    buffer_load_dwordx4 v21, s[44:47], s55 offen offset:3072 sc1 lds
    v_mfma_f32_16x16x32_bf16 a[96:99], a[56:59], a[80:83], a[96:99]
    s_add_u32 s55, s55, s56
    ds_read_b128 a[28:31], v6 offset:14336
    v_mfma_f32_16x16x32_bf16 a[100:103], a[60:63], a[80:83], a[100:103]
    ds_read_b64_tr_b16 a[80:81], v12 offset:0
    v_mfma_f32_16x16x32_bf16 v[72:75], a[32:35], a[84:87], v[72:75]
    ds_read_b64_tr_b16 a[82:83], v12 offset:2048
    v_mfma_f32_16x16x32_bf16 v[76:79], a[36:39], a[84:87], v[76:79]
    v_mfma_f32_16x16x32_bf16 v[136:139], a[40:43], a[84:87], v[136:139]
    v_mfma_f32_16x16x32_bf16 v[140:143], a[44:47], a[84:87], v[140:143]
    v_mfma_f32_16x16x32_bf16 v[200:203], a[48:51], a[84:87], v[200:203]
    v_mfma_f32_16x16x32_bf16 v[204:207], a[52:55], a[84:87], v[204:207]
    v_mfma_f32_16x16x32_bf16 a[104:107], a[56:59], a[84:87], a[104:107]
    v_mfma_f32_16x16x32_bf16 a[108:111], a[60:63], a[84:87], a[108:111]
    ds_read_b64_tr_b16 a[84:85], v13 offset:0
    v_mfma_f32_16x16x32_bf16 v[80:83], a[32:35], a[88:91], v[80:83]
    ds_read_b64_tr_b16 a[86:87], v13 offset:2048
    v_mfma_f32_16x16x32_bf16 v[84:87], a[36:39], a[88:91], v[84:87]
    v_mfma_f32_16x16x32_bf16 v[144:147], a[40:43], a[88:91], v[144:147]
    v_mfma_f32_16x16x32_bf16 v[148:151], a[44:47], a[88:91], v[148:151]
    v_mfma_f32_16x16x32_bf16 v[208:211], a[48:51], a[88:91], v[208:211]
    v_mfma_f32_16x16x32_bf16 v[212:215], a[52:55], a[88:91], v[212:215]
    v_mfma_f32_16x16x32_bf16 a[112:115], a[56:59], a[88:91], a[112:115]
    v_mfma_f32_16x16x32_bf16 a[116:119], a[60:63], a[88:91], a[116:119]
    ds_read_b64_tr_b16 a[88:89], v14 offset:0
    v_mfma_f32_16x16x32_bf16 v[88:91], a[32:35], a[92:95], v[88:91]
    ds_read_b64_tr_b16 a[90:91], v14 offset:2048
    v_mfma_f32_16x16x32_bf16 v[92:95], a[36:39], a[92:95], v[92:95]
    v_mfma_f32_16x16x32_bf16 v[152:155], a[40:43], a[92:95], v[152:155]
    v_mfma_f32_16x16x32_bf16 v[156:159], a[44:47], a[92:95], v[156:159]
    v_mfma_f32_16x16x32_bf16 v[216:219], a[48:51], a[92:95], v[216:219]
    s_sub_u32 s65, s65, 1
    v_mfma_f32_16x16x32_bf16 v[220:223], a[52:55], a[92:95], v[220:223]
    v_mfma_f32_16x16x32_bf16 a[120:123], a[56:59], a[92:95], a[120:123]
    s_cmp_gt_u32 s65, s67
    v_mfma_f32_16x16x32_bf16 a[124:127], a[60:63], a[92:95], a[124:127]
    ds_read_b64_tr_b16 a[92:93], v15 offset:0
    ds_read_b64_tr_b16 a[94:95], v15 offset:2048
    s_cbranch_scc1 m_loop20
    s_cmp_lg_u32 s65, 0
    s_cbranch_scc1 m_dosw21
m_epi12:
    s_cmp_eq_u32 s94, 0
    s_cbranch_scc1 m_last24
    s_mov_b32 s3, 1048576
m_spin28:
    v_readfirstlane_b32 s4, v4
    v_readfirstlane_b32 s5, v5
    s_nop 3
    s_cmp_lg_u32 s4, 0
    s_cbranch_scc1 m_ok29
    s_sub_u32 s3, s3, 1
    s_cbranch_scc1 m_ok29
    s_sleep 32
    buffer_load_dwordx2 v[4:5], off, s[12:15], 0 sc1
    s_waitcnt vmcnt(0)
    s_branch m_spin28
m_ok29:
    s_cmp_ge_u32 s68, 16
    s_cbranch_scc1 m_q031
    s_call_b64 s[20:21], m_epf22
    s_mov_b32 s17, s101
    s_mov_b32 s66, 2
    s_branch m_q130
m_q031:
    s_call_b64 s[20:21], m_eps23
    s_mov_b32 s17, s101
    s_mov_b32 s28, s98
    s_mov_b32 s29, s98
    s_mov_b32 s30, s99
    s_mov_b32 s31, s100
    s_mov_b32 s26, 268435456
m_q130:
    s_mov_b32 s95, s82
    s_mov_b32 s96, s83
    s_mov_b32 s97, s84
    s_mov_b32 s98, s85
    s_mov_b32 s99, s86
    s_mov_b32 s100, s87
    s_mov_b32 s101, s88
    s_sub_u32 s67, s95, 5
    s_mov_b32 s94, 0
    s_branch m_tile11
m_last24:
    s_cmp_eq_u32 s70, 0
    s_cbranch_scc1 m_kvl27
    buffer_load_dwordx2 v[4:5], off, s[12:15], 0 sc1
    s_call_b64 s[20:21], m_epf22
    s_waitcnt vmcnt(0)
    s_barrier
    s_mov_b32 s3, 1048576
m_spin32:
    v_readfirstlane_b32 s4, v4
    v_readfirstlane_b32 s5, v5
    s_nop 3
    s_cmp_lg_u32 s4, 0
    s_cbranch_scc1 m_ok33
    s_sub_u32 s3, s3, 1
    s_cbranch_scc1 m_ok33
    s_sleep 32
    buffer_load_dwordx2 v[4:5], off, s[12:15], 0 sc1
    s_waitcnt vmcnt(0)
    s_branch m_spin32
m_ok33:
    s_cmp_lg_u32 s16, 0
    s_cbranch_scc1 m_np34
    v_mov_b32 v4, s4
    v_mov_b32 v5, s5
    s_add_u32 s90, s101, 117440512
    s_mov_b64 exec, 1
    buffer_store_dwordx2 v[4:5], off, s[8:11], s90 sc1
    s_mov_b64 exec, -1
m_np34:
    s_cmp_lg_u32 s16, 0
    s_cbranch_scc1 m_pw35
    s_and_b32 s92, s2, 7
    s_lshl_b32 s92, s92, 2
    s_bfe_u32 s93, s2, 0x20003
    s_add_u32 s92, s92, s93
    s_lshr_b32 s93, s2, 5
    s_lshl_b32 s93, s93, 2
    s_or_b32 s93, s93, 0x40000
    s_lshr_b32 s90, s92, 1
    s_lshl_b32 s90, s90, 7
    s_add_u32 s90, s90, 117440512
    s_bfe_u32 s91, 873473623, s93
    s_lshr_b32 s91, s91, 1
    v_mov_b32 v0, s91
    v_add_u32 v4, 8, v1
    v_cmp_gt_u32 vcc, 8, v1
    s_nop 1
    v_cndmask_b32 v0, v0, v4, vcc
    s_bfe_u32 s91, 4225681832, s93
    s_lshr_b32 s91, s91, 1
    v_writelane_b32 v0, s91, 8
    v_lshlrev_b32 v0, 3, v0
    buffer_load_dwordx2 v[4:5], v0, s[8:11], s90 offen sc1
    s_waitcnt vmcnt(0)
    s_mov_b32 s3, 1048576
m_spin36:
    v_cmp_ne_u64 s[22:23], s[4:5], v[4:5]
    s_nop 3
    s_cmp_eq_u64 s[22:23], 0
    s_cbranch_scc1 m_ok37
    s_sub_u32 s3, s3, 1
    s_cbranch_scc1 m_ok37
    s_sleep 16
    s_and_b32 s92, s2, 7
    s_lshl_b32 s92, s92, 2
    s_bfe_u32 s93, s2, 0x20003
    s_add_u32 s92, s92, s93
    s_lshr_b32 s93, s2, 5
    s_lshl_b32 s93, s93, 2
    s_or_b32 s93, s93, 0x40000
    s_lshr_b32 s90, s92, 1
    s_lshl_b32 s90, s90, 7
    s_add_u32 s90, s90, 117440512
    s_bfe_u32 s91, 873473623, s93
    s_lshr_b32 s91, s91, 1
    v_mov_b32 v0, s91
    v_add_u32 v4, 8, v1
    v_cmp_gt_u32 vcc, 8, v1
    s_nop 1
    v_cndmask_b32 v0, v0, v4, vcc
    s_bfe_u32 s91, 4225681832, s93
    s_lshr_b32 s91, s91, 1
    v_writelane_b32 v0, s91, 8
    v_lshlrev_b32 v0, 3, v0
    buffer_load_dwordx2 v[4:5], v0, s[8:11], s90 offen sc1
    s_waitcnt vmcnt(0)
    s_branch m_spin36
m_ok37:
m_pw35:
    s_barrier
    s_and_b32 s92, s2, 7
    s_lshl_b32 s92, s92, 2
    s_bfe_u32 s93, s2, 0x20003
    s_add_u32 s92, s92, s93
    s_lshr_b32 s93, s2, 5
    s_lshl_b32 s93, s93, 2
    s_or_b32 s93, s93, 0x40000
    s_bfe_u32 s90, 4225681832, s93
    s_lshl_b32 s90, s90, 3
    s_lshl_b32 s91, s16, 1
    s_add_u32 s90, s90, s91
    s_lshl_b32 s90, s90, 12
    s_lshl_b32 s91, s92, 19
    s_add_u32 s90, s90, s91
    s_add_u32 s90, s90, 0
    buffer_load_dwordx4 a[128:131], v2, s[8:11], s90 offen offset:0 sc1
    buffer_load_dwordx4 a[132:135], v2, s[8:11], s90 offen offset:1024 sc1
    buffer_load_dwordx4 a[136:139], v2, s[8:11], s90 offen offset:2048 sc1
    buffer_load_dwordx4 a[140:143], v2, s[8:11], s90 offen offset:3072 sc1
    s_bfe_u32 s90, 4225681832, s93
    s_lshl_b32 s90, s90, 3
    s_lshl_b32 s91, s16, 1
    s_add_u32 s90, s90, s91
    s_lshl_b32 s90, s90, 12
    s_lshl_b32 s91, s92, 19
    s_add_u32 s90, s90, s91
    s_add_u32 s90, s90, 4096
    buffer_load_dwordx4 a[144:147], v2, s[8:11], s90 offen offset:0 sc1
    buffer_load_dwordx4 a[148:151], v2, s[8:11], s90 offen offset:1024 sc1
    buffer_load_dwordx4 a[152:155], v2, s[8:11], s90 offen offset:2048 sc1
    buffer_load_dwordx4 a[156:159], v2, s[8:11], s90 offen offset:3072 sc1
    s_bfe_u32 s90, 873473623, s93
    s_lshl_b32 s90, s90, 3
    s_lshl_b32 s91, s16, 1
    s_add_u32 s90, s90, s91
    s_lshl_b32 s90, s90, 12
    s_lshl_b32 s91, s92, 19
    s_add_u32 s90, s90, s91
    s_add_u32 s90, s90, 0
    buffer_load_dwordx4 a[160:163], v2, s[8:11], s90 offen offset:0 sc1
    buffer_load_dwordx4 a[164:167], v2, s[8:11], s90 offen offset:1024 sc1
    buffer_load_dwordx4 a[168:171], v2, s[8:11], s90 offen offset:2048 sc1
    buffer_load_dwordx4 a[172:175], v2, s[8:11], s90 offen offset:3072 sc1
    s_bfe_u32 s90, 873473623, s93
    s_lshl_b32 s90, s90, 3
    s_lshl_b32 s91, s16, 1
    s_add_u32 s90, s90, s91
    s_lshl_b32 s90, s90, 12
    s_lshl_b32 s91, s92, 19
    s_add_u32 s90, s90, s91
    s_add_u32 s90, s90, 4096
    buffer_load_dwordx4 a[176:179], v2, s[8:11], s90 offen offset:0 sc1
    buffer_load_dwordx4 a[180:183], v2, s[8:11], s90 offen offset:1024 sc1
    buffer_load_dwordx4 a[184:187], v2, s[8:11], s90 offen offset:2048 sc1
    buffer_load_dwordx4 a[188:191], v2, s[8:11], s90 offen offset:3072 sc1
    s_mov_b32 s94, 1
m_kvl27:
    s_waitcnt lgkmcnt(0)
    s_barrier
    s_and_b32 s92, s2, 7
    s_lshl_b32 s92, s92, 2
    s_bfe_u32 s93, s2, 0x20003
    s_add_u32 s92, s92, s93
    s_lshr_b32 s93, s2, 5
    s_lshl_b32 s93, s93, 2
    s_or_b32 s93, s93, 0x40000
    s_mov_b32 s32, s92
    s_bfe_u32 s33, 4225681832, s93
    s_add_u32 s33, s33, 1
    s_bfe_u32 s34, 873473623, s93
    s_add_u32 s34, s34, 1
    s_lshl_b32 s60, s16, 12
    v_add_u32 v7, s60, v2
    s_lshl_b32 s90, s34, 2
    s_lshl_b32 s91, s33, 2
    s_lshl_b32 s26, s91, 13
    s_mov_b32 s30, s26
    s_sub_u32 s67, s90, 4
    s_add_u32 s67, s67, s16
    s_add_u32 s68, s67, 1
    s_mov_b32 s69, s90
    s_sub_u32 s70, s91, 4
    s_add_u32 s70, s70, s16
    s_add_u32 s71, s70, 1
    s_mov_b32 s72, s91
    s_mov_b32 s27, 0x20000
    s_mov_b32 s31, 0x20000
    s_lshl_b32 s82, s32, 19
    s_add_u32 s90, s82, 16777216
    s_add_u32 s24, s6, s90
    s_addc_u32 s25, s7, 0
    s_add_u32 s90, s82, 33554432
    s_add_u32 s28, s6, s90
    s_addc_u32 s29, s7, 0
    s_cmp_eq_u32 s94, 1
    s_cbranch_scc1 m_w064
    s_mov_b32 s56, 32768
    s_mov_b32 s57, 16384
    s_add_u32 s59, s60, 65536
    s_mov_b32 m0, s59
    s_nop 0
    buffer_load_dwordx4 v7, s[24:27], s56 offen offset:0 sc1 lds
    buffer_load_dwordx4 v7, s[24:27], s56 offen offset:1024 sc1 lds
    buffer_load_dwordx4 v7, s[24:27], s56 offen offset:2048 sc1 lds
    buffer_load_dwordx4 v7, s[24:27], s56 offen offset:3072 sc1 lds
    s_add_u32 s56, s56, 16384
    s_add_u32 m0, s59, 16384
    s_nop 0
    buffer_load_dwordx4 v7, s[28:31], s57 offen offset:0 sc1 lds
    buffer_load_dwordx4 v7, s[28:31], s57 offen offset:1024 sc1 lds
    buffer_load_dwordx4 v7, s[28:31], s57 offen offset:2048 sc1 lds
    buffer_load_dwordx4 v7, s[28:31], s57 offen offset:3072 sc1 lds
    s_add_u32 s57, s57, 16384
    s_call_b64 s[20:21], m_epl62
    s_mov_b32 s17, s101
    s_mov_b32 s38, 268435456
    s_branch m_init26
m_w064:
    s_mov_b32 s56, 0
    s_mov_b32 s57, 0
    s_mov_b32 m0, s60
    s_nop 0
    buffer_load_dwordx4 v7, s[24:27], s56 offen offset:0 sc1 lds
    buffer_load_dwordx4 v7, s[24:27], s56 offen offset:1024 sc1 lds
    buffer_load_dwordx4 v7, s[24:27], s56 offen offset:2048 sc1 lds
    buffer_load_dwordx4 v7, s[24:27], s56 offen offset:3072 sc1 lds
    s_mov_b32 s56, 16384
    s_add_u32 s59, s60, 32768
    s_mov_b32 m0, s59
    s_nop 0
    buffer_load_dwordx4 v7, s[24:27], s56 offen offset:0 sc1 lds
    buffer_load_dwordx4 v7, s[24:27], s56 offen offset:1024 sc1 lds
    buffer_load_dwordx4 v7, s[24:27], s56 offen offset:2048 sc1 lds
    buffer_load_dwordx4 v7, s[24:27], s56 offen offset:3072 sc1 lds
    s_add_u32 s56, s56, 16384
    s_add_u32 m0, s59, 16384
    s_nop 0
    buffer_load_dwordx4 v7, s[28:31], s57 offen offset:0 sc1 lds
    buffer_load_dwordx4 v7, s[28:31], s57 offen offset:1024 sc1 lds
    buffer_load_dwordx4 v7, s[28:31], s57 offen offset:2048 sc1 lds
    buffer_load_dwordx4 v7, s[28:31], s57 offen offset:3072 sc1 lds
    s_add_u32 s57, s57, 16384
    s_add_u32 s59, s59, 32768
    s_mov_b32 m0, s59
    s_nop 0
    buffer_load_dwordx4 v7, s[24:27], s56 offen offset:0 sc1 lds
    buffer_load_dwordx4 v7, s[24:27], s56 offen offset:1024 sc1 lds
    buffer_load_dwordx4 v7, s[24:27], s56 offen offset:2048 sc1 lds
    buffer_load_dwordx4 v7, s[24:27], s56 offen offset:3072 sc1 lds
    s_add_u32 s56, s56, 16384
    s_add_u32 m0, s59, 16384
    s_nop 0
    buffer_load_dwordx4 v7, s[28:31], s57 offen offset:0 sc1 lds
    buffer_load_dwordx4 v7, s[28:31], s57 offen offset:1024 sc1 lds
    buffer_load_dwordx4 v7, s[28:31], s57 offen offset:2048 sc1 lds
    buffer_load_dwordx4 v7, s[28:31], s57 offen offset:3072 sc1 lds
    s_add_u32 s57, s57, 16384
    s_add_u32 s59, s59, 32768
    s_mov_b32 m0, s59
    s_nop 0
    buffer_load_dwordx4 v7, s[24:27], s56 offen offset:0 sc1 lds
    buffer_load_dwordx4 v7, s[24:27], s56 offen offset:1024 sc1 lds
    buffer_load_dwordx4 v7, s[24:27], s56 offen offset:2048 sc1 lds
    buffer_load_dwordx4 v7, s[24:27], s56 offen offset:3072 sc1 lds
    s_add_u32 s56, s56, 16384
    s_add_u32 m0, s59, 16384
    s_nop 0
    buffer_load_dwordx4 v7, s[28:31], s57 offen offset:0 sc1 lds
    buffer_load_dwordx4 v7, s[28:31], s57 offen offset:1024 sc1 lds
    buffer_load_dwordx4 v7, s[28:31], s57 offen offset:2048 sc1 lds
    buffer_load_dwordx4 v7, s[28:31], s57 offen offset:3072 sc1 lds
    s_add_u32 s57, s57, 16384
    s_add_u32 s59, s59, 32768
    s_waitcnt vmcnt(0)
    s_mov_b32 s38, 0
m_init26:
    s_mov_b32 s56, 65536
    s_mov_b32 s57, 49152
    s_nop 1
    v_mov_b32 v9, 0xff800000
    s_mov_b32 s65, 1233125376
    s_lshl_b32 s91, s16, 1
    s_sub_u32 s91, s91, 8
    s_lshl_b32 s78, s33, 3
    s_add_u32 s78, s78, s91
    s_lshl_b32 s79, s34, 3
    s_add_u32 s79, s79, s91
    s_mov_b32 s36, s6
    s_mov_b32 s37, s7
    s_mov_b32 s39, 0x20000
    s_load_dwordx2 s[48:49], s[0:1], 64
    s_load_dwordx2 s[50:51], s[0:1], 16
    s_load_dwordx2 s[54:55], s[0:1], 72
    s_mov_b32 s47, 0x20000
    s_lshl_b32 s90, s99, 1
    s_add_u32 s98, s98, s90
    s_lshl_b32 s90, s100, 2
    s_add_u32 s40, s98, s90
    s_lshr_b32 s90, s32, 1
    s_lshl_b32 s90, s90, 7
    s_add_u32 s90, s90, 117444608
    s_lshr_b32 s91, s2, 6
    s_lshl_b32 s91, s91, 8
    s_add_u32 s91, s91, 117446592
    v_min_u32 v10, 31, v1
    v_lshlrev_b32 v10, 3, v10
    v_mov_b32 v11, s90
    v_mov_b32 v8, s91
    v_cmp_gt_u32 vcc, 8, v1
    s_nop 1
    v_cndmask_b32 v11, v8, v11, vcc
    v_add_u32 v10, v10, v11
    s_mov_b32 s58, 0
    v_mov_b32 v6, v2
    v_accvgpr_write_b32 a0, 0
    v_accvgpr_write_b32 a1, 0
    v_accvgpr_write_b32 a2, 0
    v_accvgpr_write_b32 a3, 0
    v_accvgpr_write_b32 a4, 0
    v_accvgpr_write_b32 a5, 0
    v_accvgpr_write_b32 a6, 0
    v_accvgpr_write_b32 a7, 0
    v_accvgpr_write_b32 a8, 0
    v_accvgpr_write_b32 a9, 0
    v_accvgpr_write_b32 a10, 0
    v_accvgpr_write_b32 a11, 0
    v_accvgpr_write_b32 a12, 0
    v_accvgpr_write_b32 a13, 0
    v_accvgpr_write_b32 a14, 0
    v_accvgpr_write_b32 a15, 0
    v_accvgpr_write_b32 a16, 0
    v_accvgpr_write_b32 a17, 0
    v_accvgpr_write_b32 a18, 0
    v_accvgpr_write_b32 a19, 0
    v_accvgpr_write_b32 a20, 0
    v_accvgpr_write_b32 a21, 0
    v_accvgpr_write_b32 a22, 0
    v_accvgpr_write_b32 a23, 0
    v_accvgpr_write_b32 a24, 0
    v_accvgpr_write_b32 a25, 0
    v_accvgpr_write_b32 a26, 0
    v_accvgpr_write_b32 a27, 0
    v_accvgpr_write_b32 a28, 0
    v_accvgpr_write_b32 a29, 0
    v_accvgpr_write_b32 a30, 0
    v_accvgpr_write_b32 a31, 0
    v_accvgpr_write_b32 a32, 0
    v_accvgpr_write_b32 a33, 0
    v_accvgpr_write_b32 a34, 0
    v_accvgpr_write_b32 a35, 0
    v_accvgpr_write_b32 a36, 0
    v_accvgpr_write_b32 a37, 0
    v_accvgpr_write_b32 a38, 0
    v_accvgpr_write_b32 a39, 0
    v_accvgpr_write_b32 a40, 0
    v_accvgpr_write_b32 a41, 0
    v_accvgpr_write_b32 a42, 0
    v_accvgpr_write_b32 a43, 0
    v_accvgpr_write_b32 a44, 0
    v_accvgpr_write_b32 a45, 0
    v_accvgpr_write_b32 a46, 0
    v_accvgpr_write_b32 a47, 0
    v_accvgpr_write_b32 a48, 0
    v_accvgpr_write_b32 a49, 0
    v_accvgpr_write_b32 a50, 0
    v_accvgpr_write_b32 a51, 0
    v_accvgpr_write_b32 a52, 0
    v_accvgpr_write_b32 a53, 0
    v_accvgpr_write_b32 a54, 0
    v_accvgpr_write_b32 a55, 0
    v_accvgpr_write_b32 a56, 0
    v_accvgpr_write_b32 a57, 0
    v_accvgpr_write_b32 a58, 0
    v_accvgpr_write_b32 a59, 0
    v_accvgpr_write_b32 a60, 0
    v_accvgpr_write_b32 a61, 0
    v_accvgpr_write_b32 a62, 0
    v_accvgpr_write_b32 a63, 0
    v_accvgpr_write_b32 a64, 0
    v_accvgpr_write_b32 a65, 0
    v_accvgpr_write_b32 a66, 0
    v_accvgpr_write_b32 a67, 0
    v_accvgpr_write_b32 a68, 0
    v_accvgpr_write_b32 a69, 0
    v_accvgpr_write_b32 a70, 0
    v_accvgpr_write_b32 a71, 0
    v_accvgpr_write_b32 a72, 0
    v_accvgpr_write_b32 a73, 0
    v_accvgpr_write_b32 a74, 0
    v_accvgpr_write_b32 a75, 0
    v_accvgpr_write_b32 a76, 0
    v_accvgpr_write_b32 a77, 0
    v_accvgpr_write_b32 a78, 0
    v_accvgpr_write_b32 a79, 0
    v_mov_b64 v[160:161], 0
    v_mov_b64 v[162:163], 0
    v_mov_b64 v[164:165], 0
    v_mov_b64 v[166:167], 0
    v_mov_b64 v[168:169], 0
    v_mov_b64 v[170:171], 0
    v_mov_b64 v[172:173], 0
    v_mov_b64 v[174:175], 0
    v_mov_b64 v[176:177], 0
    v_mov_b64 v[178:179], 0
    v_mov_b64 v[180:181], 0
    v_mov_b64 v[182:183], 0
    v_mov_b64 v[184:185], 0
    v_mov_b64 v[186:187], 0
    v_mov_b64 v[188:189], 0
    v_mov_b64 v[190:191], 0
    v_mov_b32 v12, 0
    v_mov_b32 v28, 0
    v_mov_b32 v44, 0x3f803f80
    v_mov_b32 v13, 0
    v_mov_b32 v32, 0
    v_mov_b32 v45, 0x3f803f80
    v_mov_b32 v14, 0
    v_mov_b32 v36, 0
    v_mov_b32 v46, 0x3f803f80
    v_mov_b32 v15, 0
    v_mov_b32 v40, 0
    v_mov_b32 v47, 0x3f803f80
    s_and_b32 s90, s2, 7
    s_lshl_b32 s90, s90, 4
    s_lshl_b32 s91, s16, 2
    s_add_u32 s80, s90, s91
    s_lshr_b32 s92, s2, 3
    s_lshl_b32 s92, s92, 17
    s_lshl_b32 s90, s80, 10
    s_add_u32 s90, s90, s92
    s_add_u32 s83, s90, 50331648
    s_add_u32 s84, s90, 54525952
    s_and_b32 s81, s80, 63
    s_cmp_eq_u32 s81, 0
    s_cselect_b32 s93, 0, 1024
    s_sub_u32 s85, s84, s93
    s_lshl_b32 s90, s80, 9
    s_add_u32 s90, s90, s92
    s_add_u32 s86, s90, 58720256
    s_sub_u32 s87, s86, s93
    s_add_u32 s88, s86, 65536
    s_add_u32 s89, s87, 65536
    v_and_b32 v48, 15, v1
    v_lshrrev_b32 v49, 4, v1
    v_lshlrev_b32 v49, 2, v49
    v_sub_u32 v48, v48, v49
    v_cmp_le_i32 vcc, 0, v48
    s_nop 1
    v_cndmask_b32 v16, v9, 0, vcc
    v_cmp_le_i32 vcc, 1, v48
    s_nop 1
    v_cndmask_b32 v17, v9, 0, vcc
    v_cmp_le_i32 vcc, 2, v48
    s_nop 1
    v_cndmask_b32 v18, v9, 0, vcc
    v_cmp_le_i32 vcc, 3, v48
    s_nop 1
    v_cndmask_b32 v19, v9, 0, vcc
    s_mov_b32 s62, 35782688
    s_mov_b32 s63, 0
    s_sub_u32 s90, s67, 1
    s_bitset1_b64 s[62:63], s90
    s_sub_u32 s90, s68, 1
    s_bitset1_b64 s[62:63], s90
    s_sub_u32 s90, s69, 1
    s_bitset1_b64 s[62:63], s90
    s_sub_u32 s90, s70, 1
    s_bitset1_b64 s[62:63], s90
    s_sub_u32 s90, s71, 1
    s_bitset1_b64 s[62:63], s90
    s_sub_u32 s90, s72, 1
    s_bitset1_b64 s[62:63], s90
    s_add_u32 s53, s69, 6
    s_sub_u32 s90, s53, 1
    s_bitset1_b64 s[62:63], s90
    s_mov_b32 s64, 0
    s_cmp_lg_u32 s64, s67
    s_cbranch_scc1 m_e69
    v_add_f32 v176, v176, v16
    v_mov_b32 v180, v9
    v_add_f32 v188, v188, v16
    v_add_f32 v177, v177, v17
    v_mov_b32 v181, v9
    v_add_f32 v189, v189, v17
    v_add_f32 v178, v178, v18
    v_mov_b32 v182, v9
    v_add_f32 v190, v190, v18
    v_add_f32 v179, v179, v19
    v_mov_b32 v183, v9
    v_add_f32 v191, v191, v19
    s_nop 0
m_e69:
    s_waitcnt vmcnt(24) lgkmcnt(0)
    s_barrier
    ds_read_b128 a[192:195], v6 offset:0
    ds_read_b128 a[196:199], v6 offset:1024
    ds_read_b128 a[200:203], v6 offset:2048
    ds_read_b128 a[204:207], v6 offset:3072
    ds_read_b128 a[208:211], v6 offset:4096
    ds_read_b128 a[212:215], v6 offset:5120
    ds_read_b128 a[216:219], v6 offset:6144
    ds_read_b128 a[220:223], v6 offset:7168
    s_waitcnt lgkmcnt(0)
    v_mfma_f32_16x16x32_bf16 v[64:67], a[192:195], a[128:131], v[160:163]
    v_accvgpr_write_b32 a80, 0
    v_accvgpr_write_b32 a81, 0
    v_mfma_f32_16x16x32_bf16 v[64:67], a[196:199], a[132:135], v[64:67]
    buffer_store_dwordx4 v[192:195], v2, s[36:39], s40 offen sc1
    s_add_u32 s40, s40, s100
    v_mfma_f32_16x16x32_bf16 v[64:67], a[200:203], a[136:139], v[64:67]
    v_accvgpr_write_b32 a82, 0
    v_accvgpr_write_b32 a83, 0
    v_mfma_f32_16x16x32_bf16 v[64:67], a[204:207], a[140:143], v[64:67]
    v_accvgpr_write_b32 a84, 0
    v_accvgpr_write_b32 a85, 0
    v_mfma_f32_16x16x32_bf16 v[72:75], a[192:195], a[144:147], v[168:171]
    v_accvgpr_write_b32 a86, 0
    v_accvgpr_write_b32 a87, 0
    v_mfma_f32_16x16x32_bf16 v[72:75], a[196:199], a[148:151], v[72:75]
    buffer_store_dwordx4 v[196:199], v2, s[36:39], s40 offen sc1
    s_add_u32 s40, s40, s100
    v_mfma_f32_16x16x32_bf16 v[72:75], a[200:203], a[152:155], v[72:75]
    v_accvgpr_write_b32 a88, 0
    v_accvgpr_write_b32 a89, 0
    v_mfma_f32_16x16x32_bf16 v[72:75], a[204:207], a[156:159], v[72:75]
    v_accvgpr_write_b32 a90, 0
    v_accvgpr_write_b32 a91, 0
    v_mfma_f32_16x16x32_bf16 v[80:83], a[192:195], a[160:163], v[176:179]
    v_accvgpr_write_b32 a92, 0
    v_accvgpr_write_b32 a93, 0
    v_mfma_f32_16x16x32_bf16 v[80:83], a[196:199], a[164:167], v[80:83]
    buffer_store_dwordx4 v[200:203], v2, s[36:39], s40 offen sc1
    s_add_u32 s40, s40, s100
    v_mfma_f32_16x16x32_bf16 v[80:83], a[200:203], a[168:171], v[80:83]
    v_accvgpr_write_b32 a94, 0
    v_accvgpr_write_b32 a95, 0
    v_mfma_f32_16x16x32_bf16 v[80:83], a[204:207], a[172:175], v[80:83]
    v_accvgpr_write_b32 a96, 0
    v_accvgpr_write_b32 a97, 0
    v_mfma_f32_16x16x32_bf16 v[88:91], a[192:195], a[176:179], v[184:187]
    v_accvgpr_write_b32 a98, 0
    v_accvgpr_write_b32 a99, 0
    v_mfma_f32_16x16x32_bf16 v[88:91], a[196:199], a[180:183], v[88:91]
    buffer_store_dwordx4 v[204:207], v2, s[36:39], s40 offen sc1
    s_add_u32 s40, s98, s99
    v_mfma_f32_16x16x32_bf16 v[88:91], a[200:203], a[184:187], v[88:91]
    v_accvgpr_write_b32 a100, 0
    v_accvgpr_write_b32 a101, 0
    v_mfma_f32_16x16x32_bf16 v[88:91], a[204:207], a[188:191], v[88:91]
    v_accvgpr_write_b32 a102, 0
    v_accvgpr_write_b32 a103, 0
    v_mfma_f32_16x16x32_bf16 v[68:71], a[208:211], a[128:131], v[164:167]
    ds_read_b128 a[192:195], v6 offset:8192
    v_accvgpr_write_b32 a104, 0
    v_accvgpr_write_b32 a105, 0
    v_mfma_f32_16x16x32_bf16 v[68:71], a[212:215], a[132:135], v[68:71]
    buffer_store_dwordx4 v[208:211], v2, s[36:39], s40 offen sc1
    s_add_u32 s40, s40, s100
    ds_read_b128 a[196:199], v6 offset:9216
    v_mfma_f32_16x16x32_bf16 v[68:71], a[216:219], a[136:139], v[68:71]
    ds_read_b128 a[200:203], v6 offset:10240
    v_accvgpr_write_b32 a106, 0
    v_accvgpr_write_b32 a107, 0
    v_mfma_f32_16x16x32_bf16 v[68:71], a[220:223], a[140:143], v[68:71]
    ds_read_b128 a[204:207], v6 offset:11264
    v_accvgpr_write_b32 a108, 0
    v_accvgpr_write_b32 a109, 0
    v_mfma_f32_16x16x32_bf16 v[76:79], a[208:211], a[144:147], v[172:175]
    v_accvgpr_write_b32 a110, 0
    v_accvgpr_write_b32 a111, 0
    v_mfma_f32_16x16x32_bf16 v[76:79], a[212:215], a[148:151], v[76:79]
    buffer_store_dwordx4 v[212:215], v2, s[36:39], s40 offen sc1
    s_add_u32 s40, s40, s100
    v_mfma_f32_16x16x32_bf16 v[76:79], a[216:219], a[152:155], v[76:79]
    v_accvgpr_write_b32 a112, 0
    v_accvgpr_write_b32 a113, 0
    v_mfma_f32_16x16x32_bf16 v[76:79], a[220:223], a[156:159], v[76:79]
    v_accvgpr_write_b32 a114, 0
    v_accvgpr_write_b32 a115, 0
    v_mfma_f32_16x16x32_bf16 v[84:87], a[208:211], a[160:163], v[180:183]
    v_accvgpr_write_b32 a116, 0
    v_accvgpr_write_b32 a117, 0
    v_mfma_f32_16x16x32_bf16 v[84:87], a[212:215], a[164:167], v[84:87]
    buffer_store_dwordx4 v[216:219], v2, s[36:39], s40 offen sc1
    s_add_u32 s40, s40, s100
    v_mfma_f32_16x16x32_bf16 v[84:87], a[216:219], a[168:171], v[84:87]
    v_accvgpr_write_b32 a118, 0
    v_accvgpr_write_b32 a119, 0
    v_mfma_f32_16x16x32_bf16 v[84:87], a[220:223], a[172:175], v[84:87]
    v_accvgpr_write_b32 a120, 0
    v_accvgpr_write_b32 a121, 0
    v_mfma_f32_16x16x32_bf16 v[92:95], a[208:211], a[176:179], v[188:191]
    v_accvgpr_write_b32 a122, 0
    v_accvgpr_write_b32 a123, 0
    v_mfma_f32_16x16x32_bf16 v[92:95], a[212:215], a[180:183], v[92:95]
    buffer_store_dwordx4 v[220:223], v2, s[36:39], s40 offen sc1
    s_add_u32 s40, s40, s100
    v_mfma_f32_16x16x32_bf16 v[92:95], a[216:219], a[184:187], v[92:95]
    v_accvgpr_write_b32 a124, 0
    v_accvgpr_write_b32 a125, 0
    v_mfma_f32_16x16x32_bf16 v[92:95], a[220:223], a[188:191], v[92:95]
    v_accvgpr_write_b32 a126, 0
    v_accvgpr_write_b32 a127, 0
    ds_read_b128 a[208:211], v6 offset:12288
    ds_read_b128 a[212:215], v6 offset:13312
    ds_read_b128 a[216:219], v6 offset:14336
    ds_read_b128 a[220:223], v6 offset:15360
    s_mov_b32 s64, 1
    s_nop 0
    s_nop 3
    v_max3_f32 v48, v64, v65, v66
    v_max3_f32 v49, v72, v73, v74
    v_max3_f32 v50, v80, v81, v82
    v_max3_f32 v51, v88, v89, v90
    v_max3_f32 v48, v48, v67, v68
    v_max3_f32 v49, v49, v75, v76
    v_max3_f32 v50, v50, v83, v84
    v_max3_f32 v51, v51, v91, v92
    v_max3_f32 v48, v48, v69, v70
    v_max3_f32 v49, v49, v77, v78
    v_max3_f32 v50, v50, v85, v86
    v_max3_f32 v51, v51, v93, v94
    v_max_f32 v48, v48, v71
    v_max_f32 v49, v49, v79
    v_max_f32 v50, v50, v87
    v_max_f32 v51, v51, v95
    v_mov_b32 v52, v48
    v_mov_b32 v53, v49
    v_mov_b32 v54, v50
    v_mov_b32 v55, v51
    s_nop 1
    v_permlane32_swap_b32 v48, v52
    v_permlane32_swap_b32 v49, v53
    v_permlane32_swap_b32 v50, v54
    v_permlane32_swap_b32 v51, v55
    s_nop 1
    v_max_f32 v48, v48, v52
    v_max_f32 v49, v49, v53
    v_max_f32 v50, v50, v54
    v_max_f32 v51, v51, v55
    v_mov_b32 v52, v48
    v_mov_b32 v53, v49
    v_mov_b32 v54, v50
    v_mov_b32 v55, v51
    s_nop 1
    v_permlane16_swap_b32 v48, v52
    v_permlane16_swap_b32 v49, v53
    v_permlane16_swap_b32 v50, v54
    v_permlane16_swap_b32 v51, v55
    s_nop 1
    v_max_f32 v48, v48, v52
    v_max_f32 v49, v49, v53
    v_max_f32 v50, v50, v54
    v_max_f32 v51, v51, v55
    v_sub_f32 v160, v160, v48
    v_sub_f32 v161, v161, v48
    v_sub_f32 v162, v162, v48
    v_sub_f32 v163, v163, v48
    v_sub_f32 v164, v164, v48
    v_sub_f32 v165, v165, v48
    v_sub_f32 v166, v166, v48
    v_sub_f32 v167, v167, v48
    v_sub_f32 v168, v168, v49
    v_sub_f32 v169, v169, v49
    v_sub_f32 v170, v170, v49
    v_sub_f32 v171, v171, v49
    v_sub_f32 v172, v172, v49
    v_sub_f32 v173, v173, v49
    v_sub_f32 v174, v174, v49
    v_sub_f32 v175, v175, v49
    v_sub_f32 v176, v176, v50
    v_sub_f32 v177, v177, v50
    v_sub_f32 v178, v178, v50
    v_sub_f32 v179, v179, v50
    v_sub_f32 v180, v180, v50
    v_sub_f32 v181, v181, v50
    v_sub_f32 v182, v182, v50
    v_sub_f32 v183, v183, v50
    v_sub_f32 v184, v184, v51
    v_sub_f32 v185, v185, v51
    v_sub_f32 v186, v186, v51
    v_sub_f32 v187, v187, v51
    v_sub_f32 v188, v188, v51
    v_sub_f32 v189, v189, v51
    v_sub_f32 v190, v190, v51
    v_sub_f32 v191, v191, v51
    v_sub_f32 v64, v64, v48
    v_sub_f32 v65, v65, v48
    v_sub_f32 v66, v66, v48
    v_sub_f32 v67, v67, v48
    v_sub_f32 v68, v68, v48
    v_sub_f32 v69, v69, v48
    v_sub_f32 v70, v70, v48
    v_sub_f32 v71, v71, v48
    v_sub_f32 v72, v72, v49
    v_sub_f32 v73, v73, v49
    v_sub_f32 v74, v74, v49
    v_sub_f32 v75, v75, v49
    v_sub_f32 v76, v76, v49
    v_sub_f32 v77, v77, v49
    v_sub_f32 v78, v78, v49
    v_sub_f32 v79, v79, v49
    v_sub_f32 v80, v80, v50
    v_sub_f32 v81, v81, v50
    v_sub_f32 v82, v82, v50
    v_sub_f32 v83, v83, v50
    v_sub_f32 v84, v84, v50
    v_sub_f32 v85, v85, v50
    v_sub_f32 v86, v86, v50
    v_sub_f32 v87, v87, v50
    v_sub_f32 v88, v88, v51
    v_sub_f32 v89, v89, v51
    v_sub_f32 v90, v90, v51
    v_sub_f32 v91, v91, v51
    v_sub_f32 v92, v92, v51
    v_sub_f32 v93, v93, v51
    v_sub_f32 v94, v94, v51
    v_sub_f32 v95, v95, v51
    s_cmp_lg_u32 s64, s67
    s_cbranch_scc1 m_e70
    v_add_f32 v176, v176, v16
    v_mov_b32 v180, v9
    v_add_f32 v188, v188, v16
    v_add_f32 v177, v177, v17
    v_mov_b32 v181, v9
    v_add_f32 v189, v189, v17
    v_add_f32 v178, v178, v18
    v_mov_b32 v182, v9
    v_add_f32 v190, v190, v18
    v_add_f32 v179, v179, v19
    v_mov_b32 v183, v9
    v_add_f32 v191, v191, v19
    s_nop 0
m_e70:
    s_cmp_lg_u32 s64, s68
    s_cbranch_scc1 m_e71
    v_mov_b32 v176, v9
    v_mov_b32 v184, v9
    v_mov_b32 v188, v9
    v_mov_b32 v177, v9
    v_mov_b32 v185, v9
    v_mov_b32 v189, v9
    v_mov_b32 v178, v9
    v_mov_b32 v186, v9
    v_mov_b32 v190, v9
    v_mov_b32 v179, v9
    v_mov_b32 v187, v9
    v_mov_b32 v191, v9
    s_nop 0
m_e71:
    s_waitcnt lgkmcnt(0)
    v_mfma_f32_16x16x32_bf16 v[96:99], a[192:195], a[128:131], v[160:163]
    s_bitcmp1_b64 s[62:63], s64
    s_cselect_b32 s66, -1.0, s65
    v_exp_f32 v20, v64
    v_mfma_f32_16x16x32_bf16 v[96:99], a[196:199], a[132:135], v[96:99]
    s_add_u32 s64, s64, 1
    v_exp_f32 v21, v65
    v_exp_f32 v22, v66
    v_mfma_f32_16x16x32_bf16 v[96:99], a[200:203], a[136:139], v[96:99]
    buffer_store_dwordx4 v[224:227], v2, s[36:39], s40 offen sc1
    v_cvt_pk_bf16_f32 v128, v20, v21
    v_mfma_f32_16x16x32_bf16 v[96:99], a[204:207], a[140:143], v[96:99]
    s_add_u32 s40, s40, s100
    v_add_f32 v12, v12, v28
    v_exp_f32 v23, v67
    v_mfma_f32_16x16x32_bf16 v[104:107], a[192:195], a[144:147], v[168:171]
    v_exp_f32 v24, v68
    v_cvt_pk_bf16_f32 v129, v22, v23
    v_mfma_f32_16x16x32_bf16 v[104:107], a[196:199], a[148:151], v[104:107]
    buffer_store_dwordx4 v[228:231], v2, s[36:39], s40 offen sc1
    v_exp_f32 v25, v69
    v_mfma_f32_16x16x32_bf16 v[104:107], a[200:203], a[152:155], v[104:107]
    s_add_u32 s40, s40, s100
    v_exp_f32 v26, v70
    v_cvt_pk_bf16_f32 v130, v24, v25
    v_mfma_f32_16x16x32_bf16 v[104:107], a[204:207], a[156:159], v[104:107]
    v_exp_f32 v27, v71
    v_add_f32 v13, v13, v32
    v_mfma_f32_16x16x32_bf16 v[112:115], a[192:195], a[160:163], v[176:179]
    v_exp_f32 v20, v72
    v_cvt_pk_bf16_f32 v131, v26, v27
    v_mfma_f32_16x16x32_bf16 v[112:115], a[196:199], a[164:167], v[112:115]
    buffer_store_dwordx4 v[232:235], v2, s[36:39], s40 offen sc1
    v_exp_f32 v21, v73
    v_mfma_f32_16x16x32_bf16 v[28:31], v[44:47], v[128:131], 0
    v_exp_f32 v22, v74
    v_cvt_pk_bf16_f32 v132, v20, v21
    v_mfma_f32_16x16x32_bf16 v[112:115], a[200:203], a[168:171], v[112:115]
    s_add_u32 s40, s40, s100
    v_exp_f32 v23, v75
    v_add_f32 v14, v14, v36
    v_mfma_f32_16x16x32_bf16 v[112:115], a[204:207], a[172:175], v[112:115]
    v_exp_f32 v24, v76
    v_cvt_pk_bf16_f32 v133, v22, v23
    v_mfma_f32_16x16x32_bf16 v[120:123], a[192:195], a[176:179], v[184:187]
    buffer_store_dwordx4 v[236:239], v2, s[36:39], s40 offen sc1
    v_exp_f32 v25, v77
    v_mfma_f32_16x16x32_bf16 v[120:123], a[196:199], a[180:183], v[120:123]
    s_mov_b32 s40, s98
    v_exp_f32 v26, v78
    v_cvt_pk_bf16_f32 v134, v24, v25
    v_mfma_f32_16x16x32_bf16 v[120:123], a[200:203], a[184:187], v[120:123]
    v_exp_f32 v27, v79
    v_add_f32 v15, v15, v40
    v_mfma_f32_16x16x32_bf16 v[120:123], a[204:207], a[188:191], v[120:123]
    s_waitcnt lgkmcnt(0)
    v_exp_f32 v20, v80
    v_cvt_pk_bf16_f32 v135, v26, v27
    v_mfma_f32_16x16x32_bf16 v[100:103], a[208:211], a[128:131], v[164:167]
    v_exp_f32 v21, v81
    v_exp_f32 v22, v82
    v_mfma_f32_16x16x32_bf16 v[32:35], v[44:47], v[132:135], 0
    v_cvt_pk_bf16_f32 v136, v20, v21
    v_exp_f32 v23, v83
    v_mfma_f32_16x16x32_bf16 v[100:103], a[212:215], a[132:135], v[100:103]
    buffer_store_dwordx4 v[240:243], v2, s[36:39], s40 offen sc1
    v_cvt_pk_bf16_f32 v137, v22, v23
    v_mfma_f32_16x16x32_bf16 v[100:103], a[216:219], a[136:139], v[100:103]
    s_add_u32 s40, s40, s100
    v_exp_f32 v24, v84
    v_mfma_f32_16x16x32_bf16 v[100:103], a[220:223], a[140:143], v[100:103]
    v_exp_f32 v25, v85
    v_exp_f32 v26, v86
    v_cvt_pk_bf16_f32 v138, v24, v25
    v_mfma_f32_16x16x32_bf16 v[108:111], a[208:211], a[144:147], v[172:175]
    buffer_store_dwordx4 v[244:247], v2, s[36:39], s40 offen sc1
    v_mfma_f32_16x16x32_bf16 v[108:111], a[212:215], a[148:151], v[108:111]
    s_add_u32 s40, s40, s100
    v_exp_f32 v27, v87
    v_exp_f32 v20, v88
    v_mfma_f32_16x16x32_bf16 v[108:111], a[216:219], a[152:155], v[108:111]
    v_cvt_pk_bf16_f32 v139, v26, v27
    v_exp_f32 v21, v89
    v_mfma_f32_16x16x32_bf16 v[108:111], a[220:223], a[156:159], v[108:111]
    buffer_store_dwordx4 v[248:251], v2, s[36:39], s40 offen sc1
    v_exp_f32 v22, v90
    v_mfma_f32_16x16x32_bf16 v[36:39], v[44:47], v[136:139], 0
    v_cvt_pk_bf16_f32 v140, v20, v21
    v_exp_f32 v23, v91
    v_mfma_f32_16x16x32_bf16 v[116:119], a[208:211], a[160:163], v[180:183]
    s_add_u32 s40, s40, s100
    v_exp_f32 v24, v92
    v_cvt_pk_bf16_f32 v141, v22, v23
    v_mfma_f32_16x16x32_bf16 v[116:119], a[212:215], a[164:167], v[116:119]
    v_exp_f32 v25, v93
    v_mfma_f32_16x16x32_bf16 v[116:119], a[216:219], a[168:171], v[116:119]
    buffer_store_dwordx4 v[252:255], v2, s[36:39], s40 offen sc1
    v_exp_f32 v26, v94
    v_cvt_pk_bf16_f32 v142, v24, v25
    v_mfma_f32_16x16x32_bf16 v[116:119], a[220:223], a[172:175], v[116:119]
    s_add_u32 s40, s40, s100
    v_exp_f32 v27, v95
    s_nop 0
    v_cvt_pk_bf16_f32 v143, v26, v27
    s_nop 1
    v_mfma_f32_16x16x32_bf16 v[40:43], v[44:47], v[140:143], 0
    s_nop 2
    v_mfma_f32_16x16x32_bf16 v[124:127], a[208:211], a[176:179], v[188:191]
    s_nop 2
    v_mfma_f32_16x16x32_bf16 v[124:127], a[212:215], a[180:183], v[124:127]
    v_max3_f32 v8, v28, v32, v36
    v_max_f32 v8, v8, v40
    v_mfma_f32_16x16x32_bf16 v[124:127], a[216:219], a[184:187], v[124:127]
    v_cmp_nge_f32 vcc, s66, v8
    v_mfma_f32_16x16x32_bf16 v[124:127], a[220:223], a[188:191], v[124:127]
    s_waitcnt vmcnt(40) lgkmcnt(0)
    s_barrier
    s_add_u32 s59, s58, s60
    s_add_u32 s58, s58, 32768
    s_and_b32 s58, s58, 0x1ffff
    v_add_u32 v6, s58, v2
    ds_read_b128 a[192:195], v6 offset:0
    ds_read_b128 a[196:199], v6 offset:1024
    ds_read_b128 a[200:203], v6 offset:2048
    ds_read_b128 a[204:207], v6 offset:3072
    ds_read_b128 a[208:211], v6 offset:4096
    ds_read_b128 a[212:215], v6 offset:5120
    ds_read_b128 a[216:219], v6 offset:6144
    ds_read_b128 a[220:223], v6 offset:7168
    s_waitcnt lgkmcnt(0)
    s_cbranch_vccnz m_stub72
m_ret73:
m_dual74:
    v_mfma_f32_16x16x32_bf16 v[64:67], a[192:195], a[128:131], v[160:163]
    s_bitcmp1_b64 s[62:63], s64
    s_cselect_b32 s66, -1.0, s65
    v_add_f32 v12, v12, v28
    v_mfma_f32_16x16x32_bf16 v[64:67], a[196:199], a[132:135], v[64:67]
    s_add_u32 s64, s64, 1
    ds_read_b128 a[224:227], v6 offset:16384
    v_add_f32 v13, v13, v32
    v_mfma_f32_16x16x32_bf16 v[64:67], a[200:203], a[136:139], v[64:67]
    v_exp_f32 v20, v96
    v_mfma_f32_16x16x32_bf16 v[64:67], a[204:207], a[140:143], v[64:67]
    v_exp_f32 v21, v97
    v_mfma_f32_16x16x32_bf16 v[72:75], a[192:195], a[144:147], v[168:171]
    s_mov_b32 m0, s59
    ds_read_b128 a[228:231], v6 offset:17408
    v_cvt_pk_bf16_f32 v144, v20, v21
    v_mfma_f32_16x16x32_bf16 v[72:75], a[196:199], a[148:151], v[72:75]
    buffer_load_dwordx4 v7, s[24:27], s56 offen offset:0 sc1 lds
    v_mfma_f32_16x16x32_bf16 v[72:75], a[200:203], a[152:155], v[72:75]
    v_exp_f32 v22, v98
    v_mfma_f32_16x16x32_bf16 v[72:75], a[204:207], a[156:159], v[72:75]
    ds_read_b128 a[232:235], v6 offset:18432
    v_add_f32 v14, v14, v36
    v_mfma_f32_16x16x32_bf16 v[80:83], a[192:195], a[160:163], v[176:179]
    v_exp_f32 v23, v99
    v_mfma_f32_16x16x32_bf16 v[80:83], a[196:199], a[164:167], v[80:83]
    v_exp_f32 v24, v100
    v_mfma_f32_16x16x32_bf16 v[80:83], a[200:203], a[168:171], v[80:83]
    ds_read_b128 a[236:239], v6 offset:19456
    v_cvt_pk_bf16_f32 v145, v22, v23
    v_mfma_f32_16x16x32_bf16 v[80:83], a[204:207], a[172:175], v[80:83]
    v_exp_f32 v25, v101
    v_mfma_f32_16x16x32_bf16 v[88:91], a[192:195], a[176:179], v[184:187]
    v_exp_f32 v26, v102
    v_mfma_f32_16x16x32_bf16 v[88:91], a[196:199], a[180:183], v[88:91]
    ds_read_b128 a[240:243], v6 offset:20480
    v_cvt_pk_bf16_f32 v146, v24, v25
    v_mfma_f32_16x16x32_bf16 v[88:91], a[200:203], a[184:187], v[88:91]
    v_exp_f32 v27, v103
    v_mfma_f32_16x16x32_bf16 v[88:91], a[204:207], a[188:191], v[88:91]
    s_waitcnt lgkmcnt(5)
    v_exp_f32 v20, v104
    v_mfma_f32_16x16x32_bf16 v[68:71], a[208:211], a[128:131], v[164:167]
    ds_read_b128 a[244:247], v6 offset:21504
    v_cvt_pk_bf16_f32 v147, v26, v27
    v_mfma_f32_16x16x32_bf16 v[68:71], a[212:215], a[132:135], v[68:71]
    v_exp_f32 v21, v105
    v_mfma_f32_16x16x32_bf16 v[28:31], v[44:47], v[144:147], 0
    v_exp_f32 v22, v106
    v_mfma_f32_16x16x32_bf16 v[68:71], a[216:219], a[136:139], v[68:71]
    buffer_load_dwordx4 v7, s[24:27], s56 offen offset:1024 sc1 lds
    v_mfma_f32_16x16x32_bf16 v[68:71], a[220:223], a[140:143], v[68:71]
    ds_read_b128 a[248:251], v6 offset:22528
    v_cvt_pk_bf16_f32 v148, v20, v21
    v_mfma_f32_16x16x32_bf16 v[76:79], a[208:211], a[144:147], v[172:175]
    v_exp_f32 v23, v107
    v_mfma_f32_16x16x32_bf16 v[76:79], a[212:215], a[148:151], v[76:79]
    v_exp_f32 v24, v108
    v_mfma_f32_16x16x32_bf16 v[76:79], a[216:219], a[152:155], v[76:79]
    ds_read_b128 a[252:255], v6 offset:23552
    v_cvt_pk_bf16_f32 v149, v22, v23
    v_mfma_f32_16x16x32_bf16 v[76:79], a[220:223], a[156:159], v[76:79]
    v_exp_f32 v25, v109
    v_mfma_f32_16x16x32_bf16 v[84:87], a[208:211], a[160:163], v[180:183]
    v_exp_f32 v26, v110
    v_mfma_f32_16x16x32_bf16 v[84:87], a[212:215], a[164:167], v[84:87]
    v_cvt_pk_bf16_f32 v150, v24, v25
    v_add_f32 v15, v15, v40
    v_mfma_f32_16x16x32_bf16 v[84:87], a[216:219], a[168:171], v[84:87]
    v_exp_f32 v27, v111
    v_mfma_f32_16x16x32_bf16 v[84:87], a[220:223], a[172:175], v[84:87]
    buffer_load_dwordx4 v7, s[24:27], s56 offen offset:2048 sc1 lds
    v_mfma_f32_16x16x32_bf16 v[92:95], a[208:211], a[176:179], v[188:191]
    v_exp_f32 v20, v112
    v_mfma_f32_16x16x32_bf16 v[92:95], a[212:215], a[180:183], v[92:95]
    v_cvt_pk_bf16_f32 v151, v26, v27
    v_mfma_f32_16x16x32_bf16 v[92:95], a[216:219], a[184:187], v[92:95]
    v_exp_f32 v21, v113
    v_mfma_f32_16x16x32_bf16 v[32:35], v[44:47], v[148:151], 0
    v_exp_f32 v22, v114
    v_mfma_f32_16x16x32_bf16 v[92:95], a[220:223], a[188:191], v[92:95]
    s_waitcnt lgkmcnt(0)
    v_cvt_pk_bf16_f32 v152, v20, v21
    v_mfma_f32_16x16x32_bf16 a[0:3], a[224:227], v[128:131], a[0:3]
    ds_read_b128 a[192:195], v6 offset:8192
    v_mfma_f32_16x16x32_bf16 a[32:35], a[224:227], v[132:135], a[32:35]
    v_exp_f32 v23, v115
    v_mfma_f32_16x16x32_bf16 a[64:67], a[224:227], v[136:139], a[64:67]
    v_exp_f32 v24, v116
    v_mfma_f32_16x16x32_bf16 a[96:99], a[224:227], v[140:143], a[96:99]
    ds_read_b128 a[196:199], v6 offset:9216
    v_cvt_pk_bf16_f32 v153, v22, v23
    v_mfma_f32_16x16x32_bf16 a[4:7], a[228:231], v[128:131], a[4:7]
    v_exp_f32 v25, v117
    v_mfma_f32_16x16x32_bf16 a[36:39], a[228:231], v[132:135], a[36:39]
    v_exp_f32 v26, v118
    v_mfma_f32_16x16x32_bf16 a[68:71], a[228:231], v[136:139], a[68:71]
    ds_read_b128 a[200:203], v6 offset:10240
    v_cvt_pk_bf16_f32 v154, v24, v25
    v_mfma_f32_16x16x32_bf16 a[100:103], a[228:231], v[140:143], a[100:103]
    v_exp_f32 v27, v119
    v_mfma_f32_16x16x32_bf16 a[8:11], a[232:235], v[128:131], a[8:11]
    v_exp_f32 v20, v120
    v_mfma_f32_16x16x32_bf16 a[40:43], a[232:235], v[132:135], a[40:43]
    ds_read_b128 a[204:207], v6 offset:11264
    v_cvt_pk_bf16_f32 v155, v26, v27
    v_mfma_f32_16x16x32_bf16 a[72:75], a[232:235], v[136:139], a[72:75]
    v_exp_f32 v21, v121
    v_mfma_f32_16x16x32_bf16 v[36:39], v[44:47], v[152:155], 0
    v_exp_f32 v22, v122
    v_mfma_f32_16x16x32_bf16 a[104:107], a[232:235], v[140:143], a[104:107]
    buffer_load_dwordx4 v7, s[24:27], s56 offen offset:3072 sc1 lds
    v_mfma_f32_16x16x32_bf16 a[12:15], a[236:239], v[128:131], a[12:15]
    s_add_u32 s56, s56, 16384
    v_cvt_pk_bf16_f32 v156, v20, v21
    v_mfma_f32_16x16x32_bf16 a[44:47], a[236:239], v[132:135], a[44:47]
    v_exp_f32 v23, v123
    v_mfma_f32_16x16x32_bf16 a[76:79], a[236:239], v[136:139], a[76:79]
    v_exp_f32 v24, v124
    v_mfma_f32_16x16x32_bf16 a[108:111], a[236:239], v[140:143], a[108:111]
    v_cvt_pk_bf16_f32 v157, v22, v23
    v_mfma_f32_16x16x32_bf16 a[16:19], a[240:243], v[128:131], a[16:19]
    v_exp_f32 v25, v125
    v_mfma_f32_16x16x32_bf16 a[48:51], a[240:243], v[132:135], a[48:51]
    v_exp_f32 v26, v126
    v_mfma_f32_16x16x32_bf16 a[80:83], a[240:243], v[136:139], a[80:83]
    v_cvt_pk_bf16_f32 v158, v24, v25
    v_mfma_f32_16x16x32_bf16 a[112:115], a[240:243], v[140:143], a[112:115]
    s_add_u32 m0, s59, 16384
    v_exp_f32 v27, v127
    v_mfma_f32_16x16x32_bf16 a[20:23], a[244:247], v[128:131], a[20:23]
    buffer_load_dwordx4 v7, s[28:31], s57 offen offset:0 sc1 lds
    v_mfma_f32_16x16x32_bf16 a[52:55], a[244:247], v[132:135], a[52:55]
    v_cvt_pk_bf16_f32 v159, v26, v27
    v_mfma_f32_16x16x32_bf16 a[84:87], a[244:247], v[136:139], a[84:87]
    v_mfma_f32_16x16x32_bf16 a[116:119], a[244:247], v[140:143], a[116:119]
    v_mfma_f32_16x16x32_bf16 v[40:43], v[44:47], v[156:159], 0
    s_nop 2
    v_mfma_f32_16x16x32_bf16 a[24:27], a[248:251], v[128:131], a[24:27]
    s_nop 2
    v_mfma_f32_16x16x32_bf16 a[56:59], a[248:251], v[132:135], a[56:59]
    v_max3_f32 v8, v28, v32, v36
    v_max_f32 v8, v8, v40
    v_mfma_f32_16x16x32_bf16 a[88:91], a[248:251], v[136:139], a[88:91]
    v_cmp_nge_f32 vcc, s66, v8
    v_mfma_f32_16x16x32_bf16 a[120:123], a[248:251], v[140:143], a[120:123]
    ds_read_b128 a[208:211], v6 offset:12288
    v_mfma_f32_16x16x32_bf16 a[28:31], a[252:255], v[128:131], a[28:31]
    ds_read_b128 a[212:215], v6 offset:13312
    v_mfma_f32_16x16x32_bf16 a[60:63], a[252:255], v[132:135], a[60:63]
    ds_read_b128 a[216:219], v6 offset:14336
    v_mfma_f32_16x16x32_bf16 a[92:95], a[252:255], v[136:139], a[92:95]
    ds_read_b128 a[220:223], v6 offset:15360
    v_mfma_f32_16x16x32_bf16 a[124:127], a[252:255], v[140:143], a[124:127]
    s_waitcnt lgkmcnt(4)
    s_cbranch_vccnz m_stub75
m_ret76:
    v_mfma_f32_16x16x32_bf16 v[96:99], a[192:195], a[128:131], v[160:163]
    s_add_u32 s59, s58, s60
    v_exp_f32 v20, v64
    v_mfma_f32_16x16x32_bf16 v[96:99], a[196:199], a[132:135], v[96:99]
    s_add_u32 s58, s58, 32768
    ds_read_b128 a[224:227], v6 offset:24576
    v_add_f32 v12, v12, v28
    v_mfma_f32_16x16x32_bf16 v[96:99], a[200:203], a[136:139], v[96:99]
    s_and_b32 s58, s58, 0x1ffff
    v_exp_f32 v21, v65
    v_mfma_f32_16x16x32_bf16 v[96:99], a[204:207], a[140:143], v[96:99]
    s_bitcmp1_b64 s[62:63], s64
    s_cselect_b32 s66, -1.0, s65
    v_cvt_pk_bf16_f32 v128, v20, v21
    v_mfma_f32_16x16x32_bf16 v[104:107], a[192:195], a[144:147], v[168:171]
    s_add_u32 s64, s64, 1
    ds_read_b128 a[228:231], v6 offset:25600
    v_add_f32 v13, v13, v32
    v_mfma_f32_16x16x32_bf16 v[104:107], a[196:199], a[148:151], v[104:107]
    v_exp_f32 v22, v66
    v_mfma_f32_16x16x32_bf16 v[104:107], a[200:203], a[152:155], v[104:107]
    buffer_load_dwordx4 v7, s[28:31], s57 offen offset:1024 sc1 lds
    v_mfma_f32_16x16x32_bf16 v[104:107], a[204:207], a[156:159], v[104:107]
    ds_read_b128 a[232:235], v6 offset:26624
    v_add_f32 v14, v14, v36
    v_mfma_f32_16x16x32_bf16 v[112:115], a[192:195], a[160:163], v[176:179]
    v_exp_f32 v23, v67
    v_mfma_f32_16x16x32_bf16 v[112:115], a[196:199], a[164:167], v[112:115]
    v_exp_f32 v24, v68
    v_mfma_f32_16x16x32_bf16 v[112:115], a[200:203], a[168:171], v[112:115]
    ds_read_b128 a[236:239], v6 offset:27648
    v_cvt_pk_bf16_f32 v129, v22, v23
    v_mfma_f32_16x16x32_bf16 v[112:115], a[204:207], a[172:175], v[112:115]
    v_exp_f32 v25, v69
    v_mfma_f32_16x16x32_bf16 v[120:123], a[192:195], a[176:179], v[184:187]
    v_exp_f32 v26, v70
    v_mfma_f32_16x16x32_bf16 v[120:123], a[196:199], a[180:183], v[120:123]
    ds_read_b128 a[240:243], v6 offset:28672
    v_cvt_pk_bf16_f32 v130, v24, v25
    v_mfma_f32_16x16x32_bf16 v[120:123], a[200:203], a[184:187], v[120:123]
    v_exp_f32 v27, v71
    v_mfma_f32_16x16x32_bf16 v[120:123], a[204:207], a[188:191], v[120:123]
    s_waitcnt lgkmcnt(5)
    v_exp_f32 v20, v72
    v_mfma_f32_16x16x32_bf16 v[100:103], a[208:211], a[128:131], v[164:167]
    ds_read_b128 a[244:247], v6 offset:29696
    v_cvt_pk_bf16_f32 v131, v26, v27
    v_mfma_f32_16x16x32_bf16 v[100:103], a[212:215], a[132:135], v[100:103]
    v_exp_f32 v21, v73
    v_mfma_f32_16x16x32_bf16 v[28:31], v[44:47], v[128:131], 0
    v_exp_f32 v22, v74
    v_mfma_f32_16x16x32_bf16 v[100:103], a[216:219], a[136:139], v[100:103]
    buffer_load_dwordx4 v7, s[28:31], s57 offen offset:2048 sc1 lds
    v_mfma_f32_16x16x32_bf16 v[100:103], a[220:223], a[140:143], v[100:103]
    ds_read_b128 a[248:251], v6 offset:30720
    v_cvt_pk_bf16_f32 v132, v20, v21
    v_mfma_f32_16x16x32_bf16 v[108:111], a[208:211], a[144:147], v[172:175]
    v_exp_f32 v23, v75
    v_mfma_f32_16x16x32_bf16 v[108:111], a[212:215], a[148:151], v[108:111]
    v_exp_f32 v24, v76
    v_mfma_f32_16x16x32_bf16 v[108:111], a[216:219], a[152:155], v[108:111]
    ds_read_b128 a[252:255], v6 offset:31744
    v_cvt_pk_bf16_f32 v133, v22, v23
    v_mfma_f32_16x16x32_bf16 v[108:111], a[220:223], a[156:159], v[108:111]
    v_exp_f32 v25, v77
    v_mfma_f32_16x16x32_bf16 v[116:119], a[208:211], a[160:163], v[180:183]
    v_exp_f32 v26, v78
    v_mfma_f32_16x16x32_bf16 v[116:119], a[212:215], a[164:167], v[116:119]
    v_cvt_pk_bf16_f32 v134, v24, v25
    v_add_f32 v15, v15, v40
    v_mfma_f32_16x16x32_bf16 v[116:119], a[216:219], a[168:171], v[116:119]
    v_exp_f32 v27, v79
    v_mfma_f32_16x16x32_bf16 v[116:119], a[220:223], a[172:175], v[116:119]
    buffer_load_dwordx4 v7, s[28:31], s57 offen offset:3072 sc1 lds
    v_mfma_f32_16x16x32_bf16 v[124:127], a[208:211], a[176:179], v[188:191]
    s_add_u32 s57, s57, 16384
    v_exp_f32 v20, v80
    v_mfma_f32_16x16x32_bf16 v[124:127], a[212:215], a[180:183], v[124:127]
    v_cvt_pk_bf16_f32 v135, v26, v27
    v_mfma_f32_16x16x32_bf16 v[124:127], a[216:219], a[184:187], v[124:127]
    v_exp_f32 v21, v81
    v_mfma_f32_16x16x32_bf16 v[32:35], v[44:47], v[132:135], 0
    v_exp_f32 v22, v82
    v_mfma_f32_16x16x32_bf16 v[124:127], a[220:223], a[188:191], v[124:127]
    s_waitcnt vmcnt(16) lgkmcnt(0)
    v_add_u32 v6, s58, v2
    v_cvt_pk_bf16_f32 v136, v20, v21
    v_mfma_f32_16x16x32_bf16 a[0:3], a[224:227], v[144:147], a[0:3]
    s_barrier
    v_mfma_f32_16x16x32_bf16 a[32:35], a[224:227], v[148:151], a[32:35]
    ds_read_b128 a[192:195], v6 offset:0
    v_mfma_f32_16x16x32_bf16 a[64:67], a[224:227], v[152:155], a[64:67]
    v_exp_f32 v23, v83
    v_mfma_f32_16x16x32_bf16 a[96:99], a[224:227], v[156:159], a[96:99]
    v_exp_f32 v24, v84
    v_mfma_f32_16x16x32_bf16 a[4:7], a[228:231], v[144:147], a[4:7]
    ds_read_b128 a[196:199], v6 offset:1024
    v_cvt_pk_bf16_f32 v137, v22, v23
    v_mfma_f32_16x16x32_bf16 a[36:39], a[228:231], v[148:151], a[36:39]
    v_exp_f32 v25, v85
    v_mfma_f32_16x16x32_bf16 a[68:71], a[228:231], v[152:155], a[68:71]
    v_exp_f32 v26, v86
    v_mfma_f32_16x16x32_bf16 a[100:103], a[228:231], v[156:159], a[100:103]
    ds_read_b128 a[200:203], v6 offset:2048
    v_cvt_pk_bf16_f32 v138, v24, v25
    v_mfma_f32_16x16x32_bf16 a[8:11], a[232:235], v[144:147], a[8:11]
    v_exp_f32 v27, v87
    v_mfma_f32_16x16x32_bf16 a[40:43], a[232:235], v[148:151], a[40:43]
    v_exp_f32 v20, v88
    v_mfma_f32_16x16x32_bf16 a[72:75], a[232:235], v[152:155], a[72:75]
    ds_read_b128 a[204:207], v6 offset:3072
    v_cvt_pk_bf16_f32 v139, v26, v27
    v_mfma_f32_16x16x32_bf16 a[104:107], a[232:235], v[156:159], a[104:107]
    v_exp_f32 v21, v89
    v_mfma_f32_16x16x32_bf16 v[36:39], v[44:47], v[136:139], 0
    v_exp_f32 v22, v90
    v_mfma_f32_16x16x32_bf16 a[12:15], a[236:239], v[144:147], a[12:15]
    v_cvt_pk_bf16_f32 v140, v20, v21
    v_mfma_f32_16x16x32_bf16 a[44:47], a[236:239], v[148:151], a[44:47]
    v_exp_f32 v23, v91
    v_mfma_f32_16x16x32_bf16 a[76:79], a[236:239], v[152:155], a[76:79]
    v_exp_f32 v24, v92
    v_mfma_f32_16x16x32_bf16 a[108:111], a[236:239], v[156:159], a[108:111]
    v_cvt_pk_bf16_f32 v141, v22, v23
    v_mfma_f32_16x16x32_bf16 a[16:19], a[240:243], v[144:147], a[16:19]
    v_exp_f32 v25, v93
    v_mfma_f32_16x16x32_bf16 a[48:51], a[240:243], v[148:151], a[48:51]
    v_exp_f32 v26, v94
    v_mfma_f32_16x16x32_bf16 a[80:83], a[240:243], v[152:155], a[80:83]
    v_cvt_pk_bf16_f32 v142, v24, v25
    v_mfma_f32_16x16x32_bf16 a[112:115], a[240:243], v[156:159], a[112:115]
    v_exp_f32 v27, v95
    v_mfma_f32_16x16x32_bf16 a[20:23], a[244:247], v[144:147], a[20:23]
    v_cvt_pk_bf16_f32 v143, v26, v27
    v_mfma_f32_16x16x32_bf16 a[52:55], a[244:247], v[148:151], a[52:55]
    v_mfma_f32_16x16x32_bf16 a[84:87], a[244:247], v[152:155], a[84:87]
    v_mfma_f32_16x16x32_bf16 v[40:43], v[44:47], v[140:143], 0
    s_nop 2
    v_mfma_f32_16x16x32_bf16 a[116:119], a[244:247], v[156:159], a[116:119]
    s_nop 2
    v_mfma_f32_16x16x32_bf16 a[24:27], a[248:251], v[144:147], a[24:27]
    v_max3_f32 v8, v28, v32, v36
    v_max_f32 v8, v8, v40
    v_mfma_f32_16x16x32_bf16 a[56:59], a[248:251], v[148:151], a[56:59]
    v_cmp_nge_f32 vcc, s66, v8
    v_mfma_f32_16x16x32_bf16 a[88:91], a[248:251], v[152:155], a[88:91]
    v_mfma_f32_16x16x32_bf16 a[120:123], a[248:251], v[156:159], a[120:123]
    ds_read_b128 a[208:211], v6 offset:4096
    v_mfma_f32_16x16x32_bf16 a[28:31], a[252:255], v[144:147], a[28:31]
    ds_read_b128 a[212:215], v6 offset:5120
    v_mfma_f32_16x16x32_bf16 a[60:63], a[252:255], v[148:151], a[60:63]
    ds_read_b128 a[216:219], v6 offset:6144
    v_mfma_f32_16x16x32_bf16 a[92:95], a[252:255], v[152:155], a[92:95]
    ds_read_b128 a[220:223], v6 offset:7168
    v_mfma_f32_16x16x32_bf16 a[124:127], a[252:255], v[156:159], a[124:127]
    s_waitcnt lgkmcnt(4)
    s_cbranch_vccz m_dual74
    v_cmp_lt_f32 vcc, s65, v8
    s_cmp_lg_u32 s64, s67
    s_cbranch_scc1 m_e78
    v_add_f32 v176, v176, v16
    v_mov_b32 v180, v9
    v_add_f32 v188, v188, v16
    v_add_f32 v177, v177, v17
    v_mov_b32 v181, v9
    v_add_f32 v189, v189, v17
    v_add_f32 v178, v178, v18
    v_mov_b32 v182, v9
    v_add_f32 v190, v190, v18
    v_add_f32 v179, v179, v19
    v_mov_b32 v183, v9
    v_add_f32 v191, v191, v19
    s_nop 0
m_e78:
    s_cmp_lg_u32 s64, s68
    s_cbranch_scc1 m_e79
    v_mov_b32 v176, v9
    v_mov_b32 v184, v9
    v_mov_b32 v188, v9
    v_mov_b32 v177, v9
    v_mov_b32 v185, v9
    v_mov_b32 v189, v9
    v_mov_b32 v178, v9
    v_mov_b32 v186, v9
    v_mov_b32 v190, v9
    v_mov_b32 v179, v9
    v_mov_b32 v187, v9
    v_mov_b32 v191, v9
    s_nop 0
m_e79:
    s_cmp_lg_u32 s64, s70
    s_cbranch_scc1 m_e80
    v_add_f32 v160, v160, v16
    v_mov_b32 v164, v9
    v_add_f32 v172, v172, v16
    v_add_f32 v161, v161, v17
    v_mov_b32 v165, v9
    v_add_f32 v173, v173, v17
    v_add_f32 v162, v162, v18
    v_mov_b32 v166, v9
    v_add_f32 v174, v174, v18
    v_add_f32 v163, v163, v19
    v_mov_b32 v167, v9
    v_add_f32 v175, v175, v19
    s_nop 0
m_e80:
    s_cmp_lg_u32 s64, s53
    s_cbranch_scc1 m_e83
    s_cmp_lg_u32 s16, 0
    s_cbranch_scc1 m_np84
    v_mov_b32 v60, s4
    v_mov_b32 v61, s5
    s_add_u32 s90, s17, 117440512
    s_mov_b64 exec, 1
    buffer_store_dwordx2 v[60:61], off, s[8:11], s90 sc1
    s_mov_b64 exec, -1
m_np84:
    s_mov_b32 s17, -1
m_e83:
    s_cmp_gt_u32 s64, 26
    s_cbranch_scc1 m_e81
    s_cmp_lg_u32 s64, 6
    s_cbranch_scc1 m_e85
    s_lshr_b32 s90, s32, 1
    s_lshl_b32 s90, s90, 7
    s_add_u32 s90, s90, 117440600
    v_min_u32 v0, 1, v1
    v_lshlrev_b32 v0, 5, v0
    buffer_load_dwordx2 v[4:5], v0, s[8:11], s90 offen sc1
    s_cmp_eq_u32 s17, -1
    s_cbranch_scc1 m_e81
    s_cmp_lg_u32 s16, 0
    s_cbranch_scc1 m_np86
    v_mov_b32 v60, s4
    v_mov_b32 v61, s5
    s_add_u32 s90, s17, 117440512
    s_mov_b64 exec, 1
    buffer_store_dwordx2 v[60:61], off, s[8:11], s90 sc1
    s_mov_b64 exec, -1
m_np86:
    s_branch m_e81
m_e85:
    s_cmp_lg_u32 s64, 18
    s_cbranch_scc1 m_e87
    s_waitcnt vmcnt(18)
    s_mov_b32 s3, 1048576
m_spin88:
    v_cmp_ne_u64 s[76:77], s[4:5], v[4:5]
    s_nop 3
    s_cmp_eq_u64 s[76:77], 0
    s_cbranch_scc1 m_e81
    s_sub_u32 s3, s3, 1
    s_cbranch_scc1 m_e81
    s_sleep 32
    s_lshr_b32 s90, s32, 1
    s_lshl_b32 s90, s90, 7
    s_add_u32 s90, s90, 117440600
    v_min_u32 v0, 1, v1
    v_lshlrev_b32 v0, 5, v0
    buffer_load_dwordx2 v[4:5], v0, s[8:11], s90 offen sc1
    s_waitcnt vmcnt(0)
    s_branch m_spin88
    s_branch m_e81
m_e87:
    s_cmp_lg_u32 s64, 22
    s_cbranch_scc1 m_e89
    buffer_load_dwordx2 v[4:5], v10, s[8:11], 0 offen sc1
    s_mov_b32 s44, s48
    s_mov_b32 s45, s49
    s_mov_b32 s46, 8388608
    s_lshl_b32 s90, s2, 2
    s_add_u32 s90, s90, s16
    s_lshl_b32 s90, s90, 13
    v_lshlrev_b32 v62, 7, v1
    buffer_load_dword v255, v62, s[44:47], s90 offen
    s_branch m_e81
m_e89:
    s_cmp_lg_u32 s64, 26
    s_cbranch_scc1 m_e90
    s_mov_b32 s44, s50
    s_mov_b32 s45, s51
    s_mov_b32 s46, 2097152
    s_lshl_b32 s90, s2, 2
    s_add_u32 s90, s90, s16
    s_lshl_b32 s90, s90, 13
    v_lshlrev_b32 v62, 7, v1
    buffer_load_dword v255, v62, s[44:47], s90 offen
    s_waitcnt vmcnt(18)
    s_mov_b32 s3, 1048576
m_spin91:
    v_cmp_ne_u64 s[76:77], s[4:5], v[4:5]
    s_nop 3
    s_cmp_eq_u64 s[76:77], 0
    s_cbranch_scc1 m_e81
    s_sub_u32 s3, s3, 1
    s_cbranch_scc1 m_e81
    s_sleep 32
    buffer_load_dwordx2 v[4:5], v10, s[8:11], 0 offen sc1
    s_waitcnt vmcnt(0)
    s_branch m_spin91
    s_branch m_e81
m_e90:
m_e81:
    s_cbranch_vccnz m_rc92
m_sp77:
    s_cmp_lg_u32 s64, s69
    s_cbranch_scc1 m_dual74
    v_mfma_f32_16x16x32_bf16 v[64:67], a[192:195], a[128:131], v[160:163]
    s_bitcmp1_b64 s[62:63], s64
    s_cselect_b32 s66, -1.0, s65
    v_add_f32 v12, v12, v28
    v_mfma_f32_16x16x32_bf16 v[64:67], a[196:199], a[132:135], v[64:67]
    s_add_u32 s64, s64, 1
    ds_read_b128 a[224:227], v6 offset:16384
    v_exp_f32 v20, v96
    v_mfma_f32_16x16x32_bf16 v[64:67], a[200:203], a[136:139], v[64:67]
    s_mov_b32 m0, s59
    ds_read_b128 a[228:231], v6 offset:17408
    v_add_f32 v13, v13, v32
    v_mfma_f32_16x16x32_bf16 v[64:67], a[204:207], a[140:143], v[64:67]
    buffer_load_dwordx4 v7, s[24:27], s56 offen offset:0 sc1 lds
    v_mfma_f32_16x16x32_bf16 v[72:75], a[192:195], a[144:147], v[168:171]
    ds_read_b128 a[232:235], v6 offset:18432
    v_add_f32 v14, v14, v36
    v_mfma_f32_16x16x32_bf16 v[72:75], a[196:199], a[148:151], v[72:75]
    ds_read_b128 a[236:239], v6 offset:19456
    v_exp_f32 v21, v97
    v_mfma_f32_16x16x32_bf16 v[72:75], a[200:203], a[152:155], v[72:75]
    ds_read_b128 a[240:243], v6 offset:20480
    v_cvt_pk_bf16_f32 v144, v20, v21
    v_mfma_f32_16x16x32_bf16 v[72:75], a[204:207], a[156:159], v[72:75]
    s_waitcnt lgkmcnt(5)
    ds_read_b128 a[244:247], v6 offset:21504
    v_add_f32 v15, v15, v40
    v_mfma_f32_16x16x32_bf16 v[68:71], a[208:211], a[128:131], v[164:167]
    ds_read_b128 a[248:251], v6 offset:22528
    v_exp_f32 v22, v98
    v_mfma_f32_16x16x32_bf16 v[68:71], a[212:215], a[132:135], v[68:71]
    ds_read_b128 a[252:255], v6 offset:23552
    v_exp_f32 v23, v99
    v_mfma_f32_16x16x32_bf16 v[68:71], a[216:219], a[136:139], v[68:71]
    v_exp_f32 v24, v100
    v_mfma_f32_16x16x32_bf16 v[68:71], a[220:223], a[140:143], v[68:71]
    buffer_load_dwordx4 v7, s[24:27], s56 offen offset:1024 sc1 lds
    v_mfma_f32_16x16x32_bf16 v[76:79], a[208:211], a[144:147], v[172:175]
    v_cvt_pk_bf16_f32 v145, v22, v23
    v_exp_f32 v25, v101
    v_mfma_f32_16x16x32_bf16 v[76:79], a[212:215], a[148:151], v[76:79]
    v_exp_f32 v26, v102
    v_mfma_f32_16x16x32_bf16 v[76:79], a[216:219], a[152:155], v[76:79]
    v_cvt_pk_bf16_f32 v146, v24, v25
    v_exp_f32 v27, v103
    v_mfma_f32_16x16x32_bf16 v[76:79], a[220:223], a[156:159], v[76:79]
    s_waitcnt lgkmcnt(0)
    v_exp_f32 v20, v104
    v_mfma_f32_16x16x32_bf16 a[0:3], a[224:227], v[128:131], a[0:3]
    ds_read_b128 a[192:195], v6 offset:8192
    v_cvt_pk_bf16_f32 v147, v26, v27
    v_mfma_f32_16x16x32_bf16 a[32:35], a[224:227], v[132:135], a[32:35]
    v_exp_f32 v21, v105
    v_mfma_f32_16x16x32_bf16 v[28:31], v[44:47], v[144:147], 0
    v_exp_f32 v22, v106
    v_mfma_f32_16x16x32_bf16 a[64:67], a[224:227], v[136:139], a[64:67]
    v_cvt_pk_bf16_f32 v148, v20, v21
    v_exp_f32 v23, v107
    v_mfma_f32_16x16x32_bf16 a[96:99], a[224:227], v[140:143], a[96:99]
    ds_read_b128 a[196:199], v6 offset:9216
    v_cvt_pk_bf16_f32 v149, v22, v23
    v_mfma_f32_16x16x32_bf16 a[4:7], a[228:231], v[128:131], a[4:7]
    v_exp_f32 v24, v108
    v_mfma_f32_16x16x32_bf16 a[36:39], a[228:231], v[132:135], a[36:39]
    buffer_load_dwordx4 v7, s[24:27], s56 offen offset:2048 sc1 lds
    v_mfma_f32_16x16x32_bf16 a[68:71], a[228:231], v[136:139], a[68:71]
    ds_read_b128 a[200:203], v6 offset:10240
    v_exp_f32 v25, v109
    v_mfma_f32_16x16x32_bf16 a[100:103], a[228:231], v[140:143], a[100:103]
    v_exp_f32 v26, v110
    v_mfma_f32_16x16x32_bf16 a[8:11], a[232:235], v[128:131], a[8:11]
    v_cvt_pk_bf16_f32 v150, v24, v25
    v_exp_f32 v27, v111
    v_mfma_f32_16x16x32_bf16 a[40:43], a[232:235], v[132:135], a[40:43]
    ds_read_b128 a[204:207], v6 offset:11264
    v_cvt_pk_bf16_f32 v151, v26, v27
    v_mfma_f32_16x16x32_bf16 a[72:75], a[232:235], v[136:139], a[72:75]
    v_exp_f32 v20, v112
    v_mfma_f32_16x16x32_bf16 v[32:35], v[44:47], v[148:151], 0
    v_exp_f32 v21, v113
    v_mfma_f32_16x16x32_bf16 a[104:107], a[232:235], v[140:143], a[104:107]
    v_exp_f32 v22, v114
    v_mfma_f32_16x16x32_bf16 a[12:15], a[236:239], v[128:131], a[12:15]
    v_cvt_pk_bf16_f32 v152, v20, v21
    v_exp_f32 v23, v115
    v_mfma_f32_16x16x32_bf16 a[44:47], a[236:239], v[132:135], a[44:47]
    v_exp_f32 v24, v116
    v_mfma_f32_16x16x32_bf16 a[76:79], a[236:239], v[136:139], a[76:79]
    v_cvt_pk_bf16_f32 v153, v22, v23
    v_exp_f32 v25, v117
    v_mfma_f32_16x16x32_bf16 a[108:111], a[236:239], v[140:143], a[108:111]
    buffer_load_dwordx4 v7, s[24:27], s56 offen offset:3072 sc1 lds
    v_mfma_f32_16x16x32_bf16 a[16:19], a[240:243], v[128:131], a[16:19]
    s_add_u32 s56, s56, 16384
    v_exp_f32 v26, v118
    v_mfma_f32_16x16x32_bf16 a[48:51], a[240:243], v[132:135], a[48:51]
    v_cvt_pk_bf16_f32 v154, v24, v25
    v_exp_f32 v27, v119
    v_mfma_f32_16x16x32_bf16 a[80:83], a[240:243], v[136:139], a[80:83]
    v_exp_f32 v20, v120
    v_mfma_f32_16x16x32_bf16 a[112:115], a[240:243], v[140:143], a[112:115]
    v_cvt_pk_bf16_f32 v155, v26, v27
    v_exp_f32 v21, v121
    v_mfma_f32_16x16x32_bf16 a[20:23], a[244:247], v[128:131], a[20:23]
    v_exp_f32 v22, v122
    v_mfma_f32_16x16x32_bf16 v[36:39], v[44:47], v[152:155], 0
    v_cvt_pk_bf16_f32 v156, v20, v21
    v_mfma_f32_16x16x32_bf16 a[52:55], a[244:247], v[132:135], a[52:55]
    v_exp_f32 v23, v123
    v_mfma_f32_16x16x32_bf16 a[84:87], a[244:247], v[136:139], a[84:87]
    v_exp_f32 v24, v124
    v_cvt_pk_bf16_f32 v157, v22, v23
    v_mfma_f32_16x16x32_bf16 a[116:119], a[244:247], v[140:143], a[116:119]
    v_exp_f32 v25, v125
    v_mfma_f32_16x16x32_bf16 a[24:27], a[248:251], v[128:131], a[24:27]
    s_add_u32 m0, s59, 16384
    v_exp_f32 v26, v126
    v_mfma_f32_16x16x32_bf16 a[56:59], a[248:251], v[132:135], a[56:59]
    buffer_load_dwordx4 v7, s[28:31], s57 offen offset:0 sc1 lds
    v_mfma_f32_16x16x32_bf16 a[88:91], a[248:251], v[136:139], a[88:91]
    v_cvt_pk_bf16_f32 v158, v24, v25
    v_exp_f32 v27, v127
    v_mfma_f32_16x16x32_bf16 a[120:123], a[248:251], v[140:143], a[120:123]
    ds_read_b128 a[208:211], v6 offset:12288
    v_cvt_pk_bf16_f32 v159, v26, v27
    s_nop 1
    v_mfma_f32_16x16x32_bf16 v[40:43], v[44:47], v[156:159], 0
    s_nop 2
    v_mfma_f32_16x16x32_bf16 a[28:31], a[252:255], v[128:131], a[28:31]
    ds_read_b128 a[212:215], v6 offset:13312
    s_nop 0
    v_mfma_f32_16x16x32_bf16 a[60:63], a[252:255], v[132:135], a[60:63]
    ds_read_b128 a[216:219], v6 offset:14336
    v_max3_f32 v8, v28, v32, v36
    v_mfma_f32_16x16x32_bf16 a[92:95], a[252:255], v[136:139], a[92:95]
    ds_read_b128 a[220:223], v6 offset:15360
    v_max_f32 v8, v8, v40
    v_cmp_nge_f32 vcc, s66, v8
    v_mfma_f32_16x16x32_bf16 a[124:127], a[252:255], v[140:143], a[124:127]
    s_waitcnt lgkmcnt(4)
    s_cbranch_vccnz m_stub93
m_ret94:
    v_mfma_f32_16x16x32_bf16 v[96:99], a[192:195], a[128:131], v[160:163]
    s_add_u32 s59, s58, s60
    v_exp_f32 v20, v64
    v_mfma_f32_16x16x32_bf16 v[96:99], a[196:199], a[132:135], v[96:99]
    s_add_u32 s58, s58, 32768
    ds_read_b128 a[224:227], v6 offset:24576
    v_add_f32 v12, v12, v28
    v_mfma_f32_16x16x32_bf16 v[96:99], a[200:203], a[136:139], v[96:99]
    s_and_b32 s58, s58, 0x1ffff
    ds_read_b128 a[228:231], v6 offset:25600
    v_add_f32 v13, v13, v32
    v_mfma_f32_16x16x32_bf16 v[96:99], a[204:207], a[140:143], v[96:99]
    buffer_load_dwordx4 v7, s[28:31], s57 offen offset:1024 sc1 lds
    v_mfma_f32_16x16x32_bf16 v[104:107], a[192:195], a[144:147], v[168:171]
    s_bitcmp1_b64 s[62:63], s64
    s_cselect_b32 s66, -1.0, s65
    ds_read_b128 a[232:235], v6 offset:26624
    v_mfma_f32_16x16x32_bf16 v[104:107], a[196:199], a[148:151], v[104:107]
    s_add_u32 s64, s64, 1
    ds_read_b128 a[236:239], v6 offset:27648
    v_mfma_f32_16x16x32_bf16 v[104:107], a[200:203], a[152:155], v[104:107]
    ds_read_b128 a[240:243], v6 offset:28672
    v_mfma_f32_16x16x32_bf16 v[104:107], a[204:207], a[156:159], v[104:107]
    s_waitcnt lgkmcnt(5)
    ds_read_b128 a[244:247], v6 offset:29696
    v_mfma_f32_16x16x32_bf16 v[100:103], a[208:211], a[128:131], v[164:167]
    buffer_load_dwordx4 v7, s[28:31], s57 offen offset:2048 sc1 lds
    v_mfma_f32_16x16x32_bf16 v[100:103], a[212:215], a[132:135], v[100:103]
    ds_read_b128 a[248:251], v6 offset:30720
    v_mfma_f32_16x16x32_bf16 v[100:103], a[216:219], a[136:139], v[100:103]
    ds_read_b128 a[252:255], v6 offset:31744
    v_mfma_f32_16x16x32_bf16 v[100:103], a[220:223], a[140:143], v[100:103]
    v_exp_f32 v21, v65
    v_mfma_f32_16x16x32_bf16 v[108:111], a[208:211], a[144:147], v[172:175]
    v_exp_f32 v22, v66
    v_mfma_f32_16x16x32_bf16 v[108:111], a[212:215], a[148:151], v[108:111]
    buffer_load_dwordx4 v7, s[28:31], s57 offen offset:3072 sc1 lds
    v_mfma_f32_16x16x32_bf16 v[108:111], a[216:219], a[152:155], v[108:111]
    s_add_u32 s57, s57, 16384
    v_cvt_pk_bf16_f32 v128, v20, v21
    v_mfma_f32_16x16x32_bf16 v[108:111], a[220:223], a[156:159], v[108:111]
    s_waitcnt vmcnt(16) lgkmcnt(0)
    v_add_u32 v6, s58, v2
    v_mfma_f32_16x16x32_bf16 a[0:3], a[224:227], v[144:147], a[0:3]
    s_barrier
    v_mfma_f32_16x16x32_bf16 a[32:35], a[224:227], v[148:151], a[32:35]
    ds_read_b128 a[192:195], v6 offset:0
    v_mfma_f32_16x16x32_bf16 a[64:67], a[224:227], v[152:155], a[64:67]
    v_exp_f32 v23, v67
    v_mfma_f32_16x16x32_bf16 a[96:99], a[224:227], v[156:159], a[96:99]
    v_exp_f32 v24, v68
    v_mfma_f32_16x16x32_bf16 a[4:7], a[228:231], v[144:147], a[4:7]
    ds_read_b128 a[196:199], v6 offset:1024
    v_cvt_pk_bf16_f32 v129, v22, v23
    v_mfma_f32_16x16x32_bf16 a[36:39], a[228:231], v[148:151], a[36:39]
    v_exp_f32 v25, v69
    v_mfma_f32_16x16x32_bf16 a[68:71], a[228:231], v[152:155], a[68:71]
    v_exp_f32 v26, v70
    v_mfma_f32_16x16x32_bf16 a[100:103], a[228:231], v[156:159], a[100:103]
    ds_read_b128 a[200:203], v6 offset:2048
    v_cvt_pk_bf16_f32 v130, v24, v25
    v_mfma_f32_16x16x32_bf16 a[8:11], a[232:235], v[144:147], a[8:11]
    v_exp_f32 v27, v71
    v_mfma_f32_16x16x32_bf16 a[40:43], a[232:235], v[148:151], a[40:43]
    v_exp_f32 v20, v72
    v_mfma_f32_16x16x32_bf16 a[72:75], a[232:235], v[152:155], a[72:75]
    ds_read_b128 a[204:207], v6 offset:3072
    v_cvt_pk_bf16_f32 v131, v26, v27
    v_mfma_f32_16x16x32_bf16 a[104:107], a[232:235], v[156:159], a[104:107]
    v_exp_f32 v21, v73
    v_mfma_f32_16x16x32_bf16 v[28:31], v[44:47], v[128:131], 0
    v_exp_f32 v22, v74
    v_mfma_f32_16x16x32_bf16 a[12:15], a[236:239], v[144:147], a[12:15]
    v_cvt_pk_bf16_f32 v132, v20, v21
    v_mfma_f32_16x16x32_bf16 a[44:47], a[236:239], v[148:151], a[44:47]
    v_exp_f32 v23, v75
    v_mfma_f32_16x16x32_bf16 a[76:79], a[236:239], v[152:155], a[76:79]
    v_exp_f32 v24, v76
    v_mfma_f32_16x16x32_bf16 a[108:111], a[236:239], v[156:159], a[108:111]
    v_cvt_pk_bf16_f32 v133, v22, v23
    v_mfma_f32_16x16x32_bf16 a[16:19], a[240:243], v[144:147], a[16:19]
    v_exp_f32 v25, v77
    v_mfma_f32_16x16x32_bf16 a[48:51], a[240:243], v[148:151], a[48:51]
    v_exp_f32 v26, v78
    v_mfma_f32_16x16x32_bf16 a[80:83], a[240:243], v[152:155], a[80:83]
    v_cvt_pk_bf16_f32 v134, v24, v25
    v_mfma_f32_16x16x32_bf16 a[112:115], a[240:243], v[156:159], a[112:115]
    v_exp_f32 v27, v79
    v_mfma_f32_16x16x32_bf16 a[20:23], a[244:247], v[144:147], a[20:23]
    v_cvt_pk_bf16_f32 v135, v26, v27
    v_mfma_f32_16x16x32_bf16 a[52:55], a[244:247], v[148:151], a[52:55]
    v_mfma_f32_16x16x32_bf16 a[84:87], a[244:247], v[152:155], a[84:87]
    v_mfma_f32_16x16x32_bf16 v[32:35], v[44:47], v[132:135], 0
    s_nop 2
    v_mfma_f32_16x16x32_bf16 a[116:119], a[244:247], v[156:159], a[116:119]
    s_nop 2
    v_mfma_f32_16x16x32_bf16 a[24:27], a[248:251], v[144:147], a[24:27]
    v_max_f32 v8, v28, v32
    v_cmp_nge_f32 vcc, s66, v8
    v_mfma_f32_16x16x32_bf16 a[56:59], a[248:251], v[148:151], a[56:59]
    v_mfma_f32_16x16x32_bf16 a[88:91], a[248:251], v[152:155], a[88:91]
    v_mfma_f32_16x16x32_bf16 a[120:123], a[248:251], v[156:159], a[120:123]
    ds_read_b128 a[208:211], v6 offset:4096
    v_mfma_f32_16x16x32_bf16 a[28:31], a[252:255], v[144:147], a[28:31]
    ds_read_b128 a[212:215], v6 offset:5120
    v_mfma_f32_16x16x32_bf16 a[60:63], a[252:255], v[148:151], a[60:63]
    ds_read_b128 a[216:219], v6 offset:6144
    v_mfma_f32_16x16x32_bf16 a[92:95], a[252:255], v[152:155], a[92:95]
    ds_read_b128 a[220:223], v6 offset:7168
    v_mfma_f32_16x16x32_bf16 a[124:127], a[252:255], v[156:159], a[124:127]
    s_waitcnt lgkmcnt(4)
    s_cbranch_vccnz m_stub95
m_ret96:
    v_add_f32 v20, v14, v36
    v_add_f32 v21, v15, v40
    s_nop 3
    v_rcp_f32 v20, v20
    v_rcp_f32 v21, v21
    s_lshl_b32 s90, s79, 10
    s_add_u32 s90, s90, s82
    s_add_u32 s90, s90, 67108864
    v_accvgpr_read_b32 v48, a64
    v_accvgpr_read_b32 v49, a65
    v_accvgpr_read_b32 v50, a66
    v_accvgpr_read_b32 v51, a67
    v_accvgpr_read_b32 v52, a68
    v_accvgpr_read_b32 v53, a69
    v_accvgpr_read_b32 v54, a70
    v_accvgpr_read_b32 v55, a71
    v_mul_f32 v48, v20, v48
    v_mul_f32 v49, v20, v49
    v_mul_f32 v50, v20, v50
    v_mul_f32 v51, v20, v51
    v_mul_f32 v52, v20, v52
    v_mul_f32 v53, v20, v53
    v_mul_f32 v54, v20, v54
    v_mul_f32 v55, v20, v55
    v_cvt_pk_bf16_f32 v48, v48, v49
    v_cvt_pk_bf16_f32 v49, v50, v51
    v_cvt_pk_bf16_f32 v50, v52, v53
    v_cvt_pk_bf16_f32 v51, v54, v55
    buffer_store_dwordx4 v[48:51], v2, s[8:11], s90 offen offset:0 sc1
    v_accvgpr_read_b32 v56, a96
    v_accvgpr_read_b32 v57, a97
    v_accvgpr_read_b32 v58, a98
    v_accvgpr_read_b32 v59, a99
    v_accvgpr_read_b32 v60, a100
    v_accvgpr_read_b32 v61, a101
    v_accvgpr_read_b32 v62, a102
    v_accvgpr_read_b32 v63, a103
    v_mul_f32 v56, v21, v56
    v_mul_f32 v57, v21, v57
    v_mul_f32 v58, v21, v58
    v_mul_f32 v59, v21, v59
    v_mul_f32 v60, v21, v60
    v_mul_f32 v61, v21, v61
    v_mul_f32 v62, v21, v62
    v_mul_f32 v63, v21, v63
    v_cvt_pk_bf16_f32 v56, v56, v57
    v_cvt_pk_bf16_f32 v57, v58, v59
    v_cvt_pk_bf16_f32 v58, v60, v61
    v_cvt_pk_bf16_f32 v59, v62, v63
    buffer_store_dwordx4 v[56:59], v2, s[8:11], s90 offen offset:1024 sc1
    s_add_u32 s90, s90, 131072
    v_accvgpr_read_b32 v48, a72
    v_accvgpr_read_b32 v49, a73
    v_accvgpr_read_b32 v50, a74
    v_accvgpr_read_b32 v51, a75
    v_accvgpr_read_b32 v52, a76
    v_accvgpr_read_b32 v53, a77
    v_accvgpr_read_b32 v54, a78
    v_accvgpr_read_b32 v55, a79
    v_mul_f32 v48, v20, v48
    v_mul_f32 v49, v20, v49
    v_mul_f32 v50, v20, v50
    v_mul_f32 v51, v20, v51
    v_mul_f32 v52, v20, v52
    v_mul_f32 v53, v20, v53
    v_mul_f32 v54, v20, v54
    v_mul_f32 v55, v20, v55
    v_cvt_pk_bf16_f32 v48, v48, v49
    v_cvt_pk_bf16_f32 v49, v50, v51
    v_cvt_pk_bf16_f32 v50, v52, v53
    v_cvt_pk_bf16_f32 v51, v54, v55
    buffer_store_dwordx4 v[48:51], v2, s[8:11], s90 offen offset:0 sc1
    v_accvgpr_read_b32 v56, a104
    v_accvgpr_read_b32 v57, a105
    v_accvgpr_read_b32 v58, a106
    v_accvgpr_read_b32 v59, a107
    v_accvgpr_read_b32 v60, a108
    v_accvgpr_read_b32 v61, a109
    v_accvgpr_read_b32 v62, a110
    v_accvgpr_read_b32 v63, a111
    v_mul_f32 v56, v21, v56
    v_mul_f32 v57, v21, v57
    v_mul_f32 v58, v21, v58
    v_mul_f32 v59, v21, v59
    v_mul_f32 v60, v21, v60
    v_mul_f32 v61, v21, v61
    v_mul_f32 v62, v21, v62
    v_mul_f32 v63, v21, v63
    v_cvt_pk_bf16_f32 v56, v56, v57
    v_cvt_pk_bf16_f32 v57, v58, v59
    v_cvt_pk_bf16_f32 v58, v60, v61
    v_cvt_pk_bf16_f32 v59, v62, v63
    buffer_store_dwordx4 v[56:59], v2, s[8:11], s90 offen offset:1024 sc1
    s_add_u32 s90, s90, 131072
    v_accvgpr_read_b32 v48, a80
    v_accvgpr_read_b32 v49, a81
    v_accvgpr_read_b32 v50, a82
    v_accvgpr_read_b32 v51, a83
    v_accvgpr_read_b32 v52, a84
    v_accvgpr_read_b32 v53, a85
    v_accvgpr_read_b32 v54, a86
    v_accvgpr_read_b32 v55, a87
    v_mul_f32 v48, v20, v48
    v_mul_f32 v49, v20, v49
    v_mul_f32 v50, v20, v50
    v_mul_f32 v51, v20, v51
    v_mul_f32 v52, v20, v52
    v_mul_f32 v53, v20, v53
    v_mul_f32 v54, v20, v54
    v_mul_f32 v55, v20, v55
    v_cvt_pk_bf16_f32 v48, v48, v49
    v_cvt_pk_bf16_f32 v49, v50, v51
    v_cvt_pk_bf16_f32 v50, v52, v53
    v_cvt_pk_bf16_f32 v51, v54, v55
    buffer_store_dwordx4 v[48:51], v2, s[8:11], s90 offen offset:0 sc1
    v_accvgpr_read_b32 v56, a112
    v_accvgpr_read_b32 v57, a113
    v_accvgpr_read_b32 v58, a114
    v_accvgpr_read_b32 v59, a115
    v_accvgpr_read_b32 v60, a116
    v_accvgpr_read_b32 v61, a117
    v_accvgpr_read_b32 v62, a118
    v_accvgpr_read_b32 v63, a119
    v_mul_f32 v56, v21, v56
    v_mul_f32 v57, v21, v57
    v_mul_f32 v58, v21, v58
    v_mul_f32 v59, v21, v59
    v_mul_f32 v60, v21, v60
    v_mul_f32 v61, v21, v61
    v_mul_f32 v62, v21, v62
    v_mul_f32 v63, v21, v63
    v_cvt_pk_bf16_f32 v56, v56, v57
    v_cvt_pk_bf16_f32 v57, v58, v59
    v_cvt_pk_bf16_f32 v58, v60, v61
    v_cvt_pk_bf16_f32 v59, v62, v63
    buffer_store_dwordx4 v[56:59], v2, s[8:11], s90 offen offset:1024 sc1
    s_add_u32 s90, s90, 131072
    v_accvgpr_read_b32 v48, a88
    v_accvgpr_read_b32 v49, a89
    v_accvgpr_read_b32 v50, a90
    v_accvgpr_read_b32 v51, a91
    v_accvgpr_read_b32 v52, a92
    v_accvgpr_read_b32 v53, a93
    v_accvgpr_read_b32 v54, a94
    v_accvgpr_read_b32 v55, a95
    v_mul_f32 v48, v20, v48
    v_mul_f32 v49, v20, v49
    v_mul_f32 v50, v20, v50
    v_mul_f32 v51, v20, v51
    v_mul_f32 v52, v20, v52
    v_mul_f32 v53, v20, v53
    v_mul_f32 v54, v20, v54
    v_mul_f32 v55, v20, v55
    v_cvt_pk_bf16_f32 v48, v48, v49
    v_cvt_pk_bf16_f32 v49, v50, v51
    v_cvt_pk_bf16_f32 v50, v52, v53
    v_cvt_pk_bf16_f32 v51, v54, v55
    buffer_store_dwordx4 v[48:51], v2, s[8:11], s90 offen offset:0 sc1
    v_accvgpr_read_b32 v56, a120
    v_accvgpr_read_b32 v57, a121
    v_accvgpr_read_b32 v58, a122
    v_accvgpr_read_b32 v59, a123
    v_accvgpr_read_b32 v60, a124
    v_accvgpr_read_b32 v61, a125
    v_accvgpr_read_b32 v62, a126
    v_accvgpr_read_b32 v63, a127
    v_mul_f32 v56, v21, v56
    v_mul_f32 v57, v21, v57
    v_mul_f32 v58, v21, v58
    v_mul_f32 v59, v21, v59
    v_mul_f32 v60, v21, v60
    v_mul_f32 v61, v21, v61
    v_mul_f32 v62, v21, v62
    v_mul_f32 v63, v21, v63
    v_cvt_pk_bf16_f32 v56, v56, v57
    v_cvt_pk_bf16_f32 v57, v58, v59
    v_cvt_pk_bf16_f32 v58, v60, v61
    v_cvt_pk_bf16_f32 v59, v62, v63
    buffer_store_dwordx4 v[56:59], v2, s[8:11], s90 offen offset:1024 sc1
    s_add_u32 s90, s90, 131072
    s_lshl_b32 s17, s34, 5
    s_add_u32 s17, s17, s32
    s_lshl_b32 s17, s17, 3
    s_add_u32 s17, s17, 7936
m_single97:
    v_mfma_f32_16x16x32_bf16 v[64:67], a[192:195], a[128:131], v[160:163]
    s_bitcmp1_b64 s[62:63], s64
    s_cselect_b32 s66, -1.0, s65
    v_add_f32 v12, v12, v28
    v_mfma_f32_16x16x32_bf16 v[64:67], a[196:199], a[132:135], v[64:67]
    s_mov_b32 m0, s59
    ds_read_b128 a[224:227], v6 offset:16384
    v_add_f32 v13, v13, v32
    v_mfma_f32_16x16x32_bf16 v[64:67], a[200:203], a[136:139], v[64:67]
    buffer_load_dwordx4 v7, s[24:27], s56 offen offset:0 sc1 lds
    v_mfma_f32_16x16x32_bf16 v[64:67], a[204:207], a[140:143], v[64:67]
    s_add_u32 s64, s64, 1
    ds_read_b128 a[228:231], v6 offset:17408
    v_exp_f32 v20, v96
    v_mfma_f32_16x16x32_bf16 v[72:75], a[192:195], a[144:147], v[168:171]
    ds_read_b128 a[232:235], v6 offset:18432
    v_exp_f32 v21, v97
    v_mfma_f32_16x16x32_bf16 v[72:75], a[196:199], a[148:151], v[72:75]
    ds_read_b128 a[236:239], v6 offset:19456
    v_cvt_pk_bf16_f32 v144, v20, v21
    v_mfma_f32_16x16x32_bf16 v[72:75], a[200:203], a[152:155], v[72:75]
    ds_read_b128 a[240:243], v6 offset:20480
    v_exp_f32 v22, v98
    v_mfma_f32_16x16x32_bf16 v[72:75], a[204:207], a[156:159], v[72:75]
    s_waitcnt lgkmcnt(5)
    ds_read_b128 a[244:247], v6 offset:21504
    v_mfma_f32_16x16x32_bf16 v[68:71], a[208:211], a[128:131], v[164:167]
    ds_read_b128 a[248:251], v6 offset:22528
    v_exp_f32 v23, v99
    v_mfma_f32_16x16x32_bf16 v[68:71], a[212:215], a[132:135], v[68:71]
    ds_read_b128 a[252:255], v6 offset:23552
    v_cvt_pk_bf16_f32 v145, v22, v23
    v_mfma_f32_16x16x32_bf16 v[68:71], a[216:219], a[136:139], v[68:71]
    buffer_load_dwordx4 v7, s[24:27], s56 offen offset:1024 sc1 lds
    v_mfma_f32_16x16x32_bf16 v[68:71], a[220:223], a[140:143], v[68:71]
    v_exp_f32 v24, v100
    v_mfma_f32_16x16x32_bf16 v[76:79], a[208:211], a[144:147], v[172:175]
    v_exp_f32 v25, v101
    v_mfma_f32_16x16x32_bf16 v[76:79], a[212:215], a[148:151], v[76:79]
    v_exp_f32 v26, v102
    v_mfma_f32_16x16x32_bf16 v[76:79], a[216:219], a[152:155], v[76:79]
    buffer_load_dwordx4 v7, s[24:27], s56 offen offset:2048 sc1 lds
    v_cvt_pk_bf16_f32 v146, v24, v25
    v_mfma_f32_16x16x32_bf16 v[76:79], a[220:223], a[156:159], v[76:79]
    s_waitcnt lgkmcnt(0)
    v_exp_f32 v27, v103
    v_mfma_f32_16x16x32_bf16 a[0:3], a[224:227], v[128:131], a[0:3]
    ds_read_b128 a[192:195], v6 offset:8192
    v_cvt_pk_bf16_f32 v147, v26, v27
    v_mfma_f32_16x16x32_bf16 a[32:35], a[224:227], v[132:135], a[32:35]
    v_exp_f32 v20, v104
    v_mfma_f32_16x16x32_bf16 v[28:31], v[44:47], v[144:147], 0
    v_exp_f32 v21, v105
    v_mfma_f32_16x16x32_bf16 a[4:7], a[228:231], v[128:131], a[4:7]
    ds_read_b128 a[196:199], v6 offset:9216
    v_exp_f32 v22, v106
    v_mfma_f32_16x16x32_bf16 a[36:39], a[228:231], v[132:135], a[36:39]
    buffer_load_dwordx4 v7, s[24:27], s56 offen offset:3072 sc1 lds
    v_mfma_f32_16x16x32_bf16 a[8:11], a[232:235], v[128:131], a[8:11]
    s_add_u32 s56, s56, 16384
    ds_read_b128 a[200:203], v6 offset:10240
    v_cvt_pk_bf16_f32 v148, v20, v21
    v_mfma_f32_16x16x32_bf16 a[40:43], a[232:235], v[132:135], a[40:43]
    v_exp_f32 v23, v107
    v_mfma_f32_16x16x32_bf16 a[12:15], a[236:239], v[128:131], a[12:15]
    ds_read_b128 a[204:207], v6 offset:11264
    v_exp_f32 v24, v108
    v_mfma_f32_16x16x32_bf16 a[44:47], a[236:239], v[132:135], a[44:47]
    v_cvt_pk_bf16_f32 v149, v22, v23
    v_exp_f32 v25, v109
    v_mfma_f32_16x16x32_bf16 a[16:19], a[240:243], v[128:131], a[16:19]
    v_exp_f32 v26, v110
    v_mfma_f32_16x16x32_bf16 a[48:51], a[240:243], v[132:135], a[48:51]
    v_cvt_pk_bf16_f32 v150, v24, v25
    v_exp_f32 v27, v111
    v_mfma_f32_16x16x32_bf16 a[20:23], a[244:247], v[128:131], a[20:23]
    ds_read_b128 a[208:211], v6 offset:12288
    v_cvt_pk_bf16_f32 v151, v26, v27
    v_mfma_f32_16x16x32_bf16 a[52:55], a[244:247], v[132:135], a[52:55]
    s_add_u32 m0, s59, 16384
    ds_read_b128 a[212:215], v6 offset:13312
    v_mfma_f32_16x16x32_bf16 v[32:35], v[44:47], v[148:151], 0
    s_nop 2
    v_mfma_f32_16x16x32_bf16 a[24:27], a[248:251], v[128:131], a[24:27]
    buffer_load_dwordx4 v7, s[28:31], s57 offen offset:0 sc1 lds
    v_mfma_f32_16x16x32_bf16 a[56:59], a[248:251], v[132:135], a[56:59]
    ds_read_b128 a[216:219], v6 offset:14336
    s_nop 0
    v_mfma_f32_16x16x32_bf16 a[28:31], a[252:255], v[128:131], a[28:31]
    ds_read_b128 a[220:223], v6 offset:15360
    v_max_f32 v8, v28, v32
    v_cmp_nge_f32 vcc, s66, v8
    v_mfma_f32_16x16x32_bf16 a[60:63], a[252:255], v[132:135], a[60:63]
    s_waitcnt lgkmcnt(4)
    s_cbranch_vccnz m_stub98
m_ret99:
    v_mfma_f32_16x16x32_bf16 v[96:99], a[192:195], a[128:131], v[160:163]
    s_add_u32 s59, s58, s60
    v_exp_f32 v20, v64
    v_mfma_f32_16x16x32_bf16 v[96:99], a[196:199], a[132:135], v[96:99]
    s_add_u32 s58, s58, 32768
    ds_read_b128 a[224:227], v6 offset:24576
    v_add_f32 v12, v12, v28
    v_mfma_f32_16x16x32_bf16 v[96:99], a[200:203], a[136:139], v[96:99]
    s_and_b32 s58, s58, 0x1ffff
    ds_read_b128 a[228:231], v6 offset:25600
    v_exp_f32 v21, v65
    v_mfma_f32_16x16x32_bf16 v[96:99], a[204:207], a[140:143], v[96:99]
    s_bitcmp1_b64 s[62:63], s64
    s_cselect_b32 s66, -1.0, s65
    ds_read_b128 a[232:235], v6 offset:26624
    v_mfma_f32_16x16x32_bf16 v[104:107], a[192:195], a[144:147], v[168:171]
    buffer_load_dwordx4 v7, s[28:31], s57 offen offset:1024 sc1 lds
    v_mfma_f32_16x16x32_bf16 v[104:107], a[196:199], a[148:151], v[104:107]
    s_add_u32 s64, s64, 1
    ds_read_b128 a[236:239], v6 offset:27648
    v_cvt_pk_bf16_f32 v128, v20, v21
    v_mfma_f32_16x16x32_bf16 v[104:107], a[200:203], a[152:155], v[104:107]
    ds_read_b128 a[240:243], v6 offset:28672
    v_exp_f32 v22, v66
    v_mfma_f32_16x16x32_bf16 v[104:107], a[204:207], a[156:159], v[104:107]
    s_waitcnt lgkmcnt(5)
    ds_read_b128 a[244:247], v6 offset:29696
    v_add_f32 v13, v13, v32
    v_mfma_f32_16x16x32_bf16 v[100:103], a[208:211], a[128:131], v[164:167]
    ds_read_b128 a[248:251], v6 offset:30720
    v_exp_f32 v23, v67
    v_mfma_f32_16x16x32_bf16 v[100:103], a[212:215], a[132:135], v[100:103]
    buffer_load_dwordx4 v7, s[28:31], s57 offen offset:2048 sc1 lds
    v_mfma_f32_16x16x32_bf16 v[100:103], a[216:219], a[136:139], v[100:103]
    ds_read_b128 a[252:255], v6 offset:31744
    v_cvt_pk_bf16_f32 v129, v22, v23
    v_mfma_f32_16x16x32_bf16 v[100:103], a[220:223], a[140:143], v[100:103]
    v_exp_f32 v24, v68
    v_mfma_f32_16x16x32_bf16 v[108:111], a[208:211], a[144:147], v[172:175]
    v_exp_f32 v25, v69
    v_mfma_f32_16x16x32_bf16 v[108:111], a[212:215], a[148:151], v[108:111]
    buffer_load_dwordx4 v7, s[28:31], s57 offen offset:3072 sc1 lds
    v_mfma_f32_16x16x32_bf16 v[108:111], a[216:219], a[152:155], v[108:111]
    s_add_u32 s57, s57, 16384
    v_exp_f32 v26, v70
    v_cvt_pk_bf16_f32 v130, v24, v25
    v_mfma_f32_16x16x32_bf16 v[108:111], a[220:223], a[156:159], v[108:111]
    s_waitcnt vmcnt(16) lgkmcnt(0)
    v_add_u32 v6, s58, v2
    v_exp_f32 v27, v71
    v_mfma_f32_16x16x32_bf16 a[0:3], a[224:227], v[144:147], a[0:3]
    s_barrier
    v_mfma_f32_16x16x32_bf16 a[32:35], a[224:227], v[148:151], a[32:35]
    ds_read_b128 a[192:195], v6 offset:0
    v_cvt_pk_bf16_f32 v131, v26, v27
    v_mfma_f32_16x16x32_bf16 a[4:7], a[228:231], v[144:147], a[4:7]
    v_exp_f32 v20, v72
    v_mfma_f32_16x16x32_bf16 v[28:31], v[44:47], v[128:131], 0
    v_exp_f32 v21, v73
    v_mfma_f32_16x16x32_bf16 a[36:39], a[228:231], v[148:151], a[36:39]
    ds_read_b128 a[196:199], v6 offset:1024
    v_cvt_pk_bf16_f32 v132, v20, v21
    v_mfma_f32_16x16x32_bf16 a[8:11], a[232:235], v[144:147], a[8:11]
    v_exp_f32 v22, v74
    v_mfma_f32_16x16x32_bf16 a[40:43], a[232:235], v[148:151], a[40:43]
    ds_read_b128 a[200:203], v6 offset:2048
    v_exp_f32 v23, v75
    v_mfma_f32_16x16x32_bf16 a[12:15], a[236:239], v[144:147], a[12:15]
    v_exp_f32 v24, v76
    v_mfma_f32_16x16x32_bf16 a[44:47], a[236:239], v[148:151], a[44:47]
    ds_read_b128 a[204:207], v6 offset:3072
    v_cvt_pk_bf16_f32 v133, v22, v23
    v_mfma_f32_16x16x32_bf16 a[16:19], a[240:243], v[144:147], a[16:19]
    v_exp_f32 v25, v77
    v_mfma_f32_16x16x32_bf16 a[48:51], a[240:243], v[148:151], a[48:51]
    v_exp_f32 v26, v78
    v_cvt_pk_bf16_f32 v134, v24, v25
    v_mfma_f32_16x16x32_bf16 a[20:23], a[244:247], v[144:147], a[20:23]
    v_exp_f32 v27, v79
    v_mfma_f32_16x16x32_bf16 a[52:55], a[244:247], v[148:151], a[52:55]
    ds_read_b128 a[208:211], v6 offset:4096
    v_cvt_pk_bf16_f32 v135, v26, v27
    s_nop 1
    v_mfma_f32_16x16x32_bf16 v[32:35], v[44:47], v[132:135], 0
    s_nop 2
    v_mfma_f32_16x16x32_bf16 a[24:27], a[248:251], v[144:147], a[24:27]
    ds_read_b128 a[212:215], v6 offset:5120
    s_nop 0
    v_mfma_f32_16x16x32_bf16 a[56:59], a[248:251], v[148:151], a[56:59]
    ds_read_b128 a[216:219], v6 offset:6144
    v_max_f32 v8, v28, v32
    v_mfma_f32_16x16x32_bf16 a[28:31], a[252:255], v[144:147], a[28:31]
    ds_read_b128 a[220:223], v6 offset:7168
    v_cmp_nge_f32 vcc, s66, v8
    v_mfma_f32_16x16x32_bf16 a[60:63], a[252:255], v[148:151], a[60:63]
    s_waitcnt lgkmcnt(4)
    s_cbranch_vccz m_single97
    v_cmp_lt_f32 vcc, s65, v8
    s_cmp_lg_u32 s64, s70
    s_cbranch_scc1 m_e101
    v_add_f32 v160, v160, v16
    v_mov_b32 v164, v9
    v_add_f32 v172, v172, v16
    v_add_f32 v161, v161, v17
    v_mov_b32 v165, v9
    v_add_f32 v173, v173, v17
    v_add_f32 v162, v162, v18
    v_mov_b32 v166, v9
    v_add_f32 v174, v174, v18
    v_add_f32 v163, v163, v19
    v_mov_b32 v167, v9
    v_add_f32 v175, v175, v19
    s_nop 0
m_e101:
    s_cmp_lg_u32 s64, s71
    s_cbranch_scc1 m_e102
    v_mov_b32 v160, v9
    v_mov_b32 v168, v9
    v_mov_b32 v172, v9
    v_mov_b32 v161, v9
    v_mov_b32 v169, v9
    v_mov_b32 v173, v9
    v_mov_b32 v162, v9
    v_mov_b32 v170, v9
    v_mov_b32 v174, v9
    v_mov_b32 v163, v9
    v_mov_b32 v171, v9
    v_mov_b32 v175, v9
    s_nop 0
m_e102:
    s_cmp_lg_u32 s64, s53
    s_cbranch_scc1 m_e105
    s_cmp_lg_u32 s16, 0
    s_cbranch_scc1 m_np106
    v_mov_b32 v60, s4
    v_mov_b32 v61, s5
    s_add_u32 s90, s17, 117440512
    s_mov_b64 exec, 1
    buffer_store_dwordx2 v[60:61], off, s[8:11], s90 sc1
    s_mov_b64 exec, -1
m_np106:
    s_mov_b32 s17, -1
m_e105:
    s_cmp_gt_u32 s64, 26
    s_cbranch_scc1 m_e103
    s_cmp_lg_u32 s64, 6
    s_cbranch_scc1 m_e107
    s_lshr_b32 s90, s32, 1
    s_lshl_b32 s90, s90, 7
    s_add_u32 s90, s90, 117440600
    v_min_u32 v0, 1, v1
    v_lshlrev_b32 v0, 5, v0
    buffer_load_dwordx2 v[4:5], v0, s[8:11], s90 offen sc1
    s_cmp_eq_u32 s17, -1
    s_cbranch_scc1 m_e103
    s_cmp_lg_u32 s16, 0
    s_cbranch_scc1 m_np108
    v_mov_b32 v60, s4
    v_mov_b32 v61, s5
    s_add_u32 s90, s17, 117440512
    s_mov_b64 exec, 1
    buffer_store_dwordx2 v[60:61], off, s[8:11], s90 sc1
    s_mov_b64 exec, -1
m_np108:
    s_branch m_e103
m_e107:
    s_cmp_lg_u32 s64, 18
    s_cbranch_scc1 m_e109
    s_waitcnt vmcnt(18)
    s_mov_b32 s3, 1048576
m_spin110:
    v_cmp_ne_u64 s[76:77], s[4:5], v[4:5]
    s_nop 3
    s_cmp_eq_u64 s[76:77], 0
    s_cbranch_scc1 m_e103
    s_sub_u32 s3, s3, 1
    s_cbranch_scc1 m_e103
    s_sleep 32
    s_lshr_b32 s90, s32, 1
    s_lshl_b32 s90, s90, 7
    s_add_u32 s90, s90, 117440600
    v_min_u32 v0, 1, v1
    v_lshlrev_b32 v0, 5, v0
    buffer_load_dwordx2 v[4:5], v0, s[8:11], s90 offen sc1
    s_waitcnt vmcnt(0)
    s_branch m_spin110
    s_branch m_e103
m_e109:
    s_cmp_lg_u32 s64, 22
    s_cbranch_scc1 m_e111
    buffer_load_dwordx2 v[4:5], v10, s[8:11], 0 offen sc1
    s_mov_b32 s44, s48
    s_mov_b32 s45, s49
    s_mov_b32 s46, 8388608
    s_lshl_b32 s90, s2, 2
    s_add_u32 s90, s90, s16
    s_lshl_b32 s90, s90, 13
    v_lshlrev_b32 v62, 7, v1
    buffer_load_dword v255, v62, s[44:47], s90 offen
    s_branch m_e103
m_e111:
    s_cmp_lg_u32 s64, 26
    s_cbranch_scc1 m_e112
    s_mov_b32 s44, s50
    s_mov_b32 s45, s51
    s_mov_b32 s46, 2097152
    s_lshl_b32 s90, s2, 2
    s_add_u32 s90, s90, s16
    s_lshl_b32 s90, s90, 13
    v_lshlrev_b32 v62, 7, v1
    buffer_load_dword v255, v62, s[44:47], s90 offen
    s_waitcnt vmcnt(18)
    s_mov_b32 s3, 1048576
m_spin113:
    v_cmp_ne_u64 s[76:77], s[4:5], v[4:5]
    s_nop 3
    s_cmp_eq_u64 s[76:77], 0
    s_cbranch_scc1 m_e103
    s_sub_u32 s3, s3, 1
    s_cbranch_scc1 m_e103
    s_sleep 32
    buffer_load_dwordx2 v[4:5], v10, s[8:11], 0 offen sc1
    s_waitcnt vmcnt(0)
    s_branch m_spin113
    s_branch m_e103
m_e112:
m_e103:
    s_cbranch_vccnz m_rc114
m_sp100:
    s_cmp_lg_u32 s64, s72
    s_cbranch_scc1 m_single97
    s_bfe_u32 s95, s2, 0x10002
    s_and_b32 s90, s2, 7
    s_bitcmp1_b32 0x63, s90
    s_cselect_b32 s96, s33, s34
    s_sub_u32 s96, s96, 1
    s_and_b32 s90, s2, 1
    s_lshl_b32 s90, s90, 2
    s_bfe_u32 s91, s2, 0x20003
    s_add_u32 s97, s90, s91
    v_and_b32 v10, 31, v1
    v_lshlrev_b32 v10, 3, v10
    s_lshl_b32 s52, s96, 8
    s_add_u32 s52, s52, 117448704
    buffer_load_dwordx2 v[4:5], v10, s[8:11], s52 offen sc1
    ds_read_b128 a[224:227], v6 offset:16384
    ds_read_b128 a[228:231], v6 offset:17408
    ds_read_b128 a[232:235], v6 offset:18432
    ds_read_b128 a[236:239], v6 offset:19456
    ds_read_b128 a[240:243], v6 offset:20480
    ds_read_b128 a[244:247], v6 offset:21504
    ds_read_b128 a[248:251], v6 offset:22528
    ds_read_b128 a[252:255], v6 offset:23552
    s_waitcnt lgkmcnt(0)
    v_mfma_f32_16x16x32_bf16 a[0:3], a[224:227], v[128:131], a[0:3]
    buffer_load_dwordx4 v[192:195], v2, s[8:11], s83 offen offset:0 sc1
    v_exp_f32 v20, v96
    v_mfma_f32_16x16x32_bf16 a[32:35], a[224:227], v[132:135], a[32:35]
    v_exp_f32 v21, v97
    v_exp_f32 v22, v98
    v_mfma_f32_16x16x32_bf16 a[4:7], a[228:231], v[128:131], a[4:7]
    buffer_load_dwordx4 v[196:199], v2, s[8:11], s83 offen offset:1024 sc1
    v_cvt_pk_bf16_f32 v144, v20, v21
    v_add_f32 v12, v12, v28
    v_mfma_f32_16x16x32_bf16 a[36:39], a[228:231], v[132:135], a[36:39]
    v_exp_f32 v23, v99
    v_exp_f32 v24, v100
    v_cvt_pk_bf16_f32 v145, v22, v23
    v_mfma_f32_16x16x32_bf16 a[8:11], a[232:235], v[128:131], a[8:11]
    buffer_load_dwordx4 v[200:203], v2, s[8:11], s83 offen offset:2048 sc1
    v_exp_f32 v25, v101
    v_mfma_f32_16x16x32_bf16 a[40:43], a[232:235], v[132:135], a[40:43]
    v_exp_f32 v26, v102
    v_cvt_pk_bf16_f32 v146, v24, v25
    v_add_f32 v13, v13, v32
    v_mfma_f32_16x16x32_bf16 a[12:15], a[236:239], v[128:131], a[12:15]
    buffer_load_dwordx4 v[204:207], v2, s[8:11], s83 offen offset:3072 sc1
    v_exp_f32 v27, v103
    v_mfma_f32_16x16x32_bf16 a[44:47], a[236:239], v[132:135], a[44:47]
    v_exp_f32 v20, v104
    v_cvt_pk_bf16_f32 v147, v26, v27
    v_mfma_f32_16x16x32_bf16 a[16:19], a[240:243], v[128:131], a[16:19]
    buffer_load_dwordx4 v[212:215], v2, s[8:11], s84 offen offset:0 sc1
    v_exp_f32 v21, v105
    v_mfma_f32_16x16x32_bf16 v[28:31], v[44:47], v[144:147], 0
    v_exp_f32 v22, v106
    v_cvt_pk_bf16_f32 v148, v20, v21
    v_exp_f32 v23, v107
    v_mfma_f32_16x16x32_bf16 a[48:51], a[240:243], v[132:135], a[48:51]
    v_exp_f32 v24, v108
    v_cvt_pk_bf16_f32 v149, v22, v23
    v_exp_f32 v25, v109
    v_mfma_f32_16x16x32_bf16 a[20:23], a[244:247], v[128:131], a[20:23]
    buffer_load_dwordx4 v[216:219], v2, s[8:11], s84 offen offset:1024 sc1
    v_exp_f32 v26, v110
    v_mfma_f32_16x16x32_bf16 a[52:55], a[244:247], v[132:135], a[52:55]
    v_cvt_pk_bf16_f32 v150, v24, v25
    v_exp_f32 v27, v111
    s_nop 0
    v_cvt_pk_bf16_f32 v151, v26, v27
    s_nop 1
    v_mfma_f32_16x16x32_bf16 v[32:35], v[44:47], v[148:151], 0
    s_nop 2
    v_mfma_f32_16x16x32_bf16 a[24:27], a[248:251], v[128:131], a[24:27]
    buffer_load_dwordx4 v[220:223], v2, s[8:11], s84 offen offset:2048 sc1
    v_mfma_f32_16x16x32_bf16 a[56:59], a[248:251], v[132:135], a[56:59]
    s_nop 2
    v_mfma_f32_16x16x32_bf16 a[28:31], a[252:255], v[128:131], a[28:31]
    v_max_f32 v8, v28, v32
    v_cmp_nge_f32 vcc, s65, v8
    v_mfma_f32_16x16x32_bf16 a[60:63], a[252:255], v[132:135], a[60:63]
    s_cbranch_vccnz m_stub115
m_ret116:
    s_nop 1
    ds_read_b128 a[224:227], v6 offset:24576
    ds_read_b128 a[228:231], v6 offset:25600
    ds_read_b128 a[232:235], v6 offset:26624
    ds_read_b128 a[236:239], v6 offset:27648
    ds_read_b128 a[240:243], v6 offset:28672
    ds_read_b128 a[244:247], v6 offset:29696
    ds_read_b128 a[248:251], v6 offset:30720
    ds_read_b128 a[252:255], v6 offset:31744
    s_waitcnt lgkmcnt(0)
    v_mfma_f32_16x16x32_bf16 a[0:3], a[224:227], v[144:147], a[0:3]
    buffer_load_dwordx4 v[224:227], v2, s[8:11], s84 offen offset:3072 sc1
    v_mfma_f32_16x16x32_bf16 a[32:35], a[224:227], v[148:151], a[32:35]
    v_mfma_f32_16x16x32_bf16 a[4:7], a[228:231], v[144:147], a[4:7]
    buffer_load_dwordx4 v[208:211], v2, s[8:11], s85 offen offset:0 sc1
    v_mfma_f32_16x16x32_bf16 a[36:39], a[228:231], v[148:151], a[36:39]
    v_mfma_f32_16x16x32_bf16 a[8:11], a[232:235], v[144:147], a[8:11]
    buffer_load_dwordx4 v[232:235], v2, s[8:11], s86 offen offset:0 sc1
    v_mfma_f32_16x16x32_bf16 a[40:43], a[232:235], v[148:151], a[40:43]
    v_mfma_f32_16x16x32_bf16 a[12:15], a[236:239], v[144:147], a[12:15]
    buffer_load_dwordx4 v[236:239], v2, s[8:11], s86 offen offset:1024 sc1
    v_mfma_f32_16x16x32_bf16 a[44:47], a[236:239], v[148:151], a[44:47]
    v_mfma_f32_16x16x32_bf16 a[16:19], a[240:243], v[144:147], a[16:19]
    buffer_load_dwordx4 v[228:231], v2, s[8:11], s87 offen offset:0 sc1
    v_mfma_f32_16x16x32_bf16 a[48:51], a[240:243], v[148:151], a[48:51]
    v_mfma_f32_16x16x32_bf16 a[20:23], a[244:247], v[144:147], a[20:23]
    buffer_load_dwordx4 v[244:247], v2, s[8:11], s88 offen offset:0 sc1
    v_mfma_f32_16x16x32_bf16 a[52:55], a[244:247], v[148:151], a[52:55]
    v_mfma_f32_16x16x32_bf16 a[24:27], a[248:251], v[144:147], a[24:27]
    buffer_load_dwordx4 v[248:251], v2, s[8:11], s88 offen offset:1024 sc1
    v_mfma_f32_16x16x32_bf16 a[56:59], a[248:251], v[148:151], a[56:59]
    v_mfma_f32_16x16x32_bf16 a[28:31], a[252:255], v[144:147], a[28:31]
    buffer_load_dwordx4 v[240:243], v2, s[8:11], s89 offen offset:0 sc1
    v_mfma_f32_16x16x32_bf16 a[60:63], a[252:255], v[148:151], a[60:63]
    s_barrier
    v_add_f32 v20, v12, v28
    v_add_f32 v21, v13, v32
    s_nop 3
    v_rcp_f32 v20, v20
    v_rcp_f32 v21, v21
    s_lshl_b32 s90, s78, 10
    s_add_u32 s90, s90, s82
    s_add_u32 s90, s90, 67108864
    v_accvgpr_read_b32 v48, a0
    v_accvgpr_read_b32 v49, a1
    v_accvgpr_read_b32 v50, a2
    v_accvgpr_read_b32 v51, a3
    v_accvgpr_read_b32 v52, a4
    v_accvgpr_read_b32 v53, a5
    v_accvgpr_read_b32 v54, a6
    v_accvgpr_read_b32 v55, a7
    v_mul_f32 v48, v20, v48
    v_mul_f32 v49, v20, v49
    v_mul_f32 v50, v20, v50
    v_mul_f32 v51, v20, v51
    v_mul_f32 v52, v20, v52
    v_mul_f32 v53, v20, v53
    v_mul_f32 v54, v20, v54
    v_mul_f32 v55, v20, v55
    v_cvt_pk_bf16_f32 v48, v48, v49
    v_cvt_pk_bf16_f32 v49, v50, v51
    v_cvt_pk_bf16_f32 v50, v52, v53
    v_cvt_pk_bf16_f32 v51, v54, v55
    buffer_store_dwordx4 v[48:51], v2, s[8:11], s90 offen offset:0 sc1
    v_accvgpr_read_b32 v56, a32
    v_accvgpr_read_b32 v57, a33
    v_accvgpr_read_b32 v58, a34
    v_accvgpr_read_b32 v59, a35
    v_accvgpr_read_b32 v60, a36
    v_accvgpr_read_b32 v61, a37
    v_accvgpr_read_b32 v62, a38
    v_accvgpr_read_b32 v63, a39
    v_mul_f32 v56, v21, v56
    v_mul_f32 v57, v21, v57
    v_mul_f32 v58, v21, v58
    v_mul_f32 v59, v21, v59
    v_mul_f32 v60, v21, v60
    v_mul_f32 v61, v21, v61
    v_mul_f32 v62, v21, v62
    v_mul_f32 v63, v21, v63
    v_cvt_pk_bf16_f32 v56, v56, v57
    v_cvt_pk_bf16_f32 v57, v58, v59
    v_cvt_pk_bf16_f32 v58, v60, v61
    v_cvt_pk_bf16_f32 v59, v62, v63
    buffer_store_dwordx4 v[56:59], v2, s[8:11], s90 offen offset:1024 sc1
    s_add_u32 s90, s90, 131072
    v_accvgpr_read_b32 v48, a8
    v_accvgpr_read_b32 v49, a9
    v_accvgpr_read_b32 v50, a10
    v_accvgpr_read_b32 v51, a11
    v_accvgpr_read_b32 v52, a12
    v_accvgpr_read_b32 v53, a13
    v_accvgpr_read_b32 v54, a14
    v_accvgpr_read_b32 v55, a15
    v_mul_f32 v48, v20, v48
    v_mul_f32 v49, v20, v49
    v_mul_f32 v50, v20, v50
    v_mul_f32 v51, v20, v51
    v_mul_f32 v52, v20, v52
    v_mul_f32 v53, v20, v53
    v_mul_f32 v54, v20, v54
    v_mul_f32 v55, v20, v55
    v_cvt_pk_bf16_f32 v48, v48, v49
    v_cvt_pk_bf16_f32 v49, v50, v51
    v_cvt_pk_bf16_f32 v50, v52, v53
    v_cvt_pk_bf16_f32 v51, v54, v55
    buffer_store_dwordx4 v[48:51], v2, s[8:11], s90 offen offset:0 sc1
    v_accvgpr_read_b32 v56, a40
    v_accvgpr_read_b32 v57, a41
    v_accvgpr_read_b32 v58, a42
    v_accvgpr_read_b32 v59, a43
    v_accvgpr_read_b32 v60, a44
    v_accvgpr_read_b32 v61, a45
    v_accvgpr_read_b32 v62, a46
    v_accvgpr_read_b32 v63, a47
    v_mul_f32 v56, v21, v56
    v_mul_f32 v57, v21, v57
    v_mul_f32 v58, v21, v58
    v_mul_f32 v59, v21, v59
    v_mul_f32 v60, v21, v60
    v_mul_f32 v61, v21, v61
    v_mul_f32 v62, v21, v62
    v_mul_f32 v63, v21, v63
    v_cvt_pk_bf16_f32 v56, v56, v57
    v_cvt_pk_bf16_f32 v57, v58, v59
    v_cvt_pk_bf16_f32 v58, v60, v61
    v_cvt_pk_bf16_f32 v59, v62, v63
    buffer_store_dwordx4 v[56:59], v2, s[8:11], s90 offen offset:1024 sc1
    s_add_u32 s90, s90, 131072
    v_accvgpr_read_b32 v48, a16
    v_accvgpr_read_b32 v49, a17
    v_accvgpr_read_b32 v50, a18
    v_accvgpr_read_b32 v51, a19
    v_accvgpr_read_b32 v52, a20
    v_accvgpr_read_b32 v53, a21
    v_accvgpr_read_b32 v54, a22
    v_accvgpr_read_b32 v55, a23
    v_mul_f32 v48, v20, v48
    v_mul_f32 v49, v20, v49
    v_mul_f32 v50, v20, v50
    v_mul_f32 v51, v20, v51
    v_mul_f32 v52, v20, v52
    v_mul_f32 v53, v20, v53
    v_mul_f32 v54, v20, v54
    v_mul_f32 v55, v20, v55
    v_cvt_pk_bf16_f32 v48, v48, v49
    v_cvt_pk_bf16_f32 v49, v50, v51
    v_cvt_pk_bf16_f32 v50, v52, v53
    v_cvt_pk_bf16_f32 v51, v54, v55
    buffer_store_dwordx4 v[48:51], v2, s[8:11], s90 offen offset:0 sc1
    v_accvgpr_read_b32 v56, a48
    v_accvgpr_read_b32 v57, a49
    v_accvgpr_read_b32 v58, a50
    v_accvgpr_read_b32 v59, a51
    v_accvgpr_read_b32 v60, a52
    v_accvgpr_read_b32 v61, a53
    v_accvgpr_read_b32 v62, a54
    v_accvgpr_read_b32 v63, a55
    v_mul_f32 v56, v21, v56
    v_mul_f32 v57, v21, v57
    v_mul_f32 v58, v21, v58
    v_mul_f32 v59, v21, v59
    v_mul_f32 v60, v21, v60
    v_mul_f32 v61, v21, v61
    v_mul_f32 v62, v21, v62
    v_mul_f32 v63, v21, v63
    v_cvt_pk_bf16_f32 v56, v56, v57
    v_cvt_pk_bf16_f32 v57, v58, v59
    v_cvt_pk_bf16_f32 v58, v60, v61
    v_cvt_pk_bf16_f32 v59, v62, v63
    buffer_store_dwordx4 v[56:59], v2, s[8:11], s90 offen offset:1024 sc1
    s_add_u32 s90, s90, 131072
    v_accvgpr_read_b32 v48, a24
    v_accvgpr_read_b32 v49, a25
    v_accvgpr_read_b32 v50, a26
    v_accvgpr_read_b32 v51, a27
    v_accvgpr_read_b32 v52, a28
    v_accvgpr_read_b32 v53, a29
    v_accvgpr_read_b32 v54, a30
    v_accvgpr_read_b32 v55, a31
    v_mul_f32 v48, v20, v48
    v_mul_f32 v49, v20, v49
    v_mul_f32 v50, v20, v50
    v_mul_f32 v51, v20, v51
    v_mul_f32 v52, v20, v52
    v_mul_f32 v53, v20, v53
    v_mul_f32 v54, v20, v54
    v_mul_f32 v55, v20, v55
    v_cvt_pk_bf16_f32 v48, v48, v49
    v_cvt_pk_bf16_f32 v49, v50, v51
    v_cvt_pk_bf16_f32 v50, v52, v53
    v_cvt_pk_bf16_f32 v51, v54, v55
    buffer_store_dwordx4 v[48:51], v2, s[8:11], s90 offen offset:0 sc1
    v_accvgpr_read_b32 v56, a56
    v_accvgpr_read_b32 v57, a57
    v_accvgpr_read_b32 v58, a58
    v_accvgpr_read_b32 v59, a59
    v_accvgpr_read_b32 v60, a60
    v_accvgpr_read_b32 v61, a61
    v_accvgpr_read_b32 v62, a62
    v_accvgpr_read_b32 v63, a63
    v_mul_f32 v56, v21, v56
    v_mul_f32 v57, v21, v57
    v_mul_f32 v58, v21, v58
    v_mul_f32 v59, v21, v59
    v_mul_f32 v60, v21, v60
    v_mul_f32 v61, v21, v61
    v_mul_f32 v62, v21, v62
    v_mul_f32 v63, v21, v63
    v_cvt_pk_bf16_f32 v56, v56, v57
    v_cvt_pk_bf16_f32 v57, v58, v59
    v_cvt_pk_bf16_f32 v58, v60, v61
    v_cvt_pk_bf16_f32 v59, v62, v63
    buffer_store_dwordx4 v[56:59], v2, s[8:11], s90 offen offset:1024 sc1
    s_add_u32 s90, s90, 131072
    s_lshr_b32 s53, s16, 1
    s_and_b32 s40, s16, 1
    s_mul_i32 s90, s95, 5242880
    s_lshl_b32 s57, s97, 8
    s_add_u32 s57, s57, s90
    v_lshrrev_b32 v20, 4, v1
    s_lshl_b32 s90, s16, 4
    v_add_u32 v21, s90, v20
    v_lshlrev_b32 v21, 11, v21
    v_lshlrev_b32 v20, 1, v20
    v_and_b32 v22, 15, v1
    v_xor_b32 v20, v20, v22
    v_xor_b32 v22, 0, v20
    v_lshl_add_u32 v16, v22, 4, v21
    v_xor_b32 v22, 8, v20
    v_lshl_add_u32 v17, v22, 4, v21
    v_add_u32 v17, 7168, v17
    v_xor_b32 v22, 0, v20
    v_lshl_add_u32 v18, v22, 4, v21
    v_add_u32 v18, 14336, v18
    v_xor_b32 v22, 8, v20
    v_lshl_add_u32 v19, v22, 4, v21
    v_add_u32 v19, 21504, v19
    s_mov_b32 s24, s48
    s_mov_b32 s25, s49
    s_mov_b32 s26, 8388608
    s_mov_b32 s38, 268435456
    s_mov_b32 s28, s54
    s_mov_b32 s29, s55
    s_mov_b32 s30, 8388608
    s_lshl_b32 s90, s96, 13
    s_lshl_b32 s91, s40, 12
    s_add_u32 s90, s90, s91
    s_lshl_b32 s91, s53, 17
    s_add_u32 s69, s90, s91
    s_mul_i32 s90, s95, 10485760
    s_add_u32 s56, s69, s90
    s_add_u32 s56, s56, 67108864
    s_add_u32 s69, s69, 83886080
    s_add_u32 m0, s60, 16384
    s_nop 0
    buffer_load_dwordx4 v16, s[24:27], s57 offen offset:0 sc1 lds
    buffer_load_dwordx4 v17, s[24:27], s57 offen offset:1024 sc1 lds
    buffer_load_dwordx4 v18, s[24:27], s57 offen offset:2048 sc1 lds
    buffer_load_dwordx4 v19, s[24:27], s57 offen offset:3072 sc1 lds
    s_add_u32 s57, s57, 131072
    s_add_u32 m0, s60, 49152
    s_nop 0
    buffer_load_dwordx4 v16, s[24:27], s57 offen offset:0 sc1 lds
    buffer_load_dwordx4 v17, s[24:27], s57 offen offset:1024 sc1 lds
    buffer_load_dwordx4 v18, s[24:27], s57 offen offset:2048 sc1 lds
    buffer_load_dwordx4 v19, s[24:27], s57 offen offset:3072 sc1 lds
    s_add_u32 s57, s57, 131072
    s_add_u32 m0, s60, 81920
    s_nop 0
    buffer_load_dwordx4 v16, s[24:27], s57 offen offset:0 sc1 lds
    buffer_load_dwordx4 v17, s[24:27], s57 offen offset:1024 sc1 lds
    buffer_load_dwordx4 v18, s[24:27], s57 offen offset:2048 sc1 lds
    buffer_load_dwordx4 v19, s[24:27], s57 offen offset:3072 sc1 lds
    s_add_u32 s57, s57, 131072
    s_add_u32 m0, s60, 114688
    s_nop 0
    buffer_load_dwordx4 v16, s[24:27], s57 offen offset:0 sc1 lds
    buffer_load_dwordx4 v17, s[24:27], s57 offen offset:1024 sc1 lds
    buffer_load_dwordx4 v18, s[24:27], s57 offen offset:2048 sc1 lds
    buffer_load_dwordx4 v19, s[24:27], s57 offen offset:3072 sc1 lds
    s_add_u32 s57, s57, 131072
    s_waitcnt vmcnt(39)
    v_cmp_ne_u64 s[76:77], s[4:5], v[4:5]
    s_mul_i32 s91, s95, 20
    s_nop 2
    s_lshr_b32 s90, s76, s91
    s_ff1_i32_b32 s90, s90
    s_lshl_b32 s68, s90, 1
    s_mul_i32 s91, s95, 0
    s_sub_i32 s68, s68, s91
    s_cmp_lt_i32 s90, 0
    s_cselect_b32 s68, 1000, s68
    s_mov_b32 s99, 0
    s_cmp_gt_i32 s68, 4
    s_cbranch_scc0 m_x1117
    s_mov_b32 s99, 1
    s_add_u32 m0, s60, 0
    s_nop 0
    buffer_load_dwordx4 v2, s[36:39], s56 offen offset:0 sc1 lds
    buffer_load_dwordx4 v2, s[36:39], s56 offen offset:1024 sc1 lds
    buffer_load_dwordx4 v2, s[36:39], s56 offen offset:2048 sc1 lds
    buffer_load_dwordx4 v2, s[36:39], s56 offen offset:3072 sc1 lds
    s_add_u32 s56, s56, 262144
    s_add_u32 m0, s60, 32768
    s_nop 0
    buffer_load_dwordx4 v2, s[36:39], s56 offen offset:0 sc1 lds
    buffer_load_dwordx4 v2, s[36:39], s56 offen offset:1024 sc1 lds
    buffer_load_dwordx4 v2, s[36:39], s56 offen offset:2048 sc1 lds
    buffer_load_dwordx4 v2, s[36:39], s56 offen offset:3072 sc1 lds
    s_add_u32 s56, s56, 262144
    s_add_u32 m0, s60, 65536
    s_nop 0
    buffer_load_dwordx4 v2, s[36:39], s56 offen offset:0 sc1 lds
    buffer_load_dwordx4 v2, s[36:39], s56 offen offset:1024 sc1 lds
    buffer_load_dwordx4 v2, s[36:39], s56 offen offset:2048 sc1 lds
    buffer_load_dwordx4 v2, s[36:39], s56 offen offset:3072 sc1 lds
    s_add_u32 s56, s56, 262144
    s_add_u32 m0, s60, 98304
    s_nop 0
    buffer_load_dwordx4 v2, s[36:39], s56 offen offset:0 sc1 lds
    buffer_load_dwordx4 v2, s[36:39], s56 offen offset:1024 sc1 lds
    buffer_load_dwordx4 v2, s[36:39], s56 offen offset:2048 sc1 lds
    buffer_load_dwordx4 v2, s[36:39], s56 offen offset:3072 sc1 lds
    s_add_u32 s56, s56, 262144
    s_add_u32 m0, s60, 131072
    s_nop 0
    buffer_load_dwordx4 v2, s[36:39], s56 offen offset:0 sc1 lds
    buffer_load_dwordx4 v2, s[36:39], s56 offen offset:1024 sc1 lds
    buffer_load_dwordx4 v2, s[36:39], s56 offen offset:2048 sc1 lds
    buffer_load_dwordx4 v2, s[36:39], s56 offen offset:3072 sc1 lds
    s_add_u32 s56, s56, 262144
m_x1117:
    s_lshl_b32 s90, s53, 12
    v_add_u32 v6, s90, v2
    v_lshrrev_b32 v48, 2, v1
    v_lshlrev_b32 v48, 8, v48
    v_and_b32 v49, 3, v1
    v_lshl_add_u32 v48, v49, 3, v48
    v_add_u32 v48, 16384, v48
    v_bfe_u32 v49, v1, 2, 3
    s_lshl_b32 s90, s40, 2
    v_xor_b32 v49, s90, v49
    v_xor_b32 v50, 0, v49
    v_lshl_add_u32 v12, v50, 5, v48
    v_xor_b32 v50, 1, v49
    v_lshl_add_u32 v13, v50, 5, v48
    v_xor_b32 v50, 2, v49
    v_lshl_add_u32 v14, v50, 5, v48
    v_xor_b32 v50, 3, v49
    v_lshl_add_u32 v15, v50, 5, v48
    v_and_b32 v48, 15, v1
    v_lshlrev_b32 v48, 12, v48
    v_lshlrev_b32 v48, s95, v48
    v_bfe_u32 v49, v1, 4, 1
    v_lshl_add_u32 v48, v49, 5, v48
    v_lshrrev_b32 v49, 5, v1
    v_lshl_add_u32 v7, v49, 4, v48
    s_lshl_b32 s90, s96, 3
    s_lshl_b32 s91, s53, 2
    s_add_u32 s90, s90, s91
    s_lshl_b32 s91, s90, 16
    s_add_u32 s91, s91, 2048
    s_and_b32 s92, s90, 63
    s_lshl_b32 s92, s92, 17
    s_lshr_b32 s93, s90, 6
    s_lshl_b32 s93, s93, 12
    s_add_u32 s92, s92, s93
    s_cmp_eq_u32 s95, 1
    s_cselect_b32 s71, s92, s91
    s_lshl_b32 s72, 0x10000, s95
    s_lshl_b32 s92, s97, 8
    s_lshl_b32 s93, s40, 7
    s_add_u32 s71, s71, s92
    s_add_u32 s71, s71, s93
    v_mov_b64 v[64:65], 0
    v_mov_b64 v[66:67], 0
    v_mov_b64 v[68:69], 0
    v_mov_b64 v[70:71], 0
    v_mov_b64 v[72:73], 0
    v_mov_b64 v[74:75], 0
    v_mov_b64 v[76:77], 0
    v_mov_b64 v[78:79], 0
    v_mov_b64 v[80:81], 0
    v_mov_b64 v[82:83], 0
    v_mov_b64 v[84:85], 0
    v_mov_b64 v[86:87], 0
    v_mov_b64 v[88:89], 0
    v_mov_b64 v[90:91], 0
    v_mov_b64 v[92:93], 0
    v_mov_b64 v[94:95], 0
    v_mov_b64 v[96:97], 0
    v_mov_b64 v[98:99], 0
    v_mov_b64 v[100:101], 0
    v_mov_b64 v[102:103], 0
    v_mov_b64 v[104:105], 0
    v_mov_b64 v[106:107], 0
    v_mov_b64 v[108:109], 0
    v_mov_b64 v[110:111], 0
    v_mov_b64 v[112:113], 0
    v_mov_b64 v[114:115], 0
    v_mov_b64 v[116:117], 0
    v_mov_b64 v[118:119], 0
    v_mov_b64 v[120:121], 0
    v_mov_b64 v[122:123], 0
    v_mov_b64 v[124:125], 0
    v_mov_b64 v[126:127], 0
    v_and_b32 v48, 15, v1
    v_lshrrev_b32 v49, 4, v1
    v_lshlrev_b32 v49, 2, v49
    v_sub_u32 v48, v48, v49
    v_cmp_ge_i32 vcc, -9, v48
    v_subrev_u32 v50, 0, v48
    v_cmp_ge_u32 s[76:77], 7, v50
    s_nop 0
    v_cndmask_b32 v128, v9, 0, vcc
    v_cndmask_b32 v132, v9, 0, s[76:77]
    v_cmp_ge_i32 vcc, -8, v48
    v_subrev_u32 v50, 1, v48
    v_cmp_ge_u32 s[76:77], 7, v50
    s_nop 0
    v_cndmask_b32 v129, v9, 0, vcc
    v_cndmask_b32 v133, v9, 0, s[76:77]
    v_cmp_ge_i32 vcc, -7, v48
    v_subrev_u32 v50, 2, v48
    v_cmp_ge_u32 s[76:77], 7, v50
    s_nop 0
    v_cndmask_b32 v130, v9, 0, vcc
    v_cndmask_b32 v134, v9, 0, s[76:77]
    v_cmp_ge_i32 vcc, -6, v48
    v_subrev_u32 v50, 3, v48
    v_cmp_ge_u32 s[76:77], 7, v50
    s_nop 0
    v_cndmask_b32 v131, v9, 0, vcc
    v_cndmask_b32 v135, v9, 0, s[76:77]
    s_cmp_eq_u32 s81, 0
    s_cselect_b64 vcc, -1, 0
    s_nop 0
    v_cndmask_b32 v136, v128, v9, vcc
    v_cndmask_b32 v137, v129, v9, vcc
    v_cndmask_b32 v138, v130, v9, vcc
    v_cndmask_b32 v139, v131, v9, vcc
    s_lshl_b32 s90, s80, 10
    s_lshr_b32 s91, s2, 3
    s_lshl_b32 s91, s91, 17
    s_add_u32 s90, s90, s91
    s_add_u32 s80, s90, 83886080
    s_add_u32 s59, s60, 131072
    s_mov_b32 s58, 0
    s_mov_b32 s100, 32768
    s_mov_b32 s64, 0
    s_mov_b32 s67, 0
    s_waitcnt vmcnt(36)
    s_cmp_eq_u32 s99, 1
    s_cbranch_scc1 m_x2118
    s_waitcnt vmcnt(16)
m_x2118:
    s_barrier
    s_lshl_b32 s91, s33, 5
    s_add_u32 s91, s91, s32
    s_lshl_b32 s91, s91, 3
    s_add_u32 s91, s91, 7936
    s_cmp_lg_u32 s16, 0
    s_cbranch_scc1 m_np120
    v_mov_b32 v60, s4
    v_mov_b32 v61, s5
    s_add_u32 s90, s91, 117440512
    s_mov_b64 exec, 1
    buffer_store_dwordx2 v[60:61], off, s[8:11], s90 sc1
    s_mov_b64 exec, -1
m_np120:
    s_cmp_eq_u32 s17, -1
    s_cbranch_scc1 m_pb121
    s_cmp_lg_u32 s16, 0
    s_cbranch_scc1 m_np122
    v_mov_b32 v60, s4
    v_mov_b32 v61, s5
    s_add_u32 s90, s17, 117440512
    s_mov_b64 exec, 1
    buffer_store_dwordx2 v[60:61], off, s[8:11], s90 sc1
    s_mov_b64 exec, -1
m_np122:
m_pb121:
    s_cmp_eq_u32 s99, 1
    s_cbranch_scc1 m_x3119
    s_mov_b32 s3, 1048576
m_spin124:
    buffer_load_dwordx2 v[4:5], v10, s[8:11], s52 offen sc1
    s_waitcnt vmcnt(0)
    v_cmp_ne_u64 s[76:77], s[4:5], v[4:5]
    s_mul_i32 s91, s95, 20
    s_nop 2
    s_lshr_b32 s90, s76, s91
    s_ff1_i32_b32 s90, s90
    s_lshl_b32 s68, s90, 1
    s_mul_i32 s91, s95, 0
    s_sub_i32 s68, s68, s91
    s_cmp_lt_i32 s90, 0
    s_cselect_b32 s68, 1000, s68
    s_cmp_gt_i32 s68, 4
    s_cbranch_scc1 m_ok125
    s_sub_u32 s3, s3, 1
    s_cbranch_scc1 m_ok125
    s_sleep 4
    s_branch m_spin124
m_ok125:
    s_add_u32 m0, s60, 0
    s_nop 0
    buffer_load_dwordx4 v2, s[36:39], s56 offen offset:0 sc1 lds
    buffer_load_dwordx4 v2, s[36:39], s56 offen offset:1024 sc1 lds
    buffer_load_dwordx4 v2, s[36:39], s56 offen offset:2048 sc1 lds
    buffer_load_dwordx4 v2, s[36:39], s56 offen offset:3072 sc1 lds
    s_add_u32 s56, s56, 262144
    s_add_u32 m0, s60, 32768
    s_nop 0
    buffer_load_dwordx4 v2, s[36:39], s56 offen offset:0 sc1 lds
    buffer_load_dwordx4 v2, s[36:39], s56 offen offset:1024 sc1 lds
    buffer_load_dwordx4 v2, s[36:39], s56 offen offset:2048 sc1 lds
    buffer_load_dwordx4 v2, s[36:39], s56 offen offset:3072 sc1 lds
    s_add_u32 s56, s56, 262144
    s_add_u32 m0, s60, 65536
    s_nop 0
    buffer_load_dwordx4 v2, s[36:39], s56 offen offset:0 sc1 lds
    buffer_load_dwordx4 v2, s[36:39], s56 offen offset:1024 sc1 lds
    buffer_load_dwordx4 v2, s[36:39], s56 offen offset:2048 sc1 lds
    buffer_load_dwordx4 v2, s[36:39], s56 offen offset:3072 sc1 lds
    s_add_u32 s56, s56, 262144
    s_add_u32 m0, s60, 98304
    s_nop 0
    buffer_load_dwordx4 v2, s[36:39], s56 offen offset:0 sc1 lds
    buffer_load_dwordx4 v2, s[36:39], s56 offen offset:1024 sc1 lds
    buffer_load_dwordx4 v2, s[36:39], s56 offen offset:2048 sc1 lds
    buffer_load_dwordx4 v2, s[36:39], s56 offen offset:3072 sc1 lds
    s_add_u32 s56, s56, 262144
    s_add_u32 m0, s60, 131072
    s_nop 0
    buffer_load_dwordx4 v2, s[36:39], s56 offen offset:0 sc1 lds
    buffer_load_dwordx4 v2, s[36:39], s56 offen offset:1024 sc1 lds
    buffer_load_dwordx4 v2, s[36:39], s56 offen offset:2048 sc1 lds
    buffer_load_dwordx4 v2, s[36:39], s56 offen offset:3072 sc1 lds
    s_add_u32 s56, s56, 262144
    s_waitcnt vmcnt(4)
    s_branch m_x4123
m_x3119:
    s_waitcnt vmcnt(4)
m_x4123:
    s_barrier
    ds_read_b128 a[0:3], v6 offset:0
    ds_read_b64_tr_b16 a[16:17], v12 offset:0
    ds_read_b64_tr_b16 a[18:19], v12 offset:4096
    ds_read_b128 a[4:7], v6 offset:1024
    ds_read_b128 a[8:11], v6 offset:2048
    ds_read_b128 a[12:15], v6 offset:3072
    ds_read_b64_tr_b16 a[20:21], v13 offset:0
    ds_read_b64_tr_b16 a[22:23], v13 offset:4096
    ds_read_b64_tr_b16 a[24:25], v14 offset:0
    ds_read_b64_tr_b16 a[26:27], v14 offset:4096
    ds_read_b64_tr_b16 a[28:29], v15 offset:0
    ds_read_b64_tr_b16 a[30:31], v15 offset:4096
    s_cmp_gt_i32 s68, 5
    s_cbranch_scc0 m_lp131
m_lr132:
    s_waitcnt lgkmcnt(9)
    v_mfma_f32_16x16x32_bf16 v[64:67], a[16:19], a[0:3], v[64:67]
    s_add_u32 m0, s59, 16384
    ds_read_b128 a[32:35], v6 offset:8192
    v_mfma_f32_16x16x32_bf16 v[148:151], v[208:211], v[192:195], v[136:139]
    v_mfma_f32_16x16x32_bf16 v[152:155], v[212:215], v[192:195], v[132:135]
    s_waitcnt lgkmcnt(9)
    v_mfma_f32_16x16x32_bf16 v[72:75], a[16:19], a[4:7], v[72:75]
    ds_read_b64_tr_b16 a[48:49], v12 offset:8192
    buffer_load_dwordx4 v16, s[24:27], s57 offen offset:0 sc1 lds
    v_mfma_f32_16x16x32_bf16 v[156:159], v[212:215], v[196:199], v[128:131]
    s_waitcnt lgkmcnt(9)
    v_mfma_f32_16x16x32_bf16 v[80:83], a[16:19], a[8:11], v[80:83]
    s_add_u32 s59, s58, s60
    ds_read_b64_tr_b16 a[50:51], v12 offset:12288
    v_mfma_f32_16x16x32_bf16 v[160:163], v[216:219], v[196:199], v[132:135]
    v_mfma_f32_16x16x32_bf16 v[164:167], v[216:219], v[200:203], v[128:131]
    s_waitcnt lgkmcnt(9)
    v_mfma_f32_16x16x32_bf16 v[88:91], a[16:19], a[12:15], v[88:91]
    s_add_u32 s58, s58, 32768
    ds_read_b128 a[36:39], v6 offset:9216
    v_mfma_f32_16x16x32_bf16 v[168:171], v[220:223], v[200:203], v[132:135]
    v_mfma_f32_16x16x32_bf16 v[172:175], v[220:223], v[204:207], v[128:131]
    s_waitcnt lgkmcnt(8)
    v_mfma_f32_16x16x32_bf16 v[68:71], a[20:23], a[0:3], v[68:71]
    s_cmp_ge_u32 s58, 163840
    ds_read_b128 a[40:43], v6 offset:10240
    v_mfma_f32_16x16x32_bf16 v[176:179], v[224:227], v[204:207], v[132:135]
    s_nop 1
    v_mfma_f32_16x16x32_bf16 v[76:79], a[20:23], a[4:7], v[76:79]
    ds_read_b128 a[44:47], v6 offset:11264
    buffer_load_dwordx4 v17, s[24:27], s57 offen offset:1024 sc1 lds
    s_nop 1
    v_mfma_f32_16x16x32_bf16 v[84:87], a[20:23], a[8:11], v[84:87]
    s_cselect_b32 s66, 4294836224, s100
    ds_read_b64_tr_b16 a[52:53], v13 offset:8192
    s_nop 1
    s_nop 1
    v_mfma_f32_16x16x32_bf16 v[92:95], a[20:23], a[12:15], v[92:95]
    s_cselect_b32 s58, 0, s58
    ds_read_b64_tr_b16 a[54:55], v13 offset:12288
    v_max3_f32 v140, v148, v149, v150
    v_max3_f32 v141, v156, v157, v158
    s_waitcnt lgkmcnt(10)
    v_mfma_f32_16x16x32_bf16 v[96:99], a[24:27], a[0:3], v[96:99]
    ds_read_b64_tr_b16 a[56:57], v14 offset:8192
    v_max3_f32 v142, v164, v165, v166
    v_max3_f32 v143, v172, v173, v174
    v_mfma_f32_16x16x32_bf16 v[104:107], a[24:27], a[4:7], v[104:107]
    ds_read_b64_tr_b16 a[58:59], v14 offset:12288
    buffer_load_dwordx4 v18, s[24:27], s57 offen offset:2048 sc1 lds
    v_max3_f32 v140, v140, v151, v152
    v_mfma_f32_16x16x32_bf16 v[112:115], a[24:27], a[8:11], v[112:115]
    ds_read_b64_tr_b16 a[60:61], v15 offset:8192
    v_max3_f32 v141, v141, v159, v160
    v_max3_f32 v142, v142, v167, v168
    v_mfma_f32_16x16x32_bf16 v[120:123], a[24:27], a[12:15], v[120:123]
    ds_read_b64_tr_b16 a[62:63], v15 offset:12288
    v_max3_f32 v143, v143, v175, v176
    v_max3_f32 v140, v140, v153, v154
    s_waitcnt lgkmcnt(12)
    v_mfma_f32_16x16x32_bf16 v[100:103], a[28:31], a[0:3], v[100:103]
    v_add_u32 v6, s66, v6
    v_add_u32 v12, s66, v12
    v_max3_f32 v141, v141, v161, v162
    v_mfma_f32_16x16x32_bf16 v[108:111], a[28:31], a[4:7], v[108:111]
    buffer_load_dwordx4 v19, s[24:27], s57 offen offset:3072 sc1 lds
    v_max3_f32 v142, v142, v169, v170
    v_mfma_f32_16x16x32_bf16 v[116:119], a[28:31], a[8:11], v[116:119]
    s_add_u32 s57, s57, 131072
    v_add_u32 v13, s66, v13
    v_add_u32 v14, s66, v14
    v_max3_f32 v143, v143, v177, v178
    v_mfma_f32_16x16x32_bf16 v[124:127], a[28:31], a[12:15], v[124:127]
    s_mov_b32 m0, s59
    v_add_u32 v15, s66, v15
    v_max_f32 v140, v140, v155
    s_waitcnt vmcnt(24) lgkmcnt(0)
    v_mfma_f32_16x16x32_bf16 v[64:67], a[48:51], a[32:35], v[64:67]
    s_barrier
    v_max_f32 v141, v141, v163
    v_max_f32 v142, v142, v171
    v_mfma_f32_16x16x32_bf16 v[72:75], a[48:51], a[36:39], v[72:75]
    ds_read_b128 a[0:3], v6 offset:0
    buffer_load_dwordx4 v2, s[36:39], s56 offen offset:0 sc1 lds
    v_max_f32 v143, v143, v179
    v_mfma_f32_16x16x32_bf16 v[80:83], a[48:51], a[40:43], v[80:83]
    ds_read_b64_tr_b16 a[16:17], v12 offset:0
    v_mov_b32 v144, v140
    v_mov_b32 v145, v141
    v_mfma_f32_16x16x32_bf16 v[88:91], a[48:51], a[44:47], v[88:91]
    ds_read_b64_tr_b16 a[18:19], v12 offset:4096
    v_mov_b32 v146, v142
    v_mov_b32 v147, v143
    v_mfma_f32_16x16x32_bf16 v[68:71], a[52:55], a[32:35], v[68:71]
    ds_read_b128 a[4:7], v6 offset:1024
    s_nop 1
    v_permlane32_swap_b32 v140, v144
    v_mfma_f32_16x16x32_bf16 v[76:79], a[52:55], a[36:39], v[76:79]
    ds_read_b128 a[8:11], v6 offset:2048
    buffer_load_dwordx4 v2, s[36:39], s56 offen offset:1024 sc1 lds
    v_permlane32_swap_b32 v141, v145
    v_mfma_f32_16x16x32_bf16 v[84:87], a[52:55], a[40:43], v[84:87]
    ds_read_b128 a[12:15], v6 offset:3072
    v_permlane32_swap_b32 v142, v146
    v_permlane32_swap_b32 v143, v147
    v_mfma_f32_16x16x32_bf16 v[92:95], a[52:55], a[44:47], v[92:95]
    ds_read_b64_tr_b16 a[20:21], v13 offset:0
    s_nop 1
    v_max_f32 v140, v140, v144
    v_mfma_f32_16x16x32_bf16 v[96:99], a[56:59], a[32:35], v[96:99]
    ds_read_b64_tr_b16 a[22:23], v13 offset:4096
    v_max_f32 v141, v141, v145
    v_max_f32 v142, v142, v146
    v_mfma_f32_16x16x32_bf16 v[104:107], a[56:59], a[36:39], v[104:107]
    ds_read_b64_tr_b16 a[24:25], v14 offset:0
    buffer_load_dwordx4 v2, s[36:39], s56 offen offset:2048 sc1 lds
    v_max_f32 v143, v143, v147
    v_mfma_f32_16x16x32_bf16 v[112:115], a[56:59], a[40:43], v[112:115]
    ds_read_b64_tr_b16 a[26:27], v14 offset:4096
    v_mov_b32 v144, v140
    v_mov_b32 v145, v141
    v_mfma_f32_16x16x32_bf16 v[120:123], a[56:59], a[44:47], v[120:123]
    ds_read_b64_tr_b16 a[28:29], v15 offset:0
    v_mov_b32 v146, v142
    v_mov_b32 v147, v143
    v_mfma_f32_16x16x32_bf16 v[100:103], a[60:63], a[32:35], v[100:103]
    s_add_u32 s64, s64, 1
    ds_read_b64_tr_b16 a[30:31], v15 offset:4096
    s_nop 1
    v_permlane16_swap_b32 v140, v144
    v_mfma_f32_16x16x32_bf16 v[108:111], a[60:63], a[36:39], v[108:111]
    buffer_load_dwordx4 v2, s[36:39], s56 offen offset:3072 sc1 lds
    v_permlane16_swap_b32 v141, v145
    v_mfma_f32_16x16x32_bf16 v[116:119], a[60:63], a[40:43], v[116:119]
    s_add_u32 s56, s56, 262144
    v_permlane16_swap_b32 v142, v146
    v_permlane16_swap_b32 v143, v147
    v_mfma_f32_16x16x32_bf16 v[124:127], a[60:63], a[44:47], v[124:127]
    s_nop 1
    v_max_f32 v140, v140, v144
    s_cmp_gt_i32 s68, 6
    s_cbranch_scc0 m_lp133
m_lr134:
    s_waitcnt lgkmcnt(9)
    v_mfma_f32_16x16x32_bf16 v[64:67], a[16:19], a[0:3], v[64:67]
    s_add_u32 m0, s59, 16384
    ds_read_b128 a[32:35], v6 offset:8192
    v_max_f32 v141, v141, v145
    v_max_f32 v142, v142, v146
    s_waitcnt lgkmcnt(9)
    v_mfma_f32_16x16x32_bf16 v[72:75], a[16:19], a[4:7], v[72:75]
    ds_read_b64_tr_b16 a[48:49], v12 offset:8192
    buffer_load_dwordx4 v16, s[24:27], s57 offen offset:0 sc1 lds
    v_max_f32 v143, v143, v147
    s_waitcnt lgkmcnt(9)
    v_mfma_f32_16x16x32_bf16 v[80:83], a[16:19], a[8:11], v[80:83]
    s_add_u32 s59, s58, s60
    ds_read_b64_tr_b16 a[50:51], v12 offset:12288
    v_sub_f32 v148, v148, v140
    v_sub_f32 v149, v149, v140
    s_waitcnt lgkmcnt(9)
    v_mfma_f32_16x16x32_bf16 v[88:91], a[16:19], a[12:15], v[88:91]
    s_add_u32 s58, s58, 32768
    ds_read_b128 a[36:39], v6 offset:9216
    v_sub_f32 v150, v150, v140
    v_sub_f32 v151, v151, v140
    s_waitcnt lgkmcnt(8)
    v_mfma_f32_16x16x32_bf16 v[68:71], a[20:23], a[0:3], v[68:71]
    s_cmp_ge_u32 s58, 163840
    ds_read_b128 a[40:43], v6 offset:10240
    v_sub_f32 v152, v152, v140
    v_sub_f32 v153, v153, v140
    v_mfma_f32_16x16x32_bf16 v[76:79], a[20:23], a[4:7], v[76:79]
    ds_read_b128 a[44:47], v6 offset:11264
    buffer_load_dwordx4 v17, s[24:27], s57 offen offset:1024 sc1 lds
    v_sub_f32 v154, v154, v140
    v_mfma_f32_16x16x32_bf16 v[84:87], a[20:23], a[8:11], v[84:87]
    s_cselect_b32 s66, 4294836224, s100
    ds_read_b64_tr_b16 a[52:53], v13 offset:8192
    v_sub_f32 v155, v155, v140
    v_sub_f32 v156, v156, v141
    v_mfma_f32_16x16x32_bf16 v[92:95], a[20:23], a[12:15], v[92:95]
    s_cselect_b32 s58, 0, s58
    ds_read_b64_tr_b16 a[54:55], v13 offset:12288
    v_sub_f32 v157, v157, v141
    v_sub_f32 v158, v158, v141
    s_waitcnt lgkmcnt(10)
    v_mfma_f32_16x16x32_bf16 v[96:99], a[24:27], a[0:3], v[96:99]
    ds_read_b64_tr_b16 a[56:57], v14 offset:8192
    v_sub_f32 v159, v159, v141
    v_sub_f32 v160, v160, v141
    v_mfma_f32_16x16x32_bf16 v[104:107], a[24:27], a[4:7], v[104:107]
    ds_read_b64_tr_b16 a[58:59], v14 offset:12288
    buffer_load_dwordx4 v18, s[24:27], s57 offen offset:2048 sc1 lds
    v_sub_f32 v161, v161, v141
    v_mfma_f32_16x16x32_bf16 v[112:115], a[24:27], a[8:11], v[112:115]
    ds_read_b64_tr_b16 a[60:61], v15 offset:8192
    v_sub_f32 v162, v162, v141
    v_sub_f32 v163, v163, v141
    v_mfma_f32_16x16x32_bf16 v[120:123], a[24:27], a[12:15], v[120:123]
    ds_read_b64_tr_b16 a[62:63], v15 offset:12288
    v_sub_f32 v164, v164, v142
    v_sub_f32 v165, v165, v142
    s_waitcnt lgkmcnt(12)
    v_mfma_f32_16x16x32_bf16 v[100:103], a[28:31], a[0:3], v[100:103]
    v_add_u32 v6, s66, v6
    v_add_u32 v12, s66, v12
    v_sub_f32 v166, v166, v142
    v_mfma_f32_16x16x32_bf16 v[108:111], a[28:31], a[4:7], v[108:111]
    buffer_load_dwordx4 v19, s[24:27], s57 offen offset:3072 sc1 lds
    v_sub_f32 v167, v167, v142
    v_mfma_f32_16x16x32_bf16 v[116:119], a[28:31], a[8:11], v[116:119]
    s_add_u32 s57, s57, 131072
    v_add_u32 v13, s66, v13
    v_add_u32 v14, s66, v14
    v_sub_f32 v168, v168, v142
    v_mfma_f32_16x16x32_bf16 v[124:127], a[28:31], a[12:15], v[124:127]
    s_mov_b32 m0, s59
    v_add_u32 v15, s66, v15
    v_sub_f32 v169, v169, v142
    s_waitcnt vmcnt(24) lgkmcnt(0)
    v_mfma_f32_16x16x32_bf16 v[64:67], a[48:51], a[32:35], v[64:67]
    s_barrier
    v_sub_f32 v170, v170, v142
    v_sub_f32 v171, v171, v142
    v_mfma_f32_16x16x32_bf16 v[72:75], a[48:51], a[36:39], v[72:75]
    ds_read_b128 a[0:3], v6 offset:0
    buffer_load_dwordx4 v2, s[36:39], s56 offen offset:0 sc1 lds
    v_sub_f32 v172, v172, v143
    v_mfma_f32_16x16x32_bf16 v[80:83], a[48:51], a[40:43], v[80:83]
    ds_read_b64_tr_b16 a[16:17], v12 offset:0
    v_sub_f32 v173, v173, v143
    v_sub_f32 v174, v174, v143
    v_mfma_f32_16x16x32_bf16 v[88:91], a[48:51], a[44:47], v[88:91]
    ds_read_b64_tr_b16 a[18:19], v12 offset:4096
    v_sub_f32 v175, v175, v143
    v_sub_f32 v176, v176, v143
    v_mfma_f32_16x16x32_bf16 v[68:71], a[52:55], a[32:35], v[68:71]
    ds_read_b128 a[4:7], v6 offset:1024
    v_sub_f32 v177, v177, v143
    v_sub_f32 v178, v178, v143
    v_mfma_f32_16x16x32_bf16 v[76:79], a[52:55], a[36:39], v[76:79]
    ds_read_b128 a[8:11], v6 offset:2048
    buffer_load_dwordx4 v2, s[36:39], s56 offen offset:1024 sc1 lds
    v_sub_f32 v179, v179, v143
    v_mfma_f32_16x16x32_bf16 v[84:87], a[52:55], a[40:43], v[84:87]
    ds_read_b128 a[12:15], v6 offset:3072
    v_exp_f32 v148, v148
    v_exp_f32 v149, v149
    v_mfma_f32_16x16x32_bf16 v[92:95], a[52:55], a[44:47], v[92:95]
    ds_read_b64_tr_b16 a[20:21], v13 offset:0
    v_exp_f32 v150, v150
    v_exp_f32 v151, v151
    v_mfma_f32_16x16x32_bf16 v[96:99], a[56:59], a[32:35], v[96:99]
    ds_read_b64_tr_b16 a[22:23], v13 offset:4096
    v_exp_f32 v152, v152
    v_exp_f32 v153, v153
    v_mfma_f32_16x16x32_bf16 v[104:107], a[56:59], a[36:39], v[104:107]
    ds_read_b64_tr_b16 a[24:25], v14 offset:0
    buffer_load_dwordx4 v2, s[36:39], s56 offen offset:2048 sc1 lds
    v_exp_f32 v154, v154
    v_mfma_f32_16x16x32_bf16 v[112:115], a[56:59], a[40:43], v[112:115]
    ds_read_b64_tr_b16 a[26:27], v14 offset:4096
    v_exp_f32 v155, v155
    v_exp_f32 v156, v156
    v_mfma_f32_16x16x32_bf16 v[120:123], a[56:59], a[44:47], v[120:123]
    ds_read_b64_tr_b16 a[28:29], v15 offset:0
    v_exp_f32 v157, v157
    v_exp_f32 v158, v158
    v_mfma_f32_16x16x32_bf16 v[100:103], a[60:63], a[32:35], v[100:103]
    s_add_u32 s64, s64, 1
    ds_read_b64_tr_b16 a[30:31], v15 offset:4096
    v_exp_f32 v159, v159
    v_exp_f32 v160, v160
    v_mfma_f32_16x16x32_bf16 v[108:111], a[60:63], a[36:39], v[108:111]
    buffer_load_dwordx4 v2, s[36:39], s56 offen offset:3072 sc1 lds
    v_exp_f32 v161, v161
    v_mfma_f32_16x16x32_bf16 v[116:119], a[60:63], a[40:43], v[116:119]
    s_add_u32 s56, s56, 262144
    v_exp_f32 v162, v162
    v_exp_f32 v163, v163
    v_mfma_f32_16x16x32_bf16 v[124:127], a[60:63], a[44:47], v[124:127]
    v_exp_f32 v164, v164
    v_exp_f32 v165, v165
    s_cmp_gt_i32 s68, 7
    s_cbranch_scc0 m_lp135
m_lr136:
    s_waitcnt lgkmcnt(9)
    v_mfma_f32_16x16x32_bf16 v[64:67], a[16:19], a[0:3], v[64:67]
    s_add_u32 m0, s59, 16384
    ds_read_b128 a[32:35], v6 offset:8192
    v_exp_f32 v166, v166
    v_exp_f32 v167, v167
    s_waitcnt lgkmcnt(9)
    v_mfma_f32_16x16x32_bf16 v[72:75], a[16:19], a[4:7], v[72:75]
    ds_read_b64_tr_b16 a[48:49], v12 offset:8192
    buffer_load_dwordx4 v16, s[24:27], s57 offen offset:0 sc1 lds
    v_exp_f32 v168, v168
    s_waitcnt lgkmcnt(9)
    v_mfma_f32_16x16x32_bf16 v[80:83], a[16:19], a[8:11], v[80:83]
    s_add_u32 s59, s58, s60
    ds_read_b64_tr_b16 a[50:51], v12 offset:12288
    v_exp_f32 v169, v169
    v_exp_f32 v170, v170
    s_waitcnt lgkmcnt(9)
    v_mfma_f32_16x16x32_bf16 v[88:91], a[16:19], a[12:15], v[88:91]
    s_add_u32 s58, s58, 32768
    ds_read_b128 a[36:39], v6 offset:9216
    v_exp_f32 v171, v171
    v_exp_f32 v172, v172
    s_waitcnt lgkmcnt(8)
    v_mfma_f32_16x16x32_bf16 v[68:71], a[20:23], a[0:3], v[68:71]
    s_cmp_ge_u32 s58, 163840
    ds_read_b128 a[40:43], v6 offset:10240
    v_exp_f32 v173, v173
    v_exp_f32 v174, v174
    v_mfma_f32_16x16x32_bf16 v[76:79], a[20:23], a[4:7], v[76:79]
    ds_read_b128 a[44:47], v6 offset:11264
    buffer_load_dwordx4 v17, s[24:27], s57 offen offset:1024 sc1 lds
    v_exp_f32 v175, v175
    v_mfma_f32_16x16x32_bf16 v[84:87], a[20:23], a[8:11], v[84:87]
    s_cselect_b32 s66, 4294836224, s100
    ds_read_b64_tr_b16 a[52:53], v13 offset:8192
    v_exp_f32 v176, v176
    v_exp_f32 v177, v177
    v_mfma_f32_16x16x32_bf16 v[92:95], a[20:23], a[12:15], v[92:95]
    s_cselect_b32 s58, 0, s58
    ds_read_b64_tr_b16 a[54:55], v13 offset:12288
    v_exp_f32 v178, v178
    v_exp_f32 v179, v179
    s_waitcnt lgkmcnt(10)
    v_mfma_f32_16x16x32_bf16 v[96:99], a[24:27], a[0:3], v[96:99]
    ds_read_b64_tr_b16 a[56:57], v14 offset:8192
    v_cvt_pk_bf16_f32 v192, v148, v149
    v_cvt_pk_bf16_f32 v193, v150, v151
    v_mfma_f32_16x16x32_bf16 v[104:107], a[24:27], a[4:7], v[104:107]
    ds_read_b64_tr_b16 a[58:59], v14 offset:12288
    buffer_load_dwordx4 v18, s[24:27], s57 offen offset:2048 sc1 lds
    v_cvt_pk_bf16_f32 v194, v152, v153
    v_mfma_f32_16x16x32_bf16 v[112:115], a[24:27], a[8:11], v[112:115]
    ds_read_b64_tr_b16 a[60:61], v15 offset:8192
    v_cvt_pk_bf16_f32 v195, v154, v155
    v_cvt_pk_bf16_f32 v196, v156, v157
    v_mfma_f32_16x16x32_bf16 v[120:123], a[24:27], a[12:15], v[120:123]
    ds_read_b64_tr_b16 a[62:63], v15 offset:12288
    v_cvt_pk_bf16_f32 v197, v158, v159
    v_cvt_pk_bf16_f32 v198, v160, v161
    s_waitcnt lgkmcnt(12)
    v_mfma_f32_16x16x32_bf16 v[100:103], a[28:31], a[0:3], v[100:103]
    v_add_u32 v6, s66, v6
    v_add_u32 v12, s66, v12
    v_cvt_pk_bf16_f32 v199, v162, v163
    v_mfma_f32_16x16x32_bf16 v[108:111], a[28:31], a[4:7], v[108:111]
    buffer_load_dwordx4 v19, s[24:27], s57 offen offset:3072 sc1 lds
    v_cvt_pk_bf16_f32 v200, v164, v165
    v_mfma_f32_16x16x32_bf16 v[116:119], a[28:31], a[8:11], v[116:119]
    s_add_u32 s57, s57, 131072
    v_add_u32 v13, s66, v13
    v_add_u32 v14, s66, v14
    v_cvt_pk_bf16_f32 v201, v166, v167
    v_mfma_f32_16x16x32_bf16 v[124:127], a[28:31], a[12:15], v[124:127]
    s_mov_b32 m0, s59
    v_add_u32 v15, s66, v15
    v_cvt_pk_bf16_f32 v202, v168, v169
    s_waitcnt vmcnt(24) lgkmcnt(0)
    v_mfma_f32_16x16x32_bf16 v[64:67], a[48:51], a[32:35], v[64:67]
    s_barrier
    v_cvt_pk_bf16_f32 v203, v170, v171
    v_cvt_pk_bf16_f32 v204, v172, v173
    v_mfma_f32_16x16x32_bf16 v[72:75], a[48:51], a[36:39], v[72:75]
    ds_read_b128 a[0:3], v6 offset:0
    buffer_load_dwordx4 v2, s[36:39], s56 offen offset:0 sc1 lds
    v_cvt_pk_bf16_f32 v205, v174, v175
    v_mfma_f32_16x16x32_bf16 v[80:83], a[48:51], a[40:43], v[80:83]
    ds_read_b64_tr_b16 a[16:17], v12 offset:0
    v_cvt_pk_bf16_f32 v206, v176, v177
    v_cvt_pk_bf16_f32 v207, v178, v179
    v_mfma_f32_16x16x32_bf16 v[88:91], a[48:51], a[44:47], v[88:91]
    ds_read_b64_tr_b16 a[18:19], v12 offset:4096
    s_nop 1
    v_mfma_f32_16x16x32_bf16 v[20:23], v[44:47], v[192:195], 0
    v_mfma_f32_16x16x32_bf16 v[68:71], a[52:55], a[32:35], v[68:71]
    ds_read_b128 a[4:7], v6 offset:1024
    v_mfma_f32_16x16x32_bf16 v[24:27], v[44:47], v[196:199], 0
    v_mfma_f32_16x16x32_bf16 v[28:31], v[44:47], v[200:203], 0
    v_mfma_f32_16x16x32_bf16 v[76:79], a[52:55], a[36:39], v[76:79]
    ds_read_b128 a[8:11], v6 offset:2048
    buffer_load_dwordx4 v2, s[36:39], s56 offen offset:1024 sc1 lds
    v_mfma_f32_16x16x32_bf16 v[32:35], v[44:47], v[204:207], 0
    v_mfma_f32_16x16x32_bf16 v[84:87], a[52:55], a[40:43], v[84:87]
    ds_read_b128 a[12:15], v6 offset:3072
    v_mfma_f32_16x16x32_bf16 v[148:151], v[230:233], v[192:195], 0
    v_mfma_f32_16x16x32_bf16 v[152:155], v[242:245], v[192:195], 0
    v_mfma_f32_16x16x32_bf16 v[92:95], a[52:55], a[44:47], v[92:95]
    ds_read_b64_tr_b16 a[20:21], v13 offset:0
    v_mfma_f32_16x16x32_bf16 v[156:159], v[232:235], v[196:199], 0
    v_mfma_f32_16x16x32_bf16 v[160:163], v[244:247], v[196:199], 0
    v_mfma_f32_16x16x32_bf16 v[96:99], a[56:59], a[32:35], v[96:99]
    ds_read_b64_tr_b16 a[22:23], v13 offset:4096
    v_mfma_f32_16x16x32_bf16 v[164:167], v[234:237], v[200:203], 0
    v_mfma_f32_16x16x32_bf16 v[168:171], v[246:249], v[200:203], 0
    v_mfma_f32_16x16x32_bf16 v[104:107], a[56:59], a[36:39], v[104:107]
    ds_read_b64_tr_b16 a[24:25], v14 offset:0
    buffer_load_dwordx4 v2, s[36:39], s56 offen offset:2048 sc1 lds
    v_mfma_f32_16x16x32_bf16 v[172:175], v[236:239], v[204:207], 0
    v_mfma_f32_16x16x32_bf16 v[112:115], a[56:59], a[40:43], v[112:115]
    ds_read_b64_tr_b16 a[26:27], v14 offset:4096
    v_mfma_f32_16x16x32_bf16 v[176:179], v[248:251], v[204:207], 0
    v_rcp_f32 v140, v20
    v_mfma_f32_16x16x32_bf16 v[120:123], a[56:59], a[44:47], v[120:123]
    ds_read_b64_tr_b16 a[28:29], v15 offset:0
    v_rcp_f32 v141, v24
    v_rcp_f32 v142, v28
    v_mfma_f32_16x16x32_bf16 v[100:103], a[60:63], a[32:35], v[100:103]
    s_add_u32 s64, s64, 1
    ds_read_b64_tr_b16 a[30:31], v15 offset:4096
    v_rcp_f32 v143, v32
    s_nop 1
    v_mfma_f32_16x16x32_bf16 v[108:111], a[60:63], a[36:39], v[108:111]
    buffer_load_dwordx4 v2, s[36:39], s56 offen offset:3072 sc1 lds
    s_nop 1
    v_mfma_f32_16x16x32_bf16 v[116:119], a[60:63], a[40:43], v[116:119]
    s_add_u32 s56, s56, 262144
    v_mul_f32 v148, v148, v140
    v_mul_f32 v149, v149, v140
    v_mfma_f32_16x16x32_bf16 v[124:127], a[60:63], a[44:47], v[124:127]
    v_mul_f32 v150, v150, v140
    v_mul_f32 v151, v151, v140
    s_cmp_gt_i32 s68, 8
    s_cbranch_scc0 m_lp137
m_lr138:
    s_waitcnt lgkmcnt(9)
    v_mfma_f32_16x16x32_bf16 v[64:67], a[16:19], a[0:3], v[64:67]
    s_add_u32 m0, s59, 16384
    ds_read_b128 a[32:35], v6 offset:8192
    v_mul_f32 v152, v152, v140
    v_mul_f32 v153, v153, v140
    s_waitcnt lgkmcnt(9)
    v_mfma_f32_16x16x32_bf16 v[72:75], a[16:19], a[4:7], v[72:75]
    ds_read_b64_tr_b16 a[48:49], v12 offset:8192
    buffer_load_dwordx4 v16, s[24:27], s57 offen offset:0 sc1 lds
    v_mul_f32 v154, v154, v140
    s_waitcnt lgkmcnt(9)
    v_mfma_f32_16x16x32_bf16 v[80:83], a[16:19], a[8:11], v[80:83]
    s_add_u32 s59, s58, s60
    ds_read_b64_tr_b16 a[50:51], v12 offset:12288
    v_mul_f32 v155, v155, v140
    v_cvt_pk_bf16_f32 v148, v148, v149
    s_waitcnt lgkmcnt(9)
    v_mfma_f32_16x16x32_bf16 v[88:91], a[16:19], a[12:15], v[88:91]
    s_add_u32 s58, s58, 32768
    ds_read_b128 a[36:39], v6 offset:9216
    v_cvt_pk_bf16_f32 v149, v150, v151
    v_cvt_pk_bf16_f32 v150, v152, v153
    s_waitcnt lgkmcnt(8)
    v_mfma_f32_16x16x32_bf16 v[68:71], a[20:23], a[0:3], v[68:71]
    s_cmp_ge_u32 s58, 163840
    ds_read_b128 a[40:43], v6 offset:10240
    v_cvt_pk_bf16_f32 v151, v154, v155
    buffer_store_dwordx4 v[148:151], v2, s[8:11], s80 offen offset:0 sc1
    v_mfma_f32_16x16x32_bf16 v[76:79], a[20:23], a[4:7], v[76:79]
    ds_read_b128 a[44:47], v6 offset:11264
    buffer_load_dwordx4 v17, s[24:27], s57 offen offset:1024 sc1 lds
    v_mul_f32 v156, v156, v141
    v_mfma_f32_16x16x32_bf16 v[84:87], a[20:23], a[8:11], v[84:87]
    s_cselect_b32 s66, 4294836224, s100
    ds_read_b64_tr_b16 a[52:53], v13 offset:8192
    v_mul_f32 v157, v157, v141
    v_mul_f32 v158, v158, v141
    v_mfma_f32_16x16x32_bf16 v[92:95], a[20:23], a[12:15], v[92:95]
    s_cselect_b32 s58, 0, s58
    ds_read_b64_tr_b16 a[54:55], v13 offset:12288
    v_mul_f32 v159, v159, v141
    v_mul_f32 v160, v160, v141
    s_waitcnt lgkmcnt(10)
    v_mfma_f32_16x16x32_bf16 v[96:99], a[24:27], a[0:3], v[96:99]
    ds_read_b64_tr_b16 a[56:57], v14 offset:8192
    v_mul_f32 v161, v161, v141
    v_mul_f32 v162, v162, v141
    v_mfma_f32_16x16x32_bf16 v[104:107], a[24:27], a[4:7], v[104:107]
    ds_read_b64_tr_b16 a[58:59], v14 offset:12288
    buffer_load_dwordx4 v18, s[24:27], s57 offen offset:2048 sc1 lds
    v_mul_f32 v163, v163, v141
    v_mfma_f32_16x16x32_bf16 v[112:115], a[24:27], a[8:11], v[112:115]
    ds_read_b64_tr_b16 a[60:61], v15 offset:8192
    v_cvt_pk_bf16_f32 v156, v156, v157
    v_cvt_pk_bf16_f32 v157, v158, v159
    v_mfma_f32_16x16x32_bf16 v[120:123], a[24:27], a[12:15], v[120:123]
    ds_read_b64_tr_b16 a[62:63], v15 offset:12288
    v_cvt_pk_bf16_f32 v158, v160, v161
    v_cvt_pk_bf16_f32 v159, v162, v163
    s_waitcnt lgkmcnt(12)
    v_mfma_f32_16x16x32_bf16 v[100:103], a[28:31], a[0:3], v[100:103]
    v_add_u32 v6, s66, v6
    v_add_u32 v12, s66, v12
    buffer_store_dwordx4 v[156:159], v2, s[8:11], s80 offen offset:1024 sc1
    v_mfma_f32_16x16x32_bf16 v[108:111], a[28:31], a[4:7], v[108:111]
    buffer_load_dwordx4 v19, s[24:27], s57 offen offset:3072 sc1 lds
    v_mul_f32 v164, v164, v142
    v_mfma_f32_16x16x32_bf16 v[116:119], a[28:31], a[8:11], v[116:119]
    s_add_u32 s57, s57, 131072
    v_add_u32 v13, s66, v13
    v_add_u32 v14, s66, v14
    v_mul_f32 v165, v165, v142
    v_mfma_f32_16x16x32_bf16 v[124:127], a[28:31], a[12:15], v[124:127]
    s_mov_b32 m0, s59
    v_add_u32 v15, s66, v15
    v_mul_f32 v166, v166, v142
    s_waitcnt vmcnt(24) lgkmcnt(0)
    v_mfma_f32_16x16x32_bf16 v[64:67], a[48:51], a[32:35], v[64:67]
    s_barrier
    v_mul_f32 v167, v167, v142
    v_mul_f32 v168, v168, v142
    v_mfma_f32_16x16x32_bf16 v[72:75], a[48:51], a[36:39], v[72:75]
    ds_read_b128 a[0:3], v6 offset:0
    buffer_load_dwordx4 v2, s[36:39], s56 offen offset:0 sc1 lds
    v_mul_f32 v169, v169, v142
    v_mfma_f32_16x16x32_bf16 v[80:83], a[48:51], a[40:43], v[80:83]
    ds_read_b64_tr_b16 a[16:17], v12 offset:0
    v_mul_f32 v170, v170, v142
    v_mul_f32 v171, v171, v142
    v_mfma_f32_16x16x32_bf16 v[88:91], a[48:51], a[44:47], v[88:91]
    ds_read_b64_tr_b16 a[18:19], v12 offset:4096
    v_cvt_pk_bf16_f32 v164, v164, v165
    v_cvt_pk_bf16_f32 v165, v166, v167
    v_mfma_f32_16x16x32_bf16 v[68:71], a[52:55], a[32:35], v[68:71]
    ds_read_b128 a[4:7], v6 offset:1024
    v_cvt_pk_bf16_f32 v166, v168, v169
    v_cvt_pk_bf16_f32 v167, v170, v171
    v_mfma_f32_16x16x32_bf16 v[76:79], a[52:55], a[36:39], v[76:79]
    ds_read_b128 a[8:11], v6 offset:2048
    buffer_load_dwordx4 v2, s[36:39], s56 offen offset:1024 sc1 lds
    buffer_store_dwordx4 v[164:167], v2, s[8:11], s80 offen offset:2048 sc1
    v_mfma_f32_16x16x32_bf16 v[84:87], a[52:55], a[40:43], v[84:87]
    ds_read_b128 a[12:15], v6 offset:3072
    v_mul_f32 v172, v172, v143
    v_mul_f32 v173, v173, v143
    v_mfma_f32_16x16x32_bf16 v[92:95], a[52:55], a[44:47], v[92:95]
    ds_read_b64_tr_b16 a[20:21], v13 offset:0
    v_mul_f32 v174, v174, v143
    v_mul_f32 v175, v175, v143
    v_mfma_f32_16x16x32_bf16 v[96:99], a[56:59], a[32:35], v[96:99]
    ds_read_b64_tr_b16 a[22:23], v13 offset:4096
    v_mul_f32 v176, v176, v143
    v_mul_f32 v177, v177, v143
    v_mfma_f32_16x16x32_bf16 v[104:107], a[56:59], a[36:39], v[104:107]
    ds_read_b64_tr_b16 a[24:25], v14 offset:0
    buffer_load_dwordx4 v2, s[36:39], s56 offen offset:2048 sc1 lds
    v_mul_f32 v178, v178, v143
    v_mfma_f32_16x16x32_bf16 v[112:115], a[56:59], a[40:43], v[112:115]
    ds_read_b64_tr_b16 a[26:27], v14 offset:4096
    v_mul_f32 v179, v179, v143
    v_cvt_pk_bf16_f32 v172, v172, v173
    v_mfma_f32_16x16x32_bf16 v[120:123], a[56:59], a[44:47], v[120:123]
    ds_read_b64_tr_b16 a[28:29], v15 offset:0
    v_cvt_pk_bf16_f32 v173, v174, v175
    v_cvt_pk_bf16_f32 v174, v176, v177
    v_mfma_f32_16x16x32_bf16 v[100:103], a[60:63], a[32:35], v[100:103]
    s_add_u32 s64, s64, 1
    ds_read_b64_tr_b16 a[30:31], v15 offset:4096
    v_cvt_pk_bf16_f32 v175, v178, v179
    buffer_store_dwordx4 v[172:175], v2, s[8:11], s80 offen offset:3072 sc1
    v_mfma_f32_16x16x32_bf16 v[108:111], a[60:63], a[36:39], v[108:111]
    buffer_load_dwordx4 v2, s[36:39], s56 offen offset:3072 sc1 lds
    v_mfma_f32_16x16x32_bf16 v[116:119], a[60:63], a[40:43], v[116:119]
    s_add_u32 s56, s56, 262144
    v_mfma_f32_16x16x32_bf16 v[124:127], a[60:63], a[44:47], v[124:127]
    s_branch m_l3e127
m_lp131:
    s_mov_b32 s3, 1048576
m_spin139:
    buffer_load_dwordx2 v[4:5], v10, s[8:11], s52 offen sc1
    s_waitcnt vmcnt(0)
    v_cmp_ne_u64 s[76:77], s[4:5], v[4:5]
    s_mul_i32 s91, s95, 20
    s_nop 2
    s_lshr_b32 s90, s76, s91
    s_ff1_i32_b32 s90, s90
    s_lshl_b32 s68, s90, 1
    s_mul_i32 s91, s95, 0
    s_sub_i32 s68, s68, s91
    s_cmp_lt_i32 s90, 0
    s_cselect_b32 s68, 1000, s68
    s_cmp_gt_i32 s68, 5
    s_cbranch_scc1 m_ok140
    s_sub_u32 s3, s3, 1
    s_cbranch_scc1 m_ok140
    s_sleep 4
    s_branch m_spin139
m_ok140:
    s_branch m_lr132
m_lp133:
    s_mov_b32 s3, 1048576
m_spin141:
    buffer_load_dwordx2 v[4:5], v10, s[8:11], s52 offen sc1
    s_waitcnt vmcnt(0)
    v_cmp_ne_u64 s[76:77], s[4:5], v[4:5]
    s_mul_i32 s91, s95, 20
    s_nop 2
    s_lshr_b32 s90, s76, s91
    s_ff1_i32_b32 s90, s90
    s_lshl_b32 s68, s90, 1
    s_mul_i32 s91, s95, 0
    s_sub_i32 s68, s68, s91
    s_cmp_lt_i32 s90, 0
    s_cselect_b32 s68, 1000, s68
    s_cmp_gt_i32 s68, 6
    s_cbranch_scc1 m_ok142
    s_sub_u32 s3, s3, 1
    s_cbranch_scc1 m_ok142
    s_sleep 4
    s_branch m_spin141
m_ok142:
    s_branch m_lr134
m_lp135:
    s_mov_b32 s3, 1048576
m_spin143:
    buffer_load_dwordx2 v[4:5], v10, s[8:11], s52 offen sc1
    s_waitcnt vmcnt(0)
    v_cmp_ne_u64 s[76:77], s[4:5], v[4:5]
    s_mul_i32 s91, s95, 20
    s_nop 2
    s_lshr_b32 s90, s76, s91
    s_ff1_i32_b32 s90, s90
    s_lshl_b32 s68, s90, 1
    s_mul_i32 s91, s95, 0
    s_sub_i32 s68, s68, s91
    s_cmp_lt_i32 s90, 0
    s_cselect_b32 s68, 1000, s68
    s_cmp_gt_i32 s68, 7
    s_cbranch_scc1 m_ok144
    s_sub_u32 s3, s3, 1
    s_cbranch_scc1 m_ok144
    s_sleep 4
    s_branch m_spin143
m_ok144:
    s_branch m_lr136
m_lp137:
    s_mov_b32 s3, 1048576
m_spin145:
    buffer_load_dwordx2 v[4:5], v10, s[8:11], s52 offen sc1
    s_waitcnt vmcnt(0)
    v_cmp_ne_u64 s[76:77], s[4:5], v[4:5]
    s_mul_i32 s91, s95, 20
    s_nop 2
    s_lshr_b32 s90, s76, s91
    s_ff1_i32_b32 s90, s90
    s_lshl_b32 s68, s90, 1
    s_mul_i32 s91, s95, 0
    s_sub_i32 s68, s68, s91
    s_cmp_lt_i32 s90, 0
    s_cselect_b32 s68, 1000, s68
    s_cmp_gt_i32 s68, 8
    s_cbranch_scc1 m_ok146
    s_sub_u32 s3, s3, 1
    s_cbranch_scc1 m_ok146
    s_sleep 4
    s_branch m_spin145
m_ok146:
    s_branch m_lr138
m_l3126:
    s_waitcnt lgkmcnt(9)
    v_mfma_f32_16x16x32_bf16 v[64:67], a[16:19], a[0:3], v[64:67]
    s_add_u32 m0, s59, 16384
    ds_read_b128 a[32:35], v6 offset:8192
    s_waitcnt lgkmcnt(9)
    v_mfma_f32_16x16x32_bf16 v[72:75], a[16:19], a[4:7], v[72:75]
    ds_read_b64_tr_b16 a[48:49], v12 offset:8192
    buffer_load_dwordx4 v16, s[24:27], s57 offen offset:0 sc1 lds
    s_waitcnt lgkmcnt(9)
    v_mfma_f32_16x16x32_bf16 v[80:83], a[16:19], a[8:11], v[80:83]
    s_add_u32 s59, s58, s60
    ds_read_b64_tr_b16 a[50:51], v12 offset:12288
    s_waitcnt lgkmcnt(9)
    v_mfma_f32_16x16x32_bf16 v[88:91], a[16:19], a[12:15], v[88:91]
    s_add_u32 s58, s58, 32768
    ds_read_b128 a[36:39], v6 offset:9216
    s_waitcnt lgkmcnt(8)
    v_mfma_f32_16x16x32_bf16 v[68:71], a[20:23], a[0:3], v[68:71]
    s_cmp_ge_u32 s58, 163840
    ds_read_b128 a[40:43], v6 offset:10240
    v_mfma_f32_16x16x32_bf16 v[76:79], a[20:23], a[4:7], v[76:79]
    ds_read_b128 a[44:47], v6 offset:11264
    buffer_load_dwordx4 v17, s[24:27], s57 offen offset:1024 sc1 lds
    v_mfma_f32_16x16x32_bf16 v[84:87], a[20:23], a[8:11], v[84:87]
    s_cselect_b32 s66, 4294836224, s100
    ds_read_b64_tr_b16 a[52:53], v13 offset:8192
    v_mfma_f32_16x16x32_bf16 v[92:95], a[20:23], a[12:15], v[92:95]
    s_cselect_b32 s58, 0, s58
    ds_read_b64_tr_b16 a[54:55], v13 offset:12288
    s_waitcnt lgkmcnt(10)
    v_mfma_f32_16x16x32_bf16 v[96:99], a[24:27], a[0:3], v[96:99]
    ds_read_b64_tr_b16 a[56:57], v14 offset:8192
    v_mfma_f32_16x16x32_bf16 v[104:107], a[24:27], a[4:7], v[104:107]
    ds_read_b64_tr_b16 a[58:59], v14 offset:12288
    buffer_load_dwordx4 v18, s[24:27], s57 offen offset:2048 sc1 lds
    v_mfma_f32_16x16x32_bf16 v[112:115], a[24:27], a[8:11], v[112:115]
    ds_read_b64_tr_b16 a[60:61], v15 offset:8192
    v_mfma_f32_16x16x32_bf16 v[120:123], a[24:27], a[12:15], v[120:123]
    ds_read_b64_tr_b16 a[62:63], v15 offset:12288
    s_waitcnt lgkmcnt(12)
    v_mfma_f32_16x16x32_bf16 v[100:103], a[28:31], a[0:3], v[100:103]
    v_add_u32 v6, s66, v6
    v_add_u32 v12, s66, v12
    v_mfma_f32_16x16x32_bf16 v[108:111], a[28:31], a[4:7], v[108:111]
    buffer_load_dwordx4 v19, s[24:27], s57 offen offset:3072 sc1 lds
    v_mfma_f32_16x16x32_bf16 v[116:119], a[28:31], a[8:11], v[116:119]
    s_add_u32 s57, s57, 131072
    v_add_u32 v13, s66, v13
    v_add_u32 v14, s66, v14
    v_mfma_f32_16x16x32_bf16 v[124:127], a[28:31], a[12:15], v[124:127]
    s_mov_b32 m0, s59
    v_add_u32 v15, s66, v15
    s_waitcnt vmcnt(24) lgkmcnt(0)
    v_mfma_f32_16x16x32_bf16 v[64:67], a[48:51], a[32:35], v[64:67]
    s_barrier
    v_mfma_f32_16x16x32_bf16 v[72:75], a[48:51], a[36:39], v[72:75]
    ds_read_b128 a[0:3], v6 offset:0
    buffer_load_dwordx4 v2, s[36:39], s56 offen offset:0 sc1 lds
    v_mfma_f32_16x16x32_bf16 v[80:83], a[48:51], a[40:43], v[80:83]
    ds_read_b64_tr_b16 a[16:17], v12 offset:0
    v_mfma_f32_16x16x32_bf16 v[88:91], a[48:51], a[44:47], v[88:91]
    ds_read_b64_tr_b16 a[18:19], v12 offset:4096
    v_mfma_f32_16x16x32_bf16 v[68:71], a[52:55], a[32:35], v[68:71]
    ds_read_b128 a[4:7], v6 offset:1024
    v_mfma_f32_16x16x32_bf16 v[76:79], a[52:55], a[36:39], v[76:79]
    ds_read_b128 a[8:11], v6 offset:2048
    buffer_load_dwordx4 v2, s[36:39], s56 offen offset:1024 sc1 lds
    v_mfma_f32_16x16x32_bf16 v[84:87], a[52:55], a[40:43], v[84:87]
    ds_read_b128 a[12:15], v6 offset:3072
    v_mfma_f32_16x16x32_bf16 v[92:95], a[52:55], a[44:47], v[92:95]
    ds_read_b64_tr_b16 a[20:21], v13 offset:0
    v_mfma_f32_16x16x32_bf16 v[96:99], a[56:59], a[32:35], v[96:99]
    ds_read_b64_tr_b16 a[22:23], v13 offset:4096
    v_mfma_f32_16x16x32_bf16 v[104:107], a[56:59], a[36:39], v[104:107]
    ds_read_b64_tr_b16 a[24:25], v14 offset:0
    buffer_load_dwordx4 v2, s[36:39], s56 offen offset:2048 sc1 lds
    v_mfma_f32_16x16x32_bf16 v[112:115], a[56:59], a[40:43], v[112:115]
    ds_read_b64_tr_b16 a[26:27], v14 offset:4096
    v_mfma_f32_16x16x32_bf16 v[120:123], a[56:59], a[44:47], v[120:123]
    ds_read_b64_tr_b16 a[28:29], v15 offset:0
    v_mfma_f32_16x16x32_bf16 v[100:103], a[60:63], a[32:35], v[100:103]
    s_add_u32 s64, s64, 1
    ds_read_b64_tr_b16 a[30:31], v15 offset:4096
    v_mfma_f32_16x16x32_bf16 v[108:111], a[60:63], a[36:39], v[108:111]
    buffer_load_dwordx4 v2, s[36:39], s56 offen offset:3072 sc1 lds
    v_mfma_f32_16x16x32_bf16 v[116:119], a[60:63], a[40:43], v[116:119]
    s_add_u32 s56, s56, 262144
    s_cmp_lt_u32 s64, s67
    v_mfma_f32_16x16x32_bf16 v[124:127], a[60:63], a[44:47], v[124:127]
    s_cbranch_scc1 m_l3126
m_l3e127:
    s_add_u32 s92, s64, 5
    s_cmp_gt_i32 s68, s92
    s_cbranch_scc1 m_rdy147
    s_mov_b32 s3, 1048576
m_spin148:
    buffer_load_dwordx2 v[4:5], v10, s[8:11], s52 offen sc1
    s_waitcnt vmcnt(0)
    v_cmp_ne_u64 s[76:77], s[4:5], v[4:5]
    s_mul_i32 s91, s95, 20
    s_nop 2
    s_lshr_b32 s90, s76, s91
    s_ff1_i32_b32 s90, s90
    s_lshl_b32 s68, s90, 1
    s_mul_i32 s91, s95, 0
    s_sub_i32 s68, s68, s91
    s_cmp_lt_i32 s90, 0
    s_cselect_b32 s68, 1000, s68
    s_cmp_gt_i32 s68, s92
    s_cbranch_scc1 m_ok149
    s_sub_u32 s3, s3, 1
    s_cbranch_scc1 m_ok149
    s_sleep 4
    s_branch m_spin148
m_ok149:
m_rdy147:
    s_mov_b32 s67, 8
    s_cmp_lt_u32 s64, 8
    s_cbranch_scc1 m_l3n130
    s_cmp_eq_u32 s64, 8
    s_cbranch_scc1 m_o1150
m_o2151:
    s_cmp_eq_u32 s95, 0
    s_cbranch_scc1 m_l3c129
    s_mov_b32 s67, 18
    s_cmp_lt_u32 s64, 18
    s_cbranch_scc1 m_l3n130
    s_cmp_lg_u32 s64, 18
    s_cbranch_scc1 m_n152
    s_mov_b32 s68, 1000
    s_lshr_b32 s90, s96, 1
    s_lshl_b32 s90, s90, 8
    s_add_u32 s90, s90, 117452800
    buffer_load_dwordx2 v[4:5], v10, s[8:11], s90 offen sc1
    s_mov_b32 s67, 19
    s_branch m_l3126
m_n152:
    s_cmp_lg_u32 s64, 19
    s_cbranch_scc1 m_n153
    s_waitcnt vmcnt(8)
    s_waitcnt vmcnt(16)
    s_mov_b32 s3, 1048576
m_spin154:
    v_cmp_ne_u64 s[76:77], s[4:5], v[4:5]
    s_nop 3
    s_cmp_eq_u64 s[76:77], 0
    s_cbranch_scc1 m_ok155
    s_sub_u32 s3, s3, 1
    s_cbranch_scc1 m_ok155
    s_sleep 8
    s_lshr_b32 s90, s96, 1
    s_lshl_b32 s90, s90, 8
    s_add_u32 s90, s90, 117452800
    buffer_load_dwordx2 v[4:5], v10, s[8:11], s90 offen sc1
    s_waitcnt vmcnt(0)
    s_branch m_spin154
m_ok155:
    s_mov_b32 s56, s69
    s_mov_b32 s67, 20
    s_branch m_l3126
m_n153:
    s_cmp_lg_u32 s64, 20
    s_cbranch_scc1 m_n156
    s_mov_b32 s24, s50
    s_mov_b32 s25, s51
    s_mov_b32 s26, 2097152
    s_lshl_b32 s57, s97, 8
    s_mov_b32 s67, 24
    s_branch m_l3126
m_n156:
    s_cmp_lg_u32 s64, 24
    s_cbranch_scc1 m_n157
    s_lshl_b32 s90, s96, 3
    s_add_u32 s90, s90, s97
    s_lshl_b32 s90, s90, 15
    s_lshl_b32 s91, s16, 13
    s_add_u32 s90, s90, s91
    s_add_u32 s70, s90, 100663296
    s_nop 3
    v_cvt_pk_bf16_f32 v128, v64, v65
    v_cvt_pk_bf16_f32 v129, v66, v67
    v_cvt_pk_bf16_f32 v130, v68, v69
    v_cvt_pk_bf16_f32 v131, v70, v71
    v_cvt_pk_bf16_f32 v132, v72, v73
    v_cvt_pk_bf16_f32 v133, v74, v75
    v_cvt_pk_bf16_f32 v134, v76, v77
    v_cvt_pk_bf16_f32 v135, v78, v79
    v_cvt_pk_bf16_f32 v136, v80, v81
    v_cvt_pk_bf16_f32 v137, v82, v83
    v_cvt_pk_bf16_f32 v138, v84, v85
    v_cvt_pk_bf16_f32 v139, v86, v87
    v_cvt_pk_bf16_f32 v140, v88, v89
    v_cvt_pk_bf16_f32 v141, v90, v91
    v_cvt_pk_bf16_f32 v142, v92, v93
    v_cvt_pk_bf16_f32 v143, v94, v95
    v_cvt_pk_bf16_f32 v144, v96, v97
    v_cvt_pk_bf16_f32 v145, v98, v99
    v_cvt_pk_bf16_f32 v146, v100, v101
    v_cvt_pk_bf16_f32 v147, v102, v103
    v_cvt_pk_bf16_f32 v148, v104, v105
    v_cvt_pk_bf16_f32 v149, v106, v107
    v_cvt_pk_bf16_f32 v150, v108, v109
    v_cvt_pk_bf16_f32 v151, v110, v111
    v_cvt_pk_bf16_f32 v152, v112, v113
    v_cvt_pk_bf16_f32 v153, v114, v115
    v_cvt_pk_bf16_f32 v154, v116, v117
    v_cvt_pk_bf16_f32 v155, v118, v119
    v_cvt_pk_bf16_f32 v156, v120, v121
    v_cvt_pk_bf16_f32 v157, v122, v123
    v_cvt_pk_bf16_f32 v158, v124, v125
    v_cvt_pk_bf16_f32 v159, v126, v127
    v_mov_b64 v[64:65], 0
    v_mov_b64 v[66:67], 0
    v_mov_b64 v[68:69], 0
    v_mov_b64 v[70:71], 0
    v_mov_b64 v[72:73], 0
    v_mov_b64 v[74:75], 0
    v_mov_b64 v[76:77], 0
    v_mov_b64 v[78:79], 0
    v_mov_b64 v[80:81], 0
    v_mov_b64 v[82:83], 0
    v_mov_b64 v[84:85], 0
    v_mov_b64 v[86:87], 0
    v_mov_b64 v[88:89], 0
    v_mov_b64 v[90:91], 0
    v_mov_b64 v[92:93], 0
    v_mov_b64 v[94:95], 0
    v_mov_b64 v[96:97], 0
    v_mov_b64 v[98:99], 0
    v_mov_b64 v[100:101], 0
    v_mov_b64 v[102:103], 0
    v_mov_b64 v[104:105], 0
    v_mov_b64 v[106:107], 0
    v_mov_b64 v[108:109], 0
    v_mov_b64 v[110:111], 0
    v_mov_b64 v[112:113], 0
    v_mov_b64 v[114:115], 0
    v_mov_b64 v[116:117], 0
    v_mov_b64 v[118:119], 0
    v_mov_b64 v[120:121], 0
    v_mov_b64 v[122:123], 0
    v_mov_b64 v[124:125], 0
    v_mov_b64 v[126:127], 0
    s_nop 1
    s_waitcnt lgkmcnt(9)
    v_mfma_f32_16x16x32_bf16 v[64:67], a[16:19], a[0:3], v[64:67]
    s_add_u32 m0, s59, 16384
    ds_read_b128 a[32:35], v6 offset:8192
    s_waitcnt lgkmcnt(9)
    v_mfma_f32_16x16x32_bf16 v[72:75], a[16:19], a[4:7], v[72:75]
    ds_read_b64_tr_b16 a[48:49], v12 offset:8192
    buffer_load_dwordx4 v16, s[24:27], s57 offen offset:0 sc1 lds
    s_waitcnt lgkmcnt(9)
    v_mfma_f32_16x16x32_bf16 v[80:83], a[16:19], a[8:11], v[80:83]
    s_add_u32 s59, s58, s60
    ds_read_b64_tr_b16 a[50:51], v12 offset:12288
    s_waitcnt lgkmcnt(9)
    v_mfma_f32_16x16x32_bf16 v[88:91], a[16:19], a[12:15], v[88:91]
    s_add_u32 s58, s58, 32768
    ds_read_b128 a[36:39], v6 offset:9216
    s_waitcnt lgkmcnt(8)
    v_mfma_f32_16x16x32_bf16 v[68:71], a[20:23], a[0:3], v[68:71]
    s_cmp_ge_u32 s58, 163840
    ds_read_b128 a[40:43], v6 offset:10240
    v_mfma_f32_16x16x32_bf16 v[76:79], a[20:23], a[4:7], v[76:79]
    ds_read_b128 a[44:47], v6 offset:11264
    buffer_load_dwordx4 v17, s[24:27], s57 offen offset:1024 sc1 lds
    v_mfma_f32_16x16x32_bf16 v[84:87], a[20:23], a[8:11], v[84:87]
    s_cselect_b32 s66, 4294836224, s100
    ds_read_b64_tr_b16 a[52:53], v13 offset:8192
    v_mfma_f32_16x16x32_bf16 v[92:95], a[20:23], a[12:15], v[92:95]
    s_cselect_b32 s58, 0, s58
    ds_read_b64_tr_b16 a[54:55], v13 offset:12288
    s_waitcnt lgkmcnt(10)
    v_mfma_f32_16x16x32_bf16 v[96:99], a[24:27], a[0:3], v[96:99]
    ds_read_b64_tr_b16 a[56:57], v14 offset:8192
    v_mfma_f32_16x16x32_bf16 v[104:107], a[24:27], a[4:7], v[104:107]
    ds_read_b64_tr_b16 a[58:59], v14 offset:12288
    buffer_load_dwordx4 v18, s[24:27], s57 offen offset:2048 sc1 lds
    v_mfma_f32_16x16x32_bf16 v[112:115], a[24:27], a[8:11], v[112:115]
    ds_read_b64_tr_b16 a[60:61], v15 offset:8192
    v_mfma_f32_16x16x32_bf16 v[120:123], a[24:27], a[12:15], v[120:123]
    ds_read_b64_tr_b16 a[62:63], v15 offset:12288
    buffer_store_dwordx4 v[128:131], v2, s[8:11], s70 offen offset:0 sc1
    s_waitcnt lgkmcnt(12)
    v_mfma_f32_16x16x32_bf16 v[100:103], a[28:31], a[0:3], v[100:103]
    v_add_u32 v6, s66, v6
    v_add_u32 v12, s66, v12
    v_mfma_f32_16x16x32_bf16 v[108:111], a[28:31], a[4:7], v[108:111]
    buffer_load_dwordx4 v19, s[24:27], s57 offen offset:3072 sc1 lds
    v_mfma_f32_16x16x32_bf16 v[116:119], a[28:31], a[8:11], v[116:119]
    s_add_u32 s57, s57, 131072
    v_add_u32 v13, s66, v13
    v_add_u32 v14, s66, v14
    v_mfma_f32_16x16x32_bf16 v[124:127], a[28:31], a[12:15], v[124:127]
    s_mov_b32 m0, s59
    v_add_u32 v15, s66, v15
    s_waitcnt vmcnt(24) lgkmcnt(0)
    v_mfma_f32_16x16x32_bf16 v[64:67], a[48:51], a[32:35], v[64:67]
    s_barrier
    v_mfma_f32_16x16x32_bf16 v[72:75], a[48:51], a[36:39], v[72:75]
    ds_read_b128 a[0:3], v6 offset:0
    buffer_load_dwordx4 v2, s[36:39], s56 offen offset:0 sc1 lds
    v_mfma_f32_16x16x32_bf16 v[80:83], a[48:51], a[40:43], v[80:83]
    ds_read_b64_tr_b16 a[16:17], v12 offset:0
    v_mfma_f32_16x16x32_bf16 v[88:91], a[48:51], a[44:47], v[88:91]
    ds_read_b64_tr_b16 a[18:19], v12 offset:4096
    v_mfma_f32_16x16x32_bf16 v[68:71], a[52:55], a[32:35], v[68:71]
    ds_read_b128 a[4:7], v6 offset:1024
    v_mfma_f32_16x16x32_bf16 v[76:79], a[52:55], a[36:39], v[76:79]
    ds_read_b128 a[8:11], v6 offset:2048
    buffer_load_dwordx4 v2, s[36:39], s56 offen offset:1024 sc1 lds
    v_mfma_f32_16x16x32_bf16 v[84:87], a[52:55], a[40:43], v[84:87]
    ds_read_b128 a[12:15], v6 offset:3072
    v_mfma_f32_16x16x32_bf16 v[92:95], a[52:55], a[44:47], v[92:95]
    ds_read_b64_tr_b16 a[20:21], v13 offset:0
    v_mfma_f32_16x16x32_bf16 v[96:99], a[56:59], a[32:35], v[96:99]
    ds_read_b64_tr_b16 a[22:23], v13 offset:4096
    v_mfma_f32_16x16x32_bf16 v[104:107], a[56:59], a[36:39], v[104:107]
    ds_read_b64_tr_b16 a[24:25], v14 offset:0
    buffer_load_dwordx4 v2, s[36:39], s56 offen offset:2048 sc1 lds
    v_mfma_f32_16x16x32_bf16 v[112:115], a[56:59], a[40:43], v[112:115]
    ds_read_b64_tr_b16 a[26:27], v14 offset:4096
    v_mfma_f32_16x16x32_bf16 v[120:123], a[56:59], a[44:47], v[120:123]
    ds_read_b64_tr_b16 a[28:29], v15 offset:0
    buffer_store_dwordx4 v[132:135], v2, s[8:11], s70 offen offset:1024 sc1
    v_mfma_f32_16x16x32_bf16 v[100:103], a[60:63], a[32:35], v[100:103]
    s_add_u32 s64, s64, 1
    ds_read_b64_tr_b16 a[30:31], v15 offset:4096
    v_mfma_f32_16x16x32_bf16 v[108:111], a[60:63], a[36:39], v[108:111]
    buffer_load_dwordx4 v2, s[36:39], s56 offen offset:3072 sc1 lds
    v_mfma_f32_16x16x32_bf16 v[116:119], a[60:63], a[40:43], v[116:119]
    s_add_u32 s56, s56, 262144
    v_mfma_f32_16x16x32_bf16 v[124:127], a[60:63], a[44:47], v[124:127]
    s_waitcnt lgkmcnt(9)
    v_mfma_f32_16x16x32_bf16 v[64:67], a[16:19], a[0:3], v[64:67]
    s_add_u32 m0, s59, 16384
    ds_read_b128 a[32:35], v6 offset:8192
    s_waitcnt lgkmcnt(9)
    v_mfma_f32_16x16x32_bf16 v[72:75], a[16:19], a[4:7], v[72:75]
    ds_read_b64_tr_b16 a[48:49], v12 offset:8192
    buffer_load_dwordx4 v16, s[24:27], s57 offen offset:0 sc1 lds
    s_waitcnt lgkmcnt(9)
    v_mfma_f32_16x16x32_bf16 v[80:83], a[16:19], a[8:11], v[80:83]
    s_add_u32 s59, s58, s60
    ds_read_b64_tr_b16 a[50:51], v12 offset:12288
    s_waitcnt lgkmcnt(9)
    v_mfma_f32_16x16x32_bf16 v[88:91], a[16:19], a[12:15], v[88:91]
    s_add_u32 s58, s58, 32768
    ds_read_b128 a[36:39], v6 offset:9216
    s_waitcnt lgkmcnt(8)
    v_mfma_f32_16x16x32_bf16 v[68:71], a[20:23], a[0:3], v[68:71]
    s_cmp_ge_u32 s58, 163840
    ds_read_b128 a[40:43], v6 offset:10240
    v_mfma_f32_16x16x32_bf16 v[76:79], a[20:23], a[4:7], v[76:79]
    ds_read_b128 a[44:47], v6 offset:11264
    buffer_load_dwordx4 v17, s[24:27], s57 offen offset:1024 sc1 lds
    v_mfma_f32_16x16x32_bf16 v[84:87], a[20:23], a[8:11], v[84:87]
    s_cselect_b32 s66, 4294836224, s100
    ds_read_b64_tr_b16 a[52:53], v13 offset:8192
    v_mfma_f32_16x16x32_bf16 v[92:95], a[20:23], a[12:15], v[92:95]
    s_cselect_b32 s58, 0, s58
    ds_read_b64_tr_b16 a[54:55], v13 offset:12288
    s_waitcnt lgkmcnt(10)
    v_mfma_f32_16x16x32_bf16 v[96:99], a[24:27], a[0:3], v[96:99]
    ds_read_b64_tr_b16 a[56:57], v14 offset:8192
    v_mfma_f32_16x16x32_bf16 v[104:107], a[24:27], a[4:7], v[104:107]
    ds_read_b64_tr_b16 a[58:59], v14 offset:12288
    buffer_load_dwordx4 v18, s[24:27], s57 offen offset:2048 sc1 lds
    v_mfma_f32_16x16x32_bf16 v[112:115], a[24:27], a[8:11], v[112:115]
    ds_read_b64_tr_b16 a[60:61], v15 offset:8192
    v_mfma_f32_16x16x32_bf16 v[120:123], a[24:27], a[12:15], v[120:123]
    ds_read_b64_tr_b16 a[62:63], v15 offset:12288
    buffer_store_dwordx4 v[136:139], v2, s[8:11], s70 offen offset:2048 sc1
    s_waitcnt lgkmcnt(12)
    v_mfma_f32_16x16x32_bf16 v[100:103], a[28:31], a[0:3], v[100:103]
    v_add_u32 v6, s66, v6
    v_add_u32 v12, s66, v12
    v_mfma_f32_16x16x32_bf16 v[108:111], a[28:31], a[4:7], v[108:111]
    buffer_load_dwordx4 v19, s[24:27], s57 offen offset:3072 sc1 lds
    v_mfma_f32_16x16x32_bf16 v[116:119], a[28:31], a[8:11], v[116:119]
    s_add_u32 s57, s57, 131072
    v_add_u32 v13, s66, v13
    v_add_u32 v14, s66, v14
    v_mfma_f32_16x16x32_bf16 v[124:127], a[28:31], a[12:15], v[124:127]
    s_mov_b32 m0, s59
    v_add_u32 v15, s66, v15
    s_waitcnt vmcnt(24) lgkmcnt(0)
    v_mfma_f32_16x16x32_bf16 v[64:67], a[48:51], a[32:35], v[64:67]
    s_barrier
    v_mfma_f32_16x16x32_bf16 v[72:75], a[48:51], a[36:39], v[72:75]
    ds_read_b128 a[0:3], v6 offset:0
    buffer_load_dwordx4 v2, s[36:39], s56 offen offset:0 sc1 lds
    v_mfma_f32_16x16x32_bf16 v[80:83], a[48:51], a[40:43], v[80:83]
    ds_read_b64_tr_b16 a[16:17], v12 offset:0
    v_mfma_f32_16x16x32_bf16 v[88:91], a[48:51], a[44:47], v[88:91]
    ds_read_b64_tr_b16 a[18:19], v12 offset:4096
    v_mfma_f32_16x16x32_bf16 v[68:71], a[52:55], a[32:35], v[68:71]
    ds_read_b128 a[4:7], v6 offset:1024
    v_mfma_f32_16x16x32_bf16 v[76:79], a[52:55], a[36:39], v[76:79]
    ds_read_b128 a[8:11], v6 offset:2048
    buffer_load_dwordx4 v2, s[36:39], s56 offen offset:1024 sc1 lds
    v_mfma_f32_16x16x32_bf16 v[84:87], a[52:55], a[40:43], v[84:87]
    ds_read_b128 a[12:15], v6 offset:3072
    v_mfma_f32_16x16x32_bf16 v[92:95], a[52:55], a[44:47], v[92:95]
    ds_read_b64_tr_b16 a[20:21], v13 offset:0
    v_mfma_f32_16x16x32_bf16 v[96:99], a[56:59], a[32:35], v[96:99]
    ds_read_b64_tr_b16 a[22:23], v13 offset:4096
    v_mfma_f32_16x16x32_bf16 v[104:107], a[56:59], a[36:39], v[104:107]
    ds_read_b64_tr_b16 a[24:25], v14 offset:0
    buffer_load_dwordx4 v2, s[36:39], s56 offen offset:2048 sc1 lds
    v_mfma_f32_16x16x32_bf16 v[112:115], a[56:59], a[40:43], v[112:115]
    ds_read_b64_tr_b16 a[26:27], v14 offset:4096
    v_mfma_f32_16x16x32_bf16 v[120:123], a[56:59], a[44:47], v[120:123]
    ds_read_b64_tr_b16 a[28:29], v15 offset:0
    buffer_store_dwordx4 v[140:143], v2, s[8:11], s70 offen offset:3072 sc1
    s_add_u32 s70, s70, 4096
    v_mfma_f32_16x16x32_bf16 v[100:103], a[60:63], a[32:35], v[100:103]
    s_add_u32 s64, s64, 1
    ds_read_b64_tr_b16 a[30:31], v15 offset:4096
    v_mfma_f32_16x16x32_bf16 v[108:111], a[60:63], a[36:39], v[108:111]
    buffer_load_dwordx4 v2, s[36:39], s56 offen offset:3072 sc1 lds
    v_mfma_f32_16x16x32_bf16 v[116:119], a[60:63], a[40:43], v[116:119]
    s_add_u32 s56, s56, 262144
    v_mfma_f32_16x16x32_bf16 v[124:127], a[60:63], a[44:47], v[124:127]
    s_waitcnt lgkmcnt(9)
    v_mfma_f32_16x16x32_bf16 v[64:67], a[16:19], a[0:3], v[64:67]
    s_add_u32 m0, s59, 16384
    ds_read_b128 a[32:35], v6 offset:8192
    s_waitcnt lgkmcnt(9)
    v_mfma_f32_16x16x32_bf16 v[72:75], a[16:19], a[4:7], v[72:75]
    ds_read_b64_tr_b16 a[48:49], v12 offset:8192
    buffer_load_dwordx4 v16, s[24:27], s57 offen offset:0 sc1 lds
    s_waitcnt lgkmcnt(9)
    v_mfma_f32_16x16x32_bf16 v[80:83], a[16:19], a[8:11], v[80:83]
    s_add_u32 s59, s58, s60
    ds_read_b64_tr_b16 a[50:51], v12 offset:12288
    s_waitcnt lgkmcnt(9)
    v_mfma_f32_16x16x32_bf16 v[88:91], a[16:19], a[12:15], v[88:91]
    s_add_u32 s58, s58, 32768
    ds_read_b128 a[36:39], v6 offset:9216
    s_waitcnt lgkmcnt(8)
    v_mfma_f32_16x16x32_bf16 v[68:71], a[20:23], a[0:3], v[68:71]
    s_cmp_ge_u32 s58, 163840
    ds_read_b128 a[40:43], v6 offset:10240
    v_mfma_f32_16x16x32_bf16 v[76:79], a[20:23], a[4:7], v[76:79]
    ds_read_b128 a[44:47], v6 offset:11264
    buffer_load_dwordx4 v17, s[24:27], s57 offen offset:1024 sc1 lds
    v_mfma_f32_16x16x32_bf16 v[84:87], a[20:23], a[8:11], v[84:87]
    s_cselect_b32 s66, 4294836224, s100
    ds_read_b64_tr_b16 a[52:53], v13 offset:8192
    v_mfma_f32_16x16x32_bf16 v[92:95], a[20:23], a[12:15], v[92:95]
    s_cselect_b32 s58, 0, s58
    ds_read_b64_tr_b16 a[54:55], v13 offset:12288
    s_waitcnt lgkmcnt(10)
    v_mfma_f32_16x16x32_bf16 v[96:99], a[24:27], a[0:3], v[96:99]
    ds_read_b64_tr_b16 a[56:57], v14 offset:8192
    v_mfma_f32_16x16x32_bf16 v[104:107], a[24:27], a[4:7], v[104:107]
    ds_read_b64_tr_b16 a[58:59], v14 offset:12288
    buffer_load_dwordx4 v18, s[24:27], s57 offen offset:2048 sc1 lds
    v_mfma_f32_16x16x32_bf16 v[112:115], a[24:27], a[8:11], v[112:115]
    ds_read_b64_tr_b16 a[60:61], v15 offset:8192
    v_mfma_f32_16x16x32_bf16 v[120:123], a[24:27], a[12:15], v[120:123]
    ds_read_b64_tr_b16 a[62:63], v15 offset:12288
    buffer_store_dwordx4 v[144:147], v2, s[8:11], s70 offen offset:0 sc1
    s_waitcnt lgkmcnt(12)
    v_mfma_f32_16x16x32_bf16 v[100:103], a[28:31], a[0:3], v[100:103]
    v_add_u32 v6, s66, v6
    v_add_u32 v12, s66, v12
    v_mfma_f32_16x16x32_bf16 v[108:111], a[28:31], a[4:7], v[108:111]
    buffer_load_dwordx4 v19, s[24:27], s57 offen offset:3072 sc1 lds
    v_mfma_f32_16x16x32_bf16 v[116:119], a[28:31], a[8:11], v[116:119]
    s_add_u32 s57, s57, 131072
    v_add_u32 v13, s66, v13
    v_add_u32 v14, s66, v14
    v_mfma_f32_16x16x32_bf16 v[124:127], a[28:31], a[12:15], v[124:127]
    s_mov_b32 m0, s59
    v_add_u32 v15, s66, v15
    s_waitcnt vmcnt(24) lgkmcnt(0)
    v_mfma_f32_16x16x32_bf16 v[64:67], a[48:51], a[32:35], v[64:67]
    s_barrier
    v_mfma_f32_16x16x32_bf16 v[72:75], a[48:51], a[36:39], v[72:75]
    ds_read_b128 a[0:3], v6 offset:0
    buffer_load_dwordx4 v2, s[36:39], s56 offen offset:0 sc1 lds
    v_mfma_f32_16x16x32_bf16 v[80:83], a[48:51], a[40:43], v[80:83]
    ds_read_b64_tr_b16 a[16:17], v12 offset:0
    v_mfma_f32_16x16x32_bf16 v[88:91], a[48:51], a[44:47], v[88:91]
    ds_read_b64_tr_b16 a[18:19], v12 offset:4096
    v_mfma_f32_16x16x32_bf16 v[68:71], a[52:55], a[32:35], v[68:71]
    ds_read_b128 a[4:7], v6 offset:1024
    v_mfma_f32_16x16x32_bf16 v[76:79], a[52:55], a[36:39], v[76:79]
    ds_read_b128 a[8:11], v6 offset:2048
    buffer_load_dwordx4 v2, s[36:39], s56 offen offset:1024 sc1 lds
    v_mfma_f32_16x16x32_bf16 v[84:87], a[52:55], a[40:43], v[84:87]
    ds_read_b128 a[12:15], v6 offset:3072
    v_mfma_f32_16x16x32_bf16 v[92:95], a[52:55], a[44:47], v[92:95]
    ds_read_b64_tr_b16 a[20:21], v13 offset:0
    v_mfma_f32_16x16x32_bf16 v[96:99], a[56:59], a[32:35], v[96:99]
    ds_read_b64_tr_b16 a[22:23], v13 offset:4096
    v_mfma_f32_16x16x32_bf16 v[104:107], a[56:59], a[36:39], v[104:107]
    ds_read_b64_tr_b16 a[24:25], v14 offset:0
    buffer_load_dwordx4 v2, s[36:39], s56 offen offset:2048 sc1 lds
    v_mfma_f32_16x16x32_bf16 v[112:115], a[56:59], a[40:43], v[112:115]
    ds_read_b64_tr_b16 a[26:27], v14 offset:4096
    v_mfma_f32_16x16x32_bf16 v[120:123], a[56:59], a[44:47], v[120:123]
    ds_read_b64_tr_b16 a[28:29], v15 offset:0
    buffer_store_dwordx4 v[148:151], v2, s[8:11], s70 offen offset:1024 sc1
    v_mfma_f32_16x16x32_bf16 v[100:103], a[60:63], a[32:35], v[100:103]
    s_add_u32 s64, s64, 1
    ds_read_b64_tr_b16 a[30:31], v15 offset:4096
    v_mfma_f32_16x16x32_bf16 v[108:111], a[60:63], a[36:39], v[108:111]
    buffer_load_dwordx4 v2, s[36:39], s56 offen offset:3072 sc1 lds
    v_mfma_f32_16x16x32_bf16 v[116:119], a[60:63], a[40:43], v[116:119]
    s_add_u32 s56, s56, 262144
    v_mfma_f32_16x16x32_bf16 v[124:127], a[60:63], a[44:47], v[124:127]
    s_waitcnt lgkmcnt(9)
    v_mfma_f32_16x16x32_bf16 v[64:67], a[16:19], a[0:3], v[64:67]
    s_add_u32 m0, s59, 16384
    ds_read_b128 a[32:35], v6 offset:8192
    s_waitcnt lgkmcnt(9)
    v_mfma_f32_16x16x32_bf16 v[72:75], a[16:19], a[4:7], v[72:75]
    ds_read_b64_tr_b16 a[48:49], v12 offset:8192
    buffer_load_dwordx4 v16, s[24:27], s57 offen offset:0 sc1 lds
    s_waitcnt lgkmcnt(9)
    v_mfma_f32_16x16x32_bf16 v[80:83], a[16:19], a[8:11], v[80:83]
    s_add_u32 s59, s58, s60
    ds_read_b64_tr_b16 a[50:51], v12 offset:12288
    s_waitcnt lgkmcnt(9)
    v_mfma_f32_16x16x32_bf16 v[88:91], a[16:19], a[12:15], v[88:91]
    s_add_u32 s58, s58, 32768
    ds_read_b128 a[36:39], v6 offset:9216
    s_waitcnt lgkmcnt(8)
    v_mfma_f32_16x16x32_bf16 v[68:71], a[20:23], a[0:3], v[68:71]
    s_cmp_ge_u32 s58, 163840
    ds_read_b128 a[40:43], v6 offset:10240
    v_mfma_f32_16x16x32_bf16 v[76:79], a[20:23], a[4:7], v[76:79]
    ds_read_b128 a[44:47], v6 offset:11264
    buffer_load_dwordx4 v17, s[24:27], s57 offen offset:1024 sc1 lds
    v_mfma_f32_16x16x32_bf16 v[84:87], a[20:23], a[8:11], v[84:87]
    s_cselect_b32 s66, 4294836224, s100
    ds_read_b64_tr_b16 a[52:53], v13 offset:8192
    v_mfma_f32_16x16x32_bf16 v[92:95], a[20:23], a[12:15], v[92:95]
    s_cselect_b32 s58, 0, s58
    ds_read_b64_tr_b16 a[54:55], v13 offset:12288
    s_waitcnt lgkmcnt(10)
    v_mfma_f32_16x16x32_bf16 v[96:99], a[24:27], a[0:3], v[96:99]
    ds_read_b64_tr_b16 a[56:57], v14 offset:8192
    v_mfma_f32_16x16x32_bf16 v[104:107], a[24:27], a[4:7], v[104:107]
    ds_read_b64_tr_b16 a[58:59], v14 offset:12288
    buffer_load_dwordx4 v18, s[24:27], s57 offen offset:2048 sc1 lds
    v_mfma_f32_16x16x32_bf16 v[112:115], a[24:27], a[8:11], v[112:115]
    ds_read_b64_tr_b16 a[60:61], v15 offset:8192
    v_mfma_f32_16x16x32_bf16 v[120:123], a[24:27], a[12:15], v[120:123]
    ds_read_b64_tr_b16 a[62:63], v15 offset:12288
    buffer_store_dwordx4 v[152:155], v2, s[8:11], s70 offen offset:2048 sc1
    s_waitcnt lgkmcnt(12)
    v_mfma_f32_16x16x32_bf16 v[100:103], a[28:31], a[0:3], v[100:103]
    v_add_u32 v6, s66, v6
    v_add_u32 v12, s66, v12
    v_mfma_f32_16x16x32_bf16 v[108:111], a[28:31], a[4:7], v[108:111]
    buffer_load_dwordx4 v19, s[24:27], s57 offen offset:3072 sc1 lds
    v_mfma_f32_16x16x32_bf16 v[116:119], a[28:31], a[8:11], v[116:119]
    s_add_u32 s57, s57, 131072
    v_add_u32 v13, s66, v13
    v_add_u32 v14, s66, v14
    v_mfma_f32_16x16x32_bf16 v[124:127], a[28:31], a[12:15], v[124:127]
    s_mov_b32 m0, s59
    v_add_u32 v15, s66, v15
    s_waitcnt vmcnt(24) lgkmcnt(0)
    v_mfma_f32_16x16x32_bf16 v[64:67], a[48:51], a[32:35], v[64:67]
    s_barrier
    v_mfma_f32_16x16x32_bf16 v[72:75], a[48:51], a[36:39], v[72:75]
    ds_read_b128 a[0:3], v6 offset:0
    buffer_load_dwordx4 v2, s[36:39], s56 offen offset:0 sc1 lds
    v_mfma_f32_16x16x32_bf16 v[80:83], a[48:51], a[40:43], v[80:83]
    ds_read_b64_tr_b16 a[16:17], v12 offset:0
    v_mfma_f32_16x16x32_bf16 v[88:91], a[48:51], a[44:47], v[88:91]
    ds_read_b64_tr_b16 a[18:19], v12 offset:4096
    v_mfma_f32_16x16x32_bf16 v[68:71], a[52:55], a[32:35], v[68:71]
    ds_read_b128 a[4:7], v6 offset:1024
    v_mfma_f32_16x16x32_bf16 v[76:79], a[52:55], a[36:39], v[76:79]
    ds_read_b128 a[8:11], v6 offset:2048
    buffer_load_dwordx4 v2, s[36:39], s56 offen offset:1024 sc1 lds
    v_mfma_f32_16x16x32_bf16 v[84:87], a[52:55], a[40:43], v[84:87]
    ds_read_b128 a[12:15], v6 offset:3072
    v_mfma_f32_16x16x32_bf16 v[92:95], a[52:55], a[44:47], v[92:95]
    ds_read_b64_tr_b16 a[20:21], v13 offset:0
    v_mfma_f32_16x16x32_bf16 v[96:99], a[56:59], a[32:35], v[96:99]
    ds_read_b64_tr_b16 a[22:23], v13 offset:4096
    v_mfma_f32_16x16x32_bf16 v[104:107], a[56:59], a[36:39], v[104:107]
    ds_read_b64_tr_b16 a[24:25], v14 offset:0
    buffer_load_dwordx4 v2, s[36:39], s56 offen offset:2048 sc1 lds
    v_mfma_f32_16x16x32_bf16 v[112:115], a[56:59], a[40:43], v[112:115]
    ds_read_b64_tr_b16 a[26:27], v14 offset:4096
    v_mfma_f32_16x16x32_bf16 v[120:123], a[56:59], a[44:47], v[120:123]
    ds_read_b64_tr_b16 a[28:29], v15 offset:0
    buffer_store_dwordx4 v[156:159], v2, s[8:11], s70 offen offset:3072 sc1
    s_add_u32 s70, s70, 4096
    v_mfma_f32_16x16x32_bf16 v[100:103], a[60:63], a[32:35], v[100:103]
    s_add_u32 s64, s64, 1
    ds_read_b64_tr_b16 a[30:31], v15 offset:4096
    v_mfma_f32_16x16x32_bf16 v[108:111], a[60:63], a[36:39], v[108:111]
    buffer_load_dwordx4 v2, s[36:39], s56 offen offset:3072 sc1 lds
    v_mfma_f32_16x16x32_bf16 v[116:119], a[60:63], a[40:43], v[116:119]
    s_add_u32 s56, s56, 262144
    v_mfma_f32_16x16x32_bf16 v[124:127], a[60:63], a[44:47], v[124:127]
    s_mov_b32 s67, 32
    s_branch m_l3126
m_n157:
    s_cmp_lg_u32 s64, 32
    s_cbranch_scc1 m_n158
    s_lshl_b32 s91, s96, 3
    s_add_u32 s91, s91, s97
    s_lshl_b32 s91, s91, 7
    s_add_u32 s91, s91, 16384
    s_cmp_lg_u32 s16, 0
    s_cbranch_scc1 m_np159
    v_mov_b32 v60, s4
    v_mov_b32 v61, s5
    s_add_u32 s90, s91, 117440512
    s_mov_b64 exec, 1
    buffer_store_dwordx2 v[60:61], off, s[8:11], s90 sc1
    s_mov_b64 exec, -1
m_np159:
    s_mov_b32 s67, 35
    s_branch m_l3126
m_n158:
    s_cmp_lg_u32 s64, 35
    s_cbranch_scc1 m_n160
    s_mov_b32 s38, 0
    s_mov_b32 s67, 40
    s_branch m_l3126
m_n160:
    s_branch m_l3x128
m_l3c129:
    s_mov_b32 s67, 34
    s_cmp_lt_u32 s64, 34
    s_cbranch_scc1 m_l3n130
    s_cmp_lg_u32 s64, 34
    s_cbranch_scc1 m_n162
    s_mov_b32 s68, 1000
    s_mov_b32 s67, 35
    s_branch m_l3126
m_n162:
    s_cmp_lg_u32 s64, 35
    s_cbranch_scc1 m_n163
    s_mov_b32 s38, 0
    s_lshl_b32 s91, s96, 3
    s_add_u32 s91, s91, s97
    s_lshl_b32 s91, s91, 7
    s_add_u32 s91, s91, 16384
    s_add_u32 s52, s91, 117440512
    buffer_load_dwordx2 v[4:5], off, s[8:11], s52 sc1
    s_mov_b32 s67, 36
    s_branch m_l3126
m_n163:
    s_cmp_lg_u32 s64, 36
    s_cbranch_scc1 m_n164
    s_mov_b32 s26, 0
    s_mov_b32 s67, 37
    s_branch m_l3126
m_n164:
    s_cmp_lg_u32 s64, 37
    s_cbranch_scc1 m_n165
    s_waitcnt vmcnt(16)
    s_mov_b32 s3, 1048576
m_spin166:
    v_cmp_ne_u64 s[76:77], s[4:5], v[4:5]
    s_nop 3
    s_cmp_eq_u64 s[76:77], 0
    s_cbranch_scc1 m_ok167
    s_sub_u32 s3, s3, 1
    s_cbranch_scc1 m_ok167
    s_sleep 8
    buffer_load_dwordx2 v[4:5], off, s[8:11], s52 sc1
    s_waitcnt vmcnt(0)
    s_branch m_spin166
m_ok167:
    s_lshl_b32 s90, s96, 3
    s_add_u32 s90, s90, s97
    s_lshl_b32 s90, s90, 15
    s_lshl_b32 s91, s16, 13
    s_add_u32 s90, s90, s91
    s_add_u32 s70, s90, 100663296
    buffer_load_dwordx4 v[128:131], v2, s[8:11], s70 offen offset:0 sc1
    buffer_load_dwordx4 v[132:135], v2, s[8:11], s70 offen offset:1024 sc1
    buffer_load_dwordx4 v[136:139], v2, s[8:11], s70 offen offset:2048 sc1
    buffer_load_dwordx4 v[140:143], v2, s[8:11], s70 offen offset:3072 sc1
    s_add_u32 s70, s70, 4096
    buffer_load_dwordx4 v[144:147], v2, s[8:11], s70 offen offset:0 sc1
    buffer_load_dwordx4 v[148:151], v2, s[8:11], s70 offen offset:1024 sc1
    buffer_load_dwordx4 v[152:155], v2, s[8:11], s70 offen offset:2048 sc1
    buffer_load_dwordx4 v[156:159], v2, s[8:11], s70 offen offset:3072 sc1
    s_mov_b32 s67, 40
    s_branch m_l3126
m_n165:
    s_branch m_l3x128
m_o1150:
    s_and_b32 s91, s2, 7
    s_lshl_b32 s91, s91, 5
    s_lshr_b32 s92, s2, 3
    s_add_u32 s91, s91, s92
    s_lshl_b32 s91, s91, 3
    s_add_u32 s91, s91, 12288
    s_cmp_lg_u32 s16, 0
    s_cbranch_scc1 m_np169
    v_mov_b32 v60, s4
    v_mov_b32 v61, s5
    s_add_u32 s90, s91, 117440512
    s_mov_b64 exec, 1
    buffer_store_dwordx2 v[60:61], off, s[8:11], s90 sc1
    s_mov_b64 exec, -1
m_np169:
    s_branch m_o2151
m_l3n130:
    s_sub_u32 s90, s68, 5
    s_min_u32 s67, s67, s90
    s_branch m_l3126
m_l3x128:
    s_cmp_eq_u32 s95, 1
    s_cbranch_scc1 m_noadd170
    s_waitcnt vmcnt(0)
    v_lshlrev_b32 v160, 16, v128
    v_and_b32 v161, 0xffff0000, v128
    v_lshlrev_b32 v162, 16, v129
    v_and_b32 v163, 0xffff0000, v129
    v_lshlrev_b32 v164, 16, v130
    v_and_b32 v165, 0xffff0000, v130
    v_lshlrev_b32 v166, 16, v131
    v_and_b32 v167, 0xffff0000, v131
    v_lshlrev_b32 v168, 16, v132
    v_and_b32 v169, 0xffff0000, v132
    v_lshlrev_b32 v170, 16, v133
    v_and_b32 v171, 0xffff0000, v133
    v_lshlrev_b32 v172, 16, v134
    v_and_b32 v173, 0xffff0000, v134
    v_lshlrev_b32 v174, 16, v135
    v_and_b32 v175, 0xffff0000, v135
    v_lshlrev_b32 v176, 16, v136
    v_and_b32 v177, 0xffff0000, v136
    v_lshlrev_b32 v178, 16, v137
    v_and_b32 v179, 0xffff0000, v137
    v_lshlrev_b32 v180, 16, v138
    v_and_b32 v181, 0xffff0000, v138
    v_lshlrev_b32 v182, 16, v139
    v_and_b32 v183, 0xffff0000, v139
    v_lshlrev_b32 v184, 16, v140
    v_and_b32 v185, 0xffff0000, v140
    v_lshlrev_b32 v186, 16, v141
    v_and_b32 v187, 0xffff0000, v141
    v_lshlrev_b32 v188, 16, v142
    v_and_b32 v189, 0xffff0000, v142
    v_lshlrev_b32 v190, 16, v143
    v_and_b32 v191, 0xffff0000, v143
    v_lshlrev_b32 v192, 16, v144
    v_and_b32 v193, 0xffff0000, v144
    v_lshlrev_b32 v194, 16, v145
    v_and_b32 v195, 0xffff0000, v145
    v_lshlrev_b32 v196, 16, v146
    v_and_b32 v197, 0xffff0000, v146
    v_lshlrev_b32 v198, 16, v147
    v_and_b32 v199, 0xffff0000, v147
    v_lshlrev_b32 v200, 16, v148
    v_and_b32 v201, 0xffff0000, v148
    v_lshlrev_b32 v202, 16, v149
    v_and_b32 v203, 0xffff0000, v149
    v_lshlrev_b32 v204, 16, v150
    v_and_b32 v205, 0xffff0000, v150
    v_lshlrev_b32 v206, 16, v151
    v_and_b32 v207, 0xffff0000, v151
    v_lshlrev_b32 v208, 16, v152
    v_and_b32 v209, 0xffff0000, v152
    v_lshlrev_b32 v210, 16, v153
    v_and_b32 v211, 0xffff0000, v153
    v_lshlrev_b32 v212, 16, v154
    v_and_b32 v213, 0xffff0000, v154
    v_lshlrev_b32 v214, 16, v155
    v_and_b32 v215, 0xffff0000, v155
    v_lshlrev_b32 v216, 16, v156
    v_and_b32 v217, 0xffff0000, v156
    v_lshlrev_b32 v218, 16, v157
    v_and_b32 v219, 0xffff0000, v157
    v_lshlrev_b32 v220, 16, v158
    v_and_b32 v221, 0xffff0000, v158
    v_lshlrev_b32 v222, 16, v159
    v_and_b32 v223, 0xffff0000, v159
    v_pk_add_f32 v[64:65], v[64:65], v[160:161]
    v_pk_add_f32 v[66:67], v[66:67], v[162:163]
    v_pk_add_f32 v[68:69], v[68:69], v[164:165]
    v_pk_add_f32 v[70:71], v[70:71], v[166:167]
    v_pk_add_f32 v[72:73], v[72:73], v[168:169]
    v_pk_add_f32 v[74:75], v[74:75], v[170:171]
    v_pk_add_f32 v[76:77], v[76:77], v[172:173]
    v_pk_add_f32 v[78:79], v[78:79], v[174:175]
    v_pk_add_f32 v[80:81], v[80:81], v[176:177]
    v_pk_add_f32 v[82:83], v[82:83], v[178:179]
    v_pk_add_f32 v[84:85], v[84:85], v[180:181]
    v_pk_add_f32 v[86:87], v[86:87], v[182:183]
    v_pk_add_f32 v[88:89], v[88:89], v[184:185]
    v_pk_add_f32 v[90:91], v[90:91], v[186:187]
    v_pk_add_f32 v[92:93], v[92:93], v[188:189]
    v_pk_add_f32 v[94:95], v[94:95], v[190:191]
    v_pk_add_f32 v[96:97], v[96:97], v[192:193]
    v_pk_add_f32 v[98:99], v[98:99], v[194:195]
    v_pk_add_f32 v[100:101], v[100:101], v[196:197]
    v_pk_add_f32 v[102:103], v[102:103], v[198:199]
    v_pk_add_f32 v[104:105], v[104:105], v[200:201]
    v_pk_add_f32 v[106:107], v[106:107], v[202:203]
    v_pk_add_f32 v[108:109], v[108:109], v[204:205]
    v_pk_add_f32 v[110:111], v[110:111], v[206:207]
    v_pk_add_f32 v[112:113], v[112:113], v[208:209]
    v_pk_add_f32 v[114:115], v[114:115], v[210:211]
    v_pk_add_f32 v[116:117], v[116:117], v[212:213]
    v_pk_add_f32 v[118:119], v[118:119], v[214:215]
    v_pk_add_f32 v[120:121], v[120:121], v[216:217]
    v_pk_add_f32 v[122:123], v[122:123], v[218:219]
    v_pk_add_f32 v[124:125], v[124:125], v[220:221]
    v_pk_add_f32 v[126:127], v[126:127], v[222:223]
m_noadd170:
    v_cvt_pk_bf16_f32 v64, v64, v65
    v_cvt_pk_bf16_f32 v65, v66, v67
    v_cvt_pk_bf16_f32 v66, v68, v69
    v_cvt_pk_bf16_f32 v67, v70, v71
    v_cvt_pk_bf16_f32 v96, v96, v97
    v_cvt_pk_bf16_f32 v97, v98, v99
    v_cvt_pk_bf16_f32 v98, v100, v101
    v_cvt_pk_bf16_f32 v99, v102, v103
    s_nop 1
    v_permlane16_swap_b32 v64, v66
    v_permlane16_swap_b32 v65, v67
    v_permlane16_swap_b32 v96, v98
    v_permlane16_swap_b32 v97, v99
    buffer_store_dwordx4 v[64:67], v7, s[28:31], s71 offen offset:0 sc1
    buffer_store_dwordx4 v[96:99], v7, s[28:31], s71 offen offset:64 sc1
    s_add_u32 s71, s71, s72
    v_cvt_pk_bf16_f32 v72, v72, v73
    v_cvt_pk_bf16_f32 v73, v74, v75
    v_cvt_pk_bf16_f32 v74, v76, v77
    v_cvt_pk_bf16_f32 v75, v78, v79
    v_cvt_pk_bf16_f32 v104, v104, v105
    v_cvt_pk_bf16_f32 v105, v106, v107
    v_cvt_pk_bf16_f32 v106, v108, v109
    v_cvt_pk_bf16_f32 v107, v110, v111
    s_nop 1
    v_permlane16_swap_b32 v72, v74
    v_permlane16_swap_b32 v73, v75
    v_permlane16_swap_b32 v104, v106
    v_permlane16_swap_b32 v105, v107
    buffer_store_dwordx4 v[72:75], v7, s[28:31], s71 offen offset:0 sc1
    buffer_store_dwordx4 v[104:107], v7, s[28:31], s71 offen offset:64 sc1
    s_add_u32 s71, s71, s72
    v_cvt_pk_bf16_f32 v80, v80, v81
    v_cvt_pk_bf16_f32 v81, v82, v83
    v_cvt_pk_bf16_f32 v82, v84, v85
    v_cvt_pk_bf16_f32 v83, v86, v87
    v_cvt_pk_bf16_f32 v112, v112, v113
    v_cvt_pk_bf16_f32 v113, v114, v115
    v_cvt_pk_bf16_f32 v114, v116, v117
    v_cvt_pk_bf16_f32 v115, v118, v119
    s_nop 1
    v_permlane16_swap_b32 v80, v82
    v_permlane16_swap_b32 v81, v83
    v_permlane16_swap_b32 v112, v114
    v_permlane16_swap_b32 v113, v115
    buffer_store_dwordx4 v[80:83], v7, s[28:31], s71 offen offset:0 sc1
    buffer_store_dwordx4 v[112:115], v7, s[28:31], s71 offen offset:64 sc1
    s_add_u32 s71, s71, s72
    v_cvt_pk_bf16_f32 v88, v88, v89
    v_cvt_pk_bf16_f32 v89, v90, v91
    v_cvt_pk_bf16_f32 v90, v92, v93
    v_cvt_pk_bf16_f32 v91, v94, v95
    v_cvt_pk_bf16_f32 v120, v120, v121
    v_cvt_pk_bf16_f32 v121, v122, v123
    v_cvt_pk_bf16_f32 v122, v124, v125
    v_cvt_pk_bf16_f32 v123, v126, v127
    s_nop 1
    v_permlane16_swap_b32 v88, v90
    v_permlane16_swap_b32 v89, v91
    v_permlane16_swap_b32 v120, v122
    v_permlane16_swap_b32 v121, v123
    buffer_store_dwordx4 v[88:91], v7, s[28:31], s71 offen offset:0 sc1
    buffer_store_dwordx4 v[120:123], v7, s[28:31], s71 offen offset:64 sc1
    s_add_u32 s71, s71, s72
m_end1:
    s_endpgm
m_stub72:
    v_cmp_lt_f32 vcc, s65, v8
    s_cmp_lg_u32 s64, s67
    s_cbranch_scc1 m_e172
    v_add_f32 v176, v176, v16
    v_mov_b32 v180, v9
    v_add_f32 v188, v188, v16
    v_add_f32 v177, v177, v17
    v_mov_b32 v181, v9
    v_add_f32 v189, v189, v17
    v_add_f32 v178, v178, v18
    v_mov_b32 v182, v9
    v_add_f32 v190, v190, v18
    v_add_f32 v179, v179, v19
    v_mov_b32 v183, v9
    v_add_f32 v191, v191, v19
    s_nop 0
m_e172:
    s_cmp_lg_u32 s64, s68
    s_cbranch_scc1 m_e173
    v_mov_b32 v176, v9
    v_mov_b32 v184, v9
    v_mov_b32 v188, v9
    v_mov_b32 v177, v9
    v_mov_b32 v185, v9
    v_mov_b32 v189, v9
    v_mov_b32 v178, v9
    v_mov_b32 v186, v9
    v_mov_b32 v190, v9
    v_mov_b32 v179, v9
    v_mov_b32 v187, v9
    v_mov_b32 v191, v9
    s_nop 0
m_e173:
    s_cbranch_vccnz m_rc174
m_sp171:
    s_branch m_ret73
m_stub75:
    v_cmp_lt_f32 vcc, s65, v8
    s_cmp_lg_u32 s64, s67
    s_cbranch_scc1 m_e176
    v_add_f32 v176, v176, v16
    v_mov_b32 v180, v9
    v_add_f32 v188, v188, v16
    v_add_f32 v177, v177, v17
    v_mov_b32 v181, v9
    v_add_f32 v189, v189, v17
    v_add_f32 v178, v178, v18
    v_mov_b32 v182, v9
    v_add_f32 v190, v190, v18
    v_add_f32 v179, v179, v19
    v_mov_b32 v183, v9
    v_add_f32 v191, v191, v19
    s_nop 0
m_e176:
    s_cmp_lg_u32 s64, s68
    s_cbranch_scc1 m_e177
    v_mov_b32 v176, v9
    v_mov_b32 v184, v9
    v_mov_b32 v188, v9
    v_mov_b32 v177, v9
    v_mov_b32 v185, v9
    v_mov_b32 v189, v9
    v_mov_b32 v178, v9
    v_mov_b32 v186, v9
    v_mov_b32 v190, v9
    v_mov_b32 v179, v9
    v_mov_b32 v187, v9
    v_mov_b32 v191, v9
    s_nop 0
m_e177:
    s_cbranch_vccnz m_rc178
m_sp175:
    s_branch m_ret76
m_stub93:
    v_cmp_lt_f32 vcc, s65, v8
    s_cmp_lg_u32 s64, s70
    s_cbranch_scc1 m_e180
    v_add_f32 v160, v160, v16
    v_mov_b32 v164, v9
    v_add_f32 v172, v172, v16
    v_add_f32 v161, v161, v17
    v_mov_b32 v165, v9
    v_add_f32 v173, v173, v17
    v_add_f32 v162, v162, v18
    v_mov_b32 v166, v9
    v_add_f32 v174, v174, v18
    v_add_f32 v163, v163, v19
    v_mov_b32 v167, v9
    v_add_f32 v175, v175, v19
    s_nop 0
m_e180:
    s_cmp_lg_u32 s64, s71
    s_cbranch_scc1 m_e181
    v_mov_b32 v160, v9
    v_mov_b32 v168, v9
    v_mov_b32 v172, v9
    v_mov_b32 v161, v9
    v_mov_b32 v169, v9
    v_mov_b32 v173, v9
    v_mov_b32 v162, v9
    v_mov_b32 v170, v9
    v_mov_b32 v174, v9
    v_mov_b32 v163, v9
    v_mov_b32 v171, v9
    v_mov_b32 v175, v9
    s_nop 0
m_e181:
    s_cbranch_vccnz m_rc182
m_sp179:
    s_branch m_ret94
m_stub95:
    v_cmp_lt_f32 vcc, s65, v8
    s_cmp_lg_u32 s64, s70
    s_cbranch_scc1 m_e184
    v_add_f32 v160, v160, v16
    v_mov_b32 v164, v9
    v_add_f32 v172, v172, v16
    v_add_f32 v161, v161, v17
    v_mov_b32 v165, v9
    v_add_f32 v173, v173, v17
    v_add_f32 v162, v162, v18
    v_mov_b32 v166, v9
    v_add_f32 v174, v174, v18
    v_add_f32 v163, v163, v19
    v_mov_b32 v167, v9
    v_add_f32 v175, v175, v19
    s_nop 0
m_e184:
    s_cmp_lg_u32 s64, s71
    s_cbranch_scc1 m_e185
    v_mov_b32 v160, v9
    v_mov_b32 v168, v9
    v_mov_b32 v172, v9
    v_mov_b32 v161, v9
    v_mov_b32 v169, v9
    v_mov_b32 v173, v9
    v_mov_b32 v162, v9
    v_mov_b32 v170, v9
    v_mov_b32 v174, v9
    v_mov_b32 v163, v9
    v_mov_b32 v171, v9
    v_mov_b32 v175, v9
    s_nop 0
m_e185:
    s_cmp_lg_u32 s64, s53
    s_cbranch_scc1 m_e188
    s_cmp_lg_u32 s16, 0
    s_cbranch_scc1 m_np189
    v_mov_b32 v60, s4
    v_mov_b32 v61, s5
    s_add_u32 s90, s17, 117440512
    s_mov_b64 exec, 1
    buffer_store_dwordx2 v[60:61], off, s[8:11], s90 sc1
    s_mov_b64 exec, -1
m_np189:
    s_mov_b32 s17, -1
m_e188:
    s_cmp_gt_u32 s64, 26
    s_cbranch_scc1 m_e186
    s_cmp_lg_u32 s64, 6
    s_cbranch_scc1 m_e190
    s_lshr_b32 s90, s32, 1
    s_lshl_b32 s90, s90, 7
    s_add_u32 s90, s90, 117440600
    v_min_u32 v0, 1, v1
    v_lshlrev_b32 v0, 5, v0
    buffer_load_dwordx2 v[4:5], v0, s[8:11], s90 offen sc1
    s_cmp_eq_u32 s17, -1
    s_cbranch_scc1 m_e186
    s_cmp_lg_u32 s16, 0
    s_cbranch_scc1 m_np191
    v_mov_b32 v60, s4
    v_mov_b32 v61, s5
    s_add_u32 s90, s17, 117440512
    s_mov_b64 exec, 1
    buffer_store_dwordx2 v[60:61], off, s[8:11], s90 sc1
    s_mov_b64 exec, -1
m_np191:
    s_branch m_e186
m_e190:
    s_cmp_lg_u32 s64, 18
    s_cbranch_scc1 m_e192
    s_waitcnt vmcnt(18)
    s_mov_b32 s3, 1048576
m_spin193:
    v_cmp_ne_u64 s[76:77], s[4:5], v[4:5]
    s_nop 3
    s_cmp_eq_u64 s[76:77], 0
    s_cbranch_scc1 m_e186
    s_sub_u32 s3, s3, 1
    s_cbranch_scc1 m_e186
    s_sleep 32
    s_lshr_b32 s90, s32, 1
    s_lshl_b32 s90, s90, 7
    s_add_u32 s90, s90, 117440600
    v_min_u32 v0, 1, v1
    v_lshlrev_b32 v0, 5, v0
    buffer_load_dwordx2 v[4:5], v0, s[8:11], s90 offen sc1
    s_waitcnt vmcnt(0)
    s_branch m_spin193
    s_branch m_e186
m_e192:
    s_cmp_lg_u32 s64, 22
    s_cbranch_scc1 m_e194
    buffer_load_dwordx2 v[4:5], v10, s[8:11], 0 offen sc1
    s_mov_b32 s44, s48
    s_mov_b32 s45, s49
    s_mov_b32 s46, 8388608
    s_lshl_b32 s90, s2, 2
    s_add_u32 s90, s90, s16
    s_lshl_b32 s90, s90, 13
    v_lshlrev_b32 v62, 7, v1
    buffer_load_dword v255, v62, s[44:47], s90 offen
    s_branch m_e186
m_e194:
    s_cmp_lg_u32 s64, 26
    s_cbranch_scc1 m_e195
    s_mov_b32 s44, s50
    s_mov_b32 s45, s51
    s_mov_b32 s46, 2097152
    s_lshl_b32 s90, s2, 2
    s_add_u32 s90, s90, s16
    s_lshl_b32 s90, s90, 13
    v_lshlrev_b32 v62, 7, v1
    buffer_load_dword v255, v62, s[44:47], s90 offen
    s_waitcnt vmcnt(18)
    s_mov_b32 s3, 1048576
m_spin196:
    v_cmp_ne_u64 s[76:77], s[4:5], v[4:5]
    s_nop 3
    s_cmp_eq_u64 s[76:77], 0
    s_cbranch_scc1 m_e186
    s_sub_u32 s3, s3, 1
    s_cbranch_scc1 m_e186
    s_sleep 32
    buffer_load_dwordx2 v[4:5], v10, s[8:11], 0 offen sc1
    s_waitcnt vmcnt(0)
    s_branch m_spin196
    s_branch m_e186
m_e195:
m_e186:
    s_cbranch_vccnz m_rc197
m_sp183:
    s_branch m_ret96
m_stub98:
    v_cmp_lt_f32 vcc, s65, v8
    s_cmp_lg_u32 s64, s70
    s_cbranch_scc1 m_e199
    v_add_f32 v160, v160, v16
    v_mov_b32 v164, v9
    v_add_f32 v172, v172, v16
    v_add_f32 v161, v161, v17
    v_mov_b32 v165, v9
    v_add_f32 v173, v173, v17
    v_add_f32 v162, v162, v18
    v_mov_b32 v166, v9
    v_add_f32 v174, v174, v18
    v_add_f32 v163, v163, v19
    v_mov_b32 v167, v9
    v_add_f32 v175, v175, v19
    s_nop 0
m_e199:
    s_cmp_lg_u32 s64, s71
    s_cbranch_scc1 m_e200
    v_mov_b32 v160, v9
    v_mov_b32 v168, v9
    v_mov_b32 v172, v9
    v_mov_b32 v161, v9
    v_mov_b32 v169, v9
    v_mov_b32 v173, v9
    v_mov_b32 v162, v9
    v_mov_b32 v170, v9
    v_mov_b32 v174, v9
    v_mov_b32 v163, v9
    v_mov_b32 v171, v9
    v_mov_b32 v175, v9
    s_nop 0
m_e200:
    s_cbranch_vccnz m_rc201
m_sp198:
    s_branch m_ret99
m_stub115:
    v_cmp_lt_f32 vcc, s65, v8
    s_cbranch_vccnz m_rc203
m_sp202:
    s_branch m_ret116
m_rc92:
    s_call_b64 s[74:75], m_rs0466
    s_branch m_sp77
m_rc114:
    s_call_b64 s[74:75], m_rs0265
    s_branch m_sp100
m_rc174:
    s_call_b64 s[74:75], m_rs0466
    s_branch m_sp171
m_rc178:
    s_call_b64 s[74:75], m_rs1468
    s_branch m_sp175
m_rc182:
    s_call_b64 s[74:75], m_rs1468
    s_branch m_sp179
m_rc197:
    s_call_b64 s[74:75], m_rs0265
    s_branch m_sp183
m_rc201:
    s_call_b64 s[74:75], m_rs1267
    s_branch m_sp198
m_rc203:
    s_call_b64 s[74:75], m_rs1267
    s_branch m_sp202
m_rs0265:
    s_nop 15
    v_max3_f32 v48, v64, v65, v66
    v_max3_f32 v48, v48, v67, v68
    v_max3_f32 v48, v48, v69, v70
    v_max3_f32 v48, v48, v71, 0
    v_mov_b32 v49, v48
    s_nop 1
    v_permlane32_swap_b32 v48, v49
    s_nop 1
    v_max_f32 v48, v48, v49
    v_mov_b32 v49, v48
    s_nop 1
    v_permlane16_swap_b32 v48, v49
    s_nop 1
    v_max_f32 v48, v48, v49
    v_exp_f32 v49, -v48
    v_sub_f32 v64, v64, v48
    v_sub_f32 v65, v65, v48
    v_sub_f32 v66, v66, v48
    v_sub_f32 v67, v67, v48
    v_sub_f32 v68, v68, v48
    v_sub_f32 v69, v69, v48
    v_sub_f32 v70, v70, v48
    v_sub_f32 v71, v71, v48
    v_sub_f32 v96, v96, v48
    v_sub_f32 v97, v97, v48
    v_sub_f32 v98, v98, v48
    v_sub_f32 v99, v99, v48
    v_sub_f32 v100, v100, v48
    v_sub_f32 v101, v101, v48
    v_sub_f32 v102, v102, v48
    v_sub_f32 v103, v103, v48
    v_sub_f32 v160, v160, v48
    v_sub_f32 v161, v161, v48
    v_sub_f32 v162, v162, v48
    v_sub_f32 v163, v163, v48
    v_sub_f32 v164, v164, v48
    v_sub_f32 v165, v165, v48
    v_sub_f32 v166, v166, v48
    v_sub_f32 v167, v167, v48
    v_mul_f32 v12, v12, v49
    v_accvgpr_read_b32 v52, a0
    v_accvgpr_read_b32 v53, a1
    v_accvgpr_read_b32 v54, a2
    v_accvgpr_read_b32 v55, a3
    v_accvgpr_read_b32 v56, a4
    v_accvgpr_read_b32 v57, a5
    v_accvgpr_read_b32 v58, a6
    v_accvgpr_read_b32 v59, a7
    v_mul_f32 v52, v52, v49
    v_mul_f32 v53, v53, v49
    v_mul_f32 v54, v54, v49
    v_mul_f32 v55, v55, v49
    v_mul_f32 v56, v56, v49
    v_mul_f32 v57, v57, v49
    v_mul_f32 v58, v58, v49
    v_mul_f32 v59, v59, v49
    v_accvgpr_write_b32 a0, v52
    v_accvgpr_write_b32 a1, v53
    v_accvgpr_write_b32 a2, v54
    v_accvgpr_write_b32 a3, v55
    v_accvgpr_write_b32 a4, v56
    v_accvgpr_write_b32 a5, v57
    v_accvgpr_write_b32 a6, v58
    v_accvgpr_write_b32 a7, v59
    v_accvgpr_read_b32 v52, a8
    v_accvgpr_read_b32 v53, a9
    v_accvgpr_read_b32 v54, a10
    v_accvgpr_read_b32 v55, a11
    v_accvgpr_read_b32 v56, a12
    v_accvgpr_read_b32 v57, a13
    v_accvgpr_read_b32 v58, a14
    v_accvgpr_read_b32 v59, a15
    v_mul_f32 v52, v52, v49
    v_mul_f32 v53, v53, v49
    v_mul_f32 v54, v54, v49
    v_mul_f32 v55, v55, v49
    v_mul_f32 v56, v56, v49
    v_mul_f32 v57, v57, v49
    v_mul_f32 v58, v58, v49
    v_mul_f32 v59, v59, v49
    v_accvgpr_write_b32 a8, v52
    v_accvgpr_write_b32 a9, v53
    v_accvgpr_write_b32 a10, v54
    v_accvgpr_write_b32 a11, v55
    v_accvgpr_write_b32 a12, v56
    v_accvgpr_write_b32 a13, v57
    v_accvgpr_write_b32 a14, v58
    v_accvgpr_write_b32 a15, v59
    v_accvgpr_read_b32 v52, a16
    v_accvgpr_read_b32 v53, a17
    v_accvgpr_read_b32 v54, a18
    v_accvgpr_read_b32 v55, a19
    v_accvgpr_read_b32 v56, a20
    v_accvgpr_read_b32 v57, a21
    v_accvgpr_read_b32 v58, a22
    v_accvgpr_read_b32 v59, a23
    v_mul_f32 v52, v52, v49
    v_mul_f32 v53, v53, v49
    v_mul_f32 v54, v54, v49
    v_mul_f32 v55, v55, v49
    v_mul_f32 v56, v56, v49
    v_mul_f32 v57, v57, v49
    v_mul_f32 v58, v58, v49
    v_mul_f32 v59, v59, v49
    v_accvgpr_write_b32 a16, v52
    v_accvgpr_write_b32 a17, v53
    v_accvgpr_write_b32 a18, v54
    v_accvgpr_write_b32 a19, v55
    v_accvgpr_write_b32 a20, v56
    v_accvgpr_write_b32 a21, v57
    v_accvgpr_write_b32 a22, v58
    v_accvgpr_write_b32 a23, v59
    v_accvgpr_read_b32 v52, a24
    v_accvgpr_read_b32 v53, a25
    v_accvgpr_read_b32 v54, a26
    v_accvgpr_read_b32 v55, a27
    v_accvgpr_read_b32 v56, a28
    v_accvgpr_read_b32 v57, a29
    v_accvgpr_read_b32 v58, a30
    v_accvgpr_read_b32 v59, a31
    v_mul_f32 v52, v52, v49
    v_mul_f32 v53, v53, v49
    v_mul_f32 v54, v54, v49
    v_mul_f32 v55, v55, v49
    v_mul_f32 v56, v56, v49
    v_mul_f32 v57, v57, v49
    v_mul_f32 v58, v58, v49
    v_mul_f32 v59, v59, v49
    v_accvgpr_write_b32 a24, v52
    v_accvgpr_write_b32 a25, v53
    v_accvgpr_write_b32 a26, v54
    v_accvgpr_write_b32 a27, v55
    v_accvgpr_write_b32 a28, v56
    v_accvgpr_write_b32 a29, v57
    v_accvgpr_write_b32 a30, v58
    v_accvgpr_write_b32 a31, v59
    v_exp_f32 v52, v64
    v_exp_f32 v53, v65
    v_exp_f32 v54, v66
    v_exp_f32 v55, v67
    v_exp_f32 v56, v68
    v_exp_f32 v57, v69
    v_exp_f32 v58, v70
    v_exp_f32 v59, v71
    s_nop 0
    v_cvt_pk_bf16_f32 v128, v52, v53
    v_cvt_pk_bf16_f32 v129, v54, v55
    v_cvt_pk_bf16_f32 v130, v56, v57
    v_cvt_pk_bf16_f32 v131, v58, v59
    s_nop 1
    v_mfma_f32_16x16x32_bf16 v[28:31], v[44:47], v[128:131], 0
    v_max3_f32 v48, v72, v73, v74
    v_max3_f32 v48, v48, v75, v76
    v_max3_f32 v48, v48, v77, v78
    v_max3_f32 v48, v48, v79, 0
    v_mov_b32 v49, v48
    s_nop 1
    v_permlane32_swap_b32 v48, v49
    s_nop 1
    v_max_f32 v48, v48, v49
    v_mov_b32 v49, v48
    s_nop 1
    v_permlane16_swap_b32 v48, v49
    s_nop 1
    v_max_f32 v48, v48, v49
    v_exp_f32 v49, -v48
    v_sub_f32 v72, v72, v48
    v_sub_f32 v73, v73, v48
    v_sub_f32 v74, v74, v48
    v_sub_f32 v75, v75, v48
    v_sub_f32 v76, v76, v48
    v_sub_f32 v77, v77, v48
    v_sub_f32 v78, v78, v48
    v_sub_f32 v79, v79, v48
    v_sub_f32 v104, v104, v48
    v_sub_f32 v105, v105, v48
    v_sub_f32 v106, v106, v48
    v_sub_f32 v107, v107, v48
    v_sub_f32 v108, v108, v48
    v_sub_f32 v109, v109, v48
    v_sub_f32 v110, v110, v48
    v_sub_f32 v111, v111, v48
    v_sub_f32 v168, v168, v48
    v_sub_f32 v169, v169, v48
    v_sub_f32 v170, v170, v48
    v_sub_f32 v171, v171, v48
    v_sub_f32 v172, v172, v48
    v_sub_f32 v173, v173, v48
    v_sub_f32 v174, v174, v48
    v_sub_f32 v175, v175, v48
    v_mul_f32 v13, v13, v49
    v_accvgpr_read_b32 v52, a32
    v_accvgpr_read_b32 v53, a33
    v_accvgpr_read_b32 v54, a34
    v_accvgpr_read_b32 v55, a35
    v_accvgpr_read_b32 v56, a36
    v_accvgpr_read_b32 v57, a37
    v_accvgpr_read_b32 v58, a38
    v_accvgpr_read_b32 v59, a39
    v_mul_f32 v52, v52, v49
    v_mul_f32 v53, v53, v49
    v_mul_f32 v54, v54, v49
    v_mul_f32 v55, v55, v49
    v_mul_f32 v56, v56, v49
    v_mul_f32 v57, v57, v49
    v_mul_f32 v58, v58, v49
    v_mul_f32 v59, v59, v49
    v_accvgpr_write_b32 a32, v52
    v_accvgpr_write_b32 a33, v53
    v_accvgpr_write_b32 a34, v54
    v_accvgpr_write_b32 a35, v55
    v_accvgpr_write_b32 a36, v56
    v_accvgpr_write_b32 a37, v57
    v_accvgpr_write_b32 a38, v58
    v_accvgpr_write_b32 a39, v59
    v_accvgpr_read_b32 v52, a40
    v_accvgpr_read_b32 v53, a41
    v_accvgpr_read_b32 v54, a42
    v_accvgpr_read_b32 v55, a43
    v_accvgpr_read_b32 v56, a44
    v_accvgpr_read_b32 v57, a45
    v_accvgpr_read_b32 v58, a46
    v_accvgpr_read_b32 v59, a47
    v_mul_f32 v52, v52, v49
    v_mul_f32 v53, v53, v49
    v_mul_f32 v54, v54, v49
    v_mul_f32 v55, v55, v49
    v_mul_f32 v56, v56, v49
    v_mul_f32 v57, v57, v49
    v_mul_f32 v58, v58, v49
    v_mul_f32 v59, v59, v49
    v_accvgpr_write_b32 a40, v52
    v_accvgpr_write_b32 a41, v53
    v_accvgpr_write_b32 a42, v54
    v_accvgpr_write_b32 a43, v55
    v_accvgpr_write_b32 a44, v56
    v_accvgpr_write_b32 a45, v57
    v_accvgpr_write_b32 a46, v58
    v_accvgpr_write_b32 a47, v59
    v_accvgpr_read_b32 v52, a48
    v_accvgpr_read_b32 v53, a49
    v_accvgpr_read_b32 v54, a50
    v_accvgpr_read_b32 v55, a51
    v_accvgpr_read_b32 v56, a52
    v_accvgpr_read_b32 v57, a53
    v_accvgpr_read_b32 v58, a54
    v_accvgpr_read_b32 v59, a55
    v_mul_f32 v52, v52, v49
    v_mul_f32 v53, v53, v49
    v_mul_f32 v54, v54, v49
    v_mul_f32 v55, v55, v49
    v_mul_f32 v56, v56, v49
    v_mul_f32 v57, v57, v49
    v_mul_f32 v58, v58, v49
    v_mul_f32 v59, v59, v49
    v_accvgpr_write_b32 a48, v52
    v_accvgpr_write_b32 a49, v53
    v_accvgpr_write_b32 a50, v54
    v_accvgpr_write_b32 a51, v55
    v_accvgpr_write_b32 a52, v56
    v_accvgpr_write_b32 a53, v57
    v_accvgpr_write_b32 a54, v58
    v_accvgpr_write_b32 a55, v59
    v_accvgpr_read_b32 v52, a56
    v_accvgpr_read_b32 v53, a57
    v_accvgpr_read_b32 v54, a58
    v_accvgpr_read_b32 v55, a59
    v_accvgpr_read_b32 v56, a60
    v_accvgpr_read_b32 v57, a61
    v_accvgpr_read_b32 v58, a62
    v_accvgpr_read_b32 v59, a63
    v_mul_f32 v52, v52, v49
    v_mul_f32 v53, v53, v49
    v_mul_f32 v54, v54, v49
    v_mul_f32 v55, v55, v49
    v_mul_f32 v56, v56, v49
    v_mul_f32 v57, v57, v49
    v_mul_f32 v58, v58, v49
    v_mul_f32 v59, v59, v49
    v_accvgpr_write_b32 a56, v52
    v_accvgpr_write_b32 a57, v53
    v_accvgpr_write_b32 a58, v54
    v_accvgpr_write_b32 a59, v55
    v_accvgpr_write_b32 a60, v56
    v_accvgpr_write_b32 a61, v57
    v_accvgpr_write_b32 a62, v58
    v_accvgpr_write_b32 a63, v59
    v_exp_f32 v52, v72
    v_exp_f32 v53, v73
    v_exp_f32 v54, v74
    v_exp_f32 v55, v75
    v_exp_f32 v56, v76
    v_exp_f32 v57, v77
    v_exp_f32 v58, v78
    v_exp_f32 v59, v79
    s_nop 0
    v_cvt_pk_bf16_f32 v132, v52, v53
    v_cvt_pk_bf16_f32 v133, v54, v55
    v_cvt_pk_bf16_f32 v134, v56, v57
    v_cvt_pk_bf16_f32 v135, v58, v59
    s_nop 1
    v_mfma_f32_16x16x32_bf16 v[32:35], v[44:47], v[132:135], 0
    s_nop 7
    s_setpc_b64 s[74:75]
m_rs0466:
    s_nop 15
    v_max3_f32 v48, v64, v65, v66
    v_max3_f32 v48, v48, v67, v68
    v_max3_f32 v48, v48, v69, v70
    v_max3_f32 v48, v48, v71, 0
    v_mov_b32 v49, v48
    s_nop 1
    v_permlane32_swap_b32 v48, v49
    s_nop 1
    v_max_f32 v48, v48, v49
    v_mov_b32 v49, v48
    s_nop 1
    v_permlane16_swap_b32 v48, v49
    s_nop 1
    v_max_f32 v48, v48, v49
    v_exp_f32 v49, -v48
    v_sub_f32 v64, v64, v48
    v_sub_f32 v65, v65, v48
    v_sub_f32 v66, v66, v48
    v_sub_f32 v67, v67, v48
    v_sub_f32 v68, v68, v48
    v_sub_f32 v69, v69, v48
    v_sub_f32 v70, v70, v48
    v_sub_f32 v71, v71, v48
    v_sub_f32 v96, v96, v48
    v_sub_f32 v97, v97, v48
    v_sub_f32 v98, v98, v48
    v_sub_f32 v99, v99, v48
    v_sub_f32 v100, v100, v48
    v_sub_f32 v101, v101, v48
    v_sub_f32 v102, v102, v48
    v_sub_f32 v103, v103, v48
    v_sub_f32 v160, v160, v48
    v_sub_f32 v161, v161, v48
    v_sub_f32 v162, v162, v48
    v_sub_f32 v163, v163, v48
    v_sub_f32 v164, v164, v48
    v_sub_f32 v165, v165, v48
    v_sub_f32 v166, v166, v48
    v_sub_f32 v167, v167, v48
    v_mul_f32 v12, v12, v49
    v_accvgpr_read_b32 v52, a0
    v_accvgpr_read_b32 v53, a1
    v_accvgpr_read_b32 v54, a2
    v_accvgpr_read_b32 v55, a3
    v_accvgpr_read_b32 v56, a4
    v_accvgpr_read_b32 v57, a5
    v_accvgpr_read_b32 v58, a6
    v_accvgpr_read_b32 v59, a7
    v_mul_f32 v52, v52, v49
    v_mul_f32 v53, v53, v49
    v_mul_f32 v54, v54, v49
    v_mul_f32 v55, v55, v49
    v_mul_f32 v56, v56, v49
    v_mul_f32 v57, v57, v49
    v_mul_f32 v58, v58, v49
    v_mul_f32 v59, v59, v49
    v_accvgpr_write_b32 a0, v52
    v_accvgpr_write_b32 a1, v53
    v_accvgpr_write_b32 a2, v54
    v_accvgpr_write_b32 a3, v55
    v_accvgpr_write_b32 a4, v56
    v_accvgpr_write_b32 a5, v57
    v_accvgpr_write_b32 a6, v58
    v_accvgpr_write_b32 a7, v59
    v_accvgpr_read_b32 v52, a8
    v_accvgpr_read_b32 v53, a9
    v_accvgpr_read_b32 v54, a10
    v_accvgpr_read_b32 v55, a11
    v_accvgpr_read_b32 v56, a12
    v_accvgpr_read_b32 v57, a13
    v_accvgpr_read_b32 v58, a14
    v_accvgpr_read_b32 v59, a15
    v_mul_f32 v52, v52, v49
    v_mul_f32 v53, v53, v49
    v_mul_f32 v54, v54, v49
    v_mul_f32 v55, v55, v49
    v_mul_f32 v56, v56, v49
    v_mul_f32 v57, v57, v49
    v_mul_f32 v58, v58, v49
    v_mul_f32 v59, v59, v49
    v_accvgpr_write_b32 a8, v52
    v_accvgpr_write_b32 a9, v53
    v_accvgpr_write_b32 a10, v54
    v_accvgpr_write_b32 a11, v55
    v_accvgpr_write_b32 a12, v56
    v_accvgpr_write_b32 a13, v57
    v_accvgpr_write_b32 a14, v58
    v_accvgpr_write_b32 a15, v59
    v_accvgpr_read_b32 v52, a16
    v_accvgpr_read_b32 v53, a17
    v_accvgpr_read_b32 v54, a18
    v_accvgpr_read_b32 v55, a19
    v_accvgpr_read_b32 v56, a20
    v_accvgpr_read_b32 v57, a21
    v_accvgpr_read_b32 v58, a22
    v_accvgpr_read_b32 v59, a23
    v_mul_f32 v52, v52, v49
    v_mul_f32 v53, v53, v49
    v_mul_f32 v54, v54, v49
    v_mul_f32 v55, v55, v49
    v_mul_f32 v56, v56, v49
    v_mul_f32 v57, v57, v49
    v_mul_f32 v58, v58, v49
    v_mul_f32 v59, v59, v49
    v_accvgpr_write_b32 a16, v52
    v_accvgpr_write_b32 a17, v53
    v_accvgpr_write_b32 a18, v54
    v_accvgpr_write_b32 a19, v55
    v_accvgpr_write_b32 a20, v56
    v_accvgpr_write_b32 a21, v57
    v_accvgpr_write_b32 a22, v58
    v_accvgpr_write_b32 a23, v59
    v_accvgpr_read_b32 v52, a24
    v_accvgpr_read_b32 v53, a25
    v_accvgpr_read_b32 v54, a26
    v_accvgpr_read_b32 v55, a27
    v_accvgpr_read_b32 v56, a28
    v_accvgpr_read_b32 v57, a29
    v_accvgpr_read_b32 v58, a30
    v_accvgpr_read_b32 v59, a31
    v_mul_f32 v52, v52, v49
    v_mul_f32 v53, v53, v49
    v_mul_f32 v54, v54, v49
    v_mul_f32 v55, v55, v49
    v_mul_f32 v56, v56, v49
    v_mul_f32 v57, v57, v49
    v_mul_f32 v58, v58, v49
    v_mul_f32 v59, v59, v49
    v_accvgpr_write_b32 a24, v52
    v_accvgpr_write_b32 a25, v53
    v_accvgpr_write_b32 a26, v54
    v_accvgpr_write_b32 a27, v55
    v_accvgpr_write_b32 a28, v56
    v_accvgpr_write_b32 a29, v57
    v_accvgpr_write_b32 a30, v58
    v_accvgpr_write_b32 a31, v59
    v_exp_f32 v52, v64
    v_exp_f32 v53, v65
    v_exp_f32 v54, v66
    v_exp_f32 v55, v67
    v_exp_f32 v56, v68
    v_exp_f32 v57, v69
    v_exp_f32 v58, v70
    v_exp_f32 v59, v71
    s_nop 0
    v_cvt_pk_bf16_f32 v128, v52, v53
    v_cvt_pk_bf16_f32 v129, v54, v55
    v_cvt_pk_bf16_f32 v130, v56, v57
    v_cvt_pk_bf16_f32 v131, v58, v59
    s_nop 1
    v_mfma_f32_16x16x32_bf16 v[28:31], v[44:47], v[128:131], 0
    v_max3_f32 v48, v72, v73, v74
    v_max3_f32 v48, v48, v75, v76
    v_max3_f32 v48, v48, v77, v78
    v_max3_f32 v48, v48, v79, 0
    v_mov_b32 v49, v48
    s_nop 1
    v_permlane32_swap_b32 v48, v49
    s_nop 1
    v_max_f32 v48, v48, v49
    v_mov_b32 v49, v48
    s_nop 1
    v_permlane16_swap_b32 v48, v49
    s_nop 1
    v_max_f32 v48, v48, v49
    v_exp_f32 v49, -v48
    v_sub_f32 v72, v72, v48
    v_sub_f32 v73, v73, v48
    v_sub_f32 v74, v74, v48
    v_sub_f32 v75, v75, v48
    v_sub_f32 v76, v76, v48
    v_sub_f32 v77, v77, v48
    v_sub_f32 v78, v78, v48
    v_sub_f32 v79, v79, v48
    v_sub_f32 v104, v104, v48
    v_sub_f32 v105, v105, v48
    v_sub_f32 v106, v106, v48
    v_sub_f32 v107, v107, v48
    v_sub_f32 v108, v108, v48
    v_sub_f32 v109, v109, v48
    v_sub_f32 v110, v110, v48
    v_sub_f32 v111, v111, v48
    v_sub_f32 v168, v168, v48
    v_sub_f32 v169, v169, v48
    v_sub_f32 v170, v170, v48
    v_sub_f32 v171, v171, v48
    v_sub_f32 v172, v172, v48
    v_sub_f32 v173, v173, v48
    v_sub_f32 v174, v174, v48
    v_sub_f32 v175, v175, v48
    v_mul_f32 v13, v13, v49
    v_accvgpr_read_b32 v52, a32
    v_accvgpr_read_b32 v53, a33
    v_accvgpr_read_b32 v54, a34
    v_accvgpr_read_b32 v55, a35
    v_accvgpr_read_b32 v56, a36
    v_accvgpr_read_b32 v57, a37
    v_accvgpr_read_b32 v58, a38
    v_accvgpr_read_b32 v59, a39
    v_mul_f32 v52, v52, v49
    v_mul_f32 v53, v53, v49
    v_mul_f32 v54, v54, v49
    v_mul_f32 v55, v55, v49
    v_mul_f32 v56, v56, v49
    v_mul_f32 v57, v57, v49
    v_mul_f32 v58, v58, v49
    v_mul_f32 v59, v59, v49
    v_accvgpr_write_b32 a32, v52
    v_accvgpr_write_b32 a33, v53
    v_accvgpr_write_b32 a34, v54
    v_accvgpr_write_b32 a35, v55
    v_accvgpr_write_b32 a36, v56
    v_accvgpr_write_b32 a37, v57
    v_accvgpr_write_b32 a38, v58
    v_accvgpr_write_b32 a39, v59
    v_accvgpr_read_b32 v52, a40
    v_accvgpr_read_b32 v53, a41
    v_accvgpr_read_b32 v54, a42
    v_accvgpr_read_b32 v55, a43
    v_accvgpr_read_b32 v56, a44
    v_accvgpr_read_b32 v57, a45
    v_accvgpr_read_b32 v58, a46
    v_accvgpr_read_b32 v59, a47
    v_mul_f32 v52, v52, v49
    v_mul_f32 v53, v53, v49
    v_mul_f32 v54, v54, v49
    v_mul_f32 v55, v55, v49
    v_mul_f32 v56, v56, v49
    v_mul_f32 v57, v57, v49
    v_mul_f32 v58, v58, v49
    v_mul_f32 v59, v59, v49
    v_accvgpr_write_b32 a40, v52
    v_accvgpr_write_b32 a41, v53
    v_accvgpr_write_b32 a42, v54
    v_accvgpr_write_b32 a43, v55
    v_accvgpr_write_b32 a44, v56
    v_accvgpr_write_b32 a45, v57
    v_accvgpr_write_b32 a46, v58
    v_accvgpr_write_b32 a47, v59
    v_accvgpr_read_b32 v52, a48
    v_accvgpr_read_b32 v53, a49
    v_accvgpr_read_b32 v54, a50
    v_accvgpr_read_b32 v55, a51
    v_accvgpr_read_b32 v56, a52
    v_accvgpr_read_b32 v57, a53
    v_accvgpr_read_b32 v58, a54
    v_accvgpr_read_b32 v59, a55
    v_mul_f32 v52, v52, v49
    v_mul_f32 v53, v53, v49
    v_mul_f32 v54, v54, v49
    v_mul_f32 v55, v55, v49
    v_mul_f32 v56, v56, v49
    v_mul_f32 v57, v57, v49
    v_mul_f32 v58, v58, v49
    v_mul_f32 v59, v59, v49
    v_accvgpr_write_b32 a48, v52
    v_accvgpr_write_b32 a49, v53
    v_accvgpr_write_b32 a50, v54
    v_accvgpr_write_b32 a51, v55
    v_accvgpr_write_b32 a52, v56
    v_accvgpr_write_b32 a53, v57
    v_accvgpr_write_b32 a54, v58
    v_accvgpr_write_b32 a55, v59
    v_accvgpr_read_b32 v52, a56
    v_accvgpr_read_b32 v53, a57
    v_accvgpr_read_b32 v54, a58
    v_accvgpr_read_b32 v55, a59
    v_accvgpr_read_b32 v56, a60
    v_accvgpr_read_b32 v57, a61
    v_accvgpr_read_b32 v58, a62
    v_accvgpr_read_b32 v59, a63
    v_mul_f32 v52, v52, v49
    v_mul_f32 v53, v53, v49
    v_mul_f32 v54, v54, v49
    v_mul_f32 v55, v55, v49
    v_mul_f32 v56, v56, v49
    v_mul_f32 v57, v57, v49
    v_mul_f32 v58, v58, v49
    v_mul_f32 v59, v59, v49
    v_accvgpr_write_b32 a56, v52
    v_accvgpr_write_b32 a57, v53
    v_accvgpr_write_b32 a58, v54
    v_accvgpr_write_b32 a59, v55
    v_accvgpr_write_b32 a60, v56
    v_accvgpr_write_b32 a61, v57
    v_accvgpr_write_b32 a62, v58
    v_accvgpr_write_b32 a63, v59
    v_exp_f32 v52, v72
    v_exp_f32 v53, v73
    v_exp_f32 v54, v74
    v_exp_f32 v55, v75
    v_exp_f32 v56, v76
    v_exp_f32 v57, v77
    v_exp_f32 v58, v78
    v_exp_f32 v59, v79
    s_nop 0
    v_cvt_pk_bf16_f32 v132, v52, v53
    v_cvt_pk_bf16_f32 v133, v54, v55
    v_cvt_pk_bf16_f32 v134, v56, v57
    v_cvt_pk_bf16_f32 v135, v58, v59
    s_nop 1
    v_mfma_f32_16x16x32_bf16 v[32:35], v[44:47], v[132:135], 0
    v_max3_f32 v48, v80, v81, v82
    v_max3_f32 v48, v48, v83, v84
    v_max3_f32 v48, v48, v85, v86
    v_max3_f32 v48, v48, v87, 0
    v_mov_b32 v49, v48
    s_nop 1
    v_permlane32_swap_b32 v48, v49
    s_nop 1
    v_max_f32 v48, v48, v49
    v_mov_b32 v49, v48
    s_nop 1
    v_permlane16_swap_b32 v48, v49
    s_nop 1
    v_max_f32 v48, v48, v49
    v_exp_f32 v49, -v48
    v_sub_f32 v80, v80, v48
    v_sub_f32 v81, v81, v48
    v_sub_f32 v82, v82, v48
    v_sub_f32 v83, v83, v48
    v_sub_f32 v84, v84, v48
    v_sub_f32 v85, v85, v48
    v_sub_f32 v86, v86, v48
    v_sub_f32 v87, v87, v48
    v_sub_f32 v112, v112, v48
    v_sub_f32 v113, v113, v48
    v_sub_f32 v114, v114, v48
    v_sub_f32 v115, v115, v48
    v_sub_f32 v116, v116, v48
    v_sub_f32 v117, v117, v48
    v_sub_f32 v118, v118, v48
    v_sub_f32 v119, v119, v48
    v_sub_f32 v176, v176, v48
    v_sub_f32 v177, v177, v48
    v_sub_f32 v178, v178, v48
    v_sub_f32 v179, v179, v48
    v_sub_f32 v180, v180, v48
    v_sub_f32 v181, v181, v48
    v_sub_f32 v182, v182, v48
    v_sub_f32 v183, v183, v48
    v_mul_f32 v14, v14, v49
    v_accvgpr_read_b32 v52, a64
    v_accvgpr_read_b32 v53, a65
    v_accvgpr_read_b32 v54, a66
    v_accvgpr_read_b32 v55, a67
    v_accvgpr_read_b32 v56, a68
    v_accvgpr_read_b32 v57, a69
    v_accvgpr_read_b32 v58, a70
    v_accvgpr_read_b32 v59, a71
    v_mul_f32 v52, v52, v49
    v_mul_f32 v53, v53, v49
    v_mul_f32 v54, v54, v49
    v_mul_f32 v55, v55, v49
    v_mul_f32 v56, v56, v49
    v_mul_f32 v57, v57, v49
    v_mul_f32 v58, v58, v49
    v_mul_f32 v59, v59, v49
    v_accvgpr_write_b32 a64, v52
    v_accvgpr_write_b32 a65, v53
    v_accvgpr_write_b32 a66, v54
    v_accvgpr_write_b32 a67, v55
    v_accvgpr_write_b32 a68, v56
    v_accvgpr_write_b32 a69, v57
    v_accvgpr_write_b32 a70, v58
    v_accvgpr_write_b32 a71, v59
    v_accvgpr_read_b32 v52, a72
    v_accvgpr_read_b32 v53, a73
    v_accvgpr_read_b32 v54, a74
    v_accvgpr_read_b32 v55, a75
    v_accvgpr_read_b32 v56, a76
    v_accvgpr_read_b32 v57, a77
    v_accvgpr_read_b32 v58, a78
    v_accvgpr_read_b32 v59, a79
    v_mul_f32 v52, v52, v49
    v_mul_f32 v53, v53, v49
    v_mul_f32 v54, v54, v49
    v_mul_f32 v55, v55, v49
    v_mul_f32 v56, v56, v49
    v_mul_f32 v57, v57, v49
    v_mul_f32 v58, v58, v49
    v_mul_f32 v59, v59, v49
    v_accvgpr_write_b32 a72, v52
    v_accvgpr_write_b32 a73, v53
    v_accvgpr_write_b32 a74, v54
    v_accvgpr_write_b32 a75, v55
    v_accvgpr_write_b32 a76, v56
    v_accvgpr_write_b32 a77, v57
    v_accvgpr_write_b32 a78, v58
    v_accvgpr_write_b32 a79, v59
    v_accvgpr_read_b32 v52, a80
    v_accvgpr_read_b32 v53, a81
    v_accvgpr_read_b32 v54, a82
    v_accvgpr_read_b32 v55, a83
    v_accvgpr_read_b32 v56, a84
    v_accvgpr_read_b32 v57, a85
    v_accvgpr_read_b32 v58, a86
    v_accvgpr_read_b32 v59, a87
    v_mul_f32 v52, v52, v49
    v_mul_f32 v53, v53, v49
    v_mul_f32 v54, v54, v49
    v_mul_f32 v55, v55, v49
    v_mul_f32 v56, v56, v49
    v_mul_f32 v57, v57, v49
    v_mul_f32 v58, v58, v49
    v_mul_f32 v59, v59, v49
    v_accvgpr_write_b32 a80, v52
    v_accvgpr_write_b32 a81, v53
    v_accvgpr_write_b32 a82, v54
    v_accvgpr_write_b32 a83, v55
    v_accvgpr_write_b32 a84, v56
    v_accvgpr_write_b32 a85, v57
    v_accvgpr_write_b32 a86, v58
    v_accvgpr_write_b32 a87, v59
    v_accvgpr_read_b32 v52, a88
    v_accvgpr_read_b32 v53, a89
    v_accvgpr_read_b32 v54, a90
    v_accvgpr_read_b32 v55, a91
    v_accvgpr_read_b32 v56, a92
    v_accvgpr_read_b32 v57, a93
    v_accvgpr_read_b32 v58, a94
    v_accvgpr_read_b32 v59, a95
    v_mul_f32 v52, v52, v49
    v_mul_f32 v53, v53, v49
    v_mul_f32 v54, v54, v49
    v_mul_f32 v55, v55, v49
    v_mul_f32 v56, v56, v49
    v_mul_f32 v57, v57, v49
    v_mul_f32 v58, v58, v49
    v_mul_f32 v59, v59, v49
    v_accvgpr_write_b32 a88, v52
    v_accvgpr_write_b32 a89, v53
    v_accvgpr_write_b32 a90, v54
    v_accvgpr_write_b32 a91, v55
    v_accvgpr_write_b32 a92, v56
    v_accvgpr_write_b32 a93, v57
    v_accvgpr_write_b32 a94, v58
    v_accvgpr_write_b32 a95, v59
    v_exp_f32 v52, v80
    v_exp_f32 v53, v81
    v_exp_f32 v54, v82
    v_exp_f32 v55, v83
    v_exp_f32 v56, v84
    v_exp_f32 v57, v85
    v_exp_f32 v58, v86
    v_exp_f32 v59, v87
    s_nop 0
    v_cvt_pk_bf16_f32 v136, v52, v53
    v_cvt_pk_bf16_f32 v137, v54, v55
    v_cvt_pk_bf16_f32 v138, v56, v57
    v_cvt_pk_bf16_f32 v139, v58, v59
    s_nop 1
    v_mfma_f32_16x16x32_bf16 v[36:39], v[44:47], v[136:139], 0
    v_max3_f32 v48, v88, v89, v90
    v_max3_f32 v48, v48, v91, v92
    v_max3_f32 v48, v48, v93, v94
    v_max3_f32 v48, v48, v95, 0
    v_mov_b32 v49, v48
    s_nop 1
    v_permlane32_swap_b32 v48, v49
    s_nop 1
    v_max_f32 v48, v48, v49
    v_mov_b32 v49, v48
    s_nop 1
    v_permlane16_swap_b32 v48, v49
    s_nop 1
    v_max_f32 v48, v48, v49
    v_exp_f32 v49, -v48
    v_sub_f32 v88, v88, v48
    v_sub_f32 v89, v89, v48
    v_sub_f32 v90, v90, v48
    v_sub_f32 v91, v91, v48
    v_sub_f32 v92, v92, v48
    v_sub_f32 v93, v93, v48
    v_sub_f32 v94, v94, v48
    v_sub_f32 v95, v95, v48
    v_sub_f32 v120, v120, v48
    v_sub_f32 v121, v121, v48
    v_sub_f32 v122, v122, v48
    v_sub_f32 v123, v123, v48
    v_sub_f32 v124, v124, v48
    v_sub_f32 v125, v125, v48
    v_sub_f32 v126, v126, v48
    v_sub_f32 v127, v127, v48
    v_sub_f32 v184, v184, v48
    v_sub_f32 v185, v185, v48
    v_sub_f32 v186, v186, v48
    v_sub_f32 v187, v187, v48
    v_sub_f32 v188, v188, v48
    v_sub_f32 v189, v189, v48
    v_sub_f32 v190, v190, v48
    v_sub_f32 v191, v191, v48
    v_mul_f32 v15, v15, v49
    v_accvgpr_read_b32 v52, a96
    v_accvgpr_read_b32 v53, a97
    v_accvgpr_read_b32 v54, a98
    v_accvgpr_read_b32 v55, a99
    v_accvgpr_read_b32 v56, a100
    v_accvgpr_read_b32 v57, a101
    v_accvgpr_read_b32 v58, a102
    v_accvgpr_read_b32 v59, a103
    v_mul_f32 v52, v52, v49
    v_mul_f32 v53, v53, v49
    v_mul_f32 v54, v54, v49
    v_mul_f32 v55, v55, v49
    v_mul_f32 v56, v56, v49
    v_mul_f32 v57, v57, v49
    v_mul_f32 v58, v58, v49
    v_mul_f32 v59, v59, v49
    v_accvgpr_write_b32 a96, v52
    v_accvgpr_write_b32 a97, v53
    v_accvgpr_write_b32 a98, v54
    v_accvgpr_write_b32 a99, v55
    v_accvgpr_write_b32 a100, v56
    v_accvgpr_write_b32 a101, v57
    v_accvgpr_write_b32 a102, v58
    v_accvgpr_write_b32 a103, v59
    v_accvgpr_read_b32 v52, a104
    v_accvgpr_read_b32 v53, a105
    v_accvgpr_read_b32 v54, a106
    v_accvgpr_read_b32 v55, a107
    v_accvgpr_read_b32 v56, a108
    v_accvgpr_read_b32 v57, a109
    v_accvgpr_read_b32 v58, a110
    v_accvgpr_read_b32 v59, a111
    v_mul_f32 v52, v52, v49
    v_mul_f32 v53, v53, v49
    v_mul_f32 v54, v54, v49
    v_mul_f32 v55, v55, v49
    v_mul_f32 v56, v56, v49
    v_mul_f32 v57, v57, v49
    v_mul_f32 v58, v58, v49
    v_mul_f32 v59, v59, v49
    v_accvgpr_write_b32 a104, v52
    v_accvgpr_write_b32 a105, v53
    v_accvgpr_write_b32 a106, v54
    v_accvgpr_write_b32 a107, v55
    v_accvgpr_write_b32 a108, v56
    v_accvgpr_write_b32 a109, v57
    v_accvgpr_write_b32 a110, v58
    v_accvgpr_write_b32 a111, v59
    v_accvgpr_read_b32 v52, a112
    v_accvgpr_read_b32 v53, a113
    v_accvgpr_read_b32 v54, a114
    v_accvgpr_read_b32 v55, a115
    v_accvgpr_read_b32 v56, a116
    v_accvgpr_read_b32 v57, a117
    v_accvgpr_read_b32 v58, a118
    v_accvgpr_read_b32 v59, a119
    v_mul_f32 v52, v52, v49
    v_mul_f32 v53, v53, v49
    v_mul_f32 v54, v54, v49
    v_mul_f32 v55, v55, v49
    v_mul_f32 v56, v56, v49
    v_mul_f32 v57, v57, v49
    v_mul_f32 v58, v58, v49
    v_mul_f32 v59, v59, v49
    v_accvgpr_write_b32 a112, v52
    v_accvgpr_write_b32 a113, v53
    v_accvgpr_write_b32 a114, v54
    v_accvgpr_write_b32 a115, v55
    v_accvgpr_write_b32 a116, v56
    v_accvgpr_write_b32 a117, v57
    v_accvgpr_write_b32 a118, v58
    v_accvgpr_write_b32 a119, v59
    v_accvgpr_read_b32 v52, a120
    v_accvgpr_read_b32 v53, a121
    v_accvgpr_read_b32 v54, a122
    v_accvgpr_read_b32 v55, a123
    v_accvgpr_read_b32 v56, a124
    v_accvgpr_read_b32 v57, a125
    v_accvgpr_read_b32 v58, a126
    v_accvgpr_read_b32 v59, a127
    v_mul_f32 v52, v52, v49
    v_mul_f32 v53, v53, v49
    v_mul_f32 v54, v54, v49
    v_mul_f32 v55, v55, v49
    v_mul_f32 v56, v56, v49
    v_mul_f32 v57, v57, v49
    v_mul_f32 v58, v58, v49
    v_mul_f32 v59, v59, v49
    v_accvgpr_write_b32 a120, v52
    v_accvgpr_write_b32 a121, v53
    v_accvgpr_write_b32 a122, v54
    v_accvgpr_write_b32 a123, v55
    v_accvgpr_write_b32 a124, v56
    v_accvgpr_write_b32 a125, v57
    v_accvgpr_write_b32 a126, v58
    v_accvgpr_write_b32 a127, v59
    v_exp_f32 v52, v88
    v_exp_f32 v53, v89
    v_exp_f32 v54, v90
    v_exp_f32 v55, v91
    v_exp_f32 v56, v92
    v_exp_f32 v57, v93
    v_exp_f32 v58, v94
    v_exp_f32 v59, v95
    s_nop 0
    v_cvt_pk_bf16_f32 v140, v52, v53
    v_cvt_pk_bf16_f32 v141, v54, v55
    v_cvt_pk_bf16_f32 v142, v56, v57
    v_cvt_pk_bf16_f32 v143, v58, v59
    s_nop 1
    v_mfma_f32_16x16x32_bf16 v[40:43], v[44:47], v[140:143], 0
    s_nop 7
    s_setpc_b64 s[74:75]
m_rs1267:
    s_nop 15
    v_max3_f32 v48, v96, v97, v98
    v_max3_f32 v48, v48, v99, v100
    v_max3_f32 v48, v48, v101, v102
    v_max3_f32 v48, v48, v103, 0
    v_mov_b32 v49, v48
    s_nop 1
    v_permlane32_swap_b32 v48, v49
    s_nop 1
    v_max_f32 v48, v48, v49
    v_mov_b32 v49, v48
    s_nop 1
    v_permlane16_swap_b32 v48, v49
    s_nop 1
    v_max_f32 v48, v48, v49
    v_exp_f32 v49, -v48
    v_sub_f32 v96, v96, v48
    v_sub_f32 v97, v97, v48
    v_sub_f32 v98, v98, v48
    v_sub_f32 v99, v99, v48
    v_sub_f32 v100, v100, v48
    v_sub_f32 v101, v101, v48
    v_sub_f32 v102, v102, v48
    v_sub_f32 v103, v103, v48
    v_sub_f32 v64, v64, v48
    v_sub_f32 v65, v65, v48
    v_sub_f32 v66, v66, v48
    v_sub_f32 v67, v67, v48
    v_sub_f32 v68, v68, v48
    v_sub_f32 v69, v69, v48
    v_sub_f32 v70, v70, v48
    v_sub_f32 v71, v71, v48
    v_sub_f32 v160, v160, v48
    v_sub_f32 v161, v161, v48
    v_sub_f32 v162, v162, v48
    v_sub_f32 v163, v163, v48
    v_sub_f32 v164, v164, v48
    v_sub_f32 v165, v165, v48
    v_sub_f32 v166, v166, v48
    v_sub_f32 v167, v167, v48
    v_mul_f32 v12, v12, v49
    v_accvgpr_read_b32 v52, a0
    v_accvgpr_read_b32 v53, a1
    v_accvgpr_read_b32 v54, a2
    v_accvgpr_read_b32 v55, a3
    v_accvgpr_read_b32 v56, a4
    v_accvgpr_read_b32 v57, a5
    v_accvgpr_read_b32 v58, a6
    v_accvgpr_read_b32 v59, a7
    v_mul_f32 v52, v52, v49
    v_mul_f32 v53, v53, v49
    v_mul_f32 v54, v54, v49
    v_mul_f32 v55, v55, v49
    v_mul_f32 v56, v56, v49
    v_mul_f32 v57, v57, v49
    v_mul_f32 v58, v58, v49
    v_mul_f32 v59, v59, v49
    v_accvgpr_write_b32 a0, v52
    v_accvgpr_write_b32 a1, v53
    v_accvgpr_write_b32 a2, v54
    v_accvgpr_write_b32 a3, v55
    v_accvgpr_write_b32 a4, v56
    v_accvgpr_write_b32 a5, v57
    v_accvgpr_write_b32 a6, v58
    v_accvgpr_write_b32 a7, v59
    v_accvgpr_read_b32 v52, a8
    v_accvgpr_read_b32 v53, a9
    v_accvgpr_read_b32 v54, a10
    v_accvgpr_read_b32 v55, a11
    v_accvgpr_read_b32 v56, a12
    v_accvgpr_read_b32 v57, a13
    v_accvgpr_read_b32 v58, a14
    v_accvgpr_read_b32 v59, a15
    v_mul_f32 v52, v52, v49
    v_mul_f32 v53, v53, v49
    v_mul_f32 v54, v54, v49
    v_mul_f32 v55, v55, v49
    v_mul_f32 v56, v56, v49
    v_mul_f32 v57, v57, v49
    v_mul_f32 v58, v58, v49
    v_mul_f32 v59, v59, v49
    v_accvgpr_write_b32 a8, v52
    v_accvgpr_write_b32 a9, v53
    v_accvgpr_write_b32 a10, v54
    v_accvgpr_write_b32 a11, v55
    v_accvgpr_write_b32 a12, v56
    v_accvgpr_write_b32 a13, v57
    v_accvgpr_write_b32 a14, v58
    v_accvgpr_write_b32 a15, v59
    v_accvgpr_read_b32 v52, a16
    v_accvgpr_read_b32 v53, a17
    v_accvgpr_read_b32 v54, a18
    v_accvgpr_read_b32 v55, a19
    v_accvgpr_read_b32 v56, a20
    v_accvgpr_read_b32 v57, a21
    v_accvgpr_read_b32 v58, a22
    v_accvgpr_read_b32 v59, a23
    v_mul_f32 v52, v52, v49
    v_mul_f32 v53, v53, v49
    v_mul_f32 v54, v54, v49
    v_mul_f32 v55, v55, v49
    v_mul_f32 v56, v56, v49
    v_mul_f32 v57, v57, v49
    v_mul_f32 v58, v58, v49
    v_mul_f32 v59, v59, v49
    v_accvgpr_write_b32 a16, v52
    v_accvgpr_write_b32 a17, v53
    v_accvgpr_write_b32 a18, v54
    v_accvgpr_write_b32 a19, v55
    v_accvgpr_write_b32 a20, v56
    v_accvgpr_write_b32 a21, v57
    v_accvgpr_write_b32 a22, v58
    v_accvgpr_write_b32 a23, v59
    v_accvgpr_read_b32 v52, a24
    v_accvgpr_read_b32 v53, a25
    v_accvgpr_read_b32 v54, a26
    v_accvgpr_read_b32 v55, a27
    v_accvgpr_read_b32 v56, a28
    v_accvgpr_read_b32 v57, a29
    v_accvgpr_read_b32 v58, a30
    v_accvgpr_read_b32 v59, a31
    v_mul_f32 v52, v52, v49
    v_mul_f32 v53, v53, v49
    v_mul_f32 v54, v54, v49
    v_mul_f32 v55, v55, v49
    v_mul_f32 v56, v56, v49
    v_mul_f32 v57, v57, v49
    v_mul_f32 v58, v58, v49
    v_mul_f32 v59, v59, v49
    v_accvgpr_write_b32 a24, v52
    v_accvgpr_write_b32 a25, v53
    v_accvgpr_write_b32 a26, v54
    v_accvgpr_write_b32 a27, v55
    v_accvgpr_write_b32 a28, v56
    v_accvgpr_write_b32 a29, v57
    v_accvgpr_write_b32 a30, v58
    v_accvgpr_write_b32 a31, v59
    v_exp_f32 v52, v96
    v_exp_f32 v53, v97
    v_exp_f32 v54, v98
    v_exp_f32 v55, v99
    v_exp_f32 v56, v100
    v_exp_f32 v57, v101
    v_exp_f32 v58, v102
    v_exp_f32 v59, v103
    s_nop 0
    v_cvt_pk_bf16_f32 v144, v52, v53
    v_cvt_pk_bf16_f32 v145, v54, v55
    v_cvt_pk_bf16_f32 v146, v56, v57
    v_cvt_pk_bf16_f32 v147, v58, v59
    s_nop 1
    v_mfma_f32_16x16x32_bf16 v[28:31], v[44:47], v[144:147], 0
    v_max3_f32 v48, v104, v105, v106
    v_max3_f32 v48, v48, v107, v108
    v_max3_f32 v48, v48, v109, v110
    v_max3_f32 v48, v48, v111, 0
    v_mov_b32 v49, v48
    s_nop 1
    v_permlane32_swap_b32 v48, v49
    s_nop 1
    v_max_f32 v48, v48, v49
    v_mov_b32 v49, v48
    s_nop 1
    v_permlane16_swap_b32 v48, v49
    s_nop 1
    v_max_f32 v48, v48, v49
    v_exp_f32 v49, -v48
    v_sub_f32 v104, v104, v48
    v_sub_f32 v105, v105, v48
    v_sub_f32 v106, v106, v48
    v_sub_f32 v107, v107, v48
    v_sub_f32 v108, v108, v48
    v_sub_f32 v109, v109, v48
    v_sub_f32 v110, v110, v48
    v_sub_f32 v111, v111, v48
    v_sub_f32 v72, v72, v48
    v_sub_f32 v73, v73, v48
    v_sub_f32 v74, v74, v48
    v_sub_f32 v75, v75, v48
    v_sub_f32 v76, v76, v48
    v_sub_f32 v77, v77, v48
    v_sub_f32 v78, v78, v48
    v_sub_f32 v79, v79, v48
    v_sub_f32 v168, v168, v48
    v_sub_f32 v169, v169, v48
    v_sub_f32 v170, v170, v48
    v_sub_f32 v171, v171, v48
    v_sub_f32 v172, v172, v48
    v_sub_f32 v173, v173, v48
    v_sub_f32 v174, v174, v48
    v_sub_f32 v175, v175, v48
    v_mul_f32 v13, v13, v49
    v_accvgpr_read_b32 v52, a32
    v_accvgpr_read_b32 v53, a33
    v_accvgpr_read_b32 v54, a34
    v_accvgpr_read_b32 v55, a35
    v_accvgpr_read_b32 v56, a36
    v_accvgpr_read_b32 v57, a37
    v_accvgpr_read_b32 v58, a38
    v_accvgpr_read_b32 v59, a39
    v_mul_f32 v52, v52, v49
    v_mul_f32 v53, v53, v49
    v_mul_f32 v54, v54, v49
    v_mul_f32 v55, v55, v49
    v_mul_f32 v56, v56, v49
    v_mul_f32 v57, v57, v49
    v_mul_f32 v58, v58, v49
    v_mul_f32 v59, v59, v49
    v_accvgpr_write_b32 a32, v52
    v_accvgpr_write_b32 a33, v53
    v_accvgpr_write_b32 a34, v54
    v_accvgpr_write_b32 a35, v55
    v_accvgpr_write_b32 a36, v56
    v_accvgpr_write_b32 a37, v57
    v_accvgpr_write_b32 a38, v58
    v_accvgpr_write_b32 a39, v59
    v_accvgpr_read_b32 v52, a40
    v_accvgpr_read_b32 v53, a41
    v_accvgpr_read_b32 v54, a42
    v_accvgpr_read_b32 v55, a43
    v_accvgpr_read_b32 v56, a44
    v_accvgpr_read_b32 v57, a45
    v_accvgpr_read_b32 v58, a46
    v_accvgpr_read_b32 v59, a47
    v_mul_f32 v52, v52, v49
    v_mul_f32 v53, v53, v49
    v_mul_f32 v54, v54, v49
    v_mul_f32 v55, v55, v49
    v_mul_f32 v56, v56, v49
    v_mul_f32 v57, v57, v49
    v_mul_f32 v58, v58, v49
    v_mul_f32 v59, v59, v49
    v_accvgpr_write_b32 a40, v52
    v_accvgpr_write_b32 a41, v53
    v_accvgpr_write_b32 a42, v54
    v_accvgpr_write_b32 a43, v55
    v_accvgpr_write_b32 a44, v56
    v_accvgpr_write_b32 a45, v57
    v_accvgpr_write_b32 a46, v58
    v_accvgpr_write_b32 a47, v59
    v_accvgpr_read_b32 v52, a48
    v_accvgpr_read_b32 v53, a49
    v_accvgpr_read_b32 v54, a50
    v_accvgpr_read_b32 v55, a51
    v_accvgpr_read_b32 v56, a52
    v_accvgpr_read_b32 v57, a53
    v_accvgpr_read_b32 v58, a54
    v_accvgpr_read_b32 v59, a55
    v_mul_f32 v52, v52, v49
    v_mul_f32 v53, v53, v49
    v_mul_f32 v54, v54, v49
    v_mul_f32 v55, v55, v49
    v_mul_f32 v56, v56, v49
    v_mul_f32 v57, v57, v49
    v_mul_f32 v58, v58, v49
    v_mul_f32 v59, v59, v49
    v_accvgpr_write_b32 a48, v52
    v_accvgpr_write_b32 a49, v53
    v_accvgpr_write_b32 a50, v54
    v_accvgpr_write_b32 a51, v55
    v_accvgpr_write_b32 a52, v56
    v_accvgpr_write_b32 a53, v57
    v_accvgpr_write_b32 a54, v58
    v_accvgpr_write_b32 a55, v59
    v_accvgpr_read_b32 v52, a56
    v_accvgpr_read_b32 v53, a57
    v_accvgpr_read_b32 v54, a58
    v_accvgpr_read_b32 v55, a59
    v_accvgpr_read_b32 v56, a60
    v_accvgpr_read_b32 v57, a61
    v_accvgpr_read_b32 v58, a62
    v_accvgpr_read_b32 v59, a63
    v_mul_f32 v52, v52, v49
    v_mul_f32 v53, v53, v49
    v_mul_f32 v54, v54, v49
    v_mul_f32 v55, v55, v49
    v_mul_f32 v56, v56, v49
    v_mul_f32 v57, v57, v49
    v_mul_f32 v58, v58, v49
    v_mul_f32 v59, v59, v49
    v_accvgpr_write_b32 a56, v52
    v_accvgpr_write_b32 a57, v53
    v_accvgpr_write_b32 a58, v54
    v_accvgpr_write_b32 a59, v55
    v_accvgpr_write_b32 a60, v56
    v_accvgpr_write_b32 a61, v57
    v_accvgpr_write_b32 a62, v58
    v_accvgpr_write_b32 a63, v59
    v_exp_f32 v52, v104
    v_exp_f32 v53, v105
    v_exp_f32 v54, v106
    v_exp_f32 v55, v107
    v_exp_f32 v56, v108
    v_exp_f32 v57, v109
    v_exp_f32 v58, v110
    v_exp_f32 v59, v111
    s_nop 0
    v_cvt_pk_bf16_f32 v148, v52, v53
    v_cvt_pk_bf16_f32 v149, v54, v55
    v_cvt_pk_bf16_f32 v150, v56, v57
    v_cvt_pk_bf16_f32 v151, v58, v59
    s_nop 1
    v_mfma_f32_16x16x32_bf16 v[32:35], v[44:47], v[148:151], 0
    s_nop 7
    s_setpc_b64 s[74:75]
m_rs1468:
    s_nop 15
    v_max3_f32 v48, v96, v97, v98
    v_max3_f32 v48, v48, v99, v100
    v_max3_f32 v48, v48, v101, v102
    v_max3_f32 v48, v48, v103, 0
    v_mov_b32 v49, v48
    s_nop 1
    v_permlane32_swap_b32 v48, v49
    s_nop 1
    v_max_f32 v48, v48, v49
    v_mov_b32 v49, v48
    s_nop 1
    v_permlane16_swap_b32 v48, v49
    s_nop 1
    v_max_f32 v48, v48, v49
    v_exp_f32 v49, -v48
    v_sub_f32 v96, v96, v48
    v_sub_f32 v97, v97, v48
    v_sub_f32 v98, v98, v48
    v_sub_f32 v99, v99, v48
    v_sub_f32 v100, v100, v48
    v_sub_f32 v101, v101, v48
    v_sub_f32 v102, v102, v48
    v_sub_f32 v103, v103, v48
    v_sub_f32 v64, v64, v48
    v_sub_f32 v65, v65, v48
    v_sub_f32 v66, v66, v48
    v_sub_f32 v67, v67, v48
    v_sub_f32 v68, v68, v48
    v_sub_f32 v69, v69, v48
    v_sub_f32 v70, v70, v48
    v_sub_f32 v71, v71, v48
    v_sub_f32 v160, v160, v48
    v_sub_f32 v161, v161, v48
    v_sub_f32 v162, v162, v48
    v_sub_f32 v163, v163, v48
    v_sub_f32 v164, v164, v48
    v_sub_f32 v165, v165, v48
    v_sub_f32 v166, v166, v48
    v_sub_f32 v167, v167, v48
    v_mul_f32 v12, v12, v49
    v_accvgpr_read_b32 v52, a0
    v_accvgpr_read_b32 v53, a1
    v_accvgpr_read_b32 v54, a2
    v_accvgpr_read_b32 v55, a3
    v_accvgpr_read_b32 v56, a4
    v_accvgpr_read_b32 v57, a5
    v_accvgpr_read_b32 v58, a6
    v_accvgpr_read_b32 v59, a7
    v_mul_f32 v52, v52, v49
    v_mul_f32 v53, v53, v49
    v_mul_f32 v54, v54, v49
    v_mul_f32 v55, v55, v49
    v_mul_f32 v56, v56, v49
    v_mul_f32 v57, v57, v49
    v_mul_f32 v58, v58, v49
    v_mul_f32 v59, v59, v49
    v_accvgpr_write_b32 a0, v52
    v_accvgpr_write_b32 a1, v53
    v_accvgpr_write_b32 a2, v54
    v_accvgpr_write_b32 a3, v55
    v_accvgpr_write_b32 a4, v56
    v_accvgpr_write_b32 a5, v57
    v_accvgpr_write_b32 a6, v58
    v_accvgpr_write_b32 a7, v59
    v_accvgpr_read_b32 v52, a8
    v_accvgpr_read_b32 v53, a9
    v_accvgpr_read_b32 v54, a10
    v_accvgpr_read_b32 v55, a11
    v_accvgpr_read_b32 v56, a12
    v_accvgpr_read_b32 v57, a13
    v_accvgpr_read_b32 v58, a14
    v_accvgpr_read_b32 v59, a15
    v_mul_f32 v52, v52, v49
    v_mul_f32 v53, v53, v49
    v_mul_f32 v54, v54, v49
    v_mul_f32 v55, v55, v49
    v_mul_f32 v56, v56, v49
    v_mul_f32 v57, v57, v49
    v_mul_f32 v58, v58, v49
    v_mul_f32 v59, v59, v49
    v_accvgpr_write_b32 a8, v52
    v_accvgpr_write_b32 a9, v53
    v_accvgpr_write_b32 a10, v54
    v_accvgpr_write_b32 a11, v55
    v_accvgpr_write_b32 a12, v56
    v_accvgpr_write_b32 a13, v57
    v_accvgpr_write_b32 a14, v58
    v_accvgpr_write_b32 a15, v59
    v_accvgpr_read_b32 v52, a16
    v_accvgpr_read_b32 v53, a17
    v_accvgpr_read_b32 v54, a18
    v_accvgpr_read_b32 v55, a19
    v_accvgpr_read_b32 v56, a20
    v_accvgpr_read_b32 v57, a21
    v_accvgpr_read_b32 v58, a22
    v_accvgpr_read_b32 v59, a23
    v_mul_f32 v52, v52, v49
    v_mul_f32 v53, v53, v49
    v_mul_f32 v54, v54, v49
    v_mul_f32 v55, v55, v49
    v_mul_f32 v56, v56, v49
    v_mul_f32 v57, v57, v49
    v_mul_f32 v58, v58, v49
    v_mul_f32 v59, v59, v49
    v_accvgpr_write_b32 a16, v52
    v_accvgpr_write_b32 a17, v53
    v_accvgpr_write_b32 a18, v54
    v_accvgpr_write_b32 a19, v55
    v_accvgpr_write_b32 a20, v56
    v_accvgpr_write_b32 a21, v57
    v_accvgpr_write_b32 a22, v58
    v_accvgpr_write_b32 a23, v59
    v_accvgpr_read_b32 v52, a24
    v_accvgpr_read_b32 v53, a25
    v_accvgpr_read_b32 v54, a26
    v_accvgpr_read_b32 v55, a27
    v_accvgpr_read_b32 v56, a28
    v_accvgpr_read_b32 v57, a29
    v_accvgpr_read_b32 v58, a30
    v_accvgpr_read_b32 v59, a31
    v_mul_f32 v52, v52, v49
    v_mul_f32 v53, v53, v49
    v_mul_f32 v54, v54, v49
    v_mul_f32 v55, v55, v49
    v_mul_f32 v56, v56, v49
    v_mul_f32 v57, v57, v49
    v_mul_f32 v58, v58, v49
    v_mul_f32 v59, v59, v49
    v_accvgpr_write_b32 a24, v52
    v_accvgpr_write_b32 a25, v53
    v_accvgpr_write_b32 a26, v54
    v_accvgpr_write_b32 a27, v55
    v_accvgpr_write_b32 a28, v56
    v_accvgpr_write_b32 a29, v57
    v_accvgpr_write_b32 a30, v58
    v_accvgpr_write_b32 a31, v59
    v_exp_f32 v52, v96
    v_exp_f32 v53, v97
    v_exp_f32 v54, v98
    v_exp_f32 v55, v99
    v_exp_f32 v56, v100
    v_exp_f32 v57, v101
    v_exp_f32 v58, v102
    v_exp_f32 v59, v103
    s_nop 0
    v_cvt_pk_bf16_f32 v144, v52, v53
    v_cvt_pk_bf16_f32 v145, v54, v55
    v_cvt_pk_bf16_f32 v146, v56, v57
    v_cvt_pk_bf16_f32 v147, v58, v59
    s_nop 1
    v_mfma_f32_16x16x32_bf16 v[28:31], v[44:47], v[144:147], 0
    v_max3_f32 v48, v104, v105, v106
    v_max3_f32 v48, v48, v107, v108
    v_max3_f32 v48, v48, v109, v110
    v_max3_f32 v48, v48, v111, 0
    v_mov_b32 v49, v48
    s_nop 1
    v_permlane32_swap_b32 v48, v49
    s_nop 1
    v_max_f32 v48, v48, v49
    v_mov_b32 v49, v48
    s_nop 1
    v_permlane16_swap_b32 v48, v49
    s_nop 1
    v_max_f32 v48, v48, v49
    v_exp_f32 v49, -v48
    v_sub_f32 v104, v104, v48
    v_sub_f32 v105, v105, v48
    v_sub_f32 v106, v106, v48
    v_sub_f32 v107, v107, v48
    v_sub_f32 v108, v108, v48
    v_sub_f32 v109, v109, v48
    v_sub_f32 v110, v110, v48
    v_sub_f32 v111, v111, v48
    v_sub_f32 v72, v72, v48
    v_sub_f32 v73, v73, v48
    v_sub_f32 v74, v74, v48
    v_sub_f32 v75, v75, v48
    v_sub_f32 v76, v76, v48
    v_sub_f32 v77, v77, v48
    v_sub_f32 v78, v78, v48
    v_sub_f32 v79, v79, v48
    v_sub_f32 v168, v168, v48
    v_sub_f32 v169, v169, v48
    v_sub_f32 v170, v170, v48
    v_sub_f32 v171, v171, v48
    v_sub_f32 v172, v172, v48
    v_sub_f32 v173, v173, v48
    v_sub_f32 v174, v174, v48
    v_sub_f32 v175, v175, v48
    v_mul_f32 v13, v13, v49
    v_accvgpr_read_b32 v52, a32
    v_accvgpr_read_b32 v53, a33
    v_accvgpr_read_b32 v54, a34
    v_accvgpr_read_b32 v55, a35
    v_accvgpr_read_b32 v56, a36
    v_accvgpr_read_b32 v57, a37
    v_accvgpr_read_b32 v58, a38
    v_accvgpr_read_b32 v59, a39
    v_mul_f32 v52, v52, v49
    v_mul_f32 v53, v53, v49
    v_mul_f32 v54, v54, v49
    v_mul_f32 v55, v55, v49
    v_mul_f32 v56, v56, v49
    v_mul_f32 v57, v57, v49
    v_mul_f32 v58, v58, v49
    v_mul_f32 v59, v59, v49
    v_accvgpr_write_b32 a32, v52
    v_accvgpr_write_b32 a33, v53
    v_accvgpr_write_b32 a34, v54
    v_accvgpr_write_b32 a35, v55
    v_accvgpr_write_b32 a36, v56
    v_accvgpr_write_b32 a37, v57
    v_accvgpr_write_b32 a38, v58
    v_accvgpr_write_b32 a39, v59
    v_accvgpr_read_b32 v52, a40
    v_accvgpr_read_b32 v53, a41
    v_accvgpr_read_b32 v54, a42
    v_accvgpr_read_b32 v55, a43
    v_accvgpr_read_b32 v56, a44
    v_accvgpr_read_b32 v57, a45
    v_accvgpr_read_b32 v58, a46
    v_accvgpr_read_b32 v59, a47
    v_mul_f32 v52, v52, v49
    v_mul_f32 v53, v53, v49
    v_mul_f32 v54, v54, v49
    v_mul_f32 v55, v55, v49
    v_mul_f32 v56, v56, v49
    v_mul_f32 v57, v57, v49
    v_mul_f32 v58, v58, v49
    v_mul_f32 v59, v59, v49
    v_accvgpr_write_b32 a40, v52
    v_accvgpr_write_b32 a41, v53
    v_accvgpr_write_b32 a42, v54
    v_accvgpr_write_b32 a43, v55
    v_accvgpr_write_b32 a44, v56
    v_accvgpr_write_b32 a45, v57
    v_accvgpr_write_b32 a46, v58
    v_accvgpr_write_b32 a47, v59
    v_accvgpr_read_b32 v52, a48
    v_accvgpr_read_b32 v53, a49
    v_accvgpr_read_b32 v54, a50
    v_accvgpr_read_b32 v55, a51
    v_accvgpr_read_b32 v56, a52
    v_accvgpr_read_b32 v57, a53
    v_accvgpr_read_b32 v58, a54
    v_accvgpr_read_b32 v59, a55
    v_mul_f32 v52, v52, v49
    v_mul_f32 v53, v53, v49
    v_mul_f32 v54, v54, v49
    v_mul_f32 v55, v55, v49
    v_mul_f32 v56, v56, v49
    v_mul_f32 v57, v57, v49
    v_mul_f32 v58, v58, v49
    v_mul_f32 v59, v59, v49
    v_accvgpr_write_b32 a48, v52
    v_accvgpr_write_b32 a49, v53
    v_accvgpr_write_b32 a50, v54
    v_accvgpr_write_b32 a51, v55
    v_accvgpr_write_b32 a52, v56
    v_accvgpr_write_b32 a53, v57
    v_accvgpr_write_b32 a54, v58
    v_accvgpr_write_b32 a55, v59
    v_accvgpr_read_b32 v52, a56
    v_accvgpr_read_b32 v53, a57
    v_accvgpr_read_b32 v54, a58
    v_accvgpr_read_b32 v55, a59
    v_accvgpr_read_b32 v56, a60
    v_accvgpr_read_b32 v57, a61
    v_accvgpr_read_b32 v58, a62
    v_accvgpr_read_b32 v59, a63
    v_mul_f32 v52, v52, v49
    v_mul_f32 v53, v53, v49
    v_mul_f32 v54, v54, v49
    v_mul_f32 v55, v55, v49
    v_mul_f32 v56, v56, v49
    v_mul_f32 v57, v57, v49
    v_mul_f32 v58, v58, v49
    v_mul_f32 v59, v59, v49
    v_accvgpr_write_b32 a56, v52
    v_accvgpr_write_b32 a57, v53
    v_accvgpr_write_b32 a58, v54
    v_accvgpr_write_b32 a59, v55
    v_accvgpr_write_b32 a60, v56
    v_accvgpr_write_b32 a61, v57
    v_accvgpr_write_b32 a62, v58
    v_accvgpr_write_b32 a63, v59
    v_exp_f32 v52, v104
    v_exp_f32 v53, v105
    v_exp_f32 v54, v106
    v_exp_f32 v55, v107
    v_exp_f32 v56, v108
    v_exp_f32 v57, v109
    v_exp_f32 v58, v110
    v_exp_f32 v59, v111
    s_nop 0
    v_cvt_pk_bf16_f32 v148, v52, v53
    v_cvt_pk_bf16_f32 v149, v54, v55
    v_cvt_pk_bf16_f32 v150, v56, v57
    v_cvt_pk_bf16_f32 v151, v58, v59
    s_nop 1
    v_mfma_f32_16x16x32_bf16 v[32:35], v[44:47], v[148:151], 0
    v_max3_f32 v48, v112, v113, v114
    v_max3_f32 v48, v48, v115, v116
    v_max3_f32 v48, v48, v117, v118
    v_max3_f32 v48, v48, v119, 0
    v_mov_b32 v49, v48
    s_nop 1
    v_permlane32_swap_b32 v48, v49
    s_nop 1
    v_max_f32 v48, v48, v49
    v_mov_b32 v49, v48
    s_nop 1
    v_permlane16_swap_b32 v48, v49
    s_nop 1
    v_max_f32 v48, v48, v49
    v_exp_f32 v49, -v48
    v_sub_f32 v112, v112, v48
    v_sub_f32 v113, v113, v48
    v_sub_f32 v114, v114, v48
    v_sub_f32 v115, v115, v48
    v_sub_f32 v116, v116, v48
    v_sub_f32 v117, v117, v48
    v_sub_f32 v118, v118, v48
    v_sub_f32 v119, v119, v48
    v_sub_f32 v80, v80, v48
    v_sub_f32 v81, v81, v48
    v_sub_f32 v82, v82, v48
    v_sub_f32 v83, v83, v48
    v_sub_f32 v84, v84, v48
    v_sub_f32 v85, v85, v48
    v_sub_f32 v86, v86, v48
    v_sub_f32 v87, v87, v48
    v_sub_f32 v176, v176, v48
    v_sub_f32 v177, v177, v48
    v_sub_f32 v178, v178, v48
    v_sub_f32 v179, v179, v48
    v_sub_f32 v180, v180, v48
    v_sub_f32 v181, v181, v48
    v_sub_f32 v182, v182, v48
    v_sub_f32 v183, v183, v48
    v_mul_f32 v14, v14, v49
    v_accvgpr_read_b32 v52, a64
    v_accvgpr_read_b32 v53, a65
    v_accvgpr_read_b32 v54, a66
    v_accvgpr_read_b32 v55, a67
    v_accvgpr_read_b32 v56, a68
    v_accvgpr_read_b32 v57, a69
    v_accvgpr_read_b32 v58, a70
    v_accvgpr_read_b32 v59, a71
    v_mul_f32 v52, v52, v49
    v_mul_f32 v53, v53, v49
    v_mul_f32 v54, v54, v49
    v_mul_f32 v55, v55, v49
    v_mul_f32 v56, v56, v49
    v_mul_f32 v57, v57, v49
    v_mul_f32 v58, v58, v49
    v_mul_f32 v59, v59, v49
    v_accvgpr_write_b32 a64, v52
    v_accvgpr_write_b32 a65, v53
    v_accvgpr_write_b32 a66, v54
    v_accvgpr_write_b32 a67, v55
    v_accvgpr_write_b32 a68, v56
    v_accvgpr_write_b32 a69, v57
    v_accvgpr_write_b32 a70, v58
    v_accvgpr_write_b32 a71, v59
    v_accvgpr_read_b32 v52, a72
    v_accvgpr_read_b32 v53, a73
    v_accvgpr_read_b32 v54, a74
    v_accvgpr_read_b32 v55, a75
    v_accvgpr_read_b32 v56, a76
    v_accvgpr_read_b32 v57, a77
    v_accvgpr_read_b32 v58, a78
    v_accvgpr_read_b32 v59, a79
    v_mul_f32 v52, v52, v49
    v_mul_f32 v53, v53, v49
    v_mul_f32 v54, v54, v49
    v_mul_f32 v55, v55, v49
    v_mul_f32 v56, v56, v49
    v_mul_f32 v57, v57, v49
    v_mul_f32 v58, v58, v49
    v_mul_f32 v59, v59, v49
    v_accvgpr_write_b32 a72, v52
    v_accvgpr_write_b32 a73, v53
    v_accvgpr_write_b32 a74, v54
    v_accvgpr_write_b32 a75, v55
    v_accvgpr_write_b32 a76, v56
    v_accvgpr_write_b32 a77, v57
    v_accvgpr_write_b32 a78, v58
    v_accvgpr_write_b32 a79, v59
    v_accvgpr_read_b32 v52, a80
    v_accvgpr_read_b32 v53, a81
    v_accvgpr_read_b32 v54, a82
    v_accvgpr_read_b32 v55, a83
    v_accvgpr_read_b32 v56, a84
    v_accvgpr_read_b32 v57, a85
    v_accvgpr_read_b32 v58, a86
    v_accvgpr_read_b32 v59, a87
    v_mul_f32 v52, v52, v49
    v_mul_f32 v53, v53, v49
    v_mul_f32 v54, v54, v49
    v_mul_f32 v55, v55, v49
    v_mul_f32 v56, v56, v49
    v_mul_f32 v57, v57, v49
    v_mul_f32 v58, v58, v49
    v_mul_f32 v59, v59, v49
    v_accvgpr_write_b32 a80, v52
    v_accvgpr_write_b32 a81, v53
    v_accvgpr_write_b32 a82, v54
    v_accvgpr_write_b32 a83, v55
    v_accvgpr_write_b32 a84, v56
    v_accvgpr_write_b32 a85, v57
    v_accvgpr_write_b32 a86, v58
    v_accvgpr_write_b32 a87, v59
    v_accvgpr_read_b32 v52, a88
    v_accvgpr_read_b32 v53, a89
    v_accvgpr_read_b32 v54, a90
    v_accvgpr_read_b32 v55, a91
    v_accvgpr_read_b32 v56, a92
    v_accvgpr_read_b32 v57, a93
    v_accvgpr_read_b32 v58, a94
    v_accvgpr_read_b32 v59, a95
    v_mul_f32 v52, v52, v49
    v_mul_f32 v53, v53, v49
    v_mul_f32 v54, v54, v49
    v_mul_f32 v55, v55, v49
    v_mul_f32 v56, v56, v49
    v_mul_f32 v57, v57, v49
    v_mul_f32 v58, v58, v49
    v_mul_f32 v59, v59, v49
    v_accvgpr_write_b32 a88, v52
    v_accvgpr_write_b32 a89, v53
    v_accvgpr_write_b32 a90, v54
    v_accvgpr_write_b32 a91, v55
    v_accvgpr_write_b32 a92, v56
    v_accvgpr_write_b32 a93, v57
    v_accvgpr_write_b32 a94, v58
    v_accvgpr_write_b32 a95, v59
    v_exp_f32 v52, v112
    v_exp_f32 v53, v113
    v_exp_f32 v54, v114
    v_exp_f32 v55, v115
    v_exp_f32 v56, v116
    v_exp_f32 v57, v117
    v_exp_f32 v58, v118
    v_exp_f32 v59, v119
    s_nop 0
    v_cvt_pk_bf16_f32 v152, v52, v53
    v_cvt_pk_bf16_f32 v153, v54, v55
    v_cvt_pk_bf16_f32 v154, v56, v57
    v_cvt_pk_bf16_f32 v155, v58, v59
    s_nop 1
    v_mfma_f32_16x16x32_bf16 v[36:39], v[44:47], v[152:155], 0
    v_max3_f32 v48, v120, v121, v122
    v_max3_f32 v48, v48, v123, v124
    v_max3_f32 v48, v48, v125, v126
    v_max3_f32 v48, v48, v127, 0
    v_mov_b32 v49, v48
    s_nop 1
    v_permlane32_swap_b32 v48, v49
    s_nop 1
    v_max_f32 v48, v48, v49
    v_mov_b32 v49, v48
    s_nop 1
    v_permlane16_swap_b32 v48, v49
    s_nop 1
    v_max_f32 v48, v48, v49
    v_exp_f32 v49, -v48
    v_sub_f32 v120, v120, v48
    v_sub_f32 v121, v121, v48
    v_sub_f32 v122, v122, v48
    v_sub_f32 v123, v123, v48
    v_sub_f32 v124, v124, v48
    v_sub_f32 v125, v125, v48
    v_sub_f32 v126, v126, v48
    v_sub_f32 v127, v127, v48
    v_sub_f32 v88, v88, v48
    v_sub_f32 v89, v89, v48
    v_sub_f32 v90, v90, v48
    v_sub_f32 v91, v91, v48
    v_sub_f32 v92, v92, v48
    v_sub_f32 v93, v93, v48
    v_sub_f32 v94, v94, v48
    v_sub_f32 v95, v95, v48
    v_sub_f32 v184, v184, v48
    v_sub_f32 v185, v185, v48
    v_sub_f32 v186, v186, v48
    v_sub_f32 v187, v187, v48
    v_sub_f32 v188, v188, v48
    v_sub_f32 v189, v189, v48
    v_sub_f32 v190, v190, v48
    v_sub_f32 v191, v191, v48
    v_mul_f32 v15, v15, v49
    v_accvgpr_read_b32 v52, a96
    v_accvgpr_read_b32 v53, a97
    v_accvgpr_read_b32 v54, a98
    v_accvgpr_read_b32 v55, a99
    v_accvgpr_read_b32 v56, a100
    v_accvgpr_read_b32 v57, a101
    v_accvgpr_read_b32 v58, a102
    v_accvgpr_read_b32 v59, a103
    v_mul_f32 v52, v52, v49
    v_mul_f32 v53, v53, v49
    v_mul_f32 v54, v54, v49
    v_mul_f32 v55, v55, v49
    v_mul_f32 v56, v56, v49
    v_mul_f32 v57, v57, v49
    v_mul_f32 v58, v58, v49
    v_mul_f32 v59, v59, v49
    v_accvgpr_write_b32 a96, v52
    v_accvgpr_write_b32 a97, v53
    v_accvgpr_write_b32 a98, v54
    v_accvgpr_write_b32 a99, v55
    v_accvgpr_write_b32 a100, v56
    v_accvgpr_write_b32 a101, v57
    v_accvgpr_write_b32 a102, v58
    v_accvgpr_write_b32 a103, v59
    v_accvgpr_read_b32 v52, a104
    v_accvgpr_read_b32 v53, a105
    v_accvgpr_read_b32 v54, a106
    v_accvgpr_read_b32 v55, a107
    v_accvgpr_read_b32 v56, a108
    v_accvgpr_read_b32 v57, a109
    v_accvgpr_read_b32 v58, a110
    v_accvgpr_read_b32 v59, a111
    v_mul_f32 v52, v52, v49
    v_mul_f32 v53, v53, v49
    v_mul_f32 v54, v54, v49
    v_mul_f32 v55, v55, v49
    v_mul_f32 v56, v56, v49
    v_mul_f32 v57, v57, v49
    v_mul_f32 v58, v58, v49
    v_mul_f32 v59, v59, v49
    v_accvgpr_write_b32 a104, v52
    v_accvgpr_write_b32 a105, v53
    v_accvgpr_write_b32 a106, v54
    v_accvgpr_write_b32 a107, v55
    v_accvgpr_write_b32 a108, v56
    v_accvgpr_write_b32 a109, v57
    v_accvgpr_write_b32 a110, v58
    v_accvgpr_write_b32 a111, v59
    v_accvgpr_read_b32 v52, a112
    v_accvgpr_read_b32 v53, a113
    v_accvgpr_read_b32 v54, a114
    v_accvgpr_read_b32 v55, a115
    v_accvgpr_read_b32 v56, a116
    v_accvgpr_read_b32 v57, a117
    v_accvgpr_read_b32 v58, a118
    v_accvgpr_read_b32 v59, a119
    v_mul_f32 v52, v52, v49
    v_mul_f32 v53, v53, v49
    v_mul_f32 v54, v54, v49
    v_mul_f32 v55, v55, v49
    v_mul_f32 v56, v56, v49
    v_mul_f32 v57, v57, v49
    v_mul_f32 v58, v58, v49
    v_mul_f32 v59, v59, v49
    v_accvgpr_write_b32 a112, v52
    v_accvgpr_write_b32 a113, v53
    v_accvgpr_write_b32 a114, v54
    v_accvgpr_write_b32 a115, v55
    v_accvgpr_write_b32 a116, v56
    v_accvgpr_write_b32 a117, v57
    v_accvgpr_write_b32 a118, v58
    v_accvgpr_write_b32 a119, v59
    v_accvgpr_read_b32 v52, a120
    v_accvgpr_read_b32 v53, a121
    v_accvgpr_read_b32 v54, a122
    v_accvgpr_read_b32 v55, a123
    v_accvgpr_read_b32 v56, a124
    v_accvgpr_read_b32 v57, a125
    v_accvgpr_read_b32 v58, a126
    v_accvgpr_read_b32 v59, a127
    v_mul_f32 v52, v52, v49
    v_mul_f32 v53, v53, v49
    v_mul_f32 v54, v54, v49
    v_mul_f32 v55, v55, v49
    v_mul_f32 v56, v56, v49
    v_mul_f32 v57, v57, v49
    v_mul_f32 v58, v58, v49
    v_mul_f32 v59, v59, v49
    v_accvgpr_write_b32 a120, v52
    v_accvgpr_write_b32 a121, v53
    v_accvgpr_write_b32 a122, v54
    v_accvgpr_write_b32 a123, v55
    v_accvgpr_write_b32 a124, v56
    v_accvgpr_write_b32 a125, v57
    v_accvgpr_write_b32 a126, v58
    v_accvgpr_write_b32 a127, v59
    v_exp_f32 v52, v120
    v_exp_f32 v53, v121
    v_exp_f32 v54, v122
    v_exp_f32 v55, v123
    v_exp_f32 v56, v124
    v_exp_f32 v57, v125
    v_exp_f32 v58, v126
    v_exp_f32 v59, v127
    s_nop 0
    v_cvt_pk_bf16_f32 v156, v52, v53
    v_cvt_pk_bf16_f32 v157, v54, v55
    v_cvt_pk_bf16_f32 v158, v56, v57
    v_cvt_pk_bf16_f32 v159, v58, v59
    s_nop 1
    v_mfma_f32_16x16x32_bf16 v[40:43], v[44:47], v[156:159], 0
    s_nop 7
    s_setpc_b64 s[74:75]
m_hook14:
    s_cmp_lg_u32 s16, 0
    s_cbranch_scc1 m_np38
    v_mov_b32 v4, s4
    v_mov_b32 v5, s5
    s_add_u32 s90, s17, 117440512
    s_mov_b64 exec, 1
    buffer_store_dwordx2 v[4:5], off, s[8:11], s90 sc1
    s_mov_b64 exec, -1
m_np38:
    s_mov_b32 s17, -1
    s_branch m_hookr15
m_hook18:
    s_cmp_lg_u32 s16, 0
    s_cbranch_scc1 m_np39
    v_mov_b32 v4, s4
    v_mov_b32 v5, s5
    s_add_u32 s90, s17, 117440512
    s_mov_b64 exec, 1
    buffer_store_dwordx2 v[4:5], off, s[8:11], s90 sc1
    s_mov_b64 exec, -1
m_np39:
    s_mov_b32 s17, -1
    s_branch m_hookr19
m_dosw17:
    s_cmp_eq_u32 s17, -1
    s_cbranch_scc1 m_x40
    s_cmp_lg_u32 s16, 0
    s_cbranch_scc1 m_np45
    v_mov_b32 v4, s4
    v_mov_b32 v5, s5
    s_add_u32 s90, s17, 117440512
    s_mov_b64 exec, 1
    buffer_store_dwordx2 v[4:5], off, s[8:11], s90 sc1
    s_mov_b64 exec, -1
m_np45:
    s_mov_b32 s17, -1
    s_mov_b32 s67, 3
    s_cmp_gt_u32 s65, 3
    s_cbranch_scc1 m_loop16
m_x40:
    s_cmp_eq_u32 s94, 0
    s_cbranch_scc1 m_x41
    s_mov_b32 s42, s73
    s_mov_b32 s46, s76
    s_lshl_b32 s90, s77, 4
    s_lshl_b32 s90, s90, s81
    s_mov_b32 s48, s79
    s_mul_i32 s91, s90, 1
    s_add_u32 s49, s91, s79
    s_sub_u32 s49, s49, 2048
    s_mul_i32 s91, s90, 2
    s_add_u32 s50, s91, s79
    s_mul_i32 s91, s90, 3
    s_add_u32 s51, s91, s79
    s_sub_u32 s51, s51, 2048
    s_mov_b32 s52, s80
    s_lshl_b32 s90, s78, 2
    s_mul_i32 s91, s90, 1
    s_add_u32 s53, s91, s80
    s_sub_u32 s53, s53, 2048
    s_mul_i32 s91, s90, 2
    s_add_u32 s54, s91, s80
    s_mul_i32 s91, s90, 3
    s_add_u32 s55, s91, s80
    s_sub_u32 s55, s55, 2048
    s_lshl_b32 s56, s78, 6
    s_lshl_b32 s90, s58, 7
    s_add_u32 s90, s90, s57
    s_lshl_b32 s91, s16, 6
    s_cmp_eq_u32 s81, 1
    s_cselect_b32 s90, s90, s91
    v_lshrrev_b32 v24, 3, v1
    v_lshlrev_b32 v24, s81, v24
    v_add_u32 v24, s90, v24
    v_mul_lo_u32 v24, v24, s77
    v_lshrrev_b32 v25, 4, v1
    v_and_b32 v26, 7, v1
    v_xor_b32 v25, v25, v26
    v_lshl_add_u32 v16, v25, 4, v24
    v_xor_b32 v25, 4, v25
    v_lshl_add_u32 v17, v25, 4, v24
    s_lshl_b32 s90, s77, 3
    s_lshl_b32 s90, s90, s81
    s_sub_u32 s90, s90, 1024
    v_add_u32 v17, s90, v17
    v_lshrrev_b32 v24, 5, v1
    s_lshl_b32 s90, s16, 4
    v_add_u32 v25, s90, v24
    v_mul_lo_u32 v25, v25, s78
    v_lshlrev_b32 v24, 1, v24
    v_and_b32 v26, 31, v1
    v_xor_b32 v24, v24, v26
    s_lshl_b32 s90, s78, 1
    s_sub_u32 s90, s90, 1024
    v_add_u32 v27, s90, v25
    v_xor_b32 v26, 0, v24
    v_lshl_add_u32 v18, v26, 4, v25
    v_xor_b32 v26, 4, v24
    v_lshl_add_u32 v19, v26, 4, v27
    v_xor_b32 v26, 8, v24
    v_lshl_add_u32 v20, v26, 4, v25
    v_xor_b32 v26, 12, v24
    v_lshl_add_u32 v21, v26, 4, v27
    s_mov_b32 s40, s71
    s_mov_b32 s41, s72
    s_mov_b32 s44, s74
    s_mov_b32 s45, s75
    buffer_load_dwordx2 v[4:5], off, s[12:15], 0 sc1
    s_mov_b32 s67, 0
    s_branch m_loop16
m_x41:
    s_cmp_eq_u32 s70, 1
    s_cbranch_scc1 m_x44
    s_cmp_lg_u32 s65, 3
    s_cbranch_scc1 m_x42
    s_and_b32 s92, s2, 7
    s_lshl_b32 s92, s92, 2
    s_bfe_u32 s93, s2, 0x20003
    s_add_u32 s92, s92, s93
    s_lshr_b32 s93, s2, 5
    s_lshl_b32 s93, s93, 2
    s_or_b32 s93, s93, 0x40000
    s_lshr_b32 s90, s92, 1
    s_lshl_b32 s90, s90, 7
    s_add_u32 s90, s90, 117440512
    v_and_b32 v0, 3, v1
    v_min_u32 v0, 2, v0
    v_and_b32 v4, 4, v1
    v_add3_u32 v0, v0, v4, 8
    v_lshlrev_b32 v0, 3, v0
    buffer_load_dwordx2 v[4:5], v0, s[8:11], s90 offen sc1
    s_branch m_loop16
m_x42:
    s_waitcnt vmcnt(16)
    s_cmp_lg_u32 s65, 2
    s_cbranch_scc1 m_x43
    s_mov_b32 s3, 1048576
m_spin46:
    v_cmp_ne_u64 s[22:23], s[4:5], v[4:5]
    s_nop 3
    s_cmp_eq_u64 s[22:23], 0
    s_cbranch_scc1 m_ok47
    s_sub_u32 s3, s3, 1
    s_cbranch_scc1 m_ok47
    s_sleep 16
    s_and_b32 s92, s2, 7
    s_lshl_b32 s92, s92, 2
    s_bfe_u32 s93, s2, 0x20003
    s_add_u32 s92, s92, s93
    s_lshr_b32 s93, s2, 5
    s_lshl_b32 s93, s93, 2
    s_or_b32 s93, s93, 0x40000
    s_lshr_b32 s90, s92, 1
    s_lshl_b32 s90, s90, 7
    s_add_u32 s90, s90, 117440512
    v_and_b32 v0, 3, v1
    v_min_u32 v0, 2, v0
    v_and_b32 v4, 4, v1
    v_add3_u32 v0, v0, v4, 8
    v_lshlrev_b32 v0, 3, v0
    buffer_load_dwordx2 v[4:5], v0, s[8:11], s90 offen sc1
    s_waitcnt vmcnt(0)
    s_branch m_spin46
m_ok47:
    s_and_b32 s92, s2, 7
    s_lshl_b32 s92, s92, 2
    s_bfe_u32 s93, s2, 0x20003
    s_add_u32 s92, s92, s93
    s_lshr_b32 s93, s2, 5
    s_lshl_b32 s93, s93, 2
    s_or_b32 s93, s93, 0x40000
    s_lshr_b32 s90, s92, 1
    s_lshl_b32 s90, s90, 7
    s_add_u32 s90, s90, 117440512
    s_bfe_u32 s91, 873473623, s93
    s_lshr_b32 s91, s91, 1
    v_mov_b32 v0, s91
    s_bfe_u32 s91, 4225681832, s93
    s_lshr_b32 s91, s91, 1
    v_writelane_b32 v0, s91, 8
    v_lshlrev_b32 v0, 3, v0
    buffer_load_dwordx2 v[4:5], v0, s[8:11], s90 offen sc1
    s_lshl_b32 s90, s92, 19
    s_lshl_b32 s91, s58, 13
    s_add_u32 s90, s90, s91
    s_cmp_eq_u32 s57, 0
    s_mov_b32 s91, 33554432
    s_cselect_b32 s91, 16777216, s91
    s_mov_b32 s42, 0
    s_cselect_b32 s42, 268435456, s42
    s_add_u32 s48, s90, s91
    s_mov_b32 s49, s48
    s_add_u32 s50, s48, 4096
    s_mov_b32 s51, s50
    s_mov_b32 s40, s6
    s_mov_b32 s41, s7
    s_lshl_b32 s90, s92, 19
    s_lshl_b32 s91, s58, 13
    s_add_u32 s90, s90, s91
    s_cmp_eq_u32 s57, 0
    s_mov_b32 s91, 33587200
    s_cselect_b32 s91, 16826368, s91
    s_mov_b32 s46, 268435456
    s_cselect_b32 s46, 268435456, s46
    s_add_u32 s52, s90, s91
    s_mov_b32 s53, s52
    s_add_u32 s54, s52, 4096
    s_mov_b32 s55, s54
    s_mov_b32 s44, s6
    s_mov_b32 s45, s7
    v_mov_b32 v16, v2
    v_mov_b32 v17, v2
    v_mov_b32 v18, v2
    v_mov_b32 v19, v2
    v_mov_b32 v20, v2
    v_mov_b32 v21, v2
    s_branch m_loop16
m_x43:
    s_mov_b32 s3, 1048576
m_spin48:
    v_cmp_ne_u64 s[22:23], s[4:5], v[4:5]
    s_nop 3
    s_cmp_eq_u64 s[22:23], 0
    s_cbranch_scc1 m_ok49
    s_sub_u32 s3, s3, 1
    s_cbranch_scc1 m_ok49
    s_sleep 16
    s_and_b32 s92, s2, 7
    s_lshl_b32 s92, s92, 2
    s_bfe_u32 s93, s2, 0x20003
    s_add_u32 s92, s92, s93
    s_lshr_b32 s93, s2, 5
    s_lshl_b32 s93, s93, 2
    s_or_b32 s93, s93, 0x40000
    s_lshr_b32 s90, s92, 1
    s_lshl_b32 s90, s90, 7
    s_add_u32 s90, s90, 117440512
    s_bfe_u32 s91, 873473623, s93
    s_lshr_b32 s91, s91, 1
    v_mov_b32 v0, s91
    s_bfe_u32 s91, 4225681832, s93
    s_lshr_b32 s91, s91, 1
    v_writelane_b32 v0, s91, 8
    v_lshlrev_b32 v0, 3, v0
    buffer_load_dwordx2 v[4:5], v0, s[8:11], s90 offen sc1
    s_waitcnt vmcnt(0)
    s_branch m_spin48
m_ok49:
    s_and_b32 s92, s2, 7
    s_lshl_b32 s92, s92, 2
    s_bfe_u32 s93, s2, 0x20003
    s_add_u32 s92, s92, s93
    s_lshr_b32 s93, s2, 5
    s_lshl_b32 s93, s93, 2
    s_or_b32 s93, s93, 0x40000
    s_bfe_u32 s90, 4225681832, s93
    s_lshl_b32 s90, s90, 3
    s_lshl_b32 s91, s16, 1
    s_add_u32 s90, s90, s91
    s_lshl_b32 s90, s90, 12
    s_lshl_b32 s91, s92, 19
    s_add_u32 s90, s90, s91
    s_add_u32 s90, s90, 0
    buffer_load_dwordx4 a[128:131], v2, s[8:11], s90 offen offset:0 sc1
    buffer_load_dwordx4 a[132:135], v2, s[8:11], s90 offen offset:1024 sc1
    buffer_load_dwordx4 a[136:139], v2, s[8:11], s90 offen offset:2048 sc1
    buffer_load_dwordx4 a[140:143], v2, s[8:11], s90 offen offset:3072 sc1
    s_bfe_u32 s90, 4225681832, s93
    s_lshl_b32 s90, s90, 3
    s_lshl_b32 s91, s16, 1
    s_add_u32 s90, s90, s91
    s_lshl_b32 s90, s90, 12
    s_lshl_b32 s91, s92, 19
    s_add_u32 s90, s90, s91
    s_add_u32 s90, s90, 4096
    buffer_load_dwordx4 a[144:147], v2, s[8:11], s90 offen offset:0 sc1
    buffer_load_dwordx4 a[148:151], v2, s[8:11], s90 offen offset:1024 sc1
    buffer_load_dwordx4 a[152:155], v2, s[8:11], s90 offen offset:2048 sc1
    buffer_load_dwordx4 a[156:159], v2, s[8:11], s90 offen offset:3072 sc1
    s_bfe_u32 s90, 873473623, s93
    s_lshl_b32 s90, s90, 3
    s_lshl_b32 s91, s16, 1
    s_add_u32 s90, s90, s91
    s_lshl_b32 s90, s90, 12
    s_lshl_b32 s91, s92, 19
    s_add_u32 s90, s90, s91
    s_add_u32 s90, s90, 0
    buffer_load_dwordx4 a[160:163], v2, s[8:11], s90 offen offset:0 sc1
    buffer_load_dwordx4 a[164:167], v2, s[8:11], s90 offen offset:1024 sc1
    buffer_load_dwordx4 a[168:171], v2, s[8:11], s90 offen offset:2048 sc1
    buffer_load_dwordx4 a[172:175], v2, s[8:11], s90 offen offset:3072 sc1
    s_bfe_u32 s90, 873473623, s93
    s_lshl_b32 s90, s90, 3
    s_lshl_b32 s91, s16, 1
    s_add_u32 s90, s90, s91
    s_lshl_b32 s90, s90, 12
    s_lshl_b32 s91, s92, 19
    s_add_u32 s90, s90, s91
    s_add_u32 s90, s90, 4096
    buffer_load_dwordx4 a[176:179], v2, s[8:11], s90 offen offset:0 sc1
    buffer_load_dwordx4 a[180:183], v2, s[8:11], s90 offen offset:1024 sc1
    buffer_load_dwordx4 a[184:187], v2, s[8:11], s90 offen offset:2048 sc1
    buffer_load_dwordx4 a[188:191], v2, s[8:11], s90 offen offset:3072 sc1
    s_lshl_b32 s90, s92, 19
    s_lshl_b32 s91, s58, 13
    s_add_u32 s90, s90, s91
    s_cmp_eq_u32 s57, 0
    s_mov_b32 s91, 33554432
    s_cselect_b32 s91, 16793600, s91
    s_mov_b32 s42, 268435456
    s_cselect_b32 s42, 268435456, s42
    s_add_u32 s48, s90, s91
    s_mov_b32 s49, s48
    s_add_u32 s50, s48, 4096
    s_mov_b32 s51, s50
    s_mov_b32 s40, s6
    s_mov_b32 s41, s7
    s_mov_b32 s46, 0
    s_branch m_loop16
m_x44:
    s_mov_b32 s42, 0
    s_mov_b32 s46, 0
    s_branch m_loop16
m_dosw21:
    s_cmp_eq_u32 s17, -1
    s_cbranch_scc1 m_x50
    s_cmp_lg_u32 s16, 0
    s_cbranch_scc1 m_np55
    v_mov_b32 v4, s4
    v_mov_b32 v5, s5
    s_add_u32 s90, s17, 117440512
    s_mov_b64 exec, 1
    buffer_store_dwordx2 v[4:5], off, s[8:11], s90 sc1
    s_mov_b64 exec, -1
m_np55:
    s_mov_b32 s17, -1
    s_mov_b32 s67, 3
    s_cmp_gt_u32 s65, 3
    s_cbranch_scc1 m_loop20
m_x50:
    s_cmp_eq_u32 s94, 0
    s_cbranch_scc1 m_x51
    s_mov_b32 s42, s73
    s_mov_b32 s46, s76
    s_lshl_b32 s90, s77, 4
    s_lshl_b32 s90, s90, s81
    s_mov_b32 s48, s79
    s_mul_i32 s91, s90, 1
    s_add_u32 s49, s91, s79
    s_sub_u32 s49, s49, 2048
    s_mul_i32 s91, s90, 2
    s_add_u32 s50, s91, s79
    s_mul_i32 s91, s90, 3
    s_add_u32 s51, s91, s79
    s_sub_u32 s51, s51, 2048
    s_mov_b32 s52, s80
    s_lshl_b32 s90, s78, 2
    s_mul_i32 s91, s90, 1
    s_add_u32 s53, s91, s80
    s_sub_u32 s53, s53, 2048
    s_mul_i32 s91, s90, 2
    s_add_u32 s54, s91, s80
    s_mul_i32 s91, s90, 3
    s_add_u32 s55, s91, s80
    s_sub_u32 s55, s55, 2048
    s_lshl_b32 s56, s78, 6
    s_lshl_b32 s90, s58, 7
    s_add_u32 s90, s90, s57
    s_lshl_b32 s91, s16, 6
    s_cmp_eq_u32 s81, 1
    s_cselect_b32 s90, s90, s91
    v_lshrrev_b32 v24, 3, v1
    v_lshlrev_b32 v24, s81, v24
    v_add_u32 v24, s90, v24
    v_mul_lo_u32 v24, v24, s77
    v_lshrrev_b32 v25, 4, v1
    v_and_b32 v26, 7, v1
    v_xor_b32 v25, v25, v26
    v_lshl_add_u32 v16, v25, 4, v24
    v_xor_b32 v25, 4, v25
    v_lshl_add_u32 v17, v25, 4, v24
    s_lshl_b32 s90, s77, 3
    s_lshl_b32 s90, s90, s81
    s_sub_u32 s90, s90, 1024
    v_add_u32 v17, s90, v17
    v_lshrrev_b32 v24, 5, v1
    s_lshl_b32 s90, s16, 4
    v_add_u32 v25, s90, v24
    v_mul_lo_u32 v25, v25, s78
    v_lshlrev_b32 v24, 1, v24
    v_and_b32 v26, 31, v1
    v_xor_b32 v24, v24, v26
    s_lshl_b32 s90, s78, 1
    s_sub_u32 s90, s90, 1024
    v_add_u32 v27, s90, v25
    v_xor_b32 v26, 0, v24
    v_lshl_add_u32 v18, v26, 4, v25
    v_xor_b32 v26, 4, v24
    v_lshl_add_u32 v19, v26, 4, v27
    v_xor_b32 v26, 8, v24
    v_lshl_add_u32 v20, v26, 4, v25
    v_xor_b32 v26, 12, v24
    v_lshl_add_u32 v21, v26, 4, v27
    s_mov_b32 s40, s71
    s_mov_b32 s41, s72
    s_mov_b32 s44, s74
    s_mov_b32 s45, s75
    buffer_load_dwordx2 v[4:5], off, s[12:15], 0 sc1
    s_mov_b32 s67, 0
    s_branch m_loop20
m_x51:
    s_cmp_eq_u32 s70, 1
    s_cbranch_scc1 m_x54
    s_cmp_lg_u32 s65, 3
    s_cbranch_scc1 m_x52
    s_and_b32 s92, s2, 7
    s_lshl_b32 s92, s92, 2
    s_bfe_u32 s93, s2, 0x20003
    s_add_u32 s92, s92, s93
    s_lshr_b32 s93, s2, 5
    s_lshl_b32 s93, s93, 2
    s_or_b32 s93, s93, 0x40000
    s_lshr_b32 s90, s92, 1
    s_lshl_b32 s90, s90, 7
    s_add_u32 s90, s90, 117440512
    v_and_b32 v0, 3, v1
    v_min_u32 v0, 2, v0
    v_and_b32 v4, 4, v1
    v_add3_u32 v0, v0, v4, 8
    v_lshlrev_b32 v0, 3, v0
    buffer_load_dwordx2 v[4:5], v0, s[8:11], s90 offen sc1
    s_branch m_loop20
m_x52:
    s_waitcnt vmcnt(16)
    s_cmp_lg_u32 s65, 2
    s_cbranch_scc1 m_x53
    s_mov_b32 s3, 1048576
m_spin56:
    v_cmp_ne_u64 s[22:23], s[4:5], v[4:5]
    s_nop 3
    s_cmp_eq_u64 s[22:23], 0
    s_cbranch_scc1 m_ok57
    s_sub_u32 s3, s3, 1
    s_cbranch_scc1 m_ok57
    s_sleep 16
    s_and_b32 s92, s2, 7
    s_lshl_b32 s92, s92, 2
    s_bfe_u32 s93, s2, 0x20003
    s_add_u32 s92, s92, s93
    s_lshr_b32 s93, s2, 5
    s_lshl_b32 s93, s93, 2
    s_or_b32 s93, s93, 0x40000
    s_lshr_b32 s90, s92, 1
    s_lshl_b32 s90, s90, 7
    s_add_u32 s90, s90, 117440512
    v_and_b32 v0, 3, v1
    v_min_u32 v0, 2, v0
    v_and_b32 v4, 4, v1
    v_add3_u32 v0, v0, v4, 8
    v_lshlrev_b32 v0, 3, v0
    buffer_load_dwordx2 v[4:5], v0, s[8:11], s90 offen sc1
    s_waitcnt vmcnt(0)
    s_branch m_spin56
m_ok57:
    s_and_b32 s92, s2, 7
    s_lshl_b32 s92, s92, 2
    s_bfe_u32 s93, s2, 0x20003
    s_add_u32 s92, s92, s93
    s_lshr_b32 s93, s2, 5
    s_lshl_b32 s93, s93, 2
    s_or_b32 s93, s93, 0x40000
    s_lshr_b32 s90, s92, 1
    s_lshl_b32 s90, s90, 7
    s_add_u32 s90, s90, 117440512
    s_bfe_u32 s91, 873473623, s93
    s_lshr_b32 s91, s91, 1
    v_mov_b32 v0, s91
    s_bfe_u32 s91, 4225681832, s93
    s_lshr_b32 s91, s91, 1
    v_writelane_b32 v0, s91, 8
    v_lshlrev_b32 v0, 3, v0
    buffer_load_dwordx2 v[4:5], v0, s[8:11], s90 offen sc1
    s_lshl_b32 s90, s92, 19
    s_lshl_b32 s91, s58, 13
    s_add_u32 s90, s90, s91
    s_cmp_eq_u32 s57, 0
    s_mov_b32 s91, 33554432
    s_cselect_b32 s91, 16777216, s91
    s_mov_b32 s42, 0
    s_cselect_b32 s42, 268435456, s42
    s_add_u32 s48, s90, s91
    s_mov_b32 s49, s48
    s_add_u32 s50, s48, 4096
    s_mov_b32 s51, s50
    s_mov_b32 s40, s6
    s_mov_b32 s41, s7
    s_lshl_b32 s90, s92, 19
    s_lshl_b32 s91, s58, 13
    s_add_u32 s90, s90, s91
    s_cmp_eq_u32 s57, 0
    s_mov_b32 s91, 33587200
    s_cselect_b32 s91, 16826368, s91
    s_mov_b32 s46, 268435456
    s_cselect_b32 s46, 268435456, s46
    s_add_u32 s52, s90, s91
    s_mov_b32 s53, s52
    s_add_u32 s54, s52, 4096
    s_mov_b32 s55, s54
    s_mov_b32 s44, s6
    s_mov_b32 s45, s7
    v_mov_b32 v16, v2
    v_mov_b32 v17, v2
    v_mov_b32 v18, v2
    v_mov_b32 v19, v2
    v_mov_b32 v20, v2
    v_mov_b32 v21, v2
    s_branch m_loop20
m_x53:
    s_mov_b32 s3, 1048576
m_spin58:
    v_cmp_ne_u64 s[22:23], s[4:5], v[4:5]
    s_nop 3
    s_cmp_eq_u64 s[22:23], 0
    s_cbranch_scc1 m_ok59
    s_sub_u32 s3, s3, 1
    s_cbranch_scc1 m_ok59
    s_sleep 16
    s_and_b32 s92, s2, 7
    s_lshl_b32 s92, s92, 2
    s_bfe_u32 s93, s2, 0x20003
    s_add_u32 s92, s92, s93
    s_lshr_b32 s93, s2, 5
    s_lshl_b32 s93, s93, 2
    s_or_b32 s93, s93, 0x40000
    s_lshr_b32 s90, s92, 1
    s_lshl_b32 s90, s90, 7
    s_add_u32 s90, s90, 117440512
    s_bfe_u32 s91, 873473623, s93
    s_lshr_b32 s91, s91, 1
    v_mov_b32 v0, s91
    s_bfe_u32 s91, 4225681832, s93
    s_lshr_b32 s91, s91, 1
    v_writelane_b32 v0, s91, 8
    v_lshlrev_b32 v0, 3, v0
    buffer_load_dwordx2 v[4:5], v0, s[8:11], s90 offen sc1
    s_waitcnt vmcnt(0)
    s_branch m_spin58
m_ok59:
    s_and_b32 s92, s2, 7
    s_lshl_b32 s92, s92, 2
    s_bfe_u32 s93, s2, 0x20003
    s_add_u32 s92, s92, s93
    s_lshr_b32 s93, s2, 5
    s_lshl_b32 s93, s93, 2
    s_or_b32 s93, s93, 0x40000
    s_bfe_u32 s90, 4225681832, s93
    s_lshl_b32 s90, s90, 3
    s_lshl_b32 s91, s16, 1
    s_add_u32 s90, s90, s91
    s_lshl_b32 s90, s90, 12
    s_lshl_b32 s91, s92, 19
    s_add_u32 s90, s90, s91
    s_add_u32 s90, s90, 0
    buffer_load_dwordx4 a[128:131], v2, s[8:11], s90 offen offset:0 sc1
    buffer_load_dwordx4 a[132:135], v2, s[8:11], s90 offen offset:1024 sc1
    buffer_load_dwordx4 a[136:139], v2, s[8:11], s90 offen offset:2048 sc1
    buffer_load_dwordx4 a[140:143], v2, s[8:11], s90 offen offset:3072 sc1
    s_bfe_u32 s90, 4225681832, s93
    s_lshl_b32 s90, s90, 3
    s_lshl_b32 s91, s16, 1
    s_add_u32 s90, s90, s91
    s_lshl_b32 s90, s90, 12
    s_lshl_b32 s91, s92, 19
    s_add_u32 s90, s90, s91
    s_add_u32 s90, s90, 4096
    buffer_load_dwordx4 a[144:147], v2, s[8:11], s90 offen offset:0 sc1
    buffer_load_dwordx4 a[148:151], v2, s[8:11], s90 offen offset:1024 sc1
    buffer_load_dwordx4 a[152:155], v2, s[8:11], s90 offen offset:2048 sc1
    buffer_load_dwordx4 a[156:159], v2, s[8:11], s90 offen offset:3072 sc1
    s_bfe_u32 s90, 873473623, s93
    s_lshl_b32 s90, s90, 3
    s_lshl_b32 s91, s16, 1
    s_add_u32 s90, s90, s91
    s_lshl_b32 s90, s90, 12
    s_lshl_b32 s91, s92, 19
    s_add_u32 s90, s90, s91
    s_add_u32 s90, s90, 0
    buffer_load_dwordx4 a[160:163], v2, s[8:11], s90 offen offset:0 sc1
    buffer_load_dwordx4 a[164:167], v2, s[8:11], s90 offen offset:1024 sc1
    buffer_load_dwordx4 a[168:171], v2, s[8:11], s90 offen offset:2048 sc1
    buffer_load_dwordx4 a[172:175], v2, s[8:11], s90 offen offset:3072 sc1
    s_bfe_u32 s90, 873473623, s93
    s_lshl_b32 s90, s90, 3
    s_lshl_b32 s91, s16, 1
    s_add_u32 s90, s90, s91
    s_lshl_b32 s90, s90, 12
    s_lshl_b32 s91, s92, 19
    s_add_u32 s90, s90, s91
    s_add_u32 s90, s90, 4096
    buffer_load_dwordx4 a[176:179], v2, s[8:11], s90 offen offset:0 sc1
    buffer_load_dwordx4 a[180:183], v2, s[8:11], s90 offen offset:1024 sc1
    buffer_load_dwordx4 a[184:187], v2, s[8:11], s90 offen offset:2048 sc1
    buffer_load_dwordx4 a[188:191], v2, s[8:11], s90 offen offset:3072 sc1
    s_lshl_b32 s90, s92, 19
    s_lshl_b32 s91, s58, 13
    s_add_u32 s90, s90, s91
    s_cmp_eq_u32 s57, 0
    s_mov_b32 s91, 33554432
    s_cselect_b32 s91, 16793600, s91
    s_mov_b32 s42, 268435456
    s_cselect_b32 s42, 268435456, s42
    s_add_u32 s48, s90, s91
    s_mov_b32 s49, s48
    s_add_u32 s50, s48, 4096
    s_mov_b32 s51, s50
    s_mov_b32 s40, s6
    s_mov_b32 s41, s7
    s_mov_b32 s46, 0
    s_branch m_loop20
m_x54:
    s_mov_b32 s42, 0
    s_mov_b32 s46, 0
    s_branch m_loop20
m_eps23:
    s_mov_b32 s92, s97
    s_mov_b32 s93, s97
    s_cmp_eq_u32 s97, 0
    s_cbranch_scc1 m_ns360
    v_pk_mul_f32 v[32:33], v[32:33], s[92:93]
    v_pk_mul_f32 v[34:35], v[34:35], s[92:93]
    v_pk_mul_f32 v[36:37], v[36:37], s[92:93]
    v_pk_mul_f32 v[38:39], v[38:39], s[92:93]
    v_cvt_pk_bf16_f32 v32, v32, v33
    v_cvt_pk_bf16_f32 v33, v34, v35
    v_cvt_pk_bf16_f32 v34, v36, v37
    v_cvt_pk_bf16_f32 v35, v38, v39
    v_accvgpr_write_b32 a128, v32
    v_accvgpr_write_b32 a129, v33
    v_accvgpr_write_b32 a130, v34
    v_accvgpr_write_b32 a131, v35
    v_pk_mul_f32 v[40:41], v[40:41], s[92:93]
    v_pk_mul_f32 v[42:43], v[42:43], s[92:93]
    v_pk_mul_f32 v[44:45], v[44:45], s[92:93]
    v_pk_mul_f32 v[46:47], v[46:47], s[92:93]
    v_cvt_pk_bf16_f32 v40, v40, v41
    v_cvt_pk_bf16_f32 v41, v42, v43
    v_cvt_pk_bf16_f32 v42, v44, v45
    v_cvt_pk_bf16_f32 v43, v46, v47
    v_accvgpr_write_b32 a132, v40
    v_accvgpr_write_b32 a133, v41
    v_accvgpr_write_b32 a134, v42
    v_accvgpr_write_b32 a135, v43
    v_pk_mul_f32 v[48:49], v[48:49], s[92:93]
    v_pk_mul_f32 v[50:51], v[50:51], s[92:93]
    v_pk_mul_f32 v[52:53], v[52:53], s[92:93]
    v_pk_mul_f32 v[54:55], v[54:55], s[92:93]
    v_cvt_pk_bf16_f32 v48, v48, v49
    v_cvt_pk_bf16_f32 v49, v50, v51
    v_cvt_pk_bf16_f32 v50, v52, v53
    v_cvt_pk_bf16_f32 v51, v54, v55
    v_accvgpr_write_b32 a136, v48
    v_accvgpr_write_b32 a137, v49
    v_accvgpr_write_b32 a138, v50
    v_accvgpr_write_b32 a139, v51
    v_pk_mul_f32 v[56:57], v[56:57], s[92:93]
    v_pk_mul_f32 v[58:59], v[58:59], s[92:93]
    v_pk_mul_f32 v[60:61], v[60:61], s[92:93]
    v_pk_mul_f32 v[62:63], v[62:63], s[92:93]
    v_cvt_pk_bf16_f32 v56, v56, v57
    v_cvt_pk_bf16_f32 v57, v58, v59
    v_cvt_pk_bf16_f32 v58, v60, v61
    v_cvt_pk_bf16_f32 v59, v62, v63
    v_accvgpr_write_b32 a140, v56
    v_accvgpr_write_b32 a141, v57
    v_accvgpr_write_b32 a142, v58
    v_accvgpr_write_b32 a143, v59
    v_pk_mul_f32 v[64:65], v[64:65], s[92:93]
    v_pk_mul_f32 v[66:67], v[66:67], s[92:93]
    v_pk_mul_f32 v[68:69], v[68:69], s[92:93]
    v_pk_mul_f32 v[70:71], v[70:71], s[92:93]
    v_cvt_pk_bf16_f32 v64, v64, v65
    v_cvt_pk_bf16_f32 v65, v66, v67
    v_cvt_pk_bf16_f32 v66, v68, v69
    v_cvt_pk_bf16_f32 v67, v70, v71
    v_accvgpr_write_b32 a144, v64
    v_accvgpr_write_b32 a145, v65
    v_accvgpr_write_b32 a146, v66
    v_accvgpr_write_b32 a147, v67
    v_pk_mul_f32 v[72:73], v[72:73], s[92:93]
    v_pk_mul_f32 v[74:75], v[74:75], s[92:93]
    v_pk_mul_f32 v[76:77], v[76:77], s[92:93]
    v_pk_mul_f32 v[78:79], v[78:79], s[92:93]
    v_cvt_pk_bf16_f32 v72, v72, v73
    v_cvt_pk_bf16_f32 v73, v74, v75
    v_cvt_pk_bf16_f32 v74, v76, v77
    v_cvt_pk_bf16_f32 v75, v78, v79
    v_accvgpr_write_b32 a148, v72
    v_accvgpr_write_b32 a149, v73
    v_accvgpr_write_b32 a150, v74
    v_accvgpr_write_b32 a151, v75
    v_pk_mul_f32 v[80:81], v[80:81], s[92:93]
    v_pk_mul_f32 v[82:83], v[82:83], s[92:93]
    v_pk_mul_f32 v[84:85], v[84:85], s[92:93]
    v_pk_mul_f32 v[86:87], v[86:87], s[92:93]
    v_cvt_pk_bf16_f32 v80, v80, v81
    v_cvt_pk_bf16_f32 v81, v82, v83
    v_cvt_pk_bf16_f32 v82, v84, v85
    v_cvt_pk_bf16_f32 v83, v86, v87
    v_accvgpr_write_b32 a152, v80
    v_accvgpr_write_b32 a153, v81
    v_accvgpr_write_b32 a154, v82
    v_accvgpr_write_b32 a155, v83
    v_pk_mul_f32 v[88:89], v[88:89], s[92:93]
    v_pk_mul_f32 v[90:91], v[90:91], s[92:93]
    v_pk_mul_f32 v[92:93], v[92:93], s[92:93]
    v_pk_mul_f32 v[94:95], v[94:95], s[92:93]
    v_cvt_pk_bf16_f32 v88, v88, v89
    v_cvt_pk_bf16_f32 v89, v90, v91
    v_cvt_pk_bf16_f32 v90, v92, v93
    v_cvt_pk_bf16_f32 v91, v94, v95
    v_accvgpr_write_b32 a156, v88
    v_accvgpr_write_b32 a157, v89
    v_accvgpr_write_b32 a158, v90
    v_accvgpr_write_b32 a159, v91
    v_pk_mul_f32 v[96:97], v[96:97], s[92:93]
    v_pk_mul_f32 v[98:99], v[98:99], s[92:93]
    v_pk_mul_f32 v[100:101], v[100:101], s[92:93]
    v_pk_mul_f32 v[102:103], v[102:103], s[92:93]
    v_cvt_pk_bf16_f32 v96, v96, v97
    v_cvt_pk_bf16_f32 v97, v98, v99
    v_cvt_pk_bf16_f32 v98, v100, v101
    v_cvt_pk_bf16_f32 v99, v102, v103
    v_accvgpr_write_b32 a160, v96
    v_accvgpr_write_b32 a161, v97
    v_accvgpr_write_b32 a162, v98
    v_accvgpr_write_b32 a163, v99
    v_pk_mul_f32 v[104:105], v[104:105], s[92:93]
    v_pk_mul_f32 v[106:107], v[106:107], s[92:93]
    v_pk_mul_f32 v[108:109], v[108:109], s[92:93]
    v_pk_mul_f32 v[110:111], v[110:111], s[92:93]
    v_cvt_pk_bf16_f32 v104, v104, v105
    v_cvt_pk_bf16_f32 v105, v106, v107
    v_cvt_pk_bf16_f32 v106, v108, v109
    v_cvt_pk_bf16_f32 v107, v110, v111
    v_accvgpr_write_b32 a164, v104
    v_accvgpr_write_b32 a165, v105
    v_accvgpr_write_b32 a166, v106
    v_accvgpr_write_b32 a167, v107
    v_pk_mul_f32 v[112:113], v[112:113], s[92:93]
    v_pk_mul_f32 v[114:115], v[114:115], s[92:93]
    v_pk_mul_f32 v[116:117], v[116:117], s[92:93]
    v_pk_mul_f32 v[118:119], v[118:119], s[92:93]
    v_cvt_pk_bf16_f32 v112, v112, v113
    v_cvt_pk_bf16_f32 v113, v114, v115
    v_cvt_pk_bf16_f32 v114, v116, v117
    v_cvt_pk_bf16_f32 v115, v118, v119
    v_accvgpr_write_b32 a168, v112
    v_accvgpr_write_b32 a169, v113
    v_accvgpr_write_b32 a170, v114
    v_accvgpr_write_b32 a171, v115
    v_pk_mul_f32 v[120:121], v[120:121], s[92:93]
    v_pk_mul_f32 v[122:123], v[122:123], s[92:93]
    v_pk_mul_f32 v[124:125], v[124:125], s[92:93]
    v_pk_mul_f32 v[126:127], v[126:127], s[92:93]
    v_cvt_pk_bf16_f32 v120, v120, v121
    v_cvt_pk_bf16_f32 v121, v122, v123
    v_cvt_pk_bf16_f32 v122, v124, v125
    v_cvt_pk_bf16_f32 v123, v126, v127
    v_accvgpr_write_b32 a172, v120
    v_accvgpr_write_b32 a173, v121
    v_accvgpr_write_b32 a174, v122
    v_accvgpr_write_b32 a175, v123
    v_pk_mul_f32 v[128:129], v[128:129], s[92:93]
    v_pk_mul_f32 v[130:131], v[130:131], s[92:93]
    v_pk_mul_f32 v[132:133], v[132:133], s[92:93]
    v_pk_mul_f32 v[134:135], v[134:135], s[92:93]
    v_cvt_pk_bf16_f32 v128, v128, v129
    v_cvt_pk_bf16_f32 v129, v130, v131
    v_cvt_pk_bf16_f32 v130, v132, v133
    v_cvt_pk_bf16_f32 v131, v134, v135
    v_accvgpr_write_b32 a176, v128
    v_accvgpr_write_b32 a177, v129
    v_accvgpr_write_b32 a178, v130
    v_accvgpr_write_b32 a179, v131
    v_pk_mul_f32 v[136:137], v[136:137], s[92:93]
    v_pk_mul_f32 v[138:139], v[138:139], s[92:93]
    v_pk_mul_f32 v[140:141], v[140:141], s[92:93]
    v_pk_mul_f32 v[142:143], v[142:143], s[92:93]
    v_cvt_pk_bf16_f32 v136, v136, v137
    v_cvt_pk_bf16_f32 v137, v138, v139
    v_cvt_pk_bf16_f32 v138, v140, v141
    v_cvt_pk_bf16_f32 v139, v142, v143
    v_accvgpr_write_b32 a180, v136
    v_accvgpr_write_b32 a181, v137
    v_accvgpr_write_b32 a182, v138
    v_accvgpr_write_b32 a183, v139
    v_pk_mul_f32 v[144:145], v[144:145], s[92:93]
    v_pk_mul_f32 v[146:147], v[146:147], s[92:93]
    v_pk_mul_f32 v[148:149], v[148:149], s[92:93]
    v_pk_mul_f32 v[150:151], v[150:151], s[92:93]
    v_cvt_pk_bf16_f32 v144, v144, v145
    v_cvt_pk_bf16_f32 v145, v146, v147
    v_cvt_pk_bf16_f32 v146, v148, v149
    v_cvt_pk_bf16_f32 v147, v150, v151
    v_accvgpr_write_b32 a184, v144
    v_accvgpr_write_b32 a185, v145
    v_accvgpr_write_b32 a186, v146
    v_accvgpr_write_b32 a187, v147
    v_pk_mul_f32 v[152:153], v[152:153], s[92:93]
    v_pk_mul_f32 v[154:155], v[154:155], s[92:93]
    v_pk_mul_f32 v[156:157], v[156:157], s[92:93]
    v_pk_mul_f32 v[158:159], v[158:159], s[92:93]
    v_cvt_pk_bf16_f32 v152, v152, v153
    v_cvt_pk_bf16_f32 v153, v154, v155
    v_cvt_pk_bf16_f32 v154, v156, v157
    v_cvt_pk_bf16_f32 v155, v158, v159
    v_accvgpr_write_b32 a188, v152
    v_accvgpr_write_b32 a189, v153
    v_accvgpr_write_b32 a190, v154
    v_accvgpr_write_b32 a191, v155
    v_pk_mul_f32 v[160:161], v[160:161], s[92:93]
    v_pk_mul_f32 v[162:163], v[162:163], s[92:93]
    v_pk_mul_f32 v[164:165], v[164:165], s[92:93]
    v_pk_mul_f32 v[166:167], v[166:167], s[92:93]
    v_cvt_pk_bf16_f32 v160, v160, v161
    v_cvt_pk_bf16_f32 v161, v162, v163
    v_cvt_pk_bf16_f32 v162, v164, v165
    v_cvt_pk_bf16_f32 v163, v166, v167
    v_accvgpr_write_b32 a192, v160
    v_accvgpr_write_b32 a193, v161
    v_accvgpr_write_b32 a194, v162
    v_accvgpr_write_b32 a195, v163
    v_pk_mul_f32 v[168:169], v[168:169], s[92:93]
    v_pk_mul_f32 v[170:171], v[170:171], s[92:93]
    v_pk_mul_f32 v[172:173], v[172:173], s[92:93]
    v_pk_mul_f32 v[174:175], v[174:175], s[92:93]
    v_cvt_pk_bf16_f32 v168, v168, v169
    v_cvt_pk_bf16_f32 v169, v170, v171
    v_cvt_pk_bf16_f32 v170, v172, v173
    v_cvt_pk_bf16_f32 v171, v174, v175
    v_accvgpr_write_b32 a196, v168
    v_accvgpr_write_b32 a197, v169
    v_accvgpr_write_b32 a198, v170
    v_accvgpr_write_b32 a199, v171
    v_pk_mul_f32 v[176:177], v[176:177], s[92:93]
    v_pk_mul_f32 v[178:179], v[178:179], s[92:93]
    v_pk_mul_f32 v[180:181], v[180:181], s[92:93]
    v_pk_mul_f32 v[182:183], v[182:183], s[92:93]
    v_cvt_pk_bf16_f32 v176, v176, v177
    v_cvt_pk_bf16_f32 v177, v178, v179
    v_cvt_pk_bf16_f32 v178, v180, v181
    v_cvt_pk_bf16_f32 v179, v182, v183
    v_accvgpr_write_b32 a200, v176
    v_accvgpr_write_b32 a201, v177
    v_accvgpr_write_b32 a202, v178
    v_accvgpr_write_b32 a203, v179
    v_pk_mul_f32 v[184:185], v[184:185], s[92:93]
    v_pk_mul_f32 v[186:187], v[186:187], s[92:93]
    v_pk_mul_f32 v[188:189], v[188:189], s[92:93]
    v_pk_mul_f32 v[190:191], v[190:191], s[92:93]
    v_cvt_pk_bf16_f32 v184, v184, v185
    v_cvt_pk_bf16_f32 v185, v186, v187
    v_cvt_pk_bf16_f32 v186, v188, v189
    v_cvt_pk_bf16_f32 v187, v190, v191
    v_accvgpr_write_b32 a204, v184
    v_accvgpr_write_b32 a205, v185
    v_accvgpr_write_b32 a206, v186
    v_accvgpr_write_b32 a207, v187
    v_pk_mul_f32 v[192:193], v[192:193], s[92:93]
    v_pk_mul_f32 v[194:195], v[194:195], s[92:93]
    v_pk_mul_f32 v[196:197], v[196:197], s[92:93]
    v_pk_mul_f32 v[198:199], v[198:199], s[92:93]
    v_cvt_pk_bf16_f32 v192, v192, v193
    v_cvt_pk_bf16_f32 v193, v194, v195
    v_cvt_pk_bf16_f32 v194, v196, v197
    v_cvt_pk_bf16_f32 v195, v198, v199
    v_accvgpr_write_b32 a208, v192
    v_accvgpr_write_b32 a209, v193
    v_accvgpr_write_b32 a210, v194
    v_accvgpr_write_b32 a211, v195
    v_pk_mul_f32 v[200:201], v[200:201], s[92:93]
    v_pk_mul_f32 v[202:203], v[202:203], s[92:93]
    v_pk_mul_f32 v[204:205], v[204:205], s[92:93]
    v_pk_mul_f32 v[206:207], v[206:207], s[92:93]
    v_cvt_pk_bf16_f32 v200, v200, v201
    v_cvt_pk_bf16_f32 v201, v202, v203
    v_cvt_pk_bf16_f32 v202, v204, v205
    v_cvt_pk_bf16_f32 v203, v206, v207
    v_accvgpr_write_b32 a212, v200
    v_accvgpr_write_b32 a213, v201
    v_accvgpr_write_b32 a214, v202
    v_accvgpr_write_b32 a215, v203
    v_pk_mul_f32 v[208:209], v[208:209], s[92:93]
    v_pk_mul_f32 v[210:211], v[210:211], s[92:93]
    v_pk_mul_f32 v[212:213], v[212:213], s[92:93]
    v_pk_mul_f32 v[214:215], v[214:215], s[92:93]
    v_cvt_pk_bf16_f32 v208, v208, v209
    v_cvt_pk_bf16_f32 v209, v210, v211
    v_cvt_pk_bf16_f32 v210, v212, v213
    v_cvt_pk_bf16_f32 v211, v214, v215
    v_accvgpr_write_b32 a216, v208
    v_accvgpr_write_b32 a217, v209
    v_accvgpr_write_b32 a218, v210
    v_accvgpr_write_b32 a219, v211
    v_pk_mul_f32 v[216:217], v[216:217], s[92:93]
    v_pk_mul_f32 v[218:219], v[218:219], s[92:93]
    v_pk_mul_f32 v[220:221], v[220:221], s[92:93]
    v_pk_mul_f32 v[222:223], v[222:223], s[92:93]
    v_cvt_pk_bf16_f32 v216, v216, v217
    v_cvt_pk_bf16_f32 v217, v218, v219
    v_cvt_pk_bf16_f32 v218, v220, v221
    v_cvt_pk_bf16_f32 v219, v222, v223
    v_accvgpr_write_b32 a220, v216
    v_accvgpr_write_b32 a221, v217
    v_accvgpr_write_b32 a222, v218
    v_accvgpr_write_b32 a223, v219
    v_pk_mul_f32 v[224:225], v[224:225], s[92:93]
    v_pk_mul_f32 v[226:227], v[226:227], s[92:93]
    v_pk_mul_f32 v[228:229], v[228:229], s[92:93]
    v_pk_mul_f32 v[230:231], v[230:231], s[92:93]
    v_cvt_pk_bf16_f32 v224, v224, v225
    v_cvt_pk_bf16_f32 v225, v226, v227
    v_cvt_pk_bf16_f32 v226, v228, v229
    v_cvt_pk_bf16_f32 v227, v230, v231
    v_accvgpr_write_b32 a224, v224
    v_accvgpr_write_b32 a225, v225
    v_accvgpr_write_b32 a226, v226
    v_accvgpr_write_b32 a227, v227
    v_pk_mul_f32 v[232:233], v[232:233], s[92:93]
    v_pk_mul_f32 v[234:235], v[234:235], s[92:93]
    v_pk_mul_f32 v[236:237], v[236:237], s[92:93]
    v_pk_mul_f32 v[238:239], v[238:239], s[92:93]
    v_cvt_pk_bf16_f32 v232, v232, v233
    v_cvt_pk_bf16_f32 v233, v234, v235
    v_cvt_pk_bf16_f32 v234, v236, v237
    v_cvt_pk_bf16_f32 v235, v238, v239
    v_accvgpr_write_b32 a228, v232
    v_accvgpr_write_b32 a229, v233
    v_accvgpr_write_b32 a230, v234
    v_accvgpr_write_b32 a231, v235
    v_pk_mul_f32 v[240:241], v[240:241], s[92:93]
    v_pk_mul_f32 v[242:243], v[242:243], s[92:93]
    v_pk_mul_f32 v[244:245], v[244:245], s[92:93]
    v_pk_mul_f32 v[246:247], v[246:247], s[92:93]
    v_cvt_pk_bf16_f32 v240, v240, v241
    v_cvt_pk_bf16_f32 v241, v242, v243
    v_cvt_pk_bf16_f32 v242, v244, v245
    v_cvt_pk_bf16_f32 v243, v246, v247
    v_accvgpr_write_b32 a232, v240
    v_accvgpr_write_b32 a233, v241
    v_accvgpr_write_b32 a234, v242
    v_accvgpr_write_b32 a235, v243
    v_pk_mul_f32 v[248:249], v[248:249], s[92:93]
    v_pk_mul_f32 v[250:251], v[250:251], s[92:93]
    v_pk_mul_f32 v[252:253], v[252:253], s[92:93]
    v_pk_mul_f32 v[254:255], v[254:255], s[92:93]
    v_cvt_pk_bf16_f32 v248, v248, v249
    v_cvt_pk_bf16_f32 v249, v250, v251
    v_cvt_pk_bf16_f32 v250, v252, v253
    v_cvt_pk_bf16_f32 v251, v254, v255
    v_accvgpr_write_b32 a236, v248
    v_accvgpr_write_b32 a237, v249
    v_accvgpr_write_b32 a238, v250
    v_accvgpr_write_b32 a239, v251
    v_accvgpr_read_b32 v24, a96
    v_accvgpr_read_b32 v25, a97
    v_accvgpr_read_b32 v26, a98
    v_accvgpr_read_b32 v27, a99
    v_accvgpr_read_b32 v28, a100
    v_accvgpr_read_b32 v29, a101
    v_accvgpr_read_b32 v30, a102
    v_accvgpr_read_b32 v31, a103
    v_pk_mul_f32 v[24:25], v[24:25], s[92:93]
    v_pk_mul_f32 v[26:27], v[26:27], s[92:93]
    v_pk_mul_f32 v[28:29], v[28:29], s[92:93]
    v_pk_mul_f32 v[30:31], v[30:31], s[92:93]
    v_cvt_pk_bf16_f32 v24, v24, v25
    v_cvt_pk_bf16_f32 v25, v26, v27
    v_cvt_pk_bf16_f32 v26, v28, v29
    v_cvt_pk_bf16_f32 v27, v30, v31
    v_accvgpr_write_b32 a240, v24
    v_accvgpr_write_b32 a241, v25
    v_accvgpr_write_b32 a242, v26
    v_accvgpr_write_b32 a243, v27
    v_accvgpr_read_b32 v24, a104
    v_accvgpr_read_b32 v25, a105
    v_accvgpr_read_b32 v26, a106
    v_accvgpr_read_b32 v27, a107
    v_accvgpr_read_b32 v28, a108
    v_accvgpr_read_b32 v29, a109
    v_accvgpr_read_b32 v30, a110
    v_accvgpr_read_b32 v31, a111
    v_pk_mul_f32 v[24:25], v[24:25], s[92:93]
    v_pk_mul_f32 v[26:27], v[26:27], s[92:93]
    v_pk_mul_f32 v[28:29], v[28:29], s[92:93]
    v_pk_mul_f32 v[30:31], v[30:31], s[92:93]
    v_cvt_pk_bf16_f32 v24, v24, v25
    v_cvt_pk_bf16_f32 v25, v26, v27
    v_cvt_pk_bf16_f32 v26, v28, v29
    v_cvt_pk_bf16_f32 v27, v30, v31
    v_accvgpr_write_b32 a244, v24
    v_accvgpr_write_b32 a245, v25
    v_accvgpr_write_b32 a246, v26
    v_accvgpr_write_b32 a247, v27
    v_accvgpr_read_b32 v24, a112
    v_accvgpr_read_b32 v25, a113
    v_accvgpr_read_b32 v26, a114
    v_accvgpr_read_b32 v27, a115
    v_accvgpr_read_b32 v28, a116
    v_accvgpr_read_b32 v29, a117
    v_accvgpr_read_b32 v30, a118
    v_accvgpr_read_b32 v31, a119
    v_pk_mul_f32 v[24:25], v[24:25], s[92:93]
    v_pk_mul_f32 v[26:27], v[26:27], s[92:93]
    v_pk_mul_f32 v[28:29], v[28:29], s[92:93]
    v_pk_mul_f32 v[30:31], v[30:31], s[92:93]
    v_cvt_pk_bf16_f32 v24, v24, v25
    v_cvt_pk_bf16_f32 v25, v26, v27
    v_cvt_pk_bf16_f32 v26, v28, v29
    v_cvt_pk_bf16_f32 v27, v30, v31
    v_accvgpr_write_b32 a248, v24
    v_accvgpr_write_b32 a249, v25
    v_accvgpr_write_b32 a250, v26
    v_accvgpr_write_b32 a251, v27
    v_accvgpr_read_b32 v24, a120
    v_accvgpr_read_b32 v25, a121
    v_accvgpr_read_b32 v26, a122
    v_accvgpr_read_b32 v27, a123
    v_accvgpr_read_b32 v28, a124
    v_accvgpr_read_b32 v29, a125
    v_accvgpr_read_b32 v30, a126
    v_accvgpr_read_b32 v31, a127
    v_pk_mul_f32 v[24:25], v[24:25], s[92:93]
    v_pk_mul_f32 v[26:27], v[26:27], s[92:93]
    v_pk_mul_f32 v[28:29], v[28:29], s[92:93]
    v_pk_mul_f32 v[30:31], v[30:31], s[92:93]
    v_cvt_pk_bf16_f32 v24, v24, v25
    v_cvt_pk_bf16_f32 v25, v26, v27
    v_cvt_pk_bf16_f32 v26, v28, v29
    v_cvt_pk_bf16_f32 v27, v30, v31
    v_accvgpr_write_b32 a252, v24
    v_accvgpr_write_b32 a253, v25
    v_accvgpr_write_b32 a254, v26
    v_accvgpr_write_b32 a255, v27
    s_setpc_b64 s[20:21]
m_ns360:
    v_cvt_pk_bf16_f32 v32, v32, v33
    v_cvt_pk_bf16_f32 v33, v34, v35
    v_cvt_pk_bf16_f32 v34, v36, v37
    v_cvt_pk_bf16_f32 v35, v38, v39
    v_accvgpr_write_b32 a128, v32
    v_accvgpr_write_b32 a129, v33
    v_accvgpr_write_b32 a130, v34
    v_accvgpr_write_b32 a131, v35
    v_cvt_pk_bf16_f32 v40, v40, v41
    v_cvt_pk_bf16_f32 v41, v42, v43
    v_cvt_pk_bf16_f32 v42, v44, v45
    v_cvt_pk_bf16_f32 v43, v46, v47
    v_accvgpr_write_b32 a132, v40
    v_accvgpr_write_b32 a133, v41
    v_accvgpr_write_b32 a134, v42
    v_accvgpr_write_b32 a135, v43
    v_cvt_pk_bf16_f32 v48, v48, v49
    v_cvt_pk_bf16_f32 v49, v50, v51
    v_cvt_pk_bf16_f32 v50, v52, v53
    v_cvt_pk_bf16_f32 v51, v54, v55
    v_accvgpr_write_b32 a136, v48
    v_accvgpr_write_b32 a137, v49
    v_accvgpr_write_b32 a138, v50
    v_accvgpr_write_b32 a139, v51
    v_cvt_pk_bf16_f32 v56, v56, v57
    v_cvt_pk_bf16_f32 v57, v58, v59
    v_cvt_pk_bf16_f32 v58, v60, v61
    v_cvt_pk_bf16_f32 v59, v62, v63
    v_accvgpr_write_b32 a140, v56
    v_accvgpr_write_b32 a141, v57
    v_accvgpr_write_b32 a142, v58
    v_accvgpr_write_b32 a143, v59
    v_cvt_pk_bf16_f32 v64, v64, v65
    v_cvt_pk_bf16_f32 v65, v66, v67
    v_cvt_pk_bf16_f32 v66, v68, v69
    v_cvt_pk_bf16_f32 v67, v70, v71
    v_accvgpr_write_b32 a144, v64
    v_accvgpr_write_b32 a145, v65
    v_accvgpr_write_b32 a146, v66
    v_accvgpr_write_b32 a147, v67
    v_cvt_pk_bf16_f32 v72, v72, v73
    v_cvt_pk_bf16_f32 v73, v74, v75
    v_cvt_pk_bf16_f32 v74, v76, v77
    v_cvt_pk_bf16_f32 v75, v78, v79
    v_accvgpr_write_b32 a148, v72
    v_accvgpr_write_b32 a149, v73
    v_accvgpr_write_b32 a150, v74
    v_accvgpr_write_b32 a151, v75
    v_cvt_pk_bf16_f32 v80, v80, v81
    v_cvt_pk_bf16_f32 v81, v82, v83
    v_cvt_pk_bf16_f32 v82, v84, v85
    v_cvt_pk_bf16_f32 v83, v86, v87
    v_accvgpr_write_b32 a152, v80
    v_accvgpr_write_b32 a153, v81
    v_accvgpr_write_b32 a154, v82
    v_accvgpr_write_b32 a155, v83
    v_cvt_pk_bf16_f32 v88, v88, v89
    v_cvt_pk_bf16_f32 v89, v90, v91
    v_cvt_pk_bf16_f32 v90, v92, v93
    v_cvt_pk_bf16_f32 v91, v94, v95
    v_accvgpr_write_b32 a156, v88
    v_accvgpr_write_b32 a157, v89
    v_accvgpr_write_b32 a158, v90
    v_accvgpr_write_b32 a159, v91
    v_cvt_pk_bf16_f32 v96, v96, v97
    v_cvt_pk_bf16_f32 v97, v98, v99
    v_cvt_pk_bf16_f32 v98, v100, v101
    v_cvt_pk_bf16_f32 v99, v102, v103
    v_accvgpr_write_b32 a160, v96
    v_accvgpr_write_b32 a161, v97
    v_accvgpr_write_b32 a162, v98
    v_accvgpr_write_b32 a163, v99
    v_cvt_pk_bf16_f32 v104, v104, v105
    v_cvt_pk_bf16_f32 v105, v106, v107
    v_cvt_pk_bf16_f32 v106, v108, v109
    v_cvt_pk_bf16_f32 v107, v110, v111
    v_accvgpr_write_b32 a164, v104
    v_accvgpr_write_b32 a165, v105
    v_accvgpr_write_b32 a166, v106
    v_accvgpr_write_b32 a167, v107
    v_cvt_pk_bf16_f32 v112, v112, v113
    v_cvt_pk_bf16_f32 v113, v114, v115
    v_cvt_pk_bf16_f32 v114, v116, v117
    v_cvt_pk_bf16_f32 v115, v118, v119
    v_accvgpr_write_b32 a168, v112
    v_accvgpr_write_b32 a169, v113
    v_accvgpr_write_b32 a170, v114
    v_accvgpr_write_b32 a171, v115
    v_cvt_pk_bf16_f32 v120, v120, v121
    v_cvt_pk_bf16_f32 v121, v122, v123
    v_cvt_pk_bf16_f32 v122, v124, v125
    v_cvt_pk_bf16_f32 v123, v126, v127
    v_accvgpr_write_b32 a172, v120
    v_accvgpr_write_b32 a173, v121
    v_accvgpr_write_b32 a174, v122
    v_accvgpr_write_b32 a175, v123
    v_cvt_pk_bf16_f32 v128, v128, v129
    v_cvt_pk_bf16_f32 v129, v130, v131
    v_cvt_pk_bf16_f32 v130, v132, v133
    v_cvt_pk_bf16_f32 v131, v134, v135
    v_accvgpr_write_b32 a176, v128
    v_accvgpr_write_b32 a177, v129
    v_accvgpr_write_b32 a178, v130
    v_accvgpr_write_b32 a179, v131
    v_cvt_pk_bf16_f32 v136, v136, v137
    v_cvt_pk_bf16_f32 v137, v138, v139
    v_cvt_pk_bf16_f32 v138, v140, v141
    v_cvt_pk_bf16_f32 v139, v142, v143
    v_accvgpr_write_b32 a180, v136
    v_accvgpr_write_b32 a181, v137
    v_accvgpr_write_b32 a182, v138
    v_accvgpr_write_b32 a183, v139
    v_cvt_pk_bf16_f32 v144, v144, v145
    v_cvt_pk_bf16_f32 v145, v146, v147
    v_cvt_pk_bf16_f32 v146, v148, v149
    v_cvt_pk_bf16_f32 v147, v150, v151
    v_accvgpr_write_b32 a184, v144
    v_accvgpr_write_b32 a185, v145
    v_accvgpr_write_b32 a186, v146
    v_accvgpr_write_b32 a187, v147
    v_cvt_pk_bf16_f32 v152, v152, v153
    v_cvt_pk_bf16_f32 v153, v154, v155
    v_cvt_pk_bf16_f32 v154, v156, v157
    v_cvt_pk_bf16_f32 v155, v158, v159
    v_accvgpr_write_b32 a188, v152
    v_accvgpr_write_b32 a189, v153
    v_accvgpr_write_b32 a190, v154
    v_accvgpr_write_b32 a191, v155
    v_cvt_pk_bf16_f32 v160, v160, v161
    v_cvt_pk_bf16_f32 v161, v162, v163
    v_cvt_pk_bf16_f32 v162, v164, v165
    v_cvt_pk_bf16_f32 v163, v166, v167
    v_accvgpr_write_b32 a192, v160
    v_accvgpr_write_b32 a193, v161
    v_accvgpr_write_b32 a194, v162
    v_accvgpr_write_b32 a195, v163
    v_cvt_pk_bf16_f32 v168, v168, v169
    v_cvt_pk_bf16_f32 v169, v170, v171
    v_cvt_pk_bf16_f32 v170, v172, v173
    v_cvt_pk_bf16_f32 v171, v174, v175
    v_accvgpr_write_b32 a196, v168
    v_accvgpr_write_b32 a197, v169
    v_accvgpr_write_b32 a198, v170
    v_accvgpr_write_b32 a199, v171
    v_cvt_pk_bf16_f32 v176, v176, v177
    v_cvt_pk_bf16_f32 v177, v178, v179
    v_cvt_pk_bf16_f32 v178, v180, v181
    v_cvt_pk_bf16_f32 v179, v182, v183
    v_accvgpr_write_b32 a200, v176
    v_accvgpr_write_b32 a201, v177
    v_accvgpr_write_b32 a202, v178
    v_accvgpr_write_b32 a203, v179
    v_cvt_pk_bf16_f32 v184, v184, v185
    v_cvt_pk_bf16_f32 v185, v186, v187
    v_cvt_pk_bf16_f32 v186, v188, v189
    v_cvt_pk_bf16_f32 v187, v190, v191
    v_accvgpr_write_b32 a204, v184
    v_accvgpr_write_b32 a205, v185
    v_accvgpr_write_b32 a206, v186
    v_accvgpr_write_b32 a207, v187
    v_cvt_pk_bf16_f32 v192, v192, v193
    v_cvt_pk_bf16_f32 v193, v194, v195
    v_cvt_pk_bf16_f32 v194, v196, v197
    v_cvt_pk_bf16_f32 v195, v198, v199
    v_accvgpr_write_b32 a208, v192
    v_accvgpr_write_b32 a209, v193
    v_accvgpr_write_b32 a210, v194
    v_accvgpr_write_b32 a211, v195
    v_cvt_pk_bf16_f32 v200, v200, v201
    v_cvt_pk_bf16_f32 v201, v202, v203
    v_cvt_pk_bf16_f32 v202, v204, v205
    v_cvt_pk_bf16_f32 v203, v206, v207
    v_accvgpr_write_b32 a212, v200
    v_accvgpr_write_b32 a213, v201
    v_accvgpr_write_b32 a214, v202
    v_accvgpr_write_b32 a215, v203
    v_cvt_pk_bf16_f32 v208, v208, v209
    v_cvt_pk_bf16_f32 v209, v210, v211
    v_cvt_pk_bf16_f32 v210, v212, v213
    v_cvt_pk_bf16_f32 v211, v214, v215
    v_accvgpr_write_b32 a216, v208
    v_accvgpr_write_b32 a217, v209
    v_accvgpr_write_b32 a218, v210
    v_accvgpr_write_b32 a219, v211
    v_cvt_pk_bf16_f32 v216, v216, v217
    v_cvt_pk_bf16_f32 v217, v218, v219
    v_cvt_pk_bf16_f32 v218, v220, v221
    v_cvt_pk_bf16_f32 v219, v222, v223
    v_accvgpr_write_b32 a220, v216
    v_accvgpr_write_b32 a221, v217
    v_accvgpr_write_b32 a222, v218
    v_accvgpr_write_b32 a223, v219
    v_cvt_pk_bf16_f32 v224, v224, v225
    v_cvt_pk_bf16_f32 v225, v226, v227
    v_cvt_pk_bf16_f32 v226, v228, v229
    v_cvt_pk_bf16_f32 v227, v230, v231
    v_accvgpr_write_b32 a224, v224
    v_accvgpr_write_b32 a225, v225
    v_accvgpr_write_b32 a226, v226
    v_accvgpr_write_b32 a227, v227
    v_cvt_pk_bf16_f32 v232, v232, v233
    v_cvt_pk_bf16_f32 v233, v234, v235
    v_cvt_pk_bf16_f32 v234, v236, v237
    v_cvt_pk_bf16_f32 v235, v238, v239
    v_accvgpr_write_b32 a228, v232
    v_accvgpr_write_b32 a229, v233
    v_accvgpr_write_b32 a230, v234
    v_accvgpr_write_b32 a231, v235
    v_cvt_pk_bf16_f32 v240, v240, v241
    v_cvt_pk_bf16_f32 v241, v242, v243
    v_cvt_pk_bf16_f32 v242, v244, v245
    v_cvt_pk_bf16_f32 v243, v246, v247
    v_accvgpr_write_b32 a232, v240
    v_accvgpr_write_b32 a233, v241
    v_accvgpr_write_b32 a234, v242
    v_accvgpr_write_b32 a235, v243
    v_cvt_pk_bf16_f32 v248, v248, v249
    v_cvt_pk_bf16_f32 v249, v250, v251
    v_cvt_pk_bf16_f32 v250, v252, v253
    v_cvt_pk_bf16_f32 v251, v254, v255
    v_accvgpr_write_b32 a236, v248
    v_accvgpr_write_b32 a237, v249
    v_accvgpr_write_b32 a238, v250
    v_accvgpr_write_b32 a239, v251
    v_accvgpr_read_b32 v24, a96
    v_accvgpr_read_b32 v25, a97
    v_accvgpr_read_b32 v26, a98
    v_accvgpr_read_b32 v27, a99
    v_accvgpr_read_b32 v28, a100
    v_accvgpr_read_b32 v29, a101
    v_accvgpr_read_b32 v30, a102
    v_accvgpr_read_b32 v31, a103
    v_cvt_pk_bf16_f32 v24, v24, v25
    v_cvt_pk_bf16_f32 v25, v26, v27
    v_cvt_pk_bf16_f32 v26, v28, v29
    v_cvt_pk_bf16_f32 v27, v30, v31
    v_accvgpr_write_b32 a240, v24
    v_accvgpr_write_b32 a241, v25
    v_accvgpr_write_b32 a242, v26
    v_accvgpr_write_b32 a243, v27
    v_accvgpr_read_b32 v24, a104
    v_accvgpr_read_b32 v25, a105
    v_accvgpr_read_b32 v26, a106
    v_accvgpr_read_b32 v27, a107
    v_accvgpr_read_b32 v28, a108
    v_accvgpr_read_b32 v29, a109
    v_accvgpr_read_b32 v30, a110
    v_accvgpr_read_b32 v31, a111
    v_cvt_pk_bf16_f32 v24, v24, v25
    v_cvt_pk_bf16_f32 v25, v26, v27
    v_cvt_pk_bf16_f32 v26, v28, v29
    v_cvt_pk_bf16_f32 v27, v30, v31
    v_accvgpr_write_b32 a244, v24
    v_accvgpr_write_b32 a245, v25
    v_accvgpr_write_b32 a246, v26
    v_accvgpr_write_b32 a247, v27
    v_accvgpr_read_b32 v24, a112
    v_accvgpr_read_b32 v25, a113
    v_accvgpr_read_b32 v26, a114
    v_accvgpr_read_b32 v27, a115
    v_accvgpr_read_b32 v28, a116
    v_accvgpr_read_b32 v29, a117
    v_accvgpr_read_b32 v30, a118
    v_accvgpr_read_b32 v31, a119
    v_cvt_pk_bf16_f32 v24, v24, v25
    v_cvt_pk_bf16_f32 v25, v26, v27
    v_cvt_pk_bf16_f32 v26, v28, v29
    v_cvt_pk_bf16_f32 v27, v30, v31
    v_accvgpr_write_b32 a248, v24
    v_accvgpr_write_b32 a249, v25
    v_accvgpr_write_b32 a250, v26
    v_accvgpr_write_b32 a251, v27
    v_accvgpr_read_b32 v24, a120
    v_accvgpr_read_b32 v25, a121
    v_accvgpr_read_b32 v26, a122
    v_accvgpr_read_b32 v27, a123
    v_accvgpr_read_b32 v28, a124
    v_accvgpr_read_b32 v29, a125
    v_accvgpr_read_b32 v30, a126
    v_accvgpr_read_b32 v31, a127
    v_cvt_pk_bf16_f32 v24, v24, v25
    v_cvt_pk_bf16_f32 v25, v26, v27
    v_cvt_pk_bf16_f32 v26, v28, v29
    v_cvt_pk_bf16_f32 v27, v30, v31
    v_accvgpr_write_b32 a252, v24
    v_accvgpr_write_b32 a253, v25
    v_accvgpr_write_b32 a254, v26
    v_accvgpr_write_b32 a255, v27
    s_setpc_b64 s[20:21]
m_epf22:
    s_nop 7
    s_cmp_eq_u32 s97, 0
    s_cbranch_scc1 m_noscale61
    s_mov_b32 s91, s98
    s_mov_b32 s92, s97
    s_mov_b32 s93, s97
    s_mov_b32 s90, s91
    v_pk_mul_f32 v[32:33], v[32:33], s[92:93]
    v_pk_mul_f32 v[34:35], v[34:35], s[92:93]
    v_pk_mul_f32 v[36:37], v[36:37], s[92:93]
    v_pk_mul_f32 v[38:39], v[38:39], s[92:93]
    v_cvt_pk_bf16_f32 v32, v32, v33
    v_cvt_pk_bf16_f32 v33, v34, v35
    v_cvt_pk_bf16_f32 v34, v36, v37
    v_cvt_pk_bf16_f32 v35, v38, v39
    buffer_store_dwordx4 v[32:35], v2, s[8:11], s90 offen sc1
    s_add_u32 s90, s90, s100
    v_pk_mul_f32 v[40:41], v[40:41], s[92:93]
    v_pk_mul_f32 v[42:43], v[42:43], s[92:93]
    v_pk_mul_f32 v[44:45], v[44:45], s[92:93]
    v_pk_mul_f32 v[46:47], v[46:47], s[92:93]
    v_cvt_pk_bf16_f32 v40, v40, v41
    v_cvt_pk_bf16_f32 v41, v42, v43
    v_cvt_pk_bf16_f32 v42, v44, v45
    v_cvt_pk_bf16_f32 v43, v46, v47
    buffer_store_dwordx4 v[40:43], v2, s[8:11], s90 offen sc1
    s_add_u32 s90, s90, s100
    v_pk_mul_f32 v[48:49], v[48:49], s[92:93]
    v_pk_mul_f32 v[50:51], v[50:51], s[92:93]
    v_pk_mul_f32 v[52:53], v[52:53], s[92:93]
    v_pk_mul_f32 v[54:55], v[54:55], s[92:93]
    v_cvt_pk_bf16_f32 v48, v48, v49
    v_cvt_pk_bf16_f32 v49, v50, v51
    v_cvt_pk_bf16_f32 v50, v52, v53
    v_cvt_pk_bf16_f32 v51, v54, v55
    buffer_store_dwordx4 v[48:51], v2, s[8:11], s90 offen sc1
    s_add_u32 s90, s90, s100
    v_pk_mul_f32 v[56:57], v[56:57], s[92:93]
    v_pk_mul_f32 v[58:59], v[58:59], s[92:93]
    v_pk_mul_f32 v[60:61], v[60:61], s[92:93]
    v_pk_mul_f32 v[62:63], v[62:63], s[92:93]
    v_cvt_pk_bf16_f32 v56, v56, v57
    v_cvt_pk_bf16_f32 v57, v58, v59
    v_cvt_pk_bf16_f32 v58, v60, v61
    v_cvt_pk_bf16_f32 v59, v62, v63
    buffer_store_dwordx4 v[56:59], v2, s[8:11], s90 offen sc1
    s_add_u32 s90, s90, s100
    v_pk_mul_f32 v[64:65], v[64:65], s[92:93]
    v_pk_mul_f32 v[66:67], v[66:67], s[92:93]
    v_pk_mul_f32 v[68:69], v[68:69], s[92:93]
    v_pk_mul_f32 v[70:71], v[70:71], s[92:93]
    v_cvt_pk_bf16_f32 v64, v64, v65
    v_cvt_pk_bf16_f32 v65, v66, v67
    v_cvt_pk_bf16_f32 v66, v68, v69
    v_cvt_pk_bf16_f32 v67, v70, v71
    buffer_store_dwordx4 v[64:67], v2, s[8:11], s90 offen sc1
    s_add_u32 s90, s90, s100
    v_pk_mul_f32 v[72:73], v[72:73], s[92:93]
    v_pk_mul_f32 v[74:75], v[74:75], s[92:93]
    v_pk_mul_f32 v[76:77], v[76:77], s[92:93]
    v_pk_mul_f32 v[78:79], v[78:79], s[92:93]
    v_cvt_pk_bf16_f32 v72, v72, v73
    v_cvt_pk_bf16_f32 v73, v74, v75
    v_cvt_pk_bf16_f32 v74, v76, v77
    v_cvt_pk_bf16_f32 v75, v78, v79
    buffer_store_dwordx4 v[72:75], v2, s[8:11], s90 offen sc1
    s_add_u32 s90, s90, s100
    v_pk_mul_f32 v[80:81], v[80:81], s[92:93]
    v_pk_mul_f32 v[82:83], v[82:83], s[92:93]
    v_pk_mul_f32 v[84:85], v[84:85], s[92:93]
    v_pk_mul_f32 v[86:87], v[86:87], s[92:93]
    v_cvt_pk_bf16_f32 v80, v80, v81
    v_cvt_pk_bf16_f32 v81, v82, v83
    v_cvt_pk_bf16_f32 v82, v84, v85
    v_cvt_pk_bf16_f32 v83, v86, v87
    buffer_store_dwordx4 v[80:83], v2, s[8:11], s90 offen sc1
    s_add_u32 s90, s90, s100
    v_pk_mul_f32 v[88:89], v[88:89], s[92:93]
    v_pk_mul_f32 v[90:91], v[90:91], s[92:93]
    v_pk_mul_f32 v[92:93], v[92:93], s[92:93]
    v_pk_mul_f32 v[94:95], v[94:95], s[92:93]
    v_cvt_pk_bf16_f32 v88, v88, v89
    v_cvt_pk_bf16_f32 v89, v90, v91
    v_cvt_pk_bf16_f32 v90, v92, v93
    v_cvt_pk_bf16_f32 v91, v94, v95
    buffer_store_dwordx4 v[88:91], v2, s[8:11], s90 offen sc1
    s_add_u32 s90, s90, s100
    s_add_u32 s91, s91, s99
    s_mov_b32 s90, s91
    v_pk_mul_f32 v[96:97], v[96:97], s[92:93]
    v_pk_mul_f32 v[98:99], v[98:99], s[92:93]
    v_pk_mul_f32 v[100:101], v[100:101], s[92:93]
    v_pk_mul_f32 v[102:103], v[102:103], s[92:93]
    v_cvt_pk_bf16_f32 v96, v96, v97
    v_cvt_pk_bf16_f32 v97, v98, v99
    v_cvt_pk_bf16_f32 v98, v100, v101
    v_cvt_pk_bf16_f32 v99, v102, v103
    buffer_store_dwordx4 v[96:99], v2, s[8:11], s90 offen sc1
    s_add_u32 s90, s90, s100
    v_pk_mul_f32 v[104:105], v[104:105], s[92:93]
    v_pk_mul_f32 v[106:107], v[106:107], s[92:93]
    v_pk_mul_f32 v[108:109], v[108:109], s[92:93]
    v_pk_mul_f32 v[110:111], v[110:111], s[92:93]
    v_cvt_pk_bf16_f32 v104, v104, v105
    v_cvt_pk_bf16_f32 v105, v106, v107
    v_cvt_pk_bf16_f32 v106, v108, v109
    v_cvt_pk_bf16_f32 v107, v110, v111
    buffer_store_dwordx4 v[104:107], v2, s[8:11], s90 offen sc1
    s_add_u32 s90, s90, s100
    v_pk_mul_f32 v[112:113], v[112:113], s[92:93]
    v_pk_mul_f32 v[114:115], v[114:115], s[92:93]
    v_pk_mul_f32 v[116:117], v[116:117], s[92:93]
    v_pk_mul_f32 v[118:119], v[118:119], s[92:93]
    v_cvt_pk_bf16_f32 v112, v112, v113
    v_cvt_pk_bf16_f32 v113, v114, v115
    v_cvt_pk_bf16_f32 v114, v116, v117
    v_cvt_pk_bf16_f32 v115, v118, v119
    buffer_store_dwordx4 v[112:115], v2, s[8:11], s90 offen sc1
    s_add_u32 s90, s90, s100
    v_pk_mul_f32 v[120:121], v[120:121], s[92:93]
    v_pk_mul_f32 v[122:123], v[122:123], s[92:93]
    v_pk_mul_f32 v[124:125], v[124:125], s[92:93]
    v_pk_mul_f32 v[126:127], v[126:127], s[92:93]
    v_cvt_pk_bf16_f32 v120, v120, v121
    v_cvt_pk_bf16_f32 v121, v122, v123
    v_cvt_pk_bf16_f32 v122, v124, v125
    v_cvt_pk_bf16_f32 v123, v126, v127
    buffer_store_dwordx4 v[120:123], v2, s[8:11], s90 offen sc1
    s_add_u32 s90, s90, s100
    v_pk_mul_f32 v[128:129], v[128:129], s[92:93]
    v_pk_mul_f32 v[130:131], v[130:131], s[92:93]
    v_pk_mul_f32 v[132:133], v[132:133], s[92:93]
    v_pk_mul_f32 v[134:135], v[134:135], s[92:93]
    v_cvt_pk_bf16_f32 v128, v128, v129
    v_cvt_pk_bf16_f32 v129, v130, v131
    v_cvt_pk_bf16_f32 v130, v132, v133
    v_cvt_pk_bf16_f32 v131, v134, v135
    buffer_store_dwordx4 v[128:131], v2, s[8:11], s90 offen sc1
    s_add_u32 s90, s90, s100
    v_pk_mul_f32 v[136:137], v[136:137], s[92:93]
    v_pk_mul_f32 v[138:139], v[138:139], s[92:93]
    v_pk_mul_f32 v[140:141], v[140:141], s[92:93]
    v_pk_mul_f32 v[142:143], v[142:143], s[92:93]
    v_cvt_pk_bf16_f32 v136, v136, v137
    v_cvt_pk_bf16_f32 v137, v138, v139
    v_cvt_pk_bf16_f32 v138, v140, v141
    v_cvt_pk_bf16_f32 v139, v142, v143
    buffer_store_dwordx4 v[136:139], v2, s[8:11], s90 offen sc1
    s_add_u32 s90, s90, s100
    v_pk_mul_f32 v[144:145], v[144:145], s[92:93]
    v_pk_mul_f32 v[146:147], v[146:147], s[92:93]
    v_pk_mul_f32 v[148:149], v[148:149], s[92:93]
    v_pk_mul_f32 v[150:151], v[150:151], s[92:93]
    v_cvt_pk_bf16_f32 v144, v144, v145
    v_cvt_pk_bf16_f32 v145, v146, v147
    v_cvt_pk_bf16_f32 v146, v148, v149
    v_cvt_pk_bf16_f32 v147, v150, v151
    buffer_store_dwordx4 v[144:147], v2, s[8:11], s90 offen sc1
    s_add_u32 s90, s90, s100
    v_pk_mul_f32 v[152:153], v[152:153], s[92:93]
    v_pk_mul_f32 v[154:155], v[154:155], s[92:93]
    v_pk_mul_f32 v[156:157], v[156:157], s[92:93]
    v_pk_mul_f32 v[158:159], v[158:159], s[92:93]
    v_cvt_pk_bf16_f32 v152, v152, v153
    v_cvt_pk_bf16_f32 v153, v154, v155
    v_cvt_pk_bf16_f32 v154, v156, v157
    v_cvt_pk_bf16_f32 v155, v158, v159
    buffer_store_dwordx4 v[152:155], v2, s[8:11], s90 offen sc1
    s_add_u32 s90, s90, s100
    s_add_u32 s91, s91, s99
    s_mov_b32 s90, s91
    v_pk_mul_f32 v[160:161], v[160:161], s[92:93]
    v_pk_mul_f32 v[162:163], v[162:163], s[92:93]
    v_pk_mul_f32 v[164:165], v[164:165], s[92:93]
    v_pk_mul_f32 v[166:167], v[166:167], s[92:93]
    v_cvt_pk_bf16_f32 v160, v160, v161
    v_cvt_pk_bf16_f32 v161, v162, v163
    v_cvt_pk_bf16_f32 v162, v164, v165
    v_cvt_pk_bf16_f32 v163, v166, v167
    buffer_store_dwordx4 v[160:163], v2, s[8:11], s90 offen sc1
    s_add_u32 s90, s90, s100
    v_pk_mul_f32 v[168:169], v[168:169], s[92:93]
    v_pk_mul_f32 v[170:171], v[170:171], s[92:93]
    v_pk_mul_f32 v[172:173], v[172:173], s[92:93]
    v_pk_mul_f32 v[174:175], v[174:175], s[92:93]
    v_cvt_pk_bf16_f32 v168, v168, v169
    v_cvt_pk_bf16_f32 v169, v170, v171
    v_cvt_pk_bf16_f32 v170, v172, v173
    v_cvt_pk_bf16_f32 v171, v174, v175
    buffer_store_dwordx4 v[168:171], v2, s[8:11], s90 offen sc1
    s_add_u32 s90, s90, s100
    v_pk_mul_f32 v[176:177], v[176:177], s[92:93]
    v_pk_mul_f32 v[178:179], v[178:179], s[92:93]
    v_pk_mul_f32 v[180:181], v[180:181], s[92:93]
    v_pk_mul_f32 v[182:183], v[182:183], s[92:93]
    v_cvt_pk_bf16_f32 v176, v176, v177
    v_cvt_pk_bf16_f32 v177, v178, v179
    v_cvt_pk_bf16_f32 v178, v180, v181
    v_cvt_pk_bf16_f32 v179, v182, v183
    buffer_store_dwordx4 v[176:179], v2, s[8:11], s90 offen sc1
    s_add_u32 s90, s90, s100
    v_pk_mul_f32 v[184:185], v[184:185], s[92:93]
    v_pk_mul_f32 v[186:187], v[186:187], s[92:93]
    v_pk_mul_f32 v[188:189], v[188:189], s[92:93]
    v_pk_mul_f32 v[190:191], v[190:191], s[92:93]
    v_cvt_pk_bf16_f32 v184, v184, v185
    v_cvt_pk_bf16_f32 v185, v186, v187
    v_cvt_pk_bf16_f32 v186, v188, v189
    v_cvt_pk_bf16_f32 v187, v190, v191
    buffer_store_dwordx4 v[184:187], v2, s[8:11], s90 offen sc1
    s_add_u32 s90, s90, s100
    v_pk_mul_f32 v[192:193], v[192:193], s[92:93]
    v_pk_mul_f32 v[194:195], v[194:195], s[92:93]
    v_pk_mul_f32 v[196:197], v[196:197], s[92:93]
    v_pk_mul_f32 v[198:199], v[198:199], s[92:93]
    v_cvt_pk_bf16_f32 v192, v192, v193
    v_cvt_pk_bf16_f32 v193, v194, v195
    v_cvt_pk_bf16_f32 v194, v196, v197
    v_cvt_pk_bf16_f32 v195, v198, v199
    buffer_store_dwordx4 v[192:195], v2, s[8:11], s90 offen sc1
    s_add_u32 s90, s90, s100
    v_pk_mul_f32 v[200:201], v[200:201], s[92:93]
    v_pk_mul_f32 v[202:203], v[202:203], s[92:93]
    v_pk_mul_f32 v[204:205], v[204:205], s[92:93]
    v_pk_mul_f32 v[206:207], v[206:207], s[92:93]
    v_cvt_pk_bf16_f32 v200, v200, v201
    v_cvt_pk_bf16_f32 v201, v202, v203
    v_cvt_pk_bf16_f32 v202, v204, v205
    v_cvt_pk_bf16_f32 v203, v206, v207
    buffer_store_dwordx4 v[200:203], v2, s[8:11], s90 offen sc1
    s_add_u32 s90, s90, s100
    v_pk_mul_f32 v[208:209], v[208:209], s[92:93]
    v_pk_mul_f32 v[210:211], v[210:211], s[92:93]
    v_pk_mul_f32 v[212:213], v[212:213], s[92:93]
    v_pk_mul_f32 v[214:215], v[214:215], s[92:93]
    v_cvt_pk_bf16_f32 v208, v208, v209
    v_cvt_pk_bf16_f32 v209, v210, v211
    v_cvt_pk_bf16_f32 v210, v212, v213
    v_cvt_pk_bf16_f32 v211, v214, v215
    buffer_store_dwordx4 v[208:211], v2, s[8:11], s90 offen sc1
    s_add_u32 s90, s90, s100
    v_pk_mul_f32 v[216:217], v[216:217], s[92:93]
    v_pk_mul_f32 v[218:219], v[218:219], s[92:93]
    v_pk_mul_f32 v[220:221], v[220:221], s[92:93]
    v_pk_mul_f32 v[222:223], v[222:223], s[92:93]
    v_cvt_pk_bf16_f32 v216, v216, v217
    v_cvt_pk_bf16_f32 v217, v218, v219
    v_cvt_pk_bf16_f32 v218, v220, v221
    v_cvt_pk_bf16_f32 v219, v222, v223
    buffer_store_dwordx4 v[216:219], v2, s[8:11], s90 offen sc1
    s_add_u32 s90, s90, s100
    s_add_u32 s91, s91, s99
    s_mov_b32 s90, s91
    v_pk_mul_f32 v[224:225], v[224:225], s[92:93]
    v_pk_mul_f32 v[226:227], v[226:227], s[92:93]
    v_pk_mul_f32 v[228:229], v[228:229], s[92:93]
    v_pk_mul_f32 v[230:231], v[230:231], s[92:93]
    v_cvt_pk_bf16_f32 v224, v224, v225
    v_cvt_pk_bf16_f32 v225, v226, v227
    v_cvt_pk_bf16_f32 v226, v228, v229
    v_cvt_pk_bf16_f32 v227, v230, v231
    buffer_store_dwordx4 v[224:227], v2, s[8:11], s90 offen sc1
    s_add_u32 s90, s90, s100
    v_pk_mul_f32 v[232:233], v[232:233], s[92:93]
    v_pk_mul_f32 v[234:235], v[234:235], s[92:93]
    v_pk_mul_f32 v[236:237], v[236:237], s[92:93]
    v_pk_mul_f32 v[238:239], v[238:239], s[92:93]
    v_cvt_pk_bf16_f32 v232, v232, v233
    v_cvt_pk_bf16_f32 v233, v234, v235
    v_cvt_pk_bf16_f32 v234, v236, v237
    v_cvt_pk_bf16_f32 v235, v238, v239
    buffer_store_dwordx4 v[232:235], v2, s[8:11], s90 offen sc1
    s_add_u32 s90, s90, s100
    v_pk_mul_f32 v[240:241], v[240:241], s[92:93]
    v_pk_mul_f32 v[242:243], v[242:243], s[92:93]
    v_pk_mul_f32 v[244:245], v[244:245], s[92:93]
    v_pk_mul_f32 v[246:247], v[246:247], s[92:93]
    v_cvt_pk_bf16_f32 v240, v240, v241
    v_cvt_pk_bf16_f32 v241, v242, v243
    v_cvt_pk_bf16_f32 v242, v244, v245
    v_cvt_pk_bf16_f32 v243, v246, v247
    buffer_store_dwordx4 v[240:243], v2, s[8:11], s90 offen sc1
    s_add_u32 s90, s90, s100
    v_pk_mul_f32 v[248:249], v[248:249], s[92:93]
    v_pk_mul_f32 v[250:251], v[250:251], s[92:93]
    v_pk_mul_f32 v[252:253], v[252:253], s[92:93]
    v_pk_mul_f32 v[254:255], v[254:255], s[92:93]
    v_cvt_pk_bf16_f32 v248, v248, v249
    v_cvt_pk_bf16_f32 v249, v250, v251
    v_cvt_pk_bf16_f32 v250, v252, v253
    v_cvt_pk_bf16_f32 v251, v254, v255
    buffer_store_dwordx4 v[248:251], v2, s[8:11], s90 offen sc1
    s_add_u32 s90, s90, s100
    v_accvgpr_read_b32 v24, a96
    v_accvgpr_read_b32 v25, a97
    v_accvgpr_read_b32 v26, a98
    v_accvgpr_read_b32 v27, a99
    v_accvgpr_read_b32 v28, a100
    v_accvgpr_read_b32 v29, a101
    v_accvgpr_read_b32 v30, a102
    v_accvgpr_read_b32 v31, a103
    v_pk_mul_f32 v[24:25], v[24:25], s[92:93]
    v_pk_mul_f32 v[26:27], v[26:27], s[92:93]
    v_pk_mul_f32 v[28:29], v[28:29], s[92:93]
    v_pk_mul_f32 v[30:31], v[30:31], s[92:93]
    v_cvt_pk_bf16_f32 v24, v24, v25
    v_cvt_pk_bf16_f32 v25, v26, v27
    v_cvt_pk_bf16_f32 v26, v28, v29
    v_cvt_pk_bf16_f32 v27, v30, v31
    buffer_store_dwordx4 v[24:27], v2, s[8:11], s90 offen sc1
    s_add_u32 s90, s90, s100
    s_nop 1
    v_accvgpr_read_b32 v24, a104
    v_accvgpr_read_b32 v25, a105
    v_accvgpr_read_b32 v26, a106
    v_accvgpr_read_b32 v27, a107
    v_accvgpr_read_b32 v28, a108
    v_accvgpr_read_b32 v29, a109
    v_accvgpr_read_b32 v30, a110
    v_accvgpr_read_b32 v31, a111
    v_pk_mul_f32 v[24:25], v[24:25], s[92:93]
    v_pk_mul_f32 v[26:27], v[26:27], s[92:93]
    v_pk_mul_f32 v[28:29], v[28:29], s[92:93]
    v_pk_mul_f32 v[30:31], v[30:31], s[92:93]
    v_cvt_pk_bf16_f32 v24, v24, v25
    v_cvt_pk_bf16_f32 v25, v26, v27
    v_cvt_pk_bf16_f32 v26, v28, v29
    v_cvt_pk_bf16_f32 v27, v30, v31
    buffer_store_dwordx4 v[24:27], v2, s[8:11], s90 offen sc1
    s_add_u32 s90, s90, s100
    s_nop 1
    v_accvgpr_read_b32 v24, a112
    v_accvgpr_read_b32 v25, a113
    v_accvgpr_read_b32 v26, a114
    v_accvgpr_read_b32 v27, a115
    v_accvgpr_read_b32 v28, a116
    v_accvgpr_read_b32 v29, a117
    v_accvgpr_read_b32 v30, a118
    v_accvgpr_read_b32 v31, a119
    v_pk_mul_f32 v[24:25], v[24:25], s[92:93]
    v_pk_mul_f32 v[26:27], v[26:27], s[92:93]
    v_pk_mul_f32 v[28:29], v[28:29], s[92:93]
    v_pk_mul_f32 v[30:31], v[30:31], s[92:93]
    v_cvt_pk_bf16_f32 v24, v24, v25
    v_cvt_pk_bf16_f32 v25, v26, v27
    v_cvt_pk_bf16_f32 v26, v28, v29
    v_cvt_pk_bf16_f32 v27, v30, v31
    buffer_store_dwordx4 v[24:27], v2, s[8:11], s90 offen sc1
    s_add_u32 s90, s90, s100
    s_nop 1
    v_accvgpr_read_b32 v24, a120
    v_accvgpr_read_b32 v25, a121
    v_accvgpr_read_b32 v26, a122
    v_accvgpr_read_b32 v27, a123
    v_accvgpr_read_b32 v28, a124
    v_accvgpr_read_b32 v29, a125
    v_accvgpr_read_b32 v30, a126
    v_accvgpr_read_b32 v31, a127
    v_pk_mul_f32 v[24:25], v[24:25], s[92:93]
    v_pk_mul_f32 v[26:27], v[26:27], s[92:93]
    v_pk_mul_f32 v[28:29], v[28:29], s[92:93]
    v_pk_mul_f32 v[30:31], v[30:31], s[92:93]
    v_cvt_pk_bf16_f32 v24, v24, v25
    v_cvt_pk_bf16_f32 v25, v26, v27
    v_cvt_pk_bf16_f32 v26, v28, v29
    v_cvt_pk_bf16_f32 v27, v30, v31
    buffer_store_dwordx4 v[24:27], v2, s[8:11], s90 offen sc1
    s_add_u32 s90, s90, s100
    s_nop 1
    s_add_u32 s91, s91, s99
    s_setpc_b64 s[20:21]
m_noscale61:
    s_mov_b32 s91, s98
    s_mov_b32 s92, s97
    s_mov_b32 s93, s97
    s_mov_b32 s90, s91
    v_cvt_pk_bf16_f32 v32, v32, v33
    v_cvt_pk_bf16_f32 v33, v34, v35
    v_cvt_pk_bf16_f32 v34, v36, v37
    v_cvt_pk_bf16_f32 v35, v38, v39
    buffer_store_dwordx4 v[32:35], v2, s[8:11], s90 offen sc1
    s_add_u32 s90, s90, s100
    v_cvt_pk_bf16_f32 v40, v40, v41
    v_cvt_pk_bf16_f32 v41, v42, v43
    v_cvt_pk_bf16_f32 v42, v44, v45
    v_cvt_pk_bf16_f32 v43, v46, v47
    buffer_store_dwordx4 v[40:43], v2, s[8:11], s90 offen sc1
    s_add_u32 s90, s90, s100
    v_cvt_pk_bf16_f32 v48, v48, v49
    v_cvt_pk_bf16_f32 v49, v50, v51
    v_cvt_pk_bf16_f32 v50, v52, v53
    v_cvt_pk_bf16_f32 v51, v54, v55
    buffer_store_dwordx4 v[48:51], v2, s[8:11], s90 offen sc1
    s_add_u32 s90, s90, s100
    v_cvt_pk_bf16_f32 v56, v56, v57
    v_cvt_pk_bf16_f32 v57, v58, v59
    v_cvt_pk_bf16_f32 v58, v60, v61
    v_cvt_pk_bf16_f32 v59, v62, v63
    buffer_store_dwordx4 v[56:59], v2, s[8:11], s90 offen sc1
    s_add_u32 s90, s90, s100
    v_cvt_pk_bf16_f32 v64, v64, v65
    v_cvt_pk_bf16_f32 v65, v66, v67
    v_cvt_pk_bf16_f32 v66, v68, v69
    v_cvt_pk_bf16_f32 v67, v70, v71
    buffer_store_dwordx4 v[64:67], v2, s[8:11], s90 offen sc1
    s_add_u32 s90, s90, s100
    v_cvt_pk_bf16_f32 v72, v72, v73
    v_cvt_pk_bf16_f32 v73, v74, v75
    v_cvt_pk_bf16_f32 v74, v76, v77
    v_cvt_pk_bf16_f32 v75, v78, v79
    buffer_store_dwordx4 v[72:75], v2, s[8:11], s90 offen sc1
    s_add_u32 s90, s90, s100
    v_cvt_pk_bf16_f32 v80, v80, v81
    v_cvt_pk_bf16_f32 v81, v82, v83
    v_cvt_pk_bf16_f32 v82, v84, v85
    v_cvt_pk_bf16_f32 v83, v86, v87
    buffer_store_dwordx4 v[80:83], v2, s[8:11], s90 offen sc1
    s_add_u32 s90, s90, s100
    v_cvt_pk_bf16_f32 v88, v88, v89
    v_cvt_pk_bf16_f32 v89, v90, v91
    v_cvt_pk_bf16_f32 v90, v92, v93
    v_cvt_pk_bf16_f32 v91, v94, v95
    buffer_store_dwordx4 v[88:91], v2, s[8:11], s90 offen sc1
    s_add_u32 s90, s90, s100
    s_add_u32 s91, s91, s99
    s_mov_b32 s90, s91
    v_cvt_pk_bf16_f32 v96, v96, v97
    v_cvt_pk_bf16_f32 v97, v98, v99
    v_cvt_pk_bf16_f32 v98, v100, v101
    v_cvt_pk_bf16_f32 v99, v102, v103
    buffer_store_dwordx4 v[96:99], v2, s[8:11], s90 offen sc1
    s_add_u32 s90, s90, s100
    v_cvt_pk_bf16_f32 v104, v104, v105
    v_cvt_pk_bf16_f32 v105, v106, v107
    v_cvt_pk_bf16_f32 v106, v108, v109
    v_cvt_pk_bf16_f32 v107, v110, v111
    buffer_store_dwordx4 v[104:107], v2, s[8:11], s90 offen sc1
    s_add_u32 s90, s90, s100
    v_cvt_pk_bf16_f32 v112, v112, v113
    v_cvt_pk_bf16_f32 v113, v114, v115
    v_cvt_pk_bf16_f32 v114, v116, v117
    v_cvt_pk_bf16_f32 v115, v118, v119
    buffer_store_dwordx4 v[112:115], v2, s[8:11], s90 offen sc1
    s_add_u32 s90, s90, s100
    v_cvt_pk_bf16_f32 v120, v120, v121
    v_cvt_pk_bf16_f32 v121, v122, v123
    v_cvt_pk_bf16_f32 v122, v124, v125
    v_cvt_pk_bf16_f32 v123, v126, v127
    buffer_store_dwordx4 v[120:123], v2, s[8:11], s90 offen sc1
    s_add_u32 s90, s90, s100
    v_cvt_pk_bf16_f32 v128, v128, v129
    v_cvt_pk_bf16_f32 v129, v130, v131
    v_cvt_pk_bf16_f32 v130, v132, v133
    v_cvt_pk_bf16_f32 v131, v134, v135
    buffer_store_dwordx4 v[128:131], v2, s[8:11], s90 offen sc1
    s_add_u32 s90, s90, s100
    v_cvt_pk_bf16_f32 v136, v136, v137
    v_cvt_pk_bf16_f32 v137, v138, v139
    v_cvt_pk_bf16_f32 v138, v140, v141
    v_cvt_pk_bf16_f32 v139, v142, v143
    buffer_store_dwordx4 v[136:139], v2, s[8:11], s90 offen sc1
    s_add_u32 s90, s90, s100
    v_cvt_pk_bf16_f32 v144, v144, v145
    v_cvt_pk_bf16_f32 v145, v146, v147
    v_cvt_pk_bf16_f32 v146, v148, v149
    v_cvt_pk_bf16_f32 v147, v150, v151
    buffer_store_dwordx4 v[144:147], v2, s[8:11], s90 offen sc1
    s_add_u32 s90, s90, s100
    v_cvt_pk_bf16_f32 v152, v152, v153
    v_cvt_pk_bf16_f32 v153, v154, v155
    v_cvt_pk_bf16_f32 v154, v156, v157
    v_cvt_pk_bf16_f32 v155, v158, v159
    buffer_store_dwordx4 v[152:155], v2, s[8:11], s90 offen sc1
    s_add_u32 s90, s90, s100
    s_add_u32 s91, s91, s99
    s_mov_b32 s90, s91
    v_cvt_pk_bf16_f32 v160, v160, v161
    v_cvt_pk_bf16_f32 v161, v162, v163
    v_cvt_pk_bf16_f32 v162, v164, v165
    v_cvt_pk_bf16_f32 v163, v166, v167
    buffer_store_dwordx4 v[160:163], v2, s[8:11], s90 offen sc1
    s_add_u32 s90, s90, s100
    v_cvt_pk_bf16_f32 v168, v168, v169
    v_cvt_pk_bf16_f32 v169, v170, v171
    v_cvt_pk_bf16_f32 v170, v172, v173
    v_cvt_pk_bf16_f32 v171, v174, v175
    buffer_store_dwordx4 v[168:171], v2, s[8:11], s90 offen sc1
    s_add_u32 s90, s90, s100
    v_cvt_pk_bf16_f32 v176, v176, v177
    v_cvt_pk_bf16_f32 v177, v178, v179
    v_cvt_pk_bf16_f32 v178, v180, v181
    v_cvt_pk_bf16_f32 v179, v182, v183
    buffer_store_dwordx4 v[176:179], v2, s[8:11], s90 offen sc1
    s_add_u32 s90, s90, s100
    v_cvt_pk_bf16_f32 v184, v184, v185
    v_cvt_pk_bf16_f32 v185, v186, v187
    v_cvt_pk_bf16_f32 v186, v188, v189
    v_cvt_pk_bf16_f32 v187, v190, v191
    buffer_store_dwordx4 v[184:187], v2, s[8:11], s90 offen sc1
    s_add_u32 s90, s90, s100
    v_cvt_pk_bf16_f32 v192, v192, v193
    v_cvt_pk_bf16_f32 v193, v194, v195
    v_cvt_pk_bf16_f32 v194, v196, v197
    v_cvt_pk_bf16_f32 v195, v198, v199
    buffer_store_dwordx4 v[192:195], v2, s[8:11], s90 offen sc1
    s_add_u32 s90, s90, s100
    v_cvt_pk_bf16_f32 v200, v200, v201
    v_cvt_pk_bf16_f32 v201, v202, v203
    v_cvt_pk_bf16_f32 v202, v204, v205
    v_cvt_pk_bf16_f32 v203, v206, v207
    buffer_store_dwordx4 v[200:203], v2, s[8:11], s90 offen sc1
    s_add_u32 s90, s90, s100
    v_cvt_pk_bf16_f32 v208, v208, v209
    v_cvt_pk_bf16_f32 v209, v210, v211
    v_cvt_pk_bf16_f32 v210, v212, v213
    v_cvt_pk_bf16_f32 v211, v214, v215
    buffer_store_dwordx4 v[208:211], v2, s[8:11], s90 offen sc1
    s_add_u32 s90, s90, s100
    v_cvt_pk_bf16_f32 v216, v216, v217
    v_cvt_pk_bf16_f32 v217, v218, v219
    v_cvt_pk_bf16_f32 v218, v220, v221
    v_cvt_pk_bf16_f32 v219, v222, v223
    buffer_store_dwordx4 v[216:219], v2, s[8:11], s90 offen sc1
    s_add_u32 s90, s90, s100
    s_add_u32 s91, s91, s99
    s_mov_b32 s90, s91
    v_cvt_pk_bf16_f32 v224, v224, v225
    v_cvt_pk_bf16_f32 v225, v226, v227
    v_cvt_pk_bf16_f32 v226, v228, v229
    v_cvt_pk_bf16_f32 v227, v230, v231
    buffer_store_dwordx4 v[224:227], v2, s[8:11], s90 offen sc1
    s_add_u32 s90, s90, s100
    v_cvt_pk_bf16_f32 v232, v232, v233
    v_cvt_pk_bf16_f32 v233, v234, v235
    v_cvt_pk_bf16_f32 v234, v236, v237
    v_cvt_pk_bf16_f32 v235, v238, v239
    buffer_store_dwordx4 v[232:235], v2, s[8:11], s90 offen sc1
    s_add_u32 s90, s90, s100
    v_cvt_pk_bf16_f32 v240, v240, v241
    v_cvt_pk_bf16_f32 v241, v242, v243
    v_cvt_pk_bf16_f32 v242, v244, v245
    v_cvt_pk_bf16_f32 v243, v246, v247
    buffer_store_dwordx4 v[240:243], v2, s[8:11], s90 offen sc1
    s_add_u32 s90, s90, s100
    v_cvt_pk_bf16_f32 v248, v248, v249
    v_cvt_pk_bf16_f32 v249, v250, v251
    v_cvt_pk_bf16_f32 v250, v252, v253
    v_cvt_pk_bf16_f32 v251, v254, v255
    buffer_store_dwordx4 v[248:251], v2, s[8:11], s90 offen sc1
    s_add_u32 s90, s90, s100
    v_accvgpr_read_b32 v24, a96
    v_accvgpr_read_b32 v25, a97
    v_accvgpr_read_b32 v26, a98
    v_accvgpr_read_b32 v27, a99
    v_accvgpr_read_b32 v28, a100
    v_accvgpr_read_b32 v29, a101
    v_accvgpr_read_b32 v30, a102
    v_accvgpr_read_b32 v31, a103
    v_cvt_pk_bf16_f32 v24, v24, v25
    v_cvt_pk_bf16_f32 v25, v26, v27
    v_cvt_pk_bf16_f32 v26, v28, v29
    v_cvt_pk_bf16_f32 v27, v30, v31
    buffer_store_dwordx4 v[24:27], v2, s[8:11], s90 offen sc1
    s_add_u32 s90, s90, s100
    s_nop 1
    v_accvgpr_read_b32 v24, a104
    v_accvgpr_read_b32 v25, a105
    v_accvgpr_read_b32 v26, a106
    v_accvgpr_read_b32 v27, a107
    v_accvgpr_read_b32 v28, a108
    v_accvgpr_read_b32 v29, a109
    v_accvgpr_read_b32 v30, a110
    v_accvgpr_read_b32 v31, a111
    v_cvt_pk_bf16_f32 v24, v24, v25
    v_cvt_pk_bf16_f32 v25, v26, v27
    v_cvt_pk_bf16_f32 v26, v28, v29
    v_cvt_pk_bf16_f32 v27, v30, v31
    buffer_store_dwordx4 v[24:27], v2, s[8:11], s90 offen sc1
    s_add_u32 s90, s90, s100
    s_nop 1
    v_accvgpr_read_b32 v24, a112
    v_accvgpr_read_b32 v25, a113
    v_accvgpr_read_b32 v26, a114
    v_accvgpr_read_b32 v27, a115
    v_accvgpr_read_b32 v28, a116
    v_accvgpr_read_b32 v29, a117
    v_accvgpr_read_b32 v30, a118
    v_accvgpr_read_b32 v31, a119
    v_cvt_pk_bf16_f32 v24, v24, v25
    v_cvt_pk_bf16_f32 v25, v26, v27
    v_cvt_pk_bf16_f32 v26, v28, v29
    v_cvt_pk_bf16_f32 v27, v30, v31
    buffer_store_dwordx4 v[24:27], v2, s[8:11], s90 offen sc1
    s_add_u32 s90, s90, s100
    s_nop 1
    v_accvgpr_read_b32 v24, a120
    v_accvgpr_read_b32 v25, a121
    v_accvgpr_read_b32 v26, a122
    v_accvgpr_read_b32 v27, a123
    v_accvgpr_read_b32 v28, a124
    v_accvgpr_read_b32 v29, a125
    v_accvgpr_read_b32 v30, a126
    v_accvgpr_read_b32 v31, a127
    v_cvt_pk_bf16_f32 v24, v24, v25
    v_cvt_pk_bf16_f32 v25, v26, v27
    v_cvt_pk_bf16_f32 v26, v28, v29
    v_cvt_pk_bf16_f32 v27, v30, v31
    buffer_store_dwordx4 v[24:27], v2, s[8:11], s90 offen sc1
    s_add_u32 s90, s90, s100
    s_nop 1
    s_add_u32 s91, s91, s99
    s_setpc_b64 s[20:21]
m_epl62:
    s_mov_b32 s92, s97
    s_mov_b32 s93, s97
    s_cmp_eq_u32 s97, 0
    s_cbranch_scc1 m_ns263
    s_mov_b32 s90, s98
    v_pk_mul_f32 v[32:33], v[32:33], s[92:93]
    v_pk_mul_f32 v[34:35], v[34:35], s[92:93]
    v_pk_mul_f32 v[36:37], v[36:37], s[92:93]
    v_pk_mul_f32 v[38:39], v[38:39], s[92:93]
    v_cvt_pk_bf16_f32 v32, v32, v33
    v_cvt_pk_bf16_f32 v33, v34, v35
    v_cvt_pk_bf16_f32 v34, v36, v37
    v_cvt_pk_bf16_f32 v35, v38, v39
    buffer_store_dwordx4 v[32:35], v2, s[8:11], s90 offen sc1
    s_add_u32 s90, s90, s100
    v_pk_mul_f32 v[40:41], v[40:41], s[92:93]
    v_pk_mul_f32 v[42:43], v[42:43], s[92:93]
    v_pk_mul_f32 v[44:45], v[44:45], s[92:93]
    v_pk_mul_f32 v[46:47], v[46:47], s[92:93]
    v_cvt_pk_bf16_f32 v40, v40, v41
    v_cvt_pk_bf16_f32 v41, v42, v43
    v_cvt_pk_bf16_f32 v42, v44, v45
    v_cvt_pk_bf16_f32 v43, v46, v47
    buffer_store_dwordx4 v[40:43], v2, s[8:11], s90 offen sc1
    s_add_u32 s90, s90, s100
    v_pk_mul_f32 v[48:49], v[48:49], s[92:93]
    v_pk_mul_f32 v[50:51], v[50:51], s[92:93]
    v_pk_mul_f32 v[52:53], v[52:53], s[92:93]
    v_pk_mul_f32 v[54:55], v[54:55], s[92:93]
    v_cvt_pk_bf16_f32 v48, v48, v49
    v_cvt_pk_bf16_f32 v49, v50, v51
    v_cvt_pk_bf16_f32 v50, v52, v53
    v_cvt_pk_bf16_f32 v51, v54, v55
    buffer_store_dwordx4 v[48:51], v2, s[8:11], s90 offen sc1
    s_add_u32 s90, s90, s100
    v_pk_mul_f32 v[56:57], v[56:57], s[92:93]
    v_pk_mul_f32 v[58:59], v[58:59], s[92:93]
    v_pk_mul_f32 v[60:61], v[60:61], s[92:93]
    v_pk_mul_f32 v[62:63], v[62:63], s[92:93]
    v_cvt_pk_bf16_f32 v56, v56, v57
    v_cvt_pk_bf16_f32 v57, v58, v59
    v_cvt_pk_bf16_f32 v58, v60, v61
    v_cvt_pk_bf16_f32 v59, v62, v63
    buffer_store_dwordx4 v[56:59], v2, s[8:11], s90 offen sc1
    s_add_u32 s90, s90, s100
    v_pk_mul_f32 v[64:65], v[64:65], s[92:93]
    v_pk_mul_f32 v[66:67], v[66:67], s[92:93]
    v_pk_mul_f32 v[68:69], v[68:69], s[92:93]
    v_pk_mul_f32 v[70:71], v[70:71], s[92:93]
    v_cvt_pk_bf16_f32 v64, v64, v65
    v_cvt_pk_bf16_f32 v65, v66, v67
    v_cvt_pk_bf16_f32 v66, v68, v69
    v_cvt_pk_bf16_f32 v67, v70, v71
    buffer_store_dwordx4 v[64:67], v2, s[8:11], s90 offen sc1
    s_add_u32 s90, s90, s100
    v_pk_mul_f32 v[72:73], v[72:73], s[92:93]
    v_pk_mul_f32 v[74:75], v[74:75], s[92:93]
    v_pk_mul_f32 v[76:77], v[76:77], s[92:93]
    v_pk_mul_f32 v[78:79], v[78:79], s[92:93]
    v_cvt_pk_bf16_f32 v72, v72, v73
    v_cvt_pk_bf16_f32 v73, v74, v75
    v_cvt_pk_bf16_f32 v74, v76, v77
    v_cvt_pk_bf16_f32 v75, v78, v79
    buffer_store_dwordx4 v[72:75], v2, s[8:11], s90 offen sc1
    s_add_u32 s90, s90, s100
    v_pk_mul_f32 v[80:81], v[80:81], s[92:93]
    v_pk_mul_f32 v[82:83], v[82:83], s[92:93]
    v_pk_mul_f32 v[84:85], v[84:85], s[92:93]
    v_pk_mul_f32 v[86:87], v[86:87], s[92:93]
    v_cvt_pk_bf16_f32 v80, v80, v81
    v_cvt_pk_bf16_f32 v81, v82, v83
    v_cvt_pk_bf16_f32 v82, v84, v85
    v_cvt_pk_bf16_f32 v83, v86, v87
    buffer_store_dwordx4 v[80:83], v2, s[8:11], s90 offen sc1
    s_add_u32 s90, s90, s100
    v_pk_mul_f32 v[88:89], v[88:89], s[92:93]
    v_pk_mul_f32 v[90:91], v[90:91], s[92:93]
    v_pk_mul_f32 v[92:93], v[92:93], s[92:93]
    v_pk_mul_f32 v[94:95], v[94:95], s[92:93]
    v_cvt_pk_bf16_f32 v88, v88, v89
    v_cvt_pk_bf16_f32 v89, v90, v91
    v_cvt_pk_bf16_f32 v90, v92, v93
    v_cvt_pk_bf16_f32 v91, v94, v95
    buffer_store_dwordx4 v[88:91], v2, s[8:11], s90 offen sc1
    s_add_u32 s90, s98, s99
    v_pk_mul_f32 v[96:97], v[96:97], s[92:93]
    v_pk_mul_f32 v[98:99], v[98:99], s[92:93]
    v_pk_mul_f32 v[100:101], v[100:101], s[92:93]
    v_pk_mul_f32 v[102:103], v[102:103], s[92:93]
    v_cvt_pk_bf16_f32 v96, v96, v97
    v_cvt_pk_bf16_f32 v97, v98, v99
    v_cvt_pk_bf16_f32 v98, v100, v101
    v_cvt_pk_bf16_f32 v99, v102, v103
    buffer_store_dwordx4 v[96:99], v2, s[8:11], s90 offen sc1
    s_add_u32 s90, s90, s100
    v_pk_mul_f32 v[104:105], v[104:105], s[92:93]
    v_pk_mul_f32 v[106:107], v[106:107], s[92:93]
    v_pk_mul_f32 v[108:109], v[108:109], s[92:93]
    v_pk_mul_f32 v[110:111], v[110:111], s[92:93]
    v_cvt_pk_bf16_f32 v104, v104, v105
    v_cvt_pk_bf16_f32 v105, v106, v107
    v_cvt_pk_bf16_f32 v106, v108, v109
    v_cvt_pk_bf16_f32 v107, v110, v111
    buffer_store_dwordx4 v[104:107], v2, s[8:11], s90 offen sc1
    s_add_u32 s90, s90, s100
    v_pk_mul_f32 v[112:113], v[112:113], s[92:93]
    v_pk_mul_f32 v[114:115], v[114:115], s[92:93]
    v_pk_mul_f32 v[116:117], v[116:117], s[92:93]
    v_pk_mul_f32 v[118:119], v[118:119], s[92:93]
    v_cvt_pk_bf16_f32 v112, v112, v113
    v_cvt_pk_bf16_f32 v113, v114, v115
    v_cvt_pk_bf16_f32 v114, v116, v117
    v_cvt_pk_bf16_f32 v115, v118, v119
    buffer_store_dwordx4 v[112:115], v2, s[8:11], s90 offen sc1
    s_add_u32 s90, s90, s100
    v_pk_mul_f32 v[120:121], v[120:121], s[92:93]
    v_pk_mul_f32 v[122:123], v[122:123], s[92:93]
    v_pk_mul_f32 v[124:125], v[124:125], s[92:93]
    v_pk_mul_f32 v[126:127], v[126:127], s[92:93]
    v_cvt_pk_bf16_f32 v120, v120, v121
    v_cvt_pk_bf16_f32 v121, v122, v123
    v_cvt_pk_bf16_f32 v122, v124, v125
    v_cvt_pk_bf16_f32 v123, v126, v127
    buffer_store_dwordx4 v[120:123], v2, s[8:11], s90 offen sc1
    s_add_u32 s90, s90, s100
    v_pk_mul_f32 v[128:129], v[128:129], s[92:93]
    v_pk_mul_f32 v[130:131], v[130:131], s[92:93]
    v_pk_mul_f32 v[132:133], v[132:133], s[92:93]
    v_pk_mul_f32 v[134:135], v[134:135], s[92:93]
    v_cvt_pk_bf16_f32 v128, v128, v129
    v_cvt_pk_bf16_f32 v129, v130, v131
    v_cvt_pk_bf16_f32 v130, v132, v133
    v_cvt_pk_bf16_f32 v131, v134, v135
    buffer_store_dwordx4 v[128:131], v2, s[8:11], s90 offen sc1
    s_add_u32 s90, s90, s100
    v_pk_mul_f32 v[136:137], v[136:137], s[92:93]
    v_pk_mul_f32 v[138:139], v[138:139], s[92:93]
    v_pk_mul_f32 v[140:141], v[140:141], s[92:93]
    v_pk_mul_f32 v[142:143], v[142:143], s[92:93]
    v_cvt_pk_bf16_f32 v136, v136, v137
    v_cvt_pk_bf16_f32 v137, v138, v139
    v_cvt_pk_bf16_f32 v138, v140, v141
    v_cvt_pk_bf16_f32 v139, v142, v143
    buffer_store_dwordx4 v[136:139], v2, s[8:11], s90 offen sc1
    s_add_u32 s90, s90, s100
    v_pk_mul_f32 v[144:145], v[144:145], s[92:93]
    v_pk_mul_f32 v[146:147], v[146:147], s[92:93]
    v_pk_mul_f32 v[148:149], v[148:149], s[92:93]
    v_pk_mul_f32 v[150:151], v[150:151], s[92:93]
    v_cvt_pk_bf16_f32 v144, v144, v145
    v_cvt_pk_bf16_f32 v145, v146, v147
    v_cvt_pk_bf16_f32 v146, v148, v149
    v_cvt_pk_bf16_f32 v147, v150, v151
    buffer_store_dwordx4 v[144:147], v2, s[8:11], s90 offen sc1
    s_add_u32 s90, s90, s100
    v_pk_mul_f32 v[152:153], v[152:153], s[92:93]
    v_pk_mul_f32 v[154:155], v[154:155], s[92:93]
    v_pk_mul_f32 v[156:157], v[156:157], s[92:93]
    v_pk_mul_f32 v[158:159], v[158:159], s[92:93]
    v_cvt_pk_bf16_f32 v152, v152, v153
    v_cvt_pk_bf16_f32 v153, v154, v155
    v_cvt_pk_bf16_f32 v154, v156, v157
    v_cvt_pk_bf16_f32 v155, v158, v159
    buffer_store_dwordx4 v[152:155], v2, s[8:11], s90 offen sc1
    s_add_u32 s90, s90, s100
    v_pk_mul_f32 v[192:193], v[192:193], s[92:93]
    v_pk_mul_f32 v[194:195], v[194:195], s[92:93]
    v_pk_mul_f32 v[196:197], v[196:197], s[92:93]
    v_pk_mul_f32 v[198:199], v[198:199], s[92:93]
    v_cvt_pk_bf16_f32 v192, v192, v193
    v_cvt_pk_bf16_f32 v193, v194, v195
    v_cvt_pk_bf16_f32 v194, v196, v197
    v_cvt_pk_bf16_f32 v195, v198, v199
    v_pk_mul_f32 v[200:201], v[200:201], s[92:93]
    v_pk_mul_f32 v[202:203], v[202:203], s[92:93]
    v_pk_mul_f32 v[204:205], v[204:205], s[92:93]
    v_pk_mul_f32 v[206:207], v[206:207], s[92:93]
    v_cvt_pk_bf16_f32 v196, v200, v201
    v_cvt_pk_bf16_f32 v197, v202, v203
    v_cvt_pk_bf16_f32 v198, v204, v205
    v_cvt_pk_bf16_f32 v199, v206, v207
    v_pk_mul_f32 v[208:209], v[208:209], s[92:93]
    v_pk_mul_f32 v[210:211], v[210:211], s[92:93]
    v_pk_mul_f32 v[212:213], v[212:213], s[92:93]
    v_pk_mul_f32 v[214:215], v[214:215], s[92:93]
    v_cvt_pk_bf16_f32 v200, v208, v209
    v_cvt_pk_bf16_f32 v201, v210, v211
    v_cvt_pk_bf16_f32 v202, v212, v213
    v_cvt_pk_bf16_f32 v203, v214, v215
    v_pk_mul_f32 v[216:217], v[216:217], s[92:93]
    v_pk_mul_f32 v[218:219], v[218:219], s[92:93]
    v_pk_mul_f32 v[220:221], v[220:221], s[92:93]
    v_pk_mul_f32 v[222:223], v[222:223], s[92:93]
    v_cvt_pk_bf16_f32 v204, v216, v217
    v_cvt_pk_bf16_f32 v205, v218, v219
    v_cvt_pk_bf16_f32 v206, v220, v221
    v_cvt_pk_bf16_f32 v207, v222, v223
    v_pk_mul_f32 v[224:225], v[224:225], s[92:93]
    v_pk_mul_f32 v[226:227], v[226:227], s[92:93]
    v_pk_mul_f32 v[228:229], v[228:229], s[92:93]
    v_pk_mul_f32 v[230:231], v[230:231], s[92:93]
    v_cvt_pk_bf16_f32 v208, v224, v225
    v_cvt_pk_bf16_f32 v209, v226, v227
    v_cvt_pk_bf16_f32 v210, v228, v229
    v_cvt_pk_bf16_f32 v211, v230, v231
    v_pk_mul_f32 v[232:233], v[232:233], s[92:93]
    v_pk_mul_f32 v[234:235], v[234:235], s[92:93]
    v_pk_mul_f32 v[236:237], v[236:237], s[92:93]
    v_pk_mul_f32 v[238:239], v[238:239], s[92:93]
    v_cvt_pk_bf16_f32 v212, v232, v233
    v_cvt_pk_bf16_f32 v213, v234, v235
    v_cvt_pk_bf16_f32 v214, v236, v237
    v_cvt_pk_bf16_f32 v215, v238, v239
    v_pk_mul_f32 v[240:241], v[240:241], s[92:93]
    v_pk_mul_f32 v[242:243], v[242:243], s[92:93]
    v_pk_mul_f32 v[244:245], v[244:245], s[92:93]
    v_pk_mul_f32 v[246:247], v[246:247], s[92:93]
    v_cvt_pk_bf16_f32 v216, v240, v241
    v_cvt_pk_bf16_f32 v217, v242, v243
    v_cvt_pk_bf16_f32 v218, v244, v245
    v_cvt_pk_bf16_f32 v219, v246, v247
    v_pk_mul_f32 v[248:249], v[248:249], s[92:93]
    v_pk_mul_f32 v[250:251], v[250:251], s[92:93]
    v_pk_mul_f32 v[252:253], v[252:253], s[92:93]
    v_pk_mul_f32 v[254:255], v[254:255], s[92:93]
    v_cvt_pk_bf16_f32 v220, v248, v249
    v_cvt_pk_bf16_f32 v221, v250, v251
    v_cvt_pk_bf16_f32 v222, v252, v253
    v_cvt_pk_bf16_f32 v223, v254, v255
    v_accvgpr_read_b32 v24, a96
    v_accvgpr_read_b32 v25, a97
    v_accvgpr_read_b32 v26, a98
    v_accvgpr_read_b32 v27, a99
    v_accvgpr_read_b32 v28, a100
    v_accvgpr_read_b32 v29, a101
    v_accvgpr_read_b32 v30, a102
    v_accvgpr_read_b32 v31, a103
    v_pk_mul_f32 v[24:25], v[24:25], s[92:93]
    v_pk_mul_f32 v[26:27], v[26:27], s[92:93]
    v_pk_mul_f32 v[28:29], v[28:29], s[92:93]
    v_pk_mul_f32 v[30:31], v[30:31], s[92:93]
    v_cvt_pk_bf16_f32 v224, v24, v25
    v_cvt_pk_bf16_f32 v225, v26, v27
    v_cvt_pk_bf16_f32 v226, v28, v29
    v_cvt_pk_bf16_f32 v227, v30, v31
    v_accvgpr_read_b32 v24, a104
    v_accvgpr_read_b32 v25, a105
    v_accvgpr_read_b32 v26, a106
    v_accvgpr_read_b32 v27, a107
    v_accvgpr_read_b32 v28, a108
    v_accvgpr_read_b32 v29, a109
    v_accvgpr_read_b32 v30, a110
    v_accvgpr_read_b32 v31, a111
    v_pk_mul_f32 v[24:25], v[24:25], s[92:93]
    v_pk_mul_f32 v[26:27], v[26:27], s[92:93]
    v_pk_mul_f32 v[28:29], v[28:29], s[92:93]
    v_pk_mul_f32 v[30:31], v[30:31], s[92:93]
    v_cvt_pk_bf16_f32 v228, v24, v25
    v_cvt_pk_bf16_f32 v229, v26, v27
    v_cvt_pk_bf16_f32 v230, v28, v29
    v_cvt_pk_bf16_f32 v231, v30, v31
    v_accvgpr_read_b32 v24, a112
    v_accvgpr_read_b32 v25, a113
    v_accvgpr_read_b32 v26, a114
    v_accvgpr_read_b32 v27, a115
    v_accvgpr_read_b32 v28, a116
    v_accvgpr_read_b32 v29, a117
    v_accvgpr_read_b32 v30, a118
    v_accvgpr_read_b32 v31, a119
    v_pk_mul_f32 v[24:25], v[24:25], s[92:93]
    v_pk_mul_f32 v[26:27], v[26:27], s[92:93]
    v_pk_mul_f32 v[28:29], v[28:29], s[92:93]
    v_pk_mul_f32 v[30:31], v[30:31], s[92:93]
    v_cvt_pk_bf16_f32 v232, v24, v25
    v_cvt_pk_bf16_f32 v233, v26, v27
    v_cvt_pk_bf16_f32 v234, v28, v29
    v_cvt_pk_bf16_f32 v235, v30, v31
    v_accvgpr_read_b32 v24, a120
    v_accvgpr_read_b32 v25, a121
    v_accvgpr_read_b32 v26, a122
    v_accvgpr_read_b32 v27, a123
    v_accvgpr_read_b32 v28, a124
    v_accvgpr_read_b32 v29, a125
    v_accvgpr_read_b32 v30, a126
    v_accvgpr_read_b32 v31, a127
    v_pk_mul_f32 v[24:25], v[24:25], s[92:93]
    v_pk_mul_f32 v[26:27], v[26:27], s[92:93]
    v_pk_mul_f32 v[28:29], v[28:29], s[92:93]
    v_pk_mul_f32 v[30:31], v[30:31], s[92:93]
    v_cvt_pk_bf16_f32 v236, v24, v25
    v_cvt_pk_bf16_f32 v237, v26, v27
    v_cvt_pk_bf16_f32 v238, v28, v29
    v_cvt_pk_bf16_f32 v239, v30, v31
    v_pk_mul_f32 v[160:161], v[160:161], s[92:93]
    v_pk_mul_f32 v[162:163], v[162:163], s[92:93]
    v_pk_mul_f32 v[164:165], v[164:165], s[92:93]
    v_pk_mul_f32 v[166:167], v[166:167], s[92:93]
    v_cvt_pk_bf16_f32 v240, v160, v161
    v_cvt_pk_bf16_f32 v241, v162, v163
    v_cvt_pk_bf16_f32 v242, v164, v165
    v_cvt_pk_bf16_f32 v243, v166, v167
    v_pk_mul_f32 v[168:169], v[168:169], s[92:93]
    v_pk_mul_f32 v[170:171], v[170:171], s[92:93]
    v_pk_mul_f32 v[172:173], v[172:173], s[92:93]
    v_pk_mul_f32 v[174:175], v[174:175], s[92:93]
    v_cvt_pk_bf16_f32 v244, v168, v169
    v_cvt_pk_bf16_f32 v245, v170, v171
    v_cvt_pk_bf16_f32 v246, v172, v173
    v_cvt_pk_bf16_f32 v247, v174, v175
    v_pk_mul_f32 v[176:177], v[176:177], s[92:93]
    v_pk_mul_f32 v[178:179], v[178:179], s[92:93]
    v_pk_mul_f32 v[180:181], v[180:181], s[92:93]
    v_pk_mul_f32 v[182:183], v[182:183], s[92:93]
    v_cvt_pk_bf16_f32 v248, v176, v177
    v_cvt_pk_bf16_f32 v249, v178, v179
    v_cvt_pk_bf16_f32 v250, v180, v181
    v_cvt_pk_bf16_f32 v251, v182, v183
    v_pk_mul_f32 v[184:185], v[184:185], s[92:93]
    v_pk_mul_f32 v[186:187], v[186:187], s[92:93]
    v_pk_mul_f32 v[188:189], v[188:189], s[92:93]
    v_pk_mul_f32 v[190:191], v[190:191], s[92:93]
    v_cvt_pk_bf16_f32 v252, v184, v185
    v_cvt_pk_bf16_f32 v253, v186, v187
    v_cvt_pk_bf16_f32 v254, v188, v189
    v_cvt_pk_bf16_f32 v255, v190, v191
    s_setpc_b64 s[20:21]
m_ns263:
    s_mov_b32 s90, s98
    v_cvt_pk_bf16_f32 v32, v32, v33
    v_cvt_pk_bf16_f32 v33, v34, v35
    v_cvt_pk_bf16_f32 v34, v36, v37
    v_cvt_pk_bf16_f32 v35, v38, v39
    buffer_store_dwordx4 v[32:35], v2, s[8:11], s90 offen sc1
    s_add_u32 s90, s90, s100
    v_cvt_pk_bf16_f32 v40, v40, v41
    v_cvt_pk_bf16_f32 v41, v42, v43
    v_cvt_pk_bf16_f32 v42, v44, v45
    v_cvt_pk_bf16_f32 v43, v46, v47
    buffer_store_dwordx4 v[40:43], v2, s[8:11], s90 offen sc1
    s_add_u32 s90, s90, s100
    v_cvt_pk_bf16_f32 v48, v48, v49
    v_cvt_pk_bf16_f32 v49, v50, v51
    v_cvt_pk_bf16_f32 v50, v52, v53
    v_cvt_pk_bf16_f32 v51, v54, v55
    buffer_store_dwordx4 v[48:51], v2, s[8:11], s90 offen sc1
    s_add_u32 s90, s90, s100
    v_cvt_pk_bf16_f32 v56, v56, v57
    v_cvt_pk_bf16_f32 v57, v58, v59
    v_cvt_pk_bf16_f32 v58, v60, v61
    v_cvt_pk_bf16_f32 v59, v62, v63
    buffer_store_dwordx4 v[56:59], v2, s[8:11], s90 offen sc1
    s_add_u32 s90, s90, s100
    v_cvt_pk_bf16_f32 v64, v64, v65
    v_cvt_pk_bf16_f32 v65, v66, v67
    v_cvt_pk_bf16_f32 v66, v68, v69
    v_cvt_pk_bf16_f32 v67, v70, v71
    buffer_store_dwordx4 v[64:67], v2, s[8:11], s90 offen sc1
    s_add_u32 s90, s90, s100
    v_cvt_pk_bf16_f32 v72, v72, v73
    v_cvt_pk_bf16_f32 v73, v74, v75
    v_cvt_pk_bf16_f32 v74, v76, v77
    v_cvt_pk_bf16_f32 v75, v78, v79
    buffer_store_dwordx4 v[72:75], v2, s[8:11], s90 offen sc1
    s_add_u32 s90, s90, s100
    v_cvt_pk_bf16_f32 v80, v80, v81
    v_cvt_pk_bf16_f32 v81, v82, v83
    v_cvt_pk_bf16_f32 v82, v84, v85
    v_cvt_pk_bf16_f32 v83, v86, v87
    buffer_store_dwordx4 v[80:83], v2, s[8:11], s90 offen sc1
    s_add_u32 s90, s90, s100
    v_cvt_pk_bf16_f32 v88, v88, v89
    v_cvt_pk_bf16_f32 v89, v90, v91
    v_cvt_pk_bf16_f32 v90, v92, v93
    v_cvt_pk_bf16_f32 v91, v94, v95
    buffer_store_dwordx4 v[88:91], v2, s[8:11], s90 offen sc1
    s_add_u32 s90, s98, s99
    v_cvt_pk_bf16_f32 v96, v96, v97
    v_cvt_pk_bf16_f32 v97, v98, v99
    v_cvt_pk_bf16_f32 v98, v100, v101
    v_cvt_pk_bf16_f32 v99, v102, v103
    buffer_store_dwordx4 v[96:99], v2, s[8:11], s90 offen sc1
    s_add_u32 s90, s90, s100
    v_cvt_pk_bf16_f32 v104, v104, v105
    v_cvt_pk_bf16_f32 v105, v106, v107
    v_cvt_pk_bf16_f32 v106, v108, v109
    v_cvt_pk_bf16_f32 v107, v110, v111
    buffer_store_dwordx4 v[104:107], v2, s[8:11], s90 offen sc1
    s_add_u32 s90, s90, s100
    v_cvt_pk_bf16_f32 v112, v112, v113
    v_cvt_pk_bf16_f32 v113, v114, v115
    v_cvt_pk_bf16_f32 v114, v116, v117
    v_cvt_pk_bf16_f32 v115, v118, v119
    buffer_store_dwordx4 v[112:115], v2, s[8:11], s90 offen sc1
    s_add_u32 s90, s90, s100
    v_cvt_pk_bf16_f32 v120, v120, v121
    v_cvt_pk_bf16_f32 v121, v122, v123
    v_cvt_pk_bf16_f32 v122, v124, v125
    v_cvt_pk_bf16_f32 v123, v126, v127
    buffer_store_dwordx4 v[120:123], v2, s[8:11], s90 offen sc1
    s_add_u32 s90, s90, s100
    v_cvt_pk_bf16_f32 v128, v128, v129
    v_cvt_pk_bf16_f32 v129, v130, v131
    v_cvt_pk_bf16_f32 v130, v132, v133
    v_cvt_pk_bf16_f32 v131, v134, v135
    buffer_store_dwordx4 v[128:131], v2, s[8:11], s90 offen sc1
    s_add_u32 s90, s90, s100
    v_cvt_pk_bf16_f32 v136, v136, v137
    v_cvt_pk_bf16_f32 v137, v138, v139
    v_cvt_pk_bf16_f32 v138, v140, v141
    v_cvt_pk_bf16_f32 v139, v142, v143
    buffer_store_dwordx4 v[136:139], v2, s[8:11], s90 offen sc1
    s_add_u32 s90, s90, s100
    v_cvt_pk_bf16_f32 v144, v144, v145
    v_cvt_pk_bf16_f32 v145, v146, v147
    v_cvt_pk_bf16_f32 v146, v148, v149
    v_cvt_pk_bf16_f32 v147, v150, v151
    buffer_store_dwordx4 v[144:147], v2, s[8:11], s90 offen sc1
    s_add_u32 s90, s90, s100
    v_cvt_pk_bf16_f32 v152, v152, v153
    v_cvt_pk_bf16_f32 v153, v154, v155
    v_cvt_pk_bf16_f32 v154, v156, v157
    v_cvt_pk_bf16_f32 v155, v158, v159
    buffer_store_dwordx4 v[152:155], v2, s[8:11], s90 offen sc1
    s_add_u32 s90, s90, s100
    v_cvt_pk_bf16_f32 v192, v192, v193
    v_cvt_pk_bf16_f32 v193, v194, v195
    v_cvt_pk_bf16_f32 v194, v196, v197
    v_cvt_pk_bf16_f32 v195, v198, v199
    v_cvt_pk_bf16_f32 v196, v200, v201
    v_cvt_pk_bf16_f32 v197, v202, v203
    v_cvt_pk_bf16_f32 v198, v204, v205
    v_cvt_pk_bf16_f32 v199, v206, v207
    v_cvt_pk_bf16_f32 v200, v208, v209
    v_cvt_pk_bf16_f32 v201, v210, v211
    v_cvt_pk_bf16_f32 v202, v212, v213
    v_cvt_pk_bf16_f32 v203, v214, v215
    v_cvt_pk_bf16_f32 v204, v216, v217
    v_cvt_pk_bf16_f32 v205, v218, v219
    v_cvt_pk_bf16_f32 v206, v220, v221
    v_cvt_pk_bf16_f32 v207, v222, v223
    v_cvt_pk_bf16_f32 v208, v224, v225
    v_cvt_pk_bf16_f32 v209, v226, v227
    v_cvt_pk_bf16_f32 v210, v228, v229
    v_cvt_pk_bf16_f32 v211, v230, v231
    v_cvt_pk_bf16_f32 v212, v232, v233
    v_cvt_pk_bf16_f32 v213, v234, v235
    v_cvt_pk_bf16_f32 v214, v236, v237
    v_cvt_pk_bf16_f32 v215, v238, v239
    v_cvt_pk_bf16_f32 v216, v240, v241
    v_cvt_pk_bf16_f32 v217, v242, v243
    v_cvt_pk_bf16_f32 v218, v244, v245
    v_cvt_pk_bf16_f32 v219, v246, v247
    v_cvt_pk_bf16_f32 v220, v248, v249
    v_cvt_pk_bf16_f32 v221, v250, v251
    v_cvt_pk_bf16_f32 v222, v252, v253
    v_cvt_pk_bf16_f32 v223, v254, v255
    v_accvgpr_read_b32 v24, a96
    v_accvgpr_read_b32 v25, a97
    v_accvgpr_read_b32 v26, a98
    v_accvgpr_read_b32 v27, a99
    v_accvgpr_read_b32 v28, a100
    v_accvgpr_read_b32 v29, a101
    v_accvgpr_read_b32 v30, a102
    v_accvgpr_read_b32 v31, a103
    v_cvt_pk_bf16_f32 v224, v24, v25
    v_cvt_pk_bf16_f32 v225, v26, v27
    v_cvt_pk_bf16_f32 v226, v28, v29
    v_cvt_pk_bf16_f32 v227, v30, v31
    v_accvgpr_read_b32 v24, a104
    v_accvgpr_read_b32 v25, a105
    v_accvgpr_read_b32 v26, a106
    v_accvgpr_read_b32 v27, a107
    v_accvgpr_read_b32 v28, a108
    v_accvgpr_read_b32 v29, a109
    v_accvgpr_read_b32 v30, a110
    v_accvgpr_read_b32 v31, a111
    v_cvt_pk_bf16_f32 v228, v24, v25
    v_cvt_pk_bf16_f32 v229, v26, v27
    v_cvt_pk_bf16_f32 v230, v28, v29
    v_cvt_pk_bf16_f32 v231, v30, v31
    v_accvgpr_read_b32 v24, a112
    v_accvgpr_read_b32 v25, a113
    v_accvgpr_read_b32 v26, a114
    v_accvgpr_read_b32 v27, a115
    v_accvgpr_read_b32 v28, a116
    v_accvgpr_read_b32 v29, a117
    v_accvgpr_read_b32 v30, a118
    v_accvgpr_read_b32 v31, a119
    v_cvt_pk_bf16_f32 v232, v24, v25
    v_cvt_pk_bf16_f32 v233, v26, v27
    v_cvt_pk_bf16_f32 v234, v28, v29
    v_cvt_pk_bf16_f32 v235, v30, v31
    v_accvgpr_read_b32 v24, a120
    v_accvgpr_read_b32 v25, a121
    v_accvgpr_read_b32 v26, a122
    v_accvgpr_read_b32 v27, a123
    v_accvgpr_read_b32 v28, a124
    v_accvgpr_read_b32 v29, a125
    v_accvgpr_read_b32 v30, a126
    v_accvgpr_read_b32 v31, a127
    v_cvt_pk_bf16_f32 v236, v24, v25
    v_cvt_pk_bf16_f32 v237, v26, v27
    v_cvt_pk_bf16_f32 v238, v28, v29
    v_cvt_pk_bf16_f32 v239, v30, v31
    v_cvt_pk_bf16_f32 v240, v160, v161
    v_cvt_pk_bf16_f32 v241, v162, v163
    v_cvt_pk_bf16_f32 v242, v164, v165
    v_cvt_pk_bf16_f32 v243, v166, v167
    v_cvt_pk_bf16_f32 v244, v168, v169
    v_cvt_pk_bf16_f32 v245, v170, v171
    v_cvt_pk_bf16_f32 v246, v172, v173
    v_cvt_pk_bf16_f32 v247, v174, v175
    v_cvt_pk_bf16_f32 v248, v176, v177
    v_cvt_pk_bf16_f32 v249, v178, v179
    v_cvt_pk_bf16_f32 v250, v180, v181
    v_cvt_pk_bf16_f32 v251, v182, v183
    v_cvt_pk_bf16_f32 v252, v184, v185
    v_cvt_pk_bf16_f32 v253, v186, v187
    v_cvt_pk_bf16_f32 v254, v188, v189
    v_cvt_pk_bf16_f32 v255, v190, v191
    s_setpc_b64 s[20:21]
m_pf7:
    s_mov_b32 s15, 0x20000
    s_sub_u32 s93, s2, 224
    s_lshl_b32 s93, s93, 2
    s_add_u32 s93, s93, s16
    v_lshlrev_b32 v24, 7, v1
    v_lshrrev_b32 v25, 3, v1
    v_lshlrev_b32 v25, 11, v25
    v_and_b32 v26, 7, v1
    v_lshl_add_u32 v25, v26, 7, v25
    s_lshl_b32 s92, s93, 13
    s_lshl_b32 s93, s93, 14
    s_add_u32 s93, s93, 1024
    v_lshrrev_b32 v25, 2, v1
    v_lshlrev_b32 v25, 11, v25
    v_and_b32 v26, 3, v1
    v_lshl_add_u32 v25, v26, 7, v25
    s_lshl_b32 s93, s92, 2
    s_mov_b32 s12, s34
    s_mov_b32 s13, s35
    s_mov_b32 s14, 8388608
    s_add_u32 s90, s92, 1048576
    buffer_load_dword v22, v24, s[12:15], s90 offen
    s_add_u32 s90, s92, 2097152
    buffer_load_dword v22, v24, s[12:15], s90 offen
    s_mov_b32 s12, s30
    s_mov_b32 s13, s31
    s_mov_b32 s14, 4194304
    s_add_u32 s90, s93, 512
    buffer_load_dword v22, v25, s[12:15], s90 offen
    s_mov_b32 s12, s34
    s_mov_b32 s13, s35
    s_mov_b32 s14, 8388608
    s_add_u32 s90, s92, 3145728
    buffer_load_dword v22, v24, s[12:15], s90 offen
    s_add_u32 s90, s92, 4194304
    buffer_load_dword v22, v24, s[12:15], s90 offen
    s_mov_b32 s12, s30
    s_mov_b32 s13, s31
    s_mov_b32 s14, 4194304
    s_add_u32 s90, s93, 1024
    buffer_load_dword v22, v25, s[12:15], s90 offen
    s_mov_b32 s12, s34
    s_mov_b32 s13, s35
    s_mov_b32 s14, 8388608
    s_add_u32 s90, s92, 5242880
    buffer_load_dword v22, v24, s[12:15], s90 offen
    s_mov_b32 s12, s26
    s_mov_b32 s13, s27
    s_mov_b32 s14, 6291456
    s_add_u32 s90, s92, 0
    buffer_load_dword v22, v24, s[12:15], s90 offen
    s_mov_b32 s12, s24
    s_mov_b32 s13, s25
    s_mov_b32 s14, 4194304
    s_add_u32 s90, s93, 0
    buffer_load_dword v22, v25, s[12:15], s90 offen
    s_mov_b32 s12, s34
    s_mov_b32 s13, s35
    s_mov_b32 s14, 8388608
    s_add_u32 s90, s92, 6291456
    buffer_load_dword v22, v24, s[12:15], s90 offen
    s_mov_b32 s12, s30
    s_mov_b32 s13, s31
    s_mov_b32 s14, 4194304
    s_add_u32 s90, s93, 1536
    buffer_load_dword v22, v25, s[12:15], s90 offen
    s_mov_b32 s12, s26
    s_mov_b32 s13, s27
    s_mov_b32 s14, 6291456
    s_add_u32 s90, s92, 1048576
    buffer_load_dword v22, v24, s[12:15], s90 offen
    s_mov_b32 s12, s24
    s_mov_b32 s13, s25
    s_mov_b32 s14, 4194304
    s_add_u32 s90, s93, 512
    buffer_load_dword v22, v25, s[12:15], s90 offen
    s_mov_b32 s12, s34
    s_mov_b32 s13, s35
    s_mov_b32 s14, 8388608
    s_add_u32 s90, s92, 7340032
    buffer_load_dword v22, v24, s[12:15], s90 offen
    s_mov_b32 s12, s26
    s_mov_b32 s13, s27
    s_mov_b32 s14, 6291456
    s_add_u32 s90, s92, 2097152
    buffer_load_dword v22, v24, s[12:15], s90 offen
    s_add_u32 s90, s92, 3145728
    buffer_load_dword v22, v24, s[12:15], s90 offen
    s_mov_b32 s12, s24
    s_mov_b32 s13, s25
    s_mov_b32 s14, 4194304
    s_add_u32 s90, s93, 1024
    buffer_load_dword v22, v25, s[12:15], s90 offen
    s_mov_b32 s12, s26
    s_mov_b32 s13, s27
    s_mov_b32 s14, 6291456
    s_add_u32 s90, s92, 4194304
    buffer_load_dword v22, v24, s[12:15], s90 offen
    s_mov_b32 s12, s24
    s_mov_b32 s13, s25
    s_mov_b32 s14, 4194304
    s_add_u32 s90, s93, 1536
    buffer_load_dword v22, v25, s[12:15], s90 offen
    s_mov_b32 s12, s26
    s_mov_b32 s13, s27
    s_mov_b32 s14, 6291456
    s_add_u32 s90, s92, 5242880
    buffer_load_dword v22, v24, s[12:15], s90 offen
    s_mov_b32 s12, s32
    s_mov_b32 s13, s33
    s_mov_b32 s14, 2097152
    s_add_u32 s90, s92, 1048576
    buffer_load_dword v22, v24, s[12:15], s90 offen
    s_branch m_nopf6
concat_heads__sliding_local_dilated__compressed_kv_cla__prompt_kernel_end:
.section .rodata,"a"
.p2align 6
.amdhsa_kernel concat_heads__sliding_local_dilated__compressed_kv_cla__prompt_kernel
  .amdhsa_next_free_vgpr 512
  .amdhsa_next_free_sgpr 102
  .amdhsa_accum_offset 256
  .amdhsa_group_segment_fixed_size 0
  .amdhsa_kernarg_size 96
  .amdhsa_user_sgpr_count 2
  .amdhsa_user_sgpr_kernarg_segment_ptr 1
  .amdhsa_system_sgpr_workgroup_id_x 1
.end_amdhsa_kernel
```

```asm
; @launch grid=(256,1,1) block=(256,1,1) lds=163840
.amdgcn_target "amdgcn-amd-amdhsa--gfx950"
.text
.globl concat_heads__sliding_local_dilated__compressed_kv_cla__prompt_kernel
.p2align 8
.type concat_heads__sliding_local_dilated__compressed_kv_cla__prompt_kernel,@function
concat_heads__sliding_local_dilated__compressed_kv_cla__prompt_kernel:
    s_cmp_ge_u32 s2, 256
    s_cbranch_scc1 m_end1
    s_load_dwordx16 s[24:39], s[0:1], 0
    s_load_dwordx4 s[4:7], s[0:1], 80
    v_and_b32 v1, 63, v0
    v_lshrrev_b32 v24, 6, v0
    s_nop 0
    v_readfirstlane_b32 s16, v24
    s_lshr_b32 s68, s2, 3
    s_lshr_b32 s57, s16, 1
    s_and_b32 s58, s16, 1
    s_mov_b32 s43, 0x20000
    s_mov_b32 s47, 0x20000
    s_cmp_lt_u32 s68, 28
    s_cbranch_scc1 m_ncp2
    s_sub_u32 s91, s68, 28
    s_lshl_b32 s91, s91, 2
    s_add_u32 s91, s91, s16
    s_getpc_b64 s[8:9]
m_pc3:
    s_sub_u32 s8, s8, m_pc3-concat_heads__sliding_local_dilated__compressed_kv_cla__prompt_kernel
    s_subb_u32 s9, s9, 0
    s_mov_b32 s10, concat_heads__sliding_local_dilated__compressed_kv_cla__prompt_kernel_end-concat_heads__sliding_local_dilated__compressed_kv_cla__prompt_kernel
    s_mov_b32 s11, 0x20000
    s_lshl_b32 s90, s91, 13
    v_lshlrev_b32 v24, 7, v1
    buffer_load_dword v22, v24, s[8:11], s90 offen
m_ncp2:
    s_lshl_b32 s61, s16, 13
    s_add_u32 s62, s61, 98304
    s_cmp_ge_u32 s68, 16
    s_cbranch_scc1 m_typea4
    s_and_b32 s69, s68, 3
    s_and_b32 s90, s2, 1
    s_lshl_b32 s90, s90, 2
    s_add_u32 s69, s69, s90
    s_bfe_u32 s90, s2, 0x20001
    s_mul_i32 s90, s90, 4
    s_bfe_u32 s91, s68, 0x20002
    s_add_u32 s90, s90, s91
    s_mov_b32 s76, 8388608
    s_mov_b32 s78, 8192
    s_mov_b32 s81, 0
    s_mov_b32 s73, 4194304
    s_mov_b32 s77, 2048
    s_mov_b32 s82, 16
    s_lshl_b32 s80, s90, 9
    s_lshl_b32 s79, s69, 19
    s_lshl_b32 s88, s90, 4
    s_add_u32 s88, s88, s69
    s_lshl_b32 s88, s88, 3
    s_mov_b32 s83, 0
    s_mov_b32 s84, 1040356334
    s_lshl_b32 s91, s90, 1
    s_add_u32 s91, s91, s58
    s_lshl_b32 s91, s91, 19
    s_lshl_b32 s92, s69, 1
    s_add_u32 s92, s92, s57
    s_lshl_b32 s92, s92, 15
    s_add_u32 s85, s91, s92
    s_add_u32 s85, s85, 0
    s_mov_b32 s86, 1024
    s_mov_b32 s87, 4096
    s_branch m_go15
m_typea4:
    s_bfe_u32 s69, s68, 0x20002
    s_add_u32 s69, s69, 0
    s_and_b32 s90, s2, 7
    s_lshl_b32 s90, s90, 2
    s_and_b32 s91, s68, 3
    s_add_u32 s90, s90, s91
    s_cmp_lt_u32 s90, 16
    s_cselect_b32 s83, 0, 1
    s_mov_b32 s91, 33554432
    s_cselect_b32 s85, 16777216, s91
    s_mov_b32 s91, 8192
    s_cselect_b32 s86, 1024, s91
    s_mov_b32 s91, 1024
    s_cselect_b32 s87, 4096, s91
    s_mov_b32 s73, 2097152
    s_mov_b32 s77, 1024
    s_mov_b32 s82, 8
    s_mov_b32 s81, 0
    s_mov_b32 s76, 4194304
    s_mov_b32 s78, 8192
    s_mov_b32 s84, 0
    s_and_b32 s90, s90, 15
    s_lshl_b32 s80, s90, 9
    s_lshl_b32 s79, s69, 18
    s_lshl_b32 s91, s83, 2
    s_add_u32 s91, s91, s69
    s_cmp_ge_u32 s69, 4
    s_cselect_b32 s92, 508, 8
    s_add_u32 s91, s91, s92
    s_lshl_b32 s88, s90, 4
    s_add_u32 s88, s88, s91
    s_lshl_b32 s88, s88, 3
    s_lshl_b32 s91, s90, 1
    s_add_u32 s91, s91, s58
    s_lshl_b32 s91, s91, 19
    s_lshl_b32 s92, s69, 1
    s_add_u32 s92, s92, s57
    s_lshl_b32 s92, s92, 15
    s_add_u32 s85, s85, s91
    s_add_u32 s85, s85, s92
m_go15:
    s_mov_b32 s42, s73
    s_lshl_b32 s90, s77, 4
    s_lshl_b32 s90, s90, s81
    s_mov_b32 s48, s79
    s_mul_i32 s91, s90, 1
    s_add_u32 s49, s91, s79
    s_sub_u32 s49, s49, 2048
    s_mul_i32 s91, s90, 2
    s_add_u32 s50, s91, s79
    s_mul_i32 s91, s90, 3
    s_add_u32 s51, s91, s79
    s_sub_u32 s51, s51, 2048
    s_lshl_b32 s90, s58, 7
    s_add_u32 s90, s90, s57
    s_lshl_b32 s91, s16, 6
    s_cmp_eq_u32 s81, 1
    s_cselect_b32 s90, s90, s91
    v_lshrrev_b32 v24, 3, v1
    v_lshlrev_b32 v24, s81, v24
    v_add_u32 v24, s90, v24
    v_mul_lo_u32 v24, v24, s77
    v_lshrrev_b32 v25, 4, v1
    v_and_b32 v26, 7, v1
    v_xor_b32 v25, v25, v26
    v_lshl_add_u32 v16, v25, 4, v24
    v_xor_b32 v25, 4, v25
    v_lshl_add_u32 v17, v25, 4, v24
    s_lshl_b32 s90, s77, 3
    s_lshl_b32 s90, s90, s81
    s_sub_u32 s90, s90, 1024
    v_add_u32 v17, s90, v17
    s_mov_b32 s46, s76
    s_mov_b32 s52, s80
    s_lshl_b32 s90, s78, 2
    s_mul_i32 s91, s90, 1
    s_add_u32 s53, s91, s80
    s_sub_u32 s53, s53, 2048
    s_mul_i32 s91, s90, 2
    s_add_u32 s54, s91, s80
    s_mul_i32 s91, s90, 3
    s_add_u32 s55, s91, s80
    s_sub_u32 s55, s55, 2048
    s_lshl_b32 s56, s78, 6
    v_lshrrev_b32 v24, 5, v1
    s_lshl_b32 s90, s16, 4
    v_add_u32 v25, s90, v24
    v_mul_lo_u32 v25, v25, s78
    v_lshlrev_b32 v24, 1, v24
    v_and_b32 v26, 31, v1
    v_xor_b32 v24, v24, v26
    s_lshl_b32 s90, s78, 1
    s_sub_u32 s90, s90, 1024
    v_add_u32 v27, s90, v25
    v_xor_b32 v26, 0, v24
    v_lshl_add_u32 v18, v26, 4, v25
    v_xor_b32 v26, 4, v24
    v_lshl_add_u32 v19, v26, 4, v27
    v_xor_b32 v26, 8, v24
    v_lshl_add_u32 v20, v26, 4, v25
    v_xor_b32 v26, 12, v24
    v_lshl_add_u32 v21, v26, 4, v27
    s_cmp_eq_u32 s83, 0
    s_waitcnt lgkmcnt(0)
    s_cselect_b32 s44, s36, s38
    s_cselect_b32 s45, s37, s39
    s_cmp_lt_u32 s68, 16
    s_cselect_b32 s44, s34, s44
    s_cselect_b32 s45, s35, s45
    s_cselect_b32 s40, s30, s32
    s_cselect_b32 s41, s31, s33
    s_cmp_ge_u32 s68, 28
    s_cselect_b32 s70, 1, 0
    s_cbranch_scc1 m_pf7
m_nopf6:
    s_add_u32 m0, s61, 0
    s_nop 0
    buffer_load_dwordx4 v16, s[40:43], s48 offen offset:0 sc1 lds
    buffer_load_dwordx4 v17, s[40:43], s48 offen offset:1024 sc1 lds
    s_add_u32 s48, s48, 128
    buffer_load_dwordx4 v16, s[40:43], s49 offen offset:2048 sc1 lds
    buffer_load_dwordx4 v17, s[40:43], s49 offen offset:3072 sc1 lds
    s_add_u32 s49, s49, 128
    s_add_u32 m0, s61, 4096
    s_nop 0
    buffer_load_dwordx4 v16, s[40:43], s50 offen offset:0 sc1 lds
    buffer_load_dwordx4 v17, s[40:43], s50 offen offset:1024 sc1 lds
    s_add_u32 s50, s50, 128
    buffer_load_dwordx4 v16, s[40:43], s51 offen offset:2048 sc1 lds
    buffer_load_dwordx4 v17, s[40:43], s51 offen offset:3072 sc1 lds
    s_add_u32 s51, s51, 128
    s_add_u32 s61, s61, 32768
    s_cmp_ge_u32 s61, 98304
    s_cselect_b32 s90, 98304, 0
    s_sub_u32 s61, s61, s90
    s_add_u32 m0, s62, 0
    s_nop 0
    buffer_load_dwordx4 v18, s[44:47], s52 offen offset:0 sc1 lds
    buffer_load_dwordx4 v19, s[44:47], s52 offen offset:1024 sc1 lds
    s_add_u32 s52, s52, s56
    buffer_load_dwordx4 v18, s[44:47], s53 offen offset:2048 sc1 lds
    buffer_load_dwordx4 v19, s[44:47], s53 offen offset:3072 sc1 lds
    s_add_u32 s53, s53, s56
    s_add_u32 m0, s62, 4096
    s_nop 0
    buffer_load_dwordx4 v20, s[44:47], s54 offen offset:0 sc1 lds
    buffer_load_dwordx4 v21, s[44:47], s54 offen offset:1024 sc1 lds
    s_add_u32 s54, s54, s56
    buffer_load_dwordx4 v20, s[44:47], s55 offen offset:2048 sc1 lds
    buffer_load_dwordx4 v21, s[44:47], s55 offen offset:3072 sc1 lds
    s_add_u32 s55, s55, s56
    s_xor_b32 s62, s62, 229376
    s_mov_b32 s95, s82
    s_mov_b32 s96, s83
    s_mov_b32 s97, s84
    s_mov_b32 s98, s85
    s_mov_b32 s99, s86
    s_mov_b32 s100, s87
    s_mov_b32 s101, s88
    v_and_b32 v24, 15, v1
    v_lshrrev_b32 v25, 4, v1
    v_bfe_u32 v26, v1, 1, 3
    v_xor_b32 v26, v26, v25
    s_lshl_b32 s90, s57, 14
    v_lshlrev_b32 v27, 7, v24
    v_add_u32 v27, s90, v27
    v_xor_b32 v28, 0, v26
    v_lshl_add_u32 v6, v28, 4, v27
    v_xor_b32 v28, 4, v26
    v_lshl_add_u32 v7, v28, 4, v27
    v_bfe_u32 v26, v1, 2, 2
    v_lshl_add_u32 v27, v25, 3, v26
    v_lshlrev_b32 v27, 9, v27
    v_and_b32 v28, 3, v1
    v_lshlrev_b32 v28, 3, v28
    v_add_u32 v27, v27, v28
    s_lshl_b32 s90, s58, 8
    s_add_u32 s90, s90, 98304
    v_add_u32 v27, s90, v27
    v_bfe_u32 v26, v1, 2, 3
    v_xor_b32 v28, 0, v26
    v_lshl_add_u32 v8, v28, 5, v27
    v_xor_b32 v28, 1, v26
    v_lshl_add_u32 v9, v28, 5, v27
    v_xor_b32 v28, 2, v26
    v_lshl_add_u32 v10, v28, 5, v27
    v_xor_b32 v28, 3, v26
    v_lshl_add_u32 v11, v28, 5, v27
    v_xor_b32 v28, 4, v26
    v_lshl_add_u32 v12, v28, 5, v27
    v_xor_b32 v28, 5, v26
    v_lshl_add_u32 v13, v28, 5, v27
    v_xor_b32 v28, 6, v26
    v_lshl_add_u32 v14, v28, 5, v27
    v_xor_b32 v28, 7, v26
    v_lshl_add_u32 v15, v28, 5, v27
    v_lshlrev_b32 v2, 4, v1
    s_mov_b32 s64, 0
    s_mov_b32 s59, 32768
    s_mov_b32 s60, 229376
    s_mov_b32 s8, s6
    s_mov_b32 s9, s7
    s_mov_b32 s10, 268435456
    s_mov_b32 s11, 0x20000
    s_cmp_ge_u32 s68, 16
    s_cbranch_scc1 m_typea8
    s_bfe_u32 s69, s68, 0x20002
    s_add_u32 s69, s69, 4
    s_and_b32 s90, s2, 7
    s_lshl_b32 s90, s90, 2
    s_and_b32 s91, s68, 3
    s_add_u32 s90, s90, s91
    s_cmp_lt_u32 s90, 16
    s_cselect_b32 s83, 0, 1
    s_mov_b32 s91, 33554432
    s_cselect_b32 s85, 16777216, s91
    s_mov_b32 s91, 8192
    s_cselect_b32 s86, 1024, s91
    s_mov_b32 s91, 1024
    s_cselect_b32 s87, 4096, s91
    s_cselect_b32 s74, s36, s38
    s_cselect_b32 s75, s37, s39
    s_mov_b32 s71, s32
    s_mov_b32 s72, s33
    s_mov_b32 s73, 2097152
    s_mov_b32 s77, 1024
    s_mov_b32 s82, 8
    s_mov_b32 s81, 0
    s_mov_b32 s76, 4194304
    s_mov_b32 s78, 8192
    s_mov_b32 s84, 0
    s_and_b32 s90, s90, 15
    s_lshl_b32 s80, s90, 9
    s_lshl_b32 s79, s69, 18
    s_lshl_b32 s91, s83, 2
    s_add_u32 s91, s91, s69
    s_cmp_ge_u32 s69, 4
    s_cselect_b32 s92, 508, 8
    s_add_u32 s91, s91, s92
    s_lshl_b32 s88, s90, 4
    s_add_u32 s88, s88, s91
    s_lshl_b32 s88, s88, 3
    s_lshl_b32 s91, s90, 1
    s_add_u32 s91, s91, s58
    s_lshl_b32 s91, s91, 19
    s_lshl_b32 s92, s69, 1
    s_add_u32 s92, s92, s57
    s_lshl_b32 s92, s92, 15
    s_add_u32 s85, s85, s91
    s_add_u32 s85, s85, s92
    s_branch m_go29
m_typea8:
    s_and_b32 s69, s68, 3
    s_and_b32 s90, s2, 1
    s_lshl_b32 s90, s90, 2
    s_add_u32 s69, s69, s90
    s_bfe_u32 s90, s2, 0x20001
    s_mul_i32 s90, s90, 3
    s_bfe_u32 s91, s68, 0x20002
    s_add_u32 s90, s90, s91
    s_mov_b32 s76, 6291456
    s_mov_b32 s78, 6144
    s_mov_b32 s81, 1
    s_mov_b32 s73, 4194304
    s_mov_b32 s77, 2048
    s_mov_b32 s82, 16
    s_lshl_b32 s80, s90, 9
    s_lshl_b32 s79, s69, 19
    s_and_b32 s92, s90, 3
    s_lshr_b32 s91, s90, 2
    s_lshl_b32 s88, s92, 2
    s_add_u32 s88, s88, s91
    s_lshl_b32 s88, s88, 3
    s_add_u32 s88, s88, s69
    s_lshl_b32 s88, s88, 3
    s_add_u32 s88, s88, 6144
    s_cmp_eq_u32 s91, 0
    s_cselect_b32 s84, 1048744942, 0
    s_lshl_b32 s93, s91, 22
    s_add_u32 s85, s93, 50331648
    s_lshl_b32 s92, s92, 1
    s_add_u32 s92, s92, s58
    s_lshl_b32 s92, s92, 19
    s_add_u32 s85, s85, s92
    s_lshl_b32 s92, s57, 3
    s_add_u32 s92, s92, s69
    s_cmp_eq_u32 s91, 2
    s_cselect_b32 s83, 1, 0
    s_cselect_b32 s93, 12, 13
    s_mov_b32 s91, 131072
    s_cselect_b32 s86, 1024, s91
    s_mov_b32 s91, 1024
    s_cselect_b32 s87, 65536, s91
    s_lshl_b32 s92, s92, s93
    s_add_u32 s85, s85, s92
    s_mov_b32 s71, s24
    s_mov_b32 s72, s25
    s_mov_b32 s74, s26
    s_mov_b32 s75, s27
m_go29:
    s_xor_b32 s94, s70, 1
    s_mov_b32 s67, 3
    s_mov_b32 s17, -1
    s_mov_b32 s12, s4
    s_mov_b32 s13, s5
    s_mov_b32 s14, 256
    s_mov_b32 s15, 0x20000
    s_lshl_b32 s90, s2, 2
    s_add_u32 s90, s90, s16
    s_cmp_lg_u32 s90, 0
    s_cbranch_scc1 m_tok10
    s_memrealtime s[92:93]
    s_waitcnt lgkmcnt(0)
    s_or_b32 s92, s92, 1
    v_mov_b32 v4, s92
    v_mov_b32 v5, s93
    s_mov_b64 exec, 1
    buffer_store_dwordx2 v[4:5], off, s[12:15], 0 sc1
    s_mov_b64 exec, -1
m_tok10:
    s_add_u32 m0, s61, 0
    s_nop 0
    buffer_load_dwordx4 v16, s[40:43], s48 offen offset:0 sc1 lds
    buffer_load_dwordx4 v17, s[40:43], s48 offen offset:1024 sc1 lds
    s_add_u32 s48, s48, 128
    buffer_load_dwordx4 v16, s[40:43], s49 offen offset:2048 sc1 lds
    buffer_load_dwordx4 v17, s[40:43], s49 offen offset:3072 sc1 lds
    s_add_u32 s49, s49, 128
    s_add_u32 m0, s61, 4096
    s_nop 0
    buffer_load_dwordx4 v16, s[40:43], s50 offen offset:0 sc1 lds
    buffer_load_dwordx4 v17, s[40:43], s50 offen offset:1024 sc1 lds
    s_add_u32 s50, s50, 128
    buffer_load_dwordx4 v16, s[40:43], s51 offen offset:2048 sc1 lds
    buffer_load_dwordx4 v17, s[40:43], s51 offen offset:3072 sc1 lds
    s_add_u32 s51, s51, 128
    s_add_u32 s61, s61, 32768
    s_cmp_ge_u32 s61, 98304
    s_cselect_b32 s90, 98304, 0
    s_sub_u32 s61, s61, s90
    s_add_u32 m0, s62, 0
    s_nop 0
    buffer_load_dwordx4 v18, s[44:47], s52 offen offset:0 sc1 lds
    buffer_load_dwordx4 v19, s[44:47], s52 offen offset:1024 sc1 lds
    s_add_u32 s52, s52, s56
    buffer_load_dwordx4 v18, s[44:47], s53 offen offset:2048 sc1 lds
    buffer_load_dwordx4 v19, s[44:47], s53 offen offset:3072 sc1 lds
    s_add_u32 s53, s53, s56
    s_add_u32 m0, s62, 4096
    s_nop 0
    buffer_load_dwordx4 v20, s[44:47], s54 offen offset:0 sc1 lds
    buffer_load_dwordx4 v21, s[44:47], s54 offen offset:1024 sc1 lds
    s_add_u32 s54, s54, s56
    buffer_load_dwordx4 v20, s[44:47], s55 offen offset:2048 sc1 lds
    buffer_load_dwordx4 v21, s[44:47], s55 offen offset:3072 sc1 lds
    s_add_u32 s55, s55, s56
    s_xor_b32 s62, s62, 229376
    s_waitcnt vmcnt(16)
    s_barrier
    ds_read_b64_tr_b16 a[64:65], v8 offset:0
    ds_read_b64_tr_b16 a[66:67], v8 offset:2048
    ds_read_b64_tr_b16 a[68:69], v8 offset:16384
    ds_read_b64_tr_b16 a[70:71], v8 offset:18432
    ds_read_b64_tr_b16 a[72:73], v9 offset:0
    ds_read_b64_tr_b16 a[74:75], v9 offset:2048
    ds_read_b64_tr_b16 a[76:77], v9 offset:16384
    ds_read_b64_tr_b16 a[78:79], v9 offset:18432
    ds_read_b64_tr_b16 a[80:81], v10 offset:0
    ds_read_b64_tr_b16 a[82:83], v10 offset:2048
    ds_read_b64_tr_b16 a[84:85], v10 offset:16384
    ds_read_b64_tr_b16 a[86:87], v10 offset:18432
    ds_read_b64_tr_b16 a[88:89], v11 offset:0
    ds_read_b64_tr_b16 a[90:91], v11 offset:2048
    ds_read_b64_tr_b16 a[92:93], v11 offset:16384
    ds_read_b64_tr_b16 a[94:95], v11 offset:18432
    ds_read_b64_tr_b16 a[96:97], v12 offset:0
    ds_read_b128 a[0:3], v6 offset:0
    ds_read_b128 a[4:7], v7 offset:0
    ds_read_b64_tr_b16 a[98:99], v12 offset:2048
    ds_read_b128 a[8:11], v6 offset:2048
    ds_read_b128 a[12:15], v7 offset:2048
    ds_read_b64_tr_b16 a[100:101], v12 offset:16384
    ds_read_b128 a[16:19], v6 offset:4096
    ds_read_b128 a[20:23], v7 offset:4096
    ds_read_b64_tr_b16 a[102:103], v12 offset:18432
    ds_read_b128 a[24:27], v6 offset:6144
    ds_read_b128 a[28:31], v7 offset:6144
    ds_read_b64_tr_b16 a[104:105], v13 offset:0
    ds_read_b128 a[32:35], v6 offset:8192
    ds_read_b128 a[36:39], v7 offset:8192
    ds_read_b64_tr_b16 a[106:107], v13 offset:2048
    ds_read_b128 a[40:43], v6 offset:10240
    ds_read_b128 a[44:47], v7 offset:10240
    ds_read_b64_tr_b16 a[108:109], v13 offset:16384
    ds_read_b128 a[48:51], v6 offset:12288
    ds_read_b128 a[52:55], v7 offset:12288
    ds_read_b64_tr_b16 a[110:111], v13 offset:18432
    ds_read_b128 a[56:59], v6 offset:14336
    ds_read_b128 a[60:63], v7 offset:14336
    s_add_u32 m0, s61, 0
    s_nop 0
    buffer_load_dwordx4 v16, s[40:43], s48 offen offset:0 sc1 lds
    buffer_load_dwordx4 v17, s[40:43], s48 offen offset:1024 sc1 lds
    s_add_u32 s48, s48, 128
    buffer_load_dwordx4 v16, s[40:43], s49 offen offset:2048 sc1 lds
    buffer_load_dwordx4 v17, s[40:43], s49 offen offset:3072 sc1 lds
    s_add_u32 s49, s49, 128
    s_add_u32 m0, s61, 4096
    s_nop 0
    buffer_load_dwordx4 v16, s[40:43], s50 offen offset:0 sc1 lds
    buffer_load_dwordx4 v17, s[40:43], s50 offen offset:1024 sc1 lds
    s_add_u32 s50, s50, 128
    buffer_load_dwordx4 v16, s[40:43], s51 offen offset:2048 sc1 lds
    buffer_load_dwordx4 v17, s[40:43], s51 offen offset:3072 sc1 lds
    s_add_u32 s51, s51, 128
    s_add_u32 s61, s61, 32768
    s_cmp_ge_u32 s61, 98304
    s_cselect_b32 s90, 98304, 0
    s_sub_u32 s61, s61, s90
    s_mov_b32 s66, 1
    s_mov_b32 s24, s6
    s_mov_b32 s25, s7
    s_mov_b32 s26, 0
    s_mov_b32 s27, 0x20000
    s_mov_b32 s28, 0
    s_mov_b32 s29, 0
    s_mov_b32 s30, 0
    s_mov_b32 s31, 0
m_tile11:
    s_mov_b32 s65, s95
    s_cmp_eq_u32 s96, 1
    s_cbranch_scc1 m_swp13
    s_waitcnt lgkmcnt(15)
    v_mfma_f32_16x16x32_bf16 v[32:35], a[64:67], a[0:3], 0
    ds_read_b64_tr_b16 a[112:113], v14 offset:0
    v_mfma_f32_16x16x32_bf16 v[32:35], a[68:71], a[4:7], v[32:35]
    ds_read_b64_tr_b16 a[114:115], v14 offset:2048
    v_mfma_f32_16x16x32_bf16 v[36:39], a[72:75], a[0:3], 0
    ds_read_b64_tr_b16 a[116:117], v14 offset:16384
    v_mfma_f32_16x16x32_bf16 v[36:39], a[76:79], a[4:7], v[36:39]
    ds_read_b64_tr_b16 a[118:119], v14 offset:18432
    v_mfma_f32_16x16x32_bf16 v[40:43], a[64:67], a[8:11], 0
    ds_read_b64_tr_b16 a[120:121], v15 offset:0
    v_mfma_f32_16x16x32_bf16 v[40:43], a[68:71], a[12:15], v[40:43]
    ds_read_b64_tr_b16 a[122:123], v15 offset:2048
    v_mfma_f32_16x16x32_bf16 v[44:47], a[72:75], a[8:11], 0
    ds_read_b64_tr_b16 a[124:125], v15 offset:16384
    v_mfma_f32_16x16x32_bf16 v[44:47], a[76:79], a[12:15], v[44:47]
    ds_read_b64_tr_b16 a[126:127], v15 offset:18432
    v_mfma_f32_16x16x32_bf16 v[48:51], a[64:67], a[16:19], 0
    v_mfma_f32_16x16x32_bf16 v[48:51], a[68:71], a[20:23], v[48:51]
    v_mfma_f32_16x16x32_bf16 v[52:55], a[72:75], a[16:19], 0
    buffer_store_dwordx4 a[128:131], v2, s[24:27], s28 offen sc1
    v_mfma_f32_16x16x32_bf16 v[52:55], a[76:79], a[20:23], v[52:55]
    s_add_u32 s28, s28, s31
    s_waitcnt lgkmcnt(15)
    v_mfma_f32_16x16x32_bf16 v[56:59], a[64:67], a[24:27], 0
    v_xor_b32 v8, s60, v8
    v_xor_b32 v9, s60, v9
    v_mfma_f32_16x16x32_bf16 v[56:59], a[68:71], a[28:31], v[56:59]
    v_xor_b32 v10, s60, v10
    v_xor_b32 v11, s60, v11
    v_mfma_f32_16x16x32_bf16 v[60:63], a[72:75], a[24:27], 0
    v_xor_b32 v12, s60, v12
    v_xor_b32 v13, s60, v13
    v_mfma_f32_16x16x32_bf16 v[60:63], a[76:79], a[28:31], v[60:63]
    v_xor_b32 v14, s60, v14
    v_xor_b32 v15, s60, v15
    v_mfma_f32_16x16x32_bf16 v[64:67], a[64:67], a[32:35], 0
    buffer_store_dwordx4 a[132:135], v2, s[24:27], s28 offen sc1
    v_mfma_f32_16x16x32_bf16 v[64:67], a[68:71], a[36:39], v[64:67]
    s_add_u32 s28, s28, s31
    v_mfma_f32_16x16x32_bf16 v[68:71], a[72:75], a[32:35], 0
    v_mfma_f32_16x16x32_bf16 v[68:71], a[76:79], a[36:39], v[68:71]
    s_waitcnt lgkmcnt(14)
    v_mfma_f32_16x16x32_bf16 v[72:75], a[64:67], a[40:43], 0
    v_mfma_f32_16x16x32_bf16 v[72:75], a[68:71], a[44:47], v[72:75]
    v_mfma_f32_16x16x32_bf16 v[76:79], a[72:75], a[40:43], 0
    buffer_store_dwordx4 a[136:139], v2, s[24:27], s28 offen sc1
    v_mfma_f32_16x16x32_bf16 v[76:79], a[76:79], a[44:47], v[76:79]
    s_add_u32 s28, s28, s31
    s_waitcnt lgkmcnt(11)
    v_mfma_f32_16x16x32_bf16 v[80:83], a[64:67], a[48:51], 0
    v_mfma_f32_16x16x32_bf16 v[80:83], a[68:71], a[52:55], v[80:83]
    v_mfma_f32_16x16x32_bf16 v[84:87], a[72:75], a[48:51], 0
    v_mfma_f32_16x16x32_bf16 v[84:87], a[76:79], a[52:55], v[84:87]
    s_waitcnt lgkmcnt(8)
    v_mfma_f32_16x16x32_bf16 v[88:91], a[64:67], a[56:59], 0
    buffer_store_dwordx4 a[140:143], v2, s[24:27], s28 offen sc1
    v_mfma_f32_16x16x32_bf16 v[88:91], a[68:71], a[60:63], v[88:91]
    s_add_u32 s28, s28, s31
    v_mfma_f32_16x16x32_bf16 v[92:95], a[72:75], a[56:59], 0
    s_waitcnt vmcnt(12) lgkmcnt(0)
    v_mfma_f32_16x16x32_bf16 v[92:95], a[76:79], a[60:63], v[92:95]
    s_barrier
    v_mfma_f32_16x16x32_bf16 v[96:99], a[80:83], a[0:3], 0
    ds_read_b64_tr_b16 a[64:65], v8 offset:0
    v_mfma_f32_16x16x32_bf16 v[96:99], a[84:87], a[4:7], v[96:99]
    s_add_u32 m0, s62, 0
    v_mfma_f32_16x16x32_bf16 v[100:103], a[88:91], a[0:3], 0
    buffer_load_dwordx4 v18, s[44:47], s52 offen offset:0 sc1 lds
    v_mfma_f32_16x16x32_bf16 v[100:103], a[92:95], a[4:7], v[100:103]
    ds_read_b64_tr_b16 a[66:67], v8 offset:2048
    v_mfma_f32_16x16x32_bf16 v[104:107], a[80:83], a[8:11], 0
    s_add_u32 s64, s64, 32768
    v_mfma_f32_16x16x32_bf16 v[104:107], a[84:87], a[12:15], v[104:107]
    s_cmp_ge_u32 s64, 98304
    s_cselect_b32 s63, 4294901760, s59
    s_cselect_b32 s64, 0, s64
    v_mfma_f32_16x16x32_bf16 v[108:111], a[88:91], a[8:11], 0
    buffer_load_dwordx4 v19, s[44:47], s52 offen offset:1024 sc1 lds
    v_mfma_f32_16x16x32_bf16 v[108:111], a[92:95], a[12:15], v[108:111]
    s_add_u32 s52, s52, s56
    ds_read_b64_tr_b16 a[68:69], v8 offset:16384
    v_mfma_f32_16x16x32_bf16 v[112:115], a[80:83], a[16:19], 0
    v_mfma_f32_16x16x32_bf16 v[112:115], a[84:87], a[20:23], v[112:115]
    v_mfma_f32_16x16x32_bf16 v[116:119], a[88:91], a[16:19], 0
    buffer_load_dwordx4 v18, s[44:47], s53 offen offset:2048 sc1 lds
    v_mfma_f32_16x16x32_bf16 v[116:119], a[92:95], a[20:23], v[116:119]
    ds_read_b64_tr_b16 a[70:71], v8 offset:18432
    v_mfma_f32_16x16x32_bf16 v[120:123], a[80:83], a[24:27], 0
    v_mfma_f32_16x16x32_bf16 v[120:123], a[84:87], a[28:31], v[120:123]
    v_mfma_f32_16x16x32_bf16 v[124:127], a[88:91], a[24:27], 0
    buffer_load_dwordx4 v19, s[44:47], s53 offen offset:3072 sc1 lds
    v_mfma_f32_16x16x32_bf16 v[124:127], a[92:95], a[28:31], v[124:127]
    s_add_u32 s53, s53, s56
    ds_read_b64_tr_b16 a[72:73], v9 offset:0
    v_mfma_f32_16x16x32_bf16 v[128:131], a[80:83], a[32:35], 0
    v_mfma_f32_16x16x32_bf16 v[128:131], a[84:87], a[36:39], v[128:131]
    s_add_u32 m0, s62, 4096
    v_mfma_f32_16x16x32_bf16 v[132:135], a[88:91], a[32:35], 0
    buffer_load_dwordx4 v20, s[44:47], s54 offen offset:0 sc1 lds
    v_mfma_f32_16x16x32_bf16 v[132:135], a[92:95], a[36:39], v[132:135]
    s_xor_b32 s62, s62, 229376
    ds_read_b64_tr_b16 a[74:75], v9 offset:2048
    v_mfma_f32_16x16x32_bf16 v[136:139], a[80:83], a[40:43], 0
    v_mfma_f32_16x16x32_bf16 v[136:139], a[84:87], a[44:47], v[136:139]
    v_mfma_f32_16x16x32_bf16 v[140:143], a[88:91], a[40:43], 0
    buffer_load_dwordx4 v21, s[44:47], s54 offen offset:1024 sc1 lds
    v_mfma_f32_16x16x32_bf16 v[140:143], a[92:95], a[44:47], v[140:143]
    s_add_u32 s54, s54, s56
    ds_read_b64_tr_b16 a[76:77], v9 offset:16384
    v_mfma_f32_16x16x32_bf16 v[144:147], a[80:83], a[48:51], 0
    v_mfma_f32_16x16x32_bf16 v[144:147], a[84:87], a[52:55], v[144:147]
    v_mfma_f32_16x16x32_bf16 v[148:151], a[88:91], a[48:51], 0
    buffer_load_dwordx4 v20, s[44:47], s55 offen offset:2048 sc1 lds
    v_mfma_f32_16x16x32_bf16 v[148:151], a[92:95], a[52:55], v[148:151]
    ds_read_b64_tr_b16 a[78:79], v9 offset:18432
    v_mfma_f32_16x16x32_bf16 v[152:155], a[80:83], a[56:59], 0
    v_add_u32 v6, s63, v6
    v_add_u32 v7, s63, v7
    v_mfma_f32_16x16x32_bf16 v[152:155], a[84:87], a[60:63], v[152:155]
    v_mfma_f32_16x16x32_bf16 v[156:159], a[88:91], a[56:59], 0
    buffer_load_dwordx4 v21, s[44:47], s55 offen offset:3072 sc1 lds
    v_mfma_f32_16x16x32_bf16 v[156:159], a[92:95], a[60:63], v[156:159]
    s_add_u32 s55, s55, s56
    v_mfma_f32_16x16x32_bf16 v[160:163], a[96:99], a[0:3], 0
    ds_read_b64_tr_b16 a[80:81], v10 offset:0
    v_mfma_f32_16x16x32_bf16 v[160:163], a[100:103], a[4:7], v[160:163]
    v_mfma_f32_16x16x32_bf16 v[164:167], a[104:107], a[0:3], 0
    v_mfma_f32_16x16x32_bf16 v[164:167], a[108:111], a[4:7], v[164:167]
    s_add_u32 m0, s61, 0
    ds_read_b64_tr_b16 a[82:83], v10 offset:2048
    v_mfma_f32_16x16x32_bf16 v[168:171], a[96:99], a[8:11], 0
    buffer_load_dwordx4 v16, s[40:43], s48 offen offset:0 sc1 lds
    v_mfma_f32_16x16x32_bf16 v[168:171], a[100:103], a[12:15], v[168:171]
    v_mfma_f32_16x16x32_bf16 v[172:175], a[104:107], a[8:11], 0
    ds_read_b64_tr_b16 a[84:85], v10 offset:16384
    v_mfma_f32_16x16x32_bf16 v[172:175], a[108:111], a[12:15], v[172:175]
    v_mfma_f32_16x16x32_bf16 v[176:179], a[96:99], a[16:19], 0
    buffer_store_dwordx4 a[144:147], v2, s[24:27], s28 offen sc1
    v_mfma_f32_16x16x32_bf16 v[176:179], a[100:103], a[20:23], v[176:179]
    s_add_u32 s28, s28, s31
    ds_read_b64_tr_b16 a[86:87], v10 offset:18432
    v_mfma_f32_16x16x32_bf16 v[180:183], a[104:107], a[16:19], 0
    v_mfma_f32_16x16x32_bf16 v[180:183], a[108:111], a[20:23], v[180:183]
    v_mfma_f32_16x16x32_bf16 v[184:187], a[96:99], a[24:27], 0
    buffer_load_dwordx4 v17, s[40:43], s48 offen offset:1024 sc1 lds
    v_mfma_f32_16x16x32_bf16 v[184:187], a[100:103], a[28:31], v[184:187]
    s_add_u32 s48, s48, 128
    ds_read_b64_tr_b16 a[88:89], v11 offset:0
    v_mfma_f32_16x16x32_bf16 v[188:191], a[104:107], a[24:27], 0
    v_mfma_f32_16x16x32_bf16 v[188:191], a[108:111], a[28:31], v[188:191]
    v_mfma_f32_16x16x32_bf16 v[192:195], a[96:99], a[32:35], 0
    buffer_store_dwordx4 a[148:151], v2, s[24:27], s28 offen sc1
    v_mfma_f32_16x16x32_bf16 v[192:195], a[100:103], a[36:39], v[192:195]
    s_add_u32 s28, s28, s31
    ds_read_b64_tr_b16 a[90:91], v11 offset:2048
    v_mfma_f32_16x16x32_bf16 v[196:199], a[104:107], a[32:35], 0
    v_mfma_f32_16x16x32_bf16 v[196:199], a[108:111], a[36:39], v[196:199]
    v_mfma_f32_16x16x32_bf16 v[200:203], a[96:99], a[40:43], 0
    buffer_load_dwordx4 v16, s[40:43], s49 offen offset:2048 sc1 lds
    v_mfma_f32_16x16x32_bf16 v[200:203], a[100:103], a[44:47], v[200:203]
    ds_read_b64_tr_b16 a[92:93], v11 offset:16384
    v_mfma_f32_16x16x32_bf16 v[204:207], a[104:107], a[40:43], 0
    v_mfma_f32_16x16x32_bf16 v[204:207], a[108:111], a[44:47], v[204:207]
    v_mfma_f32_16x16x32_bf16 v[208:211], a[96:99], a[48:51], 0
    buffer_store_dwordx4 a[152:155], v2, s[24:27], s28 offen sc1
    v_mfma_f32_16x16x32_bf16 v[208:211], a[100:103], a[52:55], v[208:211]
    s_add_u32 s28, s28, s31
    ds_read_b64_tr_b16 a[94:95], v11 offset:18432
    v_mfma_f32_16x16x32_bf16 v[212:215], a[104:107], a[48:51], 0
    v_mfma_f32_16x16x32_bf16 v[212:215], a[108:111], a[52:55], v[212:215]
    v_mfma_f32_16x16x32_bf16 v[216:219], a[96:99], a[56:59], 0
    buffer_load_dwordx4 v17, s[40:43], s49 offen offset:3072 sc1 lds
    v_mfma_f32_16x16x32_bf16 v[216:219], a[100:103], a[60:63], v[216:219]
    s_add_u32 s49, s49, 128
    v_mfma_f32_16x16x32_bf16 v[220:223], a[104:107], a[56:59], 0
    buffer_store_dwordx4 a[156:159], v2, s[24:27], s28 offen sc1
    v_mfma_f32_16x16x32_bf16 v[220:223], a[108:111], a[60:63], v[220:223]
    s_add_u32 s29, s29, s30
    s_mov_b32 s28, s29
    v_mfma_f32_16x16x32_bf16 v[224:227], a[112:115], a[0:3], 0
    v_mfma_f32_16x16x32_bf16 v[224:227], a[116:119], a[4:7], v[224:227]
    ds_read_b64_tr_b16 a[96:97], v12 offset:0
    v_mfma_f32_16x16x32_bf16 v[228:231], a[120:123], a[0:3], 0
    v_mfma_f32_16x16x32_bf16 v[228:231], a[124:127], a[4:7], v[228:231]
    s_add_u32 m0, s61, 4096
    ds_read_b128 a[0:3], v6 offset:0
    v_mfma_f32_16x16x32_bf16 v[232:235], a[112:115], a[8:11], 0
    buffer_load_dwordx4 v16, s[40:43], s50 offen offset:0 sc1 lds
    v_mfma_f32_16x16x32_bf16 v[232:235], a[116:119], a[12:15], v[232:235]
    s_add_u32 s61, s61, 32768
    ds_read_b128 a[4:7], v7 offset:0
    v_mfma_f32_16x16x32_bf16 v[236:239], a[120:123], a[8:11], 0
    s_cmp_ge_u32 s61, 98304
    s_cselect_b32 s90, 98304, 0
    ds_read_b64_tr_b16 a[98:99], v12 offset:2048
    v_mfma_f32_16x16x32_bf16 v[236:239], a[124:127], a[12:15], v[236:239]
    s_sub_u32 s61, s61, s90
    ds_read_b128 a[8:11], v6 offset:2048
    v_mfma_f32_16x16x32_bf16 v[240:243], a[112:115], a[16:19], 0
    ds_read_b128 a[12:15], v7 offset:2048
    v_mfma_f32_16x16x32_bf16 v[240:243], a[116:119], a[20:23], v[240:243]
    ds_read_b64_tr_b16 a[100:101], v12 offset:16384
    v_mfma_f32_16x16x32_bf16 v[244:247], a[120:123], a[16:19], 0
    v_mfma_f32_16x16x32_bf16 v[244:247], a[124:127], a[20:23], v[244:247]
    ds_read_b128 a[16:19], v6 offset:4096
    v_mfma_f32_16x16x32_bf16 v[248:251], a[112:115], a[24:27], 0
    buffer_load_dwordx4 v17, s[40:43], s50 offen offset:1024 sc1 lds
    v_mfma_f32_16x16x32_bf16 v[248:251], a[116:119], a[28:31], v[248:251]
    s_add_u32 s50, s50, 128
    ds_read_b128 a[20:23], v7 offset:4096
    v_mfma_f32_16x16x32_bf16 v[252:255], a[120:123], a[24:27], 0
    ds_read_b64_tr_b16 a[102:103], v12 offset:18432
    v_mfma_f32_16x16x32_bf16 v[252:255], a[124:127], a[28:31], v[252:255]
    ds_read_b128 a[24:27], v6 offset:6144
    v_mfma_f32_16x16x32_bf16 a[224:227], a[112:115], a[32:35], 0
    s_sub_u32 s65, s65, 1
    ds_read_b128 a[28:31], v7 offset:6144
    v_mfma_f32_16x16x32_bf16 a[224:227], a[116:119], a[36:39], a[224:227]
    ds_read_b64_tr_b16 a[104:105], v13 offset:0
    v_mfma_f32_16x16x32_bf16 a[228:231], a[120:123], a[32:35], 0
    v_mfma_f32_16x16x32_bf16 a[228:231], a[124:127], a[36:39], a[228:231]
    ds_read_b128 a[32:35], v6 offset:8192
    v_mfma_f32_16x16x32_bf16 a[232:235], a[112:115], a[40:43], 0
    buffer_load_dwordx4 v16, s[40:43], s51 offen offset:2048 sc1 lds
    v_mfma_f32_16x16x32_bf16 a[232:235], a[116:119], a[44:47], a[232:235]
    ds_read_b128 a[36:39], v7 offset:8192
    v_mfma_f32_16x16x32_bf16 a[236:239], a[120:123], a[40:43], 0
    ds_read_b64_tr_b16 a[106:107], v13 offset:2048
    v_mfma_f32_16x16x32_bf16 a[236:239], a[124:127], a[44:47], a[236:239]
    ds_read_b128 a[40:43], v6 offset:10240
    v_mfma_f32_16x16x32_bf16 a[240:243], a[112:115], a[48:51], 0
    ds_read_b128 a[44:47], v7 offset:10240
    v_mfma_f32_16x16x32_bf16 a[240:243], a[116:119], a[52:55], a[240:243]
    ds_read_b64_tr_b16 a[108:109], v13 offset:16384
    v_mfma_f32_16x16x32_bf16 a[244:247], a[120:123], a[48:51], 0
    v_mfma_f32_16x16x32_bf16 a[244:247], a[124:127], a[52:55], a[244:247]
    ds_read_b128 a[48:51], v6 offset:12288
    v_mfma_f32_16x16x32_bf16 a[248:251], a[112:115], a[56:59], 0
    buffer_load_dwordx4 v17, s[40:43], s51 offen offset:3072 sc1 lds
    v_mfma_f32_16x16x32_bf16 a[248:251], a[116:119], a[60:63], a[248:251]
    s_add_u32 s51, s51, 128
    ds_read_b128 a[52:55], v7 offset:12288
    v_mfma_f32_16x16x32_bf16 a[252:255], a[120:123], a[56:59], 0
    ds_read_b64_tr_b16 a[110:111], v13 offset:18432
    v_mfma_f32_16x16x32_bf16 a[252:255], a[124:127], a[60:63], a[252:255]
    ds_read_b128 a[56:59], v6 offset:14336
    ds_read_b128 a[60:63], v7 offset:14336
    s_waitcnt lgkmcnt(15)
    v_mfma_f32_16x16x32_bf16 v[32:35], a[64:67], a[0:3], v[32:35]
    ds_read_b64_tr_b16 a[112:113], v14 offset:0
    v_mfma_f32_16x16x32_bf16 v[32:35], a[68:71], a[4:7], v[32:35]
    ds_read_b64_tr_b16 a[114:115], v14 offset:2048
    v_mfma_f32_16x16x32_bf16 v[36:39], a[72:75], a[0:3], v[36:39]
    ds_read_b64_tr_b16 a[116:117], v14 offset:16384
    v_mfma_f32_16x16x32_bf16 v[36:39], a[76:79], a[4:7], v[36:39]
    ds_read_b64_tr_b16 a[118:119], v14 offset:18432
    v_mfma_f32_16x16x32_bf16 v[40:43], a[64:67], a[8:11], v[40:43]
    ds_read_b64_tr_b16 a[120:121], v15 offset:0
    v_mfma_f32_16x16x32_bf16 v[40:43], a[68:71], a[12:15], v[40:43]
    ds_read_b64_tr_b16 a[122:123], v15 offset:2048
    v_mfma_f32_16x16x32_bf16 v[44:47], a[72:75], a[8:11], v[44:47]
    ds_read_b64_tr_b16 a[124:125], v15 offset:16384
    v_mfma_f32_16x16x32_bf16 v[44:47], a[76:79], a[12:15], v[44:47]
    ds_read_b64_tr_b16 a[126:127], v15 offset:18432
    v_mfma_f32_16x16x32_bf16 v[48:51], a[64:67], a[16:19], v[48:51]
    v_mfma_f32_16x16x32_bf16 v[48:51], a[68:71], a[20:23], v[48:51]
    v_mfma_f32_16x16x32_bf16 v[52:55], a[72:75], a[16:19], v[52:55]
    buffer_store_dwordx4 a[160:163], v2, s[24:27], s28 offen sc1
    v_mfma_f32_16x16x32_bf16 v[52:55], a[76:79], a[20:23], v[52:55]
    s_add_u32 s28, s28, s31
    s_waitcnt lgkmcnt(15)
    v_mfma_f32_16x16x32_bf16 v[56:59], a[64:67], a[24:27], v[56:59]
    v_xor_b32 v8, s60, v8
    v_xor_b32 v9, s60, v9
    v_mfma_f32_16x16x32_bf16 v[56:59], a[68:71], a[28:31], v[56:59]
    v_xor_b32 v10, s60, v10
    v_xor_b32 v11, s60, v11
    v_mfma_f32_16x16x32_bf16 v[60:63], a[72:75], a[24:27], v[60:63]
    v_xor_b32 v12, s60, v12
    v_xor_b32 v13, s60, v13
    v_mfma_f32_16x16x32_bf16 v[60:63], a[76:79], a[28:31], v[60:63]
    v_xor_b32 v14, s60, v14
    v_xor_b32 v15, s60, v15
    v_mfma_f32_16x16x32_bf16 v[64:67], a[64:67], a[32:35], v[64:67]
    buffer_store_dwordx4 a[164:167], v2, s[24:27], s28 offen sc1
    v_mfma_f32_16x16x32_bf16 v[64:67], a[68:71], a[36:39], v[64:67]
    s_add_u32 s28, s28, s31
    v_mfma_f32_16x16x32_bf16 v[68:71], a[72:75], a[32:35], v[68:71]
    v_mfma_f32_16x16x32_bf16 v[68:71], a[76:79], a[36:39], v[68:71]
    s_waitcnt lgkmcnt(14)
    v_mfma_f32_16x16x32_bf16 v[72:75], a[64:67], a[40:43], v[72:75]
    v_mfma_f32_16x16x32_bf16 v[72:75], a[68:71], a[44:47], v[72:75]
    v_mfma_f32_16x16x32_bf16 v[76:79], a[72:75], a[40:43], v[76:79]
    buffer_store_dwordx4 a[168:171], v2, s[24:27], s28 offen sc1
    v_mfma_f32_16x16x32_bf16 v[76:79], a[76:79], a[44:47], v[76:79]
    s_add_u32 s28, s28, s31
    s_waitcnt lgkmcnt(11)
    v_mfma_f32_16x16x32_bf16 v[80:83], a[64:67], a[48:51], v[80:83]
    v_mfma_f32_16x16x32_bf16 v[80:83], a[68:71], a[52:55], v[80:83]
    v_mfma_f32_16x16x32_bf16 v[84:87], a[72:75], a[48:51], v[84:87]
    v_mfma_f32_16x16x32_bf16 v[84:87], a[76:79], a[52:55], v[84:87]
    s_waitcnt lgkmcnt(8)
    v_mfma_f32_16x16x32_bf16 v[88:91], a[64:67], a[56:59], v[88:91]
    buffer_store_dwordx4 a[172:175], v2, s[24:27], s28 offen sc1
    v_mfma_f32_16x16x32_bf16 v[88:91], a[68:71], a[60:63], v[88:91]
    s_add_u32 s28, s28, s31
    v_mfma_f32_16x16x32_bf16 v[92:95], a[72:75], a[56:59], v[92:95]
    s_waitcnt vmcnt(16) lgkmcnt(0)
    v_mfma_f32_16x16x32_bf16 v[92:95], a[76:79], a[60:63], v[92:95]
    s_barrier
    v_mfma_f32_16x16x32_bf16 v[96:99], a[80:83], a[0:3], v[96:99]
    ds_read_b64_tr_b16 a[64:65], v8 offset:0
    v_mfma_f32_16x16x32_bf16 v[96:99], a[84:87], a[4:7], v[96:99]
    s_add_u32 m0, s62, 0
    v_mfma_f32_16x16x32_bf16 v[100:103], a[88:91], a[0:3], v[100:103]
    buffer_load_dwordx4 v18, s[44:47], s52 offen offset:0 sc1 lds
    v_mfma_f32_16x16x32_bf16 v[100:103], a[92:95], a[4:7], v[100:103]
    ds_read_b64_tr_b16 a[66:67], v8 offset:2048
    v_mfma_f32_16x16x32_bf16 v[104:107], a[80:83], a[8:11], v[104:107]
    s_add_u32 s64, s64, 32768
    v_mfma_f32_16x16x32_bf16 v[104:107], a[84:87], a[12:15], v[104:107]
    s_cmp_ge_u32 s64, 98304
    s_cselect_b32 s63, 4294901760, s59
    s_cselect_b32 s64, 0, s64
    v_mfma_f32_16x16x32_bf16 v[108:111], a[88:91], a[8:11], v[108:111]
    buffer_load_dwordx4 v19, s[44:47], s52 offen offset:1024 sc1 lds
    v_mfma_f32_16x16x32_bf16 v[108:111], a[92:95], a[12:15], v[108:111]
    s_add_u32 s52, s52, s56
    ds_read_b64_tr_b16 a[68:69], v8 offset:16384
    v_mfma_f32_16x16x32_bf16 v[112:115], a[80:83], a[16:19], v[112:115]
    v_mfma_f32_16x16x32_bf16 v[112:115], a[84:87], a[20:23], v[112:115]
    v_mfma_f32_16x16x32_bf16 v[116:119], a[88:91], a[16:19], v[116:119]
    buffer_load_dwordx4 v18, s[44:47], s53 offen offset:2048 sc1 lds
    v_mfma_f32_16x16x32_bf16 v[116:119], a[92:95], a[20:23], v[116:119]
    ds_read_b64_tr_b16 a[70:71], v8 offset:18432
    v_mfma_f32_16x16x32_bf16 v[120:123], a[80:83], a[24:27], v[120:123]
    v_mfma_f32_16x16x32_bf16 v[120:123], a[84:87], a[28:31], v[120:123]
    v_mfma_f32_16x16x32_bf16 v[124:127], a[88:91], a[24:27], v[124:127]
    buffer_load_dwordx4 v19, s[44:47], s53 offen offset:3072 sc1 lds
    v_mfma_f32_16x16x32_bf16 v[124:127], a[92:95], a[28:31], v[124:127]
    s_add_u32 s53, s53, s56
    ds_read_b64_tr_b16 a[72:73], v9 offset:0
    v_mfma_f32_16x16x32_bf16 v[128:131], a[80:83], a[32:35], v[128:131]
    v_mfma_f32_16x16x32_bf16 v[128:131], a[84:87], a[36:39], v[128:131]
    s_add_u32 m0, s62, 4096
    v_mfma_f32_16x16x32_bf16 v[132:135], a[88:91], a[32:35], v[132:135]
    buffer_load_dwordx4 v20, s[44:47], s54 offen offset:0 sc1 lds
    v_mfma_f32_16x16x32_bf16 v[132:135], a[92:95], a[36:39], v[132:135]
    s_xor_b32 s62, s62, 229376
    ds_read_b64_tr_b16 a[74:75], v9 offset:2048
    v_mfma_f32_16x16x32_bf16 v[136:139], a[80:83], a[40:43], v[136:139]
    v_mfma_f32_16x16x32_bf16 v[136:139], a[84:87], a[44:47], v[136:139]
    v_mfma_f32_16x16x32_bf16 v[140:143], a[88:91], a[40:43], v[140:143]
    buffer_load_dwordx4 v21, s[44:47], s54 offen offset:1024 sc1 lds
    v_mfma_f32_16x16x32_bf16 v[140:143], a[92:95], a[44:47], v[140:143]
    s_add_u32 s54, s54, s56
    ds_read_b64_tr_b16 a[76:77], v9 offset:16384
    v_mfma_f32_16x16x32_bf16 v[144:147], a[80:83], a[48:51], v[144:147]
    v_mfma_f32_16x16x32_bf16 v[144:147], a[84:87], a[52:55], v[144:147]
    v_mfma_f32_16x16x32_bf16 v[148:151], a[88:91], a[48:51], v[148:151]
    buffer_load_dwordx4 v20, s[44:47], s55 offen offset:2048 sc1 lds
    v_mfma_f32_16x16x32_bf16 v[148:151], a[92:95], a[52:55], v[148:151]
    ds_read_b64_tr_b16 a[78:79], v9 offset:18432
    v_mfma_f32_16x16x32_bf16 v[152:155], a[80:83], a[56:59], v[152:155]
    v_add_u32 v6, s63, v6
    v_add_u32 v7, s63, v7
    v_mfma_f32_16x16x32_bf16 v[152:155], a[84:87], a[60:63], v[152:155]
    v_mfma_f32_16x16x32_bf16 v[156:159], a[88:91], a[56:59], v[156:159]
    buffer_load_dwordx4 v21, s[44:47], s55 offen offset:3072 sc1 lds
    v_mfma_f32_16x16x32_bf16 v[156:159], a[92:95], a[60:63], v[156:159]
    s_add_u32 s55, s55, s56
    v_mfma_f32_16x16x32_bf16 v[160:163], a[96:99], a[0:3], v[160:163]
    ds_read_b64_tr_b16 a[80:81], v10 offset:0
    v_mfma_f32_16x16x32_bf16 v[160:163], a[100:103], a[4:7], v[160:163]
    v_mfma_f32_16x16x32_bf16 v[164:167], a[104:107], a[0:3], v[164:167]
    v_mfma_f32_16x16x32_bf16 v[164:167], a[108:111], a[4:7], v[164:167]
    s_add_u32 m0, s61, 0
    ds_read_b64_tr_b16 a[82:83], v10 offset:2048
    v_mfma_f32_16x16x32_bf16 v[168:171], a[96:99], a[8:11], v[168:171]
    buffer_load_dwordx4 v16, s[40:43], s48 offen offset:0 sc1 lds
    v_mfma_f32_16x16x32_bf16 v[168:171], a[100:103], a[12:15], v[168:171]
    v_mfma_f32_16x16x32_bf16 v[172:175], a[104:107], a[8:11], v[172:175]
    ds_read_b64_tr_b16 a[84:85], v10 offset:16384
    v_mfma_f32_16x16x32_bf16 v[172:175], a[108:111], a[12:15], v[172:175]
    v_mfma_f32_16x16x32_bf16 v[176:179], a[96:99], a[16:19], v[176:179]
    buffer_store_dwordx4 a[176:179], v2, s[24:27], s28 offen sc1
    v_mfma_f32_16x16x32_bf16 v[176:179], a[100:103], a[20:23], v[176:179]
    s_add_u32 s28, s28, s31
    ds_read_b64_tr_b16 a[86:87], v10 offset:18432
    v_mfma_f32_16x16x32_bf16 v[180:183], a[104:107], a[16:19], v[180:183]
    v_mfma_f32_16x16x32_bf16 v[180:183], a[108:111], a[20:23], v[180:183]
    v_mfma_f32_16x16x32_bf16 v[184:187], a[96:99], a[24:27], v[184:187]
    buffer_load_dwordx4 v17, s[40:43], s48 offen offset:1024 sc1 lds
    v_mfma_f32_16x16x32_bf16 v[184:187], a[100:103], a[28:31], v[184:187]
    s_add_u32 s48, s48, 128
    ds_read_b64_tr_b16 a[88:89], v11 offset:0
    v_mfma_f32_16x16x32_bf16 v[188:191], a[104:107], a[24:27], v[188:191]
    v_mfma_f32_16x16x32_bf16 v[188:191], a[108:111], a[28:31], v[188:191]
    v_mfma_f32_16x16x32_bf16 v[192:195], a[96:99], a[32:35], v[192:195]
    buffer_store_dwordx4 a[180:183], v2, s[24:27], s28 offen sc1
    v_mfma_f32_16x16x32_bf16 v[192:195], a[100:103], a[36:39], v[192:195]
    s_add_u32 s28, s28, s31
    ds_read_b64_tr_b16 a[90:91], v11 offset:2048
    v_mfma_f32_16x16x32_bf16 v[196:199], a[104:107], a[32:35], v[196:199]
    v_mfma_f32_16x16x32_bf16 v[196:199], a[108:111], a[36:39], v[196:199]
    v_mfma_f32_16x16x32_bf16 v[200:203], a[96:99], a[40:43], v[200:203]
    buffer_load_dwordx4 v16, s[40:43], s49 offen offset:2048 sc1 lds
    v_mfma_f32_16x16x32_bf16 v[200:203], a[100:103], a[44:47], v[200:203]
    ds_read_b64_tr_b16 a[92:93], v11 offset:16384
    v_mfma_f32_16x16x32_bf16 v[204:207], a[104:107], a[40:43], v[204:207]
    v_mfma_f32_16x16x32_bf16 v[204:207], a[108:111], a[44:47], v[204:207]
    v_mfma_f32_16x16x32_bf16 v[208:211], a[96:99], a[48:51], v[208:211]
    buffer_store_dwordx4 a[184:187], v2, s[24:27], s28 offen sc1
    v_mfma_f32_16x16x32_bf16 v[208:211], a[100:103], a[52:55], v[208:211]
    s_add_u32 s28, s28, s31
    ds_read_b64_tr_b16 a[94:95], v11 offset:18432
    v_mfma_f32_16x16x32_bf16 v[212:215], a[104:107], a[48:51], v[212:215]
    v_mfma_f32_16x16x32_bf16 v[212:215], a[108:111], a[52:55], v[212:215]
    v_mfma_f32_16x16x32_bf16 v[216:219], a[96:99], a[56:59], v[216:219]
    buffer_load_dwordx4 v17, s[40:43], s49 offen offset:3072 sc1 lds
    v_mfma_f32_16x16x32_bf16 v[216:219], a[100:103], a[60:63], v[216:219]
    s_add_u32 s49, s49, 128
    v_mfma_f32_16x16x32_bf16 v[220:223], a[104:107], a[56:59], v[220:223]
    buffer_store_dwordx4 a[188:191], v2, s[24:27], s28 offen sc1
    v_mfma_f32_16x16x32_bf16 v[220:223], a[108:111], a[60:63], v[220:223]
    s_add_u32 s29, s29, s30
    s_mov_b32 s28, s29
    v_mfma_f32_16x16x32_bf16 v[224:227], a[112:115], a[0:3], v[224:227]
    v_mfma_f32_16x16x32_bf16 v[224:227], a[116:119], a[4:7], v[224:227]
    ds_read_b64_tr_b16 a[96:97], v12 offset:0
    v_mfma_f32_16x16x32_bf16 v[228:231], a[120:123], a[0:3], v[228:231]
    v_mfma_f32_16x16x32_bf16 v[228:231], a[124:127], a[4:7], v[228:231]
    s_add_u32 m0, s61, 4096
    ds_read_b128 a[0:3], v6 offset:0
    v_mfma_f32_16x16x32_bf16 v[232:235], a[112:115], a[8:11], v[232:235]
    buffer_load_dwordx4 v16, s[40:43], s50 offen offset:0 sc1 lds
    v_mfma_f32_16x16x32_bf16 v[232:235], a[116:119], a[12:15], v[232:235]
    s_add_u32 s61, s61, 32768
    ds_read_b128 a[4:7], v7 offset:0
    v_mfma_f32_16x16x32_bf16 v[236:239], a[120:123], a[8:11], v[236:239]
    s_cmp_ge_u32 s61, 98304
    s_cselect_b32 s90, 98304, 0
    ds_read_b64_tr_b16 a[98:99], v12 offset:2048
    v_mfma_f32_16x16x32_bf16 v[236:239], a[124:127], a[12:15], v[236:239]
    s_sub_u32 s61, s61, s90
    ds_read_b128 a[8:11], v6 offset:2048
    v_mfma_f32_16x16x32_bf16 v[240:243], a[112:115], a[16:19], v[240:243]
    ds_read_b128 a[12:15], v7 offset:2048
    v_mfma_f32_16x16x32_bf16 v[240:243], a[116:119], a[20:23], v[240:243]
    ds_read_b64_tr_b16 a[100:101], v12 offset:16384
    v_mfma_f32_16x16x32_bf16 v[244:247], a[120:123], a[16:19], v[244:247]
    v_mfma_f32_16x16x32_bf16 v[244:247], a[124:127], a[20:23], v[244:247]
    ds_read_b128 a[16:19], v6 offset:4096
    v_mfma_f32_16x16x32_bf16 v[248:251], a[112:115], a[24:27], v[248:251]
    buffer_load_dwordx4 v17, s[40:43], s50 offen offset:1024 sc1 lds
    v_mfma_f32_16x16x32_bf16 v[248:251], a[116:119], a[28:31], v[248:251]
    s_add_u32 s50, s50, 128
    ds_read_b128 a[20:23], v7 offset:4096
    v_mfma_f32_16x16x32_bf16 v[252:255], a[120:123], a[24:27], v[252:255]
    ds_read_b64_tr_b16 a[102:103], v12 offset:18432
    v_mfma_f32_16x16x32_bf16 v[252:255], a[124:127], a[28:31], v[252:255]
    ds_read_b128 a[24:27], v6 offset:6144
    v_mfma_f32_16x16x32_bf16 a[224:227], a[112:115], a[32:35], a[224:227]
    s_sub_u32 s65, s65, 1
    ds_read_b128 a[28:31], v7 offset:6144
    v_mfma_f32_16x16x32_bf16 a[224:227], a[116:119], a[36:39], a[224:227]
    ds_read_b64_tr_b16 a[104:105], v13 offset:0
    v_mfma_f32_16x16x32_bf16 a[228:231], a[120:123], a[32:35], a[228:231]
    v_mfma_f32_16x16x32_bf16 a[228:231], a[124:127], a[36:39], a[228:231]
    ds_read_b128 a[32:35], v6 offset:8192
    v_mfma_f32_16x16x32_bf16 a[232:235], a[112:115], a[40:43], a[232:235]
    buffer_load_dwordx4 v16, s[40:43], s51 offen offset:2048 sc1 lds
    v_mfma_f32_16x16x32_bf16 a[232:235], a[116:119], a[44:47], a[232:235]
    ds_read_b128 a[36:39], v7 offset:8192
    v_mfma_f32_16x16x32_bf16 a[236:239], a[120:123], a[40:43], a[236:239]
    ds_read_b64_tr_b16 a[106:107], v13 offset:2048
    v_mfma_f32_16x16x32_bf16 a[236:239], a[124:127], a[44:47], a[236:239]
    ds_read_b128 a[40:43], v6 offset:10240
    v_mfma_f32_16x16x32_bf16 a[240:243], a[112:115], a[48:51], a[240:243]
    ds_read_b128 a[44:47], v7 offset:10240
    v_mfma_f32_16x16x32_bf16 a[240:243], a[116:119], a[52:55], a[240:243]
    ds_read_b64_tr_b16 a[108:109], v13 offset:16384
    v_mfma_f32_16x16x32_bf16 a[244:247], a[120:123], a[48:51], a[244:247]
    v_mfma_f32_16x16x32_bf16 a[244:247], a[124:127], a[52:55], a[244:247]
    ds_read_b128 a[48:51], v6 offset:12288
    v_mfma_f32_16x16x32_bf16 a[248:251], a[112:115], a[56:59], a[248:251]
    buffer_load_dwordx4 v17, s[40:43], s51 offen offset:3072 sc1 lds
    v_mfma_f32_16x16x32_bf16 a[248:251], a[116:119], a[60:63], a[248:251]
    s_add_u32 s51, s51, 128
    ds_read_b128 a[52:55], v7 offset:12288
    v_mfma_f32_16x16x32_bf16 a[252:255], a[120:123], a[56:59], a[252:255]
    ds_read_b64_tr_b16 a[110:111], v13 offset:18432
    v_mfma_f32_16x16x32_bf16 a[252:255], a[124:127], a[60:63], a[252:255]
    ds_read_b128 a[56:59], v6 offset:14336
    ds_read_b128 a[60:63], v7 offset:14336
    s_cmp_eq_u32 s66, 2
    s_cbranch_scc1 m_hook14
m_hookr15:
    s_waitcnt lgkmcnt(15)
    v_mfma_f32_16x16x32_bf16 v[32:35], a[64:67], a[0:3], v[32:35]
    ds_read_b64_tr_b16 a[112:113], v14 offset:0
    v_mfma_f32_16x16x32_bf16 v[32:35], a[68:71], a[4:7], v[32:35]
    ds_read_b64_tr_b16 a[114:115], v14 offset:2048
    v_mfma_f32_16x16x32_bf16 v[36:39], a[72:75], a[0:3], v[36:39]
    ds_read_b64_tr_b16 a[116:117], v14 offset:16384
    v_mfma_f32_16x16x32_bf16 v[36:39], a[76:79], a[4:7], v[36:39]
    ds_read_b64_tr_b16 a[118:119], v14 offset:18432
    v_mfma_f32_16x16x32_bf16 v[40:43], a[64:67], a[8:11], v[40:43]
    ds_read_b64_tr_b16 a[120:121], v15 offset:0
    v_mfma_f32_16x16x32_bf16 v[40:43], a[68:71], a[12:15], v[40:43]
    ds_read_b64_tr_b16 a[122:123], v15 offset:2048
    v_mfma_f32_16x16x32_bf16 v[44:47], a[72:75], a[8:11], v[44:47]
    ds_read_b64_tr_b16 a[124:125], v15 offset:16384
    v_mfma_f32_16x16x32_bf16 v[44:47], a[76:79], a[12:15], v[44:47]
    ds_read_b64_tr_b16 a[126:127], v15 offset:18432
    v_mfma_f32_16x16x32_bf16 v[48:51], a[64:67], a[16:19], v[48:51]
    v_mfma_f32_16x16x32_bf16 v[48:51], a[68:71], a[20:23], v[48:51]
    v_mfma_f32_16x16x32_bf16 v[52:55], a[72:75], a[16:19], v[52:55]
    buffer_store_dwordx4 a[192:195], v2, s[24:27], s28 offen sc1
    v_mfma_f32_16x16x32_bf16 v[52:55], a[76:79], a[20:23], v[52:55]
    s_add_u32 s28, s28, s31
    s_waitcnt lgkmcnt(15)
    v_mfma_f32_16x16x32_bf16 v[56:59], a[64:67], a[24:27], v[56:59]
    v_xor_b32 v8, s60, v8
    v_xor_b32 v9, s60, v9
    v_mfma_f32_16x16x32_bf16 v[56:59], a[68:71], a[28:31], v[56:59]
    v_xor_b32 v10, s60, v10
    v_xor_b32 v11, s60, v11
    v_mfma_f32_16x16x32_bf16 v[60:63], a[72:75], a[24:27], v[60:63]
    v_xor_b32 v12, s60, v12
    v_xor_b32 v13, s60, v13
    v_mfma_f32_16x16x32_bf16 v[60:63], a[76:79], a[28:31], v[60:63]
    v_xor_b32 v14, s60, v14
    v_xor_b32 v15, s60, v15
    v_mfma_f32_16x16x32_bf16 v[64:67], a[64:67], a[32:35], v[64:67]
    buffer_store_dwordx4 a[196:199], v2, s[24:27], s28 offen sc1
    v_mfma_f32_16x16x32_bf16 v[64:67], a[68:71], a[36:39], v[64:67]
    s_add_u32 s28, s28, s31
    v_mfma_f32_16x16x32_bf16 v[68:71], a[72:75], a[32:35], v[68:71]
    v_mfma_f32_16x16x32_bf16 v[68:71], a[76:79], a[36:39], v[68:71]
    s_waitcnt lgkmcnt(14)
    v_mfma_f32_16x16x32_bf16 v[72:75], a[64:67], a[40:43], v[72:75]
    v_mfma_f32_16x16x32_bf16 v[72:75], a[68:71], a[44:47], v[72:75]
    v_mfma_f32_16x16x32_bf16 v[76:79], a[72:75], a[40:43], v[76:79]
    buffer_store_dwordx4 a[200:203], v2, s[24:27], s28 offen sc1
    v_mfma_f32_16x16x32_bf16 v[76:79], a[76:79], a[44:47], v[76:79]
    s_add_u32 s28, s28, s31
    s_waitcnt lgkmcnt(11)
    v_mfma_f32_16x16x32_bf16 v[80:83], a[64:67], a[48:51], v[80:83]
    v_mfma_f32_16x16x32_bf16 v[80:83], a[68:71], a[52:55], v[80:83]
    v_mfma_f32_16x16x32_bf16 v[84:87], a[72:75], a[48:51], v[84:87]
    v_mfma_f32_16x16x32_bf16 v[84:87], a[76:79], a[52:55], v[84:87]
    s_waitcnt lgkmcnt(8)
    v_mfma_f32_16x16x32_bf16 v[88:91], a[64:67], a[56:59], v[88:91]
    buffer_store_dwordx4 a[204:207], v2, s[24:27], s28 offen sc1
    v_mfma_f32_16x16x32_bf16 v[88:91], a[68:71], a[60:63], v[88:91]
    s_add_u32 s28, s28, s31
    v_mfma_f32_16x16x32_bf16 v[92:95], a[72:75], a[56:59], v[92:95]
    s_waitcnt vmcnt(16) lgkmcnt(0)
    v_mfma_f32_16x16x32_bf16 v[92:95], a[76:79], a[60:63], v[92:95]
    s_barrier
    v_mfma_f32_16x16x32_bf16 v[96:99], a[80:83], a[0:3], v[96:99]
    ds_read_b64_tr_b16 a[64:65], v8 offset:0
    v_mfma_f32_16x16x32_bf16 v[96:99], a[84:87], a[4:7], v[96:99]
    s_add_u32 m0, s62, 0
    v_mfma_f32_16x16x32_bf16 v[100:103], a[88:91], a[0:3], v[100:103]
    buffer_load_dwordx4 v18, s[44:47], s52 offen offset:0 sc1 lds
    v_mfma_f32_16x16x32_bf16 v[100:103], a[92:95], a[4:7], v[100:103]
    ds_read_b64_tr_b16 a[66:67], v8 offset:2048
    v_mfma_f32_16x16x32_bf16 v[104:107], a[80:83], a[8:11], v[104:107]
    s_add_u32 s64, s64, 32768
    v_mfma_f32_16x16x32_bf16 v[104:107], a[84:87], a[12:15], v[104:107]
    s_cmp_ge_u32 s64, 98304
    s_cselect_b32 s63, 4294901760, s59
    s_cselect_b32 s64, 0, s64
    v_mfma_f32_16x16x32_bf16 v[108:111], a[88:91], a[8:11], v[108:111]
    buffer_load_dwordx4 v19, s[44:47], s52 offen offset:1024 sc1 lds
    v_mfma_f32_16x16x32_bf16 v[108:111], a[92:95], a[12:15], v[108:111]
    s_add_u32 s52, s52, s56
    ds_read_b64_tr_b16 a[68:69], v8 offset:16384
    v_mfma_f32_16x16x32_bf16 v[112:115], a[80:83], a[16:19], v[112:115]
    v_mfma_f32_16x16x32_bf16 v[112:115], a[84:87], a[20:23], v[112:115]
    v_mfma_f32_16x16x32_bf16 v[116:119], a[88:91], a[16:19], v[116:119]
    buffer_load_dwordx4 v18, s[44:47], s53 offen offset:2048 sc1 lds
    v_mfma_f32_16x16x32_bf16 v[116:119], a[92:95], a[20:23], v[116:119]
    ds_read_b64_tr_b16 a[70:71], v8 offset:18432
    v_mfma_f32_16x16x32_bf16 v[120:123], a[80:83], a[24:27], v[120:123]
    v_mfma_f32_16x16x32_bf16 v[120:123], a[84:87], a[28:31], v[120:123]
    v_mfma_f32_16x16x32_bf16 v[124:127], a[88:91], a[24:27], v[124:127]
    buffer_load_dwordx4 v19, s[44:47], s53 offen offset:3072 sc1 lds
    v_mfma_f32_16x16x32_bf16 v[124:127], a[92:95], a[28:31], v[124:127]
    s_add_u32 s53, s53, s56
    ds_read_b64_tr_b16 a[72:73], v9 offset:0
    v_mfma_f32_16x16x32_bf16 v[128:131], a[80:83], a[32:35], v[128:131]
    v_mfma_f32_16x16x32_bf16 v[128:131], a[84:87], a[36:39], v[128:131]
    s_add_u32 m0, s62, 4096
    v_mfma_f32_16x16x32_bf16 v[132:135], a[88:91], a[32:35], v[132:135]
    buffer_load_dwordx4 v20, s[44:47], s54 offen offset:0 sc1 lds
    v_mfma_f32_16x16x32_bf16 v[132:135], a[92:95], a[36:39], v[132:135]
    s_xor_b32 s62, s62, 229376
    ds_read_b64_tr_b16 a[74:75], v9 offset:2048
    v_mfma_f32_16x16x32_bf16 v[136:139], a[80:83], a[40:43], v[136:139]
    v_mfma_f32_16x16x32_bf16 v[136:139], a[84:87], a[44:47], v[136:139]
    v_mfma_f32_16x16x32_bf16 v[140:143], a[88:91], a[40:43], v[140:143]
    buffer_load_dwordx4 v21, s[44:47], s54 offen offset:1024 sc1 lds
    v_mfma_f32_16x16x32_bf16 v[140:143], a[92:95], a[44:47], v[140:143]
    s_add_u32 s54, s54, s56
    ds_read_b64_tr_b16 a[76:77], v9 offset:16384
    v_mfma_f32_16x16x32_bf16 v[144:147], a[80:83], a[48:51], v[144:147]
    v_mfma_f32_16x16x32_bf16 v[144:147], a[84:87], a[52:55], v[144:147]
    v_mfma_f32_16x16x32_bf16 v[148:151], a[88:91], a[48:51], v[148:151]
    buffer_load_dwordx4 v20, s[44:47], s55 offen offset:2048 sc1 lds
    v_mfma_f32_16x16x32_bf16 v[148:151], a[92:95], a[52:55], v[148:151]
    ds_read_b64_tr_b16 a[78:79], v9 offset:18432
    v_mfma_f32_16x16x32_bf16 v[152:155], a[80:83], a[56:59], v[152:155]
    v_add_u32 v6, s63, v6
    v_add_u32 v7, s63, v7
    v_mfma_f32_16x16x32_bf16 v[152:155], a[84:87], a[60:63], v[152:155]
    v_mfma_f32_16x16x32_bf16 v[156:159], a[88:91], a[56:59], v[156:159]
    buffer_load_dwordx4 v21, s[44:47], s55 offen offset:3072 sc1 lds
    v_mfma_f32_16x16x32_bf16 v[156:159], a[92:95], a[60:63], v[156:159]
    s_add_u32 s55, s55, s56
    v_mfma_f32_16x16x32_bf16 v[160:163], a[96:99], a[0:3], v[160:163]
    ds_read_b64_tr_b16 a[80:81], v10 offset:0
    v_mfma_f32_16x16x32_bf16 v[160:163], a[100:103], a[4:7], v[160:163]
    v_mfma_f32_16x16x32_bf16 v[164:167], a[104:107], a[0:3], v[164:167]
    v_mfma_f32_16x16x32_bf16 v[164:167], a[108:111], a[4:7], v[164:167]
    s_add_u32 m0, s61, 0
    ds_read_b64_tr_b16 a[82:83], v10 offset:2048
    v_mfma_f32_16x16x32_bf16 v[168:171], a[96:99], a[8:11], v[168:171]
    buffer_load_dwordx4 v16, s[40:43], s48 offen offset:0 sc1 lds
    v_mfma_f32_16x16x32_bf16 v[168:171], a[100:103], a[12:15], v[168:171]
    v_mfma_f32_16x16x32_bf16 v[172:175], a[104:107], a[8:11], v[172:175]
    ds_read_b64_tr_b16 a[84:85], v10 offset:16384
    v_mfma_f32_16x16x32_bf16 v[172:175], a[108:111], a[12:15], v[172:175]
    v_mfma_f32_16x16x32_bf16 v[176:179], a[96:99], a[16:19], v[176:179]
    buffer_store_dwordx4 a[208:211], v2, s[24:27], s28 offen sc1
    v_mfma_f32_16x16x32_bf16 v[176:179], a[100:103], a[20:23], v[176:179]
    s_add_u32 s28, s28, s31
    ds_read_b64_tr_b16 a[86:87], v10 offset:18432
    v_mfma_f32_16x16x32_bf16 v[180:183], a[104:107], a[16:19], v[180:183]
    v_mfma_f32_16x16x32_bf16 v[180:183], a[108:111], a[20:23], v[180:183]
    v_mfma_f32_16x16x32_bf16 v[184:187], a[96:99], a[24:27], v[184:187]
    buffer_load_dwordx4 v17, s[40:43], s48 offen offset:1024 sc1 lds
    v_mfma_f32_16x16x32_bf16 v[184:187], a[100:103], a[28:31], v[184:187]
    s_add_u32 s48, s48, 128
    ds_read_b64_tr_b16 a[88:89], v11 offset:0
    v_mfma_f32_16x16x32_bf16 v[188:191], a[104:107], a[24:27], v[188:191]
    v_mfma_f32_16x16x32_bf16 v[188:191], a[108:111], a[28:31], v[188:191]
    v_mfma_f32_16x16x32_bf16 v[192:195], a[96:99], a[32:35], v[192:195]
    buffer_store_dwordx4 a[212:215], v2, s[24:27], s28 offen sc1
    v_mfma_f32_16x16x32_bf16 v[192:195], a[100:103], a[36:39], v[192:195]
    s_add_u32 s28, s28, s31
    ds_read_b64_tr_b16 a[90:91], v11 offset:2048
    v_mfma_f32_16x16x32_bf16 v[196:199], a[104:107], a[32:35], v[196:199]
    v_mfma_f32_16x16x32_bf16 v[196:199], a[108:111], a[36:39], v[196:199]
    v_mfma_f32_16x16x32_bf16 v[200:203], a[96:99], a[40:43], v[200:203]
    buffer_load_dwordx4 v16, s[40:43], s49 offen offset:2048 sc1 lds
    v_mfma_f32_16x16x32_bf16 v[200:203], a[100:103], a[44:47], v[200:203]
    ds_read_b64_tr_b16 a[92:93], v11 offset:16384
    v_mfma_f32_16x16x32_bf16 v[204:207], a[104:107], a[40:43], v[204:207]
    v_mfma_f32_16x16x32_bf16 v[204:207], a[108:111], a[44:47], v[204:207]
    v_mfma_f32_16x16x32_bf16 v[208:211], a[96:99], a[48:51], v[208:211]
    buffer_store_dwordx4 a[216:219], v2, s[24:27], s28 offen sc1
    v_mfma_f32_16x16x32_bf16 v[208:211], a[100:103], a[52:55], v[208:211]
    s_add_u32 s28, s28, s31
    ds_read_b64_tr_b16 a[94:95], v11 offset:18432
    v_mfma_f32_16x16x32_bf16 v[212:215], a[104:107], a[48:51], v[212:215]
    v_mfma_f32_16x16x32_bf16 v[212:215], a[108:111], a[52:55], v[212:215]
    v_mfma_f32_16x16x32_bf16 v[216:219], a[96:99], a[56:59], v[216:219]
    buffer_load_dwordx4 v17, s[40:43], s49 offen offset:3072 sc1 lds
    v_mfma_f32_16x16x32_bf16 v[216:219], a[100:103], a[60:63], v[216:219]
    s_add_u32 s49, s49, 128
    v_mfma_f32_16x16x32_bf16 v[220:223], a[104:107], a[56:59], v[220:223]
    buffer_store_dwordx4 a[220:223], v2, s[24:27], s28 offen sc1
    v_mfma_f32_16x16x32_bf16 v[220:223], a[108:111], a[60:63], v[220:223]
    s_add_u32 s29, s29, s30
    s_mov_b32 s28, s29
    v_mfma_f32_16x16x32_bf16 v[224:227], a[112:115], a[0:3], v[224:227]
    v_mfma_f32_16x16x32_bf16 v[224:227], a[116:119], a[4:7], v[224:227]
    ds_read_b64_tr_b16 a[96:97], v12 offset:0
    v_mfma_f32_16x16x32_bf16 v[228:231], a[120:123], a[0:3], v[228:231]
    v_mfma_f32_16x16x32_bf16 v[228:231], a[124:127], a[4:7], v[228:231]
    s_add_u32 m0, s61, 4096
    ds_read_b128 a[0:3], v6 offset:0
    v_mfma_f32_16x16x32_bf16 v[232:235], a[112:115], a[8:11], v[232:235]
    buffer_load_dwordx4 v16, s[40:43], s50 offen offset:0 sc1 lds
    v_mfma_f32_16x16x32_bf16 v[232:235], a[116:119], a[12:15], v[232:235]
    s_add_u32 s61, s61, 32768
    ds_read_b128 a[4:7], v7 offset:0
    v_mfma_f32_16x16x32_bf16 v[236:239], a[120:123], a[8:11], v[236:239]
    s_cmp_ge_u32 s61, 98304
    s_cselect_b32 s90, 98304, 0
    ds_read_b64_tr_b16 a[98:99], v12 offset:2048
    v_mfma_f32_16x16x32_bf16 v[236:239], a[124:127], a[12:15], v[236:239]
    s_sub_u32 s61, s61, s90
    ds_read_b128 a[8:11], v6 offset:2048
    v_mfma_f32_16x16x32_bf16 v[240:243], a[112:115], a[16:19], v[240:243]
    ds_read_b128 a[12:15], v7 offset:2048
    v_mfma_f32_16x16x32_bf16 v[240:243], a[116:119], a[20:23], v[240:243]
    ds_read_b64_tr_b16 a[100:101], v12 offset:16384
    v_mfma_f32_16x16x32_bf16 v[244:247], a[120:123], a[16:19], v[244:247]
    v_mfma_f32_16x16x32_bf16 v[244:247], a[124:127], a[20:23], v[244:247]
    ds_read_b128 a[16:19], v6 offset:4096
    v_mfma_f32_16x16x32_bf16 v[248:251], a[112:115], a[24:27], v[248:251]
    buffer_load_dwordx4 v17, s[40:43], s50 offen offset:1024 sc1 lds
    v_mfma_f32_16x16x32_bf16 v[248:251], a[116:119], a[28:31], v[248:251]
    s_add_u32 s50, s50, 128
    ds_read_b128 a[20:23], v7 offset:4096
    v_mfma_f32_16x16x32_bf16 v[252:255], a[120:123], a[24:27], v[252:255]
    ds_read_b64_tr_b16 a[102:103], v12 offset:18432
    v_mfma_f32_16x16x32_bf16 v[252:255], a[124:127], a[28:31], v[252:255]
    ds_read_b128 a[24:27], v6 offset:6144
    v_mfma_f32_16x16x32_bf16 a[224:227], a[112:115], a[32:35], a[224:227]
    s_sub_u32 s65, s65, 1
    ds_read_b128 a[28:31], v7 offset:6144
    v_mfma_f32_16x16x32_bf16 a[224:227], a[116:119], a[36:39], a[224:227]
    ds_read_b64_tr_b16 a[104:105], v13 offset:0
    v_mfma_f32_16x16x32_bf16 a[228:231], a[120:123], a[32:35], a[228:231]
    v_mfma_f32_16x16x32_bf16 a[228:231], a[124:127], a[36:39], a[228:231]
    ds_read_b128 a[32:35], v6 offset:8192
    v_mfma_f32_16x16x32_bf16 a[232:235], a[112:115], a[40:43], a[232:235]
    buffer_load_dwordx4 v16, s[40:43], s51 offen offset:2048 sc1 lds
    v_mfma_f32_16x16x32_bf16 a[232:235], a[116:119], a[44:47], a[232:235]
    ds_read_b128 a[36:39], v7 offset:8192
    v_mfma_f32_16x16x32_bf16 a[236:239], a[120:123], a[40:43], a[236:239]
    ds_read_b64_tr_b16 a[106:107], v13 offset:2048
    v_mfma_f32_16x16x32_bf16 a[236:239], a[124:127], a[44:47], a[236:239]
    ds_read_b128 a[40:43], v6 offset:10240
    v_mfma_f32_16x16x32_bf16 a[240:243], a[112:115], a[48:51], a[240:243]
    ds_read_b128 a[44:47], v7 offset:10240
    v_mfma_f32_16x16x32_bf16 a[240:243], a[116:119], a[52:55], a[240:243]
    ds_read_b64_tr_b16 a[108:109], v13 offset:16384
    v_mfma_f32_16x16x32_bf16 a[244:247], a[120:123], a[48:51], a[244:247]
    v_mfma_f32_16x16x32_bf16 a[244:247], a[124:127], a[52:55], a[244:247]
    ds_read_b128 a[48:51], v6 offset:12288
    v_mfma_f32_16x16x32_bf16 a[248:251], a[112:115], a[56:59], a[248:251]
    buffer_load_dwordx4 v17, s[40:43], s51 offen offset:3072 sc1 lds
    v_mfma_f32_16x16x32_bf16 a[248:251], a[116:119], a[60:63], a[248:251]
    s_add_u32 s51, s51, 128
    ds_read_b128 a[52:55], v7 offset:12288
    v_mfma_f32_16x16x32_bf16 a[252:255], a[120:123], a[56:59], a[252:255]
    ds_read_b64_tr_b16 a[110:111], v13 offset:18432
    v_mfma_f32_16x16x32_bf16 a[252:255], a[124:127], a[60:63], a[252:255]
    ds_read_b128 a[56:59], v6 offset:14336
    ds_read_b128 a[60:63], v7 offset:14336
m_loop16:
    s_waitcnt lgkmcnt(15)
    v_mfma_f32_16x16x32_bf16 v[32:35], a[64:67], a[0:3], v[32:35]
    ds_read_b64_tr_b16 a[112:113], v14 offset:0
    v_mfma_f32_16x16x32_bf16 v[32:35], a[68:71], a[4:7], v[32:35]
    ds_read_b64_tr_b16 a[114:115], v14 offset:2048
    v_mfma_f32_16x16x32_bf16 v[36:39], a[72:75], a[0:3], v[36:39]
    ds_read_b64_tr_b16 a[116:117], v14 offset:16384
    v_mfma_f32_16x16x32_bf16 v[36:39], a[76:79], a[4:7], v[36:39]
    ds_read_b64_tr_b16 a[118:119], v14 offset:18432
    v_mfma_f32_16x16x32_bf16 v[40:43], a[64:67], a[8:11], v[40:43]
    ds_read_b64_tr_b16 a[120:121], v15 offset:0
    v_mfma_f32_16x16x32_bf16 v[40:43], a[68:71], a[12:15], v[40:43]
    ds_read_b64_tr_b16 a[122:123], v15 offset:2048
    v_mfma_f32_16x16x32_bf16 v[44:47], a[72:75], a[8:11], v[44:47]
    ds_read_b64_tr_b16 a[124:125], v15 offset:16384
    v_mfma_f32_16x16x32_bf16 v[44:47], a[76:79], a[12:15], v[44:47]
    ds_read_b64_tr_b16 a[126:127], v15 offset:18432
    v_mfma_f32_16x16x32_bf16 v[48:51], a[64:67], a[16:19], v[48:51]
    v_mfma_f32_16x16x32_bf16 v[48:51], a[68:71], a[20:23], v[48:51]
    v_mfma_f32_16x16x32_bf16 v[52:55], a[72:75], a[16:19], v[52:55]
    v_mfma_f32_16x16x32_bf16 v[52:55], a[76:79], a[20:23], v[52:55]
    s_waitcnt lgkmcnt(15)
    v_mfma_f32_16x16x32_bf16 v[56:59], a[64:67], a[24:27], v[56:59]
    v_xor_b32 v8, s60, v8
    v_xor_b32 v9, s60, v9
    v_mfma_f32_16x16x32_bf16 v[56:59], a[68:71], a[28:31], v[56:59]
    v_xor_b32 v10, s60, v10
    v_xor_b32 v11, s60, v11
    v_mfma_f32_16x16x32_bf16 v[60:63], a[72:75], a[24:27], v[60:63]
    v_xor_b32 v12, s60, v12
    v_xor_b32 v13, s60, v13
    v_mfma_f32_16x16x32_bf16 v[60:63], a[76:79], a[28:31], v[60:63]
    v_xor_b32 v14, s60, v14
    v_xor_b32 v15, s60, v15
    v_mfma_f32_16x16x32_bf16 v[64:67], a[64:67], a[32:35], v[64:67]
    v_mfma_f32_16x16x32_bf16 v[64:67], a[68:71], a[36:39], v[64:67]
    v_mfma_f32_16x16x32_bf16 v[68:71], a[72:75], a[32:35], v[68:71]
    v_mfma_f32_16x16x32_bf16 v[68:71], a[76:79], a[36:39], v[68:71]
    s_waitcnt lgkmcnt(14)
    v_mfma_f32_16x16x32_bf16 v[72:75], a[64:67], a[40:43], v[72:75]
    v_mfma_f32_16x16x32_bf16 v[72:75], a[68:71], a[44:47], v[72:75]
    v_mfma_f32_16x16x32_bf16 v[76:79], a[72:75], a[40:43], v[76:79]
    v_mfma_f32_16x16x32_bf16 v[76:79], a[76:79], a[44:47], v[76:79]
    s_waitcnt lgkmcnt(11)
    v_mfma_f32_16x16x32_bf16 v[80:83], a[64:67], a[48:51], v[80:83]
    v_mfma_f32_16x16x32_bf16 v[80:83], a[68:71], a[52:55], v[80:83]
    v_mfma_f32_16x16x32_bf16 v[84:87], a[72:75], a[48:51], v[84:87]
    v_mfma_f32_16x16x32_bf16 v[84:87], a[76:79], a[52:55], v[84:87]
    s_waitcnt lgkmcnt(8)
    v_mfma_f32_16x16x32_bf16 v[88:91], a[64:67], a[56:59], v[88:91]
    v_mfma_f32_16x16x32_bf16 v[88:91], a[68:71], a[60:63], v[88:91]
    v_mfma_f32_16x16x32_bf16 v[92:95], a[72:75], a[56:59], v[92:95]
    s_waitcnt vmcnt(8) lgkmcnt(0)
    v_mfma_f32_16x16x32_bf16 v[92:95], a[76:79], a[60:63], v[92:95]
    s_barrier
    v_mfma_f32_16x16x32_bf16 v[96:99], a[80:83], a[0:3], v[96:99]
    ds_read_b64_tr_b16 a[64:65], v8 offset:0
    v_mfma_f32_16x16x32_bf16 v[96:99], a[84:87], a[4:7], v[96:99]
    s_add_u32 m0, s62, 0
    v_mfma_f32_16x16x32_bf16 v[100:103], a[88:91], a[0:3], v[100:103]
    buffer_load_dwordx4 v18, s[44:47], s52 offen offset:0 sc1 lds
    v_mfma_f32_16x16x32_bf16 v[100:103], a[92:95], a[4:7], v[100:103]
    ds_read_b64_tr_b16 a[66:67], v8 offset:2048
    v_mfma_f32_16x16x32_bf16 v[104:107], a[80:83], a[8:11], v[104:107]
    s_add_u32 s64, s64, 32768
    v_mfma_f32_16x16x32_bf16 v[104:107], a[84:87], a[12:15], v[104:107]
    s_cmp_ge_u32 s64, 98304
    s_cselect_b32 s63, 4294901760, s59
    s_cselect_b32 s64, 0, s64
    v_mfma_f32_16x16x32_bf16 v[108:111], a[88:91], a[8:11], v[108:111]
    buffer_load_dwordx4 v19, s[44:47], s52 offen offset:1024 sc1 lds
    v_mfma_f32_16x16x32_bf16 v[108:111], a[92:95], a[12:15], v[108:111]
    s_add_u32 s52, s52, s56
    ds_read_b64_tr_b16 a[68:69], v8 offset:16384
    v_mfma_f32_16x16x32_bf16 v[112:115], a[80:83], a[16:19], v[112:115]
    v_mfma_f32_16x16x32_bf16 v[112:115], a[84:87], a[20:23], v[112:115]
    v_mfma_f32_16x16x32_bf16 v[116:119], a[88:91], a[16:19], v[116:119]
    buffer_load_dwordx4 v18, s[44:47], s53 offen offset:2048 sc1 lds
    v_mfma_f32_16x16x32_bf16 v[116:119], a[92:95], a[20:23], v[116:119]
    ds_read_b64_tr_b16 a[70:71], v8 offset:18432
    v_mfma_f32_16x16x32_bf16 v[120:123], a[80:83], a[24:27], v[120:123]
    v_mfma_f32_16x16x32_bf16 v[120:123], a[84:87], a[28:31], v[120:123]
    v_mfma_f32_16x16x32_bf16 v[124:127], a[88:91], a[24:27], v[124:127]
    buffer_load_dwordx4 v19, s[44:47], s53 offen offset:3072 sc1 lds
    v_mfma_f32_16x16x32_bf16 v[124:127], a[92:95], a[28:31], v[124:127]
    s_add_u32 s53, s53, s56
    ds_read_b64_tr_b16 a[72:73], v9 offset:0
    v_mfma_f32_16x16x32_bf16 v[128:131], a[80:83], a[32:35], v[128:131]
    v_mfma_f32_16x16x32_bf16 v[128:131], a[84:87], a[36:39], v[128:131]
    s_add_u32 m0, s62, 4096
    v_mfma_f32_16x16x32_bf16 v[132:135], a[88:91], a[32:35], v[132:135]
    buffer_load_dwordx4 v20, s[44:47], s54 offen offset:0 sc1 lds
    v_mfma_f32_16x16x32_bf16 v[132:135], a[92:95], a[36:39], v[132:135]
    s_xor_b32 s62, s62, 229376
    ds_read_b64_tr_b16 a[74:75], v9 offset:2048
    v_mfma_f32_16x16x32_bf16 v[136:139], a[80:83], a[40:43], v[136:139]
    v_mfma_f32_16x16x32_bf16 v[136:139], a[84:87], a[44:47], v[136:139]
    v_mfma_f32_16x16x32_bf16 v[140:143], a[88:91], a[40:43], v[140:143]
    buffer_load_dwordx4 v21, s[44:47], s54 offen offset:1024 sc1 lds
    v_mfma_f32_16x16x32_bf16 v[140:143], a[92:95], a[44:47], v[140:143]
    s_add_u32 s54, s54, s56
    ds_read_b64_tr_b16 a[76:77], v9 offset:16384
    v_mfma_f32_16x16x32_bf16 v[144:147], a[80:83], a[48:51], v[144:147]
    v_mfma_f32_16x16x32_bf16 v[144:147], a[84:87], a[52:55], v[144:147]
    v_mfma_f32_16x16x32_bf16 v[148:151], a[88:91], a[48:51], v[148:151]
    buffer_load_dwordx4 v20, s[44:47], s55 offen offset:2048 sc1 lds
    v_mfma_f32_16x16x32_bf16 v[148:151], a[92:95], a[52:55], v[148:151]
    ds_read_b64_tr_b16 a[78:79], v9 offset:18432
    v_mfma_f32_16x16x32_bf16 v[152:155], a[80:83], a[56:59], v[152:155]
    v_add_u32 v6, s63, v6
    v_add_u32 v7, s63, v7
    v_mfma_f32_16x16x32_bf16 v[152:155], a[84:87], a[60:63], v[152:155]
    v_mfma_f32_16x16x32_bf16 v[156:159], a[88:91], a[56:59], v[156:159]
    buffer_load_dwordx4 v21, s[44:47], s55 offen offset:3072 sc1 lds
    v_mfma_f32_16x16x32_bf16 v[156:159], a[92:95], a[60:63], v[156:159]
    s_add_u32 s55, s55, s56
    v_mfma_f32_16x16x32_bf16 v[160:163], a[96:99], a[0:3], v[160:163]
    ds_read_b64_tr_b16 a[80:81], v10 offset:0
    v_mfma_f32_16x16x32_bf16 v[160:163], a[100:103], a[4:7], v[160:163]
    v_mfma_f32_16x16x32_bf16 v[164:167], a[104:107], a[0:3], v[164:167]
    v_mfma_f32_16x16x32_bf16 v[164:167], a[108:111], a[4:7], v[164:167]
    s_add_u32 m0, s61, 0
    ds_read_b64_tr_b16 a[82:83], v10 offset:2048
    v_mfma_f32_16x16x32_bf16 v[168:171], a[96:99], a[8:11], v[168:171]
    buffer_load_dwordx4 v16, s[40:43], s48 offen offset:0 sc1 lds
    v_mfma_f32_16x16x32_bf16 v[168:171], a[100:103], a[12:15], v[168:171]
    v_mfma_f32_16x16x32_bf16 v[172:175], a[104:107], a[8:11], v[172:175]
    ds_read_b64_tr_b16 a[84:85], v10 offset:16384
    v_mfma_f32_16x16x32_bf16 v[172:175], a[108:111], a[12:15], v[172:175]
    v_mfma_f32_16x16x32_bf16 v[176:179], a[96:99], a[16:19], v[176:179]
    v_mfma_f32_16x16x32_bf16 v[176:179], a[100:103], a[20:23], v[176:179]
    ds_read_b64_tr_b16 a[86:87], v10 offset:18432
    v_mfma_f32_16x16x32_bf16 v[180:183], a[104:107], a[16:19], v[180:183]
    v_mfma_f32_16x16x32_bf16 v[180:183], a[108:111], a[20:23], v[180:183]
    v_mfma_f32_16x16x32_bf16 v[184:187], a[96:99], a[24:27], v[184:187]
    buffer_load_dwordx4 v17, s[40:43], s48 offen offset:1024 sc1 lds
    v_mfma_f32_16x16x32_bf16 v[184:187], a[100:103], a[28:31], v[184:187]
    s_add_u32 s48, s48, 128
    ds_read_b64_tr_b16 a[88:89], v11 offset:0
    v_mfma_f32_16x16x32_bf16 v[188:191], a[104:107], a[24:27], v[188:191]
    v_mfma_f32_16x16x32_bf16 v[188:191], a[108:111], a[28:31], v[188:191]
    v_mfma_f32_16x16x32_bf16 v[192:195], a[96:99], a[32:35], v[192:195]
    v_mfma_f32_16x16x32_bf16 v[192:195], a[100:103], a[36:39], v[192:195]
    ds_read_b64_tr_b16 a[90:91], v11 offset:2048
    v_mfma_f32_16x16x32_bf16 v[196:199], a[104:107], a[32:35], v[196:199]
    v_mfma_f32_16x16x32_bf16 v[196:199], a[108:111], a[36:39], v[196:199]
    v_mfma_f32_16x16x32_bf16 v[200:203], a[96:99], a[40:43], v[200:203]
    buffer_load_dwordx4 v16, s[40:43], s49 offen offset:2048 sc1 lds
    v_mfma_f32_16x16x32_bf16 v[200:203], a[100:103], a[44:47], v[200:203]
    ds_read_b64_tr_b16 a[92:93], v11 offset:16384
    v_mfma_f32_16x16x32_bf16 v[204:207], a[104:107], a[40:43], v[204:207]
    v_mfma_f32_16x16x32_bf16 v[204:207], a[108:111], a[44:47], v[204:207]
    v_mfma_f32_16x16x32_bf16 v[208:211], a[96:99], a[48:51], v[208:211]
    v_mfma_f32_16x16x32_bf16 v[208:211], a[100:103], a[52:55], v[208:211]
    ds_read_b64_tr_b16 a[94:95], v11 offset:18432
    v_mfma_f32_16x16x32_bf16 v[212:215], a[104:107], a[48:51], v[212:215]
    v_mfma_f32_16x16x32_bf16 v[212:215], a[108:111], a[52:55], v[212:215]
    v_mfma_f32_16x16x32_bf16 v[216:219], a[96:99], a[56:59], v[216:219]
    buffer_load_dwordx4 v17, s[40:43], s49 offen offset:3072 sc1 lds
    v_mfma_f32_16x16x32_bf16 v[216:219], a[100:103], a[60:63], v[216:219]
    s_add_u32 s49, s49, 128
    v_mfma_f32_16x16x32_bf16 v[220:223], a[104:107], a[56:59], v[220:223]
    v_mfma_f32_16x16x32_bf16 v[220:223], a[108:111], a[60:63], v[220:223]
    v_mfma_f32_16x16x32_bf16 v[224:227], a[112:115], a[0:3], v[224:227]
    v_mfma_f32_16x16x32_bf16 v[224:227], a[116:119], a[4:7], v[224:227]
    ds_read_b64_tr_b16 a[96:97], v12 offset:0
    v_mfma_f32_16x16x32_bf16 v[228:231], a[120:123], a[0:3], v[228:231]
    v_mfma_f32_16x16x32_bf16 v[228:231], a[124:127], a[4:7], v[228:231]
    s_add_u32 m0, s61, 4096
    ds_read_b128 a[0:3], v6 offset:0
    v_mfma_f32_16x16x32_bf16 v[232:235], a[112:115], a[8:11], v[232:235]
    buffer_load_dwordx4 v16, s[40:43], s50 offen offset:0 sc1 lds
    v_mfma_f32_16x16x32_bf16 v[232:235], a[116:119], a[12:15], v[232:235]
    s_add_u32 s61, s61, 32768
    ds_read_b128 a[4:7], v7 offset:0
    v_mfma_f32_16x16x32_bf16 v[236:239], a[120:123], a[8:11], v[236:239]
    s_cmp_ge_u32 s61, 98304
    s_cselect_b32 s90, 98304, 0
    ds_read_b64_tr_b16 a[98:99], v12 offset:2048
    v_mfma_f32_16x16x32_bf16 v[236:239], a[124:127], a[12:15], v[236:239]
    s_sub_u32 s61, s61, s90
    ds_read_b128 a[8:11], v6 offset:2048
    v_mfma_f32_16x16x32_bf16 v[240:243], a[112:115], a[16:19], v[240:243]
    ds_read_b128 a[12:15], v7 offset:2048
    v_mfma_f32_16x16x32_bf16 v[240:243], a[116:119], a[20:23], v[240:243]
    ds_read_b64_tr_b16 a[100:101], v12 offset:16384
    v_mfma_f32_16x16x32_bf16 v[244:247], a[120:123], a[16:19], v[244:247]
    v_mfma_f32_16x16x32_bf16 v[244:247], a[124:127], a[20:23], v[244:247]
    ds_read_b128 a[16:19], v6 offset:4096
    v_mfma_f32_16x16x32_bf16 v[248:251], a[112:115], a[24:27], v[248:251]
    buffer_load_dwordx4 v17, s[40:43], s50 offen offset:1024 sc1 lds
    v_mfma_f32_16x16x32_bf16 v[248:251], a[116:119], a[28:31], v[248:251]
    s_add_u32 s50, s50, 128
    ds_read_b128 a[20:23], v7 offset:4096
    v_mfma_f32_16x16x32_bf16 v[252:255], a[120:123], a[24:27], v[252:255]
    ds_read_b64_tr_b16 a[102:103], v12 offset:18432
    v_mfma_f32_16x16x32_bf16 v[252:255], a[124:127], a[28:31], v[252:255]
    ds_read_b128 a[24:27], v6 offset:6144
    v_mfma_f32_16x16x32_bf16 a[224:227], a[112:115], a[32:35], a[224:227]
    s_sub_u32 s65, s65, 1
    ds_read_b128 a[28:31], v7 offset:6144
    v_mfma_f32_16x16x32_bf16 a[224:227], a[116:119], a[36:39], a[224:227]
    ds_read_b64_tr_b16 a[104:105], v13 offset:0
    v_mfma_f32_16x16x32_bf16 a[228:231], a[120:123], a[32:35], a[228:231]
    v_mfma_f32_16x16x32_bf16 a[228:231], a[124:127], a[36:39], a[228:231]
    ds_read_b128 a[32:35], v6 offset:8192
    v_mfma_f32_16x16x32_bf16 a[232:235], a[112:115], a[40:43], a[232:235]
    buffer_load_dwordx4 v16, s[40:43], s51 offen offset:2048 sc1 lds
    v_mfma_f32_16x16x32_bf16 a[232:235], a[116:119], a[44:47], a[232:235]
    ds_read_b128 a[36:39], v7 offset:8192
    v_mfma_f32_16x16x32_bf16 a[236:239], a[120:123], a[40:43], a[236:239]
    ds_read_b64_tr_b16 a[106:107], v13 offset:2048
    v_mfma_f32_16x16x32_bf16 a[236:239], a[124:127], a[44:47], a[236:239]
    ds_read_b128 a[40:43], v6 offset:10240
    v_mfma_f32_16x16x32_bf16 a[240:243], a[112:115], a[48:51], a[240:243]
    ds_read_b128 a[44:47], v7 offset:10240
    v_mfma_f32_16x16x32_bf16 a[240:243], a[116:119], a[52:55], a[240:243]
    ds_read_b64_tr_b16 a[108:109], v13 offset:16384
    v_mfma_f32_16x16x32_bf16 a[244:247], a[120:123], a[48:51], a[244:247]
    v_mfma_f32_16x16x32_bf16 a[244:247], a[124:127], a[52:55], a[244:247]
    ds_read_b128 a[48:51], v6 offset:12288
    v_mfma_f32_16x16x32_bf16 a[248:251], a[112:115], a[56:59], a[248:251]
    buffer_load_dwordx4 v17, s[40:43], s51 offen offset:3072 sc1 lds
    v_mfma_f32_16x16x32_bf16 a[248:251], a[116:119], a[60:63], a[248:251]
    s_add_u32 s51, s51, 128
    ds_read_b128 a[52:55], v7 offset:12288
    v_mfma_f32_16x16x32_bf16 a[252:255], a[120:123], a[56:59], a[252:255]
    s_cmp_gt_u32 s65, s67
    ds_read_b64_tr_b16 a[110:111], v13 offset:18432
    v_mfma_f32_16x16x32_bf16 a[252:255], a[124:127], a[60:63], a[252:255]
    ds_read_b128 a[56:59], v6 offset:14336
    ds_read_b128 a[60:63], v7 offset:14336
    s_cbranch_scc1 m_loop16
    s_cmp_lg_u32 s65, 0
    s_cbranch_scc1 m_dosw17
    s_branch m_epi12
m_swp13:
    s_waitcnt lgkmcnt(15)
    v_mfma_f32_16x16x32_bf16 v[32:35], a[0:3], a[64:67], 0
    ds_read_b64_tr_b16 a[112:113], v14 offset:0
    v_mfma_f32_16x16x32_bf16 v[32:35], a[4:7], a[68:71], v[32:35]
    ds_read_b64_tr_b16 a[114:115], v14 offset:2048
    v_mfma_f32_16x16x32_bf16 v[40:43], a[0:3], a[72:75], 0
    ds_read_b64_tr_b16 a[116:117], v14 offset:16384
    v_mfma_f32_16x16x32_bf16 v[40:43], a[4:7], a[76:79], v[40:43]
    ds_read_b64_tr_b16 a[118:119], v14 offset:18432
    v_mfma_f32_16x16x32_bf16 v[36:39], a[8:11], a[64:67], 0
    ds_read_b64_tr_b16 a[120:121], v15 offset:0
    v_mfma_f32_16x16x32_bf16 v[36:39], a[12:15], a[68:71], v[36:39]
    ds_read_b64_tr_b16 a[122:123], v15 offset:2048
    v_mfma_f32_16x16x32_bf16 v[44:47], a[8:11], a[72:75], 0
    ds_read_b64_tr_b16 a[124:125], v15 offset:16384
    v_mfma_f32_16x16x32_bf16 v[44:47], a[12:15], a[76:79], v[44:47]
    ds_read_b64_tr_b16 a[126:127], v15 offset:18432
    v_mfma_f32_16x16x32_bf16 v[96:99], a[16:19], a[64:67], 0
    v_mfma_f32_16x16x32_bf16 v[96:99], a[20:23], a[68:71], v[96:99]
    v_mfma_f32_16x16x32_bf16 v[104:107], a[16:19], a[72:75], 0
    buffer_store_dwordx4 a[128:131], v2, s[24:27], s28 offen sc1
    v_mfma_f32_16x16x32_bf16 v[104:107], a[20:23], a[76:79], v[104:107]
    s_add_u32 s28, s28, s31
    s_waitcnt lgkmcnt(15)
    v_mfma_f32_16x16x32_bf16 v[100:103], a[24:27], a[64:67], 0
    v_xor_b32 v8, s60, v8
    v_xor_b32 v9, s60, v9
    v_mfma_f32_16x16x32_bf16 v[100:103], a[28:31], a[68:71], v[100:103]
    v_xor_b32 v10, s60, v10
    v_xor_b32 v11, s60, v11
    v_mfma_f32_16x16x32_bf16 v[108:111], a[24:27], a[72:75], 0
    v_xor_b32 v12, s60, v12
    v_xor_b32 v13, s60, v13
    v_mfma_f32_16x16x32_bf16 v[108:111], a[28:31], a[76:79], v[108:111]
    v_xor_b32 v14, s60, v14
    v_xor_b32 v15, s60, v15
    v_mfma_f32_16x16x32_bf16 v[160:163], a[32:35], a[64:67], 0
    buffer_store_dwordx4 a[132:135], v2, s[24:27], s28 offen sc1
    v_mfma_f32_16x16x32_bf16 v[160:163], a[36:39], a[68:71], v[160:163]
    s_add_u32 s28, s28, s31
    v_mfma_f32_16x16x32_bf16 v[168:171], a[32:35], a[72:75], 0
    v_mfma_f32_16x16x32_bf16 v[168:171], a[36:39], a[76:79], v[168:171]
    s_waitcnt lgkmcnt(14)
    v_mfma_f32_16x16x32_bf16 v[164:167], a[40:43], a[64:67], 0
    v_mfma_f32_16x16x32_bf16 v[164:167], a[44:47], a[68:71], v[164:167]
    v_mfma_f32_16x16x32_bf16 v[172:175], a[40:43], a[72:75], 0
    buffer_store_dwordx4 a[136:139], v2, s[24:27], s28 offen sc1
    v_mfma_f32_16x16x32_bf16 v[172:175], a[44:47], a[76:79], v[172:175]
    s_add_u32 s28, s28, s31
    s_waitcnt lgkmcnt(11)
    v_mfma_f32_16x16x32_bf16 v[224:227], a[48:51], a[64:67], 0
    v_mfma_f32_16x16x32_bf16 v[224:227], a[52:55], a[68:71], v[224:227]
    v_mfma_f32_16x16x32_bf16 v[232:235], a[48:51], a[72:75], 0
    v_mfma_f32_16x16x32_bf16 v[232:235], a[52:55], a[76:79], v[232:235]
    s_waitcnt lgkmcnt(8)
    v_mfma_f32_16x16x32_bf16 v[228:231], a[56:59], a[64:67], 0
    buffer_store_dwordx4 a[140:143], v2, s[24:27], s28 offen sc1
    v_mfma_f32_16x16x32_bf16 v[228:231], a[60:63], a[68:71], v[228:231]
    s_add_u32 s28, s28, s31
    v_mfma_f32_16x16x32_bf16 v[236:239], a[56:59], a[72:75], 0
    s_waitcnt vmcnt(12) lgkmcnt(0)
    v_mfma_f32_16x16x32_bf16 v[236:239], a[60:63], a[76:79], v[236:239]
    s_barrier
    v_mfma_f32_16x16x32_bf16 v[48:51], a[0:3], a[80:83], 0
    ds_read_b64_tr_b16 a[64:65], v8 offset:0
    v_mfma_f32_16x16x32_bf16 v[48:51], a[4:7], a[84:87], v[48:51]
    s_add_u32 m0, s62, 0
    v_mfma_f32_16x16x32_bf16 v[56:59], a[0:3], a[88:91], 0
    buffer_load_dwordx4 v18, s[44:47], s52 offen offset:0 sc1 lds
    v_mfma_f32_16x16x32_bf16 v[56:59], a[4:7], a[92:95], v[56:59]
    ds_read_b64_tr_b16 a[66:67], v8 offset:2048
    v_mfma_f32_16x16x32_bf16 v[52:55], a[8:11], a[80:83], 0
    s_add_u32 s64, s64, 32768
    v_mfma_f32_16x16x32_bf16 v[52:55], a[12:15], a[84:87], v[52:55]
    s_cmp_ge_u32 s64, 98304
    s_cselect_b32 s63, 4294901760, s59
    s_cselect_b32 s64, 0, s64
    v_mfma_f32_16x16x32_bf16 v[60:63], a[8:11], a[88:91], 0
    buffer_load_dwordx4 v19, s[44:47], s52 offen offset:1024 sc1 lds
    v_mfma_f32_16x16x32_bf16 v[60:63], a[12:15], a[92:95], v[60:63]
    s_add_u32 s52, s52, s56
    ds_read_b64_tr_b16 a[68:69], v8 offset:16384
    v_mfma_f32_16x16x32_bf16 v[112:115], a[16:19], a[80:83], 0
    v_mfma_f32_16x16x32_bf16 v[112:115], a[20:23], a[84:87], v[112:115]
    v_mfma_f32_16x16x32_bf16 v[120:123], a[16:19], a[88:91], 0
    buffer_load_dwordx4 v18, s[44:47], s53 offen offset:2048 sc1 lds
    v_mfma_f32_16x16x32_bf16 v[120:123], a[20:23], a[92:95], v[120:123]
    ds_read_b64_tr_b16 a[70:71], v8 offset:18432
    v_mfma_f32_16x16x32_bf16 v[116:119], a[24:27], a[80:83], 0
    v_mfma_f32_16x16x32_bf16 v[116:119], a[28:31], a[84:87], v[116:119]
    v_mfma_f32_16x16x32_bf16 v[124:127], a[24:27], a[88:91], 0
    buffer_load_dwordx4 v19, s[44:47], s53 offen offset:3072 sc1 lds
    v_mfma_f32_16x16x32_bf16 v[124:127], a[28:31], a[92:95], v[124:127]
    s_add_u32 s53, s53, s56
    ds_read_b64_tr_b16 a[72:73], v9 offset:0
    v_mfma_f32_16x16x32_bf16 v[176:179], a[32:35], a[80:83], 0
    v_mfma_f32_16x16x32_bf16 v[176:179], a[36:39], a[84:87], v[176:179]
    s_add_u32 m0, s62, 4096
    v_mfma_f32_16x16x32_bf16 v[184:187], a[32:35], a[88:91], 0
    buffer_load_dwordx4 v20, s[44:47], s54 offen offset:0 sc1 lds
    v_mfma_f32_16x16x32_bf16 v[184:187], a[36:39], a[92:95], v[184:187]
    s_xor_b32 s62, s62, 229376
    ds_read_b64_tr_b16 a[74:75], v9 offset:2048
    v_mfma_f32_16x16x32_bf16 v[180:183], a[40:43], a[80:83], 0
    v_mfma_f32_16x16x32_bf16 v[180:183], a[44:47], a[84:87], v[180:183]
    v_mfma_f32_16x16x32_bf16 v[188:191], a[40:43], a[88:91], 0
    buffer_load_dwordx4 v21, s[44:47], s54 offen offset:1024 sc1 lds
    v_mfma_f32_16x16x32_bf16 v[188:191], a[44:47], a[92:95], v[188:191]
    s_add_u32 s54, s54, s56
    ds_read_b64_tr_b16 a[76:77], v9 offset:16384
    v_mfma_f32_16x16x32_bf16 v[240:243], a[48:51], a[80:83], 0
    v_mfma_f32_16x16x32_bf16 v[240:243], a[52:55], a[84:87], v[240:243]
    v_mfma_f32_16x16x32_bf16 v[248:251], a[48:51], a[88:91], 0
    buffer_load_dwordx4 v20, s[44:47], s55 offen offset:2048 sc1 lds
    v_mfma_f32_16x16x32_bf16 v[248:251], a[52:55], a[92:95], v[248:251]
    ds_read_b64_tr_b16 a[78:79], v9 offset:18432
    v_mfma_f32_16x16x32_bf16 v[244:247], a[56:59], a[80:83], 0
    v_add_u32 v6, s63, v6
    v_add_u32 v7, s63, v7
    v_mfma_f32_16x16x32_bf16 v[244:247], a[60:63], a[84:87], v[244:247]
    v_mfma_f32_16x16x32_bf16 v[252:255], a[56:59], a[88:91], 0
    buffer_load_dwordx4 v21, s[44:47], s55 offen offset:3072 sc1 lds
    v_mfma_f32_16x16x32_bf16 v[252:255], a[60:63], a[92:95], v[252:255]
    s_add_u32 s55, s55, s56
    v_mfma_f32_16x16x32_bf16 v[64:67], a[0:3], a[96:99], 0
    ds_read_b64_tr_b16 a[80:81], v10 offset:0
    v_mfma_f32_16x16x32_bf16 v[64:67], a[4:7], a[100:103], v[64:67]
    v_mfma_f32_16x16x32_bf16 v[72:75], a[0:3], a[104:107], 0
    v_mfma_f32_16x16x32_bf16 v[72:75], a[4:7], a[108:111], v[72:75]
    s_add_u32 m0, s61, 0
    ds_read_b64_tr_b16 a[82:83], v10 offset:2048
    v_mfma_f32_16x16x32_bf16 v[68:71], a[8:11], a[96:99], 0
    buffer_load_dwordx4 v16, s[40:43], s48 offen offset:0 sc1 lds
    v_mfma_f32_16x16x32_bf16 v[68:71], a[12:15], a[100:103], v[68:71]
    v_mfma_f32_16x16x32_bf16 v[76:79], a[8:11], a[104:107], 0
    ds_read_b64_tr_b16 a[84:85], v10 offset:16384
    v_mfma_f32_16x16x32_bf16 v[76:79], a[12:15], a[108:111], v[76:79]
    v_mfma_f32_16x16x32_bf16 v[128:131], a[16:19], a[96:99], 0
    buffer_store_dwordx4 a[144:147], v2, s[24:27], s28 offen sc1
    v_mfma_f32_16x16x32_bf16 v[128:131], a[20:23], a[100:103], v[128:131]
    s_add_u32 s28, s28, s31
    ds_read_b64_tr_b16 a[86:87], v10 offset:18432
    v_mfma_f32_16x16x32_bf16 v[136:139], a[16:19], a[104:107], 0
    v_mfma_f32_16x16x32_bf16 v[136:139], a[20:23], a[108:111], v[136:139]
    v_mfma_f32_16x16x32_bf16 v[132:135], a[24:27], a[96:99], 0
    buffer_load_dwordx4 v17, s[40:43], s48 offen offset:1024 sc1 lds
    v_mfma_f32_16x16x32_bf16 v[132:135], a[28:31], a[100:103], v[132:135]
    s_add_u32 s48, s48, 128
    ds_read_b64_tr_b16 a[88:89], v11 offset:0
    v_mfma_f32_16x16x32_bf16 v[140:143], a[24:27], a[104:107], 0
    v_mfma_f32_16x16x32_bf16 v[140:143], a[28:31], a[108:111], v[140:143]
    v_mfma_f32_16x16x32_bf16 v[192:195], a[32:35], a[96:99], 0
    buffer_store_dwordx4 a[148:151], v2, s[24:27], s28 offen sc1
    v_mfma_f32_16x16x32_bf16 v[192:195], a[36:39], a[100:103], v[192:195]
    s_add_u32 s28, s28, s31
    ds_read_b64_tr_b16 a[90:91], v11 offset:2048
    v_mfma_f32_16x16x32_bf16 v[200:203], a[32:35], a[104:107], 0
    v_mfma_f32_16x16x32_bf16 v[200:203], a[36:39], a[108:111], v[200:203]
    v_mfma_f32_16x16x32_bf16 v[196:199], a[40:43], a[96:99], 0
    buffer_load_dwordx4 v16, s[40:43], s49 offen offset:2048 sc1 lds
    v_mfma_f32_16x16x32_bf16 v[196:199], a[44:47], a[100:103], v[196:199]
    ds_read_b64_tr_b16 a[92:93], v11 offset:16384
    v_mfma_f32_16x16x32_bf16 v[204:207], a[40:43], a[104:107], 0
    v_mfma_f32_16x16x32_bf16 v[204:207], a[44:47], a[108:111], v[204:207]
    v_mfma_f32_16x16x32_bf16 a[224:227], a[48:51], a[96:99], 0
    buffer_store_dwordx4 a[152:155], v2, s[24:27], s28 offen sc1
    v_mfma_f32_16x16x32_bf16 a[224:227], a[52:55], a[100:103], a[224:227]
    s_add_u32 s28, s28, s31
    ds_read_b64_tr_b16 a[94:95], v11 offset:18432
    v_mfma_f32_16x16x32_bf16 a[232:235], a[48:51], a[104:107], 0
    v_mfma_f32_16x16x32_bf16 a[232:235], a[52:55], a[108:111], a[232:235]
    v_mfma_f32_16x16x32_bf16 a[228:231], a[56:59], a[96:99], 0
    buffer_load_dwordx4 v17, s[40:43], s49 offen offset:3072 sc1 lds
    v_mfma_f32_16x16x32_bf16 a[228:231], a[60:63], a[100:103], a[228:231]
    s_add_u32 s49, s49, 128
    v_mfma_f32_16x16x32_bf16 a[236:239], a[56:59], a[104:107], 0
    buffer_store_dwordx4 a[156:159], v2, s[24:27], s28 offen sc1
    v_mfma_f32_16x16x32_bf16 a[236:239], a[60:63], a[108:111], a[236:239]
    s_add_u32 s29, s29, s30
    s_mov_b32 s28, s29
    v_mfma_f32_16x16x32_bf16 v[80:83], a[0:3], a[112:115], 0
    v_mfma_f32_16x16x32_bf16 v[80:83], a[4:7], a[116:119], v[80:83]
    ds_read_b64_tr_b16 a[96:97], v12 offset:0
    v_mfma_f32_16x16x32_bf16 v[88:91], a[0:3], a[120:123], 0
    v_mfma_f32_16x16x32_bf16 v[88:91], a[4:7], a[124:127], v[88:91]
    s_add_u32 m0, s61, 4096
    ds_read_b128 a[0:3], v6 offset:0
    v_mfma_f32_16x16x32_bf16 v[84:87], a[8:11], a[112:115], 0
    buffer_load_dwordx4 v16, s[40:43], s50 offen offset:0 sc1 lds
    v_mfma_f32_16x16x32_bf16 v[84:87], a[12:15], a[116:119], v[84:87]
    s_add_u32 s61, s61, 32768
    ds_read_b128 a[4:7], v7 offset:0
    v_mfma_f32_16x16x32_bf16 v[92:95], a[8:11], a[120:123], 0
    s_cmp_ge_u32 s61, 98304
    s_cselect_b32 s90, 98304, 0
    ds_read_b64_tr_b16 a[98:99], v12 offset:2048
    v_mfma_f32_16x16x32_bf16 v[92:95], a[12:15], a[124:127], v[92:95]
    s_sub_u32 s61, s61, s90
    ds_read_b128 a[8:11], v6 offset:2048
    v_mfma_f32_16x16x32_bf16 v[144:147], a[16:19], a[112:115], 0
    ds_read_b128 a[12:15], v7 offset:2048
    v_mfma_f32_16x16x32_bf16 v[144:147], a[20:23], a[116:119], v[144:147]
    ds_read_b64_tr_b16 a[100:101], v12 offset:16384
    v_mfma_f32_16x16x32_bf16 v[152:155], a[16:19], a[120:123], 0
    v_mfma_f32_16x16x32_bf16 v[152:155], a[20:23], a[124:127], v[152:155]
    ds_read_b128 a[16:19], v6 offset:4096
    v_mfma_f32_16x16x32_bf16 v[148:151], a[24:27], a[112:115], 0
    buffer_load_dwordx4 v17, s[40:43], s50 offen offset:1024 sc1 lds
    v_mfma_f32_16x16x32_bf16 v[148:151], a[28:31], a[116:119], v[148:151]
    s_add_u32 s50, s50, 128
    ds_read_b128 a[20:23], v7 offset:4096
    v_mfma_f32_16x16x32_bf16 v[156:159], a[24:27], a[120:123], 0
    ds_read_b64_tr_b16 a[102:103], v12 offset:18432
    v_mfma_f32_16x16x32_bf16 v[156:159], a[28:31], a[124:127], v[156:159]
    ds_read_b128 a[24:27], v6 offset:6144
    v_mfma_f32_16x16x32_bf16 v[208:211], a[32:35], a[112:115], 0
    s_sub_u32 s65, s65, 1
    ds_read_b128 a[28:31], v7 offset:6144
    v_mfma_f32_16x16x32_bf16 v[208:211], a[36:39], a[116:119], v[208:211]
    ds_read_b64_tr_b16 a[104:105], v13 offset:0
    v_mfma_f32_16x16x32_bf16 v[216:219], a[32:35], a[120:123], 0
    v_mfma_f32_16x16x32_bf16 v[216:219], a[36:39], a[124:127], v[216:219]
    ds_read_b128 a[32:35], v6 offset:8192
    v_mfma_f32_16x16x32_bf16 v[212:215], a[40:43], a[112:115], 0
    buffer_load_dwordx4 v16, s[40:43], s51 offen offset:2048 sc1 lds
    v_mfma_f32_16x16x32_bf16 v[212:215], a[44:47], a[116:119], v[212:215]
    ds_read_b128 a[36:39], v7 offset:8192
    v_mfma_f32_16x16x32_bf16 v[220:223], a[40:43], a[120:123], 0
    ds_read_b64_tr_b16 a[106:107], v13 offset:2048
    v_mfma_f32_16x16x32_bf16 v[220:223], a[44:47], a[124:127], v[220:223]
    ds_read_b128 a[40:43], v6 offset:10240
    v_mfma_f32_16x16x32_bf16 a[240:243], a[48:51], a[112:115], 0
    ds_read_b128 a[44:47], v7 offset:10240
    v_mfma_f32_16x16x32_bf16 a[240:243], a[52:55], a[116:119], a[240:243]
    ds_read_b64_tr_b16 a[108:109], v13 offset:16384
    v_mfma_f32_16x16x32_bf16 a[248:251], a[48:51], a[120:123], 0
    v_mfma_f32_16x16x32_bf16 a[248:251], a[52:55], a[124:127], a[248:251]
    ds_read_b128 a[48:51], v6 offset:12288
    v_mfma_f32_16x16x32_bf16 a[244:247], a[56:59], a[112:115], 0
    buffer_load_dwordx4 v17, s[40:43], s51 offen offset:3072 sc1 lds
    v_mfma_f32_16x16x32_bf16 a[244:247], a[60:63], a[116:119], a[244:247]
    s_add_u32 s51, s51, 128
    ds_read_b128 a[52:55], v7 offset:12288
    v_mfma_f32_16x16x32_bf16 a[252:255], a[56:59], a[120:123], 0
    ds_read_b64_tr_b16 a[110:111], v13 offset:18432
    v_mfma_f32_16x16x32_bf16 a[252:255], a[60:63], a[124:127], a[252:255]
    ds_read_b128 a[56:59], v6 offset:14336
    ds_read_b128 a[60:63], v7 offset:14336
    s_waitcnt lgkmcnt(15)
    v_mfma_f32_16x16x32_bf16 v[32:35], a[0:3], a[64:67], v[32:35]
    ds_read_b64_tr_b16 a[112:113], v14 offset:0
    v_mfma_f32_16x16x32_bf16 v[32:35], a[4:7], a[68:71], v[32:35]
    ds_read_b64_tr_b16 a[114:115], v14 offset:2048
    v_mfma_f32_16x16x32_bf16 v[40:43], a[0:3], a[72:75], v[40:43]
    ds_read_b64_tr_b16 a[116:117], v14 offset:16384
    v_mfma_f32_16x16x32_bf16 v[40:43], a[4:7], a[76:79], v[40:43]
    ds_read_b64_tr_b16 a[118:119], v14 offset:18432
    v_mfma_f32_16x16x32_bf16 v[36:39], a[8:11], a[64:67], v[36:39]
    ds_read_b64_tr_b16 a[120:121], v15 offset:0
    v_mfma_f32_16x16x32_bf16 v[36:39], a[12:15], a[68:71], v[36:39]
    ds_read_b64_tr_b16 a[122:123], v15 offset:2048
    v_mfma_f32_16x16x32_bf16 v[44:47], a[8:11], a[72:75], v[44:47]
    ds_read_b64_tr_b16 a[124:125], v15 offset:16384
    v_mfma_f32_16x16x32_bf16 v[44:47], a[12:15], a[76:79], v[44:47]
    ds_read_b64_tr_b16 a[126:127], v15 offset:18432
    v_mfma_f32_16x16x32_bf16 v[96:99], a[16:19], a[64:67], v[96:99]
    v_mfma_f32_16x16x32_bf16 v[96:99], a[20:23], a[68:71], v[96:99]
    v_mfma_f32_16x16x32_bf16 v[104:107], a[16:19], a[72:75], v[104:107]
    buffer_store_dwordx4 a[160:163], v2, s[24:27], s28 offen sc1
    v_mfma_f32_16x16x32_bf16 v[104:107], a[20:23], a[76:79], v[104:107]
    s_add_u32 s28, s28, s31
    s_waitcnt lgkmcnt(15)
    v_mfma_f32_16x16x32_bf16 v[100:103], a[24:27], a[64:67], v[100:103]
    v_xor_b32 v8, s60, v8
    v_xor_b32 v9, s60, v9
    v_mfma_f32_16x16x32_bf16 v[100:103], a[28:31], a[68:71], v[100:103]
    v_xor_b32 v10, s60, v10
    v_xor_b32 v11, s60, v11
    v_mfma_f32_16x16x32_bf16 v[108:111], a[24:27], a[72:75], v[108:111]
    v_xor_b32 v12, s60, v12
    v_xor_b32 v13, s60, v13
    v_mfma_f32_16x16x32_bf16 v[108:111], a[28:31], a[76:79], v[108:111]
    v_xor_b32 v14, s60, v14
    v_xor_b32 v15, s60, v15
    v_mfma_f32_16x16x32_bf16 v[160:163], a[32:35], a[64:67], v[160:163]
    buffer_store_dwordx4 a[164:167], v2, s[24:27], s28 offen sc1
    v_mfma_f32_16x16x32_bf16 v[160:163], a[36:39], a[68:71], v[160:163]
    s_add_u32 s28, s28, s31
    v_mfma_f32_16x16x32_bf16 v[168:171], a[32:35], a[72:75], v[168:171]
    v_mfma_f32_16x16x32_bf16 v[168:171], a[36:39], a[76:79], v[168:171]
    s_waitcnt lgkmcnt(14)
    v_mfma_f32_16x16x32_bf16 v[164:167], a[40:43], a[64:67], v[164:167]
    v_mfma_f32_16x16x32_bf16 v[164:167], a[44:47], a[68:71], v[164:167]
    v_mfma_f32_16x16x32_bf16 v[172:175], a[40:43], a[72:75], v[172:175]
    buffer_store_dwordx4 a[168:171], v2, s[24:27], s28 offen sc1
    v_mfma_f32_16x16x32_bf16 v[172:175], a[44:47], a[76:79], v[172:175]
    s_add_u32 s28, s28, s31
    s_waitcnt lgkmcnt(11)
    v_mfma_f32_16x16x32_bf16 v[224:227], a[48:51], a[64:67], v[224:227]
    v_mfma_f32_16x16x32_bf16 v[224:227], a[52:55], a[68:71], v[224:227]
    v_mfma_f32_16x16x32_bf16 v[232:235], a[48:51], a[72:75], v[232:235]
    v_mfma_f32_16x16x32_bf16 v[232:235], a[52:55], a[76:79], v[232:235]
    s_waitcnt lgkmcnt(8)
    v_mfma_f32_16x16x32_bf16 v[228:231], a[56:59], a[64:67], v[228:231]
    buffer_store_dwordx4 a[172:175], v2, s[24:27], s28 offen sc1
    v_mfma_f32_16x16x32_bf16 v[228:231], a[60:63], a[68:71], v[228:231]
    s_add_u32 s28, s28, s31
    v_mfma_f32_16x16x32_bf16 v[236:239], a[56:59], a[72:75], v[236:239]
    s_waitcnt vmcnt(16) lgkmcnt(0)
    v_mfma_f32_16x16x32_bf16 v[236:239], a[60:63], a[76:79], v[236:239]
    s_barrier
    v_mfma_f32_16x16x32_bf16 v[48:51], a[0:3], a[80:83], v[48:51]
    ds_read_b64_tr_b16 a[64:65], v8 offset:0
    v_mfma_f32_16x16x32_bf16 v[48:51], a[4:7], a[84:87], v[48:51]
    s_add_u32 m0, s62, 0
    v_mfma_f32_16x16x32_bf16 v[56:59], a[0:3], a[88:91], v[56:59]
    buffer_load_dwordx4 v18, s[44:47], s52 offen offset:0 sc1 lds
    v_mfma_f32_16x16x32_bf16 v[56:59], a[4:7], a[92:95], v[56:59]
    ds_read_b64_tr_b16 a[66:67], v8 offset:2048
    v_mfma_f32_16x16x32_bf16 v[52:55], a[8:11], a[80:83], v[52:55]
    s_add_u32 s64, s64, 32768
    v_mfma_f32_16x16x32_bf16 v[52:55], a[12:15], a[84:87], v[52:55]
    s_cmp_ge_u32 s64, 98304
    s_cselect_b32 s63, 4294901760, s59
    s_cselect_b32 s64, 0, s64
    v_mfma_f32_16x16x32_bf16 v[60:63], a[8:11], a[88:91], v[60:63]
    buffer_load_dwordx4 v19, s[44:47], s52 offen offset:1024 sc1 lds
    v_mfma_f32_16x16x32_bf16 v[60:63], a[12:15], a[92:95], v[60:63]
    s_add_u32 s52, s52, s56
    ds_read_b64_tr_b16 a[68:69], v8 offset:16384
    v_mfma_f32_16x16x32_bf16 v[112:115], a[16:19], a[80:83], v[112:115]
    v_mfma_f32_16x16x32_bf16 v[112:115], a[20:23], a[84:87], v[112:115]
    v_mfma_f32_16x16x32_bf16 v[120:123], a[16:19], a[88:91], v[120:123]
    buffer_load_dwordx4 v18, s[44:47], s53 offen offset:2048 sc1 lds
    v_mfma_f32_16x16x32_bf16 v[120:123], a[20:23], a[92:95], v[120:123]
    ds_read_b64_tr_b16 a[70:71], v8 offset:18432
    v_mfma_f32_16x16x32_bf16 v[116:119], a[24:27], a[80:83], v[116:119]
    v_mfma_f32_16x16x32_bf16 v[116:119], a[28:31], a[84:87], v[116:119]
    v_mfma_f32_16x16x32_bf16 v[124:127], a[24:27], a[88:91], v[124:127]
    buffer_load_dwordx4 v19, s[44:47], s53 offen offset:3072 sc1 lds
    v_mfma_f32_16x16x32_bf16 v[124:127], a[28:31], a[92:95], v[124:127]
    s_add_u32 s53, s53, s56
    ds_read_b64_tr_b16 a[72:73], v9 offset:0
    v_mfma_f32_16x16x32_bf16 v[176:179], a[32:35], a[80:83], v[176:179]
    v_mfma_f32_16x16x32_bf16 v[176:179], a[36:39], a[84:87], v[176:179]
    s_add_u32 m0, s62, 4096
    v_mfma_f32_16x16x32_bf16 v[184:187], a[32:35], a[88:91], v[184:187]
    buffer_load_dwordx4 v20, s[44:47], s54 offen offset:0 sc1 lds
    v_mfma_f32_16x16x32_bf16 v[184:187], a[36:39], a[92:95], v[184:187]
    s_xor_b32 s62, s62, 229376
    ds_read_b64_tr_b16 a[74:75], v9 offset:2048
    v_mfma_f32_16x16x32_bf16 v[180:183], a[40:43], a[80:83], v[180:183]
    v_mfma_f32_16x16x32_bf16 v[180:183], a[44:47], a[84:87], v[180:183]
    v_mfma_f32_16x16x32_bf16 v[188:191], a[40:43], a[88:91], v[188:191]
    buffer_load_dwordx4 v21, s[44:47], s54 offen offset:1024 sc1 lds
    v_mfma_f32_16x16x32_bf16 v[188:191], a[44:47], a[92:95], v[188:191]
    s_add_u32 s54, s54, s56
    ds_read_b64_tr_b16 a[76:77], v9 offset:16384
    v_mfma_f32_16x16x32_bf16 v[240:243], a[48:51], a[80:83], v[240:243]
    v_mfma_f32_16x16x32_bf16 v[240:243], a[52:55], a[84:87], v[240:243]
    v_mfma_f32_16x16x32_bf16 v[248:251], a[48:51], a[88:91], v[248:251]
    buffer_load_dwordx4 v20, s[44:47], s55 offen offset:2048 sc1 lds
    v_mfma_f32_16x16x32_bf16 v[248:251], a[52:55], a[92:95], v[248:251]
    ds_read_b64_tr_b16 a[78:79], v9 offset:18432
    v_mfma_f32_16x16x32_bf16 v[244:247], a[56:59], a[80:83], v[244:247]
    v_add_u32 v6, s63, v6
    v_add_u32 v7, s63, v7
    v_mfma_f32_16x16x32_bf16 v[244:247], a[60:63], a[84:87], v[244:247]
    v_mfma_f32_16x16x32_bf16 v[252:255], a[56:59], a[88:91], v[252:255]
    buffer_load_dwordx4 v21, s[44:47], s55 offen offset:3072 sc1 lds
    v_mfma_f32_16x16x32_bf16 v[252:255], a[60:63], a[92:95], v[252:255]
    s_add_u32 s55, s55, s56
    v_mfma_f32_16x16x32_bf16 v[64:67], a[0:3], a[96:99], v[64:67]
    ds_read_b64_tr_b16 a[80:81], v10 offset:0
    v_mfma_f32_16x16x32_bf16 v[64:67], a[4:7], a[100:103], v[64:67]
    v_mfma_f32_16x16x32_bf16 v[72:75], a[0:3], a[104:107], v[72:75]
    v_mfma_f32_16x16x32_bf16 v[72:75], a[4:7], a[108:111], v[72:75]
    s_add_u32 m0, s61, 0
    ds_read_b64_tr_b16 a[82:83], v10 offset:2048
    v_mfma_f32_16x16x32_bf16 v[68:71], a[8:11], a[96:99], v[68:71]
    buffer_load_dwordx4 v16, s[40:43], s48 offen offset:0 sc1 lds
    v_mfma_f32_16x16x32_bf16 v[68:71], a[12:15], a[100:103], v[68:71]
    v_mfma_f32_16x16x32_bf16 v[76:79], a[8:11], a[104:107], v[76:79]
    ds_read_b64_tr_b16 a[84:85], v10 offset:16384
    v_mfma_f32_16x16x32_bf16 v[76:79], a[12:15], a[108:111], v[76:79]
    v_mfma_f32_16x16x32_bf16 v[128:131], a[16:19], a[96:99], v[128:131]
    buffer_store_dwordx4 a[176:179], v2, s[24:27], s28 offen sc1
    v_mfma_f32_16x16x32_bf16 v[128:131], a[20:23], a[100:103], v[128:131]
    s_add_u32 s28, s28, s31
    ds_read_b64_tr_b16 a[86:87], v10 offset:18432
    v_mfma_f32_16x16x32_bf16 v[136:139], a[16:19], a[104:107], v[136:139]
    v_mfma_f32_16x16x32_bf16 v[136:139], a[20:23], a[108:111], v[136:139]
    v_mfma_f32_16x16x32_bf16 v[132:135], a[24:27], a[96:99], v[132:135]
    buffer_load_dwordx4 v17, s[40:43], s48 offen offset:1024 sc1 lds
    v_mfma_f32_16x16x32_bf16 v[132:135], a[28:31], a[100:103], v[132:135]
    s_add_u32 s48, s48, 128
    ds_read_b64_tr_b16 a[88:89], v11 offset:0
    v_mfma_f32_16x16x32_bf16 v[140:143], a[24:27], a[104:107], v[140:143]
    v_mfma_f32_16x16x32_bf16 v[140:143], a[28:31], a[108:111], v[140:143]
    v_mfma_f32_16x16x32_bf16 v[192:195], a[32:35], a[96:99], v[192:195]
    buffer_store_dwordx4 a[180:183], v2, s[24:27], s28 offen sc1
    v_mfma_f32_16x16x32_bf16 v[192:195], a[36:39], a[100:103], v[192:195]
    s_add_u32 s28, s28, s31
    ds_read_b64_tr_b16 a[90:91], v11 offset:2048
    v_mfma_f32_16x16x32_bf16 v[200:203], a[32:35], a[104:107], v[200:203]
    v_mfma_f32_16x16x32_bf16 v[200:203], a[36:39], a[108:111], v[200:203]
    v_mfma_f32_16x16x32_bf16 v[196:199], a[40:43], a[96:99], v[196:199]
    buffer_load_dwordx4 v16, s[40:43], s49 offen offset:2048 sc1 lds
    v_mfma_f32_16x16x32_bf16 v[196:199], a[44:47], a[100:103], v[196:199]
    ds_read_b64_tr_b16 a[92:93], v11 offset:16384
    v_mfma_f32_16x16x32_bf16 v[204:207], a[40:43], a[104:107], v[204:207]
    v_mfma_f32_16x16x32_bf16 v[204:207], a[44:47], a[108:111], v[204:207]
    v_mfma_f32_16x16x32_bf16 a[224:227], a[48:51], a[96:99], a[224:227]
    buffer_store_dwordx4 a[184:187], v2, s[24:27], s28 offen sc1
    v_mfma_f32_16x16x32_bf16 a[224:227], a[52:55], a[100:103], a[224:227]
    s_add_u32 s28, s28, s31
    ds_read_b64_tr_b16 a[94:95], v11 offset:18432
    v_mfma_f32_16x16x32_bf16 a[232:235], a[48:51], a[104:107], a[232:235]
    v_mfma_f32_16x16x32_bf16 a[232:235], a[52:55], a[108:111], a[232:235]
    v_mfma_f32_16x16x32_bf16 a[228:231], a[56:59], a[96:99], a[228:231]
    buffer_load_dwordx4 v17, s[40:43], s49 offen offset:3072 sc1 lds
    v_mfma_f32_16x16x32_bf16 a[228:231], a[60:63], a[100:103], a[228:231]
    s_add_u32 s49, s49, 128
    v_mfma_f32_16x16x32_bf16 a[236:239], a[56:59], a[104:107], a[236:239]
    buffer_store_dwordx4 a[188:191], v2, s[24:27], s28 offen sc1
    v_mfma_f32_16x16x32_bf16 a[236:239], a[60:63], a[108:111], a[236:239]
    s_add_u32 s29, s29, s30
    s_mov_b32 s28, s29
    v_mfma_f32_16x16x32_bf16 v[80:83], a[0:3], a[112:115], v[80:83]
    v_mfma_f32_16x16x32_bf16 v[80:83], a[4:7], a[116:119], v[80:83]
    ds_read_b64_tr_b16 a[96:97], v12 offset:0
    v_mfma_f32_16x16x32_bf16 v[88:91], a[0:3], a[120:123], v[88:91]
    v_mfma_f32_16x16x32_bf16 v[88:91], a[4:7], a[124:127], v[88:91]
    s_add_u32 m0, s61, 4096
    ds_read_b128 a[0:3], v6 offset:0
    v_mfma_f32_16x16x32_bf16 v[84:87], a[8:11], a[112:115], v[84:87]
    buffer_load_dwordx4 v16, s[40:43], s50 offen offset:0 sc1 lds
    v_mfma_f32_16x16x32_bf16 v[84:87], a[12:15], a[116:119], v[84:87]
    s_add_u32 s61, s61, 32768
    ds_read_b128 a[4:7], v7 offset:0
    v_mfma_f32_16x16x32_bf16 v[92:95], a[8:11], a[120:123], v[92:95]
    s_cmp_ge_u32 s61, 98304
    s_cselect_b32 s90, 98304, 0
    ds_read_b64_tr_b16 a[98:99], v12 offset:2048
    v_mfma_f32_16x16x32_bf16 v[92:95], a[12:15], a[124:127], v[92:95]
    s_sub_u32 s61, s61, s90
    ds_read_b128 a[8:11], v6 offset:2048
    v_mfma_f32_16x16x32_bf16 v[144:147], a[16:19], a[112:115], v[144:147]
    ds_read_b128 a[12:15], v7 offset:2048
    v_mfma_f32_16x16x32_bf16 v[144:147], a[20:23], a[116:119], v[144:147]
    ds_read_b64_tr_b16 a[100:101], v12 offset:16384
    v_mfma_f32_16x16x32_bf16 v[152:155], a[16:19], a[120:123], v[152:155]
    v_mfma_f32_16x16x32_bf16 v[152:155], a[20:23], a[124:127], v[152:155]
    ds_read_b128 a[16:19], v6 offset:4096
    v_mfma_f32_16x16x32_bf16 v[148:151], a[24:27], a[112:115], v[148:151]
    buffer_load_dwordx4 v17, s[40:43], s50 offen offset:1024 sc1 lds
    v_mfma_f32_16x16x32_bf16 v[148:151], a[28:31], a[116:119], v[148:151]
    s_add_u32 s50, s50, 128
    ds_read_b128 a[20:23], v7 offset:4096
    v_mfma_f32_16x16x32_bf16 v[156:159], a[24:27], a[120:123], v[156:159]
    ds_read_b64_tr_b16 a[102:103], v12 offset:18432
    v_mfma_f32_16x16x32_bf16 v[156:159], a[28:31], a[124:127], v[156:159]
    ds_read_b128 a[24:27], v6 offset:6144
    v_mfma_f32_16x16x32_bf16 v[208:211], a[32:35], a[112:115], v[208:211]
    s_sub_u32 s65, s65, 1
    ds_read_b128 a[28:31], v7 offset:6144
    v_mfma_f32_16x16x32_bf16 v[208:211], a[36:39], a[116:119], v[208:211]
    ds_read_b64_tr_b16 a[104:105], v13 offset:0
    v_mfma_f32_16x16x32_bf16 v[216:219], a[32:35], a[120:123], v[216:219]
    v_mfma_f32_16x16x32_bf16 v[216:219], a[36:39], a[124:127], v[216:219]
    ds_read_b128 a[32:35], v6 offset:8192
    v_mfma_f32_16x16x32_bf16 v[212:215], a[40:43], a[112:115], v[212:215]
    buffer_load_dwordx4 v16, s[40:43], s51 offen offset:2048 sc1 lds
    v_mfma_f32_16x16x32_bf16 v[212:215], a[44:47], a[116:119], v[212:215]
    ds_read_b128 a[36:39], v7 offset:8192
    v_mfma_f32_16x16x32_bf16 v[220:223], a[40:43], a[120:123], v[220:223]
    ds_read_b64_tr_b16 a[106:107], v13 offset:2048
    v_mfma_f32_16x16x32_bf16 v[220:223], a[44:47], a[124:127], v[220:223]
    ds_read_b128 a[40:43], v6 offset:10240
    v_mfma_f32_16x16x32_bf16 a[240:243], a[48:51], a[112:115], a[240:243]
    ds_read_b128 a[44:47], v7 offset:10240
    v_mfma_f32_16x16x32_bf16 a[240:243], a[52:55], a[116:119], a[240:243]
    ds_read_b64_tr_b16 a[108:109], v13 offset:16384
    v_mfma_f32_16x16x32_bf16 a[248:251], a[48:51], a[120:123], a[248:251]
    v_mfma_f32_16x16x32_bf16 a[248:251], a[52:55], a[124:127], a[248:251]
    ds_read_b128 a[48:51], v6 offset:12288
    v_mfma_f32_16x16x32_bf16 a[244:247], a[56:59], a[112:115], a[244:247]
    buffer_load_dwordx4 v17, s[40:43], s51 offen offset:3072 sc1 lds
    v_mfma_f32_16x16x32_bf16 a[244:247], a[60:63], a[116:119], a[244:247]
    s_add_u32 s51, s51, 128
    ds_read_b128 a[52:55], v7 offset:12288
    v_mfma_f32_16x16x32_bf16 a[252:255], a[56:59], a[120:123], a[252:255]
    ds_read_b64_tr_b16 a[110:111], v13 offset:18432
    v_mfma_f32_16x16x32_bf16 a[252:255], a[60:63], a[124:127], a[252:255]
    ds_read_b128 a[56:59], v6 offset:14336
    ds_read_b128 a[60:63], v7 offset:14336
    s_cmp_eq_u32 s66, 2
    s_cbranch_scc1 m_hook18
m_hookr19:
    s_waitcnt lgkmcnt(15)
    v_mfma_f32_16x16x32_bf16 v[32:35], a[0:3], a[64:67], v[32:35]
    ds_read_b64_tr_b16 a[112:113], v14 offset:0
    v_mfma_f32_16x16x32_bf16 v[32:35], a[4:7], a[68:71], v[32:35]
    ds_read_b64_tr_b16 a[114:115], v14 offset:2048
    v_mfma_f32_16x16x32_bf16 v[40:43], a[0:3], a[72:75], v[40:43]
    ds_read_b64_tr_b16 a[116:117], v14 offset:16384
    v_mfma_f32_16x16x32_bf16 v[40:43], a[4:7], a[76:79], v[40:43]
    ds_read_b64_tr_b16 a[118:119], v14 offset:18432
    v_mfma_f32_16x16x32_bf16 v[36:39], a[8:11], a[64:67], v[36:39]
    ds_read_b64_tr_b16 a[120:121], v15 offset:0
    v_mfma_f32_16x16x32_bf16 v[36:39], a[12:15], a[68:71], v[36:39]
    ds_read_b64_tr_b16 a[122:123], v15 offset:2048
    v_mfma_f32_16x16x32_bf16 v[44:47], a[8:11], a[72:75], v[44:47]
    ds_read_b64_tr_b16 a[124:125], v15 offset:16384
    v_mfma_f32_16x16x32_bf16 v[44:47], a[12:15], a[76:79], v[44:47]
    ds_read_b64_tr_b16 a[126:127], v15 offset:18432
    v_mfma_f32_16x16x32_bf16 v[96:99], a[16:19], a[64:67], v[96:99]
    v_mfma_f32_16x16x32_bf16 v[96:99], a[20:23], a[68:71], v[96:99]
    v_mfma_f32_16x16x32_bf16 v[104:107], a[16:19], a[72:75], v[104:107]
    buffer_store_dwordx4 a[192:195], v2, s[24:27], s28 offen sc1
    v_mfma_f32_16x16x32_bf16 v[104:107], a[20:23], a[76:79], v[104:107]
    s_add_u32 s28, s28, s31
    s_waitcnt lgkmcnt(15)
    v_mfma_f32_16x16x32_bf16 v[100:103], a[24:27], a[64:67], v[100:103]
    v_xor_b32 v8, s60, v8
    v_xor_b32 v9, s60, v9
    v_mfma_f32_16x16x32_bf16 v[100:103], a[28:31], a[68:71], v[100:103]
    v_xor_b32 v10, s60, v10
    v_xor_b32 v11, s60, v11
    v_mfma_f32_16x16x32_bf16 v[108:111], a[24:27], a[72:75], v[108:111]
    v_xor_b32 v12, s60, v12
    v_xor_b32 v13, s60, v13
    v_mfma_f32_16x16x32_bf16 v[108:111], a[28:31], a[76:79], v[108:111]
    v_xor_b32 v14, s60, v14
    v_xor_b32 v15, s60, v15
    v_mfma_f32_16x16x32_bf16 v[160:163], a[32:35], a[64:67], v[160:163]
    buffer_store_dwordx4 a[196:199], v2, s[24:27], s28 offen sc1
    v_mfma_f32_16x16x32_bf16 v[160:163], a[36:39], a[68:71], v[160:163]
    s_add_u32 s28, s28, s31
    v_mfma_f32_16x16x32_bf16 v[168:171], a[32:35], a[72:75], v[168:171]
    v_mfma_f32_16x16x32_bf16 v[168:171], a[36:39], a[76:79], v[168:171]
    s_waitcnt lgkmcnt(14)
    v_mfma_f32_16x16x32_bf16 v[164:167], a[40:43], a[64:67], v[164:167]
    v_mfma_f32_16x16x32_bf16 v[164:167], a[44:47], a[68:71], v[164:167]
    v_mfma_f32_16x16x32_bf16 v[172:175], a[40:43], a[72:75], v[172:175]
    buffer_store_dwordx4 a[200:203], v2, s[24:27], s28 offen sc1
    v_mfma_f32_16x16x32_bf16 v[172:175], a[44:47], a[76:79], v[172:175]
    s_add_u32 s28, s28, s31
    s_waitcnt lgkmcnt(11)
    v_mfma_f32_16x16x32_bf16 v[224:227], a[48:51], a[64:67], v[224:227]
    v_mfma_f32_16x16x32_bf16 v[224:227], a[52:55], a[68:71], v[224:227]
    v_mfma_f32_16x16x32_bf16 v[232:235], a[48:51], a[72:75], v[232:235]
    v_mfma_f32_16x16x32_bf16 v[232:235], a[52:55], a[76:79], v[232:235]
    s_waitcnt lgkmcnt(8)
    v_mfma_f32_16x16x32_bf16 v[228:231], a[56:59], a[64:67], v[228:231]
    buffer_store_dwordx4 a[204:207], v2, s[24:27], s28 offen sc1
    v_mfma_f32_16x16x32_bf16 v[228:231], a[60:63], a[68:71], v[228:231]
    s_add_u32 s28, s28, s31
    v_mfma_f32_16x16x32_bf16 v[236:239], a[56:59], a[72:75], v[236:239]
    s_waitcnt vmcnt(16) lgkmcnt(0)
    v_mfma_f32_16x16x32_bf16 v[236:239], a[60:63], a[76:79], v[236:239]
    s_barrier
    v_mfma_f32_16x16x32_bf16 v[48:51], a[0:3], a[80:83], v[48:51]
    ds_read_b64_tr_b16 a[64:65], v8 offset:0
    v_mfma_f32_16x16x32_bf16 v[48:51], a[4:7], a[84:87], v[48:51]
    s_add_u32 m0, s62, 0
    v_mfma_f32_16x16x32_bf16 v[56:59], a[0:3], a[88:91], v[56:59]
    buffer_load_dwordx4 v18, s[44:47], s52 offen offset:0 sc1 lds
    v_mfma_f32_16x16x32_bf16 v[56:59], a[4:7], a[92:95], v[56:59]
    ds_read_b64_tr_b16 a[66:67], v8 offset:2048
    v_mfma_f32_16x16x32_bf16 v[52:55], a[8:11], a[80:83], v[52:55]
    s_add_u32 s64, s64, 32768
    v_mfma_f32_16x16x32_bf16 v[52:55], a[12:15], a[84:87], v[52:55]
    s_cmp_ge_u32 s64, 98304
    s_cselect_b32 s63, 4294901760, s59
    s_cselect_b32 s64, 0, s64
    v_mfma_f32_16x16x32_bf16 v[60:63], a[8:11], a[88:91], v[60:63]
    buffer_load_dwordx4 v19, s[44:47], s52 offen offset:1024 sc1 lds
    v_mfma_f32_16x16x32_bf16 v[60:63], a[12:15], a[92:95], v[60:63]
    s_add_u32 s52, s52, s56
    ds_read_b64_tr_b16 a[68:69], v8 offset:16384
    v_mfma_f32_16x16x32_bf16 v[112:115], a[16:19], a[80:83], v[112:115]
    v_mfma_f32_16x16x32_bf16 v[112:115], a[20:23], a[84:87], v[112:115]
    v_mfma_f32_16x16x32_bf16 v[120:123], a[16:19], a[88:91], v[120:123]
    buffer_load_dwordx4 v18, s[44:47], s53 offen offset:2048 sc1 lds
    v_mfma_f32_16x16x32_bf16 v[120:123], a[20:23], a[92:95], v[120:123]
    ds_read_b64_tr_b16 a[70:71], v8 offset:18432
    v_mfma_f32_16x16x32_bf16 v[116:119], a[24:27], a[80:83], v[116:119]
    v_mfma_f32_16x16x32_bf16 v[116:119], a[28:31], a[84:87], v[116:119]
    v_mfma_f32_16x16x32_bf16 v[124:127], a[24:27], a[88:91], v[124:127]
    buffer_load_dwordx4 v19, s[44:47], s53 offen offset:3072 sc1 lds
    v_mfma_f32_16x16x32_bf16 v[124:127], a[28:31], a[92:95], v[124:127]
    s_add_u32 s53, s53, s56
    ds_read_b64_tr_b16 a[72:73], v9 offset:0
    v_mfma_f32_16x16x32_bf16 v[176:179], a[32:35], a[80:83], v[176:179]
    v_mfma_f32_16x16x32_bf16 v[176:179], a[36:39], a[84:87], v[176:179]
    s_add_u32 m0, s62, 4096
    v_mfma_f32_16x16x32_bf16 v[184:187], a[32:35], a[88:91], v[184:187]
    buffer_load_dwordx4 v20, s[44:47], s54 offen offset:0 sc1 lds
    v_mfma_f32_16x16x32_bf16 v[184:187], a[36:39], a[92:95], v[184:187]
    s_xor_b32 s62, s62, 229376
    ds_read_b64_tr_b16 a[74:75], v9 offset:2048
    v_mfma_f32_16x16x32_bf16 v[180:183], a[40:43], a[80:83], v[180:183]
    v_mfma_f32_16x16x32_bf16 v[180:183], a[44:47], a[84:87], v[180:183]
    v_mfma_f32_16x16x32_bf16 v[188:191], a[40:43], a[88:91], v[188:191]
    buffer_load_dwordx4 v21, s[44:47], s54 offen offset:1024 sc1 lds
    v_mfma_f32_16x16x32_bf16 v[188:191], a[44:47], a[92:95], v[188:191]
    s_add_u32 s54, s54, s56
    ds_read_b64_tr_b16 a[76:77], v9 offset:16384
    v_mfma_f32_16x16x32_bf16 v[240:243], a[48:51], a[80:83], v[240:243]
    v_mfma_f32_16x16x32_bf16 v[240:243], a[52:55], a[84:87], v[240:243]
    v_mfma_f32_16x16x32_bf16 v[248:251], a[48:51], a[88:91], v[248:251]
    buffer_load_dwordx4 v20, s[44:47], s55 offen offset:2048 sc1 lds
    v_mfma_f32_16x16x32_bf16 v[248:251], a[52:55], a[92:95], v[248:251]
    ds_read_b64_tr_b16 a[78:79], v9 offset:18432
    v_mfma_f32_16x16x32_bf16 v[244:247], a[56:59], a[80:83], v[244:247]
    v_add_u32 v6, s63, v6
    v_add_u32 v7, s63, v7
    v_mfma_f32_16x16x32_bf16 v[244:247], a[60:63], a[84:87], v[244:247]
    v_mfma_f32_16x16x32_bf16 v[252:255], a[56:59], a[88:91], v[252:255]
    buffer_load_dwordx4 v21, s[44:47], s55 offen offset:3072 sc1 lds
    v_mfma_f32_16x16x32_bf16 v[252:255], a[60:63], a[92:95], v[252:255]
    s_add_u32 s55, s55, s56
    v_mfma_f32_16x16x32_bf16 v[64:67], a[0:3], a[96:99], v[64:67]
    ds_read_b64_tr_b16 a[80:81], v10 offset:0
    v_mfma_f32_16x16x32_bf16 v[64:67], a[4:7], a[100:103], v[64:67]
    v_mfma_f32_16x16x32_bf16 v[72:75], a[0:3], a[104:107], v[72:75]
    v_mfma_f32_16x16x32_bf16 v[72:75], a[4:7], a[108:111], v[72:75]
    s_add_u32 m0, s61, 0
    ds_read_b64_tr_b16 a[82:83], v10 offset:2048
    v_mfma_f32_16x16x32_bf16 v[68:71], a[8:11], a[96:99], v[68:71]
    buffer_load_dwordx4 v16, s[40:43], s48 offen offset:0 sc1 lds
    v_mfma_f32_16x16x32_bf16 v[68:71], a[12:15], a[100:103], v[68:71]
    v_mfma_f32_16x16x32_bf16 v[76:79], a[8:11], a[104:107], v[76:79]
    ds_read_b64_tr_b16 a[84:85], v10 offset:16384
    v_mfma_f32_16x16x32_bf16 v[76:79], a[12:15], a[108:111], v[76:79]
    v_mfma_f32_16x16x32_bf16 v[128:131], a[16:19], a[96:99], v[128:131]
    buffer_store_dwordx4 a[208:211], v2, s[24:27], s28 offen sc1
    v_mfma_f32_16x16x32_bf16 v[128:131], a[20:23], a[100:103], v[128:131]
    s_add_u32 s28, s28, s31
    ds_read_b64_tr_b16 a[86:87], v10 offset:18432
    v_mfma_f32_16x16x32_bf16 v[136:139], a[16:19], a[104:107], v[136:139]
    v_mfma_f32_16x16x32_bf16 v[136:139], a[20:23], a[108:111], v[136:139]
    v_mfma_f32_16x16x32_bf16 v[132:135], a[24:27], a[96:99], v[132:135]
    buffer_load_dwordx4 v17, s[40:43], s48 offen offset:1024 sc1 lds
    v_mfma_f32_16x16x32_bf16 v[132:135], a[28:31], a[100:103], v[132:135]
    s_add_u32 s48, s48, 128
    ds_read_b64_tr_b16 a[88:89], v11 offset:0
    v_mfma_f32_16x16x32_bf16 v[140:143], a[24:27], a[104:107], v[140:143]
    v_mfma_f32_16x16x32_bf16 v[140:143], a[28:31], a[108:111], v[140:143]
    v_mfma_f32_16x16x32_bf16 v[192:195], a[32:35], a[96:99], v[192:195]
    buffer_store_dwordx4 a[212:215], v2, s[24:27], s28 offen sc1
    v_mfma_f32_16x16x32_bf16 v[192:195], a[36:39], a[100:103], v[192:195]
    s_add_u32 s28, s28, s31
    ds_read_b64_tr_b16 a[90:91], v11 offset:2048
    v_mfma_f32_16x16x32_bf16 v[200:203], a[32:35], a[104:107], v[200:203]
    v_mfma_f32_16x16x32_bf16 v[200:203], a[36:39], a[108:111], v[200:203]
    v_mfma_f32_16x16x32_bf16 v[196:199], a[40:43], a[96:99], v[196:199]
    buffer_load_dwordx4 v16, s[40:43], s49 offen offset:2048 sc1 lds
    v_mfma_f32_16x16x32_bf16 v[196:199], a[44:47], a[100:103], v[196:199]
    ds_read_b64_tr_b16 a[92:93], v11 offset:16384
    v_mfma_f32_16x16x32_bf16 v[204:207], a[40:43], a[104:107], v[204:207]
    v_mfma_f32_16x16x32_bf16 v[204:207], a[44:47], a[108:111], v[204:207]
    v_mfma_f32_16x16x32_bf16 a[224:227], a[48:51], a[96:99], a[224:227]
    buffer_store_dwordx4 a[216:219], v2, s[24:27], s28 offen sc1
    v_mfma_f32_16x16x32_bf16 a[224:227], a[52:55], a[100:103], a[224:227]
    s_add_u32 s28, s28, s31
    ds_read_b64_tr_b16 a[94:95], v11 offset:18432
    v_mfma_f32_16x16x32_bf16 a[232:235], a[48:51], a[104:107], a[232:235]
    v_mfma_f32_16x16x32_bf16 a[232:235], a[52:55], a[108:111], a[232:235]
    v_mfma_f32_16x16x32_bf16 a[228:231], a[56:59], a[96:99], a[228:231]
    buffer_load_dwordx4 v17, s[40:43], s49 offen offset:3072 sc1 lds
    v_mfma_f32_16x16x32_bf16 a[228:231], a[60:63], a[100:103], a[228:231]
    s_add_u32 s49, s49, 128
    v_mfma_f32_16x16x32_bf16 a[236:239], a[56:59], a[104:107], a[236:239]
    buffer_store_dwordx4 a[220:223], v2, s[24:27], s28 offen sc1
    v_mfma_f32_16x16x32_bf16 a[236:239], a[60:63], a[108:111], a[236:239]
    s_add_u32 s29, s29, s30
    s_mov_b32 s28, s29
    v_mfma_f32_16x16x32_bf16 v[80:83], a[0:3], a[112:115], v[80:83]
    v_mfma_f32_16x16x32_bf16 v[80:83], a[4:7], a[116:119], v[80:83]
    ds_read_b64_tr_b16 a[96:97], v12 offset:0
    v_mfma_f32_16x16x32_bf16 v[88:91], a[0:3], a[120:123], v[88:91]
    v_mfma_f32_16x16x32_bf16 v[88:91], a[4:7], a[124:127], v[88:91]
    s_add_u32 m0, s61, 4096
    ds_read_b128 a[0:3], v6 offset:0
    v_mfma_f32_16x16x32_bf16 v[84:87], a[8:11], a[112:115], v[84:87]
    buffer_load_dwordx4 v16, s[40:43], s50 offen offset:0 sc1 lds
    v_mfma_f32_16x16x32_bf16 v[84:87], a[12:15], a[116:119], v[84:87]
    s_add_u32 s61, s61, 32768
    ds_read_b128 a[4:7], v7 offset:0
    v_mfma_f32_16x16x32_bf16 v[92:95], a[8:11], a[120:123], v[92:95]
    s_cmp_ge_u32 s61, 98304
    s_cselect_b32 s90, 98304, 0
    ds_read_b64_tr_b16 a[98:99], v12 offset:2048
    v_mfma_f32_16x16x32_bf16 v[92:95], a[12:15], a[124:127], v[92:95]
    s_sub_u32 s61, s61, s90
    ds_read_b128 a[8:11], v6 offset:2048
    v_mfma_f32_16x16x32_bf16 v[144:147], a[16:19], a[112:115], v[144:147]
    ds_read_b128 a[12:15], v7 offset:2048
    v_mfma_f32_16x16x32_bf16 v[144:147], a[20:23], a[116:119], v[144:147]
    ds_read_b64_tr_b16 a[100:101], v12 offset:16384
    v_mfma_f32_16x16x32_bf16 v[152:155], a[16:19], a[120:123], v[152:155]
    v_mfma_f32_16x16x32_bf16 v[152:155], a[20:23], a[124:127], v[152:155]
    ds_read_b128 a[16:19], v6 offset:4096
    v_mfma_f32_16x16x32_bf16 v[148:151], a[24:27], a[112:115], v[148:151]
    buffer_load_dwordx4 v17, s[40:43], s50 offen offset:1024 sc1 lds
    v_mfma_f32_16x16x32_bf16 v[148:151], a[28:31], a[116:119], v[148:151]
    s_add_u32 s50, s50, 128
    ds_read_b128 a[20:23], v7 offset:4096
    v_mfma_f32_16x16x32_bf16 v[156:159], a[24:27], a[120:123], v[156:159]
    ds_read_b64_tr_b16 a[102:103], v12 offset:18432
    v_mfma_f32_16x16x32_bf16 v[156:159], a[28:31], a[124:127], v[156:159]
    ds_read_b128 a[24:27], v6 offset:6144
    v_mfma_f32_16x16x32_bf16 v[208:211], a[32:35], a[112:115], v[208:211]
    s_sub_u32 s65, s65, 1
    ds_read_b128 a[28:31], v7 offset:6144
    v_mfma_f32_16x16x32_bf16 v[208:211], a[36:39], a[116:119], v[208:211]
    ds_read_b64_tr_b16 a[104:105], v13 offset:0
    v_mfma_f32_16x16x32_bf16 v[216:219], a[32:35], a[120:123], v[216:219]
    v_mfma_f32_16x16x32_bf16 v[216:219], a[36:39], a[124:127], v[216:219]
    ds_read_b128 a[32:35], v6 offset:8192
    v_mfma_f32_16x16x32_bf16 v[212:215], a[40:43], a[112:115], v[212:215]
    buffer_load_dwordx4 v16, s[40:43], s51 offen offset:2048 sc1 lds
    v_mfma_f32_16x16x32_bf16 v[212:215], a[44:47], a[116:119], v[212:215]
    ds_read_b128 a[36:39], v7 offset:8192
    v_mfma_f32_16x16x32_bf16 v[220:223], a[40:43], a[120:123], v[220:223]
    ds_read_b64_tr_b16 a[106:107], v13 offset:2048
    v_mfma_f32_16x16x32_bf16 v[220:223], a[44:47], a[124:127], v[220:223]
    ds_read_b128 a[40:43], v6 offset:10240
    v_mfma_f32_16x16x32_bf16 a[240:243], a[48:51], a[112:115], a[240:243]
    ds_read_b128 a[44:47], v7 offset:10240
    v_mfma_f32_16x16x32_bf16 a[240:243], a[52:55], a[116:119], a[240:243]
    ds_read_b64_tr_b16 a[108:109], v13 offset:16384
    v_mfma_f32_16x16x32_bf16 a[248:251], a[48:51], a[120:123], a[248:251]
    v_mfma_f32_16x16x32_bf16 a[248:251], a[52:55], a[124:127], a[248:251]
    ds_read_b128 a[48:51], v6 offset:12288
    v_mfma_f32_16x16x32_bf16 a[244:247], a[56:59], a[112:115], a[244:247]
    buffer_load_dwordx4 v17, s[40:43], s51 offen offset:3072 sc1 lds
    v_mfma_f32_16x16x32_bf16 a[244:247], a[60:63], a[116:119], a[244:247]
    s_add_u32 s51, s51, 128
    ds_read_b128 a[52:55], v7 offset:12288
    v_mfma_f32_16x16x32_bf16 a[252:255], a[56:59], a[120:123], a[252:255]
    ds_read_b64_tr_b16 a[110:111], v13 offset:18432
    v_mfma_f32_16x16x32_bf16 a[252:255], a[60:63], a[124:127], a[252:255]
    ds_read_b128 a[56:59], v6 offset:14336
    ds_read_b128 a[60:63], v7 offset:14336
m_loop20:
    s_waitcnt lgkmcnt(15)
    v_mfma_f32_16x16x32_bf16 v[32:35], a[0:3], a[64:67], v[32:35]
    ds_read_b64_tr_b16 a[112:113], v14 offset:0
    v_mfma_f32_16x16x32_bf16 v[32:35], a[4:7], a[68:71], v[32:35]
    ds_read_b64_tr_b16 a[114:115], v14 offset:2048
    v_mfma_f32_16x16x32_bf16 v[40:43], a[0:3], a[72:75], v[40:43]
    ds_read_b64_tr_b16 a[116:117], v14 offset:16384
    v_mfma_f32_16x16x32_bf16 v[40:43], a[4:7], a[76:79], v[40:43]
    ds_read_b64_tr_b16 a[118:119], v14 offset:18432
    v_mfma_f32_16x16x32_bf16 v[36:39], a[8:11], a[64:67], v[36:39]
    ds_read_b64_tr_b16 a[120:121], v15 offset:0
    v_mfma_f32_16x16x32_bf16 v[36:39], a[12:15], a[68:71], v[36:39]
    ds_read_b64_tr_b16 a[122:123], v15 offset:2048
    v_mfma_f32_16x16x32_bf16 v[44:47], a[8:11], a[72:75], v[44:47]
    ds_read_b64_tr_b16 a[124:125], v15 offset:16384
    v_mfma_f32_16x16x32_bf16 v[44:47], a[12:15], a[76:79], v[44:47]
    ds_read_b64_tr_b16 a[126:127], v15 offset:18432
    v_mfma_f32_16x16x32_bf16 v[96:99], a[16:19], a[64:67], v[96:99]
    v_mfma_f32_16x16x32_bf16 v[96:99], a[20:23], a[68:71], v[96:99]
    v_mfma_f32_16x16x32_bf16 v[104:107], a[16:19], a[72:75], v[104:107]
    v_mfma_f32_16x16x32_bf16 v[104:107], a[20:23], a[76:79], v[104:107]
    s_waitcnt lgkmcnt(15)
    v_mfma_f32_16x16x32_bf16 v[100:103], a[24:27], a[64:67], v[100:103]
    v_xor_b32 v8, s60, v8
    v_xor_b32 v9, s60, v9
    v_mfma_f32_16x16x32_bf16 v[100:103], a[28:31], a[68:71], v[100:103]
    v_xor_b32 v10, s60, v10
    v_xor_b32 v11, s60, v11
    v_mfma_f32_16x16x32_bf16 v[108:111], a[24:27], a[72:75], v[108:111]
    v_xor_b32 v12, s60, v12
    v_xor_b32 v13, s60, v13
    v_mfma_f32_16x16x32_bf16 v[108:111], a[28:31], a[76:79], v[108:111]
    v_xor_b32 v14, s60, v14
    v_xor_b32 v15, s60, v15
    v_mfma_f32_16x16x32_bf16 v[160:163], a[32:35], a[64:67], v[160:163]
    v_mfma_f32_16x16x32_bf16 v[160:163], a[36:39], a[68:71], v[160:163]
    v_mfma_f32_16x16x32_bf16 v[168:171], a[32:35], a[72:75], v[168:171]
    v_mfma_f32_16x16x32_bf16 v[168:171], a[36:39], a[76:79], v[168:171]
    s_waitcnt lgkmcnt(14)
    v_mfma_f32_16x16x32_bf16 v[164:167], a[40:43], a[64:67], v[164:167]
    v_mfma_f32_16x16x32_bf16 v[164:167], a[44:47], a[68:71], v[164:167]
    v_mfma_f32_16x16x32_bf16 v[172:175], a[40:43], a[72:75], v[172:175]
    v_mfma_f32_16x16x32_bf16 v[172:175], a[44:47], a[76:79], v[172:175]
    s_waitcnt lgkmcnt(11)
    v_mfma_f32_16x16x32_bf16 v[224:227], a[48:51], a[64:67], v[224:227]
    v_mfma_f32_16x16x32_bf16 v[224:227], a[52:55], a[68:71], v[224:227]
    v_mfma_f32_16x16x32_bf16 v[232:235], a[48:51], a[72:75], v[232:235]
    v_mfma_f32_16x16x32_bf16 v[232:235], a[52:55], a[76:79], v[232:235]
    s_waitcnt lgkmcnt(8)
    v_mfma_f32_16x16x32_bf16 v[228:231], a[56:59], a[64:67], v[228:231]
    v_mfma_f32_16x16x32_bf16 v[228:231], a[60:63], a[68:71], v[228:231]
    v_mfma_f32_16x16x32_bf16 v[236:239], a[56:59], a[72:75], v[236:239]
    s_waitcnt vmcnt(8) lgkmcnt(0)
    v_mfma_f32_16x16x32_bf16 v[236:239], a[60:63], a[76:79], v[236:239]
    s_barrier
    v_mfma_f32_16x16x32_bf16 v[48:51], a[0:3], a[80:83], v[48:51]
    ds_read_b64_tr_b16 a[64:65], v8 offset:0
    v_mfma_f32_16x16x32_bf16 v[48:51], a[4:7], a[84:87], v[48:51]
    s_add_u32 m0, s62, 0
    v_mfma_f32_16x16x32_bf16 v[56:59], a[0:3], a[88:91], v[56:59]
    buffer_load_dwordx4 v18, s[44:47], s52 offen offset:0 sc1 lds
    v_mfma_f32_16x16x32_bf16 v[56:59], a[4:7], a[92:95], v[56:59]
    ds_read_b64_tr_b16 a[66:67], v8 offset:2048
    v_mfma_f32_16x16x32_bf16 v[52:55], a[8:11], a[80:83], v[52:55]
    s_add_u32 s64, s64, 32768
    v_mfma_f32_16x16x32_bf16 v[52:55], a[12:15], a[84:87], v[52:55]
    s_cmp_ge_u32 s64, 98304
    s_cselect_b32 s63, 4294901760, s59
    s_cselect_b32 s64, 0, s64
    v_mfma_f32_16x16x32_bf16 v[60:63], a[8:11], a[88:91], v[60:63]
    buffer_load_dwordx4 v19, s[44:47], s52 offen offset:1024 sc1 lds
    v_mfma_f32_16x16x32_bf16 v[60:63], a[12:15], a[92:95], v[60:63]
    s_add_u32 s52, s52, s56
    ds_read_b64_tr_b16 a[68:69], v8 offset:16384
    v_mfma_f32_16x16x32_bf16 v[112:115], a[16:19], a[80:83], v[112:115]
    v_mfma_f32_16x16x32_bf16 v[112:115], a[20:23], a[84:87], v[112:115]
    v_mfma_f32_16x16x32_bf16 v[120:123], a[16:19], a[88:91], v[120:123]
    buffer_load_dwordx4 v18, s[44:47], s53 offen offset:2048 sc1 lds
    v_mfma_f32_16x16x32_bf16 v[120:123], a[20:23], a[92:95], v[120:123]
    ds_read_b64_tr_b16 a[70:71], v8 offset:18432
    v_mfma_f32_16x16x32_bf16 v[116:119], a[24:27], a[80:83], v[116:119]
    v_mfma_f32_16x16x32_bf16 v[116:119], a[28:31], a[84:87], v[116:119]
    v_mfma_f32_16x16x32_bf16 v[124:127], a[24:27], a[88:91], v[124:127]
    buffer_load_dwordx4 v19, s[44:47], s53 offen offset:3072 sc1 lds
    v_mfma_f32_16x16x32_bf16 v[124:127], a[28:31], a[92:95], v[124:127]
    s_add_u32 s53, s53, s56
    ds_read_b64_tr_b16 a[72:73], v9 offset:0
    v_mfma_f32_16x16x32_bf16 v[176:179], a[32:35], a[80:83], v[176:179]
    v_mfma_f32_16x16x32_bf16 v[176:179], a[36:39], a[84:87], v[176:179]
    s_add_u32 m0, s62, 4096
    v_mfma_f32_16x16x32_bf16 v[184:187], a[32:35], a[88:91], v[184:187]
    buffer_load_dwordx4 v20, s[44:47], s54 offen offset:0 sc1 lds
    v_mfma_f32_16x16x32_bf16 v[184:187], a[36:39], a[92:95], v[184:187]
    s_xor_b32 s62, s62, 229376
    ds_read_b64_tr_b16 a[74:75], v9 offset:2048
    v_mfma_f32_16x16x32_bf16 v[180:183], a[40:43], a[80:83], v[180:183]
    v_mfma_f32_16x16x32_bf16 v[180:183], a[44:47], a[84:87], v[180:183]
    v_mfma_f32_16x16x32_bf16 v[188:191], a[40:43], a[88:91], v[188:191]
    buffer_load_dwordx4 v21, s[44:47], s54 offen offset:1024 sc1 lds
    v_mfma_f32_16x16x32_bf16 v[188:191], a[44:47], a[92:95], v[188:191]
    s_add_u32 s54, s54, s56
    ds_read_b64_tr_b16 a[76:77], v9 offset:16384
    v_mfma_f32_16x16x32_bf16 v[240:243], a[48:51], a[80:83], v[240:243]
    v_mfma_f32_16x16x32_bf16 v[240:243], a[52:55], a[84:87], v[240:243]
    v_mfma_f32_16x16x32_bf16 v[248:251], a[48:51], a[88:91], v[248:251]
    buffer_load_dwordx4 v20, s[44:47], s55 offen offset:2048 sc1 lds
    v_mfma_f32_16x16x32_bf16 v[248:251], a[52:55], a[92:95], v[248:251]
    ds_read_b64_tr_b16 a[78:79], v9 offset:18432
    v_mfma_f32_16x16x32_bf16 v[244:247], a[56:59], a[80:83], v[244:247]
    v_add_u32 v6, s63, v6
    v_add_u32 v7, s63, v7
    v_mfma_f32_16x16x32_bf16 v[244:247], a[60:63], a[84:87], v[244:247]
    v_mfma_f32_16x16x32_bf16 v[252:255], a[56:59], a[88:91], v[252:255]
    buffer_load_dwordx4 v21, s[44:47], s55 offen offset:3072 sc1 lds
    v_mfma_f32_16x16x32_bf16 v[252:255], a[60:63], a[92:95], v[252:255]
    s_add_u32 s55, s55, s56
    v_mfma_f32_16x16x32_bf16 v[64:67], a[0:3], a[96:99], v[64:67]
    ds_read_b64_tr_b16 a[80:81], v10 offset:0
    v_mfma_f32_16x16x32_bf16 v[64:67], a[4:7], a[100:103], v[64:67]
    v_mfma_f32_16x16x32_bf16 v[72:75], a[0:3], a[104:107], v[72:75]
    v_mfma_f32_16x16x32_bf16 v[72:75], a[4:7], a[108:111], v[72:75]
    s_add_u32 m0, s61, 0
    ds_read_b64_tr_b16 a[82:83], v10 offset:2048
    v_mfma_f32_16x16x32_bf16 v[68:71], a[8:11], a[96:99], v[68:71]
    buffer_load_dwordx4 v16, s[40:43], s48 offen offset:0 sc1 lds
    v_mfma_f32_16x16x32_bf16 v[68:71], a[12:15], a[100:103], v[68:71]
    v_mfma_f32_16x16x32_bf16 v[76:79], a[8:11], a[104:107], v[76:79]
    ds_read_b64_tr_b16 a[84:85], v10 offset:16384
    v_mfma_f32_16x16x32_bf16 v[76:79], a[12:15], a[108:111], v[76:79]
    v_mfma_f32_16x16x32_bf16 v[128:131], a[16:19], a[96:99], v[128:131]
    v_mfma_f32_16x16x32_bf16 v[128:131], a[20:23], a[100:103], v[128:131]
    ds_read_b64_tr_b16 a[86:87], v10 offset:18432
    v_mfma_f32_16x16x32_bf16 v[136:139], a[16:19], a[104:107], v[136:139]
    v_mfma_f32_16x16x32_bf16 v[136:139], a[20:23], a[108:111], v[136:139]
    v_mfma_f32_16x16x32_bf16 v[132:135], a[24:27], a[96:99], v[132:135]
    buffer_load_dwordx4 v17, s[40:43], s48 offen offset:1024 sc1 lds
    v_mfma_f32_16x16x32_bf16 v[132:135], a[28:31], a[100:103], v[132:135]
    s_add_u32 s48, s48, 128
    ds_read_b64_tr_b16 a[88:89], v11 offset:0
    v_mfma_f32_16x16x32_bf16 v[140:143], a[24:27], a[104:107], v[140:143]
    v_mfma_f32_16x16x32_bf16 v[140:143], a[28:31], a[108:111], v[140:143]
    v_mfma_f32_16x16x32_bf16 v[192:195], a[32:35], a[96:99], v[192:195]
    v_mfma_f32_16x16x32_bf16 v[192:195], a[36:39], a[100:103], v[192:195]
    ds_read_b64_tr_b16 a[90:91], v11 offset:2048
    v_mfma_f32_16x16x32_bf16 v[200:203], a[32:35], a[104:107], v[200:203]
    v_mfma_f32_16x16x32_bf16 v[200:203], a[36:39], a[108:111], v[200:203]
    v_mfma_f32_16x16x32_bf16 v[196:199], a[40:43], a[96:99], v[196:199]
    buffer_load_dwordx4 v16, s[40:43], s49 offen offset:2048 sc1 lds
    v_mfma_f32_16x16x32_bf16 v[196:199], a[44:47], a[100:103], v[196:199]
    ds_read_b64_tr_b16 a[92:93], v11 offset:16384
    v_mfma_f32_16x16x32_bf16 v[204:207], a[40:43], a[104:107], v[204:207]
    v_mfma_f32_16x16x32_bf16 v[204:207], a[44:47], a[108:111], v[204:207]
    v_mfma_f32_16x16x32_bf16 a[224:227], a[48:51], a[96:99], a[224:227]
    v_mfma_f32_16x16x32_bf16 a[224:227], a[52:55], a[100:103], a[224:227]
    ds_read_b64_tr_b16 a[94:95], v11 offset:18432
    v_mfma_f32_16x16x32_bf16 a[232:235], a[48:51], a[104:107], a[232:235]
    v_mfma_f32_16x16x32_bf16 a[232:235], a[52:55], a[108:111], a[232:235]
    v_mfma_f32_16x16x32_bf16 a[228:231], a[56:59], a[96:99], a[228:231]
    buffer_load_dwordx4 v17, s[40:43], s49 offen offset:3072 sc1 lds
    v_mfma_f32_16x16x32_bf16 a[228:231], a[60:63], a[100:103], a[228:231]
    s_add_u32 s49, s49, 128
    v_mfma_f32_16x16x32_bf16 a[236:239], a[56:59], a[104:107], a[236:239]
    v_mfma_f32_16x16x32_bf16 a[236:239], a[60:63], a[108:111], a[236:239]
    v_mfma_f32_16x16x32_bf16 v[80:83], a[0:3], a[112:115], v[80:83]
    v_mfma_f32_16x16x32_bf16 v[80:83], a[4:7], a[116:119], v[80:83]
    ds_read_b64_tr_b16 a[96:97], v12 offset:0
    v_mfma_f32_16x16x32_bf16 v[88:91], a[0:3], a[120:123], v[88:91]
    v_mfma_f32_16x16x32_bf16 v[88:91], a[4:7], a[124:127], v[88:91]
    s_add_u32 m0, s61, 4096
    ds_read_b128 a[0:3], v6 offset:0
    v_mfma_f32_16x16x32_bf16 v[84:87], a[8:11], a[112:115], v[84:87]
    buffer_load_dwordx4 v16, s[40:43], s50 offen offset:0 sc1 lds
    v_mfma_f32_16x16x32_bf16 v[84:87], a[12:15], a[116:119], v[84:87]
    s_add_u32 s61, s61, 32768
    ds_read_b128 a[4:7], v7 offset:0
    v_mfma_f32_16x16x32_bf16 v[92:95], a[8:11], a[120:123], v[92:95]
    s_cmp_ge_u32 s61, 98304
    s_cselect_b32 s90, 98304, 0
    ds_read_b64_tr_b16 a[98:99], v12 offset:2048
    v_mfma_f32_16x16x32_bf16 v[92:95], a[12:15], a[124:127], v[92:95]
    s_sub_u32 s61, s61, s90
    ds_read_b128 a[8:11], v6 offset:2048
    v_mfma_f32_16x16x32_bf16 v[144:147], a[16:19], a[112:115], v[144:147]
    ds_read_b128 a[12:15], v7 offset:2048
    v_mfma_f32_16x16x32_bf16 v[144:147], a[20:23], a[116:119], v[144:147]
    ds_read_b64_tr_b16 a[100:101], v12 offset:16384
    v_mfma_f32_16x16x32_bf16 v[152:155], a[16:19], a[120:123], v[152:155]
    v_mfma_f32_16x16x32_bf16 v[152:155], a[20:23], a[124:127], v[152:155]
    ds_read_b128 a[16:19], v6 offset:4096
    v_mfma_f32_16x16x32_bf16 v[148:151], a[24:27], a[112:115], v[148:151]
    buffer_load_dwordx4 v17, s[40:43], s50 offen offset:1024 sc1 lds
    v_mfma_f32_16x16x32_bf16 v[148:151], a[28:31], a[116:119], v[148:151]
    s_add_u32 s50, s50, 128
    ds_read_b128 a[20:23], v7 offset:4096
    v_mfma_f32_16x16x32_bf16 v[156:159], a[24:27], a[120:123], v[156:159]
    ds_read_b64_tr_b16 a[102:103], v12 offset:18432
    v_mfma_f32_16x16x32_bf16 v[156:159], a[28:31], a[124:127], v[156:159]
    ds_read_b128 a[24:27], v6 offset:6144
    v_mfma_f32_16x16x32_bf16 v[208:211], a[32:35], a[112:115], v[208:211]
    s_sub_u32 s65, s65, 1
    ds_read_b128 a[28:31], v7 offset:6144
    v_mfma_f32_16x16x32_bf16 v[208:211], a[36:39], a[116:119], v[208:211]
    ds_read_b64_tr_b16 a[104:105], v13 offset:0
    v_mfma_f32_16x16x32_bf16 v[216:219], a[32:35], a[120:123], v[216:219]
    v_mfma_f32_16x16x32_bf16 v[216:219], a[36:39], a[124:127], v[216:219]
    ds_read_b128 a[32:35], v6 offset:8192
    v_mfma_f32_16x16x32_bf16 v[212:215], a[40:43], a[112:115], v[212:215]
    buffer_load_dwordx4 v16, s[40:43], s51 offen offset:2048 sc1 lds
    v_mfma_f32_16x16x32_bf16 v[212:215], a[44:47], a[116:119], v[212:215]
    ds_read_b128 a[36:39], v7 offset:8192
    v_mfma_f32_16x16x32_bf16 v[220:223], a[40:43], a[120:123], v[220:223]
    ds_read_b64_tr_b16 a[106:107], v13 offset:2048
    v_mfma_f32_16x16x32_bf16 v[220:223], a[44:47], a[124:127], v[220:223]
    ds_read_b128 a[40:43], v6 offset:10240
    v_mfma_f32_16x16x32_bf16 a[240:243], a[48:51], a[112:115], a[240:243]
    ds_read_b128 a[44:47], v7 offset:10240
    v_mfma_f32_16x16x32_bf16 a[240:243], a[52:55], a[116:119], a[240:243]
    ds_read_b64_tr_b16 a[108:109], v13 offset:16384
    v_mfma_f32_16x16x32_bf16 a[248:251], a[48:51], a[120:123], a[248:251]
    v_mfma_f32_16x16x32_bf16 a[248:251], a[52:55], a[124:127], a[248:251]
    ds_read_b128 a[48:51], v6 offset:12288
    v_mfma_f32_16x16x32_bf16 a[244:247], a[56:59], a[112:115], a[244:247]
    buffer_load_dwordx4 v17, s[40:43], s51 offen offset:3072 sc1 lds
    v_mfma_f32_16x16x32_bf16 a[244:247], a[60:63], a[116:119], a[244:247]
    s_add_u32 s51, s51, 128
    ds_read_b128 a[52:55], v7 offset:12288
    v_mfma_f32_16x16x32_bf16 a[252:255], a[56:59], a[120:123], a[252:255]
    s_cmp_gt_u32 s65, s67
    ds_read_b64_tr_b16 a[110:111], v13 offset:18432
    v_mfma_f32_16x16x32_bf16 a[252:255], a[60:63], a[124:127], a[252:255]
    ds_read_b128 a[56:59], v6 offset:14336
    ds_read_b128 a[60:63], v7 offset:14336
    s_cbranch_scc1 m_loop20
    s_cmp_lg_u32 s65, 0
    s_cbranch_scc1 m_dosw21
m_epi12:
    s_cmp_eq_u32 s94, 0
    s_cbranch_scc1 m_last24
    s_mov_b32 s3, 1048576
m_spin28:
    v_readfirstlane_b32 s4, v4
    v_readfirstlane_b32 s5, v5
    s_nop 3
    s_cmp_lg_u32 s4, 0
    s_cbranch_scc1 m_ok29
    s_sub_u32 s3, s3, 1
    s_cbranch_scc1 m_ok29
    s_sleep 32
    buffer_load_dwordx2 v[4:5], off, s[12:15], 0 sc1
    s_waitcnt vmcnt(0)
    s_branch m_spin28
m_ok29:
    s_cmp_ge_u32 s68, 16
    s_cbranch_scc1 m_q031
    s_call_b64 s[20:21], m_epf22
    s_mov_b32 s17, s101
    s_mov_b32 s66, 2
    s_branch m_q130
m_q031:
    s_call_b64 s[20:21], m_eps23
    s_mov_b32 s17, s101
    s_add_u32 s28, s98, s99
    s_mov_b32 s29, s28
    s_mov_b32 s30, s99
    s_mov_b32 s31, s100
    s_mov_b32 s26, 268435456
m_q130:
    s_mov_b32 s95, s82
    s_mov_b32 s96, s83
    s_mov_b32 s97, s84
    s_mov_b32 s98, s85
    s_mov_b32 s99, s86
    s_mov_b32 s100, s87
    s_mov_b32 s101, s88
    s_sub_u32 s67, s95, 5
    s_max_u32 s67, s67, 4
    s_mov_b32 s94, 0
    s_branch m_tile11
m_last24:
    s_cmp_eq_u32 s70, 0
    s_cbranch_scc1 m_kvl27
    buffer_load_dwordx2 v[4:5], off, s[12:15], 0 sc1
    s_call_b64 s[20:21], m_epf22
    s_waitcnt vmcnt(0)
    s_barrier
    s_mov_b32 s3, 1048576
m_spin32:
    v_readfirstlane_b32 s4, v4
    v_readfirstlane_b32 s5, v5
    s_nop 3
    s_cmp_lg_u32 s4, 0
    s_cbranch_scc1 m_ok33
    s_sub_u32 s3, s3, 1
    s_cbranch_scc1 m_ok33
    s_sleep 32
    buffer_load_dwordx2 v[4:5], off, s[12:15], 0 sc1
    s_waitcnt vmcnt(0)
    s_branch m_spin32
m_ok33:
    s_cmp_lg_u32 s16, 0
    s_cbranch_scc1 m_np34
    v_mov_b32 v4, s4
    v_mov_b32 v5, s5
    s_add_u32 s90, s101, 117440512
    s_mov_b64 exec, 1
    buffer_store_dwordx2 v[4:5], off, s[8:11], s90 sc1
    s_mov_b64 exec, -1
m_np34:
    s_cmp_lg_u32 s16, 0
    s_cbranch_scc1 m_pw35
    s_and_b32 s92, s2, 7
    s_lshl_b32 s92, s92, 2
    s_bfe_u32 s93, s2, 0x20003
    s_add_u32 s92, s92, s93
    s_lshr_b32 s93, s2, 5
    s_lshl_b32 s93, s93, 2
    s_or_b32 s93, s93, 0x40000
    s_lshr_b32 s90, s92, 1
    s_lshl_b32 s90, s90, 7
    s_add_u32 s90, s90, 117440512
    s_bfe_u32 s91, 873473623, s93
    s_lshr_b32 s91, s91, 1
    v_mov_b32 v0, s91
    v_add_u32 v4, 8, v1
    v_cmp_gt_u32 vcc, 8, v1
    s_nop 1
    v_cndmask_b32 v0, v0, v4, vcc
    s_bfe_u32 s91, 4225681832, s93
    s_lshr_b32 s91, s91, 1
    v_writelane_b32 v0, s91, 8
    v_lshlrev_b32 v0, 3, v0
    buffer_load_dwordx2 v[4:5], v0, s[8:11], s90 offen sc1
    s_waitcnt vmcnt(0)
    s_mov_b32 s3, 1048576
m_spin36:
    v_cmp_ne_u64 s[22:23], s[4:5], v[4:5]
    s_nop 3
    s_cmp_eq_u64 s[22:23], 0
    s_cbranch_scc1 m_ok37
    s_sub_u32 s3, s3, 1
    s_cbranch_scc1 m_ok37
    s_sleep 16
    s_and_b32 s92, s2, 7
    s_lshl_b32 s92, s92, 2
    s_bfe_u32 s93, s2, 0x20003
    s_add_u32 s92, s92, s93
    s_lshr_b32 s93, s2, 5
    s_lshl_b32 s93, s93, 2
    s_or_b32 s93, s93, 0x40000
    s_lshr_b32 s90, s92, 1
    s_lshl_b32 s90, s90, 7
    s_add_u32 s90, s90, 117440512
    s_bfe_u32 s91, 873473623, s93
    s_lshr_b32 s91, s91, 1
    v_mov_b32 v0, s91
    v_add_u32 v4, 8, v1
    v_cmp_gt_u32 vcc, 8, v1
    s_nop 1
    v_cndmask_b32 v0, v0, v4, vcc
    s_bfe_u32 s91, 4225681832, s93
    s_lshr_b32 s91, s91, 1
    v_writelane_b32 v0, s91, 8
    v_lshlrev_b32 v0, 3, v0
    buffer_load_dwordx2 v[4:5], v0, s[8:11], s90 offen sc1
    s_waitcnt vmcnt(0)
    s_branch m_spin36
m_ok37:
m_pw35:
    s_barrier
    s_and_b32 s92, s2, 7
    s_lshl_b32 s92, s92, 2
    s_bfe_u32 s93, s2, 0x20003
    s_add_u32 s92, s92, s93
    s_lshr_b32 s93, s2, 5
    s_lshl_b32 s93, s93, 2
    s_or_b32 s93, s93, 0x40000
    s_bfe_u32 s90, 4225681832, s93
    s_lshl_b32 s90, s90, 3
    s_lshl_b32 s91, s16, 1
    s_add_u32 s90, s90, s91
    s_lshl_b32 s90, s90, 12
    s_lshl_b32 s91, s92, 19
    s_add_u32 s90, s90, s91
    s_add_u32 s90, s90, 0
    buffer_load_dwordx4 a[128:131], v2, s[8:11], s90 offen offset:0 sc1
    buffer_load_dwordx4 a[132:135], v2, s[8:11], s90 offen offset:1024 sc1
    buffer_load_dwordx4 a[136:139], v2, s[8:11], s90 offen offset:2048 sc1
    buffer_load_dwordx4 a[140:143], v2, s[8:11], s90 offen offset:3072 sc1
    s_bfe_u32 s90, 4225681832, s93
    s_lshl_b32 s90, s90, 3
    s_lshl_b32 s91, s16, 1
    s_add_u32 s90, s90, s91
    s_lshl_b32 s90, s90, 12
    s_lshl_b32 s91, s92, 19
    s_add_u32 s90, s90, s91
    s_add_u32 s90, s90, 4096
    buffer_load_dwordx4 a[144:147], v2, s[8:11], s90 offen offset:0 sc1
    buffer_load_dwordx4 a[148:151], v2, s[8:11], s90 offen offset:1024 sc1
    buffer_load_dwordx4 a[152:155], v2, s[8:11], s90 offen offset:2048 sc1
    buffer_load_dwordx4 a[156:159], v2, s[8:11], s90 offen offset:3072 sc1
    s_bfe_u32 s90, 873473623, s93
    s_lshl_b32 s90, s90, 3
    s_lshl_b32 s91, s16, 1
    s_add_u32 s90, s90, s91
    s_lshl_b32 s90, s90, 12
    s_lshl_b32 s91, s92, 19
    s_add_u32 s90, s90, s91
    s_add_u32 s90, s90, 0
    buffer_load_dwordx4 a[160:163], v2, s[8:11], s90 offen offset:0 sc1
    buffer_load_dwordx4 a[164:167], v2, s[8:11], s90 offen offset:1024 sc1
    buffer_load_dwordx4 a[168:171], v2, s[8:11], s90 offen offset:2048 sc1
    buffer_load_dwordx4 a[172:175], v2, s[8:11], s90 offen offset:3072 sc1
    s_bfe_u32 s90, 873473623, s93
    s_lshl_b32 s90, s90, 3
    s_lshl_b32 s91, s16, 1
    s_add_u32 s90, s90, s91
    s_lshl_b32 s90, s90, 12
    s_lshl_b32 s91, s92, 19
    s_add_u32 s90, s90, s91
    s_add_u32 s90, s90, 4096
    buffer_load_dwordx4 a[176:179], v2, s[8:11], s90 offen offset:0 sc1
    buffer_load_dwordx4 a[180:183], v2, s[8:11], s90 offen offset:1024 sc1
    buffer_load_dwordx4 a[184:187], v2, s[8:11], s90 offen offset:2048 sc1
    buffer_load_dwordx4 a[188:191], v2, s[8:11], s90 offen offset:3072 sc1
    s_mov_b32 s94, 1
m_kvl27:
    s_waitcnt lgkmcnt(0)
    s_and_b32 s92, s2, 7
    s_lshl_b32 s92, s92, 2
    s_bfe_u32 s93, s2, 0x20003
    s_add_u32 s92, s92, s93
    s_lshr_b32 s93, s2, 5
    s_lshl_b32 s93, s93, 2
    s_or_b32 s93, s93, 0x40000
    s_mov_b32 s32, s92
    s_bfe_u32 s33, 4225681832, s93
    s_add_u32 s33, s33, 1
    s_bfe_u32 s34, 873473623, s93
    s_add_u32 s34, s34, 1
    s_lshl_b32 s60, s16, 12
    v_add_u32 v7, s60, v2
    s_lshl_b32 s90, s34, 2
    s_lshl_b32 s91, s33, 2
    s_lshl_b32 s26, s91, 13
    s_mov_b32 s30, s26
    s_sub_u32 s67, s90, 4
    s_add_u32 s67, s67, s16
    s_add_u32 s68, s67, 1
    s_mov_b32 s69, s90
    s_sub_u32 s70, s91, 4
    s_add_u32 s70, s70, s16
    s_add_u32 s71, s70, 1
    s_mov_b32 s72, s91
    s_mov_b32 s27, 0x20000
    s_mov_b32 s31, 0x20000
    s_lshl_b32 s82, s32, 19
    s_add_u32 s90, s82, 16777216
    s_add_u32 s24, s6, s90
    s_addc_u32 s25, s7, 0
    s_add_u32 s90, s82, 33554432
    s_add_u32 s28, s6, s90
    s_addc_u32 s29, s7, 0
    s_cmp_eq_u32 s94, 1
    s_cbranch_scc1 m_w068
    s_call_b64 s[20:21], m_epl66
    s_mov_b32 s17, s101
    s_mov_b32 s38, 268435456
    s_branch m_init26
m_w068:
    s_mov_b32 s56, 0
    s_mov_b32 s57, 0
    s_mov_b32 m0, s60
    s_nop 0
    buffer_load_dwordx4 v7, s[24:27], s56 offen offset:0 sc1 lds
    buffer_load_dwordx4 v7, s[24:27], s56 offen offset:1024 sc1 lds
    buffer_load_dwordx4 v7, s[24:27], s56 offen offset:2048 sc1 lds
    buffer_load_dwordx4 v7, s[24:27], s56 offen offset:3072 sc1 lds
    s_mov_b32 s56, 16384
    s_add_u32 s59, s60, 32768
    s_mov_b32 m0, s59
    s_nop 0
    buffer_load_dwordx4 v7, s[24:27], s56 offen offset:0 sc1 lds
    buffer_load_dwordx4 v7, s[24:27], s56 offen offset:1024 sc1 lds
    buffer_load_dwordx4 v7, s[24:27], s56 offen offset:2048 sc1 lds
    buffer_load_dwordx4 v7, s[24:27], s56 offen offset:3072 sc1 lds
    s_add_u32 s56, s56, 16384
    s_add_u32 m0, s59, 16384
    s_nop 0
    buffer_load_dwordx4 v7, s[28:31], s57 offen offset:0 sc1 lds
    buffer_load_dwordx4 v7, s[28:31], s57 offen offset:1024 sc1 lds
    buffer_load_dwordx4 v7, s[28:31], s57 offen offset:2048 sc1 lds
    buffer_load_dwordx4 v7, s[28:31], s57 offen offset:3072 sc1 lds
    s_add_u32 s57, s57, 16384
    s_add_u32 s59, s59, 32768
    s_mov_b32 m0, s59
    s_nop 0
    buffer_load_dwordx4 v7, s[24:27], s56 offen offset:0 sc1 lds
    buffer_load_dwordx4 v7, s[24:27], s56 offen offset:1024 sc1 lds
    buffer_load_dwordx4 v7, s[24:27], s56 offen offset:2048 sc1 lds
    buffer_load_dwordx4 v7, s[24:27], s56 offen offset:3072 sc1 lds
    s_add_u32 s56, s56, 16384
    s_add_u32 m0, s59, 16384
    s_nop 0
    buffer_load_dwordx4 v7, s[28:31], s57 offen offset:0 sc1 lds
    buffer_load_dwordx4 v7, s[28:31], s57 offen offset:1024 sc1 lds
    buffer_load_dwordx4 v7, s[28:31], s57 offen offset:2048 sc1 lds
    buffer_load_dwordx4 v7, s[28:31], s57 offen offset:3072 sc1 lds
    s_add_u32 s57, s57, 16384
    s_add_u32 s59, s59, 32768
    s_mov_b32 m0, s59
    s_nop 0
    buffer_load_dwordx4 v7, s[24:27], s56 offen offset:0 sc1 lds
    buffer_load_dwordx4 v7, s[24:27], s56 offen offset:1024 sc1 lds
    buffer_load_dwordx4 v7, s[24:27], s56 offen offset:2048 sc1 lds
    buffer_load_dwordx4 v7, s[24:27], s56 offen offset:3072 sc1 lds
    s_add_u32 s56, s56, 16384
    s_add_u32 m0, s59, 16384
    s_nop 0
    buffer_load_dwordx4 v7, s[28:31], s57 offen offset:0 sc1 lds
    buffer_load_dwordx4 v7, s[28:31], s57 offen offset:1024 sc1 lds
    buffer_load_dwordx4 v7, s[28:31], s57 offen offset:2048 sc1 lds
    buffer_load_dwordx4 v7, s[28:31], s57 offen offset:3072 sc1 lds
    s_add_u32 s57, s57, 16384
    s_add_u32 s59, s59, 32768
    s_mov_b32 m0, s59
    s_nop 0
    buffer_load_dwordx4 v7, s[24:27], s56 offen offset:0 sc1 lds
    buffer_load_dwordx4 v7, s[24:27], s56 offen offset:1024 sc1 lds
    buffer_load_dwordx4 v7, s[24:27], s56 offen offset:2048 sc1 lds
    buffer_load_dwordx4 v7, s[24:27], s56 offen offset:3072 sc1 lds
    s_add_u32 s56, s56, 16384
    s_add_u32 m0, s59, 16384
    s_nop 0
    buffer_load_dwordx4 v7, s[28:31], s57 offen offset:0 sc1 lds
    buffer_load_dwordx4 v7, s[28:31], s57 offen offset:1024 sc1 lds
    buffer_load_dwordx4 v7, s[28:31], s57 offen offset:2048 sc1 lds
    buffer_load_dwordx4 v7, s[28:31], s57 offen offset:3072 sc1 lds
    s_add_u32 s57, s57, 16384
    s_add_u32 s59, s59, 32768
    s_waitcnt vmcnt(0)
    s_mov_b32 s38, 0
m_init26:
    s_mov_b32 s56, 81920
    s_mov_b32 s57, 65536
    s_nop 1
    v_mov_b32 v9, 0xff800000
    s_mov_b32 s65, 1233125376
    s_lshl_b32 s91, s16, 1
    s_sub_u32 s91, s91, 8
    s_lshl_b32 s78, s33, 3
    s_add_u32 s78, s78, s91
    s_lshl_b32 s79, s34, 3
    s_add_u32 s79, s79, s91
    s_mov_b32 s36, s6
    s_mov_b32 s37, s7
    s_mov_b32 s39, 0x20000
    s_load_dwordx2 s[48:49], s[0:1], 64
    s_load_dwordx2 s[50:51], s[0:1], 16
    s_load_dwordx2 s[54:55], s[0:1], 72
    s_mov_b32 s47, 0x20000
    s_lshl_b32 s90, s99, 1
    s_add_u32 s98, s98, s90
    s_lshl_b32 s90, s100, 2
    s_add_u32 s40, s98, s90
    s_lshr_b32 s90, s32, 1
    s_lshl_b32 s90, s90, 7
    s_add_u32 s90, s90, 117444608
    s_lshr_b32 s91, s2, 6
    s_lshl_b32 s91, s91, 8
    s_add_u32 s91, s91, 117446592
    v_min_u32 v10, 31, v1
    v_lshlrev_b32 v10, 3, v10
    v_mov_b32 v11, s90
    v_mov_b32 v8, s91
    v_cmp_gt_u32 vcc, 8, v1
    s_nop 1
    v_cndmask_b32 v11, v8, v11, vcc
    v_add_u32 v10, v10, v11
    s_mov_b32 s58, 0
    v_mov_b32 v6, v2
    v_accvgpr_write_b32 a0, 0
    v_accvgpr_write_b32 a1, 0
    v_accvgpr_write_b32 a2, 0
    v_accvgpr_write_b32 a3, 0
    v_accvgpr_write_b32 a4, 0
    v_accvgpr_write_b32 a5, 0
    v_accvgpr_write_b32 a6, 0
    v_accvgpr_write_b32 a7, 0
    v_accvgpr_write_b32 a8, 0
    v_accvgpr_write_b32 a9, 0
    v_accvgpr_write_b32 a10, 0
    v_accvgpr_write_b32 a11, 0
    v_accvgpr_write_b32 a12, 0
    v_accvgpr_write_b32 a13, 0
    v_accvgpr_write_b32 a14, 0
    v_accvgpr_write_b32 a15, 0
    v_accvgpr_write_b32 a16, 0
    v_accvgpr_write_b32 a17, 0
    v_accvgpr_write_b32 a18, 0
    v_accvgpr_write_b32 a19, 0
    v_accvgpr_write_b32 a20, 0
    v_accvgpr_write_b32 a21, 0
    v_accvgpr_write_b32 a22, 0
    v_accvgpr_write_b32 a23, 0
    v_accvgpr_write_b32 a24, 0
    v_accvgpr_write_b32 a25, 0
    v_accvgpr_write_b32 a26, 0
    v_accvgpr_write_b32 a27, 0
    v_accvgpr_write_b32 a28, 0
    v_accvgpr_write_b32 a29, 0
    v_accvgpr_write_b32 a30, 0
    v_accvgpr_write_b32 a31, 0
    v_accvgpr_write_b32 a32, 0
    v_accvgpr_write_b32 a33, 0
    v_accvgpr_write_b32 a34, 0
    v_accvgpr_write_b32 a35, 0
    v_accvgpr_write_b32 a36, 0
    v_accvgpr_write_b32 a37, 0
    v_accvgpr_write_b32 a38, 0
    v_accvgpr_write_b32 a39, 0
    v_accvgpr_write_b32 a40, 0
    v_accvgpr_write_b32 a41, 0
    v_accvgpr_write_b32 a42, 0
    v_accvgpr_write_b32 a43, 0
    v_accvgpr_write_b32 a44, 0
    v_accvgpr_write_b32 a45, 0
    v_accvgpr_write_b32 a46, 0
    v_accvgpr_write_b32 a47, 0
    v_accvgpr_write_b32 a48, 0
    v_accvgpr_write_b32 a49, 0
    v_accvgpr_write_b32 a50, 0
    v_accvgpr_write_b32 a51, 0
    v_accvgpr_write_b32 a52, 0
    v_accvgpr_write_b32 a53, 0
    v_accvgpr_write_b32 a54, 0
    v_accvgpr_write_b32 a55, 0
    v_accvgpr_write_b32 a56, 0
    v_accvgpr_write_b32 a57, 0
    v_accvgpr_write_b32 a58, 0
    v_accvgpr_write_b32 a59, 0
    v_accvgpr_write_b32 a60, 0
    v_accvgpr_write_b32 a61, 0
    v_accvgpr_write_b32 a62, 0
    v_accvgpr_write_b32 a63, 0
    v_accvgpr_write_b32 a64, 0
    v_accvgpr_write_b32 a65, 0
    v_accvgpr_write_b32 a66, 0
    v_accvgpr_write_b32 a67, 0
    v_accvgpr_write_b32 a68, 0
    v_accvgpr_write_b32 a69, 0
    v_accvgpr_write_b32 a70, 0
    v_accvgpr_write_b32 a71, 0
    v_accvgpr_write_b32 a72, 0
    v_accvgpr_write_b32 a73, 0
    v_accvgpr_write_b32 a74, 0
    v_accvgpr_write_b32 a75, 0
    v_accvgpr_write_b32 a76, 0
    v_accvgpr_write_b32 a77, 0
    v_accvgpr_write_b32 a78, 0
    v_accvgpr_write_b32 a79, 0
    v_mov_b64 v[160:161], 0
    v_mov_b64 v[162:163], 0
    v_mov_b64 v[164:165], 0
    v_mov_b64 v[166:167], 0
    v_mov_b64 v[168:169], 0
    v_mov_b64 v[170:171], 0
    v_mov_b64 v[172:173], 0
    v_mov_b64 v[174:175], 0
    v_mov_b64 v[176:177], 0
    v_mov_b64 v[178:179], 0
    v_mov_b64 v[180:181], 0
    v_mov_b64 v[182:183], 0
    v_mov_b64 v[184:185], 0
    v_mov_b64 v[186:187], 0
    v_mov_b64 v[188:189], 0
    v_mov_b64 v[190:191], 0
    v_mov_b32 v12, 0
    v_mov_b32 v28, 0
    v_mov_b32 v44, 0x3f803f80
    v_mov_b32 v13, 0
    v_mov_b32 v32, 0
    v_mov_b32 v45, 0x3f803f80
    v_mov_b32 v14, 0
    v_mov_b32 v36, 0
    v_mov_b32 v46, 0x3f803f80
    v_mov_b32 v15, 0
    v_mov_b32 v40, 0
    v_mov_b32 v47, 0x3f803f80
    s_and_b32 s90, s2, 7
    s_lshl_b32 s90, s90, 4
    s_lshl_b32 s91, s16, 2
    s_add_u32 s80, s90, s91
    s_lshr_b32 s92, s2, 3
    s_lshl_b32 s92, s92, 17
    s_lshl_b32 s90, s80, 10
    s_add_u32 s90, s90, s92
    s_add_u32 s83, s90, 50331648
    s_add_u32 s84, s90, 54525952
    s_and_b32 s81, s80, 63
    s_cmp_eq_u32 s81, 0
    s_cselect_b32 s93, 0, 1024
    s_sub_u32 s85, s84, s93
    s_lshl_b32 s90, s80, 9
    s_add_u32 s90, s90, s92
    s_add_u32 s86, s90, 58720256
    s_sub_u32 s87, s86, s93
    s_add_u32 s88, s86, 65536
    s_add_u32 s89, s87, 65536
    v_and_b32 v48, 15, v1
    v_lshrrev_b32 v49, 4, v1
    v_lshlrev_b32 v49, 2, v49
    v_sub_u32 v48, v48, v49
    v_cmp_le_i32 vcc, 0, v48
    s_nop 1
    v_cndmask_b32 v16, v9, 0, vcc
    v_cmp_le_i32 vcc, 1, v48
    s_nop 1
    v_cndmask_b32 v17, v9, 0, vcc
    v_cmp_le_i32 vcc, 2, v48
    s_nop 1
    v_cndmask_b32 v18, v9, 0, vcc
    v_cmp_le_i32 vcc, 3, v48
    s_nop 1
    v_cndmask_b32 v19, v9, 0, vcc
    s_mov_b32 s62, 8945792
    s_mov_b32 s63, 0
    s_sub_u32 s90, s67, 1
    s_bitset1_b64 s[62:63], s90
    s_sub_u32 s90, s68, 1
    s_bitset1_b64 s[62:63], s90
    s_sub_u32 s90, s69, 1
    s_bitset1_b64 s[62:63], s90
    s_sub_u32 s90, s70, 1
    s_bitset1_b64 s[62:63], s90
    s_sub_u32 s90, s71, 1
    s_bitset1_b64 s[62:63], s90
    s_sub_u32 s90, s72, 1
    s_bitset1_b64 s[62:63], s90
    s_add_u32 s53, s69, 8
    s_sub_u32 s90, s53, 1
    s_bitset1_b64 s[62:63], s90
    s_mov_b32 s64, 0
    s_cmp_lg_u32 s64, s67
    s_cbranch_scc1 m_e73
    v_add_f32 v176, v176, v16
    v_mov_b32 v180, v9
    v_add_f32 v188, v188, v16
    v_add_f32 v177, v177, v17
    v_mov_b32 v181, v9
    v_add_f32 v189, v189, v17
    v_add_f32 v178, v178, v18
    v_mov_b32 v182, v9
    v_add_f32 v190, v190, v18
    v_add_f32 v179, v179, v19
    v_mov_b32 v183, v9
    v_add_f32 v191, v191, v19
    s_nop 0
m_e73:
    s_waitcnt vmcnt(32) lgkmcnt(0)
    s_barrier
    ds_read_b128 a[192:195], v6 offset:0
    ds_read_b128 a[196:199], v6 offset:1024
    ds_read_b128 a[200:203], v6 offset:2048
    ds_read_b128 a[204:207], v6 offset:3072
    ds_read_b128 a[208:211], v6 offset:4096
    ds_read_b128 a[212:215], v6 offset:5120
    ds_read_b128 a[216:219], v6 offset:6144
    ds_read_b128 a[220:223], v6 offset:7168
    s_waitcnt lgkmcnt(0)
    v_mfma_f32_16x16x32_bf16 v[64:67], a[192:195], a[128:131], v[160:163]
    v_accvgpr_write_b32 a80, 0
    v_accvgpr_write_b32 a81, 0
    v_mfma_f32_16x16x32_bf16 v[64:67], a[196:199], a[132:135], v[64:67]
    buffer_store_dwordx4 v[192:195], v2, s[36:39], s40 offen sc1
    s_add_u32 s40, s40, s100
    v_mfma_f32_16x16x32_bf16 v[64:67], a[200:203], a[136:139], v[64:67]
    v_accvgpr_write_b32 a82, 0
    v_accvgpr_write_b32 a83, 0
    v_mfma_f32_16x16x32_bf16 v[64:67], a[204:207], a[140:143], v[64:67]
    v_accvgpr_write_b32 a84, 0
    v_accvgpr_write_b32 a85, 0
    v_mfma_f32_16x16x32_bf16 v[72:75], a[192:195], a[144:147], v[168:171]
    v_accvgpr_write_b32 a86, 0
    v_accvgpr_write_b32 a87, 0
    v_mfma_f32_16x16x32_bf16 v[72:75], a[196:199], a[148:151], v[72:75]
    buffer_store_dwordx4 v[196:199], v2, s[36:39], s40 offen sc1
    s_add_u32 s40, s40, s100
    v_mfma_f32_16x16x32_bf16 v[72:75], a[200:203], a[152:155], v[72:75]
    v_accvgpr_write_b32 a88, 0
    v_accvgpr_write_b32 a89, 0
    v_mfma_f32_16x16x32_bf16 v[72:75], a[204:207], a[156:159], v[72:75]
    v_accvgpr_write_b32 a90, 0
    v_accvgpr_write_b32 a91, 0
    v_mfma_f32_16x16x32_bf16 v[80:83], a[192:195], a[160:163], v[176:179]
    v_accvgpr_write_b32 a92, 0
    v_accvgpr_write_b32 a93, 0
    v_mfma_f32_16x16x32_bf16 v[80:83], a[196:199], a[164:167], v[80:83]
    buffer_store_dwordx4 v[200:203], v2, s[36:39], s40 offen sc1
    s_add_u32 s40, s40, s100
    v_mfma_f32_16x16x32_bf16 v[80:83], a[200:203], a[168:171], v[80:83]
    v_accvgpr_write_b32 a94, 0
    v_accvgpr_write_b32 a95, 0
    v_mfma_f32_16x16x32_bf16 v[80:83], a[204:207], a[172:175], v[80:83]
    v_accvgpr_write_b32 a96, 0
    v_accvgpr_write_b32 a97, 0
    v_mfma_f32_16x16x32_bf16 v[88:91], a[192:195], a[176:179], v[184:187]
    v_accvgpr_write_b32 a98, 0
    v_accvgpr_write_b32 a99, 0
    v_mfma_f32_16x16x32_bf16 v[88:91], a[196:199], a[180:183], v[88:91]
    buffer_store_dwordx4 v[204:207], v2, s[36:39], s40 offen sc1
    s_add_u32 s40, s98, s99
    v_mfma_f32_16x16x32_bf16 v[88:91], a[200:203], a[184:187], v[88:91]
    v_accvgpr_write_b32 a100, 0
    v_accvgpr_write_b32 a101, 0
    v_mfma_f32_16x16x32_bf16 v[88:91], a[204:207], a[188:191], v[88:91]
    v_accvgpr_write_b32 a102, 0
    v_accvgpr_write_b32 a103, 0
    v_mfma_f32_16x16x32_bf16 v[68:71], a[208:211], a[128:131], v[164:167]
    ds_read_b128 a[192:195], v6 offset:8192
    v_accvgpr_write_b32 a104, 0
    v_accvgpr_write_b32 a105, 0
    v_mfma_f32_16x16x32_bf16 v[68:71], a[212:215], a[132:135], v[68:71]
    buffer_store_dwordx4 v[208:211], v2, s[36:39], s40 offen sc1
    s_add_u32 s40, s40, s100
    ds_read_b128 a[196:199], v6 offset:9216
    v_mfma_f32_16x16x32_bf16 v[68:71], a[216:219], a[136:139], v[68:71]
    ds_read_b128 a[200:203], v6 offset:10240
    v_accvgpr_write_b32 a106, 0
    v_accvgpr_write_b32 a107, 0
    v_mfma_f32_16x16x32_bf16 v[68:71], a[220:223], a[140:143], v[68:71]
    ds_read_b128 a[204:207], v6 offset:11264
    v_accvgpr_write_b32 a108, 0
    v_accvgpr_write_b32 a109, 0
    v_mfma_f32_16x16x32_bf16 v[76:79], a[208:211], a[144:147], v[172:175]
    v_accvgpr_write_b32 a110, 0
    v_accvgpr_write_b32 a111, 0
    v_mfma_f32_16x16x32_bf16 v[76:79], a[212:215], a[148:151], v[76:79]
    buffer_store_dwordx4 v[212:215], v2, s[36:39], s40 offen sc1
    s_add_u32 s40, s40, s100
    v_mfma_f32_16x16x32_bf16 v[76:79], a[216:219], a[152:155], v[76:79]
    v_accvgpr_write_b32 a112, 0
    v_accvgpr_write_b32 a113, 0
    v_mfma_f32_16x16x32_bf16 v[76:79], a[220:223], a[156:159], v[76:79]
    v_accvgpr_write_b32 a114, 0
    v_accvgpr_write_b32 a115, 0
    v_mfma_f32_16x16x32_bf16 v[84:87], a[208:211], a[160:163], v[180:183]
    v_accvgpr_write_b32 a116, 0
    v_accvgpr_write_b32 a117, 0
    v_mfma_f32_16x16x32_bf16 v[84:87], a[212:215], a[164:167], v[84:87]
    buffer_store_dwordx4 v[216:219], v2, s[36:39], s40 offen sc1
    s_add_u32 s40, s40, s100
    v_mfma_f32_16x16x32_bf16 v[84:87], a[216:219], a[168:171], v[84:87]
    v_accvgpr_write_b32 a118, 0
    v_accvgpr_write_b32 a119, 0
    v_mfma_f32_16x16x32_bf16 v[84:87], a[220:223], a[172:175], v[84:87]
    v_accvgpr_write_b32 a120, 0
    v_accvgpr_write_b32 a121, 0
    v_mfma_f32_16x16x32_bf16 v[92:95], a[208:211], a[176:179], v[188:191]
    v_accvgpr_write_b32 a122, 0
    v_accvgpr_write_b32 a123, 0
    v_mfma_f32_16x16x32_bf16 v[92:95], a[212:215], a[180:183], v[92:95]
    buffer_store_dwordx4 v[220:223], v2, s[36:39], s40 offen sc1
    s_add_u32 s40, s40, s100
    v_mfma_f32_16x16x32_bf16 v[92:95], a[216:219], a[184:187], v[92:95]
    v_accvgpr_write_b32 a124, 0
    v_accvgpr_write_b32 a125, 0
    v_mfma_f32_16x16x32_bf16 v[92:95], a[220:223], a[188:191], v[92:95]
    v_accvgpr_write_b32 a126, 0
    v_accvgpr_write_b32 a127, 0
    ds_read_b128 a[208:211], v6 offset:12288
    ds_read_b128 a[212:215], v6 offset:13312
    ds_read_b128 a[216:219], v6 offset:14336
    ds_read_b128 a[220:223], v6 offset:15360
    s_mov_b32 s64, 1
    s_nop 0
    s_nop 3
    v_max3_f32 v48, v64, v65, v66
    v_max3_f32 v49, v72, v73, v74
    v_max3_f32 v50, v80, v81, v82
    v_max3_f32 v51, v88, v89, v90
    v_max3_f32 v48, v48, v67, v68
    v_max3_f32 v49, v49, v75, v76
    v_max3_f32 v50, v50, v83, v84
    v_max3_f32 v51, v51, v91, v92
    v_max3_f32 v48, v48, v69, v70
    v_max3_f32 v49, v49, v77, v78
    v_max3_f32 v50, v50, v85, v86
    v_max3_f32 v51, v51, v93, v94
    v_max_f32 v48, v48, v71
    v_max_f32 v49, v49, v79
    v_max_f32 v50, v50, v87
    v_max_f32 v51, v51, v95
    v_mov_b32 v52, v48
    v_mov_b32 v53, v49
    v_mov_b32 v54, v50
    v_mov_b32 v55, v51
    s_nop 1
    v_permlane32_swap_b32 v48, v52
    v_permlane32_swap_b32 v49, v53
    v_permlane32_swap_b32 v50, v54
    v_permlane32_swap_b32 v51, v55
    s_nop 1
    v_max_f32 v48, v48, v52
    v_max_f32 v49, v49, v53
    v_max_f32 v50, v50, v54
    v_max_f32 v51, v51, v55
    v_mov_b32 v52, v48
    v_mov_b32 v53, v49
    v_mov_b32 v54, v50
    v_mov_b32 v55, v51
    s_nop 1
    v_permlane16_swap_b32 v48, v52
    v_permlane16_swap_b32 v49, v53
    v_permlane16_swap_b32 v50, v54
    v_permlane16_swap_b32 v51, v55
    s_nop 1
    v_max_f32 v48, v48, v52
    v_max_f32 v49, v49, v53
    v_max_f32 v50, v50, v54
    v_max_f32 v51, v51, v55
    v_sub_f32 v160, v160, v48
    v_sub_f32 v161, v161, v48
    v_sub_f32 v162, v162, v48
    v_sub_f32 v163, v163, v48
    v_sub_f32 v164, v164, v48
    v_sub_f32 v165, v165, v48
    v_sub_f32 v166, v166, v48
    v_sub_f32 v167, v167, v48
    v_sub_f32 v168, v168, v49
    v_sub_f32 v169, v169, v49
    v_sub_f32 v170, v170, v49
    v_sub_f32 v171, v171, v49
    v_sub_f32 v172, v172, v49
    v_sub_f32 v173, v173, v49
    v_sub_f32 v174, v174, v49
    v_sub_f32 v175, v175, v49
    v_sub_f32 v176, v176, v50
    v_sub_f32 v177, v177, v50
    v_sub_f32 v178, v178, v50
    v_sub_f32 v179, v179, v50
    v_sub_f32 v180, v180, v50
    v_sub_f32 v181, v181, v50
    v_sub_f32 v182, v182, v50
    v_sub_f32 v183, v183, v50
    v_sub_f32 v184, v184, v51
    v_sub_f32 v185, v185, v51
    v_sub_f32 v186, v186, v51
    v_sub_f32 v187, v187, v51
    v_sub_f32 v188, v188, v51
    v_sub_f32 v189, v189, v51
    v_sub_f32 v190, v190, v51
    v_sub_f32 v191, v191, v51
    v_sub_f32 v64, v64, v48
    v_sub_f32 v65, v65, v48
    v_sub_f32 v66, v66, v48
    v_sub_f32 v67, v67, v48
    v_sub_f32 v68, v68, v48
    v_sub_f32 v69, v69, v48
    v_sub_f32 v70, v70, v48
    v_sub_f32 v71, v71, v48
    v_sub_f32 v72, v72, v49
    v_sub_f32 v73, v73, v49
    v_sub_f32 v74, v74, v49
    v_sub_f32 v75, v75, v49
    v_sub_f32 v76, v76, v49
    v_sub_f32 v77, v77, v49
    v_sub_f32 v78, v78, v49
    v_sub_f32 v79, v79, v49
    v_sub_f32 v80, v80, v50
    v_sub_f32 v81, v81, v50
    v_sub_f32 v82, v82, v50
    v_sub_f32 v83, v83, v50
    v_sub_f32 v84, v84, v50
    v_sub_f32 v85, v85, v50
    v_sub_f32 v86, v86, v50
    v_sub_f32 v87, v87, v50
    v_sub_f32 v88, v88, v51
    v_sub_f32 v89, v89, v51
    v_sub_f32 v90, v90, v51
    v_sub_f32 v91, v91, v51
    v_sub_f32 v92, v92, v51
    v_sub_f32 v93, v93, v51
    v_sub_f32 v94, v94, v51
    v_sub_f32 v95, v95, v51
    s_cmp_lg_u32 s64, s67
    s_cbranch_scc1 m_e74
    v_add_f32 v176, v176, v16
    v_mov_b32 v180, v9
    v_add_f32 v188, v188, v16
    v_add_f32 v177, v177, v17
    v_mov_b32 v181, v9
    v_add_f32 v189, v189, v17
    v_add_f32 v178, v178, v18
    v_mov_b32 v182, v9
    v_add_f32 v190, v190, v18
    v_add_f32 v179, v179, v19
    v_mov_b32 v183, v9
    v_add_f32 v191, v191, v19
    s_nop 0
m_e74:
    s_cmp_lg_u32 s64, s68
    s_cbranch_scc1 m_e75
    v_mov_b32 v176, v9
    v_mov_b32 v184, v9
    v_mov_b32 v188, v9
    v_mov_b32 v177, v9
    v_mov_b32 v185, v9
    v_mov_b32 v189, v9
    v_mov_b32 v178, v9
    v_mov_b32 v186, v9
    v_mov_b32 v190, v9
    v_mov_b32 v179, v9
    v_mov_b32 v187, v9
    v_mov_b32 v191, v9
    s_nop 0
m_e75:
    s_waitcnt lgkmcnt(0)
    v_mfma_f32_16x16x32_bf16 v[96:99], a[192:195], a[128:131], v[160:163]
    s_bitcmp1_b64 s[62:63], s64
    s_cselect_b32 s66, -1.0, s65
    v_exp_f32 v20, v64
    v_mfma_f32_16x16x32_bf16 v[96:99], a[196:199], a[132:135], v[96:99]
    s_add_u32 s64, s64, 1
    v_exp_f32 v21, v65
    v_exp_f32 v22, v66
    v_mfma_f32_16x16x32_bf16 v[96:99], a[200:203], a[136:139], v[96:99]
    buffer_store_dwordx4 v[224:227], v2, s[36:39], s40 offen sc1
    v_cvt_pk_bf16_f32 v128, v20, v21
    v_mfma_f32_16x16x32_bf16 v[96:99], a[204:207], a[140:143], v[96:99]
    s_add_u32 s40, s40, s100
    v_add_f32 v12, v12, v28
    v_exp_f32 v23, v67
    v_mfma_f32_16x16x32_bf16 v[104:107], a[192:195], a[144:147], v[168:171]
    v_exp_f32 v24, v68
    v_cvt_pk_bf16_f32 v129, v22, v23
    v_mfma_f32_16x16x32_bf16 v[104:107], a[196:199], a[148:151], v[104:107]
    buffer_store_dwordx4 v[228:231], v2, s[36:39], s40 offen sc1
    v_exp_f32 v25, v69
    v_mfma_f32_16x16x32_bf16 v[104:107], a[200:203], a[152:155], v[104:107]
    s_add_u32 s40, s40, s100
    v_exp_f32 v26, v70
    v_cvt_pk_bf16_f32 v130, v24, v25
    v_mfma_f32_16x16x32_bf16 v[104:107], a[204:207], a[156:159], v[104:107]
    v_exp_f32 v27, v71
    v_add_f32 v13, v13, v32
    v_mfma_f32_16x16x32_bf16 v[112:115], a[192:195], a[160:163], v[176:179]
    v_exp_f32 v20, v72
    v_cvt_pk_bf16_f32 v131, v26, v27
    v_mfma_f32_16x16x32_bf16 v[112:115], a[196:199], a[164:167], v[112:115]
    buffer_store_dwordx4 v[232:235], v2, s[36:39], s40 offen sc1
    v_exp_f32 v21, v73
    v_mfma_f32_16x16x32_bf16 v[28:31], v[44:47], v[128:131], 0
    v_exp_f32 v22, v74
    v_cvt_pk_bf16_f32 v132, v20, v21
    v_mfma_f32_16x16x32_bf16 v[112:115], a[200:203], a[168:171], v[112:115]
    s_add_u32 s40, s40, s100
    v_exp_f32 v23, v75
    v_add_f32 v14, v14, v36
    v_mfma_f32_16x16x32_bf16 v[112:115], a[204:207], a[172:175], v[112:115]
    v_exp_f32 v24, v76
    v_cvt_pk_bf16_f32 v133, v22, v23
    v_mfma_f32_16x16x32_bf16 v[120:123], a[192:195], a[176:179], v[184:187]
    buffer_store_dwordx4 v[236:239], v2, s[36:39], s40 offen sc1
    v_exp_f32 v25, v77
    v_mfma_f32_16x16x32_bf16 v[120:123], a[196:199], a[180:183], v[120:123]
    s_mov_b32 s40, s98
    v_exp_f32 v26, v78
    v_cvt_pk_bf16_f32 v134, v24, v25
    v_mfma_f32_16x16x32_bf16 v[120:123], a[200:203], a[184:187], v[120:123]
    v_exp_f32 v27, v79
    v_add_f32 v15, v15, v40
    v_mfma_f32_16x16x32_bf16 v[120:123], a[204:207], a[188:191], v[120:123]
    s_waitcnt lgkmcnt(0)
    v_exp_f32 v20, v80
    v_cvt_pk_bf16_f32 v135, v26, v27
    v_mfma_f32_16x16x32_bf16 v[100:103], a[208:211], a[128:131], v[164:167]
    v_exp_f32 v21, v81
    v_exp_f32 v22, v82
    v_mfma_f32_16x16x32_bf16 v[32:35], v[44:47], v[132:135], 0
    v_cvt_pk_bf16_f32 v136, v20, v21
    v_exp_f32 v23, v83
    v_mfma_f32_16x16x32_bf16 v[100:103], a[212:215], a[132:135], v[100:103]
    buffer_store_dwordx4 v[240:243], v2, s[36:39], s40 offen sc1
    v_cvt_pk_bf16_f32 v137, v22, v23
    v_mfma_f32_16x16x32_bf16 v[100:103], a[216:219], a[136:139], v[100:103]
    s_add_u32 s40, s40, s100
    v_exp_f32 v24, v84
    v_mfma_f32_16x16x32_bf16 v[100:103], a[220:223], a[140:143], v[100:103]
    v_exp_f32 v25, v85
    v_exp_f32 v26, v86
    v_cvt_pk_bf16_f32 v138, v24, v25
    v_mfma_f32_16x16x32_bf16 v[108:111], a[208:211], a[144:147], v[172:175]
    buffer_store_dwordx4 v[244:247], v2, s[36:39], s40 offen sc1
    v_mfma_f32_16x16x32_bf16 v[108:111], a[212:215], a[148:151], v[108:111]
    s_add_u32 s40, s40, s100
    v_exp_f32 v27, v87
    v_exp_f32 v20, v88
    v_mfma_f32_16x16x32_bf16 v[108:111], a[216:219], a[152:155], v[108:111]
    v_cvt_pk_bf16_f32 v139, v26, v27
    v_exp_f32 v21, v89
    v_mfma_f32_16x16x32_bf16 v[108:111], a[220:223], a[156:159], v[108:111]
    buffer_store_dwordx4 v[248:251], v2, s[36:39], s40 offen sc1
    v_exp_f32 v22, v90
    v_mfma_f32_16x16x32_bf16 v[36:39], v[44:47], v[136:139], 0
    v_cvt_pk_bf16_f32 v140, v20, v21
    v_exp_f32 v23, v91
    v_mfma_f32_16x16x32_bf16 v[116:119], a[208:211], a[160:163], v[180:183]
    s_add_u32 s40, s40, s100
    v_exp_f32 v24, v92
    v_cvt_pk_bf16_f32 v141, v22, v23
    v_mfma_f32_16x16x32_bf16 v[116:119], a[212:215], a[164:167], v[116:119]
    v_exp_f32 v25, v93
    v_mfma_f32_16x16x32_bf16 v[116:119], a[216:219], a[168:171], v[116:119]
    buffer_store_dwordx4 v[252:255], v2, s[36:39], s40 offen sc1
    v_exp_f32 v26, v94
    v_cvt_pk_bf16_f32 v142, v24, v25
    v_mfma_f32_16x16x32_bf16 v[116:119], a[220:223], a[172:175], v[116:119]
    s_add_u32 s40, s40, s100
    v_exp_f32 v27, v95
    s_nop 0
    v_cvt_pk_bf16_f32 v143, v26, v27
    s_nop 1
    v_mfma_f32_16x16x32_bf16 v[40:43], v[44:47], v[140:143], 0
    s_nop 2
    v_mfma_f32_16x16x32_bf16 v[124:127], a[208:211], a[176:179], v[188:191]
    s_nop 2
    v_mfma_f32_16x16x32_bf16 v[124:127], a[212:215], a[180:183], v[124:127]
    v_max3_f32 v8, v28, v32, v36
    v_max_f32 v8, v8, v40
    v_mfma_f32_16x16x32_bf16 v[124:127], a[216:219], a[184:187], v[124:127]
    v_cmp_nge_f32 vcc, s66, v8
    v_mfma_f32_16x16x32_bf16 v[124:127], a[220:223], a[188:191], v[124:127]
    s_waitcnt vmcnt(48) lgkmcnt(0)
    s_barrier
    s_add_u32 s59, s58, s60
    s_add_u32 s58, s58, 32768
    s_cmp_ge_u32 s58, 163840
    s_cselect_b32 s58, 0, s58
    v_add_u32 v6, s58, v2
    ds_read_b128 a[192:195], v6 offset:0
    ds_read_b128 a[196:199], v6 offset:1024
    ds_read_b128 a[200:203], v6 offset:2048
    ds_read_b128 a[204:207], v6 offset:3072
    ds_read_b128 a[208:211], v6 offset:4096
    ds_read_b128 a[212:215], v6 offset:5120
    ds_read_b128 a[216:219], v6 offset:6144
    ds_read_b128 a[220:223], v6 offset:7168
    s_waitcnt lgkmcnt(0)
    s_cbranch_vccnz m_stub76
m_ret77:
m_dual78:
    v_mfma_f32_16x16x32_bf16 v[64:67], a[192:195], a[128:131], v[160:163]
    s_bitcmp1_b64 s[62:63], s64
    s_cselect_b32 s66, -1.0, s65
    v_add_f32 v12, v12, v28
    v_mfma_f32_16x16x32_bf16 v[64:67], a[196:199], a[132:135], v[64:67]
    s_add_u32 s64, s64, 1
    ds_read_b128 a[224:227], v6 offset:16384
    v_add_f32 v13, v13, v32
    v_mfma_f32_16x16x32_bf16 v[64:67], a[200:203], a[136:139], v[64:67]
    v_exp_f32 v20, v96
    v_mfma_f32_16x16x32_bf16 v[64:67], a[204:207], a[140:143], v[64:67]
    v_exp_f32 v21, v97
    v_mfma_f32_16x16x32_bf16 v[72:75], a[192:195], a[144:147], v[168:171]
    s_mov_b32 m0, s59
    ds_read_b128 a[228:231], v6 offset:17408
    v_cvt_pk_bf16_f32 v144, v20, v21
    v_mfma_f32_16x16x32_bf16 v[72:75], a[196:199], a[148:151], v[72:75]
    buffer_load_dwordx4 v7, s[24:27], s56 offen offset:0 sc1 lds
    v_mfma_f32_16x16x32_bf16 v[72:75], a[200:203], a[152:155], v[72:75]
    v_exp_f32 v22, v98
    v_mfma_f32_16x16x32_bf16 v[72:75], a[204:207], a[156:159], v[72:75]
    ds_read_b128 a[232:235], v6 offset:18432
    v_add_f32 v14, v14, v36
    v_mfma_f32_16x16x32_bf16 v[80:83], a[192:195], a[160:163], v[176:179]
    v_exp_f32 v23, v99
    v_mfma_f32_16x16x32_bf16 v[80:83], a[196:199], a[164:167], v[80:83]
    v_exp_f32 v24, v100
    v_mfma_f32_16x16x32_bf16 v[80:83], a[200:203], a[168:171], v[80:83]
    ds_read_b128 a[236:239], v6 offset:19456
    v_cvt_pk_bf16_f32 v145, v22, v23
    v_mfma_f32_16x16x32_bf16 v[80:83], a[204:207], a[172:175], v[80:83]
    v_exp_f32 v25, v101
    v_mfma_f32_16x16x32_bf16 v[88:91], a[192:195], a[176:179], v[184:187]
    v_exp_f32 v26, v102
    v_mfma_f32_16x16x32_bf16 v[88:91], a[196:199], a[180:183], v[88:91]
    ds_read_b128 a[240:243], v6 offset:20480
    v_cvt_pk_bf16_f32 v146, v24, v25
    v_mfma_f32_16x16x32_bf16 v[88:91], a[200:203], a[184:187], v[88:91]
    v_exp_f32 v27, v103
    v_mfma_f32_16x16x32_bf16 v[88:91], a[204:207], a[188:191], v[88:91]
    s_waitcnt lgkmcnt(5)
    v_exp_f32 v20, v104
    v_mfma_f32_16x16x32_bf16 v[68:71], a[208:211], a[128:131], v[164:167]
    ds_read_b128 a[244:247], v6 offset:21504
    v_cvt_pk_bf16_f32 v147, v26, v27
    v_mfma_f32_16x16x32_bf16 v[68:71], a[212:215], a[132:135], v[68:71]
    v_exp_f32 v21, v105
    v_mfma_f32_16x16x32_bf16 v[28:31], v[44:47], v[144:147], 0
    v_exp_f32 v22, v106
    v_mfma_f32_16x16x32_bf16 v[68:71], a[216:219], a[136:139], v[68:71]
    buffer_load_dwordx4 v7, s[24:27], s56 offen offset:1024 sc1 lds
    v_mfma_f32_16x16x32_bf16 v[68:71], a[220:223], a[140:143], v[68:71]
    ds_read_b128 a[248:251], v6 offset:22528
    v_cvt_pk_bf16_f32 v148, v20, v21
    v_mfma_f32_16x16x32_bf16 v[76:79], a[208:211], a[144:147], v[172:175]
    v_exp_f32 v23, v107
    v_mfma_f32_16x16x32_bf16 v[76:79], a[212:215], a[148:151], v[76:79]
    v_exp_f32 v24, v108
    v_mfma_f32_16x16x32_bf16 v[76:79], a[216:219], a[152:155], v[76:79]
    ds_read_b128 a[252:255], v6 offset:23552
    v_cvt_pk_bf16_f32 v149, v22, v23
    v_mfma_f32_16x16x32_bf16 v[76:79], a[220:223], a[156:159], v[76:79]
    v_exp_f32 v25, v109
    v_mfma_f32_16x16x32_bf16 v[84:87], a[208:211], a[160:163], v[180:183]
    v_exp_f32 v26, v110
    v_mfma_f32_16x16x32_bf16 v[84:87], a[212:215], a[164:167], v[84:87]
    v_cvt_pk_bf16_f32 v150, v24, v25
    v_add_f32 v15, v15, v40
    v_mfma_f32_16x16x32_bf16 v[84:87], a[216:219], a[168:171], v[84:87]
    v_exp_f32 v27, v111
    v_mfma_f32_16x16x32_bf16 v[84:87], a[220:223], a[172:175], v[84:87]
    buffer_load_dwordx4 v7, s[24:27], s56 offen offset:2048 sc1 lds
    v_mfma_f32_16x16x32_bf16 v[92:95], a[208:211], a[176:179], v[188:191]
    v_exp_f32 v20, v112
    v_mfma_f32_16x16x32_bf16 v[92:95], a[212:215], a[180:183], v[92:95]
    v_cvt_pk_bf16_f32 v151, v26, v27
    v_mfma_f32_16x16x32_bf16 v[92:95], a[216:219], a[184:187], v[92:95]
    v_exp_f32 v21, v113
    v_mfma_f32_16x16x32_bf16 v[32:35], v[44:47], v[148:151], 0
    v_exp_f32 v22, v114
    v_mfma_f32_16x16x32_bf16 v[92:95], a[220:223], a[188:191], v[92:95]
    s_waitcnt lgkmcnt(0)
    v_cvt_pk_bf16_f32 v152, v20, v21
    v_mfma_f32_16x16x32_bf16 a[0:3], a[224:227], v[128:131], a[0:3]
    ds_read_b128 a[192:195], v6 offset:8192
    v_mfma_f32_16x16x32_bf16 a[32:35], a[224:227], v[132:135], a[32:35]
    v_exp_f32 v23, v115
    v_mfma_f32_16x16x32_bf16 a[64:67], a[224:227], v[136:139], a[64:67]
    v_exp_f32 v24, v116
    v_mfma_f32_16x16x32_bf16 a[96:99], a[224:227], v[140:143], a[96:99]
    ds_read_b128 a[196:199], v6 offset:9216
    v_cvt_pk_bf16_f32 v153, v22, v23
    v_mfma_f32_16x16x32_bf16 a[4:7], a[228:231], v[128:131], a[4:7]
    v_exp_f32 v25, v117
    v_mfma_f32_16x16x32_bf16 a[36:39], a[228:231], v[132:135], a[36:39]
    v_exp_f32 v26, v118
    v_mfma_f32_16x16x32_bf16 a[68:71], a[228:231], v[136:139], a[68:71]
    ds_read_b128 a[200:203], v6 offset:10240
    v_cvt_pk_bf16_f32 v154, v24, v25
    v_mfma_f32_16x16x32_bf16 a[100:103], a[228:231], v[140:143], a[100:103]
    v_exp_f32 v27, v119
    v_mfma_f32_16x16x32_bf16 a[8:11], a[232:235], v[128:131], a[8:11]
    v_exp_f32 v20, v120
    v_mfma_f32_16x16x32_bf16 a[40:43], a[232:235], v[132:135], a[40:43]
    ds_read_b128 a[204:207], v6 offset:11264
    v_cvt_pk_bf16_f32 v155, v26, v27
    v_mfma_f32_16x16x32_bf16 a[72:75], a[232:235], v[136:139], a[72:75]
    v_exp_f32 v21, v121
    v_mfma_f32_16x16x32_bf16 v[36:39], v[44:47], v[152:155], 0
    v_exp_f32 v22, v122
    v_mfma_f32_16x16x32_bf16 a[104:107], a[232:235], v[140:143], a[104:107]
    buffer_load_dwordx4 v7, s[24:27], s56 offen offset:3072 sc1 lds
    v_mfma_f32_16x16x32_bf16 a[12:15], a[236:239], v[128:131], a[12:15]
    s_add_u32 s56, s56, 16384
    v_cvt_pk_bf16_f32 v156, v20, v21
    v_mfma_f32_16x16x32_bf16 a[44:47], a[236:239], v[132:135], a[44:47]
    v_exp_f32 v23, v123
    v_mfma_f32_16x16x32_bf16 a[76:79], a[236:239], v[136:139], a[76:79]
    v_exp_f32 v24, v124
    v_mfma_f32_16x16x32_bf16 a[108:111], a[236:239], v[140:143], a[108:111]
    v_cvt_pk_bf16_f32 v157, v22, v23
    v_mfma_f32_16x16x32_bf16 a[16:19], a[240:243], v[128:131], a[16:19]
    v_exp_f32 v25, v125
    v_mfma_f32_16x16x32_bf16 a[48:51], a[240:243], v[132:135], a[48:51]
    v_exp_f32 v26, v126
    v_mfma_f32_16x16x32_bf16 a[80:83], a[240:243], v[136:139], a[80:83]
    v_cvt_pk_bf16_f32 v158, v24, v25
    v_mfma_f32_16x16x32_bf16 a[112:115], a[240:243], v[140:143], a[112:115]
    s_add_u32 m0, s59, 16384
    v_exp_f32 v27, v127
    v_mfma_f32_16x16x32_bf16 a[20:23], a[244:247], v[128:131], a[20:23]
    buffer_load_dwordx4 v7, s[28:31], s57 offen offset:0 sc1 lds
    v_mfma_f32_16x16x32_bf16 a[52:55], a[244:247], v[132:135], a[52:55]
    v_cvt_pk_bf16_f32 v159, v26, v27
    v_mfma_f32_16x16x32_bf16 a[84:87], a[244:247], v[136:139], a[84:87]
    v_mfma_f32_16x16x32_bf16 a[116:119], a[244:247], v[140:143], a[116:119]
    v_mfma_f32_16x16x32_bf16 v[40:43], v[44:47], v[156:159], 0
    s_nop 2
    v_mfma_f32_16x16x32_bf16 a[24:27], a[248:251], v[128:131], a[24:27]
    s_nop 2
    v_mfma_f32_16x16x32_bf16 a[56:59], a[248:251], v[132:135], a[56:59]
    v_max3_f32 v8, v28, v32, v36
    v_max_f32 v8, v8, v40
    v_mfma_f32_16x16x32_bf16 a[88:91], a[248:251], v[136:139], a[88:91]
    v_cmp_nge_f32 vcc, s66, v8
    v_mfma_f32_16x16x32_bf16 a[120:123], a[248:251], v[140:143], a[120:123]
    ds_read_b128 a[208:211], v6 offset:12288
    v_mfma_f32_16x16x32_bf16 a[28:31], a[252:255], v[128:131], a[28:31]
    ds_read_b128 a[212:215], v6 offset:13312
    v_mfma_f32_16x16x32_bf16 a[60:63], a[252:255], v[132:135], a[60:63]
    ds_read_b128 a[216:219], v6 offset:14336
    v_mfma_f32_16x16x32_bf16 a[92:95], a[252:255], v[136:139], a[92:95]
    ds_read_b128 a[220:223], v6 offset:15360
    v_mfma_f32_16x16x32_bf16 a[124:127], a[252:255], v[140:143], a[124:127]
    s_waitcnt lgkmcnt(4)
    s_cbranch_vccnz m_stub79
m_ret80:
    v_mfma_f32_16x16x32_bf16 v[96:99], a[192:195], a[128:131], v[160:163]
    s_add_u32 s59, s58, s60
    v_exp_f32 v20, v64
    v_mfma_f32_16x16x32_bf16 v[96:99], a[196:199], a[132:135], v[96:99]
    s_add_u32 s58, s58, 32768
    ds_read_b128 a[224:227], v6 offset:24576
    v_add_f32 v12, v12, v28
    v_mfma_f32_16x16x32_bf16 v[96:99], a[200:203], a[136:139], v[96:99]
    s_cmp_ge_u32 s58, 163840
    s_cselect_b32 s58, 0, s58
    v_exp_f32 v21, v65
    v_mfma_f32_16x16x32_bf16 v[96:99], a[204:207], a[140:143], v[96:99]
    s_bitcmp1_b64 s[62:63], s64
    s_cselect_b32 s66, -1.0, s65
    v_cvt_pk_bf16_f32 v128, v20, v21
    v_mfma_f32_16x16x32_bf16 v[104:107], a[192:195], a[144:147], v[168:171]
    s_add_u32 s64, s64, 1
    ds_read_b128 a[228:231], v6 offset:25600
    v_add_f32 v13, v13, v32
    v_mfma_f32_16x16x32_bf16 v[104:107], a[196:199], a[148:151], v[104:107]
    v_exp_f32 v22, v66
    v_mfma_f32_16x16x32_bf16 v[104:107], a[200:203], a[152:155], v[104:107]
    buffer_load_dwordx4 v7, s[28:31], s57 offen offset:1024 sc1 lds
    v_mfma_f32_16x16x32_bf16 v[104:107], a[204:207], a[156:159], v[104:107]
    ds_read_b128 a[232:235], v6 offset:26624
    v_add_f32 v14, v14, v36
    v_mfma_f32_16x16x32_bf16 v[112:115], a[192:195], a[160:163], v[176:179]
    v_exp_f32 v23, v67
    v_mfma_f32_16x16x32_bf16 v[112:115], a[196:199], a[164:167], v[112:115]
    v_exp_f32 v24, v68
    v_mfma_f32_16x16x32_bf16 v[112:115], a[200:203], a[168:171], v[112:115]
    ds_read_b128 a[236:239], v6 offset:27648
    v_cvt_pk_bf16_f32 v129, v22, v23
    v_mfma_f32_16x16x32_bf16 v[112:115], a[204:207], a[172:175], v[112:115]
    v_exp_f32 v25, v69
    v_mfma_f32_16x16x32_bf16 v[120:123], a[192:195], a[176:179], v[184:187]
    v_exp_f32 v26, v70
    v_mfma_f32_16x16x32_bf16 v[120:123], a[196:199], a[180:183], v[120:123]
    ds_read_b128 a[240:243], v6 offset:28672
    v_cvt_pk_bf16_f32 v130, v24, v25
    v_mfma_f32_16x16x32_bf16 v[120:123], a[200:203], a[184:187], v[120:123]
    v_exp_f32 v27, v71
    v_mfma_f32_16x16x32_bf16 v[120:123], a[204:207], a[188:191], v[120:123]
    s_waitcnt lgkmcnt(5)
    v_exp_f32 v20, v72
    v_mfma_f32_16x16x32_bf16 v[100:103], a[208:211], a[128:131], v[164:167]
    ds_read_b128 a[244:247], v6 offset:29696
    v_cvt_pk_bf16_f32 v131, v26, v27
    v_mfma_f32_16x16x32_bf16 v[100:103], a[212:215], a[132:135], v[100:103]
    v_exp_f32 v21, v73
    v_mfma_f32_16x16x32_bf16 v[28:31], v[44:47], v[128:131], 0
    v_exp_f32 v22, v74
    v_mfma_f32_16x16x32_bf16 v[100:103], a[216:219], a[136:139], v[100:103]
    buffer_load_dwordx4 v7, s[28:31], s57 offen offset:2048 sc1 lds
    v_mfma_f32_16x16x32_bf16 v[100:103], a[220:223], a[140:143], v[100:103]
    ds_read_b128 a[248:251], v6 offset:30720
    v_cvt_pk_bf16_f32 v132, v20, v21
    v_mfma_f32_16x16x32_bf16 v[108:111], a[208:211], a[144:147], v[172:175]
    v_exp_f32 v23, v75
    v_mfma_f32_16x16x32_bf16 v[108:111], a[212:215], a[148:151], v[108:111]
    v_exp_f32 v24, v76
    v_mfma_f32_16x16x32_bf16 v[108:111], a[216:219], a[152:155], v[108:111]
    ds_read_b128 a[252:255], v6 offset:31744
    v_cvt_pk_bf16_f32 v133, v22, v23
    v_mfma_f32_16x16x32_bf16 v[108:111], a[220:223], a[156:159], v[108:111]
    v_exp_f32 v25, v77
    v_mfma_f32_16x16x32_bf16 v[116:119], a[208:211], a[160:163], v[180:183]
    v_exp_f32 v26, v78
    v_mfma_f32_16x16x32_bf16 v[116:119], a[212:215], a[164:167], v[116:119]
    v_cvt_pk_bf16_f32 v134, v24, v25
    v_add_f32 v15, v15, v40
    v_mfma_f32_16x16x32_bf16 v[116:119], a[216:219], a[168:171], v[116:119]
    v_exp_f32 v27, v79
    v_mfma_f32_16x16x32_bf16 v[116:119], a[220:223], a[172:175], v[116:119]
    buffer_load_dwordx4 v7, s[28:31], s57 offen offset:3072 sc1 lds
    v_mfma_f32_16x16x32_bf16 v[124:127], a[208:211], a[176:179], v[188:191]
    s_add_u32 s57, s57, 16384
    v_exp_f32 v20, v80
    v_mfma_f32_16x16x32_bf16 v[124:127], a[212:215], a[180:183], v[124:127]
    v_cvt_pk_bf16_f32 v135, v26, v27
    v_mfma_f32_16x16x32_bf16 v[124:127], a[216:219], a[184:187], v[124:127]
    v_exp_f32 v21, v81
    v_mfma_f32_16x16x32_bf16 v[32:35], v[44:47], v[132:135], 0
    v_exp_f32 v22, v82
    v_mfma_f32_16x16x32_bf16 v[124:127], a[220:223], a[188:191], v[124:127]
    s_waitcnt vmcnt(24) lgkmcnt(0)
    v_add_u32 v6, s58, v2
    v_cvt_pk_bf16_f32 v136, v20, v21
    v_mfma_f32_16x16x32_bf16 a[0:3], a[224:227], v[144:147], a[0:3]
    s_barrier
    v_mfma_f32_16x16x32_bf16 a[32:35], a[224:227], v[148:151], a[32:35]
    ds_read_b128 a[192:195], v6 offset:0
    v_mfma_f32_16x16x32_bf16 a[64:67], a[224:227], v[152:155], a[64:67]
    v_exp_f32 v23, v83
    v_mfma_f32_16x16x32_bf16 a[96:99], a[224:227], v[156:159], a[96:99]
    v_exp_f32 v24, v84
    v_mfma_f32_16x16x32_bf16 a[4:7], a[228:231], v[144:147], a[4:7]
    ds_read_b128 a[196:199], v6 offset:1024
    v_cvt_pk_bf16_f32 v137, v22, v23
    v_mfma_f32_16x16x32_bf16 a[36:39], a[228:231], v[148:151], a[36:39]
    v_exp_f32 v25, v85
    v_mfma_f32_16x16x32_bf16 a[68:71], a[228:231], v[152:155], a[68:71]
    v_exp_f32 v26, v86
    v_mfma_f32_16x16x32_bf16 a[100:103], a[228:231], v[156:159], a[100:103]
    ds_read_b128 a[200:203], v6 offset:2048
    v_cvt_pk_bf16_f32 v138, v24, v25
    v_mfma_f32_16x16x32_bf16 a[8:11], a[232:235], v[144:147], a[8:11]
    v_exp_f32 v27, v87
    v_mfma_f32_16x16x32_bf16 a[40:43], a[232:235], v[148:151], a[40:43]
    v_exp_f32 v20, v88
    v_mfma_f32_16x16x32_bf16 a[72:75], a[232:235], v[152:155], a[72:75]
    ds_read_b128 a[204:207], v6 offset:3072
    v_cvt_pk_bf16_f32 v139, v26, v27
    v_mfma_f32_16x16x32_bf16 a[104:107], a[232:235], v[156:159], a[104:107]
    v_exp_f32 v21, v89
    v_mfma_f32_16x16x32_bf16 v[36:39], v[44:47], v[136:139], 0
    v_exp_f32 v22, v90
    v_mfma_f32_16x16x32_bf16 a[12:15], a[236:239], v[144:147], a[12:15]
    v_cvt_pk_bf16_f32 v140, v20, v21
    v_mfma_f32_16x16x32_bf16 a[44:47], a[236:239], v[148:151], a[44:47]
    v_exp_f32 v23, v91
    v_mfma_f32_16x16x32_bf16 a[76:79], a[236:239], v[152:155], a[76:79]
    v_exp_f32 v24, v92
    v_mfma_f32_16x16x32_bf16 a[108:111], a[236:239], v[156:159], a[108:111]
    v_cvt_pk_bf16_f32 v141, v22, v23
    v_mfma_f32_16x16x32_bf16 a[16:19], a[240:243], v[144:147], a[16:19]
    v_exp_f32 v25, v93
    v_mfma_f32_16x16x32_bf16 a[48:51], a[240:243], v[148:151], a[48:51]
    v_exp_f32 v26, v94
    v_mfma_f32_16x16x32_bf16 a[80:83], a[240:243], v[152:155], a[80:83]
    v_cvt_pk_bf16_f32 v142, v24, v25
    v_mfma_f32_16x16x32_bf16 a[112:115], a[240:243], v[156:159], a[112:115]
    v_exp_f32 v27, v95
    v_mfma_f32_16x16x32_bf16 a[20:23], a[244:247], v[144:147], a[20:23]
    v_cvt_pk_bf16_f32 v143, v26, v27
    v_mfma_f32_16x16x32_bf16 a[52:55], a[244:247], v[148:151], a[52:55]
    v_mfma_f32_16x16x32_bf16 a[84:87], a[244:247], v[152:155], a[84:87]
    v_mfma_f32_16x16x32_bf16 v[40:43], v[44:47], v[140:143], 0
    s_nop 2
    v_mfma_f32_16x16x32_bf16 a[116:119], a[244:247], v[156:159], a[116:119]
    s_nop 2
    v_mfma_f32_16x16x32_bf16 a[24:27], a[248:251], v[144:147], a[24:27]
    v_max3_f32 v8, v28, v32, v36
    v_max_f32 v8, v8, v40
    v_mfma_f32_16x16x32_bf16 a[56:59], a[248:251], v[148:151], a[56:59]
    v_cmp_nge_f32 vcc, s66, v8
    v_mfma_f32_16x16x32_bf16 a[88:91], a[248:251], v[152:155], a[88:91]
    v_mfma_f32_16x16x32_bf16 a[120:123], a[248:251], v[156:159], a[120:123]
    ds_read_b128 a[208:211], v6 offset:4096
    v_mfma_f32_16x16x32_bf16 a[28:31], a[252:255], v[144:147], a[28:31]
    ds_read_b128 a[212:215], v6 offset:5120
    v_mfma_f32_16x16x32_bf16 a[60:63], a[252:255], v[148:151], a[60:63]
    ds_read_b128 a[216:219], v6 offset:6144
    v_mfma_f32_16x16x32_bf16 a[92:95], a[252:255], v[152:155], a[92:95]
    ds_read_b128 a[220:223], v6 offset:7168
    v_mfma_f32_16x16x32_bf16 a[124:127], a[252:255], v[156:159], a[124:127]
    s_waitcnt lgkmcnt(4)
    s_cbranch_vccz m_dual78
    v_cmp_lt_f32 vcc, s65, v8
    s_cmp_lg_u32 s64, s67
    s_cbranch_scc1 m_e82
    v_add_f32 v176, v176, v16
    v_mov_b32 v180, v9
    v_add_f32 v188, v188, v16
    v_add_f32 v177, v177, v17
    v_mov_b32 v181, v9
    v_add_f32 v189, v189, v17
    v_add_f32 v178, v178, v18
    v_mov_b32 v182, v9
    v_add_f32 v190, v190, v18
    v_add_f32 v179, v179, v19
    v_mov_b32 v183, v9
    v_add_f32 v191, v191, v19
    s_nop 0
m_e82:
    s_cmp_lg_u32 s64, s68
    s_cbranch_scc1 m_e83
    v_mov_b32 v176, v9
    v_mov_b32 v184, v9
    v_mov_b32 v188, v9
    v_mov_b32 v177, v9
    v_mov_b32 v185, v9
    v_mov_b32 v189, v9
    v_mov_b32 v178, v9
    v_mov_b32 v186, v9
    v_mov_b32 v190, v9
    v_mov_b32 v179, v9
    v_mov_b32 v187, v9
    v_mov_b32 v191, v9
    s_nop 0
m_e83:
    s_cmp_lg_u32 s64, s70
    s_cbranch_scc1 m_e84
    v_add_f32 v160, v160, v16
    v_mov_b32 v164, v9
    v_add_f32 v172, v172, v16
    v_add_f32 v161, v161, v17
    v_mov_b32 v165, v9
    v_add_f32 v173, v173, v17
    v_add_f32 v162, v162, v18
    v_mov_b32 v166, v9
    v_add_f32 v174, v174, v18
    v_add_f32 v163, v163, v19
    v_mov_b32 v167, v9
    v_add_f32 v175, v175, v19
    s_nop 0
m_e84:
    s_cmp_lg_u32 s64, s53
    s_cbranch_scc1 m_e87
    s_cmp_lg_u32 s16, 0
    s_cbranch_scc1 m_np88
    v_mov_b32 v60, s4
    v_mov_b32 v61, s5
    s_add_u32 s90, s101, 117440512
    s_mov_b64 exec, 1
    buffer_store_dwordx2 v[60:61], off, s[8:11], s90 sc1
    s_mov_b64 exec, -1
m_np88:
    s_mov_b32 s101, -1
m_e87:
    s_cmp_gt_u32 s64, 24
    s_cbranch_scc1 m_e85
    s_cmp_lg_u32 s64, 8
    s_cbranch_scc1 m_e89
    s_lshr_b32 s90, s32, 1
    s_lshl_b32 s90, s90, 7
    s_add_u32 s90, s90, 117440600
    v_min_u32 v0, 1, v1
    v_lshlrev_b32 v0, 5, v0
    buffer_load_dwordx2 v[4:5], v0, s[8:11], s90 offen sc1
    s_cmp_eq_u32 s17, -1
    s_cbranch_scc1 m_e85
    s_cmp_lg_u32 s16, 0
    s_cbranch_scc1 m_np90
    v_mov_b32 v60, s4
    v_mov_b32 v61, s5
    s_add_u32 s90, s17, 117440512
    s_mov_b64 exec, 1
    buffer_store_dwordx2 v[60:61], off, s[8:11], s90 sc1
    s_mov_b64 exec, -1
m_np90:
    s_branch m_e85
m_e89:
    s_cmp_lg_u32 s64, 16
    s_cbranch_scc1 m_e91
    s_waitcnt vmcnt(18)
    s_mov_b32 s3, 1048576
m_spin92:
    v_cmp_ne_u64 s[76:77], s[4:5], v[4:5]
    s_nop 3
    s_cmp_eq_u64 s[76:77], 0
    s_cbranch_scc1 m_e85
    s_sub_u32 s3, s3, 1
    s_cbranch_scc1 m_e85
    s_sleep 32
    s_lshr_b32 s90, s32, 1
    s_lshl_b32 s90, s90, 7
    s_add_u32 s90, s90, 117440600
    v_min_u32 v0, 1, v1
    v_lshlrev_b32 v0, 5, v0
    buffer_load_dwordx2 v[4:5], v0, s[8:11], s90 offen sc1
    s_waitcnt vmcnt(0)
    s_branch m_spin92
    s_branch m_e85
m_e91:
    s_cmp_lg_u32 s64, 20
    s_cbranch_scc1 m_e93
    buffer_load_dwordx2 v[4:5], v10, s[8:11], 0 offen sc1
    s_mov_b32 s44, s48
    s_mov_b32 s45, s49
    s_mov_b32 s46, 8388608
    s_lshl_b32 s90, s2, 2
    s_add_u32 s90, s90, s16
    s_lshl_b32 s90, s90, 13
    v_lshlrev_b32 v62, 7, v1
    buffer_load_dword v255, v62, s[44:47], s90 offen
    s_branch m_e85
m_e93:
    s_cmp_lg_u32 s64, 24
    s_cbranch_scc1 m_e94
    s_mov_b32 s44, s50
    s_mov_b32 s45, s51
    s_mov_b32 s46, 2097152
    s_lshl_b32 s90, s2, 2
    s_add_u32 s90, s90, s16
    s_lshl_b32 s90, s90, 13
    v_lshlrev_b32 v62, 7, v1
    buffer_load_dword v255, v62, s[44:47], s90 offen
    s_waitcnt vmcnt(18)
    s_mov_b32 s3, 1048576
m_spin95:
    v_cmp_ne_u64 s[76:77], s[4:5], v[4:5]
    s_nop 3
    s_cmp_eq_u64 s[76:77], 0
    s_cbranch_scc1 m_e85
    s_sub_u32 s3, s3, 1
    s_cbranch_scc1 m_e85
    s_sleep 32
    buffer_load_dwordx2 v[4:5], v10, s[8:11], 0 offen sc1
    s_waitcnt vmcnt(0)
    s_branch m_spin95
    s_branch m_e85
m_e94:
m_e85:
    s_cbranch_vccnz m_rc96
m_sp81:
    s_cmp_lg_u32 s64, s69
    s_cbranch_scc1 m_dual78
    v_mfma_f32_16x16x32_bf16 v[64:67], a[192:195], a[128:131], v[160:163]
    s_bitcmp1_b64 s[62:63], s64
    s_cselect_b32 s66, -1.0, s65
    v_add_f32 v12, v12, v28
    v_mfma_f32_16x16x32_bf16 v[64:67], a[196:199], a[132:135], v[64:67]
    s_add_u32 s64, s64, 1
    ds_read_b128 a[224:227], v6 offset:16384
    v_exp_f32 v20, v96
    v_mfma_f32_16x16x32_bf16 v[64:67], a[200:203], a[136:139], v[64:67]
    s_mov_b32 m0, s59
    ds_read_b128 a[228:231], v6 offset:17408
    v_add_f32 v13, v13, v32
    v_mfma_f32_16x16x32_bf16 v[64:67], a[204:207], a[140:143], v[64:67]
    buffer_load_dwordx4 v7, s[24:27], s56 offen offset:0 sc1 lds
    v_mfma_f32_16x16x32_bf16 v[72:75], a[192:195], a[144:147], v[168:171]
    ds_read_b128 a[232:235], v6 offset:18432
    v_add_f32 v14, v14, v36
    v_mfma_f32_16x16x32_bf16 v[72:75], a[196:199], a[148:151], v[72:75]
    ds_read_b128 a[236:239], v6 offset:19456
    v_exp_f32 v21, v97
    v_mfma_f32_16x16x32_bf16 v[72:75], a[200:203], a[152:155], v[72:75]
    ds_read_b128 a[240:243], v6 offset:20480
    v_cvt_pk_bf16_f32 v144, v20, v21
    v_mfma_f32_16x16x32_bf16 v[72:75], a[204:207], a[156:159], v[72:75]
    s_waitcnt lgkmcnt(5)
    ds_read_b128 a[244:247], v6 offset:21504
    v_add_f32 v15, v15, v40
    v_mfma_f32_16x16x32_bf16 v[68:71], a[208:211], a[128:131], v[164:167]
    ds_read_b128 a[248:251], v6 offset:22528
    v_exp_f32 v22, v98
    v_mfma_f32_16x16x32_bf16 v[68:71], a[212:215], a[132:135], v[68:71]
    ds_read_b128 a[252:255], v6 offset:23552
    v_exp_f32 v23, v99
    v_mfma_f32_16x16x32_bf16 v[68:71], a[216:219], a[136:139], v[68:71]
    v_exp_f32 v24, v100
    v_mfma_f32_16x16x32_bf16 v[68:71], a[220:223], a[140:143], v[68:71]
    buffer_load_dwordx4 v7, s[24:27], s56 offen offset:1024 sc1 lds
    v_mfma_f32_16x16x32_bf16 v[76:79], a[208:211], a[144:147], v[172:175]
    v_cvt_pk_bf16_f32 v145, v22, v23
    v_exp_f32 v25, v101
    v_mfma_f32_16x16x32_bf16 v[76:79], a[212:215], a[148:151], v[76:79]
    v_exp_f32 v26, v102
    v_mfma_f32_16x16x32_bf16 v[76:79], a[216:219], a[152:155], v[76:79]
    v_cvt_pk_bf16_f32 v146, v24, v25
    v_exp_f32 v27, v103
    v_mfma_f32_16x16x32_bf16 v[76:79], a[220:223], a[156:159], v[76:79]
    s_waitcnt lgkmcnt(0)
    v_exp_f32 v20, v104
    v_mfma_f32_16x16x32_bf16 a[0:3], a[224:227], v[128:131], a[0:3]
    ds_read_b128 a[192:195], v6 offset:8192
    v_cvt_pk_bf16_f32 v147, v26, v27
    v_mfma_f32_16x16x32_bf16 a[32:35], a[224:227], v[132:135], a[32:35]
    v_exp_f32 v21, v105
    v_mfma_f32_16x16x32_bf16 v[28:31], v[44:47], v[144:147], 0
    v_exp_f32 v22, v106
    v_mfma_f32_16x16x32_bf16 a[64:67], a[224:227], v[136:139], a[64:67]
    v_cvt_pk_bf16_f32 v148, v20, v21
    v_exp_f32 v23, v107
    v_mfma_f32_16x16x32_bf16 a[96:99], a[224:227], v[140:143], a[96:99]
    ds_read_b128 a[196:199], v6 offset:9216
    v_cvt_pk_bf16_f32 v149, v22, v23
    v_mfma_f32_16x16x32_bf16 a[4:7], a[228:231], v[128:131], a[4:7]
    v_exp_f32 v24, v108
    v_mfma_f32_16x16x32_bf16 a[36:39], a[228:231], v[132:135], a[36:39]
    buffer_load_dwordx4 v7, s[24:27], s56 offen offset:2048 sc1 lds
    v_mfma_f32_16x16x32_bf16 a[68:71], a[228:231], v[136:139], a[68:71]
    ds_read_b128 a[200:203], v6 offset:10240
    v_exp_f32 v25, v109
    v_mfma_f32_16x16x32_bf16 a[100:103], a[228:231], v[140:143], a[100:103]
    v_exp_f32 v26, v110
    v_mfma_f32_16x16x32_bf16 a[8:11], a[232:235], v[128:131], a[8:11]
    v_cvt_pk_bf16_f32 v150, v24, v25
    v_exp_f32 v27, v111
    v_mfma_f32_16x16x32_bf16 a[40:43], a[232:235], v[132:135], a[40:43]
    ds_read_b128 a[204:207], v6 offset:11264
    v_cvt_pk_bf16_f32 v151, v26, v27
    v_mfma_f32_16x16x32_bf16 a[72:75], a[232:235], v[136:139], a[72:75]
    v_exp_f32 v20, v112
    v_mfma_f32_16x16x32_bf16 v[32:35], v[44:47], v[148:151], 0
    v_exp_f32 v21, v113
    v_mfma_f32_16x16x32_bf16 a[104:107], a[232:235], v[140:143], a[104:107]
    v_exp_f32 v22, v114
    v_mfma_f32_16x16x32_bf16 a[12:15], a[236:239], v[128:131], a[12:15]
    v_cvt_pk_bf16_f32 v152, v20, v21
    v_exp_f32 v23, v115
    v_mfma_f32_16x16x32_bf16 a[44:47], a[236:239], v[132:135], a[44:47]
    v_exp_f32 v24, v116
    v_mfma_f32_16x16x32_bf16 a[76:79], a[236:239], v[136:139], a[76:79]
    v_cvt_pk_bf16_f32 v153, v22, v23
    v_exp_f32 v25, v117
    v_mfma_f32_16x16x32_bf16 a[108:111], a[236:239], v[140:143], a[108:111]
    buffer_load_dwordx4 v7, s[24:27], s56 offen offset:3072 sc1 lds
    v_mfma_f32_16x16x32_bf16 a[16:19], a[240:243], v[128:131], a[16:19]
    s_add_u32 s56, s56, 16384
    v_exp_f32 v26, v118
    v_mfma_f32_16x16x32_bf16 a[48:51], a[240:243], v[132:135], a[48:51]
    v_cvt_pk_bf16_f32 v154, v24, v25
    v_exp_f32 v27, v119
    v_mfma_f32_16x16x32_bf16 a[80:83], a[240:243], v[136:139], a[80:83]
    v_exp_f32 v20, v120
    v_mfma_f32_16x16x32_bf16 a[112:115], a[240:243], v[140:143], a[112:115]
    v_cvt_pk_bf16_f32 v155, v26, v27
    v_exp_f32 v21, v121
    v_mfma_f32_16x16x32_bf16 a[20:23], a[244:247], v[128:131], a[20:23]
    v_exp_f32 v22, v122
    v_mfma_f32_16x16x32_bf16 v[36:39], v[44:47], v[152:155], 0
    v_cvt_pk_bf16_f32 v156, v20, v21
    v_mfma_f32_16x16x32_bf16 a[52:55], a[244:247], v[132:135], a[52:55]
    v_exp_f32 v23, v123
    v_mfma_f32_16x16x32_bf16 a[84:87], a[244:247], v[136:139], a[84:87]
    v_exp_f32 v24, v124
    v_cvt_pk_bf16_f32 v157, v22, v23
    v_mfma_f32_16x16x32_bf16 a[116:119], a[244:247], v[140:143], a[116:119]
    v_exp_f32 v25, v125
    v_mfma_f32_16x16x32_bf16 a[24:27], a[248:251], v[128:131], a[24:27]
    s_add_u32 m0, s59, 16384
    v_exp_f32 v26, v126
    v_mfma_f32_16x16x32_bf16 a[56:59], a[248:251], v[132:135], a[56:59]
    buffer_load_dwordx4 v7, s[28:31], s57 offen offset:0 sc1 lds
    v_mfma_f32_16x16x32_bf16 a[88:91], a[248:251], v[136:139], a[88:91]
    v_cvt_pk_bf16_f32 v158, v24, v25
    v_exp_f32 v27, v127
    v_mfma_f32_16x16x32_bf16 a[120:123], a[248:251], v[140:143], a[120:123]
    ds_read_b128 a[208:211], v6 offset:12288
    v_cvt_pk_bf16_f32 v159, v26, v27
    s_nop 1
    v_mfma_f32_16x16x32_bf16 v[40:43], v[44:47], v[156:159], 0
    s_nop 2
    v_mfma_f32_16x16x32_bf16 a[28:31], a[252:255], v[128:131], a[28:31]
    ds_read_b128 a[212:215], v6 offset:13312
    s_nop 0
    v_mfma_f32_16x16x32_bf16 a[60:63], a[252:255], v[132:135], a[60:63]
    ds_read_b128 a[216:219], v6 offset:14336
    v_max3_f32 v8, v28, v32, v36
    v_mfma_f32_16x16x32_bf16 a[92:95], a[252:255], v[136:139], a[92:95]
    ds_read_b128 a[220:223], v6 offset:15360
    v_max_f32 v8, v8, v40
    v_cmp_nge_f32 vcc, s66, v8
    v_mfma_f32_16x16x32_bf16 a[124:127], a[252:255], v[140:143], a[124:127]
    s_waitcnt lgkmcnt(4)
    s_cbranch_vccnz m_stub97
m_ret98:
    v_mfma_f32_16x16x32_bf16 v[96:99], a[192:195], a[128:131], v[160:163]
    s_add_u32 s59, s58, s60
    v_exp_f32 v20, v64
    v_mfma_f32_16x16x32_bf16 v[96:99], a[196:199], a[132:135], v[96:99]
    s_add_u32 s58, s58, 32768
    ds_read_b128 a[224:227], v6 offset:24576
    v_add_f32 v12, v12, v28
    v_mfma_f32_16x16x32_bf16 v[96:99], a[200:203], a[136:139], v[96:99]
    s_cmp_ge_u32 s58, 163840
    s_cselect_b32 s58, 0, s58
    ds_read_b128 a[228:231], v6 offset:25600
    v_add_f32 v13, v13, v32
    v_mfma_f32_16x16x32_bf16 v[96:99], a[204:207], a[140:143], v[96:99]
    buffer_load_dwordx4 v7, s[28:31], s57 offen offset:1024 sc1 lds
    v_mfma_f32_16x16x32_bf16 v[104:107], a[192:195], a[144:147], v[168:171]
    s_bitcmp1_b64 s[62:63], s64
    s_cselect_b32 s66, -1.0, s65
    ds_read_b128 a[232:235], v6 offset:26624
    v_mfma_f32_16x16x32_bf16 v[104:107], a[196:199], a[148:151], v[104:107]
    s_add_u32 s64, s64, 1
    ds_read_b128 a[236:239], v6 offset:27648
    v_mfma_f32_16x16x32_bf16 v[104:107], a[200:203], a[152:155], v[104:107]
    ds_read_b128 a[240:243], v6 offset:28672
    v_mfma_f32_16x16x32_bf16 v[104:107], a[204:207], a[156:159], v[104:107]
    s_waitcnt lgkmcnt(5)
    ds_read_b128 a[244:247], v6 offset:29696
    v_mfma_f32_16x16x32_bf16 v[100:103], a[208:211], a[128:131], v[164:167]
    buffer_load_dwordx4 v7, s[28:31], s57 offen offset:2048 sc1 lds
    v_mfma_f32_16x16x32_bf16 v[100:103], a[212:215], a[132:135], v[100:103]
    ds_read_b128 a[248:251], v6 offset:30720
    v_mfma_f32_16x16x32_bf16 v[100:103], a[216:219], a[136:139], v[100:103]
    ds_read_b128 a[252:255], v6 offset:31744
    v_mfma_f32_16x16x32_bf16 v[100:103], a[220:223], a[140:143], v[100:103]
    v_exp_f32 v21, v65
    v_mfma_f32_16x16x32_bf16 v[108:111], a[208:211], a[144:147], v[172:175]
    v_exp_f32 v22, v66
    v_mfma_f32_16x16x32_bf16 v[108:111], a[212:215], a[148:151], v[108:111]
    buffer_load_dwordx4 v7, s[28:31], s57 offen offset:3072 sc1 lds
    v_mfma_f32_16x16x32_bf16 v[108:111], a[216:219], a[152:155], v[108:111]
    s_add_u32 s57, s57, 16384
    v_cvt_pk_bf16_f32 v128, v20, v21
    v_mfma_f32_16x16x32_bf16 v[108:111], a[220:223], a[156:159], v[108:111]
    s_waitcnt vmcnt(24) lgkmcnt(0)
    v_add_u32 v6, s58, v2
    v_mfma_f32_16x16x32_bf16 a[0:3], a[224:227], v[144:147], a[0:3]
    s_barrier
    v_mfma_f32_16x16x32_bf16 a[32:35], a[224:227], v[148:151], a[32:35]
    ds_read_b128 a[192:195], v6 offset:0
    v_mfma_f32_16x16x32_bf16 a[64:67], a[224:227], v[152:155], a[64:67]
    v_exp_f32 v23, v67
    v_mfma_f32_16x16x32_bf16 a[96:99], a[224:227], v[156:159], a[96:99]
    v_exp_f32 v24, v68
    v_mfma_f32_16x16x32_bf16 a[4:7], a[228:231], v[144:147], a[4:7]
    ds_read_b128 a[196:199], v6 offset:1024
    v_cvt_pk_bf16_f32 v129, v22, v23
    v_mfma_f32_16x16x32_bf16 a[36:39], a[228:231], v[148:151], a[36:39]
    v_exp_f32 v25, v69
    v_mfma_f32_16x16x32_bf16 a[68:71], a[228:231], v[152:155], a[68:71]
    v_exp_f32 v26, v70
    v_mfma_f32_16x16x32_bf16 a[100:103], a[228:231], v[156:159], a[100:103]
    ds_read_b128 a[200:203], v6 offset:2048
    v_cvt_pk_bf16_f32 v130, v24, v25
    v_mfma_f32_16x16x32_bf16 a[8:11], a[232:235], v[144:147], a[8:11]
    v_exp_f32 v27, v71
    v_mfma_f32_16x16x32_bf16 a[40:43], a[232:235], v[148:151], a[40:43]
    v_exp_f32 v20, v72
    v_mfma_f32_16x16x32_bf16 a[72:75], a[232:235], v[152:155], a[72:75]
    ds_read_b128 a[204:207], v6 offset:3072
    v_cvt_pk_bf16_f32 v131, v26, v27
    v_mfma_f32_16x16x32_bf16 a[104:107], a[232:235], v[156:159], a[104:107]
    v_exp_f32 v21, v73
    v_mfma_f32_16x16x32_bf16 v[28:31], v[44:47], v[128:131], 0
    v_exp_f32 v22, v74
    v_mfma_f32_16x16x32_bf16 a[12:15], a[236:239], v[144:147], a[12:15]
    v_cvt_pk_bf16_f32 v132, v20, v21
    v_mfma_f32_16x16x32_bf16 a[44:47], a[236:239], v[148:151], a[44:47]
    v_exp_f32 v23, v75
    v_mfma_f32_16x16x32_bf16 a[76:79], a[236:239], v[152:155], a[76:79]
    v_exp_f32 v24, v76
    v_mfma_f32_16x16x32_bf16 a[108:111], a[236:239], v[156:159], a[108:111]
    v_cvt_pk_bf16_f32 v133, v22, v23
    v_mfma_f32_16x16x32_bf16 a[16:19], a[240:243], v[144:147], a[16:19]
    v_exp_f32 v25, v77
    v_mfma_f32_16x16x32_bf16 a[48:51], a[240:243], v[148:151], a[48:51]
    v_exp_f32 v26, v78
    v_mfma_f32_16x16x32_bf16 a[80:83], a[240:243], v[152:155], a[80:83]
    v_cvt_pk_bf16_f32 v134, v24, v25
    v_mfma_f32_16x16x32_bf16 a[112:115], a[240:243], v[156:159], a[112:115]
    v_exp_f32 v27, v79
    v_mfma_f32_16x16x32_bf16 a[20:23], a[244:247], v[144:147], a[20:23]
    v_cvt_pk_bf16_f32 v135, v26, v27
    v_mfma_f32_16x16x32_bf16 a[52:55], a[244:247], v[148:151], a[52:55]
    v_mfma_f32_16x16x32_bf16 a[84:87], a[244:247], v[152:155], a[84:87]
    v_mfma_f32_16x16x32_bf16 v[32:35], v[44:47], v[132:135], 0
    s_nop 2
    v_mfma_f32_16x16x32_bf16 a[116:119], a[244:247], v[156:159], a[116:119]
    s_nop 2
    v_mfma_f32_16x16x32_bf16 a[24:27], a[248:251], v[144:147], a[24:27]
    v_max_f32 v8, v28, v32
    v_cmp_nge_f32 vcc, s66, v8
    v_mfma_f32_16x16x32_bf16 a[56:59], a[248:251], v[148:151], a[56:59]
    v_mfma_f32_16x16x32_bf16 a[88:91], a[248:251], v[152:155], a[88:91]
    v_mfma_f32_16x16x32_bf16 a[120:123], a[248:251], v[156:159], a[120:123]
    ds_read_b128 a[208:211], v6 offset:4096
    v_mfma_f32_16x16x32_bf16 a[28:31], a[252:255], v[144:147], a[28:31]
    ds_read_b128 a[212:215], v6 offset:5120
    v_mfma_f32_16x16x32_bf16 a[60:63], a[252:255], v[148:151], a[60:63]
    ds_read_b128 a[216:219], v6 offset:6144
    v_mfma_f32_16x16x32_bf16 a[92:95], a[252:255], v[152:155], a[92:95]
    ds_read_b128 a[220:223], v6 offset:7168
    v_mfma_f32_16x16x32_bf16 a[124:127], a[252:255], v[156:159], a[124:127]
    s_waitcnt lgkmcnt(4)
    s_cbranch_vccnz m_stub99
m_ret100:
    v_add_f32 v20, v14, v36
    v_add_f32 v21, v15, v40
    s_nop 3
    v_rcp_f32 v20, v20
    v_rcp_f32 v21, v21
    s_lshl_b32 s90, s79, 10
    s_add_u32 s90, s90, s82
    s_add_u32 s90, s90, 67108864
    v_accvgpr_read_b32 v48, a64
    v_accvgpr_read_b32 v49, a65
    v_accvgpr_read_b32 v50, a66
    v_accvgpr_read_b32 v51, a67
    v_accvgpr_read_b32 v52, a68
    v_accvgpr_read_b32 v53, a69
    v_accvgpr_read_b32 v54, a70
    v_accvgpr_read_b32 v55, a71
    v_mul_f32 v48, v20, v48
    v_mul_f32 v49, v20, v49
    v_mul_f32 v50, v20, v50
    v_mul_f32 v51, v20, v51
    v_mul_f32 v52, v20, v52
    v_mul_f32 v53, v20, v53
    v_mul_f32 v54, v20, v54
    v_mul_f32 v55, v20, v55
    v_cvt_pk_bf16_f32 v48, v48, v49
    v_cvt_pk_bf16_f32 v49, v50, v51
    v_cvt_pk_bf16_f32 v50, v52, v53
    v_cvt_pk_bf16_f32 v51, v54, v55
    buffer_store_dwordx4 v[48:51], v2, s[8:11], s90 offen offset:0 sc1
    v_accvgpr_read_b32 v56, a96
    v_accvgpr_read_b32 v57, a97
    v_accvgpr_read_b32 v58, a98
    v_accvgpr_read_b32 v59, a99
    v_accvgpr_read_b32 v60, a100
    v_accvgpr_read_b32 v61, a101
    v_accvgpr_read_b32 v62, a102
    v_accvgpr_read_b32 v63, a103
    v_mul_f32 v56, v21, v56
    v_mul_f32 v57, v21, v57
    v_mul_f32 v58, v21, v58
    v_mul_f32 v59, v21, v59
    v_mul_f32 v60, v21, v60
    v_mul_f32 v61, v21, v61
    v_mul_f32 v62, v21, v62
    v_mul_f32 v63, v21, v63
    v_cvt_pk_bf16_f32 v56, v56, v57
    v_cvt_pk_bf16_f32 v57, v58, v59
    v_cvt_pk_bf16_f32 v58, v60, v61
    v_cvt_pk_bf16_f32 v59, v62, v63
    buffer_store_dwordx4 v[56:59], v2, s[8:11], s90 offen offset:1024 sc1
    s_add_u32 s90, s90, 131072
    v_accvgpr_read_b32 v48, a72
    v_accvgpr_read_b32 v49, a73
    v_accvgpr_read_b32 v50, a74
    v_accvgpr_read_b32 v51, a75
    v_accvgpr_read_b32 v52, a76
    v_accvgpr_read_b32 v53, a77
    v_accvgpr_read_b32 v54, a78
    v_accvgpr_read_b32 v55, a79
    v_mul_f32 v48, v20, v48
    v_mul_f32 v49, v20, v49
    v_mul_f32 v50, v20, v50
    v_mul_f32 v51, v20, v51
    v_mul_f32 v52, v20, v52
    v_mul_f32 v53, v20, v53
    v_mul_f32 v54, v20, v54
    v_mul_f32 v55, v20, v55
    v_cvt_pk_bf16_f32 v48, v48, v49
    v_cvt_pk_bf16_f32 v49, v50, v51
    v_cvt_pk_bf16_f32 v50, v52, v53
    v_cvt_pk_bf16_f32 v51, v54, v55
    buffer_store_dwordx4 v[48:51], v2, s[8:11], s90 offen offset:0 sc1
    v_accvgpr_read_b32 v56, a104
    v_accvgpr_read_b32 v57, a105
    v_accvgpr_read_b32 v58, a106
    v_accvgpr_read_b32 v59, a107
    v_accvgpr_read_b32 v60, a108
    v_accvgpr_read_b32 v61, a109
    v_accvgpr_read_b32 v62, a110
    v_accvgpr_read_b32 v63, a111
    v_mul_f32 v56, v21, v56
    v_mul_f32 v57, v21, v57
    v_mul_f32 v58, v21, v58
    v_mul_f32 v59, v21, v59
    v_mul_f32 v60, v21, v60
    v_mul_f32 v61, v21, v61
    v_mul_f32 v62, v21, v62
    v_mul_f32 v63, v21, v63
    v_cvt_pk_bf16_f32 v56, v56, v57
    v_cvt_pk_bf16_f32 v57, v58, v59
    v_cvt_pk_bf16_f32 v58, v60, v61
    v_cvt_pk_bf16_f32 v59, v62, v63
    buffer_store_dwordx4 v[56:59], v2, s[8:11], s90 offen offset:1024 sc1
    s_add_u32 s90, s90, 131072
    v_accvgpr_read_b32 v48, a80
    v_accvgpr_read_b32 v49, a81
    v_accvgpr_read_b32 v50, a82
    v_accvgpr_read_b32 v51, a83
    v_accvgpr_read_b32 v52, a84
    v_accvgpr_read_b32 v53, a85
    v_accvgpr_read_b32 v54, a86
    v_accvgpr_read_b32 v55, a87
    v_mul_f32 v48, v20, v48
    v_mul_f32 v49, v20, v49
    v_mul_f32 v50, v20, v50
    v_mul_f32 v51, v20, v51
    v_mul_f32 v52, v20, v52
    v_mul_f32 v53, v20, v53
    v_mul_f32 v54, v20, v54
    v_mul_f32 v55, v20, v55
    v_cvt_pk_bf16_f32 v48, v48, v49
    v_cvt_pk_bf16_f32 v49, v50, v51
    v_cvt_pk_bf16_f32 v50, v52, v53
    v_cvt_pk_bf16_f32 v51, v54, v55
    buffer_store_dwordx4 v[48:51], v2, s[8:11], s90 offen offset:0 sc1
    v_accvgpr_read_b32 v56, a112
    v_accvgpr_read_b32 v57, a113
    v_accvgpr_read_b32 v58, a114
    v_accvgpr_read_b32 v59, a115
    v_accvgpr_read_b32 v60, a116
    v_accvgpr_read_b32 v61, a117
    v_accvgpr_read_b32 v62, a118
    v_accvgpr_read_b32 v63, a119
    v_mul_f32 v56, v21, v56
    v_mul_f32 v57, v21, v57
    v_mul_f32 v58, v21, v58
    v_mul_f32 v59, v21, v59
    v_mul_f32 v60, v21, v60
    v_mul_f32 v61, v21, v61
    v_mul_f32 v62, v21, v62
    v_mul_f32 v63, v21, v63
    v_cvt_pk_bf16_f32 v56, v56, v57
    v_cvt_pk_bf16_f32 v57, v58, v59
    v_cvt_pk_bf16_f32 v58, v60, v61
    v_cvt_pk_bf16_f32 v59, v62, v63
    buffer_store_dwordx4 v[56:59], v2, s[8:11], s90 offen offset:1024 sc1
    s_add_u32 s90, s90, 131072
    v_accvgpr_read_b32 v48, a88
    v_accvgpr_read_b32 v49, a89
    v_accvgpr_read_b32 v50, a90
    v_accvgpr_read_b32 v51, a91
    v_accvgpr_read_b32 v52, a92
    v_accvgpr_read_b32 v53, a93
    v_accvgpr_read_b32 v54, a94
    v_accvgpr_read_b32 v55, a95
    v_mul_f32 v48, v20, v48
    v_mul_f32 v49, v20, v49
    v_mul_f32 v50, v20, v50
    v_mul_f32 v51, v20, v51
    v_mul_f32 v52, v20, v52
    v_mul_f32 v53, v20, v53
    v_mul_f32 v54, v20, v54
    v_mul_f32 v55, v20, v55
    v_cvt_pk_bf16_f32 v48, v48, v49
    v_cvt_pk_bf16_f32 v49, v50, v51
    v_cvt_pk_bf16_f32 v50, v52, v53
    v_cvt_pk_bf16_f32 v51, v54, v55
    buffer_store_dwordx4 v[48:51], v2, s[8:11], s90 offen offset:0 sc1
    v_accvgpr_read_b32 v56, a120
    v_accvgpr_read_b32 v57, a121
    v_accvgpr_read_b32 v58, a122
    v_accvgpr_read_b32 v59, a123
    v_accvgpr_read_b32 v60, a124
    v_accvgpr_read_b32 v61, a125
    v_accvgpr_read_b32 v62, a126
    v_accvgpr_read_b32 v63, a127
    v_mul_f32 v56, v21, v56
    v_mul_f32 v57, v21, v57
    v_mul_f32 v58, v21, v58
    v_mul_f32 v59, v21, v59
    v_mul_f32 v60, v21, v60
    v_mul_f32 v61, v21, v61
    v_mul_f32 v62, v21, v62
    v_mul_f32 v63, v21, v63
    v_cvt_pk_bf16_f32 v56, v56, v57
    v_cvt_pk_bf16_f32 v57, v58, v59
    v_cvt_pk_bf16_f32 v58, v60, v61
    v_cvt_pk_bf16_f32 v59, v62, v63
    buffer_store_dwordx4 v[56:59], v2, s[8:11], s90 offen offset:1024 sc1
    s_add_u32 s90, s90, 131072
    s_lshl_b32 s101, s34, 5
    s_add_u32 s101, s101, s32
    s_lshl_b32 s101, s101, 3
    s_add_u32 s101, s101, 7936
m_single101:
    v_mfma_f32_16x16x32_bf16 v[64:67], a[192:195], a[128:131], v[160:163]
    s_bitcmp1_b64 s[62:63], s64
    s_cselect_b32 s66, -1.0, s65
    v_add_f32 v12, v12, v28
    v_mfma_f32_16x16x32_bf16 v[64:67], a[196:199], a[132:135], v[64:67]
    s_mov_b32 m0, s59
    ds_read_b128 a[224:227], v6 offset:16384
    v_add_f32 v13, v13, v32
    v_mfma_f32_16x16x32_bf16 v[64:67], a[200:203], a[136:139], v[64:67]
    buffer_load_dwordx4 v7, s[24:27], s56 offen offset:0 sc1 lds
    v_mfma_f32_16x16x32_bf16 v[64:67], a[204:207], a[140:143], v[64:67]
    s_add_u32 s64, s64, 1
    ds_read_b128 a[228:231], v6 offset:17408
    v_exp_f32 v20, v96
    v_mfma_f32_16x16x32_bf16 v[72:75], a[192:195], a[144:147], v[168:171]
    ds_read_b128 a[232:235], v6 offset:18432
    v_exp_f32 v21, v97
    v_mfma_f32_16x16x32_bf16 v[72:75], a[196:199], a[148:151], v[72:75]
    ds_read_b128 a[236:239], v6 offset:19456
    v_cvt_pk_bf16_f32 v144, v20, v21
    v_mfma_f32_16x16x32_bf16 v[72:75], a[200:203], a[152:155], v[72:75]
    ds_read_b128 a[240:243], v6 offset:20480
    v_exp_f32 v22, v98
    v_mfma_f32_16x16x32_bf16 v[72:75], a[204:207], a[156:159], v[72:75]
    s_waitcnt lgkmcnt(5)
    ds_read_b128 a[244:247], v6 offset:21504
    v_mfma_f32_16x16x32_bf16 v[68:71], a[208:211], a[128:131], v[164:167]
    ds_read_b128 a[248:251], v6 offset:22528
    v_exp_f32 v23, v99
    v_mfma_f32_16x16x32_bf16 v[68:71], a[212:215], a[132:135], v[68:71]
    ds_read_b128 a[252:255], v6 offset:23552
    v_cvt_pk_bf16_f32 v145, v22, v23
    v_mfma_f32_16x16x32_bf16 v[68:71], a[216:219], a[136:139], v[68:71]
    buffer_load_dwordx4 v7, s[24:27], s56 offen offset:1024 sc1 lds
    v_mfma_f32_16x16x32_bf16 v[68:71], a[220:223], a[140:143], v[68:71]
    v_exp_f32 v24, v100
    v_mfma_f32_16x16x32_bf16 v[76:79], a[208:211], a[144:147], v[172:175]
    v_exp_f32 v25, v101
    v_mfma_f32_16x16x32_bf16 v[76:79], a[212:215], a[148:151], v[76:79]
    v_exp_f32 v26, v102
    v_mfma_f32_16x16x32_bf16 v[76:79], a[216:219], a[152:155], v[76:79]
    buffer_load_dwordx4 v7, s[24:27], s56 offen offset:2048 sc1 lds
    v_cvt_pk_bf16_f32 v146, v24, v25
    v_mfma_f32_16x16x32_bf16 v[76:79], a[220:223], a[156:159], v[76:79]
    s_waitcnt lgkmcnt(0)
    v_exp_f32 v27, v103
    v_mfma_f32_16x16x32_bf16 a[0:3], a[224:227], v[128:131], a[0:3]
    ds_read_b128 a[192:195], v6 offset:8192
    v_cvt_pk_bf16_f32 v147, v26, v27
    v_mfma_f32_16x16x32_bf16 a[32:35], a[224:227], v[132:135], a[32:35]
    v_exp_f32 v20, v104
    v_mfma_f32_16x16x32_bf16 v[28:31], v[44:47], v[144:147], 0
    v_exp_f32 v21, v105
    v_mfma_f32_16x16x32_bf16 a[4:7], a[228:231], v[128:131], a[4:7]
    ds_read_b128 a[196:199], v6 offset:9216
    v_exp_f32 v22, v106
    v_mfma_f32_16x16x32_bf16 a[36:39], a[228:231], v[132:135], a[36:39]
    buffer_load_dwordx4 v7, s[24:27], s56 offen offset:3072 sc1 lds
    v_mfma_f32_16x16x32_bf16 a[8:11], a[232:235], v[128:131], a[8:11]
    s_add_u32 s56, s56, 16384
    ds_read_b128 a[200:203], v6 offset:10240
    v_cvt_pk_bf16_f32 v148, v20, v21
    v_mfma_f32_16x16x32_bf16 a[40:43], a[232:235], v[132:135], a[40:43]
    v_exp_f32 v23, v107
    v_mfma_f32_16x16x32_bf16 a[12:15], a[236:239], v[128:131], a[12:15]
    ds_read_b128 a[204:207], v6 offset:11264
    v_exp_f32 v24, v108
    v_mfma_f32_16x16x32_bf16 a[44:47], a[236:239], v[132:135], a[44:47]
    v_cvt_pk_bf16_f32 v149, v22, v23
    v_exp_f32 v25, v109
    v_mfma_f32_16x16x32_bf16 a[16:19], a[240:243], v[128:131], a[16:19]
    v_exp_f32 v26, v110
    v_mfma_f32_16x16x32_bf16 a[48:51], a[240:243], v[132:135], a[48:51]
    v_cvt_pk_bf16_f32 v150, v24, v25
    v_exp_f32 v27, v111
    v_mfma_f32_16x16x32_bf16 a[20:23], a[244:247], v[128:131], a[20:23]
    ds_read_b128 a[208:211], v6 offset:12288
    v_cvt_pk_bf16_f32 v151, v26, v27
    v_mfma_f32_16x16x32_bf16 a[52:55], a[244:247], v[132:135], a[52:55]
    s_add_u32 m0, s59, 16384
    ds_read_b128 a[212:215], v6 offset:13312
    v_mfma_f32_16x16x32_bf16 v[32:35], v[44:47], v[148:151], 0
    s_nop 2
    v_mfma_f32_16x16x32_bf16 a[24:27], a[248:251], v[128:131], a[24:27]
    buffer_load_dwordx4 v7, s[28:31], s57 offen offset:0 sc1 lds
    v_mfma_f32_16x16x32_bf16 a[56:59], a[248:251], v[132:135], a[56:59]
    ds_read_b128 a[216:219], v6 offset:14336
    s_nop 0
    v_mfma_f32_16x16x32_bf16 a[28:31], a[252:255], v[128:131], a[28:31]
    ds_read_b128 a[220:223], v6 offset:15360
    v_max_f32 v8, v28, v32
    v_cmp_nge_f32 vcc, s66, v8
    v_mfma_f32_16x16x32_bf16 a[60:63], a[252:255], v[132:135], a[60:63]
    s_waitcnt lgkmcnt(4)
    s_cbranch_vccnz m_stub102
m_ret103:
    v_mfma_f32_16x16x32_bf16 v[96:99], a[192:195], a[128:131], v[160:163]
    s_add_u32 s59, s58, s60
    v_exp_f32 v20, v64
    v_mfma_f32_16x16x32_bf16 v[96:99], a[196:199], a[132:135], v[96:99]
    s_add_u32 s58, s58, 32768
    ds_read_b128 a[224:227], v6 offset:24576
    v_add_f32 v12, v12, v28
    v_mfma_f32_16x16x32_bf16 v[96:99], a[200:203], a[136:139], v[96:99]
    s_cmp_ge_u32 s58, 163840
    s_cselect_b32 s58, 0, s58
    ds_read_b128 a[228:231], v6 offset:25600
    v_exp_f32 v21, v65
    v_mfma_f32_16x16x32_bf16 v[96:99], a[204:207], a[140:143], v[96:99]
    s_bitcmp1_b64 s[62:63], s64
    s_cselect_b32 s66, -1.0, s65
    ds_read_b128 a[232:235], v6 offset:26624
    v_mfma_f32_16x16x32_bf16 v[104:107], a[192:195], a[144:147], v[168:171]
    buffer_load_dwordx4 v7, s[28:31], s57 offen offset:1024 sc1 lds
    v_mfma_f32_16x16x32_bf16 v[104:107], a[196:199], a[148:151], v[104:107]
    s_add_u32 s64, s64, 1
    ds_read_b128 a[236:239], v6 offset:27648
    v_cvt_pk_bf16_f32 v128, v20, v21
    v_mfma_f32_16x16x32_bf16 v[104:107], a[200:203], a[152:155], v[104:107]
    ds_read_b128 a[240:243], v6 offset:28672
    v_exp_f32 v22, v66
    v_mfma_f32_16x16x32_bf16 v[104:107], a[204:207], a[156:159], v[104:107]
    s_waitcnt lgkmcnt(5)
    ds_read_b128 a[244:247], v6 offset:29696
    v_add_f32 v13, v13, v32
    v_mfma_f32_16x16x32_bf16 v[100:103], a[208:211], a[128:131], v[164:167]
    ds_read_b128 a[248:251], v6 offset:30720
    v_exp_f32 v23, v67
    v_mfma_f32_16x16x32_bf16 v[100:103], a[212:215], a[132:135], v[100:103]
    buffer_load_dwordx4 v7, s[28:31], s57 offen offset:2048 sc1 lds
    v_mfma_f32_16x16x32_bf16 v[100:103], a[216:219], a[136:139], v[100:103]
    ds_read_b128 a[252:255], v6 offset:31744
    v_cvt_pk_bf16_f32 v129, v22, v23
    v_mfma_f32_16x16x32_bf16 v[100:103], a[220:223], a[140:143], v[100:103]
    v_exp_f32 v24, v68
    v_mfma_f32_16x16x32_bf16 v[108:111], a[208:211], a[144:147], v[172:175]
    v_exp_f32 v25, v69
    v_mfma_f32_16x16x32_bf16 v[108:111], a[212:215], a[148:151], v[108:111]
    buffer_load_dwordx4 v7, s[28:31], s57 offen offset:3072 sc1 lds
    v_mfma_f32_16x16x32_bf16 v[108:111], a[216:219], a[152:155], v[108:111]
    s_add_u32 s57, s57, 16384
    v_exp_f32 v26, v70
    v_cvt_pk_bf16_f32 v130, v24, v25
    v_mfma_f32_16x16x32_bf16 v[108:111], a[220:223], a[156:159], v[108:111]
    s_waitcnt vmcnt(24) lgkmcnt(0)
    v_add_u32 v6, s58, v2
    v_exp_f32 v27, v71
    v_mfma_f32_16x16x32_bf16 a[0:3], a[224:227], v[144:147], a[0:3]
    s_barrier
    v_mfma_f32_16x16x32_bf16 a[32:35], a[224:227], v[148:151], a[32:35]
    ds_read_b128 a[192:195], v6 offset:0
    v_cvt_pk_bf16_f32 v131, v26, v27
    v_mfma_f32_16x16x32_bf16 a[4:7], a[228:231], v[144:147], a[4:7]
    v_exp_f32 v20, v72
    v_mfma_f32_16x16x32_bf16 v[28:31], v[44:47], v[128:131], 0
    v_exp_f32 v21, v73
    v_mfma_f32_16x16x32_bf16 a[36:39], a[228:231], v[148:151], a[36:39]
    ds_read_b128 a[196:199], v6 offset:1024
    v_cvt_pk_bf16_f32 v132, v20, v21
    v_mfma_f32_16x16x32_bf16 a[8:11], a[232:235], v[144:147], a[8:11]
    v_exp_f32 v22, v74
    v_mfma_f32_16x16x32_bf16 a[40:43], a[232:235], v[148:151], a[40:43]
    ds_read_b128 a[200:203], v6 offset:2048
    v_exp_f32 v23, v75
    v_mfma_f32_16x16x32_bf16 a[12:15], a[236:239], v[144:147], a[12:15]
    v_exp_f32 v24, v76
    v_mfma_f32_16x16x32_bf16 a[44:47], a[236:239], v[148:151], a[44:47]
    ds_read_b128 a[204:207], v6 offset:3072
    v_cvt_pk_bf16_f32 v133, v22, v23
    v_mfma_f32_16x16x32_bf16 a[16:19], a[240:243], v[144:147], a[16:19]
    v_exp_f32 v25, v77
    v_mfma_f32_16x16x32_bf16 a[48:51], a[240:243], v[148:151], a[48:51]
    v_exp_f32 v26, v78
    v_cvt_pk_bf16_f32 v134, v24, v25
    v_mfma_f32_16x16x32_bf16 a[20:23], a[244:247], v[144:147], a[20:23]
    v_exp_f32 v27, v79
    v_mfma_f32_16x16x32_bf16 a[52:55], a[244:247], v[148:151], a[52:55]
    ds_read_b128 a[208:211], v6 offset:4096
    v_cvt_pk_bf16_f32 v135, v26, v27
    s_nop 1
    v_mfma_f32_16x16x32_bf16 v[32:35], v[44:47], v[132:135], 0
    s_nop 2
    v_mfma_f32_16x16x32_bf16 a[24:27], a[248:251], v[144:147], a[24:27]
    ds_read_b128 a[212:215], v6 offset:5120
    s_nop 0
    v_mfma_f32_16x16x32_bf16 a[56:59], a[248:251], v[148:151], a[56:59]
    ds_read_b128 a[216:219], v6 offset:6144
    v_max_f32 v8, v28, v32
    v_mfma_f32_16x16x32_bf16 a[28:31], a[252:255], v[144:147], a[28:31]
    ds_read_b128 a[220:223], v6 offset:7168
    v_cmp_nge_f32 vcc, s66, v8
    v_mfma_f32_16x16x32_bf16 a[60:63], a[252:255], v[148:151], a[60:63]
    s_waitcnt lgkmcnt(4)
    s_cbranch_vccz m_single101
    v_cmp_lt_f32 vcc, s65, v8
    s_cmp_lg_u32 s64, s70
    s_cbranch_scc1 m_e105
    v_add_f32 v160, v160, v16
    v_mov_b32 v164, v9
    v_add_f32 v172, v172, v16
    v_add_f32 v161, v161, v17
    v_mov_b32 v165, v9
    v_add_f32 v173, v173, v17
    v_add_f32 v162, v162, v18
    v_mov_b32 v166, v9
    v_add_f32 v174, v174, v18
    v_add_f32 v163, v163, v19
    v_mov_b32 v167, v9
    v_add_f32 v175, v175, v19
    s_nop 0
m_e105:
    s_cmp_lg_u32 s64, s71
    s_cbranch_scc1 m_e106
    v_mov_b32 v160, v9
    v_mov_b32 v168, v9
    v_mov_b32 v172, v9
    v_mov_b32 v161, v9
    v_mov_b32 v169, v9
    v_mov_b32 v173, v9
    v_mov_b32 v162, v9
    v_mov_b32 v170, v9
    v_mov_b32 v174, v9
    v_mov_b32 v163, v9
    v_mov_b32 v171, v9
    v_mov_b32 v175, v9
    s_nop 0
m_e106:
    s_cmp_lg_u32 s64, s53
    s_cbranch_scc1 m_e109
    s_cmp_lg_u32 s16, 0
    s_cbranch_scc1 m_np110
    v_mov_b32 v60, s4
    v_mov_b32 v61, s5
    s_add_u32 s90, s101, 117440512
    s_mov_b64 exec, 1
    buffer_store_dwordx2 v[60:61], off, s[8:11], s90 sc1
    s_mov_b64 exec, -1
m_np110:
    s_mov_b32 s101, -1
m_e109:
    s_cmp_gt_u32 s64, 24
    s_cbranch_scc1 m_e107
    s_cmp_lg_u32 s64, 8
    s_cbranch_scc1 m_e111
    s_lshr_b32 s90, s32, 1
    s_lshl_b32 s90, s90, 7
    s_add_u32 s90, s90, 117440600
    v_min_u32 v0, 1, v1
    v_lshlrev_b32 v0, 5, v0
    buffer_load_dwordx2 v[4:5], v0, s[8:11], s90 offen sc1
    s_cmp_eq_u32 s17, -1
    s_cbranch_scc1 m_e107
    s_cmp_lg_u32 s16, 0
    s_cbranch_scc1 m_np112
    v_mov_b32 v60, s4
    v_mov_b32 v61, s5
    s_add_u32 s90, s17, 117440512
    s_mov_b64 exec, 1
    buffer_store_dwordx2 v[60:61], off, s[8:11], s90 sc1
    s_mov_b64 exec, -1
m_np112:
    s_branch m_e107
m_e111:
    s_cmp_lg_u32 s64, 16
    s_cbranch_scc1 m_e113
    s_waitcnt vmcnt(18)
    s_mov_b32 s3, 1048576
m_spin114:
    v_cmp_ne_u64 s[76:77], s[4:5], v[4:5]
    s_nop 3
    s_cmp_eq_u64 s[76:77], 0
    s_cbranch_scc1 m_e107
    s_sub_u32 s3, s3, 1
    s_cbranch_scc1 m_e107
    s_sleep 32
    s_lshr_b32 s90, s32, 1
    s_lshl_b32 s90, s90, 7
    s_add_u32 s90, s90, 117440600
    v_min_u32 v0, 1, v1
    v_lshlrev_b32 v0, 5, v0
    buffer_load_dwordx2 v[4:5], v0, s[8:11], s90 offen sc1
    s_waitcnt vmcnt(0)
    s_branch m_spin114
    s_branch m_e107
m_e113:
    s_cmp_lg_u32 s64, 20
    s_cbranch_scc1 m_e115
    buffer_load_dwordx2 v[4:5], v10, s[8:11], 0 offen sc1
    s_mov_b32 s44, s48
    s_mov_b32 s45, s49
    s_mov_b32 s46, 8388608
    s_lshl_b32 s90, s2, 2
    s_add_u32 s90, s90, s16
    s_lshl_b32 s90, s90, 13
    v_lshlrev_b32 v62, 7, v1
    buffer_load_dword v255, v62, s[44:47], s90 offen
    s_branch m_e107
m_e115:
    s_cmp_lg_u32 s64, 24
    s_cbranch_scc1 m_e116
    s_mov_b32 s44, s50
    s_mov_b32 s45, s51
    s_mov_b32 s46, 2097152
    s_lshl_b32 s90, s2, 2
    s_add_u32 s90, s90, s16
    s_lshl_b32 s90, s90, 13
    v_lshlrev_b32 v62, 7, v1
    buffer_load_dword v255, v62, s[44:47], s90 offen
    s_waitcnt vmcnt(18)
    s_mov_b32 s3, 1048576
m_spin117:
    v_cmp_ne_u64 s[76:77], s[4:5], v[4:5]
    s_nop 3
    s_cmp_eq_u64 s[76:77], 0
    s_cbranch_scc1 m_e107
    s_sub_u32 s3, s3, 1
    s_cbranch_scc1 m_e107
    s_sleep 32
    buffer_load_dwordx2 v[4:5], v10, s[8:11], 0 offen sc1
    s_waitcnt vmcnt(0)
    s_branch m_spin117
    s_branch m_e107
m_e116:
m_e107:
    s_cbranch_vccnz m_rc118
m_sp104:
    s_cmp_lg_u32 s64, s72
    s_cbranch_scc1 m_single101
    s_bfe_u32 s95, s2, 0x10002
    s_and_b32 s90, s2, 7
    s_bitcmp1_b32 0x63, s90
    s_cselect_b32 s96, s33, s34
    s_sub_u32 s96, s96, 1
    s_and_b32 s90, s2, 1
    s_lshl_b32 s90, s90, 2
    s_bfe_u32 s91, s2, 0x20003
    s_add_u32 s97, s90, s91
    v_and_b32 v10, 31, v1
    v_lshlrev_b32 v10, 3, v10
    s_lshl_b32 s52, s96, 8
    s_add_u32 s52, s52, 117448704
    buffer_load_dwordx2 v[4:5], v10, s[8:11], s52 offen sc1
    ds_read_b128 a[224:227], v6 offset:16384
    ds_read_b128 a[228:231], v6 offset:17408
    ds_read_b128 a[232:235], v6 offset:18432
    ds_read_b128 a[236:239], v6 offset:19456
    ds_read_b128 a[240:243], v6 offset:20480
    ds_read_b128 a[244:247], v6 offset:21504
    ds_read_b128 a[248:251], v6 offset:22528
    ds_read_b128 a[252:255], v6 offset:23552
    s_waitcnt lgkmcnt(0)
    v_mfma_f32_16x16x32_bf16 a[0:3], a[224:227], v[128:131], a[0:3]
    buffer_load_dwordx4 v[192:195], v2, s[8:11], s83 offen offset:0 sc1
    v_exp_f32 v20, v96
    v_mfma_f32_16x16x32_bf16 a[32:35], a[224:227], v[132:135], a[32:35]
    v_exp_f32 v21, v97
    v_exp_f32 v22, v98
    v_mfma_f32_16x16x32_bf16 a[4:7], a[228:231], v[128:131], a[4:7]
    buffer_load_dwordx4 v[196:199], v2, s[8:11], s83 offen offset:1024 sc1
    v_cvt_pk_bf16_f32 v144, v20, v21
    v_add_f32 v12, v12, v28
    v_mfma_f32_16x16x32_bf16 a[36:39], a[228:231], v[132:135], a[36:39]
    v_exp_f32 v23, v99
    v_exp_f32 v24, v100
    v_cvt_pk_bf16_f32 v145, v22, v23
    v_mfma_f32_16x16x32_bf16 a[8:11], a[232:235], v[128:131], a[8:11]
    buffer_load_dwordx4 v[200:203], v2, s[8:11], s83 offen offset:2048 sc1
    v_exp_f32 v25, v101
    v_mfma_f32_16x16x32_bf16 a[40:43], a[232:235], v[132:135], a[40:43]
    v_exp_f32 v26, v102
    v_cvt_pk_bf16_f32 v146, v24, v25
    v_add_f32 v13, v13, v32
    v_mfma_f32_16x16x32_bf16 a[12:15], a[236:239], v[128:131], a[12:15]
    buffer_load_dwordx4 v[204:207], v2, s[8:11], s83 offen offset:3072 sc1
    v_exp_f32 v27, v103
    v_mfma_f32_16x16x32_bf16 a[44:47], a[236:239], v[132:135], a[44:47]
    v_exp_f32 v20, v104
    v_cvt_pk_bf16_f32 v147, v26, v27
    v_mfma_f32_16x16x32_bf16 a[16:19], a[240:243], v[128:131], a[16:19]
    buffer_load_dwordx4 v[212:215], v2, s[8:11], s84 offen offset:0 sc1
    v_exp_f32 v21, v105
    v_mfma_f32_16x16x32_bf16 v[28:31], v[44:47], v[144:147], 0
    v_exp_f32 v22, v106
    v_cvt_pk_bf16_f32 v148, v20, v21
    v_exp_f32 v23, v107
    v_mfma_f32_16x16x32_bf16 a[48:51], a[240:243], v[132:135], a[48:51]
    v_exp_f32 v24, v108
    v_cvt_pk_bf16_f32 v149, v22, v23
    v_exp_f32 v25, v109
    v_mfma_f32_16x16x32_bf16 a[20:23], a[244:247], v[128:131], a[20:23]
    buffer_load_dwordx4 v[216:219], v2, s[8:11], s84 offen offset:1024 sc1
    v_exp_f32 v26, v110
    v_mfma_f32_16x16x32_bf16 a[52:55], a[244:247], v[132:135], a[52:55]
    v_cvt_pk_bf16_f32 v150, v24, v25
    v_exp_f32 v27, v111
    s_nop 0
    v_cvt_pk_bf16_f32 v151, v26, v27
    s_nop 1
    v_mfma_f32_16x16x32_bf16 v[32:35], v[44:47], v[148:151], 0
    s_nop 2
    v_mfma_f32_16x16x32_bf16 a[24:27], a[248:251], v[128:131], a[24:27]
    buffer_load_dwordx4 v[220:223], v2, s[8:11], s84 offen offset:2048 sc1
    v_mfma_f32_16x16x32_bf16 a[56:59], a[248:251], v[132:135], a[56:59]
    s_nop 2
    v_mfma_f32_16x16x32_bf16 a[28:31], a[252:255], v[128:131], a[28:31]
    v_max_f32 v8, v28, v32
    v_cmp_nge_f32 vcc, s65, v8
    v_mfma_f32_16x16x32_bf16 a[60:63], a[252:255], v[132:135], a[60:63]
    s_cbranch_vccnz m_stub119
m_ret120:
    s_nop 1
    ds_read_b128 a[224:227], v6 offset:24576
    ds_read_b128 a[228:231], v6 offset:25600
    ds_read_b128 a[232:235], v6 offset:26624
    ds_read_b128 a[236:239], v6 offset:27648
    ds_read_b128 a[240:243], v6 offset:28672
    ds_read_b128 a[244:247], v6 offset:29696
    ds_read_b128 a[248:251], v6 offset:30720
    ds_read_b128 a[252:255], v6 offset:31744
    s_waitcnt lgkmcnt(0)
    v_mfma_f32_16x16x32_bf16 a[0:3], a[224:227], v[144:147], a[0:3]
    buffer_load_dwordx4 v[224:227], v2, s[8:11], s84 offen offset:3072 sc1
    v_mfma_f32_16x16x32_bf16 a[32:35], a[224:227], v[148:151], a[32:35]
    v_mfma_f32_16x16x32_bf16 a[4:7], a[228:231], v[144:147], a[4:7]
    buffer_load_dwordx4 v[208:211], v2, s[8:11], s85 offen offset:0 sc1
    v_mfma_f32_16x16x32_bf16 a[36:39], a[228:231], v[148:151], a[36:39]
    v_mfma_f32_16x16x32_bf16 a[8:11], a[232:235], v[144:147], a[8:11]
    buffer_load_dwordx4 v[232:235], v2, s[8:11], s86 offen offset:0 sc1
    v_mfma_f32_16x16x32_bf16 a[40:43], a[232:235], v[148:151], a[40:43]
    v_mfma_f32_16x16x32_bf16 a[12:15], a[236:239], v[144:147], a[12:15]
    buffer_load_dwordx4 v[236:239], v2, s[8:11], s86 offen offset:1024 sc1
    v_mfma_f32_16x16x32_bf16 a[44:47], a[236:239], v[148:151], a[44:47]
    v_mfma_f32_16x16x32_bf16 a[16:19], a[240:243], v[144:147], a[16:19]
    buffer_load_dwordx4 v[228:231], v2, s[8:11], s87 offen offset:0 sc1
    v_mfma_f32_16x16x32_bf16 a[48:51], a[240:243], v[148:151], a[48:51]
    v_mfma_f32_16x16x32_bf16 a[20:23], a[244:247], v[144:147], a[20:23]
    buffer_load_dwordx4 v[244:247], v2, s[8:11], s88 offen offset:0 sc1
    v_mfma_f32_16x16x32_bf16 a[52:55], a[244:247], v[148:151], a[52:55]
    v_mfma_f32_16x16x32_bf16 a[24:27], a[248:251], v[144:147], a[24:27]
    buffer_load_dwordx4 v[248:251], v2, s[8:11], s88 offen offset:1024 sc1
    v_mfma_f32_16x16x32_bf16 a[56:59], a[248:251], v[148:151], a[56:59]
    v_mfma_f32_16x16x32_bf16 a[28:31], a[252:255], v[144:147], a[28:31]
    buffer_load_dwordx4 v[240:243], v2, s[8:11], s89 offen offset:0 sc1
    v_mfma_f32_16x16x32_bf16 a[60:63], a[252:255], v[148:151], a[60:63]
    s_barrier
    v_add_f32 v20, v12, v28
    v_add_f32 v21, v13, v32
    s_nop 3
    v_rcp_f32 v20, v20
    v_rcp_f32 v21, v21
    s_lshl_b32 s90, s78, 10
    s_add_u32 s90, s90, s82
    s_add_u32 s90, s90, 67108864
    v_accvgpr_read_b32 v48, a0
    v_accvgpr_read_b32 v49, a1
    v_accvgpr_read_b32 v50, a2
    v_accvgpr_read_b32 v51, a3
    v_accvgpr_read_b32 v52, a4
    v_accvgpr_read_b32 v53, a5
    v_accvgpr_read_b32 v54, a6
    v_accvgpr_read_b32 v55, a7
    v_mul_f32 v48, v20, v48
    v_mul_f32 v49, v20, v49
    v_mul_f32 v50, v20, v50
    v_mul_f32 v51, v20, v51
    v_mul_f32 v52, v20, v52
    v_mul_f32 v53, v20, v53
    v_mul_f32 v54, v20, v54
    v_mul_f32 v55, v20, v55
    v_cvt_pk_bf16_f32 v48, v48, v49
    v_cvt_pk_bf16_f32 v49, v50, v51
    v_cvt_pk_bf16_f32 v50, v52, v53
    v_cvt_pk_bf16_f32 v51, v54, v55
    buffer_store_dwordx4 v[48:51], v2, s[8:11], s90 offen offset:0 sc1
    v_accvgpr_read_b32 v56, a32
    v_accvgpr_read_b32 v57, a33
    v_accvgpr_read_b32 v58, a34
    v_accvgpr_read_b32 v59, a35
    v_accvgpr_read_b32 v60, a36
    v_accvgpr_read_b32 v61, a37
    v_accvgpr_read_b32 v62, a38
    v_accvgpr_read_b32 v63, a39
    v_mul_f32 v56, v21, v56
    v_mul_f32 v57, v21, v57
    v_mul_f32 v58, v21, v58
    v_mul_f32 v59, v21, v59
    v_mul_f32 v60, v21, v60
    v_mul_f32 v61, v21, v61
    v_mul_f32 v62, v21, v62
    v_mul_f32 v63, v21, v63
    v_cvt_pk_bf16_f32 v56, v56, v57
    v_cvt_pk_bf16_f32 v57, v58, v59
    v_cvt_pk_bf16_f32 v58, v60, v61
    v_cvt_pk_bf16_f32 v59, v62, v63
    buffer_store_dwordx4 v[56:59], v2, s[8:11], s90 offen offset:1024 sc1
    s_add_u32 s90, s90, 131072
    v_accvgpr_read_b32 v48, a8
    v_accvgpr_read_b32 v49, a9
    v_accvgpr_read_b32 v50, a10
    v_accvgpr_read_b32 v51, a11
    v_accvgpr_read_b32 v52, a12
    v_accvgpr_read_b32 v53, a13
    v_accvgpr_read_b32 v54, a14
    v_accvgpr_read_b32 v55, a15
    v_mul_f32 v48, v20, v48
    v_mul_f32 v49, v20, v49
    v_mul_f32 v50, v20, v50
    v_mul_f32 v51, v20, v51
    v_mul_f32 v52, v20, v52
    v_mul_f32 v53, v20, v53
    v_mul_f32 v54, v20, v54
    v_mul_f32 v55, v20, v55
    v_cvt_pk_bf16_f32 v48, v48, v49
    v_cvt_pk_bf16_f32 v49, v50, v51
    v_cvt_pk_bf16_f32 v50, v52, v53
    v_cvt_pk_bf16_f32 v51, v54, v55
    buffer_store_dwordx4 v[48:51], v2, s[8:11], s90 offen offset:0 sc1
    v_accvgpr_read_b32 v56, a40
    v_accvgpr_read_b32 v57, a41
    v_accvgpr_read_b32 v58, a42
    v_accvgpr_read_b32 v59, a43
    v_accvgpr_read_b32 v60, a44
    v_accvgpr_read_b32 v61, a45
    v_accvgpr_read_b32 v62, a46
    v_accvgpr_read_b32 v63, a47
    v_mul_f32 v56, v21, v56
    v_mul_f32 v57, v21, v57
    v_mul_f32 v58, v21, v58
    v_mul_f32 v59, v21, v59
    v_mul_f32 v60, v21, v60
    v_mul_f32 v61, v21, v61
    v_mul_f32 v62, v21, v62
    v_mul_f32 v63, v21, v63
    v_cvt_pk_bf16_f32 v56, v56, v57
    v_cvt_pk_bf16_f32 v57, v58, v59
    v_cvt_pk_bf16_f32 v58, v60, v61
    v_cvt_pk_bf16_f32 v59, v62, v63
    buffer_store_dwordx4 v[56:59], v2, s[8:11], s90 offen offset:1024 sc1
    s_add_u32 s90, s90, 131072
    v_accvgpr_read_b32 v48, a16
    v_accvgpr_read_b32 v49, a17
    v_accvgpr_read_b32 v50, a18
    v_accvgpr_read_b32 v51, a19
    v_accvgpr_read_b32 v52, a20
    v_accvgpr_read_b32 v53, a21
    v_accvgpr_read_b32 v54, a22
    v_accvgpr_read_b32 v55, a23
    v_mul_f32 v48, v20, v48
    v_mul_f32 v49, v20, v49
    v_mul_f32 v50, v20, v50
    v_mul_f32 v51, v20, v51
    v_mul_f32 v52, v20, v52
    v_mul_f32 v53, v20, v53
    v_mul_f32 v54, v20, v54
    v_mul_f32 v55, v20, v55
    v_cvt_pk_bf16_f32 v48, v48, v49
    v_cvt_pk_bf16_f32 v49, v50, v51
    v_cvt_pk_bf16_f32 v50, v52, v53
    v_cvt_pk_bf16_f32 v51, v54, v55
    buffer_store_dwordx4 v[48:51], v2, s[8:11], s90 offen offset:0 sc1
    v_accvgpr_read_b32 v56, a48
    v_accvgpr_read_b32 v57, a49
    v_accvgpr_read_b32 v58, a50
    v_accvgpr_read_b32 v59, a51
    v_accvgpr_read_b32 v60, a52
    v_accvgpr_read_b32 v61, a53
    v_accvgpr_read_b32 v62, a54
    v_accvgpr_read_b32 v63, a55
    v_mul_f32 v56, v21, v56
    v_mul_f32 v57, v21, v57
    v_mul_f32 v58, v21, v58
    v_mul_f32 v59, v21, v59
    v_mul_f32 v60, v21, v60
    v_mul_f32 v61, v21, v61
    v_mul_f32 v62, v21, v62
    v_mul_f32 v63, v21, v63
    v_cvt_pk_bf16_f32 v56, v56, v57
    v_cvt_pk_bf16_f32 v57, v58, v59
    v_cvt_pk_bf16_f32 v58, v60, v61
    v_cvt_pk_bf16_f32 v59, v62, v63
    buffer_store_dwordx4 v[56:59], v2, s[8:11], s90 offen offset:1024 sc1
    s_add_u32 s90, s90, 131072
    v_accvgpr_read_b32 v48, a24
    v_accvgpr_read_b32 v49, a25
    v_accvgpr_read_b32 v50, a26
    v_accvgpr_read_b32 v51, a27
    v_accvgpr_read_b32 v52, a28
    v_accvgpr_read_b32 v53, a29
    v_accvgpr_read_b32 v54, a30
    v_accvgpr_read_b32 v55, a31
    v_mul_f32 v48, v20, v48
    v_mul_f32 v49, v20, v49
    v_mul_f32 v50, v20, v50
    v_mul_f32 v51, v20, v51
    v_mul_f32 v52, v20, v52
    v_mul_f32 v53, v20, v53
    v_mul_f32 v54, v20, v54
    v_mul_f32 v55, v20, v55
    v_cvt_pk_bf16_f32 v48, v48, v49
    v_cvt_pk_bf16_f32 v49, v50, v51
    v_cvt_pk_bf16_f32 v50, v52, v53
    v_cvt_pk_bf16_f32 v51, v54, v55
    buffer_store_dwordx4 v[48:51], v2, s[8:11], s90 offen offset:0 sc1
    v_accvgpr_read_b32 v56, a56
    v_accvgpr_read_b32 v57, a57
    v_accvgpr_read_b32 v58, a58
    v_accvgpr_read_b32 v59, a59
    v_accvgpr_read_b32 v60, a60
    v_accvgpr_read_b32 v61, a61
    v_accvgpr_read_b32 v62, a62
    v_accvgpr_read_b32 v63, a63
    v_mul_f32 v56, v21, v56
    v_mul_f32 v57, v21, v57
    v_mul_f32 v58, v21, v58
    v_mul_f32 v59, v21, v59
    v_mul_f32 v60, v21, v60
    v_mul_f32 v61, v21, v61
    v_mul_f32 v62, v21, v62
    v_mul_f32 v63, v21, v63
    v_cvt_pk_bf16_f32 v56, v56, v57
    v_cvt_pk_bf16_f32 v57, v58, v59
    v_cvt_pk_bf16_f32 v58, v60, v61
    v_cvt_pk_bf16_f32 v59, v62, v63
    buffer_store_dwordx4 v[56:59], v2, s[8:11], s90 offen offset:1024 sc1
    s_add_u32 s90, s90, 131072
    s_lshr_b32 s53, s16, 1
    s_and_b32 s40, s16, 1
    s_mul_i32 s90, s95, 5242880
    s_lshl_b32 s57, s97, 8
    s_add_u32 s57, s57, s90
    v_lshrrev_b32 v20, 4, v1
    s_lshl_b32 s90, s16, 4
    v_add_u32 v21, s90, v20
    v_lshlrev_b32 v21, 11, v21
    v_lshlrev_b32 v20, 1, v20
    v_and_b32 v22, 15, v1
    v_xor_b32 v20, v20, v22
    v_xor_b32 v22, 0, v20
    v_lshl_add_u32 v16, v22, 4, v21
    v_xor_b32 v22, 8, v20
    v_lshl_add_u32 v17, v22, 4, v21
    v_add_u32 v17, 7168, v17
    v_xor_b32 v22, 0, v20
    v_lshl_add_u32 v18, v22, 4, v21
    v_add_u32 v18, 14336, v18
    v_xor_b32 v22, 8, v20
    v_lshl_add_u32 v19, v22, 4, v21
    v_add_u32 v19, 21504, v19
    s_mov_b32 s24, s48
    s_mov_b32 s25, s49
    s_mov_b32 s26, 8388608
    s_mov_b32 s38, 268435456
    s_mov_b32 s28, s54
    s_mov_b32 s29, s55
    s_mov_b32 s30, 8388608
    s_lshl_b32 s90, s96, 13
    s_lshl_b32 s91, s40, 12
    s_add_u32 s90, s90, s91
    s_lshl_b32 s91, s53, 17
    s_add_u32 s69, s90, s91
    s_mul_i32 s90, s95, 10485760
    s_add_u32 s56, s69, s90
    s_add_u32 s56, s56, 67108864
    s_add_u32 s69, s69, 83886080
    s_add_u32 m0, s60, 16384
    s_nop 0
    buffer_load_dwordx4 v16, s[24:27], s57 offen offset:0 sc1 lds
    buffer_load_dwordx4 v17, s[24:27], s57 offen offset:1024 sc1 lds
    buffer_load_dwordx4 v18, s[24:27], s57 offen offset:2048 sc1 lds
    buffer_load_dwordx4 v19, s[24:27], s57 offen offset:3072 sc1 lds
    s_add_u32 s57, s57, 131072
    s_add_u32 m0, s60, 49152
    s_nop 0
    buffer_load_dwordx4 v16, s[24:27], s57 offen offset:0 sc1 lds
    buffer_load_dwordx4 v17, s[24:27], s57 offen offset:1024 sc1 lds
    buffer_load_dwordx4 v18, s[24:27], s57 offen offset:2048 sc1 lds
    buffer_load_dwordx4 v19, s[24:27], s57 offen offset:3072 sc1 lds
    s_add_u32 s57, s57, 131072
    s_add_u32 m0, s60, 81920
    s_nop 0
    buffer_load_dwordx4 v16, s[24:27], s57 offen offset:0 sc1 lds
    buffer_load_dwordx4 v17, s[24:27], s57 offen offset:1024 sc1 lds
    buffer_load_dwordx4 v18, s[24:27], s57 offen offset:2048 sc1 lds
    buffer_load_dwordx4 v19, s[24:27], s57 offen offset:3072 sc1 lds
    s_add_u32 s57, s57, 131072
    s_add_u32 m0, s60, 114688
    s_nop 0
    buffer_load_dwordx4 v16, s[24:27], s57 offen offset:0 sc1 lds
    buffer_load_dwordx4 v17, s[24:27], s57 offen offset:1024 sc1 lds
    buffer_load_dwordx4 v18, s[24:27], s57 offen offset:2048 sc1 lds
    buffer_load_dwordx4 v19, s[24:27], s57 offen offset:3072 sc1 lds
    s_add_u32 s57, s57, 131072
    s_waitcnt vmcnt(39)
    v_cmp_ne_u64 s[76:77], s[4:5], v[4:5]
    s_mul_i32 s91, s95, 20
    s_nop 2
    s_lshr_b32 s90, s76, s91
    s_ff1_i32_b32 s90, s90
    s_lshl_b32 s68, s90, 1
    s_mul_i32 s91, s95, 0
    s_sub_i32 s68, s68, s91
    s_cmp_lt_i32 s90, 0
    s_cselect_b32 s68, 1000, s68
    s_mov_b32 s99, 0
    s_cmp_gt_i32 s68, 4
    s_cbranch_scc0 m_x1121
    s_mov_b32 s99, 1
    s_add_u32 m0, s60, 0
    s_nop 0
    buffer_load_dwordx4 v2, s[36:39], s56 offen offset:0 sc1 lds
    buffer_load_dwordx4 v2, s[36:39], s56 offen offset:1024 sc1 lds
    buffer_load_dwordx4 v2, s[36:39], s56 offen offset:2048 sc1 lds
    buffer_load_dwordx4 v2, s[36:39], s56 offen offset:3072 sc1 lds
    s_add_u32 s56, s56, 262144
    s_add_u32 m0, s60, 32768
    s_nop 0
    buffer_load_dwordx4 v2, s[36:39], s56 offen offset:0 sc1 lds
    buffer_load_dwordx4 v2, s[36:39], s56 offen offset:1024 sc1 lds
    buffer_load_dwordx4 v2, s[36:39], s56 offen offset:2048 sc1 lds
    buffer_load_dwordx4 v2, s[36:39], s56 offen offset:3072 sc1 lds
    s_add_u32 s56, s56, 262144
    s_add_u32 m0, s60, 65536
    s_nop 0
    buffer_load_dwordx4 v2, s[36:39], s56 offen offset:0 sc1 lds
    buffer_load_dwordx4 v2, s[36:39], s56 offen offset:1024 sc1 lds
    buffer_load_dwordx4 v2, s[36:39], s56 offen offset:2048 sc1 lds
    buffer_load_dwordx4 v2, s[36:39], s56 offen offset:3072 sc1 lds
    s_add_u32 s56, s56, 262144
    s_add_u32 m0, s60, 98304
    s_nop 0
    buffer_load_dwordx4 v2, s[36:39], s56 offen offset:0 sc1 lds
    buffer_load_dwordx4 v2, s[36:39], s56 offen offset:1024 sc1 lds
    buffer_load_dwordx4 v2, s[36:39], s56 offen offset:2048 sc1 lds
    buffer_load_dwordx4 v2, s[36:39], s56 offen offset:3072 sc1 lds
    s_add_u32 s56, s56, 262144
    s_add_u32 m0, s60, 131072
    s_nop 0
    buffer_load_dwordx4 v2, s[36:39], s56 offen offset:0 sc1 lds
    buffer_load_dwordx4 v2, s[36:39], s56 offen offset:1024 sc1 lds
    buffer_load_dwordx4 v2, s[36:39], s56 offen offset:2048 sc1 lds
    buffer_load_dwordx4 v2, s[36:39], s56 offen offset:3072 sc1 lds
    s_add_u32 s56, s56, 262144
m_x1121:
    s_lshl_b32 s90, s53, 12
    v_add_u32 v6, s90, v2
    v_lshrrev_b32 v48, 2, v1
    v_lshlrev_b32 v48, 8, v48
    v_and_b32 v49, 3, v1
    v_lshl_add_u32 v48, v49, 3, v48
    v_add_u32 v48, 16384, v48
    v_bfe_u32 v49, v1, 2, 3
    s_lshl_b32 s90, s40, 2
    v_xor_b32 v49, s90, v49
    v_xor_b32 v50, 0, v49
    v_lshl_add_u32 v12, v50, 5, v48
    v_xor_b32 v50, 1, v49
    v_lshl_add_u32 v13, v50, 5, v48
    v_xor_b32 v50, 2, v49
    v_lshl_add_u32 v14, v50, 5, v48
    v_xor_b32 v50, 3, v49
    v_lshl_add_u32 v15, v50, 5, v48
    v_and_b32 v48, 15, v1
    v_lshlrev_b32 v48, 12, v48
    v_lshlrev_b32 v48, s95, v48
    v_bfe_u32 v49, v1, 4, 1
    v_lshl_add_u32 v48, v49, 5, v48
    v_lshrrev_b32 v49, 5, v1
    v_lshl_add_u32 v7, v49, 4, v48
    s_lshl_b32 s90, s96, 3
    s_lshl_b32 s91, s53, 2
    s_add_u32 s90, s90, s91
    s_lshl_b32 s91, s90, 16
    s_add_u32 s91, s91, 2048
    s_and_b32 s92, s90, 63
    s_lshl_b32 s92, s92, 17
    s_lshr_b32 s93, s90, 6
    s_lshl_b32 s93, s93, 12
    s_add_u32 s92, s92, s93
    s_cmp_eq_u32 s95, 1
    s_cselect_b32 s71, s92, s91
    s_lshl_b32 s72, 0x10000, s95
    s_lshl_b32 s92, s97, 8
    s_lshl_b32 s93, s40, 7
    s_add_u32 s71, s71, s92
    s_add_u32 s71, s71, s93
    v_mov_b64 v[64:65], 0
    v_mov_b64 v[66:67], 0
    v_mov_b64 v[68:69], 0
    v_mov_b64 v[70:71], 0
    v_mov_b64 v[72:73], 0
    v_mov_b64 v[74:75], 0
    v_mov_b64 v[76:77], 0
    v_mov_b64 v[78:79], 0
    v_mov_b64 v[80:81], 0
    v_mov_b64 v[82:83], 0
    v_mov_b64 v[84:85], 0
    v_mov_b64 v[86:87], 0
    v_mov_b64 v[88:89], 0
    v_mov_b64 v[90:91], 0
    v_mov_b64 v[92:93], 0
    v_mov_b64 v[94:95], 0
    v_mov_b64 v[96:97], 0
    v_mov_b64 v[98:99], 0
    v_mov_b64 v[100:101], 0
    v_mov_b64 v[102:103], 0
    v_mov_b64 v[104:105], 0
    v_mov_b64 v[106:107], 0
    v_mov_b64 v[108:109], 0
    v_mov_b64 v[110:111], 0
    v_mov_b64 v[112:113], 0
    v_mov_b64 v[114:115], 0
    v_mov_b64 v[116:117], 0
    v_mov_b64 v[118:119], 0
    v_mov_b64 v[120:121], 0
    v_mov_b64 v[122:123], 0
    v_mov_b64 v[124:125], 0
    v_mov_b64 v[126:127], 0
    v_and_b32 v48, 15, v1
    v_lshrrev_b32 v49, 4, v1
    v_lshlrev_b32 v49, 2, v49
    v_sub_u32 v48, v48, v49
    v_cmp_ge_i32 vcc, -9, v48
    v_subrev_u32 v50, 0, v48
    v_cmp_ge_u32 s[76:77], 7, v50
    s_nop 0
    v_cndmask_b32 v128, v9, 0, vcc
    v_cndmask_b32 v132, v9, 0, s[76:77]
    v_cmp_ge_i32 vcc, -8, v48
    v_subrev_u32 v50, 1, v48
    v_cmp_ge_u32 s[76:77], 7, v50
    s_nop 0
    v_cndmask_b32 v129, v9, 0, vcc
    v_cndmask_b32 v133, v9, 0, s[76:77]
    v_cmp_ge_i32 vcc, -7, v48
    v_subrev_u32 v50, 2, v48
    v_cmp_ge_u32 s[76:77], 7, v50
    s_nop 0
    v_cndmask_b32 v130, v9, 0, vcc
    v_cndmask_b32 v134, v9, 0, s[76:77]
    v_cmp_ge_i32 vcc, -6, v48
    v_subrev_u32 v50, 3, v48
    v_cmp_ge_u32 s[76:77], 7, v50
    s_nop 0
    v_cndmask_b32 v131, v9, 0, vcc
    v_cndmask_b32 v135, v9, 0, s[76:77]
    s_cmp_eq_u32 s81, 0
    s_cselect_b64 vcc, -1, 0
    s_nop 0
    v_cndmask_b32 v136, v128, v9, vcc
    v_cndmask_b32 v137, v129, v9, vcc
    v_cndmask_b32 v138, v130, v9, vcc
    v_cndmask_b32 v139, v131, v9, vcc
    s_lshl_b32 s90, s80, 10
    s_lshr_b32 s91, s2, 3
    s_lshl_b32 s91, s91, 17
    s_add_u32 s90, s90, s91
    s_add_u32 s80, s90, 83886080
    s_add_u32 s59, s60, 131072
    s_mov_b32 s58, 0
    s_mov_b32 s100, 32768
    s_mov_b32 s64, 0
    s_mov_b32 s67, 0
    s_waitcnt vmcnt(36)
    s_cmp_eq_u32 s99, 1
    s_cbranch_scc1 m_x2122
    s_waitcnt vmcnt(16)
m_x2122:
    s_barrier
    s_lshl_b32 s91, s33, 5
    s_add_u32 s91, s91, s32
    s_lshl_b32 s91, s91, 3
    s_add_u32 s91, s91, 7936
    s_cmp_lg_u32 s16, 0
    s_cbranch_scc1 m_np124
    v_mov_b32 v60, s4
    v_mov_b32 v61, s5
    s_add_u32 s90, s91, 117440512
    s_mov_b64 exec, 1
    buffer_store_dwordx2 v[60:61], off, s[8:11], s90 sc1
    s_mov_b64 exec, -1
m_np124:
    s_cmp_eq_u32 s101, -1
    s_cbranch_scc1 m_pb125
    s_cmp_lg_u32 s16, 0
    s_cbranch_scc1 m_np126
    v_mov_b32 v60, s4
    v_mov_b32 v61, s5
    s_add_u32 s90, s101, 117440512
    s_mov_b64 exec, 1
    buffer_store_dwordx2 v[60:61], off, s[8:11], s90 sc1
    s_mov_b64 exec, -1
m_np126:
m_pb125:
    s_cmp_eq_u32 s99, 1
    s_cbranch_scc1 m_x3123
    s_mov_b32 s3, 1048576
m_spin128:
    buffer_load_dwordx2 v[4:5], v10, s[8:11], s52 offen sc1
    s_waitcnt vmcnt(0)
    v_cmp_ne_u64 s[76:77], s[4:5], v[4:5]
    s_mul_i32 s91, s95, 20
    s_nop 2
    s_lshr_b32 s90, s76, s91
    s_ff1_i32_b32 s90, s90
    s_lshl_b32 s68, s90, 1
    s_mul_i32 s91, s95, 0
    s_sub_i32 s68, s68, s91
    s_cmp_lt_i32 s90, 0
    s_cselect_b32 s68, 1000, s68
    s_cmp_gt_i32 s68, 4
    s_cbranch_scc1 m_ok129
    s_sub_u32 s3, s3, 1
    s_cbranch_scc1 m_ok129
    s_sleep 4
    s_branch m_spin128
m_ok129:
    s_add_u32 m0, s60, 0
    s_nop 0
    buffer_load_dwordx4 v2, s[36:39], s56 offen offset:0 sc1 lds
    buffer_load_dwordx4 v2, s[36:39], s56 offen offset:1024 sc1 lds
    buffer_load_dwordx4 v2, s[36:39], s56 offen offset:2048 sc1 lds
    buffer_load_dwordx4 v2, s[36:39], s56 offen offset:3072 sc1 lds
    s_add_u32 s56, s56, 262144
    s_add_u32 m0, s60, 32768
    s_nop 0
    buffer_load_dwordx4 v2, s[36:39], s56 offen offset:0 sc1 lds
    buffer_load_dwordx4 v2, s[36:39], s56 offen offset:1024 sc1 lds
    buffer_load_dwordx4 v2, s[36:39], s56 offen offset:2048 sc1 lds
    buffer_load_dwordx4 v2, s[36:39], s56 offen offset:3072 sc1 lds
    s_add_u32 s56, s56, 262144
    s_add_u32 m0, s60, 65536
    s_nop 0
    buffer_load_dwordx4 v2, s[36:39], s56 offen offset:0 sc1 lds
    buffer_load_dwordx4 v2, s[36:39], s56 offen offset:1024 sc1 lds
    buffer_load_dwordx4 v2, s[36:39], s56 offen offset:2048 sc1 lds
    buffer_load_dwordx4 v2, s[36:39], s56 offen offset:3072 sc1 lds
    s_add_u32 s56, s56, 262144
    s_add_u32 m0, s60, 98304
    s_nop 0
    buffer_load_dwordx4 v2, s[36:39], s56 offen offset:0 sc1 lds
    buffer_load_dwordx4 v2, s[36:39], s56 offen offset:1024 sc1 lds
    buffer_load_dwordx4 v2, s[36:39], s56 offen offset:2048 sc1 lds
    buffer_load_dwordx4 v2, s[36:39], s56 offen offset:3072 sc1 lds
    s_add_u32 s56, s56, 262144
    s_add_u32 m0, s60, 131072
    s_nop 0
    buffer_load_dwordx4 v2, s[36:39], s56 offen offset:0 sc1 lds
    buffer_load_dwordx4 v2, s[36:39], s56 offen offset:1024 sc1 lds
    buffer_load_dwordx4 v2, s[36:39], s56 offen offset:2048 sc1 lds
    buffer_load_dwordx4 v2, s[36:39], s56 offen offset:3072 sc1 lds
    s_add_u32 s56, s56, 262144
    s_waitcnt vmcnt(4)
    s_branch m_x4127
m_x3123:
    s_waitcnt vmcnt(4)
m_x4127:
    s_barrier
    ds_read_b128 a[0:3], v6 offset:0
    ds_read_b64_tr_b16 a[16:17], v12 offset:0
    ds_read_b64_tr_b16 a[18:19], v12 offset:4096
    ds_read_b128 a[4:7], v6 offset:1024
    ds_read_b128 a[8:11], v6 offset:2048
    ds_read_b128 a[12:15], v6 offset:3072
    ds_read_b64_tr_b16 a[20:21], v13 offset:0
    ds_read_b64_tr_b16 a[22:23], v13 offset:4096
    ds_read_b64_tr_b16 a[24:25], v14 offset:0
    ds_read_b64_tr_b16 a[26:27], v14 offset:4096
    ds_read_b64_tr_b16 a[28:29], v15 offset:0
    ds_read_b64_tr_b16 a[30:31], v15 offset:4096
    s_cmp_gt_i32 s68, 5
    s_cbranch_scc0 m_lp135
m_lr136:
    s_waitcnt lgkmcnt(9)
    v_mfma_f32_16x16x32_bf16 v[64:67], a[16:19], a[0:3], v[64:67]
    s_add_u32 m0, s59, 16384
    ds_read_b128 a[32:35], v6 offset:8192
    v_mfma_f32_16x16x32_bf16 v[148:151], v[208:211], v[192:195], v[136:139]
    v_mfma_f32_16x16x32_bf16 v[152:155], v[212:215], v[192:195], v[132:135]
    s_waitcnt lgkmcnt(9)
    v_mfma_f32_16x16x32_bf16 v[72:75], a[16:19], a[4:7], v[72:75]
    ds_read_b64_tr_b16 a[48:49], v12 offset:8192
    buffer_load_dwordx4 v16, s[24:27], s57 offen offset:0 sc1 lds
    v_mfma_f32_16x16x32_bf16 v[156:159], v[212:215], v[196:199], v[128:131]
    s_waitcnt lgkmcnt(9)
    v_mfma_f32_16x16x32_bf16 v[80:83], a[16:19], a[8:11], v[80:83]
    s_add_u32 s59, s58, s60
    ds_read_b64_tr_b16 a[50:51], v12 offset:12288
    v_mfma_f32_16x16x32_bf16 v[160:163], v[216:219], v[196:199], v[132:135]
    v_mfma_f32_16x16x32_bf16 v[164:167], v[216:219], v[200:203], v[128:131]
    s_waitcnt lgkmcnt(9)
    v_mfma_f32_16x16x32_bf16 v[88:91], a[16:19], a[12:15], v[88:91]
    s_add_u32 s58, s58, 32768
    ds_read_b128 a[36:39], v6 offset:9216
    v_mfma_f32_16x16x32_bf16 v[168:171], v[220:223], v[200:203], v[132:135]
    v_mfma_f32_16x16x32_bf16 v[172:175], v[220:223], v[204:207], v[128:131]
    s_waitcnt lgkmcnt(8)
    v_mfma_f32_16x16x32_bf16 v[68:71], a[20:23], a[0:3], v[68:71]
    s_cmp_ge_u32 s58, 163840
    ds_read_b128 a[40:43], v6 offset:10240
    v_mfma_f32_16x16x32_bf16 v[176:179], v[224:227], v[204:207], v[132:135]
    s_nop 1
    v_mfma_f32_16x16x32_bf16 v[76:79], a[20:23], a[4:7], v[76:79]
    ds_read_b128 a[44:47], v6 offset:11264
    buffer_load_dwordx4 v17, s[24:27], s57 offen offset:1024 sc1 lds
    s_nop 1
    v_mfma_f32_16x16x32_bf16 v[84:87], a[20:23], a[8:11], v[84:87]
    s_cselect_b32 s66, 4294836224, s100
    ds_read_b64_tr_b16 a[52:53], v13 offset:8192
    s_nop 1
    s_nop 1
    v_mfma_f32_16x16x32_bf16 v[92:95], a[20:23], a[12:15], v[92:95]
    s_cselect_b32 s58, 0, s58
    ds_read_b64_tr_b16 a[54:55], v13 offset:12288
    v_max3_f32 v140, v148, v149, v150
    v_max3_f32 v141, v156, v157, v158
    s_waitcnt lgkmcnt(10)
    v_mfma_f32_16x16x32_bf16 v[96:99], a[24:27], a[0:3], v[96:99]
    ds_read_b64_tr_b16 a[56:57], v14 offset:8192
    v_max3_f32 v142, v164, v165, v166
    v_max3_f32 v143, v172, v173, v174
    v_mfma_f32_16x16x32_bf16 v[104:107], a[24:27], a[4:7], v[104:107]
    ds_read_b64_tr_b16 a[58:59], v14 offset:12288
    buffer_load_dwordx4 v18, s[24:27], s57 offen offset:2048 sc1 lds
    v_max3_f32 v140, v140, v151, v152
    v_mfma_f32_16x16x32_bf16 v[112:115], a[24:27], a[8:11], v[112:115]
    ds_read_b64_tr_b16 a[60:61], v15 offset:8192
    v_max3_f32 v141, v141, v159, v160
    v_max3_f32 v142, v142, v167, v168
    v_mfma_f32_16x16x32_bf16 v[120:123], a[24:27], a[12:15], v[120:123]
    ds_read_b64_tr_b16 a[62:63], v15 offset:12288
    v_max3_f32 v143, v143, v175, v176
    v_max3_f32 v140, v140, v153, v154
    s_waitcnt lgkmcnt(12)
    v_mfma_f32_16x16x32_bf16 v[100:103], a[28:31], a[0:3], v[100:103]
    v_add_u32 v6, s66, v6
    v_add_u32 v12, s66, v12
    v_max3_f32 v141, v141, v161, v162
    v_mfma_f32_16x16x32_bf16 v[108:111], a[28:31], a[4:7], v[108:111]
    buffer_load_dwordx4 v19, s[24:27], s57 offen offset:3072 sc1 lds
    v_max3_f32 v142, v142, v169, v170
    v_mfma_f32_16x16x32_bf16 v[116:119], a[28:31], a[8:11], v[116:119]
    s_add_u32 s57, s57, 131072
    v_add_u32 v13, s66, v13
    v_add_u32 v14, s66, v14
    v_max3_f32 v143, v143, v177, v178
    v_mfma_f32_16x16x32_bf16 v[124:127], a[28:31], a[12:15], v[124:127]
    s_mov_b32 m0, s59
    v_add_u32 v15, s66, v15
    v_max_f32 v140, v140, v155
    s_waitcnt vmcnt(24) lgkmcnt(0)
    v_mfma_f32_16x16x32_bf16 v[64:67], a[48:51], a[32:35], v[64:67]
    s_barrier
    v_max_f32 v141, v141, v163
    v_max_f32 v142, v142, v171
    v_mfma_f32_16x16x32_bf16 v[72:75], a[48:51], a[36:39], v[72:75]
    ds_read_b128 a[0:3], v6 offset:0
    buffer_load_dwordx4 v2, s[36:39], s56 offen offset:0 sc1 lds
    v_max_f32 v143, v143, v179
    v_mfma_f32_16x16x32_bf16 v[80:83], a[48:51], a[40:43], v[80:83]
    ds_read_b64_tr_b16 a[16:17], v12 offset:0
    v_mov_b32 v144, v140
    v_mov_b32 v145, v141
    v_mfma_f32_16x16x32_bf16 v[88:91], a[48:51], a[44:47], v[88:91]
    ds_read_b64_tr_b16 a[18:19], v12 offset:4096
    v_mov_b32 v146, v142
    v_mov_b32 v147, v143
    v_mfma_f32_16x16x32_bf16 v[68:71], a[52:55], a[32:35], v[68:71]
    ds_read_b128 a[4:7], v6 offset:1024
    s_nop 1
    v_permlane32_swap_b32 v140, v144
    v_mfma_f32_16x16x32_bf16 v[76:79], a[52:55], a[36:39], v[76:79]
    ds_read_b128 a[8:11], v6 offset:2048
    buffer_load_dwordx4 v2, s[36:39], s56 offen offset:1024 sc1 lds
    v_permlane32_swap_b32 v141, v145
    v_mfma_f32_16x16x32_bf16 v[84:87], a[52:55], a[40:43], v[84:87]
    ds_read_b128 a[12:15], v6 offset:3072
    v_permlane32_swap_b32 v142, v146
    v_permlane32_swap_b32 v143, v147
    v_mfma_f32_16x16x32_bf16 v[92:95], a[52:55], a[44:47], v[92:95]
    ds_read_b64_tr_b16 a[20:21], v13 offset:0
    s_nop 1
    v_max_f32 v140, v140, v144
    v_mfma_f32_16x16x32_bf16 v[96:99], a[56:59], a[32:35], v[96:99]
    ds_read_b64_tr_b16 a[22:23], v13 offset:4096
    v_max_f32 v141, v141, v145
    v_max_f32 v142, v142, v146
    v_mfma_f32_16x16x32_bf16 v[104:107], a[56:59], a[36:39], v[104:107]
    ds_read_b64_tr_b16 a[24:25], v14 offset:0
    buffer_load_dwordx4 v2, s[36:39], s56 offen offset:2048 sc1 lds
    v_max_f32 v143, v143, v147
    v_mfma_f32_16x16x32_bf16 v[112:115], a[56:59], a[40:43], v[112:115]
    ds_read_b64_tr_b16 a[26:27], v14 offset:4096
    v_mov_b32 v144, v140
    v_mov_b32 v145, v141
    v_mfma_f32_16x16x32_bf16 v[120:123], a[56:59], a[44:47], v[120:123]
    ds_read_b64_tr_b16 a[28:29], v15 offset:0
    v_mov_b32 v146, v142
    v_mov_b32 v147, v143
    v_mfma_f32_16x16x32_bf16 v[100:103], a[60:63], a[32:35], v[100:103]
    s_add_u32 s64, s64, 1
    ds_read_b64_tr_b16 a[30:31], v15 offset:4096
    s_nop 1
    v_permlane16_swap_b32 v140, v144
    v_mfma_f32_16x16x32_bf16 v[108:111], a[60:63], a[36:39], v[108:111]
    buffer_load_dwordx4 v2, s[36:39], s56 offen offset:3072 sc1 lds
    v_permlane16_swap_b32 v141, v145
    v_mfma_f32_16x16x32_bf16 v[116:119], a[60:63], a[40:43], v[116:119]
    s_add_u32 s56, s56, 262144
    v_permlane16_swap_b32 v142, v146
    v_permlane16_swap_b32 v143, v147
    v_mfma_f32_16x16x32_bf16 v[124:127], a[60:63], a[44:47], v[124:127]
    s_nop 1
    v_max_f32 v140, v140, v144
    s_cmp_gt_i32 s68, 6
    s_cbranch_scc0 m_lp137
m_lr138:
    s_waitcnt lgkmcnt(9)
    v_mfma_f32_16x16x32_bf16 v[64:67], a[16:19], a[0:3], v[64:67]
    s_add_u32 m0, s59, 16384
    ds_read_b128 a[32:35], v6 offset:8192
    v_max_f32 v141, v141, v145
    v_max_f32 v142, v142, v146
    s_waitcnt lgkmcnt(9)
    v_mfma_f32_16x16x32_bf16 v[72:75], a[16:19], a[4:7], v[72:75]
    ds_read_b64_tr_b16 a[48:49], v12 offset:8192
    buffer_load_dwordx4 v16, s[24:27], s57 offen offset:0 sc1 lds
    v_max_f32 v143, v143, v147
    s_waitcnt lgkmcnt(9)
    v_mfma_f32_16x16x32_bf16 v[80:83], a[16:19], a[8:11], v[80:83]
    s_add_u32 s59, s58, s60
    ds_read_b64_tr_b16 a[50:51], v12 offset:12288
    v_sub_f32 v148, v148, v140
    v_sub_f32 v149, v149, v140
    s_waitcnt lgkmcnt(9)
    v_mfma_f32_16x16x32_bf16 v[88:91], a[16:19], a[12:15], v[88:91]
    s_add_u32 s58, s58, 32768
    ds_read_b128 a[36:39], v6 offset:9216
    v_sub_f32 v150, v150, v140
    v_sub_f32 v151, v151, v140
    s_waitcnt lgkmcnt(8)
    v_mfma_f32_16x16x32_bf16 v[68:71], a[20:23], a[0:3], v[68:71]
    s_cmp_ge_u32 s58, 163840
    ds_read_b128 a[40:43], v6 offset:10240
    v_sub_f32 v152, v152, v140
    v_sub_f32 v153, v153, v140
    v_mfma_f32_16x16x32_bf16 v[76:79], a[20:23], a[4:7], v[76:79]
    ds_read_b128 a[44:47], v6 offset:11264
    buffer_load_dwordx4 v17, s[24:27], s57 offen offset:1024 sc1 lds
    v_sub_f32 v154, v154, v140
    v_mfma_f32_16x16x32_bf16 v[84:87], a[20:23], a[8:11], v[84:87]
    s_cselect_b32 s66, 4294836224, s100
    ds_read_b64_tr_b16 a[52:53], v13 offset:8192
    v_sub_f32 v155, v155, v140
    v_sub_f32 v156, v156, v141
    v_mfma_f32_16x16x32_bf16 v[92:95], a[20:23], a[12:15], v[92:95]
    s_cselect_b32 s58, 0, s58
    ds_read_b64_tr_b16 a[54:55], v13 offset:12288
    v_sub_f32 v157, v157, v141
    v_sub_f32 v158, v158, v141
    s_waitcnt lgkmcnt(10)
    v_mfma_f32_16x16x32_bf16 v[96:99], a[24:27], a[0:3], v[96:99]
    ds_read_b64_tr_b16 a[56:57], v14 offset:8192
    v_sub_f32 v159, v159, v141
    v_sub_f32 v160, v160, v141
    v_mfma_f32_16x16x32_bf16 v[104:107], a[24:27], a[4:7], v[104:107]
    ds_read_b64_tr_b16 a[58:59], v14 offset:12288
    buffer_load_dwordx4 v18, s[24:27], s57 offen offset:2048 sc1 lds
    v_sub_f32 v161, v161, v141
    v_mfma_f32_16x16x32_bf16 v[112:115], a[24:27], a[8:11], v[112:115]
    ds_read_b64_tr_b16 a[60:61], v15 offset:8192
    v_sub_f32 v162, v162, v141
    v_sub_f32 v163, v163, v141
    v_mfma_f32_16x16x32_bf16 v[120:123], a[24:27], a[12:15], v[120:123]
    ds_read_b64_tr_b16 a[62:63], v15 offset:12288
    v_sub_f32 v164, v164, v142
    v_sub_f32 v165, v165, v142
    s_waitcnt lgkmcnt(12)
    v_mfma_f32_16x16x32_bf16 v[100:103], a[28:31], a[0:3], v[100:103]
    v_add_u32 v6, s66, v6
    v_add_u32 v12, s66, v12
    v_sub_f32 v166, v166, v142
    v_mfma_f32_16x16x32_bf16 v[108:111], a[28:31], a[4:7], v[108:111]
    buffer_load_dwordx4 v19, s[24:27], s57 offen offset:3072 sc1 lds
    v_sub_f32 v167, v167, v142
    v_mfma_f32_16x16x32_bf16 v[116:119], a[28:31], a[8:11], v[116:119]
    s_add_u32 s57, s57, 131072
    v_add_u32 v13, s66, v13
    v_add_u32 v14, s66, v14
    v_sub_f32 v168, v168, v142
    v_mfma_f32_16x16x32_bf16 v[124:127], a[28:31], a[12:15], v[124:127]
    s_mov_b32 m0, s59
    v_add_u32 v15, s66, v15
    v_sub_f32 v169, v169, v142
    s_waitcnt vmcnt(24) lgkmcnt(0)
    v_mfma_f32_16x16x32_bf16 v[64:67], a[48:51], a[32:35], v[64:67]
    s_barrier
    v_sub_f32 v170, v170, v142
    v_sub_f32 v171, v171, v142
    v_mfma_f32_16x16x32_bf16 v[72:75], a[48:51], a[36:39], v[72:75]
    ds_read_b128 a[0:3], v6 offset:0
    buffer_load_dwordx4 v2, s[36:39], s56 offen offset:0 sc1 lds
    v_sub_f32 v172, v172, v143
    v_mfma_f32_16x16x32_bf16 v[80:83], a[48:51], a[40:43], v[80:83]
    ds_read_b64_tr_b16 a[16:17], v12 offset:0
    v_sub_f32 v173, v173, v143
    v_sub_f32 v174, v174, v143
    v_mfma_f32_16x16x32_bf16 v[88:91], a[48:51], a[44:47], v[88:91]
    ds_read_b64_tr_b16 a[18:19], v12 offset:4096
    v_sub_f32 v175, v175, v143
    v_sub_f32 v176, v176, v143
    v_mfma_f32_16x16x32_bf16 v[68:71], a[52:55], a[32:35], v[68:71]
    ds_read_b128 a[4:7], v6 offset:1024
    v_sub_f32 v177, v177, v143
    v_sub_f32 v178, v178, v143
    v_mfma_f32_16x16x32_bf16 v[76:79], a[52:55], a[36:39], v[76:79]
    ds_read_b128 a[8:11], v6 offset:2048
    buffer_load_dwordx4 v2, s[36:39], s56 offen offset:1024 sc1 lds
    v_sub_f32 v179, v179, v143
    v_mfma_f32_16x16x32_bf16 v[84:87], a[52:55], a[40:43], v[84:87]
    ds_read_b128 a[12:15], v6 offset:3072
    v_exp_f32 v148, v148
    v_exp_f32 v149, v149
    v_mfma_f32_16x16x32_bf16 v[92:95], a[52:55], a[44:47], v[92:95]
    ds_read_b64_tr_b16 a[20:21], v13 offset:0
    v_exp_f32 v150, v150
    v_exp_f32 v151, v151
    v_mfma_f32_16x16x32_bf16 v[96:99], a[56:59], a[32:35], v[96:99]
    ds_read_b64_tr_b16 a[22:23], v13 offset:4096
    v_exp_f32 v152, v152
    v_exp_f32 v153, v153
    v_mfma_f32_16x16x32_bf16 v[104:107], a[56:59], a[36:39], v[104:107]
    ds_read_b64_tr_b16 a[24:25], v14 offset:0
    buffer_load_dwordx4 v2, s[36:39], s56 offen offset:2048 sc1 lds
    v_exp_f32 v154, v154
    v_mfma_f32_16x16x32_bf16 v[112:115], a[56:59], a[40:43], v[112:115]
    ds_read_b64_tr_b16 a[26:27], v14 offset:4096
    v_exp_f32 v155, v155
    v_exp_f32 v156, v156
    v_mfma_f32_16x16x32_bf16 v[120:123], a[56:59], a[44:47], v[120:123]
    ds_read_b64_tr_b16 a[28:29], v15 offset:0
    v_exp_f32 v157, v157
    v_exp_f32 v158, v158
    v_mfma_f32_16x16x32_bf16 v[100:103], a[60:63], a[32:35], v[100:103]
    s_add_u32 s64, s64, 1
    ds_read_b64_tr_b16 a[30:31], v15 offset:4096
    v_exp_f32 v159, v159
    v_exp_f32 v160, v160
    v_mfma_f32_16x16x32_bf16 v[108:111], a[60:63], a[36:39], v[108:111]
    buffer_load_dwordx4 v2, s[36:39], s56 offen offset:3072 sc1 lds
    v_exp_f32 v161, v161
    v_mfma_f32_16x16x32_bf16 v[116:119], a[60:63], a[40:43], v[116:119]
    s_add_u32 s56, s56, 262144
    v_exp_f32 v162, v162
    v_exp_f32 v163, v163
    v_mfma_f32_16x16x32_bf16 v[124:127], a[60:63], a[44:47], v[124:127]
    v_exp_f32 v164, v164
    v_exp_f32 v165, v165
    s_cmp_gt_i32 s68, 7
    s_cbranch_scc0 m_lp139
m_lr140:
    s_waitcnt lgkmcnt(9)
    v_mfma_f32_16x16x32_bf16 v[64:67], a[16:19], a[0:3], v[64:67]
    s_add_u32 m0, s59, 16384
    ds_read_b128 a[32:35], v6 offset:8192
    v_exp_f32 v166, v166
    v_exp_f32 v167, v167
    s_waitcnt lgkmcnt(9)
    v_mfma_f32_16x16x32_bf16 v[72:75], a[16:19], a[4:7], v[72:75]
    ds_read_b64_tr_b16 a[48:49], v12 offset:8192
    buffer_load_dwordx4 v16, s[24:27], s57 offen offset:0 sc1 lds
    v_exp_f32 v168, v168
    s_waitcnt lgkmcnt(9)
    v_mfma_f32_16x16x32_bf16 v[80:83], a[16:19], a[8:11], v[80:83]
    s_add_u32 s59, s58, s60
    ds_read_b64_tr_b16 a[50:51], v12 offset:12288
    v_exp_f32 v169, v169
    v_exp_f32 v170, v170
    s_waitcnt lgkmcnt(9)
    v_mfma_f32_16x16x32_bf16 v[88:91], a[16:19], a[12:15], v[88:91]
    s_add_u32 s58, s58, 32768
    ds_read_b128 a[36:39], v6 offset:9216
    v_exp_f32 v171, v171
    v_exp_f32 v172, v172
    s_waitcnt lgkmcnt(8)
    v_mfma_f32_16x16x32_bf16 v[68:71], a[20:23], a[0:3], v[68:71]
    s_cmp_ge_u32 s58, 163840
    ds_read_b128 a[40:43], v6 offset:10240
    v_exp_f32 v173, v173
    v_exp_f32 v174, v174
    v_mfma_f32_16x16x32_bf16 v[76:79], a[20:23], a[4:7], v[76:79]
    ds_read_b128 a[44:47], v6 offset:11264
    buffer_load_dwordx4 v17, s[24:27], s57 offen offset:1024 sc1 lds
    v_exp_f32 v175, v175
    v_mfma_f32_16x16x32_bf16 v[84:87], a[20:23], a[8:11], v[84:87]
    s_cselect_b32 s66, 4294836224, s100
    ds_read_b64_tr_b16 a[52:53], v13 offset:8192
    v_exp_f32 v176, v176
    v_exp_f32 v177, v177
    v_mfma_f32_16x16x32_bf16 v[92:95], a[20:23], a[12:15], v[92:95]
    s_cselect_b32 s58, 0, s58
    ds_read_b64_tr_b16 a[54:55], v13 offset:12288
    v_exp_f32 v178, v178
    v_exp_f32 v179, v179
    s_waitcnt lgkmcnt(10)
    v_mfma_f32_16x16x32_bf16 v[96:99], a[24:27], a[0:3], v[96:99]
    ds_read_b64_tr_b16 a[56:57], v14 offset:8192
    v_cvt_pk_bf16_f32 v192, v148, v149
    v_cvt_pk_bf16_f32 v193, v150, v151
    v_mfma_f32_16x16x32_bf16 v[104:107], a[24:27], a[4:7], v[104:107]
    ds_read_b64_tr_b16 a[58:59], v14 offset:12288
    buffer_load_dwordx4 v18, s[24:27], s57 offen offset:2048 sc1 lds
    v_cvt_pk_bf16_f32 v194, v152, v153
    v_mfma_f32_16x16x32_bf16 v[112:115], a[24:27], a[8:11], v[112:115]
    ds_read_b64_tr_b16 a[60:61], v15 offset:8192
    v_cvt_pk_bf16_f32 v195, v154, v155
    v_cvt_pk_bf16_f32 v196, v156, v157
    v_mfma_f32_16x16x32_bf16 v[120:123], a[24:27], a[12:15], v[120:123]
    ds_read_b64_tr_b16 a[62:63], v15 offset:12288
    v_cvt_pk_bf16_f32 v197, v158, v159
    v_cvt_pk_bf16_f32 v198, v160, v161
    s_waitcnt lgkmcnt(12)
    v_mfma_f32_16x16x32_bf16 v[100:103], a[28:31], a[0:3], v[100:103]
    v_add_u32 v6, s66, v6
    v_add_u32 v12, s66, v12
    v_cvt_pk_bf16_f32 v199, v162, v163
    v_mfma_f32_16x16x32_bf16 v[108:111], a[28:31], a[4:7], v[108:111]
    buffer_load_dwordx4 v19, s[24:27], s57 offen offset:3072 sc1 lds
    v_cvt_pk_bf16_f32 v200, v164, v165
    v_mfma_f32_16x16x32_bf16 v[116:119], a[28:31], a[8:11], v[116:119]
    s_add_u32 s57, s57, 131072
    v_add_u32 v13, s66, v13
    v_add_u32 v14, s66, v14
    v_cvt_pk_bf16_f32 v201, v166, v167
    v_mfma_f32_16x16x32_bf16 v[124:127], a[28:31], a[12:15], v[124:127]
    s_mov_b32 m0, s59
    v_add_u32 v15, s66, v15
    v_cvt_pk_bf16_f32 v202, v168, v169
    s_waitcnt vmcnt(24) lgkmcnt(0)
    v_mfma_f32_16x16x32_bf16 v[64:67], a[48:51], a[32:35], v[64:67]
    s_barrier
    v_cvt_pk_bf16_f32 v203, v170, v171
    v_cvt_pk_bf16_f32 v204, v172, v173
    v_mfma_f32_16x16x32_bf16 v[72:75], a[48:51], a[36:39], v[72:75]
    ds_read_b128 a[0:3], v6 offset:0
    buffer_load_dwordx4 v2, s[36:39], s56 offen offset:0 sc1 lds
    v_cvt_pk_bf16_f32 v205, v174, v175
    v_mfma_f32_16x16x32_bf16 v[80:83], a[48:51], a[40:43], v[80:83]
    ds_read_b64_tr_b16 a[16:17], v12 offset:0
    v_cvt_pk_bf16_f32 v206, v176, v177
    v_cvt_pk_bf16_f32 v207, v178, v179
    v_mfma_f32_16x16x32_bf16 v[88:91], a[48:51], a[44:47], v[88:91]
    ds_read_b64_tr_b16 a[18:19], v12 offset:4096
    s_nop 1
    v_mfma_f32_16x16x32_bf16 v[20:23], v[44:47], v[192:195], 0
    v_mfma_f32_16x16x32_bf16 v[68:71], a[52:55], a[32:35], v[68:71]
    ds_read_b128 a[4:7], v6 offset:1024
    v_mfma_f32_16x16x32_bf16 v[24:27], v[44:47], v[196:199], 0
    v_mfma_f32_16x16x32_bf16 v[28:31], v[44:47], v[200:203], 0
    v_mfma_f32_16x16x32_bf16 v[76:79], a[52:55], a[36:39], v[76:79]
    ds_read_b128 a[8:11], v6 offset:2048
    buffer_load_dwordx4 v2, s[36:39], s56 offen offset:1024 sc1 lds
    v_mfma_f32_16x16x32_bf16 v[32:35], v[44:47], v[204:207], 0
    v_mfma_f32_16x16x32_bf16 v[84:87], a[52:55], a[40:43], v[84:87]
    ds_read_b128 a[12:15], v6 offset:3072
    v_mfma_f32_16x16x32_bf16 v[148:151], v[230:233], v[192:195], 0
    v_mfma_f32_16x16x32_bf16 v[152:155], v[242:245], v[192:195], 0
    v_mfma_f32_16x16x32_bf16 v[92:95], a[52:55], a[44:47], v[92:95]
    ds_read_b64_tr_b16 a[20:21], v13 offset:0
    v_mfma_f32_16x16x32_bf16 v[156:159], v[232:235], v[196:199], 0
    v_mfma_f32_16x16x32_bf16 v[160:163], v[244:247], v[196:199], 0
    v_mfma_f32_16x16x32_bf16 v[96:99], a[56:59], a[32:35], v[96:99]
    ds_read_b64_tr_b16 a[22:23], v13 offset:4096
    v_mfma_f32_16x16x32_bf16 v[164:167], v[234:237], v[200:203], 0
    v_mfma_f32_16x16x32_bf16 v[168:171], v[246:249], v[200:203], 0
    v_mfma_f32_16x16x32_bf16 v[104:107], a[56:59], a[36:39], v[104:107]
    ds_read_b64_tr_b16 a[24:25], v14 offset:0
    buffer_load_dwordx4 v2, s[36:39], s56 offen offset:2048 sc1 lds
    v_mfma_f32_16x16x32_bf16 v[172:175], v[236:239], v[204:207], 0
    v_mfma_f32_16x16x32_bf16 v[112:115], a[56:59], a[40:43], v[112:115]
    ds_read_b64_tr_b16 a[26:27], v14 offset:4096
    v_mfma_f32_16x16x32_bf16 v[176:179], v[248:251], v[204:207], 0
    v_rcp_f32 v140, v20
    v_mfma_f32_16x16x32_bf16 v[120:123], a[56:59], a[44:47], v[120:123]
    ds_read_b64_tr_b16 a[28:29], v15 offset:0
    v_rcp_f32 v141, v24
    v_rcp_f32 v142, v28
    v_mfma_f32_16x16x32_bf16 v[100:103], a[60:63], a[32:35], v[100:103]
    s_add_u32 s64, s64, 1
    ds_read_b64_tr_b16 a[30:31], v15 offset:4096
    v_rcp_f32 v143, v32
    s_nop 1
    v_mfma_f32_16x16x32_bf16 v[108:111], a[60:63], a[36:39], v[108:111]
    buffer_load_dwordx4 v2, s[36:39], s56 offen offset:3072 sc1 lds
    s_nop 1
    v_mfma_f32_16x16x32_bf16 v[116:119], a[60:63], a[40:43], v[116:119]
    s_add_u32 s56, s56, 262144
    v_mul_f32 v148, v148, v140
    v_mul_f32 v149, v149, v140
    v_mfma_f32_16x16x32_bf16 v[124:127], a[60:63], a[44:47], v[124:127]
    v_mul_f32 v150, v150, v140
    v_mul_f32 v151, v151, v140
    s_cmp_gt_i32 s68, 8
    s_cbranch_scc0 m_lp141
m_lr142:
    s_waitcnt lgkmcnt(9)
    v_mfma_f32_16x16x32_bf16 v[64:67], a[16:19], a[0:3], v[64:67]
    s_add_u32 m0, s59, 16384
    ds_read_b128 a[32:35], v6 offset:8192
    v_mul_f32 v152, v152, v140
    v_mul_f32 v153, v153, v140
    s_waitcnt lgkmcnt(9)
    v_mfma_f32_16x16x32_bf16 v[72:75], a[16:19], a[4:7], v[72:75]
    ds_read_b64_tr_b16 a[48:49], v12 offset:8192
    buffer_load_dwordx4 v16, s[24:27], s57 offen offset:0 sc1 lds
    v_mul_f32 v154, v154, v140
    s_waitcnt lgkmcnt(9)
    v_mfma_f32_16x16x32_bf16 v[80:83], a[16:19], a[8:11], v[80:83]
    s_add_u32 s59, s58, s60
    ds_read_b64_tr_b16 a[50:51], v12 offset:12288
    v_mul_f32 v155, v155, v140
    v_cvt_pk_bf16_f32 v148, v148, v149
    s_waitcnt lgkmcnt(9)
    v_mfma_f32_16x16x32_bf16 v[88:91], a[16:19], a[12:15], v[88:91]
    s_add_u32 s58, s58, 32768
    ds_read_b128 a[36:39], v6 offset:9216
    v_cvt_pk_bf16_f32 v149, v150, v151
    v_cvt_pk_bf16_f32 v150, v152, v153
    s_waitcnt lgkmcnt(8)
    v_mfma_f32_16x16x32_bf16 v[68:71], a[20:23], a[0:3], v[68:71]
    s_cmp_ge_u32 s58, 163840
    ds_read_b128 a[40:43], v6 offset:10240
    v_cvt_pk_bf16_f32 v151, v154, v155
    buffer_store_dwordx4 v[148:151], v2, s[8:11], s80 offen offset:0 sc1
    v_mfma_f32_16x16x32_bf16 v[76:79], a[20:23], a[4:7], v[76:79]
    ds_read_b128 a[44:47], v6 offset:11264
    buffer_load_dwordx4 v17, s[24:27], s57 offen offset:1024 sc1 lds
    v_mul_f32 v156, v156, v141
    v_mfma_f32_16x16x32_bf16 v[84:87], a[20:23], a[8:11], v[84:87]
    s_cselect_b32 s66, 4294836224, s100
    ds_read_b64_tr_b16 a[52:53], v13 offset:8192
    v_mul_f32 v157, v157, v141
    v_mul_f32 v158, v158, v141
    v_mfma_f32_16x16x32_bf16 v[92:95], a[20:23], a[12:15], v[92:95]
    s_cselect_b32 s58, 0, s58
    ds_read_b64_tr_b16 a[54:55], v13 offset:12288
    v_mul_f32 v159, v159, v141
    v_mul_f32 v160, v160, v141
    s_waitcnt lgkmcnt(10)
    v_mfma_f32_16x16x32_bf16 v[96:99], a[24:27], a[0:3], v[96:99]
    ds_read_b64_tr_b16 a[56:57], v14 offset:8192
    v_mul_f32 v161, v161, v141
    v_mul_f32 v162, v162, v141
    v_mfma_f32_16x16x32_bf16 v[104:107], a[24:27], a[4:7], v[104:107]
    ds_read_b64_tr_b16 a[58:59], v14 offset:12288
    buffer_load_dwordx4 v18, s[24:27], s57 offen offset:2048 sc1 lds
    v_mul_f32 v163, v163, v141
    v_mfma_f32_16x16x32_bf16 v[112:115], a[24:27], a[8:11], v[112:115]
    ds_read_b64_tr_b16 a[60:61], v15 offset:8192
    v_cvt_pk_bf16_f32 v156, v156, v157
    v_cvt_pk_bf16_f32 v157, v158, v159
    v_mfma_f32_16x16x32_bf16 v[120:123], a[24:27], a[12:15], v[120:123]
    ds_read_b64_tr_b16 a[62:63], v15 offset:12288
    v_cvt_pk_bf16_f32 v158, v160, v161
    v_cvt_pk_bf16_f32 v159, v162, v163
    s_waitcnt lgkmcnt(12)
    v_mfma_f32_16x16x32_bf16 v[100:103], a[28:31], a[0:3], v[100:103]
    v_add_u32 v6, s66, v6
    v_add_u32 v12, s66, v12
    buffer_store_dwordx4 v[156:159], v2, s[8:11], s80 offen offset:1024 sc1
    v_mfma_f32_16x16x32_bf16 v[108:111], a[28:31], a[4:7], v[108:111]
    buffer_load_dwordx4 v19, s[24:27], s57 offen offset:3072 sc1 lds
    v_mul_f32 v164, v164, v142
    v_mfma_f32_16x16x32_bf16 v[116:119], a[28:31], a[8:11], v[116:119]
    s_add_u32 s57, s57, 131072
    v_add_u32 v13, s66, v13
    v_add_u32 v14, s66, v14
    v_mul_f32 v165, v165, v142
    v_mfma_f32_16x16x32_bf16 v[124:127], a[28:31], a[12:15], v[124:127]
    s_mov_b32 m0, s59
    v_add_u32 v15, s66, v15
    v_mul_f32 v166, v166, v142
    s_waitcnt vmcnt(24) lgkmcnt(0)
    v_mfma_f32_16x16x32_bf16 v[64:67], a[48:51], a[32:35], v[64:67]
    s_barrier
    v_mul_f32 v167, v167, v142
    v_mul_f32 v168, v168, v142
    v_mfma_f32_16x16x32_bf16 v[72:75], a[48:51], a[36:39], v[72:75]
    ds_read_b128 a[0:3], v6 offset:0
    buffer_load_dwordx4 v2, s[36:39], s56 offen offset:0 sc1 lds
    v_mul_f32 v169, v169, v142
    v_mfma_f32_16x16x32_bf16 v[80:83], a[48:51], a[40:43], v[80:83]
    ds_read_b64_tr_b16 a[16:17], v12 offset:0
    v_mul_f32 v170, v170, v142
    v_mul_f32 v171, v171, v142
    v_mfma_f32_16x16x32_bf16 v[88:91], a[48:51], a[44:47], v[88:91]
    ds_read_b64_tr_b16 a[18:19], v12 offset:4096
    v_cvt_pk_bf16_f32 v164, v164, v165
    v_cvt_pk_bf16_f32 v165, v166, v167
    v_mfma_f32_16x16x32_bf16 v[68:71], a[52:55], a[32:35], v[68:71]
    ds_read_b128 a[4:7], v6 offset:1024
    v_cvt_pk_bf16_f32 v166, v168, v169
    v_cvt_pk_bf16_f32 v167, v170, v171
    v_mfma_f32_16x16x32_bf16 v[76:79], a[52:55], a[36:39], v[76:79]
    ds_read_b128 a[8:11], v6 offset:2048
    buffer_load_dwordx4 v2, s[36:39], s56 offen offset:1024 sc1 lds
    buffer_store_dwordx4 v[164:167], v2, s[8:11], s80 offen offset:2048 sc1
    v_mfma_f32_16x16x32_bf16 v[84:87], a[52:55], a[40:43], v[84:87]
    ds_read_b128 a[12:15], v6 offset:3072
    v_mul_f32 v172, v172, v143
    v_mul_f32 v173, v173, v143
    v_mfma_f32_16x16x32_bf16 v[92:95], a[52:55], a[44:47], v[92:95]
    ds_read_b64_tr_b16 a[20:21], v13 offset:0
    v_mul_f32 v174, v174, v143
    v_mul_f32 v175, v175, v143
    v_mfma_f32_16x16x32_bf16 v[96:99], a[56:59], a[32:35], v[96:99]
    ds_read_b64_tr_b16 a[22:23], v13 offset:4096
    v_mul_f32 v176, v176, v143
    v_mul_f32 v177, v177, v143
    v_mfma_f32_16x16x32_bf16 v[104:107], a[56:59], a[36:39], v[104:107]
    ds_read_b64_tr_b16 a[24:25], v14 offset:0
    buffer_load_dwordx4 v2, s[36:39], s56 offen offset:2048 sc1 lds
    v_mul_f32 v178, v178, v143
    v_mfma_f32_16x16x32_bf16 v[112:115], a[56:59], a[40:43], v[112:115]
    ds_read_b64_tr_b16 a[26:27], v14 offset:4096
    v_mul_f32 v179, v179, v143
    v_cvt_pk_bf16_f32 v172, v172, v173
    v_mfma_f32_16x16x32_bf16 v[120:123], a[56:59], a[44:47], v[120:123]
    ds_read_b64_tr_b16 a[28:29], v15 offset:0
    v_cvt_pk_bf16_f32 v173, v174, v175
    v_cvt_pk_bf16_f32 v174, v176, v177
    v_mfma_f32_16x16x32_bf16 v[100:103], a[60:63], a[32:35], v[100:103]
    s_add_u32 s64, s64, 1
    ds_read_b64_tr_b16 a[30:31], v15 offset:4096
    v_cvt_pk_bf16_f32 v175, v178, v179
    buffer_store_dwordx4 v[172:175], v2, s[8:11], s80 offen offset:3072 sc1
    v_mfma_f32_16x16x32_bf16 v[108:111], a[60:63], a[36:39], v[108:111]
    buffer_load_dwordx4 v2, s[36:39], s56 offen offset:3072 sc1 lds
    v_mfma_f32_16x16x32_bf16 v[116:119], a[60:63], a[40:43], v[116:119]
    s_add_u32 s56, s56, 262144
    v_mfma_f32_16x16x32_bf16 v[124:127], a[60:63], a[44:47], v[124:127]
    s_branch m_l3e131
m_lp135:
    s_mov_b32 s3, 1048576
m_spin143:
    buffer_load_dwordx2 v[4:5], v10, s[8:11], s52 offen sc1
    s_waitcnt vmcnt(0)
    v_cmp_ne_u64 s[76:77], s[4:5], v[4:5]
    s_mul_i32 s91, s95, 20
    s_nop 2
    s_lshr_b32 s90, s76, s91
    s_ff1_i32_b32 s90, s90
    s_lshl_b32 s68, s90, 1
    s_mul_i32 s91, s95, 0
    s_sub_i32 s68, s68, s91
    s_cmp_lt_i32 s90, 0
    s_cselect_b32 s68, 1000, s68
    s_cmp_gt_i32 s68, 5
    s_cbranch_scc1 m_ok144
    s_sub_u32 s3, s3, 1
    s_cbranch_scc1 m_ok144
    s_sleep 4
    s_branch m_spin143
m_ok144:
    s_branch m_lr136
m_lp137:
    s_mov_b32 s3, 1048576
m_spin145:
    buffer_load_dwordx2 v[4:5], v10, s[8:11], s52 offen sc1
    s_waitcnt vmcnt(0)
    v_cmp_ne_u64 s[76:77], s[4:5], v[4:5]
    s_mul_i32 s91, s95, 20
    s_nop 2
    s_lshr_b32 s90, s76, s91
    s_ff1_i32_b32 s90, s90
    s_lshl_b32 s68, s90, 1
    s_mul_i32 s91, s95, 0
    s_sub_i32 s68, s68, s91
    s_cmp_lt_i32 s90, 0
    s_cselect_b32 s68, 1000, s68
    s_cmp_gt_i32 s68, 6
    s_cbranch_scc1 m_ok146
    s_sub_u32 s3, s3, 1
    s_cbranch_scc1 m_ok146
    s_sleep 4
    s_branch m_spin145
m_ok146:
    s_branch m_lr138
m_lp139:
    s_mov_b32 s3, 1048576
m_spin147:
    buffer_load_dwordx2 v[4:5], v10, s[8:11], s52 offen sc1
    s_waitcnt vmcnt(0)
    v_cmp_ne_u64 s[76:77], s[4:5], v[4:5]
    s_mul_i32 s91, s95, 20
    s_nop 2
    s_lshr_b32 s90, s76, s91
    s_ff1_i32_b32 s90, s90
    s_lshl_b32 s68, s90, 1
    s_mul_i32 s91, s95, 0
    s_sub_i32 s68, s68, s91
    s_cmp_lt_i32 s90, 0
    s_cselect_b32 s68, 1000, s68
    s_cmp_gt_i32 s68, 7
    s_cbranch_scc1 m_ok148
    s_sub_u32 s3, s3, 1
    s_cbranch_scc1 m_ok148
    s_sleep 4
    s_branch m_spin147
m_ok148:
    s_branch m_lr140
m_lp141:
    s_mov_b32 s3, 1048576
m_spin149:
    buffer_load_dwordx2 v[4:5], v10, s[8:11], s52 offen sc1
    s_waitcnt vmcnt(0)
    v_cmp_ne_u64 s[76:77], s[4:5], v[4:5]
    s_mul_i32 s91, s95, 20
    s_nop 2
    s_lshr_b32 s90, s76, s91
    s_ff1_i32_b32 s90, s90
    s_lshl_b32 s68, s90, 1
    s_mul_i32 s91, s95, 0
    s_sub_i32 s68, s68, s91
    s_cmp_lt_i32 s90, 0
    s_cselect_b32 s68, 1000, s68
    s_cmp_gt_i32 s68, 8
    s_cbranch_scc1 m_ok150
    s_sub_u32 s3, s3, 1
    s_cbranch_scc1 m_ok150
    s_sleep 4
    s_branch m_spin149
m_ok150:
    s_branch m_lr142
m_l3130:
    s_waitcnt lgkmcnt(9)
    v_mfma_f32_16x16x32_bf16 v[64:67], a[16:19], a[0:3], v[64:67]
    s_add_u32 m0, s59, 16384
    ds_read_b128 a[32:35], v6 offset:8192
    s_waitcnt lgkmcnt(9)
    v_mfma_f32_16x16x32_bf16 v[72:75], a[16:19], a[4:7], v[72:75]
    ds_read_b64_tr_b16 a[48:49], v12 offset:8192
    buffer_load_dwordx4 v16, s[24:27], s57 offen offset:0 sc1 lds
    s_waitcnt lgkmcnt(9)
    v_mfma_f32_16x16x32_bf16 v[80:83], a[16:19], a[8:11], v[80:83]
    s_add_u32 s59, s58, s60
    ds_read_b64_tr_b16 a[50:51], v12 offset:12288
    s_waitcnt lgkmcnt(9)
    v_mfma_f32_16x16x32_bf16 v[88:91], a[16:19], a[12:15], v[88:91]
    s_add_u32 s58, s58, 32768
    ds_read_b128 a[36:39], v6 offset:9216
    s_waitcnt lgkmcnt(8)
    v_mfma_f32_16x16x32_bf16 v[68:71], a[20:23], a[0:3], v[68:71]
    s_cmp_ge_u32 s58, 163840
    ds_read_b128 a[40:43], v6 offset:10240
    v_mfma_f32_16x16x32_bf16 v[76:79], a[20:23], a[4:7], v[76:79]
    ds_read_b128 a[44:47], v6 offset:11264
    buffer_load_dwordx4 v17, s[24:27], s57 offen offset:1024 sc1 lds
    v_mfma_f32_16x16x32_bf16 v[84:87], a[20:23], a[8:11], v[84:87]
    s_cselect_b32 s66, 4294836224, s100
    ds_read_b64_tr_b16 a[52:53], v13 offset:8192
    v_mfma_f32_16x16x32_bf16 v[92:95], a[20:23], a[12:15], v[92:95]
    s_cselect_b32 s58, 0, s58
    ds_read_b64_tr_b16 a[54:55], v13 offset:12288
    s_waitcnt lgkmcnt(10)
    v_mfma_f32_16x16x32_bf16 v[96:99], a[24:27], a[0:3], v[96:99]
    ds_read_b64_tr_b16 a[56:57], v14 offset:8192
    v_mfma_f32_16x16x32_bf16 v[104:107], a[24:27], a[4:7], v[104:107]
    ds_read_b64_tr_b16 a[58:59], v14 offset:12288
    buffer_load_dwordx4 v18, s[24:27], s57 offen offset:2048 sc1 lds
    v_mfma_f32_16x16x32_bf16 v[112:115], a[24:27], a[8:11], v[112:115]
    ds_read_b64_tr_b16 a[60:61], v15 offset:8192
    v_mfma_f32_16x16x32_bf16 v[120:123], a[24:27], a[12:15], v[120:123]
    ds_read_b64_tr_b16 a[62:63], v15 offset:12288
    s_waitcnt lgkmcnt(12)
    v_mfma_f32_16x16x32_bf16 v[100:103], a[28:31], a[0:3], v[100:103]
    v_add_u32 v6, s66, v6
    v_add_u32 v12, s66, v12
    v_mfma_f32_16x16x32_bf16 v[108:111], a[28:31], a[4:7], v[108:111]
    buffer_load_dwordx4 v19, s[24:27], s57 offen offset:3072 sc1 lds
    v_mfma_f32_16x16x32_bf16 v[116:119], a[28:31], a[8:11], v[116:119]
    s_add_u32 s57, s57, 131072
    v_add_u32 v13, s66, v13
    v_add_u32 v14, s66, v14
    v_mfma_f32_16x16x32_bf16 v[124:127], a[28:31], a[12:15], v[124:127]
    s_mov_b32 m0, s59
    v_add_u32 v15, s66, v15
    s_waitcnt vmcnt(24) lgkmcnt(0)
    v_mfma_f32_16x16x32_bf16 v[64:67], a[48:51], a[32:35], v[64:67]
    s_barrier
    v_mfma_f32_16x16x32_bf16 v[72:75], a[48:51], a[36:39], v[72:75]
    ds_read_b128 a[0:3], v6 offset:0
    buffer_load_dwordx4 v2, s[36:39], s56 offen offset:0 sc1 lds
    v_mfma_f32_16x16x32_bf16 v[80:83], a[48:51], a[40:43], v[80:83]
    ds_read_b64_tr_b16 a[16:17], v12 offset:0
    v_mfma_f32_16x16x32_bf16 v[88:91], a[48:51], a[44:47], v[88:91]
    ds_read_b64_tr_b16 a[18:19], v12 offset:4096
    v_mfma_f32_16x16x32_bf16 v[68:71], a[52:55], a[32:35], v[68:71]
    ds_read_b128 a[4:7], v6 offset:1024
    v_mfma_f32_16x16x32_bf16 v[76:79], a[52:55], a[36:39], v[76:79]
    ds_read_b128 a[8:11], v6 offset:2048
    buffer_load_dwordx4 v2, s[36:39], s56 offen offset:1024 sc1 lds
    v_mfma_f32_16x16x32_bf16 v[84:87], a[52:55], a[40:43], v[84:87]
    ds_read_b128 a[12:15], v6 offset:3072
    v_mfma_f32_16x16x32_bf16 v[92:95], a[52:55], a[44:47], v[92:95]
    ds_read_b64_tr_b16 a[20:21], v13 offset:0
    v_mfma_f32_16x16x32_bf16 v[96:99], a[56:59], a[32:35], v[96:99]
    ds_read_b64_tr_b16 a[22:23], v13 offset:4096
    v_mfma_f32_16x16x32_bf16 v[104:107], a[56:59], a[36:39], v[104:107]
    ds_read_b64_tr_b16 a[24:25], v14 offset:0
    buffer_load_dwordx4 v2, s[36:39], s56 offen offset:2048 sc1 lds
    v_mfma_f32_16x16x32_bf16 v[112:115], a[56:59], a[40:43], v[112:115]
    ds_read_b64_tr_b16 a[26:27], v14 offset:4096
    v_mfma_f32_16x16x32_bf16 v[120:123], a[56:59], a[44:47], v[120:123]
    ds_read_b64_tr_b16 a[28:29], v15 offset:0
    v_mfma_f32_16x16x32_bf16 v[100:103], a[60:63], a[32:35], v[100:103]
    s_add_u32 s64, s64, 1
    ds_read_b64_tr_b16 a[30:31], v15 offset:4096
    v_mfma_f32_16x16x32_bf16 v[108:111], a[60:63], a[36:39], v[108:111]
    buffer_load_dwordx4 v2, s[36:39], s56 offen offset:3072 sc1 lds
    v_mfma_f32_16x16x32_bf16 v[116:119], a[60:63], a[40:43], v[116:119]
    s_add_u32 s56, s56, 262144
    s_cmp_lt_u32 s64, s67
    v_mfma_f32_16x16x32_bf16 v[124:127], a[60:63], a[44:47], v[124:127]
    s_cbranch_scc1 m_l3130
m_l3e131:
    s_add_u32 s92, s64, 5
    s_cmp_gt_i32 s68, s92
    s_cbranch_scc1 m_rdy151
    s_mov_b32 s3, 1048576
m_spin152:
    buffer_load_dwordx2 v[4:5], v10, s[8:11], s52 offen sc1
    s_waitcnt vmcnt(0)
    v_cmp_ne_u64 s[76:77], s[4:5], v[4:5]
    s_mul_i32 s91, s95, 20
    s_nop 2
    s_lshr_b32 s90, s76, s91
    s_ff1_i32_b32 s90, s90
    s_lshl_b32 s68, s90, 1
    s_mul_i32 s91, s95, 0
    s_sub_i32 s68, s68, s91
    s_cmp_lt_i32 s90, 0
    s_cselect_b32 s68, 1000, s68
    s_cmp_gt_i32 s68, s92
    s_cbranch_scc1 m_ok153
    s_sub_u32 s3, s3, 1
    s_cbranch_scc1 m_ok153
    s_sleep 4
    s_branch m_spin152
m_ok153:
m_rdy151:
    s_mov_b32 s67, 8
    s_cmp_lt_u32 s64, 8
    s_cbranch_scc1 m_l3n134
    s_cmp_eq_u32 s64, 8
    s_cbranch_scc1 m_o1154
m_o2155:
    s_cmp_eq_u32 s95, 0
    s_cbranch_scc1 m_l3c133
    s_mov_b32 s67, 18
    s_cmp_lt_u32 s64, 18
    s_cbranch_scc1 m_l3n134
    s_cmp_lg_u32 s64, 18
    s_cbranch_scc1 m_n156
    s_mov_b32 s68, 1000
    s_lshr_b32 s90, s96, 1
    s_lshl_b32 s90, s90, 8
    s_add_u32 s90, s90, 117452800
    buffer_load_dwordx2 v[4:5], v10, s[8:11], s90 offen sc1
    s_mov_b32 s67, 19
    s_branch m_l3130
m_n156:
    s_cmp_lg_u32 s64, 19
    s_cbranch_scc1 m_n157
    s_waitcnt vmcnt(8)
    s_waitcnt vmcnt(16)
    s_mov_b32 s3, 1048576
m_spin158:
    v_cmp_ne_u64 s[76:77], s[4:5], v[4:5]
    s_nop 3
    s_cmp_eq_u64 s[76:77], 0
    s_cbranch_scc1 m_ok159
    s_sub_u32 s3, s3, 1
    s_cbranch_scc1 m_ok159
    s_sleep 8
    s_lshr_b32 s90, s96, 1
    s_lshl_b32 s90, s90, 8
    s_add_u32 s90, s90, 117452800
    buffer_load_dwordx2 v[4:5], v10, s[8:11], s90 offen sc1
    s_waitcnt vmcnt(0)
    s_branch m_spin158
m_ok159:
    s_mov_b32 s56, s69
    s_mov_b32 s67, 20
    s_branch m_l3130
m_n157:
    s_cmp_lg_u32 s64, 20
    s_cbranch_scc1 m_n160
    s_mov_b32 s24, s50
    s_mov_b32 s25, s51
    s_mov_b32 s26, 2097152
    s_lshl_b32 s57, s97, 8
    s_mov_b32 s67, 24
    s_branch m_l3130
m_n160:
    s_cmp_lg_u32 s64, 24
    s_cbranch_scc1 m_n161
    s_lshl_b32 s90, s96, 3
    s_add_u32 s90, s90, s97
    s_lshl_b32 s90, s90, 15
    s_lshl_b32 s91, s16, 13
    s_add_u32 s90, s90, s91
    s_add_u32 s70, s90, 100663296
    s_nop 3
    v_cvt_pk_bf16_f32 v128, v64, v65
    v_cvt_pk_bf16_f32 v129, v66, v67
    v_cvt_pk_bf16_f32 v130, v68, v69
    v_cvt_pk_bf16_f32 v131, v70, v71
    v_cvt_pk_bf16_f32 v132, v72, v73
    v_cvt_pk_bf16_f32 v133, v74, v75
    v_cvt_pk_bf16_f32 v134, v76, v77
    v_cvt_pk_bf16_f32 v135, v78, v79
    v_cvt_pk_bf16_f32 v136, v80, v81
    v_cvt_pk_bf16_f32 v137, v82, v83
    v_cvt_pk_bf16_f32 v138, v84, v85
    v_cvt_pk_bf16_f32 v139, v86, v87
    v_cvt_pk_bf16_f32 v140, v88, v89
    v_cvt_pk_bf16_f32 v141, v90, v91
    v_cvt_pk_bf16_f32 v142, v92, v93
    v_cvt_pk_bf16_f32 v143, v94, v95
    v_cvt_pk_bf16_f32 v144, v96, v97
    v_cvt_pk_bf16_f32 v145, v98, v99
    v_cvt_pk_bf16_f32 v146, v100, v101
    v_cvt_pk_bf16_f32 v147, v102, v103
    v_cvt_pk_bf16_f32 v148, v104, v105
    v_cvt_pk_bf16_f32 v149, v106, v107
    v_cvt_pk_bf16_f32 v150, v108, v109
    v_cvt_pk_bf16_f32 v151, v110, v111
    v_cvt_pk_bf16_f32 v152, v112, v113
    v_cvt_pk_bf16_f32 v153, v114, v115
    v_cvt_pk_bf16_f32 v154, v116, v117
    v_cvt_pk_bf16_f32 v155, v118, v119
    v_cvt_pk_bf16_f32 v156, v120, v121
    v_cvt_pk_bf16_f32 v157, v122, v123
    v_cvt_pk_bf16_f32 v158, v124, v125
    v_cvt_pk_bf16_f32 v159, v126, v127
    v_mov_b64 v[64:65], 0
    v_mov_b64 v[66:67], 0
    v_mov_b64 v[68:69], 0
    v_mov_b64 v[70:71], 0
    v_mov_b64 v[72:73], 0
    v_mov_b64 v[74:75], 0
    v_mov_b64 v[76:77], 0
    v_mov_b64 v[78:79], 0
    v_mov_b64 v[80:81], 0
    v_mov_b64 v[82:83], 0
    v_mov_b64 v[84:85], 0
    v_mov_b64 v[86:87], 0
    v_mov_b64 v[88:89], 0
    v_mov_b64 v[90:91], 0
    v_mov_b64 v[92:93], 0
    v_mov_b64 v[94:95], 0
    v_mov_b64 v[96:97], 0
    v_mov_b64 v[98:99], 0
    v_mov_b64 v[100:101], 0
    v_mov_b64 v[102:103], 0
    v_mov_b64 v[104:105], 0
    v_mov_b64 v[106:107], 0
    v_mov_b64 v[108:109], 0
    v_mov_b64 v[110:111], 0
    v_mov_b64 v[112:113], 0
    v_mov_b64 v[114:115], 0
    v_mov_b64 v[116:117], 0
    v_mov_b64 v[118:119], 0
    v_mov_b64 v[120:121], 0
    v_mov_b64 v[122:123], 0
    v_mov_b64 v[124:125], 0
    v_mov_b64 v[126:127], 0
    s_nop 1
    s_waitcnt lgkmcnt(9)
    v_mfma_f32_16x16x32_bf16 v[64:67], a[16:19], a[0:3], v[64:67]
    s_add_u32 m0, s59, 16384
    ds_read_b128 a[32:35], v6 offset:8192
    s_waitcnt lgkmcnt(9)
    v_mfma_f32_16x16x32_bf16 v[72:75], a[16:19], a[4:7], v[72:75]
    ds_read_b64_tr_b16 a[48:49], v12 offset:8192
    buffer_load_dwordx4 v16, s[24:27], s57 offen offset:0 sc1 lds
    s_waitcnt lgkmcnt(9)
    v_mfma_f32_16x16x32_bf16 v[80:83], a[16:19], a[8:11], v[80:83]
    s_add_u32 s59, s58, s60
    ds_read_b64_tr_b16 a[50:51], v12 offset:12288
    s_waitcnt lgkmcnt(9)
    v_mfma_f32_16x16x32_bf16 v[88:91], a[16:19], a[12:15], v[88:91]
    s_add_u32 s58, s58, 32768
    ds_read_b128 a[36:39], v6 offset:9216
    s_waitcnt lgkmcnt(8)
    v_mfma_f32_16x16x32_bf16 v[68:71], a[20:23], a[0:3], v[68:71]
    s_cmp_ge_u32 s58, 163840
    ds_read_b128 a[40:43], v6 offset:10240
    v_mfma_f32_16x16x32_bf16 v[76:79], a[20:23], a[4:7], v[76:79]
    ds_read_b128 a[44:47], v6 offset:11264
    buffer_load_dwordx4 v17, s[24:27], s57 offen offset:1024 sc1 lds
    v_mfma_f32_16x16x32_bf16 v[84:87], a[20:23], a[8:11], v[84:87]
    s_cselect_b32 s66, 4294836224, s100
    ds_read_b64_tr_b16 a[52:53], v13 offset:8192
    v_mfma_f32_16x16x32_bf16 v[92:95], a[20:23], a[12:15], v[92:95]
    s_cselect_b32 s58, 0, s58
    ds_read_b64_tr_b16 a[54:55], v13 offset:12288
    s_waitcnt lgkmcnt(10)
    v_mfma_f32_16x16x32_bf16 v[96:99], a[24:27], a[0:3], v[96:99]
    ds_read_b64_tr_b16 a[56:57], v14 offset:8192
    v_mfma_f32_16x16x32_bf16 v[104:107], a[24:27], a[4:7], v[104:107]
    ds_read_b64_tr_b16 a[58:59], v14 offset:12288
    buffer_load_dwordx4 v18, s[24:27], s57 offen offset:2048 sc1 lds
    v_mfma_f32_16x16x32_bf16 v[112:115], a[24:27], a[8:11], v[112:115]
    ds_read_b64_tr_b16 a[60:61], v15 offset:8192
    v_mfma_f32_16x16x32_bf16 v[120:123], a[24:27], a[12:15], v[120:123]
    ds_read_b64_tr_b16 a[62:63], v15 offset:12288
    buffer_store_dwordx4 v[128:131], v2, s[8:11], s70 offen offset:0 sc1
    s_waitcnt lgkmcnt(12)
    v_mfma_f32_16x16x32_bf16 v[100:103], a[28:31], a[0:3], v[100:103]
    v_add_u32 v6, s66, v6
    v_add_u32 v12, s66, v12
    v_mfma_f32_16x16x32_bf16 v[108:111], a[28:31], a[4:7], v[108:111]
    buffer_load_dwordx4 v19, s[24:27], s57 offen offset:3072 sc1 lds
    v_mfma_f32_16x16x32_bf16 v[116:119], a[28:31], a[8:11], v[116:119]
    s_add_u32 s57, s57, 131072
    v_add_u32 v13, s66, v13
    v_add_u32 v14, s66, v14
    v_mfma_f32_16x16x32_bf16 v[124:127], a[28:31], a[12:15], v[124:127]
    s_mov_b32 m0, s59
    v_add_u32 v15, s66, v15
    s_waitcnt vmcnt(24) lgkmcnt(0)
    v_mfma_f32_16x16x32_bf16 v[64:67], a[48:51], a[32:35], v[64:67]
    s_barrier
    v_mfma_f32_16x16x32_bf16 v[72:75], a[48:51], a[36:39], v[72:75]
    ds_read_b128 a[0:3], v6 offset:0
    buffer_load_dwordx4 v2, s[36:39], s56 offen offset:0 sc1 lds
    v_mfma_f32_16x16x32_bf16 v[80:83], a[48:51], a[40:43], v[80:83]
    ds_read_b64_tr_b16 a[16:17], v12 offset:0
    v_mfma_f32_16x16x32_bf16 v[88:91], a[48:51], a[44:47], v[88:91]
    ds_read_b64_tr_b16 a[18:19], v12 offset:4096
    v_mfma_f32_16x16x32_bf16 v[68:71], a[52:55], a[32:35], v[68:71]
    ds_read_b128 a[4:7], v6 offset:1024
    v_mfma_f32_16x16x32_bf16 v[76:79], a[52:55], a[36:39], v[76:79]
    ds_read_b128 a[8:11], v6 offset:2048
    buffer_load_dwordx4 v2, s[36:39], s56 offen offset:1024 sc1 lds
    v_mfma_f32_16x16x32_bf16 v[84:87], a[52:55], a[40:43], v[84:87]
    ds_read_b128 a[12:15], v6 offset:3072
    v_mfma_f32_16x16x32_bf16 v[92:95], a[52:55], a[44:47], v[92:95]
    ds_read_b64_tr_b16 a[20:21], v13 offset:0
    v_mfma_f32_16x16x32_bf16 v[96:99], a[56:59], a[32:35], v[96:99]
    ds_read_b64_tr_b16 a[22:23], v13 offset:4096
    v_mfma_f32_16x16x32_bf16 v[104:107], a[56:59], a[36:39], v[104:107]
    ds_read_b64_tr_b16 a[24:25], v14 offset:0
    buffer_load_dwordx4 v2, s[36:39], s56 offen offset:2048 sc1 lds
    v_mfma_f32_16x16x32_bf16 v[112:115], a[56:59], a[40:43], v[112:115]
    ds_read_b64_tr_b16 a[26:27], v14 offset:4096
    v_mfma_f32_16x16x32_bf16 v[120:123], a[56:59], a[44:47], v[120:123]
    ds_read_b64_tr_b16 a[28:29], v15 offset:0
    buffer_store_dwordx4 v[132:135], v2, s[8:11], s70 offen offset:1024 sc1
    v_mfma_f32_16x16x32_bf16 v[100:103], a[60:63], a[32:35], v[100:103]
    s_add_u32 s64, s64, 1
    ds_read_b64_tr_b16 a[30:31], v15 offset:4096
    v_mfma_f32_16x16x32_bf16 v[108:111], a[60:63], a[36:39], v[108:111]
    buffer_load_dwordx4 v2, s[36:39], s56 offen offset:3072 sc1 lds
    v_mfma_f32_16x16x32_bf16 v[116:119], a[60:63], a[40:43], v[116:119]
    s_add_u32 s56, s56, 262144
    v_mfma_f32_16x16x32_bf16 v[124:127], a[60:63], a[44:47], v[124:127]
    s_waitcnt lgkmcnt(9)
    v_mfma_f32_16x16x32_bf16 v[64:67], a[16:19], a[0:3], v[64:67]
    s_add_u32 m0, s59, 16384
    ds_read_b128 a[32:35], v6 offset:8192
    s_waitcnt lgkmcnt(9)
    v_mfma_f32_16x16x32_bf16 v[72:75], a[16:19], a[4:7], v[72:75]
    ds_read_b64_tr_b16 a[48:49], v12 offset:8192
    buffer_load_dwordx4 v16, s[24:27], s57 offen offset:0 sc1 lds
    s_waitcnt lgkmcnt(9)
    v_mfma_f32_16x16x32_bf16 v[80:83], a[16:19], a[8:11], v[80:83]
    s_add_u32 s59, s58, s60
    ds_read_b64_tr_b16 a[50:51], v12 offset:12288
    s_waitcnt lgkmcnt(9)
    v_mfma_f32_16x16x32_bf16 v[88:91], a[16:19], a[12:15], v[88:91]
    s_add_u32 s58, s58, 32768
    ds_read_b128 a[36:39], v6 offset:9216
    s_waitcnt lgkmcnt(8)
    v_mfma_f32_16x16x32_bf16 v[68:71], a[20:23], a[0:3], v[68:71]
    s_cmp_ge_u32 s58, 163840
    ds_read_b128 a[40:43], v6 offset:10240
    v_mfma_f32_16x16x32_bf16 v[76:79], a[20:23], a[4:7], v[76:79]
    ds_read_b128 a[44:47], v6 offset:11264
    buffer_load_dwordx4 v17, s[24:27], s57 offen offset:1024 sc1 lds
    v_mfma_f32_16x16x32_bf16 v[84:87], a[20:23], a[8:11], v[84:87]
    s_cselect_b32 s66, 4294836224, s100
    ds_read_b64_tr_b16 a[52:53], v13 offset:8192
    v_mfma_f32_16x16x32_bf16 v[92:95], a[20:23], a[12:15], v[92:95]
    s_cselect_b32 s58, 0, s58
    ds_read_b64_tr_b16 a[54:55], v13 offset:12288
    s_waitcnt lgkmcnt(10)
    v_mfma_f32_16x16x32_bf16 v[96:99], a[24:27], a[0:3], v[96:99]
    ds_read_b64_tr_b16 a[56:57], v14 offset:8192
    v_mfma_f32_16x16x32_bf16 v[104:107], a[24:27], a[4:7], v[104:107]
    ds_read_b64_tr_b16 a[58:59], v14 offset:12288
    buffer_load_dwordx4 v18, s[24:27], s57 offen offset:2048 sc1 lds
    v_mfma_f32_16x16x32_bf16 v[112:115], a[24:27], a[8:11], v[112:115]
    ds_read_b64_tr_b16 a[60:61], v15 offset:8192
    v_mfma_f32_16x16x32_bf16 v[120:123], a[24:27], a[12:15], v[120:123]
    ds_read_b64_tr_b16 a[62:63], v15 offset:12288
    buffer_store_dwordx4 v[136:139], v2, s[8:11], s70 offen offset:2048 sc1
    s_waitcnt lgkmcnt(12)
    v_mfma_f32_16x16x32_bf16 v[100:103], a[28:31], a[0:3], v[100:103]
    v_add_u32 v6, s66, v6
    v_add_u32 v12, s66, v12
    v_mfma_f32_16x16x32_bf16 v[108:111], a[28:31], a[4:7], v[108:111]
    buffer_load_dwordx4 v19, s[24:27], s57 offen offset:3072 sc1 lds
    v_mfma_f32_16x16x32_bf16 v[116:119], a[28:31], a[8:11], v[116:119]
    s_add_u32 s57, s57, 131072
    v_add_u32 v13, s66, v13
    v_add_u32 v14, s66, v14
    v_mfma_f32_16x16x32_bf16 v[124:127], a[28:31], a[12:15], v[124:127]
    s_mov_b32 m0, s59
    v_add_u32 v15, s66, v15
    s_waitcnt vmcnt(24) lgkmcnt(0)
    v_mfma_f32_16x16x32_bf16 v[64:67], a[48:51], a[32:35], v[64:67]
    s_barrier
    v_mfma_f32_16x16x32_bf16 v[72:75], a[48:51], a[36:39], v[72:75]
    ds_read_b128 a[0:3], v6 offset:0
    buffer_load_dwordx4 v2, s[36:39], s56 offen offset:0 sc1 lds
    v_mfma_f32_16x16x32_bf16 v[80:83], a[48:51], a[40:43], v[80:83]
    ds_read_b64_tr_b16 a[16:17], v12 offset:0
    v_mfma_f32_16x16x32_bf16 v[88:91], a[48:51], a[44:47], v[88:91]
    ds_read_b64_tr_b16 a[18:19], v12 offset:4096
    v_mfma_f32_16x16x32_bf16 v[68:71], a[52:55], a[32:35], v[68:71]
    ds_read_b128 a[4:7], v6 offset:1024
    v_mfma_f32_16x16x32_bf16 v[76:79], a[52:55], a[36:39], v[76:79]
    ds_read_b128 a[8:11], v6 offset:2048
    buffer_load_dwordx4 v2, s[36:39], s56 offen offset:1024 sc1 lds
    v_mfma_f32_16x16x32_bf16 v[84:87], a[52:55], a[40:43], v[84:87]
    ds_read_b128 a[12:15], v6 offset:3072
    v_mfma_f32_16x16x32_bf16 v[92:95], a[52:55], a[44:47], v[92:95]
    ds_read_b64_tr_b16 a[20:21], v13 offset:0
    v_mfma_f32_16x16x32_bf16 v[96:99], a[56:59], a[32:35], v[96:99]
    ds_read_b64_tr_b16 a[22:23], v13 offset:4096
    v_mfma_f32_16x16x32_bf16 v[104:107], a[56:59], a[36:39], v[104:107]
    ds_read_b64_tr_b16 a[24:25], v14 offset:0
    buffer_load_dwordx4 v2, s[36:39], s56 offen offset:2048 sc1 lds
    v_mfma_f32_16x16x32_bf16 v[112:115], a[56:59], a[40:43], v[112:115]
    ds_read_b64_tr_b16 a[26:27], v14 offset:4096
    v_mfma_f32_16x16x32_bf16 v[120:123], a[56:59], a[44:47], v[120:123]
    ds_read_b64_tr_b16 a[28:29], v15 offset:0
    buffer_store_dwordx4 v[140:143], v2, s[8:11], s70 offen offset:3072 sc1
    s_add_u32 s70, s70, 4096
    v_mfma_f32_16x16x32_bf16 v[100:103], a[60:63], a[32:35], v[100:103]
    s_add_u32 s64, s64, 1
    ds_read_b64_tr_b16 a[30:31], v15 offset:4096
    v_mfma_f32_16x16x32_bf16 v[108:111], a[60:63], a[36:39], v[108:111]
    buffer_load_dwordx4 v2, s[36:39], s56 offen offset:3072 sc1 lds
    v_mfma_f32_16x16x32_bf16 v[116:119], a[60:63], a[40:43], v[116:119]
    s_add_u32 s56, s56, 262144
    v_mfma_f32_16x16x32_bf16 v[124:127], a[60:63], a[44:47], v[124:127]
    s_waitcnt lgkmcnt(9)
    v_mfma_f32_16x16x32_bf16 v[64:67], a[16:19], a[0:3], v[64:67]
    s_add_u32 m0, s59, 16384
    ds_read_b128 a[32:35], v6 offset:8192
    s_waitcnt lgkmcnt(9)
    v_mfma_f32_16x16x32_bf16 v[72:75], a[16:19], a[4:7], v[72:75]
    ds_read_b64_tr_b16 a[48:49], v12 offset:8192
    buffer_load_dwordx4 v16, s[24:27], s57 offen offset:0 sc1 lds
    s_waitcnt lgkmcnt(9)
    v_mfma_f32_16x16x32_bf16 v[80:83], a[16:19], a[8:11], v[80:83]
    s_add_u32 s59, s58, s60
    ds_read_b64_tr_b16 a[50:51], v12 offset:12288
    s_waitcnt lgkmcnt(9)
    v_mfma_f32_16x16x32_bf16 v[88:91], a[16:19], a[12:15], v[88:91]
    s_add_u32 s58, s58, 32768
    ds_read_b128 a[36:39], v6 offset:9216
    s_waitcnt lgkmcnt(8)
    v_mfma_f32_16x16x32_bf16 v[68:71], a[20:23], a[0:3], v[68:71]
    s_cmp_ge_u32 s58, 163840
    ds_read_b128 a[40:43], v6 offset:10240
    v_mfma_f32_16x16x32_bf16 v[76:79], a[20:23], a[4:7], v[76:79]
    ds_read_b128 a[44:47], v6 offset:11264
    buffer_load_dwordx4 v17, s[24:27], s57 offen offset:1024 sc1 lds
    v_mfma_f32_16x16x32_bf16 v[84:87], a[20:23], a[8:11], v[84:87]
    s_cselect_b32 s66, 4294836224, s100
    ds_read_b64_tr_b16 a[52:53], v13 offset:8192
    v_mfma_f32_16x16x32_bf16 v[92:95], a[20:23], a[12:15], v[92:95]
    s_cselect_b32 s58, 0, s58
    ds_read_b64_tr_b16 a[54:55], v13 offset:12288
    s_waitcnt lgkmcnt(10)
    v_mfma_f32_16x16x32_bf16 v[96:99], a[24:27], a[0:3], v[96:99]
    ds_read_b64_tr_b16 a[56:57], v14 offset:8192
    v_mfma_f32_16x16x32_bf16 v[104:107], a[24:27], a[4:7], v[104:107]
    ds_read_b64_tr_b16 a[58:59], v14 offset:12288
    buffer_load_dwordx4 v18, s[24:27], s57 offen offset:2048 sc1 lds
    v_mfma_f32_16x16x32_bf16 v[112:115], a[24:27], a[8:11], v[112:115]
    ds_read_b64_tr_b16 a[60:61], v15 offset:8192
    v_mfma_f32_16x16x32_bf16 v[120:123], a[24:27], a[12:15], v[120:123]
    ds_read_b64_tr_b16 a[62:63], v15 offset:12288
    buffer_store_dwordx4 v[144:147], v2, s[8:11], s70 offen offset:0 sc1
    s_waitcnt lgkmcnt(12)
    v_mfma_f32_16x16x32_bf16 v[100:103], a[28:31], a[0:3], v[100:103]
    v_add_u32 v6, s66, v6
    v_add_u32 v12, s66, v12
    v_mfma_f32_16x16x32_bf16 v[108:111], a[28:31], a[4:7], v[108:111]
    buffer_load_dwordx4 v19, s[24:27], s57 offen offset:3072 sc1 lds
    v_mfma_f32_16x16x32_bf16 v[116:119], a[28:31], a[8:11], v[116:119]
    s_add_u32 s57, s57, 131072
    v_add_u32 v13, s66, v13
    v_add_u32 v14, s66, v14
    v_mfma_f32_16x16x32_bf16 v[124:127], a[28:31], a[12:15], v[124:127]
    s_mov_b32 m0, s59
    v_add_u32 v15, s66, v15
    s_waitcnt vmcnt(24) lgkmcnt(0)
    v_mfma_f32_16x16x32_bf16 v[64:67], a[48:51], a[32:35], v[64:67]
    s_barrier
    v_mfma_f32_16x16x32_bf16 v[72:75], a[48:51], a[36:39], v[72:75]
    ds_read_b128 a[0:3], v6 offset:0
    buffer_load_dwordx4 v2, s[36:39], s56 offen offset:0 sc1 lds
    v_mfma_f32_16x16x32_bf16 v[80:83], a[48:51], a[40:43], v[80:83]
    ds_read_b64_tr_b16 a[16:17], v12 offset:0
    v_mfma_f32_16x16x32_bf16 v[88:91], a[48:51], a[44:47], v[88:91]
    ds_read_b64_tr_b16 a[18:19], v12 offset:4096
    v_mfma_f32_16x16x32_bf16 v[68:71], a[52:55], a[32:35], v[68:71]
    ds_read_b128 a[4:7], v6 offset:1024
    v_mfma_f32_16x16x32_bf16 v[76:79], a[52:55], a[36:39], v[76:79]
    ds_read_b128 a[8:11], v6 offset:2048
    buffer_load_dwordx4 v2, s[36:39], s56 offen offset:1024 sc1 lds
    v_mfma_f32_16x16x32_bf16 v[84:87], a[52:55], a[40:43], v[84:87]
    ds_read_b128 a[12:15], v6 offset:3072
    v_mfma_f32_16x16x32_bf16 v[92:95], a[52:55], a[44:47], v[92:95]
    ds_read_b64_tr_b16 a[20:21], v13 offset:0
    v_mfma_f32_16x16x32_bf16 v[96:99], a[56:59], a[32:35], v[96:99]
    ds_read_b64_tr_b16 a[22:23], v13 offset:4096
    v_mfma_f32_16x16x32_bf16 v[104:107], a[56:59], a[36:39], v[104:107]
    ds_read_b64_tr_b16 a[24:25], v14 offset:0
    buffer_load_dwordx4 v2, s[36:39], s56 offen offset:2048 sc1 lds
    v_mfma_f32_16x16x32_bf16 v[112:115], a[56:59], a[40:43], v[112:115]
    ds_read_b64_tr_b16 a[26:27], v14 offset:4096
    v_mfma_f32_16x16x32_bf16 v[120:123], a[56:59], a[44:47], v[120:123]
    ds_read_b64_tr_b16 a[28:29], v15 offset:0
    buffer_store_dwordx4 v[148:151], v2, s[8:11], s70 offen offset:1024 sc1
    v_mfma_f32_16x16x32_bf16 v[100:103], a[60:63], a[32:35], v[100:103]
    s_add_u32 s64, s64, 1
    ds_read_b64_tr_b16 a[30:31], v15 offset:4096
    v_mfma_f32_16x16x32_bf16 v[108:111], a[60:63], a[36:39], v[108:111]
    buffer_load_dwordx4 v2, s[36:39], s56 offen offset:3072 sc1 lds
    v_mfma_f32_16x16x32_bf16 v[116:119], a[60:63], a[40:43], v[116:119]
    s_add_u32 s56, s56, 262144
    v_mfma_f32_16x16x32_bf16 v[124:127], a[60:63], a[44:47], v[124:127]
    s_waitcnt lgkmcnt(9)
    v_mfma_f32_16x16x32_bf16 v[64:67], a[16:19], a[0:3], v[64:67]
    s_add_u32 m0, s59, 16384
    ds_read_b128 a[32:35], v6 offset:8192
    s_waitcnt lgkmcnt(9)
    v_mfma_f32_16x16x32_bf16 v[72:75], a[16:19], a[4:7], v[72:75]
    ds_read_b64_tr_b16 a[48:49], v12 offset:8192
    buffer_load_dwordx4 v16, s[24:27], s57 offen offset:0 sc1 lds
    s_waitcnt lgkmcnt(9)
    v_mfma_f32_16x16x32_bf16 v[80:83], a[16:19], a[8:11], v[80:83]
    s_add_u32 s59, s58, s60
    ds_read_b64_tr_b16 a[50:51], v12 offset:12288
    s_waitcnt lgkmcnt(9)
    v_mfma_f32_16x16x32_bf16 v[88:91], a[16:19], a[12:15], v[88:91]
    s_add_u32 s58, s58, 32768
    ds_read_b128 a[36:39], v6 offset:9216
    s_waitcnt lgkmcnt(8)
    v_mfma_f32_16x16x32_bf16 v[68:71], a[20:23], a[0:3], v[68:71]
    s_cmp_ge_u32 s58, 163840
    ds_read_b128 a[40:43], v6 offset:10240
    v_mfma_f32_16x16x32_bf16 v[76:79], a[20:23], a[4:7], v[76:79]
    ds_read_b128 a[44:47], v6 offset:11264
    buffer_load_dwordx4 v17, s[24:27], s57 offen offset:1024 sc1 lds
    v_mfma_f32_16x16x32_bf16 v[84:87], a[20:23], a[8:11], v[84:87]
    s_cselect_b32 s66, 4294836224, s100
    ds_read_b64_tr_b16 a[52:53], v13 offset:8192
    v_mfma_f32_16x16x32_bf16 v[92:95], a[20:23], a[12:15], v[92:95]
    s_cselect_b32 s58, 0, s58
    ds_read_b64_tr_b16 a[54:55], v13 offset:12288
    s_waitcnt lgkmcnt(10)
    v_mfma_f32_16x16x32_bf16 v[96:99], a[24:27], a[0:3], v[96:99]
    ds_read_b64_tr_b16 a[56:57], v14 offset:8192
    v_mfma_f32_16x16x32_bf16 v[104:107], a[24:27], a[4:7], v[104:107]
    ds_read_b64_tr_b16 a[58:59], v14 offset:12288
    buffer_load_dwordx4 v18, s[24:27], s57 offen offset:2048 sc1 lds
    v_mfma_f32_16x16x32_bf16 v[112:115], a[24:27], a[8:11], v[112:115]
    ds_read_b64_tr_b16 a[60:61], v15 offset:8192
    v_mfma_f32_16x16x32_bf16 v[120:123], a[24:27], a[12:15], v[120:123]
    ds_read_b64_tr_b16 a[62:63], v15 offset:12288
    buffer_store_dwordx4 v[152:155], v2, s[8:11], s70 offen offset:2048 sc1
    s_waitcnt lgkmcnt(12)
    v_mfma_f32_16x16x32_bf16 v[100:103], a[28:31], a[0:3], v[100:103]
    v_add_u32 v6, s66, v6
    v_add_u32 v12, s66, v12
    v_mfma_f32_16x16x32_bf16 v[108:111], a[28:31], a[4:7], v[108:111]
    buffer_load_dwordx4 v19, s[24:27], s57 offen offset:3072 sc1 lds
    v_mfma_f32_16x16x32_bf16 v[116:119], a[28:31], a[8:11], v[116:119]
    s_add_u32 s57, s57, 131072
    v_add_u32 v13, s66, v13
    v_add_u32 v14, s66, v14
    v_mfma_f32_16x16x32_bf16 v[124:127], a[28:31], a[12:15], v[124:127]
    s_mov_b32 m0, s59
    v_add_u32 v15, s66, v15
    s_waitcnt vmcnt(24) lgkmcnt(0)
    v_mfma_f32_16x16x32_bf16 v[64:67], a[48:51], a[32:35], v[64:67]
    s_barrier
    v_mfma_f32_16x16x32_bf16 v[72:75], a[48:51], a[36:39], v[72:75]
    ds_read_b128 a[0:3], v6 offset:0
    buffer_load_dwordx4 v2, s[36:39], s56 offen offset:0 sc1 lds
    v_mfma_f32_16x16x32_bf16 v[80:83], a[48:51], a[40:43], v[80:83]
    ds_read_b64_tr_b16 a[16:17], v12 offset:0
    v_mfma_f32_16x16x32_bf16 v[88:91], a[48:51], a[44:47], v[88:91]
    ds_read_b64_tr_b16 a[18:19], v12 offset:4096
    v_mfma_f32_16x16x32_bf16 v[68:71], a[52:55], a[32:35], v[68:71]
    ds_read_b128 a[4:7], v6 offset:1024
    v_mfma_f32_16x16x32_bf16 v[76:79], a[52:55], a[36:39], v[76:79]
    ds_read_b128 a[8:11], v6 offset:2048
    buffer_load_dwordx4 v2, s[36:39], s56 offen offset:1024 sc1 lds
    v_mfma_f32_16x16x32_bf16 v[84:87], a[52:55], a[40:43], v[84:87]
    ds_read_b128 a[12:15], v6 offset:3072
    v_mfma_f32_16x16x32_bf16 v[92:95], a[52:55], a[44:47], v[92:95]
    ds_read_b64_tr_b16 a[20:21], v13 offset:0
    v_mfma_f32_16x16x32_bf16 v[96:99], a[56:59], a[32:35], v[96:99]
    ds_read_b64_tr_b16 a[22:23], v13 offset:4096
    v_mfma_f32_16x16x32_bf16 v[104:107], a[56:59], a[36:39], v[104:107]
    ds_read_b64_tr_b16 a[24:25], v14 offset:0
    buffer_load_dwordx4 v2, s[36:39], s56 offen offset:2048 sc1 lds
    v_mfma_f32_16x16x32_bf16 v[112:115], a[56:59], a[40:43], v[112:115]
    ds_read_b64_tr_b16 a[26:27], v14 offset:4096
    v_mfma_f32_16x16x32_bf16 v[120:123], a[56:59], a[44:47], v[120:123]
    ds_read_b64_tr_b16 a[28:29], v15 offset:0
    buffer_store_dwordx4 v[156:159], v2, s[8:11], s70 offen offset:3072 sc1
    s_add_u32 s70, s70, 4096
    v_mfma_f32_16x16x32_bf16 v[100:103], a[60:63], a[32:35], v[100:103]
    s_add_u32 s64, s64, 1
    ds_read_b64_tr_b16 a[30:31], v15 offset:4096
    v_mfma_f32_16x16x32_bf16 v[108:111], a[60:63], a[36:39], v[108:111]
    buffer_load_dwordx4 v2, s[36:39], s56 offen offset:3072 sc1 lds
    v_mfma_f32_16x16x32_bf16 v[116:119], a[60:63], a[40:43], v[116:119]
    s_add_u32 s56, s56, 262144
    v_mfma_f32_16x16x32_bf16 v[124:127], a[60:63], a[44:47], v[124:127]
    s_mov_b32 s67, 32
    s_branch m_l3130
m_n161:
    s_cmp_lg_u32 s64, 32
    s_cbranch_scc1 m_n162
    s_lshl_b32 s91, s96, 3
    s_add_u32 s91, s91, s97
    s_lshl_b32 s91, s91, 7
    s_add_u32 s91, s91, 16384
    s_cmp_lg_u32 s16, 0
    s_cbranch_scc1 m_np163
    v_mov_b32 v60, s4
    v_mov_b32 v61, s5
    s_add_u32 s90, s91, 117440512
    s_mov_b64 exec, 1
    buffer_store_dwordx2 v[60:61], off, s[8:11], s90 sc1
    s_mov_b64 exec, -1
m_np163:
    s_mov_b32 s67, 35
    s_branch m_l3130
m_n162:
    s_cmp_lg_u32 s64, 35
    s_cbranch_scc1 m_n164
    s_mov_b32 s38, 0
    s_mov_b32 s67, 40
    s_branch m_l3130
m_n164:
    s_branch m_l3x132
m_l3c133:
    s_mov_b32 s67, 34
    s_cmp_lt_u32 s64, 34
    s_cbranch_scc1 m_l3n134
    s_cmp_lg_u32 s64, 34
    s_cbranch_scc1 m_n166
    s_mov_b32 s68, 1000
    s_mov_b32 s67, 35
    s_branch m_l3130
m_n166:
    s_cmp_lg_u32 s64, 35
    s_cbranch_scc1 m_n167
    s_mov_b32 s38, 0
    s_lshl_b32 s91, s96, 3
    s_add_u32 s91, s91, s97
    s_lshl_b32 s91, s91, 7
    s_add_u32 s91, s91, 16384
    s_add_u32 s52, s91, 117440512
    buffer_load_dwordx2 v[4:5], off, s[8:11], s52 sc1
    s_mov_b32 s67, 36
    s_branch m_l3130
m_n167:
    s_cmp_lg_u32 s64, 36
    s_cbranch_scc1 m_n168
    s_mov_b32 s26, 0
    s_mov_b32 s67, 37
    s_branch m_l3130
m_n168:
    s_cmp_lg_u32 s64, 37
    s_cbranch_scc1 m_n169
    s_waitcnt vmcnt(16)
    s_mov_b32 s3, 1048576
m_spin170:
    v_cmp_ne_u64 s[76:77], s[4:5], v[4:5]
    s_nop 3
    s_cmp_eq_u64 s[76:77], 0
    s_cbranch_scc1 m_ok171
    s_sub_u32 s3, s3, 1
    s_cbranch_scc1 m_ok171
    s_sleep 8
    buffer_load_dwordx2 v[4:5], off, s[8:11], s52 sc1
    s_waitcnt vmcnt(0)
    s_branch m_spin170
m_ok171:
    s_lshl_b32 s90, s96, 3
    s_add_u32 s90, s90, s97
    s_lshl_b32 s90, s90, 15
    s_lshl_b32 s91, s16, 13
    s_add_u32 s90, s90, s91
    s_add_u32 s70, s90, 100663296
    buffer_load_dwordx4 v[128:131], v2, s[8:11], s70 offen offset:0 sc1
    buffer_load_dwordx4 v[132:135], v2, s[8:11], s70 offen offset:1024 sc1
    buffer_load_dwordx4 v[136:139], v2, s[8:11], s70 offen offset:2048 sc1
    buffer_load_dwordx4 v[140:143], v2, s[8:11], s70 offen offset:3072 sc1
    s_add_u32 s70, s70, 4096
    buffer_load_dwordx4 v[144:147], v2, s[8:11], s70 offen offset:0 sc1
    buffer_load_dwordx4 v[148:151], v2, s[8:11], s70 offen offset:1024 sc1
    buffer_load_dwordx4 v[152:155], v2, s[8:11], s70 offen offset:2048 sc1
    buffer_load_dwordx4 v[156:159], v2, s[8:11], s70 offen offset:3072 sc1
    s_mov_b32 s67, 40
    s_branch m_l3130
m_n169:
    s_branch m_l3x132
m_o1154:
    s_and_b32 s91, s2, 7
    s_lshl_b32 s91, s91, 5
    s_lshr_b32 s92, s2, 3
    s_add_u32 s91, s91, s92
    s_lshl_b32 s91, s91, 3
    s_add_u32 s91, s91, 12288
    s_cmp_lg_u32 s16, 0
    s_cbranch_scc1 m_np173
    v_mov_b32 v60, s4
    v_mov_b32 v61, s5
    s_add_u32 s90, s91, 117440512
    s_mov_b64 exec, 1
    buffer_store_dwordx2 v[60:61], off, s[8:11], s90 sc1
    s_mov_b64 exec, -1
m_np173:
    s_branch m_o2155
m_l3n134:
    s_sub_u32 s90, s68, 5
    s_min_u32 s67, s67, s90
    s_branch m_l3130
m_l3x132:
    s_cmp_eq_u32 s95, 1
    s_cbranch_scc1 m_noadd174
    s_waitcnt vmcnt(0)
    v_lshlrev_b32 v160, 16, v128
    v_and_b32 v161, 0xffff0000, v128
    v_lshlrev_b32 v162, 16, v129
    v_and_b32 v163, 0xffff0000, v129
    v_lshlrev_b32 v164, 16, v130
    v_and_b32 v165, 0xffff0000, v130
    v_lshlrev_b32 v166, 16, v131
    v_and_b32 v167, 0xffff0000, v131
    v_lshlrev_b32 v168, 16, v132
    v_and_b32 v169, 0xffff0000, v132
    v_lshlrev_b32 v170, 16, v133
    v_and_b32 v171, 0xffff0000, v133
    v_lshlrev_b32 v172, 16, v134
    v_and_b32 v173, 0xffff0000, v134
    v_lshlrev_b32 v174, 16, v135
    v_and_b32 v175, 0xffff0000, v135
    v_lshlrev_b32 v176, 16, v136
    v_and_b32 v177, 0xffff0000, v136
    v_lshlrev_b32 v178, 16, v137
    v_and_b32 v179, 0xffff0000, v137
    v_lshlrev_b32 v180, 16, v138
    v_and_b32 v181, 0xffff0000, v138
    v_lshlrev_b32 v182, 16, v139
    v_and_b32 v183, 0xffff0000, v139
    v_lshlrev_b32 v184, 16, v140
    v_and_b32 v185, 0xffff0000, v140
    v_lshlrev_b32 v186, 16, v141
    v_and_b32 v187, 0xffff0000, v141
    v_lshlrev_b32 v188, 16, v142
    v_and_b32 v189, 0xffff0000, v142
    v_lshlrev_b32 v190, 16, v143
    v_and_b32 v191, 0xffff0000, v143
    v_lshlrev_b32 v192, 16, v144
    v_and_b32 v193, 0xffff0000, v144
    v_lshlrev_b32 v194, 16, v145
    v_and_b32 v195, 0xffff0000, v145
    v_lshlrev_b32 v196, 16, v146
    v_and_b32 v197, 0xffff0000, v146
    v_lshlrev_b32 v198, 16, v147
    v_and_b32 v199, 0xffff0000, v147
    v_lshlrev_b32 v200, 16, v148
    v_and_b32 v201, 0xffff0000, v148
    v_lshlrev_b32 v202, 16, v149
    v_and_b32 v203, 0xffff0000, v149
    v_lshlrev_b32 v204, 16, v150
    v_and_b32 v205, 0xffff0000, v150
    v_lshlrev_b32 v206, 16, v151
    v_and_b32 v207, 0xffff0000, v151
    v_lshlrev_b32 v208, 16, v152
    v_and_b32 v209, 0xffff0000, v152
    v_lshlrev_b32 v210, 16, v153
    v_and_b32 v211, 0xffff0000, v153
    v_lshlrev_b32 v212, 16, v154
    v_and_b32 v213, 0xffff0000, v154
    v_lshlrev_b32 v214, 16, v155
    v_and_b32 v215, 0xffff0000, v155
    v_lshlrev_b32 v216, 16, v156
    v_and_b32 v217, 0xffff0000, v156
    v_lshlrev_b32 v218, 16, v157
    v_and_b32 v219, 0xffff0000, v157
    v_lshlrev_b32 v220, 16, v158
    v_and_b32 v221, 0xffff0000, v158
    v_lshlrev_b32 v222, 16, v159
    v_and_b32 v223, 0xffff0000, v159
    v_pk_add_f32 v[64:65], v[64:65], v[160:161]
    v_pk_add_f32 v[66:67], v[66:67], v[162:163]
    v_pk_add_f32 v[68:69], v[68:69], v[164:165]
    v_pk_add_f32 v[70:71], v[70:71], v[166:167]
    v_pk_add_f32 v[72:73], v[72:73], v[168:169]
    v_pk_add_f32 v[74:75], v[74:75], v[170:171]
    v_pk_add_f32 v[76:77], v[76:77], v[172:173]
    v_pk_add_f32 v[78:79], v[78:79], v[174:175]
    v_pk_add_f32 v[80:81], v[80:81], v[176:177]
    v_pk_add_f32 v[82:83], v[82:83], v[178:179]
    v_pk_add_f32 v[84:85], v[84:85], v[180:181]
    v_pk_add_f32 v[86:87], v[86:87], v[182:183]
    v_pk_add_f32 v[88:89], v[88:89], v[184:185]
    v_pk_add_f32 v[90:91], v[90:91], v[186:187]
    v_pk_add_f32 v[92:93], v[92:93], v[188:189]
    v_pk_add_f32 v[94:95], v[94:95], v[190:191]
    v_pk_add_f32 v[96:97], v[96:97], v[192:193]
    v_pk_add_f32 v[98:99], v[98:99], v[194:195]
    v_pk_add_f32 v[100:101], v[100:101], v[196:197]
    v_pk_add_f32 v[102:103], v[102:103], v[198:199]
    v_pk_add_f32 v[104:105], v[104:105], v[200:201]
    v_pk_add_f32 v[106:107], v[106:107], v[202:203]
    v_pk_add_f32 v[108:109], v[108:109], v[204:205]
    v_pk_add_f32 v[110:111], v[110:111], v[206:207]
    v_pk_add_f32 v[112:113], v[112:113], v[208:209]
    v_pk_add_f32 v[114:115], v[114:115], v[210:211]
    v_pk_add_f32 v[116:117], v[116:117], v[212:213]
    v_pk_add_f32 v[118:119], v[118:119], v[214:215]
    v_pk_add_f32 v[120:121], v[120:121], v[216:217]
    v_pk_add_f32 v[122:123], v[122:123], v[218:219]
    v_pk_add_f32 v[124:125], v[124:125], v[220:221]
    v_pk_add_f32 v[126:127], v[126:127], v[222:223]
m_noadd174:
    v_cvt_pk_bf16_f32 v64, v64, v65
    v_cvt_pk_bf16_f32 v65, v66, v67
    v_cvt_pk_bf16_f32 v66, v68, v69
    v_cvt_pk_bf16_f32 v67, v70, v71
    v_cvt_pk_bf16_f32 v96, v96, v97
    v_cvt_pk_bf16_f32 v97, v98, v99
    v_cvt_pk_bf16_f32 v98, v100, v101
    v_cvt_pk_bf16_f32 v99, v102, v103
    s_nop 1
    v_permlane16_swap_b32 v64, v66
    v_permlane16_swap_b32 v65, v67
    v_permlane16_swap_b32 v96, v98
    v_permlane16_swap_b32 v97, v99
    buffer_store_dwordx4 v[64:67], v7, s[28:31], s71 offen offset:0 sc1
    buffer_store_dwordx4 v[96:99], v7, s[28:31], s71 offen offset:64 sc1
    s_add_u32 s71, s71, s72
    v_cvt_pk_bf16_f32 v72, v72, v73
    v_cvt_pk_bf16_f32 v73, v74, v75
    v_cvt_pk_bf16_f32 v74, v76, v77
    v_cvt_pk_bf16_f32 v75, v78, v79
    v_cvt_pk_bf16_f32 v104, v104, v105
    v_cvt_pk_bf16_f32 v105, v106, v107
    v_cvt_pk_bf16_f32 v106, v108, v109
    v_cvt_pk_bf16_f32 v107, v110, v111
    s_nop 1
    v_permlane16_swap_b32 v72, v74
    v_permlane16_swap_b32 v73, v75
    v_permlane16_swap_b32 v104, v106
    v_permlane16_swap_b32 v105, v107
    buffer_store_dwordx4 v[72:75], v7, s[28:31], s71 offen offset:0 sc1
    buffer_store_dwordx4 v[104:107], v7, s[28:31], s71 offen offset:64 sc1
    s_add_u32 s71, s71, s72
    v_cvt_pk_bf16_f32 v80, v80, v81
    v_cvt_pk_bf16_f32 v81, v82, v83
    v_cvt_pk_bf16_f32 v82, v84, v85
    v_cvt_pk_bf16_f32 v83, v86, v87
    v_cvt_pk_bf16_f32 v112, v112, v113
    v_cvt_pk_bf16_f32 v113, v114, v115
    v_cvt_pk_bf16_f32 v114, v116, v117
    v_cvt_pk_bf16_f32 v115, v118, v119
    s_nop 1
    v_permlane16_swap_b32 v80, v82
    v_permlane16_swap_b32 v81, v83
    v_permlane16_swap_b32 v112, v114
    v_permlane16_swap_b32 v113, v115
    buffer_store_dwordx4 v[80:83], v7, s[28:31], s71 offen offset:0 sc1
    buffer_store_dwordx4 v[112:115], v7, s[28:31], s71 offen offset:64 sc1
    s_add_u32 s71, s71, s72
    v_cvt_pk_bf16_f32 v88, v88, v89
    v_cvt_pk_bf16_f32 v89, v90, v91
    v_cvt_pk_bf16_f32 v90, v92, v93
    v_cvt_pk_bf16_f32 v91, v94, v95
    v_cvt_pk_bf16_f32 v120, v120, v121
    v_cvt_pk_bf16_f32 v121, v122, v123
    v_cvt_pk_bf16_f32 v122, v124, v125
    v_cvt_pk_bf16_f32 v123, v126, v127
    s_nop 1
    v_permlane16_swap_b32 v88, v90
    v_permlane16_swap_b32 v89, v91
    v_permlane16_swap_b32 v120, v122
    v_permlane16_swap_b32 v121, v123
    buffer_store_dwordx4 v[88:91], v7, s[28:31], s71 offen offset:0 sc1
    buffer_store_dwordx4 v[120:123], v7, s[28:31], s71 offen offset:64 sc1
    s_add_u32 s71, s71, s72
m_end1:
    s_endpgm
m_stub76:
    v_cmp_lt_f32 vcc, s65, v8
    s_cmp_lg_u32 s64, s67
    s_cbranch_scc1 m_e176
    v_add_f32 v176, v176, v16
    v_mov_b32 v180, v9
    v_add_f32 v188, v188, v16
    v_add_f32 v177, v177, v17
    v_mov_b32 v181, v9
    v_add_f32 v189, v189, v17
    v_add_f32 v178, v178, v18
    v_mov_b32 v182, v9
    v_add_f32 v190, v190, v18
    v_add_f32 v179, v179, v19
    v_mov_b32 v183, v9
    v_add_f32 v191, v191, v19
    s_nop 0
m_e176:
    s_cmp_lg_u32 s64, s68
    s_cbranch_scc1 m_e177
    v_mov_b32 v176, v9
    v_mov_b32 v184, v9
    v_mov_b32 v188, v9
    v_mov_b32 v177, v9
    v_mov_b32 v185, v9
    v_mov_b32 v189, v9
    v_mov_b32 v178, v9
    v_mov_b32 v186, v9
    v_mov_b32 v190, v9
    v_mov_b32 v179, v9
    v_mov_b32 v187, v9
    v_mov_b32 v191, v9
    s_nop 0
m_e177:
    s_cbranch_vccnz m_rc178
m_sp175:
    s_branch m_ret77
m_stub79:
    v_cmp_lt_f32 vcc, s65, v8
    s_cmp_lg_u32 s64, s67
    s_cbranch_scc1 m_e180
    v_add_f32 v176, v176, v16
    v_mov_b32 v180, v9
    v_add_f32 v188, v188, v16
    v_add_f32 v177, v177, v17
    v_mov_b32 v181, v9
    v_add_f32 v189, v189, v17
    v_add_f32 v178, v178, v18
    v_mov_b32 v182, v9
    v_add_f32 v190, v190, v18
    v_add_f32 v179, v179, v19
    v_mov_b32 v183, v9
    v_add_f32 v191, v191, v19
    s_nop 0
m_e180:
    s_cmp_lg_u32 s64, s68
    s_cbranch_scc1 m_e181
    v_mov_b32 v176, v9
    v_mov_b32 v184, v9
    v_mov_b32 v188, v9
    v_mov_b32 v177, v9
    v_mov_b32 v185, v9
    v_mov_b32 v189, v9
    v_mov_b32 v178, v9
    v_mov_b32 v186, v9
    v_mov_b32 v190, v9
    v_mov_b32 v179, v9
    v_mov_b32 v187, v9
    v_mov_b32 v191, v9
    s_nop 0
m_e181:
    s_cbranch_vccnz m_rc182
m_sp179:
    s_branch m_ret80
m_stub97:
    v_cmp_lt_f32 vcc, s65, v8
    s_cmp_lg_u32 s64, s70
    s_cbranch_scc1 m_e184
    v_add_f32 v160, v160, v16
    v_mov_b32 v164, v9
    v_add_f32 v172, v172, v16
    v_add_f32 v161, v161, v17
    v_mov_b32 v165, v9
    v_add_f32 v173, v173, v17
    v_add_f32 v162, v162, v18
    v_mov_b32 v166, v9
    v_add_f32 v174, v174, v18
    v_add_f32 v163, v163, v19
    v_mov_b32 v167, v9
    v_add_f32 v175, v175, v19
    s_nop 0
m_e184:
    s_cmp_lg_u32 s64, s71
    s_cbranch_scc1 m_e185
    v_mov_b32 v160, v9
    v_mov_b32 v168, v9
    v_mov_b32 v172, v9
    v_mov_b32 v161, v9
    v_mov_b32 v169, v9
    v_mov_b32 v173, v9
    v_mov_b32 v162, v9
    v_mov_b32 v170, v9
    v_mov_b32 v174, v9
    v_mov_b32 v163, v9
    v_mov_b32 v171, v9
    v_mov_b32 v175, v9
    s_nop 0
m_e185:
    s_cbranch_vccnz m_rc186
m_sp183:
    s_branch m_ret98
m_stub99:
    v_cmp_lt_f32 vcc, s65, v8
    s_cmp_lg_u32 s64, s70
    s_cbranch_scc1 m_e188
    v_add_f32 v160, v160, v16
    v_mov_b32 v164, v9
    v_add_f32 v172, v172, v16
    v_add_f32 v161, v161, v17
    v_mov_b32 v165, v9
    v_add_f32 v173, v173, v17
    v_add_f32 v162, v162, v18
    v_mov_b32 v166, v9
    v_add_f32 v174, v174, v18
    v_add_f32 v163, v163, v19
    v_mov_b32 v167, v9
    v_add_f32 v175, v175, v19
    s_nop 0
m_e188:
    s_cmp_lg_u32 s64, s71
    s_cbranch_scc1 m_e189
    v_mov_b32 v160, v9
    v_mov_b32 v168, v9
    v_mov_b32 v172, v9
    v_mov_b32 v161, v9
    v_mov_b32 v169, v9
    v_mov_b32 v173, v9
    v_mov_b32 v162, v9
    v_mov_b32 v170, v9
    v_mov_b32 v174, v9
    v_mov_b32 v163, v9
    v_mov_b32 v171, v9
    v_mov_b32 v175, v9
    s_nop 0
m_e189:
    s_cmp_lg_u32 s64, s53
    s_cbranch_scc1 m_e192
    s_cmp_lg_u32 s16, 0
    s_cbranch_scc1 m_np193
    v_mov_b32 v60, s4
    v_mov_b32 v61, s5
    s_add_u32 s90, s101, 117440512
    s_mov_b64 exec, 1
    buffer_store_dwordx2 v[60:61], off, s[8:11], s90 sc1
    s_mov_b64 exec, -1
m_np193:
    s_mov_b32 s101, -1
m_e192:
    s_cmp_gt_u32 s64, 24
    s_cbranch_scc1 m_e190
    s_cmp_lg_u32 s64, 8
    s_cbranch_scc1 m_e194
    s_lshr_b32 s90, s32, 1
    s_lshl_b32 s90, s90, 7
    s_add_u32 s90, s90, 117440600
    v_min_u32 v0, 1, v1
    v_lshlrev_b32 v0, 5, v0
    buffer_load_dwordx2 v[4:5], v0, s[8:11], s90 offen sc1
    s_cmp_eq_u32 s17, -1
    s_cbranch_scc1 m_e190
    s_cmp_lg_u32 s16, 0
    s_cbranch_scc1 m_np195
    v_mov_b32 v60, s4
    v_mov_b32 v61, s5
    s_add_u32 s90, s17, 117440512
    s_mov_b64 exec, 1
    buffer_store_dwordx2 v[60:61], off, s[8:11], s90 sc1
    s_mov_b64 exec, -1
m_np195:
    s_branch m_e190
m_e194:
    s_cmp_lg_u32 s64, 16
    s_cbranch_scc1 m_e196
    s_waitcnt vmcnt(18)
    s_mov_b32 s3, 1048576
m_spin197:
    v_cmp_ne_u64 s[76:77], s[4:5], v[4:5]
    s_nop 3
    s_cmp_eq_u64 s[76:77], 0
    s_cbranch_scc1 m_e190
    s_sub_u32 s3, s3, 1
    s_cbranch_scc1 m_e190
    s_sleep 32
    s_lshr_b32 s90, s32, 1
    s_lshl_b32 s90, s90, 7
    s_add_u32 s90, s90, 117440600
    v_min_u32 v0, 1, v1
    v_lshlrev_b32 v0, 5, v0
    buffer_load_dwordx2 v[4:5], v0, s[8:11], s90 offen sc1
    s_waitcnt vmcnt(0)
    s_branch m_spin197
    s_branch m_e190
m_e196:
    s_cmp_lg_u32 s64, 20
    s_cbranch_scc1 m_e198
    buffer_load_dwordx2 v[4:5], v10, s[8:11], 0 offen sc1
    s_mov_b32 s44, s48
    s_mov_b32 s45, s49
    s_mov_b32 s46, 8388608
    s_lshl_b32 s90, s2, 2
    s_add_u32 s90, s90, s16
    s_lshl_b32 s90, s90, 13
    v_lshlrev_b32 v62, 7, v1
    buffer_load_dword v255, v62, s[44:47], s90 offen
    s_branch m_e190
m_e198:
    s_cmp_lg_u32 s64, 24
    s_cbranch_scc1 m_e199
    s_mov_b32 s44, s50
    s_mov_b32 s45, s51
    s_mov_b32 s46, 2097152
    s_lshl_b32 s90, s2, 2
    s_add_u32 s90, s90, s16
    s_lshl_b32 s90, s90, 13
    v_lshlrev_b32 v62, 7, v1
    buffer_load_dword v255, v62, s[44:47], s90 offen
    s_waitcnt vmcnt(18)
    s_mov_b32 s3, 1048576
m_spin200:
    v_cmp_ne_u64 s[76:77], s[4:5], v[4:5]
    s_nop 3
    s_cmp_eq_u64 s[76:77], 0
    s_cbranch_scc1 m_e190
    s_sub_u32 s3, s3, 1
    s_cbranch_scc1 m_e190
    s_sleep 32
    buffer_load_dwordx2 v[4:5], v10, s[8:11], 0 offen sc1
    s_waitcnt vmcnt(0)
    s_branch m_spin200
    s_branch m_e190
m_e199:
m_e190:
    s_cbranch_vccnz m_rc201
m_sp187:
    s_branch m_ret100
m_stub102:
    v_cmp_lt_f32 vcc, s65, v8
    s_cmp_lg_u32 s64, s70
    s_cbranch_scc1 m_e203
    v_add_f32 v160, v160, v16
    v_mov_b32 v164, v9
    v_add_f32 v172, v172, v16
    v_add_f32 v161, v161, v17
    v_mov_b32 v165, v9
    v_add_f32 v173, v173, v17
    v_add_f32 v162, v162, v18
    v_mov_b32 v166, v9
    v_add_f32 v174, v174, v18
    v_add_f32 v163, v163, v19
    v_mov_b32 v167, v9
    v_add_f32 v175, v175, v19
    s_nop 0
m_e203:
    s_cmp_lg_u32 s64, s71
    s_cbranch_scc1 m_e204
    v_mov_b32 v160, v9
    v_mov_b32 v168, v9
    v_mov_b32 v172, v9
    v_mov_b32 v161, v9
    v_mov_b32 v169, v9
    v_mov_b32 v173, v9
    v_mov_b32 v162, v9
    v_mov_b32 v170, v9
    v_mov_b32 v174, v9
    v_mov_b32 v163, v9
    v_mov_b32 v171, v9
    v_mov_b32 v175, v9
    s_nop 0
m_e204:
    s_cbranch_vccnz m_rc205
m_sp202:
    s_branch m_ret103
m_stub119:
    v_cmp_lt_f32 vcc, s65, v8
    s_cbranch_vccnz m_rc207
m_sp206:
    s_branch m_ret120
m_rc96:
    s_call_b64 s[74:75], m_rs0470
    s_branch m_sp81
m_rc118:
    s_call_b64 s[74:75], m_rs0269
    s_branch m_sp104
m_rc178:
    s_call_b64 s[74:75], m_rs0470
    s_branch m_sp175
m_rc182:
    s_call_b64 s[74:75], m_rs1472
    s_branch m_sp179
m_rc186:
    s_call_b64 s[74:75], m_rs1472
    s_branch m_sp183
m_rc201:
    s_call_b64 s[74:75], m_rs0269
    s_branch m_sp187
m_rc205:
    s_call_b64 s[74:75], m_rs1271
    s_branch m_sp202
m_rc207:
    s_call_b64 s[74:75], m_rs1271
    s_branch m_sp206
m_rs0269:
    s_nop 15
    v_max3_f32 v48, v64, v65, v66
    v_max3_f32 v48, v48, v67, v68
    v_max3_f32 v48, v48, v69, v70
    v_max3_f32 v48, v48, v71, 0
    v_mov_b32 v49, v48
    s_nop 1
    v_permlane32_swap_b32 v48, v49
    s_nop 1
    v_max_f32 v48, v48, v49
    v_mov_b32 v49, v48
    s_nop 1
    v_permlane16_swap_b32 v48, v49
    s_nop 1
    v_max_f32 v48, v48, v49
    v_exp_f32 v49, -v48
    v_sub_f32 v64, v64, v48
    v_sub_f32 v65, v65, v48
    v_sub_f32 v66, v66, v48
    v_sub_f32 v67, v67, v48
    v_sub_f32 v68, v68, v48
    v_sub_f32 v69, v69, v48
    v_sub_f32 v70, v70, v48
    v_sub_f32 v71, v71, v48
    v_sub_f32 v96, v96, v48
    v_sub_f32 v97, v97, v48
    v_sub_f32 v98, v98, v48
    v_sub_f32 v99, v99, v48
    v_sub_f32 v100, v100, v48
    v_sub_f32 v101, v101, v48
    v_sub_f32 v102, v102, v48
    v_sub_f32 v103, v103, v48
    v_sub_f32 v160, v160, v48
    v_sub_f32 v161, v161, v48
    v_sub_f32 v162, v162, v48
    v_sub_f32 v163, v163, v48
    v_sub_f32 v164, v164, v48
    v_sub_f32 v165, v165, v48
    v_sub_f32 v166, v166, v48
    v_sub_f32 v167, v167, v48
    v_mul_f32 v12, v12, v49
    v_accvgpr_read_b32 v52, a0
    v_accvgpr_read_b32 v53, a1
    v_accvgpr_read_b32 v54, a2
    v_accvgpr_read_b32 v55, a3
    v_accvgpr_read_b32 v56, a4
    v_accvgpr_read_b32 v57, a5
    v_accvgpr_read_b32 v58, a6
    v_accvgpr_read_b32 v59, a7
    v_mul_f32 v52, v52, v49
    v_mul_f32 v53, v53, v49
    v_mul_f32 v54, v54, v49
    v_mul_f32 v55, v55, v49
    v_mul_f32 v56, v56, v49
    v_mul_f32 v57, v57, v49
    v_mul_f32 v58, v58, v49
    v_mul_f32 v59, v59, v49
    v_accvgpr_write_b32 a0, v52
    v_accvgpr_write_b32 a1, v53
    v_accvgpr_write_b32 a2, v54
    v_accvgpr_write_b32 a3, v55
    v_accvgpr_write_b32 a4, v56
    v_accvgpr_write_b32 a5, v57
    v_accvgpr_write_b32 a6, v58
    v_accvgpr_write_b32 a7, v59
    v_accvgpr_read_b32 v52, a8
    v_accvgpr_read_b32 v53, a9
    v_accvgpr_read_b32 v54, a10
    v_accvgpr_read_b32 v55, a11
    v_accvgpr_read_b32 v56, a12
    v_accvgpr_read_b32 v57, a13
    v_accvgpr_read_b32 v58, a14
    v_accvgpr_read_b32 v59, a15
    v_mul_f32 v52, v52, v49
    v_mul_f32 v53, v53, v49
    v_mul_f32 v54, v54, v49
    v_mul_f32 v55, v55, v49
    v_mul_f32 v56, v56, v49
    v_mul_f32 v57, v57, v49
    v_mul_f32 v58, v58, v49
    v_mul_f32 v59, v59, v49
    v_accvgpr_write_b32 a8, v52
    v_accvgpr_write_b32 a9, v53
    v_accvgpr_write_b32 a10, v54
    v_accvgpr_write_b32 a11, v55
    v_accvgpr_write_b32 a12, v56
    v_accvgpr_write_b32 a13, v57
    v_accvgpr_write_b32 a14, v58
    v_accvgpr_write_b32 a15, v59
    v_accvgpr_read_b32 v52, a16
    v_accvgpr_read_b32 v53, a17
    v_accvgpr_read_b32 v54, a18
    v_accvgpr_read_b32 v55, a19
    v_accvgpr_read_b32 v56, a20
    v_accvgpr_read_b32 v57, a21
    v_accvgpr_read_b32 v58, a22
    v_accvgpr_read_b32 v59, a23
    v_mul_f32 v52, v52, v49
    v_mul_f32 v53, v53, v49
    v_mul_f32 v54, v54, v49
    v_mul_f32 v55, v55, v49
    v_mul_f32 v56, v56, v49
    v_mul_f32 v57, v57, v49
    v_mul_f32 v58, v58, v49
    v_mul_f32 v59, v59, v49
    v_accvgpr_write_b32 a16, v52
    v_accvgpr_write_b32 a17, v53
    v_accvgpr_write_b32 a18, v54
    v_accvgpr_write_b32 a19, v55
    v_accvgpr_write_b32 a20, v56
    v_accvgpr_write_b32 a21, v57
    v_accvgpr_write_b32 a22, v58
    v_accvgpr_write_b32 a23, v59
    v_accvgpr_read_b32 v52, a24
    v_accvgpr_read_b32 v53, a25
    v_accvgpr_read_b32 v54, a26
    v_accvgpr_read_b32 v55, a27
    v_accvgpr_read_b32 v56, a28
    v_accvgpr_read_b32 v57, a29
    v_accvgpr_read_b32 v58, a30
    v_accvgpr_read_b32 v59, a31
    v_mul_f32 v52, v52, v49
    v_mul_f32 v53, v53, v49
    v_mul_f32 v54, v54, v49
    v_mul_f32 v55, v55, v49
    v_mul_f32 v56, v56, v49
    v_mul_f32 v57, v57, v49
    v_mul_f32 v58, v58, v49
    v_mul_f32 v59, v59, v49
    v_accvgpr_write_b32 a24, v52
    v_accvgpr_write_b32 a25, v53
    v_accvgpr_write_b32 a26, v54
    v_accvgpr_write_b32 a27, v55
    v_accvgpr_write_b32 a28, v56
    v_accvgpr_write_b32 a29, v57
    v_accvgpr_write_b32 a30, v58
    v_accvgpr_write_b32 a31, v59
    v_exp_f32 v52, v64
    v_exp_f32 v53, v65
    v_exp_f32 v54, v66
    v_exp_f32 v55, v67
    v_exp_f32 v56, v68
    v_exp_f32 v57, v69
    v_exp_f32 v58, v70
    v_exp_f32 v59, v71
    s_nop 0
    v_cvt_pk_bf16_f32 v128, v52, v53
    v_cvt_pk_bf16_f32 v129, v54, v55
    v_cvt_pk_bf16_f32 v130, v56, v57
    v_cvt_pk_bf16_f32 v131, v58, v59
    s_nop 1
    v_mfma_f32_16x16x32_bf16 v[28:31], v[44:47], v[128:131], 0
    v_max3_f32 v48, v72, v73, v74
    v_max3_f32 v48, v48, v75, v76
    v_max3_f32 v48, v48, v77, v78
    v_max3_f32 v48, v48, v79, 0
    v_mov_b32 v49, v48
    s_nop 1
    v_permlane32_swap_b32 v48, v49
    s_nop 1
    v_max_f32 v48, v48, v49
    v_mov_b32 v49, v48
    s_nop 1
    v_permlane16_swap_b32 v48, v49
    s_nop 1
    v_max_f32 v48, v48, v49
    v_exp_f32 v49, -v48
    v_sub_f32 v72, v72, v48
    v_sub_f32 v73, v73, v48
    v_sub_f32 v74, v74, v48
    v_sub_f32 v75, v75, v48
    v_sub_f32 v76, v76, v48
    v_sub_f32 v77, v77, v48
    v_sub_f32 v78, v78, v48
    v_sub_f32 v79, v79, v48
    v_sub_f32 v104, v104, v48
    v_sub_f32 v105, v105, v48
    v_sub_f32 v106, v106, v48
    v_sub_f32 v107, v107, v48
    v_sub_f32 v108, v108, v48
    v_sub_f32 v109, v109, v48
    v_sub_f32 v110, v110, v48
    v_sub_f32 v111, v111, v48
    v_sub_f32 v168, v168, v48
    v_sub_f32 v169, v169, v48
    v_sub_f32 v170, v170, v48
    v_sub_f32 v171, v171, v48
    v_sub_f32 v172, v172, v48
    v_sub_f32 v173, v173, v48
    v_sub_f32 v174, v174, v48
    v_sub_f32 v175, v175, v48
    v_mul_f32 v13, v13, v49
    v_accvgpr_read_b32 v52, a32
    v_accvgpr_read_b32 v53, a33
    v_accvgpr_read_b32 v54, a34
    v_accvgpr_read_b32 v55, a35
    v_accvgpr_read_b32 v56, a36
    v_accvgpr_read_b32 v57, a37
    v_accvgpr_read_b32 v58, a38
    v_accvgpr_read_b32 v59, a39
    v_mul_f32 v52, v52, v49
    v_mul_f32 v53, v53, v49
    v_mul_f32 v54, v54, v49
    v_mul_f32 v55, v55, v49
    v_mul_f32 v56, v56, v49
    v_mul_f32 v57, v57, v49
    v_mul_f32 v58, v58, v49
    v_mul_f32 v59, v59, v49
    v_accvgpr_write_b32 a32, v52
    v_accvgpr_write_b32 a33, v53
    v_accvgpr_write_b32 a34, v54
    v_accvgpr_write_b32 a35, v55
    v_accvgpr_write_b32 a36, v56
    v_accvgpr_write_b32 a37, v57
    v_accvgpr_write_b32 a38, v58
    v_accvgpr_write_b32 a39, v59
    v_accvgpr_read_b32 v52, a40
    v_accvgpr_read_b32 v53, a41
    v_accvgpr_read_b32 v54, a42
    v_accvgpr_read_b32 v55, a43
    v_accvgpr_read_b32 v56, a44
    v_accvgpr_read_b32 v57, a45
    v_accvgpr_read_b32 v58, a46
    v_accvgpr_read_b32 v59, a47
    v_mul_f32 v52, v52, v49
    v_mul_f32 v53, v53, v49
    v_mul_f32 v54, v54, v49
    v_mul_f32 v55, v55, v49
    v_mul_f32 v56, v56, v49
    v_mul_f32 v57, v57, v49
    v_mul_f32 v58, v58, v49
    v_mul_f32 v59, v59, v49
    v_accvgpr_write_b32 a40, v52
    v_accvgpr_write_b32 a41, v53
    v_accvgpr_write_b32 a42, v54
    v_accvgpr_write_b32 a43, v55
    v_accvgpr_write_b32 a44, v56
    v_accvgpr_write_b32 a45, v57
    v_accvgpr_write_b32 a46, v58
    v_accvgpr_write_b32 a47, v59
    v_accvgpr_read_b32 v52, a48
    v_accvgpr_read_b32 v53, a49
    v_accvgpr_read_b32 v54, a50
    v_accvgpr_read_b32 v55, a51
    v_accvgpr_read_b32 v56, a52
    v_accvgpr_read_b32 v57, a53
    v_accvgpr_read_b32 v58, a54
    v_accvgpr_read_b32 v59, a55
    v_mul_f32 v52, v52, v49
    v_mul_f32 v53, v53, v49
    v_mul_f32 v54, v54, v49
    v_mul_f32 v55, v55, v49
    v_mul_f32 v56, v56, v49
    v_mul_f32 v57, v57, v49
    v_mul_f32 v58, v58, v49
    v_mul_f32 v59, v59, v49
    v_accvgpr_write_b32 a48, v52
    v_accvgpr_write_b32 a49, v53
    v_accvgpr_write_b32 a50, v54
    v_accvgpr_write_b32 a51, v55
    v_accvgpr_write_b32 a52, v56
    v_accvgpr_write_b32 a53, v57
    v_accvgpr_write_b32 a54, v58
    v_accvgpr_write_b32 a55, v59
    v_accvgpr_read_b32 v52, a56
    v_accvgpr_read_b32 v53, a57
    v_accvgpr_read_b32 v54, a58
    v_accvgpr_read_b32 v55, a59
    v_accvgpr_read_b32 v56, a60
    v_accvgpr_read_b32 v57, a61
    v_accvgpr_read_b32 v58, a62
    v_accvgpr_read_b32 v59, a63
    v_mul_f32 v52, v52, v49
    v_mul_f32 v53, v53, v49
    v_mul_f32 v54, v54, v49
    v_mul_f32 v55, v55, v49
    v_mul_f32 v56, v56, v49
    v_mul_f32 v57, v57, v49
    v_mul_f32 v58, v58, v49
    v_mul_f32 v59, v59, v49
    v_accvgpr_write_b32 a56, v52
    v_accvgpr_write_b32 a57, v53
    v_accvgpr_write_b32 a58, v54
    v_accvgpr_write_b32 a59, v55
    v_accvgpr_write_b32 a60, v56
    v_accvgpr_write_b32 a61, v57
    v_accvgpr_write_b32 a62, v58
    v_accvgpr_write_b32 a63, v59
    v_exp_f32 v52, v72
    v_exp_f32 v53, v73
    v_exp_f32 v54, v74
    v_exp_f32 v55, v75
    v_exp_f32 v56, v76
    v_exp_f32 v57, v77
    v_exp_f32 v58, v78
    v_exp_f32 v59, v79
    s_nop 0
    v_cvt_pk_bf16_f32 v132, v52, v53
    v_cvt_pk_bf16_f32 v133, v54, v55
    v_cvt_pk_bf16_f32 v134, v56, v57
    v_cvt_pk_bf16_f32 v135, v58, v59
    s_nop 1
    v_mfma_f32_16x16x32_bf16 v[32:35], v[44:47], v[132:135], 0
    s_nop 7
    s_setpc_b64 s[74:75]
m_rs0470:
    s_nop 15
    v_max3_f32 v48, v64, v65, v66
    v_max3_f32 v48, v48, v67, v68
    v_max3_f32 v48, v48, v69, v70
    v_max3_f32 v48, v48, v71, 0
    v_mov_b32 v49, v48
    s_nop 1
    v_permlane32_swap_b32 v48, v49
    s_nop 1
    v_max_f32 v48, v48, v49
    v_mov_b32 v49, v48
    s_nop 1
    v_permlane16_swap_b32 v48, v49
    s_nop 1
    v_max_f32 v48, v48, v49
    v_exp_f32 v49, -v48
    v_sub_f32 v64, v64, v48
    v_sub_f32 v65, v65, v48
    v_sub_f32 v66, v66, v48
    v_sub_f32 v67, v67, v48
    v_sub_f32 v68, v68, v48
    v_sub_f32 v69, v69, v48
    v_sub_f32 v70, v70, v48
    v_sub_f32 v71, v71, v48
    v_sub_f32 v96, v96, v48
    v_sub_f32 v97, v97, v48
    v_sub_f32 v98, v98, v48
    v_sub_f32 v99, v99, v48
    v_sub_f32 v100, v100, v48
    v_sub_f32 v101, v101, v48
    v_sub_f32 v102, v102, v48
    v_sub_f32 v103, v103, v48
    v_sub_f32 v160, v160, v48
    v_sub_f32 v161, v161, v48
    v_sub_f32 v162, v162, v48
    v_sub_f32 v163, v163, v48
    v_sub_f32 v164, v164, v48
    v_sub_f32 v165, v165, v48
    v_sub_f32 v166, v166, v48
    v_sub_f32 v167, v167, v48
    v_mul_f32 v12, v12, v49
    v_accvgpr_read_b32 v52, a0
    v_accvgpr_read_b32 v53, a1
    v_accvgpr_read_b32 v54, a2
    v_accvgpr_read_b32 v55, a3
    v_accvgpr_read_b32 v56, a4
    v_accvgpr_read_b32 v57, a5
    v_accvgpr_read_b32 v58, a6
    v_accvgpr_read_b32 v59, a7
    v_mul_f32 v52, v52, v49
    v_mul_f32 v53, v53, v49
    v_mul_f32 v54, v54, v49
    v_mul_f32 v55, v55, v49
    v_mul_f32 v56, v56, v49
    v_mul_f32 v57, v57, v49
    v_mul_f32 v58, v58, v49
    v_mul_f32 v59, v59, v49
    v_accvgpr_write_b32 a0, v52
    v_accvgpr_write_b32 a1, v53
    v_accvgpr_write_b32 a2, v54
    v_accvgpr_write_b32 a3, v55
    v_accvgpr_write_b32 a4, v56
    v_accvgpr_write_b32 a5, v57
    v_accvgpr_write_b32 a6, v58
    v_accvgpr_write_b32 a7, v59
    v_accvgpr_read_b32 v52, a8
    v_accvgpr_read_b32 v53, a9
    v_accvgpr_read_b32 v54, a10
    v_accvgpr_read_b32 v55, a11
    v_accvgpr_read_b32 v56, a12
    v_accvgpr_read_b32 v57, a13
    v_accvgpr_read_b32 v58, a14
    v_accvgpr_read_b32 v59, a15
    v_mul_f32 v52, v52, v49
    v_mul_f32 v53, v53, v49
    v_mul_f32 v54, v54, v49
    v_mul_f32 v55, v55, v49
    v_mul_f32 v56, v56, v49
    v_mul_f32 v57, v57, v49
    v_mul_f32 v58, v58, v49
    v_mul_f32 v59, v59, v49
    v_accvgpr_write_b32 a8, v52
    v_accvgpr_write_b32 a9, v53
    v_accvgpr_write_b32 a10, v54
    v_accvgpr_write_b32 a11, v55
    v_accvgpr_write_b32 a12, v56
    v_accvgpr_write_b32 a13, v57
    v_accvgpr_write_b32 a14, v58
    v_accvgpr_write_b32 a15, v59
    v_accvgpr_read_b32 v52, a16
    v_accvgpr_read_b32 v53, a17
    v_accvgpr_read_b32 v54, a18
    v_accvgpr_read_b32 v55, a19
    v_accvgpr_read_b32 v56, a20
    v_accvgpr_read_b32 v57, a21
    v_accvgpr_read_b32 v58, a22
    v_accvgpr_read_b32 v59, a23
    v_mul_f32 v52, v52, v49
    v_mul_f32 v53, v53, v49
    v_mul_f32 v54, v54, v49
    v_mul_f32 v55, v55, v49
    v_mul_f32 v56, v56, v49
    v_mul_f32 v57, v57, v49
    v_mul_f32 v58, v58, v49
    v_mul_f32 v59, v59, v49
    v_accvgpr_write_b32 a16, v52
    v_accvgpr_write_b32 a17, v53
    v_accvgpr_write_b32 a18, v54
    v_accvgpr_write_b32 a19, v55
    v_accvgpr_write_b32 a20, v56
    v_accvgpr_write_b32 a21, v57
    v_accvgpr_write_b32 a22, v58
    v_accvgpr_write_b32 a23, v59
    v_accvgpr_read_b32 v52, a24
    v_accvgpr_read_b32 v53, a25
    v_accvgpr_read_b32 v54, a26
    v_accvgpr_read_b32 v55, a27
    v_accvgpr_read_b32 v56, a28
    v_accvgpr_read_b32 v57, a29
    v_accvgpr_read_b32 v58, a30
    v_accvgpr_read_b32 v59, a31
    v_mul_f32 v52, v52, v49
    v_mul_f32 v53, v53, v49
    v_mul_f32 v54, v54, v49
    v_mul_f32 v55, v55, v49
    v_mul_f32 v56, v56, v49
    v_mul_f32 v57, v57, v49
    v_mul_f32 v58, v58, v49
    v_mul_f32 v59, v59, v49
    v_accvgpr_write_b32 a24, v52
    v_accvgpr_write_b32 a25, v53
    v_accvgpr_write_b32 a26, v54
    v_accvgpr_write_b32 a27, v55
    v_accvgpr_write_b32 a28, v56
    v_accvgpr_write_b32 a29, v57
    v_accvgpr_write_b32 a30, v58
    v_accvgpr_write_b32 a31, v59
    v_exp_f32 v52, v64
    v_exp_f32 v53, v65
    v_exp_f32 v54, v66
    v_exp_f32 v55, v67
    v_exp_f32 v56, v68
    v_exp_f32 v57, v69
    v_exp_f32 v58, v70
    v_exp_f32 v59, v71
    s_nop 0
    v_cvt_pk_bf16_f32 v128, v52, v53
    v_cvt_pk_bf16_f32 v129, v54, v55
    v_cvt_pk_bf16_f32 v130, v56, v57
    v_cvt_pk_bf16_f32 v131, v58, v59
    s_nop 1
    v_mfma_f32_16x16x32_bf16 v[28:31], v[44:47], v[128:131], 0
    v_max3_f32 v48, v72, v73, v74
    v_max3_f32 v48, v48, v75, v76
    v_max3_f32 v48, v48, v77, v78
    v_max3_f32 v48, v48, v79, 0
    v_mov_b32 v49, v48
    s_nop 1
    v_permlane32_swap_b32 v48, v49
    s_nop 1
    v_max_f32 v48, v48, v49
    v_mov_b32 v49, v48
    s_nop 1
    v_permlane16_swap_b32 v48, v49
    s_nop 1
    v_max_f32 v48, v48, v49
    v_exp_f32 v49, -v48
    v_sub_f32 v72, v72, v48
    v_sub_f32 v73, v73, v48
    v_sub_f32 v74, v74, v48
    v_sub_f32 v75, v75, v48
    v_sub_f32 v76, v76, v48
    v_sub_f32 v77, v77, v48
    v_sub_f32 v78, v78, v48
    v_sub_f32 v79, v79, v48
    v_sub_f32 v104, v104, v48
    v_sub_f32 v105, v105, v48
    v_sub_f32 v106, v106, v48
    v_sub_f32 v107, v107, v48
    v_sub_f32 v108, v108, v48
    v_sub_f32 v109, v109, v48
    v_sub_f32 v110, v110, v48
    v_sub_f32 v111, v111, v48
    v_sub_f32 v168, v168, v48
    v_sub_f32 v169, v169, v48
    v_sub_f32 v170, v170, v48
    v_sub_f32 v171, v171, v48
    v_sub_f32 v172, v172, v48
    v_sub_f32 v173, v173, v48
    v_sub_f32 v174, v174, v48
    v_sub_f32 v175, v175, v48
    v_mul_f32 v13, v13, v49
    v_accvgpr_read_b32 v52, a32
    v_accvgpr_read_b32 v53, a33
    v_accvgpr_read_b32 v54, a34
    v_accvgpr_read_b32 v55, a35
    v_accvgpr_read_b32 v56, a36
    v_accvgpr_read_b32 v57, a37
    v_accvgpr_read_b32 v58, a38
    v_accvgpr_read_b32 v59, a39
    v_mul_f32 v52, v52, v49
    v_mul_f32 v53, v53, v49
    v_mul_f32 v54, v54, v49
    v_mul_f32 v55, v55, v49
    v_mul_f32 v56, v56, v49
    v_mul_f32 v57, v57, v49
    v_mul_f32 v58, v58, v49
    v_mul_f32 v59, v59, v49
    v_accvgpr_write_b32 a32, v52
    v_accvgpr_write_b32 a33, v53
    v_accvgpr_write_b32 a34, v54
    v_accvgpr_write_b32 a35, v55
    v_accvgpr_write_b32 a36, v56
    v_accvgpr_write_b32 a37, v57
    v_accvgpr_write_b32 a38, v58
    v_accvgpr_write_b32 a39, v59
    v_accvgpr_read_b32 v52, a40
    v_accvgpr_read_b32 v53, a41
    v_accvgpr_read_b32 v54, a42
    v_accvgpr_read_b32 v55, a43
    v_accvgpr_read_b32 v56, a44
    v_accvgpr_read_b32 v57, a45
    v_accvgpr_read_b32 v58, a46
    v_accvgpr_read_b32 v59, a47
    v_mul_f32 v52, v52, v49
    v_mul_f32 v53, v53, v49
    v_mul_f32 v54, v54, v49
    v_mul_f32 v55, v55, v49
    v_mul_f32 v56, v56, v49
    v_mul_f32 v57, v57, v49
    v_mul_f32 v58, v58, v49
    v_mul_f32 v59, v59, v49
    v_accvgpr_write_b32 a40, v52
    v_accvgpr_write_b32 a41, v53
    v_accvgpr_write_b32 a42, v54
    v_accvgpr_write_b32 a43, v55
    v_accvgpr_write_b32 a44, v56
    v_accvgpr_write_b32 a45, v57
    v_accvgpr_write_b32 a46, v58
    v_accvgpr_write_b32 a47, v59
    v_accvgpr_read_b32 v52, a48
    v_accvgpr_read_b32 v53, a49
    v_accvgpr_read_b32 v54, a50
    v_accvgpr_read_b32 v55, a51
    v_accvgpr_read_b32 v56, a52
    v_accvgpr_read_b32 v57, a53
    v_accvgpr_read_b32 v58, a54
    v_accvgpr_read_b32 v59, a55
    v_mul_f32 v52, v52, v49
    v_mul_f32 v53, v53, v49
    v_mul_f32 v54, v54, v49
    v_mul_f32 v55, v55, v49
    v_mul_f32 v56, v56, v49
    v_mul_f32 v57, v57, v49
    v_mul_f32 v58, v58, v49
    v_mul_f32 v59, v59, v49
    v_accvgpr_write_b32 a48, v52
    v_accvgpr_write_b32 a49, v53
    v_accvgpr_write_b32 a50, v54
    v_accvgpr_write_b32 a51, v55
    v_accvgpr_write_b32 a52, v56
    v_accvgpr_write_b32 a53, v57
    v_accvgpr_write_b32 a54, v58
    v_accvgpr_write_b32 a55, v59
    v_accvgpr_read_b32 v52, a56
    v_accvgpr_read_b32 v53, a57
    v_accvgpr_read_b32 v54, a58
    v_accvgpr_read_b32 v55, a59
    v_accvgpr_read_b32 v56, a60
    v_accvgpr_read_b32 v57, a61
    v_accvgpr_read_b32 v58, a62
    v_accvgpr_read_b32 v59, a63
    v_mul_f32 v52, v52, v49
    v_mul_f32 v53, v53, v49
    v_mul_f32 v54, v54, v49
    v_mul_f32 v55, v55, v49
    v_mul_f32 v56, v56, v49
    v_mul_f32 v57, v57, v49
    v_mul_f32 v58, v58, v49
    v_mul_f32 v59, v59, v49
    v_accvgpr_write_b32 a56, v52
    v_accvgpr_write_b32 a57, v53
    v_accvgpr_write_b32 a58, v54
    v_accvgpr_write_b32 a59, v55
    v_accvgpr_write_b32 a60, v56
    v_accvgpr_write_b32 a61, v57
    v_accvgpr_write_b32 a62, v58
    v_accvgpr_write_b32 a63, v59
    v_exp_f32 v52, v72
    v_exp_f32 v53, v73
    v_exp_f32 v54, v74
    v_exp_f32 v55, v75
    v_exp_f32 v56, v76
    v_exp_f32 v57, v77
    v_exp_f32 v58, v78
    v_exp_f32 v59, v79
    s_nop 0
    v_cvt_pk_bf16_f32 v132, v52, v53
    v_cvt_pk_bf16_f32 v133, v54, v55
    v_cvt_pk_bf16_f32 v134, v56, v57
    v_cvt_pk_bf16_f32 v135, v58, v59
    s_nop 1
    v_mfma_f32_16x16x32_bf16 v[32:35], v[44:47], v[132:135], 0
    v_max3_f32 v48, v80, v81, v82
    v_max3_f32 v48, v48, v83, v84
    v_max3_f32 v48, v48, v85, v86
    v_max3_f32 v48, v48, v87, 0
    v_mov_b32 v49, v48
    s_nop 1
    v_permlane32_swap_b32 v48, v49
    s_nop 1
    v_max_f32 v48, v48, v49
    v_mov_b32 v49, v48
    s_nop 1
    v_permlane16_swap_b32 v48, v49
    s_nop 1
    v_max_f32 v48, v48, v49
    v_exp_f32 v49, -v48
    v_sub_f32 v80, v80, v48
    v_sub_f32 v81, v81, v48
    v_sub_f32 v82, v82, v48
    v_sub_f32 v83, v83, v48
    v_sub_f32 v84, v84, v48
    v_sub_f32 v85, v85, v48
    v_sub_f32 v86, v86, v48
    v_sub_f32 v87, v87, v48
    v_sub_f32 v112, v112, v48
    v_sub_f32 v113, v113, v48
    v_sub_f32 v114, v114, v48
    v_sub_f32 v115, v115, v48
    v_sub_f32 v116, v116, v48
    v_sub_f32 v117, v117, v48
    v_sub_f32 v118, v118, v48
    v_sub_f32 v119, v119, v48
    v_sub_f32 v176, v176, v48
    v_sub_f32 v177, v177, v48
    v_sub_f32 v178, v178, v48
    v_sub_f32 v179, v179, v48
    v_sub_f32 v180, v180, v48
    v_sub_f32 v181, v181, v48
    v_sub_f32 v182, v182, v48
    v_sub_f32 v183, v183, v48
    v_mul_f32 v14, v14, v49
    v_accvgpr_read_b32 v52, a64
    v_accvgpr_read_b32 v53, a65
    v_accvgpr_read_b32 v54, a66
    v_accvgpr_read_b32 v55, a67
    v_accvgpr_read_b32 v56, a68
    v_accvgpr_read_b32 v57, a69
    v_accvgpr_read_b32 v58, a70
    v_accvgpr_read_b32 v59, a71
    v_mul_f32 v52, v52, v49
    v_mul_f32 v53, v53, v49
    v_mul_f32 v54, v54, v49
    v_mul_f32 v55, v55, v49
    v_mul_f32 v56, v56, v49
    v_mul_f32 v57, v57, v49
    v_mul_f32 v58, v58, v49
    v_mul_f32 v59, v59, v49
    v_accvgpr_write_b32 a64, v52
    v_accvgpr_write_b32 a65, v53
    v_accvgpr_write_b32 a66, v54
    v_accvgpr_write_b32 a67, v55
    v_accvgpr_write_b32 a68, v56
    v_accvgpr_write_b32 a69, v57
    v_accvgpr_write_b32 a70, v58
    v_accvgpr_write_b32 a71, v59
    v_accvgpr_read_b32 v52, a72
    v_accvgpr_read_b32 v53, a73
    v_accvgpr_read_b32 v54, a74
    v_accvgpr_read_b32 v55, a75
    v_accvgpr_read_b32 v56, a76
    v_accvgpr_read_b32 v57, a77
    v_accvgpr_read_b32 v58, a78
    v_accvgpr_read_b32 v59, a79
    v_mul_f32 v52, v52, v49
    v_mul_f32 v53, v53, v49
    v_mul_f32 v54, v54, v49
    v_mul_f32 v55, v55, v49
    v_mul_f32 v56, v56, v49
    v_mul_f32 v57, v57, v49
    v_mul_f32 v58, v58, v49
    v_mul_f32 v59, v59, v49
    v_accvgpr_write_b32 a72, v52
    v_accvgpr_write_b32 a73, v53
    v_accvgpr_write_b32 a74, v54
    v_accvgpr_write_b32 a75, v55
    v_accvgpr_write_b32 a76, v56
    v_accvgpr_write_b32 a77, v57
    v_accvgpr_write_b32 a78, v58
    v_accvgpr_write_b32 a79, v59
    v_accvgpr_read_b32 v52, a80
    v_accvgpr_read_b32 v53, a81
    v_accvgpr_read_b32 v54, a82
    v_accvgpr_read_b32 v55, a83
    v_accvgpr_read_b32 v56, a84
    v_accvgpr_read_b32 v57, a85
    v_accvgpr_read_b32 v58, a86
    v_accvgpr_read_b32 v59, a87
    v_mul_f32 v52, v52, v49
    v_mul_f32 v53, v53, v49
    v_mul_f32 v54, v54, v49
    v_mul_f32 v55, v55, v49
    v_mul_f32 v56, v56, v49
    v_mul_f32 v57, v57, v49
    v_mul_f32 v58, v58, v49
    v_mul_f32 v59, v59, v49
    v_accvgpr_write_b32 a80, v52
    v_accvgpr_write_b32 a81, v53
    v_accvgpr_write_b32 a82, v54
    v_accvgpr_write_b32 a83, v55
    v_accvgpr_write_b32 a84, v56
    v_accvgpr_write_b32 a85, v57
    v_accvgpr_write_b32 a86, v58
    v_accvgpr_write_b32 a87, v59
    v_accvgpr_read_b32 v52, a88
    v_accvgpr_read_b32 v53, a89
    v_accvgpr_read_b32 v54, a90
    v_accvgpr_read_b32 v55, a91
    v_accvgpr_read_b32 v56, a92
    v_accvgpr_read_b32 v57, a93
    v_accvgpr_read_b32 v58, a94
    v_accvgpr_read_b32 v59, a95
    v_mul_f32 v52, v52, v49
    v_mul_f32 v53, v53, v49
    v_mul_f32 v54, v54, v49
    v_mul_f32 v55, v55, v49
    v_mul_f32 v56, v56, v49
    v_mul_f32 v57, v57, v49
    v_mul_f32 v58, v58, v49
    v_mul_f32 v59, v59, v49
    v_accvgpr_write_b32 a88, v52
    v_accvgpr_write_b32 a89, v53
    v_accvgpr_write_b32 a90, v54
    v_accvgpr_write_b32 a91, v55
    v_accvgpr_write_b32 a92, v56
    v_accvgpr_write_b32 a93, v57
    v_accvgpr_write_b32 a94, v58
    v_accvgpr_write_b32 a95, v59
    v_exp_f32 v52, v80
    v_exp_f32 v53, v81
    v_exp_f32 v54, v82
    v_exp_f32 v55, v83
    v_exp_f32 v56, v84
    v_exp_f32 v57, v85
    v_exp_f32 v58, v86
    v_exp_f32 v59, v87
    s_nop 0
    v_cvt_pk_bf16_f32 v136, v52, v53
    v_cvt_pk_bf16_f32 v137, v54, v55
    v_cvt_pk_bf16_f32 v138, v56, v57
    v_cvt_pk_bf16_f32 v139, v58, v59
    s_nop 1
    v_mfma_f32_16x16x32_bf16 v[36:39], v[44:47], v[136:139], 0
    v_max3_f32 v48, v88, v89, v90
    v_max3_f32 v48, v48, v91, v92
    v_max3_f32 v48, v48, v93, v94
    v_max3_f32 v48, v48, v95, 0
    v_mov_b32 v49, v48
    s_nop 1
    v_permlane32_swap_b32 v48, v49
    s_nop 1
    v_max_f32 v48, v48, v49
    v_mov_b32 v49, v48
    s_nop 1
    v_permlane16_swap_b32 v48, v49
    s_nop 1
    v_max_f32 v48, v48, v49
    v_exp_f32 v49, -v48
    v_sub_f32 v88, v88, v48
    v_sub_f32 v89, v89, v48
    v_sub_f32 v90, v90, v48
    v_sub_f32 v91, v91, v48
    v_sub_f32 v92, v92, v48
    v_sub_f32 v93, v93, v48
    v_sub_f32 v94, v94, v48
    v_sub_f32 v95, v95, v48
    v_sub_f32 v120, v120, v48
    v_sub_f32 v121, v121, v48
    v_sub_f32 v122, v122, v48
    v_sub_f32 v123, v123, v48
    v_sub_f32 v124, v124, v48
    v_sub_f32 v125, v125, v48
    v_sub_f32 v126, v126, v48
    v_sub_f32 v127, v127, v48
    v_sub_f32 v184, v184, v48
    v_sub_f32 v185, v185, v48
    v_sub_f32 v186, v186, v48
    v_sub_f32 v187, v187, v48
    v_sub_f32 v188, v188, v48
    v_sub_f32 v189, v189, v48
    v_sub_f32 v190, v190, v48
    v_sub_f32 v191, v191, v48
    v_mul_f32 v15, v15, v49
    v_accvgpr_read_b32 v52, a96
    v_accvgpr_read_b32 v53, a97
    v_accvgpr_read_b32 v54, a98
    v_accvgpr_read_b32 v55, a99
    v_accvgpr_read_b32 v56, a100
    v_accvgpr_read_b32 v57, a101
    v_accvgpr_read_b32 v58, a102
    v_accvgpr_read_b32 v59, a103
    v_mul_f32 v52, v52, v49
    v_mul_f32 v53, v53, v49
    v_mul_f32 v54, v54, v49
    v_mul_f32 v55, v55, v49
    v_mul_f32 v56, v56, v49
    v_mul_f32 v57, v57, v49
    v_mul_f32 v58, v58, v49
    v_mul_f32 v59, v59, v49
    v_accvgpr_write_b32 a96, v52
    v_accvgpr_write_b32 a97, v53
    v_accvgpr_write_b32 a98, v54
    v_accvgpr_write_b32 a99, v55
    v_accvgpr_write_b32 a100, v56
    v_accvgpr_write_b32 a101, v57
    v_accvgpr_write_b32 a102, v58
    v_accvgpr_write_b32 a103, v59
    v_accvgpr_read_b32 v52, a104
    v_accvgpr_read_b32 v53, a105
    v_accvgpr_read_b32 v54, a106
    v_accvgpr_read_b32 v55, a107
    v_accvgpr_read_b32 v56, a108
    v_accvgpr_read_b32 v57, a109
    v_accvgpr_read_b32 v58, a110
    v_accvgpr_read_b32 v59, a111
    v_mul_f32 v52, v52, v49
    v_mul_f32 v53, v53, v49
    v_mul_f32 v54, v54, v49
    v_mul_f32 v55, v55, v49
    v_mul_f32 v56, v56, v49
    v_mul_f32 v57, v57, v49
    v_mul_f32 v58, v58, v49
    v_mul_f32 v59, v59, v49
    v_accvgpr_write_b32 a104, v52
    v_accvgpr_write_b32 a105, v53
    v_accvgpr_write_b32 a106, v54
    v_accvgpr_write_b32 a107, v55
    v_accvgpr_write_b32 a108, v56
    v_accvgpr_write_b32 a109, v57
    v_accvgpr_write_b32 a110, v58
    v_accvgpr_write_b32 a111, v59
    v_accvgpr_read_b32 v52, a112
    v_accvgpr_read_b32 v53, a113
    v_accvgpr_read_b32 v54, a114
    v_accvgpr_read_b32 v55, a115
    v_accvgpr_read_b32 v56, a116
    v_accvgpr_read_b32 v57, a117
    v_accvgpr_read_b32 v58, a118
    v_accvgpr_read_b32 v59, a119
    v_mul_f32 v52, v52, v49
    v_mul_f32 v53, v53, v49
    v_mul_f32 v54, v54, v49
    v_mul_f32 v55, v55, v49
    v_mul_f32 v56, v56, v49
    v_mul_f32 v57, v57, v49
    v_mul_f32 v58, v58, v49
    v_mul_f32 v59, v59, v49
    v_accvgpr_write_b32 a112, v52
    v_accvgpr_write_b32 a113, v53
    v_accvgpr_write_b32 a114, v54
    v_accvgpr_write_b32 a115, v55
    v_accvgpr_write_b32 a116, v56
    v_accvgpr_write_b32 a117, v57
    v_accvgpr_write_b32 a118, v58
    v_accvgpr_write_b32 a119, v59
    v_accvgpr_read_b32 v52, a120
    v_accvgpr_read_b32 v53, a121
    v_accvgpr_read_b32 v54, a122
    v_accvgpr_read_b32 v55, a123
    v_accvgpr_read_b32 v56, a124
    v_accvgpr_read_b32 v57, a125
    v_accvgpr_read_b32 v58, a126
    v_accvgpr_read_b32 v59, a127
    v_mul_f32 v52, v52, v49
    v_mul_f32 v53, v53, v49
    v_mul_f32 v54, v54, v49
    v_mul_f32 v55, v55, v49
    v_mul_f32 v56, v56, v49
    v_mul_f32 v57, v57, v49
    v_mul_f32 v58, v58, v49
    v_mul_f32 v59, v59, v49
    v_accvgpr_write_b32 a120, v52
    v_accvgpr_write_b32 a121, v53
    v_accvgpr_write_b32 a122, v54
    v_accvgpr_write_b32 a123, v55
    v_accvgpr_write_b32 a124, v56
    v_accvgpr_write_b32 a125, v57
    v_accvgpr_write_b32 a126, v58
    v_accvgpr_write_b32 a127, v59
    v_exp_f32 v52, v88
    v_exp_f32 v53, v89
    v_exp_f32 v54, v90
    v_exp_f32 v55, v91
    v_exp_f32 v56, v92
    v_exp_f32 v57, v93
    v_exp_f32 v58, v94
    v_exp_f32 v59, v95
    s_nop 0
    v_cvt_pk_bf16_f32 v140, v52, v53
    v_cvt_pk_bf16_f32 v141, v54, v55
    v_cvt_pk_bf16_f32 v142, v56, v57
    v_cvt_pk_bf16_f32 v143, v58, v59
    s_nop 1
    v_mfma_f32_16x16x32_bf16 v[40:43], v[44:47], v[140:143], 0
    s_nop 7
    s_setpc_b64 s[74:75]
m_rs1271:
    s_nop 15
    v_max3_f32 v48, v96, v97, v98
    v_max3_f32 v48, v48, v99, v100
    v_max3_f32 v48, v48, v101, v102
    v_max3_f32 v48, v48, v103, 0
    v_mov_b32 v49, v48
    s_nop 1
    v_permlane32_swap_b32 v48, v49
    s_nop 1
    v_max_f32 v48, v48, v49
    v_mov_b32 v49, v48
    s_nop 1
    v_permlane16_swap_b32 v48, v49
    s_nop 1
    v_max_f32 v48, v48, v49
    v_exp_f32 v49, -v48
    v_sub_f32 v96, v96, v48
    v_sub_f32 v97, v97, v48
    v_sub_f32 v98, v98, v48
    v_sub_f32 v99, v99, v48
    v_sub_f32 v100, v100, v48
    v_sub_f32 v101, v101, v48
    v_sub_f32 v102, v102, v48
    v_sub_f32 v103, v103, v48
    v_sub_f32 v64, v64, v48
    v_sub_f32 v65, v65, v48
    v_sub_f32 v66, v66, v48
    v_sub_f32 v67, v67, v48
    v_sub_f32 v68, v68, v48
    v_sub_f32 v69, v69, v48
    v_sub_f32 v70, v70, v48
    v_sub_f32 v71, v71, v48
    v_sub_f32 v160, v160, v48
    v_sub_f32 v161, v161, v48
    v_sub_f32 v162, v162, v48
    v_sub_f32 v163, v163, v48
    v_sub_f32 v164, v164, v48
    v_sub_f32 v165, v165, v48
    v_sub_f32 v166, v166, v48
    v_sub_f32 v167, v167, v48
    v_mul_f32 v12, v12, v49
    v_accvgpr_read_b32 v52, a0
    v_accvgpr_read_b32 v53, a1
    v_accvgpr_read_b32 v54, a2
    v_accvgpr_read_b32 v55, a3
    v_accvgpr_read_b32 v56, a4
    v_accvgpr_read_b32 v57, a5
    v_accvgpr_read_b32 v58, a6
    v_accvgpr_read_b32 v59, a7
    v_mul_f32 v52, v52, v49
    v_mul_f32 v53, v53, v49
    v_mul_f32 v54, v54, v49
    v_mul_f32 v55, v55, v49
    v_mul_f32 v56, v56, v49
    v_mul_f32 v57, v57, v49
    v_mul_f32 v58, v58, v49
    v_mul_f32 v59, v59, v49
    v_accvgpr_write_b32 a0, v52
    v_accvgpr_write_b32 a1, v53
    v_accvgpr_write_b32 a2, v54
    v_accvgpr_write_b32 a3, v55
    v_accvgpr_write_b32 a4, v56
    v_accvgpr_write_b32 a5, v57
    v_accvgpr_write_b32 a6, v58
    v_accvgpr_write_b32 a7, v59
    v_accvgpr_read_b32 v52, a8
    v_accvgpr_read_b32 v53, a9
    v_accvgpr_read_b32 v54, a10
    v_accvgpr_read_b32 v55, a11
    v_accvgpr_read_b32 v56, a12
    v_accvgpr_read_b32 v57, a13
    v_accvgpr_read_b32 v58, a14
    v_accvgpr_read_b32 v59, a15
    v_mul_f32 v52, v52, v49
    v_mul_f32 v53, v53, v49
    v_mul_f32 v54, v54, v49
    v_mul_f32 v55, v55, v49
    v_mul_f32 v56, v56, v49
    v_mul_f32 v57, v57, v49
    v_mul_f32 v58, v58, v49
    v_mul_f32 v59, v59, v49
    v_accvgpr_write_b32 a8, v52
    v_accvgpr_write_b32 a9, v53
    v_accvgpr_write_b32 a10, v54
    v_accvgpr_write_b32 a11, v55
    v_accvgpr_write_b32 a12, v56
    v_accvgpr_write_b32 a13, v57
    v_accvgpr_write_b32 a14, v58
    v_accvgpr_write_b32 a15, v59
    v_accvgpr_read_b32 v52, a16
    v_accvgpr_read_b32 v53, a17
    v_accvgpr_read_b32 v54, a18
    v_accvgpr_read_b32 v55, a19
    v_accvgpr_read_b32 v56, a20
    v_accvgpr_read_b32 v57, a21
    v_accvgpr_read_b32 v58, a22
    v_accvgpr_read_b32 v59, a23
    v_mul_f32 v52, v52, v49
    v_mul_f32 v53, v53, v49
    v_mul_f32 v54, v54, v49
    v_mul_f32 v55, v55, v49
    v_mul_f32 v56, v56, v49
    v_mul_f32 v57, v57, v49
    v_mul_f32 v58, v58, v49
    v_mul_f32 v59, v59, v49
    v_accvgpr_write_b32 a16, v52
    v_accvgpr_write_b32 a17, v53
    v_accvgpr_write_b32 a18, v54
    v_accvgpr_write_b32 a19, v55
    v_accvgpr_write_b32 a20, v56
    v_accvgpr_write_b32 a21, v57
    v_accvgpr_write_b32 a22, v58
    v_accvgpr_write_b32 a23, v59
    v_accvgpr_read_b32 v52, a24
    v_accvgpr_read_b32 v53, a25
    v_accvgpr_read_b32 v54, a26
    v_accvgpr_read_b32 v55, a27
    v_accvgpr_read_b32 v56, a28
    v_accvgpr_read_b32 v57, a29
    v_accvgpr_read_b32 v58, a30
    v_accvgpr_read_b32 v59, a31
    v_mul_f32 v52, v52, v49
    v_mul_f32 v53, v53, v49
    v_mul_f32 v54, v54, v49
    v_mul_f32 v55, v55, v49
    v_mul_f32 v56, v56, v49
    v_mul_f32 v57, v57, v49
    v_mul_f32 v58, v58, v49
    v_mul_f32 v59, v59, v49
    v_accvgpr_write_b32 a24, v52
    v_accvgpr_write_b32 a25, v53
    v_accvgpr_write_b32 a26, v54
    v_accvgpr_write_b32 a27, v55
    v_accvgpr_write_b32 a28, v56
    v_accvgpr_write_b32 a29, v57
    v_accvgpr_write_b32 a30, v58
    v_accvgpr_write_b32 a31, v59
    v_exp_f32 v52, v96
    v_exp_f32 v53, v97
    v_exp_f32 v54, v98
    v_exp_f32 v55, v99
    v_exp_f32 v56, v100
    v_exp_f32 v57, v101
    v_exp_f32 v58, v102
    v_exp_f32 v59, v103
    s_nop 0
    v_cvt_pk_bf16_f32 v144, v52, v53
    v_cvt_pk_bf16_f32 v145, v54, v55
    v_cvt_pk_bf16_f32 v146, v56, v57
    v_cvt_pk_bf16_f32 v147, v58, v59
    s_nop 1
    v_mfma_f32_16x16x32_bf16 v[28:31], v[44:47], v[144:147], 0
    v_max3_f32 v48, v104, v105, v106
    v_max3_f32 v48, v48, v107, v108
    v_max3_f32 v48, v48, v109, v110
    v_max3_f32 v48, v48, v111, 0
    v_mov_b32 v49, v48
    s_nop 1
    v_permlane32_swap_b32 v48, v49
    s_nop 1
    v_max_f32 v48, v48, v49
    v_mov_b32 v49, v48
    s_nop 1
    v_permlane16_swap_b32 v48, v49
    s_nop 1
    v_max_f32 v48, v48, v49
    v_exp_f32 v49, -v48
    v_sub_f32 v104, v104, v48
    v_sub_f32 v105, v105, v48
    v_sub_f32 v106, v106, v48
    v_sub_f32 v107, v107, v48
    v_sub_f32 v108, v108, v48
    v_sub_f32 v109, v109, v48
    v_sub_f32 v110, v110, v48
    v_sub_f32 v111, v111, v48
    v_sub_f32 v72, v72, v48
    v_sub_f32 v73, v73, v48
    v_sub_f32 v74, v74, v48
    v_sub_f32 v75, v75, v48
    v_sub_f32 v76, v76, v48
    v_sub_f32 v77, v77, v48
    v_sub_f32 v78, v78, v48
    v_sub_f32 v79, v79, v48
    v_sub_f32 v168, v168, v48
    v_sub_f32 v169, v169, v48
    v_sub_f32 v170, v170, v48
    v_sub_f32 v171, v171, v48
    v_sub_f32 v172, v172, v48
    v_sub_f32 v173, v173, v48
    v_sub_f32 v174, v174, v48
    v_sub_f32 v175, v175, v48
    v_mul_f32 v13, v13, v49
    v_accvgpr_read_b32 v52, a32
    v_accvgpr_read_b32 v53, a33
    v_accvgpr_read_b32 v54, a34
    v_accvgpr_read_b32 v55, a35
    v_accvgpr_read_b32 v56, a36
    v_accvgpr_read_b32 v57, a37
    v_accvgpr_read_b32 v58, a38
    v_accvgpr_read_b32 v59, a39
    v_mul_f32 v52, v52, v49
    v_mul_f32 v53, v53, v49
    v_mul_f32 v54, v54, v49
    v_mul_f32 v55, v55, v49
    v_mul_f32 v56, v56, v49
    v_mul_f32 v57, v57, v49
    v_mul_f32 v58, v58, v49
    v_mul_f32 v59, v59, v49
    v_accvgpr_write_b32 a32, v52
    v_accvgpr_write_b32 a33, v53
    v_accvgpr_write_b32 a34, v54
    v_accvgpr_write_b32 a35, v55
    v_accvgpr_write_b32 a36, v56
    v_accvgpr_write_b32 a37, v57
    v_accvgpr_write_b32 a38, v58
    v_accvgpr_write_b32 a39, v59
    v_accvgpr_read_b32 v52, a40
    v_accvgpr_read_b32 v53, a41
    v_accvgpr_read_b32 v54, a42
    v_accvgpr_read_b32 v55, a43
    v_accvgpr_read_b32 v56, a44
    v_accvgpr_read_b32 v57, a45
    v_accvgpr_read_b32 v58, a46
    v_accvgpr_read_b32 v59, a47
    v_mul_f32 v52, v52, v49
    v_mul_f32 v53, v53, v49
    v_mul_f32 v54, v54, v49
    v_mul_f32 v55, v55, v49
    v_mul_f32 v56, v56, v49
    v_mul_f32 v57, v57, v49
    v_mul_f32 v58, v58, v49
    v_mul_f32 v59, v59, v49
    v_accvgpr_write_b32 a40, v52
    v_accvgpr_write_b32 a41, v53
    v_accvgpr_write_b32 a42, v54
    v_accvgpr_write_b32 a43, v55
    v_accvgpr_write_b32 a44, v56
    v_accvgpr_write_b32 a45, v57
    v_accvgpr_write_b32 a46, v58
    v_accvgpr_write_b32 a47, v59
    v_accvgpr_read_b32 v52, a48
    v_accvgpr_read_b32 v53, a49
    v_accvgpr_read_b32 v54, a50
    v_accvgpr_read_b32 v55, a51
    v_accvgpr_read_b32 v56, a52
    v_accvgpr_read_b32 v57, a53
    v_accvgpr_read_b32 v58, a54
    v_accvgpr_read_b32 v59, a55
    v_mul_f32 v52, v52, v49
    v_mul_f32 v53, v53, v49
    v_mul_f32 v54, v54, v49
    v_mul_f32 v55, v55, v49
    v_mul_f32 v56, v56, v49
    v_mul_f32 v57, v57, v49
    v_mul_f32 v58, v58, v49
    v_mul_f32 v59, v59, v49
    v_accvgpr_write_b32 a48, v52
    v_accvgpr_write_b32 a49, v53
    v_accvgpr_write_b32 a50, v54
    v_accvgpr_write_b32 a51, v55
    v_accvgpr_write_b32 a52, v56
    v_accvgpr_write_b32 a53, v57
    v_accvgpr_write_b32 a54, v58
    v_accvgpr_write_b32 a55, v59
    v_accvgpr_read_b32 v52, a56
    v_accvgpr_read_b32 v53, a57
    v_accvgpr_read_b32 v54, a58
    v_accvgpr_read_b32 v55, a59
    v_accvgpr_read_b32 v56, a60
    v_accvgpr_read_b32 v57, a61
    v_accvgpr_read_b32 v58, a62
    v_accvgpr_read_b32 v59, a63
    v_mul_f32 v52, v52, v49
    v_mul_f32 v53, v53, v49
    v_mul_f32 v54, v54, v49
    v_mul_f32 v55, v55, v49
    v_mul_f32 v56, v56, v49
    v_mul_f32 v57, v57, v49
    v_mul_f32 v58, v58, v49
    v_mul_f32 v59, v59, v49
    v_accvgpr_write_b32 a56, v52
    v_accvgpr_write_b32 a57, v53
    v_accvgpr_write_b32 a58, v54
    v_accvgpr_write_b32 a59, v55
    v_accvgpr_write_b32 a60, v56
    v_accvgpr_write_b32 a61, v57
    v_accvgpr_write_b32 a62, v58
    v_accvgpr_write_b32 a63, v59
    v_exp_f32 v52, v104
    v_exp_f32 v53, v105
    v_exp_f32 v54, v106
    v_exp_f32 v55, v107
    v_exp_f32 v56, v108
    v_exp_f32 v57, v109
    v_exp_f32 v58, v110
    v_exp_f32 v59, v111
    s_nop 0
    v_cvt_pk_bf16_f32 v148, v52, v53
    v_cvt_pk_bf16_f32 v149, v54, v55
    v_cvt_pk_bf16_f32 v150, v56, v57
    v_cvt_pk_bf16_f32 v151, v58, v59
    s_nop 1
    v_mfma_f32_16x16x32_bf16 v[32:35], v[44:47], v[148:151], 0
    s_nop 7
    s_setpc_b64 s[74:75]
m_rs1472:
    s_nop 15
    v_max3_f32 v48, v96, v97, v98
    v_max3_f32 v48, v48, v99, v100
    v_max3_f32 v48, v48, v101, v102
    v_max3_f32 v48, v48, v103, 0
    v_mov_b32 v49, v48
    s_nop 1
    v_permlane32_swap_b32 v48, v49
    s_nop 1
    v_max_f32 v48, v48, v49
    v_mov_b32 v49, v48
    s_nop 1
    v_permlane16_swap_b32 v48, v49
    s_nop 1
    v_max_f32 v48, v48, v49
    v_exp_f32 v49, -v48
    v_sub_f32 v96, v96, v48
    v_sub_f32 v97, v97, v48
    v_sub_f32 v98, v98, v48
    v_sub_f32 v99, v99, v48
    v_sub_f32 v100, v100, v48
    v_sub_f32 v101, v101, v48
    v_sub_f32 v102, v102, v48
    v_sub_f32 v103, v103, v48
    v_sub_f32 v64, v64, v48
    v_sub_f32 v65, v65, v48
    v_sub_f32 v66, v66, v48
    v_sub_f32 v67, v67, v48
    v_sub_f32 v68, v68, v48
    v_sub_f32 v69, v69, v48
    v_sub_f32 v70, v70, v48
    v_sub_f32 v71, v71, v48
    v_sub_f32 v160, v160, v48
    v_sub_f32 v161, v161, v48
    v_sub_f32 v162, v162, v48
    v_sub_f32 v163, v163, v48
    v_sub_f32 v164, v164, v48
    v_sub_f32 v165, v165, v48
    v_sub_f32 v166, v166, v48
    v_sub_f32 v167, v167, v48
    v_mul_f32 v12, v12, v49
    v_accvgpr_read_b32 v52, a0
    v_accvgpr_read_b32 v53, a1
    v_accvgpr_read_b32 v54, a2
    v_accvgpr_read_b32 v55, a3
    v_accvgpr_read_b32 v56, a4
    v_accvgpr_read_b32 v57, a5
    v_accvgpr_read_b32 v58, a6
    v_accvgpr_read_b32 v59, a7
    v_mul_f32 v52, v52, v49
    v_mul_f32 v53, v53, v49
    v_mul_f32 v54, v54, v49
    v_mul_f32 v55, v55, v49
    v_mul_f32 v56, v56, v49
    v_mul_f32 v57, v57, v49
    v_mul_f32 v58, v58, v49
    v_mul_f32 v59, v59, v49
    v_accvgpr_write_b32 a0, v52
    v_accvgpr_write_b32 a1, v53
    v_accvgpr_write_b32 a2, v54
    v_accvgpr_write_b32 a3, v55
    v_accvgpr_write_b32 a4, v56
    v_accvgpr_write_b32 a5, v57
    v_accvgpr_write_b32 a6, v58
    v_accvgpr_write_b32 a7, v59
    v_accvgpr_read_b32 v52, a8
    v_accvgpr_read_b32 v53, a9
    v_accvgpr_read_b32 v54, a10
    v_accvgpr_read_b32 v55, a11
    v_accvgpr_read_b32 v56, a12
    v_accvgpr_read_b32 v57, a13
    v_accvgpr_read_b32 v58, a14
    v_accvgpr_read_b32 v59, a15
    v_mul_f32 v52, v52, v49
    v_mul_f32 v53, v53, v49
    v_mul_f32 v54, v54, v49
    v_mul_f32 v55, v55, v49
    v_mul_f32 v56, v56, v49
    v_mul_f32 v57, v57, v49
    v_mul_f32 v58, v58, v49
    v_mul_f32 v59, v59, v49
    v_accvgpr_write_b32 a8, v52
    v_accvgpr_write_b32 a9, v53
    v_accvgpr_write_b32 a10, v54
    v_accvgpr_write_b32 a11, v55
    v_accvgpr_write_b32 a12, v56
    v_accvgpr_write_b32 a13, v57
    v_accvgpr_write_b32 a14, v58
    v_accvgpr_write_b32 a15, v59
    v_accvgpr_read_b32 v52, a16
    v_accvgpr_read_b32 v53, a17
    v_accvgpr_read_b32 v54, a18
    v_accvgpr_read_b32 v55, a19
    v_accvgpr_read_b32 v56, a20
    v_accvgpr_read_b32 v57, a21
    v_accvgpr_read_b32 v58, a22
    v_accvgpr_read_b32 v59, a23
    v_mul_f32 v52, v52, v49
    v_mul_f32 v53, v53, v49
    v_mul_f32 v54, v54, v49
    v_mul_f32 v55, v55, v49
    v_mul_f32 v56, v56, v49
    v_mul_f32 v57, v57, v49
    v_mul_f32 v58, v58, v49
    v_mul_f32 v59, v59, v49
    v_accvgpr_write_b32 a16, v52
    v_accvgpr_write_b32 a17, v53
    v_accvgpr_write_b32 a18, v54
    v_accvgpr_write_b32 a19, v55
    v_accvgpr_write_b32 a20, v56
    v_accvgpr_write_b32 a21, v57
    v_accvgpr_write_b32 a22, v58
    v_accvgpr_write_b32 a23, v59
    v_accvgpr_read_b32 v52, a24
    v_accvgpr_read_b32 v53, a25
    v_accvgpr_read_b32 v54, a26
    v_accvgpr_read_b32 v55, a27
    v_accvgpr_read_b32 v56, a28
    v_accvgpr_read_b32 v57, a29
    v_accvgpr_read_b32 v58, a30
    v_accvgpr_read_b32 v59, a31
    v_mul_f32 v52, v52, v49
    v_mul_f32 v53, v53, v49
    v_mul_f32 v54, v54, v49
    v_mul_f32 v55, v55, v49
    v_mul_f32 v56, v56, v49
    v_mul_f32 v57, v57, v49
    v_mul_f32 v58, v58, v49
    v_mul_f32 v59, v59, v49
    v_accvgpr_write_b32 a24, v52
    v_accvgpr_write_b32 a25, v53
    v_accvgpr_write_b32 a26, v54
    v_accvgpr_write_b32 a27, v55
    v_accvgpr_write_b32 a28, v56
    v_accvgpr_write_b32 a29, v57
    v_accvgpr_write_b32 a30, v58
    v_accvgpr_write_b32 a31, v59
    v_exp_f32 v52, v96
    v_exp_f32 v53, v97
    v_exp_f32 v54, v98
    v_exp_f32 v55, v99
    v_exp_f32 v56, v100
    v_exp_f32 v57, v101
    v_exp_f32 v58, v102
    v_exp_f32 v59, v103
    s_nop 0
    v_cvt_pk_bf16_f32 v144, v52, v53
    v_cvt_pk_bf16_f32 v145, v54, v55
    v_cvt_pk_bf16_f32 v146, v56, v57
    v_cvt_pk_bf16_f32 v147, v58, v59
    s_nop 1
    v_mfma_f32_16x16x32_bf16 v[28:31], v[44:47], v[144:147], 0
    v_max3_f32 v48, v104, v105, v106
    v_max3_f32 v48, v48, v107, v108
    v_max3_f32 v48, v48, v109, v110
    v_max3_f32 v48, v48, v111, 0
    v_mov_b32 v49, v48
    s_nop 1
    v_permlane32_swap_b32 v48, v49
    s_nop 1
    v_max_f32 v48, v48, v49
    v_mov_b32 v49, v48
    s_nop 1
    v_permlane16_swap_b32 v48, v49
    s_nop 1
    v_max_f32 v48, v48, v49
    v_exp_f32 v49, -v48
    v_sub_f32 v104, v104, v48
    v_sub_f32 v105, v105, v48
    v_sub_f32 v106, v106, v48
    v_sub_f32 v107, v107, v48
    v_sub_f32 v108, v108, v48
    v_sub_f32 v109, v109, v48
    v_sub_f32 v110, v110, v48
    v_sub_f32 v111, v111, v48
    v_sub_f32 v72, v72, v48
    v_sub_f32 v73, v73, v48
    v_sub_f32 v74, v74, v48
    v_sub_f32 v75, v75, v48
    v_sub_f32 v76, v76, v48
    v_sub_f32 v77, v77, v48
    v_sub_f32 v78, v78, v48
    v_sub_f32 v79, v79, v48
    v_sub_f32 v168, v168, v48
    v_sub_f32 v169, v169, v48
    v_sub_f32 v170, v170, v48
    v_sub_f32 v171, v171, v48
    v_sub_f32 v172, v172, v48
    v_sub_f32 v173, v173, v48
    v_sub_f32 v174, v174, v48
    v_sub_f32 v175, v175, v48
    v_mul_f32 v13, v13, v49
    v_accvgpr_read_b32 v52, a32
    v_accvgpr_read_b32 v53, a33
    v_accvgpr_read_b32 v54, a34
    v_accvgpr_read_b32 v55, a35
    v_accvgpr_read_b32 v56, a36
    v_accvgpr_read_b32 v57, a37
    v_accvgpr_read_b32 v58, a38
    v_accvgpr_read_b32 v59, a39
    v_mul_f32 v52, v52, v49
    v_mul_f32 v53, v53, v49
    v_mul_f32 v54, v54, v49
    v_mul_f32 v55, v55, v49
    v_mul_f32 v56, v56, v49
    v_mul_f32 v57, v57, v49
    v_mul_f32 v58, v58, v49
    v_mul_f32 v59, v59, v49
    v_accvgpr_write_b32 a32, v52
    v_accvgpr_write_b32 a33, v53
    v_accvgpr_write_b32 a34, v54
    v_accvgpr_write_b32 a35, v55
    v_accvgpr_write_b32 a36, v56
    v_accvgpr_write_b32 a37, v57
    v_accvgpr_write_b32 a38, v58
    v_accvgpr_write_b32 a39, v59
    v_accvgpr_read_b32 v52, a40
    v_accvgpr_read_b32 v53, a41
    v_accvgpr_read_b32 v54, a42
    v_accvgpr_read_b32 v55, a43
    v_accvgpr_read_b32 v56, a44
    v_accvgpr_read_b32 v57, a45
    v_accvgpr_read_b32 v58, a46
    v_accvgpr_read_b32 v59, a47
    v_mul_f32 v52, v52, v49
    v_mul_f32 v53, v53, v49
    v_mul_f32 v54, v54, v49
    v_mul_f32 v55, v55, v49
    v_mul_f32 v56, v56, v49
    v_mul_f32 v57, v57, v49
    v_mul_f32 v58, v58, v49
    v_mul_f32 v59, v59, v49
    v_accvgpr_write_b32 a40, v52
    v_accvgpr_write_b32 a41, v53
    v_accvgpr_write_b32 a42, v54
    v_accvgpr_write_b32 a43, v55
    v_accvgpr_write_b32 a44, v56
    v_accvgpr_write_b32 a45, v57
    v_accvgpr_write_b32 a46, v58
    v_accvgpr_write_b32 a47, v59
    v_accvgpr_read_b32 v52, a48
    v_accvgpr_read_b32 v53, a49
    v_accvgpr_read_b32 v54, a50
    v_accvgpr_read_b32 v55, a51
    v_accvgpr_read_b32 v56, a52
    v_accvgpr_read_b32 v57, a53
    v_accvgpr_read_b32 v58, a54
    v_accvgpr_read_b32 v59, a55
    v_mul_f32 v52, v52, v49
    v_mul_f32 v53, v53, v49
    v_mul_f32 v54, v54, v49
    v_mul_f32 v55, v55, v49
    v_mul_f32 v56, v56, v49
    v_mul_f32 v57, v57, v49
    v_mul_f32 v58, v58, v49
    v_mul_f32 v59, v59, v49
    v_accvgpr_write_b32 a48, v52
    v_accvgpr_write_b32 a49, v53
    v_accvgpr_write_b32 a50, v54
    v_accvgpr_write_b32 a51, v55
    v_accvgpr_write_b32 a52, v56
    v_accvgpr_write_b32 a53, v57
    v_accvgpr_write_b32 a54, v58
    v_accvgpr_write_b32 a55, v59
    v_accvgpr_read_b32 v52, a56
    v_accvgpr_read_b32 v53, a57
    v_accvgpr_read_b32 v54, a58
    v_accvgpr_read_b32 v55, a59
    v_accvgpr_read_b32 v56, a60
    v_accvgpr_read_b32 v57, a61
    v_accvgpr_read_b32 v58, a62
    v_accvgpr_read_b32 v59, a63
    v_mul_f32 v52, v52, v49
    v_mul_f32 v53, v53, v49
    v_mul_f32 v54, v54, v49
    v_mul_f32 v55, v55, v49
    v_mul_f32 v56, v56, v49
    v_mul_f32 v57, v57, v49
    v_mul_f32 v58, v58, v49
    v_mul_f32 v59, v59, v49
    v_accvgpr_write_b32 a56, v52
    v_accvgpr_write_b32 a57, v53
    v_accvgpr_write_b32 a58, v54
    v_accvgpr_write_b32 a59, v55
    v_accvgpr_write_b32 a60, v56
    v_accvgpr_write_b32 a61, v57
    v_accvgpr_write_b32 a62, v58
    v_accvgpr_write_b32 a63, v59
    v_exp_f32 v52, v104
    v_exp_f32 v53, v105
    v_exp_f32 v54, v106
    v_exp_f32 v55, v107
    v_exp_f32 v56, v108
    v_exp_f32 v57, v109
    v_exp_f32 v58, v110
    v_exp_f32 v59, v111
    s_nop 0
    v_cvt_pk_bf16_f32 v148, v52, v53
    v_cvt_pk_bf16_f32 v149, v54, v55
    v_cvt_pk_bf16_f32 v150, v56, v57
    v_cvt_pk_bf16_f32 v151, v58, v59
    s_nop 1
    v_mfma_f32_16x16x32_bf16 v[32:35], v[44:47], v[148:151], 0
    v_max3_f32 v48, v112, v113, v114
    v_max3_f32 v48, v48, v115, v116
    v_max3_f32 v48, v48, v117, v118
    v_max3_f32 v48, v48, v119, 0
    v_mov_b32 v49, v48
    s_nop 1
    v_permlane32_swap_b32 v48, v49
    s_nop 1
    v_max_f32 v48, v48, v49
    v_mov_b32 v49, v48
    s_nop 1
    v_permlane16_swap_b32 v48, v49
    s_nop 1
    v_max_f32 v48, v48, v49
    v_exp_f32 v49, -v48
    v_sub_f32 v112, v112, v48
    v_sub_f32 v113, v113, v48
    v_sub_f32 v114, v114, v48
    v_sub_f32 v115, v115, v48
    v_sub_f32 v116, v116, v48
    v_sub_f32 v117, v117, v48
    v_sub_f32 v118, v118, v48
    v_sub_f32 v119, v119, v48
    v_sub_f32 v80, v80, v48
    v_sub_f32 v81, v81, v48
    v_sub_f32 v82, v82, v48
    v_sub_f32 v83, v83, v48
    v_sub_f32 v84, v84, v48
    v_sub_f32 v85, v85, v48
    v_sub_f32 v86, v86, v48
    v_sub_f32 v87, v87, v48
    v_sub_f32 v176, v176, v48
    v_sub_f32 v177, v177, v48
    v_sub_f32 v178, v178, v48
    v_sub_f32 v179, v179, v48
    v_sub_f32 v180, v180, v48
    v_sub_f32 v181, v181, v48
    v_sub_f32 v182, v182, v48
    v_sub_f32 v183, v183, v48
    v_mul_f32 v14, v14, v49
    v_accvgpr_read_b32 v52, a64
    v_accvgpr_read_b32 v53, a65
    v_accvgpr_read_b32 v54, a66
    v_accvgpr_read_b32 v55, a67
    v_accvgpr_read_b32 v56, a68
    v_accvgpr_read_b32 v57, a69
    v_accvgpr_read_b32 v58, a70
    v_accvgpr_read_b32 v59, a71
    v_mul_f32 v52, v52, v49
    v_mul_f32 v53, v53, v49
    v_mul_f32 v54, v54, v49
    v_mul_f32 v55, v55, v49
    v_mul_f32 v56, v56, v49
    v_mul_f32 v57, v57, v49
    v_mul_f32 v58, v58, v49
    v_mul_f32 v59, v59, v49
    v_accvgpr_write_b32 a64, v52
    v_accvgpr_write_b32 a65, v53
    v_accvgpr_write_b32 a66, v54
    v_accvgpr_write_b32 a67, v55
    v_accvgpr_write_b32 a68, v56
    v_accvgpr_write_b32 a69, v57
    v_accvgpr_write_b32 a70, v58
    v_accvgpr_write_b32 a71, v59
    v_accvgpr_read_b32 v52, a72
    v_accvgpr_read_b32 v53, a73
    v_accvgpr_read_b32 v54, a74
    v_accvgpr_read_b32 v55, a75
    v_accvgpr_read_b32 v56, a76
    v_accvgpr_read_b32 v57, a77
    v_accvgpr_read_b32 v58, a78
    v_accvgpr_read_b32 v59, a79
    v_mul_f32 v52, v52, v49
    v_mul_f32 v53, v53, v49
    v_mul_f32 v54, v54, v49
    v_mul_f32 v55, v55, v49
    v_mul_f32 v56, v56, v49
    v_mul_f32 v57, v57, v49
    v_mul_f32 v58, v58, v49
    v_mul_f32 v59, v59, v49
    v_accvgpr_write_b32 a72, v52
    v_accvgpr_write_b32 a73, v53
    v_accvgpr_write_b32 a74, v54
    v_accvgpr_write_b32 a75, v55
    v_accvgpr_write_b32 a76, v56
    v_accvgpr_write_b32 a77, v57
    v_accvgpr_write_b32 a78, v58
    v_accvgpr_write_b32 a79, v59
    v_accvgpr_read_b32 v52, a80
    v_accvgpr_read_b32 v53, a81
    v_accvgpr_read_b32 v54, a82
    v_accvgpr_read_b32 v55, a83
    v_accvgpr_read_b32 v56, a84
    v_accvgpr_read_b32 v57, a85
    v_accvgpr_read_b32 v58, a86
    v_accvgpr_read_b32 v59, a87
    v_mul_f32 v52, v52, v49
    v_mul_f32 v53, v53, v49
    v_mul_f32 v54, v54, v49
    v_mul_f32 v55, v55, v49
    v_mul_f32 v56, v56, v49
    v_mul_f32 v57, v57, v49
    v_mul_f32 v58, v58, v49
    v_mul_f32 v59, v59, v49
    v_accvgpr_write_b32 a80, v52
    v_accvgpr_write_b32 a81, v53
    v_accvgpr_write_b32 a82, v54
    v_accvgpr_write_b32 a83, v55
    v_accvgpr_write_b32 a84, v56
    v_accvgpr_write_b32 a85, v57
    v_accvgpr_write_b32 a86, v58
    v_accvgpr_write_b32 a87, v59
    v_accvgpr_read_b32 v52, a88
    v_accvgpr_read_b32 v53, a89
    v_accvgpr_read_b32 v54, a90
    v_accvgpr_read_b32 v55, a91
    v_accvgpr_read_b32 v56, a92
    v_accvgpr_read_b32 v57, a93
    v_accvgpr_read_b32 v58, a94
    v_accvgpr_read_b32 v59, a95
    v_mul_f32 v52, v52, v49
    v_mul_f32 v53, v53, v49
    v_mul_f32 v54, v54, v49
    v_mul_f32 v55, v55, v49
    v_mul_f32 v56, v56, v49
    v_mul_f32 v57, v57, v49
    v_mul_f32 v58, v58, v49
    v_mul_f32 v59, v59, v49
    v_accvgpr_write_b32 a88, v52
    v_accvgpr_write_b32 a89, v53
    v_accvgpr_write_b32 a90, v54
    v_accvgpr_write_b32 a91, v55
    v_accvgpr_write_b32 a92, v56
    v_accvgpr_write_b32 a93, v57
    v_accvgpr_write_b32 a94, v58
    v_accvgpr_write_b32 a95, v59
    v_exp_f32 v52, v112
    v_exp_f32 v53, v113
    v_exp_f32 v54, v114
    v_exp_f32 v55, v115
    v_exp_f32 v56, v116
    v_exp_f32 v57, v117
    v_exp_f32 v58, v118
    v_exp_f32 v59, v119
    s_nop 0
    v_cvt_pk_bf16_f32 v152, v52, v53
    v_cvt_pk_bf16_f32 v153, v54, v55
    v_cvt_pk_bf16_f32 v154, v56, v57
    v_cvt_pk_bf16_f32 v155, v58, v59
    s_nop 1
    v_mfma_f32_16x16x32_bf16 v[36:39], v[44:47], v[152:155], 0
    v_max3_f32 v48, v120, v121, v122
    v_max3_f32 v48, v48, v123, v124
    v_max3_f32 v48, v48, v125, v126
    v_max3_f32 v48, v48, v127, 0
    v_mov_b32 v49, v48
    s_nop 1
    v_permlane32_swap_b32 v48, v49
    s_nop 1
    v_max_f32 v48, v48, v49
    v_mov_b32 v49, v48
    s_nop 1
    v_permlane16_swap_b32 v48, v49
    s_nop 1
    v_max_f32 v48, v48, v49
    v_exp_f32 v49, -v48
    v_sub_f32 v120, v120, v48
    v_sub_f32 v121, v121, v48
    v_sub_f32 v122, v122, v48
    v_sub_f32 v123, v123, v48
    v_sub_f32 v124, v124, v48
    v_sub_f32 v125, v125, v48
    v_sub_f32 v126, v126, v48
    v_sub_f32 v127, v127, v48
    v_sub_f32 v88, v88, v48
    v_sub_f32 v89, v89, v48
    v_sub_f32 v90, v90, v48
    v_sub_f32 v91, v91, v48
    v_sub_f32 v92, v92, v48
    v_sub_f32 v93, v93, v48
    v_sub_f32 v94, v94, v48
    v_sub_f32 v95, v95, v48
    v_sub_f32 v184, v184, v48
    v_sub_f32 v185, v185, v48
    v_sub_f32 v186, v186, v48
    v_sub_f32 v187, v187, v48
    v_sub_f32 v188, v188, v48
    v_sub_f32 v189, v189, v48
    v_sub_f32 v190, v190, v48
    v_sub_f32 v191, v191, v48
    v_mul_f32 v15, v15, v49
    v_accvgpr_read_b32 v52, a96
    v_accvgpr_read_b32 v53, a97
    v_accvgpr_read_b32 v54, a98
    v_accvgpr_read_b32 v55, a99
    v_accvgpr_read_b32 v56, a100
    v_accvgpr_read_b32 v57, a101
    v_accvgpr_read_b32 v58, a102
    v_accvgpr_read_b32 v59, a103
    v_mul_f32 v52, v52, v49
    v_mul_f32 v53, v53, v49
    v_mul_f32 v54, v54, v49
    v_mul_f32 v55, v55, v49
    v_mul_f32 v56, v56, v49
    v_mul_f32 v57, v57, v49
    v_mul_f32 v58, v58, v49
    v_mul_f32 v59, v59, v49
    v_accvgpr_write_b32 a96, v52
    v_accvgpr_write_b32 a97, v53
    v_accvgpr_write_b32 a98, v54
    v_accvgpr_write_b32 a99, v55
    v_accvgpr_write_b32 a100, v56
    v_accvgpr_write_b32 a101, v57
    v_accvgpr_write_b32 a102, v58
    v_accvgpr_write_b32 a103, v59
    v_accvgpr_read_b32 v52, a104
    v_accvgpr_read_b32 v53, a105
    v_accvgpr_read_b32 v54, a106
    v_accvgpr_read_b32 v55, a107
    v_accvgpr_read_b32 v56, a108
    v_accvgpr_read_b32 v57, a109
    v_accvgpr_read_b32 v58, a110
    v_accvgpr_read_b32 v59, a111
    v_mul_f32 v52, v52, v49
    v_mul_f32 v53, v53, v49
    v_mul_f32 v54, v54, v49
    v_mul_f32 v55, v55, v49
    v_mul_f32 v56, v56, v49
    v_mul_f32 v57, v57, v49
    v_mul_f32 v58, v58, v49
    v_mul_f32 v59, v59, v49
    v_accvgpr_write_b32 a104, v52
    v_accvgpr_write_b32 a105, v53
    v_accvgpr_write_b32 a106, v54
    v_accvgpr_write_b32 a107, v55
    v_accvgpr_write_b32 a108, v56
    v_accvgpr_write_b32 a109, v57
    v_accvgpr_write_b32 a110, v58
    v_accvgpr_write_b32 a111, v59
    v_accvgpr_read_b32 v52, a112
    v_accvgpr_read_b32 v53, a113
    v_accvgpr_read_b32 v54, a114
    v_accvgpr_read_b32 v55, a115
    v_accvgpr_read_b32 v56, a116
    v_accvgpr_read_b32 v57, a117
    v_accvgpr_read_b32 v58, a118
    v_accvgpr_read_b32 v59, a119
    v_mul_f32 v52, v52, v49
    v_mul_f32 v53, v53, v49
    v_mul_f32 v54, v54, v49
    v_mul_f32 v55, v55, v49
    v_mul_f32 v56, v56, v49
    v_mul_f32 v57, v57, v49
    v_mul_f32 v58, v58, v49
    v_mul_f32 v59, v59, v49
    v_accvgpr_write_b32 a112, v52
    v_accvgpr_write_b32 a113, v53
    v_accvgpr_write_b32 a114, v54
    v_accvgpr_write_b32 a115, v55
    v_accvgpr_write_b32 a116, v56
    v_accvgpr_write_b32 a117, v57
    v_accvgpr_write_b32 a118, v58
    v_accvgpr_write_b32 a119, v59
    v_accvgpr_read_b32 v52, a120
    v_accvgpr_read_b32 v53, a121
    v_accvgpr_read_b32 v54, a122
    v_accvgpr_read_b32 v55, a123
    v_accvgpr_read_b32 v56, a124
    v_accvgpr_read_b32 v57, a125
    v_accvgpr_read_b32 v58, a126
    v_accvgpr_read_b32 v59, a127
    v_mul_f32 v52, v52, v49
    v_mul_f32 v53, v53, v49
    v_mul_f32 v54, v54, v49
    v_mul_f32 v55, v55, v49
    v_mul_f32 v56, v56, v49
    v_mul_f32 v57, v57, v49
    v_mul_f32 v58, v58, v49
    v_mul_f32 v59, v59, v49
    v_accvgpr_write_b32 a120, v52
    v_accvgpr_write_b32 a121, v53
    v_accvgpr_write_b32 a122, v54
    v_accvgpr_write_b32 a123, v55
    v_accvgpr_write_b32 a124, v56
    v_accvgpr_write_b32 a125, v57
    v_accvgpr_write_b32 a126, v58
    v_accvgpr_write_b32 a127, v59
    v_exp_f32 v52, v120
    v_exp_f32 v53, v121
    v_exp_f32 v54, v122
    v_exp_f32 v55, v123
    v_exp_f32 v56, v124
    v_exp_f32 v57, v125
    v_exp_f32 v58, v126
    v_exp_f32 v59, v127
    s_nop 0
    v_cvt_pk_bf16_f32 v156, v52, v53
    v_cvt_pk_bf16_f32 v157, v54, v55
    v_cvt_pk_bf16_f32 v158, v56, v57
    v_cvt_pk_bf16_f32 v159, v58, v59
    s_nop 1
    v_mfma_f32_16x16x32_bf16 v[40:43], v[44:47], v[156:159], 0
    s_nop 7
    s_setpc_b64 s[74:75]
m_hook14:
    s_cmp_lg_u32 s16, 0
    s_cbranch_scc1 m_np38
    v_mov_b32 v4, s4
    v_mov_b32 v5, s5
    s_add_u32 s90, s17, 117440512
    s_mov_b64 exec, 1
    buffer_store_dwordx2 v[4:5], off, s[8:11], s90 sc1
    s_mov_b64 exec, -1
m_np38:
    s_mov_b32 s17, -1
    s_branch m_hookr15
m_hook18:
    s_cmp_lg_u32 s16, 0
    s_cbranch_scc1 m_np39
    v_mov_b32 v4, s4
    v_mov_b32 v5, s5
    s_add_u32 s90, s17, 117440512
    s_mov_b64 exec, 1
    buffer_store_dwordx2 v[4:5], off, s[8:11], s90 sc1
    s_mov_b64 exec, -1
m_np39:
    s_mov_b32 s17, -1
    s_branch m_hookr19
m_dosw17:
    s_cmp_eq_u32 s94, 0
    s_cbranch_scc1 m_x40
    s_cmp_lg_u32 s65, 3
    s_cbranch_scc1 m_x46
    s_mov_b32 s42, s73
    s_lshl_b32 s90, s77, 4
    s_lshl_b32 s90, s90, s81
    s_mov_b32 s48, s79
    s_mul_i32 s91, s90, 1
    s_add_u32 s49, s91, s79
    s_sub_u32 s49, s49, 2048
    s_mul_i32 s91, s90, 2
    s_add_u32 s50, s91, s79
    s_mul_i32 s91, s90, 3
    s_add_u32 s51, s91, s79
    s_sub_u32 s51, s51, 2048
    s_lshl_b32 s90, s58, 7
    s_add_u32 s90, s90, s57
    s_lshl_b32 s91, s16, 6
    s_cmp_eq_u32 s81, 1
    s_cselect_b32 s90, s90, s91
    v_lshrrev_b32 v24, 3, v1
    v_lshlrev_b32 v24, s81, v24
    v_add_u32 v24, s90, v24
    v_mul_lo_u32 v24, v24, s77
    v_lshrrev_b32 v25, 4, v1
    v_and_b32 v26, 7, v1
    v_xor_b32 v25, v25, v26
    v_lshl_add_u32 v16, v25, 4, v24
    v_xor_b32 v25, 4, v25
    v_lshl_add_u32 v17, v25, 4, v24
    s_lshl_b32 s90, s77, 3
    s_lshl_b32 s90, s90, s81
    s_sub_u32 s90, s90, 1024
    v_add_u32 v17, s90, v17
    s_mov_b32 s40, s71
    s_mov_b32 s41, s72
    buffer_load_dwordx2 v[4:5], off, s[12:15], 0 sc1
    s_branch m_loop16
m_x46:
    s_mov_b32 s46, s76
    s_mov_b32 s52, s80
    s_lshl_b32 s90, s78, 2
    s_mul_i32 s91, s90, 1
    s_add_u32 s53, s91, s80
    s_sub_u32 s53, s53, 2048
    s_mul_i32 s91, s90, 2
    s_add_u32 s54, s91, s80
    s_mul_i32 s91, s90, 3
    s_add_u32 s55, s91, s80
    s_sub_u32 s55, s55, 2048
    s_lshl_b32 s56, s78, 6
    v_lshrrev_b32 v24, 5, v1
    s_lshl_b32 s90, s16, 4
    v_add_u32 v25, s90, v24
    v_mul_lo_u32 v25, v25, s78
    v_lshlrev_b32 v24, 1, v24
    v_and_b32 v26, 31, v1
    v_xor_b32 v24, v24, v26
    s_lshl_b32 s90, s78, 1
    s_sub_u32 s90, s90, 1024
    v_add_u32 v27, s90, v25
    v_xor_b32 v26, 0, v24
    v_lshl_add_u32 v18, v26, 4, v25
    v_xor_b32 v26, 4, v24
    v_lshl_add_u32 v19, v26, 4, v27
    v_xor_b32 v26, 8, v24
    v_lshl_add_u32 v20, v26, 4, v25
    v_xor_b32 v26, 12, v24
    v_lshl_add_u32 v21, v26, 4, v27
    s_mov_b32 s44, s74
    s_mov_b32 s45, s75
    s_mov_b32 s67, 0
    s_branch m_loop16
m_x40:
    s_cmp_eq_u32 s70, 1
    s_cbranch_scc1 m_x45
    s_cmp_le_u32 s65, 4
    s_cbranch_scc1 m_x41
    s_cmp_lg_u32 s16, 0
    s_cbranch_scc1 m_np47
    v_mov_b32 v4, s4
    v_mov_b32 v5, s5
    s_add_u32 s90, s17, 117440512
    s_mov_b64 exec, 1
    buffer_store_dwordx2 v[4:5], off, s[8:11], s90 sc1
    s_mov_b64 exec, -1
m_np47:
    s_mov_b32 s17, -1
    s_mov_b32 s67, 4
    s_branch m_loop16
m_x41:
    s_cmp_lg_u32 s65, 4
    s_cbranch_scc1 m_x42
    s_and_b32 s92, s2, 7
    s_lshl_b32 s92, s92, 2
    s_bfe_u32 s93, s2, 0x20003
    s_add_u32 s92, s92, s93
    s_lshr_b32 s93, s2, 5
    s_lshl_b32 s93, s93, 2
    s_or_b32 s93, s93, 0x40000
    s_lshr_b32 s90, s92, 1
    s_lshl_b32 s90, s90, 7
    s_add_u32 s90, s90, 117440512
    v_and_b32 v0, 3, v1
    v_min_u32 v0, 2, v0
    v_and_b32 v4, 4, v1
    v_add3_u32 v0, v0, v4, 8
    v_lshlrev_b32 v0, 3, v0
    buffer_load_dwordx2 v[4:5], v0, s[8:11], s90 offen sc1
    s_branch m_loop16
m_x42:
    s_waitcnt vmcnt(16)
    s_cmp_lg_u32 s65, 3
    s_cbranch_scc1 m_x43
    s_mov_b32 s3, 1048576
m_spin48:
    v_cmp_ne_u64 s[22:23], s[4:5], v[4:5]
    s_nop 3
    s_cmp_eq_u64 s[22:23], 0
    s_cbranch_scc1 m_ok49
    s_sub_u32 s3, s3, 1
    s_cbranch_scc1 m_ok49
    s_sleep 16
    s_and_b32 s92, s2, 7
    s_lshl_b32 s92, s92, 2
    s_bfe_u32 s93, s2, 0x20003
    s_add_u32 s92, s92, s93
    s_lshr_b32 s93, s2, 5
    s_lshl_b32 s93, s93, 2
    s_or_b32 s93, s93, 0x40000
    s_lshr_b32 s90, s92, 1
    s_lshl_b32 s90, s90, 7
    s_add_u32 s90, s90, 117440512
    v_and_b32 v0, 3, v1
    v_min_u32 v0, 2, v0
    v_and_b32 v4, 4, v1
    v_add3_u32 v0, v0, v4, 8
    v_lshlrev_b32 v0, 3, v0
    buffer_load_dwordx2 v[4:5], v0, s[8:11], s90 offen sc1
    s_waitcnt vmcnt(0)
    s_branch m_spin48
m_ok49:
    s_and_b32 s92, s2, 7
    s_lshl_b32 s92, s92, 2
    s_bfe_u32 s93, s2, 0x20003
    s_add_u32 s92, s92, s93
    s_lshr_b32 s93, s2, 5
    s_lshl_b32 s93, s93, 2
    s_or_b32 s93, s93, 0x40000
    s_lshl_b32 s90, s92, 19
    s_lshl_b32 s91, s58, 13
    s_add_u32 s90, s90, s91
    s_cmp_eq_u32 s57, 0
    s_mov_b32 s91, 33554432
    s_cselect_b32 s91, 16777216, s91
    s_mov_b32 s42, 0
    s_cselect_b32 s42, 268435456, s42
    s_add_u32 s48, s90, s91
    s_mov_b32 s49, s48
    s_add_u32 s50, s48, 4096
    s_mov_b32 s51, s50
    s_mov_b32 s40, s6
    s_mov_b32 s41, s7
    v_mov_b32 v16, v2
    v_mov_b32 v17, v2
    s_branch m_loop16
m_x43:
    s_cmp_lg_u32 s65, 2
    s_cbranch_scc1 m_x44
    s_and_b32 s92, s2, 7
    s_lshl_b32 s92, s92, 2
    s_bfe_u32 s93, s2, 0x20003
    s_add_u32 s92, s92, s93
    s_lshr_b32 s93, s2, 5
    s_lshl_b32 s93, s93, 2
    s_or_b32 s93, s93, 0x40000
    s_lshr_b32 s90, s92, 1
    s_lshl_b32 s90, s90, 7
    s_add_u32 s90, s90, 117440512
    s_bfe_u32 s91, 873473623, s93
    s_lshr_b32 s91, s91, 1
    v_mov_b32 v0, s91
    s_bfe_u32 s91, 4225681832, s93
    s_lshr_b32 s91, s91, 1
    v_writelane_b32 v0, s91, 8
    v_lshlrev_b32 v0, 3, v0
    buffer_load_dwordx2 v[4:5], v0, s[8:11], s90 offen sc1
    s_lshl_b32 s90, s92, 19
    s_lshl_b32 s91, s58, 13
    s_add_u32 s90, s90, s91
    s_cmp_eq_u32 s57, 0
    s_mov_b32 s91, 33554432
    s_cselect_b32 s91, 16793600, s91
    s_mov_b32 s42, 268435456
    s_cselect_b32 s42, 268435456, s42
    s_add_u32 s48, s90, s91
    s_mov_b32 s49, s48
    s_add_u32 s50, s48, 4096
    s_mov_b32 s51, s50
    s_mov_b32 s40, s6
    s_mov_b32 s41, s7
    s_lshl_b32 s90, s92, 19
    s_lshl_b32 s91, s58, 13
    s_add_u32 s90, s90, s91
    s_cmp_eq_u32 s57, 0
    s_mov_b32 s91, 33587200
    s_cselect_b32 s91, 16826368, s91
    s_mov_b32 s46, 268435456
    s_cselect_b32 s46, 268435456, s46
    s_add_u32 s52, s90, s91
    s_mov_b32 s53, s52
    s_add_u32 s54, s52, 4096
    s_mov_b32 s55, s54
    s_mov_b32 s44, s6
    s_mov_b32 s45, s7
    v_mov_b32 v18, v2
    v_mov_b32 v19, v2
    v_mov_b32 v20, v2
    v_mov_b32 v21, v2
    s_branch m_loop16
m_x44:
    s_mov_b32 s3, 1048576
m_spin50:
    v_cmp_ne_u64 s[22:23], s[4:5], v[4:5]
    s_nop 3
    s_cmp_eq_u64 s[22:23], 0
    s_cbranch_scc1 m_ok51
    s_sub_u32 s3, s3, 1
    s_cbranch_scc1 m_ok51
    s_sleep 16
    s_and_b32 s92, s2, 7
    s_lshl_b32 s92, s92, 2
    s_bfe_u32 s93, s2, 0x20003
    s_add_u32 s92, s92, s93
    s_lshr_b32 s93, s2, 5
    s_lshl_b32 s93, s93, 2
    s_or_b32 s93, s93, 0x40000
    s_lshr_b32 s90, s92, 1
    s_lshl_b32 s90, s90, 7
    s_add_u32 s90, s90, 117440512
    s_bfe_u32 s91, 873473623, s93
    s_lshr_b32 s91, s91, 1
    v_mov_b32 v0, s91
    s_bfe_u32 s91, 4225681832, s93
    s_lshr_b32 s91, s91, 1
    v_writelane_b32 v0, s91, 8
    v_lshlrev_b32 v0, 3, v0
    buffer_load_dwordx2 v[4:5], v0, s[8:11], s90 offen sc1
    s_waitcnt vmcnt(0)
    s_branch m_spin50
m_ok51:
    s_and_b32 s92, s2, 7
    s_lshl_b32 s92, s92, 2
    s_bfe_u32 s93, s2, 0x20003
    s_add_u32 s92, s92, s93
    s_lshr_b32 s93, s2, 5
    s_lshl_b32 s93, s93, 2
    s_or_b32 s93, s93, 0x40000
    s_bfe_u32 s90, 4225681832, s93
    s_lshl_b32 s90, s90, 3
    s_lshl_b32 s91, s16, 1
    s_add_u32 s90, s90, s91
    s_lshl_b32 s90, s90, 12
    s_lshl_b32 s91, s92, 19
    s_add_u32 s90, s90, s91
    s_add_u32 s90, s90, 0
    buffer_load_dwordx4 a[128:131], v2, s[8:11], s90 offen offset:0 sc1
    buffer_load_dwordx4 a[132:135], v2, s[8:11], s90 offen offset:1024 sc1
    buffer_load_dwordx4 a[136:139], v2, s[8:11], s90 offen offset:2048 sc1
    buffer_load_dwordx4 a[140:143], v2, s[8:11], s90 offen offset:3072 sc1
    s_bfe_u32 s90, 4225681832, s93
    s_lshl_b32 s90, s90, 3
    s_lshl_b32 s91, s16, 1
    s_add_u32 s90, s90, s91
    s_lshl_b32 s90, s90, 12
    s_lshl_b32 s91, s92, 19
    s_add_u32 s90, s90, s91
    s_add_u32 s90, s90, 4096
    buffer_load_dwordx4 a[144:147], v2, s[8:11], s90 offen offset:0 sc1
    buffer_load_dwordx4 a[148:151], v2, s[8:11], s90 offen offset:1024 sc1
    buffer_load_dwordx4 a[152:155], v2, s[8:11], s90 offen offset:2048 sc1
    buffer_load_dwordx4 a[156:159], v2, s[8:11], s90 offen offset:3072 sc1
    s_bfe_u32 s90, 873473623, s93
    s_lshl_b32 s90, s90, 3
    s_lshl_b32 s91, s16, 1
    s_add_u32 s90, s90, s91
    s_lshl_b32 s90, s90, 12
    s_lshl_b32 s91, s92, 19
    s_add_u32 s90, s90, s91
    s_add_u32 s90, s90, 0
    buffer_load_dwordx4 a[160:163], v2, s[8:11], s90 offen offset:0 sc1
    buffer_load_dwordx4 a[164:167], v2, s[8:11], s90 offen offset:1024 sc1
    buffer_load_dwordx4 a[168:171], v2, s[8:11], s90 offen offset:2048 sc1
    buffer_load_dwordx4 a[172:175], v2, s[8:11], s90 offen offset:3072 sc1
    s_bfe_u32 s90, 873473623, s93
    s_lshl_b32 s90, s90, 3
    s_lshl_b32 s91, s16, 1
    s_add_u32 s90, s90, s91
    s_lshl_b32 s90, s90, 12
    s_lshl_b32 s91, s92, 19
    s_add_u32 s90, s90, s91
    s_add_u32 s90, s90, 4096
    buffer_load_dwordx4 a[176:179], v2, s[8:11], s90 offen offset:0 sc1
    buffer_load_dwordx4 a[180:183], v2, s[8:11], s90 offen offset:1024 sc1
    buffer_load_dwordx4 a[184:187], v2, s[8:11], s90 offen offset:2048 sc1
    buffer_load_dwordx4 a[188:191], v2, s[8:11], s90 offen offset:3072 sc1
    s_lshl_b32 s90, s92, 19
    s_lshl_b32 s91, s58, 13
    s_add_u32 s90, s90, s91
    s_cmp_eq_u32 s57, 0
    s_mov_b32 s91, 33570816
    s_cselect_b32 s91, 16809984, s91
    s_mov_b32 s42, 268435456
    s_cselect_b32 s42, 268435456, s42
    s_add_u32 s48, s90, s91
    s_mov_b32 s49, s48
    s_add_u32 s50, s48, 4096
    s_mov_b32 s51, s50
    s_mov_b32 s40, s6
    s_mov_b32 s41, s7
    s_lshl_b32 s90, s92, 19
    s_lshl_b32 s91, s58, 13
    s_add_u32 s90, s90, s91
    s_cmp_eq_u32 s57, 0
    s_mov_b32 s91, 33603584
    s_cselect_b32 s91, 16842752, s91
    s_mov_b32 s46, 268435456
    s_cselect_b32 s46, 268435456, s46
    s_add_u32 s52, s90, s91
    s_mov_b32 s53, s52
    s_add_u32 s54, s52, 4096
    s_mov_b32 s55, s54
    s_mov_b32 s44, s6
    s_mov_b32 s45, s7
    s_branch m_loop16
m_x45:
    s_mov_b32 s42, 0
    s_cmp_eq_u32 s65, 3
    s_cbranch_scc1 m_loop16
    s_mov_b32 s46, 0
    s_branch m_loop16
m_dosw21:
    s_cmp_eq_u32 s94, 0
    s_cbranch_scc1 m_x52
    s_cmp_lg_u32 s65, 3
    s_cbranch_scc1 m_x58
    s_mov_b32 s42, s73
    s_lshl_b32 s90, s77, 4
    s_lshl_b32 s90, s90, s81
    s_mov_b32 s48, s79
    s_mul_i32 s91, s90, 1
    s_add_u32 s49, s91, s79
    s_sub_u32 s49, s49, 2048
    s_mul_i32 s91, s90, 2
    s_add_u32 s50, s91, s79
    s_mul_i32 s91, s90, 3
    s_add_u32 s51, s91, s79
    s_sub_u32 s51, s51, 2048
    s_lshl_b32 s90, s58, 7
    s_add_u32 s90, s90, s57
    s_lshl_b32 s91, s16, 6
    s_cmp_eq_u32 s81, 1
    s_cselect_b32 s90, s90, s91
    v_lshrrev_b32 v24, 3, v1
    v_lshlrev_b32 v24, s81, v24
    v_add_u32 v24, s90, v24
    v_mul_lo_u32 v24, v24, s77
    v_lshrrev_b32 v25, 4, v1
    v_and_b32 v26, 7, v1
    v_xor_b32 v25, v25, v26
    v_lshl_add_u32 v16, v25, 4, v24
    v_xor_b32 v25, 4, v25
    v_lshl_add_u32 v17, v25, 4, v24
    s_lshl_b32 s90, s77, 3
    s_lshl_b32 s90, s90, s81
    s_sub_u32 s90, s90, 1024
    v_add_u32 v17, s90, v17
    s_mov_b32 s40, s71
    s_mov_b32 s41, s72
    buffer_load_dwordx2 v[4:5], off, s[12:15], 0 sc1
    s_branch m_loop20
m_x58:
    s_mov_b32 s46, s76
    s_mov_b32 s52, s80
    s_lshl_b32 s90, s78, 2
    s_mul_i32 s91, s90, 1
    s_add_u32 s53, s91, s80
    s_sub_u32 s53, s53, 2048
    s_mul_i32 s91, s90, 2
    s_add_u32 s54, s91, s80
    s_mul_i32 s91, s90, 3
    s_add_u32 s55, s91, s80
    s_sub_u32 s55, s55, 2048
    s_lshl_b32 s56, s78, 6
    v_lshrrev_b32 v24, 5, v1
    s_lshl_b32 s90, s16, 4
    v_add_u32 v25, s90, v24
    v_mul_lo_u32 v25, v25, s78
    v_lshlrev_b32 v24, 1, v24
    v_and_b32 v26, 31, v1
    v_xor_b32 v24, v24, v26
    s_lshl_b32 s90, s78, 1
    s_sub_u32 s90, s90, 1024
    v_add_u32 v27, s90, v25
    v_xor_b32 v26, 0, v24
    v_lshl_add_u32 v18, v26, 4, v25
    v_xor_b32 v26, 4, v24
    v_lshl_add_u32 v19, v26, 4, v27
    v_xor_b32 v26, 8, v24
    v_lshl_add_u32 v20, v26, 4, v25
    v_xor_b32 v26, 12, v24
    v_lshl_add_u32 v21, v26, 4, v27
    s_mov_b32 s44, s74
    s_mov_b32 s45, s75
    s_mov_b32 s67, 0
    s_branch m_loop20
m_x52:
    s_cmp_eq_u32 s70, 1
    s_cbranch_scc1 m_x57
    s_cmp_le_u32 s65, 4
    s_cbranch_scc1 m_x53
    s_cmp_lg_u32 s16, 0
    s_cbranch_scc1 m_np59
    v_mov_b32 v4, s4
    v_mov_b32 v5, s5
    s_add_u32 s90, s17, 117440512
    s_mov_b64 exec, 1
    buffer_store_dwordx2 v[4:5], off, s[8:11], s90 sc1
    s_mov_b64 exec, -1
m_np59:
    s_mov_b32 s17, -1
    s_mov_b32 s67, 4
    s_branch m_loop20
m_x53:
    s_cmp_lg_u32 s65, 4
    s_cbranch_scc1 m_x54
    s_and_b32 s92, s2, 7
    s_lshl_b32 s92, s92, 2
    s_bfe_u32 s93, s2, 0x20003
    s_add_u32 s92, s92, s93
    s_lshr_b32 s93, s2, 5
    s_lshl_b32 s93, s93, 2
    s_or_b32 s93, s93, 0x40000
    s_lshr_b32 s90, s92, 1
    s_lshl_b32 s90, s90, 7
    s_add_u32 s90, s90, 117440512
    v_and_b32 v0, 3, v1
    v_min_u32 v0, 2, v0
    v_and_b32 v4, 4, v1
    v_add3_u32 v0, v0, v4, 8
    v_lshlrev_b32 v0, 3, v0
    buffer_load_dwordx2 v[4:5], v0, s[8:11], s90 offen sc1
    s_branch m_loop20
m_x54:
    s_waitcnt vmcnt(16)
    s_cmp_lg_u32 s65, 3
    s_cbranch_scc1 m_x55
    s_mov_b32 s3, 1048576
m_spin60:
    v_cmp_ne_u64 s[22:23], s[4:5], v[4:5]
    s_nop 3
    s_cmp_eq_u64 s[22:23], 0
    s_cbranch_scc1 m_ok61
    s_sub_u32 s3, s3, 1
    s_cbranch_scc1 m_ok61
    s_sleep 16
    s_and_b32 s92, s2, 7
    s_lshl_b32 s92, s92, 2
    s_bfe_u32 s93, s2, 0x20003
    s_add_u32 s92, s92, s93
    s_lshr_b32 s93, s2, 5
    s_lshl_b32 s93, s93, 2
    s_or_b32 s93, s93, 0x40000
    s_lshr_b32 s90, s92, 1
    s_lshl_b32 s90, s90, 7
    s_add_u32 s90, s90, 117440512
    v_and_b32 v0, 3, v1
    v_min_u32 v0, 2, v0
    v_and_b32 v4, 4, v1
    v_add3_u32 v0, v0, v4, 8
    v_lshlrev_b32 v0, 3, v0
    buffer_load_dwordx2 v[4:5], v0, s[8:11], s90 offen sc1
    s_waitcnt vmcnt(0)
    s_branch m_spin60
m_ok61:
    s_and_b32 s92, s2, 7
    s_lshl_b32 s92, s92, 2
    s_bfe_u32 s93, s2, 0x20003
    s_add_u32 s92, s92, s93
    s_lshr_b32 s93, s2, 5
    s_lshl_b32 s93, s93, 2
    s_or_b32 s93, s93, 0x40000
    s_lshl_b32 s90, s92, 19
    s_lshl_b32 s91, s58, 13
    s_add_u32 s90, s90, s91
    s_cmp_eq_u32 s57, 0
    s_mov_b32 s91, 33554432
    s_cselect_b32 s91, 16777216, s91
    s_mov_b32 s42, 0
    s_cselect_b32 s42, 268435456, s42
    s_add_u32 s48, s90, s91
    s_mov_b32 s49, s48
    s_add_u32 s50, s48, 4096
    s_mov_b32 s51, s50
    s_mov_b32 s40, s6
    s_mov_b32 s41, s7
    v_mov_b32 v16, v2
    v_mov_b32 v17, v2
    s_branch m_loop20
m_x55:
    s_cmp_lg_u32 s65, 2
    s_cbranch_scc1 m_x56
    s_and_b32 s92, s2, 7
    s_lshl_b32 s92, s92, 2
    s_bfe_u32 s93, s2, 0x20003
    s_add_u32 s92, s92, s93
    s_lshr_b32 s93, s2, 5
    s_lshl_b32 s93, s93, 2
    s_or_b32 s93, s93, 0x40000
    s_lshr_b32 s90, s92, 1
    s_lshl_b32 s90, s90, 7
    s_add_u32 s90, s90, 117440512
    s_bfe_u32 s91, 873473623, s93
    s_lshr_b32 s91, s91, 1
    v_mov_b32 v0, s91
    s_bfe_u32 s91, 4225681832, s93
    s_lshr_b32 s91, s91, 1
    v_writelane_b32 v0, s91, 8
    v_lshlrev_b32 v0, 3, v0
    buffer_load_dwordx2 v[4:5], v0, s[8:11], s90 offen sc1
    s_lshl_b32 s90, s92, 19
    s_lshl_b32 s91, s58, 13
    s_add_u32 s90, s90, s91
    s_cmp_eq_u32 s57, 0
    s_mov_b32 s91, 33554432
    s_cselect_b32 s91, 16793600, s91
    s_mov_b32 s42, 268435456
    s_cselect_b32 s42, 268435456, s42
    s_add_u32 s48, s90, s91
    s_mov_b32 s49, s48
    s_add_u32 s50, s48, 4096
    s_mov_b32 s51, s50
    s_mov_b32 s40, s6
    s_mov_b32 s41, s7
    s_lshl_b32 s90, s92, 19
    s_lshl_b32 s91, s58, 13
    s_add_u32 s90, s90, s91
    s_cmp_eq_u32 s57, 0
    s_mov_b32 s91, 33587200
    s_cselect_b32 s91, 16826368, s91
    s_mov_b32 s46, 268435456
    s_cselect_b32 s46, 268435456, s46
    s_add_u32 s52, s90, s91
    s_mov_b32 s53, s52
    s_add_u32 s54, s52, 4096
    s_mov_b32 s55, s54
    s_mov_b32 s44, s6
    s_mov_b32 s45, s7
    v_mov_b32 v18, v2
    v_mov_b32 v19, v2
    v_mov_b32 v20, v2
    v_mov_b32 v21, v2
    s_branch m_loop20
m_x56:
    s_mov_b32 s3, 1048576
m_spin62:
    v_cmp_ne_u64 s[22:23], s[4:5], v[4:5]
    s_nop 3
    s_cmp_eq_u64 s[22:23], 0
    s_cbranch_scc1 m_ok63
    s_sub_u32 s3, s3, 1
    s_cbranch_scc1 m_ok63
    s_sleep 16
    s_and_b32 s92, s2, 7
    s_lshl_b32 s92, s92, 2
    s_bfe_u32 s93, s2, 0x20003
    s_add_u32 s92, s92, s93
    s_lshr_b32 s93, s2, 5
    s_lshl_b32 s93, s93, 2
    s_or_b32 s93, s93, 0x40000
    s_lshr_b32 s90, s92, 1
    s_lshl_b32 s90, s90, 7
    s_add_u32 s90, s90, 117440512
    s_bfe_u32 s91, 873473623, s93
    s_lshr_b32 s91, s91, 1
    v_mov_b32 v0, s91
    s_bfe_u32 s91, 4225681832, s93
    s_lshr_b32 s91, s91, 1
    v_writelane_b32 v0, s91, 8
    v_lshlrev_b32 v0, 3, v0
    buffer_load_dwordx2 v[4:5], v0, s[8:11], s90 offen sc1
    s_waitcnt vmcnt(0)
    s_branch m_spin62
m_ok63:
    s_and_b32 s92, s2, 7
    s_lshl_b32 s92, s92, 2
    s_bfe_u32 s93, s2, 0x20003
    s_add_u32 s92, s92, s93
    s_lshr_b32 s93, s2, 5
    s_lshl_b32 s93, s93, 2
    s_or_b32 s93, s93, 0x40000
    s_bfe_u32 s90, 4225681832, s93
    s_lshl_b32 s90, s90, 3
    s_lshl_b32 s91, s16, 1
    s_add_u32 s90, s90, s91
    s_lshl_b32 s90, s90, 12
    s_lshl_b32 s91, s92, 19
    s_add_u32 s90, s90, s91
    s_add_u32 s90, s90, 0
    buffer_load_dwordx4 a[128:131], v2, s[8:11], s90 offen offset:0 sc1
    buffer_load_dwordx4 a[132:135], v2, s[8:11], s90 offen offset:1024 sc1
    buffer_load_dwordx4 a[136:139], v2, s[8:11], s90 offen offset:2048 sc1
    buffer_load_dwordx4 a[140:143], v2, s[8:11], s90 offen offset:3072 sc1
    s_bfe_u32 s90, 4225681832, s93
    s_lshl_b32 s90, s90, 3
    s_lshl_b32 s91, s16, 1
    s_add_u32 s90, s90, s91
    s_lshl_b32 s90, s90, 12
    s_lshl_b32 s91, s92, 19
    s_add_u32 s90, s90, s91
    s_add_u32 s90, s90, 4096
    buffer_load_dwordx4 a[144:147], v2, s[8:11], s90 offen offset:0 sc1
    buffer_load_dwordx4 a[148:151], v2, s[8:11], s90 offen offset:1024 sc1
    buffer_load_dwordx4 a[152:155], v2, s[8:11], s90 offen offset:2048 sc1
    buffer_load_dwordx4 a[156:159], v2, s[8:11], s90 offen offset:3072 sc1
    s_bfe_u32 s90, 873473623, s93
    s_lshl_b32 s90, s90, 3
    s_lshl_b32 s91, s16, 1
    s_add_u32 s90, s90, s91
    s_lshl_b32 s90, s90, 12
    s_lshl_b32 s91, s92, 19
    s_add_u32 s90, s90, s91
    s_add_u32 s90, s90, 0
    buffer_load_dwordx4 a[160:163], v2, s[8:11], s90 offen offset:0 sc1
    buffer_load_dwordx4 a[164:167], v2, s[8:11], s90 offen offset:1024 sc1
    buffer_load_dwordx4 a[168:171], v2, s[8:11], s90 offen offset:2048 sc1
    buffer_load_dwordx4 a[172:175], v2, s[8:11], s90 offen offset:3072 sc1
    s_bfe_u32 s90, 873473623, s93
    s_lshl_b32 s90, s90, 3
    s_lshl_b32 s91, s16, 1
    s_add_u32 s90, s90, s91
    s_lshl_b32 s90, s90, 12
    s_lshl_b32 s91, s92, 19
    s_add_u32 s90, s90, s91
    s_add_u32 s90, s90, 4096
    buffer_load_dwordx4 a[176:179], v2, s[8:11], s90 offen offset:0 sc1
    buffer_load_dwordx4 a[180:183], v2, s[8:11], s90 offen offset:1024 sc1
    buffer_load_dwordx4 a[184:187], v2, s[8:11], s90 offen offset:2048 sc1
    buffer_load_dwordx4 a[188:191], v2, s[8:11], s90 offen offset:3072 sc1
    s_lshl_b32 s90, s92, 19
    s_lshl_b32 s91, s58, 13
    s_add_u32 s90, s90, s91
    s_cmp_eq_u32 s57, 0
    s_mov_b32 s91, 33570816
    s_cselect_b32 s91, 16809984, s91
    s_mov_b32 s42, 268435456
    s_cselect_b32 s42, 268435456, s42
    s_add_u32 s48, s90, s91
    s_mov_b32 s49, s48
    s_add_u32 s50, s48, 4096
    s_mov_b32 s51, s50
    s_mov_b32 s40, s6
    s_mov_b32 s41, s7
    s_lshl_b32 s90, s92, 19
    s_lshl_b32 s91, s58, 13
    s_add_u32 s90, s90, s91
    s_cmp_eq_u32 s57, 0
    s_mov_b32 s91, 33603584
    s_cselect_b32 s91, 16842752, s91
    s_mov_b32 s46, 268435456
    s_cselect_b32 s46, 268435456, s46
    s_add_u32 s52, s90, s91
    s_mov_b32 s53, s52
    s_add_u32 s54, s52, 4096
    s_mov_b32 s55, s54
    s_mov_b32 s44, s6
    s_mov_b32 s45, s7
    s_branch m_loop20
m_x57:
    s_mov_b32 s42, 0
    s_cmp_eq_u32 s65, 3
    s_cbranch_scc1 m_loop20
    s_mov_b32 s46, 0
    s_branch m_loop20
m_eps23:
    s_mov_b32 s92, s97
    s_mov_b32 s93, s97
    s_cmp_eq_u32 s97, 0
    s_cbranch_scc1 m_ns364
    s_mov_b32 s90, s98
    v_pk_mul_f32 v[32:33], v[32:33], s[92:93]
    v_pk_mul_f32 v[34:35], v[34:35], s[92:93]
    v_pk_mul_f32 v[36:37], v[36:37], s[92:93]
    v_pk_mul_f32 v[38:39], v[38:39], s[92:93]
    v_cvt_pk_bf16_f32 v32, v32, v33
    v_cvt_pk_bf16_f32 v33, v34, v35
    v_cvt_pk_bf16_f32 v34, v36, v37
    v_cvt_pk_bf16_f32 v35, v38, v39
    buffer_store_dwordx4 v[32:35], v2, s[8:11], s90 offen sc1
    s_add_u32 s90, s90, s100
    v_pk_mul_f32 v[40:41], v[40:41], s[92:93]
    v_pk_mul_f32 v[42:43], v[42:43], s[92:93]
    v_pk_mul_f32 v[44:45], v[44:45], s[92:93]
    v_pk_mul_f32 v[46:47], v[46:47], s[92:93]
    v_cvt_pk_bf16_f32 v40, v40, v41
    v_cvt_pk_bf16_f32 v41, v42, v43
    v_cvt_pk_bf16_f32 v42, v44, v45
    v_cvt_pk_bf16_f32 v43, v46, v47
    buffer_store_dwordx4 v[40:43], v2, s[8:11], s90 offen sc1
    s_add_u32 s90, s90, s100
    v_pk_mul_f32 v[48:49], v[48:49], s[92:93]
    v_pk_mul_f32 v[50:51], v[50:51], s[92:93]
    v_pk_mul_f32 v[52:53], v[52:53], s[92:93]
    v_pk_mul_f32 v[54:55], v[54:55], s[92:93]
    v_cvt_pk_bf16_f32 v48, v48, v49
    v_cvt_pk_bf16_f32 v49, v50, v51
    v_cvt_pk_bf16_f32 v50, v52, v53
    v_cvt_pk_bf16_f32 v51, v54, v55
    buffer_store_dwordx4 v[48:51], v2, s[8:11], s90 offen sc1
    s_add_u32 s90, s90, s100
    v_pk_mul_f32 v[56:57], v[56:57], s[92:93]
    v_pk_mul_f32 v[58:59], v[58:59], s[92:93]
    v_pk_mul_f32 v[60:61], v[60:61], s[92:93]
    v_pk_mul_f32 v[62:63], v[62:63], s[92:93]
    v_cvt_pk_bf16_f32 v56, v56, v57
    v_cvt_pk_bf16_f32 v57, v58, v59
    v_cvt_pk_bf16_f32 v58, v60, v61
    v_cvt_pk_bf16_f32 v59, v62, v63
    buffer_store_dwordx4 v[56:59], v2, s[8:11], s90 offen sc1
    s_add_u32 s90, s90, s100
    v_pk_mul_f32 v[64:65], v[64:65], s[92:93]
    v_pk_mul_f32 v[66:67], v[66:67], s[92:93]
    v_pk_mul_f32 v[68:69], v[68:69], s[92:93]
    v_pk_mul_f32 v[70:71], v[70:71], s[92:93]
    v_cvt_pk_bf16_f32 v64, v64, v65
    v_cvt_pk_bf16_f32 v65, v66, v67
    v_cvt_pk_bf16_f32 v66, v68, v69
    v_cvt_pk_bf16_f32 v67, v70, v71
    buffer_store_dwordx4 v[64:67], v2, s[8:11], s90 offen sc1
    s_add_u32 s90, s90, s100
    v_pk_mul_f32 v[72:73], v[72:73], s[92:93]
    v_pk_mul_f32 v[74:75], v[74:75], s[92:93]
    v_pk_mul_f32 v[76:77], v[76:77], s[92:93]
    v_pk_mul_f32 v[78:79], v[78:79], s[92:93]
    v_cvt_pk_bf16_f32 v72, v72, v73
    v_cvt_pk_bf16_f32 v73, v74, v75
    v_cvt_pk_bf16_f32 v74, v76, v77
    v_cvt_pk_bf16_f32 v75, v78, v79
    buffer_store_dwordx4 v[72:75], v2, s[8:11], s90 offen sc1
    s_add_u32 s90, s90, s100
    v_pk_mul_f32 v[80:81], v[80:81], s[92:93]
    v_pk_mul_f32 v[82:83], v[82:83], s[92:93]
    v_pk_mul_f32 v[84:85], v[84:85], s[92:93]
    v_pk_mul_f32 v[86:87], v[86:87], s[92:93]
    v_cvt_pk_bf16_f32 v80, v80, v81
    v_cvt_pk_bf16_f32 v81, v82, v83
    v_cvt_pk_bf16_f32 v82, v84, v85
    v_cvt_pk_bf16_f32 v83, v86, v87
    buffer_store_dwordx4 v[80:83], v2, s[8:11], s90 offen sc1
    s_add_u32 s90, s90, s100
    v_pk_mul_f32 v[88:89], v[88:89], s[92:93]
    v_pk_mul_f32 v[90:91], v[90:91], s[92:93]
    v_pk_mul_f32 v[92:93], v[92:93], s[92:93]
    v_pk_mul_f32 v[94:95], v[94:95], s[92:93]
    v_cvt_pk_bf16_f32 v88, v88, v89
    v_cvt_pk_bf16_f32 v89, v90, v91
    v_cvt_pk_bf16_f32 v90, v92, v93
    v_cvt_pk_bf16_f32 v91, v94, v95
    buffer_store_dwordx4 v[88:91], v2, s[8:11], s90 offen sc1
    s_add_u32 s90, s90, s100
    v_pk_mul_f32 v[96:97], v[96:97], s[92:93]
    v_pk_mul_f32 v[98:99], v[98:99], s[92:93]
    v_pk_mul_f32 v[100:101], v[100:101], s[92:93]
    v_pk_mul_f32 v[102:103], v[102:103], s[92:93]
    v_cvt_pk_bf16_f32 v96, v96, v97
    v_cvt_pk_bf16_f32 v97, v98, v99
    v_cvt_pk_bf16_f32 v98, v100, v101
    v_cvt_pk_bf16_f32 v99, v102, v103
    v_accvgpr_write_b32 a128, v96
    v_accvgpr_write_b32 a129, v97
    v_accvgpr_write_b32 a130, v98
    v_accvgpr_write_b32 a131, v99
    v_pk_mul_f32 v[104:105], v[104:105], s[92:93]
    v_pk_mul_f32 v[106:107], v[106:107], s[92:93]
    v_pk_mul_f32 v[108:109], v[108:109], s[92:93]
    v_pk_mul_f32 v[110:111], v[110:111], s[92:93]
    v_cvt_pk_bf16_f32 v104, v104, v105
    v_cvt_pk_bf16_f32 v105, v106, v107
    v_cvt_pk_bf16_f32 v106, v108, v109
    v_cvt_pk_bf16_f32 v107, v110, v111
    v_accvgpr_write_b32 a132, v104
    v_accvgpr_write_b32 a133, v105
    v_accvgpr_write_b32 a134, v106
    v_accvgpr_write_b32 a135, v107
    v_pk_mul_f32 v[112:113], v[112:113], s[92:93]
    v_pk_mul_f32 v[114:115], v[114:115], s[92:93]
    v_pk_mul_f32 v[116:117], v[116:117], s[92:93]
    v_pk_mul_f32 v[118:119], v[118:119], s[92:93]
    v_cvt_pk_bf16_f32 v112, v112, v113
    v_cvt_pk_bf16_f32 v113, v114, v115
    v_cvt_pk_bf16_f32 v114, v116, v117
    v_cvt_pk_bf16_f32 v115, v118, v119
    v_accvgpr_write_b32 a136, v112
    v_accvgpr_write_b32 a137, v113
    v_accvgpr_write_b32 a138, v114
    v_accvgpr_write_b32 a139, v115
    v_pk_mul_f32 v[120:121], v[120:121], s[92:93]
    v_pk_mul_f32 v[122:123], v[122:123], s[92:93]
    v_pk_mul_f32 v[124:125], v[124:125], s[92:93]
    v_pk_mul_f32 v[126:127], v[126:127], s[92:93]
    v_cvt_pk_bf16_f32 v120, v120, v121
    v_cvt_pk_bf16_f32 v121, v122, v123
    v_cvt_pk_bf16_f32 v122, v124, v125
    v_cvt_pk_bf16_f32 v123, v126, v127
    v_accvgpr_write_b32 a140, v120
    v_accvgpr_write_b32 a141, v121
    v_accvgpr_write_b32 a142, v122
    v_accvgpr_write_b32 a143, v123
    v_pk_mul_f32 v[128:129], v[128:129], s[92:93]
    v_pk_mul_f32 v[130:131], v[130:131], s[92:93]
    v_pk_mul_f32 v[132:133], v[132:133], s[92:93]
    v_pk_mul_f32 v[134:135], v[134:135], s[92:93]
    v_cvt_pk_bf16_f32 v128, v128, v129
    v_cvt_pk_bf16_f32 v129, v130, v131
    v_cvt_pk_bf16_f32 v130, v132, v133
    v_cvt_pk_bf16_f32 v131, v134, v135
    v_accvgpr_write_b32 a144, v128
    v_accvgpr_write_b32 a145, v129
    v_accvgpr_write_b32 a146, v130
    v_accvgpr_write_b32 a147, v131
    v_pk_mul_f32 v[136:137], v[136:137], s[92:93]
    v_pk_mul_f32 v[138:139], v[138:139], s[92:93]
    v_pk_mul_f32 v[140:141], v[140:141], s[92:93]
    v_pk_mul_f32 v[142:143], v[142:143], s[92:93]
    v_cvt_pk_bf16_f32 v136, v136, v137
    v_cvt_pk_bf16_f32 v137, v138, v139
    v_cvt_pk_bf16_f32 v138, v140, v141
    v_cvt_pk_bf16_f32 v139, v142, v143
    v_accvgpr_write_b32 a148, v136
    v_accvgpr_write_b32 a149, v137
    v_accvgpr_write_b32 a150, v138
    v_accvgpr_write_b32 a151, v139
    v_pk_mul_f32 v[144:145], v[144:145], s[92:93]
    v_pk_mul_f32 v[146:147], v[146:147], s[92:93]
    v_pk_mul_f32 v[148:149], v[148:149], s[92:93]
    v_pk_mul_f32 v[150:151], v[150:151], s[92:93]
    v_cvt_pk_bf16_f32 v144, v144, v145
    v_cvt_pk_bf16_f32 v145, v146, v147
    v_cvt_pk_bf16_f32 v146, v148, v149
    v_cvt_pk_bf16_f32 v147, v150, v151
    v_accvgpr_write_b32 a152, v144
    v_accvgpr_write_b32 a153, v145
    v_accvgpr_write_b32 a154, v146
    v_accvgpr_write_b32 a155, v147
    v_pk_mul_f32 v[152:153], v[152:153], s[92:93]
    v_pk_mul_f32 v[154:155], v[154:155], s[92:93]
    v_pk_mul_f32 v[156:157], v[156:157], s[92:93]
    v_pk_mul_f32 v[158:159], v[158:159], s[92:93]
    v_cvt_pk_bf16_f32 v152, v152, v153
    v_cvt_pk_bf16_f32 v153, v154, v155
    v_cvt_pk_bf16_f32 v154, v156, v157
    v_cvt_pk_bf16_f32 v155, v158, v159
    v_accvgpr_write_b32 a156, v152
    v_accvgpr_write_b32 a157, v153
    v_accvgpr_write_b32 a158, v154
    v_accvgpr_write_b32 a159, v155
    v_pk_mul_f32 v[160:161], v[160:161], s[92:93]
    v_pk_mul_f32 v[162:163], v[162:163], s[92:93]
    v_pk_mul_f32 v[164:165], v[164:165], s[92:93]
    v_pk_mul_f32 v[166:167], v[166:167], s[92:93]
    v_cvt_pk_bf16_f32 v160, v160, v161
    v_cvt_pk_bf16_f32 v161, v162, v163
    v_cvt_pk_bf16_f32 v162, v164, v165
    v_cvt_pk_bf16_f32 v163, v166, v167
    v_accvgpr_write_b32 a160, v160
    v_accvgpr_write_b32 a161, v161
    v_accvgpr_write_b32 a162, v162
    v_accvgpr_write_b32 a163, v163
    v_pk_mul_f32 v[168:169], v[168:169], s[92:93]
    v_pk_mul_f32 v[170:171], v[170:171], s[92:93]
    v_pk_mul_f32 v[172:173], v[172:173], s[92:93]
    v_pk_mul_f32 v[174:175], v[174:175], s[92:93]
    v_cvt_pk_bf16_f32 v168, v168, v169
    v_cvt_pk_bf16_f32 v169, v170, v171
    v_cvt_pk_bf16_f32 v170, v172, v173
    v_cvt_pk_bf16_f32 v171, v174, v175
    v_accvgpr_write_b32 a164, v168
    v_accvgpr_write_b32 a165, v169
    v_accvgpr_write_b32 a166, v170
    v_accvgpr_write_b32 a167, v171
    v_pk_mul_f32 v[176:177], v[176:177], s[92:93]
    v_pk_mul_f32 v[178:179], v[178:179], s[92:93]
    v_pk_mul_f32 v[180:181], v[180:181], s[92:93]
    v_pk_mul_f32 v[182:183], v[182:183], s[92:93]
    v_cvt_pk_bf16_f32 v176, v176, v177
    v_cvt_pk_bf16_f32 v177, v178, v179
    v_cvt_pk_bf16_f32 v178, v180, v181
    v_cvt_pk_bf16_f32 v179, v182, v183
    v_accvgpr_write_b32 a168, v176
    v_accvgpr_write_b32 a169, v177
    v_accvgpr_write_b32 a170, v178
    v_accvgpr_write_b32 a171, v179
    v_pk_mul_f32 v[184:185], v[184:185], s[92:93]
    v_pk_mul_f32 v[186:187], v[186:187], s[92:93]
    v_pk_mul_f32 v[188:189], v[188:189], s[92:93]
    v_pk_mul_f32 v[190:191], v[190:191], s[92:93]
    v_cvt_pk_bf16_f32 v184, v184, v185
    v_cvt_pk_bf16_f32 v185, v186, v187
    v_cvt_pk_bf16_f32 v186, v188, v189
    v_cvt_pk_bf16_f32 v187, v190, v191
    v_accvgpr_write_b32 a172, v184
    v_accvgpr_write_b32 a173, v185
    v_accvgpr_write_b32 a174, v186
    v_accvgpr_write_b32 a175, v187
    v_pk_mul_f32 v[192:193], v[192:193], s[92:93]
    v_pk_mul_f32 v[194:195], v[194:195], s[92:93]
    v_pk_mul_f32 v[196:197], v[196:197], s[92:93]
    v_pk_mul_f32 v[198:199], v[198:199], s[92:93]
    v_cvt_pk_bf16_f32 v192, v192, v193
    v_cvt_pk_bf16_f32 v193, v194, v195
    v_cvt_pk_bf16_f32 v194, v196, v197
    v_cvt_pk_bf16_f32 v195, v198, v199
    v_accvgpr_write_b32 a176, v192
    v_accvgpr_write_b32 a177, v193
    v_accvgpr_write_b32 a178, v194
    v_accvgpr_write_b32 a179, v195
    v_pk_mul_f32 v[200:201], v[200:201], s[92:93]
    v_pk_mul_f32 v[202:203], v[202:203], s[92:93]
    v_pk_mul_f32 v[204:205], v[204:205], s[92:93]
    v_pk_mul_f32 v[206:207], v[206:207], s[92:93]
    v_cvt_pk_bf16_f32 v200, v200, v201
    v_cvt_pk_bf16_f32 v201, v202, v203
    v_cvt_pk_bf16_f32 v202, v204, v205
    v_cvt_pk_bf16_f32 v203, v206, v207
    v_accvgpr_write_b32 a180, v200
    v_accvgpr_write_b32 a181, v201
    v_accvgpr_write_b32 a182, v202
    v_accvgpr_write_b32 a183, v203
    v_pk_mul_f32 v[208:209], v[208:209], s[92:93]
    v_pk_mul_f32 v[210:211], v[210:211], s[92:93]
    v_pk_mul_f32 v[212:213], v[212:213], s[92:93]
    v_pk_mul_f32 v[214:215], v[214:215], s[92:93]
    v_cvt_pk_bf16_f32 v208, v208, v209
    v_cvt_pk_bf16_f32 v209, v210, v211
    v_cvt_pk_bf16_f32 v210, v212, v213
    v_cvt_pk_bf16_f32 v211, v214, v215
    v_accvgpr_write_b32 a184, v208
    v_accvgpr_write_b32 a185, v209
    v_accvgpr_write_b32 a186, v210
    v_accvgpr_write_b32 a187, v211
    v_pk_mul_f32 v[216:217], v[216:217], s[92:93]
    v_pk_mul_f32 v[218:219], v[218:219], s[92:93]
    v_pk_mul_f32 v[220:221], v[220:221], s[92:93]
    v_pk_mul_f32 v[222:223], v[222:223], s[92:93]
    v_cvt_pk_bf16_f32 v216, v216, v217
    v_cvt_pk_bf16_f32 v217, v218, v219
    v_cvt_pk_bf16_f32 v218, v220, v221
    v_cvt_pk_bf16_f32 v219, v222, v223
    v_accvgpr_write_b32 a188, v216
    v_accvgpr_write_b32 a189, v217
    v_accvgpr_write_b32 a190, v218
    v_accvgpr_write_b32 a191, v219
    v_pk_mul_f32 v[224:225], v[224:225], s[92:93]
    v_pk_mul_f32 v[226:227], v[226:227], s[92:93]
    v_pk_mul_f32 v[228:229], v[228:229], s[92:93]
    v_pk_mul_f32 v[230:231], v[230:231], s[92:93]
    v_cvt_pk_bf16_f32 v224, v224, v225
    v_cvt_pk_bf16_f32 v225, v226, v227
    v_cvt_pk_bf16_f32 v226, v228, v229
    v_cvt_pk_bf16_f32 v227, v230, v231
    v_accvgpr_write_b32 a192, v224
    v_accvgpr_write_b32 a193, v225
    v_accvgpr_write_b32 a194, v226
    v_accvgpr_write_b32 a195, v227
    v_pk_mul_f32 v[232:233], v[232:233], s[92:93]
    v_pk_mul_f32 v[234:235], v[234:235], s[92:93]
    v_pk_mul_f32 v[236:237], v[236:237], s[92:93]
    v_pk_mul_f32 v[238:239], v[238:239], s[92:93]
    v_cvt_pk_bf16_f32 v232, v232, v233
    v_cvt_pk_bf16_f32 v233, v234, v235
    v_cvt_pk_bf16_f32 v234, v236, v237
    v_cvt_pk_bf16_f32 v235, v238, v239
    v_accvgpr_write_b32 a196, v232
    v_accvgpr_write_b32 a197, v233
    v_accvgpr_write_b32 a198, v234
    v_accvgpr_write_b32 a199, v235
    v_pk_mul_f32 v[240:241], v[240:241], s[92:93]
    v_pk_mul_f32 v[242:243], v[242:243], s[92:93]
    v_pk_mul_f32 v[244:245], v[244:245], s[92:93]
    v_pk_mul_f32 v[246:247], v[246:247], s[92:93]
    v_cvt_pk_bf16_f32 v240, v240, v241
    v_cvt_pk_bf16_f32 v241, v242, v243
    v_cvt_pk_bf16_f32 v242, v244, v245
    v_cvt_pk_bf16_f32 v243, v246, v247
    v_accvgpr_write_b32 a200, v240
    v_accvgpr_write_b32 a201, v241
    v_accvgpr_write_b32 a202, v242
    v_accvgpr_write_b32 a203, v243
    v_pk_mul_f32 v[248:249], v[248:249], s[92:93]
    v_pk_mul_f32 v[250:251], v[250:251], s[92:93]
    v_pk_mul_f32 v[252:253], v[252:253], s[92:93]
    v_pk_mul_f32 v[254:255], v[254:255], s[92:93]
    v_cvt_pk_bf16_f32 v248, v248, v249
    v_cvt_pk_bf16_f32 v249, v250, v251
    v_cvt_pk_bf16_f32 v250, v252, v253
    v_cvt_pk_bf16_f32 v251, v254, v255
    v_accvgpr_write_b32 a204, v248
    v_accvgpr_write_b32 a205, v249
    v_accvgpr_write_b32 a206, v250
    v_accvgpr_write_b32 a207, v251
    v_accvgpr_read_b32 v24, a224
    v_accvgpr_read_b32 v25, a225
    v_accvgpr_read_b32 v26, a226
    v_accvgpr_read_b32 v27, a227
    v_accvgpr_read_b32 v28, a228
    v_accvgpr_read_b32 v29, a229
    v_accvgpr_read_b32 v30, a230
    v_accvgpr_read_b32 v31, a231
    v_pk_mul_f32 v[24:25], v[24:25], s[92:93]
    v_pk_mul_f32 v[26:27], v[26:27], s[92:93]
    v_pk_mul_f32 v[28:29], v[28:29], s[92:93]
    v_pk_mul_f32 v[30:31], v[30:31], s[92:93]
    v_cvt_pk_bf16_f32 v24, v24, v25
    v_cvt_pk_bf16_f32 v25, v26, v27
    v_cvt_pk_bf16_f32 v26, v28, v29
    v_cvt_pk_bf16_f32 v27, v30, v31
    v_accvgpr_write_b32 a208, v24
    v_accvgpr_write_b32 a209, v25
    v_accvgpr_write_b32 a210, v26
    v_accvgpr_write_b32 a211, v27
    v_accvgpr_read_b32 v24, a232
    v_accvgpr_read_b32 v25, a233
    v_accvgpr_read_b32 v26, a234
    v_accvgpr_read_b32 v27, a235
    v_accvgpr_read_b32 v28, a236
    v_accvgpr_read_b32 v29, a237
    v_accvgpr_read_b32 v30, a238
    v_accvgpr_read_b32 v31, a239
    v_pk_mul_f32 v[24:25], v[24:25], s[92:93]
    v_pk_mul_f32 v[26:27], v[26:27], s[92:93]
    v_pk_mul_f32 v[28:29], v[28:29], s[92:93]
    v_pk_mul_f32 v[30:31], v[30:31], s[92:93]
    v_cvt_pk_bf16_f32 v24, v24, v25
    v_cvt_pk_bf16_f32 v25, v26, v27
    v_cvt_pk_bf16_f32 v26, v28, v29
    v_cvt_pk_bf16_f32 v27, v30, v31
    v_accvgpr_write_b32 a212, v24
    v_accvgpr_write_b32 a213, v25
    v_accvgpr_write_b32 a214, v26
    v_accvgpr_write_b32 a215, v27
    v_accvgpr_read_b32 v24, a240
    v_accvgpr_read_b32 v25, a241
    v_accvgpr_read_b32 v26, a242
    v_accvgpr_read_b32 v27, a243
    v_accvgpr_read_b32 v28, a244
    v_accvgpr_read_b32 v29, a245
    v_accvgpr_read_b32 v30, a246
    v_accvgpr_read_b32 v31, a247
    v_pk_mul_f32 v[24:25], v[24:25], s[92:93]
    v_pk_mul_f32 v[26:27], v[26:27], s[92:93]
    v_pk_mul_f32 v[28:29], v[28:29], s[92:93]
    v_pk_mul_f32 v[30:31], v[30:31], s[92:93]
    v_cvt_pk_bf16_f32 v24, v24, v25
    v_cvt_pk_bf16_f32 v25, v26, v27
    v_cvt_pk_bf16_f32 v26, v28, v29
    v_cvt_pk_bf16_f32 v27, v30, v31
    v_accvgpr_write_b32 a216, v24
    v_accvgpr_write_b32 a217, v25
    v_accvgpr_write_b32 a218, v26
    v_accvgpr_write_b32 a219, v27
    v_accvgpr_read_b32 v24, a248
    v_accvgpr_read_b32 v25, a249
    v_accvgpr_read_b32 v26, a250
    v_accvgpr_read_b32 v27, a251
    v_accvgpr_read_b32 v28, a252
    v_accvgpr_read_b32 v29, a253
    v_accvgpr_read_b32 v30, a254
    v_accvgpr_read_b32 v31, a255
    v_pk_mul_f32 v[24:25], v[24:25], s[92:93]
    v_pk_mul_f32 v[26:27], v[26:27], s[92:93]
    v_pk_mul_f32 v[28:29], v[28:29], s[92:93]
    v_pk_mul_f32 v[30:31], v[30:31], s[92:93]
    v_cvt_pk_bf16_f32 v24, v24, v25
    v_cvt_pk_bf16_f32 v25, v26, v27
    v_cvt_pk_bf16_f32 v26, v28, v29
    v_cvt_pk_bf16_f32 v27, v30, v31
    v_accvgpr_write_b32 a220, v24
    v_accvgpr_write_b32 a221, v25
    v_accvgpr_write_b32 a222, v26
    v_accvgpr_write_b32 a223, v27
    s_setpc_b64 s[20:21]
m_ns364:
    s_mov_b32 s90, s98
    v_cvt_pk_bf16_f32 v32, v32, v33
    v_cvt_pk_bf16_f32 v33, v34, v35
    v_cvt_pk_bf16_f32 v34, v36, v37
    v_cvt_pk_bf16_f32 v35, v38, v39
    buffer_store_dwordx4 v[32:35], v2, s[8:11], s90 offen sc1
    s_add_u32 s90, s90, s100
    v_cvt_pk_bf16_f32 v40, v40, v41
    v_cvt_pk_bf16_f32 v41, v42, v43
    v_cvt_pk_bf16_f32 v42, v44, v45
    v_cvt_pk_bf16_f32 v43, v46, v47
    buffer_store_dwordx4 v[40:43], v2, s[8:11], s90 offen sc1
    s_add_u32 s90, s90, s100
    v_cvt_pk_bf16_f32 v48, v48, v49
    v_cvt_pk_bf16_f32 v49, v50, v51
    v_cvt_pk_bf16_f32 v50, v52, v53
    v_cvt_pk_bf16_f32 v51, v54, v55
    buffer_store_dwordx4 v[48:51], v2, s[8:11], s90 offen sc1
    s_add_u32 s90, s90, s100
    v_cvt_pk_bf16_f32 v56, v56, v57
    v_cvt_pk_bf16_f32 v57, v58, v59
    v_cvt_pk_bf16_f32 v58, v60, v61
    v_cvt_pk_bf16_f32 v59, v62, v63
    buffer_store_dwordx4 v[56:59], v2, s[8:11], s90 offen sc1
    s_add_u32 s90, s90, s100
    v_cvt_pk_bf16_f32 v64, v64, v65
    v_cvt_pk_bf16_f32 v65, v66, v67
    v_cvt_pk_bf16_f32 v66, v68, v69
    v_cvt_pk_bf16_f32 v67, v70, v71
    buffer_store_dwordx4 v[64:67], v2, s[8:11], s90 offen sc1
    s_add_u32 s90, s90, s100
    v_cvt_pk_bf16_f32 v72, v72, v73
    v_cvt_pk_bf16_f32 v73, v74, v75
    v_cvt_pk_bf16_f32 v74, v76, v77
    v_cvt_pk_bf16_f32 v75, v78, v79
    buffer_store_dwordx4 v[72:75], v2, s[8:11], s90 offen sc1
    s_add_u32 s90, s90, s100
    v_cvt_pk_bf16_f32 v80, v80, v81
    v_cvt_pk_bf16_f32 v81, v82, v83
    v_cvt_pk_bf16_f32 v82, v84, v85
    v_cvt_pk_bf16_f32 v83, v86, v87
    buffer_store_dwordx4 v[80:83], v2, s[8:11], s90 offen sc1
    s_add_u32 s90, s90, s100
    v_cvt_pk_bf16_f32 v88, v88, v89
    v_cvt_pk_bf16_f32 v89, v90, v91
    v_cvt_pk_bf16_f32 v90, v92, v93
    v_cvt_pk_bf16_f32 v91, v94, v95
    buffer_store_dwordx4 v[88:91], v2, s[8:11], s90 offen sc1
    s_add_u32 s90, s90, s100
    v_cvt_pk_bf16_f32 v96, v96, v97
    v_cvt_pk_bf16_f32 v97, v98, v99
    v_cvt_pk_bf16_f32 v98, v100, v101
    v_cvt_pk_bf16_f32 v99, v102, v103
    v_accvgpr_write_b32 a128, v96
    v_accvgpr_write_b32 a129, v97
    v_accvgpr_write_b32 a130, v98
    v_accvgpr_write_b32 a131, v99
    v_cvt_pk_bf16_f32 v104, v104, v105
    v_cvt_pk_bf16_f32 v105, v106, v107
    v_cvt_pk_bf16_f32 v106, v108, v109
    v_cvt_pk_bf16_f32 v107, v110, v111
    v_accvgpr_write_b32 a132, v104
    v_accvgpr_write_b32 a133, v105
    v_accvgpr_write_b32 a134, v106
    v_accvgpr_write_b32 a135, v107
    v_cvt_pk_bf16_f32 v112, v112, v113
    v_cvt_pk_bf16_f32 v113, v114, v115
    v_cvt_pk_bf16_f32 v114, v116, v117
    v_cvt_pk_bf16_f32 v115, v118, v119
    v_accvgpr_write_b32 a136, v112
    v_accvgpr_write_b32 a137, v113
    v_accvgpr_write_b32 a138, v114
    v_accvgpr_write_b32 a139, v115
    v_cvt_pk_bf16_f32 v120, v120, v121
    v_cvt_pk_bf16_f32 v121, v122, v123
    v_cvt_pk_bf16_f32 v122, v124, v125
    v_cvt_pk_bf16_f32 v123, v126, v127
    v_accvgpr_write_b32 a140, v120
    v_accvgpr_write_b32 a141, v121
    v_accvgpr_write_b32 a142, v122
    v_accvgpr_write_b32 a143, v123
    v_cvt_pk_bf16_f32 v128, v128, v129
    v_cvt_pk_bf16_f32 v129, v130, v131
    v_cvt_pk_bf16_f32 v130, v132, v133
    v_cvt_pk_bf16_f32 v131, v134, v135
    v_accvgpr_write_b32 a144, v128
    v_accvgpr_write_b32 a145, v129
    v_accvgpr_write_b32 a146, v130
    v_accvgpr_write_b32 a147, v131
    v_cvt_pk_bf16_f32 v136, v136, v137
    v_cvt_pk_bf16_f32 v137, v138, v139
    v_cvt_pk_bf16_f32 v138, v140, v141
    v_cvt_pk_bf16_f32 v139, v142, v143
    v_accvgpr_write_b32 a148, v136
    v_accvgpr_write_b32 a149, v137
    v_accvgpr_write_b32 a150, v138
    v_accvgpr_write_b32 a151, v139
    v_cvt_pk_bf16_f32 v144, v144, v145
    v_cvt_pk_bf16_f32 v145, v146, v147
    v_cvt_pk_bf16_f32 v146, v148, v149
    v_cvt_pk_bf16_f32 v147, v150, v151
    v_accvgpr_write_b32 a152, v144
    v_accvgpr_write_b32 a153, v145
    v_accvgpr_write_b32 a154, v146
    v_accvgpr_write_b32 a155, v147
    v_cvt_pk_bf16_f32 v152, v152, v153
    v_cvt_pk_bf16_f32 v153, v154, v155
    v_cvt_pk_bf16_f32 v154, v156, v157
    v_cvt_pk_bf16_f32 v155, v158, v159
    v_accvgpr_write_b32 a156, v152
    v_accvgpr_write_b32 a157, v153
    v_accvgpr_write_b32 a158, v154
    v_accvgpr_write_b32 a159, v155
    v_cvt_pk_bf16_f32 v160, v160, v161
    v_cvt_pk_bf16_f32 v161, v162, v163
    v_cvt_pk_bf16_f32 v162, v164, v165
    v_cvt_pk_bf16_f32 v163, v166, v167
    v_accvgpr_write_b32 a160, v160
    v_accvgpr_write_b32 a161, v161
    v_accvgpr_write_b32 a162, v162
    v_accvgpr_write_b32 a163, v163
    v_cvt_pk_bf16_f32 v168, v168, v169
    v_cvt_pk_bf16_f32 v169, v170, v171
    v_cvt_pk_bf16_f32 v170, v172, v173
    v_cvt_pk_bf16_f32 v171, v174, v175
    v_accvgpr_write_b32 a164, v168
    v_accvgpr_write_b32 a165, v169
    v_accvgpr_write_b32 a166, v170
    v_accvgpr_write_b32 a167, v171
    v_cvt_pk_bf16_f32 v176, v176, v177
    v_cvt_pk_bf16_f32 v177, v178, v179
    v_cvt_pk_bf16_f32 v178, v180, v181
    v_cvt_pk_bf16_f32 v179, v182, v183
    v_accvgpr_write_b32 a168, v176
    v_accvgpr_write_b32 a169, v177
    v_accvgpr_write_b32 a170, v178
    v_accvgpr_write_b32 a171, v179
    v_cvt_pk_bf16_f32 v184, v184, v185
    v_cvt_pk_bf16_f32 v185, v186, v187
    v_cvt_pk_bf16_f32 v186, v188, v189
    v_cvt_pk_bf16_f32 v187, v190, v191
    v_accvgpr_write_b32 a172, v184
    v_accvgpr_write_b32 a173, v185
    v_accvgpr_write_b32 a174, v186
    v_accvgpr_write_b32 a175, v187
    v_cvt_pk_bf16_f32 v192, v192, v193
    v_cvt_pk_bf16_f32 v193, v194, v195
    v_cvt_pk_bf16_f32 v194, v196, v197
    v_cvt_pk_bf16_f32 v195, v198, v199
    v_accvgpr_write_b32 a176, v192
    v_accvgpr_write_b32 a177, v193
    v_accvgpr_write_b32 a178, v194
    v_accvgpr_write_b32 a179, v195
    v_cvt_pk_bf16_f32 v200, v200, v201
    v_cvt_pk_bf16_f32 v201, v202, v203
    v_cvt_pk_bf16_f32 v202, v204, v205
    v_cvt_pk_bf16_f32 v203, v206, v207
    v_accvgpr_write_b32 a180, v200
    v_accvgpr_write_b32 a181, v201
    v_accvgpr_write_b32 a182, v202
    v_accvgpr_write_b32 a183, v203
    v_cvt_pk_bf16_f32 v208, v208, v209
    v_cvt_pk_bf16_f32 v209, v210, v211
    v_cvt_pk_bf16_f32 v210, v212, v213
    v_cvt_pk_bf16_f32 v211, v214, v215
    v_accvgpr_write_b32 a184, v208
    v_accvgpr_write_b32 a185, v209
    v_accvgpr_write_b32 a186, v210
    v_accvgpr_write_b32 a187, v211
    v_cvt_pk_bf16_f32 v216, v216, v217
    v_cvt_pk_bf16_f32 v217, v218, v219
    v_cvt_pk_bf16_f32 v218, v220, v221
    v_cvt_pk_bf16_f32 v219, v222, v223
    v_accvgpr_write_b32 a188, v216
    v_accvgpr_write_b32 a189, v217
    v_accvgpr_write_b32 a190, v218
    v_accvgpr_write_b32 a191, v219
    v_cvt_pk_bf16_f32 v224, v224, v225
    v_cvt_pk_bf16_f32 v225, v226, v227
    v_cvt_pk_bf16_f32 v226, v228, v229
    v_cvt_pk_bf16_f32 v227, v230, v231
    v_accvgpr_write_b32 a192, v224
    v_accvgpr_write_b32 a193, v225
    v_accvgpr_write_b32 a194, v226
    v_accvgpr_write_b32 a195, v227
    v_cvt_pk_bf16_f32 v232, v232, v233
    v_cvt_pk_bf16_f32 v233, v234, v235
    v_cvt_pk_bf16_f32 v234, v236, v237
    v_cvt_pk_bf16_f32 v235, v238, v239
    v_accvgpr_write_b32 a196, v232
    v_accvgpr_write_b32 a197, v233
    v_accvgpr_write_b32 a198, v234
    v_accvgpr_write_b32 a199, v235
    v_cvt_pk_bf16_f32 v240, v240, v241
    v_cvt_pk_bf16_f32 v241, v242, v243
    v_cvt_pk_bf16_f32 v242, v244, v245
    v_cvt_pk_bf16_f32 v243, v246, v247
    v_accvgpr_write_b32 a200, v240
    v_accvgpr_write_b32 a201, v241
    v_accvgpr_write_b32 a202, v242
    v_accvgpr_write_b32 a203, v243
    v_cvt_pk_bf16_f32 v248, v248, v249
    v_cvt_pk_bf16_f32 v249, v250, v251
    v_cvt_pk_bf16_f32 v250, v252, v253
    v_cvt_pk_bf16_f32 v251, v254, v255
    v_accvgpr_write_b32 a204, v248
    v_accvgpr_write_b32 a205, v249
    v_accvgpr_write_b32 a206, v250
    v_accvgpr_write_b32 a207, v251
    v_accvgpr_read_b32 v24, a224
    v_accvgpr_read_b32 v25, a225
    v_accvgpr_read_b32 v26, a226
    v_accvgpr_read_b32 v27, a227
    v_accvgpr_read_b32 v28, a228
    v_accvgpr_read_b32 v29, a229
    v_accvgpr_read_b32 v30, a230
    v_accvgpr_read_b32 v31, a231
    v_cvt_pk_bf16_f32 v24, v24, v25
    v_cvt_pk_bf16_f32 v25, v26, v27
    v_cvt_pk_bf16_f32 v26, v28, v29
    v_cvt_pk_bf16_f32 v27, v30, v31
    v_accvgpr_write_b32 a208, v24
    v_accvgpr_write_b32 a209, v25
    v_accvgpr_write_b32 a210, v26
    v_accvgpr_write_b32 a211, v27
    v_accvgpr_read_b32 v24, a232
    v_accvgpr_read_b32 v25, a233
    v_accvgpr_read_b32 v26, a234
    v_accvgpr_read_b32 v27, a235
    v_accvgpr_read_b32 v28, a236
    v_accvgpr_read_b32 v29, a237
    v_accvgpr_read_b32 v30, a238
    v_accvgpr_read_b32 v31, a239
    v_cvt_pk_bf16_f32 v24, v24, v25
    v_cvt_pk_bf16_f32 v25, v26, v27
    v_cvt_pk_bf16_f32 v26, v28, v29
    v_cvt_pk_bf16_f32 v27, v30, v31
    v_accvgpr_write_b32 a212, v24
    v_accvgpr_write_b32 a213, v25
    v_accvgpr_write_b32 a214, v26
    v_accvgpr_write_b32 a215, v27
    v_accvgpr_read_b32 v24, a240
    v_accvgpr_read_b32 v25, a241
    v_accvgpr_read_b32 v26, a242
    v_accvgpr_read_b32 v27, a243
    v_accvgpr_read_b32 v28, a244
    v_accvgpr_read_b32 v29, a245
    v_accvgpr_read_b32 v30, a246
    v_accvgpr_read_b32 v31, a247
    v_cvt_pk_bf16_f32 v24, v24, v25
    v_cvt_pk_bf16_f32 v25, v26, v27
    v_cvt_pk_bf16_f32 v26, v28, v29
    v_cvt_pk_bf16_f32 v27, v30, v31
    v_accvgpr_write_b32 a216, v24
    v_accvgpr_write_b32 a217, v25
    v_accvgpr_write_b32 a218, v26
    v_accvgpr_write_b32 a219, v27
    v_accvgpr_read_b32 v24, a248
    v_accvgpr_read_b32 v25, a249
    v_accvgpr_read_b32 v26, a250
    v_accvgpr_read_b32 v27, a251
    v_accvgpr_read_b32 v28, a252
    v_accvgpr_read_b32 v29, a253
    v_accvgpr_read_b32 v30, a254
    v_accvgpr_read_b32 v31, a255
    v_cvt_pk_bf16_f32 v24, v24, v25
    v_cvt_pk_bf16_f32 v25, v26, v27
    v_cvt_pk_bf16_f32 v26, v28, v29
    v_cvt_pk_bf16_f32 v27, v30, v31
    v_accvgpr_write_b32 a220, v24
    v_accvgpr_write_b32 a221, v25
    v_accvgpr_write_b32 a222, v26
    v_accvgpr_write_b32 a223, v27
    s_setpc_b64 s[20:21]
m_epf22:
    s_nop 7
    s_cmp_eq_u32 s97, 0
    s_cbranch_scc1 m_noscale65
    s_mov_b32 s91, s98
    s_mov_b32 s92, s97
    s_mov_b32 s93, s97
    s_mov_b32 s90, s91
    v_pk_mul_f32 v[32:33], v[32:33], s[92:93]
    v_pk_mul_f32 v[34:35], v[34:35], s[92:93]
    v_pk_mul_f32 v[36:37], v[36:37], s[92:93]
    v_pk_mul_f32 v[38:39], v[38:39], s[92:93]
    v_cvt_pk_bf16_f32 v32, v32, v33
    v_cvt_pk_bf16_f32 v33, v34, v35
    v_cvt_pk_bf16_f32 v34, v36, v37
    v_cvt_pk_bf16_f32 v35, v38, v39
    buffer_store_dwordx4 v[32:35], v2, s[8:11], s90 offen sc1
    s_add_u32 s90, s90, s100
    v_pk_mul_f32 v[40:41], v[40:41], s[92:93]
    v_pk_mul_f32 v[42:43], v[42:43], s[92:93]
    v_pk_mul_f32 v[44:45], v[44:45], s[92:93]
    v_pk_mul_f32 v[46:47], v[46:47], s[92:93]
    v_cvt_pk_bf16_f32 v40, v40, v41
    v_cvt_pk_bf16_f32 v41, v42, v43
    v_cvt_pk_bf16_f32 v42, v44, v45
    v_cvt_pk_bf16_f32 v43, v46, v47
    buffer_store_dwordx4 v[40:43], v2, s[8:11], s90 offen sc1
    s_add_u32 s90, s90, s100
    v_pk_mul_f32 v[48:49], v[48:49], s[92:93]
    v_pk_mul_f32 v[50:51], v[50:51], s[92:93]
    v_pk_mul_f32 v[52:53], v[52:53], s[92:93]
    v_pk_mul_f32 v[54:55], v[54:55], s[92:93]
    v_cvt_pk_bf16_f32 v48, v48, v49
    v_cvt_pk_bf16_f32 v49, v50, v51
    v_cvt_pk_bf16_f32 v50, v52, v53
    v_cvt_pk_bf16_f32 v51, v54, v55
    buffer_store_dwordx4 v[48:51], v2, s[8:11], s90 offen sc1
    s_add_u32 s90, s90, s100
    v_pk_mul_f32 v[56:57], v[56:57], s[92:93]
    v_pk_mul_f32 v[58:59], v[58:59], s[92:93]
    v_pk_mul_f32 v[60:61], v[60:61], s[92:93]
    v_pk_mul_f32 v[62:63], v[62:63], s[92:93]
    v_cvt_pk_bf16_f32 v56, v56, v57
    v_cvt_pk_bf16_f32 v57, v58, v59
    v_cvt_pk_bf16_f32 v58, v60, v61
    v_cvt_pk_bf16_f32 v59, v62, v63
    buffer_store_dwordx4 v[56:59], v2, s[8:11], s90 offen sc1
    s_add_u32 s90, s90, s100
    v_pk_mul_f32 v[64:65], v[64:65], s[92:93]
    v_pk_mul_f32 v[66:67], v[66:67], s[92:93]
    v_pk_mul_f32 v[68:69], v[68:69], s[92:93]
    v_pk_mul_f32 v[70:71], v[70:71], s[92:93]
    v_cvt_pk_bf16_f32 v64, v64, v65
    v_cvt_pk_bf16_f32 v65, v66, v67
    v_cvt_pk_bf16_f32 v66, v68, v69
    v_cvt_pk_bf16_f32 v67, v70, v71
    buffer_store_dwordx4 v[64:67], v2, s[8:11], s90 offen sc1
    s_add_u32 s90, s90, s100
    v_pk_mul_f32 v[72:73], v[72:73], s[92:93]
    v_pk_mul_f32 v[74:75], v[74:75], s[92:93]
    v_pk_mul_f32 v[76:77], v[76:77], s[92:93]
    v_pk_mul_f32 v[78:79], v[78:79], s[92:93]
    v_cvt_pk_bf16_f32 v72, v72, v73
    v_cvt_pk_bf16_f32 v73, v74, v75
    v_cvt_pk_bf16_f32 v74, v76, v77
    v_cvt_pk_bf16_f32 v75, v78, v79
    buffer_store_dwordx4 v[72:75], v2, s[8:11], s90 offen sc1
    s_add_u32 s90, s90, s100
    v_pk_mul_f32 v[80:81], v[80:81], s[92:93]
    v_pk_mul_f32 v[82:83], v[82:83], s[92:93]
    v_pk_mul_f32 v[84:85], v[84:85], s[92:93]
    v_pk_mul_f32 v[86:87], v[86:87], s[92:93]
    v_cvt_pk_bf16_f32 v80, v80, v81
    v_cvt_pk_bf16_f32 v81, v82, v83
    v_cvt_pk_bf16_f32 v82, v84, v85
    v_cvt_pk_bf16_f32 v83, v86, v87
    buffer_store_dwordx4 v[80:83], v2, s[8:11], s90 offen sc1
    s_add_u32 s90, s90, s100
    v_pk_mul_f32 v[88:89], v[88:89], s[92:93]
    v_pk_mul_f32 v[90:91], v[90:91], s[92:93]
    v_pk_mul_f32 v[92:93], v[92:93], s[92:93]
    v_pk_mul_f32 v[94:95], v[94:95], s[92:93]
    v_cvt_pk_bf16_f32 v88, v88, v89
    v_cvt_pk_bf16_f32 v89, v90, v91
    v_cvt_pk_bf16_f32 v90, v92, v93
    v_cvt_pk_bf16_f32 v91, v94, v95
    buffer_store_dwordx4 v[88:91], v2, s[8:11], s90 offen sc1
    s_add_u32 s90, s90, s100
    s_add_u32 s91, s91, s99
    s_mov_b32 s90, s91
    v_pk_mul_f32 v[96:97], v[96:97], s[92:93]
    v_pk_mul_f32 v[98:99], v[98:99], s[92:93]
    v_pk_mul_f32 v[100:101], v[100:101], s[92:93]
    v_pk_mul_f32 v[102:103], v[102:103], s[92:93]
    v_cvt_pk_bf16_f32 v96, v96, v97
    v_cvt_pk_bf16_f32 v97, v98, v99
    v_cvt_pk_bf16_f32 v98, v100, v101
    v_cvt_pk_bf16_f32 v99, v102, v103
    buffer_store_dwordx4 v[96:99], v2, s[8:11], s90 offen sc1
    s_add_u32 s90, s90, s100
    v_pk_mul_f32 v[104:105], v[104:105], s[92:93]
    v_pk_mul_f32 v[106:107], v[106:107], s[92:93]
    v_pk_mul_f32 v[108:109], v[108:109], s[92:93]
    v_pk_mul_f32 v[110:111], v[110:111], s[92:93]
    v_cvt_pk_bf16_f32 v104, v104, v105
    v_cvt_pk_bf16_f32 v105, v106, v107
    v_cvt_pk_bf16_f32 v106, v108, v109
    v_cvt_pk_bf16_f32 v107, v110, v111
    buffer_store_dwordx4 v[104:107], v2, s[8:11], s90 offen sc1
    s_add_u32 s90, s90, s100
    v_pk_mul_f32 v[112:113], v[112:113], s[92:93]
    v_pk_mul_f32 v[114:115], v[114:115], s[92:93]
    v_pk_mul_f32 v[116:117], v[116:117], s[92:93]
    v_pk_mul_f32 v[118:119], v[118:119], s[92:93]
    v_cvt_pk_bf16_f32 v112, v112, v113
    v_cvt_pk_bf16_f32 v113, v114, v115
    v_cvt_pk_bf16_f32 v114, v116, v117
    v_cvt_pk_bf16_f32 v115, v118, v119
    buffer_store_dwordx4 v[112:115], v2, s[8:11], s90 offen sc1
    s_add_u32 s90, s90, s100
    v_pk_mul_f32 v[120:121], v[120:121], s[92:93]
    v_pk_mul_f32 v[122:123], v[122:123], s[92:93]
    v_pk_mul_f32 v[124:125], v[124:125], s[92:93]
    v_pk_mul_f32 v[126:127], v[126:127], s[92:93]
    v_cvt_pk_bf16_f32 v120, v120, v121
    v_cvt_pk_bf16_f32 v121, v122, v123
    v_cvt_pk_bf16_f32 v122, v124, v125
    v_cvt_pk_bf16_f32 v123, v126, v127
    buffer_store_dwordx4 v[120:123], v2, s[8:11], s90 offen sc1
    s_add_u32 s90, s90, s100
    v_pk_mul_f32 v[128:129], v[128:129], s[92:93]
    v_pk_mul_f32 v[130:131], v[130:131], s[92:93]
    v_pk_mul_f32 v[132:133], v[132:133], s[92:93]
    v_pk_mul_f32 v[134:135], v[134:135], s[92:93]
    v_cvt_pk_bf16_f32 v128, v128, v129
    v_cvt_pk_bf16_f32 v129, v130, v131
    v_cvt_pk_bf16_f32 v130, v132, v133
    v_cvt_pk_bf16_f32 v131, v134, v135
    buffer_store_dwordx4 v[128:131], v2, s[8:11], s90 offen sc1
    s_add_u32 s90, s90, s100
    v_pk_mul_f32 v[136:137], v[136:137], s[92:93]
    v_pk_mul_f32 v[138:139], v[138:139], s[92:93]
    v_pk_mul_f32 v[140:141], v[140:141], s[92:93]
    v_pk_mul_f32 v[142:143], v[142:143], s[92:93]
    v_cvt_pk_bf16_f32 v136, v136, v137
    v_cvt_pk_bf16_f32 v137, v138, v139
    v_cvt_pk_bf16_f32 v138, v140, v141
    v_cvt_pk_bf16_f32 v139, v142, v143
    buffer_store_dwordx4 v[136:139], v2, s[8:11], s90 offen sc1
    s_add_u32 s90, s90, s100
    v_pk_mul_f32 v[144:145], v[144:145], s[92:93]
    v_pk_mul_f32 v[146:147], v[146:147], s[92:93]
    v_pk_mul_f32 v[148:149], v[148:149], s[92:93]
    v_pk_mul_f32 v[150:151], v[150:151], s[92:93]
    v_cvt_pk_bf16_f32 v144, v144, v145
    v_cvt_pk_bf16_f32 v145, v146, v147
    v_cvt_pk_bf16_f32 v146, v148, v149
    v_cvt_pk_bf16_f32 v147, v150, v151
    buffer_store_dwordx4 v[144:147], v2, s[8:11], s90 offen sc1
    s_add_u32 s90, s90, s100
    v_pk_mul_f32 v[152:153], v[152:153], s[92:93]
    v_pk_mul_f32 v[154:155], v[154:155], s[92:93]
    v_pk_mul_f32 v[156:157], v[156:157], s[92:93]
    v_pk_mul_f32 v[158:159], v[158:159], s[92:93]
    v_cvt_pk_bf16_f32 v152, v152, v153
    v_cvt_pk_bf16_f32 v153, v154, v155
    v_cvt_pk_bf16_f32 v154, v156, v157
    v_cvt_pk_bf16_f32 v155, v158, v159
    buffer_store_dwordx4 v[152:155], v2, s[8:11], s90 offen sc1
    s_add_u32 s90, s90, s100
    s_add_u32 s91, s91, s99
    s_mov_b32 s90, s91
    v_pk_mul_f32 v[160:161], v[160:161], s[92:93]
    v_pk_mul_f32 v[162:163], v[162:163], s[92:93]
    v_pk_mul_f32 v[164:165], v[164:165], s[92:93]
    v_pk_mul_f32 v[166:167], v[166:167], s[92:93]
    v_cvt_pk_bf16_f32 v160, v160, v161
    v_cvt_pk_bf16_f32 v161, v162, v163
    v_cvt_pk_bf16_f32 v162, v164, v165
    v_cvt_pk_bf16_f32 v163, v166, v167
    buffer_store_dwordx4 v[160:163], v2, s[8:11], s90 offen sc1
    s_add_u32 s90, s90, s100
    v_pk_mul_f32 v[168:169], v[168:169], s[92:93]
    v_pk_mul_f32 v[170:171], v[170:171], s[92:93]
    v_pk_mul_f32 v[172:173], v[172:173], s[92:93]
    v_pk_mul_f32 v[174:175], v[174:175], s[92:93]
    v_cvt_pk_bf16_f32 v168, v168, v169
    v_cvt_pk_bf16_f32 v169, v170, v171
    v_cvt_pk_bf16_f32 v170, v172, v173
    v_cvt_pk_bf16_f32 v171, v174, v175
    buffer_store_dwordx4 v[168:171], v2, s[8:11], s90 offen sc1
    s_add_u32 s90, s90, s100
    v_pk_mul_f32 v[176:177], v[176:177], s[92:93]
    v_pk_mul_f32 v[178:179], v[178:179], s[92:93]
    v_pk_mul_f32 v[180:181], v[180:181], s[92:93]
    v_pk_mul_f32 v[182:183], v[182:183], s[92:93]
    v_cvt_pk_bf16_f32 v176, v176, v177
    v_cvt_pk_bf16_f32 v177, v178, v179
    v_cvt_pk_bf16_f32 v178, v180, v181
    v_cvt_pk_bf16_f32 v179, v182, v183
    buffer_store_dwordx4 v[176:179], v2, s[8:11], s90 offen sc1
    s_add_u32 s90, s90, s100
    v_pk_mul_f32 v[184:185], v[184:185], s[92:93]
    v_pk_mul_f32 v[186:187], v[186:187], s[92:93]
    v_pk_mul_f32 v[188:189], v[188:189], s[92:93]
    v_pk_mul_f32 v[190:191], v[190:191], s[92:93]
    v_cvt_pk_bf16_f32 v184, v184, v185
    v_cvt_pk_bf16_f32 v185, v186, v187
    v_cvt_pk_bf16_f32 v186, v188, v189
    v_cvt_pk_bf16_f32 v187, v190, v191
    buffer_store_dwordx4 v[184:187], v2, s[8:11], s90 offen sc1
    s_add_u32 s90, s90, s100
    v_pk_mul_f32 v[192:193], v[192:193], s[92:93]
    v_pk_mul_f32 v[194:195], v[194:195], s[92:93]
    v_pk_mul_f32 v[196:197], v[196:197], s[92:93]
    v_pk_mul_f32 v[198:199], v[198:199], s[92:93]
    v_cvt_pk_bf16_f32 v192, v192, v193
    v_cvt_pk_bf16_f32 v193, v194, v195
    v_cvt_pk_bf16_f32 v194, v196, v197
    v_cvt_pk_bf16_f32 v195, v198, v199
    buffer_store_dwordx4 v[192:195], v2, s[8:11], s90 offen sc1
    s_add_u32 s90, s90, s100
    v_pk_mul_f32 v[200:201], v[200:201], s[92:93]
    v_pk_mul_f32 v[202:203], v[202:203], s[92:93]
    v_pk_mul_f32 v[204:205], v[204:205], s[92:93]
    v_pk_mul_f32 v[206:207], v[206:207], s[92:93]
    v_cvt_pk_bf16_f32 v200, v200, v201
    v_cvt_pk_bf16_f32 v201, v202, v203
    v_cvt_pk_bf16_f32 v202, v204, v205
    v_cvt_pk_bf16_f32 v203, v206, v207
    buffer_store_dwordx4 v[200:203], v2, s[8:11], s90 offen sc1
    s_add_u32 s90, s90, s100
    v_pk_mul_f32 v[208:209], v[208:209], s[92:93]
    v_pk_mul_f32 v[210:211], v[210:211], s[92:93]
    v_pk_mul_f32 v[212:213], v[212:213], s[92:93]
    v_pk_mul_f32 v[214:215], v[214:215], s[92:93]
    v_cvt_pk_bf16_f32 v208, v208, v209
    v_cvt_pk_bf16_f32 v209, v210, v211
    v_cvt_pk_bf16_f32 v210, v212, v213
    v_cvt_pk_bf16_f32 v211, v214, v215
    buffer_store_dwordx4 v[208:211], v2, s[8:11], s90 offen sc1
    s_add_u32 s90, s90, s100
    v_pk_mul_f32 v[216:217], v[216:217], s[92:93]
    v_pk_mul_f32 v[218:219], v[218:219], s[92:93]
    v_pk_mul_f32 v[220:221], v[220:221], s[92:93]
    v_pk_mul_f32 v[222:223], v[222:223], s[92:93]
    v_cvt_pk_bf16_f32 v216, v216, v217
    v_cvt_pk_bf16_f32 v217, v218, v219
    v_cvt_pk_bf16_f32 v218, v220, v221
    v_cvt_pk_bf16_f32 v219, v222, v223
    buffer_store_dwordx4 v[216:219], v2, s[8:11], s90 offen sc1
    s_add_u32 s90, s90, s100
    s_add_u32 s91, s91, s99
    s_mov_b32 s90, s91
    v_pk_mul_f32 v[224:225], v[224:225], s[92:93]
    v_pk_mul_f32 v[226:227], v[226:227], s[92:93]
    v_pk_mul_f32 v[228:229], v[228:229], s[92:93]
    v_pk_mul_f32 v[230:231], v[230:231], s[92:93]
    v_cvt_pk_bf16_f32 v224, v224, v225
    v_cvt_pk_bf16_f32 v225, v226, v227
    v_cvt_pk_bf16_f32 v226, v228, v229
    v_cvt_pk_bf16_f32 v227, v230, v231
    buffer_store_dwordx4 v[224:227], v2, s[8:11], s90 offen sc1
    s_add_u32 s90, s90, s100
    v_pk_mul_f32 v[232:233], v[232:233], s[92:93]
    v_pk_mul_f32 v[234:235], v[234:235], s[92:93]
    v_pk_mul_f32 v[236:237], v[236:237], s[92:93]
    v_pk_mul_f32 v[238:239], v[238:239], s[92:93]
    v_cvt_pk_bf16_f32 v232, v232, v233
    v_cvt_pk_bf16_f32 v233, v234, v235
    v_cvt_pk_bf16_f32 v234, v236, v237
    v_cvt_pk_bf16_f32 v235, v238, v239
    buffer_store_dwordx4 v[232:235], v2, s[8:11], s90 offen sc1
    s_add_u32 s90, s90, s100
    v_pk_mul_f32 v[240:241], v[240:241], s[92:93]
    v_pk_mul_f32 v[242:243], v[242:243], s[92:93]
    v_pk_mul_f32 v[244:245], v[244:245], s[92:93]
    v_pk_mul_f32 v[246:247], v[246:247], s[92:93]
    v_cvt_pk_bf16_f32 v240, v240, v241
    v_cvt_pk_bf16_f32 v241, v242, v243
    v_cvt_pk_bf16_f32 v242, v244, v245
    v_cvt_pk_bf16_f32 v243, v246, v247
    buffer_store_dwordx4 v[240:243], v2, s[8:11], s90 offen sc1
    s_add_u32 s90, s90, s100
    v_pk_mul_f32 v[248:249], v[248:249], s[92:93]
    v_pk_mul_f32 v[250:251], v[250:251], s[92:93]
    v_pk_mul_f32 v[252:253], v[252:253], s[92:93]
    v_pk_mul_f32 v[254:255], v[254:255], s[92:93]
    v_cvt_pk_bf16_f32 v248, v248, v249
    v_cvt_pk_bf16_f32 v249, v250, v251
    v_cvt_pk_bf16_f32 v250, v252, v253
    v_cvt_pk_bf16_f32 v251, v254, v255
    buffer_store_dwordx4 v[248:251], v2, s[8:11], s90 offen sc1
    s_add_u32 s90, s90, s100
    v_accvgpr_read_b32 v24, a224
    v_accvgpr_read_b32 v25, a225
    v_accvgpr_read_b32 v26, a226
    v_accvgpr_read_b32 v27, a227
    v_accvgpr_read_b32 v28, a228
    v_accvgpr_read_b32 v29, a229
    v_accvgpr_read_b32 v30, a230
    v_accvgpr_read_b32 v31, a231
    v_pk_mul_f32 v[24:25], v[24:25], s[92:93]
    v_pk_mul_f32 v[26:27], v[26:27], s[92:93]
    v_pk_mul_f32 v[28:29], v[28:29], s[92:93]
    v_pk_mul_f32 v[30:31], v[30:31], s[92:93]
    v_cvt_pk_bf16_f32 v24, v24, v25
    v_cvt_pk_bf16_f32 v25, v26, v27
    v_cvt_pk_bf16_f32 v26, v28, v29
    v_cvt_pk_bf16_f32 v27, v30, v31
    buffer_store_dwordx4 v[24:27], v2, s[8:11], s90 offen sc1
    s_add_u32 s90, s90, s100
    s_nop 1
    v_accvgpr_read_b32 v24, a232
    v_accvgpr_read_b32 v25, a233
    v_accvgpr_read_b32 v26, a234
    v_accvgpr_read_b32 v27, a235
    v_accvgpr_read_b32 v28, a236
    v_accvgpr_read_b32 v29, a237
    v_accvgpr_read_b32 v30, a238
    v_accvgpr_read_b32 v31, a239
    v_pk_mul_f32 v[24:25], v[24:25], s[92:93]
    v_pk_mul_f32 v[26:27], v[26:27], s[92:93]
    v_pk_mul_f32 v[28:29], v[28:29], s[92:93]
    v_pk_mul_f32 v[30:31], v[30:31], s[92:93]
    v_cvt_pk_bf16_f32 v24, v24, v25
    v_cvt_pk_bf16_f32 v25, v26, v27
    v_cvt_pk_bf16_f32 v26, v28, v29
    v_cvt_pk_bf16_f32 v27, v30, v31
    buffer_store_dwordx4 v[24:27], v2, s[8:11], s90 offen sc1
    s_add_u32 s90, s90, s100
    s_nop 1
    v_accvgpr_read_b32 v24, a240
    v_accvgpr_read_b32 v25, a241
    v_accvgpr_read_b32 v26, a242
    v_accvgpr_read_b32 v27, a243
    v_accvgpr_read_b32 v28, a244
    v_accvgpr_read_b32 v29, a245
    v_accvgpr_read_b32 v30, a246
    v_accvgpr_read_b32 v31, a247
    v_pk_mul_f32 v[24:25], v[24:25], s[92:93]
    v_pk_mul_f32 v[26:27], v[26:27], s[92:93]
    v_pk_mul_f32 v[28:29], v[28:29], s[92:93]
    v_pk_mul_f32 v[30:31], v[30:31], s[92:93]
    v_cvt_pk_bf16_f32 v24, v24, v25
    v_cvt_pk_bf16_f32 v25, v26, v27
    v_cvt_pk_bf16_f32 v26, v28, v29
    v_cvt_pk_bf16_f32 v27, v30, v31
    buffer_store_dwordx4 v[24:27], v2, s[8:11], s90 offen sc1
    s_add_u32 s90, s90, s100
    s_nop 1
    v_accvgpr_read_b32 v24, a248
    v_accvgpr_read_b32 v25, a249
    v_accvgpr_read_b32 v26, a250
    v_accvgpr_read_b32 v27, a251
    v_accvgpr_read_b32 v28, a252
    v_accvgpr_read_b32 v29, a253
    v_accvgpr_read_b32 v30, a254
    v_accvgpr_read_b32 v31, a255
    v_pk_mul_f32 v[24:25], v[24:25], s[92:93]
    v_pk_mul_f32 v[26:27], v[26:27], s[92:93]
    v_pk_mul_f32 v[28:29], v[28:29], s[92:93]
    v_pk_mul_f32 v[30:31], v[30:31], s[92:93]
    v_cvt_pk_bf16_f32 v24, v24, v25
    v_cvt_pk_bf16_f32 v25, v26, v27
    v_cvt_pk_bf16_f32 v26, v28, v29
    v_cvt_pk_bf16_f32 v27, v30, v31
    buffer_store_dwordx4 v[24:27], v2, s[8:11], s90 offen sc1
    s_add_u32 s90, s90, s100
    s_nop 1
    s_add_u32 s91, s91, s99
    s_setpc_b64 s[20:21]
m_noscale65:
    s_mov_b32 s91, s98
    s_mov_b32 s92, s97
    s_mov_b32 s93, s97
    s_mov_b32 s90, s91
    v_cvt_pk_bf16_f32 v32, v32, v33
    v_cvt_pk_bf16_f32 v33, v34, v35
    v_cvt_pk_bf16_f32 v34, v36, v37
    v_cvt_pk_bf16_f32 v35, v38, v39
    buffer_store_dwordx4 v[32:35], v2, s[8:11], s90 offen sc1
    s_add_u32 s90, s90, s100
    v_cvt_pk_bf16_f32 v40, v40, v41
    v_cvt_pk_bf16_f32 v41, v42, v43
    v_cvt_pk_bf16_f32 v42, v44, v45
    v_cvt_pk_bf16_f32 v43, v46, v47
    buffer_store_dwordx4 v[40:43], v2, s[8:11], s90 offen sc1
    s_add_u32 s90, s90, s100
    v_cvt_pk_bf16_f32 v48, v48, v49
    v_cvt_pk_bf16_f32 v49, v50, v51
    v_cvt_pk_bf16_f32 v50, v52, v53
    v_cvt_pk_bf16_f32 v51, v54, v55
    buffer_store_dwordx4 v[48:51], v2, s[8:11], s90 offen sc1
    s_add_u32 s90, s90, s100
    v_cvt_pk_bf16_f32 v56, v56, v57
    v_cvt_pk_bf16_f32 v57, v58, v59
    v_cvt_pk_bf16_f32 v58, v60, v61
    v_cvt_pk_bf16_f32 v59, v62, v63
    buffer_store_dwordx4 v[56:59], v2, s[8:11], s90 offen sc1
    s_add_u32 s90, s90, s100
    v_cvt_pk_bf16_f32 v64, v64, v65
    v_cvt_pk_bf16_f32 v65, v66, v67
    v_cvt_pk_bf16_f32 v66, v68, v69
    v_cvt_pk_bf16_f32 v67, v70, v71
    buffer_store_dwordx4 v[64:67], v2, s[8:11], s90 offen sc1
    s_add_u32 s90, s90, s100
    v_cvt_pk_bf16_f32 v72, v72, v73
    v_cvt_pk_bf16_f32 v73, v74, v75
    v_cvt_pk_bf16_f32 v74, v76, v77
    v_cvt_pk_bf16_f32 v75, v78, v79
    buffer_store_dwordx4 v[72:75], v2, s[8:11], s90 offen sc1
    s_add_u32 s90, s90, s100
    v_cvt_pk_bf16_f32 v80, v80, v81
    v_cvt_pk_bf16_f32 v81, v82, v83
    v_cvt_pk_bf16_f32 v82, v84, v85
    v_cvt_pk_bf16_f32 v83, v86, v87
    buffer_store_dwordx4 v[80:83], v2, s[8:11], s90 offen sc1
    s_add_u32 s90, s90, s100
    v_cvt_pk_bf16_f32 v88, v88, v89
    v_cvt_pk_bf16_f32 v89, v90, v91
    v_cvt_pk_bf16_f32 v90, v92, v93
    v_cvt_pk_bf16_f32 v91, v94, v95
    buffer_store_dwordx4 v[88:91], v2, s[8:11], s90 offen sc1
    s_add_u32 s90, s90, s100
    s_add_u32 s91, s91, s99
    s_mov_b32 s90, s91
    v_cvt_pk_bf16_f32 v96, v96, v97
    v_cvt_pk_bf16_f32 v97, v98, v99
    v_cvt_pk_bf16_f32 v98, v100, v101
    v_cvt_pk_bf16_f32 v99, v102, v103
    buffer_store_dwordx4 v[96:99], v2, s[8:11], s90 offen sc1
    s_add_u32 s90, s90, s100
    v_cvt_pk_bf16_f32 v104, v104, v105
    v_cvt_pk_bf16_f32 v105, v106, v107
    v_cvt_pk_bf16_f32 v106, v108, v109
    v_cvt_pk_bf16_f32 v107, v110, v111
    buffer_store_dwordx4 v[104:107], v2, s[8:11], s90 offen sc1
    s_add_u32 s90, s90, s100
    v_cvt_pk_bf16_f32 v112, v112, v113
    v_cvt_pk_bf16_f32 v113, v114, v115
    v_cvt_pk_bf16_f32 v114, v116, v117
    v_cvt_pk_bf16_f32 v115, v118, v119
    buffer_store_dwordx4 v[112:115], v2, s[8:11], s90 offen sc1
    s_add_u32 s90, s90, s100
    v_cvt_pk_bf16_f32 v120, v120, v121
    v_cvt_pk_bf16_f32 v121, v122, v123
    v_cvt_pk_bf16_f32 v122, v124, v125
    v_cvt_pk_bf16_f32 v123, v126, v127
    buffer_store_dwordx4 v[120:123], v2, s[8:11], s90 offen sc1
    s_add_u32 s90, s90, s100
    v_cvt_pk_bf16_f32 v128, v128, v129
    v_cvt_pk_bf16_f32 v129, v130, v131
    v_cvt_pk_bf16_f32 v130, v132, v133
    v_cvt_pk_bf16_f32 v131, v134, v135
    buffer_store_dwordx4 v[128:131], v2, s[8:11], s90 offen sc1
    s_add_u32 s90, s90, s100
    v_cvt_pk_bf16_f32 v136, v136, v137
    v_cvt_pk_bf16_f32 v137, v138, v139
    v_cvt_pk_bf16_f32 v138, v140, v141
    v_cvt_pk_bf16_f32 v139, v142, v143
    buffer_store_dwordx4 v[136:139], v2, s[8:11], s90 offen sc1
    s_add_u32 s90, s90, s100
    v_cvt_pk_bf16_f32 v144, v144, v145
    v_cvt_pk_bf16_f32 v145, v146, v147
    v_cvt_pk_bf16_f32 v146, v148, v149
    v_cvt_pk_bf16_f32 v147, v150, v151
    buffer_store_dwordx4 v[144:147], v2, s[8:11], s90 offen sc1
    s_add_u32 s90, s90, s100
    v_cvt_pk_bf16_f32 v152, v152, v153
    v_cvt_pk_bf16_f32 v153, v154, v155
    v_cvt_pk_bf16_f32 v154, v156, v157
    v_cvt_pk_bf16_f32 v155, v158, v159
    buffer_store_dwordx4 v[152:155], v2, s[8:11], s90 offen sc1
    s_add_u32 s90, s90, s100
    s_add_u32 s91, s91, s99
    s_mov_b32 s90, s91
    v_cvt_pk_bf16_f32 v160, v160, v161
    v_cvt_pk_bf16_f32 v161, v162, v163
    v_cvt_pk_bf16_f32 v162, v164, v165
    v_cvt_pk_bf16_f32 v163, v166, v167
    buffer_store_dwordx4 v[160:163], v2, s[8:11], s90 offen sc1
    s_add_u32 s90, s90, s100
    v_cvt_pk_bf16_f32 v168, v168, v169
    v_cvt_pk_bf16_f32 v169, v170, v171
    v_cvt_pk_bf16_f32 v170, v172, v173
    v_cvt_pk_bf16_f32 v171, v174, v175
    buffer_store_dwordx4 v[168:171], v2, s[8:11], s90 offen sc1
    s_add_u32 s90, s90, s100
    v_cvt_pk_bf16_f32 v176, v176, v177
    v_cvt_pk_bf16_f32 v177, v178, v179
    v_cvt_pk_bf16_f32 v178, v180, v181
    v_cvt_pk_bf16_f32 v179, v182, v183
    buffer_store_dwordx4 v[176:179], v2, s[8:11], s90 offen sc1
    s_add_u32 s90, s90, s100
    v_cvt_pk_bf16_f32 v184, v184, v185
    v_cvt_pk_bf16_f32 v185, v186, v187
    v_cvt_pk_bf16_f32 v186, v188, v189
    v_cvt_pk_bf16_f32 v187, v190, v191
    buffer_store_dwordx4 v[184:187], v2, s[8:11], s90 offen sc1
    s_add_u32 s90, s90, s100
    v_cvt_pk_bf16_f32 v192, v192, v193
    v_cvt_pk_bf16_f32 v193, v194, v195
    v_cvt_pk_bf16_f32 v194, v196, v197
    v_cvt_pk_bf16_f32 v195, v198, v199
    buffer_store_dwordx4 v[192:195], v2, s[8:11], s90 offen sc1
    s_add_u32 s90, s90, s100
    v_cvt_pk_bf16_f32 v200, v200, v201
    v_cvt_pk_bf16_f32 v201, v202, v203
    v_cvt_pk_bf16_f32 v202, v204, v205
    v_cvt_pk_bf16_f32 v203, v206, v207
    buffer_store_dwordx4 v[200:203], v2, s[8:11], s90 offen sc1
    s_add_u32 s90, s90, s100
    v_cvt_pk_bf16_f32 v208, v208, v209
    v_cvt_pk_bf16_f32 v209, v210, v211
    v_cvt_pk_bf16_f32 v210, v212, v213
    v_cvt_pk_bf16_f32 v211, v214, v215
    buffer_store_dwordx4 v[208:211], v2, s[8:11], s90 offen sc1
    s_add_u32 s90, s90, s100
    v_cvt_pk_bf16_f32 v216, v216, v217
    v_cvt_pk_bf16_f32 v217, v218, v219
    v_cvt_pk_bf16_f32 v218, v220, v221
    v_cvt_pk_bf16_f32 v219, v222, v223
    buffer_store_dwordx4 v[216:219], v2, s[8:11], s90 offen sc1
    s_add_u32 s90, s90, s100
    s_add_u32 s91, s91, s99
    s_mov_b32 s90, s91
    v_cvt_pk_bf16_f32 v224, v224, v225
    v_cvt_pk_bf16_f32 v225, v226, v227
    v_cvt_pk_bf16_f32 v226, v228, v229
    v_cvt_pk_bf16_f32 v227, v230, v231
    buffer_store_dwordx4 v[224:227], v2, s[8:11], s90 offen sc1
    s_add_u32 s90, s90, s100
    v_cvt_pk_bf16_f32 v232, v232, v233
    v_cvt_pk_bf16_f32 v233, v234, v235
    v_cvt_pk_bf16_f32 v234, v236, v237
    v_cvt_pk_bf16_f32 v235, v238, v239
    buffer_store_dwordx4 v[232:235], v2, s[8:11], s90 offen sc1
    s_add_u32 s90, s90, s100
    v_cvt_pk_bf16_f32 v240, v240, v241
    v_cvt_pk_bf16_f32 v241, v242, v243
    v_cvt_pk_bf16_f32 v242, v244, v245
    v_cvt_pk_bf16_f32 v243, v246, v247
    buffer_store_dwordx4 v[240:243], v2, s[8:11], s90 offen sc1
    s_add_u32 s90, s90, s100
    v_cvt_pk_bf16_f32 v248, v248, v249
    v_cvt_pk_bf16_f32 v249, v250, v251
    v_cvt_pk_bf16_f32 v250, v252, v253
    v_cvt_pk_bf16_f32 v251, v254, v255
    buffer_store_dwordx4 v[248:251], v2, s[8:11], s90 offen sc1
    s_add_u32 s90, s90, s100
    v_accvgpr_read_b32 v24, a224
    v_accvgpr_read_b32 v25, a225
    v_accvgpr_read_b32 v26, a226
    v_accvgpr_read_b32 v27, a227
    v_accvgpr_read_b32 v28, a228
    v_accvgpr_read_b32 v29, a229
    v_accvgpr_read_b32 v30, a230
    v_accvgpr_read_b32 v31, a231
    v_cvt_pk_bf16_f32 v24, v24, v25
    v_cvt_pk_bf16_f32 v25, v26, v27
    v_cvt_pk_bf16_f32 v26, v28, v29
    v_cvt_pk_bf16_f32 v27, v30, v31
    buffer_store_dwordx4 v[24:27], v2, s[8:11], s90 offen sc1
    s_add_u32 s90, s90, s100
    s_nop 1
    v_accvgpr_read_b32 v24, a232
    v_accvgpr_read_b32 v25, a233
    v_accvgpr_read_b32 v26, a234
    v_accvgpr_read_b32 v27, a235
    v_accvgpr_read_b32 v28, a236
    v_accvgpr_read_b32 v29, a237
    v_accvgpr_read_b32 v30, a238
    v_accvgpr_read_b32 v31, a239
    v_cvt_pk_bf16_f32 v24, v24, v25
    v_cvt_pk_bf16_f32 v25, v26, v27
    v_cvt_pk_bf16_f32 v26, v28, v29
    v_cvt_pk_bf16_f32 v27, v30, v31
    buffer_store_dwordx4 v[24:27], v2, s[8:11], s90 offen sc1
    s_add_u32 s90, s90, s100
    s_nop 1
    v_accvgpr_read_b32 v24, a240
    v_accvgpr_read_b32 v25, a241
    v_accvgpr_read_b32 v26, a242
    v_accvgpr_read_b32 v27, a243
    v_accvgpr_read_b32 v28, a244
    v_accvgpr_read_b32 v29, a245
    v_accvgpr_read_b32 v30, a246
    v_accvgpr_read_b32 v31, a247
    v_cvt_pk_bf16_f32 v24, v24, v25
    v_cvt_pk_bf16_f32 v25, v26, v27
    v_cvt_pk_bf16_f32 v26, v28, v29
    v_cvt_pk_bf16_f32 v27, v30, v31
    buffer_store_dwordx4 v[24:27], v2, s[8:11], s90 offen sc1
    s_add_u32 s90, s90, s100
    s_nop 1
    v_accvgpr_read_b32 v24, a248
    v_accvgpr_read_b32 v25, a249
    v_accvgpr_read_b32 v26, a250
    v_accvgpr_read_b32 v27, a251
    v_accvgpr_read_b32 v28, a252
    v_accvgpr_read_b32 v29, a253
    v_accvgpr_read_b32 v30, a254
    v_accvgpr_read_b32 v31, a255
    v_cvt_pk_bf16_f32 v24, v24, v25
    v_cvt_pk_bf16_f32 v25, v26, v27
    v_cvt_pk_bf16_f32 v26, v28, v29
    v_cvt_pk_bf16_f32 v27, v30, v31
    buffer_store_dwordx4 v[24:27], v2, s[8:11], s90 offen sc1
    s_add_u32 s90, s90, s100
    s_nop 1
    s_add_u32 s91, s91, s99
    s_setpc_b64 s[20:21]
m_epl66:
    s_mov_b32 s92, s97
    s_mov_b32 s93, s97
    s_cmp_eq_u32 s97, 0
    s_cbranch_scc1 m_ns267
    s_mov_b32 s90, s98
    v_pk_mul_f32 v[32:33], v[32:33], s[92:93]
    v_pk_mul_f32 v[34:35], v[34:35], s[92:93]
    v_pk_mul_f32 v[36:37], v[36:37], s[92:93]
    v_pk_mul_f32 v[38:39], v[38:39], s[92:93]
    v_cvt_pk_bf16_f32 v32, v32, v33
    v_cvt_pk_bf16_f32 v33, v34, v35
    v_cvt_pk_bf16_f32 v34, v36, v37
    v_cvt_pk_bf16_f32 v35, v38, v39
    buffer_store_dwordx4 v[32:35], v2, s[8:11], s90 offen sc1
    s_add_u32 s90, s90, s100
    v_pk_mul_f32 v[40:41], v[40:41], s[92:93]
    v_pk_mul_f32 v[42:43], v[42:43], s[92:93]
    v_pk_mul_f32 v[44:45], v[44:45], s[92:93]
    v_pk_mul_f32 v[46:47], v[46:47], s[92:93]
    v_cvt_pk_bf16_f32 v40, v40, v41
    v_cvt_pk_bf16_f32 v41, v42, v43
    v_cvt_pk_bf16_f32 v42, v44, v45
    v_cvt_pk_bf16_f32 v43, v46, v47
    buffer_store_dwordx4 v[40:43], v2, s[8:11], s90 offen sc1
    s_add_u32 s90, s90, s100
    v_pk_mul_f32 v[48:49], v[48:49], s[92:93]
    v_pk_mul_f32 v[50:51], v[50:51], s[92:93]
    v_pk_mul_f32 v[52:53], v[52:53], s[92:93]
    v_pk_mul_f32 v[54:55], v[54:55], s[92:93]
    v_cvt_pk_bf16_f32 v48, v48, v49
    v_cvt_pk_bf16_f32 v49, v50, v51
    v_cvt_pk_bf16_f32 v50, v52, v53
    v_cvt_pk_bf16_f32 v51, v54, v55
    buffer_store_dwordx4 v[48:51], v2, s[8:11], s90 offen sc1
    s_add_u32 s90, s90, s100
    v_pk_mul_f32 v[56:57], v[56:57], s[92:93]
    v_pk_mul_f32 v[58:59], v[58:59], s[92:93]
    v_pk_mul_f32 v[60:61], v[60:61], s[92:93]
    v_pk_mul_f32 v[62:63], v[62:63], s[92:93]
    v_cvt_pk_bf16_f32 v56, v56, v57
    v_cvt_pk_bf16_f32 v57, v58, v59
    v_cvt_pk_bf16_f32 v58, v60, v61
    v_cvt_pk_bf16_f32 v59, v62, v63
    buffer_store_dwordx4 v[56:59], v2, s[8:11], s90 offen sc1
    s_add_u32 s90, s90, s100
    v_pk_mul_f32 v[64:65], v[64:65], s[92:93]
    v_pk_mul_f32 v[66:67], v[66:67], s[92:93]
    v_pk_mul_f32 v[68:69], v[68:69], s[92:93]
    v_pk_mul_f32 v[70:71], v[70:71], s[92:93]
    v_cvt_pk_bf16_f32 v64, v64, v65
    v_cvt_pk_bf16_f32 v65, v66, v67
    v_cvt_pk_bf16_f32 v66, v68, v69
    v_cvt_pk_bf16_f32 v67, v70, v71
    buffer_store_dwordx4 v[64:67], v2, s[8:11], s90 offen sc1
    s_add_u32 s90, s90, s100
    v_pk_mul_f32 v[72:73], v[72:73], s[92:93]
    v_pk_mul_f32 v[74:75], v[74:75], s[92:93]
    v_pk_mul_f32 v[76:77], v[76:77], s[92:93]
    v_pk_mul_f32 v[78:79], v[78:79], s[92:93]
    v_cvt_pk_bf16_f32 v72, v72, v73
    v_cvt_pk_bf16_f32 v73, v74, v75
    v_cvt_pk_bf16_f32 v74, v76, v77
    v_cvt_pk_bf16_f32 v75, v78, v79
    buffer_store_dwordx4 v[72:75], v2, s[8:11], s90 offen sc1
    s_add_u32 s90, s90, s100
    v_pk_mul_f32 v[80:81], v[80:81], s[92:93]
    v_pk_mul_f32 v[82:83], v[82:83], s[92:93]
    v_pk_mul_f32 v[84:85], v[84:85], s[92:93]
    v_pk_mul_f32 v[86:87], v[86:87], s[92:93]
    v_cvt_pk_bf16_f32 v80, v80, v81
    v_cvt_pk_bf16_f32 v81, v82, v83
    v_cvt_pk_bf16_f32 v82, v84, v85
    v_cvt_pk_bf16_f32 v83, v86, v87
    buffer_store_dwordx4 v[80:83], v2, s[8:11], s90 offen sc1
    s_add_u32 s90, s90, s100
    v_pk_mul_f32 v[88:89], v[88:89], s[92:93]
    v_pk_mul_f32 v[90:91], v[90:91], s[92:93]
    v_pk_mul_f32 v[92:93], v[92:93], s[92:93]
    v_pk_mul_f32 v[94:95], v[94:95], s[92:93]
    v_cvt_pk_bf16_f32 v88, v88, v89
    v_cvt_pk_bf16_f32 v89, v90, v91
    v_cvt_pk_bf16_f32 v90, v92, v93
    v_cvt_pk_bf16_f32 v91, v94, v95
    buffer_store_dwordx4 v[88:91], v2, s[8:11], s90 offen sc1
    s_add_u32 s90, s98, s99
    v_pk_mul_f32 v[96:97], v[96:97], s[92:93]
    v_pk_mul_f32 v[98:99], v[98:99], s[92:93]
    v_pk_mul_f32 v[100:101], v[100:101], s[92:93]
    v_pk_mul_f32 v[102:103], v[102:103], s[92:93]
    v_cvt_pk_bf16_f32 v96, v96, v97
    v_cvt_pk_bf16_f32 v97, v98, v99
    v_cvt_pk_bf16_f32 v98, v100, v101
    v_cvt_pk_bf16_f32 v99, v102, v103
    buffer_store_dwordx4 v[96:99], v2, s[8:11], s90 offen sc1
    s_add_u32 s90, s90, s100
    v_pk_mul_f32 v[104:105], v[104:105], s[92:93]
    v_pk_mul_f32 v[106:107], v[106:107], s[92:93]
    v_pk_mul_f32 v[108:109], v[108:109], s[92:93]
    v_pk_mul_f32 v[110:111], v[110:111], s[92:93]
    v_cvt_pk_bf16_f32 v104, v104, v105
    v_cvt_pk_bf16_f32 v105, v106, v107
    v_cvt_pk_bf16_f32 v106, v108, v109
    v_cvt_pk_bf16_f32 v107, v110, v111
    buffer_store_dwordx4 v[104:107], v2, s[8:11], s90 offen sc1
    s_add_u32 s90, s90, s100
    v_pk_mul_f32 v[112:113], v[112:113], s[92:93]
    v_pk_mul_f32 v[114:115], v[114:115], s[92:93]
    v_pk_mul_f32 v[116:117], v[116:117], s[92:93]
    v_pk_mul_f32 v[118:119], v[118:119], s[92:93]
    v_cvt_pk_bf16_f32 v112, v112, v113
    v_cvt_pk_bf16_f32 v113, v114, v115
    v_cvt_pk_bf16_f32 v114, v116, v117
    v_cvt_pk_bf16_f32 v115, v118, v119
    buffer_store_dwordx4 v[112:115], v2, s[8:11], s90 offen sc1
    s_add_u32 s90, s90, s100
    v_pk_mul_f32 v[120:121], v[120:121], s[92:93]
    v_pk_mul_f32 v[122:123], v[122:123], s[92:93]
    v_pk_mul_f32 v[124:125], v[124:125], s[92:93]
    v_pk_mul_f32 v[126:127], v[126:127], s[92:93]
    v_cvt_pk_bf16_f32 v120, v120, v121
    v_cvt_pk_bf16_f32 v121, v122, v123
    v_cvt_pk_bf16_f32 v122, v124, v125
    v_cvt_pk_bf16_f32 v123, v126, v127
    buffer_store_dwordx4 v[120:123], v2, s[8:11], s90 offen sc1
    s_add_u32 s90, s90, s100
    v_pk_mul_f32 v[128:129], v[128:129], s[92:93]
    v_pk_mul_f32 v[130:131], v[130:131], s[92:93]
    v_pk_mul_f32 v[132:133], v[132:133], s[92:93]
    v_pk_mul_f32 v[134:135], v[134:135], s[92:93]
    v_cvt_pk_bf16_f32 v128, v128, v129
    v_cvt_pk_bf16_f32 v129, v130, v131
    v_cvt_pk_bf16_f32 v130, v132, v133
    v_cvt_pk_bf16_f32 v131, v134, v135
    buffer_store_dwordx4 v[128:131], v2, s[8:11], s90 offen sc1
    s_add_u32 s90, s90, s100
    v_pk_mul_f32 v[136:137], v[136:137], s[92:93]
    v_pk_mul_f32 v[138:139], v[138:139], s[92:93]
    v_pk_mul_f32 v[140:141], v[140:141], s[92:93]
    v_pk_mul_f32 v[142:143], v[142:143], s[92:93]
    v_cvt_pk_bf16_f32 v136, v136, v137
    v_cvt_pk_bf16_f32 v137, v138, v139
    v_cvt_pk_bf16_f32 v138, v140, v141
    v_cvt_pk_bf16_f32 v139, v142, v143
    buffer_store_dwordx4 v[136:139], v2, s[8:11], s90 offen sc1
    s_add_u32 s90, s90, s100
    v_pk_mul_f32 v[144:145], v[144:145], s[92:93]
    v_pk_mul_f32 v[146:147], v[146:147], s[92:93]
    v_pk_mul_f32 v[148:149], v[148:149], s[92:93]
    v_pk_mul_f32 v[150:151], v[150:151], s[92:93]
    v_cvt_pk_bf16_f32 v144, v144, v145
    v_cvt_pk_bf16_f32 v145, v146, v147
    v_cvt_pk_bf16_f32 v146, v148, v149
    v_cvt_pk_bf16_f32 v147, v150, v151
    buffer_store_dwordx4 v[144:147], v2, s[8:11], s90 offen sc1
    s_add_u32 s90, s90, s100
    v_pk_mul_f32 v[152:153], v[152:153], s[92:93]
    v_pk_mul_f32 v[154:155], v[154:155], s[92:93]
    v_pk_mul_f32 v[156:157], v[156:157], s[92:93]
    v_pk_mul_f32 v[158:159], v[158:159], s[92:93]
    v_cvt_pk_bf16_f32 v152, v152, v153
    v_cvt_pk_bf16_f32 v153, v154, v155
    v_cvt_pk_bf16_f32 v154, v156, v157
    v_cvt_pk_bf16_f32 v155, v158, v159
    buffer_store_dwordx4 v[152:155], v2, s[8:11], s90 offen sc1
    s_add_u32 s90, s90, s100
    v_pk_mul_f32 v[192:193], v[192:193], s[92:93]
    v_pk_mul_f32 v[194:195], v[194:195], s[92:93]
    v_pk_mul_f32 v[196:197], v[196:197], s[92:93]
    v_pk_mul_f32 v[198:199], v[198:199], s[92:93]
    v_cvt_pk_bf16_f32 v192, v192, v193
    v_cvt_pk_bf16_f32 v193, v194, v195
    v_cvt_pk_bf16_f32 v194, v196, v197
    v_cvt_pk_bf16_f32 v195, v198, v199
    v_pk_mul_f32 v[200:201], v[200:201], s[92:93]
    v_pk_mul_f32 v[202:203], v[202:203], s[92:93]
    v_pk_mul_f32 v[204:205], v[204:205], s[92:93]
    v_pk_mul_f32 v[206:207], v[206:207], s[92:93]
    v_cvt_pk_bf16_f32 v196, v200, v201
    v_cvt_pk_bf16_f32 v197, v202, v203
    v_cvt_pk_bf16_f32 v198, v204, v205
    v_cvt_pk_bf16_f32 v199, v206, v207
    v_pk_mul_f32 v[208:209], v[208:209], s[92:93]
    v_pk_mul_f32 v[210:211], v[210:211], s[92:93]
    v_pk_mul_f32 v[212:213], v[212:213], s[92:93]
    v_pk_mul_f32 v[214:215], v[214:215], s[92:93]
    v_cvt_pk_bf16_f32 v200, v208, v209
    v_cvt_pk_bf16_f32 v201, v210, v211
    v_cvt_pk_bf16_f32 v202, v212, v213
    v_cvt_pk_bf16_f32 v203, v214, v215
    v_pk_mul_f32 v[216:217], v[216:217], s[92:93]
    v_pk_mul_f32 v[218:219], v[218:219], s[92:93]
    v_pk_mul_f32 v[220:221], v[220:221], s[92:93]
    v_pk_mul_f32 v[222:223], v[222:223], s[92:93]
    v_cvt_pk_bf16_f32 v204, v216, v217
    v_cvt_pk_bf16_f32 v205, v218, v219
    v_cvt_pk_bf16_f32 v206, v220, v221
    v_cvt_pk_bf16_f32 v207, v222, v223
    v_pk_mul_f32 v[224:225], v[224:225], s[92:93]
    v_pk_mul_f32 v[226:227], v[226:227], s[92:93]
    v_pk_mul_f32 v[228:229], v[228:229], s[92:93]
    v_pk_mul_f32 v[230:231], v[230:231], s[92:93]
    v_cvt_pk_bf16_f32 v208, v224, v225
    v_cvt_pk_bf16_f32 v209, v226, v227
    v_cvt_pk_bf16_f32 v210, v228, v229
    v_cvt_pk_bf16_f32 v211, v230, v231
    v_pk_mul_f32 v[232:233], v[232:233], s[92:93]
    v_pk_mul_f32 v[234:235], v[234:235], s[92:93]
    v_pk_mul_f32 v[236:237], v[236:237], s[92:93]
    v_pk_mul_f32 v[238:239], v[238:239], s[92:93]
    v_cvt_pk_bf16_f32 v212, v232, v233
    v_cvt_pk_bf16_f32 v213, v234, v235
    v_cvt_pk_bf16_f32 v214, v236, v237
    v_cvt_pk_bf16_f32 v215, v238, v239
    v_pk_mul_f32 v[240:241], v[240:241], s[92:93]
    v_pk_mul_f32 v[242:243], v[242:243], s[92:93]
    v_pk_mul_f32 v[244:245], v[244:245], s[92:93]
    v_pk_mul_f32 v[246:247], v[246:247], s[92:93]
    v_cvt_pk_bf16_f32 v216, v240, v241
    v_cvt_pk_bf16_f32 v217, v242, v243
    v_cvt_pk_bf16_f32 v218, v244, v245
    v_cvt_pk_bf16_f32 v219, v246, v247
    v_pk_mul_f32 v[248:249], v[248:249], s[92:93]
    v_pk_mul_f32 v[250:251], v[250:251], s[92:93]
    v_pk_mul_f32 v[252:253], v[252:253], s[92:93]
    v_pk_mul_f32 v[254:255], v[254:255], s[92:93]
    v_cvt_pk_bf16_f32 v220, v248, v249
    v_cvt_pk_bf16_f32 v221, v250, v251
    v_cvt_pk_bf16_f32 v222, v252, v253
    v_cvt_pk_bf16_f32 v223, v254, v255
    v_accvgpr_read_b32 v24, a224
    v_accvgpr_read_b32 v25, a225
    v_accvgpr_read_b32 v26, a226
    v_accvgpr_read_b32 v27, a227
    v_accvgpr_read_b32 v28, a228
    v_accvgpr_read_b32 v29, a229
    v_accvgpr_read_b32 v30, a230
    v_accvgpr_read_b32 v31, a231
    v_pk_mul_f32 v[24:25], v[24:25], s[92:93]
    v_pk_mul_f32 v[26:27], v[26:27], s[92:93]
    v_pk_mul_f32 v[28:29], v[28:29], s[92:93]
    v_pk_mul_f32 v[30:31], v[30:31], s[92:93]
    v_cvt_pk_bf16_f32 v224, v24, v25
    v_cvt_pk_bf16_f32 v225, v26, v27
    v_cvt_pk_bf16_f32 v226, v28, v29
    v_cvt_pk_bf16_f32 v227, v30, v31
    v_accvgpr_read_b32 v24, a232
    v_accvgpr_read_b32 v25, a233
    v_accvgpr_read_b32 v26, a234
    v_accvgpr_read_b32 v27, a235
    v_accvgpr_read_b32 v28, a236
    v_accvgpr_read_b32 v29, a237
    v_accvgpr_read_b32 v30, a238
    v_accvgpr_read_b32 v31, a239
    v_pk_mul_f32 v[24:25], v[24:25], s[92:93]
    v_pk_mul_f32 v[26:27], v[26:27], s[92:93]
    v_pk_mul_f32 v[28:29], v[28:29], s[92:93]
    v_pk_mul_f32 v[30:31], v[30:31], s[92:93]
    v_cvt_pk_bf16_f32 v228, v24, v25
    v_cvt_pk_bf16_f32 v229, v26, v27
    v_cvt_pk_bf16_f32 v230, v28, v29
    v_cvt_pk_bf16_f32 v231, v30, v31
    v_accvgpr_read_b32 v24, a240
    v_accvgpr_read_b32 v25, a241
    v_accvgpr_read_b32 v26, a242
    v_accvgpr_read_b32 v27, a243
    v_accvgpr_read_b32 v28, a244
    v_accvgpr_read_b32 v29, a245
    v_accvgpr_read_b32 v30, a246
    v_accvgpr_read_b32 v31, a247
    v_pk_mul_f32 v[24:25], v[24:25], s[92:93]
    v_pk_mul_f32 v[26:27], v[26:27], s[92:93]
    v_pk_mul_f32 v[28:29], v[28:29], s[92:93]
    v_pk_mul_f32 v[30:31], v[30:31], s[92:93]
    v_cvt_pk_bf16_f32 v232, v24, v25
    v_cvt_pk_bf16_f32 v233, v26, v27
    v_cvt_pk_bf16_f32 v234, v28, v29
    v_cvt_pk_bf16_f32 v235, v30, v31
    v_accvgpr_read_b32 v24, a248
    v_accvgpr_read_b32 v25, a249
    v_accvgpr_read_b32 v26, a250
    v_accvgpr_read_b32 v27, a251
    v_accvgpr_read_b32 v28, a252
    v_accvgpr_read_b32 v29, a253
    v_accvgpr_read_b32 v30, a254
    v_accvgpr_read_b32 v31, a255
    v_pk_mul_f32 v[24:25], v[24:25], s[92:93]
    v_pk_mul_f32 v[26:27], v[26:27], s[92:93]
    v_pk_mul_f32 v[28:29], v[28:29], s[92:93]
    v_pk_mul_f32 v[30:31], v[30:31], s[92:93]
    v_cvt_pk_bf16_f32 v236, v24, v25
    v_cvt_pk_bf16_f32 v237, v26, v27
    v_cvt_pk_bf16_f32 v238, v28, v29
    v_cvt_pk_bf16_f32 v239, v30, v31
    v_pk_mul_f32 v[160:161], v[160:161], s[92:93]
    v_pk_mul_f32 v[162:163], v[162:163], s[92:93]
    v_pk_mul_f32 v[164:165], v[164:165], s[92:93]
    v_pk_mul_f32 v[166:167], v[166:167], s[92:93]
    v_cvt_pk_bf16_f32 v240, v160, v161
    v_cvt_pk_bf16_f32 v241, v162, v163
    v_cvt_pk_bf16_f32 v242, v164, v165
    v_cvt_pk_bf16_f32 v243, v166, v167
    v_pk_mul_f32 v[168:169], v[168:169], s[92:93]
    v_pk_mul_f32 v[170:171], v[170:171], s[92:93]
    v_pk_mul_f32 v[172:173], v[172:173], s[92:93]
    v_pk_mul_f32 v[174:175], v[174:175], s[92:93]
    v_cvt_pk_bf16_f32 v244, v168, v169
    v_cvt_pk_bf16_f32 v245, v170, v171
    v_cvt_pk_bf16_f32 v246, v172, v173
    v_cvt_pk_bf16_f32 v247, v174, v175
    v_pk_mul_f32 v[176:177], v[176:177], s[92:93]
    v_pk_mul_f32 v[178:179], v[178:179], s[92:93]
    v_pk_mul_f32 v[180:181], v[180:181], s[92:93]
    v_pk_mul_f32 v[182:183], v[182:183], s[92:93]
    v_cvt_pk_bf16_f32 v248, v176, v177
    v_cvt_pk_bf16_f32 v249, v178, v179
    v_cvt_pk_bf16_f32 v250, v180, v181
    v_cvt_pk_bf16_f32 v251, v182, v183
    v_pk_mul_f32 v[184:185], v[184:185], s[92:93]
    v_pk_mul_f32 v[186:187], v[186:187], s[92:93]
    v_pk_mul_f32 v[188:189], v[188:189], s[92:93]
    v_pk_mul_f32 v[190:191], v[190:191], s[92:93]
    v_cvt_pk_bf16_f32 v252, v184, v185
    v_cvt_pk_bf16_f32 v253, v186, v187
    v_cvt_pk_bf16_f32 v254, v188, v189
    v_cvt_pk_bf16_f32 v255, v190, v191
    s_setpc_b64 s[20:21]
m_ns267:
    s_mov_b32 s90, s98
    v_cvt_pk_bf16_f32 v32, v32, v33
    v_cvt_pk_bf16_f32 v33, v34, v35
    v_cvt_pk_bf16_f32 v34, v36, v37
    v_cvt_pk_bf16_f32 v35, v38, v39
    buffer_store_dwordx4 v[32:35], v2, s[8:11], s90 offen sc1
    s_add_u32 s90, s90, s100
    v_cvt_pk_bf16_f32 v40, v40, v41
    v_cvt_pk_bf16_f32 v41, v42, v43
    v_cvt_pk_bf16_f32 v42, v44, v45
    v_cvt_pk_bf16_f32 v43, v46, v47
    buffer_store_dwordx4 v[40:43], v2, s[8:11], s90 offen sc1
    s_add_u32 s90, s90, s100
    v_cvt_pk_bf16_f32 v48, v48, v49
    v_cvt_pk_bf16_f32 v49, v50, v51
    v_cvt_pk_bf16_f32 v50, v52, v53
    v_cvt_pk_bf16_f32 v51, v54, v55
    buffer_store_dwordx4 v[48:51], v2, s[8:11], s90 offen sc1
    s_add_u32 s90, s90, s100
    v_cvt_pk_bf16_f32 v56, v56, v57
    v_cvt_pk_bf16_f32 v57, v58, v59
    v_cvt_pk_bf16_f32 v58, v60, v61
    v_cvt_pk_bf16_f32 v59, v62, v63
    buffer_store_dwordx4 v[56:59], v2, s[8:11], s90 offen sc1
    s_add_u32 s90, s90, s100
    v_cvt_pk_bf16_f32 v64, v64, v65
    v_cvt_pk_bf16_f32 v65, v66, v67
    v_cvt_pk_bf16_f32 v66, v68, v69
    v_cvt_pk_bf16_f32 v67, v70, v71
    buffer_store_dwordx4 v[64:67], v2, s[8:11], s90 offen sc1
    s_add_u32 s90, s90, s100
    v_cvt_pk_bf16_f32 v72, v72, v73
    v_cvt_pk_bf16_f32 v73, v74, v75
    v_cvt_pk_bf16_f32 v74, v76, v77
    v_cvt_pk_bf16_f32 v75, v78, v79
    buffer_store_dwordx4 v[72:75], v2, s[8:11], s90 offen sc1
    s_add_u32 s90, s90, s100
    v_cvt_pk_bf16_f32 v80, v80, v81
    v_cvt_pk_bf16_f32 v81, v82, v83
    v_cvt_pk_bf16_f32 v82, v84, v85
    v_cvt_pk_bf16_f32 v83, v86, v87
    buffer_store_dwordx4 v[80:83], v2, s[8:11], s90 offen sc1
    s_add_u32 s90, s90, s100
    v_cvt_pk_bf16_f32 v88, v88, v89
    v_cvt_pk_bf16_f32 v89, v90, v91
    v_cvt_pk_bf16_f32 v90, v92, v93
    v_cvt_pk_bf16_f32 v91, v94, v95
    buffer_store_dwordx4 v[88:91], v2, s[8:11], s90 offen sc1
    s_add_u32 s90, s98, s99
    v_cvt_pk_bf16_f32 v96, v96, v97
    v_cvt_pk_bf16_f32 v97, v98, v99
    v_cvt_pk_bf16_f32 v98, v100, v101
    v_cvt_pk_bf16_f32 v99, v102, v103
    buffer_store_dwordx4 v[96:99], v2, s[8:11], s90 offen sc1
    s_add_u32 s90, s90, s100
    v_cvt_pk_bf16_f32 v104, v104, v105
    v_cvt_pk_bf16_f32 v105, v106, v107
    v_cvt_pk_bf16_f32 v106, v108, v109
    v_cvt_pk_bf16_f32 v107, v110, v111
    buffer_store_dwordx4 v[104:107], v2, s[8:11], s90 offen sc1
    s_add_u32 s90, s90, s100
    v_cvt_pk_bf16_f32 v112, v112, v113
    v_cvt_pk_bf16_f32 v113, v114, v115
    v_cvt_pk_bf16_f32 v114, v116, v117
    v_cvt_pk_bf16_f32 v115, v118, v119
    buffer_store_dwordx4 v[112:115], v2, s[8:11], s90 offen sc1
    s_add_u32 s90, s90, s100
    v_cvt_pk_bf16_f32 v120, v120, v121
    v_cvt_pk_bf16_f32 v121, v122, v123
    v_cvt_pk_bf16_f32 v122, v124, v125
    v_cvt_pk_bf16_f32 v123, v126, v127
    buffer_store_dwordx4 v[120:123], v2, s[8:11], s90 offen sc1
    s_add_u32 s90, s90, s100
    v_cvt_pk_bf16_f32 v128, v128, v129
    v_cvt_pk_bf16_f32 v129, v130, v131
    v_cvt_pk_bf16_f32 v130, v132, v133
    v_cvt_pk_bf16_f32 v131, v134, v135
    buffer_store_dwordx4 v[128:131], v2, s[8:11], s90 offen sc1
    s_add_u32 s90, s90, s100
    v_cvt_pk_bf16_f32 v136, v136, v137
    v_cvt_pk_bf16_f32 v137, v138, v139
    v_cvt_pk_bf16_f32 v138, v140, v141
    v_cvt_pk_bf16_f32 v139, v142, v143
    buffer_store_dwordx4 v[136:139], v2, s[8:11], s90 offen sc1
    s_add_u32 s90, s90, s100
    v_cvt_pk_bf16_f32 v144, v144, v145
    v_cvt_pk_bf16_f32 v145, v146, v147
    v_cvt_pk_bf16_f32 v146, v148, v149
    v_cvt_pk_bf16_f32 v147, v150, v151
    buffer_store_dwordx4 v[144:147], v2, s[8:11], s90 offen sc1
    s_add_u32 s90, s90, s100
    v_cvt_pk_bf16_f32 v152, v152, v153
    v_cvt_pk_bf16_f32 v153, v154, v155
    v_cvt_pk_bf16_f32 v154, v156, v157
    v_cvt_pk_bf16_f32 v155, v158, v159
    buffer_store_dwordx4 v[152:155], v2, s[8:11], s90 offen sc1
    s_add_u32 s90, s90, s100
    v_cvt_pk_bf16_f32 v192, v192, v193
    v_cvt_pk_bf16_f32 v193, v194, v195
    v_cvt_pk_bf16_f32 v194, v196, v197
    v_cvt_pk_bf16_f32 v195, v198, v199
    v_cvt_pk_bf16_f32 v196, v200, v201
    v_cvt_pk_bf16_f32 v197, v202, v203
    v_cvt_pk_bf16_f32 v198, v204, v205
    v_cvt_pk_bf16_f32 v199, v206, v207
    v_cvt_pk_bf16_f32 v200, v208, v209
    v_cvt_pk_bf16_f32 v201, v210, v211
    v_cvt_pk_bf16_f32 v202, v212, v213
    v_cvt_pk_bf16_f32 v203, v214, v215
    v_cvt_pk_bf16_f32 v204, v216, v217
    v_cvt_pk_bf16_f32 v205, v218, v219
    v_cvt_pk_bf16_f32 v206, v220, v221
    v_cvt_pk_bf16_f32 v207, v222, v223
    v_cvt_pk_bf16_f32 v208, v224, v225
    v_cvt_pk_bf16_f32 v209, v226, v227
    v_cvt_pk_bf16_f32 v210, v228, v229
    v_cvt_pk_bf16_f32 v211, v230, v231
    v_cvt_pk_bf16_f32 v212, v232, v233
    v_cvt_pk_bf16_f32 v213, v234, v235
    v_cvt_pk_bf16_f32 v214, v236, v237
    v_cvt_pk_bf16_f32 v215, v238, v239
    v_cvt_pk_bf16_f32 v216, v240, v241
    v_cvt_pk_bf16_f32 v217, v242, v243
    v_cvt_pk_bf16_f32 v218, v244, v245
    v_cvt_pk_bf16_f32 v219, v246, v247
    v_cvt_pk_bf16_f32 v220, v248, v249
    v_cvt_pk_bf16_f32 v221, v250, v251
    v_cvt_pk_bf16_f32 v222, v252, v253
    v_cvt_pk_bf16_f32 v223, v254, v255
    v_accvgpr_read_b32 v24, a224
    v_accvgpr_read_b32 v25, a225
    v_accvgpr_read_b32 v26, a226
    v_accvgpr_read_b32 v27, a227
    v_accvgpr_read_b32 v28, a228
    v_accvgpr_read_b32 v29, a229
    v_accvgpr_read_b32 v30, a230
    v_accvgpr_read_b32 v31, a231
    v_cvt_pk_bf16_f32 v224, v24, v25
    v_cvt_pk_bf16_f32 v225, v26, v27
    v_cvt_pk_bf16_f32 v226, v28, v29
    v_cvt_pk_bf16_f32 v227, v30, v31
    v_accvgpr_read_b32 v24, a232
    v_accvgpr_read_b32 v25, a233
    v_accvgpr_read_b32 v26, a234
    v_accvgpr_read_b32 v27, a235
    v_accvgpr_read_b32 v28, a236
    v_accvgpr_read_b32 v29, a237
    v_accvgpr_read_b32 v30, a238
    v_accvgpr_read_b32 v31, a239
    v_cvt_pk_bf16_f32 v228, v24, v25
    v_cvt_pk_bf16_f32 v229, v26, v27
    v_cvt_pk_bf16_f32 v230, v28, v29
    v_cvt_pk_bf16_f32 v231, v30, v31
    v_accvgpr_read_b32 v24, a240
    v_accvgpr_read_b32 v25, a241
    v_accvgpr_read_b32 v26, a242
    v_accvgpr_read_b32 v27, a243
    v_accvgpr_read_b32 v28, a244
    v_accvgpr_read_b32 v29, a245
    v_accvgpr_read_b32 v30, a246
    v_accvgpr_read_b32 v31, a247
    v_cvt_pk_bf16_f32 v232, v24, v25
    v_cvt_pk_bf16_f32 v233, v26, v27
    v_cvt_pk_bf16_f32 v234, v28, v29
    v_cvt_pk_bf16_f32 v235, v30, v31
    v_accvgpr_read_b32 v24, a248
    v_accvgpr_read_b32 v25, a249
    v_accvgpr_read_b32 v26, a250
    v_accvgpr_read_b32 v27, a251
    v_accvgpr_read_b32 v28, a252
    v_accvgpr_read_b32 v29, a253
    v_accvgpr_read_b32 v30, a254
    v_accvgpr_read_b32 v31, a255
    v_cvt_pk_bf16_f32 v236, v24, v25
    v_cvt_pk_bf16_f32 v237, v26, v27
    v_cvt_pk_bf16_f32 v238, v28, v29
    v_cvt_pk_bf16_f32 v239, v30, v31
    v_cvt_pk_bf16_f32 v240, v160, v161
    v_cvt_pk_bf16_f32 v241, v162, v163
    v_cvt_pk_bf16_f32 v242, v164, v165
    v_cvt_pk_bf16_f32 v243, v166, v167
    v_cvt_pk_bf16_f32 v244, v168, v169
    v_cvt_pk_bf16_f32 v245, v170, v171
    v_cvt_pk_bf16_f32 v246, v172, v173
    v_cvt_pk_bf16_f32 v247, v174, v175
    v_cvt_pk_bf16_f32 v248, v176, v177
    v_cvt_pk_bf16_f32 v249, v178, v179
    v_cvt_pk_bf16_f32 v250, v180, v181
    v_cvt_pk_bf16_f32 v251, v182, v183
    v_cvt_pk_bf16_f32 v252, v184, v185
    v_cvt_pk_bf16_f32 v253, v186, v187
    v_cvt_pk_bf16_f32 v254, v188, v189
    v_cvt_pk_bf16_f32 v255, v190, v191
    s_setpc_b64 s[20:21]
m_pf7:
    s_mov_b32 s15, 0x20000
    s_sub_u32 s93, s2, 224
    s_lshl_b32 s93, s93, 2
    s_add_u32 s93, s93, s16
    v_lshlrev_b32 v24, 7, v1
    v_lshrrev_b32 v25, 3, v1
    v_lshlrev_b32 v25, 11, v25
    v_and_b32 v26, 7, v1
    v_lshl_add_u32 v25, v26, 7, v25
    s_lshl_b32 s92, s93, 13
    s_lshl_b32 s93, s93, 14
    s_add_u32 s93, s93, 1024
    v_lshrrev_b32 v25, 2, v1
    v_lshlrev_b32 v25, 11, v25
    v_and_b32 v26, 3, v1
    v_lshl_add_u32 v25, v26, 7, v25
    s_lshl_b32 s93, s92, 2
    s_mov_b32 s12, s34
    s_mov_b32 s13, s35
    s_mov_b32 s14, 8388608
    s_add_u32 s90, s92, 1048576
    buffer_load_dword v22, v24, s[12:15], s90 offen
    s_add_u32 s90, s92, 2097152
    buffer_load_dword v22, v24, s[12:15], s90 offen
    s_mov_b32 s12, s30
    s_mov_b32 s13, s31
    s_mov_b32 s14, 4194304
    s_add_u32 s90, s93, 512
    buffer_load_dword v22, v25, s[12:15], s90 offen
    s_mov_b32 s12, s34
    s_mov_b32 s13, s35
    s_mov_b32 s14, 8388608
    s_add_u32 s90, s92, 3145728
    buffer_load_dword v22, v24, s[12:15], s90 offen
    s_add_u32 s90, s92, 4194304
    buffer_load_dword v22, v24, s[12:15], s90 offen
    s_mov_b32 s12, s30
    s_mov_b32 s13, s31
    s_mov_b32 s14, 4194304
    s_add_u32 s90, s93, 1024
    buffer_load_dword v22, v25, s[12:15], s90 offen
    s_mov_b32 s12, s34
    s_mov_b32 s13, s35
    s_mov_b32 s14, 8388608
    s_add_u32 s90, s92, 5242880
    buffer_load_dword v22, v24, s[12:15], s90 offen
    s_mov_b32 s12, s26
    s_mov_b32 s13, s27
    s_mov_b32 s14, 6291456
    s_add_u32 s90, s92, 0
    buffer_load_dword v22, v24, s[12:15], s90 offen
    s_mov_b32 s12, s24
    s_mov_b32 s13, s25
    s_mov_b32 s14, 4194304
    s_add_u32 s90, s93, 0
    buffer_load_dword v22, v25, s[12:15], s90 offen
    s_mov_b32 s12, s34
    s_mov_b32 s13, s35
    s_mov_b32 s14, 8388608
    s_add_u32 s90, s92, 6291456
    buffer_load_dword v22, v24, s[12:15], s90 offen
    s_mov_b32 s12, s30
    s_mov_b32 s13, s31
    s_mov_b32 s14, 4194304
    s_add_u32 s90, s93, 1536
    buffer_load_dword v22, v25, s[12:15], s90 offen
    s_mov_b32 s12, s26
    s_mov_b32 s13, s27
    s_mov_b32 s14, 6291456
    s_add_u32 s90, s92, 1048576
    buffer_load_dword v22, v24, s[12:15], s90 offen
    s_mov_b32 s12, s24
    s_mov_b32 s13, s25
    s_mov_b32 s14, 4194304
    s_add_u32 s90, s93, 512
    buffer_load_dword v22, v25, s[12:15], s90 offen
    s_mov_b32 s12, s34
    s_mov_b32 s13, s35
    s_mov_b32 s14, 8388608
    s_add_u32 s90, s92, 7340032
    buffer_load_dword v22, v24, s[12:15], s90 offen
    s_mov_b32 s12, s26
    s_mov_b32 s13, s27
    s_mov_b32 s14, 6291456
    s_add_u32 s90, s92, 2097152
    buffer_load_dword v22, v24, s[12:15], s90 offen
    s_add_u32 s90, s92, 3145728
    buffer_load_dword v22, v24, s[12:15], s90 offen
    s_mov_b32 s12, s24
    s_mov_b32 s13, s25
    s_mov_b32 s14, 4194304
    s_add_u32 s90, s93, 1024
    buffer_load_dword v22, v25, s[12:15], s90 offen
    s_mov_b32 s12, s26
    s_mov_b32 s13, s27
    s_mov_b32 s14, 6291456
    s_add_u32 s90, s92, 4194304
    buffer_load_dword v22, v24, s[12:15], s90 offen
    s_mov_b32 s12, s24
    s_mov_b32 s13, s25
    s_mov_b32 s14, 4194304
    s_add_u32 s90, s93, 1536
    buffer_load_dword v22, v25, s[12:15], s90 offen
    s_mov_b32 s12, s26
    s_mov_b32 s13, s27
    s_mov_b32 s14, 6291456
    s_add_u32 s90, s92, 5242880
    buffer_load_dword v22, v24, s[12:15], s90 offen
    s_mov_b32 s12, s32
    s_mov_b32 s13, s33
    s_mov_b32 s14, 2097152
    s_add_u32 s90, s92, 1048576
    buffer_load_dword v22, v24, s[12:15], s90 offen
    s_branch m_nopf6
concat_heads__sliding_local_dilated__compressed_kv_cla__prompt_kernel_end:
.section .rodata,"a"
.p2align 6
.amdhsa_kernel concat_heads__sliding_local_dilated__compressed_kv_cla__prompt_kernel
  .amdhsa_next_free_vgpr 512
  .amdhsa_next_free_sgpr 102
  .amdhsa_accum_offset 256
  .amdhsa_group_segment_fixed_size 0
  .amdhsa_kernarg_size 96
  .amdhsa_user_sgpr_count 2
  .amdhsa_user_sgpr_kernarg_segment_ptr 1
  .amdhsa_system_sgpr_workgroup_id_x 1
.end_amdhsa_kernel
```

```asm
; @launch grid=(256,1,1) block=(256,1,1) lds=163840
.amdgcn_target "amdgcn-amd-amdhsa--gfx950"
.text
.globl concat_heads__sliding_local_dilated__compressed_kv_cla__prompt_kernel
.p2align 8
.type concat_heads__sliding_local_dilated__compressed_kv_cla__prompt_kernel,@function
concat_heads__sliding_local_dilated__compressed_kv_cla__prompt_kernel:
    s_cmp_ge_u32 s2, 256
    s_cbranch_scc1 m_end1
    s_load_dwordx16 s[24:39], s[0:1], 0
    s_load_dwordx4 s[4:7], s[0:1], 80
    v_and_b32 v1, 63, v0
    v_lshrrev_b32 v24, 6, v0
    s_nop 0
    v_readfirstlane_b32 s16, v24
    s_lshr_b32 s68, s2, 3
    s_lshr_b32 s57, s16, 1
    s_and_b32 s58, s16, 1
    s_mov_b32 s43, 0x20000
    s_mov_b32 s47, 0x20000
    s_cmp_lt_u32 s68, 28
    s_cbranch_scc1 m_ncp2
    s_sub_u32 s91, s68, 28
    s_lshl_b32 s91, s91, 2
    s_add_u32 s91, s91, s16
    s_getpc_b64 s[8:9]
m_pc3:
    s_sub_u32 s8, s8, m_pc3-concat_heads__sliding_local_dilated__compressed_kv_cla__prompt_kernel
    s_subb_u32 s9, s9, 0
    s_mov_b32 s10, concat_heads__sliding_local_dilated__compressed_kv_cla__prompt_kernel_end-concat_heads__sliding_local_dilated__compressed_kv_cla__prompt_kernel
    s_mov_b32 s11, 0x20000
    s_lshl_b32 s90, s91, 13
    v_lshlrev_b32 v24, 7, v1
    buffer_load_dword v22, v24, s[8:11], s90 offen
m_ncp2:
    s_lshl_b32 s61, s16, 13
    s_add_u32 s62, s61, 98304
    s_cmp_ge_u32 s68, 16
    s_cbranch_scc1 m_typea4
    s_and_b32 s69, s68, 3
    s_and_b32 s90, s2, 1
    s_lshl_b32 s90, s90, 2
    s_add_u32 s69, s69, s90
    s_bfe_u32 s90, s2, 0x20001
    s_mul_i32 s90, s90, 4
    s_bfe_u32 s91, s68, 0x20002
    s_add_u32 s90, s90, s91
    s_mov_b32 s76, 8388608
    s_mov_b32 s78, 8192
    s_mov_b32 s81, 0
    s_mov_b32 s73, 4194304
    s_mov_b32 s77, 2048
    s_mov_b32 s82, 16
    s_lshl_b32 s80, s90, 9
    s_lshl_b32 s79, s69, 19
    s_lshl_b32 s88, s90, 4
    s_add_u32 s88, s88, s69
    s_lshl_b32 s88, s88, 3
    s_mov_b32 s83, 0
    s_mov_b32 s84, 1040356334
    s_lshl_b32 s91, s90, 1
    s_add_u32 s91, s91, s58
    s_lshl_b32 s91, s91, 19
    s_lshl_b32 s92, s69, 1
    s_add_u32 s92, s92, s57
    s_lshl_b32 s92, s92, 15
    s_add_u32 s85, s91, s92
    s_add_u32 s85, s85, 0
    s_mov_b32 s86, 1024
    s_mov_b32 s87, 4096
    s_branch m_go15
m_typea4:
    s_bfe_u32 s69, s68, 0x20002
    s_add_u32 s69, s69, 0
    s_and_b32 s90, s2, 7
    s_lshl_b32 s90, s90, 2
    s_and_b32 s91, s68, 3
    s_add_u32 s90, s90, s91
    s_cmp_lt_u32 s90, 16
    s_cselect_b32 s83, 0, 1
    s_mov_b32 s91, 33554432
    s_cselect_b32 s85, 16777216, s91
    s_mov_b32 s91, 8192
    s_cselect_b32 s86, 1024, s91
    s_mov_b32 s91, 1024
    s_cselect_b32 s87, 4096, s91
    s_mov_b32 s73, 2097152
    s_mov_b32 s77, 1024
    s_mov_b32 s82, 8
    s_mov_b32 s81, 0
    s_mov_b32 s76, 4194304
    s_mov_b32 s78, 8192
    s_mov_b32 s84, 0
    s_and_b32 s90, s90, 15
    s_lshl_b32 s80, s90, 9
    s_lshl_b32 s79, s69, 18
    s_lshl_b32 s91, s83, 2
    s_add_u32 s91, s91, s69
    s_cmp_ge_u32 s69, 4
    s_cselect_b32 s92, 508, 8
    s_add_u32 s91, s91, s92
    s_lshl_b32 s88, s90, 4
    s_add_u32 s88, s88, s91
    s_lshl_b32 s88, s88, 3
    s_lshl_b32 s91, s90, 1
    s_add_u32 s91, s91, s58
    s_lshl_b32 s91, s91, 19
    s_lshl_b32 s92, s69, 1
    s_add_u32 s92, s92, s57
    s_lshl_b32 s92, s92, 15
    s_add_u32 s85, s85, s91
    s_add_u32 s85, s85, s92
m_go15:
    s_mov_b32 s42, s73
    s_lshl_b32 s90, s77, 4
    s_lshl_b32 s90, s90, s81
    s_mov_b32 s48, s79
    s_mul_i32 s91, s90, 1
    s_add_u32 s49, s91, s79
    s_sub_u32 s49, s49, 2048
    s_mul_i32 s91, s90, 2
    s_add_u32 s50, s91, s79
    s_mul_i32 s91, s90, 3
    s_add_u32 s51, s91, s79
    s_sub_u32 s51, s51, 2048
    s_lshl_b32 s90, s58, 7
    s_add_u32 s90, s90, s57
    s_lshl_b32 s91, s16, 6
    s_cmp_eq_u32 s81, 1
    s_cselect_b32 s90, s90, s91
    v_lshrrev_b32 v24, 3, v1
    v_lshlrev_b32 v24, s81, v24
    v_add_u32 v24, s90, v24
    v_mul_lo_u32 v24, v24, s77
    v_lshrrev_b32 v25, 4, v1
    v_and_b32 v26, 7, v1
    v_xor_b32 v25, v25, v26
    v_lshl_add_u32 v16, v25, 4, v24
    v_xor_b32 v25, 4, v25
    v_lshl_add_u32 v17, v25, 4, v24
    s_lshl_b32 s90, s77, 3
    s_lshl_b32 s90, s90, s81
    s_sub_u32 s90, s90, 1024
    v_add_u32 v17, s90, v17
    s_mov_b32 s46, s76
    s_mov_b32 s52, s80
    s_lshl_b32 s90, s78, 2
    s_mul_i32 s91, s90, 1
    s_add_u32 s53, s91, s80
    s_sub_u32 s53, s53, 2048
    s_mul_i32 s91, s90, 2
    s_add_u32 s54, s91, s80
    s_mul_i32 s91, s90, 3
    s_add_u32 s55, s91, s80
    s_sub_u32 s55, s55, 2048
    s_lshl_b32 s56, s78, 6
    v_lshrrev_b32 v24, 5, v1
    s_lshl_b32 s90, s16, 4
    v_add_u32 v25, s90, v24
    v_mul_lo_u32 v25, v25, s78
    v_lshlrev_b32 v24, 1, v24
    v_and_b32 v26, 31, v1
    v_xor_b32 v24, v24, v26
    s_lshl_b32 s90, s78, 1
    s_sub_u32 s90, s90, 1024
    v_add_u32 v27, s90, v25
    v_xor_b32 v26, 0, v24
    v_lshl_add_u32 v18, v26, 4, v25
    v_xor_b32 v26, 4, v24
    v_lshl_add_u32 v19, v26, 4, v27
    v_xor_b32 v26, 8, v24
    v_lshl_add_u32 v20, v26, 4, v25
    v_xor_b32 v26, 12, v24
    v_lshl_add_u32 v21, v26, 4, v27
    s_cmp_eq_u32 s83, 0
    s_waitcnt lgkmcnt(0)
    s_cselect_b32 s44, s36, s38
    s_cselect_b32 s45, s37, s39
    s_cmp_lt_u32 s68, 16
    s_cselect_b32 s44, s34, s44
    s_cselect_b32 s45, s35, s45
    s_cselect_b32 s40, s30, s32
    s_cselect_b32 s41, s31, s33
    s_cmp_ge_u32 s68, 28
    s_cselect_b32 s70, 1, 0
    s_cbranch_scc1 m_pf7
m_nopf6:
    s_add_u32 m0, s61, 0
    s_nop 0
    buffer_load_dwordx4 v16, s[40:43], s48 offen offset:0 sc1 lds
    buffer_load_dwordx4 v17, s[40:43], s48 offen offset:1024 sc1 lds
    s_add_u32 s48, s48, 128
    buffer_load_dwordx4 v16, s[40:43], s49 offen offset:2048 sc1 lds
    buffer_load_dwordx4 v17, s[40:43], s49 offen offset:3072 sc1 lds
    s_add_u32 s49, s49, 128
    s_add_u32 m0, s61, 4096
    s_nop 0
    buffer_load_dwordx4 v16, s[40:43], s50 offen offset:0 sc1 lds
    buffer_load_dwordx4 v17, s[40:43], s50 offen offset:1024 sc1 lds
    s_add_u32 s50, s50, 128
    buffer_load_dwordx4 v16, s[40:43], s51 offen offset:2048 sc1 lds
    buffer_load_dwordx4 v17, s[40:43], s51 offen offset:3072 sc1 lds
    s_add_u32 s51, s51, 128
    s_add_u32 s61, s61, 32768
    s_cmp_ge_u32 s61, 98304
    s_cselect_b32 s90, 98304, 0
    s_sub_u32 s61, s61, s90
    s_add_u32 m0, s62, 0
    s_nop 0
    buffer_load_dwordx4 v18, s[44:47], s52 offen offset:0 sc1 lds
    buffer_load_dwordx4 v19, s[44:47], s52 offen offset:1024 sc1 lds
    s_add_u32 s52, s52, s56
    buffer_load_dwordx4 v18, s[44:47], s53 offen offset:2048 sc1 lds
    buffer_load_dwordx4 v19, s[44:47], s53 offen offset:3072 sc1 lds
    s_add_u32 s53, s53, s56
    s_add_u32 m0, s62, 4096
    s_nop 0
    buffer_load_dwordx4 v20, s[44:47], s54 offen offset:0 sc1 lds
    buffer_load_dwordx4 v21, s[44:47], s54 offen offset:1024 sc1 lds
    s_add_u32 s54, s54, s56
    buffer_load_dwordx4 v20, s[44:47], s55 offen offset:2048 sc1 lds
    buffer_load_dwordx4 v21, s[44:47], s55 offen offset:3072 sc1 lds
    s_add_u32 s55, s55, s56
    s_xor_b32 s62, s62, 229376
    s_mov_b32 s95, s82
    s_mov_b32 s96, s83
    s_mov_b32 s97, s84
    s_mov_b32 s98, s85
    s_mov_b32 s99, s86
    s_mov_b32 s100, s87
    s_mov_b32 s101, s88
    v_and_b32 v24, 15, v1
    v_lshrrev_b32 v25, 4, v1
    v_bfe_u32 v26, v1, 1, 3
    v_xor_b32 v26, v26, v25
    s_lshl_b32 s90, s57, 14
    v_lshlrev_b32 v27, 7, v24
    v_add_u32 v27, s90, v27
    v_xor_b32 v28, 0, v26
    v_lshl_add_u32 v6, v28, 4, v27
    v_xor_b32 v28, 4, v26
    v_lshl_add_u32 v7, v28, 4, v27
    v_bfe_u32 v26, v1, 2, 2
    v_lshl_add_u32 v27, v25, 3, v26
    v_lshlrev_b32 v27, 9, v27
    v_and_b32 v28, 3, v1
    v_lshlrev_b32 v28, 3, v28
    v_add_u32 v27, v27, v28
    s_lshl_b32 s90, s58, 8
    s_add_u32 s90, s90, 98304
    v_add_u32 v27, s90, v27
    v_bfe_u32 v26, v1, 2, 3
    v_xor_b32 v28, 0, v26
    v_lshl_add_u32 v8, v28, 5, v27
    v_xor_b32 v28, 1, v26
    v_lshl_add_u32 v9, v28, 5, v27
    v_xor_b32 v28, 2, v26
    v_lshl_add_u32 v10, v28, 5, v27
    v_xor_b32 v28, 3, v26
    v_lshl_add_u32 v11, v28, 5, v27
    v_xor_b32 v28, 4, v26
    v_lshl_add_u32 v12, v28, 5, v27
    v_xor_b32 v28, 5, v26
    v_lshl_add_u32 v13, v28, 5, v27
    v_xor_b32 v28, 6, v26
    v_lshl_add_u32 v14, v28, 5, v27
    v_xor_b32 v28, 7, v26
    v_lshl_add_u32 v15, v28, 5, v27
    v_lshlrev_b32 v2, 4, v1
    s_mov_b32 s64, 0
    s_mov_b32 s59, 32768
    s_mov_b32 s60, 229376
    s_mov_b32 s8, s6
    s_mov_b32 s9, s7
    s_mov_b32 s10, 268435456
    s_mov_b32 s11, 0x20000
    s_cmp_ge_u32 s68, 16
    s_cbranch_scc1 m_typea8
    s_bfe_u32 s69, s68, 0x20002
    s_add_u32 s69, s69, 4
    s_and_b32 s90, s2, 7
    s_lshl_b32 s90, s90, 2
    s_and_b32 s91, s68, 3
    s_add_u32 s90, s90, s91
    s_cmp_lt_u32 s90, 16
    s_cselect_b32 s83, 0, 1
    s_mov_b32 s91, 33554432
    s_cselect_b32 s85, 16777216, s91
    s_mov_b32 s91, 8192
    s_cselect_b32 s86, 1024, s91
    s_mov_b32 s91, 1024
    s_cselect_b32 s87, 4096, s91
    s_cselect_b32 s74, s36, s38
    s_cselect_b32 s75, s37, s39
    s_mov_b32 s71, s32
    s_mov_b32 s72, s33
    s_mov_b32 s73, 2097152
    s_mov_b32 s77, 1024
    s_mov_b32 s82, 8
    s_mov_b32 s81, 0
    s_mov_b32 s76, 4194304
    s_mov_b32 s78, 8192
    s_mov_b32 s84, 0
    s_and_b32 s90, s90, 15
    s_lshl_b32 s80, s90, 9
    s_lshl_b32 s79, s69, 18
    s_lshl_b32 s91, s83, 2
    s_add_u32 s91, s91, s69
    s_cmp_ge_u32 s69, 4
    s_cselect_b32 s92, 508, 8
    s_add_u32 s91, s91, s92
    s_lshl_b32 s88, s90, 4
    s_add_u32 s88, s88, s91
    s_lshl_b32 s88, s88, 3
    s_lshl_b32 s91, s90, 1
    s_add_u32 s91, s91, s58
    s_lshl_b32 s91, s91, 19
    s_lshl_b32 s92, s69, 1
    s_add_u32 s92, s92, s57
    s_lshl_b32 s92, s92, 15
    s_add_u32 s85, s85, s91
    s_add_u32 s85, s85, s92
    s_branch m_go29
m_typea8:
    s_and_b32 s69, s68, 3
    s_and_b32 s90, s2, 1
    s_lshl_b32 s90, s90, 2
    s_add_u32 s69, s69, s90
    s_bfe_u32 s90, s2, 0x20001
    s_mul_i32 s90, s90, 3
    s_bfe_u32 s91, s68, 0x20002
    s_add_u32 s90, s90, s91
    s_mov_b32 s76, 6291456
    s_mov_b32 s78, 6144
    s_mov_b32 s81, 1
    s_mov_b32 s73, 4194304
    s_mov_b32 s77, 2048
    s_mov_b32 s82, 16
    s_lshl_b32 s80, s90, 9
    s_lshl_b32 s79, s69, 19
    s_and_b32 s92, s90, 3
    s_lshr_b32 s91, s90, 2
    s_lshl_b32 s88, s92, 2
    s_add_u32 s88, s88, s91
    s_lshl_b32 s88, s88, 3
    s_add_u32 s88, s88, s69
    s_lshl_b32 s88, s88, 3
    s_add_u32 s88, s88, 6144
    s_cmp_eq_u32 s91, 0
    s_cselect_b32 s84, 1048744942, 0
    s_lshl_b32 s93, s91, 22
    s_add_u32 s85, s93, 50331648
    s_lshl_b32 s92, s92, 1
    s_add_u32 s92, s92, s58
    s_lshl_b32 s92, s92, 19
    s_add_u32 s85, s85, s92
    s_lshl_b32 s92, s57, 3
    s_add_u32 s92, s92, s69
    s_cmp_eq_u32 s91, 2
    s_cselect_b32 s83, 1, 0
    s_cselect_b32 s93, 12, 13
    s_mov_b32 s91, 131072
    s_cselect_b32 s86, 1024, s91
    s_mov_b32 s91, 1024
    s_cselect_b32 s87, 65536, s91
    s_lshl_b32 s92, s92, s93
    s_add_u32 s85, s85, s92
    s_mov_b32 s71, s24
    s_mov_b32 s72, s25
    s_mov_b32 s74, s26
    s_mov_b32 s75, s27
m_go29:
    s_xor_b32 s94, s70, 1
    s_mov_b32 s67, 3
    s_mov_b32 s17, -1
    s_mov_b32 s12, s4
    s_mov_b32 s13, s5
    s_mov_b32 s14, 256
    s_mov_b32 s15, 0x20000
    s_lshl_b32 s90, s2, 2
    s_add_u32 s90, s90, s16
    s_cmp_lg_u32 s90, 0
    s_cbranch_scc1 m_tok10
    s_memrealtime s[92:93]
    s_waitcnt lgkmcnt(0)
    s_or_b32 s92, s92, 1
    v_mov_b32 v4, s92
    v_mov_b32 v5, s93
    s_mov_b64 exec, 1
    buffer_store_dwordx2 v[4:5], off, s[12:15], 0 sc1
    s_mov_b64 exec, -1
m_tok10:
    s_add_u32 m0, s61, 0
    s_nop 0
    buffer_load_dwordx4 v16, s[40:43], s48 offen offset:0 sc1 lds
    buffer_load_dwordx4 v17, s[40:43], s48 offen offset:1024 sc1 lds
    s_add_u32 s48, s48, 128
    buffer_load_dwordx4 v16, s[40:43], s49 offen offset:2048 sc1 lds
    buffer_load_dwordx4 v17, s[40:43], s49 offen offset:3072 sc1 lds
    s_add_u32 s49, s49, 128
    s_add_u32 m0, s61, 4096
    s_nop 0
    buffer_load_dwordx4 v16, s[40:43], s50 offen offset:0 sc1 lds
    buffer_load_dwordx4 v17, s[40:43], s50 offen offset:1024 sc1 lds
    s_add_u32 s50, s50, 128
    buffer_load_dwordx4 v16, s[40:43], s51 offen offset:2048 sc1 lds
    buffer_load_dwordx4 v17, s[40:43], s51 offen offset:3072 sc1 lds
    s_add_u32 s51, s51, 128
    s_add_u32 s61, s61, 32768
    s_cmp_ge_u32 s61, 98304
    s_cselect_b32 s90, 98304, 0
    s_sub_u32 s61, s61, s90
    s_add_u32 m0, s62, 0
    s_nop 0
    buffer_load_dwordx4 v18, s[44:47], s52 offen offset:0 sc1 lds
    buffer_load_dwordx4 v19, s[44:47], s52 offen offset:1024 sc1 lds
    s_add_u32 s52, s52, s56
    buffer_load_dwordx4 v18, s[44:47], s53 offen offset:2048 sc1 lds
    buffer_load_dwordx4 v19, s[44:47], s53 offen offset:3072 sc1 lds
    s_add_u32 s53, s53, s56
    s_add_u32 m0, s62, 4096
    s_nop 0
    buffer_load_dwordx4 v20, s[44:47], s54 offen offset:0 sc1 lds
    buffer_load_dwordx4 v21, s[44:47], s54 offen offset:1024 sc1 lds
    s_add_u32 s54, s54, s56
    buffer_load_dwordx4 v20, s[44:47], s55 offen offset:2048 sc1 lds
    buffer_load_dwordx4 v21, s[44:47], s55 offen offset:3072 sc1 lds
    s_add_u32 s55, s55, s56
    s_xor_b32 s62, s62, 229376
    s_waitcnt vmcnt(16)
    s_barrier
    ds_read_b64_tr_b16 a[64:65], v8 offset:0
    ds_read_b64_tr_b16 a[66:67], v8 offset:2048
    ds_read_b64_tr_b16 a[68:69], v8 offset:16384
    ds_read_b64_tr_b16 a[70:71], v8 offset:18432
    ds_read_b64_tr_b16 a[72:73], v9 offset:0
    ds_read_b64_tr_b16 a[74:75], v9 offset:2048
    ds_read_b64_tr_b16 a[76:77], v9 offset:16384
    ds_read_b64_tr_b16 a[78:79], v9 offset:18432
    ds_read_b64_tr_b16 a[80:81], v10 offset:0
    ds_read_b64_tr_b16 a[82:83], v10 offset:2048
    ds_read_b64_tr_b16 a[84:85], v10 offset:16384
    ds_read_b64_tr_b16 a[86:87], v10 offset:18432
    ds_read_b64_tr_b16 a[88:89], v11 offset:0
    ds_read_b64_tr_b16 a[90:91], v11 offset:2048
    ds_read_b64_tr_b16 a[92:93], v11 offset:16384
    ds_read_b64_tr_b16 a[94:95], v11 offset:18432
    ds_read_b64_tr_b16 a[96:97], v12 offset:0
    ds_read_b128 a[0:3], v6 offset:0
    ds_read_b128 a[4:7], v7 offset:0
    ds_read_b64_tr_b16 a[98:99], v12 offset:2048
    ds_read_b128 a[8:11], v6 offset:2048
    ds_read_b128 a[12:15], v7 offset:2048
    ds_read_b64_tr_b16 a[100:101], v12 offset:16384
    ds_read_b128 a[16:19], v6 offset:4096
    ds_read_b128 a[20:23], v7 offset:4096
    ds_read_b64_tr_b16 a[102:103], v12 offset:18432
    ds_read_b128 a[24:27], v6 offset:6144
    ds_read_b128 a[28:31], v7 offset:6144
    ds_read_b64_tr_b16 a[104:105], v13 offset:0
    ds_read_b128 a[32:35], v6 offset:8192
    ds_read_b128 a[36:39], v7 offset:8192
    ds_read_b64_tr_b16 a[106:107], v13 offset:2048
    ds_read_b128 a[40:43], v6 offset:10240
    ds_read_b128 a[44:47], v7 offset:10240
    ds_read_b64_tr_b16 a[108:109], v13 offset:16384
    ds_read_b128 a[48:51], v6 offset:12288
    ds_read_b128 a[52:55], v7 offset:12288
    ds_read_b64_tr_b16 a[110:111], v13 offset:18432
    ds_read_b128 a[56:59], v6 offset:14336
    ds_read_b128 a[60:63], v7 offset:14336
    s_add_u32 m0, s61, 0
    s_nop 0
    buffer_load_dwordx4 v16, s[40:43], s48 offen offset:0 sc1 lds
    buffer_load_dwordx4 v17, s[40:43], s48 offen offset:1024 sc1 lds
    s_add_u32 s48, s48, 128
    buffer_load_dwordx4 v16, s[40:43], s49 offen offset:2048 sc1 lds
    buffer_load_dwordx4 v17, s[40:43], s49 offen offset:3072 sc1 lds
    s_add_u32 s49, s49, 128
    s_add_u32 m0, s61, 4096
    s_nop 0
    buffer_load_dwordx4 v16, s[40:43], s50 offen offset:0 sc1 lds
    buffer_load_dwordx4 v17, s[40:43], s50 offen offset:1024 sc1 lds
    s_add_u32 s50, s50, 128
    buffer_load_dwordx4 v16, s[40:43], s51 offen offset:2048 sc1 lds
    buffer_load_dwordx4 v17, s[40:43], s51 offen offset:3072 sc1 lds
    s_add_u32 s51, s51, 128
    s_add_u32 s61, s61, 32768
    s_cmp_ge_u32 s61, 98304
    s_cselect_b32 s90, 98304, 0
    s_sub_u32 s61, s61, s90
    s_mov_b32 s66, 1
    s_mov_b32 s24, s6
    s_mov_b32 s25, s7
    s_mov_b32 s26, 0
    s_mov_b32 s27, 0x20000
    s_mov_b32 s28, 0
    s_mov_b32 s29, 0
    s_mov_b32 s30, 0
    s_mov_b32 s31, 0
m_tile11:
    s_mov_b32 s65, s95
    s_cmp_eq_u32 s96, 1
    s_cbranch_scc1 m_swp13
    s_waitcnt lgkmcnt(15)
    v_mfma_f32_16x16x32_bf16 v[32:35], a[64:67], a[0:3], 0
    ds_read_b64_tr_b16 a[112:113], v14 offset:0
    v_mfma_f32_16x16x32_bf16 v[32:35], a[68:71], a[4:7], v[32:35]
    ds_read_b64_tr_b16 a[114:115], v14 offset:2048
    v_mfma_f32_16x16x32_bf16 v[36:39], a[76:79], a[4:7], 0
    ds_read_b64_tr_b16 a[116:117], v14 offset:16384
    v_mfma_f32_16x16x32_bf16 v[36:39], a[72:75], a[0:3], v[36:39]
    ds_read_b64_tr_b16 a[118:119], v14 offset:18432
    v_mfma_f32_16x16x32_bf16 v[44:47], a[72:75], a[8:11], 0
    ds_read_b64_tr_b16 a[120:121], v15 offset:0
    v_mfma_f32_16x16x32_bf16 v[44:47], a[76:79], a[12:15], v[44:47]
    ds_read_b64_tr_b16 a[122:123], v15 offset:2048
    v_mfma_f32_16x16x32_bf16 v[40:43], a[68:71], a[12:15], 0
    ds_read_b64_tr_b16 a[124:125], v15 offset:16384
    v_mfma_f32_16x16x32_bf16 v[40:43], a[64:67], a[8:11], v[40:43]
    ds_read_b64_tr_b16 a[126:127], v15 offset:18432
    v_mfma_f32_16x16x32_bf16 v[48:51], a[64:67], a[16:19], 0
    v_mfma_f32_16x16x32_bf16 v[48:51], a[68:71], a[20:23], v[48:51]
    v_mfma_f32_16x16x32_bf16 v[52:55], a[76:79], a[20:23], 0
    buffer_store_dwordx4 a[128:131], v2, s[24:27], s28 offen sc1
    v_mfma_f32_16x16x32_bf16 v[52:55], a[72:75], a[16:19], v[52:55]
    s_add_u32 s28, s28, s31
    s_waitcnt lgkmcnt(15)
    v_mfma_f32_16x16x32_bf16 v[60:63], a[72:75], a[24:27], 0
    v_xor_b32 v8, s60, v8
    v_xor_b32 v9, s60, v9
    v_mfma_f32_16x16x32_bf16 v[60:63], a[76:79], a[28:31], v[60:63]
    v_xor_b32 v10, s60, v10
    v_xor_b32 v11, s60, v11
    v_mfma_f32_16x16x32_bf16 v[56:59], a[68:71], a[28:31], 0
    v_xor_b32 v12, s60, v12
    v_xor_b32 v13, s60, v13
    v_mfma_f32_16x16x32_bf16 v[56:59], a[64:67], a[24:27], v[56:59]
    v_xor_b32 v14, s60, v14
    v_xor_b32 v15, s60, v15
    v_mfma_f32_16x16x32_bf16 v[64:67], a[64:67], a[32:35], 0
    buffer_store_dwordx4 a[132:135], v2, s[24:27], s28 offen sc1
    v_mfma_f32_16x16x32_bf16 v[64:67], a[68:71], a[36:39], v[64:67]
    s_add_u32 s28, s28, s31
    v_mfma_f32_16x16x32_bf16 v[68:71], a[76:79], a[36:39], 0
    v_mfma_f32_16x16x32_bf16 v[68:71], a[72:75], a[32:35], v[68:71]
    s_waitcnt lgkmcnt(14)
    v_mfma_f32_16x16x32_bf16 v[76:79], a[72:75], a[40:43], 0
    v_mfma_f32_16x16x32_bf16 v[76:79], a[76:79], a[44:47], v[76:79]
    v_mfma_f32_16x16x32_bf16 v[72:75], a[68:71], a[44:47], 0
    buffer_store_dwordx4 a[136:139], v2, s[24:27], s28 offen sc1
    v_mfma_f32_16x16x32_bf16 v[72:75], a[64:67], a[40:43], v[72:75]
    s_add_u32 s28, s28, s31
    s_waitcnt lgkmcnt(11)
    v_mfma_f32_16x16x32_bf16 v[80:83], a[64:67], a[48:51], 0
    v_mfma_f32_16x16x32_bf16 v[80:83], a[68:71], a[52:55], v[80:83]
    v_mfma_f32_16x16x32_bf16 v[84:87], a[76:79], a[52:55], 0
    v_mfma_f32_16x16x32_bf16 v[84:87], a[72:75], a[48:51], v[84:87]
    s_waitcnt lgkmcnt(8)
    v_mfma_f32_16x16x32_bf16 v[92:95], a[72:75], a[56:59], 0
    buffer_store_dwordx4 a[140:143], v2, s[24:27], s28 offen sc1
    v_mfma_f32_16x16x32_bf16 v[92:95], a[76:79], a[60:63], v[92:95]
    s_add_u32 s28, s28, s31
    v_mfma_f32_16x16x32_bf16 v[88:91], a[68:71], a[60:63], 0
    s_waitcnt vmcnt(12) lgkmcnt(0)
    v_mfma_f32_16x16x32_bf16 v[88:91], a[64:67], a[56:59], v[88:91]
    s_barrier
    v_mfma_f32_16x16x32_bf16 v[96:99], a[80:83], a[0:3], 0
    ds_read_b64_tr_b16 a[64:65], v8 offset:0
    v_mfma_f32_16x16x32_bf16 v[96:99], a[84:87], a[4:7], v[96:99]
    s_add_u32 m0, s62, 0
    v_mfma_f32_16x16x32_bf16 v[100:103], a[92:95], a[4:7], 0
    buffer_load_dwordx4 v18, s[44:47], s52 offen offset:0 sc1 lds
    v_mfma_f32_16x16x32_bf16 v[100:103], a[88:91], a[0:3], v[100:103]
    ds_read_b64_tr_b16 a[66:67], v8 offset:2048
    v_mfma_f32_16x16x32_bf16 v[108:111], a[88:91], a[8:11], 0
    s_add_u32 s64, s64, 32768
    v_mfma_f32_16x16x32_bf16 v[108:111], a[92:95], a[12:15], v[108:111]
    s_cmp_ge_u32 s64, 98304
    s_cselect_b32 s63, 4294901760, s59
    s_cselect_b32 s64, 0, s64
    v_mfma_f32_16x16x32_bf16 v[104:107], a[84:87], a[12:15], 0
    buffer_load_dwordx4 v19, s[44:47], s52 offen offset:1024 sc1 lds
    v_mfma_f32_16x16x32_bf16 v[104:107], a[80:83], a[8:11], v[104:107]
    s_add_u32 s52, s52, s56
    ds_read_b64_tr_b16 a[68:69], v8 offset:16384
    v_mfma_f32_16x16x32_bf16 v[112:115], a[80:83], a[16:19], 0
    v_mfma_f32_16x16x32_bf16 v[112:115], a[84:87], a[20:23], v[112:115]
    v_mfma_f32_16x16x32_bf16 v[116:119], a[92:95], a[20:23], 0
    buffer_load_dwordx4 v18, s[44:47], s53 offen offset:2048 sc1 lds
    v_mfma_f32_16x16x32_bf16 v[116:119], a[88:91], a[16:19], v[116:119]
    ds_read_b64_tr_b16 a[70:71], v8 offset:18432
    v_mfma_f32_16x16x32_bf16 v[124:127], a[88:91], a[24:27], 0
    v_mfma_f32_16x16x32_bf16 v[124:127], a[92:95], a[28:31], v[124:127]
    v_mfma_f32_16x16x32_bf16 v[120:123], a[84:87], a[28:31], 0
    buffer_load_dwordx4 v19, s[44:47], s53 offen offset:3072 sc1 lds
    v_mfma_f32_16x16x32_bf16 v[120:123], a[80:83], a[24:27], v[120:123]
    s_add_u32 s53, s53, s56
    ds_read_b64_tr_b16 a[72:73], v9 offset:0
    v_mfma_f32_16x16x32_bf16 v[128:131], a[80:83], a[32:35], 0
    v_mfma_f32_16x16x32_bf16 v[128:131], a[84:87], a[36:39], v[128:131]
    s_add_u32 m0, s62, 4096
    v_mfma_f32_16x16x32_bf16 v[132:135], a[92:95], a[36:39], 0
    buffer_load_dwordx4 v20, s[44:47], s54 offen offset:0 sc1 lds
    v_mfma_f32_16x16x32_bf16 v[132:135], a[88:91], a[32:35], v[132:135]
    s_xor_b32 s62, s62, 229376
    ds_read_b64_tr_b16 a[74:75], v9 offset:2048
    v_mfma_f32_16x16x32_bf16 v[140:143], a[88:91], a[40:43], 0
    v_mfma_f32_16x16x32_bf16 v[140:143], a[92:95], a[44:47], v[140:143]
    v_mfma_f32_16x16x32_bf16 v[136:139], a[84:87], a[44:47], 0
    buffer_load_dwordx4 v21, s[44:47], s54 offen offset:1024 sc1 lds
    v_mfma_f32_16x16x32_bf16 v[136:139], a[80:83], a[40:43], v[136:139]
    s_add_u32 s54, s54, s56
    ds_read_b64_tr_b16 a[76:77], v9 offset:16384
    v_mfma_f32_16x16x32_bf16 v[144:147], a[80:83], a[48:51], 0
    v_mfma_f32_16x16x32_bf16 v[144:147], a[84:87], a[52:55], v[144:147]
    v_mfma_f32_16x16x32_bf16 v[148:151], a[92:95], a[52:55], 0
    buffer_load_dwordx4 v20, s[44:47], s55 offen offset:2048 sc1 lds
    v_mfma_f32_16x16x32_bf16 v[148:151], a[88:91], a[48:51], v[148:151]
    ds_read_b64_tr_b16 a[78:79], v9 offset:18432
    v_mfma_f32_16x16x32_bf16 v[156:159], a[88:91], a[56:59], 0
    v_add_u32 v6, s63, v6
    v_add_u32 v7, s63, v7
    v_mfma_f32_16x16x32_bf16 v[156:159], a[92:95], a[60:63], v[156:159]
    v_mfma_f32_16x16x32_bf16 v[152:155], a[84:87], a[60:63], 0
    buffer_load_dwordx4 v21, s[44:47], s55 offen offset:3072 sc1 lds
    v_mfma_f32_16x16x32_bf16 v[152:155], a[80:83], a[56:59], v[152:155]
    s_add_u32 s55, s55, s56
    v_mfma_f32_16x16x32_bf16 v[160:163], a[96:99], a[0:3], 0
    ds_read_b64_tr_b16 a[80:81], v10 offset:0
    v_mfma_f32_16x16x32_bf16 v[160:163], a[100:103], a[4:7], v[160:163]
    v_mfma_f32_16x16x32_bf16 v[164:167], a[108:111], a[4:7], 0
    v_mfma_f32_16x16x32_bf16 v[164:167], a[104:107], a[0:3], v[164:167]
    s_add_u32 m0, s61, 0
    ds_read_b64_tr_b16 a[82:83], v10 offset:2048
    v_mfma_f32_16x16x32_bf16 v[172:175], a[104:107], a[8:11], 0
    buffer_load_dwordx4 v16, s[40:43], s48 offen offset:0 sc1 lds
    v_mfma_f32_16x16x32_bf16 v[172:175], a[108:111], a[12:15], v[172:175]
    v_mfma_f32_16x16x32_bf16 v[168:171], a[100:103], a[12:15], 0
    ds_read_b64_tr_b16 a[84:85], v10 offset:16384
    v_mfma_f32_16x16x32_bf16 v[168:171], a[96:99], a[8:11], v[168:171]
    v_mfma_f32_16x16x32_bf16 v[176:179], a[96:99], a[16:19], 0
    buffer_store_dwordx4 a[144:147], v2, s[24:27], s28 offen sc1
    v_mfma_f32_16x16x32_bf16 v[176:179], a[100:103], a[20:23], v[176:179]
    s_add_u32 s28, s28, s31
    ds_read_b64_tr_b16 a[86:87], v10 offset:18432
    v_mfma_f32_16x16x32_bf16 v[180:183], a[108:111], a[20:23], 0
    v_mfma_f32_16x16x32_bf16 v[180:183], a[104:107], a[16:19], v[180:183]
    v_mfma_f32_16x16x32_bf16 v[188:191], a[104:107], a[24:27], 0
    buffer_load_dwordx4 v17, s[40:43], s48 offen offset:1024 sc1 lds
    v_mfma_f32_16x16x32_bf16 v[188:191], a[108:111], a[28:31], v[188:191]
    s_add_u32 s48, s48, 128
    ds_read_b64_tr_b16 a[88:89], v11 offset:0
    v_mfma_f32_16x16x32_bf16 v[184:187], a[100:103], a[28:31], 0
    v_mfma_f32_16x16x32_bf16 v[184:187], a[96:99], a[24:27], v[184:187]
    v_mfma_f32_16x16x32_bf16 v[192:195], a[96:99], a[32:35], 0
    buffer_store_dwordx4 a[148:151], v2, s[24:27], s28 offen sc1
    v_mfma_f32_16x16x32_bf16 v[192:195], a[100:103], a[36:39], v[192:195]
    s_add_u32 s28, s28, s31
    ds_read_b64_tr_b16 a[90:91], v11 offset:2048
    v_mfma_f32_16x16x32_bf16 v[196:199], a[108:111], a[36:39], 0
    v_mfma_f32_16x16x32_bf16 v[196:199], a[104:107], a[32:35], v[196:199]
    v_mfma_f32_16x16x32_bf16 v[204:207], a[104:107], a[40:43], 0
    buffer_load_dwordx4 v16, s[40:43], s49 offen offset:2048 sc1 lds
    v_mfma_f32_16x16x32_bf16 v[204:207], a[108:111], a[44:47], v[204:207]
    ds_read_b64_tr_b16 a[92:93], v11 offset:16384
    v_mfma_f32_16x16x32_bf16 v[200:203], a[100:103], a[44:47], 0
    v_mfma_f32_16x16x32_bf16 v[200:203], a[96:99], a[40:43], v[200:203]
    v_mfma_f32_16x16x32_bf16 v[208:211], a[96:99], a[48:51], 0
    buffer_store_dwordx4 a[152:155], v2, s[24:27], s28 offen sc1
    v_mfma_f32_16x16x32_bf16 v[208:211], a[100:103], a[52:55], v[208:211]
    s_add_u32 s28, s28, s31
    ds_read_b64_tr_b16 a[94:95], v11 offset:18432
    v_mfma_f32_16x16x32_bf16 v[212:215], a[108:111], a[52:55], 0
    v_mfma_f32_16x16x32_bf16 v[212:215], a[104:107], a[48:51], v[212:215]
    v_mfma_f32_16x16x32_bf16 v[220:223], a[104:107], a[56:59], 0
    buffer_load_dwordx4 v17, s[40:43], s49 offen offset:3072 sc1 lds
    v_mfma_f32_16x16x32_bf16 v[220:223], a[108:111], a[60:63], v[220:223]
    s_add_u32 s49, s49, 128
    v_mfma_f32_16x16x32_bf16 v[216:219], a[100:103], a[60:63], 0
    buffer_store_dwordx4 a[156:159], v2, s[24:27], s28 offen sc1
    v_mfma_f32_16x16x32_bf16 v[216:219], a[96:99], a[56:59], v[216:219]
    s_add_u32 s29, s29, s30
    s_mov_b32 s28, s29
    v_mfma_f32_16x16x32_bf16 v[224:227], a[112:115], a[0:3], 0
    v_mfma_f32_16x16x32_bf16 v[224:227], a[116:119], a[4:7], v[224:227]
    ds_read_b64_tr_b16 a[96:97], v12 offset:0
    v_mfma_f32_16x16x32_bf16 v[228:231], a[124:127], a[4:7], 0
    v_mfma_f32_16x16x32_bf16 v[228:231], a[120:123], a[0:3], v[228:231]
    s_add_u32 m0, s61, 4096
    ds_read_b128 a[0:3], v6 offset:0
    v_mfma_f32_16x16x32_bf16 v[236:239], a[120:123], a[8:11], 0
    buffer_load_dwordx4 v16, s[40:43], s50 offen offset:0 sc1 lds
    v_mfma_f32_16x16x32_bf16 v[236:239], a[124:127], a[12:15], v[236:239]
    s_add_u32 s61, s61, 32768
    ds_read_b128 a[4:7], v7 offset:0
    v_mfma_f32_16x16x32_bf16 v[232:235], a[116:119], a[12:15], 0
    s_cmp_ge_u32 s61, 98304
    s_cselect_b32 s90, 98304, 0
    ds_read_b64_tr_b16 a[98:99], v12 offset:2048
    v_mfma_f32_16x16x32_bf16 v[232:235], a[112:115], a[8:11], v[232:235]
    s_sub_u32 s61, s61, s90
    ds_read_b128 a[8:11], v6 offset:2048
    v_mfma_f32_16x16x32_bf16 v[240:243], a[112:115], a[16:19], 0
    ds_read_b128 a[12:15], v7 offset:2048
    v_mfma_f32_16x16x32_bf16 v[240:243], a[116:119], a[20:23], v[240:243]
    ds_read_b64_tr_b16 a[100:101], v12 offset:16384
    v_mfma_f32_16x16x32_bf16 v[244:247], a[124:127], a[20:23], 0
    v_mfma_f32_16x16x32_bf16 v[244:247], a[120:123], a[16:19], v[244:247]
    ds_read_b128 a[16:19], v6 offset:4096
    v_mfma_f32_16x16x32_bf16 v[252:255], a[120:123], a[24:27], 0
    buffer_load_dwordx4 v17, s[40:43], s50 offen offset:1024 sc1 lds
    v_mfma_f32_16x16x32_bf16 v[252:255], a[124:127], a[28:31], v[252:255]
    s_add_u32 s50, s50, 128
    ds_read_b128 a[20:23], v7 offset:4096
    v_mfma_f32_16x16x32_bf16 v[248:251], a[116:119], a[28:31], 0
    ds_read_b64_tr_b16 a[102:103], v12 offset:18432
    v_mfma_f32_16x16x32_bf16 v[248:251], a[112:115], a[24:27], v[248:251]
    ds_read_b128 a[24:27], v6 offset:6144
    v_mfma_f32_16x16x32_bf16 a[224:227], a[112:115], a[32:35], 0
    s_sub_u32 s65, s65, 1
    ds_read_b128 a[28:31], v7 offset:6144
    v_mfma_f32_16x16x32_bf16 a[224:227], a[116:119], a[36:39], a[224:227]
    ds_read_b64_tr_b16 a[104:105], v13 offset:0
    v_mfma_f32_16x16x32_bf16 a[228:231], a[124:127], a[36:39], 0
    v_mfma_f32_16x16x32_bf16 a[228:231], a[120:123], a[32:35], a[228:231]
    ds_read_b128 a[32:35], v6 offset:8192
    v_mfma_f32_16x16x32_bf16 a[236:239], a[120:123], a[40:43], 0
    buffer_load_dwordx4 v16, s[40:43], s51 offen offset:2048 sc1 lds
    v_mfma_f32_16x16x32_bf16 a[236:239], a[124:127], a[44:47], a[236:239]
    ds_read_b128 a[36:39], v7 offset:8192
    v_mfma_f32_16x16x32_bf16 a[232:235], a[116:119], a[44:47], 0
    ds_read_b64_tr_b16 a[106:107], v13 offset:2048
    v_mfma_f32_16x16x32_bf16 a[232:235], a[112:115], a[40:43], a[232:235]
    ds_read_b128 a[40:43], v6 offset:10240
    v_mfma_f32_16x16x32_bf16 a[240:243], a[112:115], a[48:51], 0
    ds_read_b128 a[44:47], v7 offset:10240
    v_mfma_f32_16x16x32_bf16 a[240:243], a[116:119], a[52:55], a[240:243]
    ds_read_b64_tr_b16 a[108:109], v13 offset:16384
    v_mfma_f32_16x16x32_bf16 a[244:247], a[124:127], a[52:55], 0
    v_mfma_f32_16x16x32_bf16 a[244:247], a[120:123], a[48:51], a[244:247]
    ds_read_b128 a[48:51], v6 offset:12288
    v_mfma_f32_16x16x32_bf16 a[252:255], a[120:123], a[56:59], 0
    buffer_load_dwordx4 v17, s[40:43], s51 offen offset:3072 sc1 lds
    v_mfma_f32_16x16x32_bf16 a[252:255], a[124:127], a[60:63], a[252:255]
    s_add_u32 s51, s51, 128
    ds_read_b128 a[52:55], v7 offset:12288
    v_mfma_f32_16x16x32_bf16 a[248:251], a[116:119], a[60:63], 0
    ds_read_b64_tr_b16 a[110:111], v13 offset:18432
    v_mfma_f32_16x16x32_bf16 a[248:251], a[112:115], a[56:59], a[248:251]
    ds_read_b128 a[56:59], v6 offset:14336
    ds_read_b128 a[60:63], v7 offset:14336
    s_waitcnt lgkmcnt(15)
    v_mfma_f32_16x16x32_bf16 v[32:35], a[64:67], a[0:3], v[32:35]
    ds_read_b64_tr_b16 a[112:113], v14 offset:0
    v_mfma_f32_16x16x32_bf16 v[32:35], a[68:71], a[4:7], v[32:35]
    ds_read_b64_tr_b16 a[114:115], v14 offset:2048
    v_mfma_f32_16x16x32_bf16 v[36:39], a[76:79], a[4:7], v[36:39]
    ds_read_b64_tr_b16 a[116:117], v14 offset:16384
    v_mfma_f32_16x16x32_bf16 v[36:39], a[72:75], a[0:3], v[36:39]
    ds_read_b64_tr_b16 a[118:119], v14 offset:18432
    v_mfma_f32_16x16x32_bf16 v[44:47], a[72:75], a[8:11], v[44:47]
    ds_read_b64_tr_b16 a[120:121], v15 offset:0
    v_mfma_f32_16x16x32_bf16 v[44:47], a[76:79], a[12:15], v[44:47]
    ds_read_b64_tr_b16 a[122:123], v15 offset:2048
    v_mfma_f32_16x16x32_bf16 v[40:43], a[68:71], a[12:15], v[40:43]
    ds_read_b64_tr_b16 a[124:125], v15 offset:16384
    v_mfma_f32_16x16x32_bf16 v[40:43], a[64:67], a[8:11], v[40:43]
    ds_read_b64_tr_b16 a[126:127], v15 offset:18432
    v_mfma_f32_16x16x32_bf16 v[48:51], a[64:67], a[16:19], v[48:51]
    v_mfma_f32_16x16x32_bf16 v[48:51], a[68:71], a[20:23], v[48:51]
    v_mfma_f32_16x16x32_bf16 v[52:55], a[76:79], a[20:23], v[52:55]
    buffer_store_dwordx4 a[160:163], v2, s[24:27], s28 offen sc1
    v_mfma_f32_16x16x32_bf16 v[52:55], a[72:75], a[16:19], v[52:55]
    s_add_u32 s28, s28, s31
    s_waitcnt lgkmcnt(15)
    v_mfma_f32_16x16x32_bf16 v[60:63], a[72:75], a[24:27], v[60:63]
    v_xor_b32 v8, s60, v8
    v_xor_b32 v9, s60, v9
    v_mfma_f32_16x16x32_bf16 v[60:63], a[76:79], a[28:31], v[60:63]
    v_xor_b32 v10, s60, v10
    v_xor_b32 v11, s60, v11
    v_mfma_f32_16x16x32_bf16 v[56:59], a[68:71], a[28:31], v[56:59]
    v_xor_b32 v12, s60, v12
    v_xor_b32 v13, s60, v13
    v_mfma_f32_16x16x32_bf16 v[56:59], a[64:67], a[24:27], v[56:59]
    v_xor_b32 v14, s60, v14
    v_xor_b32 v15, s60, v15
    v_mfma_f32_16x16x32_bf16 v[64:67], a[64:67], a[32:35], v[64:67]
    buffer_store_dwordx4 a[164:167], v2, s[24:27], s28 offen sc1
    v_mfma_f32_16x16x32_bf16 v[64:67], a[68:71], a[36:39], v[64:67]
    s_add_u32 s28, s28, s31
    v_mfma_f32_16x16x32_bf16 v[68:71], a[76:79], a[36:39], v[68:71]
    v_mfma_f32_16x16x32_bf16 v[68:71], a[72:75], a[32:35], v[68:71]
    s_waitcnt lgkmcnt(14)
    v_mfma_f32_16x16x32_bf16 v[76:79], a[72:75], a[40:43], v[76:79]
    v_mfma_f32_16x16x32_bf16 v[76:79], a[76:79], a[44:47], v[76:79]
    v_mfma_f32_16x16x32_bf16 v[72:75], a[68:71], a[44:47], v[72:75]
    buffer_store_dwordx4 a[168:171], v2, s[24:27], s28 offen sc1
    v_mfma_f32_16x16x32_bf16 v[72:75], a[64:67], a[40:43], v[72:75]
    s_add_u32 s28, s28, s31
    s_waitcnt lgkmcnt(11)
    v_mfma_f32_16x16x32_bf16 v[80:83], a[64:67], a[48:51], v[80:83]
    v_mfma_f32_16x16x32_bf16 v[80:83], a[68:71], a[52:55], v[80:83]
    v_mfma_f32_16x16x32_bf16 v[84:87], a[76:79], a[52:55], v[84:87]
    v_mfma_f32_16x16x32_bf16 v[84:87], a[72:75], a[48:51], v[84:87]
    s_waitcnt lgkmcnt(8)
    v_mfma_f32_16x16x32_bf16 v[92:95], a[72:75], a[56:59], v[92:95]
    buffer_store_dwordx4 a[172:175], v2, s[24:27], s28 offen sc1
    v_mfma_f32_16x16x32_bf16 v[92:95], a[76:79], a[60:63], v[92:95]
    s_add_u32 s28, s28, s31
    v_mfma_f32_16x16x32_bf16 v[88:91], a[68:71], a[60:63], v[88:91]
    s_waitcnt vmcnt(16) lgkmcnt(0)
    v_mfma_f32_16x16x32_bf16 v[88:91], a[64:67], a[56:59], v[88:91]
    s_barrier
    v_mfma_f32_16x16x32_bf16 v[96:99], a[80:83], a[0:3], v[96:99]
    ds_read_b64_tr_b16 a[64:65], v8 offset:0
    v_mfma_f32_16x16x32_bf16 v[96:99], a[84:87], a[4:7], v[96:99]
    s_add_u32 m0, s62, 0
    v_mfma_f32_16x16x32_bf16 v[100:103], a[92:95], a[4:7], v[100:103]
    buffer_load_dwordx4 v18, s[44:47], s52 offen offset:0 sc1 lds
    v_mfma_f32_16x16x32_bf16 v[100:103], a[88:91], a[0:3], v[100:103]
    ds_read_b64_tr_b16 a[66:67], v8 offset:2048
    v_mfma_f32_16x16x32_bf16 v[108:111], a[88:91], a[8:11], v[108:111]
    s_add_u32 s64, s64, 32768
    v_mfma_f32_16x16x32_bf16 v[108:111], a[92:95], a[12:15], v[108:111]
    s_cmp_ge_u32 s64, 98304
    s_cselect_b32 s63, 4294901760, s59
    s_cselect_b32 s64, 0, s64
    v_mfma_f32_16x16x32_bf16 v[104:107], a[84:87], a[12:15], v[104:107]
    buffer_load_dwordx4 v19, s[44:47], s52 offen offset:1024 sc1 lds
    v_mfma_f32_16x16x32_bf16 v[104:107], a[80:83], a[8:11], v[104:107]
    s_add_u32 s52, s52, s56
    ds_read_b64_tr_b16 a[68:69], v8 offset:16384
    v_mfma_f32_16x16x32_bf16 v[112:115], a[80:83], a[16:19], v[112:115]
    v_mfma_f32_16x16x32_bf16 v[112:115], a[84:87], a[20:23], v[112:115]
    v_mfma_f32_16x16x32_bf16 v[116:119], a[92:95], a[20:23], v[116:119]
    buffer_load_dwordx4 v18, s[44:47], s53 offen offset:2048 sc1 lds
    v_mfma_f32_16x16x32_bf16 v[116:119], a[88:91], a[16:19], v[116:119]
    ds_read_b64_tr_b16 a[70:71], v8 offset:18432
    v_mfma_f32_16x16x32_bf16 v[124:127], a[88:91], a[24:27], v[124:127]
    v_mfma_f32_16x16x32_bf16 v[124:127], a[92:95], a[28:31], v[124:127]
    v_mfma_f32_16x16x32_bf16 v[120:123], a[84:87], a[28:31], v[120:123]
    buffer_load_dwordx4 v19, s[44:47], s53 offen offset:3072 sc1 lds
    v_mfma_f32_16x16x32_bf16 v[120:123], a[80:83], a[24:27], v[120:123]
    s_add_u32 s53, s53, s56
    ds_read_b64_tr_b16 a[72:73], v9 offset:0
    v_mfma_f32_16x16x32_bf16 v[128:131], a[80:83], a[32:35], v[128:131]
    v_mfma_f32_16x16x32_bf16 v[128:131], a[84:87], a[36:39], v[128:131]
    s_add_u32 m0, s62, 4096
    v_mfma_f32_16x16x32_bf16 v[132:135], a[92:95], a[36:39], v[132:135]
    buffer_load_dwordx4 v20, s[44:47], s54 offen offset:0 sc1 lds
    v_mfma_f32_16x16x32_bf16 v[132:135], a[88:91], a[32:35], v[132:135]
    s_xor_b32 s62, s62, 229376
    ds_read_b64_tr_b16 a[74:75], v9 offset:2048
    v_mfma_f32_16x16x32_bf16 v[140:143], a[88:91], a[40:43], v[140:143]
    v_mfma_f32_16x16x32_bf16 v[140:143], a[92:95], a[44:47], v[140:143]
    v_mfma_f32_16x16x32_bf16 v[136:139], a[84:87], a[44:47], v[136:139]
    buffer_load_dwordx4 v21, s[44:47], s54 offen offset:1024 sc1 lds
    v_mfma_f32_16x16x32_bf16 v[136:139], a[80:83], a[40:43], v[136:139]
    s_add_u32 s54, s54, s56
    ds_read_b64_tr_b16 a[76:77], v9 offset:16384
    v_mfma_f32_16x16x32_bf16 v[144:147], a[80:83], a[48:51], v[144:147]
    v_mfma_f32_16x16x32_bf16 v[144:147], a[84:87], a[52:55], v[144:147]
    v_mfma_f32_16x16x32_bf16 v[148:151], a[92:95], a[52:55], v[148:151]
    buffer_load_dwordx4 v20, s[44:47], s55 offen offset:2048 sc1 lds
    v_mfma_f32_16x16x32_bf16 v[148:151], a[88:91], a[48:51], v[148:151]
    ds_read_b64_tr_b16 a[78:79], v9 offset:18432
    v_mfma_f32_16x16x32_bf16 v[156:159], a[88:91], a[56:59], v[156:159]
    v_add_u32 v6, s63, v6
    v_add_u32 v7, s63, v7
    v_mfma_f32_16x16x32_bf16 v[156:159], a[92:95], a[60:63], v[156:159]
    v_mfma_f32_16x16x32_bf16 v[152:155], a[84:87], a[60:63], v[152:155]
    buffer_load_dwordx4 v21, s[44:47], s55 offen offset:3072 sc1 lds
    v_mfma_f32_16x16x32_bf16 v[152:155], a[80:83], a[56:59], v[152:155]
    s_add_u32 s55, s55, s56
    v_mfma_f32_16x16x32_bf16 v[160:163], a[96:99], a[0:3], v[160:163]
    ds_read_b64_tr_b16 a[80:81], v10 offset:0
    v_mfma_f32_16x16x32_bf16 v[160:163], a[100:103], a[4:7], v[160:163]
    v_mfma_f32_16x16x32_bf16 v[164:167], a[108:111], a[4:7], v[164:167]
    v_mfma_f32_16x16x32_bf16 v[164:167], a[104:107], a[0:3], v[164:167]
    s_add_u32 m0, s61, 0
    ds_read_b64_tr_b16 a[82:83], v10 offset:2048
    v_mfma_f32_16x16x32_bf16 v[172:175], a[104:107], a[8:11], v[172:175]
    buffer_load_dwordx4 v16, s[40:43], s48 offen offset:0 sc1 lds
    v_mfma_f32_16x16x32_bf16 v[172:175], a[108:111], a[12:15], v[172:175]
    v_mfma_f32_16x16x32_bf16 v[168:171], a[100:103], a[12:15], v[168:171]
    ds_read_b64_tr_b16 a[84:85], v10 offset:16384
    v_mfma_f32_16x16x32_bf16 v[168:171], a[96:99], a[8:11], v[168:171]
    v_mfma_f32_16x16x32_bf16 v[176:179], a[96:99], a[16:19], v[176:179]
    buffer_store_dwordx4 a[176:179], v2, s[24:27], s28 offen sc1
    v_mfma_f32_16x16x32_bf16 v[176:179], a[100:103], a[20:23], v[176:179]
    s_add_u32 s28, s28, s31
    ds_read_b64_tr_b16 a[86:87], v10 offset:18432
    v_mfma_f32_16x16x32_bf16 v[180:183], a[108:111], a[20:23], v[180:183]
    v_mfma_f32_16x16x32_bf16 v[180:183], a[104:107], a[16:19], v[180:183]
    v_mfma_f32_16x16x32_bf16 v[188:191], a[104:107], a[24:27], v[188:191]
    buffer_load_dwordx4 v17, s[40:43], s48 offen offset:1024 sc1 lds
    v_mfma_f32_16x16x32_bf16 v[188:191], a[108:111], a[28:31], v[188:191]
    s_add_u32 s48, s48, 128
    ds_read_b64_tr_b16 a[88:89], v11 offset:0
    v_mfma_f32_16x16x32_bf16 v[184:187], a[100:103], a[28:31], v[184:187]
    v_mfma_f32_16x16x32_bf16 v[184:187], a[96:99], a[24:27], v[184:187]
    v_mfma_f32_16x16x32_bf16 v[192:195], a[96:99], a[32:35], v[192:195]
    buffer_store_dwordx4 a[180:183], v2, s[24:27], s28 offen sc1
    v_mfma_f32_16x16x32_bf16 v[192:195], a[100:103], a[36:39], v[192:195]
    s_add_u32 s28, s28, s31
    ds_read_b64_tr_b16 a[90:91], v11 offset:2048
    v_mfma_f32_16x16x32_bf16 v[196:199], a[108:111], a[36:39], v[196:199]
    v_mfma_f32_16x16x32_bf16 v[196:199], a[104:107], a[32:35], v[196:199]
    v_mfma_f32_16x16x32_bf16 v[204:207], a[104:107], a[40:43], v[204:207]
    buffer_load_dwordx4 v16, s[40:43], s49 offen offset:2048 sc1 lds
    v_mfma_f32_16x16x32_bf16 v[204:207], a[108:111], a[44:47], v[204:207]
    ds_read_b64_tr_b16 a[92:93], v11 offset:16384
    v_mfma_f32_16x16x32_bf16 v[200:203], a[100:103], a[44:47], v[200:203]
    v_mfma_f32_16x16x32_bf16 v[200:203], a[96:99], a[40:43], v[200:203]
    v_mfma_f32_16x16x32_bf16 v[208:211], a[96:99], a[48:51], v[208:211]
    buffer_store_dwordx4 a[184:187], v2, s[24:27], s28 offen sc1
    v_mfma_f32_16x16x32_bf16 v[208:211], a[100:103], a[52:55], v[208:211]
    s_add_u32 s28, s28, s31
    ds_read_b64_tr_b16 a[94:95], v11 offset:18432
    v_mfma_f32_16x16x32_bf16 v[212:215], a[108:111], a[52:55], v[212:215]
    v_mfma_f32_16x16x32_bf16 v[212:215], a[104:107], a[48:51], v[212:215]
    v_mfma_f32_16x16x32_bf16 v[220:223], a[104:107], a[56:59], v[220:223]
    buffer_load_dwordx4 v17, s[40:43], s49 offen offset:3072 sc1 lds
    v_mfma_f32_16x16x32_bf16 v[220:223], a[108:111], a[60:63], v[220:223]
    s_add_u32 s49, s49, 128
    v_mfma_f32_16x16x32_bf16 v[216:219], a[100:103], a[60:63], v[216:219]
    buffer_store_dwordx4 a[188:191], v2, s[24:27], s28 offen sc1
    v_mfma_f32_16x16x32_bf16 v[216:219], a[96:99], a[56:59], v[216:219]
    s_add_u32 s29, s29, s30
    s_mov_b32 s28, s29
    v_mfma_f32_16x16x32_bf16 v[224:227], a[112:115], a[0:3], v[224:227]
    v_mfma_f32_16x16x32_bf16 v[224:227], a[116:119], a[4:7], v[224:227]
    ds_read_b64_tr_b16 a[96:97], v12 offset:0
    v_mfma_f32_16x16x32_bf16 v[228:231], a[124:127], a[4:7], v[228:231]
    v_mfma_f32_16x16x32_bf16 v[228:231], a[120:123], a[0:3], v[228:231]
    s_add_u32 m0, s61, 4096
    ds_read_b128 a[0:3], v6 offset:0
    v_mfma_f32_16x16x32_bf16 v[236:239], a[120:123], a[8:11], v[236:239]
    buffer_load_dwordx4 v16, s[40:43], s50 offen offset:0 sc1 lds
    v_mfma_f32_16x16x32_bf16 v[236:239], a[124:127], a[12:15], v[236:239]
    s_add_u32 s61, s61, 32768
    ds_read_b128 a[4:7], v7 offset:0
    v_mfma_f32_16x16x32_bf16 v[232:235], a[116:119], a[12:15], v[232:235]
    s_cmp_ge_u32 s61, 98304
    s_cselect_b32 s90, 98304, 0
    ds_read_b64_tr_b16 a[98:99], v12 offset:2048
    v_mfma_f32_16x16x32_bf16 v[232:235], a[112:115], a[8:11], v[232:235]
    s_sub_u32 s61, s61, s90
    ds_read_b128 a[8:11], v6 offset:2048
    v_mfma_f32_16x16x32_bf16 v[240:243], a[112:115], a[16:19], v[240:243]
    ds_read_b128 a[12:15], v7 offset:2048
    v_mfma_f32_16x16x32_bf16 v[240:243], a[116:119], a[20:23], v[240:243]
    ds_read_b64_tr_b16 a[100:101], v12 offset:16384
    v_mfma_f32_16x16x32_bf16 v[244:247], a[124:127], a[20:23], v[244:247]
    v_mfma_f32_16x16x32_bf16 v[244:247], a[120:123], a[16:19], v[244:247]
    ds_read_b128 a[16:19], v6 offset:4096
    v_mfma_f32_16x16x32_bf16 v[252:255], a[120:123], a[24:27], v[252:255]
    buffer_load_dwordx4 v17, s[40:43], s50 offen offset:1024 sc1 lds
    v_mfma_f32_16x16x32_bf16 v[252:255], a[124:127], a[28:31], v[252:255]
    s_add_u32 s50, s50, 128
    ds_read_b128 a[20:23], v7 offset:4096
    v_mfma_f32_16x16x32_bf16 v[248:251], a[116:119], a[28:31], v[248:251]
    ds_read_b64_tr_b16 a[102:103], v12 offset:18432
    v_mfma_f32_16x16x32_bf16 v[248:251], a[112:115], a[24:27], v[248:251]
    ds_read_b128 a[24:27], v6 offset:6144
    v_mfma_f32_16x16x32_bf16 a[224:227], a[112:115], a[32:35], a[224:227]
    s_sub_u32 s65, s65, 1
    ds_read_b128 a[28:31], v7 offset:6144
    v_mfma_f32_16x16x32_bf16 a[224:227], a[116:119], a[36:39], a[224:227]
    ds_read_b64_tr_b16 a[104:105], v13 offset:0
    v_mfma_f32_16x16x32_bf16 a[228:231], a[124:127], a[36:39], a[228:231]
    v_mfma_f32_16x16x32_bf16 a[228:231], a[120:123], a[32:35], a[228:231]
    ds_read_b128 a[32:35], v6 offset:8192
    v_mfma_f32_16x16x32_bf16 a[236:239], a[120:123], a[40:43], a[236:239]
    buffer_load_dwordx4 v16, s[40:43], s51 offen offset:2048 sc1 lds
    v_mfma_f32_16x16x32_bf16 a[236:239], a[124:127], a[44:47], a[236:239]
    ds_read_b128 a[36:39], v7 offset:8192
    v_mfma_f32_16x16x32_bf16 a[232:235], a[116:119], a[44:47], a[232:235]
    ds_read_b64_tr_b16 a[106:107], v13 offset:2048
    v_mfma_f32_16x16x32_bf16 a[232:235], a[112:115], a[40:43], a[232:235]
    ds_read_b128 a[40:43], v6 offset:10240
    v_mfma_f32_16x16x32_bf16 a[240:243], a[112:115], a[48:51], a[240:243]
    ds_read_b128 a[44:47], v7 offset:10240
    v_mfma_f32_16x16x32_bf16 a[240:243], a[116:119], a[52:55], a[240:243]
    ds_read_b64_tr_b16 a[108:109], v13 offset:16384
    v_mfma_f32_16x16x32_bf16 a[244:247], a[124:127], a[52:55], a[244:247]
    v_mfma_f32_16x16x32_bf16 a[244:247], a[120:123], a[48:51], a[244:247]
    ds_read_b128 a[48:51], v6 offset:12288
    v_mfma_f32_16x16x32_bf16 a[252:255], a[120:123], a[56:59], a[252:255]
    buffer_load_dwordx4 v17, s[40:43], s51 offen offset:3072 sc1 lds
    v_mfma_f32_16x16x32_bf16 a[252:255], a[124:127], a[60:63], a[252:255]
    s_add_u32 s51, s51, 128
    ds_read_b128 a[52:55], v7 offset:12288
    v_mfma_f32_16x16x32_bf16 a[248:251], a[116:119], a[60:63], a[248:251]
    ds_read_b64_tr_b16 a[110:111], v13 offset:18432
    v_mfma_f32_16x16x32_bf16 a[248:251], a[112:115], a[56:59], a[248:251]
    ds_read_b128 a[56:59], v6 offset:14336
    ds_read_b128 a[60:63], v7 offset:14336
    s_cmp_eq_u32 s66, 2
    s_cbranch_scc1 m_hook14
m_hookr15:
    s_waitcnt lgkmcnt(15)
    v_mfma_f32_16x16x32_bf16 v[32:35], a[64:67], a[0:3], v[32:35]
    ds_read_b64_tr_b16 a[112:113], v14 offset:0
    v_mfma_f32_16x16x32_bf16 v[32:35], a[68:71], a[4:7], v[32:35]
    ds_read_b64_tr_b16 a[114:115], v14 offset:2048
    v_mfma_f32_16x16x32_bf16 v[36:39], a[76:79], a[4:7], v[36:39]
    ds_read_b64_tr_b16 a[116:117], v14 offset:16384
    v_mfma_f32_16x16x32_bf16 v[36:39], a[72:75], a[0:3], v[36:39]
    ds_read_b64_tr_b16 a[118:119], v14 offset:18432
    v_mfma_f32_16x16x32_bf16 v[44:47], a[72:75], a[8:11], v[44:47]
    ds_read_b64_tr_b16 a[120:121], v15 offset:0
    v_mfma_f32_16x16x32_bf16 v[44:47], a[76:79], a[12:15], v[44:47]
    ds_read_b64_tr_b16 a[122:123], v15 offset:2048
    v_mfma_f32_16x16x32_bf16 v[40:43], a[68:71], a[12:15], v[40:43]
    ds_read_b64_tr_b16 a[124:125], v15 offset:16384
    v_mfma_f32_16x16x32_bf16 v[40:43], a[64:67], a[8:11], v[40:43]
    ds_read_b64_tr_b16 a[126:127], v15 offset:18432
    v_mfma_f32_16x16x32_bf16 v[48:51], a[64:67], a[16:19], v[48:51]
    v_mfma_f32_16x16x32_bf16 v[48:51], a[68:71], a[20:23], v[48:51]
    v_mfma_f32_16x16x32_bf16 v[52:55], a[76:79], a[20:23], v[52:55]
    buffer_store_dwordx4 a[192:195], v2, s[24:27], s28 offen sc1
    v_mfma_f32_16x16x32_bf16 v[52:55], a[72:75], a[16:19], v[52:55]
    s_add_u32 s28, s28, s31
    s_waitcnt lgkmcnt(15)
    v_mfma_f32_16x16x32_bf16 v[60:63], a[72:75], a[24:27], v[60:63]
    v_xor_b32 v8, s60, v8
    v_xor_b32 v9, s60, v9
    v_mfma_f32_16x16x32_bf16 v[60:63], a[76:79], a[28:31], v[60:63]
    v_xor_b32 v10, s60, v10
    v_xor_b32 v11, s60, v11
    v_mfma_f32_16x16x32_bf16 v[56:59], a[68:71], a[28:31], v[56:59]
    v_xor_b32 v12, s60, v12
    v_xor_b32 v13, s60, v13
    v_mfma_f32_16x16x32_bf16 v[56:59], a[64:67], a[24:27], v[56:59]
    v_xor_b32 v14, s60, v14
    v_xor_b32 v15, s60, v15
    v_mfma_f32_16x16x32_bf16 v[64:67], a[64:67], a[32:35], v[64:67]
    buffer_store_dwordx4 a[196:199], v2, s[24:27], s28 offen sc1
    v_mfma_f32_16x16x32_bf16 v[64:67], a[68:71], a[36:39], v[64:67]
    s_add_u32 s28, s28, s31
    v_mfma_f32_16x16x32_bf16 v[68:71], a[76:79], a[36:39], v[68:71]
    v_mfma_f32_16x16x32_bf16 v[68:71], a[72:75], a[32:35], v[68:71]
    s_waitcnt lgkmcnt(14)
    v_mfma_f32_16x16x32_bf16 v[76:79], a[72:75], a[40:43], v[76:79]
    v_mfma_f32_16x16x32_bf16 v[76:79], a[76:79], a[44:47], v[76:79]
    v_mfma_f32_16x16x32_bf16 v[72:75], a[68:71], a[44:47], v[72:75]
    buffer_store_dwordx4 a[200:203], v2, s[24:27], s28 offen sc1
    v_mfma_f32_16x16x32_bf16 v[72:75], a[64:67], a[40:43], v[72:75]
    s_add_u32 s28, s28, s31
    s_waitcnt lgkmcnt(11)
    v_mfma_f32_16x16x32_bf16 v[80:83], a[64:67], a[48:51], v[80:83]
    v_mfma_f32_16x16x32_bf16 v[80:83], a[68:71], a[52:55], v[80:83]
    v_mfma_f32_16x16x32_bf16 v[84:87], a[76:79], a[52:55], v[84:87]
    v_mfma_f32_16x16x32_bf16 v[84:87], a[72:75], a[48:51], v[84:87]
    s_waitcnt lgkmcnt(8)
    v_mfma_f32_16x16x32_bf16 v[92:95], a[72:75], a[56:59], v[92:95]
    buffer_store_dwordx4 a[204:207], v2, s[24:27], s28 offen sc1
    v_mfma_f32_16x16x32_bf16 v[92:95], a[76:79], a[60:63], v[92:95]
    s_add_u32 s28, s28, s31
    v_mfma_f32_16x16x32_bf16 v[88:91], a[68:71], a[60:63], v[88:91]
    s_waitcnt vmcnt(16) lgkmcnt(0)
    v_mfma_f32_16x16x32_bf16 v[88:91], a[64:67], a[56:59], v[88:91]
    s_barrier
    v_mfma_f32_16x16x32_bf16 v[96:99], a[80:83], a[0:3], v[96:99]
    ds_read_b64_tr_b16 a[64:65], v8 offset:0
    v_mfma_f32_16x16x32_bf16 v[96:99], a[84:87], a[4:7], v[96:99]
    s_add_u32 m0, s62, 0
    v_mfma_f32_16x16x32_bf16 v[100:103], a[92:95], a[4:7], v[100:103]
    buffer_load_dwordx4 v18, s[44:47], s52 offen offset:0 sc1 lds
    v_mfma_f32_16x16x32_bf16 v[100:103], a[88:91], a[0:3], v[100:103]
    ds_read_b64_tr_b16 a[66:67], v8 offset:2048
    v_mfma_f32_16x16x32_bf16 v[108:111], a[88:91], a[8:11], v[108:111]
    s_add_u32 s64, s64, 32768
    v_mfma_f32_16x16x32_bf16 v[108:111], a[92:95], a[12:15], v[108:111]
    s_cmp_ge_u32 s64, 98304
    s_cselect_b32 s63, 4294901760, s59
    s_cselect_b32 s64, 0, s64
    v_mfma_f32_16x16x32_bf16 v[104:107], a[84:87], a[12:15], v[104:107]
    buffer_load_dwordx4 v19, s[44:47], s52 offen offset:1024 sc1 lds
    v_mfma_f32_16x16x32_bf16 v[104:107], a[80:83], a[8:11], v[104:107]
    s_add_u32 s52, s52, s56
    ds_read_b64_tr_b16 a[68:69], v8 offset:16384
    v_mfma_f32_16x16x32_bf16 v[112:115], a[80:83], a[16:19], v[112:115]
    v_mfma_f32_16x16x32_bf16 v[112:115], a[84:87], a[20:23], v[112:115]
    v_mfma_f32_16x16x32_bf16 v[116:119], a[92:95], a[20:23], v[116:119]
    buffer_load_dwordx4 v18, s[44:47], s53 offen offset:2048 sc1 lds
    v_mfma_f32_16x16x32_bf16 v[116:119], a[88:91], a[16:19], v[116:119]
    ds_read_b64_tr_b16 a[70:71], v8 offset:18432
    v_mfma_f32_16x16x32_bf16 v[124:127], a[88:91], a[24:27], v[124:127]
    v_mfma_f32_16x16x32_bf16 v[124:127], a[92:95], a[28:31], v[124:127]
    v_mfma_f32_16x16x32_bf16 v[120:123], a[84:87], a[28:31], v[120:123]
    buffer_load_dwordx4 v19, s[44:47], s53 offen offset:3072 sc1 lds
    v_mfma_f32_16x16x32_bf16 v[120:123], a[80:83], a[24:27], v[120:123]
    s_add_u32 s53, s53, s56
    ds_read_b64_tr_b16 a[72:73], v9 offset:0
    v_mfma_f32_16x16x32_bf16 v[128:131], a[80:83], a[32:35], v[128:131]
    v_mfma_f32_16x16x32_bf16 v[128:131], a[84:87], a[36:39], v[128:131]
    s_add_u32 m0, s62, 4096
    v_mfma_f32_16x16x32_bf16 v[132:135], a[92:95], a[36:39], v[132:135]
    buffer_load_dwordx4 v20, s[44:47], s54 offen offset:0 sc1 lds
    v_mfma_f32_16x16x32_bf16 v[132:135], a[88:91], a[32:35], v[132:135]
    s_xor_b32 s62, s62, 229376
    ds_read_b64_tr_b16 a[74:75], v9 offset:2048
    v_mfma_f32_16x16x32_bf16 v[140:143], a[88:91], a[40:43], v[140:143]
    v_mfma_f32_16x16x32_bf16 v[140:143], a[92:95], a[44:47], v[140:143]
    v_mfma_f32_16x16x32_bf16 v[136:139], a[84:87], a[44:47], v[136:139]
    buffer_load_dwordx4 v21, s[44:47], s54 offen offset:1024 sc1 lds
    v_mfma_f32_16x16x32_bf16 v[136:139], a[80:83], a[40:43], v[136:139]
    s_add_u32 s54, s54, s56
    ds_read_b64_tr_b16 a[76:77], v9 offset:16384
    v_mfma_f32_16x16x32_bf16 v[144:147], a[80:83], a[48:51], v[144:147]
    v_mfma_f32_16x16x32_bf16 v[144:147], a[84:87], a[52:55], v[144:147]
    v_mfma_f32_16x16x32_bf16 v[148:151], a[92:95], a[52:55], v[148:151]
    buffer_load_dwordx4 v20, s[44:47], s55 offen offset:2048 sc1 lds
    v_mfma_f32_16x16x32_bf16 v[148:151], a[88:91], a[48:51], v[148:151]
    ds_read_b64_tr_b16 a[78:79], v9 offset:18432
    v_mfma_f32_16x16x32_bf16 v[156:159], a[88:91], a[56:59], v[156:159]
    v_add_u32 v6, s63, v6
    v_add_u32 v7, s63, v7
    v_mfma_f32_16x16x32_bf16 v[156:159], a[92:95], a[60:63], v[156:159]
    v_mfma_f32_16x16x32_bf16 v[152:155], a[84:87], a[60:63], v[152:155]
    buffer_load_dwordx4 v21, s[44:47], s55 offen offset:3072 sc1 lds
    v_mfma_f32_16x16x32_bf16 v[152:155], a[80:83], a[56:59], v[152:155]
    s_add_u32 s55, s55, s56
    v_mfma_f32_16x16x32_bf16 v[160:163], a[96:99], a[0:3], v[160:163]
    ds_read_b64_tr_b16 a[80:81], v10 offset:0
    v_mfma_f32_16x16x32_bf16 v[160:163], a[100:103], a[4:7], v[160:163]
    v_mfma_f32_16x16x32_bf16 v[164:167], a[108:111], a[4:7], v[164:167]
    v_mfma_f32_16x16x32_bf16 v[164:167], a[104:107], a[0:3], v[164:167]
    s_add_u32 m0, s61, 0
    ds_read_b64_tr_b16 a[82:83], v10 offset:2048
    v_mfma_f32_16x16x32_bf16 v[172:175], a[104:107], a[8:11], v[172:175]
    buffer_load_dwordx4 v16, s[40:43], s48 offen offset:0 sc1 lds
    v_mfma_f32_16x16x32_bf16 v[172:175], a[108:111], a[12:15], v[172:175]
    v_mfma_f32_16x16x32_bf16 v[168:171], a[100:103], a[12:15], v[168:171]
    ds_read_b64_tr_b16 a[84:85], v10 offset:16384
    v_mfma_f32_16x16x32_bf16 v[168:171], a[96:99], a[8:11], v[168:171]
    v_mfma_f32_16x16x32_bf16 v[176:179], a[96:99], a[16:19], v[176:179]
    buffer_store_dwordx4 a[208:211], v2, s[24:27], s28 offen sc1
    v_mfma_f32_16x16x32_bf16 v[176:179], a[100:103], a[20:23], v[176:179]
    s_add_u32 s28, s28, s31
    ds_read_b64_tr_b16 a[86:87], v10 offset:18432
    v_mfma_f32_16x16x32_bf16 v[180:183], a[108:111], a[20:23], v[180:183]
    v_mfma_f32_16x16x32_bf16 v[180:183], a[104:107], a[16:19], v[180:183]
    v_mfma_f32_16x16x32_bf16 v[188:191], a[104:107], a[24:27], v[188:191]
    buffer_load_dwordx4 v17, s[40:43], s48 offen offset:1024 sc1 lds
    v_mfma_f32_16x16x32_bf16 v[188:191], a[108:111], a[28:31], v[188:191]
    s_add_u32 s48, s48, 128
    ds_read_b64_tr_b16 a[88:89], v11 offset:0
    v_mfma_f32_16x16x32_bf16 v[184:187], a[100:103], a[28:31], v[184:187]
    v_mfma_f32_16x16x32_bf16 v[184:187], a[96:99], a[24:27], v[184:187]
    v_mfma_f32_16x16x32_bf16 v[192:195], a[96:99], a[32:35], v[192:195]
    buffer_store_dwordx4 a[212:215], v2, s[24:27], s28 offen sc1
    v_mfma_f32_16x16x32_bf16 v[192:195], a[100:103], a[36:39], v[192:195]
    s_add_u32 s28, s28, s31
    ds_read_b64_tr_b16 a[90:91], v11 offset:2048
    v_mfma_f32_16x16x32_bf16 v[196:199], a[108:111], a[36:39], v[196:199]
    v_mfma_f32_16x16x32_bf16 v[196:199], a[104:107], a[32:35], v[196:199]
    v_mfma_f32_16x16x32_bf16 v[204:207], a[104:107], a[40:43], v[204:207]
    buffer_load_dwordx4 v16, s[40:43], s49 offen offset:2048 sc1 lds
    v_mfma_f32_16x16x32_bf16 v[204:207], a[108:111], a[44:47], v[204:207]
    ds_read_b64_tr_b16 a[92:93], v11 offset:16384
    v_mfma_f32_16x16x32_bf16 v[200:203], a[100:103], a[44:47], v[200:203]
    v_mfma_f32_16x16x32_bf16 v[200:203], a[96:99], a[40:43], v[200:203]
    v_mfma_f32_16x16x32_bf16 v[208:211], a[96:99], a[48:51], v[208:211]
    buffer_store_dwordx4 a[216:219], v2, s[24:27], s28 offen sc1
    v_mfma_f32_16x16x32_bf16 v[208:211], a[100:103], a[52:55], v[208:211]
    s_add_u32 s28, s28, s31
    ds_read_b64_tr_b16 a[94:95], v11 offset:18432
    v_mfma_f32_16x16x32_bf16 v[212:215], a[108:111], a[52:55], v[212:215]
    v_mfma_f32_16x16x32_bf16 v[212:215], a[104:107], a[48:51], v[212:215]
    v_mfma_f32_16x16x32_bf16 v[220:223], a[104:107], a[56:59], v[220:223]
    buffer_load_dwordx4 v17, s[40:43], s49 offen offset:3072 sc1 lds
    v_mfma_f32_16x16x32_bf16 v[220:223], a[108:111], a[60:63], v[220:223]
    s_add_u32 s49, s49, 128
    v_mfma_f32_16x16x32_bf16 v[216:219], a[100:103], a[60:63], v[216:219]
    buffer_store_dwordx4 a[220:223], v2, s[24:27], s28 offen sc1
    v_mfma_f32_16x16x32_bf16 v[216:219], a[96:99], a[56:59], v[216:219]
    s_add_u32 s29, s29, s30
    s_mov_b32 s28, s29
    v_mfma_f32_16x16x32_bf16 v[224:227], a[112:115], a[0:3], v[224:227]
    v_mfma_f32_16x16x32_bf16 v[224:227], a[116:119], a[4:7], v[224:227]
    ds_read_b64_tr_b16 a[96:97], v12 offset:0
    v_mfma_f32_16x16x32_bf16 v[228:231], a[124:127], a[4:7], v[228:231]
    v_mfma_f32_16x16x32_bf16 v[228:231], a[120:123], a[0:3], v[228:231]
    s_add_u32 m0, s61, 4096
    ds_read_b128 a[0:3], v6 offset:0
    v_mfma_f32_16x16x32_bf16 v[236:239], a[120:123], a[8:11], v[236:239]
    buffer_load_dwordx4 v16, s[40:43], s50 offen offset:0 sc1 lds
    v_mfma_f32_16x16x32_bf16 v[236:239], a[124:127], a[12:15], v[236:239]
    s_add_u32 s61, s61, 32768
    ds_read_b128 a[4:7], v7 offset:0
    v_mfma_f32_16x16x32_bf16 v[232:235], a[116:119], a[12:15], v[232:235]
    s_cmp_ge_u32 s61, 98304
    s_cselect_b32 s90, 98304, 0
    ds_read_b64_tr_b16 a[98:99], v12 offset:2048
    v_mfma_f32_16x16x32_bf16 v[232:235], a[112:115], a[8:11], v[232:235]
    s_sub_u32 s61, s61, s90
    ds_read_b128 a[8:11], v6 offset:2048
    v_mfma_f32_16x16x32_bf16 v[240:243], a[112:115], a[16:19], v[240:243]
    ds_read_b128 a[12:15], v7 offset:2048
    v_mfma_f32_16x16x32_bf16 v[240:243], a[116:119], a[20:23], v[240:243]
    ds_read_b64_tr_b16 a[100:101], v12 offset:16384
    v_mfma_f32_16x16x32_bf16 v[244:247], a[124:127], a[20:23], v[244:247]
    v_mfma_f32_16x16x32_bf16 v[244:247], a[120:123], a[16:19], v[244:247]
    ds_read_b128 a[16:19], v6 offset:4096
    v_mfma_f32_16x16x32_bf16 v[252:255], a[120:123], a[24:27], v[252:255]
    buffer_load_dwordx4 v17, s[40:43], s50 offen offset:1024 sc1 lds
    v_mfma_f32_16x16x32_bf16 v[252:255], a[124:127], a[28:31], v[252:255]
    s_add_u32 s50, s50, 128
    ds_read_b128 a[20:23], v7 offset:4096
    v_mfma_f32_16x16x32_bf16 v[248:251], a[116:119], a[28:31], v[248:251]
    ds_read_b64_tr_b16 a[102:103], v12 offset:18432
    v_mfma_f32_16x16x32_bf16 v[248:251], a[112:115], a[24:27], v[248:251]
    ds_read_b128 a[24:27], v6 offset:6144
    v_mfma_f32_16x16x32_bf16 a[224:227], a[112:115], a[32:35], a[224:227]
    s_sub_u32 s65, s65, 1
    ds_read_b128 a[28:31], v7 offset:6144
    v_mfma_f32_16x16x32_bf16 a[224:227], a[116:119], a[36:39], a[224:227]
    ds_read_b64_tr_b16 a[104:105], v13 offset:0
    v_mfma_f32_16x16x32_bf16 a[228:231], a[124:127], a[36:39], a[228:231]
    v_mfma_f32_16x16x32_bf16 a[228:231], a[120:123], a[32:35], a[228:231]
    ds_read_b128 a[32:35], v6 offset:8192
    v_mfma_f32_16x16x32_bf16 a[236:239], a[120:123], a[40:43], a[236:239]
    buffer_load_dwordx4 v16, s[40:43], s51 offen offset:2048 sc1 lds
    v_mfma_f32_16x16x32_bf16 a[236:239], a[124:127], a[44:47], a[236:239]
    ds_read_b128 a[36:39], v7 offset:8192
    v_mfma_f32_16x16x32_bf16 a[232:235], a[116:119], a[44:47], a[232:235]
    ds_read_b64_tr_b16 a[106:107], v13 offset:2048
    v_mfma_f32_16x16x32_bf16 a[232:235], a[112:115], a[40:43], a[232:235]
    ds_read_b128 a[40:43], v6 offset:10240
    v_mfma_f32_16x16x32_bf16 a[240:243], a[112:115], a[48:51], a[240:243]
    ds_read_b128 a[44:47], v7 offset:10240
    v_mfma_f32_16x16x32_bf16 a[240:243], a[116:119], a[52:55], a[240:243]
    ds_read_b64_tr_b16 a[108:109], v13 offset:16384
    v_mfma_f32_16x16x32_bf16 a[244:247], a[124:127], a[52:55], a[244:247]
    v_mfma_f32_16x16x32_bf16 a[244:247], a[120:123], a[48:51], a[244:247]
    ds_read_b128 a[48:51], v6 offset:12288
    v_mfma_f32_16x16x32_bf16 a[252:255], a[120:123], a[56:59], a[252:255]
    buffer_load_dwordx4 v17, s[40:43], s51 offen offset:3072 sc1 lds
    v_mfma_f32_16x16x32_bf16 a[252:255], a[124:127], a[60:63], a[252:255]
    s_add_u32 s51, s51, 128
    ds_read_b128 a[52:55], v7 offset:12288
    v_mfma_f32_16x16x32_bf16 a[248:251], a[116:119], a[60:63], a[248:251]
    ds_read_b64_tr_b16 a[110:111], v13 offset:18432
    v_mfma_f32_16x16x32_bf16 a[248:251], a[112:115], a[56:59], a[248:251]
    ds_read_b128 a[56:59], v6 offset:14336
    ds_read_b128 a[60:63], v7 offset:14336
m_loop16:
    s_waitcnt lgkmcnt(15)
    v_mfma_f32_16x16x32_bf16 v[32:35], a[64:67], a[0:3], v[32:35]
    ds_read_b64_tr_b16 a[112:113], v14 offset:0
    v_mfma_f32_16x16x32_bf16 v[32:35], a[68:71], a[4:7], v[32:35]
    ds_read_b64_tr_b16 a[114:115], v14 offset:2048
    v_mfma_f32_16x16x32_bf16 v[36:39], a[76:79], a[4:7], v[36:39]
    ds_read_b64_tr_b16 a[116:117], v14 offset:16384
    v_mfma_f32_16x16x32_bf16 v[36:39], a[72:75], a[0:3], v[36:39]
    ds_read_b64_tr_b16 a[118:119], v14 offset:18432
    v_mfma_f32_16x16x32_bf16 v[44:47], a[72:75], a[8:11], v[44:47]
    ds_read_b64_tr_b16 a[120:121], v15 offset:0
    v_mfma_f32_16x16x32_bf16 v[44:47], a[76:79], a[12:15], v[44:47]
    ds_read_b64_tr_b16 a[122:123], v15 offset:2048
    v_mfma_f32_16x16x32_bf16 v[40:43], a[68:71], a[12:15], v[40:43]
    ds_read_b64_tr_b16 a[124:125], v15 offset:16384
    v_mfma_f32_16x16x32_bf16 v[40:43], a[64:67], a[8:11], v[40:43]
    ds_read_b64_tr_b16 a[126:127], v15 offset:18432
    v_mfma_f32_16x16x32_bf16 v[48:51], a[64:67], a[16:19], v[48:51]
    v_mfma_f32_16x16x32_bf16 v[48:51], a[68:71], a[20:23], v[48:51]
    v_mfma_f32_16x16x32_bf16 v[52:55], a[76:79], a[20:23], v[52:55]
    v_mfma_f32_16x16x32_bf16 v[52:55], a[72:75], a[16:19], v[52:55]
    s_waitcnt lgkmcnt(15)
    v_mfma_f32_16x16x32_bf16 v[60:63], a[72:75], a[24:27], v[60:63]
    v_xor_b32 v8, s60, v8
    v_xor_b32 v9, s60, v9
    v_mfma_f32_16x16x32_bf16 v[60:63], a[76:79], a[28:31], v[60:63]
    v_xor_b32 v10, s60, v10
    v_xor_b32 v11, s60, v11
    v_mfma_f32_16x16x32_bf16 v[56:59], a[68:71], a[28:31], v[56:59]
    v_xor_b32 v12, s60, v12
    v_xor_b32 v13, s60, v13
    v_mfma_f32_16x16x32_bf16 v[56:59], a[64:67], a[24:27], v[56:59]
    v_xor_b32 v14, s60, v14
    v_xor_b32 v15, s60, v15
    v_mfma_f32_16x16x32_bf16 v[64:67], a[64:67], a[32:35], v[64:67]
    v_mfma_f32_16x16x32_bf16 v[64:67], a[68:71], a[36:39], v[64:67]
    v_mfma_f32_16x16x32_bf16 v[68:71], a[76:79], a[36:39], v[68:71]
    v_mfma_f32_16x16x32_bf16 v[68:71], a[72:75], a[32:35], v[68:71]
    s_waitcnt lgkmcnt(14)
    v_mfma_f32_16x16x32_bf16 v[76:79], a[72:75], a[40:43], v[76:79]
    v_mfma_f32_16x16x32_bf16 v[76:79], a[76:79], a[44:47], v[76:79]
    v_mfma_f32_16x16x32_bf16 v[72:75], a[68:71], a[44:47], v[72:75]
    v_mfma_f32_16x16x32_bf16 v[72:75], a[64:67], a[40:43], v[72:75]
    s_waitcnt lgkmcnt(11)
    v_mfma_f32_16x16x32_bf16 v[80:83], a[64:67], a[48:51], v[80:83]
    v_mfma_f32_16x16x32_bf16 v[80:83], a[68:71], a[52:55], v[80:83]
    v_mfma_f32_16x16x32_bf16 v[84:87], a[76:79], a[52:55], v[84:87]
    v_mfma_f32_16x16x32_bf16 v[84:87], a[72:75], a[48:51], v[84:87]
    s_waitcnt lgkmcnt(8)
    v_mfma_f32_16x16x32_bf16 v[92:95], a[72:75], a[56:59], v[92:95]
    v_mfma_f32_16x16x32_bf16 v[92:95], a[76:79], a[60:63], v[92:95]
    v_mfma_f32_16x16x32_bf16 v[88:91], a[68:71], a[60:63], v[88:91]
    s_waitcnt vmcnt(8) lgkmcnt(0)
    v_mfma_f32_16x16x32_bf16 v[88:91], a[64:67], a[56:59], v[88:91]
    s_barrier
    v_mfma_f32_16x16x32_bf16 v[96:99], a[80:83], a[0:3], v[96:99]
    ds_read_b64_tr_b16 a[64:65], v8 offset:0
    v_mfma_f32_16x16x32_bf16 v[96:99], a[84:87], a[4:7], v[96:99]
    s_add_u32 m0, s62, 0
    v_mfma_f32_16x16x32_bf16 v[100:103], a[92:95], a[4:7], v[100:103]
    buffer_load_dwordx4 v18, s[44:47], s52 offen offset:0 sc1 lds
    v_mfma_f32_16x16x32_bf16 v[100:103], a[88:91], a[0:3], v[100:103]
    ds_read_b64_tr_b16 a[66:67], v8 offset:2048
    v_mfma_f32_16x16x32_bf16 v[108:111], a[88:91], a[8:11], v[108:111]
    s_add_u32 s64, s64, 32768
    v_mfma_f32_16x16x32_bf16 v[108:111], a[92:95], a[12:15], v[108:111]
    s_cmp_ge_u32 s64, 98304
    s_cselect_b32 s63, 4294901760, s59
    s_cselect_b32 s64, 0, s64
    v_mfma_f32_16x16x32_bf16 v[104:107], a[84:87], a[12:15], v[104:107]
    buffer_load_dwordx4 v19, s[44:47], s52 offen offset:1024 sc1 lds
    v_mfma_f32_16x16x32_bf16 v[104:107], a[80:83], a[8:11], v[104:107]
    s_add_u32 s52, s52, s56
    ds_read_b64_tr_b16 a[68:69], v8 offset:16384
    v_mfma_f32_16x16x32_bf16 v[112:115], a[80:83], a[16:19], v[112:115]
    v_mfma_f32_16x16x32_bf16 v[112:115], a[84:87], a[20:23], v[112:115]
    v_mfma_f32_16x16x32_bf16 v[116:119], a[92:95], a[20:23], v[116:119]
    buffer_load_dwordx4 v18, s[44:47], s53 offen offset:2048 sc1 lds
    v_mfma_f32_16x16x32_bf16 v[116:119], a[88:91], a[16:19], v[116:119]
    ds_read_b64_tr_b16 a[70:71], v8 offset:18432
    v_mfma_f32_16x16x32_bf16 v[124:127], a[88:91], a[24:27], v[124:127]
    v_mfma_f32_16x16x32_bf16 v[124:127], a[92:95], a[28:31], v[124:127]
    v_mfma_f32_16x16x32_bf16 v[120:123], a[84:87], a[28:31], v[120:123]
    buffer_load_dwordx4 v19, s[44:47], s53 offen offset:3072 sc1 lds
    v_mfma_f32_16x16x32_bf16 v[120:123], a[80:83], a[24:27], v[120:123]
    s_add_u32 s53, s53, s56
    ds_read_b64_tr_b16 a[72:73], v9 offset:0
    v_mfma_f32_16x16x32_bf16 v[128:131], a[80:83], a[32:35], v[128:131]
    v_mfma_f32_16x16x32_bf16 v[128:131], a[84:87], a[36:39], v[128:131]
    s_add_u32 m0, s62, 4096
    v_mfma_f32_16x16x32_bf16 v[132:135], a[92:95], a[36:39], v[132:135]
    buffer_load_dwordx4 v20, s[44:47], s54 offen offset:0 sc1 lds
    v_mfma_f32_16x16x32_bf16 v[132:135], a[88:91], a[32:35], v[132:135]
    s_xor_b32 s62, s62, 229376
    ds_read_b64_tr_b16 a[74:75], v9 offset:2048
    v_mfma_f32_16x16x32_bf16 v[140:143], a[88:91], a[40:43], v[140:143]
    v_mfma_f32_16x16x32_bf16 v[140:143], a[92:95], a[44:47], v[140:143]
    v_mfma_f32_16x16x32_bf16 v[136:139], a[84:87], a[44:47], v[136:139]
    buffer_load_dwordx4 v21, s[44:47], s54 offen offset:1024 sc1 lds
    v_mfma_f32_16x16x32_bf16 v[136:139], a[80:83], a[40:43], v[136:139]
    s_add_u32 s54, s54, s56
    ds_read_b64_tr_b16 a[76:77], v9 offset:16384
    v_mfma_f32_16x16x32_bf16 v[144:147], a[80:83], a[48:51], v[144:147]
    v_mfma_f32_16x16x32_bf16 v[144:147], a[84:87], a[52:55], v[144:147]
    v_mfma_f32_16x16x32_bf16 v[148:151], a[92:95], a[52:55], v[148:151]
    buffer_load_dwordx4 v20, s[44:47], s55 offen offset:2048 sc1 lds
    v_mfma_f32_16x16x32_bf16 v[148:151], a[88:91], a[48:51], v[148:151]
    ds_read_b64_tr_b16 a[78:79], v9 offset:18432
    v_mfma_f32_16x16x32_bf16 v[156:159], a[88:91], a[56:59], v[156:159]
    v_add_u32 v6, s63, v6
    v_add_u32 v7, s63, v7
    v_mfma_f32_16x16x32_bf16 v[156:159], a[92:95], a[60:63], v[156:159]
    v_mfma_f32_16x16x32_bf16 v[152:155], a[84:87], a[60:63], v[152:155]
    buffer_load_dwordx4 v21, s[44:47], s55 offen offset:3072 sc1 lds
    v_mfma_f32_16x16x32_bf16 v[152:155], a[80:83], a[56:59], v[152:155]
    s_add_u32 s55, s55, s56
    v_mfma_f32_16x16x32_bf16 v[160:163], a[96:99], a[0:3], v[160:163]
    ds_read_b64_tr_b16 a[80:81], v10 offset:0
    v_mfma_f32_16x16x32_bf16 v[160:163], a[100:103], a[4:7], v[160:163]
    v_mfma_f32_16x16x32_bf16 v[164:167], a[108:111], a[4:7], v[164:167]
    v_mfma_f32_16x16x32_bf16 v[164:167], a[104:107], a[0:3], v[164:167]
    s_add_u32 m0, s61, 0
    ds_read_b64_tr_b16 a[82:83], v10 offset:2048
    v_mfma_f32_16x16x32_bf16 v[172:175], a[104:107], a[8:11], v[172:175]
    buffer_load_dwordx4 v16, s[40:43], s48 offen offset:0 sc1 lds
    v_mfma_f32_16x16x32_bf16 v[172:175], a[108:111], a[12:15], v[172:175]
    v_mfma_f32_16x16x32_bf16 v[168:171], a[100:103], a[12:15], v[168:171]
    ds_read_b64_tr_b16 a[84:85], v10 offset:16384
    v_mfma_f32_16x16x32_bf16 v[168:171], a[96:99], a[8:11], v[168:171]
    v_mfma_f32_16x16x32_bf16 v[176:179], a[96:99], a[16:19], v[176:179]
    v_mfma_f32_16x16x32_bf16 v[176:179], a[100:103], a[20:23], v[176:179]
    ds_read_b64_tr_b16 a[86:87], v10 offset:18432
    v_mfma_f32_16x16x32_bf16 v[180:183], a[108:111], a[20:23], v[180:183]
    v_mfma_f32_16x16x32_bf16 v[180:183], a[104:107], a[16:19], v[180:183]
    v_mfma_f32_16x16x32_bf16 v[188:191], a[104:107], a[24:27], v[188:191]
    buffer_load_dwordx4 v17, s[40:43], s48 offen offset:1024 sc1 lds
    v_mfma_f32_16x16x32_bf16 v[188:191], a[108:111], a[28:31], v[188:191]
    s_add_u32 s48, s48, 128
    ds_read_b64_tr_b16 a[88:89], v11 offset:0
    v_mfma_f32_16x16x32_bf16 v[184:187], a[100:103], a[28:31], v[184:187]
    v_mfma_f32_16x16x32_bf16 v[184:187], a[96:99], a[24:27], v[184:187]
    v_mfma_f32_16x16x32_bf16 v[192:195], a[96:99], a[32:35], v[192:195]
    v_mfma_f32_16x16x32_bf16 v[192:195], a[100:103], a[36:39], v[192:195]
    ds_read_b64_tr_b16 a[90:91], v11 offset:2048
    v_mfma_f32_16x16x32_bf16 v[196:199], a[108:111], a[36:39], v[196:199]
    v_mfma_f32_16x16x32_bf16 v[196:199], a[104:107], a[32:35], v[196:199]
    v_mfma_f32_16x16x32_bf16 v[204:207], a[104:107], a[40:43], v[204:207]
    buffer_load_dwordx4 v16, s[40:43], s49 offen offset:2048 sc1 lds
    v_mfma_f32_16x16x32_bf16 v[204:207], a[108:111], a[44:47], v[204:207]
    ds_read_b64_tr_b16 a[92:93], v11 offset:16384
    v_mfma_f32_16x16x32_bf16 v[200:203], a[100:103], a[44:47], v[200:203]
    v_mfma_f32_16x16x32_bf16 v[200:203], a[96:99], a[40:43], v[200:203]
    v_mfma_f32_16x16x32_bf16 v[208:211], a[96:99], a[48:51], v[208:211]
    v_mfma_f32_16x16x32_bf16 v[208:211], a[100:103], a[52:55], v[208:211]
    ds_read_b64_tr_b16 a[94:95], v11 offset:18432
    v_mfma_f32_16x16x32_bf16 v[212:215], a[108:111], a[52:55], v[212:215]
    v_mfma_f32_16x16x32_bf16 v[212:215], a[104:107], a[48:51], v[212:215]
    v_mfma_f32_16x16x32_bf16 v[220:223], a[104:107], a[56:59], v[220:223]
    buffer_load_dwordx4 v17, s[40:43], s49 offen offset:3072 sc1 lds
    v_mfma_f32_16x16x32_bf16 v[220:223], a[108:111], a[60:63], v[220:223]
    s_add_u32 s49, s49, 128
    v_mfma_f32_16x16x32_bf16 v[216:219], a[100:103], a[60:63], v[216:219]
    v_mfma_f32_16x16x32_bf16 v[216:219], a[96:99], a[56:59], v[216:219]
    v_mfma_f32_16x16x32_bf16 v[224:227], a[112:115], a[0:3], v[224:227]
    v_mfma_f32_16x16x32_bf16 v[224:227], a[116:119], a[4:7], v[224:227]
    ds_read_b64_tr_b16 a[96:97], v12 offset:0
    v_mfma_f32_16x16x32_bf16 v[228:231], a[124:127], a[4:7], v[228:231]
    v_mfma_f32_16x16x32_bf16 v[228:231], a[120:123], a[0:3], v[228:231]
    s_add_u32 m0, s61, 4096
    ds_read_b128 a[0:3], v6 offset:0
    v_mfma_f32_16x16x32_bf16 v[236:239], a[120:123], a[8:11], v[236:239]
    buffer_load_dwordx4 v16, s[40:43], s50 offen offset:0 sc1 lds
    v_mfma_f32_16x16x32_bf16 v[236:239], a[124:127], a[12:15], v[236:239]
    s_add_u32 s61, s61, 32768
    ds_read_b128 a[4:7], v7 offset:0
    v_mfma_f32_16x16x32_bf16 v[232:235], a[116:119], a[12:15], v[232:235]
    s_cmp_ge_u32 s61, 98304
    s_cselect_b32 s90, 98304, 0
    ds_read_b64_tr_b16 a[98:99], v12 offset:2048
    v_mfma_f32_16x16x32_bf16 v[232:235], a[112:115], a[8:11], v[232:235]
    s_sub_u32 s61, s61, s90
    ds_read_b128 a[8:11], v6 offset:2048
    v_mfma_f32_16x16x32_bf16 v[240:243], a[112:115], a[16:19], v[240:243]
    ds_read_b128 a[12:15], v7 offset:2048
    v_mfma_f32_16x16x32_bf16 v[240:243], a[116:119], a[20:23], v[240:243]
    ds_read_b64_tr_b16 a[100:101], v12 offset:16384
    v_mfma_f32_16x16x32_bf16 v[244:247], a[124:127], a[20:23], v[244:247]
    v_mfma_f32_16x16x32_bf16 v[244:247], a[120:123], a[16:19], v[244:247]
    ds_read_b128 a[16:19], v6 offset:4096
    v_mfma_f32_16x16x32_bf16 v[252:255], a[120:123], a[24:27], v[252:255]
    buffer_load_dwordx4 v17, s[40:43], s50 offen offset:1024 sc1 lds
    v_mfma_f32_16x16x32_bf16 v[252:255], a[124:127], a[28:31], v[252:255]
    s_add_u32 s50, s50, 128
    ds_read_b128 a[20:23], v7 offset:4096
    v_mfma_f32_16x16x32_bf16 v[248:251], a[116:119], a[28:31], v[248:251]
    ds_read_b64_tr_b16 a[102:103], v12 offset:18432
    v_mfma_f32_16x16x32_bf16 v[248:251], a[112:115], a[24:27], v[248:251]
    ds_read_b128 a[24:27], v6 offset:6144
    v_mfma_f32_16x16x32_bf16 a[224:227], a[112:115], a[32:35], a[224:227]
    s_sub_u32 s65, s65, 1
    ds_read_b128 a[28:31], v7 offset:6144
    v_mfma_f32_16x16x32_bf16 a[224:227], a[116:119], a[36:39], a[224:227]
    ds_read_b64_tr_b16 a[104:105], v13 offset:0
    v_mfma_f32_16x16x32_bf16 a[228:231], a[124:127], a[36:39], a[228:231]
    v_mfma_f32_16x16x32_bf16 a[228:231], a[120:123], a[32:35], a[228:231]
    ds_read_b128 a[32:35], v6 offset:8192
    v_mfma_f32_16x16x32_bf16 a[236:239], a[120:123], a[40:43], a[236:239]
    buffer_load_dwordx4 v16, s[40:43], s51 offen offset:2048 sc1 lds
    v_mfma_f32_16x16x32_bf16 a[236:239], a[124:127], a[44:47], a[236:239]
    ds_read_b128 a[36:39], v7 offset:8192
    v_mfma_f32_16x16x32_bf16 a[232:235], a[116:119], a[44:47], a[232:235]
    ds_read_b64_tr_b16 a[106:107], v13 offset:2048
    v_mfma_f32_16x16x32_bf16 a[232:235], a[112:115], a[40:43], a[232:235]
    ds_read_b128 a[40:43], v6 offset:10240
    v_mfma_f32_16x16x32_bf16 a[240:243], a[112:115], a[48:51], a[240:243]
    ds_read_b128 a[44:47], v7 offset:10240
    v_mfma_f32_16x16x32_bf16 a[240:243], a[116:119], a[52:55], a[240:243]
    ds_read_b64_tr_b16 a[108:109], v13 offset:16384
    v_mfma_f32_16x16x32_bf16 a[244:247], a[124:127], a[52:55], a[244:247]
    v_mfma_f32_16x16x32_bf16 a[244:247], a[120:123], a[48:51], a[244:247]
    ds_read_b128 a[48:51], v6 offset:12288
    v_mfma_f32_16x16x32_bf16 a[252:255], a[120:123], a[56:59], a[252:255]
    buffer_load_dwordx4 v17, s[40:43], s51 offen offset:3072 sc1 lds
    v_mfma_f32_16x16x32_bf16 a[252:255], a[124:127], a[60:63], a[252:255]
    s_add_u32 s51, s51, 128
    ds_read_b128 a[52:55], v7 offset:12288
    v_mfma_f32_16x16x32_bf16 a[248:251], a[116:119], a[60:63], a[248:251]
    s_cmp_gt_u32 s65, s67
    ds_read_b64_tr_b16 a[110:111], v13 offset:18432
    v_mfma_f32_16x16x32_bf16 a[248:251], a[112:115], a[56:59], a[248:251]
    ds_read_b128 a[56:59], v6 offset:14336
    ds_read_b128 a[60:63], v7 offset:14336
    s_cbranch_scc1 m_loop16
    s_cmp_lg_u32 s65, 0
    s_cbranch_scc1 m_dosw17
    s_branch m_epi12
m_swp13:
    s_waitcnt lgkmcnt(15)
    v_mfma_f32_16x16x32_bf16 v[32:35], a[0:3], a[64:67], 0
    ds_read_b64_tr_b16 a[112:113], v14 offset:0
    v_mfma_f32_16x16x32_bf16 v[32:35], a[4:7], a[68:71], v[32:35]
    ds_read_b64_tr_b16 a[114:115], v14 offset:2048
    v_mfma_f32_16x16x32_bf16 v[40:43], a[4:7], a[76:79], 0
    ds_read_b64_tr_b16 a[116:117], v14 offset:16384
    v_mfma_f32_16x16x32_bf16 v[40:43], a[0:3], a[72:75], v[40:43]
    ds_read_b64_tr_b16 a[118:119], v14 offset:18432
    v_mfma_f32_16x16x32_bf16 v[44:47], a[8:11], a[72:75], 0
    ds_read_b64_tr_b16 a[120:121], v15 offset:0
    v_mfma_f32_16x16x32_bf16 v[44:47], a[12:15], a[76:79], v[44:47]
    ds_read_b64_tr_b16 a[122:123], v15 offset:2048
    v_mfma_f32_16x16x32_bf16 v[36:39], a[12:15], a[68:71], 0
    ds_read_b64_tr_b16 a[124:125], v15 offset:16384
    v_mfma_f32_16x16x32_bf16 v[36:39], a[8:11], a[64:67], v[36:39]
    ds_read_b64_tr_b16 a[126:127], v15 offset:18432
    v_mfma_f32_16x16x32_bf16 v[96:99], a[16:19], a[64:67], 0
    v_mfma_f32_16x16x32_bf16 v[96:99], a[20:23], a[68:71], v[96:99]
    v_mfma_f32_16x16x32_bf16 v[104:107], a[20:23], a[76:79], 0
    buffer_store_dwordx4 a[128:131], v2, s[24:27], s28 offen sc1
    v_mfma_f32_16x16x32_bf16 v[104:107], a[16:19], a[72:75], v[104:107]
    s_add_u32 s28, s28, s31
    s_waitcnt lgkmcnt(15)
    v_mfma_f32_16x16x32_bf16 v[108:111], a[24:27], a[72:75], 0
    v_xor_b32 v8, s60, v8
    v_xor_b32 v9, s60, v9
    v_mfma_f32_16x16x32_bf16 v[108:111], a[28:31], a[76:79], v[108:111]
    v_xor_b32 v10, s60, v10
    v_xor_b32 v11, s60, v11
    v_mfma_f32_16x16x32_bf16 v[100:103], a[28:31], a[68:71], 0
    v_xor_b32 v12, s60, v12
    v_xor_b32 v13, s60, v13
    v_mfma_f32_16x16x32_bf16 v[100:103], a[24:27], a[64:67], v[100:103]
    v_xor_b32 v14, s60, v14
    v_xor_b32 v15, s60, v15
    v_mfma_f32_16x16x32_bf16 v[160:163], a[32:35], a[64:67], 0
    buffer_store_dwordx4 a[132:135], v2, s[24:27], s28 offen sc1
    v_mfma_f32_16x16x32_bf16 v[160:163], a[36:39], a[68:71], v[160:163]
    s_add_u32 s28, s28, s31
    v_mfma_f32_16x16x32_bf16 v[168:171], a[36:39], a[76:79], 0
    v_mfma_f32_16x16x32_bf16 v[168:171], a[32:35], a[72:75], v[168:171]
    s_waitcnt lgkmcnt(14)
    v_mfma_f32_16x16x32_bf16 v[172:175], a[40:43], a[72:75], 0
    v_mfma_f32_16x16x32_bf16 v[172:175], a[44:47], a[76:79], v[172:175]
    v_mfma_f32_16x16x32_bf16 v[164:167], a[44:47], a[68:71], 0
    buffer_store_dwordx4 a[136:139], v2, s[24:27], s28 offen sc1
    v_mfma_f32_16x16x32_bf16 v[164:167], a[40:43], a[64:67], v[164:167]
    s_add_u32 s28, s28, s31
    s_waitcnt lgkmcnt(11)
    v_mfma_f32_16x16x32_bf16 v[224:227], a[48:51], a[64:67], 0
    v_mfma_f32_16x16x32_bf16 v[224:227], a[52:55], a[68:71], v[224:227]
    v_mfma_f32_16x16x32_bf16 v[232:235], a[52:55], a[76:79], 0
    v_mfma_f32_16x16x32_bf16 v[232:235], a[48:51], a[72:75], v[232:235]
    s_waitcnt lgkmcnt(8)
    v_mfma_f32_16x16x32_bf16 v[236:239], a[56:59], a[72:75], 0
    buffer_store_dwordx4 a[140:143], v2, s[24:27], s28 offen sc1
    v_mfma_f32_16x16x32_bf16 v[236:239], a[60:63], a[76:79], v[236:239]
    s_add_u32 s28, s28, s31
    v_mfma_f32_16x16x32_bf16 v[228:231], a[60:63], a[68:71], 0
    s_waitcnt vmcnt(12) lgkmcnt(0)
    v_mfma_f32_16x16x32_bf16 v[228:231], a[56:59], a[64:67], v[228:231]
    s_barrier
    v_mfma_f32_16x16x32_bf16 v[48:51], a[0:3], a[80:83], 0
    ds_read_b64_tr_b16 a[64:65], v8 offset:0
    v_mfma_f32_16x16x32_bf16 v[48:51], a[4:7], a[84:87], v[48:51]
    s_add_u32 m0, s62, 0
    v_mfma_f32_16x16x32_bf16 v[56:59], a[4:7], a[92:95], 0
    buffer_load_dwordx4 v18, s[44:47], s52 offen offset:0 sc1 lds
    v_mfma_f32_16x16x32_bf16 v[56:59], a[0:3], a[88:91], v[56:59]
    ds_read_b64_tr_b16 a[66:67], v8 offset:2048
    v_mfma_f32_16x16x32_bf16 v[60:63], a[8:11], a[88:91], 0
    s_add_u32 s64, s64, 32768
    v_mfma_f32_16x16x32_bf16 v[60:63], a[12:15], a[92:95], v[60:63]
    s_cmp_ge_u32 s64, 98304
    s_cselect_b32 s63, 4294901760, s59
    s_cselect_b32 s64, 0, s64
    v_mfma_f32_16x16x32_bf16 v[52:55], a[12:15], a[84:87], 0
    buffer_load_dwordx4 v19, s[44:47], s52 offen offset:1024 sc1 lds
    v_mfma_f32_16x16x32_bf16 v[52:55], a[8:11], a[80:83], v[52:55]
    s_add_u32 s52, s52, s56
    ds_read_b64_tr_b16 a[68:69], v8 offset:16384
    v_mfma_f32_16x16x32_bf16 v[112:115], a[16:19], a[80:83], 0
    v_mfma_f32_16x16x32_bf16 v[112:115], a[20:23], a[84:87], v[112:115]
    v_mfma_f32_16x16x32_bf16 v[120:123], a[20:23], a[92:95], 0
    buffer_load_dwordx4 v18, s[44:47], s53 offen offset:2048 sc1 lds
    v_mfma_f32_16x16x32_bf16 v[120:123], a[16:19], a[88:91], v[120:123]
    ds_read_b64_tr_b16 a[70:71], v8 offset:18432
    v_mfma_f32_16x16x32_bf16 v[124:127], a[24:27], a[88:91], 0
    v_mfma_f32_16x16x32_bf16 v[124:127], a[28:31], a[92:95], v[124:127]
    v_mfma_f32_16x16x32_bf16 v[116:119], a[28:31], a[84:87], 0
    buffer_load_dwordx4 v19, s[44:47], s53 offen offset:3072 sc1 lds
    v_mfma_f32_16x16x32_bf16 v[116:119], a[24:27], a[80:83], v[116:119]
    s_add_u32 s53, s53, s56
    ds_read_b64_tr_b16 a[72:73], v9 offset:0
    v_mfma_f32_16x16x32_bf16 v[176:179], a[32:35], a[80:83], 0
    v_mfma_f32_16x16x32_bf16 v[176:179], a[36:39], a[84:87], v[176:179]
    s_add_u32 m0, s62, 4096
    v_mfma_f32_16x16x32_bf16 v[184:187], a[36:39], a[92:95], 0
    buffer_load_dwordx4 v20, s[44:47], s54 offen offset:0 sc1 lds
    v_mfma_f32_16x16x32_bf16 v[184:187], a[32:35], a[88:91], v[184:187]
    s_xor_b32 s62, s62, 229376
    ds_read_b64_tr_b16 a[74:75], v9 offset:2048
    v_mfma_f32_16x16x32_bf16 v[188:191], a[40:43], a[88:91], 0
    v_mfma_f32_16x16x32_bf16 v[188:191], a[44:47], a[92:95], v[188:191]
    v_mfma_f32_16x16x32_bf16 v[180:183], a[44:47], a[84:87], 0
    buffer_load_dwordx4 v21, s[44:47], s54 offen offset:1024 sc1 lds
    v_mfma_f32_16x16x32_bf16 v[180:183], a[40:43], a[80:83], v[180:183]
    s_add_u32 s54, s54, s56
    ds_read_b64_tr_b16 a[76:77], v9 offset:16384
    v_mfma_f32_16x16x32_bf16 v[240:243], a[48:51], a[80:83], 0
    v_mfma_f32_16x16x32_bf16 v[240:243], a[52:55], a[84:87], v[240:243]
    v_mfma_f32_16x16x32_bf16 v[248:251], a[52:55], a[92:95], 0
    buffer_load_dwordx4 v20, s[44:47], s55 offen offset:2048 sc1 lds
    v_mfma_f32_16x16x32_bf16 v[248:251], a[48:51], a[88:91], v[248:251]
    ds_read_b64_tr_b16 a[78:79], v9 offset:18432
    v_mfma_f32_16x16x32_bf16 v[252:255], a[56:59], a[88:91], 0
    v_add_u32 v6, s63, v6
    v_add_u32 v7, s63, v7
    v_mfma_f32_16x16x32_bf16 v[252:255], a[60:63], a[92:95], v[252:255]
    v_mfma_f32_16x16x32_bf16 v[244:247], a[60:63], a[84:87], 0
    buffer_load_dwordx4 v21, s[44:47], s55 offen offset:3072 sc1 lds
    v_mfma_f32_16x16x32_bf16 v[244:247], a[56:59], a[80:83], v[244:247]
    s_add_u32 s55, s55, s56
    v_mfma_f32_16x16x32_bf16 v[64:67], a[0:3], a[96:99], 0
    ds_read_b64_tr_b16 a[80:81], v10 offset:0
    v_mfma_f32_16x16x32_bf16 v[64:67], a[4:7], a[100:103], v[64:67]
    v_mfma_f32_16x16x32_bf16 v[72:75], a[4:7], a[108:111], 0
    v_mfma_f32_16x16x32_bf16 v[72:75], a[0:3], a[104:107], v[72:75]
    s_add_u32 m0, s61, 0
    ds_read_b64_tr_b16 a[82:83], v10 offset:2048
    v_mfma_f32_16x16x32_bf16 v[76:79], a[8:11], a[104:107], 0
    buffer_load_dwordx4 v16, s[40:43], s48 offen offset:0 sc1 lds
    v_mfma_f32_16x16x32_bf16 v[76:79], a[12:15], a[108:111], v[76:79]
    v_mfma_f32_16x16x32_bf16 v[68:71], a[12:15], a[100:103], 0
    ds_read_b64_tr_b16 a[84:85], v10 offset:16384
    v_mfma_f32_16x16x32_bf16 v[68:71], a[8:11], a[96:99], v[68:71]
    v_mfma_f32_16x16x32_bf16 v[128:131], a[16:19], a[96:99], 0
    buffer_store_dwordx4 a[144:147], v2, s[24:27], s28 offen sc1
    v_mfma_f32_16x16x32_bf16 v[128:131], a[20:23], a[100:103], v[128:131]
    s_add_u32 s28, s28, s31
    ds_read_b64_tr_b16 a[86:87], v10 offset:18432
    v_mfma_f32_16x16x32_bf16 v[136:139], a[20:23], a[108:111], 0
    v_mfma_f32_16x16x32_bf16 v[136:139], a[16:19], a[104:107], v[136:139]
    v_mfma_f32_16x16x32_bf16 v[140:143], a[24:27], a[104:107], 0
    buffer_load_dwordx4 v17, s[40:43], s48 offen offset:1024 sc1 lds
    v_mfma_f32_16x16x32_bf16 v[140:143], a[28:31], a[108:111], v[140:143]
    s_add_u32 s48, s48, 128
    ds_read_b64_tr_b16 a[88:89], v11 offset:0
    v_mfma_f32_16x16x32_bf16 v[132:135], a[28:31], a[100:103], 0
    v_mfma_f32_16x16x32_bf16 v[132:135], a[24:27], a[96:99], v[132:135]
    v_mfma_f32_16x16x32_bf16 v[192:195], a[32:35], a[96:99], 0
    buffer_store_dwordx4 a[148:151], v2, s[24:27], s28 offen sc1
    v_mfma_f32_16x16x32_bf16 v[192:195], a[36:39], a[100:103], v[192:195]
    s_add_u32 s28, s28, s31
    ds_read_b64_tr_b16 a[90:91], v11 offset:2048
    v_mfma_f32_16x16x32_bf16 v[200:203], a[36:39], a[108:111], 0
    v_mfma_f32_16x16x32_bf16 v[200:203], a[32:35], a[104:107], v[200:203]
    v_mfma_f32_16x16x32_bf16 v[204:207], a[40:43], a[104:107], 0
    buffer_load_dwordx4 v16, s[40:43], s49 offen offset:2048 sc1 lds
    v_mfma_f32_16x16x32_bf16 v[204:207], a[44:47], a[108:111], v[204:207]
    ds_read_b64_tr_b16 a[92:93], v11 offset:16384
    v_mfma_f32_16x16x32_bf16 v[196:199], a[44:47], a[100:103], 0
    v_mfma_f32_16x16x32_bf16 v[196:199], a[40:43], a[96:99], v[196:199]
    v_mfma_f32_16x16x32_bf16 a[224:227], a[48:51], a[96:99], 0
    buffer_store_dwordx4 a[152:155], v2, s[24:27], s28 offen sc1
    v_mfma_f32_16x16x32_bf16 a[224:227], a[52:55], a[100:103], a[224:227]
    s_add_u32 s28, s28, s31
    ds_read_b64_tr_b16 a[94:95], v11 offset:18432
    v_mfma_f32_16x16x32_bf16 a[232:235], a[52:55], a[108:111], 0
    v_mfma_f32_16x16x32_bf16 a[232:235], a[48:51], a[104:107], a[232:235]
    v_mfma_f32_16x16x32_bf16 a[236:239], a[56:59], a[104:107], 0
    buffer_load_dwordx4 v17, s[40:43], s49 offen offset:3072 sc1 lds
    v_mfma_f32_16x16x32_bf16 a[236:239], a[60:63], a[108:111], a[236:239]
    s_add_u32 s49, s49, 128
    v_mfma_f32_16x16x32_bf16 a[228:231], a[60:63], a[100:103], 0
    buffer_store_dwordx4 a[156:159], v2, s[24:27], s28 offen sc1
    v_mfma_f32_16x16x32_bf16 a[228:231], a[56:59], a[96:99], a[228:231]
    s_add_u32 s29, s29, s30
    s_mov_b32 s28, s29
    v_mfma_f32_16x16x32_bf16 v[80:83], a[0:3], a[112:115], 0
    v_mfma_f32_16x16x32_bf16 v[80:83], a[4:7], a[116:119], v[80:83]
    ds_read_b64_tr_b16 a[96:97], v12 offset:0
    v_mfma_f32_16x16x32_bf16 v[88:91], a[4:7], a[124:127], 0
    v_mfma_f32_16x16x32_bf16 v[88:91], a[0:3], a[120:123], v[88:91]
    s_add_u32 m0, s61, 4096
    ds_read_b128 a[0:3], v6 offset:0
    v_mfma_f32_16x16x32_bf16 v[92:95], a[8:11], a[120:123], 0
    buffer_load_dwordx4 v16, s[40:43], s50 offen offset:0 sc1 lds
    v_mfma_f32_16x16x32_bf16 v[92:95], a[12:15], a[124:127], v[92:95]
    s_add_u32 s61, s61, 32768
    ds_read_b128 a[4:7], v7 offset:0
    v_mfma_f32_16x16x32_bf16 v[84:87], a[12:15], a[116:119], 0
    s_cmp_ge_u32 s61, 98304
    s_cselect_b32 s90, 98304, 0
    ds_read_b64_tr_b16 a[98:99], v12 offset:2048
    v_mfma_f32_16x16x32_bf16 v[84:87], a[8:11], a[112:115], v[84:87]
    s_sub_u32 s61, s61, s90
    ds_read_b128 a[8:11], v6 offset:2048
    v_mfma_f32_16x16x32_bf16 v[144:147], a[16:19], a[112:115], 0
    ds_read_b128 a[12:15], v7 offset:2048
    v_mfma_f32_16x16x32_bf16 v[144:147], a[20:23], a[116:119], v[144:147]
    ds_read_b64_tr_b16 a[100:101], v12 offset:16384
    v_mfma_f32_16x16x32_bf16 v[152:155], a[20:23], a[124:127], 0
    v_mfma_f32_16x16x32_bf16 v[152:155], a[16:19], a[120:123], v[152:155]
    ds_read_b128 a[16:19], v6 offset:4096
    v_mfma_f32_16x16x32_bf16 v[156:159], a[24:27], a[120:123], 0
    buffer_load_dwordx4 v17, s[40:43], s50 offen offset:1024 sc1 lds
    v_mfma_f32_16x16x32_bf16 v[156:159], a[28:31], a[124:127], v[156:159]
    s_add_u32 s50, s50, 128
    ds_read_b128 a[20:23], v7 offset:4096
    v_mfma_f32_16x16x32_bf16 v[148:151], a[28:31], a[116:119], 0
    ds_read_b64_tr_b16 a[102:103], v12 offset:18432
    v_mfma_f32_16x16x32_bf16 v[148:151], a[24:27], a[112:115], v[148:151]
    ds_read_b128 a[24:27], v6 offset:6144
    v_mfma_f32_16x16x32_bf16 v[208:211], a[32:35], a[112:115], 0
    s_sub_u32 s65, s65, 1
    ds_read_b128 a[28:31], v7 offset:6144
    v_mfma_f32_16x16x32_bf16 v[208:211], a[36:39], a[116:119], v[208:211]
    ds_read_b64_tr_b16 a[104:105], v13 offset:0
    v_mfma_f32_16x16x32_bf16 v[216:219], a[36:39], a[124:127], 0
    v_mfma_f32_16x16x32_bf16 v[216:219], a[32:35], a[120:123], v[216:219]
    ds_read_b128 a[32:35], v6 offset:8192
    v_mfma_f32_16x16x32_bf16 v[220:223], a[40:43], a[120:123], 0
    buffer_load_dwordx4 v16, s[40:43], s51 offen offset:2048 sc1 lds
    v_mfma_f32_16x16x32_bf16 v[220:223], a[44:47], a[124:127], v[220:223]
    ds_read_b128 a[36:39], v7 offset:8192
    v_mfma_f32_16x16x32_bf16 v[212:215], a[44:47], a[116:119], 0
    ds_read_b64_tr_b16 a[106:107], v13 offset:2048
    v_mfma_f32_16x16x32_bf16 v[212:215], a[40:43], a[112:115], v[212:215]
    ds_read_b128 a[40:43], v6 offset:10240
    v_mfma_f32_16x16x32_bf16 a[240:243], a[48:51], a[112:115], 0
    ds_read_b128 a[44:47], v7 offset:10240
    v_mfma_f32_16x16x32_bf16 a[240:243], a[52:55], a[116:119], a[240:243]
    ds_read_b64_tr_b16 a[108:109], v13 offset:16384
    v_mfma_f32_16x16x32_bf16 a[248:251], a[52:55], a[124:127], 0
    v_mfma_f32_16x16x32_bf16 a[248:251], a[48:51], a[120:123], a[248:251]
    ds_read_b128 a[48:51], v6 offset:12288
    v_mfma_f32_16x16x32_bf16 a[252:255], a[56:59], a[120:123], 0
    buffer_load_dwordx4 v17, s[40:43], s51 offen offset:3072 sc1 lds
    v_mfma_f32_16x16x32_bf16 a[252:255], a[60:63], a[124:127], a[252:255]
    s_add_u32 s51, s51, 128
    ds_read_b128 a[52:55], v7 offset:12288
    v_mfma_f32_16x16x32_bf16 a[244:247], a[60:63], a[116:119], 0
    ds_read_b64_tr_b16 a[110:111], v13 offset:18432
    v_mfma_f32_16x16x32_bf16 a[244:247], a[56:59], a[112:115], a[244:247]
    ds_read_b128 a[56:59], v6 offset:14336
    ds_read_b128 a[60:63], v7 offset:14336
    s_waitcnt lgkmcnt(15)
    v_mfma_f32_16x16x32_bf16 v[32:35], a[0:3], a[64:67], v[32:35]
    ds_read_b64_tr_b16 a[112:113], v14 offset:0
    v_mfma_f32_16x16x32_bf16 v[32:35], a[4:7], a[68:71], v[32:35]
    ds_read_b64_tr_b16 a[114:115], v14 offset:2048
    v_mfma_f32_16x16x32_bf16 v[40:43], a[4:7], a[76:79], v[40:43]
    ds_read_b64_tr_b16 a[116:117], v14 offset:16384
    v_mfma_f32_16x16x32_bf16 v[40:43], a[0:3], a[72:75], v[40:43]
    ds_read_b64_tr_b16 a[118:119], v14 offset:18432
    v_mfma_f32_16x16x32_bf16 v[44:47], a[8:11], a[72:75], v[44:47]
    ds_read_b64_tr_b16 a[120:121], v15 offset:0
    v_mfma_f32_16x16x32_bf16 v[44:47], a[12:15], a[76:79], v[44:47]
    ds_read_b64_tr_b16 a[122:123], v15 offset:2048
    v_mfma_f32_16x16x32_bf16 v[36:39], a[12:15], a[68:71], v[36:39]
    ds_read_b64_tr_b16 a[124:125], v15 offset:16384
    v_mfma_f32_16x16x32_bf16 v[36:39], a[8:11], a[64:67], v[36:39]
    ds_read_b64_tr_b16 a[126:127], v15 offset:18432
    v_mfma_f32_16x16x32_bf16 v[96:99], a[16:19], a[64:67], v[96:99]
    v_mfma_f32_16x16x32_bf16 v[96:99], a[20:23], a[68:71], v[96:99]
    v_mfma_f32_16x16x32_bf16 v[104:107], a[20:23], a[76:79], v[104:107]
    buffer_store_dwordx4 a[160:163], v2, s[24:27], s28 offen sc1
    v_mfma_f32_16x16x32_bf16 v[104:107], a[16:19], a[72:75], v[104:107]
    s_add_u32 s28, s28, s31
    s_waitcnt lgkmcnt(15)
    v_mfma_f32_16x16x32_bf16 v[108:111], a[24:27], a[72:75], v[108:111]
    v_xor_b32 v8, s60, v8
    v_xor_b32 v9, s60, v9
    v_mfma_f32_16x16x32_bf16 v[108:111], a[28:31], a[76:79], v[108:111]
    v_xor_b32 v10, s60, v10
    v_xor_b32 v11, s60, v11
    v_mfma_f32_16x16x32_bf16 v[100:103], a[28:31], a[68:71], v[100:103]
    v_xor_b32 v12, s60, v12
    v_xor_b32 v13, s60, v13
    v_mfma_f32_16x16x32_bf16 v[100:103], a[24:27], a[64:67], v[100:103]
    v_xor_b32 v14, s60, v14
    v_xor_b32 v15, s60, v15
    v_mfma_f32_16x16x32_bf16 v[160:163], a[32:35], a[64:67], v[160:163]
    buffer_store_dwordx4 a[164:167], v2, s[24:27], s28 offen sc1
    v_mfma_f32_16x16x32_bf16 v[160:163], a[36:39], a[68:71], v[160:163]
    s_add_u32 s28, s28, s31
    v_mfma_f32_16x16x32_bf16 v[168:171], a[36:39], a[76:79], v[168:171]
    v_mfma_f32_16x16x32_bf16 v[168:171], a[32:35], a[72:75], v[168:171]
    s_waitcnt lgkmcnt(14)
    v_mfma_f32_16x16x32_bf16 v[172:175], a[40:43], a[72:75], v[172:175]
    v_mfma_f32_16x16x32_bf16 v[172:175], a[44:47], a[76:79], v[172:175]
    v_mfma_f32_16x16x32_bf16 v[164:167], a[44:47], a[68:71], v[164:167]
    buffer_store_dwordx4 a[168:171], v2, s[24:27], s28 offen sc1
    v_mfma_f32_16x16x32_bf16 v[164:167], a[40:43], a[64:67], v[164:167]
    s_add_u32 s28, s28, s31
    s_waitcnt lgkmcnt(11)
    v_mfma_f32_16x16x32_bf16 v[224:227], a[48:51], a[64:67], v[224:227]
    v_mfma_f32_16x16x32_bf16 v[224:227], a[52:55], a[68:71], v[224:227]
    v_mfma_f32_16x16x32_bf16 v[232:235], a[52:55], a[76:79], v[232:235]
    v_mfma_f32_16x16x32_bf16 v[232:235], a[48:51], a[72:75], v[232:235]
    s_waitcnt lgkmcnt(8)
    v_mfma_f32_16x16x32_bf16 v[236:239], a[56:59], a[72:75], v[236:239]
    buffer_store_dwordx4 a[172:175], v2, s[24:27], s28 offen sc1
    v_mfma_f32_16x16x32_bf16 v[236:239], a[60:63], a[76:79], v[236:239]
    s_add_u32 s28, s28, s31
    v_mfma_f32_16x16x32_bf16 v[228:231], a[60:63], a[68:71], v[228:231]
    s_waitcnt vmcnt(16) lgkmcnt(0)
    v_mfma_f32_16x16x32_bf16 v[228:231], a[56:59], a[64:67], v[228:231]
    s_barrier
    v_mfma_f32_16x16x32_bf16 v[48:51], a[0:3], a[80:83], v[48:51]
    ds_read_b64_tr_b16 a[64:65], v8 offset:0
    v_mfma_f32_16x16x32_bf16 v[48:51], a[4:7], a[84:87], v[48:51]
    s_add_u32 m0, s62, 0
    v_mfma_f32_16x16x32_bf16 v[56:59], a[4:7], a[92:95], v[56:59]
    buffer_load_dwordx4 v18, s[44:47], s52 offen offset:0 sc1 lds
    v_mfma_f32_16x16x32_bf16 v[56:59], a[0:3], a[88:91], v[56:59]
    ds_read_b64_tr_b16 a[66:67], v8 offset:2048
    v_mfma_f32_16x16x32_bf16 v[60:63], a[8:11], a[88:91], v[60:63]
    s_add_u32 s64, s64, 32768
    v_mfma_f32_16x16x32_bf16 v[60:63], a[12:15], a[92:95], v[60:63]
    s_cmp_ge_u32 s64, 98304
    s_cselect_b32 s63, 4294901760, s59
    s_cselect_b32 s64, 0, s64
    v_mfma_f32_16x16x32_bf16 v[52:55], a[12:15], a[84:87], v[52:55]
    buffer_load_dwordx4 v19, s[44:47], s52 offen offset:1024 sc1 lds
    v_mfma_f32_16x16x32_bf16 v[52:55], a[8:11], a[80:83], v[52:55]
    s_add_u32 s52, s52, s56
    ds_read_b64_tr_b16 a[68:69], v8 offset:16384
    v_mfma_f32_16x16x32_bf16 v[112:115], a[16:19], a[80:83], v[112:115]
    v_mfma_f32_16x16x32_bf16 v[112:115], a[20:23], a[84:87], v[112:115]
    v_mfma_f32_16x16x32_bf16 v[120:123], a[20:23], a[92:95], v[120:123]
    buffer_load_dwordx4 v18, s[44:47], s53 offen offset:2048 sc1 lds
    v_mfma_f32_16x16x32_bf16 v[120:123], a[16:19], a[88:91], v[120:123]
    ds_read_b64_tr_b16 a[70:71], v8 offset:18432
    v_mfma_f32_16x16x32_bf16 v[124:127], a[24:27], a[88:91], v[124:127]
    v_mfma_f32_16x16x32_bf16 v[124:127], a[28:31], a[92:95], v[124:127]
    v_mfma_f32_16x16x32_bf16 v[116:119], a[28:31], a[84:87], v[116:119]
    buffer_load_dwordx4 v19, s[44:47], s53 offen offset:3072 sc1 lds
    v_mfma_f32_16x16x32_bf16 v[116:119], a[24:27], a[80:83], v[116:119]
    s_add_u32 s53, s53, s56
    ds_read_b64_tr_b16 a[72:73], v9 offset:0
    v_mfma_f32_16x16x32_bf16 v[176:179], a[32:35], a[80:83], v[176:179]
    v_mfma_f32_16x16x32_bf16 v[176:179], a[36:39], a[84:87], v[176:179]
    s_add_u32 m0, s62, 4096
    v_mfma_f32_16x16x32_bf16 v[184:187], a[36:39], a[92:95], v[184:187]
    buffer_load_dwordx4 v20, s[44:47], s54 offen offset:0 sc1 lds
    v_mfma_f32_16x16x32_bf16 v[184:187], a[32:35], a[88:91], v[184:187]
    s_xor_b32 s62, s62, 229376
    ds_read_b64_tr_b16 a[74:75], v9 offset:2048
    v_mfma_f32_16x16x32_bf16 v[188:191], a[40:43], a[88:91], v[188:191]
    v_mfma_f32_16x16x32_bf16 v[188:191], a[44:47], a[92:95], v[188:191]
    v_mfma_f32_16x16x32_bf16 v[180:183], a[44:47], a[84:87], v[180:183]
    buffer_load_dwordx4 v21, s[44:47], s54 offen offset:1024 sc1 lds
    v_mfma_f32_16x16x32_bf16 v[180:183], a[40:43], a[80:83], v[180:183]
    s_add_u32 s54, s54, s56
    ds_read_b64_tr_b16 a[76:77], v9 offset:16384
    v_mfma_f32_16x16x32_bf16 v[240:243], a[48:51], a[80:83], v[240:243]
    v_mfma_f32_16x16x32_bf16 v[240:243], a[52:55], a[84:87], v[240:243]
    v_mfma_f32_16x16x32_bf16 v[248:251], a[52:55], a[92:95], v[248:251]
    buffer_load_dwordx4 v20, s[44:47], s55 offen offset:2048 sc1 lds
    v_mfma_f32_16x16x32_bf16 v[248:251], a[48:51], a[88:91], v[248:251]
    ds_read_b64_tr_b16 a[78:79], v9 offset:18432
    v_mfma_f32_16x16x32_bf16 v[252:255], a[56:59], a[88:91], v[252:255]
    v_add_u32 v6, s63, v6
    v_add_u32 v7, s63, v7
    v_mfma_f32_16x16x32_bf16 v[252:255], a[60:63], a[92:95], v[252:255]
    v_mfma_f32_16x16x32_bf16 v[244:247], a[60:63], a[84:87], v[244:247]
    buffer_load_dwordx4 v21, s[44:47], s55 offen offset:3072 sc1 lds
    v_mfma_f32_16x16x32_bf16 v[244:247], a[56:59], a[80:83], v[244:247]
    s_add_u32 s55, s55, s56
    v_mfma_f32_16x16x32_bf16 v[64:67], a[0:3], a[96:99], v[64:67]
    ds_read_b64_tr_b16 a[80:81], v10 offset:0
    v_mfma_f32_16x16x32_bf16 v[64:67], a[4:7], a[100:103], v[64:67]
    v_mfma_f32_16x16x32_bf16 v[72:75], a[4:7], a[108:111], v[72:75]
    v_mfma_f32_16x16x32_bf16 v[72:75], a[0:3], a[104:107], v[72:75]
    s_add_u32 m0, s61, 0
    ds_read_b64_tr_b16 a[82:83], v10 offset:2048
    v_mfma_f32_16x16x32_bf16 v[76:79], a[8:11], a[104:107], v[76:79]
    buffer_load_dwordx4 v16, s[40:43], s48 offen offset:0 sc1 lds
    v_mfma_f32_16x16x32_bf16 v[76:79], a[12:15], a[108:111], v[76:79]
    v_mfma_f32_16x16x32_bf16 v[68:71], a[12:15], a[100:103], v[68:71]
    ds_read_b64_tr_b16 a[84:85], v10 offset:16384
    v_mfma_f32_16x16x32_bf16 v[68:71], a[8:11], a[96:99], v[68:71]
    v_mfma_f32_16x16x32_bf16 v[128:131], a[16:19], a[96:99], v[128:131]
    buffer_store_dwordx4 a[176:179], v2, s[24:27], s28 offen sc1
    v_mfma_f32_16x16x32_bf16 v[128:131], a[20:23], a[100:103], v[128:131]
    s_add_u32 s28, s28, s31
    ds_read_b64_tr_b16 a[86:87], v10 offset:18432
    v_mfma_f32_16x16x32_bf16 v[136:139], a[20:23], a[108:111], v[136:139]
    v_mfma_f32_16x16x32_bf16 v[136:139], a[16:19], a[104:107], v[136:139]
    v_mfma_f32_16x16x32_bf16 v[140:143], a[24:27], a[104:107], v[140:143]
    buffer_load_dwordx4 v17, s[40:43], s48 offen offset:1024 sc1 lds
    v_mfma_f32_16x16x32_bf16 v[140:143], a[28:31], a[108:111], v[140:143]
    s_add_u32 s48, s48, 128
    ds_read_b64_tr_b16 a[88:89], v11 offset:0
    v_mfma_f32_16x16x32_bf16 v[132:135], a[28:31], a[100:103], v[132:135]
    v_mfma_f32_16x16x32_bf16 v[132:135], a[24:27], a[96:99], v[132:135]
    v_mfma_f32_16x16x32_bf16 v[192:195], a[32:35], a[96:99], v[192:195]
    buffer_store_dwordx4 a[180:183], v2, s[24:27], s28 offen sc1
    v_mfma_f32_16x16x32_bf16 v[192:195], a[36:39], a[100:103], v[192:195]
    s_add_u32 s28, s28, s31
    ds_read_b64_tr_b16 a[90:91], v11 offset:2048
    v_mfma_f32_16x16x32_bf16 v[200:203], a[36:39], a[108:111], v[200:203]
    v_mfma_f32_16x16x32_bf16 v[200:203], a[32:35], a[104:107], v[200:203]
    v_mfma_f32_16x16x32_bf16 v[204:207], a[40:43], a[104:107], v[204:207]
    buffer_load_dwordx4 v16, s[40:43], s49 offen offset:2048 sc1 lds
    v_mfma_f32_16x16x32_bf16 v[204:207], a[44:47], a[108:111], v[204:207]
    ds_read_b64_tr_b16 a[92:93], v11 offset:16384
    v_mfma_f32_16x16x32_bf16 v[196:199], a[44:47], a[100:103], v[196:199]
    v_mfma_f32_16x16x32_bf16 v[196:199], a[40:43], a[96:99], v[196:199]
    v_mfma_f32_16x16x32_bf16 a[224:227], a[48:51], a[96:99], a[224:227]
    buffer_store_dwordx4 a[184:187], v2, s[24:27], s28 offen sc1
    v_mfma_f32_16x16x32_bf16 a[224:227], a[52:55], a[100:103], a[224:227]
    s_add_u32 s28, s28, s31
    ds_read_b64_tr_b16 a[94:95], v11 offset:18432
    v_mfma_f32_16x16x32_bf16 a[232:235], a[52:55], a[108:111], a[232:235]
    v_mfma_f32_16x16x32_bf16 a[232:235], a[48:51], a[104:107], a[232:235]
    v_mfma_f32_16x16x32_bf16 a[236:239], a[56:59], a[104:107], a[236:239]
    buffer_load_dwordx4 v17, s[40:43], s49 offen offset:3072 sc1 lds
    v_mfma_f32_16x16x32_bf16 a[236:239], a[60:63], a[108:111], a[236:239]
    s_add_u32 s49, s49, 128
    v_mfma_f32_16x16x32_bf16 a[228:231], a[60:63], a[100:103], a[228:231]
    buffer_store_dwordx4 a[188:191], v2, s[24:27], s28 offen sc1
    v_mfma_f32_16x16x32_bf16 a[228:231], a[56:59], a[96:99], a[228:231]
    s_add_u32 s29, s29, s30
    s_mov_b32 s28, s29
    v_mfma_f32_16x16x32_bf16 v[80:83], a[0:3], a[112:115], v[80:83]
    v_mfma_f32_16x16x32_bf16 v[80:83], a[4:7], a[116:119], v[80:83]
    ds_read_b64_tr_b16 a[96:97], v12 offset:0
    v_mfma_f32_16x16x32_bf16 v[88:91], a[4:7], a[124:127], v[88:91]
    v_mfma_f32_16x16x32_bf16 v[88:91], a[0:3], a[120:123], v[88:91]
    s_add_u32 m0, s61, 4096
    ds_read_b128 a[0:3], v6 offset:0
    v_mfma_f32_16x16x32_bf16 v[92:95], a[8:11], a[120:123], v[92:95]
    buffer_load_dwordx4 v16, s[40:43], s50 offen offset:0 sc1 lds
    v_mfma_f32_16x16x32_bf16 v[92:95], a[12:15], a[124:127], v[92:95]
    s_add_u32 s61, s61, 32768
    ds_read_b128 a[4:7], v7 offset:0
    v_mfma_f32_16x16x32_bf16 v[84:87], a[12:15], a[116:119], v[84:87]
    s_cmp_ge_u32 s61, 98304
    s_cselect_b32 s90, 98304, 0
    ds_read_b64_tr_b16 a[98:99], v12 offset:2048
    v_mfma_f32_16x16x32_bf16 v[84:87], a[8:11], a[112:115], v[84:87]
    s_sub_u32 s61, s61, s90
    ds_read_b128 a[8:11], v6 offset:2048
    v_mfma_f32_16x16x32_bf16 v[144:147], a[16:19], a[112:115], v[144:147]
    ds_read_b128 a[12:15], v7 offset:2048
    v_mfma_f32_16x16x32_bf16 v[144:147], a[20:23], a[116:119], v[144:147]
    ds_read_b64_tr_b16 a[100:101], v12 offset:16384
    v_mfma_f32_16x16x32_bf16 v[152:155], a[20:23], a[124:127], v[152:155]
    v_mfma_f32_16x16x32_bf16 v[152:155], a[16:19], a[120:123], v[152:155]
    ds_read_b128 a[16:19], v6 offset:4096
    v_mfma_f32_16x16x32_bf16 v[156:159], a[24:27], a[120:123], v[156:159]
    buffer_load_dwordx4 v17, s[40:43], s50 offen offset:1024 sc1 lds
    v_mfma_f32_16x16x32_bf16 v[156:159], a[28:31], a[124:127], v[156:159]
    s_add_u32 s50, s50, 128
    ds_read_b128 a[20:23], v7 offset:4096
    v_mfma_f32_16x16x32_bf16 v[148:151], a[28:31], a[116:119], v[148:151]
    ds_read_b64_tr_b16 a[102:103], v12 offset:18432
    v_mfma_f32_16x16x32_bf16 v[148:151], a[24:27], a[112:115], v[148:151]
    ds_read_b128 a[24:27], v6 offset:6144
    v_mfma_f32_16x16x32_bf16 v[208:211], a[32:35], a[112:115], v[208:211]
    s_sub_u32 s65, s65, 1
    ds_read_b128 a[28:31], v7 offset:6144
    v_mfma_f32_16x16x32_bf16 v[208:211], a[36:39], a[116:119], v[208:211]
    ds_read_b64_tr_b16 a[104:105], v13 offset:0
    v_mfma_f32_16x16x32_bf16 v[216:219], a[36:39], a[124:127], v[216:219]
    v_mfma_f32_16x16x32_bf16 v[216:219], a[32:35], a[120:123], v[216:219]
    ds_read_b128 a[32:35], v6 offset:8192
    v_mfma_f32_16x16x32_bf16 v[220:223], a[40:43], a[120:123], v[220:223]
    buffer_load_dwordx4 v16, s[40:43], s51 offen offset:2048 sc1 lds
    v_mfma_f32_16x16x32_bf16 v[220:223], a[44:47], a[124:127], v[220:223]
    ds_read_b128 a[36:39], v7 offset:8192
    v_mfma_f32_16x16x32_bf16 v[212:215], a[44:47], a[116:119], v[212:215]
    ds_read_b64_tr_b16 a[106:107], v13 offset:2048
    v_mfma_f32_16x16x32_bf16 v[212:215], a[40:43], a[112:115], v[212:215]
    ds_read_b128 a[40:43], v6 offset:10240
    v_mfma_f32_16x16x32_bf16 a[240:243], a[48:51], a[112:115], a[240:243]
    ds_read_b128 a[44:47], v7 offset:10240
    v_mfma_f32_16x16x32_bf16 a[240:243], a[52:55], a[116:119], a[240:243]
    ds_read_b64_tr_b16 a[108:109], v13 offset:16384
    v_mfma_f32_16x16x32_bf16 a[248:251], a[52:55], a[124:127], a[248:251]
    v_mfma_f32_16x16x32_bf16 a[248:251], a[48:51], a[120:123], a[248:251]
    ds_read_b128 a[48:51], v6 offset:12288
    v_mfma_f32_16x16x32_bf16 a[252:255], a[56:59], a[120:123], a[252:255]
    buffer_load_dwordx4 v17, s[40:43], s51 offen offset:3072 sc1 lds
    v_mfma_f32_16x16x32_bf16 a[252:255], a[60:63], a[124:127], a[252:255]
    s_add_u32 s51, s51, 128
    ds_read_b128 a[52:55], v7 offset:12288
    v_mfma_f32_16x16x32_bf16 a[244:247], a[60:63], a[116:119], a[244:247]
    ds_read_b64_tr_b16 a[110:111], v13 offset:18432
    v_mfma_f32_16x16x32_bf16 a[244:247], a[56:59], a[112:115], a[244:247]
    ds_read_b128 a[56:59], v6 offset:14336
    ds_read_b128 a[60:63], v7 offset:14336
    s_cmp_eq_u32 s66, 2
    s_cbranch_scc1 m_hook18
m_hookr19:
    s_waitcnt lgkmcnt(15)
    v_mfma_f32_16x16x32_bf16 v[32:35], a[0:3], a[64:67], v[32:35]
    ds_read_b64_tr_b16 a[112:113], v14 offset:0
    v_mfma_f32_16x16x32_bf16 v[32:35], a[4:7], a[68:71], v[32:35]
    ds_read_b64_tr_b16 a[114:115], v14 offset:2048
    v_mfma_f32_16x16x32_bf16 v[40:43], a[4:7], a[76:79], v[40:43]
    ds_read_b64_tr_b16 a[116:117], v14 offset:16384
    v_mfma_f32_16x16x32_bf16 v[40:43], a[0:3], a[72:75], v[40:43]
    ds_read_b64_tr_b16 a[118:119], v14 offset:18432
    v_mfma_f32_16x16x32_bf16 v[44:47], a[8:11], a[72:75], v[44:47]
    ds_read_b64_tr_b16 a[120:121], v15 offset:0
    v_mfma_f32_16x16x32_bf16 v[44:47], a[12:15], a[76:79], v[44:47]
    ds_read_b64_tr_b16 a[122:123], v15 offset:2048
    v_mfma_f32_16x16x32_bf16 v[36:39], a[12:15], a[68:71], v[36:39]
    ds_read_b64_tr_b16 a[124:125], v15 offset:16384
    v_mfma_f32_16x16x32_bf16 v[36:39], a[8:11], a[64:67], v[36:39]
    ds_read_b64_tr_b16 a[126:127], v15 offset:18432
    v_mfma_f32_16x16x32_bf16 v[96:99], a[16:19], a[64:67], v[96:99]
    v_mfma_f32_16x16x32_bf16 v[96:99], a[20:23], a[68:71], v[96:99]
    v_mfma_f32_16x16x32_bf16 v[104:107], a[20:23], a[76:79], v[104:107]
    buffer_store_dwordx4 a[192:195], v2, s[24:27], s28 offen sc1
    v_mfma_f32_16x16x32_bf16 v[104:107], a[16:19], a[72:75], v[104:107]
    s_add_u32 s28, s28, s31
    s_waitcnt lgkmcnt(15)
    v_mfma_f32_16x16x32_bf16 v[108:111], a[24:27], a[72:75], v[108:111]
    v_xor_b32 v8, s60, v8
    v_xor_b32 v9, s60, v9
    v_mfma_f32_16x16x32_bf16 v[108:111], a[28:31], a[76:79], v[108:111]
    v_xor_b32 v10, s60, v10
    v_xor_b32 v11, s60, v11
    v_mfma_f32_16x16x32_bf16 v[100:103], a[28:31], a[68:71], v[100:103]
    v_xor_b32 v12, s60, v12
    v_xor_b32 v13, s60, v13
    v_mfma_f32_16x16x32_bf16 v[100:103], a[24:27], a[64:67], v[100:103]
    v_xor_b32 v14, s60, v14
    v_xor_b32 v15, s60, v15
    v_mfma_f32_16x16x32_bf16 v[160:163], a[32:35], a[64:67], v[160:163]
    buffer_store_dwordx4 a[196:199], v2, s[24:27], s28 offen sc1
    v_mfma_f32_16x16x32_bf16 v[160:163], a[36:39], a[68:71], v[160:163]
    s_add_u32 s28, s28, s31
    v_mfma_f32_16x16x32_bf16 v[168:171], a[36:39], a[76:79], v[168:171]
    v_mfma_f32_16x16x32_bf16 v[168:171], a[32:35], a[72:75], v[168:171]
    s_waitcnt lgkmcnt(14)
    v_mfma_f32_16x16x32_bf16 v[172:175], a[40:43], a[72:75], v[172:175]
    v_mfma_f32_16x16x32_bf16 v[172:175], a[44:47], a[76:79], v[172:175]
    v_mfma_f32_16x16x32_bf16 v[164:167], a[44:47], a[68:71], v[164:167]
    buffer_store_dwordx4 a[200:203], v2, s[24:27], s28 offen sc1
    v_mfma_f32_16x16x32_bf16 v[164:167], a[40:43], a[64:67], v[164:167]
    s_add_u32 s28, s28, s31
    s_waitcnt lgkmcnt(11)
    v_mfma_f32_16x16x32_bf16 v[224:227], a[48:51], a[64:67], v[224:227]
    v_mfma_f32_16x16x32_bf16 v[224:227], a[52:55], a[68:71], v[224:227]
    v_mfma_f32_16x16x32_bf16 v[232:235], a[52:55], a[76:79], v[232:235]
    v_mfma_f32_16x16x32_bf16 v[232:235], a[48:51], a[72:75], v[232:235]
    s_waitcnt lgkmcnt(8)
    v_mfma_f32_16x16x32_bf16 v[236:239], a[56:59], a[72:75], v[236:239]
    buffer_store_dwordx4 a[204:207], v2, s[24:27], s28 offen sc1
    v_mfma_f32_16x16x32_bf16 v[236:239], a[60:63], a[76:79], v[236:239]
    s_add_u32 s28, s28, s31
    v_mfma_f32_16x16x32_bf16 v[228:231], a[60:63], a[68:71], v[228:231]
    s_waitcnt vmcnt(16) lgkmcnt(0)
    v_mfma_f32_16x16x32_bf16 v[228:231], a[56:59], a[64:67], v[228:231]
    s_barrier
    v_mfma_f32_16x16x32_bf16 v[48:51], a[0:3], a[80:83], v[48:51]
    ds_read_b64_tr_b16 a[64:65], v8 offset:0
    v_mfma_f32_16x16x32_bf16 v[48:51], a[4:7], a[84:87], v[48:51]
    s_add_u32 m0, s62, 0
    v_mfma_f32_16x16x32_bf16 v[56:59], a[4:7], a[92:95], v[56:59]
    buffer_load_dwordx4 v18, s[44:47], s52 offen offset:0 sc1 lds
    v_mfma_f32_16x16x32_bf16 v[56:59], a[0:3], a[88:91], v[56:59]
    ds_read_b64_tr_b16 a[66:67], v8 offset:2048
    v_mfma_f32_16x16x32_bf16 v[60:63], a[8:11], a[88:91], v[60:63]
    s_add_u32 s64, s64, 32768
    v_mfma_f32_16x16x32_bf16 v[60:63], a[12:15], a[92:95], v[60:63]
    s_cmp_ge_u32 s64, 98304
    s_cselect_b32 s63, 4294901760, s59
    s_cselect_b32 s64, 0, s64
    v_mfma_f32_16x16x32_bf16 v[52:55], a[12:15], a[84:87], v[52:55]
    buffer_load_dwordx4 v19, s[44:47], s52 offen offset:1024 sc1 lds
    v_mfma_f32_16x16x32_bf16 v[52:55], a[8:11], a[80:83], v[52:55]
    s_add_u32 s52, s52, s56
    ds_read_b64_tr_b16 a[68:69], v8 offset:16384
    v_mfma_f32_16x16x32_bf16 v[112:115], a[16:19], a[80:83], v[112:115]
    v_mfma_f32_16x16x32_bf16 v[112:115], a[20:23], a[84:87], v[112:115]
    v_mfma_f32_16x16x32_bf16 v[120:123], a[20:23], a[92:95], v[120:123]
    buffer_load_dwordx4 v18, s[44:47], s53 offen offset:2048 sc1 lds
    v_mfma_f32_16x16x32_bf16 v[120:123], a[16:19], a[88:91], v[120:123]
    ds_read_b64_tr_b16 a[70:71], v8 offset:18432
    v_mfma_f32_16x16x32_bf16 v[124:127], a[24:27], a[88:91], v[124:127]
    v_mfma_f32_16x16x32_bf16 v[124:127], a[28:31], a[92:95], v[124:127]
    v_mfma_f32_16x16x32_bf16 v[116:119], a[28:31], a[84:87], v[116:119]
    buffer_load_dwordx4 v19, s[44:47], s53 offen offset:3072 sc1 lds
    v_mfma_f32_16x16x32_bf16 v[116:119], a[24:27], a[80:83], v[116:119]
    s_add_u32 s53, s53, s56
    ds_read_b64_tr_b16 a[72:73], v9 offset:0
    v_mfma_f32_16x16x32_bf16 v[176:179], a[32:35], a[80:83], v[176:179]
    v_mfma_f32_16x16x32_bf16 v[176:179], a[36:39], a[84:87], v[176:179]
    s_add_u32 m0, s62, 4096
    v_mfma_f32_16x16x32_bf16 v[184:187], a[36:39], a[92:95], v[184:187]
    buffer_load_dwordx4 v20, s[44:47], s54 offen offset:0 sc1 lds
    v_mfma_f32_16x16x32_bf16 v[184:187], a[32:35], a[88:91], v[184:187]
    s_xor_b32 s62, s62, 229376
    ds_read_b64_tr_b16 a[74:75], v9 offset:2048
    v_mfma_f32_16x16x32_bf16 v[188:191], a[40:43], a[88:91], v[188:191]
    v_mfma_f32_16x16x32_bf16 v[188:191], a[44:47], a[92:95], v[188:191]
    v_mfma_f32_16x16x32_bf16 v[180:183], a[44:47], a[84:87], v[180:183]
    buffer_load_dwordx4 v21, s[44:47], s54 offen offset:1024 sc1 lds
    v_mfma_f32_16x16x32_bf16 v[180:183], a[40:43], a[80:83], v[180:183]
    s_add_u32 s54, s54, s56
    ds_read_b64_tr_b16 a[76:77], v9 offset:16384
    v_mfma_f32_16x16x32_bf16 v[240:243], a[48:51], a[80:83], v[240:243]
    v_mfma_f32_16x16x32_bf16 v[240:243], a[52:55], a[84:87], v[240:243]
    v_mfma_f32_16x16x32_bf16 v[248:251], a[52:55], a[92:95], v[248:251]
    buffer_load_dwordx4 v20, s[44:47], s55 offen offset:2048 sc1 lds
    v_mfma_f32_16x16x32_bf16 v[248:251], a[48:51], a[88:91], v[248:251]
    ds_read_b64_tr_b16 a[78:79], v9 offset:18432
    v_mfma_f32_16x16x32_bf16 v[252:255], a[56:59], a[88:91], v[252:255]
    v_add_u32 v6, s63, v6
    v_add_u32 v7, s63, v7
    v_mfma_f32_16x16x32_bf16 v[252:255], a[60:63], a[92:95], v[252:255]
    v_mfma_f32_16x16x32_bf16 v[244:247], a[60:63], a[84:87], v[244:247]
    buffer_load_dwordx4 v21, s[44:47], s55 offen offset:3072 sc1 lds
    v_mfma_f32_16x16x32_bf16 v[244:247], a[56:59], a[80:83], v[244:247]
    s_add_u32 s55, s55, s56
    v_mfma_f32_16x16x32_bf16 v[64:67], a[0:3], a[96:99], v[64:67]
    ds_read_b64_tr_b16 a[80:81], v10 offset:0
    v_mfma_f32_16x16x32_bf16 v[64:67], a[4:7], a[100:103], v[64:67]
    v_mfma_f32_16x16x32_bf16 v[72:75], a[4:7], a[108:111], v[72:75]
    v_mfma_f32_16x16x32_bf16 v[72:75], a[0:3], a[104:107], v[72:75]
    s_add_u32 m0, s61, 0
    ds_read_b64_tr_b16 a[82:83], v10 offset:2048
    v_mfma_f32_16x16x32_bf16 v[76:79], a[8:11], a[104:107], v[76:79]
    buffer_load_dwordx4 v16, s[40:43], s48 offen offset:0 sc1 lds
    v_mfma_f32_16x16x32_bf16 v[76:79], a[12:15], a[108:111], v[76:79]
    v_mfma_f32_16x16x32_bf16 v[68:71], a[12:15], a[100:103], v[68:71]
    ds_read_b64_tr_b16 a[84:85], v10 offset:16384
    v_mfma_f32_16x16x32_bf16 v[68:71], a[8:11], a[96:99], v[68:71]
    v_mfma_f32_16x16x32_bf16 v[128:131], a[16:19], a[96:99], v[128:131]
    buffer_store_dwordx4 a[208:211], v2, s[24:27], s28 offen sc1
    v_mfma_f32_16x16x32_bf16 v[128:131], a[20:23], a[100:103], v[128:131]
    s_add_u32 s28, s28, s31
    ds_read_b64_tr_b16 a[86:87], v10 offset:18432
    v_mfma_f32_16x16x32_bf16 v[136:139], a[20:23], a[108:111], v[136:139]
    v_mfma_f32_16x16x32_bf16 v[136:139], a[16:19], a[104:107], v[136:139]
    v_mfma_f32_16x16x32_bf16 v[140:143], a[24:27], a[104:107], v[140:143]
    buffer_load_dwordx4 v17, s[40:43], s48 offen offset:1024 sc1 lds
    v_mfma_f32_16x16x32_bf16 v[140:143], a[28:31], a[108:111], v[140:143]
    s_add_u32 s48, s48, 128
    ds_read_b64_tr_b16 a[88:89], v11 offset:0
    v_mfma_f32_16x16x32_bf16 v[132:135], a[28:31], a[100:103], v[132:135]
    v_mfma_f32_16x16x32_bf16 v[132:135], a[24:27], a[96:99], v[132:135]
    v_mfma_f32_16x16x32_bf16 v[192:195], a[32:35], a[96:99], v[192:195]
    buffer_store_dwordx4 a[212:215], v2, s[24:27], s28 offen sc1
    v_mfma_f32_16x16x32_bf16 v[192:195], a[36:39], a[100:103], v[192:195]
    s_add_u32 s28, s28, s31
    ds_read_b64_tr_b16 a[90:91], v11 offset:2048
    v_mfma_f32_16x16x32_bf16 v[200:203], a[36:39], a[108:111], v[200:203]
    v_mfma_f32_16x16x32_bf16 v[200:203], a[32:35], a[104:107], v[200:203]
    v_mfma_f32_16x16x32_bf16 v[204:207], a[40:43], a[104:107], v[204:207]
    buffer_load_dwordx4 v16, s[40:43], s49 offen offset:2048 sc1 lds
    v_mfma_f32_16x16x32_bf16 v[204:207], a[44:47], a[108:111], v[204:207]
    ds_read_b64_tr_b16 a[92:93], v11 offset:16384
    v_mfma_f32_16x16x32_bf16 v[196:199], a[44:47], a[100:103], v[196:199]
    v_mfma_f32_16x16x32_bf16 v[196:199], a[40:43], a[96:99], v[196:199]
    v_mfma_f32_16x16x32_bf16 a[224:227], a[48:51], a[96:99], a[224:227]
    buffer_store_dwordx4 a[216:219], v2, s[24:27], s28 offen sc1
    v_mfma_f32_16x16x32_bf16 a[224:227], a[52:55], a[100:103], a[224:227]
    s_add_u32 s28, s28, s31
    ds_read_b64_tr_b16 a[94:95], v11 offset:18432
    v_mfma_f32_16x16x32_bf16 a[232:235], a[52:55], a[108:111], a[232:235]
    v_mfma_f32_16x16x32_bf16 a[232:235], a[48:51], a[104:107], a[232:235]
    v_mfma_f32_16x16x32_bf16 a[236:239], a[56:59], a[104:107], a[236:239]
    buffer_load_dwordx4 v17, s[40:43], s49 offen offset:3072 sc1 lds
    v_mfma_f32_16x16x32_bf16 a[236:239], a[60:63], a[108:111], a[236:239]
    s_add_u32 s49, s49, 128
    v_mfma_f32_16x16x32_bf16 a[228:231], a[60:63], a[100:103], a[228:231]
    buffer_store_dwordx4 a[220:223], v2, s[24:27], s28 offen sc1
    v_mfma_f32_16x16x32_bf16 a[228:231], a[56:59], a[96:99], a[228:231]
    s_add_u32 s29, s29, s30
    s_mov_b32 s28, s29
    v_mfma_f32_16x16x32_bf16 v[80:83], a[0:3], a[112:115], v[80:83]
    v_mfma_f32_16x16x32_bf16 v[80:83], a[4:7], a[116:119], v[80:83]
    ds_read_b64_tr_b16 a[96:97], v12 offset:0
    v_mfma_f32_16x16x32_bf16 v[88:91], a[4:7], a[124:127], v[88:91]
    v_mfma_f32_16x16x32_bf16 v[88:91], a[0:3], a[120:123], v[88:91]
    s_add_u32 m0, s61, 4096
    ds_read_b128 a[0:3], v6 offset:0
    v_mfma_f32_16x16x32_bf16 v[92:95], a[8:11], a[120:123], v[92:95]
    buffer_load_dwordx4 v16, s[40:43], s50 offen offset:0 sc1 lds
    v_mfma_f32_16x16x32_bf16 v[92:95], a[12:15], a[124:127], v[92:95]
    s_add_u32 s61, s61, 32768
    ds_read_b128 a[4:7], v7 offset:0
    v_mfma_f32_16x16x32_bf16 v[84:87], a[12:15], a[116:119], v[84:87]
    s_cmp_ge_u32 s61, 98304
    s_cselect_b32 s90, 98304, 0
    ds_read_b64_tr_b16 a[98:99], v12 offset:2048
    v_mfma_f32_16x16x32_bf16 v[84:87], a[8:11], a[112:115], v[84:87]
    s_sub_u32 s61, s61, s90
    ds_read_b128 a[8:11], v6 offset:2048
    v_mfma_f32_16x16x32_bf16 v[144:147], a[16:19], a[112:115], v[144:147]
    ds_read_b128 a[12:15], v7 offset:2048
    v_mfma_f32_16x16x32_bf16 v[144:147], a[20:23], a[116:119], v[144:147]
    ds_read_b64_tr_b16 a[100:101], v12 offset:16384
    v_mfma_f32_16x16x32_bf16 v[152:155], a[20:23], a[124:127], v[152:155]
    v_mfma_f32_16x16x32_bf16 v[152:155], a[16:19], a[120:123], v[152:155]
    ds_read_b128 a[16:19], v6 offset:4096
    v_mfma_f32_16x16x32_bf16 v[156:159], a[24:27], a[120:123], v[156:159]
    buffer_load_dwordx4 v17, s[40:43], s50 offen offset:1024 sc1 lds
    v_mfma_f32_16x16x32_bf16 v[156:159], a[28:31], a[124:127], v[156:159]
    s_add_u32 s50, s50, 128
    ds_read_b128 a[20:23], v7 offset:4096
    v_mfma_f32_16x16x32_bf16 v[148:151], a[28:31], a[116:119], v[148:151]
    ds_read_b64_tr_b16 a[102:103], v12 offset:18432
    v_mfma_f32_16x16x32_bf16 v[148:151], a[24:27], a[112:115], v[148:151]
    ds_read_b128 a[24:27], v6 offset:6144
    v_mfma_f32_16x16x32_bf16 v[208:211], a[32:35], a[112:115], v[208:211]
    s_sub_u32 s65, s65, 1
    ds_read_b128 a[28:31], v7 offset:6144
    v_mfma_f32_16x16x32_bf16 v[208:211], a[36:39], a[116:119], v[208:211]
    ds_read_b64_tr_b16 a[104:105], v13 offset:0
    v_mfma_f32_16x16x32_bf16 v[216:219], a[36:39], a[124:127], v[216:219]
    v_mfma_f32_16x16x32_bf16 v[216:219], a[32:35], a[120:123], v[216:219]
    ds_read_b128 a[32:35], v6 offset:8192
    v_mfma_f32_16x16x32_bf16 v[220:223], a[40:43], a[120:123], v[220:223]
    buffer_load_dwordx4 v16, s[40:43], s51 offen offset:2048 sc1 lds
    v_mfma_f32_16x16x32_bf16 v[220:223], a[44:47], a[124:127], v[220:223]
    ds_read_b128 a[36:39], v7 offset:8192
    v_mfma_f32_16x16x32_bf16 v[212:215], a[44:47], a[116:119], v[212:215]
    ds_read_b64_tr_b16 a[106:107], v13 offset:2048
    v_mfma_f32_16x16x32_bf16 v[212:215], a[40:43], a[112:115], v[212:215]
    ds_read_b128 a[40:43], v6 offset:10240
    v_mfma_f32_16x16x32_bf16 a[240:243], a[48:51], a[112:115], a[240:243]
    ds_read_b128 a[44:47], v7 offset:10240
    v_mfma_f32_16x16x32_bf16 a[240:243], a[52:55], a[116:119], a[240:243]
    ds_read_b64_tr_b16 a[108:109], v13 offset:16384
    v_mfma_f32_16x16x32_bf16 a[248:251], a[52:55], a[124:127], a[248:251]
    v_mfma_f32_16x16x32_bf16 a[248:251], a[48:51], a[120:123], a[248:251]
    ds_read_b128 a[48:51], v6 offset:12288
    v_mfma_f32_16x16x32_bf16 a[252:255], a[56:59], a[120:123], a[252:255]
    buffer_load_dwordx4 v17, s[40:43], s51 offen offset:3072 sc1 lds
    v_mfma_f32_16x16x32_bf16 a[252:255], a[60:63], a[124:127], a[252:255]
    s_add_u32 s51, s51, 128
    ds_read_b128 a[52:55], v7 offset:12288
    v_mfma_f32_16x16x32_bf16 a[244:247], a[60:63], a[116:119], a[244:247]
    ds_read_b64_tr_b16 a[110:111], v13 offset:18432
    v_mfma_f32_16x16x32_bf16 a[244:247], a[56:59], a[112:115], a[244:247]
    ds_read_b128 a[56:59], v6 offset:14336
    ds_read_b128 a[60:63], v7 offset:14336
m_loop20:
    s_waitcnt lgkmcnt(15)
    v_mfma_f32_16x16x32_bf16 v[32:35], a[0:3], a[64:67], v[32:35]
    ds_read_b64_tr_b16 a[112:113], v14 offset:0
    v_mfma_f32_16x16x32_bf16 v[32:35], a[4:7], a[68:71], v[32:35]
    ds_read_b64_tr_b16 a[114:115], v14 offset:2048
    v_mfma_f32_16x16x32_bf16 v[40:43], a[4:7], a[76:79], v[40:43]
    ds_read_b64_tr_b16 a[116:117], v14 offset:16384
    v_mfma_f32_16x16x32_bf16 v[40:43], a[0:3], a[72:75], v[40:43]
    ds_read_b64_tr_b16 a[118:119], v14 offset:18432
    v_mfma_f32_16x16x32_bf16 v[44:47], a[8:11], a[72:75], v[44:47]
    ds_read_b64_tr_b16 a[120:121], v15 offset:0
    v_mfma_f32_16x16x32_bf16 v[44:47], a[12:15], a[76:79], v[44:47]
    ds_read_b64_tr_b16 a[122:123], v15 offset:2048
    v_mfma_f32_16x16x32_bf16 v[36:39], a[12:15], a[68:71], v[36:39]
    ds_read_b64_tr_b16 a[124:125], v15 offset:16384
    v_mfma_f32_16x16x32_bf16 v[36:39], a[8:11], a[64:67], v[36:39]
    ds_read_b64_tr_b16 a[126:127], v15 offset:18432
    v_mfma_f32_16x16x32_bf16 v[96:99], a[16:19], a[64:67], v[96:99]
    v_mfma_f32_16x16x32_bf16 v[96:99], a[20:23], a[68:71], v[96:99]
    v_mfma_f32_16x16x32_bf16 v[104:107], a[20:23], a[76:79], v[104:107]
    v_mfma_f32_16x16x32_bf16 v[104:107], a[16:19], a[72:75], v[104:107]
    s_waitcnt lgkmcnt(15)
    v_mfma_f32_16x16x32_bf16 v[108:111], a[24:27], a[72:75], v[108:111]
    v_xor_b32 v8, s60, v8
    v_xor_b32 v9, s60, v9
    v_mfma_f32_16x16x32_bf16 v[108:111], a[28:31], a[76:79], v[108:111]
    v_xor_b32 v10, s60, v10
    v_xor_b32 v11, s60, v11
    v_mfma_f32_16x16x32_bf16 v[100:103], a[28:31], a[68:71], v[100:103]
    v_xor_b32 v12, s60, v12
    v_xor_b32 v13, s60, v13
    v_mfma_f32_16x16x32_bf16 v[100:103], a[24:27], a[64:67], v[100:103]
    v_xor_b32 v14, s60, v14
    v_xor_b32 v15, s60, v15
    v_mfma_f32_16x16x32_bf16 v[160:163], a[32:35], a[64:67], v[160:163]
    v_mfma_f32_16x16x32_bf16 v[160:163], a[36:39], a[68:71], v[160:163]
    v_mfma_f32_16x16x32_bf16 v[168:171], a[36:39], a[76:79], v[168:171]
    v_mfma_f32_16x16x32_bf16 v[168:171], a[32:35], a[72:75], v[168:171]
    s_waitcnt lgkmcnt(14)
    v_mfma_f32_16x16x32_bf16 v[172:175], a[40:43], a[72:75], v[172:175]
    v_mfma_f32_16x16x32_bf16 v[172:175], a[44:47], a[76:79], v[172:175]
    v_mfma_f32_16x16x32_bf16 v[164:167], a[44:47], a[68:71], v[164:167]
    v_mfma_f32_16x16x32_bf16 v[164:167], a[40:43], a[64:67], v[164:167]
    s_waitcnt lgkmcnt(11)
    v_mfma_f32_16x16x32_bf16 v[224:227], a[48:51], a[64:67], v[224:227]
    v_mfma_f32_16x16x32_bf16 v[224:227], a[52:55], a[68:71], v[224:227]
    v_mfma_f32_16x16x32_bf16 v[232:235], a[52:55], a[76:79], v[232:235]
    v_mfma_f32_16x16x32_bf16 v[232:235], a[48:51], a[72:75], v[232:235]
    s_waitcnt lgkmcnt(8)
    v_mfma_f32_16x16x32_bf16 v[236:239], a[56:59], a[72:75], v[236:239]
    v_mfma_f32_16x16x32_bf16 v[236:239], a[60:63], a[76:79], v[236:239]
    v_mfma_f32_16x16x32_bf16 v[228:231], a[60:63], a[68:71], v[228:231]
    s_waitcnt vmcnt(8) lgkmcnt(0)
    v_mfma_f32_16x16x32_bf16 v[228:231], a[56:59], a[64:67], v[228:231]
    s_barrier
    v_mfma_f32_16x16x32_bf16 v[48:51], a[0:3], a[80:83], v[48:51]
    ds_read_b64_tr_b16 a[64:65], v8 offset:0
    v_mfma_f32_16x16x32_bf16 v[48:51], a[4:7], a[84:87], v[48:51]
    s_add_u32 m0, s62, 0
    v_mfma_f32_16x16x32_bf16 v[56:59], a[4:7], a[92:95], v[56:59]
    buffer_load_dwordx4 v18, s[44:47], s52 offen offset:0 sc1 lds
    v_mfma_f32_16x16x32_bf16 v[56:59], a[0:3], a[88:91], v[56:59]
    ds_read_b64_tr_b16 a[66:67], v8 offset:2048
    v_mfma_f32_16x16x32_bf16 v[60:63], a[8:11], a[88:91], v[60:63]
    s_add_u32 s64, s64, 32768
    v_mfma_f32_16x16x32_bf16 v[60:63], a[12:15], a[92:95], v[60:63]
    s_cmp_ge_u32 s64, 98304
    s_cselect_b32 s63, 4294901760, s59
    s_cselect_b32 s64, 0, s64
    v_mfma_f32_16x16x32_bf16 v[52:55], a[12:15], a[84:87], v[52:55]
    buffer_load_dwordx4 v19, s[44:47], s52 offen offset:1024 sc1 lds
    v_mfma_f32_16x16x32_bf16 v[52:55], a[8:11], a[80:83], v[52:55]
    s_add_u32 s52, s52, s56
    ds_read_b64_tr_b16 a[68:69], v8 offset:16384
    v_mfma_f32_16x16x32_bf16 v[112:115], a[16:19], a[80:83], v[112:115]
    v_mfma_f32_16x16x32_bf16 v[112:115], a[20:23], a[84:87], v[112:115]
    v_mfma_f32_16x16x32_bf16 v[120:123], a[20:23], a[92:95], v[120:123]
    buffer_load_dwordx4 v18, s[44:47], s53 offen offset:2048 sc1 lds
    v_mfma_f32_16x16x32_bf16 v[120:123], a[16:19], a[88:91], v[120:123]
    ds_read_b64_tr_b16 a[70:71], v8 offset:18432
    v_mfma_f32_16x16x32_bf16 v[124:127], a[24:27], a[88:91], v[124:127]
    v_mfma_f32_16x16x32_bf16 v[124:127], a[28:31], a[92:95], v[124:127]
    v_mfma_f32_16x16x32_bf16 v[116:119], a[28:31], a[84:87], v[116:119]
    buffer_load_dwordx4 v19, s[44:47], s53 offen offset:3072 sc1 lds
    v_mfma_f32_16x16x32_bf16 v[116:119], a[24:27], a[80:83], v[116:119]
    s_add_u32 s53, s53, s56
    ds_read_b64_tr_b16 a[72:73], v9 offset:0
    v_mfma_f32_16x16x32_bf16 v[176:179], a[32:35], a[80:83], v[176:179]
    v_mfma_f32_16x16x32_bf16 v[176:179], a[36:39], a[84:87], v[176:179]
    s_add_u32 m0, s62, 4096
    v_mfma_f32_16x16x32_bf16 v[184:187], a[36:39], a[92:95], v[184:187]
    buffer_load_dwordx4 v20, s[44:47], s54 offen offset:0 sc1 lds
    v_mfma_f32_16x16x32_bf16 v[184:187], a[32:35], a[88:91], v[184:187]
    s_xor_b32 s62, s62, 229376
    ds_read_b64_tr_b16 a[74:75], v9 offset:2048
    v_mfma_f32_16x16x32_bf16 v[188:191], a[40:43], a[88:91], v[188:191]
    v_mfma_f32_16x16x32_bf16 v[188:191], a[44:47], a[92:95], v[188:191]
    v_mfma_f32_16x16x32_bf16 v[180:183], a[44:47], a[84:87], v[180:183]
    buffer_load_dwordx4 v21, s[44:47], s54 offen offset:1024 sc1 lds
    v_mfma_f32_16x16x32_bf16 v[180:183], a[40:43], a[80:83], v[180:183]
    s_add_u32 s54, s54, s56
    ds_read_b64_tr_b16 a[76:77], v9 offset:16384
    v_mfma_f32_16x16x32_bf16 v[240:243], a[48:51], a[80:83], v[240:243]
    v_mfma_f32_16x16x32_bf16 v[240:243], a[52:55], a[84:87], v[240:243]
    v_mfma_f32_16x16x32_bf16 v[248:251], a[52:55], a[92:95], v[248:251]
    buffer_load_dwordx4 v20, s[44:47], s55 offen offset:2048 sc1 lds
    v_mfma_f32_16x16x32_bf16 v[248:251], a[48:51], a[88:91], v[248:251]
    ds_read_b64_tr_b16 a[78:79], v9 offset:18432
    v_mfma_f32_16x16x32_bf16 v[252:255], a[56:59], a[88:91], v[252:255]
    v_add_u32 v6, s63, v6
    v_add_u32 v7, s63, v7
    v_mfma_f32_16x16x32_bf16 v[252:255], a[60:63], a[92:95], v[252:255]
    v_mfma_f32_16x16x32_bf16 v[244:247], a[60:63], a[84:87], v[244:247]
    buffer_load_dwordx4 v21, s[44:47], s55 offen offset:3072 sc1 lds
    v_mfma_f32_16x16x32_bf16 v[244:247], a[56:59], a[80:83], v[244:247]
    s_add_u32 s55, s55, s56
    v_mfma_f32_16x16x32_bf16 v[64:67], a[0:3], a[96:99], v[64:67]
    ds_read_b64_tr_b16 a[80:81], v10 offset:0
    v_mfma_f32_16x16x32_bf16 v[64:67], a[4:7], a[100:103], v[64:67]
    v_mfma_f32_16x16x32_bf16 v[72:75], a[4:7], a[108:111], v[72:75]
    v_mfma_f32_16x16x32_bf16 v[72:75], a[0:3], a[104:107], v[72:75]
    s_add_u32 m0, s61, 0
    ds_read_b64_tr_b16 a[82:83], v10 offset:2048
    v_mfma_f32_16x16x32_bf16 v[76:79], a[8:11], a[104:107], v[76:79]
    buffer_load_dwordx4 v16, s[40:43], s48 offen offset:0 sc1 lds
    v_mfma_f32_16x16x32_bf16 v[76:79], a[12:15], a[108:111], v[76:79]
    v_mfma_f32_16x16x32_bf16 v[68:71], a[12:15], a[100:103], v[68:71]
    ds_read_b64_tr_b16 a[84:85], v10 offset:16384
    v_mfma_f32_16x16x32_bf16 v[68:71], a[8:11], a[96:99], v[68:71]
    v_mfma_f32_16x16x32_bf16 v[128:131], a[16:19], a[96:99], v[128:131]
    v_mfma_f32_16x16x32_bf16 v[128:131], a[20:23], a[100:103], v[128:131]
    ds_read_b64_tr_b16 a[86:87], v10 offset:18432
    v_mfma_f32_16x16x32_bf16 v[136:139], a[20:23], a[108:111], v[136:139]
    v_mfma_f32_16x16x32_bf16 v[136:139], a[16:19], a[104:107], v[136:139]
    v_mfma_f32_16x16x32_bf16 v[140:143], a[24:27], a[104:107], v[140:143]
    buffer_load_dwordx4 v17, s[40:43], s48 offen offset:1024 sc1 lds
    v_mfma_f32_16x16x32_bf16 v[140:143], a[28:31], a[108:111], v[140:143]
    s_add_u32 s48, s48, 128
    ds_read_b64_tr_b16 a[88:89], v11 offset:0
    v_mfma_f32_16x16x32_bf16 v[132:135], a[28:31], a[100:103], v[132:135]
    v_mfma_f32_16x16x32_bf16 v[132:135], a[24:27], a[96:99], v[132:135]
    v_mfma_f32_16x16x32_bf16 v[192:195], a[32:35], a[96:99], v[192:195]
    v_mfma_f32_16x16x32_bf16 v[192:195], a[36:39], a[100:103], v[192:195]
    ds_read_b64_tr_b16 a[90:91], v11 offset:2048
    v_mfma_f32_16x16x32_bf16 v[200:203], a[36:39], a[108:111], v[200:203]
    v_mfma_f32_16x16x32_bf16 v[200:203], a[32:35], a[104:107], v[200:203]
    v_mfma_f32_16x16x32_bf16 v[204:207], a[40:43], a[104:107], v[204:207]
    buffer_load_dwordx4 v16, s[40:43], s49 offen offset:2048 sc1 lds
    v_mfma_f32_16x16x32_bf16 v[204:207], a[44:47], a[108:111], v[204:207]
    ds_read_b64_tr_b16 a[92:93], v11 offset:16384
    v_mfma_f32_16x16x32_bf16 v[196:199], a[44:47], a[100:103], v[196:199]
    v_mfma_f32_16x16x32_bf16 v[196:199], a[40:43], a[96:99], v[196:199]
    v_mfma_f32_16x16x32_bf16 a[224:227], a[48:51], a[96:99], a[224:227]
    v_mfma_f32_16x16x32_bf16 a[224:227], a[52:55], a[100:103], a[224:227]
    ds_read_b64_tr_b16 a[94:95], v11 offset:18432
    v_mfma_f32_16x16x32_bf16 a[232:235], a[52:55], a[108:111], a[232:235]
    v_mfma_f32_16x16x32_bf16 a[232:235], a[48:51], a[104:107], a[232:235]
    v_mfma_f32_16x16x32_bf16 a[236:239], a[56:59], a[104:107], a[236:239]
    buffer_load_dwordx4 v17, s[40:43], s49 offen offset:3072 sc1 lds
    v_mfma_f32_16x16x32_bf16 a[236:239], a[60:63], a[108:111], a[236:239]
    s_add_u32 s49, s49, 128
    v_mfma_f32_16x16x32_bf16 a[228:231], a[60:63], a[100:103], a[228:231]
    v_mfma_f32_16x16x32_bf16 a[228:231], a[56:59], a[96:99], a[228:231]
    v_mfma_f32_16x16x32_bf16 v[80:83], a[0:3], a[112:115], v[80:83]
    v_mfma_f32_16x16x32_bf16 v[80:83], a[4:7], a[116:119], v[80:83]
    ds_read_b64_tr_b16 a[96:97], v12 offset:0
    v_mfma_f32_16x16x32_bf16 v[88:91], a[4:7], a[124:127], v[88:91]
    v_mfma_f32_16x16x32_bf16 v[88:91], a[0:3], a[120:123], v[88:91]
    s_add_u32 m0, s61, 4096
    ds_read_b128 a[0:3], v6 offset:0
    v_mfma_f32_16x16x32_bf16 v[92:95], a[8:11], a[120:123], v[92:95]
    buffer_load_dwordx4 v16, s[40:43], s50 offen offset:0 sc1 lds
    v_mfma_f32_16x16x32_bf16 v[92:95], a[12:15], a[124:127], v[92:95]
    s_add_u32 s61, s61, 32768
    ds_read_b128 a[4:7], v7 offset:0
    v_mfma_f32_16x16x32_bf16 v[84:87], a[12:15], a[116:119], v[84:87]
    s_cmp_ge_u32 s61, 98304
    s_cselect_b32 s90, 98304, 0
    ds_read_b64_tr_b16 a[98:99], v12 offset:2048
    v_mfma_f32_16x16x32_bf16 v[84:87], a[8:11], a[112:115], v[84:87]
    s_sub_u32 s61, s61, s90
    ds_read_b128 a[8:11], v6 offset:2048
    v_mfma_f32_16x16x32_bf16 v[144:147], a[16:19], a[112:115], v[144:147]
    ds_read_b128 a[12:15], v7 offset:2048
    v_mfma_f32_16x16x32_bf16 v[144:147], a[20:23], a[116:119], v[144:147]
    ds_read_b64_tr_b16 a[100:101], v12 offset:16384
    v_mfma_f32_16x16x32_bf16 v[152:155], a[20:23], a[124:127], v[152:155]
    v_mfma_f32_16x16x32_bf16 v[152:155], a[16:19], a[120:123], v[152:155]
    ds_read_b128 a[16:19], v6 offset:4096
    v_mfma_f32_16x16x32_bf16 v[156:159], a[24:27], a[120:123], v[156:159]
    buffer_load_dwordx4 v17, s[40:43], s50 offen offset:1024 sc1 lds
    v_mfma_f32_16x16x32_bf16 v[156:159], a[28:31], a[124:127], v[156:159]
    s_add_u32 s50, s50, 128
    ds_read_b128 a[20:23], v7 offset:4096
    v_mfma_f32_16x16x32_bf16 v[148:151], a[28:31], a[116:119], v[148:151]
    ds_read_b64_tr_b16 a[102:103], v12 offset:18432
    v_mfma_f32_16x16x32_bf16 v[148:151], a[24:27], a[112:115], v[148:151]
    ds_read_b128 a[24:27], v6 offset:6144
    v_mfma_f32_16x16x32_bf16 v[208:211], a[32:35], a[112:115], v[208:211]
    s_sub_u32 s65, s65, 1
    ds_read_b128 a[28:31], v7 offset:6144
    v_mfma_f32_16x16x32_bf16 v[208:211], a[36:39], a[116:119], v[208:211]
    ds_read_b64_tr_b16 a[104:105], v13 offset:0
    v_mfma_f32_16x16x32_bf16 v[216:219], a[36:39], a[124:127], v[216:219]
    v_mfma_f32_16x16x32_bf16 v[216:219], a[32:35], a[120:123], v[216:219]
    ds_read_b128 a[32:35], v6 offset:8192
    v_mfma_f32_16x16x32_bf16 v[220:223], a[40:43], a[120:123], v[220:223]
    buffer_load_dwordx4 v16, s[40:43], s51 offen offset:2048 sc1 lds
    v_mfma_f32_16x16x32_bf16 v[220:223], a[44:47], a[124:127], v[220:223]
    ds_read_b128 a[36:39], v7 offset:8192
    v_mfma_f32_16x16x32_bf16 v[212:215], a[44:47], a[116:119], v[212:215]
    ds_read_b64_tr_b16 a[106:107], v13 offset:2048
    v_mfma_f32_16x16x32_bf16 v[212:215], a[40:43], a[112:115], v[212:215]
    ds_read_b128 a[40:43], v6 offset:10240
    v_mfma_f32_16x16x32_bf16 a[240:243], a[48:51], a[112:115], a[240:243]
    ds_read_b128 a[44:47], v7 offset:10240
    v_mfma_f32_16x16x32_bf16 a[240:243], a[52:55], a[116:119], a[240:243]
    ds_read_b64_tr_b16 a[108:109], v13 offset:16384
    v_mfma_f32_16x16x32_bf16 a[248:251], a[52:55], a[124:127], a[248:251]
    v_mfma_f32_16x16x32_bf16 a[248:251], a[48:51], a[120:123], a[248:251]
    ds_read_b128 a[48:51], v6 offset:12288
    v_mfma_f32_16x16x32_bf16 a[252:255], a[56:59], a[120:123], a[252:255]
    buffer_load_dwordx4 v17, s[40:43], s51 offen offset:3072 sc1 lds
    v_mfma_f32_16x16x32_bf16 a[252:255], a[60:63], a[124:127], a[252:255]
    s_add_u32 s51, s51, 128
    ds_read_b128 a[52:55], v7 offset:12288
    v_mfma_f32_16x16x32_bf16 a[244:247], a[60:63], a[116:119], a[244:247]
    s_cmp_gt_u32 s65, s67
    ds_read_b64_tr_b16 a[110:111], v13 offset:18432
    v_mfma_f32_16x16x32_bf16 a[244:247], a[56:59], a[112:115], a[244:247]
    ds_read_b128 a[56:59], v6 offset:14336
    ds_read_b128 a[60:63], v7 offset:14336
    s_cbranch_scc1 m_loop20
    s_cmp_lg_u32 s65, 0
    s_cbranch_scc1 m_dosw21
m_epi12:
    s_cmp_eq_u32 s94, 0
    s_cbranch_scc1 m_last24
    s_mov_b32 s3, 1048576
m_spin28:
    v_readfirstlane_b32 s4, v4
    v_readfirstlane_b32 s5, v5
    s_nop 3
    s_cmp_lg_u32 s4, 0
    s_cbranch_scc1 m_ok29
    s_sub_u32 s3, s3, 1
    s_cbranch_scc1 m_ok29
    s_sleep 32
    buffer_load_dwordx2 v[4:5], off, s[12:15], 0 sc1
    s_waitcnt vmcnt(0)
    s_branch m_spin28
m_ok29:
    s_cmp_ge_u32 s68, 16
    s_cbranch_scc1 m_q031
    s_call_b64 s[20:21], m_epf22
    s_mov_b32 s17, s101
    s_mov_b32 s66, 2
    s_branch m_q130
m_q031:
    s_call_b64 s[20:21], m_eps23
    s_mov_b32 s17, s101
    s_add_u32 s28, s98, s99
    s_mov_b32 s29, s28
    s_mov_b32 s30, s99
    s_mov_b32 s31, s100
    s_mov_b32 s26, 268435456
m_q130:
    s_mov_b32 s95, s82
    s_mov_b32 s96, s83
    s_mov_b32 s97, s84
    s_mov_b32 s98, s85
    s_mov_b32 s99, s86
    s_mov_b32 s100, s87
    s_mov_b32 s101, s88
    s_sub_u32 s67, s95, 5
    s_max_u32 s67, s67, 4
    s_mov_b32 s94, 0
    s_branch m_tile11
m_last24:
    s_cmp_eq_u32 s70, 0
    s_cbranch_scc1 m_kvl27
    buffer_load_dwordx2 v[4:5], off, s[12:15], 0 sc1
    s_call_b64 s[20:21], m_epf22
    s_waitcnt vmcnt(0)
    s_barrier
    s_mov_b32 s3, 1048576
m_spin32:
    v_readfirstlane_b32 s4, v4
    v_readfirstlane_b32 s5, v5
    s_nop 3
    s_cmp_lg_u32 s4, 0
    s_cbranch_scc1 m_ok33
    s_sub_u32 s3, s3, 1
    s_cbranch_scc1 m_ok33
    s_sleep 32
    buffer_load_dwordx2 v[4:5], off, s[12:15], 0 sc1
    s_waitcnt vmcnt(0)
    s_branch m_spin32
m_ok33:
    s_cmp_lg_u32 s16, 0
    s_cbranch_scc1 m_np34
    v_mov_b32 v4, s4
    v_mov_b32 v5, s5
    s_add_u32 s90, s101, 117440512
    s_mov_b64 exec, 1
    buffer_store_dwordx2 v[4:5], off, s[8:11], s90 sc1
    s_mov_b64 exec, -1
m_np34:
    s_cmp_lg_u32 s16, 0
    s_cbranch_scc1 m_pw35
    s_and_b32 s92, s2, 7
    s_lshl_b32 s92, s92, 2
    s_bfe_u32 s93, s2, 0x20003
    s_add_u32 s92, s92, s93
    s_lshr_b32 s93, s2, 5
    s_lshl_b32 s93, s93, 2
    s_or_b32 s93, s93, 0x40000
    s_lshr_b32 s90, s92, 1
    s_lshl_b32 s90, s90, 7
    s_add_u32 s90, s90, 117440512
    s_bfe_u32 s91, 873473623, s93
    s_lshr_b32 s91, s91, 1
    v_mov_b32 v0, s91
    v_add_u32 v4, 8, v1
    v_cmp_gt_u32 vcc, 8, v1
    s_nop 1
    v_cndmask_b32 v0, v0, v4, vcc
    s_bfe_u32 s91, 4225681832, s93
    s_lshr_b32 s91, s91, 1
    v_writelane_b32 v0, s91, 8
    v_lshlrev_b32 v0, 3, v0
    buffer_load_dwordx2 v[4:5], v0, s[8:11], s90 offen sc1
    s_waitcnt vmcnt(0)
    s_mov_b32 s3, 1048576
m_spin36:
    v_cmp_ne_u64 s[22:23], s[4:5], v[4:5]
    s_nop 3
    s_cmp_eq_u64 s[22:23], 0
    s_cbranch_scc1 m_ok37
    s_sub_u32 s3, s3, 1
    s_cbranch_scc1 m_ok37
    s_sleep 16
    s_and_b32 s92, s2, 7
    s_lshl_b32 s92, s92, 2
    s_bfe_u32 s93, s2, 0x20003
    s_add_u32 s92, s92, s93
    s_lshr_b32 s93, s2, 5
    s_lshl_b32 s93, s93, 2
    s_or_b32 s93, s93, 0x40000
    s_lshr_b32 s90, s92, 1
    s_lshl_b32 s90, s90, 7
    s_add_u32 s90, s90, 117440512
    s_bfe_u32 s91, 873473623, s93
    s_lshr_b32 s91, s91, 1
    v_mov_b32 v0, s91
    v_add_u32 v4, 8, v1
    v_cmp_gt_u32 vcc, 8, v1
    s_nop 1
    v_cndmask_b32 v0, v0, v4, vcc
    s_bfe_u32 s91, 4225681832, s93
    s_lshr_b32 s91, s91, 1
    v_writelane_b32 v0, s91, 8
    v_lshlrev_b32 v0, 3, v0
    buffer_load_dwordx2 v[4:5], v0, s[8:11], s90 offen sc1
    s_waitcnt vmcnt(0)
    s_branch m_spin36
m_ok37:
m_pw35:
    s_barrier
    s_and_b32 s92, s2, 7
    s_lshl_b32 s92, s92, 2
    s_bfe_u32 s93, s2, 0x20003
    s_add_u32 s92, s92, s93
    s_lshr_b32 s93, s2, 5
    s_lshl_b32 s93, s93, 2
    s_or_b32 s93, s93, 0x40000
    s_bfe_u32 s90, 4225681832, s93
    s_lshl_b32 s90, s90, 3
    s_lshl_b32 s91, s16, 1
    s_add_u32 s90, s90, s91
    s_lshl_b32 s90, s90, 12
    s_lshl_b32 s91, s92, 19
    s_add_u32 s90, s90, s91
    s_add_u32 s90, s90, 0
    buffer_load_dwordx4 a[128:131], v2, s[8:11], s90 offen offset:0 sc1
    buffer_load_dwordx4 a[132:135], v2, s[8:11], s90 offen offset:1024 sc1
    buffer_load_dwordx4 a[136:139], v2, s[8:11], s90 offen offset:2048 sc1
    buffer_load_dwordx4 a[140:143], v2, s[8:11], s90 offen offset:3072 sc1
    s_bfe_u32 s90, 4225681832, s93
    s_lshl_b32 s90, s90, 3
    s_lshl_b32 s91, s16, 1
    s_add_u32 s90, s90, s91
    s_lshl_b32 s90, s90, 12
    s_lshl_b32 s91, s92, 19
    s_add_u32 s90, s90, s91
    s_add_u32 s90, s90, 4096
    buffer_load_dwordx4 a[144:147], v2, s[8:11], s90 offen offset:0 sc1
    buffer_load_dwordx4 a[148:151], v2, s[8:11], s90 offen offset:1024 sc1
    buffer_load_dwordx4 a[152:155], v2, s[8:11], s90 offen offset:2048 sc1
    buffer_load_dwordx4 a[156:159], v2, s[8:11], s90 offen offset:3072 sc1
    s_bfe_u32 s90, 873473623, s93
    s_lshl_b32 s90, s90, 3
    s_lshl_b32 s91, s16, 1
    s_add_u32 s90, s90, s91
    s_lshl_b32 s90, s90, 12
    s_lshl_b32 s91, s92, 19
    s_add_u32 s90, s90, s91
    s_add_u32 s90, s90, 0
    buffer_load_dwordx4 a[160:163], v2, s[8:11], s90 offen offset:0 sc1
    buffer_load_dwordx4 a[164:167], v2, s[8:11], s90 offen offset:1024 sc1
    buffer_load_dwordx4 a[168:171], v2, s[8:11], s90 offen offset:2048 sc1
    buffer_load_dwordx4 a[172:175], v2, s[8:11], s90 offen offset:3072 sc1
    s_bfe_u32 s90, 873473623, s93
    s_lshl_b32 s90, s90, 3
    s_lshl_b32 s91, s16, 1
    s_add_u32 s90, s90, s91
    s_lshl_b32 s90, s90, 12
    s_lshl_b32 s91, s92, 19
    s_add_u32 s90, s90, s91
    s_add_u32 s90, s90, 4096
    buffer_load_dwordx4 a[176:179], v2, s[8:11], s90 offen offset:0 sc1
    buffer_load_dwordx4 a[180:183], v2, s[8:11], s90 offen offset:1024 sc1
    buffer_load_dwordx4 a[184:187], v2, s[8:11], s90 offen offset:2048 sc1
    buffer_load_dwordx4 a[188:191], v2, s[8:11], s90 offen offset:3072 sc1
    s_mov_b32 s94, 1
m_kvl27:
    s_waitcnt lgkmcnt(0)
    s_and_b32 s92, s2, 7
    s_lshl_b32 s92, s92, 2
    s_bfe_u32 s93, s2, 0x20003
    s_add_u32 s92, s92, s93
    s_lshr_b32 s93, s2, 5
    s_lshl_b32 s93, s93, 2
    s_or_b32 s93, s93, 0x40000
    s_mov_b32 s32, s92
    s_bfe_u32 s33, 4225681832, s93
    s_add_u32 s33, s33, 1
    s_bfe_u32 s34, 873473623, s93
    s_add_u32 s34, s34, 1
    s_lshl_b32 s60, s16, 12
    v_add_u32 v7, s60, v2
    s_lshl_b32 s90, s34, 2
    s_lshl_b32 s91, s33, 2
    s_lshl_b32 s26, s91, 13
    s_mov_b32 s30, s26
    s_sub_u32 s67, s90, 4
    s_add_u32 s67, s67, s16
    s_add_u32 s68, s67, 1
    s_mov_b32 s69, s90
    s_sub_u32 s70, s91, 4
    s_add_u32 s70, s70, s16
    s_add_u32 s71, s70, 1
    s_mov_b32 s72, s91
    s_cmp_lt_u32 s16, 2
    s_cselect_b32 s90, 2, 0
    s_sub_u32 s72, s72, s90
    s_mov_b32 s27, 0x20000
    s_mov_b32 s31, 0x20000
    s_lshl_b32 s82, s32, 19
    s_add_u32 s90, s82, 16777216
    s_add_u32 s24, s6, s90
    s_addc_u32 s25, s7, 0
    s_add_u32 s90, s82, 33554432
    s_add_u32 s28, s6, s90
    s_addc_u32 s29, s7, 0
    s_cmp_eq_u32 s94, 1
    s_cbranch_scc1 m_w068
    s_call_b64 s[20:21], m_epl66
    s_mov_b32 s17, s101
    s_mov_b32 s38, 268435456
    s_branch m_init26
m_w068:
    s_mov_b32 s56, 0
    s_mov_b32 s57, 0
    s_mov_b32 m0, s60
    s_nop 0
    buffer_load_dwordx4 v7, s[24:27], s56 offen offset:0 sc1 lds
    buffer_load_dwordx4 v7, s[24:27], s56 offen offset:1024 sc1 lds
    buffer_load_dwordx4 v7, s[24:27], s56 offen offset:2048 sc1 lds
    buffer_load_dwordx4 v7, s[24:27], s56 offen offset:3072 sc1 lds
    s_mov_b32 s56, 16384
    s_add_u32 s59, s60, 32768
    s_mov_b32 m0, s59
    s_nop 0
    buffer_load_dwordx4 v7, s[24:27], s56 offen offset:0 sc1 lds
    buffer_load_dwordx4 v7, s[24:27], s56 offen offset:1024 sc1 lds
    buffer_load_dwordx4 v7, s[24:27], s56 offen offset:2048 sc1 lds
    buffer_load_dwordx4 v7, s[24:27], s56 offen offset:3072 sc1 lds
    s_add_u32 s56, s56, 16384
    s_add_u32 m0, s59, 16384
    s_nop 0
    buffer_load_dwordx4 v7, s[28:31], s57 offen offset:0 sc1 lds
    buffer_load_dwordx4 v7, s[28:31], s57 offen offset:1024 sc1 lds
    buffer_load_dwordx4 v7, s[28:31], s57 offen offset:2048 sc1 lds
    buffer_load_dwordx4 v7, s[28:31], s57 offen offset:3072 sc1 lds
    s_add_u32 s57, s57, 16384
    s_add_u32 s59, s59, 32768
    s_mov_b32 m0, s59
    s_nop 0
    buffer_load_dwordx4 v7, s[24:27], s56 offen offset:0 sc1 lds
    buffer_load_dwordx4 v7, s[24:27], s56 offen offset:1024 sc1 lds
    buffer_load_dwordx4 v7, s[24:27], s56 offen offset:2048 sc1 lds
    buffer_load_dwordx4 v7, s[24:27], s56 offen offset:3072 sc1 lds
    s_add_u32 s56, s56, 16384
    s_add_u32 m0, s59, 16384
    s_nop 0
    buffer_load_dwordx4 v7, s[28:31], s57 offen offset:0 sc1 lds
    buffer_load_dwordx4 v7, s[28:31], s57 offen offset:1024 sc1 lds
    buffer_load_dwordx4 v7, s[28:31], s57 offen offset:2048 sc1 lds
    buffer_load_dwordx4 v7, s[28:31], s57 offen offset:3072 sc1 lds
    s_add_u32 s57, s57, 16384
    s_add_u32 s59, s59, 32768
    s_mov_b32 m0, s59
    s_nop 0
    buffer_load_dwordx4 v7, s[24:27], s56 offen offset:0 sc1 lds
    buffer_load_dwordx4 v7, s[24:27], s56 offen offset:1024 sc1 lds
    buffer_load_dwordx4 v7, s[24:27], s56 offen offset:2048 sc1 lds
    buffer_load_dwordx4 v7, s[24:27], s56 offen offset:3072 sc1 lds
    s_add_u32 s56, s56, 16384
    s_add_u32 m0, s59, 16384
    s_nop 0
    buffer_load_dwordx4 v7, s[28:31], s57 offen offset:0 sc1 lds
    buffer_load_dwordx4 v7, s[28:31], s57 offen offset:1024 sc1 lds
    buffer_load_dwordx4 v7, s[28:31], s57 offen offset:2048 sc1 lds
    buffer_load_dwordx4 v7, s[28:31], s57 offen offset:3072 sc1 lds
    s_add_u32 s57, s57, 16384
    s_add_u32 s59, s59, 32768
    s_mov_b32 m0, s59
    s_nop 0
    buffer_load_dwordx4 v7, s[24:27], s56 offen offset:0 sc1 lds
    buffer_load_dwordx4 v7, s[24:27], s56 offen offset:1024 sc1 lds
    buffer_load_dwordx4 v7, s[24:27], s56 offen offset:2048 sc1 lds
    buffer_load_dwordx4 v7, s[24:27], s56 offen offset:3072 sc1 lds
    s_add_u32 s56, s56, 16384
    s_add_u32 m0, s59, 16384
    s_nop 0
    buffer_load_dwordx4 v7, s[28:31], s57 offen offset:0 sc1 lds
    buffer_load_dwordx4 v7, s[28:31], s57 offen offset:1024 sc1 lds
    buffer_load_dwordx4 v7, s[28:31], s57 offen offset:2048 sc1 lds
    buffer_load_dwordx4 v7, s[28:31], s57 offen offset:3072 sc1 lds
    s_add_u32 s57, s57, 16384
    s_add_u32 s59, s59, 32768
    s_waitcnt vmcnt(0)
    s_mov_b32 s38, 0
m_init26:
    s_mov_b32 s56, 81920
    s_mov_b32 s57, 65536
    s_nop 1
    v_mov_b32 v9, 0xff800000
    s_mov_b32 s65, 1233125376
    s_lshl_b32 s91, s16, 1
    s_sub_u32 s91, s91, 8
    s_lshl_b32 s78, s33, 3
    s_add_u32 s78, s78, s91
    s_lshl_b32 s79, s34, 3
    s_add_u32 s79, s79, s91
    s_mov_b32 s36, s6
    s_mov_b32 s37, s7
    s_mov_b32 s39, 0x20000
    s_load_dwordx2 s[48:49], s[0:1], 64
    s_load_dwordx2 s[50:51], s[0:1], 16
    s_load_dwordx2 s[54:55], s[0:1], 72
    s_mov_b32 s47, 0x20000
    s_lshl_b32 s90, s99, 1
    s_add_u32 s98, s98, s90
    s_lshl_b32 s90, s100, 2
    s_add_u32 s40, s98, s90
    s_lshr_b32 s90, s32, 1
    s_lshl_b32 s90, s90, 7
    s_add_u32 s90, s90, 117444608
    s_lshr_b32 s91, s2, 6
    s_lshl_b32 s91, s91, 8
    s_add_u32 s91, s91, 117446592
    v_min_u32 v10, 31, v1
    v_lshlrev_b32 v10, 3, v10
    v_mov_b32 v11, s90
    v_mov_b32 v8, s91
    v_cmp_gt_u32 vcc, 8, v1
    s_nop 1
    v_cndmask_b32 v11, v8, v11, vcc
    v_add_u32 v10, v10, v11
    s_mov_b32 s58, 0
    v_mov_b32 v6, v2
    v_accvgpr_write_b32 a0, 0
    v_accvgpr_write_b32 a1, 0
    v_accvgpr_write_b32 a2, 0
    v_accvgpr_write_b32 a3, 0
    v_accvgpr_write_b32 a4, 0
    v_accvgpr_write_b32 a5, 0
    v_accvgpr_write_b32 a6, 0
    v_accvgpr_write_b32 a7, 0
    v_accvgpr_write_b32 a8, 0
    v_accvgpr_write_b32 a9, 0
    v_accvgpr_write_b32 a10, 0
    v_accvgpr_write_b32 a11, 0
    v_accvgpr_write_b32 a12, 0
    v_accvgpr_write_b32 a13, 0
    v_accvgpr_write_b32 a14, 0
    v_accvgpr_write_b32 a15, 0
    v_accvgpr_write_b32 a16, 0
    v_accvgpr_write_b32 a17, 0
    v_accvgpr_write_b32 a18, 0
    v_accvgpr_write_b32 a19, 0
    v_accvgpr_write_b32 a20, 0
    v_accvgpr_write_b32 a21, 0
    v_accvgpr_write_b32 a22, 0
    v_accvgpr_write_b32 a23, 0
    v_accvgpr_write_b32 a24, 0
    v_accvgpr_write_b32 a25, 0
    v_accvgpr_write_b32 a26, 0
    v_accvgpr_write_b32 a27, 0
    v_accvgpr_write_b32 a28, 0
    v_accvgpr_write_b32 a29, 0
    v_accvgpr_write_b32 a30, 0
    v_accvgpr_write_b32 a31, 0
    v_accvgpr_write_b32 a32, 0
    v_accvgpr_write_b32 a33, 0
    v_accvgpr_write_b32 a34, 0
    v_accvgpr_write_b32 a35, 0
    v_accvgpr_write_b32 a36, 0
    v_accvgpr_write_b32 a37, 0
    v_accvgpr_write_b32 a38, 0
    v_accvgpr_write_b32 a39, 0
    v_accvgpr_write_b32 a40, 0
    v_accvgpr_write_b32 a41, 0
    v_accvgpr_write_b32 a42, 0
    v_accvgpr_write_b32 a43, 0
    v_accvgpr_write_b32 a44, 0
    v_accvgpr_write_b32 a45, 0
    v_accvgpr_write_b32 a46, 0
    v_accvgpr_write_b32 a47, 0
    v_accvgpr_write_b32 a48, 0
    v_accvgpr_write_b32 a49, 0
    v_accvgpr_write_b32 a50, 0
    v_accvgpr_write_b32 a51, 0
    v_accvgpr_write_b32 a52, 0
    v_accvgpr_write_b32 a53, 0
    v_accvgpr_write_b32 a54, 0
    v_accvgpr_write_b32 a55, 0
    v_accvgpr_write_b32 a56, 0
    v_accvgpr_write_b32 a57, 0
    v_accvgpr_write_b32 a58, 0
    v_accvgpr_write_b32 a59, 0
    v_accvgpr_write_b32 a60, 0
    v_accvgpr_write_b32 a61, 0
    v_accvgpr_write_b32 a62, 0
    v_accvgpr_write_b32 a63, 0
    v_accvgpr_write_b32 a64, 0
    v_accvgpr_write_b32 a65, 0
    v_accvgpr_write_b32 a66, 0
    v_accvgpr_write_b32 a67, 0
    v_accvgpr_write_b32 a68, 0
    v_accvgpr_write_b32 a69, 0
    v_accvgpr_write_b32 a70, 0
    v_accvgpr_write_b32 a71, 0
    v_accvgpr_write_b32 a72, 0
    v_accvgpr_write_b32 a73, 0
    v_accvgpr_write_b32 a74, 0
    v_accvgpr_write_b32 a75, 0
    v_accvgpr_write_b32 a76, 0
    v_accvgpr_write_b32 a77, 0
    v_accvgpr_write_b32 a78, 0
    v_accvgpr_write_b32 a79, 0
    v_mov_b64 v[160:161], 0
    v_mov_b64 v[162:163], 0
    v_mov_b64 v[164:165], 0
    v_mov_b64 v[166:167], 0
    v_mov_b64 v[168:169], 0
    v_mov_b64 v[170:171], 0
    v_mov_b64 v[172:173], 0
    v_mov_b64 v[174:175], 0
    v_mov_b64 v[176:177], 0
    v_mov_b64 v[178:179], 0
    v_mov_b64 v[180:181], 0
    v_mov_b64 v[182:183], 0
    v_mov_b64 v[184:185], 0
    v_mov_b64 v[186:187], 0
    v_mov_b64 v[188:189], 0
    v_mov_b64 v[190:191], 0
    v_mov_b32 v12, 0
    v_mov_b32 v28, 0
    v_mov_b32 v44, 0x3f803f80
    v_mov_b32 v13, 0
    v_mov_b32 v32, 0
    v_mov_b32 v45, 0x3f803f80
    v_mov_b32 v14, 0
    v_mov_b32 v36, 0
    v_mov_b32 v46, 0x3f803f80
    v_mov_b32 v15, 0
    v_mov_b32 v40, 0
    v_mov_b32 v47, 0x3f803f80
    s_and_b32 s90, s2, 7
    s_lshl_b32 s90, s90, 4
    s_lshl_b32 s91, s16, 2
    s_add_u32 s80, s90, s91
    s_lshr_b32 s92, s2, 3
    s_lshl_b32 s92, s92, 17
    s_lshl_b32 s90, s80, 10
    s_add_u32 s90, s90, s92
    s_add_u32 s83, s90, 50331648
    s_add_u32 s84, s90, 54525952
    s_and_b32 s81, s80, 63
    s_cmp_eq_u32 s81, 0
    s_cselect_b32 s93, 0, 1024
    s_sub_u32 s85, s84, s93
    s_lshl_b32 s90, s80, 9
    s_add_u32 s90, s90, s92
    s_add_u32 s86, s90, 58720256
    s_sub_u32 s87, s86, s93
    s_add_u32 s88, s86, 65536
    s_add_u32 s89, s87, 65536
    v_and_b32 v48, 15, v1
    v_lshrrev_b32 v49, 4, v1
    v_lshlrev_b32 v49, 2, v49
    v_sub_u32 v48, v48, v49
    v_cmp_le_i32 vcc, 0, v48
    s_nop 1
    v_cndmask_b32 v16, v9, 0, vcc
    v_cmp_le_i32 vcc, 1, v48
    s_nop 1
    v_cndmask_b32 v17, v9, 0, vcc
    v_cmp_le_i32 vcc, 2, v48
    s_nop 1
    v_cndmask_b32 v18, v9, 0, vcc
    v_cmp_le_i32 vcc, 3, v48
    s_nop 1
    v_cndmask_b32 v19, v9, 0, vcc
    s_mov_b32 s62, 8945792
    s_mov_b32 s63, 0
    s_sub_u32 s90, s67, 1
    s_bitset1_b64 s[62:63], s90
    s_sub_u32 s90, s68, 1
    s_bitset1_b64 s[62:63], s90
    s_sub_u32 s90, s69, 1
    s_bitset1_b64 s[62:63], s90
    s_sub_u32 s90, s70, 1
    s_bitset1_b64 s[62:63], s90
    s_sub_u32 s90, s71, 1
    s_bitset1_b64 s[62:63], s90
    s_sub_u32 s90, s72, 1
    s_bitset1_b64 s[62:63], s90
    s_add_u32 s53, s69, 8
    s_sub_u32 s90, s53, 1
    s_bitset1_b64 s[62:63], s90
    s_mov_b32 s64, 0
    s_cmp_lg_u32 s64, s67
    s_cbranch_scc1 m_e73
    v_add_f32 v176, v176, v16
    v_mov_b32 v180, v9
    v_add_f32 v188, v188, v16
    v_add_f32 v177, v177, v17
    v_mov_b32 v181, v9
    v_add_f32 v189, v189, v17
    v_add_f32 v178, v178, v18
    v_mov_b32 v182, v9
    v_add_f32 v190, v190, v18
    v_add_f32 v179, v179, v19
    v_mov_b32 v183, v9
    v_add_f32 v191, v191, v19
    s_nop 0
m_e73:
    s_waitcnt vmcnt(32) lgkmcnt(0)
    s_barrier
    ds_read_b128 a[192:195], v6 offset:0
    ds_read_b128 a[196:199], v6 offset:1024
    ds_read_b128 a[200:203], v6 offset:2048
    ds_read_b128 a[204:207], v6 offset:3072
    ds_read_b128 a[208:211], v6 offset:4096
    ds_read_b128 a[212:215], v6 offset:5120
    ds_read_b128 a[216:219], v6 offset:6144
    ds_read_b128 a[220:223], v6 offset:7168
    s_waitcnt lgkmcnt(0)
    v_mfma_f32_16x16x32_bf16 v[64:67], a[192:195], a[128:131], v[160:163]
    v_accvgpr_write_b32 a80, 0
    v_accvgpr_write_b32 a81, 0
    v_mfma_f32_16x16x32_bf16 v[64:67], a[196:199], a[132:135], v[64:67]
    buffer_store_dwordx4 v[192:195], v2, s[36:39], s40 offen sc1
    s_add_u32 s40, s40, s100
    v_mfma_f32_16x16x32_bf16 v[64:67], a[200:203], a[136:139], v[64:67]
    v_accvgpr_write_b32 a82, 0
    v_accvgpr_write_b32 a83, 0
    v_mfma_f32_16x16x32_bf16 v[64:67], a[204:207], a[140:143], v[64:67]
    v_accvgpr_write_b32 a84, 0
    v_accvgpr_write_b32 a85, 0
    v_mfma_f32_16x16x32_bf16 v[72:75], a[204:207], a[156:159], v[168:171]
    v_accvgpr_write_b32 a86, 0
    v_accvgpr_write_b32 a87, 0
    v_mfma_f32_16x16x32_bf16 v[72:75], a[200:203], a[152:155], v[72:75]
    buffer_store_dwordx4 v[196:199], v2, s[36:39], s40 offen sc1
    s_add_u32 s40, s40, s100
    v_mfma_f32_16x16x32_bf16 v[72:75], a[196:199], a[148:151], v[72:75]
    v_accvgpr_write_b32 a88, 0
    v_accvgpr_write_b32 a89, 0
    v_mfma_f32_16x16x32_bf16 v[72:75], a[192:195], a[144:147], v[72:75]
    v_accvgpr_write_b32 a90, 0
    v_accvgpr_write_b32 a91, 0
    v_mfma_f32_16x16x32_bf16 v[80:83], a[192:195], a[160:163], v[176:179]
    v_accvgpr_write_b32 a92, 0
    v_accvgpr_write_b32 a93, 0
    v_mfma_f32_16x16x32_bf16 v[80:83], a[196:199], a[164:167], v[80:83]
    buffer_store_dwordx4 v[200:203], v2, s[36:39], s40 offen sc1
    s_add_u32 s40, s40, s100
    v_mfma_f32_16x16x32_bf16 v[80:83], a[200:203], a[168:171], v[80:83]
    v_accvgpr_write_b32 a94, 0
    v_accvgpr_write_b32 a95, 0
    v_mfma_f32_16x16x32_bf16 v[80:83], a[204:207], a[172:175], v[80:83]
    v_accvgpr_write_b32 a96, 0
    v_accvgpr_write_b32 a97, 0
    v_mfma_f32_16x16x32_bf16 v[88:91], a[204:207], a[188:191], v[184:187]
    v_accvgpr_write_b32 a98, 0
    v_accvgpr_write_b32 a99, 0
    v_mfma_f32_16x16x32_bf16 v[88:91], a[200:203], a[184:187], v[88:91]
    buffer_store_dwordx4 v[204:207], v2, s[36:39], s40 offen sc1
    s_add_u32 s40, s98, s99
    v_mfma_f32_16x16x32_bf16 v[88:91], a[196:199], a[180:183], v[88:91]
    v_accvgpr_write_b32 a100, 0
    v_accvgpr_write_b32 a101, 0
    v_mfma_f32_16x16x32_bf16 v[88:91], a[192:195], a[176:179], v[88:91]
    v_accvgpr_write_b32 a102, 0
    v_accvgpr_write_b32 a103, 0
    v_mfma_f32_16x16x32_bf16 v[92:95], a[208:211], a[176:179], v[188:191]
    ds_read_b128 a[192:195], v6 offset:8192
    v_accvgpr_write_b32 a104, 0
    v_accvgpr_write_b32 a105, 0
    v_mfma_f32_16x16x32_bf16 v[92:95], a[212:215], a[180:183], v[92:95]
    buffer_store_dwordx4 v[208:211], v2, s[36:39], s40 offen sc1
    s_add_u32 s40, s40, s100
    ds_read_b128 a[196:199], v6 offset:9216
    v_mfma_f32_16x16x32_bf16 v[92:95], a[216:219], a[184:187], v[92:95]
    ds_read_b128 a[200:203], v6 offset:10240
    v_accvgpr_write_b32 a106, 0
    v_accvgpr_write_b32 a107, 0
    v_mfma_f32_16x16x32_bf16 v[92:95], a[220:223], a[188:191], v[92:95]
    ds_read_b128 a[204:207], v6 offset:11264
    v_accvgpr_write_b32 a108, 0
    v_accvgpr_write_b32 a109, 0
    v_mfma_f32_16x16x32_bf16 v[84:87], a[220:223], a[172:175], v[180:183]
    v_accvgpr_write_b32 a110, 0
    v_accvgpr_write_b32 a111, 0
    v_mfma_f32_16x16x32_bf16 v[84:87], a[216:219], a[168:171], v[84:87]
    buffer_store_dwordx4 v[212:215], v2, s[36:39], s40 offen sc1
    s_add_u32 s40, s40, s100
    v_mfma_f32_16x16x32_bf16 v[84:87], a[212:215], a[164:167], v[84:87]
    v_accvgpr_write_b32 a112, 0
    v_accvgpr_write_b32 a113, 0
    v_mfma_f32_16x16x32_bf16 v[84:87], a[208:211], a[160:163], v[84:87]
    v_accvgpr_write_b32 a114, 0
    v_accvgpr_write_b32 a115, 0
    v_mfma_f32_16x16x32_bf16 v[76:79], a[208:211], a[144:147], v[172:175]
    v_accvgpr_write_b32 a116, 0
    v_accvgpr_write_b32 a117, 0
    v_mfma_f32_16x16x32_bf16 v[76:79], a[212:215], a[148:151], v[76:79]
    buffer_store_dwordx4 v[216:219], v2, s[36:39], s40 offen sc1
    s_add_u32 s40, s40, s100
    v_mfma_f32_16x16x32_bf16 v[76:79], a[216:219], a[152:155], v[76:79]
    v_accvgpr_write_b32 a118, 0
    v_accvgpr_write_b32 a119, 0
    v_mfma_f32_16x16x32_bf16 v[76:79], a[220:223], a[156:159], v[76:79]
    v_accvgpr_write_b32 a120, 0
    v_accvgpr_write_b32 a121, 0
    v_mfma_f32_16x16x32_bf16 v[68:71], a[220:223], a[140:143], v[164:167]
    v_accvgpr_write_b32 a122, 0
    v_accvgpr_write_b32 a123, 0
    v_mfma_f32_16x16x32_bf16 v[68:71], a[216:219], a[136:139], v[68:71]
    buffer_store_dwordx4 v[220:223], v2, s[36:39], s40 offen sc1
    s_add_u32 s40, s40, s100
    v_mfma_f32_16x16x32_bf16 v[68:71], a[212:215], a[132:135], v[68:71]
    v_accvgpr_write_b32 a124, 0
    v_accvgpr_write_b32 a125, 0
    v_mfma_f32_16x16x32_bf16 v[68:71], a[208:211], a[128:131], v[68:71]
    v_accvgpr_write_b32 a126, 0
    v_accvgpr_write_b32 a127, 0
    ds_read_b128 a[208:211], v6 offset:12288
    ds_read_b128 a[212:215], v6 offset:13312
    ds_read_b128 a[216:219], v6 offset:14336
    ds_read_b128 a[220:223], v6 offset:15360
    s_mov_b32 s64, 1
    s_nop 0
    s_nop 3
    v_max3_f32 v48, v64, v65, v66
    v_max3_f32 v49, v72, v73, v74
    v_max3_f32 v50, v80, v81, v82
    v_max3_f32 v51, v88, v89, v90
    v_max3_f32 v48, v48, v67, v68
    v_max3_f32 v49, v49, v75, v76
    v_max3_f32 v50, v50, v83, v84
    v_max3_f32 v51, v51, v91, v92
    v_max3_f32 v48, v48, v69, v70
    v_max3_f32 v49, v49, v77, v78
    v_max3_f32 v50, v50, v85, v86
    v_max3_f32 v51, v51, v93, v94
    v_max_f32 v48, v48, v71
    v_max_f32 v49, v49, v79
    v_max_f32 v50, v50, v87
    v_max_f32 v51, v51, v95
    v_mov_b32 v52, v48
    v_mov_b32 v53, v49
    v_mov_b32 v54, v50
    v_mov_b32 v55, v51
    s_nop 1
    v_permlane32_swap_b32 v48, v52
    v_permlane32_swap_b32 v49, v53
    v_permlane32_swap_b32 v50, v54
    v_permlane32_swap_b32 v51, v55
    s_nop 1
    v_max_f32 v48, v48, v52
    v_max_f32 v49, v49, v53
    v_max_f32 v50, v50, v54
    v_max_f32 v51, v51, v55
    v_mov_b32 v52, v48
    v_mov_b32 v53, v49
    v_mov_b32 v54, v50
    v_mov_b32 v55, v51
    s_nop 1
    v_permlane16_swap_b32 v48, v52
    v_permlane16_swap_b32 v49, v53
    v_permlane16_swap_b32 v50, v54
    v_permlane16_swap_b32 v51, v55
    s_nop 1
    v_max_f32 v48, v48, v52
    v_max_f32 v49, v49, v53
    v_max_f32 v50, v50, v54
    v_max_f32 v51, v51, v55
    v_sub_f32 v160, v160, v48
    v_sub_f32 v161, v161, v48
    v_sub_f32 v162, v162, v48
    v_sub_f32 v163, v163, v48
    v_sub_f32 v164, v164, v48
    v_sub_f32 v165, v165, v48
    v_sub_f32 v166, v166, v48
    v_sub_f32 v167, v167, v48
    v_sub_f32 v168, v168, v49
    v_sub_f32 v169, v169, v49
    v_sub_f32 v170, v170, v49
    v_sub_f32 v171, v171, v49
    v_sub_f32 v172, v172, v49
    v_sub_f32 v173, v173, v49
    v_sub_f32 v174, v174, v49
    v_sub_f32 v175, v175, v49
    v_sub_f32 v176, v176, v50
    v_sub_f32 v177, v177, v50
    v_sub_f32 v178, v178, v50
    v_sub_f32 v179, v179, v50
    v_sub_f32 v180, v180, v50
    v_sub_f32 v181, v181, v50
    v_sub_f32 v182, v182, v50
    v_sub_f32 v183, v183, v50
    v_sub_f32 v184, v184, v51
    v_sub_f32 v185, v185, v51
    v_sub_f32 v186, v186, v51
    v_sub_f32 v187, v187, v51
    v_sub_f32 v188, v188, v51
    v_sub_f32 v189, v189, v51
    v_sub_f32 v190, v190, v51
    v_sub_f32 v191, v191, v51
    v_sub_f32 v64, v64, v48
    v_sub_f32 v65, v65, v48
    v_sub_f32 v66, v66, v48
    v_sub_f32 v67, v67, v48
    v_sub_f32 v68, v68, v48
    v_sub_f32 v69, v69, v48
    v_sub_f32 v70, v70, v48
    v_sub_f32 v71, v71, v48
    v_sub_f32 v72, v72, v49
    v_sub_f32 v73, v73, v49
    v_sub_f32 v74, v74, v49
    v_sub_f32 v75, v75, v49
    v_sub_f32 v76, v76, v49
    v_sub_f32 v77, v77, v49
    v_sub_f32 v78, v78, v49
    v_sub_f32 v79, v79, v49
    v_sub_f32 v80, v80, v50
    v_sub_f32 v81, v81, v50
    v_sub_f32 v82, v82, v50
    v_sub_f32 v83, v83, v50
    v_sub_f32 v84, v84, v50
    v_sub_f32 v85, v85, v50
    v_sub_f32 v86, v86, v50
    v_sub_f32 v87, v87, v50
    v_sub_f32 v88, v88, v51
    v_sub_f32 v89, v89, v51
    v_sub_f32 v90, v90, v51
    v_sub_f32 v91, v91, v51
    v_sub_f32 v92, v92, v51
    v_sub_f32 v93, v93, v51
    v_sub_f32 v94, v94, v51
    v_sub_f32 v95, v95, v51
    s_cmp_lg_u32 s64, s67
    s_cbranch_scc1 m_e74
    v_add_f32 v176, v176, v16
    v_mov_b32 v180, v9
    v_add_f32 v188, v188, v16
    v_add_f32 v177, v177, v17
    v_mov_b32 v181, v9
    v_add_f32 v189, v189, v17
    v_add_f32 v178, v178, v18
    v_mov_b32 v182, v9
    v_add_f32 v190, v190, v18
    v_add_f32 v179, v179, v19
    v_mov_b32 v183, v9
    v_add_f32 v191, v191, v19
    s_nop 0
m_e74:
    s_cmp_lg_u32 s64, s68
    s_cbranch_scc1 m_e75
    v_mov_b32 v176, v9
    v_mov_b32 v184, v9
    v_mov_b32 v188, v9
    v_mov_b32 v177, v9
    v_mov_b32 v185, v9
    v_mov_b32 v189, v9
    v_mov_b32 v178, v9
    v_mov_b32 v186, v9
    v_mov_b32 v190, v9
    v_mov_b32 v179, v9
    v_mov_b32 v187, v9
    v_mov_b32 v191, v9
    s_nop 0
m_e75:
    s_waitcnt lgkmcnt(0)
    v_mfma_f32_16x16x32_bf16 v[96:99], a[192:195], a[128:131], v[160:163]
    s_bitcmp1_b64 s[62:63], s64
    s_cselect_b32 s66, -1.0, s65
    v_exp_f32 v20, v64
    v_mfma_f32_16x16x32_bf16 v[96:99], a[196:199], a[132:135], v[96:99]
    s_add_u32 s64, s64, 1
    v_exp_f32 v21, v65
    v_exp_f32 v22, v66
    v_mfma_f32_16x16x32_bf16 v[96:99], a[200:203], a[136:139], v[96:99]
    buffer_store_dwordx4 v[224:227], v2, s[36:39], s40 offen sc1
    v_cvt_pk_bf16_f32 v128, v20, v21
    v_mfma_f32_16x16x32_bf16 v[96:99], a[204:207], a[140:143], v[96:99]
    s_add_u32 s40, s40, s100
    v_add_f32 v12, v12, v28
    v_exp_f32 v23, v67
    v_mfma_f32_16x16x32_bf16 v[104:107], a[204:207], a[156:159], v[168:171]
    v_exp_f32 v24, v68
    v_cvt_pk_bf16_f32 v129, v22, v23
    v_mfma_f32_16x16x32_bf16 v[104:107], a[200:203], a[152:155], v[104:107]
    buffer_store_dwordx4 v[228:231], v2, s[36:39], s40 offen sc1
    v_exp_f32 v25, v69
    v_mfma_f32_16x16x32_bf16 v[104:107], a[196:199], a[148:151], v[104:107]
    s_add_u32 s40, s40, s100
    v_exp_f32 v26, v70
    v_cvt_pk_bf16_f32 v130, v24, v25
    v_mfma_f32_16x16x32_bf16 v[104:107], a[192:195], a[144:147], v[104:107]
    v_exp_f32 v27, v71
    v_add_f32 v13, v13, v32
    v_mfma_f32_16x16x32_bf16 v[112:115], a[192:195], a[160:163], v[176:179]
    v_exp_f32 v20, v72
    v_cvt_pk_bf16_f32 v131, v26, v27
    v_mfma_f32_16x16x32_bf16 v[112:115], a[196:199], a[164:167], v[112:115]
    buffer_store_dwordx4 v[232:235], v2, s[36:39], s40 offen sc1
    v_exp_f32 v21, v73
    v_mfma_f32_16x16x32_bf16 v[28:31], v[44:47], v[128:131], 0
    v_exp_f32 v22, v74
    v_cvt_pk_bf16_f32 v132, v20, v21
    v_mfma_f32_16x16x32_bf16 v[112:115], a[200:203], a[168:171], v[112:115]
    s_add_u32 s40, s40, s100
    v_exp_f32 v23, v75
    v_add_f32 v14, v14, v36
    v_mfma_f32_16x16x32_bf16 v[112:115], a[204:207], a[172:175], v[112:115]
    v_exp_f32 v24, v76
    v_cvt_pk_bf16_f32 v133, v22, v23
    v_mfma_f32_16x16x32_bf16 v[120:123], a[204:207], a[188:191], v[184:187]
    buffer_store_dwordx4 v[236:239], v2, s[36:39], s40 offen sc1
    v_exp_f32 v25, v77
    v_mfma_f32_16x16x32_bf16 v[120:123], a[200:203], a[184:187], v[120:123]
    s_mov_b32 s40, s98
    v_exp_f32 v26, v78
    v_cvt_pk_bf16_f32 v134, v24, v25
    v_mfma_f32_16x16x32_bf16 v[120:123], a[196:199], a[180:183], v[120:123]
    v_exp_f32 v27, v79
    v_add_f32 v15, v15, v40
    v_mfma_f32_16x16x32_bf16 v[120:123], a[192:195], a[176:179], v[120:123]
    s_waitcnt lgkmcnt(0)
    v_exp_f32 v20, v80
    v_cvt_pk_bf16_f32 v135, v26, v27
    v_mfma_f32_16x16x32_bf16 v[124:127], a[208:211], a[176:179], v[188:191]
    v_exp_f32 v21, v81
    v_exp_f32 v22, v82
    v_mfma_f32_16x16x32_bf16 v[32:35], v[44:47], v[132:135], 0
    v_cvt_pk_bf16_f32 v136, v20, v21
    v_exp_f32 v23, v83
    v_mfma_f32_16x16x32_bf16 v[124:127], a[212:215], a[180:183], v[124:127]
    buffer_store_dwordx4 v[240:243], v2, s[36:39], s40 offen sc1
    v_cvt_pk_bf16_f32 v137, v22, v23
    v_mfma_f32_16x16x32_bf16 v[124:127], a[216:219], a[184:187], v[124:127]
    s_add_u32 s40, s40, s100
    v_exp_f32 v24, v84
    v_mfma_f32_16x16x32_bf16 v[124:127], a[220:223], a[188:191], v[124:127]
    v_exp_f32 v25, v85
    v_exp_f32 v26, v86
    v_cvt_pk_bf16_f32 v138, v24, v25
    v_mfma_f32_16x16x32_bf16 v[116:119], a[220:223], a[172:175], v[180:183]
    buffer_store_dwordx4 v[244:247], v2, s[36:39], s40 offen sc1
    v_mfma_f32_16x16x32_bf16 v[116:119], a[216:219], a[168:171], v[116:119]
    s_add_u32 s40, s40, s100
    v_exp_f32 v27, v87
    v_exp_f32 v20, v88
    v_mfma_f32_16x16x32_bf16 v[116:119], a[212:215], a[164:167], v[116:119]
    v_cvt_pk_bf16_f32 v139, v26, v27
    v_exp_f32 v21, v89
    v_mfma_f32_16x16x32_bf16 v[116:119], a[208:211], a[160:163], v[116:119]
    buffer_store_dwordx4 v[248:251], v2, s[36:39], s40 offen sc1
    v_exp_f32 v22, v90
    v_mfma_f32_16x16x32_bf16 v[36:39], v[44:47], v[136:139], 0
    v_cvt_pk_bf16_f32 v140, v20, v21
    v_exp_f32 v23, v91
    v_mfma_f32_16x16x32_bf16 v[108:111], a[208:211], a[144:147], v[172:175]
    s_add_u32 s40, s40, s100
    v_exp_f32 v24, v92
    v_cvt_pk_bf16_f32 v141, v22, v23
    v_mfma_f32_16x16x32_bf16 v[108:111], a[212:215], a[148:151], v[108:111]
    v_exp_f32 v25, v93
    v_mfma_f32_16x16x32_bf16 v[108:111], a[216:219], a[152:155], v[108:111]
    buffer_store_dwordx4 v[252:255], v2, s[36:39], s40 offen sc1
    v_exp_f32 v26, v94
    v_cvt_pk_bf16_f32 v142, v24, v25
    v_mfma_f32_16x16x32_bf16 v[108:111], a[220:223], a[156:159], v[108:111]
    s_add_u32 s40, s40, s100
    v_exp_f32 v27, v95
    s_nop 0
    v_cvt_pk_bf16_f32 v143, v26, v27
    s_nop 1
    v_mfma_f32_16x16x32_bf16 v[40:43], v[44:47], v[140:143], 0
    s_nop 2
    v_mfma_f32_16x16x32_bf16 v[100:103], a[220:223], a[140:143], v[164:167]
    s_nop 2
    v_mfma_f32_16x16x32_bf16 v[100:103], a[216:219], a[136:139], v[100:103]
    v_max3_f32 v8, v28, v32, v36
    v_max_f32 v8, v8, v40
    v_mfma_f32_16x16x32_bf16 v[100:103], a[212:215], a[132:135], v[100:103]
    v_cmp_nge_f32 vcc, s66, v8
    v_mfma_f32_16x16x32_bf16 v[100:103], a[208:211], a[128:131], v[100:103]
    s_waitcnt vmcnt(48) lgkmcnt(0)
    s_barrier
    s_add_u32 s59, s58, s60
    s_add_u32 s58, s58, 32768
    s_cmp_ge_u32 s58, 163840
    s_cselect_b32 s58, 0, s58
    v_add_u32 v6, s58, v2
    ds_read_b128 a[192:195], v6 offset:0
    ds_read_b128 a[196:199], v6 offset:1024
    ds_read_b128 a[200:203], v6 offset:2048
    ds_read_b128 a[204:207], v6 offset:3072
    ds_read_b128 a[208:211], v6 offset:4096
    ds_read_b128 a[212:215], v6 offset:5120
    ds_read_b128 a[216:219], v6 offset:6144
    ds_read_b128 a[220:223], v6 offset:7168
    s_waitcnt lgkmcnt(0)
    s_cbranch_vccnz m_stub76
m_ret77:
m_dual78:
    v_mfma_f32_16x16x32_bf16 v[64:67], a[192:195], a[128:131], v[160:163]
    s_bitcmp1_b64 s[62:63], s64
    s_cselect_b32 s66, -1.0, s65
    v_add_f32 v12, v12, v28
    v_mfma_f32_16x16x32_bf16 v[64:67], a[196:199], a[132:135], v[64:67]
    s_add_u32 s64, s64, 1
    ds_read_b128 a[224:227], v6 offset:16384
    v_add_f32 v13, v13, v32
    v_mfma_f32_16x16x32_bf16 v[64:67], a[200:203], a[136:139], v[64:67]
    v_exp_f32 v20, v96
    v_mfma_f32_16x16x32_bf16 v[64:67], a[204:207], a[140:143], v[64:67]
    v_exp_f32 v21, v97
    v_mfma_f32_16x16x32_bf16 v[72:75], a[204:207], a[156:159], v[168:171]
    s_mov_b32 m0, s59
    ds_read_b128 a[228:231], v6 offset:17408
    v_cvt_pk_bf16_f32 v144, v20, v21
    v_mfma_f32_16x16x32_bf16 v[72:75], a[200:203], a[152:155], v[72:75]
    buffer_load_dwordx4 v7, s[24:27], s56 offen offset:0 sc1 lds
    v_mfma_f32_16x16x32_bf16 v[72:75], a[196:199], a[148:151], v[72:75]
    v_exp_f32 v22, v98
    v_mfma_f32_16x16x32_bf16 v[72:75], a[192:195], a[144:147], v[72:75]
    ds_read_b128 a[232:235], v6 offset:18432
    v_add_f32 v14, v14, v36
    v_mfma_f32_16x16x32_bf16 v[80:83], a[192:195], a[160:163], v[176:179]
    v_exp_f32 v23, v99
    v_mfma_f32_16x16x32_bf16 v[80:83], a[196:199], a[164:167], v[80:83]
    v_exp_f32 v24, v100
    v_mfma_f32_16x16x32_bf16 v[80:83], a[200:203], a[168:171], v[80:83]
    ds_read_b128 a[236:239], v6 offset:19456
    v_cvt_pk_bf16_f32 v145, v22, v23
    v_mfma_f32_16x16x32_bf16 v[80:83], a[204:207], a[172:175], v[80:83]
    v_exp_f32 v25, v101
    v_mfma_f32_16x16x32_bf16 v[88:91], a[204:207], a[188:191], v[184:187]
    v_exp_f32 v26, v102
    v_mfma_f32_16x16x32_bf16 v[88:91], a[200:203], a[184:187], v[88:91]
    ds_read_b128 a[240:243], v6 offset:20480
    v_cvt_pk_bf16_f32 v146, v24, v25
    v_mfma_f32_16x16x32_bf16 v[88:91], a[196:199], a[180:183], v[88:91]
    v_exp_f32 v27, v103
    v_mfma_f32_16x16x32_bf16 v[88:91], a[192:195], a[176:179], v[88:91]
    s_waitcnt lgkmcnt(5)
    v_exp_f32 v20, v104
    v_mfma_f32_16x16x32_bf16 v[92:95], a[208:211], a[176:179], v[188:191]
    ds_read_b128 a[244:247], v6 offset:21504
    v_cvt_pk_bf16_f32 v147, v26, v27
    v_mfma_f32_16x16x32_bf16 v[92:95], a[212:215], a[180:183], v[92:95]
    v_exp_f32 v21, v105
    v_mfma_f32_16x16x32_bf16 v[28:31], v[44:47], v[144:147], 0
    v_exp_f32 v22, v106
    v_mfma_f32_16x16x32_bf16 v[92:95], a[216:219], a[184:187], v[92:95]
    buffer_load_dwordx4 v7, s[24:27], s56 offen offset:1024 sc1 lds
    v_mfma_f32_16x16x32_bf16 v[92:95], a[220:223], a[188:191], v[92:95]
    ds_read_b128 a[248:251], v6 offset:22528
    v_cvt_pk_bf16_f32 v148, v20, v21
    v_mfma_f32_16x16x32_bf16 v[84:87], a[220:223], a[172:175], v[180:183]
    v_exp_f32 v23, v107
    v_mfma_f32_16x16x32_bf16 v[84:87], a[216:219], a[168:171], v[84:87]
    v_exp_f32 v24, v108
    v_mfma_f32_16x16x32_bf16 v[84:87], a[212:215], a[164:167], v[84:87]
    ds_read_b128 a[252:255], v6 offset:23552
    v_cvt_pk_bf16_f32 v149, v22, v23
    v_mfma_f32_16x16x32_bf16 v[84:87], a[208:211], a[160:163], v[84:87]
    v_exp_f32 v25, v109
    v_mfma_f32_16x16x32_bf16 v[76:79], a[208:211], a[144:147], v[172:175]
    v_exp_f32 v26, v110
    v_mfma_f32_16x16x32_bf16 v[76:79], a[212:215], a[148:151], v[76:79]
    v_cvt_pk_bf16_f32 v150, v24, v25
    v_add_f32 v15, v15, v40
    v_mfma_f32_16x16x32_bf16 v[76:79], a[216:219], a[152:155], v[76:79]
    v_exp_f32 v27, v111
    v_mfma_f32_16x16x32_bf16 v[76:79], a[220:223], a[156:159], v[76:79]
    buffer_load_dwordx4 v7, s[24:27], s56 offen offset:2048 sc1 lds
    v_mfma_f32_16x16x32_bf16 v[68:71], a[220:223], a[140:143], v[164:167]
    v_exp_f32 v20, v112
    v_mfma_f32_16x16x32_bf16 v[68:71], a[216:219], a[136:139], v[68:71]
    v_cvt_pk_bf16_f32 v151, v26, v27
    v_mfma_f32_16x16x32_bf16 v[68:71], a[212:215], a[132:135], v[68:71]
    v_exp_f32 v21, v113
    v_mfma_f32_16x16x32_bf16 v[32:35], v[44:47], v[148:151], 0
    v_exp_f32 v22, v114
    v_mfma_f32_16x16x32_bf16 v[68:71], a[208:211], a[128:131], v[68:71]
    s_waitcnt lgkmcnt(0)
    v_cvt_pk_bf16_f32 v152, v20, v21
    v_mfma_f32_16x16x32_bf16 a[0:3], a[224:227], v[128:131], a[0:3]
    ds_read_b128 a[192:195], v6 offset:8192
    v_mfma_f32_16x16x32_bf16 a[32:35], a[224:227], v[132:135], a[32:35]
    v_exp_f32 v23, v115
    v_mfma_f32_16x16x32_bf16 a[64:67], a[224:227], v[136:139], a[64:67]
    v_exp_f32 v24, v116
    v_mfma_f32_16x16x32_bf16 a[96:99], a[224:227], v[140:143], a[96:99]
    ds_read_b128 a[196:199], v6 offset:9216
    v_cvt_pk_bf16_f32 v153, v22, v23
    v_mfma_f32_16x16x32_bf16 a[100:103], a[228:231], v[140:143], a[100:103]
    v_exp_f32 v25, v117
    v_mfma_f32_16x16x32_bf16 a[68:71], a[228:231], v[136:139], a[68:71]
    v_exp_f32 v26, v118
    v_mfma_f32_16x16x32_bf16 a[36:39], a[228:231], v[132:135], a[36:39]
    ds_read_b128 a[200:203], v6 offset:10240
    v_cvt_pk_bf16_f32 v154, v24, v25
    v_mfma_f32_16x16x32_bf16 a[4:7], a[228:231], v[128:131], a[4:7]
    v_exp_f32 v27, v119
    v_mfma_f32_16x16x32_bf16 a[8:11], a[232:235], v[128:131], a[8:11]
    v_exp_f32 v20, v120
    v_mfma_f32_16x16x32_bf16 a[40:43], a[232:235], v[132:135], a[40:43]
    ds_read_b128 a[204:207], v6 offset:11264
    v_cvt_pk_bf16_f32 v155, v26, v27
    v_mfma_f32_16x16x32_bf16 a[72:75], a[232:235], v[136:139], a[72:75]
    v_exp_f32 v21, v121
    v_mfma_f32_16x16x32_bf16 v[36:39], v[44:47], v[152:155], 0
    v_exp_f32 v22, v122
    v_mfma_f32_16x16x32_bf16 a[104:107], a[232:235], v[140:143], a[104:107]
    buffer_load_dwordx4 v7, s[24:27], s56 offen offset:3072 sc1 lds
    v_mfma_f32_16x16x32_bf16 a[108:111], a[236:239], v[140:143], a[108:111]
    s_add_u32 s56, s56, 16384
    v_cvt_pk_bf16_f32 v156, v20, v21
    v_mfma_f32_16x16x32_bf16 a[76:79], a[236:239], v[136:139], a[76:79]
    v_exp_f32 v23, v123
    v_mfma_f32_16x16x32_bf16 a[44:47], a[236:239], v[132:135], a[44:47]
    v_exp_f32 v24, v124
    v_mfma_f32_16x16x32_bf16 a[12:15], a[236:239], v[128:131], a[12:15]
    v_cvt_pk_bf16_f32 v157, v22, v23
    v_mfma_f32_16x16x32_bf16 a[16:19], a[240:243], v[128:131], a[16:19]
    v_exp_f32 v25, v125
    v_mfma_f32_16x16x32_bf16 a[48:51], a[240:243], v[132:135], a[48:51]
    v_exp_f32 v26, v126
    v_mfma_f32_16x16x32_bf16 a[80:83], a[240:243], v[136:139], a[80:83]
    v_cvt_pk_bf16_f32 v158, v24, v25
    v_mfma_f32_16x16x32_bf16 a[112:115], a[240:243], v[140:143], a[112:115]
    s_add_u32 m0, s59, 16384
    v_exp_f32 v27, v127
    v_mfma_f32_16x16x32_bf16 a[116:119], a[244:247], v[140:143], a[116:119]
    buffer_load_dwordx4 v7, s[28:31], s57 offen offset:0 sc1 lds
    v_mfma_f32_16x16x32_bf16 a[84:87], a[244:247], v[136:139], a[84:87]
    v_cvt_pk_bf16_f32 v159, v26, v27
    v_mfma_f32_16x16x32_bf16 a[52:55], a[244:247], v[132:135], a[52:55]
    v_mfma_f32_16x16x32_bf16 a[20:23], a[244:247], v[128:131], a[20:23]
    v_mfma_f32_16x16x32_bf16 v[40:43], v[44:47], v[156:159], 0
    s_nop 2
    v_mfma_f32_16x16x32_bf16 a[24:27], a[248:251], v[128:131], a[24:27]
    s_nop 2
    v_mfma_f32_16x16x32_bf16 a[56:59], a[248:251], v[132:135], a[56:59]
    v_max3_f32 v8, v28, v32, v36
    v_max_f32 v8, v8, v40
    v_mfma_f32_16x16x32_bf16 a[88:91], a[248:251], v[136:139], a[88:91]
    v_cmp_nge_f32 vcc, s66, v8
    v_mfma_f32_16x16x32_bf16 a[120:123], a[248:251], v[140:143], a[120:123]
    ds_read_b128 a[208:211], v6 offset:12288
    v_mfma_f32_16x16x32_bf16 a[124:127], a[252:255], v[140:143], a[124:127]
    ds_read_b128 a[212:215], v6 offset:13312
    v_mfma_f32_16x16x32_bf16 a[92:95], a[252:255], v[136:139], a[92:95]
    ds_read_b128 a[216:219], v6 offset:14336
    v_mfma_f32_16x16x32_bf16 a[60:63], a[252:255], v[132:135], a[60:63]
    ds_read_b128 a[220:223], v6 offset:15360
    v_mfma_f32_16x16x32_bf16 a[28:31], a[252:255], v[128:131], a[28:31]
    s_waitcnt lgkmcnt(4)
    s_cbranch_vccnz m_stub79
m_ret80:
    v_mfma_f32_16x16x32_bf16 v[96:99], a[192:195], a[128:131], v[160:163]
    s_add_u32 s59, s58, s60
    v_exp_f32 v20, v64
    v_mfma_f32_16x16x32_bf16 v[96:99], a[196:199], a[132:135], v[96:99]
    s_add_u32 s58, s58, 32768
    ds_read_b128 a[224:227], v6 offset:24576
    v_add_f32 v12, v12, v28
    v_mfma_f32_16x16x32_bf16 v[96:99], a[200:203], a[136:139], v[96:99]
    s_cmp_ge_u32 s58, 163840
    s_cselect_b32 s58, 0, s58
    v_exp_f32 v21, v65
    v_mfma_f32_16x16x32_bf16 v[96:99], a[204:207], a[140:143], v[96:99]
    s_bitcmp1_b64 s[62:63], s64
    s_cselect_b32 s66, -1.0, s65
    v_cvt_pk_bf16_f32 v128, v20, v21
    v_mfma_f32_16x16x32_bf16 v[104:107], a[204:207], a[156:159], v[168:171]
    s_add_u32 s64, s64, 1
    ds_read_b128 a[228:231], v6 offset:25600
    v_add_f32 v13, v13, v32
    v_mfma_f32_16x16x32_bf16 v[104:107], a[200:203], a[152:155], v[104:107]
    v_exp_f32 v22, v66
    v_mfma_f32_16x16x32_bf16 v[104:107], a[196:199], a[148:151], v[104:107]
    buffer_load_dwordx4 v7, s[28:31], s57 offen offset:1024 sc1 lds
    v_mfma_f32_16x16x32_bf16 v[104:107], a[192:195], a[144:147], v[104:107]
    ds_read_b128 a[232:235], v6 offset:26624
    v_add_f32 v14, v14, v36
    v_mfma_f32_16x16x32_bf16 v[112:115], a[192:195], a[160:163], v[176:179]
    v_exp_f32 v23, v67
    v_mfma_f32_16x16x32_bf16 v[112:115], a[196:199], a[164:167], v[112:115]
    v_exp_f32 v24, v68
    v_mfma_f32_16x16x32_bf16 v[112:115], a[200:203], a[168:171], v[112:115]
    ds_read_b128 a[236:239], v6 offset:27648
    v_cvt_pk_bf16_f32 v129, v22, v23
    v_mfma_f32_16x16x32_bf16 v[112:115], a[204:207], a[172:175], v[112:115]
    v_exp_f32 v25, v69
    v_mfma_f32_16x16x32_bf16 v[120:123], a[204:207], a[188:191], v[184:187]
    v_exp_f32 v26, v70
    v_mfma_f32_16x16x32_bf16 v[120:123], a[200:203], a[184:187], v[120:123]
    ds_read_b128 a[240:243], v6 offset:28672
    v_cvt_pk_bf16_f32 v130, v24, v25
    v_mfma_f32_16x16x32_bf16 v[120:123], a[196:199], a[180:183], v[120:123]
    v_exp_f32 v27, v71
    v_mfma_f32_16x16x32_bf16 v[120:123], a[192:195], a[176:179], v[120:123]
    s_waitcnt lgkmcnt(5)
    v_exp_f32 v20, v72
    v_mfma_f32_16x16x32_bf16 v[124:127], a[208:211], a[176:179], v[188:191]
    ds_read_b128 a[244:247], v6 offset:29696
    v_cvt_pk_bf16_f32 v131, v26, v27
    v_mfma_f32_16x16x32_bf16 v[124:127], a[212:215], a[180:183], v[124:127]
    v_exp_f32 v21, v73
    v_mfma_f32_16x16x32_bf16 v[28:31], v[44:47], v[128:131], 0
    v_exp_f32 v22, v74
    v_mfma_f32_16x16x32_bf16 v[124:127], a[216:219], a[184:187], v[124:127]
    buffer_load_dwordx4 v7, s[28:31], s57 offen offset:2048 sc1 lds
    v_mfma_f32_16x16x32_bf16 v[124:127], a[220:223], a[188:191], v[124:127]
    ds_read_b128 a[248:251], v6 offset:30720
    v_cvt_pk_bf16_f32 v132, v20, v21
    v_mfma_f32_16x16x32_bf16 v[116:119], a[220:223], a[172:175], v[180:183]
    v_exp_f32 v23, v75
    v_mfma_f32_16x16x32_bf16 v[116:119], a[216:219], a[168:171], v[116:119]
    v_exp_f32 v24, v76
    v_mfma_f32_16x16x32_bf16 v[116:119], a[212:215], a[164:167], v[116:119]
    ds_read_b128 a[252:255], v6 offset:31744
    v_cvt_pk_bf16_f32 v133, v22, v23
    v_mfma_f32_16x16x32_bf16 v[116:119], a[208:211], a[160:163], v[116:119]
    v_exp_f32 v25, v77
    v_mfma_f32_16x16x32_bf16 v[108:111], a[208:211], a[144:147], v[172:175]
    v_exp_f32 v26, v78
    v_mfma_f32_16x16x32_bf16 v[108:111], a[212:215], a[148:151], v[108:111]
    v_cvt_pk_bf16_f32 v134, v24, v25
    v_add_f32 v15, v15, v40
    v_mfma_f32_16x16x32_bf16 v[108:111], a[216:219], a[152:155], v[108:111]
    v_exp_f32 v27, v79
    v_mfma_f32_16x16x32_bf16 v[108:111], a[220:223], a[156:159], v[108:111]
    buffer_load_dwordx4 v7, s[28:31], s57 offen offset:3072 sc1 lds
    v_mfma_f32_16x16x32_bf16 v[100:103], a[220:223], a[140:143], v[164:167]
    s_add_u32 s57, s57, 16384
    v_exp_f32 v20, v80
    v_mfma_f32_16x16x32_bf16 v[100:103], a[216:219], a[136:139], v[100:103]
    v_cvt_pk_bf16_f32 v135, v26, v27
    v_mfma_f32_16x16x32_bf16 v[100:103], a[212:215], a[132:135], v[100:103]
    v_exp_f32 v21, v81
    v_mfma_f32_16x16x32_bf16 v[32:35], v[44:47], v[132:135], 0
    v_exp_f32 v22, v82
    v_mfma_f32_16x16x32_bf16 v[100:103], a[208:211], a[128:131], v[100:103]
    s_waitcnt vmcnt(24) lgkmcnt(0)
    v_add_u32 v6, s58, v2
    v_cvt_pk_bf16_f32 v136, v20, v21
    v_mfma_f32_16x16x32_bf16 a[0:3], a[224:227], v[144:147], a[0:3]
    s_barrier
    v_mfma_f32_16x16x32_bf16 a[32:35], a[224:227], v[148:151], a[32:35]
    ds_read_b128 a[192:195], v6 offset:0
    v_mfma_f32_16x16x32_bf16 a[64:67], a[224:227], v[152:155], a[64:67]
    v_exp_f32 v23, v83
    v_mfma_f32_16x16x32_bf16 a[96:99], a[224:227], v[156:159], a[96:99]
    v_exp_f32 v24, v84
    v_mfma_f32_16x16x32_bf16 a[100:103], a[228:231], v[156:159], a[100:103]
    ds_read_b128 a[196:199], v6 offset:1024
    v_cvt_pk_bf16_f32 v137, v22, v23
    v_mfma_f32_16x16x32_bf16 a[68:71], a[228:231], v[152:155], a[68:71]
    v_exp_f32 v25, v85
    v_mfma_f32_16x16x32_bf16 a[36:39], a[228:231], v[148:151], a[36:39]
    v_exp_f32 v26, v86
    v_mfma_f32_16x16x32_bf16 a[4:7], a[228:231], v[144:147], a[4:7]
    ds_read_b128 a[200:203], v6 offset:2048
    v_cvt_pk_bf16_f32 v138, v24, v25
    v_mfma_f32_16x16x32_bf16 a[8:11], a[232:235], v[144:147], a[8:11]
    v_exp_f32 v27, v87
    v_mfma_f32_16x16x32_bf16 a[40:43], a[232:235], v[148:151], a[40:43]
    v_exp_f32 v20, v88
    v_mfma_f32_16x16x32_bf16 a[72:75], a[232:235], v[152:155], a[72:75]
    ds_read_b128 a[204:207], v6 offset:3072
    v_cvt_pk_bf16_f32 v139, v26, v27
    v_mfma_f32_16x16x32_bf16 a[104:107], a[232:235], v[156:159], a[104:107]
    v_exp_f32 v21, v89
    v_mfma_f32_16x16x32_bf16 v[36:39], v[44:47], v[136:139], 0
    v_exp_f32 v22, v90
    v_mfma_f32_16x16x32_bf16 a[108:111], a[236:239], v[156:159], a[108:111]
    v_cvt_pk_bf16_f32 v140, v20, v21
    v_mfma_f32_16x16x32_bf16 a[76:79], a[236:239], v[152:155], a[76:79]
    v_exp_f32 v23, v91
    v_mfma_f32_16x16x32_bf16 a[44:47], a[236:239], v[148:151], a[44:47]
    v_exp_f32 v24, v92
    v_mfma_f32_16x16x32_bf16 a[12:15], a[236:239], v[144:147], a[12:15]
    v_cvt_pk_bf16_f32 v141, v22, v23
    v_mfma_f32_16x16x32_bf16 a[16:19], a[240:243], v[144:147], a[16:19]
    v_exp_f32 v25, v93
    v_mfma_f32_16x16x32_bf16 a[48:51], a[240:243], v[148:151], a[48:51]
    v_exp_f32 v26, v94
    v_mfma_f32_16x16x32_bf16 a[80:83], a[240:243], v[152:155], a[80:83]
    v_cvt_pk_bf16_f32 v142, v24, v25
    v_mfma_f32_16x16x32_bf16 a[112:115], a[240:243], v[156:159], a[112:115]
    v_exp_f32 v27, v95
    v_mfma_f32_16x16x32_bf16 a[116:119], a[244:247], v[156:159], a[116:119]
    v_cvt_pk_bf16_f32 v143, v26, v27
    v_mfma_f32_16x16x32_bf16 a[84:87], a[244:247], v[152:155], a[84:87]
    v_mfma_f32_16x16x32_bf16 a[52:55], a[244:247], v[148:151], a[52:55]
    v_mfma_f32_16x16x32_bf16 v[40:43], v[44:47], v[140:143], 0
    s_nop 2
    v_mfma_f32_16x16x32_bf16 a[20:23], a[244:247], v[144:147], a[20:23]
    s_nop 2
    v_mfma_f32_16x16x32_bf16 a[24:27], a[248:251], v[144:147], a[24:27]
    v_max3_f32 v8, v28, v32, v36
    v_max_f32 v8, v8, v40
    v_mfma_f32_16x16x32_bf16 a[56:59], a[248:251], v[148:151], a[56:59]
    v_cmp_nge_f32 vcc, s66, v8
    v_mfma_f32_16x16x32_bf16 a[88:91], a[248:251], v[152:155], a[88:91]
    v_mfma_f32_16x16x32_bf16 a[120:123], a[248:251], v[156:159], a[120:123]
    ds_read_b128 a[208:211], v6 offset:4096
    v_mfma_f32_16x16x32_bf16 a[124:127], a[252:255], v[156:159], a[124:127]
    ds_read_b128 a[212:215], v6 offset:5120
    v_mfma_f32_16x16x32_bf16 a[92:95], a[252:255], v[152:155], a[92:95]
    ds_read_b128 a[216:219], v6 offset:6144
    v_mfma_f32_16x16x32_bf16 a[60:63], a[252:255], v[148:151], a[60:63]
    ds_read_b128 a[220:223], v6 offset:7168
    v_mfma_f32_16x16x32_bf16 a[28:31], a[252:255], v[144:147], a[28:31]
    s_waitcnt lgkmcnt(4)
    s_cbranch_vccz m_dual78
    v_cmp_lt_f32 vcc, s65, v8
    s_cmp_lg_u32 s64, s67
    s_cbranch_scc1 m_e82
    v_add_f32 v176, v176, v16
    v_mov_b32 v180, v9
    v_add_f32 v188, v188, v16
    v_add_f32 v177, v177, v17
    v_mov_b32 v181, v9
    v_add_f32 v189, v189, v17
    v_add_f32 v178, v178, v18
    v_mov_b32 v182, v9
    v_add_f32 v190, v190, v18
    v_add_f32 v179, v179, v19
    v_mov_b32 v183, v9
    v_add_f32 v191, v191, v19
    s_nop 0
m_e82:
    s_cmp_lg_u32 s64, s68
    s_cbranch_scc1 m_e83
    v_mov_b32 v176, v9
    v_mov_b32 v184, v9
    v_mov_b32 v188, v9
    v_mov_b32 v177, v9
    v_mov_b32 v185, v9
    v_mov_b32 v189, v9
    v_mov_b32 v178, v9
    v_mov_b32 v186, v9
    v_mov_b32 v190, v9
    v_mov_b32 v179, v9
    v_mov_b32 v187, v9
    v_mov_b32 v191, v9
    s_nop 0
m_e83:
    s_cmp_lg_u32 s64, s70
    s_cbranch_scc1 m_e84
    v_add_f32 v160, v160, v16
    v_mov_b32 v164, v9
    v_add_f32 v172, v172, v16
    v_add_f32 v161, v161, v17
    v_mov_b32 v165, v9
    v_add_f32 v173, v173, v17
    v_add_f32 v162, v162, v18
    v_mov_b32 v166, v9
    v_add_f32 v174, v174, v18
    v_add_f32 v163, v163, v19
    v_mov_b32 v167, v9
    v_add_f32 v175, v175, v19
    s_nop 0
m_e84:
    s_cmp_lg_u32 s64, s53
    s_cbranch_scc1 m_e87
    s_cmp_lg_u32 s16, 0
    s_cbranch_scc1 m_np88
    v_mov_b32 v60, s4
    v_mov_b32 v61, s5
    s_add_u32 s90, s101, 117440512
    s_mov_b64 exec, 1
    buffer_store_dwordx2 v[60:61], off, s[8:11], s90 sc1
    s_mov_b64 exec, -1
m_np88:
    s_mov_b32 s101, -1
m_e87:
    s_cmp_gt_u32 s64, 24
    s_cbranch_scc1 m_e85
    s_cmp_lg_u32 s64, 8
    s_cbranch_scc1 m_e89
    s_lshr_b32 s90, s32, 1
    s_lshl_b32 s90, s90, 7
    s_add_u32 s90, s90, 117440600
    v_min_u32 v0, 1, v1
    v_lshlrev_b32 v0, 5, v0
    buffer_load_dwordx2 v[4:5], v0, s[8:11], s90 offen sc1
    s_cmp_eq_u32 s17, -1
    s_cbranch_scc1 m_e85
    s_cmp_lg_u32 s16, 0
    s_cbranch_scc1 m_np90
    v_mov_b32 v60, s4
    v_mov_b32 v61, s5
    s_add_u32 s90, s17, 117440512
    s_mov_b64 exec, 1
    buffer_store_dwordx2 v[60:61], off, s[8:11], s90 sc1
    s_mov_b64 exec, -1
m_np90:
    s_branch m_e85
m_e89:
    s_cmp_lg_u32 s64, 16
    s_cbranch_scc1 m_e91
    s_waitcnt vmcnt(18)
    s_mov_b32 s3, 1048576
m_spin92:
    v_cmp_ne_u64 s[76:77], s[4:5], v[4:5]
    s_nop 3
    s_cmp_eq_u64 s[76:77], 0
    s_cbranch_scc1 m_e85
    s_sub_u32 s3, s3, 1
    s_cbranch_scc1 m_e85
    s_sleep 32
    s_lshr_b32 s90, s32, 1
    s_lshl_b32 s90, s90, 7
    s_add_u32 s90, s90, 117440600
    v_min_u32 v0, 1, v1
    v_lshlrev_b32 v0, 5, v0
    buffer_load_dwordx2 v[4:5], v0, s[8:11], s90 offen sc1
    s_waitcnt vmcnt(0)
    s_branch m_spin92
    s_branch m_e85
m_e91:
    s_cmp_lg_u32 s64, 20
    s_cbranch_scc1 m_e93
    buffer_load_dwordx2 v[4:5], v10, s[8:11], 0 offen sc1
    s_mov_b32 s44, s48
    s_mov_b32 s45, s49
    s_mov_b32 s46, 8388608
    s_lshl_b32 s90, s2, 2
    s_add_u32 s90, s90, s16
    s_lshl_b32 s90, s90, 13
    v_lshlrev_b32 v62, 7, v1
    buffer_load_dword v255, v62, s[44:47], s90 offen
    s_branch m_e85
m_e93:
    s_cmp_lg_u32 s64, 24
    s_cbranch_scc1 m_e94
    s_mov_b32 s44, s50
    s_mov_b32 s45, s51
    s_mov_b32 s46, 2097152
    s_lshl_b32 s90, s2, 2
    s_add_u32 s90, s90, s16
    s_lshl_b32 s90, s90, 13
    v_lshlrev_b32 v62, 7, v1
    buffer_load_dword v255, v62, s[44:47], s90 offen
    s_waitcnt vmcnt(18)
    s_mov_b32 s3, 1048576
m_spin95:
    v_cmp_ne_u64 s[76:77], s[4:5], v[4:5]
    s_nop 3
    s_cmp_eq_u64 s[76:77], 0
    s_cbranch_scc1 m_e85
    s_sub_u32 s3, s3, 1
    s_cbranch_scc1 m_e85
    s_sleep 32
    buffer_load_dwordx2 v[4:5], v10, s[8:11], 0 offen sc1
    s_waitcnt vmcnt(0)
    s_branch m_spin95
    s_branch m_e85
m_e94:
m_e85:
    s_cbranch_vccnz m_rc96
m_sp81:
    s_cmp_lg_u32 s64, s69
    s_cbranch_scc1 m_dual78
    v_mfma_f32_16x16x32_bf16 v[64:67], a[192:195], a[128:131], v[160:163]
    s_bitcmp1_b64 s[62:63], s64
    s_cselect_b32 s66, -1.0, s65
    v_add_f32 v12, v12, v28
    v_mfma_f32_16x16x32_bf16 v[64:67], a[196:199], a[132:135], v[64:67]
    s_add_u32 s64, s64, 1
    ds_read_b128 a[224:227], v6 offset:16384
    v_exp_f32 v20, v96
    v_mfma_f32_16x16x32_bf16 v[64:67], a[200:203], a[136:139], v[64:67]
    s_mov_b32 m0, s59
    ds_read_b128 a[228:231], v6 offset:17408
    v_add_f32 v13, v13, v32
    v_mfma_f32_16x16x32_bf16 v[64:67], a[204:207], a[140:143], v[64:67]
    buffer_load_dwordx4 v7, s[24:27], s56 offen offset:0 sc1 lds
    v_mfma_f32_16x16x32_bf16 v[72:75], a[204:207], a[156:159], v[168:171]
    ds_read_b128 a[232:235], v6 offset:18432
    v_add_f32 v14, v14, v36
    v_mfma_f32_16x16x32_bf16 v[72:75], a[200:203], a[152:155], v[72:75]
    ds_read_b128 a[236:239], v6 offset:19456
    v_exp_f32 v21, v97
    v_mfma_f32_16x16x32_bf16 v[72:75], a[196:199], a[148:151], v[72:75]
    ds_read_b128 a[240:243], v6 offset:20480
    v_cvt_pk_bf16_f32 v144, v20, v21
    v_mfma_f32_16x16x32_bf16 v[72:75], a[192:195], a[144:147], v[72:75]
    s_waitcnt lgkmcnt(5)
    ds_read_b128 a[244:247], v6 offset:21504
    v_add_f32 v15, v15, v40
    v_mfma_f32_16x16x32_bf16 v[76:79], a[208:211], a[144:147], v[172:175]
    ds_read_b128 a[248:251], v6 offset:22528
    v_exp_f32 v22, v98
    v_mfma_f32_16x16x32_bf16 v[76:79], a[212:215], a[148:151], v[76:79]
    ds_read_b128 a[252:255], v6 offset:23552
    v_exp_f32 v23, v99
    v_mfma_f32_16x16x32_bf16 v[76:79], a[216:219], a[152:155], v[76:79]
    v_exp_f32 v24, v100
    v_mfma_f32_16x16x32_bf16 v[76:79], a[220:223], a[156:159], v[76:79]
    buffer_load_dwordx4 v7, s[24:27], s56 offen offset:1024 sc1 lds
    v_mfma_f32_16x16x32_bf16 v[68:71], a[220:223], a[140:143], v[164:167]
    v_cvt_pk_bf16_f32 v145, v22, v23
    v_exp_f32 v25, v101
    v_mfma_f32_16x16x32_bf16 v[68:71], a[216:219], a[136:139], v[68:71]
    v_exp_f32 v26, v102
    v_mfma_f32_16x16x32_bf16 v[68:71], a[212:215], a[132:135], v[68:71]
    v_cvt_pk_bf16_f32 v146, v24, v25
    v_exp_f32 v27, v103
    v_mfma_f32_16x16x32_bf16 v[68:71], a[208:211], a[128:131], v[68:71]
    s_waitcnt lgkmcnt(0)
    v_exp_f32 v20, v104
    v_mfma_f32_16x16x32_bf16 a[0:3], a[224:227], v[128:131], a[0:3]
    ds_read_b128 a[192:195], v6 offset:8192
    v_cvt_pk_bf16_f32 v147, v26, v27
    v_mfma_f32_16x16x32_bf16 a[32:35], a[224:227], v[132:135], a[32:35]
    v_exp_f32 v21, v105
    v_mfma_f32_16x16x32_bf16 v[28:31], v[44:47], v[144:147], 0
    v_exp_f32 v22, v106
    v_mfma_f32_16x16x32_bf16 a[64:67], a[224:227], v[136:139], a[64:67]
    v_cvt_pk_bf16_f32 v148, v20, v21
    v_exp_f32 v23, v107
    v_mfma_f32_16x16x32_bf16 a[96:99], a[224:227], v[140:143], a[96:99]
    ds_read_b128 a[196:199], v6 offset:9216
    v_cvt_pk_bf16_f32 v149, v22, v23
    v_mfma_f32_16x16x32_bf16 a[100:103], a[228:231], v[140:143], a[100:103]
    v_exp_f32 v24, v108
    v_mfma_f32_16x16x32_bf16 a[68:71], a[228:231], v[136:139], a[68:71]
    buffer_load_dwordx4 v7, s[24:27], s56 offen offset:2048 sc1 lds
    v_mfma_f32_16x16x32_bf16 a[36:39], a[228:231], v[132:135], a[36:39]
    ds_read_b128 a[200:203], v6 offset:10240
    v_exp_f32 v25, v109
    v_mfma_f32_16x16x32_bf16 a[4:7], a[228:231], v[128:131], a[4:7]
    v_exp_f32 v26, v110
    v_mfma_f32_16x16x32_bf16 a[8:11], a[232:235], v[128:131], a[8:11]
    v_cvt_pk_bf16_f32 v150, v24, v25
    v_exp_f32 v27, v111
    v_mfma_f32_16x16x32_bf16 a[40:43], a[232:235], v[132:135], a[40:43]
    ds_read_b128 a[204:207], v6 offset:11264
    v_cvt_pk_bf16_f32 v151, v26, v27
    v_mfma_f32_16x16x32_bf16 a[72:75], a[232:235], v[136:139], a[72:75]
    v_exp_f32 v20, v112
    v_mfma_f32_16x16x32_bf16 v[32:35], v[44:47], v[148:151], 0
    v_exp_f32 v21, v113
    v_mfma_f32_16x16x32_bf16 a[104:107], a[232:235], v[140:143], a[104:107]
    v_exp_f32 v22, v114
    v_mfma_f32_16x16x32_bf16 a[108:111], a[236:239], v[140:143], a[108:111]
    v_cvt_pk_bf16_f32 v152, v20, v21
    v_exp_f32 v23, v115
    v_mfma_f32_16x16x32_bf16 a[76:79], a[236:239], v[136:139], a[76:79]
    v_exp_f32 v24, v116
    v_mfma_f32_16x16x32_bf16 a[44:47], a[236:239], v[132:135], a[44:47]
    v_cvt_pk_bf16_f32 v153, v22, v23
    v_exp_f32 v25, v117
    v_mfma_f32_16x16x32_bf16 a[12:15], a[236:239], v[128:131], a[12:15]
    buffer_load_dwordx4 v7, s[24:27], s56 offen offset:3072 sc1 lds
    v_mfma_f32_16x16x32_bf16 a[16:19], a[240:243], v[128:131], a[16:19]
    s_add_u32 s56, s56, 16384
    v_exp_f32 v26, v118
    v_mfma_f32_16x16x32_bf16 a[48:51], a[240:243], v[132:135], a[48:51]
    v_cvt_pk_bf16_f32 v154, v24, v25
    v_exp_f32 v27, v119
    v_mfma_f32_16x16x32_bf16 a[80:83], a[240:243], v[136:139], a[80:83]
    v_exp_f32 v20, v120
    v_mfma_f32_16x16x32_bf16 a[112:115], a[240:243], v[140:143], a[112:115]
    v_cvt_pk_bf16_f32 v155, v26, v27
    v_exp_f32 v21, v121
    v_mfma_f32_16x16x32_bf16 a[116:119], a[244:247], v[140:143], a[116:119]
    v_exp_f32 v22, v122
    v_mfma_f32_16x16x32_bf16 v[36:39], v[44:47], v[152:155], 0
    v_cvt_pk_bf16_f32 v156, v20, v21
    v_mfma_f32_16x16x32_bf16 a[84:87], a[244:247], v[136:139], a[84:87]
    v_exp_f32 v23, v123
    v_mfma_f32_16x16x32_bf16 a[52:55], a[244:247], v[132:135], a[52:55]
    v_exp_f32 v24, v124
    v_cvt_pk_bf16_f32 v157, v22, v23
    v_mfma_f32_16x16x32_bf16 a[20:23], a[244:247], v[128:131], a[20:23]
    v_exp_f32 v25, v125
    v_mfma_f32_16x16x32_bf16 a[24:27], a[248:251], v[128:131], a[24:27]
    s_add_u32 m0, s59, 16384
    v_exp_f32 v26, v126
    v_mfma_f32_16x16x32_bf16 a[56:59], a[248:251], v[132:135], a[56:59]
    buffer_load_dwordx4 v7, s[28:31], s57 offen offset:0 sc1 lds
    v_mfma_f32_16x16x32_bf16 a[88:91], a[248:251], v[136:139], a[88:91]
    v_cvt_pk_bf16_f32 v158, v24, v25
    v_exp_f32 v27, v127
    v_mfma_f32_16x16x32_bf16 a[120:123], a[248:251], v[140:143], a[120:123]
    ds_read_b128 a[208:211], v6 offset:12288
    v_cvt_pk_bf16_f32 v159, v26, v27
    s_nop 1
    v_mfma_f32_16x16x32_bf16 v[40:43], v[44:47], v[156:159], 0
    s_nop 2
    v_mfma_f32_16x16x32_bf16 a[124:127], a[252:255], v[140:143], a[124:127]
    ds_read_b128 a[212:215], v6 offset:13312
    s_nop 0
    v_mfma_f32_16x16x32_bf16 a[92:95], a[252:255], v[136:139], a[92:95]
    ds_read_b128 a[216:219], v6 offset:14336
    v_max3_f32 v8, v28, v32, v36
    v_mfma_f32_16x16x32_bf16 a[60:63], a[252:255], v[132:135], a[60:63]
    ds_read_b128 a[220:223], v6 offset:15360
    v_max_f32 v8, v8, v40
    v_cmp_nge_f32 vcc, s66, v8
    v_mfma_f32_16x16x32_bf16 a[28:31], a[252:255], v[128:131], a[28:31]
    s_waitcnt lgkmcnt(4)
    s_cbranch_vccnz m_stub97
m_ret98:
    v_mfma_f32_16x16x32_bf16 v[96:99], a[192:195], a[128:131], v[160:163]
    s_add_u32 s59, s58, s60
    v_exp_f32 v20, v64
    v_mfma_f32_16x16x32_bf16 v[96:99], a[196:199], a[132:135], v[96:99]
    s_add_u32 s58, s58, 32768
    ds_read_b128 a[224:227], v6 offset:24576
    v_add_f32 v12, v12, v28
    v_mfma_f32_16x16x32_bf16 v[96:99], a[200:203], a[136:139], v[96:99]
    s_cmp_ge_u32 s58, 163840
    s_cselect_b32 s58, 0, s58
    ds_read_b128 a[228:231], v6 offset:25600
    v_add_f32 v13, v13, v32
    v_mfma_f32_16x16x32_bf16 v[96:99], a[204:207], a[140:143], v[96:99]
    buffer_load_dwordx4 v7, s[28:31], s57 offen offset:1024 sc1 lds
    v_mfma_f32_16x16x32_bf16 v[104:107], a[204:207], a[156:159], v[168:171]
    s_bitcmp1_b64 s[62:63], s64
    s_cselect_b32 s66, -1.0, s65
    ds_read_b128 a[232:235], v6 offset:26624
    v_mfma_f32_16x16x32_bf16 v[104:107], a[200:203], a[152:155], v[104:107]
    s_add_u32 s64, s64, 1
    ds_read_b128 a[236:239], v6 offset:27648
    v_mfma_f32_16x16x32_bf16 v[104:107], a[196:199], a[148:151], v[104:107]
    ds_read_b128 a[240:243], v6 offset:28672
    v_mfma_f32_16x16x32_bf16 v[104:107], a[192:195], a[144:147], v[104:107]
    s_waitcnt lgkmcnt(5)
    ds_read_b128 a[244:247], v6 offset:29696
    v_mfma_f32_16x16x32_bf16 v[108:111], a[208:211], a[144:147], v[172:175]
    buffer_load_dwordx4 v7, s[28:31], s57 offen offset:2048 sc1 lds
    v_mfma_f32_16x16x32_bf16 v[108:111], a[212:215], a[148:151], v[108:111]
    ds_read_b128 a[248:251], v6 offset:30720
    v_mfma_f32_16x16x32_bf16 v[108:111], a[216:219], a[152:155], v[108:111]
    ds_read_b128 a[252:255], v6 offset:31744
    v_mfma_f32_16x16x32_bf16 v[108:111], a[220:223], a[156:159], v[108:111]
    v_exp_f32 v21, v65
    v_mfma_f32_16x16x32_bf16 v[100:103], a[220:223], a[140:143], v[164:167]
    v_exp_f32 v22, v66
    v_mfma_f32_16x16x32_bf16 v[100:103], a[216:219], a[136:139], v[100:103]
    buffer_load_dwordx4 v7, s[28:31], s57 offen offset:3072 sc1 lds
    v_mfma_f32_16x16x32_bf16 v[100:103], a[212:215], a[132:135], v[100:103]
    s_add_u32 s57, s57, 16384
    v_cvt_pk_bf16_f32 v128, v20, v21
    v_mfma_f32_16x16x32_bf16 v[100:103], a[208:211], a[128:131], v[100:103]
    s_waitcnt vmcnt(24) lgkmcnt(0)
    v_add_u32 v6, s58, v2
    v_mfma_f32_16x16x32_bf16 a[0:3], a[224:227], v[144:147], a[0:3]
    s_barrier
    v_mfma_f32_16x16x32_bf16 a[32:35], a[224:227], v[148:151], a[32:35]
    ds_read_b128 a[192:195], v6 offset:0
    v_mfma_f32_16x16x32_bf16 a[64:67], a[224:227], v[152:155], a[64:67]
    v_exp_f32 v23, v67
    v_mfma_f32_16x16x32_bf16 a[96:99], a[224:227], v[156:159], a[96:99]
    v_exp_f32 v24, v68
    v_mfma_f32_16x16x32_bf16 a[100:103], a[228:231], v[156:159], a[100:103]
    ds_read_b128 a[196:199], v6 offset:1024
    v_cvt_pk_bf16_f32 v129, v22, v23
    v_mfma_f32_16x16x32_bf16 a[68:71], a[228:231], v[152:155], a[68:71]
    v_exp_f32 v25, v69
    v_mfma_f32_16x16x32_bf16 a[36:39], a[228:231], v[148:151], a[36:39]
    v_exp_f32 v26, v70
    v_mfma_f32_16x16x32_bf16 a[4:7], a[228:231], v[144:147], a[4:7]
    ds_read_b128 a[200:203], v6 offset:2048
    v_cvt_pk_bf16_f32 v130, v24, v25
    v_mfma_f32_16x16x32_bf16 a[8:11], a[232:235], v[144:147], a[8:11]
    v_exp_f32 v27, v71
    v_mfma_f32_16x16x32_bf16 a[40:43], a[232:235], v[148:151], a[40:43]
    v_exp_f32 v20, v72
    v_mfma_f32_16x16x32_bf16 a[72:75], a[232:235], v[152:155], a[72:75]
    ds_read_b128 a[204:207], v6 offset:3072
    v_cvt_pk_bf16_f32 v131, v26, v27
    v_mfma_f32_16x16x32_bf16 a[104:107], a[232:235], v[156:159], a[104:107]
    v_exp_f32 v21, v73
    v_mfma_f32_16x16x32_bf16 v[28:31], v[44:47], v[128:131], 0
    v_exp_f32 v22, v74
    v_mfma_f32_16x16x32_bf16 a[108:111], a[236:239], v[156:159], a[108:111]
    v_cvt_pk_bf16_f32 v132, v20, v21
    v_mfma_f32_16x16x32_bf16 a[76:79], a[236:239], v[152:155], a[76:79]
    v_exp_f32 v23, v75
    v_mfma_f32_16x16x32_bf16 a[44:47], a[236:239], v[148:151], a[44:47]
    v_exp_f32 v24, v76
    v_mfma_f32_16x16x32_bf16 a[12:15], a[236:239], v[144:147], a[12:15]
    v_cvt_pk_bf16_f32 v133, v22, v23
    v_mfma_f32_16x16x32_bf16 a[16:19], a[240:243], v[144:147], a[16:19]
    v_exp_f32 v25, v77
    v_mfma_f32_16x16x32_bf16 a[48:51], a[240:243], v[148:151], a[48:51]
    v_exp_f32 v26, v78
    v_mfma_f32_16x16x32_bf16 a[80:83], a[240:243], v[152:155], a[80:83]
    v_cvt_pk_bf16_f32 v134, v24, v25
    v_mfma_f32_16x16x32_bf16 a[112:115], a[240:243], v[156:159], a[112:115]
    v_exp_f32 v27, v79
    v_mfma_f32_16x16x32_bf16 a[116:119], a[244:247], v[156:159], a[116:119]
    v_cvt_pk_bf16_f32 v135, v26, v27
    v_mfma_f32_16x16x32_bf16 a[84:87], a[244:247], v[152:155], a[84:87]
    v_mfma_f32_16x16x32_bf16 a[52:55], a[244:247], v[148:151], a[52:55]
    v_mfma_f32_16x16x32_bf16 v[32:35], v[44:47], v[132:135], 0
    s_nop 2
    v_mfma_f32_16x16x32_bf16 a[20:23], a[244:247], v[144:147], a[20:23]
    s_nop 2
    v_mfma_f32_16x16x32_bf16 a[24:27], a[248:251], v[144:147], a[24:27]
    v_max_f32 v8, v28, v32
    v_cmp_nge_f32 vcc, s66, v8
    v_mfma_f32_16x16x32_bf16 a[56:59], a[248:251], v[148:151], a[56:59]
    v_mfma_f32_16x16x32_bf16 a[88:91], a[248:251], v[152:155], a[88:91]
    v_mfma_f32_16x16x32_bf16 a[120:123], a[248:251], v[156:159], a[120:123]
    ds_read_b128 a[208:211], v6 offset:4096
    v_mfma_f32_16x16x32_bf16 a[124:127], a[252:255], v[156:159], a[124:127]
    ds_read_b128 a[212:215], v6 offset:5120
    v_mfma_f32_16x16x32_bf16 a[92:95], a[252:255], v[152:155], a[92:95]
    ds_read_b128 a[216:219], v6 offset:6144
    v_mfma_f32_16x16x32_bf16 a[60:63], a[252:255], v[148:151], a[60:63]
    ds_read_b128 a[220:223], v6 offset:7168
    v_mfma_f32_16x16x32_bf16 a[28:31], a[252:255], v[144:147], a[28:31]
    s_waitcnt lgkmcnt(4)
    s_cbranch_vccnz m_stub99
m_ret100:
    v_add_f32 v20, v14, v36
    v_add_f32 v21, v15, v40
    s_nop 3
    v_rcp_f32 v20, v20
    v_rcp_f32 v21, v21
    s_lshl_b32 s90, s79, 10
    s_add_u32 s90, s90, s82
    s_add_u32 s90, s90, 67108864
    v_accvgpr_read_b32 v48, a64
    v_accvgpr_read_b32 v49, a65
    v_accvgpr_read_b32 v50, a66
    v_accvgpr_read_b32 v51, a67
    v_accvgpr_read_b32 v52, a68
    v_accvgpr_read_b32 v53, a69
    v_accvgpr_read_b32 v54, a70
    v_accvgpr_read_b32 v55, a71
    v_mul_f32 v48, v20, v48
    v_mul_f32 v49, v20, v49
    v_mul_f32 v50, v20, v50
    v_mul_f32 v51, v20, v51
    v_mul_f32 v52, v20, v52
    v_mul_f32 v53, v20, v53
    v_mul_f32 v54, v20, v54
    v_mul_f32 v55, v20, v55
    v_cvt_pk_bf16_f32 v48, v48, v49
    v_cvt_pk_bf16_f32 v49, v50, v51
    v_cvt_pk_bf16_f32 v50, v52, v53
    v_cvt_pk_bf16_f32 v51, v54, v55
    buffer_store_dwordx4 v[48:51], v2, s[8:11], s90 offen offset:0 sc1
    v_accvgpr_read_b32 v56, a96
    v_accvgpr_read_b32 v57, a97
    v_accvgpr_read_b32 v58, a98
    v_accvgpr_read_b32 v59, a99
    v_accvgpr_read_b32 v60, a100
    v_accvgpr_read_b32 v61, a101
    v_accvgpr_read_b32 v62, a102
    v_accvgpr_read_b32 v63, a103
    v_mul_f32 v56, v21, v56
    v_mul_f32 v57, v21, v57
    v_mul_f32 v58, v21, v58
    v_mul_f32 v59, v21, v59
    v_mul_f32 v60, v21, v60
    v_mul_f32 v61, v21, v61
    v_mul_f32 v62, v21, v62
    v_mul_f32 v63, v21, v63
    v_cvt_pk_bf16_f32 v56, v56, v57
    v_cvt_pk_bf16_f32 v57, v58, v59
    v_cvt_pk_bf16_f32 v58, v60, v61
    v_cvt_pk_bf16_f32 v59, v62, v63
    buffer_store_dwordx4 v[56:59], v2, s[8:11], s90 offen offset:1024 sc1
    s_add_u32 s90, s90, 131072
    v_accvgpr_read_b32 v48, a72
    v_accvgpr_read_b32 v49, a73
    v_accvgpr_read_b32 v50, a74
    v_accvgpr_read_b32 v51, a75
    v_accvgpr_read_b32 v52, a76
    v_accvgpr_read_b32 v53, a77
    v_accvgpr_read_b32 v54, a78
    v_accvgpr_read_b32 v55, a79
    v_mul_f32 v48, v20, v48
    v_mul_f32 v49, v20, v49
    v_mul_f32 v50, v20, v50
    v_mul_f32 v51, v20, v51
    v_mul_f32 v52, v20, v52
    v_mul_f32 v53, v20, v53
    v_mul_f32 v54, v20, v54
    v_mul_f32 v55, v20, v55
    v_cvt_pk_bf16_f32 v48, v48, v49
    v_cvt_pk_bf16_f32 v49, v50, v51
    v_cvt_pk_bf16_f32 v50, v52, v53
    v_cvt_pk_bf16_f32 v51, v54, v55
    buffer_store_dwordx4 v[48:51], v2, s[8:11], s90 offen offset:0 sc1
    v_accvgpr_read_b32 v56, a104
    v_accvgpr_read_b32 v57, a105
    v_accvgpr_read_b32 v58, a106
    v_accvgpr_read_b32 v59, a107
    v_accvgpr_read_b32 v60, a108
    v_accvgpr_read_b32 v61, a109
    v_accvgpr_read_b32 v62, a110
    v_accvgpr_read_b32 v63, a111
    v_mul_f32 v56, v21, v56
    v_mul_f32 v57, v21, v57
    v_mul_f32 v58, v21, v58
    v_mul_f32 v59, v21, v59
    v_mul_f32 v60, v21, v60
    v_mul_f32 v61, v21, v61
    v_mul_f32 v62, v21, v62
    v_mul_f32 v63, v21, v63
    v_cvt_pk_bf16_f32 v56, v56, v57
    v_cvt_pk_bf16_f32 v57, v58, v59
    v_cvt_pk_bf16_f32 v58, v60, v61
    v_cvt_pk_bf16_f32 v59, v62, v63
    buffer_store_dwordx4 v[56:59], v2, s[8:11], s90 offen offset:1024 sc1
    s_add_u32 s90, s90, 131072
    v_accvgpr_read_b32 v48, a80
    v_accvgpr_read_b32 v49, a81
    v_accvgpr_read_b32 v50, a82
    v_accvgpr_read_b32 v51, a83
    v_accvgpr_read_b32 v52, a84
    v_accvgpr_read_b32 v53, a85
    v_accvgpr_read_b32 v54, a86
    v_accvgpr_read_b32 v55, a87
    v_mul_f32 v48, v20, v48
    v_mul_f32 v49, v20, v49
    v_mul_f32 v50, v20, v50
    v_mul_f32 v51, v20, v51
    v_mul_f32 v52, v20, v52
    v_mul_f32 v53, v20, v53
    v_mul_f32 v54, v20, v54
    v_mul_f32 v55, v20, v55
    v_cvt_pk_bf16_f32 v48, v48, v49
    v_cvt_pk_bf16_f32 v49, v50, v51
    v_cvt_pk_bf16_f32 v50, v52, v53
    v_cvt_pk_bf16_f32 v51, v54, v55
    buffer_store_dwordx4 v[48:51], v2, s[8:11], s90 offen offset:0 sc1
    v_accvgpr_read_b32 v56, a112
    v_accvgpr_read_b32 v57, a113
    v_accvgpr_read_b32 v58, a114
    v_accvgpr_read_b32 v59, a115
    v_accvgpr_read_b32 v60, a116
    v_accvgpr_read_b32 v61, a117
    v_accvgpr_read_b32 v62, a118
    v_accvgpr_read_b32 v63, a119
    v_mul_f32 v56, v21, v56
    v_mul_f32 v57, v21, v57
    v_mul_f32 v58, v21, v58
    v_mul_f32 v59, v21, v59
    v_mul_f32 v60, v21, v60
    v_mul_f32 v61, v21, v61
    v_mul_f32 v62, v21, v62
    v_mul_f32 v63, v21, v63
    v_cvt_pk_bf16_f32 v56, v56, v57
    v_cvt_pk_bf16_f32 v57, v58, v59
    v_cvt_pk_bf16_f32 v58, v60, v61
    v_cvt_pk_bf16_f32 v59, v62, v63
    buffer_store_dwordx4 v[56:59], v2, s[8:11], s90 offen offset:1024 sc1
    s_add_u32 s90, s90, 131072
    v_accvgpr_read_b32 v48, a88
    v_accvgpr_read_b32 v49, a89
    v_accvgpr_read_b32 v50, a90
    v_accvgpr_read_b32 v51, a91
    v_accvgpr_read_b32 v52, a92
    v_accvgpr_read_b32 v53, a93
    v_accvgpr_read_b32 v54, a94
    v_accvgpr_read_b32 v55, a95
    v_mul_f32 v48, v20, v48
    v_mul_f32 v49, v20, v49
    v_mul_f32 v50, v20, v50
    v_mul_f32 v51, v20, v51
    v_mul_f32 v52, v20, v52
    v_mul_f32 v53, v20, v53
    v_mul_f32 v54, v20, v54
    v_mul_f32 v55, v20, v55
    v_cvt_pk_bf16_f32 v48, v48, v49
    v_cvt_pk_bf16_f32 v49, v50, v51
    v_cvt_pk_bf16_f32 v50, v52, v53
    v_cvt_pk_bf16_f32 v51, v54, v55
    buffer_store_dwordx4 v[48:51], v2, s[8:11], s90 offen offset:0 sc1
    v_accvgpr_read_b32 v56, a120
    v_accvgpr_read_b32 v57, a121
    v_accvgpr_read_b32 v58, a122
    v_accvgpr_read_b32 v59, a123
    v_accvgpr_read_b32 v60, a124
    v_accvgpr_read_b32 v61, a125
    v_accvgpr_read_b32 v62, a126
    v_accvgpr_read_b32 v63, a127
    v_mul_f32 v56, v21, v56
    v_mul_f32 v57, v21, v57
    v_mul_f32 v58, v21, v58
    v_mul_f32 v59, v21, v59
    v_mul_f32 v60, v21, v60
    v_mul_f32 v61, v21, v61
    v_mul_f32 v62, v21, v62
    v_mul_f32 v63, v21, v63
    v_cvt_pk_bf16_f32 v56, v56, v57
    v_cvt_pk_bf16_f32 v57, v58, v59
    v_cvt_pk_bf16_f32 v58, v60, v61
    v_cvt_pk_bf16_f32 v59, v62, v63
    buffer_store_dwordx4 v[56:59], v2, s[8:11], s90 offen offset:1024 sc1
    s_add_u32 s90, s90, 131072
    s_lshl_b32 s101, s34, 5
    s_add_u32 s101, s101, s32
    s_lshl_b32 s101, s101, 3
    s_add_u32 s101, s101, 7936
    s_cmp_eq_u32 s64, s72
    s_cbranch_scc1 m_singlex102
m_single101:
    v_mfma_f32_16x16x32_bf16 v[64:67], a[192:195], a[128:131], v[160:163]
    s_bitcmp1_b64 s[62:63], s64
    s_cselect_b32 s66, -1.0, s65
    v_add_f32 v12, v12, v28
    v_mfma_f32_16x16x32_bf16 v[64:67], a[196:199], a[132:135], v[64:67]
    s_mov_b32 m0, s59
    ds_read_b128 a[224:227], v6 offset:16384
    v_add_f32 v13, v13, v32
    v_mfma_f32_16x16x32_bf16 v[64:67], a[200:203], a[136:139], v[64:67]
    buffer_load_dwordx4 v7, s[24:27], s56 offen offset:0 sc1 lds
    v_mfma_f32_16x16x32_bf16 v[64:67], a[204:207], a[140:143], v[64:67]
    s_add_u32 s64, s64, 1
    ds_read_b128 a[228:231], v6 offset:17408
    v_exp_f32 v20, v96
    v_mfma_f32_16x16x32_bf16 v[72:75], a[204:207], a[156:159], v[168:171]
    ds_read_b128 a[232:235], v6 offset:18432
    v_exp_f32 v21, v97
    v_mfma_f32_16x16x32_bf16 v[72:75], a[200:203], a[152:155], v[72:75]
    ds_read_b128 a[236:239], v6 offset:19456
    v_cvt_pk_bf16_f32 v144, v20, v21
    v_mfma_f32_16x16x32_bf16 v[72:75], a[196:199], a[148:151], v[72:75]
    ds_read_b128 a[240:243], v6 offset:20480
    v_exp_f32 v22, v98
    v_mfma_f32_16x16x32_bf16 v[72:75], a[192:195], a[144:147], v[72:75]
    s_waitcnt lgkmcnt(5)
    ds_read_b128 a[244:247], v6 offset:21504
    v_mfma_f32_16x16x32_bf16 v[76:79], a[208:211], a[144:147], v[172:175]
    ds_read_b128 a[248:251], v6 offset:22528
    v_exp_f32 v23, v99
    v_mfma_f32_16x16x32_bf16 v[76:79], a[212:215], a[148:151], v[76:79]
    ds_read_b128 a[252:255], v6 offset:23552
    v_cvt_pk_bf16_f32 v145, v22, v23
    v_mfma_f32_16x16x32_bf16 v[76:79], a[216:219], a[152:155], v[76:79]
    buffer_load_dwordx4 v7, s[24:27], s56 offen offset:1024 sc1 lds
    v_mfma_f32_16x16x32_bf16 v[76:79], a[220:223], a[156:159], v[76:79]
    v_exp_f32 v24, v100
    v_mfma_f32_16x16x32_bf16 v[68:71], a[220:223], a[140:143], v[164:167]
    v_exp_f32 v25, v101
    v_mfma_f32_16x16x32_bf16 v[68:71], a[216:219], a[136:139], v[68:71]
    v_exp_f32 v26, v102
    v_mfma_f32_16x16x32_bf16 v[68:71], a[212:215], a[132:135], v[68:71]
    buffer_load_dwordx4 v7, s[24:27], s56 offen offset:2048 sc1 lds
    v_cvt_pk_bf16_f32 v146, v24, v25
    v_mfma_f32_16x16x32_bf16 v[68:71], a[208:211], a[128:131], v[68:71]
    s_waitcnt lgkmcnt(0)
    v_exp_f32 v27, v103
    v_mfma_f32_16x16x32_bf16 a[0:3], a[224:227], v[128:131], a[0:3]
    ds_read_b128 a[192:195], v6 offset:8192
    v_cvt_pk_bf16_f32 v147, v26, v27
    v_mfma_f32_16x16x32_bf16 a[32:35], a[224:227], v[132:135], a[32:35]
    v_exp_f32 v20, v104
    v_mfma_f32_16x16x32_bf16 v[28:31], v[44:47], v[144:147], 0
    v_exp_f32 v21, v105
    v_mfma_f32_16x16x32_bf16 a[36:39], a[228:231], v[132:135], a[36:39]
    ds_read_b128 a[196:199], v6 offset:9216
    v_exp_f32 v22, v106
    v_mfma_f32_16x16x32_bf16 a[4:7], a[228:231], v[128:131], a[4:7]
    buffer_load_dwordx4 v7, s[24:27], s56 offen offset:3072 sc1 lds
    v_mfma_f32_16x16x32_bf16 a[8:11], a[232:235], v[128:131], a[8:11]
    s_add_u32 s56, s56, 16384
    ds_read_b128 a[200:203], v6 offset:10240
    v_cvt_pk_bf16_f32 v148, v20, v21
    v_mfma_f32_16x16x32_bf16 a[40:43], a[232:235], v[132:135], a[40:43]
    v_exp_f32 v23, v107
    v_mfma_f32_16x16x32_bf16 a[44:47], a[236:239], v[132:135], a[44:47]
    ds_read_b128 a[204:207], v6 offset:11264
    v_exp_f32 v24, v108
    v_mfma_f32_16x16x32_bf16 a[12:15], a[236:239], v[128:131], a[12:15]
    v_cvt_pk_bf16_f32 v149, v22, v23
    v_exp_f32 v25, v109
    v_mfma_f32_16x16x32_bf16 a[16:19], a[240:243], v[128:131], a[16:19]
    v_exp_f32 v26, v110
    v_mfma_f32_16x16x32_bf16 a[48:51], a[240:243], v[132:135], a[48:51]
    v_cvt_pk_bf16_f32 v150, v24, v25
    v_exp_f32 v27, v111
    v_mfma_f32_16x16x32_bf16 a[52:55], a[244:247], v[132:135], a[52:55]
    ds_read_b128 a[208:211], v6 offset:12288
    v_cvt_pk_bf16_f32 v151, v26, v27
    v_mfma_f32_16x16x32_bf16 a[20:23], a[244:247], v[128:131], a[20:23]
    s_add_u32 m0, s59, 16384
    ds_read_b128 a[212:215], v6 offset:13312
    v_mfma_f32_16x16x32_bf16 v[32:35], v[44:47], v[148:151], 0
    s_nop 2
    v_mfma_f32_16x16x32_bf16 a[24:27], a[248:251], v[128:131], a[24:27]
    buffer_load_dwordx4 v7, s[28:31], s57 offen offset:0 sc1 lds
    v_mfma_f32_16x16x32_bf16 a[56:59], a[248:251], v[132:135], a[56:59]
    ds_read_b128 a[216:219], v6 offset:14336
    s_nop 0
    v_mfma_f32_16x16x32_bf16 a[60:63], a[252:255], v[132:135], a[60:63]
    ds_read_b128 a[220:223], v6 offset:15360
    v_max_f32 v8, v28, v32
    v_cmp_nge_f32 vcc, s66, v8
    v_mfma_f32_16x16x32_bf16 a[28:31], a[252:255], v[128:131], a[28:31]
    s_waitcnt lgkmcnt(4)
    s_cbranch_vccnz m_stub103
m_ret104:
    v_mfma_f32_16x16x32_bf16 v[96:99], a[192:195], a[128:131], v[160:163]
    s_add_u32 s59, s58, s60
    v_exp_f32 v20, v64
    v_mfma_f32_16x16x32_bf16 v[96:99], a[196:199], a[132:135], v[96:99]
    s_add_u32 s58, s58, 32768
    ds_read_b128 a[224:227], v6 offset:24576
    v_add_f32 v12, v12, v28
    v_mfma_f32_16x16x32_bf16 v[96:99], a[200:203], a[136:139], v[96:99]
    s_cmp_ge_u32 s58, 163840
    s_cselect_b32 s58, 0, s58
    ds_read_b128 a[228:231], v6 offset:25600
    v_exp_f32 v21, v65
    v_mfma_f32_16x16x32_bf16 v[96:99], a[204:207], a[140:143], v[96:99]
    s_bitcmp1_b64 s[62:63], s64
    s_cselect_b32 s66, -1.0, s65
    ds_read_b128 a[232:235], v6 offset:26624
    v_mfma_f32_16x16x32_bf16 v[104:107], a[204:207], a[156:159], v[168:171]
    buffer_load_dwordx4 v7, s[28:31], s57 offen offset:1024 sc1 lds
    v_mfma_f32_16x16x32_bf16 v[104:107], a[200:203], a[152:155], v[104:107]
    s_add_u32 s64, s64, 1
    ds_read_b128 a[236:239], v6 offset:27648
    v_cvt_pk_bf16_f32 v128, v20, v21
    v_mfma_f32_16x16x32_bf16 v[104:107], a[196:199], a[148:151], v[104:107]
    ds_read_b128 a[240:243], v6 offset:28672
    v_exp_f32 v22, v66
    v_mfma_f32_16x16x32_bf16 v[104:107], a[192:195], a[144:147], v[104:107]
    s_waitcnt lgkmcnt(5)
    ds_read_b128 a[244:247], v6 offset:29696
    v_add_f32 v13, v13, v32
    v_mfma_f32_16x16x32_bf16 v[108:111], a[208:211], a[144:147], v[172:175]
    ds_read_b128 a[248:251], v6 offset:30720
    v_exp_f32 v23, v67
    v_mfma_f32_16x16x32_bf16 v[108:111], a[212:215], a[148:151], v[108:111]
    buffer_load_dwordx4 v7, s[28:31], s57 offen offset:2048 sc1 lds
    v_mfma_f32_16x16x32_bf16 v[108:111], a[216:219], a[152:155], v[108:111]
    ds_read_b128 a[252:255], v6 offset:31744
    v_cvt_pk_bf16_f32 v129, v22, v23
    v_mfma_f32_16x16x32_bf16 v[108:111], a[220:223], a[156:159], v[108:111]
    v_exp_f32 v24, v68
    v_mfma_f32_16x16x32_bf16 v[100:103], a[220:223], a[140:143], v[164:167]
    v_exp_f32 v25, v69
    v_mfma_f32_16x16x32_bf16 v[100:103], a[216:219], a[136:139], v[100:103]
    buffer_load_dwordx4 v7, s[28:31], s57 offen offset:3072 sc1 lds
    v_mfma_f32_16x16x32_bf16 v[100:103], a[212:215], a[132:135], v[100:103]
    s_add_u32 s57, s57, 16384
    v_exp_f32 v26, v70
    v_cvt_pk_bf16_f32 v130, v24, v25
    v_mfma_f32_16x16x32_bf16 v[100:103], a[208:211], a[128:131], v[100:103]
    s_waitcnt vmcnt(24) lgkmcnt(0)
    v_add_u32 v6, s58, v2
    v_exp_f32 v27, v71
    v_mfma_f32_16x16x32_bf16 a[0:3], a[224:227], v[144:147], a[0:3]
    s_barrier
    v_mfma_f32_16x16x32_bf16 a[32:35], a[224:227], v[148:151], a[32:35]
    ds_read_b128 a[192:195], v6 offset:0
    v_cvt_pk_bf16_f32 v131, v26, v27
    v_mfma_f32_16x16x32_bf16 a[36:39], a[228:231], v[148:151], a[36:39]
    v_exp_f32 v20, v72
    v_mfma_f32_16x16x32_bf16 v[28:31], v[44:47], v[128:131], 0
    v_exp_f32 v21, v73
    v_mfma_f32_16x16x32_bf16 a[4:7], a[228:231], v[144:147], a[4:7]
    ds_read_b128 a[196:199], v6 offset:1024
    v_cvt_pk_bf16_f32 v132, v20, v21
    v_mfma_f32_16x16x32_bf16 a[8:11], a[232:235], v[144:147], a[8:11]
    v_exp_f32 v22, v74
    v_mfma_f32_16x16x32_bf16 a[40:43], a[232:235], v[148:151], a[40:43]
    ds_read_b128 a[200:203], v6 offset:2048
    v_exp_f32 v23, v75
    v_mfma_f32_16x16x32_bf16 a[44:47], a[236:239], v[148:151], a[44:47]
    v_exp_f32 v24, v76
    v_mfma_f32_16x16x32_bf16 a[12:15], a[236:239], v[144:147], a[12:15]
    ds_read_b128 a[204:207], v6 offset:3072
    v_cvt_pk_bf16_f32 v133, v22, v23
    v_mfma_f32_16x16x32_bf16 a[16:19], a[240:243], v[144:147], a[16:19]
    v_exp_f32 v25, v77
    v_mfma_f32_16x16x32_bf16 a[48:51], a[240:243], v[148:151], a[48:51]
    v_exp_f32 v26, v78
    v_cvt_pk_bf16_f32 v134, v24, v25
    v_mfma_f32_16x16x32_bf16 a[52:55], a[244:247], v[148:151], a[52:55]
    v_exp_f32 v27, v79
    v_mfma_f32_16x16x32_bf16 a[20:23], a[244:247], v[144:147], a[20:23]
    ds_read_b128 a[208:211], v6 offset:4096
    v_cvt_pk_bf16_f32 v135, v26, v27
    s_nop 1
    v_mfma_f32_16x16x32_bf16 v[32:35], v[44:47], v[132:135], 0
    s_nop 2
    v_mfma_f32_16x16x32_bf16 a[24:27], a[248:251], v[144:147], a[24:27]
    ds_read_b128 a[212:215], v6 offset:5120
    s_nop 0
    v_mfma_f32_16x16x32_bf16 a[56:59], a[248:251], v[148:151], a[56:59]
    ds_read_b128 a[216:219], v6 offset:6144
    v_max_f32 v8, v28, v32
    v_mfma_f32_16x16x32_bf16 a[60:63], a[252:255], v[148:151], a[60:63]
    ds_read_b128 a[220:223], v6 offset:7168
    v_cmp_nge_f32 vcc, s66, v8
    v_mfma_f32_16x16x32_bf16 a[28:31], a[252:255], v[144:147], a[28:31]
    s_waitcnt lgkmcnt(4)
    s_cbranch_vccz m_single101
    v_cmp_lt_f32 vcc, s65, v8
    s_cmp_lg_u32 s64, s70
    s_cbranch_scc1 m_e106
    v_add_f32 v160, v160, v16
    v_mov_b32 v164, v9
    v_add_f32 v172, v172, v16
    v_add_f32 v161, v161, v17
    v_mov_b32 v165, v9
    v_add_f32 v173, v173, v17
    v_add_f32 v162, v162, v18
    v_mov_b32 v166, v9
    v_add_f32 v174, v174, v18
    v_add_f32 v163, v163, v19
    v_mov_b32 v167, v9
    v_add_f32 v175, v175, v19
    s_nop 0
m_e106:
    s_cmp_lg_u32 s64, s71
    s_cbranch_scc1 m_e107
    v_mov_b32 v160, v9
    v_mov_b32 v168, v9
    v_mov_b32 v172, v9
    v_mov_b32 v161, v9
    v_mov_b32 v169, v9
    v_mov_b32 v173, v9
    v_mov_b32 v162, v9
    v_mov_b32 v170, v9
    v_mov_b32 v174, v9
    v_mov_b32 v163, v9
    v_mov_b32 v171, v9
    v_mov_b32 v175, v9
    s_nop 0
m_e107:
    s_cmp_lg_u32 s64, s53
    s_cbranch_scc1 m_e110
    s_cmp_lg_u32 s16, 0
    s_cbranch_scc1 m_np111
    v_mov_b32 v60, s4
    v_mov_b32 v61, s5
    s_add_u32 s90, s101, 117440512
    s_mov_b64 exec, 1
    buffer_store_dwordx2 v[60:61], off, s[8:11], s90 sc1
    s_mov_b64 exec, -1
m_np111:
    s_mov_b32 s101, -1
m_e110:
    s_cmp_gt_u32 s64, 24
    s_cbranch_scc1 m_e108
    s_cmp_lg_u32 s64, 8
    s_cbranch_scc1 m_e112
    s_lshr_b32 s90, s32, 1
    s_lshl_b32 s90, s90, 7
    s_add_u32 s90, s90, 117440600
    v_min_u32 v0, 1, v1
    v_lshlrev_b32 v0, 5, v0
    buffer_load_dwordx2 v[4:5], v0, s[8:11], s90 offen sc1
    s_cmp_eq_u32 s17, -1
    s_cbranch_scc1 m_e108
    s_cmp_lg_u32 s16, 0
    s_cbranch_scc1 m_np113
    v_mov_b32 v60, s4
    v_mov_b32 v61, s5
    s_add_u32 s90, s17, 117440512
    s_mov_b64 exec, 1
    buffer_store_dwordx2 v[60:61], off, s[8:11], s90 sc1
    s_mov_b64 exec, -1
m_np113:
    s_branch m_e108
m_e112:
    s_cmp_lg_u32 s64, 16
    s_cbranch_scc1 m_e114
    s_waitcnt vmcnt(18)
    s_mov_b32 s3, 1048576
m_spin115:
    v_cmp_ne_u64 s[76:77], s[4:5], v[4:5]
    s_nop 3
    s_cmp_eq_u64 s[76:77], 0
    s_cbranch_scc1 m_e108
    s_sub_u32 s3, s3, 1
    s_cbranch_scc1 m_e108
    s_sleep 32
    s_lshr_b32 s90, s32, 1
    s_lshl_b32 s90, s90, 7
    s_add_u32 s90, s90, 117440600
    v_min_u32 v0, 1, v1
    v_lshlrev_b32 v0, 5, v0
    buffer_load_dwordx2 v[4:5], v0, s[8:11], s90 offen sc1
    s_waitcnt vmcnt(0)
    s_branch m_spin115
    s_branch m_e108
m_e114:
    s_cmp_lg_u32 s64, 20
    s_cbranch_scc1 m_e116
    buffer_load_dwordx2 v[4:5], v10, s[8:11], 0 offen sc1
    s_mov_b32 s44, s48
    s_mov_b32 s45, s49
    s_mov_b32 s46, 8388608
    s_lshl_b32 s90, s2, 2
    s_add_u32 s90, s90, s16
    s_lshl_b32 s90, s90, 13
    v_lshlrev_b32 v62, 7, v1
    buffer_load_dword v255, v62, s[44:47], s90 offen
    s_branch m_e108
m_e116:
    s_cmp_lg_u32 s64, 24
    s_cbranch_scc1 m_e117
    s_mov_b32 s44, s50
    s_mov_b32 s45, s51
    s_mov_b32 s46, 2097152
    s_lshl_b32 s90, s2, 2
    s_add_u32 s90, s90, s16
    s_lshl_b32 s90, s90, 13
    v_lshlrev_b32 v62, 7, v1
    buffer_load_dword v255, v62, s[44:47], s90 offen
    s_waitcnt vmcnt(18)
    s_mov_b32 s3, 1048576
m_spin118:
    v_cmp_ne_u64 s[76:77], s[4:5], v[4:5]
    s_nop 3
    s_cmp_eq_u64 s[76:77], 0
    s_cbranch_scc1 m_e108
    s_sub_u32 s3, s3, 1
    s_cbranch_scc1 m_e108
    s_sleep 32
    buffer_load_dwordx2 v[4:5], v10, s[8:11], 0 offen sc1
    s_waitcnt vmcnt(0)
    s_branch m_spin118
    s_branch m_e108
m_e117:
m_e108:
    s_cbranch_vccnz m_rc119
m_sp105:
    s_cmp_lg_u32 s64, s72
    s_cbranch_scc1 m_single101
m_singlex102:
    s_bfe_u32 s95, s2, 0x10002
    s_and_b32 s90, s2, 7
    s_bitcmp1_b32 0x63, s90
    s_cselect_b32 s96, s33, s34
    s_sub_u32 s96, s96, 1
    s_and_b32 s90, s2, 1
    s_lshl_b32 s90, s90, 2
    s_bfe_u32 s91, s2, 0x20003
    s_add_u32 s97, s90, s91
    v_and_b32 v10, 31, v1
    v_lshlrev_b32 v10, 3, v10
    s_lshl_b32 s52, s96, 8
    s_add_u32 s52, s52, 117448704
    buffer_load_dwordx2 v[4:5], v10, s[8:11], s52 offen sc1
    ds_read_b128 a[224:227], v6 offset:16384
    ds_read_b128 a[228:231], v6 offset:17408
    ds_read_b128 a[232:235], v6 offset:18432
    ds_read_b128 a[236:239], v6 offset:19456
    ds_read_b128 a[240:243], v6 offset:20480
    ds_read_b128 a[244:247], v6 offset:21504
    ds_read_b128 a[248:251], v6 offset:22528
    ds_read_b128 a[252:255], v6 offset:23552
    s_waitcnt lgkmcnt(0)
    v_mfma_f32_16x16x32_bf16 a[0:3], a[224:227], v[128:131], a[0:3]
    buffer_load_dwordx4 v[192:195], v2, s[8:11], s83 offen offset:0 sc1
    v_exp_f32 v20, v96
    v_mfma_f32_16x16x32_bf16 a[32:35], a[224:227], v[132:135], a[32:35]
    v_exp_f32 v21, v97
    v_exp_f32 v22, v98
    v_mfma_f32_16x16x32_bf16 a[36:39], a[228:231], v[132:135], a[36:39]
    buffer_load_dwordx4 v[196:199], v2, s[8:11], s83 offen offset:1024 sc1
    v_cvt_pk_bf16_f32 v144, v20, v21
    v_add_f32 v12, v12, v28
    v_mfma_f32_16x16x32_bf16 a[4:7], a[228:231], v[128:131], a[4:7]
    v_exp_f32 v23, v99
    v_exp_f32 v24, v100
    v_cvt_pk_bf16_f32 v145, v22, v23
    v_mfma_f32_16x16x32_bf16 a[8:11], a[232:235], v[128:131], a[8:11]
    buffer_load_dwordx4 v[200:203], v2, s[8:11], s83 offen offset:2048 sc1
    v_exp_f32 v25, v101
    v_mfma_f32_16x16x32_bf16 a[40:43], a[232:235], v[132:135], a[40:43]
    v_exp_f32 v26, v102
    v_cvt_pk_bf16_f32 v146, v24, v25
    v_add_f32 v13, v13, v32
    v_mfma_f32_16x16x32_bf16 a[44:47], a[236:239], v[132:135], a[44:47]
    buffer_load_dwordx4 v[204:207], v2, s[8:11], s83 offen offset:3072 sc1
    v_exp_f32 v27, v103
    v_mfma_f32_16x16x32_bf16 a[12:15], a[236:239], v[128:131], a[12:15]
    v_exp_f32 v20, v104
    v_cvt_pk_bf16_f32 v147, v26, v27
    v_mfma_f32_16x16x32_bf16 a[16:19], a[240:243], v[128:131], a[16:19]
    buffer_load_dwordx4 v[212:215], v2, s[8:11], s84 offen offset:0 sc1
    v_exp_f32 v21, v105
    v_mfma_f32_16x16x32_bf16 v[28:31], v[44:47], v[144:147], 0
    v_exp_f32 v22, v106
    v_cvt_pk_bf16_f32 v148, v20, v21
    v_exp_f32 v23, v107
    v_mfma_f32_16x16x32_bf16 a[48:51], a[240:243], v[132:135], a[48:51]
    v_exp_f32 v24, v108
    v_cvt_pk_bf16_f32 v149, v22, v23
    v_exp_f32 v25, v109
    v_mfma_f32_16x16x32_bf16 a[52:55], a[244:247], v[132:135], a[52:55]
    buffer_load_dwordx4 v[216:219], v2, s[8:11], s84 offen offset:1024 sc1
    v_exp_f32 v26, v110
    v_mfma_f32_16x16x32_bf16 a[20:23], a[244:247], v[128:131], a[20:23]
    v_cvt_pk_bf16_f32 v150, v24, v25
    v_exp_f32 v27, v111
    s_nop 0
    v_cvt_pk_bf16_f32 v151, v26, v27
    s_nop 1
    v_mfma_f32_16x16x32_bf16 v[32:35], v[44:47], v[148:151], 0
    s_nop 2
    v_mfma_f32_16x16x32_bf16 a[24:27], a[248:251], v[128:131], a[24:27]
    buffer_load_dwordx4 v[220:223], v2, s[8:11], s84 offen offset:2048 sc1
    v_mfma_f32_16x16x32_bf16 a[56:59], a[248:251], v[132:135], a[56:59]
    s_nop 2
    v_mfma_f32_16x16x32_bf16 a[60:63], a[252:255], v[132:135], a[60:63]
    v_max_f32 v8, v28, v32
    v_cmp_nge_f32 vcc, s65, v8
    v_mfma_f32_16x16x32_bf16 a[28:31], a[252:255], v[128:131], a[28:31]
    s_cbranch_vccnz m_stub120
m_ret121:
    s_nop 1
    s_cmp_ge_u32 s16, 2
    s_cbranch_scc1 m_xb122
    s_waitcnt vmcnt(24)
    s_barrier
m_xb122:
    ds_read_b128 a[224:227], v6 offset:24576
    ds_read_b128 a[228:231], v6 offset:25600
    ds_read_b128 a[232:235], v6 offset:26624
    ds_read_b128 a[236:239], v6 offset:27648
    ds_read_b128 a[240:243], v6 offset:28672
    ds_read_b128 a[244:247], v6 offset:29696
    ds_read_b128 a[248:251], v6 offset:30720
    ds_read_b128 a[252:255], v6 offset:31744
    s_waitcnt lgkmcnt(0)
    v_mfma_f32_16x16x32_bf16 a[0:3], a[224:227], v[144:147], a[0:3]
    buffer_load_dwordx4 v[224:227], v2, s[8:11], s84 offen offset:3072 sc1
    v_mfma_f32_16x16x32_bf16 a[32:35], a[224:227], v[148:151], a[32:35]
    v_mfma_f32_16x16x32_bf16 a[36:39], a[228:231], v[148:151], a[36:39]
    buffer_load_dwordx4 v[208:211], v2, s[8:11], s85 offen offset:0 sc1
    v_mfma_f32_16x16x32_bf16 a[4:7], a[228:231], v[144:147], a[4:7]
    v_mfma_f32_16x16x32_bf16 a[8:11], a[232:235], v[144:147], a[8:11]
    buffer_load_dwordx4 v[232:235], v2, s[8:11], s86 offen offset:0 sc1
    v_mfma_f32_16x16x32_bf16 a[40:43], a[232:235], v[148:151], a[40:43]
    v_mfma_f32_16x16x32_bf16 a[44:47], a[236:239], v[148:151], a[44:47]
    buffer_load_dwordx4 v[236:239], v2, s[8:11], s86 offen offset:1024 sc1
    v_mfma_f32_16x16x32_bf16 a[12:15], a[236:239], v[144:147], a[12:15]
    v_mfma_f32_16x16x32_bf16 a[16:19], a[240:243], v[144:147], a[16:19]
    buffer_load_dwordx4 v[228:231], v2, s[8:11], s87 offen offset:0 sc1
    v_mfma_f32_16x16x32_bf16 a[48:51], a[240:243], v[148:151], a[48:51]
    v_mfma_f32_16x16x32_bf16 a[52:55], a[244:247], v[148:151], a[52:55]
    buffer_load_dwordx4 v[244:247], v2, s[8:11], s88 offen offset:0 sc1
    v_mfma_f32_16x16x32_bf16 a[20:23], a[244:247], v[144:147], a[20:23]
    v_mfma_f32_16x16x32_bf16 a[24:27], a[248:251], v[144:147], a[24:27]
    buffer_load_dwordx4 v[248:251], v2, s[8:11], s88 offen offset:1024 sc1
    v_mfma_f32_16x16x32_bf16 a[56:59], a[248:251], v[148:151], a[56:59]
    v_mfma_f32_16x16x32_bf16 a[60:63], a[252:255], v[148:151], a[60:63]
    buffer_load_dwordx4 v[240:243], v2, s[8:11], s89 offen offset:0 sc1
    v_mfma_f32_16x16x32_bf16 a[28:31], a[252:255], v[144:147], a[28:31]
    v_add_f32 v20, v12, v28
    v_add_f32 v21, v13, v32
    s_nop 3
    v_rcp_f32 v20, v20
    v_rcp_f32 v21, v21
    s_lshl_b32 s90, s78, 10
    s_add_u32 s90, s90, s82
    s_add_u32 s90, s90, 67108864
    v_accvgpr_read_b32 v48, a0
    v_accvgpr_read_b32 v49, a1
    v_accvgpr_read_b32 v50, a2
    v_accvgpr_read_b32 v51, a3
    v_accvgpr_read_b32 v52, a4
    v_accvgpr_read_b32 v53, a5
    v_accvgpr_read_b32 v54, a6
    v_accvgpr_read_b32 v55, a7
    v_mul_f32 v48, v20, v48
    v_mul_f32 v49, v20, v49
    v_mul_f32 v50, v20, v50
    v_mul_f32 v51, v20, v51
    v_mul_f32 v52, v20, v52
    v_mul_f32 v53, v20, v53
    v_mul_f32 v54, v20, v54
    v_mul_f32 v55, v20, v55
    v_cvt_pk_bf16_f32 v48, v48, v49
    v_cvt_pk_bf16_f32 v49, v50, v51
    v_cvt_pk_bf16_f32 v50, v52, v53
    v_cvt_pk_bf16_f32 v51, v54, v55
    buffer_store_dwordx4 v[48:51], v2, s[8:11], s90 offen offset:0 sc1
    v_accvgpr_read_b32 v56, a32
    v_accvgpr_read_b32 v57, a33
    v_accvgpr_read_b32 v58, a34
    v_accvgpr_read_b32 v59, a35
    v_accvgpr_read_b32 v60, a36
    v_accvgpr_read_b32 v61, a37
    v_accvgpr_read_b32 v62, a38
    v_accvgpr_read_b32 v63, a39
    v_mul_f32 v56, v21, v56
    v_mul_f32 v57, v21, v57
    v_mul_f32 v58, v21, v58
    v_mul_f32 v59, v21, v59
    v_mul_f32 v60, v21, v60
    v_mul_f32 v61, v21, v61
    v_mul_f32 v62, v21, v62
    v_mul_f32 v63, v21, v63
    v_cvt_pk_bf16_f32 v56, v56, v57
    v_cvt_pk_bf16_f32 v57, v58, v59
    v_cvt_pk_bf16_f32 v58, v60, v61
    v_cvt_pk_bf16_f32 v59, v62, v63
    buffer_store_dwordx4 v[56:59], v2, s[8:11], s90 offen offset:1024 sc1
    s_add_u32 s90, s90, 131072
    v_accvgpr_read_b32 v48, a8
    v_accvgpr_read_b32 v49, a9
    v_accvgpr_read_b32 v50, a10
    v_accvgpr_read_b32 v51, a11
    v_accvgpr_read_b32 v52, a12
    v_accvgpr_read_b32 v53, a13
    v_accvgpr_read_b32 v54, a14
    v_accvgpr_read_b32 v55, a15
    v_mul_f32 v48, v20, v48
    v_mul_f32 v49, v20, v49
    v_mul_f32 v50, v20, v50
    v_mul_f32 v51, v20, v51
    v_mul_f32 v52, v20, v52
    v_mul_f32 v53, v20, v53
    v_mul_f32 v54, v20, v54
    v_mul_f32 v55, v20, v55
    v_cvt_pk_bf16_f32 v48, v48, v49
    v_cvt_pk_bf16_f32 v49, v50, v51
    v_cvt_pk_bf16_f32 v50, v52, v53
    v_cvt_pk_bf16_f32 v51, v54, v55
    buffer_store_dwordx4 v[48:51], v2, s[8:11], s90 offen offset:0 sc1
    v_accvgpr_read_b32 v56, a40
    v_accvgpr_read_b32 v57, a41
    v_accvgpr_read_b32 v58, a42
    v_accvgpr_read_b32 v59, a43
    v_accvgpr_read_b32 v60, a44
    v_accvgpr_read_b32 v61, a45
    v_accvgpr_read_b32 v62, a46
    v_accvgpr_read_b32 v63, a47
    v_mul_f32 v56, v21, v56
    v_mul_f32 v57, v21, v57
    v_mul_f32 v58, v21, v58
    v_mul_f32 v59, v21, v59
    v_mul_f32 v60, v21, v60
    v_mul_f32 v61, v21, v61
    v_mul_f32 v62, v21, v62
    v_mul_f32 v63, v21, v63
    v_cvt_pk_bf16_f32 v56, v56, v57
    v_cvt_pk_bf16_f32 v57, v58, v59
    v_cvt_pk_bf16_f32 v58, v60, v61
    v_cvt_pk_bf16_f32 v59, v62, v63
    buffer_store_dwordx4 v[56:59], v2, s[8:11], s90 offen offset:1024 sc1
    s_add_u32 s90, s90, 131072
    v_accvgpr_read_b32 v48, a16
    v_accvgpr_read_b32 v49, a17
    v_accvgpr_read_b32 v50, a18
    v_accvgpr_read_b32 v51, a19
    v_accvgpr_read_b32 v52, a20
    v_accvgpr_read_b32 v53, a21
    v_accvgpr_read_b32 v54, a22
    v_accvgpr_read_b32 v55, a23
    v_mul_f32 v48, v20, v48
    v_mul_f32 v49, v20, v49
    v_mul_f32 v50, v20, v50
    v_mul_f32 v51, v20, v51
    v_mul_f32 v52, v20, v52
    v_mul_f32 v53, v20, v53
    v_mul_f32 v54, v20, v54
    v_mul_f32 v55, v20, v55
    v_cvt_pk_bf16_f32 v48, v48, v49
    v_cvt_pk_bf16_f32 v49, v50, v51
    v_cvt_pk_bf16_f32 v50, v52, v53
    v_cvt_pk_bf16_f32 v51, v54, v55
    buffer_store_dwordx4 v[48:51], v2, s[8:11], s90 offen offset:0 sc1
    v_accvgpr_read_b32 v56, a48
    v_accvgpr_read_b32 v57, a49
    v_accvgpr_read_b32 v58, a50
    v_accvgpr_read_b32 v59, a51
    v_accvgpr_read_b32 v60, a52
    v_accvgpr_read_b32 v61, a53
    v_accvgpr_read_b32 v62, a54
    v_accvgpr_read_b32 v63, a55
    v_mul_f32 v56, v21, v56
    v_mul_f32 v57, v21, v57
    v_mul_f32 v58, v21, v58
    v_mul_f32 v59, v21, v59
    v_mul_f32 v60, v21, v60
    v_mul_f32 v61, v21, v61
    v_mul_f32 v62, v21, v62
    v_mul_f32 v63, v21, v63
    v_cvt_pk_bf16_f32 v56, v56, v57
    v_cvt_pk_bf16_f32 v57, v58, v59
    v_cvt_pk_bf16_f32 v58, v60, v61
    v_cvt_pk_bf16_f32 v59, v62, v63
    buffer_store_dwordx4 v[56:59], v2, s[8:11], s90 offen offset:1024 sc1
    s_add_u32 s90, s90, 131072
    v_accvgpr_read_b32 v48, a24
    v_accvgpr_read_b32 v49, a25
    v_accvgpr_read_b32 v50, a26
    v_accvgpr_read_b32 v51, a27
    v_accvgpr_read_b32 v52, a28
    v_accvgpr_read_b32 v53, a29
    v_accvgpr_read_b32 v54, a30
    v_accvgpr_read_b32 v55, a31
    v_mul_f32 v48, v20, v48
    v_mul_f32 v49, v20, v49
    v_mul_f32 v50, v20, v50
    v_mul_f32 v51, v20, v51
    v_mul_f32 v52, v20, v52
    v_mul_f32 v53, v20, v53
    v_mul_f32 v54, v20, v54
    v_mul_f32 v55, v20, v55
    v_cvt_pk_bf16_f32 v48, v48, v49
    v_cvt_pk_bf16_f32 v49, v50, v51
    v_cvt_pk_bf16_f32 v50, v52, v53
    v_cvt_pk_bf16_f32 v51, v54, v55
    buffer_store_dwordx4 v[48:51], v2, s[8:11], s90 offen offset:0 sc1
    v_accvgpr_read_b32 v56, a56
    v_accvgpr_read_b32 v57, a57
    v_accvgpr_read_b32 v58, a58
    v_accvgpr_read_b32 v59, a59
    v_accvgpr_read_b32 v60, a60
    v_accvgpr_read_b32 v61, a61
    v_accvgpr_read_b32 v62, a62
    v_accvgpr_read_b32 v63, a63
    v_mul_f32 v56, v21, v56
    v_mul_f32 v57, v21, v57
    v_mul_f32 v58, v21, v58
    v_mul_f32 v59, v21, v59
    v_mul_f32 v60, v21, v60
    v_mul_f32 v61, v21, v61
    v_mul_f32 v62, v21, v62
    v_mul_f32 v63, v21, v63
    v_cvt_pk_bf16_f32 v56, v56, v57
    v_cvt_pk_bf16_f32 v57, v58, v59
    v_cvt_pk_bf16_f32 v58, v60, v61
    v_cvt_pk_bf16_f32 v59, v62, v63
    buffer_store_dwordx4 v[56:59], v2, s[8:11], s90 offen offset:1024 sc1
    s_add_u32 s90, s90, 131072
    s_barrier
    s_lshr_b32 s53, s16, 1
    s_and_b32 s40, s16, 1
    s_mul_i32 s90, s95, 5242880
    s_lshl_b32 s57, s97, 8
    s_add_u32 s57, s57, s90
    v_lshrrev_b32 v20, 4, v1
    s_lshl_b32 s90, s16, 4
    v_add_u32 v21, s90, v20
    v_lshlrev_b32 v21, 11, v21
    v_lshlrev_b32 v20, 1, v20
    v_and_b32 v22, 15, v1
    v_xor_b32 v20, v20, v22
    v_xor_b32 v22, 0, v20
    v_lshl_add_u32 v16, v22, 4, v21
    v_xor_b32 v22, 8, v20
    v_lshl_add_u32 v17, v22, 4, v21
    v_add_u32 v17, 7168, v17
    v_xor_b32 v22, 0, v20
    v_lshl_add_u32 v18, v22, 4, v21
    v_add_u32 v18, 14336, v18
    v_xor_b32 v22, 8, v20
    v_lshl_add_u32 v19, v22, 4, v21
    v_add_u32 v19, 21504, v19
    s_mov_b32 s24, s48
    s_mov_b32 s25, s49
    s_mov_b32 s26, 8388608
    s_mov_b32 s38, 268435456
    s_mov_b32 s28, s54
    s_mov_b32 s29, s55
    s_mov_b32 s30, 8388608
    s_lshl_b32 s90, s96, 13
    s_lshl_b32 s91, s40, 12
    s_add_u32 s90, s90, s91
    s_lshl_b32 s91, s53, 17
    s_add_u32 s69, s90, s91
    s_mul_i32 s90, s95, 10485760
    s_add_u32 s56, s69, s90
    s_add_u32 s56, s56, 67108864
    s_add_u32 s69, s69, 83886080
    s_add_u32 m0, s60, 16384
    s_nop 0
    buffer_load_dwordx4 v16, s[24:27], s57 offen offset:0 sc1 lds
    buffer_load_dwordx4 v17, s[24:27], s57 offen offset:1024 sc1 lds
    buffer_load_dwordx4 v18, s[24:27], s57 offen offset:2048 sc1 lds
    buffer_load_dwordx4 v19, s[24:27], s57 offen offset:3072 sc1 lds
    s_add_u32 s57, s57, 131072
    s_add_u32 m0, s60, 49152
    s_nop 0
    buffer_load_dwordx4 v16, s[24:27], s57 offen offset:0 sc1 lds
    buffer_load_dwordx4 v17, s[24:27], s57 offen offset:1024 sc1 lds
    buffer_load_dwordx4 v18, s[24:27], s57 offen offset:2048 sc1 lds
    buffer_load_dwordx4 v19, s[24:27], s57 offen offset:3072 sc1 lds
    s_add_u32 s57, s57, 131072
    s_add_u32 m0, s60, 81920
    s_nop 0
    buffer_load_dwordx4 v16, s[24:27], s57 offen offset:0 sc1 lds
    buffer_load_dwordx4 v17, s[24:27], s57 offen offset:1024 sc1 lds
    buffer_load_dwordx4 v18, s[24:27], s57 offen offset:2048 sc1 lds
    buffer_load_dwordx4 v19, s[24:27], s57 offen offset:3072 sc1 lds
    s_add_u32 s57, s57, 131072
    s_add_u32 m0, s60, 114688
    s_nop 0
    buffer_load_dwordx4 v16, s[24:27], s57 offen offset:0 sc1 lds
    buffer_load_dwordx4 v17, s[24:27], s57 offen offset:1024 sc1 lds
    buffer_load_dwordx4 v18, s[24:27], s57 offen offset:2048 sc1 lds
    buffer_load_dwordx4 v19, s[24:27], s57 offen offset:3072 sc1 lds
    s_add_u32 s57, s57, 131072
    s_waitcnt vmcnt(39)
    v_cmp_ne_u64 s[76:77], s[4:5], v[4:5]
    s_mul_i32 s91, s95, 20
    s_nop 2
    s_lshr_b32 s90, s76, s91
    s_ff1_i32_b32 s90, s90
    s_lshl_b32 s68, s90, 1
    s_mul_i32 s91, s95, 0
    s_sub_i32 s68, s68, s91
    s_cmp_lt_i32 s90, 0
    s_cselect_b32 s68, 1000, s68
    s_mov_b32 s99, 0
    s_cmp_gt_i32 s68, 4
    s_cbranch_scc0 m_x1123
    s_mov_b32 s99, 1
    s_add_u32 m0, s60, 0
    s_nop 0
    buffer_load_dwordx4 v2, s[36:39], s56 offen offset:0 sc1 lds
    buffer_load_dwordx4 v2, s[36:39], s56 offen offset:1024 sc1 lds
    buffer_load_dwordx4 v2, s[36:39], s56 offen offset:2048 sc1 lds
    buffer_load_dwordx4 v2, s[36:39], s56 offen offset:3072 sc1 lds
    s_add_u32 s56, s56, 262144
    s_add_u32 m0, s60, 32768
    s_nop 0
    buffer_load_dwordx4 v2, s[36:39], s56 offen offset:0 sc1 lds
    buffer_load_dwordx4 v2, s[36:39], s56 offen offset:1024 sc1 lds
    buffer_load_dwordx4 v2, s[36:39], s56 offen offset:2048 sc1 lds
    buffer_load_dwordx4 v2, s[36:39], s56 offen offset:3072 sc1 lds
    s_add_u32 s56, s56, 262144
    s_add_u32 m0, s60, 65536
    s_nop 0
    buffer_load_dwordx4 v2, s[36:39], s56 offen offset:0 sc1 lds
    buffer_load_dwordx4 v2, s[36:39], s56 offen offset:1024 sc1 lds
    buffer_load_dwordx4 v2, s[36:39], s56 offen offset:2048 sc1 lds
    buffer_load_dwordx4 v2, s[36:39], s56 offen offset:3072 sc1 lds
    s_add_u32 s56, s56, 262144
    s_add_u32 m0, s60, 98304
    s_nop 0
    buffer_load_dwordx4 v2, s[36:39], s56 offen offset:0 sc1 lds
    buffer_load_dwordx4 v2, s[36:39], s56 offen offset:1024 sc1 lds
    buffer_load_dwordx4 v2, s[36:39], s56 offen offset:2048 sc1 lds
    buffer_load_dwordx4 v2, s[36:39], s56 offen offset:3072 sc1 lds
    s_add_u32 s56, s56, 262144
    s_add_u32 m0, s60, 131072
    s_nop 0
    buffer_load_dwordx4 v2, s[36:39], s56 offen offset:0 sc1 lds
    buffer_load_dwordx4 v2, s[36:39], s56 offen offset:1024 sc1 lds
    buffer_load_dwordx4 v2, s[36:39], s56 offen offset:2048 sc1 lds
    buffer_load_dwordx4 v2, s[36:39], s56 offen offset:3072 sc1 lds
    s_add_u32 s56, s56, 262144
m_x1123:
    s_lshl_b32 s90, s53, 12
    v_add_u32 v6, s90, v2
    v_lshrrev_b32 v48, 2, v1
    v_lshlrev_b32 v48, 8, v48
    v_and_b32 v49, 3, v1
    v_lshl_add_u32 v48, v49, 3, v48
    v_add_u32 v48, 16384, v48
    v_bfe_u32 v49, v1, 2, 3
    s_lshl_b32 s90, s40, 2
    v_xor_b32 v49, s90, v49
    v_xor_b32 v50, 0, v49
    v_lshl_add_u32 v12, v50, 5, v48
    v_xor_b32 v50, 1, v49
    v_lshl_add_u32 v13, v50, 5, v48
    v_xor_b32 v50, 2, v49
    v_lshl_add_u32 v14, v50, 5, v48
    v_xor_b32 v50, 3, v49
    v_lshl_add_u32 v15, v50, 5, v48
    v_and_b32 v48, 15, v1
    v_lshlrev_b32 v48, 12, v48
    v_lshlrev_b32 v48, s95, v48
    v_bfe_u32 v49, v1, 4, 1
    v_lshl_add_u32 v48, v49, 5, v48
    v_lshrrev_b32 v49, 5, v1
    v_lshl_add_u32 v7, v49, 4, v48
    s_lshl_b32 s90, s96, 3
    s_lshl_b32 s91, s53, 2
    s_add_u32 s90, s90, s91
    s_lshl_b32 s91, s90, 16
    s_add_u32 s91, s91, 2048
    s_and_b32 s92, s90, 63
    s_lshl_b32 s92, s92, 17
    s_lshr_b32 s93, s90, 6
    s_lshl_b32 s93, s93, 12
    s_add_u32 s92, s92, s93
    s_cmp_eq_u32 s95, 1
    s_cselect_b32 s71, s92, s91
    s_lshl_b32 s72, 0x10000, s95
    s_lshl_b32 s92, s97, 8
    s_lshl_b32 s93, s40, 7
    s_add_u32 s71, s71, s92
    s_add_u32 s71, s71, s93
    v_mov_b64 v[64:65], 0
    v_mov_b64 v[66:67], 0
    v_mov_b64 v[68:69], 0
    v_mov_b64 v[70:71], 0
    v_mov_b64 v[72:73], 0
    v_mov_b64 v[74:75], 0
    v_mov_b64 v[76:77], 0
    v_mov_b64 v[78:79], 0
    v_mov_b64 v[80:81], 0
    v_mov_b64 v[82:83], 0
    v_mov_b64 v[84:85], 0
    v_mov_b64 v[86:87], 0
    v_mov_b64 v[88:89], 0
    v_mov_b64 v[90:91], 0
    v_mov_b64 v[92:93], 0
    v_mov_b64 v[94:95], 0
    v_mov_b64 v[96:97], 0
    v_mov_b64 v[98:99], 0
    v_mov_b64 v[100:101], 0
    v_mov_b64 v[102:103], 0
    v_mov_b64 v[104:105], 0
    v_mov_b64 v[106:107], 0
    v_mov_b64 v[108:109], 0
    v_mov_b64 v[110:111], 0
    v_mov_b64 v[112:113], 0
    v_mov_b64 v[114:115], 0
    v_mov_b64 v[116:117], 0
    v_mov_b64 v[118:119], 0
    v_mov_b64 v[120:121], 0
    v_mov_b64 v[122:123], 0
    v_mov_b64 v[124:125], 0
    v_mov_b64 v[126:127], 0
    v_and_b32 v48, 15, v1
    v_lshrrev_b32 v49, 4, v1
    v_lshlrev_b32 v49, 2, v49
    v_sub_u32 v48, v48, v49
    v_cmp_ge_i32 vcc, -9, v48
    v_subrev_u32 v50, 0, v48
    v_cmp_ge_u32 s[76:77], 7, v50
    s_nop 0
    v_cndmask_b32 v128, v9, 0, vcc
    v_cndmask_b32 v132, v9, 0, s[76:77]
    v_cmp_ge_i32 vcc, -8, v48
    v_subrev_u32 v50, 1, v48
    v_cmp_ge_u32 s[76:77], 7, v50
    s_nop 0
    v_cndmask_b32 v129, v9, 0, vcc
    v_cndmask_b32 v133, v9, 0, s[76:77]
    v_cmp_ge_i32 vcc, -7, v48
    v_subrev_u32 v50, 2, v48
    v_cmp_ge_u32 s[76:77], 7, v50
    s_nop 0
    v_cndmask_b32 v130, v9, 0, vcc
    v_cndmask_b32 v134, v9, 0, s[76:77]
    v_cmp_ge_i32 vcc, -6, v48
    v_subrev_u32 v50, 3, v48
    v_cmp_ge_u32 s[76:77], 7, v50
    s_nop 0
    v_cndmask_b32 v131, v9, 0, vcc
    v_cndmask_b32 v135, v9, 0, s[76:77]
    s_cmp_eq_u32 s81, 0
    s_cselect_b64 vcc, -1, 0
    s_nop 0
    v_cndmask_b32 v136, v128, v9, vcc
    v_cndmask_b32 v137, v129, v9, vcc
    v_cndmask_b32 v138, v130, v9, vcc
    v_cndmask_b32 v139, v131, v9, vcc
    s_lshl_b32 s90, s80, 10
    s_lshr_b32 s91, s2, 3
    s_lshl_b32 s91, s91, 17
    s_add_u32 s90, s90, s91
    s_add_u32 s80, s90, 83886080
    s_add_u32 s59, s60, 131072
    s_mov_b32 s58, 0
    s_mov_b32 s100, 32768
    s_mov_b32 s64, 0
    s_mov_b32 s67, 0
    s_waitcnt vmcnt(36)
    s_cmp_eq_u32 s99, 1
    s_cbranch_scc1 m_x2124
    s_waitcnt vmcnt(16)
m_x2124:
    s_barrier
    s_lshl_b32 s91, s33, 5
    s_add_u32 s91, s91, s32
    s_lshl_b32 s91, s91, 3
    s_add_u32 s91, s91, 7936
    s_cmp_lg_u32 s16, 0
    s_cbranch_scc1 m_np126
    v_mov_b32 v60, s4
    v_mov_b32 v61, s5
    s_add_u32 s90, s91, 117440512
    s_mov_b64 exec, 1
    buffer_store_dwordx2 v[60:61], off, s[8:11], s90 sc1
    s_mov_b64 exec, -1
m_np126:
    s_cmp_eq_u32 s101, -1
    s_cbranch_scc1 m_pb127
    s_cmp_lg_u32 s16, 0
    s_cbranch_scc1 m_np128
    v_mov_b32 v60, s4
    v_mov_b32 v61, s5
    s_add_u32 s90, s101, 117440512
    s_mov_b64 exec, 1
    buffer_store_dwordx2 v[60:61], off, s[8:11], s90 sc1
    s_mov_b64 exec, -1
m_np128:
m_pb127:
    s_cmp_eq_u32 s99, 1
    s_cbranch_scc1 m_x3125
    s_mov_b32 s3, 1048576
m_spin130:
    buffer_load_dwordx2 v[4:5], v10, s[8:11], s52 offen sc1
    s_waitcnt vmcnt(0)
    v_cmp_ne_u64 s[76:77], s[4:5], v[4:5]
    s_mul_i32 s91, s95, 20
    s_nop 2
    s_lshr_b32 s90, s76, s91
    s_ff1_i32_b32 s90, s90
    s_lshl_b32 s68, s90, 1
    s_mul_i32 s91, s95, 0
    s_sub_i32 s68, s68, s91
    s_cmp_lt_i32 s90, 0
    s_cselect_b32 s68, 1000, s68
    s_cmp_gt_i32 s68, 4
    s_cbranch_scc1 m_ok131
    s_sub_u32 s3, s3, 1
    s_cbranch_scc1 m_ok131
    s_sleep 4
    s_branch m_spin130
m_ok131:
    s_add_u32 m0, s60, 0
    s_nop 0
    buffer_load_dwordx4 v2, s[36:39], s56 offen offset:0 sc1 lds
    buffer_load_dwordx4 v2, s[36:39], s56 offen offset:1024 sc1 lds
    buffer_load_dwordx4 v2, s[36:39], s56 offen offset:2048 sc1 lds
    buffer_load_dwordx4 v2, s[36:39], s56 offen offset:3072 sc1 lds
    s_add_u32 s56, s56, 262144
    s_add_u32 m0, s60, 32768
    s_nop 0
    buffer_load_dwordx4 v2, s[36:39], s56 offen offset:0 sc1 lds
    buffer_load_dwordx4 v2, s[36:39], s56 offen offset:1024 sc1 lds
    buffer_load_dwordx4 v2, s[36:39], s56 offen offset:2048 sc1 lds
    buffer_load_dwordx4 v2, s[36:39], s56 offen offset:3072 sc1 lds
    s_add_u32 s56, s56, 262144
    s_add_u32 m0, s60, 65536
    s_nop 0
    buffer_load_dwordx4 v2, s[36:39], s56 offen offset:0 sc1 lds
    buffer_load_dwordx4 v2, s[36:39], s56 offen offset:1024 sc1 lds
    buffer_load_dwordx4 v2, s[36:39], s56 offen offset:2048 sc1 lds
    buffer_load_dwordx4 v2, s[36:39], s56 offen offset:3072 sc1 lds
    s_add_u32 s56, s56, 262144
    s_add_u32 m0, s60, 98304
    s_nop 0
    buffer_load_dwordx4 v2, s[36:39], s56 offen offset:0 sc1 lds
    buffer_load_dwordx4 v2, s[36:39], s56 offen offset:1024 sc1 lds
    buffer_load_dwordx4 v2, s[36:39], s56 offen offset:2048 sc1 lds
    buffer_load_dwordx4 v2, s[36:39], s56 offen offset:3072 sc1 lds
    s_add_u32 s56, s56, 262144
    s_add_u32 m0, s60, 131072
    s_nop 0
    buffer_load_dwordx4 v2, s[36:39], s56 offen offset:0 sc1 lds
    buffer_load_dwordx4 v2, s[36:39], s56 offen offset:1024 sc1 lds
    buffer_load_dwordx4 v2, s[36:39], s56 offen offset:2048 sc1 lds
    buffer_load_dwordx4 v2, s[36:39], s56 offen offset:3072 sc1 lds
    s_add_u32 s56, s56, 262144
    s_waitcnt vmcnt(4)
    s_branch m_x4129
m_x3125:
    s_waitcnt vmcnt(4)
m_x4129:
    s_barrier
    ds_read_b128 a[0:3], v6 offset:0
    ds_read_b64_tr_b16 a[16:17], v12 offset:0
    ds_read_b64_tr_b16 a[18:19], v12 offset:4096
    ds_read_b128 a[4:7], v6 offset:1024
    ds_read_b128 a[8:11], v6 offset:2048
    ds_read_b128 a[12:15], v6 offset:3072
    ds_read_b64_tr_b16 a[20:21], v13 offset:0
    ds_read_b64_tr_b16 a[22:23], v13 offset:4096
    ds_read_b64_tr_b16 a[24:25], v14 offset:0
    ds_read_b64_tr_b16 a[26:27], v14 offset:4096
    ds_read_b64_tr_b16 a[28:29], v15 offset:0
    ds_read_b64_tr_b16 a[30:31], v15 offset:4096
    s_cmp_gt_i32 s68, 5
    s_cbranch_scc0 m_lp137
m_lr138:
    s_waitcnt lgkmcnt(9)
    v_mfma_f32_16x16x32_bf16 v[64:67], a[16:19], a[0:3], v[64:67]
    s_add_u32 m0, s59, 16384
    ds_read_b128 a[32:35], v6 offset:8192
    v_mfma_f32_16x16x32_bf16 v[148:151], v[208:211], v[192:195], v[136:139]
    v_mfma_f32_16x16x32_bf16 v[152:155], v[212:215], v[192:195], v[132:135]
    s_waitcnt lgkmcnt(9)
    v_mfma_f32_16x16x32_bf16 v[72:75], a[16:19], a[4:7], v[72:75]
    ds_read_b64_tr_b16 a[48:49], v12 offset:8192
    buffer_load_dwordx4 v16, s[24:27], s57 offen offset:0 sc1 lds
    v_mfma_f32_16x16x32_bf16 v[156:159], v[212:215], v[196:199], v[128:131]
    s_waitcnt lgkmcnt(9)
    v_mfma_f32_16x16x32_bf16 v[80:83], a[16:19], a[8:11], v[80:83]
    s_add_u32 s59, s58, s60
    ds_read_b64_tr_b16 a[50:51], v12 offset:12288
    v_mfma_f32_16x16x32_bf16 v[160:163], v[216:219], v[196:199], v[132:135]
    v_mfma_f32_16x16x32_bf16 v[164:167], v[216:219], v[200:203], v[128:131]
    s_waitcnt lgkmcnt(9)
    v_mfma_f32_16x16x32_bf16 v[88:91], a[16:19], a[12:15], v[88:91]
    s_add_u32 s58, s58, 32768
    ds_read_b128 a[36:39], v6 offset:9216
    v_mfma_f32_16x16x32_bf16 v[168:171], v[220:223], v[200:203], v[132:135]
    v_mfma_f32_16x16x32_bf16 v[172:175], v[220:223], v[204:207], v[128:131]
    s_waitcnt lgkmcnt(8)
    v_mfma_f32_16x16x32_bf16 v[68:71], a[20:23], a[0:3], v[68:71]
    s_cmp_ge_u32 s58, 163840
    ds_read_b128 a[40:43], v6 offset:10240
    v_mfma_f32_16x16x32_bf16 v[176:179], v[224:227], v[204:207], v[132:135]
    s_nop 1
    v_mfma_f32_16x16x32_bf16 v[76:79], a[20:23], a[4:7], v[76:79]
    ds_read_b128 a[44:47], v6 offset:11264
    buffer_load_dwordx4 v17, s[24:27], s57 offen offset:1024 sc1 lds
    s_nop 1
    v_mfma_f32_16x16x32_bf16 v[84:87], a[20:23], a[8:11], v[84:87]
    s_cselect_b32 s66, 4294836224, s100
    ds_read_b64_tr_b16 a[52:53], v13 offset:8192
    s_nop 1
    s_nop 1
    v_mfma_f32_16x16x32_bf16 v[92:95], a[20:23], a[12:15], v[92:95]
    s_cselect_b32 s58, 0, s58
    ds_read_b64_tr_b16 a[54:55], v13 offset:12288
    v_max3_f32 v140, v148, v149, v150
    v_max3_f32 v141, v156, v157, v158
    s_waitcnt lgkmcnt(10)
    v_mfma_f32_16x16x32_bf16 v[96:99], a[24:27], a[0:3], v[96:99]
    ds_read_b64_tr_b16 a[56:57], v14 offset:8192
    v_max3_f32 v142, v164, v165, v166
    v_max3_f32 v143, v172, v173, v174
    v_mfma_f32_16x16x32_bf16 v[104:107], a[24:27], a[4:7], v[104:107]
    ds_read_b64_tr_b16 a[58:59], v14 offset:12288
    buffer_load_dwordx4 v18, s[24:27], s57 offen offset:2048 sc1 lds
    v_max3_f32 v140, v140, v151, v152
    v_mfma_f32_16x16x32_bf16 v[112:115], a[24:27], a[8:11], v[112:115]
    ds_read_b64_tr_b16 a[60:61], v15 offset:8192
    v_max3_f32 v141, v141, v159, v160
    v_max3_f32 v142, v142, v167, v168
    v_mfma_f32_16x16x32_bf16 v[120:123], a[24:27], a[12:15], v[120:123]
    ds_read_b64_tr_b16 a[62:63], v15 offset:12288
    v_max3_f32 v143, v143, v175, v176
    v_max3_f32 v140, v140, v153, v154
    s_waitcnt lgkmcnt(12)
    v_mfma_f32_16x16x32_bf16 v[100:103], a[28:31], a[0:3], v[100:103]
    v_add_u32 v6, s66, v6
    v_add_u32 v12, s66, v12
    v_max3_f32 v141, v141, v161, v162
    v_mfma_f32_16x16x32_bf16 v[108:111], a[28:31], a[4:7], v[108:111]
    buffer_load_dwordx4 v19, s[24:27], s57 offen offset:3072 sc1 lds
    v_max3_f32 v142, v142, v169, v170
    v_mfma_f32_16x16x32_bf16 v[116:119], a[28:31], a[8:11], v[116:119]
    s_add_u32 s57, s57, 131072
    v_add_u32 v13, s66, v13
    v_add_u32 v14, s66, v14
    v_max3_f32 v143, v143, v177, v178
    v_mfma_f32_16x16x32_bf16 v[124:127], a[28:31], a[12:15], v[124:127]
    s_mov_b32 m0, s59
    v_add_u32 v15, s66, v15
    v_max_f32 v140, v140, v155
    s_waitcnt vmcnt(24) lgkmcnt(0)
    v_mfma_f32_16x16x32_bf16 v[64:67], a[48:51], a[32:35], v[64:67]
    s_barrier
    v_max_f32 v141, v141, v163
    v_max_f32 v142, v142, v171
    v_mfma_f32_16x16x32_bf16 v[72:75], a[48:51], a[36:39], v[72:75]
    ds_read_b128 a[0:3], v6 offset:0
    buffer_load_dwordx4 v2, s[36:39], s56 offen offset:0 sc1 lds
    v_max_f32 v143, v143, v179
    v_mfma_f32_16x16x32_bf16 v[80:83], a[48:51], a[40:43], v[80:83]
    ds_read_b64_tr_b16 a[16:17], v12 offset:0
    v_mov_b32 v144, v140
    v_mov_b32 v145, v141
    v_mfma_f32_16x16x32_bf16 v[88:91], a[48:51], a[44:47], v[88:91]
    ds_read_b64_tr_b16 a[18:19], v12 offset:4096
    v_mov_b32 v146, v142
    v_mov_b32 v147, v143
    v_mfma_f32_16x16x32_bf16 v[68:71], a[52:55], a[32:35], v[68:71]
    ds_read_b128 a[4:7], v6 offset:1024
    s_nop 1
    v_permlane32_swap_b32 v140, v144
    v_mfma_f32_16x16x32_bf16 v[76:79], a[52:55], a[36:39], v[76:79]
    ds_read_b128 a[8:11], v6 offset:2048
    buffer_load_dwordx4 v2, s[36:39], s56 offen offset:1024 sc1 lds
    v_permlane32_swap_b32 v141, v145
    v_mfma_f32_16x16x32_bf16 v[84:87], a[52:55], a[40:43], v[84:87]
    ds_read_b128 a[12:15], v6 offset:3072
    v_permlane32_swap_b32 v142, v146
    v_permlane32_swap_b32 v143, v147
    v_mfma_f32_16x16x32_bf16 v[92:95], a[52:55], a[44:47], v[92:95]
    ds_read_b64_tr_b16 a[20:21], v13 offset:0
    s_nop 1
    v_max_f32 v140, v140, v144
    v_mfma_f32_16x16x32_bf16 v[96:99], a[56:59], a[32:35], v[96:99]
    ds_read_b64_tr_b16 a[22:23], v13 offset:4096
    v_max_f32 v141, v141, v145
    v_max_f32 v142, v142, v146
    v_mfma_f32_16x16x32_bf16 v[104:107], a[56:59], a[36:39], v[104:107]
    ds_read_b64_tr_b16 a[24:25], v14 offset:0
    buffer_load_dwordx4 v2, s[36:39], s56 offen offset:2048 sc1 lds
    v_max_f32 v143, v143, v147
    v_mfma_f32_16x16x32_bf16 v[112:115], a[56:59], a[40:43], v[112:115]
    ds_read_b64_tr_b16 a[26:27], v14 offset:4096
    v_mov_b32 v144, v140
    v_mov_b32 v145, v141
    v_mfma_f32_16x16x32_bf16 v[120:123], a[56:59], a[44:47], v[120:123]
    ds_read_b64_tr_b16 a[28:29], v15 offset:0
    v_mov_b32 v146, v142
    v_mov_b32 v147, v143
    v_mfma_f32_16x16x32_bf16 v[100:103], a[60:63], a[32:35], v[100:103]
    s_add_u32 s64, s64, 1
    ds_read_b64_tr_b16 a[30:31], v15 offset:4096
    s_nop 1
    v_permlane16_swap_b32 v140, v144
    v_mfma_f32_16x16x32_bf16 v[108:111], a[60:63], a[36:39], v[108:111]
    buffer_load_dwordx4 v2, s[36:39], s56 offen offset:3072 sc1 lds
    v_permlane16_swap_b32 v141, v145
    v_mfma_f32_16x16x32_bf16 v[116:119], a[60:63], a[40:43], v[116:119]
    s_add_u32 s56, s56, 262144
    v_permlane16_swap_b32 v142, v146
    v_permlane16_swap_b32 v143, v147
    v_mfma_f32_16x16x32_bf16 v[124:127], a[60:63], a[44:47], v[124:127]
    s_nop 1
    v_max_f32 v140, v140, v144
    s_cmp_gt_i32 s68, 6
    s_cbranch_scc0 m_lp139
m_lr140:
    s_waitcnt lgkmcnt(9)
    v_mfma_f32_16x16x32_bf16 v[64:67], a[16:19], a[0:3], v[64:67]
    s_add_u32 m0, s59, 16384
    ds_read_b128 a[32:35], v6 offset:8192
    v_max_f32 v141, v141, v145
    v_max_f32 v142, v142, v146
    s_waitcnt lgkmcnt(9)
    v_mfma_f32_16x16x32_bf16 v[72:75], a[16:19], a[4:7], v[72:75]
    ds_read_b64_tr_b16 a[48:49], v12 offset:8192
    buffer_load_dwordx4 v16, s[24:27], s57 offen offset:0 sc1 lds
    v_max_f32 v143, v143, v147
    s_waitcnt lgkmcnt(9)
    v_mfma_f32_16x16x32_bf16 v[80:83], a[16:19], a[8:11], v[80:83]
    s_add_u32 s59, s58, s60
    ds_read_b64_tr_b16 a[50:51], v12 offset:12288
    v_sub_f32 v148, v148, v140
    v_sub_f32 v149, v149, v140
    s_waitcnt lgkmcnt(9)
    v_mfma_f32_16x16x32_bf16 v[88:91], a[16:19], a[12:15], v[88:91]
    s_add_u32 s58, s58, 32768
    ds_read_b128 a[36:39], v6 offset:9216
    v_sub_f32 v150, v150, v140
    v_sub_f32 v151, v151, v140
    s_waitcnt lgkmcnt(8)
    v_mfma_f32_16x16x32_bf16 v[68:71], a[20:23], a[0:3], v[68:71]
    s_cmp_ge_u32 s58, 163840
    ds_read_b128 a[40:43], v6 offset:10240
    v_sub_f32 v152, v152, v140
    v_sub_f32 v153, v153, v140
    v_mfma_f32_16x16x32_bf16 v[76:79], a[20:23], a[4:7], v[76:79]
    ds_read_b128 a[44:47], v6 offset:11264
    buffer_load_dwordx4 v17, s[24:27], s57 offen offset:1024 sc1 lds
    v_sub_f32 v154, v154, v140
    v_mfma_f32_16x16x32_bf16 v[84:87], a[20:23], a[8:11], v[84:87]
    s_cselect_b32 s66, 4294836224, s100
    ds_read_b64_tr_b16 a[52:53], v13 offset:8192
    v_sub_f32 v155, v155, v140
    v_sub_f32 v156, v156, v141
    v_mfma_f32_16x16x32_bf16 v[92:95], a[20:23], a[12:15], v[92:95]
    s_cselect_b32 s58, 0, s58
    ds_read_b64_tr_b16 a[54:55], v13 offset:12288
    v_sub_f32 v157, v157, v141
    v_sub_f32 v158, v158, v141
    s_waitcnt lgkmcnt(10)
    v_mfma_f32_16x16x32_bf16 v[96:99], a[24:27], a[0:3], v[96:99]
    ds_read_b64_tr_b16 a[56:57], v14 offset:8192
    v_sub_f32 v159, v159, v141
    v_sub_f32 v160, v160, v141
    v_mfma_f32_16x16x32_bf16 v[104:107], a[24:27], a[4:7], v[104:107]
    ds_read_b64_tr_b16 a[58:59], v14 offset:12288
    buffer_load_dwordx4 v18, s[24:27], s57 offen offset:2048 sc1 lds
    v_sub_f32 v161, v161, v141
    v_mfma_f32_16x16x32_bf16 v[112:115], a[24:27], a[8:11], v[112:115]
    ds_read_b64_tr_b16 a[60:61], v15 offset:8192
    v_sub_f32 v162, v162, v141
    v_sub_f32 v163, v163, v141
    v_mfma_f32_16x16x32_bf16 v[120:123], a[24:27], a[12:15], v[120:123]
    ds_read_b64_tr_b16 a[62:63], v15 offset:12288
    v_sub_f32 v164, v164, v142
    v_sub_f32 v165, v165, v142
    s_waitcnt lgkmcnt(12)
    v_mfma_f32_16x16x32_bf16 v[100:103], a[28:31], a[0:3], v[100:103]
    v_add_u32 v6, s66, v6
    v_add_u32 v12, s66, v12
    v_sub_f32 v166, v166, v142
    v_mfma_f32_16x16x32_bf16 v[108:111], a[28:31], a[4:7], v[108:111]
    buffer_load_dwordx4 v19, s[24:27], s57 offen offset:3072 sc1 lds
    v_sub_f32 v167, v167, v142
    v_mfma_f32_16x16x32_bf16 v[116:119], a[28:31], a[8:11], v[116:119]
    s_add_u32 s57, s57, 131072
    v_add_u32 v13, s66, v13
    v_add_u32 v14, s66, v14
    v_sub_f32 v168, v168, v142
    v_mfma_f32_16x16x32_bf16 v[124:127], a[28:31], a[12:15], v[124:127]
    s_mov_b32 m0, s59
    v_add_u32 v15, s66, v15
    v_sub_f32 v169, v169, v142
    s_waitcnt vmcnt(24) lgkmcnt(0)
    v_mfma_f32_16x16x32_bf16 v[64:67], a[48:51], a[32:35], v[64:67]
    s_barrier
    v_sub_f32 v170, v170, v142
    v_sub_f32 v171, v171, v142
    v_mfma_f32_16x16x32_bf16 v[72:75], a[48:51], a[36:39], v[72:75]
    ds_read_b128 a[0:3], v6 offset:0
    buffer_load_dwordx4 v2, s[36:39], s56 offen offset:0 sc1 lds
    v_sub_f32 v172, v172, v143
    v_mfma_f32_16x16x32_bf16 v[80:83], a[48:51], a[40:43], v[80:83]
    ds_read_b64_tr_b16 a[16:17], v12 offset:0
    v_sub_f32 v173, v173, v143
    v_sub_f32 v174, v174, v143
    v_mfma_f32_16x16x32_bf16 v[88:91], a[48:51], a[44:47], v[88:91]
    ds_read_b64_tr_b16 a[18:19], v12 offset:4096
    v_sub_f32 v175, v175, v143
    v_sub_f32 v176, v176, v143
    v_mfma_f32_16x16x32_bf16 v[68:71], a[52:55], a[32:35], v[68:71]
    ds_read_b128 a[4:7], v6 offset:1024
    v_sub_f32 v177, v177, v143
    v_sub_f32 v178, v178, v143
    v_mfma_f32_16x16x32_bf16 v[76:79], a[52:55], a[36:39], v[76:79]
    ds_read_b128 a[8:11], v6 offset:2048
    buffer_load_dwordx4 v2, s[36:39], s56 offen offset:1024 sc1 lds
    v_sub_f32 v179, v179, v143
    v_mfma_f32_16x16x32_bf16 v[84:87], a[52:55], a[40:43], v[84:87]
    ds_read_b128 a[12:15], v6 offset:3072
    v_exp_f32 v148, v148
    v_exp_f32 v149, v149
    v_mfma_f32_16x16x32_bf16 v[92:95], a[52:55], a[44:47], v[92:95]
    ds_read_b64_tr_b16 a[20:21], v13 offset:0
    v_exp_f32 v150, v150
    v_exp_f32 v151, v151
    v_mfma_f32_16x16x32_bf16 v[96:99], a[56:59], a[32:35], v[96:99]
    ds_read_b64_tr_b16 a[22:23], v13 offset:4096
    v_exp_f32 v152, v152
    v_exp_f32 v153, v153
    v_mfma_f32_16x16x32_bf16 v[104:107], a[56:59], a[36:39], v[104:107]
    ds_read_b64_tr_b16 a[24:25], v14 offset:0
    buffer_load_dwordx4 v2, s[36:39], s56 offen offset:2048 sc1 lds
    v_exp_f32 v154, v154
    v_mfma_f32_16x16x32_bf16 v[112:115], a[56:59], a[40:43], v[112:115]
    ds_read_b64_tr_b16 a[26:27], v14 offset:4096
    v_exp_f32 v155, v155
    v_exp_f32 v156, v156
    v_mfma_f32_16x16x32_bf16 v[120:123], a[56:59], a[44:47], v[120:123]
    ds_read_b64_tr_b16 a[28:29], v15 offset:0
    v_exp_f32 v157, v157
    v_exp_f32 v158, v158
    v_mfma_f32_16x16x32_bf16 v[100:103], a[60:63], a[32:35], v[100:103]
    s_add_u32 s64, s64, 1
    ds_read_b64_tr_b16 a[30:31], v15 offset:4096
    v_exp_f32 v159, v159
    v_exp_f32 v160, v160
    v_mfma_f32_16x16x32_bf16 v[108:111], a[60:63], a[36:39], v[108:111]
    buffer_load_dwordx4 v2, s[36:39], s56 offen offset:3072 sc1 lds
    v_exp_f32 v161, v161
    v_mfma_f32_16x16x32_bf16 v[116:119], a[60:63], a[40:43], v[116:119]
    s_add_u32 s56, s56, 262144
    v_exp_f32 v162, v162
    v_exp_f32 v163, v163
    v_mfma_f32_16x16x32_bf16 v[124:127], a[60:63], a[44:47], v[124:127]
    v_exp_f32 v164, v164
    v_exp_f32 v165, v165
    s_cmp_gt_i32 s68, 7
    s_cbranch_scc0 m_lp141
m_lr142:
    s_waitcnt lgkmcnt(9)
    v_mfma_f32_16x16x32_bf16 v[64:67], a[16:19], a[0:3], v[64:67]
    s_add_u32 m0, s59, 16384
    ds_read_b128 a[32:35], v6 offset:8192
    v_exp_f32 v166, v166
    v_exp_f32 v167, v167
    s_waitcnt lgkmcnt(9)
    v_mfma_f32_16x16x32_bf16 v[72:75], a[16:19], a[4:7], v[72:75]
    ds_read_b64_tr_b16 a[48:49], v12 offset:8192
    buffer_load_dwordx4 v16, s[24:27], s57 offen offset:0 sc1 lds
    v_exp_f32 v168, v168
    s_waitcnt lgkmcnt(9)
    v_mfma_f32_16x16x32_bf16 v[80:83], a[16:19], a[8:11], v[80:83]
    s_add_u32 s59, s58, s60
    ds_read_b64_tr_b16 a[50:51], v12 offset:12288
    v_exp_f32 v169, v169
    v_exp_f32 v170, v170
    s_waitcnt lgkmcnt(9)
    v_mfma_f32_16x16x32_bf16 v[88:91], a[16:19], a[12:15], v[88:91]
    s_add_u32 s58, s58, 32768
    ds_read_b128 a[36:39], v6 offset:9216
    v_exp_f32 v171, v171
    v_exp_f32 v172, v172
    s_waitcnt lgkmcnt(8)
    v_mfma_f32_16x16x32_bf16 v[68:71], a[20:23], a[0:3], v[68:71]
    s_cmp_ge_u32 s58, 163840
    ds_read_b128 a[40:43], v6 offset:10240
    v_exp_f32 v173, v173
    v_exp_f32 v174, v174
    v_mfma_f32_16x16x32_bf16 v[76:79], a[20:23], a[4:7], v[76:79]
    ds_read_b128 a[44:47], v6 offset:11264
    buffer_load_dwordx4 v17, s[24:27], s57 offen offset:1024 sc1 lds
    v_exp_f32 v175, v175
    v_mfma_f32_16x16x32_bf16 v[84:87], a[20:23], a[8:11], v[84:87]
    s_cselect_b32 s66, 4294836224, s100
    ds_read_b64_tr_b16 a[52:53], v13 offset:8192
    v_exp_f32 v176, v176
    v_exp_f32 v177, v177
    v_mfma_f32_16x16x32_bf16 v[92:95], a[20:23], a[12:15], v[92:95]
    s_cselect_b32 s58, 0, s58
    ds_read_b64_tr_b16 a[54:55], v13 offset:12288
    v_exp_f32 v178, v178
    v_exp_f32 v179, v179
    s_waitcnt lgkmcnt(10)
    v_mfma_f32_16x16x32_bf16 v[96:99], a[24:27], a[0:3], v[96:99]
    ds_read_b64_tr_b16 a[56:57], v14 offset:8192
    v_cvt_pk_bf16_f32 v192, v148, v149
    v_cvt_pk_bf16_f32 v193, v150, v151
    v_mfma_f32_16x16x32_bf16 v[104:107], a[24:27], a[4:7], v[104:107]
    ds_read_b64_tr_b16 a[58:59], v14 offset:12288
    buffer_load_dwordx4 v18, s[24:27], s57 offen offset:2048 sc1 lds
    v_cvt_pk_bf16_f32 v194, v152, v153
    v_mfma_f32_16x16x32_bf16 v[112:115], a[24:27], a[8:11], v[112:115]
    ds_read_b64_tr_b16 a[60:61], v15 offset:8192
    v_cvt_pk_bf16_f32 v195, v154, v155
    v_cvt_pk_bf16_f32 v196, v156, v157
    v_mfma_f32_16x16x32_bf16 v[120:123], a[24:27], a[12:15], v[120:123]
    ds_read_b64_tr_b16 a[62:63], v15 offset:12288
    v_cvt_pk_bf16_f32 v197, v158, v159
    v_cvt_pk_bf16_f32 v198, v160, v161
    s_waitcnt lgkmcnt(12)
    v_mfma_f32_16x16x32_bf16 v[100:103], a[28:31], a[0:3], v[100:103]
    v_add_u32 v6, s66, v6
    v_add_u32 v12, s66, v12
    v_cvt_pk_bf16_f32 v199, v162, v163
    v_mfma_f32_16x16x32_bf16 v[108:111], a[28:31], a[4:7], v[108:111]
    buffer_load_dwordx4 v19, s[24:27], s57 offen offset:3072 sc1 lds
    v_cvt_pk_bf16_f32 v200, v164, v165
    v_mfma_f32_16x16x32_bf16 v[116:119], a[28:31], a[8:11], v[116:119]
    s_add_u32 s57, s57, 131072
    v_add_u32 v13, s66, v13
    v_add_u32 v14, s66, v14
    v_cvt_pk_bf16_f32 v201, v166, v167
    v_mfma_f32_16x16x32_bf16 v[124:127], a[28:31], a[12:15], v[124:127]
    s_mov_b32 m0, s59
    v_add_u32 v15, s66, v15
    v_cvt_pk_bf16_f32 v202, v168, v169
    s_waitcnt vmcnt(24) lgkmcnt(0)
    v_mfma_f32_16x16x32_bf16 v[64:67], a[48:51], a[32:35], v[64:67]
    s_barrier
    v_cvt_pk_bf16_f32 v203, v170, v171
    v_cvt_pk_bf16_f32 v204, v172, v173
    v_mfma_f32_16x16x32_bf16 v[72:75], a[48:51], a[36:39], v[72:75]
    ds_read_b128 a[0:3], v6 offset:0
    buffer_load_dwordx4 v2, s[36:39], s56 offen offset:0 sc1 lds
    v_cvt_pk_bf16_f32 v205, v174, v175
    v_mfma_f32_16x16x32_bf16 v[80:83], a[48:51], a[40:43], v[80:83]
    ds_read_b64_tr_b16 a[16:17], v12 offset:0
    v_cvt_pk_bf16_f32 v206, v176, v177
    v_cvt_pk_bf16_f32 v207, v178, v179
    v_mfma_f32_16x16x32_bf16 v[88:91], a[48:51], a[44:47], v[88:91]
    ds_read_b64_tr_b16 a[18:19], v12 offset:4096
    s_nop 1
    v_mfma_f32_16x16x32_bf16 v[20:23], v[44:47], v[192:195], 0
    v_mfma_f32_16x16x32_bf16 v[68:71], a[52:55], a[32:35], v[68:71]
    ds_read_b128 a[4:7], v6 offset:1024
    v_mfma_f32_16x16x32_bf16 v[24:27], v[44:47], v[196:199], 0
    v_mfma_f32_16x16x32_bf16 v[28:31], v[44:47], v[200:203], 0
    v_mfma_f32_16x16x32_bf16 v[76:79], a[52:55], a[36:39], v[76:79]
    ds_read_b128 a[8:11], v6 offset:2048
    buffer_load_dwordx4 v2, s[36:39], s56 offen offset:1024 sc1 lds
    v_mfma_f32_16x16x32_bf16 v[32:35], v[44:47], v[204:207], 0
    v_mfma_f32_16x16x32_bf16 v[84:87], a[52:55], a[40:43], v[84:87]
    ds_read_b128 a[12:15], v6 offset:3072
    v_mfma_f32_16x16x32_bf16 v[148:151], v[230:233], v[192:195], 0
    v_mfma_f32_16x16x32_bf16 v[152:155], v[242:245], v[192:195], 0
    v_mfma_f32_16x16x32_bf16 v[92:95], a[52:55], a[44:47], v[92:95]
    ds_read_b64_tr_b16 a[20:21], v13 offset:0
    v_mfma_f32_16x16x32_bf16 v[156:159], v[232:235], v[196:199], 0
    v_mfma_f32_16x16x32_bf16 v[160:163], v[244:247], v[196:199], 0
    v_mfma_f32_16x16x32_bf16 v[96:99], a[56:59], a[32:35], v[96:99]
    ds_read_b64_tr_b16 a[22:23], v13 offset:4096
    v_mfma_f32_16x16x32_bf16 v[164:167], v[234:237], v[200:203], 0
    v_mfma_f32_16x16x32_bf16 v[168:171], v[246:249], v[200:203], 0
    v_mfma_f32_16x16x32_bf16 v[104:107], a[56:59], a[36:39], v[104:107]
    ds_read_b64_tr_b16 a[24:25], v14 offset:0
    buffer_load_dwordx4 v2, s[36:39], s56 offen offset:2048 sc1 lds
    v_mfma_f32_16x16x32_bf16 v[172:175], v[236:239], v[204:207], 0
    v_mfma_f32_16x16x32_bf16 v[112:115], a[56:59], a[40:43], v[112:115]
    ds_read_b64_tr_b16 a[26:27], v14 offset:4096
    v_mfma_f32_16x16x32_bf16 v[176:179], v[248:251], v[204:207], 0
    v_rcp_f32 v140, v20
    v_mfma_f32_16x16x32_bf16 v[120:123], a[56:59], a[44:47], v[120:123]
    ds_read_b64_tr_b16 a[28:29], v15 offset:0
    v_rcp_f32 v141, v24
    v_rcp_f32 v142, v28
    v_mfma_f32_16x16x32_bf16 v[100:103], a[60:63], a[32:35], v[100:103]
    s_add_u32 s64, s64, 1
    ds_read_b64_tr_b16 a[30:31], v15 offset:4096
    v_rcp_f32 v143, v32
    s_nop 1
    v_mfma_f32_16x16x32_bf16 v[108:111], a[60:63], a[36:39], v[108:111]
    buffer_load_dwordx4 v2, s[36:39], s56 offen offset:3072 sc1 lds
    s_nop 1
    v_mfma_f32_16x16x32_bf16 v[116:119], a[60:63], a[40:43], v[116:119]
    s_add_u32 s56, s56, 262144
    v_mul_f32 v148, v148, v140
    v_mul_f32 v149, v149, v140
    v_mfma_f32_16x16x32_bf16 v[124:127], a[60:63], a[44:47], v[124:127]
    v_mul_f32 v150, v150, v140
    v_mul_f32 v151, v151, v140
    s_cmp_gt_i32 s68, 8
    s_cbranch_scc0 m_lp143
m_lr144:
    s_waitcnt lgkmcnt(9)
    v_mfma_f32_16x16x32_bf16 v[64:67], a[16:19], a[0:3], v[64:67]
    s_add_u32 m0, s59, 16384
    ds_read_b128 a[32:35], v6 offset:8192
    v_mul_f32 v152, v152, v140
    v_mul_f32 v153, v153, v140
    s_waitcnt lgkmcnt(9)
    v_mfma_f32_16x16x32_bf16 v[72:75], a[16:19], a[4:7], v[72:75]
    ds_read_b64_tr_b16 a[48:49], v12 offset:8192
    buffer_load_dwordx4 v16, s[24:27], s57 offen offset:0 sc1 lds
    v_mul_f32 v154, v154, v140
    s_waitcnt lgkmcnt(9)
    v_mfma_f32_16x16x32_bf16 v[80:83], a[16:19], a[8:11], v[80:83]
    s_add_u32 s59, s58, s60
    ds_read_b64_tr_b16 a[50:51], v12 offset:12288
    v_mul_f32 v155, v155, v140
    v_cvt_pk_bf16_f32 v148, v148, v149
    s_waitcnt lgkmcnt(9)
    v_mfma_f32_16x16x32_bf16 v[88:91], a[16:19], a[12:15], v[88:91]
    s_add_u32 s58, s58, 32768
    ds_read_b128 a[36:39], v6 offset:9216
    v_cvt_pk_bf16_f32 v149, v150, v151
    v_cvt_pk_bf16_f32 v150, v152, v153
    s_waitcnt lgkmcnt(8)
    v_mfma_f32_16x16x32_bf16 v[68:71], a[20:23], a[0:3], v[68:71]
    s_cmp_ge_u32 s58, 163840
    ds_read_b128 a[40:43], v6 offset:10240
    v_cvt_pk_bf16_f32 v151, v154, v155
    buffer_store_dwordx4 v[148:151], v2, s[8:11], s80 offen offset:0 sc1
    v_mfma_f32_16x16x32_bf16 v[76:79], a[20:23], a[4:7], v[76:79]
    ds_read_b128 a[44:47], v6 offset:11264
    buffer_load_dwordx4 v17, s[24:27], s57 offen offset:1024 sc1 lds
    v_mul_f32 v156, v156, v141
    v_mfma_f32_16x16x32_bf16 v[84:87], a[20:23], a[8:11], v[84:87]
    s_cselect_b32 s66, 4294836224, s100
    ds_read_b64_tr_b16 a[52:53], v13 offset:8192
    v_mul_f32 v157, v157, v141
    v_mul_f32 v158, v158, v141
    v_mfma_f32_16x16x32_bf16 v[92:95], a[20:23], a[12:15], v[92:95]
    s_cselect_b32 s58, 0, s58
    ds_read_b64_tr_b16 a[54:55], v13 offset:12288
    v_mul_f32 v159, v159, v141
    v_mul_f32 v160, v160, v141
    s_waitcnt lgkmcnt(10)
    v_mfma_f32_16x16x32_bf16 v[96:99], a[24:27], a[0:3], v[96:99]
    ds_read_b64_tr_b16 a[56:57], v14 offset:8192
    v_mul_f32 v161, v161, v141
    v_mul_f32 v162, v162, v141
    v_mfma_f32_16x16x32_bf16 v[104:107], a[24:27], a[4:7], v[104:107]
    ds_read_b64_tr_b16 a[58:59], v14 offset:12288
    buffer_load_dwordx4 v18, s[24:27], s57 offen offset:2048 sc1 lds
    v_mul_f32 v163, v163, v141
    v_mfma_f32_16x16x32_bf16 v[112:115], a[24:27], a[8:11], v[112:115]
    ds_read_b64_tr_b16 a[60:61], v15 offset:8192
    v_cvt_pk_bf16_f32 v156, v156, v157
    v_cvt_pk_bf16_f32 v157, v158, v159
    v_mfma_f32_16x16x32_bf16 v[120:123], a[24:27], a[12:15], v[120:123]
    ds_read_b64_tr_b16 a[62:63], v15 offset:12288
    v_cvt_pk_bf16_f32 v158, v160, v161
    v_cvt_pk_bf16_f32 v159, v162, v163
    s_waitcnt lgkmcnt(12)
    v_mfma_f32_16x16x32_bf16 v[100:103], a[28:31], a[0:3], v[100:103]
    v_add_u32 v6, s66, v6
    v_add_u32 v12, s66, v12
    buffer_store_dwordx4 v[156:159], v2, s[8:11], s80 offen offset:1024 sc1
    v_mfma_f32_16x16x32_bf16 v[108:111], a[28:31], a[4:7], v[108:111]
    buffer_load_dwordx4 v19, s[24:27], s57 offen offset:3072 sc1 lds
    v_mul_f32 v164, v164, v142
    v_mfma_f32_16x16x32_bf16 v[116:119], a[28:31], a[8:11], v[116:119]
    s_add_u32 s57, s57, 131072
    v_add_u32 v13, s66, v13
    v_add_u32 v14, s66, v14
    v_mul_f32 v165, v165, v142
    v_mfma_f32_16x16x32_bf16 v[124:127], a[28:31], a[12:15], v[124:127]
    s_mov_b32 m0, s59
    v_add_u32 v15, s66, v15
    v_mul_f32 v166, v166, v142
    s_waitcnt vmcnt(24) lgkmcnt(0)
    v_mfma_f32_16x16x32_bf16 v[64:67], a[48:51], a[32:35], v[64:67]
    s_barrier
    v_mul_f32 v167, v167, v142
    v_mul_f32 v168, v168, v142
    v_mfma_f32_16x16x32_bf16 v[72:75], a[48:51], a[36:39], v[72:75]
    ds_read_b128 a[0:3], v6 offset:0
    buffer_load_dwordx4 v2, s[36:39], s56 offen offset:0 sc1 lds
    v_mul_f32 v169, v169, v142
    v_mfma_f32_16x16x32_bf16 v[80:83], a[48:51], a[40:43], v[80:83]
    ds_read_b64_tr_b16 a[16:17], v12 offset:0
    v_mul_f32 v170, v170, v142
    v_mul_f32 v171, v171, v142
    v_mfma_f32_16x16x32_bf16 v[88:91], a[48:51], a[44:47], v[88:91]
    ds_read_b64_tr_b16 a[18:19], v12 offset:4096
    v_cvt_pk_bf16_f32 v164, v164, v165
    v_cvt_pk_bf16_f32 v165, v166, v167
    v_mfma_f32_16x16x32_bf16 v[68:71], a[52:55], a[32:35], v[68:71]
    ds_read_b128 a[4:7], v6 offset:1024
    v_cvt_pk_bf16_f32 v166, v168, v169
    v_cvt_pk_bf16_f32 v167, v170, v171
    v_mfma_f32_16x16x32_bf16 v[76:79], a[52:55], a[36:39], v[76:79]
    ds_read_b128 a[8:11], v6 offset:2048
    buffer_load_dwordx4 v2, s[36:39], s56 offen offset:1024 sc1 lds
    buffer_store_dwordx4 v[164:167], v2, s[8:11], s80 offen offset:2048 sc1
    v_mfma_f32_16x16x32_bf16 v[84:87], a[52:55], a[40:43], v[84:87]
    ds_read_b128 a[12:15], v6 offset:3072
    v_mul_f32 v172, v172, v143
    v_mul_f32 v173, v173, v143
    v_mfma_f32_16x16x32_bf16 v[92:95], a[52:55], a[44:47], v[92:95]
    ds_read_b64_tr_b16 a[20:21], v13 offset:0
    v_mul_f32 v174, v174, v143
    v_mul_f32 v175, v175, v143
    v_mfma_f32_16x16x32_bf16 v[96:99], a[56:59], a[32:35], v[96:99]
    ds_read_b64_tr_b16 a[22:23], v13 offset:4096
    v_mul_f32 v176, v176, v143
    v_mul_f32 v177, v177, v143
    v_mfma_f32_16x16x32_bf16 v[104:107], a[56:59], a[36:39], v[104:107]
    ds_read_b64_tr_b16 a[24:25], v14 offset:0
    buffer_load_dwordx4 v2, s[36:39], s56 offen offset:2048 sc1 lds
    v_mul_f32 v178, v178, v143
    v_mfma_f32_16x16x32_bf16 v[112:115], a[56:59], a[40:43], v[112:115]
    ds_read_b64_tr_b16 a[26:27], v14 offset:4096
    v_mul_f32 v179, v179, v143
    v_cvt_pk_bf16_f32 v172, v172, v173
    v_mfma_f32_16x16x32_bf16 v[120:123], a[56:59], a[44:47], v[120:123]
    ds_read_b64_tr_b16 a[28:29], v15 offset:0
    v_cvt_pk_bf16_f32 v173, v174, v175
    v_cvt_pk_bf16_f32 v174, v176, v177
    v_mfma_f32_16x16x32_bf16 v[100:103], a[60:63], a[32:35], v[100:103]
    s_add_u32 s64, s64, 1
    ds_read_b64_tr_b16 a[30:31], v15 offset:4096
    v_cvt_pk_bf16_f32 v175, v178, v179
    buffer_store_dwordx4 v[172:175], v2, s[8:11], s80 offen offset:3072 sc1
    v_mfma_f32_16x16x32_bf16 v[108:111], a[60:63], a[36:39], v[108:111]
    buffer_load_dwordx4 v2, s[36:39], s56 offen offset:3072 sc1 lds
    v_mfma_f32_16x16x32_bf16 v[116:119], a[60:63], a[40:43], v[116:119]
    s_add_u32 s56, s56, 262144
    v_mfma_f32_16x16x32_bf16 v[124:127], a[60:63], a[44:47], v[124:127]
    s_branch m_l3e133
m_lp137:
    s_mov_b32 s3, 1048576
m_spin145:
    buffer_load_dwordx2 v[4:5], v10, s[8:11], s52 offen sc1
    s_waitcnt vmcnt(0)
    v_cmp_ne_u64 s[76:77], s[4:5], v[4:5]
    s_mul_i32 s91, s95, 20
    s_nop 2
    s_lshr_b32 s90, s76, s91
    s_ff1_i32_b32 s90, s90
    s_lshl_b32 s68, s90, 1
    s_mul_i32 s91, s95, 0
    s_sub_i32 s68, s68, s91
    s_cmp_lt_i32 s90, 0
    s_cselect_b32 s68, 1000, s68
    s_cmp_gt_i32 s68, 5
    s_cbranch_scc1 m_ok146
    s_sub_u32 s3, s3, 1
    s_cbranch_scc1 m_ok146
    s_sleep 4
    s_branch m_spin145
m_ok146:
    s_branch m_lr138
m_lp139:
    s_mov_b32 s3, 1048576
m_spin147:
    buffer_load_dwordx2 v[4:5], v10, s[8:11], s52 offen sc1
    s_waitcnt vmcnt(0)
    v_cmp_ne_u64 s[76:77], s[4:5], v[4:5]
    s_mul_i32 s91, s95, 20
    s_nop 2
    s_lshr_b32 s90, s76, s91
    s_ff1_i32_b32 s90, s90
    s_lshl_b32 s68, s90, 1
    s_mul_i32 s91, s95, 0
    s_sub_i32 s68, s68, s91
    s_cmp_lt_i32 s90, 0
    s_cselect_b32 s68, 1000, s68
    s_cmp_gt_i32 s68, 6
    s_cbranch_scc1 m_ok148
    s_sub_u32 s3, s3, 1
    s_cbranch_scc1 m_ok148
    s_sleep 4
    s_branch m_spin147
m_ok148:
    s_branch m_lr140
m_lp141:
    s_mov_b32 s3, 1048576
m_spin149:
    buffer_load_dwordx2 v[4:5], v10, s[8:11], s52 offen sc1
    s_waitcnt vmcnt(0)
    v_cmp_ne_u64 s[76:77], s[4:5], v[4:5]
    s_mul_i32 s91, s95, 20
    s_nop 2
    s_lshr_b32 s90, s76, s91
    s_ff1_i32_b32 s90, s90
    s_lshl_b32 s68, s90, 1
    s_mul_i32 s91, s95, 0
    s_sub_i32 s68, s68, s91
    s_cmp_lt_i32 s90, 0
    s_cselect_b32 s68, 1000, s68
    s_cmp_gt_i32 s68, 7
    s_cbranch_scc1 m_ok150
    s_sub_u32 s3, s3, 1
    s_cbranch_scc1 m_ok150
    s_sleep 4
    s_branch m_spin149
m_ok150:
    s_branch m_lr142
m_lp143:
    s_mov_b32 s3, 1048576
m_spin151:
    buffer_load_dwordx2 v[4:5], v10, s[8:11], s52 offen sc1
    s_waitcnt vmcnt(0)
    v_cmp_ne_u64 s[76:77], s[4:5], v[4:5]
    s_mul_i32 s91, s95, 20
    s_nop 2
    s_lshr_b32 s90, s76, s91
    s_ff1_i32_b32 s90, s90
    s_lshl_b32 s68, s90, 1
    s_mul_i32 s91, s95, 0
    s_sub_i32 s68, s68, s91
    s_cmp_lt_i32 s90, 0
    s_cselect_b32 s68, 1000, s68
    s_cmp_gt_i32 s68, 8
    s_cbranch_scc1 m_ok152
    s_sub_u32 s3, s3, 1
    s_cbranch_scc1 m_ok152
    s_sleep 4
    s_branch m_spin151
m_ok152:
    s_branch m_lr144
m_l3132:
    s_waitcnt lgkmcnt(9)
    v_mfma_f32_16x16x32_bf16 v[64:67], a[16:19], a[0:3], v[64:67]
    s_add_u32 m0, s59, 16384
    ds_read_b128 a[32:35], v6 offset:8192
    s_waitcnt lgkmcnt(9)
    v_mfma_f32_16x16x32_bf16 v[72:75], a[16:19], a[4:7], v[72:75]
    ds_read_b64_tr_b16 a[48:49], v12 offset:8192
    buffer_load_dwordx4 v16, s[24:27], s57 offen offset:0 sc1 lds
    s_waitcnt lgkmcnt(9)
    v_mfma_f32_16x16x32_bf16 v[80:83], a[16:19], a[8:11], v[80:83]
    s_add_u32 s59, s58, s60
    ds_read_b64_tr_b16 a[50:51], v12 offset:12288
    s_waitcnt lgkmcnt(9)
    v_mfma_f32_16x16x32_bf16 v[88:91], a[16:19], a[12:15], v[88:91]
    s_add_u32 s58, s58, 32768
    ds_read_b128 a[36:39], v6 offset:9216
    s_waitcnt lgkmcnt(8)
    v_mfma_f32_16x16x32_bf16 v[68:71], a[20:23], a[0:3], v[68:71]
    s_cmp_ge_u32 s58, 163840
    ds_read_b128 a[40:43], v6 offset:10240
    v_mfma_f32_16x16x32_bf16 v[76:79], a[20:23], a[4:7], v[76:79]
    ds_read_b128 a[44:47], v6 offset:11264
    buffer_load_dwordx4 v17, s[24:27], s57 offen offset:1024 sc1 lds
    v_mfma_f32_16x16x32_bf16 v[84:87], a[20:23], a[8:11], v[84:87]
    s_cselect_b32 s66, 4294836224, s100
    ds_read_b64_tr_b16 a[52:53], v13 offset:8192
    v_mfma_f32_16x16x32_bf16 v[92:95], a[20:23], a[12:15], v[92:95]
    s_cselect_b32 s58, 0, s58
    ds_read_b64_tr_b16 a[54:55], v13 offset:12288
    s_waitcnt lgkmcnt(10)
    v_mfma_f32_16x16x32_bf16 v[96:99], a[24:27], a[0:3], v[96:99]
    ds_read_b64_tr_b16 a[56:57], v14 offset:8192
    v_mfma_f32_16x16x32_bf16 v[104:107], a[24:27], a[4:7], v[104:107]
    ds_read_b64_tr_b16 a[58:59], v14 offset:12288
    buffer_load_dwordx4 v18, s[24:27], s57 offen offset:2048 sc1 lds
    v_mfma_f32_16x16x32_bf16 v[112:115], a[24:27], a[8:11], v[112:115]
    ds_read_b64_tr_b16 a[60:61], v15 offset:8192
    v_mfma_f32_16x16x32_bf16 v[120:123], a[24:27], a[12:15], v[120:123]
    ds_read_b64_tr_b16 a[62:63], v15 offset:12288
    s_waitcnt lgkmcnt(12)
    v_mfma_f32_16x16x32_bf16 v[100:103], a[28:31], a[0:3], v[100:103]
    v_add_u32 v6, s66, v6
    v_add_u32 v12, s66, v12
    v_mfma_f32_16x16x32_bf16 v[108:111], a[28:31], a[4:7], v[108:111]
    buffer_load_dwordx4 v19, s[24:27], s57 offen offset:3072 sc1 lds
    v_mfma_f32_16x16x32_bf16 v[116:119], a[28:31], a[8:11], v[116:119]
    s_add_u32 s57, s57, 131072
    v_add_u32 v13, s66, v13
    v_add_u32 v14, s66, v14
    v_mfma_f32_16x16x32_bf16 v[124:127], a[28:31], a[12:15], v[124:127]
    s_mov_b32 m0, s59
    v_add_u32 v15, s66, v15
    s_waitcnt vmcnt(24) lgkmcnt(0)
    v_mfma_f32_16x16x32_bf16 v[64:67], a[48:51], a[32:35], v[64:67]
    s_barrier
    v_mfma_f32_16x16x32_bf16 v[72:75], a[48:51], a[36:39], v[72:75]
    ds_read_b128 a[0:3], v6 offset:0
    buffer_load_dwordx4 v2, s[36:39], s56 offen offset:0 sc1 lds
    v_mfma_f32_16x16x32_bf16 v[80:83], a[48:51], a[40:43], v[80:83]
    ds_read_b64_tr_b16 a[16:17], v12 offset:0
    v_mfma_f32_16x16x32_bf16 v[88:91], a[48:51], a[44:47], v[88:91]
    ds_read_b64_tr_b16 a[18:19], v12 offset:4096
    v_mfma_f32_16x16x32_bf16 v[68:71], a[52:55], a[32:35], v[68:71]
    ds_read_b128 a[4:7], v6 offset:1024
    v_mfma_f32_16x16x32_bf16 v[76:79], a[52:55], a[36:39], v[76:79]
    ds_read_b128 a[8:11], v6 offset:2048
    buffer_load_dwordx4 v2, s[36:39], s56 offen offset:1024 sc1 lds
    v_mfma_f32_16x16x32_bf16 v[84:87], a[52:55], a[40:43], v[84:87]
    ds_read_b128 a[12:15], v6 offset:3072
    v_mfma_f32_16x16x32_bf16 v[92:95], a[52:55], a[44:47], v[92:95]
    ds_read_b64_tr_b16 a[20:21], v13 offset:0
    v_mfma_f32_16x16x32_bf16 v[96:99], a[56:59], a[32:35], v[96:99]
    ds_read_b64_tr_b16 a[22:23], v13 offset:4096
    v_mfma_f32_16x16x32_bf16 v[104:107], a[56:59], a[36:39], v[104:107]
    ds_read_b64_tr_b16 a[24:25], v14 offset:0
    buffer_load_dwordx4 v2, s[36:39], s56 offen offset:2048 sc1 lds
    v_mfma_f32_16x16x32_bf16 v[112:115], a[56:59], a[40:43], v[112:115]
    ds_read_b64_tr_b16 a[26:27], v14 offset:4096
    v_mfma_f32_16x16x32_bf16 v[120:123], a[56:59], a[44:47], v[120:123]
    ds_read_b64_tr_b16 a[28:29], v15 offset:0
    v_mfma_f32_16x16x32_bf16 v[100:103], a[60:63], a[32:35], v[100:103]
    s_add_u32 s64, s64, 1
    ds_read_b64_tr_b16 a[30:31], v15 offset:4096
    v_mfma_f32_16x16x32_bf16 v[108:111], a[60:63], a[36:39], v[108:111]
    buffer_load_dwordx4 v2, s[36:39], s56 offen offset:3072 sc1 lds
    v_mfma_f32_16x16x32_bf16 v[116:119], a[60:63], a[40:43], v[116:119]
    s_add_u32 s56, s56, 262144
    s_cmp_lt_u32 s64, s67
    v_mfma_f32_16x16x32_bf16 v[124:127], a[60:63], a[44:47], v[124:127]
    s_cbranch_scc1 m_l3132
m_l3e133:
    s_add_u32 s92, s64, 5
    s_cmp_gt_i32 s68, s92
    s_cbranch_scc1 m_rdy153
    s_mov_b32 s3, 1048576
m_spin154:
    buffer_load_dwordx2 v[4:5], v10, s[8:11], s52 offen sc1
    s_waitcnt vmcnt(0)
    v_cmp_ne_u64 s[76:77], s[4:5], v[4:5]
    s_mul_i32 s91, s95, 20
    s_nop 2
    s_lshr_b32 s90, s76, s91
    s_ff1_i32_b32 s90, s90
    s_lshl_b32 s68, s90, 1
    s_mul_i32 s91, s95, 0
    s_sub_i32 s68, s68, s91
    s_cmp_lt_i32 s90, 0
    s_cselect_b32 s68, 1000, s68
    s_cmp_gt_i32 s68, s92
    s_cbranch_scc1 m_ok155
    s_sub_u32 s3, s3, 1
    s_cbranch_scc1 m_ok155
    s_sleep 4
    s_branch m_spin154
m_ok155:
m_rdy153:
    s_mov_b32 s67, 8
    s_cmp_lt_u32 s64, 8
    s_cbranch_scc1 m_l3n136
    s_cmp_eq_u32 s64, 8
    s_cbranch_scc1 m_o1156
m_o2157:
    s_cmp_eq_u32 s95, 0
    s_cbranch_scc1 m_l3c135
    s_mov_b32 s67, 18
    s_cmp_lt_u32 s64, 18
    s_cbranch_scc1 m_l3n136
    s_cmp_lg_u32 s64, 18
    s_cbranch_scc1 m_n158
    s_mov_b32 s68, 1000
    s_lshr_b32 s90, s96, 1
    s_lshl_b32 s90, s90, 8
    s_add_u32 s90, s90, 117452800
    buffer_load_dwordx2 v[4:5], v10, s[8:11], s90 offen sc1
    s_mov_b32 s67, 19
    s_branch m_l3132
m_n158:
    s_cmp_lg_u32 s64, 19
    s_cbranch_scc1 m_n159
    s_waitcnt vmcnt(8)
    s_waitcnt vmcnt(16)
    s_mov_b32 s3, 1048576
m_spin160:
    v_cmp_ne_u64 s[76:77], s[4:5], v[4:5]
    s_nop 3
    s_cmp_eq_u64 s[76:77], 0
    s_cbranch_scc1 m_ok161
    s_sub_u32 s3, s3, 1
    s_cbranch_scc1 m_ok161
    s_sleep 8
    s_lshr_b32 s90, s96, 1
    s_lshl_b32 s90, s90, 8
    s_add_u32 s90, s90, 117452800
    buffer_load_dwordx2 v[4:5], v10, s[8:11], s90 offen sc1
    s_waitcnt vmcnt(0)
    s_branch m_spin160
m_ok161:
    s_mov_b32 s56, s69
    s_mov_b32 s67, 20
    s_branch m_l3132
m_n159:
    s_cmp_lg_u32 s64, 20
    s_cbranch_scc1 m_n162
    s_mov_b32 s24, s50
    s_mov_b32 s25, s51
    s_mov_b32 s26, 2097152
    s_lshl_b32 s57, s97, 8
    s_mov_b32 s67, 24
    s_branch m_l3132
m_n162:
    s_cmp_lg_u32 s64, 24
    s_cbranch_scc1 m_n163
    s_lshl_b32 s90, s96, 3
    s_add_u32 s90, s90, s97
    s_lshl_b32 s90, s90, 15
    s_lshl_b32 s91, s16, 13
    s_add_u32 s90, s90, s91
    s_add_u32 s70, s90, 100663296
    s_nop 3
    v_cvt_pk_bf16_f32 v128, v64, v65
    v_cvt_pk_bf16_f32 v129, v66, v67
    v_cvt_pk_bf16_f32 v130, v68, v69
    v_cvt_pk_bf16_f32 v131, v70, v71
    v_cvt_pk_bf16_f32 v132, v72, v73
    v_cvt_pk_bf16_f32 v133, v74, v75
    v_cvt_pk_bf16_f32 v134, v76, v77
    v_cvt_pk_bf16_f32 v135, v78, v79
    v_cvt_pk_bf16_f32 v136, v80, v81
    v_cvt_pk_bf16_f32 v137, v82, v83
    v_cvt_pk_bf16_f32 v138, v84, v85
    v_cvt_pk_bf16_f32 v139, v86, v87
    v_cvt_pk_bf16_f32 v140, v88, v89
    v_cvt_pk_bf16_f32 v141, v90, v91
    v_cvt_pk_bf16_f32 v142, v92, v93
    v_cvt_pk_bf16_f32 v143, v94, v95
    v_cvt_pk_bf16_f32 v144, v96, v97
    v_cvt_pk_bf16_f32 v145, v98, v99
    v_cvt_pk_bf16_f32 v146, v100, v101
    v_cvt_pk_bf16_f32 v147, v102, v103
    v_cvt_pk_bf16_f32 v148, v104, v105
    v_cvt_pk_bf16_f32 v149, v106, v107
    v_cvt_pk_bf16_f32 v150, v108, v109
    v_cvt_pk_bf16_f32 v151, v110, v111
    v_cvt_pk_bf16_f32 v152, v112, v113
    v_cvt_pk_bf16_f32 v153, v114, v115
    v_cvt_pk_bf16_f32 v154, v116, v117
    v_cvt_pk_bf16_f32 v155, v118, v119
    v_cvt_pk_bf16_f32 v156, v120, v121
    v_cvt_pk_bf16_f32 v157, v122, v123
    v_cvt_pk_bf16_f32 v158, v124, v125
    v_cvt_pk_bf16_f32 v159, v126, v127
    v_mov_b64 v[64:65], 0
    v_mov_b64 v[66:67], 0
    v_mov_b64 v[68:69], 0
    v_mov_b64 v[70:71], 0
    v_mov_b64 v[72:73], 0
    v_mov_b64 v[74:75], 0
    v_mov_b64 v[76:77], 0
    v_mov_b64 v[78:79], 0
    v_mov_b64 v[80:81], 0
    v_mov_b64 v[82:83], 0
    v_mov_b64 v[84:85], 0
    v_mov_b64 v[86:87], 0
    v_mov_b64 v[88:89], 0
    v_mov_b64 v[90:91], 0
    v_mov_b64 v[92:93], 0
    v_mov_b64 v[94:95], 0
    v_mov_b64 v[96:97], 0
    v_mov_b64 v[98:99], 0
    v_mov_b64 v[100:101], 0
    v_mov_b64 v[102:103], 0
    v_mov_b64 v[104:105], 0
    v_mov_b64 v[106:107], 0
    v_mov_b64 v[108:109], 0
    v_mov_b64 v[110:111], 0
    v_mov_b64 v[112:113], 0
    v_mov_b64 v[114:115], 0
    v_mov_b64 v[116:117], 0
    v_mov_b64 v[118:119], 0
    v_mov_b64 v[120:121], 0
    v_mov_b64 v[122:123], 0
    v_mov_b64 v[124:125], 0
    v_mov_b64 v[126:127], 0
    s_nop 1
    s_waitcnt lgkmcnt(9)
    v_mfma_f32_16x16x32_bf16 v[64:67], a[16:19], a[0:3], v[64:67]
    s_add_u32 m0, s59, 16384
    ds_read_b128 a[32:35], v6 offset:8192
    s_waitcnt lgkmcnt(9)
    v_mfma_f32_16x16x32_bf16 v[72:75], a[16:19], a[4:7], v[72:75]
    ds_read_b64_tr_b16 a[48:49], v12 offset:8192
    buffer_load_dwordx4 v16, s[24:27], s57 offen offset:0 sc1 lds
    s_waitcnt lgkmcnt(9)
    v_mfma_f32_16x16x32_bf16 v[80:83], a[16:19], a[8:11], v[80:83]
    s_add_u32 s59, s58, s60
    ds_read_b64_tr_b16 a[50:51], v12 offset:12288
    s_waitcnt lgkmcnt(9)
    v_mfma_f32_16x16x32_bf16 v[88:91], a[16:19], a[12:15], v[88:91]
    s_add_u32 s58, s58, 32768
    ds_read_b128 a[36:39], v6 offset:9216
    s_waitcnt lgkmcnt(8)
    v_mfma_f32_16x16x32_bf16 v[68:71], a[20:23], a[0:3], v[68:71]
    s_cmp_ge_u32 s58, 163840
    ds_read_b128 a[40:43], v6 offset:10240
    v_mfma_f32_16x16x32_bf16 v[76:79], a[20:23], a[4:7], v[76:79]
    ds_read_b128 a[44:47], v6 offset:11264
    buffer_load_dwordx4 v17, s[24:27], s57 offen offset:1024 sc1 lds
    v_mfma_f32_16x16x32_bf16 v[84:87], a[20:23], a[8:11], v[84:87]
    s_cselect_b32 s66, 4294836224, s100
    ds_read_b64_tr_b16 a[52:53], v13 offset:8192
    v_mfma_f32_16x16x32_bf16 v[92:95], a[20:23], a[12:15], v[92:95]
    s_cselect_b32 s58, 0, s58
    ds_read_b64_tr_b16 a[54:55], v13 offset:12288
    s_waitcnt lgkmcnt(10)
    v_mfma_f32_16x16x32_bf16 v[96:99], a[24:27], a[0:3], v[96:99]
    ds_read_b64_tr_b16 a[56:57], v14 offset:8192
    v_mfma_f32_16x16x32_bf16 v[104:107], a[24:27], a[4:7], v[104:107]
    ds_read_b64_tr_b16 a[58:59], v14 offset:12288
    buffer_load_dwordx4 v18, s[24:27], s57 offen offset:2048 sc1 lds
    v_mfma_f32_16x16x32_bf16 v[112:115], a[24:27], a[8:11], v[112:115]
    ds_read_b64_tr_b16 a[60:61], v15 offset:8192
    v_mfma_f32_16x16x32_bf16 v[120:123], a[24:27], a[12:15], v[120:123]
    ds_read_b64_tr_b16 a[62:63], v15 offset:12288
    buffer_store_dwordx4 v[128:131], v2, s[8:11], s70 offen offset:0 sc1
    s_waitcnt lgkmcnt(12)
    v_mfma_f32_16x16x32_bf16 v[100:103], a[28:31], a[0:3], v[100:103]
    v_add_u32 v6, s66, v6
    v_add_u32 v12, s66, v12
    v_mfma_f32_16x16x32_bf16 v[108:111], a[28:31], a[4:7], v[108:111]
    buffer_load_dwordx4 v19, s[24:27], s57 offen offset:3072 sc1 lds
    v_mfma_f32_16x16x32_bf16 v[116:119], a[28:31], a[8:11], v[116:119]
    s_add_u32 s57, s57, 131072
    v_add_u32 v13, s66, v13
    v_add_u32 v14, s66, v14
    v_mfma_f32_16x16x32_bf16 v[124:127], a[28:31], a[12:15], v[124:127]
    s_mov_b32 m0, s59
    v_add_u32 v15, s66, v15
    s_waitcnt vmcnt(24) lgkmcnt(0)
    v_mfma_f32_16x16x32_bf16 v[64:67], a[48:51], a[32:35], v[64:67]
    s_barrier
    v_mfma_f32_16x16x32_bf16 v[72:75], a[48:51], a[36:39], v[72:75]
    ds_read_b128 a[0:3], v6 offset:0
    buffer_load_dwordx4 v2, s[36:39], s56 offen offset:0 sc1 lds
    v_mfma_f32_16x16x32_bf16 v[80:83], a[48:51], a[40:43], v[80:83]
    ds_read_b64_tr_b16 a[16:17], v12 offset:0
    v_mfma_f32_16x16x32_bf16 v[88:91], a[48:51], a[44:47], v[88:91]
    ds_read_b64_tr_b16 a[18:19], v12 offset:4096
    v_mfma_f32_16x16x32_bf16 v[68:71], a[52:55], a[32:35], v[68:71]
    ds_read_b128 a[4:7], v6 offset:1024
    v_mfma_f32_16x16x32_bf16 v[76:79], a[52:55], a[36:39], v[76:79]
    ds_read_b128 a[8:11], v6 offset:2048
    buffer_load_dwordx4 v2, s[36:39], s56 offen offset:1024 sc1 lds
    v_mfma_f32_16x16x32_bf16 v[84:87], a[52:55], a[40:43], v[84:87]
    ds_read_b128 a[12:15], v6 offset:3072
    v_mfma_f32_16x16x32_bf16 v[92:95], a[52:55], a[44:47], v[92:95]
    ds_read_b64_tr_b16 a[20:21], v13 offset:0
    v_mfma_f32_16x16x32_bf16 v[96:99], a[56:59], a[32:35], v[96:99]
    ds_read_b64_tr_b16 a[22:23], v13 offset:4096
    v_mfma_f32_16x16x32_bf16 v[104:107], a[56:59], a[36:39], v[104:107]
    ds_read_b64_tr_b16 a[24:25], v14 offset:0
    buffer_load_dwordx4 v2, s[36:39], s56 offen offset:2048 sc1 lds
    v_mfma_f32_16x16x32_bf16 v[112:115], a[56:59], a[40:43], v[112:115]
    ds_read_b64_tr_b16 a[26:27], v14 offset:4096
    v_mfma_f32_16x16x32_bf16 v[120:123], a[56:59], a[44:47], v[120:123]
    ds_read_b64_tr_b16 a[28:29], v15 offset:0
    buffer_store_dwordx4 v[132:135], v2, s[8:11], s70 offen offset:1024 sc1
    v_mfma_f32_16x16x32_bf16 v[100:103], a[60:63], a[32:35], v[100:103]
    s_add_u32 s64, s64, 1
    ds_read_b64_tr_b16 a[30:31], v15 offset:4096
    v_mfma_f32_16x16x32_bf16 v[108:111], a[60:63], a[36:39], v[108:111]
    buffer_load_dwordx4 v2, s[36:39], s56 offen offset:3072 sc1 lds
    v_mfma_f32_16x16x32_bf16 v[116:119], a[60:63], a[40:43], v[116:119]
    s_add_u32 s56, s56, 262144
    v_mfma_f32_16x16x32_bf16 v[124:127], a[60:63], a[44:47], v[124:127]
    s_waitcnt lgkmcnt(9)
    v_mfma_f32_16x16x32_bf16 v[64:67], a[16:19], a[0:3], v[64:67]
    s_add_u32 m0, s59, 16384
    ds_read_b128 a[32:35], v6 offset:8192
    s_waitcnt lgkmcnt(9)
    v_mfma_f32_16x16x32_bf16 v[72:75], a[16:19], a[4:7], v[72:75]
    ds_read_b64_tr_b16 a[48:49], v12 offset:8192
    buffer_load_dwordx4 v16, s[24:27], s57 offen offset:0 sc1 lds
    s_waitcnt lgkmcnt(9)
    v_mfma_f32_16x16x32_bf16 v[80:83], a[16:19], a[8:11], v[80:83]
    s_add_u32 s59, s58, s60
    ds_read_b64_tr_b16 a[50:51], v12 offset:12288
    s_waitcnt lgkmcnt(9)
    v_mfma_f32_16x16x32_bf16 v[88:91], a[16:19], a[12:15], v[88:91]
    s_add_u32 s58, s58, 32768
    ds_read_b128 a[36:39], v6 offset:9216
    s_waitcnt lgkmcnt(8)
    v_mfma_f32_16x16x32_bf16 v[68:71], a[20:23], a[0:3], v[68:71]
    s_cmp_ge_u32 s58, 163840
    ds_read_b128 a[40:43], v6 offset:10240
    v_mfma_f32_16x16x32_bf16 v[76:79], a[20:23], a[4:7], v[76:79]
    ds_read_b128 a[44:47], v6 offset:11264
    buffer_load_dwordx4 v17, s[24:27], s57 offen offset:1024 sc1 lds
    v_mfma_f32_16x16x32_bf16 v[84:87], a[20:23], a[8:11], v[84:87]
    s_cselect_b32 s66, 4294836224, s100
    ds_read_b64_tr_b16 a[52:53], v13 offset:8192
    v_mfma_f32_16x16x32_bf16 v[92:95], a[20:23], a[12:15], v[92:95]
    s_cselect_b32 s58, 0, s58
    ds_read_b64_tr_b16 a[54:55], v13 offset:12288
    s_waitcnt lgkmcnt(10)
    v_mfma_f32_16x16x32_bf16 v[96:99], a[24:27], a[0:3], v[96:99]
    ds_read_b64_tr_b16 a[56:57], v14 offset:8192
    v_mfma_f32_16x16x32_bf16 v[104:107], a[24:27], a[4:7], v[104:107]
    ds_read_b64_tr_b16 a[58:59], v14 offset:12288
    buffer_load_dwordx4 v18, s[24:27], s57 offen offset:2048 sc1 lds
    v_mfma_f32_16x16x32_bf16 v[112:115], a[24:27], a[8:11], v[112:115]
    ds_read_b64_tr_b16 a[60:61], v15 offset:8192
    v_mfma_f32_16x16x32_bf16 v[120:123], a[24:27], a[12:15], v[120:123]
    ds_read_b64_tr_b16 a[62:63], v15 offset:12288
    buffer_store_dwordx4 v[136:139], v2, s[8:11], s70 offen offset:2048 sc1
    s_waitcnt lgkmcnt(12)
    v_mfma_f32_16x16x32_bf16 v[100:103], a[28:31], a[0:3], v[100:103]
    v_add_u32 v6, s66, v6
    v_add_u32 v12, s66, v12
    v_mfma_f32_16x16x32_bf16 v[108:111], a[28:31], a[4:7], v[108:111]
    buffer_load_dwordx4 v19, s[24:27], s57 offen offset:3072 sc1 lds
    v_mfma_f32_16x16x32_bf16 v[116:119], a[28:31], a[8:11], v[116:119]
    s_add_u32 s57, s57, 131072
    v_add_u32 v13, s66, v13
    v_add_u32 v14, s66, v14
    v_mfma_f32_16x16x32_bf16 v[124:127], a[28:31], a[12:15], v[124:127]
    s_mov_b32 m0, s59
    v_add_u32 v15, s66, v15
    s_waitcnt vmcnt(24) lgkmcnt(0)
    v_mfma_f32_16x16x32_bf16 v[64:67], a[48:51], a[32:35], v[64:67]
    s_barrier
    v_mfma_f32_16x16x32_bf16 v[72:75], a[48:51], a[36:39], v[72:75]
    ds_read_b128 a[0:3], v6 offset:0
    buffer_load_dwordx4 v2, s[36:39], s56 offen offset:0 sc1 lds
    v_mfma_f32_16x16x32_bf16 v[80:83], a[48:51], a[40:43], v[80:83]
    ds_read_b64_tr_b16 a[16:17], v12 offset:0
    v_mfma_f32_16x16x32_bf16 v[88:91], a[48:51], a[44:47], v[88:91]
    ds_read_b64_tr_b16 a[18:19], v12 offset:4096
    v_mfma_f32_16x16x32_bf16 v[68:71], a[52:55], a[32:35], v[68:71]
    ds_read_b128 a[4:7], v6 offset:1024
    v_mfma_f32_16x16x32_bf16 v[76:79], a[52:55], a[36:39], v[76:79]
    ds_read_b128 a[8:11], v6 offset:2048
    buffer_load_dwordx4 v2, s[36:39], s56 offen offset:1024 sc1 lds
    v_mfma_f32_16x16x32_bf16 v[84:87], a[52:55], a[40:43], v[84:87]
    ds_read_b128 a[12:15], v6 offset:3072
    v_mfma_f32_16x16x32_bf16 v[92:95], a[52:55], a[44:47], v[92:95]
    ds_read_b64_tr_b16 a[20:21], v13 offset:0
    v_mfma_f32_16x16x32_bf16 v[96:99], a[56:59], a[32:35], v[96:99]
    ds_read_b64_tr_b16 a[22:23], v13 offset:4096
    v_mfma_f32_16x16x32_bf16 v[104:107], a[56:59], a[36:39], v[104:107]
    ds_read_b64_tr_b16 a[24:25], v14 offset:0
    buffer_load_dwordx4 v2, s[36:39], s56 offen offset:2048 sc1 lds
    v_mfma_f32_16x16x32_bf16 v[112:115], a[56:59], a[40:43], v[112:115]
    ds_read_b64_tr_b16 a[26:27], v14 offset:4096
    v_mfma_f32_16x16x32_bf16 v[120:123], a[56:59], a[44:47], v[120:123]
    ds_read_b64_tr_b16 a[28:29], v15 offset:0
    buffer_store_dwordx4 v[140:143], v2, s[8:11], s70 offen offset:3072 sc1
    s_add_u32 s70, s70, 4096
    v_mfma_f32_16x16x32_bf16 v[100:103], a[60:63], a[32:35], v[100:103]
    s_add_u32 s64, s64, 1
    ds_read_b64_tr_b16 a[30:31], v15 offset:4096
    v_mfma_f32_16x16x32_bf16 v[108:111], a[60:63], a[36:39], v[108:111]
    buffer_load_dwordx4 v2, s[36:39], s56 offen offset:3072 sc1 lds
    v_mfma_f32_16x16x32_bf16 v[116:119], a[60:63], a[40:43], v[116:119]
    s_add_u32 s56, s56, 262144
    v_mfma_f32_16x16x32_bf16 v[124:127], a[60:63], a[44:47], v[124:127]
    s_waitcnt lgkmcnt(9)
    v_mfma_f32_16x16x32_bf16 v[64:67], a[16:19], a[0:3], v[64:67]
    s_add_u32 m0, s59, 16384
    ds_read_b128 a[32:35], v6 offset:8192
    s_waitcnt lgkmcnt(9)
    v_mfma_f32_16x16x32_bf16 v[72:75], a[16:19], a[4:7], v[72:75]
    ds_read_b64_tr_b16 a[48:49], v12 offset:8192
    buffer_load_dwordx4 v16, s[24:27], s57 offen offset:0 sc1 lds
    s_waitcnt lgkmcnt(9)
    v_mfma_f32_16x16x32_bf16 v[80:83], a[16:19], a[8:11], v[80:83]
    s_add_u32 s59, s58, s60
    ds_read_b64_tr_b16 a[50:51], v12 offset:12288
    s_waitcnt lgkmcnt(9)
    v_mfma_f32_16x16x32_bf16 v[88:91], a[16:19], a[12:15], v[88:91]
    s_add_u32 s58, s58, 32768
    ds_read_b128 a[36:39], v6 offset:9216
    s_waitcnt lgkmcnt(8)
    v_mfma_f32_16x16x32_bf16 v[68:71], a[20:23], a[0:3], v[68:71]
    s_cmp_ge_u32 s58, 163840
    ds_read_b128 a[40:43], v6 offset:10240
    v_mfma_f32_16x16x32_bf16 v[76:79], a[20:23], a[4:7], v[76:79]
    ds_read_b128 a[44:47], v6 offset:11264
    buffer_load_dwordx4 v17, s[24:27], s57 offen offset:1024 sc1 lds
    v_mfma_f32_16x16x32_bf16 v[84:87], a[20:23], a[8:11], v[84:87]
    s_cselect_b32 s66, 4294836224, s100
    ds_read_b64_tr_b16 a[52:53], v13 offset:8192
    v_mfma_f32_16x16x32_bf16 v[92:95], a[20:23], a[12:15], v[92:95]
    s_cselect_b32 s58, 0, s58
    ds_read_b64_tr_b16 a[54:55], v13 offset:12288
    s_waitcnt lgkmcnt(10)
    v_mfma_f32_16x16x32_bf16 v[96:99], a[24:27], a[0:3], v[96:99]
    ds_read_b64_tr_b16 a[56:57], v14 offset:8192
    v_mfma_f32_16x16x32_bf16 v[104:107], a[24:27], a[4:7], v[104:107]
    ds_read_b64_tr_b16 a[58:59], v14 offset:12288
    buffer_load_dwordx4 v18, s[24:27], s57 offen offset:2048 sc1 lds
    v_mfma_f32_16x16x32_bf16 v[112:115], a[24:27], a[8:11], v[112:115]
    ds_read_b64_tr_b16 a[60:61], v15 offset:8192
    v_mfma_f32_16x16x32_bf16 v[120:123], a[24:27], a[12:15], v[120:123]
    ds_read_b64_tr_b16 a[62:63], v15 offset:12288
    buffer_store_dwordx4 v[144:147], v2, s[8:11], s70 offen offset:0 sc1
    s_waitcnt lgkmcnt(12)
    v_mfma_f32_16x16x32_bf16 v[100:103], a[28:31], a[0:3], v[100:103]
    v_add_u32 v6, s66, v6
    v_add_u32 v12, s66, v12
    v_mfma_f32_16x16x32_bf16 v[108:111], a[28:31], a[4:7], v[108:111]
    buffer_load_dwordx4 v19, s[24:27], s57 offen offset:3072 sc1 lds
    v_mfma_f32_16x16x32_bf16 v[116:119], a[28:31], a[8:11], v[116:119]
    s_add_u32 s57, s57, 131072
    v_add_u32 v13, s66, v13
    v_add_u32 v14, s66, v14
    v_mfma_f32_16x16x32_bf16 v[124:127], a[28:31], a[12:15], v[124:127]
    s_mov_b32 m0, s59
    v_add_u32 v15, s66, v15
    s_waitcnt vmcnt(24) lgkmcnt(0)
    v_mfma_f32_16x16x32_bf16 v[64:67], a[48:51], a[32:35], v[64:67]
    s_barrier
    v_mfma_f32_16x16x32_bf16 v[72:75], a[48:51], a[36:39], v[72:75]
    ds_read_b128 a[0:3], v6 offset:0
    buffer_load_dwordx4 v2, s[36:39], s56 offen offset:0 sc1 lds
    v_mfma_f32_16x16x32_bf16 v[80:83], a[48:51], a[40:43], v[80:83]
    ds_read_b64_tr_b16 a[16:17], v12 offset:0
    v_mfma_f32_16x16x32_bf16 v[88:91], a[48:51], a[44:47], v[88:91]
    ds_read_b64_tr_b16 a[18:19], v12 offset:4096
    v_mfma_f32_16x16x32_bf16 v[68:71], a[52:55], a[32:35], v[68:71]
    ds_read_b128 a[4:7], v6 offset:1024
    v_mfma_f32_16x16x32_bf16 v[76:79], a[52:55], a[36:39], v[76:79]
    ds_read_b128 a[8:11], v6 offset:2048
    buffer_load_dwordx4 v2, s[36:39], s56 offen offset:1024 sc1 lds
    v_mfma_f32_16x16x32_bf16 v[84:87], a[52:55], a[40:43], v[84:87]
    ds_read_b128 a[12:15], v6 offset:3072
    v_mfma_f32_16x16x32_bf16 v[92:95], a[52:55], a[44:47], v[92:95]
    ds_read_b64_tr_b16 a[20:21], v13 offset:0
    v_mfma_f32_16x16x32_bf16 v[96:99], a[56:59], a[32:35], v[96:99]
    ds_read_b64_tr_b16 a[22:23], v13 offset:4096
    v_mfma_f32_16x16x32_bf16 v[104:107], a[56:59], a[36:39], v[104:107]
    ds_read_b64_tr_b16 a[24:25], v14 offset:0
    buffer_load_dwordx4 v2, s[36:39], s56 offen offset:2048 sc1 lds
    v_mfma_f32_16x16x32_bf16 v[112:115], a[56:59], a[40:43], v[112:115]
    ds_read_b64_tr_b16 a[26:27], v14 offset:4096
    v_mfma_f32_16x16x32_bf16 v[120:123], a[56:59], a[44:47], v[120:123]
    ds_read_b64_tr_b16 a[28:29], v15 offset:0
    buffer_store_dwordx4 v[148:151], v2, s[8:11], s70 offen offset:1024 sc1
    v_mfma_f32_16x16x32_bf16 v[100:103], a[60:63], a[32:35], v[100:103]
    s_add_u32 s64, s64, 1
    ds_read_b64_tr_b16 a[30:31], v15 offset:4096
    v_mfma_f32_16x16x32_bf16 v[108:111], a[60:63], a[36:39], v[108:111]
    buffer_load_dwordx4 v2, s[36:39], s56 offen offset:3072 sc1 lds
    v_mfma_f32_16x16x32_bf16 v[116:119], a[60:63], a[40:43], v[116:119]
    s_add_u32 s56, s56, 262144
    v_mfma_f32_16x16x32_bf16 v[124:127], a[60:63], a[44:47], v[124:127]
    s_waitcnt lgkmcnt(9)
    v_mfma_f32_16x16x32_bf16 v[64:67], a[16:19], a[0:3], v[64:67]
    s_add_u32 m0, s59, 16384
    ds_read_b128 a[32:35], v6 offset:8192
    s_waitcnt lgkmcnt(9)
    v_mfma_f32_16x16x32_bf16 v[72:75], a[16:19], a[4:7], v[72:75]
    ds_read_b64_tr_b16 a[48:49], v12 offset:8192
    buffer_load_dwordx4 v16, s[24:27], s57 offen offset:0 sc1 lds
    s_waitcnt lgkmcnt(9)
    v_mfma_f32_16x16x32_bf16 v[80:83], a[16:19], a[8:11], v[80:83]
    s_add_u32 s59, s58, s60
    ds_read_b64_tr_b16 a[50:51], v12 offset:12288
    s_waitcnt lgkmcnt(9)
    v_mfma_f32_16x16x32_bf16 v[88:91], a[16:19], a[12:15], v[88:91]
    s_add_u32 s58, s58, 32768
    ds_read_b128 a[36:39], v6 offset:9216
    s_waitcnt lgkmcnt(8)
    v_mfma_f32_16x16x32_bf16 v[68:71], a[20:23], a[0:3], v[68:71]
    s_cmp_ge_u32 s58, 163840
    ds_read_b128 a[40:43], v6 offset:10240
    v_mfma_f32_16x16x32_bf16 v[76:79], a[20:23], a[4:7], v[76:79]
    ds_read_b128 a[44:47], v6 offset:11264
    buffer_load_dwordx4 v17, s[24:27], s57 offen offset:1024 sc1 lds
    v_mfma_f32_16x16x32_bf16 v[84:87], a[20:23], a[8:11], v[84:87]
    s_cselect_b32 s66, 4294836224, s100
    ds_read_b64_tr_b16 a[52:53], v13 offset:8192
    v_mfma_f32_16x16x32_bf16 v[92:95], a[20:23], a[12:15], v[92:95]
    s_cselect_b32 s58, 0, s58
    ds_read_b64_tr_b16 a[54:55], v13 offset:12288
    s_waitcnt lgkmcnt(10)
    v_mfma_f32_16x16x32_bf16 v[96:99], a[24:27], a[0:3], v[96:99]
    ds_read_b64_tr_b16 a[56:57], v14 offset:8192
    v_mfma_f32_16x16x32_bf16 v[104:107], a[24:27], a[4:7], v[104:107]
    ds_read_b64_tr_b16 a[58:59], v14 offset:12288
    buffer_load_dwordx4 v18, s[24:27], s57 offen offset:2048 sc1 lds
    v_mfma_f32_16x16x32_bf16 v[112:115], a[24:27], a[8:11], v[112:115]
    ds_read_b64_tr_b16 a[60:61], v15 offset:8192
    v_mfma_f32_16x16x32_bf16 v[120:123], a[24:27], a[12:15], v[120:123]
    ds_read_b64_tr_b16 a[62:63], v15 offset:12288
    buffer_store_dwordx4 v[152:155], v2, s[8:11], s70 offen offset:2048 sc1
    s_waitcnt lgkmcnt(12)
    v_mfma_f32_16x16x32_bf16 v[100:103], a[28:31], a[0:3], v[100:103]
    v_add_u32 v6, s66, v6
    v_add_u32 v12, s66, v12
    v_mfma_f32_16x16x32_bf16 v[108:111], a[28:31], a[4:7], v[108:111]
    buffer_load_dwordx4 v19, s[24:27], s57 offen offset:3072 sc1 lds
    v_mfma_f32_16x16x32_bf16 v[116:119], a[28:31], a[8:11], v[116:119]
    s_add_u32 s57, s57, 131072
    v_add_u32 v13, s66, v13
    v_add_u32 v14, s66, v14
    v_mfma_f32_16x16x32_bf16 v[124:127], a[28:31], a[12:15], v[124:127]
    s_mov_b32 m0, s59
    v_add_u32 v15, s66, v15
    s_waitcnt vmcnt(24) lgkmcnt(0)
    v_mfma_f32_16x16x32_bf16 v[64:67], a[48:51], a[32:35], v[64:67]
    s_barrier
    v_mfma_f32_16x16x32_bf16 v[72:75], a[48:51], a[36:39], v[72:75]
    ds_read_b128 a[0:3], v6 offset:0
    buffer_load_dwordx4 v2, s[36:39], s56 offen offset:0 sc1 lds
    v_mfma_f32_16x16x32_bf16 v[80:83], a[48:51], a[40:43], v[80:83]
    ds_read_b64_tr_b16 a[16:17], v12 offset:0
    v_mfma_f32_16x16x32_bf16 v[88:91], a[48:51], a[44:47], v[88:91]
    ds_read_b64_tr_b16 a[18:19], v12 offset:4096
    v_mfma_f32_16x16x32_bf16 v[68:71], a[52:55], a[32:35], v[68:71]
    ds_read_b128 a[4:7], v6 offset:1024
    v_mfma_f32_16x16x32_bf16 v[76:79], a[52:55], a[36:39], v[76:79]
    ds_read_b128 a[8:11], v6 offset:2048
    buffer_load_dwordx4 v2, s[36:39], s56 offen offset:1024 sc1 lds
    v_mfma_f32_16x16x32_bf16 v[84:87], a[52:55], a[40:43], v[84:87]
    ds_read_b128 a[12:15], v6 offset:3072
    v_mfma_f32_16x16x32_bf16 v[92:95], a[52:55], a[44:47], v[92:95]
    ds_read_b64_tr_b16 a[20:21], v13 offset:0
    v_mfma_f32_16x16x32_bf16 v[96:99], a[56:59], a[32:35], v[96:99]
    ds_read_b64_tr_b16 a[22:23], v13 offset:4096
    v_mfma_f32_16x16x32_bf16 v[104:107], a[56:59], a[36:39], v[104:107]
    ds_read_b64_tr_b16 a[24:25], v14 offset:0
    buffer_load_dwordx4 v2, s[36:39], s56 offen offset:2048 sc1 lds
    v_mfma_f32_16x16x32_bf16 v[112:115], a[56:59], a[40:43], v[112:115]
    ds_read_b64_tr_b16 a[26:27], v14 offset:4096
    v_mfma_f32_16x16x32_bf16 v[120:123], a[56:59], a[44:47], v[120:123]
    ds_read_b64_tr_b16 a[28:29], v15 offset:0
    buffer_store_dwordx4 v[156:159], v2, s[8:11], s70 offen offset:3072 sc1
    s_add_u32 s70, s70, 4096
    v_mfma_f32_16x16x32_bf16 v[100:103], a[60:63], a[32:35], v[100:103]
    s_add_u32 s64, s64, 1
    ds_read_b64_tr_b16 a[30:31], v15 offset:4096
    v_mfma_f32_16x16x32_bf16 v[108:111], a[60:63], a[36:39], v[108:111]
    buffer_load_dwordx4 v2, s[36:39], s56 offen offset:3072 sc1 lds
    v_mfma_f32_16x16x32_bf16 v[116:119], a[60:63], a[40:43], v[116:119]
    s_add_u32 s56, s56, 262144
    v_mfma_f32_16x16x32_bf16 v[124:127], a[60:63], a[44:47], v[124:127]
    s_mov_b32 s67, 32
    s_branch m_l3132
m_n163:
    s_cmp_lg_u32 s64, 32
    s_cbranch_scc1 m_n164
    s_lshl_b32 s91, s96, 3
    s_add_u32 s91, s91, s97
    s_lshl_b32 s91, s91, 7
    s_add_u32 s91, s91, 16384
    s_cmp_lg_u32 s16, 0
    s_cbranch_scc1 m_np165
    v_mov_b32 v60, s4
    v_mov_b32 v61, s5
    s_add_u32 s90, s91, 117440512
    s_mov_b64 exec, 1
    buffer_store_dwordx2 v[60:61], off, s[8:11], s90 sc1
    s_mov_b64 exec, -1
m_np165:
    s_mov_b32 s67, 35
    s_branch m_l3132
m_n164:
    s_cmp_lg_u32 s64, 35
    s_cbranch_scc1 m_n166
    s_mov_b32 s38, 0
    s_mov_b32 s67, 40
    s_branch m_l3132
m_n166:
    s_branch m_l3x134
m_l3c135:
    s_mov_b32 s67, 34
    s_cmp_lt_u32 s64, 34
    s_cbranch_scc1 m_l3n136
    s_cmp_lg_u32 s64, 34
    s_cbranch_scc1 m_n168
    s_mov_b32 s68, 1000
    s_mov_b32 s67, 35
    s_branch m_l3132
m_n168:
    s_cmp_lg_u32 s64, 35
    s_cbranch_scc1 m_n169
    s_mov_b32 s38, 0
    s_lshl_b32 s91, s96, 3
    s_add_u32 s91, s91, s97
    s_lshl_b32 s91, s91, 7
    s_add_u32 s91, s91, 16384
    s_add_u32 s52, s91, 117440512
    buffer_load_dwordx2 v[4:5], off, s[8:11], s52 sc1
    s_mov_b32 s67, 36
    s_branch m_l3132
m_n169:
    s_cmp_lg_u32 s64, 36
    s_cbranch_scc1 m_n170
    s_mov_b32 s26, 0
    s_mov_b32 s67, 37
    s_branch m_l3132
m_n170:
    s_cmp_lg_u32 s64, 37
    s_cbranch_scc1 m_n171
    s_waitcnt vmcnt(16)
    s_mov_b32 s3, 1048576
m_spin172:
    v_cmp_ne_u64 s[76:77], s[4:5], v[4:5]
    s_nop 3
    s_cmp_eq_u64 s[76:77], 0
    s_cbranch_scc1 m_ok173
    s_sub_u32 s3, s3, 1
    s_cbranch_scc1 m_ok173
    s_sleep 8
    buffer_load_dwordx2 v[4:5], off, s[8:11], s52 sc1
    s_waitcnt vmcnt(0)
    s_branch m_spin172
m_ok173:
    s_lshl_b32 s90, s96, 3
    s_add_u32 s90, s90, s97
    s_lshl_b32 s90, s90, 15
    s_lshl_b32 s91, s16, 13
    s_add_u32 s90, s90, s91
    s_add_u32 s70, s90, 100663296
    buffer_load_dwordx4 v[128:131], v2, s[8:11], s70 offen offset:0 sc1
    buffer_load_dwordx4 v[132:135], v2, s[8:11], s70 offen offset:1024 sc1
    buffer_load_dwordx4 v[136:139], v2, s[8:11], s70 offen offset:2048 sc1
    buffer_load_dwordx4 v[140:143], v2, s[8:11], s70 offen offset:3072 sc1
    s_add_u32 s70, s70, 4096
    buffer_load_dwordx4 v[144:147], v2, s[8:11], s70 offen offset:0 sc1
    buffer_load_dwordx4 v[148:151], v2, s[8:11], s70 offen offset:1024 sc1
    buffer_load_dwordx4 v[152:155], v2, s[8:11], s70 offen offset:2048 sc1
    buffer_load_dwordx4 v[156:159], v2, s[8:11], s70 offen offset:3072 sc1
    s_mov_b32 s67, 40
    s_branch m_l3132
m_n171:
    s_branch m_l3x134
m_o1156:
    s_and_b32 s91, s2, 7
    s_lshl_b32 s91, s91, 5
    s_lshr_b32 s92, s2, 3
    s_add_u32 s91, s91, s92
    s_lshl_b32 s91, s91, 3
    s_add_u32 s91, s91, 12288
    s_cmp_lg_u32 s16, 0
    s_cbranch_scc1 m_np175
    v_mov_b32 v60, s4
    v_mov_b32 v61, s5
    s_add_u32 s90, s91, 117440512
    s_mov_b64 exec, 1
    buffer_store_dwordx2 v[60:61], off, s[8:11], s90 sc1
    s_mov_b64 exec, -1
m_np175:
    s_branch m_o2157
m_l3n136:
    s_sub_u32 s90, s68, 5
    s_min_u32 s67, s67, s90
    s_branch m_l3132
m_l3x134:
    s_cmp_eq_u32 s95, 1
    s_cbranch_scc1 m_noadd176
    s_waitcnt vmcnt(0)
    v_lshlrev_b32 v160, 16, v128
    v_and_b32 v161, 0xffff0000, v128
    v_lshlrev_b32 v162, 16, v129
    v_and_b32 v163, 0xffff0000, v129
    v_lshlrev_b32 v164, 16, v130
    v_and_b32 v165, 0xffff0000, v130
    v_lshlrev_b32 v166, 16, v131
    v_and_b32 v167, 0xffff0000, v131
    v_lshlrev_b32 v168, 16, v132
    v_and_b32 v169, 0xffff0000, v132
    v_lshlrev_b32 v170, 16, v133
    v_and_b32 v171, 0xffff0000, v133
    v_lshlrev_b32 v172, 16, v134
    v_and_b32 v173, 0xffff0000, v134
    v_lshlrev_b32 v174, 16, v135
    v_and_b32 v175, 0xffff0000, v135
    v_lshlrev_b32 v176, 16, v136
    v_and_b32 v177, 0xffff0000, v136
    v_lshlrev_b32 v178, 16, v137
    v_and_b32 v179, 0xffff0000, v137
    v_lshlrev_b32 v180, 16, v138
    v_and_b32 v181, 0xffff0000, v138
    v_lshlrev_b32 v182, 16, v139
    v_and_b32 v183, 0xffff0000, v139
    v_lshlrev_b32 v184, 16, v140
    v_and_b32 v185, 0xffff0000, v140
    v_lshlrev_b32 v186, 16, v141
    v_and_b32 v187, 0xffff0000, v141
    v_lshlrev_b32 v188, 16, v142
    v_and_b32 v189, 0xffff0000, v142
    v_lshlrev_b32 v190, 16, v143
    v_and_b32 v191, 0xffff0000, v143
    v_lshlrev_b32 v192, 16, v144
    v_and_b32 v193, 0xffff0000, v144
    v_lshlrev_b32 v194, 16, v145
    v_and_b32 v195, 0xffff0000, v145
    v_lshlrev_b32 v196, 16, v146
    v_and_b32 v197, 0xffff0000, v146
    v_lshlrev_b32 v198, 16, v147
    v_and_b32 v199, 0xffff0000, v147
    v_lshlrev_b32 v200, 16, v148
    v_and_b32 v201, 0xffff0000, v148
    v_lshlrev_b32 v202, 16, v149
    v_and_b32 v203, 0xffff0000, v149
    v_lshlrev_b32 v204, 16, v150
    v_and_b32 v205, 0xffff0000, v150
    v_lshlrev_b32 v206, 16, v151
    v_and_b32 v207, 0xffff0000, v151
    v_lshlrev_b32 v208, 16, v152
    v_and_b32 v209, 0xffff0000, v152
    v_lshlrev_b32 v210, 16, v153
    v_and_b32 v211, 0xffff0000, v153
    v_lshlrev_b32 v212, 16, v154
    v_and_b32 v213, 0xffff0000, v154
    v_lshlrev_b32 v214, 16, v155
    v_and_b32 v215, 0xffff0000, v155
    v_lshlrev_b32 v216, 16, v156
    v_and_b32 v217, 0xffff0000, v156
    v_lshlrev_b32 v218, 16, v157
    v_and_b32 v219, 0xffff0000, v157
    v_lshlrev_b32 v220, 16, v158
    v_and_b32 v221, 0xffff0000, v158
    v_lshlrev_b32 v222, 16, v159
    v_and_b32 v223, 0xffff0000, v159
    v_pk_add_f32 v[64:65], v[64:65], v[160:161]
    v_pk_add_f32 v[66:67], v[66:67], v[162:163]
    v_pk_add_f32 v[68:69], v[68:69], v[164:165]
    v_pk_add_f32 v[70:71], v[70:71], v[166:167]
    v_pk_add_f32 v[72:73], v[72:73], v[168:169]
    v_pk_add_f32 v[74:75], v[74:75], v[170:171]
    v_pk_add_f32 v[76:77], v[76:77], v[172:173]
    v_pk_add_f32 v[78:79], v[78:79], v[174:175]
    v_pk_add_f32 v[80:81], v[80:81], v[176:177]
    v_pk_add_f32 v[82:83], v[82:83], v[178:179]
    v_pk_add_f32 v[84:85], v[84:85], v[180:181]
    v_pk_add_f32 v[86:87], v[86:87], v[182:183]
    v_pk_add_f32 v[88:89], v[88:89], v[184:185]
    v_pk_add_f32 v[90:91], v[90:91], v[186:187]
    v_pk_add_f32 v[92:93], v[92:93], v[188:189]
    v_pk_add_f32 v[94:95], v[94:95], v[190:191]
    v_pk_add_f32 v[96:97], v[96:97], v[192:193]
    v_pk_add_f32 v[98:99], v[98:99], v[194:195]
    v_pk_add_f32 v[100:101], v[100:101], v[196:197]
    v_pk_add_f32 v[102:103], v[102:103], v[198:199]
    v_pk_add_f32 v[104:105], v[104:105], v[200:201]
    v_pk_add_f32 v[106:107], v[106:107], v[202:203]
    v_pk_add_f32 v[108:109], v[108:109], v[204:205]
    v_pk_add_f32 v[110:111], v[110:111], v[206:207]
    v_pk_add_f32 v[112:113], v[112:113], v[208:209]
    v_pk_add_f32 v[114:115], v[114:115], v[210:211]
    v_pk_add_f32 v[116:117], v[116:117], v[212:213]
    v_pk_add_f32 v[118:119], v[118:119], v[214:215]
    v_pk_add_f32 v[120:121], v[120:121], v[216:217]
    v_pk_add_f32 v[122:123], v[122:123], v[218:219]
    v_pk_add_f32 v[124:125], v[124:125], v[220:221]
    v_pk_add_f32 v[126:127], v[126:127], v[222:223]
m_noadd176:
    v_cvt_pk_bf16_f32 v64, v64, v65
    v_cvt_pk_bf16_f32 v65, v66, v67
    v_cvt_pk_bf16_f32 v66, v68, v69
    v_cvt_pk_bf16_f32 v67, v70, v71
    v_cvt_pk_bf16_f32 v96, v96, v97
    v_cvt_pk_bf16_f32 v97, v98, v99
    v_cvt_pk_bf16_f32 v98, v100, v101
    v_cvt_pk_bf16_f32 v99, v102, v103
    s_nop 1
    v_permlane16_swap_b32 v64, v66
    v_permlane16_swap_b32 v65, v67
    v_permlane16_swap_b32 v96, v98
    v_permlane16_swap_b32 v97, v99
    buffer_store_dwordx4 v[64:67], v7, s[28:31], s71 offen offset:0 sc1
    buffer_store_dwordx4 v[96:99], v7, s[28:31], s71 offen offset:64 sc1
    s_add_u32 s71, s71, s72
    v_cvt_pk_bf16_f32 v72, v72, v73
    v_cvt_pk_bf16_f32 v73, v74, v75
    v_cvt_pk_bf16_f32 v74, v76, v77
    v_cvt_pk_bf16_f32 v75, v78, v79
    v_cvt_pk_bf16_f32 v104, v104, v105
    v_cvt_pk_bf16_f32 v105, v106, v107
    v_cvt_pk_bf16_f32 v106, v108, v109
    v_cvt_pk_bf16_f32 v107, v110, v111
    s_nop 1
    v_permlane16_swap_b32 v72, v74
    v_permlane16_swap_b32 v73, v75
    v_permlane16_swap_b32 v104, v106
    v_permlane16_swap_b32 v105, v107
    buffer_store_dwordx4 v[72:75], v7, s[28:31], s71 offen offset:0 sc1
    buffer_store_dwordx4 v[104:107], v7, s[28:31], s71 offen offset:64 sc1
    s_add_u32 s71, s71, s72
    v_cvt_pk_bf16_f32 v80, v80, v81
    v_cvt_pk_bf16_f32 v81, v82, v83
    v_cvt_pk_bf16_f32 v82, v84, v85
    v_cvt_pk_bf16_f32 v83, v86, v87
    v_cvt_pk_bf16_f32 v112, v112, v113
    v_cvt_pk_bf16_f32 v113, v114, v115
    v_cvt_pk_bf16_f32 v114, v116, v117
    v_cvt_pk_bf16_f32 v115, v118, v119
    s_nop 1
    v_permlane16_swap_b32 v80, v82
    v_permlane16_swap_b32 v81, v83
    v_permlane16_swap_b32 v112, v114
    v_permlane16_swap_b32 v113, v115
    buffer_store_dwordx4 v[80:83], v7, s[28:31], s71 offen offset:0 sc1
    buffer_store_dwordx4 v[112:115], v7, s[28:31], s71 offen offset:64 sc1
    s_add_u32 s71, s71, s72
    v_cvt_pk_bf16_f32 v88, v88, v89
    v_cvt_pk_bf16_f32 v89, v90, v91
    v_cvt_pk_bf16_f32 v90, v92, v93
    v_cvt_pk_bf16_f32 v91, v94, v95
    v_cvt_pk_bf16_f32 v120, v120, v121
    v_cvt_pk_bf16_f32 v121, v122, v123
    v_cvt_pk_bf16_f32 v122, v124, v125
    v_cvt_pk_bf16_f32 v123, v126, v127
    s_nop 1
    v_permlane16_swap_b32 v88, v90
    v_permlane16_swap_b32 v89, v91
    v_permlane16_swap_b32 v120, v122
    v_permlane16_swap_b32 v121, v123
    buffer_store_dwordx4 v[88:91], v7, s[28:31], s71 offen offset:0 sc1
    buffer_store_dwordx4 v[120:123], v7, s[28:31], s71 offen offset:64 sc1
    s_add_u32 s71, s71, s72
m_end1:
    s_endpgm
m_stub76:
    v_cmp_lt_f32 vcc, s65, v8
    s_cmp_lg_u32 s64, s67
    s_cbranch_scc1 m_e178
    v_add_f32 v176, v176, v16
    v_mov_b32 v180, v9
    v_add_f32 v188, v188, v16
    v_add_f32 v177, v177, v17
    v_mov_b32 v181, v9
    v_add_f32 v189, v189, v17
    v_add_f32 v178, v178, v18
    v_mov_b32 v182, v9
    v_add_f32 v190, v190, v18
    v_add_f32 v179, v179, v19
    v_mov_b32 v183, v9
    v_add_f32 v191, v191, v19
    s_nop 0
m_e178:
    s_cmp_lg_u32 s64, s68
    s_cbranch_scc1 m_e179
    v_mov_b32 v176, v9
    v_mov_b32 v184, v9
    v_mov_b32 v188, v9
    v_mov_b32 v177, v9
    v_mov_b32 v185, v9
    v_mov_b32 v189, v9
    v_mov_b32 v178, v9
    v_mov_b32 v186, v9
    v_mov_b32 v190, v9
    v_mov_b32 v179, v9
    v_mov_b32 v187, v9
    v_mov_b32 v191, v9
    s_nop 0
m_e179:
    s_cbranch_vccnz m_rc180
m_sp177:
    s_branch m_ret77
m_stub79:
    v_cmp_lt_f32 vcc, s65, v8
    s_cmp_lg_u32 s64, s67
    s_cbranch_scc1 m_e182
    v_add_f32 v176, v176, v16
    v_mov_b32 v180, v9
    v_add_f32 v188, v188, v16
    v_add_f32 v177, v177, v17
    v_mov_b32 v181, v9
    v_add_f32 v189, v189, v17
    v_add_f32 v178, v178, v18
    v_mov_b32 v182, v9
    v_add_f32 v190, v190, v18
    v_add_f32 v179, v179, v19
    v_mov_b32 v183, v9
    v_add_f32 v191, v191, v19
    s_nop 0
m_e182:
    s_cmp_lg_u32 s64, s68
    s_cbranch_scc1 m_e183
    v_mov_b32 v176, v9
    v_mov_b32 v184, v9
    v_mov_b32 v188, v9
    v_mov_b32 v177, v9
    v_mov_b32 v185, v9
    v_mov_b32 v189, v9
    v_mov_b32 v178, v9
    v_mov_b32 v186, v9
    v_mov_b32 v190, v9
    v_mov_b32 v179, v9
    v_mov_b32 v187, v9
    v_mov_b32 v191, v9
    s_nop 0
m_e183:
    s_cbranch_vccnz m_rc184
m_sp181:
    s_branch m_ret80
m_stub97:
    v_cmp_lt_f32 vcc, s65, v8
    s_cmp_lg_u32 s64, s70
    s_cbranch_scc1 m_e186
    v_add_f32 v160, v160, v16
    v_mov_b32 v164, v9
    v_add_f32 v172, v172, v16
    v_add_f32 v161, v161, v17
    v_mov_b32 v165, v9
    v_add_f32 v173, v173, v17
    v_add_f32 v162, v162, v18
    v_mov_b32 v166, v9
    v_add_f32 v174, v174, v18
    v_add_f32 v163, v163, v19
    v_mov_b32 v167, v9
    v_add_f32 v175, v175, v19
    s_nop 0
m_e186:
    s_cmp_lg_u32 s64, s71
    s_cbranch_scc1 m_e187
    v_mov_b32 v160, v9
    v_mov_b32 v168, v9
    v_mov_b32 v172, v9
    v_mov_b32 v161, v9
    v_mov_b32 v169, v9
    v_mov_b32 v173, v9
    v_mov_b32 v162, v9
    v_mov_b32 v170, v9
    v_mov_b32 v174, v9
    v_mov_b32 v163, v9
    v_mov_b32 v171, v9
    v_mov_b32 v175, v9
    s_nop 0
m_e187:
    s_cbranch_vccnz m_rc188
m_sp185:
    s_branch m_ret98
m_stub99:
    v_cmp_lt_f32 vcc, s65, v8
    s_cmp_lg_u32 s64, s70
    s_cbranch_scc1 m_e190
    v_add_f32 v160, v160, v16
    v_mov_b32 v164, v9
    v_add_f32 v172, v172, v16
    v_add_f32 v161, v161, v17
    v_mov_b32 v165, v9
    v_add_f32 v173, v173, v17
    v_add_f32 v162, v162, v18
    v_mov_b32 v166, v9
    v_add_f32 v174, v174, v18
    v_add_f32 v163, v163, v19
    v_mov_b32 v167, v9
    v_add_f32 v175, v175, v19
    s_nop 0
m_e190:
    s_cmp_lg_u32 s64, s71
    s_cbranch_scc1 m_e191
    v_mov_b32 v160, v9
    v_mov_b32 v168, v9
    v_mov_b32 v172, v9
    v_mov_b32 v161, v9
    v_mov_b32 v169, v9
    v_mov_b32 v173, v9
    v_mov_b32 v162, v9
    v_mov_b32 v170, v9
    v_mov_b32 v174, v9
    v_mov_b32 v163, v9
    v_mov_b32 v171, v9
    v_mov_b32 v175, v9
    s_nop 0
m_e191:
    s_cmp_lg_u32 s64, s53
    s_cbranch_scc1 m_e194
    s_cmp_lg_u32 s16, 0
    s_cbranch_scc1 m_np195
    v_mov_b32 v60, s4
    v_mov_b32 v61, s5
    s_add_u32 s90, s101, 117440512
    s_mov_b64 exec, 1
    buffer_store_dwordx2 v[60:61], off, s[8:11], s90 sc1
    s_mov_b64 exec, -1
m_np195:
    s_mov_b32 s101, -1
m_e194:
    s_cmp_gt_u32 s64, 24
    s_cbranch_scc1 m_e192
    s_cmp_lg_u32 s64, 8
    s_cbranch_scc1 m_e196
    s_lshr_b32 s90, s32, 1
    s_lshl_b32 s90, s90, 7
    s_add_u32 s90, s90, 117440600
    v_min_u32 v0, 1, v1
    v_lshlrev_b32 v0, 5, v0
    buffer_load_dwordx2 v[4:5], v0, s[8:11], s90 offen sc1
    s_cmp_eq_u32 s17, -1
    s_cbranch_scc1 m_e192
    s_cmp_lg_u32 s16, 0
    s_cbranch_scc1 m_np197
    v_mov_b32 v60, s4
    v_mov_b32 v61, s5
    s_add_u32 s90, s17, 117440512
    s_mov_b64 exec, 1
    buffer_store_dwordx2 v[60:61], off, s[8:11], s90 sc1
    s_mov_b64 exec, -1
m_np197:
    s_branch m_e192
m_e196:
    s_cmp_lg_u32 s64, 16
    s_cbranch_scc1 m_e198
    s_waitcnt vmcnt(18)
    s_mov_b32 s3, 1048576
m_spin199:
    v_cmp_ne_u64 s[76:77], s[4:5], v[4:5]
    s_nop 3
    s_cmp_eq_u64 s[76:77], 0
    s_cbranch_scc1 m_e192
    s_sub_u32 s3, s3, 1
    s_cbranch_scc1 m_e192
    s_sleep 32
    s_lshr_b32 s90, s32, 1
    s_lshl_b32 s90, s90, 7
    s_add_u32 s90, s90, 117440600
    v_min_u32 v0, 1, v1
    v_lshlrev_b32 v0, 5, v0
    buffer_load_dwordx2 v[4:5], v0, s[8:11], s90 offen sc1
    s_waitcnt vmcnt(0)
    s_branch m_spin199
    s_branch m_e192
m_e198:
    s_cmp_lg_u32 s64, 20
    s_cbranch_scc1 m_e200
    buffer_load_dwordx2 v[4:5], v10, s[8:11], 0 offen sc1
    s_mov_b32 s44, s48
    s_mov_b32 s45, s49
    s_mov_b32 s46, 8388608
    s_lshl_b32 s90, s2, 2
    s_add_u32 s90, s90, s16
    s_lshl_b32 s90, s90, 13
    v_lshlrev_b32 v62, 7, v1
    buffer_load_dword v255, v62, s[44:47], s90 offen
    s_branch m_e192
m_e200:
    s_cmp_lg_u32 s64, 24
    s_cbranch_scc1 m_e201
    s_mov_b32 s44, s50
    s_mov_b32 s45, s51
    s_mov_b32 s46, 2097152
    s_lshl_b32 s90, s2, 2
    s_add_u32 s90, s90, s16
    s_lshl_b32 s90, s90, 13
    v_lshlrev_b32 v62, 7, v1
    buffer_load_dword v255, v62, s[44:47], s90 offen
    s_waitcnt vmcnt(18)
    s_mov_b32 s3, 1048576
m_spin202:
    v_cmp_ne_u64 s[76:77], s[4:5], v[4:5]
    s_nop 3
    s_cmp_eq_u64 s[76:77], 0
    s_cbranch_scc1 m_e192
    s_sub_u32 s3, s3, 1
    s_cbranch_scc1 m_e192
    s_sleep 32
    buffer_load_dwordx2 v[4:5], v10, s[8:11], 0 offen sc1
    s_waitcnt vmcnt(0)
    s_branch m_spin202
    s_branch m_e192
m_e201:
m_e192:
    s_cbranch_vccnz m_rc203
m_sp189:
    s_branch m_ret100
m_stub103:
    v_cmp_lt_f32 vcc, s65, v8
    s_cmp_lg_u32 s64, s70
    s_cbranch_scc1 m_e205
    v_add_f32 v160, v160, v16
    v_mov_b32 v164, v9
    v_add_f32 v172, v172, v16
    v_add_f32 v161, v161, v17
    v_mov_b32 v165, v9
    v_add_f32 v173, v173, v17
    v_add_f32 v162, v162, v18
    v_mov_b32 v166, v9
    v_add_f32 v174, v174, v18
    v_add_f32 v163, v163, v19
    v_mov_b32 v167, v9
    v_add_f32 v175, v175, v19
    s_nop 0
m_e205:
    s_cmp_lg_u32 s64, s71
    s_cbranch_scc1 m_e206
    v_mov_b32 v160, v9
    v_mov_b32 v168, v9
    v_mov_b32 v172, v9
    v_mov_b32 v161, v9
    v_mov_b32 v169, v9
    v_mov_b32 v173, v9
    v_mov_b32 v162, v9
    v_mov_b32 v170, v9
    v_mov_b32 v174, v9
    v_mov_b32 v163, v9
    v_mov_b32 v171, v9
    v_mov_b32 v175, v9
    s_nop 0
m_e206:
    s_cbranch_vccnz m_rc207
m_sp204:
    s_branch m_ret104
m_stub120:
    v_cmp_lt_f32 vcc, s65, v8
    s_cbranch_vccnz m_rc209
m_sp208:
    s_branch m_ret121
m_rc96:
    s_call_b64 s[74:75], m_rs0470
    s_branch m_sp81
m_rc119:
    s_call_b64 s[74:75], m_rs0269
    s_branch m_sp105
m_rc180:
    s_call_b64 s[74:75], m_rs0470
    s_branch m_sp177
m_rc184:
    s_call_b64 s[74:75], m_rs1472
    s_branch m_sp181
m_rc188:
    s_call_b64 s[74:75], m_rs1472
    s_branch m_sp185
m_rc203:
    s_call_b64 s[74:75], m_rs0269
    s_branch m_sp189
m_rc207:
    s_call_b64 s[74:75], m_rs1271
    s_branch m_sp204
m_rc209:
    s_call_b64 s[74:75], m_rs1271
    s_branch m_sp208
m_rs0269:
    s_nop 15
    v_max3_f32 v48, v64, v65, v66
    v_max3_f32 v48, v48, v67, v68
    v_max3_f32 v48, v48, v69, v70
    v_max3_f32 v48, v48, v71, 0
    v_mov_b32 v49, v48
    s_nop 1
    v_permlane32_swap_b32 v48, v49
    s_nop 1
    v_max_f32 v48, v48, v49
    v_mov_b32 v49, v48
    s_nop 1
    v_permlane16_swap_b32 v48, v49
    s_nop 1
    v_max_f32 v48, v48, v49
    v_exp_f32 v49, -v48
    v_sub_f32 v64, v64, v48
    v_sub_f32 v65, v65, v48
    v_sub_f32 v66, v66, v48
    v_sub_f32 v67, v67, v48
    v_sub_f32 v68, v68, v48
    v_sub_f32 v69, v69, v48
    v_sub_f32 v70, v70, v48
    v_sub_f32 v71, v71, v48
    v_sub_f32 v96, v96, v48
    v_sub_f32 v97, v97, v48
    v_sub_f32 v98, v98, v48
    v_sub_f32 v99, v99, v48
    v_sub_f32 v100, v100, v48
    v_sub_f32 v101, v101, v48
    v_sub_f32 v102, v102, v48
    v_sub_f32 v103, v103, v48
    v_sub_f32 v160, v160, v48
    v_sub_f32 v161, v161, v48
    v_sub_f32 v162, v162, v48
    v_sub_f32 v163, v163, v48
    v_sub_f32 v164, v164, v48
    v_sub_f32 v165, v165, v48
    v_sub_f32 v166, v166, v48
    v_sub_f32 v167, v167, v48
    v_mul_f32 v12, v12, v49
    v_accvgpr_read_b32 v52, a0
    v_accvgpr_read_b32 v53, a1
    v_accvgpr_read_b32 v54, a2
    v_accvgpr_read_b32 v55, a3
    v_accvgpr_read_b32 v56, a4
    v_accvgpr_read_b32 v57, a5
    v_accvgpr_read_b32 v58, a6
    v_accvgpr_read_b32 v59, a7
    v_mul_f32 v52, v52, v49
    v_mul_f32 v53, v53, v49
    v_mul_f32 v54, v54, v49
    v_mul_f32 v55, v55, v49
    v_mul_f32 v56, v56, v49
    v_mul_f32 v57, v57, v49
    v_mul_f32 v58, v58, v49
    v_mul_f32 v59, v59, v49
    v_accvgpr_write_b32 a0, v52
    v_accvgpr_write_b32 a1, v53
    v_accvgpr_write_b32 a2, v54
    v_accvgpr_write_b32 a3, v55
    v_accvgpr_write_b32 a4, v56
    v_accvgpr_write_b32 a5, v57
    v_accvgpr_write_b32 a6, v58
    v_accvgpr_write_b32 a7, v59
    v_accvgpr_read_b32 v52, a8
    v_accvgpr_read_b32 v53, a9
    v_accvgpr_read_b32 v54, a10
    v_accvgpr_read_b32 v55, a11
    v_accvgpr_read_b32 v56, a12
    v_accvgpr_read_b32 v57, a13
    v_accvgpr_read_b32 v58, a14
    v_accvgpr_read_b32 v59, a15
    v_mul_f32 v52, v52, v49
    v_mul_f32 v53, v53, v49
    v_mul_f32 v54, v54, v49
    v_mul_f32 v55, v55, v49
    v_mul_f32 v56, v56, v49
    v_mul_f32 v57, v57, v49
    v_mul_f32 v58, v58, v49
    v_mul_f32 v59, v59, v49
    v_accvgpr_write_b32 a8, v52
    v_accvgpr_write_b32 a9, v53
    v_accvgpr_write_b32 a10, v54
    v_accvgpr_write_b32 a11, v55
    v_accvgpr_write_b32 a12, v56
    v_accvgpr_write_b32 a13, v57
    v_accvgpr_write_b32 a14, v58
    v_accvgpr_write_b32 a15, v59
    v_accvgpr_read_b32 v52, a16
    v_accvgpr_read_b32 v53, a17
    v_accvgpr_read_b32 v54, a18
    v_accvgpr_read_b32 v55, a19
    v_accvgpr_read_b32 v56, a20
    v_accvgpr_read_b32 v57, a21
    v_accvgpr_read_b32 v58, a22
    v_accvgpr_read_b32 v59, a23
    v_mul_f32 v52, v52, v49
    v_mul_f32 v53, v53, v49
    v_mul_f32 v54, v54, v49
    v_mul_f32 v55, v55, v49
    v_mul_f32 v56, v56, v49
    v_mul_f32 v57, v57, v49
    v_mul_f32 v58, v58, v49
    v_mul_f32 v59, v59, v49
    v_accvgpr_write_b32 a16, v52
    v_accvgpr_write_b32 a17, v53
    v_accvgpr_write_b32 a18, v54
    v_accvgpr_write_b32 a19, v55
    v_accvgpr_write_b32 a20, v56
    v_accvgpr_write_b32 a21, v57
    v_accvgpr_write_b32 a22, v58
    v_accvgpr_write_b32 a23, v59
    v_accvgpr_read_b32 v52, a24
    v_accvgpr_read_b32 v53, a25
    v_accvgpr_read_b32 v54, a26
    v_accvgpr_read_b32 v55, a27
    v_accvgpr_read_b32 v56, a28
    v_accvgpr_read_b32 v57, a29
    v_accvgpr_read_b32 v58, a30
    v_accvgpr_read_b32 v59, a31
    v_mul_f32 v52, v52, v49
    v_mul_f32 v53, v53, v49
    v_mul_f32 v54, v54, v49
    v_mul_f32 v55, v55, v49
    v_mul_f32 v56, v56, v49
    v_mul_f32 v57, v57, v49
    v_mul_f32 v58, v58, v49
    v_mul_f32 v59, v59, v49
    v_accvgpr_write_b32 a24, v52
    v_accvgpr_write_b32 a25, v53
    v_accvgpr_write_b32 a26, v54
    v_accvgpr_write_b32 a27, v55
    v_accvgpr_write_b32 a28, v56
    v_accvgpr_write_b32 a29, v57
    v_accvgpr_write_b32 a30, v58
    v_accvgpr_write_b32 a31, v59
    v_exp_f32 v52, v64
    v_exp_f32 v53, v65
    v_exp_f32 v54, v66
    v_exp_f32 v55, v67
    v_exp_f32 v56, v68
    v_exp_f32 v57, v69
    v_exp_f32 v58, v70
    v_exp_f32 v59, v71
    s_nop 0
    v_cvt_pk_bf16_f32 v128, v52, v53
    v_cvt_pk_bf16_f32 v129, v54, v55
    v_cvt_pk_bf16_f32 v130, v56, v57
    v_cvt_pk_bf16_f32 v131, v58, v59
    s_nop 1
    v_mfma_f32_16x16x32_bf16 v[28:31], v[44:47], v[128:131], 0
    v_max3_f32 v48, v72, v73, v74
    v_max3_f32 v48, v48, v75, v76
    v_max3_f32 v48, v48, v77, v78
    v_max3_f32 v48, v48, v79, 0
    v_mov_b32 v49, v48
    s_nop 1
    v_permlane32_swap_b32 v48, v49
    s_nop 1
    v_max_f32 v48, v48, v49
    v_mov_b32 v49, v48
    s_nop 1
    v_permlane16_swap_b32 v48, v49
    s_nop 1
    v_max_f32 v48, v48, v49
    v_exp_f32 v49, -v48
    v_sub_f32 v72, v72, v48
    v_sub_f32 v73, v73, v48
    v_sub_f32 v74, v74, v48
    v_sub_f32 v75, v75, v48
    v_sub_f32 v76, v76, v48
    v_sub_f32 v77, v77, v48
    v_sub_f32 v78, v78, v48
    v_sub_f32 v79, v79, v48
    v_sub_f32 v104, v104, v48
    v_sub_f32 v105, v105, v48
    v_sub_f32 v106, v106, v48
    v_sub_f32 v107, v107, v48
    v_sub_f32 v108, v108, v48
    v_sub_f32 v109, v109, v48
    v_sub_f32 v110, v110, v48
    v_sub_f32 v111, v111, v48
    v_sub_f32 v168, v168, v48
    v_sub_f32 v169, v169, v48
    v_sub_f32 v170, v170, v48
    v_sub_f32 v171, v171, v48
    v_sub_f32 v172, v172, v48
    v_sub_f32 v173, v173, v48
    v_sub_f32 v174, v174, v48
    v_sub_f32 v175, v175, v48
    v_mul_f32 v13, v13, v49
    v_accvgpr_read_b32 v52, a32
    v_accvgpr_read_b32 v53, a33
    v_accvgpr_read_b32 v54, a34
    v_accvgpr_read_b32 v55, a35
    v_accvgpr_read_b32 v56, a36
    v_accvgpr_read_b32 v57, a37
    v_accvgpr_read_b32 v58, a38
    v_accvgpr_read_b32 v59, a39
    v_mul_f32 v52, v52, v49
    v_mul_f32 v53, v53, v49
    v_mul_f32 v54, v54, v49
    v_mul_f32 v55, v55, v49
    v_mul_f32 v56, v56, v49
    v_mul_f32 v57, v57, v49
    v_mul_f32 v58, v58, v49
    v_mul_f32 v59, v59, v49
    v_accvgpr_write_b32 a32, v52
    v_accvgpr_write_b32 a33, v53
    v_accvgpr_write_b32 a34, v54
    v_accvgpr_write_b32 a35, v55
    v_accvgpr_write_b32 a36, v56
    v_accvgpr_write_b32 a37, v57
    v_accvgpr_write_b32 a38, v58
    v_accvgpr_write_b32 a39, v59
    v_accvgpr_read_b32 v52, a40
    v_accvgpr_read_b32 v53, a41
    v_accvgpr_read_b32 v54, a42
    v_accvgpr_read_b32 v55, a43
    v_accvgpr_read_b32 v56, a44
    v_accvgpr_read_b32 v57, a45
    v_accvgpr_read_b32 v58, a46
    v_accvgpr_read_b32 v59, a47
    v_mul_f32 v52, v52, v49
    v_mul_f32 v53, v53, v49
    v_mul_f32 v54, v54, v49
    v_mul_f32 v55, v55, v49
    v_mul_f32 v56, v56, v49
    v_mul_f32 v57, v57, v49
    v_mul_f32 v58, v58, v49
    v_mul_f32 v59, v59, v49
    v_accvgpr_write_b32 a40, v52
    v_accvgpr_write_b32 a41, v53
    v_accvgpr_write_b32 a42, v54
    v_accvgpr_write_b32 a43, v55
    v_accvgpr_write_b32 a44, v56
    v_accvgpr_write_b32 a45, v57
    v_accvgpr_write_b32 a46, v58
    v_accvgpr_write_b32 a47, v59
    v_accvgpr_read_b32 v52, a48
    v_accvgpr_read_b32 v53, a49
    v_accvgpr_read_b32 v54, a50
    v_accvgpr_read_b32 v55, a51
    v_accvgpr_read_b32 v56, a52
    v_accvgpr_read_b32 v57, a53
    v_accvgpr_read_b32 v58, a54
    v_accvgpr_read_b32 v59, a55
    v_mul_f32 v52, v52, v49
    v_mul_f32 v53, v53, v49
    v_mul_f32 v54, v54, v49
    v_mul_f32 v55, v55, v49
    v_mul_f32 v56, v56, v49
    v_mul_f32 v57, v57, v49
    v_mul_f32 v58, v58, v49
    v_mul_f32 v59, v59, v49
    v_accvgpr_write_b32 a48, v52
    v_accvgpr_write_b32 a49, v53
    v_accvgpr_write_b32 a50, v54
    v_accvgpr_write_b32 a51, v55
    v_accvgpr_write_b32 a52, v56
    v_accvgpr_write_b32 a53, v57
    v_accvgpr_write_b32 a54, v58
    v_accvgpr_write_b32 a55, v59
    v_accvgpr_read_b32 v52, a56
    v_accvgpr_read_b32 v53, a57
    v_accvgpr_read_b32 v54, a58
    v_accvgpr_read_b32 v55, a59
    v_accvgpr_read_b32 v56, a60
    v_accvgpr_read_b32 v57, a61
    v_accvgpr_read_b32 v58, a62
    v_accvgpr_read_b32 v59, a63
    v_mul_f32 v52, v52, v49
    v_mul_f32 v53, v53, v49
    v_mul_f32 v54, v54, v49
    v_mul_f32 v55, v55, v49
    v_mul_f32 v56, v56, v49
    v_mul_f32 v57, v57, v49
    v_mul_f32 v58, v58, v49
    v_mul_f32 v59, v59, v49
    v_accvgpr_write_b32 a56, v52
    v_accvgpr_write_b32 a57, v53
    v_accvgpr_write_b32 a58, v54
    v_accvgpr_write_b32 a59, v55
    v_accvgpr_write_b32 a60, v56
    v_accvgpr_write_b32 a61, v57
    v_accvgpr_write_b32 a62, v58
    v_accvgpr_write_b32 a63, v59
    v_exp_f32 v52, v72
    v_exp_f32 v53, v73
    v_exp_f32 v54, v74
    v_exp_f32 v55, v75
    v_exp_f32 v56, v76
    v_exp_f32 v57, v77
    v_exp_f32 v58, v78
    v_exp_f32 v59, v79
    s_nop 0
    v_cvt_pk_bf16_f32 v132, v52, v53
    v_cvt_pk_bf16_f32 v133, v54, v55
    v_cvt_pk_bf16_f32 v134, v56, v57
    v_cvt_pk_bf16_f32 v135, v58, v59
    s_nop 1
    v_mfma_f32_16x16x32_bf16 v[32:35], v[44:47], v[132:135], 0
    s_nop 7
    s_setpc_b64 s[74:75]
m_rs0470:
    s_nop 15
    v_max3_f32 v48, v64, v65, v66
    v_max3_f32 v48, v48, v67, v68
    v_max3_f32 v48, v48, v69, v70
    v_max3_f32 v48, v48, v71, 0
    v_mov_b32 v49, v48
    s_nop 1
    v_permlane32_swap_b32 v48, v49
    s_nop 1
    v_max_f32 v48, v48, v49
    v_mov_b32 v49, v48
    s_nop 1
    v_permlane16_swap_b32 v48, v49
    s_nop 1
    v_max_f32 v48, v48, v49
    v_exp_f32 v49, -v48
    v_sub_f32 v64, v64, v48
    v_sub_f32 v65, v65, v48
    v_sub_f32 v66, v66, v48
    v_sub_f32 v67, v67, v48
    v_sub_f32 v68, v68, v48
    v_sub_f32 v69, v69, v48
    v_sub_f32 v70, v70, v48
    v_sub_f32 v71, v71, v48
    v_sub_f32 v96, v96, v48
    v_sub_f32 v97, v97, v48
    v_sub_f32 v98, v98, v48
    v_sub_f32 v99, v99, v48
    v_sub_f32 v100, v100, v48
    v_sub_f32 v101, v101, v48
    v_sub_f32 v102, v102, v48
    v_sub_f32 v103, v103, v48
    v_sub_f32 v160, v160, v48
    v_sub_f32 v161, v161, v48
    v_sub_f32 v162, v162, v48
    v_sub_f32 v163, v163, v48
    v_sub_f32 v164, v164, v48
    v_sub_f32 v165, v165, v48
    v_sub_f32 v166, v166, v48
    v_sub_f32 v167, v167, v48
    v_mul_f32 v12, v12, v49
    v_accvgpr_read_b32 v52, a0
    v_accvgpr_read_b32 v53, a1
    v_accvgpr_read_b32 v54, a2
    v_accvgpr_read_b32 v55, a3
    v_accvgpr_read_b32 v56, a4
    v_accvgpr_read_b32 v57, a5
    v_accvgpr_read_b32 v58, a6
    v_accvgpr_read_b32 v59, a7
    v_mul_f32 v52, v52, v49
    v_mul_f32 v53, v53, v49
    v_mul_f32 v54, v54, v49
    v_mul_f32 v55, v55, v49
    v_mul_f32 v56, v56, v49
    v_mul_f32 v57, v57, v49
    v_mul_f32 v58, v58, v49
    v_mul_f32 v59, v59, v49
    v_accvgpr_write_b32 a0, v52
    v_accvgpr_write_b32 a1, v53
    v_accvgpr_write_b32 a2, v54
    v_accvgpr_write_b32 a3, v55
    v_accvgpr_write_b32 a4, v56
    v_accvgpr_write_b32 a5, v57
    v_accvgpr_write_b32 a6, v58
    v_accvgpr_write_b32 a7, v59
    v_accvgpr_read_b32 v52, a8
    v_accvgpr_read_b32 v53, a9
    v_accvgpr_read_b32 v54, a10
    v_accvgpr_read_b32 v55, a11
    v_accvgpr_read_b32 v56, a12
    v_accvgpr_read_b32 v57, a13
    v_accvgpr_read_b32 v58, a14
    v_accvgpr_read_b32 v59, a15
    v_mul_f32 v52, v52, v49
    v_mul_f32 v53, v53, v49
    v_mul_f32 v54, v54, v49
    v_mul_f32 v55, v55, v49
    v_mul_f32 v56, v56, v49
    v_mul_f32 v57, v57, v49
    v_mul_f32 v58, v58, v49
    v_mul_f32 v59, v59, v49
    v_accvgpr_write_b32 a8, v52
    v_accvgpr_write_b32 a9, v53
    v_accvgpr_write_b32 a10, v54
    v_accvgpr_write_b32 a11, v55
    v_accvgpr_write_b32 a12, v56
    v_accvgpr_write_b32 a13, v57
    v_accvgpr_write_b32 a14, v58
    v_accvgpr_write_b32 a15, v59
    v_accvgpr_read_b32 v52, a16
    v_accvgpr_read_b32 v53, a17
    v_accvgpr_read_b32 v54, a18
    v_accvgpr_read_b32 v55, a19
    v_accvgpr_read_b32 v56, a20
    v_accvgpr_read_b32 v57, a21
    v_accvgpr_read_b32 v58, a22
    v_accvgpr_read_b32 v59, a23
    v_mul_f32 v52, v52, v49
    v_mul_f32 v53, v53, v49
    v_mul_f32 v54, v54, v49
    v_mul_f32 v55, v55, v49
    v_mul_f32 v56, v56, v49
    v_mul_f32 v57, v57, v49
    v_mul_f32 v58, v58, v49
    v_mul_f32 v59, v59, v49
    v_accvgpr_write_b32 a16, v52
    v_accvgpr_write_b32 a17, v53
    v_accvgpr_write_b32 a18, v54
    v_accvgpr_write_b32 a19, v55
    v_accvgpr_write_b32 a20, v56
    v_accvgpr_write_b32 a21, v57
    v_accvgpr_write_b32 a22, v58
    v_accvgpr_write_b32 a23, v59
    v_accvgpr_read_b32 v52, a24
    v_accvgpr_read_b32 v53, a25
    v_accvgpr_read_b32 v54, a26
    v_accvgpr_read_b32 v55, a27
    v_accvgpr_read_b32 v56, a28
    v_accvgpr_read_b32 v57, a29
    v_accvgpr_read_b32 v58, a30
    v_accvgpr_read_b32 v59, a31
    v_mul_f32 v52, v52, v49
    v_mul_f32 v53, v53, v49
    v_mul_f32 v54, v54, v49
    v_mul_f32 v55, v55, v49
    v_mul_f32 v56, v56, v49
    v_mul_f32 v57, v57, v49
    v_mul_f32 v58, v58, v49
    v_mul_f32 v59, v59, v49
    v_accvgpr_write_b32 a24, v52
    v_accvgpr_write_b32 a25, v53
    v_accvgpr_write_b32 a26, v54
    v_accvgpr_write_b32 a27, v55
    v_accvgpr_write_b32 a28, v56
    v_accvgpr_write_b32 a29, v57
    v_accvgpr_write_b32 a30, v58
    v_accvgpr_write_b32 a31, v59
    v_exp_f32 v52, v64
    v_exp_f32 v53, v65
    v_exp_f32 v54, v66
    v_exp_f32 v55, v67
    v_exp_f32 v56, v68
    v_exp_f32 v57, v69
    v_exp_f32 v58, v70
    v_exp_f32 v59, v71
    s_nop 0
    v_cvt_pk_bf16_f32 v128, v52, v53
    v_cvt_pk_bf16_f32 v129, v54, v55
    v_cvt_pk_bf16_f32 v130, v56, v57
    v_cvt_pk_bf16_f32 v131, v58, v59
    s_nop 1
    v_mfma_f32_16x16x32_bf16 v[28:31], v[44:47], v[128:131], 0
    v_max3_f32 v48, v72, v73, v74
    v_max3_f32 v48, v48, v75, v76
    v_max3_f32 v48, v48, v77, v78
    v_max3_f32 v48, v48, v79, 0
    v_mov_b32 v49, v48
    s_nop 1
    v_permlane32_swap_b32 v48, v49
    s_nop 1
    v_max_f32 v48, v48, v49
    v_mov_b32 v49, v48
    s_nop 1
    v_permlane16_swap_b32 v48, v49
    s_nop 1
    v_max_f32 v48, v48, v49
    v_exp_f32 v49, -v48
    v_sub_f32 v72, v72, v48
    v_sub_f32 v73, v73, v48
    v_sub_f32 v74, v74, v48
    v_sub_f32 v75, v75, v48
    v_sub_f32 v76, v76, v48
    v_sub_f32 v77, v77, v48
    v_sub_f32 v78, v78, v48
    v_sub_f32 v79, v79, v48
    v_sub_f32 v104, v104, v48
    v_sub_f32 v105, v105, v48
    v_sub_f32 v106, v106, v48
    v_sub_f32 v107, v107, v48
    v_sub_f32 v108, v108, v48
    v_sub_f32 v109, v109, v48
    v_sub_f32 v110, v110, v48
    v_sub_f32 v111, v111, v48
    v_sub_f32 v168, v168, v48
    v_sub_f32 v169, v169, v48
    v_sub_f32 v170, v170, v48
    v_sub_f32 v171, v171, v48
    v_sub_f32 v172, v172, v48
    v_sub_f32 v173, v173, v48
    v_sub_f32 v174, v174, v48
    v_sub_f32 v175, v175, v48
    v_mul_f32 v13, v13, v49
    v_accvgpr_read_b32 v52, a32
    v_accvgpr_read_b32 v53, a33
    v_accvgpr_read_b32 v54, a34
    v_accvgpr_read_b32 v55, a35
    v_accvgpr_read_b32 v56, a36
    v_accvgpr_read_b32 v57, a37
    v_accvgpr_read_b32 v58, a38
    v_accvgpr_read_b32 v59, a39
    v_mul_f32 v52, v52, v49
    v_mul_f32 v53, v53, v49
    v_mul_f32 v54, v54, v49
    v_mul_f32 v55, v55, v49
    v_mul_f32 v56, v56, v49
    v_mul_f32 v57, v57, v49
    v_mul_f32 v58, v58, v49
    v_mul_f32 v59, v59, v49
    v_accvgpr_write_b32 a32, v52
    v_accvgpr_write_b32 a33, v53
    v_accvgpr_write_b32 a34, v54
    v_accvgpr_write_b32 a35, v55
    v_accvgpr_write_b32 a36, v56
    v_accvgpr_write_b32 a37, v57
    v_accvgpr_write_b32 a38, v58
    v_accvgpr_write_b32 a39, v59
    v_accvgpr_read_b32 v52, a40
    v_accvgpr_read_b32 v53, a41
    v_accvgpr_read_b32 v54, a42
    v_accvgpr_read_b32 v55, a43
    v_accvgpr_read_b32 v56, a44
    v_accvgpr_read_b32 v57, a45
    v_accvgpr_read_b32 v58, a46
    v_accvgpr_read_b32 v59, a47
    v_mul_f32 v52, v52, v49
    v_mul_f32 v53, v53, v49
    v_mul_f32 v54, v54, v49
    v_mul_f32 v55, v55, v49
    v_mul_f32 v56, v56, v49
    v_mul_f32 v57, v57, v49
    v_mul_f32 v58, v58, v49
    v_mul_f32 v59, v59, v49
    v_accvgpr_write_b32 a40, v52
    v_accvgpr_write_b32 a41, v53
    v_accvgpr_write_b32 a42, v54
    v_accvgpr_write_b32 a43, v55
    v_accvgpr_write_b32 a44, v56
    v_accvgpr_write_b32 a45, v57
    v_accvgpr_write_b32 a46, v58
    v_accvgpr_write_b32 a47, v59
    v_accvgpr_read_b32 v52, a48
    v_accvgpr_read_b32 v53, a49
    v_accvgpr_read_b32 v54, a50
    v_accvgpr_read_b32 v55, a51
    v_accvgpr_read_b32 v56, a52
    v_accvgpr_read_b32 v57, a53
    v_accvgpr_read_b32 v58, a54
    v_accvgpr_read_b32 v59, a55
    v_mul_f32 v52, v52, v49
    v_mul_f32 v53, v53, v49
    v_mul_f32 v54, v54, v49
    v_mul_f32 v55, v55, v49
    v_mul_f32 v56, v56, v49
    v_mul_f32 v57, v57, v49
    v_mul_f32 v58, v58, v49
    v_mul_f32 v59, v59, v49
    v_accvgpr_write_b32 a48, v52
    v_accvgpr_write_b32 a49, v53
    v_accvgpr_write_b32 a50, v54
    v_accvgpr_write_b32 a51, v55
    v_accvgpr_write_b32 a52, v56
    v_accvgpr_write_b32 a53, v57
    v_accvgpr_write_b32 a54, v58
    v_accvgpr_write_b32 a55, v59
    v_accvgpr_read_b32 v52, a56
    v_accvgpr_read_b32 v53, a57
    v_accvgpr_read_b32 v54, a58
    v_accvgpr_read_b32 v55, a59
    v_accvgpr_read_b32 v56, a60
    v_accvgpr_read_b32 v57, a61
    v_accvgpr_read_b32 v58, a62
    v_accvgpr_read_b32 v59, a63
    v_mul_f32 v52, v52, v49
    v_mul_f32 v53, v53, v49
    v_mul_f32 v54, v54, v49
    v_mul_f32 v55, v55, v49
    v_mul_f32 v56, v56, v49
    v_mul_f32 v57, v57, v49
    v_mul_f32 v58, v58, v49
    v_mul_f32 v59, v59, v49
    v_accvgpr_write_b32 a56, v52
    v_accvgpr_write_b32 a57, v53
    v_accvgpr_write_b32 a58, v54
    v_accvgpr_write_b32 a59, v55
    v_accvgpr_write_b32 a60, v56
    v_accvgpr_write_b32 a61, v57
    v_accvgpr_write_b32 a62, v58
    v_accvgpr_write_b32 a63, v59
    v_exp_f32 v52, v72
    v_exp_f32 v53, v73
    v_exp_f32 v54, v74
    v_exp_f32 v55, v75
    v_exp_f32 v56, v76
    v_exp_f32 v57, v77
    v_exp_f32 v58, v78
    v_exp_f32 v59, v79
    s_nop 0
    v_cvt_pk_bf16_f32 v132, v52, v53
    v_cvt_pk_bf16_f32 v133, v54, v55
    v_cvt_pk_bf16_f32 v134, v56, v57
    v_cvt_pk_bf16_f32 v135, v58, v59
    s_nop 1
    v_mfma_f32_16x16x32_bf16 v[32:35], v[44:47], v[132:135], 0
    v_max3_f32 v48, v80, v81, v82
    v_max3_f32 v48, v48, v83, v84
    v_max3_f32 v48, v48, v85, v86
    v_max3_f32 v48, v48, v87, 0
    v_mov_b32 v49, v48
    s_nop 1
    v_permlane32_swap_b32 v48, v49
    s_nop 1
    v_max_f32 v48, v48, v49
    v_mov_b32 v49, v48
    s_nop 1
    v_permlane16_swap_b32 v48, v49
    s_nop 1
    v_max_f32 v48, v48, v49
    v_exp_f32 v49, -v48
    v_sub_f32 v80, v80, v48
    v_sub_f32 v81, v81, v48
    v_sub_f32 v82, v82, v48
    v_sub_f32 v83, v83, v48
    v_sub_f32 v84, v84, v48
    v_sub_f32 v85, v85, v48
    v_sub_f32 v86, v86, v48
    v_sub_f32 v87, v87, v48
    v_sub_f32 v112, v112, v48
    v_sub_f32 v113, v113, v48
    v_sub_f32 v114, v114, v48
    v_sub_f32 v115, v115, v48
    v_sub_f32 v116, v116, v48
    v_sub_f32 v117, v117, v48
    v_sub_f32 v118, v118, v48
    v_sub_f32 v119, v119, v48
    v_sub_f32 v176, v176, v48
    v_sub_f32 v177, v177, v48
    v_sub_f32 v178, v178, v48
    v_sub_f32 v179, v179, v48
    v_sub_f32 v180, v180, v48
    v_sub_f32 v181, v181, v48
    v_sub_f32 v182, v182, v48
    v_sub_f32 v183, v183, v48
    v_mul_f32 v14, v14, v49
    v_accvgpr_read_b32 v52, a64
    v_accvgpr_read_b32 v53, a65
    v_accvgpr_read_b32 v54, a66
    v_accvgpr_read_b32 v55, a67
    v_accvgpr_read_b32 v56, a68
    v_accvgpr_read_b32 v57, a69
    v_accvgpr_read_b32 v58, a70
    v_accvgpr_read_b32 v59, a71
    v_mul_f32 v52, v52, v49
    v_mul_f32 v53, v53, v49
    v_mul_f32 v54, v54, v49
    v_mul_f32 v55, v55, v49
    v_mul_f32 v56, v56, v49
    v_mul_f32 v57, v57, v49
    v_mul_f32 v58, v58, v49
    v_mul_f32 v59, v59, v49
    v_accvgpr_write_b32 a64, v52
    v_accvgpr_write_b32 a65, v53
    v_accvgpr_write_b32 a66, v54
    v_accvgpr_write_b32 a67, v55
    v_accvgpr_write_b32 a68, v56
    v_accvgpr_write_b32 a69, v57
    v_accvgpr_write_b32 a70, v58
    v_accvgpr_write_b32 a71, v59
    v_accvgpr_read_b32 v52, a72
    v_accvgpr_read_b32 v53, a73
    v_accvgpr_read_b32 v54, a74
    v_accvgpr_read_b32 v55, a75
    v_accvgpr_read_b32 v56, a76
    v_accvgpr_read_b32 v57, a77
    v_accvgpr_read_b32 v58, a78
    v_accvgpr_read_b32 v59, a79
    v_mul_f32 v52, v52, v49
    v_mul_f32 v53, v53, v49
    v_mul_f32 v54, v54, v49
    v_mul_f32 v55, v55, v49
    v_mul_f32 v56, v56, v49
    v_mul_f32 v57, v57, v49
    v_mul_f32 v58, v58, v49
    v_mul_f32 v59, v59, v49
    v_accvgpr_write_b32 a72, v52
    v_accvgpr_write_b32 a73, v53
    v_accvgpr_write_b32 a74, v54
    v_accvgpr_write_b32 a75, v55
    v_accvgpr_write_b32 a76, v56
    v_accvgpr_write_b32 a77, v57
    v_accvgpr_write_b32 a78, v58
    v_accvgpr_write_b32 a79, v59
    v_accvgpr_read_b32 v52, a80
    v_accvgpr_read_b32 v53, a81
    v_accvgpr_read_b32 v54, a82
    v_accvgpr_read_b32 v55, a83
    v_accvgpr_read_b32 v56, a84
    v_accvgpr_read_b32 v57, a85
    v_accvgpr_read_b32 v58, a86
    v_accvgpr_read_b32 v59, a87
    v_mul_f32 v52, v52, v49
    v_mul_f32 v53, v53, v49
    v_mul_f32 v54, v54, v49
    v_mul_f32 v55, v55, v49
    v_mul_f32 v56, v56, v49
    v_mul_f32 v57, v57, v49
    v_mul_f32 v58, v58, v49
    v_mul_f32 v59, v59, v49
    v_accvgpr_write_b32 a80, v52
    v_accvgpr_write_b32 a81, v53
    v_accvgpr_write_b32 a82, v54
    v_accvgpr_write_b32 a83, v55
    v_accvgpr_write_b32 a84, v56
    v_accvgpr_write_b32 a85, v57
    v_accvgpr_write_b32 a86, v58
    v_accvgpr_write_b32 a87, v59
    v_accvgpr_read_b32 v52, a88
    v_accvgpr_read_b32 v53, a89
    v_accvgpr_read_b32 v54, a90
    v_accvgpr_read_b32 v55, a91
    v_accvgpr_read_b32 v56, a92
    v_accvgpr_read_b32 v57, a93
    v_accvgpr_read_b32 v58, a94
    v_accvgpr_read_b32 v59, a95
    v_mul_f32 v52, v52, v49
    v_mul_f32 v53, v53, v49
    v_mul_f32 v54, v54, v49
    v_mul_f32 v55, v55, v49
    v_mul_f32 v56, v56, v49
    v_mul_f32 v57, v57, v49
    v_mul_f32 v58, v58, v49
    v_mul_f32 v59, v59, v49
    v_accvgpr_write_b32 a88, v52
    v_accvgpr_write_b32 a89, v53
    v_accvgpr_write_b32 a90, v54
    v_accvgpr_write_b32 a91, v55
    v_accvgpr_write_b32 a92, v56
    v_accvgpr_write_b32 a93, v57
    v_accvgpr_write_b32 a94, v58
    v_accvgpr_write_b32 a95, v59
    v_exp_f32 v52, v80
    v_exp_f32 v53, v81
    v_exp_f32 v54, v82
    v_exp_f32 v55, v83
    v_exp_f32 v56, v84
    v_exp_f32 v57, v85
    v_exp_f32 v58, v86
    v_exp_f32 v59, v87
    s_nop 0
    v_cvt_pk_bf16_f32 v136, v52, v53
    v_cvt_pk_bf16_f32 v137, v54, v55
    v_cvt_pk_bf16_f32 v138, v56, v57
    v_cvt_pk_bf16_f32 v139, v58, v59
    s_nop 1
    v_mfma_f32_16x16x32_bf16 v[36:39], v[44:47], v[136:139], 0
    v_max3_f32 v48, v88, v89, v90
    v_max3_f32 v48, v48, v91, v92
    v_max3_f32 v48, v48, v93, v94
    v_max3_f32 v48, v48, v95, 0
    v_mov_b32 v49, v48
    s_nop 1
    v_permlane32_swap_b32 v48, v49
    s_nop 1
    v_max_f32 v48, v48, v49
    v_mov_b32 v49, v48
    s_nop 1
    v_permlane16_swap_b32 v48, v49
    s_nop 1
    v_max_f32 v48, v48, v49
    v_exp_f32 v49, -v48
    v_sub_f32 v88, v88, v48
    v_sub_f32 v89, v89, v48
    v_sub_f32 v90, v90, v48
    v_sub_f32 v91, v91, v48
    v_sub_f32 v92, v92, v48
    v_sub_f32 v93, v93, v48
    v_sub_f32 v94, v94, v48
    v_sub_f32 v95, v95, v48
    v_sub_f32 v120, v120, v48
    v_sub_f32 v121, v121, v48
    v_sub_f32 v122, v122, v48
    v_sub_f32 v123, v123, v48
    v_sub_f32 v124, v124, v48
    v_sub_f32 v125, v125, v48
    v_sub_f32 v126, v126, v48
    v_sub_f32 v127, v127, v48
    v_sub_f32 v184, v184, v48
    v_sub_f32 v185, v185, v48
    v_sub_f32 v186, v186, v48
    v_sub_f32 v187, v187, v48
    v_sub_f32 v188, v188, v48
    v_sub_f32 v189, v189, v48
    v_sub_f32 v190, v190, v48
    v_sub_f32 v191, v191, v48
    v_mul_f32 v15, v15, v49
    v_accvgpr_read_b32 v52, a96
    v_accvgpr_read_b32 v53, a97
    v_accvgpr_read_b32 v54, a98
    v_accvgpr_read_b32 v55, a99
    v_accvgpr_read_b32 v56, a100
    v_accvgpr_read_b32 v57, a101
    v_accvgpr_read_b32 v58, a102
    v_accvgpr_read_b32 v59, a103
    v_mul_f32 v52, v52, v49
    v_mul_f32 v53, v53, v49
    v_mul_f32 v54, v54, v49
    v_mul_f32 v55, v55, v49
    v_mul_f32 v56, v56, v49
    v_mul_f32 v57, v57, v49
    v_mul_f32 v58, v58, v49
    v_mul_f32 v59, v59, v49
    v_accvgpr_write_b32 a96, v52
    v_accvgpr_write_b32 a97, v53
    v_accvgpr_write_b32 a98, v54
    v_accvgpr_write_b32 a99, v55
    v_accvgpr_write_b32 a100, v56
    v_accvgpr_write_b32 a101, v57
    v_accvgpr_write_b32 a102, v58
    v_accvgpr_write_b32 a103, v59
    v_accvgpr_read_b32 v52, a104
    v_accvgpr_read_b32 v53, a105
    v_accvgpr_read_b32 v54, a106
    v_accvgpr_read_b32 v55, a107
    v_accvgpr_read_b32 v56, a108
    v_accvgpr_read_b32 v57, a109
    v_accvgpr_read_b32 v58, a110
    v_accvgpr_read_b32 v59, a111
    v_mul_f32 v52, v52, v49
    v_mul_f32 v53, v53, v49
    v_mul_f32 v54, v54, v49
    v_mul_f32 v55, v55, v49
    v_mul_f32 v56, v56, v49
    v_mul_f32 v57, v57, v49
    v_mul_f32 v58, v58, v49
    v_mul_f32 v59, v59, v49
    v_accvgpr_write_b32 a104, v52
    v_accvgpr_write_b32 a105, v53
    v_accvgpr_write_b32 a106, v54
    v_accvgpr_write_b32 a107, v55
    v_accvgpr_write_b32 a108, v56
    v_accvgpr_write_b32 a109, v57
    v_accvgpr_write_b32 a110, v58
    v_accvgpr_write_b32 a111, v59
    v_accvgpr_read_b32 v52, a112
    v_accvgpr_read_b32 v53, a113
    v_accvgpr_read_b32 v54, a114
    v_accvgpr_read_b32 v55, a115
    v_accvgpr_read_b32 v56, a116
    v_accvgpr_read_b32 v57, a117
    v_accvgpr_read_b32 v58, a118
    v_accvgpr_read_b32 v59, a119
    v_mul_f32 v52, v52, v49
    v_mul_f32 v53, v53, v49
    v_mul_f32 v54, v54, v49
    v_mul_f32 v55, v55, v49
    v_mul_f32 v56, v56, v49
    v_mul_f32 v57, v57, v49
    v_mul_f32 v58, v58, v49
    v_mul_f32 v59, v59, v49
    v_accvgpr_write_b32 a112, v52
    v_accvgpr_write_b32 a113, v53
    v_accvgpr_write_b32 a114, v54
    v_accvgpr_write_b32 a115, v55
    v_accvgpr_write_b32 a116, v56
    v_accvgpr_write_b32 a117, v57
    v_accvgpr_write_b32 a118, v58
    v_accvgpr_write_b32 a119, v59
    v_accvgpr_read_b32 v52, a120
    v_accvgpr_read_b32 v53, a121
    v_accvgpr_read_b32 v54, a122
    v_accvgpr_read_b32 v55, a123
    v_accvgpr_read_b32 v56, a124
    v_accvgpr_read_b32 v57, a125
    v_accvgpr_read_b32 v58, a126
    v_accvgpr_read_b32 v59, a127
    v_mul_f32 v52, v52, v49
    v_mul_f32 v53, v53, v49
    v_mul_f32 v54, v54, v49
    v_mul_f32 v55, v55, v49
    v_mul_f32 v56, v56, v49
    v_mul_f32 v57, v57, v49
    v_mul_f32 v58, v58, v49
    v_mul_f32 v59, v59, v49
    v_accvgpr_write_b32 a120, v52
    v_accvgpr_write_b32 a121, v53
    v_accvgpr_write_b32 a122, v54
    v_accvgpr_write_b32 a123, v55
    v_accvgpr_write_b32 a124, v56
    v_accvgpr_write_b32 a125, v57
    v_accvgpr_write_b32 a126, v58
    v_accvgpr_write_b32 a127, v59
    v_exp_f32 v52, v88
    v_exp_f32 v53, v89
    v_exp_f32 v54, v90
    v_exp_f32 v55, v91
    v_exp_f32 v56, v92
    v_exp_f32 v57, v93
    v_exp_f32 v58, v94
    v_exp_f32 v59, v95
    s_nop 0
    v_cvt_pk_bf16_f32 v140, v52, v53
    v_cvt_pk_bf16_f32 v141, v54, v55
    v_cvt_pk_bf16_f32 v142, v56, v57
    v_cvt_pk_bf16_f32 v143, v58, v59
    s_nop 1
    v_mfma_f32_16x16x32_bf16 v[40:43], v[44:47], v[140:143], 0
    s_nop 7
    s_setpc_b64 s[74:75]
m_rs1271:
    s_nop 15
    v_max3_f32 v48, v96, v97, v98
    v_max3_f32 v48, v48, v99, v100
    v_max3_f32 v48, v48, v101, v102
    v_max3_f32 v48, v48, v103, 0
    v_mov_b32 v49, v48
    s_nop 1
    v_permlane32_swap_b32 v48, v49
    s_nop 1
    v_max_f32 v48, v48, v49
    v_mov_b32 v49, v48
    s_nop 1
    v_permlane16_swap_b32 v48, v49
    s_nop 1
    v_max_f32 v48, v48, v49
    v_exp_f32 v49, -v48
    v_sub_f32 v96, v96, v48
    v_sub_f32 v97, v97, v48
    v_sub_f32 v98, v98, v48
    v_sub_f32 v99, v99, v48
    v_sub_f32 v100, v100, v48
    v_sub_f32 v101, v101, v48
    v_sub_f32 v102, v102, v48
    v_sub_f32 v103, v103, v48
    v_sub_f32 v64, v64, v48
    v_sub_f32 v65, v65, v48
    v_sub_f32 v66, v66, v48
    v_sub_f32 v67, v67, v48
    v_sub_f32 v68, v68, v48
    v_sub_f32 v69, v69, v48
    v_sub_f32 v70, v70, v48
    v_sub_f32 v71, v71, v48
    v_sub_f32 v160, v160, v48
    v_sub_f32 v161, v161, v48
    v_sub_f32 v162, v162, v48
    v_sub_f32 v163, v163, v48
    v_sub_f32 v164, v164, v48
    v_sub_f32 v165, v165, v48
    v_sub_f32 v166, v166, v48
    v_sub_f32 v167, v167, v48
    v_mul_f32 v12, v12, v49
    v_accvgpr_read_b32 v52, a0
    v_accvgpr_read_b32 v53, a1
    v_accvgpr_read_b32 v54, a2
    v_accvgpr_read_b32 v55, a3
    v_accvgpr_read_b32 v56, a4
    v_accvgpr_read_b32 v57, a5
    v_accvgpr_read_b32 v58, a6
    v_accvgpr_read_b32 v59, a7
    v_mul_f32 v52, v52, v49
    v_mul_f32 v53, v53, v49
    v_mul_f32 v54, v54, v49
    v_mul_f32 v55, v55, v49
    v_mul_f32 v56, v56, v49
    v_mul_f32 v57, v57, v49
    v_mul_f32 v58, v58, v49
    v_mul_f32 v59, v59, v49
    v_accvgpr_write_b32 a0, v52
    v_accvgpr_write_b32 a1, v53
    v_accvgpr_write_b32 a2, v54
    v_accvgpr_write_b32 a3, v55
    v_accvgpr_write_b32 a4, v56
    v_accvgpr_write_b32 a5, v57
    v_accvgpr_write_b32 a6, v58
    v_accvgpr_write_b32 a7, v59
    v_accvgpr_read_b32 v52, a8
    v_accvgpr_read_b32 v53, a9
    v_accvgpr_read_b32 v54, a10
    v_accvgpr_read_b32 v55, a11
    v_accvgpr_read_b32 v56, a12
    v_accvgpr_read_b32 v57, a13
    v_accvgpr_read_b32 v58, a14
    v_accvgpr_read_b32 v59, a15
    v_mul_f32 v52, v52, v49
    v_mul_f32 v53, v53, v49
    v_mul_f32 v54, v54, v49
    v_mul_f32 v55, v55, v49
    v_mul_f32 v56, v56, v49
    v_mul_f32 v57, v57, v49
    v_mul_f32 v58, v58, v49
    v_mul_f32 v59, v59, v49
    v_accvgpr_write_b32 a8, v52
    v_accvgpr_write_b32 a9, v53
    v_accvgpr_write_b32 a10, v54
    v_accvgpr_write_b32 a11, v55
    v_accvgpr_write_b32 a12, v56
    v_accvgpr_write_b32 a13, v57
    v_accvgpr_write_b32 a14, v58
    v_accvgpr_write_b32 a15, v59
    v_accvgpr_read_b32 v52, a16
    v_accvgpr_read_b32 v53, a17
    v_accvgpr_read_b32 v54, a18
    v_accvgpr_read_b32 v55, a19
    v_accvgpr_read_b32 v56, a20
    v_accvgpr_read_b32 v57, a21
    v_accvgpr_read_b32 v58, a22
    v_accvgpr_read_b32 v59, a23
    v_mul_f32 v52, v52, v49
    v_mul_f32 v53, v53, v49
    v_mul_f32 v54, v54, v49
    v_mul_f32 v55, v55, v49
    v_mul_f32 v56, v56, v49
    v_mul_f32 v57, v57, v49
    v_mul_f32 v58, v58, v49
    v_mul_f32 v59, v59, v49
    v_accvgpr_write_b32 a16, v52
    v_accvgpr_write_b32 a17, v53
    v_accvgpr_write_b32 a18, v54
    v_accvgpr_write_b32 a19, v55
    v_accvgpr_write_b32 a20, v56
    v_accvgpr_write_b32 a21, v57
    v_accvgpr_write_b32 a22, v58
    v_accvgpr_write_b32 a23, v59
    v_accvgpr_read_b32 v52, a24
    v_accvgpr_read_b32 v53, a25
    v_accvgpr_read_b32 v54, a26
    v_accvgpr_read_b32 v55, a27
    v_accvgpr_read_b32 v56, a28
    v_accvgpr_read_b32 v57, a29
    v_accvgpr_read_b32 v58, a30
    v_accvgpr_read_b32 v59, a31
    v_mul_f32 v52, v52, v49
    v_mul_f32 v53, v53, v49
    v_mul_f32 v54, v54, v49
    v_mul_f32 v55, v55, v49
    v_mul_f32 v56, v56, v49
    v_mul_f32 v57, v57, v49
    v_mul_f32 v58, v58, v49
    v_mul_f32 v59, v59, v49
    v_accvgpr_write_b32 a24, v52
    v_accvgpr_write_b32 a25, v53
    v_accvgpr_write_b32 a26, v54
    v_accvgpr_write_b32 a27, v55
    v_accvgpr_write_b32 a28, v56
    v_accvgpr_write_b32 a29, v57
    v_accvgpr_write_b32 a30, v58
    v_accvgpr_write_b32 a31, v59
    v_exp_f32 v52, v96
    v_exp_f32 v53, v97
    v_exp_f32 v54, v98
    v_exp_f32 v55, v99
    v_exp_f32 v56, v100
    v_exp_f32 v57, v101
    v_exp_f32 v58, v102
    v_exp_f32 v59, v103
    s_nop 0
    v_cvt_pk_bf16_f32 v144, v52, v53
    v_cvt_pk_bf16_f32 v145, v54, v55
    v_cvt_pk_bf16_f32 v146, v56, v57
    v_cvt_pk_bf16_f32 v147, v58, v59
    s_nop 1
    v_mfma_f32_16x16x32_bf16 v[28:31], v[44:47], v[144:147], 0
    v_max3_f32 v48, v104, v105, v106
    v_max3_f32 v48, v48, v107, v108
    v_max3_f32 v48, v48, v109, v110
    v_max3_f32 v48, v48, v111, 0
    v_mov_b32 v49, v48
    s_nop 1
    v_permlane32_swap_b32 v48, v49
    s_nop 1
    v_max_f32 v48, v48, v49
    v_mov_b32 v49, v48
    s_nop 1
    v_permlane16_swap_b32 v48, v49
    s_nop 1
    v_max_f32 v48, v48, v49
    v_exp_f32 v49, -v48
    v_sub_f32 v104, v104, v48
    v_sub_f32 v105, v105, v48
    v_sub_f32 v106, v106, v48
    v_sub_f32 v107, v107, v48
    v_sub_f32 v108, v108, v48
    v_sub_f32 v109, v109, v48
    v_sub_f32 v110, v110, v48
    v_sub_f32 v111, v111, v48
    v_sub_f32 v72, v72, v48
    v_sub_f32 v73, v73, v48
    v_sub_f32 v74, v74, v48
    v_sub_f32 v75, v75, v48
    v_sub_f32 v76, v76, v48
    v_sub_f32 v77, v77, v48
    v_sub_f32 v78, v78, v48
    v_sub_f32 v79, v79, v48
    v_sub_f32 v168, v168, v48
    v_sub_f32 v169, v169, v48
    v_sub_f32 v170, v170, v48
    v_sub_f32 v171, v171, v48
    v_sub_f32 v172, v172, v48
    v_sub_f32 v173, v173, v48
    v_sub_f32 v174, v174, v48
    v_sub_f32 v175, v175, v48
    v_mul_f32 v13, v13, v49
    v_accvgpr_read_b32 v52, a32
    v_accvgpr_read_b32 v53, a33
    v_accvgpr_read_b32 v54, a34
    v_accvgpr_read_b32 v55, a35
    v_accvgpr_read_b32 v56, a36
    v_accvgpr_read_b32 v57, a37
    v_accvgpr_read_b32 v58, a38
    v_accvgpr_read_b32 v59, a39
    v_mul_f32 v52, v52, v49
    v_mul_f32 v53, v53, v49
    v_mul_f32 v54, v54, v49
    v_mul_f32 v55, v55, v49
    v_mul_f32 v56, v56, v49
    v_mul_f32 v57, v57, v49
    v_mul_f32 v58, v58, v49
    v_mul_f32 v59, v59, v49
    v_accvgpr_write_b32 a32, v52
    v_accvgpr_write_b32 a33, v53
    v_accvgpr_write_b32 a34, v54
    v_accvgpr_write_b32 a35, v55
    v_accvgpr_write_b32 a36, v56
    v_accvgpr_write_b32 a37, v57
    v_accvgpr_write_b32 a38, v58
    v_accvgpr_write_b32 a39, v59
    v_accvgpr_read_b32 v52, a40
    v_accvgpr_read_b32 v53, a41
    v_accvgpr_read_b32 v54, a42
    v_accvgpr_read_b32 v55, a43
    v_accvgpr_read_b32 v56, a44
    v_accvgpr_read_b32 v57, a45
    v_accvgpr_read_b32 v58, a46
    v_accvgpr_read_b32 v59, a47
    v_mul_f32 v52, v52, v49
    v_mul_f32 v53, v53, v49
    v_mul_f32 v54, v54, v49
    v_mul_f32 v55, v55, v49
    v_mul_f32 v56, v56, v49
    v_mul_f32 v57, v57, v49
    v_mul_f32 v58, v58, v49
    v_mul_f32 v59, v59, v49
    v_accvgpr_write_b32 a40, v52
    v_accvgpr_write_b32 a41, v53
    v_accvgpr_write_b32 a42, v54
    v_accvgpr_write_b32 a43, v55
    v_accvgpr_write_b32 a44, v56
    v_accvgpr_write_b32 a45, v57
    v_accvgpr_write_b32 a46, v58
    v_accvgpr_write_b32 a47, v59
    v_accvgpr_read_b32 v52, a48
    v_accvgpr_read_b32 v53, a49
    v_accvgpr_read_b32 v54, a50
    v_accvgpr_read_b32 v55, a51
    v_accvgpr_read_b32 v56, a52
    v_accvgpr_read_b32 v57, a53
    v_accvgpr_read_b32 v58, a54
    v_accvgpr_read_b32 v59, a55
    v_mul_f32 v52, v52, v49
    v_mul_f32 v53, v53, v49
    v_mul_f32 v54, v54, v49
    v_mul_f32 v55, v55, v49
    v_mul_f32 v56, v56, v49
    v_mul_f32 v57, v57, v49
    v_mul_f32 v58, v58, v49
    v_mul_f32 v59, v59, v49
    v_accvgpr_write_b32 a48, v52
    v_accvgpr_write_b32 a49, v53
    v_accvgpr_write_b32 a50, v54
    v_accvgpr_write_b32 a51, v55
    v_accvgpr_write_b32 a52, v56
    v_accvgpr_write_b32 a53, v57
    v_accvgpr_write_b32 a54, v58
    v_accvgpr_write_b32 a55, v59
    v_accvgpr_read_b32 v52, a56
    v_accvgpr_read_b32 v53, a57
    v_accvgpr_read_b32 v54, a58
    v_accvgpr_read_b32 v55, a59
    v_accvgpr_read_b32 v56, a60
    v_accvgpr_read_b32 v57, a61
    v_accvgpr_read_b32 v58, a62
    v_accvgpr_read_b32 v59, a63
    v_mul_f32 v52, v52, v49
    v_mul_f32 v53, v53, v49
    v_mul_f32 v54, v54, v49
    v_mul_f32 v55, v55, v49
    v_mul_f32 v56, v56, v49
    v_mul_f32 v57, v57, v49
    v_mul_f32 v58, v58, v49
    v_mul_f32 v59, v59, v49
    v_accvgpr_write_b32 a56, v52
    v_accvgpr_write_b32 a57, v53
    v_accvgpr_write_b32 a58, v54
    v_accvgpr_write_b32 a59, v55
    v_accvgpr_write_b32 a60, v56
    v_accvgpr_write_b32 a61, v57
    v_accvgpr_write_b32 a62, v58
    v_accvgpr_write_b32 a63, v59
    v_exp_f32 v52, v104
    v_exp_f32 v53, v105
    v_exp_f32 v54, v106
    v_exp_f32 v55, v107
    v_exp_f32 v56, v108
    v_exp_f32 v57, v109
    v_exp_f32 v58, v110
    v_exp_f32 v59, v111
    s_nop 0
    v_cvt_pk_bf16_f32 v148, v52, v53
    v_cvt_pk_bf16_f32 v149, v54, v55
    v_cvt_pk_bf16_f32 v150, v56, v57
    v_cvt_pk_bf16_f32 v151, v58, v59
    s_nop 1
    v_mfma_f32_16x16x32_bf16 v[32:35], v[44:47], v[148:151], 0
    s_nop 7
    s_setpc_b64 s[74:75]
m_rs1472:
    s_nop 15
    v_max3_f32 v48, v96, v97, v98
    v_max3_f32 v48, v48, v99, v100
    v_max3_f32 v48, v48, v101, v102
    v_max3_f32 v48, v48, v103, 0
    v_mov_b32 v49, v48
    s_nop 1
    v_permlane32_swap_b32 v48, v49
    s_nop 1
    v_max_f32 v48, v48, v49
    v_mov_b32 v49, v48
    s_nop 1
    v_permlane16_swap_b32 v48, v49
    s_nop 1
    v_max_f32 v48, v48, v49
    v_exp_f32 v49, -v48
    v_sub_f32 v96, v96, v48
    v_sub_f32 v97, v97, v48
    v_sub_f32 v98, v98, v48
    v_sub_f32 v99, v99, v48
    v_sub_f32 v100, v100, v48
    v_sub_f32 v101, v101, v48
    v_sub_f32 v102, v102, v48
    v_sub_f32 v103, v103, v48
    v_sub_f32 v64, v64, v48
    v_sub_f32 v65, v65, v48
    v_sub_f32 v66, v66, v48
    v_sub_f32 v67, v67, v48
    v_sub_f32 v68, v68, v48
    v_sub_f32 v69, v69, v48
    v_sub_f32 v70, v70, v48
    v_sub_f32 v71, v71, v48
    v_sub_f32 v160, v160, v48
    v_sub_f32 v161, v161, v48
    v_sub_f32 v162, v162, v48
    v_sub_f32 v163, v163, v48
    v_sub_f32 v164, v164, v48
    v_sub_f32 v165, v165, v48
    v_sub_f32 v166, v166, v48
    v_sub_f32 v167, v167, v48
    v_mul_f32 v12, v12, v49
    v_accvgpr_read_b32 v52, a0
    v_accvgpr_read_b32 v53, a1
    v_accvgpr_read_b32 v54, a2
    v_accvgpr_read_b32 v55, a3
    v_accvgpr_read_b32 v56, a4
    v_accvgpr_read_b32 v57, a5
    v_accvgpr_read_b32 v58, a6
    v_accvgpr_read_b32 v59, a7
    v_mul_f32 v52, v52, v49
    v_mul_f32 v53, v53, v49
    v_mul_f32 v54, v54, v49
    v_mul_f32 v55, v55, v49
    v_mul_f32 v56, v56, v49
    v_mul_f32 v57, v57, v49
    v_mul_f32 v58, v58, v49
    v_mul_f32 v59, v59, v49
    v_accvgpr_write_b32 a0, v52
    v_accvgpr_write_b32 a1, v53
    v_accvgpr_write_b32 a2, v54
    v_accvgpr_write_b32 a3, v55
    v_accvgpr_write_b32 a4, v56
    v_accvgpr_write_b32 a5, v57
    v_accvgpr_write_b32 a6, v58
    v_accvgpr_write_b32 a7, v59
    v_accvgpr_read_b32 v52, a8
    v_accvgpr_read_b32 v53, a9
    v_accvgpr_read_b32 v54, a10
    v_accvgpr_read_b32 v55, a11
    v_accvgpr_read_b32 v56, a12
    v_accvgpr_read_b32 v57, a13
    v_accvgpr_read_b32 v58, a14
    v_accvgpr_read_b32 v59, a15
    v_mul_f32 v52, v52, v49
    v_mul_f32 v53, v53, v49
    v_mul_f32 v54, v54, v49
    v_mul_f32 v55, v55, v49
    v_mul_f32 v56, v56, v49
    v_mul_f32 v57, v57, v49
    v_mul_f32 v58, v58, v49
    v_mul_f32 v59, v59, v49
    v_accvgpr_write_b32 a8, v52
    v_accvgpr_write_b32 a9, v53
    v_accvgpr_write_b32 a10, v54
    v_accvgpr_write_b32 a11, v55
    v_accvgpr_write_b32 a12, v56
    v_accvgpr_write_b32 a13, v57
    v_accvgpr_write_b32 a14, v58
    v_accvgpr_write_b32 a15, v59
    v_accvgpr_read_b32 v52, a16
    v_accvgpr_read_b32 v53, a17
    v_accvgpr_read_b32 v54, a18
    v_accvgpr_read_b32 v55, a19
    v_accvgpr_read_b32 v56, a20
    v_accvgpr_read_b32 v57, a21
    v_accvgpr_read_b32 v58, a22
    v_accvgpr_read_b32 v59, a23
    v_mul_f32 v52, v52, v49
    v_mul_f32 v53, v53, v49
    v_mul_f32 v54, v54, v49
    v_mul_f32 v55, v55, v49
    v_mul_f32 v56, v56, v49
    v_mul_f32 v57, v57, v49
    v_mul_f32 v58, v58, v49
    v_mul_f32 v59, v59, v49
    v_accvgpr_write_b32 a16, v52
    v_accvgpr_write_b32 a17, v53
    v_accvgpr_write_b32 a18, v54
    v_accvgpr_write_b32 a19, v55
    v_accvgpr_write_b32 a20, v56
    v_accvgpr_write_b32 a21, v57
    v_accvgpr_write_b32 a22, v58
    v_accvgpr_write_b32 a23, v59
    v_accvgpr_read_b32 v52, a24
    v_accvgpr_read_b32 v53, a25
    v_accvgpr_read_b32 v54, a26
    v_accvgpr_read_b32 v55, a27
    v_accvgpr_read_b32 v56, a28
    v_accvgpr_read_b32 v57, a29
    v_accvgpr_read_b32 v58, a30
    v_accvgpr_read_b32 v59, a31
    v_mul_f32 v52, v52, v49
    v_mul_f32 v53, v53, v49
    v_mul_f32 v54, v54, v49
    v_mul_f32 v55, v55, v49
    v_mul_f32 v56, v56, v49
    v_mul_f32 v57, v57, v49
    v_mul_f32 v58, v58, v49
    v_mul_f32 v59, v59, v49
    v_accvgpr_write_b32 a24, v52
    v_accvgpr_write_b32 a25, v53
    v_accvgpr_write_b32 a26, v54
    v_accvgpr_write_b32 a27, v55
    v_accvgpr_write_b32 a28, v56
    v_accvgpr_write_b32 a29, v57
    v_accvgpr_write_b32 a30, v58
    v_accvgpr_write_b32 a31, v59
    v_exp_f32 v52, v96
    v_exp_f32 v53, v97
    v_exp_f32 v54, v98
    v_exp_f32 v55, v99
    v_exp_f32 v56, v100
    v_exp_f32 v57, v101
    v_exp_f32 v58, v102
    v_exp_f32 v59, v103
    s_nop 0
    v_cvt_pk_bf16_f32 v144, v52, v53
    v_cvt_pk_bf16_f32 v145, v54, v55
    v_cvt_pk_bf16_f32 v146, v56, v57
    v_cvt_pk_bf16_f32 v147, v58, v59
    s_nop 1
    v_mfma_f32_16x16x32_bf16 v[28:31], v[44:47], v[144:147], 0
    v_max3_f32 v48, v104, v105, v106
    v_max3_f32 v48, v48, v107, v108
    v_max3_f32 v48, v48, v109, v110
    v_max3_f32 v48, v48, v111, 0
    v_mov_b32 v49, v48
    s_nop 1
    v_permlane32_swap_b32 v48, v49
    s_nop 1
    v_max_f32 v48, v48, v49
    v_mov_b32 v49, v48
    s_nop 1
    v_permlane16_swap_b32 v48, v49
    s_nop 1
    v_max_f32 v48, v48, v49
    v_exp_f32 v49, -v48
    v_sub_f32 v104, v104, v48
    v_sub_f32 v105, v105, v48
    v_sub_f32 v106, v106, v48
    v_sub_f32 v107, v107, v48
    v_sub_f32 v108, v108, v48
    v_sub_f32 v109, v109, v48
    v_sub_f32 v110, v110, v48
    v_sub_f32 v111, v111, v48
    v_sub_f32 v72, v72, v48
    v_sub_f32 v73, v73, v48
    v_sub_f32 v74, v74, v48
    v_sub_f32 v75, v75, v48
    v_sub_f32 v76, v76, v48
    v_sub_f32 v77, v77, v48
    v_sub_f32 v78, v78, v48
    v_sub_f32 v79, v79, v48
    v_sub_f32 v168, v168, v48
    v_sub_f32 v169, v169, v48
    v_sub_f32 v170, v170, v48
    v_sub_f32 v171, v171, v48
    v_sub_f32 v172, v172, v48
    v_sub_f32 v173, v173, v48
    v_sub_f32 v174, v174, v48
    v_sub_f32 v175, v175, v48
    v_mul_f32 v13, v13, v49
    v_accvgpr_read_b32 v52, a32
    v_accvgpr_read_b32 v53, a33
    v_accvgpr_read_b32 v54, a34
    v_accvgpr_read_b32 v55, a35
    v_accvgpr_read_b32 v56, a36
    v_accvgpr_read_b32 v57, a37
    v_accvgpr_read_b32 v58, a38
    v_accvgpr_read_b32 v59, a39
    v_mul_f32 v52, v52, v49
    v_mul_f32 v53, v53, v49
    v_mul_f32 v54, v54, v49
    v_mul_f32 v55, v55, v49
    v_mul_f32 v56, v56, v49
    v_mul_f32 v57, v57, v49
    v_mul_f32 v58, v58, v49
    v_mul_f32 v59, v59, v49
    v_accvgpr_write_b32 a32, v52
    v_accvgpr_write_b32 a33, v53
    v_accvgpr_write_b32 a34, v54
    v_accvgpr_write_b32 a35, v55
    v_accvgpr_write_b32 a36, v56
    v_accvgpr_write_b32 a37, v57
    v_accvgpr_write_b32 a38, v58
    v_accvgpr_write_b32 a39, v59
    v_accvgpr_read_b32 v52, a40
    v_accvgpr_read_b32 v53, a41
    v_accvgpr_read_b32 v54, a42
    v_accvgpr_read_b32 v55, a43
    v_accvgpr_read_b32 v56, a44
    v_accvgpr_read_b32 v57, a45
    v_accvgpr_read_b32 v58, a46
    v_accvgpr_read_b32 v59, a47
    v_mul_f32 v52, v52, v49
    v_mul_f32 v53, v53, v49
    v_mul_f32 v54, v54, v49
    v_mul_f32 v55, v55, v49
    v_mul_f32 v56, v56, v49
    v_mul_f32 v57, v57, v49
    v_mul_f32 v58, v58, v49
    v_mul_f32 v59, v59, v49
    v_accvgpr_write_b32 a40, v52
    v_accvgpr_write_b32 a41, v53
    v_accvgpr_write_b32 a42, v54
    v_accvgpr_write_b32 a43, v55
    v_accvgpr_write_b32 a44, v56
    v_accvgpr_write_b32 a45, v57
    v_accvgpr_write_b32 a46, v58
    v_accvgpr_write_b32 a47, v59
    v_accvgpr_read_b32 v52, a48
    v_accvgpr_read_b32 v53, a49
    v_accvgpr_read_b32 v54, a50
    v_accvgpr_read_b32 v55, a51
    v_accvgpr_read_b32 v56, a52
    v_accvgpr_read_b32 v57, a53
    v_accvgpr_read_b32 v58, a54
    v_accvgpr_read_b32 v59, a55
    v_mul_f32 v52, v52, v49
    v_mul_f32 v53, v53, v49
    v_mul_f32 v54, v54, v49
    v_mul_f32 v55, v55, v49
    v_mul_f32 v56, v56, v49
    v_mul_f32 v57, v57, v49
    v_mul_f32 v58, v58, v49
    v_mul_f32 v59, v59, v49
    v_accvgpr_write_b32 a48, v52
    v_accvgpr_write_b32 a49, v53
    v_accvgpr_write_b32 a50, v54
    v_accvgpr_write_b32 a51, v55
    v_accvgpr_write_b32 a52, v56
    v_accvgpr_write_b32 a53, v57
    v_accvgpr_write_b32 a54, v58
    v_accvgpr_write_b32 a55, v59
    v_accvgpr_read_b32 v52, a56
    v_accvgpr_read_b32 v53, a57
    v_accvgpr_read_b32 v54, a58
    v_accvgpr_read_b32 v55, a59
    v_accvgpr_read_b32 v56, a60
    v_accvgpr_read_b32 v57, a61
    v_accvgpr_read_b32 v58, a62
    v_accvgpr_read_b32 v59, a63
    v_mul_f32 v52, v52, v49
    v_mul_f32 v53, v53, v49
    v_mul_f32 v54, v54, v49
    v_mul_f32 v55, v55, v49
    v_mul_f32 v56, v56, v49
    v_mul_f32 v57, v57, v49
    v_mul_f32 v58, v58, v49
    v_mul_f32 v59, v59, v49
    v_accvgpr_write_b32 a56, v52
    v_accvgpr_write_b32 a57, v53
    v_accvgpr_write_b32 a58, v54
    v_accvgpr_write_b32 a59, v55
    v_accvgpr_write_b32 a60, v56
    v_accvgpr_write_b32 a61, v57
    v_accvgpr_write_b32 a62, v58
    v_accvgpr_write_b32 a63, v59
    v_exp_f32 v52, v104
    v_exp_f32 v53, v105
    v_exp_f32 v54, v106
    v_exp_f32 v55, v107
    v_exp_f32 v56, v108
    v_exp_f32 v57, v109
    v_exp_f32 v58, v110
    v_exp_f32 v59, v111
    s_nop 0
    v_cvt_pk_bf16_f32 v148, v52, v53
    v_cvt_pk_bf16_f32 v149, v54, v55
    v_cvt_pk_bf16_f32 v150, v56, v57
    v_cvt_pk_bf16_f32 v151, v58, v59
    s_nop 1
    v_mfma_f32_16x16x32_bf16 v[32:35], v[44:47], v[148:151], 0
    v_max3_f32 v48, v112, v113, v114
    v_max3_f32 v48, v48, v115, v116
    v_max3_f32 v48, v48, v117, v118
    v_max3_f32 v48, v48, v119, 0
    v_mov_b32 v49, v48
    s_nop 1
    v_permlane32_swap_b32 v48, v49
    s_nop 1
    v_max_f32 v48, v48, v49
    v_mov_b32 v49, v48
    s_nop 1
    v_permlane16_swap_b32 v48, v49
    s_nop 1
    v_max_f32 v48, v48, v49
    v_exp_f32 v49, -v48
    v_sub_f32 v112, v112, v48
    v_sub_f32 v113, v113, v48
    v_sub_f32 v114, v114, v48
    v_sub_f32 v115, v115, v48
    v_sub_f32 v116, v116, v48
    v_sub_f32 v117, v117, v48
    v_sub_f32 v118, v118, v48
    v_sub_f32 v119, v119, v48
    v_sub_f32 v80, v80, v48
    v_sub_f32 v81, v81, v48
    v_sub_f32 v82, v82, v48
    v_sub_f32 v83, v83, v48
    v_sub_f32 v84, v84, v48
    v_sub_f32 v85, v85, v48
    v_sub_f32 v86, v86, v48
    v_sub_f32 v87, v87, v48
    v_sub_f32 v176, v176, v48
    v_sub_f32 v177, v177, v48
    v_sub_f32 v178, v178, v48
    v_sub_f32 v179, v179, v48
    v_sub_f32 v180, v180, v48
    v_sub_f32 v181, v181, v48
    v_sub_f32 v182, v182, v48
    v_sub_f32 v183, v183, v48
    v_mul_f32 v14, v14, v49
    v_accvgpr_read_b32 v52, a64
    v_accvgpr_read_b32 v53, a65
    v_accvgpr_read_b32 v54, a66
    v_accvgpr_read_b32 v55, a67
    v_accvgpr_read_b32 v56, a68
    v_accvgpr_read_b32 v57, a69
    v_accvgpr_read_b32 v58, a70
    v_accvgpr_read_b32 v59, a71
    v_mul_f32 v52, v52, v49
    v_mul_f32 v53, v53, v49
    v_mul_f32 v54, v54, v49
    v_mul_f32 v55, v55, v49
    v_mul_f32 v56, v56, v49
    v_mul_f32 v57, v57, v49
    v_mul_f32 v58, v58, v49
    v_mul_f32 v59, v59, v49
    v_accvgpr_write_b32 a64, v52
    v_accvgpr_write_b32 a65, v53
    v_accvgpr_write_b32 a66, v54
    v_accvgpr_write_b32 a67, v55
    v_accvgpr_write_b32 a68, v56
    v_accvgpr_write_b32 a69, v57
    v_accvgpr_write_b32 a70, v58
    v_accvgpr_write_b32 a71, v59
    v_accvgpr_read_b32 v52, a72
    v_accvgpr_read_b32 v53, a73
    v_accvgpr_read_b32 v54, a74
    v_accvgpr_read_b32 v55, a75
    v_accvgpr_read_b32 v56, a76
    v_accvgpr_read_b32 v57, a77
    v_accvgpr_read_b32 v58, a78
    v_accvgpr_read_b32 v59, a79
    v_mul_f32 v52, v52, v49
    v_mul_f32 v53, v53, v49
    v_mul_f32 v54, v54, v49
    v_mul_f32 v55, v55, v49
    v_mul_f32 v56, v56, v49
    v_mul_f32 v57, v57, v49
    v_mul_f32 v58, v58, v49
    v_mul_f32 v59, v59, v49
    v_accvgpr_write_b32 a72, v52
    v_accvgpr_write_b32 a73, v53
    v_accvgpr_write_b32 a74, v54
    v_accvgpr_write_b32 a75, v55
    v_accvgpr_write_b32 a76, v56
    v_accvgpr_write_b32 a77, v57
    v_accvgpr_write_b32 a78, v58
    v_accvgpr_write_b32 a79, v59
    v_accvgpr_read_b32 v52, a80
    v_accvgpr_read_b32 v53, a81
    v_accvgpr_read_b32 v54, a82
    v_accvgpr_read_b32 v55, a83
    v_accvgpr_read_b32 v56, a84
    v_accvgpr_read_b32 v57, a85
    v_accvgpr_read_b32 v58, a86
    v_accvgpr_read_b32 v59, a87
    v_mul_f32 v52, v52, v49
    v_mul_f32 v53, v53, v49
    v_mul_f32 v54, v54, v49
    v_mul_f32 v55, v55, v49
    v_mul_f32 v56, v56, v49
    v_mul_f32 v57, v57, v49
    v_mul_f32 v58, v58, v49
    v_mul_f32 v59, v59, v49
    v_accvgpr_write_b32 a80, v52
    v_accvgpr_write_b32 a81, v53
    v_accvgpr_write_b32 a82, v54
    v_accvgpr_write_b32 a83, v55
    v_accvgpr_write_b32 a84, v56
    v_accvgpr_write_b32 a85, v57
    v_accvgpr_write_b32 a86, v58
    v_accvgpr_write_b32 a87, v59
    v_accvgpr_read_b32 v52, a88
    v_accvgpr_read_b32 v53, a89
    v_accvgpr_read_b32 v54, a90
    v_accvgpr_read_b32 v55, a91
    v_accvgpr_read_b32 v56, a92
    v_accvgpr_read_b32 v57, a93
    v_accvgpr_read_b32 v58, a94
    v_accvgpr_read_b32 v59, a95
    v_mul_f32 v52, v52, v49
    v_mul_f32 v53, v53, v49
    v_mul_f32 v54, v54, v49
    v_mul_f32 v55, v55, v49
    v_mul_f32 v56, v56, v49
    v_mul_f32 v57, v57, v49
    v_mul_f32 v58, v58, v49
    v_mul_f32 v59, v59, v49
    v_accvgpr_write_b32 a88, v52
    v_accvgpr_write_b32 a89, v53
    v_accvgpr_write_b32 a90, v54
    v_accvgpr_write_b32 a91, v55
    v_accvgpr_write_b32 a92, v56
    v_accvgpr_write_b32 a93, v57
    v_accvgpr_write_b32 a94, v58
    v_accvgpr_write_b32 a95, v59
    v_exp_f32 v52, v112
    v_exp_f32 v53, v113
    v_exp_f32 v54, v114
    v_exp_f32 v55, v115
    v_exp_f32 v56, v116
    v_exp_f32 v57, v117
    v_exp_f32 v58, v118
    v_exp_f32 v59, v119
    s_nop 0
    v_cvt_pk_bf16_f32 v152, v52, v53
    v_cvt_pk_bf16_f32 v153, v54, v55
    v_cvt_pk_bf16_f32 v154, v56, v57
    v_cvt_pk_bf16_f32 v155, v58, v59
    s_nop 1
    v_mfma_f32_16x16x32_bf16 v[36:39], v[44:47], v[152:155], 0
    v_max3_f32 v48, v120, v121, v122
    v_max3_f32 v48, v48, v123, v124
    v_max3_f32 v48, v48, v125, v126
    v_max3_f32 v48, v48, v127, 0
    v_mov_b32 v49, v48
    s_nop 1
    v_permlane32_swap_b32 v48, v49
    s_nop 1
    v_max_f32 v48, v48, v49
    v_mov_b32 v49, v48
    s_nop 1
    v_permlane16_swap_b32 v48, v49
    s_nop 1
    v_max_f32 v48, v48, v49
    v_exp_f32 v49, -v48
    v_sub_f32 v120, v120, v48
    v_sub_f32 v121, v121, v48
    v_sub_f32 v122, v122, v48
    v_sub_f32 v123, v123, v48
    v_sub_f32 v124, v124, v48
    v_sub_f32 v125, v125, v48
    v_sub_f32 v126, v126, v48
    v_sub_f32 v127, v127, v48
    v_sub_f32 v88, v88, v48
    v_sub_f32 v89, v89, v48
    v_sub_f32 v90, v90, v48
    v_sub_f32 v91, v91, v48
    v_sub_f32 v92, v92, v48
    v_sub_f32 v93, v93, v48
    v_sub_f32 v94, v94, v48
    v_sub_f32 v95, v95, v48
    v_sub_f32 v184, v184, v48
    v_sub_f32 v185, v185, v48
    v_sub_f32 v186, v186, v48
    v_sub_f32 v187, v187, v48
    v_sub_f32 v188, v188, v48
    v_sub_f32 v189, v189, v48
    v_sub_f32 v190, v190, v48
    v_sub_f32 v191, v191, v48
    v_mul_f32 v15, v15, v49
    v_accvgpr_read_b32 v52, a96
    v_accvgpr_read_b32 v53, a97
    v_accvgpr_read_b32 v54, a98
    v_accvgpr_read_b32 v55, a99
    v_accvgpr_read_b32 v56, a100
    v_accvgpr_read_b32 v57, a101
    v_accvgpr_read_b32 v58, a102
    v_accvgpr_read_b32 v59, a103
    v_mul_f32 v52, v52, v49
    v_mul_f32 v53, v53, v49
    v_mul_f32 v54, v54, v49
    v_mul_f32 v55, v55, v49
    v_mul_f32 v56, v56, v49
    v_mul_f32 v57, v57, v49
    v_mul_f32 v58, v58, v49
    v_mul_f32 v59, v59, v49
    v_accvgpr_write_b32 a96, v52
    v_accvgpr_write_b32 a97, v53
    v_accvgpr_write_b32 a98, v54
    v_accvgpr_write_b32 a99, v55
    v_accvgpr_write_b32 a100, v56
    v_accvgpr_write_b32 a101, v57
    v_accvgpr_write_b32 a102, v58
    v_accvgpr_write_b32 a103, v59
    v_accvgpr_read_b32 v52, a104
    v_accvgpr_read_b32 v53, a105
    v_accvgpr_read_b32 v54, a106
    v_accvgpr_read_b32 v55, a107
    v_accvgpr_read_b32 v56, a108
    v_accvgpr_read_b32 v57, a109
    v_accvgpr_read_b32 v58, a110
    v_accvgpr_read_b32 v59, a111
    v_mul_f32 v52, v52, v49
    v_mul_f32 v53, v53, v49
    v_mul_f32 v54, v54, v49
    v_mul_f32 v55, v55, v49
    v_mul_f32 v56, v56, v49
    v_mul_f32 v57, v57, v49
    v_mul_f32 v58, v58, v49
    v_mul_f32 v59, v59, v49
    v_accvgpr_write_b32 a104, v52
    v_accvgpr_write_b32 a105, v53
    v_accvgpr_write_b32 a106, v54
    v_accvgpr_write_b32 a107, v55
    v_accvgpr_write_b32 a108, v56
    v_accvgpr_write_b32 a109, v57
    v_accvgpr_write_b32 a110, v58
    v_accvgpr_write_b32 a111, v59
    v_accvgpr_read_b32 v52, a112
    v_accvgpr_read_b32 v53, a113
    v_accvgpr_read_b32 v54, a114
    v_accvgpr_read_b32 v55, a115
    v_accvgpr_read_b32 v56, a116
    v_accvgpr_read_b32 v57, a117
    v_accvgpr_read_b32 v58, a118
    v_accvgpr_read_b32 v59, a119
    v_mul_f32 v52, v52, v49
    v_mul_f32 v53, v53, v49
    v_mul_f32 v54, v54, v49
    v_mul_f32 v55, v55, v49
    v_mul_f32 v56, v56, v49
    v_mul_f32 v57, v57, v49
    v_mul_f32 v58, v58, v49
    v_mul_f32 v59, v59, v49
    v_accvgpr_write_b32 a112, v52
    v_accvgpr_write_b32 a113, v53
    v_accvgpr_write_b32 a114, v54
    v_accvgpr_write_b32 a115, v55
    v_accvgpr_write_b32 a116, v56
    v_accvgpr_write_b32 a117, v57
    v_accvgpr_write_b32 a118, v58
    v_accvgpr_write_b32 a119, v59
    v_accvgpr_read_b32 v52, a120
    v_accvgpr_read_b32 v53, a121
    v_accvgpr_read_b32 v54, a122
    v_accvgpr_read_b32 v55, a123
    v_accvgpr_read_b32 v56, a124
    v_accvgpr_read_b32 v57, a125
    v_accvgpr_read_b32 v58, a126
    v_accvgpr_read_b32 v59, a127
    v_mul_f32 v52, v52, v49
    v_mul_f32 v53, v53, v49
    v_mul_f32 v54, v54, v49
    v_mul_f32 v55, v55, v49
    v_mul_f32 v56, v56, v49
    v_mul_f32 v57, v57, v49
    v_mul_f32 v58, v58, v49
    v_mul_f32 v59, v59, v49
    v_accvgpr_write_b32 a120, v52
    v_accvgpr_write_b32 a121, v53
    v_accvgpr_write_b32 a122, v54
    v_accvgpr_write_b32 a123, v55
    v_accvgpr_write_b32 a124, v56
    v_accvgpr_write_b32 a125, v57
    v_accvgpr_write_b32 a126, v58
    v_accvgpr_write_b32 a127, v59
    v_exp_f32 v52, v120
    v_exp_f32 v53, v121
    v_exp_f32 v54, v122
    v_exp_f32 v55, v123
    v_exp_f32 v56, v124
    v_exp_f32 v57, v125
    v_exp_f32 v58, v126
    v_exp_f32 v59, v127
    s_nop 0
    v_cvt_pk_bf16_f32 v156, v52, v53
    v_cvt_pk_bf16_f32 v157, v54, v55
    v_cvt_pk_bf16_f32 v158, v56, v57
    v_cvt_pk_bf16_f32 v159, v58, v59
    s_nop 1
    v_mfma_f32_16x16x32_bf16 v[40:43], v[44:47], v[156:159], 0
    s_nop 7
    s_setpc_b64 s[74:75]
m_hook14:
    s_cmp_lg_u32 s16, 0
    s_cbranch_scc1 m_np38
    v_mov_b32 v4, s4
    v_mov_b32 v5, s5
    s_add_u32 s90, s17, 117440512
    s_mov_b64 exec, 1
    buffer_store_dwordx2 v[4:5], off, s[8:11], s90 sc1
    s_mov_b64 exec, -1
m_np38:
    s_mov_b32 s17, -1
    s_branch m_hookr15
m_hook18:
    s_cmp_lg_u32 s16, 0
    s_cbranch_scc1 m_np39
    v_mov_b32 v4, s4
    v_mov_b32 v5, s5
    s_add_u32 s90, s17, 117440512
    s_mov_b64 exec, 1
    buffer_store_dwordx2 v[4:5], off, s[8:11], s90 sc1
    s_mov_b64 exec, -1
m_np39:
    s_mov_b32 s17, -1
    s_branch m_hookr19
m_dosw17:
    s_cmp_eq_u32 s94, 0
    s_cbranch_scc1 m_x40
    s_cmp_lg_u32 s65, 3
    s_cbranch_scc1 m_x46
    s_mov_b32 s42, s73
    s_lshl_b32 s90, s77, 4
    s_lshl_b32 s90, s90, s81
    s_mov_b32 s48, s79
    s_mul_i32 s91, s90, 1
    s_add_u32 s49, s91, s79
    s_sub_u32 s49, s49, 2048
    s_mul_i32 s91, s90, 2
    s_add_u32 s50, s91, s79
    s_mul_i32 s91, s90, 3
    s_add_u32 s51, s91, s79
    s_sub_u32 s51, s51, 2048
    s_lshl_b32 s90, s58, 7
    s_add_u32 s90, s90, s57
    s_lshl_b32 s91, s16, 6
    s_cmp_eq_u32 s81, 1
    s_cselect_b32 s90, s90, s91
    v_lshrrev_b32 v24, 3, v1
    v_lshlrev_b32 v24, s81, v24
    v_add_u32 v24, s90, v24
    v_mul_lo_u32 v24, v24, s77
    v_lshrrev_b32 v25, 4, v1
    v_and_b32 v26, 7, v1
    v_xor_b32 v25, v25, v26
    v_lshl_add_u32 v16, v25, 4, v24
    v_xor_b32 v25, 4, v25
    v_lshl_add_u32 v17, v25, 4, v24
    s_lshl_b32 s90, s77, 3
    s_lshl_b32 s90, s90, s81
    s_sub_u32 s90, s90, 1024
    v_add_u32 v17, s90, v17
    s_mov_b32 s40, s71
    s_mov_b32 s41, s72
    buffer_load_dwordx2 v[4:5], off, s[12:15], 0 sc1
    s_branch m_loop16
m_x46:
    s_mov_b32 s46, s76
    s_mov_b32 s52, s80
    s_lshl_b32 s90, s78, 2
    s_mul_i32 s91, s90, 1
    s_add_u32 s53, s91, s80
    s_sub_u32 s53, s53, 2048
    s_mul_i32 s91, s90, 2
    s_add_u32 s54, s91, s80
    s_mul_i32 s91, s90, 3
    s_add_u32 s55, s91, s80
    s_sub_u32 s55, s55, 2048
    s_lshl_b32 s56, s78, 6
    v_lshrrev_b32 v24, 5, v1
    s_lshl_b32 s90, s16, 4
    v_add_u32 v25, s90, v24
    v_mul_lo_u32 v25, v25, s78
    v_lshlrev_b32 v24, 1, v24
    v_and_b32 v26, 31, v1
    v_xor_b32 v24, v24, v26
    s_lshl_b32 s90, s78, 1
    s_sub_u32 s90, s90, 1024
    v_add_u32 v27, s90, v25
    v_xor_b32 v26, 0, v24
    v_lshl_add_u32 v18, v26, 4, v25
    v_xor_b32 v26, 4, v24
    v_lshl_add_u32 v19, v26, 4, v27
    v_xor_b32 v26, 8, v24
    v_lshl_add_u32 v20, v26, 4, v25
    v_xor_b32 v26, 12, v24
    v_lshl_add_u32 v21, v26, 4, v27
    s_mov_b32 s44, s74
    s_mov_b32 s45, s75
    s_mov_b32 s67, 0
    s_branch m_loop16
m_x40:
    s_cmp_eq_u32 s70, 1
    s_cbranch_scc1 m_x45
    s_cmp_le_u32 s65, 4
    s_cbranch_scc1 m_x41
    s_cmp_lg_u32 s16, 0
    s_cbranch_scc1 m_np47
    v_mov_b32 v4, s4
    v_mov_b32 v5, s5
    s_add_u32 s90, s17, 117440512
    s_mov_b64 exec, 1
    buffer_store_dwordx2 v[4:5], off, s[8:11], s90 sc1
    s_mov_b64 exec, -1
m_np47:
    s_mov_b32 s17, -1
    s_mov_b32 s67, 4
    s_branch m_loop16
m_x41:
    s_cmp_lg_u32 s65, 4
    s_cbranch_scc1 m_x42
    s_and_b32 s92, s2, 7
    s_lshl_b32 s92, s92, 2
    s_bfe_u32 s93, s2, 0x20003
    s_add_u32 s92, s92, s93
    s_lshr_b32 s93, s2, 5
    s_lshl_b32 s93, s93, 2
    s_or_b32 s93, s93, 0x40000
    s_lshr_b32 s90, s92, 1
    s_lshl_b32 s90, s90, 7
    s_add_u32 s90, s90, 117440512
    v_and_b32 v0, 3, v1
    v_min_u32 v0, 2, v0
    v_and_b32 v4, 4, v1
    v_add3_u32 v0, v0, v4, 8
    v_lshlrev_b32 v0, 3, v0
    buffer_load_dwordx2 v[4:5], v0, s[8:11], s90 offen sc1
    s_branch m_loop16
m_x42:
    s_waitcnt vmcnt(16)
    s_cmp_lg_u32 s65, 3
    s_cbranch_scc1 m_x43
    s_mov_b32 s3, 1048576
m_spin48:
    v_cmp_ne_u64 s[22:23], s[4:5], v[4:5]
    s_nop 3
    s_cmp_eq_u64 s[22:23], 0
    s_cbranch_scc1 m_ok49
    s_sub_u32 s3, s3, 1
    s_cbranch_scc1 m_ok49
    s_sleep 16
    s_and_b32 s92, s2, 7
    s_lshl_b32 s92, s92, 2
    s_bfe_u32 s93, s2, 0x20003
    s_add_u32 s92, s92, s93
    s_lshr_b32 s93, s2, 5
    s_lshl_b32 s93, s93, 2
    s_or_b32 s93, s93, 0x40000
    s_lshr_b32 s90, s92, 1
    s_lshl_b32 s90, s90, 7
    s_add_u32 s90, s90, 117440512
    v_and_b32 v0, 3, v1
    v_min_u32 v0, 2, v0
    v_and_b32 v4, 4, v1
    v_add3_u32 v0, v0, v4, 8
    v_lshlrev_b32 v0, 3, v0
    buffer_load_dwordx2 v[4:5], v0, s[8:11], s90 offen sc1
    s_waitcnt vmcnt(0)
    s_branch m_spin48
m_ok49:
    s_and_b32 s92, s2, 7
    s_lshl_b32 s92, s92, 2
    s_bfe_u32 s93, s2, 0x20003
    s_add_u32 s92, s92, s93
    s_lshr_b32 s93, s2, 5
    s_lshl_b32 s93, s93, 2
    s_or_b32 s93, s93, 0x40000
    s_lshl_b32 s90, s92, 19
    s_lshl_b32 s91, s58, 13
    s_add_u32 s90, s90, s91
    s_cmp_eq_u32 s57, 0
    s_mov_b32 s91, 33554432
    s_cselect_b32 s91, 16777216, s91
    s_mov_b32 s42, 0
    s_cselect_b32 s42, 268435456, s42
    s_add_u32 s48, s90, s91
    s_mov_b32 s49, s48
    s_add_u32 s50, s48, 4096
    s_mov_b32 s51, s50
    s_mov_b32 s40, s6
    s_mov_b32 s41, s7
    v_mov_b32 v16, v2
    v_mov_b32 v17, v2
    s_branch m_loop16
m_x43:
    s_cmp_lg_u32 s65, 2
    s_cbranch_scc1 m_x44
    s_and_b32 s92, s2, 7
    s_lshl_b32 s92, s92, 2
    s_bfe_u32 s93, s2, 0x20003
    s_add_u32 s92, s92, s93
    s_lshr_b32 s93, s2, 5
    s_lshl_b32 s93, s93, 2
    s_or_b32 s93, s93, 0x40000
    s_lshr_b32 s90, s92, 1
    s_lshl_b32 s90, s90, 7
    s_add_u32 s90, s90, 117440512
    s_bfe_u32 s91, 873473623, s93
    s_lshr_b32 s91, s91, 1
    v_mov_b32 v0, s91
    s_bfe_u32 s91, 4225681832, s93
    s_lshr_b32 s91, s91, 1
    v_writelane_b32 v0, s91, 8
    v_lshlrev_b32 v0, 3, v0
    buffer_load_dwordx2 v[4:5], v0, s[8:11], s90 offen sc1
    s_lshl_b32 s90, s92, 19
    s_lshl_b32 s91, s58, 13
    s_add_u32 s90, s90, s91
    s_cmp_eq_u32 s57, 0
    s_mov_b32 s91, 33554432
    s_cselect_b32 s91, 16793600, s91
    s_mov_b32 s42, 268435456
    s_cselect_b32 s42, 268435456, s42
    s_add_u32 s48, s90, s91
    s_mov_b32 s49, s48
    s_add_u32 s50, s48, 4096
    s_mov_b32 s51, s50
    s_mov_b32 s40, s6
    s_mov_b32 s41, s7
    s_lshl_b32 s90, s92, 19
    s_lshl_b32 s91, s58, 13
    s_add_u32 s90, s90, s91
    s_cmp_eq_u32 s57, 0
    s_mov_b32 s91, 33587200
    s_cselect_b32 s91, 16826368, s91
    s_mov_b32 s46, 268435456
    s_cselect_b32 s46, 268435456, s46
    s_add_u32 s52, s90, s91
    s_mov_b32 s53, s52
    s_add_u32 s54, s52, 4096
    s_mov_b32 s55, s54
    s_mov_b32 s44, s6
    s_mov_b32 s45, s7
    v_mov_b32 v18, v2
    v_mov_b32 v19, v2
    v_mov_b32 v20, v2
    v_mov_b32 v21, v2
    s_branch m_loop16
m_x44:
    s_mov_b32 s3, 1048576
m_spin50:
    v_cmp_ne_u64 s[22:23], s[4:5], v[4:5]
    s_nop 3
    s_cmp_eq_u64 s[22:23], 0
    s_cbranch_scc1 m_ok51
    s_sub_u32 s3, s3, 1
    s_cbranch_scc1 m_ok51
    s_sleep 16
    s_and_b32 s92, s2, 7
    s_lshl_b32 s92, s92, 2
    s_bfe_u32 s93, s2, 0x20003
    s_add_u32 s92, s92, s93
    s_lshr_b32 s93, s2, 5
    s_lshl_b32 s93, s93, 2
    s_or_b32 s93, s93, 0x40000
    s_lshr_b32 s90, s92, 1
    s_lshl_b32 s90, s90, 7
    s_add_u32 s90, s90, 117440512
    s_bfe_u32 s91, 873473623, s93
    s_lshr_b32 s91, s91, 1
    v_mov_b32 v0, s91
    s_bfe_u32 s91, 4225681832, s93
    s_lshr_b32 s91, s91, 1
    v_writelane_b32 v0, s91, 8
    v_lshlrev_b32 v0, 3, v0
    buffer_load_dwordx2 v[4:5], v0, s[8:11], s90 offen sc1
    s_waitcnt vmcnt(0)
    s_branch m_spin50
m_ok51:
    s_and_b32 s92, s2, 7
    s_lshl_b32 s92, s92, 2
    s_bfe_u32 s93, s2, 0x20003
    s_add_u32 s92, s92, s93
    s_lshr_b32 s93, s2, 5
    s_lshl_b32 s93, s93, 2
    s_or_b32 s93, s93, 0x40000
    s_bfe_u32 s90, 4225681832, s93
    s_lshl_b32 s90, s90, 3
    s_lshl_b32 s91, s16, 1
    s_add_u32 s90, s90, s91
    s_lshl_b32 s90, s90, 12
    s_lshl_b32 s91, s92, 19
    s_add_u32 s90, s90, s91
    s_add_u32 s90, s90, 0
    buffer_load_dwordx4 a[128:131], v2, s[8:11], s90 offen offset:0 sc1
    buffer_load_dwordx4 a[132:135], v2, s[8:11], s90 offen offset:1024 sc1
    buffer_load_dwordx4 a[136:139], v2, s[8:11], s90 offen offset:2048 sc1
    buffer_load_dwordx4 a[140:143], v2, s[8:11], s90 offen offset:3072 sc1
    s_bfe_u32 s90, 4225681832, s93
    s_lshl_b32 s90, s90, 3
    s_lshl_b32 s91, s16, 1
    s_add_u32 s90, s90, s91
    s_lshl_b32 s90, s90, 12
    s_lshl_b32 s91, s92, 19
    s_add_u32 s90, s90, s91
    s_add_u32 s90, s90, 4096
    buffer_load_dwordx4 a[144:147], v2, s[8:11], s90 offen offset:0 sc1
    buffer_load_dwordx4 a[148:151], v2, s[8:11], s90 offen offset:1024 sc1
    buffer_load_dwordx4 a[152:155], v2, s[8:11], s90 offen offset:2048 sc1
    buffer_load_dwordx4 a[156:159], v2, s[8:11], s90 offen offset:3072 sc1
    s_bfe_u32 s90, 873473623, s93
    s_lshl_b32 s90, s90, 3
    s_lshl_b32 s91, s16, 1
    s_add_u32 s90, s90, s91
    s_lshl_b32 s90, s90, 12
    s_lshl_b32 s91, s92, 19
    s_add_u32 s90, s90, s91
    s_add_u32 s90, s90, 0
    buffer_load_dwordx4 a[160:163], v2, s[8:11], s90 offen offset:0 sc1
    buffer_load_dwordx4 a[164:167], v2, s[8:11], s90 offen offset:1024 sc1
    buffer_load_dwordx4 a[168:171], v2, s[8:11], s90 offen offset:2048 sc1
    buffer_load_dwordx4 a[172:175], v2, s[8:11], s90 offen offset:3072 sc1
    s_bfe_u32 s90, 873473623, s93
    s_lshl_b32 s90, s90, 3
    s_lshl_b32 s91, s16, 1
    s_add_u32 s90, s90, s91
    s_lshl_b32 s90, s90, 12
    s_lshl_b32 s91, s92, 19
    s_add_u32 s90, s90, s91
    s_add_u32 s90, s90, 4096
    buffer_load_dwordx4 a[176:179], v2, s[8:11], s90 offen offset:0 sc1
    buffer_load_dwordx4 a[180:183], v2, s[8:11], s90 offen offset:1024 sc1
    buffer_load_dwordx4 a[184:187], v2, s[8:11], s90 offen offset:2048 sc1
    buffer_load_dwordx4 a[188:191], v2, s[8:11], s90 offen offset:3072 sc1
    s_lshl_b32 s90, s92, 19
    s_lshl_b32 s91, s58, 13
    s_add_u32 s90, s90, s91
    s_cmp_eq_u32 s57, 0
    s_mov_b32 s91, 33570816
    s_cselect_b32 s91, 16809984, s91
    s_mov_b32 s42, 268435456
    s_cselect_b32 s42, 268435456, s42
    s_add_u32 s48, s90, s91
    s_mov_b32 s49, s48
    s_add_u32 s50, s48, 4096
    s_mov_b32 s51, s50
    s_mov_b32 s40, s6
    s_mov_b32 s41, s7
    s_lshl_b32 s90, s92, 19
    s_lshl_b32 s91, s58, 13
    s_add_u32 s90, s90, s91
    s_cmp_eq_u32 s57, 0
    s_mov_b32 s91, 33603584
    s_cselect_b32 s91, 16842752, s91
    s_mov_b32 s46, 268435456
    s_cselect_b32 s46, 268435456, s46
    s_add_u32 s52, s90, s91
    s_mov_b32 s53, s52
    s_add_u32 s54, s52, 4096
    s_mov_b32 s55, s54
    s_mov_b32 s44, s6
    s_mov_b32 s45, s7
    s_branch m_loop16
m_x45:
    s_mov_b32 s42, 0
    s_cmp_eq_u32 s65, 3
    s_cbranch_scc1 m_loop16
    s_mov_b32 s46, 0
    s_branch m_loop16
m_dosw21:
    s_cmp_eq_u32 s94, 0
    s_cbranch_scc1 m_x52
    s_cmp_lg_u32 s65, 3
    s_cbranch_scc1 m_x58
    s_mov_b32 s42, s73
    s_lshl_b32 s90, s77, 4
    s_lshl_b32 s90, s90, s81
    s_mov_b32 s48, s79
    s_mul_i32 s91, s90, 1
    s_add_u32 s49, s91, s79
    s_sub_u32 s49, s49, 2048
    s_mul_i32 s91, s90, 2
    s_add_u32 s50, s91, s79
    s_mul_i32 s91, s90, 3
    s_add_u32 s51, s91, s79
    s_sub_u32 s51, s51, 2048
    s_lshl_b32 s90, s58, 7
    s_add_u32 s90, s90, s57
    s_lshl_b32 s91, s16, 6
    s_cmp_eq_u32 s81, 1
    s_cselect_b32 s90, s90, s91
    v_lshrrev_b32 v24, 3, v1
    v_lshlrev_b32 v24, s81, v24
    v_add_u32 v24, s90, v24
    v_mul_lo_u32 v24, v24, s77
    v_lshrrev_b32 v25, 4, v1
    v_and_b32 v26, 7, v1
    v_xor_b32 v25, v25, v26
    v_lshl_add_u32 v16, v25, 4, v24
    v_xor_b32 v25, 4, v25
    v_lshl_add_u32 v17, v25, 4, v24
    s_lshl_b32 s90, s77, 3
    s_lshl_b32 s90, s90, s81
    s_sub_u32 s90, s90, 1024
    v_add_u32 v17, s90, v17
    s_mov_b32 s40, s71
    s_mov_b32 s41, s72
    buffer_load_dwordx2 v[4:5], off, s[12:15], 0 sc1
    s_branch m_loop20
m_x58:
    s_mov_b32 s46, s76
    s_mov_b32 s52, s80
    s_lshl_b32 s90, s78, 2
    s_mul_i32 s91, s90, 1
    s_add_u32 s53, s91, s80
    s_sub_u32 s53, s53, 2048
    s_mul_i32 s91, s90, 2
    s_add_u32 s54, s91, s80
    s_mul_i32 s91, s90, 3
    s_add_u32 s55, s91, s80
    s_sub_u32 s55, s55, 2048
    s_lshl_b32 s56, s78, 6
    v_lshrrev_b32 v24, 5, v1
    s_lshl_b32 s90, s16, 4
    v_add_u32 v25, s90, v24
    v_mul_lo_u32 v25, v25, s78
    v_lshlrev_b32 v24, 1, v24
    v_and_b32 v26, 31, v1
    v_xor_b32 v24, v24, v26
    s_lshl_b32 s90, s78, 1
    s_sub_u32 s90, s90, 1024
    v_add_u32 v27, s90, v25
    v_xor_b32 v26, 0, v24
    v_lshl_add_u32 v18, v26, 4, v25
    v_xor_b32 v26, 4, v24
    v_lshl_add_u32 v19, v26, 4, v27
    v_xor_b32 v26, 8, v24
    v_lshl_add_u32 v20, v26, 4, v25
    v_xor_b32 v26, 12, v24
    v_lshl_add_u32 v21, v26, 4, v27
    s_mov_b32 s44, s74
    s_mov_b32 s45, s75
    s_mov_b32 s67, 0
    s_branch m_loop20
m_x52:
    s_cmp_eq_u32 s70, 1
    s_cbranch_scc1 m_x57
    s_cmp_le_u32 s65, 4
    s_cbranch_scc1 m_x53
    s_cmp_lg_u32 s16, 0
    s_cbranch_scc1 m_np59
    v_mov_b32 v4, s4
    v_mov_b32 v5, s5
    s_add_u32 s90, s17, 117440512
    s_mov_b64 exec, 1
    buffer_store_dwordx2 v[4:5], off, s[8:11], s90 sc1
    s_mov_b64 exec, -1
m_np59:
    s_mov_b32 s17, -1
    s_mov_b32 s67, 4
    s_branch m_loop20
m_x53:
    s_cmp_lg_u32 s65, 4
    s_cbranch_scc1 m_x54
    s_and_b32 s92, s2, 7
    s_lshl_b32 s92, s92, 2
    s_bfe_u32 s93, s2, 0x20003
    s_add_u32 s92, s92, s93
    s_lshr_b32 s93, s2, 5
    s_lshl_b32 s93, s93, 2
    s_or_b32 s93, s93, 0x40000
    s_lshr_b32 s90, s92, 1
    s_lshl_b32 s90, s90, 7
    s_add_u32 s90, s90, 117440512
    v_and_b32 v0, 3, v1
    v_min_u32 v0, 2, v0
    v_and_b32 v4, 4, v1
    v_add3_u32 v0, v0, v4, 8
    v_lshlrev_b32 v0, 3, v0
    buffer_load_dwordx2 v[4:5], v0, s[8:11], s90 offen sc1
    s_branch m_loop20
m_x54:
    s_waitcnt vmcnt(16)
    s_cmp_lg_u32 s65, 3
    s_cbranch_scc1 m_x55
    s_mov_b32 s3, 1048576
m_spin60:
    v_cmp_ne_u64 s[22:23], s[4:5], v[4:5]
    s_nop 3
    s_cmp_eq_u64 s[22:23], 0
    s_cbranch_scc1 m_ok61
    s_sub_u32 s3, s3, 1
    s_cbranch_scc1 m_ok61
    s_sleep 16
    s_and_b32 s92, s2, 7
    s_lshl_b32 s92, s92, 2
    s_bfe_u32 s93, s2, 0x20003
    s_add_u32 s92, s92, s93
    s_lshr_b32 s93, s2, 5
    s_lshl_b32 s93, s93, 2
    s_or_b32 s93, s93, 0x40000
    s_lshr_b32 s90, s92, 1
    s_lshl_b32 s90, s90, 7
    s_add_u32 s90, s90, 117440512
    v_and_b32 v0, 3, v1
    v_min_u32 v0, 2, v0
    v_and_b32 v4, 4, v1
    v_add3_u32 v0, v0, v4, 8
    v_lshlrev_b32 v0, 3, v0
    buffer_load_dwordx2 v[4:5], v0, s[8:11], s90 offen sc1
    s_waitcnt vmcnt(0)
    s_branch m_spin60
m_ok61:
    s_and_b32 s92, s2, 7
    s_lshl_b32 s92, s92, 2
    s_bfe_u32 s93, s2, 0x20003
    s_add_u32 s92, s92, s93
    s_lshr_b32 s93, s2, 5
    s_lshl_b32 s93, s93, 2
    s_or_b32 s93, s93, 0x40000
    s_lshl_b32 s90, s92, 19
    s_lshl_b32 s91, s58, 13
    s_add_u32 s90, s90, s91
    s_cmp_eq_u32 s57, 0
    s_mov_b32 s91, 33554432
    s_cselect_b32 s91, 16777216, s91
    s_mov_b32 s42, 0
    s_cselect_b32 s42, 268435456, s42
    s_add_u32 s48, s90, s91
    s_mov_b32 s49, s48
    s_add_u32 s50, s48, 4096
    s_mov_b32 s51, s50
    s_mov_b32 s40, s6
    s_mov_b32 s41, s7
    v_mov_b32 v16, v2
    v_mov_b32 v17, v2
    s_branch m_loop20
m_x55:
    s_cmp_lg_u32 s65, 2
    s_cbranch_scc1 m_x56
    s_and_b32 s92, s2, 7
    s_lshl_b32 s92, s92, 2
    s_bfe_u32 s93, s2, 0x20003
    s_add_u32 s92, s92, s93
    s_lshr_b32 s93, s2, 5
    s_lshl_b32 s93, s93, 2
    s_or_b32 s93, s93, 0x40000
    s_lshr_b32 s90, s92, 1
    s_lshl_b32 s90, s90, 7
    s_add_u32 s90, s90, 117440512
    s_bfe_u32 s91, 873473623, s93
    s_lshr_b32 s91, s91, 1
    v_mov_b32 v0, s91
    s_bfe_u32 s91, 4225681832, s93
    s_lshr_b32 s91, s91, 1
    v_writelane_b32 v0, s91, 8
    v_lshlrev_b32 v0, 3, v0
    buffer_load_dwordx2 v[4:5], v0, s[8:11], s90 offen sc1
    s_lshl_b32 s90, s92, 19
    s_lshl_b32 s91, s58, 13
    s_add_u32 s90, s90, s91
    s_cmp_eq_u32 s57, 0
    s_mov_b32 s91, 33554432
    s_cselect_b32 s91, 16793600, s91
    s_mov_b32 s42, 268435456
    s_cselect_b32 s42, 268435456, s42
    s_add_u32 s48, s90, s91
    s_mov_b32 s49, s48
    s_add_u32 s50, s48, 4096
    s_mov_b32 s51, s50
    s_mov_b32 s40, s6
    s_mov_b32 s41, s7
    s_lshl_b32 s90, s92, 19
    s_lshl_b32 s91, s58, 13
    s_add_u32 s90, s90, s91
    s_cmp_eq_u32 s57, 0
    s_mov_b32 s91, 33587200
    s_cselect_b32 s91, 16826368, s91
    s_mov_b32 s46, 268435456
    s_cselect_b32 s46, 268435456, s46
    s_add_u32 s52, s90, s91
    s_mov_b32 s53, s52
    s_add_u32 s54, s52, 4096
    s_mov_b32 s55, s54
    s_mov_b32 s44, s6
    s_mov_b32 s45, s7
    v_mov_b32 v18, v2
    v_mov_b32 v19, v2
    v_mov_b32 v20, v2
    v_mov_b32 v21, v2
    s_branch m_loop20
m_x56:
    s_mov_b32 s3, 1048576
m_spin62:
    v_cmp_ne_u64 s[22:23], s[4:5], v[4:5]
    s_nop 3
    s_cmp_eq_u64 s[22:23], 0
    s_cbranch_scc1 m_ok63
    s_sub_u32 s3, s3, 1
    s_cbranch_scc1 m_ok63
    s_sleep 16
    s_and_b32 s92, s2, 7
    s_lshl_b32 s92, s92, 2
    s_bfe_u32 s93, s2, 0x20003
    s_add_u32 s92, s92, s93
    s_lshr_b32 s93, s2, 5
    s_lshl_b32 s93, s93, 2
    s_or_b32 s93, s93, 0x40000
    s_lshr_b32 s90, s92, 1
    s_lshl_b32 s90, s90, 7
    s_add_u32 s90, s90, 117440512
    s_bfe_u32 s91, 873473623, s93
    s_lshr_b32 s91, s91, 1
    v_mov_b32 v0, s91
    s_bfe_u32 s91, 4225681832, s93
    s_lshr_b32 s91, s91, 1
    v_writelane_b32 v0, s91, 8
    v_lshlrev_b32 v0, 3, v0
    buffer_load_dwordx2 v[4:5], v0, s[8:11], s90 offen sc1
    s_waitcnt vmcnt(0)
    s_branch m_spin62
m_ok63:
    s_and_b32 s92, s2, 7
    s_lshl_b32 s92, s92, 2
    s_bfe_u32 s93, s2, 0x20003
    s_add_u32 s92, s92, s93
    s_lshr_b32 s93, s2, 5
    s_lshl_b32 s93, s93, 2
    s_or_b32 s93, s93, 0x40000
    s_bfe_u32 s90, 4225681832, s93
    s_lshl_b32 s90, s90, 3
    s_lshl_b32 s91, s16, 1
    s_add_u32 s90, s90, s91
    s_lshl_b32 s90, s90, 12
    s_lshl_b32 s91, s92, 19
    s_add_u32 s90, s90, s91
    s_add_u32 s90, s90, 0
    buffer_load_dwordx4 a[128:131], v2, s[8:11], s90 offen offset:0 sc1
    buffer_load_dwordx4 a[132:135], v2, s[8:11], s90 offen offset:1024 sc1
    buffer_load_dwordx4 a[136:139], v2, s[8:11], s90 offen offset:2048 sc1
    buffer_load_dwordx4 a[140:143], v2, s[8:11], s90 offen offset:3072 sc1
    s_bfe_u32 s90, 4225681832, s93
    s_lshl_b32 s90, s90, 3
    s_lshl_b32 s91, s16, 1
    s_add_u32 s90, s90, s91
    s_lshl_b32 s90, s90, 12
    s_lshl_b32 s91, s92, 19
    s_add_u32 s90, s90, s91
    s_add_u32 s90, s90, 4096
    buffer_load_dwordx4 a[144:147], v2, s[8:11], s90 offen offset:0 sc1
    buffer_load_dwordx4 a[148:151], v2, s[8:11], s90 offen offset:1024 sc1
    buffer_load_dwordx4 a[152:155], v2, s[8:11], s90 offen offset:2048 sc1
    buffer_load_dwordx4 a[156:159], v2, s[8:11], s90 offen offset:3072 sc1
    s_bfe_u32 s90, 873473623, s93
    s_lshl_b32 s90, s90, 3
    s_lshl_b32 s91, s16, 1
    s_add_u32 s90, s90, s91
    s_lshl_b32 s90, s90, 12
    s_lshl_b32 s91, s92, 19
    s_add_u32 s90, s90, s91
    s_add_u32 s90, s90, 0
    buffer_load_dwordx4 a[160:163], v2, s[8:11], s90 offen offset:0 sc1
    buffer_load_dwordx4 a[164:167], v2, s[8:11], s90 offen offset:1024 sc1
    buffer_load_dwordx4 a[168:171], v2, s[8:11], s90 offen offset:2048 sc1
    buffer_load_dwordx4 a[172:175], v2, s[8:11], s90 offen offset:3072 sc1
    s_bfe_u32 s90, 873473623, s93
    s_lshl_b32 s90, s90, 3
    s_lshl_b32 s91, s16, 1
    s_add_u32 s90, s90, s91
    s_lshl_b32 s90, s90, 12
    s_lshl_b32 s91, s92, 19
    s_add_u32 s90, s90, s91
    s_add_u32 s90, s90, 4096
    buffer_load_dwordx4 a[176:179], v2, s[8:11], s90 offen offset:0 sc1
    buffer_load_dwordx4 a[180:183], v2, s[8:11], s90 offen offset:1024 sc1
    buffer_load_dwordx4 a[184:187], v2, s[8:11], s90 offen offset:2048 sc1
    buffer_load_dwordx4 a[188:191], v2, s[8:11], s90 offen offset:3072 sc1
    s_lshl_b32 s90, s92, 19
    s_lshl_b32 s91, s58, 13
    s_add_u32 s90, s90, s91
    s_cmp_eq_u32 s57, 0
    s_mov_b32 s91, 33570816
    s_cselect_b32 s91, 16809984, s91
    s_mov_b32 s42, 268435456
    s_cselect_b32 s42, 268435456, s42
    s_add_u32 s48, s90, s91
    s_mov_b32 s49, s48
    s_add_u32 s50, s48, 4096
    s_mov_b32 s51, s50
    s_mov_b32 s40, s6
    s_mov_b32 s41, s7
    s_lshl_b32 s90, s92, 19
    s_lshl_b32 s91, s58, 13
    s_add_u32 s90, s90, s91
    s_cmp_eq_u32 s57, 0
    s_mov_b32 s91, 33603584
    s_cselect_b32 s91, 16842752, s91
    s_mov_b32 s46, 268435456
    s_cselect_b32 s46, 268435456, s46
    s_add_u32 s52, s90, s91
    s_mov_b32 s53, s52
    s_add_u32 s54, s52, 4096
    s_mov_b32 s55, s54
    s_mov_b32 s44, s6
    s_mov_b32 s45, s7
    s_branch m_loop20
m_x57:
    s_mov_b32 s42, 0
    s_cmp_eq_u32 s65, 3
    s_cbranch_scc1 m_loop20
    s_mov_b32 s46, 0
    s_branch m_loop20
m_eps23:
    s_mov_b32 s92, s97
    s_mov_b32 s93, s97
    s_cmp_eq_u32 s97, 0
    s_cbranch_scc1 m_ns364
    s_mov_b32 s90, s98
    v_pk_mul_f32 v[32:33], v[32:33], s[92:93]
    v_pk_mul_f32 v[34:35], v[34:35], s[92:93]
    v_pk_mul_f32 v[36:37], v[36:37], s[92:93]
    v_pk_mul_f32 v[38:39], v[38:39], s[92:93]
    v_cvt_pk_bf16_f32 v32, v32, v33
    v_cvt_pk_bf16_f32 v33, v34, v35
    v_cvt_pk_bf16_f32 v34, v36, v37
    v_cvt_pk_bf16_f32 v35, v38, v39
    buffer_store_dwordx4 v[32:35], v2, s[8:11], s90 offen sc1
    s_add_u32 s90, s90, s100
    v_pk_mul_f32 v[40:41], v[40:41], s[92:93]
    v_pk_mul_f32 v[42:43], v[42:43], s[92:93]
    v_pk_mul_f32 v[44:45], v[44:45], s[92:93]
    v_pk_mul_f32 v[46:47], v[46:47], s[92:93]
    v_cvt_pk_bf16_f32 v40, v40, v41
    v_cvt_pk_bf16_f32 v41, v42, v43
    v_cvt_pk_bf16_f32 v42, v44, v45
    v_cvt_pk_bf16_f32 v43, v46, v47
    buffer_store_dwordx4 v[40:43], v2, s[8:11], s90 offen sc1
    s_add_u32 s90, s90, s100
    v_pk_mul_f32 v[48:49], v[48:49], s[92:93]
    v_pk_mul_f32 v[50:51], v[50:51], s[92:93]
    v_pk_mul_f32 v[52:53], v[52:53], s[92:93]
    v_pk_mul_f32 v[54:55], v[54:55], s[92:93]
    v_cvt_pk_bf16_f32 v48, v48, v49
    v_cvt_pk_bf16_f32 v49, v50, v51
    v_cvt_pk_bf16_f32 v50, v52, v53
    v_cvt_pk_bf16_f32 v51, v54, v55
    buffer_store_dwordx4 v[48:51], v2, s[8:11], s90 offen sc1
    s_add_u32 s90, s90, s100
    v_pk_mul_f32 v[56:57], v[56:57], s[92:93]
    v_pk_mul_f32 v[58:59], v[58:59], s[92:93]
    v_pk_mul_f32 v[60:61], v[60:61], s[92:93]
    v_pk_mul_f32 v[62:63], v[62:63], s[92:93]
    v_cvt_pk_bf16_f32 v56, v56, v57
    v_cvt_pk_bf16_f32 v57, v58, v59
    v_cvt_pk_bf16_f32 v58, v60, v61
    v_cvt_pk_bf16_f32 v59, v62, v63
    buffer_store_dwordx4 v[56:59], v2, s[8:11], s90 offen sc1
    s_add_u32 s90, s90, s100
    v_pk_mul_f32 v[64:65], v[64:65], s[92:93]
    v_pk_mul_f32 v[66:67], v[66:67], s[92:93]
    v_pk_mul_f32 v[68:69], v[68:69], s[92:93]
    v_pk_mul_f32 v[70:71], v[70:71], s[92:93]
    v_cvt_pk_bf16_f32 v64, v64, v65
    v_cvt_pk_bf16_f32 v65, v66, v67
    v_cvt_pk_bf16_f32 v66, v68, v69
    v_cvt_pk_bf16_f32 v67, v70, v71
    buffer_store_dwordx4 v[64:67], v2, s[8:11], s90 offen sc1
    s_add_u32 s90, s90, s100
    v_pk_mul_f32 v[72:73], v[72:73], s[92:93]
    v_pk_mul_f32 v[74:75], v[74:75], s[92:93]
    v_pk_mul_f32 v[76:77], v[76:77], s[92:93]
    v_pk_mul_f32 v[78:79], v[78:79], s[92:93]
    v_cvt_pk_bf16_f32 v72, v72, v73
    v_cvt_pk_bf16_f32 v73, v74, v75
    v_cvt_pk_bf16_f32 v74, v76, v77
    v_cvt_pk_bf16_f32 v75, v78, v79
    buffer_store_dwordx4 v[72:75], v2, s[8:11], s90 offen sc1
    s_add_u32 s90, s90, s100
    v_pk_mul_f32 v[80:81], v[80:81], s[92:93]
    v_pk_mul_f32 v[82:83], v[82:83], s[92:93]
    v_pk_mul_f32 v[84:85], v[84:85], s[92:93]
    v_pk_mul_f32 v[86:87], v[86:87], s[92:93]
    v_cvt_pk_bf16_f32 v80, v80, v81
    v_cvt_pk_bf16_f32 v81, v82, v83
    v_cvt_pk_bf16_f32 v82, v84, v85
    v_cvt_pk_bf16_f32 v83, v86, v87
    buffer_store_dwordx4 v[80:83], v2, s[8:11], s90 offen sc1
    s_add_u32 s90, s90, s100
    v_pk_mul_f32 v[88:89], v[88:89], s[92:93]
    v_pk_mul_f32 v[90:91], v[90:91], s[92:93]
    v_pk_mul_f32 v[92:93], v[92:93], s[92:93]
    v_pk_mul_f32 v[94:95], v[94:95], s[92:93]
    v_cvt_pk_bf16_f32 v88, v88, v89
    v_cvt_pk_bf16_f32 v89, v90, v91
    v_cvt_pk_bf16_f32 v90, v92, v93
    v_cvt_pk_bf16_f32 v91, v94, v95
    buffer_store_dwordx4 v[88:91], v2, s[8:11], s90 offen sc1
    s_add_u32 s90, s90, s100
    v_pk_mul_f32 v[96:97], v[96:97], s[92:93]
    v_pk_mul_f32 v[98:99], v[98:99], s[92:93]
    v_pk_mul_f32 v[100:101], v[100:101], s[92:93]
    v_pk_mul_f32 v[102:103], v[102:103], s[92:93]
    v_cvt_pk_bf16_f32 v96, v96, v97
    v_cvt_pk_bf16_f32 v97, v98, v99
    v_cvt_pk_bf16_f32 v98, v100, v101
    v_cvt_pk_bf16_f32 v99, v102, v103
    v_accvgpr_write_b32 a128, v96
    v_accvgpr_write_b32 a129, v97
    v_accvgpr_write_b32 a130, v98
    v_accvgpr_write_b32 a131, v99
    v_pk_mul_f32 v[104:105], v[104:105], s[92:93]
    v_pk_mul_f32 v[106:107], v[106:107], s[92:93]
    v_pk_mul_f32 v[108:109], v[108:109], s[92:93]
    v_pk_mul_f32 v[110:111], v[110:111], s[92:93]
    v_cvt_pk_bf16_f32 v104, v104, v105
    v_cvt_pk_bf16_f32 v105, v106, v107
    v_cvt_pk_bf16_f32 v106, v108, v109
    v_cvt_pk_bf16_f32 v107, v110, v111
    v_accvgpr_write_b32 a132, v104
    v_accvgpr_write_b32 a133, v105
    v_accvgpr_write_b32 a134, v106
    v_accvgpr_write_b32 a135, v107
    v_pk_mul_f32 v[112:113], v[112:113], s[92:93]
    v_pk_mul_f32 v[114:115], v[114:115], s[92:93]
    v_pk_mul_f32 v[116:117], v[116:117], s[92:93]
    v_pk_mul_f32 v[118:119], v[118:119], s[92:93]
    v_cvt_pk_bf16_f32 v112, v112, v113
    v_cvt_pk_bf16_f32 v113, v114, v115
    v_cvt_pk_bf16_f32 v114, v116, v117
    v_cvt_pk_bf16_f32 v115, v118, v119
    v_accvgpr_write_b32 a136, v112
    v_accvgpr_write_b32 a137, v113
    v_accvgpr_write_b32 a138, v114
    v_accvgpr_write_b32 a139, v115
    v_pk_mul_f32 v[120:121], v[120:121], s[92:93]
    v_pk_mul_f32 v[122:123], v[122:123], s[92:93]
    v_pk_mul_f32 v[124:125], v[124:125], s[92:93]
    v_pk_mul_f32 v[126:127], v[126:127], s[92:93]
    v_cvt_pk_bf16_f32 v120, v120, v121
    v_cvt_pk_bf16_f32 v121, v122, v123
    v_cvt_pk_bf16_f32 v122, v124, v125
    v_cvt_pk_bf16_f32 v123, v126, v127
    v_accvgpr_write_b32 a140, v120
    v_accvgpr_write_b32 a141, v121
    v_accvgpr_write_b32 a142, v122
    v_accvgpr_write_b32 a143, v123
    v_pk_mul_f32 v[128:129], v[128:129], s[92:93]
    v_pk_mul_f32 v[130:131], v[130:131], s[92:93]
    v_pk_mul_f32 v[132:133], v[132:133], s[92:93]
    v_pk_mul_f32 v[134:135], v[134:135], s[92:93]
    v_cvt_pk_bf16_f32 v128, v128, v129
    v_cvt_pk_bf16_f32 v129, v130, v131
    v_cvt_pk_bf16_f32 v130, v132, v133
    v_cvt_pk_bf16_f32 v131, v134, v135
    v_accvgpr_write_b32 a144, v128
    v_accvgpr_write_b32 a145, v129
    v_accvgpr_write_b32 a146, v130
    v_accvgpr_write_b32 a147, v131
    v_pk_mul_f32 v[136:137], v[136:137], s[92:93]
    v_pk_mul_f32 v[138:139], v[138:139], s[92:93]
    v_pk_mul_f32 v[140:141], v[140:141], s[92:93]
    v_pk_mul_f32 v[142:143], v[142:143], s[92:93]
    v_cvt_pk_bf16_f32 v136, v136, v137
    v_cvt_pk_bf16_f32 v137, v138, v139
    v_cvt_pk_bf16_f32 v138, v140, v141
    v_cvt_pk_bf16_f32 v139, v142, v143
    v_accvgpr_write_b32 a148, v136
    v_accvgpr_write_b32 a149, v137
    v_accvgpr_write_b32 a150, v138
    v_accvgpr_write_b32 a151, v139
    v_pk_mul_f32 v[144:145], v[144:145], s[92:93]
    v_pk_mul_f32 v[146:147], v[146:147], s[92:93]
    v_pk_mul_f32 v[148:149], v[148:149], s[92:93]
    v_pk_mul_f32 v[150:151], v[150:151], s[92:93]
    v_cvt_pk_bf16_f32 v144, v144, v145
    v_cvt_pk_bf16_f32 v145, v146, v147
    v_cvt_pk_bf16_f32 v146, v148, v149
    v_cvt_pk_bf16_f32 v147, v150, v151
    v_accvgpr_write_b32 a152, v144
    v_accvgpr_write_b32 a153, v145
    v_accvgpr_write_b32 a154, v146
    v_accvgpr_write_b32 a155, v147
    v_pk_mul_f32 v[152:153], v[152:153], s[92:93]
    v_pk_mul_f32 v[154:155], v[154:155], s[92:93]
    v_pk_mul_f32 v[156:157], v[156:157], s[92:93]
    v_pk_mul_f32 v[158:159], v[158:159], s[92:93]
    v_cvt_pk_bf16_f32 v152, v152, v153
    v_cvt_pk_bf16_f32 v153, v154, v155
    v_cvt_pk_bf16_f32 v154, v156, v157
    v_cvt_pk_bf16_f32 v155, v158, v159
    v_accvgpr_write_b32 a156, v152
    v_accvgpr_write_b32 a157, v153
    v_accvgpr_write_b32 a158, v154
    v_accvgpr_write_b32 a159, v155
    v_pk_mul_f32 v[160:161], v[160:161], s[92:93]
    v_pk_mul_f32 v[162:163], v[162:163], s[92:93]
    v_pk_mul_f32 v[164:165], v[164:165], s[92:93]
    v_pk_mul_f32 v[166:167], v[166:167], s[92:93]
    v_cvt_pk_bf16_f32 v160, v160, v161
    v_cvt_pk_bf16_f32 v161, v162, v163
    v_cvt_pk_bf16_f32 v162, v164, v165
    v_cvt_pk_bf16_f32 v163, v166, v167
    v_accvgpr_write_b32 a160, v160
    v_accvgpr_write_b32 a161, v161
    v_accvgpr_write_b32 a162, v162
    v_accvgpr_write_b32 a163, v163
    v_pk_mul_f32 v[168:169], v[168:169], s[92:93]
    v_pk_mul_f32 v[170:171], v[170:171], s[92:93]
    v_pk_mul_f32 v[172:173], v[172:173], s[92:93]
    v_pk_mul_f32 v[174:175], v[174:175], s[92:93]
    v_cvt_pk_bf16_f32 v168, v168, v169
    v_cvt_pk_bf16_f32 v169, v170, v171
    v_cvt_pk_bf16_f32 v170, v172, v173
    v_cvt_pk_bf16_f32 v171, v174, v175
    v_accvgpr_write_b32 a164, v168
    v_accvgpr_write_b32 a165, v169
    v_accvgpr_write_b32 a166, v170
    v_accvgpr_write_b32 a167, v171
    v_pk_mul_f32 v[176:177], v[176:177], s[92:93]
    v_pk_mul_f32 v[178:179], v[178:179], s[92:93]
    v_pk_mul_f32 v[180:181], v[180:181], s[92:93]
    v_pk_mul_f32 v[182:183], v[182:183], s[92:93]
    v_cvt_pk_bf16_f32 v176, v176, v177
    v_cvt_pk_bf16_f32 v177, v178, v179
    v_cvt_pk_bf16_f32 v178, v180, v181
    v_cvt_pk_bf16_f32 v179, v182, v183
    v_accvgpr_write_b32 a168, v176
    v_accvgpr_write_b32 a169, v177
    v_accvgpr_write_b32 a170, v178
    v_accvgpr_write_b32 a171, v179
    v_pk_mul_f32 v[184:185], v[184:185], s[92:93]
    v_pk_mul_f32 v[186:187], v[186:187], s[92:93]
    v_pk_mul_f32 v[188:189], v[188:189], s[92:93]
    v_pk_mul_f32 v[190:191], v[190:191], s[92:93]
    v_cvt_pk_bf16_f32 v184, v184, v185
    v_cvt_pk_bf16_f32 v185, v186, v187
    v_cvt_pk_bf16_f32 v186, v188, v189
    v_cvt_pk_bf16_f32 v187, v190, v191
    v_accvgpr_write_b32 a172, v184
    v_accvgpr_write_b32 a173, v185
    v_accvgpr_write_b32 a174, v186
    v_accvgpr_write_b32 a175, v187
    v_pk_mul_f32 v[192:193], v[192:193], s[92:93]
    v_pk_mul_f32 v[194:195], v[194:195], s[92:93]
    v_pk_mul_f32 v[196:197], v[196:197], s[92:93]
    v_pk_mul_f32 v[198:199], v[198:199], s[92:93]
    v_cvt_pk_bf16_f32 v192, v192, v193
    v_cvt_pk_bf16_f32 v193, v194, v195
    v_cvt_pk_bf16_f32 v194, v196, v197
    v_cvt_pk_bf16_f32 v195, v198, v199
    v_accvgpr_write_b32 a176, v192
    v_accvgpr_write_b32 a177, v193
    v_accvgpr_write_b32 a178, v194
    v_accvgpr_write_b32 a179, v195
    v_pk_mul_f32 v[200:201], v[200:201], s[92:93]
    v_pk_mul_f32 v[202:203], v[202:203], s[92:93]
    v_pk_mul_f32 v[204:205], v[204:205], s[92:93]
    v_pk_mul_f32 v[206:207], v[206:207], s[92:93]
    v_cvt_pk_bf16_f32 v200, v200, v201
    v_cvt_pk_bf16_f32 v201, v202, v203
    v_cvt_pk_bf16_f32 v202, v204, v205
    v_cvt_pk_bf16_f32 v203, v206, v207
    v_accvgpr_write_b32 a180, v200
    v_accvgpr_write_b32 a181, v201
    v_accvgpr_write_b32 a182, v202
    v_accvgpr_write_b32 a183, v203
    v_pk_mul_f32 v[208:209], v[208:209], s[92:93]
    v_pk_mul_f32 v[210:211], v[210:211], s[92:93]
    v_pk_mul_f32 v[212:213], v[212:213], s[92:93]
    v_pk_mul_f32 v[214:215], v[214:215], s[92:93]
    v_cvt_pk_bf16_f32 v208, v208, v209
    v_cvt_pk_bf16_f32 v209, v210, v211
    v_cvt_pk_bf16_f32 v210, v212, v213
    v_cvt_pk_bf16_f32 v211, v214, v215
    v_accvgpr_write_b32 a184, v208
    v_accvgpr_write_b32 a185, v209
    v_accvgpr_write_b32 a186, v210
    v_accvgpr_write_b32 a187, v211
    v_pk_mul_f32 v[216:217], v[216:217], s[92:93]
    v_pk_mul_f32 v[218:219], v[218:219], s[92:93]
    v_pk_mul_f32 v[220:221], v[220:221], s[92:93]
    v_pk_mul_f32 v[222:223], v[222:223], s[92:93]
    v_cvt_pk_bf16_f32 v216, v216, v217
    v_cvt_pk_bf16_f32 v217, v218, v219
    v_cvt_pk_bf16_f32 v218, v220, v221
    v_cvt_pk_bf16_f32 v219, v222, v223
    v_accvgpr_write_b32 a188, v216
    v_accvgpr_write_b32 a189, v217
    v_accvgpr_write_b32 a190, v218
    v_accvgpr_write_b32 a191, v219
    v_pk_mul_f32 v[224:225], v[224:225], s[92:93]
    v_pk_mul_f32 v[226:227], v[226:227], s[92:93]
    v_pk_mul_f32 v[228:229], v[228:229], s[92:93]
    v_pk_mul_f32 v[230:231], v[230:231], s[92:93]
    v_cvt_pk_bf16_f32 v224, v224, v225
    v_cvt_pk_bf16_f32 v225, v226, v227
    v_cvt_pk_bf16_f32 v226, v228, v229
    v_cvt_pk_bf16_f32 v227, v230, v231
    v_accvgpr_write_b32 a192, v224
    v_accvgpr_write_b32 a193, v225
    v_accvgpr_write_b32 a194, v226
    v_accvgpr_write_b32 a195, v227
    v_pk_mul_f32 v[232:233], v[232:233], s[92:93]
    v_pk_mul_f32 v[234:235], v[234:235], s[92:93]
    v_pk_mul_f32 v[236:237], v[236:237], s[92:93]
    v_pk_mul_f32 v[238:239], v[238:239], s[92:93]
    v_cvt_pk_bf16_f32 v232, v232, v233
    v_cvt_pk_bf16_f32 v233, v234, v235
    v_cvt_pk_bf16_f32 v234, v236, v237
    v_cvt_pk_bf16_f32 v235, v238, v239
    v_accvgpr_write_b32 a196, v232
    v_accvgpr_write_b32 a197, v233
    v_accvgpr_write_b32 a198, v234
    v_accvgpr_write_b32 a199, v235
    v_pk_mul_f32 v[240:241], v[240:241], s[92:93]
    v_pk_mul_f32 v[242:243], v[242:243], s[92:93]
    v_pk_mul_f32 v[244:245], v[244:245], s[92:93]
    v_pk_mul_f32 v[246:247], v[246:247], s[92:93]
    v_cvt_pk_bf16_f32 v240, v240, v241
    v_cvt_pk_bf16_f32 v241, v242, v243
    v_cvt_pk_bf16_f32 v242, v244, v245
    v_cvt_pk_bf16_f32 v243, v246, v247
    v_accvgpr_write_b32 a200, v240
    v_accvgpr_write_b32 a201, v241
    v_accvgpr_write_b32 a202, v242
    v_accvgpr_write_b32 a203, v243
    v_pk_mul_f32 v[248:249], v[248:249], s[92:93]
    v_pk_mul_f32 v[250:251], v[250:251], s[92:93]
    v_pk_mul_f32 v[252:253], v[252:253], s[92:93]
    v_pk_mul_f32 v[254:255], v[254:255], s[92:93]
    v_cvt_pk_bf16_f32 v248, v248, v249
    v_cvt_pk_bf16_f32 v249, v250, v251
    v_cvt_pk_bf16_f32 v250, v252, v253
    v_cvt_pk_bf16_f32 v251, v254, v255
    v_accvgpr_write_b32 a204, v248
    v_accvgpr_write_b32 a205, v249
    v_accvgpr_write_b32 a206, v250
    v_accvgpr_write_b32 a207, v251
    v_accvgpr_read_b32 v24, a224
    v_accvgpr_read_b32 v25, a225
    v_accvgpr_read_b32 v26, a226
    v_accvgpr_read_b32 v27, a227
    v_accvgpr_read_b32 v28, a228
    v_accvgpr_read_b32 v29, a229
    v_accvgpr_read_b32 v30, a230
    v_accvgpr_read_b32 v31, a231
    v_pk_mul_f32 v[24:25], v[24:25], s[92:93]
    v_pk_mul_f32 v[26:27], v[26:27], s[92:93]
    v_pk_mul_f32 v[28:29], v[28:29], s[92:93]
    v_pk_mul_f32 v[30:31], v[30:31], s[92:93]
    v_cvt_pk_bf16_f32 v24, v24, v25
    v_cvt_pk_bf16_f32 v25, v26, v27
    v_cvt_pk_bf16_f32 v26, v28, v29
    v_cvt_pk_bf16_f32 v27, v30, v31
    v_accvgpr_write_b32 a208, v24
    v_accvgpr_write_b32 a209, v25
    v_accvgpr_write_b32 a210, v26
    v_accvgpr_write_b32 a211, v27
    v_accvgpr_read_b32 v24, a232
    v_accvgpr_read_b32 v25, a233
    v_accvgpr_read_b32 v26, a234
    v_accvgpr_read_b32 v27, a235
    v_accvgpr_read_b32 v28, a236
    v_accvgpr_read_b32 v29, a237
    v_accvgpr_read_b32 v30, a238
    v_accvgpr_read_b32 v31, a239
    v_pk_mul_f32 v[24:25], v[24:25], s[92:93]
    v_pk_mul_f32 v[26:27], v[26:27], s[92:93]
    v_pk_mul_f32 v[28:29], v[28:29], s[92:93]
    v_pk_mul_f32 v[30:31], v[30:31], s[92:93]
    v_cvt_pk_bf16_f32 v24, v24, v25
    v_cvt_pk_bf16_f32 v25, v26, v27
    v_cvt_pk_bf16_f32 v26, v28, v29
    v_cvt_pk_bf16_f32 v27, v30, v31
    v_accvgpr_write_b32 a212, v24
    v_accvgpr_write_b32 a213, v25
    v_accvgpr_write_b32 a214, v26
    v_accvgpr_write_b32 a215, v27
    v_accvgpr_read_b32 v24, a240
    v_accvgpr_read_b32 v25, a241
    v_accvgpr_read_b32 v26, a242
    v_accvgpr_read_b32 v27, a243
    v_accvgpr_read_b32 v28, a244
    v_accvgpr_read_b32 v29, a245
    v_accvgpr_read_b32 v30, a246
    v_accvgpr_read_b32 v31, a247
    v_pk_mul_f32 v[24:25], v[24:25], s[92:93]
    v_pk_mul_f32 v[26:27], v[26:27], s[92:93]
    v_pk_mul_f32 v[28:29], v[28:29], s[92:93]
    v_pk_mul_f32 v[30:31], v[30:31], s[92:93]
    v_cvt_pk_bf16_f32 v24, v24, v25
    v_cvt_pk_bf16_f32 v25, v26, v27
    v_cvt_pk_bf16_f32 v26, v28, v29
    v_cvt_pk_bf16_f32 v27, v30, v31
    v_accvgpr_write_b32 a216, v24
    v_accvgpr_write_b32 a217, v25
    v_accvgpr_write_b32 a218, v26
    v_accvgpr_write_b32 a219, v27
    v_accvgpr_read_b32 v24, a248
    v_accvgpr_read_b32 v25, a249
    v_accvgpr_read_b32 v26, a250
    v_accvgpr_read_b32 v27, a251
    v_accvgpr_read_b32 v28, a252
    v_accvgpr_read_b32 v29, a253
    v_accvgpr_read_b32 v30, a254
    v_accvgpr_read_b32 v31, a255
    v_pk_mul_f32 v[24:25], v[24:25], s[92:93]
    v_pk_mul_f32 v[26:27], v[26:27], s[92:93]
    v_pk_mul_f32 v[28:29], v[28:29], s[92:93]
    v_pk_mul_f32 v[30:31], v[30:31], s[92:93]
    v_cvt_pk_bf16_f32 v24, v24, v25
    v_cvt_pk_bf16_f32 v25, v26, v27
    v_cvt_pk_bf16_f32 v26, v28, v29
    v_cvt_pk_bf16_f32 v27, v30, v31
    v_accvgpr_write_b32 a220, v24
    v_accvgpr_write_b32 a221, v25
    v_accvgpr_write_b32 a222, v26
    v_accvgpr_write_b32 a223, v27
    s_setpc_b64 s[20:21]
m_ns364:
    s_mov_b32 s90, s98
    v_cvt_pk_bf16_f32 v32, v32, v33
    v_cvt_pk_bf16_f32 v33, v34, v35
    v_cvt_pk_bf16_f32 v34, v36, v37
    v_cvt_pk_bf16_f32 v35, v38, v39
    buffer_store_dwordx4 v[32:35], v2, s[8:11], s90 offen sc1
    s_add_u32 s90, s90, s100
    v_cvt_pk_bf16_f32 v40, v40, v41
    v_cvt_pk_bf16_f32 v41, v42, v43
    v_cvt_pk_bf16_f32 v42, v44, v45
    v_cvt_pk_bf16_f32 v43, v46, v47
    buffer_store_dwordx4 v[40:43], v2, s[8:11], s90 offen sc1
    s_add_u32 s90, s90, s100
    v_cvt_pk_bf16_f32 v48, v48, v49
    v_cvt_pk_bf16_f32 v49, v50, v51
    v_cvt_pk_bf16_f32 v50, v52, v53
    v_cvt_pk_bf16_f32 v51, v54, v55
    buffer_store_dwordx4 v[48:51], v2, s[8:11], s90 offen sc1
    s_add_u32 s90, s90, s100
    v_cvt_pk_bf16_f32 v56, v56, v57
    v_cvt_pk_bf16_f32 v57, v58, v59
    v_cvt_pk_bf16_f32 v58, v60, v61
    v_cvt_pk_bf16_f32 v59, v62, v63
    buffer_store_dwordx4 v[56:59], v2, s[8:11], s90 offen sc1
    s_add_u32 s90, s90, s100
    v_cvt_pk_bf16_f32 v64, v64, v65
    v_cvt_pk_bf16_f32 v65, v66, v67
    v_cvt_pk_bf16_f32 v66, v68, v69
    v_cvt_pk_bf16_f32 v67, v70, v71
    buffer_store_dwordx4 v[64:67], v2, s[8:11], s90 offen sc1
    s_add_u32 s90, s90, s100
    v_cvt_pk_bf16_f32 v72, v72, v73
    v_cvt_pk_bf16_f32 v73, v74, v75
    v_cvt_pk_bf16_f32 v74, v76, v77
    v_cvt_pk_bf16_f32 v75, v78, v79
    buffer_store_dwordx4 v[72:75], v2, s[8:11], s90 offen sc1
    s_add_u32 s90, s90, s100
    v_cvt_pk_bf16_f32 v80, v80, v81
    v_cvt_pk_bf16_f32 v81, v82, v83
    v_cvt_pk_bf16_f32 v82, v84, v85
    v_cvt_pk_bf16_f32 v83, v86, v87
    buffer_store_dwordx4 v[80:83], v2, s[8:11], s90 offen sc1
    s_add_u32 s90, s90, s100
    v_cvt_pk_bf16_f32 v88, v88, v89
    v_cvt_pk_bf16_f32 v89, v90, v91
    v_cvt_pk_bf16_f32 v90, v92, v93
    v_cvt_pk_bf16_f32 v91, v94, v95
    buffer_store_dwordx4 v[88:91], v2, s[8:11], s90 offen sc1
    s_add_u32 s90, s90, s100
    v_cvt_pk_bf16_f32 v96, v96, v97
    v_cvt_pk_bf16_f32 v97, v98, v99
    v_cvt_pk_bf16_f32 v98, v100, v101
    v_cvt_pk_bf16_f32 v99, v102, v103
    v_accvgpr_write_b32 a128, v96
    v_accvgpr_write_b32 a129, v97
    v_accvgpr_write_b32 a130, v98
    v_accvgpr_write_b32 a131, v99
    v_cvt_pk_bf16_f32 v104, v104, v105
    v_cvt_pk_bf16_f32 v105, v106, v107
    v_cvt_pk_bf16_f32 v106, v108, v109
    v_cvt_pk_bf16_f32 v107, v110, v111
    v_accvgpr_write_b32 a132, v104
    v_accvgpr_write_b32 a133, v105
    v_accvgpr_write_b32 a134, v106
    v_accvgpr_write_b32 a135, v107
    v_cvt_pk_bf16_f32 v112, v112, v113
    v_cvt_pk_bf16_f32 v113, v114, v115
    v_cvt_pk_bf16_f32 v114, v116, v117
    v_cvt_pk_bf16_f32 v115, v118, v119
    v_accvgpr_write_b32 a136, v112
    v_accvgpr_write_b32 a137, v113
    v_accvgpr_write_b32 a138, v114
    v_accvgpr_write_b32 a139, v115
    v_cvt_pk_bf16_f32 v120, v120, v121
    v_cvt_pk_bf16_f32 v121, v122, v123
    v_cvt_pk_bf16_f32 v122, v124, v125
    v_cvt_pk_bf16_f32 v123, v126, v127
    v_accvgpr_write_b32 a140, v120
    v_accvgpr_write_b32 a141, v121
    v_accvgpr_write_b32 a142, v122
    v_accvgpr_write_b32 a143, v123
    v_cvt_pk_bf16_f32 v128, v128, v129
    v_cvt_pk_bf16_f32 v129, v130, v131
    v_cvt_pk_bf16_f32 v130, v132, v133
    v_cvt_pk_bf16_f32 v131, v134, v135
    v_accvgpr_write_b32 a144, v128
    v_accvgpr_write_b32 a145, v129
    v_accvgpr_write_b32 a146, v130
    v_accvgpr_write_b32 a147, v131
    v_cvt_pk_bf16_f32 v136, v136, v137
    v_cvt_pk_bf16_f32 v137, v138, v139
    v_cvt_pk_bf16_f32 v138, v140, v141
    v_cvt_pk_bf16_f32 v139, v142, v143
    v_accvgpr_write_b32 a148, v136
    v_accvgpr_write_b32 a149, v137
    v_accvgpr_write_b32 a150, v138
    v_accvgpr_write_b32 a151, v139
    v_cvt_pk_bf16_f32 v144, v144, v145
    v_cvt_pk_bf16_f32 v145, v146, v147
    v_cvt_pk_bf16_f32 v146, v148, v149
    v_cvt_pk_bf16_f32 v147, v150, v151
    v_accvgpr_write_b32 a152, v144
    v_accvgpr_write_b32 a153, v145
    v_accvgpr_write_b32 a154, v146
    v_accvgpr_write_b32 a155, v147
    v_cvt_pk_bf16_f32 v152, v152, v153
    v_cvt_pk_bf16_f32 v153, v154, v155
    v_cvt_pk_bf16_f32 v154, v156, v157
    v_cvt_pk_bf16_f32 v155, v158, v159
    v_accvgpr_write_b32 a156, v152
    v_accvgpr_write_b32 a157, v153
    v_accvgpr_write_b32 a158, v154
    v_accvgpr_write_b32 a159, v155
    v_cvt_pk_bf16_f32 v160, v160, v161
    v_cvt_pk_bf16_f32 v161, v162, v163
    v_cvt_pk_bf16_f32 v162, v164, v165
    v_cvt_pk_bf16_f32 v163, v166, v167
    v_accvgpr_write_b32 a160, v160
    v_accvgpr_write_b32 a161, v161
    v_accvgpr_write_b32 a162, v162
    v_accvgpr_write_b32 a163, v163
    v_cvt_pk_bf16_f32 v168, v168, v169
    v_cvt_pk_bf16_f32 v169, v170, v171
    v_cvt_pk_bf16_f32 v170, v172, v173
    v_cvt_pk_bf16_f32 v171, v174, v175
    v_accvgpr_write_b32 a164, v168
    v_accvgpr_write_b32 a165, v169
    v_accvgpr_write_b32 a166, v170
    v_accvgpr_write_b32 a167, v171
    v_cvt_pk_bf16_f32 v176, v176, v177
    v_cvt_pk_bf16_f32 v177, v178, v179
    v_cvt_pk_bf16_f32 v178, v180, v181
    v_cvt_pk_bf16_f32 v179, v182, v183
    v_accvgpr_write_b32 a168, v176
    v_accvgpr_write_b32 a169, v177
    v_accvgpr_write_b32 a170, v178
    v_accvgpr_write_b32 a171, v179
    v_cvt_pk_bf16_f32 v184, v184, v185
    v_cvt_pk_bf16_f32 v185, v186, v187
    v_cvt_pk_bf16_f32 v186, v188, v189
    v_cvt_pk_bf16_f32 v187, v190, v191
    v_accvgpr_write_b32 a172, v184
    v_accvgpr_write_b32 a173, v185
    v_accvgpr_write_b32 a174, v186
    v_accvgpr_write_b32 a175, v187
    v_cvt_pk_bf16_f32 v192, v192, v193
    v_cvt_pk_bf16_f32 v193, v194, v195
    v_cvt_pk_bf16_f32 v194, v196, v197
    v_cvt_pk_bf16_f32 v195, v198, v199
    v_accvgpr_write_b32 a176, v192
    v_accvgpr_write_b32 a177, v193
    v_accvgpr_write_b32 a178, v194
    v_accvgpr_write_b32 a179, v195
    v_cvt_pk_bf16_f32 v200, v200, v201
    v_cvt_pk_bf16_f32 v201, v202, v203
    v_cvt_pk_bf16_f32 v202, v204, v205
    v_cvt_pk_bf16_f32 v203, v206, v207
    v_accvgpr_write_b32 a180, v200
    v_accvgpr_write_b32 a181, v201
    v_accvgpr_write_b32 a182, v202
    v_accvgpr_write_b32 a183, v203
    v_cvt_pk_bf16_f32 v208, v208, v209
    v_cvt_pk_bf16_f32 v209, v210, v211
    v_cvt_pk_bf16_f32 v210, v212, v213
    v_cvt_pk_bf16_f32 v211, v214, v215
    v_accvgpr_write_b32 a184, v208
    v_accvgpr_write_b32 a185, v209
    v_accvgpr_write_b32 a186, v210
    v_accvgpr_write_b32 a187, v211
    v_cvt_pk_bf16_f32 v216, v216, v217
    v_cvt_pk_bf16_f32 v217, v218, v219
    v_cvt_pk_bf16_f32 v218, v220, v221
    v_cvt_pk_bf16_f32 v219, v222, v223
    v_accvgpr_write_b32 a188, v216
    v_accvgpr_write_b32 a189, v217
    v_accvgpr_write_b32 a190, v218
    v_accvgpr_write_b32 a191, v219
    v_cvt_pk_bf16_f32 v224, v224, v225
    v_cvt_pk_bf16_f32 v225, v226, v227
    v_cvt_pk_bf16_f32 v226, v228, v229
    v_cvt_pk_bf16_f32 v227, v230, v231
    v_accvgpr_write_b32 a192, v224
    v_accvgpr_write_b32 a193, v225
    v_accvgpr_write_b32 a194, v226
    v_accvgpr_write_b32 a195, v227
    v_cvt_pk_bf16_f32 v232, v232, v233
    v_cvt_pk_bf16_f32 v233, v234, v235
    v_cvt_pk_bf16_f32 v234, v236, v237
    v_cvt_pk_bf16_f32 v235, v238, v239
    v_accvgpr_write_b32 a196, v232
    v_accvgpr_write_b32 a197, v233
    v_accvgpr_write_b32 a198, v234
    v_accvgpr_write_b32 a199, v235
    v_cvt_pk_bf16_f32 v240, v240, v241
    v_cvt_pk_bf16_f32 v241, v242, v243
    v_cvt_pk_bf16_f32 v242, v244, v245
    v_cvt_pk_bf16_f32 v243, v246, v247
    v_accvgpr_write_b32 a200, v240
    v_accvgpr_write_b32 a201, v241
    v_accvgpr_write_b32 a202, v242
    v_accvgpr_write_b32 a203, v243
    v_cvt_pk_bf16_f32 v248, v248, v249
    v_cvt_pk_bf16_f32 v249, v250, v251
    v_cvt_pk_bf16_f32 v250, v252, v253
    v_cvt_pk_bf16_f32 v251, v254, v255
    v_accvgpr_write_b32 a204, v248
    v_accvgpr_write_b32 a205, v249
    v_accvgpr_write_b32 a206, v250
    v_accvgpr_write_b32 a207, v251
    v_accvgpr_read_b32 v24, a224
    v_accvgpr_read_b32 v25, a225
    v_accvgpr_read_b32 v26, a226
    v_accvgpr_read_b32 v27, a227
    v_accvgpr_read_b32 v28, a228
    v_accvgpr_read_b32 v29, a229
    v_accvgpr_read_b32 v30, a230
    v_accvgpr_read_b32 v31, a231
    v_cvt_pk_bf16_f32 v24, v24, v25
    v_cvt_pk_bf16_f32 v25, v26, v27
    v_cvt_pk_bf16_f32 v26, v28, v29
    v_cvt_pk_bf16_f32 v27, v30, v31
    v_accvgpr_write_b32 a208, v24
    v_accvgpr_write_b32 a209, v25
    v_accvgpr_write_b32 a210, v26
    v_accvgpr_write_b32 a211, v27
    v_accvgpr_read_b32 v24, a232
    v_accvgpr_read_b32 v25, a233
    v_accvgpr_read_b32 v26, a234
    v_accvgpr_read_b32 v27, a235
    v_accvgpr_read_b32 v28, a236
    v_accvgpr_read_b32 v29, a237
    v_accvgpr_read_b32 v30, a238
    v_accvgpr_read_b32 v31, a239
    v_cvt_pk_bf16_f32 v24, v24, v25
    v_cvt_pk_bf16_f32 v25, v26, v27
    v_cvt_pk_bf16_f32 v26, v28, v29
    v_cvt_pk_bf16_f32 v27, v30, v31
    v_accvgpr_write_b32 a212, v24
    v_accvgpr_write_b32 a213, v25
    v_accvgpr_write_b32 a214, v26
    v_accvgpr_write_b32 a215, v27
    v_accvgpr_read_b32 v24, a240
    v_accvgpr_read_b32 v25, a241
    v_accvgpr_read_b32 v26, a242
    v_accvgpr_read_b32 v27, a243
    v_accvgpr_read_b32 v28, a244
    v_accvgpr_read_b32 v29, a245
    v_accvgpr_read_b32 v30, a246
    v_accvgpr_read_b32 v31, a247
    v_cvt_pk_bf16_f32 v24, v24, v25
    v_cvt_pk_bf16_f32 v25, v26, v27
    v_cvt_pk_bf16_f32 v26, v28, v29
    v_cvt_pk_bf16_f32 v27, v30, v31
    v_accvgpr_write_b32 a216, v24
    v_accvgpr_write_b32 a217, v25
    v_accvgpr_write_b32 a218, v26
    v_accvgpr_write_b32 a219, v27
    v_accvgpr_read_b32 v24, a248
    v_accvgpr_read_b32 v25, a249
    v_accvgpr_read_b32 v26, a250
    v_accvgpr_read_b32 v27, a251
    v_accvgpr_read_b32 v28, a252
    v_accvgpr_read_b32 v29, a253
    v_accvgpr_read_b32 v30, a254
    v_accvgpr_read_b32 v31, a255
    v_cvt_pk_bf16_f32 v24, v24, v25
    v_cvt_pk_bf16_f32 v25, v26, v27
    v_cvt_pk_bf16_f32 v26, v28, v29
    v_cvt_pk_bf16_f32 v27, v30, v31
    v_accvgpr_write_b32 a220, v24
    v_accvgpr_write_b32 a221, v25
    v_accvgpr_write_b32 a222, v26
    v_accvgpr_write_b32 a223, v27
    s_setpc_b64 s[20:21]
m_epf22:
    s_nop 7
    s_cmp_eq_u32 s97, 0
    s_cbranch_scc1 m_noscale65
    s_mov_b32 s91, s98
    s_mov_b32 s92, s97
    s_mov_b32 s93, s97
    s_mov_b32 s90, s91
    v_pk_mul_f32 v[32:33], v[32:33], s[92:93]
    v_pk_mul_f32 v[34:35], v[34:35], s[92:93]
    v_pk_mul_f32 v[36:37], v[36:37], s[92:93]
    v_pk_mul_f32 v[38:39], v[38:39], s[92:93]
    v_cvt_pk_bf16_f32 v32, v32, v33
    v_cvt_pk_bf16_f32 v33, v34, v35
    v_cvt_pk_bf16_f32 v34, v36, v37
    v_cvt_pk_bf16_f32 v35, v38, v39
    buffer_store_dwordx4 v[32:35], v2, s[8:11], s90 offen sc1
    s_add_u32 s90, s90, s100
    v_pk_mul_f32 v[40:41], v[40:41], s[92:93]
    v_pk_mul_f32 v[42:43], v[42:43], s[92:93]
    v_pk_mul_f32 v[44:45], v[44:45], s[92:93]
    v_pk_mul_f32 v[46:47], v[46:47], s[92:93]
    v_cvt_pk_bf16_f32 v40, v40, v41
    v_cvt_pk_bf16_f32 v41, v42, v43
    v_cvt_pk_bf16_f32 v42, v44, v45
    v_cvt_pk_bf16_f32 v43, v46, v47
    buffer_store_dwordx4 v[40:43], v2, s[8:11], s90 offen sc1
    s_add_u32 s90, s90, s100
    v_pk_mul_f32 v[48:49], v[48:49], s[92:93]
    v_pk_mul_f32 v[50:51], v[50:51], s[92:93]
    v_pk_mul_f32 v[52:53], v[52:53], s[92:93]
    v_pk_mul_f32 v[54:55], v[54:55], s[92:93]
    v_cvt_pk_bf16_f32 v48, v48, v49
    v_cvt_pk_bf16_f32 v49, v50, v51
    v_cvt_pk_bf16_f32 v50, v52, v53
    v_cvt_pk_bf16_f32 v51, v54, v55
    buffer_store_dwordx4 v[48:51], v2, s[8:11], s90 offen sc1
    s_add_u32 s90, s90, s100
    v_pk_mul_f32 v[56:57], v[56:57], s[92:93]
    v_pk_mul_f32 v[58:59], v[58:59], s[92:93]
    v_pk_mul_f32 v[60:61], v[60:61], s[92:93]
    v_pk_mul_f32 v[62:63], v[62:63], s[92:93]
    v_cvt_pk_bf16_f32 v56, v56, v57
    v_cvt_pk_bf16_f32 v57, v58, v59
    v_cvt_pk_bf16_f32 v58, v60, v61
    v_cvt_pk_bf16_f32 v59, v62, v63
    buffer_store_dwordx4 v[56:59], v2, s[8:11], s90 offen sc1
    s_add_u32 s90, s90, s100
    v_pk_mul_f32 v[64:65], v[64:65], s[92:93]
    v_pk_mul_f32 v[66:67], v[66:67], s[92:93]
    v_pk_mul_f32 v[68:69], v[68:69], s[92:93]
    v_pk_mul_f32 v[70:71], v[70:71], s[92:93]
    v_cvt_pk_bf16_f32 v64, v64, v65
    v_cvt_pk_bf16_f32 v65, v66, v67
    v_cvt_pk_bf16_f32 v66, v68, v69
    v_cvt_pk_bf16_f32 v67, v70, v71
    buffer_store_dwordx4 v[64:67], v2, s[8:11], s90 offen sc1
    s_add_u32 s90, s90, s100
    v_pk_mul_f32 v[72:73], v[72:73], s[92:93]
    v_pk_mul_f32 v[74:75], v[74:75], s[92:93]
    v_pk_mul_f32 v[76:77], v[76:77], s[92:93]
    v_pk_mul_f32 v[78:79], v[78:79], s[92:93]
    v_cvt_pk_bf16_f32 v72, v72, v73
    v_cvt_pk_bf16_f32 v73, v74, v75
    v_cvt_pk_bf16_f32 v74, v76, v77
    v_cvt_pk_bf16_f32 v75, v78, v79
    buffer_store_dwordx4 v[72:75], v2, s[8:11], s90 offen sc1
    s_add_u32 s90, s90, s100
    v_pk_mul_f32 v[80:81], v[80:81], s[92:93]
    v_pk_mul_f32 v[82:83], v[82:83], s[92:93]
    v_pk_mul_f32 v[84:85], v[84:85], s[92:93]
    v_pk_mul_f32 v[86:87], v[86:87], s[92:93]
    v_cvt_pk_bf16_f32 v80, v80, v81
    v_cvt_pk_bf16_f32 v81, v82, v83
    v_cvt_pk_bf16_f32 v82, v84, v85
    v_cvt_pk_bf16_f32 v83, v86, v87
    buffer_store_dwordx4 v[80:83], v2, s[8:11], s90 offen sc1
    s_add_u32 s90, s90, s100
    v_pk_mul_f32 v[88:89], v[88:89], s[92:93]
    v_pk_mul_f32 v[90:91], v[90:91], s[92:93]
    v_pk_mul_f32 v[92:93], v[92:93], s[92:93]
    v_pk_mul_f32 v[94:95], v[94:95], s[92:93]
    v_cvt_pk_bf16_f32 v88, v88, v89
    v_cvt_pk_bf16_f32 v89, v90, v91
    v_cvt_pk_bf16_f32 v90, v92, v93
    v_cvt_pk_bf16_f32 v91, v94, v95
    buffer_store_dwordx4 v[88:91], v2, s[8:11], s90 offen sc1
    s_add_u32 s90, s90, s100
    s_add_u32 s91, s91, s99
    s_mov_b32 s90, s91
    v_pk_mul_f32 v[96:97], v[96:97], s[92:93]
    v_pk_mul_f32 v[98:99], v[98:99], s[92:93]
    v_pk_mul_f32 v[100:101], v[100:101], s[92:93]
    v_pk_mul_f32 v[102:103], v[102:103], s[92:93]
    v_cvt_pk_bf16_f32 v96, v96, v97
    v_cvt_pk_bf16_f32 v97, v98, v99
    v_cvt_pk_bf16_f32 v98, v100, v101
    v_cvt_pk_bf16_f32 v99, v102, v103
    buffer_store_dwordx4 v[96:99], v2, s[8:11], s90 offen sc1
    s_add_u32 s90, s90, s100
    v_pk_mul_f32 v[104:105], v[104:105], s[92:93]
    v_pk_mul_f32 v[106:107], v[106:107], s[92:93]
    v_pk_mul_f32 v[108:109], v[108:109], s[92:93]
    v_pk_mul_f32 v[110:111], v[110:111], s[92:93]
    v_cvt_pk_bf16_f32 v104, v104, v105
    v_cvt_pk_bf16_f32 v105, v106, v107
    v_cvt_pk_bf16_f32 v106, v108, v109
    v_cvt_pk_bf16_f32 v107, v110, v111
    buffer_store_dwordx4 v[104:107], v2, s[8:11], s90 offen sc1
    s_add_u32 s90, s90, s100
    v_pk_mul_f32 v[112:113], v[112:113], s[92:93]
    v_pk_mul_f32 v[114:115], v[114:115], s[92:93]
    v_pk_mul_f32 v[116:117], v[116:117], s[92:93]
    v_pk_mul_f32 v[118:119], v[118:119], s[92:93]
    v_cvt_pk_bf16_f32 v112, v112, v113
    v_cvt_pk_bf16_f32 v113, v114, v115
    v_cvt_pk_bf16_f32 v114, v116, v117
    v_cvt_pk_bf16_f32 v115, v118, v119
    buffer_store_dwordx4 v[112:115], v2, s[8:11], s90 offen sc1
    s_add_u32 s90, s90, s100
    v_pk_mul_f32 v[120:121], v[120:121], s[92:93]
    v_pk_mul_f32 v[122:123], v[122:123], s[92:93]
    v_pk_mul_f32 v[124:125], v[124:125], s[92:93]
    v_pk_mul_f32 v[126:127], v[126:127], s[92:93]
    v_cvt_pk_bf16_f32 v120, v120, v121
    v_cvt_pk_bf16_f32 v121, v122, v123
    v_cvt_pk_bf16_f32 v122, v124, v125
    v_cvt_pk_bf16_f32 v123, v126, v127
    buffer_store_dwordx4 v[120:123], v2, s[8:11], s90 offen sc1
    s_add_u32 s90, s90, s100
    v_pk_mul_f32 v[128:129], v[128:129], s[92:93]
    v_pk_mul_f32 v[130:131], v[130:131], s[92:93]
    v_pk_mul_f32 v[132:133], v[132:133], s[92:93]
    v_pk_mul_f32 v[134:135], v[134:135], s[92:93]
    v_cvt_pk_bf16_f32 v128, v128, v129
    v_cvt_pk_bf16_f32 v129, v130, v131
    v_cvt_pk_bf16_f32 v130, v132, v133
    v_cvt_pk_bf16_f32 v131, v134, v135
    buffer_store_dwordx4 v[128:131], v2, s[8:11], s90 offen sc1
    s_add_u32 s90, s90, s100
    v_pk_mul_f32 v[136:137], v[136:137], s[92:93]
    v_pk_mul_f32 v[138:139], v[138:139], s[92:93]
    v_pk_mul_f32 v[140:141], v[140:141], s[92:93]
    v_pk_mul_f32 v[142:143], v[142:143], s[92:93]
    v_cvt_pk_bf16_f32 v136, v136, v137
    v_cvt_pk_bf16_f32 v137, v138, v139
    v_cvt_pk_bf16_f32 v138, v140, v141
    v_cvt_pk_bf16_f32 v139, v142, v143
    buffer_store_dwordx4 v[136:139], v2, s[8:11], s90 offen sc1
    s_add_u32 s90, s90, s100
    v_pk_mul_f32 v[144:145], v[144:145], s[92:93]
    v_pk_mul_f32 v[146:147], v[146:147], s[92:93]
    v_pk_mul_f32 v[148:149], v[148:149], s[92:93]
    v_pk_mul_f32 v[150:151], v[150:151], s[92:93]
    v_cvt_pk_bf16_f32 v144, v144, v145
    v_cvt_pk_bf16_f32 v145, v146, v147
    v_cvt_pk_bf16_f32 v146, v148, v149
    v_cvt_pk_bf16_f32 v147, v150, v151
    buffer_store_dwordx4 v[144:147], v2, s[8:11], s90 offen sc1
    s_add_u32 s90, s90, s100
    v_pk_mul_f32 v[152:153], v[152:153], s[92:93]
    v_pk_mul_f32 v[154:155], v[154:155], s[92:93]
    v_pk_mul_f32 v[156:157], v[156:157], s[92:93]
    v_pk_mul_f32 v[158:159], v[158:159], s[92:93]
    v_cvt_pk_bf16_f32 v152, v152, v153
    v_cvt_pk_bf16_f32 v153, v154, v155
    v_cvt_pk_bf16_f32 v154, v156, v157
    v_cvt_pk_bf16_f32 v155, v158, v159
    buffer_store_dwordx4 v[152:155], v2, s[8:11], s90 offen sc1
    s_add_u32 s90, s90, s100
    s_add_u32 s91, s91, s99
    s_mov_b32 s90, s91
    v_pk_mul_f32 v[160:161], v[160:161], s[92:93]
    v_pk_mul_f32 v[162:163], v[162:163], s[92:93]
    v_pk_mul_f32 v[164:165], v[164:165], s[92:93]
    v_pk_mul_f32 v[166:167], v[166:167], s[92:93]
    v_cvt_pk_bf16_f32 v160, v160, v161
    v_cvt_pk_bf16_f32 v161, v162, v163
    v_cvt_pk_bf16_f32 v162, v164, v165
    v_cvt_pk_bf16_f32 v163, v166, v167
    buffer_store_dwordx4 v[160:163], v2, s[8:11], s90 offen sc1
    s_add_u32 s90, s90, s100
    v_pk_mul_f32 v[168:169], v[168:169], s[92:93]
    v_pk_mul_f32 v[170:171], v[170:171], s[92:93]
    v_pk_mul_f32 v[172:173], v[172:173], s[92:93]
    v_pk_mul_f32 v[174:175], v[174:175], s[92:93]
    v_cvt_pk_bf16_f32 v168, v168, v169
    v_cvt_pk_bf16_f32 v169, v170, v171
    v_cvt_pk_bf16_f32 v170, v172, v173
    v_cvt_pk_bf16_f32 v171, v174, v175
    buffer_store_dwordx4 v[168:171], v2, s[8:11], s90 offen sc1
    s_add_u32 s90, s90, s100
    v_pk_mul_f32 v[176:177], v[176:177], s[92:93]
    v_pk_mul_f32 v[178:179], v[178:179], s[92:93]
    v_pk_mul_f32 v[180:181], v[180:181], s[92:93]
    v_pk_mul_f32 v[182:183], v[182:183], s[92:93]
    v_cvt_pk_bf16_f32 v176, v176, v177
    v_cvt_pk_bf16_f32 v177, v178, v179
    v_cvt_pk_bf16_f32 v178, v180, v181
    v_cvt_pk_bf16_f32 v179, v182, v183
    buffer_store_dwordx4 v[176:179], v2, s[8:11], s90 offen sc1
    s_add_u32 s90, s90, s100
    v_pk_mul_f32 v[184:185], v[184:185], s[92:93]
    v_pk_mul_f32 v[186:187], v[186:187], s[92:93]
    v_pk_mul_f32 v[188:189], v[188:189], s[92:93]
    v_pk_mul_f32 v[190:191], v[190:191], s[92:93]
    v_cvt_pk_bf16_f32 v184, v184, v185
    v_cvt_pk_bf16_f32 v185, v186, v187
    v_cvt_pk_bf16_f32 v186, v188, v189
    v_cvt_pk_bf16_f32 v187, v190, v191
    buffer_store_dwordx4 v[184:187], v2, s[8:11], s90 offen sc1
    s_add_u32 s90, s90, s100
    v_pk_mul_f32 v[192:193], v[192:193], s[92:93]
    v_pk_mul_f32 v[194:195], v[194:195], s[92:93]
    v_pk_mul_f32 v[196:197], v[196:197], s[92:93]
    v_pk_mul_f32 v[198:199], v[198:199], s[92:93]
    v_cvt_pk_bf16_f32 v192, v192, v193
    v_cvt_pk_bf16_f32 v193, v194, v195
    v_cvt_pk_bf16_f32 v194, v196, v197
    v_cvt_pk_bf16_f32 v195, v198, v199
    buffer_store_dwordx4 v[192:195], v2, s[8:11], s90 offen sc1
    s_add_u32 s90, s90, s100
    v_pk_mul_f32 v[200:201], v[200:201], s[92:93]
    v_pk_mul_f32 v[202:203], v[202:203], s[92:93]
    v_pk_mul_f32 v[204:205], v[204:205], s[92:93]
    v_pk_mul_f32 v[206:207], v[206:207], s[92:93]
    v_cvt_pk_bf16_f32 v200, v200, v201
    v_cvt_pk_bf16_f32 v201, v202, v203
    v_cvt_pk_bf16_f32 v202, v204, v205
    v_cvt_pk_bf16_f32 v203, v206, v207
    buffer_store_dwordx4 v[200:203], v2, s[8:11], s90 offen sc1
    s_add_u32 s90, s90, s100
    v_pk_mul_f32 v[208:209], v[208:209], s[92:93]
    v_pk_mul_f32 v[210:211], v[210:211], s[92:93]
    v_pk_mul_f32 v[212:213], v[212:213], s[92:93]
    v_pk_mul_f32 v[214:215], v[214:215], s[92:93]
    v_cvt_pk_bf16_f32 v208, v208, v209
    v_cvt_pk_bf16_f32 v209, v210, v211
    v_cvt_pk_bf16_f32 v210, v212, v213
    v_cvt_pk_bf16_f32 v211, v214, v215
    buffer_store_dwordx4 v[208:211], v2, s[8:11], s90 offen sc1
    s_add_u32 s90, s90, s100
    v_pk_mul_f32 v[216:217], v[216:217], s[92:93]
    v_pk_mul_f32 v[218:219], v[218:219], s[92:93]
    v_pk_mul_f32 v[220:221], v[220:221], s[92:93]
    v_pk_mul_f32 v[222:223], v[222:223], s[92:93]
    v_cvt_pk_bf16_f32 v216, v216, v217
    v_cvt_pk_bf16_f32 v217, v218, v219
    v_cvt_pk_bf16_f32 v218, v220, v221
    v_cvt_pk_bf16_f32 v219, v222, v223
    buffer_store_dwordx4 v[216:219], v2, s[8:11], s90 offen sc1
    s_add_u32 s90, s90, s100
    s_add_u32 s91, s91, s99
    s_mov_b32 s90, s91
    v_pk_mul_f32 v[224:225], v[224:225], s[92:93]
    v_pk_mul_f32 v[226:227], v[226:227], s[92:93]
    v_pk_mul_f32 v[228:229], v[228:229], s[92:93]
    v_pk_mul_f32 v[230:231], v[230:231], s[92:93]
    v_cvt_pk_bf16_f32 v224, v224, v225
    v_cvt_pk_bf16_f32 v225, v226, v227
    v_cvt_pk_bf16_f32 v226, v228, v229
    v_cvt_pk_bf16_f32 v227, v230, v231
    buffer_store_dwordx4 v[224:227], v2, s[8:11], s90 offen sc1
    s_add_u32 s90, s90, s100
    v_pk_mul_f32 v[232:233], v[232:233], s[92:93]
    v_pk_mul_f32 v[234:235], v[234:235], s[92:93]
    v_pk_mul_f32 v[236:237], v[236:237], s[92:93]
    v_pk_mul_f32 v[238:239], v[238:239], s[92:93]
    v_cvt_pk_bf16_f32 v232, v232, v233
    v_cvt_pk_bf16_f32 v233, v234, v235
    v_cvt_pk_bf16_f32 v234, v236, v237
    v_cvt_pk_bf16_f32 v235, v238, v239
    buffer_store_dwordx4 v[232:235], v2, s[8:11], s90 offen sc1
    s_add_u32 s90, s90, s100
    v_pk_mul_f32 v[240:241], v[240:241], s[92:93]
    v_pk_mul_f32 v[242:243], v[242:243], s[92:93]
    v_pk_mul_f32 v[244:245], v[244:245], s[92:93]
    v_pk_mul_f32 v[246:247], v[246:247], s[92:93]
    v_cvt_pk_bf16_f32 v240, v240, v241
    v_cvt_pk_bf16_f32 v241, v242, v243
    v_cvt_pk_bf16_f32 v242, v244, v245
    v_cvt_pk_bf16_f32 v243, v246, v247
    buffer_store_dwordx4 v[240:243], v2, s[8:11], s90 offen sc1
    s_add_u32 s90, s90, s100
    v_pk_mul_f32 v[248:249], v[248:249], s[92:93]
    v_pk_mul_f32 v[250:251], v[250:251], s[92:93]
    v_pk_mul_f32 v[252:253], v[252:253], s[92:93]
    v_pk_mul_f32 v[254:255], v[254:255], s[92:93]
    v_cvt_pk_bf16_f32 v248, v248, v249
    v_cvt_pk_bf16_f32 v249, v250, v251
    v_cvt_pk_bf16_f32 v250, v252, v253
    v_cvt_pk_bf16_f32 v251, v254, v255
    buffer_store_dwordx4 v[248:251], v2, s[8:11], s90 offen sc1
    s_add_u32 s90, s90, s100
    v_accvgpr_read_b32 v24, a224
    v_accvgpr_read_b32 v25, a225
    v_accvgpr_read_b32 v26, a226
    v_accvgpr_read_b32 v27, a227
    v_accvgpr_read_b32 v28, a228
    v_accvgpr_read_b32 v29, a229
    v_accvgpr_read_b32 v30, a230
    v_accvgpr_read_b32 v31, a231
    v_pk_mul_f32 v[24:25], v[24:25], s[92:93]
    v_pk_mul_f32 v[26:27], v[26:27], s[92:93]
    v_pk_mul_f32 v[28:29], v[28:29], s[92:93]
    v_pk_mul_f32 v[30:31], v[30:31], s[92:93]
    v_cvt_pk_bf16_f32 v24, v24, v25
    v_cvt_pk_bf16_f32 v25, v26, v27
    v_cvt_pk_bf16_f32 v26, v28, v29
    v_cvt_pk_bf16_f32 v27, v30, v31
    buffer_store_dwordx4 v[24:27], v2, s[8:11], s90 offen sc1
    s_add_u32 s90, s90, s100
    s_nop 1
    v_accvgpr_read_b32 v24, a232
    v_accvgpr_read_b32 v25, a233
    v_accvgpr_read_b32 v26, a234
    v_accvgpr_read_b32 v27, a235
    v_accvgpr_read_b32 v28, a236
    v_accvgpr_read_b32 v29, a237
    v_accvgpr_read_b32 v30, a238
    v_accvgpr_read_b32 v31, a239
    v_pk_mul_f32 v[24:25], v[24:25], s[92:93]
    v_pk_mul_f32 v[26:27], v[26:27], s[92:93]
    v_pk_mul_f32 v[28:29], v[28:29], s[92:93]
    v_pk_mul_f32 v[30:31], v[30:31], s[92:93]
    v_cvt_pk_bf16_f32 v24, v24, v25
    v_cvt_pk_bf16_f32 v25, v26, v27
    v_cvt_pk_bf16_f32 v26, v28, v29
    v_cvt_pk_bf16_f32 v27, v30, v31
    buffer_store_dwordx4 v[24:27], v2, s[8:11], s90 offen sc1
    s_add_u32 s90, s90, s100
    s_nop 1
    v_accvgpr_read_b32 v24, a240
    v_accvgpr_read_b32 v25, a241
    v_accvgpr_read_b32 v26, a242
    v_accvgpr_read_b32 v27, a243
    v_accvgpr_read_b32 v28, a244
    v_accvgpr_read_b32 v29, a245
    v_accvgpr_read_b32 v30, a246
    v_accvgpr_read_b32 v31, a247
    v_pk_mul_f32 v[24:25], v[24:25], s[92:93]
    v_pk_mul_f32 v[26:27], v[26:27], s[92:93]
    v_pk_mul_f32 v[28:29], v[28:29], s[92:93]
    v_pk_mul_f32 v[30:31], v[30:31], s[92:93]
    v_cvt_pk_bf16_f32 v24, v24, v25
    v_cvt_pk_bf16_f32 v25, v26, v27
    v_cvt_pk_bf16_f32 v26, v28, v29
    v_cvt_pk_bf16_f32 v27, v30, v31
    buffer_store_dwordx4 v[24:27], v2, s[8:11], s90 offen sc1
    s_add_u32 s90, s90, s100
    s_nop 1
    v_accvgpr_read_b32 v24, a248
    v_accvgpr_read_b32 v25, a249
    v_accvgpr_read_b32 v26, a250
    v_accvgpr_read_b32 v27, a251
    v_accvgpr_read_b32 v28, a252
    v_accvgpr_read_b32 v29, a253
    v_accvgpr_read_b32 v30, a254
    v_accvgpr_read_b32 v31, a255
    v_pk_mul_f32 v[24:25], v[24:25], s[92:93]
    v_pk_mul_f32 v[26:27], v[26:27], s[92:93]
    v_pk_mul_f32 v[28:29], v[28:29], s[92:93]
    v_pk_mul_f32 v[30:31], v[30:31], s[92:93]
    v_cvt_pk_bf16_f32 v24, v24, v25
    v_cvt_pk_bf16_f32 v25, v26, v27
    v_cvt_pk_bf16_f32 v26, v28, v29
    v_cvt_pk_bf16_f32 v27, v30, v31
    buffer_store_dwordx4 v[24:27], v2, s[8:11], s90 offen sc1
    s_add_u32 s90, s90, s100
    s_nop 1
    s_add_u32 s91, s91, s99
    s_setpc_b64 s[20:21]
m_noscale65:
    s_mov_b32 s91, s98
    s_mov_b32 s92, s97
    s_mov_b32 s93, s97
    s_mov_b32 s90, s91
    v_cvt_pk_bf16_f32 v32, v32, v33
    v_cvt_pk_bf16_f32 v33, v34, v35
    v_cvt_pk_bf16_f32 v34, v36, v37
    v_cvt_pk_bf16_f32 v35, v38, v39
    buffer_store_dwordx4 v[32:35], v2, s[8:11], s90 offen sc1
    s_add_u32 s90, s90, s100
    v_cvt_pk_bf16_f32 v40, v40, v41
    v_cvt_pk_bf16_f32 v41, v42, v43
    v_cvt_pk_bf16_f32 v42, v44, v45
    v_cvt_pk_bf16_f32 v43, v46, v47
    buffer_store_dwordx4 v[40:43], v2, s[8:11], s90 offen sc1
    s_add_u32 s90, s90, s100
    v_cvt_pk_bf16_f32 v48, v48, v49
    v_cvt_pk_bf16_f32 v49, v50, v51
    v_cvt_pk_bf16_f32 v50, v52, v53
    v_cvt_pk_bf16_f32 v51, v54, v55
    buffer_store_dwordx4 v[48:51], v2, s[8:11], s90 offen sc1
    s_add_u32 s90, s90, s100
    v_cvt_pk_bf16_f32 v56, v56, v57
    v_cvt_pk_bf16_f32 v57, v58, v59
    v_cvt_pk_bf16_f32 v58, v60, v61
    v_cvt_pk_bf16_f32 v59, v62, v63
    buffer_store_dwordx4 v[56:59], v2, s[8:11], s90 offen sc1
    s_add_u32 s90, s90, s100
    v_cvt_pk_bf16_f32 v64, v64, v65
    v_cvt_pk_bf16_f32 v65, v66, v67
    v_cvt_pk_bf16_f32 v66, v68, v69
    v_cvt_pk_bf16_f32 v67, v70, v71
    buffer_store_dwordx4 v[64:67], v2, s[8:11], s90 offen sc1
    s_add_u32 s90, s90, s100
    v_cvt_pk_bf16_f32 v72, v72, v73
    v_cvt_pk_bf16_f32 v73, v74, v75
    v_cvt_pk_bf16_f32 v74, v76, v77
    v_cvt_pk_bf16_f32 v75, v78, v79
    buffer_store_dwordx4 v[72:75], v2, s[8:11], s90 offen sc1
    s_add_u32 s90, s90, s100
    v_cvt_pk_bf16_f32 v80, v80, v81
    v_cvt_pk_bf16_f32 v81, v82, v83
    v_cvt_pk_bf16_f32 v82, v84, v85
    v_cvt_pk_bf16_f32 v83, v86, v87
    buffer_store_dwordx4 v[80:83], v2, s[8:11], s90 offen sc1
    s_add_u32 s90, s90, s100
    v_cvt_pk_bf16_f32 v88, v88, v89
    v_cvt_pk_bf16_f32 v89, v90, v91
    v_cvt_pk_bf16_f32 v90, v92, v93
    v_cvt_pk_bf16_f32 v91, v94, v95
    buffer_store_dwordx4 v[88:91], v2, s[8:11], s90 offen sc1
    s_add_u32 s90, s90, s100
    s_add_u32 s91, s91, s99
    s_mov_b32 s90, s91
    v_cvt_pk_bf16_f32 v96, v96, v97
    v_cvt_pk_bf16_f32 v97, v98, v99
    v_cvt_pk_bf16_f32 v98, v100, v101
    v_cvt_pk_bf16_f32 v99, v102, v103
    buffer_store_dwordx4 v[96:99], v2, s[8:11], s90 offen sc1
    s_add_u32 s90, s90, s100
    v_cvt_pk_bf16_f32 v104, v104, v105
    v_cvt_pk_bf16_f32 v105, v106, v107
    v_cvt_pk_bf16_f32 v106, v108, v109
    v_cvt_pk_bf16_f32 v107, v110, v111
    buffer_store_dwordx4 v[104:107], v2, s[8:11], s90 offen sc1
    s_add_u32 s90, s90, s100
    v_cvt_pk_bf16_f32 v112, v112, v113
    v_cvt_pk_bf16_f32 v113, v114, v115
    v_cvt_pk_bf16_f32 v114, v116, v117
    v_cvt_pk_bf16_f32 v115, v118, v119
    buffer_store_dwordx4 v[112:115], v2, s[8:11], s90 offen sc1
    s_add_u32 s90, s90, s100
    v_cvt_pk_bf16_f32 v120, v120, v121
    v_cvt_pk_bf16_f32 v121, v122, v123
    v_cvt_pk_bf16_f32 v122, v124, v125
    v_cvt_pk_bf16_f32 v123, v126, v127
    buffer_store_dwordx4 v[120:123], v2, s[8:11], s90 offen sc1
    s_add_u32 s90, s90, s100
    v_cvt_pk_bf16_f32 v128, v128, v129
    v_cvt_pk_bf16_f32 v129, v130, v131
    v_cvt_pk_bf16_f32 v130, v132, v133
    v_cvt_pk_bf16_f32 v131, v134, v135
    buffer_store_dwordx4 v[128:131], v2, s[8:11], s90 offen sc1
    s_add_u32 s90, s90, s100
    v_cvt_pk_bf16_f32 v136, v136, v137
    v_cvt_pk_bf16_f32 v137, v138, v139
    v_cvt_pk_bf16_f32 v138, v140, v141
    v_cvt_pk_bf16_f32 v139, v142, v143
    buffer_store_dwordx4 v[136:139], v2, s[8:11], s90 offen sc1
    s_add_u32 s90, s90, s100
    v_cvt_pk_bf16_f32 v144, v144, v145
    v_cvt_pk_bf16_f32 v145, v146, v147
    v_cvt_pk_bf16_f32 v146, v148, v149
    v_cvt_pk_bf16_f32 v147, v150, v151
    buffer_store_dwordx4 v[144:147], v2, s[8:11], s90 offen sc1
    s_add_u32 s90, s90, s100
    v_cvt_pk_bf16_f32 v152, v152, v153
    v_cvt_pk_bf16_f32 v153, v154, v155
    v_cvt_pk_bf16_f32 v154, v156, v157
    v_cvt_pk_bf16_f32 v155, v158, v159
    buffer_store_dwordx4 v[152:155], v2, s[8:11], s90 offen sc1
    s_add_u32 s90, s90, s100
    s_add_u32 s91, s91, s99
    s_mov_b32 s90, s91
    v_cvt_pk_bf16_f32 v160, v160, v161
    v_cvt_pk_bf16_f32 v161, v162, v163
    v_cvt_pk_bf16_f32 v162, v164, v165
    v_cvt_pk_bf16_f32 v163, v166, v167
    buffer_store_dwordx4 v[160:163], v2, s[8:11], s90 offen sc1
    s_add_u32 s90, s90, s100
    v_cvt_pk_bf16_f32 v168, v168, v169
    v_cvt_pk_bf16_f32 v169, v170, v171
    v_cvt_pk_bf16_f32 v170, v172, v173
    v_cvt_pk_bf16_f32 v171, v174, v175
    buffer_store_dwordx4 v[168:171], v2, s[8:11], s90 offen sc1
    s_add_u32 s90, s90, s100
    v_cvt_pk_bf16_f32 v176, v176, v177
    v_cvt_pk_bf16_f32 v177, v178, v179
    v_cvt_pk_bf16_f32 v178, v180, v181
    v_cvt_pk_bf16_f32 v179, v182, v183
    buffer_store_dwordx4 v[176:179], v2, s[8:11], s90 offen sc1
    s_add_u32 s90, s90, s100
    v_cvt_pk_bf16_f32 v184, v184, v185
    v_cvt_pk_bf16_f32 v185, v186, v187
    v_cvt_pk_bf16_f32 v186, v188, v189
    v_cvt_pk_bf16_f32 v187, v190, v191
    buffer_store_dwordx4 v[184:187], v2, s[8:11], s90 offen sc1
    s_add_u32 s90, s90, s100
    v_cvt_pk_bf16_f32 v192, v192, v193
    v_cvt_pk_bf16_f32 v193, v194, v195
    v_cvt_pk_bf16_f32 v194, v196, v197
    v_cvt_pk_bf16_f32 v195, v198, v199
    buffer_store_dwordx4 v[192:195], v2, s[8:11], s90 offen sc1
    s_add_u32 s90, s90, s100
    v_cvt_pk_bf16_f32 v200, v200, v201
    v_cvt_pk_bf16_f32 v201, v202, v203
    v_cvt_pk_bf16_f32 v202, v204, v205
    v_cvt_pk_bf16_f32 v203, v206, v207
    buffer_store_dwordx4 v[200:203], v2, s[8:11], s90 offen sc1
    s_add_u32 s90, s90, s100
    v_cvt_pk_bf16_f32 v208, v208, v209
    v_cvt_pk_bf16_f32 v209, v210, v211
    v_cvt_pk_bf16_f32 v210, v212, v213
    v_cvt_pk_bf16_f32 v211, v214, v215
    buffer_store_dwordx4 v[208:211], v2, s[8:11], s90 offen sc1
    s_add_u32 s90, s90, s100
    v_cvt_pk_bf16_f32 v216, v216, v217
    v_cvt_pk_bf16_f32 v217, v218, v219
    v_cvt_pk_bf16_f32 v218, v220, v221
    v_cvt_pk_bf16_f32 v219, v222, v223
    buffer_store_dwordx4 v[216:219], v2, s[8:11], s90 offen sc1
    s_add_u32 s90, s90, s100
    s_add_u32 s91, s91, s99
    s_mov_b32 s90, s91
    v_cvt_pk_bf16_f32 v224, v224, v225
    v_cvt_pk_bf16_f32 v225, v226, v227
    v_cvt_pk_bf16_f32 v226, v228, v229
    v_cvt_pk_bf16_f32 v227, v230, v231
    buffer_store_dwordx4 v[224:227], v2, s[8:11], s90 offen sc1
    s_add_u32 s90, s90, s100
    v_cvt_pk_bf16_f32 v232, v232, v233
    v_cvt_pk_bf16_f32 v233, v234, v235
    v_cvt_pk_bf16_f32 v234, v236, v237
    v_cvt_pk_bf16_f32 v235, v238, v239
    buffer_store_dwordx4 v[232:235], v2, s[8:11], s90 offen sc1
    s_add_u32 s90, s90, s100
    v_cvt_pk_bf16_f32 v240, v240, v241
    v_cvt_pk_bf16_f32 v241, v242, v243
    v_cvt_pk_bf16_f32 v242, v244, v245
    v_cvt_pk_bf16_f32 v243, v246, v247
    buffer_store_dwordx4 v[240:243], v2, s[8:11], s90 offen sc1
    s_add_u32 s90, s90, s100
    v_cvt_pk_bf16_f32 v248, v248, v249
    v_cvt_pk_bf16_f32 v249, v250, v251
    v_cvt_pk_bf16_f32 v250, v252, v253
    v_cvt_pk_bf16_f32 v251, v254, v255
    buffer_store_dwordx4 v[248:251], v2, s[8:11], s90 offen sc1
    s_add_u32 s90, s90, s100
    v_accvgpr_read_b32 v24, a224
    v_accvgpr_read_b32 v25, a225
    v_accvgpr_read_b32 v26, a226
    v_accvgpr_read_b32 v27, a227
    v_accvgpr_read_b32 v28, a228
    v_accvgpr_read_b32 v29, a229
    v_accvgpr_read_b32 v30, a230
    v_accvgpr_read_b32 v31, a231
    v_cvt_pk_bf16_f32 v24, v24, v25
    v_cvt_pk_bf16_f32 v25, v26, v27
    v_cvt_pk_bf16_f32 v26, v28, v29
    v_cvt_pk_bf16_f32 v27, v30, v31
    buffer_store_dwordx4 v[24:27], v2, s[8:11], s90 offen sc1
    s_add_u32 s90, s90, s100
    s_nop 1
    v_accvgpr_read_b32 v24, a232
    v_accvgpr_read_b32 v25, a233
    v_accvgpr_read_b32 v26, a234
    v_accvgpr_read_b32 v27, a235
    v_accvgpr_read_b32 v28, a236
    v_accvgpr_read_b32 v29, a237
    v_accvgpr_read_b32 v30, a238
    v_accvgpr_read_b32 v31, a239
    v_cvt_pk_bf16_f32 v24, v24, v25
    v_cvt_pk_bf16_f32 v25, v26, v27
    v_cvt_pk_bf16_f32 v26, v28, v29
    v_cvt_pk_bf16_f32 v27, v30, v31
    buffer_store_dwordx4 v[24:27], v2, s[8:11], s90 offen sc1
    s_add_u32 s90, s90, s100
    s_nop 1
    v_accvgpr_read_b32 v24, a240
    v_accvgpr_read_b32 v25, a241
    v_accvgpr_read_b32 v26, a242
    v_accvgpr_read_b32 v27, a243
    v_accvgpr_read_b32 v28, a244
    v_accvgpr_read_b32 v29, a245
    v_accvgpr_read_b32 v30, a246
    v_accvgpr_read_b32 v31, a247
    v_cvt_pk_bf16_f32 v24, v24, v25
    v_cvt_pk_bf16_f32 v25, v26, v27
    v_cvt_pk_bf16_f32 v26, v28, v29
    v_cvt_pk_bf16_f32 v27, v30, v31
    buffer_store_dwordx4 v[24:27], v2, s[8:11], s90 offen sc1
    s_add_u32 s90, s90, s100
    s_nop 1
    v_accvgpr_read_b32 v24, a248
    v_accvgpr_read_b32 v25, a249
    v_accvgpr_read_b32 v26, a250
    v_accvgpr_read_b32 v27, a251
    v_accvgpr_read_b32 v28, a252
    v_accvgpr_read_b32 v29, a253
    v_accvgpr_read_b32 v30, a254
    v_accvgpr_read_b32 v31, a255
    v_cvt_pk_bf16_f32 v24, v24, v25
    v_cvt_pk_bf16_f32 v25, v26, v27
    v_cvt_pk_bf16_f32 v26, v28, v29
    v_cvt_pk_bf16_f32 v27, v30, v31
    buffer_store_dwordx4 v[24:27], v2, s[8:11], s90 offen sc1
    s_add_u32 s90, s90, s100
    s_nop 1
    s_add_u32 s91, s91, s99
    s_setpc_b64 s[20:21]
m_epl66:
    s_mov_b32 s92, s97
    s_mov_b32 s93, s97
    s_cmp_eq_u32 s97, 0
    s_cbranch_scc1 m_ns267
    s_mov_b32 s90, s98
    v_pk_mul_f32 v[32:33], v[32:33], s[92:93]
    v_pk_mul_f32 v[34:35], v[34:35], s[92:93]
    v_pk_mul_f32 v[36:37], v[36:37], s[92:93]
    v_pk_mul_f32 v[38:39], v[38:39], s[92:93]
    v_cvt_pk_bf16_f32 v32, v32, v33
    v_cvt_pk_bf16_f32 v33, v34, v35
    v_cvt_pk_bf16_f32 v34, v36, v37
    v_cvt_pk_bf16_f32 v35, v38, v39
    buffer_store_dwordx4 v[32:35], v2, s[8:11], s90 offen sc1
    s_add_u32 s90, s90, s100
    v_pk_mul_f32 v[40:41], v[40:41], s[92:93]
    v_pk_mul_f32 v[42:43], v[42:43], s[92:93]
    v_pk_mul_f32 v[44:45], v[44:45], s[92:93]
    v_pk_mul_f32 v[46:47], v[46:47], s[92:93]
    v_cvt_pk_bf16_f32 v40, v40, v41
    v_cvt_pk_bf16_f32 v41, v42, v43
    v_cvt_pk_bf16_f32 v42, v44, v45
    v_cvt_pk_bf16_f32 v43, v46, v47
    buffer_store_dwordx4 v[40:43], v2, s[8:11], s90 offen sc1
    s_add_u32 s90, s90, s100
    v_pk_mul_f32 v[48:49], v[48:49], s[92:93]
    v_pk_mul_f32 v[50:51], v[50:51], s[92:93]
    v_pk_mul_f32 v[52:53], v[52:53], s[92:93]
    v_pk_mul_f32 v[54:55], v[54:55], s[92:93]
    v_cvt_pk_bf16_f32 v48, v48, v49
    v_cvt_pk_bf16_f32 v49, v50, v51
    v_cvt_pk_bf16_f32 v50, v52, v53
    v_cvt_pk_bf16_f32 v51, v54, v55
    buffer_store_dwordx4 v[48:51], v2, s[8:11], s90 offen sc1
    s_add_u32 s90, s90, s100
    v_pk_mul_f32 v[56:57], v[56:57], s[92:93]
    v_pk_mul_f32 v[58:59], v[58:59], s[92:93]
    v_pk_mul_f32 v[60:61], v[60:61], s[92:93]
    v_pk_mul_f32 v[62:63], v[62:63], s[92:93]
    v_cvt_pk_bf16_f32 v56, v56, v57
    v_cvt_pk_bf16_f32 v57, v58, v59
    v_cvt_pk_bf16_f32 v58, v60, v61
    v_cvt_pk_bf16_f32 v59, v62, v63
    buffer_store_dwordx4 v[56:59], v2, s[8:11], s90 offen sc1
    s_add_u32 s90, s90, s100
    v_pk_mul_f32 v[64:65], v[64:65], s[92:93]
    v_pk_mul_f32 v[66:67], v[66:67], s[92:93]
    v_pk_mul_f32 v[68:69], v[68:69], s[92:93]
    v_pk_mul_f32 v[70:71], v[70:71], s[92:93]
    v_cvt_pk_bf16_f32 v64, v64, v65
    v_cvt_pk_bf16_f32 v65, v66, v67
    v_cvt_pk_bf16_f32 v66, v68, v69
    v_cvt_pk_bf16_f32 v67, v70, v71
    buffer_store_dwordx4 v[64:67], v2, s[8:11], s90 offen sc1
    s_add_u32 s90, s90, s100
    v_pk_mul_f32 v[72:73], v[72:73], s[92:93]
    v_pk_mul_f32 v[74:75], v[74:75], s[92:93]
    v_pk_mul_f32 v[76:77], v[76:77], s[92:93]
    v_pk_mul_f32 v[78:79], v[78:79], s[92:93]
    v_cvt_pk_bf16_f32 v72, v72, v73
    v_cvt_pk_bf16_f32 v73, v74, v75
    v_cvt_pk_bf16_f32 v74, v76, v77
    v_cvt_pk_bf16_f32 v75, v78, v79
    buffer_store_dwordx4 v[72:75], v2, s[8:11], s90 offen sc1
    s_add_u32 s90, s90, s100
    v_pk_mul_f32 v[80:81], v[80:81], s[92:93]
    v_pk_mul_f32 v[82:83], v[82:83], s[92:93]
    v_pk_mul_f32 v[84:85], v[84:85], s[92:93]
    v_pk_mul_f32 v[86:87], v[86:87], s[92:93]
    v_cvt_pk_bf16_f32 v80, v80, v81
    v_cvt_pk_bf16_f32 v81, v82, v83
    v_cvt_pk_bf16_f32 v82, v84, v85
    v_cvt_pk_bf16_f32 v83, v86, v87
    buffer_store_dwordx4 v[80:83], v2, s[8:11], s90 offen sc1
    s_add_u32 s90, s90, s100
    v_pk_mul_f32 v[88:89], v[88:89], s[92:93]
    v_pk_mul_f32 v[90:91], v[90:91], s[92:93]
    v_pk_mul_f32 v[92:93], v[92:93], s[92:93]
    v_pk_mul_f32 v[94:95], v[94:95], s[92:93]
    v_cvt_pk_bf16_f32 v88, v88, v89
    v_cvt_pk_bf16_f32 v89, v90, v91
    v_cvt_pk_bf16_f32 v90, v92, v93
    v_cvt_pk_bf16_f32 v91, v94, v95
    buffer_store_dwordx4 v[88:91], v2, s[8:11], s90 offen sc1
    s_add_u32 s90, s98, s99
    v_pk_mul_f32 v[96:97], v[96:97], s[92:93]
    v_pk_mul_f32 v[98:99], v[98:99], s[92:93]
    v_pk_mul_f32 v[100:101], v[100:101], s[92:93]
    v_pk_mul_f32 v[102:103], v[102:103], s[92:93]
    v_cvt_pk_bf16_f32 v96, v96, v97
    v_cvt_pk_bf16_f32 v97, v98, v99
    v_cvt_pk_bf16_f32 v98, v100, v101
    v_cvt_pk_bf16_f32 v99, v102, v103
    buffer_store_dwordx4 v[96:99], v2, s[8:11], s90 offen sc1
    s_add_u32 s90, s90, s100
    v_pk_mul_f32 v[104:105], v[104:105], s[92:93]
    v_pk_mul_f32 v[106:107], v[106:107], s[92:93]
    v_pk_mul_f32 v[108:109], v[108:109], s[92:93]
    v_pk_mul_f32 v[110:111], v[110:111], s[92:93]
    v_cvt_pk_bf16_f32 v104, v104, v105
    v_cvt_pk_bf16_f32 v105, v106, v107
    v_cvt_pk_bf16_f32 v106, v108, v109
    v_cvt_pk_bf16_f32 v107, v110, v111
    buffer_store_dwordx4 v[104:107], v2, s[8:11], s90 offen sc1
    s_add_u32 s90, s90, s100
    v_pk_mul_f32 v[112:113], v[112:113], s[92:93]
    v_pk_mul_f32 v[114:115], v[114:115], s[92:93]
    v_pk_mul_f32 v[116:117], v[116:117], s[92:93]
    v_pk_mul_f32 v[118:119], v[118:119], s[92:93]
    v_cvt_pk_bf16_f32 v112, v112, v113
    v_cvt_pk_bf16_f32 v113, v114, v115
    v_cvt_pk_bf16_f32 v114, v116, v117
    v_cvt_pk_bf16_f32 v115, v118, v119
    buffer_store_dwordx4 v[112:115], v2, s[8:11], s90 offen sc1
    s_add_u32 s90, s90, s100
    v_pk_mul_f32 v[120:121], v[120:121], s[92:93]
    v_pk_mul_f32 v[122:123], v[122:123], s[92:93]
    v_pk_mul_f32 v[124:125], v[124:125], s[92:93]
    v_pk_mul_f32 v[126:127], v[126:127], s[92:93]
    v_cvt_pk_bf16_f32 v120, v120, v121
    v_cvt_pk_bf16_f32 v121, v122, v123
    v_cvt_pk_bf16_f32 v122, v124, v125
    v_cvt_pk_bf16_f32 v123, v126, v127
    buffer_store_dwordx4 v[120:123], v2, s[8:11], s90 offen sc1
    s_add_u32 s90, s90, s100
    v_pk_mul_f32 v[128:129], v[128:129], s[92:93]
    v_pk_mul_f32 v[130:131], v[130:131], s[92:93]
    v_pk_mul_f32 v[132:133], v[132:133], s[92:93]
    v_pk_mul_f32 v[134:135], v[134:135], s[92:93]
    v_cvt_pk_bf16_f32 v128, v128, v129
    v_cvt_pk_bf16_f32 v129, v130, v131
    v_cvt_pk_bf16_f32 v130, v132, v133
    v_cvt_pk_bf16_f32 v131, v134, v135
    buffer_store_dwordx4 v[128:131], v2, s[8:11], s90 offen sc1
    s_add_u32 s90, s90, s100
    v_pk_mul_f32 v[136:137], v[136:137], s[92:93]
    v_pk_mul_f32 v[138:139], v[138:139], s[92:93]
    v_pk_mul_f32 v[140:141], v[140:141], s[92:93]
    v_pk_mul_f32 v[142:143], v[142:143], s[92:93]
    v_cvt_pk_bf16_f32 v136, v136, v137
    v_cvt_pk_bf16_f32 v137, v138, v139
    v_cvt_pk_bf16_f32 v138, v140, v141
    v_cvt_pk_bf16_f32 v139, v142, v143
    buffer_store_dwordx4 v[136:139], v2, s[8:11], s90 offen sc1
    s_add_u32 s90, s90, s100
    v_pk_mul_f32 v[144:145], v[144:145], s[92:93]
    v_pk_mul_f32 v[146:147], v[146:147], s[92:93]
    v_pk_mul_f32 v[148:149], v[148:149], s[92:93]
    v_pk_mul_f32 v[150:151], v[150:151], s[92:93]
    v_cvt_pk_bf16_f32 v144, v144, v145
    v_cvt_pk_bf16_f32 v145, v146, v147
    v_cvt_pk_bf16_f32 v146, v148, v149
    v_cvt_pk_bf16_f32 v147, v150, v151
    buffer_store_dwordx4 v[144:147], v2, s[8:11], s90 offen sc1
    s_add_u32 s90, s90, s100
    v_pk_mul_f32 v[152:153], v[152:153], s[92:93]
    v_pk_mul_f32 v[154:155], v[154:155], s[92:93]
    v_pk_mul_f32 v[156:157], v[156:157], s[92:93]
    v_pk_mul_f32 v[158:159], v[158:159], s[92:93]
    v_cvt_pk_bf16_f32 v152, v152, v153
    v_cvt_pk_bf16_f32 v153, v154, v155
    v_cvt_pk_bf16_f32 v154, v156, v157
    v_cvt_pk_bf16_f32 v155, v158, v159
    buffer_store_dwordx4 v[152:155], v2, s[8:11], s90 offen sc1
    s_add_u32 s90, s90, s100
    v_pk_mul_f32 v[192:193], v[192:193], s[92:93]
    v_pk_mul_f32 v[194:195], v[194:195], s[92:93]
    v_pk_mul_f32 v[196:197], v[196:197], s[92:93]
    v_pk_mul_f32 v[198:199], v[198:199], s[92:93]
    v_cvt_pk_bf16_f32 v192, v192, v193
    v_cvt_pk_bf16_f32 v193, v194, v195
    v_cvt_pk_bf16_f32 v194, v196, v197
    v_cvt_pk_bf16_f32 v195, v198, v199
    v_pk_mul_f32 v[200:201], v[200:201], s[92:93]
    v_pk_mul_f32 v[202:203], v[202:203], s[92:93]
    v_pk_mul_f32 v[204:205], v[204:205], s[92:93]
    v_pk_mul_f32 v[206:207], v[206:207], s[92:93]
    v_cvt_pk_bf16_f32 v196, v200, v201
    v_cvt_pk_bf16_f32 v197, v202, v203
    v_cvt_pk_bf16_f32 v198, v204, v205
    v_cvt_pk_bf16_f32 v199, v206, v207
    v_pk_mul_f32 v[208:209], v[208:209], s[92:93]
    v_pk_mul_f32 v[210:211], v[210:211], s[92:93]
    v_pk_mul_f32 v[212:213], v[212:213], s[92:93]
    v_pk_mul_f32 v[214:215], v[214:215], s[92:93]
    v_cvt_pk_bf16_f32 v200, v208, v209
    v_cvt_pk_bf16_f32 v201, v210, v211
    v_cvt_pk_bf16_f32 v202, v212, v213
    v_cvt_pk_bf16_f32 v203, v214, v215
    v_pk_mul_f32 v[216:217], v[216:217], s[92:93]
    v_pk_mul_f32 v[218:219], v[218:219], s[92:93]
    v_pk_mul_f32 v[220:221], v[220:221], s[92:93]
    v_pk_mul_f32 v[222:223], v[222:223], s[92:93]
    v_cvt_pk_bf16_f32 v204, v216, v217
    v_cvt_pk_bf16_f32 v205, v218, v219
    v_cvt_pk_bf16_f32 v206, v220, v221
    v_cvt_pk_bf16_f32 v207, v222, v223
    v_pk_mul_f32 v[224:225], v[224:225], s[92:93]
    v_pk_mul_f32 v[226:227], v[226:227], s[92:93]
    v_pk_mul_f32 v[228:229], v[228:229], s[92:93]
    v_pk_mul_f32 v[230:231], v[230:231], s[92:93]
    v_cvt_pk_bf16_f32 v208, v224, v225
    v_cvt_pk_bf16_f32 v209, v226, v227
    v_cvt_pk_bf16_f32 v210, v228, v229
    v_cvt_pk_bf16_f32 v211, v230, v231
    v_pk_mul_f32 v[232:233], v[232:233], s[92:93]
    v_pk_mul_f32 v[234:235], v[234:235], s[92:93]
    v_pk_mul_f32 v[236:237], v[236:237], s[92:93]
    v_pk_mul_f32 v[238:239], v[238:239], s[92:93]
    v_cvt_pk_bf16_f32 v212, v232, v233
    v_cvt_pk_bf16_f32 v213, v234, v235
    v_cvt_pk_bf16_f32 v214, v236, v237
    v_cvt_pk_bf16_f32 v215, v238, v239
    v_pk_mul_f32 v[240:241], v[240:241], s[92:93]
    v_pk_mul_f32 v[242:243], v[242:243], s[92:93]
    v_pk_mul_f32 v[244:245], v[244:245], s[92:93]
    v_pk_mul_f32 v[246:247], v[246:247], s[92:93]
    v_cvt_pk_bf16_f32 v216, v240, v241
    v_cvt_pk_bf16_f32 v217, v242, v243
    v_cvt_pk_bf16_f32 v218, v244, v245
    v_cvt_pk_bf16_f32 v219, v246, v247
    v_pk_mul_f32 v[248:249], v[248:249], s[92:93]
    v_pk_mul_f32 v[250:251], v[250:251], s[92:93]
    v_pk_mul_f32 v[252:253], v[252:253], s[92:93]
    v_pk_mul_f32 v[254:255], v[254:255], s[92:93]
    v_cvt_pk_bf16_f32 v220, v248, v249
    v_cvt_pk_bf16_f32 v221, v250, v251
    v_cvt_pk_bf16_f32 v222, v252, v253
    v_cvt_pk_bf16_f32 v223, v254, v255
    v_accvgpr_read_b32 v24, a224
    v_accvgpr_read_b32 v25, a225
    v_accvgpr_read_b32 v26, a226
    v_accvgpr_read_b32 v27, a227
    v_accvgpr_read_b32 v28, a228
    v_accvgpr_read_b32 v29, a229
    v_accvgpr_read_b32 v30, a230
    v_accvgpr_read_b32 v31, a231
    v_pk_mul_f32 v[24:25], v[24:25], s[92:93]
    v_pk_mul_f32 v[26:27], v[26:27], s[92:93]
    v_pk_mul_f32 v[28:29], v[28:29], s[92:93]
    v_pk_mul_f32 v[30:31], v[30:31], s[92:93]
    v_cvt_pk_bf16_f32 v224, v24, v25
    v_cvt_pk_bf16_f32 v225, v26, v27
    v_cvt_pk_bf16_f32 v226, v28, v29
    v_cvt_pk_bf16_f32 v227, v30, v31
    v_accvgpr_read_b32 v24, a232
    v_accvgpr_read_b32 v25, a233
    v_accvgpr_read_b32 v26, a234
    v_accvgpr_read_b32 v27, a235
    v_accvgpr_read_b32 v28, a236
    v_accvgpr_read_b32 v29, a237
    v_accvgpr_read_b32 v30, a238
    v_accvgpr_read_b32 v31, a239
    v_pk_mul_f32 v[24:25], v[24:25], s[92:93]
    v_pk_mul_f32 v[26:27], v[26:27], s[92:93]
    v_pk_mul_f32 v[28:29], v[28:29], s[92:93]
    v_pk_mul_f32 v[30:31], v[30:31], s[92:93]
    v_cvt_pk_bf16_f32 v228, v24, v25
    v_cvt_pk_bf16_f32 v229, v26, v27
    v_cvt_pk_bf16_f32 v230, v28, v29
    v_cvt_pk_bf16_f32 v231, v30, v31
    v_accvgpr_read_b32 v24, a240
    v_accvgpr_read_b32 v25, a241
    v_accvgpr_read_b32 v26, a242
    v_accvgpr_read_b32 v27, a243
    v_accvgpr_read_b32 v28, a244
    v_accvgpr_read_b32 v29, a245
    v_accvgpr_read_b32 v30, a246
    v_accvgpr_read_b32 v31, a247
    v_pk_mul_f32 v[24:25], v[24:25], s[92:93]
    v_pk_mul_f32 v[26:27], v[26:27], s[92:93]
    v_pk_mul_f32 v[28:29], v[28:29], s[92:93]
    v_pk_mul_f32 v[30:31], v[30:31], s[92:93]
    v_cvt_pk_bf16_f32 v232, v24, v25
    v_cvt_pk_bf16_f32 v233, v26, v27
    v_cvt_pk_bf16_f32 v234, v28, v29
    v_cvt_pk_bf16_f32 v235, v30, v31
    v_accvgpr_read_b32 v24, a248
    v_accvgpr_read_b32 v25, a249
    v_accvgpr_read_b32 v26, a250
    v_accvgpr_read_b32 v27, a251
    v_accvgpr_read_b32 v28, a252
    v_accvgpr_read_b32 v29, a253
    v_accvgpr_read_b32 v30, a254
    v_accvgpr_read_b32 v31, a255
    v_pk_mul_f32 v[24:25], v[24:25], s[92:93]
    v_pk_mul_f32 v[26:27], v[26:27], s[92:93]
    v_pk_mul_f32 v[28:29], v[28:29], s[92:93]
    v_pk_mul_f32 v[30:31], v[30:31], s[92:93]
    v_cvt_pk_bf16_f32 v236, v24, v25
    v_cvt_pk_bf16_f32 v237, v26, v27
    v_cvt_pk_bf16_f32 v238, v28, v29
    v_cvt_pk_bf16_f32 v239, v30, v31
    v_pk_mul_f32 v[160:161], v[160:161], s[92:93]
    v_pk_mul_f32 v[162:163], v[162:163], s[92:93]
    v_pk_mul_f32 v[164:165], v[164:165], s[92:93]
    v_pk_mul_f32 v[166:167], v[166:167], s[92:93]
    v_cvt_pk_bf16_f32 v240, v160, v161
    v_cvt_pk_bf16_f32 v241, v162, v163
    v_cvt_pk_bf16_f32 v242, v164, v165
    v_cvt_pk_bf16_f32 v243, v166, v167
    v_pk_mul_f32 v[168:169], v[168:169], s[92:93]
    v_pk_mul_f32 v[170:171], v[170:171], s[92:93]
    v_pk_mul_f32 v[172:173], v[172:173], s[92:93]
    v_pk_mul_f32 v[174:175], v[174:175], s[92:93]
    v_cvt_pk_bf16_f32 v244, v168, v169
    v_cvt_pk_bf16_f32 v245, v170, v171
    v_cvt_pk_bf16_f32 v246, v172, v173
    v_cvt_pk_bf16_f32 v247, v174, v175
    v_pk_mul_f32 v[176:177], v[176:177], s[92:93]
    v_pk_mul_f32 v[178:179], v[178:179], s[92:93]
    v_pk_mul_f32 v[180:181], v[180:181], s[92:93]
    v_pk_mul_f32 v[182:183], v[182:183], s[92:93]
    v_cvt_pk_bf16_f32 v248, v176, v177
    v_cvt_pk_bf16_f32 v249, v178, v179
    v_cvt_pk_bf16_f32 v250, v180, v181
    v_cvt_pk_bf16_f32 v251, v182, v183
    v_pk_mul_f32 v[184:185], v[184:185], s[92:93]
    v_pk_mul_f32 v[186:187], v[186:187], s[92:93]
    v_pk_mul_f32 v[188:189], v[188:189], s[92:93]
    v_pk_mul_f32 v[190:191], v[190:191], s[92:93]
    v_cvt_pk_bf16_f32 v252, v184, v185
    v_cvt_pk_bf16_f32 v253, v186, v187
    v_cvt_pk_bf16_f32 v254, v188, v189
    v_cvt_pk_bf16_f32 v255, v190, v191
    s_setpc_b64 s[20:21]
m_ns267:
    s_mov_b32 s90, s98
    v_cvt_pk_bf16_f32 v32, v32, v33
    v_cvt_pk_bf16_f32 v33, v34, v35
    v_cvt_pk_bf16_f32 v34, v36, v37
    v_cvt_pk_bf16_f32 v35, v38, v39
    buffer_store_dwordx4 v[32:35], v2, s[8:11], s90 offen sc1
    s_add_u32 s90, s90, s100
    v_cvt_pk_bf16_f32 v40, v40, v41
    v_cvt_pk_bf16_f32 v41, v42, v43
    v_cvt_pk_bf16_f32 v42, v44, v45
    v_cvt_pk_bf16_f32 v43, v46, v47
    buffer_store_dwordx4 v[40:43], v2, s[8:11], s90 offen sc1
    s_add_u32 s90, s90, s100
    v_cvt_pk_bf16_f32 v48, v48, v49
    v_cvt_pk_bf16_f32 v49, v50, v51
    v_cvt_pk_bf16_f32 v50, v52, v53
    v_cvt_pk_bf16_f32 v51, v54, v55
    buffer_store_dwordx4 v[48:51], v2, s[8:11], s90 offen sc1
    s_add_u32 s90, s90, s100
    v_cvt_pk_bf16_f32 v56, v56, v57
    v_cvt_pk_bf16_f32 v57, v58, v59
    v_cvt_pk_bf16_f32 v58, v60, v61
    v_cvt_pk_bf16_f32 v59, v62, v63
    buffer_store_dwordx4 v[56:59], v2, s[8:11], s90 offen sc1
    s_add_u32 s90, s90, s100
    v_cvt_pk_bf16_f32 v64, v64, v65
    v_cvt_pk_bf16_f32 v65, v66, v67
    v_cvt_pk_bf16_f32 v66, v68, v69
    v_cvt_pk_bf16_f32 v67, v70, v71
    buffer_store_dwordx4 v[64:67], v2, s[8:11], s90 offen sc1
    s_add_u32 s90, s90, s100
    v_cvt_pk_bf16_f32 v72, v72, v73
    v_cvt_pk_bf16_f32 v73, v74, v75
    v_cvt_pk_bf16_f32 v74, v76, v77
    v_cvt_pk_bf16_f32 v75, v78, v79
    buffer_store_dwordx4 v[72:75], v2, s[8:11], s90 offen sc1
    s_add_u32 s90, s90, s100
    v_cvt_pk_bf16_f32 v80, v80, v81
    v_cvt_pk_bf16_f32 v81, v82, v83
    v_cvt_pk_bf16_f32 v82, v84, v85
    v_cvt_pk_bf16_f32 v83, v86, v87
    buffer_store_dwordx4 v[80:83], v2, s[8:11], s90 offen sc1
    s_add_u32 s90, s90, s100
    v_cvt_pk_bf16_f32 v88, v88, v89
    v_cvt_pk_bf16_f32 v89, v90, v91
    v_cvt_pk_bf16_f32 v90, v92, v93
    v_cvt_pk_bf16_f32 v91, v94, v95
    buffer_store_dwordx4 v[88:91], v2, s[8:11], s90 offen sc1
    s_add_u32 s90, s98, s99
    v_cvt_pk_bf16_f32 v96, v96, v97
    v_cvt_pk_bf16_f32 v97, v98, v99
    v_cvt_pk_bf16_f32 v98, v100, v101
    v_cvt_pk_bf16_f32 v99, v102, v103
    buffer_store_dwordx4 v[96:99], v2, s[8:11], s90 offen sc1
    s_add_u32 s90, s90, s100
    v_cvt_pk_bf16_f32 v104, v104, v105
    v_cvt_pk_bf16_f32 v105, v106, v107
    v_cvt_pk_bf16_f32 v106, v108, v109
    v_cvt_pk_bf16_f32 v107, v110, v111
    buffer_store_dwordx4 v[104:107], v2, s[8:11], s90 offen sc1
    s_add_u32 s90, s90, s100
    v_cvt_pk_bf16_f32 v112, v112, v113
    v_cvt_pk_bf16_f32 v113, v114, v115
    v_cvt_pk_bf16_f32 v114, v116, v117
    v_cvt_pk_bf16_f32 v115, v118, v119
    buffer_store_dwordx4 v[112:115], v2, s[8:11], s90 offen sc1
    s_add_u32 s90, s90, s100
    v_cvt_pk_bf16_f32 v120, v120, v121
    v_cvt_pk_bf16_f32 v121, v122, v123
    v_cvt_pk_bf16_f32 v122, v124, v125
    v_cvt_pk_bf16_f32 v123, v126, v127
    buffer_store_dwordx4 v[120:123], v2, s[8:11], s90 offen sc1
    s_add_u32 s90, s90, s100
    v_cvt_pk_bf16_f32 v128, v128, v129
    v_cvt_pk_bf16_f32 v129, v130, v131
    v_cvt_pk_bf16_f32 v130, v132, v133
    v_cvt_pk_bf16_f32 v131, v134, v135
    buffer_store_dwordx4 v[128:131], v2, s[8:11], s90 offen sc1
    s_add_u32 s90, s90, s100
    v_cvt_pk_bf16_f32 v136, v136, v137
    v_cvt_pk_bf16_f32 v137, v138, v139
    v_cvt_pk_bf16_f32 v138, v140, v141
    v_cvt_pk_bf16_f32 v139, v142, v143
    buffer_store_dwordx4 v[136:139], v2, s[8:11], s90 offen sc1
    s_add_u32 s90, s90, s100
    v_cvt_pk_bf16_f32 v144, v144, v145
    v_cvt_pk_bf16_f32 v145, v146, v147
    v_cvt_pk_bf16_f32 v146, v148, v149
    v_cvt_pk_bf16_f32 v147, v150, v151
    buffer_store_dwordx4 v[144:147], v2, s[8:11], s90 offen sc1
    s_add_u32 s90, s90, s100
    v_cvt_pk_bf16_f32 v152, v152, v153
    v_cvt_pk_bf16_f32 v153, v154, v155
    v_cvt_pk_bf16_f32 v154, v156, v157
    v_cvt_pk_bf16_f32 v155, v158, v159
    buffer_store_dwordx4 v[152:155], v2, s[8:11], s90 offen sc1
    s_add_u32 s90, s90, s100
    v_cvt_pk_bf16_f32 v192, v192, v193
    v_cvt_pk_bf16_f32 v193, v194, v195
    v_cvt_pk_bf16_f32 v194, v196, v197
    v_cvt_pk_bf16_f32 v195, v198, v199
    v_cvt_pk_bf16_f32 v196, v200, v201
    v_cvt_pk_bf16_f32 v197, v202, v203
    v_cvt_pk_bf16_f32 v198, v204, v205
    v_cvt_pk_bf16_f32 v199, v206, v207
    v_cvt_pk_bf16_f32 v200, v208, v209
    v_cvt_pk_bf16_f32 v201, v210, v211
    v_cvt_pk_bf16_f32 v202, v212, v213
    v_cvt_pk_bf16_f32 v203, v214, v215
    v_cvt_pk_bf16_f32 v204, v216, v217
    v_cvt_pk_bf16_f32 v205, v218, v219
    v_cvt_pk_bf16_f32 v206, v220, v221
    v_cvt_pk_bf16_f32 v207, v222, v223
    v_cvt_pk_bf16_f32 v208, v224, v225
    v_cvt_pk_bf16_f32 v209, v226, v227
    v_cvt_pk_bf16_f32 v210, v228, v229
    v_cvt_pk_bf16_f32 v211, v230, v231
    v_cvt_pk_bf16_f32 v212, v232, v233
    v_cvt_pk_bf16_f32 v213, v234, v235
    v_cvt_pk_bf16_f32 v214, v236, v237
    v_cvt_pk_bf16_f32 v215, v238, v239
    v_cvt_pk_bf16_f32 v216, v240, v241
    v_cvt_pk_bf16_f32 v217, v242, v243
    v_cvt_pk_bf16_f32 v218, v244, v245
    v_cvt_pk_bf16_f32 v219, v246, v247
    v_cvt_pk_bf16_f32 v220, v248, v249
    v_cvt_pk_bf16_f32 v221, v250, v251
    v_cvt_pk_bf16_f32 v222, v252, v253
    v_cvt_pk_bf16_f32 v223, v254, v255
    v_accvgpr_read_b32 v24, a224
    v_accvgpr_read_b32 v25, a225
    v_accvgpr_read_b32 v26, a226
    v_accvgpr_read_b32 v27, a227
    v_accvgpr_read_b32 v28, a228
    v_accvgpr_read_b32 v29, a229
    v_accvgpr_read_b32 v30, a230
    v_accvgpr_read_b32 v31, a231
    v_cvt_pk_bf16_f32 v224, v24, v25
    v_cvt_pk_bf16_f32 v225, v26, v27
    v_cvt_pk_bf16_f32 v226, v28, v29
    v_cvt_pk_bf16_f32 v227, v30, v31
    v_accvgpr_read_b32 v24, a232
    v_accvgpr_read_b32 v25, a233
    v_accvgpr_read_b32 v26, a234
    v_accvgpr_read_b32 v27, a235
    v_accvgpr_read_b32 v28, a236
    v_accvgpr_read_b32 v29, a237
    v_accvgpr_read_b32 v30, a238
    v_accvgpr_read_b32 v31, a239
    v_cvt_pk_bf16_f32 v228, v24, v25
    v_cvt_pk_bf16_f32 v229, v26, v27
    v_cvt_pk_bf16_f32 v230, v28, v29
    v_cvt_pk_bf16_f32 v231, v30, v31
    v_accvgpr_read_b32 v24, a240
    v_accvgpr_read_b32 v25, a241
    v_accvgpr_read_b32 v26, a242
    v_accvgpr_read_b32 v27, a243
    v_accvgpr_read_b32 v28, a244
    v_accvgpr_read_b32 v29, a245
    v_accvgpr_read_b32 v30, a246
    v_accvgpr_read_b32 v31, a247
    v_cvt_pk_bf16_f32 v232, v24, v25
    v_cvt_pk_bf16_f32 v233, v26, v27
    v_cvt_pk_bf16_f32 v234, v28, v29
    v_cvt_pk_bf16_f32 v235, v30, v31
    v_accvgpr_read_b32 v24, a248
    v_accvgpr_read_b32 v25, a249
    v_accvgpr_read_b32 v26, a250
    v_accvgpr_read_b32 v27, a251
    v_accvgpr_read_b32 v28, a252
    v_accvgpr_read_b32 v29, a253
    v_accvgpr_read_b32 v30, a254
    v_accvgpr_read_b32 v31, a255
    v_cvt_pk_bf16_f32 v236, v24, v25
    v_cvt_pk_bf16_f32 v237, v26, v27
    v_cvt_pk_bf16_f32 v238, v28, v29
    v_cvt_pk_bf16_f32 v239, v30, v31
    v_cvt_pk_bf16_f32 v240, v160, v161
    v_cvt_pk_bf16_f32 v241, v162, v163
    v_cvt_pk_bf16_f32 v242, v164, v165
    v_cvt_pk_bf16_f32 v243, v166, v167
    v_cvt_pk_bf16_f32 v244, v168, v169
    v_cvt_pk_bf16_f32 v245, v170, v171
    v_cvt_pk_bf16_f32 v246, v172, v173
    v_cvt_pk_bf16_f32 v247, v174, v175
    v_cvt_pk_bf16_f32 v248, v176, v177
    v_cvt_pk_bf16_f32 v249, v178, v179
    v_cvt_pk_bf16_f32 v250, v180, v181
    v_cvt_pk_bf16_f32 v251, v182, v183
    v_cvt_pk_bf16_f32 v252, v184, v185
    v_cvt_pk_bf16_f32 v253, v186, v187
    v_cvt_pk_bf16_f32 v254, v188, v189
    v_cvt_pk_bf16_f32 v255, v190, v191
    s_setpc_b64 s[20:21]
m_pf7:
    s_mov_b32 s15, 0x20000
    s_sub_u32 s93, s2, 224
    s_lshl_b32 s93, s93, 2
    s_add_u32 s93, s93, s16
    v_lshlrev_b32 v24, 7, v1
    v_lshrrev_b32 v25, 3, v1
    v_lshlrev_b32 v25, 11, v25
    v_and_b32 v26, 7, v1
    v_lshl_add_u32 v25, v26, 7, v25
    s_lshl_b32 s92, s93, 13
    s_lshl_b32 s93, s93, 14
    s_add_u32 s93, s93, 1024
    v_lshrrev_b32 v25, 2, v1
    v_lshlrev_b32 v25, 11, v25
    v_and_b32 v26, 3, v1
    v_lshl_add_u32 v25, v26, 7, v25
    s_lshl_b32 s93, s92, 2
    s_mov_b32 s12, s34
    s_mov_b32 s13, s35
    s_mov_b32 s14, 8388608
    s_add_u32 s90, s92, 1048576
    buffer_load_dword v22, v24, s[12:15], s90 offen
    s_add_u32 s90, s92, 2097152
    buffer_load_dword v22, v24, s[12:15], s90 offen
    s_mov_b32 s12, s30
    s_mov_b32 s13, s31
    s_mov_b32 s14, 4194304
    s_add_u32 s90, s93, 512
    buffer_load_dword v22, v25, s[12:15], s90 offen
    s_mov_b32 s12, s34
    s_mov_b32 s13, s35
    s_mov_b32 s14, 8388608
    s_add_u32 s90, s92, 3145728
    buffer_load_dword v22, v24, s[12:15], s90 offen
    s_add_u32 s90, s92, 4194304
    buffer_load_dword v22, v24, s[12:15], s90 offen
    s_mov_b32 s12, s30
    s_mov_b32 s13, s31
    s_mov_b32 s14, 4194304
    s_add_u32 s90, s93, 1024
    buffer_load_dword v22, v25, s[12:15], s90 offen
    s_mov_b32 s12, s34
    s_mov_b32 s13, s35
    s_mov_b32 s14, 8388608
    s_add_u32 s90, s92, 5242880
    buffer_load_dword v22, v24, s[12:15], s90 offen
    s_mov_b32 s12, s26
    s_mov_b32 s13, s27
    s_mov_b32 s14, 6291456
    s_add_u32 s90, s92, 0
    buffer_load_dword v22, v24, s[12:15], s90 offen
    s_mov_b32 s12, s24
    s_mov_b32 s13, s25
    s_mov_b32 s14, 4194304
    s_add_u32 s90, s93, 0
    buffer_load_dword v22, v25, s[12:15], s90 offen
    s_mov_b32 s12, s34
    s_mov_b32 s13, s35
    s_mov_b32 s14, 8388608
    s_add_u32 s90, s92, 6291456
    buffer_load_dword v22, v24, s[12:15], s90 offen
    s_mov_b32 s12, s30
    s_mov_b32 s13, s31
    s_mov_b32 s14, 4194304
    s_add_u32 s90, s93, 1536
    buffer_load_dword v22, v25, s[12:15], s90 offen
    s_mov_b32 s12, s26
    s_mov_b32 s13, s27
    s_mov_b32 s14, 6291456
    s_add_u32 s90, s92, 1048576
    buffer_load_dword v22, v24, s[12:15], s90 offen
    s_mov_b32 s12, s24
    s_mov_b32 s13, s25
    s_mov_b32 s14, 4194304
    s_add_u32 s90, s93, 512
    buffer_load_dword v22, v25, s[12:15], s90 offen
    s_mov_b32 s12, s34
    s_mov_b32 s13, s35
    s_mov_b32 s14, 8388608
    s_add_u32 s90, s92, 7340032
    buffer_load_dword v22, v24, s[12:15], s90 offen
    s_mov_b32 s12, s26
    s_mov_b32 s13, s27
    s_mov_b32 s14, 6291456
    s_add_u32 s90, s92, 2097152
    buffer_load_dword v22, v24, s[12:15], s90 offen
    s_add_u32 s90, s92, 3145728
    buffer_load_dword v22, v24, s[12:15], s90 offen
    s_mov_b32 s12, s24
    s_mov_b32 s13, s25
    s_mov_b32 s14, 4194304
    s_add_u32 s90, s93, 1024
    buffer_load_dword v22, v25, s[12:15], s90 offen
    s_mov_b32 s12, s26
    s_mov_b32 s13, s27
    s_mov_b32 s14, 6291456
    s_add_u32 s90, s92, 4194304
    buffer_load_dword v22, v24, s[12:15], s90 offen
    s_mov_b32 s12, s24
    s_mov_b32 s13, s25
    s_mov_b32 s14, 4194304
    s_add_u32 s90, s93, 1536
    buffer_load_dword v22, v25, s[12:15], s90 offen
    s_mov_b32 s12, s26
    s_mov_b32 s13, s27
    s_mov_b32 s14, 6291456
    s_add_u32 s90, s92, 5242880
    buffer_load_dword v22, v24, s[12:15], s90 offen
    s_mov_b32 s12, s32
    s_mov_b32 s13, s33
    s_mov_b32 s14, 2097152
    s_add_u32 s90, s92, 1048576
    buffer_load_dword v22, v24, s[12:15], s90 offen
    s_branch m_nopf6
concat_heads__sliding_local_dilated__compressed_kv_cla__prompt_kernel_end:
.section .rodata,"a"
.p2align 6
.amdhsa_kernel concat_heads__sliding_local_dilated__compressed_kv_cla__prompt_kernel
  .amdhsa_next_free_vgpr 512
  .amdhsa_next_free_sgpr 102
  .amdhsa_accum_offset 256
  .amdhsa_group_segment_fixed_size 0
  .amdhsa_kernarg_size 96
  .amdhsa_user_sgpr_count 2
  .amdhsa_user_sgpr_kernarg_segment_ptr 1
  .amdhsa_system_sgpr_workgroup_id_x 1
.end_amdhsa_kernel
```

```asm
; @launch grid=(256,1,1) block=(256,1,1) lds=163840
.amdgcn_target "amdgcn-amd-amdhsa--gfx950"
.text
.globl concat_heads__sliding_local_dilated__compressed_kv_cla__prompt_kernel
.p2align 8
.type concat_heads__sliding_local_dilated__compressed_kv_cla__prompt_kernel,@function
concat_heads__sliding_local_dilated__compressed_kv_cla__prompt_kernel:
    s_cmp_ge_u32 s2, 256
    s_cbranch_scc1 m_end1
    s_load_dwordx16 s[24:39], s[0:1], 0
    s_load_dwordx4 s[4:7], s[0:1], 80
    v_and_b32 v1, 63, v0
    v_lshrrev_b32 v24, 6, v0
    s_nop 0
    v_readfirstlane_b32 s16, v24
    s_lshr_b32 s68, s2, 3
    s_lshr_b32 s57, s16, 1
    s_and_b32 s58, s16, 1
    s_mov_b32 s43, 0x20000
    s_mov_b32 s47, 0x20000
    s_cmp_lt_u32 s68, 28
    s_cbranch_scc1 m_ncp2
    s_sub_u32 s91, s68, 28
    s_lshl_b32 s91, s91, 2
    s_add_u32 s91, s91, s16
    s_getpc_b64 s[8:9]
m_pc3:
    s_sub_u32 s8, s8, m_pc3-concat_heads__sliding_local_dilated__compressed_kv_cla__prompt_kernel
    s_subb_u32 s9, s9, 0
    s_lshl_b32 s90, s91, 13
    v_lshlrev_b32 v24, 7, v1
    v_add_u32 v24, s90, v24
    v_min_u32 v24, concat_heads__sliding_local_dilated__compressed_kv_cla__prompt_kernel_end-concat_heads__sliding_local_dilated__compressed_kv_cla__prompt_kernel-4, v24
    v_mov_b32 v25, s9
    v_add_co_u32 v24, vcc, s8, v24
    s_nop 1
    v_addc_co_u32 v25, vcc, 0, v25, vcc
    global_load_dword v22, v[24:25], off
m_ncp2:
    s_lshl_b32 s61, s16, 13
    s_add_u32 s62, s61, 98304
    s_cmp_ge_u32 s68, 16
    s_cbranch_scc1 m_typea4
    s_and_b32 s69, s68, 3
    s_and_b32 s90, s2, 1
    s_lshl_b32 s90, s90, 2
    s_add_u32 s69, s69, s90
    s_bfe_u32 s90, s2, 0x20001
    s_mul_i32 s90, s90, 4
    s_bfe_u32 s91, s68, 0x20002
    s_add_u32 s90, s90, s91
    s_mov_b32 s76, 8388608
    s_mov_b32 s78, 8192
    s_mov_b32 s81, 0
    s_mov_b32 s73, 4194304
    s_mov_b32 s77, 2048
    s_mov_b32 s82, 16
    s_lshl_b32 s80, s90, 9
    s_lshl_b32 s79, s69, 19
    s_lshl_b32 s88, s90, 4
    s_add_u32 s88, s88, s69
    s_lshl_b32 s88, s88, 3
    s_mov_b32 s83, 0
    s_mov_b32 s84, 1040356334
    s_lshl_b32 s91, s90, 1
    s_add_u32 s91, s91, s58
    s_lshl_b32 s91, s91, 19
    s_lshl_b32 s92, s69, 1
    s_add_u32 s92, s92, s57
    s_lshl_b32 s92, s92, 15
    s_add_u32 s85, s91, s92
    s_add_u32 s85, s85, 0
    s_mov_b32 s86, 1024
    s_mov_b32 s87, 4096
    s_branch m_go15
m_typea4:
    s_bfe_u32 s69, s68, 0x20002
    s_add_u32 s69, s69, 0
    s_and_b32 s90, s2, 7
    s_lshl_b32 s90, s90, 2
    s_and_b32 s91, s68, 3
    s_add_u32 s90, s90, s91
    s_cmp_lt_u32 s90, 16
    s_cselect_b32 s83, 0, 1
    s_mov_b32 s91, 33554432
    s_cselect_b32 s85, 16777216, s91
    s_mov_b32 s91, 8192
    s_cselect_b32 s86, 1024, s91
    s_mov_b32 s91, 1024
    s_cselect_b32 s87, 4096, s91
    s_mov_b32 s73, 2097152
    s_mov_b32 s77, 1024
    s_mov_b32 s82, 8
    s_mov_b32 s81, 0
    s_mov_b32 s76, 4194304
    s_mov_b32 s78, 8192
    s_mov_b32 s84, 0
    s_and_b32 s90, s90, 15
    s_lshl_b32 s80, s90, 9
    s_lshl_b32 s79, s69, 18
    s_lshl_b32 s91, s83, 2
    s_add_u32 s91, s91, s69
    s_cmp_ge_u32 s69, 4
    s_cselect_b32 s92, 508, 8
    s_add_u32 s91, s91, s92
    s_lshl_b32 s88, s90, 4
    s_add_u32 s88, s88, s91
    s_lshl_b32 s88, s88, 3
    s_lshl_b32 s91, s90, 1
    s_add_u32 s91, s91, s58
    s_lshl_b32 s91, s91, 19
    s_lshl_b32 s92, s69, 1
    s_add_u32 s92, s92, s57
    s_lshl_b32 s92, s92, 15
    s_add_u32 s85, s85, s91
    s_add_u32 s85, s85, s92
m_go15:
    s_mov_b32 s42, s73
    s_lshl_b32 s90, s77, 4
    s_lshl_b32 s90, s90, s81
    s_mov_b32 s48, s79
    s_mul_i32 s91, s90, 1
    s_add_u32 s49, s91, s79
    s_sub_u32 s49, s49, 2048
    s_mul_i32 s91, s90, 2
    s_add_u32 s50, s91, s79
    s_mul_i32 s91, s90, 3
    s_add_u32 s51, s91, s79
    s_sub_u32 s51, s51, 2048
    s_lshl_b32 s90, s58, 7
    s_add_u32 s90, s90, s57
    s_lshl_b32 s91, s16, 6
    s_cmp_eq_u32 s81, 1
    s_cselect_b32 s90, s90, s91
    v_lshrrev_b32 v24, 3, v1
    v_lshlrev_b32 v24, s81, v24
    v_add_u32 v24, s90, v24
    v_mul_lo_u32 v24, v24, s77
    v_lshrrev_b32 v25, 4, v1
    v_and_b32 v26, 7, v1
    v_xor_b32 v25, v25, v26
    v_lshl_add_u32 v16, v25, 4, v24
    v_xor_b32 v25, 4, v25
    v_lshl_add_u32 v17, v25, 4, v24
    s_lshl_b32 s90, s77, 3
    s_lshl_b32 s90, s90, s81
    s_sub_u32 s90, s90, 1024
    v_add_u32 v17, s90, v17
    s_mov_b32 s46, s76
    s_mov_b32 s52, s80
    s_lshl_b32 s90, s78, 2
    s_mul_i32 s91, s90, 1
    s_add_u32 s53, s91, s80
    s_sub_u32 s53, s53, 2048
    s_mul_i32 s91, s90, 2
    s_add_u32 s54, s91, s80
    s_mul_i32 s91, s90, 3
    s_add_u32 s55, s91, s80
    s_sub_u32 s55, s55, 2048
    s_lshl_b32 s56, s78, 6
    v_lshrrev_b32 v24, 5, v1
    s_lshl_b32 s90, s16, 4
    v_add_u32 v25, s90, v24
    v_mul_lo_u32 v25, v25, s78
    v_lshlrev_b32 v24, 1, v24
    v_and_b32 v26, 31, v1
    v_xor_b32 v24, v24, v26
    s_lshl_b32 s90, s78, 1
    s_sub_u32 s90, s90, 1024
    v_add_u32 v27, s90, v25
    v_xor_b32 v26, 0, v24
    v_lshl_add_u32 v18, v26, 4, v25
    v_xor_b32 v26, 4, v24
    v_lshl_add_u32 v19, v26, 4, v27
    v_xor_b32 v26, 8, v24
    v_lshl_add_u32 v20, v26, 4, v25
    v_xor_b32 v26, 12, v24
    v_lshl_add_u32 v21, v26, 4, v27
    s_cmp_eq_u32 s83, 0
    s_waitcnt lgkmcnt(0)
    s_cselect_b32 s44, s36, s38
    s_cselect_b32 s45, s37, s39
    s_cmp_lt_u32 s68, 16
    s_cselect_b32 s44, s34, s44
    s_cselect_b32 s45, s35, s45
    s_cselect_b32 s40, s30, s32
    s_cselect_b32 s41, s31, s33
    s_cmp_ge_u32 s68, 28
    s_cselect_b32 s70, 1, 0
    s_cbranch_scc1 m_pf7
m_nopf6:
    s_add_u32 m0, s61, 0
    s_nop 0
    buffer_load_dwordx4 v16, s[40:43], s48 offen offset:0 sc1 lds
    buffer_load_dwordx4 v17, s[40:43], s48 offen offset:1024 sc1 lds
    s_add_u32 s48, s48, 128
    buffer_load_dwordx4 v16, s[40:43], s49 offen offset:2048 sc1 lds
    buffer_load_dwordx4 v17, s[40:43], s49 offen offset:3072 sc1 lds
    s_add_u32 s49, s49, 128
    s_add_u32 m0, s61, 4096
    s_nop 0
    buffer_load_dwordx4 v16, s[40:43], s50 offen offset:0 sc1 lds
    buffer_load_dwordx4 v17, s[40:43], s50 offen offset:1024 sc1 lds
    s_add_u32 s50, s50, 128
    buffer_load_dwordx4 v16, s[40:43], s51 offen offset:2048 sc1 lds
    buffer_load_dwordx4 v17, s[40:43], s51 offen offset:3072 sc1 lds
    s_add_u32 s51, s51, 128
    s_add_u32 s61, s61, 32768
    s_cmp_ge_u32 s61, 98304
    s_cselect_b32 s90, 98304, 0
    s_sub_u32 s61, s61, s90
    s_add_u32 m0, s62, 0
    s_nop 0
    buffer_load_dwordx4 v18, s[44:47], s52 offen offset:0 sc1 lds
    buffer_load_dwordx4 v19, s[44:47], s52 offen offset:1024 sc1 lds
    s_add_u32 s52, s52, s56
    buffer_load_dwordx4 v18, s[44:47], s53 offen offset:2048 sc1 lds
    buffer_load_dwordx4 v19, s[44:47], s53 offen offset:3072 sc1 lds
    s_add_u32 s53, s53, s56
    s_add_u32 m0, s62, 4096
    s_nop 0
    buffer_load_dwordx4 v20, s[44:47], s54 offen offset:0 sc1 lds
    buffer_load_dwordx4 v21, s[44:47], s54 offen offset:1024 sc1 lds
    s_add_u32 s54, s54, s56
    buffer_load_dwordx4 v20, s[44:47], s55 offen offset:2048 sc1 lds
    buffer_load_dwordx4 v21, s[44:47], s55 offen offset:3072 sc1 lds
    s_add_u32 s55, s55, s56
    s_xor_b32 s62, s62, 229376
    s_mov_b32 s95, s82
    s_mov_b32 s96, s83
    s_mov_b32 s97, s84
    s_mov_b32 s98, s85
    s_mov_b32 s99, s86
    s_mov_b32 s100, s87
    s_mov_b32 s101, s88
    v_and_b32 v24, 15, v1
    v_lshrrev_b32 v25, 4, v1
    v_bfe_u32 v26, v1, 1, 3
    v_xor_b32 v26, v26, v25
    s_lshl_b32 s90, s57, 14
    v_lshlrev_b32 v27, 7, v24
    v_add_u32 v27, s90, v27
    v_xor_b32 v28, 0, v26
    v_lshl_add_u32 v6, v28, 4, v27
    v_xor_b32 v28, 4, v26
    v_lshl_add_u32 v7, v28, 4, v27
    v_bfe_u32 v26, v1, 2, 2
    v_lshl_add_u32 v27, v25, 3, v26
    v_lshlrev_b32 v27, 9, v27
    v_and_b32 v28, 3, v1
    v_lshlrev_b32 v28, 3, v28
    v_add_u32 v27, v27, v28
    s_lshl_b32 s90, s58, 8
    s_add_u32 s90, s90, 98304
    v_add_u32 v27, s90, v27
    v_bfe_u32 v26, v1, 2, 3
    v_xor_b32 v28, 0, v26
    v_lshl_add_u32 v8, v28, 5, v27
    v_xor_b32 v28, 1, v26
    v_lshl_add_u32 v9, v28, 5, v27
    v_xor_b32 v28, 2, v26
    v_lshl_add_u32 v10, v28, 5, v27
    v_xor_b32 v28, 3, v26
    v_lshl_add_u32 v11, v28, 5, v27
    v_xor_b32 v28, 4, v26
    v_lshl_add_u32 v12, v28, 5, v27
    v_xor_b32 v28, 5, v26
    v_lshl_add_u32 v13, v28, 5, v27
    v_xor_b32 v28, 6, v26
    v_lshl_add_u32 v14, v28, 5, v27
    v_xor_b32 v28, 7, v26
    v_lshl_add_u32 v15, v28, 5, v27
    v_lshlrev_b32 v2, 4, v1
    s_mov_b32 s64, 0
    s_mov_b32 s59, 32768
    s_mov_b32 s60, 229376
    s_mov_b32 s8, s6
    s_mov_b32 s9, s7
    s_mov_b32 s10, 268435456
    s_mov_b32 s11, 0x20000
    s_cmp_ge_u32 s68, 16
    s_cbranch_scc1 m_typea8
    s_bfe_u32 s69, s68, 0x20002
    s_add_u32 s69, s69, 4
    s_and_b32 s90, s2, 7
    s_lshl_b32 s90, s90, 2
    s_and_b32 s91, s68, 3
    s_add_u32 s90, s90, s91
    s_cmp_lt_u32 s90, 16
    s_cselect_b32 s83, 0, 1
    s_mov_b32 s91, 33554432
    s_cselect_b32 s85, 16777216, s91
    s_mov_b32 s91, 8192
    s_cselect_b32 s86, 1024, s91
    s_mov_b32 s91, 1024
    s_cselect_b32 s87, 4096, s91
    s_cselect_b32 s74, s36, s38
    s_cselect_b32 s75, s37, s39
    s_mov_b32 s71, s32
    s_mov_b32 s72, s33
    s_mov_b32 s73, 2097152
    s_mov_b32 s77, 1024
    s_mov_b32 s82, 8
    s_mov_b32 s81, 0
    s_mov_b32 s76, 4194304
    s_mov_b32 s78, 8192
    s_mov_b32 s84, 0
    s_and_b32 s90, s90, 15
    s_lshl_b32 s80, s90, 9
    s_lshl_b32 s79, s69, 18
    s_lshl_b32 s91, s83, 2
    s_add_u32 s91, s91, s69
    s_cmp_ge_u32 s69, 4
    s_cselect_b32 s92, 508, 8
    s_add_u32 s91, s91, s92
    s_lshl_b32 s88, s90, 4
    s_add_u32 s88, s88, s91
    s_lshl_b32 s88, s88, 3
    s_lshl_b32 s91, s90, 1
    s_add_u32 s91, s91, s58
    s_lshl_b32 s91, s91, 19
    s_lshl_b32 s92, s69, 1
    s_add_u32 s92, s92, s57
    s_lshl_b32 s92, s92, 15
    s_add_u32 s85, s85, s91
    s_add_u32 s85, s85, s92
    s_branch m_go29
m_typea8:
    s_and_b32 s69, s68, 3
    s_and_b32 s90, s2, 1
    s_lshl_b32 s90, s90, 2
    s_add_u32 s69, s69, s90
    s_bfe_u32 s90, s2, 0x20001
    s_mul_i32 s90, s90, 3
    s_bfe_u32 s91, s68, 0x20002
    s_add_u32 s90, s90, s91
    s_mov_b32 s76, 6291456
    s_mov_b32 s78, 6144
    s_mov_b32 s81, 1
    s_mov_b32 s73, 4194304
    s_mov_b32 s77, 2048
    s_mov_b32 s82, 16
    s_lshl_b32 s80, s90, 9
    s_lshl_b32 s79, s69, 19
    s_and_b32 s92, s90, 3
    s_lshr_b32 s91, s90, 2
    s_lshl_b32 s88, s92, 2
    s_add_u32 s88, s88, s91
    s_lshl_b32 s88, s88, 3
    s_add_u32 s88, s88, s69
    s_lshl_b32 s88, s88, 3
    s_add_u32 s88, s88, 6144
    s_cmp_eq_u32 s91, 0
    s_cselect_b32 s84, 1048744942, 0
    s_lshl_b32 s93, s91, 22
    s_add_u32 s85, s93, 50331648
    s_lshl_b32 s92, s92, 1
    s_add_u32 s92, s92, s58
    s_lshl_b32 s92, s92, 19
    s_add_u32 s85, s85, s92
    s_lshl_b32 s92, s57, 3
    s_add_u32 s92, s92, s69
    s_cmp_eq_u32 s91, 2
    s_cselect_b32 s83, 1, 0
    s_cselect_b32 s93, 12, 13
    s_mov_b32 s91, 131072
    s_cselect_b32 s86, 1024, s91
    s_mov_b32 s91, 1024
    s_cselect_b32 s87, 65536, s91
    s_lshl_b32 s92, s92, s93
    s_add_u32 s85, s85, s92
    s_mov_b32 s71, s24
    s_mov_b32 s72, s25
    s_mov_b32 s74, s26
    s_mov_b32 s75, s27
m_go29:
    s_xor_b32 s94, s70, 1
    s_mov_b32 s67, 3
    s_mov_b32 s17, -1
    s_mov_b32 s12, s4
    s_mov_b32 s13, s5
    s_mov_b32 s14, 256
    s_mov_b32 s15, 0x20000
    s_lshl_b32 s90, s2, 2
    s_add_u32 s90, s90, s16
    s_cmp_lg_u32 s90, 0
    s_cbranch_scc1 m_tok10
    s_memrealtime s[92:93]
    s_waitcnt lgkmcnt(0)
    s_or_b32 s92, s92, 1
    v_mov_b32 v4, s92
    v_mov_b32 v5, s93
    s_mov_b64 exec, 1
    buffer_store_dwordx2 v[4:5], off, s[12:15], 0 sc1
    s_mov_b64 exec, -1
m_tok10:
    s_add_u32 m0, s61, 0
    s_nop 0
    buffer_load_dwordx4 v16, s[40:43], s48 offen offset:0 sc1 lds
    buffer_load_dwordx4 v17, s[40:43], s48 offen offset:1024 sc1 lds
    s_add_u32 s48, s48, 128
    buffer_load_dwordx4 v16, s[40:43], s49 offen offset:2048 sc1 lds
    buffer_load_dwordx4 v17, s[40:43], s49 offen offset:3072 sc1 lds
    s_add_u32 s49, s49, 128
    s_add_u32 m0, s61, 4096
    s_nop 0
    buffer_load_dwordx4 v16, s[40:43], s50 offen offset:0 sc1 lds
    buffer_load_dwordx4 v17, s[40:43], s50 offen offset:1024 sc1 lds
    s_add_u32 s50, s50, 128
    buffer_load_dwordx4 v16, s[40:43], s51 offen offset:2048 sc1 lds
    buffer_load_dwordx4 v17, s[40:43], s51 offen offset:3072 sc1 lds
    s_add_u32 s51, s51, 128
    s_add_u32 s61, s61, 32768
    s_cmp_ge_u32 s61, 98304
    s_cselect_b32 s90, 98304, 0
    s_sub_u32 s61, s61, s90
    s_add_u32 m0, s62, 0
    s_nop 0
    buffer_load_dwordx4 v18, s[44:47], s52 offen offset:0 sc1 lds
    buffer_load_dwordx4 v19, s[44:47], s52 offen offset:1024 sc1 lds
    s_add_u32 s52, s52, s56
    buffer_load_dwordx4 v18, s[44:47], s53 offen offset:2048 sc1 lds
    buffer_load_dwordx4 v19, s[44:47], s53 offen offset:3072 sc1 lds
    s_add_u32 s53, s53, s56
    s_add_u32 m0, s62, 4096
    s_nop 0
    buffer_load_dwordx4 v20, s[44:47], s54 offen offset:0 sc1 lds
    buffer_load_dwordx4 v21, s[44:47], s54 offen offset:1024 sc1 lds
    s_add_u32 s54, s54, s56
    buffer_load_dwordx4 v20, s[44:47], s55 offen offset:2048 sc1 lds
    buffer_load_dwordx4 v21, s[44:47], s55 offen offset:3072 sc1 lds
    s_add_u32 s55, s55, s56
    s_xor_b32 s62, s62, 229376
    s_waitcnt vmcnt(16)
    s_barrier
    ds_read_b64_tr_b16 a[64:65], v8 offset:0
    ds_read_b64_tr_b16 a[66:67], v8 offset:2048
    ds_read_b64_tr_b16 a[68:69], v8 offset:16384
    ds_read_b64_tr_b16 a[70:71], v8 offset:18432
    ds_read_b64_tr_b16 a[72:73], v9 offset:0
    ds_read_b64_tr_b16 a[74:75], v9 offset:2048
    ds_read_b64_tr_b16 a[76:77], v9 offset:16384
    ds_read_b64_tr_b16 a[78:79], v9 offset:18432
    ds_read_b64_tr_b16 a[80:81], v10 offset:0
    ds_read_b64_tr_b16 a[82:83], v10 offset:2048
    ds_read_b64_tr_b16 a[84:85], v10 offset:16384
    ds_read_b64_tr_b16 a[86:87], v10 offset:18432
    ds_read_b64_tr_b16 a[88:89], v11 offset:0
    ds_read_b64_tr_b16 a[90:91], v11 offset:2048
    ds_read_b64_tr_b16 a[92:93], v11 offset:16384
    ds_read_b64_tr_b16 a[94:95], v11 offset:18432
    ds_read_b64_tr_b16 a[96:97], v12 offset:0
    ds_read_b128 a[0:3], v6 offset:0
    ds_read_b128 a[4:7], v7 offset:0
    ds_read_b64_tr_b16 a[98:99], v12 offset:2048
    ds_read_b128 a[8:11], v6 offset:2048
    ds_read_b128 a[12:15], v7 offset:2048
    ds_read_b64_tr_b16 a[100:101], v12 offset:16384
    ds_read_b128 a[16:19], v6 offset:4096
    ds_read_b128 a[20:23], v7 offset:4096
    ds_read_b64_tr_b16 a[102:103], v12 offset:18432
    ds_read_b128 a[24:27], v6 offset:6144
    ds_read_b128 a[28:31], v7 offset:6144
    ds_read_b64_tr_b16 a[104:105], v13 offset:0
    ds_read_b128 a[32:35], v6 offset:8192
    ds_read_b128 a[36:39], v7 offset:8192
    ds_read_b64_tr_b16 a[106:107], v13 offset:2048
    ds_read_b128 a[40:43], v6 offset:10240
    ds_read_b128 a[44:47], v7 offset:10240
    ds_read_b64_tr_b16 a[108:109], v13 offset:16384
    ds_read_b128 a[48:51], v6 offset:12288
    ds_read_b128 a[52:55], v7 offset:12288
    ds_read_b64_tr_b16 a[110:111], v13 offset:18432
    ds_read_b128 a[56:59], v6 offset:14336
    ds_read_b128 a[60:63], v7 offset:14336
    s_add_u32 m0, s61, 0
    s_nop 0
    buffer_load_dwordx4 v16, s[40:43], s48 offen offset:0 sc1 lds
    buffer_load_dwordx4 v17, s[40:43], s48 offen offset:1024 sc1 lds
    s_add_u32 s48, s48, 128
    buffer_load_dwordx4 v16, s[40:43], s49 offen offset:2048 sc1 lds
    buffer_load_dwordx4 v17, s[40:43], s49 offen offset:3072 sc1 lds
    s_add_u32 s49, s49, 128
    s_add_u32 m0, s61, 4096
    s_nop 0
    buffer_load_dwordx4 v16, s[40:43], s50 offen offset:0 sc1 lds
    buffer_load_dwordx4 v17, s[40:43], s50 offen offset:1024 sc1 lds
    s_add_u32 s50, s50, 128
    buffer_load_dwordx4 v16, s[40:43], s51 offen offset:2048 sc1 lds
    buffer_load_dwordx4 v17, s[40:43], s51 offen offset:3072 sc1 lds
    s_add_u32 s51, s51, 128
    s_add_u32 s61, s61, 32768
    s_cmp_ge_u32 s61, 98304
    s_cselect_b32 s90, 98304, 0
    s_sub_u32 s61, s61, s90
    s_mov_b32 s66, 1
    s_mov_b32 s24, s6
    s_mov_b32 s25, s7
    s_mov_b32 s26, 0
    s_mov_b32 s27, 0x20000
    s_mov_b32 s28, 0
    s_mov_b32 s29, 0
    s_mov_b32 s30, 0
    s_mov_b32 s31, 0
m_tile11:
    s_mov_b32 s65, s95
    s_cmp_eq_u32 s96, 1
    s_cbranch_scc1 m_swp13
    s_waitcnt lgkmcnt(15)
    v_mfma_f32_16x16x32_bf16 v[32:35], a[64:67], a[0:3], 0
    ds_read_b64_tr_b16 a[112:113], v14 offset:0
    v_mfma_f32_16x16x32_bf16 v[32:35], a[68:71], a[4:7], v[32:35]
    ds_read_b64_tr_b16 a[114:115], v14 offset:2048
    v_mfma_f32_16x16x32_bf16 v[36:39], a[76:79], a[4:7], 0
    ds_read_b64_tr_b16 a[116:117], v14 offset:16384
    v_mfma_f32_16x16x32_bf16 v[36:39], a[72:75], a[0:3], v[36:39]
    ds_read_b64_tr_b16 a[118:119], v14 offset:18432
    v_mfma_f32_16x16x32_bf16 v[44:47], a[72:75], a[8:11], 0
    ds_read_b64_tr_b16 a[120:121], v15 offset:0
    v_mfma_f32_16x16x32_bf16 v[44:47], a[76:79], a[12:15], v[44:47]
    ds_read_b64_tr_b16 a[122:123], v15 offset:2048
    v_mfma_f32_16x16x32_bf16 v[40:43], a[68:71], a[12:15], 0
    ds_read_b64_tr_b16 a[124:125], v15 offset:16384
    v_mfma_f32_16x16x32_bf16 v[40:43], a[64:67], a[8:11], v[40:43]
    ds_read_b64_tr_b16 a[126:127], v15 offset:18432
    v_mfma_f32_16x16x32_bf16 v[48:51], a[64:67], a[16:19], 0
    v_mfma_f32_16x16x32_bf16 v[48:51], a[68:71], a[20:23], v[48:51]
    v_mfma_f32_16x16x32_bf16 v[52:55], a[76:79], a[20:23], 0
    buffer_store_dwordx4 a[128:131], v2, s[24:27], s28 offen sc1
    v_mfma_f32_16x16x32_bf16 v[52:55], a[72:75], a[16:19], v[52:55]
    s_add_u32 s28, s28, s31
    s_waitcnt lgkmcnt(15)
    v_mfma_f32_16x16x32_bf16 v[60:63], a[72:75], a[24:27], 0
    v_xor_b32 v8, s60, v8
    v_xor_b32 v9, s60, v9
    v_mfma_f32_16x16x32_bf16 v[60:63], a[76:79], a[28:31], v[60:63]
    v_xor_b32 v10, s60, v10
    v_xor_b32 v11, s60, v11
    v_mfma_f32_16x16x32_bf16 v[56:59], a[68:71], a[28:31], 0
    v_xor_b32 v12, s60, v12
    v_xor_b32 v13, s60, v13
    v_mfma_f32_16x16x32_bf16 v[56:59], a[64:67], a[24:27], v[56:59]
    v_xor_b32 v14, s60, v14
    v_xor_b32 v15, s60, v15
    v_mfma_f32_16x16x32_bf16 v[64:67], a[64:67], a[32:35], 0
    buffer_store_dwordx4 a[132:135], v2, s[24:27], s28 offen sc1
    v_mfma_f32_16x16x32_bf16 v[64:67], a[68:71], a[36:39], v[64:67]
    s_add_u32 s28, s28, s31
    v_mfma_f32_16x16x32_bf16 v[68:71], a[76:79], a[36:39], 0
    v_mfma_f32_16x16x32_bf16 v[68:71], a[72:75], a[32:35], v[68:71]
    s_waitcnt lgkmcnt(14)
    v_mfma_f32_16x16x32_bf16 v[76:79], a[72:75], a[40:43], 0
    v_mfma_f32_16x16x32_bf16 v[76:79], a[76:79], a[44:47], v[76:79]
    v_mfma_f32_16x16x32_bf16 v[72:75], a[68:71], a[44:47], 0
    buffer_store_dwordx4 a[136:139], v2, s[24:27], s28 offen sc1
    v_mfma_f32_16x16x32_bf16 v[72:75], a[64:67], a[40:43], v[72:75]
    s_add_u32 s28, s28, s31
    s_waitcnt lgkmcnt(11)
    v_mfma_f32_16x16x32_bf16 v[80:83], a[64:67], a[48:51], 0
    v_mfma_f32_16x16x32_bf16 v[80:83], a[68:71], a[52:55], v[80:83]
    v_mfma_f32_16x16x32_bf16 v[84:87], a[76:79], a[52:55], 0
    v_mfma_f32_16x16x32_bf16 v[84:87], a[72:75], a[48:51], v[84:87]
    s_waitcnt lgkmcnt(8)
    v_mfma_f32_16x16x32_bf16 v[92:95], a[72:75], a[56:59], 0
    buffer_store_dwordx4 a[140:143], v2, s[24:27], s28 offen sc1
    v_mfma_f32_16x16x32_bf16 v[92:95], a[76:79], a[60:63], v[92:95]
    s_add_u32 s28, s28, s31
    v_mfma_f32_16x16x32_bf16 v[88:91], a[68:71], a[60:63], 0
    s_waitcnt vmcnt(12) lgkmcnt(0)
    v_mfma_f32_16x16x32_bf16 v[88:91], a[64:67], a[56:59], v[88:91]
    s_barrier
    v_mfma_f32_16x16x32_bf16 v[96:99], a[80:83], a[0:3], 0
    ds_read_b64_tr_b16 a[64:65], v8 offset:0
    v_mfma_f32_16x16x32_bf16 v[96:99], a[84:87], a[4:7], v[96:99]
    s_add_u32 m0, s62, 0
    v_mfma_f32_16x16x32_bf16 v[100:103], a[92:95], a[4:7], 0
    buffer_load_dwordx4 v18, s[44:47], s52 offen offset:0 sc1 lds
    v_mfma_f32_16x16x32_bf16 v[100:103], a[88:91], a[0:3], v[100:103]
    ds_read_b64_tr_b16 a[66:67], v8 offset:2048
    v_mfma_f32_16x16x32_bf16 v[108:111], a[88:91], a[8:11], 0
    s_add_u32 s64, s64, 32768
    v_mfma_f32_16x16x32_bf16 v[108:111], a[92:95], a[12:15], v[108:111]
    s_cmp_ge_u32 s64, 98304
    s_cselect_b32 s63, 4294901760, s59
    s_cselect_b32 s64, 0, s64
    v_mfma_f32_16x16x32_bf16 v[104:107], a[84:87], a[12:15], 0
    buffer_load_dwordx4 v19, s[44:47], s52 offen offset:1024 sc1 lds
    v_mfma_f32_16x16x32_bf16 v[104:107], a[80:83], a[8:11], v[104:107]
    s_add_u32 s52, s52, s56
    ds_read_b64_tr_b16 a[68:69], v8 offset:16384
    v_mfma_f32_16x16x32_bf16 v[112:115], a[80:83], a[16:19], 0
    v_mfma_f32_16x16x32_bf16 v[112:115], a[84:87], a[20:23], v[112:115]
    v_mfma_f32_16x16x32_bf16 v[116:119], a[92:95], a[20:23], 0
    buffer_load_dwordx4 v18, s[44:47], s53 offen offset:2048 sc1 lds
    v_mfma_f32_16x16x32_bf16 v[116:119], a[88:91], a[16:19], v[116:119]
    ds_read_b64_tr_b16 a[70:71], v8 offset:18432
    v_mfma_f32_16x16x32_bf16 v[124:127], a[88:91], a[24:27], 0
    v_mfma_f32_16x16x32_bf16 v[124:127], a[92:95], a[28:31], v[124:127]
    v_mfma_f32_16x16x32_bf16 v[120:123], a[84:87], a[28:31], 0
    buffer_load_dwordx4 v19, s[44:47], s53 offen offset:3072 sc1 lds
    v_mfma_f32_16x16x32_bf16 v[120:123], a[80:83], a[24:27], v[120:123]
    s_add_u32 s53, s53, s56
    ds_read_b64_tr_b16 a[72:73], v9 offset:0
    v_mfma_f32_16x16x32_bf16 v[128:131], a[80:83], a[32:35], 0
    v_mfma_f32_16x16x32_bf16 v[128:131], a[84:87], a[36:39], v[128:131]
    s_add_u32 m0, s62, 4096
    v_mfma_f32_16x16x32_bf16 v[132:135], a[92:95], a[36:39], 0
    buffer_load_dwordx4 v20, s[44:47], s54 offen offset:0 sc1 lds
    v_mfma_f32_16x16x32_bf16 v[132:135], a[88:91], a[32:35], v[132:135]
    s_xor_b32 s62, s62, 229376
    ds_read_b64_tr_b16 a[74:75], v9 offset:2048
    v_mfma_f32_16x16x32_bf16 v[140:143], a[88:91], a[40:43], 0
    v_mfma_f32_16x16x32_bf16 v[140:143], a[92:95], a[44:47], v[140:143]
    v_mfma_f32_16x16x32_bf16 v[136:139], a[84:87], a[44:47], 0
    buffer_load_dwordx4 v21, s[44:47], s54 offen offset:1024 sc1 lds
    v_mfma_f32_16x16x32_bf16 v[136:139], a[80:83], a[40:43], v[136:139]
    s_add_u32 s54, s54, s56
    ds_read_b64_tr_b16 a[76:77], v9 offset:16384
    v_mfma_f32_16x16x32_bf16 v[144:147], a[80:83], a[48:51], 0
    v_mfma_f32_16x16x32_bf16 v[144:147], a[84:87], a[52:55], v[144:147]
    v_mfma_f32_16x16x32_bf16 v[148:151], a[92:95], a[52:55], 0
    buffer_load_dwordx4 v20, s[44:47], s55 offen offset:2048 sc1 lds
    v_mfma_f32_16x16x32_bf16 v[148:151], a[88:91], a[48:51], v[148:151]
    ds_read_b64_tr_b16 a[78:79], v9 offset:18432
    v_mfma_f32_16x16x32_bf16 v[156:159], a[88:91], a[56:59], 0
    v_add_u32 v6, s63, v6
    v_add_u32 v7, s63, v7
    v_mfma_f32_16x16x32_bf16 v[156:159], a[92:95], a[60:63], v[156:159]
    v_mfma_f32_16x16x32_bf16 v[152:155], a[84:87], a[60:63], 0
    buffer_load_dwordx4 v21, s[44:47], s55 offen offset:3072 sc1 lds
    v_mfma_f32_16x16x32_bf16 v[152:155], a[80:83], a[56:59], v[152:155]
    s_add_u32 s55, s55, s56
    v_mfma_f32_16x16x32_bf16 v[160:163], a[96:99], a[0:3], 0
    ds_read_b64_tr_b16 a[80:81], v10 offset:0
    v_mfma_f32_16x16x32_bf16 v[160:163], a[100:103], a[4:7], v[160:163]
    v_mfma_f32_16x16x32_bf16 v[164:167], a[108:111], a[4:7], 0
    v_mfma_f32_16x16x32_bf16 v[164:167], a[104:107], a[0:3], v[164:167]
    s_add_u32 m0, s61, 0
    ds_read_b64_tr_b16 a[82:83], v10 offset:2048
    v_mfma_f32_16x16x32_bf16 v[172:175], a[104:107], a[8:11], 0
    buffer_load_dwordx4 v16, s[40:43], s48 offen offset:0 sc1 lds
    v_mfma_f32_16x16x32_bf16 v[172:175], a[108:111], a[12:15], v[172:175]
    v_mfma_f32_16x16x32_bf16 v[168:171], a[100:103], a[12:15], 0
    ds_read_b64_tr_b16 a[84:85], v10 offset:16384
    v_mfma_f32_16x16x32_bf16 v[168:171], a[96:99], a[8:11], v[168:171]
    v_mfma_f32_16x16x32_bf16 v[176:179], a[96:99], a[16:19], 0
    buffer_store_dwordx4 a[144:147], v2, s[24:27], s28 offen sc1
    v_mfma_f32_16x16x32_bf16 v[176:179], a[100:103], a[20:23], v[176:179]
    s_add_u32 s28, s28, s31
    ds_read_b64_tr_b16 a[86:87], v10 offset:18432
    v_mfma_f32_16x16x32_bf16 v[180:183], a[108:111], a[20:23], 0
    v_mfma_f32_16x16x32_bf16 v[180:183], a[104:107], a[16:19], v[180:183]
    v_mfma_f32_16x16x32_bf16 v[188:191], a[104:107], a[24:27], 0
    buffer_load_dwordx4 v17, s[40:43], s48 offen offset:1024 sc1 lds
    v_mfma_f32_16x16x32_bf16 v[188:191], a[108:111], a[28:31], v[188:191]
    s_add_u32 s48, s48, 128
    ds_read_b64_tr_b16 a[88:89], v11 offset:0
    v_mfma_f32_16x16x32_bf16 v[184:187], a[100:103], a[28:31], 0
    v_mfma_f32_16x16x32_bf16 v[184:187], a[96:99], a[24:27], v[184:187]
    v_mfma_f32_16x16x32_bf16 v[192:195], a[96:99], a[32:35], 0
    buffer_store_dwordx4 a[148:151], v2, s[24:27], s28 offen sc1
    v_mfma_f32_16x16x32_bf16 v[192:195], a[100:103], a[36:39], v[192:195]
    s_add_u32 s28, s28, s31
    ds_read_b64_tr_b16 a[90:91], v11 offset:2048
    v_mfma_f32_16x16x32_bf16 v[196:199], a[108:111], a[36:39], 0
    v_mfma_f32_16x16x32_bf16 v[196:199], a[104:107], a[32:35], v[196:199]
    v_mfma_f32_16x16x32_bf16 v[204:207], a[104:107], a[40:43], 0
    buffer_load_dwordx4 v16, s[40:43], s49 offen offset:2048 sc1 lds
    v_mfma_f32_16x16x32_bf16 v[204:207], a[108:111], a[44:47], v[204:207]
    ds_read_b64_tr_b16 a[92:93], v11 offset:16384
    v_mfma_f32_16x16x32_bf16 v[200:203], a[100:103], a[44:47], 0
    v_mfma_f32_16x16x32_bf16 v[200:203], a[96:99], a[40:43], v[200:203]
    v_mfma_f32_16x16x32_bf16 v[208:211], a[96:99], a[48:51], 0
    buffer_store_dwordx4 a[152:155], v2, s[24:27], s28 offen sc1
    v_mfma_f32_16x16x32_bf16 v[208:211], a[100:103], a[52:55], v[208:211]
    s_add_u32 s28, s28, s31
    ds_read_b64_tr_b16 a[94:95], v11 offset:18432
    v_mfma_f32_16x16x32_bf16 v[212:215], a[108:111], a[52:55], 0
    v_mfma_f32_16x16x32_bf16 v[212:215], a[104:107], a[48:51], v[212:215]
    v_mfma_f32_16x16x32_bf16 v[220:223], a[104:107], a[56:59], 0
    buffer_load_dwordx4 v17, s[40:43], s49 offen offset:3072 sc1 lds
    v_mfma_f32_16x16x32_bf16 v[220:223], a[108:111], a[60:63], v[220:223]
    s_add_u32 s49, s49, 128
    v_mfma_f32_16x16x32_bf16 v[216:219], a[100:103], a[60:63], 0
    buffer_store_dwordx4 a[156:159], v2, s[24:27], s28 offen sc1
    v_mfma_f32_16x16x32_bf16 v[216:219], a[96:99], a[56:59], v[216:219]
    s_add_u32 s29, s29, s30
    s_mov_b32 s28, s29
    v_mfma_f32_16x16x32_bf16 v[224:227], a[112:115], a[0:3], 0
    v_mfma_f32_16x16x32_bf16 v[224:227], a[116:119], a[4:7], v[224:227]
    ds_read_b64_tr_b16 a[96:97], v12 offset:0
    v_mfma_f32_16x16x32_bf16 v[228:231], a[124:127], a[4:7], 0
    v_mfma_f32_16x16x32_bf16 v[228:231], a[120:123], a[0:3], v[228:231]
    s_add_u32 m0, s61, 4096
    ds_read_b128 a[0:3], v6 offset:0
    v_mfma_f32_16x16x32_bf16 v[236:239], a[120:123], a[8:11], 0
    buffer_load_dwordx4 v16, s[40:43], s50 offen offset:0 sc1 lds
    v_mfma_f32_16x16x32_bf16 v[236:239], a[124:127], a[12:15], v[236:239]
    s_add_u32 s61, s61, 32768
    ds_read_b128 a[4:7], v7 offset:0
    v_mfma_f32_16x16x32_bf16 v[232:235], a[116:119], a[12:15], 0
    s_cmp_ge_u32 s61, 98304
    s_cselect_b32 s90, 98304, 0
    ds_read_b64_tr_b16 a[98:99], v12 offset:2048
    v_mfma_f32_16x16x32_bf16 v[232:235], a[112:115], a[8:11], v[232:235]
    s_sub_u32 s61, s61, s90
    ds_read_b128 a[8:11], v6 offset:2048
    v_mfma_f32_16x16x32_bf16 v[240:243], a[112:115], a[16:19], 0
    ds_read_b128 a[12:15], v7 offset:2048
    v_mfma_f32_16x16x32_bf16 v[240:243], a[116:119], a[20:23], v[240:243]
    ds_read_b64_tr_b16 a[100:101], v12 offset:16384
    v_mfma_f32_16x16x32_bf16 v[244:247], a[124:127], a[20:23], 0
    v_mfma_f32_16x16x32_bf16 v[244:247], a[120:123], a[16:19], v[244:247]
    ds_read_b128 a[16:19], v6 offset:4096
    v_mfma_f32_16x16x32_bf16 v[252:255], a[120:123], a[24:27], 0
    buffer_load_dwordx4 v17, s[40:43], s50 offen offset:1024 sc1 lds
    v_mfma_f32_16x16x32_bf16 v[252:255], a[124:127], a[28:31], v[252:255]
    s_add_u32 s50, s50, 128
    ds_read_b128 a[20:23], v7 offset:4096
    v_mfma_f32_16x16x32_bf16 v[248:251], a[116:119], a[28:31], 0
    ds_read_b64_tr_b16 a[102:103], v12 offset:18432
    v_mfma_f32_16x16x32_bf16 v[248:251], a[112:115], a[24:27], v[248:251]
    ds_read_b128 a[24:27], v6 offset:6144
    v_mfma_f32_16x16x32_bf16 a[224:227], a[112:115], a[32:35], 0
    s_sub_u32 s65, s65, 1
    ds_read_b128 a[28:31], v7 offset:6144
    v_mfma_f32_16x16x32_bf16 a[224:227], a[116:119], a[36:39], a[224:227]
    ds_read_b64_tr_b16 a[104:105], v13 offset:0
    v_mfma_f32_16x16x32_bf16 a[228:231], a[124:127], a[36:39], 0
    v_mfma_f32_16x16x32_bf16 a[228:231], a[120:123], a[32:35], a[228:231]
    ds_read_b128 a[32:35], v6 offset:8192
    v_mfma_f32_16x16x32_bf16 a[236:239], a[120:123], a[40:43], 0
    buffer_load_dwordx4 v16, s[40:43], s51 offen offset:2048 sc1 lds
    v_mfma_f32_16x16x32_bf16 a[236:239], a[124:127], a[44:47], a[236:239]
    ds_read_b128 a[36:39], v7 offset:8192
    v_mfma_f32_16x16x32_bf16 a[232:235], a[116:119], a[44:47], 0
    ds_read_b64_tr_b16 a[106:107], v13 offset:2048
    v_mfma_f32_16x16x32_bf16 a[232:235], a[112:115], a[40:43], a[232:235]
    ds_read_b128 a[40:43], v6 offset:10240
    v_mfma_f32_16x16x32_bf16 a[240:243], a[112:115], a[48:51], 0
    ds_read_b128 a[44:47], v7 offset:10240
    v_mfma_f32_16x16x32_bf16 a[240:243], a[116:119], a[52:55], a[240:243]
    ds_read_b64_tr_b16 a[108:109], v13 offset:16384
    v_mfma_f32_16x16x32_bf16 a[244:247], a[124:127], a[52:55], 0
    v_mfma_f32_16x16x32_bf16 a[244:247], a[120:123], a[48:51], a[244:247]
    ds_read_b128 a[48:51], v6 offset:12288
    v_mfma_f32_16x16x32_bf16 a[252:255], a[120:123], a[56:59], 0
    buffer_load_dwordx4 v17, s[40:43], s51 offen offset:3072 sc1 lds
    v_mfma_f32_16x16x32_bf16 a[252:255], a[124:127], a[60:63], a[252:255]
    s_add_u32 s51, s51, 128
    ds_read_b128 a[52:55], v7 offset:12288
    v_mfma_f32_16x16x32_bf16 a[248:251], a[116:119], a[60:63], 0
    ds_read_b64_tr_b16 a[110:111], v13 offset:18432
    v_mfma_f32_16x16x32_bf16 a[248:251], a[112:115], a[56:59], a[248:251]
    ds_read_b128 a[56:59], v6 offset:14336
    ds_read_b128 a[60:63], v7 offset:14336
    s_waitcnt lgkmcnt(15)
    v_mfma_f32_16x16x32_bf16 v[32:35], a[64:67], a[0:3], v[32:35]
    ds_read_b64_tr_b16 a[112:113], v14 offset:0
    v_mfma_f32_16x16x32_bf16 v[32:35], a[68:71], a[4:7], v[32:35]
    ds_read_b64_tr_b16 a[114:115], v14 offset:2048
    v_mfma_f32_16x16x32_bf16 v[36:39], a[76:79], a[4:7], v[36:39]
    ds_read_b64_tr_b16 a[116:117], v14 offset:16384
    v_mfma_f32_16x16x32_bf16 v[36:39], a[72:75], a[0:3], v[36:39]
    ds_read_b64_tr_b16 a[118:119], v14 offset:18432
    v_mfma_f32_16x16x32_bf16 v[44:47], a[72:75], a[8:11], v[44:47]
    ds_read_b64_tr_b16 a[120:121], v15 offset:0
    v_mfma_f32_16x16x32_bf16 v[44:47], a[76:79], a[12:15], v[44:47]
    ds_read_b64_tr_b16 a[122:123], v15 offset:2048
    v_mfma_f32_16x16x32_bf16 v[40:43], a[68:71], a[12:15], v[40:43]
    ds_read_b64_tr_b16 a[124:125], v15 offset:16384
    v_mfma_f32_16x16x32_bf16 v[40:43], a[64:67], a[8:11], v[40:43]
    ds_read_b64_tr_b16 a[126:127], v15 offset:18432
    v_mfma_f32_16x16x32_bf16 v[48:51], a[64:67], a[16:19], v[48:51]
    v_mfma_f32_16x16x32_bf16 v[48:51], a[68:71], a[20:23], v[48:51]
    v_mfma_f32_16x16x32_bf16 v[52:55], a[76:79], a[20:23], v[52:55]
    buffer_store_dwordx4 a[160:163], v2, s[24:27], s28 offen sc1
    v_mfma_f32_16x16x32_bf16 v[52:55], a[72:75], a[16:19], v[52:55]
    s_add_u32 s28, s28, s31
    s_waitcnt lgkmcnt(15)
    v_mfma_f32_16x16x32_bf16 v[60:63], a[72:75], a[24:27], v[60:63]
    v_xor_b32 v8, s60, v8
    v_xor_b32 v9, s60, v9
    v_mfma_f32_16x16x32_bf16 v[60:63], a[76:79], a[28:31], v[60:63]
    v_xor_b32 v10, s60, v10
    v_xor_b32 v11, s60, v11
    v_mfma_f32_16x16x32_bf16 v[56:59], a[68:71], a[28:31], v[56:59]
    v_xor_b32 v12, s60, v12
    v_xor_b32 v13, s60, v13
    v_mfma_f32_16x16x32_bf16 v[56:59], a[64:67], a[24:27], v[56:59]
    v_xor_b32 v14, s60, v14
    v_xor_b32 v15, s60, v15
    v_mfma_f32_16x16x32_bf16 v[64:67], a[64:67], a[32:35], v[64:67]
    buffer_store_dwordx4 a[164:167], v2, s[24:27], s28 offen sc1
    v_mfma_f32_16x16x32_bf16 v[64:67], a[68:71], a[36:39], v[64:67]
    s_add_u32 s28, s28, s31
    v_mfma_f32_16x16x32_bf16 v[68:71], a[76:79], a[36:39], v[68:71]
    v_mfma_f32_16x16x32_bf16 v[68:71], a[72:75], a[32:35], v[68:71]
    s_waitcnt lgkmcnt(14)
    v_mfma_f32_16x16x32_bf16 v[76:79], a[72:75], a[40:43], v[76:79]
    v_mfma_f32_16x16x32_bf16 v[76:79], a[76:79], a[44:47], v[76:79]
    v_mfma_f32_16x16x32_bf16 v[72:75], a[68:71], a[44:47], v[72:75]
    buffer_store_dwordx4 a[168:171], v2, s[24:27], s28 offen sc1
    v_mfma_f32_16x16x32_bf16 v[72:75], a[64:67], a[40:43], v[72:75]
    s_add_u32 s28, s28, s31
    s_waitcnt lgkmcnt(11)
    v_mfma_f32_16x16x32_bf16 v[80:83], a[64:67], a[48:51], v[80:83]
    v_mfma_f32_16x16x32_bf16 v[80:83], a[68:71], a[52:55], v[80:83]
    v_mfma_f32_16x16x32_bf16 v[84:87], a[76:79], a[52:55], v[84:87]
    v_mfma_f32_16x16x32_bf16 v[84:87], a[72:75], a[48:51], v[84:87]
    s_waitcnt lgkmcnt(8)
    v_mfma_f32_16x16x32_bf16 v[92:95], a[72:75], a[56:59], v[92:95]
    buffer_store_dwordx4 a[172:175], v2, s[24:27], s28 offen sc1
    v_mfma_f32_16x16x32_bf16 v[92:95], a[76:79], a[60:63], v[92:95]
    s_add_u32 s28, s28, s31
    v_mfma_f32_16x16x32_bf16 v[88:91], a[68:71], a[60:63], v[88:91]
    s_waitcnt vmcnt(16) lgkmcnt(0)
    v_mfma_f32_16x16x32_bf16 v[88:91], a[64:67], a[56:59], v[88:91]
    s_barrier
    v_mfma_f32_16x16x32_bf16 v[96:99], a[80:83], a[0:3], v[96:99]
    ds_read_b64_tr_b16 a[64:65], v8 offset:0
    v_mfma_f32_16x16x32_bf16 v[96:99], a[84:87], a[4:7], v[96:99]
    s_add_u32 m0, s62, 0
    v_mfma_f32_16x16x32_bf16 v[100:103], a[92:95], a[4:7], v[100:103]
    buffer_load_dwordx4 v18, s[44:47], s52 offen offset:0 sc1 lds
    v_mfma_f32_16x16x32_bf16 v[100:103], a[88:91], a[0:3], v[100:103]
    ds_read_b64_tr_b16 a[66:67], v8 offset:2048
    v_mfma_f32_16x16x32_bf16 v[108:111], a[88:91], a[8:11], v[108:111]
    s_add_u32 s64, s64, 32768
    v_mfma_f32_16x16x32_bf16 v[108:111], a[92:95], a[12:15], v[108:111]
    s_cmp_ge_u32 s64, 98304
    s_cselect_b32 s63, 4294901760, s59
    s_cselect_b32 s64, 0, s64
    v_mfma_f32_16x16x32_bf16 v[104:107], a[84:87], a[12:15], v[104:107]
    buffer_load_dwordx4 v19, s[44:47], s52 offen offset:1024 sc1 lds
    v_mfma_f32_16x16x32_bf16 v[104:107], a[80:83], a[8:11], v[104:107]
    s_add_u32 s52, s52, s56
    ds_read_b64_tr_b16 a[68:69], v8 offset:16384
    v_mfma_f32_16x16x32_bf16 v[112:115], a[80:83], a[16:19], v[112:115]
    v_mfma_f32_16x16x32_bf16 v[112:115], a[84:87], a[20:23], v[112:115]
    v_mfma_f32_16x16x32_bf16 v[116:119], a[92:95], a[20:23], v[116:119]
    buffer_load_dwordx4 v18, s[44:47], s53 offen offset:2048 sc1 lds
    v_mfma_f32_16x16x32_bf16 v[116:119], a[88:91], a[16:19], v[116:119]
    ds_read_b64_tr_b16 a[70:71], v8 offset:18432
    v_mfma_f32_16x16x32_bf16 v[124:127], a[88:91], a[24:27], v[124:127]
    v_mfma_f32_16x16x32_bf16 v[124:127], a[92:95], a[28:31], v[124:127]
    v_mfma_f32_16x16x32_bf16 v[120:123], a[84:87], a[28:31], v[120:123]
    buffer_load_dwordx4 v19, s[44:47], s53 offen offset:3072 sc1 lds
    v_mfma_f32_16x16x32_bf16 v[120:123], a[80:83], a[24:27], v[120:123]
    s_add_u32 s53, s53, s56
    ds_read_b64_tr_b16 a[72:73], v9 offset:0
    v_mfma_f32_16x16x32_bf16 v[128:131], a[80:83], a[32:35], v[128:131]
    v_mfma_f32_16x16x32_bf16 v[128:131], a[84:87], a[36:39], v[128:131]
    s_add_u32 m0, s62, 4096
    v_mfma_f32_16x16x32_bf16 v[132:135], a[92:95], a[36:39], v[132:135]
    buffer_load_dwordx4 v20, s[44:47], s54 offen offset:0 sc1 lds
    v_mfma_f32_16x16x32_bf16 v[132:135], a[88:91], a[32:35], v[132:135]
    s_xor_b32 s62, s62, 229376
    ds_read_b64_tr_b16 a[74:75], v9 offset:2048
    v_mfma_f32_16x16x32_bf16 v[140:143], a[88:91], a[40:43], v[140:143]
    v_mfma_f32_16x16x32_bf16 v[140:143], a[92:95], a[44:47], v[140:143]
    v_mfma_f32_16x16x32_bf16 v[136:139], a[84:87], a[44:47], v[136:139]
    buffer_load_dwordx4 v21, s[44:47], s54 offen offset:1024 sc1 lds
    v_mfma_f32_16x16x32_bf16 v[136:139], a[80:83], a[40:43], v[136:139]
    s_add_u32 s54, s54, s56
    ds_read_b64_tr_b16 a[76:77], v9 offset:16384
    v_mfma_f32_16x16x32_bf16 v[144:147], a[80:83], a[48:51], v[144:147]
    v_mfma_f32_16x16x32_bf16 v[144:147], a[84:87], a[52:55], v[144:147]
    v_mfma_f32_16x16x32_bf16 v[148:151], a[92:95], a[52:55], v[148:151]
    buffer_load_dwordx4 v20, s[44:47], s55 offen offset:2048 sc1 lds
    v_mfma_f32_16x16x32_bf16 v[148:151], a[88:91], a[48:51], v[148:151]
    ds_read_b64_tr_b16 a[78:79], v9 offset:18432
    v_mfma_f32_16x16x32_bf16 v[156:159], a[88:91], a[56:59], v[156:159]
    v_add_u32 v6, s63, v6
    v_add_u32 v7, s63, v7
    v_mfma_f32_16x16x32_bf16 v[156:159], a[92:95], a[60:63], v[156:159]
    v_mfma_f32_16x16x32_bf16 v[152:155], a[84:87], a[60:63], v[152:155]
    buffer_load_dwordx4 v21, s[44:47], s55 offen offset:3072 sc1 lds
    v_mfma_f32_16x16x32_bf16 v[152:155], a[80:83], a[56:59], v[152:155]
    s_add_u32 s55, s55, s56
    v_mfma_f32_16x16x32_bf16 v[160:163], a[96:99], a[0:3], v[160:163]
    ds_read_b64_tr_b16 a[80:81], v10 offset:0
    v_mfma_f32_16x16x32_bf16 v[160:163], a[100:103], a[4:7], v[160:163]
    v_mfma_f32_16x16x32_bf16 v[164:167], a[108:111], a[4:7], v[164:167]
    v_mfma_f32_16x16x32_bf16 v[164:167], a[104:107], a[0:3], v[164:167]
    s_add_u32 m0, s61, 0
    ds_read_b64_tr_b16 a[82:83], v10 offset:2048
    v_mfma_f32_16x16x32_bf16 v[172:175], a[104:107], a[8:11], v[172:175]
    buffer_load_dwordx4 v16, s[40:43], s48 offen offset:0 sc1 lds
    v_mfma_f32_16x16x32_bf16 v[172:175], a[108:111], a[12:15], v[172:175]
    v_mfma_f32_16x16x32_bf16 v[168:171], a[100:103], a[12:15], v[168:171]
    ds_read_b64_tr_b16 a[84:85], v10 offset:16384
    v_mfma_f32_16x16x32_bf16 v[168:171], a[96:99], a[8:11], v[168:171]
    v_mfma_f32_16x16x32_bf16 v[176:179], a[96:99], a[16:19], v[176:179]
    buffer_store_dwordx4 a[176:179], v2, s[24:27], s28 offen sc1
    v_mfma_f32_16x16x32_bf16 v[176:179], a[100:103], a[20:23], v[176:179]
    s_add_u32 s28, s28, s31
    ds_read_b64_tr_b16 a[86:87], v10 offset:18432
    v_mfma_f32_16x16x32_bf16 v[180:183], a[108:111], a[20:23], v[180:183]
    v_mfma_f32_16x16x32_bf16 v[180:183], a[104:107], a[16:19], v[180:183]
    v_mfma_f32_16x16x32_bf16 v[188:191], a[104:107], a[24:27], v[188:191]
    buffer_load_dwordx4 v17, s[40:43], s48 offen offset:1024 sc1 lds
    v_mfma_f32_16x16x32_bf16 v[188:191], a[108:111], a[28:31], v[188:191]
    s_add_u32 s48, s48, 128
    ds_read_b64_tr_b16 a[88:89], v11 offset:0
    v_mfma_f32_16x16x32_bf16 v[184:187], a[100:103], a[28:31], v[184:187]
    v_mfma_f32_16x16x32_bf16 v[184:187], a[96:99], a[24:27], v[184:187]
    v_mfma_f32_16x16x32_bf16 v[192:195], a[96:99], a[32:35], v[192:195]
    buffer_store_dwordx4 a[180:183], v2, s[24:27], s28 offen sc1
    v_mfma_f32_16x16x32_bf16 v[192:195], a[100:103], a[36:39], v[192:195]
    s_add_u32 s28, s28, s31
    ds_read_b64_tr_b16 a[90:91], v11 offset:2048
    v_mfma_f32_16x16x32_bf16 v[196:199], a[108:111], a[36:39], v[196:199]
    v_mfma_f32_16x16x32_bf16 v[196:199], a[104:107], a[32:35], v[196:199]
    v_mfma_f32_16x16x32_bf16 v[204:207], a[104:107], a[40:43], v[204:207]
    buffer_load_dwordx4 v16, s[40:43], s49 offen offset:2048 sc1 lds
    v_mfma_f32_16x16x32_bf16 v[204:207], a[108:111], a[44:47], v[204:207]
    ds_read_b64_tr_b16 a[92:93], v11 offset:16384
    v_mfma_f32_16x16x32_bf16 v[200:203], a[100:103], a[44:47], v[200:203]
    v_mfma_f32_16x16x32_bf16 v[200:203], a[96:99], a[40:43], v[200:203]
    v_mfma_f32_16x16x32_bf16 v[208:211], a[96:99], a[48:51], v[208:211]
    buffer_store_dwordx4 a[184:187], v2, s[24:27], s28 offen sc1
    v_mfma_f32_16x16x32_bf16 v[208:211], a[100:103], a[52:55], v[208:211]
    s_add_u32 s28, s28, s31
    ds_read_b64_tr_b16 a[94:95], v11 offset:18432
    v_mfma_f32_16x16x32_bf16 v[212:215], a[108:111], a[52:55], v[212:215]
    v_mfma_f32_16x16x32_bf16 v[212:215], a[104:107], a[48:51], v[212:215]
    v_mfma_f32_16x16x32_bf16 v[220:223], a[104:107], a[56:59], v[220:223]
    buffer_load_dwordx4 v17, s[40:43], s49 offen offset:3072 sc1 lds
    v_mfma_f32_16x16x32_bf16 v[220:223], a[108:111], a[60:63], v[220:223]
    s_add_u32 s49, s49, 128
    v_mfma_f32_16x16x32_bf16 v[216:219], a[100:103], a[60:63], v[216:219]
    buffer_store_dwordx4 a[188:191], v2, s[24:27], s28 offen sc1
    v_mfma_f32_16x16x32_bf16 v[216:219], a[96:99], a[56:59], v[216:219]
    s_add_u32 s29, s29, s30
    s_mov_b32 s28, s29
    v_mfma_f32_16x16x32_bf16 v[224:227], a[112:115], a[0:3], v[224:227]
    v_mfma_f32_16x16x32_bf16 v[224:227], a[116:119], a[4:7], v[224:227]
    ds_read_b64_tr_b16 a[96:97], v12 offset:0
    v_mfma_f32_16x16x32_bf16 v[228:231], a[124:127], a[4:7], v[228:231]
    v_mfma_f32_16x16x32_bf16 v[228:231], a[120:123], a[0:3], v[228:231]
    s_add_u32 m0, s61, 4096
    ds_read_b128 a[0:3], v6 offset:0
    v_mfma_f32_16x16x32_bf16 v[236:239], a[120:123], a[8:11], v[236:239]
    buffer_load_dwordx4 v16, s[40:43], s50 offen offset:0 sc1 lds
    v_mfma_f32_16x16x32_bf16 v[236:239], a[124:127], a[12:15], v[236:239]
    s_add_u32 s61, s61, 32768
    ds_read_b128 a[4:7], v7 offset:0
    v_mfma_f32_16x16x32_bf16 v[232:235], a[116:119], a[12:15], v[232:235]
    s_cmp_ge_u32 s61, 98304
    s_cselect_b32 s90, 98304, 0
    ds_read_b64_tr_b16 a[98:99], v12 offset:2048
    v_mfma_f32_16x16x32_bf16 v[232:235], a[112:115], a[8:11], v[232:235]
    s_sub_u32 s61, s61, s90
    ds_read_b128 a[8:11], v6 offset:2048
    v_mfma_f32_16x16x32_bf16 v[240:243], a[112:115], a[16:19], v[240:243]
    ds_read_b128 a[12:15], v7 offset:2048
    v_mfma_f32_16x16x32_bf16 v[240:243], a[116:119], a[20:23], v[240:243]
    ds_read_b64_tr_b16 a[100:101], v12 offset:16384
    v_mfma_f32_16x16x32_bf16 v[244:247], a[124:127], a[20:23], v[244:247]
    v_mfma_f32_16x16x32_bf16 v[244:247], a[120:123], a[16:19], v[244:247]
    ds_read_b128 a[16:19], v6 offset:4096
    v_mfma_f32_16x16x32_bf16 v[252:255], a[120:123], a[24:27], v[252:255]
    buffer_load_dwordx4 v17, s[40:43], s50 offen offset:1024 sc1 lds
    v_mfma_f32_16x16x32_bf16 v[252:255], a[124:127], a[28:31], v[252:255]
    s_add_u32 s50, s50, 128
    ds_read_b128 a[20:23], v7 offset:4096
    v_mfma_f32_16x16x32_bf16 v[248:251], a[116:119], a[28:31], v[248:251]
    ds_read_b64_tr_b16 a[102:103], v12 offset:18432
    v_mfma_f32_16x16x32_bf16 v[248:251], a[112:115], a[24:27], v[248:251]
    ds_read_b128 a[24:27], v6 offset:6144
    v_mfma_f32_16x16x32_bf16 a[224:227], a[112:115], a[32:35], a[224:227]
    s_sub_u32 s65, s65, 1
    ds_read_b128 a[28:31], v7 offset:6144
    v_mfma_f32_16x16x32_bf16 a[224:227], a[116:119], a[36:39], a[224:227]
    ds_read_b64_tr_b16 a[104:105], v13 offset:0
    v_mfma_f32_16x16x32_bf16 a[228:231], a[124:127], a[36:39], a[228:231]
    v_mfma_f32_16x16x32_bf16 a[228:231], a[120:123], a[32:35], a[228:231]
    ds_read_b128 a[32:35], v6 offset:8192
    v_mfma_f32_16x16x32_bf16 a[236:239], a[120:123], a[40:43], a[236:239]
    buffer_load_dwordx4 v16, s[40:43], s51 offen offset:2048 sc1 lds
    v_mfma_f32_16x16x32_bf16 a[236:239], a[124:127], a[44:47], a[236:239]
    ds_read_b128 a[36:39], v7 offset:8192
    v_mfma_f32_16x16x32_bf16 a[232:235], a[116:119], a[44:47], a[232:235]
    ds_read_b64_tr_b16 a[106:107], v13 offset:2048
    v_mfma_f32_16x16x32_bf16 a[232:235], a[112:115], a[40:43], a[232:235]
    ds_read_b128 a[40:43], v6 offset:10240
    v_mfma_f32_16x16x32_bf16 a[240:243], a[112:115], a[48:51], a[240:243]
    ds_read_b128 a[44:47], v7 offset:10240
    v_mfma_f32_16x16x32_bf16 a[240:243], a[116:119], a[52:55], a[240:243]
    ds_read_b64_tr_b16 a[108:109], v13 offset:16384
    v_mfma_f32_16x16x32_bf16 a[244:247], a[124:127], a[52:55], a[244:247]
    v_mfma_f32_16x16x32_bf16 a[244:247], a[120:123], a[48:51], a[244:247]
    ds_read_b128 a[48:51], v6 offset:12288
    v_mfma_f32_16x16x32_bf16 a[252:255], a[120:123], a[56:59], a[252:255]
    buffer_load_dwordx4 v17, s[40:43], s51 offen offset:3072 sc1 lds
    v_mfma_f32_16x16x32_bf16 a[252:255], a[124:127], a[60:63], a[252:255]
    s_add_u32 s51, s51, 128
    ds_read_b128 a[52:55], v7 offset:12288
    v_mfma_f32_16x16x32_bf16 a[248:251], a[116:119], a[60:63], a[248:251]
    ds_read_b64_tr_b16 a[110:111], v13 offset:18432
    v_mfma_f32_16x16x32_bf16 a[248:251], a[112:115], a[56:59], a[248:251]
    ds_read_b128 a[56:59], v6 offset:14336
    ds_read_b128 a[60:63], v7 offset:14336
    s_cmp_eq_u32 s66, 2
    s_cbranch_scc1 m_hook14
m_hookr15:
    s_waitcnt lgkmcnt(15)
    v_mfma_f32_16x16x32_bf16 v[32:35], a[64:67], a[0:3], v[32:35]
    ds_read_b64_tr_b16 a[112:113], v14 offset:0
    v_mfma_f32_16x16x32_bf16 v[32:35], a[68:71], a[4:7], v[32:35]
    ds_read_b64_tr_b16 a[114:115], v14 offset:2048
    v_mfma_f32_16x16x32_bf16 v[36:39], a[76:79], a[4:7], v[36:39]
    ds_read_b64_tr_b16 a[116:117], v14 offset:16384
    v_mfma_f32_16x16x32_bf16 v[36:39], a[72:75], a[0:3], v[36:39]
    ds_read_b64_tr_b16 a[118:119], v14 offset:18432
    v_mfma_f32_16x16x32_bf16 v[44:47], a[72:75], a[8:11], v[44:47]
    ds_read_b64_tr_b16 a[120:121], v15 offset:0
    v_mfma_f32_16x16x32_bf16 v[44:47], a[76:79], a[12:15], v[44:47]
    ds_read_b64_tr_b16 a[122:123], v15 offset:2048
    v_mfma_f32_16x16x32_bf16 v[40:43], a[68:71], a[12:15], v[40:43]
    ds_read_b64_tr_b16 a[124:125], v15 offset:16384
    v_mfma_f32_16x16x32_bf16 v[40:43], a[64:67], a[8:11], v[40:43]
    ds_read_b64_tr_b16 a[126:127], v15 offset:18432
    v_mfma_f32_16x16x32_bf16 v[48:51], a[64:67], a[16:19], v[48:51]
    v_mfma_f32_16x16x32_bf16 v[48:51], a[68:71], a[20:23], v[48:51]
    v_mfma_f32_16x16x32_bf16 v[52:55], a[76:79], a[20:23], v[52:55]
    buffer_store_dwordx4 a[192:195], v2, s[24:27], s28 offen sc1
    v_mfma_f32_16x16x32_bf16 v[52:55], a[72:75], a[16:19], v[52:55]
    s_add_u32 s28, s28, s31
    s_waitcnt lgkmcnt(15)
    v_mfma_f32_16x16x32_bf16 v[60:63], a[72:75], a[24:27], v[60:63]
    v_xor_b32 v8, s60, v8
    v_xor_b32 v9, s60, v9
    v_mfma_f32_16x16x32_bf16 v[60:63], a[76:79], a[28:31], v[60:63]
    v_xor_b32 v10, s60, v10
    v_xor_b32 v11, s60, v11
    v_mfma_f32_16x16x32_bf16 v[56:59], a[68:71], a[28:31], v[56:59]
    v_xor_b32 v12, s60, v12
    v_xor_b32 v13, s60, v13
    v_mfma_f32_16x16x32_bf16 v[56:59], a[64:67], a[24:27], v[56:59]
    v_xor_b32 v14, s60, v14
    v_xor_b32 v15, s60, v15
    v_mfma_f32_16x16x32_bf16 v[64:67], a[64:67], a[32:35], v[64:67]
    buffer_store_dwordx4 a[196:199], v2, s[24:27], s28 offen sc1
    v_mfma_f32_16x16x32_bf16 v[64:67], a[68:71], a[36:39], v[64:67]
    s_add_u32 s28, s28, s31
    v_mfma_f32_16x16x32_bf16 v[68:71], a[76:79], a[36:39], v[68:71]
    v_mfma_f32_16x16x32_bf16 v[68:71], a[72:75], a[32:35], v[68:71]
    s_waitcnt lgkmcnt(14)
    v_mfma_f32_16x16x32_bf16 v[76:79], a[72:75], a[40:43], v[76:79]
    v_mfma_f32_16x16x32_bf16 v[76:79], a[76:79], a[44:47], v[76:79]
    v_mfma_f32_16x16x32_bf16 v[72:75], a[68:71], a[44:47], v[72:75]
    buffer_store_dwordx4 a[200:203], v2, s[24:27], s28 offen sc1
    v_mfma_f32_16x16x32_bf16 v[72:75], a[64:67], a[40:43], v[72:75]
    s_add_u32 s28, s28, s31
    s_waitcnt lgkmcnt(11)
    v_mfma_f32_16x16x32_bf16 v[80:83], a[64:67], a[48:51], v[80:83]
    v_mfma_f32_16x16x32_bf16 v[80:83], a[68:71], a[52:55], v[80:83]
    v_mfma_f32_16x16x32_bf16 v[84:87], a[76:79], a[52:55], v[84:87]
    v_mfma_f32_16x16x32_bf16 v[84:87], a[72:75], a[48:51], v[84:87]
    s_waitcnt lgkmcnt(8)
    v_mfma_f32_16x16x32_bf16 v[92:95], a[72:75], a[56:59], v[92:95]
    buffer_store_dwordx4 a[204:207], v2, s[24:27], s28 offen sc1
    v_mfma_f32_16x16x32_bf16 v[92:95], a[76:79], a[60:63], v[92:95]
    s_add_u32 s28, s28, s31
    v_mfma_f32_16x16x32_bf16 v[88:91], a[68:71], a[60:63], v[88:91]
    s_waitcnt vmcnt(16) lgkmcnt(0)
    v_mfma_f32_16x16x32_bf16 v[88:91], a[64:67], a[56:59], v[88:91]
    s_barrier
    v_mfma_f32_16x16x32_bf16 v[96:99], a[80:83], a[0:3], v[96:99]
    ds_read_b64_tr_b16 a[64:65], v8 offset:0
    v_mfma_f32_16x16x32_bf16 v[96:99], a[84:87], a[4:7], v[96:99]
    s_add_u32 m0, s62, 0
    v_mfma_f32_16x16x32_bf16 v[100:103], a[92:95], a[4:7], v[100:103]
    buffer_load_dwordx4 v18, s[44:47], s52 offen offset:0 sc1 lds
    v_mfma_f32_16x16x32_bf16 v[100:103], a[88:91], a[0:3], v[100:103]
    ds_read_b64_tr_b16 a[66:67], v8 offset:2048
    v_mfma_f32_16x16x32_bf16 v[108:111], a[88:91], a[8:11], v[108:111]
    s_add_u32 s64, s64, 32768
    v_mfma_f32_16x16x32_bf16 v[108:111], a[92:95], a[12:15], v[108:111]
    s_cmp_ge_u32 s64, 98304
    s_cselect_b32 s63, 4294901760, s59
    s_cselect_b32 s64, 0, s64
    v_mfma_f32_16x16x32_bf16 v[104:107], a[84:87], a[12:15], v[104:107]
    buffer_load_dwordx4 v19, s[44:47], s52 offen offset:1024 sc1 lds
    v_mfma_f32_16x16x32_bf16 v[104:107], a[80:83], a[8:11], v[104:107]
    s_add_u32 s52, s52, s56
    ds_read_b64_tr_b16 a[68:69], v8 offset:16384
    v_mfma_f32_16x16x32_bf16 v[112:115], a[80:83], a[16:19], v[112:115]
    v_mfma_f32_16x16x32_bf16 v[112:115], a[84:87], a[20:23], v[112:115]
    v_mfma_f32_16x16x32_bf16 v[116:119], a[92:95], a[20:23], v[116:119]
    buffer_load_dwordx4 v18, s[44:47], s53 offen offset:2048 sc1 lds
    v_mfma_f32_16x16x32_bf16 v[116:119], a[88:91], a[16:19], v[116:119]
    ds_read_b64_tr_b16 a[70:71], v8 offset:18432
    v_mfma_f32_16x16x32_bf16 v[124:127], a[88:91], a[24:27], v[124:127]
    v_mfma_f32_16x16x32_bf16 v[124:127], a[92:95], a[28:31], v[124:127]
    v_mfma_f32_16x16x32_bf16 v[120:123], a[84:87], a[28:31], v[120:123]
    buffer_load_dwordx4 v19, s[44:47], s53 offen offset:3072 sc1 lds
    v_mfma_f32_16x16x32_bf16 v[120:123], a[80:83], a[24:27], v[120:123]
    s_add_u32 s53, s53, s56
    ds_read_b64_tr_b16 a[72:73], v9 offset:0
    v_mfma_f32_16x16x32_bf16 v[128:131], a[80:83], a[32:35], v[128:131]
    v_mfma_f32_16x16x32_bf16 v[128:131], a[84:87], a[36:39], v[128:131]
    s_add_u32 m0, s62, 4096
    v_mfma_f32_16x16x32_bf16 v[132:135], a[92:95], a[36:39], v[132:135]
    buffer_load_dwordx4 v20, s[44:47], s54 offen offset:0 sc1 lds
    v_mfma_f32_16x16x32_bf16 v[132:135], a[88:91], a[32:35], v[132:135]
    s_xor_b32 s62, s62, 229376
    ds_read_b64_tr_b16 a[74:75], v9 offset:2048
    v_mfma_f32_16x16x32_bf16 v[140:143], a[88:91], a[40:43], v[140:143]
    v_mfma_f32_16x16x32_bf16 v[140:143], a[92:95], a[44:47], v[140:143]
    v_mfma_f32_16x16x32_bf16 v[136:139], a[84:87], a[44:47], v[136:139]
    buffer_load_dwordx4 v21, s[44:47], s54 offen offset:1024 sc1 lds
    v_mfma_f32_16x16x32_bf16 v[136:139], a[80:83], a[40:43], v[136:139]
    s_add_u32 s54, s54, s56
    ds_read_b64_tr_b16 a[76:77], v9 offset:16384
    v_mfma_f32_16x16x32_bf16 v[144:147], a[80:83], a[48:51], v[144:147]
    v_mfma_f32_16x16x32_bf16 v[144:147], a[84:87], a[52:55], v[144:147]
    v_mfma_f32_16x16x32_bf16 v[148:151], a[92:95], a[52:55], v[148:151]
    buffer_load_dwordx4 v20, s[44:47], s55 offen offset:2048 sc1 lds
    v_mfma_f32_16x16x32_bf16 v[148:151], a[88:91], a[48:51], v[148:151]
    ds_read_b64_tr_b16 a[78:79], v9 offset:18432
    v_mfma_f32_16x16x32_bf16 v[156:159], a[88:91], a[56:59], v[156:159]
    v_add_u32 v6, s63, v6
    v_add_u32 v7, s63, v7
    v_mfma_f32_16x16x32_bf16 v[156:159], a[92:95], a[60:63], v[156:159]
    v_mfma_f32_16x16x32_bf16 v[152:155], a[84:87], a[60:63], v[152:155]
    buffer_load_dwordx4 v21, s[44:47], s55 offen offset:3072 sc1 lds
    v_mfma_f32_16x16x32_bf16 v[152:155], a[80:83], a[56:59], v[152:155]
    s_add_u32 s55, s55, s56
    v_mfma_f32_16x16x32_bf16 v[160:163], a[96:99], a[0:3], v[160:163]
    ds_read_b64_tr_b16 a[80:81], v10 offset:0
    v_mfma_f32_16x16x32_bf16 v[160:163], a[100:103], a[4:7], v[160:163]
    v_mfma_f32_16x16x32_bf16 v[164:167], a[108:111], a[4:7], v[164:167]
    v_mfma_f32_16x16x32_bf16 v[164:167], a[104:107], a[0:3], v[164:167]
    s_add_u32 m0, s61, 0
    ds_read_b64_tr_b16 a[82:83], v10 offset:2048
    v_mfma_f32_16x16x32_bf16 v[172:175], a[104:107], a[8:11], v[172:175]
    buffer_load_dwordx4 v16, s[40:43], s48 offen offset:0 sc1 lds
    v_mfma_f32_16x16x32_bf16 v[172:175], a[108:111], a[12:15], v[172:175]
    v_mfma_f32_16x16x32_bf16 v[168:171], a[100:103], a[12:15], v[168:171]
    ds_read_b64_tr_b16 a[84:85], v10 offset:16384
    v_mfma_f32_16x16x32_bf16 v[168:171], a[96:99], a[8:11], v[168:171]
    v_mfma_f32_16x16x32_bf16 v[176:179], a[96:99], a[16:19], v[176:179]
    buffer_store_dwordx4 a[208:211], v2, s[24:27], s28 offen sc1
    v_mfma_f32_16x16x32_bf16 v[176:179], a[100:103], a[20:23], v[176:179]
    s_add_u32 s28, s28, s31
    ds_read_b64_tr_b16 a[86:87], v10 offset:18432
    v_mfma_f32_16x16x32_bf16 v[180:183], a[108:111], a[20:23], v[180:183]
    v_mfma_f32_16x16x32_bf16 v[180:183], a[104:107], a[16:19], v[180:183]
    v_mfma_f32_16x16x32_bf16 v[188:191], a[104:107], a[24:27], v[188:191]
    buffer_load_dwordx4 v17, s[40:43], s48 offen offset:1024 sc1 lds
    v_mfma_f32_16x16x32_bf16 v[188:191], a[108:111], a[28:31], v[188:191]
    s_add_u32 s48, s48, 128
    ds_read_b64_tr_b16 a[88:89], v11 offset:0
    v_mfma_f32_16x16x32_bf16 v[184:187], a[100:103], a[28:31], v[184:187]
    v_mfma_f32_16x16x32_bf16 v[184:187], a[96:99], a[24:27], v[184:187]
    v_mfma_f32_16x16x32_bf16 v[192:195], a[96:99], a[32:35], v[192:195]
    buffer_store_dwordx4 a[212:215], v2, s[24:27], s28 offen sc1
    v_mfma_f32_16x16x32_bf16 v[192:195], a[100:103], a[36:39], v[192:195]
    s_add_u32 s28, s28, s31
    ds_read_b64_tr_b16 a[90:91], v11 offset:2048
    v_mfma_f32_16x16x32_bf16 v[196:199], a[108:111], a[36:39], v[196:199]
    v_mfma_f32_16x16x32_bf16 v[196:199], a[104:107], a[32:35], v[196:199]
    v_mfma_f32_16x16x32_bf16 v[204:207], a[104:107], a[40:43], v[204:207]
    buffer_load_dwordx4 v16, s[40:43], s49 offen offset:2048 sc1 lds
    v_mfma_f32_16x16x32_bf16 v[204:207], a[108:111], a[44:47], v[204:207]
    ds_read_b64_tr_b16 a[92:93], v11 offset:16384
    v_mfma_f32_16x16x32_bf16 v[200:203], a[100:103], a[44:47], v[200:203]
    v_mfma_f32_16x16x32_bf16 v[200:203], a[96:99], a[40:43], v[200:203]
    v_mfma_f32_16x16x32_bf16 v[208:211], a[96:99], a[48:51], v[208:211]
    buffer_store_dwordx4 a[216:219], v2, s[24:27], s28 offen sc1
    v_mfma_f32_16x16x32_bf16 v[208:211], a[100:103], a[52:55], v[208:211]
    s_add_u32 s28, s28, s31
    ds_read_b64_tr_b16 a[94:95], v11 offset:18432
    v_mfma_f32_16x16x32_bf16 v[212:215], a[108:111], a[52:55], v[212:215]
    v_mfma_f32_16x16x32_bf16 v[212:215], a[104:107], a[48:51], v[212:215]
    v_mfma_f32_16x16x32_bf16 v[220:223], a[104:107], a[56:59], v[220:223]
    buffer_load_dwordx4 v17, s[40:43], s49 offen offset:3072 sc1 lds
    v_mfma_f32_16x16x32_bf16 v[220:223], a[108:111], a[60:63], v[220:223]
    s_add_u32 s49, s49, 128
    v_mfma_f32_16x16x32_bf16 v[216:219], a[100:103], a[60:63], v[216:219]
    buffer_store_dwordx4 a[220:223], v2, s[24:27], s28 offen sc1
    v_mfma_f32_16x16x32_bf16 v[216:219], a[96:99], a[56:59], v[216:219]
    s_add_u32 s29, s29, s30
    s_mov_b32 s28, s29
    v_mfma_f32_16x16x32_bf16 v[224:227], a[112:115], a[0:3], v[224:227]
    v_mfma_f32_16x16x32_bf16 v[224:227], a[116:119], a[4:7], v[224:227]
    ds_read_b64_tr_b16 a[96:97], v12 offset:0
    v_mfma_f32_16x16x32_bf16 v[228:231], a[124:127], a[4:7], v[228:231]
    v_mfma_f32_16x16x32_bf16 v[228:231], a[120:123], a[0:3], v[228:231]
    s_add_u32 m0, s61, 4096
    ds_read_b128 a[0:3], v6 offset:0
    v_mfma_f32_16x16x32_bf16 v[236:239], a[120:123], a[8:11], v[236:239]
    buffer_load_dwordx4 v16, s[40:43], s50 offen offset:0 sc1 lds
    v_mfma_f32_16x16x32_bf16 v[236:239], a[124:127], a[12:15], v[236:239]
    s_add_u32 s61, s61, 32768
    ds_read_b128 a[4:7], v7 offset:0
    v_mfma_f32_16x16x32_bf16 v[232:235], a[116:119], a[12:15], v[232:235]
    s_cmp_ge_u32 s61, 98304
    s_cselect_b32 s90, 98304, 0
    ds_read_b64_tr_b16 a[98:99], v12 offset:2048
    v_mfma_f32_16x16x32_bf16 v[232:235], a[112:115], a[8:11], v[232:235]
    s_sub_u32 s61, s61, s90
    ds_read_b128 a[8:11], v6 offset:2048
    v_mfma_f32_16x16x32_bf16 v[240:243], a[112:115], a[16:19], v[240:243]
    ds_read_b128 a[12:15], v7 offset:2048
    v_mfma_f32_16x16x32_bf16 v[240:243], a[116:119], a[20:23], v[240:243]
    ds_read_b64_tr_b16 a[100:101], v12 offset:16384
    v_mfma_f32_16x16x32_bf16 v[244:247], a[124:127], a[20:23], v[244:247]
    v_mfma_f32_16x16x32_bf16 v[244:247], a[120:123], a[16:19], v[244:247]
    ds_read_b128 a[16:19], v6 offset:4096
    v_mfma_f32_16x16x32_bf16 v[252:255], a[120:123], a[24:27], v[252:255]
    buffer_load_dwordx4 v17, s[40:43], s50 offen offset:1024 sc1 lds
    v_mfma_f32_16x16x32_bf16 v[252:255], a[124:127], a[28:31], v[252:255]
    s_add_u32 s50, s50, 128
    ds_read_b128 a[20:23], v7 offset:4096
    v_mfma_f32_16x16x32_bf16 v[248:251], a[116:119], a[28:31], v[248:251]
    ds_read_b64_tr_b16 a[102:103], v12 offset:18432
    v_mfma_f32_16x16x32_bf16 v[248:251], a[112:115], a[24:27], v[248:251]
    ds_read_b128 a[24:27], v6 offset:6144
    v_mfma_f32_16x16x32_bf16 a[224:227], a[112:115], a[32:35], a[224:227]
    s_sub_u32 s65, s65, 1
    ds_read_b128 a[28:31], v7 offset:6144
    v_mfma_f32_16x16x32_bf16 a[224:227], a[116:119], a[36:39], a[224:227]
    ds_read_b64_tr_b16 a[104:105], v13 offset:0
    v_mfma_f32_16x16x32_bf16 a[228:231], a[124:127], a[36:39], a[228:231]
    v_mfma_f32_16x16x32_bf16 a[228:231], a[120:123], a[32:35], a[228:231]
    ds_read_b128 a[32:35], v6 offset:8192
    v_mfma_f32_16x16x32_bf16 a[236:239], a[120:123], a[40:43], a[236:239]
    buffer_load_dwordx4 v16, s[40:43], s51 offen offset:2048 sc1 lds
    v_mfma_f32_16x16x32_bf16 a[236:239], a[124:127], a[44:47], a[236:239]
    ds_read_b128 a[36:39], v7 offset:8192
    v_mfma_f32_16x16x32_bf16 a[232:235], a[116:119], a[44:47], a[232:235]
    ds_read_b64_tr_b16 a[106:107], v13 offset:2048
    v_mfma_f32_16x16x32_bf16 a[232:235], a[112:115], a[40:43], a[232:235]
    ds_read_b128 a[40:43], v6 offset:10240
    v_mfma_f32_16x16x32_bf16 a[240:243], a[112:115], a[48:51], a[240:243]
    ds_read_b128 a[44:47], v7 offset:10240
    v_mfma_f32_16x16x32_bf16 a[240:243], a[116:119], a[52:55], a[240:243]
    ds_read_b64_tr_b16 a[108:109], v13 offset:16384
    v_mfma_f32_16x16x32_bf16 a[244:247], a[124:127], a[52:55], a[244:247]
    v_mfma_f32_16x16x32_bf16 a[244:247], a[120:123], a[48:51], a[244:247]
    ds_read_b128 a[48:51], v6 offset:12288
    v_mfma_f32_16x16x32_bf16 a[252:255], a[120:123], a[56:59], a[252:255]
    buffer_load_dwordx4 v17, s[40:43], s51 offen offset:3072 sc1 lds
    v_mfma_f32_16x16x32_bf16 a[252:255], a[124:127], a[60:63], a[252:255]
    s_add_u32 s51, s51, 128
    ds_read_b128 a[52:55], v7 offset:12288
    v_mfma_f32_16x16x32_bf16 a[248:251], a[116:119], a[60:63], a[248:251]
    ds_read_b64_tr_b16 a[110:111], v13 offset:18432
    v_mfma_f32_16x16x32_bf16 a[248:251], a[112:115], a[56:59], a[248:251]
    ds_read_b128 a[56:59], v6 offset:14336
    ds_read_b128 a[60:63], v7 offset:14336
.p2align 3
m_loop16:
    s_waitcnt lgkmcnt(15)
    v_mfma_f32_16x16x32_bf16 v[32:35], a[64:67], a[0:3], v[32:35]
    ds_read_b64_tr_b16 a[112:113], v14 offset:0
    v_mfma_f32_16x16x32_bf16 v[32:35], a[68:71], a[4:7], v[32:35]
    ds_read_b64_tr_b16 a[114:115], v14 offset:2048
    v_mfma_f32_16x16x32_bf16 v[36:39], a[76:79], a[4:7], v[36:39]
    ds_read_b64_tr_b16 a[116:117], v14 offset:16384
    v_mfma_f32_16x16x32_bf16 v[36:39], a[72:75], a[0:3], v[36:39]
    ds_read_b64_tr_b16 a[118:119], v14 offset:18432
    v_mfma_f32_16x16x32_bf16 v[44:47], a[72:75], a[8:11], v[44:47]
    ds_read_b64_tr_b16 a[120:121], v15 offset:0
    v_mfma_f32_16x16x32_bf16 v[44:47], a[76:79], a[12:15], v[44:47]
    ds_read_b64_tr_b16 a[122:123], v15 offset:2048
    v_mfma_f32_16x16x32_bf16 v[40:43], a[68:71], a[12:15], v[40:43]
    ds_read_b64_tr_b16 a[124:125], v15 offset:16384
    v_mfma_f32_16x16x32_bf16 v[40:43], a[64:67], a[8:11], v[40:43]
    ds_read_b64_tr_b16 a[126:127], v15 offset:18432
    v_mfma_f32_16x16x32_bf16 v[48:51], a[64:67], a[16:19], v[48:51]
    v_mfma_f32_16x16x32_bf16 v[48:51], a[68:71], a[20:23], v[48:51]
    v_mfma_f32_16x16x32_bf16 v[52:55], a[76:79], a[20:23], v[52:55]
    v_mfma_f32_16x16x32_bf16 v[52:55], a[72:75], a[16:19], v[52:55]
    s_waitcnt lgkmcnt(15)
    v_mfma_f32_16x16x32_bf16 v[60:63], a[72:75], a[24:27], v[60:63]
    v_xor_b32 v8, s60, v8
    v_xor_b32 v9, s60, v9
    v_mfma_f32_16x16x32_bf16 v[60:63], a[76:79], a[28:31], v[60:63]
    v_xor_b32 v10, s60, v10
    v_xor_b32 v11, s60, v11
    v_mfma_f32_16x16x32_bf16 v[56:59], a[68:71], a[28:31], v[56:59]
    v_xor_b32 v12, s60, v12
    v_xor_b32 v13, s60, v13
    v_mfma_f32_16x16x32_bf16 v[56:59], a[64:67], a[24:27], v[56:59]
    v_xor_b32 v14, s60, v14
    v_xor_b32 v15, s60, v15
    v_mfma_f32_16x16x32_bf16 v[64:67], a[64:67], a[32:35], v[64:67]
    v_mfma_f32_16x16x32_bf16 v[64:67], a[68:71], a[36:39], v[64:67]
    v_mfma_f32_16x16x32_bf16 v[68:71], a[76:79], a[36:39], v[68:71]
    v_mfma_f32_16x16x32_bf16 v[68:71], a[72:75], a[32:35], v[68:71]
    s_waitcnt lgkmcnt(14)
    v_mfma_f32_16x16x32_bf16 v[76:79], a[72:75], a[40:43], v[76:79]
    v_mfma_f32_16x16x32_bf16 v[76:79], a[76:79], a[44:47], v[76:79]
    v_mfma_f32_16x16x32_bf16 v[72:75], a[68:71], a[44:47], v[72:75]
    v_mfma_f32_16x16x32_bf16 v[72:75], a[64:67], a[40:43], v[72:75]
    s_waitcnt lgkmcnt(11)
    v_mfma_f32_16x16x32_bf16 v[80:83], a[64:67], a[48:51], v[80:83]
    v_mfma_f32_16x16x32_bf16 v[80:83], a[68:71], a[52:55], v[80:83]
    v_mfma_f32_16x16x32_bf16 v[84:87], a[76:79], a[52:55], v[84:87]
    v_mfma_f32_16x16x32_bf16 v[84:87], a[72:75], a[48:51], v[84:87]
    s_waitcnt lgkmcnt(8)
    v_mfma_f32_16x16x32_bf16 v[92:95], a[72:75], a[56:59], v[92:95]
    v_mfma_f32_16x16x32_bf16 v[92:95], a[76:79], a[60:63], v[92:95]
    v_mfma_f32_16x16x32_bf16 v[88:91], a[68:71], a[60:63], v[88:91]
    s_waitcnt vmcnt(8) lgkmcnt(0)
    v_mfma_f32_16x16x32_bf16 v[88:91], a[64:67], a[56:59], v[88:91]
    s_barrier
    v_mfma_f32_16x16x32_bf16 v[96:99], a[80:83], a[0:3], v[96:99]
    ds_read_b64_tr_b16 a[64:65], v8 offset:0
    v_mfma_f32_16x16x32_bf16 v[96:99], a[84:87], a[4:7], v[96:99]
    s_add_u32 m0, s62, 0
    v_mfma_f32_16x16x32_bf16 v[100:103], a[92:95], a[4:7], v[100:103]
    buffer_load_dwordx4 v18, s[44:47], s52 offen offset:0 sc1 lds
    v_mfma_f32_16x16x32_bf16 v[100:103], a[88:91], a[0:3], v[100:103]
    ds_read_b64_tr_b16 a[66:67], v8 offset:2048
    v_mfma_f32_16x16x32_bf16 v[108:111], a[88:91], a[8:11], v[108:111]
    s_add_u32 s64, s64, 32768
    v_mfma_f32_16x16x32_bf16 v[108:111], a[92:95], a[12:15], v[108:111]
    s_cmp_ge_u32 s64, 98304
    s_cselect_b32 s63, 4294901760, s59
    s_cselect_b32 s64, 0, s64
    v_mfma_f32_16x16x32_bf16 v[104:107], a[84:87], a[12:15], v[104:107]
    buffer_load_dwordx4 v19, s[44:47], s52 offen offset:1024 sc1 lds
    v_mfma_f32_16x16x32_bf16 v[104:107], a[80:83], a[8:11], v[104:107]
    s_add_u32 s52, s52, s56
    ds_read_b64_tr_b16 a[68:69], v8 offset:16384
    v_mfma_f32_16x16x32_bf16 v[112:115], a[80:83], a[16:19], v[112:115]
    v_mfma_f32_16x16x32_bf16 v[112:115], a[84:87], a[20:23], v[112:115]
    v_mfma_f32_16x16x32_bf16 v[116:119], a[92:95], a[20:23], v[116:119]
    buffer_load_dwordx4 v18, s[44:47], s53 offen offset:2048 sc1 lds
    v_mfma_f32_16x16x32_bf16 v[116:119], a[88:91], a[16:19], v[116:119]
    ds_read_b64_tr_b16 a[70:71], v8 offset:18432
    v_mfma_f32_16x16x32_bf16 v[124:127], a[88:91], a[24:27], v[124:127]
    v_mfma_f32_16x16x32_bf16 v[124:127], a[92:95], a[28:31], v[124:127]
    v_mfma_f32_16x16x32_bf16 v[120:123], a[84:87], a[28:31], v[120:123]
    buffer_load_dwordx4 v19, s[44:47], s53 offen offset:3072 sc1 lds
    v_mfma_f32_16x16x32_bf16 v[120:123], a[80:83], a[24:27], v[120:123]
    s_add_u32 s53, s53, s56
    ds_read_b64_tr_b16 a[72:73], v9 offset:0
    v_mfma_f32_16x16x32_bf16 v[128:131], a[80:83], a[32:35], v[128:131]
    v_mfma_f32_16x16x32_bf16 v[128:131], a[84:87], a[36:39], v[128:131]
    s_add_u32 m0, s62, 4096
    v_mfma_f32_16x16x32_bf16 v[132:135], a[92:95], a[36:39], v[132:135]
    buffer_load_dwordx4 v20, s[44:47], s54 offen offset:0 sc1 lds
    v_mfma_f32_16x16x32_bf16 v[132:135], a[88:91], a[32:35], v[132:135]
    s_xor_b32 s62, s62, 229376
    ds_read_b64_tr_b16 a[74:75], v9 offset:2048
    v_mfma_f32_16x16x32_bf16 v[140:143], a[88:91], a[40:43], v[140:143]
    v_mfma_f32_16x16x32_bf16 v[140:143], a[92:95], a[44:47], v[140:143]
    v_mfma_f32_16x16x32_bf16 v[136:139], a[84:87], a[44:47], v[136:139]
    buffer_load_dwordx4 v21, s[44:47], s54 offen offset:1024 sc1 lds
    v_mfma_f32_16x16x32_bf16 v[136:139], a[80:83], a[40:43], v[136:139]
    s_add_u32 s54, s54, s56
    ds_read_b64_tr_b16 a[76:77], v9 offset:16384
    v_mfma_f32_16x16x32_bf16 v[144:147], a[80:83], a[48:51], v[144:147]
    v_mfma_f32_16x16x32_bf16 v[144:147], a[84:87], a[52:55], v[144:147]
    v_mfma_f32_16x16x32_bf16 v[148:151], a[92:95], a[52:55], v[148:151]
    buffer_load_dwordx4 v20, s[44:47], s55 offen offset:2048 sc1 lds
    v_mfma_f32_16x16x32_bf16 v[148:151], a[88:91], a[48:51], v[148:151]
    ds_read_b64_tr_b16 a[78:79], v9 offset:18432
    v_mfma_f32_16x16x32_bf16 v[156:159], a[88:91], a[56:59], v[156:159]
    v_add_u32 v6, s63, v6
    v_add_u32 v7, s63, v7
    v_mfma_f32_16x16x32_bf16 v[156:159], a[92:95], a[60:63], v[156:159]
    v_mfma_f32_16x16x32_bf16 v[152:155], a[84:87], a[60:63], v[152:155]
    buffer_load_dwordx4 v21, s[44:47], s55 offen offset:3072 sc1 lds
    v_mfma_f32_16x16x32_bf16 v[152:155], a[80:83], a[56:59], v[152:155]
    s_add_u32 s55, s55, s56
    v_mfma_f32_16x16x32_bf16 v[160:163], a[96:99], a[0:3], v[160:163]
    ds_read_b64_tr_b16 a[80:81], v10 offset:0
    v_mfma_f32_16x16x32_bf16 v[160:163], a[100:103], a[4:7], v[160:163]
    v_mfma_f32_16x16x32_bf16 v[164:167], a[108:111], a[4:7], v[164:167]
    v_mfma_f32_16x16x32_bf16 v[164:167], a[104:107], a[0:3], v[164:167]
    s_add_u32 m0, s61, 0
    ds_read_b64_tr_b16 a[82:83], v10 offset:2048
    v_mfma_f32_16x16x32_bf16 v[172:175], a[104:107], a[8:11], v[172:175]
    buffer_load_dwordx4 v16, s[40:43], s48 offen offset:0 sc1 lds
    v_mfma_f32_16x16x32_bf16 v[172:175], a[108:111], a[12:15], v[172:175]
    v_mfma_f32_16x16x32_bf16 v[168:171], a[100:103], a[12:15], v[168:171]
    ds_read_b64_tr_b16 a[84:85], v10 offset:16384
    v_mfma_f32_16x16x32_bf16 v[168:171], a[96:99], a[8:11], v[168:171]
    v_mfma_f32_16x16x32_bf16 v[176:179], a[96:99], a[16:19], v[176:179]
    v_mfma_f32_16x16x32_bf16 v[176:179], a[100:103], a[20:23], v[176:179]
    ds_read_b64_tr_b16 a[86:87], v10 offset:18432
    v_mfma_f32_16x16x32_bf16 v[180:183], a[108:111], a[20:23], v[180:183]
    v_mfma_f32_16x16x32_bf16 v[180:183], a[104:107], a[16:19], v[180:183]
    v_mfma_f32_16x16x32_bf16 v[188:191], a[104:107], a[24:27], v[188:191]
    buffer_load_dwordx4 v17, s[40:43], s48 offen offset:1024 sc1 lds
    v_mfma_f32_16x16x32_bf16 v[188:191], a[108:111], a[28:31], v[188:191]
    s_add_u32 s48, s48, 128
    ds_read_b64_tr_b16 a[88:89], v11 offset:0
    v_mfma_f32_16x16x32_bf16 v[184:187], a[100:103], a[28:31], v[184:187]
    v_mfma_f32_16x16x32_bf16 v[184:187], a[96:99], a[24:27], v[184:187]
    v_mfma_f32_16x16x32_bf16 v[192:195], a[96:99], a[32:35], v[192:195]
    v_mfma_f32_16x16x32_bf16 v[192:195], a[100:103], a[36:39], v[192:195]
    ds_read_b64_tr_b16 a[90:91], v11 offset:2048
    v_mfma_f32_16x16x32_bf16 v[196:199], a[108:111], a[36:39], v[196:199]
    v_mfma_f32_16x16x32_bf16 v[196:199], a[104:107], a[32:35], v[196:199]
    v_mfma_f32_16x16x32_bf16 v[204:207], a[104:107], a[40:43], v[204:207]
    buffer_load_dwordx4 v16, s[40:43], s49 offen offset:2048 sc1 lds
    v_mfma_f32_16x16x32_bf16 v[204:207], a[108:111], a[44:47], v[204:207]
    ds_read_b64_tr_b16 a[92:93], v11 offset:16384
    v_mfma_f32_16x16x32_bf16 v[200:203], a[100:103], a[44:47], v[200:203]
    v_mfma_f32_16x16x32_bf16 v[200:203], a[96:99], a[40:43], v[200:203]
    v_mfma_f32_16x16x32_bf16 v[208:211], a[96:99], a[48:51], v[208:211]
    v_mfma_f32_16x16x32_bf16 v[208:211], a[100:103], a[52:55], v[208:211]
    ds_read_b64_tr_b16 a[94:95], v11 offset:18432
    v_mfma_f32_16x16x32_bf16 v[212:215], a[108:111], a[52:55], v[212:215]
    v_mfma_f32_16x16x32_bf16 v[212:215], a[104:107], a[48:51], v[212:215]
    v_mfma_f32_16x16x32_bf16 v[220:223], a[104:107], a[56:59], v[220:223]
    buffer_load_dwordx4 v17, s[40:43], s49 offen offset:3072 sc1 lds
    v_mfma_f32_16x16x32_bf16 v[220:223], a[108:111], a[60:63], v[220:223]
    s_add_u32 s49, s49, 128
    v_mfma_f32_16x16x32_bf16 v[216:219], a[100:103], a[60:63], v[216:219]
    v_mfma_f32_16x16x32_bf16 v[216:219], a[96:99], a[56:59], v[216:219]
    v_mfma_f32_16x16x32_bf16 v[224:227], a[112:115], a[0:3], v[224:227]
    v_mfma_f32_16x16x32_bf16 v[224:227], a[116:119], a[4:7], v[224:227]
    ds_read_b64_tr_b16 a[96:97], v12 offset:0
    v_mfma_f32_16x16x32_bf16 v[228:231], a[124:127], a[4:7], v[228:231]
    v_mfma_f32_16x16x32_bf16 v[228:231], a[120:123], a[0:3], v[228:231]
    s_add_u32 m0, s61, 4096
    ds_read_b128 a[0:3], v6 offset:0
    v_mfma_f32_16x16x32_bf16 v[236:239], a[120:123], a[8:11], v[236:239]
    buffer_load_dwordx4 v16, s[40:43], s50 offen offset:0 sc1 lds
    v_mfma_f32_16x16x32_bf16 v[236:239], a[124:127], a[12:15], v[236:239]
    s_add_u32 s61, s61, 32768
    ds_read_b128 a[4:7], v7 offset:0
    v_mfma_f32_16x16x32_bf16 v[232:235], a[116:119], a[12:15], v[232:235]
    s_cmp_ge_u32 s61, 98304
    s_cselect_b32 s90, 98304, 0
    ds_read_b64_tr_b16 a[98:99], v12 offset:2048
    v_mfma_f32_16x16x32_bf16 v[232:235], a[112:115], a[8:11], v[232:235]
    s_sub_u32 s61, s61, s90
    ds_read_b128 a[8:11], v6 offset:2048
    v_mfma_f32_16x16x32_bf16 v[240:243], a[112:115], a[16:19], v[240:243]
    ds_read_b128 a[12:15], v7 offset:2048
    v_mfma_f32_16x16x32_bf16 v[240:243], a[116:119], a[20:23], v[240:243]
    ds_read_b64_tr_b16 a[100:101], v12 offset:16384
    v_mfma_f32_16x16x32_bf16 v[244:247], a[124:127], a[20:23], v[244:247]
    v_mfma_f32_16x16x32_bf16 v[244:247], a[120:123], a[16:19], v[244:247]
    ds_read_b128 a[16:19], v6 offset:4096
    v_mfma_f32_16x16x32_bf16 v[252:255], a[120:123], a[24:27], v[252:255]
    buffer_load_dwordx4 v17, s[40:43], s50 offen offset:1024 sc1 lds
    v_mfma_f32_16x16x32_bf16 v[252:255], a[124:127], a[28:31], v[252:255]
    s_add_u32 s50, s50, 128
    ds_read_b128 a[20:23], v7 offset:4096
    v_mfma_f32_16x16x32_bf16 v[248:251], a[116:119], a[28:31], v[248:251]
    ds_read_b64_tr_b16 a[102:103], v12 offset:18432
    v_mfma_f32_16x16x32_bf16 v[248:251], a[112:115], a[24:27], v[248:251]
    ds_read_b128 a[24:27], v6 offset:6144
    v_mfma_f32_16x16x32_bf16 a[224:227], a[112:115], a[32:35], a[224:227]
    s_sub_u32 s65, s65, 1
    ds_read_b128 a[28:31], v7 offset:6144
    v_mfma_f32_16x16x32_bf16 a[224:227], a[116:119], a[36:39], a[224:227]
    ds_read_b64_tr_b16 a[104:105], v13 offset:0
    v_mfma_f32_16x16x32_bf16 a[228:231], a[124:127], a[36:39], a[228:231]
    v_mfma_f32_16x16x32_bf16 a[228:231], a[120:123], a[32:35], a[228:231]
    ds_read_b128 a[32:35], v6 offset:8192
    v_mfma_f32_16x16x32_bf16 a[236:239], a[120:123], a[40:43], a[236:239]
    buffer_load_dwordx4 v16, s[40:43], s51 offen offset:2048 sc1 lds
    v_mfma_f32_16x16x32_bf16 a[236:239], a[124:127], a[44:47], a[236:239]
    ds_read_b128 a[36:39], v7 offset:8192
    v_mfma_f32_16x16x32_bf16 a[232:235], a[116:119], a[44:47], a[232:235]
    ds_read_b64_tr_b16 a[106:107], v13 offset:2048
    v_mfma_f32_16x16x32_bf16 a[232:235], a[112:115], a[40:43], a[232:235]
    ds_read_b128 a[40:43], v6 offset:10240
    v_mfma_f32_16x16x32_bf16 a[240:243], a[112:115], a[48:51], a[240:243]
    ds_read_b128 a[44:47], v7 offset:10240
    v_mfma_f32_16x16x32_bf16 a[240:243], a[116:119], a[52:55], a[240:243]
    ds_read_b64_tr_b16 a[108:109], v13 offset:16384
    v_mfma_f32_16x16x32_bf16 a[244:247], a[124:127], a[52:55], a[244:247]
    v_mfma_f32_16x16x32_bf16 a[244:247], a[120:123], a[48:51], a[244:247]
    ds_read_b128 a[48:51], v6 offset:12288
    v_mfma_f32_16x16x32_bf16 a[252:255], a[120:123], a[56:59], a[252:255]
    buffer_load_dwordx4 v17, s[40:43], s51 offen offset:3072 sc1 lds
    v_mfma_f32_16x16x32_bf16 a[252:255], a[124:127], a[60:63], a[252:255]
    s_add_u32 s51, s51, 128
    ds_read_b128 a[52:55], v7 offset:12288
    v_mfma_f32_16x16x32_bf16 a[248:251], a[116:119], a[60:63], a[248:251]
    s_cmp_gt_u32 s65, s67
    ds_read_b64_tr_b16 a[110:111], v13 offset:18432
    v_mfma_f32_16x16x32_bf16 a[248:251], a[112:115], a[56:59], a[248:251]
    ds_read_b128 a[56:59], v6 offset:14336
    ds_read_b128 a[60:63], v7 offset:14336
    s_cbranch_scc1 m_loop16
    s_cmp_lg_u32 s65, 0
    s_cbranch_scc1 m_dosw17
    s_branch m_epi12
m_swp13:
    s_waitcnt lgkmcnt(15)
    v_mfma_f32_16x16x32_bf16 v[32:35], a[0:3], a[64:67], 0
    ds_read_b64_tr_b16 a[112:113], v14 offset:0
    v_mfma_f32_16x16x32_bf16 v[32:35], a[4:7], a[68:71], v[32:35]
    ds_read_b64_tr_b16 a[114:115], v14 offset:2048
    v_mfma_f32_16x16x32_bf16 v[40:43], a[4:7], a[76:79], 0
    ds_read_b64_tr_b16 a[116:117], v14 offset:16384
    v_mfma_f32_16x16x32_bf16 v[40:43], a[0:3], a[72:75], v[40:43]
    ds_read_b64_tr_b16 a[118:119], v14 offset:18432
    v_mfma_f32_16x16x32_bf16 v[44:47], a[8:11], a[72:75], 0
    ds_read_b64_tr_b16 a[120:121], v15 offset:0
    v_mfma_f32_16x16x32_bf16 v[44:47], a[12:15], a[76:79], v[44:47]
    ds_read_b64_tr_b16 a[122:123], v15 offset:2048
    v_mfma_f32_16x16x32_bf16 v[36:39], a[12:15], a[68:71], 0
    ds_read_b64_tr_b16 a[124:125], v15 offset:16384
    v_mfma_f32_16x16x32_bf16 v[36:39], a[8:11], a[64:67], v[36:39]
    ds_read_b64_tr_b16 a[126:127], v15 offset:18432
    v_mfma_f32_16x16x32_bf16 v[96:99], a[16:19], a[64:67], 0
    v_mfma_f32_16x16x32_bf16 v[96:99], a[20:23], a[68:71], v[96:99]
    v_mfma_f32_16x16x32_bf16 v[104:107], a[20:23], a[76:79], 0
    buffer_store_dwordx4 a[128:131], v2, s[24:27], s28 offen sc1
    v_mfma_f32_16x16x32_bf16 v[104:107], a[16:19], a[72:75], v[104:107]
    s_add_u32 s28, s28, s31
    s_waitcnt lgkmcnt(15)
    v_mfma_f32_16x16x32_bf16 v[108:111], a[24:27], a[72:75], 0
    v_xor_b32 v8, s60, v8
    v_xor_b32 v9, s60, v9
    v_mfma_f32_16x16x32_bf16 v[108:111], a[28:31], a[76:79], v[108:111]
    v_xor_b32 v10, s60, v10
    v_xor_b32 v11, s60, v11
    v_mfma_f32_16x16x32_bf16 v[100:103], a[28:31], a[68:71], 0
    v_xor_b32 v12, s60, v12
    v_xor_b32 v13, s60, v13
    v_mfma_f32_16x16x32_bf16 v[100:103], a[24:27], a[64:67], v[100:103]
    v_xor_b32 v14, s60, v14
    v_xor_b32 v15, s60, v15
    v_mfma_f32_16x16x32_bf16 v[160:163], a[32:35], a[64:67], 0
    buffer_store_dwordx4 a[132:135], v2, s[24:27], s28 offen sc1
    v_mfma_f32_16x16x32_bf16 v[160:163], a[36:39], a[68:71], v[160:163]
    s_add_u32 s28, s28, s31
    v_mfma_f32_16x16x32_bf16 v[168:171], a[36:39], a[76:79], 0
    v_mfma_f32_16x16x32_bf16 v[168:171], a[32:35], a[72:75], v[168:171]
    s_waitcnt lgkmcnt(14)
    v_mfma_f32_16x16x32_bf16 v[172:175], a[40:43], a[72:75], 0
    v_mfma_f32_16x16x32_bf16 v[172:175], a[44:47], a[76:79], v[172:175]
    v_mfma_f32_16x16x32_bf16 v[164:167], a[44:47], a[68:71], 0
    buffer_store_dwordx4 a[136:139], v2, s[24:27], s28 offen sc1
    v_mfma_f32_16x16x32_bf16 v[164:167], a[40:43], a[64:67], v[164:167]
    s_add_u32 s28, s28, s31
    s_waitcnt lgkmcnt(11)
    v_mfma_f32_16x16x32_bf16 v[224:227], a[48:51], a[64:67], 0
    v_mfma_f32_16x16x32_bf16 v[224:227], a[52:55], a[68:71], v[224:227]
    v_mfma_f32_16x16x32_bf16 v[232:235], a[52:55], a[76:79], 0
    v_mfma_f32_16x16x32_bf16 v[232:235], a[48:51], a[72:75], v[232:235]
    s_waitcnt lgkmcnt(8)
    v_mfma_f32_16x16x32_bf16 v[236:239], a[56:59], a[72:75], 0
    buffer_store_dwordx4 a[140:143], v2, s[24:27], s28 offen sc1
    v_mfma_f32_16x16x32_bf16 v[236:239], a[60:63], a[76:79], v[236:239]
    s_add_u32 s28, s28, s31
    v_mfma_f32_16x16x32_bf16 v[228:231], a[60:63], a[68:71], 0
    s_waitcnt vmcnt(12) lgkmcnt(0)
    v_mfma_f32_16x16x32_bf16 v[228:231], a[56:59], a[64:67], v[228:231]
    s_barrier
    v_mfma_f32_16x16x32_bf16 v[48:51], a[0:3], a[80:83], 0
    ds_read_b64_tr_b16 a[64:65], v8 offset:0
    v_mfma_f32_16x16x32_bf16 v[48:51], a[4:7], a[84:87], v[48:51]
    s_add_u32 m0, s62, 0
    v_mfma_f32_16x16x32_bf16 v[56:59], a[4:7], a[92:95], 0
    buffer_load_dwordx4 v18, s[44:47], s52 offen offset:0 sc1 lds
    v_mfma_f32_16x16x32_bf16 v[56:59], a[0:3], a[88:91], v[56:59]
    ds_read_b64_tr_b16 a[66:67], v8 offset:2048
    v_mfma_f32_16x16x32_bf16 v[60:63], a[8:11], a[88:91], 0
    s_add_u32 s64, s64, 32768
    v_mfma_f32_16x16x32_bf16 v[60:63], a[12:15], a[92:95], v[60:63]
    s_cmp_ge_u32 s64, 98304
    s_cselect_b32 s63, 4294901760, s59
    s_cselect_b32 s64, 0, s64
    v_mfma_f32_16x16x32_bf16 v[52:55], a[12:15], a[84:87], 0
    buffer_load_dwordx4 v19, s[44:47], s52 offen offset:1024 sc1 lds
    v_mfma_f32_16x16x32_bf16 v[52:55], a[8:11], a[80:83], v[52:55]
    s_add_u32 s52, s52, s56
    ds_read_b64_tr_b16 a[68:69], v8 offset:16384
    v_mfma_f32_16x16x32_bf16 v[112:115], a[16:19], a[80:83], 0
    v_mfma_f32_16x16x32_bf16 v[112:115], a[20:23], a[84:87], v[112:115]
    v_mfma_f32_16x16x32_bf16 v[120:123], a[20:23], a[92:95], 0
    buffer_load_dwordx4 v18, s[44:47], s53 offen offset:2048 sc1 lds
    v_mfma_f32_16x16x32_bf16 v[120:123], a[16:19], a[88:91], v[120:123]
    ds_read_b64_tr_b16 a[70:71], v8 offset:18432
    v_mfma_f32_16x16x32_bf16 v[124:127], a[24:27], a[88:91], 0
    v_mfma_f32_16x16x32_bf16 v[124:127], a[28:31], a[92:95], v[124:127]
    v_mfma_f32_16x16x32_bf16 v[116:119], a[28:31], a[84:87], 0
    buffer_load_dwordx4 v19, s[44:47], s53 offen offset:3072 sc1 lds
    v_mfma_f32_16x16x32_bf16 v[116:119], a[24:27], a[80:83], v[116:119]
    s_add_u32 s53, s53, s56
    ds_read_b64_tr_b16 a[72:73], v9 offset:0
    v_mfma_f32_16x16x32_bf16 v[176:179], a[32:35], a[80:83], 0
    v_mfma_f32_16x16x32_bf16 v[176:179], a[36:39], a[84:87], v[176:179]
    s_add_u32 m0, s62, 4096
    v_mfma_f32_16x16x32_bf16 v[184:187], a[36:39], a[92:95], 0
    buffer_load_dwordx4 v20, s[44:47], s54 offen offset:0 sc1 lds
    v_mfma_f32_16x16x32_bf16 v[184:187], a[32:35], a[88:91], v[184:187]
    s_xor_b32 s62, s62, 229376
    ds_read_b64_tr_b16 a[74:75], v9 offset:2048
    v_mfma_f32_16x16x32_bf16 v[188:191], a[40:43], a[88:91], 0
    v_mfma_f32_16x16x32_bf16 v[188:191], a[44:47], a[92:95], v[188:191]
    v_mfma_f32_16x16x32_bf16 v[180:183], a[44:47], a[84:87], 0
    buffer_load_dwordx4 v21, s[44:47], s54 offen offset:1024 sc1 lds
    v_mfma_f32_16x16x32_bf16 v[180:183], a[40:43], a[80:83], v[180:183]
    s_add_u32 s54, s54, s56
    ds_read_b64_tr_b16 a[76:77], v9 offset:16384
    v_mfma_f32_16x16x32_bf16 v[240:243], a[48:51], a[80:83], 0
    v_mfma_f32_16x16x32_bf16 v[240:243], a[52:55], a[84:87], v[240:243]
    v_mfma_f32_16x16x32_bf16 v[248:251], a[52:55], a[92:95], 0
    buffer_load_dwordx4 v20, s[44:47], s55 offen offset:2048 sc1 lds
    v_mfma_f32_16x16x32_bf16 v[248:251], a[48:51], a[88:91], v[248:251]
    ds_read_b64_tr_b16 a[78:79], v9 offset:18432
    v_mfma_f32_16x16x32_bf16 v[252:255], a[56:59], a[88:91], 0
    v_add_u32 v6, s63, v6
    v_add_u32 v7, s63, v7
    v_mfma_f32_16x16x32_bf16 v[252:255], a[60:63], a[92:95], v[252:255]
    v_mfma_f32_16x16x32_bf16 v[244:247], a[60:63], a[84:87], 0
    buffer_load_dwordx4 v21, s[44:47], s55 offen offset:3072 sc1 lds
    v_mfma_f32_16x16x32_bf16 v[244:247], a[56:59], a[80:83], v[244:247]
    s_add_u32 s55, s55, s56
    v_mfma_f32_16x16x32_bf16 v[64:67], a[0:3], a[96:99], 0
    ds_read_b64_tr_b16 a[80:81], v10 offset:0
    v_mfma_f32_16x16x32_bf16 v[64:67], a[4:7], a[100:103], v[64:67]
    v_mfma_f32_16x16x32_bf16 v[72:75], a[4:7], a[108:111], 0
    v_mfma_f32_16x16x32_bf16 v[72:75], a[0:3], a[104:107], v[72:75]
    s_add_u32 m0, s61, 0
    ds_read_b64_tr_b16 a[82:83], v10 offset:2048
    v_mfma_f32_16x16x32_bf16 v[76:79], a[8:11], a[104:107], 0
    buffer_load_dwordx4 v16, s[40:43], s48 offen offset:0 sc1 lds
    v_mfma_f32_16x16x32_bf16 v[76:79], a[12:15], a[108:111], v[76:79]
    v_mfma_f32_16x16x32_bf16 v[68:71], a[12:15], a[100:103], 0
    ds_read_b64_tr_b16 a[84:85], v10 offset:16384
    v_mfma_f32_16x16x32_bf16 v[68:71], a[8:11], a[96:99], v[68:71]
    v_mfma_f32_16x16x32_bf16 v[128:131], a[16:19], a[96:99], 0
    buffer_store_dwordx4 a[144:147], v2, s[24:27], s28 offen sc1
    v_mfma_f32_16x16x32_bf16 v[128:131], a[20:23], a[100:103], v[128:131]
    s_add_u32 s28, s28, s31
    ds_read_b64_tr_b16 a[86:87], v10 offset:18432
    v_mfma_f32_16x16x32_bf16 v[136:139], a[20:23], a[108:111], 0
    v_mfma_f32_16x16x32_bf16 v[136:139], a[16:19], a[104:107], v[136:139]
    v_mfma_f32_16x16x32_bf16 v[140:143], a[24:27], a[104:107], 0
    buffer_load_dwordx4 v17, s[40:43], s48 offen offset:1024 sc1 lds
    v_mfma_f32_16x16x32_bf16 v[140:143], a[28:31], a[108:111], v[140:143]
    s_add_u32 s48, s48, 128
    ds_read_b64_tr_b16 a[88:89], v11 offset:0
    v_mfma_f32_16x16x32_bf16 v[132:135], a[28:31], a[100:103], 0
    v_mfma_f32_16x16x32_bf16 v[132:135], a[24:27], a[96:99], v[132:135]
    v_mfma_f32_16x16x32_bf16 v[192:195], a[32:35], a[96:99], 0
    buffer_store_dwordx4 a[148:151], v2, s[24:27], s28 offen sc1
    v_mfma_f32_16x16x32_bf16 v[192:195], a[36:39], a[100:103], v[192:195]
    s_add_u32 s28, s28, s31
    ds_read_b64_tr_b16 a[90:91], v11 offset:2048
    v_mfma_f32_16x16x32_bf16 v[200:203], a[36:39], a[108:111], 0
    v_mfma_f32_16x16x32_bf16 v[200:203], a[32:35], a[104:107], v[200:203]
    v_mfma_f32_16x16x32_bf16 v[204:207], a[40:43], a[104:107], 0
    buffer_load_dwordx4 v16, s[40:43], s49 offen offset:2048 sc1 lds
    v_mfma_f32_16x16x32_bf16 v[204:207], a[44:47], a[108:111], v[204:207]
    ds_read_b64_tr_b16 a[92:93], v11 offset:16384
    v_mfma_f32_16x16x32_bf16 v[196:199], a[44:47], a[100:103], 0
    v_mfma_f32_16x16x32_bf16 v[196:199], a[40:43], a[96:99], v[196:199]
    v_mfma_f32_16x16x32_bf16 a[224:227], a[48:51], a[96:99], 0
    buffer_store_dwordx4 a[152:155], v2, s[24:27], s28 offen sc1
    v_mfma_f32_16x16x32_bf16 a[224:227], a[52:55], a[100:103], a[224:227]
    s_add_u32 s28, s28, s31
    ds_read_b64_tr_b16 a[94:95], v11 offset:18432
    v_mfma_f32_16x16x32_bf16 a[232:235], a[52:55], a[108:111], 0
    v_mfma_f32_16x16x32_bf16 a[232:235], a[48:51], a[104:107], a[232:235]
    v_mfma_f32_16x16x32_bf16 a[236:239], a[56:59], a[104:107], 0
    buffer_load_dwordx4 v17, s[40:43], s49 offen offset:3072 sc1 lds
    v_mfma_f32_16x16x32_bf16 a[236:239], a[60:63], a[108:111], a[236:239]
    s_add_u32 s49, s49, 128
    v_mfma_f32_16x16x32_bf16 a[228:231], a[60:63], a[100:103], 0
    buffer_store_dwordx4 a[156:159], v2, s[24:27], s28 offen sc1
    v_mfma_f32_16x16x32_bf16 a[228:231], a[56:59], a[96:99], a[228:231]
    s_add_u32 s29, s29, s30
    s_mov_b32 s28, s29
    v_mfma_f32_16x16x32_bf16 v[80:83], a[0:3], a[112:115], 0
    v_mfma_f32_16x16x32_bf16 v[80:83], a[4:7], a[116:119], v[80:83]
    ds_read_b64_tr_b16 a[96:97], v12 offset:0
    v_mfma_f32_16x16x32_bf16 v[88:91], a[4:7], a[124:127], 0
    v_mfma_f32_16x16x32_bf16 v[88:91], a[0:3], a[120:123], v[88:91]
    s_add_u32 m0, s61, 4096
    ds_read_b128 a[0:3], v6 offset:0
    v_mfma_f32_16x16x32_bf16 v[92:95], a[8:11], a[120:123], 0
    buffer_load_dwordx4 v16, s[40:43], s50 offen offset:0 sc1 lds
    v_mfma_f32_16x16x32_bf16 v[92:95], a[12:15], a[124:127], v[92:95]
    s_add_u32 s61, s61, 32768
    ds_read_b128 a[4:7], v7 offset:0
    v_mfma_f32_16x16x32_bf16 v[84:87], a[12:15], a[116:119], 0
    s_cmp_ge_u32 s61, 98304
    s_cselect_b32 s90, 98304, 0
    ds_read_b64_tr_b16 a[98:99], v12 offset:2048
    v_mfma_f32_16x16x32_bf16 v[84:87], a[8:11], a[112:115], v[84:87]
    s_sub_u32 s61, s61, s90
    ds_read_b128 a[8:11], v6 offset:2048
    v_mfma_f32_16x16x32_bf16 v[144:147], a[16:19], a[112:115], 0
    ds_read_b128 a[12:15], v7 offset:2048
    v_mfma_f32_16x16x32_bf16 v[144:147], a[20:23], a[116:119], v[144:147]
    ds_read_b64_tr_b16 a[100:101], v12 offset:16384
    v_mfma_f32_16x16x32_bf16 v[152:155], a[20:23], a[124:127], 0
    v_mfma_f32_16x16x32_bf16 v[152:155], a[16:19], a[120:123], v[152:155]
    ds_read_b128 a[16:19], v6 offset:4096
    v_mfma_f32_16x16x32_bf16 v[156:159], a[24:27], a[120:123], 0
    buffer_load_dwordx4 v17, s[40:43], s50 offen offset:1024 sc1 lds
    v_mfma_f32_16x16x32_bf16 v[156:159], a[28:31], a[124:127], v[156:159]
    s_add_u32 s50, s50, 128
    ds_read_b128 a[20:23], v7 offset:4096
    v_mfma_f32_16x16x32_bf16 v[148:151], a[28:31], a[116:119], 0
    ds_read_b64_tr_b16 a[102:103], v12 offset:18432
    v_mfma_f32_16x16x32_bf16 v[148:151], a[24:27], a[112:115], v[148:151]
    ds_read_b128 a[24:27], v6 offset:6144
    v_mfma_f32_16x16x32_bf16 v[208:211], a[32:35], a[112:115], 0
    s_sub_u32 s65, s65, 1
    ds_read_b128 a[28:31], v7 offset:6144
    v_mfma_f32_16x16x32_bf16 v[208:211], a[36:39], a[116:119], v[208:211]
    ds_read_b64_tr_b16 a[104:105], v13 offset:0
    v_mfma_f32_16x16x32_bf16 v[216:219], a[36:39], a[124:127], 0
    v_mfma_f32_16x16x32_bf16 v[216:219], a[32:35], a[120:123], v[216:219]
    ds_read_b128 a[32:35], v6 offset:8192
    v_mfma_f32_16x16x32_bf16 v[220:223], a[40:43], a[120:123], 0
    buffer_load_dwordx4 v16, s[40:43], s51 offen offset:2048 sc1 lds
    v_mfma_f32_16x16x32_bf16 v[220:223], a[44:47], a[124:127], v[220:223]
    ds_read_b128 a[36:39], v7 offset:8192
    v_mfma_f32_16x16x32_bf16 v[212:215], a[44:47], a[116:119], 0
    ds_read_b64_tr_b16 a[106:107], v13 offset:2048
    v_mfma_f32_16x16x32_bf16 v[212:215], a[40:43], a[112:115], v[212:215]
    ds_read_b128 a[40:43], v6 offset:10240
    v_mfma_f32_16x16x32_bf16 a[240:243], a[48:51], a[112:115], 0
    ds_read_b128 a[44:47], v7 offset:10240
    v_mfma_f32_16x16x32_bf16 a[240:243], a[52:55], a[116:119], a[240:243]
    ds_read_b64_tr_b16 a[108:109], v13 offset:16384
    v_mfma_f32_16x16x32_bf16 a[248:251], a[52:55], a[124:127], 0
    v_mfma_f32_16x16x32_bf16 a[248:251], a[48:51], a[120:123], a[248:251]
    ds_read_b128 a[48:51], v6 offset:12288
    v_mfma_f32_16x16x32_bf16 a[252:255], a[56:59], a[120:123], 0
    buffer_load_dwordx4 v17, s[40:43], s51 offen offset:3072 sc1 lds
    v_mfma_f32_16x16x32_bf16 a[252:255], a[60:63], a[124:127], a[252:255]
    s_add_u32 s51, s51, 128
    ds_read_b128 a[52:55], v7 offset:12288
    v_mfma_f32_16x16x32_bf16 a[244:247], a[60:63], a[116:119], 0
    ds_read_b64_tr_b16 a[110:111], v13 offset:18432
    v_mfma_f32_16x16x32_bf16 a[244:247], a[56:59], a[112:115], a[244:247]
    ds_read_b128 a[56:59], v6 offset:14336
    ds_read_b128 a[60:63], v7 offset:14336
    s_waitcnt lgkmcnt(15)
    v_mfma_f32_16x16x32_bf16 v[32:35], a[0:3], a[64:67], v[32:35]
    ds_read_b64_tr_b16 a[112:113], v14 offset:0
    v_mfma_f32_16x16x32_bf16 v[32:35], a[4:7], a[68:71], v[32:35]
    ds_read_b64_tr_b16 a[114:115], v14 offset:2048
    v_mfma_f32_16x16x32_bf16 v[40:43], a[4:7], a[76:79], v[40:43]
    ds_read_b64_tr_b16 a[116:117], v14 offset:16384
    v_mfma_f32_16x16x32_bf16 v[40:43], a[0:3], a[72:75], v[40:43]
    ds_read_b64_tr_b16 a[118:119], v14 offset:18432
    v_mfma_f32_16x16x32_bf16 v[44:47], a[8:11], a[72:75], v[44:47]
    ds_read_b64_tr_b16 a[120:121], v15 offset:0
    v_mfma_f32_16x16x32_bf16 v[44:47], a[12:15], a[76:79], v[44:47]
    ds_read_b64_tr_b16 a[122:123], v15 offset:2048
    v_mfma_f32_16x16x32_bf16 v[36:39], a[12:15], a[68:71], v[36:39]
    ds_read_b64_tr_b16 a[124:125], v15 offset:16384
    v_mfma_f32_16x16x32_bf16 v[36:39], a[8:11], a[64:67], v[36:39]
    ds_read_b64_tr_b16 a[126:127], v15 offset:18432
    v_mfma_f32_16x16x32_bf16 v[96:99], a[16:19], a[64:67], v[96:99]
    v_mfma_f32_16x16x32_bf16 v[96:99], a[20:23], a[68:71], v[96:99]
    v_mfma_f32_16x16x32_bf16 v[104:107], a[20:23], a[76:79], v[104:107]
    buffer_store_dwordx4 a[160:163], v2, s[24:27], s28 offen sc1
    v_mfma_f32_16x16x32_bf16 v[104:107], a[16:19], a[72:75], v[104:107]
    s_add_u32 s28, s28, s31
    s_waitcnt lgkmcnt(15)
    v_mfma_f32_16x16x32_bf16 v[108:111], a[24:27], a[72:75], v[108:111]
    v_xor_b32 v8, s60, v8
    v_xor_b32 v9, s60, v9
    v_mfma_f32_16x16x32_bf16 v[108:111], a[28:31], a[76:79], v[108:111]
    v_xor_b32 v10, s60, v10
    v_xor_b32 v11, s60, v11
    v_mfma_f32_16x16x32_bf16 v[100:103], a[28:31], a[68:71], v[100:103]
    v_xor_b32 v12, s60, v12
    v_xor_b32 v13, s60, v13
    v_mfma_f32_16x16x32_bf16 v[100:103], a[24:27], a[64:67], v[100:103]
    v_xor_b32 v14, s60, v14
    v_xor_b32 v15, s60, v15
    v_mfma_f32_16x16x32_bf16 v[160:163], a[32:35], a[64:67], v[160:163]
    buffer_store_dwordx4 a[164:167], v2, s[24:27], s28 offen sc1
    v_mfma_f32_16x16x32_bf16 v[160:163], a[36:39], a[68:71], v[160:163]
    s_add_u32 s28, s28, s31
    v_mfma_f32_16x16x32_bf16 v[168:171], a[36:39], a[76:79], v[168:171]
    v_mfma_f32_16x16x32_bf16 v[168:171], a[32:35], a[72:75], v[168:171]
    s_waitcnt lgkmcnt(14)
    v_mfma_f32_16x16x32_bf16 v[172:175], a[40:43], a[72:75], v[172:175]
    v_mfma_f32_16x16x32_bf16 v[172:175], a[44:47], a[76:79], v[172:175]
    v_mfma_f32_16x16x32_bf16 v[164:167], a[44:47], a[68:71], v[164:167]
    buffer_store_dwordx4 a[168:171], v2, s[24:27], s28 offen sc1
    v_mfma_f32_16x16x32_bf16 v[164:167], a[40:43], a[64:67], v[164:167]
    s_add_u32 s28, s28, s31
    s_waitcnt lgkmcnt(11)
    v_mfma_f32_16x16x32_bf16 v[224:227], a[48:51], a[64:67], v[224:227]
    v_mfma_f32_16x16x32_bf16 v[224:227], a[52:55], a[68:71], v[224:227]
    v_mfma_f32_16x16x32_bf16 v[232:235], a[52:55], a[76:79], v[232:235]
    v_mfma_f32_16x16x32_bf16 v[232:235], a[48:51], a[72:75], v[232:235]
    s_waitcnt lgkmcnt(8)
    v_mfma_f32_16x16x32_bf16 v[236:239], a[56:59], a[72:75], v[236:239]
    buffer_store_dwordx4 a[172:175], v2, s[24:27], s28 offen sc1
    v_mfma_f32_16x16x32_bf16 v[236:239], a[60:63], a[76:79], v[236:239]
    s_add_u32 s28, s28, s31
    v_mfma_f32_16x16x32_bf16 v[228:231], a[60:63], a[68:71], v[228:231]
    s_waitcnt vmcnt(16) lgkmcnt(0)
    v_mfma_f32_16x16x32_bf16 v[228:231], a[56:59], a[64:67], v[228:231]
    s_barrier
    v_mfma_f32_16x16x32_bf16 v[48:51], a[0:3], a[80:83], v[48:51]
    ds_read_b64_tr_b16 a[64:65], v8 offset:0
    v_mfma_f32_16x16x32_bf16 v[48:51], a[4:7], a[84:87], v[48:51]
    s_add_u32 m0, s62, 0
    v_mfma_f32_16x16x32_bf16 v[56:59], a[4:7], a[92:95], v[56:59]
    buffer_load_dwordx4 v18, s[44:47], s52 offen offset:0 sc1 lds
    v_mfma_f32_16x16x32_bf16 v[56:59], a[0:3], a[88:91], v[56:59]
    ds_read_b64_tr_b16 a[66:67], v8 offset:2048
    v_mfma_f32_16x16x32_bf16 v[60:63], a[8:11], a[88:91], v[60:63]
    s_add_u32 s64, s64, 32768
    v_mfma_f32_16x16x32_bf16 v[60:63], a[12:15], a[92:95], v[60:63]
    s_cmp_ge_u32 s64, 98304
    s_cselect_b32 s63, 4294901760, s59
    s_cselect_b32 s64, 0, s64
    v_mfma_f32_16x16x32_bf16 v[52:55], a[12:15], a[84:87], v[52:55]
    buffer_load_dwordx4 v19, s[44:47], s52 offen offset:1024 sc1 lds
    v_mfma_f32_16x16x32_bf16 v[52:55], a[8:11], a[80:83], v[52:55]
    s_add_u32 s52, s52, s56
    ds_read_b64_tr_b16 a[68:69], v8 offset:16384
    v_mfma_f32_16x16x32_bf16 v[112:115], a[16:19], a[80:83], v[112:115]
    v_mfma_f32_16x16x32_bf16 v[112:115], a[20:23], a[84:87], v[112:115]
    v_mfma_f32_16x16x32_bf16 v[120:123], a[20:23], a[92:95], v[120:123]
    buffer_load_dwordx4 v18, s[44:47], s53 offen offset:2048 sc1 lds
    v_mfma_f32_16x16x32_bf16 v[120:123], a[16:19], a[88:91], v[120:123]
    ds_read_b64_tr_b16 a[70:71], v8 offset:18432
    v_mfma_f32_16x16x32_bf16 v[124:127], a[24:27], a[88:91], v[124:127]
    v_mfma_f32_16x16x32_bf16 v[124:127], a[28:31], a[92:95], v[124:127]
    v_mfma_f32_16x16x32_bf16 v[116:119], a[28:31], a[84:87], v[116:119]
    buffer_load_dwordx4 v19, s[44:47], s53 offen offset:3072 sc1 lds
    v_mfma_f32_16x16x32_bf16 v[116:119], a[24:27], a[80:83], v[116:119]
    s_add_u32 s53, s53, s56
    ds_read_b64_tr_b16 a[72:73], v9 offset:0
    v_mfma_f32_16x16x32_bf16 v[176:179], a[32:35], a[80:83], v[176:179]
    v_mfma_f32_16x16x32_bf16 v[176:179], a[36:39], a[84:87], v[176:179]
    s_add_u32 m0, s62, 4096
    v_mfma_f32_16x16x32_bf16 v[184:187], a[36:39], a[92:95], v[184:187]
    buffer_load_dwordx4 v20, s[44:47], s54 offen offset:0 sc1 lds
    v_mfma_f32_16x16x32_bf16 v[184:187], a[32:35], a[88:91], v[184:187]
    s_xor_b32 s62, s62, 229376
    ds_read_b64_tr_b16 a[74:75], v9 offset:2048
    v_mfma_f32_16x16x32_bf16 v[188:191], a[40:43], a[88:91], v[188:191]
    v_mfma_f32_16x16x32_bf16 v[188:191], a[44:47], a[92:95], v[188:191]
    v_mfma_f32_16x16x32_bf16 v[180:183], a[44:47], a[84:87], v[180:183]
    buffer_load_dwordx4 v21, s[44:47], s54 offen offset:1024 sc1 lds
    v_mfma_f32_16x16x32_bf16 v[180:183], a[40:43], a[80:83], v[180:183]
    s_add_u32 s54, s54, s56
    ds_read_b64_tr_b16 a[76:77], v9 offset:16384
    v_mfma_f32_16x16x32_bf16 v[240:243], a[48:51], a[80:83], v[240:243]
    v_mfma_f32_16x16x32_bf16 v[240:243], a[52:55], a[84:87], v[240:243]
    v_mfma_f32_16x16x32_bf16 v[248:251], a[52:55], a[92:95], v[248:251]
    buffer_load_dwordx4 v20, s[44:47], s55 offen offset:2048 sc1 lds
    v_mfma_f32_16x16x32_bf16 v[248:251], a[48:51], a[88:91], v[248:251]
    ds_read_b64_tr_b16 a[78:79], v9 offset:18432
    v_mfma_f32_16x16x32_bf16 v[252:255], a[56:59], a[88:91], v[252:255]
    v_add_u32 v6, s63, v6
    v_add_u32 v7, s63, v7
    v_mfma_f32_16x16x32_bf16 v[252:255], a[60:63], a[92:95], v[252:255]
    v_mfma_f32_16x16x32_bf16 v[244:247], a[60:63], a[84:87], v[244:247]
    buffer_load_dwordx4 v21, s[44:47], s55 offen offset:3072 sc1 lds
    v_mfma_f32_16x16x32_bf16 v[244:247], a[56:59], a[80:83], v[244:247]
    s_add_u32 s55, s55, s56
    v_mfma_f32_16x16x32_bf16 v[64:67], a[0:3], a[96:99], v[64:67]
    ds_read_b64_tr_b16 a[80:81], v10 offset:0
    v_mfma_f32_16x16x32_bf16 v[64:67], a[4:7], a[100:103], v[64:67]
    v_mfma_f32_16x16x32_bf16 v[72:75], a[4:7], a[108:111], v[72:75]
    v_mfma_f32_16x16x32_bf16 v[72:75], a[0:3], a[104:107], v[72:75]
    s_add_u32 m0, s61, 0
    ds_read_b64_tr_b16 a[82:83], v10 offset:2048
    v_mfma_f32_16x16x32_bf16 v[76:79], a[8:11], a[104:107], v[76:79]
    buffer_load_dwordx4 v16, s[40:43], s48 offen offset:0 sc1 lds
    v_mfma_f32_16x16x32_bf16 v[76:79], a[12:15], a[108:111], v[76:79]
    v_mfma_f32_16x16x32_bf16 v[68:71], a[12:15], a[100:103], v[68:71]
    ds_read_b64_tr_b16 a[84:85], v10 offset:16384
    v_mfma_f32_16x16x32_bf16 v[68:71], a[8:11], a[96:99], v[68:71]
    v_mfma_f32_16x16x32_bf16 v[128:131], a[16:19], a[96:99], v[128:131]
    buffer_store_dwordx4 a[176:179], v2, s[24:27], s28 offen sc1
    v_mfma_f32_16x16x32_bf16 v[128:131], a[20:23], a[100:103], v[128:131]
    s_add_u32 s28, s28, s31
    ds_read_b64_tr_b16 a[86:87], v10 offset:18432
    v_mfma_f32_16x16x32_bf16 v[136:139], a[20:23], a[108:111], v[136:139]
    v_mfma_f32_16x16x32_bf16 v[136:139], a[16:19], a[104:107], v[136:139]
    v_mfma_f32_16x16x32_bf16 v[140:143], a[24:27], a[104:107], v[140:143]
    buffer_load_dwordx4 v17, s[40:43], s48 offen offset:1024 sc1 lds
    v_mfma_f32_16x16x32_bf16 v[140:143], a[28:31], a[108:111], v[140:143]
    s_add_u32 s48, s48, 128
    ds_read_b64_tr_b16 a[88:89], v11 offset:0
    v_mfma_f32_16x16x32_bf16 v[132:135], a[28:31], a[100:103], v[132:135]
    v_mfma_f32_16x16x32_bf16 v[132:135], a[24:27], a[96:99], v[132:135]
    v_mfma_f32_16x16x32_bf16 v[192:195], a[32:35], a[96:99], v[192:195]
    buffer_store_dwordx4 a[180:183], v2, s[24:27], s28 offen sc1
    v_mfma_f32_16x16x32_bf16 v[192:195], a[36:39], a[100:103], v[192:195]
    s_add_u32 s28, s28, s31
    ds_read_b64_tr_b16 a[90:91], v11 offset:2048
    v_mfma_f32_16x16x32_bf16 v[200:203], a[36:39], a[108:111], v[200:203]
    v_mfma_f32_16x16x32_bf16 v[200:203], a[32:35], a[104:107], v[200:203]
    v_mfma_f32_16x16x32_bf16 v[204:207], a[40:43], a[104:107], v[204:207]
    buffer_load_dwordx4 v16, s[40:43], s49 offen offset:2048 sc1 lds
    v_mfma_f32_16x16x32_bf16 v[204:207], a[44:47], a[108:111], v[204:207]
    ds_read_b64_tr_b16 a[92:93], v11 offset:16384
    v_mfma_f32_16x16x32_bf16 v[196:199], a[44:47], a[100:103], v[196:199]
    v_mfma_f32_16x16x32_bf16 v[196:199], a[40:43], a[96:99], v[196:199]
    v_mfma_f32_16x16x32_bf16 a[224:227], a[48:51], a[96:99], a[224:227]
    buffer_store_dwordx4 a[184:187], v2, s[24:27], s28 offen sc1
    v_mfma_f32_16x16x32_bf16 a[224:227], a[52:55], a[100:103], a[224:227]
    s_add_u32 s28, s28, s31
    ds_read_b64_tr_b16 a[94:95], v11 offset:18432
    v_mfma_f32_16x16x32_bf16 a[232:235], a[52:55], a[108:111], a[232:235]
    v_mfma_f32_16x16x32_bf16 a[232:235], a[48:51], a[104:107], a[232:235]
    v_mfma_f32_16x16x32_bf16 a[236:239], a[56:59], a[104:107], a[236:239]
    buffer_load_dwordx4 v17, s[40:43], s49 offen offset:3072 sc1 lds
    v_mfma_f32_16x16x32_bf16 a[236:239], a[60:63], a[108:111], a[236:239]
    s_add_u32 s49, s49, 128
    v_mfma_f32_16x16x32_bf16 a[228:231], a[60:63], a[100:103], a[228:231]
    buffer_store_dwordx4 a[188:191], v2, s[24:27], s28 offen sc1
    v_mfma_f32_16x16x32_bf16 a[228:231], a[56:59], a[96:99], a[228:231]
    s_add_u32 s29, s29, s30
    s_mov_b32 s28, s29
    v_mfma_f32_16x16x32_bf16 v[80:83], a[0:3], a[112:115], v[80:83]
    v_mfma_f32_16x16x32_bf16 v[80:83], a[4:7], a[116:119], v[80:83]
    ds_read_b64_tr_b16 a[96:97], v12 offset:0
    v_mfma_f32_16x16x32_bf16 v[88:91], a[4:7], a[124:127], v[88:91]
    v_mfma_f32_16x16x32_bf16 v[88:91], a[0:3], a[120:123], v[88:91]
    s_add_u32 m0, s61, 4096
    ds_read_b128 a[0:3], v6 offset:0
    v_mfma_f32_16x16x32_bf16 v[92:95], a[8:11], a[120:123], v[92:95]
    buffer_load_dwordx4 v16, s[40:43], s50 offen offset:0 sc1 lds
    v_mfma_f32_16x16x32_bf16 v[92:95], a[12:15], a[124:127], v[92:95]
    s_add_u32 s61, s61, 32768
    ds_read_b128 a[4:7], v7 offset:0
    v_mfma_f32_16x16x32_bf16 v[84:87], a[12:15], a[116:119], v[84:87]
    s_cmp_ge_u32 s61, 98304
    s_cselect_b32 s90, 98304, 0
    ds_read_b64_tr_b16 a[98:99], v12 offset:2048
    v_mfma_f32_16x16x32_bf16 v[84:87], a[8:11], a[112:115], v[84:87]
    s_sub_u32 s61, s61, s90
    ds_read_b128 a[8:11], v6 offset:2048
    v_mfma_f32_16x16x32_bf16 v[144:147], a[16:19], a[112:115], v[144:147]
    ds_read_b128 a[12:15], v7 offset:2048
    v_mfma_f32_16x16x32_bf16 v[144:147], a[20:23], a[116:119], v[144:147]
    ds_read_b64_tr_b16 a[100:101], v12 offset:16384
    v_mfma_f32_16x16x32_bf16 v[152:155], a[20:23], a[124:127], v[152:155]
    v_mfma_f32_16x16x32_bf16 v[152:155], a[16:19], a[120:123], v[152:155]
    ds_read_b128 a[16:19], v6 offset:4096
    v_mfma_f32_16x16x32_bf16 v[156:159], a[24:27], a[120:123], v[156:159]
    buffer_load_dwordx4 v17, s[40:43], s50 offen offset:1024 sc1 lds
    v_mfma_f32_16x16x32_bf16 v[156:159], a[28:31], a[124:127], v[156:159]
    s_add_u32 s50, s50, 128
    ds_read_b128 a[20:23], v7 offset:4096
    v_mfma_f32_16x16x32_bf16 v[148:151], a[28:31], a[116:119], v[148:151]
    ds_read_b64_tr_b16 a[102:103], v12 offset:18432
    v_mfma_f32_16x16x32_bf16 v[148:151], a[24:27], a[112:115], v[148:151]
    ds_read_b128 a[24:27], v6 offset:6144
    v_mfma_f32_16x16x32_bf16 v[208:211], a[32:35], a[112:115], v[208:211]
    s_sub_u32 s65, s65, 1
    ds_read_b128 a[28:31], v7 offset:6144
    v_mfma_f32_16x16x32_bf16 v[208:211], a[36:39], a[116:119], v[208:211]
    ds_read_b64_tr_b16 a[104:105], v13 offset:0
    v_mfma_f32_16x16x32_bf16 v[216:219], a[36:39], a[124:127], v[216:219]
    v_mfma_f32_16x16x32_bf16 v[216:219], a[32:35], a[120:123], v[216:219]
    ds_read_b128 a[32:35], v6 offset:8192
    v_mfma_f32_16x16x32_bf16 v[220:223], a[40:43], a[120:123], v[220:223]
    buffer_load_dwordx4 v16, s[40:43], s51 offen offset:2048 sc1 lds
    v_mfma_f32_16x16x32_bf16 v[220:223], a[44:47], a[124:127], v[220:223]
    ds_read_b128 a[36:39], v7 offset:8192
    v_mfma_f32_16x16x32_bf16 v[212:215], a[44:47], a[116:119], v[212:215]
    ds_read_b64_tr_b16 a[106:107], v13 offset:2048
    v_mfma_f32_16x16x32_bf16 v[212:215], a[40:43], a[112:115], v[212:215]
    ds_read_b128 a[40:43], v6 offset:10240
    v_mfma_f32_16x16x32_bf16 a[240:243], a[48:51], a[112:115], a[240:243]
    ds_read_b128 a[44:47], v7 offset:10240
    v_mfma_f32_16x16x32_bf16 a[240:243], a[52:55], a[116:119], a[240:243]
    ds_read_b64_tr_b16 a[108:109], v13 offset:16384
    v_mfma_f32_16x16x32_bf16 a[248:251], a[52:55], a[124:127], a[248:251]
    v_mfma_f32_16x16x32_bf16 a[248:251], a[48:51], a[120:123], a[248:251]
    ds_read_b128 a[48:51], v6 offset:12288
    v_mfma_f32_16x16x32_bf16 a[252:255], a[56:59], a[120:123], a[252:255]
    buffer_load_dwordx4 v17, s[40:43], s51 offen offset:3072 sc1 lds
    v_mfma_f32_16x16x32_bf16 a[252:255], a[60:63], a[124:127], a[252:255]
    s_add_u32 s51, s51, 128
    ds_read_b128 a[52:55], v7 offset:12288
    v_mfma_f32_16x16x32_bf16 a[244:247], a[60:63], a[116:119], a[244:247]
    ds_read_b64_tr_b16 a[110:111], v13 offset:18432
    v_mfma_f32_16x16x32_bf16 a[244:247], a[56:59], a[112:115], a[244:247]
    ds_read_b128 a[56:59], v6 offset:14336
    ds_read_b128 a[60:63], v7 offset:14336
    s_cmp_eq_u32 s66, 2
    s_cbranch_scc1 m_hook18
m_hookr19:
    s_waitcnt lgkmcnt(15)
    v_mfma_f32_16x16x32_bf16 v[32:35], a[0:3], a[64:67], v[32:35]
    ds_read_b64_tr_b16 a[112:113], v14 offset:0
    v_mfma_f32_16x16x32_bf16 v[32:35], a[4:7], a[68:71], v[32:35]
    ds_read_b64_tr_b16 a[114:115], v14 offset:2048
    v_mfma_f32_16x16x32_bf16 v[40:43], a[4:7], a[76:79], v[40:43]
    ds_read_b64_tr_b16 a[116:117], v14 offset:16384
    v_mfma_f32_16x16x32_bf16 v[40:43], a[0:3], a[72:75], v[40:43]
    ds_read_b64_tr_b16 a[118:119], v14 offset:18432
    v_mfma_f32_16x16x32_bf16 v[44:47], a[8:11], a[72:75], v[44:47]
    ds_read_b64_tr_b16 a[120:121], v15 offset:0
    v_mfma_f32_16x16x32_bf16 v[44:47], a[12:15], a[76:79], v[44:47]
    ds_read_b64_tr_b16 a[122:123], v15 offset:2048
    v_mfma_f32_16x16x32_bf16 v[36:39], a[12:15], a[68:71], v[36:39]
    ds_read_b64_tr_b16 a[124:125], v15 offset:16384
    v_mfma_f32_16x16x32_bf16 v[36:39], a[8:11], a[64:67], v[36:39]
    ds_read_b64_tr_b16 a[126:127], v15 offset:18432
    v_mfma_f32_16x16x32_bf16 v[96:99], a[16:19], a[64:67], v[96:99]
    v_mfma_f32_16x16x32_bf16 v[96:99], a[20:23], a[68:71], v[96:99]
    v_mfma_f32_16x16x32_bf16 v[104:107], a[20:23], a[76:79], v[104:107]
    buffer_store_dwordx4 a[192:195], v2, s[24:27], s28 offen sc1
    v_mfma_f32_16x16x32_bf16 v[104:107], a[16:19], a[72:75], v[104:107]
    s_add_u32 s28, s28, s31
    s_waitcnt lgkmcnt(15)
    v_mfma_f32_16x16x32_bf16 v[108:111], a[24:27], a[72:75], v[108:111]
    v_xor_b32 v8, s60, v8
    v_xor_b32 v9, s60, v9
    v_mfma_f32_16x16x32_bf16 v[108:111], a[28:31], a[76:79], v[108:111]
    v_xor_b32 v10, s60, v10
    v_xor_b32 v11, s60, v11
    v_mfma_f32_16x16x32_bf16 v[100:103], a[28:31], a[68:71], v[100:103]
    v_xor_b32 v12, s60, v12
    v_xor_b32 v13, s60, v13
    v_mfma_f32_16x16x32_bf16 v[100:103], a[24:27], a[64:67], v[100:103]
    v_xor_b32 v14, s60, v14
    v_xor_b32 v15, s60, v15
    v_mfma_f32_16x16x32_bf16 v[160:163], a[32:35], a[64:67], v[160:163]
    buffer_store_dwordx4 a[196:199], v2, s[24:27], s28 offen sc1
    v_mfma_f32_16x16x32_bf16 v[160:163], a[36:39], a[68:71], v[160:163]
    s_add_u32 s28, s28, s31
    v_mfma_f32_16x16x32_bf16 v[168:171], a[36:39], a[76:79], v[168:171]
    v_mfma_f32_16x16x32_bf16 v[168:171], a[32:35], a[72:75], v[168:171]
    s_waitcnt lgkmcnt(14)
    v_mfma_f32_16x16x32_bf16 v[172:175], a[40:43], a[72:75], v[172:175]
    v_mfma_f32_16x16x32_bf16 v[172:175], a[44:47], a[76:79], v[172:175]
    v_mfma_f32_16x16x32_bf16 v[164:167], a[44:47], a[68:71], v[164:167]
    buffer_store_dwordx4 a[200:203], v2, s[24:27], s28 offen sc1
    v_mfma_f32_16x16x32_bf16 v[164:167], a[40:43], a[64:67], v[164:167]
    s_add_u32 s28, s28, s31
    s_waitcnt lgkmcnt(11)
    v_mfma_f32_16x16x32_bf16 v[224:227], a[48:51], a[64:67], v[224:227]
    v_mfma_f32_16x16x32_bf16 v[224:227], a[52:55], a[68:71], v[224:227]
    v_mfma_f32_16x16x32_bf16 v[232:235], a[52:55], a[76:79], v[232:235]
    v_mfma_f32_16x16x32_bf16 v[232:235], a[48:51], a[72:75], v[232:235]
    s_waitcnt lgkmcnt(8)
    v_mfma_f32_16x16x32_bf16 v[236:239], a[56:59], a[72:75], v[236:239]
    buffer_store_dwordx4 a[204:207], v2, s[24:27], s28 offen sc1
    v_mfma_f32_16x16x32_bf16 v[236:239], a[60:63], a[76:79], v[236:239]
    s_add_u32 s28, s28, s31
    v_mfma_f32_16x16x32_bf16 v[228:231], a[60:63], a[68:71], v[228:231]
    s_waitcnt vmcnt(16) lgkmcnt(0)
    v_mfma_f32_16x16x32_bf16 v[228:231], a[56:59], a[64:67], v[228:231]
    s_barrier
    v_mfma_f32_16x16x32_bf16 v[48:51], a[0:3], a[80:83], v[48:51]
    ds_read_b64_tr_b16 a[64:65], v8 offset:0
    v_mfma_f32_16x16x32_bf16 v[48:51], a[4:7], a[84:87], v[48:51]
    s_add_u32 m0, s62, 0
    v_mfma_f32_16x16x32_bf16 v[56:59], a[4:7], a[92:95], v[56:59]
    buffer_load_dwordx4 v18, s[44:47], s52 offen offset:0 sc1 lds
    v_mfma_f32_16x16x32_bf16 v[56:59], a[0:3], a[88:91], v[56:59]
    ds_read_b64_tr_b16 a[66:67], v8 offset:2048
    v_mfma_f32_16x16x32_bf16 v[60:63], a[8:11], a[88:91], v[60:63]
    s_add_u32 s64, s64, 32768
    v_mfma_f32_16x16x32_bf16 v[60:63], a[12:15], a[92:95], v[60:63]
    s_cmp_ge_u32 s64, 98304
    s_cselect_b32 s63, 4294901760, s59
    s_cselect_b32 s64, 0, s64
    v_mfma_f32_16x16x32_bf16 v[52:55], a[12:15], a[84:87], v[52:55]
    buffer_load_dwordx4 v19, s[44:47], s52 offen offset:1024 sc1 lds
    v_mfma_f32_16x16x32_bf16 v[52:55], a[8:11], a[80:83], v[52:55]
    s_add_u32 s52, s52, s56
    ds_read_b64_tr_b16 a[68:69], v8 offset:16384
    v_mfma_f32_16x16x32_bf16 v[112:115], a[16:19], a[80:83], v[112:115]
    v_mfma_f32_16x16x32_bf16 v[112:115], a[20:23], a[84:87], v[112:115]
    v_mfma_f32_16x16x32_bf16 v[120:123], a[20:23], a[92:95], v[120:123]
    buffer_load_dwordx4 v18, s[44:47], s53 offen offset:2048 sc1 lds
    v_mfma_f32_16x16x32_bf16 v[120:123], a[16:19], a[88:91], v[120:123]
    ds_read_b64_tr_b16 a[70:71], v8 offset:18432
    v_mfma_f32_16x16x32_bf16 v[124:127], a[24:27], a[88:91], v[124:127]
    v_mfma_f32_16x16x32_bf16 v[124:127], a[28:31], a[92:95], v[124:127]
    v_mfma_f32_16x16x32_bf16 v[116:119], a[28:31], a[84:87], v[116:119]
    buffer_load_dwordx4 v19, s[44:47], s53 offen offset:3072 sc1 lds
    v_mfma_f32_16x16x32_bf16 v[116:119], a[24:27], a[80:83], v[116:119]
    s_add_u32 s53, s53, s56
    ds_read_b64_tr_b16 a[72:73], v9 offset:0
    v_mfma_f32_16x16x32_bf16 v[176:179], a[32:35], a[80:83], v[176:179]
    v_mfma_f32_16x16x32_bf16 v[176:179], a[36:39], a[84:87], v[176:179]
    s_add_u32 m0, s62, 4096
    v_mfma_f32_16x16x32_bf16 v[184:187], a[36:39], a[92:95], v[184:187]
    buffer_load_dwordx4 v20, s[44:47], s54 offen offset:0 sc1 lds
    v_mfma_f32_16x16x32_bf16 v[184:187], a[32:35], a[88:91], v[184:187]
    s_xor_b32 s62, s62, 229376
    ds_read_b64_tr_b16 a[74:75], v9 offset:2048
    v_mfma_f32_16x16x32_bf16 v[188:191], a[40:43], a[88:91], v[188:191]
    v_mfma_f32_16x16x32_bf16 v[188:191], a[44:47], a[92:95], v[188:191]
    v_mfma_f32_16x16x32_bf16 v[180:183], a[44:47], a[84:87], v[180:183]
    buffer_load_dwordx4 v21, s[44:47], s54 offen offset:1024 sc1 lds
    v_mfma_f32_16x16x32_bf16 v[180:183], a[40:43], a[80:83], v[180:183]
    s_add_u32 s54, s54, s56
    ds_read_b64_tr_b16 a[76:77], v9 offset:16384
    v_mfma_f32_16x16x32_bf16 v[240:243], a[48:51], a[80:83], v[240:243]
    v_mfma_f32_16x16x32_bf16 v[240:243], a[52:55], a[84:87], v[240:243]
    v_mfma_f32_16x16x32_bf16 v[248:251], a[52:55], a[92:95], v[248:251]
    buffer_load_dwordx4 v20, s[44:47], s55 offen offset:2048 sc1 lds
    v_mfma_f32_16x16x32_bf16 v[248:251], a[48:51], a[88:91], v[248:251]
    ds_read_b64_tr_b16 a[78:79], v9 offset:18432
    v_mfma_f32_16x16x32_bf16 v[252:255], a[56:59], a[88:91], v[252:255]
    v_add_u32 v6, s63, v6
    v_add_u32 v7, s63, v7
    v_mfma_f32_16x16x32_bf16 v[252:255], a[60:63], a[92:95], v[252:255]
    v_mfma_f32_16x16x32_bf16 v[244:247], a[60:63], a[84:87], v[244:247]
    buffer_load_dwordx4 v21, s[44:47], s55 offen offset:3072 sc1 lds
    v_mfma_f32_16x16x32_bf16 v[244:247], a[56:59], a[80:83], v[244:247]
    s_add_u32 s55, s55, s56
    v_mfma_f32_16x16x32_bf16 v[64:67], a[0:3], a[96:99], v[64:67]
    ds_read_b64_tr_b16 a[80:81], v10 offset:0
    v_mfma_f32_16x16x32_bf16 v[64:67], a[4:7], a[100:103], v[64:67]
    v_mfma_f32_16x16x32_bf16 v[72:75], a[4:7], a[108:111], v[72:75]
    v_mfma_f32_16x16x32_bf16 v[72:75], a[0:3], a[104:107], v[72:75]
    s_add_u32 m0, s61, 0
    ds_read_b64_tr_b16 a[82:83], v10 offset:2048
    v_mfma_f32_16x16x32_bf16 v[76:79], a[8:11], a[104:107], v[76:79]
    buffer_load_dwordx4 v16, s[40:43], s48 offen offset:0 sc1 lds
    v_mfma_f32_16x16x32_bf16 v[76:79], a[12:15], a[108:111], v[76:79]
    v_mfma_f32_16x16x32_bf16 v[68:71], a[12:15], a[100:103], v[68:71]
    ds_read_b64_tr_b16 a[84:85], v10 offset:16384
    v_mfma_f32_16x16x32_bf16 v[68:71], a[8:11], a[96:99], v[68:71]
    v_mfma_f32_16x16x32_bf16 v[128:131], a[16:19], a[96:99], v[128:131]
    buffer_store_dwordx4 a[208:211], v2, s[24:27], s28 offen sc1
    v_mfma_f32_16x16x32_bf16 v[128:131], a[20:23], a[100:103], v[128:131]
    s_add_u32 s28, s28, s31
    ds_read_b64_tr_b16 a[86:87], v10 offset:18432
    v_mfma_f32_16x16x32_bf16 v[136:139], a[20:23], a[108:111], v[136:139]
    v_mfma_f32_16x16x32_bf16 v[136:139], a[16:19], a[104:107], v[136:139]
    v_mfma_f32_16x16x32_bf16 v[140:143], a[24:27], a[104:107], v[140:143]
    buffer_load_dwordx4 v17, s[40:43], s48 offen offset:1024 sc1 lds
    v_mfma_f32_16x16x32_bf16 v[140:143], a[28:31], a[108:111], v[140:143]
    s_add_u32 s48, s48, 128
    ds_read_b64_tr_b16 a[88:89], v11 offset:0
    v_mfma_f32_16x16x32_bf16 v[132:135], a[28:31], a[100:103], v[132:135]
    v_mfma_f32_16x16x32_bf16 v[132:135], a[24:27], a[96:99], v[132:135]
    v_mfma_f32_16x16x32_bf16 v[192:195], a[32:35], a[96:99], v[192:195]
    buffer_store_dwordx4 a[212:215], v2, s[24:27], s28 offen sc1
    v_mfma_f32_16x16x32_bf16 v[192:195], a[36:39], a[100:103], v[192:195]
    s_add_u32 s28, s28, s31
    ds_read_b64_tr_b16 a[90:91], v11 offset:2048
    v_mfma_f32_16x16x32_bf16 v[200:203], a[36:39], a[108:111], v[200:203]
    v_mfma_f32_16x16x32_bf16 v[200:203], a[32:35], a[104:107], v[200:203]
    v_mfma_f32_16x16x32_bf16 v[204:207], a[40:43], a[104:107], v[204:207]
    buffer_load_dwordx4 v16, s[40:43], s49 offen offset:2048 sc1 lds
    v_mfma_f32_16x16x32_bf16 v[204:207], a[44:47], a[108:111], v[204:207]
    ds_read_b64_tr_b16 a[92:93], v11 offset:16384
    v_mfma_f32_16x16x32_bf16 v[196:199], a[44:47], a[100:103], v[196:199]
    v_mfma_f32_16x16x32_bf16 v[196:199], a[40:43], a[96:99], v[196:199]
    v_mfma_f32_16x16x32_bf16 a[224:227], a[48:51], a[96:99], a[224:227]
    buffer_store_dwordx4 a[216:219], v2, s[24:27], s28 offen sc1
    v_mfma_f32_16x16x32_bf16 a[224:227], a[52:55], a[100:103], a[224:227]
    s_add_u32 s28, s28, s31
    ds_read_b64_tr_b16 a[94:95], v11 offset:18432
    v_mfma_f32_16x16x32_bf16 a[232:235], a[52:55], a[108:111], a[232:235]
    v_mfma_f32_16x16x32_bf16 a[232:235], a[48:51], a[104:107], a[232:235]
    v_mfma_f32_16x16x32_bf16 a[236:239], a[56:59], a[104:107], a[236:239]
    buffer_load_dwordx4 v17, s[40:43], s49 offen offset:3072 sc1 lds
    v_mfma_f32_16x16x32_bf16 a[236:239], a[60:63], a[108:111], a[236:239]
    s_add_u32 s49, s49, 128
    v_mfma_f32_16x16x32_bf16 a[228:231], a[60:63], a[100:103], a[228:231]
    buffer_store_dwordx4 a[220:223], v2, s[24:27], s28 offen sc1
    v_mfma_f32_16x16x32_bf16 a[228:231], a[56:59], a[96:99], a[228:231]
    s_add_u32 s29, s29, s30
    s_mov_b32 s28, s29
    v_mfma_f32_16x16x32_bf16 v[80:83], a[0:3], a[112:115], v[80:83]
    v_mfma_f32_16x16x32_bf16 v[80:83], a[4:7], a[116:119], v[80:83]
    ds_read_b64_tr_b16 a[96:97], v12 offset:0
    v_mfma_f32_16x16x32_bf16 v[88:91], a[4:7], a[124:127], v[88:91]
    v_mfma_f32_16x16x32_bf16 v[88:91], a[0:3], a[120:123], v[88:91]
    s_add_u32 m0, s61, 4096
    ds_read_b128 a[0:3], v6 offset:0
    v_mfma_f32_16x16x32_bf16 v[92:95], a[8:11], a[120:123], v[92:95]
    buffer_load_dwordx4 v16, s[40:43], s50 offen offset:0 sc1 lds
    v_mfma_f32_16x16x32_bf16 v[92:95], a[12:15], a[124:127], v[92:95]
    s_add_u32 s61, s61, 32768
    ds_read_b128 a[4:7], v7 offset:0
    v_mfma_f32_16x16x32_bf16 v[84:87], a[12:15], a[116:119], v[84:87]
    s_cmp_ge_u32 s61, 98304
    s_cselect_b32 s90, 98304, 0
    ds_read_b64_tr_b16 a[98:99], v12 offset:2048
    v_mfma_f32_16x16x32_bf16 v[84:87], a[8:11], a[112:115], v[84:87]
    s_sub_u32 s61, s61, s90
    ds_read_b128 a[8:11], v6 offset:2048
    v_mfma_f32_16x16x32_bf16 v[144:147], a[16:19], a[112:115], v[144:147]
    ds_read_b128 a[12:15], v7 offset:2048
    v_mfma_f32_16x16x32_bf16 v[144:147], a[20:23], a[116:119], v[144:147]
    ds_read_b64_tr_b16 a[100:101], v12 offset:16384
    v_mfma_f32_16x16x32_bf16 v[152:155], a[20:23], a[124:127], v[152:155]
    v_mfma_f32_16x16x32_bf16 v[152:155], a[16:19], a[120:123], v[152:155]
    ds_read_b128 a[16:19], v6 offset:4096
    v_mfma_f32_16x16x32_bf16 v[156:159], a[24:27], a[120:123], v[156:159]
    buffer_load_dwordx4 v17, s[40:43], s50 offen offset:1024 sc1 lds
    v_mfma_f32_16x16x32_bf16 v[156:159], a[28:31], a[124:127], v[156:159]
    s_add_u32 s50, s50, 128
    ds_read_b128 a[20:23], v7 offset:4096
    v_mfma_f32_16x16x32_bf16 v[148:151], a[28:31], a[116:119], v[148:151]
    ds_read_b64_tr_b16 a[102:103], v12 offset:18432
    v_mfma_f32_16x16x32_bf16 v[148:151], a[24:27], a[112:115], v[148:151]
    ds_read_b128 a[24:27], v6 offset:6144
    v_mfma_f32_16x16x32_bf16 v[208:211], a[32:35], a[112:115], v[208:211]
    s_sub_u32 s65, s65, 1
    ds_read_b128 a[28:31], v7 offset:6144
    v_mfma_f32_16x16x32_bf16 v[208:211], a[36:39], a[116:119], v[208:211]
    ds_read_b64_tr_b16 a[104:105], v13 offset:0
    v_mfma_f32_16x16x32_bf16 v[216:219], a[36:39], a[124:127], v[216:219]
    v_mfma_f32_16x16x32_bf16 v[216:219], a[32:35], a[120:123], v[216:219]
    ds_read_b128 a[32:35], v6 offset:8192
    v_mfma_f32_16x16x32_bf16 v[220:223], a[40:43], a[120:123], v[220:223]
    buffer_load_dwordx4 v16, s[40:43], s51 offen offset:2048 sc1 lds
    v_mfma_f32_16x16x32_bf16 v[220:223], a[44:47], a[124:127], v[220:223]
    ds_read_b128 a[36:39], v7 offset:8192
    v_mfma_f32_16x16x32_bf16 v[212:215], a[44:47], a[116:119], v[212:215]
    ds_read_b64_tr_b16 a[106:107], v13 offset:2048
    v_mfma_f32_16x16x32_bf16 v[212:215], a[40:43], a[112:115], v[212:215]
    ds_read_b128 a[40:43], v6 offset:10240
    v_mfma_f32_16x16x32_bf16 a[240:243], a[48:51], a[112:115], a[240:243]
    ds_read_b128 a[44:47], v7 offset:10240
    v_mfma_f32_16x16x32_bf16 a[240:243], a[52:55], a[116:119], a[240:243]
    ds_read_b64_tr_b16 a[108:109], v13 offset:16384
    v_mfma_f32_16x16x32_bf16 a[248:251], a[52:55], a[124:127], a[248:251]
    v_mfma_f32_16x16x32_bf16 a[248:251], a[48:51], a[120:123], a[248:251]
    ds_read_b128 a[48:51], v6 offset:12288
    v_mfma_f32_16x16x32_bf16 a[252:255], a[56:59], a[120:123], a[252:255]
    buffer_load_dwordx4 v17, s[40:43], s51 offen offset:3072 sc1 lds
    v_mfma_f32_16x16x32_bf16 a[252:255], a[60:63], a[124:127], a[252:255]
    s_add_u32 s51, s51, 128
    ds_read_b128 a[52:55], v7 offset:12288
    v_mfma_f32_16x16x32_bf16 a[244:247], a[60:63], a[116:119], a[244:247]
    ds_read_b64_tr_b16 a[110:111], v13 offset:18432
    v_mfma_f32_16x16x32_bf16 a[244:247], a[56:59], a[112:115], a[244:247]
    ds_read_b128 a[56:59], v6 offset:14336
    ds_read_b128 a[60:63], v7 offset:14336
.p2align 3
m_loop20:
    s_waitcnt lgkmcnt(15)
    v_mfma_f32_16x16x32_bf16 v[32:35], a[0:3], a[64:67], v[32:35]
    ds_read_b64_tr_b16 a[112:113], v14 offset:0
    v_mfma_f32_16x16x32_bf16 v[32:35], a[4:7], a[68:71], v[32:35]
    ds_read_b64_tr_b16 a[114:115], v14 offset:2048
    v_mfma_f32_16x16x32_bf16 v[40:43], a[4:7], a[76:79], v[40:43]
    ds_read_b64_tr_b16 a[116:117], v14 offset:16384
    v_mfma_f32_16x16x32_bf16 v[40:43], a[0:3], a[72:75], v[40:43]
    ds_read_b64_tr_b16 a[118:119], v14 offset:18432
    v_mfma_f32_16x16x32_bf16 v[44:47], a[8:11], a[72:75], v[44:47]
    ds_read_b64_tr_b16 a[120:121], v15 offset:0
    v_mfma_f32_16x16x32_bf16 v[44:47], a[12:15], a[76:79], v[44:47]
    ds_read_b64_tr_b16 a[122:123], v15 offset:2048
    v_mfma_f32_16x16x32_bf16 v[36:39], a[12:15], a[68:71], v[36:39]
    ds_read_b64_tr_b16 a[124:125], v15 offset:16384
    v_mfma_f32_16x16x32_bf16 v[36:39], a[8:11], a[64:67], v[36:39]
    ds_read_b64_tr_b16 a[126:127], v15 offset:18432
    v_mfma_f32_16x16x32_bf16 v[96:99], a[16:19], a[64:67], v[96:99]
    v_mfma_f32_16x16x32_bf16 v[96:99], a[20:23], a[68:71], v[96:99]
    v_mfma_f32_16x16x32_bf16 v[104:107], a[20:23], a[76:79], v[104:107]
    v_mfma_f32_16x16x32_bf16 v[104:107], a[16:19], a[72:75], v[104:107]
    s_waitcnt lgkmcnt(15)
    v_mfma_f32_16x16x32_bf16 v[108:111], a[24:27], a[72:75], v[108:111]
    v_xor_b32 v8, s60, v8
    v_xor_b32 v9, s60, v9
    v_mfma_f32_16x16x32_bf16 v[108:111], a[28:31], a[76:79], v[108:111]
    v_xor_b32 v10, s60, v10
    v_xor_b32 v11, s60, v11
    v_mfma_f32_16x16x32_bf16 v[100:103], a[28:31], a[68:71], v[100:103]
    v_xor_b32 v12, s60, v12
    v_xor_b32 v13, s60, v13
    v_mfma_f32_16x16x32_bf16 v[100:103], a[24:27], a[64:67], v[100:103]
    v_xor_b32 v14, s60, v14
    v_xor_b32 v15, s60, v15
    v_mfma_f32_16x16x32_bf16 v[160:163], a[32:35], a[64:67], v[160:163]
    v_mfma_f32_16x16x32_bf16 v[160:163], a[36:39], a[68:71], v[160:163]
    v_mfma_f32_16x16x32_bf16 v[168:171], a[36:39], a[76:79], v[168:171]
    v_mfma_f32_16x16x32_bf16 v[168:171], a[32:35], a[72:75], v[168:171]
    s_waitcnt lgkmcnt(14)
    v_mfma_f32_16x16x32_bf16 v[172:175], a[40:43], a[72:75], v[172:175]
    v_mfma_f32_16x16x32_bf16 v[172:175], a[44:47], a[76:79], v[172:175]
    v_mfma_f32_16x16x32_bf16 v[164:167], a[44:47], a[68:71], v[164:167]
    v_mfma_f32_16x16x32_bf16 v[164:167], a[40:43], a[64:67], v[164:167]
    s_waitcnt lgkmcnt(11)
    v_mfma_f32_16x16x32_bf16 v[224:227], a[48:51], a[64:67], v[224:227]
    v_mfma_f32_16x16x32_bf16 v[224:227], a[52:55], a[68:71], v[224:227]
    v_mfma_f32_16x16x32_bf16 v[232:235], a[52:55], a[76:79], v[232:235]
    v_mfma_f32_16x16x32_bf16 v[232:235], a[48:51], a[72:75], v[232:235]
    s_waitcnt lgkmcnt(8)
    v_mfma_f32_16x16x32_bf16 v[236:239], a[56:59], a[72:75], v[236:239]
    v_mfma_f32_16x16x32_bf16 v[236:239], a[60:63], a[76:79], v[236:239]
    v_mfma_f32_16x16x32_bf16 v[228:231], a[60:63], a[68:71], v[228:231]
    s_waitcnt vmcnt(8) lgkmcnt(0)
    v_mfma_f32_16x16x32_bf16 v[228:231], a[56:59], a[64:67], v[228:231]
    s_barrier
    v_mfma_f32_16x16x32_bf16 v[48:51], a[0:3], a[80:83], v[48:51]
    ds_read_b64_tr_b16 a[64:65], v8 offset:0
    v_mfma_f32_16x16x32_bf16 v[48:51], a[4:7], a[84:87], v[48:51]
    s_add_u32 m0, s62, 0
    v_mfma_f32_16x16x32_bf16 v[56:59], a[4:7], a[92:95], v[56:59]
    buffer_load_dwordx4 v18, s[44:47], s52 offen offset:0 sc1 lds
    v_mfma_f32_16x16x32_bf16 v[56:59], a[0:3], a[88:91], v[56:59]
    ds_read_b64_tr_b16 a[66:67], v8 offset:2048
    v_mfma_f32_16x16x32_bf16 v[60:63], a[8:11], a[88:91], v[60:63]
    s_add_u32 s64, s64, 32768
    v_mfma_f32_16x16x32_bf16 v[60:63], a[12:15], a[92:95], v[60:63]
    s_cmp_ge_u32 s64, 98304
    s_cselect_b32 s63, 4294901760, s59
    s_cselect_b32 s64, 0, s64
    v_mfma_f32_16x16x32_bf16 v[52:55], a[12:15], a[84:87], v[52:55]
    buffer_load_dwordx4 v19, s[44:47], s52 offen offset:1024 sc1 lds
    v_mfma_f32_16x16x32_bf16 v[52:55], a[8:11], a[80:83], v[52:55]
    s_add_u32 s52, s52, s56
    ds_read_b64_tr_b16 a[68:69], v8 offset:16384
    v_mfma_f32_16x16x32_bf16 v[112:115], a[16:19], a[80:83], v[112:115]
    v_mfma_f32_16x16x32_bf16 v[112:115], a[20:23], a[84:87], v[112:115]
    v_mfma_f32_16x16x32_bf16 v[120:123], a[20:23], a[92:95], v[120:123]
    buffer_load_dwordx4 v18, s[44:47], s53 offen offset:2048 sc1 lds
    v_mfma_f32_16x16x32_bf16 v[120:123], a[16:19], a[88:91], v[120:123]
    ds_read_b64_tr_b16 a[70:71], v8 offset:18432
    v_mfma_f32_16x16x32_bf16 v[124:127], a[24:27], a[88:91], v[124:127]
    v_mfma_f32_16x16x32_bf16 v[124:127], a[28:31], a[92:95], v[124:127]
    v_mfma_f32_16x16x32_bf16 v[116:119], a[28:31], a[84:87], v[116:119]
    buffer_load_dwordx4 v19, s[44:47], s53 offen offset:3072 sc1 lds
    v_mfma_f32_16x16x32_bf16 v[116:119], a[24:27], a[80:83], v[116:119]
    s_add_u32 s53, s53, s56
    ds_read_b64_tr_b16 a[72:73], v9 offset:0
    v_mfma_f32_16x16x32_bf16 v[176:179], a[32:35], a[80:83], v[176:179]
    v_mfma_f32_16x16x32_bf16 v[176:179], a[36:39], a[84:87], v[176:179]
    s_add_u32 m0, s62, 4096
    v_mfma_f32_16x16x32_bf16 v[184:187], a[36:39], a[92:95], v[184:187]
    buffer_load_dwordx4 v20, s[44:47], s54 offen offset:0 sc1 lds
    v_mfma_f32_16x16x32_bf16 v[184:187], a[32:35], a[88:91], v[184:187]
    s_xor_b32 s62, s62, 229376
    ds_read_b64_tr_b16 a[74:75], v9 offset:2048
    v_mfma_f32_16x16x32_bf16 v[188:191], a[40:43], a[88:91], v[188:191]
    v_mfma_f32_16x16x32_bf16 v[188:191], a[44:47], a[92:95], v[188:191]
    v_mfma_f32_16x16x32_bf16 v[180:183], a[44:47], a[84:87], v[180:183]
    buffer_load_dwordx4 v21, s[44:47], s54 offen offset:1024 sc1 lds
    v_mfma_f32_16x16x32_bf16 v[180:183], a[40:43], a[80:83], v[180:183]
    s_add_u32 s54, s54, s56
    ds_read_b64_tr_b16 a[76:77], v9 offset:16384
    v_mfma_f32_16x16x32_bf16 v[240:243], a[48:51], a[80:83], v[240:243]
    v_mfma_f32_16x16x32_bf16 v[240:243], a[52:55], a[84:87], v[240:243]
    v_mfma_f32_16x16x32_bf16 v[248:251], a[52:55], a[92:95], v[248:251]
    buffer_load_dwordx4 v20, s[44:47], s55 offen offset:2048 sc1 lds
    v_mfma_f32_16x16x32_bf16 v[248:251], a[48:51], a[88:91], v[248:251]
    ds_read_b64_tr_b16 a[78:79], v9 offset:18432
    v_mfma_f32_16x16x32_bf16 v[252:255], a[56:59], a[88:91], v[252:255]
    v_add_u32 v6, s63, v6
    v_add_u32 v7, s63, v7
    v_mfma_f32_16x16x32_bf16 v[252:255], a[60:63], a[92:95], v[252:255]
    v_mfma_f32_16x16x32_bf16 v[244:247], a[60:63], a[84:87], v[244:247]
    buffer_load_dwordx4 v21, s[44:47], s55 offen offset:3072 sc1 lds
    v_mfma_f32_16x16x32_bf16 v[244:247], a[56:59], a[80:83], v[244:247]
    s_add_u32 s55, s55, s56
    v_mfma_f32_16x16x32_bf16 v[64:67], a[0:3], a[96:99], v[64:67]
    ds_read_b64_tr_b16 a[80:81], v10 offset:0
    v_mfma_f32_16x16x32_bf16 v[64:67], a[4:7], a[100:103], v[64:67]
    v_mfma_f32_16x16x32_bf16 v[72:75], a[4:7], a[108:111], v[72:75]
    v_mfma_f32_16x16x32_bf16 v[72:75], a[0:3], a[104:107], v[72:75]
    s_add_u32 m0, s61, 0
    ds_read_b64_tr_b16 a[82:83], v10 offset:2048
    v_mfma_f32_16x16x32_bf16 v[76:79], a[8:11], a[104:107], v[76:79]
    buffer_load_dwordx4 v16, s[40:43], s48 offen offset:0 sc1 lds
    v_mfma_f32_16x16x32_bf16 v[76:79], a[12:15], a[108:111], v[76:79]
    v_mfma_f32_16x16x32_bf16 v[68:71], a[12:15], a[100:103], v[68:71]
    ds_read_b64_tr_b16 a[84:85], v10 offset:16384
    v_mfma_f32_16x16x32_bf16 v[68:71], a[8:11], a[96:99], v[68:71]
    v_mfma_f32_16x16x32_bf16 v[128:131], a[16:19], a[96:99], v[128:131]
    v_mfma_f32_16x16x32_bf16 v[128:131], a[20:23], a[100:103], v[128:131]
    ds_read_b64_tr_b16 a[86:87], v10 offset:18432
    v_mfma_f32_16x16x32_bf16 v[136:139], a[20:23], a[108:111], v[136:139]
    v_mfma_f32_16x16x32_bf16 v[136:139], a[16:19], a[104:107], v[136:139]
    v_mfma_f32_16x16x32_bf16 v[140:143], a[24:27], a[104:107], v[140:143]
    buffer_load_dwordx4 v17, s[40:43], s48 offen offset:1024 sc1 lds
    v_mfma_f32_16x16x32_bf16 v[140:143], a[28:31], a[108:111], v[140:143]
    s_add_u32 s48, s48, 128
    ds_read_b64_tr_b16 a[88:89], v11 offset:0
    v_mfma_f32_16x16x32_bf16 v[132:135], a[28:31], a[100:103], v[132:135]
    v_mfma_f32_16x16x32_bf16 v[132:135], a[24:27], a[96:99], v[132:135]
    v_mfma_f32_16x16x32_bf16 v[192:195], a[32:35], a[96:99], v[192:195]
    v_mfma_f32_16x16x32_bf16 v[192:195], a[36:39], a[100:103], v[192:195]
    ds_read_b64_tr_b16 a[90:91], v11 offset:2048
    v_mfma_f32_16x16x32_bf16 v[200:203], a[36:39], a[108:111], v[200:203]
    v_mfma_f32_16x16x32_bf16 v[200:203], a[32:35], a[104:107], v[200:203]
    v_mfma_f32_16x16x32_bf16 v[204:207], a[40:43], a[104:107], v[204:207]
    buffer_load_dwordx4 v16, s[40:43], s49 offen offset:2048 sc1 lds
    v_mfma_f32_16x16x32_bf16 v[204:207], a[44:47], a[108:111], v[204:207]
    ds_read_b64_tr_b16 a[92:93], v11 offset:16384
    v_mfma_f32_16x16x32_bf16 v[196:199], a[44:47], a[100:103], v[196:199]
    v_mfma_f32_16x16x32_bf16 v[196:199], a[40:43], a[96:99], v[196:199]
    v_mfma_f32_16x16x32_bf16 a[224:227], a[48:51], a[96:99], a[224:227]
    v_mfma_f32_16x16x32_bf16 a[224:227], a[52:55], a[100:103], a[224:227]
    ds_read_b64_tr_b16 a[94:95], v11 offset:18432
    v_mfma_f32_16x16x32_bf16 a[232:235], a[52:55], a[108:111], a[232:235]
    v_mfma_f32_16x16x32_bf16 a[232:235], a[48:51], a[104:107], a[232:235]
    v_mfma_f32_16x16x32_bf16 a[236:239], a[56:59], a[104:107], a[236:239]
    buffer_load_dwordx4 v17, s[40:43], s49 offen offset:3072 sc1 lds
    v_mfma_f32_16x16x32_bf16 a[236:239], a[60:63], a[108:111], a[236:239]
    s_add_u32 s49, s49, 128
    v_mfma_f32_16x16x32_bf16 a[228:231], a[60:63], a[100:103], a[228:231]
    v_mfma_f32_16x16x32_bf16 a[228:231], a[56:59], a[96:99], a[228:231]
    v_mfma_f32_16x16x32_bf16 v[80:83], a[0:3], a[112:115], v[80:83]
    v_mfma_f32_16x16x32_bf16 v[80:83], a[4:7], a[116:119], v[80:83]
    ds_read_b64_tr_b16 a[96:97], v12 offset:0
    v_mfma_f32_16x16x32_bf16 v[88:91], a[4:7], a[124:127], v[88:91]
    v_mfma_f32_16x16x32_bf16 v[88:91], a[0:3], a[120:123], v[88:91]
    s_add_u32 m0, s61, 4096
    ds_read_b128 a[0:3], v6 offset:0
    v_mfma_f32_16x16x32_bf16 v[92:95], a[8:11], a[120:123], v[92:95]
    buffer_load_dwordx4 v16, s[40:43], s50 offen offset:0 sc1 lds
    v_mfma_f32_16x16x32_bf16 v[92:95], a[12:15], a[124:127], v[92:95]
    s_add_u32 s61, s61, 32768
    ds_read_b128 a[4:7], v7 offset:0
    v_mfma_f32_16x16x32_bf16 v[84:87], a[12:15], a[116:119], v[84:87]
    s_cmp_ge_u32 s61, 98304
    s_cselect_b32 s90, 98304, 0
    ds_read_b64_tr_b16 a[98:99], v12 offset:2048
    v_mfma_f32_16x16x32_bf16 v[84:87], a[8:11], a[112:115], v[84:87]
    s_sub_u32 s61, s61, s90
    ds_read_b128 a[8:11], v6 offset:2048
    v_mfma_f32_16x16x32_bf16 v[144:147], a[16:19], a[112:115], v[144:147]
    ds_read_b128 a[12:15], v7 offset:2048
    v_mfma_f32_16x16x32_bf16 v[144:147], a[20:23], a[116:119], v[144:147]
    ds_read_b64_tr_b16 a[100:101], v12 offset:16384
    v_mfma_f32_16x16x32_bf16 v[152:155], a[20:23], a[124:127], v[152:155]
    v_mfma_f32_16x16x32_bf16 v[152:155], a[16:19], a[120:123], v[152:155]
    ds_read_b128 a[16:19], v6 offset:4096
    v_mfma_f32_16x16x32_bf16 v[156:159], a[24:27], a[120:123], v[156:159]
    buffer_load_dwordx4 v17, s[40:43], s50 offen offset:1024 sc1 lds
    v_mfma_f32_16x16x32_bf16 v[156:159], a[28:31], a[124:127], v[156:159]
    s_add_u32 s50, s50, 128
    ds_read_b128 a[20:23], v7 offset:4096
    v_mfma_f32_16x16x32_bf16 v[148:151], a[28:31], a[116:119], v[148:151]
    ds_read_b64_tr_b16 a[102:103], v12 offset:18432
    v_mfma_f32_16x16x32_bf16 v[148:151], a[24:27], a[112:115], v[148:151]
    ds_read_b128 a[24:27], v6 offset:6144
    v_mfma_f32_16x16x32_bf16 v[208:211], a[32:35], a[112:115], v[208:211]
    s_sub_u32 s65, s65, 1
    ds_read_b128 a[28:31], v7 offset:6144
    v_mfma_f32_16x16x32_bf16 v[208:211], a[36:39], a[116:119], v[208:211]
    ds_read_b64_tr_b16 a[104:105], v13 offset:0
    v_mfma_f32_16x16x32_bf16 v[216:219], a[36:39], a[124:127], v[216:219]
    v_mfma_f32_16x16x32_bf16 v[216:219], a[32:35], a[120:123], v[216:219]
    ds_read_b128 a[32:35], v6 offset:8192
    v_mfma_f32_16x16x32_bf16 v[220:223], a[40:43], a[120:123], v[220:223]
    buffer_load_dwordx4 v16, s[40:43], s51 offen offset:2048 sc1 lds
    v_mfma_f32_16x16x32_bf16 v[220:223], a[44:47], a[124:127], v[220:223]
    ds_read_b128 a[36:39], v7 offset:8192
    v_mfma_f32_16x16x32_bf16 v[212:215], a[44:47], a[116:119], v[212:215]
    ds_read_b64_tr_b16 a[106:107], v13 offset:2048
    v_mfma_f32_16x16x32_bf16 v[212:215], a[40:43], a[112:115], v[212:215]
    ds_read_b128 a[40:43], v6 offset:10240
    v_mfma_f32_16x16x32_bf16 a[240:243], a[48:51], a[112:115], a[240:243]
    ds_read_b128 a[44:47], v7 offset:10240
    v_mfma_f32_16x16x32_bf16 a[240:243], a[52:55], a[116:119], a[240:243]
    ds_read_b64_tr_b16 a[108:109], v13 offset:16384
    v_mfma_f32_16x16x32_bf16 a[248:251], a[52:55], a[124:127], a[248:251]
    v_mfma_f32_16x16x32_bf16 a[248:251], a[48:51], a[120:123], a[248:251]
    ds_read_b128 a[48:51], v6 offset:12288
    v_mfma_f32_16x16x32_bf16 a[252:255], a[56:59], a[120:123], a[252:255]
    buffer_load_dwordx4 v17, s[40:43], s51 offen offset:3072 sc1 lds
    v_mfma_f32_16x16x32_bf16 a[252:255], a[60:63], a[124:127], a[252:255]
    s_add_u32 s51, s51, 128
    ds_read_b128 a[52:55], v7 offset:12288
    v_mfma_f32_16x16x32_bf16 a[244:247], a[60:63], a[116:119], a[244:247]
    s_cmp_gt_u32 s65, s67
    ds_read_b64_tr_b16 a[110:111], v13 offset:18432
    v_mfma_f32_16x16x32_bf16 a[244:247], a[56:59], a[112:115], a[244:247]
    ds_read_b128 a[56:59], v6 offset:14336
    ds_read_b128 a[60:63], v7 offset:14336
    s_cbranch_scc1 m_loop20
    s_cmp_lg_u32 s65, 0
    s_cbranch_scc1 m_dosw21
m_epi12:
    s_cmp_eq_u32 s94, 0
    s_cbranch_scc1 m_last24
    s_mov_b32 s3, 1048576
m_spin28:
    v_readfirstlane_b32 s4, v4
    v_readfirstlane_b32 s5, v5
    s_nop 3
    s_cmp_lg_u32 s4, 0
    s_cbranch_scc1 m_ok29
    s_sub_u32 s3, s3, 1
    s_cbranch_scc1 m_ok29
    s_sleep 32
    buffer_load_dwordx2 v[4:5], off, s[12:15], 0 sc1
    s_waitcnt vmcnt(0)
    s_branch m_spin28
m_ok29:
    s_cmp_ge_u32 s68, 16
    s_cbranch_scc1 m_q031
    s_call_b64 s[20:21], m_epf22
    s_mov_b32 s17, s101
    s_mov_b32 s66, 2
    s_branch m_q130
m_q031:
    s_call_b64 s[20:21], m_eps23
    s_mov_b32 s17, s101
    s_add_u32 s28, s98, s99
    s_mov_b32 s29, s28
    s_mov_b32 s30, s99
    s_mov_b32 s31, s100
    s_mov_b32 s26, 268435456
m_q130:
    s_mov_b32 s95, s82
    s_mov_b32 s96, s83
    s_mov_b32 s97, s84
    s_mov_b32 s98, s85
    s_mov_b32 s99, s86
    s_mov_b32 s100, s87
    s_mov_b32 s101, s88
    s_sub_u32 s67, s95, 5
    s_max_u32 s67, s67, 4
    s_mov_b32 s94, 0
    s_branch m_tile11
m_last24:
    s_cmp_eq_u32 s70, 0
    s_cbranch_scc1 m_kvl27
    buffer_load_dwordx2 v[4:5], off, s[12:15], 0 sc1
    s_call_b64 s[20:21], m_epf22
    s_waitcnt vmcnt(0)
    s_barrier
    s_mov_b32 s3, 1048576
m_spin32:
    v_readfirstlane_b32 s4, v4
    v_readfirstlane_b32 s5, v5
    s_nop 3
    s_cmp_lg_u32 s4, 0
    s_cbranch_scc1 m_ok33
    s_sub_u32 s3, s3, 1
    s_cbranch_scc1 m_ok33
    s_sleep 32
    buffer_load_dwordx2 v[4:5], off, s[12:15], 0 sc1
    s_waitcnt vmcnt(0)
    s_branch m_spin32
m_ok33:
    s_cmp_lg_u32 s16, 0
    s_cbranch_scc1 m_np34
    v_mov_b32 v4, s4
    v_mov_b32 v5, s5
    s_add_u32 s90, s101, 117440512
    s_mov_b64 exec, 1
    buffer_store_dwordx2 v[4:5], off, s[8:11], s90 sc1
    s_mov_b64 exec, -1
m_np34:
    s_cmp_lg_u32 s16, 0
    s_cbranch_scc1 m_pw35
    s_and_b32 s92, s2, 7
    s_lshl_b32 s92, s92, 2
    s_bfe_u32 s93, s2, 0x20003
    s_add_u32 s92, s92, s93
    s_lshr_b32 s93, s2, 5
    s_lshl_b32 s93, s93, 2
    s_or_b32 s93, s93, 0x40000
    s_lshr_b32 s90, s92, 1
    s_lshl_b32 s90, s90, 7
    s_add_u32 s90, s90, 117440512
    s_bfe_u32 s91, 873473623, s93
    s_lshr_b32 s91, s91, 1
    v_mov_b32 v0, s91
    v_add_u32 v4, 8, v1
    v_cmp_gt_u32 vcc, 8, v1
    s_nop 1
    v_cndmask_b32 v0, v0, v4, vcc
    s_bfe_u32 s91, 4225681832, s93
    s_lshr_b32 s91, s91, 1
    v_writelane_b32 v0, s91, 8
    v_lshlrev_b32 v0, 3, v0
    buffer_load_dwordx2 v[4:5], v0, s[8:11], s90 offen sc1
    s_waitcnt vmcnt(0)
    s_mov_b32 s3, 1048576
m_spin36:
    v_cmp_ne_u64 s[22:23], s[4:5], v[4:5]
    s_nop 3
    s_cmp_eq_u64 s[22:23], 0
    s_cbranch_scc1 m_ok37
    s_sub_u32 s3, s3, 1
    s_cbranch_scc1 m_ok37
    s_sleep 16
    s_and_b32 s92, s2, 7
    s_lshl_b32 s92, s92, 2
    s_bfe_u32 s93, s2, 0x20003
    s_add_u32 s92, s92, s93
    s_lshr_b32 s93, s2, 5
    s_lshl_b32 s93, s93, 2
    s_or_b32 s93, s93, 0x40000
    s_lshr_b32 s90, s92, 1
    s_lshl_b32 s90, s90, 7
    s_add_u32 s90, s90, 117440512
    s_bfe_u32 s91, 873473623, s93
    s_lshr_b32 s91, s91, 1
    v_mov_b32 v0, s91
    v_add_u32 v4, 8, v1
    v_cmp_gt_u32 vcc, 8, v1
    s_nop 1
    v_cndmask_b32 v0, v0, v4, vcc
    s_bfe_u32 s91, 4225681832, s93
    s_lshr_b32 s91, s91, 1
    v_writelane_b32 v0, s91, 8
    v_lshlrev_b32 v0, 3, v0
    buffer_load_dwordx2 v[4:5], v0, s[8:11], s90 offen sc1
    s_waitcnt vmcnt(0)
    s_branch m_spin36
m_ok37:
m_pw35:
    s_barrier
    s_and_b32 s92, s2, 7
    s_lshl_b32 s92, s92, 2
    s_bfe_u32 s93, s2, 0x20003
    s_add_u32 s92, s92, s93
    s_lshr_b32 s93, s2, 5
    s_lshl_b32 s93, s93, 2
    s_or_b32 s93, s93, 0x40000
    s_bfe_u32 s90, 4225681832, s93
    s_lshl_b32 s90, s90, 3
    s_lshl_b32 s91, s16, 1
    s_add_u32 s90, s90, s91
    s_lshl_b32 s90, s90, 12
    s_lshl_b32 s91, s92, 19
    s_add_u32 s90, s90, s91
    s_add_u32 s90, s90, 0
    buffer_load_dwordx4 a[128:131], v2, s[8:11], s90 offen offset:0 sc1
    buffer_load_dwordx4 a[132:135], v2, s[8:11], s90 offen offset:1024 sc1
    buffer_load_dwordx4 a[136:139], v2, s[8:11], s90 offen offset:2048 sc1
    buffer_load_dwordx4 a[140:143], v2, s[8:11], s90 offen offset:3072 sc1
    s_bfe_u32 s90, 4225681832, s93
    s_lshl_b32 s90, s90, 3
    s_lshl_b32 s91, s16, 1
    s_add_u32 s90, s90, s91
    s_lshl_b32 s90, s90, 12
    s_lshl_b32 s91, s92, 19
    s_add_u32 s90, s90, s91
    s_add_u32 s90, s90, 4096
    buffer_load_dwordx4 a[144:147], v2, s[8:11], s90 offen offset:0 sc1
    buffer_load_dwordx4 a[148:151], v2, s[8:11], s90 offen offset:1024 sc1
    buffer_load_dwordx4 a[152:155], v2, s[8:11], s90 offen offset:2048 sc1
    buffer_load_dwordx4 a[156:159], v2, s[8:11], s90 offen offset:3072 sc1
    s_bfe_u32 s90, 873473623, s93
    s_lshl_b32 s90, s90, 3
    s_lshl_b32 s91, s16, 1
    s_add_u32 s90, s90, s91
    s_lshl_b32 s90, s90, 12
    s_lshl_b32 s91, s92, 19
    s_add_u32 s90, s90, s91
    s_add_u32 s90, s90, 0
    buffer_load_dwordx4 a[160:163], v2, s[8:11], s90 offen offset:0 sc1
    buffer_load_dwordx4 a[164:167], v2, s[8:11], s90 offen offset:1024 sc1
    buffer_load_dwordx4 a[168:171], v2, s[8:11], s90 offen offset:2048 sc1
    buffer_load_dwordx4 a[172:175], v2, s[8:11], s90 offen offset:3072 sc1
    s_bfe_u32 s90, 873473623, s93
    s_lshl_b32 s90, s90, 3
    s_lshl_b32 s91, s16, 1
    s_add_u32 s90, s90, s91
    s_lshl_b32 s90, s90, 12
    s_lshl_b32 s91, s92, 19
    s_add_u32 s90, s90, s91
    s_add_u32 s90, s90, 4096
    buffer_load_dwordx4 a[176:179], v2, s[8:11], s90 offen offset:0 sc1
    buffer_load_dwordx4 a[180:183], v2, s[8:11], s90 offen offset:1024 sc1
    buffer_load_dwordx4 a[184:187], v2, s[8:11], s90 offen offset:2048 sc1
    buffer_load_dwordx4 a[188:191], v2, s[8:11], s90 offen offset:3072 sc1
    s_mov_b32 s94, 1
m_kvl27:
    s_waitcnt lgkmcnt(0)
    s_and_b32 s92, s2, 7
    s_lshl_b32 s92, s92, 2
    s_bfe_u32 s93, s2, 0x20003
    s_add_u32 s92, s92, s93
    s_lshr_b32 s93, s2, 5
    s_lshl_b32 s93, s93, 2
    s_or_b32 s93, s93, 0x40000
    s_mov_b32 s32, s92
    s_bfe_u32 s33, 4225681832, s93
    s_add_u32 s33, s33, 1
    s_bfe_u32 s34, 873473623, s93
    s_add_u32 s34, s34, 1
    s_lshl_b32 s60, s16, 12
    v_add_u32 v7, s60, v2
    s_lshl_b32 s90, s34, 2
    s_lshl_b32 s91, s33, 2
    s_lshl_b32 s26, s91, 13
    s_mov_b32 s30, s26
    s_sub_u32 s67, s90, 4
    s_add_u32 s67, s67, s16
    s_add_u32 s68, s67, 1
    s_mov_b32 s69, s90
    s_sub_u32 s70, s91, 4
    s_add_u32 s70, s70, s16
    s_add_u32 s71, s70, 1
    s_mov_b32 s72, s91
    s_cmp_lt_u32 s16, 2
    s_cselect_b32 s90, 2, 0
    s_sub_u32 s72, s72, s90
    s_mov_b32 s27, 0x20000
    s_mov_b32 s31, 0x20000
    s_lshl_b32 s82, s32, 19
    s_add_u32 s90, s82, 16777216
    s_add_u32 s24, s6, s90
    s_addc_u32 s25, s7, 0
    s_add_u32 s90, s82, 33554432
    s_add_u32 s28, s6, s90
    s_addc_u32 s29, s7, 0
    s_cmp_eq_u32 s94, 1
    s_cbranch_scc1 m_w068
    s_call_b64 s[20:21], m_epl66
    s_mov_b32 s17, s101
    s_mov_b32 s38, 268435456
    s_branch m_init26
m_w068:
    s_mov_b32 s56, 0
    s_mov_b32 s57, 0
    s_mov_b32 m0, s60
    s_nop 0
    buffer_load_dwordx4 v7, s[24:27], s56 offen offset:0 sc1 lds
    buffer_load_dwordx4 v7, s[24:27], s56 offen offset:1024 sc1 lds
    buffer_load_dwordx4 v7, s[24:27], s56 offen offset:2048 sc1 lds
    buffer_load_dwordx4 v7, s[24:27], s56 offen offset:3072 sc1 lds
    s_mov_b32 s56, 16384
    s_add_u32 s59, s60, 32768
    s_mov_b32 m0, s59
    s_nop 0
    buffer_load_dwordx4 v7, s[24:27], s56 offen offset:0 sc1 lds
    buffer_load_dwordx4 v7, s[24:27], s56 offen offset:1024 sc1 lds
    buffer_load_dwordx4 v7, s[24:27], s56 offen offset:2048 sc1 lds
    buffer_load_dwordx4 v7, s[24:27], s56 offen offset:3072 sc1 lds
    s_add_u32 s56, s56, 16384
    s_add_u32 m0, s59, 16384
    s_nop 0
    buffer_load_dwordx4 v7, s[28:31], s57 offen offset:0 sc1 lds
    buffer_load_dwordx4 v7, s[28:31], s57 offen offset:1024 sc1 lds
    buffer_load_dwordx4 v7, s[28:31], s57 offen offset:2048 sc1 lds
    buffer_load_dwordx4 v7, s[28:31], s57 offen offset:3072 sc1 lds
    s_add_u32 s57, s57, 16384
    s_add_u32 s59, s59, 32768
    s_mov_b32 m0, s59
    s_nop 0
    buffer_load_dwordx4 v7, s[24:27], s56 offen offset:0 sc1 lds
    buffer_load_dwordx4 v7, s[24:27], s56 offen offset:1024 sc1 lds
    buffer_load_dwordx4 v7, s[24:27], s56 offen offset:2048 sc1 lds
    buffer_load_dwordx4 v7, s[24:27], s56 offen offset:3072 sc1 lds
    s_add_u32 s56, s56, 16384
    s_add_u32 m0, s59, 16384
    s_nop 0
    buffer_load_dwordx4 v7, s[28:31], s57 offen offset:0 sc1 lds
    buffer_load_dwordx4 v7, s[28:31], s57 offen offset:1024 sc1 lds
    buffer_load_dwordx4 v7, s[28:31], s57 offen offset:2048 sc1 lds
    buffer_load_dwordx4 v7, s[28:31], s57 offen offset:3072 sc1 lds
    s_add_u32 s57, s57, 16384
    s_add_u32 s59, s59, 32768
    s_mov_b32 m0, s59
    s_nop 0
    buffer_load_dwordx4 v7, s[24:27], s56 offen offset:0 sc1 lds
    buffer_load_dwordx4 v7, s[24:27], s56 offen offset:1024 sc1 lds
    buffer_load_dwordx4 v7, s[24:27], s56 offen offset:2048 sc1 lds
    buffer_load_dwordx4 v7, s[24:27], s56 offen offset:3072 sc1 lds
    s_add_u32 s56, s56, 16384
    s_add_u32 m0, s59, 16384
    s_nop 0
    buffer_load_dwordx4 v7, s[28:31], s57 offen offset:0 sc1 lds
    buffer_load_dwordx4 v7, s[28:31], s57 offen offset:1024 sc1 lds
    buffer_load_dwordx4 v7, s[28:31], s57 offen offset:2048 sc1 lds
    buffer_load_dwordx4 v7, s[28:31], s57 offen offset:3072 sc1 lds
    s_add_u32 s57, s57, 16384
    s_add_u32 s59, s59, 32768
    s_mov_b32 m0, s59
    s_nop 0
    buffer_load_dwordx4 v7, s[24:27], s56 offen offset:0 sc1 lds
    buffer_load_dwordx4 v7, s[24:27], s56 offen offset:1024 sc1 lds
    buffer_load_dwordx4 v7, s[24:27], s56 offen offset:2048 sc1 lds
    buffer_load_dwordx4 v7, s[24:27], s56 offen offset:3072 sc1 lds
    s_add_u32 s56, s56, 16384
    s_add_u32 m0, s59, 16384
    s_nop 0
    buffer_load_dwordx4 v7, s[28:31], s57 offen offset:0 sc1 lds
    buffer_load_dwordx4 v7, s[28:31], s57 offen offset:1024 sc1 lds
    buffer_load_dwordx4 v7, s[28:31], s57 offen offset:2048 sc1 lds
    buffer_load_dwordx4 v7, s[28:31], s57 offen offset:3072 sc1 lds
    s_add_u32 s57, s57, 16384
    s_add_u32 s59, s59, 32768
    s_waitcnt vmcnt(0)
    s_mov_b32 s38, 0
m_init26:
    s_mov_b32 s56, 81920
    s_mov_b32 s57, 65536
    s_nop 1
    v_mov_b32 v9, 0xff800000
    s_mov_b32 s65, 1233125376
    s_lshl_b32 s91, s16, 1
    s_sub_u32 s91, s91, 8
    s_lshl_b32 s78, s33, 3
    s_add_u32 s78, s78, s91
    s_lshl_b32 s79, s34, 3
    s_add_u32 s79, s79, s91
    s_mov_b32 s36, s6
    s_mov_b32 s37, s7
    s_mov_b32 s39, 0x20000
    s_load_dwordx2 s[48:49], s[0:1], 64
    s_load_dwordx2 s[50:51], s[0:1], 16
    s_load_dwordx2 s[54:55], s[0:1], 72
    s_mov_b32 s47, 0x20000
    s_lshl_b32 s90, s99, 1
    s_add_u32 s98, s98, s90
    s_lshl_b32 s90, s100, 2
    s_add_u32 s40, s98, s90
    s_lshr_b32 s90, s32, 1
    s_lshl_b32 s90, s90, 7
    s_add_u32 s90, s90, 117444608
    s_lshr_b32 s91, s2, 6
    s_lshl_b32 s91, s91, 8
    s_add_u32 s91, s91, 117446592
    v_min_u32 v10, 31, v1
    v_lshlrev_b32 v10, 3, v10
    v_mov_b32 v11, s90
    v_mov_b32 v8, s91
    v_cmp_gt_u32 vcc, 8, v1
    s_nop 1
    v_cndmask_b32 v11, v8, v11, vcc
    v_add_u32 v10, v10, v11
    s_mov_b32 s58, 0
    v_mov_b32 v6, v2
    v_accvgpr_write_b32 a0, 0
    v_accvgpr_write_b32 a1, 0
    v_accvgpr_write_b32 a2, 0
    v_accvgpr_write_b32 a3, 0
    v_accvgpr_write_b32 a4, 0
    v_accvgpr_write_b32 a5, 0
    v_accvgpr_write_b32 a6, 0
    v_accvgpr_write_b32 a7, 0
    v_accvgpr_write_b32 a8, 0
    v_accvgpr_write_b32 a9, 0
    v_accvgpr_write_b32 a10, 0
    v_accvgpr_write_b32 a11, 0
    v_accvgpr_write_b32 a12, 0
    v_accvgpr_write_b32 a13, 0
    v_accvgpr_write_b32 a14, 0
    v_accvgpr_write_b32 a15, 0
    v_accvgpr_write_b32 a16, 0
    v_accvgpr_write_b32 a17, 0
    v_accvgpr_write_b32 a18, 0
    v_accvgpr_write_b32 a19, 0
    v_accvgpr_write_b32 a20, 0
    v_accvgpr_write_b32 a21, 0
    v_accvgpr_write_b32 a22, 0
    v_accvgpr_write_b32 a23, 0
    v_accvgpr_write_b32 a24, 0
    v_accvgpr_write_b32 a25, 0
    v_accvgpr_write_b32 a26, 0
    v_accvgpr_write_b32 a27, 0
    v_accvgpr_write_b32 a28, 0
    v_accvgpr_write_b32 a29, 0
    v_accvgpr_write_b32 a30, 0
    v_accvgpr_write_b32 a31, 0
    v_accvgpr_write_b32 a32, 0
    v_accvgpr_write_b32 a33, 0
    v_accvgpr_write_b32 a34, 0
    v_accvgpr_write_b32 a35, 0
    v_accvgpr_write_b32 a36, 0
    v_accvgpr_write_b32 a37, 0
    v_accvgpr_write_b32 a38, 0
    v_accvgpr_write_b32 a39, 0
    v_accvgpr_write_b32 a40, 0
    v_accvgpr_write_b32 a41, 0
    v_accvgpr_write_b32 a42, 0
    v_accvgpr_write_b32 a43, 0
    v_accvgpr_write_b32 a44, 0
    v_accvgpr_write_b32 a45, 0
    v_accvgpr_write_b32 a46, 0
    v_accvgpr_write_b32 a47, 0
    v_accvgpr_write_b32 a48, 0
    v_accvgpr_write_b32 a49, 0
    v_accvgpr_write_b32 a50, 0
    v_accvgpr_write_b32 a51, 0
    v_accvgpr_write_b32 a52, 0
    v_accvgpr_write_b32 a53, 0
    v_accvgpr_write_b32 a54, 0
    v_accvgpr_write_b32 a55, 0
    v_accvgpr_write_b32 a56, 0
    v_accvgpr_write_b32 a57, 0
    v_accvgpr_write_b32 a58, 0
    v_accvgpr_write_b32 a59, 0
    v_accvgpr_write_b32 a60, 0
    v_accvgpr_write_b32 a61, 0
    v_accvgpr_write_b32 a62, 0
    v_accvgpr_write_b32 a63, 0
    v_accvgpr_write_b32 a64, 0
    v_accvgpr_write_b32 a65, 0
    v_accvgpr_write_b32 a66, 0
    v_accvgpr_write_b32 a67, 0
    v_accvgpr_write_b32 a68, 0
    v_accvgpr_write_b32 a69, 0
    v_accvgpr_write_b32 a70, 0
    v_accvgpr_write_b32 a71, 0
    v_accvgpr_write_b32 a72, 0
    v_accvgpr_write_b32 a73, 0
    v_accvgpr_write_b32 a74, 0
    v_accvgpr_write_b32 a75, 0
    v_accvgpr_write_b32 a76, 0
    v_accvgpr_write_b32 a77, 0
    v_accvgpr_write_b32 a78, 0
    v_accvgpr_write_b32 a79, 0
    v_mov_b64 v[160:161], 0
    v_mov_b64 v[162:163], 0
    v_mov_b64 v[164:165], 0
    v_mov_b64 v[166:167], 0
    v_mov_b64 v[168:169], 0
    v_mov_b64 v[170:171], 0
    v_mov_b64 v[172:173], 0
    v_mov_b64 v[174:175], 0
    v_mov_b64 v[176:177], 0
    v_mov_b64 v[178:179], 0
    v_mov_b64 v[180:181], 0
    v_mov_b64 v[182:183], 0
    v_mov_b64 v[184:185], 0
    v_mov_b64 v[186:187], 0
    v_mov_b64 v[188:189], 0
    v_mov_b64 v[190:191], 0
    v_mov_b32 v12, 0
    v_mov_b32 v28, 0
    v_mov_b32 v44, 0x3f803f80
    v_mov_b32 v13, 0
    v_mov_b32 v32, 0
    v_mov_b32 v45, 0x3f803f80
    v_mov_b32 v14, 0
    v_mov_b32 v36, 0
    v_mov_b32 v46, 0x3f803f80
    v_mov_b32 v15, 0
    v_mov_b32 v40, 0
    v_mov_b32 v47, 0x3f803f80
    s_and_b32 s90, s2, 7
    s_lshl_b32 s90, s90, 4
    s_lshl_b32 s91, s16, 2
    s_add_u32 s80, s90, s91
    s_lshr_b32 s92, s2, 3
    s_lshl_b32 s92, s92, 17
    s_lshl_b32 s90, s80, 10
    s_add_u32 s90, s90, s92
    s_add_u32 s83, s90, 50331648
    s_add_u32 s84, s90, 54525952
    s_and_b32 s81, s80, 63
    s_cmp_eq_u32 s81, 0
    s_cselect_b32 s93, 0, 1024
    s_sub_u32 s85, s84, s93
    s_lshl_b32 s90, s80, 9
    s_add_u32 s90, s90, s92
    s_add_u32 s86, s90, 58720256
    s_sub_u32 s87, s86, s93
    s_add_u32 s88, s86, 65536
    s_add_u32 s89, s87, 65536
    v_and_b32 v48, 15, v1
    v_lshrrev_b32 v49, 4, v1
    v_lshlrev_b32 v49, 2, v49
    v_sub_u32 v48, v48, v49
    v_cmp_le_i32 vcc, 0, v48
    s_nop 1
    v_cndmask_b32 v16, v9, 0, vcc
    v_cmp_le_i32 vcc, 1, v48
    s_nop 1
    v_cndmask_b32 v17, v9, 0, vcc
    v_cmp_le_i32 vcc, 2, v48
    s_nop 1
    v_cndmask_b32 v18, v9, 0, vcc
    v_cmp_le_i32 vcc, 3, v48
    s_nop 1
    v_cndmask_b32 v19, v9, 0, vcc
    s_mov_b32 s62, 8945792
    s_mov_b32 s63, 0
    s_sub_u32 s90, s67, 1
    s_bitset1_b64 s[62:63], s90
    s_sub_u32 s90, s68, 1
    s_bitset1_b64 s[62:63], s90
    s_sub_u32 s90, s69, 1
    s_bitset1_b64 s[62:63], s90
    s_sub_u32 s90, s70, 1
    s_bitset1_b64 s[62:63], s90
    s_sub_u32 s90, s71, 1
    s_bitset1_b64 s[62:63], s90
    s_sub_u32 s90, s72, 1
    s_bitset1_b64 s[62:63], s90
    s_add_u32 s53, s69, 8
    s_sub_u32 s90, s53, 1
    s_bitset1_b64 s[62:63], s90
    s_mov_b32 s64, 0
    s_cmp_lg_u32 s64, s67
    s_cbranch_scc1 m_e73
    v_add_f32 v176, v176, v16
    v_mov_b32 v180, v9
    v_add_f32 v188, v188, v16
    v_add_f32 v177, v177, v17
    v_mov_b32 v181, v9
    v_add_f32 v189, v189, v17
    v_add_f32 v178, v178, v18
    v_mov_b32 v182, v9
    v_add_f32 v190, v190, v18
    v_add_f32 v179, v179, v19
    v_mov_b32 v183, v9
    v_add_f32 v191, v191, v19
    s_nop 0
m_e73:
    s_waitcnt vmcnt(32) lgkmcnt(0)
    s_barrier
    ds_read_b128 a[192:195], v6 offset:0
    ds_read_b128 a[196:199], v6 offset:1024
    ds_read_b128 a[200:203], v6 offset:2048
    ds_read_b128 a[204:207], v6 offset:3072
    ds_read_b128 a[208:211], v6 offset:4096
    ds_read_b128 a[212:215], v6 offset:5120
    ds_read_b128 a[216:219], v6 offset:6144
    ds_read_b128 a[220:223], v6 offset:7168
    s_waitcnt lgkmcnt(0)
    v_mfma_f32_16x16x32_bf16 v[64:67], a[192:195], a[128:131], v[160:163]
    v_accvgpr_write_b32 a80, 0
    v_accvgpr_write_b32 a81, 0
    v_mfma_f32_16x16x32_bf16 v[64:67], a[196:199], a[132:135], v[64:67]
    buffer_store_dwordx4 v[192:195], v2, s[36:39], s40 offen sc1
    s_add_u32 s40, s40, s100
    v_mfma_f32_16x16x32_bf16 v[64:67], a[200:203], a[136:139], v[64:67]
    v_accvgpr_write_b32 a82, 0
    v_accvgpr_write_b32 a83, 0
    v_mfma_f32_16x16x32_bf16 v[64:67], a[204:207], a[140:143], v[64:67]
    v_accvgpr_write_b32 a84, 0
    v_accvgpr_write_b32 a85, 0
    v_mfma_f32_16x16x32_bf16 v[72:75], a[204:207], a[156:159], v[168:171]
    v_accvgpr_write_b32 a86, 0
    v_accvgpr_write_b32 a87, 0
    v_mfma_f32_16x16x32_bf16 v[72:75], a[200:203], a[152:155], v[72:75]
    buffer_store_dwordx4 v[196:199], v2, s[36:39], s40 offen sc1
    s_add_u32 s40, s40, s100
    v_mfma_f32_16x16x32_bf16 v[72:75], a[196:199], a[148:151], v[72:75]
    v_accvgpr_write_b32 a88, 0
    v_accvgpr_write_b32 a89, 0
    v_mfma_f32_16x16x32_bf16 v[72:75], a[192:195], a[144:147], v[72:75]
    v_accvgpr_write_b32 a90, 0
    v_accvgpr_write_b32 a91, 0
    v_mfma_f32_16x16x32_bf16 v[80:83], a[192:195], a[160:163], v[176:179]
    v_accvgpr_write_b32 a92, 0
    v_accvgpr_write_b32 a93, 0
    v_mfma_f32_16x16x32_bf16 v[80:83], a[196:199], a[164:167], v[80:83]
    buffer_store_dwordx4 v[200:203], v2, s[36:39], s40 offen sc1
    s_add_u32 s40, s40, s100
    v_mfma_f32_16x16x32_bf16 v[80:83], a[200:203], a[168:171], v[80:83]
    v_accvgpr_write_b32 a94, 0
    v_accvgpr_write_b32 a95, 0
    v_mfma_f32_16x16x32_bf16 v[80:83], a[204:207], a[172:175], v[80:83]
    v_accvgpr_write_b32 a96, 0
    v_accvgpr_write_b32 a97, 0
    v_mfma_f32_16x16x32_bf16 v[88:91], a[204:207], a[188:191], v[184:187]
    v_accvgpr_write_b32 a98, 0
    v_accvgpr_write_b32 a99, 0
    v_mfma_f32_16x16x32_bf16 v[88:91], a[200:203], a[184:187], v[88:91]
    buffer_store_dwordx4 v[204:207], v2, s[36:39], s40 offen sc1
    s_add_u32 s40, s98, s99
    v_mfma_f32_16x16x32_bf16 v[88:91], a[196:199], a[180:183], v[88:91]
    v_accvgpr_write_b32 a100, 0
    v_accvgpr_write_b32 a101, 0
    v_mfma_f32_16x16x32_bf16 v[88:91], a[192:195], a[176:179], v[88:91]
    v_accvgpr_write_b32 a102, 0
    v_accvgpr_write_b32 a103, 0
    v_mfma_f32_16x16x32_bf16 v[92:95], a[208:211], a[176:179], v[188:191]
    ds_read_b128 a[192:195], v6 offset:8192
    v_accvgpr_write_b32 a104, 0
    v_accvgpr_write_b32 a105, 0
    v_mfma_f32_16x16x32_bf16 v[92:95], a[212:215], a[180:183], v[92:95]
    buffer_store_dwordx4 v[208:211], v2, s[36:39], s40 offen sc1
    s_add_u32 s40, s40, s100
    ds_read_b128 a[196:199], v6 offset:9216
    v_mfma_f32_16x16x32_bf16 v[92:95], a[216:219], a[184:187], v[92:95]
    ds_read_b128 a[200:203], v6 offset:10240
    v_accvgpr_write_b32 a106, 0
    v_accvgpr_write_b32 a107, 0
    v_mfma_f32_16x16x32_bf16 v[92:95], a[220:223], a[188:191], v[92:95]
    ds_read_b128 a[204:207], v6 offset:11264
    v_accvgpr_write_b32 a108, 0
    v_accvgpr_write_b32 a109, 0
    v_mfma_f32_16x16x32_bf16 v[84:87], a[220:223], a[172:175], v[180:183]
    v_accvgpr_write_b32 a110, 0
    v_accvgpr_write_b32 a111, 0
    v_mfma_f32_16x16x32_bf16 v[84:87], a[216:219], a[168:171], v[84:87]
    buffer_store_dwordx4 v[212:215], v2, s[36:39], s40 offen sc1
    s_add_u32 s40, s40, s100
    v_mfma_f32_16x16x32_bf16 v[84:87], a[212:215], a[164:167], v[84:87]
    v_accvgpr_write_b32 a112, 0
    v_accvgpr_write_b32 a113, 0
    v_mfma_f32_16x16x32_bf16 v[84:87], a[208:211], a[160:163], v[84:87]
    v_accvgpr_write_b32 a114, 0
    v_accvgpr_write_b32 a115, 0
    v_mfma_f32_16x16x32_bf16 v[76:79], a[208:211], a[144:147], v[172:175]
    v_accvgpr_write_b32 a116, 0
    v_accvgpr_write_b32 a117, 0
    v_mfma_f32_16x16x32_bf16 v[76:79], a[212:215], a[148:151], v[76:79]
    buffer_store_dwordx4 v[216:219], v2, s[36:39], s40 offen sc1
    s_add_u32 s40, s40, s100
    v_mfma_f32_16x16x32_bf16 v[76:79], a[216:219], a[152:155], v[76:79]
    v_accvgpr_write_b32 a118, 0
    v_accvgpr_write_b32 a119, 0
    v_mfma_f32_16x16x32_bf16 v[76:79], a[220:223], a[156:159], v[76:79]
    v_accvgpr_write_b32 a120, 0
    v_accvgpr_write_b32 a121, 0
    v_mfma_f32_16x16x32_bf16 v[68:71], a[220:223], a[140:143], v[164:167]
    v_accvgpr_write_b32 a122, 0
    v_accvgpr_write_b32 a123, 0
    v_mfma_f32_16x16x32_bf16 v[68:71], a[216:219], a[136:139], v[68:71]
    buffer_store_dwordx4 v[220:223], v2, s[36:39], s40 offen sc1
    s_add_u32 s40, s40, s100
    v_mfma_f32_16x16x32_bf16 v[68:71], a[212:215], a[132:135], v[68:71]
    v_accvgpr_write_b32 a124, 0
    v_accvgpr_write_b32 a125, 0
    v_mfma_f32_16x16x32_bf16 v[68:71], a[208:211], a[128:131], v[68:71]
    v_accvgpr_write_b32 a126, 0
    v_accvgpr_write_b32 a127, 0
    ds_read_b128 a[208:211], v6 offset:12288
    ds_read_b128 a[212:215], v6 offset:13312
    ds_read_b128 a[216:219], v6 offset:14336
    ds_read_b128 a[220:223], v6 offset:15360
    s_mov_b32 s64, 1
    s_nop 0
    s_nop 3
    v_max3_f32 v48, v64, v65, v66
    v_max3_f32 v49, v72, v73, v74
    v_max3_f32 v50, v80, v81, v82
    v_max3_f32 v51, v88, v89, v90
    v_max3_f32 v48, v48, v67, v68
    v_max3_f32 v49, v49, v75, v76
    v_max3_f32 v50, v50, v83, v84
    v_max3_f32 v51, v51, v91, v92
    v_max3_f32 v48, v48, v69, v70
    v_max3_f32 v49, v49, v77, v78
    v_max3_f32 v50, v50, v85, v86
    v_max3_f32 v51, v51, v93, v94
    v_max_f32 v48, v48, v71
    v_max_f32 v49, v49, v79
    v_max_f32 v50, v50, v87
    v_max_f32 v51, v51, v95
    v_mov_b32 v52, v48
    v_mov_b32 v53, v49
    v_mov_b32 v54, v50
    v_mov_b32 v55, v51
    s_nop 1
    v_permlane32_swap_b32 v48, v52
    v_permlane32_swap_b32 v49, v53
    v_permlane32_swap_b32 v50, v54
    v_permlane32_swap_b32 v51, v55
    s_nop 1
    v_max_f32 v48, v48, v52
    v_max_f32 v49, v49, v53
    v_max_f32 v50, v50, v54
    v_max_f32 v51, v51, v55
    v_mov_b32 v52, v48
    v_mov_b32 v53, v49
    v_mov_b32 v54, v50
    v_mov_b32 v55, v51
    s_nop 1
    v_permlane16_swap_b32 v48, v52
    v_permlane16_swap_b32 v49, v53
    v_permlane16_swap_b32 v50, v54
    v_permlane16_swap_b32 v51, v55
    s_nop 1
    v_max_f32 v48, v48, v52
    v_max_f32 v49, v49, v53
    v_max_f32 v50, v50, v54
    v_max_f32 v51, v51, v55
    v_sub_f32 v160, v160, v48
    v_sub_f32 v161, v161, v48
    v_sub_f32 v162, v162, v48
    v_sub_f32 v163, v163, v48
    v_sub_f32 v164, v164, v48
    v_sub_f32 v165, v165, v48
    v_sub_f32 v166, v166, v48
    v_sub_f32 v167, v167, v48
    v_sub_f32 v168, v168, v49
    v_sub_f32 v169, v169, v49
    v_sub_f32 v170, v170, v49
    v_sub_f32 v171, v171, v49
    v_sub_f32 v172, v172, v49
    v_sub_f32 v173, v173, v49
    v_sub_f32 v174, v174, v49
    v_sub_f32 v175, v175, v49
    v_sub_f32 v176, v176, v50
    v_sub_f32 v177, v177, v50
    v_sub_f32 v178, v178, v50
    v_sub_f32 v179, v179, v50
    v_sub_f32 v180, v180, v50
    v_sub_f32 v181, v181, v50
    v_sub_f32 v182, v182, v50
    v_sub_f32 v183, v183, v50
    v_sub_f32 v184, v184, v51
    v_sub_f32 v185, v185, v51
    v_sub_f32 v186, v186, v51
    v_sub_f32 v187, v187, v51
    v_sub_f32 v188, v188, v51
    v_sub_f32 v189, v189, v51
    v_sub_f32 v190, v190, v51
    v_sub_f32 v191, v191, v51
    v_sub_f32 v64, v64, v48
    v_sub_f32 v65, v65, v48
    v_sub_f32 v66, v66, v48
    v_sub_f32 v67, v67, v48
    v_sub_f32 v68, v68, v48
    v_sub_f32 v69, v69, v48
    v_sub_f32 v70, v70, v48
    v_sub_f32 v71, v71, v48
    v_sub_f32 v72, v72, v49
    v_sub_f32 v73, v73, v49
    v_sub_f32 v74, v74, v49
    v_sub_f32 v75, v75, v49
    v_sub_f32 v76, v76, v49
    v_sub_f32 v77, v77, v49
    v_sub_f32 v78, v78, v49
    v_sub_f32 v79, v79, v49
    v_sub_f32 v80, v80, v50
    v_sub_f32 v81, v81, v50
    v_sub_f32 v82, v82, v50
    v_sub_f32 v83, v83, v50
    v_sub_f32 v84, v84, v50
    v_sub_f32 v85, v85, v50
    v_sub_f32 v86, v86, v50
    v_sub_f32 v87, v87, v50
    v_sub_f32 v88, v88, v51
    v_sub_f32 v89, v89, v51
    v_sub_f32 v90, v90, v51
    v_sub_f32 v91, v91, v51
    v_sub_f32 v92, v92, v51
    v_sub_f32 v93, v93, v51
    v_sub_f32 v94, v94, v51
    v_sub_f32 v95, v95, v51
    s_cmp_lg_u32 s64, s67
    s_cbranch_scc1 m_e74
    v_add_f32 v176, v176, v16
    v_mov_b32 v180, v9
    v_add_f32 v188, v188, v16
    v_add_f32 v177, v177, v17
    v_mov_b32 v181, v9
    v_add_f32 v189, v189, v17
    v_add_f32 v178, v178, v18
    v_mov_b32 v182, v9
    v_add_f32 v190, v190, v18
    v_add_f32 v179, v179, v19
    v_mov_b32 v183, v9
    v_add_f32 v191, v191, v19
    s_nop 0
m_e74:
    s_cmp_lg_u32 s64, s68
    s_cbranch_scc1 m_e75
    v_mov_b32 v176, v9
    v_mov_b32 v184, v9
    v_mov_b32 v188, v9
    v_mov_b32 v177, v9
    v_mov_b32 v185, v9
    v_mov_b32 v189, v9
    v_mov_b32 v178, v9
    v_mov_b32 v186, v9
    v_mov_b32 v190, v9
    v_mov_b32 v179, v9
    v_mov_b32 v187, v9
    v_mov_b32 v191, v9
    s_nop 0
m_e75:
    s_waitcnt lgkmcnt(0)
    v_mfma_f32_16x16x32_bf16 v[96:99], a[192:195], a[128:131], v[160:163]
    s_bitcmp1_b64 s[62:63], s64
    s_cselect_b32 s66, -1.0, s65
    v_exp_f32 v20, v64
    v_mfma_f32_16x16x32_bf16 v[96:99], a[196:199], a[132:135], v[96:99]
    s_add_u32 s64, s64, 1
    v_exp_f32 v21, v65
    v_exp_f32 v22, v66
    v_mfma_f32_16x16x32_bf16 v[96:99], a[200:203], a[136:139], v[96:99]
    buffer_store_dwordx4 v[224:227], v2, s[36:39], s40 offen sc1
    v_cvt_pk_bf16_f32 v128, v20, v21
    v_mfma_f32_16x16x32_bf16 v[96:99], a[204:207], a[140:143], v[96:99]
    s_add_u32 s40, s40, s100
    v_add_f32 v12, v12, v28
    v_exp_f32 v23, v67
    v_mfma_f32_16x16x32_bf16 v[104:107], a[204:207], a[156:159], v[168:171]
    v_exp_f32 v24, v68
    v_cvt_pk_bf16_f32 v129, v22, v23
    v_mfma_f32_16x16x32_bf16 v[104:107], a[200:203], a[152:155], v[104:107]
    buffer_store_dwordx4 v[228:231], v2, s[36:39], s40 offen sc1
    v_exp_f32 v25, v69
    v_mfma_f32_16x16x32_bf16 v[104:107], a[196:199], a[148:151], v[104:107]
    s_add_u32 s40, s40, s100
    v_exp_f32 v26, v70
    v_cvt_pk_bf16_f32 v130, v24, v25
    v_mfma_f32_16x16x32_bf16 v[104:107], a[192:195], a[144:147], v[104:107]
    v_exp_f32 v27, v71
    v_add_f32 v13, v13, v32
    v_mfma_f32_16x16x32_bf16 v[112:115], a[192:195], a[160:163], v[176:179]
    v_exp_f32 v20, v72
    v_cvt_pk_bf16_f32 v131, v26, v27
    v_mfma_f32_16x16x32_bf16 v[112:115], a[196:199], a[164:167], v[112:115]
    buffer_store_dwordx4 v[232:235], v2, s[36:39], s40 offen sc1
    v_exp_f32 v21, v73
    v_mfma_f32_16x16x32_bf16 v[28:31], v[44:47], v[128:131], 0
    v_exp_f32 v22, v74
    v_cvt_pk_bf16_f32 v132, v20, v21
    v_mfma_f32_16x16x32_bf16 v[112:115], a[200:203], a[168:171], v[112:115]
    s_add_u32 s40, s40, s100
    v_exp_f32 v23, v75
    v_add_f32 v14, v14, v36
    v_mfma_f32_16x16x32_bf16 v[112:115], a[204:207], a[172:175], v[112:115]
    v_exp_f32 v24, v76
    v_cvt_pk_bf16_f32 v133, v22, v23
    v_mfma_f32_16x16x32_bf16 v[120:123], a[204:207], a[188:191], v[184:187]
    buffer_store_dwordx4 v[236:239], v2, s[36:39], s40 offen sc1
    v_exp_f32 v25, v77
    v_mfma_f32_16x16x32_bf16 v[120:123], a[200:203], a[184:187], v[120:123]
    s_mov_b32 s40, s98
    v_exp_f32 v26, v78
    v_cvt_pk_bf16_f32 v134, v24, v25
    v_mfma_f32_16x16x32_bf16 v[120:123], a[196:199], a[180:183], v[120:123]
    v_exp_f32 v27, v79
    v_add_f32 v15, v15, v40
    v_mfma_f32_16x16x32_bf16 v[120:123], a[192:195], a[176:179], v[120:123]
    s_waitcnt lgkmcnt(0)
    v_exp_f32 v20, v80
    v_cvt_pk_bf16_f32 v135, v26, v27
    v_mfma_f32_16x16x32_bf16 v[124:127], a[208:211], a[176:179], v[188:191]
    v_exp_f32 v21, v81
    v_exp_f32 v22, v82
    v_mfma_f32_16x16x32_bf16 v[32:35], v[44:47], v[132:135], 0
    v_cvt_pk_bf16_f32 v136, v20, v21
    v_exp_f32 v23, v83
    v_mfma_f32_16x16x32_bf16 v[124:127], a[212:215], a[180:183], v[124:127]
    buffer_store_dwordx4 v[240:243], v2, s[36:39], s40 offen sc1
    v_cvt_pk_bf16_f32 v137, v22, v23
    v_mfma_f32_16x16x32_bf16 v[124:127], a[216:219], a[184:187], v[124:127]
    s_add_u32 s40, s40, s100
    v_exp_f32 v24, v84
    v_mfma_f32_16x16x32_bf16 v[124:127], a[220:223], a[188:191], v[124:127]
    v_exp_f32 v25, v85
    v_exp_f32 v26, v86
    v_cvt_pk_bf16_f32 v138, v24, v25
    v_mfma_f32_16x16x32_bf16 v[116:119], a[220:223], a[172:175], v[180:183]
    buffer_store_dwordx4 v[244:247], v2, s[36:39], s40 offen sc1
    v_mfma_f32_16x16x32_bf16 v[116:119], a[216:219], a[168:171], v[116:119]
    s_add_u32 s40, s40, s100
    v_exp_f32 v27, v87
    v_exp_f32 v20, v88
    v_mfma_f32_16x16x32_bf16 v[116:119], a[212:215], a[164:167], v[116:119]
    v_cvt_pk_bf16_f32 v139, v26, v27
    v_exp_f32 v21, v89
    v_mfma_f32_16x16x32_bf16 v[116:119], a[208:211], a[160:163], v[116:119]
    buffer_store_dwordx4 v[248:251], v2, s[36:39], s40 offen sc1
    v_exp_f32 v22, v90
    v_mfma_f32_16x16x32_bf16 v[36:39], v[44:47], v[136:139], 0
    v_cvt_pk_bf16_f32 v140, v20, v21
    v_exp_f32 v23, v91
    v_mfma_f32_16x16x32_bf16 v[108:111], a[208:211], a[144:147], v[172:175]
    s_add_u32 s40, s40, s100
    v_exp_f32 v24, v92
    v_cvt_pk_bf16_f32 v141, v22, v23
    v_mfma_f32_16x16x32_bf16 v[108:111], a[212:215], a[148:151], v[108:111]
    v_exp_f32 v25, v93
    v_mfma_f32_16x16x32_bf16 v[108:111], a[216:219], a[152:155], v[108:111]
    buffer_store_dwordx4 v[252:255], v2, s[36:39], s40 offen sc1
    v_exp_f32 v26, v94
    v_cvt_pk_bf16_f32 v142, v24, v25
    v_mfma_f32_16x16x32_bf16 v[108:111], a[220:223], a[156:159], v[108:111]
    s_add_u32 s40, s40, s100
    v_exp_f32 v27, v95
    s_nop 0
    v_cvt_pk_bf16_f32 v143, v26, v27
    s_nop 1
    v_mfma_f32_16x16x32_bf16 v[40:43], v[44:47], v[140:143], 0
    s_nop 2
    v_mfma_f32_16x16x32_bf16 v[100:103], a[220:223], a[140:143], v[164:167]
    s_nop 2
    v_mfma_f32_16x16x32_bf16 v[100:103], a[216:219], a[136:139], v[100:103]
    v_max3_f32 v8, v28, v32, v36
    v_max_f32 v8, v8, v40
    v_mfma_f32_16x16x32_bf16 v[100:103], a[212:215], a[132:135], v[100:103]
    v_cmp_nge_f32 vcc, s66, v8
    v_mfma_f32_16x16x32_bf16 v[100:103], a[208:211], a[128:131], v[100:103]
    s_waitcnt vmcnt(48) lgkmcnt(0)
    s_barrier
    s_add_u32 s59, s58, s60
    s_add_u32 s58, s58, 32768
    s_cmp_ge_u32 s58, 163840
    s_cselect_b32 s58, 0, s58
    v_add_u32 v6, s58, v2
    ds_read_b128 a[192:195], v6 offset:0
    ds_read_b128 a[196:199], v6 offset:1024
    ds_read_b128 a[200:203], v6 offset:2048
    ds_read_b128 a[204:207], v6 offset:3072
    ds_read_b128 a[208:211], v6 offset:4096
    ds_read_b128 a[212:215], v6 offset:5120
    ds_read_b128 a[216:219], v6 offset:6144
    ds_read_b128 a[220:223], v6 offset:7168
    s_waitcnt lgkmcnt(0)
    s_cbranch_vccnz m_stub76
m_ret77:
.p2align 3
m_dual78:
    v_mfma_f32_16x16x32_bf16 v[64:67], a[192:195], a[128:131], v[160:163]
    s_bitcmp1_b64 s[62:63], s64
    s_cselect_b32 s66, -1.0, s65
    v_add_f32 v12, v12, v28
    v_mfma_f32_16x16x32_bf16 v[64:67], a[196:199], a[132:135], v[64:67]
    s_add_u32 s64, s64, 1
    ds_read_b128 a[224:227], v6 offset:16384
    v_add_f32 v13, v13, v32
    v_mfma_f32_16x16x32_bf16 v[64:67], a[200:203], a[136:139], v[64:67]
    v_exp_f32 v20, v96
    v_mfma_f32_16x16x32_bf16 v[64:67], a[204:207], a[140:143], v[64:67]
    v_exp_f32 v21, v97
    v_mfma_f32_16x16x32_bf16 v[72:75], a[204:207], a[156:159], v[168:171]
    s_mov_b32 m0, s59
    ds_read_b128 a[228:231], v6 offset:17408
    v_cvt_pk_bf16_f32 v144, v20, v21
    v_mfma_f32_16x16x32_bf16 v[72:75], a[200:203], a[152:155], v[72:75]
    buffer_load_dwordx4 v7, s[24:27], s56 offen offset:0 sc1 lds
    v_mfma_f32_16x16x32_bf16 v[72:75], a[196:199], a[148:151], v[72:75]
    v_exp_f32 v22, v98
    v_mfma_f32_16x16x32_bf16 v[72:75], a[192:195], a[144:147], v[72:75]
    ds_read_b128 a[232:235], v6 offset:18432
    v_add_f32 v14, v14, v36
    v_mfma_f32_16x16x32_bf16 v[80:83], a[192:195], a[160:163], v[176:179]
    v_exp_f32 v23, v99
    v_mfma_f32_16x16x32_bf16 v[80:83], a[196:199], a[164:167], v[80:83]
    v_exp_f32 v24, v100
    v_mfma_f32_16x16x32_bf16 v[80:83], a[200:203], a[168:171], v[80:83]
    ds_read_b128 a[236:239], v6 offset:19456
    v_cvt_pk_bf16_f32 v145, v22, v23
    v_mfma_f32_16x16x32_bf16 v[80:83], a[204:207], a[172:175], v[80:83]
    v_exp_f32 v25, v101
    v_mfma_f32_16x16x32_bf16 v[88:91], a[204:207], a[188:191], v[184:187]
    v_exp_f32 v26, v102
    v_mfma_f32_16x16x32_bf16 v[88:91], a[200:203], a[184:187], v[88:91]
    ds_read_b128 a[240:243], v6 offset:20480
    v_cvt_pk_bf16_f32 v146, v24, v25
    v_mfma_f32_16x16x32_bf16 v[88:91], a[196:199], a[180:183], v[88:91]
    v_exp_f32 v27, v103
    v_mfma_f32_16x16x32_bf16 v[88:91], a[192:195], a[176:179], v[88:91]
    s_waitcnt lgkmcnt(5)
    v_exp_f32 v20, v104
    v_mfma_f32_16x16x32_bf16 v[92:95], a[208:211], a[176:179], v[188:191]
    ds_read_b128 a[244:247], v6 offset:21504
    v_cvt_pk_bf16_f32 v147, v26, v27
    v_mfma_f32_16x16x32_bf16 v[92:95], a[212:215], a[180:183], v[92:95]
    v_exp_f32 v21, v105
    v_mfma_f32_16x16x32_bf16 v[28:31], v[44:47], v[144:147], 0
    v_exp_f32 v22, v106
    v_mfma_f32_16x16x32_bf16 v[92:95], a[216:219], a[184:187], v[92:95]
    buffer_load_dwordx4 v7, s[24:27], s56 offen offset:1024 sc1 lds
    v_mfma_f32_16x16x32_bf16 v[92:95], a[220:223], a[188:191], v[92:95]
    ds_read_b128 a[248:251], v6 offset:22528
    v_cvt_pk_bf16_f32 v148, v20, v21
    v_mfma_f32_16x16x32_bf16 v[84:87], a[220:223], a[172:175], v[180:183]
    v_exp_f32 v23, v107
    v_mfma_f32_16x16x32_bf16 v[84:87], a[216:219], a[168:171], v[84:87]
    v_exp_f32 v24, v108
    v_mfma_f32_16x16x32_bf16 v[84:87], a[212:215], a[164:167], v[84:87]
    ds_read_b128 a[252:255], v6 offset:23552
    v_cvt_pk_bf16_f32 v149, v22, v23
    v_mfma_f32_16x16x32_bf16 v[84:87], a[208:211], a[160:163], v[84:87]
    v_exp_f32 v25, v109
    v_mfma_f32_16x16x32_bf16 v[76:79], a[208:211], a[144:147], v[172:175]
    v_exp_f32 v26, v110
    v_mfma_f32_16x16x32_bf16 v[76:79], a[212:215], a[148:151], v[76:79]
    v_cvt_pk_bf16_f32 v150, v24, v25
    v_add_f32 v15, v15, v40
    v_mfma_f32_16x16x32_bf16 v[76:79], a[216:219], a[152:155], v[76:79]
    v_exp_f32 v27, v111
    v_mfma_f32_16x16x32_bf16 v[76:79], a[220:223], a[156:159], v[76:79]
    buffer_load_dwordx4 v7, s[24:27], s56 offen offset:2048 sc1 lds
    v_mfma_f32_16x16x32_bf16 v[68:71], a[220:223], a[140:143], v[164:167]
    v_exp_f32 v20, v112
    v_mfma_f32_16x16x32_bf16 v[68:71], a[216:219], a[136:139], v[68:71]
    v_cvt_pk_bf16_f32 v151, v26, v27
    v_mfma_f32_16x16x32_bf16 v[68:71], a[212:215], a[132:135], v[68:71]
    v_exp_f32 v21, v113
    v_mfma_f32_16x16x32_bf16 v[32:35], v[44:47], v[148:151], 0
    v_exp_f32 v22, v114
    v_mfma_f32_16x16x32_bf16 v[68:71], a[208:211], a[128:131], v[68:71]
    s_waitcnt lgkmcnt(0)
    v_cvt_pk_bf16_f32 v152, v20, v21
    v_mfma_f32_16x16x32_bf16 a[0:3], a[224:227], v[128:131], a[0:3]
    ds_read_b128 a[192:195], v6 offset:8192
    v_mfma_f32_16x16x32_bf16 a[32:35], a[224:227], v[132:135], a[32:35]
    v_exp_f32 v23, v115
    v_mfma_f32_16x16x32_bf16 a[64:67], a[224:227], v[136:139], a[64:67]
    v_exp_f32 v24, v116
    v_mfma_f32_16x16x32_bf16 a[96:99], a[224:227], v[140:143], a[96:99]
    ds_read_b128 a[196:199], v6 offset:9216
    v_cvt_pk_bf16_f32 v153, v22, v23
    v_mfma_f32_16x16x32_bf16 a[100:103], a[228:231], v[140:143], a[100:103]
    v_exp_f32 v25, v117
    v_mfma_f32_16x16x32_bf16 a[68:71], a[228:231], v[136:139], a[68:71]
    v_exp_f32 v26, v118
    v_mfma_f32_16x16x32_bf16 a[36:39], a[228:231], v[132:135], a[36:39]
    ds_read_b128 a[200:203], v6 offset:10240
    v_cvt_pk_bf16_f32 v154, v24, v25
    v_mfma_f32_16x16x32_bf16 a[4:7], a[228:231], v[128:131], a[4:7]
    v_exp_f32 v27, v119
    v_mfma_f32_16x16x32_bf16 a[8:11], a[232:235], v[128:131], a[8:11]
    v_exp_f32 v20, v120
    v_mfma_f32_16x16x32_bf16 a[40:43], a[232:235], v[132:135], a[40:43]
    ds_read_b128 a[204:207], v6 offset:11264
    v_cvt_pk_bf16_f32 v155, v26, v27
    v_mfma_f32_16x16x32_bf16 a[72:75], a[232:235], v[136:139], a[72:75]
    v_exp_f32 v21, v121
    v_mfma_f32_16x16x32_bf16 v[36:39], v[44:47], v[152:155], 0
    v_exp_f32 v22, v122
    v_mfma_f32_16x16x32_bf16 a[104:107], a[232:235], v[140:143], a[104:107]
    buffer_load_dwordx4 v7, s[24:27], s56 offen offset:3072 sc1 lds
    v_mfma_f32_16x16x32_bf16 a[108:111], a[236:239], v[140:143], a[108:111]
    s_add_u32 s56, s56, 16384
    v_cvt_pk_bf16_f32 v156, v20, v21
    v_mfma_f32_16x16x32_bf16 a[76:79], a[236:239], v[136:139], a[76:79]
    v_exp_f32 v23, v123
    v_mfma_f32_16x16x32_bf16 a[44:47], a[236:239], v[132:135], a[44:47]
    v_exp_f32 v24, v124
    v_mfma_f32_16x16x32_bf16 a[12:15], a[236:239], v[128:131], a[12:15]
    v_cvt_pk_bf16_f32 v157, v22, v23
    v_mfma_f32_16x16x32_bf16 a[16:19], a[240:243], v[128:131], a[16:19]
    v_exp_f32 v25, v125
    v_mfma_f32_16x16x32_bf16 a[48:51], a[240:243], v[132:135], a[48:51]
    v_exp_f32 v26, v126
    v_mfma_f32_16x16x32_bf16 a[80:83], a[240:243], v[136:139], a[80:83]
    v_cvt_pk_bf16_f32 v158, v24, v25
    v_mfma_f32_16x16x32_bf16 a[112:115], a[240:243], v[140:143], a[112:115]
    s_add_u32 m0, s59, 16384
    v_exp_f32 v27, v127
    v_mfma_f32_16x16x32_bf16 a[116:119], a[244:247], v[140:143], a[116:119]
    buffer_load_dwordx4 v7, s[28:31], s57 offen offset:0 sc1 lds
    v_mfma_f32_16x16x32_bf16 a[84:87], a[244:247], v[136:139], a[84:87]
    v_cvt_pk_bf16_f32 v159, v26, v27
    v_mfma_f32_16x16x32_bf16 a[52:55], a[244:247], v[132:135], a[52:55]
    v_mfma_f32_16x16x32_bf16 a[20:23], a[244:247], v[128:131], a[20:23]
    v_mfma_f32_16x16x32_bf16 v[40:43], v[44:47], v[156:159], 0
    s_nop 2
    v_mfma_f32_16x16x32_bf16 a[24:27], a[248:251], v[128:131], a[24:27]
    s_nop 2
    v_mfma_f32_16x16x32_bf16 a[56:59], a[248:251], v[132:135], a[56:59]
    v_max3_f32 v8, v28, v32, v36
    v_max_f32 v8, v8, v40
    v_mfma_f32_16x16x32_bf16 a[88:91], a[248:251], v[136:139], a[88:91]
    v_cmp_nge_f32 vcc, s66, v8
    v_mfma_f32_16x16x32_bf16 a[120:123], a[248:251], v[140:143], a[120:123]
    ds_read_b128 a[208:211], v6 offset:12288
    v_mfma_f32_16x16x32_bf16 a[124:127], a[252:255], v[140:143], a[124:127]
    ds_read_b128 a[212:215], v6 offset:13312
    v_mfma_f32_16x16x32_bf16 a[92:95], a[252:255], v[136:139], a[92:95]
    ds_read_b128 a[216:219], v6 offset:14336
    v_mfma_f32_16x16x32_bf16 a[60:63], a[252:255], v[132:135], a[60:63]
    ds_read_b128 a[220:223], v6 offset:15360
    v_mfma_f32_16x16x32_bf16 a[28:31], a[252:255], v[128:131], a[28:31]
    s_waitcnt lgkmcnt(4)
    s_cbranch_vccnz m_stub79
m_ret80:
    v_mfma_f32_16x16x32_bf16 v[96:99], a[192:195], a[128:131], v[160:163]
    s_add_u32 s59, s58, s60
    v_exp_f32 v20, v64
    v_mfma_f32_16x16x32_bf16 v[96:99], a[196:199], a[132:135], v[96:99]
    s_add_u32 s58, s58, 32768
    ds_read_b128 a[224:227], v6 offset:24576
    v_add_f32 v12, v12, v28
    v_mfma_f32_16x16x32_bf16 v[96:99], a[200:203], a[136:139], v[96:99]
    s_cmp_ge_u32 s58, 163840
    s_cselect_b32 s58, 0, s58
    v_exp_f32 v21, v65
    v_mfma_f32_16x16x32_bf16 v[96:99], a[204:207], a[140:143], v[96:99]
    s_bitcmp1_b64 s[62:63], s64
    s_cselect_b32 s66, -1.0, s65
    v_cvt_pk_bf16_f32 v128, v20, v21
    v_mfma_f32_16x16x32_bf16 v[104:107], a[204:207], a[156:159], v[168:171]
    s_add_u32 s64, s64, 1
    ds_read_b128 a[228:231], v6 offset:25600
    v_add_f32 v13, v13, v32
    v_mfma_f32_16x16x32_bf16 v[104:107], a[200:203], a[152:155], v[104:107]
    v_exp_f32 v22, v66
    v_mfma_f32_16x16x32_bf16 v[104:107], a[196:199], a[148:151], v[104:107]
    buffer_load_dwordx4 v7, s[28:31], s57 offen offset:1024 sc1 lds
    v_mfma_f32_16x16x32_bf16 v[104:107], a[192:195], a[144:147], v[104:107]
    ds_read_b128 a[232:235], v6 offset:26624
    v_add_f32 v14, v14, v36
    v_mfma_f32_16x16x32_bf16 v[112:115], a[192:195], a[160:163], v[176:179]
    v_exp_f32 v23, v67
    v_mfma_f32_16x16x32_bf16 v[112:115], a[196:199], a[164:167], v[112:115]
    v_exp_f32 v24, v68
    v_mfma_f32_16x16x32_bf16 v[112:115], a[200:203], a[168:171], v[112:115]
    ds_read_b128 a[236:239], v6 offset:27648
    v_cvt_pk_bf16_f32 v129, v22, v23
    v_mfma_f32_16x16x32_bf16 v[112:115], a[204:207], a[172:175], v[112:115]
    v_exp_f32 v25, v69
    v_mfma_f32_16x16x32_bf16 v[120:123], a[204:207], a[188:191], v[184:187]
    v_exp_f32 v26, v70
    v_mfma_f32_16x16x32_bf16 v[120:123], a[200:203], a[184:187], v[120:123]
    ds_read_b128 a[240:243], v6 offset:28672
    v_cvt_pk_bf16_f32 v130, v24, v25
    v_mfma_f32_16x16x32_bf16 v[120:123], a[196:199], a[180:183], v[120:123]
    v_exp_f32 v27, v71
    v_mfma_f32_16x16x32_bf16 v[120:123], a[192:195], a[176:179], v[120:123]
    s_waitcnt lgkmcnt(5)
    v_exp_f32 v20, v72
    v_mfma_f32_16x16x32_bf16 v[124:127], a[208:211], a[176:179], v[188:191]
    ds_read_b128 a[244:247], v6 offset:29696
    v_cvt_pk_bf16_f32 v131, v26, v27
    v_mfma_f32_16x16x32_bf16 v[124:127], a[212:215], a[180:183], v[124:127]
    v_exp_f32 v21, v73
    v_mfma_f32_16x16x32_bf16 v[28:31], v[44:47], v[128:131], 0
    v_exp_f32 v22, v74
    v_mfma_f32_16x16x32_bf16 v[124:127], a[216:219], a[184:187], v[124:127]
    buffer_load_dwordx4 v7, s[28:31], s57 offen offset:2048 sc1 lds
    v_mfma_f32_16x16x32_bf16 v[124:127], a[220:223], a[188:191], v[124:127]
    ds_read_b128 a[248:251], v6 offset:30720
    v_cvt_pk_bf16_f32 v132, v20, v21
    v_mfma_f32_16x16x32_bf16 v[116:119], a[220:223], a[172:175], v[180:183]
    v_exp_f32 v23, v75
    v_mfma_f32_16x16x32_bf16 v[116:119], a[216:219], a[168:171], v[116:119]
    v_exp_f32 v24, v76
    v_mfma_f32_16x16x32_bf16 v[116:119], a[212:215], a[164:167], v[116:119]
    ds_read_b128 a[252:255], v6 offset:31744
    v_cvt_pk_bf16_f32 v133, v22, v23
    v_mfma_f32_16x16x32_bf16 v[116:119], a[208:211], a[160:163], v[116:119]
    v_exp_f32 v25, v77
    v_mfma_f32_16x16x32_bf16 v[108:111], a[208:211], a[144:147], v[172:175]
    v_exp_f32 v26, v78
    v_mfma_f32_16x16x32_bf16 v[108:111], a[212:215], a[148:151], v[108:111]
    v_cvt_pk_bf16_f32 v134, v24, v25
    v_add_f32 v15, v15, v40
    v_mfma_f32_16x16x32_bf16 v[108:111], a[216:219], a[152:155], v[108:111]
    v_exp_f32 v27, v79
    v_mfma_f32_16x16x32_bf16 v[108:111], a[220:223], a[156:159], v[108:111]
    buffer_load_dwordx4 v7, s[28:31], s57 offen offset:3072 sc1 lds
    v_mfma_f32_16x16x32_bf16 v[100:103], a[220:223], a[140:143], v[164:167]
    s_add_u32 s57, s57, 16384
    v_exp_f32 v20, v80
    v_mfma_f32_16x16x32_bf16 v[100:103], a[216:219], a[136:139], v[100:103]
    v_cvt_pk_bf16_f32 v135, v26, v27
    v_mfma_f32_16x16x32_bf16 v[100:103], a[212:215], a[132:135], v[100:103]
    v_exp_f32 v21, v81
    v_mfma_f32_16x16x32_bf16 v[32:35], v[44:47], v[132:135], 0
    v_exp_f32 v22, v82
    v_mfma_f32_16x16x32_bf16 v[100:103], a[208:211], a[128:131], v[100:103]
    s_waitcnt vmcnt(24) lgkmcnt(0)
    v_add_u32 v6, s58, v2
    v_cvt_pk_bf16_f32 v136, v20, v21
    v_mfma_f32_16x16x32_bf16 a[0:3], a[224:227], v[144:147], a[0:3]
    s_barrier
    v_mfma_f32_16x16x32_bf16 a[32:35], a[224:227], v[148:151], a[32:35]
    ds_read_b128 a[192:195], v6 offset:0
    v_mfma_f32_16x16x32_bf16 a[64:67], a[224:227], v[152:155], a[64:67]
    v_exp_f32 v23, v83
    v_mfma_f32_16x16x32_bf16 a[96:99], a[224:227], v[156:159], a[96:99]
    v_exp_f32 v24, v84
    v_mfma_f32_16x16x32_bf16 a[100:103], a[228:231], v[156:159], a[100:103]
    ds_read_b128 a[196:199], v6 offset:1024
    v_cvt_pk_bf16_f32 v137, v22, v23
    v_mfma_f32_16x16x32_bf16 a[68:71], a[228:231], v[152:155], a[68:71]
    v_exp_f32 v25, v85
    v_mfma_f32_16x16x32_bf16 a[36:39], a[228:231], v[148:151], a[36:39]
    v_exp_f32 v26, v86
    v_mfma_f32_16x16x32_bf16 a[4:7], a[228:231], v[144:147], a[4:7]
    ds_read_b128 a[200:203], v6 offset:2048
    v_cvt_pk_bf16_f32 v138, v24, v25
    v_mfma_f32_16x16x32_bf16 a[8:11], a[232:235], v[144:147], a[8:11]
    v_exp_f32 v27, v87
    v_mfma_f32_16x16x32_bf16 a[40:43], a[232:235], v[148:151], a[40:43]
    v_exp_f32 v20, v88
    v_mfma_f32_16x16x32_bf16 a[72:75], a[232:235], v[152:155], a[72:75]
    ds_read_b128 a[204:207], v6 offset:3072
    v_cvt_pk_bf16_f32 v139, v26, v27
    v_mfma_f32_16x16x32_bf16 a[104:107], a[232:235], v[156:159], a[104:107]
    v_exp_f32 v21, v89
    v_mfma_f32_16x16x32_bf16 v[36:39], v[44:47], v[136:139], 0
    v_exp_f32 v22, v90
    v_mfma_f32_16x16x32_bf16 a[108:111], a[236:239], v[156:159], a[108:111]
    v_cvt_pk_bf16_f32 v140, v20, v21
    v_mfma_f32_16x16x32_bf16 a[76:79], a[236:239], v[152:155], a[76:79]
    v_exp_f32 v23, v91
    v_mfma_f32_16x16x32_bf16 a[44:47], a[236:239], v[148:151], a[44:47]
    v_exp_f32 v24, v92
    v_mfma_f32_16x16x32_bf16 a[12:15], a[236:239], v[144:147], a[12:15]
    v_cvt_pk_bf16_f32 v141, v22, v23
    v_mfma_f32_16x16x32_bf16 a[16:19], a[240:243], v[144:147], a[16:19]
    v_exp_f32 v25, v93
    v_mfma_f32_16x16x32_bf16 a[48:51], a[240:243], v[148:151], a[48:51]
    v_exp_f32 v26, v94
    v_mfma_f32_16x16x32_bf16 a[80:83], a[240:243], v[152:155], a[80:83]
    v_cvt_pk_bf16_f32 v142, v24, v25
    v_mfma_f32_16x16x32_bf16 a[112:115], a[240:243], v[156:159], a[112:115]
    v_exp_f32 v27, v95
    v_mfma_f32_16x16x32_bf16 a[116:119], a[244:247], v[156:159], a[116:119]
    v_cvt_pk_bf16_f32 v143, v26, v27
    v_mfma_f32_16x16x32_bf16 a[84:87], a[244:247], v[152:155], a[84:87]
    v_mfma_f32_16x16x32_bf16 a[52:55], a[244:247], v[148:151], a[52:55]
    v_mfma_f32_16x16x32_bf16 v[40:43], v[44:47], v[140:143], 0
    s_nop 2
    v_mfma_f32_16x16x32_bf16 a[20:23], a[244:247], v[144:147], a[20:23]
    s_nop 2
    v_mfma_f32_16x16x32_bf16 a[24:27], a[248:251], v[144:147], a[24:27]
    v_max3_f32 v8, v28, v32, v36
    v_max_f32 v8, v8, v40
    v_mfma_f32_16x16x32_bf16 a[56:59], a[248:251], v[148:151], a[56:59]
    v_cmp_nge_f32 vcc, s66, v8
    v_mfma_f32_16x16x32_bf16 a[88:91], a[248:251], v[152:155], a[88:91]
    v_mfma_f32_16x16x32_bf16 a[120:123], a[248:251], v[156:159], a[120:123]
    ds_read_b128 a[208:211], v6 offset:4096
    v_mfma_f32_16x16x32_bf16 a[124:127], a[252:255], v[156:159], a[124:127]
    ds_read_b128 a[212:215], v6 offset:5120
    v_mfma_f32_16x16x32_bf16 a[92:95], a[252:255], v[152:155], a[92:95]
    ds_read_b128 a[216:219], v6 offset:6144
    v_mfma_f32_16x16x32_bf16 a[60:63], a[252:255], v[148:151], a[60:63]
    ds_read_b128 a[220:223], v6 offset:7168
    v_mfma_f32_16x16x32_bf16 a[28:31], a[252:255], v[144:147], a[28:31]
    s_waitcnt lgkmcnt(4)
    s_cbranch_vccz m_dual78
    v_cmp_lt_f32 vcc, s65, v8
    s_cmp_lg_u32 s64, s67
    s_cbranch_scc1 m_e82
    v_add_f32 v176, v176, v16
    v_mov_b32 v180, v9
    v_add_f32 v188, v188, v16
    v_add_f32 v177, v177, v17
    v_mov_b32 v181, v9
    v_add_f32 v189, v189, v17
    v_add_f32 v178, v178, v18
    v_mov_b32 v182, v9
    v_add_f32 v190, v190, v18
    v_add_f32 v179, v179, v19
    v_mov_b32 v183, v9
    v_add_f32 v191, v191, v19
    s_nop 0
m_e82:
    s_cmp_lg_u32 s64, s68
    s_cbranch_scc1 m_e83
    v_mov_b32 v176, v9
    v_mov_b32 v184, v9
    v_mov_b32 v188, v9
    v_mov_b32 v177, v9
    v_mov_b32 v185, v9
    v_mov_b32 v189, v9
    v_mov_b32 v178, v9
    v_mov_b32 v186, v9
    v_mov_b32 v190, v9
    v_mov_b32 v179, v9
    v_mov_b32 v187, v9
    v_mov_b32 v191, v9
    s_nop 0
m_e83:
    s_cmp_lg_u32 s64, s70
    s_cbranch_scc1 m_e84
    v_add_f32 v160, v160, v16
    v_mov_b32 v164, v9
    v_add_f32 v172, v172, v16
    v_add_f32 v161, v161, v17
    v_mov_b32 v165, v9
    v_add_f32 v173, v173, v17
    v_add_f32 v162, v162, v18
    v_mov_b32 v166, v9
    v_add_f32 v174, v174, v18
    v_add_f32 v163, v163, v19
    v_mov_b32 v167, v9
    v_add_f32 v175, v175, v19
    s_nop 0
m_e84:
    s_cmp_lg_u32 s64, s53
    s_cbranch_scc1 m_e87
    s_cmp_lg_u32 s16, 0
    s_cbranch_scc1 m_np88
    v_mov_b32 v60, s4
    v_mov_b32 v61, s5
    s_add_u32 s90, s101, 117440512
    s_mov_b64 exec, 1
    buffer_store_dwordx2 v[60:61], off, s[8:11], s90 sc1
    s_mov_b64 exec, -1
m_np88:
    s_mov_b32 s101, -1
m_e87:
    s_cmp_gt_u32 s64, 24
    s_cbranch_scc1 m_e85
    s_cmp_lg_u32 s64, 8
    s_cbranch_scc1 m_e89
    s_lshr_b32 s90, s32, 1
    s_lshl_b32 s90, s90, 7
    s_add_u32 s90, s90, 117440600
    v_min_u32 v0, 1, v1
    v_lshlrev_b32 v0, 5, v0
    buffer_load_dwordx2 v[4:5], v0, s[8:11], s90 offen sc1
    s_cmp_eq_u32 s17, -1
    s_cbranch_scc1 m_e85
    s_cmp_lg_u32 s16, 0
    s_cbranch_scc1 m_np90
    v_mov_b32 v60, s4
    v_mov_b32 v61, s5
    s_add_u32 s90, s17, 117440512
    s_mov_b64 exec, 1
    buffer_store_dwordx2 v[60:61], off, s[8:11], s90 sc1
    s_mov_b64 exec, -1
m_np90:
    s_branch m_e85
m_e89:
    s_cmp_lg_u32 s64, 16
    s_cbranch_scc1 m_e91
    s_waitcnt vmcnt(18)
    s_mov_b32 s3, 1048576
m_spin92:
    v_cmp_ne_u64 s[76:77], s[4:5], v[4:5]
    s_nop 3
    s_cmp_eq_u64 s[76:77], 0
    s_cbranch_scc1 m_e85
    s_sub_u32 s3, s3, 1
    s_cbranch_scc1 m_e85
    s_sleep 32
    s_lshr_b32 s90, s32, 1
    s_lshl_b32 s90, s90, 7
    s_add_u32 s90, s90, 117440600
    v_min_u32 v0, 1, v1
    v_lshlrev_b32 v0, 5, v0
    buffer_load_dwordx2 v[4:5], v0, s[8:11], s90 offen sc1
    s_waitcnt vmcnt(0)
    s_branch m_spin92
    s_branch m_e85
m_e91:
    s_cmp_lg_u32 s64, 20
    s_cbranch_scc1 m_e93
    buffer_load_dwordx2 v[4:5], v10, s[8:11], 0 offen sc1
    s_mov_b32 s44, s48
    s_mov_b32 s45, s49
    s_mov_b32 s46, 8388608
    s_lshl_b32 s90, s2, 2
    s_add_u32 s90, s90, s16
    s_lshl_b32 s90, s90, 13
    v_lshlrev_b32 v62, 7, v1
    buffer_load_dword v255, v62, s[44:47], s90 offen
    s_branch m_e85
m_e93:
    s_cmp_lg_u32 s64, 24
    s_cbranch_scc1 m_e94
    s_mov_b32 s44, s50
    s_mov_b32 s45, s51
    s_mov_b32 s46, 2097152
    s_lshl_b32 s90, s2, 2
    s_add_u32 s90, s90, s16
    s_lshl_b32 s90, s90, 13
    v_lshlrev_b32 v62, 7, v1
    buffer_load_dword v255, v62, s[44:47], s90 offen
    s_waitcnt vmcnt(18)
    s_mov_b32 s3, 1048576
m_spin95:
    v_cmp_ne_u64 s[76:77], s[4:5], v[4:5]
    s_nop 3
    s_cmp_eq_u64 s[76:77], 0
    s_cbranch_scc1 m_e85
    s_sub_u32 s3, s3, 1
    s_cbranch_scc1 m_e85
    s_sleep 32
    buffer_load_dwordx2 v[4:5], v10, s[8:11], 0 offen sc1
    s_waitcnt vmcnt(0)
    s_branch m_spin95
    s_branch m_e85
m_e94:
m_e85:
    s_cbranch_vccnz m_rc96
m_sp81:
    s_cmp_lg_u32 s64, s69
    s_cbranch_scc1 m_dual78
    v_mfma_f32_16x16x32_bf16 v[64:67], a[192:195], a[128:131], v[160:163]
    s_bitcmp1_b64 s[62:63], s64
    s_cselect_b32 s66, -1.0, s65
    v_add_f32 v12, v12, v28
    v_mfma_f32_16x16x32_bf16 v[64:67], a[196:199], a[132:135], v[64:67]
    s_add_u32 s64, s64, 1
    ds_read_b128 a[224:227], v6 offset:16384
    v_exp_f32 v20, v96
    v_mfma_f32_16x16x32_bf16 v[64:67], a[200:203], a[136:139], v[64:67]
    s_mov_b32 m0, s59
    ds_read_b128 a[228:231], v6 offset:17408
    v_add_f32 v13, v13, v32
    v_mfma_f32_16x16x32_bf16 v[64:67], a[204:207], a[140:143], v[64:67]
    buffer_load_dwordx4 v7, s[24:27], s56 offen offset:0 sc1 lds
    v_mfma_f32_16x16x32_bf16 v[72:75], a[204:207], a[156:159], v[168:171]
    ds_read_b128 a[232:235], v6 offset:18432
    v_add_f32 v14, v14, v36
    v_mfma_f32_16x16x32_bf16 v[72:75], a[200:203], a[152:155], v[72:75]
    ds_read_b128 a[236:239], v6 offset:19456
    v_exp_f32 v21, v97
    v_mfma_f32_16x16x32_bf16 v[72:75], a[196:199], a[148:151], v[72:75]
    ds_read_b128 a[240:243], v6 offset:20480
    v_cvt_pk_bf16_f32 v144, v20, v21
    v_mfma_f32_16x16x32_bf16 v[72:75], a[192:195], a[144:147], v[72:75]
    s_waitcnt lgkmcnt(5)
    ds_read_b128 a[244:247], v6 offset:21504
    v_add_f32 v15, v15, v40
    v_mfma_f32_16x16x32_bf16 v[76:79], a[208:211], a[144:147], v[172:175]
    ds_read_b128 a[248:251], v6 offset:22528
    v_exp_f32 v22, v98
    v_mfma_f32_16x16x32_bf16 v[76:79], a[212:215], a[148:151], v[76:79]
    ds_read_b128 a[252:255], v6 offset:23552
    v_exp_f32 v23, v99
    v_mfma_f32_16x16x32_bf16 v[76:79], a[216:219], a[152:155], v[76:79]
    v_exp_f32 v24, v100
    v_mfma_f32_16x16x32_bf16 v[76:79], a[220:223], a[156:159], v[76:79]
    buffer_load_dwordx4 v7, s[24:27], s56 offen offset:1024 sc1 lds
    v_mfma_f32_16x16x32_bf16 v[68:71], a[220:223], a[140:143], v[164:167]
    v_cvt_pk_bf16_f32 v145, v22, v23
    v_exp_f32 v25, v101
    v_mfma_f32_16x16x32_bf16 v[68:71], a[216:219], a[136:139], v[68:71]
    v_exp_f32 v26, v102
    v_mfma_f32_16x16x32_bf16 v[68:71], a[212:215], a[132:135], v[68:71]
    v_cvt_pk_bf16_f32 v146, v24, v25
    v_exp_f32 v27, v103
    v_mfma_f32_16x16x32_bf16 v[68:71], a[208:211], a[128:131], v[68:71]
    s_waitcnt lgkmcnt(0)
    v_exp_f32 v20, v104
    v_mfma_f32_16x16x32_bf16 a[0:3], a[224:227], v[128:131], a[0:3]
    ds_read_b128 a[192:195], v6 offset:8192
    v_cvt_pk_bf16_f32 v147, v26, v27
    v_mfma_f32_16x16x32_bf16 a[32:35], a[224:227], v[132:135], a[32:35]
    v_exp_f32 v21, v105
    v_mfma_f32_16x16x32_bf16 v[28:31], v[44:47], v[144:147], 0
    v_exp_f32 v22, v106
    v_mfma_f32_16x16x32_bf16 a[64:67], a[224:227], v[136:139], a[64:67]
    v_cvt_pk_bf16_f32 v148, v20, v21
    v_exp_f32 v23, v107
    v_mfma_f32_16x16x32_bf16 a[96:99], a[224:227], v[140:143], a[96:99]
    ds_read_b128 a[196:199], v6 offset:9216
    v_cvt_pk_bf16_f32 v149, v22, v23
    v_mfma_f32_16x16x32_bf16 a[100:103], a[228:231], v[140:143], a[100:103]
    v_exp_f32 v24, v108
    v_mfma_f32_16x16x32_bf16 a[68:71], a[228:231], v[136:139], a[68:71]
    buffer_load_dwordx4 v7, s[24:27], s56 offen offset:2048 sc1 lds
    v_mfma_f32_16x16x32_bf16 a[36:39], a[228:231], v[132:135], a[36:39]
    ds_read_b128 a[200:203], v6 offset:10240
    v_exp_f32 v25, v109
    v_mfma_f32_16x16x32_bf16 a[4:7], a[228:231], v[128:131], a[4:7]
    v_exp_f32 v26, v110
    v_mfma_f32_16x16x32_bf16 a[8:11], a[232:235], v[128:131], a[8:11]
    v_cvt_pk_bf16_f32 v150, v24, v25
    v_exp_f32 v27, v111
    v_mfma_f32_16x16x32_bf16 a[40:43], a[232:235], v[132:135], a[40:43]
    ds_read_b128 a[204:207], v6 offset:11264
    v_cvt_pk_bf16_f32 v151, v26, v27
    v_mfma_f32_16x16x32_bf16 a[72:75], a[232:235], v[136:139], a[72:75]
    v_exp_f32 v20, v112
    v_mfma_f32_16x16x32_bf16 v[32:35], v[44:47], v[148:151], 0
    v_exp_f32 v21, v113
    v_mfma_f32_16x16x32_bf16 a[104:107], a[232:235], v[140:143], a[104:107]
    v_exp_f32 v22, v114
    v_mfma_f32_16x16x32_bf16 a[108:111], a[236:239], v[140:143], a[108:111]
    v_cvt_pk_bf16_f32 v152, v20, v21
    v_exp_f32 v23, v115
    v_mfma_f32_16x16x32_bf16 a[76:79], a[236:239], v[136:139], a[76:79]
    v_exp_f32 v24, v116
    v_mfma_f32_16x16x32_bf16 a[44:47], a[236:239], v[132:135], a[44:47]
    v_cvt_pk_bf16_f32 v153, v22, v23
    v_exp_f32 v25, v117
    v_mfma_f32_16x16x32_bf16 a[12:15], a[236:239], v[128:131], a[12:15]
    buffer_load_dwordx4 v7, s[24:27], s56 offen offset:3072 sc1 lds
    v_mfma_f32_16x16x32_bf16 a[16:19], a[240:243], v[128:131], a[16:19]
    s_add_u32 s56, s56, 16384
    v_exp_f32 v26, v118
    v_mfma_f32_16x16x32_bf16 a[48:51], a[240:243], v[132:135], a[48:51]
    v_cvt_pk_bf16_f32 v154, v24, v25
    v_exp_f32 v27, v119
    v_mfma_f32_16x16x32_bf16 a[80:83], a[240:243], v[136:139], a[80:83]
    v_exp_f32 v20, v120
    v_mfma_f32_16x16x32_bf16 a[112:115], a[240:243], v[140:143], a[112:115]
    v_cvt_pk_bf16_f32 v155, v26, v27
    v_exp_f32 v21, v121
    v_mfma_f32_16x16x32_bf16 a[116:119], a[244:247], v[140:143], a[116:119]
    v_exp_f32 v22, v122
    v_mfma_f32_16x16x32_bf16 v[36:39], v[44:47], v[152:155], 0
    v_cvt_pk_bf16_f32 v156, v20, v21
    v_mfma_f32_16x16x32_bf16 a[84:87], a[244:247], v[136:139], a[84:87]
    v_exp_f32 v23, v123
    v_mfma_f32_16x16x32_bf16 a[52:55], a[244:247], v[132:135], a[52:55]
    v_exp_f32 v24, v124
    v_cvt_pk_bf16_f32 v157, v22, v23
    v_mfma_f32_16x16x32_bf16 a[20:23], a[244:247], v[128:131], a[20:23]
    v_exp_f32 v25, v125
    v_mfma_f32_16x16x32_bf16 a[24:27], a[248:251], v[128:131], a[24:27]
    s_add_u32 m0, s59, 16384
    v_exp_f32 v26, v126
    v_mfma_f32_16x16x32_bf16 a[56:59], a[248:251], v[132:135], a[56:59]
    buffer_load_dwordx4 v7, s[28:31], s57 offen offset:0 sc1 lds
    v_mfma_f32_16x16x32_bf16 a[88:91], a[248:251], v[136:139], a[88:91]
    v_cvt_pk_bf16_f32 v158, v24, v25
    v_exp_f32 v27, v127
    v_mfma_f32_16x16x32_bf16 a[120:123], a[248:251], v[140:143], a[120:123]
    ds_read_b128 a[208:211], v6 offset:12288
    v_cvt_pk_bf16_f32 v159, v26, v27
    s_nop 1
    v_mfma_f32_16x16x32_bf16 v[40:43], v[44:47], v[156:159], 0
    s_nop 2
    v_mfma_f32_16x16x32_bf16 a[124:127], a[252:255], v[140:143], a[124:127]
    ds_read_b128 a[212:215], v6 offset:13312
    s_nop 0
    v_mfma_f32_16x16x32_bf16 a[92:95], a[252:255], v[136:139], a[92:95]
    ds_read_b128 a[216:219], v6 offset:14336
    v_max3_f32 v8, v28, v32, v36
    v_mfma_f32_16x16x32_bf16 a[60:63], a[252:255], v[132:135], a[60:63]
    ds_read_b128 a[220:223], v6 offset:15360
    v_max_f32 v8, v8, v40
    v_cmp_nge_f32 vcc, s66, v8
    v_mfma_f32_16x16x32_bf16 a[28:31], a[252:255], v[128:131], a[28:31]
    s_waitcnt lgkmcnt(4)
    s_cbranch_vccnz m_stub97
m_ret98:
    v_mfma_f32_16x16x32_bf16 v[96:99], a[192:195], a[128:131], v[160:163]
    s_add_u32 s59, s58, s60
    v_exp_f32 v20, v64
    v_mfma_f32_16x16x32_bf16 v[96:99], a[196:199], a[132:135], v[96:99]
    s_add_u32 s58, s58, 32768
    ds_read_b128 a[224:227], v6 offset:24576
    v_add_f32 v12, v12, v28
    v_mfma_f32_16x16x32_bf16 v[96:99], a[200:203], a[136:139], v[96:99]
    s_cmp_ge_u32 s58, 163840
    s_cselect_b32 s58, 0, s58
    ds_read_b128 a[228:231], v6 offset:25600
    v_add_f32 v13, v13, v32
    v_mfma_f32_16x16x32_bf16 v[96:99], a[204:207], a[140:143], v[96:99]
    buffer_load_dwordx4 v7, s[28:31], s57 offen offset:1024 sc1 lds
    v_mfma_f32_16x16x32_bf16 v[104:107], a[204:207], a[156:159], v[168:171]
    s_bitcmp1_b64 s[62:63], s64
    s_cselect_b32 s66, -1.0, s65
    ds_read_b128 a[232:235], v6 offset:26624
    v_mfma_f32_16x16x32_bf16 v[104:107], a[200:203], a[152:155], v[104:107]
    s_add_u32 s64, s64, 1
    ds_read_b128 a[236:239], v6 offset:27648
    v_mfma_f32_16x16x32_bf16 v[104:107], a[196:199], a[148:151], v[104:107]
    ds_read_b128 a[240:243], v6 offset:28672
    v_mfma_f32_16x16x32_bf16 v[104:107], a[192:195], a[144:147], v[104:107]
    s_waitcnt lgkmcnt(5)
    ds_read_b128 a[244:247], v6 offset:29696
    v_mfma_f32_16x16x32_bf16 v[108:111], a[208:211], a[144:147], v[172:175]
    buffer_load_dwordx4 v7, s[28:31], s57 offen offset:2048 sc1 lds
    v_mfma_f32_16x16x32_bf16 v[108:111], a[212:215], a[148:151], v[108:111]
    ds_read_b128 a[248:251], v6 offset:30720
    v_mfma_f32_16x16x32_bf16 v[108:111], a[216:219], a[152:155], v[108:111]
    ds_read_b128 a[252:255], v6 offset:31744
    v_mfma_f32_16x16x32_bf16 v[108:111], a[220:223], a[156:159], v[108:111]
    v_exp_f32 v21, v65
    v_mfma_f32_16x16x32_bf16 v[100:103], a[220:223], a[140:143], v[164:167]
    v_exp_f32 v22, v66
    v_mfma_f32_16x16x32_bf16 v[100:103], a[216:219], a[136:139], v[100:103]
    buffer_load_dwordx4 v7, s[28:31], s57 offen offset:3072 sc1 lds
    v_mfma_f32_16x16x32_bf16 v[100:103], a[212:215], a[132:135], v[100:103]
    s_add_u32 s57, s57, 16384
    v_cvt_pk_bf16_f32 v128, v20, v21
    v_mfma_f32_16x16x32_bf16 v[100:103], a[208:211], a[128:131], v[100:103]
    s_waitcnt vmcnt(24) lgkmcnt(0)
    v_add_u32 v6, s58, v2
    v_mfma_f32_16x16x32_bf16 a[0:3], a[224:227], v[144:147], a[0:3]
    s_barrier
    v_mfma_f32_16x16x32_bf16 a[32:35], a[224:227], v[148:151], a[32:35]
    ds_read_b128 a[192:195], v6 offset:0
    v_mfma_f32_16x16x32_bf16 a[64:67], a[224:227], v[152:155], a[64:67]
    v_exp_f32 v23, v67
    v_mfma_f32_16x16x32_bf16 a[96:99], a[224:227], v[156:159], a[96:99]
    v_exp_f32 v24, v68
    v_mfma_f32_16x16x32_bf16 a[100:103], a[228:231], v[156:159], a[100:103]
    ds_read_b128 a[196:199], v6 offset:1024
    v_cvt_pk_bf16_f32 v129, v22, v23
    v_mfma_f32_16x16x32_bf16 a[68:71], a[228:231], v[152:155], a[68:71]
    v_exp_f32 v25, v69
    v_mfma_f32_16x16x32_bf16 a[36:39], a[228:231], v[148:151], a[36:39]
    v_exp_f32 v26, v70
    v_mfma_f32_16x16x32_bf16 a[4:7], a[228:231], v[144:147], a[4:7]
    ds_read_b128 a[200:203], v6 offset:2048
    v_cvt_pk_bf16_f32 v130, v24, v25
    v_mfma_f32_16x16x32_bf16 a[8:11], a[232:235], v[144:147], a[8:11]
    v_exp_f32 v27, v71
    v_mfma_f32_16x16x32_bf16 a[40:43], a[232:235], v[148:151], a[40:43]
    v_exp_f32 v20, v72
    v_mfma_f32_16x16x32_bf16 a[72:75], a[232:235], v[152:155], a[72:75]
    ds_read_b128 a[204:207], v6 offset:3072
    v_cvt_pk_bf16_f32 v131, v26, v27
    v_mfma_f32_16x16x32_bf16 a[104:107], a[232:235], v[156:159], a[104:107]
    v_exp_f32 v21, v73
    v_mfma_f32_16x16x32_bf16 v[28:31], v[44:47], v[128:131], 0
    v_exp_f32 v22, v74
    v_mfma_f32_16x16x32_bf16 a[108:111], a[236:239], v[156:159], a[108:111]
    v_cvt_pk_bf16_f32 v132, v20, v21
    v_mfma_f32_16x16x32_bf16 a[76:79], a[236:239], v[152:155], a[76:79]
    v_exp_f32 v23, v75
    v_mfma_f32_16x16x32_bf16 a[44:47], a[236:239], v[148:151], a[44:47]
    v_exp_f32 v24, v76
    v_mfma_f32_16x16x32_bf16 a[12:15], a[236:239], v[144:147], a[12:15]
    v_cvt_pk_bf16_f32 v133, v22, v23
    v_mfma_f32_16x16x32_bf16 a[16:19], a[240:243], v[144:147], a[16:19]
    v_exp_f32 v25, v77
    v_mfma_f32_16x16x32_bf16 a[48:51], a[240:243], v[148:151], a[48:51]
    v_exp_f32 v26, v78
    v_mfma_f32_16x16x32_bf16 a[80:83], a[240:243], v[152:155], a[80:83]
    v_cvt_pk_bf16_f32 v134, v24, v25
    v_mfma_f32_16x16x32_bf16 a[112:115], a[240:243], v[156:159], a[112:115]
    v_exp_f32 v27, v79
    v_mfma_f32_16x16x32_bf16 a[116:119], a[244:247], v[156:159], a[116:119]
    v_cvt_pk_bf16_f32 v135, v26, v27
    v_mfma_f32_16x16x32_bf16 a[84:87], a[244:247], v[152:155], a[84:87]
    v_mfma_f32_16x16x32_bf16 a[52:55], a[244:247], v[148:151], a[52:55]
    v_mfma_f32_16x16x32_bf16 v[32:35], v[44:47], v[132:135], 0
    s_nop 2
    v_mfma_f32_16x16x32_bf16 a[20:23], a[244:247], v[144:147], a[20:23]
    s_nop 2
    v_mfma_f32_16x16x32_bf16 a[24:27], a[248:251], v[144:147], a[24:27]
    v_max_f32 v8, v28, v32
    v_cmp_nge_f32 vcc, s66, v8
    v_mfma_f32_16x16x32_bf16 a[56:59], a[248:251], v[148:151], a[56:59]
    v_mfma_f32_16x16x32_bf16 a[88:91], a[248:251], v[152:155], a[88:91]
    v_mfma_f32_16x16x32_bf16 a[120:123], a[248:251], v[156:159], a[120:123]
    ds_read_b128 a[208:211], v6 offset:4096
    v_mfma_f32_16x16x32_bf16 a[124:127], a[252:255], v[156:159], a[124:127]
    ds_read_b128 a[212:215], v6 offset:5120
    v_mfma_f32_16x16x32_bf16 a[92:95], a[252:255], v[152:155], a[92:95]
    ds_read_b128 a[216:219], v6 offset:6144
    v_mfma_f32_16x16x32_bf16 a[60:63], a[252:255], v[148:151], a[60:63]
    ds_read_b128 a[220:223], v6 offset:7168
    v_mfma_f32_16x16x32_bf16 a[28:31], a[252:255], v[144:147], a[28:31]
    s_waitcnt lgkmcnt(4)
    s_cbranch_vccnz m_stub99
m_ret100:
    v_add_f32 v20, v14, v36
    v_add_f32 v21, v15, v40
    s_nop 3
    v_rcp_f32 v20, v20
    v_rcp_f32 v21, v21
    s_lshl_b32 s90, s79, 10
    s_add_u32 s90, s90, s82
    s_add_u32 s90, s90, 67108864
    v_accvgpr_read_b32 v48, a64
    v_accvgpr_read_b32 v49, a65
    v_accvgpr_read_b32 v50, a66
    v_accvgpr_read_b32 v51, a67
    v_accvgpr_read_b32 v52, a68
    v_accvgpr_read_b32 v53, a69
    v_accvgpr_read_b32 v54, a70
    v_accvgpr_read_b32 v55, a71
    v_mul_f32 v48, v20, v48
    v_mul_f32 v49, v20, v49
    v_mul_f32 v50, v20, v50
    v_mul_f32 v51, v20, v51
    v_mul_f32 v52, v20, v52
    v_mul_f32 v53, v20, v53
    v_mul_f32 v54, v20, v54
    v_mul_f32 v55, v20, v55
    v_cvt_pk_bf16_f32 v48, v48, v49
    v_cvt_pk_bf16_f32 v49, v50, v51
    v_cvt_pk_bf16_f32 v50, v52, v53
    v_cvt_pk_bf16_f32 v51, v54, v55
    buffer_store_dwordx4 v[48:51], v2, s[8:11], s90 offen offset:0 sc1
    v_accvgpr_read_b32 v56, a96
    v_accvgpr_read_b32 v57, a97
    v_accvgpr_read_b32 v58, a98
    v_accvgpr_read_b32 v59, a99
    v_accvgpr_read_b32 v60, a100
    v_accvgpr_read_b32 v61, a101
    v_accvgpr_read_b32 v62, a102
    v_accvgpr_read_b32 v63, a103
    v_mul_f32 v56, v21, v56
    v_mul_f32 v57, v21, v57
    v_mul_f32 v58, v21, v58
    v_mul_f32 v59, v21, v59
    v_mul_f32 v60, v21, v60
    v_mul_f32 v61, v21, v61
    v_mul_f32 v62, v21, v62
    v_mul_f32 v63, v21, v63
    v_cvt_pk_bf16_f32 v56, v56, v57
    v_cvt_pk_bf16_f32 v57, v58, v59
    v_cvt_pk_bf16_f32 v58, v60, v61
    v_cvt_pk_bf16_f32 v59, v62, v63
    buffer_store_dwordx4 v[56:59], v2, s[8:11], s90 offen offset:1024 sc1
    s_add_u32 s90, s90, 131072
    v_accvgpr_read_b32 v48, a72
    v_accvgpr_read_b32 v49, a73
    v_accvgpr_read_b32 v50, a74
    v_accvgpr_read_b32 v51, a75
    v_accvgpr_read_b32 v52, a76
    v_accvgpr_read_b32 v53, a77
    v_accvgpr_read_b32 v54, a78
    v_accvgpr_read_b32 v55, a79
    v_mul_f32 v48, v20, v48
    v_mul_f32 v49, v20, v49
    v_mul_f32 v50, v20, v50
    v_mul_f32 v51, v20, v51
    v_mul_f32 v52, v20, v52
    v_mul_f32 v53, v20, v53
    v_mul_f32 v54, v20, v54
    v_mul_f32 v55, v20, v55
    v_cvt_pk_bf16_f32 v48, v48, v49
    v_cvt_pk_bf16_f32 v49, v50, v51
    v_cvt_pk_bf16_f32 v50, v52, v53
    v_cvt_pk_bf16_f32 v51, v54, v55
    buffer_store_dwordx4 v[48:51], v2, s[8:11], s90 offen offset:0 sc1
    v_accvgpr_read_b32 v56, a104
    v_accvgpr_read_b32 v57, a105
    v_accvgpr_read_b32 v58, a106
    v_accvgpr_read_b32 v59, a107
    v_accvgpr_read_b32 v60, a108
    v_accvgpr_read_b32 v61, a109
    v_accvgpr_read_b32 v62, a110
    v_accvgpr_read_b32 v63, a111
    v_mul_f32 v56, v21, v56
    v_mul_f32 v57, v21, v57
    v_mul_f32 v58, v21, v58
    v_mul_f32 v59, v21, v59
    v_mul_f32 v60, v21, v60
    v_mul_f32 v61, v21, v61
    v_mul_f32 v62, v21, v62
    v_mul_f32 v63, v21, v63
    v_cvt_pk_bf16_f32 v56, v56, v57
    v_cvt_pk_bf16_f32 v57, v58, v59
    v_cvt_pk_bf16_f32 v58, v60, v61
    v_cvt_pk_bf16_f32 v59, v62, v63
    buffer_store_dwordx4 v[56:59], v2, s[8:11], s90 offen offset:1024 sc1
    s_add_u32 s90, s90, 131072
    v_accvgpr_read_b32 v48, a80
    v_accvgpr_read_b32 v49, a81
    v_accvgpr_read_b32 v50, a82
    v_accvgpr_read_b32 v51, a83
    v_accvgpr_read_b32 v52, a84
    v_accvgpr_read_b32 v53, a85
    v_accvgpr_read_b32 v54, a86
    v_accvgpr_read_b32 v55, a87
    v_mul_f32 v48, v20, v48
    v_mul_f32 v49, v20, v49
    v_mul_f32 v50, v20, v50
    v_mul_f32 v51, v20, v51
    v_mul_f32 v52, v20, v52
    v_mul_f32 v53, v20, v53
    v_mul_f32 v54, v20, v54
    v_mul_f32 v55, v20, v55
    v_cvt_pk_bf16_f32 v48, v48, v49
    v_cvt_pk_bf16_f32 v49, v50, v51
    v_cvt_pk_bf16_f32 v50, v52, v53
    v_cvt_pk_bf16_f32 v51, v54, v55
    buffer_store_dwordx4 v[48:51], v2, s[8:11], s90 offen offset:0 sc1
    v_accvgpr_read_b32 v56, a112
    v_accvgpr_read_b32 v57, a113
    v_accvgpr_read_b32 v58, a114
    v_accvgpr_read_b32 v59, a115
    v_accvgpr_read_b32 v60, a116
    v_accvgpr_read_b32 v61, a117
    v_accvgpr_read_b32 v62, a118
    v_accvgpr_read_b32 v63, a119
    v_mul_f32 v56, v21, v56
    v_mul_f32 v57, v21, v57
    v_mul_f32 v58, v21, v58
    v_mul_f32 v59, v21, v59
    v_mul_f32 v60, v21, v60
    v_mul_f32 v61, v21, v61
    v_mul_f32 v62, v21, v62
    v_mul_f32 v63, v21, v63
    v_cvt_pk_bf16_f32 v56, v56, v57
    v_cvt_pk_bf16_f32 v57, v58, v59
    v_cvt_pk_bf16_f32 v58, v60, v61
    v_cvt_pk_bf16_f32 v59, v62, v63
    buffer_store_dwordx4 v[56:59], v2, s[8:11], s90 offen offset:1024 sc1
    s_add_u32 s90, s90, 131072
    v_accvgpr_read_b32 v48, a88
    v_accvgpr_read_b32 v49, a89
    v_accvgpr_read_b32 v50, a90
    v_accvgpr_read_b32 v51, a91
    v_accvgpr_read_b32 v52, a92
    v_accvgpr_read_b32 v53, a93
    v_accvgpr_read_b32 v54, a94
    v_accvgpr_read_b32 v55, a95
    v_mul_f32 v48, v20, v48
    v_mul_f32 v49, v20, v49
    v_mul_f32 v50, v20, v50
    v_mul_f32 v51, v20, v51
    v_mul_f32 v52, v20, v52
    v_mul_f32 v53, v20, v53
    v_mul_f32 v54, v20, v54
    v_mul_f32 v55, v20, v55
    v_cvt_pk_bf16_f32 v48, v48, v49
    v_cvt_pk_bf16_f32 v49, v50, v51
    v_cvt_pk_bf16_f32 v50, v52, v53
    v_cvt_pk_bf16_f32 v51, v54, v55
    buffer_store_dwordx4 v[48:51], v2, s[8:11], s90 offen offset:0 sc1
    v_accvgpr_read_b32 v56, a120
    v_accvgpr_read_b32 v57, a121
    v_accvgpr_read_b32 v58, a122
    v_accvgpr_read_b32 v59, a123
    v_accvgpr_read_b32 v60, a124
    v_accvgpr_read_b32 v61, a125
    v_accvgpr_read_b32 v62, a126
    v_accvgpr_read_b32 v63, a127
    v_mul_f32 v56, v21, v56
    v_mul_f32 v57, v21, v57
    v_mul_f32 v58, v21, v58
    v_mul_f32 v59, v21, v59
    v_mul_f32 v60, v21, v60
    v_mul_f32 v61, v21, v61
    v_mul_f32 v62, v21, v62
    v_mul_f32 v63, v21, v63
    v_cvt_pk_bf16_f32 v56, v56, v57
    v_cvt_pk_bf16_f32 v57, v58, v59
    v_cvt_pk_bf16_f32 v58, v60, v61
    v_cvt_pk_bf16_f32 v59, v62, v63
    buffer_store_dwordx4 v[56:59], v2, s[8:11], s90 offen offset:1024 sc1
    s_add_u32 s90, s90, 131072
    s_lshl_b32 s101, s34, 5
    s_add_u32 s101, s101, s32
    s_lshl_b32 s101, s101, 3
    s_add_u32 s101, s101, 7936
    s_cmp_eq_u32 s64, s72
    s_cbranch_scc1 m_singlex102
.p2align 3
m_single101:
    v_mfma_f32_16x16x32_bf16 v[64:67], a[192:195], a[128:131], v[160:163]
    s_bitcmp1_b64 s[62:63], s64
    s_cselect_b32 s66, -1.0, s65
    v_add_f32 v12, v12, v28
    v_mfma_f32_16x16x32_bf16 v[64:67], a[196:199], a[132:135], v[64:67]
    s_mov_b32 m0, s59
    ds_read_b128 a[224:227], v6 offset:16384
    v_add_f32 v13, v13, v32
    v_mfma_f32_16x16x32_bf16 v[64:67], a[200:203], a[136:139], v[64:67]
    buffer_load_dwordx4 v7, s[24:27], s56 offen offset:0 sc1 lds
    v_mfma_f32_16x16x32_bf16 v[64:67], a[204:207], a[140:143], v[64:67]
    s_add_u32 s64, s64, 1
    ds_read_b128 a[228:231], v6 offset:17408
    v_exp_f32 v20, v96
    v_mfma_f32_16x16x32_bf16 v[72:75], a[204:207], a[156:159], v[168:171]
    ds_read_b128 a[232:235], v6 offset:18432
    v_exp_f32 v21, v97
    v_mfma_f32_16x16x32_bf16 v[72:75], a[200:203], a[152:155], v[72:75]
    ds_read_b128 a[236:239], v6 offset:19456
    v_cvt_pk_bf16_f32 v144, v20, v21
    v_mfma_f32_16x16x32_bf16 v[72:75], a[196:199], a[148:151], v[72:75]
    ds_read_b128 a[240:243], v6 offset:20480
    v_exp_f32 v22, v98
    v_mfma_f32_16x16x32_bf16 v[72:75], a[192:195], a[144:147], v[72:75]
    s_waitcnt lgkmcnt(5)
    ds_read_b128 a[244:247], v6 offset:21504
    v_mfma_f32_16x16x32_bf16 v[76:79], a[208:211], a[144:147], v[172:175]
    ds_read_b128 a[248:251], v6 offset:22528
    v_exp_f32 v23, v99
    v_mfma_f32_16x16x32_bf16 v[76:79], a[212:215], a[148:151], v[76:79]
    ds_read_b128 a[252:255], v6 offset:23552
    v_cvt_pk_bf16_f32 v145, v22, v23
    v_mfma_f32_16x16x32_bf16 v[76:79], a[216:219], a[152:155], v[76:79]
    buffer_load_dwordx4 v7, s[24:27], s56 offen offset:1024 sc1 lds
    v_mfma_f32_16x16x32_bf16 v[76:79], a[220:223], a[156:159], v[76:79]
    v_exp_f32 v24, v100
    v_mfma_f32_16x16x32_bf16 v[68:71], a[220:223], a[140:143], v[164:167]
    v_exp_f32 v25, v101
    v_mfma_f32_16x16x32_bf16 v[68:71], a[216:219], a[136:139], v[68:71]
    v_exp_f32 v26, v102
    v_mfma_f32_16x16x32_bf16 v[68:71], a[212:215], a[132:135], v[68:71]
    buffer_load_dwordx4 v7, s[24:27], s56 offen offset:2048 sc1 lds
    v_cvt_pk_bf16_f32 v146, v24, v25
    v_mfma_f32_16x16x32_bf16 v[68:71], a[208:211], a[128:131], v[68:71]
    s_waitcnt lgkmcnt(0)
    v_exp_f32 v27, v103
    v_mfma_f32_16x16x32_bf16 a[0:3], a[224:227], v[128:131], a[0:3]
    ds_read_b128 a[192:195], v6 offset:8192
    v_cvt_pk_bf16_f32 v147, v26, v27
    v_mfma_f32_16x16x32_bf16 a[32:35], a[224:227], v[132:135], a[32:35]
    v_exp_f32 v20, v104
    v_mfma_f32_16x16x32_bf16 v[28:31], v[44:47], v[144:147], 0
    v_exp_f32 v21, v105
    v_mfma_f32_16x16x32_bf16 a[36:39], a[228:231], v[132:135], a[36:39]
    ds_read_b128 a[196:199], v6 offset:9216
    v_exp_f32 v22, v106
    v_mfma_f32_16x16x32_bf16 a[4:7], a[228:231], v[128:131], a[4:7]
    buffer_load_dwordx4 v7, s[24:27], s56 offen offset:3072 sc1 lds
    v_mfma_f32_16x16x32_bf16 a[8:11], a[232:235], v[128:131], a[8:11]
    s_add_u32 s56, s56, 16384
    ds_read_b128 a[200:203], v6 offset:10240
    v_cvt_pk_bf16_f32 v148, v20, v21
    v_mfma_f32_16x16x32_bf16 a[40:43], a[232:235], v[132:135], a[40:43]
    v_exp_f32 v23, v107
    v_mfma_f32_16x16x32_bf16 a[44:47], a[236:239], v[132:135], a[44:47]
    ds_read_b128 a[204:207], v6 offset:11264
    v_exp_f32 v24, v108
    v_mfma_f32_16x16x32_bf16 a[12:15], a[236:239], v[128:131], a[12:15]
    v_cvt_pk_bf16_f32 v149, v22, v23
    v_exp_f32 v25, v109
    v_mfma_f32_16x16x32_bf16 a[16:19], a[240:243], v[128:131], a[16:19]
    v_exp_f32 v26, v110
    v_mfma_f32_16x16x32_bf16 a[48:51], a[240:243], v[132:135], a[48:51]
    v_cvt_pk_bf16_f32 v150, v24, v25
    v_exp_f32 v27, v111
    v_mfma_f32_16x16x32_bf16 a[52:55], a[244:247], v[132:135], a[52:55]
    ds_read_b128 a[208:211], v6 offset:12288
    v_cvt_pk_bf16_f32 v151, v26, v27
    v_mfma_f32_16x16x32_bf16 a[20:23], a[244:247], v[128:131], a[20:23]
    s_add_u32 m0, s59, 16384
    ds_read_b128 a[212:215], v6 offset:13312
    v_mfma_f32_16x16x32_bf16 v[32:35], v[44:47], v[148:151], 0
    s_nop 2
    v_mfma_f32_16x16x32_bf16 a[24:27], a[248:251], v[128:131], a[24:27]
    buffer_load_dwordx4 v7, s[28:31], s57 offen offset:0 sc1 lds
    v_mfma_f32_16x16x32_bf16 a[56:59], a[248:251], v[132:135], a[56:59]
    ds_read_b128 a[216:219], v6 offset:14336
    s_nop 0
    v_mfma_f32_16x16x32_bf16 a[60:63], a[252:255], v[132:135], a[60:63]
    ds_read_b128 a[220:223], v6 offset:15360
    v_max_f32 v8, v28, v32
    v_cmp_nge_f32 vcc, s66, v8
    v_mfma_f32_16x16x32_bf16 a[28:31], a[252:255], v[128:131], a[28:31]
    s_waitcnt lgkmcnt(4)
    s_cbranch_vccnz m_stub103
m_ret104:
    v_mfma_f32_16x16x32_bf16 v[96:99], a[192:195], a[128:131], v[160:163]
    s_add_u32 s59, s58, s60
    v_exp_f32 v20, v64
    v_mfma_f32_16x16x32_bf16 v[96:99], a[196:199], a[132:135], v[96:99]
    s_add_u32 s58, s58, 32768
    ds_read_b128 a[224:227], v6 offset:24576
    v_add_f32 v12, v12, v28
    v_mfma_f32_16x16x32_bf16 v[96:99], a[200:203], a[136:139], v[96:99]
    s_cmp_ge_u32 s58, 163840
    s_cselect_b32 s58, 0, s58
    ds_read_b128 a[228:231], v6 offset:25600
    v_exp_f32 v21, v65
    v_mfma_f32_16x16x32_bf16 v[96:99], a[204:207], a[140:143], v[96:99]
    s_bitcmp1_b64 s[62:63], s64
    s_cselect_b32 s66, -1.0, s65
    ds_read_b128 a[232:235], v6 offset:26624
    v_mfma_f32_16x16x32_bf16 v[104:107], a[204:207], a[156:159], v[168:171]
    buffer_load_dwordx4 v7, s[28:31], s57 offen offset:1024 sc1 lds
    v_mfma_f32_16x16x32_bf16 v[104:107], a[200:203], a[152:155], v[104:107]
    s_add_u32 s64, s64, 1
    ds_read_b128 a[236:239], v6 offset:27648
    v_cvt_pk_bf16_f32 v128, v20, v21
    v_mfma_f32_16x16x32_bf16 v[104:107], a[196:199], a[148:151], v[104:107]
    ds_read_b128 a[240:243], v6 offset:28672
    v_exp_f32 v22, v66
    v_mfma_f32_16x16x32_bf16 v[104:107], a[192:195], a[144:147], v[104:107]
    s_waitcnt lgkmcnt(5)
    ds_read_b128 a[244:247], v6 offset:29696
    v_add_f32 v13, v13, v32
    v_mfma_f32_16x16x32_bf16 v[108:111], a[208:211], a[144:147], v[172:175]
    ds_read_b128 a[248:251], v6 offset:30720
    v_exp_f32 v23, v67
    v_mfma_f32_16x16x32_bf16 v[108:111], a[212:215], a[148:151], v[108:111]
    buffer_load_dwordx4 v7, s[28:31], s57 offen offset:2048 sc1 lds
    v_mfma_f32_16x16x32_bf16 v[108:111], a[216:219], a[152:155], v[108:111]
    ds_read_b128 a[252:255], v6 offset:31744
    v_cvt_pk_bf16_f32 v129, v22, v23
    v_mfma_f32_16x16x32_bf16 v[108:111], a[220:223], a[156:159], v[108:111]
    v_exp_f32 v24, v68
    v_mfma_f32_16x16x32_bf16 v[100:103], a[220:223], a[140:143], v[164:167]
    v_exp_f32 v25, v69
    v_mfma_f32_16x16x32_bf16 v[100:103], a[216:219], a[136:139], v[100:103]
    buffer_load_dwordx4 v7, s[28:31], s57 offen offset:3072 sc1 lds
    v_mfma_f32_16x16x32_bf16 v[100:103], a[212:215], a[132:135], v[100:103]
    s_add_u32 s57, s57, 16384
    v_exp_f32 v26, v70
    v_cvt_pk_bf16_f32 v130, v24, v25
    v_mfma_f32_16x16x32_bf16 v[100:103], a[208:211], a[128:131], v[100:103]
    s_waitcnt vmcnt(24) lgkmcnt(0)
    v_add_u32 v6, s58, v2
    v_exp_f32 v27, v71
    v_mfma_f32_16x16x32_bf16 a[0:3], a[224:227], v[144:147], a[0:3]
    s_barrier
    v_mfma_f32_16x16x32_bf16 a[32:35], a[224:227], v[148:151], a[32:35]
    ds_read_b128 a[192:195], v6 offset:0
    v_cvt_pk_bf16_f32 v131, v26, v27
    v_mfma_f32_16x16x32_bf16 a[36:39], a[228:231], v[148:151], a[36:39]
    v_exp_f32 v20, v72
    v_mfma_f32_16x16x32_bf16 v[28:31], v[44:47], v[128:131], 0
    v_exp_f32 v21, v73
    v_mfma_f32_16x16x32_bf16 a[4:7], a[228:231], v[144:147], a[4:7]
    ds_read_b128 a[196:199], v6 offset:1024
    v_cvt_pk_bf16_f32 v132, v20, v21
    v_mfma_f32_16x16x32_bf16 a[8:11], a[232:235], v[144:147], a[8:11]
    v_exp_f32 v22, v74
    v_mfma_f32_16x16x32_bf16 a[40:43], a[232:235], v[148:151], a[40:43]
    ds_read_b128 a[200:203], v6 offset:2048
    v_exp_f32 v23, v75
    v_mfma_f32_16x16x32_bf16 a[44:47], a[236:239], v[148:151], a[44:47]
    v_exp_f32 v24, v76
    v_mfma_f32_16x16x32_bf16 a[12:15], a[236:239], v[144:147], a[12:15]
    ds_read_b128 a[204:207], v6 offset:3072
    v_cvt_pk_bf16_f32 v133, v22, v23
    v_mfma_f32_16x16x32_bf16 a[16:19], a[240:243], v[144:147], a[16:19]
    v_exp_f32 v25, v77
    v_mfma_f32_16x16x32_bf16 a[48:51], a[240:243], v[148:151], a[48:51]
    v_exp_f32 v26, v78
    v_cvt_pk_bf16_f32 v134, v24, v25
    v_mfma_f32_16x16x32_bf16 a[52:55], a[244:247], v[148:151], a[52:55]
    v_exp_f32 v27, v79
    v_mfma_f32_16x16x32_bf16 a[20:23], a[244:247], v[144:147], a[20:23]
    ds_read_b128 a[208:211], v6 offset:4096
    v_cvt_pk_bf16_f32 v135, v26, v27
    s_nop 1
    v_mfma_f32_16x16x32_bf16 v[32:35], v[44:47], v[132:135], 0
    s_nop 2
    v_mfma_f32_16x16x32_bf16 a[24:27], a[248:251], v[144:147], a[24:27]
    ds_read_b128 a[212:215], v6 offset:5120
    s_nop 0
    v_mfma_f32_16x16x32_bf16 a[56:59], a[248:251], v[148:151], a[56:59]
    ds_read_b128 a[216:219], v6 offset:6144
    v_max_f32 v8, v28, v32
    v_mfma_f32_16x16x32_bf16 a[60:63], a[252:255], v[148:151], a[60:63]
    ds_read_b128 a[220:223], v6 offset:7168
    v_cmp_nge_f32 vcc, s66, v8
    v_mfma_f32_16x16x32_bf16 a[28:31], a[252:255], v[144:147], a[28:31]
    s_waitcnt lgkmcnt(4)
    s_cbranch_vccz m_single101
    v_cmp_lt_f32 vcc, s65, v8
    s_cmp_lg_u32 s64, s70
    s_cbranch_scc1 m_e106
    v_add_f32 v160, v160, v16
    v_mov_b32 v164, v9
    v_add_f32 v172, v172, v16
    v_add_f32 v161, v161, v17
    v_mov_b32 v165, v9
    v_add_f32 v173, v173, v17
    v_add_f32 v162, v162, v18
    v_mov_b32 v166, v9
    v_add_f32 v174, v174, v18
    v_add_f32 v163, v163, v19
    v_mov_b32 v167, v9
    v_add_f32 v175, v175, v19
    s_nop 0
m_e106:
    s_cmp_lg_u32 s64, s71
    s_cbranch_scc1 m_e107
    v_mov_b32 v160, v9
    v_mov_b32 v168, v9
    v_mov_b32 v172, v9
    v_mov_b32 v161, v9
    v_mov_b32 v169, v9
    v_mov_b32 v173, v9
    v_mov_b32 v162, v9
    v_mov_b32 v170, v9
    v_mov_b32 v174, v9
    v_mov_b32 v163, v9
    v_mov_b32 v171, v9
    v_mov_b32 v175, v9
    s_nop 0
m_e107:
    s_cmp_lg_u32 s64, s53
    s_cbranch_scc1 m_e110
    s_cmp_lg_u32 s16, 0
    s_cbranch_scc1 m_np111
    v_mov_b32 v60, s4
    v_mov_b32 v61, s5
    s_add_u32 s90, s101, 117440512
    s_mov_b64 exec, 1
    buffer_store_dwordx2 v[60:61], off, s[8:11], s90 sc1
    s_mov_b64 exec, -1
m_np111:
    s_mov_b32 s101, -1
m_e110:
    s_cmp_gt_u32 s64, 24
    s_cbranch_scc1 m_e108
    s_cmp_lg_u32 s64, 8
    s_cbranch_scc1 m_e112
    s_lshr_b32 s90, s32, 1
    s_lshl_b32 s90, s90, 7
    s_add_u32 s90, s90, 117440600
    v_min_u32 v0, 1, v1
    v_lshlrev_b32 v0, 5, v0
    buffer_load_dwordx2 v[4:5], v0, s[8:11], s90 offen sc1
    s_cmp_eq_u32 s17, -1
    s_cbranch_scc1 m_e108
    s_cmp_lg_u32 s16, 0
    s_cbranch_scc1 m_np113
    v_mov_b32 v60, s4
    v_mov_b32 v61, s5
    s_add_u32 s90, s17, 117440512
    s_mov_b64 exec, 1
    buffer_store_dwordx2 v[60:61], off, s[8:11], s90 sc1
    s_mov_b64 exec, -1
m_np113:
    s_branch m_e108
m_e112:
    s_cmp_lg_u32 s64, 16
    s_cbranch_scc1 m_e114
    s_waitcnt vmcnt(18)
    s_mov_b32 s3, 1048576
m_spin115:
    v_cmp_ne_u64 s[76:77], s[4:5], v[4:5]
    s_nop 3
    s_cmp_eq_u64 s[76:77], 0
    s_cbranch_scc1 m_e108
    s_sub_u32 s3, s3, 1
    s_cbranch_scc1 m_e108
    s_sleep 32
    s_lshr_b32 s90, s32, 1
    s_lshl_b32 s90, s90, 7
    s_add_u32 s90, s90, 117440600
    v_min_u32 v0, 1, v1
    v_lshlrev_b32 v0, 5, v0
    buffer_load_dwordx2 v[4:5], v0, s[8:11], s90 offen sc1
    s_waitcnt vmcnt(0)
    s_branch m_spin115
    s_branch m_e108
m_e114:
    s_cmp_lg_u32 s64, 20
    s_cbranch_scc1 m_e116
    buffer_load_dwordx2 v[4:5], v10, s[8:11], 0 offen sc1
    s_mov_b32 s44, s48
    s_mov_b32 s45, s49
    s_mov_b32 s46, 8388608
    s_lshl_b32 s90, s2, 2
    s_add_u32 s90, s90, s16
    s_lshl_b32 s90, s90, 13
    v_lshlrev_b32 v62, 7, v1
    buffer_load_dword v255, v62, s[44:47], s90 offen
    s_branch m_e108
m_e116:
    s_cmp_lg_u32 s64, 24
    s_cbranch_scc1 m_e117
    s_mov_b32 s44, s50
    s_mov_b32 s45, s51
    s_mov_b32 s46, 2097152
    s_lshl_b32 s90, s2, 2
    s_add_u32 s90, s90, s16
    s_lshl_b32 s90, s90, 13
    v_lshlrev_b32 v62, 7, v1
    buffer_load_dword v255, v62, s[44:47], s90 offen
    s_waitcnt vmcnt(18)
    s_mov_b32 s3, 1048576
m_spin118:
    v_cmp_ne_u64 s[76:77], s[4:5], v[4:5]
    s_nop 3
    s_cmp_eq_u64 s[76:77], 0
    s_cbranch_scc1 m_e108
    s_sub_u32 s3, s3, 1
    s_cbranch_scc1 m_e108
    s_sleep 32
    buffer_load_dwordx2 v[4:5], v10, s[8:11], 0 offen sc1
    s_waitcnt vmcnt(0)
    s_branch m_spin118
    s_branch m_e108
m_e117:
m_e108:
    s_cbranch_vccnz m_rc119
m_sp105:
    s_cmp_lg_u32 s64, s72
    s_cbranch_scc1 m_single101
m_singlex102:
    s_bfe_u32 s95, s2, 0x10002
    s_and_b32 s90, s2, 7
    s_bitcmp1_b32 0x63, s90
    s_cselect_b32 s96, s33, s34
    s_sub_u32 s96, s96, 1
    s_and_b32 s90, s2, 1
    s_lshl_b32 s90, s90, 2
    s_bfe_u32 s91, s2, 0x20003
    s_add_u32 s97, s90, s91
    v_and_b32 v10, 31, v1
    v_lshlrev_b32 v10, 3, v10
    s_lshl_b32 s52, s96, 8
    s_add_u32 s52, s52, 117448704
    buffer_load_dwordx2 v[4:5], v10, s[8:11], s52 offen sc1
    ds_read_b128 a[224:227], v6 offset:16384
    ds_read_b128 a[228:231], v6 offset:17408
    ds_read_b128 a[232:235], v6 offset:18432
    ds_read_b128 a[236:239], v6 offset:19456
    ds_read_b128 a[240:243], v6 offset:20480
    ds_read_b128 a[244:247], v6 offset:21504
    ds_read_b128 a[248:251], v6 offset:22528
    ds_read_b128 a[252:255], v6 offset:23552
    s_waitcnt lgkmcnt(0)
    v_mfma_f32_16x16x32_bf16 a[0:3], a[224:227], v[128:131], a[0:3]
    buffer_load_dwordx4 v[192:195], v2, s[8:11], s83 offen offset:0 sc1
    v_exp_f32 v20, v96
    v_mfma_f32_16x16x32_bf16 a[32:35], a[224:227], v[132:135], a[32:35]
    v_exp_f32 v21, v97
    v_exp_f32 v22, v98
    v_mfma_f32_16x16x32_bf16 a[36:39], a[228:231], v[132:135], a[36:39]
    buffer_load_dwordx4 v[196:199], v2, s[8:11], s83 offen offset:1024 sc1
    v_cvt_pk_bf16_f32 v144, v20, v21
    v_add_f32 v12, v12, v28
    v_mfma_f32_16x16x32_bf16 a[4:7], a[228:231], v[128:131], a[4:7]
    v_exp_f32 v23, v99
    v_exp_f32 v24, v100
    v_cvt_pk_bf16_f32 v145, v22, v23
    v_mfma_f32_16x16x32_bf16 a[8:11], a[232:235], v[128:131], a[8:11]
    buffer_load_dwordx4 v[200:203], v2, s[8:11], s83 offen offset:2048 sc1
    v_exp_f32 v25, v101
    v_mfma_f32_16x16x32_bf16 a[40:43], a[232:235], v[132:135], a[40:43]
    v_exp_f32 v26, v102
    v_cvt_pk_bf16_f32 v146, v24, v25
    v_add_f32 v13, v13, v32
    v_mfma_f32_16x16x32_bf16 a[44:47], a[236:239], v[132:135], a[44:47]
    buffer_load_dwordx4 v[204:207], v2, s[8:11], s83 offen offset:3072 sc1
    v_exp_f32 v27, v103
    v_mfma_f32_16x16x32_bf16 a[12:15], a[236:239], v[128:131], a[12:15]
    v_exp_f32 v20, v104
    v_cvt_pk_bf16_f32 v147, v26, v27
    v_mfma_f32_16x16x32_bf16 a[16:19], a[240:243], v[128:131], a[16:19]
    buffer_load_dwordx4 v[212:215], v2, s[8:11], s84 offen offset:0 sc1
    v_exp_f32 v21, v105
    v_mfma_f32_16x16x32_bf16 v[28:31], v[44:47], v[144:147], 0
    v_exp_f32 v22, v106
    v_cvt_pk_bf16_f32 v148, v20, v21
    v_exp_f32 v23, v107
    v_mfma_f32_16x16x32_bf16 a[48:51], a[240:243], v[132:135], a[48:51]
    v_exp_f32 v24, v108
    v_cvt_pk_bf16_f32 v149, v22, v23
    v_exp_f32 v25, v109
    v_mfma_f32_16x16x32_bf16 a[52:55], a[244:247], v[132:135], a[52:55]
    buffer_load_dwordx4 v[216:219], v2, s[8:11], s84 offen offset:1024 sc1
    v_exp_f32 v26, v110
    v_mfma_f32_16x16x32_bf16 a[20:23], a[244:247], v[128:131], a[20:23]
    v_cvt_pk_bf16_f32 v150, v24, v25
    v_exp_f32 v27, v111
    s_nop 0
    v_cvt_pk_bf16_f32 v151, v26, v27
    s_nop 1
    v_mfma_f32_16x16x32_bf16 v[32:35], v[44:47], v[148:151], 0
    s_nop 2
    v_mfma_f32_16x16x32_bf16 a[24:27], a[248:251], v[128:131], a[24:27]
    buffer_load_dwordx4 v[220:223], v2, s[8:11], s84 offen offset:2048 sc1
    v_mfma_f32_16x16x32_bf16 a[56:59], a[248:251], v[132:135], a[56:59]
    s_nop 2
    v_mfma_f32_16x16x32_bf16 a[60:63], a[252:255], v[132:135], a[60:63]
    v_max_f32 v8, v28, v32
    v_cmp_nge_f32 vcc, s65, v8
    v_mfma_f32_16x16x32_bf16 a[28:31], a[252:255], v[128:131], a[28:31]
    s_cbranch_vccnz m_stub120
m_ret121:
    s_nop 1
    s_cmp_ge_u32 s16, 2
    s_cbranch_scc1 m_xb122
    s_waitcnt vmcnt(24)
    s_barrier
m_xb122:
    ds_read_b128 a[224:227], v6 offset:24576
    ds_read_b128 a[228:231], v6 offset:25600
    ds_read_b128 a[232:235], v6 offset:26624
    ds_read_b128 a[236:239], v6 offset:27648
    ds_read_b128 a[240:243], v6 offset:28672
    ds_read_b128 a[244:247], v6 offset:29696
    ds_read_b128 a[248:251], v6 offset:30720
    ds_read_b128 a[252:255], v6 offset:31744
    s_waitcnt lgkmcnt(0)
    v_mfma_f32_16x16x32_bf16 a[0:3], a[224:227], v[144:147], a[0:3]
    buffer_load_dwordx4 v[224:227], v2, s[8:11], s84 offen offset:3072 sc1
    v_mfma_f32_16x16x32_bf16 a[32:35], a[224:227], v[148:151], a[32:35]
    v_mfma_f32_16x16x32_bf16 a[36:39], a[228:231], v[148:151], a[36:39]
    buffer_load_dwordx4 v[208:211], v2, s[8:11], s85 offen offset:0 sc1
    v_mfma_f32_16x16x32_bf16 a[4:7], a[228:231], v[144:147], a[4:7]
    v_mfma_f32_16x16x32_bf16 a[8:11], a[232:235], v[144:147], a[8:11]
    buffer_load_dwordx4 v[232:235], v2, s[8:11], s86 offen offset:0 sc1
    v_mfma_f32_16x16x32_bf16 a[40:43], a[232:235], v[148:151], a[40:43]
    v_mfma_f32_16x16x32_bf16 a[44:47], a[236:239], v[148:151], a[44:47]
    buffer_load_dwordx4 v[236:239], v2, s[8:11], s86 offen offset:1024 sc1
    v_mfma_f32_16x16x32_bf16 a[12:15], a[236:239], v[144:147], a[12:15]
    v_mfma_f32_16x16x32_bf16 a[16:19], a[240:243], v[144:147], a[16:19]
    buffer_load_dwordx4 v[228:231], v2, s[8:11], s87 offen offset:0 sc1
    v_mfma_f32_16x16x32_bf16 a[48:51], a[240:243], v[148:151], a[48:51]
    v_mfma_f32_16x16x32_bf16 a[52:55], a[244:247], v[148:151], a[52:55]
    buffer_load_dwordx4 v[244:247], v2, s[8:11], s88 offen offset:0 sc1
    v_mfma_f32_16x16x32_bf16 a[20:23], a[244:247], v[144:147], a[20:23]
    v_mfma_f32_16x16x32_bf16 a[24:27], a[248:251], v[144:147], a[24:27]
    buffer_load_dwordx4 v[248:251], v2, s[8:11], s88 offen offset:1024 sc1
    v_mfma_f32_16x16x32_bf16 a[56:59], a[248:251], v[148:151], a[56:59]
    v_mfma_f32_16x16x32_bf16 a[60:63], a[252:255], v[148:151], a[60:63]
    buffer_load_dwordx4 v[240:243], v2, s[8:11], s89 offen offset:0 sc1
    v_mfma_f32_16x16x32_bf16 a[28:31], a[252:255], v[144:147], a[28:31]
    v_add_f32 v20, v12, v28
    v_add_f32 v21, v13, v32
    s_nop 3
    v_rcp_f32 v20, v20
    v_rcp_f32 v21, v21
    s_lshl_b32 s90, s78, 10
    s_add_u32 s90, s90, s82
    s_add_u32 s90, s90, 67108864
    v_accvgpr_read_b32 v48, a0
    v_accvgpr_read_b32 v49, a1
    v_accvgpr_read_b32 v50, a2
    v_accvgpr_read_b32 v51, a3
    v_accvgpr_read_b32 v52, a4
    v_accvgpr_read_b32 v53, a5
    v_accvgpr_read_b32 v54, a6
    v_accvgpr_read_b32 v55, a7
    v_mul_f32 v48, v20, v48
    v_mul_f32 v49, v20, v49
    v_mul_f32 v50, v20, v50
    v_mul_f32 v51, v20, v51
    v_mul_f32 v52, v20, v52
    v_mul_f32 v53, v20, v53
    v_mul_f32 v54, v20, v54
    v_mul_f32 v55, v20, v55
    v_cvt_pk_bf16_f32 v48, v48, v49
    v_cvt_pk_bf16_f32 v49, v50, v51
    v_cvt_pk_bf16_f32 v50, v52, v53
    v_cvt_pk_bf16_f32 v51, v54, v55
    buffer_store_dwordx4 v[48:51], v2, s[8:11], s90 offen offset:0 sc1
    v_accvgpr_read_b32 v56, a32
    v_accvgpr_read_b32 v57, a33
    v_accvgpr_read_b32 v58, a34
    v_accvgpr_read_b32 v59, a35
    v_accvgpr_read_b32 v60, a36
    v_accvgpr_read_b32 v61, a37
    v_accvgpr_read_b32 v62, a38
    v_accvgpr_read_b32 v63, a39
    v_mul_f32 v56, v21, v56
    v_mul_f32 v57, v21, v57
    v_mul_f32 v58, v21, v58
    v_mul_f32 v59, v21, v59
    v_mul_f32 v60, v21, v60
    v_mul_f32 v61, v21, v61
    v_mul_f32 v62, v21, v62
    v_mul_f32 v63, v21, v63
    v_cvt_pk_bf16_f32 v56, v56, v57
    v_cvt_pk_bf16_f32 v57, v58, v59
    v_cvt_pk_bf16_f32 v58, v60, v61
    v_cvt_pk_bf16_f32 v59, v62, v63
    buffer_store_dwordx4 v[56:59], v2, s[8:11], s90 offen offset:1024 sc1
    s_add_u32 s90, s90, 131072
    v_accvgpr_read_b32 v48, a8
    v_accvgpr_read_b32 v49, a9
    v_accvgpr_read_b32 v50, a10
    v_accvgpr_read_b32 v51, a11
    v_accvgpr_read_b32 v52, a12
    v_accvgpr_read_b32 v53, a13
    v_accvgpr_read_b32 v54, a14
    v_accvgpr_read_b32 v55, a15
    v_mul_f32 v48, v20, v48
    v_mul_f32 v49, v20, v49
    v_mul_f32 v50, v20, v50
    v_mul_f32 v51, v20, v51
    v_mul_f32 v52, v20, v52
    v_mul_f32 v53, v20, v53
    v_mul_f32 v54, v20, v54
    v_mul_f32 v55, v20, v55
    v_cvt_pk_bf16_f32 v48, v48, v49
    v_cvt_pk_bf16_f32 v49, v50, v51
    v_cvt_pk_bf16_f32 v50, v52, v53
    v_cvt_pk_bf16_f32 v51, v54, v55
    buffer_store_dwordx4 v[48:51], v2, s[8:11], s90 offen offset:0 sc1
    v_accvgpr_read_b32 v56, a40
    v_accvgpr_read_b32 v57, a41
    v_accvgpr_read_b32 v58, a42
    v_accvgpr_read_b32 v59, a43
    v_accvgpr_read_b32 v60, a44
    v_accvgpr_read_b32 v61, a45
    v_accvgpr_read_b32 v62, a46
    v_accvgpr_read_b32 v63, a47
    v_mul_f32 v56, v21, v56
    v_mul_f32 v57, v21, v57
    v_mul_f32 v58, v21, v58
    v_mul_f32 v59, v21, v59
    v_mul_f32 v60, v21, v60
    v_mul_f32 v61, v21, v61
    v_mul_f32 v62, v21, v62
    v_mul_f32 v63, v21, v63
    v_cvt_pk_bf16_f32 v56, v56, v57
    v_cvt_pk_bf16_f32 v57, v58, v59
    v_cvt_pk_bf16_f32 v58, v60, v61
    v_cvt_pk_bf16_f32 v59, v62, v63
    buffer_store_dwordx4 v[56:59], v2, s[8:11], s90 offen offset:1024 sc1
    s_add_u32 s90, s90, 131072
    v_accvgpr_read_b32 v48, a16
    v_accvgpr_read_b32 v49, a17
    v_accvgpr_read_b32 v50, a18
    v_accvgpr_read_b32 v51, a19
    v_accvgpr_read_b32 v52, a20
    v_accvgpr_read_b32 v53, a21
    v_accvgpr_read_b32 v54, a22
    v_accvgpr_read_b32 v55, a23
    v_mul_f32 v48, v20, v48
    v_mul_f32 v49, v20, v49
    v_mul_f32 v50, v20, v50
    v_mul_f32 v51, v20, v51
    v_mul_f32 v52, v20, v52
    v_mul_f32 v53, v20, v53
    v_mul_f32 v54, v20, v54
    v_mul_f32 v55, v20, v55
    v_cvt_pk_bf16_f32 v48, v48, v49
    v_cvt_pk_bf16_f32 v49, v50, v51
    v_cvt_pk_bf16_f32 v50, v52, v53
    v_cvt_pk_bf16_f32 v51, v54, v55
    buffer_store_dwordx4 v[48:51], v2, s[8:11], s90 offen offset:0 sc1
    v_accvgpr_read_b32 v56, a48
    v_accvgpr_read_b32 v57, a49
    v_accvgpr_read_b32 v58, a50
    v_accvgpr_read_b32 v59, a51
    v_accvgpr_read_b32 v60, a52
    v_accvgpr_read_b32 v61, a53
    v_accvgpr_read_b32 v62, a54
    v_accvgpr_read_b32 v63, a55
    v_mul_f32 v56, v21, v56
    v_mul_f32 v57, v21, v57
    v_mul_f32 v58, v21, v58
    v_mul_f32 v59, v21, v59
    v_mul_f32 v60, v21, v60
    v_mul_f32 v61, v21, v61
    v_mul_f32 v62, v21, v62
    v_mul_f32 v63, v21, v63
    v_cvt_pk_bf16_f32 v56, v56, v57
    v_cvt_pk_bf16_f32 v57, v58, v59
    v_cvt_pk_bf16_f32 v58, v60, v61
    v_cvt_pk_bf16_f32 v59, v62, v63
    buffer_store_dwordx4 v[56:59], v2, s[8:11], s90 offen offset:1024 sc1
    s_add_u32 s90, s90, 131072
    v_accvgpr_read_b32 v48, a24
    v_accvgpr_read_b32 v49, a25
    v_accvgpr_read_b32 v50, a26
    v_accvgpr_read_b32 v51, a27
    v_accvgpr_read_b32 v52, a28
    v_accvgpr_read_b32 v53, a29
    v_accvgpr_read_b32 v54, a30
    v_accvgpr_read_b32 v55, a31
    v_mul_f32 v48, v20, v48
    v_mul_f32 v49, v20, v49
    v_mul_f32 v50, v20, v50
    v_mul_f32 v51, v20, v51
    v_mul_f32 v52, v20, v52
    v_mul_f32 v53, v20, v53
    v_mul_f32 v54, v20, v54
    v_mul_f32 v55, v20, v55
    v_cvt_pk_bf16_f32 v48, v48, v49
    v_cvt_pk_bf16_f32 v49, v50, v51
    v_cvt_pk_bf16_f32 v50, v52, v53
    v_cvt_pk_bf16_f32 v51, v54, v55
    buffer_store_dwordx4 v[48:51], v2, s[8:11], s90 offen offset:0 sc1
    v_accvgpr_read_b32 v56, a56
    v_accvgpr_read_b32 v57, a57
    v_accvgpr_read_b32 v58, a58
    v_accvgpr_read_b32 v59, a59
    v_accvgpr_read_b32 v60, a60
    v_accvgpr_read_b32 v61, a61
    v_accvgpr_read_b32 v62, a62
    v_accvgpr_read_b32 v63, a63
    v_mul_f32 v56, v21, v56
    v_mul_f32 v57, v21, v57
    v_mul_f32 v58, v21, v58
    v_mul_f32 v59, v21, v59
    v_mul_f32 v60, v21, v60
    v_mul_f32 v61, v21, v61
    v_mul_f32 v62, v21, v62
    v_mul_f32 v63, v21, v63
    v_cvt_pk_bf16_f32 v56, v56, v57
    v_cvt_pk_bf16_f32 v57, v58, v59
    v_cvt_pk_bf16_f32 v58, v60, v61
    v_cvt_pk_bf16_f32 v59, v62, v63
    buffer_store_dwordx4 v[56:59], v2, s[8:11], s90 offen offset:1024 sc1
    s_add_u32 s90, s90, 131072
    s_barrier
    s_lshr_b32 s53, s16, 1
    s_and_b32 s40, s16, 1
    s_mul_i32 s90, s95, 5242880
    s_lshl_b32 s57, s97, 8
    s_add_u32 s57, s57, s90
    v_lshrrev_b32 v20, 4, v1
    s_lshl_b32 s90, s16, 4
    v_add_u32 v21, s90, v20
    v_lshlrev_b32 v21, 11, v21
    v_lshlrev_b32 v20, 1, v20
    v_and_b32 v22, 15, v1
    v_xor_b32 v20, v20, v22
    v_xor_b32 v22, 0, v20
    v_lshl_add_u32 v16, v22, 4, v21
    v_xor_b32 v22, 8, v20
    v_lshl_add_u32 v17, v22, 4, v21
    v_add_u32 v17, 7168, v17
    v_xor_b32 v22, 0, v20
    v_lshl_add_u32 v18, v22, 4, v21
    v_add_u32 v18, 14336, v18
    v_xor_b32 v22, 8, v20
    v_lshl_add_u32 v19, v22, 4, v21
    v_add_u32 v19, 21504, v19
    s_mov_b32 s24, s48
    s_mov_b32 s25, s49
    s_mov_b32 s26, 8388608
    s_mov_b32 s38, 268435456
    s_mov_b32 s28, s54
    s_mov_b32 s29, s55
    s_mov_b32 s30, 8388608
    s_lshl_b32 s90, s96, 13
    s_lshl_b32 s91, s40, 12
    s_add_u32 s90, s90, s91
    s_lshl_b32 s91, s53, 17
    s_add_u32 s69, s90, s91
    s_mul_i32 s90, s95, 10485760
    s_add_u32 s56, s69, s90
    s_add_u32 s56, s56, 67108864
    s_add_u32 s69, s69, 83886080
    s_add_u32 m0, s60, 16384
    s_nop 0
    buffer_load_dwordx4 v16, s[24:27], s57 offen offset:0 sc1 lds
    buffer_load_dwordx4 v17, s[24:27], s57 offen offset:1024 sc1 lds
    buffer_load_dwordx4 v18, s[24:27], s57 offen offset:2048 sc1 lds
    buffer_load_dwordx4 v19, s[24:27], s57 offen offset:3072 sc1 lds
    s_add_u32 s57, s57, 131072
    s_add_u32 m0, s60, 49152
    s_nop 0
    buffer_load_dwordx4 v16, s[24:27], s57 offen offset:0 sc1 lds
    buffer_load_dwordx4 v17, s[24:27], s57 offen offset:1024 sc1 lds
    buffer_load_dwordx4 v18, s[24:27], s57 offen offset:2048 sc1 lds
    buffer_load_dwordx4 v19, s[24:27], s57 offen offset:3072 sc1 lds
    s_add_u32 s57, s57, 131072
    s_add_u32 m0, s60, 81920
    s_nop 0
    buffer_load_dwordx4 v16, s[24:27], s57 offen offset:0 sc1 lds
    buffer_load_dwordx4 v17, s[24:27], s57 offen offset:1024 sc1 lds
    buffer_load_dwordx4 v18, s[24:27], s57 offen offset:2048 sc1 lds
    buffer_load_dwordx4 v19, s[24:27], s57 offen offset:3072 sc1 lds
    s_add_u32 s57, s57, 131072
    s_add_u32 m0, s60, 114688
    s_nop 0
    buffer_load_dwordx4 v16, s[24:27], s57 offen offset:0 sc1 lds
    buffer_load_dwordx4 v17, s[24:27], s57 offen offset:1024 sc1 lds
    buffer_load_dwordx4 v18, s[24:27], s57 offen offset:2048 sc1 lds
    buffer_load_dwordx4 v19, s[24:27], s57 offen offset:3072 sc1 lds
    s_add_u32 s57, s57, 131072
    s_waitcnt vmcnt(39)
    v_cmp_ne_u64 s[76:77], s[4:5], v[4:5]
    s_mul_i32 s91, s95, 20
    s_nop 2
    s_lshr_b32 s90, s76, s91
    s_ff1_i32_b32 s90, s90
    s_lshl_b32 s68, s90, 1
    s_mul_i32 s91, s95, 0
    s_sub_i32 s68, s68, s91
    s_cmp_lt_i32 s90, 0
    s_cselect_b32 s68, 1000, s68
    s_mov_b32 s99, 0
    s_cmp_gt_i32 s68, 4
    s_cbranch_scc0 m_x1123
    s_mov_b32 s99, 1
    s_add_u32 m0, s60, 0
    s_nop 0
    buffer_load_dwordx4 v2, s[36:39], s56 offen offset:0 sc1 lds
    buffer_load_dwordx4 v2, s[36:39], s56 offen offset:1024 sc1 lds
    buffer_load_dwordx4 v2, s[36:39], s56 offen offset:2048 sc1 lds
    buffer_load_dwordx4 v2, s[36:39], s56 offen offset:3072 sc1 lds
    s_add_u32 s56, s56, 262144
    s_add_u32 m0, s60, 32768
    s_nop 0
    buffer_load_dwordx4 v2, s[36:39], s56 offen offset:0 sc1 lds
    buffer_load_dwordx4 v2, s[36:39], s56 offen offset:1024 sc1 lds
    buffer_load_dwordx4 v2, s[36:39], s56 offen offset:2048 sc1 lds
    buffer_load_dwordx4 v2, s[36:39], s56 offen offset:3072 sc1 lds
    s_add_u32 s56, s56, 262144
    s_add_u32 m0, s60, 65536
    s_nop 0
    buffer_load_dwordx4 v2, s[36:39], s56 offen offset:0 sc1 lds
    buffer_load_dwordx4 v2, s[36:39], s56 offen offset:1024 sc1 lds
    buffer_load_dwordx4 v2, s[36:39], s56 offen offset:2048 sc1 lds
    buffer_load_dwordx4 v2, s[36:39], s56 offen offset:3072 sc1 lds
    s_add_u32 s56, s56, 262144
    s_add_u32 m0, s60, 98304
    s_nop 0
    buffer_load_dwordx4 v2, s[36:39], s56 offen offset:0 sc1 lds
    buffer_load_dwordx4 v2, s[36:39], s56 offen offset:1024 sc1 lds
    buffer_load_dwordx4 v2, s[36:39], s56 offen offset:2048 sc1 lds
    buffer_load_dwordx4 v2, s[36:39], s56 offen offset:3072 sc1 lds
    s_add_u32 s56, s56, 262144
    s_add_u32 m0, s60, 131072
    s_nop 0
    buffer_load_dwordx4 v2, s[36:39], s56 offen offset:0 sc1 lds
    buffer_load_dwordx4 v2, s[36:39], s56 offen offset:1024 sc1 lds
    buffer_load_dwordx4 v2, s[36:39], s56 offen offset:2048 sc1 lds
    buffer_load_dwordx4 v2, s[36:39], s56 offen offset:3072 sc1 lds
    s_add_u32 s56, s56, 262144
m_x1123:
    s_lshl_b32 s90, s53, 12
    v_add_u32 v6, s90, v2
    v_lshrrev_b32 v48, 2, v1
    v_lshlrev_b32 v48, 8, v48
    v_and_b32 v49, 3, v1
    v_lshl_add_u32 v48, v49, 3, v48
    v_add_u32 v48, 16384, v48
    v_bfe_u32 v49, v1, 2, 3
    s_lshl_b32 s90, s40, 2
    v_xor_b32 v49, s90, v49
    v_xor_b32 v50, 0, v49
    v_lshl_add_u32 v12, v50, 5, v48
    v_xor_b32 v50, 1, v49
    v_lshl_add_u32 v13, v50, 5, v48
    v_xor_b32 v50, 2, v49
    v_lshl_add_u32 v14, v50, 5, v48
    v_xor_b32 v50, 3, v49
    v_lshl_add_u32 v15, v50, 5, v48
    v_and_b32 v48, 15, v1
    v_lshlrev_b32 v48, 12, v48
    v_lshlrev_b32 v48, s95, v48
    v_bfe_u32 v49, v1, 4, 1
    v_lshl_add_u32 v48, v49, 5, v48
    v_lshrrev_b32 v49, 5, v1
    v_lshl_add_u32 v7, v49, 4, v48
    s_lshl_b32 s90, s96, 3
    s_lshl_b32 s91, s53, 2
    s_add_u32 s90, s90, s91
    s_lshl_b32 s91, s90, 16
    s_add_u32 s91, s91, 2048
    s_and_b32 s92, s90, 63
    s_lshl_b32 s92, s92, 17
    s_lshr_b32 s93, s90, 6
    s_lshl_b32 s93, s93, 12
    s_add_u32 s92, s92, s93
    s_cmp_eq_u32 s95, 1
    s_cselect_b32 s71, s92, s91
    s_lshl_b32 s72, 0x10000, s95
    s_lshl_b32 s92, s97, 8
    s_lshl_b32 s93, s40, 7
    s_add_u32 s71, s71, s92
    s_add_u32 s71, s71, s93
    v_mov_b64 v[64:65], 0
    v_mov_b64 v[66:67], 0
    v_mov_b64 v[68:69], 0
    v_mov_b64 v[70:71], 0
    v_mov_b64 v[72:73], 0
    v_mov_b64 v[74:75], 0
    v_mov_b64 v[76:77], 0
    v_mov_b64 v[78:79], 0
    v_mov_b64 v[80:81], 0
    v_mov_b64 v[82:83], 0
    v_mov_b64 v[84:85], 0
    v_mov_b64 v[86:87], 0
    v_mov_b64 v[88:89], 0
    v_mov_b64 v[90:91], 0
    v_mov_b64 v[92:93], 0
    v_mov_b64 v[94:95], 0
    v_mov_b64 v[96:97], 0
    v_mov_b64 v[98:99], 0
    v_mov_b64 v[100:101], 0
    v_mov_b64 v[102:103], 0
    v_mov_b64 v[104:105], 0
    v_mov_b64 v[106:107], 0
    v_mov_b64 v[108:109], 0
    v_mov_b64 v[110:111], 0
    v_mov_b64 v[112:113], 0
    v_mov_b64 v[114:115], 0
    v_mov_b64 v[116:117], 0
    v_mov_b64 v[118:119], 0
    v_mov_b64 v[120:121], 0
    v_mov_b64 v[122:123], 0
    v_mov_b64 v[124:125], 0
    v_mov_b64 v[126:127], 0
    v_and_b32 v48, 15, v1
    v_lshrrev_b32 v49, 4, v1
    v_lshlrev_b32 v49, 2, v49
    v_sub_u32 v48, v48, v49
    v_cmp_ge_i32 vcc, -9, v48
    v_subrev_u32 v50, 0, v48
    v_cmp_ge_u32 s[76:77], 7, v50
    s_nop 0
    v_cndmask_b32 v128, v9, 0, vcc
    v_cndmask_b32 v132, v9, 0, s[76:77]
    v_cmp_ge_i32 vcc, -8, v48
    v_subrev_u32 v50, 1, v48
    v_cmp_ge_u32 s[76:77], 7, v50
    s_nop 0
    v_cndmask_b32 v129, v9, 0, vcc
    v_cndmask_b32 v133, v9, 0, s[76:77]
    v_cmp_ge_i32 vcc, -7, v48
    v_subrev_u32 v50, 2, v48
    v_cmp_ge_u32 s[76:77], 7, v50
    s_nop 0
    v_cndmask_b32 v130, v9, 0, vcc
    v_cndmask_b32 v134, v9, 0, s[76:77]
    v_cmp_ge_i32 vcc, -6, v48
    v_subrev_u32 v50, 3, v48
    v_cmp_ge_u32 s[76:77], 7, v50
    s_nop 0
    v_cndmask_b32 v131, v9, 0, vcc
    v_cndmask_b32 v135, v9, 0, s[76:77]
    s_cmp_eq_u32 s81, 0
    s_cselect_b64 vcc, -1, 0
    s_nop 0
    v_cndmask_b32 v136, v128, v9, vcc
    v_cndmask_b32 v137, v129, v9, vcc
    v_cndmask_b32 v138, v130, v9, vcc
    v_cndmask_b32 v139, v131, v9, vcc
    s_lshl_b32 s90, s80, 10
    s_lshr_b32 s91, s2, 3
    s_lshl_b32 s91, s91, 17
    s_add_u32 s90, s90, s91
    s_add_u32 s80, s90, 83886080
    s_add_u32 s59, s60, 131072
    s_mov_b32 s58, 0
    s_mov_b32 s100, 32768
    s_mov_b32 s64, 0
    s_mov_b32 s67, 0
    s_waitcnt vmcnt(36)
    s_cmp_eq_u32 s99, 1
    s_cbranch_scc1 m_x2124
    s_waitcnt vmcnt(16)
m_x2124:
    s_barrier
    s_lshl_b32 s91, s33, 5
    s_add_u32 s91, s91, s32
    s_lshl_b32 s91, s91, 3
    s_add_u32 s91, s91, 7936
    s_cmp_lg_u32 s16, 0
    s_cbranch_scc1 m_np126
    v_mov_b32 v60, s4
    v_mov_b32 v61, s5
    s_add_u32 s90, s91, 117440512
    s_mov_b64 exec, 1
    buffer_store_dwordx2 v[60:61], off, s[8:11], s90 sc1
    s_mov_b64 exec, -1
m_np126:
    s_cmp_eq_u32 s101, -1
    s_cbranch_scc1 m_pb127
    s_cmp_lg_u32 s16, 0
    s_cbranch_scc1 m_np128
    v_mov_b32 v60, s4
    v_mov_b32 v61, s5
    s_add_u32 s90, s101, 117440512
    s_mov_b64 exec, 1
    buffer_store_dwordx2 v[60:61], off, s[8:11], s90 sc1
    s_mov_b64 exec, -1
m_np128:
m_pb127:
    s_cmp_eq_u32 s99, 1
    s_cbranch_scc1 m_x3125
    s_mov_b32 s3, 1048576
m_spin130:
    buffer_load_dwordx2 v[4:5], v10, s[8:11], s52 offen sc1
    s_waitcnt vmcnt(0)
    v_cmp_ne_u64 s[76:77], s[4:5], v[4:5]
    s_mul_i32 s91, s95, 20
    s_nop 2
    s_lshr_b32 s90, s76, s91
    s_ff1_i32_b32 s90, s90
    s_lshl_b32 s68, s90, 1
    s_mul_i32 s91, s95, 0
    s_sub_i32 s68, s68, s91
    s_cmp_lt_i32 s90, 0
    s_cselect_b32 s68, 1000, s68
    s_cmp_gt_i32 s68, 4
    s_cbranch_scc1 m_ok131
    s_sub_u32 s3, s3, 1
    s_cbranch_scc1 m_ok131
    s_sleep 4
    s_branch m_spin130
m_ok131:
    s_add_u32 m0, s60, 0
    s_nop 0
    buffer_load_dwordx4 v2, s[36:39], s56 offen offset:0 sc1 lds
    buffer_load_dwordx4 v2, s[36:39], s56 offen offset:1024 sc1 lds
    buffer_load_dwordx4 v2, s[36:39], s56 offen offset:2048 sc1 lds
    buffer_load_dwordx4 v2, s[36:39], s56 offen offset:3072 sc1 lds
    s_add_u32 s56, s56, 262144
    s_add_u32 m0, s60, 32768
    s_nop 0
    buffer_load_dwordx4 v2, s[36:39], s56 offen offset:0 sc1 lds
    buffer_load_dwordx4 v2, s[36:39], s56 offen offset:1024 sc1 lds
    buffer_load_dwordx4 v2, s[36:39], s56 offen offset:2048 sc1 lds
    buffer_load_dwordx4 v2, s[36:39], s56 offen offset:3072 sc1 lds
    s_add_u32 s56, s56, 262144
    s_add_u32 m0, s60, 65536
    s_nop 0
    buffer_load_dwordx4 v2, s[36:39], s56 offen offset:0 sc1 lds
    buffer_load_dwordx4 v2, s[36:39], s56 offen offset:1024 sc1 lds
    buffer_load_dwordx4 v2, s[36:39], s56 offen offset:2048 sc1 lds
    buffer_load_dwordx4 v2, s[36:39], s56 offen offset:3072 sc1 lds
    s_add_u32 s56, s56, 262144
    s_add_u32 m0, s60, 98304
    s_nop 0
    buffer_load_dwordx4 v2, s[36:39], s56 offen offset:0 sc1 lds
    buffer_load_dwordx4 v2, s[36:39], s56 offen offset:1024 sc1 lds
    buffer_load_dwordx4 v2, s[36:39], s56 offen offset:2048 sc1 lds
    buffer_load_dwordx4 v2, s[36:39], s56 offen offset:3072 sc1 lds
    s_add_u32 s56, s56, 262144
    s_add_u32 m0, s60, 131072
    s_nop 0
    buffer_load_dwordx4 v2, s[36:39], s56 offen offset:0 sc1 lds
    buffer_load_dwordx4 v2, s[36:39], s56 offen offset:1024 sc1 lds
    buffer_load_dwordx4 v2, s[36:39], s56 offen offset:2048 sc1 lds
    buffer_load_dwordx4 v2, s[36:39], s56 offen offset:3072 sc1 lds
    s_add_u32 s56, s56, 262144
    s_waitcnt vmcnt(4)
    s_branch m_x4129
m_x3125:
    s_waitcnt vmcnt(4)
m_x4129:
    s_barrier
    ds_read_b128 a[0:3], v6 offset:0
    ds_read_b64_tr_b16 a[16:17], v12 offset:0
    ds_read_b64_tr_b16 a[18:19], v12 offset:4096
    ds_read_b128 a[4:7], v6 offset:1024
    ds_read_b128 a[8:11], v6 offset:2048
    ds_read_b128 a[12:15], v6 offset:3072
    ds_read_b64_tr_b16 a[20:21], v13 offset:0
    ds_read_b64_tr_b16 a[22:23], v13 offset:4096
    ds_read_b64_tr_b16 a[24:25], v14 offset:0
    ds_read_b64_tr_b16 a[26:27], v14 offset:4096
    ds_read_b64_tr_b16 a[28:29], v15 offset:0
    ds_read_b64_tr_b16 a[30:31], v15 offset:4096
    s_cmp_gt_i32 s68, 5
    s_cbranch_scc0 m_lp137
m_lr138:
    s_waitcnt lgkmcnt(9)
    v_mfma_f32_16x16x32_bf16 v[64:67], a[16:19], a[0:3], v[64:67]
    s_add_u32 m0, s59, 16384
    ds_read_b128 a[32:35], v6 offset:8192
    v_mfma_f32_16x16x32_bf16 v[148:151], v[208:211], v[192:195], v[136:139]
    v_mfma_f32_16x16x32_bf16 v[152:155], v[212:215], v[192:195], v[132:135]
    s_waitcnt lgkmcnt(9)
    v_mfma_f32_16x16x32_bf16 v[72:75], a[16:19], a[4:7], v[72:75]
    ds_read_b64_tr_b16 a[48:49], v12 offset:8192
    buffer_load_dwordx4 v16, s[24:27], s57 offen offset:0 sc1 lds
    v_mfma_f32_16x16x32_bf16 v[156:159], v[212:215], v[196:199], v[128:131]
    s_waitcnt lgkmcnt(9)
    v_mfma_f32_16x16x32_bf16 v[80:83], a[16:19], a[8:11], v[80:83]
    s_add_u32 s59, s58, s60
    ds_read_b64_tr_b16 a[50:51], v12 offset:12288
    v_mfma_f32_16x16x32_bf16 v[160:163], v[216:219], v[196:199], v[132:135]
    v_mfma_f32_16x16x32_bf16 v[164:167], v[216:219], v[200:203], v[128:131]
    s_waitcnt lgkmcnt(9)
    v_mfma_f32_16x16x32_bf16 v[88:91], a[16:19], a[12:15], v[88:91]
    s_add_u32 s58, s58, 32768
    ds_read_b128 a[36:39], v6 offset:9216
    v_mfma_f32_16x16x32_bf16 v[168:171], v[220:223], v[200:203], v[132:135]
    v_mfma_f32_16x16x32_bf16 v[172:175], v[220:223], v[204:207], v[128:131]
    s_waitcnt lgkmcnt(8)
    v_mfma_f32_16x16x32_bf16 v[68:71], a[20:23], a[0:3], v[68:71]
    s_cmp_ge_u32 s58, 163840
    ds_read_b128 a[40:43], v6 offset:10240
    v_mfma_f32_16x16x32_bf16 v[176:179], v[224:227], v[204:207], v[132:135]
    s_nop 1
    v_mfma_f32_16x16x32_bf16 v[76:79], a[20:23], a[4:7], v[76:79]
    ds_read_b128 a[44:47], v6 offset:11264
    buffer_load_dwordx4 v17, s[24:27], s57 offen offset:1024 sc1 lds
    s_nop 1
    v_mfma_f32_16x16x32_bf16 v[84:87], a[20:23], a[8:11], v[84:87]
    s_cselect_b32 s66, 4294836224, s100
    ds_read_b64_tr_b16 a[52:53], v13 offset:8192
    s_nop 1
    s_nop 1
    v_mfma_f32_16x16x32_bf16 v[92:95], a[20:23], a[12:15], v[92:95]
    s_cselect_b32 s58, 0, s58
    ds_read_b64_tr_b16 a[54:55], v13 offset:12288
    v_max3_f32 v140, v148, v149, v150
    v_max3_f32 v141, v156, v157, v158
    s_waitcnt lgkmcnt(10)
    v_mfma_f32_16x16x32_bf16 v[96:99], a[24:27], a[0:3], v[96:99]
    ds_read_b64_tr_b16 a[56:57], v14 offset:8192
    v_max3_f32 v142, v164, v165, v166
    v_max3_f32 v143, v172, v173, v174
    v_mfma_f32_16x16x32_bf16 v[104:107], a[24:27], a[4:7], v[104:107]
    ds_read_b64_tr_b16 a[58:59], v14 offset:12288
    buffer_load_dwordx4 v18, s[24:27], s57 offen offset:2048 sc1 lds
    v_max3_f32 v140, v140, v151, v152
    v_mfma_f32_16x16x32_bf16 v[112:115], a[24:27], a[8:11], v[112:115]
    ds_read_b64_tr_b16 a[60:61], v15 offset:8192
    v_max3_f32 v141, v141, v159, v160
    v_max3_f32 v142, v142, v167, v168
    v_mfma_f32_16x16x32_bf16 v[120:123], a[24:27], a[12:15], v[120:123]
    ds_read_b64_tr_b16 a[62:63], v15 offset:12288
    v_max3_f32 v143, v143, v175, v176
    v_max3_f32 v140, v140, v153, v154
    s_waitcnt lgkmcnt(12)
    v_mfma_f32_16x16x32_bf16 v[100:103], a[28:31], a[0:3], v[100:103]
    v_add_u32 v6, s66, v6
    v_add_u32 v12, s66, v12
    v_max3_f32 v141, v141, v161, v162
    v_mfma_f32_16x16x32_bf16 v[108:111], a[28:31], a[4:7], v[108:111]
    buffer_load_dwordx4 v19, s[24:27], s57 offen offset:3072 sc1 lds
    v_max3_f32 v142, v142, v169, v170
    v_mfma_f32_16x16x32_bf16 v[116:119], a[28:31], a[8:11], v[116:119]
    s_add_u32 s57, s57, 131072
    v_add_u32 v13, s66, v13
    v_add_u32 v14, s66, v14
    v_max3_f32 v143, v143, v177, v178
    v_mfma_f32_16x16x32_bf16 v[124:127], a[28:31], a[12:15], v[124:127]
    s_mov_b32 m0, s59
    v_add_u32 v15, s66, v15
    v_max_f32 v140, v140, v155
    s_waitcnt vmcnt(24) lgkmcnt(0)
    v_mfma_f32_16x16x32_bf16 v[64:67], a[48:51], a[32:35], v[64:67]
    s_barrier
    v_max_f32 v141, v141, v163
    v_max_f32 v142, v142, v171
    v_mfma_f32_16x16x32_bf16 v[72:75], a[48:51], a[36:39], v[72:75]
    ds_read_b128 a[0:3], v6 offset:0
    buffer_load_dwordx4 v2, s[36:39], s56 offen offset:0 sc1 lds
    v_max_f32 v143, v143, v179
    v_mfma_f32_16x16x32_bf16 v[80:83], a[48:51], a[40:43], v[80:83]
    ds_read_b64_tr_b16 a[16:17], v12 offset:0
    v_mov_b32 v144, v140
    v_mov_b32 v145, v141
    v_mfma_f32_16x16x32_bf16 v[88:91], a[48:51], a[44:47], v[88:91]
    ds_read_b64_tr_b16 a[18:19], v12 offset:4096
    v_mov_b32 v146, v142
    v_mov_b32 v147, v143
    v_mfma_f32_16x16x32_bf16 v[68:71], a[52:55], a[32:35], v[68:71]
    ds_read_b128 a[4:7], v6 offset:1024
    s_nop 1
    v_permlane32_swap_b32 v140, v144
    v_mfma_f32_16x16x32_bf16 v[76:79], a[52:55], a[36:39], v[76:79]
    ds_read_b128 a[8:11], v6 offset:2048
    buffer_load_dwordx4 v2, s[36:39], s56 offen offset:1024 sc1 lds
    v_permlane32_swap_b32 v141, v145
    v_mfma_f32_16x16x32_bf16 v[84:87], a[52:55], a[40:43], v[84:87]
    ds_read_b128 a[12:15], v6 offset:3072
    v_permlane32_swap_b32 v142, v146
    v_permlane32_swap_b32 v143, v147
    v_mfma_f32_16x16x32_bf16 v[92:95], a[52:55], a[44:47], v[92:95]
    ds_read_b64_tr_b16 a[20:21], v13 offset:0
    s_nop 1
    v_max_f32 v140, v140, v144
    v_mfma_f32_16x16x32_bf16 v[96:99], a[56:59], a[32:35], v[96:99]
    ds_read_b64_tr_b16 a[22:23], v13 offset:4096
    v_max_f32 v141, v141, v145
    v_max_f32 v142, v142, v146
    v_mfma_f32_16x16x32_bf16 v[104:107], a[56:59], a[36:39], v[104:107]
    ds_read_b64_tr_b16 a[24:25], v14 offset:0
    buffer_load_dwordx4 v2, s[36:39], s56 offen offset:2048 sc1 lds
    v_max_f32 v143, v143, v147
    v_mfma_f32_16x16x32_bf16 v[112:115], a[56:59], a[40:43], v[112:115]
    ds_read_b64_tr_b16 a[26:27], v14 offset:4096
    v_mov_b32 v144, v140
    v_mov_b32 v145, v141
    v_mfma_f32_16x16x32_bf16 v[120:123], a[56:59], a[44:47], v[120:123]
    ds_read_b64_tr_b16 a[28:29], v15 offset:0
    v_mov_b32 v146, v142
    v_mov_b32 v147, v143
    v_mfma_f32_16x16x32_bf16 v[100:103], a[60:63], a[32:35], v[100:103]
    s_add_u32 s64, s64, 1
    ds_read_b64_tr_b16 a[30:31], v15 offset:4096
    s_nop 1
    v_permlane16_swap_b32 v140, v144
    v_mfma_f32_16x16x32_bf16 v[108:111], a[60:63], a[36:39], v[108:111]
    buffer_load_dwordx4 v2, s[36:39], s56 offen offset:3072 sc1 lds
    v_permlane16_swap_b32 v141, v145
    v_mfma_f32_16x16x32_bf16 v[116:119], a[60:63], a[40:43], v[116:119]
    s_add_u32 s56, s56, 262144
    v_permlane16_swap_b32 v142, v146
    v_permlane16_swap_b32 v143, v147
    v_mfma_f32_16x16x32_bf16 v[124:127], a[60:63], a[44:47], v[124:127]
    s_nop 1
    v_max_f32 v140, v140, v144
    s_cmp_gt_i32 s68, 6
    s_cbranch_scc0 m_lp139
m_lr140:
    s_waitcnt lgkmcnt(9)
    v_mfma_f32_16x16x32_bf16 v[64:67], a[16:19], a[0:3], v[64:67]
    s_add_u32 m0, s59, 16384
    ds_read_b128 a[32:35], v6 offset:8192
    v_max_f32 v141, v141, v145
    v_max_f32 v142, v142, v146
    s_waitcnt lgkmcnt(9)
    v_mfma_f32_16x16x32_bf16 v[72:75], a[16:19], a[4:7], v[72:75]
    ds_read_b64_tr_b16 a[48:49], v12 offset:8192
    buffer_load_dwordx4 v16, s[24:27], s57 offen offset:0 sc1 lds
    v_max_f32 v143, v143, v147
    s_waitcnt lgkmcnt(9)
    v_mfma_f32_16x16x32_bf16 v[80:83], a[16:19], a[8:11], v[80:83]
    s_add_u32 s59, s58, s60
    ds_read_b64_tr_b16 a[50:51], v12 offset:12288
    v_sub_f32 v148, v148, v140
    v_sub_f32 v149, v149, v140
    s_waitcnt lgkmcnt(9)
    v_mfma_f32_16x16x32_bf16 v[88:91], a[16:19], a[12:15], v[88:91]
    s_add_u32 s58, s58, 32768
    ds_read_b128 a[36:39], v6 offset:9216
    v_sub_f32 v150, v150, v140
    v_sub_f32 v151, v151, v140
    s_waitcnt lgkmcnt(8)
    v_mfma_f32_16x16x32_bf16 v[68:71], a[20:23], a[0:3], v[68:71]
    s_cmp_ge_u32 s58, 163840
    ds_read_b128 a[40:43], v6 offset:10240
    v_sub_f32 v152, v152, v140
    v_sub_f32 v153, v153, v140
    v_mfma_f32_16x16x32_bf16 v[76:79], a[20:23], a[4:7], v[76:79]
    ds_read_b128 a[44:47], v6 offset:11264
    buffer_load_dwordx4 v17, s[24:27], s57 offen offset:1024 sc1 lds
    v_sub_f32 v154, v154, v140
    v_mfma_f32_16x16x32_bf16 v[84:87], a[20:23], a[8:11], v[84:87]
    s_cselect_b32 s66, 4294836224, s100
    ds_read_b64_tr_b16 a[52:53], v13 offset:8192
    v_sub_f32 v155, v155, v140
    v_sub_f32 v156, v156, v141
    v_mfma_f32_16x16x32_bf16 v[92:95], a[20:23], a[12:15], v[92:95]
    s_cselect_b32 s58, 0, s58
    ds_read_b64_tr_b16 a[54:55], v13 offset:12288
    v_sub_f32 v157, v157, v141
    v_sub_f32 v158, v158, v141
    s_waitcnt lgkmcnt(10)
    v_mfma_f32_16x16x32_bf16 v[96:99], a[24:27], a[0:3], v[96:99]
    ds_read_b64_tr_b16 a[56:57], v14 offset:8192
    v_sub_f32 v159, v159, v141
    v_sub_f32 v160, v160, v141
    v_mfma_f32_16x16x32_bf16 v[104:107], a[24:27], a[4:7], v[104:107]
    ds_read_b64_tr_b16 a[58:59], v14 offset:12288
    buffer_load_dwordx4 v18, s[24:27], s57 offen offset:2048 sc1 lds
    v_sub_f32 v161, v161, v141
    v_mfma_f32_16x16x32_bf16 v[112:115], a[24:27], a[8:11], v[112:115]
    ds_read_b64_tr_b16 a[60:61], v15 offset:8192
    v_sub_f32 v162, v162, v141
    v_sub_f32 v163, v163, v141
    v_mfma_f32_16x16x32_bf16 v[120:123], a[24:27], a[12:15], v[120:123]
    ds_read_b64_tr_b16 a[62:63], v15 offset:12288
    v_sub_f32 v164, v164, v142
    v_sub_f32 v165, v165, v142
    s_waitcnt lgkmcnt(12)
    v_mfma_f32_16x16x32_bf16 v[100:103], a[28:31], a[0:3], v[100:103]
    v_add_u32 v6, s66, v6
    v_add_u32 v12, s66, v12
    v_sub_f32 v166, v166, v142
    v_mfma_f32_16x16x32_bf16 v[108:111], a[28:31], a[4:7], v[108:111]
    buffer_load_dwordx4 v19, s[24:27], s57 offen offset:3072 sc1 lds
    v_sub_f32 v167, v167, v142
    v_mfma_f32_16x16x32_bf16 v[116:119], a[28:31], a[8:11], v[116:119]
    s_add_u32 s57, s57, 131072
    v_add_u32 v13, s66, v13
    v_add_u32 v14, s66, v14
    v_sub_f32 v168, v168, v142
    v_mfma_f32_16x16x32_bf16 v[124:127], a[28:31], a[12:15], v[124:127]
    s_mov_b32 m0, s59
    v_add_u32 v15, s66, v15
    v_sub_f32 v169, v169, v142
    s_waitcnt vmcnt(24) lgkmcnt(0)
    v_mfma_f32_16x16x32_bf16 v[64:67], a[48:51], a[32:35], v[64:67]
    s_barrier
    v_sub_f32 v170, v170, v142
    v_sub_f32 v171, v171, v142
    v_mfma_f32_16x16x32_bf16 v[72:75], a[48:51], a[36:39], v[72:75]
    ds_read_b128 a[0:3], v6 offset:0
    buffer_load_dwordx4 v2, s[36:39], s56 offen offset:0 sc1 lds
    v_sub_f32 v172, v172, v143
    v_mfma_f32_16x16x32_bf16 v[80:83], a[48:51], a[40:43], v[80:83]
    ds_read_b64_tr_b16 a[16:17], v12 offset:0
    v_sub_f32 v173, v173, v143
    v_sub_f32 v174, v174, v143
    v_mfma_f32_16x16x32_bf16 v[88:91], a[48:51], a[44:47], v[88:91]
    ds_read_b64_tr_b16 a[18:19], v12 offset:4096
    v_sub_f32 v175, v175, v143
    v_sub_f32 v176, v176, v143
    v_mfma_f32_16x16x32_bf16 v[68:71], a[52:55], a[32:35], v[68:71]
    ds_read_b128 a[4:7], v6 offset:1024
    v_sub_f32 v177, v177, v143
    v_sub_f32 v178, v178, v143
    v_mfma_f32_16x16x32_bf16 v[76:79], a[52:55], a[36:39], v[76:79]
    ds_read_b128 a[8:11], v6 offset:2048
    buffer_load_dwordx4 v2, s[36:39], s56 offen offset:1024 sc1 lds
    v_sub_f32 v179, v179, v143
    v_mfma_f32_16x16x32_bf16 v[84:87], a[52:55], a[40:43], v[84:87]
    ds_read_b128 a[12:15], v6 offset:3072
    v_exp_f32 v148, v148
    v_exp_f32 v149, v149
    v_mfma_f32_16x16x32_bf16 v[92:95], a[52:55], a[44:47], v[92:95]
    ds_read_b64_tr_b16 a[20:21], v13 offset:0
    v_exp_f32 v150, v150
    v_exp_f32 v151, v151
    v_mfma_f32_16x16x32_bf16 v[96:99], a[56:59], a[32:35], v[96:99]
    ds_read_b64_tr_b16 a[22:23], v13 offset:4096
    v_exp_f32 v152, v152
    v_exp_f32 v153, v153
    v_mfma_f32_16x16x32_bf16 v[104:107], a[56:59], a[36:39], v[104:107]
    ds_read_b64_tr_b16 a[24:25], v14 offset:0
    buffer_load_dwordx4 v2, s[36:39], s56 offen offset:2048 sc1 lds
    v_exp_f32 v154, v154
    v_mfma_f32_16x16x32_bf16 v[112:115], a[56:59], a[40:43], v[112:115]
    ds_read_b64_tr_b16 a[26:27], v14 offset:4096
    v_exp_f32 v155, v155
    v_exp_f32 v156, v156
    v_mfma_f32_16x16x32_bf16 v[120:123], a[56:59], a[44:47], v[120:123]
    ds_read_b64_tr_b16 a[28:29], v15 offset:0
    v_exp_f32 v157, v157
    v_exp_f32 v158, v158
    v_mfma_f32_16x16x32_bf16 v[100:103], a[60:63], a[32:35], v[100:103]
    s_add_u32 s64, s64, 1
    ds_read_b64_tr_b16 a[30:31], v15 offset:4096
    v_exp_f32 v159, v159
    v_exp_f32 v160, v160
    v_mfma_f32_16x16x32_bf16 v[108:111], a[60:63], a[36:39], v[108:111]
    buffer_load_dwordx4 v2, s[36:39], s56 offen offset:3072 sc1 lds
    v_exp_f32 v161, v161
    v_mfma_f32_16x16x32_bf16 v[116:119], a[60:63], a[40:43], v[116:119]
    s_add_u32 s56, s56, 262144
    v_exp_f32 v162, v162
    v_exp_f32 v163, v163
    v_mfma_f32_16x16x32_bf16 v[124:127], a[60:63], a[44:47], v[124:127]
    v_exp_f32 v164, v164
    v_exp_f32 v165, v165
    s_cmp_gt_i32 s68, 7
    s_cbranch_scc0 m_lp141
m_lr142:
    s_waitcnt lgkmcnt(9)
    v_mfma_f32_16x16x32_bf16 v[64:67], a[16:19], a[0:3], v[64:67]
    s_add_u32 m0, s59, 16384
    ds_read_b128 a[32:35], v6 offset:8192
    v_exp_f32 v166, v166
    v_exp_f32 v167, v167
    s_waitcnt lgkmcnt(9)
    v_mfma_f32_16x16x32_bf16 v[72:75], a[16:19], a[4:7], v[72:75]
    ds_read_b64_tr_b16 a[48:49], v12 offset:8192
    buffer_load_dwordx4 v16, s[24:27], s57 offen offset:0 sc1 lds
    v_exp_f32 v168, v168
    s_waitcnt lgkmcnt(9)
    v_mfma_f32_16x16x32_bf16 v[80:83], a[16:19], a[8:11], v[80:83]
    s_add_u32 s59, s58, s60
    ds_read_b64_tr_b16 a[50:51], v12 offset:12288
    v_exp_f32 v169, v169
    v_exp_f32 v170, v170
    s_waitcnt lgkmcnt(9)
    v_mfma_f32_16x16x32_bf16 v[88:91], a[16:19], a[12:15], v[88:91]
    s_add_u32 s58, s58, 32768
    ds_read_b128 a[36:39], v6 offset:9216
    v_exp_f32 v171, v171
    v_exp_f32 v172, v172
    s_waitcnt lgkmcnt(8)
    v_mfma_f32_16x16x32_bf16 v[68:71], a[20:23], a[0:3], v[68:71]
    s_cmp_ge_u32 s58, 163840
    ds_read_b128 a[40:43], v6 offset:10240
    v_exp_f32 v173, v173
    v_exp_f32 v174, v174
    v_mfma_f32_16x16x32_bf16 v[76:79], a[20:23], a[4:7], v[76:79]
    ds_read_b128 a[44:47], v6 offset:11264
    buffer_load_dwordx4 v17, s[24:27], s57 offen offset:1024 sc1 lds
    v_exp_f32 v175, v175
    v_mfma_f32_16x16x32_bf16 v[84:87], a[20:23], a[8:11], v[84:87]
    s_cselect_b32 s66, 4294836224, s100
    ds_read_b64_tr_b16 a[52:53], v13 offset:8192
    v_exp_f32 v176, v176
    v_exp_f32 v177, v177
    v_mfma_f32_16x16x32_bf16 v[92:95], a[20:23], a[12:15], v[92:95]
    s_cselect_b32 s58, 0, s58
    ds_read_b64_tr_b16 a[54:55], v13 offset:12288
    v_exp_f32 v178, v178
    v_exp_f32 v179, v179
    s_waitcnt lgkmcnt(10)
    v_mfma_f32_16x16x32_bf16 v[96:99], a[24:27], a[0:3], v[96:99]
    ds_read_b64_tr_b16 a[56:57], v14 offset:8192
    v_cvt_pk_bf16_f32 v192, v148, v149
    v_cvt_pk_bf16_f32 v193, v150, v151
    v_mfma_f32_16x16x32_bf16 v[104:107], a[24:27], a[4:7], v[104:107]
    ds_read_b64_tr_b16 a[58:59], v14 offset:12288
    buffer_load_dwordx4 v18, s[24:27], s57 offen offset:2048 sc1 lds
    v_cvt_pk_bf16_f32 v194, v152, v153
    v_mfma_f32_16x16x32_bf16 v[112:115], a[24:27], a[8:11], v[112:115]
    ds_read_b64_tr_b16 a[60:61], v15 offset:8192
    v_cvt_pk_bf16_f32 v195, v154, v155
    v_cvt_pk_bf16_f32 v196, v156, v157
    v_mfma_f32_16x16x32_bf16 v[120:123], a[24:27], a[12:15], v[120:123]
    ds_read_b64_tr_b16 a[62:63], v15 offset:12288
    v_cvt_pk_bf16_f32 v197, v158, v159
    v_cvt_pk_bf16_f32 v198, v160, v161
    s_waitcnt lgkmcnt(12)
    v_mfma_f32_16x16x32_bf16 v[100:103], a[28:31], a[0:3], v[100:103]
    v_add_u32 v6, s66, v6
    v_add_u32 v12, s66, v12
    v_cvt_pk_bf16_f32 v199, v162, v163
    v_mfma_f32_16x16x32_bf16 v[108:111], a[28:31], a[4:7], v[108:111]
    buffer_load_dwordx4 v19, s[24:27], s57 offen offset:3072 sc1 lds
    v_cvt_pk_bf16_f32 v200, v164, v165
    v_mfma_f32_16x16x32_bf16 v[116:119], a[28:31], a[8:11], v[116:119]
    s_add_u32 s57, s57, 131072
    v_add_u32 v13, s66, v13
    v_add_u32 v14, s66, v14
    v_cvt_pk_bf16_f32 v201, v166, v167
    v_mfma_f32_16x16x32_bf16 v[124:127], a[28:31], a[12:15], v[124:127]
    s_mov_b32 m0, s59
    v_add_u32 v15, s66, v15
    v_cvt_pk_bf16_f32 v202, v168, v169
    s_waitcnt vmcnt(24) lgkmcnt(0)
    v_mfma_f32_16x16x32_bf16 v[64:67], a[48:51], a[32:35], v[64:67]
    s_barrier
    v_cvt_pk_bf16_f32 v203, v170, v171
    v_cvt_pk_bf16_f32 v204, v172, v173
    v_mfma_f32_16x16x32_bf16 v[72:75], a[48:51], a[36:39], v[72:75]
    ds_read_b128 a[0:3], v6 offset:0
    buffer_load_dwordx4 v2, s[36:39], s56 offen offset:0 sc1 lds
    v_cvt_pk_bf16_f32 v205, v174, v175
    v_mfma_f32_16x16x32_bf16 v[80:83], a[48:51], a[40:43], v[80:83]
    ds_read_b64_tr_b16 a[16:17], v12 offset:0
    v_cvt_pk_bf16_f32 v206, v176, v177
    v_cvt_pk_bf16_f32 v207, v178, v179
    v_mfma_f32_16x16x32_bf16 v[88:91], a[48:51], a[44:47], v[88:91]
    ds_read_b64_tr_b16 a[18:19], v12 offset:4096
    s_nop 1
    v_mfma_f32_16x16x32_bf16 v[20:23], v[44:47], v[192:195], 0
    v_mfma_f32_16x16x32_bf16 v[68:71], a[52:55], a[32:35], v[68:71]
    ds_read_b128 a[4:7], v6 offset:1024
    v_mfma_f32_16x16x32_bf16 v[24:27], v[44:47], v[196:199], 0
    v_mfma_f32_16x16x32_bf16 v[28:31], v[44:47], v[200:203], 0
    v_mfma_f32_16x16x32_bf16 v[76:79], a[52:55], a[36:39], v[76:79]
    ds_read_b128 a[8:11], v6 offset:2048
    buffer_load_dwordx4 v2, s[36:39], s56 offen offset:1024 sc1 lds
    v_mfma_f32_16x16x32_bf16 v[32:35], v[44:47], v[204:207], 0
    v_mfma_f32_16x16x32_bf16 v[84:87], a[52:55], a[40:43], v[84:87]
    ds_read_b128 a[12:15], v6 offset:3072
    v_mfma_f32_16x16x32_bf16 v[148:151], v[230:233], v[192:195], 0
    v_mfma_f32_16x16x32_bf16 v[152:155], v[242:245], v[192:195], 0
    v_mfma_f32_16x16x32_bf16 v[92:95], a[52:55], a[44:47], v[92:95]
    ds_read_b64_tr_b16 a[20:21], v13 offset:0
    v_mfma_f32_16x16x32_bf16 v[156:159], v[232:235], v[196:199], 0
    v_mfma_f32_16x16x32_bf16 v[160:163], v[244:247], v[196:199], 0
    v_mfma_f32_16x16x32_bf16 v[96:99], a[56:59], a[32:35], v[96:99]
    ds_read_b64_tr_b16 a[22:23], v13 offset:4096
    v_mfma_f32_16x16x32_bf16 v[164:167], v[234:237], v[200:203], 0
    v_mfma_f32_16x16x32_bf16 v[168:171], v[246:249], v[200:203], 0
    v_mfma_f32_16x16x32_bf16 v[104:107], a[56:59], a[36:39], v[104:107]
    ds_read_b64_tr_b16 a[24:25], v14 offset:0
    buffer_load_dwordx4 v2, s[36:39], s56 offen offset:2048 sc1 lds
    v_mfma_f32_16x16x32_bf16 v[172:175], v[236:239], v[204:207], 0
    v_mfma_f32_16x16x32_bf16 v[112:115], a[56:59], a[40:43], v[112:115]
    ds_read_b64_tr_b16 a[26:27], v14 offset:4096
    v_mfma_f32_16x16x32_bf16 v[176:179], v[248:251], v[204:207], 0
    v_rcp_f32 v140, v20
    v_mfma_f32_16x16x32_bf16 v[120:123], a[56:59], a[44:47], v[120:123]
    ds_read_b64_tr_b16 a[28:29], v15 offset:0
    v_rcp_f32 v141, v24
    v_rcp_f32 v142, v28
    v_mfma_f32_16x16x32_bf16 v[100:103], a[60:63], a[32:35], v[100:103]
    s_add_u32 s64, s64, 1
    ds_read_b64_tr_b16 a[30:31], v15 offset:4096
    v_rcp_f32 v143, v32
    s_nop 1
    v_mfma_f32_16x16x32_bf16 v[108:111], a[60:63], a[36:39], v[108:111]
    buffer_load_dwordx4 v2, s[36:39], s56 offen offset:3072 sc1 lds
    s_nop 1
    v_mfma_f32_16x16x32_bf16 v[116:119], a[60:63], a[40:43], v[116:119]
    s_add_u32 s56, s56, 262144
    v_mul_f32 v148, v148, v140
    v_mul_f32 v149, v149, v140
    v_mfma_f32_16x16x32_bf16 v[124:127], a[60:63], a[44:47], v[124:127]
    v_mul_f32 v150, v150, v140
    v_mul_f32 v151, v151, v140
    s_cmp_gt_i32 s68, 8
    s_cbranch_scc0 m_lp143
m_lr144:
    s_waitcnt lgkmcnt(9)
    v_mfma_f32_16x16x32_bf16 v[64:67], a[16:19], a[0:3], v[64:67]
    s_add_u32 m0, s59, 16384
    ds_read_b128 a[32:35], v6 offset:8192
    v_mul_f32 v152, v152, v140
    v_mul_f32 v153, v153, v140
    s_waitcnt lgkmcnt(9)
    v_mfma_f32_16x16x32_bf16 v[72:75], a[16:19], a[4:7], v[72:75]
    ds_read_b64_tr_b16 a[48:49], v12 offset:8192
    buffer_load_dwordx4 v16, s[24:27], s57 offen offset:0 sc1 lds
    v_mul_f32 v154, v154, v140
    s_waitcnt lgkmcnt(9)
    v_mfma_f32_16x16x32_bf16 v[80:83], a[16:19], a[8:11], v[80:83]
    s_add_u32 s59, s58, s60
    ds_read_b64_tr_b16 a[50:51], v12 offset:12288
    v_mul_f32 v155, v155, v140
    v_cvt_pk_bf16_f32 v148, v148, v149
    s_waitcnt lgkmcnt(9)
    v_mfma_f32_16x16x32_bf16 v[88:91], a[16:19], a[12:15], v[88:91]
    s_add_u32 s58, s58, 32768
    ds_read_b128 a[36:39], v6 offset:9216
    v_cvt_pk_bf16_f32 v149, v150, v151
    v_cvt_pk_bf16_f32 v150, v152, v153
    s_waitcnt lgkmcnt(8)
    v_mfma_f32_16x16x32_bf16 v[68:71], a[20:23], a[0:3], v[68:71]
    s_cmp_ge_u32 s58, 163840
    ds_read_b128 a[40:43], v6 offset:10240
    v_cvt_pk_bf16_f32 v151, v154, v155
    buffer_store_dwordx4 v[148:151], v2, s[8:11], s80 offen offset:0 sc1
    v_mfma_f32_16x16x32_bf16 v[76:79], a[20:23], a[4:7], v[76:79]
    ds_read_b128 a[44:47], v6 offset:11264
    buffer_load_dwordx4 v17, s[24:27], s57 offen offset:1024 sc1 lds
    v_mul_f32 v156, v156, v141
    v_mfma_f32_16x16x32_bf16 v[84:87], a[20:23], a[8:11], v[84:87]
    s_cselect_b32 s66, 4294836224, s100
    ds_read_b64_tr_b16 a[52:53], v13 offset:8192
    v_mul_f32 v157, v157, v141
    v_mul_f32 v158, v158, v141
    v_mfma_f32_16x16x32_bf16 v[92:95], a[20:23], a[12:15], v[92:95]
    s_cselect_b32 s58, 0, s58
    ds_read_b64_tr_b16 a[54:55], v13 offset:12288
    v_mul_f32 v159, v159, v141
    v_mul_f32 v160, v160, v141
    s_waitcnt lgkmcnt(10)
    v_mfma_f32_16x16x32_bf16 v[96:99], a[24:27], a[0:3], v[96:99]
    ds_read_b64_tr_b16 a[56:57], v14 offset:8192
    v_mul_f32 v161, v161, v141
    v_mul_f32 v162, v162, v141
    v_mfma_f32_16x16x32_bf16 v[104:107], a[24:27], a[4:7], v[104:107]
    ds_read_b64_tr_b16 a[58:59], v14 offset:12288
    buffer_load_dwordx4 v18, s[24:27], s57 offen offset:2048 sc1 lds
    v_mul_f32 v163, v163, v141
    v_mfma_f32_16x16x32_bf16 v[112:115], a[24:27], a[8:11], v[112:115]
    ds_read_b64_tr_b16 a[60:61], v15 offset:8192
    v_cvt_pk_bf16_f32 v156, v156, v157
    v_cvt_pk_bf16_f32 v157, v158, v159
    v_mfma_f32_16x16x32_bf16 v[120:123], a[24:27], a[12:15], v[120:123]
    ds_read_b64_tr_b16 a[62:63], v15 offset:12288
    v_cvt_pk_bf16_f32 v158, v160, v161
    v_cvt_pk_bf16_f32 v159, v162, v163
    s_waitcnt lgkmcnt(12)
    v_mfma_f32_16x16x32_bf16 v[100:103], a[28:31], a[0:3], v[100:103]
    v_add_u32 v6, s66, v6
    v_add_u32 v12, s66, v12
    buffer_store_dwordx4 v[156:159], v2, s[8:11], s80 offen offset:1024 sc1
    v_mfma_f32_16x16x32_bf16 v[108:111], a[28:31], a[4:7], v[108:111]
    buffer_load_dwordx4 v19, s[24:27], s57 offen offset:3072 sc1 lds
    v_mul_f32 v164, v164, v142
    v_mfma_f32_16x16x32_bf16 v[116:119], a[28:31], a[8:11], v[116:119]
    s_add_u32 s57, s57, 131072
    v_add_u32 v13, s66, v13
    v_add_u32 v14, s66, v14
    v_mul_f32 v165, v165, v142
    v_mfma_f32_16x16x32_bf16 v[124:127], a[28:31], a[12:15], v[124:127]
    s_mov_b32 m0, s59
    v_add_u32 v15, s66, v15
    v_mul_f32 v166, v166, v142
    s_waitcnt vmcnt(24) lgkmcnt(0)
    v_mfma_f32_16x16x32_bf16 v[64:67], a[48:51], a[32:35], v[64:67]
    s_barrier
    v_mul_f32 v167, v167, v142
    v_mul_f32 v168, v168, v142
    v_mfma_f32_16x16x32_bf16 v[72:75], a[48:51], a[36:39], v[72:75]
    ds_read_b128 a[0:3], v6 offset:0
    buffer_load_dwordx4 v2, s[36:39], s56 offen offset:0 sc1 lds
    v_mul_f32 v169, v169, v142
    v_mfma_f32_16x16x32_bf16 v[80:83], a[48:51], a[40:43], v[80:83]
    ds_read_b64_tr_b16 a[16:17], v12 offset:0
    v_mul_f32 v170, v170, v142
    v_mul_f32 v171, v171, v142
    v_mfma_f32_16x16x32_bf16 v[88:91], a[48:51], a[44:47], v[88:91]
    ds_read_b64_tr_b16 a[18:19], v12 offset:4096
    v_cvt_pk_bf16_f32 v164, v164, v165
    v_cvt_pk_bf16_f32 v165, v166, v167
    v_mfma_f32_16x16x32_bf16 v[68:71], a[52:55], a[32:35], v[68:71]
    ds_read_b128 a[4:7], v6 offset:1024
    v_cvt_pk_bf16_f32 v166, v168, v169
    v_cvt_pk_bf16_f32 v167, v170, v171
    v_mfma_f32_16x16x32_bf16 v[76:79], a[52:55], a[36:39], v[76:79]
    ds_read_b128 a[8:11], v6 offset:2048
    buffer_load_dwordx4 v2, s[36:39], s56 offen offset:1024 sc1 lds
    buffer_store_dwordx4 v[164:167], v2, s[8:11], s80 offen offset:2048 sc1
    v_mfma_f32_16x16x32_bf16 v[84:87], a[52:55], a[40:43], v[84:87]
    ds_read_b128 a[12:15], v6 offset:3072
    v_mul_f32 v172, v172, v143
    v_mul_f32 v173, v173, v143
    v_mfma_f32_16x16x32_bf16 v[92:95], a[52:55], a[44:47], v[92:95]
    ds_read_b64_tr_b16 a[20:21], v13 offset:0
    v_mul_f32 v174, v174, v143
    v_mul_f32 v175, v175, v143
    v_mfma_f32_16x16x32_bf16 v[96:99], a[56:59], a[32:35], v[96:99]
    ds_read_b64_tr_b16 a[22:23], v13 offset:4096
    v_mul_f32 v176, v176, v143
    v_mul_f32 v177, v177, v143
    v_mfma_f32_16x16x32_bf16 v[104:107], a[56:59], a[36:39], v[104:107]
    ds_read_b64_tr_b16 a[24:25], v14 offset:0
    buffer_load_dwordx4 v2, s[36:39], s56 offen offset:2048 sc1 lds
    v_mul_f32 v178, v178, v143
    v_mfma_f32_16x16x32_bf16 v[112:115], a[56:59], a[40:43], v[112:115]
    ds_read_b64_tr_b16 a[26:27], v14 offset:4096
    v_mul_f32 v179, v179, v143
    v_cvt_pk_bf16_f32 v172, v172, v173
    v_mfma_f32_16x16x32_bf16 v[120:123], a[56:59], a[44:47], v[120:123]
    ds_read_b64_tr_b16 a[28:29], v15 offset:0
    v_cvt_pk_bf16_f32 v173, v174, v175
    v_cvt_pk_bf16_f32 v174, v176, v177
    v_mfma_f32_16x16x32_bf16 v[100:103], a[60:63], a[32:35], v[100:103]
    s_add_u32 s64, s64, 1
    ds_read_b64_tr_b16 a[30:31], v15 offset:4096
    v_cvt_pk_bf16_f32 v175, v178, v179
    buffer_store_dwordx4 v[172:175], v2, s[8:11], s80 offen offset:3072 sc1
    v_mfma_f32_16x16x32_bf16 v[108:111], a[60:63], a[36:39], v[108:111]
    buffer_load_dwordx4 v2, s[36:39], s56 offen offset:3072 sc1 lds
    v_mfma_f32_16x16x32_bf16 v[116:119], a[60:63], a[40:43], v[116:119]
    s_add_u32 s56, s56, 262144
    v_mfma_f32_16x16x32_bf16 v[124:127], a[60:63], a[44:47], v[124:127]
    s_branch m_l3e133
m_lp137:
    s_mov_b32 s3, 1048576
m_spin145:
    buffer_load_dwordx2 v[4:5], v10, s[8:11], s52 offen sc1
    s_waitcnt vmcnt(0)
    v_cmp_ne_u64 s[76:77], s[4:5], v[4:5]
    s_mul_i32 s91, s95, 20
    s_nop 2
    s_lshr_b32 s90, s76, s91
    s_ff1_i32_b32 s90, s90
    s_lshl_b32 s68, s90, 1
    s_mul_i32 s91, s95, 0
    s_sub_i32 s68, s68, s91
    s_cmp_lt_i32 s90, 0
    s_cselect_b32 s68, 1000, s68
    s_cmp_gt_i32 s68, 5
    s_cbranch_scc1 m_ok146
    s_sub_u32 s3, s3, 1
    s_cbranch_scc1 m_ok146
    s_sleep 4
    s_branch m_spin145
m_ok146:
    s_branch m_lr138
m_lp139:
    s_mov_b32 s3, 1048576
m_spin147:
    buffer_load_dwordx2 v[4:5], v10, s[8:11], s52 offen sc1
    s_waitcnt vmcnt(0)
    v_cmp_ne_u64 s[76:77], s[4:5], v[4:5]
    s_mul_i32 s91, s95, 20
    s_nop 2
    s_lshr_b32 s90, s76, s91
    s_ff1_i32_b32 s90, s90
    s_lshl_b32 s68, s90, 1
    s_mul_i32 s91, s95, 0
    s_sub_i32 s68, s68, s91
    s_cmp_lt_i32 s90, 0
    s_cselect_b32 s68, 1000, s68
    s_cmp_gt_i32 s68, 6
    s_cbranch_scc1 m_ok148
    s_sub_u32 s3, s3, 1
    s_cbranch_scc1 m_ok148
    s_sleep 4
    s_branch m_spin147
m_ok148:
    s_branch m_lr140
m_lp141:
    s_mov_b32 s3, 1048576
m_spin149:
    buffer_load_dwordx2 v[4:5], v10, s[8:11], s52 offen sc1
    s_waitcnt vmcnt(0)
    v_cmp_ne_u64 s[76:77], s[4:5], v[4:5]
    s_mul_i32 s91, s95, 20
    s_nop 2
    s_lshr_b32 s90, s76, s91
    s_ff1_i32_b32 s90, s90
    s_lshl_b32 s68, s90, 1
    s_mul_i32 s91, s95, 0
    s_sub_i32 s68, s68, s91
    s_cmp_lt_i32 s90, 0
    s_cselect_b32 s68, 1000, s68
    s_cmp_gt_i32 s68, 7
    s_cbranch_scc1 m_ok150
    s_sub_u32 s3, s3, 1
    s_cbranch_scc1 m_ok150
    s_sleep 4
    s_branch m_spin149
m_ok150:
    s_branch m_lr142
m_lp143:
    s_mov_b32 s3, 1048576
m_spin151:
    buffer_load_dwordx2 v[4:5], v10, s[8:11], s52 offen sc1
    s_waitcnt vmcnt(0)
    v_cmp_ne_u64 s[76:77], s[4:5], v[4:5]
    s_mul_i32 s91, s95, 20
    s_nop 2
    s_lshr_b32 s90, s76, s91
    s_ff1_i32_b32 s90, s90
    s_lshl_b32 s68, s90, 1
    s_mul_i32 s91, s95, 0
    s_sub_i32 s68, s68, s91
    s_cmp_lt_i32 s90, 0
    s_cselect_b32 s68, 1000, s68
    s_cmp_gt_i32 s68, 8
    s_cbranch_scc1 m_ok152
    s_sub_u32 s3, s3, 1
    s_cbranch_scc1 m_ok152
    s_sleep 4
    s_branch m_spin151
m_ok152:
    s_branch m_lr144
.p2align 3
m_l3132:
    s_waitcnt lgkmcnt(9)
    v_mfma_f32_16x16x32_bf16 v[64:67], a[16:19], a[0:3], v[64:67]
    s_add_u32 m0, s59, 16384
    ds_read_b128 a[32:35], v6 offset:8192
    s_waitcnt lgkmcnt(9)
    v_mfma_f32_16x16x32_bf16 v[72:75], a[16:19], a[4:7], v[72:75]
    ds_read_b64_tr_b16 a[48:49], v12 offset:8192
    buffer_load_dwordx4 v16, s[24:27], s57 offen offset:0 sc1 lds
    s_waitcnt lgkmcnt(9)
    v_mfma_f32_16x16x32_bf16 v[80:83], a[16:19], a[8:11], v[80:83]
    s_add_u32 s59, s58, s60
    ds_read_b64_tr_b16 a[50:51], v12 offset:12288
    s_waitcnt lgkmcnt(9)
    v_mfma_f32_16x16x32_bf16 v[88:91], a[16:19], a[12:15], v[88:91]
    s_add_u32 s58, s58, 32768
    ds_read_b128 a[36:39], v6 offset:9216
    s_waitcnt lgkmcnt(8)
    v_mfma_f32_16x16x32_bf16 v[68:71], a[20:23], a[0:3], v[68:71]
    s_cmp_ge_u32 s58, 163840
    ds_read_b128 a[40:43], v6 offset:10240
    v_mfma_f32_16x16x32_bf16 v[76:79], a[20:23], a[4:7], v[76:79]
    ds_read_b128 a[44:47], v6 offset:11264
    buffer_load_dwordx4 v17, s[24:27], s57 offen offset:1024 sc1 lds
    v_mfma_f32_16x16x32_bf16 v[84:87], a[20:23], a[8:11], v[84:87]
    s_cselect_b32 s66, 4294836224, s100
    ds_read_b64_tr_b16 a[52:53], v13 offset:8192
    v_mfma_f32_16x16x32_bf16 v[92:95], a[20:23], a[12:15], v[92:95]
    s_cselect_b32 s58, 0, s58
    ds_read_b64_tr_b16 a[54:55], v13 offset:12288
    s_waitcnt lgkmcnt(10)
    v_mfma_f32_16x16x32_bf16 v[96:99], a[24:27], a[0:3], v[96:99]
    ds_read_b64_tr_b16 a[56:57], v14 offset:8192
    v_mfma_f32_16x16x32_bf16 v[104:107], a[24:27], a[4:7], v[104:107]
    ds_read_b64_tr_b16 a[58:59], v14 offset:12288
    buffer_load_dwordx4 v18, s[24:27], s57 offen offset:2048 sc1 lds
    v_mfma_f32_16x16x32_bf16 v[112:115], a[24:27], a[8:11], v[112:115]
    ds_read_b64_tr_b16 a[60:61], v15 offset:8192
    v_mfma_f32_16x16x32_bf16 v[120:123], a[24:27], a[12:15], v[120:123]
    ds_read_b64_tr_b16 a[62:63], v15 offset:12288
    s_waitcnt lgkmcnt(12)
    v_mfma_f32_16x16x32_bf16 v[100:103], a[28:31], a[0:3], v[100:103]
    v_add_u32 v6, s66, v6
    v_add_u32 v12, s66, v12
    v_mfma_f32_16x16x32_bf16 v[108:111], a[28:31], a[4:7], v[108:111]
    buffer_load_dwordx4 v19, s[24:27], s57 offen offset:3072 sc1 lds
    v_mfma_f32_16x16x32_bf16 v[116:119], a[28:31], a[8:11], v[116:119]
    s_add_u32 s57, s57, 131072
    v_add_u32 v13, s66, v13
    v_add_u32 v14, s66, v14
    v_mfma_f32_16x16x32_bf16 v[124:127], a[28:31], a[12:15], v[124:127]
    s_mov_b32 m0, s59
    v_add_u32 v15, s66, v15
    s_waitcnt vmcnt(24) lgkmcnt(0)
    v_mfma_f32_16x16x32_bf16 v[64:67], a[48:51], a[32:35], v[64:67]
    s_barrier
    v_mfma_f32_16x16x32_bf16 v[72:75], a[48:51], a[36:39], v[72:75]
    ds_read_b128 a[0:3], v6 offset:0
    buffer_load_dwordx4 v2, s[36:39], s56 offen offset:0 sc1 lds
    v_mfma_f32_16x16x32_bf16 v[80:83], a[48:51], a[40:43], v[80:83]
    ds_read_b64_tr_b16 a[16:17], v12 offset:0
    v_mfma_f32_16x16x32_bf16 v[88:91], a[48:51], a[44:47], v[88:91]
    ds_read_b64_tr_b16 a[18:19], v12 offset:4096
    v_mfma_f32_16x16x32_bf16 v[68:71], a[52:55], a[32:35], v[68:71]
    ds_read_b128 a[4:7], v6 offset:1024
    v_mfma_f32_16x16x32_bf16 v[76:79], a[52:55], a[36:39], v[76:79]
    ds_read_b128 a[8:11], v6 offset:2048
    buffer_load_dwordx4 v2, s[36:39], s56 offen offset:1024 sc1 lds
    v_mfma_f32_16x16x32_bf16 v[84:87], a[52:55], a[40:43], v[84:87]
    ds_read_b128 a[12:15], v6 offset:3072
    v_mfma_f32_16x16x32_bf16 v[92:95], a[52:55], a[44:47], v[92:95]
    ds_read_b64_tr_b16 a[20:21], v13 offset:0
    v_mfma_f32_16x16x32_bf16 v[96:99], a[56:59], a[32:35], v[96:99]
    ds_read_b64_tr_b16 a[22:23], v13 offset:4096
    v_mfma_f32_16x16x32_bf16 v[104:107], a[56:59], a[36:39], v[104:107]
    ds_read_b64_tr_b16 a[24:25], v14 offset:0
    buffer_load_dwordx4 v2, s[36:39], s56 offen offset:2048 sc1 lds
    v_mfma_f32_16x16x32_bf16 v[112:115], a[56:59], a[40:43], v[112:115]
    ds_read_b64_tr_b16 a[26:27], v14 offset:4096
    v_mfma_f32_16x16x32_bf16 v[120:123], a[56:59], a[44:47], v[120:123]
    ds_read_b64_tr_b16 a[28:29], v15 offset:0
    v_mfma_f32_16x16x32_bf16 v[100:103], a[60:63], a[32:35], v[100:103]
    s_add_u32 s64, s64, 1
    ds_read_b64_tr_b16 a[30:31], v15 offset:4096
    v_mfma_f32_16x16x32_bf16 v[108:111], a[60:63], a[36:39], v[108:111]
    buffer_load_dwordx4 v2, s[36:39], s56 offen offset:3072 sc1 lds
    v_mfma_f32_16x16x32_bf16 v[116:119], a[60:63], a[40:43], v[116:119]
    s_add_u32 s56, s56, 262144
    s_cmp_lt_u32 s64, s67
    v_mfma_f32_16x16x32_bf16 v[124:127], a[60:63], a[44:47], v[124:127]
    s_cbranch_scc1 m_l3132
m_l3e133:
    s_add_u32 s92, s64, 5
    s_cmp_gt_i32 s68, s92
    s_cbranch_scc1 m_rdy153
    s_mov_b32 s3, 1048576
m_spin154:
    buffer_load_dwordx2 v[4:5], v10, s[8:11], s52 offen sc1
    s_waitcnt vmcnt(0)
    v_cmp_ne_u64 s[76:77], s[4:5], v[4:5]
    s_mul_i32 s91, s95, 20
    s_nop 2
    s_lshr_b32 s90, s76, s91
    s_ff1_i32_b32 s90, s90
    s_lshl_b32 s68, s90, 1
    s_mul_i32 s91, s95, 0
    s_sub_i32 s68, s68, s91
    s_cmp_lt_i32 s90, 0
    s_cselect_b32 s68, 1000, s68
    s_cmp_gt_i32 s68, s92
    s_cbranch_scc1 m_ok155
    s_sub_u32 s3, s3, 1
    s_cbranch_scc1 m_ok155
    s_sleep 4
    s_branch m_spin154
m_ok155:
m_rdy153:
    s_mov_b32 s67, 8
    s_cmp_lt_u32 s64, 8
    s_cbranch_scc1 m_l3n136
    s_cmp_eq_u32 s64, 8
    s_cbranch_scc1 m_o1156
m_o2157:
    s_cmp_eq_u32 s95, 0
    s_cbranch_scc1 m_l3c135
    s_mov_b32 s67, 18
    s_cmp_lt_u32 s64, 18
    s_cbranch_scc1 m_l3n136
    s_cmp_lg_u32 s64, 18
    s_cbranch_scc1 m_n158
    s_mov_b32 s68, 1000
    s_lshr_b32 s90, s96, 1
    s_lshl_b32 s90, s90, 8
    s_add_u32 s90, s90, 117452800
    buffer_load_dwordx2 v[4:5], v10, s[8:11], s90 offen sc1
    s_mov_b32 s67, 19
    s_branch m_l3132
m_n158:
    s_cmp_lg_u32 s64, 19
    s_cbranch_scc1 m_n159
    s_waitcnt vmcnt(8)
    s_waitcnt vmcnt(16)
    s_mov_b32 s3, 1048576
m_spin160:
    v_cmp_ne_u64 s[76:77], s[4:5], v[4:5]
    s_nop 3
    s_cmp_eq_u64 s[76:77], 0
    s_cbranch_scc1 m_ok161
    s_sub_u32 s3, s3, 1
    s_cbranch_scc1 m_ok161
    s_sleep 8
    s_lshr_b32 s90, s96, 1
    s_lshl_b32 s90, s90, 8
    s_add_u32 s90, s90, 117452800
    buffer_load_dwordx2 v[4:5], v10, s[8:11], s90 offen sc1
    s_waitcnt vmcnt(0)
    s_branch m_spin160
m_ok161:
    s_mov_b32 s56, s69
    s_mov_b32 s67, 20
    s_branch m_l3132
m_n159:
    s_cmp_lg_u32 s64, 20
    s_cbranch_scc1 m_n162
    s_mov_b32 s24, s50
    s_mov_b32 s25, s51
    s_mov_b32 s26, 2097152
    s_lshl_b32 s57, s97, 8
    s_mov_b32 s67, 24
    s_branch m_l3132
m_n162:
    s_cmp_lg_u32 s64, 24
    s_cbranch_scc1 m_n163
    s_lshl_b32 s90, s96, 3
    s_add_u32 s90, s90, s97
    s_lshl_b32 s90, s90, 15
    s_lshl_b32 s91, s16, 13
    s_add_u32 s90, s90, s91
    s_add_u32 s70, s90, 100663296
    s_nop 3
    v_cvt_pk_bf16_f32 v128, v64, v65
    v_cvt_pk_bf16_f32 v129, v66, v67
    v_cvt_pk_bf16_f32 v130, v68, v69
    v_cvt_pk_bf16_f32 v131, v70, v71
    v_cvt_pk_bf16_f32 v132, v72, v73
    v_cvt_pk_bf16_f32 v133, v74, v75
    v_cvt_pk_bf16_f32 v134, v76, v77
    v_cvt_pk_bf16_f32 v135, v78, v79
    v_cvt_pk_bf16_f32 v136, v80, v81
    v_cvt_pk_bf16_f32 v137, v82, v83
    v_cvt_pk_bf16_f32 v138, v84, v85
    v_cvt_pk_bf16_f32 v139, v86, v87
    v_cvt_pk_bf16_f32 v140, v88, v89
    v_cvt_pk_bf16_f32 v141, v90, v91
    v_cvt_pk_bf16_f32 v142, v92, v93
    v_cvt_pk_bf16_f32 v143, v94, v95
    v_cvt_pk_bf16_f32 v144, v96, v97
    v_cvt_pk_bf16_f32 v145, v98, v99
    v_cvt_pk_bf16_f32 v146, v100, v101
    v_cvt_pk_bf16_f32 v147, v102, v103
    v_cvt_pk_bf16_f32 v148, v104, v105
    v_cvt_pk_bf16_f32 v149, v106, v107
    v_cvt_pk_bf16_f32 v150, v108, v109
    v_cvt_pk_bf16_f32 v151, v110, v111
    v_cvt_pk_bf16_f32 v152, v112, v113
    v_cvt_pk_bf16_f32 v153, v114, v115
    v_cvt_pk_bf16_f32 v154, v116, v117
    v_cvt_pk_bf16_f32 v155, v118, v119
    v_cvt_pk_bf16_f32 v156, v120, v121
    v_cvt_pk_bf16_f32 v157, v122, v123
    v_cvt_pk_bf16_f32 v158, v124, v125
    v_cvt_pk_bf16_f32 v159, v126, v127
    v_mov_b64 v[64:65], 0
    v_mov_b64 v[66:67], 0
    v_mov_b64 v[68:69], 0
    v_mov_b64 v[70:71], 0
    v_mov_b64 v[72:73], 0
    v_mov_b64 v[74:75], 0
    v_mov_b64 v[76:77], 0
    v_mov_b64 v[78:79], 0
    v_mov_b64 v[80:81], 0
    v_mov_b64 v[82:83], 0
    v_mov_b64 v[84:85], 0
    v_mov_b64 v[86:87], 0
    v_mov_b64 v[88:89], 0
    v_mov_b64 v[90:91], 0
    v_mov_b64 v[92:93], 0
    v_mov_b64 v[94:95], 0
    v_mov_b64 v[96:97], 0
    v_mov_b64 v[98:99], 0
    v_mov_b64 v[100:101], 0
    v_mov_b64 v[102:103], 0
    v_mov_b64 v[104:105], 0
    v_mov_b64 v[106:107], 0
    v_mov_b64 v[108:109], 0
    v_mov_b64 v[110:111], 0
    v_mov_b64 v[112:113], 0
    v_mov_b64 v[114:115], 0
    v_mov_b64 v[116:117], 0
    v_mov_b64 v[118:119], 0
    v_mov_b64 v[120:121], 0
    v_mov_b64 v[122:123], 0
    v_mov_b64 v[124:125], 0
    v_mov_b64 v[126:127], 0
    s_nop 1
    s_waitcnt lgkmcnt(9)
    v_mfma_f32_16x16x32_bf16 v[64:67], a[16:19], a[0:3], v[64:67]
    s_add_u32 m0, s59, 16384
    ds_read_b128 a[32:35], v6 offset:8192
    s_waitcnt lgkmcnt(9)
    v_mfma_f32_16x16x32_bf16 v[72:75], a[16:19], a[4:7], v[72:75]
    ds_read_b64_tr_b16 a[48:49], v12 offset:8192
    buffer_load_dwordx4 v16, s[24:27], s57 offen offset:0 sc1 lds
    s_waitcnt lgkmcnt(9)
    v_mfma_f32_16x16x32_bf16 v[80:83], a[16:19], a[8:11], v[80:83]
    s_add_u32 s59, s58, s60
    ds_read_b64_tr_b16 a[50:51], v12 offset:12288
    s_waitcnt lgkmcnt(9)
    v_mfma_f32_16x16x32_bf16 v[88:91], a[16:19], a[12:15], v[88:91]
    s_add_u32 s58, s58, 32768
    ds_read_b128 a[36:39], v6 offset:9216
    s_waitcnt lgkmcnt(8)
    v_mfma_f32_16x16x32_bf16 v[68:71], a[20:23], a[0:3], v[68:71]
    s_cmp_ge_u32 s58, 163840
    ds_read_b128 a[40:43], v6 offset:10240
    v_mfma_f32_16x16x32_bf16 v[76:79], a[20:23], a[4:7], v[76:79]
    ds_read_b128 a[44:47], v6 offset:11264
    buffer_load_dwordx4 v17, s[24:27], s57 offen offset:1024 sc1 lds
    v_mfma_f32_16x16x32_bf16 v[84:87], a[20:23], a[8:11], v[84:87]
    s_cselect_b32 s66, 4294836224, s100
    ds_read_b64_tr_b16 a[52:53], v13 offset:8192
    v_mfma_f32_16x16x32_bf16 v[92:95], a[20:23], a[12:15], v[92:95]
    s_cselect_b32 s58, 0, s58
    ds_read_b64_tr_b16 a[54:55], v13 offset:12288
    s_waitcnt lgkmcnt(10)
    v_mfma_f32_16x16x32_bf16 v[96:99], a[24:27], a[0:3], v[96:99]
    ds_read_b64_tr_b16 a[56:57], v14 offset:8192
    v_mfma_f32_16x16x32_bf16 v[104:107], a[24:27], a[4:7], v[104:107]
    ds_read_b64_tr_b16 a[58:59], v14 offset:12288
    buffer_load_dwordx4 v18, s[24:27], s57 offen offset:2048 sc1 lds
    v_mfma_f32_16x16x32_bf16 v[112:115], a[24:27], a[8:11], v[112:115]
    ds_read_b64_tr_b16 a[60:61], v15 offset:8192
    v_mfma_f32_16x16x32_bf16 v[120:123], a[24:27], a[12:15], v[120:123]
    ds_read_b64_tr_b16 a[62:63], v15 offset:12288
    buffer_store_dwordx4 v[128:131], v2, s[8:11], s70 offen offset:0 sc1
    s_waitcnt lgkmcnt(12)
    v_mfma_f32_16x16x32_bf16 v[100:103], a[28:31], a[0:3], v[100:103]
    v_add_u32 v6, s66, v6
    v_add_u32 v12, s66, v12
    v_mfma_f32_16x16x32_bf16 v[108:111], a[28:31], a[4:7], v[108:111]
    buffer_load_dwordx4 v19, s[24:27], s57 offen offset:3072 sc1 lds
    v_mfma_f32_16x16x32_bf16 v[116:119], a[28:31], a[8:11], v[116:119]
    s_add_u32 s57, s57, 131072
    v_add_u32 v13, s66, v13
    v_add_u32 v14, s66, v14
    v_mfma_f32_16x16x32_bf16 v[124:127], a[28:31], a[12:15], v[124:127]
    s_mov_b32 m0, s59
    v_add_u32 v15, s66, v15
    s_waitcnt vmcnt(24) lgkmcnt(0)
    v_mfma_f32_16x16x32_bf16 v[64:67], a[48:51], a[32:35], v[64:67]
    s_barrier
    v_mfma_f32_16x16x32_bf16 v[72:75], a[48:51], a[36:39], v[72:75]
    ds_read_b128 a[0:3], v6 offset:0
    buffer_load_dwordx4 v2, s[36:39], s56 offen offset:0 sc1 lds
    v_mfma_f32_16x16x32_bf16 v[80:83], a[48:51], a[40:43], v[80:83]
    ds_read_b64_tr_b16 a[16:17], v12 offset:0
    v_mfma_f32_16x16x32_bf16 v[88:91], a[48:51], a[44:47], v[88:91]
    ds_read_b64_tr_b16 a[18:19], v12 offset:4096
    v_mfma_f32_16x16x32_bf16 v[68:71], a[52:55], a[32:35], v[68:71]
    ds_read_b128 a[4:7], v6 offset:1024
    v_mfma_f32_16x16x32_bf16 v[76:79], a[52:55], a[36:39], v[76:79]
    ds_read_b128 a[8:11], v6 offset:2048
    buffer_load_dwordx4 v2, s[36:39], s56 offen offset:1024 sc1 lds
    v_mfma_f32_16x16x32_bf16 v[84:87], a[52:55], a[40:43], v[84:87]
    ds_read_b128 a[12:15], v6 offset:3072
    v_mfma_f32_16x16x32_bf16 v[92:95], a[52:55], a[44:47], v[92:95]
    ds_read_b64_tr_b16 a[20:21], v13 offset:0
    v_mfma_f32_16x16x32_bf16 v[96:99], a[56:59], a[32:35], v[96:99]
    ds_read_b64_tr_b16 a[22:23], v13 offset:4096
    v_mfma_f32_16x16x32_bf16 v[104:107], a[56:59], a[36:39], v[104:107]
    ds_read_b64_tr_b16 a[24:25], v14 offset:0
    buffer_load_dwordx4 v2, s[36:39], s56 offen offset:2048 sc1 lds
    v_mfma_f32_16x16x32_bf16 v[112:115], a[56:59], a[40:43], v[112:115]
    ds_read_b64_tr_b16 a[26:27], v14 offset:4096
    v_mfma_f32_16x16x32_bf16 v[120:123], a[56:59], a[44:47], v[120:123]
    ds_read_b64_tr_b16 a[28:29], v15 offset:0
    buffer_store_dwordx4 v[132:135], v2, s[8:11], s70 offen offset:1024 sc1
    v_mfma_f32_16x16x32_bf16 v[100:103], a[60:63], a[32:35], v[100:103]
    s_add_u32 s64, s64, 1
    ds_read_b64_tr_b16 a[30:31], v15 offset:4096
    v_mfma_f32_16x16x32_bf16 v[108:111], a[60:63], a[36:39], v[108:111]
    buffer_load_dwordx4 v2, s[36:39], s56 offen offset:3072 sc1 lds
    v_mfma_f32_16x16x32_bf16 v[116:119], a[60:63], a[40:43], v[116:119]
    s_add_u32 s56, s56, 262144
    v_mfma_f32_16x16x32_bf16 v[124:127], a[60:63], a[44:47], v[124:127]
    s_waitcnt lgkmcnt(9)
    v_mfma_f32_16x16x32_bf16 v[64:67], a[16:19], a[0:3], v[64:67]
    s_add_u32 m0, s59, 16384
    ds_read_b128 a[32:35], v6 offset:8192
    s_waitcnt lgkmcnt(9)
    v_mfma_f32_16x16x32_bf16 v[72:75], a[16:19], a[4:7], v[72:75]
    ds_read_b64_tr_b16 a[48:49], v12 offset:8192
    buffer_load_dwordx4 v16, s[24:27], s57 offen offset:0 sc1 lds
    s_waitcnt lgkmcnt(9)
    v_mfma_f32_16x16x32_bf16 v[80:83], a[16:19], a[8:11], v[80:83]
    s_add_u32 s59, s58, s60
    ds_read_b64_tr_b16 a[50:51], v12 offset:12288
    s_waitcnt lgkmcnt(9)
    v_mfma_f32_16x16x32_bf16 v[88:91], a[16:19], a[12:15], v[88:91]
    s_add_u32 s58, s58, 32768
    ds_read_b128 a[36:39], v6 offset:9216
    s_waitcnt lgkmcnt(8)
    v_mfma_f32_16x16x32_bf16 v[68:71], a[20:23], a[0:3], v[68:71]
    s_cmp_ge_u32 s58, 163840
    ds_read_b128 a[40:43], v6 offset:10240
    v_mfma_f32_16x16x32_bf16 v[76:79], a[20:23], a[4:7], v[76:79]
    ds_read_b128 a[44:47], v6 offset:11264
    buffer_load_dwordx4 v17, s[24:27], s57 offen offset:1024 sc1 lds
    v_mfma_f32_16x16x32_bf16 v[84:87], a[20:23], a[8:11], v[84:87]
    s_cselect_b32 s66, 4294836224, s100
    ds_read_b64_tr_b16 a[52:53], v13 offset:8192
    v_mfma_f32_16x16x32_bf16 v[92:95], a[20:23], a[12:15], v[92:95]
    s_cselect_b32 s58, 0, s58
    ds_read_b64_tr_b16 a[54:55], v13 offset:12288
    s_waitcnt lgkmcnt(10)
    v_mfma_f32_16x16x32_bf16 v[96:99], a[24:27], a[0:3], v[96:99]
    ds_read_b64_tr_b16 a[56:57], v14 offset:8192
    v_mfma_f32_16x16x32_bf16 v[104:107], a[24:27], a[4:7], v[104:107]
    ds_read_b64_tr_b16 a[58:59], v14 offset:12288
    buffer_load_dwordx4 v18, s[24:27], s57 offen offset:2048 sc1 lds
    v_mfma_f32_16x16x32_bf16 v[112:115], a[24:27], a[8:11], v[112:115]
    ds_read_b64_tr_b16 a[60:61], v15 offset:8192
    v_mfma_f32_16x16x32_bf16 v[120:123], a[24:27], a[12:15], v[120:123]
    ds_read_b64_tr_b16 a[62:63], v15 offset:12288
    buffer_store_dwordx4 v[136:139], v2, s[8:11], s70 offen offset:2048 sc1
    s_waitcnt lgkmcnt(12)
    v_mfma_f32_16x16x32_bf16 v[100:103], a[28:31], a[0:3], v[100:103]
    v_add_u32 v6, s66, v6
    v_add_u32 v12, s66, v12
    v_mfma_f32_16x16x32_bf16 v[108:111], a[28:31], a[4:7], v[108:111]
    buffer_load_dwordx4 v19, s[24:27], s57 offen offset:3072 sc1 lds
    v_mfma_f32_16x16x32_bf16 v[116:119], a[28:31], a[8:11], v[116:119]
    s_add_u32 s57, s57, 131072
    v_add_u32 v13, s66, v13
    v_add_u32 v14, s66, v14
    v_mfma_f32_16x16x32_bf16 v[124:127], a[28:31], a[12:15], v[124:127]
    s_mov_b32 m0, s59
    v_add_u32 v15, s66, v15
    s_waitcnt vmcnt(24) lgkmcnt(0)
    v_mfma_f32_16x16x32_bf16 v[64:67], a[48:51], a[32:35], v[64:67]
    s_barrier
    v_mfma_f32_16x16x32_bf16 v[72:75], a[48:51], a[36:39], v[72:75]
    ds_read_b128 a[0:3], v6 offset:0
    buffer_load_dwordx4 v2, s[36:39], s56 offen offset:0 sc1 lds
    v_mfma_f32_16x16x32_bf16 v[80:83], a[48:51], a[40:43], v[80:83]
    ds_read_b64_tr_b16 a[16:17], v12 offset:0
    v_mfma_f32_16x16x32_bf16 v[88:91], a[48:51], a[44:47], v[88:91]
    ds_read_b64_tr_b16 a[18:19], v12 offset:4096
    v_mfma_f32_16x16x32_bf16 v[68:71], a[52:55], a[32:35], v[68:71]
    ds_read_b128 a[4:7], v6 offset:1024
    v_mfma_f32_16x16x32_bf16 v[76:79], a[52:55], a[36:39], v[76:79]
    ds_read_b128 a[8:11], v6 offset:2048
    buffer_load_dwordx4 v2, s[36:39], s56 offen offset:1024 sc1 lds
    v_mfma_f32_16x16x32_bf16 v[84:87], a[52:55], a[40:43], v[84:87]
    ds_read_b128 a[12:15], v6 offset:3072
    v_mfma_f32_16x16x32_bf16 v[92:95], a[52:55], a[44:47], v[92:95]
    ds_read_b64_tr_b16 a[20:21], v13 offset:0
    v_mfma_f32_16x16x32_bf16 v[96:99], a[56:59], a[32:35], v[96:99]
    ds_read_b64_tr_b16 a[22:23], v13 offset:4096
    v_mfma_f32_16x16x32_bf16 v[104:107], a[56:59], a[36:39], v[104:107]
    ds_read_b64_tr_b16 a[24:25], v14 offset:0
    buffer_load_dwordx4 v2, s[36:39], s56 offen offset:2048 sc1 lds
    v_mfma_f32_16x16x32_bf16 v[112:115], a[56:59], a[40:43], v[112:115]
    ds_read_b64_tr_b16 a[26:27], v14 offset:4096
    v_mfma_f32_16x16x32_bf16 v[120:123], a[56:59], a[44:47], v[120:123]
    ds_read_b64_tr_b16 a[28:29], v15 offset:0
    buffer_store_dwordx4 v[140:143], v2, s[8:11], s70 offen offset:3072 sc1
    s_add_u32 s70, s70, 4096
    v_mfma_f32_16x16x32_bf16 v[100:103], a[60:63], a[32:35], v[100:103]
    s_add_u32 s64, s64, 1
    ds_read_b64_tr_b16 a[30:31], v15 offset:4096
    v_mfma_f32_16x16x32_bf16 v[108:111], a[60:63], a[36:39], v[108:111]
    buffer_load_dwordx4 v2, s[36:39], s56 offen offset:3072 sc1 lds
    v_mfma_f32_16x16x32_bf16 v[116:119], a[60:63], a[40:43], v[116:119]
    s_add_u32 s56, s56, 262144
    v_mfma_f32_16x16x32_bf16 v[124:127], a[60:63], a[44:47], v[124:127]
    s_waitcnt lgkmcnt(9)
    v_mfma_f32_16x16x32_bf16 v[64:67], a[16:19], a[0:3], v[64:67]
    s_add_u32 m0, s59, 16384
    ds_read_b128 a[32:35], v6 offset:8192
    s_waitcnt lgkmcnt(9)
    v_mfma_f32_16x16x32_bf16 v[72:75], a[16:19], a[4:7], v[72:75]
    ds_read_b64_tr_b16 a[48:49], v12 offset:8192
    buffer_load_dwordx4 v16, s[24:27], s57 offen offset:0 sc1 lds
    s_waitcnt lgkmcnt(9)
    v_mfma_f32_16x16x32_bf16 v[80:83], a[16:19], a[8:11], v[80:83]
    s_add_u32 s59, s58, s60
    ds_read_b64_tr_b16 a[50:51], v12 offset:12288
    s_waitcnt lgkmcnt(9)
    v_mfma_f32_16x16x32_bf16 v[88:91], a[16:19], a[12:15], v[88:91]
    s_add_u32 s58, s58, 32768
    ds_read_b128 a[36:39], v6 offset:9216
    s_waitcnt lgkmcnt(8)
    v_mfma_f32_16x16x32_bf16 v[68:71], a[20:23], a[0:3], v[68:71]
    s_cmp_ge_u32 s58, 163840
    ds_read_b128 a[40:43], v6 offset:10240
    v_mfma_f32_16x16x32_bf16 v[76:79], a[20:23], a[4:7], v[76:79]
    ds_read_b128 a[44:47], v6 offset:11264
    buffer_load_dwordx4 v17, s[24:27], s57 offen offset:1024 sc1 lds
    v_mfma_f32_16x16x32_bf16 v[84:87], a[20:23], a[8:11], v[84:87]
    s_cselect_b32 s66, 4294836224, s100
    ds_read_b64_tr_b16 a[52:53], v13 offset:8192
    v_mfma_f32_16x16x32_bf16 v[92:95], a[20:23], a[12:15], v[92:95]
    s_cselect_b32 s58, 0, s58
    ds_read_b64_tr_b16 a[54:55], v13 offset:12288
    s_waitcnt lgkmcnt(10)
    v_mfma_f32_16x16x32_bf16 v[96:99], a[24:27], a[0:3], v[96:99]
    ds_read_b64_tr_b16 a[56:57], v14 offset:8192
    v_mfma_f32_16x16x32_bf16 v[104:107], a[24:27], a[4:7], v[104:107]
    ds_read_b64_tr_b16 a[58:59], v14 offset:12288
    buffer_load_dwordx4 v18, s[24:27], s57 offen offset:2048 sc1 lds
    v_mfma_f32_16x16x32_bf16 v[112:115], a[24:27], a[8:11], v[112:115]
    ds_read_b64_tr_b16 a[60:61], v15 offset:8192
    v_mfma_f32_16x16x32_bf16 v[120:123], a[24:27], a[12:15], v[120:123]
    ds_read_b64_tr_b16 a[62:63], v15 offset:12288
    buffer_store_dwordx4 v[144:147], v2, s[8:11], s70 offen offset:0 sc1
    s_waitcnt lgkmcnt(12)
    v_mfma_f32_16x16x32_bf16 v[100:103], a[28:31], a[0:3], v[100:103]
    v_add_u32 v6, s66, v6
    v_add_u32 v12, s66, v12
    v_mfma_f32_16x16x32_bf16 v[108:111], a[28:31], a[4:7], v[108:111]
    buffer_load_dwordx4 v19, s[24:27], s57 offen offset:3072 sc1 lds
    v_mfma_f32_16x16x32_bf16 v[116:119], a[28:31], a[8:11], v[116:119]
    s_add_u32 s57, s57, 131072
    v_add_u32 v13, s66, v13
    v_add_u32 v14, s66, v14
    v_mfma_f32_16x16x32_bf16 v[124:127], a[28:31], a[12:15], v[124:127]
    s_mov_b32 m0, s59
    v_add_u32 v15, s66, v15
    s_waitcnt vmcnt(24) lgkmcnt(0)
    v_mfma_f32_16x16x32_bf16 v[64:67], a[48:51], a[32:35], v[64:67]
    s_barrier
    v_mfma_f32_16x16x32_bf16 v[72:75], a[48:51], a[36:39], v[72:75]
    ds_read_b128 a[0:3], v6 offset:0
    buffer_load_dwordx4 v2, s[36:39], s56 offen offset:0 sc1 lds
    v_mfma_f32_16x16x32_bf16 v[80:83], a[48:51], a[40:43], v[80:83]
    ds_read_b64_tr_b16 a[16:17], v12 offset:0
    v_mfma_f32_16x16x32_bf16 v[88:91], a[48:51], a[44:47], v[88:91]
    ds_read_b64_tr_b16 a[18:19], v12 offset:4096
    v_mfma_f32_16x16x32_bf16 v[68:71], a[52:55], a[32:35], v[68:71]
    ds_read_b128 a[4:7], v6 offset:1024
    v_mfma_f32_16x16x32_bf16 v[76:79], a[52:55], a[36:39], v[76:79]
    ds_read_b128 a[8:11], v6 offset:2048
    buffer_load_dwordx4 v2, s[36:39], s56 offen offset:1024 sc1 lds
    v_mfma_f32_16x16x32_bf16 v[84:87], a[52:55], a[40:43], v[84:87]
    ds_read_b128 a[12:15], v6 offset:3072
    v_mfma_f32_16x16x32_bf16 v[92:95], a[52:55], a[44:47], v[92:95]
    ds_read_b64_tr_b16 a[20:21], v13 offset:0
    v_mfma_f32_16x16x32_bf16 v[96:99], a[56:59], a[32:35], v[96:99]
    ds_read_b64_tr_b16 a[22:23], v13 offset:4096
    v_mfma_f32_16x16x32_bf16 v[104:107], a[56:59], a[36:39], v[104:107]
    ds_read_b64_tr_b16 a[24:25], v14 offset:0
    buffer_load_dwordx4 v2, s[36:39], s56 offen offset:2048 sc1 lds
    v_mfma_f32_16x16x32_bf16 v[112:115], a[56:59], a[40:43], v[112:115]
    ds_read_b64_tr_b16 a[26:27], v14 offset:4096
    v_mfma_f32_16x16x32_bf16 v[120:123], a[56:59], a[44:47], v[120:123]
    ds_read_b64_tr_b16 a[28:29], v15 offset:0
    buffer_store_dwordx4 v[148:151], v2, s[8:11], s70 offen offset:1024 sc1
    v_mfma_f32_16x16x32_bf16 v[100:103], a[60:63], a[32:35], v[100:103]
    s_add_u32 s64, s64, 1
    ds_read_b64_tr_b16 a[30:31], v15 offset:4096
    v_mfma_f32_16x16x32_bf16 v[108:111], a[60:63], a[36:39], v[108:111]
    buffer_load_dwordx4 v2, s[36:39], s56 offen offset:3072 sc1 lds
    v_mfma_f32_16x16x32_bf16 v[116:119], a[60:63], a[40:43], v[116:119]
    s_add_u32 s56, s56, 262144
    v_mfma_f32_16x16x32_bf16 v[124:127], a[60:63], a[44:47], v[124:127]
    s_waitcnt lgkmcnt(9)
    v_mfma_f32_16x16x32_bf16 v[64:67], a[16:19], a[0:3], v[64:67]
    s_add_u32 m0, s59, 16384
    ds_read_b128 a[32:35], v6 offset:8192
    s_waitcnt lgkmcnt(9)
    v_mfma_f32_16x16x32_bf16 v[72:75], a[16:19], a[4:7], v[72:75]
    ds_read_b64_tr_b16 a[48:49], v12 offset:8192
    buffer_load_dwordx4 v16, s[24:27], s57 offen offset:0 sc1 lds
    s_waitcnt lgkmcnt(9)
    v_mfma_f32_16x16x32_bf16 v[80:83], a[16:19], a[8:11], v[80:83]
    s_add_u32 s59, s58, s60
    ds_read_b64_tr_b16 a[50:51], v12 offset:12288
    s_waitcnt lgkmcnt(9)
    v_mfma_f32_16x16x32_bf16 v[88:91], a[16:19], a[12:15], v[88:91]
    s_add_u32 s58, s58, 32768
    ds_read_b128 a[36:39], v6 offset:9216
    s_waitcnt lgkmcnt(8)
    v_mfma_f32_16x16x32_bf16 v[68:71], a[20:23], a[0:3], v[68:71]
    s_cmp_ge_u32 s58, 163840
    ds_read_b128 a[40:43], v6 offset:10240
    v_mfma_f32_16x16x32_bf16 v[76:79], a[20:23], a[4:7], v[76:79]
    ds_read_b128 a[44:47], v6 offset:11264
    buffer_load_dwordx4 v17, s[24:27], s57 offen offset:1024 sc1 lds
    v_mfma_f32_16x16x32_bf16 v[84:87], a[20:23], a[8:11], v[84:87]
    s_cselect_b32 s66, 4294836224, s100
    ds_read_b64_tr_b16 a[52:53], v13 offset:8192
    v_mfma_f32_16x16x32_bf16 v[92:95], a[20:23], a[12:15], v[92:95]
    s_cselect_b32 s58, 0, s58
    ds_read_b64_tr_b16 a[54:55], v13 offset:12288
    s_waitcnt lgkmcnt(10)
    v_mfma_f32_16x16x32_bf16 v[96:99], a[24:27], a[0:3], v[96:99]
    ds_read_b64_tr_b16 a[56:57], v14 offset:8192
    v_mfma_f32_16x16x32_bf16 v[104:107], a[24:27], a[4:7], v[104:107]
    ds_read_b64_tr_b16 a[58:59], v14 offset:12288
    buffer_load_dwordx4 v18, s[24:27], s57 offen offset:2048 sc1 lds
    v_mfma_f32_16x16x32_bf16 v[112:115], a[24:27], a[8:11], v[112:115]
    ds_read_b64_tr_b16 a[60:61], v15 offset:8192
    v_mfma_f32_16x16x32_bf16 v[120:123], a[24:27], a[12:15], v[120:123]
    ds_read_b64_tr_b16 a[62:63], v15 offset:12288
    buffer_store_dwordx4 v[152:155], v2, s[8:11], s70 offen offset:2048 sc1
    s_waitcnt lgkmcnt(12)
    v_mfma_f32_16x16x32_bf16 v[100:103], a[28:31], a[0:3], v[100:103]
    v_add_u32 v6, s66, v6
    v_add_u32 v12, s66, v12
    v_mfma_f32_16x16x32_bf16 v[108:111], a[28:31], a[4:7], v[108:111]
    buffer_load_dwordx4 v19, s[24:27], s57 offen offset:3072 sc1 lds
    v_mfma_f32_16x16x32_bf16 v[116:119], a[28:31], a[8:11], v[116:119]
    s_add_u32 s57, s57, 131072
    v_add_u32 v13, s66, v13
    v_add_u32 v14, s66, v14
    v_mfma_f32_16x16x32_bf16 v[124:127], a[28:31], a[12:15], v[124:127]
    s_mov_b32 m0, s59
    v_add_u32 v15, s66, v15
    s_waitcnt vmcnt(24) lgkmcnt(0)
    v_mfma_f32_16x16x32_bf16 v[64:67], a[48:51], a[32:35], v[64:67]
    s_barrier
    v_mfma_f32_16x16x32_bf16 v[72:75], a[48:51], a[36:39], v[72:75]
    ds_read_b128 a[0:3], v6 offset:0
    buffer_load_dwordx4 v2, s[36:39], s56 offen offset:0 sc1 lds
    v_mfma_f32_16x16x32_bf16 v[80:83], a[48:51], a[40:43], v[80:83]
    ds_read_b64_tr_b16 a[16:17], v12 offset:0
    v_mfma_f32_16x16x32_bf16 v[88:91], a[48:51], a[44:47], v[88:91]
    ds_read_b64_tr_b16 a[18:19], v12 offset:4096
    v_mfma_f32_16x16x32_bf16 v[68:71], a[52:55], a[32:35], v[68:71]
    ds_read_b128 a[4:7], v6 offset:1024
    v_mfma_f32_16x16x32_bf16 v[76:79], a[52:55], a[36:39], v[76:79]
    ds_read_b128 a[8:11], v6 offset:2048
    buffer_load_dwordx4 v2, s[36:39], s56 offen offset:1024 sc1 lds
    v_mfma_f32_16x16x32_bf16 v[84:87], a[52:55], a[40:43], v[84:87]
    ds_read_b128 a[12:15], v6 offset:3072
    v_mfma_f32_16x16x32_bf16 v[92:95], a[52:55], a[44:47], v[92:95]
    ds_read_b64_tr_b16 a[20:21], v13 offset:0
    v_mfma_f32_16x16x32_bf16 v[96:99], a[56:59], a[32:35], v[96:99]
    ds_read_b64_tr_b16 a[22:23], v13 offset:4096
    v_mfma_f32_16x16x32_bf16 v[104:107], a[56:59], a[36:39], v[104:107]
    ds_read_b64_tr_b16 a[24:25], v14 offset:0
    buffer_load_dwordx4 v2, s[36:39], s56 offen offset:2048 sc1 lds
    v_mfma_f32_16x16x32_bf16 v[112:115], a[56:59], a[40:43], v[112:115]
    ds_read_b64_tr_b16 a[26:27], v14 offset:4096
    v_mfma_f32_16x16x32_bf16 v[120:123], a[56:59], a[44:47], v[120:123]
    ds_read_b64_tr_b16 a[28:29], v15 offset:0
    buffer_store_dwordx4 v[156:159], v2, s[8:11], s70 offen offset:3072 sc1
    s_add_u32 s70, s70, 4096
    v_mfma_f32_16x16x32_bf16 v[100:103], a[60:63], a[32:35], v[100:103]
    s_add_u32 s64, s64, 1
    ds_read_b64_tr_b16 a[30:31], v15 offset:4096
    v_mfma_f32_16x16x32_bf16 v[108:111], a[60:63], a[36:39], v[108:111]
    buffer_load_dwordx4 v2, s[36:39], s56 offen offset:3072 sc1 lds
    v_mfma_f32_16x16x32_bf16 v[116:119], a[60:63], a[40:43], v[116:119]
    s_add_u32 s56, s56, 262144
    v_mfma_f32_16x16x32_bf16 v[124:127], a[60:63], a[44:47], v[124:127]
    s_mov_b32 s67, 32
    s_branch m_l3132
m_n163:
    s_cmp_lg_u32 s64, 32
    s_cbranch_scc1 m_n164
    s_lshl_b32 s91, s96, 3
    s_add_u32 s91, s91, s97
    s_lshl_b32 s91, s91, 7
    s_add_u32 s91, s91, 16384
    s_cmp_lg_u32 s16, 0
    s_cbranch_scc1 m_np165
    v_mov_b32 v60, s4
    v_mov_b32 v61, s5
    s_add_u32 s90, s91, 117440512
    s_mov_b64 exec, 1
    buffer_store_dwordx2 v[60:61], off, s[8:11], s90 sc1
    s_mov_b64 exec, -1
m_np165:
    s_mov_b32 s67, 35
    s_branch m_l3132
m_n164:
    s_cmp_lg_u32 s64, 35
    s_cbranch_scc1 m_n166
    s_mov_b32 s38, 0
    s_mov_b32 s67, 40
    s_branch m_l3132
m_n166:
    s_branch m_l3x134
m_l3c135:
    s_mov_b32 s67, 34
    s_cmp_lt_u32 s64, 34
    s_cbranch_scc1 m_l3n136
    s_cmp_lg_u32 s64, 34
    s_cbranch_scc1 m_n168
    s_mov_b32 s68, 1000
    s_mov_b32 s67, 35
    s_branch m_l3132
m_n168:
    s_cmp_lg_u32 s64, 35
    s_cbranch_scc1 m_n169
    s_mov_b32 s38, 0
    s_lshl_b32 s91, s96, 3
    s_add_u32 s91, s91, s97
    s_lshl_b32 s91, s91, 7
    s_add_u32 s91, s91, 16384
    s_add_u32 s52, s91, 117440512
    buffer_load_dwordx2 v[4:5], off, s[8:11], s52 sc1
    s_mov_b32 s67, 36
    s_branch m_l3132
m_n169:
    s_cmp_lg_u32 s64, 36
    s_cbranch_scc1 m_n170
    s_mov_b32 s26, 0
    s_mov_b32 s67, 37
    s_branch m_l3132
m_n170:
    s_cmp_lg_u32 s64, 37
    s_cbranch_scc1 m_n171
    s_waitcnt vmcnt(16)
    s_mov_b32 s3, 1048576
m_spin172:
    v_cmp_ne_u64 s[76:77], s[4:5], v[4:5]
    s_nop 3
    s_cmp_eq_u64 s[76:77], 0
    s_cbranch_scc1 m_ok173
    s_sub_u32 s3, s3, 1
    s_cbranch_scc1 m_ok173
    s_sleep 8
    buffer_load_dwordx2 v[4:5], off, s[8:11], s52 sc1
    s_waitcnt vmcnt(0)
    s_branch m_spin172
m_ok173:
    s_lshl_b32 s90, s96, 3
    s_add_u32 s90, s90, s97
    s_lshl_b32 s90, s90, 15
    s_lshl_b32 s91, s16, 13
    s_add_u32 s90, s90, s91
    s_add_u32 s70, s90, 100663296
    buffer_load_dwordx4 v[128:131], v2, s[8:11], s70 offen offset:0 sc1
    buffer_load_dwordx4 v[132:135], v2, s[8:11], s70 offen offset:1024 sc1
    buffer_load_dwordx4 v[136:139], v2, s[8:11], s70 offen offset:2048 sc1
    buffer_load_dwordx4 v[140:143], v2, s[8:11], s70 offen offset:3072 sc1
    s_add_u32 s70, s70, 4096
    buffer_load_dwordx4 v[144:147], v2, s[8:11], s70 offen offset:0 sc1
    buffer_load_dwordx4 v[148:151], v2, s[8:11], s70 offen offset:1024 sc1
    buffer_load_dwordx4 v[152:155], v2, s[8:11], s70 offen offset:2048 sc1
    buffer_load_dwordx4 v[156:159], v2, s[8:11], s70 offen offset:3072 sc1
    s_mov_b32 s67, 40
    s_branch m_l3132
m_n171:
    s_branch m_l3x134
m_o1156:
    s_and_b32 s91, s2, 7
    s_lshl_b32 s91, s91, 5
    s_lshr_b32 s92, s2, 3
    s_add_u32 s91, s91, s92
    s_lshl_b32 s91, s91, 3
    s_add_u32 s91, s91, 12288
    s_cmp_lg_u32 s16, 0
    s_cbranch_scc1 m_np175
    v_mov_b32 v60, s4
    v_mov_b32 v61, s5
    s_add_u32 s90, s91, 117440512
    s_mov_b64 exec, 1
    buffer_store_dwordx2 v[60:61], off, s[8:11], s90 sc1
    s_mov_b64 exec, -1
m_np175:
    s_branch m_o2157
m_l3n136:
    s_sub_u32 s90, s68, 5
    s_min_u32 s67, s67, s90
    s_branch m_l3132
m_l3x134:
    s_cmp_eq_u32 s95, 1
    s_cbranch_scc1 m_noadd176
    s_waitcnt vmcnt(0)
    v_lshlrev_b32 v160, 16, v128
    v_and_b32 v161, 0xffff0000, v128
    v_lshlrev_b32 v162, 16, v129
    v_and_b32 v163, 0xffff0000, v129
    v_lshlrev_b32 v164, 16, v130
    v_and_b32 v165, 0xffff0000, v130
    v_lshlrev_b32 v166, 16, v131
    v_and_b32 v167, 0xffff0000, v131
    v_lshlrev_b32 v168, 16, v132
    v_and_b32 v169, 0xffff0000, v132
    v_lshlrev_b32 v170, 16, v133
    v_and_b32 v171, 0xffff0000, v133
    v_lshlrev_b32 v172, 16, v134
    v_and_b32 v173, 0xffff0000, v134
    v_lshlrev_b32 v174, 16, v135
    v_and_b32 v175, 0xffff0000, v135
    v_lshlrev_b32 v176, 16, v136
    v_and_b32 v177, 0xffff0000, v136
    v_lshlrev_b32 v178, 16, v137
    v_and_b32 v179, 0xffff0000, v137
    v_lshlrev_b32 v180, 16, v138
    v_and_b32 v181, 0xffff0000, v138
    v_lshlrev_b32 v182, 16, v139
    v_and_b32 v183, 0xffff0000, v139
    v_lshlrev_b32 v184, 16, v140
    v_and_b32 v185, 0xffff0000, v140
    v_lshlrev_b32 v186, 16, v141
    v_and_b32 v187, 0xffff0000, v141
    v_lshlrev_b32 v188, 16, v142
    v_and_b32 v189, 0xffff0000, v142
    v_lshlrev_b32 v190, 16, v143
    v_and_b32 v191, 0xffff0000, v143
    v_lshlrev_b32 v192, 16, v144
    v_and_b32 v193, 0xffff0000, v144
    v_lshlrev_b32 v194, 16, v145
    v_and_b32 v195, 0xffff0000, v145
    v_lshlrev_b32 v196, 16, v146
    v_and_b32 v197, 0xffff0000, v146
    v_lshlrev_b32 v198, 16, v147
    v_and_b32 v199, 0xffff0000, v147
    v_lshlrev_b32 v200, 16, v148
    v_and_b32 v201, 0xffff0000, v148
    v_lshlrev_b32 v202, 16, v149
    v_and_b32 v203, 0xffff0000, v149
    v_lshlrev_b32 v204, 16, v150
    v_and_b32 v205, 0xffff0000, v150
    v_lshlrev_b32 v206, 16, v151
    v_and_b32 v207, 0xffff0000, v151
    v_lshlrev_b32 v208, 16, v152
    v_and_b32 v209, 0xffff0000, v152
    v_lshlrev_b32 v210, 16, v153
    v_and_b32 v211, 0xffff0000, v153
    v_lshlrev_b32 v212, 16, v154
    v_and_b32 v213, 0xffff0000, v154
    v_lshlrev_b32 v214, 16, v155
    v_and_b32 v215, 0xffff0000, v155
    v_lshlrev_b32 v216, 16, v156
    v_and_b32 v217, 0xffff0000, v156
    v_lshlrev_b32 v218, 16, v157
    v_and_b32 v219, 0xffff0000, v157
    v_lshlrev_b32 v220, 16, v158
    v_and_b32 v221, 0xffff0000, v158
    v_lshlrev_b32 v222, 16, v159
    v_and_b32 v223, 0xffff0000, v159
    v_pk_add_f32 v[64:65], v[64:65], v[160:161]
    v_pk_add_f32 v[66:67], v[66:67], v[162:163]
    v_pk_add_f32 v[68:69], v[68:69], v[164:165]
    v_pk_add_f32 v[70:71], v[70:71], v[166:167]
    v_pk_add_f32 v[72:73], v[72:73], v[168:169]
    v_pk_add_f32 v[74:75], v[74:75], v[170:171]
    v_pk_add_f32 v[76:77], v[76:77], v[172:173]
    v_pk_add_f32 v[78:79], v[78:79], v[174:175]
    v_pk_add_f32 v[80:81], v[80:81], v[176:177]
    v_pk_add_f32 v[82:83], v[82:83], v[178:179]
    v_pk_add_f32 v[84:85], v[84:85], v[180:181]
    v_pk_add_f32 v[86:87], v[86:87], v[182:183]
    v_pk_add_f32 v[88:89], v[88:89], v[184:185]
    v_pk_add_f32 v[90:91], v[90:91], v[186:187]
    v_pk_add_f32 v[92:93], v[92:93], v[188:189]
    v_pk_add_f32 v[94:95], v[94:95], v[190:191]
    v_pk_add_f32 v[96:97], v[96:97], v[192:193]
    v_pk_add_f32 v[98:99], v[98:99], v[194:195]
    v_pk_add_f32 v[100:101], v[100:101], v[196:197]
    v_pk_add_f32 v[102:103], v[102:103], v[198:199]
    v_pk_add_f32 v[104:105], v[104:105], v[200:201]
    v_pk_add_f32 v[106:107], v[106:107], v[202:203]
    v_pk_add_f32 v[108:109], v[108:109], v[204:205]
    v_pk_add_f32 v[110:111], v[110:111], v[206:207]
    v_pk_add_f32 v[112:113], v[112:113], v[208:209]
    v_pk_add_f32 v[114:115], v[114:115], v[210:211]
    v_pk_add_f32 v[116:117], v[116:117], v[212:213]
    v_pk_add_f32 v[118:119], v[118:119], v[214:215]
    v_pk_add_f32 v[120:121], v[120:121], v[216:217]
    v_pk_add_f32 v[122:123], v[122:123], v[218:219]
    v_pk_add_f32 v[124:125], v[124:125], v[220:221]
    v_pk_add_f32 v[126:127], v[126:127], v[222:223]
m_noadd176:
    v_cvt_pk_bf16_f32 v64, v64, v65
    v_cvt_pk_bf16_f32 v65, v66, v67
    v_cvt_pk_bf16_f32 v66, v68, v69
    v_cvt_pk_bf16_f32 v67, v70, v71
    v_cvt_pk_bf16_f32 v96, v96, v97
    v_cvt_pk_bf16_f32 v97, v98, v99
    v_cvt_pk_bf16_f32 v98, v100, v101
    v_cvt_pk_bf16_f32 v99, v102, v103
    s_nop 1
    v_permlane16_swap_b32 v64, v66
    v_permlane16_swap_b32 v65, v67
    v_permlane16_swap_b32 v96, v98
    v_permlane16_swap_b32 v97, v99
    buffer_store_dwordx4 v[64:67], v7, s[28:31], s71 offen offset:0 sc1
    buffer_store_dwordx4 v[96:99], v7, s[28:31], s71 offen offset:64 sc1
    s_add_u32 s71, s71, s72
    v_cvt_pk_bf16_f32 v72, v72, v73
    v_cvt_pk_bf16_f32 v73, v74, v75
    v_cvt_pk_bf16_f32 v74, v76, v77
    v_cvt_pk_bf16_f32 v75, v78, v79
    v_cvt_pk_bf16_f32 v104, v104, v105
    v_cvt_pk_bf16_f32 v105, v106, v107
    v_cvt_pk_bf16_f32 v106, v108, v109
    v_cvt_pk_bf16_f32 v107, v110, v111
    s_nop 1
    v_permlane16_swap_b32 v72, v74
    v_permlane16_swap_b32 v73, v75
    v_permlane16_swap_b32 v104, v106
    v_permlane16_swap_b32 v105, v107
    buffer_store_dwordx4 v[72:75], v7, s[28:31], s71 offen offset:0 sc1
    buffer_store_dwordx4 v[104:107], v7, s[28:31], s71 offen offset:64 sc1
    s_add_u32 s71, s71, s72
    v_cvt_pk_bf16_f32 v80, v80, v81
    v_cvt_pk_bf16_f32 v81, v82, v83
    v_cvt_pk_bf16_f32 v82, v84, v85
    v_cvt_pk_bf16_f32 v83, v86, v87
    v_cvt_pk_bf16_f32 v112, v112, v113
    v_cvt_pk_bf16_f32 v113, v114, v115
    v_cvt_pk_bf16_f32 v114, v116, v117
    v_cvt_pk_bf16_f32 v115, v118, v119
    s_nop 1
    v_permlane16_swap_b32 v80, v82
    v_permlane16_swap_b32 v81, v83
    v_permlane16_swap_b32 v112, v114
    v_permlane16_swap_b32 v113, v115
    buffer_store_dwordx4 v[80:83], v7, s[28:31], s71 offen offset:0 sc1
    buffer_store_dwordx4 v[112:115], v7, s[28:31], s71 offen offset:64 sc1
    s_add_u32 s71, s71, s72
    v_cvt_pk_bf16_f32 v88, v88, v89
    v_cvt_pk_bf16_f32 v89, v90, v91
    v_cvt_pk_bf16_f32 v90, v92, v93
    v_cvt_pk_bf16_f32 v91, v94, v95
    v_cvt_pk_bf16_f32 v120, v120, v121
    v_cvt_pk_bf16_f32 v121, v122, v123
    v_cvt_pk_bf16_f32 v122, v124, v125
    v_cvt_pk_bf16_f32 v123, v126, v127
    s_nop 1
    v_permlane16_swap_b32 v88, v90
    v_permlane16_swap_b32 v89, v91
    v_permlane16_swap_b32 v120, v122
    v_permlane16_swap_b32 v121, v123
    buffer_store_dwordx4 v[88:91], v7, s[28:31], s71 offen offset:0 sc1
    buffer_store_dwordx4 v[120:123], v7, s[28:31], s71 offen offset:64 sc1
    s_add_u32 s71, s71, s72
m_end1:
    s_endpgm
m_stub76:
    v_cmp_lt_f32 vcc, s65, v8
    s_cmp_lg_u32 s64, s67
    s_cbranch_scc1 m_e178
    v_add_f32 v176, v176, v16
    v_mov_b32 v180, v9
    v_add_f32 v188, v188, v16
    v_add_f32 v177, v177, v17
    v_mov_b32 v181, v9
    v_add_f32 v189, v189, v17
    v_add_f32 v178, v178, v18
    v_mov_b32 v182, v9
    v_add_f32 v190, v190, v18
    v_add_f32 v179, v179, v19
    v_mov_b32 v183, v9
    v_add_f32 v191, v191, v19
    s_nop 0
m_e178:
    s_cmp_lg_u32 s64, s68
    s_cbranch_scc1 m_e179
    v_mov_b32 v176, v9
    v_mov_b32 v184, v9
    v_mov_b32 v188, v9
    v_mov_b32 v177, v9
    v_mov_b32 v185, v9
    v_mov_b32 v189, v9
    v_mov_b32 v178, v9
    v_mov_b32 v186, v9
    v_mov_b32 v190, v9
    v_mov_b32 v179, v9
    v_mov_b32 v187, v9
    v_mov_b32 v191, v9
    s_nop 0
m_e179:
    s_cbranch_vccnz m_rc180
m_sp177:
    s_branch m_ret77
m_stub79:
    v_cmp_lt_f32 vcc, s65, v8
    s_cmp_lg_u32 s64, s67
    s_cbranch_scc1 m_e182
    v_add_f32 v176, v176, v16
    v_mov_b32 v180, v9
    v_add_f32 v188, v188, v16
    v_add_f32 v177, v177, v17
    v_mov_b32 v181, v9
    v_add_f32 v189, v189, v17
    v_add_f32 v178, v178, v18
    v_mov_b32 v182, v9
    v_add_f32 v190, v190, v18
    v_add_f32 v179, v179, v19
    v_mov_b32 v183, v9
    v_add_f32 v191, v191, v19
    s_nop 0
m_e182:
    s_cmp_lg_u32 s64, s68
    s_cbranch_scc1 m_e183
    v_mov_b32 v176, v9
    v_mov_b32 v184, v9
    v_mov_b32 v188, v9
    v_mov_b32 v177, v9
    v_mov_b32 v185, v9
    v_mov_b32 v189, v9
    v_mov_b32 v178, v9
    v_mov_b32 v186, v9
    v_mov_b32 v190, v9
    v_mov_b32 v179, v9
    v_mov_b32 v187, v9
    v_mov_b32 v191, v9
    s_nop 0
m_e183:
    s_cbranch_vccnz m_rc184
m_sp181:
    s_branch m_ret80
m_stub97:
    v_cmp_lt_f32 vcc, s65, v8
    s_cmp_lg_u32 s64, s70
    s_cbranch_scc1 m_e186
    v_add_f32 v160, v160, v16
    v_mov_b32 v164, v9
    v_add_f32 v172, v172, v16
    v_add_f32 v161, v161, v17
    v_mov_b32 v165, v9
    v_add_f32 v173, v173, v17
    v_add_f32 v162, v162, v18
    v_mov_b32 v166, v9
    v_add_f32 v174, v174, v18
    v_add_f32 v163, v163, v19
    v_mov_b32 v167, v9
    v_add_f32 v175, v175, v19
    s_nop 0
m_e186:
    s_cmp_lg_u32 s64, s71
    s_cbranch_scc1 m_e187
    v_mov_b32 v160, v9
    v_mov_b32 v168, v9
    v_mov_b32 v172, v9
    v_mov_b32 v161, v9
    v_mov_b32 v169, v9
    v_mov_b32 v173, v9
    v_mov_b32 v162, v9
    v_mov_b32 v170, v9
    v_mov_b32 v174, v9
    v_mov_b32 v163, v9
    v_mov_b32 v171, v9
    v_mov_b32 v175, v9
    s_nop 0
m_e187:
    s_cbranch_vccnz m_rc188
m_sp185:
    s_branch m_ret98
m_stub99:
    v_cmp_lt_f32 vcc, s65, v8
    s_cmp_lg_u32 s64, s70
    s_cbranch_scc1 m_e190
    v_add_f32 v160, v160, v16
    v_mov_b32 v164, v9
    v_add_f32 v172, v172, v16
    v_add_f32 v161, v161, v17
    v_mov_b32 v165, v9
    v_add_f32 v173, v173, v17
    v_add_f32 v162, v162, v18
    v_mov_b32 v166, v9
    v_add_f32 v174, v174, v18
    v_add_f32 v163, v163, v19
    v_mov_b32 v167, v9
    v_add_f32 v175, v175, v19
    s_nop 0
m_e190:
    s_cmp_lg_u32 s64, s71
    s_cbranch_scc1 m_e191
    v_mov_b32 v160, v9
    v_mov_b32 v168, v9
    v_mov_b32 v172, v9
    v_mov_b32 v161, v9
    v_mov_b32 v169, v9
    v_mov_b32 v173, v9
    v_mov_b32 v162, v9
    v_mov_b32 v170, v9
    v_mov_b32 v174, v9
    v_mov_b32 v163, v9
    v_mov_b32 v171, v9
    v_mov_b32 v175, v9
    s_nop 0
m_e191:
    s_cmp_lg_u32 s64, s53
    s_cbranch_scc1 m_e194
    s_cmp_lg_u32 s16, 0
    s_cbranch_scc1 m_np195
    v_mov_b32 v60, s4
    v_mov_b32 v61, s5
    s_add_u32 s90, s101, 117440512
    s_mov_b64 exec, 1
    buffer_store_dwordx2 v[60:61], off, s[8:11], s90 sc1
    s_mov_b64 exec, -1
m_np195:
    s_mov_b32 s101, -1
m_e194:
    s_cmp_gt_u32 s64, 24
    s_cbranch_scc1 m_e192
    s_cmp_lg_u32 s64, 8
    s_cbranch_scc1 m_e196
    s_lshr_b32 s90, s32, 1
    s_lshl_b32 s90, s90, 7
    s_add_u32 s90, s90, 117440600
    v_min_u32 v0, 1, v1
    v_lshlrev_b32 v0, 5, v0
    buffer_load_dwordx2 v[4:5], v0, s[8:11], s90 offen sc1
    s_cmp_eq_u32 s17, -1
    s_cbranch_scc1 m_e192
    s_cmp_lg_u32 s16, 0
    s_cbranch_scc1 m_np197
    v_mov_b32 v60, s4
    v_mov_b32 v61, s5
    s_add_u32 s90, s17, 117440512
    s_mov_b64 exec, 1
    buffer_store_dwordx2 v[60:61], off, s[8:11], s90 sc1
    s_mov_b64 exec, -1
m_np197:
    s_branch m_e192
m_e196:
    s_cmp_lg_u32 s64, 16
    s_cbranch_scc1 m_e198
    s_waitcnt vmcnt(18)
    s_mov_b32 s3, 1048576
m_spin199:
    v_cmp_ne_u64 s[76:77], s[4:5], v[4:5]
    s_nop 3
    s_cmp_eq_u64 s[76:77], 0
    s_cbranch_scc1 m_e192
    s_sub_u32 s3, s3, 1
    s_cbranch_scc1 m_e192
    s_sleep 32
    s_lshr_b32 s90, s32, 1
    s_lshl_b32 s90, s90, 7
    s_add_u32 s90, s90, 117440600
    v_min_u32 v0, 1, v1
    v_lshlrev_b32 v0, 5, v0
    buffer_load_dwordx2 v[4:5], v0, s[8:11], s90 offen sc1
    s_waitcnt vmcnt(0)
    s_branch m_spin199
    s_branch m_e192
m_e198:
    s_cmp_lg_u32 s64, 20
    s_cbranch_scc1 m_e200
    buffer_load_dwordx2 v[4:5], v10, s[8:11], 0 offen sc1
    s_mov_b32 s44, s48
    s_mov_b32 s45, s49
    s_mov_b32 s46, 8388608
    s_lshl_b32 s90, s2, 2
    s_add_u32 s90, s90, s16
    s_lshl_b32 s90, s90, 13
    v_lshlrev_b32 v62, 7, v1
    buffer_load_dword v255, v62, s[44:47], s90 offen
    s_branch m_e192
m_e200:
    s_cmp_lg_u32 s64, 24
    s_cbranch_scc1 m_e201
    s_mov_b32 s44, s50
    s_mov_b32 s45, s51
    s_mov_b32 s46, 2097152
    s_lshl_b32 s90, s2, 2
    s_add_u32 s90, s90, s16
    s_lshl_b32 s90, s90, 13
    v_lshlrev_b32 v62, 7, v1
    buffer_load_dword v255, v62, s[44:47], s90 offen
    s_waitcnt vmcnt(18)
    s_mov_b32 s3, 1048576
m_spin202:
    v_cmp_ne_u64 s[76:77], s[4:5], v[4:5]
    s_nop 3
    s_cmp_eq_u64 s[76:77], 0
    s_cbranch_scc1 m_e192
    s_sub_u32 s3, s3, 1
    s_cbranch_scc1 m_e192
    s_sleep 32
    buffer_load_dwordx2 v[4:5], v10, s[8:11], 0 offen sc1
    s_waitcnt vmcnt(0)
    s_branch m_spin202
    s_branch m_e192
m_e201:
m_e192:
    s_cbranch_vccnz m_rc203
m_sp189:
    s_branch m_ret100
m_stub103:
    v_cmp_lt_f32 vcc, s65, v8
    s_cmp_lg_u32 s64, s70
    s_cbranch_scc1 m_e205
    v_add_f32 v160, v160, v16
    v_mov_b32 v164, v9
    v_add_f32 v172, v172, v16
    v_add_f32 v161, v161, v17
    v_mov_b32 v165, v9
    v_add_f32 v173, v173, v17
    v_add_f32 v162, v162, v18
    v_mov_b32 v166, v9
    v_add_f32 v174, v174, v18
    v_add_f32 v163, v163, v19
    v_mov_b32 v167, v9
    v_add_f32 v175, v175, v19
    s_nop 0
m_e205:
    s_cmp_lg_u32 s64, s71
    s_cbranch_scc1 m_e206
    v_mov_b32 v160, v9
    v_mov_b32 v168, v9
    v_mov_b32 v172, v9
    v_mov_b32 v161, v9
    v_mov_b32 v169, v9
    v_mov_b32 v173, v9
    v_mov_b32 v162, v9
    v_mov_b32 v170, v9
    v_mov_b32 v174, v9
    v_mov_b32 v163, v9
    v_mov_b32 v171, v9
    v_mov_b32 v175, v9
    s_nop 0
m_e206:
    s_cbranch_vccnz m_rc207
m_sp204:
    s_branch m_ret104
m_stub120:
    v_cmp_lt_f32 vcc, s65, v8
    s_cbranch_vccnz m_rc209
m_sp208:
    s_branch m_ret121
m_rc96:
    s_call_b64 s[74:75], m_rs0470
    s_branch m_sp81
m_rc119:
    s_call_b64 s[74:75], m_rs0269
    s_branch m_sp105
m_rc180:
    s_call_b64 s[74:75], m_rs0470
    s_branch m_sp177
m_rc184:
    s_call_b64 s[74:75], m_rs1472
    s_branch m_sp181
m_rc188:
    s_call_b64 s[74:75], m_rs1472
    s_branch m_sp185
m_rc203:
    s_call_b64 s[74:75], m_rs0269
    s_branch m_sp189
m_rc207:
    s_call_b64 s[74:75], m_rs1271
    s_branch m_sp204
m_rc209:
    s_call_b64 s[74:75], m_rs1271
    s_branch m_sp208
m_rs0269:
    s_nop 15
    v_max3_f32 v48, v64, v65, v66
    v_max3_f32 v48, v48, v67, v68
    v_max3_f32 v48, v48, v69, v70
    v_max3_f32 v48, v48, v71, 0
    v_mov_b32 v49, v48
    s_nop 1
    v_permlane32_swap_b32 v48, v49
    s_nop 1
    v_max_f32 v48, v48, v49
    v_mov_b32 v49, v48
    s_nop 1
    v_permlane16_swap_b32 v48, v49
    s_nop 1
    v_max_f32 v48, v48, v49
    v_exp_f32 v49, -v48
    v_sub_f32 v64, v64, v48
    v_sub_f32 v65, v65, v48
    v_sub_f32 v66, v66, v48
    v_sub_f32 v67, v67, v48
    v_sub_f32 v68, v68, v48
    v_sub_f32 v69, v69, v48
    v_sub_f32 v70, v70, v48
    v_sub_f32 v71, v71, v48
    v_sub_f32 v96, v96, v48
    v_sub_f32 v97, v97, v48
    v_sub_f32 v98, v98, v48
    v_sub_f32 v99, v99, v48
    v_sub_f32 v100, v100, v48
    v_sub_f32 v101, v101, v48
    v_sub_f32 v102, v102, v48
    v_sub_f32 v103, v103, v48
    v_sub_f32 v160, v160, v48
    v_sub_f32 v161, v161, v48
    v_sub_f32 v162, v162, v48
    v_sub_f32 v163, v163, v48
    v_sub_f32 v164, v164, v48
    v_sub_f32 v165, v165, v48
    v_sub_f32 v166, v166, v48
    v_sub_f32 v167, v167, v48
    v_mul_f32 v12, v12, v49
    v_accvgpr_read_b32 v52, a0
    v_accvgpr_read_b32 v53, a1
    v_accvgpr_read_b32 v54, a2
    v_accvgpr_read_b32 v55, a3
    v_accvgpr_read_b32 v56, a4
    v_accvgpr_read_b32 v57, a5
    v_accvgpr_read_b32 v58, a6
    v_accvgpr_read_b32 v59, a7
    v_mul_f32 v52, v52, v49
    v_mul_f32 v53, v53, v49
    v_mul_f32 v54, v54, v49
    v_mul_f32 v55, v55, v49
    v_mul_f32 v56, v56, v49
    v_mul_f32 v57, v57, v49
    v_mul_f32 v58, v58, v49
    v_mul_f32 v59, v59, v49
    v_accvgpr_write_b32 a0, v52
    v_accvgpr_write_b32 a1, v53
    v_accvgpr_write_b32 a2, v54
    v_accvgpr_write_b32 a3, v55
    v_accvgpr_write_b32 a4, v56
    v_accvgpr_write_b32 a5, v57
    v_accvgpr_write_b32 a6, v58
    v_accvgpr_write_b32 a7, v59
    v_accvgpr_read_b32 v52, a8
    v_accvgpr_read_b32 v53, a9
    v_accvgpr_read_b32 v54, a10
    v_accvgpr_read_b32 v55, a11
    v_accvgpr_read_b32 v56, a12
    v_accvgpr_read_b32 v57, a13
    v_accvgpr_read_b32 v58, a14
    v_accvgpr_read_b32 v59, a15
    v_mul_f32 v52, v52, v49
    v_mul_f32 v53, v53, v49
    v_mul_f32 v54, v54, v49
    v_mul_f32 v55, v55, v49
    v_mul_f32 v56, v56, v49
    v_mul_f32 v57, v57, v49
    v_mul_f32 v58, v58, v49
    v_mul_f32 v59, v59, v49
    v_accvgpr_write_b32 a8, v52
    v_accvgpr_write_b32 a9, v53
    v_accvgpr_write_b32 a10, v54
    v_accvgpr_write_b32 a11, v55
    v_accvgpr_write_b32 a12, v56
    v_accvgpr_write_b32 a13, v57
    v_accvgpr_write_b32 a14, v58
    v_accvgpr_write_b32 a15, v59
    v_accvgpr_read_b32 v52, a16
    v_accvgpr_read_b32 v53, a17
    v_accvgpr_read_b32 v54, a18
    v_accvgpr_read_b32 v55, a19
    v_accvgpr_read_b32 v56, a20
    v_accvgpr_read_b32 v57, a21
    v_accvgpr_read_b32 v58, a22
    v_accvgpr_read_b32 v59, a23
    v_mul_f32 v52, v52, v49
    v_mul_f32 v53, v53, v49
    v_mul_f32 v54, v54, v49
    v_mul_f32 v55, v55, v49
    v_mul_f32 v56, v56, v49
    v_mul_f32 v57, v57, v49
    v_mul_f32 v58, v58, v49
    v_mul_f32 v59, v59, v49
    v_accvgpr_write_b32 a16, v52
    v_accvgpr_write_b32 a17, v53
    v_accvgpr_write_b32 a18, v54
    v_accvgpr_write_b32 a19, v55
    v_accvgpr_write_b32 a20, v56
    v_accvgpr_write_b32 a21, v57
    v_accvgpr_write_b32 a22, v58
    v_accvgpr_write_b32 a23, v59
    v_accvgpr_read_b32 v52, a24
    v_accvgpr_read_b32 v53, a25
    v_accvgpr_read_b32 v54, a26
    v_accvgpr_read_b32 v55, a27
    v_accvgpr_read_b32 v56, a28
    v_accvgpr_read_b32 v57, a29
    v_accvgpr_read_b32 v58, a30
    v_accvgpr_read_b32 v59, a31
    v_mul_f32 v52, v52, v49
    v_mul_f32 v53, v53, v49
    v_mul_f32 v54, v54, v49
    v_mul_f32 v55, v55, v49
    v_mul_f32 v56, v56, v49
    v_mul_f32 v57, v57, v49
    v_mul_f32 v58, v58, v49
    v_mul_f32 v59, v59, v49
    v_accvgpr_write_b32 a24, v52
    v_accvgpr_write_b32 a25, v53
    v_accvgpr_write_b32 a26, v54
    v_accvgpr_write_b32 a27, v55
    v_accvgpr_write_b32 a28, v56
    v_accvgpr_write_b32 a29, v57
    v_accvgpr_write_b32 a30, v58
    v_accvgpr_write_b32 a31, v59
    v_exp_f32 v52, v64
    v_exp_f32 v53, v65
    v_exp_f32 v54, v66
    v_exp_f32 v55, v67
    v_exp_f32 v56, v68
    v_exp_f32 v57, v69
    v_exp_f32 v58, v70
    v_exp_f32 v59, v71
    s_nop 0
    v_cvt_pk_bf16_f32 v128, v52, v53
    v_cvt_pk_bf16_f32 v129, v54, v55
    v_cvt_pk_bf16_f32 v130, v56, v57
    v_cvt_pk_bf16_f32 v131, v58, v59
    s_nop 1
    v_mfma_f32_16x16x32_bf16 v[28:31], v[44:47], v[128:131], 0
    v_max3_f32 v48, v72, v73, v74
    v_max3_f32 v48, v48, v75, v76
    v_max3_f32 v48, v48, v77, v78
    v_max3_f32 v48, v48, v79, 0
    v_mov_b32 v49, v48
    s_nop 1
    v_permlane32_swap_b32 v48, v49
    s_nop 1
    v_max_f32 v48, v48, v49
    v_mov_b32 v49, v48
    s_nop 1
    v_permlane16_swap_b32 v48, v49
    s_nop 1
    v_max_f32 v48, v48, v49
    v_exp_f32 v49, -v48
    v_sub_f32 v72, v72, v48
    v_sub_f32 v73, v73, v48
    v_sub_f32 v74, v74, v48
    v_sub_f32 v75, v75, v48
    v_sub_f32 v76, v76, v48
    v_sub_f32 v77, v77, v48
    v_sub_f32 v78, v78, v48
    v_sub_f32 v79, v79, v48
    v_sub_f32 v104, v104, v48
    v_sub_f32 v105, v105, v48
    v_sub_f32 v106, v106, v48
    v_sub_f32 v107, v107, v48
    v_sub_f32 v108, v108, v48
    v_sub_f32 v109, v109, v48
    v_sub_f32 v110, v110, v48
    v_sub_f32 v111, v111, v48
    v_sub_f32 v168, v168, v48
    v_sub_f32 v169, v169, v48
    v_sub_f32 v170, v170, v48
    v_sub_f32 v171, v171, v48
    v_sub_f32 v172, v172, v48
    v_sub_f32 v173, v173, v48
    v_sub_f32 v174, v174, v48
    v_sub_f32 v175, v175, v48
    v_mul_f32 v13, v13, v49
    v_accvgpr_read_b32 v52, a32
    v_accvgpr_read_b32 v53, a33
    v_accvgpr_read_b32 v54, a34
    v_accvgpr_read_b32 v55, a35
    v_accvgpr_read_b32 v56, a36
    v_accvgpr_read_b32 v57, a37
    v_accvgpr_read_b32 v58, a38
    v_accvgpr_read_b32 v59, a39
    v_mul_f32 v52, v52, v49
    v_mul_f32 v53, v53, v49
    v_mul_f32 v54, v54, v49
    v_mul_f32 v55, v55, v49
    v_mul_f32 v56, v56, v49
    v_mul_f32 v57, v57, v49
    v_mul_f32 v58, v58, v49
    v_mul_f32 v59, v59, v49
    v_accvgpr_write_b32 a32, v52
    v_accvgpr_write_b32 a33, v53
    v_accvgpr_write_b32 a34, v54
    v_accvgpr_write_b32 a35, v55
    v_accvgpr_write_b32 a36, v56
    v_accvgpr_write_b32 a37, v57
    v_accvgpr_write_b32 a38, v58
    v_accvgpr_write_b32 a39, v59
    v_accvgpr_read_b32 v52, a40
    v_accvgpr_read_b32 v53, a41
    v_accvgpr_read_b32 v54, a42
    v_accvgpr_read_b32 v55, a43
    v_accvgpr_read_b32 v56, a44
    v_accvgpr_read_b32 v57, a45
    v_accvgpr_read_b32 v58, a46
    v_accvgpr_read_b32 v59, a47
    v_mul_f32 v52, v52, v49
    v_mul_f32 v53, v53, v49
    v_mul_f32 v54, v54, v49
    v_mul_f32 v55, v55, v49
    v_mul_f32 v56, v56, v49
    v_mul_f32 v57, v57, v49
    v_mul_f32 v58, v58, v49
    v_mul_f32 v59, v59, v49
    v_accvgpr_write_b32 a40, v52
    v_accvgpr_write_b32 a41, v53
    v_accvgpr_write_b32 a42, v54
    v_accvgpr_write_b32 a43, v55
    v_accvgpr_write_b32 a44, v56
    v_accvgpr_write_b32 a45, v57
    v_accvgpr_write_b32 a46, v58
    v_accvgpr_write_b32 a47, v59
    v_accvgpr_read_b32 v52, a48
    v_accvgpr_read_b32 v53, a49
    v_accvgpr_read_b32 v54, a50
    v_accvgpr_read_b32 v55, a51
    v_accvgpr_read_b32 v56, a52
    v_accvgpr_read_b32 v57, a53
    v_accvgpr_read_b32 v58, a54
    v_accvgpr_read_b32 v59, a55
    v_mul_f32 v52, v52, v49
    v_mul_f32 v53, v53, v49
    v_mul_f32 v54, v54, v49
    v_mul_f32 v55, v55, v49
    v_mul_f32 v56, v56, v49
    v_mul_f32 v57, v57, v49
    v_mul_f32 v58, v58, v49
    v_mul_f32 v59, v59, v49
    v_accvgpr_write_b32 a48, v52
    v_accvgpr_write_b32 a49, v53
    v_accvgpr_write_b32 a50, v54
    v_accvgpr_write_b32 a51, v55
    v_accvgpr_write_b32 a52, v56
    v_accvgpr_write_b32 a53, v57
    v_accvgpr_write_b32 a54, v58
    v_accvgpr_write_b32 a55, v59
    v_accvgpr_read_b32 v52, a56
    v_accvgpr_read_b32 v53, a57
    v_accvgpr_read_b32 v54, a58
    v_accvgpr_read_b32 v55, a59
    v_accvgpr_read_b32 v56, a60
    v_accvgpr_read_b32 v57, a61
    v_accvgpr_read_b32 v58, a62
    v_accvgpr_read_b32 v59, a63
    v_mul_f32 v52, v52, v49
    v_mul_f32 v53, v53, v49
    v_mul_f32 v54, v54, v49
    v_mul_f32 v55, v55, v49
    v_mul_f32 v56, v56, v49
    v_mul_f32 v57, v57, v49
    v_mul_f32 v58, v58, v49
    v_mul_f32 v59, v59, v49
    v_accvgpr_write_b32 a56, v52
    v_accvgpr_write_b32 a57, v53
    v_accvgpr_write_b32 a58, v54
    v_accvgpr_write_b32 a59, v55
    v_accvgpr_write_b32 a60, v56
    v_accvgpr_write_b32 a61, v57
    v_accvgpr_write_b32 a62, v58
    v_accvgpr_write_b32 a63, v59
    v_exp_f32 v52, v72
    v_exp_f32 v53, v73
    v_exp_f32 v54, v74
    v_exp_f32 v55, v75
    v_exp_f32 v56, v76
    v_exp_f32 v57, v77
    v_exp_f32 v58, v78
    v_exp_f32 v59, v79
    s_nop 0
    v_cvt_pk_bf16_f32 v132, v52, v53
    v_cvt_pk_bf16_f32 v133, v54, v55
    v_cvt_pk_bf16_f32 v134, v56, v57
    v_cvt_pk_bf16_f32 v135, v58, v59
    s_nop 1
    v_mfma_f32_16x16x32_bf16 v[32:35], v[44:47], v[132:135], 0
    s_nop 7
    s_setpc_b64 s[74:75]
m_rs0470:
    s_nop 15
    v_max3_f32 v48, v64, v65, v66
    v_max3_f32 v48, v48, v67, v68
    v_max3_f32 v48, v48, v69, v70
    v_max3_f32 v48, v48, v71, 0
    v_mov_b32 v49, v48
    s_nop 1
    v_permlane32_swap_b32 v48, v49
    s_nop 1
    v_max_f32 v48, v48, v49
    v_mov_b32 v49, v48
    s_nop 1
    v_permlane16_swap_b32 v48, v49
    s_nop 1
    v_max_f32 v48, v48, v49
    v_exp_f32 v49, -v48
    v_sub_f32 v64, v64, v48
    v_sub_f32 v65, v65, v48
    v_sub_f32 v66, v66, v48
    v_sub_f32 v67, v67, v48
    v_sub_f32 v68, v68, v48
    v_sub_f32 v69, v69, v48
    v_sub_f32 v70, v70, v48
    v_sub_f32 v71, v71, v48
    v_sub_f32 v96, v96, v48
    v_sub_f32 v97, v97, v48
    v_sub_f32 v98, v98, v48
    v_sub_f32 v99, v99, v48
    v_sub_f32 v100, v100, v48
    v_sub_f32 v101, v101, v48
    v_sub_f32 v102, v102, v48
    v_sub_f32 v103, v103, v48
    v_sub_f32 v160, v160, v48
    v_sub_f32 v161, v161, v48
    v_sub_f32 v162, v162, v48
    v_sub_f32 v163, v163, v48
    v_sub_f32 v164, v164, v48
    v_sub_f32 v165, v165, v48
    v_sub_f32 v166, v166, v48
    v_sub_f32 v167, v167, v48
    v_mul_f32 v12, v12, v49
    v_accvgpr_read_b32 v52, a0
    v_accvgpr_read_b32 v53, a1
    v_accvgpr_read_b32 v54, a2
    v_accvgpr_read_b32 v55, a3
    v_accvgpr_read_b32 v56, a4
    v_accvgpr_read_b32 v57, a5
    v_accvgpr_read_b32 v58, a6
    v_accvgpr_read_b32 v59, a7
    v_mul_f32 v52, v52, v49
    v_mul_f32 v53, v53, v49
    v_mul_f32 v54, v54, v49
    v_mul_f32 v55, v55, v49
    v_mul_f32 v56, v56, v49
    v_mul_f32 v57, v57, v49
    v_mul_f32 v58, v58, v49
    v_mul_f32 v59, v59, v49
    v_accvgpr_write_b32 a0, v52
    v_accvgpr_write_b32 a1, v53
    v_accvgpr_write_b32 a2, v54
    v_accvgpr_write_b32 a3, v55
    v_accvgpr_write_b32 a4, v56
    v_accvgpr_write_b32 a5, v57
    v_accvgpr_write_b32 a6, v58
    v_accvgpr_write_b32 a7, v59
    v_accvgpr_read_b32 v52, a8
    v_accvgpr_read_b32 v53, a9
    v_accvgpr_read_b32 v54, a10
    v_accvgpr_read_b32 v55, a11
    v_accvgpr_read_b32 v56, a12
    v_accvgpr_read_b32 v57, a13
    v_accvgpr_read_b32 v58, a14
    v_accvgpr_read_b32 v59, a15
    v_mul_f32 v52, v52, v49
    v_mul_f32 v53, v53, v49
    v_mul_f32 v54, v54, v49
    v_mul_f32 v55, v55, v49
    v_mul_f32 v56, v56, v49
    v_mul_f32 v57, v57, v49
    v_mul_f32 v58, v58, v49
    v_mul_f32 v59, v59, v49
    v_accvgpr_write_b32 a8, v52
    v_accvgpr_write_b32 a9, v53
    v_accvgpr_write_b32 a10, v54
    v_accvgpr_write_b32 a11, v55
    v_accvgpr_write_b32 a12, v56
    v_accvgpr_write_b32 a13, v57
    v_accvgpr_write_b32 a14, v58
    v_accvgpr_write_b32 a15, v59
    v_accvgpr_read_b32 v52, a16
    v_accvgpr_read_b32 v53, a17
    v_accvgpr_read_b32 v54, a18
    v_accvgpr_read_b32 v55, a19
    v_accvgpr_read_b32 v56, a20
    v_accvgpr_read_b32 v57, a21
    v_accvgpr_read_b32 v58, a22
    v_accvgpr_read_b32 v59, a23
    v_mul_f32 v52, v52, v49
    v_mul_f32 v53, v53, v49
    v_mul_f32 v54, v54, v49
    v_mul_f32 v55, v55, v49
    v_mul_f32 v56, v56, v49
    v_mul_f32 v57, v57, v49
    v_mul_f32 v58, v58, v49
    v_mul_f32 v59, v59, v49
    v_accvgpr_write_b32 a16, v52
    v_accvgpr_write_b32 a17, v53
    v_accvgpr_write_b32 a18, v54
    v_accvgpr_write_b32 a19, v55
    v_accvgpr_write_b32 a20, v56
    v_accvgpr_write_b32 a21, v57
    v_accvgpr_write_b32 a22, v58
    v_accvgpr_write_b32 a23, v59
    v_accvgpr_read_b32 v52, a24
    v_accvgpr_read_b32 v53, a25
    v_accvgpr_read_b32 v54, a26
    v_accvgpr_read_b32 v55, a27
    v_accvgpr_read_b32 v56, a28
    v_accvgpr_read_b32 v57, a29
    v_accvgpr_read_b32 v58, a30
    v_accvgpr_read_b32 v59, a31
    v_mul_f32 v52, v52, v49
    v_mul_f32 v53, v53, v49
    v_mul_f32 v54, v54, v49
    v_mul_f32 v55, v55, v49
    v_mul_f32 v56, v56, v49
    v_mul_f32 v57, v57, v49
    v_mul_f32 v58, v58, v49
    v_mul_f32 v59, v59, v49
    v_accvgpr_write_b32 a24, v52
    v_accvgpr_write_b32 a25, v53
    v_accvgpr_write_b32 a26, v54
    v_accvgpr_write_b32 a27, v55
    v_accvgpr_write_b32 a28, v56
    v_accvgpr_write_b32 a29, v57
    v_accvgpr_write_b32 a30, v58
    v_accvgpr_write_b32 a31, v59
    v_exp_f32 v52, v64
    v_exp_f32 v53, v65
    v_exp_f32 v54, v66
    v_exp_f32 v55, v67
    v_exp_f32 v56, v68
    v_exp_f32 v57, v69
    v_exp_f32 v58, v70
    v_exp_f32 v59, v71
    s_nop 0
    v_cvt_pk_bf16_f32 v128, v52, v53
    v_cvt_pk_bf16_f32 v129, v54, v55
    v_cvt_pk_bf16_f32 v130, v56, v57
    v_cvt_pk_bf16_f32 v131, v58, v59
    s_nop 1
    v_mfma_f32_16x16x32_bf16 v[28:31], v[44:47], v[128:131], 0
    v_max3_f32 v48, v72, v73, v74
    v_max3_f32 v48, v48, v75, v76
    v_max3_f32 v48, v48, v77, v78
    v_max3_f32 v48, v48, v79, 0
    v_mov_b32 v49, v48
    s_nop 1
    v_permlane32_swap_b32 v48, v49
    s_nop 1
    v_max_f32 v48, v48, v49
    v_mov_b32 v49, v48
    s_nop 1
    v_permlane16_swap_b32 v48, v49
    s_nop 1
    v_max_f32 v48, v48, v49
    v_exp_f32 v49, -v48
    v_sub_f32 v72, v72, v48
    v_sub_f32 v73, v73, v48
    v_sub_f32 v74, v74, v48
    v_sub_f32 v75, v75, v48
    v_sub_f32 v76, v76, v48
    v_sub_f32 v77, v77, v48
    v_sub_f32 v78, v78, v48
    v_sub_f32 v79, v79, v48
    v_sub_f32 v104, v104, v48
    v_sub_f32 v105, v105, v48
    v_sub_f32 v106, v106, v48
    v_sub_f32 v107, v107, v48
    v_sub_f32 v108, v108, v48
    v_sub_f32 v109, v109, v48
    v_sub_f32 v110, v110, v48
    v_sub_f32 v111, v111, v48
    v_sub_f32 v168, v168, v48
    v_sub_f32 v169, v169, v48
    v_sub_f32 v170, v170, v48
    v_sub_f32 v171, v171, v48
    v_sub_f32 v172, v172, v48
    v_sub_f32 v173, v173, v48
    v_sub_f32 v174, v174, v48
    v_sub_f32 v175, v175, v48
    v_mul_f32 v13, v13, v49
    v_accvgpr_read_b32 v52, a32
    v_accvgpr_read_b32 v53, a33
    v_accvgpr_read_b32 v54, a34
    v_accvgpr_read_b32 v55, a35
    v_accvgpr_read_b32 v56, a36
    v_accvgpr_read_b32 v57, a37
    v_accvgpr_read_b32 v58, a38
    v_accvgpr_read_b32 v59, a39
    v_mul_f32 v52, v52, v49
    v_mul_f32 v53, v53, v49
    v_mul_f32 v54, v54, v49
    v_mul_f32 v55, v55, v49
    v_mul_f32 v56, v56, v49
    v_mul_f32 v57, v57, v49
    v_mul_f32 v58, v58, v49
    v_mul_f32 v59, v59, v49
    v_accvgpr_write_b32 a32, v52
    v_accvgpr_write_b32 a33, v53
    v_accvgpr_write_b32 a34, v54
    v_accvgpr_write_b32 a35, v55
    v_accvgpr_write_b32 a36, v56
    v_accvgpr_write_b32 a37, v57
    v_accvgpr_write_b32 a38, v58
    v_accvgpr_write_b32 a39, v59
    v_accvgpr_read_b32 v52, a40
    v_accvgpr_read_b32 v53, a41
    v_accvgpr_read_b32 v54, a42
    v_accvgpr_read_b32 v55, a43
    v_accvgpr_read_b32 v56, a44
    v_accvgpr_read_b32 v57, a45
    v_accvgpr_read_b32 v58, a46
    v_accvgpr_read_b32 v59, a47
    v_mul_f32 v52, v52, v49
    v_mul_f32 v53, v53, v49
    v_mul_f32 v54, v54, v49
    v_mul_f32 v55, v55, v49
    v_mul_f32 v56, v56, v49
    v_mul_f32 v57, v57, v49
    v_mul_f32 v58, v58, v49
    v_mul_f32 v59, v59, v49
    v_accvgpr_write_b32 a40, v52
    v_accvgpr_write_b32 a41, v53
    v_accvgpr_write_b32 a42, v54
    v_accvgpr_write_b32 a43, v55
    v_accvgpr_write_b32 a44, v56
    v_accvgpr_write_b32 a45, v57
    v_accvgpr_write_b32 a46, v58
    v_accvgpr_write_b32 a47, v59
    v_accvgpr_read_b32 v52, a48
    v_accvgpr_read_b32 v53, a49
    v_accvgpr_read_b32 v54, a50
    v_accvgpr_read_b32 v55, a51
    v_accvgpr_read_b32 v56, a52
    v_accvgpr_read_b32 v57, a53
    v_accvgpr_read_b32 v58, a54
    v_accvgpr_read_b32 v59, a55
    v_mul_f32 v52, v52, v49
    v_mul_f32 v53, v53, v49
    v_mul_f32 v54, v54, v49
    v_mul_f32 v55, v55, v49
    v_mul_f32 v56, v56, v49
    v_mul_f32 v57, v57, v49
    v_mul_f32 v58, v58, v49
    v_mul_f32 v59, v59, v49
    v_accvgpr_write_b32 a48, v52
    v_accvgpr_write_b32 a49, v53
    v_accvgpr_write_b32 a50, v54
    v_accvgpr_write_b32 a51, v55
    v_accvgpr_write_b32 a52, v56
    v_accvgpr_write_b32 a53, v57
    v_accvgpr_write_b32 a54, v58
    v_accvgpr_write_b32 a55, v59
    v_accvgpr_read_b32 v52, a56
    v_accvgpr_read_b32 v53, a57
    v_accvgpr_read_b32 v54, a58
    v_accvgpr_read_b32 v55, a59
    v_accvgpr_read_b32 v56, a60
    v_accvgpr_read_b32 v57, a61
    v_accvgpr_read_b32 v58, a62
    v_accvgpr_read_b32 v59, a63
    v_mul_f32 v52, v52, v49
    v_mul_f32 v53, v53, v49
    v_mul_f32 v54, v54, v49
    v_mul_f32 v55, v55, v49
    v_mul_f32 v56, v56, v49
    v_mul_f32 v57, v57, v49
    v_mul_f32 v58, v58, v49
    v_mul_f32 v59, v59, v49
    v_accvgpr_write_b32 a56, v52
    v_accvgpr_write_b32 a57, v53
    v_accvgpr_write_b32 a58, v54
    v_accvgpr_write_b32 a59, v55
    v_accvgpr_write_b32 a60, v56
    v_accvgpr_write_b32 a61, v57
    v_accvgpr_write_b32 a62, v58
    v_accvgpr_write_b32 a63, v59
    v_exp_f32 v52, v72
    v_exp_f32 v53, v73
    v_exp_f32 v54, v74
    v_exp_f32 v55, v75
    v_exp_f32 v56, v76
    v_exp_f32 v57, v77
    v_exp_f32 v58, v78
    v_exp_f32 v59, v79
    s_nop 0
    v_cvt_pk_bf16_f32 v132, v52, v53
    v_cvt_pk_bf16_f32 v133, v54, v55
    v_cvt_pk_bf16_f32 v134, v56, v57
    v_cvt_pk_bf16_f32 v135, v58, v59
    s_nop 1
    v_mfma_f32_16x16x32_bf16 v[32:35], v[44:47], v[132:135], 0
    v_max3_f32 v48, v80, v81, v82
    v_max3_f32 v48, v48, v83, v84
    v_max3_f32 v48, v48, v85, v86
    v_max3_f32 v48, v48, v87, 0
    v_mov_b32 v49, v48
    s_nop 1
    v_permlane32_swap_b32 v48, v49
    s_nop 1
    v_max_f32 v48, v48, v49
    v_mov_b32 v49, v48
    s_nop 1
    v_permlane16_swap_b32 v48, v49
    s_nop 1
    v_max_f32 v48, v48, v49
    v_exp_f32 v49, -v48
    v_sub_f32 v80, v80, v48
    v_sub_f32 v81, v81, v48
    v_sub_f32 v82, v82, v48
    v_sub_f32 v83, v83, v48
    v_sub_f32 v84, v84, v48
    v_sub_f32 v85, v85, v48
    v_sub_f32 v86, v86, v48
    v_sub_f32 v87, v87, v48
    v_sub_f32 v112, v112, v48
    v_sub_f32 v113, v113, v48
    v_sub_f32 v114, v114, v48
    v_sub_f32 v115, v115, v48
    v_sub_f32 v116, v116, v48
    v_sub_f32 v117, v117, v48
    v_sub_f32 v118, v118, v48
    v_sub_f32 v119, v119, v48
    v_sub_f32 v176, v176, v48
    v_sub_f32 v177, v177, v48
    v_sub_f32 v178, v178, v48
    v_sub_f32 v179, v179, v48
    v_sub_f32 v180, v180, v48
    v_sub_f32 v181, v181, v48
    v_sub_f32 v182, v182, v48
    v_sub_f32 v183, v183, v48
    v_mul_f32 v14, v14, v49
    v_accvgpr_read_b32 v52, a64
    v_accvgpr_read_b32 v53, a65
    v_accvgpr_read_b32 v54, a66
    v_accvgpr_read_b32 v55, a67
    v_accvgpr_read_b32 v56, a68
    v_accvgpr_read_b32 v57, a69
    v_accvgpr_read_b32 v58, a70
    v_accvgpr_read_b32 v59, a71
    v_mul_f32 v52, v52, v49
    v_mul_f32 v53, v53, v49
    v_mul_f32 v54, v54, v49
    v_mul_f32 v55, v55, v49
    v_mul_f32 v56, v56, v49
    v_mul_f32 v57, v57, v49
    v_mul_f32 v58, v58, v49
    v_mul_f32 v59, v59, v49
    v_accvgpr_write_b32 a64, v52
    v_accvgpr_write_b32 a65, v53
    v_accvgpr_write_b32 a66, v54
    v_accvgpr_write_b32 a67, v55
    v_accvgpr_write_b32 a68, v56
    v_accvgpr_write_b32 a69, v57
    v_accvgpr_write_b32 a70, v58
    v_accvgpr_write_b32 a71, v59
    v_accvgpr_read_b32 v52, a72
    v_accvgpr_read_b32 v53, a73
    v_accvgpr_read_b32 v54, a74
    v_accvgpr_read_b32 v55, a75
    v_accvgpr_read_b32 v56, a76
    v_accvgpr_read_b32 v57, a77
    v_accvgpr_read_b32 v58, a78
    v_accvgpr_read_b32 v59, a79
    v_mul_f32 v52, v52, v49
    v_mul_f32 v53, v53, v49
    v_mul_f32 v54, v54, v49
    v_mul_f32 v55, v55, v49
    v_mul_f32 v56, v56, v49
    v_mul_f32 v57, v57, v49
    v_mul_f32 v58, v58, v49
    v_mul_f32 v59, v59, v49
    v_accvgpr_write_b32 a72, v52
    v_accvgpr_write_b32 a73, v53
    v_accvgpr_write_b32 a74, v54
    v_accvgpr_write_b32 a75, v55
    v_accvgpr_write_b32 a76, v56
    v_accvgpr_write_b32 a77, v57
    v_accvgpr_write_b32 a78, v58
    v_accvgpr_write_b32 a79, v59
    v_accvgpr_read_b32 v52, a80
    v_accvgpr_read_b32 v53, a81
    v_accvgpr_read_b32 v54, a82
    v_accvgpr_read_b32 v55, a83
    v_accvgpr_read_b32 v56, a84
    v_accvgpr_read_b32 v57, a85
    v_accvgpr_read_b32 v58, a86
    v_accvgpr_read_b32 v59, a87
    v_mul_f32 v52, v52, v49
    v_mul_f32 v53, v53, v49
    v_mul_f32 v54, v54, v49
    v_mul_f32 v55, v55, v49
    v_mul_f32 v56, v56, v49
    v_mul_f32 v57, v57, v49
    v_mul_f32 v58, v58, v49
    v_mul_f32 v59, v59, v49
    v_accvgpr_write_b32 a80, v52
    v_accvgpr_write_b32 a81, v53
    v_accvgpr_write_b32 a82, v54
    v_accvgpr_write_b32 a83, v55
    v_accvgpr_write_b32 a84, v56
    v_accvgpr_write_b32 a85, v57
    v_accvgpr_write_b32 a86, v58
    v_accvgpr_write_b32 a87, v59
    v_accvgpr_read_b32 v52, a88
    v_accvgpr_read_b32 v53, a89
    v_accvgpr_read_b32 v54, a90
    v_accvgpr_read_b32 v55, a91
    v_accvgpr_read_b32 v56, a92
    v_accvgpr_read_b32 v57, a93
    v_accvgpr_read_b32 v58, a94
    v_accvgpr_read_b32 v59, a95
    v_mul_f32 v52, v52, v49
    v_mul_f32 v53, v53, v49
    v_mul_f32 v54, v54, v49
    v_mul_f32 v55, v55, v49
    v_mul_f32 v56, v56, v49
    v_mul_f32 v57, v57, v49
    v_mul_f32 v58, v58, v49
    v_mul_f32 v59, v59, v49
    v_accvgpr_write_b32 a88, v52
    v_accvgpr_write_b32 a89, v53
    v_accvgpr_write_b32 a90, v54
    v_accvgpr_write_b32 a91, v55
    v_accvgpr_write_b32 a92, v56
    v_accvgpr_write_b32 a93, v57
    v_accvgpr_write_b32 a94, v58
    v_accvgpr_write_b32 a95, v59
    v_exp_f32 v52, v80
    v_exp_f32 v53, v81
    v_exp_f32 v54, v82
    v_exp_f32 v55, v83
    v_exp_f32 v56, v84
    v_exp_f32 v57, v85
    v_exp_f32 v58, v86
    v_exp_f32 v59, v87
    s_nop 0
    v_cvt_pk_bf16_f32 v136, v52, v53
    v_cvt_pk_bf16_f32 v137, v54, v55
    v_cvt_pk_bf16_f32 v138, v56, v57
    v_cvt_pk_bf16_f32 v139, v58, v59
    s_nop 1
    v_mfma_f32_16x16x32_bf16 v[36:39], v[44:47], v[136:139], 0
    v_max3_f32 v48, v88, v89, v90
    v_max3_f32 v48, v48, v91, v92
    v_max3_f32 v48, v48, v93, v94
    v_max3_f32 v48, v48, v95, 0
    v_mov_b32 v49, v48
    s_nop 1
    v_permlane32_swap_b32 v48, v49
    s_nop 1
    v_max_f32 v48, v48, v49
    v_mov_b32 v49, v48
    s_nop 1
    v_permlane16_swap_b32 v48, v49
    s_nop 1
    v_max_f32 v48, v48, v49
    v_exp_f32 v49, -v48
    v_sub_f32 v88, v88, v48
    v_sub_f32 v89, v89, v48
    v_sub_f32 v90, v90, v48
    v_sub_f32 v91, v91, v48
    v_sub_f32 v92, v92, v48
    v_sub_f32 v93, v93, v48
    v_sub_f32 v94, v94, v48
    v_sub_f32 v95, v95, v48
    v_sub_f32 v120, v120, v48
    v_sub_f32 v121, v121, v48
    v_sub_f32 v122, v122, v48
    v_sub_f32 v123, v123, v48
    v_sub_f32 v124, v124, v48
    v_sub_f32 v125, v125, v48
    v_sub_f32 v126, v126, v48
    v_sub_f32 v127, v127, v48
    v_sub_f32 v184, v184, v48
    v_sub_f32 v185, v185, v48
    v_sub_f32 v186, v186, v48
    v_sub_f32 v187, v187, v48
    v_sub_f32 v188, v188, v48
    v_sub_f32 v189, v189, v48
    v_sub_f32 v190, v190, v48
    v_sub_f32 v191, v191, v48
    v_mul_f32 v15, v15, v49
    v_accvgpr_read_b32 v52, a96
    v_accvgpr_read_b32 v53, a97
    v_accvgpr_read_b32 v54, a98
    v_accvgpr_read_b32 v55, a99
    v_accvgpr_read_b32 v56, a100
    v_accvgpr_read_b32 v57, a101
    v_accvgpr_read_b32 v58, a102
    v_accvgpr_read_b32 v59, a103
    v_mul_f32 v52, v52, v49
    v_mul_f32 v53, v53, v49
    v_mul_f32 v54, v54, v49
    v_mul_f32 v55, v55, v49
    v_mul_f32 v56, v56, v49
    v_mul_f32 v57, v57, v49
    v_mul_f32 v58, v58, v49
    v_mul_f32 v59, v59, v49
    v_accvgpr_write_b32 a96, v52
    v_accvgpr_write_b32 a97, v53
    v_accvgpr_write_b32 a98, v54
    v_accvgpr_write_b32 a99, v55
    v_accvgpr_write_b32 a100, v56
    v_accvgpr_write_b32 a101, v57
    v_accvgpr_write_b32 a102, v58
    v_accvgpr_write_b32 a103, v59
    v_accvgpr_read_b32 v52, a104
    v_accvgpr_read_b32 v53, a105
    v_accvgpr_read_b32 v54, a106
    v_accvgpr_read_b32 v55, a107
    v_accvgpr_read_b32 v56, a108
    v_accvgpr_read_b32 v57, a109
    v_accvgpr_read_b32 v58, a110
    v_accvgpr_read_b32 v59, a111
    v_mul_f32 v52, v52, v49
    v_mul_f32 v53, v53, v49
    v_mul_f32 v54, v54, v49
    v_mul_f32 v55, v55, v49
    v_mul_f32 v56, v56, v49
    v_mul_f32 v57, v57, v49
    v_mul_f32 v58, v58, v49
    v_mul_f32 v59, v59, v49
    v_accvgpr_write_b32 a104, v52
    v_accvgpr_write_b32 a105, v53
    v_accvgpr_write_b32 a106, v54
    v_accvgpr_write_b32 a107, v55
    v_accvgpr_write_b32 a108, v56
    v_accvgpr_write_b32 a109, v57
    v_accvgpr_write_b32 a110, v58
    v_accvgpr_write_b32 a111, v59
    v_accvgpr_read_b32 v52, a112
    v_accvgpr_read_b32 v53, a113
    v_accvgpr_read_b32 v54, a114
    v_accvgpr_read_b32 v55, a115
    v_accvgpr_read_b32 v56, a116
    v_accvgpr_read_b32 v57, a117
    v_accvgpr_read_b32 v58, a118
    v_accvgpr_read_b32 v59, a119
    v_mul_f32 v52, v52, v49
    v_mul_f32 v53, v53, v49
    v_mul_f32 v54, v54, v49
    v_mul_f32 v55, v55, v49
    v_mul_f32 v56, v56, v49
    v_mul_f32 v57, v57, v49
    v_mul_f32 v58, v58, v49
    v_mul_f32 v59, v59, v49
    v_accvgpr_write_b32 a112, v52
    v_accvgpr_write_b32 a113, v53
    v_accvgpr_write_b32 a114, v54
    v_accvgpr_write_b32 a115, v55
    v_accvgpr_write_b32 a116, v56
    v_accvgpr_write_b32 a117, v57
    v_accvgpr_write_b32 a118, v58
    v_accvgpr_write_b32 a119, v59
    v_accvgpr_read_b32 v52, a120
    v_accvgpr_read_b32 v53, a121
    v_accvgpr_read_b32 v54, a122
    v_accvgpr_read_b32 v55, a123
    v_accvgpr_read_b32 v56, a124
    v_accvgpr_read_b32 v57, a125
    v_accvgpr_read_b32 v58, a126
    v_accvgpr_read_b32 v59, a127
    v_mul_f32 v52, v52, v49
    v_mul_f32 v53, v53, v49
    v_mul_f32 v54, v54, v49
    v_mul_f32 v55, v55, v49
    v_mul_f32 v56, v56, v49
    v_mul_f32 v57, v57, v49
    v_mul_f32 v58, v58, v49
    v_mul_f32 v59, v59, v49
    v_accvgpr_write_b32 a120, v52
    v_accvgpr_write_b32 a121, v53
    v_accvgpr_write_b32 a122, v54
    v_accvgpr_write_b32 a123, v55
    v_accvgpr_write_b32 a124, v56
    v_accvgpr_write_b32 a125, v57
    v_accvgpr_write_b32 a126, v58
    v_accvgpr_write_b32 a127, v59
    v_exp_f32 v52, v88
    v_exp_f32 v53, v89
    v_exp_f32 v54, v90
    v_exp_f32 v55, v91
    v_exp_f32 v56, v92
    v_exp_f32 v57, v93
    v_exp_f32 v58, v94
    v_exp_f32 v59, v95
    s_nop 0
    v_cvt_pk_bf16_f32 v140, v52, v53
    v_cvt_pk_bf16_f32 v141, v54, v55
    v_cvt_pk_bf16_f32 v142, v56, v57
    v_cvt_pk_bf16_f32 v143, v58, v59
    s_nop 1
    v_mfma_f32_16x16x32_bf16 v[40:43], v[44:47], v[140:143], 0
    s_nop 7
    s_setpc_b64 s[74:75]
m_rs1271:
    s_nop 15
    v_max3_f32 v48, v96, v97, v98
    v_max3_f32 v48, v48, v99, v100
    v_max3_f32 v48, v48, v101, v102
    v_max3_f32 v48, v48, v103, 0
    v_mov_b32 v49, v48
    s_nop 1
    v_permlane32_swap_b32 v48, v49
    s_nop 1
    v_max_f32 v48, v48, v49
    v_mov_b32 v49, v48
    s_nop 1
    v_permlane16_swap_b32 v48, v49
    s_nop 1
    v_max_f32 v48, v48, v49
    v_exp_f32 v49, -v48
    v_sub_f32 v96, v96, v48
    v_sub_f32 v97, v97, v48
    v_sub_f32 v98, v98, v48
    v_sub_f32 v99, v99, v48
    v_sub_f32 v100, v100, v48
    v_sub_f32 v101, v101, v48
    v_sub_f32 v102, v102, v48
    v_sub_f32 v103, v103, v48
    v_sub_f32 v64, v64, v48
    v_sub_f32 v65, v65, v48
    v_sub_f32 v66, v66, v48
    v_sub_f32 v67, v67, v48
    v_sub_f32 v68, v68, v48
    v_sub_f32 v69, v69, v48
    v_sub_f32 v70, v70, v48
    v_sub_f32 v71, v71, v48
    v_sub_f32 v160, v160, v48
    v_sub_f32 v161, v161, v48
    v_sub_f32 v162, v162, v48
    v_sub_f32 v163, v163, v48
    v_sub_f32 v164, v164, v48
    v_sub_f32 v165, v165, v48
    v_sub_f32 v166, v166, v48
    v_sub_f32 v167, v167, v48
    v_mul_f32 v12, v12, v49
    v_accvgpr_read_b32 v52, a0
    v_accvgpr_read_b32 v53, a1
    v_accvgpr_read_b32 v54, a2
    v_accvgpr_read_b32 v55, a3
    v_accvgpr_read_b32 v56, a4
    v_accvgpr_read_b32 v57, a5
    v_accvgpr_read_b32 v58, a6
    v_accvgpr_read_b32 v59, a7
    v_mul_f32 v52, v52, v49
    v_mul_f32 v53, v53, v49
    v_mul_f32 v54, v54, v49
    v_mul_f32 v55, v55, v49
    v_mul_f32 v56, v56, v49
    v_mul_f32 v57, v57, v49
    v_mul_f32 v58, v58, v49
    v_mul_f32 v59, v59, v49
    v_accvgpr_write_b32 a0, v52
    v_accvgpr_write_b32 a1, v53
    v_accvgpr_write_b32 a2, v54
    v_accvgpr_write_b32 a3, v55
    v_accvgpr_write_b32 a4, v56
    v_accvgpr_write_b32 a5, v57
    v_accvgpr_write_b32 a6, v58
    v_accvgpr_write_b32 a7, v59
    v_accvgpr_read_b32 v52, a8
    v_accvgpr_read_b32 v53, a9
    v_accvgpr_read_b32 v54, a10
    v_accvgpr_read_b32 v55, a11
    v_accvgpr_read_b32 v56, a12
    v_accvgpr_read_b32 v57, a13
    v_accvgpr_read_b32 v58, a14
    v_accvgpr_read_b32 v59, a15
    v_mul_f32 v52, v52, v49
    v_mul_f32 v53, v53, v49
    v_mul_f32 v54, v54, v49
    v_mul_f32 v55, v55, v49
    v_mul_f32 v56, v56, v49
    v_mul_f32 v57, v57, v49
    v_mul_f32 v58, v58, v49
    v_mul_f32 v59, v59, v49
    v_accvgpr_write_b32 a8, v52
    v_accvgpr_write_b32 a9, v53
    v_accvgpr_write_b32 a10, v54
    v_accvgpr_write_b32 a11, v55
    v_accvgpr_write_b32 a12, v56
    v_accvgpr_write_b32 a13, v57
    v_accvgpr_write_b32 a14, v58
    v_accvgpr_write_b32 a15, v59
    v_accvgpr_read_b32 v52, a16
    v_accvgpr_read_b32 v53, a17
    v_accvgpr_read_b32 v54, a18
    v_accvgpr_read_b32 v55, a19
    v_accvgpr_read_b32 v56, a20
    v_accvgpr_read_b32 v57, a21
    v_accvgpr_read_b32 v58, a22
    v_accvgpr_read_b32 v59, a23
    v_mul_f32 v52, v52, v49
    v_mul_f32 v53, v53, v49
    v_mul_f32 v54, v54, v49
    v_mul_f32 v55, v55, v49
    v_mul_f32 v56, v56, v49
    v_mul_f32 v57, v57, v49
    v_mul_f32 v58, v58, v49
    v_mul_f32 v59, v59, v49
    v_accvgpr_write_b32 a16, v52
    v_accvgpr_write_b32 a17, v53
    v_accvgpr_write_b32 a18, v54
    v_accvgpr_write_b32 a19, v55
    v_accvgpr_write_b32 a20, v56
    v_accvgpr_write_b32 a21, v57
    v_accvgpr_write_b32 a22, v58
    v_accvgpr_write_b32 a23, v59
    v_accvgpr_read_b32 v52, a24
    v_accvgpr_read_b32 v53, a25
    v_accvgpr_read_b32 v54, a26
    v_accvgpr_read_b32 v55, a27
    v_accvgpr_read_b32 v56, a28
    v_accvgpr_read_b32 v57, a29
    v_accvgpr_read_b32 v58, a30
    v_accvgpr_read_b32 v59, a31
    v_mul_f32 v52, v52, v49
    v_mul_f32 v53, v53, v49
    v_mul_f32 v54, v54, v49
    v_mul_f32 v55, v55, v49
    v_mul_f32 v56, v56, v49
    v_mul_f32 v57, v57, v49
    v_mul_f32 v58, v58, v49
    v_mul_f32 v59, v59, v49
    v_accvgpr_write_b32 a24, v52
    v_accvgpr_write_b32 a25, v53
    v_accvgpr_write_b32 a26, v54
    v_accvgpr_write_b32 a27, v55
    v_accvgpr_write_b32 a28, v56
    v_accvgpr_write_b32 a29, v57
    v_accvgpr_write_b32 a30, v58
    v_accvgpr_write_b32 a31, v59
    v_exp_f32 v52, v96
    v_exp_f32 v53, v97
    v_exp_f32 v54, v98
    v_exp_f32 v55, v99
    v_exp_f32 v56, v100
    v_exp_f32 v57, v101
    v_exp_f32 v58, v102
    v_exp_f32 v59, v103
    s_nop 0
    v_cvt_pk_bf16_f32 v144, v52, v53
    v_cvt_pk_bf16_f32 v145, v54, v55
    v_cvt_pk_bf16_f32 v146, v56, v57
    v_cvt_pk_bf16_f32 v147, v58, v59
    s_nop 1
    v_mfma_f32_16x16x32_bf16 v[28:31], v[44:47], v[144:147], 0
    v_max3_f32 v48, v104, v105, v106
    v_max3_f32 v48, v48, v107, v108
    v_max3_f32 v48, v48, v109, v110
    v_max3_f32 v48, v48, v111, 0
    v_mov_b32 v49, v48
    s_nop 1
    v_permlane32_swap_b32 v48, v49
    s_nop 1
    v_max_f32 v48, v48, v49
    v_mov_b32 v49, v48
    s_nop 1
    v_permlane16_swap_b32 v48, v49
    s_nop 1
    v_max_f32 v48, v48, v49
    v_exp_f32 v49, -v48
    v_sub_f32 v104, v104, v48
    v_sub_f32 v105, v105, v48
    v_sub_f32 v106, v106, v48
    v_sub_f32 v107, v107, v48
    v_sub_f32 v108, v108, v48
    v_sub_f32 v109, v109, v48
    v_sub_f32 v110, v110, v48
    v_sub_f32 v111, v111, v48
    v_sub_f32 v72, v72, v48
    v_sub_f32 v73, v73, v48
    v_sub_f32 v74, v74, v48
    v_sub_f32 v75, v75, v48
    v_sub_f32 v76, v76, v48
    v_sub_f32 v77, v77, v48
    v_sub_f32 v78, v78, v48
    v_sub_f32 v79, v79, v48
    v_sub_f32 v168, v168, v48
    v_sub_f32 v169, v169, v48
    v_sub_f32 v170, v170, v48
    v_sub_f32 v171, v171, v48
    v_sub_f32 v172, v172, v48
    v_sub_f32 v173, v173, v48
    v_sub_f32 v174, v174, v48
    v_sub_f32 v175, v175, v48
    v_mul_f32 v13, v13, v49
    v_accvgpr_read_b32 v52, a32
    v_accvgpr_read_b32 v53, a33
    v_accvgpr_read_b32 v54, a34
    v_accvgpr_read_b32 v55, a35
    v_accvgpr_read_b32 v56, a36
    v_accvgpr_read_b32 v57, a37
    v_accvgpr_read_b32 v58, a38
    v_accvgpr_read_b32 v59, a39
    v_mul_f32 v52, v52, v49
    v_mul_f32 v53, v53, v49
    v_mul_f32 v54, v54, v49
    v_mul_f32 v55, v55, v49
    v_mul_f32 v56, v56, v49
    v_mul_f32 v57, v57, v49
    v_mul_f32 v58, v58, v49
    v_mul_f32 v59, v59, v49
    v_accvgpr_write_b32 a32, v52
    v_accvgpr_write_b32 a33, v53
    v_accvgpr_write_b32 a34, v54
    v_accvgpr_write_b32 a35, v55
    v_accvgpr_write_b32 a36, v56
    v_accvgpr_write_b32 a37, v57
    v_accvgpr_write_b32 a38, v58
    v_accvgpr_write_b32 a39, v59
    v_accvgpr_read_b32 v52, a40
    v_accvgpr_read_b32 v53, a41
    v_accvgpr_read_b32 v54, a42
    v_accvgpr_read_b32 v55, a43
    v_accvgpr_read_b32 v56, a44
    v_accvgpr_read_b32 v57, a45
    v_accvgpr_read_b32 v58, a46
    v_accvgpr_read_b32 v59, a47
    v_mul_f32 v52, v52, v49
    v_mul_f32 v53, v53, v49
    v_mul_f32 v54, v54, v49
    v_mul_f32 v55, v55, v49
    v_mul_f32 v56, v56, v49
    v_mul_f32 v57, v57, v49
    v_mul_f32 v58, v58, v49
    v_mul_f32 v59, v59, v49
    v_accvgpr_write_b32 a40, v52
    v_accvgpr_write_b32 a41, v53
    v_accvgpr_write_b32 a42, v54
    v_accvgpr_write_b32 a43, v55
    v_accvgpr_write_b32 a44, v56
    v_accvgpr_write_b32 a45, v57
    v_accvgpr_write_b32 a46, v58
    v_accvgpr_write_b32 a47, v59
    v_accvgpr_read_b32 v52, a48
    v_accvgpr_read_b32 v53, a49
    v_accvgpr_read_b32 v54, a50
    v_accvgpr_read_b32 v55, a51
    v_accvgpr_read_b32 v56, a52
    v_accvgpr_read_b32 v57, a53
    v_accvgpr_read_b32 v58, a54
    v_accvgpr_read_b32 v59, a55
    v_mul_f32 v52, v52, v49
    v_mul_f32 v53, v53, v49
    v_mul_f32 v54, v54, v49
    v_mul_f32 v55, v55, v49
    v_mul_f32 v56, v56, v49
    v_mul_f32 v57, v57, v49
    v_mul_f32 v58, v58, v49
    v_mul_f32 v59, v59, v49
    v_accvgpr_write_b32 a48, v52
    v_accvgpr_write_b32 a49, v53
    v_accvgpr_write_b32 a50, v54
    v_accvgpr_write_b32 a51, v55
    v_accvgpr_write_b32 a52, v56
    v_accvgpr_write_b32 a53, v57
    v_accvgpr_write_b32 a54, v58
    v_accvgpr_write_b32 a55, v59
    v_accvgpr_read_b32 v52, a56
    v_accvgpr_read_b32 v53, a57
    v_accvgpr_read_b32 v54, a58
    v_accvgpr_read_b32 v55, a59
    v_accvgpr_read_b32 v56, a60
    v_accvgpr_read_b32 v57, a61
    v_accvgpr_read_b32 v58, a62
    v_accvgpr_read_b32 v59, a63
    v_mul_f32 v52, v52, v49
    v_mul_f32 v53, v53, v49
    v_mul_f32 v54, v54, v49
    v_mul_f32 v55, v55, v49
    v_mul_f32 v56, v56, v49
    v_mul_f32 v57, v57, v49
    v_mul_f32 v58, v58, v49
    v_mul_f32 v59, v59, v49
    v_accvgpr_write_b32 a56, v52
    v_accvgpr_write_b32 a57, v53
    v_accvgpr_write_b32 a58, v54
    v_accvgpr_write_b32 a59, v55
    v_accvgpr_write_b32 a60, v56
    v_accvgpr_write_b32 a61, v57
    v_accvgpr_write_b32 a62, v58
    v_accvgpr_write_b32 a63, v59
    v_exp_f32 v52, v104
    v_exp_f32 v53, v105
    v_exp_f32 v54, v106
    v_exp_f32 v55, v107
    v_exp_f32 v56, v108
    v_exp_f32 v57, v109
    v_exp_f32 v58, v110
    v_exp_f32 v59, v111
    s_nop 0
    v_cvt_pk_bf16_f32 v148, v52, v53
    v_cvt_pk_bf16_f32 v149, v54, v55
    v_cvt_pk_bf16_f32 v150, v56, v57
    v_cvt_pk_bf16_f32 v151, v58, v59
    s_nop 1
    v_mfma_f32_16x16x32_bf16 v[32:35], v[44:47], v[148:151], 0
    s_nop 7
    s_setpc_b64 s[74:75]
m_rs1472:
    s_nop 15
    v_max3_f32 v48, v96, v97, v98
    v_max3_f32 v48, v48, v99, v100
    v_max3_f32 v48, v48, v101, v102
    v_max3_f32 v48, v48, v103, 0
    v_mov_b32 v49, v48
    s_nop 1
    v_permlane32_swap_b32 v48, v49
    s_nop 1
    v_max_f32 v48, v48, v49
    v_mov_b32 v49, v48
    s_nop 1
    v_permlane16_swap_b32 v48, v49
    s_nop 1
    v_max_f32 v48, v48, v49
    v_exp_f32 v49, -v48
    v_sub_f32 v96, v96, v48
    v_sub_f32 v97, v97, v48
    v_sub_f32 v98, v98, v48
    v_sub_f32 v99, v99, v48
    v_sub_f32 v100, v100, v48
    v_sub_f32 v101, v101, v48
    v_sub_f32 v102, v102, v48
    v_sub_f32 v103, v103, v48
    v_sub_f32 v64, v64, v48
    v_sub_f32 v65, v65, v48
    v_sub_f32 v66, v66, v48
    v_sub_f32 v67, v67, v48
    v_sub_f32 v68, v68, v48
    v_sub_f32 v69, v69, v48
    v_sub_f32 v70, v70, v48
    v_sub_f32 v71, v71, v48
    v_sub_f32 v160, v160, v48
    v_sub_f32 v161, v161, v48
    v_sub_f32 v162, v162, v48
    v_sub_f32 v163, v163, v48
    v_sub_f32 v164, v164, v48
    v_sub_f32 v165, v165, v48
    v_sub_f32 v166, v166, v48
    v_sub_f32 v167, v167, v48
    v_mul_f32 v12, v12, v49
    v_accvgpr_read_b32 v52, a0
    v_accvgpr_read_b32 v53, a1
    v_accvgpr_read_b32 v54, a2
    v_accvgpr_read_b32 v55, a3
    v_accvgpr_read_b32 v56, a4
    v_accvgpr_read_b32 v57, a5
    v_accvgpr_read_b32 v58, a6
    v_accvgpr_read_b32 v59, a7
    v_mul_f32 v52, v52, v49
    v_mul_f32 v53, v53, v49
    v_mul_f32 v54, v54, v49
    v_mul_f32 v55, v55, v49
    v_mul_f32 v56, v56, v49
    v_mul_f32 v57, v57, v49
    v_mul_f32 v58, v58, v49
    v_mul_f32 v59, v59, v49
    v_accvgpr_write_b32 a0, v52
    v_accvgpr_write_b32 a1, v53
    v_accvgpr_write_b32 a2, v54
    v_accvgpr_write_b32 a3, v55
    v_accvgpr_write_b32 a4, v56
    v_accvgpr_write_b32 a5, v57
    v_accvgpr_write_b32 a6, v58
    v_accvgpr_write_b32 a7, v59
    v_accvgpr_read_b32 v52, a8
    v_accvgpr_read_b32 v53, a9
    v_accvgpr_read_b32 v54, a10
    v_accvgpr_read_b32 v55, a11
    v_accvgpr_read_b32 v56, a12
    v_accvgpr_read_b32 v57, a13
    v_accvgpr_read_b32 v58, a14
    v_accvgpr_read_b32 v59, a15
    v_mul_f32 v52, v52, v49
    v_mul_f32 v53, v53, v49
    v_mul_f32 v54, v54, v49
    v_mul_f32 v55, v55, v49
    v_mul_f32 v56, v56, v49
    v_mul_f32 v57, v57, v49
    v_mul_f32 v58, v58, v49
    v_mul_f32 v59, v59, v49
    v_accvgpr_write_b32 a8, v52
    v_accvgpr_write_b32 a9, v53
    v_accvgpr_write_b32 a10, v54
    v_accvgpr_write_b32 a11, v55
    v_accvgpr_write_b32 a12, v56
    v_accvgpr_write_b32 a13, v57
    v_accvgpr_write_b32 a14, v58
    v_accvgpr_write_b32 a15, v59
    v_accvgpr_read_b32 v52, a16
    v_accvgpr_read_b32 v53, a17
    v_accvgpr_read_b32 v54, a18
    v_accvgpr_read_b32 v55, a19
    v_accvgpr_read_b32 v56, a20
    v_accvgpr_read_b32 v57, a21
    v_accvgpr_read_b32 v58, a22
    v_accvgpr_read_b32 v59, a23
    v_mul_f32 v52, v52, v49
    v_mul_f32 v53, v53, v49
    v_mul_f32 v54, v54, v49
    v_mul_f32 v55, v55, v49
    v_mul_f32 v56, v56, v49
    v_mul_f32 v57, v57, v49
    v_mul_f32 v58, v58, v49
    v_mul_f32 v59, v59, v49
    v_accvgpr_write_b32 a16, v52
    v_accvgpr_write_b32 a17, v53
    v_accvgpr_write_b32 a18, v54
    v_accvgpr_write_b32 a19, v55
    v_accvgpr_write_b32 a20, v56
    v_accvgpr_write_b32 a21, v57
    v_accvgpr_write_b32 a22, v58
    v_accvgpr_write_b32 a23, v59
    v_accvgpr_read_b32 v52, a24
    v_accvgpr_read_b32 v53, a25
    v_accvgpr_read_b32 v54, a26
    v_accvgpr_read_b32 v55, a27
    v_accvgpr_read_b32 v56, a28
    v_accvgpr_read_b32 v57, a29
    v_accvgpr_read_b32 v58, a30
    v_accvgpr_read_b32 v59, a31
    v_mul_f32 v52, v52, v49
    v_mul_f32 v53, v53, v49
    v_mul_f32 v54, v54, v49
    v_mul_f32 v55, v55, v49
    v_mul_f32 v56, v56, v49
    v_mul_f32 v57, v57, v49
    v_mul_f32 v58, v58, v49
    v_mul_f32 v59, v59, v49
    v_accvgpr_write_b32 a24, v52
    v_accvgpr_write_b32 a25, v53
    v_accvgpr_write_b32 a26, v54
    v_accvgpr_write_b32 a27, v55
    v_accvgpr_write_b32 a28, v56
    v_accvgpr_write_b32 a29, v57
    v_accvgpr_write_b32 a30, v58
    v_accvgpr_write_b32 a31, v59
    v_exp_f32 v52, v96
    v_exp_f32 v53, v97
    v_exp_f32 v54, v98
    v_exp_f32 v55, v99
    v_exp_f32 v56, v100
    v_exp_f32 v57, v101
    v_exp_f32 v58, v102
    v_exp_f32 v59, v103
    s_nop 0
    v_cvt_pk_bf16_f32 v144, v52, v53
    v_cvt_pk_bf16_f32 v145, v54, v55
    v_cvt_pk_bf16_f32 v146, v56, v57
    v_cvt_pk_bf16_f32 v147, v58, v59
    s_nop 1
    v_mfma_f32_16x16x32_bf16 v[28:31], v[44:47], v[144:147], 0
    v_max3_f32 v48, v104, v105, v106
    v_max3_f32 v48, v48, v107, v108
    v_max3_f32 v48, v48, v109, v110
    v_max3_f32 v48, v48, v111, 0
    v_mov_b32 v49, v48
    s_nop 1
    v_permlane32_swap_b32 v48, v49
    s_nop 1
    v_max_f32 v48, v48, v49
    v_mov_b32 v49, v48
    s_nop 1
    v_permlane16_swap_b32 v48, v49
    s_nop 1
    v_max_f32 v48, v48, v49
    v_exp_f32 v49, -v48
    v_sub_f32 v104, v104, v48
    v_sub_f32 v105, v105, v48
    v_sub_f32 v106, v106, v48
    v_sub_f32 v107, v107, v48
    v_sub_f32 v108, v108, v48
    v_sub_f32 v109, v109, v48
    v_sub_f32 v110, v110, v48
    v_sub_f32 v111, v111, v48
    v_sub_f32 v72, v72, v48
    v_sub_f32 v73, v73, v48
    v_sub_f32 v74, v74, v48
    v_sub_f32 v75, v75, v48
    v_sub_f32 v76, v76, v48
    v_sub_f32 v77, v77, v48
    v_sub_f32 v78, v78, v48
    v_sub_f32 v79, v79, v48
    v_sub_f32 v168, v168, v48
    v_sub_f32 v169, v169, v48
    v_sub_f32 v170, v170, v48
    v_sub_f32 v171, v171, v48
    v_sub_f32 v172, v172, v48
    v_sub_f32 v173, v173, v48
    v_sub_f32 v174, v174, v48
    v_sub_f32 v175, v175, v48
    v_mul_f32 v13, v13, v49
    v_accvgpr_read_b32 v52, a32
    v_accvgpr_read_b32 v53, a33
    v_accvgpr_read_b32 v54, a34
    v_accvgpr_read_b32 v55, a35
    v_accvgpr_read_b32 v56, a36
    v_accvgpr_read_b32 v57, a37
    v_accvgpr_read_b32 v58, a38
    v_accvgpr_read_b32 v59, a39
    v_mul_f32 v52, v52, v49
    v_mul_f32 v53, v53, v49
    v_mul_f32 v54, v54, v49
    v_mul_f32 v55, v55, v49
    v_mul_f32 v56, v56, v49
    v_mul_f32 v57, v57, v49
    v_mul_f32 v58, v58, v49
    v_mul_f32 v59, v59, v49
    v_accvgpr_write_b32 a32, v52
    v_accvgpr_write_b32 a33, v53
    v_accvgpr_write_b32 a34, v54
    v_accvgpr_write_b32 a35, v55
    v_accvgpr_write_b32 a36, v56
    v_accvgpr_write_b32 a37, v57
    v_accvgpr_write_b32 a38, v58
    v_accvgpr_write_b32 a39, v59
    v_accvgpr_read_b32 v52, a40
    v_accvgpr_read_b32 v53, a41
    v_accvgpr_read_b32 v54, a42
    v_accvgpr_read_b32 v55, a43
    v_accvgpr_read_b32 v56, a44
    v_accvgpr_read_b32 v57, a45
    v_accvgpr_read_b32 v58, a46
    v_accvgpr_read_b32 v59, a47
    v_mul_f32 v52, v52, v49
    v_mul_f32 v53, v53, v49
    v_mul_f32 v54, v54, v49
    v_mul_f32 v55, v55, v49
    v_mul_f32 v56, v56, v49
    v_mul_f32 v57, v57, v49
    v_mul_f32 v58, v58, v49
    v_mul_f32 v59, v59, v49
    v_accvgpr_write_b32 a40, v52
    v_accvgpr_write_b32 a41, v53
    v_accvgpr_write_b32 a42, v54
    v_accvgpr_write_b32 a43, v55
    v_accvgpr_write_b32 a44, v56
    v_accvgpr_write_b32 a45, v57
    v_accvgpr_write_b32 a46, v58
    v_accvgpr_write_b32 a47, v59
    v_accvgpr_read_b32 v52, a48
    v_accvgpr_read_b32 v53, a49
    v_accvgpr_read_b32 v54, a50
    v_accvgpr_read_b32 v55, a51
    v_accvgpr_read_b32 v56, a52
    v_accvgpr_read_b32 v57, a53
    v_accvgpr_read_b32 v58, a54
    v_accvgpr_read_b32 v59, a55
    v_mul_f32 v52, v52, v49
    v_mul_f32 v53, v53, v49
    v_mul_f32 v54, v54, v49
    v_mul_f32 v55, v55, v49
    v_mul_f32 v56, v56, v49
    v_mul_f32 v57, v57, v49
    v_mul_f32 v58, v58, v49
    v_mul_f32 v59, v59, v49
    v_accvgpr_write_b32 a48, v52
    v_accvgpr_write_b32 a49, v53
    v_accvgpr_write_b32 a50, v54
    v_accvgpr_write_b32 a51, v55
    v_accvgpr_write_b32 a52, v56
    v_accvgpr_write_b32 a53, v57
    v_accvgpr_write_b32 a54, v58
    v_accvgpr_write_b32 a55, v59
    v_accvgpr_read_b32 v52, a56
    v_accvgpr_read_b32 v53, a57
    v_accvgpr_read_b32 v54, a58
    v_accvgpr_read_b32 v55, a59
    v_accvgpr_read_b32 v56, a60
    v_accvgpr_read_b32 v57, a61
    v_accvgpr_read_b32 v58, a62
    v_accvgpr_read_b32 v59, a63
    v_mul_f32 v52, v52, v49
    v_mul_f32 v53, v53, v49
    v_mul_f32 v54, v54, v49
    v_mul_f32 v55, v55, v49
    v_mul_f32 v56, v56, v49
    v_mul_f32 v57, v57, v49
    v_mul_f32 v58, v58, v49
    v_mul_f32 v59, v59, v49
    v_accvgpr_write_b32 a56, v52
    v_accvgpr_write_b32 a57, v53
    v_accvgpr_write_b32 a58, v54
    v_accvgpr_write_b32 a59, v55
    v_accvgpr_write_b32 a60, v56
    v_accvgpr_write_b32 a61, v57
    v_accvgpr_write_b32 a62, v58
    v_accvgpr_write_b32 a63, v59
    v_exp_f32 v52, v104
    v_exp_f32 v53, v105
    v_exp_f32 v54, v106
    v_exp_f32 v55, v107
    v_exp_f32 v56, v108
    v_exp_f32 v57, v109
    v_exp_f32 v58, v110
    v_exp_f32 v59, v111
    s_nop 0
    v_cvt_pk_bf16_f32 v148, v52, v53
    v_cvt_pk_bf16_f32 v149, v54, v55
    v_cvt_pk_bf16_f32 v150, v56, v57
    v_cvt_pk_bf16_f32 v151, v58, v59
    s_nop 1
    v_mfma_f32_16x16x32_bf16 v[32:35], v[44:47], v[148:151], 0
    v_max3_f32 v48, v112, v113, v114
    v_max3_f32 v48, v48, v115, v116
    v_max3_f32 v48, v48, v117, v118
    v_max3_f32 v48, v48, v119, 0
    v_mov_b32 v49, v48
    s_nop 1
    v_permlane32_swap_b32 v48, v49
    s_nop 1
    v_max_f32 v48, v48, v49
    v_mov_b32 v49, v48
    s_nop 1
    v_permlane16_swap_b32 v48, v49
    s_nop 1
    v_max_f32 v48, v48, v49
    v_exp_f32 v49, -v48
    v_sub_f32 v112, v112, v48
    v_sub_f32 v113, v113, v48
    v_sub_f32 v114, v114, v48
    v_sub_f32 v115, v115, v48
    v_sub_f32 v116, v116, v48
    v_sub_f32 v117, v117, v48
    v_sub_f32 v118, v118, v48
    v_sub_f32 v119, v119, v48
    v_sub_f32 v80, v80, v48
    v_sub_f32 v81, v81, v48
    v_sub_f32 v82, v82, v48
    v_sub_f32 v83, v83, v48
    v_sub_f32 v84, v84, v48
    v_sub_f32 v85, v85, v48
    v_sub_f32 v86, v86, v48
    v_sub_f32 v87, v87, v48
    v_sub_f32 v176, v176, v48
    v_sub_f32 v177, v177, v48
    v_sub_f32 v178, v178, v48
    v_sub_f32 v179, v179, v48
    v_sub_f32 v180, v180, v48
    v_sub_f32 v181, v181, v48
    v_sub_f32 v182, v182, v48
    v_sub_f32 v183, v183, v48
    v_mul_f32 v14, v14, v49
    v_accvgpr_read_b32 v52, a64
    v_accvgpr_read_b32 v53, a65
    v_accvgpr_read_b32 v54, a66
    v_accvgpr_read_b32 v55, a67
    v_accvgpr_read_b32 v56, a68
    v_accvgpr_read_b32 v57, a69
    v_accvgpr_read_b32 v58, a70
    v_accvgpr_read_b32 v59, a71
    v_mul_f32 v52, v52, v49
    v_mul_f32 v53, v53, v49
    v_mul_f32 v54, v54, v49
    v_mul_f32 v55, v55, v49
    v_mul_f32 v56, v56, v49
    v_mul_f32 v57, v57, v49
    v_mul_f32 v58, v58, v49
    v_mul_f32 v59, v59, v49
    v_accvgpr_write_b32 a64, v52
    v_accvgpr_write_b32 a65, v53
    v_accvgpr_write_b32 a66, v54
    v_accvgpr_write_b32 a67, v55
    v_accvgpr_write_b32 a68, v56
    v_accvgpr_write_b32 a69, v57
    v_accvgpr_write_b32 a70, v58
    v_accvgpr_write_b32 a71, v59
    v_accvgpr_read_b32 v52, a72
    v_accvgpr_read_b32 v53, a73
    v_accvgpr_read_b32 v54, a74
    v_accvgpr_read_b32 v55, a75
    v_accvgpr_read_b32 v56, a76
    v_accvgpr_read_b32 v57, a77
    v_accvgpr_read_b32 v58, a78
    v_accvgpr_read_b32 v59, a79
    v_mul_f32 v52, v52, v49
    v_mul_f32 v53, v53, v49
    v_mul_f32 v54, v54, v49
    v_mul_f32 v55, v55, v49
    v_mul_f32 v56, v56, v49
    v_mul_f32 v57, v57, v49
    v_mul_f32 v58, v58, v49
    v_mul_f32 v59, v59, v49
    v_accvgpr_write_b32 a72, v52
    v_accvgpr_write_b32 a73, v53
    v_accvgpr_write_b32 a74, v54
    v_accvgpr_write_b32 a75, v55
    v_accvgpr_write_b32 a76, v56
    v_accvgpr_write_b32 a77, v57
    v_accvgpr_write_b32 a78, v58
    v_accvgpr_write_b32 a79, v59
    v_accvgpr_read_b32 v52, a80
    v_accvgpr_read_b32 v53, a81
    v_accvgpr_read_b32 v54, a82
    v_accvgpr_read_b32 v55, a83
    v_accvgpr_read_b32 v56, a84
    v_accvgpr_read_b32 v57, a85
    v_accvgpr_read_b32 v58, a86
    v_accvgpr_read_b32 v59, a87
    v_mul_f32 v52, v52, v49
    v_mul_f32 v53, v53, v49
    v_mul_f32 v54, v54, v49
    v_mul_f32 v55, v55, v49
    v_mul_f32 v56, v56, v49
    v_mul_f32 v57, v57, v49
    v_mul_f32 v58, v58, v49
    v_mul_f32 v59, v59, v49
    v_accvgpr_write_b32 a80, v52
    v_accvgpr_write_b32 a81, v53
    v_accvgpr_write_b32 a82, v54
    v_accvgpr_write_b32 a83, v55
    v_accvgpr_write_b32 a84, v56
    v_accvgpr_write_b32 a85, v57
    v_accvgpr_write_b32 a86, v58
    v_accvgpr_write_b32 a87, v59
    v_accvgpr_read_b32 v52, a88
    v_accvgpr_read_b32 v53, a89
    v_accvgpr_read_b32 v54, a90
    v_accvgpr_read_b32 v55, a91
    v_accvgpr_read_b32 v56, a92
    v_accvgpr_read_b32 v57, a93
    v_accvgpr_read_b32 v58, a94
    v_accvgpr_read_b32 v59, a95
    v_mul_f32 v52, v52, v49
    v_mul_f32 v53, v53, v49
    v_mul_f32 v54, v54, v49
    v_mul_f32 v55, v55, v49
    v_mul_f32 v56, v56, v49
    v_mul_f32 v57, v57, v49
    v_mul_f32 v58, v58, v49
    v_mul_f32 v59, v59, v49
    v_accvgpr_write_b32 a88, v52
    v_accvgpr_write_b32 a89, v53
    v_accvgpr_write_b32 a90, v54
    v_accvgpr_write_b32 a91, v55
    v_accvgpr_write_b32 a92, v56
    v_accvgpr_write_b32 a93, v57
    v_accvgpr_write_b32 a94, v58
    v_accvgpr_write_b32 a95, v59
    v_exp_f32 v52, v112
    v_exp_f32 v53, v113
    v_exp_f32 v54, v114
    v_exp_f32 v55, v115
    v_exp_f32 v56, v116
    v_exp_f32 v57, v117
    v_exp_f32 v58, v118
    v_exp_f32 v59, v119
    s_nop 0
    v_cvt_pk_bf16_f32 v152, v52, v53
    v_cvt_pk_bf16_f32 v153, v54, v55
    v_cvt_pk_bf16_f32 v154, v56, v57
    v_cvt_pk_bf16_f32 v155, v58, v59
    s_nop 1
    v_mfma_f32_16x16x32_bf16 v[36:39], v[44:47], v[152:155], 0
    v_max3_f32 v48, v120, v121, v122
    v_max3_f32 v48, v48, v123, v124
    v_max3_f32 v48, v48, v125, v126
    v_max3_f32 v48, v48, v127, 0
    v_mov_b32 v49, v48
    s_nop 1
    v_permlane32_swap_b32 v48, v49
    s_nop 1
    v_max_f32 v48, v48, v49
    v_mov_b32 v49, v48
    s_nop 1
    v_permlane16_swap_b32 v48, v49
    s_nop 1
    v_max_f32 v48, v48, v49
    v_exp_f32 v49, -v48
    v_sub_f32 v120, v120, v48
    v_sub_f32 v121, v121, v48
    v_sub_f32 v122, v122, v48
    v_sub_f32 v123, v123, v48
    v_sub_f32 v124, v124, v48
    v_sub_f32 v125, v125, v48
    v_sub_f32 v126, v126, v48
    v_sub_f32 v127, v127, v48
    v_sub_f32 v88, v88, v48
    v_sub_f32 v89, v89, v48
    v_sub_f32 v90, v90, v48
    v_sub_f32 v91, v91, v48
    v_sub_f32 v92, v92, v48
    v_sub_f32 v93, v93, v48
    v_sub_f32 v94, v94, v48
    v_sub_f32 v95, v95, v48
    v_sub_f32 v184, v184, v48
    v_sub_f32 v185, v185, v48
    v_sub_f32 v186, v186, v48
    v_sub_f32 v187, v187, v48
    v_sub_f32 v188, v188, v48
    v_sub_f32 v189, v189, v48
    v_sub_f32 v190, v190, v48
    v_sub_f32 v191, v191, v48
    v_mul_f32 v15, v15, v49
    v_accvgpr_read_b32 v52, a96
    v_accvgpr_read_b32 v53, a97
    v_accvgpr_read_b32 v54, a98
    v_accvgpr_read_b32 v55, a99
    v_accvgpr_read_b32 v56, a100
    v_accvgpr_read_b32 v57, a101
    v_accvgpr_read_b32 v58, a102
    v_accvgpr_read_b32 v59, a103
    v_mul_f32 v52, v52, v49
    v_mul_f32 v53, v53, v49
    v_mul_f32 v54, v54, v49
    v_mul_f32 v55, v55, v49
    v_mul_f32 v56, v56, v49
    v_mul_f32 v57, v57, v49
    v_mul_f32 v58, v58, v49
    v_mul_f32 v59, v59, v49
    v_accvgpr_write_b32 a96, v52
    v_accvgpr_write_b32 a97, v53
    v_accvgpr_write_b32 a98, v54
    v_accvgpr_write_b32 a99, v55
    v_accvgpr_write_b32 a100, v56
    v_accvgpr_write_b32 a101, v57
    v_accvgpr_write_b32 a102, v58
    v_accvgpr_write_b32 a103, v59
    v_accvgpr_read_b32 v52, a104
    v_accvgpr_read_b32 v53, a105
    v_accvgpr_read_b32 v54, a106
    v_accvgpr_read_b32 v55, a107
    v_accvgpr_read_b32 v56, a108
    v_accvgpr_read_b32 v57, a109
    v_accvgpr_read_b32 v58, a110
    v_accvgpr_read_b32 v59, a111
    v_mul_f32 v52, v52, v49
    v_mul_f32 v53, v53, v49
    v_mul_f32 v54, v54, v49
    v_mul_f32 v55, v55, v49
    v_mul_f32 v56, v56, v49
    v_mul_f32 v57, v57, v49
    v_mul_f32 v58, v58, v49
    v_mul_f32 v59, v59, v49
    v_accvgpr_write_b32 a104, v52
    v_accvgpr_write_b32 a105, v53
    v_accvgpr_write_b32 a106, v54
    v_accvgpr_write_b32 a107, v55
    v_accvgpr_write_b32 a108, v56
    v_accvgpr_write_b32 a109, v57
    v_accvgpr_write_b32 a110, v58
    v_accvgpr_write_b32 a111, v59
    v_accvgpr_read_b32 v52, a112
    v_accvgpr_read_b32 v53, a113
    v_accvgpr_read_b32 v54, a114
    v_accvgpr_read_b32 v55, a115
    v_accvgpr_read_b32 v56, a116
    v_accvgpr_read_b32 v57, a117
    v_accvgpr_read_b32 v58, a118
    v_accvgpr_read_b32 v59, a119
    v_mul_f32 v52, v52, v49
    v_mul_f32 v53, v53, v49
    v_mul_f32 v54, v54, v49
    v_mul_f32 v55, v55, v49
    v_mul_f32 v56, v56, v49
    v_mul_f32 v57, v57, v49
    v_mul_f32 v58, v58, v49
    v_mul_f32 v59, v59, v49
    v_accvgpr_write_b32 a112, v52
    v_accvgpr_write_b32 a113, v53
    v_accvgpr_write_b32 a114, v54
    v_accvgpr_write_b32 a115, v55
    v_accvgpr_write_b32 a116, v56
    v_accvgpr_write_b32 a117, v57
    v_accvgpr_write_b32 a118, v58
    v_accvgpr_write_b32 a119, v59
    v_accvgpr_read_b32 v52, a120
    v_accvgpr_read_b32 v53, a121
    v_accvgpr_read_b32 v54, a122
    v_accvgpr_read_b32 v55, a123
    v_accvgpr_read_b32 v56, a124
    v_accvgpr_read_b32 v57, a125
    v_accvgpr_read_b32 v58, a126
    v_accvgpr_read_b32 v59, a127
    v_mul_f32 v52, v52, v49
    v_mul_f32 v53, v53, v49
    v_mul_f32 v54, v54, v49
    v_mul_f32 v55, v55, v49
    v_mul_f32 v56, v56, v49
    v_mul_f32 v57, v57, v49
    v_mul_f32 v58, v58, v49
    v_mul_f32 v59, v59, v49
    v_accvgpr_write_b32 a120, v52
    v_accvgpr_write_b32 a121, v53
    v_accvgpr_write_b32 a122, v54
    v_accvgpr_write_b32 a123, v55
    v_accvgpr_write_b32 a124, v56
    v_accvgpr_write_b32 a125, v57
    v_accvgpr_write_b32 a126, v58
    v_accvgpr_write_b32 a127, v59
    v_exp_f32 v52, v120
    v_exp_f32 v53, v121
    v_exp_f32 v54, v122
    v_exp_f32 v55, v123
    v_exp_f32 v56, v124
    v_exp_f32 v57, v125
    v_exp_f32 v58, v126
    v_exp_f32 v59, v127
    s_nop 0
    v_cvt_pk_bf16_f32 v156, v52, v53
    v_cvt_pk_bf16_f32 v157, v54, v55
    v_cvt_pk_bf16_f32 v158, v56, v57
    v_cvt_pk_bf16_f32 v159, v58, v59
    s_nop 1
    v_mfma_f32_16x16x32_bf16 v[40:43], v[44:47], v[156:159], 0
    s_nop 7
    s_setpc_b64 s[74:75]
m_hook14:
    s_cmp_lg_u32 s16, 0
    s_cbranch_scc1 m_np38
    v_mov_b32 v4, s4
    v_mov_b32 v5, s5
    s_add_u32 s90, s17, 117440512
    s_mov_b64 exec, 1
    buffer_store_dwordx2 v[4:5], off, s[8:11], s90 sc1
    s_mov_b64 exec, -1
m_np38:
    s_mov_b32 s17, -1
    s_branch m_hookr15
m_hook18:
    s_cmp_lg_u32 s16, 0
    s_cbranch_scc1 m_np39
    v_mov_b32 v4, s4
    v_mov_b32 v5, s5
    s_add_u32 s90, s17, 117440512
    s_mov_b64 exec, 1
    buffer_store_dwordx2 v[4:5], off, s[8:11], s90 sc1
    s_mov_b64 exec, -1
m_np39:
    s_mov_b32 s17, -1
    s_branch m_hookr19
m_dosw17:
    s_cmp_eq_u32 s94, 0
    s_cbranch_scc1 m_x40
    s_cmp_lg_u32 s65, 3
    s_cbranch_scc1 m_x46
    s_mov_b32 s42, s73
    s_lshl_b32 s90, s77, 4
    s_lshl_b32 s90, s90, s81
    s_mov_b32 s48, s79
    s_mul_i32 s91, s90, 1
    s_add_u32 s49, s91, s79
    s_sub_u32 s49, s49, 2048
    s_mul_i32 s91, s90, 2
    s_add_u32 s50, s91, s79
    s_mul_i32 s91, s90, 3
    s_add_u32 s51, s91, s79
    s_sub_u32 s51, s51, 2048
    s_lshl_b32 s90, s58, 7
    s_add_u32 s90, s90, s57
    s_lshl_b32 s91, s16, 6
    s_cmp_eq_u32 s81, 1
    s_cselect_b32 s90, s90, s91
    v_lshrrev_b32 v24, 3, v1
    v_lshlrev_b32 v24, s81, v24
    v_add_u32 v24, s90, v24
    v_mul_lo_u32 v24, v24, s77
    v_lshrrev_b32 v25, 4, v1
    v_and_b32 v26, 7, v1
    v_xor_b32 v25, v25, v26
    v_lshl_add_u32 v16, v25, 4, v24
    v_xor_b32 v25, 4, v25
    v_lshl_add_u32 v17, v25, 4, v24
    s_lshl_b32 s90, s77, 3
    s_lshl_b32 s90, s90, s81
    s_sub_u32 s90, s90, 1024
    v_add_u32 v17, s90, v17
    s_mov_b32 s40, s71
    s_mov_b32 s41, s72
    buffer_load_dwordx2 v[4:5], off, s[12:15], 0 sc1
    s_branch m_loop16
m_x46:
    s_mov_b32 s46, s76
    s_mov_b32 s52, s80
    s_lshl_b32 s90, s78, 2
    s_mul_i32 s91, s90, 1
    s_add_u32 s53, s91, s80
    s_sub_u32 s53, s53, 2048
    s_mul_i32 s91, s90, 2
    s_add_u32 s54, s91, s80
    s_mul_i32 s91, s90, 3
    s_add_u32 s55, s91, s80
    s_sub_u32 s55, s55, 2048
    s_lshl_b32 s56, s78, 6
    v_lshrrev_b32 v24, 5, v1
    s_lshl_b32 s90, s16, 4
    v_add_u32 v25, s90, v24
    v_mul_lo_u32 v25, v25, s78
    v_lshlrev_b32 v24, 1, v24
    v_and_b32 v26, 31, v1
    v_xor_b32 v24, v24, v26
    s_lshl_b32 s90, s78, 1
    s_sub_u32 s90, s90, 1024
    v_add_u32 v27, s90, v25
    v_xor_b32 v26, 0, v24
    v_lshl_add_u32 v18, v26, 4, v25
    v_xor_b32 v26, 4, v24
    v_lshl_add_u32 v19, v26, 4, v27
    v_xor_b32 v26, 8, v24
    v_lshl_add_u32 v20, v26, 4, v25
    v_xor_b32 v26, 12, v24
    v_lshl_add_u32 v21, v26, 4, v27
    s_mov_b32 s44, s74
    s_mov_b32 s45, s75
    s_mov_b32 s67, 0
    s_branch m_loop16
m_x40:
    s_cmp_eq_u32 s70, 1
    s_cbranch_scc1 m_x45
    s_cmp_le_u32 s65, 4
    s_cbranch_scc1 m_x41
    s_cmp_lg_u32 s16, 0
    s_cbranch_scc1 m_np47
    v_mov_b32 v4, s4
    v_mov_b32 v5, s5
    s_add_u32 s90, s17, 117440512
    s_mov_b64 exec, 1
    buffer_store_dwordx2 v[4:5], off, s[8:11], s90 sc1
    s_mov_b64 exec, -1
m_np47:
    s_mov_b32 s17, -1
    s_mov_b32 s67, 4
    s_branch m_loop16
m_x41:
    s_cmp_lg_u32 s65, 4
    s_cbranch_scc1 m_x42
    s_and_b32 s92, s2, 7
    s_lshl_b32 s92, s92, 2
    s_bfe_u32 s93, s2, 0x20003
    s_add_u32 s92, s92, s93
    s_lshr_b32 s93, s2, 5
    s_lshl_b32 s93, s93, 2
    s_or_b32 s93, s93, 0x40000
    s_lshr_b32 s90, s92, 1
    s_lshl_b32 s90, s90, 7
    s_add_u32 s90, s90, 117440512
    v_and_b32 v0, 3, v1
    v_min_u32 v0, 2, v0
    v_and_b32 v4, 4, v1
    v_add3_u32 v0, v0, v4, 8
    v_lshlrev_b32 v0, 3, v0
    buffer_load_dwordx2 v[4:5], v0, s[8:11], s90 offen sc1
    s_branch m_loop16
m_x42:
    s_waitcnt vmcnt(16)
    s_cmp_lg_u32 s65, 3
    s_cbranch_scc1 m_x43
    s_mov_b32 s3, 1048576
m_spin48:
    v_cmp_ne_u64 s[22:23], s[4:5], v[4:5]
    s_nop 3
    s_cmp_eq_u64 s[22:23], 0
    s_cbranch_scc1 m_ok49
    s_sub_u32 s3, s3, 1
    s_cbranch_scc1 m_ok49
    s_sleep 16
    s_and_b32 s92, s2, 7
    s_lshl_b32 s92, s92, 2
    s_bfe_u32 s93, s2, 0x20003
    s_add_u32 s92, s92, s93
    s_lshr_b32 s93, s2, 5
    s_lshl_b32 s93, s93, 2
    s_or_b32 s93, s93, 0x40000
    s_lshr_b32 s90, s92, 1
    s_lshl_b32 s90, s90, 7
    s_add_u32 s90, s90, 117440512
    v_and_b32 v0, 3, v1
    v_min_u32 v0, 2, v0
    v_and_b32 v4, 4, v1
    v_add3_u32 v0, v0, v4, 8
    v_lshlrev_b32 v0, 3, v0
    buffer_load_dwordx2 v[4:5], v0, s[8:11], s90 offen sc1
    s_waitcnt vmcnt(0)
    s_branch m_spin48
m_ok49:
    s_and_b32 s92, s2, 7
    s_lshl_b32 s92, s92, 2
    s_bfe_u32 s93, s2, 0x20003
    s_add_u32 s92, s92, s93
    s_lshr_b32 s93, s2, 5
    s_lshl_b32 s93, s93, 2
    s_or_b32 s93, s93, 0x40000
    s_lshl_b32 s90, s92, 19
    s_lshl_b32 s91, s58, 13
    s_add_u32 s90, s90, s91
    s_cmp_eq_u32 s57, 0
    s_mov_b32 s91, 33554432
    s_cselect_b32 s91, 16777216, s91
    s_mov_b32 s42, 0
    s_cselect_b32 s42, 268435456, s42
    s_add_u32 s48, s90, s91
    s_mov_b32 s49, s48
    s_add_u32 s50, s48, 4096
    s_mov_b32 s51, s50
    s_mov_b32 s40, s6
    s_mov_b32 s41, s7
    v_mov_b32 v16, v2
    v_mov_b32 v17, v2
    s_branch m_loop16
m_x43:
    s_cmp_lg_u32 s65, 2
    s_cbranch_scc1 m_x44
    s_and_b32 s92, s2, 7
    s_lshl_b32 s92, s92, 2
    s_bfe_u32 s93, s2, 0x20003
    s_add_u32 s92, s92, s93
    s_lshr_b32 s93, s2, 5
    s_lshl_b32 s93, s93, 2
    s_or_b32 s93, s93, 0x40000
    s_lshr_b32 s90, s92, 1
    s_lshl_b32 s90, s90, 7
    s_add_u32 s90, s90, 117440512
    s_bfe_u32 s91, 873473623, s93
    s_lshr_b32 s91, s91, 1
    v_mov_b32 v0, s91
    s_bfe_u32 s91, 4225681832, s93
    s_lshr_b32 s91, s91, 1
    v_writelane_b32 v0, s91, 8
    v_lshlrev_b32 v0, 3, v0
    buffer_load_dwordx2 v[4:5], v0, s[8:11], s90 offen sc1
    s_lshl_b32 s90, s92, 19
    s_lshl_b32 s91, s58, 13
    s_add_u32 s90, s90, s91
    s_cmp_eq_u32 s57, 0
    s_mov_b32 s91, 33554432
    s_cselect_b32 s91, 16793600, s91
    s_mov_b32 s42, 268435456
    s_cselect_b32 s42, 268435456, s42
    s_add_u32 s48, s90, s91
    s_mov_b32 s49, s48
    s_add_u32 s50, s48, 4096
    s_mov_b32 s51, s50
    s_mov_b32 s40, s6
    s_mov_b32 s41, s7
    s_lshl_b32 s90, s92, 19
    s_lshl_b32 s91, s58, 13
    s_add_u32 s90, s90, s91
    s_cmp_eq_u32 s57, 0
    s_mov_b32 s91, 33587200
    s_cselect_b32 s91, 16826368, s91
    s_mov_b32 s46, 268435456
    s_cselect_b32 s46, 268435456, s46
    s_add_u32 s52, s90, s91
    s_mov_b32 s53, s52
    s_add_u32 s54, s52, 4096
    s_mov_b32 s55, s54
    s_mov_b32 s44, s6
    s_mov_b32 s45, s7
    v_mov_b32 v18, v2
    v_mov_b32 v19, v2
    v_mov_b32 v20, v2
    v_mov_b32 v21, v2
    s_branch m_loop16
m_x44:
    s_mov_b32 s3, 1048576
m_spin50:
    v_cmp_ne_u64 s[22:23], s[4:5], v[4:5]
    s_nop 3
    s_cmp_eq_u64 s[22:23], 0
    s_cbranch_scc1 m_ok51
    s_sub_u32 s3, s3, 1
    s_cbranch_scc1 m_ok51
    s_sleep 16
    s_and_b32 s92, s2, 7
    s_lshl_b32 s92, s92, 2
    s_bfe_u32 s93, s2, 0x20003
    s_add_u32 s92, s92, s93
    s_lshr_b32 s93, s2, 5
    s_lshl_b32 s93, s93, 2
    s_or_b32 s93, s93, 0x40000
    s_lshr_b32 s90, s92, 1
    s_lshl_b32 s90, s90, 7
    s_add_u32 s90, s90, 117440512
    s_bfe_u32 s91, 873473623, s93
    s_lshr_b32 s91, s91, 1
    v_mov_b32 v0, s91
    s_bfe_u32 s91, 4225681832, s93
    s_lshr_b32 s91, s91, 1
    v_writelane_b32 v0, s91, 8
    v_lshlrev_b32 v0, 3, v0
    buffer_load_dwordx2 v[4:5], v0, s[8:11], s90 offen sc1
    s_waitcnt vmcnt(0)
    s_branch m_spin50
m_ok51:
    s_and_b32 s92, s2, 7
    s_lshl_b32 s92, s92, 2
    s_bfe_u32 s93, s2, 0x20003
    s_add_u32 s92, s92, s93
    s_lshr_b32 s93, s2, 5
    s_lshl_b32 s93, s93, 2
    s_or_b32 s93, s93, 0x40000
    s_bfe_u32 s90, 4225681832, s93
    s_lshl_b32 s90, s90, 3
    s_lshl_b32 s91, s16, 1
    s_add_u32 s90, s90, s91
    s_lshl_b32 s90, s90, 12
    s_lshl_b32 s91, s92, 19
    s_add_u32 s90, s90, s91
    s_add_u32 s90, s90, 0
    buffer_load_dwordx4 a[128:131], v2, s[8:11], s90 offen offset:0 sc1
    buffer_load_dwordx4 a[132:135], v2, s[8:11], s90 offen offset:1024 sc1
    buffer_load_dwordx4 a[136:139], v2, s[8:11], s90 offen offset:2048 sc1
    buffer_load_dwordx4 a[140:143], v2, s[8:11], s90 offen offset:3072 sc1
    s_bfe_u32 s90, 4225681832, s93
    s_lshl_b32 s90, s90, 3
    s_lshl_b32 s91, s16, 1
    s_add_u32 s90, s90, s91
    s_lshl_b32 s90, s90, 12
    s_lshl_b32 s91, s92, 19
    s_add_u32 s90, s90, s91
    s_add_u32 s90, s90, 4096
    buffer_load_dwordx4 a[144:147], v2, s[8:11], s90 offen offset:0 sc1
    buffer_load_dwordx4 a[148:151], v2, s[8:11], s90 offen offset:1024 sc1
    buffer_load_dwordx4 a[152:155], v2, s[8:11], s90 offen offset:2048 sc1
    buffer_load_dwordx4 a[156:159], v2, s[8:11], s90 offen offset:3072 sc1
    s_bfe_u32 s90, 873473623, s93
    s_lshl_b32 s90, s90, 3
    s_lshl_b32 s91, s16, 1
    s_add_u32 s90, s90, s91
    s_lshl_b32 s90, s90, 12
    s_lshl_b32 s91, s92, 19
    s_add_u32 s90, s90, s91
    s_add_u32 s90, s90, 0
    buffer_load_dwordx4 a[160:163], v2, s[8:11], s90 offen offset:0 sc1
    buffer_load_dwordx4 a[164:167], v2, s[8:11], s90 offen offset:1024 sc1
    buffer_load_dwordx4 a[168:171], v2, s[8:11], s90 offen offset:2048 sc1
    buffer_load_dwordx4 a[172:175], v2, s[8:11], s90 offen offset:3072 sc1
    s_bfe_u32 s90, 873473623, s93
    s_lshl_b32 s90, s90, 3
    s_lshl_b32 s91, s16, 1
    s_add_u32 s90, s90, s91
    s_lshl_b32 s90, s90, 12
    s_lshl_b32 s91, s92, 19
    s_add_u32 s90, s90, s91
    s_add_u32 s90, s90, 4096
    buffer_load_dwordx4 a[176:179], v2, s[8:11], s90 offen offset:0 sc1
    buffer_load_dwordx4 a[180:183], v2, s[8:11], s90 offen offset:1024 sc1
    buffer_load_dwordx4 a[184:187], v2, s[8:11], s90 offen offset:2048 sc1
    buffer_load_dwordx4 a[188:191], v2, s[8:11], s90 offen offset:3072 sc1
    s_lshl_b32 s90, s92, 19
    s_lshl_b32 s91, s58, 13
    s_add_u32 s90, s90, s91
    s_cmp_eq_u32 s57, 0
    s_mov_b32 s91, 33570816
    s_cselect_b32 s91, 16809984, s91
    s_mov_b32 s42, 268435456
    s_cselect_b32 s42, 268435456, s42
    s_add_u32 s48, s90, s91
    s_mov_b32 s49, s48
    s_add_u32 s50, s48, 4096
    s_mov_b32 s51, s50
    s_mov_b32 s40, s6
    s_mov_b32 s41, s7
    s_lshl_b32 s90, s92, 19
    s_lshl_b32 s91, s58, 13
    s_add_u32 s90, s90, s91
    s_cmp_eq_u32 s57, 0
    s_mov_b32 s91, 33603584
    s_cselect_b32 s91, 16842752, s91
    s_mov_b32 s46, 268435456
    s_cselect_b32 s46, 268435456, s46
    s_add_u32 s52, s90, s91
    s_mov_b32 s53, s52
    s_add_u32 s54, s52, 4096
    s_mov_b32 s55, s54
    s_mov_b32 s44, s6
    s_mov_b32 s45, s7
    s_branch m_loop16
m_x45:
    s_mov_b32 s42, 0
    s_cmp_eq_u32 s65, 3
    s_cbranch_scc1 m_loop16
    s_mov_b32 s46, 0
    s_branch m_loop16
m_dosw21:
    s_cmp_eq_u32 s94, 0
    s_cbranch_scc1 m_x52
    s_cmp_lg_u32 s65, 3
    s_cbranch_scc1 m_x58
    s_mov_b32 s42, s73
    s_lshl_b32 s90, s77, 4
    s_lshl_b32 s90, s90, s81
    s_mov_b32 s48, s79
    s_mul_i32 s91, s90, 1
    s_add_u32 s49, s91, s79
    s_sub_u32 s49, s49, 2048
    s_mul_i32 s91, s90, 2
    s_add_u32 s50, s91, s79
    s_mul_i32 s91, s90, 3
    s_add_u32 s51, s91, s79
    s_sub_u32 s51, s51, 2048
    s_lshl_b32 s90, s58, 7
    s_add_u32 s90, s90, s57
    s_lshl_b32 s91, s16, 6
    s_cmp_eq_u32 s81, 1
    s_cselect_b32 s90, s90, s91
    v_lshrrev_b32 v24, 3, v1
    v_lshlrev_b32 v24, s81, v24
    v_add_u32 v24, s90, v24
    v_mul_lo_u32 v24, v24, s77
    v_lshrrev_b32 v25, 4, v1
    v_and_b32 v26, 7, v1
    v_xor_b32 v25, v25, v26
    v_lshl_add_u32 v16, v25, 4, v24
    v_xor_b32 v25, 4, v25
    v_lshl_add_u32 v17, v25, 4, v24
    s_lshl_b32 s90, s77, 3
    s_lshl_b32 s90, s90, s81
    s_sub_u32 s90, s90, 1024
    v_add_u32 v17, s90, v17
    s_mov_b32 s40, s71
    s_mov_b32 s41, s72
    buffer_load_dwordx2 v[4:5], off, s[12:15], 0 sc1
    s_branch m_loop20
m_x58:
    s_mov_b32 s46, s76
    s_mov_b32 s52, s80
    s_lshl_b32 s90, s78, 2
    s_mul_i32 s91, s90, 1
    s_add_u32 s53, s91, s80
    s_sub_u32 s53, s53, 2048
    s_mul_i32 s91, s90, 2
    s_add_u32 s54, s91, s80
    s_mul_i32 s91, s90, 3
    s_add_u32 s55, s91, s80
    s_sub_u32 s55, s55, 2048
    s_lshl_b32 s56, s78, 6
    v_lshrrev_b32 v24, 5, v1
    s_lshl_b32 s90, s16, 4
    v_add_u32 v25, s90, v24
    v_mul_lo_u32 v25, v25, s78
    v_lshlrev_b32 v24, 1, v24
    v_and_b32 v26, 31, v1
    v_xor_b32 v24, v24, v26
    s_lshl_b32 s90, s78, 1
    s_sub_u32 s90, s90, 1024
    v_add_u32 v27, s90, v25
    v_xor_b32 v26, 0, v24
    v_lshl_add_u32 v18, v26, 4, v25
    v_xor_b32 v26, 4, v24
    v_lshl_add_u32 v19, v26, 4, v27
    v_xor_b32 v26, 8, v24
    v_lshl_add_u32 v20, v26, 4, v25
    v_xor_b32 v26, 12, v24
    v_lshl_add_u32 v21, v26, 4, v27
    s_mov_b32 s44, s74
    s_mov_b32 s45, s75
    s_mov_b32 s67, 0
    s_branch m_loop20
m_x52:
    s_cmp_eq_u32 s70, 1
    s_cbranch_scc1 m_x57
    s_cmp_le_u32 s65, 4
    s_cbranch_scc1 m_x53
    s_cmp_lg_u32 s16, 0
    s_cbranch_scc1 m_np59
    v_mov_b32 v4, s4
    v_mov_b32 v5, s5
    s_add_u32 s90, s17, 117440512
    s_mov_b64 exec, 1
    buffer_store_dwordx2 v[4:5], off, s[8:11], s90 sc1
    s_mov_b64 exec, -1
m_np59:
    s_mov_b32 s17, -1
    s_mov_b32 s67, 4
    s_branch m_loop20
m_x53:
    s_cmp_lg_u32 s65, 4
    s_cbranch_scc1 m_x54
    s_and_b32 s92, s2, 7
    s_lshl_b32 s92, s92, 2
    s_bfe_u32 s93, s2, 0x20003
    s_add_u32 s92, s92, s93
    s_lshr_b32 s93, s2, 5
    s_lshl_b32 s93, s93, 2
    s_or_b32 s93, s93, 0x40000
    s_lshr_b32 s90, s92, 1
    s_lshl_b32 s90, s90, 7
    s_add_u32 s90, s90, 117440512
    v_and_b32 v0, 3, v1
    v_min_u32 v0, 2, v0
    v_and_b32 v4, 4, v1
    v_add3_u32 v0, v0, v4, 8
    v_lshlrev_b32 v0, 3, v0
    buffer_load_dwordx2 v[4:5], v0, s[8:11], s90 offen sc1
    s_branch m_loop20
m_x54:
    s_waitcnt vmcnt(16)
    s_cmp_lg_u32 s65, 3
    s_cbranch_scc1 m_x55
    s_mov_b32 s3, 1048576
m_spin60:
    v_cmp_ne_u64 s[22:23], s[4:5], v[4:5]
    s_nop 3
    s_cmp_eq_u64 s[22:23], 0
    s_cbranch_scc1 m_ok61
    s_sub_u32 s3, s3, 1
    s_cbranch_scc1 m_ok61
    s_sleep 16
    s_and_b32 s92, s2, 7
    s_lshl_b32 s92, s92, 2
    s_bfe_u32 s93, s2, 0x20003
    s_add_u32 s92, s92, s93
    s_lshr_b32 s93, s2, 5
    s_lshl_b32 s93, s93, 2
    s_or_b32 s93, s93, 0x40000
    s_lshr_b32 s90, s92, 1
    s_lshl_b32 s90, s90, 7
    s_add_u32 s90, s90, 117440512
    v_and_b32 v0, 3, v1
    v_min_u32 v0, 2, v0
    v_and_b32 v4, 4, v1
    v_add3_u32 v0, v0, v4, 8
    v_lshlrev_b32 v0, 3, v0
    buffer_load_dwordx2 v[4:5], v0, s[8:11], s90 offen sc1
    s_waitcnt vmcnt(0)
    s_branch m_spin60
m_ok61:
    s_and_b32 s92, s2, 7
    s_lshl_b32 s92, s92, 2
    s_bfe_u32 s93, s2, 0x20003
    s_add_u32 s92, s92, s93
    s_lshr_b32 s93, s2, 5
    s_lshl_b32 s93, s93, 2
    s_or_b32 s93, s93, 0x40000
    s_lshl_b32 s90, s92, 19
    s_lshl_b32 s91, s58, 13
    s_add_u32 s90, s90, s91
    s_cmp_eq_u32 s57, 0
    s_mov_b32 s91, 33554432
    s_cselect_b32 s91, 16777216, s91
    s_mov_b32 s42, 0
    s_cselect_b32 s42, 268435456, s42
    s_add_u32 s48, s90, s91
    s_mov_b32 s49, s48
    s_add_u32 s50, s48, 4096
    s_mov_b32 s51, s50
    s_mov_b32 s40, s6
    s_mov_b32 s41, s7
    v_mov_b32 v16, v2
    v_mov_b32 v17, v2
    s_branch m_loop20
m_x55:
    s_cmp_lg_u32 s65, 2
    s_cbranch_scc1 m_x56
    s_and_b32 s92, s2, 7
    s_lshl_b32 s92, s92, 2
    s_bfe_u32 s93, s2, 0x20003
    s_add_u32 s92, s92, s93
    s_lshr_b32 s93, s2, 5
    s_lshl_b32 s93, s93, 2
    s_or_b32 s93, s93, 0x40000
    s_lshr_b32 s90, s92, 1
    s_lshl_b32 s90, s90, 7
    s_add_u32 s90, s90, 117440512
    s_bfe_u32 s91, 873473623, s93
    s_lshr_b32 s91, s91, 1
    v_mov_b32 v0, s91
    s_bfe_u32 s91, 4225681832, s93
    s_lshr_b32 s91, s91, 1
    v_writelane_b32 v0, s91, 8
    v_lshlrev_b32 v0, 3, v0
    buffer_load_dwordx2 v[4:5], v0, s[8:11], s90 offen sc1
    s_lshl_b32 s90, s92, 19
    s_lshl_b32 s91, s58, 13
    s_add_u32 s90, s90, s91
    s_cmp_eq_u32 s57, 0
    s_mov_b32 s91, 33554432
    s_cselect_b32 s91, 16793600, s91
    s_mov_b32 s42, 268435456
    s_cselect_b32 s42, 268435456, s42
    s_add_u32 s48, s90, s91
    s_mov_b32 s49, s48
    s_add_u32 s50, s48, 4096
    s_mov_b32 s51, s50
    s_mov_b32 s40, s6
    s_mov_b32 s41, s7
    s_lshl_b32 s90, s92, 19
    s_lshl_b32 s91, s58, 13
    s_add_u32 s90, s90, s91
    s_cmp_eq_u32 s57, 0
    s_mov_b32 s91, 33587200
    s_cselect_b32 s91, 16826368, s91
    s_mov_b32 s46, 268435456
    s_cselect_b32 s46, 268435456, s46
    s_add_u32 s52, s90, s91
    s_mov_b32 s53, s52
    s_add_u32 s54, s52, 4096
    s_mov_b32 s55, s54
    s_mov_b32 s44, s6
    s_mov_b32 s45, s7
    v_mov_b32 v18, v2
    v_mov_b32 v19, v2
    v_mov_b32 v20, v2
    v_mov_b32 v21, v2
    s_branch m_loop20
m_x56:
    s_mov_b32 s3, 1048576
m_spin62:
    v_cmp_ne_u64 s[22:23], s[4:5], v[4:5]
    s_nop 3
    s_cmp_eq_u64 s[22:23], 0
    s_cbranch_scc1 m_ok63
    s_sub_u32 s3, s3, 1
    s_cbranch_scc1 m_ok63
    s_sleep 16
    s_and_b32 s92, s2, 7
    s_lshl_b32 s92, s92, 2
    s_bfe_u32 s93, s2, 0x20003
    s_add_u32 s92, s92, s93
    s_lshr_b32 s93, s2, 5
    s_lshl_b32 s93, s93, 2
    s_or_b32 s93, s93, 0x40000
    s_lshr_b32 s90, s92, 1
    s_lshl_b32 s90, s90, 7
    s_add_u32 s90, s90, 117440512
    s_bfe_u32 s91, 873473623, s93
    s_lshr_b32 s91, s91, 1
    v_mov_b32 v0, s91
    s_bfe_u32 s91, 4225681832, s93
    s_lshr_b32 s91, s91, 1
    v_writelane_b32 v0, s91, 8
    v_lshlrev_b32 v0, 3, v0
    buffer_load_dwordx2 v[4:5], v0, s[8:11], s90 offen sc1
    s_waitcnt vmcnt(0)
    s_branch m_spin62
m_ok63:
    s_and_b32 s92, s2, 7
    s_lshl_b32 s92, s92, 2
    s_bfe_u32 s93, s2, 0x20003
    s_add_u32 s92, s92, s93
    s_lshr_b32 s93, s2, 5
    s_lshl_b32 s93, s93, 2
    s_or_b32 s93, s93, 0x40000
    s_bfe_u32 s90, 4225681832, s93
    s_lshl_b32 s90, s90, 3
    s_lshl_b32 s91, s16, 1
    s_add_u32 s90, s90, s91
    s_lshl_b32 s90, s90, 12
    s_lshl_b32 s91, s92, 19
    s_add_u32 s90, s90, s91
    s_add_u32 s90, s90, 0
    buffer_load_dwordx4 a[128:131], v2, s[8:11], s90 offen offset:0 sc1
    buffer_load_dwordx4 a[132:135], v2, s[8:11], s90 offen offset:1024 sc1
    buffer_load_dwordx4 a[136:139], v2, s[8:11], s90 offen offset:2048 sc1
    buffer_load_dwordx4 a[140:143], v2, s[8:11], s90 offen offset:3072 sc1
    s_bfe_u32 s90, 4225681832, s93
    s_lshl_b32 s90, s90, 3
    s_lshl_b32 s91, s16, 1
    s_add_u32 s90, s90, s91
    s_lshl_b32 s90, s90, 12
    s_lshl_b32 s91, s92, 19
    s_add_u32 s90, s90, s91
    s_add_u32 s90, s90, 4096
    buffer_load_dwordx4 a[144:147], v2, s[8:11], s90 offen offset:0 sc1
    buffer_load_dwordx4 a[148:151], v2, s[8:11], s90 offen offset:1024 sc1
    buffer_load_dwordx4 a[152:155], v2, s[8:11], s90 offen offset:2048 sc1
    buffer_load_dwordx4 a[156:159], v2, s[8:11], s90 offen offset:3072 sc1
    s_bfe_u32 s90, 873473623, s93
    s_lshl_b32 s90, s90, 3
    s_lshl_b32 s91, s16, 1
    s_add_u32 s90, s90, s91
    s_lshl_b32 s90, s90, 12
    s_lshl_b32 s91, s92, 19
    s_add_u32 s90, s90, s91
    s_add_u32 s90, s90, 0
    buffer_load_dwordx4 a[160:163], v2, s[8:11], s90 offen offset:0 sc1
    buffer_load_dwordx4 a[164:167], v2, s[8:11], s90 offen offset:1024 sc1
    buffer_load_dwordx4 a[168:171], v2, s[8:11], s90 offen offset:2048 sc1
    buffer_load_dwordx4 a[172:175], v2, s[8:11], s90 offen offset:3072 sc1
    s_bfe_u32 s90, 873473623, s93
    s_lshl_b32 s90, s90, 3
    s_lshl_b32 s91, s16, 1
    s_add_u32 s90, s90, s91
    s_lshl_b32 s90, s90, 12
    s_lshl_b32 s91, s92, 19
    s_add_u32 s90, s90, s91
    s_add_u32 s90, s90, 4096
    buffer_load_dwordx4 a[176:179], v2, s[8:11], s90 offen offset:0 sc1
    buffer_load_dwordx4 a[180:183], v2, s[8:11], s90 offen offset:1024 sc1
    buffer_load_dwordx4 a[184:187], v2, s[8:11], s90 offen offset:2048 sc1
    buffer_load_dwordx4 a[188:191], v2, s[8:11], s90 offen offset:3072 sc1
    s_lshl_b32 s90, s92, 19
    s_lshl_b32 s91, s58, 13
    s_add_u32 s90, s90, s91
    s_cmp_eq_u32 s57, 0
    s_mov_b32 s91, 33570816
    s_cselect_b32 s91, 16809984, s91
    s_mov_b32 s42, 268435456
    s_cselect_b32 s42, 268435456, s42
    s_add_u32 s48, s90, s91
    s_mov_b32 s49, s48
    s_add_u32 s50, s48, 4096
    s_mov_b32 s51, s50
    s_mov_b32 s40, s6
    s_mov_b32 s41, s7
    s_lshl_b32 s90, s92, 19
    s_lshl_b32 s91, s58, 13
    s_add_u32 s90, s90, s91
    s_cmp_eq_u32 s57, 0
    s_mov_b32 s91, 33603584
    s_cselect_b32 s91, 16842752, s91
    s_mov_b32 s46, 268435456
    s_cselect_b32 s46, 268435456, s46
    s_add_u32 s52, s90, s91
    s_mov_b32 s53, s52
    s_add_u32 s54, s52, 4096
    s_mov_b32 s55, s54
    s_mov_b32 s44, s6
    s_mov_b32 s45, s7
    s_branch m_loop20
m_x57:
    s_mov_b32 s42, 0
    s_cmp_eq_u32 s65, 3
    s_cbranch_scc1 m_loop20
    s_mov_b32 s46, 0
    s_branch m_loop20
m_eps23:
    s_mov_b32 s92, s97
    s_mov_b32 s93, s97
    s_cmp_eq_u32 s97, 0
    s_cbranch_scc1 m_ns364
    s_mov_b32 s90, s98
    v_pk_mul_f32 v[32:33], v[32:33], s[92:93]
    v_pk_mul_f32 v[34:35], v[34:35], s[92:93]
    v_pk_mul_f32 v[36:37], v[36:37], s[92:93]
    v_pk_mul_f32 v[38:39], v[38:39], s[92:93]
    v_cvt_pk_bf16_f32 v32, v32, v33
    v_cvt_pk_bf16_f32 v33, v34, v35
    v_cvt_pk_bf16_f32 v34, v36, v37
    v_cvt_pk_bf16_f32 v35, v38, v39
    buffer_store_dwordx4 v[32:35], v2, s[8:11], s90 offen sc1
    s_add_u32 s90, s90, s100
    v_pk_mul_f32 v[40:41], v[40:41], s[92:93]
    v_pk_mul_f32 v[42:43], v[42:43], s[92:93]
    v_pk_mul_f32 v[44:45], v[44:45], s[92:93]
    v_pk_mul_f32 v[46:47], v[46:47], s[92:93]
    v_cvt_pk_bf16_f32 v40, v40, v41
    v_cvt_pk_bf16_f32 v41, v42, v43
    v_cvt_pk_bf16_f32 v42, v44, v45
    v_cvt_pk_bf16_f32 v43, v46, v47
    buffer_store_dwordx4 v[40:43], v2, s[8:11], s90 offen sc1
    s_add_u32 s90, s90, s100
    v_pk_mul_f32 v[48:49], v[48:49], s[92:93]
    v_pk_mul_f32 v[50:51], v[50:51], s[92:93]
    v_pk_mul_f32 v[52:53], v[52:53], s[92:93]
    v_pk_mul_f32 v[54:55], v[54:55], s[92:93]
    v_cvt_pk_bf16_f32 v48, v48, v49
    v_cvt_pk_bf16_f32 v49, v50, v51
    v_cvt_pk_bf16_f32 v50, v52, v53
    v_cvt_pk_bf16_f32 v51, v54, v55
    buffer_store_dwordx4 v[48:51], v2, s[8:11], s90 offen sc1
    s_add_u32 s90, s90, s100
    v_pk_mul_f32 v[56:57], v[56:57], s[92:93]
    v_pk_mul_f32 v[58:59], v[58:59], s[92:93]
    v_pk_mul_f32 v[60:61], v[60:61], s[92:93]
    v_pk_mul_f32 v[62:63], v[62:63], s[92:93]
    v_cvt_pk_bf16_f32 v56, v56, v57
    v_cvt_pk_bf16_f32 v57, v58, v59
    v_cvt_pk_bf16_f32 v58, v60, v61
    v_cvt_pk_bf16_f32 v59, v62, v63
    buffer_store_dwordx4 v[56:59], v2, s[8:11], s90 offen sc1
    s_add_u32 s90, s90, s100
    v_pk_mul_f32 v[64:65], v[64:65], s[92:93]
    v_pk_mul_f32 v[66:67], v[66:67], s[92:93]
    v_pk_mul_f32 v[68:69], v[68:69], s[92:93]
    v_pk_mul_f32 v[70:71], v[70:71], s[92:93]
    v_cvt_pk_bf16_f32 v64, v64, v65
    v_cvt_pk_bf16_f32 v65, v66, v67
    v_cvt_pk_bf16_f32 v66, v68, v69
    v_cvt_pk_bf16_f32 v67, v70, v71
    buffer_store_dwordx4 v[64:67], v2, s[8:11], s90 offen sc1
    s_add_u32 s90, s90, s100
    v_pk_mul_f32 v[72:73], v[72:73], s[92:93]
    v_pk_mul_f32 v[74:75], v[74:75], s[92:93]
    v_pk_mul_f32 v[76:77], v[76:77], s[92:93]
    v_pk_mul_f32 v[78:79], v[78:79], s[92:93]
    v_cvt_pk_bf16_f32 v72, v72, v73
    v_cvt_pk_bf16_f32 v73, v74, v75
    v_cvt_pk_bf16_f32 v74, v76, v77
    v_cvt_pk_bf16_f32 v75, v78, v79
    buffer_store_dwordx4 v[72:75], v2, s[8:11], s90 offen sc1
    s_add_u32 s90, s90, s100
    v_pk_mul_f32 v[80:81], v[80:81], s[92:93]
    v_pk_mul_f32 v[82:83], v[82:83], s[92:93]
    v_pk_mul_f32 v[84:85], v[84:85], s[92:93]
    v_pk_mul_f32 v[86:87], v[86:87], s[92:93]
    v_cvt_pk_bf16_f32 v80, v80, v81
    v_cvt_pk_bf16_f32 v81, v82, v83
    v_cvt_pk_bf16_f32 v82, v84, v85
    v_cvt_pk_bf16_f32 v83, v86, v87
    buffer_store_dwordx4 v[80:83], v2, s[8:11], s90 offen sc1
    s_add_u32 s90, s90, s100
    v_pk_mul_f32 v[88:89], v[88:89], s[92:93]
    v_pk_mul_f32 v[90:91], v[90:91], s[92:93]
    v_pk_mul_f32 v[92:93], v[92:93], s[92:93]
    v_pk_mul_f32 v[94:95], v[94:95], s[92:93]
    v_cvt_pk_bf16_f32 v88, v88, v89
    v_cvt_pk_bf16_f32 v89, v90, v91
    v_cvt_pk_bf16_f32 v90, v92, v93
    v_cvt_pk_bf16_f32 v91, v94, v95
    buffer_store_dwordx4 v[88:91], v2, s[8:11], s90 offen sc1
    s_add_u32 s90, s90, s100
    v_pk_mul_f32 v[96:97], v[96:97], s[92:93]
    v_pk_mul_f32 v[98:99], v[98:99], s[92:93]
    v_pk_mul_f32 v[100:101], v[100:101], s[92:93]
    v_pk_mul_f32 v[102:103], v[102:103], s[92:93]
    v_cvt_pk_bf16_f32 v96, v96, v97
    v_cvt_pk_bf16_f32 v97, v98, v99
    v_cvt_pk_bf16_f32 v98, v100, v101
    v_cvt_pk_bf16_f32 v99, v102, v103
    v_accvgpr_write_b32 a128, v96
    v_accvgpr_write_b32 a129, v97
    v_accvgpr_write_b32 a130, v98
    v_accvgpr_write_b32 a131, v99
    v_pk_mul_f32 v[104:105], v[104:105], s[92:93]
    v_pk_mul_f32 v[106:107], v[106:107], s[92:93]
    v_pk_mul_f32 v[108:109], v[108:109], s[92:93]
    v_pk_mul_f32 v[110:111], v[110:111], s[92:93]
    v_cvt_pk_bf16_f32 v104, v104, v105
    v_cvt_pk_bf16_f32 v105, v106, v107
    v_cvt_pk_bf16_f32 v106, v108, v109
    v_cvt_pk_bf16_f32 v107, v110, v111
    v_accvgpr_write_b32 a132, v104
    v_accvgpr_write_b32 a133, v105
    v_accvgpr_write_b32 a134, v106
    v_accvgpr_write_b32 a135, v107
    v_pk_mul_f32 v[112:113], v[112:113], s[92:93]
    v_pk_mul_f32 v[114:115], v[114:115], s[92:93]
    v_pk_mul_f32 v[116:117], v[116:117], s[92:93]
    v_pk_mul_f32 v[118:119], v[118:119], s[92:93]
    v_cvt_pk_bf16_f32 v112, v112, v113
    v_cvt_pk_bf16_f32 v113, v114, v115
    v_cvt_pk_bf16_f32 v114, v116, v117
    v_cvt_pk_bf16_f32 v115, v118, v119
    v_accvgpr_write_b32 a136, v112
    v_accvgpr_write_b32 a137, v113
    v_accvgpr_write_b32 a138, v114
    v_accvgpr_write_b32 a139, v115
    v_pk_mul_f32 v[120:121], v[120:121], s[92:93]
    v_pk_mul_f32 v[122:123], v[122:123], s[92:93]
    v_pk_mul_f32 v[124:125], v[124:125], s[92:93]
    v_pk_mul_f32 v[126:127], v[126:127], s[92:93]
    v_cvt_pk_bf16_f32 v120, v120, v121
    v_cvt_pk_bf16_f32 v121, v122, v123
    v_cvt_pk_bf16_f32 v122, v124, v125
    v_cvt_pk_bf16_f32 v123, v126, v127
    v_accvgpr_write_b32 a140, v120
    v_accvgpr_write_b32 a141, v121
    v_accvgpr_write_b32 a142, v122
    v_accvgpr_write_b32 a143, v123
    v_pk_mul_f32 v[128:129], v[128:129], s[92:93]
    v_pk_mul_f32 v[130:131], v[130:131], s[92:93]
    v_pk_mul_f32 v[132:133], v[132:133], s[92:93]
    v_pk_mul_f32 v[134:135], v[134:135], s[92:93]
    v_cvt_pk_bf16_f32 v128, v128, v129
    v_cvt_pk_bf16_f32 v129, v130, v131
    v_cvt_pk_bf16_f32 v130, v132, v133
    v_cvt_pk_bf16_f32 v131, v134, v135
    v_accvgpr_write_b32 a144, v128
    v_accvgpr_write_b32 a145, v129
    v_accvgpr_write_b32 a146, v130
    v_accvgpr_write_b32 a147, v131
    v_pk_mul_f32 v[136:137], v[136:137], s[92:93]
    v_pk_mul_f32 v[138:139], v[138:139], s[92:93]
    v_pk_mul_f32 v[140:141], v[140:141], s[92:93]
    v_pk_mul_f32 v[142:143], v[142:143], s[92:93]
    v_cvt_pk_bf16_f32 v136, v136, v137
    v_cvt_pk_bf16_f32 v137, v138, v139
    v_cvt_pk_bf16_f32 v138, v140, v141
    v_cvt_pk_bf16_f32 v139, v142, v143
    v_accvgpr_write_b32 a148, v136
    v_accvgpr_write_b32 a149, v137
    v_accvgpr_write_b32 a150, v138
    v_accvgpr_write_b32 a151, v139
    v_pk_mul_f32 v[144:145], v[144:145], s[92:93]
    v_pk_mul_f32 v[146:147], v[146:147], s[92:93]
    v_pk_mul_f32 v[148:149], v[148:149], s[92:93]
    v_pk_mul_f32 v[150:151], v[150:151], s[92:93]
    v_cvt_pk_bf16_f32 v144, v144, v145
    v_cvt_pk_bf16_f32 v145, v146, v147
    v_cvt_pk_bf16_f32 v146, v148, v149
    v_cvt_pk_bf16_f32 v147, v150, v151
    v_accvgpr_write_b32 a152, v144
    v_accvgpr_write_b32 a153, v145
    v_accvgpr_write_b32 a154, v146
    v_accvgpr_write_b32 a155, v147
    v_pk_mul_f32 v[152:153], v[152:153], s[92:93]
    v_pk_mul_f32 v[154:155], v[154:155], s[92:93]
    v_pk_mul_f32 v[156:157], v[156:157], s[92:93]
    v_pk_mul_f32 v[158:159], v[158:159], s[92:93]
    v_cvt_pk_bf16_f32 v152, v152, v153
    v_cvt_pk_bf16_f32 v153, v154, v155
    v_cvt_pk_bf16_f32 v154, v156, v157
    v_cvt_pk_bf16_f32 v155, v158, v159
    v_accvgpr_write_b32 a156, v152
    v_accvgpr_write_b32 a157, v153
    v_accvgpr_write_b32 a158, v154
    v_accvgpr_write_b32 a159, v155
    v_pk_mul_f32 v[160:161], v[160:161], s[92:93]
    v_pk_mul_f32 v[162:163], v[162:163], s[92:93]
    v_pk_mul_f32 v[164:165], v[164:165], s[92:93]
    v_pk_mul_f32 v[166:167], v[166:167], s[92:93]
    v_cvt_pk_bf16_f32 v160, v160, v161
    v_cvt_pk_bf16_f32 v161, v162, v163
    v_cvt_pk_bf16_f32 v162, v164, v165
    v_cvt_pk_bf16_f32 v163, v166, v167
    v_accvgpr_write_b32 a160, v160
    v_accvgpr_write_b32 a161, v161
    v_accvgpr_write_b32 a162, v162
    v_accvgpr_write_b32 a163, v163
    v_pk_mul_f32 v[168:169], v[168:169], s[92:93]
    v_pk_mul_f32 v[170:171], v[170:171], s[92:93]
    v_pk_mul_f32 v[172:173], v[172:173], s[92:93]
    v_pk_mul_f32 v[174:175], v[174:175], s[92:93]
    v_cvt_pk_bf16_f32 v168, v168, v169
    v_cvt_pk_bf16_f32 v169, v170, v171
    v_cvt_pk_bf16_f32 v170, v172, v173
    v_cvt_pk_bf16_f32 v171, v174, v175
    v_accvgpr_write_b32 a164, v168
    v_accvgpr_write_b32 a165, v169
    v_accvgpr_write_b32 a166, v170
    v_accvgpr_write_b32 a167, v171
    v_pk_mul_f32 v[176:177], v[176:177], s[92:93]
    v_pk_mul_f32 v[178:179], v[178:179], s[92:93]
    v_pk_mul_f32 v[180:181], v[180:181], s[92:93]
    v_pk_mul_f32 v[182:183], v[182:183], s[92:93]
    v_cvt_pk_bf16_f32 v176, v176, v177
    v_cvt_pk_bf16_f32 v177, v178, v179
    v_cvt_pk_bf16_f32 v178, v180, v181
    v_cvt_pk_bf16_f32 v179, v182, v183
    v_accvgpr_write_b32 a168, v176
    v_accvgpr_write_b32 a169, v177
    v_accvgpr_write_b32 a170, v178
    v_accvgpr_write_b32 a171, v179
    v_pk_mul_f32 v[184:185], v[184:185], s[92:93]
    v_pk_mul_f32 v[186:187], v[186:187], s[92:93]
    v_pk_mul_f32 v[188:189], v[188:189], s[92:93]
    v_pk_mul_f32 v[190:191], v[190:191], s[92:93]
    v_cvt_pk_bf16_f32 v184, v184, v185
    v_cvt_pk_bf16_f32 v185, v186, v187
    v_cvt_pk_bf16_f32 v186, v188, v189
    v_cvt_pk_bf16_f32 v187, v190, v191
    v_accvgpr_write_b32 a172, v184
    v_accvgpr_write_b32 a173, v185
    v_accvgpr_write_b32 a174, v186
    v_accvgpr_write_b32 a175, v187
    v_pk_mul_f32 v[192:193], v[192:193], s[92:93]
    v_pk_mul_f32 v[194:195], v[194:195], s[92:93]
    v_pk_mul_f32 v[196:197], v[196:197], s[92:93]
    v_pk_mul_f32 v[198:199], v[198:199], s[92:93]
    v_cvt_pk_bf16_f32 v192, v192, v193
    v_cvt_pk_bf16_f32 v193, v194, v195
    v_cvt_pk_bf16_f32 v194, v196, v197
    v_cvt_pk_bf16_f32 v195, v198, v199
    v_accvgpr_write_b32 a176, v192
    v_accvgpr_write_b32 a177, v193
    v_accvgpr_write_b32 a178, v194
    v_accvgpr_write_b32 a179, v195
    v_pk_mul_f32 v[200:201], v[200:201], s[92:93]
    v_pk_mul_f32 v[202:203], v[202:203], s[92:93]
    v_pk_mul_f32 v[204:205], v[204:205], s[92:93]
    v_pk_mul_f32 v[206:207], v[206:207], s[92:93]
    v_cvt_pk_bf16_f32 v200, v200, v201
    v_cvt_pk_bf16_f32 v201, v202, v203
    v_cvt_pk_bf16_f32 v202, v204, v205
    v_cvt_pk_bf16_f32 v203, v206, v207
    v_accvgpr_write_b32 a180, v200
    v_accvgpr_write_b32 a181, v201
    v_accvgpr_write_b32 a182, v202
    v_accvgpr_write_b32 a183, v203
    v_pk_mul_f32 v[208:209], v[208:209], s[92:93]
    v_pk_mul_f32 v[210:211], v[210:211], s[92:93]
    v_pk_mul_f32 v[212:213], v[212:213], s[92:93]
    v_pk_mul_f32 v[214:215], v[214:215], s[92:93]
    v_cvt_pk_bf16_f32 v208, v208, v209
    v_cvt_pk_bf16_f32 v209, v210, v211
    v_cvt_pk_bf16_f32 v210, v212, v213
    v_cvt_pk_bf16_f32 v211, v214, v215
    v_accvgpr_write_b32 a184, v208
    v_accvgpr_write_b32 a185, v209
    v_accvgpr_write_b32 a186, v210
    v_accvgpr_write_b32 a187, v211
    v_pk_mul_f32 v[216:217], v[216:217], s[92:93]
    v_pk_mul_f32 v[218:219], v[218:219], s[92:93]
    v_pk_mul_f32 v[220:221], v[220:221], s[92:93]
    v_pk_mul_f32 v[222:223], v[222:223], s[92:93]
    v_cvt_pk_bf16_f32 v216, v216, v217
    v_cvt_pk_bf16_f32 v217, v218, v219
    v_cvt_pk_bf16_f32 v218, v220, v221
    v_cvt_pk_bf16_f32 v219, v222, v223
    v_accvgpr_write_b32 a188, v216
    v_accvgpr_write_b32 a189, v217
    v_accvgpr_write_b32 a190, v218
    v_accvgpr_write_b32 a191, v219
    v_pk_mul_f32 v[224:225], v[224:225], s[92:93]
    v_pk_mul_f32 v[226:227], v[226:227], s[92:93]
    v_pk_mul_f32 v[228:229], v[228:229], s[92:93]
    v_pk_mul_f32 v[230:231], v[230:231], s[92:93]
    v_cvt_pk_bf16_f32 v224, v224, v225
    v_cvt_pk_bf16_f32 v225, v226, v227
    v_cvt_pk_bf16_f32 v226, v228, v229
    v_cvt_pk_bf16_f32 v227, v230, v231
    v_accvgpr_write_b32 a192, v224
    v_accvgpr_write_b32 a193, v225
    v_accvgpr_write_b32 a194, v226
    v_accvgpr_write_b32 a195, v227
    v_pk_mul_f32 v[232:233], v[232:233], s[92:93]
    v_pk_mul_f32 v[234:235], v[234:235], s[92:93]
    v_pk_mul_f32 v[236:237], v[236:237], s[92:93]
    v_pk_mul_f32 v[238:239], v[238:239], s[92:93]
    v_cvt_pk_bf16_f32 v232, v232, v233
    v_cvt_pk_bf16_f32 v233, v234, v235
    v_cvt_pk_bf16_f32 v234, v236, v237
    v_cvt_pk_bf16_f32 v235, v238, v239
    v_accvgpr_write_b32 a196, v232
    v_accvgpr_write_b32 a197, v233
    v_accvgpr_write_b32 a198, v234
    v_accvgpr_write_b32 a199, v235
    v_pk_mul_f32 v[240:241], v[240:241], s[92:93]
    v_pk_mul_f32 v[242:243], v[242:243], s[92:93]
    v_pk_mul_f32 v[244:245], v[244:245], s[92:93]
    v_pk_mul_f32 v[246:247], v[246:247], s[92:93]
    v_cvt_pk_bf16_f32 v240, v240, v241
    v_cvt_pk_bf16_f32 v241, v242, v243
    v_cvt_pk_bf16_f32 v242, v244, v245
    v_cvt_pk_bf16_f32 v243, v246, v247
    v_accvgpr_write_b32 a200, v240
    v_accvgpr_write_b32 a201, v241
    v_accvgpr_write_b32 a202, v242
    v_accvgpr_write_b32 a203, v243
    v_pk_mul_f32 v[248:249], v[248:249], s[92:93]
    v_pk_mul_f32 v[250:251], v[250:251], s[92:93]
    v_pk_mul_f32 v[252:253], v[252:253], s[92:93]
    v_pk_mul_f32 v[254:255], v[254:255], s[92:93]
    v_cvt_pk_bf16_f32 v248, v248, v249
    v_cvt_pk_bf16_f32 v249, v250, v251
    v_cvt_pk_bf16_f32 v250, v252, v253
    v_cvt_pk_bf16_f32 v251, v254, v255
    v_accvgpr_write_b32 a204, v248
    v_accvgpr_write_b32 a205, v249
    v_accvgpr_write_b32 a206, v250
    v_accvgpr_write_b32 a207, v251
    v_accvgpr_read_b32 v24, a224
    v_accvgpr_read_b32 v25, a225
    v_accvgpr_read_b32 v26, a226
    v_accvgpr_read_b32 v27, a227
    v_accvgpr_read_b32 v28, a228
    v_accvgpr_read_b32 v29, a229
    v_accvgpr_read_b32 v30, a230
    v_accvgpr_read_b32 v31, a231
    v_pk_mul_f32 v[24:25], v[24:25], s[92:93]
    v_pk_mul_f32 v[26:27], v[26:27], s[92:93]
    v_pk_mul_f32 v[28:29], v[28:29], s[92:93]
    v_pk_mul_f32 v[30:31], v[30:31], s[92:93]
    v_cvt_pk_bf16_f32 v24, v24, v25
    v_cvt_pk_bf16_f32 v25, v26, v27
    v_cvt_pk_bf16_f32 v26, v28, v29
    v_cvt_pk_bf16_f32 v27, v30, v31
    v_accvgpr_write_b32 a208, v24
    v_accvgpr_write_b32 a209, v25
    v_accvgpr_write_b32 a210, v26
    v_accvgpr_write_b32 a211, v27
    v_accvgpr_read_b32 v24, a232
    v_accvgpr_read_b32 v25, a233
    v_accvgpr_read_b32 v26, a234
    v_accvgpr_read_b32 v27, a235
    v_accvgpr_read_b32 v28, a236
    v_accvgpr_read_b32 v29, a237
    v_accvgpr_read_b32 v30, a238
    v_accvgpr_read_b32 v31, a239
    v_pk_mul_f32 v[24:25], v[24:25], s[92:93]
    v_pk_mul_f32 v[26:27], v[26:27], s[92:93]
    v_pk_mul_f32 v[28:29], v[28:29], s[92:93]
    v_pk_mul_f32 v[30:31], v[30:31], s[92:93]
    v_cvt_pk_bf16_f32 v24, v24, v25
    v_cvt_pk_bf16_f32 v25, v26, v27
    v_cvt_pk_bf16_f32 v26, v28, v29
    v_cvt_pk_bf16_f32 v27, v30, v31
    v_accvgpr_write_b32 a212, v24
    v_accvgpr_write_b32 a213, v25
    v_accvgpr_write_b32 a214, v26
    v_accvgpr_write_b32 a215, v27
    v_accvgpr_read_b32 v24, a240
    v_accvgpr_read_b32 v25, a241
    v_accvgpr_read_b32 v26, a242
    v_accvgpr_read_b32 v27, a243
    v_accvgpr_read_b32 v28, a244
    v_accvgpr_read_b32 v29, a245
    v_accvgpr_read_b32 v30, a246
    v_accvgpr_read_b32 v31, a247
    v_pk_mul_f32 v[24:25], v[24:25], s[92:93]
    v_pk_mul_f32 v[26:27], v[26:27], s[92:93]
    v_pk_mul_f32 v[28:29], v[28:29], s[92:93]
    v_pk_mul_f32 v[30:31], v[30:31], s[92:93]
    v_cvt_pk_bf16_f32 v24, v24, v25
    v_cvt_pk_bf16_f32 v25, v26, v27
    v_cvt_pk_bf16_f32 v26, v28, v29
    v_cvt_pk_bf16_f32 v27, v30, v31
    v_accvgpr_write_b32 a216, v24
    v_accvgpr_write_b32 a217, v25
    v_accvgpr_write_b32 a218, v26
    v_accvgpr_write_b32 a219, v27
    v_accvgpr_read_b32 v24, a248
    v_accvgpr_read_b32 v25, a249
    v_accvgpr_read_b32 v26, a250
    v_accvgpr_read_b32 v27, a251
    v_accvgpr_read_b32 v28, a252
    v_accvgpr_read_b32 v29, a253
    v_accvgpr_read_b32 v30, a254
    v_accvgpr_read_b32 v31, a255
    v_pk_mul_f32 v[24:25], v[24:25], s[92:93]
    v_pk_mul_f32 v[26:27], v[26:27], s[92:93]
    v_pk_mul_f32 v[28:29], v[28:29], s[92:93]
    v_pk_mul_f32 v[30:31], v[30:31], s[92:93]
    v_cvt_pk_bf16_f32 v24, v24, v25
    v_cvt_pk_bf16_f32 v25, v26, v27
    v_cvt_pk_bf16_f32 v26, v28, v29
    v_cvt_pk_bf16_f32 v27, v30, v31
    v_accvgpr_write_b32 a220, v24
    v_accvgpr_write_b32 a221, v25
    v_accvgpr_write_b32 a222, v26
    v_accvgpr_write_b32 a223, v27
    s_setpc_b64 s[20:21]
m_ns364:
    s_mov_b32 s90, s98
    v_cvt_pk_bf16_f32 v32, v32, v33
    v_cvt_pk_bf16_f32 v33, v34, v35
    v_cvt_pk_bf16_f32 v34, v36, v37
    v_cvt_pk_bf16_f32 v35, v38, v39
    buffer_store_dwordx4 v[32:35], v2, s[8:11], s90 offen sc1
    s_add_u32 s90, s90, s100
    v_cvt_pk_bf16_f32 v40, v40, v41
    v_cvt_pk_bf16_f32 v41, v42, v43
    v_cvt_pk_bf16_f32 v42, v44, v45
    v_cvt_pk_bf16_f32 v43, v46, v47
    buffer_store_dwordx4 v[40:43], v2, s[8:11], s90 offen sc1
    s_add_u32 s90, s90, s100
    v_cvt_pk_bf16_f32 v48, v48, v49
    v_cvt_pk_bf16_f32 v49, v50, v51
    v_cvt_pk_bf16_f32 v50, v52, v53
    v_cvt_pk_bf16_f32 v51, v54, v55
    buffer_store_dwordx4 v[48:51], v2, s[8:11], s90 offen sc1
    s_add_u32 s90, s90, s100
    v_cvt_pk_bf16_f32 v56, v56, v57
    v_cvt_pk_bf16_f32 v57, v58, v59
    v_cvt_pk_bf16_f32 v58, v60, v61
    v_cvt_pk_bf16_f32 v59, v62, v63
    buffer_store_dwordx4 v[56:59], v2, s[8:11], s90 offen sc1
    s_add_u32 s90, s90, s100
    v_cvt_pk_bf16_f32 v64, v64, v65
    v_cvt_pk_bf16_f32 v65, v66, v67
    v_cvt_pk_bf16_f32 v66, v68, v69
    v_cvt_pk_bf16_f32 v67, v70, v71
    buffer_store_dwordx4 v[64:67], v2, s[8:11], s90 offen sc1
    s_add_u32 s90, s90, s100
    v_cvt_pk_bf16_f32 v72, v72, v73
    v_cvt_pk_bf16_f32 v73, v74, v75
    v_cvt_pk_bf16_f32 v74, v76, v77
    v_cvt_pk_bf16_f32 v75, v78, v79
    buffer_store_dwordx4 v[72:75], v2, s[8:11], s90 offen sc1
    s_add_u32 s90, s90, s100
    v_cvt_pk_bf16_f32 v80, v80, v81
    v_cvt_pk_bf16_f32 v81, v82, v83
    v_cvt_pk_bf16_f32 v82, v84, v85
    v_cvt_pk_bf16_f32 v83, v86, v87
    buffer_store_dwordx4 v[80:83], v2, s[8:11], s90 offen sc1
    s_add_u32 s90, s90, s100
    v_cvt_pk_bf16_f32 v88, v88, v89
    v_cvt_pk_bf16_f32 v89, v90, v91
    v_cvt_pk_bf16_f32 v90, v92, v93
    v_cvt_pk_bf16_f32 v91, v94, v95
    buffer_store_dwordx4 v[88:91], v2, s[8:11], s90 offen sc1
    s_add_u32 s90, s90, s100
    v_cvt_pk_bf16_f32 v96, v96, v97
    v_cvt_pk_bf16_f32 v97, v98, v99
    v_cvt_pk_bf16_f32 v98, v100, v101
    v_cvt_pk_bf16_f32 v99, v102, v103
    v_accvgpr_write_b32 a128, v96
    v_accvgpr_write_b32 a129, v97
    v_accvgpr_write_b32 a130, v98
    v_accvgpr_write_b32 a131, v99
    v_cvt_pk_bf16_f32 v104, v104, v105
    v_cvt_pk_bf16_f32 v105, v106, v107
    v_cvt_pk_bf16_f32 v106, v108, v109
    v_cvt_pk_bf16_f32 v107, v110, v111
    v_accvgpr_write_b32 a132, v104
    v_accvgpr_write_b32 a133, v105
    v_accvgpr_write_b32 a134, v106
    v_accvgpr_write_b32 a135, v107
    v_cvt_pk_bf16_f32 v112, v112, v113
    v_cvt_pk_bf16_f32 v113, v114, v115
    v_cvt_pk_bf16_f32 v114, v116, v117
    v_cvt_pk_bf16_f32 v115, v118, v119
    v_accvgpr_write_b32 a136, v112
    v_accvgpr_write_b32 a137, v113
    v_accvgpr_write_b32 a138, v114
    v_accvgpr_write_b32 a139, v115
    v_cvt_pk_bf16_f32 v120, v120, v121
    v_cvt_pk_bf16_f32 v121, v122, v123
    v_cvt_pk_bf16_f32 v122, v124, v125
    v_cvt_pk_bf16_f32 v123, v126, v127
    v_accvgpr_write_b32 a140, v120
    v_accvgpr_write_b32 a141, v121
    v_accvgpr_write_b32 a142, v122
    v_accvgpr_write_b32 a143, v123
    v_cvt_pk_bf16_f32 v128, v128, v129
    v_cvt_pk_bf16_f32 v129, v130, v131
    v_cvt_pk_bf16_f32 v130, v132, v133
    v_cvt_pk_bf16_f32 v131, v134, v135
    v_accvgpr_write_b32 a144, v128
    v_accvgpr_write_b32 a145, v129
    v_accvgpr_write_b32 a146, v130
    v_accvgpr_write_b32 a147, v131
    v_cvt_pk_bf16_f32 v136, v136, v137
    v_cvt_pk_bf16_f32 v137, v138, v139
    v_cvt_pk_bf16_f32 v138, v140, v141
    v_cvt_pk_bf16_f32 v139, v142, v143
    v_accvgpr_write_b32 a148, v136
    v_accvgpr_write_b32 a149, v137
    v_accvgpr_write_b32 a150, v138
    v_accvgpr_write_b32 a151, v139
    v_cvt_pk_bf16_f32 v144, v144, v145
    v_cvt_pk_bf16_f32 v145, v146, v147
    v_cvt_pk_bf16_f32 v146, v148, v149
    v_cvt_pk_bf16_f32 v147, v150, v151
    v_accvgpr_write_b32 a152, v144
    v_accvgpr_write_b32 a153, v145
    v_accvgpr_write_b32 a154, v146
    v_accvgpr_write_b32 a155, v147
    v_cvt_pk_bf16_f32 v152, v152, v153
    v_cvt_pk_bf16_f32 v153, v154, v155
    v_cvt_pk_bf16_f32 v154, v156, v157
    v_cvt_pk_bf16_f32 v155, v158, v159
    v_accvgpr_write_b32 a156, v152
    v_accvgpr_write_b32 a157, v153
    v_accvgpr_write_b32 a158, v154
    v_accvgpr_write_b32 a159, v155
    v_cvt_pk_bf16_f32 v160, v160, v161
    v_cvt_pk_bf16_f32 v161, v162, v163
    v_cvt_pk_bf16_f32 v162, v164, v165
    v_cvt_pk_bf16_f32 v163, v166, v167
    v_accvgpr_write_b32 a160, v160
    v_accvgpr_write_b32 a161, v161
    v_accvgpr_write_b32 a162, v162
    v_accvgpr_write_b32 a163, v163
    v_cvt_pk_bf16_f32 v168, v168, v169
    v_cvt_pk_bf16_f32 v169, v170, v171
    v_cvt_pk_bf16_f32 v170, v172, v173
    v_cvt_pk_bf16_f32 v171, v174, v175
    v_accvgpr_write_b32 a164, v168
    v_accvgpr_write_b32 a165, v169
    v_accvgpr_write_b32 a166, v170
    v_accvgpr_write_b32 a167, v171
    v_cvt_pk_bf16_f32 v176, v176, v177
    v_cvt_pk_bf16_f32 v177, v178, v179
    v_cvt_pk_bf16_f32 v178, v180, v181
    v_cvt_pk_bf16_f32 v179, v182, v183
    v_accvgpr_write_b32 a168, v176
    v_accvgpr_write_b32 a169, v177
    v_accvgpr_write_b32 a170, v178
    v_accvgpr_write_b32 a171, v179
    v_cvt_pk_bf16_f32 v184, v184, v185
    v_cvt_pk_bf16_f32 v185, v186, v187
    v_cvt_pk_bf16_f32 v186, v188, v189
    v_cvt_pk_bf16_f32 v187, v190, v191
    v_accvgpr_write_b32 a172, v184
    v_accvgpr_write_b32 a173, v185
    v_accvgpr_write_b32 a174, v186
    v_accvgpr_write_b32 a175, v187
    v_cvt_pk_bf16_f32 v192, v192, v193
    v_cvt_pk_bf16_f32 v193, v194, v195
    v_cvt_pk_bf16_f32 v194, v196, v197
    v_cvt_pk_bf16_f32 v195, v198, v199
    v_accvgpr_write_b32 a176, v192
    v_accvgpr_write_b32 a177, v193
    v_accvgpr_write_b32 a178, v194
    v_accvgpr_write_b32 a179, v195
    v_cvt_pk_bf16_f32 v200, v200, v201
    v_cvt_pk_bf16_f32 v201, v202, v203
    v_cvt_pk_bf16_f32 v202, v204, v205
    v_cvt_pk_bf16_f32 v203, v206, v207
    v_accvgpr_write_b32 a180, v200
    v_accvgpr_write_b32 a181, v201
    v_accvgpr_write_b32 a182, v202
    v_accvgpr_write_b32 a183, v203
    v_cvt_pk_bf16_f32 v208, v208, v209
    v_cvt_pk_bf16_f32 v209, v210, v211
    v_cvt_pk_bf16_f32 v210, v212, v213
    v_cvt_pk_bf16_f32 v211, v214, v215
    v_accvgpr_write_b32 a184, v208
    v_accvgpr_write_b32 a185, v209
    v_accvgpr_write_b32 a186, v210
    v_accvgpr_write_b32 a187, v211
    v_cvt_pk_bf16_f32 v216, v216, v217
    v_cvt_pk_bf16_f32 v217, v218, v219
    v_cvt_pk_bf16_f32 v218, v220, v221
    v_cvt_pk_bf16_f32 v219, v222, v223
    v_accvgpr_write_b32 a188, v216
    v_accvgpr_write_b32 a189, v217
    v_accvgpr_write_b32 a190, v218
    v_accvgpr_write_b32 a191, v219
    v_cvt_pk_bf16_f32 v224, v224, v225
    v_cvt_pk_bf16_f32 v225, v226, v227
    v_cvt_pk_bf16_f32 v226, v228, v229
    v_cvt_pk_bf16_f32 v227, v230, v231
    v_accvgpr_write_b32 a192, v224
    v_accvgpr_write_b32 a193, v225
    v_accvgpr_write_b32 a194, v226
    v_accvgpr_write_b32 a195, v227
    v_cvt_pk_bf16_f32 v232, v232, v233
    v_cvt_pk_bf16_f32 v233, v234, v235
    v_cvt_pk_bf16_f32 v234, v236, v237
    v_cvt_pk_bf16_f32 v235, v238, v239
    v_accvgpr_write_b32 a196, v232
    v_accvgpr_write_b32 a197, v233
    v_accvgpr_write_b32 a198, v234
    v_accvgpr_write_b32 a199, v235
    v_cvt_pk_bf16_f32 v240, v240, v241
    v_cvt_pk_bf16_f32 v241, v242, v243
    v_cvt_pk_bf16_f32 v242, v244, v245
    v_cvt_pk_bf16_f32 v243, v246, v247
    v_accvgpr_write_b32 a200, v240
    v_accvgpr_write_b32 a201, v241
    v_accvgpr_write_b32 a202, v242
    v_accvgpr_write_b32 a203, v243
    v_cvt_pk_bf16_f32 v248, v248, v249
    v_cvt_pk_bf16_f32 v249, v250, v251
    v_cvt_pk_bf16_f32 v250, v252, v253
    v_cvt_pk_bf16_f32 v251, v254, v255
    v_accvgpr_write_b32 a204, v248
    v_accvgpr_write_b32 a205, v249
    v_accvgpr_write_b32 a206, v250
    v_accvgpr_write_b32 a207, v251
    v_accvgpr_read_b32 v24, a224
    v_accvgpr_read_b32 v25, a225
    v_accvgpr_read_b32 v26, a226
    v_accvgpr_read_b32 v27, a227
    v_accvgpr_read_b32 v28, a228
    v_accvgpr_read_b32 v29, a229
    v_accvgpr_read_b32 v30, a230
    v_accvgpr_read_b32 v31, a231
    v_cvt_pk_bf16_f32 v24, v24, v25
    v_cvt_pk_bf16_f32 v25, v26, v27
    v_cvt_pk_bf16_f32 v26, v28, v29
    v_cvt_pk_bf16_f32 v27, v30, v31
    v_accvgpr_write_b32 a208, v24
    v_accvgpr_write_b32 a209, v25
    v_accvgpr_write_b32 a210, v26
    v_accvgpr_write_b32 a211, v27
    v_accvgpr_read_b32 v24, a232
    v_accvgpr_read_b32 v25, a233
    v_accvgpr_read_b32 v26, a234
    v_accvgpr_read_b32 v27, a235
    v_accvgpr_read_b32 v28, a236
    v_accvgpr_read_b32 v29, a237
    v_accvgpr_read_b32 v30, a238
    v_accvgpr_read_b32 v31, a239
    v_cvt_pk_bf16_f32 v24, v24, v25
    v_cvt_pk_bf16_f32 v25, v26, v27
    v_cvt_pk_bf16_f32 v26, v28, v29
    v_cvt_pk_bf16_f32 v27, v30, v31
    v_accvgpr_write_b32 a212, v24
    v_accvgpr_write_b32 a213, v25
    v_accvgpr_write_b32 a214, v26
    v_accvgpr_write_b32 a215, v27
    v_accvgpr_read_b32 v24, a240
    v_accvgpr_read_b32 v25, a241
    v_accvgpr_read_b32 v26, a242
    v_accvgpr_read_b32 v27, a243
    v_accvgpr_read_b32 v28, a244
    v_accvgpr_read_b32 v29, a245
    v_accvgpr_read_b32 v30, a246
    v_accvgpr_read_b32 v31, a247
    v_cvt_pk_bf16_f32 v24, v24, v25
    v_cvt_pk_bf16_f32 v25, v26, v27
    v_cvt_pk_bf16_f32 v26, v28, v29
    v_cvt_pk_bf16_f32 v27, v30, v31
    v_accvgpr_write_b32 a216, v24
    v_accvgpr_write_b32 a217, v25
    v_accvgpr_write_b32 a218, v26
    v_accvgpr_write_b32 a219, v27
    v_accvgpr_read_b32 v24, a248
    v_accvgpr_read_b32 v25, a249
    v_accvgpr_read_b32 v26, a250
    v_accvgpr_read_b32 v27, a251
    v_accvgpr_read_b32 v28, a252
    v_accvgpr_read_b32 v29, a253
    v_accvgpr_read_b32 v30, a254
    v_accvgpr_read_b32 v31, a255
    v_cvt_pk_bf16_f32 v24, v24, v25
    v_cvt_pk_bf16_f32 v25, v26, v27
    v_cvt_pk_bf16_f32 v26, v28, v29
    v_cvt_pk_bf16_f32 v27, v30, v31
    v_accvgpr_write_b32 a220, v24
    v_accvgpr_write_b32 a221, v25
    v_accvgpr_write_b32 a222, v26
    v_accvgpr_write_b32 a223, v27
    s_setpc_b64 s[20:21]
m_epf22:
    s_nop 7
    s_cmp_eq_u32 s97, 0
    s_cbranch_scc1 m_noscale65
    s_mov_b32 s91, s98
    s_mov_b32 s92, s97
    s_mov_b32 s93, s97
    s_mov_b32 s90, s91
    v_pk_mul_f32 v[32:33], v[32:33], s[92:93]
    v_pk_mul_f32 v[34:35], v[34:35], s[92:93]
    v_pk_mul_f32 v[36:37], v[36:37], s[92:93]
    v_pk_mul_f32 v[38:39], v[38:39], s[92:93]
    v_cvt_pk_bf16_f32 v32, v32, v33
    v_cvt_pk_bf16_f32 v33, v34, v35
    v_cvt_pk_bf16_f32 v34, v36, v37
    v_cvt_pk_bf16_f32 v35, v38, v39
    buffer_store_dwordx4 v[32:35], v2, s[8:11], s90 offen sc1
    s_add_u32 s90, s90, s100
    v_pk_mul_f32 v[40:41], v[40:41], s[92:93]
    v_pk_mul_f32 v[42:43], v[42:43], s[92:93]
    v_pk_mul_f32 v[44:45], v[44:45], s[92:93]
    v_pk_mul_f32 v[46:47], v[46:47], s[92:93]
    v_cvt_pk_bf16_f32 v40, v40, v41
    v_cvt_pk_bf16_f32 v41, v42, v43
    v_cvt_pk_bf16_f32 v42, v44, v45
    v_cvt_pk_bf16_f32 v43, v46, v47
    buffer_store_dwordx4 v[40:43], v2, s[8:11], s90 offen sc1
    s_add_u32 s90, s90, s100
    v_pk_mul_f32 v[48:49], v[48:49], s[92:93]
    v_pk_mul_f32 v[50:51], v[50:51], s[92:93]
    v_pk_mul_f32 v[52:53], v[52:53], s[92:93]
    v_pk_mul_f32 v[54:55], v[54:55], s[92:93]
    v_cvt_pk_bf16_f32 v48, v48, v49
    v_cvt_pk_bf16_f32 v49, v50, v51
    v_cvt_pk_bf16_f32 v50, v52, v53
    v_cvt_pk_bf16_f32 v51, v54, v55
    buffer_store_dwordx4 v[48:51], v2, s[8:11], s90 offen sc1
    s_add_u32 s90, s90, s100
    v_pk_mul_f32 v[56:57], v[56:57], s[92:93]
    v_pk_mul_f32 v[58:59], v[58:59], s[92:93]
    v_pk_mul_f32 v[60:61], v[60:61], s[92:93]
    v_pk_mul_f32 v[62:63], v[62:63], s[92:93]
    v_cvt_pk_bf16_f32 v56, v56, v57
    v_cvt_pk_bf16_f32 v57, v58, v59
    v_cvt_pk_bf16_f32 v58, v60, v61
    v_cvt_pk_bf16_f32 v59, v62, v63
    buffer_store_dwordx4 v[56:59], v2, s[8:11], s90 offen sc1
    s_add_u32 s90, s90, s100
    v_pk_mul_f32 v[64:65], v[64:65], s[92:93]
    v_pk_mul_f32 v[66:67], v[66:67], s[92:93]
    v_pk_mul_f32 v[68:69], v[68:69], s[92:93]
    v_pk_mul_f32 v[70:71], v[70:71], s[92:93]
    v_cvt_pk_bf16_f32 v64, v64, v65
    v_cvt_pk_bf16_f32 v65, v66, v67
    v_cvt_pk_bf16_f32 v66, v68, v69
    v_cvt_pk_bf16_f32 v67, v70, v71
    buffer_store_dwordx4 v[64:67], v2, s[8:11], s90 offen sc1
    s_add_u32 s90, s90, s100
    v_pk_mul_f32 v[72:73], v[72:73], s[92:93]
    v_pk_mul_f32 v[74:75], v[74:75], s[92:93]
    v_pk_mul_f32 v[76:77], v[76:77], s[92:93]
    v_pk_mul_f32 v[78:79], v[78:79], s[92:93]
    v_cvt_pk_bf16_f32 v72, v72, v73
    v_cvt_pk_bf16_f32 v73, v74, v75
    v_cvt_pk_bf16_f32 v74, v76, v77
    v_cvt_pk_bf16_f32 v75, v78, v79
    buffer_store_dwordx4 v[72:75], v2, s[8:11], s90 offen sc1
    s_add_u32 s90, s90, s100
    v_pk_mul_f32 v[80:81], v[80:81], s[92:93]
    v_pk_mul_f32 v[82:83], v[82:83], s[92:93]
    v_pk_mul_f32 v[84:85], v[84:85], s[92:93]
    v_pk_mul_f32 v[86:87], v[86:87], s[92:93]
    v_cvt_pk_bf16_f32 v80, v80, v81
    v_cvt_pk_bf16_f32 v81, v82, v83
    v_cvt_pk_bf16_f32 v82, v84, v85
    v_cvt_pk_bf16_f32 v83, v86, v87
    buffer_store_dwordx4 v[80:83], v2, s[8:11], s90 offen sc1
    s_add_u32 s90, s90, s100
    v_pk_mul_f32 v[88:89], v[88:89], s[92:93]
    v_pk_mul_f32 v[90:91], v[90:91], s[92:93]
    v_pk_mul_f32 v[92:93], v[92:93], s[92:93]
    v_pk_mul_f32 v[94:95], v[94:95], s[92:93]
    v_cvt_pk_bf16_f32 v88, v88, v89
    v_cvt_pk_bf16_f32 v89, v90, v91
    v_cvt_pk_bf16_f32 v90, v92, v93
    v_cvt_pk_bf16_f32 v91, v94, v95
    buffer_store_dwordx4 v[88:91], v2, s[8:11], s90 offen sc1
    s_add_u32 s90, s90, s100
    s_add_u32 s91, s91, s99
    s_mov_b32 s90, s91
    v_pk_mul_f32 v[96:97], v[96:97], s[92:93]
    v_pk_mul_f32 v[98:99], v[98:99], s[92:93]
    v_pk_mul_f32 v[100:101], v[100:101], s[92:93]
    v_pk_mul_f32 v[102:103], v[102:103], s[92:93]
    v_cvt_pk_bf16_f32 v96, v96, v97
    v_cvt_pk_bf16_f32 v97, v98, v99
    v_cvt_pk_bf16_f32 v98, v100, v101
    v_cvt_pk_bf16_f32 v99, v102, v103
    buffer_store_dwordx4 v[96:99], v2, s[8:11], s90 offen sc1
    s_add_u32 s90, s90, s100
    v_pk_mul_f32 v[104:105], v[104:105], s[92:93]
    v_pk_mul_f32 v[106:107], v[106:107], s[92:93]
    v_pk_mul_f32 v[108:109], v[108:109], s[92:93]
    v_pk_mul_f32 v[110:111], v[110:111], s[92:93]
    v_cvt_pk_bf16_f32 v104, v104, v105
    v_cvt_pk_bf16_f32 v105, v106, v107
    v_cvt_pk_bf16_f32 v106, v108, v109
    v_cvt_pk_bf16_f32 v107, v110, v111
    buffer_store_dwordx4 v[104:107], v2, s[8:11], s90 offen sc1
    s_add_u32 s90, s90, s100
    v_pk_mul_f32 v[112:113], v[112:113], s[92:93]
    v_pk_mul_f32 v[114:115], v[114:115], s[92:93]
    v_pk_mul_f32 v[116:117], v[116:117], s[92:93]
    v_pk_mul_f32 v[118:119], v[118:119], s[92:93]
    v_cvt_pk_bf16_f32 v112, v112, v113
    v_cvt_pk_bf16_f32 v113, v114, v115
    v_cvt_pk_bf16_f32 v114, v116, v117
    v_cvt_pk_bf16_f32 v115, v118, v119
    buffer_store_dwordx4 v[112:115], v2, s[8:11], s90 offen sc1
    s_add_u32 s90, s90, s100
    v_pk_mul_f32 v[120:121], v[120:121], s[92:93]
    v_pk_mul_f32 v[122:123], v[122:123], s[92:93]
    v_pk_mul_f32 v[124:125], v[124:125], s[92:93]
    v_pk_mul_f32 v[126:127], v[126:127], s[92:93]
    v_cvt_pk_bf16_f32 v120, v120, v121
    v_cvt_pk_bf16_f32 v121, v122, v123
    v_cvt_pk_bf16_f32 v122, v124, v125
    v_cvt_pk_bf16_f32 v123, v126, v127
    buffer_store_dwordx4 v[120:123], v2, s[8:11], s90 offen sc1
    s_add_u32 s90, s90, s100
    v_pk_mul_f32 v[128:129], v[128:129], s[92:93]
    v_pk_mul_f32 v[130:131], v[130:131], s[92:93]
    v_pk_mul_f32 v[132:133], v[132:133], s[92:93]
    v_pk_mul_f32 v[134:135], v[134:135], s[92:93]
    v_cvt_pk_bf16_f32 v128, v128, v129
    v_cvt_pk_bf16_f32 v129, v130, v131
    v_cvt_pk_bf16_f32 v130, v132, v133
    v_cvt_pk_bf16_f32 v131, v134, v135
    buffer_store_dwordx4 v[128:131], v2, s[8:11], s90 offen sc1
    s_add_u32 s90, s90, s100
    v_pk_mul_f32 v[136:137], v[136:137], s[92:93]
    v_pk_mul_f32 v[138:139], v[138:139], s[92:93]
    v_pk_mul_f32 v[140:141], v[140:141], s[92:93]
    v_pk_mul_f32 v[142:143], v[142:143], s[92:93]
    v_cvt_pk_bf16_f32 v136, v136, v137
    v_cvt_pk_bf16_f32 v137, v138, v139
    v_cvt_pk_bf16_f32 v138, v140, v141
    v_cvt_pk_bf16_f32 v139, v142, v143
    buffer_store_dwordx4 v[136:139], v2, s[8:11], s90 offen sc1
    s_add_u32 s90, s90, s100
    v_pk_mul_f32 v[144:145], v[144:145], s[92:93]
    v_pk_mul_f32 v[146:147], v[146:147], s[92:93]
    v_pk_mul_f32 v[148:149], v[148:149], s[92:93]
    v_pk_mul_f32 v[150:151], v[150:151], s[92:93]
    v_cvt_pk_bf16_f32 v144, v144, v145
    v_cvt_pk_bf16_f32 v145, v146, v147
    v_cvt_pk_bf16_f32 v146, v148, v149
    v_cvt_pk_bf16_f32 v147, v150, v151
    buffer_store_dwordx4 v[144:147], v2, s[8:11], s90 offen sc1
    s_add_u32 s90, s90, s100
    v_pk_mul_f32 v[152:153], v[152:153], s[92:93]
    v_pk_mul_f32 v[154:155], v[154:155], s[92:93]
    v_pk_mul_f32 v[156:157], v[156:157], s[92:93]
    v_pk_mul_f32 v[158:159], v[158:159], s[92:93]
    v_cvt_pk_bf16_f32 v152, v152, v153
    v_cvt_pk_bf16_f32 v153, v154, v155
    v_cvt_pk_bf16_f32 v154, v156, v157
    v_cvt_pk_bf16_f32 v155, v158, v159
    buffer_store_dwordx4 v[152:155], v2, s[8:11], s90 offen sc1
    s_add_u32 s90, s90, s100
    s_add_u32 s91, s91, s99
    s_mov_b32 s90, s91
    v_pk_mul_f32 v[160:161], v[160:161], s[92:93]
    v_pk_mul_f32 v[162:163], v[162:163], s[92:93]
    v_pk_mul_f32 v[164:165], v[164:165], s[92:93]
    v_pk_mul_f32 v[166:167], v[166:167], s[92:93]
    v_cvt_pk_bf16_f32 v160, v160, v161
    v_cvt_pk_bf16_f32 v161, v162, v163
    v_cvt_pk_bf16_f32 v162, v164, v165
    v_cvt_pk_bf16_f32 v163, v166, v167
    buffer_store_dwordx4 v[160:163], v2, s[8:11], s90 offen sc1
    s_add_u32 s90, s90, s100
    v_pk_mul_f32 v[168:169], v[168:169], s[92:93]
    v_pk_mul_f32 v[170:171], v[170:171], s[92:93]
    v_pk_mul_f32 v[172:173], v[172:173], s[92:93]
    v_pk_mul_f32 v[174:175], v[174:175], s[92:93]
    v_cvt_pk_bf16_f32 v168, v168, v169
    v_cvt_pk_bf16_f32 v169, v170, v171
    v_cvt_pk_bf16_f32 v170, v172, v173
    v_cvt_pk_bf16_f32 v171, v174, v175
    buffer_store_dwordx4 v[168:171], v2, s[8:11], s90 offen sc1
    s_add_u32 s90, s90, s100
    v_pk_mul_f32 v[176:177], v[176:177], s[92:93]
    v_pk_mul_f32 v[178:179], v[178:179], s[92:93]
    v_pk_mul_f32 v[180:181], v[180:181], s[92:93]
    v_pk_mul_f32 v[182:183], v[182:183], s[92:93]
    v_cvt_pk_bf16_f32 v176, v176, v177
    v_cvt_pk_bf16_f32 v177, v178, v179
    v_cvt_pk_bf16_f32 v178, v180, v181
    v_cvt_pk_bf16_f32 v179, v182, v183
    buffer_store_dwordx4 v[176:179], v2, s[8:11], s90 offen sc1
    s_add_u32 s90, s90, s100
    v_pk_mul_f32 v[184:185], v[184:185], s[92:93]
    v_pk_mul_f32 v[186:187], v[186:187], s[92:93]
    v_pk_mul_f32 v[188:189], v[188:189], s[92:93]
    v_pk_mul_f32 v[190:191], v[190:191], s[92:93]
    v_cvt_pk_bf16_f32 v184, v184, v185
    v_cvt_pk_bf16_f32 v185, v186, v187
    v_cvt_pk_bf16_f32 v186, v188, v189
    v_cvt_pk_bf16_f32 v187, v190, v191
    buffer_store_dwordx4 v[184:187], v2, s[8:11], s90 offen sc1
    s_add_u32 s90, s90, s100
    v_pk_mul_f32 v[192:193], v[192:193], s[92:93]
    v_pk_mul_f32 v[194:195], v[194:195], s[92:93]
    v_pk_mul_f32 v[196:197], v[196:197], s[92:93]
    v_pk_mul_f32 v[198:199], v[198:199], s[92:93]
    v_cvt_pk_bf16_f32 v192, v192, v193
    v_cvt_pk_bf16_f32 v193, v194, v195
    v_cvt_pk_bf16_f32 v194, v196, v197
    v_cvt_pk_bf16_f32 v195, v198, v199
    buffer_store_dwordx4 v[192:195], v2, s[8:11], s90 offen sc1
    s_add_u32 s90, s90, s100
    v_pk_mul_f32 v[200:201], v[200:201], s[92:93]
    v_pk_mul_f32 v[202:203], v[202:203], s[92:93]
    v_pk_mul_f32 v[204:205], v[204:205], s[92:93]
    v_pk_mul_f32 v[206:207], v[206:207], s[92:93]
    v_cvt_pk_bf16_f32 v200, v200, v201
    v_cvt_pk_bf16_f32 v201, v202, v203
    v_cvt_pk_bf16_f32 v202, v204, v205
    v_cvt_pk_bf16_f32 v203, v206, v207
    buffer_store_dwordx4 v[200:203], v2, s[8:11], s90 offen sc1
    s_add_u32 s90, s90, s100
    v_pk_mul_f32 v[208:209], v[208:209], s[92:93]
    v_pk_mul_f32 v[210:211], v[210:211], s[92:93]
    v_pk_mul_f32 v[212:213], v[212:213], s[92:93]
    v_pk_mul_f32 v[214:215], v[214:215], s[92:93]
    v_cvt_pk_bf16_f32 v208, v208, v209
    v_cvt_pk_bf16_f32 v209, v210, v211
    v_cvt_pk_bf16_f32 v210, v212, v213
    v_cvt_pk_bf16_f32 v211, v214, v215
    buffer_store_dwordx4 v[208:211], v2, s[8:11], s90 offen sc1
    s_add_u32 s90, s90, s100
    v_pk_mul_f32 v[216:217], v[216:217], s[92:93]
    v_pk_mul_f32 v[218:219], v[218:219], s[92:93]
    v_pk_mul_f32 v[220:221], v[220:221], s[92:93]
    v_pk_mul_f32 v[222:223], v[222:223], s[92:93]
    v_cvt_pk_bf16_f32 v216, v216, v217
    v_cvt_pk_bf16_f32 v217, v218, v219
    v_cvt_pk_bf16_f32 v218, v220, v221
    v_cvt_pk_bf16_f32 v219, v222, v223
    buffer_store_dwordx4 v[216:219], v2, s[8:11], s90 offen sc1
    s_add_u32 s90, s90, s100
    s_add_u32 s91, s91, s99
    s_mov_b32 s90, s91
    v_pk_mul_f32 v[224:225], v[224:225], s[92:93]
    v_pk_mul_f32 v[226:227], v[226:227], s[92:93]
    v_pk_mul_f32 v[228:229], v[228:229], s[92:93]
    v_pk_mul_f32 v[230:231], v[230:231], s[92:93]
    v_cvt_pk_bf16_f32 v224, v224, v225
    v_cvt_pk_bf16_f32 v225, v226, v227
    v_cvt_pk_bf16_f32 v226, v228, v229
    v_cvt_pk_bf16_f32 v227, v230, v231
    buffer_store_dwordx4 v[224:227], v2, s[8:11], s90 offen sc1
    s_add_u32 s90, s90, s100
    v_pk_mul_f32 v[232:233], v[232:233], s[92:93]
    v_pk_mul_f32 v[234:235], v[234:235], s[92:93]
    v_pk_mul_f32 v[236:237], v[236:237], s[92:93]
    v_pk_mul_f32 v[238:239], v[238:239], s[92:93]
    v_cvt_pk_bf16_f32 v232, v232, v233
    v_cvt_pk_bf16_f32 v233, v234, v235
    v_cvt_pk_bf16_f32 v234, v236, v237
    v_cvt_pk_bf16_f32 v235, v238, v239
    buffer_store_dwordx4 v[232:235], v2, s[8:11], s90 offen sc1
    s_add_u32 s90, s90, s100
    v_pk_mul_f32 v[240:241], v[240:241], s[92:93]
    v_pk_mul_f32 v[242:243], v[242:243], s[92:93]
    v_pk_mul_f32 v[244:245], v[244:245], s[92:93]
    v_pk_mul_f32 v[246:247], v[246:247], s[92:93]
    v_cvt_pk_bf16_f32 v240, v240, v241
    v_cvt_pk_bf16_f32 v241, v242, v243
    v_cvt_pk_bf16_f32 v242, v244, v245
    v_cvt_pk_bf16_f32 v243, v246, v247
    buffer_store_dwordx4 v[240:243], v2, s[8:11], s90 offen sc1
    s_add_u32 s90, s90, s100
    v_pk_mul_f32 v[248:249], v[248:249], s[92:93]
    v_pk_mul_f32 v[250:251], v[250:251], s[92:93]
    v_pk_mul_f32 v[252:253], v[252:253], s[92:93]
    v_pk_mul_f32 v[254:255], v[254:255], s[92:93]
    v_cvt_pk_bf16_f32 v248, v248, v249
    v_cvt_pk_bf16_f32 v249, v250, v251
    v_cvt_pk_bf16_f32 v250, v252, v253
    v_cvt_pk_bf16_f32 v251, v254, v255
    buffer_store_dwordx4 v[248:251], v2, s[8:11], s90 offen sc1
    s_add_u32 s90, s90, s100
    v_accvgpr_read_b32 v24, a224
    v_accvgpr_read_b32 v25, a225
    v_accvgpr_read_b32 v26, a226
    v_accvgpr_read_b32 v27, a227
    v_accvgpr_read_b32 v28, a228
    v_accvgpr_read_b32 v29, a229
    v_accvgpr_read_b32 v30, a230
    v_accvgpr_read_b32 v31, a231
    v_pk_mul_f32 v[24:25], v[24:25], s[92:93]
    v_pk_mul_f32 v[26:27], v[26:27], s[92:93]
    v_pk_mul_f32 v[28:29], v[28:29], s[92:93]
    v_pk_mul_f32 v[30:31], v[30:31], s[92:93]
    v_cvt_pk_bf16_f32 v24, v24, v25
    v_cvt_pk_bf16_f32 v25, v26, v27
    v_cvt_pk_bf16_f32 v26, v28, v29
    v_cvt_pk_bf16_f32 v27, v30, v31
    buffer_store_dwordx4 v[24:27], v2, s[8:11], s90 offen sc1
    s_add_u32 s90, s90, s100
    s_nop 1
    v_accvgpr_read_b32 v24, a232
    v_accvgpr_read_b32 v25, a233
    v_accvgpr_read_b32 v26, a234
    v_accvgpr_read_b32 v27, a235
    v_accvgpr_read_b32 v28, a236
    v_accvgpr_read_b32 v29, a237
    v_accvgpr_read_b32 v30, a238
    v_accvgpr_read_b32 v31, a239
    v_pk_mul_f32 v[24:25], v[24:25], s[92:93]
    v_pk_mul_f32 v[26:27], v[26:27], s[92:93]
    v_pk_mul_f32 v[28:29], v[28:29], s[92:93]
    v_pk_mul_f32 v[30:31], v[30:31], s[92:93]
    v_cvt_pk_bf16_f32 v24, v24, v25
    v_cvt_pk_bf16_f32 v25, v26, v27
    v_cvt_pk_bf16_f32 v26, v28, v29
    v_cvt_pk_bf16_f32 v27, v30, v31
    buffer_store_dwordx4 v[24:27], v2, s[8:11], s90 offen sc1
    s_add_u32 s90, s90, s100
    s_nop 1
    v_accvgpr_read_b32 v24, a240
    v_accvgpr_read_b32 v25, a241
    v_accvgpr_read_b32 v26, a242
    v_accvgpr_read_b32 v27, a243
    v_accvgpr_read_b32 v28, a244
    v_accvgpr_read_b32 v29, a245
    v_accvgpr_read_b32 v30, a246
    v_accvgpr_read_b32 v31, a247
    v_pk_mul_f32 v[24:25], v[24:25], s[92:93]
    v_pk_mul_f32 v[26:27], v[26:27], s[92:93]
    v_pk_mul_f32 v[28:29], v[28:29], s[92:93]
    v_pk_mul_f32 v[30:31], v[30:31], s[92:93]
    v_cvt_pk_bf16_f32 v24, v24, v25
    v_cvt_pk_bf16_f32 v25, v26, v27
    v_cvt_pk_bf16_f32 v26, v28, v29
    v_cvt_pk_bf16_f32 v27, v30, v31
    buffer_store_dwordx4 v[24:27], v2, s[8:11], s90 offen sc1
    s_add_u32 s90, s90, s100
    s_nop 1
    v_accvgpr_read_b32 v24, a248
    v_accvgpr_read_b32 v25, a249
    v_accvgpr_read_b32 v26, a250
    v_accvgpr_read_b32 v27, a251
    v_accvgpr_read_b32 v28, a252
    v_accvgpr_read_b32 v29, a253
    v_accvgpr_read_b32 v30, a254
    v_accvgpr_read_b32 v31, a255
    v_pk_mul_f32 v[24:25], v[24:25], s[92:93]
    v_pk_mul_f32 v[26:27], v[26:27], s[92:93]
    v_pk_mul_f32 v[28:29], v[28:29], s[92:93]
    v_pk_mul_f32 v[30:31], v[30:31], s[92:93]
    v_cvt_pk_bf16_f32 v24, v24, v25
    v_cvt_pk_bf16_f32 v25, v26, v27
    v_cvt_pk_bf16_f32 v26, v28, v29
    v_cvt_pk_bf16_f32 v27, v30, v31
    buffer_store_dwordx4 v[24:27], v2, s[8:11], s90 offen sc1
    s_add_u32 s90, s90, s100
    s_nop 1
    s_add_u32 s91, s91, s99
    s_setpc_b64 s[20:21]
m_noscale65:
    s_mov_b32 s91, s98
    s_mov_b32 s92, s97
    s_mov_b32 s93, s97
    s_mov_b32 s90, s91
    v_cvt_pk_bf16_f32 v32, v32, v33
    v_cvt_pk_bf16_f32 v33, v34, v35
    v_cvt_pk_bf16_f32 v34, v36, v37
    v_cvt_pk_bf16_f32 v35, v38, v39
    buffer_store_dwordx4 v[32:35], v2, s[8:11], s90 offen sc1
    s_add_u32 s90, s90, s100
    v_cvt_pk_bf16_f32 v40, v40, v41
    v_cvt_pk_bf16_f32 v41, v42, v43
    v_cvt_pk_bf16_f32 v42, v44, v45
    v_cvt_pk_bf16_f32 v43, v46, v47
    buffer_store_dwordx4 v[40:43], v2, s[8:11], s90 offen sc1
    s_add_u32 s90, s90, s100
    v_cvt_pk_bf16_f32 v48, v48, v49
    v_cvt_pk_bf16_f32 v49, v50, v51
    v_cvt_pk_bf16_f32 v50, v52, v53
    v_cvt_pk_bf16_f32 v51, v54, v55
    buffer_store_dwordx4 v[48:51], v2, s[8:11], s90 offen sc1
    s_add_u32 s90, s90, s100
    v_cvt_pk_bf16_f32 v56, v56, v57
    v_cvt_pk_bf16_f32 v57, v58, v59
    v_cvt_pk_bf16_f32 v58, v60, v61
    v_cvt_pk_bf16_f32 v59, v62, v63
    buffer_store_dwordx4 v[56:59], v2, s[8:11], s90 offen sc1
    s_add_u32 s90, s90, s100
    v_cvt_pk_bf16_f32 v64, v64, v65
    v_cvt_pk_bf16_f32 v65, v66, v67
    v_cvt_pk_bf16_f32 v66, v68, v69
    v_cvt_pk_bf16_f32 v67, v70, v71
    buffer_store_dwordx4 v[64:67], v2, s[8:11], s90 offen sc1
    s_add_u32 s90, s90, s100
    v_cvt_pk_bf16_f32 v72, v72, v73
    v_cvt_pk_bf16_f32 v73, v74, v75
    v_cvt_pk_bf16_f32 v74, v76, v77
    v_cvt_pk_bf16_f32 v75, v78, v79
    buffer_store_dwordx4 v[72:75], v2, s[8:11], s90 offen sc1
    s_add_u32 s90, s90, s100
    v_cvt_pk_bf16_f32 v80, v80, v81
    v_cvt_pk_bf16_f32 v81, v82, v83
    v_cvt_pk_bf16_f32 v82, v84, v85
    v_cvt_pk_bf16_f32 v83, v86, v87
    buffer_store_dwordx4 v[80:83], v2, s[8:11], s90 offen sc1
    s_add_u32 s90, s90, s100
    v_cvt_pk_bf16_f32 v88, v88, v89
    v_cvt_pk_bf16_f32 v89, v90, v91
    v_cvt_pk_bf16_f32 v90, v92, v93
    v_cvt_pk_bf16_f32 v91, v94, v95
    buffer_store_dwordx4 v[88:91], v2, s[8:11], s90 offen sc1
    s_add_u32 s90, s90, s100
    s_add_u32 s91, s91, s99
    s_mov_b32 s90, s91
    v_cvt_pk_bf16_f32 v96, v96, v97
    v_cvt_pk_bf16_f32 v97, v98, v99
    v_cvt_pk_bf16_f32 v98, v100, v101
    v_cvt_pk_bf16_f32 v99, v102, v103
    buffer_store_dwordx4 v[96:99], v2, s[8:11], s90 offen sc1
    s_add_u32 s90, s90, s100
    v_cvt_pk_bf16_f32 v104, v104, v105
    v_cvt_pk_bf16_f32 v105, v106, v107
    v_cvt_pk_bf16_f32 v106, v108, v109
    v_cvt_pk_bf16_f32 v107, v110, v111
    buffer_store_dwordx4 v[104:107], v2, s[8:11], s90 offen sc1
    s_add_u32 s90, s90, s100
    v_cvt_pk_bf16_f32 v112, v112, v113
    v_cvt_pk_bf16_f32 v113, v114, v115
    v_cvt_pk_bf16_f32 v114, v116, v117
    v_cvt_pk_bf16_f32 v115, v118, v119
    buffer_store_dwordx4 v[112:115], v2, s[8:11], s90 offen sc1
    s_add_u32 s90, s90, s100
    v_cvt_pk_bf16_f32 v120, v120, v121
    v_cvt_pk_bf16_f32 v121, v122, v123
    v_cvt_pk_bf16_f32 v122, v124, v125
    v_cvt_pk_bf16_f32 v123, v126, v127
    buffer_store_dwordx4 v[120:123], v2, s[8:11], s90 offen sc1
    s_add_u32 s90, s90, s100
    v_cvt_pk_bf16_f32 v128, v128, v129
    v_cvt_pk_bf16_f32 v129, v130, v131
    v_cvt_pk_bf16_f32 v130, v132, v133
    v_cvt_pk_bf16_f32 v131, v134, v135
    buffer_store_dwordx4 v[128:131], v2, s[8:11], s90 offen sc1
    s_add_u32 s90, s90, s100
    v_cvt_pk_bf16_f32 v136, v136, v137
    v_cvt_pk_bf16_f32 v137, v138, v139
    v_cvt_pk_bf16_f32 v138, v140, v141
    v_cvt_pk_bf16_f32 v139, v142, v143
    buffer_store_dwordx4 v[136:139], v2, s[8:11], s90 offen sc1
    s_add_u32 s90, s90, s100
    v_cvt_pk_bf16_f32 v144, v144, v145
    v_cvt_pk_bf16_f32 v145, v146, v147
    v_cvt_pk_bf16_f32 v146, v148, v149
    v_cvt_pk_bf16_f32 v147, v150, v151
    buffer_store_dwordx4 v[144:147], v2, s[8:11], s90 offen sc1
    s_add_u32 s90, s90, s100
    v_cvt_pk_bf16_f32 v152, v152, v153
    v_cvt_pk_bf16_f32 v153, v154, v155
    v_cvt_pk_bf16_f32 v154, v156, v157
    v_cvt_pk_bf16_f32 v155, v158, v159
    buffer_store_dwordx4 v[152:155], v2, s[8:11], s90 offen sc1
    s_add_u32 s90, s90, s100
    s_add_u32 s91, s91, s99
    s_mov_b32 s90, s91
    v_cvt_pk_bf16_f32 v160, v160, v161
    v_cvt_pk_bf16_f32 v161, v162, v163
    v_cvt_pk_bf16_f32 v162, v164, v165
    v_cvt_pk_bf16_f32 v163, v166, v167
    buffer_store_dwordx4 v[160:163], v2, s[8:11], s90 offen sc1
    s_add_u32 s90, s90, s100
    v_cvt_pk_bf16_f32 v168, v168, v169
    v_cvt_pk_bf16_f32 v169, v170, v171
    v_cvt_pk_bf16_f32 v170, v172, v173
    v_cvt_pk_bf16_f32 v171, v174, v175
    buffer_store_dwordx4 v[168:171], v2, s[8:11], s90 offen sc1
    s_add_u32 s90, s90, s100
    v_cvt_pk_bf16_f32 v176, v176, v177
    v_cvt_pk_bf16_f32 v177, v178, v179
    v_cvt_pk_bf16_f32 v178, v180, v181
    v_cvt_pk_bf16_f32 v179, v182, v183
    buffer_store_dwordx4 v[176:179], v2, s[8:11], s90 offen sc1
    s_add_u32 s90, s90, s100
    v_cvt_pk_bf16_f32 v184, v184, v185
    v_cvt_pk_bf16_f32 v185, v186, v187
    v_cvt_pk_bf16_f32 v186, v188, v189
    v_cvt_pk_bf16_f32 v187, v190, v191
    buffer_store_dwordx4 v[184:187], v2, s[8:11], s90 offen sc1
    s_add_u32 s90, s90, s100
    v_cvt_pk_bf16_f32 v192, v192, v193
    v_cvt_pk_bf16_f32 v193, v194, v195
    v_cvt_pk_bf16_f32 v194, v196, v197
    v_cvt_pk_bf16_f32 v195, v198, v199
    buffer_store_dwordx4 v[192:195], v2, s[8:11], s90 offen sc1
    s_add_u32 s90, s90, s100
    v_cvt_pk_bf16_f32 v200, v200, v201
    v_cvt_pk_bf16_f32 v201, v202, v203
    v_cvt_pk_bf16_f32 v202, v204, v205
    v_cvt_pk_bf16_f32 v203, v206, v207
    buffer_store_dwordx4 v[200:203], v2, s[8:11], s90 offen sc1
    s_add_u32 s90, s90, s100
    v_cvt_pk_bf16_f32 v208, v208, v209
    v_cvt_pk_bf16_f32 v209, v210, v211
    v_cvt_pk_bf16_f32 v210, v212, v213
    v_cvt_pk_bf16_f32 v211, v214, v215
    buffer_store_dwordx4 v[208:211], v2, s[8:11], s90 offen sc1
    s_add_u32 s90, s90, s100
    v_cvt_pk_bf16_f32 v216, v216, v217
    v_cvt_pk_bf16_f32 v217, v218, v219
    v_cvt_pk_bf16_f32 v218, v220, v221
    v_cvt_pk_bf16_f32 v219, v222, v223
    buffer_store_dwordx4 v[216:219], v2, s[8:11], s90 offen sc1
    s_add_u32 s90, s90, s100
    s_add_u32 s91, s91, s99
    s_mov_b32 s90, s91
    v_cvt_pk_bf16_f32 v224, v224, v225
    v_cvt_pk_bf16_f32 v225, v226, v227
    v_cvt_pk_bf16_f32 v226, v228, v229
    v_cvt_pk_bf16_f32 v227, v230, v231
    buffer_store_dwordx4 v[224:227], v2, s[8:11], s90 offen sc1
    s_add_u32 s90, s90, s100
    v_cvt_pk_bf16_f32 v232, v232, v233
    v_cvt_pk_bf16_f32 v233, v234, v235
    v_cvt_pk_bf16_f32 v234, v236, v237
    v_cvt_pk_bf16_f32 v235, v238, v239
    buffer_store_dwordx4 v[232:235], v2, s[8:11], s90 offen sc1
    s_add_u32 s90, s90, s100
    v_cvt_pk_bf16_f32 v240, v240, v241
    v_cvt_pk_bf16_f32 v241, v242, v243
    v_cvt_pk_bf16_f32 v242, v244, v245
    v_cvt_pk_bf16_f32 v243, v246, v247
    buffer_store_dwordx4 v[240:243], v2, s[8:11], s90 offen sc1
    s_add_u32 s90, s90, s100
    v_cvt_pk_bf16_f32 v248, v248, v249
    v_cvt_pk_bf16_f32 v249, v250, v251
    v_cvt_pk_bf16_f32 v250, v252, v253
    v_cvt_pk_bf16_f32 v251, v254, v255
    buffer_store_dwordx4 v[248:251], v2, s[8:11], s90 offen sc1
    s_add_u32 s90, s90, s100
    v_accvgpr_read_b32 v24, a224
    v_accvgpr_read_b32 v25, a225
    v_accvgpr_read_b32 v26, a226
    v_accvgpr_read_b32 v27, a227
    v_accvgpr_read_b32 v28, a228
    v_accvgpr_read_b32 v29, a229
    v_accvgpr_read_b32 v30, a230
    v_accvgpr_read_b32 v31, a231
    v_cvt_pk_bf16_f32 v24, v24, v25
    v_cvt_pk_bf16_f32 v25, v26, v27
    v_cvt_pk_bf16_f32 v26, v28, v29
    v_cvt_pk_bf16_f32 v27, v30, v31
    buffer_store_dwordx4 v[24:27], v2, s[8:11], s90 offen sc1
    s_add_u32 s90, s90, s100
    s_nop 1
    v_accvgpr_read_b32 v24, a232
    v_accvgpr_read_b32 v25, a233
    v_accvgpr_read_b32 v26, a234
    v_accvgpr_read_b32 v27, a235
    v_accvgpr_read_b32 v28, a236
    v_accvgpr_read_b32 v29, a237
    v_accvgpr_read_b32 v30, a238
    v_accvgpr_read_b32 v31, a239
    v_cvt_pk_bf16_f32 v24, v24, v25
    v_cvt_pk_bf16_f32 v25, v26, v27
    v_cvt_pk_bf16_f32 v26, v28, v29
    v_cvt_pk_bf16_f32 v27, v30, v31
    buffer_store_dwordx4 v[24:27], v2, s[8:11], s90 offen sc1
    s_add_u32 s90, s90, s100
    s_nop 1
    v_accvgpr_read_b32 v24, a240
    v_accvgpr_read_b32 v25, a241
    v_accvgpr_read_b32 v26, a242
    v_accvgpr_read_b32 v27, a243
    v_accvgpr_read_b32 v28, a244
    v_accvgpr_read_b32 v29, a245
    v_accvgpr_read_b32 v30, a246
    v_accvgpr_read_b32 v31, a247
    v_cvt_pk_bf16_f32 v24, v24, v25
    v_cvt_pk_bf16_f32 v25, v26, v27
    v_cvt_pk_bf16_f32 v26, v28, v29
    v_cvt_pk_bf16_f32 v27, v30, v31
    buffer_store_dwordx4 v[24:27], v2, s[8:11], s90 offen sc1
    s_add_u32 s90, s90, s100
    s_nop 1
    v_accvgpr_read_b32 v24, a248
    v_accvgpr_read_b32 v25, a249
    v_accvgpr_read_b32 v26, a250
    v_accvgpr_read_b32 v27, a251
    v_accvgpr_read_b32 v28, a252
    v_accvgpr_read_b32 v29, a253
    v_accvgpr_read_b32 v30, a254
    v_accvgpr_read_b32 v31, a255
    v_cvt_pk_bf16_f32 v24, v24, v25
    v_cvt_pk_bf16_f32 v25, v26, v27
    v_cvt_pk_bf16_f32 v26, v28, v29
    v_cvt_pk_bf16_f32 v27, v30, v31
    buffer_store_dwordx4 v[24:27], v2, s[8:11], s90 offen sc1
    s_add_u32 s90, s90, s100
    s_nop 1
    s_add_u32 s91, s91, s99
    s_setpc_b64 s[20:21]
m_epl66:
    s_mov_b32 s92, s97
    s_mov_b32 s93, s97
    s_cmp_eq_u32 s97, 0
    s_cbranch_scc1 m_ns267
    s_mov_b32 s90, s98
    v_pk_mul_f32 v[32:33], v[32:33], s[92:93]
    v_pk_mul_f32 v[34:35], v[34:35], s[92:93]
    v_pk_mul_f32 v[36:37], v[36:37], s[92:93]
    v_pk_mul_f32 v[38:39], v[38:39], s[92:93]
    v_cvt_pk_bf16_f32 v32, v32, v33
    v_cvt_pk_bf16_f32 v33, v34, v35
    v_cvt_pk_bf16_f32 v34, v36, v37
    v_cvt_pk_bf16_f32 v35, v38, v39
    buffer_store_dwordx4 v[32:35], v2, s[8:11], s90 offen sc1
    s_add_u32 s90, s90, s100
    v_pk_mul_f32 v[40:41], v[40:41], s[92:93]
    v_pk_mul_f32 v[42:43], v[42:43], s[92:93]
    v_pk_mul_f32 v[44:45], v[44:45], s[92:93]
    v_pk_mul_f32 v[46:47], v[46:47], s[92:93]
    v_cvt_pk_bf16_f32 v40, v40, v41
    v_cvt_pk_bf16_f32 v41, v42, v43
    v_cvt_pk_bf16_f32 v42, v44, v45
    v_cvt_pk_bf16_f32 v43, v46, v47
    buffer_store_dwordx4 v[40:43], v2, s[8:11], s90 offen sc1
    s_add_u32 s90, s90, s100
    v_pk_mul_f32 v[48:49], v[48:49], s[92:93]
    v_pk_mul_f32 v[50:51], v[50:51], s[92:93]
    v_pk_mul_f32 v[52:53], v[52:53], s[92:93]
    v_pk_mul_f32 v[54:55], v[54:55], s[92:93]
    v_cvt_pk_bf16_f32 v48, v48, v49
    v_cvt_pk_bf16_f32 v49, v50, v51
    v_cvt_pk_bf16_f32 v50, v52, v53
    v_cvt_pk_bf16_f32 v51, v54, v55
    buffer_store_dwordx4 v[48:51], v2, s[8:11], s90 offen sc1
    s_add_u32 s90, s90, s100
    v_pk_mul_f32 v[56:57], v[56:57], s[92:93]
    v_pk_mul_f32 v[58:59], v[58:59], s[92:93]
    v_pk_mul_f32 v[60:61], v[60:61], s[92:93]
    v_pk_mul_f32 v[62:63], v[62:63], s[92:93]
    v_cvt_pk_bf16_f32 v56, v56, v57
    v_cvt_pk_bf16_f32 v57, v58, v59
    v_cvt_pk_bf16_f32 v58, v60, v61
    v_cvt_pk_bf16_f32 v59, v62, v63
    buffer_store_dwordx4 v[56:59], v2, s[8:11], s90 offen sc1
    s_add_u32 s90, s90, s100
    v_pk_mul_f32 v[64:65], v[64:65], s[92:93]
    v_pk_mul_f32 v[66:67], v[66:67], s[92:93]
    v_pk_mul_f32 v[68:69], v[68:69], s[92:93]
    v_pk_mul_f32 v[70:71], v[70:71], s[92:93]
    v_cvt_pk_bf16_f32 v64, v64, v65
    v_cvt_pk_bf16_f32 v65, v66, v67
    v_cvt_pk_bf16_f32 v66, v68, v69
    v_cvt_pk_bf16_f32 v67, v70, v71
    buffer_store_dwordx4 v[64:67], v2, s[8:11], s90 offen sc1
    s_add_u32 s90, s90, s100
    v_pk_mul_f32 v[72:73], v[72:73], s[92:93]
    v_pk_mul_f32 v[74:75], v[74:75], s[92:93]
    v_pk_mul_f32 v[76:77], v[76:77], s[92:93]
    v_pk_mul_f32 v[78:79], v[78:79], s[92:93]
    v_cvt_pk_bf16_f32 v72, v72, v73
    v_cvt_pk_bf16_f32 v73, v74, v75
    v_cvt_pk_bf16_f32 v74, v76, v77
    v_cvt_pk_bf16_f32 v75, v78, v79
    buffer_store_dwordx4 v[72:75], v2, s[8:11], s90 offen sc1
    s_add_u32 s90, s90, s100
    v_pk_mul_f32 v[80:81], v[80:81], s[92:93]
    v_pk_mul_f32 v[82:83], v[82:83], s[92:93]
    v_pk_mul_f32 v[84:85], v[84:85], s[92:93]
    v_pk_mul_f32 v[86:87], v[86:87], s[92:93]
    v_cvt_pk_bf16_f32 v80, v80, v81
    v_cvt_pk_bf16_f32 v81, v82, v83
    v_cvt_pk_bf16_f32 v82, v84, v85
    v_cvt_pk_bf16_f32 v83, v86, v87
    buffer_store_dwordx4 v[80:83], v2, s[8:11], s90 offen sc1
    s_add_u32 s90, s90, s100
    v_pk_mul_f32 v[88:89], v[88:89], s[92:93]
    v_pk_mul_f32 v[90:91], v[90:91], s[92:93]
    v_pk_mul_f32 v[92:93], v[92:93], s[92:93]
    v_pk_mul_f32 v[94:95], v[94:95], s[92:93]
    v_cvt_pk_bf16_f32 v88, v88, v89
    v_cvt_pk_bf16_f32 v89, v90, v91
    v_cvt_pk_bf16_f32 v90, v92, v93
    v_cvt_pk_bf16_f32 v91, v94, v95
    buffer_store_dwordx4 v[88:91], v2, s[8:11], s90 offen sc1
    s_add_u32 s90, s98, s99
    v_pk_mul_f32 v[96:97], v[96:97], s[92:93]
    v_pk_mul_f32 v[98:99], v[98:99], s[92:93]
    v_pk_mul_f32 v[100:101], v[100:101], s[92:93]
    v_pk_mul_f32 v[102:103], v[102:103], s[92:93]
    v_cvt_pk_bf16_f32 v96, v96, v97
    v_cvt_pk_bf16_f32 v97, v98, v99
    v_cvt_pk_bf16_f32 v98, v100, v101
    v_cvt_pk_bf16_f32 v99, v102, v103
    buffer_store_dwordx4 v[96:99], v2, s[8:11], s90 offen sc1
    s_add_u32 s90, s90, s100
    v_pk_mul_f32 v[104:105], v[104:105], s[92:93]
    v_pk_mul_f32 v[106:107], v[106:107], s[92:93]
    v_pk_mul_f32 v[108:109], v[108:109], s[92:93]
    v_pk_mul_f32 v[110:111], v[110:111], s[92:93]
    v_cvt_pk_bf16_f32 v104, v104, v105
    v_cvt_pk_bf16_f32 v105, v106, v107
    v_cvt_pk_bf16_f32 v106, v108, v109
    v_cvt_pk_bf16_f32 v107, v110, v111
    buffer_store_dwordx4 v[104:107], v2, s[8:11], s90 offen sc1
    s_add_u32 s90, s90, s100
    v_pk_mul_f32 v[112:113], v[112:113], s[92:93]
    v_pk_mul_f32 v[114:115], v[114:115], s[92:93]
    v_pk_mul_f32 v[116:117], v[116:117], s[92:93]
    v_pk_mul_f32 v[118:119], v[118:119], s[92:93]
    v_cvt_pk_bf16_f32 v112, v112, v113
    v_cvt_pk_bf16_f32 v113, v114, v115
    v_cvt_pk_bf16_f32 v114, v116, v117
    v_cvt_pk_bf16_f32 v115, v118, v119
    buffer_store_dwordx4 v[112:115], v2, s[8:11], s90 offen sc1
    s_add_u32 s90, s90, s100
    v_pk_mul_f32 v[120:121], v[120:121], s[92:93]
    v_pk_mul_f32 v[122:123], v[122:123], s[92:93]
    v_pk_mul_f32 v[124:125], v[124:125], s[92:93]
    v_pk_mul_f32 v[126:127], v[126:127], s[92:93]
    v_cvt_pk_bf16_f32 v120, v120, v121
    v_cvt_pk_bf16_f32 v121, v122, v123
    v_cvt_pk_bf16_f32 v122, v124, v125
    v_cvt_pk_bf16_f32 v123, v126, v127
    buffer_store_dwordx4 v[120:123], v2, s[8:11], s90 offen sc1
    s_add_u32 s90, s90, s100
    v_pk_mul_f32 v[128:129], v[128:129], s[92:93]
    v_pk_mul_f32 v[130:131], v[130:131], s[92:93]
    v_pk_mul_f32 v[132:133], v[132:133], s[92:93]
    v_pk_mul_f32 v[134:135], v[134:135], s[92:93]
    v_cvt_pk_bf16_f32 v128, v128, v129
    v_cvt_pk_bf16_f32 v129, v130, v131
    v_cvt_pk_bf16_f32 v130, v132, v133
    v_cvt_pk_bf16_f32 v131, v134, v135
    buffer_store_dwordx4 v[128:131], v2, s[8:11], s90 offen sc1
    s_add_u32 s90, s90, s100
    v_pk_mul_f32 v[136:137], v[136:137], s[92:93]
    v_pk_mul_f32 v[138:139], v[138:139], s[92:93]
    v_pk_mul_f32 v[140:141], v[140:141], s[92:93]
    v_pk_mul_f32 v[142:143], v[142:143], s[92:93]
    v_cvt_pk_bf16_f32 v136, v136, v137
    v_cvt_pk_bf16_f32 v137, v138, v139
    v_cvt_pk_bf16_f32 v138, v140, v141
    v_cvt_pk_bf16_f32 v139, v142, v143
    buffer_store_dwordx4 v[136:139], v2, s[8:11], s90 offen sc1
    s_add_u32 s90, s90, s100
    v_pk_mul_f32 v[144:145], v[144:145], s[92:93]
    v_pk_mul_f32 v[146:147], v[146:147], s[92:93]
    v_pk_mul_f32 v[148:149], v[148:149], s[92:93]
    v_pk_mul_f32 v[150:151], v[150:151], s[92:93]
    v_cvt_pk_bf16_f32 v144, v144, v145
    v_cvt_pk_bf16_f32 v145, v146, v147
    v_cvt_pk_bf16_f32 v146, v148, v149
    v_cvt_pk_bf16_f32 v147, v150, v151
    buffer_store_dwordx4 v[144:147], v2, s[8:11], s90 offen sc1
    s_add_u32 s90, s90, s100
    v_pk_mul_f32 v[152:153], v[152:153], s[92:93]
    v_pk_mul_f32 v[154:155], v[154:155], s[92:93]
    v_pk_mul_f32 v[156:157], v[156:157], s[92:93]
    v_pk_mul_f32 v[158:159], v[158:159], s[92:93]
    v_cvt_pk_bf16_f32 v152, v152, v153
    v_cvt_pk_bf16_f32 v153, v154, v155
    v_cvt_pk_bf16_f32 v154, v156, v157
    v_cvt_pk_bf16_f32 v155, v158, v159
    buffer_store_dwordx4 v[152:155], v2, s[8:11], s90 offen sc1
    s_add_u32 s90, s90, s100
    v_pk_mul_f32 v[192:193], v[192:193], s[92:93]
    v_pk_mul_f32 v[194:195], v[194:195], s[92:93]
    v_pk_mul_f32 v[196:197], v[196:197], s[92:93]
    v_pk_mul_f32 v[198:199], v[198:199], s[92:93]
    v_cvt_pk_bf16_f32 v192, v192, v193
    v_cvt_pk_bf16_f32 v193, v194, v195
    v_cvt_pk_bf16_f32 v194, v196, v197
    v_cvt_pk_bf16_f32 v195, v198, v199
    v_pk_mul_f32 v[200:201], v[200:201], s[92:93]
    v_pk_mul_f32 v[202:203], v[202:203], s[92:93]
    v_pk_mul_f32 v[204:205], v[204:205], s[92:93]
    v_pk_mul_f32 v[206:207], v[206:207], s[92:93]
    v_cvt_pk_bf16_f32 v196, v200, v201
    v_cvt_pk_bf16_f32 v197, v202, v203
    v_cvt_pk_bf16_f32 v198, v204, v205
    v_cvt_pk_bf16_f32 v199, v206, v207
    v_pk_mul_f32 v[208:209], v[208:209], s[92:93]
    v_pk_mul_f32 v[210:211], v[210:211], s[92:93]
    v_pk_mul_f32 v[212:213], v[212:213], s[92:93]
    v_pk_mul_f32 v[214:215], v[214:215], s[92:93]
    v_cvt_pk_bf16_f32 v200, v208, v209
    v_cvt_pk_bf16_f32 v201, v210, v211
    v_cvt_pk_bf16_f32 v202, v212, v213
    v_cvt_pk_bf16_f32 v203, v214, v215
    v_pk_mul_f32 v[216:217], v[216:217], s[92:93]
    v_pk_mul_f32 v[218:219], v[218:219], s[92:93]
    v_pk_mul_f32 v[220:221], v[220:221], s[92:93]
    v_pk_mul_f32 v[222:223], v[222:223], s[92:93]
    v_cvt_pk_bf16_f32 v204, v216, v217
    v_cvt_pk_bf16_f32 v205, v218, v219
    v_cvt_pk_bf16_f32 v206, v220, v221
    v_cvt_pk_bf16_f32 v207, v222, v223
    v_pk_mul_f32 v[224:225], v[224:225], s[92:93]
    v_pk_mul_f32 v[226:227], v[226:227], s[92:93]
    v_pk_mul_f32 v[228:229], v[228:229], s[92:93]
    v_pk_mul_f32 v[230:231], v[230:231], s[92:93]
    v_cvt_pk_bf16_f32 v208, v224, v225
    v_cvt_pk_bf16_f32 v209, v226, v227
    v_cvt_pk_bf16_f32 v210, v228, v229
    v_cvt_pk_bf16_f32 v211, v230, v231
    v_pk_mul_f32 v[232:233], v[232:233], s[92:93]
    v_pk_mul_f32 v[234:235], v[234:235], s[92:93]
    v_pk_mul_f32 v[236:237], v[236:237], s[92:93]
    v_pk_mul_f32 v[238:239], v[238:239], s[92:93]
    v_cvt_pk_bf16_f32 v212, v232, v233
    v_cvt_pk_bf16_f32 v213, v234, v235
    v_cvt_pk_bf16_f32 v214, v236, v237
    v_cvt_pk_bf16_f32 v215, v238, v239
    v_pk_mul_f32 v[240:241], v[240:241], s[92:93]
    v_pk_mul_f32 v[242:243], v[242:243], s[92:93]
    v_pk_mul_f32 v[244:245], v[244:245], s[92:93]
    v_pk_mul_f32 v[246:247], v[246:247], s[92:93]
    v_cvt_pk_bf16_f32 v216, v240, v241
    v_cvt_pk_bf16_f32 v217, v242, v243
    v_cvt_pk_bf16_f32 v218, v244, v245
    v_cvt_pk_bf16_f32 v219, v246, v247
    v_pk_mul_f32 v[248:249], v[248:249], s[92:93]
    v_pk_mul_f32 v[250:251], v[250:251], s[92:93]
    v_pk_mul_f32 v[252:253], v[252:253], s[92:93]
    v_pk_mul_f32 v[254:255], v[254:255], s[92:93]
    v_cvt_pk_bf16_f32 v220, v248, v249
    v_cvt_pk_bf16_f32 v221, v250, v251
    v_cvt_pk_bf16_f32 v222, v252, v253
    v_cvt_pk_bf16_f32 v223, v254, v255
    v_accvgpr_read_b32 v24, a224
    v_accvgpr_read_b32 v25, a225
    v_accvgpr_read_b32 v26, a226
    v_accvgpr_read_b32 v27, a227
    v_accvgpr_read_b32 v28, a228
    v_accvgpr_read_b32 v29, a229
    v_accvgpr_read_b32 v30, a230
    v_accvgpr_read_b32 v31, a231
    v_pk_mul_f32 v[24:25], v[24:25], s[92:93]
    v_pk_mul_f32 v[26:27], v[26:27], s[92:93]
    v_pk_mul_f32 v[28:29], v[28:29], s[92:93]
    v_pk_mul_f32 v[30:31], v[30:31], s[92:93]
    v_cvt_pk_bf16_f32 v224, v24, v25
    v_cvt_pk_bf16_f32 v225, v26, v27
    v_cvt_pk_bf16_f32 v226, v28, v29
    v_cvt_pk_bf16_f32 v227, v30, v31
    v_accvgpr_read_b32 v24, a232
    v_accvgpr_read_b32 v25, a233
    v_accvgpr_read_b32 v26, a234
    v_accvgpr_read_b32 v27, a235
    v_accvgpr_read_b32 v28, a236
    v_accvgpr_read_b32 v29, a237
    v_accvgpr_read_b32 v30, a238
    v_accvgpr_read_b32 v31, a239
    v_pk_mul_f32 v[24:25], v[24:25], s[92:93]
    v_pk_mul_f32 v[26:27], v[26:27], s[92:93]
    v_pk_mul_f32 v[28:29], v[28:29], s[92:93]
    v_pk_mul_f32 v[30:31], v[30:31], s[92:93]
    v_cvt_pk_bf16_f32 v228, v24, v25
    v_cvt_pk_bf16_f32 v229, v26, v27
    v_cvt_pk_bf16_f32 v230, v28, v29
    v_cvt_pk_bf16_f32 v231, v30, v31
    v_accvgpr_read_b32 v24, a240
    v_accvgpr_read_b32 v25, a241
    v_accvgpr_read_b32 v26, a242
    v_accvgpr_read_b32 v27, a243
    v_accvgpr_read_b32 v28, a244
    v_accvgpr_read_b32 v29, a245
    v_accvgpr_read_b32 v30, a246
    v_accvgpr_read_b32 v31, a247
    v_pk_mul_f32 v[24:25], v[24:25], s[92:93]
    v_pk_mul_f32 v[26:27], v[26:27], s[92:93]
    v_pk_mul_f32 v[28:29], v[28:29], s[92:93]
    v_pk_mul_f32 v[30:31], v[30:31], s[92:93]
    v_cvt_pk_bf16_f32 v232, v24, v25
    v_cvt_pk_bf16_f32 v233, v26, v27
    v_cvt_pk_bf16_f32 v234, v28, v29
    v_cvt_pk_bf16_f32 v235, v30, v31
    v_accvgpr_read_b32 v24, a248
    v_accvgpr_read_b32 v25, a249
    v_accvgpr_read_b32 v26, a250
    v_accvgpr_read_b32 v27, a251
    v_accvgpr_read_b32 v28, a252
    v_accvgpr_read_b32 v29, a253
    v_accvgpr_read_b32 v30, a254
    v_accvgpr_read_b32 v31, a255
    v_pk_mul_f32 v[24:25], v[24:25], s[92:93]
    v_pk_mul_f32 v[26:27], v[26:27], s[92:93]
    v_pk_mul_f32 v[28:29], v[28:29], s[92:93]
    v_pk_mul_f32 v[30:31], v[30:31], s[92:93]
    v_cvt_pk_bf16_f32 v236, v24, v25
    v_cvt_pk_bf16_f32 v237, v26, v27
    v_cvt_pk_bf16_f32 v238, v28, v29
    v_cvt_pk_bf16_f32 v239, v30, v31
    v_pk_mul_f32 v[160:161], v[160:161], s[92:93]
    v_pk_mul_f32 v[162:163], v[162:163], s[92:93]
    v_pk_mul_f32 v[164:165], v[164:165], s[92:93]
    v_pk_mul_f32 v[166:167], v[166:167], s[92:93]
    v_cvt_pk_bf16_f32 v240, v160, v161
    v_cvt_pk_bf16_f32 v241, v162, v163
    v_cvt_pk_bf16_f32 v242, v164, v165
    v_cvt_pk_bf16_f32 v243, v166, v167
    v_pk_mul_f32 v[168:169], v[168:169], s[92:93]
    v_pk_mul_f32 v[170:171], v[170:171], s[92:93]
    v_pk_mul_f32 v[172:173], v[172:173], s[92:93]
    v_pk_mul_f32 v[174:175], v[174:175], s[92:93]
    v_cvt_pk_bf16_f32 v244, v168, v169
    v_cvt_pk_bf16_f32 v245, v170, v171
    v_cvt_pk_bf16_f32 v246, v172, v173
    v_cvt_pk_bf16_f32 v247, v174, v175
    v_pk_mul_f32 v[176:177], v[176:177], s[92:93]
    v_pk_mul_f32 v[178:179], v[178:179], s[92:93]
    v_pk_mul_f32 v[180:181], v[180:181], s[92:93]
    v_pk_mul_f32 v[182:183], v[182:183], s[92:93]
    v_cvt_pk_bf16_f32 v248, v176, v177
    v_cvt_pk_bf16_f32 v249, v178, v179
    v_cvt_pk_bf16_f32 v250, v180, v181
    v_cvt_pk_bf16_f32 v251, v182, v183
    v_pk_mul_f32 v[184:185], v[184:185], s[92:93]
    v_pk_mul_f32 v[186:187], v[186:187], s[92:93]
    v_pk_mul_f32 v[188:189], v[188:189], s[92:93]
    v_pk_mul_f32 v[190:191], v[190:191], s[92:93]
    v_cvt_pk_bf16_f32 v252, v184, v185
    v_cvt_pk_bf16_f32 v253, v186, v187
    v_cvt_pk_bf16_f32 v254, v188, v189
    v_cvt_pk_bf16_f32 v255, v190, v191
    s_setpc_b64 s[20:21]
m_ns267:
    s_mov_b32 s90, s98
    v_cvt_pk_bf16_f32 v32, v32, v33
    v_cvt_pk_bf16_f32 v33, v34, v35
    v_cvt_pk_bf16_f32 v34, v36, v37
    v_cvt_pk_bf16_f32 v35, v38, v39
    buffer_store_dwordx4 v[32:35], v2, s[8:11], s90 offen sc1
    s_add_u32 s90, s90, s100
    v_cvt_pk_bf16_f32 v40, v40, v41
    v_cvt_pk_bf16_f32 v41, v42, v43
    v_cvt_pk_bf16_f32 v42, v44, v45
    v_cvt_pk_bf16_f32 v43, v46, v47
    buffer_store_dwordx4 v[40:43], v2, s[8:11], s90 offen sc1
    s_add_u32 s90, s90, s100
    v_cvt_pk_bf16_f32 v48, v48, v49
    v_cvt_pk_bf16_f32 v49, v50, v51
    v_cvt_pk_bf16_f32 v50, v52, v53
    v_cvt_pk_bf16_f32 v51, v54, v55
    buffer_store_dwordx4 v[48:51], v2, s[8:11], s90 offen sc1
    s_add_u32 s90, s90, s100
    v_cvt_pk_bf16_f32 v56, v56, v57
    v_cvt_pk_bf16_f32 v57, v58, v59
    v_cvt_pk_bf16_f32 v58, v60, v61
    v_cvt_pk_bf16_f32 v59, v62, v63
    buffer_store_dwordx4 v[56:59], v2, s[8:11], s90 offen sc1
    s_add_u32 s90, s90, s100
    v_cvt_pk_bf16_f32 v64, v64, v65
    v_cvt_pk_bf16_f32 v65, v66, v67
    v_cvt_pk_bf16_f32 v66, v68, v69
    v_cvt_pk_bf16_f32 v67, v70, v71
    buffer_store_dwordx4 v[64:67], v2, s[8:11], s90 offen sc1
    s_add_u32 s90, s90, s100
    v_cvt_pk_bf16_f32 v72, v72, v73
    v_cvt_pk_bf16_f32 v73, v74, v75
    v_cvt_pk_bf16_f32 v74, v76, v77
    v_cvt_pk_bf16_f32 v75, v78, v79
    buffer_store_dwordx4 v[72:75], v2, s[8:11], s90 offen sc1
    s_add_u32 s90, s90, s100
    v_cvt_pk_bf16_f32 v80, v80, v81
    v_cvt_pk_bf16_f32 v81, v82, v83
    v_cvt_pk_bf16_f32 v82, v84, v85
    v_cvt_pk_bf16_f32 v83, v86, v87
    buffer_store_dwordx4 v[80:83], v2, s[8:11], s90 offen sc1
    s_add_u32 s90, s90, s100
    v_cvt_pk_bf16_f32 v88, v88, v89
    v_cvt_pk_bf16_f32 v89, v90, v91
    v_cvt_pk_bf16_f32 v90, v92, v93
    v_cvt_pk_bf16_f32 v91, v94, v95
    buffer_store_dwordx4 v[88:91], v2, s[8:11], s90 offen sc1
    s_add_u32 s90, s98, s99
    v_cvt_pk_bf16_f32 v96, v96, v97
    v_cvt_pk_bf16_f32 v97, v98, v99
    v_cvt_pk_bf16_f32 v98, v100, v101
    v_cvt_pk_bf16_f32 v99, v102, v103
    buffer_store_dwordx4 v[96:99], v2, s[8:11], s90 offen sc1
    s_add_u32 s90, s90, s100
    v_cvt_pk_bf16_f32 v104, v104, v105
    v_cvt_pk_bf16_f32 v105, v106, v107
    v_cvt_pk_bf16_f32 v106, v108, v109
    v_cvt_pk_bf16_f32 v107, v110, v111
    buffer_store_dwordx4 v[104:107], v2, s[8:11], s90 offen sc1
    s_add_u32 s90, s90, s100
    v_cvt_pk_bf16_f32 v112, v112, v113
    v_cvt_pk_bf16_f32 v113, v114, v115
    v_cvt_pk_bf16_f32 v114, v116, v117
    v_cvt_pk_bf16_f32 v115, v118, v119
    buffer_store_dwordx4 v[112:115], v2, s[8:11], s90 offen sc1
    s_add_u32 s90, s90, s100
    v_cvt_pk_bf16_f32 v120, v120, v121
    v_cvt_pk_bf16_f32 v121, v122, v123
    v_cvt_pk_bf16_f32 v122, v124, v125
    v_cvt_pk_bf16_f32 v123, v126, v127
    buffer_store_dwordx4 v[120:123], v2, s[8:11], s90 offen sc1
    s_add_u32 s90, s90, s100
    v_cvt_pk_bf16_f32 v128, v128, v129
    v_cvt_pk_bf16_f32 v129, v130, v131
    v_cvt_pk_bf16_f32 v130, v132, v133
    v_cvt_pk_bf16_f32 v131, v134, v135
    buffer_store_dwordx4 v[128:131], v2, s[8:11], s90 offen sc1
    s_add_u32 s90, s90, s100
    v_cvt_pk_bf16_f32 v136, v136, v137
    v_cvt_pk_bf16_f32 v137, v138, v139
    v_cvt_pk_bf16_f32 v138, v140, v141
    v_cvt_pk_bf16_f32 v139, v142, v143
    buffer_store_dwordx4 v[136:139], v2, s[8:11], s90 offen sc1
    s_add_u32 s90, s90, s100
    v_cvt_pk_bf16_f32 v144, v144, v145
    v_cvt_pk_bf16_f32 v145, v146, v147
    v_cvt_pk_bf16_f32 v146, v148, v149
    v_cvt_pk_bf16_f32 v147, v150, v151
    buffer_store_dwordx4 v[144:147], v2, s[8:11], s90 offen sc1
    s_add_u32 s90, s90, s100
    v_cvt_pk_bf16_f32 v152, v152, v153
    v_cvt_pk_bf16_f32 v153, v154, v155
    v_cvt_pk_bf16_f32 v154, v156, v157
    v_cvt_pk_bf16_f32 v155, v158, v159
    buffer_store_dwordx4 v[152:155], v2, s[8:11], s90 offen sc1
    s_add_u32 s90, s90, s100
    v_cvt_pk_bf16_f32 v192, v192, v193
    v_cvt_pk_bf16_f32 v193, v194, v195
    v_cvt_pk_bf16_f32 v194, v196, v197
    v_cvt_pk_bf16_f32 v195, v198, v199
    v_cvt_pk_bf16_f32 v196, v200, v201
    v_cvt_pk_bf16_f32 v197, v202, v203
    v_cvt_pk_bf16_f32 v198, v204, v205
    v_cvt_pk_bf16_f32 v199, v206, v207
    v_cvt_pk_bf16_f32 v200, v208, v209
    v_cvt_pk_bf16_f32 v201, v210, v211
    v_cvt_pk_bf16_f32 v202, v212, v213
    v_cvt_pk_bf16_f32 v203, v214, v215
    v_cvt_pk_bf16_f32 v204, v216, v217
    v_cvt_pk_bf16_f32 v205, v218, v219
    v_cvt_pk_bf16_f32 v206, v220, v221
    v_cvt_pk_bf16_f32 v207, v222, v223
    v_cvt_pk_bf16_f32 v208, v224, v225
    v_cvt_pk_bf16_f32 v209, v226, v227
    v_cvt_pk_bf16_f32 v210, v228, v229
    v_cvt_pk_bf16_f32 v211, v230, v231
    v_cvt_pk_bf16_f32 v212, v232, v233
    v_cvt_pk_bf16_f32 v213, v234, v235
    v_cvt_pk_bf16_f32 v214, v236, v237
    v_cvt_pk_bf16_f32 v215, v238, v239
    v_cvt_pk_bf16_f32 v216, v240, v241
    v_cvt_pk_bf16_f32 v217, v242, v243
    v_cvt_pk_bf16_f32 v218, v244, v245
    v_cvt_pk_bf16_f32 v219, v246, v247
    v_cvt_pk_bf16_f32 v220, v248, v249
    v_cvt_pk_bf16_f32 v221, v250, v251
    v_cvt_pk_bf16_f32 v222, v252, v253
    v_cvt_pk_bf16_f32 v223, v254, v255
    v_accvgpr_read_b32 v24, a224
    v_accvgpr_read_b32 v25, a225
    v_accvgpr_read_b32 v26, a226
    v_accvgpr_read_b32 v27, a227
    v_accvgpr_read_b32 v28, a228
    v_accvgpr_read_b32 v29, a229
    v_accvgpr_read_b32 v30, a230
    v_accvgpr_read_b32 v31, a231
    v_cvt_pk_bf16_f32 v224, v24, v25
    v_cvt_pk_bf16_f32 v225, v26, v27
    v_cvt_pk_bf16_f32 v226, v28, v29
    v_cvt_pk_bf16_f32 v227, v30, v31
    v_accvgpr_read_b32 v24, a232
    v_accvgpr_read_b32 v25, a233
    v_accvgpr_read_b32 v26, a234
    v_accvgpr_read_b32 v27, a235
    v_accvgpr_read_b32 v28, a236
    v_accvgpr_read_b32 v29, a237
    v_accvgpr_read_b32 v30, a238
    v_accvgpr_read_b32 v31, a239
    v_cvt_pk_bf16_f32 v228, v24, v25
    v_cvt_pk_bf16_f32 v229, v26, v27
    v_cvt_pk_bf16_f32 v230, v28, v29
    v_cvt_pk_bf16_f32 v231, v30, v31
    v_accvgpr_read_b32 v24, a240
    v_accvgpr_read_b32 v25, a241
    v_accvgpr_read_b32 v26, a242
    v_accvgpr_read_b32 v27, a243
    v_accvgpr_read_b32 v28, a244
    v_accvgpr_read_b32 v29, a245
    v_accvgpr_read_b32 v30, a246
    v_accvgpr_read_b32 v31, a247
    v_cvt_pk_bf16_f32 v232, v24, v25
    v_cvt_pk_bf16_f32 v233, v26, v27
    v_cvt_pk_bf16_f32 v234, v28, v29
    v_cvt_pk_bf16_f32 v235, v30, v31
    v_accvgpr_read_b32 v24, a248
    v_accvgpr_read_b32 v25, a249
    v_accvgpr_read_b32 v26, a250
    v_accvgpr_read_b32 v27, a251
    v_accvgpr_read_b32 v28, a252
    v_accvgpr_read_b32 v29, a253
    v_accvgpr_read_b32 v30, a254
    v_accvgpr_read_b32 v31, a255
    v_cvt_pk_bf16_f32 v236, v24, v25
    v_cvt_pk_bf16_f32 v237, v26, v27
    v_cvt_pk_bf16_f32 v238, v28, v29
    v_cvt_pk_bf16_f32 v239, v30, v31
    v_cvt_pk_bf16_f32 v240, v160, v161
    v_cvt_pk_bf16_f32 v241, v162, v163
    v_cvt_pk_bf16_f32 v242, v164, v165
    v_cvt_pk_bf16_f32 v243, v166, v167
    v_cvt_pk_bf16_f32 v244, v168, v169
    v_cvt_pk_bf16_f32 v245, v170, v171
    v_cvt_pk_bf16_f32 v246, v172, v173
    v_cvt_pk_bf16_f32 v247, v174, v175
    v_cvt_pk_bf16_f32 v248, v176, v177
    v_cvt_pk_bf16_f32 v249, v178, v179
    v_cvt_pk_bf16_f32 v250, v180, v181
    v_cvt_pk_bf16_f32 v251, v182, v183
    v_cvt_pk_bf16_f32 v252, v184, v185
    v_cvt_pk_bf16_f32 v253, v186, v187
    v_cvt_pk_bf16_f32 v254, v188, v189
    v_cvt_pk_bf16_f32 v255, v190, v191
    s_setpc_b64 s[20:21]
m_pf7:
    s_mov_b32 s15, 0x20000
    s_sub_u32 s93, s2, 224
    s_lshl_b32 s93, s93, 2
    s_add_u32 s93, s93, s16
    v_lshlrev_b32 v24, 7, v1
    v_lshrrev_b32 v25, 3, v1
    v_lshlrev_b32 v25, 11, v25
    v_and_b32 v26, 7, v1
    v_lshl_add_u32 v25, v26, 7, v25
    s_lshl_b32 s92, s93, 13
    s_lshl_b32 s93, s93, 14
    s_add_u32 s93, s93, 1024
    s_mov_b32 s12, s26
    s_mov_b32 s13, s27
    s_mov_b32 s14, 6291456
    s_add_u32 s90, s92, 0
    buffer_load_dword v22, v24, s[12:15], s90 offen
    s_add_u32 s90, s92, 1048576
    buffer_load_dword v22, v24, s[12:15], s90 offen
    s_mov_b32 s12, s24
    s_mov_b32 s13, s25
    s_mov_b32 s14, 4194304
    s_add_u32 s90, s92, 0
    buffer_load_dword v22, v24, s[12:15], s90 offen
    s_add_u32 s90, s92, 1048576
    buffer_load_dword v22, v24, s[12:15], s90 offen
    s_add_u32 s90, s92, 2097152
    buffer_load_dword v22, v24, s[12:15], s90 offen
    s_add_u32 s90, s92, 3145728
    buffer_load_dword v22, v24, s[12:15], s90 offen
    s_mov_b32 s12, s34
    s_mov_b32 s13, s35
    s_mov_b32 s14, 8388608
    s_add_u32 s90, s92, 4194304
    buffer_load_dword v22, v24, s[12:15], s90 offen
    s_add_u32 s90, s92, 5242880
    buffer_load_dword v22, v24, s[12:15], s90 offen
    s_mov_b32 s12, s30
    s_mov_b32 s13, s31
    s_mov_b32 s14, 4194304
    s_add_u32 s90, s93, 0
    buffer_load_dword v22, v25, s[12:15], s90 offen
    s_add_u32 s90, s93, 2097152
    buffer_load_dword v22, v25, s[12:15], s90 offen
    s_mov_b32 s12, s26
    s_mov_b32 s13, s27
    s_mov_b32 s14, 6291456
    s_add_u32 s90, s92, 2097152
    buffer_load_dword v22, v24, s[12:15], s90 offen
    s_mov_b32 s12, s34
    s_mov_b32 s13, s35
    s_mov_b32 s14, 8388608
    s_add_u32 s90, s92, 6291456
    buffer_load_dword v22, v24, s[12:15], s90 offen
    s_add_u32 s90, s92, 7340032
    buffer_load_dword v22, v24, s[12:15], s90 offen
    s_mov_b32 s12, s26
    s_mov_b32 s13, s27
    s_mov_b32 s14, 6291456
    s_add_u32 s90, s92, 3145728
    buffer_load_dword v22, v24, s[12:15], s90 offen
    s_add_u32 s90, s92, 4194304
    buffer_load_dword v22, v24, s[12:15], s90 offen
    s_add_u32 s90, s92, 5242880
    buffer_load_dword v22, v24, s[12:15], s90 offen
    s_mov_b32 s12, s32
    s_mov_b32 s13, s33
    s_mov_b32 s14, 2097152
    s_add_u32 s90, s92, 1048576
    buffer_load_dword v22, v24, s[12:15], s90 offen
    s_branch m_nopf6
concat_heads__sliding_local_dilated__compressed_kv_cla__prompt_kernel_end:
.section .rodata,"a"
.p2align 6
.amdhsa_kernel concat_heads__sliding_local_dilated__compressed_kv_cla__prompt_kernel
  .amdhsa_next_free_vgpr 512
  .amdhsa_next_free_sgpr 102
  .amdhsa_accum_offset 256
  .amdhsa_group_segment_fixed_size 0
  .amdhsa_kernarg_size 96
  .amdhsa_user_sgpr_count 2
  .amdhsa_user_sgpr_kernarg_segment_ptr 1
  .amdhsa_system_sgpr_workgroup_id_x 1
.end_amdhsa_kernel
```

```asm
; @launch grid=(256,1,1) block=(256,1,1) lds=163840
.amdgcn_target "amdgcn-amd-amdhsa--gfx950"
.text
.globl concat_heads__sliding_local_dilated__compressed_kv_cla__prompt_kernel
.p2align 8
.type concat_heads__sliding_local_dilated__compressed_kv_cla__prompt_kernel,@function
concat_heads__sliding_local_dilated__compressed_kv_cla__prompt_kernel:
    s_cmp_ge_u32 s2, 256
    s_cbranch_scc1 m_end1
    s_load_dwordx16 s[24:39], s[0:1], 0
    s_load_dwordx4 s[4:7], s[0:1], 80
    v_and_b32 v1, 63, v0
    v_lshrrev_b32 v24, 6, v0
    s_nop 0
    v_readfirstlane_b32 s16, v24
    s_lshr_b32 s68, s2, 3
    s_lshr_b32 s57, s16, 1
    s_and_b32 s58, s16, 1
    s_mov_b32 s43, 0x20000
    s_mov_b32 s47, 0x20000
    s_cmp_lt_u32 s68, 28
    s_cbranch_scc1 m_ncp2
    s_sub_u32 s91, s68, 28
    s_lshl_b32 s91, s91, 2
    s_add_u32 s91, s91, s16
    s_getpc_b64 s[8:9]
m_pc3:
    s_sub_u32 s8, s8, m_pc3-concat_heads__sliding_local_dilated__compressed_kv_cla__prompt_kernel
    s_subb_u32 s9, s9, 0
    s_lshl_b32 s90, s91, 13
    v_lshlrev_b32 v24, 7, v1
    v_add_u32 v24, s90, v24
    v_min_u32 v24, concat_heads__sliding_local_dilated__compressed_kv_cla__prompt_kernel_end-concat_heads__sliding_local_dilated__compressed_kv_cla__prompt_kernel-4, v24
    v_mov_b32 v25, s9
    v_add_co_u32 v24, vcc, s8, v24
    s_nop 1
    v_addc_co_u32 v25, vcc, 0, v25, vcc
    global_load_dword v22, v[24:25], off
m_ncp2:
    s_lshl_b32 s61, s16, 13
    s_add_u32 s62, s61, 98304
    s_cmp_ge_u32 s68, 16
    s_cbranch_scc1 m_typea4
    s_and_b32 s69, s68, 3
    s_and_b32 s90, s2, 1
    s_lshl_b32 s90, s90, 2
    s_add_u32 s69, s69, s90
    s_bfe_u32 s90, s2, 0x20001
    s_mul_i32 s90, s90, 4
    s_bfe_u32 s91, s68, 0x20002
    s_add_u32 s90, s90, s91
    s_mov_b32 s76, 8388608
    s_mov_b32 s78, 8192
    s_mov_b32 s81, 0
    s_mov_b32 s73, 4194304
    s_mov_b32 s77, 2048
    s_mov_b32 s82, 16
    s_lshl_b32 s80, s90, 9
    s_lshl_b32 s79, s69, 19
    s_lshl_b32 s88, s90, 4
    s_add_u32 s88, s88, s69
    s_lshl_b32 s88, s88, 3
    s_mov_b32 s83, 0
    s_mov_b32 s84, 1040356334
    s_lshl_b32 s91, s90, 1
    s_add_u32 s91, s91, s58
    s_lshl_b32 s91, s91, 19
    s_lshl_b32 s92, s69, 1
    s_add_u32 s92, s92, s57
    s_lshl_b32 s92, s92, 15
    s_add_u32 s85, s91, s92
    s_add_u32 s85, s85, 0
    s_mov_b32 s86, 1024
    s_mov_b32 s87, 4096
    s_branch m_go15
m_typea4:
    s_bfe_u32 s69, s68, 0x20002
    s_add_u32 s69, s69, 0
    s_and_b32 s90, s2, 7
    s_lshl_b32 s90, s90, 2
    s_and_b32 s91, s68, 3
    s_add_u32 s90, s90, s91
    s_cmp_lt_u32 s90, 16
    s_cselect_b32 s83, 0, 1
    s_mov_b32 s91, 33554432
    s_cselect_b32 s85, 16777216, s91
    s_mov_b32 s91, 8192
    s_cselect_b32 s86, 1024, s91
    s_mov_b32 s91, 1024
    s_cselect_b32 s87, 4096, s91
    s_mov_b32 s73, 2097152
    s_mov_b32 s77, 1024
    s_mov_b32 s82, 8
    s_mov_b32 s81, 0
    s_mov_b32 s76, 4194304
    s_mov_b32 s78, 8192
    s_mov_b32 s84, 0
    s_and_b32 s90, s90, 15
    s_lshl_b32 s80, s90, 9
    s_lshl_b32 s79, s69, 18
    s_lshl_b32 s91, s83, 2
    s_add_u32 s91, s91, s69
    s_cmp_ge_u32 s69, 4
    s_cselect_b32 s92, 508, 8
    s_add_u32 s91, s91, s92
    s_lshl_b32 s88, s90, 4
    s_add_u32 s88, s88, s91
    s_lshl_b32 s88, s88, 3
    s_lshl_b32 s91, s90, 1
    s_add_u32 s91, s91, s58
    s_lshl_b32 s91, s91, 19
    s_lshl_b32 s92, s69, 1
    s_add_u32 s92, s92, s57
    s_lshl_b32 s92, s92, 15
    s_add_u32 s85, s85, s91
    s_add_u32 s85, s85, s92
m_go15:
    s_mov_b32 s42, s73
    s_lshl_b32 s90, s77, 4
    s_lshl_b32 s90, s90, s81
    s_mov_b32 s48, s79
    s_mul_i32 s91, s90, 1
    s_add_u32 s49, s91, s79
    s_sub_u32 s49, s49, 2048
    s_mul_i32 s91, s90, 2
    s_add_u32 s50, s91, s79
    s_mul_i32 s91, s90, 3
    s_add_u32 s51, s91, s79
    s_sub_u32 s51, s51, 2048
    s_lshl_b32 s90, s58, 7
    s_add_u32 s90, s90, s57
    s_lshl_b32 s91, s16, 6
    s_cmp_eq_u32 s81, 1
    s_cselect_b32 s90, s90, s91
    v_lshrrev_b32 v24, 3, v1
    v_lshlrev_b32 v24, s81, v24
    v_add_u32 v24, s90, v24
    v_mul_lo_u32 v24, v24, s77
    v_lshrrev_b32 v25, 4, v1
    v_and_b32 v26, 7, v1
    v_xor_b32 v25, v25, v26
    v_lshl_add_u32 v16, v25, 4, v24
    v_xor_b32 v25, 4, v25
    v_lshl_add_u32 v17, v25, 4, v24
    s_lshl_b32 s90, s77, 3
    s_lshl_b32 s90, s90, s81
    s_sub_u32 s90, s90, 1024
    v_add_u32 v17, s90, v17
    s_mov_b32 s46, s76
    s_mov_b32 s52, s80
    s_lshl_b32 s90, s78, 2
    s_mul_i32 s91, s90, 1
    s_add_u32 s53, s91, s80
    s_sub_u32 s53, s53, 2048
    s_mul_i32 s91, s90, 2
    s_add_u32 s54, s91, s80
    s_mul_i32 s91, s90, 3
    s_add_u32 s55, s91, s80
    s_sub_u32 s55, s55, 2048
    s_lshl_b32 s56, s78, 6
    v_lshrrev_b32 v24, 5, v1
    s_lshl_b32 s90, s16, 4
    v_add_u32 v25, s90, v24
    v_mul_lo_u32 v25, v25, s78
    v_lshlrev_b32 v24, 1, v24
    v_and_b32 v26, 31, v1
    v_xor_b32 v24, v24, v26
    s_lshl_b32 s90, s78, 1
    s_sub_u32 s90, s90, 1024
    v_add_u32 v27, s90, v25
    v_xor_b32 v26, 0, v24
    v_lshl_add_u32 v18, v26, 4, v25
    v_xor_b32 v26, 4, v24
    v_lshl_add_u32 v19, v26, 4, v27
    v_xor_b32 v26, 8, v24
    v_lshl_add_u32 v20, v26, 4, v25
    v_xor_b32 v26, 12, v24
    v_lshl_add_u32 v21, v26, 4, v27
    s_cmp_eq_u32 s83, 0
    s_waitcnt lgkmcnt(0)
    s_cselect_b32 s44, s36, s38
    s_cselect_b32 s45, s37, s39
    s_cmp_lt_u32 s68, 16
    s_cselect_b32 s44, s34, s44
    s_cselect_b32 s45, s35, s45
    s_cselect_b32 s40, s30, s32
    s_cselect_b32 s41, s31, s33
    s_cmp_ge_u32 s68, 28
    s_cselect_b32 s70, 1, 0
    s_cbranch_scc1 m_pf7
m_nopf6:
    s_add_u32 m0, s61, 0
    s_nop 0
    buffer_load_dwordx4 v16, s[40:43], s48 offen offset:0 sc1 lds
    buffer_load_dwordx4 v17, s[40:43], s48 offen offset:1024 sc1 lds
    s_add_u32 s48, s48, 128
    buffer_load_dwordx4 v16, s[40:43], s49 offen offset:2048 sc1 lds
    buffer_load_dwordx4 v17, s[40:43], s49 offen offset:3072 sc1 lds
    s_add_u32 s49, s49, 128
    s_add_u32 m0, s61, 4096
    s_nop 0
    buffer_load_dwordx4 v16, s[40:43], s50 offen offset:0 sc1 lds
    buffer_load_dwordx4 v17, s[40:43], s50 offen offset:1024 sc1 lds
    s_add_u32 s50, s50, 128
    buffer_load_dwordx4 v16, s[40:43], s51 offen offset:2048 sc1 lds
    buffer_load_dwordx4 v17, s[40:43], s51 offen offset:3072 sc1 lds
    s_add_u32 s51, s51, 128
    s_add_u32 s61, s61, 32768
    s_cmp_ge_u32 s61, 98304
    s_cselect_b32 s90, 98304, 0
    s_sub_u32 s61, s61, s90
    s_add_u32 m0, s62, 0
    s_nop 0
    buffer_load_dwordx4 v18, s[44:47], s52 offen offset:0 sc1 lds
    buffer_load_dwordx4 v19, s[44:47], s52 offen offset:1024 sc1 lds
    s_add_u32 s52, s52, s56
    buffer_load_dwordx4 v18, s[44:47], s53 offen offset:2048 sc1 lds
    buffer_load_dwordx4 v19, s[44:47], s53 offen offset:3072 sc1 lds
    s_add_u32 s53, s53, s56
    s_add_u32 m0, s62, 4096
    s_nop 0
    buffer_load_dwordx4 v20, s[44:47], s54 offen offset:0 sc1 lds
    buffer_load_dwordx4 v21, s[44:47], s54 offen offset:1024 sc1 lds
    s_add_u32 s54, s54, s56
    buffer_load_dwordx4 v20, s[44:47], s55 offen offset:2048 sc1 lds
    buffer_load_dwordx4 v21, s[44:47], s55 offen offset:3072 sc1 lds
    s_add_u32 s55, s55, s56
    s_xor_b32 s62, s62, 229376
    s_mov_b32 s95, s82
    s_mov_b32 s96, s83
    s_mov_b32 s97, s84
    s_mov_b32 s98, s85
    s_mov_b32 s99, s86
    s_mov_b32 s100, s87
    s_mov_b32 s101, s88
    v_and_b32 v24, 15, v1
    v_lshrrev_b32 v25, 4, v1
    v_bfe_u32 v26, v1, 1, 3
    v_xor_b32 v26, v26, v25
    s_lshl_b32 s90, s57, 14
    v_lshlrev_b32 v27, 7, v24
    v_add_u32 v27, s90, v27
    v_xor_b32 v28, 0, v26
    v_lshl_add_u32 v6, v28, 4, v27
    v_xor_b32 v28, 4, v26
    v_lshl_add_u32 v7, v28, 4, v27
    v_bfe_u32 v26, v1, 2, 2
    v_lshl_add_u32 v27, v25, 3, v26
    v_lshlrev_b32 v27, 9, v27
    v_and_b32 v28, 3, v1
    v_lshlrev_b32 v28, 3, v28
    v_add_u32 v27, v27, v28
    s_lshl_b32 s90, s58, 8
    s_add_u32 s90, s90, 98304
    v_add_u32 v27, s90, v27
    v_bfe_u32 v26, v1, 2, 3
    v_xor_b32 v28, 0, v26
    v_lshl_add_u32 v8, v28, 5, v27
    v_xor_b32 v28, 1, v26
    v_lshl_add_u32 v9, v28, 5, v27
    v_xor_b32 v28, 2, v26
    v_lshl_add_u32 v10, v28, 5, v27
    v_xor_b32 v28, 3, v26
    v_lshl_add_u32 v11, v28, 5, v27
    v_xor_b32 v28, 4, v26
    v_lshl_add_u32 v12, v28, 5, v27
    v_xor_b32 v28, 5, v26
    v_lshl_add_u32 v13, v28, 5, v27
    v_xor_b32 v28, 6, v26
    v_lshl_add_u32 v14, v28, 5, v27
    v_xor_b32 v28, 7, v26
    v_lshl_add_u32 v15, v28, 5, v27
    v_lshlrev_b32 v2, 4, v1
    s_mov_b32 s64, 0
    s_mov_b32 s59, 32768
    s_mov_b32 s60, 229376
    s_mov_b32 s8, s6
    s_mov_b32 s9, s7
    s_mov_b32 s10, 268435456
    s_mov_b32 s11, 0x20000
    s_cmp_ge_u32 s68, 16
    s_cbranch_scc1 m_typea8
    s_bfe_u32 s69, s68, 0x20002
    s_add_u32 s69, s69, 4
    s_and_b32 s90, s2, 7
    s_lshl_b32 s90, s90, 2
    s_and_b32 s91, s68, 3
    s_add_u32 s90, s90, s91
    s_cmp_lt_u32 s90, 16
    s_cselect_b32 s83, 0, 1
    s_mov_b32 s91, 33554432
    s_cselect_b32 s85, 16777216, s91
    s_mov_b32 s91, 8192
    s_cselect_b32 s86, 1024, s91
    s_mov_b32 s91, 1024
    s_cselect_b32 s87, 4096, s91
    s_cselect_b32 s74, s36, s38
    s_cselect_b32 s75, s37, s39
    s_mov_b32 s71, s32
    s_mov_b32 s72, s33
    s_mov_b32 s73, 2097152
    s_mov_b32 s77, 1024
    s_mov_b32 s82, 8
    s_mov_b32 s81, 0
    s_mov_b32 s76, 4194304
    s_mov_b32 s78, 8192
    s_mov_b32 s84, 0
    s_and_b32 s90, s90, 15
    s_lshl_b32 s80, s90, 9
    s_lshl_b32 s79, s69, 18
    s_lshl_b32 s91, s83, 2
    s_add_u32 s91, s91, s69
    s_cmp_ge_u32 s69, 4
    s_cselect_b32 s92, 508, 8
    s_add_u32 s91, s91, s92
    s_lshl_b32 s88, s90, 4
    s_add_u32 s88, s88, s91
    s_lshl_b32 s88, s88, 3
    s_lshl_b32 s91, s90, 1
    s_add_u32 s91, s91, s58
    s_lshl_b32 s91, s91, 19
    s_lshl_b32 s92, s69, 1
    s_add_u32 s92, s92, s57
    s_lshl_b32 s92, s92, 15
    s_add_u32 s85, s85, s91
    s_add_u32 s85, s85, s92
    s_branch m_go29
m_typea8:
    s_and_b32 s69, s68, 3
    s_and_b32 s90, s2, 1
    s_lshl_b32 s90, s90, 2
    s_add_u32 s69, s69, s90
    s_bfe_u32 s90, s2, 0x20001
    s_mul_i32 s90, s90, 3
    s_bfe_u32 s91, s68, 0x20002
    s_add_u32 s90, s90, s91
    s_mov_b32 s76, 6291456
    s_mov_b32 s78, 6144
    s_mov_b32 s81, 1
    s_mov_b32 s73, 4194304
    s_mov_b32 s77, 2048
    s_mov_b32 s82, 16
    s_lshl_b32 s80, s90, 9
    s_lshl_b32 s79, s69, 19
    s_and_b32 s92, s90, 3
    s_lshr_b32 s91, s90, 2
    s_lshl_b32 s88, s92, 2
    s_add_u32 s88, s88, s91
    s_lshl_b32 s88, s88, 3
    s_add_u32 s88, s88, s69
    s_lshl_b32 s88, s88, 3
    s_add_u32 s88, s88, 6144
    s_cmp_eq_u32 s91, 0
    s_cselect_b32 s84, 1048744942, 0
    s_lshl_b32 s93, s91, 22
    s_add_u32 s85, s93, 50331648
    s_lshl_b32 s92, s92, 1
    s_add_u32 s92, s92, s58
    s_lshl_b32 s92, s92, 19
    s_add_u32 s85, s85, s92
    s_lshl_b32 s92, s57, 3
    s_add_u32 s92, s92, s69
    s_cmp_eq_u32 s91, 2
    s_cselect_b32 s83, 1, 0
    s_cselect_b32 s93, 12, 13
    s_mov_b32 s91, 131072
    s_cselect_b32 s86, 1024, s91
    s_mov_b32 s91, 1024
    s_cselect_b32 s87, 65536, s91
    s_lshl_b32 s92, s92, s93
    s_add_u32 s85, s85, s92
    s_mov_b32 s71, s24
    s_mov_b32 s72, s25
    s_mov_b32 s74, s26
    s_mov_b32 s75, s27
m_go29:
    s_xor_b32 s94, s70, 1
    s_add_u32 s67, s70, 3
    s_mov_b32 s17, -1
    s_mul_i32 s64, s70, 32768
    v_add_u32 v6, s64, v6
    v_add_u32 v7, s64, v7
    s_mov_b32 s12, s4
    s_mov_b32 s13, s5
    s_mov_b32 s14, 256
    s_mov_b32 s15, 0x20000
    s_lshl_b32 s90, s2, 2
    s_add_u32 s90, s90, s16
    s_cmp_lg_u32 s90, 0
    s_cbranch_scc1 m_tok10
    s_memrealtime s[92:93]
    s_waitcnt lgkmcnt(0)
    s_or_b32 s92, s92, 1
    v_mov_b32 v4, s92
    v_mov_b32 v5, s93
    s_mov_b64 exec, 1
    buffer_store_dwordx2 v[4:5], off, s[12:15], 0 sc1
    s_mov_b64 exec, -1
m_tok10:
    s_cmp_eq_u32 s70, 0
    s_cbranch_scc1 m_tok11
    buffer_load_dwordx2 v[4:5], off, s[12:15], 0 sc1
    s_waitcnt vmcnt(0)
    s_mov_b32 s3, 1048576
m_spin12:
    v_readfirstlane_b32 s4, v4
    v_readfirstlane_b32 s5, v5
    s_nop 3
    s_cmp_lg_u32 s4, 0
    s_cbranch_scc1 m_ok13
    s_sub_u32 s3, s3, 1
    s_cbranch_scc1 m_ok13
    s_sleep 32
    buffer_load_dwordx2 v[4:5], off, s[12:15], 0 sc1
    s_waitcnt vmcnt(0)
    s_branch m_spin12
m_ok13:
m_tok11:
    s_add_u32 m0, s61, 0
    s_nop 0
    buffer_load_dwordx4 v16, s[40:43], s48 offen offset:0 sc1 lds
    buffer_load_dwordx4 v17, s[40:43], s48 offen offset:1024 sc1 lds
    s_add_u32 s48, s48, 128
    buffer_load_dwordx4 v16, s[40:43], s49 offen offset:2048 sc1 lds
    buffer_load_dwordx4 v17, s[40:43], s49 offen offset:3072 sc1 lds
    s_add_u32 s49, s49, 128
    s_add_u32 m0, s61, 4096
    s_nop 0
    buffer_load_dwordx4 v16, s[40:43], s50 offen offset:0 sc1 lds
    buffer_load_dwordx4 v17, s[40:43], s50 offen offset:1024 sc1 lds
    s_add_u32 s50, s50, 128
    buffer_load_dwordx4 v16, s[40:43], s51 offen offset:2048 sc1 lds
    buffer_load_dwordx4 v17, s[40:43], s51 offen offset:3072 sc1 lds
    s_add_u32 s51, s51, 128
    s_add_u32 s61, s61, 32768
    s_cmp_ge_u32 s61, 98304
    s_cselect_b32 s90, 98304, 0
    s_sub_u32 s61, s61, s90
    s_add_u32 m0, s62, 0
    s_nop 0
    buffer_load_dwordx4 v18, s[44:47], s52 offen offset:0 sc1 lds
    buffer_load_dwordx4 v19, s[44:47], s52 offen offset:1024 sc1 lds
    s_add_u32 s52, s52, s56
    buffer_load_dwordx4 v18, s[44:47], s53 offen offset:2048 sc1 lds
    buffer_load_dwordx4 v19, s[44:47], s53 offen offset:3072 sc1 lds
    s_add_u32 s53, s53, s56
    s_add_u32 m0, s62, 4096
    s_nop 0
    buffer_load_dwordx4 v20, s[44:47], s54 offen offset:0 sc1 lds
    buffer_load_dwordx4 v21, s[44:47], s54 offen offset:1024 sc1 lds
    s_add_u32 s54, s54, s56
    buffer_load_dwordx4 v20, s[44:47], s55 offen offset:2048 sc1 lds
    buffer_load_dwordx4 v21, s[44:47], s55 offen offset:3072 sc1 lds
    s_add_u32 s55, s55, s56
    s_xor_b32 s62, s62, 229376
    s_waitcnt vmcnt(16)
    s_barrier
    ds_read_b64_tr_b16 a[64:65], v8 offset:0
    ds_read_b64_tr_b16 a[66:67], v8 offset:2048
    ds_read_b64_tr_b16 a[68:69], v8 offset:16384
    ds_read_b64_tr_b16 a[70:71], v8 offset:18432
    ds_read_b64_tr_b16 a[72:73], v9 offset:0
    ds_read_b64_tr_b16 a[74:75], v9 offset:2048
    ds_read_b64_tr_b16 a[76:77], v9 offset:16384
    ds_read_b64_tr_b16 a[78:79], v9 offset:18432
    ds_read_b64_tr_b16 a[80:81], v10 offset:0
    ds_read_b64_tr_b16 a[82:83], v10 offset:2048
    ds_read_b64_tr_b16 a[84:85], v10 offset:16384
    ds_read_b64_tr_b16 a[86:87], v10 offset:18432
    ds_read_b64_tr_b16 a[88:89], v11 offset:0
    ds_read_b64_tr_b16 a[90:91], v11 offset:2048
    ds_read_b64_tr_b16 a[92:93], v11 offset:16384
    ds_read_b64_tr_b16 a[94:95], v11 offset:18432
    ds_read_b64_tr_b16 a[96:97], v12 offset:0
    ds_read_b128 a[0:3], v6 offset:0
    ds_read_b128 a[4:7], v7 offset:0
    ds_read_b64_tr_b16 a[98:99], v12 offset:2048
    ds_read_b128 a[8:11], v6 offset:2048
    ds_read_b128 a[12:15], v7 offset:2048
    ds_read_b64_tr_b16 a[100:101], v12 offset:16384
    ds_read_b128 a[16:19], v6 offset:4096
    ds_read_b128 a[20:23], v7 offset:4096
    ds_read_b64_tr_b16 a[102:103], v12 offset:18432
    ds_read_b128 a[24:27], v6 offset:6144
    ds_read_b128 a[28:31], v7 offset:6144
    ds_read_b64_tr_b16 a[104:105], v13 offset:0
    ds_read_b128 a[32:35], v6 offset:8192
    ds_read_b128 a[36:39], v7 offset:8192
    ds_read_b64_tr_b16 a[106:107], v13 offset:2048
    ds_read_b128 a[40:43], v6 offset:10240
    ds_read_b128 a[44:47], v7 offset:10240
    ds_read_b64_tr_b16 a[108:109], v13 offset:16384
    ds_read_b128 a[48:51], v6 offset:12288
    ds_read_b128 a[52:55], v7 offset:12288
    ds_read_b64_tr_b16 a[110:111], v13 offset:18432
    ds_read_b128 a[56:59], v6 offset:14336
    ds_read_b128 a[60:63], v7 offset:14336
    s_add_u32 m0, s61, 0
    s_nop 0
    buffer_load_dwordx4 v16, s[40:43], s48 offen offset:0 sc1 lds
    buffer_load_dwordx4 v17, s[40:43], s48 offen offset:1024 sc1 lds
    s_add_u32 s48, s48, 128
    buffer_load_dwordx4 v16, s[40:43], s49 offen offset:2048 sc1 lds
    buffer_load_dwordx4 v17, s[40:43], s49 offen offset:3072 sc1 lds
    s_add_u32 s49, s49, 128
    s_add_u32 m0, s61, 4096
    s_nop 0
    buffer_load_dwordx4 v16, s[40:43], s50 offen offset:0 sc1 lds
    buffer_load_dwordx4 v17, s[40:43], s50 offen offset:1024 sc1 lds
    s_add_u32 s50, s50, 128
    buffer_load_dwordx4 v16, s[40:43], s51 offen offset:2048 sc1 lds
    buffer_load_dwordx4 v17, s[40:43], s51 offen offset:3072 sc1 lds
    s_add_u32 s51, s51, 128
    s_add_u32 s61, s61, 32768
    s_cmp_ge_u32 s61, 98304
    s_cselect_b32 s90, 98304, 0
    s_sub_u32 s61, s61, s90
    s_mov_b32 s66, 1
    s_mov_b32 s24, s6
    s_mov_b32 s25, s7
    s_mov_b32 s26, 0
    s_mov_b32 s27, 0x20000
    s_mov_b32 s28, 0
    s_mov_b32 s29, 0
    s_mov_b32 s30, 0
    s_mov_b32 s31, 0
m_tile14:
    s_mov_b32 s65, s95
    s_cmp_eq_u32 s96, 1
    s_cbranch_scc1 m_swp16
    s_waitcnt lgkmcnt(15)
    v_mfma_f32_16x16x32_bf16 v[32:35], a[64:67], a[0:3], 0
    ds_read_b64_tr_b16 a[112:113], v14 offset:0
    v_mfma_f32_16x16x32_bf16 v[32:35], a[68:71], a[4:7], v[32:35]
    ds_read_b64_tr_b16 a[114:115], v14 offset:2048
    v_mfma_f32_16x16x32_bf16 v[36:39], a[76:79], a[4:7], 0
    ds_read_b64_tr_b16 a[116:117], v14 offset:16384
    v_mfma_f32_16x16x32_bf16 v[36:39], a[72:75], a[0:3], v[36:39]
    ds_read_b64_tr_b16 a[118:119], v14 offset:18432
    v_mfma_f32_16x16x32_bf16 v[44:47], a[72:75], a[8:11], 0
    ds_read_b64_tr_b16 a[120:121], v15 offset:0
    v_mfma_f32_16x16x32_bf16 v[44:47], a[76:79], a[12:15], v[44:47]
    ds_read_b64_tr_b16 a[122:123], v15 offset:2048
    v_mfma_f32_16x16x32_bf16 v[40:43], a[68:71], a[12:15], 0
    ds_read_b64_tr_b16 a[124:125], v15 offset:16384
    v_mfma_f32_16x16x32_bf16 v[40:43], a[64:67], a[8:11], v[40:43]
    ds_read_b64_tr_b16 a[126:127], v15 offset:18432
    v_mfma_f32_16x16x32_bf16 v[48:51], a[64:67], a[16:19], 0
    v_mfma_f32_16x16x32_bf16 v[48:51], a[68:71], a[20:23], v[48:51]
    v_mfma_f32_16x16x32_bf16 v[52:55], a[76:79], a[20:23], 0
    buffer_store_dwordx4 a[128:131], v2, s[24:27], s28 offen sc1
    v_mfma_f32_16x16x32_bf16 v[52:55], a[72:75], a[16:19], v[52:55]
    s_add_u32 s28, s28, s31
    s_waitcnt lgkmcnt(15)
    v_mfma_f32_16x16x32_bf16 v[60:63], a[72:75], a[24:27], 0
    v_xor_b32 v8, s60, v8
    v_xor_b32 v9, s60, v9
    v_mfma_f32_16x16x32_bf16 v[60:63], a[76:79], a[28:31], v[60:63]
    v_xor_b32 v10, s60, v10
    v_xor_b32 v11, s60, v11
    v_mfma_f32_16x16x32_bf16 v[56:59], a[68:71], a[28:31], 0
    v_xor_b32 v12, s60, v12
    v_xor_b32 v13, s60, v13
    v_mfma_f32_16x16x32_bf16 v[56:59], a[64:67], a[24:27], v[56:59]
    v_xor_b32 v14, s60, v14
    v_xor_b32 v15, s60, v15
    v_mfma_f32_16x16x32_bf16 v[64:67], a[64:67], a[32:35], 0
    buffer_store_dwordx4 a[132:135], v2, s[24:27], s28 offen sc1
    v_mfma_f32_16x16x32_bf16 v[64:67], a[68:71], a[36:39], v[64:67]
    s_add_u32 s28, s28, s31
    v_mfma_f32_16x16x32_bf16 v[68:71], a[76:79], a[36:39], 0
    v_mfma_f32_16x16x32_bf16 v[68:71], a[72:75], a[32:35], v[68:71]
    s_waitcnt lgkmcnt(14)
    v_mfma_f32_16x16x32_bf16 v[76:79], a[72:75], a[40:43], 0
    v_mfma_f32_16x16x32_bf16 v[76:79], a[76:79], a[44:47], v[76:79]
    v_mfma_f32_16x16x32_bf16 v[72:75], a[68:71], a[44:47], 0
    buffer_store_dwordx4 a[136:139], v2, s[24:27], s28 offen sc1
    v_mfma_f32_16x16x32_bf16 v[72:75], a[64:67], a[40:43], v[72:75]
    s_add_u32 s28, s28, s31
    s_waitcnt lgkmcnt(11)
    v_mfma_f32_16x16x32_bf16 v[80:83], a[64:67], a[48:51], 0
    v_mfma_f32_16x16x32_bf16 v[80:83], a[68:71], a[52:55], v[80:83]
    v_mfma_f32_16x16x32_bf16 v[84:87], a[76:79], a[52:55], 0
    v_mfma_f32_16x16x32_bf16 v[84:87], a[72:75], a[48:51], v[84:87]
    s_waitcnt lgkmcnt(8)
    v_mfma_f32_16x16x32_bf16 v[92:95], a[72:75], a[56:59], 0
    buffer_store_dwordx4 a[140:143], v2, s[24:27], s28 offen sc1
    v_mfma_f32_16x16x32_bf16 v[92:95], a[76:79], a[60:63], v[92:95]
    s_add_u32 s28, s28, s31
    v_mfma_f32_16x16x32_bf16 v[88:91], a[68:71], a[60:63], 0
    s_waitcnt vmcnt(12) lgkmcnt(0)
    v_mfma_f32_16x16x32_bf16 v[88:91], a[64:67], a[56:59], v[88:91]
    s_barrier
    v_mfma_f32_16x16x32_bf16 v[96:99], a[80:83], a[0:3], 0
    ds_read_b64_tr_b16 a[64:65], v8 offset:0
    v_mfma_f32_16x16x32_bf16 v[96:99], a[84:87], a[4:7], v[96:99]
    s_add_u32 m0, s62, 0
    v_mfma_f32_16x16x32_bf16 v[100:103], a[92:95], a[4:7], 0
    buffer_load_dwordx4 v18, s[44:47], s52 offen offset:0 sc1 lds
    v_mfma_f32_16x16x32_bf16 v[100:103], a[88:91], a[0:3], v[100:103]
    ds_read_b64_tr_b16 a[66:67], v8 offset:2048
    v_mfma_f32_16x16x32_bf16 v[108:111], a[88:91], a[8:11], 0
    s_add_u32 s64, s64, 32768
    v_mfma_f32_16x16x32_bf16 v[108:111], a[92:95], a[12:15], v[108:111]
    s_cmp_ge_u32 s64, 98304
    s_cselect_b32 s63, 4294901760, s59
    s_cselect_b32 s64, 0, s64
    v_mfma_f32_16x16x32_bf16 v[104:107], a[84:87], a[12:15], 0
    buffer_load_dwordx4 v19, s[44:47], s52 offen offset:1024 sc1 lds
    v_mfma_f32_16x16x32_bf16 v[104:107], a[80:83], a[8:11], v[104:107]
    s_add_u32 s52, s52, s56
    ds_read_b64_tr_b16 a[68:69], v8 offset:16384
    v_mfma_f32_16x16x32_bf16 v[112:115], a[80:83], a[16:19], 0
    v_mfma_f32_16x16x32_bf16 v[112:115], a[84:87], a[20:23], v[112:115]
    v_mfma_f32_16x16x32_bf16 v[116:119], a[92:95], a[20:23], 0
    buffer_load_dwordx4 v18, s[44:47], s53 offen offset:2048 sc1 lds
    v_mfma_f32_16x16x32_bf16 v[116:119], a[88:91], a[16:19], v[116:119]
    ds_read_b64_tr_b16 a[70:71], v8 offset:18432
    v_mfma_f32_16x16x32_bf16 v[124:127], a[88:91], a[24:27], 0
    v_mfma_f32_16x16x32_bf16 v[124:127], a[92:95], a[28:31], v[124:127]
    v_mfma_f32_16x16x32_bf16 v[120:123], a[84:87], a[28:31], 0
    buffer_load_dwordx4 v19, s[44:47], s53 offen offset:3072 sc1 lds
    v_mfma_f32_16x16x32_bf16 v[120:123], a[80:83], a[24:27], v[120:123]
    s_add_u32 s53, s53, s56
    ds_read_b64_tr_b16 a[72:73], v9 offset:0
    v_mfma_f32_16x16x32_bf16 v[128:131], a[80:83], a[32:35], 0
    v_mfma_f32_16x16x32_bf16 v[128:131], a[84:87], a[36:39], v[128:131]
    s_add_u32 m0, s62, 4096
    v_mfma_f32_16x16x32_bf16 v[132:135], a[92:95], a[36:39], 0
    buffer_load_dwordx4 v20, s[44:47], s54 offen offset:0 sc1 lds
    v_mfma_f32_16x16x32_bf16 v[132:135], a[88:91], a[32:35], v[132:135]
    s_xor_b32 s62, s62, 229376
    ds_read_b64_tr_b16 a[74:75], v9 offset:2048
    v_mfma_f32_16x16x32_bf16 v[140:143], a[88:91], a[40:43], 0
    v_mfma_f32_16x16x32_bf16 v[140:143], a[92:95], a[44:47], v[140:143]
    v_mfma_f32_16x16x32_bf16 v[136:139], a[84:87], a[44:47], 0
    buffer_load_dwordx4 v21, s[44:47], s54 offen offset:1024 sc1 lds
    v_mfma_f32_16x16x32_bf16 v[136:139], a[80:83], a[40:43], v[136:139]
    s_add_u32 s54, s54, s56
    ds_read_b64_tr_b16 a[76:77], v9 offset:16384
    v_mfma_f32_16x16x32_bf16 v[144:147], a[80:83], a[48:51], 0
    v_mfma_f32_16x16x32_bf16 v[144:147], a[84:87], a[52:55], v[144:147]
    v_mfma_f32_16x16x32_bf16 v[148:151], a[92:95], a[52:55], 0
    buffer_load_dwordx4 v20, s[44:47], s55 offen offset:2048 sc1 lds
    v_mfma_f32_16x16x32_bf16 v[148:151], a[88:91], a[48:51], v[148:151]
    ds_read_b64_tr_b16 a[78:79], v9 offset:18432
    v_mfma_f32_16x16x32_bf16 v[156:159], a[88:91], a[56:59], 0
    v_add_u32 v6, s63, v6
    v_add_u32 v7, s63, v7
    v_mfma_f32_16x16x32_bf16 v[156:159], a[92:95], a[60:63], v[156:159]
    v_mfma_f32_16x16x32_bf16 v[152:155], a[84:87], a[60:63], 0
    buffer_load_dwordx4 v21, s[44:47], s55 offen offset:3072 sc1 lds
    v_mfma_f32_16x16x32_bf16 v[152:155], a[80:83], a[56:59], v[152:155]
    s_add_u32 s55, s55, s56
    v_mfma_f32_16x16x32_bf16 v[160:163], a[96:99], a[0:3], 0
    ds_read_b64_tr_b16 a[80:81], v10 offset:0
    v_mfma_f32_16x16x32_bf16 v[160:163], a[100:103], a[4:7], v[160:163]
    v_mfma_f32_16x16x32_bf16 v[164:167], a[108:111], a[4:7], 0
    v_mfma_f32_16x16x32_bf16 v[164:167], a[104:107], a[0:3], v[164:167]
    s_add_u32 m0, s61, 0
    ds_read_b64_tr_b16 a[82:83], v10 offset:2048
    v_mfma_f32_16x16x32_bf16 v[172:175], a[104:107], a[8:11], 0
    buffer_load_dwordx4 v16, s[40:43], s48 offen offset:0 sc1 lds
    v_mfma_f32_16x16x32_bf16 v[172:175], a[108:111], a[12:15], v[172:175]
    v_mfma_f32_16x16x32_bf16 v[168:171], a[100:103], a[12:15], 0
    ds_read_b64_tr_b16 a[84:85], v10 offset:16384
    v_mfma_f32_16x16x32_bf16 v[168:171], a[96:99], a[8:11], v[168:171]
    v_mfma_f32_16x16x32_bf16 v[176:179], a[96:99], a[16:19], 0
    buffer_store_dwordx4 a[144:147], v2, s[24:27], s28 offen sc1
    v_mfma_f32_16x16x32_bf16 v[176:179], a[100:103], a[20:23], v[176:179]
    s_add_u32 s28, s28, s31
    ds_read_b64_tr_b16 a[86:87], v10 offset:18432
    v_mfma_f32_16x16x32_bf16 v[180:183], a[108:111], a[20:23], 0
    v_mfma_f32_16x16x32_bf16 v[180:183], a[104:107], a[16:19], v[180:183]
    v_mfma_f32_16x16x32_bf16 v[188:191], a[104:107], a[24:27], 0
    buffer_load_dwordx4 v17, s[40:43], s48 offen offset:1024 sc1 lds
    v_mfma_f32_16x16x32_bf16 v[188:191], a[108:111], a[28:31], v[188:191]
    s_add_u32 s48, s48, 128
    ds_read_b64_tr_b16 a[88:89], v11 offset:0
    v_mfma_f32_16x16x32_bf16 v[184:187], a[100:103], a[28:31], 0
    v_mfma_f32_16x16x32_bf16 v[184:187], a[96:99], a[24:27], v[184:187]
    v_mfma_f32_16x16x32_bf16 v[192:195], a[96:99], a[32:35], 0
    buffer_store_dwordx4 a[148:151], v2, s[24:27], s28 offen sc1
    v_mfma_f32_16x16x32_bf16 v[192:195], a[100:103], a[36:39], v[192:195]
    s_add_u32 s28, s28, s31
    ds_read_b64_tr_b16 a[90:91], v11 offset:2048
    v_mfma_f32_16x16x32_bf16 v[196:199], a[108:111], a[36:39], 0
    v_mfma_f32_16x16x32_bf16 v[196:199], a[104:107], a[32:35], v[196:199]
    v_mfma_f32_16x16x32_bf16 v[204:207], a[104:107], a[40:43], 0
    buffer_load_dwordx4 v16, s[40:43], s49 offen offset:2048 sc1 lds
    v_mfma_f32_16x16x32_bf16 v[204:207], a[108:111], a[44:47], v[204:207]
    ds_read_b64_tr_b16 a[92:93], v11 offset:16384
    v_mfma_f32_16x16x32_bf16 v[200:203], a[100:103], a[44:47], 0
    v_mfma_f32_16x16x32_bf16 v[200:203], a[96:99], a[40:43], v[200:203]
    v_mfma_f32_16x16x32_bf16 v[208:211], a[96:99], a[48:51], 0
    buffer_store_dwordx4 a[152:155], v2, s[24:27], s28 offen sc1
    v_mfma_f32_16x16x32_bf16 v[208:211], a[100:103], a[52:55], v[208:211]
    s_add_u32 s28, s28, s31
    ds_read_b64_tr_b16 a[94:95], v11 offset:18432
    v_mfma_f32_16x16x32_bf16 v[212:215], a[108:111], a[52:55], 0
    v_mfma_f32_16x16x32_bf16 v[212:215], a[104:107], a[48:51], v[212:215]
    v_mfma_f32_16x16x32_bf16 v[220:223], a[104:107], a[56:59], 0
    buffer_load_dwordx4 v17, s[40:43], s49 offen offset:3072 sc1 lds
    v_mfma_f32_16x16x32_bf16 v[220:223], a[108:111], a[60:63], v[220:223]
    s_add_u32 s49, s49, 128
    v_mfma_f32_16x16x32_bf16 v[216:219], a[100:103], a[60:63], 0
    buffer_store_dwordx4 a[156:159], v2, s[24:27], s28 offen sc1
    v_mfma_f32_16x16x32_bf16 v[216:219], a[96:99], a[56:59], v[216:219]
    s_add_u32 s29, s29, s30
    s_mov_b32 s28, s29
    v_mfma_f32_16x16x32_bf16 v[224:227], a[112:115], a[0:3], 0
    v_mfma_f32_16x16x32_bf16 v[224:227], a[116:119], a[4:7], v[224:227]
    ds_read_b64_tr_b16 a[96:97], v12 offset:0
    v_mfma_f32_16x16x32_bf16 v[228:231], a[124:127], a[4:7], 0
    v_mfma_f32_16x16x32_bf16 v[228:231], a[120:123], a[0:3], v[228:231]
    s_add_u32 m0, s61, 4096
    ds_read_b128 a[0:3], v6 offset:0
    v_mfma_f32_16x16x32_bf16 v[236:239], a[120:123], a[8:11], 0
    buffer_load_dwordx4 v16, s[40:43], s50 offen offset:0 sc1 lds
    v_mfma_f32_16x16x32_bf16 v[236:239], a[124:127], a[12:15], v[236:239]
    s_add_u32 s61, s61, 32768
    ds_read_b128 a[4:7], v7 offset:0
    v_mfma_f32_16x16x32_bf16 v[232:235], a[116:119], a[12:15], 0
    s_cmp_ge_u32 s61, 98304
    s_cselect_b32 s90, 98304, 0
    ds_read_b64_tr_b16 a[98:99], v12 offset:2048
    v_mfma_f32_16x16x32_bf16 v[232:235], a[112:115], a[8:11], v[232:235]
    s_sub_u32 s61, s61, s90
    ds_read_b128 a[8:11], v6 offset:2048
    v_mfma_f32_16x16x32_bf16 v[240:243], a[112:115], a[16:19], 0
    ds_read_b128 a[12:15], v7 offset:2048
    v_mfma_f32_16x16x32_bf16 v[240:243], a[116:119], a[20:23], v[240:243]
    ds_read_b64_tr_b16 a[100:101], v12 offset:16384
    v_mfma_f32_16x16x32_bf16 v[244:247], a[124:127], a[20:23], 0
    v_mfma_f32_16x16x32_bf16 v[244:247], a[120:123], a[16:19], v[244:247]
    ds_read_b128 a[16:19], v6 offset:4096
    v_mfma_f32_16x16x32_bf16 v[252:255], a[120:123], a[24:27], 0
    buffer_load_dwordx4 v17, s[40:43], s50 offen offset:1024 sc1 lds
    v_mfma_f32_16x16x32_bf16 v[252:255], a[124:127], a[28:31], v[252:255]
    s_add_u32 s50, s50, 128
    ds_read_b128 a[20:23], v7 offset:4096
    v_mfma_f32_16x16x32_bf16 v[248:251], a[116:119], a[28:31], 0
    ds_read_b64_tr_b16 a[102:103], v12 offset:18432
    v_mfma_f32_16x16x32_bf16 v[248:251], a[112:115], a[24:27], v[248:251]
    ds_read_b128 a[24:27], v6 offset:6144
    v_mfma_f32_16x16x32_bf16 a[224:227], a[112:115], a[32:35], 0
    s_sub_u32 s65, s65, 1
    ds_read_b128 a[28:31], v7 offset:6144
    v_mfma_f32_16x16x32_bf16 a[224:227], a[116:119], a[36:39], a[224:227]
    ds_read_b64_tr_b16 a[104:105], v13 offset:0
    v_mfma_f32_16x16x32_bf16 a[228:231], a[124:127], a[36:39], 0
    v_mfma_f32_16x16x32_bf16 a[228:231], a[120:123], a[32:35], a[228:231]
    ds_read_b128 a[32:35], v6 offset:8192
    v_mfma_f32_16x16x32_bf16 a[236:239], a[120:123], a[40:43], 0
    buffer_load_dwordx4 v16, s[40:43], s51 offen offset:2048 sc1 lds
    v_mfma_f32_16x16x32_bf16 a[236:239], a[124:127], a[44:47], a[236:239]
    ds_read_b128 a[36:39], v7 offset:8192
    v_mfma_f32_16x16x32_bf16 a[232:235], a[116:119], a[44:47], 0
    ds_read_b64_tr_b16 a[106:107], v13 offset:2048
    v_mfma_f32_16x16x32_bf16 a[232:235], a[112:115], a[40:43], a[232:235]
    ds_read_b128 a[40:43], v6 offset:10240
    v_mfma_f32_16x16x32_bf16 a[240:243], a[112:115], a[48:51], 0
    ds_read_b128 a[44:47], v7 offset:10240
    v_mfma_f32_16x16x32_bf16 a[240:243], a[116:119], a[52:55], a[240:243]
    ds_read_b64_tr_b16 a[108:109], v13 offset:16384
    v_mfma_f32_16x16x32_bf16 a[244:247], a[124:127], a[52:55], 0
    v_mfma_f32_16x16x32_bf16 a[244:247], a[120:123], a[48:51], a[244:247]
    ds_read_b128 a[48:51], v6 offset:12288
    v_mfma_f32_16x16x32_bf16 a[252:255], a[120:123], a[56:59], 0
    buffer_load_dwordx4 v17, s[40:43], s51 offen offset:3072 sc1 lds
    v_mfma_f32_16x16x32_bf16 a[252:255], a[124:127], a[60:63], a[252:255]
    s_add_u32 s51, s51, 128
    ds_read_b128 a[52:55], v7 offset:12288
    v_mfma_f32_16x16x32_bf16 a[248:251], a[116:119], a[60:63], 0
    ds_read_b64_tr_b16 a[110:111], v13 offset:18432
    v_mfma_f32_16x16x32_bf16 a[248:251], a[112:115], a[56:59], a[248:251]
    ds_read_b128 a[56:59], v6 offset:14336
    ds_read_b128 a[60:63], v7 offset:14336
    s_waitcnt lgkmcnt(15)
    v_mfma_f32_16x16x32_bf16 v[32:35], a[64:67], a[0:3], v[32:35]
    ds_read_b64_tr_b16 a[112:113], v14 offset:0
    v_mfma_f32_16x16x32_bf16 v[32:35], a[68:71], a[4:7], v[32:35]
    ds_read_b64_tr_b16 a[114:115], v14 offset:2048
    v_mfma_f32_16x16x32_bf16 v[36:39], a[76:79], a[4:7], v[36:39]
    ds_read_b64_tr_b16 a[116:117], v14 offset:16384
    v_mfma_f32_16x16x32_bf16 v[36:39], a[72:75], a[0:3], v[36:39]
    ds_read_b64_tr_b16 a[118:119], v14 offset:18432
    v_mfma_f32_16x16x32_bf16 v[44:47], a[72:75], a[8:11], v[44:47]
    ds_read_b64_tr_b16 a[120:121], v15 offset:0
    v_mfma_f32_16x16x32_bf16 v[44:47], a[76:79], a[12:15], v[44:47]
    ds_read_b64_tr_b16 a[122:123], v15 offset:2048
    v_mfma_f32_16x16x32_bf16 v[40:43], a[68:71], a[12:15], v[40:43]
    ds_read_b64_tr_b16 a[124:125], v15 offset:16384
    v_mfma_f32_16x16x32_bf16 v[40:43], a[64:67], a[8:11], v[40:43]
    ds_read_b64_tr_b16 a[126:127], v15 offset:18432
    v_mfma_f32_16x16x32_bf16 v[48:51], a[64:67], a[16:19], v[48:51]
    v_mfma_f32_16x16x32_bf16 v[48:51], a[68:71], a[20:23], v[48:51]
    v_mfma_f32_16x16x32_bf16 v[52:55], a[76:79], a[20:23], v[52:55]
    buffer_store_dwordx4 a[160:163], v2, s[24:27], s28 offen sc1
    v_mfma_f32_16x16x32_bf16 v[52:55], a[72:75], a[16:19], v[52:55]
    s_add_u32 s28, s28, s31
    s_waitcnt lgkmcnt(15)
    v_mfma_f32_16x16x32_bf16 v[60:63], a[72:75], a[24:27], v[60:63]
    v_xor_b32 v8, s60, v8
    v_xor_b32 v9, s60, v9
    v_mfma_f32_16x16x32_bf16 v[60:63], a[76:79], a[28:31], v[60:63]
    v_xor_b32 v10, s60, v10
    v_xor_b32 v11, s60, v11
    v_mfma_f32_16x16x32_bf16 v[56:59], a[68:71], a[28:31], v[56:59]
    v_xor_b32 v12, s60, v12
    v_xor_b32 v13, s60, v13
    v_mfma_f32_16x16x32_bf16 v[56:59], a[64:67], a[24:27], v[56:59]
    v_xor_b32 v14, s60, v14
    v_xor_b32 v15, s60, v15
    v_mfma_f32_16x16x32_bf16 v[64:67], a[64:67], a[32:35], v[64:67]
    buffer_store_dwordx4 a[164:167], v2, s[24:27], s28 offen sc1
    v_mfma_f32_16x16x32_bf16 v[64:67], a[68:71], a[36:39], v[64:67]
    s_add_u32 s28, s28, s31
    v_mfma_f32_16x16x32_bf16 v[68:71], a[76:79], a[36:39], v[68:71]
    v_mfma_f32_16x16x32_bf16 v[68:71], a[72:75], a[32:35], v[68:71]
    s_waitcnt lgkmcnt(14)
    v_mfma_f32_16x16x32_bf16 v[76:79], a[72:75], a[40:43], v[76:79]
    v_mfma_f32_16x16x32_bf16 v[76:79], a[76:79], a[44:47], v[76:79]
    v_mfma_f32_16x16x32_bf16 v[72:75], a[68:71], a[44:47], v[72:75]
    buffer_store_dwordx4 a[168:171], v2, s[24:27], s28 offen sc1
    v_mfma_f32_16x16x32_bf16 v[72:75], a[64:67], a[40:43], v[72:75]
    s_add_u32 s28, s28, s31
    s_waitcnt lgkmcnt(11)
    v_mfma_f32_16x16x32_bf16 v[80:83], a[64:67], a[48:51], v[80:83]
    v_mfma_f32_16x16x32_bf16 v[80:83], a[68:71], a[52:55], v[80:83]
    v_mfma_f32_16x16x32_bf16 v[84:87], a[76:79], a[52:55], v[84:87]
    v_mfma_f32_16x16x32_bf16 v[84:87], a[72:75], a[48:51], v[84:87]
    s_waitcnt lgkmcnt(8)
    v_mfma_f32_16x16x32_bf16 v[92:95], a[72:75], a[56:59], v[92:95]
    buffer_store_dwordx4 a[172:175], v2, s[24:27], s28 offen sc1
    v_mfma_f32_16x16x32_bf16 v[92:95], a[76:79], a[60:63], v[92:95]
    s_add_u32 s28, s28, s31
    v_mfma_f32_16x16x32_bf16 v[88:91], a[68:71], a[60:63], v[88:91]
    s_waitcnt vmcnt(16) lgkmcnt(0)
    v_mfma_f32_16x16x32_bf16 v[88:91], a[64:67], a[56:59], v[88:91]
    s_barrier
    v_mfma_f32_16x16x32_bf16 v[96:99], a[80:83], a[0:3], v[96:99]
    ds_read_b64_tr_b16 a[64:65], v8 offset:0
    v_mfma_f32_16x16x32_bf16 v[96:99], a[84:87], a[4:7], v[96:99]
    s_add_u32 m0, s62, 0
    v_mfma_f32_16x16x32_bf16 v[100:103], a[92:95], a[4:7], v[100:103]
    buffer_load_dwordx4 v18, s[44:47], s52 offen offset:0 sc1 lds
    v_mfma_f32_16x16x32_bf16 v[100:103], a[88:91], a[0:3], v[100:103]
    ds_read_b64_tr_b16 a[66:67], v8 offset:2048
    v_mfma_f32_16x16x32_bf16 v[108:111], a[88:91], a[8:11], v[108:111]
    s_add_u32 s64, s64, 32768
    v_mfma_f32_16x16x32_bf16 v[108:111], a[92:95], a[12:15], v[108:111]
    s_cmp_ge_u32 s64, 98304
    s_cselect_b32 s63, 4294901760, s59
    s_cselect_b32 s64, 0, s64
    v_mfma_f32_16x16x32_bf16 v[104:107], a[84:87], a[12:15], v[104:107]
    buffer_load_dwordx4 v19, s[44:47], s52 offen offset:1024 sc1 lds
    v_mfma_f32_16x16x32_bf16 v[104:107], a[80:83], a[8:11], v[104:107]
    s_add_u32 s52, s52, s56
    ds_read_b64_tr_b16 a[68:69], v8 offset:16384
    v_mfma_f32_16x16x32_bf16 v[112:115], a[80:83], a[16:19], v[112:115]
    v_mfma_f32_16x16x32_bf16 v[112:115], a[84:87], a[20:23], v[112:115]
    v_mfma_f32_16x16x32_bf16 v[116:119], a[92:95], a[20:23], v[116:119]
    buffer_load_dwordx4 v18, s[44:47], s53 offen offset:2048 sc1 lds
    v_mfma_f32_16x16x32_bf16 v[116:119], a[88:91], a[16:19], v[116:119]
    ds_read_b64_tr_b16 a[70:71], v8 offset:18432
    v_mfma_f32_16x16x32_bf16 v[124:127], a[88:91], a[24:27], v[124:127]
    v_mfma_f32_16x16x32_bf16 v[124:127], a[92:95], a[28:31], v[124:127]
    v_mfma_f32_16x16x32_bf16 v[120:123], a[84:87], a[28:31], v[120:123]
    buffer_load_dwordx4 v19, s[44:47], s53 offen offset:3072 sc1 lds
    v_mfma_f32_16x16x32_bf16 v[120:123], a[80:83], a[24:27], v[120:123]
    s_add_u32 s53, s53, s56
    ds_read_b64_tr_b16 a[72:73], v9 offset:0
    v_mfma_f32_16x16x32_bf16 v[128:131], a[80:83], a[32:35], v[128:131]
    v_mfma_f32_16x16x32_bf16 v[128:131], a[84:87], a[36:39], v[128:131]
    s_add_u32 m0, s62, 4096
    v_mfma_f32_16x16x32_bf16 v[132:135], a[92:95], a[36:39], v[132:135]
    buffer_load_dwordx4 v20, s[44:47], s54 offen offset:0 sc1 lds
    v_mfma_f32_16x16x32_bf16 v[132:135], a[88:91], a[32:35], v[132:135]
    s_xor_b32 s62, s62, 229376
    ds_read_b64_tr_b16 a[74:75], v9 offset:2048
    v_mfma_f32_16x16x32_bf16 v[140:143], a[88:91], a[40:43], v[140:143]
    v_mfma_f32_16x16x32_bf16 v[140:143], a[92:95], a[44:47], v[140:143]
    v_mfma_f32_16x16x32_bf16 v[136:139], a[84:87], a[44:47], v[136:139]
    buffer_load_dwordx4 v21, s[44:47], s54 offen offset:1024 sc1 lds
    v_mfma_f32_16x16x32_bf16 v[136:139], a[80:83], a[40:43], v[136:139]
    s_add_u32 s54, s54, s56
    ds_read_b64_tr_b16 a[76:77], v9 offset:16384
    v_mfma_f32_16x16x32_bf16 v[144:147], a[80:83], a[48:51], v[144:147]
    v_mfma_f32_16x16x32_bf16 v[144:147], a[84:87], a[52:55], v[144:147]
    v_mfma_f32_16x16x32_bf16 v[148:151], a[92:95], a[52:55], v[148:151]
    buffer_load_dwordx4 v20, s[44:47], s55 offen offset:2048 sc1 lds
    v_mfma_f32_16x16x32_bf16 v[148:151], a[88:91], a[48:51], v[148:151]
    ds_read_b64_tr_b16 a[78:79], v9 offset:18432
    v_mfma_f32_16x16x32_bf16 v[156:159], a[88:91], a[56:59], v[156:159]
    v_add_u32 v6, s63, v6
    v_add_u32 v7, s63, v7
    v_mfma_f32_16x16x32_bf16 v[156:159], a[92:95], a[60:63], v[156:159]
    v_mfma_f32_16x16x32_bf16 v[152:155], a[84:87], a[60:63], v[152:155]
    buffer_load_dwordx4 v21, s[44:47], s55 offen offset:3072 sc1 lds
    v_mfma_f32_16x16x32_bf16 v[152:155], a[80:83], a[56:59], v[152:155]
    s_add_u32 s55, s55, s56
    v_mfma_f32_16x16x32_bf16 v[160:163], a[96:99], a[0:3], v[160:163]
    ds_read_b64_tr_b16 a[80:81], v10 offset:0
    v_mfma_f32_16x16x32_bf16 v[160:163], a[100:103], a[4:7], v[160:163]
    v_mfma_f32_16x16x32_bf16 v[164:167], a[108:111], a[4:7], v[164:167]
    v_mfma_f32_16x16x32_bf16 v[164:167], a[104:107], a[0:3], v[164:167]
    s_add_u32 m0, s61, 0
    ds_read_b64_tr_b16 a[82:83], v10 offset:2048
    v_mfma_f32_16x16x32_bf16 v[172:175], a[104:107], a[8:11], v[172:175]
    buffer_load_dwordx4 v16, s[40:43], s48 offen offset:0 sc1 lds
    v_mfma_f32_16x16x32_bf16 v[172:175], a[108:111], a[12:15], v[172:175]
    v_mfma_f32_16x16x32_bf16 v[168:171], a[100:103], a[12:15], v[168:171]
    ds_read_b64_tr_b16 a[84:85], v10 offset:16384
    v_mfma_f32_16x16x32_bf16 v[168:171], a[96:99], a[8:11], v[168:171]
    v_mfma_f32_16x16x32_bf16 v[176:179], a[96:99], a[16:19], v[176:179]
    buffer_store_dwordx4 a[176:179], v2, s[24:27], s28 offen sc1
    v_mfma_f32_16x16x32_bf16 v[176:179], a[100:103], a[20:23], v[176:179]
    s_add_u32 s28, s28, s31
    ds_read_b64_tr_b16 a[86:87], v10 offset:18432
    v_mfma_f32_16x16x32_bf16 v[180:183], a[108:111], a[20:23], v[180:183]
    v_mfma_f32_16x16x32_bf16 v[180:183], a[104:107], a[16:19], v[180:183]
    v_mfma_f32_16x16x32_bf16 v[188:191], a[104:107], a[24:27], v[188:191]
    buffer_load_dwordx4 v17, s[40:43], s48 offen offset:1024 sc1 lds
    v_mfma_f32_16x16x32_bf16 v[188:191], a[108:111], a[28:31], v[188:191]
    s_add_u32 s48, s48, 128
    ds_read_b64_tr_b16 a[88:89], v11 offset:0
    v_mfma_f32_16x16x32_bf16 v[184:187], a[100:103], a[28:31], v[184:187]
    v_mfma_f32_16x16x32_bf16 v[184:187], a[96:99], a[24:27], v[184:187]
    v_mfma_f32_16x16x32_bf16 v[192:195], a[96:99], a[32:35], v[192:195]
    buffer_store_dwordx4 a[180:183], v2, s[24:27], s28 offen sc1
    v_mfma_f32_16x16x32_bf16 v[192:195], a[100:103], a[36:39], v[192:195]
    s_add_u32 s28, s28, s31
    ds_read_b64_tr_b16 a[90:91], v11 offset:2048
    v_mfma_f32_16x16x32_bf16 v[196:199], a[108:111], a[36:39], v[196:199]
    v_mfma_f32_16x16x32_bf16 v[196:199], a[104:107], a[32:35], v[196:199]
    v_mfma_f32_16x16x32_bf16 v[204:207], a[104:107], a[40:43], v[204:207]
    buffer_load_dwordx4 v16, s[40:43], s49 offen offset:2048 sc1 lds
    v_mfma_f32_16x16x32_bf16 v[204:207], a[108:111], a[44:47], v[204:207]
    ds_read_b64_tr_b16 a[92:93], v11 offset:16384
    v_mfma_f32_16x16x32_bf16 v[200:203], a[100:103], a[44:47], v[200:203]
    v_mfma_f32_16x16x32_bf16 v[200:203], a[96:99], a[40:43], v[200:203]
    v_mfma_f32_16x16x32_bf16 v[208:211], a[96:99], a[48:51], v[208:211]
    buffer_store_dwordx4 a[184:187], v2, s[24:27], s28 offen sc1
    v_mfma_f32_16x16x32_bf16 v[208:211], a[100:103], a[52:55], v[208:211]
    s_add_u32 s28, s28, s31
    ds_read_b64_tr_b16 a[94:95], v11 offset:18432
    v_mfma_f32_16x16x32_bf16 v[212:215], a[108:111], a[52:55], v[212:215]
    v_mfma_f32_16x16x32_bf16 v[212:215], a[104:107], a[48:51], v[212:215]
    v_mfma_f32_16x16x32_bf16 v[220:223], a[104:107], a[56:59], v[220:223]
    buffer_load_dwordx4 v17, s[40:43], s49 offen offset:3072 sc1 lds
    v_mfma_f32_16x16x32_bf16 v[220:223], a[108:111], a[60:63], v[220:223]
    s_add_u32 s49, s49, 128
    v_mfma_f32_16x16x32_bf16 v[216:219], a[100:103], a[60:63], v[216:219]
    buffer_store_dwordx4 a[188:191], v2, s[24:27], s28 offen sc1
    v_mfma_f32_16x16x32_bf16 v[216:219], a[96:99], a[56:59], v[216:219]
    s_add_u32 s29, s29, s30
    s_mov_b32 s28, s29
    v_mfma_f32_16x16x32_bf16 v[224:227], a[112:115], a[0:3], v[224:227]
    v_mfma_f32_16x16x32_bf16 v[224:227], a[116:119], a[4:7], v[224:227]
    ds_read_b64_tr_b16 a[96:97], v12 offset:0
    v_mfma_f32_16x16x32_bf16 v[228:231], a[124:127], a[4:7], v[228:231]
    v_mfma_f32_16x16x32_bf16 v[228:231], a[120:123], a[0:3], v[228:231]
    s_add_u32 m0, s61, 4096
    ds_read_b128 a[0:3], v6 offset:0
    v_mfma_f32_16x16x32_bf16 v[236:239], a[120:123], a[8:11], v[236:239]
    buffer_load_dwordx4 v16, s[40:43], s50 offen offset:0 sc1 lds
    v_mfma_f32_16x16x32_bf16 v[236:239], a[124:127], a[12:15], v[236:239]
    s_add_u32 s61, s61, 32768
    ds_read_b128 a[4:7], v7 offset:0
    v_mfma_f32_16x16x32_bf16 v[232:235], a[116:119], a[12:15], v[232:235]
    s_cmp_ge_u32 s61, 98304
    s_cselect_b32 s90, 98304, 0
    ds_read_b64_tr_b16 a[98:99], v12 offset:2048
    v_mfma_f32_16x16x32_bf16 v[232:235], a[112:115], a[8:11], v[232:235]
    s_sub_u32 s61, s61, s90
    ds_read_b128 a[8:11], v6 offset:2048
    v_mfma_f32_16x16x32_bf16 v[240:243], a[112:115], a[16:19], v[240:243]
    ds_read_b128 a[12:15], v7 offset:2048
    v_mfma_f32_16x16x32_bf16 v[240:243], a[116:119], a[20:23], v[240:243]
    ds_read_b64_tr_b16 a[100:101], v12 offset:16384
    v_mfma_f32_16x16x32_bf16 v[244:247], a[124:127], a[20:23], v[244:247]
    v_mfma_f32_16x16x32_bf16 v[244:247], a[120:123], a[16:19], v[244:247]
    ds_read_b128 a[16:19], v6 offset:4096
    v_mfma_f32_16x16x32_bf16 v[252:255], a[120:123], a[24:27], v[252:255]
    buffer_load_dwordx4 v17, s[40:43], s50 offen offset:1024 sc1 lds
    v_mfma_f32_16x16x32_bf16 v[252:255], a[124:127], a[28:31], v[252:255]
    s_add_u32 s50, s50, 128
    ds_read_b128 a[20:23], v7 offset:4096
    v_mfma_f32_16x16x32_bf16 v[248:251], a[116:119], a[28:31], v[248:251]
    ds_read_b64_tr_b16 a[102:103], v12 offset:18432
    v_mfma_f32_16x16x32_bf16 v[248:251], a[112:115], a[24:27], v[248:251]
    ds_read_b128 a[24:27], v6 offset:6144
    v_mfma_f32_16x16x32_bf16 a[224:227], a[112:115], a[32:35], a[224:227]
    s_sub_u32 s65, s65, 1
    ds_read_b128 a[28:31], v7 offset:6144
    v_mfma_f32_16x16x32_bf16 a[224:227], a[116:119], a[36:39], a[224:227]
    ds_read_b64_tr_b16 a[104:105], v13 offset:0
    v_mfma_f32_16x16x32_bf16 a[228:231], a[124:127], a[36:39], a[228:231]
    v_mfma_f32_16x16x32_bf16 a[228:231], a[120:123], a[32:35], a[228:231]
    ds_read_b128 a[32:35], v6 offset:8192
    v_mfma_f32_16x16x32_bf16 a[236:239], a[120:123], a[40:43], a[236:239]
    buffer_load_dwordx4 v16, s[40:43], s51 offen offset:2048 sc1 lds
    v_mfma_f32_16x16x32_bf16 a[236:239], a[124:127], a[44:47], a[236:239]
    ds_read_b128 a[36:39], v7 offset:8192
    v_mfma_f32_16x16x32_bf16 a[232:235], a[116:119], a[44:47], a[232:235]
    ds_read_b64_tr_b16 a[106:107], v13 offset:2048
    v_mfma_f32_16x16x32_bf16 a[232:235], a[112:115], a[40:43], a[232:235]
    ds_read_b128 a[40:43], v6 offset:10240
    v_mfma_f32_16x16x32_bf16 a[240:243], a[112:115], a[48:51], a[240:243]
    ds_read_b128 a[44:47], v7 offset:10240
    v_mfma_f32_16x16x32_bf16 a[240:243], a[116:119], a[52:55], a[240:243]
    ds_read_b64_tr_b16 a[108:109], v13 offset:16384
    v_mfma_f32_16x16x32_bf16 a[244:247], a[124:127], a[52:55], a[244:247]
    v_mfma_f32_16x16x32_bf16 a[244:247], a[120:123], a[48:51], a[244:247]
    ds_read_b128 a[48:51], v6 offset:12288
    v_mfma_f32_16x16x32_bf16 a[252:255], a[120:123], a[56:59], a[252:255]
    buffer_load_dwordx4 v17, s[40:43], s51 offen offset:3072 sc1 lds
    v_mfma_f32_16x16x32_bf16 a[252:255], a[124:127], a[60:63], a[252:255]
    s_add_u32 s51, s51, 128
    ds_read_b128 a[52:55], v7 offset:12288
    v_mfma_f32_16x16x32_bf16 a[248:251], a[116:119], a[60:63], a[248:251]
    ds_read_b64_tr_b16 a[110:111], v13 offset:18432
    v_mfma_f32_16x16x32_bf16 a[248:251], a[112:115], a[56:59], a[248:251]
    ds_read_b128 a[56:59], v6 offset:14336
    ds_read_b128 a[60:63], v7 offset:14336
    s_cmp_eq_u32 s66, 2
    s_cbranch_scc1 m_hook17
m_hookr18:
    s_waitcnt lgkmcnt(15)
    v_mfma_f32_16x16x32_bf16 v[32:35], a[64:67], a[0:3], v[32:35]
    ds_read_b64_tr_b16 a[112:113], v14 offset:0
    v_mfma_f32_16x16x32_bf16 v[32:35], a[68:71], a[4:7], v[32:35]
    ds_read_b64_tr_b16 a[114:115], v14 offset:2048
    v_mfma_f32_16x16x32_bf16 v[36:39], a[76:79], a[4:7], v[36:39]
    ds_read_b64_tr_b16 a[116:117], v14 offset:16384
    v_mfma_f32_16x16x32_bf16 v[36:39], a[72:75], a[0:3], v[36:39]
    ds_read_b64_tr_b16 a[118:119], v14 offset:18432
    v_mfma_f32_16x16x32_bf16 v[44:47], a[72:75], a[8:11], v[44:47]
    ds_read_b64_tr_b16 a[120:121], v15 offset:0
    v_mfma_f32_16x16x32_bf16 v[44:47], a[76:79], a[12:15], v[44:47]
    ds_read_b64_tr_b16 a[122:123], v15 offset:2048
    v_mfma_f32_16x16x32_bf16 v[40:43], a[68:71], a[12:15], v[40:43]
    ds_read_b64_tr_b16 a[124:125], v15 offset:16384
    v_mfma_f32_16x16x32_bf16 v[40:43], a[64:67], a[8:11], v[40:43]
    ds_read_b64_tr_b16 a[126:127], v15 offset:18432
    v_mfma_f32_16x16x32_bf16 v[48:51], a[64:67], a[16:19], v[48:51]
    v_mfma_f32_16x16x32_bf16 v[48:51], a[68:71], a[20:23], v[48:51]
    v_mfma_f32_16x16x32_bf16 v[52:55], a[76:79], a[20:23], v[52:55]
    buffer_store_dwordx4 a[192:195], v2, s[24:27], s28 offen sc1
    v_mfma_f32_16x16x32_bf16 v[52:55], a[72:75], a[16:19], v[52:55]
    s_add_u32 s28, s28, s31
    s_waitcnt lgkmcnt(15)
    v_mfma_f32_16x16x32_bf16 v[60:63], a[72:75], a[24:27], v[60:63]
    v_xor_b32 v8, s60, v8
    v_xor_b32 v9, s60, v9
    v_mfma_f32_16x16x32_bf16 v[60:63], a[76:79], a[28:31], v[60:63]
    v_xor_b32 v10, s60, v10
    v_xor_b32 v11, s60, v11
    v_mfma_f32_16x16x32_bf16 v[56:59], a[68:71], a[28:31], v[56:59]
    v_xor_b32 v12, s60, v12
    v_xor_b32 v13, s60, v13
    v_mfma_f32_16x16x32_bf16 v[56:59], a[64:67], a[24:27], v[56:59]
    v_xor_b32 v14, s60, v14
    v_xor_b32 v15, s60, v15
    v_mfma_f32_16x16x32_bf16 v[64:67], a[64:67], a[32:35], v[64:67]
    buffer_store_dwordx4 a[196:199], v2, s[24:27], s28 offen sc1
    v_mfma_f32_16x16x32_bf16 v[64:67], a[68:71], a[36:39], v[64:67]
    s_add_u32 s28, s28, s31
    v_mfma_f32_16x16x32_bf16 v[68:71], a[76:79], a[36:39], v[68:71]
    v_mfma_f32_16x16x32_bf16 v[68:71], a[72:75], a[32:35], v[68:71]
    s_waitcnt lgkmcnt(14)
    v_mfma_f32_16x16x32_bf16 v[76:79], a[72:75], a[40:43], v[76:79]
    v_mfma_f32_16x16x32_bf16 v[76:79], a[76:79], a[44:47], v[76:79]
    v_mfma_f32_16x16x32_bf16 v[72:75], a[68:71], a[44:47], v[72:75]
    buffer_store_dwordx4 a[200:203], v2, s[24:27], s28 offen sc1
    v_mfma_f32_16x16x32_bf16 v[72:75], a[64:67], a[40:43], v[72:75]
    s_add_u32 s28, s28, s31
    s_waitcnt lgkmcnt(11)
    v_mfma_f32_16x16x32_bf16 v[80:83], a[64:67], a[48:51], v[80:83]
    v_mfma_f32_16x16x32_bf16 v[80:83], a[68:71], a[52:55], v[80:83]
    v_mfma_f32_16x16x32_bf16 v[84:87], a[76:79], a[52:55], v[84:87]
    v_mfma_f32_16x16x32_bf16 v[84:87], a[72:75], a[48:51], v[84:87]
    s_waitcnt lgkmcnt(8)
    v_mfma_f32_16x16x32_bf16 v[92:95], a[72:75], a[56:59], v[92:95]
    buffer_store_dwordx4 a[204:207], v2, s[24:27], s28 offen sc1
    v_mfma_f32_16x16x32_bf16 v[92:95], a[76:79], a[60:63], v[92:95]
    s_add_u32 s28, s28, s31
    v_mfma_f32_16x16x32_bf16 v[88:91], a[68:71], a[60:63], v[88:91]
    s_waitcnt vmcnt(16) lgkmcnt(0)
    v_mfma_f32_16x16x32_bf16 v[88:91], a[64:67], a[56:59], v[88:91]
    s_barrier
    v_mfma_f32_16x16x32_bf16 v[96:99], a[80:83], a[0:3], v[96:99]
    ds_read_b64_tr_b16 a[64:65], v8 offset:0
    v_mfma_f32_16x16x32_bf16 v[96:99], a[84:87], a[4:7], v[96:99]
    s_add_u32 m0, s62, 0
    v_mfma_f32_16x16x32_bf16 v[100:103], a[92:95], a[4:7], v[100:103]
    buffer_load_dwordx4 v18, s[44:47], s52 offen offset:0 sc1 lds
    v_mfma_f32_16x16x32_bf16 v[100:103], a[88:91], a[0:3], v[100:103]
    ds_read_b64_tr_b16 a[66:67], v8 offset:2048
    v_mfma_f32_16x16x32_bf16 v[108:111], a[88:91], a[8:11], v[108:111]
    s_add_u32 s64, s64, 32768
    v_mfma_f32_16x16x32_bf16 v[108:111], a[92:95], a[12:15], v[108:111]
    s_cmp_ge_u32 s64, 98304
    s_cselect_b32 s63, 4294901760, s59
    s_cselect_b32 s64, 0, s64
    v_mfma_f32_16x16x32_bf16 v[104:107], a[84:87], a[12:15], v[104:107]
    buffer_load_dwordx4 v19, s[44:47], s52 offen offset:1024 sc1 lds
    v_mfma_f32_16x16x32_bf16 v[104:107], a[80:83], a[8:11], v[104:107]
    s_add_u32 s52, s52, s56
    ds_read_b64_tr_b16 a[68:69], v8 offset:16384
    v_mfma_f32_16x16x32_bf16 v[112:115], a[80:83], a[16:19], v[112:115]
    v_mfma_f32_16x16x32_bf16 v[112:115], a[84:87], a[20:23], v[112:115]
    v_mfma_f32_16x16x32_bf16 v[116:119], a[92:95], a[20:23], v[116:119]
    buffer_load_dwordx4 v18, s[44:47], s53 offen offset:2048 sc1 lds
    v_mfma_f32_16x16x32_bf16 v[116:119], a[88:91], a[16:19], v[116:119]
    ds_read_b64_tr_b16 a[70:71], v8 offset:18432
    v_mfma_f32_16x16x32_bf16 v[124:127], a[88:91], a[24:27], v[124:127]
    v_mfma_f32_16x16x32_bf16 v[124:127], a[92:95], a[28:31], v[124:127]
    v_mfma_f32_16x16x32_bf16 v[120:123], a[84:87], a[28:31], v[120:123]
    buffer_load_dwordx4 v19, s[44:47], s53 offen offset:3072 sc1 lds
    v_mfma_f32_16x16x32_bf16 v[120:123], a[80:83], a[24:27], v[120:123]
    s_add_u32 s53, s53, s56
    ds_read_b64_tr_b16 a[72:73], v9 offset:0
    v_mfma_f32_16x16x32_bf16 v[128:131], a[80:83], a[32:35], v[128:131]
    v_mfma_f32_16x16x32_bf16 v[128:131], a[84:87], a[36:39], v[128:131]
    s_add_u32 m0, s62, 4096
    v_mfma_f32_16x16x32_bf16 v[132:135], a[92:95], a[36:39], v[132:135]
    buffer_load_dwordx4 v20, s[44:47], s54 offen offset:0 sc1 lds
    v_mfma_f32_16x16x32_bf16 v[132:135], a[88:91], a[32:35], v[132:135]
    s_xor_b32 s62, s62, 229376
    ds_read_b64_tr_b16 a[74:75], v9 offset:2048
    v_mfma_f32_16x16x32_bf16 v[140:143], a[88:91], a[40:43], v[140:143]
    v_mfma_f32_16x16x32_bf16 v[140:143], a[92:95], a[44:47], v[140:143]
    v_mfma_f32_16x16x32_bf16 v[136:139], a[84:87], a[44:47], v[136:139]
    buffer_load_dwordx4 v21, s[44:47], s54 offen offset:1024 sc1 lds
    v_mfma_f32_16x16x32_bf16 v[136:139], a[80:83], a[40:43], v[136:139]
    s_add_u32 s54, s54, s56
    ds_read_b64_tr_b16 a[76:77], v9 offset:16384
    v_mfma_f32_16x16x32_bf16 v[144:147], a[80:83], a[48:51], v[144:147]
    v_mfma_f32_16x16x32_bf16 v[144:147], a[84:87], a[52:55], v[144:147]
    v_mfma_f32_16x16x32_bf16 v[148:151], a[92:95], a[52:55], v[148:151]
    buffer_load_dwordx4 v20, s[44:47], s55 offen offset:2048 sc1 lds
    v_mfma_f32_16x16x32_bf16 v[148:151], a[88:91], a[48:51], v[148:151]
    ds_read_b64_tr_b16 a[78:79], v9 offset:18432
    v_mfma_f32_16x16x32_bf16 v[156:159], a[88:91], a[56:59], v[156:159]
    v_add_u32 v6, s63, v6
    v_add_u32 v7, s63, v7
    v_mfma_f32_16x16x32_bf16 v[156:159], a[92:95], a[60:63], v[156:159]
    v_mfma_f32_16x16x32_bf16 v[152:155], a[84:87], a[60:63], v[152:155]
    buffer_load_dwordx4 v21, s[44:47], s55 offen offset:3072 sc1 lds
    v_mfma_f32_16x16x32_bf16 v[152:155], a[80:83], a[56:59], v[152:155]
    s_add_u32 s55, s55, s56
    v_mfma_f32_16x16x32_bf16 v[160:163], a[96:99], a[0:3], v[160:163]
    ds_read_b64_tr_b16 a[80:81], v10 offset:0
    v_mfma_f32_16x16x32_bf16 v[160:163], a[100:103], a[4:7], v[160:163]
    v_mfma_f32_16x16x32_bf16 v[164:167], a[108:111], a[4:7], v[164:167]
    v_mfma_f32_16x16x32_bf16 v[164:167], a[104:107], a[0:3], v[164:167]
    s_add_u32 m0, s61, 0
    ds_read_b64_tr_b16 a[82:83], v10 offset:2048
    v_mfma_f32_16x16x32_bf16 v[172:175], a[104:107], a[8:11], v[172:175]
    buffer_load_dwordx4 v16, s[40:43], s48 offen offset:0 sc1 lds
    v_mfma_f32_16x16x32_bf16 v[172:175], a[108:111], a[12:15], v[172:175]
    v_mfma_f32_16x16x32_bf16 v[168:171], a[100:103], a[12:15], v[168:171]
    ds_read_b64_tr_b16 a[84:85], v10 offset:16384
    v_mfma_f32_16x16x32_bf16 v[168:171], a[96:99], a[8:11], v[168:171]
    v_mfma_f32_16x16x32_bf16 v[176:179], a[96:99], a[16:19], v[176:179]
    buffer_store_dwordx4 a[208:211], v2, s[24:27], s28 offen sc1
    v_mfma_f32_16x16x32_bf16 v[176:179], a[100:103], a[20:23], v[176:179]
    s_add_u32 s28, s28, s31
    ds_read_b64_tr_b16 a[86:87], v10 offset:18432
    v_mfma_f32_16x16x32_bf16 v[180:183], a[108:111], a[20:23], v[180:183]
    v_mfma_f32_16x16x32_bf16 v[180:183], a[104:107], a[16:19], v[180:183]
    v_mfma_f32_16x16x32_bf16 v[188:191], a[104:107], a[24:27], v[188:191]
    buffer_load_dwordx4 v17, s[40:43], s48 offen offset:1024 sc1 lds
    v_mfma_f32_16x16x32_bf16 v[188:191], a[108:111], a[28:31], v[188:191]
    s_add_u32 s48, s48, 128
    ds_read_b64_tr_b16 a[88:89], v11 offset:0
    v_mfma_f32_16x16x32_bf16 v[184:187], a[100:103], a[28:31], v[184:187]
    v_mfma_f32_16x16x32_bf16 v[184:187], a[96:99], a[24:27], v[184:187]
    v_mfma_f32_16x16x32_bf16 v[192:195], a[96:99], a[32:35], v[192:195]
    buffer_store_dwordx4 a[212:215], v2, s[24:27], s28 offen sc1
    v_mfma_f32_16x16x32_bf16 v[192:195], a[100:103], a[36:39], v[192:195]
    s_add_u32 s28, s28, s31
    ds_read_b64_tr_b16 a[90:91], v11 offset:2048
    v_mfma_f32_16x16x32_bf16 v[196:199], a[108:111], a[36:39], v[196:199]
    v_mfma_f32_16x16x32_bf16 v[196:199], a[104:107], a[32:35], v[196:199]
    v_mfma_f32_16x16x32_bf16 v[204:207], a[104:107], a[40:43], v[204:207]
    buffer_load_dwordx4 v16, s[40:43], s49 offen offset:2048 sc1 lds
    v_mfma_f32_16x16x32_bf16 v[204:207], a[108:111], a[44:47], v[204:207]
    ds_read_b64_tr_b16 a[92:93], v11 offset:16384
    v_mfma_f32_16x16x32_bf16 v[200:203], a[100:103], a[44:47], v[200:203]
    v_mfma_f32_16x16x32_bf16 v[200:203], a[96:99], a[40:43], v[200:203]
    v_mfma_f32_16x16x32_bf16 v[208:211], a[96:99], a[48:51], v[208:211]
    buffer_store_dwordx4 a[216:219], v2, s[24:27], s28 offen sc1
    v_mfma_f32_16x16x32_bf16 v[208:211], a[100:103], a[52:55], v[208:211]
    s_add_u32 s28, s28, s31
    ds_read_b64_tr_b16 a[94:95], v11 offset:18432
    v_mfma_f32_16x16x32_bf16 v[212:215], a[108:111], a[52:55], v[212:215]
    v_mfma_f32_16x16x32_bf16 v[212:215], a[104:107], a[48:51], v[212:215]
    v_mfma_f32_16x16x32_bf16 v[220:223], a[104:107], a[56:59], v[220:223]
    buffer_load_dwordx4 v17, s[40:43], s49 offen offset:3072 sc1 lds
    v_mfma_f32_16x16x32_bf16 v[220:223], a[108:111], a[60:63], v[220:223]
    s_add_u32 s49, s49, 128
    v_mfma_f32_16x16x32_bf16 v[216:219], a[100:103], a[60:63], v[216:219]
    buffer_store_dwordx4 a[220:223], v2, s[24:27], s28 offen sc1
    v_mfma_f32_16x16x32_bf16 v[216:219], a[96:99], a[56:59], v[216:219]
    s_add_u32 s29, s29, s30
    s_mov_b32 s28, s29
    v_mfma_f32_16x16x32_bf16 v[224:227], a[112:115], a[0:3], v[224:227]
    v_mfma_f32_16x16x32_bf16 v[224:227], a[116:119], a[4:7], v[224:227]
    ds_read_b64_tr_b16 a[96:97], v12 offset:0
    v_mfma_f32_16x16x32_bf16 v[228:231], a[124:127], a[4:7], v[228:231]
    v_mfma_f32_16x16x32_bf16 v[228:231], a[120:123], a[0:3], v[228:231]
    s_add_u32 m0, s61, 4096
    ds_read_b128 a[0:3], v6 offset:0
    v_mfma_f32_16x16x32_bf16 v[236:239], a[120:123], a[8:11], v[236:239]
    buffer_load_dwordx4 v16, s[40:43], s50 offen offset:0 sc1 lds
    v_mfma_f32_16x16x32_bf16 v[236:239], a[124:127], a[12:15], v[236:239]
    s_add_u32 s61, s61, 32768
    ds_read_b128 a[4:7], v7 offset:0
    v_mfma_f32_16x16x32_bf16 v[232:235], a[116:119], a[12:15], v[232:235]
    s_cmp_ge_u32 s61, 98304
    s_cselect_b32 s90, 98304, 0
    ds_read_b64_tr_b16 a[98:99], v12 offset:2048
    v_mfma_f32_16x16x32_bf16 v[232:235], a[112:115], a[8:11], v[232:235]
    s_sub_u32 s61, s61, s90
    ds_read_b128 a[8:11], v6 offset:2048
    v_mfma_f32_16x16x32_bf16 v[240:243], a[112:115], a[16:19], v[240:243]
    ds_read_b128 a[12:15], v7 offset:2048
    v_mfma_f32_16x16x32_bf16 v[240:243], a[116:119], a[20:23], v[240:243]
    ds_read_b64_tr_b16 a[100:101], v12 offset:16384
    v_mfma_f32_16x16x32_bf16 v[244:247], a[124:127], a[20:23], v[244:247]
    v_mfma_f32_16x16x32_bf16 v[244:247], a[120:123], a[16:19], v[244:247]
    ds_read_b128 a[16:19], v6 offset:4096
    v_mfma_f32_16x16x32_bf16 v[252:255], a[120:123], a[24:27], v[252:255]
    buffer_load_dwordx4 v17, s[40:43], s50 offen offset:1024 sc1 lds
    v_mfma_f32_16x16x32_bf16 v[252:255], a[124:127], a[28:31], v[252:255]
    s_add_u32 s50, s50, 128
    ds_read_b128 a[20:23], v7 offset:4096
    v_mfma_f32_16x16x32_bf16 v[248:251], a[116:119], a[28:31], v[248:251]
    ds_read_b64_tr_b16 a[102:103], v12 offset:18432
    v_mfma_f32_16x16x32_bf16 v[248:251], a[112:115], a[24:27], v[248:251]
    ds_read_b128 a[24:27], v6 offset:6144
    v_mfma_f32_16x16x32_bf16 a[224:227], a[112:115], a[32:35], a[224:227]
    s_sub_u32 s65, s65, 1
    ds_read_b128 a[28:31], v7 offset:6144
    v_mfma_f32_16x16x32_bf16 a[224:227], a[116:119], a[36:39], a[224:227]
    ds_read_b64_tr_b16 a[104:105], v13 offset:0
    v_mfma_f32_16x16x32_bf16 a[228:231], a[124:127], a[36:39], a[228:231]
    v_mfma_f32_16x16x32_bf16 a[228:231], a[120:123], a[32:35], a[228:231]
    ds_read_b128 a[32:35], v6 offset:8192
    v_mfma_f32_16x16x32_bf16 a[236:239], a[120:123], a[40:43], a[236:239]
    buffer_load_dwordx4 v16, s[40:43], s51 offen offset:2048 sc1 lds
    v_mfma_f32_16x16x32_bf16 a[236:239], a[124:127], a[44:47], a[236:239]
    ds_read_b128 a[36:39], v7 offset:8192
    v_mfma_f32_16x16x32_bf16 a[232:235], a[116:119], a[44:47], a[232:235]
    ds_read_b64_tr_b16 a[106:107], v13 offset:2048
    v_mfma_f32_16x16x32_bf16 a[232:235], a[112:115], a[40:43], a[232:235]
    ds_read_b128 a[40:43], v6 offset:10240
    v_mfma_f32_16x16x32_bf16 a[240:243], a[112:115], a[48:51], a[240:243]
    ds_read_b128 a[44:47], v7 offset:10240
    v_mfma_f32_16x16x32_bf16 a[240:243], a[116:119], a[52:55], a[240:243]
    ds_read_b64_tr_b16 a[108:109], v13 offset:16384
    v_mfma_f32_16x16x32_bf16 a[244:247], a[124:127], a[52:55], a[244:247]
    v_mfma_f32_16x16x32_bf16 a[244:247], a[120:123], a[48:51], a[244:247]
    ds_read_b128 a[48:51], v6 offset:12288
    v_mfma_f32_16x16x32_bf16 a[252:255], a[120:123], a[56:59], a[252:255]
    buffer_load_dwordx4 v17, s[40:43], s51 offen offset:3072 sc1 lds
    v_mfma_f32_16x16x32_bf16 a[252:255], a[124:127], a[60:63], a[252:255]
    s_add_u32 s51, s51, 128
    ds_read_b128 a[52:55], v7 offset:12288
    v_mfma_f32_16x16x32_bf16 a[248:251], a[116:119], a[60:63], a[248:251]
    ds_read_b64_tr_b16 a[110:111], v13 offset:18432
    v_mfma_f32_16x16x32_bf16 a[248:251], a[112:115], a[56:59], a[248:251]
    ds_read_b128 a[56:59], v6 offset:14336
    ds_read_b128 a[60:63], v7 offset:14336
.p2align 3
m_loop19:
    s_waitcnt lgkmcnt(15)
    v_mfma_f32_16x16x32_bf16 v[32:35], a[64:67], a[0:3], v[32:35]
    ds_read_b64_tr_b16 a[112:113], v14 offset:0
    v_mfma_f32_16x16x32_bf16 v[32:35], a[68:71], a[4:7], v[32:35]
    ds_read_b64_tr_b16 a[114:115], v14 offset:2048
    v_mfma_f32_16x16x32_bf16 v[36:39], a[76:79], a[4:7], v[36:39]
    ds_read_b64_tr_b16 a[116:117], v14 offset:16384
    v_mfma_f32_16x16x32_bf16 v[36:39], a[72:75], a[0:3], v[36:39]
    ds_read_b64_tr_b16 a[118:119], v14 offset:18432
    v_mfma_f32_16x16x32_bf16 v[44:47], a[72:75], a[8:11], v[44:47]
    ds_read_b64_tr_b16 a[120:121], v15 offset:0
    v_mfma_f32_16x16x32_bf16 v[44:47], a[76:79], a[12:15], v[44:47]
    ds_read_b64_tr_b16 a[122:123], v15 offset:2048
    v_mfma_f32_16x16x32_bf16 v[40:43], a[68:71], a[12:15], v[40:43]
    ds_read_b64_tr_b16 a[124:125], v15 offset:16384
    v_mfma_f32_16x16x32_bf16 v[40:43], a[64:67], a[8:11], v[40:43]
    ds_read_b64_tr_b16 a[126:127], v15 offset:18432
    v_mfma_f32_16x16x32_bf16 v[48:51], a[64:67], a[16:19], v[48:51]
    v_mfma_f32_16x16x32_bf16 v[48:51], a[68:71], a[20:23], v[48:51]
    v_mfma_f32_16x16x32_bf16 v[52:55], a[76:79], a[20:23], v[52:55]
    v_mfma_f32_16x16x32_bf16 v[52:55], a[72:75], a[16:19], v[52:55]
    s_waitcnt lgkmcnt(15)
    v_mfma_f32_16x16x32_bf16 v[60:63], a[72:75], a[24:27], v[60:63]
    v_xor_b32 v8, s60, v8
    v_xor_b32 v9, s60, v9
    v_mfma_f32_16x16x32_bf16 v[60:63], a[76:79], a[28:31], v[60:63]
    v_xor_b32 v10, s60, v10
    v_xor_b32 v11, s60, v11
    v_mfma_f32_16x16x32_bf16 v[56:59], a[68:71], a[28:31], v[56:59]
    v_xor_b32 v12, s60, v12
    v_xor_b32 v13, s60, v13
    v_mfma_f32_16x16x32_bf16 v[56:59], a[64:67], a[24:27], v[56:59]
    v_xor_b32 v14, s60, v14
    v_xor_b32 v15, s60, v15
    v_mfma_f32_16x16x32_bf16 v[64:67], a[64:67], a[32:35], v[64:67]
    v_mfma_f32_16x16x32_bf16 v[64:67], a[68:71], a[36:39], v[64:67]
    v_mfma_f32_16x16x32_bf16 v[68:71], a[76:79], a[36:39], v[68:71]
    v_mfma_f32_16x16x32_bf16 v[68:71], a[72:75], a[32:35], v[68:71]
    s_waitcnt lgkmcnt(14)
    v_mfma_f32_16x16x32_bf16 v[76:79], a[72:75], a[40:43], v[76:79]
    v_mfma_f32_16x16x32_bf16 v[76:79], a[76:79], a[44:47], v[76:79]
    v_mfma_f32_16x16x32_bf16 v[72:75], a[68:71], a[44:47], v[72:75]
    v_mfma_f32_16x16x32_bf16 v[72:75], a[64:67], a[40:43], v[72:75]
    s_waitcnt lgkmcnt(11)
    v_mfma_f32_16x16x32_bf16 v[80:83], a[64:67], a[48:51], v[80:83]
    v_mfma_f32_16x16x32_bf16 v[80:83], a[68:71], a[52:55], v[80:83]
    v_mfma_f32_16x16x32_bf16 v[84:87], a[76:79], a[52:55], v[84:87]
    v_mfma_f32_16x16x32_bf16 v[84:87], a[72:75], a[48:51], v[84:87]
    s_waitcnt lgkmcnt(8)
    v_mfma_f32_16x16x32_bf16 v[92:95], a[72:75], a[56:59], v[92:95]
    v_mfma_f32_16x16x32_bf16 v[92:95], a[76:79], a[60:63], v[92:95]
    v_mfma_f32_16x16x32_bf16 v[88:91], a[68:71], a[60:63], v[88:91]
    s_waitcnt vmcnt(8) lgkmcnt(0)
    v_mfma_f32_16x16x32_bf16 v[88:91], a[64:67], a[56:59], v[88:91]
    s_barrier
    v_mfma_f32_16x16x32_bf16 v[96:99], a[80:83], a[0:3], v[96:99]
    ds_read_b64_tr_b16 a[64:65], v8 offset:0
    v_mfma_f32_16x16x32_bf16 v[96:99], a[84:87], a[4:7], v[96:99]
    s_add_u32 m0, s62, 0
    v_mfma_f32_16x16x32_bf16 v[100:103], a[92:95], a[4:7], v[100:103]
    buffer_load_dwordx4 v18, s[44:47], s52 offen offset:0 sc1 lds
    v_mfma_f32_16x16x32_bf16 v[100:103], a[88:91], a[0:3], v[100:103]
    ds_read_b64_tr_b16 a[66:67], v8 offset:2048
    v_mfma_f32_16x16x32_bf16 v[108:111], a[88:91], a[8:11], v[108:111]
    s_add_u32 s64, s64, 32768
    v_mfma_f32_16x16x32_bf16 v[108:111], a[92:95], a[12:15], v[108:111]
    s_cmp_ge_u32 s64, 98304
    s_cselect_b32 s63, 4294901760, s59
    s_cselect_b32 s64, 0, s64
    v_mfma_f32_16x16x32_bf16 v[104:107], a[84:87], a[12:15], v[104:107]
    buffer_load_dwordx4 v19, s[44:47], s52 offen offset:1024 sc1 lds
    v_mfma_f32_16x16x32_bf16 v[104:107], a[80:83], a[8:11], v[104:107]
    s_add_u32 s52, s52, s56
    ds_read_b64_tr_b16 a[68:69], v8 offset:16384
    v_mfma_f32_16x16x32_bf16 v[112:115], a[80:83], a[16:19], v[112:115]
    v_mfma_f32_16x16x32_bf16 v[112:115], a[84:87], a[20:23], v[112:115]
    v_mfma_f32_16x16x32_bf16 v[116:119], a[92:95], a[20:23], v[116:119]
    buffer_load_dwordx4 v18, s[44:47], s53 offen offset:2048 sc1 lds
    v_mfma_f32_16x16x32_bf16 v[116:119], a[88:91], a[16:19], v[116:119]
    ds_read_b64_tr_b16 a[70:71], v8 offset:18432
    v_mfma_f32_16x16x32_bf16 v[124:127], a[88:91], a[24:27], v[124:127]
    v_mfma_f32_16x16x32_bf16 v[124:127], a[92:95], a[28:31], v[124:127]
    v_mfma_f32_16x16x32_bf16 v[120:123], a[84:87], a[28:31], v[120:123]
    buffer_load_dwordx4 v19, s[44:47], s53 offen offset:3072 sc1 lds
    v_mfma_f32_16x16x32_bf16 v[120:123], a[80:83], a[24:27], v[120:123]
    s_add_u32 s53, s53, s56
    ds_read_b64_tr_b16 a[72:73], v9 offset:0
    v_mfma_f32_16x16x32_bf16 v[128:131], a[80:83], a[32:35], v[128:131]
    v_mfma_f32_16x16x32_bf16 v[128:131], a[84:87], a[36:39], v[128:131]
    s_add_u32 m0, s62, 4096
    v_mfma_f32_16x16x32_bf16 v[132:135], a[92:95], a[36:39], v[132:135]
    buffer_load_dwordx4 v20, s[44:47], s54 offen offset:0 sc1 lds
    v_mfma_f32_16x16x32_bf16 v[132:135], a[88:91], a[32:35], v[132:135]
    s_xor_b32 s62, s62, 229376
    ds_read_b64_tr_b16 a[74:75], v9 offset:2048
    v_mfma_f32_16x16x32_bf16 v[140:143], a[88:91], a[40:43], v[140:143]
    v_mfma_f32_16x16x32_bf16 v[140:143], a[92:95], a[44:47], v[140:143]
    v_mfma_f32_16x16x32_bf16 v[136:139], a[84:87], a[44:47], v[136:139]
    buffer_load_dwordx4 v21, s[44:47], s54 offen offset:1024 sc1 lds
    v_mfma_f32_16x16x32_bf16 v[136:139], a[80:83], a[40:43], v[136:139]
    s_add_u32 s54, s54, s56
    ds_read_b64_tr_b16 a[76:77], v9 offset:16384
    v_mfma_f32_16x16x32_bf16 v[144:147], a[80:83], a[48:51], v[144:147]
    v_mfma_f32_16x16x32_bf16 v[144:147], a[84:87], a[52:55], v[144:147]
    v_mfma_f32_16x16x32_bf16 v[148:151], a[92:95], a[52:55], v[148:151]
    buffer_load_dwordx4 v20, s[44:47], s55 offen offset:2048 sc1 lds
    v_mfma_f32_16x16x32_bf16 v[148:151], a[88:91], a[48:51], v[148:151]
    ds_read_b64_tr_b16 a[78:79], v9 offset:18432
    v_mfma_f32_16x16x32_bf16 v[156:159], a[88:91], a[56:59], v[156:159]
    v_add_u32 v6, s63, v6
    v_add_u32 v7, s63, v7
    v_mfma_f32_16x16x32_bf16 v[156:159], a[92:95], a[60:63], v[156:159]
    v_mfma_f32_16x16x32_bf16 v[152:155], a[84:87], a[60:63], v[152:155]
    buffer_load_dwordx4 v21, s[44:47], s55 offen offset:3072 sc1 lds
    v_mfma_f32_16x16x32_bf16 v[152:155], a[80:83], a[56:59], v[152:155]
    s_add_u32 s55, s55, s56
    v_mfma_f32_16x16x32_bf16 v[160:163], a[96:99], a[0:3], v[160:163]
    ds_read_b64_tr_b16 a[80:81], v10 offset:0
    v_mfma_f32_16x16x32_bf16 v[160:163], a[100:103], a[4:7], v[160:163]
    v_mfma_f32_16x16x32_bf16 v[164:167], a[108:111], a[4:7], v[164:167]
    v_mfma_f32_16x16x32_bf16 v[164:167], a[104:107], a[0:3], v[164:167]
    s_add_u32 m0, s61, 0
    ds_read_b64_tr_b16 a[82:83], v10 offset:2048
    v_mfma_f32_16x16x32_bf16 v[172:175], a[104:107], a[8:11], v[172:175]
    buffer_load_dwordx4 v16, s[40:43], s48 offen offset:0 sc1 lds
    v_mfma_f32_16x16x32_bf16 v[172:175], a[108:111], a[12:15], v[172:175]
    v_mfma_f32_16x16x32_bf16 v[168:171], a[100:103], a[12:15], v[168:171]
    ds_read_b64_tr_b16 a[84:85], v10 offset:16384
    v_mfma_f32_16x16x32_bf16 v[168:171], a[96:99], a[8:11], v[168:171]
    v_mfma_f32_16x16x32_bf16 v[176:179], a[96:99], a[16:19], v[176:179]
    v_mfma_f32_16x16x32_bf16 v[176:179], a[100:103], a[20:23], v[176:179]
    ds_read_b64_tr_b16 a[86:87], v10 offset:18432
    v_mfma_f32_16x16x32_bf16 v[180:183], a[108:111], a[20:23], v[180:183]
    v_mfma_f32_16x16x32_bf16 v[180:183], a[104:107], a[16:19], v[180:183]
    v_mfma_f32_16x16x32_bf16 v[188:191], a[104:107], a[24:27], v[188:191]
    buffer_load_dwordx4 v17, s[40:43], s48 offen offset:1024 sc1 lds
    v_mfma_f32_16x16x32_bf16 v[188:191], a[108:111], a[28:31], v[188:191]
    s_add_u32 s48, s48, 128
    ds_read_b64_tr_b16 a[88:89], v11 offset:0
    v_mfma_f32_16x16x32_bf16 v[184:187], a[100:103], a[28:31], v[184:187]
    v_mfma_f32_16x16x32_bf16 v[184:187], a[96:99], a[24:27], v[184:187]
    v_mfma_f32_16x16x32_bf16 v[192:195], a[96:99], a[32:35], v[192:195]
    v_mfma_f32_16x16x32_bf16 v[192:195], a[100:103], a[36:39], v[192:195]
    ds_read_b64_tr_b16 a[90:91], v11 offset:2048
    v_mfma_f32_16x16x32_bf16 v[196:199], a[108:111], a[36:39], v[196:199]
    v_mfma_f32_16x16x32_bf16 v[196:199], a[104:107], a[32:35], v[196:199]
    v_mfma_f32_16x16x32_bf16 v[204:207], a[104:107], a[40:43], v[204:207]
    buffer_load_dwordx4 v16, s[40:43], s49 offen offset:2048 sc1 lds
    v_mfma_f32_16x16x32_bf16 v[204:207], a[108:111], a[44:47], v[204:207]
    ds_read_b64_tr_b16 a[92:93], v11 offset:16384
    v_mfma_f32_16x16x32_bf16 v[200:203], a[100:103], a[44:47], v[200:203]
    v_mfma_f32_16x16x32_bf16 v[200:203], a[96:99], a[40:43], v[200:203]
    v_mfma_f32_16x16x32_bf16 v[208:211], a[96:99], a[48:51], v[208:211]
    v_mfma_f32_16x16x32_bf16 v[208:211], a[100:103], a[52:55], v[208:211]
    ds_read_b64_tr_b16 a[94:95], v11 offset:18432
    v_mfma_f32_16x16x32_bf16 v[212:215], a[108:111], a[52:55], v[212:215]
    v_mfma_f32_16x16x32_bf16 v[212:215], a[104:107], a[48:51], v[212:215]
    v_mfma_f32_16x16x32_bf16 v[220:223], a[104:107], a[56:59], v[220:223]
    buffer_load_dwordx4 v17, s[40:43], s49 offen offset:3072 sc1 lds
    v_mfma_f32_16x16x32_bf16 v[220:223], a[108:111], a[60:63], v[220:223]
    s_add_u32 s49, s49, 128
    v_mfma_f32_16x16x32_bf16 v[216:219], a[100:103], a[60:63], v[216:219]
    v_mfma_f32_16x16x32_bf16 v[216:219], a[96:99], a[56:59], v[216:219]
    v_mfma_f32_16x16x32_bf16 v[224:227], a[112:115], a[0:3], v[224:227]
    v_mfma_f32_16x16x32_bf16 v[224:227], a[116:119], a[4:7], v[224:227]
    ds_read_b64_tr_b16 a[96:97], v12 offset:0
    v_mfma_f32_16x16x32_bf16 v[228:231], a[124:127], a[4:7], v[228:231]
    v_mfma_f32_16x16x32_bf16 v[228:231], a[120:123], a[0:3], v[228:231]
    s_add_u32 m0, s61, 4096
    ds_read_b128 a[0:3], v6 offset:0
    v_mfma_f32_16x16x32_bf16 v[236:239], a[120:123], a[8:11], v[236:239]
    buffer_load_dwordx4 v16, s[40:43], s50 offen offset:0 sc1 lds
    v_mfma_f32_16x16x32_bf16 v[236:239], a[124:127], a[12:15], v[236:239]
    s_add_u32 s61, s61, 32768
    ds_read_b128 a[4:7], v7 offset:0
    v_mfma_f32_16x16x32_bf16 v[232:235], a[116:119], a[12:15], v[232:235]
    s_cmp_ge_u32 s61, 98304
    s_cselect_b32 s90, 98304, 0
    ds_read_b64_tr_b16 a[98:99], v12 offset:2048
    v_mfma_f32_16x16x32_bf16 v[232:235], a[112:115], a[8:11], v[232:235]
    s_sub_u32 s61, s61, s90
    ds_read_b128 a[8:11], v6 offset:2048
    v_mfma_f32_16x16x32_bf16 v[240:243], a[112:115], a[16:19], v[240:243]
    ds_read_b128 a[12:15], v7 offset:2048
    v_mfma_f32_16x16x32_bf16 v[240:243], a[116:119], a[20:23], v[240:243]
    ds_read_b64_tr_b16 a[100:101], v12 offset:16384
    v_mfma_f32_16x16x32_bf16 v[244:247], a[124:127], a[20:23], v[244:247]
    v_mfma_f32_16x16x32_bf16 v[244:247], a[120:123], a[16:19], v[244:247]
    ds_read_b128 a[16:19], v6 offset:4096
    v_mfma_f32_16x16x32_bf16 v[252:255], a[120:123], a[24:27], v[252:255]
    buffer_load_dwordx4 v17, s[40:43], s50 offen offset:1024 sc1 lds
    v_mfma_f32_16x16x32_bf16 v[252:255], a[124:127], a[28:31], v[252:255]
    s_add_u32 s50, s50, 128
    ds_read_b128 a[20:23], v7 offset:4096
    v_mfma_f32_16x16x32_bf16 v[248:251], a[116:119], a[28:31], v[248:251]
    ds_read_b64_tr_b16 a[102:103], v12 offset:18432
    v_mfma_f32_16x16x32_bf16 v[248:251], a[112:115], a[24:27], v[248:251]
    ds_read_b128 a[24:27], v6 offset:6144
    v_mfma_f32_16x16x32_bf16 a[224:227], a[112:115], a[32:35], a[224:227]
    s_sub_u32 s65, s65, 1
    ds_read_b128 a[28:31], v7 offset:6144
    v_mfma_f32_16x16x32_bf16 a[224:227], a[116:119], a[36:39], a[224:227]
    ds_read_b64_tr_b16 a[104:105], v13 offset:0
    v_mfma_f32_16x16x32_bf16 a[228:231], a[124:127], a[36:39], a[228:231]
    v_mfma_f32_16x16x32_bf16 a[228:231], a[120:123], a[32:35], a[228:231]
    ds_read_b128 a[32:35], v6 offset:8192
    v_mfma_f32_16x16x32_bf16 a[236:239], a[120:123], a[40:43], a[236:239]
    buffer_load_dwordx4 v16, s[40:43], s51 offen offset:2048 sc1 lds
    v_mfma_f32_16x16x32_bf16 a[236:239], a[124:127], a[44:47], a[236:239]
    ds_read_b128 a[36:39], v7 offset:8192
    v_mfma_f32_16x16x32_bf16 a[232:235], a[116:119], a[44:47], a[232:235]
    ds_read_b64_tr_b16 a[106:107], v13 offset:2048
    v_mfma_f32_16x16x32_bf16 a[232:235], a[112:115], a[40:43], a[232:235]
    ds_read_b128 a[40:43], v6 offset:10240
    v_mfma_f32_16x16x32_bf16 a[240:243], a[112:115], a[48:51], a[240:243]
    ds_read_b128 a[44:47], v7 offset:10240
    v_mfma_f32_16x16x32_bf16 a[240:243], a[116:119], a[52:55], a[240:243]
    ds_read_b64_tr_b16 a[108:109], v13 offset:16384
    v_mfma_f32_16x16x32_bf16 a[244:247], a[124:127], a[52:55], a[244:247]
    v_mfma_f32_16x16x32_bf16 a[244:247], a[120:123], a[48:51], a[244:247]
    ds_read_b128 a[48:51], v6 offset:12288
    v_mfma_f32_16x16x32_bf16 a[252:255], a[120:123], a[56:59], a[252:255]
    buffer_load_dwordx4 v17, s[40:43], s51 offen offset:3072 sc1 lds
    v_mfma_f32_16x16x32_bf16 a[252:255], a[124:127], a[60:63], a[252:255]
    s_add_u32 s51, s51, 128
    ds_read_b128 a[52:55], v7 offset:12288
    v_mfma_f32_16x16x32_bf16 a[248:251], a[116:119], a[60:63], a[248:251]
    s_cmp_gt_u32 s65, s67
    ds_read_b64_tr_b16 a[110:111], v13 offset:18432
    v_mfma_f32_16x16x32_bf16 a[248:251], a[112:115], a[56:59], a[248:251]
    ds_read_b128 a[56:59], v6 offset:14336
    ds_read_b128 a[60:63], v7 offset:14336
    s_cbranch_scc1 m_loop19
    s_cmp_lg_u32 s65, 0
    s_cbranch_scc1 m_dosw20
    s_branch m_epi15
m_swp16:
    s_waitcnt lgkmcnt(15)
    v_mfma_f32_16x16x32_bf16 v[32:35], a[0:3], a[64:67], 0
    ds_read_b64_tr_b16 a[112:113], v14 offset:0
    v_mfma_f32_16x16x32_bf16 v[32:35], a[4:7], a[68:71], v[32:35]
    ds_read_b64_tr_b16 a[114:115], v14 offset:2048
    v_mfma_f32_16x16x32_bf16 v[40:43], a[4:7], a[76:79], 0
    ds_read_b64_tr_b16 a[116:117], v14 offset:16384
    v_mfma_f32_16x16x32_bf16 v[40:43], a[0:3], a[72:75], v[40:43]
    ds_read_b64_tr_b16 a[118:119], v14 offset:18432
    v_mfma_f32_16x16x32_bf16 v[44:47], a[8:11], a[72:75], 0
    ds_read_b64_tr_b16 a[120:121], v15 offset:0
    v_mfma_f32_16x16x32_bf16 v[44:47], a[12:15], a[76:79], v[44:47]
    ds_read_b64_tr_b16 a[122:123], v15 offset:2048
    v_mfma_f32_16x16x32_bf16 v[36:39], a[12:15], a[68:71], 0
    ds_read_b64_tr_b16 a[124:125], v15 offset:16384
    v_mfma_f32_16x16x32_bf16 v[36:39], a[8:11], a[64:67], v[36:39]
    ds_read_b64_tr_b16 a[126:127], v15 offset:18432
    v_mfma_f32_16x16x32_bf16 v[96:99], a[16:19], a[64:67], 0
    v_mfma_f32_16x16x32_bf16 v[96:99], a[20:23], a[68:71], v[96:99]
    v_mfma_f32_16x16x32_bf16 v[104:107], a[20:23], a[76:79], 0
    buffer_store_dwordx4 a[128:131], v2, s[24:27], s28 offen sc1
    v_mfma_f32_16x16x32_bf16 v[104:107], a[16:19], a[72:75], v[104:107]
    s_add_u32 s28, s28, s31
    s_waitcnt lgkmcnt(15)
    v_mfma_f32_16x16x32_bf16 v[108:111], a[24:27], a[72:75], 0
    v_xor_b32 v8, s60, v8
    v_xor_b32 v9, s60, v9
    v_mfma_f32_16x16x32_bf16 v[108:111], a[28:31], a[76:79], v[108:111]
    v_xor_b32 v10, s60, v10
    v_xor_b32 v11, s60, v11
    v_mfma_f32_16x16x32_bf16 v[100:103], a[28:31], a[68:71], 0
    v_xor_b32 v12, s60, v12
    v_xor_b32 v13, s60, v13
    v_mfma_f32_16x16x32_bf16 v[100:103], a[24:27], a[64:67], v[100:103]
    v_xor_b32 v14, s60, v14
    v_xor_b32 v15, s60, v15
    v_mfma_f32_16x16x32_bf16 v[160:163], a[32:35], a[64:67], 0
    buffer_store_dwordx4 a[132:135], v2, s[24:27], s28 offen sc1
    v_mfma_f32_16x16x32_bf16 v[160:163], a[36:39], a[68:71], v[160:163]
    s_add_u32 s28, s28, s31
    v_mfma_f32_16x16x32_bf16 v[168:171], a[36:39], a[76:79], 0
    v_mfma_f32_16x16x32_bf16 v[168:171], a[32:35], a[72:75], v[168:171]
    s_waitcnt lgkmcnt(14)
    v_mfma_f32_16x16x32_bf16 v[172:175], a[40:43], a[72:75], 0
    v_mfma_f32_16x16x32_bf16 v[172:175], a[44:47], a[76:79], v[172:175]
    v_mfma_f32_16x16x32_bf16 v[164:167], a[44:47], a[68:71], 0
    buffer_store_dwordx4 a[136:139], v2, s[24:27], s28 offen sc1
    v_mfma_f32_16x16x32_bf16 v[164:167], a[40:43], a[64:67], v[164:167]
    s_add_u32 s28, s28, s31
    s_waitcnt lgkmcnt(11)
    v_mfma_f32_16x16x32_bf16 v[224:227], a[48:51], a[64:67], 0
    v_mfma_f32_16x16x32_bf16 v[224:227], a[52:55], a[68:71], v[224:227]
    v_mfma_f32_16x16x32_bf16 v[232:235], a[52:55], a[76:79], 0
    v_mfma_f32_16x16x32_bf16 v[232:235], a[48:51], a[72:75], v[232:235]
    s_waitcnt lgkmcnt(8)
    v_mfma_f32_16x16x32_bf16 v[236:239], a[56:59], a[72:75], 0
    buffer_store_dwordx4 a[140:143], v2, s[24:27], s28 offen sc1
    v_mfma_f32_16x16x32_bf16 v[236:239], a[60:63], a[76:79], v[236:239]
    s_add_u32 s28, s28, s31
    v_mfma_f32_16x16x32_bf16 v[228:231], a[60:63], a[68:71], 0
    s_waitcnt vmcnt(12) lgkmcnt(0)
    v_mfma_f32_16x16x32_bf16 v[228:231], a[56:59], a[64:67], v[228:231]
    s_barrier
    v_mfma_f32_16x16x32_bf16 v[48:51], a[0:3], a[80:83], 0
    ds_read_b64_tr_b16 a[64:65], v8 offset:0
    v_mfma_f32_16x16x32_bf16 v[48:51], a[4:7], a[84:87], v[48:51]
    s_add_u32 m0, s62, 0
    v_mfma_f32_16x16x32_bf16 v[56:59], a[4:7], a[92:95], 0
    buffer_load_dwordx4 v18, s[44:47], s52 offen offset:0 sc1 lds
    v_mfma_f32_16x16x32_bf16 v[56:59], a[0:3], a[88:91], v[56:59]
    ds_read_b64_tr_b16 a[66:67], v8 offset:2048
    v_mfma_f32_16x16x32_bf16 v[60:63], a[8:11], a[88:91], 0
    s_add_u32 s64, s64, 32768
    v_mfma_f32_16x16x32_bf16 v[60:63], a[12:15], a[92:95], v[60:63]
    s_cmp_ge_u32 s64, 98304
    s_cselect_b32 s63, 4294901760, s59
    s_cselect_b32 s64, 0, s64
    v_mfma_f32_16x16x32_bf16 v[52:55], a[12:15], a[84:87], 0
    buffer_load_dwordx4 v19, s[44:47], s52 offen offset:1024 sc1 lds
    v_mfma_f32_16x16x32_bf16 v[52:55], a[8:11], a[80:83], v[52:55]
    s_add_u32 s52, s52, s56
    ds_read_b64_tr_b16 a[68:69], v8 offset:16384
    v_mfma_f32_16x16x32_bf16 v[112:115], a[16:19], a[80:83], 0
    v_mfma_f32_16x16x32_bf16 v[112:115], a[20:23], a[84:87], v[112:115]
    v_mfma_f32_16x16x32_bf16 v[120:123], a[20:23], a[92:95], 0
    buffer_load_dwordx4 v18, s[44:47], s53 offen offset:2048 sc1 lds
    v_mfma_f32_16x16x32_bf16 v[120:123], a[16:19], a[88:91], v[120:123]
    ds_read_b64_tr_b16 a[70:71], v8 offset:18432
    v_mfma_f32_16x16x32_bf16 v[124:127], a[24:27], a[88:91], 0
    v_mfma_f32_16x16x32_bf16 v[124:127], a[28:31], a[92:95], v[124:127]
    v_mfma_f32_16x16x32_bf16 v[116:119], a[28:31], a[84:87], 0
    buffer_load_dwordx4 v19, s[44:47], s53 offen offset:3072 sc1 lds
    v_mfma_f32_16x16x32_bf16 v[116:119], a[24:27], a[80:83], v[116:119]
    s_add_u32 s53, s53, s56
    ds_read_b64_tr_b16 a[72:73], v9 offset:0
    v_mfma_f32_16x16x32_bf16 v[176:179], a[32:35], a[80:83], 0
    v_mfma_f32_16x16x32_bf16 v[176:179], a[36:39], a[84:87], v[176:179]
    s_add_u32 m0, s62, 4096
    v_mfma_f32_16x16x32_bf16 v[184:187], a[36:39], a[92:95], 0
    buffer_load_dwordx4 v20, s[44:47], s54 offen offset:0 sc1 lds
    v_mfma_f32_16x16x32_bf16 v[184:187], a[32:35], a[88:91], v[184:187]
    s_xor_b32 s62, s62, 229376
    ds_read_b64_tr_b16 a[74:75], v9 offset:2048
    v_mfma_f32_16x16x32_bf16 v[188:191], a[40:43], a[88:91], 0
    v_mfma_f32_16x16x32_bf16 v[188:191], a[44:47], a[92:95], v[188:191]
    v_mfma_f32_16x16x32_bf16 v[180:183], a[44:47], a[84:87], 0
    buffer_load_dwordx4 v21, s[44:47], s54 offen offset:1024 sc1 lds
    v_mfma_f32_16x16x32_bf16 v[180:183], a[40:43], a[80:83], v[180:183]
    s_add_u32 s54, s54, s56
    ds_read_b64_tr_b16 a[76:77], v9 offset:16384
    v_mfma_f32_16x16x32_bf16 v[240:243], a[48:51], a[80:83], 0
    v_mfma_f32_16x16x32_bf16 v[240:243], a[52:55], a[84:87], v[240:243]
    v_mfma_f32_16x16x32_bf16 v[248:251], a[52:55], a[92:95], 0
    buffer_load_dwordx4 v20, s[44:47], s55 offen offset:2048 sc1 lds
    v_mfma_f32_16x16x32_bf16 v[248:251], a[48:51], a[88:91], v[248:251]
    ds_read_b64_tr_b16 a[78:79], v9 offset:18432
    v_mfma_f32_16x16x32_bf16 v[252:255], a[56:59], a[88:91], 0
    v_add_u32 v6, s63, v6
    v_add_u32 v7, s63, v7
    v_mfma_f32_16x16x32_bf16 v[252:255], a[60:63], a[92:95], v[252:255]
    v_mfma_f32_16x16x32_bf16 v[244:247], a[60:63], a[84:87], 0
    buffer_load_dwordx4 v21, s[44:47], s55 offen offset:3072 sc1 lds
    v_mfma_f32_16x16x32_bf16 v[244:247], a[56:59], a[80:83], v[244:247]
    s_add_u32 s55, s55, s56
    v_mfma_f32_16x16x32_bf16 v[64:67], a[0:3], a[96:99], 0
    ds_read_b64_tr_b16 a[80:81], v10 offset:0
    v_mfma_f32_16x16x32_bf16 v[64:67], a[4:7], a[100:103], v[64:67]
    v_mfma_f32_16x16x32_bf16 v[72:75], a[4:7], a[108:111], 0
    v_mfma_f32_16x16x32_bf16 v[72:75], a[0:3], a[104:107], v[72:75]
    s_add_u32 m0, s61, 0
    ds_read_b64_tr_b16 a[82:83], v10 offset:2048
    v_mfma_f32_16x16x32_bf16 v[76:79], a[8:11], a[104:107], 0
    buffer_load_dwordx4 v16, s[40:43], s48 offen offset:0 sc1 lds
    v_mfma_f32_16x16x32_bf16 v[76:79], a[12:15], a[108:111], v[76:79]
    v_mfma_f32_16x16x32_bf16 v[68:71], a[12:15], a[100:103], 0
    ds_read_b64_tr_b16 a[84:85], v10 offset:16384
    v_mfma_f32_16x16x32_bf16 v[68:71], a[8:11], a[96:99], v[68:71]
    v_mfma_f32_16x16x32_bf16 v[128:131], a[16:19], a[96:99], 0
    buffer_store_dwordx4 a[144:147], v2, s[24:27], s28 offen sc1
    v_mfma_f32_16x16x32_bf16 v[128:131], a[20:23], a[100:103], v[128:131]
    s_add_u32 s28, s28, s31
    ds_read_b64_tr_b16 a[86:87], v10 offset:18432
    v_mfma_f32_16x16x32_bf16 v[136:139], a[20:23], a[108:111], 0
    v_mfma_f32_16x16x32_bf16 v[136:139], a[16:19], a[104:107], v[136:139]
    v_mfma_f32_16x16x32_bf16 v[140:143], a[24:27], a[104:107], 0
    buffer_load_dwordx4 v17, s[40:43], s48 offen offset:1024 sc1 lds
    v_mfma_f32_16x16x32_bf16 v[140:143], a[28:31], a[108:111], v[140:143]
    s_add_u32 s48, s48, 128
    ds_read_b64_tr_b16 a[88:89], v11 offset:0
    v_mfma_f32_16x16x32_bf16 v[132:135], a[28:31], a[100:103], 0
    v_mfma_f32_16x16x32_bf16 v[132:135], a[24:27], a[96:99], v[132:135]
    v_mfma_f32_16x16x32_bf16 v[192:195], a[32:35], a[96:99], 0
    buffer_store_dwordx4 a[148:151], v2, s[24:27], s28 offen sc1
    v_mfma_f32_16x16x32_bf16 v[192:195], a[36:39], a[100:103], v[192:195]
    s_add_u32 s28, s28, s31
    ds_read_b64_tr_b16 a[90:91], v11 offset:2048
    v_mfma_f32_16x16x32_bf16 v[200:203], a[36:39], a[108:111], 0
    v_mfma_f32_16x16x32_bf16 v[200:203], a[32:35], a[104:107], v[200:203]
    v_mfma_f32_16x16x32_bf16 v[204:207], a[40:43], a[104:107], 0
    buffer_load_dwordx4 v16, s[40:43], s49 offen offset:2048 sc1 lds
    v_mfma_f32_16x16x32_bf16 v[204:207], a[44:47], a[108:111], v[204:207]
    ds_read_b64_tr_b16 a[92:93], v11 offset:16384
    v_mfma_f32_16x16x32_bf16 v[196:199], a[44:47], a[100:103], 0
    v_mfma_f32_16x16x32_bf16 v[196:199], a[40:43], a[96:99], v[196:199]
    v_mfma_f32_16x16x32_bf16 a[224:227], a[48:51], a[96:99], 0
    buffer_store_dwordx4 a[152:155], v2, s[24:27], s28 offen sc1
    v_mfma_f32_16x16x32_bf16 a[224:227], a[52:55], a[100:103], a[224:227]
    s_add_u32 s28, s28, s31
    ds_read_b64_tr_b16 a[94:95], v11 offset:18432
    v_mfma_f32_16x16x32_bf16 a[232:235], a[52:55], a[108:111], 0
    v_mfma_f32_16x16x32_bf16 a[232:235], a[48:51], a[104:107], a[232:235]
    v_mfma_f32_16x16x32_bf16 a[236:239], a[56:59], a[104:107], 0
    buffer_load_dwordx4 v17, s[40:43], s49 offen offset:3072 sc1 lds
    v_mfma_f32_16x16x32_bf16 a[236:239], a[60:63], a[108:111], a[236:239]
    s_add_u32 s49, s49, 128
    v_mfma_f32_16x16x32_bf16 a[228:231], a[60:63], a[100:103], 0
    buffer_store_dwordx4 a[156:159], v2, s[24:27], s28 offen sc1
    v_mfma_f32_16x16x32_bf16 a[228:231], a[56:59], a[96:99], a[228:231]
    s_add_u32 s29, s29, s30
    s_mov_b32 s28, s29
    v_mfma_f32_16x16x32_bf16 v[80:83], a[0:3], a[112:115], 0
    v_mfma_f32_16x16x32_bf16 v[80:83], a[4:7], a[116:119], v[80:83]
    ds_read_b64_tr_b16 a[96:97], v12 offset:0
    v_mfma_f32_16x16x32_bf16 v[88:91], a[4:7], a[124:127], 0
    v_mfma_f32_16x16x32_bf16 v[88:91], a[0:3], a[120:123], v[88:91]
    s_add_u32 m0, s61, 4096
    ds_read_b128 a[0:3], v6 offset:0
    v_mfma_f32_16x16x32_bf16 v[92:95], a[8:11], a[120:123], 0
    buffer_load_dwordx4 v16, s[40:43], s50 offen offset:0 sc1 lds
    v_mfma_f32_16x16x32_bf16 v[92:95], a[12:15], a[124:127], v[92:95]
    s_add_u32 s61, s61, 32768
    ds_read_b128 a[4:7], v7 offset:0
    v_mfma_f32_16x16x32_bf16 v[84:87], a[12:15], a[116:119], 0
    s_cmp_ge_u32 s61, 98304
    s_cselect_b32 s90, 98304, 0
    ds_read_b64_tr_b16 a[98:99], v12 offset:2048
    v_mfma_f32_16x16x32_bf16 v[84:87], a[8:11], a[112:115], v[84:87]
    s_sub_u32 s61, s61, s90
    ds_read_b128 a[8:11], v6 offset:2048
    v_mfma_f32_16x16x32_bf16 v[144:147], a[16:19], a[112:115], 0
    ds_read_b128 a[12:15], v7 offset:2048
    v_mfma_f32_16x16x32_bf16 v[144:147], a[20:23], a[116:119], v[144:147]
    ds_read_b64_tr_b16 a[100:101], v12 offset:16384
    v_mfma_f32_16x16x32_bf16 v[152:155], a[20:23], a[124:127], 0
    v_mfma_f32_16x16x32_bf16 v[152:155], a[16:19], a[120:123], v[152:155]
    ds_read_b128 a[16:19], v6 offset:4096
    v_mfma_f32_16x16x32_bf16 v[156:159], a[24:27], a[120:123], 0
    buffer_load_dwordx4 v17, s[40:43], s50 offen offset:1024 sc1 lds
    v_mfma_f32_16x16x32_bf16 v[156:159], a[28:31], a[124:127], v[156:159]
    s_add_u32 s50, s50, 128
    ds_read_b128 a[20:23], v7 offset:4096
    v_mfma_f32_16x16x32_bf16 v[148:151], a[28:31], a[116:119], 0
    ds_read_b64_tr_b16 a[102:103], v12 offset:18432
    v_mfma_f32_16x16x32_bf16 v[148:151], a[24:27], a[112:115], v[148:151]
    ds_read_b128 a[24:27], v6 offset:6144
    v_mfma_f32_16x16x32_bf16 v[208:211], a[32:35], a[112:115], 0
    s_sub_u32 s65, s65, 1
    ds_read_b128 a[28:31], v7 offset:6144
    v_mfma_f32_16x16x32_bf16 v[208:211], a[36:39], a[116:119], v[208:211]
    ds_read_b64_tr_b16 a[104:105], v13 offset:0
    v_mfma_f32_16x16x32_bf16 v[216:219], a[36:39], a[124:127], 0
    v_mfma_f32_16x16x32_bf16 v[216:219], a[32:35], a[120:123], v[216:219]
    ds_read_b128 a[32:35], v6 offset:8192
    v_mfma_f32_16x16x32_bf16 v[220:223], a[40:43], a[120:123], 0
    buffer_load_dwordx4 v16, s[40:43], s51 offen offset:2048 sc1 lds
    v_mfma_f32_16x16x32_bf16 v[220:223], a[44:47], a[124:127], v[220:223]
    ds_read_b128 a[36:39], v7 offset:8192
    v_mfma_f32_16x16x32_bf16 v[212:215], a[44:47], a[116:119], 0
    ds_read_b64_tr_b16 a[106:107], v13 offset:2048
    v_mfma_f32_16x16x32_bf16 v[212:215], a[40:43], a[112:115], v[212:215]
    ds_read_b128 a[40:43], v6 offset:10240
    v_mfma_f32_16x16x32_bf16 a[240:243], a[48:51], a[112:115], 0
    ds_read_b128 a[44:47], v7 offset:10240
    v_mfma_f32_16x16x32_bf16 a[240:243], a[52:55], a[116:119], a[240:243]
    ds_read_b64_tr_b16 a[108:109], v13 offset:16384
    v_mfma_f32_16x16x32_bf16 a[248:251], a[52:55], a[124:127], 0
    v_mfma_f32_16x16x32_bf16 a[248:251], a[48:51], a[120:123], a[248:251]
    ds_read_b128 a[48:51], v6 offset:12288
    v_mfma_f32_16x16x32_bf16 a[252:255], a[56:59], a[120:123], 0
    buffer_load_dwordx4 v17, s[40:43], s51 offen offset:3072 sc1 lds
    v_mfma_f32_16x16x32_bf16 a[252:255], a[60:63], a[124:127], a[252:255]
    s_add_u32 s51, s51, 128
    ds_read_b128 a[52:55], v7 offset:12288
    v_mfma_f32_16x16x32_bf16 a[244:247], a[60:63], a[116:119], 0
    ds_read_b64_tr_b16 a[110:111], v13 offset:18432
    v_mfma_f32_16x16x32_bf16 a[244:247], a[56:59], a[112:115], a[244:247]
    ds_read_b128 a[56:59], v6 offset:14336
    ds_read_b128 a[60:63], v7 offset:14336
    s_waitcnt lgkmcnt(15)
    v_mfma_f32_16x16x32_bf16 v[32:35], a[0:3], a[64:67], v[32:35]
    ds_read_b64_tr_b16 a[112:113], v14 offset:0
    v_mfma_f32_16x16x32_bf16 v[32:35], a[4:7], a[68:71], v[32:35]
    ds_read_b64_tr_b16 a[114:115], v14 offset:2048
    v_mfma_f32_16x16x32_bf16 v[40:43], a[4:7], a[76:79], v[40:43]
    ds_read_b64_tr_b16 a[116:117], v14 offset:16384
    v_mfma_f32_16x16x32_bf16 v[40:43], a[0:3], a[72:75], v[40:43]
    ds_read_b64_tr_b16 a[118:119], v14 offset:18432
    v_mfma_f32_16x16x32_bf16 v[44:47], a[8:11], a[72:75], v[44:47]
    ds_read_b64_tr_b16 a[120:121], v15 offset:0
    v_mfma_f32_16x16x32_bf16 v[44:47], a[12:15], a[76:79], v[44:47]
    ds_read_b64_tr_b16 a[122:123], v15 offset:2048
    v_mfma_f32_16x16x32_bf16 v[36:39], a[12:15], a[68:71], v[36:39]
    ds_read_b64_tr_b16 a[124:125], v15 offset:16384
    v_mfma_f32_16x16x32_bf16 v[36:39], a[8:11], a[64:67], v[36:39]
    ds_read_b64_tr_b16 a[126:127], v15 offset:18432
    v_mfma_f32_16x16x32_bf16 v[96:99], a[16:19], a[64:67], v[96:99]
    v_mfma_f32_16x16x32_bf16 v[96:99], a[20:23], a[68:71], v[96:99]
    v_mfma_f32_16x16x32_bf16 v[104:107], a[20:23], a[76:79], v[104:107]
    buffer_store_dwordx4 a[160:163], v2, s[24:27], s28 offen sc1
    v_mfma_f32_16x16x32_bf16 v[104:107], a[16:19], a[72:75], v[104:107]
    s_add_u32 s28, s28, s31
    s_waitcnt lgkmcnt(15)
    v_mfma_f32_16x16x32_bf16 v[108:111], a[24:27], a[72:75], v[108:111]
    v_xor_b32 v8, s60, v8
    v_xor_b32 v9, s60, v9
    v_mfma_f32_16x16x32_bf16 v[108:111], a[28:31], a[76:79], v[108:111]
    v_xor_b32 v10, s60, v10
    v_xor_b32 v11, s60, v11
    v_mfma_f32_16x16x32_bf16 v[100:103], a[28:31], a[68:71], v[100:103]
    v_xor_b32 v12, s60, v12
    v_xor_b32 v13, s60, v13
    v_mfma_f32_16x16x32_bf16 v[100:103], a[24:27], a[64:67], v[100:103]
    v_xor_b32 v14, s60, v14
    v_xor_b32 v15, s60, v15
    v_mfma_f32_16x16x32_bf16 v[160:163], a[32:35], a[64:67], v[160:163]
    buffer_store_dwordx4 a[164:167], v2, s[24:27], s28 offen sc1
    v_mfma_f32_16x16x32_bf16 v[160:163], a[36:39], a[68:71], v[160:163]
    s_add_u32 s28, s28, s31
    v_mfma_f32_16x16x32_bf16 v[168:171], a[36:39], a[76:79], v[168:171]
    v_mfma_f32_16x16x32_bf16 v[168:171], a[32:35], a[72:75], v[168:171]
    s_waitcnt lgkmcnt(14)
    v_mfma_f32_16x16x32_bf16 v[172:175], a[40:43], a[72:75], v[172:175]
    v_mfma_f32_16x16x32_bf16 v[172:175], a[44:47], a[76:79], v[172:175]
    v_mfma_f32_16x16x32_bf16 v[164:167], a[44:47], a[68:71], v[164:167]
    buffer_store_dwordx4 a[168:171], v2, s[24:27], s28 offen sc1
    v_mfma_f32_16x16x32_bf16 v[164:167], a[40:43], a[64:67], v[164:167]
    s_add_u32 s28, s28, s31
    s_waitcnt lgkmcnt(11)
    v_mfma_f32_16x16x32_bf16 v[224:227], a[48:51], a[64:67], v[224:227]
    v_mfma_f32_16x16x32_bf16 v[224:227], a[52:55], a[68:71], v[224:227]
    v_mfma_f32_16x16x32_bf16 v[232:235], a[52:55], a[76:79], v[232:235]
    v_mfma_f32_16x16x32_bf16 v[232:235], a[48:51], a[72:75], v[232:235]
    s_waitcnt lgkmcnt(8)
    v_mfma_f32_16x16x32_bf16 v[236:239], a[56:59], a[72:75], v[236:239]
    buffer_store_dwordx4 a[172:175], v2, s[24:27], s28 offen sc1
    v_mfma_f32_16x16x32_bf16 v[236:239], a[60:63], a[76:79], v[236:239]
    s_add_u32 s28, s28, s31
    v_mfma_f32_16x16x32_bf16 v[228:231], a[60:63], a[68:71], v[228:231]
    s_waitcnt vmcnt(16) lgkmcnt(0)
    v_mfma_f32_16x16x32_bf16 v[228:231], a[56:59], a[64:67], v[228:231]
    s_barrier
    v_mfma_f32_16x16x32_bf16 v[48:51], a[0:3], a[80:83], v[48:51]
    ds_read_b64_tr_b16 a[64:65], v8 offset:0
    v_mfma_f32_16x16x32_bf16 v[48:51], a[4:7], a[84:87], v[48:51]
    s_add_u32 m0, s62, 0
    v_mfma_f32_16x16x32_bf16 v[56:59], a[4:7], a[92:95], v[56:59]
    buffer_load_dwordx4 v18, s[44:47], s52 offen offset:0 sc1 lds
    v_mfma_f32_16x16x32_bf16 v[56:59], a[0:3], a[88:91], v[56:59]
    ds_read_b64_tr_b16 a[66:67], v8 offset:2048
    v_mfma_f32_16x16x32_bf16 v[60:63], a[8:11], a[88:91], v[60:63]
    s_add_u32 s64, s64, 32768
    v_mfma_f32_16x16x32_bf16 v[60:63], a[12:15], a[92:95], v[60:63]
    s_cmp_ge_u32 s64, 98304
    s_cselect_b32 s63, 4294901760, s59
    s_cselect_b32 s64, 0, s64
    v_mfma_f32_16x16x32_bf16 v[52:55], a[12:15], a[84:87], v[52:55]
    buffer_load_dwordx4 v19, s[44:47], s52 offen offset:1024 sc1 lds
    v_mfma_f32_16x16x32_bf16 v[52:55], a[8:11], a[80:83], v[52:55]
    s_add_u32 s52, s52, s56
    ds_read_b64_tr_b16 a[68:69], v8 offset:16384
    v_mfma_f32_16x16x32_bf16 v[112:115], a[16:19], a[80:83], v[112:115]
    v_mfma_f32_16x16x32_bf16 v[112:115], a[20:23], a[84:87], v[112:115]
    v_mfma_f32_16x16x32_bf16 v[120:123], a[20:23], a[92:95], v[120:123]
    buffer_load_dwordx4 v18, s[44:47], s53 offen offset:2048 sc1 lds
    v_mfma_f32_16x16x32_bf16 v[120:123], a[16:19], a[88:91], v[120:123]
    ds_read_b64_tr_b16 a[70:71], v8 offset:18432
    v_mfma_f32_16x16x32_bf16 v[124:127], a[24:27], a[88:91], v[124:127]
    v_mfma_f32_16x16x32_bf16 v[124:127], a[28:31], a[92:95], v[124:127]
    v_mfma_f32_16x16x32_bf16 v[116:119], a[28:31], a[84:87], v[116:119]
    buffer_load_dwordx4 v19, s[44:47], s53 offen offset:3072 sc1 lds
    v_mfma_f32_16x16x32_bf16 v[116:119], a[24:27], a[80:83], v[116:119]
    s_add_u32 s53, s53, s56
    ds_read_b64_tr_b16 a[72:73], v9 offset:0
    v_mfma_f32_16x16x32_bf16 v[176:179], a[32:35], a[80:83], v[176:179]
    v_mfma_f32_16x16x32_bf16 v[176:179], a[36:39], a[84:87], v[176:179]
    s_add_u32 m0, s62, 4096
    v_mfma_f32_16x16x32_bf16 v[184:187], a[36:39], a[92:95], v[184:187]
    buffer_load_dwordx4 v20, s[44:47], s54 offen offset:0 sc1 lds
    v_mfma_f32_16x16x32_bf16 v[184:187], a[32:35], a[88:91], v[184:187]
    s_xor_b32 s62, s62, 229376
    ds_read_b64_tr_b16 a[74:75], v9 offset:2048
    v_mfma_f32_16x16x32_bf16 v[188:191], a[40:43], a[88:91], v[188:191]
    v_mfma_f32_16x16x32_bf16 v[188:191], a[44:47], a[92:95], v[188:191]
    v_mfma_f32_16x16x32_bf16 v[180:183], a[44:47], a[84:87], v[180:183]
    buffer_load_dwordx4 v21, s[44:47], s54 offen offset:1024 sc1 lds
    v_mfma_f32_16x16x32_bf16 v[180:183], a[40:43], a[80:83], v[180:183]
    s_add_u32 s54, s54, s56
    ds_read_b64_tr_b16 a[76:77], v9 offset:16384
    v_mfma_f32_16x16x32_bf16 v[240:243], a[48:51], a[80:83], v[240:243]
    v_mfma_f32_16x16x32_bf16 v[240:243], a[52:55], a[84:87], v[240:243]
    v_mfma_f32_16x16x32_bf16 v[248:251], a[52:55], a[92:95], v[248:251]
    buffer_load_dwordx4 v20, s[44:47], s55 offen offset:2048 sc1 lds
    v_mfma_f32_16x16x32_bf16 v[248:251], a[48:51], a[88:91], v[248:251]
    ds_read_b64_tr_b16 a[78:79], v9 offset:18432
    v_mfma_f32_16x16x32_bf16 v[252:255], a[56:59], a[88:91], v[252:255]
    v_add_u32 v6, s63, v6
    v_add_u32 v7, s63, v7
    v_mfma_f32_16x16x32_bf16 v[252:255], a[60:63], a[92:95], v[252:255]
    v_mfma_f32_16x16x32_bf16 v[244:247], a[60:63], a[84:87], v[244:247]
    buffer_load_dwordx4 v21, s[44:47], s55 offen offset:3072 sc1 lds
    v_mfma_f32_16x16x32_bf16 v[244:247], a[56:59], a[80:83], v[244:247]
    s_add_u32 s55, s55, s56
    v_mfma_f32_16x16x32_bf16 v[64:67], a[0:3], a[96:99], v[64:67]
    ds_read_b64_tr_b16 a[80:81], v10 offset:0
    v_mfma_f32_16x16x32_bf16 v[64:67], a[4:7], a[100:103], v[64:67]
    v_mfma_f32_16x16x32_bf16 v[72:75], a[4:7], a[108:111], v[72:75]
    v_mfma_f32_16x16x32_bf16 v[72:75], a[0:3], a[104:107], v[72:75]
    s_add_u32 m0, s61, 0
    ds_read_b64_tr_b16 a[82:83], v10 offset:2048
    v_mfma_f32_16x16x32_bf16 v[76:79], a[8:11], a[104:107], v[76:79]
    buffer_load_dwordx4 v16, s[40:43], s48 offen offset:0 sc1 lds
    v_mfma_f32_16x16x32_bf16 v[76:79], a[12:15], a[108:111], v[76:79]
    v_mfma_f32_16x16x32_bf16 v[68:71], a[12:15], a[100:103], v[68:71]
    ds_read_b64_tr_b16 a[84:85], v10 offset:16384
    v_mfma_f32_16x16x32_bf16 v[68:71], a[8:11], a[96:99], v[68:71]
    v_mfma_f32_16x16x32_bf16 v[128:131], a[16:19], a[96:99], v[128:131]
    buffer_store_dwordx4 a[176:179], v2, s[24:27], s28 offen sc1
    v_mfma_f32_16x16x32_bf16 v[128:131], a[20:23], a[100:103], v[128:131]
    s_add_u32 s28, s28, s31
    ds_read_b64_tr_b16 a[86:87], v10 offset:18432
    v_mfma_f32_16x16x32_bf16 v[136:139], a[20:23], a[108:111], v[136:139]
    v_mfma_f32_16x16x32_bf16 v[136:139], a[16:19], a[104:107], v[136:139]
    v_mfma_f32_16x16x32_bf16 v[140:143], a[24:27], a[104:107], v[140:143]
    buffer_load_dwordx4 v17, s[40:43], s48 offen offset:1024 sc1 lds
    v_mfma_f32_16x16x32_bf16 v[140:143], a[28:31], a[108:111], v[140:143]
    s_add_u32 s48, s48, 128
    ds_read_b64_tr_b16 a[88:89], v11 offset:0
    v_mfma_f32_16x16x32_bf16 v[132:135], a[28:31], a[100:103], v[132:135]
    v_mfma_f32_16x16x32_bf16 v[132:135], a[24:27], a[96:99], v[132:135]
    v_mfma_f32_16x16x32_bf16 v[192:195], a[32:35], a[96:99], v[192:195]
    buffer_store_dwordx4 a[180:183], v2, s[24:27], s28 offen sc1
    v_mfma_f32_16x16x32_bf16 v[192:195], a[36:39], a[100:103], v[192:195]
    s_add_u32 s28, s28, s31
    ds_read_b64_tr_b16 a[90:91], v11 offset:2048
    v_mfma_f32_16x16x32_bf16 v[200:203], a[36:39], a[108:111], v[200:203]
    v_mfma_f32_16x16x32_bf16 v[200:203], a[32:35], a[104:107], v[200:203]
    v_mfma_f32_16x16x32_bf16 v[204:207], a[40:43], a[104:107], v[204:207]
    buffer_load_dwordx4 v16, s[40:43], s49 offen offset:2048 sc1 lds
    v_mfma_f32_16x16x32_bf16 v[204:207], a[44:47], a[108:111], v[204:207]
    ds_read_b64_tr_b16 a[92:93], v11 offset:16384
    v_mfma_f32_16x16x32_bf16 v[196:199], a[44:47], a[100:103], v[196:199]
    v_mfma_f32_16x16x32_bf16 v[196:199], a[40:43], a[96:99], v[196:199]
    v_mfma_f32_16x16x32_bf16 a[224:227], a[48:51], a[96:99], a[224:227]
    buffer_store_dwordx4 a[184:187], v2, s[24:27], s28 offen sc1
    v_mfma_f32_16x16x32_bf16 a[224:227], a[52:55], a[100:103], a[224:227]
    s_add_u32 s28, s28, s31
    ds_read_b64_tr_b16 a[94:95], v11 offset:18432
    v_mfma_f32_16x16x32_bf16 a[232:235], a[52:55], a[108:111], a[232:235]
    v_mfma_f32_16x16x32_bf16 a[232:235], a[48:51], a[104:107], a[232:235]
    v_mfma_f32_16x16x32_bf16 a[236:239], a[56:59], a[104:107], a[236:239]
    buffer_load_dwordx4 v17, s[40:43], s49 offen offset:3072 sc1 lds
    v_mfma_f32_16x16x32_bf16 a[236:239], a[60:63], a[108:111], a[236:239]
    s_add_u32 s49, s49, 128
    v_mfma_f32_16x16x32_bf16 a[228:231], a[60:63], a[100:103], a[228:231]
    buffer_store_dwordx4 a[188:191], v2, s[24:27], s28 offen sc1
    v_mfma_f32_16x16x32_bf16 a[228:231], a[56:59], a[96:99], a[228:231]
    s_add_u32 s29, s29, s30
    s_mov_b32 s28, s29
    v_mfma_f32_16x16x32_bf16 v[80:83], a[0:3], a[112:115], v[80:83]
    v_mfma_f32_16x16x32_bf16 v[80:83], a[4:7], a[116:119], v[80:83]
    ds_read_b64_tr_b16 a[96:97], v12 offset:0
    v_mfma_f32_16x16x32_bf16 v[88:91], a[4:7], a[124:127], v[88:91]
    v_mfma_f32_16x16x32_bf16 v[88:91], a[0:3], a[120:123], v[88:91]
    s_add_u32 m0, s61, 4096
    ds_read_b128 a[0:3], v6 offset:0
    v_mfma_f32_16x16x32_bf16 v[92:95], a[8:11], a[120:123], v[92:95]
    buffer_load_dwordx4 v16, s[40:43], s50 offen offset:0 sc1 lds
    v_mfma_f32_16x16x32_bf16 v[92:95], a[12:15], a[124:127], v[92:95]
    s_add_u32 s61, s61, 32768
    ds_read_b128 a[4:7], v7 offset:0
    v_mfma_f32_16x16x32_bf16 v[84:87], a[12:15], a[116:119], v[84:87]
    s_cmp_ge_u32 s61, 98304
    s_cselect_b32 s90, 98304, 0
    ds_read_b64_tr_b16 a[98:99], v12 offset:2048
    v_mfma_f32_16x16x32_bf16 v[84:87], a[8:11], a[112:115], v[84:87]
    s_sub_u32 s61, s61, s90
    ds_read_b128 a[8:11], v6 offset:2048
    v_mfma_f32_16x16x32_bf16 v[144:147], a[16:19], a[112:115], v[144:147]
    ds_read_b128 a[12:15], v7 offset:2048
    v_mfma_f32_16x16x32_bf16 v[144:147], a[20:23], a[116:119], v[144:147]
    ds_read_b64_tr_b16 a[100:101], v12 offset:16384
    v_mfma_f32_16x16x32_bf16 v[152:155], a[20:23], a[124:127], v[152:155]
    v_mfma_f32_16x16x32_bf16 v[152:155], a[16:19], a[120:123], v[152:155]
    ds_read_b128 a[16:19], v6 offset:4096
    v_mfma_f32_16x16x32_bf16 v[156:159], a[24:27], a[120:123], v[156:159]
    buffer_load_dwordx4 v17, s[40:43], s50 offen offset:1024 sc1 lds
    v_mfma_f32_16x16x32_bf16 v[156:159], a[28:31], a[124:127], v[156:159]
    s_add_u32 s50, s50, 128
    ds_read_b128 a[20:23], v7 offset:4096
    v_mfma_f32_16x16x32_bf16 v[148:151], a[28:31], a[116:119], v[148:151]
    ds_read_b64_tr_b16 a[102:103], v12 offset:18432
    v_mfma_f32_16x16x32_bf16 v[148:151], a[24:27], a[112:115], v[148:151]
    ds_read_b128 a[24:27], v6 offset:6144
    v_mfma_f32_16x16x32_bf16 v[208:211], a[32:35], a[112:115], v[208:211]
    s_sub_u32 s65, s65, 1
    ds_read_b128 a[28:31], v7 offset:6144
    v_mfma_f32_16x16x32_bf16 v[208:211], a[36:39], a[116:119], v[208:211]
    ds_read_b64_tr_b16 a[104:105], v13 offset:0
    v_mfma_f32_16x16x32_bf16 v[216:219], a[36:39], a[124:127], v[216:219]
    v_mfma_f32_16x16x32_bf16 v[216:219], a[32:35], a[120:123], v[216:219]
    ds_read_b128 a[32:35], v6 offset:8192
    v_mfma_f32_16x16x32_bf16 v[220:223], a[40:43], a[120:123], v[220:223]
    buffer_load_dwordx4 v16, s[40:43], s51 offen offset:2048 sc1 lds
    v_mfma_f32_16x16x32_bf16 v[220:223], a[44:47], a[124:127], v[220:223]
    ds_read_b128 a[36:39], v7 offset:8192
    v_mfma_f32_16x16x32_bf16 v[212:215], a[44:47], a[116:119], v[212:215]
    ds_read_b64_tr_b16 a[106:107], v13 offset:2048
    v_mfma_f32_16x16x32_bf16 v[212:215], a[40:43], a[112:115], v[212:215]
    ds_read_b128 a[40:43], v6 offset:10240
    v_mfma_f32_16x16x32_bf16 a[240:243], a[48:51], a[112:115], a[240:243]
    ds_read_b128 a[44:47], v7 offset:10240
    v_mfma_f32_16x16x32_bf16 a[240:243], a[52:55], a[116:119], a[240:243]
    ds_read_b64_tr_b16 a[108:109], v13 offset:16384
    v_mfma_f32_16x16x32_bf16 a[248:251], a[52:55], a[124:127], a[248:251]
    v_mfma_f32_16x16x32_bf16 a[248:251], a[48:51], a[120:123], a[248:251]
    ds_read_b128 a[48:51], v6 offset:12288
    v_mfma_f32_16x16x32_bf16 a[252:255], a[56:59], a[120:123], a[252:255]
    buffer_load_dwordx4 v17, s[40:43], s51 offen offset:3072 sc1 lds
    v_mfma_f32_16x16x32_bf16 a[252:255], a[60:63], a[124:127], a[252:255]
    s_add_u32 s51, s51, 128
    ds_read_b128 a[52:55], v7 offset:12288
    v_mfma_f32_16x16x32_bf16 a[244:247], a[60:63], a[116:119], a[244:247]
    ds_read_b64_tr_b16 a[110:111], v13 offset:18432
    v_mfma_f32_16x16x32_bf16 a[244:247], a[56:59], a[112:115], a[244:247]
    ds_read_b128 a[56:59], v6 offset:14336
    ds_read_b128 a[60:63], v7 offset:14336
    s_cmp_eq_u32 s66, 2
    s_cbranch_scc1 m_hook21
m_hookr22:
    s_waitcnt lgkmcnt(15)
    v_mfma_f32_16x16x32_bf16 v[32:35], a[0:3], a[64:67], v[32:35]
    ds_read_b64_tr_b16 a[112:113], v14 offset:0
    v_mfma_f32_16x16x32_bf16 v[32:35], a[4:7], a[68:71], v[32:35]
    ds_read_b64_tr_b16 a[114:115], v14 offset:2048
    v_mfma_f32_16x16x32_bf16 v[40:43], a[4:7], a[76:79], v[40:43]
    ds_read_b64_tr_b16 a[116:117], v14 offset:16384
    v_mfma_f32_16x16x32_bf16 v[40:43], a[0:3], a[72:75], v[40:43]
    ds_read_b64_tr_b16 a[118:119], v14 offset:18432
    v_mfma_f32_16x16x32_bf16 v[44:47], a[8:11], a[72:75], v[44:47]
    ds_read_b64_tr_b16 a[120:121], v15 offset:0
    v_mfma_f32_16x16x32_bf16 v[44:47], a[12:15], a[76:79], v[44:47]
    ds_read_b64_tr_b16 a[122:123], v15 offset:2048
    v_mfma_f32_16x16x32_bf16 v[36:39], a[12:15], a[68:71], v[36:39]
    ds_read_b64_tr_b16 a[124:125], v15 offset:16384
    v_mfma_f32_16x16x32_bf16 v[36:39], a[8:11], a[64:67], v[36:39]
    ds_read_b64_tr_b16 a[126:127], v15 offset:18432
    v_mfma_f32_16x16x32_bf16 v[96:99], a[16:19], a[64:67], v[96:99]
    v_mfma_f32_16x16x32_bf16 v[96:99], a[20:23], a[68:71], v[96:99]
    v_mfma_f32_16x16x32_bf16 v[104:107], a[20:23], a[76:79], v[104:107]
    buffer_store_dwordx4 a[192:195], v2, s[24:27], s28 offen sc1
    v_mfma_f32_16x16x32_bf16 v[104:107], a[16:19], a[72:75], v[104:107]
    s_add_u32 s28, s28, s31
    s_waitcnt lgkmcnt(15)
    v_mfma_f32_16x16x32_bf16 v[108:111], a[24:27], a[72:75], v[108:111]
    v_xor_b32 v8, s60, v8
    v_xor_b32 v9, s60, v9
    v_mfma_f32_16x16x32_bf16 v[108:111], a[28:31], a[76:79], v[108:111]
    v_xor_b32 v10, s60, v10
    v_xor_b32 v11, s60, v11
    v_mfma_f32_16x16x32_bf16 v[100:103], a[28:31], a[68:71], v[100:103]
    v_xor_b32 v12, s60, v12
    v_xor_b32 v13, s60, v13
    v_mfma_f32_16x16x32_bf16 v[100:103], a[24:27], a[64:67], v[100:103]
    v_xor_b32 v14, s60, v14
    v_xor_b32 v15, s60, v15
    v_mfma_f32_16x16x32_bf16 v[160:163], a[32:35], a[64:67], v[160:163]
    buffer_store_dwordx4 a[196:199], v2, s[24:27], s28 offen sc1
    v_mfma_f32_16x16x32_bf16 v[160:163], a[36:39], a[68:71], v[160:163]
    s_add_u32 s28, s28, s31
    v_mfma_f32_16x16x32_bf16 v[168:171], a[36:39], a[76:79], v[168:171]
    v_mfma_f32_16x16x32_bf16 v[168:171], a[32:35], a[72:75], v[168:171]
    s_waitcnt lgkmcnt(14)
    v_mfma_f32_16x16x32_bf16 v[172:175], a[40:43], a[72:75], v[172:175]
    v_mfma_f32_16x16x32_bf16 v[172:175], a[44:47], a[76:79], v[172:175]
    v_mfma_f32_16x16x32_bf16 v[164:167], a[44:47], a[68:71], v[164:167]
    buffer_store_dwordx4 a[200:203], v2, s[24:27], s28 offen sc1
    v_mfma_f32_16x16x32_bf16 v[164:167], a[40:43], a[64:67], v[164:167]
    s_add_u32 s28, s28, s31
    s_waitcnt lgkmcnt(11)
    v_mfma_f32_16x16x32_bf16 v[224:227], a[48:51], a[64:67], v[224:227]
    v_mfma_f32_16x16x32_bf16 v[224:227], a[52:55], a[68:71], v[224:227]
    v_mfma_f32_16x16x32_bf16 v[232:235], a[52:55], a[76:79], v[232:235]
    v_mfma_f32_16x16x32_bf16 v[232:235], a[48:51], a[72:75], v[232:235]
    s_waitcnt lgkmcnt(8)
    v_mfma_f32_16x16x32_bf16 v[236:239], a[56:59], a[72:75], v[236:239]
    buffer_store_dwordx4 a[204:207], v2, s[24:27], s28 offen sc1
    v_mfma_f32_16x16x32_bf16 v[236:239], a[60:63], a[76:79], v[236:239]
    s_add_u32 s28, s28, s31
    v_mfma_f32_16x16x32_bf16 v[228:231], a[60:63], a[68:71], v[228:231]
    s_waitcnt vmcnt(16) lgkmcnt(0)
    v_mfma_f32_16x16x32_bf16 v[228:231], a[56:59], a[64:67], v[228:231]
    s_barrier
    v_mfma_f32_16x16x32_bf16 v[48:51], a[0:3], a[80:83], v[48:51]
    ds_read_b64_tr_b16 a[64:65], v8 offset:0
    v_mfma_f32_16x16x32_bf16 v[48:51], a[4:7], a[84:87], v[48:51]
    s_add_u32 m0, s62, 0
    v_mfma_f32_16x16x32_bf16 v[56:59], a[4:7], a[92:95], v[56:59]
    buffer_load_dwordx4 v18, s[44:47], s52 offen offset:0 sc1 lds
    v_mfma_f32_16x16x32_bf16 v[56:59], a[0:3], a[88:91], v[56:59]
    ds_read_b64_tr_b16 a[66:67], v8 offset:2048
    v_mfma_f32_16x16x32_bf16 v[60:63], a[8:11], a[88:91], v[60:63]
    s_add_u32 s64, s64, 32768
    v_mfma_f32_16x16x32_bf16 v[60:63], a[12:15], a[92:95], v[60:63]
    s_cmp_ge_u32 s64, 98304
    s_cselect_b32 s63, 4294901760, s59
    s_cselect_b32 s64, 0, s64
    v_mfma_f32_16x16x32_bf16 v[52:55], a[12:15], a[84:87], v[52:55]
    buffer_load_dwordx4 v19, s[44:47], s52 offen offset:1024 sc1 lds
    v_mfma_f32_16x16x32_bf16 v[52:55], a[8:11], a[80:83], v[52:55]
    s_add_u32 s52, s52, s56
    ds_read_b64_tr_b16 a[68:69], v8 offset:16384
    v_mfma_f32_16x16x32_bf16 v[112:115], a[16:19], a[80:83], v[112:115]
    v_mfma_f32_16x16x32_bf16 v[112:115], a[20:23], a[84:87], v[112:115]
    v_mfma_f32_16x16x32_bf16 v[120:123], a[20:23], a[92:95], v[120:123]
    buffer_load_dwordx4 v18, s[44:47], s53 offen offset:2048 sc1 lds
    v_mfma_f32_16x16x32_bf16 v[120:123], a[16:19], a[88:91], v[120:123]
    ds_read_b64_tr_b16 a[70:71], v8 offset:18432
    v_mfma_f32_16x16x32_bf16 v[124:127], a[24:27], a[88:91], v[124:127]
    v_mfma_f32_16x16x32_bf16 v[124:127], a[28:31], a[92:95], v[124:127]
    v_mfma_f32_16x16x32_bf16 v[116:119], a[28:31], a[84:87], v[116:119]
    buffer_load_dwordx4 v19, s[44:47], s53 offen offset:3072 sc1 lds
    v_mfma_f32_16x16x32_bf16 v[116:119], a[24:27], a[80:83], v[116:119]
    s_add_u32 s53, s53, s56
    ds_read_b64_tr_b16 a[72:73], v9 offset:0
    v_mfma_f32_16x16x32_bf16 v[176:179], a[32:35], a[80:83], v[176:179]
    v_mfma_f32_16x16x32_bf16 v[176:179], a[36:39], a[84:87], v[176:179]
    s_add_u32 m0, s62, 4096
    v_mfma_f32_16x16x32_bf16 v[184:187], a[36:39], a[92:95], v[184:187]
    buffer_load_dwordx4 v20, s[44:47], s54 offen offset:0 sc1 lds
    v_mfma_f32_16x16x32_bf16 v[184:187], a[32:35], a[88:91], v[184:187]
    s_xor_b32 s62, s62, 229376
    ds_read_b64_tr_b16 a[74:75], v9 offset:2048
    v_mfma_f32_16x16x32_bf16 v[188:191], a[40:43], a[88:91], v[188:191]
    v_mfma_f32_16x16x32_bf16 v[188:191], a[44:47], a[92:95], v[188:191]
    v_mfma_f32_16x16x32_bf16 v[180:183], a[44:47], a[84:87], v[180:183]
    buffer_load_dwordx4 v21, s[44:47], s54 offen offset:1024 sc1 lds
    v_mfma_f32_16x16x32_bf16 v[180:183], a[40:43], a[80:83], v[180:183]
    s_add_u32 s54, s54, s56
    ds_read_b64_tr_b16 a[76:77], v9 offset:16384
    v_mfma_f32_16x16x32_bf16 v[240:243], a[48:51], a[80:83], v[240:243]
    v_mfma_f32_16x16x32_bf16 v[240:243], a[52:55], a[84:87], v[240:243]
    v_mfma_f32_16x16x32_bf16 v[248:251], a[52:55], a[92:95], v[248:251]
    buffer_load_dwordx4 v20, s[44:47], s55 offen offset:2048 sc1 lds
    v_mfma_f32_16x16x32_bf16 v[248:251], a[48:51], a[88:91], v[248:251]
    ds_read_b64_tr_b16 a[78:79], v9 offset:18432
    v_mfma_f32_16x16x32_bf16 v[252:255], a[56:59], a[88:91], v[252:255]
    v_add_u32 v6, s63, v6
    v_add_u32 v7, s63, v7
    v_mfma_f32_16x16x32_bf16 v[252:255], a[60:63], a[92:95], v[252:255]
    v_mfma_f32_16x16x32_bf16 v[244:247], a[60:63], a[84:87], v[244:247]
    buffer_load_dwordx4 v21, s[44:47], s55 offen offset:3072 sc1 lds
    v_mfma_f32_16x16x32_bf16 v[244:247], a[56:59], a[80:83], v[244:247]
    s_add_u32 s55, s55, s56
    v_mfma_f32_16x16x32_bf16 v[64:67], a[0:3], a[96:99], v[64:67]
    ds_read_b64_tr_b16 a[80:81], v10 offset:0
    v_mfma_f32_16x16x32_bf16 v[64:67], a[4:7], a[100:103], v[64:67]
    v_mfma_f32_16x16x32_bf16 v[72:75], a[4:7], a[108:111], v[72:75]
    v_mfma_f32_16x16x32_bf16 v[72:75], a[0:3], a[104:107], v[72:75]
    s_add_u32 m0, s61, 0
    ds_read_b64_tr_b16 a[82:83], v10 offset:2048
    v_mfma_f32_16x16x32_bf16 v[76:79], a[8:11], a[104:107], v[76:79]
    buffer_load_dwordx4 v16, s[40:43], s48 offen offset:0 sc1 lds
    v_mfma_f32_16x16x32_bf16 v[76:79], a[12:15], a[108:111], v[76:79]
    v_mfma_f32_16x16x32_bf16 v[68:71], a[12:15], a[100:103], v[68:71]
    ds_read_b64_tr_b16 a[84:85], v10 offset:16384
    v_mfma_f32_16x16x32_bf16 v[68:71], a[8:11], a[96:99], v[68:71]
    v_mfma_f32_16x16x32_bf16 v[128:131], a[16:19], a[96:99], v[128:131]
    buffer_store_dwordx4 a[208:211], v2, s[24:27], s28 offen sc1
    v_mfma_f32_16x16x32_bf16 v[128:131], a[20:23], a[100:103], v[128:131]
    s_add_u32 s28, s28, s31
    ds_read_b64_tr_b16 a[86:87], v10 offset:18432
    v_mfma_f32_16x16x32_bf16 v[136:139], a[20:23], a[108:111], v[136:139]
    v_mfma_f32_16x16x32_bf16 v[136:139], a[16:19], a[104:107], v[136:139]
    v_mfma_f32_16x16x32_bf16 v[140:143], a[24:27], a[104:107], v[140:143]
    buffer_load_dwordx4 v17, s[40:43], s48 offen offset:1024 sc1 lds
    v_mfma_f32_16x16x32_bf16 v[140:143], a[28:31], a[108:111], v[140:143]
    s_add_u32 s48, s48, 128
    ds_read_b64_tr_b16 a[88:89], v11 offset:0
    v_mfma_f32_16x16x32_bf16 v[132:135], a[28:31], a[100:103], v[132:135]
    v_mfma_f32_16x16x32_bf16 v[132:135], a[24:27], a[96:99], v[132:135]
    v_mfma_f32_16x16x32_bf16 v[192:195], a[32:35], a[96:99], v[192:195]
    buffer_store_dwordx4 a[212:215], v2, s[24:27], s28 offen sc1
    v_mfma_f32_16x16x32_bf16 v[192:195], a[36:39], a[100:103], v[192:195]
    s_add_u32 s28, s28, s31
    ds_read_b64_tr_b16 a[90:91], v11 offset:2048
    v_mfma_f32_16x16x32_bf16 v[200:203], a[36:39], a[108:111], v[200:203]
    v_mfma_f32_16x16x32_bf16 v[200:203], a[32:35], a[104:107], v[200:203]
    v_mfma_f32_16x16x32_bf16 v[204:207], a[40:43], a[104:107], v[204:207]
    buffer_load_dwordx4 v16, s[40:43], s49 offen offset:2048 sc1 lds
    v_mfma_f32_16x16x32_bf16 v[204:207], a[44:47], a[108:111], v[204:207]
    ds_read_b64_tr_b16 a[92:93], v11 offset:16384
    v_mfma_f32_16x16x32_bf16 v[196:199], a[44:47], a[100:103], v[196:199]
    v_mfma_f32_16x16x32_bf16 v[196:199], a[40:43], a[96:99], v[196:199]
    v_mfma_f32_16x16x32_bf16 a[224:227], a[48:51], a[96:99], a[224:227]
    buffer_store_dwordx4 a[216:219], v2, s[24:27], s28 offen sc1
    v_mfma_f32_16x16x32_bf16 a[224:227], a[52:55], a[100:103], a[224:227]
    s_add_u32 s28, s28, s31
    ds_read_b64_tr_b16 a[94:95], v11 offset:18432
    v_mfma_f32_16x16x32_bf16 a[232:235], a[52:55], a[108:111], a[232:235]
    v_mfma_f32_16x16x32_bf16 a[232:235], a[48:51], a[104:107], a[232:235]
    v_mfma_f32_16x16x32_bf16 a[236:239], a[56:59], a[104:107], a[236:239]
    buffer_load_dwordx4 v17, s[40:43], s49 offen offset:3072 sc1 lds
    v_mfma_f32_16x16x32_bf16 a[236:239], a[60:63], a[108:111], a[236:239]
    s_add_u32 s49, s49, 128
    v_mfma_f32_16x16x32_bf16 a[228:231], a[60:63], a[100:103], a[228:231]
    buffer_store_dwordx4 a[220:223], v2, s[24:27], s28 offen sc1
    v_mfma_f32_16x16x32_bf16 a[228:231], a[56:59], a[96:99], a[228:231]
    s_add_u32 s29, s29, s30
    s_mov_b32 s28, s29
    v_mfma_f32_16x16x32_bf16 v[80:83], a[0:3], a[112:115], v[80:83]
    v_mfma_f32_16x16x32_bf16 v[80:83], a[4:7], a[116:119], v[80:83]
    ds_read_b64_tr_b16 a[96:97], v12 offset:0
    v_mfma_f32_16x16x32_bf16 v[88:91], a[4:7], a[124:127], v[88:91]
    v_mfma_f32_16x16x32_bf16 v[88:91], a[0:3], a[120:123], v[88:91]
    s_add_u32 m0, s61, 4096
    ds_read_b128 a[0:3], v6 offset:0
    v_mfma_f32_16x16x32_bf16 v[92:95], a[8:11], a[120:123], v[92:95]
    buffer_load_dwordx4 v16, s[40:43], s50 offen offset:0 sc1 lds
    v_mfma_f32_16x16x32_bf16 v[92:95], a[12:15], a[124:127], v[92:95]
    s_add_u32 s61, s61, 32768
    ds_read_b128 a[4:7], v7 offset:0
    v_mfma_f32_16x16x32_bf16 v[84:87], a[12:15], a[116:119], v[84:87]
    s_cmp_ge_u32 s61, 98304
    s_cselect_b32 s90, 98304, 0
    ds_read_b64_tr_b16 a[98:99], v12 offset:2048
    v_mfma_f32_16x16x32_bf16 v[84:87], a[8:11], a[112:115], v[84:87]
    s_sub_u32 s61, s61, s90
    ds_read_b128 a[8:11], v6 offset:2048
    v_mfma_f32_16x16x32_bf16 v[144:147], a[16:19], a[112:115], v[144:147]
    ds_read_b128 a[12:15], v7 offset:2048
    v_mfma_f32_16x16x32_bf16 v[144:147], a[20:23], a[116:119], v[144:147]
    ds_read_b64_tr_b16 a[100:101], v12 offset:16384
    v_mfma_f32_16x16x32_bf16 v[152:155], a[20:23], a[124:127], v[152:155]
    v_mfma_f32_16x16x32_bf16 v[152:155], a[16:19], a[120:123], v[152:155]
    ds_read_b128 a[16:19], v6 offset:4096
    v_mfma_f32_16x16x32_bf16 v[156:159], a[24:27], a[120:123], v[156:159]
    buffer_load_dwordx4 v17, s[40:43], s50 offen offset:1024 sc1 lds
    v_mfma_f32_16x16x32_bf16 v[156:159], a[28:31], a[124:127], v[156:159]
    s_add_u32 s50, s50, 128
    ds_read_b128 a[20:23], v7 offset:4096
    v_mfma_f32_16x16x32_bf16 v[148:151], a[28:31], a[116:119], v[148:151]
    ds_read_b64_tr_b16 a[102:103], v12 offset:18432
    v_mfma_f32_16x16x32_bf16 v[148:151], a[24:27], a[112:115], v[148:151]
    ds_read_b128 a[24:27], v6 offset:6144
    v_mfma_f32_16x16x32_bf16 v[208:211], a[32:35], a[112:115], v[208:211]
    s_sub_u32 s65, s65, 1
    ds_read_b128 a[28:31], v7 offset:6144
    v_mfma_f32_16x16x32_bf16 v[208:211], a[36:39], a[116:119], v[208:211]
    ds_read_b64_tr_b16 a[104:105], v13 offset:0
    v_mfma_f32_16x16x32_bf16 v[216:219], a[36:39], a[124:127], v[216:219]
    v_mfma_f32_16x16x32_bf16 v[216:219], a[32:35], a[120:123], v[216:219]
    ds_read_b128 a[32:35], v6 offset:8192
    v_mfma_f32_16x16x32_bf16 v[220:223], a[40:43], a[120:123], v[220:223]
    buffer_load_dwordx4 v16, s[40:43], s51 offen offset:2048 sc1 lds
    v_mfma_f32_16x16x32_bf16 v[220:223], a[44:47], a[124:127], v[220:223]
    ds_read_b128 a[36:39], v7 offset:8192
    v_mfma_f32_16x16x32_bf16 v[212:215], a[44:47], a[116:119], v[212:215]
    ds_read_b64_tr_b16 a[106:107], v13 offset:2048
    v_mfma_f32_16x16x32_bf16 v[212:215], a[40:43], a[112:115], v[212:215]
    ds_read_b128 a[40:43], v6 offset:10240
    v_mfma_f32_16x16x32_bf16 a[240:243], a[48:51], a[112:115], a[240:243]
    ds_read_b128 a[44:47], v7 offset:10240
    v_mfma_f32_16x16x32_bf16 a[240:243], a[52:55], a[116:119], a[240:243]
    ds_read_b64_tr_b16 a[108:109], v13 offset:16384
    v_mfma_f32_16x16x32_bf16 a[248:251], a[52:55], a[124:127], a[248:251]
    v_mfma_f32_16x16x32_bf16 a[248:251], a[48:51], a[120:123], a[248:251]
    ds_read_b128 a[48:51], v6 offset:12288
    v_mfma_f32_16x16x32_bf16 a[252:255], a[56:59], a[120:123], a[252:255]
    buffer_load_dwordx4 v17, s[40:43], s51 offen offset:3072 sc1 lds
    v_mfma_f32_16x16x32_bf16 a[252:255], a[60:63], a[124:127], a[252:255]
    s_add_u32 s51, s51, 128
    ds_read_b128 a[52:55], v7 offset:12288
    v_mfma_f32_16x16x32_bf16 a[244:247], a[60:63], a[116:119], a[244:247]
    ds_read_b64_tr_b16 a[110:111], v13 offset:18432
    v_mfma_f32_16x16x32_bf16 a[244:247], a[56:59], a[112:115], a[244:247]
    ds_read_b128 a[56:59], v6 offset:14336
    ds_read_b128 a[60:63], v7 offset:14336
.p2align 3
m_loop23:
    s_waitcnt lgkmcnt(15)
    v_mfma_f32_16x16x32_bf16 v[32:35], a[0:3], a[64:67], v[32:35]
    ds_read_b64_tr_b16 a[112:113], v14 offset:0
    v_mfma_f32_16x16x32_bf16 v[32:35], a[4:7], a[68:71], v[32:35]
    ds_read_b64_tr_b16 a[114:115], v14 offset:2048
    v_mfma_f32_16x16x32_bf16 v[40:43], a[4:7], a[76:79], v[40:43]
    ds_read_b64_tr_b16 a[116:117], v14 offset:16384
    v_mfma_f32_16x16x32_bf16 v[40:43], a[0:3], a[72:75], v[40:43]
    ds_read_b64_tr_b16 a[118:119], v14 offset:18432
    v_mfma_f32_16x16x32_bf16 v[44:47], a[8:11], a[72:75], v[44:47]
    ds_read_b64_tr_b16 a[120:121], v15 offset:0
    v_mfma_f32_16x16x32_bf16 v[44:47], a[12:15], a[76:79], v[44:47]
    ds_read_b64_tr_b16 a[122:123], v15 offset:2048
    v_mfma_f32_16x16x32_bf16 v[36:39], a[12:15], a[68:71], v[36:39]
    ds_read_b64_tr_b16 a[124:125], v15 offset:16384
    v_mfma_f32_16x16x32_bf16 v[36:39], a[8:11], a[64:67], v[36:39]
    ds_read_b64_tr_b16 a[126:127], v15 offset:18432
    v_mfma_f32_16x16x32_bf16 v[96:99], a[16:19], a[64:67], v[96:99]
    v_mfma_f32_16x16x32_bf16 v[96:99], a[20:23], a[68:71], v[96:99]
    v_mfma_f32_16x16x32_bf16 v[104:107], a[20:23], a[76:79], v[104:107]
    v_mfma_f32_16x16x32_bf16 v[104:107], a[16:19], a[72:75], v[104:107]
    s_waitcnt lgkmcnt(15)
    v_mfma_f32_16x16x32_bf16 v[108:111], a[24:27], a[72:75], v[108:111]
    v_xor_b32 v8, s60, v8
    v_xor_b32 v9, s60, v9
    v_mfma_f32_16x16x32_bf16 v[108:111], a[28:31], a[76:79], v[108:111]
    v_xor_b32 v10, s60, v10
    v_xor_b32 v11, s60, v11
    v_mfma_f32_16x16x32_bf16 v[100:103], a[28:31], a[68:71], v[100:103]
    v_xor_b32 v12, s60, v12
    v_xor_b32 v13, s60, v13
    v_mfma_f32_16x16x32_bf16 v[100:103], a[24:27], a[64:67], v[100:103]
    v_xor_b32 v14, s60, v14
    v_xor_b32 v15, s60, v15
    v_mfma_f32_16x16x32_bf16 v[160:163], a[32:35], a[64:67], v[160:163]
    v_mfma_f32_16x16x32_bf16 v[160:163], a[36:39], a[68:71], v[160:163]
    v_mfma_f32_16x16x32_bf16 v[168:171], a[36:39], a[76:79], v[168:171]
    v_mfma_f32_16x16x32_bf16 v[168:171], a[32:35], a[72:75], v[168:171]
    s_waitcnt lgkmcnt(14)
    v_mfma_f32_16x16x32_bf16 v[172:175], a[40:43], a[72:75], v[172:175]
    v_mfma_f32_16x16x32_bf16 v[172:175], a[44:47], a[76:79], v[172:175]
    v_mfma_f32_16x16x32_bf16 v[164:167], a[44:47], a[68:71], v[164:167]
    v_mfma_f32_16x16x32_bf16 v[164:167], a[40:43], a[64:67], v[164:167]
    s_waitcnt lgkmcnt(11)
    v_mfma_f32_16x16x32_bf16 v[224:227], a[48:51], a[64:67], v[224:227]
    v_mfma_f32_16x16x32_bf16 v[224:227], a[52:55], a[68:71], v[224:227]
    v_mfma_f32_16x16x32_bf16 v[232:235], a[52:55], a[76:79], v[232:235]
    v_mfma_f32_16x16x32_bf16 v[232:235], a[48:51], a[72:75], v[232:235]
    s_waitcnt lgkmcnt(8)
    v_mfma_f32_16x16x32_bf16 v[236:239], a[56:59], a[72:75], v[236:239]
    v_mfma_f32_16x16x32_bf16 v[236:239], a[60:63], a[76:79], v[236:239]
    v_mfma_f32_16x16x32_bf16 v[228:231], a[60:63], a[68:71], v[228:231]
    s_waitcnt vmcnt(8) lgkmcnt(0)
    v_mfma_f32_16x16x32_bf16 v[228:231], a[56:59], a[64:67], v[228:231]
    s_barrier
    v_mfma_f32_16x16x32_bf16 v[48:51], a[0:3], a[80:83], v[48:51]
    ds_read_b64_tr_b16 a[64:65], v8 offset:0
    v_mfma_f32_16x16x32_bf16 v[48:51], a[4:7], a[84:87], v[48:51]
    s_add_u32 m0, s62, 0
    v_mfma_f32_16x16x32_bf16 v[56:59], a[4:7], a[92:95], v[56:59]
    buffer_load_dwordx4 v18, s[44:47], s52 offen offset:0 sc1 lds
    v_mfma_f32_16x16x32_bf16 v[56:59], a[0:3], a[88:91], v[56:59]
    ds_read_b64_tr_b16 a[66:67], v8 offset:2048
    v_mfma_f32_16x16x32_bf16 v[60:63], a[8:11], a[88:91], v[60:63]
    s_add_u32 s64, s64, 32768
    v_mfma_f32_16x16x32_bf16 v[60:63], a[12:15], a[92:95], v[60:63]
    s_cmp_ge_u32 s64, 98304
    s_cselect_b32 s63, 4294901760, s59
    s_cselect_b32 s64, 0, s64
    v_mfma_f32_16x16x32_bf16 v[52:55], a[12:15], a[84:87], v[52:55]
    buffer_load_dwordx4 v19, s[44:47], s52 offen offset:1024 sc1 lds
    v_mfma_f32_16x16x32_bf16 v[52:55], a[8:11], a[80:83], v[52:55]
    s_add_u32 s52, s52, s56
    ds_read_b64_tr_b16 a[68:69], v8 offset:16384
    v_mfma_f32_16x16x32_bf16 v[112:115], a[16:19], a[80:83], v[112:115]
    v_mfma_f32_16x16x32_bf16 v[112:115], a[20:23], a[84:87], v[112:115]
    v_mfma_f32_16x16x32_bf16 v[120:123], a[20:23], a[92:95], v[120:123]
    buffer_load_dwordx4 v18, s[44:47], s53 offen offset:2048 sc1 lds
    v_mfma_f32_16x16x32_bf16 v[120:123], a[16:19], a[88:91], v[120:123]
    ds_read_b64_tr_b16 a[70:71], v8 offset:18432
    v_mfma_f32_16x16x32_bf16 v[124:127], a[24:27], a[88:91], v[124:127]
    v_mfma_f32_16x16x32_bf16 v[124:127], a[28:31], a[92:95], v[124:127]
    v_mfma_f32_16x16x32_bf16 v[116:119], a[28:31], a[84:87], v[116:119]
    buffer_load_dwordx4 v19, s[44:47], s53 offen offset:3072 sc1 lds
    v_mfma_f32_16x16x32_bf16 v[116:119], a[24:27], a[80:83], v[116:119]
    s_add_u32 s53, s53, s56
    ds_read_b64_tr_b16 a[72:73], v9 offset:0
    v_mfma_f32_16x16x32_bf16 v[176:179], a[32:35], a[80:83], v[176:179]
    v_mfma_f32_16x16x32_bf16 v[176:179], a[36:39], a[84:87], v[176:179]
    s_add_u32 m0, s62, 4096
    v_mfma_f32_16x16x32_bf16 v[184:187], a[36:39], a[92:95], v[184:187]
    buffer_load_dwordx4 v20, s[44:47], s54 offen offset:0 sc1 lds
    v_mfma_f32_16x16x32_bf16 v[184:187], a[32:35], a[88:91], v[184:187]
    s_xor_b32 s62, s62, 229376
    ds_read_b64_tr_b16 a[74:75], v9 offset:2048
    v_mfma_f32_16x16x32_bf16 v[188:191], a[40:43], a[88:91], v[188:191]
    v_mfma_f32_16x16x32_bf16 v[188:191], a[44:47], a[92:95], v[188:191]
    v_mfma_f32_16x16x32_bf16 v[180:183], a[44:47], a[84:87], v[180:183]
    buffer_load_dwordx4 v21, s[44:47], s54 offen offset:1024 sc1 lds
    v_mfma_f32_16x16x32_bf16 v[180:183], a[40:43], a[80:83], v[180:183]
    s_add_u32 s54, s54, s56
    ds_read_b64_tr_b16 a[76:77], v9 offset:16384
    v_mfma_f32_16x16x32_bf16 v[240:243], a[48:51], a[80:83], v[240:243]
    v_mfma_f32_16x16x32_bf16 v[240:243], a[52:55], a[84:87], v[240:243]
    v_mfma_f32_16x16x32_bf16 v[248:251], a[52:55], a[92:95], v[248:251]
    buffer_load_dwordx4 v20, s[44:47], s55 offen offset:2048 sc1 lds
    v_mfma_f32_16x16x32_bf16 v[248:251], a[48:51], a[88:91], v[248:251]
    ds_read_b64_tr_b16 a[78:79], v9 offset:18432
    v_mfma_f32_16x16x32_bf16 v[252:255], a[56:59], a[88:91], v[252:255]
    v_add_u32 v6, s63, v6
    v_add_u32 v7, s63, v7
    v_mfma_f32_16x16x32_bf16 v[252:255], a[60:63], a[92:95], v[252:255]
    v_mfma_f32_16x16x32_bf16 v[244:247], a[60:63], a[84:87], v[244:247]
    buffer_load_dwordx4 v21, s[44:47], s55 offen offset:3072 sc1 lds
    v_mfma_f32_16x16x32_bf16 v[244:247], a[56:59], a[80:83], v[244:247]
    s_add_u32 s55, s55, s56
    v_mfma_f32_16x16x32_bf16 v[64:67], a[0:3], a[96:99], v[64:67]
    ds_read_b64_tr_b16 a[80:81], v10 offset:0
    v_mfma_f32_16x16x32_bf16 v[64:67], a[4:7], a[100:103], v[64:67]
    v_mfma_f32_16x16x32_bf16 v[72:75], a[4:7], a[108:111], v[72:75]
    v_mfma_f32_16x16x32_bf16 v[72:75], a[0:3], a[104:107], v[72:75]
    s_add_u32 m0, s61, 0
    ds_read_b64_tr_b16 a[82:83], v10 offset:2048
    v_mfma_f32_16x16x32_bf16 v[76:79], a[8:11], a[104:107], v[76:79]
    buffer_load_dwordx4 v16, s[40:43], s48 offen offset:0 sc1 lds
    v_mfma_f32_16x16x32_bf16 v[76:79], a[12:15], a[108:111], v[76:79]
    v_mfma_f32_16x16x32_bf16 v[68:71], a[12:15], a[100:103], v[68:71]
    ds_read_b64_tr_b16 a[84:85], v10 offset:16384
    v_mfma_f32_16x16x32_bf16 v[68:71], a[8:11], a[96:99], v[68:71]
    v_mfma_f32_16x16x32_bf16 v[128:131], a[16:19], a[96:99], v[128:131]
    v_mfma_f32_16x16x32_bf16 v[128:131], a[20:23], a[100:103], v[128:131]
    ds_read_b64_tr_b16 a[86:87], v10 offset:18432
    v_mfma_f32_16x16x32_bf16 v[136:139], a[20:23], a[108:111], v[136:139]
    v_mfma_f32_16x16x32_bf16 v[136:139], a[16:19], a[104:107], v[136:139]
    v_mfma_f32_16x16x32_bf16 v[140:143], a[24:27], a[104:107], v[140:143]
    buffer_load_dwordx4 v17, s[40:43], s48 offen offset:1024 sc1 lds
    v_mfma_f32_16x16x32_bf16 v[140:143], a[28:31], a[108:111], v[140:143]
    s_add_u32 s48, s48, 128
    ds_read_b64_tr_b16 a[88:89], v11 offset:0
    v_mfma_f32_16x16x32_bf16 v[132:135], a[28:31], a[100:103], v[132:135]
    v_mfma_f32_16x16x32_bf16 v[132:135], a[24:27], a[96:99], v[132:135]
    v_mfma_f32_16x16x32_bf16 v[192:195], a[32:35], a[96:99], v[192:195]
    v_mfma_f32_16x16x32_bf16 v[192:195], a[36:39], a[100:103], v[192:195]
    ds_read_b64_tr_b16 a[90:91], v11 offset:2048
    v_mfma_f32_16x16x32_bf16 v[200:203], a[36:39], a[108:111], v[200:203]
    v_mfma_f32_16x16x32_bf16 v[200:203], a[32:35], a[104:107], v[200:203]
    v_mfma_f32_16x16x32_bf16 v[204:207], a[40:43], a[104:107], v[204:207]
    buffer_load_dwordx4 v16, s[40:43], s49 offen offset:2048 sc1 lds
    v_mfma_f32_16x16x32_bf16 v[204:207], a[44:47], a[108:111], v[204:207]
    ds_read_b64_tr_b16 a[92:93], v11 offset:16384
    v_mfma_f32_16x16x32_bf16 v[196:199], a[44:47], a[100:103], v[196:199]
    v_mfma_f32_16x16x32_bf16 v[196:199], a[40:43], a[96:99], v[196:199]
    v_mfma_f32_16x16x32_bf16 a[224:227], a[48:51], a[96:99], a[224:227]
    v_mfma_f32_16x16x32_bf16 a[224:227], a[52:55], a[100:103], a[224:227]
    ds_read_b64_tr_b16 a[94:95], v11 offset:18432
    v_mfma_f32_16x16x32_bf16 a[232:235], a[52:55], a[108:111], a[232:235]
    v_mfma_f32_16x16x32_bf16 a[232:235], a[48:51], a[104:107], a[232:235]
    v_mfma_f32_16x16x32_bf16 a[236:239], a[56:59], a[104:107], a[236:239]
    buffer_load_dwordx4 v17, s[40:43], s49 offen offset:3072 sc1 lds
    v_mfma_f32_16x16x32_bf16 a[236:239], a[60:63], a[108:111], a[236:239]
    s_add_u32 s49, s49, 128
    v_mfma_f32_16x16x32_bf16 a[228:231], a[60:63], a[100:103], a[228:231]
    v_mfma_f32_16x16x32_bf16 a[228:231], a[56:59], a[96:99], a[228:231]
    v_mfma_f32_16x16x32_bf16 v[80:83], a[0:3], a[112:115], v[80:83]
    v_mfma_f32_16x16x32_bf16 v[80:83], a[4:7], a[116:119], v[80:83]
    ds_read_b64_tr_b16 a[96:97], v12 offset:0
    v_mfma_f32_16x16x32_bf16 v[88:91], a[4:7], a[124:127], v[88:91]
    v_mfma_f32_16x16x32_bf16 v[88:91], a[0:3], a[120:123], v[88:91]
    s_add_u32 m0, s61, 4096
    ds_read_b128 a[0:3], v6 offset:0
    v_mfma_f32_16x16x32_bf16 v[92:95], a[8:11], a[120:123], v[92:95]
    buffer_load_dwordx4 v16, s[40:43], s50 offen offset:0 sc1 lds
    v_mfma_f32_16x16x32_bf16 v[92:95], a[12:15], a[124:127], v[92:95]
    s_add_u32 s61, s61, 32768
    ds_read_b128 a[4:7], v7 offset:0
    v_mfma_f32_16x16x32_bf16 v[84:87], a[12:15], a[116:119], v[84:87]
    s_cmp_ge_u32 s61, 98304
    s_cselect_b32 s90, 98304, 0
    ds_read_b64_tr_b16 a[98:99], v12 offset:2048
    v_mfma_f32_16x16x32_bf16 v[84:87], a[8:11], a[112:115], v[84:87]
    s_sub_u32 s61, s61, s90
    ds_read_b128 a[8:11], v6 offset:2048
    v_mfma_f32_16x16x32_bf16 v[144:147], a[16:19], a[112:115], v[144:147]
    ds_read_b128 a[12:15], v7 offset:2048
    v_mfma_f32_16x16x32_bf16 v[144:147], a[20:23], a[116:119], v[144:147]
    ds_read_b64_tr_b16 a[100:101], v12 offset:16384
    v_mfma_f32_16x16x32_bf16 v[152:155], a[20:23], a[124:127], v[152:155]
    v_mfma_f32_16x16x32_bf16 v[152:155], a[16:19], a[120:123], v[152:155]
    ds_read_b128 a[16:19], v6 offset:4096
    v_mfma_f32_16x16x32_bf16 v[156:159], a[24:27], a[120:123], v[156:159]
    buffer_load_dwordx4 v17, s[40:43], s50 offen offset:1024 sc1 lds
    v_mfma_f32_16x16x32_bf16 v[156:159], a[28:31], a[124:127], v[156:159]
    s_add_u32 s50, s50, 128
    ds_read_b128 a[20:23], v7 offset:4096
    v_mfma_f32_16x16x32_bf16 v[148:151], a[28:31], a[116:119], v[148:151]
    ds_read_b64_tr_b16 a[102:103], v12 offset:18432
    v_mfma_f32_16x16x32_bf16 v[148:151], a[24:27], a[112:115], v[148:151]
    ds_read_b128 a[24:27], v6 offset:6144
    v_mfma_f32_16x16x32_bf16 v[208:211], a[32:35], a[112:115], v[208:211]
    s_sub_u32 s65, s65, 1
    ds_read_b128 a[28:31], v7 offset:6144
    v_mfma_f32_16x16x32_bf16 v[208:211], a[36:39], a[116:119], v[208:211]
    ds_read_b64_tr_b16 a[104:105], v13 offset:0
    v_mfma_f32_16x16x32_bf16 v[216:219], a[36:39], a[124:127], v[216:219]
    v_mfma_f32_16x16x32_bf16 v[216:219], a[32:35], a[120:123], v[216:219]
    ds_read_b128 a[32:35], v6 offset:8192
    v_mfma_f32_16x16x32_bf16 v[220:223], a[40:43], a[120:123], v[220:223]
    buffer_load_dwordx4 v16, s[40:43], s51 offen offset:2048 sc1 lds
    v_mfma_f32_16x16x32_bf16 v[220:223], a[44:47], a[124:127], v[220:223]
    ds_read_b128 a[36:39], v7 offset:8192
    v_mfma_f32_16x16x32_bf16 v[212:215], a[44:47], a[116:119], v[212:215]
    ds_read_b64_tr_b16 a[106:107], v13 offset:2048
    v_mfma_f32_16x16x32_bf16 v[212:215], a[40:43], a[112:115], v[212:215]
    ds_read_b128 a[40:43], v6 offset:10240
    v_mfma_f32_16x16x32_bf16 a[240:243], a[48:51], a[112:115], a[240:243]
    ds_read_b128 a[44:47], v7 offset:10240
    v_mfma_f32_16x16x32_bf16 a[240:243], a[52:55], a[116:119], a[240:243]
    ds_read_b64_tr_b16 a[108:109], v13 offset:16384
    v_mfma_f32_16x16x32_bf16 a[248:251], a[52:55], a[124:127], a[248:251]
    v_mfma_f32_16x16x32_bf16 a[248:251], a[48:51], a[120:123], a[248:251]
    ds_read_b128 a[48:51], v6 offset:12288
    v_mfma_f32_16x16x32_bf16 a[252:255], a[56:59], a[120:123], a[252:255]
    buffer_load_dwordx4 v17, s[40:43], s51 offen offset:3072 sc1 lds
    v_mfma_f32_16x16x32_bf16 a[252:255], a[60:63], a[124:127], a[252:255]
    s_add_u32 s51, s51, 128
    ds_read_b128 a[52:55], v7 offset:12288
    v_mfma_f32_16x16x32_bf16 a[244:247], a[60:63], a[116:119], a[244:247]
    s_cmp_gt_u32 s65, s67
    ds_read_b64_tr_b16 a[110:111], v13 offset:18432
    v_mfma_f32_16x16x32_bf16 a[244:247], a[56:59], a[112:115], a[244:247]
    ds_read_b128 a[56:59], v6 offset:14336
    ds_read_b128 a[60:63], v7 offset:14336
    s_cbranch_scc1 m_loop23
    s_cmp_lg_u32 s65, 0
    s_cbranch_scc1 m_dosw24
m_epi15:
    s_cmp_eq_u32 s94, 0
    s_cbranch_scc1 m_last27
    s_mov_b32 s3, 1048576
m_spin31:
    v_readfirstlane_b32 s4, v4
    v_readfirstlane_b32 s5, v5
    s_nop 3
    s_cmp_lg_u32 s4, 0
    s_cbranch_scc1 m_ok32
    s_sub_u32 s3, s3, 1
    s_cbranch_scc1 m_ok32
    s_sleep 32
    buffer_load_dwordx2 v[4:5], off, s[12:15], 0 sc1
    s_waitcnt vmcnt(0)
    s_branch m_spin31
m_ok32:
    s_cmp_ge_u32 s68, 16
    s_cbranch_scc1 m_q034
    s_call_b64 s[20:21], m_epf25
    s_mov_b32 s17, s101
    s_mov_b32 s66, 2
    s_branch m_q133
m_q034:
    s_call_b64 s[20:21], m_eps26
    s_mov_b32 s17, s101
    s_add_u32 s28, s98, s99
    s_mov_b32 s29, s28
    s_mov_b32 s30, s99
    s_mov_b32 s31, s100
    s_mov_b32 s26, 268435456
m_q133:
    s_mov_b32 s95, s82
    s_mov_b32 s96, s83
    s_mov_b32 s97, s84
    s_mov_b32 s98, s85
    s_mov_b32 s99, s86
    s_mov_b32 s100, s87
    s_mov_b32 s101, s88
    s_sub_u32 s67, s95, 5
    s_max_u32 s67, s67, 4
    s_mov_b32 s94, 0
    s_branch m_tile14
m_last27:
m_kvl30:
    s_waitcnt lgkmcnt(0)
    s_and_b32 s92, s2, 7
    s_lshl_b32 s92, s92, 2
    s_bfe_u32 s93, s2, 0x20003
    s_add_u32 s92, s92, s93
    s_lshr_b32 s93, s2, 5
    s_lshl_b32 s93, s93, 2
    s_or_b32 s93, s93, 0x40000
    s_mov_b32 s32, s92
    s_bfe_u32 s33, 4225681832, s93
    s_add_u32 s33, s33, 1
    s_bfe_u32 s34, 873473623, s93
    s_add_u32 s34, s34, 1
    s_lshl_b32 s60, s16, 12
    v_add_u32 v7, s60, v2
    s_lshl_b32 s90, s34, 2
    s_lshl_b32 s91, s33, 2
    s_lshl_b32 s26, s91, 13
    s_mov_b32 s30, s26
    s_sub_u32 s67, s90, 4
    s_add_u32 s67, s67, s16
    s_add_u32 s68, s67, 1
    s_mov_b32 s69, s90
    s_sub_u32 s70, s91, 4
    s_add_u32 s70, s70, s16
    s_add_u32 s71, s70, 1
    s_mov_b32 s72, s91
    s_cmp_lt_u32 s16, 2
    s_cselect_b32 s90, 2, 0
    s_sub_u32 s72, s72, s90
    s_mov_b32 s27, 0x20000
    s_mov_b32 s31, 0x20000
    s_lshl_b32 s82, s32, 19
    s_add_u32 s90, s82, 16777216
    s_add_u32 s24, s6, s90
    s_addc_u32 s25, s7, 0
    s_add_u32 s90, s82, 33554432
    s_add_u32 s28, s6, s90
    s_addc_u32 s29, s7, 0
    s_call_b64 s[20:21], m_epl63
    s_mov_b32 s17, s101
    s_mov_b32 s38, 268435456
m_init29:
    s_mov_b32 s56, 81920
    s_mov_b32 s57, 65536
    s_nop 1
    v_mov_b32 v9, 0xff800000
    s_mov_b32 s65, 1233125376
    s_lshl_b32 s91, s16, 1
    s_sub_u32 s91, s91, 8
    s_lshl_b32 s78, s33, 3
    s_add_u32 s78, s78, s91
    s_lshl_b32 s79, s34, 3
    s_add_u32 s79, s79, s91
    s_mov_b32 s36, s6
    s_mov_b32 s37, s7
    s_mov_b32 s39, 0x20000
    s_load_dwordx2 s[48:49], s[0:1], 64
    s_load_dwordx2 s[50:51], s[0:1], 16
    s_load_dwordx2 s[54:55], s[0:1], 72
    s_mov_b32 s47, 0x20000
    s_lshl_b32 s90, s99, 1
    s_add_u32 s98, s98, s90
    s_lshl_b32 s90, s100, 2
    s_add_u32 s40, s98, s90
    s_lshr_b32 s90, s32, 1
    s_lshl_b32 s90, s90, 7
    s_add_u32 s90, s90, 117444608
    s_lshr_b32 s91, s2, 6
    s_lshl_b32 s91, s91, 8
    s_add_u32 s91, s91, 117446592
    v_min_u32 v10, 31, v1
    v_lshlrev_b32 v10, 3, v10
    v_mov_b32 v11, s90
    v_mov_b32 v8, s91
    v_cmp_gt_u32 vcc, 8, v1
    s_nop 1
    v_cndmask_b32 v11, v8, v11, vcc
    v_add_u32 v10, v10, v11
    s_mov_b32 s58, 0
    v_mov_b32 v6, v2
    v_accvgpr_write_b32 a0, 0
    v_accvgpr_write_b32 a1, 0
    v_accvgpr_write_b32 a2, 0
    v_accvgpr_write_b32 a3, 0
    v_accvgpr_write_b32 a4, 0
    v_accvgpr_write_b32 a5, 0
    v_accvgpr_write_b32 a6, 0
    v_accvgpr_write_b32 a7, 0
    v_accvgpr_write_b32 a8, 0
    v_accvgpr_write_b32 a9, 0
    v_accvgpr_write_b32 a10, 0
    v_accvgpr_write_b32 a11, 0
    v_accvgpr_write_b32 a12, 0
    v_accvgpr_write_b32 a13, 0
    v_accvgpr_write_b32 a14, 0
    v_accvgpr_write_b32 a15, 0
    v_accvgpr_write_b32 a16, 0
    v_accvgpr_write_b32 a17, 0
    v_accvgpr_write_b32 a18, 0
    v_accvgpr_write_b32 a19, 0
    v_accvgpr_write_b32 a20, 0
    v_accvgpr_write_b32 a21, 0
    v_accvgpr_write_b32 a22, 0
    v_accvgpr_write_b32 a23, 0
    v_accvgpr_write_b32 a24, 0
    v_accvgpr_write_b32 a25, 0
    v_accvgpr_write_b32 a26, 0
    v_accvgpr_write_b32 a27, 0
    v_accvgpr_write_b32 a28, 0
    v_accvgpr_write_b32 a29, 0
    v_accvgpr_write_b32 a30, 0
    v_accvgpr_write_b32 a31, 0
    v_accvgpr_write_b32 a32, 0
    v_accvgpr_write_b32 a33, 0
    v_accvgpr_write_b32 a34, 0
    v_accvgpr_write_b32 a35, 0
    v_accvgpr_write_b32 a36, 0
    v_accvgpr_write_b32 a37, 0
    v_accvgpr_write_b32 a38, 0
    v_accvgpr_write_b32 a39, 0
    v_accvgpr_write_b32 a40, 0
    v_accvgpr_write_b32 a41, 0
    v_accvgpr_write_b32 a42, 0
    v_accvgpr_write_b32 a43, 0
    v_accvgpr_write_b32 a44, 0
    v_accvgpr_write_b32 a45, 0
    v_accvgpr_write_b32 a46, 0
    v_accvgpr_write_b32 a47, 0
    v_accvgpr_write_b32 a48, 0
    v_accvgpr_write_b32 a49, 0
    v_accvgpr_write_b32 a50, 0
    v_accvgpr_write_b32 a51, 0
    v_accvgpr_write_b32 a52, 0
    v_accvgpr_write_b32 a53, 0
    v_accvgpr_write_b32 a54, 0
    v_accvgpr_write_b32 a55, 0
    v_accvgpr_write_b32 a56, 0
    v_accvgpr_write_b32 a57, 0
    v_accvgpr_write_b32 a58, 0
    v_accvgpr_write_b32 a59, 0
    v_accvgpr_write_b32 a60, 0
    v_accvgpr_write_b32 a61, 0
    v_accvgpr_write_b32 a62, 0
    v_accvgpr_write_b32 a63, 0
    v_accvgpr_write_b32 a64, 0
    v_accvgpr_write_b32 a65, 0
    v_accvgpr_write_b32 a66, 0
    v_accvgpr_write_b32 a67, 0
    v_accvgpr_write_b32 a68, 0
    v_accvgpr_write_b32 a69, 0
    v_accvgpr_write_b32 a70, 0
    v_accvgpr_write_b32 a71, 0
    v_accvgpr_write_b32 a72, 0
    v_accvgpr_write_b32 a73, 0
    v_accvgpr_write_b32 a74, 0
    v_accvgpr_write_b32 a75, 0
    v_accvgpr_write_b32 a76, 0
    v_accvgpr_write_b32 a77, 0
    v_accvgpr_write_b32 a78, 0
    v_accvgpr_write_b32 a79, 0
    v_mov_b64 v[160:161], 0
    v_mov_b64 v[162:163], 0
    v_mov_b64 v[164:165], 0
    v_mov_b64 v[166:167], 0
    v_mov_b64 v[168:169], 0
    v_mov_b64 v[170:171], 0
    v_mov_b64 v[172:173], 0
    v_mov_b64 v[174:175], 0
    v_mov_b64 v[176:177], 0
    v_mov_b64 v[178:179], 0
    v_mov_b64 v[180:181], 0
    v_mov_b64 v[182:183], 0
    v_mov_b64 v[184:185], 0
    v_mov_b64 v[186:187], 0
    v_mov_b64 v[188:189], 0
    v_mov_b64 v[190:191], 0
    v_mov_b32 v12, 0
    v_mov_b32 v28, 0
    v_mov_b32 v44, 0x3f803f80
    v_mov_b32 v13, 0
    v_mov_b32 v32, 0
    v_mov_b32 v45, 0x3f803f80
    v_mov_b32 v14, 0
    v_mov_b32 v36, 0
    v_mov_b32 v46, 0x3f803f80
    v_mov_b32 v15, 0
    v_mov_b32 v40, 0
    v_mov_b32 v47, 0x3f803f80
    s_and_b32 s90, s2, 7
    s_lshl_b32 s90, s90, 4
    s_lshl_b32 s91, s16, 2
    s_add_u32 s80, s90, s91
    s_lshr_b32 s92, s2, 3
    s_lshl_b32 s92, s92, 17
    s_lshl_b32 s90, s80, 10
    s_add_u32 s90, s90, s92
    s_add_u32 s83, s90, 50331648
    s_add_u32 s84, s90, 54525952
    s_and_b32 s81, s80, 63
    s_cmp_eq_u32 s81, 0
    s_cselect_b32 s93, 0, 1024
    s_sub_u32 s85, s84, s93
    s_lshl_b32 s90, s80, 9
    s_add_u32 s90, s90, s92
    s_add_u32 s86, s90, 58720256
    s_sub_u32 s87, s86, s93
    s_add_u32 s88, s86, 65536
    s_add_u32 s89, s87, 65536
    v_and_b32 v48, 15, v1
    v_lshrrev_b32 v49, 4, v1
    v_lshlrev_b32 v49, 2, v49
    v_sub_u32 v48, v48, v49
    v_cmp_le_i32 vcc, 0, v48
    s_nop 1
    v_cndmask_b32 v16, v9, 0, vcc
    v_cmp_le_i32 vcc, 1, v48
    s_nop 1
    v_cndmask_b32 v17, v9, 0, vcc
    v_cmp_le_i32 vcc, 2, v48
    s_nop 1
    v_cndmask_b32 v18, v9, 0, vcc
    v_cmp_le_i32 vcc, 3, v48
    s_nop 1
    v_cndmask_b32 v19, v9, 0, vcc
    s_mov_b32 s62, 8945792
    s_mov_b32 s63, 0
    s_sub_u32 s90, s67, 1
    s_bitset1_b64 s[62:63], s90
    s_sub_u32 s90, s68, 1
    s_bitset1_b64 s[62:63], s90
    s_sub_u32 s90, s69, 1
    s_bitset1_b64 s[62:63], s90
    s_sub_u32 s90, s70, 1
    s_bitset1_b64 s[62:63], s90
    s_sub_u32 s90, s71, 1
    s_bitset1_b64 s[62:63], s90
    s_sub_u32 s90, s72, 1
    s_bitset1_b64 s[62:63], s90
    s_add_u32 s53, s69, 8
    s_sub_u32 s90, s53, 1
    s_bitset1_b64 s[62:63], s90
    s_mov_b32 s64, 0
    s_cmp_lg_u32 s64, s67
    s_cbranch_scc1 m_e69
    v_add_f32 v176, v176, v16
    v_mov_b32 v180, v9
    v_add_f32 v188, v188, v16
    v_add_f32 v177, v177, v17
    v_mov_b32 v181, v9
    v_add_f32 v189, v189, v17
    v_add_f32 v178, v178, v18
    v_mov_b32 v182, v9
    v_add_f32 v190, v190, v18
    v_add_f32 v179, v179, v19
    v_mov_b32 v183, v9
    v_add_f32 v191, v191, v19
    s_nop 0
m_e69:
    s_waitcnt vmcnt(32) lgkmcnt(0)
    s_barrier
    ds_read_b128 a[192:195], v6 offset:0
    ds_read_b128 a[196:199], v6 offset:1024
    ds_read_b128 a[200:203], v6 offset:2048
    ds_read_b128 a[204:207], v6 offset:3072
    ds_read_b128 a[208:211], v6 offset:4096
    ds_read_b128 a[212:215], v6 offset:5120
    ds_read_b128 a[216:219], v6 offset:6144
    ds_read_b128 a[220:223], v6 offset:7168
    s_waitcnt lgkmcnt(0)
    v_mfma_f32_16x16x32_bf16 v[64:67], a[192:195], a[128:131], v[160:163]
    v_accvgpr_write_b32 a80, 0
    v_accvgpr_write_b32 a81, 0
    v_mfma_f32_16x16x32_bf16 v[64:67], a[196:199], a[132:135], v[64:67]
    buffer_store_dwordx4 v[192:195], v2, s[36:39], s40 offen sc1
    s_add_u32 s40, s40, s100
    v_mfma_f32_16x16x32_bf16 v[64:67], a[200:203], a[136:139], v[64:67]
    v_accvgpr_write_b32 a82, 0
    v_accvgpr_write_b32 a83, 0
    v_mfma_f32_16x16x32_bf16 v[64:67], a[204:207], a[140:143], v[64:67]
    v_accvgpr_write_b32 a84, 0
    v_accvgpr_write_b32 a85, 0
    v_mfma_f32_16x16x32_bf16 v[72:75], a[204:207], a[156:159], v[168:171]
    v_accvgpr_write_b32 a86, 0
    v_accvgpr_write_b32 a87, 0
    v_mfma_f32_16x16x32_bf16 v[72:75], a[200:203], a[152:155], v[72:75]
    buffer_store_dwordx4 v[196:199], v2, s[36:39], s40 offen sc1
    s_add_u32 s40, s40, s100
    v_mfma_f32_16x16x32_bf16 v[72:75], a[196:199], a[148:151], v[72:75]
    v_accvgpr_write_b32 a88, 0
    v_accvgpr_write_b32 a89, 0
    v_mfma_f32_16x16x32_bf16 v[72:75], a[192:195], a[144:147], v[72:75]
    v_accvgpr_write_b32 a90, 0
    v_accvgpr_write_b32 a91, 0
    v_mfma_f32_16x16x32_bf16 v[80:83], a[192:195], a[160:163], v[176:179]
    v_accvgpr_write_b32 a92, 0
    v_accvgpr_write_b32 a93, 0
    v_mfma_f32_16x16x32_bf16 v[80:83], a[196:199], a[164:167], v[80:83]
    buffer_store_dwordx4 v[200:203], v2, s[36:39], s40 offen sc1
    s_add_u32 s40, s40, s100
    v_mfma_f32_16x16x32_bf16 v[80:83], a[200:203], a[168:171], v[80:83]
    v_accvgpr_write_b32 a94, 0
    v_accvgpr_write_b32 a95, 0
    v_mfma_f32_16x16x32_bf16 v[80:83], a[204:207], a[172:175], v[80:83]
    v_accvgpr_write_b32 a96, 0
    v_accvgpr_write_b32 a97, 0
    v_mfma_f32_16x16x32_bf16 v[88:91], a[204:207], a[188:191], v[184:187]
    v_accvgpr_write_b32 a98, 0
    v_accvgpr_write_b32 a99, 0
    v_mfma_f32_16x16x32_bf16 v[88:91], a[200:203], a[184:187], v[88:91]
    buffer_store_dwordx4 v[204:207], v2, s[36:39], s40 offen sc1
    s_add_u32 s40, s98, s99
    v_mfma_f32_16x16x32_bf16 v[88:91], a[196:199], a[180:183], v[88:91]
    v_accvgpr_write_b32 a100, 0
    v_accvgpr_write_b32 a101, 0
    v_mfma_f32_16x16x32_bf16 v[88:91], a[192:195], a[176:179], v[88:91]
    v_accvgpr_write_b32 a102, 0
    v_accvgpr_write_b32 a103, 0
    v_mfma_f32_16x16x32_bf16 v[92:95], a[208:211], a[176:179], v[188:191]
    ds_read_b128 a[192:195], v6 offset:8192
    v_accvgpr_write_b32 a104, 0
    v_accvgpr_write_b32 a105, 0
    v_mfma_f32_16x16x32_bf16 v[92:95], a[212:215], a[180:183], v[92:95]
    buffer_store_dwordx4 v[208:211], v2, s[36:39], s40 offen sc1
    s_add_u32 s40, s40, s100
    ds_read_b128 a[196:199], v6 offset:9216
    v_mfma_f32_16x16x32_bf16 v[92:95], a[216:219], a[184:187], v[92:95]
    ds_read_b128 a[200:203], v6 offset:10240
    v_accvgpr_write_b32 a106, 0
    v_accvgpr_write_b32 a107, 0
    v_mfma_f32_16x16x32_bf16 v[92:95], a[220:223], a[188:191], v[92:95]
    ds_read_b128 a[204:207], v6 offset:11264
    v_accvgpr_write_b32 a108, 0
    v_accvgpr_write_b32 a109, 0
    v_mfma_f32_16x16x32_bf16 v[84:87], a[220:223], a[172:175], v[180:183]
    v_accvgpr_write_b32 a110, 0
    v_accvgpr_write_b32 a111, 0
    v_mfma_f32_16x16x32_bf16 v[84:87], a[216:219], a[168:171], v[84:87]
    buffer_store_dwordx4 v[212:215], v2, s[36:39], s40 offen sc1
    s_add_u32 s40, s40, s100
    v_mfma_f32_16x16x32_bf16 v[84:87], a[212:215], a[164:167], v[84:87]
    v_accvgpr_write_b32 a112, 0
    v_accvgpr_write_b32 a113, 0
    v_mfma_f32_16x16x32_bf16 v[84:87], a[208:211], a[160:163], v[84:87]
    v_accvgpr_write_b32 a114, 0
    v_accvgpr_write_b32 a115, 0
    v_mfma_f32_16x16x32_bf16 v[76:79], a[208:211], a[144:147], v[172:175]
    v_accvgpr_write_b32 a116, 0
    v_accvgpr_write_b32 a117, 0
    v_mfma_f32_16x16x32_bf16 v[76:79], a[212:215], a[148:151], v[76:79]
    buffer_store_dwordx4 v[216:219], v2, s[36:39], s40 offen sc1
    s_add_u32 s40, s40, s100
    v_mfma_f32_16x16x32_bf16 v[76:79], a[216:219], a[152:155], v[76:79]
    v_accvgpr_write_b32 a118, 0
    v_accvgpr_write_b32 a119, 0
    v_mfma_f32_16x16x32_bf16 v[76:79], a[220:223], a[156:159], v[76:79]
    v_accvgpr_write_b32 a120, 0
    v_accvgpr_write_b32 a121, 0
    v_mfma_f32_16x16x32_bf16 v[68:71], a[220:223], a[140:143], v[164:167]
    v_accvgpr_write_b32 a122, 0
    v_accvgpr_write_b32 a123, 0
    v_mfma_f32_16x16x32_bf16 v[68:71], a[216:219], a[136:139], v[68:71]
    buffer_store_dwordx4 v[220:223], v2, s[36:39], s40 offen sc1
    s_add_u32 s40, s40, s100
    v_mfma_f32_16x16x32_bf16 v[68:71], a[212:215], a[132:135], v[68:71]
    v_accvgpr_write_b32 a124, 0
    v_accvgpr_write_b32 a125, 0
    v_mfma_f32_16x16x32_bf16 v[68:71], a[208:211], a[128:131], v[68:71]
    v_accvgpr_write_b32 a126, 0
    v_accvgpr_write_b32 a127, 0
    ds_read_b128 a[208:211], v6 offset:12288
    ds_read_b128 a[212:215], v6 offset:13312
    ds_read_b128 a[216:219], v6 offset:14336
    ds_read_b128 a[220:223], v6 offset:15360
    s_mov_b32 s64, 1
    s_nop 0
    s_nop 3
    v_max3_f32 v48, v64, v65, v66
    v_max3_f32 v49, v72, v73, v74
    v_max3_f32 v50, v80, v81, v82
    v_max3_f32 v51, v88, v89, v90
    v_max3_f32 v48, v48, v67, v68
    v_max3_f32 v49, v49, v75, v76
    v_max3_f32 v50, v50, v83, v84
    v_max3_f32 v51, v51, v91, v92
    v_max3_f32 v48, v48, v69, v70
    v_max3_f32 v49, v49, v77, v78
    v_max3_f32 v50, v50, v85, v86
    v_max3_f32 v51, v51, v93, v94
    v_max_f32 v48, v48, v71
    v_max_f32 v49, v49, v79
    v_max_f32 v50, v50, v87
    v_max_f32 v51, v51, v95
    v_mov_b32 v52, v48
    v_mov_b32 v53, v49
    v_mov_b32 v54, v50
    v_mov_b32 v55, v51
    s_nop 1
    v_permlane32_swap_b32 v48, v52
    v_permlane32_swap_b32 v49, v53
    v_permlane32_swap_b32 v50, v54
    v_permlane32_swap_b32 v51, v55
    s_nop 1
    v_max_f32 v48, v48, v52
    v_max_f32 v49, v49, v53
    v_max_f32 v50, v50, v54
    v_max_f32 v51, v51, v55
    v_mov_b32 v52, v48
    v_mov_b32 v53, v49
    v_mov_b32 v54, v50
    v_mov_b32 v55, v51
    s_nop 1
    v_permlane16_swap_b32 v48, v52
    v_permlane16_swap_b32 v49, v53
    v_permlane16_swap_b32 v50, v54
    v_permlane16_swap_b32 v51, v55
    s_nop 1
    v_max_f32 v48, v48, v52
    v_max_f32 v49, v49, v53
    v_max_f32 v50, v50, v54
    v_max_f32 v51, v51, v55
    v_sub_f32 v160, v160, v48
    v_sub_f32 v161, v161, v48
    v_sub_f32 v162, v162, v48
    v_sub_f32 v163, v163, v48
    v_sub_f32 v164, v164, v48
    v_sub_f32 v165, v165, v48
    v_sub_f32 v166, v166, v48
    v_sub_f32 v167, v167, v48
    v_sub_f32 v168, v168, v49
    v_sub_f32 v169, v169, v49
    v_sub_f32 v170, v170, v49
    v_sub_f32 v171, v171, v49
    v_sub_f32 v172, v172, v49
    v_sub_f32 v173, v173, v49
    v_sub_f32 v174, v174, v49
    v_sub_f32 v175, v175, v49
    v_sub_f32 v176, v176, v50
    v_sub_f32 v177, v177, v50
    v_sub_f32 v178, v178, v50
    v_sub_f32 v179, v179, v50
    v_sub_f32 v180, v180, v50
    v_sub_f32 v181, v181, v50
    v_sub_f32 v182, v182, v50
    v_sub_f32 v183, v183, v50
    v_sub_f32 v184, v184, v51
    v_sub_f32 v185, v185, v51
    v_sub_f32 v186, v186, v51
    v_sub_f32 v187, v187, v51
    v_sub_f32 v188, v188, v51
    v_sub_f32 v189, v189, v51
    v_sub_f32 v190, v190, v51
    v_sub_f32 v191, v191, v51
    v_sub_f32 v64, v64, v48
    v_sub_f32 v65, v65, v48
    v_sub_f32 v66, v66, v48
    v_sub_f32 v67, v67, v48
    v_sub_f32 v68, v68, v48
    v_sub_f32 v69, v69, v48
    v_sub_f32 v70, v70, v48
    v_sub_f32 v71, v71, v48
    v_sub_f32 v72, v72, v49
    v_sub_f32 v73, v73, v49
    v_sub_f32 v74, v74, v49
    v_sub_f32 v75, v75, v49
    v_sub_f32 v76, v76, v49
    v_sub_f32 v77, v77, v49
    v_sub_f32 v78, v78, v49
    v_sub_f32 v79, v79, v49
    v_sub_f32 v80, v80, v50
    v_sub_f32 v81, v81, v50
    v_sub_f32 v82, v82, v50
    v_sub_f32 v83, v83, v50
    v_sub_f32 v84, v84, v50
    v_sub_f32 v85, v85, v50
    v_sub_f32 v86, v86, v50
    v_sub_f32 v87, v87, v50
    v_sub_f32 v88, v88, v51
    v_sub_f32 v89, v89, v51
    v_sub_f32 v90, v90, v51
    v_sub_f32 v91, v91, v51
    v_sub_f32 v92, v92, v51
    v_sub_f32 v93, v93, v51
    v_sub_f32 v94, v94, v51
    v_sub_f32 v95, v95, v51
    s_cmp_lg_u32 s64, s67
    s_cbranch_scc1 m_e70
    v_add_f32 v176, v176, v16
    v_mov_b32 v180, v9
    v_add_f32 v188, v188, v16
    v_add_f32 v177, v177, v17
    v_mov_b32 v181, v9
    v_add_f32 v189, v189, v17
    v_add_f32 v178, v178, v18
    v_mov_b32 v182, v9
    v_add_f32 v190, v190, v18
    v_add_f32 v179, v179, v19
    v_mov_b32 v183, v9
    v_add_f32 v191, v191, v19
    s_nop 0
m_e70:
    s_cmp_lg_u32 s64, s68
    s_cbranch_scc1 m_e71
    v_mov_b32 v176, v9
    v_mov_b32 v184, v9
    v_mov_b32 v188, v9
    v_mov_b32 v177, v9
    v_mov_b32 v185, v9
    v_mov_b32 v189, v9
    v_mov_b32 v178, v9
    v_mov_b32 v186, v9
    v_mov_b32 v190, v9
    v_mov_b32 v179, v9
    v_mov_b32 v187, v9
    v_mov_b32 v191, v9
    s_nop 0
m_e71:
    s_waitcnt lgkmcnt(0)
    v_mfma_f32_16x16x32_bf16 v[96:99], a[192:195], a[128:131], v[160:163]
    s_bitcmp1_b64 s[62:63], s64
    s_cselect_b32 s66, -1.0, s65
    v_exp_f32 v20, v64
    v_mfma_f32_16x16x32_bf16 v[96:99], a[196:199], a[132:135], v[96:99]
    s_add_u32 s64, s64, 1
    v_exp_f32 v21, v65
    v_exp_f32 v22, v66
    v_mfma_f32_16x16x32_bf16 v[96:99], a[200:203], a[136:139], v[96:99]
    buffer_store_dwordx4 v[224:227], v2, s[36:39], s40 offen sc1
    v_cvt_pk_bf16_f32 v128, v20, v21
    v_mfma_f32_16x16x32_bf16 v[96:99], a[204:207], a[140:143], v[96:99]
    s_add_u32 s40, s40, s100
    v_add_f32 v12, v12, v28
    v_exp_f32 v23, v67
    v_mfma_f32_16x16x32_bf16 v[104:107], a[204:207], a[156:159], v[168:171]
    v_exp_f32 v24, v68
    v_cvt_pk_bf16_f32 v129, v22, v23
    v_mfma_f32_16x16x32_bf16 v[104:107], a[200:203], a[152:155], v[104:107]
    buffer_store_dwordx4 v[228:231], v2, s[36:39], s40 offen sc1
    v_exp_f32 v25, v69
    v_mfma_f32_16x16x32_bf16 v[104:107], a[196:199], a[148:151], v[104:107]
    s_add_u32 s40, s40, s100
    v_exp_f32 v26, v70
    v_cvt_pk_bf16_f32 v130, v24, v25
    v_mfma_f32_16x16x32_bf16 v[104:107], a[192:195], a[144:147], v[104:107]
    v_exp_f32 v27, v71
    v_add_f32 v13, v13, v32
    v_mfma_f32_16x16x32_bf16 v[112:115], a[192:195], a[160:163], v[176:179]
    v_exp_f32 v20, v72
    v_cvt_pk_bf16_f32 v131, v26, v27
    v_mfma_f32_16x16x32_bf16 v[112:115], a[196:199], a[164:167], v[112:115]
    buffer_store_dwordx4 v[232:235], v2, s[36:39], s40 offen sc1
    v_exp_f32 v21, v73
    v_mfma_f32_16x16x32_bf16 v[28:31], v[44:47], v[128:131], 0
    v_exp_f32 v22, v74
    v_cvt_pk_bf16_f32 v132, v20, v21
    v_mfma_f32_16x16x32_bf16 v[112:115], a[200:203], a[168:171], v[112:115]
    s_add_u32 s40, s40, s100
    v_exp_f32 v23, v75
    v_add_f32 v14, v14, v36
    v_mfma_f32_16x16x32_bf16 v[112:115], a[204:207], a[172:175], v[112:115]
    v_exp_f32 v24, v76
    v_cvt_pk_bf16_f32 v133, v22, v23
    v_mfma_f32_16x16x32_bf16 v[120:123], a[204:207], a[188:191], v[184:187]
    buffer_store_dwordx4 v[236:239], v2, s[36:39], s40 offen sc1
    v_exp_f32 v25, v77
    v_mfma_f32_16x16x32_bf16 v[120:123], a[200:203], a[184:187], v[120:123]
    s_mov_b32 s40, s98
    v_exp_f32 v26, v78
    v_cvt_pk_bf16_f32 v134, v24, v25
    v_mfma_f32_16x16x32_bf16 v[120:123], a[196:199], a[180:183], v[120:123]
    v_exp_f32 v27, v79
    v_add_f32 v15, v15, v40
    v_mfma_f32_16x16x32_bf16 v[120:123], a[192:195], a[176:179], v[120:123]
    s_waitcnt lgkmcnt(0)
    v_exp_f32 v20, v80
    v_cvt_pk_bf16_f32 v135, v26, v27
    v_mfma_f32_16x16x32_bf16 v[124:127], a[208:211], a[176:179], v[188:191]
    v_exp_f32 v21, v81
    v_exp_f32 v22, v82
    v_mfma_f32_16x16x32_bf16 v[32:35], v[44:47], v[132:135], 0
    v_cvt_pk_bf16_f32 v136, v20, v21
    v_exp_f32 v23, v83
    v_mfma_f32_16x16x32_bf16 v[124:127], a[212:215], a[180:183], v[124:127]
    buffer_store_dwordx4 v[240:243], v2, s[36:39], s40 offen sc1
    v_cvt_pk_bf16_f32 v137, v22, v23
    v_mfma_f32_16x16x32_bf16 v[124:127], a[216:219], a[184:187], v[124:127]
    s_add_u32 s40, s40, s100
    v_exp_f32 v24, v84
    v_mfma_f32_16x16x32_bf16 v[124:127], a[220:223], a[188:191], v[124:127]
    v_exp_f32 v25, v85
    v_exp_f32 v26, v86
    v_cvt_pk_bf16_f32 v138, v24, v25
    v_mfma_f32_16x16x32_bf16 v[116:119], a[220:223], a[172:175], v[180:183]
    buffer_store_dwordx4 v[244:247], v2, s[36:39], s40 offen sc1
    v_mfma_f32_16x16x32_bf16 v[116:119], a[216:219], a[168:171], v[116:119]
    s_add_u32 s40, s40, s100
    v_exp_f32 v27, v87
    v_exp_f32 v20, v88
    v_mfma_f32_16x16x32_bf16 v[116:119], a[212:215], a[164:167], v[116:119]
    v_cvt_pk_bf16_f32 v139, v26, v27
    v_exp_f32 v21, v89
    v_mfma_f32_16x16x32_bf16 v[116:119], a[208:211], a[160:163], v[116:119]
    buffer_store_dwordx4 v[248:251], v2, s[36:39], s40 offen sc1
    v_exp_f32 v22, v90
    v_mfma_f32_16x16x32_bf16 v[36:39], v[44:47], v[136:139], 0
    v_cvt_pk_bf16_f32 v140, v20, v21
    v_exp_f32 v23, v91
    v_mfma_f32_16x16x32_bf16 v[108:111], a[208:211], a[144:147], v[172:175]
    s_add_u32 s40, s40, s100
    v_exp_f32 v24, v92
    v_cvt_pk_bf16_f32 v141, v22, v23
    v_mfma_f32_16x16x32_bf16 v[108:111], a[212:215], a[148:151], v[108:111]
    v_exp_f32 v25, v93
    v_mfma_f32_16x16x32_bf16 v[108:111], a[216:219], a[152:155], v[108:111]
    buffer_store_dwordx4 v[252:255], v2, s[36:39], s40 offen sc1
    v_exp_f32 v26, v94
    v_cvt_pk_bf16_f32 v142, v24, v25
    v_mfma_f32_16x16x32_bf16 v[108:111], a[220:223], a[156:159], v[108:111]
    s_add_u32 s40, s40, s100
    v_exp_f32 v27, v95
    s_nop 0
    v_cvt_pk_bf16_f32 v143, v26, v27
    s_nop 1
    v_mfma_f32_16x16x32_bf16 v[40:43], v[44:47], v[140:143], 0
    s_nop 2
    v_mfma_f32_16x16x32_bf16 v[100:103], a[220:223], a[140:143], v[164:167]
    s_nop 2
    v_mfma_f32_16x16x32_bf16 v[100:103], a[216:219], a[136:139], v[100:103]
    v_max3_f32 v8, v28, v32, v36
    v_max_f32 v8, v8, v40
    v_mfma_f32_16x16x32_bf16 v[100:103], a[212:215], a[132:135], v[100:103]
    v_cmp_nge_f32 vcc, s66, v8
    v_mfma_f32_16x16x32_bf16 v[100:103], a[208:211], a[128:131], v[100:103]
    s_waitcnt vmcnt(48) lgkmcnt(0)
    s_barrier
    s_add_u32 s59, s58, s60
    s_add_u32 s58, s58, 32768
    s_cmp_ge_u32 s58, 163840
    s_cselect_b32 s58, 0, s58
    v_add_u32 v6, s58, v2
    ds_read_b128 a[192:195], v6 offset:0
    ds_read_b128 a[196:199], v6 offset:1024
    ds_read_b128 a[200:203], v6 offset:2048
    ds_read_b128 a[204:207], v6 offset:3072
    ds_read_b128 a[208:211], v6 offset:4096
    ds_read_b128 a[212:215], v6 offset:5120
    ds_read_b128 a[216:219], v6 offset:6144
    ds_read_b128 a[220:223], v6 offset:7168
    s_waitcnt lgkmcnt(0)
    s_cbranch_vccnz m_stub72
m_ret73:
.p2align 3
m_dual74:
    v_mfma_f32_16x16x32_bf16 v[64:67], a[192:195], a[128:131], v[160:163]
    s_bitcmp1_b64 s[62:63], s64
    s_cselect_b32 s66, -1.0, s65
    v_add_f32 v12, v12, v28
    v_mfma_f32_16x16x32_bf16 v[64:67], a[196:199], a[132:135], v[64:67]
    s_add_u32 s64, s64, 1
    ds_read_b128 a[224:227], v6 offset:16384
    v_add_f32 v13, v13, v32
    v_mfma_f32_16x16x32_bf16 v[64:67], a[200:203], a[136:139], v[64:67]
    v_exp_f32 v20, v96
    v_mfma_f32_16x16x32_bf16 v[64:67], a[204:207], a[140:143], v[64:67]
    v_exp_f32 v21, v97
    v_mfma_f32_16x16x32_bf16 v[72:75], a[204:207], a[156:159], v[168:171]
    s_mov_b32 m0, s59
    ds_read_b128 a[228:231], v6 offset:17408
    v_cvt_pk_bf16_f32 v144, v20, v21
    v_mfma_f32_16x16x32_bf16 v[72:75], a[200:203], a[152:155], v[72:75]
    buffer_load_dwordx4 v7, s[24:27], s56 offen offset:0 sc1 lds
    v_mfma_f32_16x16x32_bf16 v[72:75], a[196:199], a[148:151], v[72:75]
    v_exp_f32 v22, v98
    v_mfma_f32_16x16x32_bf16 v[72:75], a[192:195], a[144:147], v[72:75]
    ds_read_b128 a[232:235], v6 offset:18432
    v_add_f32 v14, v14, v36
    v_mfma_f32_16x16x32_bf16 v[80:83], a[192:195], a[160:163], v[176:179]
    v_exp_f32 v23, v99
    v_mfma_f32_16x16x32_bf16 v[80:83], a[196:199], a[164:167], v[80:83]
    v_exp_f32 v24, v100
    v_mfma_f32_16x16x32_bf16 v[80:83], a[200:203], a[168:171], v[80:83]
    ds_read_b128 a[236:239], v6 offset:19456
    v_cvt_pk_bf16_f32 v145, v22, v23
    v_mfma_f32_16x16x32_bf16 v[80:83], a[204:207], a[172:175], v[80:83]
    v_exp_f32 v25, v101
    v_mfma_f32_16x16x32_bf16 v[88:91], a[204:207], a[188:191], v[184:187]
    v_exp_f32 v26, v102
    v_mfma_f32_16x16x32_bf16 v[88:91], a[200:203], a[184:187], v[88:91]
    ds_read_b128 a[240:243], v6 offset:20480
    v_cvt_pk_bf16_f32 v146, v24, v25
    v_mfma_f32_16x16x32_bf16 v[88:91], a[196:199], a[180:183], v[88:91]
    v_exp_f32 v27, v103
    v_mfma_f32_16x16x32_bf16 v[88:91], a[192:195], a[176:179], v[88:91]
    s_waitcnt lgkmcnt(5)
    v_exp_f32 v20, v104
    v_mfma_f32_16x16x32_bf16 v[92:95], a[208:211], a[176:179], v[188:191]
    ds_read_b128 a[244:247], v6 offset:21504
    v_cvt_pk_bf16_f32 v147, v26, v27
    v_mfma_f32_16x16x32_bf16 v[92:95], a[212:215], a[180:183], v[92:95]
    v_exp_f32 v21, v105
    v_mfma_f32_16x16x32_bf16 v[28:31], v[44:47], v[144:147], 0
    v_exp_f32 v22, v106
    v_mfma_f32_16x16x32_bf16 v[92:95], a[216:219], a[184:187], v[92:95]
    buffer_load_dwordx4 v7, s[24:27], s56 offen offset:1024 sc1 lds
    v_mfma_f32_16x16x32_bf16 v[92:95], a[220:223], a[188:191], v[92:95]
    ds_read_b128 a[248:251], v6 offset:22528
    v_cvt_pk_bf16_f32 v148, v20, v21
    v_mfma_f32_16x16x32_bf16 v[84:87], a[220:223], a[172:175], v[180:183]
    v_exp_f32 v23, v107
    v_mfma_f32_16x16x32_bf16 v[84:87], a[216:219], a[168:171], v[84:87]
    v_exp_f32 v24, v108
    v_mfma_f32_16x16x32_bf16 v[84:87], a[212:215], a[164:167], v[84:87]
    ds_read_b128 a[252:255], v6 offset:23552
    v_cvt_pk_bf16_f32 v149, v22, v23
    v_mfma_f32_16x16x32_bf16 v[84:87], a[208:211], a[160:163], v[84:87]
    v_exp_f32 v25, v109
    v_mfma_f32_16x16x32_bf16 v[76:79], a[208:211], a[144:147], v[172:175]
    v_exp_f32 v26, v110
    v_mfma_f32_16x16x32_bf16 v[76:79], a[212:215], a[148:151], v[76:79]
    v_cvt_pk_bf16_f32 v150, v24, v25
    v_add_f32 v15, v15, v40
    v_mfma_f32_16x16x32_bf16 v[76:79], a[216:219], a[152:155], v[76:79]
    v_exp_f32 v27, v111
    v_mfma_f32_16x16x32_bf16 v[76:79], a[220:223], a[156:159], v[76:79]
    buffer_load_dwordx4 v7, s[24:27], s56 offen offset:2048 sc1 lds
    v_mfma_f32_16x16x32_bf16 v[68:71], a[220:223], a[140:143], v[164:167]
    v_exp_f32 v20, v112
    v_mfma_f32_16x16x32_bf16 v[68:71], a[216:219], a[136:139], v[68:71]
    v_cvt_pk_bf16_f32 v151, v26, v27
    v_mfma_f32_16x16x32_bf16 v[68:71], a[212:215], a[132:135], v[68:71]
    v_exp_f32 v21, v113
    v_mfma_f32_16x16x32_bf16 v[32:35], v[44:47], v[148:151], 0
    v_exp_f32 v22, v114
    v_mfma_f32_16x16x32_bf16 v[68:71], a[208:211], a[128:131], v[68:71]
    s_waitcnt lgkmcnt(0)
    v_cvt_pk_bf16_f32 v152, v20, v21
    v_mfma_f32_16x16x32_bf16 a[0:3], a[224:227], v[128:131], a[0:3]
    ds_read_b128 a[192:195], v6 offset:8192
    v_mfma_f32_16x16x32_bf16 a[32:35], a[224:227], v[132:135], a[32:35]
    v_exp_f32 v23, v115
    v_mfma_f32_16x16x32_bf16 a[64:67], a[224:227], v[136:139], a[64:67]
    v_exp_f32 v24, v116
    v_mfma_f32_16x16x32_bf16 a[96:99], a[224:227], v[140:143], a[96:99]
    ds_read_b128 a[196:199], v6 offset:9216
    v_cvt_pk_bf16_f32 v153, v22, v23
    v_mfma_f32_16x16x32_bf16 a[100:103], a[228:231], v[140:143], a[100:103]
    v_exp_f32 v25, v117
    v_mfma_f32_16x16x32_bf16 a[68:71], a[228:231], v[136:139], a[68:71]
    v_exp_f32 v26, v118
    v_mfma_f32_16x16x32_bf16 a[36:39], a[228:231], v[132:135], a[36:39]
    ds_read_b128 a[200:203], v6 offset:10240
    v_cvt_pk_bf16_f32 v154, v24, v25
    v_mfma_f32_16x16x32_bf16 a[4:7], a[228:231], v[128:131], a[4:7]
    v_exp_f32 v27, v119
    v_mfma_f32_16x16x32_bf16 a[8:11], a[232:235], v[128:131], a[8:11]
    v_exp_f32 v20, v120
    v_mfma_f32_16x16x32_bf16 a[40:43], a[232:235], v[132:135], a[40:43]
    ds_read_b128 a[204:207], v6 offset:11264
    v_cvt_pk_bf16_f32 v155, v26, v27
    v_mfma_f32_16x16x32_bf16 a[72:75], a[232:235], v[136:139], a[72:75]
    v_exp_f32 v21, v121
    v_mfma_f32_16x16x32_bf16 v[36:39], v[44:47], v[152:155], 0
    v_exp_f32 v22, v122
    v_mfma_f32_16x16x32_bf16 a[104:107], a[232:235], v[140:143], a[104:107]
    buffer_load_dwordx4 v7, s[24:27], s56 offen offset:3072 sc1 lds
    v_mfma_f32_16x16x32_bf16 a[108:111], a[236:239], v[140:143], a[108:111]
    s_add_u32 s56, s56, 16384
    v_cvt_pk_bf16_f32 v156, v20, v21
    v_mfma_f32_16x16x32_bf16 a[76:79], a[236:239], v[136:139], a[76:79]
    v_exp_f32 v23, v123
    v_mfma_f32_16x16x32_bf16 a[44:47], a[236:239], v[132:135], a[44:47]
    v_exp_f32 v24, v124
    v_mfma_f32_16x16x32_bf16 a[12:15], a[236:239], v[128:131], a[12:15]
    v_cvt_pk_bf16_f32 v157, v22, v23
    v_mfma_f32_16x16x32_bf16 a[16:19], a[240:243], v[128:131], a[16:19]
    v_exp_f32 v25, v125
    v_mfma_f32_16x16x32_bf16 a[48:51], a[240:243], v[132:135], a[48:51]
    v_exp_f32 v26, v126
    v_mfma_f32_16x16x32_bf16 a[80:83], a[240:243], v[136:139], a[80:83]
    v_cvt_pk_bf16_f32 v158, v24, v25
    v_mfma_f32_16x16x32_bf16 a[112:115], a[240:243], v[140:143], a[112:115]
    s_add_u32 m0, s59, 16384
    v_exp_f32 v27, v127
    v_mfma_f32_16x16x32_bf16 a[116:119], a[244:247], v[140:143], a[116:119]
    buffer_load_dwordx4 v7, s[28:31], s57 offen offset:0 sc1 lds
    v_mfma_f32_16x16x32_bf16 a[84:87], a[244:247], v[136:139], a[84:87]
    v_cvt_pk_bf16_f32 v159, v26, v27
    v_mfma_f32_16x16x32_bf16 a[52:55], a[244:247], v[132:135], a[52:55]
    v_mfma_f32_16x16x32_bf16 a[20:23], a[244:247], v[128:131], a[20:23]
    v_mfma_f32_16x16x32_bf16 v[40:43], v[44:47], v[156:159], 0
    s_nop 2
    v_mfma_f32_16x16x32_bf16 a[24:27], a[248:251], v[128:131], a[24:27]
    s_nop 2
    v_mfma_f32_16x16x32_bf16 a[56:59], a[248:251], v[132:135], a[56:59]
    v_max3_f32 v8, v28, v32, v36
    v_max_f32 v8, v8, v40
    v_mfma_f32_16x16x32_bf16 a[88:91], a[248:251], v[136:139], a[88:91]
    v_cmp_nge_f32 vcc, s66, v8
    v_mfma_f32_16x16x32_bf16 a[120:123], a[248:251], v[140:143], a[120:123]
    ds_read_b128 a[208:211], v6 offset:12288
    v_mfma_f32_16x16x32_bf16 a[124:127], a[252:255], v[140:143], a[124:127]
    ds_read_b128 a[212:215], v6 offset:13312
    v_mfma_f32_16x16x32_bf16 a[92:95], a[252:255], v[136:139], a[92:95]
    ds_read_b128 a[216:219], v6 offset:14336
    v_mfma_f32_16x16x32_bf16 a[60:63], a[252:255], v[132:135], a[60:63]
    ds_read_b128 a[220:223], v6 offset:15360
    v_mfma_f32_16x16x32_bf16 a[28:31], a[252:255], v[128:131], a[28:31]
    s_waitcnt lgkmcnt(4)
    s_cbranch_vccnz m_stub75
m_ret76:
    v_mfma_f32_16x16x32_bf16 v[96:99], a[192:195], a[128:131], v[160:163]
    s_add_u32 s59, s58, s60
    v_exp_f32 v20, v64
    v_mfma_f32_16x16x32_bf16 v[96:99], a[196:199], a[132:135], v[96:99]
    s_add_u32 s58, s58, 32768
    ds_read_b128 a[224:227], v6 offset:24576
    v_add_f32 v12, v12, v28
    v_mfma_f32_16x16x32_bf16 v[96:99], a[200:203], a[136:139], v[96:99]
    s_cmp_ge_u32 s58, 163840
    s_cselect_b32 s58, 0, s58
    v_exp_f32 v21, v65
    v_mfma_f32_16x16x32_bf16 v[96:99], a[204:207], a[140:143], v[96:99]
    s_bitcmp1_b64 s[62:63], s64
    s_cselect_b32 s66, -1.0, s65
    v_cvt_pk_bf16_f32 v128, v20, v21
    v_mfma_f32_16x16x32_bf16 v[104:107], a[204:207], a[156:159], v[168:171]
    s_add_u32 s64, s64, 1
    ds_read_b128 a[228:231], v6 offset:25600
    v_add_f32 v13, v13, v32
    v_mfma_f32_16x16x32_bf16 v[104:107], a[200:203], a[152:155], v[104:107]
    v_exp_f32 v22, v66
    v_mfma_f32_16x16x32_bf16 v[104:107], a[196:199], a[148:151], v[104:107]
    buffer_load_dwordx4 v7, s[28:31], s57 offen offset:1024 sc1 lds
    v_mfma_f32_16x16x32_bf16 v[104:107], a[192:195], a[144:147], v[104:107]
    ds_read_b128 a[232:235], v6 offset:26624
    v_add_f32 v14, v14, v36
    v_mfma_f32_16x16x32_bf16 v[112:115], a[192:195], a[160:163], v[176:179]
    v_exp_f32 v23, v67
    v_mfma_f32_16x16x32_bf16 v[112:115], a[196:199], a[164:167], v[112:115]
    v_exp_f32 v24, v68
    v_mfma_f32_16x16x32_bf16 v[112:115], a[200:203], a[168:171], v[112:115]
    ds_read_b128 a[236:239], v6 offset:27648
    v_cvt_pk_bf16_f32 v129, v22, v23
    v_mfma_f32_16x16x32_bf16 v[112:115], a[204:207], a[172:175], v[112:115]
    v_exp_f32 v25, v69
    v_mfma_f32_16x16x32_bf16 v[120:123], a[204:207], a[188:191], v[184:187]
    v_exp_f32 v26, v70
    v_mfma_f32_16x16x32_bf16 v[120:123], a[200:203], a[184:187], v[120:123]
    ds_read_b128 a[240:243], v6 offset:28672
    v_cvt_pk_bf16_f32 v130, v24, v25
    v_mfma_f32_16x16x32_bf16 v[120:123], a[196:199], a[180:183], v[120:123]
    v_exp_f32 v27, v71
    v_mfma_f32_16x16x32_bf16 v[120:123], a[192:195], a[176:179], v[120:123]
    s_waitcnt lgkmcnt(5)
    v_exp_f32 v20, v72
    v_mfma_f32_16x16x32_bf16 v[124:127], a[208:211], a[176:179], v[188:191]
    ds_read_b128 a[244:247], v6 offset:29696
    v_cvt_pk_bf16_f32 v131, v26, v27
    v_mfma_f32_16x16x32_bf16 v[124:127], a[212:215], a[180:183], v[124:127]
    v_exp_f32 v21, v73
    v_mfma_f32_16x16x32_bf16 v[28:31], v[44:47], v[128:131], 0
    v_exp_f32 v22, v74
    v_mfma_f32_16x16x32_bf16 v[124:127], a[216:219], a[184:187], v[124:127]
    buffer_load_dwordx4 v7, s[28:31], s57 offen offset:2048 sc1 lds
    v_mfma_f32_16x16x32_bf16 v[124:127], a[220:223], a[188:191], v[124:127]
    ds_read_b128 a[248:251], v6 offset:30720
    v_cvt_pk_bf16_f32 v132, v20, v21
    v_mfma_f32_16x16x32_bf16 v[116:119], a[220:223], a[172:175], v[180:183]
    v_exp_f32 v23, v75
    v_mfma_f32_16x16x32_bf16 v[116:119], a[216:219], a[168:171], v[116:119]
    v_exp_f32 v24, v76
    v_mfma_f32_16x16x32_bf16 v[116:119], a[212:215], a[164:167], v[116:119]
    ds_read_b128 a[252:255], v6 offset:31744
    v_cvt_pk_bf16_f32 v133, v22, v23
    v_mfma_f32_16x16x32_bf16 v[116:119], a[208:211], a[160:163], v[116:119]
    v_exp_f32 v25, v77
    v_mfma_f32_16x16x32_bf16 v[108:111], a[208:211], a[144:147], v[172:175]
    v_exp_f32 v26, v78
    v_mfma_f32_16x16x32_bf16 v[108:111], a[212:215], a[148:151], v[108:111]
    v_cvt_pk_bf16_f32 v134, v24, v25
    v_add_f32 v15, v15, v40
    v_mfma_f32_16x16x32_bf16 v[108:111], a[216:219], a[152:155], v[108:111]
    v_exp_f32 v27, v79
    v_mfma_f32_16x16x32_bf16 v[108:111], a[220:223], a[156:159], v[108:111]
    buffer_load_dwordx4 v7, s[28:31], s57 offen offset:3072 sc1 lds
    v_mfma_f32_16x16x32_bf16 v[100:103], a[220:223], a[140:143], v[164:167]
    s_add_u32 s57, s57, 16384
    v_exp_f32 v20, v80
    v_mfma_f32_16x16x32_bf16 v[100:103], a[216:219], a[136:139], v[100:103]
    v_cvt_pk_bf16_f32 v135, v26, v27
    v_mfma_f32_16x16x32_bf16 v[100:103], a[212:215], a[132:135], v[100:103]
    v_exp_f32 v21, v81
    v_mfma_f32_16x16x32_bf16 v[32:35], v[44:47], v[132:135], 0
    v_exp_f32 v22, v82
    v_mfma_f32_16x16x32_bf16 v[100:103], a[208:211], a[128:131], v[100:103]
    s_waitcnt vmcnt(24) lgkmcnt(0)
    v_add_u32 v6, s58, v2
    v_cvt_pk_bf16_f32 v136, v20, v21
    v_mfma_f32_16x16x32_bf16 a[0:3], a[224:227], v[144:147], a[0:3]
    s_barrier
    v_mfma_f32_16x16x32_bf16 a[32:35], a[224:227], v[148:151], a[32:35]
    ds_read_b128 a[192:195], v6 offset:0
    v_mfma_f32_16x16x32_bf16 a[64:67], a[224:227], v[152:155], a[64:67]
    v_exp_f32 v23, v83
    v_mfma_f32_16x16x32_bf16 a[96:99], a[224:227], v[156:159], a[96:99]
    v_exp_f32 v24, v84
    v_mfma_f32_16x16x32_bf16 a[100:103], a[228:231], v[156:159], a[100:103]
    ds_read_b128 a[196:199], v6 offset:1024
    v_cvt_pk_bf16_f32 v137, v22, v23
    v_mfma_f32_16x16x32_bf16 a[68:71], a[228:231], v[152:155], a[68:71]
    v_exp_f32 v25, v85
    v_mfma_f32_16x16x32_bf16 a[36:39], a[228:231], v[148:151], a[36:39]
    v_exp_f32 v26, v86
    v_mfma_f32_16x16x32_bf16 a[4:7], a[228:231], v[144:147], a[4:7]
    ds_read_b128 a[200:203], v6 offset:2048
    v_cvt_pk_bf16_f32 v138, v24, v25
    v_mfma_f32_16x16x32_bf16 a[8:11], a[232:235], v[144:147], a[8:11]
    v_exp_f32 v27, v87
    v_mfma_f32_16x16x32_bf16 a[40:43], a[232:235], v[148:151], a[40:43]
    v_exp_f32 v20, v88
    v_mfma_f32_16x16x32_bf16 a[72:75], a[232:235], v[152:155], a[72:75]
    ds_read_b128 a[204:207], v6 offset:3072
    v_cvt_pk_bf16_f32 v139, v26, v27
    v_mfma_f32_16x16x32_bf16 a[104:107], a[232:235], v[156:159], a[104:107]
    v_exp_f32 v21, v89
    v_mfma_f32_16x16x32_bf16 v[36:39], v[44:47], v[136:139], 0
    v_exp_f32 v22, v90
    v_mfma_f32_16x16x32_bf16 a[108:111], a[236:239], v[156:159], a[108:111]
    v_cvt_pk_bf16_f32 v140, v20, v21
    v_mfma_f32_16x16x32_bf16 a[76:79], a[236:239], v[152:155], a[76:79]
    v_exp_f32 v23, v91
    v_mfma_f32_16x16x32_bf16 a[44:47], a[236:239], v[148:151], a[44:47]
    v_exp_f32 v24, v92
    v_mfma_f32_16x16x32_bf16 a[12:15], a[236:239], v[144:147], a[12:15]
    v_cvt_pk_bf16_f32 v141, v22, v23
    v_mfma_f32_16x16x32_bf16 a[16:19], a[240:243], v[144:147], a[16:19]
    v_exp_f32 v25, v93
    v_mfma_f32_16x16x32_bf16 a[48:51], a[240:243], v[148:151], a[48:51]
    v_exp_f32 v26, v94
    v_mfma_f32_16x16x32_bf16 a[80:83], a[240:243], v[152:155], a[80:83]
    v_cvt_pk_bf16_f32 v142, v24, v25
    v_mfma_f32_16x16x32_bf16 a[112:115], a[240:243], v[156:159], a[112:115]
    v_exp_f32 v27, v95
    v_mfma_f32_16x16x32_bf16 a[116:119], a[244:247], v[156:159], a[116:119]
    v_cvt_pk_bf16_f32 v143, v26, v27
    v_mfma_f32_16x16x32_bf16 a[84:87], a[244:247], v[152:155], a[84:87]
    v_mfma_f32_16x16x32_bf16 a[52:55], a[244:247], v[148:151], a[52:55]
    v_mfma_f32_16x16x32_bf16 v[40:43], v[44:47], v[140:143], 0
    s_nop 2
    v_mfma_f32_16x16x32_bf16 a[20:23], a[244:247], v[144:147], a[20:23]
    s_nop 2
    v_mfma_f32_16x16x32_bf16 a[24:27], a[248:251], v[144:147], a[24:27]
    v_max3_f32 v8, v28, v32, v36
    v_max_f32 v8, v8, v40
    v_mfma_f32_16x16x32_bf16 a[56:59], a[248:251], v[148:151], a[56:59]
    v_cmp_nge_f32 vcc, s66, v8
    v_mfma_f32_16x16x32_bf16 a[88:91], a[248:251], v[152:155], a[88:91]
    v_mfma_f32_16x16x32_bf16 a[120:123], a[248:251], v[156:159], a[120:123]
    ds_read_b128 a[208:211], v6 offset:4096
    v_mfma_f32_16x16x32_bf16 a[124:127], a[252:255], v[156:159], a[124:127]
    ds_read_b128 a[212:215], v6 offset:5120
    v_mfma_f32_16x16x32_bf16 a[92:95], a[252:255], v[152:155], a[92:95]
    ds_read_b128 a[216:219], v6 offset:6144
    v_mfma_f32_16x16x32_bf16 a[60:63], a[252:255], v[148:151], a[60:63]
    ds_read_b128 a[220:223], v6 offset:7168
    v_mfma_f32_16x16x32_bf16 a[28:31], a[252:255], v[144:147], a[28:31]
    s_waitcnt lgkmcnt(4)
    s_cbranch_vccz m_dual74
    v_cmp_lt_f32 vcc, s65, v8
    s_cmp_lg_u32 s64, s67
    s_cbranch_scc1 m_e78
    v_add_f32 v176, v176, v16
    v_mov_b32 v180, v9
    v_add_f32 v188, v188, v16
    v_add_f32 v177, v177, v17
    v_mov_b32 v181, v9
    v_add_f32 v189, v189, v17
    v_add_f32 v178, v178, v18
    v_mov_b32 v182, v9
    v_add_f32 v190, v190, v18
    v_add_f32 v179, v179, v19
    v_mov_b32 v183, v9
    v_add_f32 v191, v191, v19
    s_nop 0
m_e78:
    s_cmp_lg_u32 s64, s68
    s_cbranch_scc1 m_e79
    v_mov_b32 v176, v9
    v_mov_b32 v184, v9
    v_mov_b32 v188, v9
    v_mov_b32 v177, v9
    v_mov_b32 v185, v9
    v_mov_b32 v189, v9
    v_mov_b32 v178, v9
    v_mov_b32 v186, v9
    v_mov_b32 v190, v9
    v_mov_b32 v179, v9
    v_mov_b32 v187, v9
    v_mov_b32 v191, v9
    s_nop 0
m_e79:
    s_cmp_lg_u32 s64, s70
    s_cbranch_scc1 m_e80
    v_add_f32 v160, v160, v16
    v_mov_b32 v164, v9
    v_add_f32 v172, v172, v16
    v_add_f32 v161, v161, v17
    v_mov_b32 v165, v9
    v_add_f32 v173, v173, v17
    v_add_f32 v162, v162, v18
    v_mov_b32 v166, v9
    v_add_f32 v174, v174, v18
    v_add_f32 v163, v163, v19
    v_mov_b32 v167, v9
    v_add_f32 v175, v175, v19
    s_nop 0
m_e80:
    s_cmp_lg_u32 s64, s53
    s_cbranch_scc1 m_e83
    s_cmp_lg_u32 s16, 0
    s_cbranch_scc1 m_np84
    v_mov_b32 v60, s4
    v_mov_b32 v61, s5
    s_add_u32 s90, s101, 117440512
    s_mov_b64 exec, 1
    buffer_store_dwordx2 v[60:61], off, s[8:11], s90 sc1
    s_mov_b64 exec, -1
m_np84:
    s_mov_b32 s101, -1
m_e83:
    s_cmp_gt_u32 s64, 24
    s_cbranch_scc1 m_e81
    s_cmp_lg_u32 s64, 8
    s_cbranch_scc1 m_e85
    s_lshr_b32 s90, s32, 1
    s_lshl_b32 s90, s90, 7
    s_add_u32 s90, s90, 117440600
    v_min_u32 v0, 1, v1
    v_lshlrev_b32 v0, 5, v0
    buffer_load_dwordx2 v[4:5], v0, s[8:11], s90 offen sc1
    s_cmp_eq_u32 s17, -1
    s_cbranch_scc1 m_e81
    s_cmp_lg_u32 s16, 0
    s_cbranch_scc1 m_np86
    v_mov_b32 v60, s4
    v_mov_b32 v61, s5
    s_add_u32 s90, s17, 117440512
    s_mov_b64 exec, 1
    buffer_store_dwordx2 v[60:61], off, s[8:11], s90 sc1
    s_mov_b64 exec, -1
m_np86:
    s_branch m_e81
m_e85:
    s_cmp_lg_u32 s64, 16
    s_cbranch_scc1 m_e87
    s_waitcnt vmcnt(18)
    s_mov_b32 s3, 1048576
m_spin88:
    v_cmp_ne_u64 s[76:77], s[4:5], v[4:5]
    s_nop 3
    s_cmp_eq_u64 s[76:77], 0
    s_cbranch_scc1 m_e81
    s_sub_u32 s3, s3, 1
    s_cbranch_scc1 m_e81
    s_sleep 32
    s_lshr_b32 s90, s32, 1
    s_lshl_b32 s90, s90, 7
    s_add_u32 s90, s90, 117440600
    v_min_u32 v0, 1, v1
    v_lshlrev_b32 v0, 5, v0
    buffer_load_dwordx2 v[4:5], v0, s[8:11], s90 offen sc1
    s_waitcnt vmcnt(0)
    s_branch m_spin88
    s_branch m_e81
m_e87:
    s_cmp_lg_u32 s64, 20
    s_cbranch_scc1 m_e89
    buffer_load_dwordx2 v[4:5], v10, s[8:11], 0 offen sc1
    s_mov_b32 s44, s48
    s_mov_b32 s45, s49
    s_mov_b32 s46, 8388608
    s_lshl_b32 s90, s2, 2
    s_add_u32 s90, s90, s16
    s_lshl_b32 s90, s90, 13
    v_lshlrev_b32 v62, 7, v1
    buffer_load_dword v255, v62, s[44:47], s90 offen
    s_branch m_e81
m_e89:
    s_cmp_lg_u32 s64, 24
    s_cbranch_scc1 m_e90
    s_mov_b32 s44, s50
    s_mov_b32 s45, s51
    s_mov_b32 s46, 2097152
    s_lshl_b32 s90, s2, 2
    s_add_u32 s90, s90, s16
    s_lshl_b32 s90, s90, 13
    v_lshlrev_b32 v62, 7, v1
    buffer_load_dword v255, v62, s[44:47], s90 offen
    s_waitcnt vmcnt(18)
    s_mov_b32 s3, 1048576
m_spin91:
    v_cmp_ne_u64 s[76:77], s[4:5], v[4:5]
    s_nop 3
    s_cmp_eq_u64 s[76:77], 0
    s_cbranch_scc1 m_e81
    s_sub_u32 s3, s3, 1
    s_cbranch_scc1 m_e81
    s_sleep 32
    buffer_load_dwordx2 v[4:5], v10, s[8:11], 0 offen sc1
    s_waitcnt vmcnt(0)
    s_branch m_spin91
    s_branch m_e81
m_e90:
m_e81:
    s_cbranch_vccnz m_rc92
m_sp77:
    s_cmp_lg_u32 s64, s69
    s_cbranch_scc1 m_dual74
    v_mfma_f32_16x16x32_bf16 v[64:67], a[192:195], a[128:131], v[160:163]
    s_bitcmp1_b64 s[62:63], s64
    s_cselect_b32 s66, -1.0, s65
    v_add_f32 v12, v12, v28
    v_mfma_f32_16x16x32_bf16 v[64:67], a[196:199], a[132:135], v[64:67]
    s_add_u32 s64, s64, 1
    ds_read_b128 a[224:227], v6 offset:16384
    v_exp_f32 v20, v96
    v_mfma_f32_16x16x32_bf16 v[64:67], a[200:203], a[136:139], v[64:67]
    s_mov_b32 m0, s59
    ds_read_b128 a[228:231], v6 offset:17408
    v_add_f32 v13, v13, v32
    v_mfma_f32_16x16x32_bf16 v[64:67], a[204:207], a[140:143], v[64:67]
    buffer_load_dwordx4 v7, s[24:27], s56 offen offset:0 sc1 lds
    v_mfma_f32_16x16x32_bf16 v[72:75], a[204:207], a[156:159], v[168:171]
    ds_read_b128 a[232:235], v6 offset:18432
    v_add_f32 v14, v14, v36
    v_mfma_f32_16x16x32_bf16 v[72:75], a[200:203], a[152:155], v[72:75]
    ds_read_b128 a[236:239], v6 offset:19456
    v_exp_f32 v21, v97
    v_mfma_f32_16x16x32_bf16 v[72:75], a[196:199], a[148:151], v[72:75]
    ds_read_b128 a[240:243], v6 offset:20480
    v_cvt_pk_bf16_f32 v144, v20, v21
    v_mfma_f32_16x16x32_bf16 v[72:75], a[192:195], a[144:147], v[72:75]
    s_waitcnt lgkmcnt(5)
    ds_read_b128 a[244:247], v6 offset:21504
    v_add_f32 v15, v15, v40
    v_mfma_f32_16x16x32_bf16 v[76:79], a[208:211], a[144:147], v[172:175]
    ds_read_b128 a[248:251], v6 offset:22528
    v_exp_f32 v22, v98
    v_mfma_f32_16x16x32_bf16 v[76:79], a[212:215], a[148:151], v[76:79]
    ds_read_b128 a[252:255], v6 offset:23552
    v_exp_f32 v23, v99
    v_mfma_f32_16x16x32_bf16 v[76:79], a[216:219], a[152:155], v[76:79]
    v_exp_f32 v24, v100
    v_mfma_f32_16x16x32_bf16 v[76:79], a[220:223], a[156:159], v[76:79]
    buffer_load_dwordx4 v7, s[24:27], s56 offen offset:1024 sc1 lds
    v_mfma_f32_16x16x32_bf16 v[68:71], a[220:223], a[140:143], v[164:167]
    v_cvt_pk_bf16_f32 v145, v22, v23
    v_exp_f32 v25, v101
    v_mfma_f32_16x16x32_bf16 v[68:71], a[216:219], a[136:139], v[68:71]
    v_exp_f32 v26, v102
    v_mfma_f32_16x16x32_bf16 v[68:71], a[212:215], a[132:135], v[68:71]
    v_cvt_pk_bf16_f32 v146, v24, v25
    v_exp_f32 v27, v103
    v_mfma_f32_16x16x32_bf16 v[68:71], a[208:211], a[128:131], v[68:71]
    s_waitcnt lgkmcnt(0)
    v_exp_f32 v20, v104
    v_mfma_f32_16x16x32_bf16 a[0:3], a[224:227], v[128:131], a[0:3]
    ds_read_b128 a[192:195], v6 offset:8192
    v_cvt_pk_bf16_f32 v147, v26, v27
    v_mfma_f32_16x16x32_bf16 a[32:35], a[224:227], v[132:135], a[32:35]
    v_exp_f32 v21, v105
    v_mfma_f32_16x16x32_bf16 v[28:31], v[44:47], v[144:147], 0
    v_exp_f32 v22, v106
    v_mfma_f32_16x16x32_bf16 a[64:67], a[224:227], v[136:139], a[64:67]
    v_cvt_pk_bf16_f32 v148, v20, v21
    v_exp_f32 v23, v107
    v_mfma_f32_16x16x32_bf16 a[96:99], a[224:227], v[140:143], a[96:99]
    ds_read_b128 a[196:199], v6 offset:9216
    v_cvt_pk_bf16_f32 v149, v22, v23
    v_mfma_f32_16x16x32_bf16 a[100:103], a[228:231], v[140:143], a[100:103]
    v_exp_f32 v24, v108
    v_mfma_f32_16x16x32_bf16 a[68:71], a[228:231], v[136:139], a[68:71]
    buffer_load_dwordx4 v7, s[24:27], s56 offen offset:2048 sc1 lds
    v_mfma_f32_16x16x32_bf16 a[36:39], a[228:231], v[132:135], a[36:39]
    ds_read_b128 a[200:203], v6 offset:10240
    v_exp_f32 v25, v109
    v_mfma_f32_16x16x32_bf16 a[4:7], a[228:231], v[128:131], a[4:7]
    v_exp_f32 v26, v110
    v_mfma_f32_16x16x32_bf16 a[8:11], a[232:235], v[128:131], a[8:11]
    v_cvt_pk_bf16_f32 v150, v24, v25
    v_exp_f32 v27, v111
    v_mfma_f32_16x16x32_bf16 a[40:43], a[232:235], v[132:135], a[40:43]
    ds_read_b128 a[204:207], v6 offset:11264
    v_cvt_pk_bf16_f32 v151, v26, v27
    v_mfma_f32_16x16x32_bf16 a[72:75], a[232:235], v[136:139], a[72:75]
    v_exp_f32 v20, v112
    v_mfma_f32_16x16x32_bf16 v[32:35], v[44:47], v[148:151], 0
    v_exp_f32 v21, v113
    v_mfma_f32_16x16x32_bf16 a[104:107], a[232:235], v[140:143], a[104:107]
    v_exp_f32 v22, v114
    v_mfma_f32_16x16x32_bf16 a[108:111], a[236:239], v[140:143], a[108:111]
    v_cvt_pk_bf16_f32 v152, v20, v21
    v_exp_f32 v23, v115
    v_mfma_f32_16x16x32_bf16 a[76:79], a[236:239], v[136:139], a[76:79]
    v_exp_f32 v24, v116
    v_mfma_f32_16x16x32_bf16 a[44:47], a[236:239], v[132:135], a[44:47]
    v_cvt_pk_bf16_f32 v153, v22, v23
    v_exp_f32 v25, v117
    v_mfma_f32_16x16x32_bf16 a[12:15], a[236:239], v[128:131], a[12:15]
    buffer_load_dwordx4 v7, s[24:27], s56 offen offset:3072 sc1 lds
    v_mfma_f32_16x16x32_bf16 a[16:19], a[240:243], v[128:131], a[16:19]
    s_add_u32 s56, s56, 16384
    v_exp_f32 v26, v118
    v_mfma_f32_16x16x32_bf16 a[48:51], a[240:243], v[132:135], a[48:51]
    v_cvt_pk_bf16_f32 v154, v24, v25
    v_exp_f32 v27, v119
    v_mfma_f32_16x16x32_bf16 a[80:83], a[240:243], v[136:139], a[80:83]
    v_exp_f32 v20, v120
    v_mfma_f32_16x16x32_bf16 a[112:115], a[240:243], v[140:143], a[112:115]
    v_cvt_pk_bf16_f32 v155, v26, v27
    v_exp_f32 v21, v121
    v_mfma_f32_16x16x32_bf16 a[116:119], a[244:247], v[140:143], a[116:119]
    v_exp_f32 v22, v122
    v_mfma_f32_16x16x32_bf16 v[36:39], v[44:47], v[152:155], 0
    v_cvt_pk_bf16_f32 v156, v20, v21
    v_mfma_f32_16x16x32_bf16 a[84:87], a[244:247], v[136:139], a[84:87]
    v_exp_f32 v23, v123
    v_mfma_f32_16x16x32_bf16 a[52:55], a[244:247], v[132:135], a[52:55]
    v_exp_f32 v24, v124
    v_cvt_pk_bf16_f32 v157, v22, v23
    v_mfma_f32_16x16x32_bf16 a[20:23], a[244:247], v[128:131], a[20:23]
    v_exp_f32 v25, v125
    v_mfma_f32_16x16x32_bf16 a[24:27], a[248:251], v[128:131], a[24:27]
    s_add_u32 m0, s59, 16384
    v_exp_f32 v26, v126
    v_mfma_f32_16x16x32_bf16 a[56:59], a[248:251], v[132:135], a[56:59]
    buffer_load_dwordx4 v7, s[28:31], s57 offen offset:0 sc1 lds
    v_mfma_f32_16x16x32_bf16 a[88:91], a[248:251], v[136:139], a[88:91]
    v_cvt_pk_bf16_f32 v158, v24, v25
    v_exp_f32 v27, v127
    v_mfma_f32_16x16x32_bf16 a[120:123], a[248:251], v[140:143], a[120:123]
    ds_read_b128 a[208:211], v6 offset:12288
    v_cvt_pk_bf16_f32 v159, v26, v27
    s_nop 1
    v_mfma_f32_16x16x32_bf16 v[40:43], v[44:47], v[156:159], 0
    s_nop 2
    v_mfma_f32_16x16x32_bf16 a[124:127], a[252:255], v[140:143], a[124:127]
    ds_read_b128 a[212:215], v6 offset:13312
    s_nop 0
    v_mfma_f32_16x16x32_bf16 a[92:95], a[252:255], v[136:139], a[92:95]
    ds_read_b128 a[216:219], v6 offset:14336
    v_max3_f32 v8, v28, v32, v36
    v_mfma_f32_16x16x32_bf16 a[60:63], a[252:255], v[132:135], a[60:63]
    ds_read_b128 a[220:223], v6 offset:15360
    v_max_f32 v8, v8, v40
    v_cmp_nge_f32 vcc, s66, v8
    v_mfma_f32_16x16x32_bf16 a[28:31], a[252:255], v[128:131], a[28:31]
    s_waitcnt lgkmcnt(4)
    s_cbranch_vccnz m_stub93
m_ret94:
    v_mfma_f32_16x16x32_bf16 v[96:99], a[192:195], a[128:131], v[160:163]
    s_add_u32 s59, s58, s60
    v_exp_f32 v20, v64
    v_mfma_f32_16x16x32_bf16 v[96:99], a[196:199], a[132:135], v[96:99]
    s_add_u32 s58, s58, 32768
    ds_read_b128 a[224:227], v6 offset:24576
    v_add_f32 v12, v12, v28
    v_mfma_f32_16x16x32_bf16 v[96:99], a[200:203], a[136:139], v[96:99]
    s_cmp_ge_u32 s58, 163840
    s_cselect_b32 s58, 0, s58
    ds_read_b128 a[228:231], v6 offset:25600
    v_add_f32 v13, v13, v32
    v_mfma_f32_16x16x32_bf16 v[96:99], a[204:207], a[140:143], v[96:99]
    buffer_load_dwordx4 v7, s[28:31], s57 offen offset:1024 sc1 lds
    v_mfma_f32_16x16x32_bf16 v[104:107], a[204:207], a[156:159], v[168:171]
    s_bitcmp1_b64 s[62:63], s64
    s_cselect_b32 s66, -1.0, s65
    ds_read_b128 a[232:235], v6 offset:26624
    v_mfma_f32_16x16x32_bf16 v[104:107], a[200:203], a[152:155], v[104:107]
    s_add_u32 s64, s64, 1
    ds_read_b128 a[236:239], v6 offset:27648
    v_mfma_f32_16x16x32_bf16 v[104:107], a[196:199], a[148:151], v[104:107]
    ds_read_b128 a[240:243], v6 offset:28672
    v_mfma_f32_16x16x32_bf16 v[104:107], a[192:195], a[144:147], v[104:107]
    s_waitcnt lgkmcnt(5)
    ds_read_b128 a[244:247], v6 offset:29696
    v_mfma_f32_16x16x32_bf16 v[108:111], a[208:211], a[144:147], v[172:175]
    buffer_load_dwordx4 v7, s[28:31], s57 offen offset:2048 sc1 lds
    v_mfma_f32_16x16x32_bf16 v[108:111], a[212:215], a[148:151], v[108:111]
    ds_read_b128 a[248:251], v6 offset:30720
    v_mfma_f32_16x16x32_bf16 v[108:111], a[216:219], a[152:155], v[108:111]
    ds_read_b128 a[252:255], v6 offset:31744
    v_mfma_f32_16x16x32_bf16 v[108:111], a[220:223], a[156:159], v[108:111]
    v_exp_f32 v21, v65
    v_mfma_f32_16x16x32_bf16 v[100:103], a[220:223], a[140:143], v[164:167]
    v_exp_f32 v22, v66
    v_mfma_f32_16x16x32_bf16 v[100:103], a[216:219], a[136:139], v[100:103]
    buffer_load_dwordx4 v7, s[28:31], s57 offen offset:3072 sc1 lds
    v_mfma_f32_16x16x32_bf16 v[100:103], a[212:215], a[132:135], v[100:103]
    s_add_u32 s57, s57, 16384
    v_cvt_pk_bf16_f32 v128, v20, v21
    v_mfma_f32_16x16x32_bf16 v[100:103], a[208:211], a[128:131], v[100:103]
    s_waitcnt vmcnt(24) lgkmcnt(0)
    v_add_u32 v6, s58, v2
    v_mfma_f32_16x16x32_bf16 a[0:3], a[224:227], v[144:147], a[0:3]
    s_barrier
    v_mfma_f32_16x16x32_bf16 a[32:35], a[224:227], v[148:151], a[32:35]
    ds_read_b128 a[192:195], v6 offset:0
    v_mfma_f32_16x16x32_bf16 a[64:67], a[224:227], v[152:155], a[64:67]
    v_exp_f32 v23, v67
    v_mfma_f32_16x16x32_bf16 a[96:99], a[224:227], v[156:159], a[96:99]
    v_exp_f32 v24, v68
    v_mfma_f32_16x16x32_bf16 a[100:103], a[228:231], v[156:159], a[100:103]
    ds_read_b128 a[196:199], v6 offset:1024
    v_cvt_pk_bf16_f32 v129, v22, v23
    v_mfma_f32_16x16x32_bf16 a[68:71], a[228:231], v[152:155], a[68:71]
    v_exp_f32 v25, v69
    v_mfma_f32_16x16x32_bf16 a[36:39], a[228:231], v[148:151], a[36:39]
    v_exp_f32 v26, v70
    v_mfma_f32_16x16x32_bf16 a[4:7], a[228:231], v[144:147], a[4:7]
    ds_read_b128 a[200:203], v6 offset:2048
    v_cvt_pk_bf16_f32 v130, v24, v25
    v_mfma_f32_16x16x32_bf16 a[8:11], a[232:235], v[144:147], a[8:11]
    v_exp_f32 v27, v71
    v_mfma_f32_16x16x32_bf16 a[40:43], a[232:235], v[148:151], a[40:43]
    v_exp_f32 v20, v72
    v_mfma_f32_16x16x32_bf16 a[72:75], a[232:235], v[152:155], a[72:75]
    ds_read_b128 a[204:207], v6 offset:3072
    v_cvt_pk_bf16_f32 v131, v26, v27
    v_mfma_f32_16x16x32_bf16 a[104:107], a[232:235], v[156:159], a[104:107]
    v_exp_f32 v21, v73
    v_mfma_f32_16x16x32_bf16 v[28:31], v[44:47], v[128:131], 0
    v_exp_f32 v22, v74
    v_mfma_f32_16x16x32_bf16 a[108:111], a[236:239], v[156:159], a[108:111]
    v_cvt_pk_bf16_f32 v132, v20, v21
    v_mfma_f32_16x16x32_bf16 a[76:79], a[236:239], v[152:155], a[76:79]
    v_exp_f32 v23, v75
    v_mfma_f32_16x16x32_bf16 a[44:47], a[236:239], v[148:151], a[44:47]
    v_exp_f32 v24, v76
    v_mfma_f32_16x16x32_bf16 a[12:15], a[236:239], v[144:147], a[12:15]
    v_cvt_pk_bf16_f32 v133, v22, v23
    v_mfma_f32_16x16x32_bf16 a[16:19], a[240:243], v[144:147], a[16:19]
    v_exp_f32 v25, v77
    v_mfma_f32_16x16x32_bf16 a[48:51], a[240:243], v[148:151], a[48:51]
    v_exp_f32 v26, v78
    v_mfma_f32_16x16x32_bf16 a[80:83], a[240:243], v[152:155], a[80:83]
    v_cvt_pk_bf16_f32 v134, v24, v25
    v_mfma_f32_16x16x32_bf16 a[112:115], a[240:243], v[156:159], a[112:115]
    v_exp_f32 v27, v79
    v_mfma_f32_16x16x32_bf16 a[116:119], a[244:247], v[156:159], a[116:119]
    v_cvt_pk_bf16_f32 v135, v26, v27
    v_mfma_f32_16x16x32_bf16 a[84:87], a[244:247], v[152:155], a[84:87]
    v_mfma_f32_16x16x32_bf16 a[52:55], a[244:247], v[148:151], a[52:55]
    v_mfma_f32_16x16x32_bf16 v[32:35], v[44:47], v[132:135], 0
    s_nop 2
    v_mfma_f32_16x16x32_bf16 a[20:23], a[244:247], v[144:147], a[20:23]
    s_nop 2
    v_mfma_f32_16x16x32_bf16 a[24:27], a[248:251], v[144:147], a[24:27]
    v_max_f32 v8, v28, v32
    v_cmp_nge_f32 vcc, s66, v8
    v_mfma_f32_16x16x32_bf16 a[56:59], a[248:251], v[148:151], a[56:59]
    v_mfma_f32_16x16x32_bf16 a[88:91], a[248:251], v[152:155], a[88:91]
    v_mfma_f32_16x16x32_bf16 a[120:123], a[248:251], v[156:159], a[120:123]
    ds_read_b128 a[208:211], v6 offset:4096
    v_mfma_f32_16x16x32_bf16 a[124:127], a[252:255], v[156:159], a[124:127]
    ds_read_b128 a[212:215], v6 offset:5120
    v_mfma_f32_16x16x32_bf16 a[92:95], a[252:255], v[152:155], a[92:95]
    ds_read_b128 a[216:219], v6 offset:6144
    v_mfma_f32_16x16x32_bf16 a[60:63], a[252:255], v[148:151], a[60:63]
    ds_read_b128 a[220:223], v6 offset:7168
    v_mfma_f32_16x16x32_bf16 a[28:31], a[252:255], v[144:147], a[28:31]
    s_waitcnt lgkmcnt(4)
    s_cbranch_vccnz m_stub95
m_ret96:
    v_add_f32 v20, v14, v36
    v_add_f32 v21, v15, v40
    s_nop 3
    v_rcp_f32 v20, v20
    v_rcp_f32 v21, v21
    s_lshl_b32 s90, s79, 10
    s_add_u32 s90, s90, s82
    s_add_u32 s90, s90, 67108864
    v_accvgpr_read_b32 v48, a64
    v_accvgpr_read_b32 v49, a65
    v_accvgpr_read_b32 v50, a66
    v_accvgpr_read_b32 v51, a67
    v_accvgpr_read_b32 v52, a68
    v_accvgpr_read_b32 v53, a69
    v_accvgpr_read_b32 v54, a70
    v_accvgpr_read_b32 v55, a71
    v_mul_f32 v48, v20, v48
    v_mul_f32 v49, v20, v49
    v_mul_f32 v50, v20, v50
    v_mul_f32 v51, v20, v51
    v_mul_f32 v52, v20, v52
    v_mul_f32 v53, v20, v53
    v_mul_f32 v54, v20, v54
    v_mul_f32 v55, v20, v55
    v_cvt_pk_bf16_f32 v48, v48, v49
    v_cvt_pk_bf16_f32 v49, v50, v51
    v_cvt_pk_bf16_f32 v50, v52, v53
    v_cvt_pk_bf16_f32 v51, v54, v55
    buffer_store_dwordx4 v[48:51], v2, s[8:11], s90 offen offset:0 sc1
    v_accvgpr_read_b32 v56, a96
    v_accvgpr_read_b32 v57, a97
    v_accvgpr_read_b32 v58, a98
    v_accvgpr_read_b32 v59, a99
    v_accvgpr_read_b32 v60, a100
    v_accvgpr_read_b32 v61, a101
    v_accvgpr_read_b32 v62, a102
    v_accvgpr_read_b32 v63, a103
    v_mul_f32 v56, v21, v56
    v_mul_f32 v57, v21, v57
    v_mul_f32 v58, v21, v58
    v_mul_f32 v59, v21, v59
    v_mul_f32 v60, v21, v60
    v_mul_f32 v61, v21, v61
    v_mul_f32 v62, v21, v62
    v_mul_f32 v63, v21, v63
    v_cvt_pk_bf16_f32 v56, v56, v57
    v_cvt_pk_bf16_f32 v57, v58, v59
    v_cvt_pk_bf16_f32 v58, v60, v61
    v_cvt_pk_bf16_f32 v59, v62, v63
    buffer_store_dwordx4 v[56:59], v2, s[8:11], s90 offen offset:1024 sc1
    s_add_u32 s90, s90, 131072
    v_accvgpr_read_b32 v48, a72
    v_accvgpr_read_b32 v49, a73
    v_accvgpr_read_b32 v50, a74
    v_accvgpr_read_b32 v51, a75
    v_accvgpr_read_b32 v52, a76
    v_accvgpr_read_b32 v53, a77
    v_accvgpr_read_b32 v54, a78
    v_accvgpr_read_b32 v55, a79
    v_mul_f32 v48, v20, v48
    v_mul_f32 v49, v20, v49
    v_mul_f32 v50, v20, v50
    v_mul_f32 v51, v20, v51
    v_mul_f32 v52, v20, v52
    v_mul_f32 v53, v20, v53
    v_mul_f32 v54, v20, v54
    v_mul_f32 v55, v20, v55
    v_cvt_pk_bf16_f32 v48, v48, v49
    v_cvt_pk_bf16_f32 v49, v50, v51
    v_cvt_pk_bf16_f32 v50, v52, v53
    v_cvt_pk_bf16_f32 v51, v54, v55
    buffer_store_dwordx4 v[48:51], v2, s[8:11], s90 offen offset:0 sc1
    v_accvgpr_read_b32 v56, a104
    v_accvgpr_read_b32 v57, a105
    v_accvgpr_read_b32 v58, a106
    v_accvgpr_read_b32 v59, a107
    v_accvgpr_read_b32 v60, a108
    v_accvgpr_read_b32 v61, a109
    v_accvgpr_read_b32 v62, a110
    v_accvgpr_read_b32 v63, a111
    v_mul_f32 v56, v21, v56
    v_mul_f32 v57, v21, v57
    v_mul_f32 v58, v21, v58
    v_mul_f32 v59, v21, v59
    v_mul_f32 v60, v21, v60
    v_mul_f32 v61, v21, v61
    v_mul_f32 v62, v21, v62
    v_mul_f32 v63, v21, v63
    v_cvt_pk_bf16_f32 v56, v56, v57
    v_cvt_pk_bf16_f32 v57, v58, v59
    v_cvt_pk_bf16_f32 v58, v60, v61
    v_cvt_pk_bf16_f32 v59, v62, v63
    buffer_store_dwordx4 v[56:59], v2, s[8:11], s90 offen offset:1024 sc1
    s_add_u32 s90, s90, 131072
    v_accvgpr_read_b32 v48, a80
    v_accvgpr_read_b32 v49, a81
    v_accvgpr_read_b32 v50, a82
    v_accvgpr_read_b32 v51, a83
    v_accvgpr_read_b32 v52, a84
    v_accvgpr_read_b32 v53, a85
    v_accvgpr_read_b32 v54, a86
    v_accvgpr_read_b32 v55, a87
    v_mul_f32 v48, v20, v48
    v_mul_f32 v49, v20, v49
    v_mul_f32 v50, v20, v50
    v_mul_f32 v51, v20, v51
    v_mul_f32 v52, v20, v52
    v_mul_f32 v53, v20, v53
    v_mul_f32 v54, v20, v54
    v_mul_f32 v55, v20, v55
    v_cvt_pk_bf16_f32 v48, v48, v49
    v_cvt_pk_bf16_f32 v49, v50, v51
    v_cvt_pk_bf16_f32 v50, v52, v53
    v_cvt_pk_bf16_f32 v51, v54, v55
    buffer_store_dwordx4 v[48:51], v2, s[8:11], s90 offen offset:0 sc1
    v_accvgpr_read_b32 v56, a112
    v_accvgpr_read_b32 v57, a113
    v_accvgpr_read_b32 v58, a114
    v_accvgpr_read_b32 v59, a115
    v_accvgpr_read_b32 v60, a116
    v_accvgpr_read_b32 v61, a117
    v_accvgpr_read_b32 v62, a118
    v_accvgpr_read_b32 v63, a119
    v_mul_f32 v56, v21, v56
    v_mul_f32 v57, v21, v57
    v_mul_f32 v58, v21, v58
    v_mul_f32 v59, v21, v59
    v_mul_f32 v60, v21, v60
    v_mul_f32 v61, v21, v61
    v_mul_f32 v62, v21, v62
    v_mul_f32 v63, v21, v63
    v_cvt_pk_bf16_f32 v56, v56, v57
    v_cvt_pk_bf16_f32 v57, v58, v59
    v_cvt_pk_bf16_f32 v58, v60, v61
    v_cvt_pk_bf16_f32 v59, v62, v63
    buffer_store_dwordx4 v[56:59], v2, s[8:11], s90 offen offset:1024 sc1
    s_add_u32 s90, s90, 131072
    v_accvgpr_read_b32 v48, a88
    v_accvgpr_read_b32 v49, a89
    v_accvgpr_read_b32 v50, a90
    v_accvgpr_read_b32 v51, a91
    v_accvgpr_read_b32 v52, a92
    v_accvgpr_read_b32 v53, a93
    v_accvgpr_read_b32 v54, a94
    v_accvgpr_read_b32 v55, a95
    v_mul_f32 v48, v20, v48
    v_mul_f32 v49, v20, v49
    v_mul_f32 v50, v20, v50
    v_mul_f32 v51, v20, v51
    v_mul_f32 v52, v20, v52
    v_mul_f32 v53, v20, v53
    v_mul_f32 v54, v20, v54
    v_mul_f32 v55, v20, v55
    v_cvt_pk_bf16_f32 v48, v48, v49
    v_cvt_pk_bf16_f32 v49, v50, v51
    v_cvt_pk_bf16_f32 v50, v52, v53
    v_cvt_pk_bf16_f32 v51, v54, v55
    buffer_store_dwordx4 v[48:51], v2, s[8:11], s90 offen offset:0 sc1
    v_accvgpr_read_b32 v56, a120
    v_accvgpr_read_b32 v57, a121
    v_accvgpr_read_b32 v58, a122
    v_accvgpr_read_b32 v59, a123
    v_accvgpr_read_b32 v60, a124
    v_accvgpr_read_b32 v61, a125
    v_accvgpr_read_b32 v62, a126
    v_accvgpr_read_b32 v63, a127
    v_mul_f32 v56, v21, v56
    v_mul_f32 v57, v21, v57
    v_mul_f32 v58, v21, v58
    v_mul_f32 v59, v21, v59
    v_mul_f32 v60, v21, v60
    v_mul_f32 v61, v21, v61
    v_mul_f32 v62, v21, v62
    v_mul_f32 v63, v21, v63
    v_cvt_pk_bf16_f32 v56, v56, v57
    v_cvt_pk_bf16_f32 v57, v58, v59
    v_cvt_pk_bf16_f32 v58, v60, v61
    v_cvt_pk_bf16_f32 v59, v62, v63
    buffer_store_dwordx4 v[56:59], v2, s[8:11], s90 offen offset:1024 sc1
    s_add_u32 s90, s90, 131072
    s_lshl_b32 s101, s34, 5
    s_add_u32 s101, s101, s32
    s_lshl_b32 s101, s101, 3
    s_add_u32 s101, s101, 7936
    s_cmp_eq_u32 s64, s72
    s_cbranch_scc1 m_singlex98
.p2align 3
m_single97:
    v_mfma_f32_16x16x32_bf16 v[64:67], a[192:195], a[128:131], v[160:163]
    s_bitcmp1_b64 s[62:63], s64
    s_cselect_b32 s66, -1.0, s65
    v_add_f32 v12, v12, v28
    v_mfma_f32_16x16x32_bf16 v[64:67], a[196:199], a[132:135], v[64:67]
    s_mov_b32 m0, s59
    ds_read_b128 a[224:227], v6 offset:16384
    v_add_f32 v13, v13, v32
    v_mfma_f32_16x16x32_bf16 v[64:67], a[200:203], a[136:139], v[64:67]
    buffer_load_dwordx4 v7, s[24:27], s56 offen offset:0 sc1 lds
    v_mfma_f32_16x16x32_bf16 v[64:67], a[204:207], a[140:143], v[64:67]
    s_add_u32 s64, s64, 1
    ds_read_b128 a[228:231], v6 offset:17408
    v_exp_f32 v20, v96
    v_mfma_f32_16x16x32_bf16 v[72:75], a[204:207], a[156:159], v[168:171]
    ds_read_b128 a[232:235], v6 offset:18432
    v_exp_f32 v21, v97
    v_mfma_f32_16x16x32_bf16 v[72:75], a[200:203], a[152:155], v[72:75]
    ds_read_b128 a[236:239], v6 offset:19456
    v_cvt_pk_bf16_f32 v144, v20, v21
    v_mfma_f32_16x16x32_bf16 v[72:75], a[196:199], a[148:151], v[72:75]
    ds_read_b128 a[240:243], v6 offset:20480
    v_exp_f32 v22, v98
    v_mfma_f32_16x16x32_bf16 v[72:75], a[192:195], a[144:147], v[72:75]
    s_waitcnt lgkmcnt(5)
    ds_read_b128 a[244:247], v6 offset:21504
    v_mfma_f32_16x16x32_bf16 v[76:79], a[208:211], a[144:147], v[172:175]
    ds_read_b128 a[248:251], v6 offset:22528
    v_exp_f32 v23, v99
    v_mfma_f32_16x16x32_bf16 v[76:79], a[212:215], a[148:151], v[76:79]
    ds_read_b128 a[252:255], v6 offset:23552
    v_cvt_pk_bf16_f32 v145, v22, v23
    v_mfma_f32_16x16x32_bf16 v[76:79], a[216:219], a[152:155], v[76:79]
    buffer_load_dwordx4 v7, s[24:27], s56 offen offset:1024 sc1 lds
    v_mfma_f32_16x16x32_bf16 v[76:79], a[220:223], a[156:159], v[76:79]
    v_exp_f32 v24, v100
    v_mfma_f32_16x16x32_bf16 v[68:71], a[220:223], a[140:143], v[164:167]
    v_exp_f32 v25, v101
    v_mfma_f32_16x16x32_bf16 v[68:71], a[216:219], a[136:139], v[68:71]
    v_exp_f32 v26, v102
    v_mfma_f32_16x16x32_bf16 v[68:71], a[212:215], a[132:135], v[68:71]
    buffer_load_dwordx4 v7, s[24:27], s56 offen offset:2048 sc1 lds
    v_cvt_pk_bf16_f32 v146, v24, v25
    v_mfma_f32_16x16x32_bf16 v[68:71], a[208:211], a[128:131], v[68:71]
    s_waitcnt lgkmcnt(0)
    v_exp_f32 v27, v103
    v_mfma_f32_16x16x32_bf16 a[0:3], a[224:227], v[128:131], a[0:3]
    ds_read_b128 a[192:195], v6 offset:8192
    v_cvt_pk_bf16_f32 v147, v26, v27
    v_mfma_f32_16x16x32_bf16 a[32:35], a[224:227], v[132:135], a[32:35]
    v_exp_f32 v20, v104
    v_mfma_f32_16x16x32_bf16 v[28:31], v[44:47], v[144:147], 0
    v_exp_f32 v21, v105
    v_mfma_f32_16x16x32_bf16 a[36:39], a[228:231], v[132:135], a[36:39]
    ds_read_b128 a[196:199], v6 offset:9216
    v_exp_f32 v22, v106
    v_mfma_f32_16x16x32_bf16 a[4:7], a[228:231], v[128:131], a[4:7]
    buffer_load_dwordx4 v7, s[24:27], s56 offen offset:3072 sc1 lds
    v_mfma_f32_16x16x32_bf16 a[8:11], a[232:235], v[128:131], a[8:11]
    s_add_u32 s56, s56, 16384
    ds_read_b128 a[200:203], v6 offset:10240
    v_cvt_pk_bf16_f32 v148, v20, v21
    v_mfma_f32_16x16x32_bf16 a[40:43], a[232:235], v[132:135], a[40:43]
    v_exp_f32 v23, v107
    v_mfma_f32_16x16x32_bf16 a[44:47], a[236:239], v[132:135], a[44:47]
    ds_read_b128 a[204:207], v6 offset:11264
    v_exp_f32 v24, v108
    v_mfma_f32_16x16x32_bf16 a[12:15], a[236:239], v[128:131], a[12:15]
    v_cvt_pk_bf16_f32 v149, v22, v23
    v_exp_f32 v25, v109
    v_mfma_f32_16x16x32_bf16 a[16:19], a[240:243], v[128:131], a[16:19]
    v_exp_f32 v26, v110
    v_mfma_f32_16x16x32_bf16 a[48:51], a[240:243], v[132:135], a[48:51]
    v_cvt_pk_bf16_f32 v150, v24, v25
    v_exp_f32 v27, v111
    v_mfma_f32_16x16x32_bf16 a[52:55], a[244:247], v[132:135], a[52:55]
    ds_read_b128 a[208:211], v6 offset:12288
    v_cvt_pk_bf16_f32 v151, v26, v27
    v_mfma_f32_16x16x32_bf16 a[20:23], a[244:247], v[128:131], a[20:23]
    s_add_u32 m0, s59, 16384
    ds_read_b128 a[212:215], v6 offset:13312
    v_mfma_f32_16x16x32_bf16 v[32:35], v[44:47], v[148:151], 0
    s_nop 2
    v_mfma_f32_16x16x32_bf16 a[24:27], a[248:251], v[128:131], a[24:27]
    buffer_load_dwordx4 v7, s[28:31], s57 offen offset:0 sc1 lds
    v_mfma_f32_16x16x32_bf16 a[56:59], a[248:251], v[132:135], a[56:59]
    ds_read_b128 a[216:219], v6 offset:14336
    s_nop 0
    v_mfma_f32_16x16x32_bf16 a[60:63], a[252:255], v[132:135], a[60:63]
    ds_read_b128 a[220:223], v6 offset:15360
    v_max_f32 v8, v28, v32
    v_cmp_nge_f32 vcc, s66, v8
    v_mfma_f32_16x16x32_bf16 a[28:31], a[252:255], v[128:131], a[28:31]
    s_waitcnt lgkmcnt(4)
    s_cbranch_vccnz m_stub99
m_ret100:
    v_mfma_f32_16x16x32_bf16 v[96:99], a[192:195], a[128:131], v[160:163]
    s_add_u32 s59, s58, s60
    v_exp_f32 v20, v64
    v_mfma_f32_16x16x32_bf16 v[96:99], a[196:199], a[132:135], v[96:99]
    s_add_u32 s58, s58, 32768
    ds_read_b128 a[224:227], v6 offset:24576
    v_add_f32 v12, v12, v28
    v_mfma_f32_16x16x32_bf16 v[96:99], a[200:203], a[136:139], v[96:99]
    s_cmp_ge_u32 s58, 163840
    s_cselect_b32 s58, 0, s58
    ds_read_b128 a[228:231], v6 offset:25600
    v_exp_f32 v21, v65
    v_mfma_f32_16x16x32_bf16 v[96:99], a[204:207], a[140:143], v[96:99]
    s_bitcmp1_b64 s[62:63], s64
    s_cselect_b32 s66, -1.0, s65
    ds_read_b128 a[232:235], v6 offset:26624
    v_mfma_f32_16x16x32_bf16 v[104:107], a[204:207], a[156:159], v[168:171]
    buffer_load_dwordx4 v7, s[28:31], s57 offen offset:1024 sc1 lds
    v_mfma_f32_16x16x32_bf16 v[104:107], a[200:203], a[152:155], v[104:107]
    s_add_u32 s64, s64, 1
    ds_read_b128 a[236:239], v6 offset:27648
    v_cvt_pk_bf16_f32 v128, v20, v21
    v_mfma_f32_16x16x32_bf16 v[104:107], a[196:199], a[148:151], v[104:107]
    ds_read_b128 a[240:243], v6 offset:28672
    v_exp_f32 v22, v66
    v_mfma_f32_16x16x32_bf16 v[104:107], a[192:195], a[144:147], v[104:107]
    s_waitcnt lgkmcnt(5)
    ds_read_b128 a[244:247], v6 offset:29696
    v_add_f32 v13, v13, v32
    v_mfma_f32_16x16x32_bf16 v[108:111], a[208:211], a[144:147], v[172:175]
    ds_read_b128 a[248:251], v6 offset:30720
    v_exp_f32 v23, v67
    v_mfma_f32_16x16x32_bf16 v[108:111], a[212:215], a[148:151], v[108:111]
    buffer_load_dwordx4 v7, s[28:31], s57 offen offset:2048 sc1 lds
    v_mfma_f32_16x16x32_bf16 v[108:111], a[216:219], a[152:155], v[108:111]
    ds_read_b128 a[252:255], v6 offset:31744
    v_cvt_pk_bf16_f32 v129, v22, v23
    v_mfma_f32_16x16x32_bf16 v[108:111], a[220:223], a[156:159], v[108:111]
    v_exp_f32 v24, v68
    v_mfma_f32_16x16x32_bf16 v[100:103], a[220:223], a[140:143], v[164:167]
    v_exp_f32 v25, v69
    v_mfma_f32_16x16x32_bf16 v[100:103], a[216:219], a[136:139], v[100:103]
    buffer_load_dwordx4 v7, s[28:31], s57 offen offset:3072 sc1 lds
    v_mfma_f32_16x16x32_bf16 v[100:103], a[212:215], a[132:135], v[100:103]
    s_add_u32 s57, s57, 16384
    v_exp_f32 v26, v70
    v_cvt_pk_bf16_f32 v130, v24, v25
    v_mfma_f32_16x16x32_bf16 v[100:103], a[208:211], a[128:131], v[100:103]
    s_waitcnt vmcnt(24) lgkmcnt(0)
    v_add_u32 v6, s58, v2
    v_exp_f32 v27, v71
    v_mfma_f32_16x16x32_bf16 a[0:3], a[224:227], v[144:147], a[0:3]
    s_barrier
    v_mfma_f32_16x16x32_bf16 a[32:35], a[224:227], v[148:151], a[32:35]
    ds_read_b128 a[192:195], v6 offset:0
    v_cvt_pk_bf16_f32 v131, v26, v27
    v_mfma_f32_16x16x32_bf16 a[36:39], a[228:231], v[148:151], a[36:39]
    v_exp_f32 v20, v72
    v_mfma_f32_16x16x32_bf16 v[28:31], v[44:47], v[128:131], 0
    v_exp_f32 v21, v73
    v_mfma_f32_16x16x32_bf16 a[4:7], a[228:231], v[144:147], a[4:7]
    ds_read_b128 a[196:199], v6 offset:1024
    v_cvt_pk_bf16_f32 v132, v20, v21
    v_mfma_f32_16x16x32_bf16 a[8:11], a[232:235], v[144:147], a[8:11]
    v_exp_f32 v22, v74
    v_mfma_f32_16x16x32_bf16 a[40:43], a[232:235], v[148:151], a[40:43]
    ds_read_b128 a[200:203], v6 offset:2048
    v_exp_f32 v23, v75
    v_mfma_f32_16x16x32_bf16 a[44:47], a[236:239], v[148:151], a[44:47]
    v_exp_f32 v24, v76
    v_mfma_f32_16x16x32_bf16 a[12:15], a[236:239], v[144:147], a[12:15]
    ds_read_b128 a[204:207], v6 offset:3072
    v_cvt_pk_bf16_f32 v133, v22, v23
    v_mfma_f32_16x16x32_bf16 a[16:19], a[240:243], v[144:147], a[16:19]
    v_exp_f32 v25, v77
    v_mfma_f32_16x16x32_bf16 a[48:51], a[240:243], v[148:151], a[48:51]
    v_exp_f32 v26, v78
    v_cvt_pk_bf16_f32 v134, v24, v25
    v_mfma_f32_16x16x32_bf16 a[52:55], a[244:247], v[148:151], a[52:55]
    v_exp_f32 v27, v79
    v_mfma_f32_16x16x32_bf16 a[20:23], a[244:247], v[144:147], a[20:23]
    ds_read_b128 a[208:211], v6 offset:4096
    v_cvt_pk_bf16_f32 v135, v26, v27
    s_nop 1
    v_mfma_f32_16x16x32_bf16 v[32:35], v[44:47], v[132:135], 0
    s_nop 2
    v_mfma_f32_16x16x32_bf16 a[24:27], a[248:251], v[144:147], a[24:27]
    ds_read_b128 a[212:215], v6 offset:5120
    s_nop 0
    v_mfma_f32_16x16x32_bf16 a[56:59], a[248:251], v[148:151], a[56:59]
    ds_read_b128 a[216:219], v6 offset:6144
    v_max_f32 v8, v28, v32
    v_mfma_f32_16x16x32_bf16 a[60:63], a[252:255], v[148:151], a[60:63]
    ds_read_b128 a[220:223], v6 offset:7168
    v_cmp_nge_f32 vcc, s66, v8
    v_mfma_f32_16x16x32_bf16 a[28:31], a[252:255], v[144:147], a[28:31]
    s_waitcnt lgkmcnt(4)
    s_cbranch_vccz m_single97
    v_cmp_lt_f32 vcc, s65, v8
    s_cmp_lg_u32 s64, s70
    s_cbranch_scc1 m_e102
    v_add_f32 v160, v160, v16
    v_mov_b32 v164, v9
    v_add_f32 v172, v172, v16
    v_add_f32 v161, v161, v17
    v_mov_b32 v165, v9
    v_add_f32 v173, v173, v17
    v_add_f32 v162, v162, v18
    v_mov_b32 v166, v9
    v_add_f32 v174, v174, v18
    v_add_f32 v163, v163, v19
    v_mov_b32 v167, v9
    v_add_f32 v175, v175, v19
    s_nop 0
m_e102:
    s_cmp_lg_u32 s64, s71
    s_cbranch_scc1 m_e103
    v_mov_b32 v160, v9
    v_mov_b32 v168, v9
    v_mov_b32 v172, v9
    v_mov_b32 v161, v9
    v_mov_b32 v169, v9
    v_mov_b32 v173, v9
    v_mov_b32 v162, v9
    v_mov_b32 v170, v9
    v_mov_b32 v174, v9
    v_mov_b32 v163, v9
    v_mov_b32 v171, v9
    v_mov_b32 v175, v9
    s_nop 0
m_e103:
    s_cmp_lg_u32 s64, s53
    s_cbranch_scc1 m_e106
    s_cmp_lg_u32 s16, 0
    s_cbranch_scc1 m_np107
    v_mov_b32 v60, s4
    v_mov_b32 v61, s5
    s_add_u32 s90, s101, 117440512
    s_mov_b64 exec, 1
    buffer_store_dwordx2 v[60:61], off, s[8:11], s90 sc1
    s_mov_b64 exec, -1
m_np107:
    s_mov_b32 s101, -1
m_e106:
    s_cmp_gt_u32 s64, 24
    s_cbranch_scc1 m_e104
    s_cmp_lg_u32 s64, 8
    s_cbranch_scc1 m_e108
    s_lshr_b32 s90, s32, 1
    s_lshl_b32 s90, s90, 7
    s_add_u32 s90, s90, 117440600
    v_min_u32 v0, 1, v1
    v_lshlrev_b32 v0, 5, v0
    buffer_load_dwordx2 v[4:5], v0, s[8:11], s90 offen sc1
    s_cmp_eq_u32 s17, -1
    s_cbranch_scc1 m_e104
    s_cmp_lg_u32 s16, 0
    s_cbranch_scc1 m_np109
    v_mov_b32 v60, s4
    v_mov_b32 v61, s5
    s_add_u32 s90, s17, 117440512
    s_mov_b64 exec, 1
    buffer_store_dwordx2 v[60:61], off, s[8:11], s90 sc1
    s_mov_b64 exec, -1
m_np109:
    s_branch m_e104
m_e108:
    s_cmp_lg_u32 s64, 16
    s_cbranch_scc1 m_e110
    s_waitcnt vmcnt(18)
    s_mov_b32 s3, 1048576
m_spin111:
    v_cmp_ne_u64 s[76:77], s[4:5], v[4:5]
    s_nop 3
    s_cmp_eq_u64 s[76:77], 0
    s_cbranch_scc1 m_e104
    s_sub_u32 s3, s3, 1
    s_cbranch_scc1 m_e104
    s_sleep 32
    s_lshr_b32 s90, s32, 1
    s_lshl_b32 s90, s90, 7
    s_add_u32 s90, s90, 117440600
    v_min_u32 v0, 1, v1
    v_lshlrev_b32 v0, 5, v0
    buffer_load_dwordx2 v[4:5], v0, s[8:11], s90 offen sc1
    s_waitcnt vmcnt(0)
    s_branch m_spin111
    s_branch m_e104
m_e110:
    s_cmp_lg_u32 s64, 20
    s_cbranch_scc1 m_e112
    buffer_load_dwordx2 v[4:5], v10, s[8:11], 0 offen sc1
    s_mov_b32 s44, s48
    s_mov_b32 s45, s49
    s_mov_b32 s46, 8388608
    s_lshl_b32 s90, s2, 2
    s_add_u32 s90, s90, s16
    s_lshl_b32 s90, s90, 13
    v_lshlrev_b32 v62, 7, v1
    buffer_load_dword v255, v62, s[44:47], s90 offen
    s_branch m_e104
m_e112:
    s_cmp_lg_u32 s64, 24
    s_cbranch_scc1 m_e113
    s_mov_b32 s44, s50
    s_mov_b32 s45, s51
    s_mov_b32 s46, 2097152
    s_lshl_b32 s90, s2, 2
    s_add_u32 s90, s90, s16
    s_lshl_b32 s90, s90, 13
    v_lshlrev_b32 v62, 7, v1
    buffer_load_dword v255, v62, s[44:47], s90 offen
    s_waitcnt vmcnt(18)
    s_mov_b32 s3, 1048576
m_spin114:
    v_cmp_ne_u64 s[76:77], s[4:5], v[4:5]
    s_nop 3
    s_cmp_eq_u64 s[76:77], 0
    s_cbranch_scc1 m_e104
    s_sub_u32 s3, s3, 1
    s_cbranch_scc1 m_e104
    s_sleep 32
    buffer_load_dwordx2 v[4:5], v10, s[8:11], 0 offen sc1
    s_waitcnt vmcnt(0)
    s_branch m_spin114
    s_branch m_e104
m_e113:
m_e104:
    s_cbranch_vccnz m_rc115
m_sp101:
    s_cmp_lg_u32 s64, s72
    s_cbranch_scc1 m_single97
m_singlex98:
    s_bfe_u32 s95, s2, 0x10002
    s_and_b32 s90, s2, 7
    s_bitcmp1_b32 0x63, s90
    s_cselect_b32 s96, s33, s34
    s_sub_u32 s96, s96, 1
    s_and_b32 s90, s2, 1
    s_lshl_b32 s90, s90, 2
    s_bfe_u32 s91, s2, 0x20003
    s_add_u32 s97, s90, s91
    v_and_b32 v10, 31, v1
    v_lshlrev_b32 v10, 3, v10
    s_lshl_b32 s52, s96, 8
    s_add_u32 s52, s52, 117448704
    buffer_load_dwordx2 v[4:5], v10, s[8:11], s52 offen sc1
    ds_read_b128 a[224:227], v6 offset:16384
    ds_read_b128 a[228:231], v6 offset:17408
    ds_read_b128 a[232:235], v6 offset:18432
    ds_read_b128 a[236:239], v6 offset:19456
    ds_read_b128 a[240:243], v6 offset:20480
    ds_read_b128 a[244:247], v6 offset:21504
    ds_read_b128 a[248:251], v6 offset:22528
    ds_read_b128 a[252:255], v6 offset:23552
    s_waitcnt lgkmcnt(0)
    v_mfma_f32_16x16x32_bf16 a[0:3], a[224:227], v[128:131], a[0:3]
    buffer_load_dwordx4 v[192:195], v2, s[8:11], s83 offen offset:0 sc1
    v_exp_f32 v20, v96
    v_mfma_f32_16x16x32_bf16 a[32:35], a[224:227], v[132:135], a[32:35]
    v_exp_f32 v21, v97
    v_exp_f32 v22, v98
    v_mfma_f32_16x16x32_bf16 a[36:39], a[228:231], v[132:135], a[36:39]
    buffer_load_dwordx4 v[196:199], v2, s[8:11], s83 offen offset:1024 sc1
    v_cvt_pk_bf16_f32 v144, v20, v21
    v_add_f32 v12, v12, v28
    v_mfma_f32_16x16x32_bf16 a[4:7], a[228:231], v[128:131], a[4:7]
    v_exp_f32 v23, v99
    v_exp_f32 v24, v100
    v_cvt_pk_bf16_f32 v145, v22, v23
    v_mfma_f32_16x16x32_bf16 a[8:11], a[232:235], v[128:131], a[8:11]
    buffer_load_dwordx4 v[200:203], v2, s[8:11], s83 offen offset:2048 sc1
    v_exp_f32 v25, v101
    v_mfma_f32_16x16x32_bf16 a[40:43], a[232:235], v[132:135], a[40:43]
    v_exp_f32 v26, v102
    v_cvt_pk_bf16_f32 v146, v24, v25
    v_add_f32 v13, v13, v32
    v_mfma_f32_16x16x32_bf16 a[44:47], a[236:239], v[132:135], a[44:47]
    buffer_load_dwordx4 v[204:207], v2, s[8:11], s83 offen offset:3072 sc1
    v_exp_f32 v27, v103
    v_mfma_f32_16x16x32_bf16 a[12:15], a[236:239], v[128:131], a[12:15]
    v_exp_f32 v20, v104
    v_cvt_pk_bf16_f32 v147, v26, v27
    v_mfma_f32_16x16x32_bf16 a[16:19], a[240:243], v[128:131], a[16:19]
    buffer_load_dwordx4 v[212:215], v2, s[8:11], s84 offen offset:0 sc1
    v_exp_f32 v21, v105
    v_mfma_f32_16x16x32_bf16 v[28:31], v[44:47], v[144:147], 0
    v_exp_f32 v22, v106
    v_cvt_pk_bf16_f32 v148, v20, v21
    v_exp_f32 v23, v107
    v_mfma_f32_16x16x32_bf16 a[48:51], a[240:243], v[132:135], a[48:51]
    v_exp_f32 v24, v108
    v_cvt_pk_bf16_f32 v149, v22, v23
    v_exp_f32 v25, v109
    v_mfma_f32_16x16x32_bf16 a[52:55], a[244:247], v[132:135], a[52:55]
    buffer_load_dwordx4 v[216:219], v2, s[8:11], s84 offen offset:1024 sc1
    v_exp_f32 v26, v110
    v_mfma_f32_16x16x32_bf16 a[20:23], a[244:247], v[128:131], a[20:23]
    v_cvt_pk_bf16_f32 v150, v24, v25
    v_exp_f32 v27, v111
    s_nop 0
    v_cvt_pk_bf16_f32 v151, v26, v27
    s_nop 1
    v_mfma_f32_16x16x32_bf16 v[32:35], v[44:47], v[148:151], 0
    s_nop 2
    v_mfma_f32_16x16x32_bf16 a[24:27], a[248:251], v[128:131], a[24:27]
    buffer_load_dwordx4 v[220:223], v2, s[8:11], s84 offen offset:2048 sc1
    v_mfma_f32_16x16x32_bf16 a[56:59], a[248:251], v[132:135], a[56:59]
    s_nop 2
    v_mfma_f32_16x16x32_bf16 a[60:63], a[252:255], v[132:135], a[60:63]
    v_max_f32 v8, v28, v32
    v_cmp_nge_f32 vcc, s65, v8
    v_mfma_f32_16x16x32_bf16 a[28:31], a[252:255], v[128:131], a[28:31]
    s_cbranch_vccnz m_stub116
m_ret117:
    s_nop 1
    s_cmp_ge_u32 s16, 2
    s_cbranch_scc1 m_xb118
    s_waitcnt vmcnt(24)
    s_barrier
m_xb118:
    ds_read_b128 a[224:227], v6 offset:24576
    ds_read_b128 a[228:231], v6 offset:25600
    ds_read_b128 a[232:235], v6 offset:26624
    ds_read_b128 a[236:239], v6 offset:27648
    ds_read_b128 a[240:243], v6 offset:28672
    ds_read_b128 a[244:247], v6 offset:29696
    ds_read_b128 a[248:251], v6 offset:30720
    ds_read_b128 a[252:255], v6 offset:31744
    s_waitcnt lgkmcnt(0)
    v_mfma_f32_16x16x32_bf16 a[0:3], a[224:227], v[144:147], a[0:3]
    buffer_load_dwordx4 v[224:227], v2, s[8:11], s84 offen offset:3072 sc1
    v_mfma_f32_16x16x32_bf16 a[32:35], a[224:227], v[148:151], a[32:35]
    v_mfma_f32_16x16x32_bf16 a[36:39], a[228:231], v[148:151], a[36:39]
    buffer_load_dwordx4 v[208:211], v2, s[8:11], s85 offen offset:0 sc1
    v_mfma_f32_16x16x32_bf16 a[4:7], a[228:231], v[144:147], a[4:7]
    v_mfma_f32_16x16x32_bf16 a[8:11], a[232:235], v[144:147], a[8:11]
    buffer_load_dwordx4 v[232:235], v2, s[8:11], s86 offen offset:0 sc1
    v_mfma_f32_16x16x32_bf16 a[40:43], a[232:235], v[148:151], a[40:43]
    v_mfma_f32_16x16x32_bf16 a[44:47], a[236:239], v[148:151], a[44:47]
    buffer_load_dwordx4 v[236:239], v2, s[8:11], s86 offen offset:1024 sc1
    v_mfma_f32_16x16x32_bf16 a[12:15], a[236:239], v[144:147], a[12:15]
    v_mfma_f32_16x16x32_bf16 a[16:19], a[240:243], v[144:147], a[16:19]
    buffer_load_dwordx4 v[228:231], v2, s[8:11], s87 offen offset:0 sc1
    v_mfma_f32_16x16x32_bf16 a[48:51], a[240:243], v[148:151], a[48:51]
    v_mfma_f32_16x16x32_bf16 a[52:55], a[244:247], v[148:151], a[52:55]
    buffer_load_dwordx4 v[244:247], v2, s[8:11], s88 offen offset:0 sc1
    v_mfma_f32_16x16x32_bf16 a[20:23], a[244:247], v[144:147], a[20:23]
    v_mfma_f32_16x16x32_bf16 a[24:27], a[248:251], v[144:147], a[24:27]
    buffer_load_dwordx4 v[248:251], v2, s[8:11], s88 offen offset:1024 sc1
    v_mfma_f32_16x16x32_bf16 a[56:59], a[248:251], v[148:151], a[56:59]
    v_mfma_f32_16x16x32_bf16 a[60:63], a[252:255], v[148:151], a[60:63]
    buffer_load_dwordx4 v[240:243], v2, s[8:11], s89 offen offset:0 sc1
    v_mfma_f32_16x16x32_bf16 a[28:31], a[252:255], v[144:147], a[28:31]
    v_add_f32 v20, v12, v28
    v_add_f32 v21, v13, v32
    s_nop 3
    v_rcp_f32 v20, v20
    v_rcp_f32 v21, v21
    s_lshl_b32 s90, s78, 10
    s_add_u32 s90, s90, s82
    s_add_u32 s90, s90, 67108864
    v_accvgpr_read_b32 v48, a0
    v_accvgpr_read_b32 v49, a1
    v_accvgpr_read_b32 v50, a2
    v_accvgpr_read_b32 v51, a3
    v_accvgpr_read_b32 v52, a4
    v_accvgpr_read_b32 v53, a5
    v_accvgpr_read_b32 v54, a6
    v_accvgpr_read_b32 v55, a7
    v_mul_f32 v48, v20, v48
    v_mul_f32 v49, v20, v49
    v_mul_f32 v50, v20, v50
    v_mul_f32 v51, v20, v51
    v_mul_f32 v52, v20, v52
    v_mul_f32 v53, v20, v53
    v_mul_f32 v54, v20, v54
    v_mul_f32 v55, v20, v55
    v_cvt_pk_bf16_f32 v48, v48, v49
    v_cvt_pk_bf16_f32 v49, v50, v51
    v_cvt_pk_bf16_f32 v50, v52, v53
    v_cvt_pk_bf16_f32 v51, v54, v55
    buffer_store_dwordx4 v[48:51], v2, s[8:11], s90 offen offset:0 sc1
    v_accvgpr_read_b32 v56, a32
    v_accvgpr_read_b32 v57, a33
    v_accvgpr_read_b32 v58, a34
    v_accvgpr_read_b32 v59, a35
    v_accvgpr_read_b32 v60, a36
    v_accvgpr_read_b32 v61, a37
    v_accvgpr_read_b32 v62, a38
    v_accvgpr_read_b32 v63, a39
    v_mul_f32 v56, v21, v56
    v_mul_f32 v57, v21, v57
    v_mul_f32 v58, v21, v58
    v_mul_f32 v59, v21, v59
    v_mul_f32 v60, v21, v60
    v_mul_f32 v61, v21, v61
    v_mul_f32 v62, v21, v62
    v_mul_f32 v63, v21, v63
    v_cvt_pk_bf16_f32 v56, v56, v57
    v_cvt_pk_bf16_f32 v57, v58, v59
    v_cvt_pk_bf16_f32 v58, v60, v61
    v_cvt_pk_bf16_f32 v59, v62, v63
    buffer_store_dwordx4 v[56:59], v2, s[8:11], s90 offen offset:1024 sc1
    s_add_u32 s90, s90, 131072
    v_accvgpr_read_b32 v48, a8
    v_accvgpr_read_b32 v49, a9
    v_accvgpr_read_b32 v50, a10
    v_accvgpr_read_b32 v51, a11
    v_accvgpr_read_b32 v52, a12
    v_accvgpr_read_b32 v53, a13
    v_accvgpr_read_b32 v54, a14
    v_accvgpr_read_b32 v55, a15
    v_mul_f32 v48, v20, v48
    v_mul_f32 v49, v20, v49
    v_mul_f32 v50, v20, v50
    v_mul_f32 v51, v20, v51
    v_mul_f32 v52, v20, v52
    v_mul_f32 v53, v20, v53
    v_mul_f32 v54, v20, v54
    v_mul_f32 v55, v20, v55
    v_cvt_pk_bf16_f32 v48, v48, v49
    v_cvt_pk_bf16_f32 v49, v50, v51
    v_cvt_pk_bf16_f32 v50, v52, v53
    v_cvt_pk_bf16_f32 v51, v54, v55
    buffer_store_dwordx4 v[48:51], v2, s[8:11], s90 offen offset:0 sc1
    v_accvgpr_read_b32 v56, a40
    v_accvgpr_read_b32 v57, a41
    v_accvgpr_read_b32 v58, a42
    v_accvgpr_read_b32 v59, a43
    v_accvgpr_read_b32 v60, a44
    v_accvgpr_read_b32 v61, a45
    v_accvgpr_read_b32 v62, a46
    v_accvgpr_read_b32 v63, a47
    v_mul_f32 v56, v21, v56
    v_mul_f32 v57, v21, v57
    v_mul_f32 v58, v21, v58
    v_mul_f32 v59, v21, v59
    v_mul_f32 v60, v21, v60
    v_mul_f32 v61, v21, v61
    v_mul_f32 v62, v21, v62
    v_mul_f32 v63, v21, v63
    v_cvt_pk_bf16_f32 v56, v56, v57
    v_cvt_pk_bf16_f32 v57, v58, v59
    v_cvt_pk_bf16_f32 v58, v60, v61
    v_cvt_pk_bf16_f32 v59, v62, v63
    buffer_store_dwordx4 v[56:59], v2, s[8:11], s90 offen offset:1024 sc1
    s_add_u32 s90, s90, 131072
    v_accvgpr_read_b32 v48, a16
    v_accvgpr_read_b32 v49, a17
    v_accvgpr_read_b32 v50, a18
    v_accvgpr_read_b32 v51, a19
    v_accvgpr_read_b32 v52, a20
    v_accvgpr_read_b32 v53, a21
    v_accvgpr_read_b32 v54, a22
    v_accvgpr_read_b32 v55, a23
    v_mul_f32 v48, v20, v48
    v_mul_f32 v49, v20, v49
    v_mul_f32 v50, v20, v50
    v_mul_f32 v51, v20, v51
    v_mul_f32 v52, v20, v52
    v_mul_f32 v53, v20, v53
    v_mul_f32 v54, v20, v54
    v_mul_f32 v55, v20, v55
    v_cvt_pk_bf16_f32 v48, v48, v49
    v_cvt_pk_bf16_f32 v49, v50, v51
    v_cvt_pk_bf16_f32 v50, v52, v53
    v_cvt_pk_bf16_f32 v51, v54, v55
    buffer_store_dwordx4 v[48:51], v2, s[8:11], s90 offen offset:0 sc1
    v_accvgpr_read_b32 v56, a48
    v_accvgpr_read_b32 v57, a49
    v_accvgpr_read_b32 v58, a50
    v_accvgpr_read_b32 v59, a51
    v_accvgpr_read_b32 v60, a52
    v_accvgpr_read_b32 v61, a53
    v_accvgpr_read_b32 v62, a54
    v_accvgpr_read_b32 v63, a55
    v_mul_f32 v56, v21, v56
    v_mul_f32 v57, v21, v57
    v_mul_f32 v58, v21, v58
    v_mul_f32 v59, v21, v59
    v_mul_f32 v60, v21, v60
    v_mul_f32 v61, v21, v61
    v_mul_f32 v62, v21, v62
    v_mul_f32 v63, v21, v63
    v_cvt_pk_bf16_f32 v56, v56, v57
    v_cvt_pk_bf16_f32 v57, v58, v59
    v_cvt_pk_bf16_f32 v58, v60, v61
    v_cvt_pk_bf16_f32 v59, v62, v63
    buffer_store_dwordx4 v[56:59], v2, s[8:11], s90 offen offset:1024 sc1
    s_add_u32 s90, s90, 131072
    v_accvgpr_read_b32 v48, a24
    v_accvgpr_read_b32 v49, a25
    v_accvgpr_read_b32 v50, a26
    v_accvgpr_read_b32 v51, a27
    v_accvgpr_read_b32 v52, a28
    v_accvgpr_read_b32 v53, a29
    v_accvgpr_read_b32 v54, a30
    v_accvgpr_read_b32 v55, a31
    v_mul_f32 v48, v20, v48
    v_mul_f32 v49, v20, v49
    v_mul_f32 v50, v20, v50
    v_mul_f32 v51, v20, v51
    v_mul_f32 v52, v20, v52
    v_mul_f32 v53, v20, v53
    v_mul_f32 v54, v20, v54
    v_mul_f32 v55, v20, v55
    v_cvt_pk_bf16_f32 v48, v48, v49
    v_cvt_pk_bf16_f32 v49, v50, v51
    v_cvt_pk_bf16_f32 v50, v52, v53
    v_cvt_pk_bf16_f32 v51, v54, v55
    buffer_store_dwordx4 v[48:51], v2, s[8:11], s90 offen offset:0 sc1
    v_accvgpr_read_b32 v56, a56
    v_accvgpr_read_b32 v57, a57
    v_accvgpr_read_b32 v58, a58
    v_accvgpr_read_b32 v59, a59
    v_accvgpr_read_b32 v60, a60
    v_accvgpr_read_b32 v61, a61
    v_accvgpr_read_b32 v62, a62
    v_accvgpr_read_b32 v63, a63
    v_mul_f32 v56, v21, v56
    v_mul_f32 v57, v21, v57
    v_mul_f32 v58, v21, v58
    v_mul_f32 v59, v21, v59
    v_mul_f32 v60, v21, v60
    v_mul_f32 v61, v21, v61
    v_mul_f32 v62, v21, v62
    v_mul_f32 v63, v21, v63
    v_cvt_pk_bf16_f32 v56, v56, v57
    v_cvt_pk_bf16_f32 v57, v58, v59
    v_cvt_pk_bf16_f32 v58, v60, v61
    v_cvt_pk_bf16_f32 v59, v62, v63
    buffer_store_dwordx4 v[56:59], v2, s[8:11], s90 offen offset:1024 sc1
    s_add_u32 s90, s90, 131072
    s_barrier
    s_lshr_b32 s53, s16, 1
    s_and_b32 s40, s16, 1
    s_mul_i32 s90, s95, 5242880
    s_lshl_b32 s57, s97, 8
    s_add_u32 s57, s57, s90
    v_lshrrev_b32 v20, 4, v1
    s_lshl_b32 s90, s16, 4
    v_add_u32 v21, s90, v20
    v_lshlrev_b32 v21, 11, v21
    v_lshlrev_b32 v20, 1, v20
    v_and_b32 v22, 15, v1
    v_xor_b32 v20, v20, v22
    v_xor_b32 v22, 0, v20
    v_lshl_add_u32 v16, v22, 4, v21
    v_xor_b32 v22, 8, v20
    v_lshl_add_u32 v17, v22, 4, v21
    v_add_u32 v17, 7168, v17
    v_xor_b32 v22, 0, v20
    v_lshl_add_u32 v18, v22, 4, v21
    v_add_u32 v18, 14336, v18
    v_xor_b32 v22, 8, v20
    v_lshl_add_u32 v19, v22, 4, v21
    v_add_u32 v19, 21504, v19
    s_mov_b32 s24, s48
    s_mov_b32 s25, s49
    s_mov_b32 s26, 8388608
    s_mov_b32 s38, 268435456
    s_mov_b32 s28, s54
    s_mov_b32 s29, s55
    s_mov_b32 s30, 8388608
    s_lshl_b32 s90, s96, 13
    s_lshl_b32 s91, s40, 12
    s_add_u32 s90, s90, s91
    s_lshl_b32 s91, s53, 17
    s_add_u32 s69, s90, s91
    s_mul_i32 s90, s95, 10485760
    s_add_u32 s56, s69, s90
    s_add_u32 s56, s56, 67108864
    s_add_u32 s69, s69, 83886080
    s_add_u32 m0, s60, 16384
    s_nop 0
    buffer_load_dwordx4 v16, s[24:27], s57 offen offset:0 sc1 lds
    buffer_load_dwordx4 v17, s[24:27], s57 offen offset:1024 sc1 lds
    buffer_load_dwordx4 v18, s[24:27], s57 offen offset:2048 sc1 lds
    buffer_load_dwordx4 v19, s[24:27], s57 offen offset:3072 sc1 lds
    s_add_u32 s57, s57, 131072
    s_add_u32 m0, s60, 49152
    s_nop 0
    buffer_load_dwordx4 v16, s[24:27], s57 offen offset:0 sc1 lds
    buffer_load_dwordx4 v17, s[24:27], s57 offen offset:1024 sc1 lds
    buffer_load_dwordx4 v18, s[24:27], s57 offen offset:2048 sc1 lds
    buffer_load_dwordx4 v19, s[24:27], s57 offen offset:3072 sc1 lds
    s_add_u32 s57, s57, 131072
    s_add_u32 m0, s60, 81920
    s_nop 0
    buffer_load_dwordx4 v16, s[24:27], s57 offen offset:0 sc1 lds
    buffer_load_dwordx4 v17, s[24:27], s57 offen offset:1024 sc1 lds
    buffer_load_dwordx4 v18, s[24:27], s57 offen offset:2048 sc1 lds
    buffer_load_dwordx4 v19, s[24:27], s57 offen offset:3072 sc1 lds
    s_add_u32 s57, s57, 131072
    s_add_u32 m0, s60, 114688
    s_nop 0
    buffer_load_dwordx4 v16, s[24:27], s57 offen offset:0 sc1 lds
    buffer_load_dwordx4 v17, s[24:27], s57 offen offset:1024 sc1 lds
    buffer_load_dwordx4 v18, s[24:27], s57 offen offset:2048 sc1 lds
    buffer_load_dwordx4 v19, s[24:27], s57 offen offset:3072 sc1 lds
    s_add_u32 s57, s57, 131072
    s_waitcnt vmcnt(39)
    v_cmp_ne_u64 s[76:77], s[4:5], v[4:5]
    s_mul_i32 s91, s95, 20
    s_nop 2
    s_lshr_b32 s90, s76, s91
    s_ff1_i32_b32 s90, s90
    s_lshl_b32 s68, s90, 1
    s_mul_i32 s91, s95, 0
    s_sub_i32 s68, s68, s91
    s_cmp_lt_i32 s90, 0
    s_cselect_b32 s68, 1000, s68
    s_mov_b32 s99, 0
    s_cmp_gt_i32 s68, 4
    s_cbranch_scc0 m_x1119
    s_mov_b32 s99, 1
    s_add_u32 m0, s60, 0
    s_nop 0
    buffer_load_dwordx4 v2, s[36:39], s56 offen offset:0 sc1 lds
    buffer_load_dwordx4 v2, s[36:39], s56 offen offset:1024 sc1 lds
    buffer_load_dwordx4 v2, s[36:39], s56 offen offset:2048 sc1 lds
    buffer_load_dwordx4 v2, s[36:39], s56 offen offset:3072 sc1 lds
    s_add_u32 s56, s56, 262144
    s_add_u32 m0, s60, 32768
    s_nop 0
    buffer_load_dwordx4 v2, s[36:39], s56 offen offset:0 sc1 lds
    buffer_load_dwordx4 v2, s[36:39], s56 offen offset:1024 sc1 lds
    buffer_load_dwordx4 v2, s[36:39], s56 offen offset:2048 sc1 lds
    buffer_load_dwordx4 v2, s[36:39], s56 offen offset:3072 sc1 lds
    s_add_u32 s56, s56, 262144
    s_add_u32 m0, s60, 65536
    s_nop 0
    buffer_load_dwordx4 v2, s[36:39], s56 offen offset:0 sc1 lds
    buffer_load_dwordx4 v2, s[36:39], s56 offen offset:1024 sc1 lds
    buffer_load_dwordx4 v2, s[36:39], s56 offen offset:2048 sc1 lds
    buffer_load_dwordx4 v2, s[36:39], s56 offen offset:3072 sc1 lds
    s_add_u32 s56, s56, 262144
    s_add_u32 m0, s60, 98304
    s_nop 0
    buffer_load_dwordx4 v2, s[36:39], s56 offen offset:0 sc1 lds
    buffer_load_dwordx4 v2, s[36:39], s56 offen offset:1024 sc1 lds
    buffer_load_dwordx4 v2, s[36:39], s56 offen offset:2048 sc1 lds
    buffer_load_dwordx4 v2, s[36:39], s56 offen offset:3072 sc1 lds
    s_add_u32 s56, s56, 262144
    s_add_u32 m0, s60, 131072
    s_nop 0
    buffer_load_dwordx4 v2, s[36:39], s56 offen offset:0 sc1 lds
    buffer_load_dwordx4 v2, s[36:39], s56 offen offset:1024 sc1 lds
    buffer_load_dwordx4 v2, s[36:39], s56 offen offset:2048 sc1 lds
    buffer_load_dwordx4 v2, s[36:39], s56 offen offset:3072 sc1 lds
    s_add_u32 s56, s56, 262144
m_x1119:
    s_lshl_b32 s90, s53, 12
    v_add_u32 v6, s90, v2
    v_lshrrev_b32 v48, 2, v1
    v_lshlrev_b32 v48, 8, v48
    v_and_b32 v49, 3, v1
    v_lshl_add_u32 v48, v49, 3, v48
    v_add_u32 v48, 16384, v48
    v_bfe_u32 v49, v1, 2, 3
    s_lshl_b32 s90, s40, 2
    v_xor_b32 v49, s90, v49
    v_xor_b32 v50, 0, v49
    v_lshl_add_u32 v12, v50, 5, v48
    v_xor_b32 v50, 1, v49
    v_lshl_add_u32 v13, v50, 5, v48
    v_xor_b32 v50, 2, v49
    v_lshl_add_u32 v14, v50, 5, v48
    v_xor_b32 v50, 3, v49
    v_lshl_add_u32 v15, v50, 5, v48
    v_and_b32 v48, 15, v1
    v_lshlrev_b32 v48, 12, v48
    v_lshlrev_b32 v48, s95, v48
    v_bfe_u32 v49, v1, 4, 1
    v_lshl_add_u32 v48, v49, 5, v48
    v_lshrrev_b32 v49, 5, v1
    v_lshl_add_u32 v7, v49, 4, v48
    s_lshl_b32 s90, s96, 3
    s_lshl_b32 s91, s53, 2
    s_add_u32 s90, s90, s91
    s_lshl_b32 s91, s90, 16
    s_add_u32 s91, s91, 2048
    s_and_b32 s92, s90, 63
    s_lshl_b32 s92, s92, 17
    s_lshr_b32 s93, s90, 6
    s_lshl_b32 s93, s93, 12
    s_add_u32 s92, s92, s93
    s_cmp_eq_u32 s95, 1
    s_cselect_b32 s71, s92, s91
    s_lshl_b32 s72, 0x10000, s95
    s_lshl_b32 s92, s97, 8
    s_lshl_b32 s93, s40, 7
    s_add_u32 s71, s71, s92
    s_add_u32 s71, s71, s93
    v_mov_b64 v[64:65], 0
    v_mov_b64 v[66:67], 0
    v_mov_b64 v[68:69], 0
    v_mov_b64 v[70:71], 0
    v_mov_b64 v[72:73], 0
    v_mov_b64 v[74:75], 0
    v_mov_b64 v[76:77], 0
    v_mov_b64 v[78:79], 0
    v_mov_b64 v[80:81], 0
    v_mov_b64 v[82:83], 0
    v_mov_b64 v[84:85], 0
    v_mov_b64 v[86:87], 0
    v_mov_b64 v[88:89], 0
    v_mov_b64 v[90:91], 0
    v_mov_b64 v[92:93], 0
    v_mov_b64 v[94:95], 0
    v_mov_b64 v[96:97], 0
    v_mov_b64 v[98:99], 0
    v_mov_b64 v[100:101], 0
    v_mov_b64 v[102:103], 0
    v_mov_b64 v[104:105], 0
    v_mov_b64 v[106:107], 0
    v_mov_b64 v[108:109], 0
    v_mov_b64 v[110:111], 0
    v_mov_b64 v[112:113], 0
    v_mov_b64 v[114:115], 0
    v_mov_b64 v[116:117], 0
    v_mov_b64 v[118:119], 0
    v_mov_b64 v[120:121], 0
    v_mov_b64 v[122:123], 0
    v_mov_b64 v[124:125], 0
    v_mov_b64 v[126:127], 0
    v_and_b32 v48, 15, v1
    v_lshrrev_b32 v49, 4, v1
    v_lshlrev_b32 v49, 2, v49
    v_sub_u32 v48, v48, v49
    v_cmp_ge_i32 vcc, -9, v48
    v_subrev_u32 v50, 0, v48
    v_cmp_ge_u32 s[76:77], 7, v50
    s_nop 0
    v_cndmask_b32 v128, v9, 0, vcc
    v_cndmask_b32 v132, v9, 0, s[76:77]
    v_cmp_ge_i32 vcc, -8, v48
    v_subrev_u32 v50, 1, v48
    v_cmp_ge_u32 s[76:77], 7, v50
    s_nop 0
    v_cndmask_b32 v129, v9, 0, vcc
    v_cndmask_b32 v133, v9, 0, s[76:77]
    v_cmp_ge_i32 vcc, -7, v48
    v_subrev_u32 v50, 2, v48
    v_cmp_ge_u32 s[76:77], 7, v50
    s_nop 0
    v_cndmask_b32 v130, v9, 0, vcc
    v_cndmask_b32 v134, v9, 0, s[76:77]
    v_cmp_ge_i32 vcc, -6, v48
    v_subrev_u32 v50, 3, v48
    v_cmp_ge_u32 s[76:77], 7, v50
    s_nop 0
    v_cndmask_b32 v131, v9, 0, vcc
    v_cndmask_b32 v135, v9, 0, s[76:77]
    s_cmp_eq_u32 s81, 0
    s_cselect_b64 vcc, -1, 0
    s_nop 0
    v_cndmask_b32 v136, v128, v9, vcc
    v_cndmask_b32 v137, v129, v9, vcc
    v_cndmask_b32 v138, v130, v9, vcc
    v_cndmask_b32 v139, v131, v9, vcc
    s_lshl_b32 s90, s80, 10
    s_lshr_b32 s91, s2, 3
    s_lshl_b32 s91, s91, 17
    s_add_u32 s90, s90, s91
    s_add_u32 s80, s90, 83886080
    s_add_u32 s59, s60, 131072
    s_mov_b32 s58, 0
    s_mov_b32 s100, 32768
    s_mov_b32 s64, 0
    s_mov_b32 s67, 0
    s_waitcnt vmcnt(36)
    s_cmp_eq_u32 s99, 1
    s_cbranch_scc1 m_x2120
    s_waitcnt vmcnt(16)
m_x2120:
    s_barrier
    s_lshl_b32 s91, s33, 5
    s_add_u32 s91, s91, s32
    s_lshl_b32 s91, s91, 3
    s_add_u32 s91, s91, 7936
    s_cmp_lg_u32 s16, 0
    s_cbranch_scc1 m_np122
    v_mov_b32 v60, s4
    v_mov_b32 v61, s5
    s_add_u32 s90, s91, 117440512
    s_mov_b64 exec, 1
    buffer_store_dwordx2 v[60:61], off, s[8:11], s90 sc1
    s_mov_b64 exec, -1
m_np122:
    s_cmp_eq_u32 s101, -1
    s_cbranch_scc1 m_pb123
    s_cmp_lg_u32 s16, 0
    s_cbranch_scc1 m_np124
    v_mov_b32 v60, s4
    v_mov_b32 v61, s5
    s_add_u32 s90, s101, 117440512
    s_mov_b64 exec, 1
    buffer_store_dwordx2 v[60:61], off, s[8:11], s90 sc1
    s_mov_b64 exec, -1
m_np124:
m_pb123:
    s_cmp_eq_u32 s99, 1
    s_cbranch_scc1 m_x3121
    s_mov_b32 s3, 1048576
m_spin126:
    buffer_load_dwordx2 v[4:5], v10, s[8:11], s52 offen sc1
    s_waitcnt vmcnt(0)
    v_cmp_ne_u64 s[76:77], s[4:5], v[4:5]
    s_mul_i32 s91, s95, 20
    s_nop 2
    s_lshr_b32 s90, s76, s91
    s_ff1_i32_b32 s90, s90
    s_lshl_b32 s68, s90, 1
    s_mul_i32 s91, s95, 0
    s_sub_i32 s68, s68, s91
    s_cmp_lt_i32 s90, 0
    s_cselect_b32 s68, 1000, s68
    s_cmp_gt_i32 s68, 4
    s_cbranch_scc1 m_ok127
    s_sub_u32 s3, s3, 1
    s_cbranch_scc1 m_ok127
    s_sleep 4
    s_branch m_spin126
m_ok127:
    s_add_u32 m0, s60, 0
    s_nop 0
    buffer_load_dwordx4 v2, s[36:39], s56 offen offset:0 sc1 lds
    buffer_load_dwordx4 v2, s[36:39], s56 offen offset:1024 sc1 lds
    buffer_load_dwordx4 v2, s[36:39], s56 offen offset:2048 sc1 lds
    buffer_load_dwordx4 v2, s[36:39], s56 offen offset:3072 sc1 lds
    s_add_u32 s56, s56, 262144
    s_add_u32 m0, s60, 32768
    s_nop 0
    buffer_load_dwordx4 v2, s[36:39], s56 offen offset:0 sc1 lds
    buffer_load_dwordx4 v2, s[36:39], s56 offen offset:1024 sc1 lds
    buffer_load_dwordx4 v2, s[36:39], s56 offen offset:2048 sc1 lds
    buffer_load_dwordx4 v2, s[36:39], s56 offen offset:3072 sc1 lds
    s_add_u32 s56, s56, 262144
    s_add_u32 m0, s60, 65536
    s_nop 0
    buffer_load_dwordx4 v2, s[36:39], s56 offen offset:0 sc1 lds
    buffer_load_dwordx4 v2, s[36:39], s56 offen offset:1024 sc1 lds
    buffer_load_dwordx4 v2, s[36:39], s56 offen offset:2048 sc1 lds
    buffer_load_dwordx4 v2, s[36:39], s56 offen offset:3072 sc1 lds
    s_add_u32 s56, s56, 262144
    s_add_u32 m0, s60, 98304
    s_nop 0
    buffer_load_dwordx4 v2, s[36:39], s56 offen offset:0 sc1 lds
    buffer_load_dwordx4 v2, s[36:39], s56 offen offset:1024 sc1 lds
    buffer_load_dwordx4 v2, s[36:39], s56 offen offset:2048 sc1 lds
    buffer_load_dwordx4 v2, s[36:39], s56 offen offset:3072 sc1 lds
    s_add_u32 s56, s56, 262144
    s_add_u32 m0, s60, 131072
    s_nop 0
    buffer_load_dwordx4 v2, s[36:39], s56 offen offset:0 sc1 lds
    buffer_load_dwordx4 v2, s[36:39], s56 offen offset:1024 sc1 lds
    buffer_load_dwordx4 v2, s[36:39], s56 offen offset:2048 sc1 lds
    buffer_load_dwordx4 v2, s[36:39], s56 offen offset:3072 sc1 lds
    s_add_u32 s56, s56, 262144
    s_waitcnt vmcnt(4)
    s_branch m_x4125
m_x3121:
    s_waitcnt vmcnt(4)
m_x4125:
    s_barrier
    ds_read_b128 a[0:3], v6 offset:0
    ds_read_b64_tr_b16 a[16:17], v12 offset:0
    ds_read_b64_tr_b16 a[18:19], v12 offset:4096
    ds_read_b128 a[4:7], v6 offset:1024
    ds_read_b128 a[8:11], v6 offset:2048
    ds_read_b128 a[12:15], v6 offset:3072
    ds_read_b64_tr_b16 a[20:21], v13 offset:0
    ds_read_b64_tr_b16 a[22:23], v13 offset:4096
    ds_read_b64_tr_b16 a[24:25], v14 offset:0
    ds_read_b64_tr_b16 a[26:27], v14 offset:4096
    ds_read_b64_tr_b16 a[28:29], v15 offset:0
    ds_read_b64_tr_b16 a[30:31], v15 offset:4096
    s_cmp_gt_i32 s68, 5
    s_cbranch_scc0 m_lp133
m_lr134:
    s_waitcnt lgkmcnt(9)
    v_mfma_f32_16x16x32_bf16 v[64:67], a[16:19], a[0:3], v[64:67]
    s_add_u32 m0, s59, 16384
    ds_read_b128 a[32:35], v6 offset:8192
    v_mfma_f32_16x16x32_bf16 v[148:151], v[208:211], v[192:195], v[136:139]
    v_mfma_f32_16x16x32_bf16 v[152:155], v[212:215], v[192:195], v[132:135]
    s_waitcnt lgkmcnt(9)
    v_mfma_f32_16x16x32_bf16 v[72:75], a[16:19], a[4:7], v[72:75]
    ds_read_b64_tr_b16 a[48:49], v12 offset:8192
    buffer_load_dwordx4 v16, s[24:27], s57 offen offset:0 sc1 lds
    v_mfma_f32_16x16x32_bf16 v[156:159], v[212:215], v[196:199], v[128:131]
    s_waitcnt lgkmcnt(9)
    v_mfma_f32_16x16x32_bf16 v[80:83], a[16:19], a[8:11], v[80:83]
    s_add_u32 s59, s58, s60
    ds_read_b64_tr_b16 a[50:51], v12 offset:12288
    v_mfma_f32_16x16x32_bf16 v[160:163], v[216:219], v[196:199], v[132:135]
    v_mfma_f32_16x16x32_bf16 v[164:167], v[216:219], v[200:203], v[128:131]
    s_waitcnt lgkmcnt(9)
    v_mfma_f32_16x16x32_bf16 v[88:91], a[16:19], a[12:15], v[88:91]
    s_add_u32 s58, s58, 32768
    ds_read_b128 a[36:39], v6 offset:9216
    v_mfma_f32_16x16x32_bf16 v[168:171], v[220:223], v[200:203], v[132:135]
    v_mfma_f32_16x16x32_bf16 v[172:175], v[220:223], v[204:207], v[128:131]
    s_waitcnt lgkmcnt(8)
    v_mfma_f32_16x16x32_bf16 v[68:71], a[20:23], a[0:3], v[68:71]
    s_cmp_ge_u32 s58, 163840
    ds_read_b128 a[40:43], v6 offset:10240
    v_mfma_f32_16x16x32_bf16 v[176:179], v[224:227], v[204:207], v[132:135]
    s_nop 1
    v_mfma_f32_16x16x32_bf16 v[76:79], a[20:23], a[4:7], v[76:79]
    ds_read_b128 a[44:47], v6 offset:11264
    buffer_load_dwordx4 v17, s[24:27], s57 offen offset:1024 sc1 lds
    s_nop 1
    v_mfma_f32_16x16x32_bf16 v[84:87], a[20:23], a[8:11], v[84:87]
    s_cselect_b32 s66, 4294836224, s100
    ds_read_b64_tr_b16 a[52:53], v13 offset:8192
    s_nop 1
    s_nop 1
    v_mfma_f32_16x16x32_bf16 v[92:95], a[20:23], a[12:15], v[92:95]
    s_cselect_b32 s58, 0, s58
    ds_read_b64_tr_b16 a[54:55], v13 offset:12288
    v_max3_f32 v140, v148, v149, v150
    v_max3_f32 v141, v156, v157, v158
    s_waitcnt lgkmcnt(10)
    v_mfma_f32_16x16x32_bf16 v[96:99], a[24:27], a[0:3], v[96:99]
    ds_read_b64_tr_b16 a[56:57], v14 offset:8192
    v_max3_f32 v142, v164, v165, v166
    v_max3_f32 v143, v172, v173, v174
    v_mfma_f32_16x16x32_bf16 v[104:107], a[24:27], a[4:7], v[104:107]
    ds_read_b64_tr_b16 a[58:59], v14 offset:12288
    buffer_load_dwordx4 v18, s[24:27], s57 offen offset:2048 sc1 lds
    v_max3_f32 v140, v140, v151, v152
    v_mfma_f32_16x16x32_bf16 v[112:115], a[24:27], a[8:11], v[112:115]
    ds_read_b64_tr_b16 a[60:61], v15 offset:8192
    v_max3_f32 v141, v141, v159, v160
    v_max3_f32 v142, v142, v167, v168
    v_mfma_f32_16x16x32_bf16 v[120:123], a[24:27], a[12:15], v[120:123]
    ds_read_b64_tr_b16 a[62:63], v15 offset:12288
    v_max3_f32 v143, v143, v175, v176
    v_max3_f32 v140, v140, v153, v154
    s_waitcnt lgkmcnt(12)
    v_mfma_f32_16x16x32_bf16 v[100:103], a[28:31], a[0:3], v[100:103]
    v_add_u32 v6, s66, v6
    v_add_u32 v12, s66, v12
    v_max3_f32 v141, v141, v161, v162
    v_mfma_f32_16x16x32_bf16 v[108:111], a[28:31], a[4:7], v[108:111]
    buffer_load_dwordx4 v19, s[24:27], s57 offen offset:3072 sc1 lds
    v_max3_f32 v142, v142, v169, v170
    v_mfma_f32_16x16x32_bf16 v[116:119], a[28:31], a[8:11], v[116:119]
    s_add_u32 s57, s57, 131072
    v_add_u32 v13, s66, v13
    v_add_u32 v14, s66, v14
    v_max3_f32 v143, v143, v177, v178
    v_mfma_f32_16x16x32_bf16 v[124:127], a[28:31], a[12:15], v[124:127]
    s_mov_b32 m0, s59
    v_add_u32 v15, s66, v15
    v_max_f32 v140, v140, v155
    s_waitcnt vmcnt(24) lgkmcnt(0)
    v_mfma_f32_16x16x32_bf16 v[64:67], a[48:51], a[32:35], v[64:67]
    s_barrier
    v_max_f32 v141, v141, v163
    v_max_f32 v142, v142, v171
    v_mfma_f32_16x16x32_bf16 v[72:75], a[48:51], a[36:39], v[72:75]
    ds_read_b128 a[0:3], v6 offset:0
    buffer_load_dwordx4 v2, s[36:39], s56 offen offset:0 sc1 lds
    v_max_f32 v143, v143, v179
    v_mfma_f32_16x16x32_bf16 v[80:83], a[48:51], a[40:43], v[80:83]
    ds_read_b64_tr_b16 a[16:17], v12 offset:0
    v_mov_b32 v144, v140
    v_mov_b32 v145, v141
    v_mfma_f32_16x16x32_bf16 v[88:91], a[48:51], a[44:47], v[88:91]
    ds_read_b64_tr_b16 a[18:19], v12 offset:4096
    v_mov_b32 v146, v142
    v_mov_b32 v147, v143
    v_mfma_f32_16x16x32_bf16 v[68:71], a[52:55], a[32:35], v[68:71]
    ds_read_b128 a[4:7], v6 offset:1024
    s_nop 1
    v_permlane32_swap_b32 v140, v144
    v_mfma_f32_16x16x32_bf16 v[76:79], a[52:55], a[36:39], v[76:79]
    ds_read_b128 a[8:11], v6 offset:2048
    buffer_load_dwordx4 v2, s[36:39], s56 offen offset:1024 sc1 lds
    v_permlane32_swap_b32 v141, v145
    v_mfma_f32_16x16x32_bf16 v[84:87], a[52:55], a[40:43], v[84:87]
    ds_read_b128 a[12:15], v6 offset:3072
    v_permlane32_swap_b32 v142, v146
    v_permlane32_swap_b32 v143, v147
    v_mfma_f32_16x16x32_bf16 v[92:95], a[52:55], a[44:47], v[92:95]
    ds_read_b64_tr_b16 a[20:21], v13 offset:0
    s_nop 1
    v_max_f32 v140, v140, v144
    v_mfma_f32_16x16x32_bf16 v[96:99], a[56:59], a[32:35], v[96:99]
    ds_read_b64_tr_b16 a[22:23], v13 offset:4096
    v_max_f32 v141, v141, v145
    v_max_f32 v142, v142, v146
    v_mfma_f32_16x16x32_bf16 v[104:107], a[56:59], a[36:39], v[104:107]
    ds_read_b64_tr_b16 a[24:25], v14 offset:0
    buffer_load_dwordx4 v2, s[36:39], s56 offen offset:2048 sc1 lds
    v_max_f32 v143, v143, v147
    v_mfma_f32_16x16x32_bf16 v[112:115], a[56:59], a[40:43], v[112:115]
    ds_read_b64_tr_b16 a[26:27], v14 offset:4096
    v_mov_b32 v144, v140
    v_mov_b32 v145, v141
    v_mfma_f32_16x16x32_bf16 v[120:123], a[56:59], a[44:47], v[120:123]
    ds_read_b64_tr_b16 a[28:29], v15 offset:0
    v_mov_b32 v146, v142
    v_mov_b32 v147, v143
    v_mfma_f32_16x16x32_bf16 v[100:103], a[60:63], a[32:35], v[100:103]
    s_add_u32 s64, s64, 1
    ds_read_b64_tr_b16 a[30:31], v15 offset:4096
    s_nop 1
    v_permlane16_swap_b32 v140, v144
    v_mfma_f32_16x16x32_bf16 v[108:111], a[60:63], a[36:39], v[108:111]
    buffer_load_dwordx4 v2, s[36:39], s56 offen offset:3072 sc1 lds
    v_permlane16_swap_b32 v141, v145
    v_mfma_f32_16x16x32_bf16 v[116:119], a[60:63], a[40:43], v[116:119]
    s_add_u32 s56, s56, 262144
    v_permlane16_swap_b32 v142, v146
    v_permlane16_swap_b32 v143, v147
    v_mfma_f32_16x16x32_bf16 v[124:127], a[60:63], a[44:47], v[124:127]
    s_nop 1
    v_max_f32 v140, v140, v144
    s_cmp_gt_i32 s68, 6
    s_cbranch_scc0 m_lp135
m_lr136:
    s_waitcnt lgkmcnt(9)
    v_mfma_f32_16x16x32_bf16 v[64:67], a[16:19], a[0:3], v[64:67]
    s_add_u32 m0, s59, 16384
    ds_read_b128 a[32:35], v6 offset:8192
    v_max_f32 v141, v141, v145
    v_max_f32 v142, v142, v146
    s_waitcnt lgkmcnt(9)
    v_mfma_f32_16x16x32_bf16 v[72:75], a[16:19], a[4:7], v[72:75]
    ds_read_b64_tr_b16 a[48:49], v12 offset:8192
    buffer_load_dwordx4 v16, s[24:27], s57 offen offset:0 sc1 lds
    v_max_f32 v143, v143, v147
    s_waitcnt lgkmcnt(9)
    v_mfma_f32_16x16x32_bf16 v[80:83], a[16:19], a[8:11], v[80:83]
    s_add_u32 s59, s58, s60
    ds_read_b64_tr_b16 a[50:51], v12 offset:12288
    v_sub_f32 v148, v148, v140
    v_sub_f32 v149, v149, v140
    s_waitcnt lgkmcnt(9)
    v_mfma_f32_16x16x32_bf16 v[88:91], a[16:19], a[12:15], v[88:91]
    s_add_u32 s58, s58, 32768
    ds_read_b128 a[36:39], v6 offset:9216
    v_sub_f32 v150, v150, v140
    v_sub_f32 v151, v151, v140
    s_waitcnt lgkmcnt(8)
    v_mfma_f32_16x16x32_bf16 v[68:71], a[20:23], a[0:3], v[68:71]
    s_cmp_ge_u32 s58, 163840
    ds_read_b128 a[40:43], v6 offset:10240
    v_sub_f32 v152, v152, v140
    v_sub_f32 v153, v153, v140
    v_mfma_f32_16x16x32_bf16 v[76:79], a[20:23], a[4:7], v[76:79]
    ds_read_b128 a[44:47], v6 offset:11264
    buffer_load_dwordx4 v17, s[24:27], s57 offen offset:1024 sc1 lds
    v_sub_f32 v154, v154, v140
    v_mfma_f32_16x16x32_bf16 v[84:87], a[20:23], a[8:11], v[84:87]
    s_cselect_b32 s66, 4294836224, s100
    ds_read_b64_tr_b16 a[52:53], v13 offset:8192
    v_sub_f32 v155, v155, v140
    v_sub_f32 v156, v156, v141
    v_mfma_f32_16x16x32_bf16 v[92:95], a[20:23], a[12:15], v[92:95]
    s_cselect_b32 s58, 0, s58
    ds_read_b64_tr_b16 a[54:55], v13 offset:12288
    v_sub_f32 v157, v157, v141
    v_sub_f32 v158, v158, v141
    s_waitcnt lgkmcnt(10)
    v_mfma_f32_16x16x32_bf16 v[96:99], a[24:27], a[0:3], v[96:99]
    ds_read_b64_tr_b16 a[56:57], v14 offset:8192
    v_sub_f32 v159, v159, v141
    v_sub_f32 v160, v160, v141
    v_mfma_f32_16x16x32_bf16 v[104:107], a[24:27], a[4:7], v[104:107]
    ds_read_b64_tr_b16 a[58:59], v14 offset:12288
    buffer_load_dwordx4 v18, s[24:27], s57 offen offset:2048 sc1 lds
    v_sub_f32 v161, v161, v141
    v_mfma_f32_16x16x32_bf16 v[112:115], a[24:27], a[8:11], v[112:115]
    ds_read_b64_tr_b16 a[60:61], v15 offset:8192
    v_sub_f32 v162, v162, v141
    v_sub_f32 v163, v163, v141
    v_mfma_f32_16x16x32_bf16 v[120:123], a[24:27], a[12:15], v[120:123]
    ds_read_b64_tr_b16 a[62:63], v15 offset:12288
    v_sub_f32 v164, v164, v142
    v_sub_f32 v165, v165, v142
    s_waitcnt lgkmcnt(12)
    v_mfma_f32_16x16x32_bf16 v[100:103], a[28:31], a[0:3], v[100:103]
    v_add_u32 v6, s66, v6
    v_add_u32 v12, s66, v12
    v_sub_f32 v166, v166, v142
    v_mfma_f32_16x16x32_bf16 v[108:111], a[28:31], a[4:7], v[108:111]
    buffer_load_dwordx4 v19, s[24:27], s57 offen offset:3072 sc1 lds
    v_sub_f32 v167, v167, v142
    v_mfma_f32_16x16x32_bf16 v[116:119], a[28:31], a[8:11], v[116:119]
    s_add_u32 s57, s57, 131072
    v_add_u32 v13, s66, v13
    v_add_u32 v14, s66, v14
    v_sub_f32 v168, v168, v142
    v_mfma_f32_16x16x32_bf16 v[124:127], a[28:31], a[12:15], v[124:127]
    s_mov_b32 m0, s59
    v_add_u32 v15, s66, v15
    v_sub_f32 v169, v169, v142
    s_waitcnt vmcnt(24) lgkmcnt(0)
    v_mfma_f32_16x16x32_bf16 v[64:67], a[48:51], a[32:35], v[64:67]
    s_barrier
    v_sub_f32 v170, v170, v142
    v_sub_f32 v171, v171, v142
    v_mfma_f32_16x16x32_bf16 v[72:75], a[48:51], a[36:39], v[72:75]
    ds_read_b128 a[0:3], v6 offset:0
    buffer_load_dwordx4 v2, s[36:39], s56 offen offset:0 sc1 lds
    v_sub_f32 v172, v172, v143
    v_mfma_f32_16x16x32_bf16 v[80:83], a[48:51], a[40:43], v[80:83]
    ds_read_b64_tr_b16 a[16:17], v12 offset:0
    v_sub_f32 v173, v173, v143
    v_sub_f32 v174, v174, v143
    v_mfma_f32_16x16x32_bf16 v[88:91], a[48:51], a[44:47], v[88:91]
    ds_read_b64_tr_b16 a[18:19], v12 offset:4096
    v_sub_f32 v175, v175, v143
    v_sub_f32 v176, v176, v143
    v_mfma_f32_16x16x32_bf16 v[68:71], a[52:55], a[32:35], v[68:71]
    ds_read_b128 a[4:7], v6 offset:1024
    v_sub_f32 v177, v177, v143
    v_sub_f32 v178, v178, v143
    v_mfma_f32_16x16x32_bf16 v[76:79], a[52:55], a[36:39], v[76:79]
    ds_read_b128 a[8:11], v6 offset:2048
    buffer_load_dwordx4 v2, s[36:39], s56 offen offset:1024 sc1 lds
    v_sub_f32 v179, v179, v143
    v_mfma_f32_16x16x32_bf16 v[84:87], a[52:55], a[40:43], v[84:87]
    ds_read_b128 a[12:15], v6 offset:3072
    v_exp_f32 v148, v148
    v_exp_f32 v149, v149
    v_mfma_f32_16x16x32_bf16 v[92:95], a[52:55], a[44:47], v[92:95]
    ds_read_b64_tr_b16 a[20:21], v13 offset:0
    v_exp_f32 v150, v150
    v_exp_f32 v151, v151
    v_mfma_f32_16x16x32_bf16 v[96:99], a[56:59], a[32:35], v[96:99]
    ds_read_b64_tr_b16 a[22:23], v13 offset:4096
    v_exp_f32 v152, v152
    v_exp_f32 v153, v153
    v_mfma_f32_16x16x32_bf16 v[104:107], a[56:59], a[36:39], v[104:107]
    ds_read_b64_tr_b16 a[24:25], v14 offset:0
    buffer_load_dwordx4 v2, s[36:39], s56 offen offset:2048 sc1 lds
    v_exp_f32 v154, v154
    v_mfma_f32_16x16x32_bf16 v[112:115], a[56:59], a[40:43], v[112:115]
    ds_read_b64_tr_b16 a[26:27], v14 offset:4096
    v_exp_f32 v155, v155
    v_exp_f32 v156, v156
    v_mfma_f32_16x16x32_bf16 v[120:123], a[56:59], a[44:47], v[120:123]
    ds_read_b64_tr_b16 a[28:29], v15 offset:0
    v_exp_f32 v157, v157
    v_exp_f32 v158, v158
    v_mfma_f32_16x16x32_bf16 v[100:103], a[60:63], a[32:35], v[100:103]
    s_add_u32 s64, s64, 1
    ds_read_b64_tr_b16 a[30:31], v15 offset:4096
    v_exp_f32 v159, v159
    v_exp_f32 v160, v160
    v_mfma_f32_16x16x32_bf16 v[108:111], a[60:63], a[36:39], v[108:111]
    buffer_load_dwordx4 v2, s[36:39], s56 offen offset:3072 sc1 lds
    v_exp_f32 v161, v161
    v_mfma_f32_16x16x32_bf16 v[116:119], a[60:63], a[40:43], v[116:119]
    s_add_u32 s56, s56, 262144
    v_exp_f32 v162, v162
    v_exp_f32 v163, v163
    v_mfma_f32_16x16x32_bf16 v[124:127], a[60:63], a[44:47], v[124:127]
    v_exp_f32 v164, v164
    v_exp_f32 v165, v165
    s_cmp_gt_i32 s68, 7
    s_cbranch_scc0 m_lp137
m_lr138:
    s_waitcnt lgkmcnt(9)
    v_mfma_f32_16x16x32_bf16 v[64:67], a[16:19], a[0:3], v[64:67]
    s_add_u32 m0, s59, 16384
    ds_read_b128 a[32:35], v6 offset:8192
    v_exp_f32 v166, v166
    v_exp_f32 v167, v167
    s_waitcnt lgkmcnt(9)
    v_mfma_f32_16x16x32_bf16 v[72:75], a[16:19], a[4:7], v[72:75]
    ds_read_b64_tr_b16 a[48:49], v12 offset:8192
    buffer_load_dwordx4 v16, s[24:27], s57 offen offset:0 sc1 lds
    v_exp_f32 v168, v168
    s_waitcnt lgkmcnt(9)
    v_mfma_f32_16x16x32_bf16 v[80:83], a[16:19], a[8:11], v[80:83]
    s_add_u32 s59, s58, s60
    ds_read_b64_tr_b16 a[50:51], v12 offset:12288
    v_exp_f32 v169, v169
    v_exp_f32 v170, v170
    s_waitcnt lgkmcnt(9)
    v_mfma_f32_16x16x32_bf16 v[88:91], a[16:19], a[12:15], v[88:91]
    s_add_u32 s58, s58, 32768
    ds_read_b128 a[36:39], v6 offset:9216
    v_exp_f32 v171, v171
    v_exp_f32 v172, v172
    s_waitcnt lgkmcnt(8)
    v_mfma_f32_16x16x32_bf16 v[68:71], a[20:23], a[0:3], v[68:71]
    s_cmp_ge_u32 s58, 163840
    ds_read_b128 a[40:43], v6 offset:10240
    v_exp_f32 v173, v173
    v_exp_f32 v174, v174
    v_mfma_f32_16x16x32_bf16 v[76:79], a[20:23], a[4:7], v[76:79]
    ds_read_b128 a[44:47], v6 offset:11264
    buffer_load_dwordx4 v17, s[24:27], s57 offen offset:1024 sc1 lds
    v_exp_f32 v175, v175
    v_mfma_f32_16x16x32_bf16 v[84:87], a[20:23], a[8:11], v[84:87]
    s_cselect_b32 s66, 4294836224, s100
    ds_read_b64_tr_b16 a[52:53], v13 offset:8192
    v_exp_f32 v176, v176
    v_exp_f32 v177, v177
    v_mfma_f32_16x16x32_bf16 v[92:95], a[20:23], a[12:15], v[92:95]
    s_cselect_b32 s58, 0, s58
    ds_read_b64_tr_b16 a[54:55], v13 offset:12288
    v_exp_f32 v178, v178
    v_exp_f32 v179, v179
    s_waitcnt lgkmcnt(10)
    v_mfma_f32_16x16x32_bf16 v[96:99], a[24:27], a[0:3], v[96:99]
    ds_read_b64_tr_b16 a[56:57], v14 offset:8192
    v_cvt_pk_bf16_f32 v192, v148, v149
    v_cvt_pk_bf16_f32 v193, v150, v151
    v_mfma_f32_16x16x32_bf16 v[104:107], a[24:27], a[4:7], v[104:107]
    ds_read_b64_tr_b16 a[58:59], v14 offset:12288
    buffer_load_dwordx4 v18, s[24:27], s57 offen offset:2048 sc1 lds
    v_cvt_pk_bf16_f32 v194, v152, v153
    v_mfma_f32_16x16x32_bf16 v[112:115], a[24:27], a[8:11], v[112:115]
    ds_read_b64_tr_b16 a[60:61], v15 offset:8192
    v_cvt_pk_bf16_f32 v195, v154, v155
    v_cvt_pk_bf16_f32 v196, v156, v157
    v_mfma_f32_16x16x32_bf16 v[120:123], a[24:27], a[12:15], v[120:123]
    ds_read_b64_tr_b16 a[62:63], v15 offset:12288
    v_cvt_pk_bf16_f32 v197, v158, v159
    v_cvt_pk_bf16_f32 v198, v160, v161
    s_waitcnt lgkmcnt(12)
    v_mfma_f32_16x16x32_bf16 v[100:103], a[28:31], a[0:3], v[100:103]
    v_add_u32 v6, s66, v6
    v_add_u32 v12, s66, v12
    v_cvt_pk_bf16_f32 v199, v162, v163
    v_mfma_f32_16x16x32_bf16 v[108:111], a[28:31], a[4:7], v[108:111]
    buffer_load_dwordx4 v19, s[24:27], s57 offen offset:3072 sc1 lds
    v_cvt_pk_bf16_f32 v200, v164, v165
    v_mfma_f32_16x16x32_bf16 v[116:119], a[28:31], a[8:11], v[116:119]
    s_add_u32 s57, s57, 131072
    v_add_u32 v13, s66, v13
    v_add_u32 v14, s66, v14
    v_cvt_pk_bf16_f32 v201, v166, v167
    v_mfma_f32_16x16x32_bf16 v[124:127], a[28:31], a[12:15], v[124:127]
    s_mov_b32 m0, s59
    v_add_u32 v15, s66, v15
    v_cvt_pk_bf16_f32 v202, v168, v169
    s_waitcnt vmcnt(24) lgkmcnt(0)
    v_mfma_f32_16x16x32_bf16 v[64:67], a[48:51], a[32:35], v[64:67]
    s_barrier
    v_cvt_pk_bf16_f32 v203, v170, v171
    v_cvt_pk_bf16_f32 v204, v172, v173
    v_mfma_f32_16x16x32_bf16 v[72:75], a[48:51], a[36:39], v[72:75]
    ds_read_b128 a[0:3], v6 offset:0
    buffer_load_dwordx4 v2, s[36:39], s56 offen offset:0 sc1 lds
    v_cvt_pk_bf16_f32 v205, v174, v175
    v_mfma_f32_16x16x32_bf16 v[80:83], a[48:51], a[40:43], v[80:83]
    ds_read_b64_tr_b16 a[16:17], v12 offset:0
    v_cvt_pk_bf16_f32 v206, v176, v177
    v_cvt_pk_bf16_f32 v207, v178, v179
    v_mfma_f32_16x16x32_bf16 v[88:91], a[48:51], a[44:47], v[88:91]
    ds_read_b64_tr_b16 a[18:19], v12 offset:4096
    s_nop 1
    v_mfma_f32_16x16x32_bf16 v[20:23], v[44:47], v[192:195], 0
    v_mfma_f32_16x16x32_bf16 v[68:71], a[52:55], a[32:35], v[68:71]
    ds_read_b128 a[4:7], v6 offset:1024
    v_mfma_f32_16x16x32_bf16 v[24:27], v[44:47], v[196:199], 0
    v_mfma_f32_16x16x32_bf16 v[28:31], v[44:47], v[200:203], 0
    v_mfma_f32_16x16x32_bf16 v[76:79], a[52:55], a[36:39], v[76:79]
    ds_read_b128 a[8:11], v6 offset:2048
    buffer_load_dwordx4 v2, s[36:39], s56 offen offset:1024 sc1 lds
    v_mfma_f32_16x16x32_bf16 v[32:35], v[44:47], v[204:207], 0
    v_mfma_f32_16x16x32_bf16 v[84:87], a[52:55], a[40:43], v[84:87]
    ds_read_b128 a[12:15], v6 offset:3072
    v_mfma_f32_16x16x32_bf16 v[148:151], v[230:233], v[192:195], 0
    v_mfma_f32_16x16x32_bf16 v[152:155], v[242:245], v[192:195], 0
    v_mfma_f32_16x16x32_bf16 v[92:95], a[52:55], a[44:47], v[92:95]
    ds_read_b64_tr_b16 a[20:21], v13 offset:0
    v_mfma_f32_16x16x32_bf16 v[156:159], v[232:235], v[196:199], 0
    v_mfma_f32_16x16x32_bf16 v[160:163], v[244:247], v[196:199], 0
    v_mfma_f32_16x16x32_bf16 v[96:99], a[56:59], a[32:35], v[96:99]
    ds_read_b64_tr_b16 a[22:23], v13 offset:4096
    v_mfma_f32_16x16x32_bf16 v[164:167], v[234:237], v[200:203], 0
    v_mfma_f32_16x16x32_bf16 v[168:171], v[246:249], v[200:203], 0
    v_mfma_f32_16x16x32_bf16 v[104:107], a[56:59], a[36:39], v[104:107]
    ds_read_b64_tr_b16 a[24:25], v14 offset:0
    buffer_load_dwordx4 v2, s[36:39], s56 offen offset:2048 sc1 lds
    v_mfma_f32_16x16x32_bf16 v[172:175], v[236:239], v[204:207], 0
    v_mfma_f32_16x16x32_bf16 v[112:115], a[56:59], a[40:43], v[112:115]
    ds_read_b64_tr_b16 a[26:27], v14 offset:4096
    v_mfma_f32_16x16x32_bf16 v[176:179], v[248:251], v[204:207], 0
    v_rcp_f32 v140, v20
    v_mfma_f32_16x16x32_bf16 v[120:123], a[56:59], a[44:47], v[120:123]
    ds_read_b64_tr_b16 a[28:29], v15 offset:0
    v_rcp_f32 v141, v24
    v_rcp_f32 v142, v28
    v_mfma_f32_16x16x32_bf16 v[100:103], a[60:63], a[32:35], v[100:103]
    s_add_u32 s64, s64, 1
    ds_read_b64_tr_b16 a[30:31], v15 offset:4096
    v_rcp_f32 v143, v32
    s_nop 1
    v_mfma_f32_16x16x32_bf16 v[108:111], a[60:63], a[36:39], v[108:111]
    buffer_load_dwordx4 v2, s[36:39], s56 offen offset:3072 sc1 lds
    s_nop 1
    v_mfma_f32_16x16x32_bf16 v[116:119], a[60:63], a[40:43], v[116:119]
    s_add_u32 s56, s56, 262144
    v_mul_f32 v148, v148, v140
    v_mul_f32 v149, v149, v140
    v_mfma_f32_16x16x32_bf16 v[124:127], a[60:63], a[44:47], v[124:127]
    v_mul_f32 v150, v150, v140
    v_mul_f32 v151, v151, v140
    s_cmp_gt_i32 s68, 8
    s_cbranch_scc0 m_lp139
m_lr140:
    s_waitcnt lgkmcnt(9)
    v_mfma_f32_16x16x32_bf16 v[64:67], a[16:19], a[0:3], v[64:67]
    s_add_u32 m0, s59, 16384
    ds_read_b128 a[32:35], v6 offset:8192
    v_mul_f32 v152, v152, v140
    v_mul_f32 v153, v153, v140
    s_waitcnt lgkmcnt(9)
    v_mfma_f32_16x16x32_bf16 v[72:75], a[16:19], a[4:7], v[72:75]
    ds_read_b64_tr_b16 a[48:49], v12 offset:8192
    buffer_load_dwordx4 v16, s[24:27], s57 offen offset:0 sc1 lds
    v_mul_f32 v154, v154, v140
    s_waitcnt lgkmcnt(9)
    v_mfma_f32_16x16x32_bf16 v[80:83], a[16:19], a[8:11], v[80:83]
    s_add_u32 s59, s58, s60
    ds_read_b64_tr_b16 a[50:51], v12 offset:12288
    v_mul_f32 v155, v155, v140
    v_cvt_pk_bf16_f32 v148, v148, v149
    s_waitcnt lgkmcnt(9)
    v_mfma_f32_16x16x32_bf16 v[88:91], a[16:19], a[12:15], v[88:91]
    s_add_u32 s58, s58, 32768
    ds_read_b128 a[36:39], v6 offset:9216
    v_cvt_pk_bf16_f32 v149, v150, v151
    v_cvt_pk_bf16_f32 v150, v152, v153
    s_waitcnt lgkmcnt(8)
    v_mfma_f32_16x16x32_bf16 v[68:71], a[20:23], a[0:3], v[68:71]
    s_cmp_ge_u32 s58, 163840
    ds_read_b128 a[40:43], v6 offset:10240
    v_cvt_pk_bf16_f32 v151, v154, v155
    buffer_store_dwordx4 v[148:151], v2, s[8:11], s80 offen offset:0 sc1
    v_mfma_f32_16x16x32_bf16 v[76:79], a[20:23], a[4:7], v[76:79]
    ds_read_b128 a[44:47], v6 offset:11264
    buffer_load_dwordx4 v17, s[24:27], s57 offen offset:1024 sc1 lds
    v_mul_f32 v156, v156, v141
    v_mfma_f32_16x16x32_bf16 v[84:87], a[20:23], a[8:11], v[84:87]
    s_cselect_b32 s66, 4294836224, s100
    ds_read_b64_tr_b16 a[52:53], v13 offset:8192
    v_mul_f32 v157, v157, v141
    v_mul_f32 v158, v158, v141
    v_mfma_f32_16x16x32_bf16 v[92:95], a[20:23], a[12:15], v[92:95]
    s_cselect_b32 s58, 0, s58
    ds_read_b64_tr_b16 a[54:55], v13 offset:12288
    v_mul_f32 v159, v159, v141
    v_mul_f32 v160, v160, v141
    s_waitcnt lgkmcnt(10)
    v_mfma_f32_16x16x32_bf16 v[96:99], a[24:27], a[0:3], v[96:99]
    ds_read_b64_tr_b16 a[56:57], v14 offset:8192
    v_mul_f32 v161, v161, v141
    v_mul_f32 v162, v162, v141
    v_mfma_f32_16x16x32_bf16 v[104:107], a[24:27], a[4:7], v[104:107]
    ds_read_b64_tr_b16 a[58:59], v14 offset:12288
    buffer_load_dwordx4 v18, s[24:27], s57 offen offset:2048 sc1 lds
    v_mul_f32 v163, v163, v141
    v_mfma_f32_16x16x32_bf16 v[112:115], a[24:27], a[8:11], v[112:115]
    ds_read_b64_tr_b16 a[60:61], v15 offset:8192
    v_cvt_pk_bf16_f32 v156, v156, v157
    v_cvt_pk_bf16_f32 v157, v158, v159
    v_mfma_f32_16x16x32_bf16 v[120:123], a[24:27], a[12:15], v[120:123]
    ds_read_b64_tr_b16 a[62:63], v15 offset:12288
    v_cvt_pk_bf16_f32 v158, v160, v161
    v_cvt_pk_bf16_f32 v159, v162, v163
    s_waitcnt lgkmcnt(12)
    v_mfma_f32_16x16x32_bf16 v[100:103], a[28:31], a[0:3], v[100:103]
    v_add_u32 v6, s66, v6
    v_add_u32 v12, s66, v12
    buffer_store_dwordx4 v[156:159], v2, s[8:11], s80 offen offset:1024 sc1
    v_mfma_f32_16x16x32_bf16 v[108:111], a[28:31], a[4:7], v[108:111]
    buffer_load_dwordx4 v19, s[24:27], s57 offen offset:3072 sc1 lds
    v_mul_f32 v164, v164, v142
    v_mfma_f32_16x16x32_bf16 v[116:119], a[28:31], a[8:11], v[116:119]
    s_add_u32 s57, s57, 131072
    v_add_u32 v13, s66, v13
    v_add_u32 v14, s66, v14
    v_mul_f32 v165, v165, v142
    v_mfma_f32_16x16x32_bf16 v[124:127], a[28:31], a[12:15], v[124:127]
    s_mov_b32 m0, s59
    v_add_u32 v15, s66, v15
    v_mul_f32 v166, v166, v142
    s_waitcnt vmcnt(24) lgkmcnt(0)
    v_mfma_f32_16x16x32_bf16 v[64:67], a[48:51], a[32:35], v[64:67]
    s_barrier
    v_mul_f32 v167, v167, v142
    v_mul_f32 v168, v168, v142
    v_mfma_f32_16x16x32_bf16 v[72:75], a[48:51], a[36:39], v[72:75]
    ds_read_b128 a[0:3], v6 offset:0
    buffer_load_dwordx4 v2, s[36:39], s56 offen offset:0 sc1 lds
    v_mul_f32 v169, v169, v142
    v_mfma_f32_16x16x32_bf16 v[80:83], a[48:51], a[40:43], v[80:83]
    ds_read_b64_tr_b16 a[16:17], v12 offset:0
    v_mul_f32 v170, v170, v142
    v_mul_f32 v171, v171, v142
    v_mfma_f32_16x16x32_bf16 v[88:91], a[48:51], a[44:47], v[88:91]
    ds_read_b64_tr_b16 a[18:19], v12 offset:4096
    v_cvt_pk_bf16_f32 v164, v164, v165
    v_cvt_pk_bf16_f32 v165, v166, v167
    v_mfma_f32_16x16x32_bf16 v[68:71], a[52:55], a[32:35], v[68:71]
    ds_read_b128 a[4:7], v6 offset:1024
    v_cvt_pk_bf16_f32 v166, v168, v169
    v_cvt_pk_bf16_f32 v167, v170, v171
    v_mfma_f32_16x16x32_bf16 v[76:79], a[52:55], a[36:39], v[76:79]
    ds_read_b128 a[8:11], v6 offset:2048
    buffer_load_dwordx4 v2, s[36:39], s56 offen offset:1024 sc1 lds
    buffer_store_dwordx4 v[164:167], v2, s[8:11], s80 offen offset:2048 sc1
    v_mfma_f32_16x16x32_bf16 v[84:87], a[52:55], a[40:43], v[84:87]
    ds_read_b128 a[12:15], v6 offset:3072
    v_mul_f32 v172, v172, v143
    v_mul_f32 v173, v173, v143
    v_mfma_f32_16x16x32_bf16 v[92:95], a[52:55], a[44:47], v[92:95]
    ds_read_b64_tr_b16 a[20:21], v13 offset:0
    v_mul_f32 v174, v174, v143
    v_mul_f32 v175, v175, v143
    v_mfma_f32_16x16x32_bf16 v[96:99], a[56:59], a[32:35], v[96:99]
    ds_read_b64_tr_b16 a[22:23], v13 offset:4096
    v_mul_f32 v176, v176, v143
    v_mul_f32 v177, v177, v143
    v_mfma_f32_16x16x32_bf16 v[104:107], a[56:59], a[36:39], v[104:107]
    ds_read_b64_tr_b16 a[24:25], v14 offset:0
    buffer_load_dwordx4 v2, s[36:39], s56 offen offset:2048 sc1 lds
    v_mul_f32 v178, v178, v143
    v_mfma_f32_16x16x32_bf16 v[112:115], a[56:59], a[40:43], v[112:115]
    ds_read_b64_tr_b16 a[26:27], v14 offset:4096
    v_mul_f32 v179, v179, v143
    v_cvt_pk_bf16_f32 v172, v172, v173
    v_mfma_f32_16x16x32_bf16 v[120:123], a[56:59], a[44:47], v[120:123]
    ds_read_b64_tr_b16 a[28:29], v15 offset:0
    v_cvt_pk_bf16_f32 v173, v174, v175
    v_cvt_pk_bf16_f32 v174, v176, v177
    v_mfma_f32_16x16x32_bf16 v[100:103], a[60:63], a[32:35], v[100:103]
    s_add_u32 s64, s64, 1
    ds_read_b64_tr_b16 a[30:31], v15 offset:4096
    v_cvt_pk_bf16_f32 v175, v178, v179
    buffer_store_dwordx4 v[172:175], v2, s[8:11], s80 offen offset:3072 sc1
    v_mfma_f32_16x16x32_bf16 v[108:111], a[60:63], a[36:39], v[108:111]
    buffer_load_dwordx4 v2, s[36:39], s56 offen offset:3072 sc1 lds
    v_mfma_f32_16x16x32_bf16 v[116:119], a[60:63], a[40:43], v[116:119]
    s_add_u32 s56, s56, 262144
    v_mfma_f32_16x16x32_bf16 v[124:127], a[60:63], a[44:47], v[124:127]
    s_branch m_l3e129
m_lp133:
    s_mov_b32 s3, 1048576
m_spin141:
    buffer_load_dwordx2 v[4:5], v10, s[8:11], s52 offen sc1
    s_waitcnt vmcnt(0)
    v_cmp_ne_u64 s[76:77], s[4:5], v[4:5]
    s_mul_i32 s91, s95, 20
    s_nop 2
    s_lshr_b32 s90, s76, s91
    s_ff1_i32_b32 s90, s90
    s_lshl_b32 s68, s90, 1
    s_mul_i32 s91, s95, 0
    s_sub_i32 s68, s68, s91
    s_cmp_lt_i32 s90, 0
    s_cselect_b32 s68, 1000, s68
    s_cmp_gt_i32 s68, 5
    s_cbranch_scc1 m_ok142
    s_sub_u32 s3, s3, 1
    s_cbranch_scc1 m_ok142
    s_sleep 4
    s_branch m_spin141
m_ok142:
    s_branch m_lr134
m_lp135:
    s_mov_b32 s3, 1048576
m_spin143:
    buffer_load_dwordx2 v[4:5], v10, s[8:11], s52 offen sc1
    s_waitcnt vmcnt(0)
    v_cmp_ne_u64 s[76:77], s[4:5], v[4:5]
    s_mul_i32 s91, s95, 20
    s_nop 2
    s_lshr_b32 s90, s76, s91
    s_ff1_i32_b32 s90, s90
    s_lshl_b32 s68, s90, 1
    s_mul_i32 s91, s95, 0
    s_sub_i32 s68, s68, s91
    s_cmp_lt_i32 s90, 0
    s_cselect_b32 s68, 1000, s68
    s_cmp_gt_i32 s68, 6
    s_cbranch_scc1 m_ok144
    s_sub_u32 s3, s3, 1
    s_cbranch_scc1 m_ok144
    s_sleep 4
    s_branch m_spin143
m_ok144:
    s_branch m_lr136
m_lp137:
    s_mov_b32 s3, 1048576
m_spin145:
    buffer_load_dwordx2 v[4:5], v10, s[8:11], s52 offen sc1
    s_waitcnt vmcnt(0)
    v_cmp_ne_u64 s[76:77], s[4:5], v[4:5]
    s_mul_i32 s91, s95, 20
    s_nop 2
    s_lshr_b32 s90, s76, s91
    s_ff1_i32_b32 s90, s90
    s_lshl_b32 s68, s90, 1
    s_mul_i32 s91, s95, 0
    s_sub_i32 s68, s68, s91
    s_cmp_lt_i32 s90, 0
    s_cselect_b32 s68, 1000, s68
    s_cmp_gt_i32 s68, 7
    s_cbranch_scc1 m_ok146
    s_sub_u32 s3, s3, 1
    s_cbranch_scc1 m_ok146
    s_sleep 4
    s_branch m_spin145
m_ok146:
    s_branch m_lr138
m_lp139:
    s_mov_b32 s3, 1048576
m_spin147:
    buffer_load_dwordx2 v[4:5], v10, s[8:11], s52 offen sc1
    s_waitcnt vmcnt(0)
    v_cmp_ne_u64 s[76:77], s[4:5], v[4:5]
    s_mul_i32 s91, s95, 20
    s_nop 2
    s_lshr_b32 s90, s76, s91
    s_ff1_i32_b32 s90, s90
    s_lshl_b32 s68, s90, 1
    s_mul_i32 s91, s95, 0
    s_sub_i32 s68, s68, s91
    s_cmp_lt_i32 s90, 0
    s_cselect_b32 s68, 1000, s68
    s_cmp_gt_i32 s68, 8
    s_cbranch_scc1 m_ok148
    s_sub_u32 s3, s3, 1
    s_cbranch_scc1 m_ok148
    s_sleep 4
    s_branch m_spin147
m_ok148:
    s_branch m_lr140
.p2align 3
m_l3128:
    s_waitcnt lgkmcnt(9)
    v_mfma_f32_16x16x32_bf16 v[64:67], a[16:19], a[0:3], v[64:67]
    s_add_u32 m0, s59, 16384
    ds_read_b128 a[32:35], v6 offset:8192
    s_waitcnt lgkmcnt(9)
    v_mfma_f32_16x16x32_bf16 v[72:75], a[16:19], a[4:7], v[72:75]
    ds_read_b64_tr_b16 a[48:49], v12 offset:8192
    buffer_load_dwordx4 v16, s[24:27], s57 offen offset:0 sc1 lds
    s_waitcnt lgkmcnt(9)
    v_mfma_f32_16x16x32_bf16 v[80:83], a[16:19], a[8:11], v[80:83]
    s_add_u32 s59, s58, s60
    ds_read_b64_tr_b16 a[50:51], v12 offset:12288
    s_waitcnt lgkmcnt(9)
    v_mfma_f32_16x16x32_bf16 v[88:91], a[16:19], a[12:15], v[88:91]
    s_add_u32 s58, s58, 32768
    ds_read_b128 a[36:39], v6 offset:9216
    s_waitcnt lgkmcnt(8)
    v_mfma_f32_16x16x32_bf16 v[68:71], a[20:23], a[0:3], v[68:71]
    s_cmp_ge_u32 s58, 163840
    ds_read_b128 a[40:43], v6 offset:10240
    v_mfma_f32_16x16x32_bf16 v[76:79], a[20:23], a[4:7], v[76:79]
    ds_read_b128 a[44:47], v6 offset:11264
    buffer_load_dwordx4 v17, s[24:27], s57 offen offset:1024 sc1 lds
    v_mfma_f32_16x16x32_bf16 v[84:87], a[20:23], a[8:11], v[84:87]
    s_cselect_b32 s66, 4294836224, s100
    ds_read_b64_tr_b16 a[52:53], v13 offset:8192
    v_mfma_f32_16x16x32_bf16 v[92:95], a[20:23], a[12:15], v[92:95]
    s_cselect_b32 s58, 0, s58
    ds_read_b64_tr_b16 a[54:55], v13 offset:12288
    s_waitcnt lgkmcnt(10)
    v_mfma_f32_16x16x32_bf16 v[96:99], a[24:27], a[0:3], v[96:99]
    ds_read_b64_tr_b16 a[56:57], v14 offset:8192
    v_mfma_f32_16x16x32_bf16 v[104:107], a[24:27], a[4:7], v[104:107]
    ds_read_b64_tr_b16 a[58:59], v14 offset:12288
    buffer_load_dwordx4 v18, s[24:27], s57 offen offset:2048 sc1 lds
    v_mfma_f32_16x16x32_bf16 v[112:115], a[24:27], a[8:11], v[112:115]
    ds_read_b64_tr_b16 a[60:61], v15 offset:8192
    v_mfma_f32_16x16x32_bf16 v[120:123], a[24:27], a[12:15], v[120:123]
    ds_read_b64_tr_b16 a[62:63], v15 offset:12288
    s_waitcnt lgkmcnt(12)
    v_mfma_f32_16x16x32_bf16 v[100:103], a[28:31], a[0:3], v[100:103]
    v_add_u32 v6, s66, v6
    v_add_u32 v12, s66, v12
    v_mfma_f32_16x16x32_bf16 v[108:111], a[28:31], a[4:7], v[108:111]
    buffer_load_dwordx4 v19, s[24:27], s57 offen offset:3072 sc1 lds
    v_mfma_f32_16x16x32_bf16 v[116:119], a[28:31], a[8:11], v[116:119]
    s_add_u32 s57, s57, 131072
    v_add_u32 v13, s66, v13
    v_add_u32 v14, s66, v14
    v_mfma_f32_16x16x32_bf16 v[124:127], a[28:31], a[12:15], v[124:127]
    s_mov_b32 m0, s59
    v_add_u32 v15, s66, v15
    s_waitcnt vmcnt(24) lgkmcnt(0)
    v_mfma_f32_16x16x32_bf16 v[64:67], a[48:51], a[32:35], v[64:67]
    s_barrier
    v_mfma_f32_16x16x32_bf16 v[72:75], a[48:51], a[36:39], v[72:75]
    ds_read_b128 a[0:3], v6 offset:0
    buffer_load_dwordx4 v2, s[36:39], s56 offen offset:0 sc1 lds
    v_mfma_f32_16x16x32_bf16 v[80:83], a[48:51], a[40:43], v[80:83]
    ds_read_b64_tr_b16 a[16:17], v12 offset:0
    v_mfma_f32_16x16x32_bf16 v[88:91], a[48:51], a[44:47], v[88:91]
    ds_read_b64_tr_b16 a[18:19], v12 offset:4096
    v_mfma_f32_16x16x32_bf16 v[68:71], a[52:55], a[32:35], v[68:71]
    ds_read_b128 a[4:7], v6 offset:1024
    v_mfma_f32_16x16x32_bf16 v[76:79], a[52:55], a[36:39], v[76:79]
    ds_read_b128 a[8:11], v6 offset:2048
    buffer_load_dwordx4 v2, s[36:39], s56 offen offset:1024 sc1 lds
    v_mfma_f32_16x16x32_bf16 v[84:87], a[52:55], a[40:43], v[84:87]
    ds_read_b128 a[12:15], v6 offset:3072
    v_mfma_f32_16x16x32_bf16 v[92:95], a[52:55], a[44:47], v[92:95]
    ds_read_b64_tr_b16 a[20:21], v13 offset:0
    v_mfma_f32_16x16x32_bf16 v[96:99], a[56:59], a[32:35], v[96:99]
    ds_read_b64_tr_b16 a[22:23], v13 offset:4096
    v_mfma_f32_16x16x32_bf16 v[104:107], a[56:59], a[36:39], v[104:107]
    ds_read_b64_tr_b16 a[24:25], v14 offset:0
    buffer_load_dwordx4 v2, s[36:39], s56 offen offset:2048 sc1 lds
    v_mfma_f32_16x16x32_bf16 v[112:115], a[56:59], a[40:43], v[112:115]
    ds_read_b64_tr_b16 a[26:27], v14 offset:4096
    v_mfma_f32_16x16x32_bf16 v[120:123], a[56:59], a[44:47], v[120:123]
    ds_read_b64_tr_b16 a[28:29], v15 offset:0
    v_mfma_f32_16x16x32_bf16 v[100:103], a[60:63], a[32:35], v[100:103]
    s_add_u32 s64, s64, 1
    ds_read_b64_tr_b16 a[30:31], v15 offset:4096
    v_mfma_f32_16x16x32_bf16 v[108:111], a[60:63], a[36:39], v[108:111]
    buffer_load_dwordx4 v2, s[36:39], s56 offen offset:3072 sc1 lds
    v_mfma_f32_16x16x32_bf16 v[116:119], a[60:63], a[40:43], v[116:119]
    s_add_u32 s56, s56, 262144
    s_cmp_lt_u32 s64, s67
    v_mfma_f32_16x16x32_bf16 v[124:127], a[60:63], a[44:47], v[124:127]
    s_cbranch_scc1 m_l3128
m_l3e129:
    s_add_u32 s92, s64, 5
    s_cmp_gt_i32 s68, s92
    s_cbranch_scc1 m_rdy149
    s_mov_b32 s3, 1048576
m_spin150:
    buffer_load_dwordx2 v[4:5], v10, s[8:11], s52 offen sc1
    s_waitcnt vmcnt(0)
    v_cmp_ne_u64 s[76:77], s[4:5], v[4:5]
    s_mul_i32 s91, s95, 20
    s_nop 2
    s_lshr_b32 s90, s76, s91
    s_ff1_i32_b32 s90, s90
    s_lshl_b32 s68, s90, 1
    s_mul_i32 s91, s95, 0
    s_sub_i32 s68, s68, s91
    s_cmp_lt_i32 s90, 0
    s_cselect_b32 s68, 1000, s68
    s_cmp_gt_i32 s68, s92
    s_cbranch_scc1 m_ok151
    s_sub_u32 s3, s3, 1
    s_cbranch_scc1 m_ok151
    s_sleep 4
    s_branch m_spin150
m_ok151:
m_rdy149:
    s_mov_b32 s67, 8
    s_cmp_lt_u32 s64, 8
    s_cbranch_scc1 m_l3n132
    s_cmp_eq_u32 s64, 8
    s_cbranch_scc1 m_o1152
m_o2153:
    s_cmp_eq_u32 s95, 0
    s_cbranch_scc1 m_l3c131
    s_mov_b32 s67, 18
    s_cmp_lt_u32 s64, 18
    s_cbranch_scc1 m_l3n132
    s_cmp_lg_u32 s64, 18
    s_cbranch_scc1 m_n154
    s_mov_b32 s68, 1000
    s_lshr_b32 s90, s96, 1
    s_lshl_b32 s90, s90, 8
    s_add_u32 s90, s90, 117452800
    buffer_load_dwordx2 v[4:5], v10, s[8:11], s90 offen sc1
    s_mov_b32 s67, 19
    s_branch m_l3128
m_n154:
    s_cmp_lg_u32 s64, 19
    s_cbranch_scc1 m_n155
    s_waitcnt vmcnt(8)
    s_waitcnt vmcnt(16)
    s_mov_b32 s3, 1048576
m_spin156:
    v_cmp_ne_u64 s[76:77], s[4:5], v[4:5]
    s_nop 3
    s_cmp_eq_u64 s[76:77], 0
    s_cbranch_scc1 m_ok157
    s_sub_u32 s3, s3, 1
    s_cbranch_scc1 m_ok157
    s_sleep 8
    s_lshr_b32 s90, s96, 1
    s_lshl_b32 s90, s90, 8
    s_add_u32 s90, s90, 117452800
    buffer_load_dwordx2 v[4:5], v10, s[8:11], s90 offen sc1
    s_waitcnt vmcnt(0)
    s_branch m_spin156
m_ok157:
    s_mov_b32 s56, s69
    s_mov_b32 s67, 20
    s_branch m_l3128
m_n155:
    s_cmp_lg_u32 s64, 20
    s_cbranch_scc1 m_n158
    s_mov_b32 s24, s50
    s_mov_b32 s25, s51
    s_mov_b32 s26, 2097152
    s_lshl_b32 s57, s97, 8
    s_mov_b32 s67, 24
    s_branch m_l3128
m_n158:
    s_cmp_lg_u32 s64, 24
    s_cbranch_scc1 m_n159
    s_lshl_b32 s90, s96, 3
    s_add_u32 s90, s90, s97
    s_lshl_b32 s90, s90, 15
    s_lshl_b32 s91, s16, 13
    s_add_u32 s90, s90, s91
    s_add_u32 s70, s90, 100663296
    s_nop 3
    v_cvt_pk_bf16_f32 v128, v64, v65
    v_cvt_pk_bf16_f32 v129, v66, v67
    v_cvt_pk_bf16_f32 v130, v68, v69
    v_cvt_pk_bf16_f32 v131, v70, v71
    v_cvt_pk_bf16_f32 v132, v72, v73
    v_cvt_pk_bf16_f32 v133, v74, v75
    v_cvt_pk_bf16_f32 v134, v76, v77
    v_cvt_pk_bf16_f32 v135, v78, v79
    v_cvt_pk_bf16_f32 v136, v80, v81
    v_cvt_pk_bf16_f32 v137, v82, v83
    v_cvt_pk_bf16_f32 v138, v84, v85
    v_cvt_pk_bf16_f32 v139, v86, v87
    v_cvt_pk_bf16_f32 v140, v88, v89
    v_cvt_pk_bf16_f32 v141, v90, v91
    v_cvt_pk_bf16_f32 v142, v92, v93
    v_cvt_pk_bf16_f32 v143, v94, v95
    v_cvt_pk_bf16_f32 v144, v96, v97
    v_cvt_pk_bf16_f32 v145, v98, v99
    v_cvt_pk_bf16_f32 v146, v100, v101
    v_cvt_pk_bf16_f32 v147, v102, v103
    v_cvt_pk_bf16_f32 v148, v104, v105
    v_cvt_pk_bf16_f32 v149, v106, v107
    v_cvt_pk_bf16_f32 v150, v108, v109
    v_cvt_pk_bf16_f32 v151, v110, v111
    v_cvt_pk_bf16_f32 v152, v112, v113
    v_cvt_pk_bf16_f32 v153, v114, v115
    v_cvt_pk_bf16_f32 v154, v116, v117
    v_cvt_pk_bf16_f32 v155, v118, v119
    v_cvt_pk_bf16_f32 v156, v120, v121
    v_cvt_pk_bf16_f32 v157, v122, v123
    v_cvt_pk_bf16_f32 v158, v124, v125
    v_cvt_pk_bf16_f32 v159, v126, v127
    v_mov_b64 v[64:65], 0
    v_mov_b64 v[66:67], 0
    v_mov_b64 v[68:69], 0
    v_mov_b64 v[70:71], 0
    v_mov_b64 v[72:73], 0
    v_mov_b64 v[74:75], 0
    v_mov_b64 v[76:77], 0
    v_mov_b64 v[78:79], 0
    v_mov_b64 v[80:81], 0
    v_mov_b64 v[82:83], 0
    v_mov_b64 v[84:85], 0
    v_mov_b64 v[86:87], 0
    v_mov_b64 v[88:89], 0
    v_mov_b64 v[90:91], 0
    v_mov_b64 v[92:93], 0
    v_mov_b64 v[94:95], 0
    v_mov_b64 v[96:97], 0
    v_mov_b64 v[98:99], 0
    v_mov_b64 v[100:101], 0
    v_mov_b64 v[102:103], 0
    v_mov_b64 v[104:105], 0
    v_mov_b64 v[106:107], 0
    v_mov_b64 v[108:109], 0
    v_mov_b64 v[110:111], 0
    v_mov_b64 v[112:113], 0
    v_mov_b64 v[114:115], 0
    v_mov_b64 v[116:117], 0
    v_mov_b64 v[118:119], 0
    v_mov_b64 v[120:121], 0
    v_mov_b64 v[122:123], 0
    v_mov_b64 v[124:125], 0
    v_mov_b64 v[126:127], 0
    s_nop 1
    s_waitcnt lgkmcnt(9)
    v_mfma_f32_16x16x32_bf16 v[64:67], a[16:19], a[0:3], v[64:67]
    s_add_u32 m0, s59, 16384
    ds_read_b128 a[32:35], v6 offset:8192
    s_waitcnt lgkmcnt(9)
    v_mfma_f32_16x16x32_bf16 v[72:75], a[16:19], a[4:7], v[72:75]
    ds_read_b64_tr_b16 a[48:49], v12 offset:8192
    buffer_load_dwordx4 v16, s[24:27], s57 offen offset:0 sc1 lds
    s_waitcnt lgkmcnt(9)
    v_mfma_f32_16x16x32_bf16 v[80:83], a[16:19], a[8:11], v[80:83]
    s_add_u32 s59, s58, s60
    ds_read_b64_tr_b16 a[50:51], v12 offset:12288
    s_waitcnt lgkmcnt(9)
    v_mfma_f32_16x16x32_bf16 v[88:91], a[16:19], a[12:15], v[88:91]
    s_add_u32 s58, s58, 32768
    ds_read_b128 a[36:39], v6 offset:9216
    s_waitcnt lgkmcnt(8)
    v_mfma_f32_16x16x32_bf16 v[68:71], a[20:23], a[0:3], v[68:71]
    s_cmp_ge_u32 s58, 163840
    ds_read_b128 a[40:43], v6 offset:10240
    v_mfma_f32_16x16x32_bf16 v[76:79], a[20:23], a[4:7], v[76:79]
    ds_read_b128 a[44:47], v6 offset:11264
    buffer_load_dwordx4 v17, s[24:27], s57 offen offset:1024 sc1 lds
    v_mfma_f32_16x16x32_bf16 v[84:87], a[20:23], a[8:11], v[84:87]
    s_cselect_b32 s66, 4294836224, s100
    ds_read_b64_tr_b16 a[52:53], v13 offset:8192
    v_mfma_f32_16x16x32_bf16 v[92:95], a[20:23], a[12:15], v[92:95]
    s_cselect_b32 s58, 0, s58
    ds_read_b64_tr_b16 a[54:55], v13 offset:12288
    s_waitcnt lgkmcnt(10)
    v_mfma_f32_16x16x32_bf16 v[96:99], a[24:27], a[0:3], v[96:99]
    ds_read_b64_tr_b16 a[56:57], v14 offset:8192
    v_mfma_f32_16x16x32_bf16 v[104:107], a[24:27], a[4:7], v[104:107]
    ds_read_b64_tr_b16 a[58:59], v14 offset:12288
    buffer_load_dwordx4 v18, s[24:27], s57 offen offset:2048 sc1 lds
    v_mfma_f32_16x16x32_bf16 v[112:115], a[24:27], a[8:11], v[112:115]
    ds_read_b64_tr_b16 a[60:61], v15 offset:8192
    v_mfma_f32_16x16x32_bf16 v[120:123], a[24:27], a[12:15], v[120:123]
    ds_read_b64_tr_b16 a[62:63], v15 offset:12288
    buffer_store_dwordx4 v[128:131], v2, s[8:11], s70 offen offset:0 sc1
    s_waitcnt lgkmcnt(12)
    v_mfma_f32_16x16x32_bf16 v[100:103], a[28:31], a[0:3], v[100:103]
    v_add_u32 v6, s66, v6
    v_add_u32 v12, s66, v12
    v_mfma_f32_16x16x32_bf16 v[108:111], a[28:31], a[4:7], v[108:111]
    buffer_load_dwordx4 v19, s[24:27], s57 offen offset:3072 sc1 lds
    v_mfma_f32_16x16x32_bf16 v[116:119], a[28:31], a[8:11], v[116:119]
    s_add_u32 s57, s57, 131072
    v_add_u32 v13, s66, v13
    v_add_u32 v14, s66, v14
    v_mfma_f32_16x16x32_bf16 v[124:127], a[28:31], a[12:15], v[124:127]
    s_mov_b32 m0, s59
    v_add_u32 v15, s66, v15
    s_waitcnt vmcnt(24) lgkmcnt(0)
    v_mfma_f32_16x16x32_bf16 v[64:67], a[48:51], a[32:35], v[64:67]
    s_barrier
    v_mfma_f32_16x16x32_bf16 v[72:75], a[48:51], a[36:39], v[72:75]
    ds_read_b128 a[0:3], v6 offset:0
    buffer_load_dwordx4 v2, s[36:39], s56 offen offset:0 sc1 lds
    v_mfma_f32_16x16x32_bf16 v[80:83], a[48:51], a[40:43], v[80:83]
    ds_read_b64_tr_b16 a[16:17], v12 offset:0
    v_mfma_f32_16x16x32_bf16 v[88:91], a[48:51], a[44:47], v[88:91]
    ds_read_b64_tr_b16 a[18:19], v12 offset:4096
    v_mfma_f32_16x16x32_bf16 v[68:71], a[52:55], a[32:35], v[68:71]
    ds_read_b128 a[4:7], v6 offset:1024
    v_mfma_f32_16x16x32_bf16 v[76:79], a[52:55], a[36:39], v[76:79]
    ds_read_b128 a[8:11], v6 offset:2048
    buffer_load_dwordx4 v2, s[36:39], s56 offen offset:1024 sc1 lds
    v_mfma_f32_16x16x32_bf16 v[84:87], a[52:55], a[40:43], v[84:87]
    ds_read_b128 a[12:15], v6 offset:3072
    v_mfma_f32_16x16x32_bf16 v[92:95], a[52:55], a[44:47], v[92:95]
    ds_read_b64_tr_b16 a[20:21], v13 offset:0
    v_mfma_f32_16x16x32_bf16 v[96:99], a[56:59], a[32:35], v[96:99]
    ds_read_b64_tr_b16 a[22:23], v13 offset:4096
    v_mfma_f32_16x16x32_bf16 v[104:107], a[56:59], a[36:39], v[104:107]
    ds_read_b64_tr_b16 a[24:25], v14 offset:0
    buffer_load_dwordx4 v2, s[36:39], s56 offen offset:2048 sc1 lds
    v_mfma_f32_16x16x32_bf16 v[112:115], a[56:59], a[40:43], v[112:115]
    ds_read_b64_tr_b16 a[26:27], v14 offset:4096
    v_mfma_f32_16x16x32_bf16 v[120:123], a[56:59], a[44:47], v[120:123]
    ds_read_b64_tr_b16 a[28:29], v15 offset:0
    buffer_store_dwordx4 v[132:135], v2, s[8:11], s70 offen offset:1024 sc1
    v_mfma_f32_16x16x32_bf16 v[100:103], a[60:63], a[32:35], v[100:103]
    s_add_u32 s64, s64, 1
    ds_read_b64_tr_b16 a[30:31], v15 offset:4096
    v_mfma_f32_16x16x32_bf16 v[108:111], a[60:63], a[36:39], v[108:111]
    buffer_load_dwordx4 v2, s[36:39], s56 offen offset:3072 sc1 lds
    v_mfma_f32_16x16x32_bf16 v[116:119], a[60:63], a[40:43], v[116:119]
    s_add_u32 s56, s56, 262144
    v_mfma_f32_16x16x32_bf16 v[124:127], a[60:63], a[44:47], v[124:127]
    s_waitcnt lgkmcnt(9)
    v_mfma_f32_16x16x32_bf16 v[64:67], a[16:19], a[0:3], v[64:67]
    s_add_u32 m0, s59, 16384
    ds_read_b128 a[32:35], v6 offset:8192
    s_waitcnt lgkmcnt(9)
    v_mfma_f32_16x16x32_bf16 v[72:75], a[16:19], a[4:7], v[72:75]
    ds_read_b64_tr_b16 a[48:49], v12 offset:8192
    buffer_load_dwordx4 v16, s[24:27], s57 offen offset:0 sc1 lds
    s_waitcnt lgkmcnt(9)
    v_mfma_f32_16x16x32_bf16 v[80:83], a[16:19], a[8:11], v[80:83]
    s_add_u32 s59, s58, s60
    ds_read_b64_tr_b16 a[50:51], v12 offset:12288
    s_waitcnt lgkmcnt(9)
    v_mfma_f32_16x16x32_bf16 v[88:91], a[16:19], a[12:15], v[88:91]
    s_add_u32 s58, s58, 32768
    ds_read_b128 a[36:39], v6 offset:9216
    s_waitcnt lgkmcnt(8)
    v_mfma_f32_16x16x32_bf16 v[68:71], a[20:23], a[0:3], v[68:71]
    s_cmp_ge_u32 s58, 163840
    ds_read_b128 a[40:43], v6 offset:10240
    v_mfma_f32_16x16x32_bf16 v[76:79], a[20:23], a[4:7], v[76:79]
    ds_read_b128 a[44:47], v6 offset:11264
    buffer_load_dwordx4 v17, s[24:27], s57 offen offset:1024 sc1 lds
    v_mfma_f32_16x16x32_bf16 v[84:87], a[20:23], a[8:11], v[84:87]
    s_cselect_b32 s66, 4294836224, s100
    ds_read_b64_tr_b16 a[52:53], v13 offset:8192
    v_mfma_f32_16x16x32_bf16 v[92:95], a[20:23], a[12:15], v[92:95]
    s_cselect_b32 s58, 0, s58
    ds_read_b64_tr_b16 a[54:55], v13 offset:12288
    s_waitcnt lgkmcnt(10)
    v_mfma_f32_16x16x32_bf16 v[96:99], a[24:27], a[0:3], v[96:99]
    ds_read_b64_tr_b16 a[56:57], v14 offset:8192
    v_mfma_f32_16x16x32_bf16 v[104:107], a[24:27], a[4:7], v[104:107]
    ds_read_b64_tr_b16 a[58:59], v14 offset:12288
    buffer_load_dwordx4 v18, s[24:27], s57 offen offset:2048 sc1 lds
    v_mfma_f32_16x16x32_bf16 v[112:115], a[24:27], a[8:11], v[112:115]
    ds_read_b64_tr_b16 a[60:61], v15 offset:8192
    v_mfma_f32_16x16x32_bf16 v[120:123], a[24:27], a[12:15], v[120:123]
    ds_read_b64_tr_b16 a[62:63], v15 offset:12288
    buffer_store_dwordx4 v[136:139], v2, s[8:11], s70 offen offset:2048 sc1
    s_waitcnt lgkmcnt(12)
    v_mfma_f32_16x16x32_bf16 v[100:103], a[28:31], a[0:3], v[100:103]
    v_add_u32 v6, s66, v6
    v_add_u32 v12, s66, v12
    v_mfma_f32_16x16x32_bf16 v[108:111], a[28:31], a[4:7], v[108:111]
    buffer_load_dwordx4 v19, s[24:27], s57 offen offset:3072 sc1 lds
    v_mfma_f32_16x16x32_bf16 v[116:119], a[28:31], a[8:11], v[116:119]
    s_add_u32 s57, s57, 131072
    v_add_u32 v13, s66, v13
    v_add_u32 v14, s66, v14
    v_mfma_f32_16x16x32_bf16 v[124:127], a[28:31], a[12:15], v[124:127]
    s_mov_b32 m0, s59
    v_add_u32 v15, s66, v15
    s_waitcnt vmcnt(24) lgkmcnt(0)
    v_mfma_f32_16x16x32_bf16 v[64:67], a[48:51], a[32:35], v[64:67]
    s_barrier
    v_mfma_f32_16x16x32_bf16 v[72:75], a[48:51], a[36:39], v[72:75]
    ds_read_b128 a[0:3], v6 offset:0
    buffer_load_dwordx4 v2, s[36:39], s56 offen offset:0 sc1 lds
    v_mfma_f32_16x16x32_bf16 v[80:83], a[48:51], a[40:43], v[80:83]
    ds_read_b64_tr_b16 a[16:17], v12 offset:0
    v_mfma_f32_16x16x32_bf16 v[88:91], a[48:51], a[44:47], v[88:91]
    ds_read_b64_tr_b16 a[18:19], v12 offset:4096
    v_mfma_f32_16x16x32_bf16 v[68:71], a[52:55], a[32:35], v[68:71]
    ds_read_b128 a[4:7], v6 offset:1024
    v_mfma_f32_16x16x32_bf16 v[76:79], a[52:55], a[36:39], v[76:79]
    ds_read_b128 a[8:11], v6 offset:2048
    buffer_load_dwordx4 v2, s[36:39], s56 offen offset:1024 sc1 lds
    v_mfma_f32_16x16x32_bf16 v[84:87], a[52:55], a[40:43], v[84:87]
    ds_read_b128 a[12:15], v6 offset:3072
    v_mfma_f32_16x16x32_bf16 v[92:95], a[52:55], a[44:47], v[92:95]
    ds_read_b64_tr_b16 a[20:21], v13 offset:0
    v_mfma_f32_16x16x32_bf16 v[96:99], a[56:59], a[32:35], v[96:99]
    ds_read_b64_tr_b16 a[22:23], v13 offset:4096
    v_mfma_f32_16x16x32_bf16 v[104:107], a[56:59], a[36:39], v[104:107]
    ds_read_b64_tr_b16 a[24:25], v14 offset:0
    buffer_load_dwordx4 v2, s[36:39], s56 offen offset:2048 sc1 lds
    v_mfma_f32_16x16x32_bf16 v[112:115], a[56:59], a[40:43], v[112:115]
    ds_read_b64_tr_b16 a[26:27], v14 offset:4096
    v_mfma_f32_16x16x32_bf16 v[120:123], a[56:59], a[44:47], v[120:123]
    ds_read_b64_tr_b16 a[28:29], v15 offset:0
    buffer_store_dwordx4 v[140:143], v2, s[8:11], s70 offen offset:3072 sc1
    s_add_u32 s70, s70, 4096
    v_mfma_f32_16x16x32_bf16 v[100:103], a[60:63], a[32:35], v[100:103]
    s_add_u32 s64, s64, 1
    ds_read_b64_tr_b16 a[30:31], v15 offset:4096
    v_mfma_f32_16x16x32_bf16 v[108:111], a[60:63], a[36:39], v[108:111]
    buffer_load_dwordx4 v2, s[36:39], s56 offen offset:3072 sc1 lds
    v_mfma_f32_16x16x32_bf16 v[116:119], a[60:63], a[40:43], v[116:119]
    s_add_u32 s56, s56, 262144
    v_mfma_f32_16x16x32_bf16 v[124:127], a[60:63], a[44:47], v[124:127]
    s_waitcnt lgkmcnt(9)
    v_mfma_f32_16x16x32_bf16 v[64:67], a[16:19], a[0:3], v[64:67]
    s_add_u32 m0, s59, 16384
    ds_read_b128 a[32:35], v6 offset:8192
    s_waitcnt lgkmcnt(9)
    v_mfma_f32_16x16x32_bf16 v[72:75], a[16:19], a[4:7], v[72:75]
    ds_read_b64_tr_b16 a[48:49], v12 offset:8192
    buffer_load_dwordx4 v16, s[24:27], s57 offen offset:0 sc1 lds
    s_waitcnt lgkmcnt(9)
    v_mfma_f32_16x16x32_bf16 v[80:83], a[16:19], a[8:11], v[80:83]
    s_add_u32 s59, s58, s60
    ds_read_b64_tr_b16 a[50:51], v12 offset:12288
    s_waitcnt lgkmcnt(9)
    v_mfma_f32_16x16x32_bf16 v[88:91], a[16:19], a[12:15], v[88:91]
    s_add_u32 s58, s58, 32768
    ds_read_b128 a[36:39], v6 offset:9216
    s_waitcnt lgkmcnt(8)
    v_mfma_f32_16x16x32_bf16 v[68:71], a[20:23], a[0:3], v[68:71]
    s_cmp_ge_u32 s58, 163840
    ds_read_b128 a[40:43], v6 offset:10240
    v_mfma_f32_16x16x32_bf16 v[76:79], a[20:23], a[4:7], v[76:79]
    ds_read_b128 a[44:47], v6 offset:11264
    buffer_load_dwordx4 v17, s[24:27], s57 offen offset:1024 sc1 lds
    v_mfma_f32_16x16x32_bf16 v[84:87], a[20:23], a[8:11], v[84:87]
    s_cselect_b32 s66, 4294836224, s100
    ds_read_b64_tr_b16 a[52:53], v13 offset:8192
    v_mfma_f32_16x16x32_bf16 v[92:95], a[20:23], a[12:15], v[92:95]
    s_cselect_b32 s58, 0, s58
    ds_read_b64_tr_b16 a[54:55], v13 offset:12288
    s_waitcnt lgkmcnt(10)
    v_mfma_f32_16x16x32_bf16 v[96:99], a[24:27], a[0:3], v[96:99]
    ds_read_b64_tr_b16 a[56:57], v14 offset:8192
    v_mfma_f32_16x16x32_bf16 v[104:107], a[24:27], a[4:7], v[104:107]
    ds_read_b64_tr_b16 a[58:59], v14 offset:12288
    buffer_load_dwordx4 v18, s[24:27], s57 offen offset:2048 sc1 lds
    v_mfma_f32_16x16x32_bf16 v[112:115], a[24:27], a[8:11], v[112:115]
    ds_read_b64_tr_b16 a[60:61], v15 offset:8192
    v_mfma_f32_16x16x32_bf16 v[120:123], a[24:27], a[12:15], v[120:123]
    ds_read_b64_tr_b16 a[62:63], v15 offset:12288
    buffer_store_dwordx4 v[144:147], v2, s[8:11], s70 offen offset:0 sc1
    s_waitcnt lgkmcnt(12)
    v_mfma_f32_16x16x32_bf16 v[100:103], a[28:31], a[0:3], v[100:103]
    v_add_u32 v6, s66, v6
    v_add_u32 v12, s66, v12
    v_mfma_f32_16x16x32_bf16 v[108:111], a[28:31], a[4:7], v[108:111]
    buffer_load_dwordx4 v19, s[24:27], s57 offen offset:3072 sc1 lds
    v_mfma_f32_16x16x32_bf16 v[116:119], a[28:31], a[8:11], v[116:119]
    s_add_u32 s57, s57, 131072
    v_add_u32 v13, s66, v13
    v_add_u32 v14, s66, v14
    v_mfma_f32_16x16x32_bf16 v[124:127], a[28:31], a[12:15], v[124:127]
    s_mov_b32 m0, s59
    v_add_u32 v15, s66, v15
    s_waitcnt vmcnt(24) lgkmcnt(0)
    v_mfma_f32_16x16x32_bf16 v[64:67], a[48:51], a[32:35], v[64:67]
    s_barrier
    v_mfma_f32_16x16x32_bf16 v[72:75], a[48:51], a[36:39], v[72:75]
    ds_read_b128 a[0:3], v6 offset:0
    buffer_load_dwordx4 v2, s[36:39], s56 offen offset:0 sc1 lds
    v_mfma_f32_16x16x32_bf16 v[80:83], a[48:51], a[40:43], v[80:83]
    ds_read_b64_tr_b16 a[16:17], v12 offset:0
    v_mfma_f32_16x16x32_bf16 v[88:91], a[48:51], a[44:47], v[88:91]
    ds_read_b64_tr_b16 a[18:19], v12 offset:4096
    v_mfma_f32_16x16x32_bf16 v[68:71], a[52:55], a[32:35], v[68:71]
    ds_read_b128 a[4:7], v6 offset:1024
    v_mfma_f32_16x16x32_bf16 v[76:79], a[52:55], a[36:39], v[76:79]
    ds_read_b128 a[8:11], v6 offset:2048
    buffer_load_dwordx4 v2, s[36:39], s56 offen offset:1024 sc1 lds
    v_mfma_f32_16x16x32_bf16 v[84:87], a[52:55], a[40:43], v[84:87]
    ds_read_b128 a[12:15], v6 offset:3072
    v_mfma_f32_16x16x32_bf16 v[92:95], a[52:55], a[44:47], v[92:95]
    ds_read_b64_tr_b16 a[20:21], v13 offset:0
    v_mfma_f32_16x16x32_bf16 v[96:99], a[56:59], a[32:35], v[96:99]
    ds_read_b64_tr_b16 a[22:23], v13 offset:4096
    v_mfma_f32_16x16x32_bf16 v[104:107], a[56:59], a[36:39], v[104:107]
    ds_read_b64_tr_b16 a[24:25], v14 offset:0
    buffer_load_dwordx4 v2, s[36:39], s56 offen offset:2048 sc1 lds
    v_mfma_f32_16x16x32_bf16 v[112:115], a[56:59], a[40:43], v[112:115]
    ds_read_b64_tr_b16 a[26:27], v14 offset:4096
    v_mfma_f32_16x16x32_bf16 v[120:123], a[56:59], a[44:47], v[120:123]
    ds_read_b64_tr_b16 a[28:29], v15 offset:0
    buffer_store_dwordx4 v[148:151], v2, s[8:11], s70 offen offset:1024 sc1
    v_mfma_f32_16x16x32_bf16 v[100:103], a[60:63], a[32:35], v[100:103]
    s_add_u32 s64, s64, 1
    ds_read_b64_tr_b16 a[30:31], v15 offset:4096
    v_mfma_f32_16x16x32_bf16 v[108:111], a[60:63], a[36:39], v[108:111]
    buffer_load_dwordx4 v2, s[36:39], s56 offen offset:3072 sc1 lds
    v_mfma_f32_16x16x32_bf16 v[116:119], a[60:63], a[40:43], v[116:119]
    s_add_u32 s56, s56, 262144
    v_mfma_f32_16x16x32_bf16 v[124:127], a[60:63], a[44:47], v[124:127]
    s_waitcnt lgkmcnt(9)
    v_mfma_f32_16x16x32_bf16 v[64:67], a[16:19], a[0:3], v[64:67]
    s_add_u32 m0, s59, 16384
    ds_read_b128 a[32:35], v6 offset:8192
    s_waitcnt lgkmcnt(9)
    v_mfma_f32_16x16x32_bf16 v[72:75], a[16:19], a[4:7], v[72:75]
    ds_read_b64_tr_b16 a[48:49], v12 offset:8192
    buffer_load_dwordx4 v16, s[24:27], s57 offen offset:0 sc1 lds
    s_waitcnt lgkmcnt(9)
    v_mfma_f32_16x16x32_bf16 v[80:83], a[16:19], a[8:11], v[80:83]
    s_add_u32 s59, s58, s60
    ds_read_b64_tr_b16 a[50:51], v12 offset:12288
    s_waitcnt lgkmcnt(9)
    v_mfma_f32_16x16x32_bf16 v[88:91], a[16:19], a[12:15], v[88:91]
    s_add_u32 s58, s58, 32768
    ds_read_b128 a[36:39], v6 offset:9216
    s_waitcnt lgkmcnt(8)
    v_mfma_f32_16x16x32_bf16 v[68:71], a[20:23], a[0:3], v[68:71]
    s_cmp_ge_u32 s58, 163840
    ds_read_b128 a[40:43], v6 offset:10240
    v_mfma_f32_16x16x32_bf16 v[76:79], a[20:23], a[4:7], v[76:79]
    ds_read_b128 a[44:47], v6 offset:11264
    buffer_load_dwordx4 v17, s[24:27], s57 offen offset:1024 sc1 lds
    v_mfma_f32_16x16x32_bf16 v[84:87], a[20:23], a[8:11], v[84:87]
    s_cselect_b32 s66, 4294836224, s100
    ds_read_b64_tr_b16 a[52:53], v13 offset:8192
    v_mfma_f32_16x16x32_bf16 v[92:95], a[20:23], a[12:15], v[92:95]
    s_cselect_b32 s58, 0, s58
    ds_read_b64_tr_b16 a[54:55], v13 offset:12288
    s_waitcnt lgkmcnt(10)
    v_mfma_f32_16x16x32_bf16 v[96:99], a[24:27], a[0:3], v[96:99]
    ds_read_b64_tr_b16 a[56:57], v14 offset:8192
    v_mfma_f32_16x16x32_bf16 v[104:107], a[24:27], a[4:7], v[104:107]
    ds_read_b64_tr_b16 a[58:59], v14 offset:12288
    buffer_load_dwordx4 v18, s[24:27], s57 offen offset:2048 sc1 lds
    v_mfma_f32_16x16x32_bf16 v[112:115], a[24:27], a[8:11], v[112:115]
    ds_read_b64_tr_b16 a[60:61], v15 offset:8192
    v_mfma_f32_16x16x32_bf16 v[120:123], a[24:27], a[12:15], v[120:123]
    ds_read_b64_tr_b16 a[62:63], v15 offset:12288
    buffer_store_dwordx4 v[152:155], v2, s[8:11], s70 offen offset:2048 sc1
    s_waitcnt lgkmcnt(12)
    v_mfma_f32_16x16x32_bf16 v[100:103], a[28:31], a[0:3], v[100:103]
    v_add_u32 v6, s66, v6
    v_add_u32 v12, s66, v12
    v_mfma_f32_16x16x32_bf16 v[108:111], a[28:31], a[4:7], v[108:111]
    buffer_load_dwordx4 v19, s[24:27], s57 offen offset:3072 sc1 lds
    v_mfma_f32_16x16x32_bf16 v[116:119], a[28:31], a[8:11], v[116:119]
    s_add_u32 s57, s57, 131072
    v_add_u32 v13, s66, v13
    v_add_u32 v14, s66, v14
    v_mfma_f32_16x16x32_bf16 v[124:127], a[28:31], a[12:15], v[124:127]
    s_mov_b32 m0, s59
    v_add_u32 v15, s66, v15
    s_waitcnt vmcnt(24) lgkmcnt(0)
    v_mfma_f32_16x16x32_bf16 v[64:67], a[48:51], a[32:35], v[64:67]
    s_barrier
    v_mfma_f32_16x16x32_bf16 v[72:75], a[48:51], a[36:39], v[72:75]
    ds_read_b128 a[0:3], v6 offset:0
    buffer_load_dwordx4 v2, s[36:39], s56 offen offset:0 sc1 lds
    v_mfma_f32_16x16x32_bf16 v[80:83], a[48:51], a[40:43], v[80:83]
    ds_read_b64_tr_b16 a[16:17], v12 offset:0
    v_mfma_f32_16x16x32_bf16 v[88:91], a[48:51], a[44:47], v[88:91]
    ds_read_b64_tr_b16 a[18:19], v12 offset:4096
    v_mfma_f32_16x16x32_bf16 v[68:71], a[52:55], a[32:35], v[68:71]
    ds_read_b128 a[4:7], v6 offset:1024
    v_mfma_f32_16x16x32_bf16 v[76:79], a[52:55], a[36:39], v[76:79]
    ds_read_b128 a[8:11], v6 offset:2048
    buffer_load_dwordx4 v2, s[36:39], s56 offen offset:1024 sc1 lds
    v_mfma_f32_16x16x32_bf16 v[84:87], a[52:55], a[40:43], v[84:87]
    ds_read_b128 a[12:15], v6 offset:3072
    v_mfma_f32_16x16x32_bf16 v[92:95], a[52:55], a[44:47], v[92:95]
    ds_read_b64_tr_b16 a[20:21], v13 offset:0
    v_mfma_f32_16x16x32_bf16 v[96:99], a[56:59], a[32:35], v[96:99]
    ds_read_b64_tr_b16 a[22:23], v13 offset:4096
    v_mfma_f32_16x16x32_bf16 v[104:107], a[56:59], a[36:39], v[104:107]
    ds_read_b64_tr_b16 a[24:25], v14 offset:0
    buffer_load_dwordx4 v2, s[36:39], s56 offen offset:2048 sc1 lds
    v_mfma_f32_16x16x32_bf16 v[112:115], a[56:59], a[40:43], v[112:115]
    ds_read_b64_tr_b16 a[26:27], v14 offset:4096
    v_mfma_f32_16x16x32_bf16 v[120:123], a[56:59], a[44:47], v[120:123]
    ds_read_b64_tr_b16 a[28:29], v15 offset:0
    buffer_store_dwordx4 v[156:159], v2, s[8:11], s70 offen offset:3072 sc1
    s_add_u32 s70, s70, 4096
    v_mfma_f32_16x16x32_bf16 v[100:103], a[60:63], a[32:35], v[100:103]
    s_add_u32 s64, s64, 1
    ds_read_b64_tr_b16 a[30:31], v15 offset:4096
    v_mfma_f32_16x16x32_bf16 v[108:111], a[60:63], a[36:39], v[108:111]
    buffer_load_dwordx4 v2, s[36:39], s56 offen offset:3072 sc1 lds
    v_mfma_f32_16x16x32_bf16 v[116:119], a[60:63], a[40:43], v[116:119]
    s_add_u32 s56, s56, 262144
    v_mfma_f32_16x16x32_bf16 v[124:127], a[60:63], a[44:47], v[124:127]
    s_mov_b32 s67, 32
    s_branch m_l3128
m_n159:
    s_cmp_lg_u32 s64, 32
    s_cbranch_scc1 m_n160
    s_lshl_b32 s91, s96, 3
    s_add_u32 s91, s91, s97
    s_lshl_b32 s91, s91, 7
    s_add_u32 s91, s91, 16384
    s_cmp_lg_u32 s16, 0
    s_cbranch_scc1 m_np161
    v_mov_b32 v60, s4
    v_mov_b32 v61, s5
    s_add_u32 s90, s91, 117440512
    s_mov_b64 exec, 1
    buffer_store_dwordx2 v[60:61], off, s[8:11], s90 sc1
    s_mov_b64 exec, -1
m_np161:
    s_mov_b32 s67, 35
    s_branch m_l3128
m_n160:
    s_cmp_lg_u32 s64, 35
    s_cbranch_scc1 m_n162
    s_mov_b32 s38, 0
    s_mov_b32 s67, 40
    s_branch m_l3128
m_n162:
    s_branch m_l3x130
m_l3c131:
    s_mov_b32 s67, 34
    s_cmp_lt_u32 s64, 34
    s_cbranch_scc1 m_l3n132
    s_cmp_lg_u32 s64, 34
    s_cbranch_scc1 m_n164
    s_mov_b32 s68, 1000
    s_mov_b32 s67, 35
    s_branch m_l3128
m_n164:
    s_cmp_lg_u32 s64, 35
    s_cbranch_scc1 m_n165
    s_mov_b32 s38, 0
    s_lshl_b32 s91, s96, 3
    s_add_u32 s91, s91, s97
    s_lshl_b32 s91, s91, 7
    s_add_u32 s91, s91, 16384
    s_add_u32 s52, s91, 117440512
    buffer_load_dwordx2 v[4:5], off, s[8:11], s52 sc1
    s_mov_b32 s67, 36
    s_branch m_l3128
m_n165:
    s_cmp_lg_u32 s64, 36
    s_cbranch_scc1 m_n166
    s_mov_b32 s26, 0
    s_mov_b32 s67, 37
    s_branch m_l3128
m_n166:
    s_cmp_lg_u32 s64, 37
    s_cbranch_scc1 m_n167
    s_waitcnt vmcnt(16)
    s_mov_b32 s3, 1048576
m_spin168:
    v_cmp_ne_u64 s[76:77], s[4:5], v[4:5]
    s_nop 3
    s_cmp_eq_u64 s[76:77], 0
    s_cbranch_scc1 m_ok169
    s_sub_u32 s3, s3, 1
    s_cbranch_scc1 m_ok169
    s_sleep 8
    buffer_load_dwordx2 v[4:5], off, s[8:11], s52 sc1
    s_waitcnt vmcnt(0)
    s_branch m_spin168
m_ok169:
    s_lshl_b32 s90, s96, 3
    s_add_u32 s90, s90, s97
    s_lshl_b32 s90, s90, 15
    s_lshl_b32 s91, s16, 13
    s_add_u32 s90, s90, s91
    s_add_u32 s70, s90, 100663296
    buffer_load_dwordx4 v[128:131], v2, s[8:11], s70 offen offset:0 sc1
    buffer_load_dwordx4 v[132:135], v2, s[8:11], s70 offen offset:1024 sc1
    buffer_load_dwordx4 v[136:139], v2, s[8:11], s70 offen offset:2048 sc1
    buffer_load_dwordx4 v[140:143], v2, s[8:11], s70 offen offset:3072 sc1
    s_add_u32 s70, s70, 4096
    buffer_load_dwordx4 v[144:147], v2, s[8:11], s70 offen offset:0 sc1
    buffer_load_dwordx4 v[148:151], v2, s[8:11], s70 offen offset:1024 sc1
    buffer_load_dwordx4 v[152:155], v2, s[8:11], s70 offen offset:2048 sc1
    buffer_load_dwordx4 v[156:159], v2, s[8:11], s70 offen offset:3072 sc1
    s_mov_b32 s67, 40
    s_branch m_l3128
m_n167:
    s_branch m_l3x130
m_o1152:
    s_and_b32 s91, s2, 7
    s_lshl_b32 s91, s91, 5
    s_lshr_b32 s92, s2, 3
    s_add_u32 s91, s91, s92
    s_lshl_b32 s91, s91, 3
    s_add_u32 s91, s91, 12288
    s_cmp_lg_u32 s16, 0
    s_cbranch_scc1 m_np171
    v_mov_b32 v60, s4
    v_mov_b32 v61, s5
    s_add_u32 s90, s91, 117440512
    s_mov_b64 exec, 1
    buffer_store_dwordx2 v[60:61], off, s[8:11], s90 sc1
    s_mov_b64 exec, -1
m_np171:
    s_branch m_o2153
m_l3n132:
    s_sub_u32 s90, s68, 5
    s_min_u32 s67, s67, s90
    s_branch m_l3128
m_l3x130:
    s_cmp_eq_u32 s95, 1
    s_cbranch_scc1 m_noadd172
    s_waitcnt vmcnt(0)
    v_lshlrev_b32 v160, 16, v128
    v_and_b32 v161, 0xffff0000, v128
    v_lshlrev_b32 v162, 16, v129
    v_and_b32 v163, 0xffff0000, v129
    v_lshlrev_b32 v164, 16, v130
    v_and_b32 v165, 0xffff0000, v130
    v_lshlrev_b32 v166, 16, v131
    v_and_b32 v167, 0xffff0000, v131
    v_lshlrev_b32 v168, 16, v132
    v_and_b32 v169, 0xffff0000, v132
    v_lshlrev_b32 v170, 16, v133
    v_and_b32 v171, 0xffff0000, v133
    v_lshlrev_b32 v172, 16, v134
    v_and_b32 v173, 0xffff0000, v134
    v_lshlrev_b32 v174, 16, v135
    v_and_b32 v175, 0xffff0000, v135
    v_lshlrev_b32 v176, 16, v136
    v_and_b32 v177, 0xffff0000, v136
    v_lshlrev_b32 v178, 16, v137
    v_and_b32 v179, 0xffff0000, v137
    v_lshlrev_b32 v180, 16, v138
    v_and_b32 v181, 0xffff0000, v138
    v_lshlrev_b32 v182, 16, v139
    v_and_b32 v183, 0xffff0000, v139
    v_lshlrev_b32 v184, 16, v140
    v_and_b32 v185, 0xffff0000, v140
    v_lshlrev_b32 v186, 16, v141
    v_and_b32 v187, 0xffff0000, v141
    v_lshlrev_b32 v188, 16, v142
    v_and_b32 v189, 0xffff0000, v142
    v_lshlrev_b32 v190, 16, v143
    v_and_b32 v191, 0xffff0000, v143
    v_lshlrev_b32 v192, 16, v144
    v_and_b32 v193, 0xffff0000, v144
    v_lshlrev_b32 v194, 16, v145
    v_and_b32 v195, 0xffff0000, v145
    v_lshlrev_b32 v196, 16, v146
    v_and_b32 v197, 0xffff0000, v146
    v_lshlrev_b32 v198, 16, v147
    v_and_b32 v199, 0xffff0000, v147
    v_lshlrev_b32 v200, 16, v148
    v_and_b32 v201, 0xffff0000, v148
    v_lshlrev_b32 v202, 16, v149
    v_and_b32 v203, 0xffff0000, v149
    v_lshlrev_b32 v204, 16, v150
    v_and_b32 v205, 0xffff0000, v150
    v_lshlrev_b32 v206, 16, v151
    v_and_b32 v207, 0xffff0000, v151
    v_lshlrev_b32 v208, 16, v152
    v_and_b32 v209, 0xffff0000, v152
    v_lshlrev_b32 v210, 16, v153
    v_and_b32 v211, 0xffff0000, v153
    v_lshlrev_b32 v212, 16, v154
    v_and_b32 v213, 0xffff0000, v154
    v_lshlrev_b32 v214, 16, v155
    v_and_b32 v215, 0xffff0000, v155
    v_lshlrev_b32 v216, 16, v156
    v_and_b32 v217, 0xffff0000, v156
    v_lshlrev_b32 v218, 16, v157
    v_and_b32 v219, 0xffff0000, v157
    v_lshlrev_b32 v220, 16, v158
    v_and_b32 v221, 0xffff0000, v158
    v_lshlrev_b32 v222, 16, v159
    v_and_b32 v223, 0xffff0000, v159
    v_pk_add_f32 v[64:65], v[64:65], v[160:161]
    v_pk_add_f32 v[66:67], v[66:67], v[162:163]
    v_pk_add_f32 v[68:69], v[68:69], v[164:165]
    v_pk_add_f32 v[70:71], v[70:71], v[166:167]
    v_pk_add_f32 v[72:73], v[72:73], v[168:169]
    v_pk_add_f32 v[74:75], v[74:75], v[170:171]
    v_pk_add_f32 v[76:77], v[76:77], v[172:173]
    v_pk_add_f32 v[78:79], v[78:79], v[174:175]
    v_pk_add_f32 v[80:81], v[80:81], v[176:177]
    v_pk_add_f32 v[82:83], v[82:83], v[178:179]
    v_pk_add_f32 v[84:85], v[84:85], v[180:181]
    v_pk_add_f32 v[86:87], v[86:87], v[182:183]
    v_pk_add_f32 v[88:89], v[88:89], v[184:185]
    v_pk_add_f32 v[90:91], v[90:91], v[186:187]
    v_pk_add_f32 v[92:93], v[92:93], v[188:189]
    v_pk_add_f32 v[94:95], v[94:95], v[190:191]
    v_pk_add_f32 v[96:97], v[96:97], v[192:193]
    v_pk_add_f32 v[98:99], v[98:99], v[194:195]
    v_pk_add_f32 v[100:101], v[100:101], v[196:197]
    v_pk_add_f32 v[102:103], v[102:103], v[198:199]
    v_pk_add_f32 v[104:105], v[104:105], v[200:201]
    v_pk_add_f32 v[106:107], v[106:107], v[202:203]
    v_pk_add_f32 v[108:109], v[108:109], v[204:205]
    v_pk_add_f32 v[110:111], v[110:111], v[206:207]
    v_pk_add_f32 v[112:113], v[112:113], v[208:209]
    v_pk_add_f32 v[114:115], v[114:115], v[210:211]
    v_pk_add_f32 v[116:117], v[116:117], v[212:213]
    v_pk_add_f32 v[118:119], v[118:119], v[214:215]
    v_pk_add_f32 v[120:121], v[120:121], v[216:217]
    v_pk_add_f32 v[122:123], v[122:123], v[218:219]
    v_pk_add_f32 v[124:125], v[124:125], v[220:221]
    v_pk_add_f32 v[126:127], v[126:127], v[222:223]
m_noadd172:
    v_cvt_pk_bf16_f32 v64, v64, v65
    v_cvt_pk_bf16_f32 v65, v66, v67
    v_cvt_pk_bf16_f32 v66, v68, v69
    v_cvt_pk_bf16_f32 v67, v70, v71
    v_cvt_pk_bf16_f32 v96, v96, v97
    v_cvt_pk_bf16_f32 v97, v98, v99
    v_cvt_pk_bf16_f32 v98, v100, v101
    v_cvt_pk_bf16_f32 v99, v102, v103
    s_nop 1
    v_permlane16_swap_b32 v64, v66
    v_permlane16_swap_b32 v65, v67
    v_permlane16_swap_b32 v96, v98
    v_permlane16_swap_b32 v97, v99
    buffer_store_dwordx4 v[64:67], v7, s[28:31], s71 offen offset:0 sc1
    buffer_store_dwordx4 v[96:99], v7, s[28:31], s71 offen offset:64 sc1
    s_add_u32 s71, s71, s72
    v_cvt_pk_bf16_f32 v72, v72, v73
    v_cvt_pk_bf16_f32 v73, v74, v75
    v_cvt_pk_bf16_f32 v74, v76, v77
    v_cvt_pk_bf16_f32 v75, v78, v79
    v_cvt_pk_bf16_f32 v104, v104, v105
    v_cvt_pk_bf16_f32 v105, v106, v107
    v_cvt_pk_bf16_f32 v106, v108, v109
    v_cvt_pk_bf16_f32 v107, v110, v111
    s_nop 1
    v_permlane16_swap_b32 v72, v74
    v_permlane16_swap_b32 v73, v75
    v_permlane16_swap_b32 v104, v106
    v_permlane16_swap_b32 v105, v107
    buffer_store_dwordx4 v[72:75], v7, s[28:31], s71 offen offset:0 sc1
    buffer_store_dwordx4 v[104:107], v7, s[28:31], s71 offen offset:64 sc1
    s_add_u32 s71, s71, s72
    v_cvt_pk_bf16_f32 v80, v80, v81
    v_cvt_pk_bf16_f32 v81, v82, v83
    v_cvt_pk_bf16_f32 v82, v84, v85
    v_cvt_pk_bf16_f32 v83, v86, v87
    v_cvt_pk_bf16_f32 v112, v112, v113
    v_cvt_pk_bf16_f32 v113, v114, v115
    v_cvt_pk_bf16_f32 v114, v116, v117
    v_cvt_pk_bf16_f32 v115, v118, v119
    s_nop 1
    v_permlane16_swap_b32 v80, v82
    v_permlane16_swap_b32 v81, v83
    v_permlane16_swap_b32 v112, v114
    v_permlane16_swap_b32 v113, v115
    buffer_store_dwordx4 v[80:83], v7, s[28:31], s71 offen offset:0 sc1
    buffer_store_dwordx4 v[112:115], v7, s[28:31], s71 offen offset:64 sc1
    s_add_u32 s71, s71, s72
    v_cvt_pk_bf16_f32 v88, v88, v89
    v_cvt_pk_bf16_f32 v89, v90, v91
    v_cvt_pk_bf16_f32 v90, v92, v93
    v_cvt_pk_bf16_f32 v91, v94, v95
    v_cvt_pk_bf16_f32 v120, v120, v121
    v_cvt_pk_bf16_f32 v121, v122, v123
    v_cvt_pk_bf16_f32 v122, v124, v125
    v_cvt_pk_bf16_f32 v123, v126, v127
    s_nop 1
    v_permlane16_swap_b32 v88, v90
    v_permlane16_swap_b32 v89, v91
    v_permlane16_swap_b32 v120, v122
    v_permlane16_swap_b32 v121, v123
    buffer_store_dwordx4 v[88:91], v7, s[28:31], s71 offen offset:0 sc1
    buffer_store_dwordx4 v[120:123], v7, s[28:31], s71 offen offset:64 sc1
    s_add_u32 s71, s71, s72
m_end1:
    s_endpgm
m_stub72:
    v_cmp_lt_f32 vcc, s65, v8
    s_cmp_lg_u32 s64, s67
    s_cbranch_scc1 m_e174
    v_add_f32 v176, v176, v16
    v_mov_b32 v180, v9
    v_add_f32 v188, v188, v16
    v_add_f32 v177, v177, v17
    v_mov_b32 v181, v9
    v_add_f32 v189, v189, v17
    v_add_f32 v178, v178, v18
    v_mov_b32 v182, v9
    v_add_f32 v190, v190, v18
    v_add_f32 v179, v179, v19
    v_mov_b32 v183, v9
    v_add_f32 v191, v191, v19
    s_nop 0
m_e174:
    s_cmp_lg_u32 s64, s68
    s_cbranch_scc1 m_e175
    v_mov_b32 v176, v9
    v_mov_b32 v184, v9
    v_mov_b32 v188, v9
    v_mov_b32 v177, v9
    v_mov_b32 v185, v9
    v_mov_b32 v189, v9
    v_mov_b32 v178, v9
    v_mov_b32 v186, v9
    v_mov_b32 v190, v9
    v_mov_b32 v179, v9
    v_mov_b32 v187, v9
    v_mov_b32 v191, v9
    s_nop 0
m_e175:
    s_cbranch_vccnz m_rc176
m_sp173:
    s_branch m_ret73
m_stub75:
    v_cmp_lt_f32 vcc, s65, v8
    s_cmp_lg_u32 s64, s67
    s_cbranch_scc1 m_e178
    v_add_f32 v176, v176, v16
    v_mov_b32 v180, v9
    v_add_f32 v188, v188, v16
    v_add_f32 v177, v177, v17
    v_mov_b32 v181, v9
    v_add_f32 v189, v189, v17
    v_add_f32 v178, v178, v18
    v_mov_b32 v182, v9
    v_add_f32 v190, v190, v18
    v_add_f32 v179, v179, v19
    v_mov_b32 v183, v9
    v_add_f32 v191, v191, v19
    s_nop 0
m_e178:
    s_cmp_lg_u32 s64, s68
    s_cbranch_scc1 m_e179
    v_mov_b32 v176, v9
    v_mov_b32 v184, v9
    v_mov_b32 v188, v9
    v_mov_b32 v177, v9
    v_mov_b32 v185, v9
    v_mov_b32 v189, v9
    v_mov_b32 v178, v9
    v_mov_b32 v186, v9
    v_mov_b32 v190, v9
    v_mov_b32 v179, v9
    v_mov_b32 v187, v9
    v_mov_b32 v191, v9
    s_nop 0
m_e179:
    s_cbranch_vccnz m_rc180
m_sp177:
    s_branch m_ret76
m_stub93:
    v_cmp_lt_f32 vcc, s65, v8
    s_cmp_lg_u32 s64, s70
    s_cbranch_scc1 m_e182
    v_add_f32 v160, v160, v16
    v_mov_b32 v164, v9
    v_add_f32 v172, v172, v16
    v_add_f32 v161, v161, v17
    v_mov_b32 v165, v9
    v_add_f32 v173, v173, v17
    v_add_f32 v162, v162, v18
    v_mov_b32 v166, v9
    v_add_f32 v174, v174, v18
    v_add_f32 v163, v163, v19
    v_mov_b32 v167, v9
    v_add_f32 v175, v175, v19
    s_nop 0
m_e182:
    s_cmp_lg_u32 s64, s71
    s_cbranch_scc1 m_e183
    v_mov_b32 v160, v9
    v_mov_b32 v168, v9
    v_mov_b32 v172, v9
    v_mov_b32 v161, v9
    v_mov_b32 v169, v9
    v_mov_b32 v173, v9
    v_mov_b32 v162, v9
    v_mov_b32 v170, v9
    v_mov_b32 v174, v9
    v_mov_b32 v163, v9
    v_mov_b32 v171, v9
    v_mov_b32 v175, v9
    s_nop 0
m_e183:
    s_cbranch_vccnz m_rc184
m_sp181:
    s_branch m_ret94
m_stub95:
    v_cmp_lt_f32 vcc, s65, v8
    s_cmp_lg_u32 s64, s70
    s_cbranch_scc1 m_e186
    v_add_f32 v160, v160, v16
    v_mov_b32 v164, v9
    v_add_f32 v172, v172, v16
    v_add_f32 v161, v161, v17
    v_mov_b32 v165, v9
    v_add_f32 v173, v173, v17
    v_add_f32 v162, v162, v18
    v_mov_b32 v166, v9
    v_add_f32 v174, v174, v18
    v_add_f32 v163, v163, v19
    v_mov_b32 v167, v9
    v_add_f32 v175, v175, v19
    s_nop 0
m_e186:
    s_cmp_lg_u32 s64, s71
    s_cbranch_scc1 m_e187
    v_mov_b32 v160, v9
    v_mov_b32 v168, v9
    v_mov_b32 v172, v9
    v_mov_b32 v161, v9
    v_mov_b32 v169, v9
    v_mov_b32 v173, v9
    v_mov_b32 v162, v9
    v_mov_b32 v170, v9
    v_mov_b32 v174, v9
    v_mov_b32 v163, v9
    v_mov_b32 v171, v9
    v_mov_b32 v175, v9
    s_nop 0
m_e187:
    s_cmp_lg_u32 s64, s53
    s_cbranch_scc1 m_e190
    s_cmp_lg_u32 s16, 0
    s_cbranch_scc1 m_np191
    v_mov_b32 v60, s4
    v_mov_b32 v61, s5
    s_add_u32 s90, s101, 117440512
    s_mov_b64 exec, 1
    buffer_store_dwordx2 v[60:61], off, s[8:11], s90 sc1
    s_mov_b64 exec, -1
m_np191:
    s_mov_b32 s101, -1
m_e190:
    s_cmp_gt_u32 s64, 24
    s_cbranch_scc1 m_e188
    s_cmp_lg_u32 s64, 8
    s_cbranch_scc1 m_e192
    s_lshr_b32 s90, s32, 1
    s_lshl_b32 s90, s90, 7
    s_add_u32 s90, s90, 117440600
    v_min_u32 v0, 1, v1
    v_lshlrev_b32 v0, 5, v0
    buffer_load_dwordx2 v[4:5], v0, s[8:11], s90 offen sc1
    s_cmp_eq_u32 s17, -1
    s_cbranch_scc1 m_e188
    s_cmp_lg_u32 s16, 0
    s_cbranch_scc1 m_np193
    v_mov_b32 v60, s4
    v_mov_b32 v61, s5
    s_add_u32 s90, s17, 117440512
    s_mov_b64 exec, 1
    buffer_store_dwordx2 v[60:61], off, s[8:11], s90 sc1
    s_mov_b64 exec, -1
m_np193:
    s_branch m_e188
m_e192:
    s_cmp_lg_u32 s64, 16
    s_cbranch_scc1 m_e194
    s_waitcnt vmcnt(18)
    s_mov_b32 s3, 1048576
m_spin195:
    v_cmp_ne_u64 s[76:77], s[4:5], v[4:5]
    s_nop 3
    s_cmp_eq_u64 s[76:77], 0
    s_cbranch_scc1 m_e188
    s_sub_u32 s3, s3, 1
    s_cbranch_scc1 m_e188
    s_sleep 32
    s_lshr_b32 s90, s32, 1
    s_lshl_b32 s90, s90, 7
    s_add_u32 s90, s90, 117440600
    v_min_u32 v0, 1, v1
    v_lshlrev_b32 v0, 5, v0
    buffer_load_dwordx2 v[4:5], v0, s[8:11], s90 offen sc1
    s_waitcnt vmcnt(0)
    s_branch m_spin195
    s_branch m_e188
m_e194:
    s_cmp_lg_u32 s64, 20
    s_cbranch_scc1 m_e196
    buffer_load_dwordx2 v[4:5], v10, s[8:11], 0 offen sc1
    s_mov_b32 s44, s48
    s_mov_b32 s45, s49
    s_mov_b32 s46, 8388608
    s_lshl_b32 s90, s2, 2
    s_add_u32 s90, s90, s16
    s_lshl_b32 s90, s90, 13
    v_lshlrev_b32 v62, 7, v1
    buffer_load_dword v255, v62, s[44:47], s90 offen
    s_branch m_e188
m_e196:
    s_cmp_lg_u32 s64, 24
    s_cbranch_scc1 m_e197
    s_mov_b32 s44, s50
    s_mov_b32 s45, s51
    s_mov_b32 s46, 2097152
    s_lshl_b32 s90, s2, 2
    s_add_u32 s90, s90, s16
    s_lshl_b32 s90, s90, 13
    v_lshlrev_b32 v62, 7, v1
    buffer_load_dword v255, v62, s[44:47], s90 offen
    s_waitcnt vmcnt(18)
    s_mov_b32 s3, 1048576
m_spin198:
    v_cmp_ne_u64 s[76:77], s[4:5], v[4:5]
    s_nop 3
    s_cmp_eq_u64 s[76:77], 0
    s_cbranch_scc1 m_e188
    s_sub_u32 s3, s3, 1
    s_cbranch_scc1 m_e188
    s_sleep 32
    buffer_load_dwordx2 v[4:5], v10, s[8:11], 0 offen sc1
    s_waitcnt vmcnt(0)
    s_branch m_spin198
    s_branch m_e188
m_e197:
m_e188:
    s_cbranch_vccnz m_rc199
m_sp185:
    s_branch m_ret96
m_stub99:
    v_cmp_lt_f32 vcc, s65, v8
    s_cmp_lg_u32 s64, s70
    s_cbranch_scc1 m_e201
    v_add_f32 v160, v160, v16
    v_mov_b32 v164, v9
    v_add_f32 v172, v172, v16
    v_add_f32 v161, v161, v17
    v_mov_b32 v165, v9
    v_add_f32 v173, v173, v17
    v_add_f32 v162, v162, v18
    v_mov_b32 v166, v9
    v_add_f32 v174, v174, v18
    v_add_f32 v163, v163, v19
    v_mov_b32 v167, v9
    v_add_f32 v175, v175, v19
    s_nop 0
m_e201:
    s_cmp_lg_u32 s64, s71
    s_cbranch_scc1 m_e202
    v_mov_b32 v160, v9
    v_mov_b32 v168, v9
    v_mov_b32 v172, v9
    v_mov_b32 v161, v9
    v_mov_b32 v169, v9
    v_mov_b32 v173, v9
    v_mov_b32 v162, v9
    v_mov_b32 v170, v9
    v_mov_b32 v174, v9
    v_mov_b32 v163, v9
    v_mov_b32 v171, v9
    v_mov_b32 v175, v9
    s_nop 0
m_e202:
    s_cbranch_vccnz m_rc203
m_sp200:
    s_branch m_ret100
m_stub116:
    v_cmp_lt_f32 vcc, s65, v8
    s_cbranch_vccnz m_rc205
m_sp204:
    s_branch m_ret117
m_rc92:
    s_call_b64 s[74:75], m_rs0466
    s_branch m_sp77
m_rc115:
    s_call_b64 s[74:75], m_rs0265
    s_branch m_sp101
m_rc176:
    s_call_b64 s[74:75], m_rs0466
    s_branch m_sp173
m_rc180:
    s_call_b64 s[74:75], m_rs1468
    s_branch m_sp177
m_rc184:
    s_call_b64 s[74:75], m_rs1468
    s_branch m_sp181
m_rc199:
    s_call_b64 s[74:75], m_rs0265
    s_branch m_sp185
m_rc203:
    s_call_b64 s[74:75], m_rs1267
    s_branch m_sp200
m_rc205:
    s_call_b64 s[74:75], m_rs1267
    s_branch m_sp204
m_rs0265:
    s_nop 15
    v_max3_f32 v48, v64, v65, v66
    v_max3_f32 v48, v48, v67, v68
    v_max3_f32 v48, v48, v69, v70
    v_max3_f32 v48, v48, v71, 0
    v_mov_b32 v49, v48
    s_nop 1
    v_permlane32_swap_b32 v48, v49
    s_nop 1
    v_max_f32 v48, v48, v49
    v_mov_b32 v49, v48
    s_nop 1
    v_permlane16_swap_b32 v48, v49
    s_nop 1
    v_max_f32 v48, v48, v49
    v_exp_f32 v49, -v48
    v_sub_f32 v64, v64, v48
    v_sub_f32 v65, v65, v48
    v_sub_f32 v66, v66, v48
    v_sub_f32 v67, v67, v48
    v_sub_f32 v68, v68, v48
    v_sub_f32 v69, v69, v48
    v_sub_f32 v70, v70, v48
    v_sub_f32 v71, v71, v48
    v_sub_f32 v96, v96, v48
    v_sub_f32 v97, v97, v48
    v_sub_f32 v98, v98, v48
    v_sub_f32 v99, v99, v48
    v_sub_f32 v100, v100, v48
    v_sub_f32 v101, v101, v48
    v_sub_f32 v102, v102, v48
    v_sub_f32 v103, v103, v48
    v_sub_f32 v160, v160, v48
    v_sub_f32 v161, v161, v48
    v_sub_f32 v162, v162, v48
    v_sub_f32 v163, v163, v48
    v_sub_f32 v164, v164, v48
    v_sub_f32 v165, v165, v48
    v_sub_f32 v166, v166, v48
    v_sub_f32 v167, v167, v48
    v_mul_f32 v12, v12, v49
    v_accvgpr_read_b32 v52, a0
    v_accvgpr_read_b32 v53, a1
    v_accvgpr_read_b32 v54, a2
    v_accvgpr_read_b32 v55, a3
    v_accvgpr_read_b32 v56, a4
    v_accvgpr_read_b32 v57, a5
    v_accvgpr_read_b32 v58, a6
    v_accvgpr_read_b32 v59, a7
    v_mul_f32 v52, v52, v49
    v_mul_f32 v53, v53, v49
    v_mul_f32 v54, v54, v49
    v_mul_f32 v55, v55, v49
    v_mul_f32 v56, v56, v49
    v_mul_f32 v57, v57, v49
    v_mul_f32 v58, v58, v49
    v_mul_f32 v59, v59, v49
    v_accvgpr_write_b32 a0, v52
    v_accvgpr_write_b32 a1, v53
    v_accvgpr_write_b32 a2, v54
    v_accvgpr_write_b32 a3, v55
    v_accvgpr_write_b32 a4, v56
    v_accvgpr_write_b32 a5, v57
    v_accvgpr_write_b32 a6, v58
    v_accvgpr_write_b32 a7, v59
    v_accvgpr_read_b32 v52, a8
    v_accvgpr_read_b32 v53, a9
    v_accvgpr_read_b32 v54, a10
    v_accvgpr_read_b32 v55, a11
    v_accvgpr_read_b32 v56, a12
    v_accvgpr_read_b32 v57, a13
    v_accvgpr_read_b32 v58, a14
    v_accvgpr_read_b32 v59, a15
    v_mul_f32 v52, v52, v49
    v_mul_f32 v53, v53, v49
    v_mul_f32 v54, v54, v49
    v_mul_f32 v55, v55, v49
    v_mul_f32 v56, v56, v49
    v_mul_f32 v57, v57, v49
    v_mul_f32 v58, v58, v49
    v_mul_f32 v59, v59, v49
    v_accvgpr_write_b32 a8, v52
    v_accvgpr_write_b32 a9, v53
    v_accvgpr_write_b32 a10, v54
    v_accvgpr_write_b32 a11, v55
    v_accvgpr_write_b32 a12, v56
    v_accvgpr_write_b32 a13, v57
    v_accvgpr_write_b32 a14, v58
    v_accvgpr_write_b32 a15, v59
    v_accvgpr_read_b32 v52, a16
    v_accvgpr_read_b32 v53, a17
    v_accvgpr_read_b32 v54, a18
    v_accvgpr_read_b32 v55, a19
    v_accvgpr_read_b32 v56, a20
    v_accvgpr_read_b32 v57, a21
    v_accvgpr_read_b32 v58, a22
    v_accvgpr_read_b32 v59, a23
    v_mul_f32 v52, v52, v49
    v_mul_f32 v53, v53, v49
    v_mul_f32 v54, v54, v49
    v_mul_f32 v55, v55, v49
    v_mul_f32 v56, v56, v49
    v_mul_f32 v57, v57, v49
    v_mul_f32 v58, v58, v49
    v_mul_f32 v59, v59, v49
    v_accvgpr_write_b32 a16, v52
    v_accvgpr_write_b32 a17, v53
    v_accvgpr_write_b32 a18, v54
    v_accvgpr_write_b32 a19, v55
    v_accvgpr_write_b32 a20, v56
    v_accvgpr_write_b32 a21, v57
    v_accvgpr_write_b32 a22, v58
    v_accvgpr_write_b32 a23, v59
    v_accvgpr_read_b32 v52, a24
    v_accvgpr_read_b32 v53, a25
    v_accvgpr_read_b32 v54, a26
    v_accvgpr_read_b32 v55, a27
    v_accvgpr_read_b32 v56, a28
    v_accvgpr_read_b32 v57, a29
    v_accvgpr_read_b32 v58, a30
    v_accvgpr_read_b32 v59, a31
    v_mul_f32 v52, v52, v49
    v_mul_f32 v53, v53, v49
    v_mul_f32 v54, v54, v49
    v_mul_f32 v55, v55, v49
    v_mul_f32 v56, v56, v49
    v_mul_f32 v57, v57, v49
    v_mul_f32 v58, v58, v49
    v_mul_f32 v59, v59, v49
    v_accvgpr_write_b32 a24, v52
    v_accvgpr_write_b32 a25, v53
    v_accvgpr_write_b32 a26, v54
    v_accvgpr_write_b32 a27, v55
    v_accvgpr_write_b32 a28, v56
    v_accvgpr_write_b32 a29, v57
    v_accvgpr_write_b32 a30, v58
    v_accvgpr_write_b32 a31, v59
    v_exp_f32 v52, v64
    v_exp_f32 v53, v65
    v_exp_f32 v54, v66
    v_exp_f32 v55, v67
    v_exp_f32 v56, v68
    v_exp_f32 v57, v69
    v_exp_f32 v58, v70
    v_exp_f32 v59, v71
    s_nop 0
    v_cvt_pk_bf16_f32 v128, v52, v53
    v_cvt_pk_bf16_f32 v129, v54, v55
    v_cvt_pk_bf16_f32 v130, v56, v57
    v_cvt_pk_bf16_f32 v131, v58, v59
    s_nop 1
    v_mfma_f32_16x16x32_bf16 v[28:31], v[44:47], v[128:131], 0
    v_max3_f32 v48, v72, v73, v74
    v_max3_f32 v48, v48, v75, v76
    v_max3_f32 v48, v48, v77, v78
    v_max3_f32 v48, v48, v79, 0
    v_mov_b32 v49, v48
    s_nop 1
    v_permlane32_swap_b32 v48, v49
    s_nop 1
    v_max_f32 v48, v48, v49
    v_mov_b32 v49, v48
    s_nop 1
    v_permlane16_swap_b32 v48, v49
    s_nop 1
    v_max_f32 v48, v48, v49
    v_exp_f32 v49, -v48
    v_sub_f32 v72, v72, v48
    v_sub_f32 v73, v73, v48
    v_sub_f32 v74, v74, v48
    v_sub_f32 v75, v75, v48
    v_sub_f32 v76, v76, v48
    v_sub_f32 v77, v77, v48
    v_sub_f32 v78, v78, v48
    v_sub_f32 v79, v79, v48
    v_sub_f32 v104, v104, v48
    v_sub_f32 v105, v105, v48
    v_sub_f32 v106, v106, v48
    v_sub_f32 v107, v107, v48
    v_sub_f32 v108, v108, v48
    v_sub_f32 v109, v109, v48
    v_sub_f32 v110, v110, v48
    v_sub_f32 v111, v111, v48
    v_sub_f32 v168, v168, v48
    v_sub_f32 v169, v169, v48
    v_sub_f32 v170, v170, v48
    v_sub_f32 v171, v171, v48
    v_sub_f32 v172, v172, v48
    v_sub_f32 v173, v173, v48
    v_sub_f32 v174, v174, v48
    v_sub_f32 v175, v175, v48
    v_mul_f32 v13, v13, v49
    v_accvgpr_read_b32 v52, a32
    v_accvgpr_read_b32 v53, a33
    v_accvgpr_read_b32 v54, a34
    v_accvgpr_read_b32 v55, a35
    v_accvgpr_read_b32 v56, a36
    v_accvgpr_read_b32 v57, a37
    v_accvgpr_read_b32 v58, a38
    v_accvgpr_read_b32 v59, a39
    v_mul_f32 v52, v52, v49
    v_mul_f32 v53, v53, v49
    v_mul_f32 v54, v54, v49
    v_mul_f32 v55, v55, v49
    v_mul_f32 v56, v56, v49
    v_mul_f32 v57, v57, v49
    v_mul_f32 v58, v58, v49
    v_mul_f32 v59, v59, v49
    v_accvgpr_write_b32 a32, v52
    v_accvgpr_write_b32 a33, v53
    v_accvgpr_write_b32 a34, v54
    v_accvgpr_write_b32 a35, v55
    v_accvgpr_write_b32 a36, v56
    v_accvgpr_write_b32 a37, v57
    v_accvgpr_write_b32 a38, v58
    v_accvgpr_write_b32 a39, v59
    v_accvgpr_read_b32 v52, a40
    v_accvgpr_read_b32 v53, a41
    v_accvgpr_read_b32 v54, a42
    v_accvgpr_read_b32 v55, a43
    v_accvgpr_read_b32 v56, a44
    v_accvgpr_read_b32 v57, a45
    v_accvgpr_read_b32 v58, a46
    v_accvgpr_read_b32 v59, a47
    v_mul_f32 v52, v52, v49
    v_mul_f32 v53, v53, v49
    v_mul_f32 v54, v54, v49
    v_mul_f32 v55, v55, v49
    v_mul_f32 v56, v56, v49
    v_mul_f32 v57, v57, v49
    v_mul_f32 v58, v58, v49
    v_mul_f32 v59, v59, v49
    v_accvgpr_write_b32 a40, v52
    v_accvgpr_write_b32 a41, v53
    v_accvgpr_write_b32 a42, v54
    v_accvgpr_write_b32 a43, v55
    v_accvgpr_write_b32 a44, v56
    v_accvgpr_write_b32 a45, v57
    v_accvgpr_write_b32 a46, v58
    v_accvgpr_write_b32 a47, v59
    v_accvgpr_read_b32 v52, a48
    v_accvgpr_read_b32 v53, a49
    v_accvgpr_read_b32 v54, a50
    v_accvgpr_read_b32 v55, a51
    v_accvgpr_read_b32 v56, a52
    v_accvgpr_read_b32 v57, a53
    v_accvgpr_read_b32 v58, a54
    v_accvgpr_read_b32 v59, a55
    v_mul_f32 v52, v52, v49
    v_mul_f32 v53, v53, v49
    v_mul_f32 v54, v54, v49
    v_mul_f32 v55, v55, v49
    v_mul_f32 v56, v56, v49
    v_mul_f32 v57, v57, v49
    v_mul_f32 v58, v58, v49
    v_mul_f32 v59, v59, v49
    v_accvgpr_write_b32 a48, v52
    v_accvgpr_write_b32 a49, v53
    v_accvgpr_write_b32 a50, v54
    v_accvgpr_write_b32 a51, v55
    v_accvgpr_write_b32 a52, v56
    v_accvgpr_write_b32 a53, v57
    v_accvgpr_write_b32 a54, v58
    v_accvgpr_write_b32 a55, v59
    v_accvgpr_read_b32 v52, a56
    v_accvgpr_read_b32 v53, a57
    v_accvgpr_read_b32 v54, a58
    v_accvgpr_read_b32 v55, a59
    v_accvgpr_read_b32 v56, a60
    v_accvgpr_read_b32 v57, a61
    v_accvgpr_read_b32 v58, a62
    v_accvgpr_read_b32 v59, a63
    v_mul_f32 v52, v52, v49
    v_mul_f32 v53, v53, v49
    v_mul_f32 v54, v54, v49
    v_mul_f32 v55, v55, v49
    v_mul_f32 v56, v56, v49
    v_mul_f32 v57, v57, v49
    v_mul_f32 v58, v58, v49
    v_mul_f32 v59, v59, v49
    v_accvgpr_write_b32 a56, v52
    v_accvgpr_write_b32 a57, v53
    v_accvgpr_write_b32 a58, v54
    v_accvgpr_write_b32 a59, v55
    v_accvgpr_write_b32 a60, v56
    v_accvgpr_write_b32 a61, v57
    v_accvgpr_write_b32 a62, v58
    v_accvgpr_write_b32 a63, v59
    v_exp_f32 v52, v72
    v_exp_f32 v53, v73
    v_exp_f32 v54, v74
    v_exp_f32 v55, v75
    v_exp_f32 v56, v76
    v_exp_f32 v57, v77
    v_exp_f32 v58, v78
    v_exp_f32 v59, v79
    s_nop 0
    v_cvt_pk_bf16_f32 v132, v52, v53
    v_cvt_pk_bf16_f32 v133, v54, v55
    v_cvt_pk_bf16_f32 v134, v56, v57
    v_cvt_pk_bf16_f32 v135, v58, v59
    s_nop 1
    v_mfma_f32_16x16x32_bf16 v[32:35], v[44:47], v[132:135], 0
    s_nop 7
    s_setpc_b64 s[74:75]
m_rs0466:
    s_nop 15
    v_max3_f32 v48, v64, v65, v66
    v_max3_f32 v48, v48, v67, v68
    v_max3_f32 v48, v48, v69, v70
    v_max3_f32 v48, v48, v71, 0
    v_mov_b32 v49, v48
    s_nop 1
    v_permlane32_swap_b32 v48, v49
    s_nop 1
    v_max_f32 v48, v48, v49
    v_mov_b32 v49, v48
    s_nop 1
    v_permlane16_swap_b32 v48, v49
    s_nop 1
    v_max_f32 v48, v48, v49
    v_exp_f32 v49, -v48
    v_sub_f32 v64, v64, v48
    v_sub_f32 v65, v65, v48
    v_sub_f32 v66, v66, v48
    v_sub_f32 v67, v67, v48
    v_sub_f32 v68, v68, v48
    v_sub_f32 v69, v69, v48
    v_sub_f32 v70, v70, v48
    v_sub_f32 v71, v71, v48
    v_sub_f32 v96, v96, v48
    v_sub_f32 v97, v97, v48
    v_sub_f32 v98, v98, v48
    v_sub_f32 v99, v99, v48
    v_sub_f32 v100, v100, v48
    v_sub_f32 v101, v101, v48
    v_sub_f32 v102, v102, v48
    v_sub_f32 v103, v103, v48
    v_sub_f32 v160, v160, v48
    v_sub_f32 v161, v161, v48
    v_sub_f32 v162, v162, v48
    v_sub_f32 v163, v163, v48
    v_sub_f32 v164, v164, v48
    v_sub_f32 v165, v165, v48
    v_sub_f32 v166, v166, v48
    v_sub_f32 v167, v167, v48
    v_mul_f32 v12, v12, v49
    v_accvgpr_read_b32 v52, a0
    v_accvgpr_read_b32 v53, a1
    v_accvgpr_read_b32 v54, a2
    v_accvgpr_read_b32 v55, a3
    v_accvgpr_read_b32 v56, a4
    v_accvgpr_read_b32 v57, a5
    v_accvgpr_read_b32 v58, a6
    v_accvgpr_read_b32 v59, a7
    v_mul_f32 v52, v52, v49
    v_mul_f32 v53, v53, v49
    v_mul_f32 v54, v54, v49
    v_mul_f32 v55, v55, v49
    v_mul_f32 v56, v56, v49
    v_mul_f32 v57, v57, v49
    v_mul_f32 v58, v58, v49
    v_mul_f32 v59, v59, v49
    v_accvgpr_write_b32 a0, v52
    v_accvgpr_write_b32 a1, v53
    v_accvgpr_write_b32 a2, v54
    v_accvgpr_write_b32 a3, v55
    v_accvgpr_write_b32 a4, v56
    v_accvgpr_write_b32 a5, v57
    v_accvgpr_write_b32 a6, v58
    v_accvgpr_write_b32 a7, v59
    v_accvgpr_read_b32 v52, a8
    v_accvgpr_read_b32 v53, a9
    v_accvgpr_read_b32 v54, a10
    v_accvgpr_read_b32 v55, a11
    v_accvgpr_read_b32 v56, a12
    v_accvgpr_read_b32 v57, a13
    v_accvgpr_read_b32 v58, a14
    v_accvgpr_read_b32 v59, a15
    v_mul_f32 v52, v52, v49
    v_mul_f32 v53, v53, v49
    v_mul_f32 v54, v54, v49
    v_mul_f32 v55, v55, v49
    v_mul_f32 v56, v56, v49
    v_mul_f32 v57, v57, v49
    v_mul_f32 v58, v58, v49
    v_mul_f32 v59, v59, v49
    v_accvgpr_write_b32 a8, v52
    v_accvgpr_write_b32 a9, v53
    v_accvgpr_write_b32 a10, v54
    v_accvgpr_write_b32 a11, v55
    v_accvgpr_write_b32 a12, v56
    v_accvgpr_write_b32 a13, v57
    v_accvgpr_write_b32 a14, v58
    v_accvgpr_write_b32 a15, v59
    v_accvgpr_read_b32 v52, a16
    v_accvgpr_read_b32 v53, a17
    v_accvgpr_read_b32 v54, a18
    v_accvgpr_read_b32 v55, a19
    v_accvgpr_read_b32 v56, a20
    v_accvgpr_read_b32 v57, a21
    v_accvgpr_read_b32 v58, a22
    v_accvgpr_read_b32 v59, a23
    v_mul_f32 v52, v52, v49
    v_mul_f32 v53, v53, v49
    v_mul_f32 v54, v54, v49
    v_mul_f32 v55, v55, v49
    v_mul_f32 v56, v56, v49
    v_mul_f32 v57, v57, v49
    v_mul_f32 v58, v58, v49
    v_mul_f32 v59, v59, v49
    v_accvgpr_write_b32 a16, v52
    v_accvgpr_write_b32 a17, v53
    v_accvgpr_write_b32 a18, v54
    v_accvgpr_write_b32 a19, v55
    v_accvgpr_write_b32 a20, v56
    v_accvgpr_write_b32 a21, v57
    v_accvgpr_write_b32 a22, v58
    v_accvgpr_write_b32 a23, v59
    v_accvgpr_read_b32 v52, a24
    v_accvgpr_read_b32 v53, a25
    v_accvgpr_read_b32 v54, a26
    v_accvgpr_read_b32 v55, a27
    v_accvgpr_read_b32 v56, a28
    v_accvgpr_read_b32 v57, a29
    v_accvgpr_read_b32 v58, a30
    v_accvgpr_read_b32 v59, a31
    v_mul_f32 v52, v52, v49
    v_mul_f32 v53, v53, v49
    v_mul_f32 v54, v54, v49
    v_mul_f32 v55, v55, v49
    v_mul_f32 v56, v56, v49
    v_mul_f32 v57, v57, v49
    v_mul_f32 v58, v58, v49
    v_mul_f32 v59, v59, v49
    v_accvgpr_write_b32 a24, v52
    v_accvgpr_write_b32 a25, v53
    v_accvgpr_write_b32 a26, v54
    v_accvgpr_write_b32 a27, v55
    v_accvgpr_write_b32 a28, v56
    v_accvgpr_write_b32 a29, v57
    v_accvgpr_write_b32 a30, v58
    v_accvgpr_write_b32 a31, v59
    v_exp_f32 v52, v64
    v_exp_f32 v53, v65
    v_exp_f32 v54, v66
    v_exp_f32 v55, v67
    v_exp_f32 v56, v68
    v_exp_f32 v57, v69
    v_exp_f32 v58, v70
    v_exp_f32 v59, v71
    s_nop 0
    v_cvt_pk_bf16_f32 v128, v52, v53
    v_cvt_pk_bf16_f32 v129, v54, v55
    v_cvt_pk_bf16_f32 v130, v56, v57
    v_cvt_pk_bf16_f32 v131, v58, v59
    s_nop 1
    v_mfma_f32_16x16x32_bf16 v[28:31], v[44:47], v[128:131], 0
    v_max3_f32 v48, v72, v73, v74
    v_max3_f32 v48, v48, v75, v76
    v_max3_f32 v48, v48, v77, v78
    v_max3_f32 v48, v48, v79, 0
    v_mov_b32 v49, v48
    s_nop 1
    v_permlane32_swap_b32 v48, v49
    s_nop 1
    v_max_f32 v48, v48, v49
    v_mov_b32 v49, v48
    s_nop 1
    v_permlane16_swap_b32 v48, v49
    s_nop 1
    v_max_f32 v48, v48, v49
    v_exp_f32 v49, -v48
    v_sub_f32 v72, v72, v48
    v_sub_f32 v73, v73, v48
    v_sub_f32 v74, v74, v48
    v_sub_f32 v75, v75, v48
    v_sub_f32 v76, v76, v48
    v_sub_f32 v77, v77, v48
    v_sub_f32 v78, v78, v48
    v_sub_f32 v79, v79, v48
    v_sub_f32 v104, v104, v48
    v_sub_f32 v105, v105, v48
    v_sub_f32 v106, v106, v48
    v_sub_f32 v107, v107, v48
    v_sub_f32 v108, v108, v48
    v_sub_f32 v109, v109, v48
    v_sub_f32 v110, v110, v48
    v_sub_f32 v111, v111, v48
    v_sub_f32 v168, v168, v48
    v_sub_f32 v169, v169, v48
    v_sub_f32 v170, v170, v48
    v_sub_f32 v171, v171, v48
    v_sub_f32 v172, v172, v48
    v_sub_f32 v173, v173, v48
    v_sub_f32 v174, v174, v48
    v_sub_f32 v175, v175, v48
    v_mul_f32 v13, v13, v49
    v_accvgpr_read_b32 v52, a32
    v_accvgpr_read_b32 v53, a33
    v_accvgpr_read_b32 v54, a34
    v_accvgpr_read_b32 v55, a35
    v_accvgpr_read_b32 v56, a36
    v_accvgpr_read_b32 v57, a37
    v_accvgpr_read_b32 v58, a38
    v_accvgpr_read_b32 v59, a39
    v_mul_f32 v52, v52, v49
    v_mul_f32 v53, v53, v49
    v_mul_f32 v54, v54, v49
    v_mul_f32 v55, v55, v49
    v_mul_f32 v56, v56, v49
    v_mul_f32 v57, v57, v49
    v_mul_f32 v58, v58, v49
    v_mul_f32 v59, v59, v49
    v_accvgpr_write_b32 a32, v52
    v_accvgpr_write_b32 a33, v53
    v_accvgpr_write_b32 a34, v54
    v_accvgpr_write_b32 a35, v55
    v_accvgpr_write_b32 a36, v56
    v_accvgpr_write_b32 a37, v57
    v_accvgpr_write_b32 a38, v58
    v_accvgpr_write_b32 a39, v59
    v_accvgpr_read_b32 v52, a40
    v_accvgpr_read_b32 v53, a41
    v_accvgpr_read_b32 v54, a42
    v_accvgpr_read_b32 v55, a43
    v_accvgpr_read_b32 v56, a44
    v_accvgpr_read_b32 v57, a45
    v_accvgpr_read_b32 v58, a46
    v_accvgpr_read_b32 v59, a47
    v_mul_f32 v52, v52, v49
    v_mul_f32 v53, v53, v49
    v_mul_f32 v54, v54, v49
    v_mul_f32 v55, v55, v49
    v_mul_f32 v56, v56, v49
    v_mul_f32 v57, v57, v49
    v_mul_f32 v58, v58, v49
    v_mul_f32 v59, v59, v49
    v_accvgpr_write_b32 a40, v52
    v_accvgpr_write_b32 a41, v53
    v_accvgpr_write_b32 a42, v54
    v_accvgpr_write_b32 a43, v55
    v_accvgpr_write_b32 a44, v56
    v_accvgpr_write_b32 a45, v57
    v_accvgpr_write_b32 a46, v58
    v_accvgpr_write_b32 a47, v59
    v_accvgpr_read_b32 v52, a48
    v_accvgpr_read_b32 v53, a49
    v_accvgpr_read_b32 v54, a50
    v_accvgpr_read_b32 v55, a51
    v_accvgpr_read_b32 v56, a52
    v_accvgpr_read_b32 v57, a53
    v_accvgpr_read_b32 v58, a54
    v_accvgpr_read_b32 v59, a55
    v_mul_f32 v52, v52, v49
    v_mul_f32 v53, v53, v49
    v_mul_f32 v54, v54, v49
    v_mul_f32 v55, v55, v49
    v_mul_f32 v56, v56, v49
    v_mul_f32 v57, v57, v49
    v_mul_f32 v58, v58, v49
    v_mul_f32 v59, v59, v49
    v_accvgpr_write_b32 a48, v52
    v_accvgpr_write_b32 a49, v53
    v_accvgpr_write_b32 a50, v54
    v_accvgpr_write_b32 a51, v55
    v_accvgpr_write_b32 a52, v56
    v_accvgpr_write_b32 a53, v57
    v_accvgpr_write_b32 a54, v58
    v_accvgpr_write_b32 a55, v59
    v_accvgpr_read_b32 v52, a56
    v_accvgpr_read_b32 v53, a57
    v_accvgpr_read_b32 v54, a58
    v_accvgpr_read_b32 v55, a59
    v_accvgpr_read_b32 v56, a60
    v_accvgpr_read_b32 v57, a61
    v_accvgpr_read_b32 v58, a62
    v_accvgpr_read_b32 v59, a63
    v_mul_f32 v52, v52, v49
    v_mul_f32 v53, v53, v49
    v_mul_f32 v54, v54, v49
    v_mul_f32 v55, v55, v49
    v_mul_f32 v56, v56, v49
    v_mul_f32 v57, v57, v49
    v_mul_f32 v58, v58, v49
    v_mul_f32 v59, v59, v49
    v_accvgpr_write_b32 a56, v52
    v_accvgpr_write_b32 a57, v53
    v_accvgpr_write_b32 a58, v54
    v_accvgpr_write_b32 a59, v55
    v_accvgpr_write_b32 a60, v56
    v_accvgpr_write_b32 a61, v57
    v_accvgpr_write_b32 a62, v58
    v_accvgpr_write_b32 a63, v59
    v_exp_f32 v52, v72
    v_exp_f32 v53, v73
    v_exp_f32 v54, v74
    v_exp_f32 v55, v75
    v_exp_f32 v56, v76
    v_exp_f32 v57, v77
    v_exp_f32 v58, v78
    v_exp_f32 v59, v79
    s_nop 0
    v_cvt_pk_bf16_f32 v132, v52, v53
    v_cvt_pk_bf16_f32 v133, v54, v55
    v_cvt_pk_bf16_f32 v134, v56, v57
    v_cvt_pk_bf16_f32 v135, v58, v59
    s_nop 1
    v_mfma_f32_16x16x32_bf16 v[32:35], v[44:47], v[132:135], 0
    v_max3_f32 v48, v80, v81, v82
    v_max3_f32 v48, v48, v83, v84
    v_max3_f32 v48, v48, v85, v86
    v_max3_f32 v48, v48, v87, 0
    v_mov_b32 v49, v48
    s_nop 1
    v_permlane32_swap_b32 v48, v49
    s_nop 1
    v_max_f32 v48, v48, v49
    v_mov_b32 v49, v48
    s_nop 1
    v_permlane16_swap_b32 v48, v49
    s_nop 1
    v_max_f32 v48, v48, v49
    v_exp_f32 v49, -v48
    v_sub_f32 v80, v80, v48
    v_sub_f32 v81, v81, v48
    v_sub_f32 v82, v82, v48
    v_sub_f32 v83, v83, v48
    v_sub_f32 v84, v84, v48
    v_sub_f32 v85, v85, v48
    v_sub_f32 v86, v86, v48
    v_sub_f32 v87, v87, v48
    v_sub_f32 v112, v112, v48
    v_sub_f32 v113, v113, v48
    v_sub_f32 v114, v114, v48
    v_sub_f32 v115, v115, v48
    v_sub_f32 v116, v116, v48
    v_sub_f32 v117, v117, v48
    v_sub_f32 v118, v118, v48
    v_sub_f32 v119, v119, v48
    v_sub_f32 v176, v176, v48
    v_sub_f32 v177, v177, v48
    v_sub_f32 v178, v178, v48
    v_sub_f32 v179, v179, v48
    v_sub_f32 v180, v180, v48
    v_sub_f32 v181, v181, v48
    v_sub_f32 v182, v182, v48
    v_sub_f32 v183, v183, v48
    v_mul_f32 v14, v14, v49
    v_accvgpr_read_b32 v52, a64
    v_accvgpr_read_b32 v53, a65
    v_accvgpr_read_b32 v54, a66
    v_accvgpr_read_b32 v55, a67
    v_accvgpr_read_b32 v56, a68
    v_accvgpr_read_b32 v57, a69
    v_accvgpr_read_b32 v58, a70
    v_accvgpr_read_b32 v59, a71
    v_mul_f32 v52, v52, v49
    v_mul_f32 v53, v53, v49
    v_mul_f32 v54, v54, v49
    v_mul_f32 v55, v55, v49
    v_mul_f32 v56, v56, v49
    v_mul_f32 v57, v57, v49
    v_mul_f32 v58, v58, v49
    v_mul_f32 v59, v59, v49
    v_accvgpr_write_b32 a64, v52
    v_accvgpr_write_b32 a65, v53
    v_accvgpr_write_b32 a66, v54
    v_accvgpr_write_b32 a67, v55
    v_accvgpr_write_b32 a68, v56
    v_accvgpr_write_b32 a69, v57
    v_accvgpr_write_b32 a70, v58
    v_accvgpr_write_b32 a71, v59
    v_accvgpr_read_b32 v52, a72
    v_accvgpr_read_b32 v53, a73
    v_accvgpr_read_b32 v54, a74
    v_accvgpr_read_b32 v55, a75
    v_accvgpr_read_b32 v56, a76
    v_accvgpr_read_b32 v57, a77
    v_accvgpr_read_b32 v58, a78
    v_accvgpr_read_b32 v59, a79
    v_mul_f32 v52, v52, v49
    v_mul_f32 v53, v53, v49
    v_mul_f32 v54, v54, v49
    v_mul_f32 v55, v55, v49
    v_mul_f32 v56, v56, v49
    v_mul_f32 v57, v57, v49
    v_mul_f32 v58, v58, v49
    v_mul_f32 v59, v59, v49
    v_accvgpr_write_b32 a72, v52
    v_accvgpr_write_b32 a73, v53
    v_accvgpr_write_b32 a74, v54
    v_accvgpr_write_b32 a75, v55
    v_accvgpr_write_b32 a76, v56
    v_accvgpr_write_b32 a77, v57
    v_accvgpr_write_b32 a78, v58
    v_accvgpr_write_b32 a79, v59
    v_accvgpr_read_b32 v52, a80
    v_accvgpr_read_b32 v53, a81
    v_accvgpr_read_b32 v54, a82
    v_accvgpr_read_b32 v55, a83
    v_accvgpr_read_b32 v56, a84
    v_accvgpr_read_b32 v57, a85
    v_accvgpr_read_b32 v58, a86
    v_accvgpr_read_b32 v59, a87
    v_mul_f32 v52, v52, v49
    v_mul_f32 v53, v53, v49
    v_mul_f32 v54, v54, v49
    v_mul_f32 v55, v55, v49
    v_mul_f32 v56, v56, v49
    v_mul_f32 v57, v57, v49
    v_mul_f32 v58, v58, v49
    v_mul_f32 v59, v59, v49
    v_accvgpr_write_b32 a80, v52
    v_accvgpr_write_b32 a81, v53
    v_accvgpr_write_b32 a82, v54
    v_accvgpr_write_b32 a83, v55
    v_accvgpr_write_b32 a84, v56
    v_accvgpr_write_b32 a85, v57
    v_accvgpr_write_b32 a86, v58
    v_accvgpr_write_b32 a87, v59
    v_accvgpr_read_b32 v52, a88
    v_accvgpr_read_b32 v53, a89
    v_accvgpr_read_b32 v54, a90
    v_accvgpr_read_b32 v55, a91
    v_accvgpr_read_b32 v56, a92
    v_accvgpr_read_b32 v57, a93
    v_accvgpr_read_b32 v58, a94
    v_accvgpr_read_b32 v59, a95
    v_mul_f32 v52, v52, v49
    v_mul_f32 v53, v53, v49
    v_mul_f32 v54, v54, v49
    v_mul_f32 v55, v55, v49
    v_mul_f32 v56, v56, v49
    v_mul_f32 v57, v57, v49
    v_mul_f32 v58, v58, v49
    v_mul_f32 v59, v59, v49
    v_accvgpr_write_b32 a88, v52
    v_accvgpr_write_b32 a89, v53
    v_accvgpr_write_b32 a90, v54
    v_accvgpr_write_b32 a91, v55
    v_accvgpr_write_b32 a92, v56
    v_accvgpr_write_b32 a93, v57
    v_accvgpr_write_b32 a94, v58
    v_accvgpr_write_b32 a95, v59
    v_exp_f32 v52, v80
    v_exp_f32 v53, v81
    v_exp_f32 v54, v82
    v_exp_f32 v55, v83
    v_exp_f32 v56, v84
    v_exp_f32 v57, v85
    v_exp_f32 v58, v86
    v_exp_f32 v59, v87
    s_nop 0
    v_cvt_pk_bf16_f32 v136, v52, v53
    v_cvt_pk_bf16_f32 v137, v54, v55
    v_cvt_pk_bf16_f32 v138, v56, v57
    v_cvt_pk_bf16_f32 v139, v58, v59
    s_nop 1
    v_mfma_f32_16x16x32_bf16 v[36:39], v[44:47], v[136:139], 0
    v_max3_f32 v48, v88, v89, v90
    v_max3_f32 v48, v48, v91, v92
    v_max3_f32 v48, v48, v93, v94
    v_max3_f32 v48, v48, v95, 0
    v_mov_b32 v49, v48
    s_nop 1
    v_permlane32_swap_b32 v48, v49
    s_nop 1
    v_max_f32 v48, v48, v49
    v_mov_b32 v49, v48
    s_nop 1
    v_permlane16_swap_b32 v48, v49
    s_nop 1
    v_max_f32 v48, v48, v49
    v_exp_f32 v49, -v48
    v_sub_f32 v88, v88, v48
    v_sub_f32 v89, v89, v48
    v_sub_f32 v90, v90, v48
    v_sub_f32 v91, v91, v48
    v_sub_f32 v92, v92, v48
    v_sub_f32 v93, v93, v48
    v_sub_f32 v94, v94, v48
    v_sub_f32 v95, v95, v48
    v_sub_f32 v120, v120, v48
    v_sub_f32 v121, v121, v48
    v_sub_f32 v122, v122, v48
    v_sub_f32 v123, v123, v48
    v_sub_f32 v124, v124, v48
    v_sub_f32 v125, v125, v48
    v_sub_f32 v126, v126, v48
    v_sub_f32 v127, v127, v48
    v_sub_f32 v184, v184, v48
    v_sub_f32 v185, v185, v48
    v_sub_f32 v186, v186, v48
    v_sub_f32 v187, v187, v48
    v_sub_f32 v188, v188, v48
    v_sub_f32 v189, v189, v48
    v_sub_f32 v190, v190, v48
    v_sub_f32 v191, v191, v48
    v_mul_f32 v15, v15, v49
    v_accvgpr_read_b32 v52, a96
    v_accvgpr_read_b32 v53, a97
    v_accvgpr_read_b32 v54, a98
    v_accvgpr_read_b32 v55, a99
    v_accvgpr_read_b32 v56, a100
    v_accvgpr_read_b32 v57, a101
    v_accvgpr_read_b32 v58, a102
    v_accvgpr_read_b32 v59, a103
    v_mul_f32 v52, v52, v49
    v_mul_f32 v53, v53, v49
    v_mul_f32 v54, v54, v49
    v_mul_f32 v55, v55, v49
    v_mul_f32 v56, v56, v49
    v_mul_f32 v57, v57, v49
    v_mul_f32 v58, v58, v49
    v_mul_f32 v59, v59, v49
    v_accvgpr_write_b32 a96, v52
    v_accvgpr_write_b32 a97, v53
    v_accvgpr_write_b32 a98, v54
    v_accvgpr_write_b32 a99, v55
    v_accvgpr_write_b32 a100, v56
    v_accvgpr_write_b32 a101, v57
    v_accvgpr_write_b32 a102, v58
    v_accvgpr_write_b32 a103, v59
    v_accvgpr_read_b32 v52, a104
    v_accvgpr_read_b32 v53, a105
    v_accvgpr_read_b32 v54, a106
    v_accvgpr_read_b32 v55, a107
    v_accvgpr_read_b32 v56, a108
    v_accvgpr_read_b32 v57, a109
    v_accvgpr_read_b32 v58, a110
    v_accvgpr_read_b32 v59, a111
    v_mul_f32 v52, v52, v49
    v_mul_f32 v53, v53, v49
    v_mul_f32 v54, v54, v49
    v_mul_f32 v55, v55, v49
    v_mul_f32 v56, v56, v49
    v_mul_f32 v57, v57, v49
    v_mul_f32 v58, v58, v49
    v_mul_f32 v59, v59, v49
    v_accvgpr_write_b32 a104, v52
    v_accvgpr_write_b32 a105, v53
    v_accvgpr_write_b32 a106, v54
    v_accvgpr_write_b32 a107, v55
    v_accvgpr_write_b32 a108, v56
    v_accvgpr_write_b32 a109, v57
    v_accvgpr_write_b32 a110, v58
    v_accvgpr_write_b32 a111, v59
    v_accvgpr_read_b32 v52, a112
    v_accvgpr_read_b32 v53, a113
    v_accvgpr_read_b32 v54, a114
    v_accvgpr_read_b32 v55, a115
    v_accvgpr_read_b32 v56, a116
    v_accvgpr_read_b32 v57, a117
    v_accvgpr_read_b32 v58, a118
    v_accvgpr_read_b32 v59, a119
    v_mul_f32 v52, v52, v49
    v_mul_f32 v53, v53, v49
    v_mul_f32 v54, v54, v49
    v_mul_f32 v55, v55, v49
    v_mul_f32 v56, v56, v49
    v_mul_f32 v57, v57, v49
    v_mul_f32 v58, v58, v49
    v_mul_f32 v59, v59, v49
    v_accvgpr_write_b32 a112, v52
    v_accvgpr_write_b32 a113, v53
    v_accvgpr_write_b32 a114, v54
    v_accvgpr_write_b32 a115, v55
    v_accvgpr_write_b32 a116, v56
    v_accvgpr_write_b32 a117, v57
    v_accvgpr_write_b32 a118, v58
    v_accvgpr_write_b32 a119, v59
    v_accvgpr_read_b32 v52, a120
    v_accvgpr_read_b32 v53, a121
    v_accvgpr_read_b32 v54, a122
    v_accvgpr_read_b32 v55, a123
    v_accvgpr_read_b32 v56, a124
    v_accvgpr_read_b32 v57, a125
    v_accvgpr_read_b32 v58, a126
    v_accvgpr_read_b32 v59, a127
    v_mul_f32 v52, v52, v49
    v_mul_f32 v53, v53, v49
    v_mul_f32 v54, v54, v49
    v_mul_f32 v55, v55, v49
    v_mul_f32 v56, v56, v49
    v_mul_f32 v57, v57, v49
    v_mul_f32 v58, v58, v49
    v_mul_f32 v59, v59, v49
    v_accvgpr_write_b32 a120, v52
    v_accvgpr_write_b32 a121, v53
    v_accvgpr_write_b32 a122, v54
    v_accvgpr_write_b32 a123, v55
    v_accvgpr_write_b32 a124, v56
    v_accvgpr_write_b32 a125, v57
    v_accvgpr_write_b32 a126, v58
    v_accvgpr_write_b32 a127, v59
    v_exp_f32 v52, v88
    v_exp_f32 v53, v89
    v_exp_f32 v54, v90
    v_exp_f32 v55, v91
    v_exp_f32 v56, v92
    v_exp_f32 v57, v93
    v_exp_f32 v58, v94
    v_exp_f32 v59, v95
    s_nop 0
    v_cvt_pk_bf16_f32 v140, v52, v53
    v_cvt_pk_bf16_f32 v141, v54, v55
    v_cvt_pk_bf16_f32 v142, v56, v57
    v_cvt_pk_bf16_f32 v143, v58, v59
    s_nop 1
    v_mfma_f32_16x16x32_bf16 v[40:43], v[44:47], v[140:143], 0
    s_nop 7
    s_setpc_b64 s[74:75]
m_rs1267:
    s_nop 15
    v_max3_f32 v48, v96, v97, v98
    v_max3_f32 v48, v48, v99, v100
    v_max3_f32 v48, v48, v101, v102
    v_max3_f32 v48, v48, v103, 0
    v_mov_b32 v49, v48
    s_nop 1
    v_permlane32_swap_b32 v48, v49
    s_nop 1
    v_max_f32 v48, v48, v49
    v_mov_b32 v49, v48
    s_nop 1
    v_permlane16_swap_b32 v48, v49
    s_nop 1
    v_max_f32 v48, v48, v49
    v_exp_f32 v49, -v48
    v_sub_f32 v96, v96, v48
    v_sub_f32 v97, v97, v48
    v_sub_f32 v98, v98, v48
    v_sub_f32 v99, v99, v48
    v_sub_f32 v100, v100, v48
    v_sub_f32 v101, v101, v48
    v_sub_f32 v102, v102, v48
    v_sub_f32 v103, v103, v48
    v_sub_f32 v64, v64, v48
    v_sub_f32 v65, v65, v48
    v_sub_f32 v66, v66, v48
    v_sub_f32 v67, v67, v48
    v_sub_f32 v68, v68, v48
    v_sub_f32 v69, v69, v48
    v_sub_f32 v70, v70, v48
    v_sub_f32 v71, v71, v48
    v_sub_f32 v160, v160, v48
    v_sub_f32 v161, v161, v48
    v_sub_f32 v162, v162, v48
    v_sub_f32 v163, v163, v48
    v_sub_f32 v164, v164, v48
    v_sub_f32 v165, v165, v48
    v_sub_f32 v166, v166, v48
    v_sub_f32 v167, v167, v48
    v_mul_f32 v12, v12, v49
    v_accvgpr_read_b32 v52, a0
    v_accvgpr_read_b32 v53, a1
    v_accvgpr_read_b32 v54, a2
    v_accvgpr_read_b32 v55, a3
    v_accvgpr_read_b32 v56, a4
    v_accvgpr_read_b32 v57, a5
    v_accvgpr_read_b32 v58, a6
    v_accvgpr_read_b32 v59, a7
    v_mul_f32 v52, v52, v49
    v_mul_f32 v53, v53, v49
    v_mul_f32 v54, v54, v49
    v_mul_f32 v55, v55, v49
    v_mul_f32 v56, v56, v49
    v_mul_f32 v57, v57, v49
    v_mul_f32 v58, v58, v49
    v_mul_f32 v59, v59, v49
    v_accvgpr_write_b32 a0, v52
    v_accvgpr_write_b32 a1, v53
    v_accvgpr_write_b32 a2, v54
    v_accvgpr_write_b32 a3, v55
    v_accvgpr_write_b32 a4, v56
    v_accvgpr_write_b32 a5, v57
    v_accvgpr_write_b32 a6, v58
    v_accvgpr_write_b32 a7, v59
    v_accvgpr_read_b32 v52, a8
    v_accvgpr_read_b32 v53, a9
    v_accvgpr_read_b32 v54, a10
    v_accvgpr_read_b32 v55, a11
    v_accvgpr_read_b32 v56, a12
    v_accvgpr_read_b32 v57, a13
    v_accvgpr_read_b32 v58, a14
    v_accvgpr_read_b32 v59, a15
    v_mul_f32 v52, v52, v49
    v_mul_f32 v53, v53, v49
    v_mul_f32 v54, v54, v49
    v_mul_f32 v55, v55, v49
    v_mul_f32 v56, v56, v49
    v_mul_f32 v57, v57, v49
    v_mul_f32 v58, v58, v49
    v_mul_f32 v59, v59, v49
    v_accvgpr_write_b32 a8, v52
    v_accvgpr_write_b32 a9, v53
    v_accvgpr_write_b32 a10, v54
    v_accvgpr_write_b32 a11, v55
    v_accvgpr_write_b32 a12, v56
    v_accvgpr_write_b32 a13, v57
    v_accvgpr_write_b32 a14, v58
    v_accvgpr_write_b32 a15, v59
    v_accvgpr_read_b32 v52, a16
    v_accvgpr_read_b32 v53, a17
    v_accvgpr_read_b32 v54, a18
    v_accvgpr_read_b32 v55, a19
    v_accvgpr_read_b32 v56, a20
    v_accvgpr_read_b32 v57, a21
    v_accvgpr_read_b32 v58, a22
    v_accvgpr_read_b32 v59, a23
    v_mul_f32 v52, v52, v49
    v_mul_f32 v53, v53, v49
    v_mul_f32 v54, v54, v49
    v_mul_f32 v55, v55, v49
    v_mul_f32 v56, v56, v49
    v_mul_f32 v57, v57, v49
    v_mul_f32 v58, v58, v49
    v_mul_f32 v59, v59, v49
    v_accvgpr_write_b32 a16, v52
    v_accvgpr_write_b32 a17, v53
    v_accvgpr_write_b32 a18, v54
    v_accvgpr_write_b32 a19, v55
    v_accvgpr_write_b32 a20, v56
    v_accvgpr_write_b32 a21, v57
    v_accvgpr_write_b32 a22, v58
    v_accvgpr_write_b32 a23, v59
    v_accvgpr_read_b32 v52, a24
    v_accvgpr_read_b32 v53, a25
    v_accvgpr_read_b32 v54, a26
    v_accvgpr_read_b32 v55, a27
    v_accvgpr_read_b32 v56, a28
    v_accvgpr_read_b32 v57, a29
    v_accvgpr_read_b32 v58, a30
    v_accvgpr_read_b32 v59, a31
    v_mul_f32 v52, v52, v49
    v_mul_f32 v53, v53, v49
    v_mul_f32 v54, v54, v49
    v_mul_f32 v55, v55, v49
    v_mul_f32 v56, v56, v49
    v_mul_f32 v57, v57, v49
    v_mul_f32 v58, v58, v49
    v_mul_f32 v59, v59, v49
    v_accvgpr_write_b32 a24, v52
    v_accvgpr_write_b32 a25, v53
    v_accvgpr_write_b32 a26, v54
    v_accvgpr_write_b32 a27, v55
    v_accvgpr_write_b32 a28, v56
    v_accvgpr_write_b32 a29, v57
    v_accvgpr_write_b32 a30, v58
    v_accvgpr_write_b32 a31, v59
    v_exp_f32 v52, v96
    v_exp_f32 v53, v97
    v_exp_f32 v54, v98
    v_exp_f32 v55, v99
    v_exp_f32 v56, v100
    v_exp_f32 v57, v101
    v_exp_f32 v58, v102
    v_exp_f32 v59, v103
    s_nop 0
    v_cvt_pk_bf16_f32 v144, v52, v53
    v_cvt_pk_bf16_f32 v145, v54, v55
    v_cvt_pk_bf16_f32 v146, v56, v57
    v_cvt_pk_bf16_f32 v147, v58, v59
    s_nop 1
    v_mfma_f32_16x16x32_bf16 v[28:31], v[44:47], v[144:147], 0
    v_max3_f32 v48, v104, v105, v106
    v_max3_f32 v48, v48, v107, v108
    v_max3_f32 v48, v48, v109, v110
    v_max3_f32 v48, v48, v111, 0
    v_mov_b32 v49, v48
    s_nop 1
    v_permlane32_swap_b32 v48, v49
    s_nop 1
    v_max_f32 v48, v48, v49
    v_mov_b32 v49, v48
    s_nop 1
    v_permlane16_swap_b32 v48, v49
    s_nop 1
    v_max_f32 v48, v48, v49
    v_exp_f32 v49, -v48
    v_sub_f32 v104, v104, v48
    v_sub_f32 v105, v105, v48
    v_sub_f32 v106, v106, v48
    v_sub_f32 v107, v107, v48
    v_sub_f32 v108, v108, v48
    v_sub_f32 v109, v109, v48
    v_sub_f32 v110, v110, v48
    v_sub_f32 v111, v111, v48
    v_sub_f32 v72, v72, v48
    v_sub_f32 v73, v73, v48
    v_sub_f32 v74, v74, v48
    v_sub_f32 v75, v75, v48
    v_sub_f32 v76, v76, v48
    v_sub_f32 v77, v77, v48
    v_sub_f32 v78, v78, v48
    v_sub_f32 v79, v79, v48
    v_sub_f32 v168, v168, v48
    v_sub_f32 v169, v169, v48
    v_sub_f32 v170, v170, v48
    v_sub_f32 v171, v171, v48
    v_sub_f32 v172, v172, v48
    v_sub_f32 v173, v173, v48
    v_sub_f32 v174, v174, v48
    v_sub_f32 v175, v175, v48
    v_mul_f32 v13, v13, v49
    v_accvgpr_read_b32 v52, a32
    v_accvgpr_read_b32 v53, a33
    v_accvgpr_read_b32 v54, a34
    v_accvgpr_read_b32 v55, a35
    v_accvgpr_read_b32 v56, a36
    v_accvgpr_read_b32 v57, a37
    v_accvgpr_read_b32 v58, a38
    v_accvgpr_read_b32 v59, a39
    v_mul_f32 v52, v52, v49
    v_mul_f32 v53, v53, v49
    v_mul_f32 v54, v54, v49
    v_mul_f32 v55, v55, v49
    v_mul_f32 v56, v56, v49
    v_mul_f32 v57, v57, v49
    v_mul_f32 v58, v58, v49
    v_mul_f32 v59, v59, v49
    v_accvgpr_write_b32 a32, v52
    v_accvgpr_write_b32 a33, v53
    v_accvgpr_write_b32 a34, v54
    v_accvgpr_write_b32 a35, v55
    v_accvgpr_write_b32 a36, v56
    v_accvgpr_write_b32 a37, v57
    v_accvgpr_write_b32 a38, v58
    v_accvgpr_write_b32 a39, v59
    v_accvgpr_read_b32 v52, a40
    v_accvgpr_read_b32 v53, a41
    v_accvgpr_read_b32 v54, a42
    v_accvgpr_read_b32 v55, a43
    v_accvgpr_read_b32 v56, a44
    v_accvgpr_read_b32 v57, a45
    v_accvgpr_read_b32 v58, a46
    v_accvgpr_read_b32 v59, a47
    v_mul_f32 v52, v52, v49
    v_mul_f32 v53, v53, v49
    v_mul_f32 v54, v54, v49
    v_mul_f32 v55, v55, v49
    v_mul_f32 v56, v56, v49
    v_mul_f32 v57, v57, v49
    v_mul_f32 v58, v58, v49
    v_mul_f32 v59, v59, v49
    v_accvgpr_write_b32 a40, v52
    v_accvgpr_write_b32 a41, v53
    v_accvgpr_write_b32 a42, v54
    v_accvgpr_write_b32 a43, v55
    v_accvgpr_write_b32 a44, v56
    v_accvgpr_write_b32 a45, v57
    v_accvgpr_write_b32 a46, v58
    v_accvgpr_write_b32 a47, v59
    v_accvgpr_read_b32 v52, a48
    v_accvgpr_read_b32 v53, a49
    v_accvgpr_read_b32 v54, a50
    v_accvgpr_read_b32 v55, a51
    v_accvgpr_read_b32 v56, a52
    v_accvgpr_read_b32 v57, a53
    v_accvgpr_read_b32 v58, a54
    v_accvgpr_read_b32 v59, a55
    v_mul_f32 v52, v52, v49
    v_mul_f32 v53, v53, v49
    v_mul_f32 v54, v54, v49
    v_mul_f32 v55, v55, v49
    v_mul_f32 v56, v56, v49
    v_mul_f32 v57, v57, v49
    v_mul_f32 v58, v58, v49
    v_mul_f32 v59, v59, v49
    v_accvgpr_write_b32 a48, v52
    v_accvgpr_write_b32 a49, v53
    v_accvgpr_write_b32 a50, v54
    v_accvgpr_write_b32 a51, v55
    v_accvgpr_write_b32 a52, v56
    v_accvgpr_write_b32 a53, v57
    v_accvgpr_write_b32 a54, v58
    v_accvgpr_write_b32 a55, v59
    v_accvgpr_read_b32 v52, a56
    v_accvgpr_read_b32 v53, a57
    v_accvgpr_read_b32 v54, a58
    v_accvgpr_read_b32 v55, a59
    v_accvgpr_read_b32 v56, a60
    v_accvgpr_read_b32 v57, a61
    v_accvgpr_read_b32 v58, a62
    v_accvgpr_read_b32 v59, a63
    v_mul_f32 v52, v52, v49
    v_mul_f32 v53, v53, v49
    v_mul_f32 v54, v54, v49
    v_mul_f32 v55, v55, v49
    v_mul_f32 v56, v56, v49
    v_mul_f32 v57, v57, v49
    v_mul_f32 v58, v58, v49
    v_mul_f32 v59, v59, v49
    v_accvgpr_write_b32 a56, v52
    v_accvgpr_write_b32 a57, v53
    v_accvgpr_write_b32 a58, v54
    v_accvgpr_write_b32 a59, v55
    v_accvgpr_write_b32 a60, v56
    v_accvgpr_write_b32 a61, v57
    v_accvgpr_write_b32 a62, v58
    v_accvgpr_write_b32 a63, v59
    v_exp_f32 v52, v104
    v_exp_f32 v53, v105
    v_exp_f32 v54, v106
    v_exp_f32 v55, v107
    v_exp_f32 v56, v108
    v_exp_f32 v57, v109
    v_exp_f32 v58, v110
    v_exp_f32 v59, v111
    s_nop 0
    v_cvt_pk_bf16_f32 v148, v52, v53
    v_cvt_pk_bf16_f32 v149, v54, v55
    v_cvt_pk_bf16_f32 v150, v56, v57
    v_cvt_pk_bf16_f32 v151, v58, v59
    s_nop 1
    v_mfma_f32_16x16x32_bf16 v[32:35], v[44:47], v[148:151], 0
    s_nop 7
    s_setpc_b64 s[74:75]
m_rs1468:
    s_nop 15
    v_max3_f32 v48, v96, v97, v98
    v_max3_f32 v48, v48, v99, v100
    v_max3_f32 v48, v48, v101, v102
    v_max3_f32 v48, v48, v103, 0
    v_mov_b32 v49, v48
    s_nop 1
    v_permlane32_swap_b32 v48, v49
    s_nop 1
    v_max_f32 v48, v48, v49
    v_mov_b32 v49, v48
    s_nop 1
    v_permlane16_swap_b32 v48, v49
    s_nop 1
    v_max_f32 v48, v48, v49
    v_exp_f32 v49, -v48
    v_sub_f32 v96, v96, v48
    v_sub_f32 v97, v97, v48
    v_sub_f32 v98, v98, v48
    v_sub_f32 v99, v99, v48
    v_sub_f32 v100, v100, v48
    v_sub_f32 v101, v101, v48
    v_sub_f32 v102, v102, v48
    v_sub_f32 v103, v103, v48
    v_sub_f32 v64, v64, v48
    v_sub_f32 v65, v65, v48
    v_sub_f32 v66, v66, v48
    v_sub_f32 v67, v67, v48
    v_sub_f32 v68, v68, v48
    v_sub_f32 v69, v69, v48
    v_sub_f32 v70, v70, v48
    v_sub_f32 v71, v71, v48
    v_sub_f32 v160, v160, v48
    v_sub_f32 v161, v161, v48
    v_sub_f32 v162, v162, v48
    v_sub_f32 v163, v163, v48
    v_sub_f32 v164, v164, v48
    v_sub_f32 v165, v165, v48
    v_sub_f32 v166, v166, v48
    v_sub_f32 v167, v167, v48
    v_mul_f32 v12, v12, v49
    v_accvgpr_read_b32 v52, a0
    v_accvgpr_read_b32 v53, a1
    v_accvgpr_read_b32 v54, a2
    v_accvgpr_read_b32 v55, a3
    v_accvgpr_read_b32 v56, a4
    v_accvgpr_read_b32 v57, a5
    v_accvgpr_read_b32 v58, a6
    v_accvgpr_read_b32 v59, a7
    v_mul_f32 v52, v52, v49
    v_mul_f32 v53, v53, v49
    v_mul_f32 v54, v54, v49
    v_mul_f32 v55, v55, v49
    v_mul_f32 v56, v56, v49
    v_mul_f32 v57, v57, v49
    v_mul_f32 v58, v58, v49
    v_mul_f32 v59, v59, v49
    v_accvgpr_write_b32 a0, v52
    v_accvgpr_write_b32 a1, v53
    v_accvgpr_write_b32 a2, v54
    v_accvgpr_write_b32 a3, v55
    v_accvgpr_write_b32 a4, v56
    v_accvgpr_write_b32 a5, v57
    v_accvgpr_write_b32 a6, v58
    v_accvgpr_write_b32 a7, v59
    v_accvgpr_read_b32 v52, a8
    v_accvgpr_read_b32 v53, a9
    v_accvgpr_read_b32 v54, a10
    v_accvgpr_read_b32 v55, a11
    v_accvgpr_read_b32 v56, a12
    v_accvgpr_read_b32 v57, a13
    v_accvgpr_read_b32 v58, a14
    v_accvgpr_read_b32 v59, a15
    v_mul_f32 v52, v52, v49
    v_mul_f32 v53, v53, v49
    v_mul_f32 v54, v54, v49
    v_mul_f32 v55, v55, v49
    v_mul_f32 v56, v56, v49
    v_mul_f32 v57, v57, v49
    v_mul_f32 v58, v58, v49
    v_mul_f32 v59, v59, v49
    v_accvgpr_write_b32 a8, v52
    v_accvgpr_write_b32 a9, v53
    v_accvgpr_write_b32 a10, v54
    v_accvgpr_write_b32 a11, v55
    v_accvgpr_write_b32 a12, v56
    v_accvgpr_write_b32 a13, v57
    v_accvgpr_write_b32 a14, v58
    v_accvgpr_write_b32 a15, v59
    v_accvgpr_read_b32 v52, a16
    v_accvgpr_read_b32 v53, a17
    v_accvgpr_read_b32 v54, a18
    v_accvgpr_read_b32 v55, a19
    v_accvgpr_read_b32 v56, a20
    v_accvgpr_read_b32 v57, a21
    v_accvgpr_read_b32 v58, a22
    v_accvgpr_read_b32 v59, a23
    v_mul_f32 v52, v52, v49
    v_mul_f32 v53, v53, v49
    v_mul_f32 v54, v54, v49
    v_mul_f32 v55, v55, v49
    v_mul_f32 v56, v56, v49
    v_mul_f32 v57, v57, v49
    v_mul_f32 v58, v58, v49
    v_mul_f32 v59, v59, v49
    v_accvgpr_write_b32 a16, v52
    v_accvgpr_write_b32 a17, v53
    v_accvgpr_write_b32 a18, v54
    v_accvgpr_write_b32 a19, v55
    v_accvgpr_write_b32 a20, v56
    v_accvgpr_write_b32 a21, v57
    v_accvgpr_write_b32 a22, v58
    v_accvgpr_write_b32 a23, v59
    v_accvgpr_read_b32 v52, a24
    v_accvgpr_read_b32 v53, a25
    v_accvgpr_read_b32 v54, a26
    v_accvgpr_read_b32 v55, a27
    v_accvgpr_read_b32 v56, a28
    v_accvgpr_read_b32 v57, a29
    v_accvgpr_read_b32 v58, a30
    v_accvgpr_read_b32 v59, a31
    v_mul_f32 v52, v52, v49
    v_mul_f32 v53, v53, v49
    v_mul_f32 v54, v54, v49
    v_mul_f32 v55, v55, v49
    v_mul_f32 v56, v56, v49
    v_mul_f32 v57, v57, v49
    v_mul_f32 v58, v58, v49
    v_mul_f32 v59, v59, v49
    v_accvgpr_write_b32 a24, v52
    v_accvgpr_write_b32 a25, v53
    v_accvgpr_write_b32 a26, v54
    v_accvgpr_write_b32 a27, v55
    v_accvgpr_write_b32 a28, v56
    v_accvgpr_write_b32 a29, v57
    v_accvgpr_write_b32 a30, v58
    v_accvgpr_write_b32 a31, v59
    v_exp_f32 v52, v96
    v_exp_f32 v53, v97
    v_exp_f32 v54, v98
    v_exp_f32 v55, v99
    v_exp_f32 v56, v100
    v_exp_f32 v57, v101
    v_exp_f32 v58, v102
    v_exp_f32 v59, v103
    s_nop 0
    v_cvt_pk_bf16_f32 v144, v52, v53
    v_cvt_pk_bf16_f32 v145, v54, v55
    v_cvt_pk_bf16_f32 v146, v56, v57
    v_cvt_pk_bf16_f32 v147, v58, v59
    s_nop 1
    v_mfma_f32_16x16x32_bf16 v[28:31], v[44:47], v[144:147], 0
    v_max3_f32 v48, v104, v105, v106
    v_max3_f32 v48, v48, v107, v108
    v_max3_f32 v48, v48, v109, v110
    v_max3_f32 v48, v48, v111, 0
    v_mov_b32 v49, v48
    s_nop 1
    v_permlane32_swap_b32 v48, v49
    s_nop 1
    v_max_f32 v48, v48, v49
    v_mov_b32 v49, v48
    s_nop 1
    v_permlane16_swap_b32 v48, v49
    s_nop 1
    v_max_f32 v48, v48, v49
    v_exp_f32 v49, -v48
    v_sub_f32 v104, v104, v48
    v_sub_f32 v105, v105, v48
    v_sub_f32 v106, v106, v48
    v_sub_f32 v107, v107, v48
    v_sub_f32 v108, v108, v48
    v_sub_f32 v109, v109, v48
    v_sub_f32 v110, v110, v48
    v_sub_f32 v111, v111, v48
    v_sub_f32 v72, v72, v48
    v_sub_f32 v73, v73, v48
    v_sub_f32 v74, v74, v48
    v_sub_f32 v75, v75, v48
    v_sub_f32 v76, v76, v48
    v_sub_f32 v77, v77, v48
    v_sub_f32 v78, v78, v48
    v_sub_f32 v79, v79, v48
    v_sub_f32 v168, v168, v48
    v_sub_f32 v169, v169, v48
    v_sub_f32 v170, v170, v48
    v_sub_f32 v171, v171, v48
    v_sub_f32 v172, v172, v48
    v_sub_f32 v173, v173, v48
    v_sub_f32 v174, v174, v48
    v_sub_f32 v175, v175, v48
    v_mul_f32 v13, v13, v49
    v_accvgpr_read_b32 v52, a32
    v_accvgpr_read_b32 v53, a33
    v_accvgpr_read_b32 v54, a34
    v_accvgpr_read_b32 v55, a35
    v_accvgpr_read_b32 v56, a36
    v_accvgpr_read_b32 v57, a37
    v_accvgpr_read_b32 v58, a38
    v_accvgpr_read_b32 v59, a39
    v_mul_f32 v52, v52, v49
    v_mul_f32 v53, v53, v49
    v_mul_f32 v54, v54, v49
    v_mul_f32 v55, v55, v49
    v_mul_f32 v56, v56, v49
    v_mul_f32 v57, v57, v49
    v_mul_f32 v58, v58, v49
    v_mul_f32 v59, v59, v49
    v_accvgpr_write_b32 a32, v52
    v_accvgpr_write_b32 a33, v53
    v_accvgpr_write_b32 a34, v54
    v_accvgpr_write_b32 a35, v55
    v_accvgpr_write_b32 a36, v56
    v_accvgpr_write_b32 a37, v57
    v_accvgpr_write_b32 a38, v58
    v_accvgpr_write_b32 a39, v59
    v_accvgpr_read_b32 v52, a40
    v_accvgpr_read_b32 v53, a41
    v_accvgpr_read_b32 v54, a42
    v_accvgpr_read_b32 v55, a43
    v_accvgpr_read_b32 v56, a44
    v_accvgpr_read_b32 v57, a45
    v_accvgpr_read_b32 v58, a46
    v_accvgpr_read_b32 v59, a47
    v_mul_f32 v52, v52, v49
    v_mul_f32 v53, v53, v49
    v_mul_f32 v54, v54, v49
    v_mul_f32 v55, v55, v49
    v_mul_f32 v56, v56, v49
    v_mul_f32 v57, v57, v49
    v_mul_f32 v58, v58, v49
    v_mul_f32 v59, v59, v49
    v_accvgpr_write_b32 a40, v52
    v_accvgpr_write_b32 a41, v53
    v_accvgpr_write_b32 a42, v54
    v_accvgpr_write_b32 a43, v55
    v_accvgpr_write_b32 a44, v56
    v_accvgpr_write_b32 a45, v57
    v_accvgpr_write_b32 a46, v58
    v_accvgpr_write_b32 a47, v59
    v_accvgpr_read_b32 v52, a48
    v_accvgpr_read_b32 v53, a49
    v_accvgpr_read_b32 v54, a50
    v_accvgpr_read_b32 v55, a51
    v_accvgpr_read_b32 v56, a52
    v_accvgpr_read_b32 v57, a53
    v_accvgpr_read_b32 v58, a54
    v_accvgpr_read_b32 v59, a55
    v_mul_f32 v52, v52, v49
    v_mul_f32 v53, v53, v49
    v_mul_f32 v54, v54, v49
    v_mul_f32 v55, v55, v49
    v_mul_f32 v56, v56, v49
    v_mul_f32 v57, v57, v49
    v_mul_f32 v58, v58, v49
    v_mul_f32 v59, v59, v49
    v_accvgpr_write_b32 a48, v52
    v_accvgpr_write_b32 a49, v53
    v_accvgpr_write_b32 a50, v54
    v_accvgpr_write_b32 a51, v55
    v_accvgpr_write_b32 a52, v56
    v_accvgpr_write_b32 a53, v57
    v_accvgpr_write_b32 a54, v58
    v_accvgpr_write_b32 a55, v59
    v_accvgpr_read_b32 v52, a56
    v_accvgpr_read_b32 v53, a57
    v_accvgpr_read_b32 v54, a58
    v_accvgpr_read_b32 v55, a59
    v_accvgpr_read_b32 v56, a60
    v_accvgpr_read_b32 v57, a61
    v_accvgpr_read_b32 v58, a62
    v_accvgpr_read_b32 v59, a63
    v_mul_f32 v52, v52, v49
    v_mul_f32 v53, v53, v49
    v_mul_f32 v54, v54, v49
    v_mul_f32 v55, v55, v49
    v_mul_f32 v56, v56, v49
    v_mul_f32 v57, v57, v49
    v_mul_f32 v58, v58, v49
    v_mul_f32 v59, v59, v49
    v_accvgpr_write_b32 a56, v52
    v_accvgpr_write_b32 a57, v53
    v_accvgpr_write_b32 a58, v54
    v_accvgpr_write_b32 a59, v55
    v_accvgpr_write_b32 a60, v56
    v_accvgpr_write_b32 a61, v57
    v_accvgpr_write_b32 a62, v58
    v_accvgpr_write_b32 a63, v59
    v_exp_f32 v52, v104
    v_exp_f32 v53, v105
    v_exp_f32 v54, v106
    v_exp_f32 v55, v107
    v_exp_f32 v56, v108
    v_exp_f32 v57, v109
    v_exp_f32 v58, v110
    v_exp_f32 v59, v111
    s_nop 0
    v_cvt_pk_bf16_f32 v148, v52, v53
    v_cvt_pk_bf16_f32 v149, v54, v55
    v_cvt_pk_bf16_f32 v150, v56, v57
    v_cvt_pk_bf16_f32 v151, v58, v59
    s_nop 1
    v_mfma_f32_16x16x32_bf16 v[32:35], v[44:47], v[148:151], 0
    v_max3_f32 v48, v112, v113, v114
    v_max3_f32 v48, v48, v115, v116
    v_max3_f32 v48, v48, v117, v118
    v_max3_f32 v48, v48, v119, 0
    v_mov_b32 v49, v48
    s_nop 1
    v_permlane32_swap_b32 v48, v49
    s_nop 1
    v_max_f32 v48, v48, v49
    v_mov_b32 v49, v48
    s_nop 1
    v_permlane16_swap_b32 v48, v49
    s_nop 1
    v_max_f32 v48, v48, v49
    v_exp_f32 v49, -v48
    v_sub_f32 v112, v112, v48
    v_sub_f32 v113, v113, v48
    v_sub_f32 v114, v114, v48
    v_sub_f32 v115, v115, v48
    v_sub_f32 v116, v116, v48
    v_sub_f32 v117, v117, v48
    v_sub_f32 v118, v118, v48
    v_sub_f32 v119, v119, v48
    v_sub_f32 v80, v80, v48
    v_sub_f32 v81, v81, v48
    v_sub_f32 v82, v82, v48
    v_sub_f32 v83, v83, v48
    v_sub_f32 v84, v84, v48
    v_sub_f32 v85, v85, v48
    v_sub_f32 v86, v86, v48
    v_sub_f32 v87, v87, v48
    v_sub_f32 v176, v176, v48
    v_sub_f32 v177, v177, v48
    v_sub_f32 v178, v178, v48
    v_sub_f32 v179, v179, v48
    v_sub_f32 v180, v180, v48
    v_sub_f32 v181, v181, v48
    v_sub_f32 v182, v182, v48
    v_sub_f32 v183, v183, v48
    v_mul_f32 v14, v14, v49
    v_accvgpr_read_b32 v52, a64
    v_accvgpr_read_b32 v53, a65
    v_accvgpr_read_b32 v54, a66
    v_accvgpr_read_b32 v55, a67
    v_accvgpr_read_b32 v56, a68
    v_accvgpr_read_b32 v57, a69
    v_accvgpr_read_b32 v58, a70
    v_accvgpr_read_b32 v59, a71
    v_mul_f32 v52, v52, v49
    v_mul_f32 v53, v53, v49
    v_mul_f32 v54, v54, v49
    v_mul_f32 v55, v55, v49
    v_mul_f32 v56, v56, v49
    v_mul_f32 v57, v57, v49
    v_mul_f32 v58, v58, v49
    v_mul_f32 v59, v59, v49
    v_accvgpr_write_b32 a64, v52
    v_accvgpr_write_b32 a65, v53
    v_accvgpr_write_b32 a66, v54
    v_accvgpr_write_b32 a67, v55
    v_accvgpr_write_b32 a68, v56
    v_accvgpr_write_b32 a69, v57
    v_accvgpr_write_b32 a70, v58
    v_accvgpr_write_b32 a71, v59
    v_accvgpr_read_b32 v52, a72
    v_accvgpr_read_b32 v53, a73
    v_accvgpr_read_b32 v54, a74
    v_accvgpr_read_b32 v55, a75
    v_accvgpr_read_b32 v56, a76
    v_accvgpr_read_b32 v57, a77
    v_accvgpr_read_b32 v58, a78
    v_accvgpr_read_b32 v59, a79
    v_mul_f32 v52, v52, v49
    v_mul_f32 v53, v53, v49
    v_mul_f32 v54, v54, v49
    v_mul_f32 v55, v55, v49
    v_mul_f32 v56, v56, v49
    v_mul_f32 v57, v57, v49
    v_mul_f32 v58, v58, v49
    v_mul_f32 v59, v59, v49
    v_accvgpr_write_b32 a72, v52
    v_accvgpr_write_b32 a73, v53
    v_accvgpr_write_b32 a74, v54
    v_accvgpr_write_b32 a75, v55
    v_accvgpr_write_b32 a76, v56
    v_accvgpr_write_b32 a77, v57
    v_accvgpr_write_b32 a78, v58
    v_accvgpr_write_b32 a79, v59
    v_accvgpr_read_b32 v52, a80
    v_accvgpr_read_b32 v53, a81
    v_accvgpr_read_b32 v54, a82
    v_accvgpr_read_b32 v55, a83
    v_accvgpr_read_b32 v56, a84
    v_accvgpr_read_b32 v57, a85
    v_accvgpr_read_b32 v58, a86
    v_accvgpr_read_b32 v59, a87
    v_mul_f32 v52, v52, v49
    v_mul_f32 v53, v53, v49
    v_mul_f32 v54, v54, v49
    v_mul_f32 v55, v55, v49
    v_mul_f32 v56, v56, v49
    v_mul_f32 v57, v57, v49
    v_mul_f32 v58, v58, v49
    v_mul_f32 v59, v59, v49
    v_accvgpr_write_b32 a80, v52
    v_accvgpr_write_b32 a81, v53
    v_accvgpr_write_b32 a82, v54
    v_accvgpr_write_b32 a83, v55
    v_accvgpr_write_b32 a84, v56
    v_accvgpr_write_b32 a85, v57
    v_accvgpr_write_b32 a86, v58
    v_accvgpr_write_b32 a87, v59
    v_accvgpr_read_b32 v52, a88
    v_accvgpr_read_b32 v53, a89
    v_accvgpr_read_b32 v54, a90
    v_accvgpr_read_b32 v55, a91
    v_accvgpr_read_b32 v56, a92
    v_accvgpr_read_b32 v57, a93
    v_accvgpr_read_b32 v58, a94
    v_accvgpr_read_b32 v59, a95
    v_mul_f32 v52, v52, v49
    v_mul_f32 v53, v53, v49
    v_mul_f32 v54, v54, v49
    v_mul_f32 v55, v55, v49
    v_mul_f32 v56, v56, v49
    v_mul_f32 v57, v57, v49
    v_mul_f32 v58, v58, v49
    v_mul_f32 v59, v59, v49
    v_accvgpr_write_b32 a88, v52
    v_accvgpr_write_b32 a89, v53
    v_accvgpr_write_b32 a90, v54
    v_accvgpr_write_b32 a91, v55
    v_accvgpr_write_b32 a92, v56
    v_accvgpr_write_b32 a93, v57
    v_accvgpr_write_b32 a94, v58
    v_accvgpr_write_b32 a95, v59
    v_exp_f32 v52, v112
    v_exp_f32 v53, v113
    v_exp_f32 v54, v114
    v_exp_f32 v55, v115
    v_exp_f32 v56, v116
    v_exp_f32 v57, v117
    v_exp_f32 v58, v118
    v_exp_f32 v59, v119
    s_nop 0
    v_cvt_pk_bf16_f32 v152, v52, v53
    v_cvt_pk_bf16_f32 v153, v54, v55
    v_cvt_pk_bf16_f32 v154, v56, v57
    v_cvt_pk_bf16_f32 v155, v58, v59
    s_nop 1
    v_mfma_f32_16x16x32_bf16 v[36:39], v[44:47], v[152:155], 0
    v_max3_f32 v48, v120, v121, v122
    v_max3_f32 v48, v48, v123, v124
    v_max3_f32 v48, v48, v125, v126
    v_max3_f32 v48, v48, v127, 0
    v_mov_b32 v49, v48
    s_nop 1
    v_permlane32_swap_b32 v48, v49
    s_nop 1
    v_max_f32 v48, v48, v49
    v_mov_b32 v49, v48
    s_nop 1
    v_permlane16_swap_b32 v48, v49
    s_nop 1
    v_max_f32 v48, v48, v49
    v_exp_f32 v49, -v48
    v_sub_f32 v120, v120, v48
    v_sub_f32 v121, v121, v48
    v_sub_f32 v122, v122, v48
    v_sub_f32 v123, v123, v48
    v_sub_f32 v124, v124, v48
    v_sub_f32 v125, v125, v48
    v_sub_f32 v126, v126, v48
    v_sub_f32 v127, v127, v48
    v_sub_f32 v88, v88, v48
    v_sub_f32 v89, v89, v48
    v_sub_f32 v90, v90, v48
    v_sub_f32 v91, v91, v48
    v_sub_f32 v92, v92, v48
    v_sub_f32 v93, v93, v48
    v_sub_f32 v94, v94, v48
    v_sub_f32 v95, v95, v48
    v_sub_f32 v184, v184, v48
    v_sub_f32 v185, v185, v48
    v_sub_f32 v186, v186, v48
    v_sub_f32 v187, v187, v48
    v_sub_f32 v188, v188, v48
    v_sub_f32 v189, v189, v48
    v_sub_f32 v190, v190, v48
    v_sub_f32 v191, v191, v48
    v_mul_f32 v15, v15, v49
    v_accvgpr_read_b32 v52, a96
    v_accvgpr_read_b32 v53, a97
    v_accvgpr_read_b32 v54, a98
    v_accvgpr_read_b32 v55, a99
    v_accvgpr_read_b32 v56, a100
    v_accvgpr_read_b32 v57, a101
    v_accvgpr_read_b32 v58, a102
    v_accvgpr_read_b32 v59, a103
    v_mul_f32 v52, v52, v49
    v_mul_f32 v53, v53, v49
    v_mul_f32 v54, v54, v49
    v_mul_f32 v55, v55, v49
    v_mul_f32 v56, v56, v49
    v_mul_f32 v57, v57, v49
    v_mul_f32 v58, v58, v49
    v_mul_f32 v59, v59, v49
    v_accvgpr_write_b32 a96, v52
    v_accvgpr_write_b32 a97, v53
    v_accvgpr_write_b32 a98, v54
    v_accvgpr_write_b32 a99, v55
    v_accvgpr_write_b32 a100, v56
    v_accvgpr_write_b32 a101, v57
    v_accvgpr_write_b32 a102, v58
    v_accvgpr_write_b32 a103, v59
    v_accvgpr_read_b32 v52, a104
    v_accvgpr_read_b32 v53, a105
    v_accvgpr_read_b32 v54, a106
    v_accvgpr_read_b32 v55, a107
    v_accvgpr_read_b32 v56, a108
    v_accvgpr_read_b32 v57, a109
    v_accvgpr_read_b32 v58, a110
    v_accvgpr_read_b32 v59, a111
    v_mul_f32 v52, v52, v49
    v_mul_f32 v53, v53, v49
    v_mul_f32 v54, v54, v49
    v_mul_f32 v55, v55, v49
    v_mul_f32 v56, v56, v49
    v_mul_f32 v57, v57, v49
    v_mul_f32 v58, v58, v49
    v_mul_f32 v59, v59, v49
    v_accvgpr_write_b32 a104, v52
    v_accvgpr_write_b32 a105, v53
    v_accvgpr_write_b32 a106, v54
    v_accvgpr_write_b32 a107, v55
    v_accvgpr_write_b32 a108, v56
    v_accvgpr_write_b32 a109, v57
    v_accvgpr_write_b32 a110, v58
    v_accvgpr_write_b32 a111, v59
    v_accvgpr_read_b32 v52, a112
    v_accvgpr_read_b32 v53, a113
    v_accvgpr_read_b32 v54, a114
    v_accvgpr_read_b32 v55, a115
    v_accvgpr_read_b32 v56, a116
    v_accvgpr_read_b32 v57, a117
    v_accvgpr_read_b32 v58, a118
    v_accvgpr_read_b32 v59, a119
    v_mul_f32 v52, v52, v49
    v_mul_f32 v53, v53, v49
    v_mul_f32 v54, v54, v49
    v_mul_f32 v55, v55, v49
    v_mul_f32 v56, v56, v49
    v_mul_f32 v57, v57, v49
    v_mul_f32 v58, v58, v49
    v_mul_f32 v59, v59, v49
    v_accvgpr_write_b32 a112, v52
    v_accvgpr_write_b32 a113, v53
    v_accvgpr_write_b32 a114, v54
    v_accvgpr_write_b32 a115, v55
    v_accvgpr_write_b32 a116, v56
    v_accvgpr_write_b32 a117, v57
    v_accvgpr_write_b32 a118, v58
    v_accvgpr_write_b32 a119, v59
    v_accvgpr_read_b32 v52, a120
    v_accvgpr_read_b32 v53, a121
    v_accvgpr_read_b32 v54, a122
    v_accvgpr_read_b32 v55, a123
    v_accvgpr_read_b32 v56, a124
    v_accvgpr_read_b32 v57, a125
    v_accvgpr_read_b32 v58, a126
    v_accvgpr_read_b32 v59, a127
    v_mul_f32 v52, v52, v49
    v_mul_f32 v53, v53, v49
    v_mul_f32 v54, v54, v49
    v_mul_f32 v55, v55, v49
    v_mul_f32 v56, v56, v49
    v_mul_f32 v57, v57, v49
    v_mul_f32 v58, v58, v49
    v_mul_f32 v59, v59, v49
    v_accvgpr_write_b32 a120, v52
    v_accvgpr_write_b32 a121, v53
    v_accvgpr_write_b32 a122, v54
    v_accvgpr_write_b32 a123, v55
    v_accvgpr_write_b32 a124, v56
    v_accvgpr_write_b32 a125, v57
    v_accvgpr_write_b32 a126, v58
    v_accvgpr_write_b32 a127, v59
    v_exp_f32 v52, v120
    v_exp_f32 v53, v121
    v_exp_f32 v54, v122
    v_exp_f32 v55, v123
    v_exp_f32 v56, v124
    v_exp_f32 v57, v125
    v_exp_f32 v58, v126
    v_exp_f32 v59, v127
    s_nop 0
    v_cvt_pk_bf16_f32 v156, v52, v53
    v_cvt_pk_bf16_f32 v157, v54, v55
    v_cvt_pk_bf16_f32 v158, v56, v57
    v_cvt_pk_bf16_f32 v159, v58, v59
    s_nop 1
    v_mfma_f32_16x16x32_bf16 v[40:43], v[44:47], v[156:159], 0
    s_nop 7
    s_setpc_b64 s[74:75]
m_hook17:
    s_cmp_lg_u32 s16, 0
    s_cbranch_scc1 m_np35
    v_mov_b32 v4, s4
    v_mov_b32 v5, s5
    s_add_u32 s90, s17, 117440512
    s_mov_b64 exec, 1
    buffer_store_dwordx2 v[4:5], off, s[8:11], s90 sc1
    s_mov_b64 exec, -1
m_np35:
    s_mov_b32 s17, -1
    s_branch m_hookr18
m_hook21:
    s_cmp_lg_u32 s16, 0
    s_cbranch_scc1 m_np36
    v_mov_b32 v4, s4
    v_mov_b32 v5, s5
    s_add_u32 s90, s17, 117440512
    s_mov_b64 exec, 1
    buffer_store_dwordx2 v[4:5], off, s[8:11], s90 sc1
    s_mov_b64 exec, -1
m_np36:
    s_mov_b32 s17, -1
    s_branch m_hookr22
m_dosw20:
    s_cmp_eq_u32 s94, 0
    s_cbranch_scc1 m_x37
    s_cmp_lg_u32 s65, 3
    s_cbranch_scc1 m_x43
    s_mov_b32 s42, s73
    s_lshl_b32 s90, s77, 4
    s_lshl_b32 s90, s90, s81
    s_mov_b32 s48, s79
    s_mul_i32 s91, s90, 1
    s_add_u32 s49, s91, s79
    s_sub_u32 s49, s49, 2048
    s_mul_i32 s91, s90, 2
    s_add_u32 s50, s91, s79
    s_mul_i32 s91, s90, 3
    s_add_u32 s51, s91, s79
    s_sub_u32 s51, s51, 2048
    s_lshl_b32 s90, s58, 7
    s_add_u32 s90, s90, s57
    s_lshl_b32 s91, s16, 6
    s_cmp_eq_u32 s81, 1
    s_cselect_b32 s90, s90, s91
    v_lshrrev_b32 v24, 3, v1
    v_lshlrev_b32 v24, s81, v24
    v_add_u32 v24, s90, v24
    v_mul_lo_u32 v24, v24, s77
    v_lshrrev_b32 v25, 4, v1
    v_and_b32 v26, 7, v1
    v_xor_b32 v25, v25, v26
    v_lshl_add_u32 v16, v25, 4, v24
    v_xor_b32 v25, 4, v25
    v_lshl_add_u32 v17, v25, 4, v24
    s_lshl_b32 s90, s77, 3
    s_lshl_b32 s90, s90, s81
    s_sub_u32 s90, s90, 1024
    v_add_u32 v17, s90, v17
    s_mov_b32 s40, s71
    s_mov_b32 s41, s72
    buffer_load_dwordx2 v[4:5], off, s[12:15], 0 sc1
    s_branch m_loop19
m_x43:
    s_mov_b32 s46, s76
    s_mov_b32 s52, s80
    s_lshl_b32 s90, s78, 2
    s_mul_i32 s91, s90, 1
    s_add_u32 s53, s91, s80
    s_sub_u32 s53, s53, 2048
    s_mul_i32 s91, s90, 2
    s_add_u32 s54, s91, s80
    s_mul_i32 s91, s90, 3
    s_add_u32 s55, s91, s80
    s_sub_u32 s55, s55, 2048
    s_lshl_b32 s56, s78, 6
    v_lshrrev_b32 v24, 5, v1
    s_lshl_b32 s90, s16, 4
    v_add_u32 v25, s90, v24
    v_mul_lo_u32 v25, v25, s78
    v_lshlrev_b32 v24, 1, v24
    v_and_b32 v26, 31, v1
    v_xor_b32 v24, v24, v26
    s_lshl_b32 s90, s78, 1
    s_sub_u32 s90, s90, 1024
    v_add_u32 v27, s90, v25
    v_xor_b32 v26, 0, v24
    v_lshl_add_u32 v18, v26, 4, v25
    v_xor_b32 v26, 4, v24
    v_lshl_add_u32 v19, v26, 4, v27
    v_xor_b32 v26, 8, v24
    v_lshl_add_u32 v20, v26, 4, v25
    v_xor_b32 v26, 12, v24
    v_lshl_add_u32 v21, v26, 4, v27
    s_mov_b32 s44, s74
    s_mov_b32 s45, s75
    s_mov_b32 s67, 0
    s_branch m_loop19
m_x37:
    s_cmp_le_u32 s65, 4
    s_cbranch_scc1 m_x38
    s_cmp_lg_u32 s16, 0
    s_cbranch_scc1 m_np44
    v_mov_b32 v4, s4
    v_mov_b32 v5, s5
    s_add_u32 s90, s17, 117440512
    s_mov_b64 exec, 1
    buffer_store_dwordx2 v[4:5], off, s[8:11], s90 sc1
    s_mov_b64 exec, -1
m_np44:
    s_mov_b32 s17, -1
    s_mov_b32 s67, 4
    s_branch m_loop19
m_x38:
    s_cmp_lg_u32 s65, 4
    s_cbranch_scc1 m_x39
    s_and_b32 s92, s2, 7
    s_lshl_b32 s92, s92, 2
    s_bfe_u32 s93, s2, 0x20003
    s_add_u32 s92, s92, s93
    s_lshr_b32 s93, s2, 5
    s_lshl_b32 s93, s93, 2
    s_or_b32 s93, s93, 0x40000
    s_lshr_b32 s90, s92, 1
    s_lshl_b32 s90, s90, 7
    s_add_u32 s90, s90, 117440512
    v_and_b32 v0, 3, v1
    v_min_u32 v0, 2, v0
    v_and_b32 v4, 4, v1
    v_add3_u32 v0, v0, v4, 8
    v_lshlrev_b32 v0, 3, v0
    buffer_load_dwordx2 v[4:5], v0, s[8:11], s90 offen sc1
    s_branch m_loop19
m_x39:
    s_waitcnt vmcnt(16)
    s_cmp_lg_u32 s65, 3
    s_cbranch_scc1 m_x40
    s_mov_b32 s3, 1048576
m_spin45:
    v_cmp_ne_u64 s[22:23], s[4:5], v[4:5]
    s_nop 3
    s_cmp_eq_u64 s[22:23], 0
    s_cbranch_scc1 m_ok46
    s_sub_u32 s3, s3, 1
    s_cbranch_scc1 m_ok46
    s_sleep 16
    s_and_b32 s92, s2, 7
    s_lshl_b32 s92, s92, 2
    s_bfe_u32 s93, s2, 0x20003
    s_add_u32 s92, s92, s93
    s_lshr_b32 s93, s2, 5
    s_lshl_b32 s93, s93, 2
    s_or_b32 s93, s93, 0x40000
    s_lshr_b32 s90, s92, 1
    s_lshl_b32 s90, s90, 7
    s_add_u32 s90, s90, 117440512
    v_and_b32 v0, 3, v1
    v_min_u32 v0, 2, v0
    v_and_b32 v4, 4, v1
    v_add3_u32 v0, v0, v4, 8
    v_lshlrev_b32 v0, 3, v0
    buffer_load_dwordx2 v[4:5], v0, s[8:11], s90 offen sc1
    s_waitcnt vmcnt(0)
    s_branch m_spin45
m_ok46:
    s_and_b32 s92, s2, 7
    s_lshl_b32 s92, s92, 2
    s_bfe_u32 s93, s2, 0x20003
    s_add_u32 s92, s92, s93
    s_lshr_b32 s93, s2, 5
    s_lshl_b32 s93, s93, 2
    s_or_b32 s93, s93, 0x40000
    s_lshl_b32 s90, s92, 19
    s_lshl_b32 s91, s58, 13
    s_add_u32 s90, s90, s91
    s_cmp_eq_u32 s57, 0
    s_mov_b32 s91, 33554432
    s_cselect_b32 s91, 16777216, s91
    s_mov_b32 s42, 0
    s_cselect_b32 s42, 268435456, s42
    s_add_u32 s48, s90, s91
    s_mov_b32 s49, s48
    s_add_u32 s50, s48, 4096
    s_mov_b32 s51, s50
    s_mov_b32 s40, s6
    s_mov_b32 s41, s7
    v_mov_b32 v16, v2
    v_mov_b32 v17, v2
    s_branch m_loop19
m_x40:
    s_cmp_lg_u32 s65, 2
    s_cbranch_scc1 m_x41
    s_and_b32 s92, s2, 7
    s_lshl_b32 s92, s92, 2
    s_bfe_u32 s93, s2, 0x20003
    s_add_u32 s92, s92, s93
    s_lshr_b32 s93, s2, 5
    s_lshl_b32 s93, s93, 2
    s_or_b32 s93, s93, 0x40000
    s_lshr_b32 s90, s92, 1
    s_lshl_b32 s90, s90, 7
    s_add_u32 s90, s90, 117440512
    s_bfe_u32 s91, 873473623, s93
    s_lshr_b32 s91, s91, 1
    v_mov_b32 v0, s91
    s_bfe_u32 s91, 4225681832, s93
    s_lshr_b32 s91, s91, 1
    v_writelane_b32 v0, s91, 8
    v_lshlrev_b32 v0, 3, v0
    buffer_load_dwordx2 v[4:5], v0, s[8:11], s90 offen sc1
    s_lshl_b32 s90, s92, 19
    s_lshl_b32 s91, s58, 13
    s_add_u32 s90, s90, s91
    s_cmp_eq_u32 s57, 0
    s_mov_b32 s91, 33554432
    s_cselect_b32 s91, 16793600, s91
    s_mov_b32 s42, 268435456
    s_cselect_b32 s42, 268435456, s42
    s_add_u32 s48, s90, s91
    s_mov_b32 s49, s48
    s_add_u32 s50, s48, 4096
    s_mov_b32 s51, s50
    s_mov_b32 s40, s6
    s_mov_b32 s41, s7
    s_lshl_b32 s90, s92, 19
    s_lshl_b32 s91, s58, 13
    s_add_u32 s90, s90, s91
    s_cmp_eq_u32 s57, 0
    s_mov_b32 s91, 33587200
    s_cselect_b32 s91, 16826368, s91
    s_mov_b32 s46, 268435456
    s_cselect_b32 s46, 268435456, s46
    s_add_u32 s52, s90, s91
    s_mov_b32 s53, s52
    s_add_u32 s54, s52, 4096
    s_mov_b32 s55, s54
    s_mov_b32 s44, s6
    s_mov_b32 s45, s7
    v_mov_b32 v18, v2
    v_mov_b32 v19, v2
    v_mov_b32 v20, v2
    v_mov_b32 v21, v2
    s_branch m_loop19
m_x41:
    s_mov_b32 s3, 1048576
m_spin47:
    v_cmp_ne_u64 s[22:23], s[4:5], v[4:5]
    s_nop 3
    s_cmp_eq_u64 s[22:23], 0
    s_cbranch_scc1 m_ok48
    s_sub_u32 s3, s3, 1
    s_cbranch_scc1 m_ok48
    s_sleep 16
    s_and_b32 s92, s2, 7
    s_lshl_b32 s92, s92, 2
    s_bfe_u32 s93, s2, 0x20003
    s_add_u32 s92, s92, s93
    s_lshr_b32 s93, s2, 5
    s_lshl_b32 s93, s93, 2
    s_or_b32 s93, s93, 0x40000
    s_lshr_b32 s90, s92, 1
    s_lshl_b32 s90, s90, 7
    s_add_u32 s90, s90, 117440512
    s_bfe_u32 s91, 873473623, s93
    s_lshr_b32 s91, s91, 1
    v_mov_b32 v0, s91
    s_bfe_u32 s91, 4225681832, s93
    s_lshr_b32 s91, s91, 1
    v_writelane_b32 v0, s91, 8
    v_lshlrev_b32 v0, 3, v0
    buffer_load_dwordx2 v[4:5], v0, s[8:11], s90 offen sc1
    s_waitcnt vmcnt(0)
    s_branch m_spin47
m_ok48:
    s_and_b32 s92, s2, 7
    s_lshl_b32 s92, s92, 2
    s_bfe_u32 s93, s2, 0x20003
    s_add_u32 s92, s92, s93
    s_lshr_b32 s93, s2, 5
    s_lshl_b32 s93, s93, 2
    s_or_b32 s93, s93, 0x40000
    s_bfe_u32 s90, 4225681832, s93
    s_lshl_b32 s90, s90, 3
    s_lshl_b32 s91, s16, 1
    s_add_u32 s90, s90, s91
    s_lshl_b32 s90, s90, 12
    s_lshl_b32 s91, s92, 19
    s_add_u32 s90, s90, s91
    s_add_u32 s90, s90, 0
    buffer_load_dwordx4 a[128:131], v2, s[8:11], s90 offen offset:0 sc1
    buffer_load_dwordx4 a[132:135], v2, s[8:11], s90 offen offset:1024 sc1
    buffer_load_dwordx4 a[136:139], v2, s[8:11], s90 offen offset:2048 sc1
    buffer_load_dwordx4 a[140:143], v2, s[8:11], s90 offen offset:3072 sc1
    s_bfe_u32 s90, 4225681832, s93
    s_lshl_b32 s90, s90, 3
    s_lshl_b32 s91, s16, 1
    s_add_u32 s90, s90, s91
    s_lshl_b32 s90, s90, 12
    s_lshl_b32 s91, s92, 19
    s_add_u32 s90, s90, s91
    s_add_u32 s90, s90, 4096
    buffer_load_dwordx4 a[144:147], v2, s[8:11], s90 offen offset:0 sc1
    buffer_load_dwordx4 a[148:151], v2, s[8:11], s90 offen offset:1024 sc1
    buffer_load_dwordx4 a[152:155], v2, s[8:11], s90 offen offset:2048 sc1
    buffer_load_dwordx4 a[156:159], v2, s[8:11], s90 offen offset:3072 sc1
    s_bfe_u32 s90, 873473623, s93
    s_lshl_b32 s90, s90, 3
    s_lshl_b32 s91, s16, 1
    s_add_u32 s90, s90, s91
    s_lshl_b32 s90, s90, 12
    s_lshl_b32 s91, s92, 19
    s_add_u32 s90, s90, s91
    s_add_u32 s90, s90, 0
    buffer_load_dwordx4 a[160:163], v2, s[8:11], s90 offen offset:0 sc1
    buffer_load_dwordx4 a[164:167], v2, s[8:11], s90 offen offset:1024 sc1
    buffer_load_dwordx4 a[168:171], v2, s[8:11], s90 offen offset:2048 sc1
    buffer_load_dwordx4 a[172:175], v2, s[8:11], s90 offen offset:3072 sc1
    s_bfe_u32 s90, 873473623, s93
    s_lshl_b32 s90, s90, 3
    s_lshl_b32 s91, s16, 1
    s_add_u32 s90, s90, s91
    s_lshl_b32 s90, s90, 12
    s_lshl_b32 s91, s92, 19
    s_add_u32 s90, s90, s91
    s_add_u32 s90, s90, 4096
    buffer_load_dwordx4 a[176:179], v2, s[8:11], s90 offen offset:0 sc1
    buffer_load_dwordx4 a[180:183], v2, s[8:11], s90 offen offset:1024 sc1
    buffer_load_dwordx4 a[184:187], v2, s[8:11], s90 offen offset:2048 sc1
    buffer_load_dwordx4 a[188:191], v2, s[8:11], s90 offen offset:3072 sc1
    s_lshl_b32 s90, s92, 19
    s_lshl_b32 s91, s58, 13
    s_add_u32 s90, s90, s91
    s_cmp_eq_u32 s57, 0
    s_mov_b32 s91, 33570816
    s_cselect_b32 s91, 16809984, s91
    s_mov_b32 s42, 268435456
    s_cselect_b32 s42, 268435456, s42
    s_add_u32 s48, s90, s91
    s_mov_b32 s49, s48
    s_add_u32 s50, s48, 4096
    s_mov_b32 s51, s50
    s_mov_b32 s40, s6
    s_mov_b32 s41, s7
    s_lshl_b32 s90, s92, 19
    s_lshl_b32 s91, s58, 13
    s_add_u32 s90, s90, s91
    s_cmp_eq_u32 s57, 0
    s_mov_b32 s91, 33603584
    s_cselect_b32 s91, 16842752, s91
    s_mov_b32 s46, 268435456
    s_cselect_b32 s46, 268435456, s46
    s_add_u32 s52, s90, s91
    s_mov_b32 s53, s52
    s_add_u32 s54, s52, 4096
    s_mov_b32 s55, s54
    s_mov_b32 s44, s6
    s_mov_b32 s45, s7
    s_branch m_loop19
m_dosw24:
    s_cmp_eq_u32 s94, 0
    s_cbranch_scc1 m_x49
    s_cmp_lg_u32 s65, 3
    s_cbranch_scc1 m_x55
    s_mov_b32 s42, s73
    s_lshl_b32 s90, s77, 4
    s_lshl_b32 s90, s90, s81
    s_mov_b32 s48, s79
    s_mul_i32 s91, s90, 1
    s_add_u32 s49, s91, s79
    s_sub_u32 s49, s49, 2048
    s_mul_i32 s91, s90, 2
    s_add_u32 s50, s91, s79
    s_mul_i32 s91, s90, 3
    s_add_u32 s51, s91, s79
    s_sub_u32 s51, s51, 2048
    s_lshl_b32 s90, s58, 7
    s_add_u32 s90, s90, s57
    s_lshl_b32 s91, s16, 6
    s_cmp_eq_u32 s81, 1
    s_cselect_b32 s90, s90, s91
    v_lshrrev_b32 v24, 3, v1
    v_lshlrev_b32 v24, s81, v24
    v_add_u32 v24, s90, v24
    v_mul_lo_u32 v24, v24, s77
    v_lshrrev_b32 v25, 4, v1
    v_and_b32 v26, 7, v1
    v_xor_b32 v25, v25, v26
    v_lshl_add_u32 v16, v25, 4, v24
    v_xor_b32 v25, 4, v25
    v_lshl_add_u32 v17, v25, 4, v24
    s_lshl_b32 s90, s77, 3
    s_lshl_b32 s90, s90, s81
    s_sub_u32 s90, s90, 1024
    v_add_u32 v17, s90, v17
    s_mov_b32 s40, s71
    s_mov_b32 s41, s72
    buffer_load_dwordx2 v[4:5], off, s[12:15], 0 sc1
    s_branch m_loop23
m_x55:
    s_mov_b32 s46, s76
    s_mov_b32 s52, s80
    s_lshl_b32 s90, s78, 2
    s_mul_i32 s91, s90, 1
    s_add_u32 s53, s91, s80
    s_sub_u32 s53, s53, 2048
    s_mul_i32 s91, s90, 2
    s_add_u32 s54, s91, s80
    s_mul_i32 s91, s90, 3
    s_add_u32 s55, s91, s80
    s_sub_u32 s55, s55, 2048
    s_lshl_b32 s56, s78, 6
    v_lshrrev_b32 v24, 5, v1
    s_lshl_b32 s90, s16, 4
    v_add_u32 v25, s90, v24
    v_mul_lo_u32 v25, v25, s78
    v_lshlrev_b32 v24, 1, v24
    v_and_b32 v26, 31, v1
    v_xor_b32 v24, v24, v26
    s_lshl_b32 s90, s78, 1
    s_sub_u32 s90, s90, 1024
    v_add_u32 v27, s90, v25
    v_xor_b32 v26, 0, v24
    v_lshl_add_u32 v18, v26, 4, v25
    v_xor_b32 v26, 4, v24
    v_lshl_add_u32 v19, v26, 4, v27
    v_xor_b32 v26, 8, v24
    v_lshl_add_u32 v20, v26, 4, v25
    v_xor_b32 v26, 12, v24
    v_lshl_add_u32 v21, v26, 4, v27
    s_mov_b32 s44, s74
    s_mov_b32 s45, s75
    s_mov_b32 s67, 0
    s_branch m_loop23
m_x49:
    s_cmp_le_u32 s65, 4
    s_cbranch_scc1 m_x50
    s_cmp_lg_u32 s16, 0
    s_cbranch_scc1 m_np56
    v_mov_b32 v4, s4
    v_mov_b32 v5, s5
    s_add_u32 s90, s17, 117440512
    s_mov_b64 exec, 1
    buffer_store_dwordx2 v[4:5], off, s[8:11], s90 sc1
    s_mov_b64 exec, -1
m_np56:
    s_mov_b32 s17, -1
    s_mov_b32 s67, 4
    s_branch m_loop23
m_x50:
    s_cmp_lg_u32 s65, 4
    s_cbranch_scc1 m_x51
    s_and_b32 s92, s2, 7
    s_lshl_b32 s92, s92, 2
    s_bfe_u32 s93, s2, 0x20003
    s_add_u32 s92, s92, s93
    s_lshr_b32 s93, s2, 5
    s_lshl_b32 s93, s93, 2
    s_or_b32 s93, s93, 0x40000
    s_lshr_b32 s90, s92, 1
    s_lshl_b32 s90, s90, 7
    s_add_u32 s90, s90, 117440512
    v_and_b32 v0, 3, v1
    v_min_u32 v0, 2, v0
    v_and_b32 v4, 4, v1
    v_add3_u32 v0, v0, v4, 8
    v_lshlrev_b32 v0, 3, v0
    buffer_load_dwordx2 v[4:5], v0, s[8:11], s90 offen sc1
    s_branch m_loop23
m_x51:
    s_waitcnt vmcnt(16)
    s_cmp_lg_u32 s65, 3
    s_cbranch_scc1 m_x52
    s_mov_b32 s3, 1048576
m_spin57:
    v_cmp_ne_u64 s[22:23], s[4:5], v[4:5]
    s_nop 3
    s_cmp_eq_u64 s[22:23], 0
    s_cbranch_scc1 m_ok58
    s_sub_u32 s3, s3, 1
    s_cbranch_scc1 m_ok58
    s_sleep 16
    s_and_b32 s92, s2, 7
    s_lshl_b32 s92, s92, 2
    s_bfe_u32 s93, s2, 0x20003
    s_add_u32 s92, s92, s93
    s_lshr_b32 s93, s2, 5
    s_lshl_b32 s93, s93, 2
    s_or_b32 s93, s93, 0x40000
    s_lshr_b32 s90, s92, 1
    s_lshl_b32 s90, s90, 7
    s_add_u32 s90, s90, 117440512
    v_and_b32 v0, 3, v1
    v_min_u32 v0, 2, v0
    v_and_b32 v4, 4, v1
    v_add3_u32 v0, v0, v4, 8
    v_lshlrev_b32 v0, 3, v0
    buffer_load_dwordx2 v[4:5], v0, s[8:11], s90 offen sc1
    s_waitcnt vmcnt(0)
    s_branch m_spin57
m_ok58:
    s_and_b32 s92, s2, 7
    s_lshl_b32 s92, s92, 2
    s_bfe_u32 s93, s2, 0x20003
    s_add_u32 s92, s92, s93
    s_lshr_b32 s93, s2, 5
    s_lshl_b32 s93, s93, 2
    s_or_b32 s93, s93, 0x40000
    s_lshl_b32 s90, s92, 19
    s_lshl_b32 s91, s58, 13
    s_add_u32 s90, s90, s91
    s_cmp_eq_u32 s57, 0
    s_mov_b32 s91, 33554432
    s_cselect_b32 s91, 16777216, s91
    s_mov_b32 s42, 0
    s_cselect_b32 s42, 268435456, s42
    s_add_u32 s48, s90, s91
    s_mov_b32 s49, s48
    s_add_u32 s50, s48, 4096
    s_mov_b32 s51, s50
    s_mov_b32 s40, s6
    s_mov_b32 s41, s7
    v_mov_b32 v16, v2
    v_mov_b32 v17, v2
    s_branch m_loop23
m_x52:
    s_cmp_lg_u32 s65, 2
    s_cbranch_scc1 m_x53
    s_and_b32 s92, s2, 7
    s_lshl_b32 s92, s92, 2
    s_bfe_u32 s93, s2, 0x20003
    s_add_u32 s92, s92, s93
    s_lshr_b32 s93, s2, 5
    s_lshl_b32 s93, s93, 2
    s_or_b32 s93, s93, 0x40000
    s_lshr_b32 s90, s92, 1
    s_lshl_b32 s90, s90, 7
    s_add_u32 s90, s90, 117440512
    s_bfe_u32 s91, 873473623, s93
    s_lshr_b32 s91, s91, 1
    v_mov_b32 v0, s91
    s_bfe_u32 s91, 4225681832, s93
    s_lshr_b32 s91, s91, 1
    v_writelane_b32 v0, s91, 8
    v_lshlrev_b32 v0, 3, v0
    buffer_load_dwordx2 v[4:5], v0, s[8:11], s90 offen sc1
    s_lshl_b32 s90, s92, 19
    s_lshl_b32 s91, s58, 13
    s_add_u32 s90, s90, s91
    s_cmp_eq_u32 s57, 0
    s_mov_b32 s91, 33554432
    s_cselect_b32 s91, 16793600, s91
    s_mov_b32 s42, 268435456
    s_cselect_b32 s42, 268435456, s42
    s_add_u32 s48, s90, s91
    s_mov_b32 s49, s48
    s_add_u32 s50, s48, 4096
    s_mov_b32 s51, s50
    s_mov_b32 s40, s6
    s_mov_b32 s41, s7
    s_lshl_b32 s90, s92, 19
    s_lshl_b32 s91, s58, 13
    s_add_u32 s90, s90, s91
    s_cmp_eq_u32 s57, 0
    s_mov_b32 s91, 33587200
    s_cselect_b32 s91, 16826368, s91
    s_mov_b32 s46, 268435456
    s_cselect_b32 s46, 268435456, s46
    s_add_u32 s52, s90, s91
    s_mov_b32 s53, s52
    s_add_u32 s54, s52, 4096
    s_mov_b32 s55, s54
    s_mov_b32 s44, s6
    s_mov_b32 s45, s7
    v_mov_b32 v18, v2
    v_mov_b32 v19, v2
    v_mov_b32 v20, v2
    v_mov_b32 v21, v2
    s_branch m_loop23
m_x53:
    s_mov_b32 s3, 1048576
m_spin59:
    v_cmp_ne_u64 s[22:23], s[4:5], v[4:5]
    s_nop 3
    s_cmp_eq_u64 s[22:23], 0
    s_cbranch_scc1 m_ok60
    s_sub_u32 s3, s3, 1
    s_cbranch_scc1 m_ok60
    s_sleep 16
    s_and_b32 s92, s2, 7
    s_lshl_b32 s92, s92, 2
    s_bfe_u32 s93, s2, 0x20003
    s_add_u32 s92, s92, s93
    s_lshr_b32 s93, s2, 5
    s_lshl_b32 s93, s93, 2
    s_or_b32 s93, s93, 0x40000
    s_lshr_b32 s90, s92, 1
    s_lshl_b32 s90, s90, 7
    s_add_u32 s90, s90, 117440512
    s_bfe_u32 s91, 873473623, s93
    s_lshr_b32 s91, s91, 1
    v_mov_b32 v0, s91
    s_bfe_u32 s91, 4225681832, s93
    s_lshr_b32 s91, s91, 1
    v_writelane_b32 v0, s91, 8
    v_lshlrev_b32 v0, 3, v0
    buffer_load_dwordx2 v[4:5], v0, s[8:11], s90 offen sc1
    s_waitcnt vmcnt(0)
    s_branch m_spin59
m_ok60:
    s_and_b32 s92, s2, 7
    s_lshl_b32 s92, s92, 2
    s_bfe_u32 s93, s2, 0x20003
    s_add_u32 s92, s92, s93
    s_lshr_b32 s93, s2, 5
    s_lshl_b32 s93, s93, 2
    s_or_b32 s93, s93, 0x40000
    s_bfe_u32 s90, 4225681832, s93
    s_lshl_b32 s90, s90, 3
    s_lshl_b32 s91, s16, 1
    s_add_u32 s90, s90, s91
    s_lshl_b32 s90, s90, 12
    s_lshl_b32 s91, s92, 19
    s_add_u32 s90, s90, s91
    s_add_u32 s90, s90, 0
    buffer_load_dwordx4 a[128:131], v2, s[8:11], s90 offen offset:0 sc1
    buffer_load_dwordx4 a[132:135], v2, s[8:11], s90 offen offset:1024 sc1
    buffer_load_dwordx4 a[136:139], v2, s[8:11], s90 offen offset:2048 sc1
    buffer_load_dwordx4 a[140:143], v2, s[8:11], s90 offen offset:3072 sc1
    s_bfe_u32 s90, 4225681832, s93
    s_lshl_b32 s90, s90, 3
    s_lshl_b32 s91, s16, 1
    s_add_u32 s90, s90, s91
    s_lshl_b32 s90, s90, 12
    s_lshl_b32 s91, s92, 19
    s_add_u32 s90, s90, s91
    s_add_u32 s90, s90, 4096
    buffer_load_dwordx4 a[144:147], v2, s[8:11], s90 offen offset:0 sc1
    buffer_load_dwordx4 a[148:151], v2, s[8:11], s90 offen offset:1024 sc1
    buffer_load_dwordx4 a[152:155], v2, s[8:11], s90 offen offset:2048 sc1
    buffer_load_dwordx4 a[156:159], v2, s[8:11], s90 offen offset:3072 sc1
    s_bfe_u32 s90, 873473623, s93
    s_lshl_b32 s90, s90, 3
    s_lshl_b32 s91, s16, 1
    s_add_u32 s90, s90, s91
    s_lshl_b32 s90, s90, 12
    s_lshl_b32 s91, s92, 19
    s_add_u32 s90, s90, s91
    s_add_u32 s90, s90, 0
    buffer_load_dwordx4 a[160:163], v2, s[8:11], s90 offen offset:0 sc1
    buffer_load_dwordx4 a[164:167], v2, s[8:11], s90 offen offset:1024 sc1
    buffer_load_dwordx4 a[168:171], v2, s[8:11], s90 offen offset:2048 sc1
    buffer_load_dwordx4 a[172:175], v2, s[8:11], s90 offen offset:3072 sc1
    s_bfe_u32 s90, 873473623, s93
    s_lshl_b32 s90, s90, 3
    s_lshl_b32 s91, s16, 1
    s_add_u32 s90, s90, s91
    s_lshl_b32 s90, s90, 12
    s_lshl_b32 s91, s92, 19
    s_add_u32 s90, s90, s91
    s_add_u32 s90, s90, 4096
    buffer_load_dwordx4 a[176:179], v2, s[8:11], s90 offen offset:0 sc1
    buffer_load_dwordx4 a[180:183], v2, s[8:11], s90 offen offset:1024 sc1
    buffer_load_dwordx4 a[184:187], v2, s[8:11], s90 offen offset:2048 sc1
    buffer_load_dwordx4 a[188:191], v2, s[8:11], s90 offen offset:3072 sc1
    s_lshl_b32 s90, s92, 19
    s_lshl_b32 s91, s58, 13
    s_add_u32 s90, s90, s91
    s_cmp_eq_u32 s57, 0
    s_mov_b32 s91, 33570816
    s_cselect_b32 s91, 16809984, s91
    s_mov_b32 s42, 268435456
    s_cselect_b32 s42, 268435456, s42
    s_add_u32 s48, s90, s91
    s_mov_b32 s49, s48
    s_add_u32 s50, s48, 4096
    s_mov_b32 s51, s50
    s_mov_b32 s40, s6
    s_mov_b32 s41, s7
    s_lshl_b32 s90, s92, 19
    s_lshl_b32 s91, s58, 13
    s_add_u32 s90, s90, s91
    s_cmp_eq_u32 s57, 0
    s_mov_b32 s91, 33603584
    s_cselect_b32 s91, 16842752, s91
    s_mov_b32 s46, 268435456
    s_cselect_b32 s46, 268435456, s46
    s_add_u32 s52, s90, s91
    s_mov_b32 s53, s52
    s_add_u32 s54, s52, 4096
    s_mov_b32 s55, s54
    s_mov_b32 s44, s6
    s_mov_b32 s45, s7
    s_branch m_loop23
m_eps26:
    s_nop 3
    s_mov_b32 s90, s98
    v_cvt_pk_bf16_f32 v32, v32, v33
    v_cvt_pk_bf16_f32 v33, v34, v35
    v_cvt_pk_bf16_f32 v34, v36, v37
    v_cvt_pk_bf16_f32 v35, v38, v39
    buffer_store_dwordx4 v[32:35], v2, s[8:11], s90 offen sc1
    s_add_u32 s90, s90, s100
    v_cvt_pk_bf16_f32 v40, v40, v41
    v_cvt_pk_bf16_f32 v41, v42, v43
    v_cvt_pk_bf16_f32 v42, v44, v45
    v_cvt_pk_bf16_f32 v43, v46, v47
    buffer_store_dwordx4 v[40:43], v2, s[8:11], s90 offen sc1
    s_add_u32 s90, s90, s100
    v_cvt_pk_bf16_f32 v48, v48, v49
    v_cvt_pk_bf16_f32 v49, v50, v51
    v_cvt_pk_bf16_f32 v50, v52, v53
    v_cvt_pk_bf16_f32 v51, v54, v55
    buffer_store_dwordx4 v[48:51], v2, s[8:11], s90 offen sc1
    s_add_u32 s90, s90, s100
    v_cvt_pk_bf16_f32 v56, v56, v57
    v_cvt_pk_bf16_f32 v57, v58, v59
    v_cvt_pk_bf16_f32 v58, v60, v61
    v_cvt_pk_bf16_f32 v59, v62, v63
    buffer_store_dwordx4 v[56:59], v2, s[8:11], s90 offen sc1
    s_add_u32 s90, s90, s100
    v_cvt_pk_bf16_f32 v64, v64, v65
    v_cvt_pk_bf16_f32 v65, v66, v67
    v_cvt_pk_bf16_f32 v66, v68, v69
    v_cvt_pk_bf16_f32 v67, v70, v71
    buffer_store_dwordx4 v[64:67], v2, s[8:11], s90 offen sc1
    s_add_u32 s90, s90, s100
    v_cvt_pk_bf16_f32 v72, v72, v73
    v_cvt_pk_bf16_f32 v73, v74, v75
    v_cvt_pk_bf16_f32 v74, v76, v77
    v_cvt_pk_bf16_f32 v75, v78, v79
    buffer_store_dwordx4 v[72:75], v2, s[8:11], s90 offen sc1
    s_add_u32 s90, s90, s100
    v_cvt_pk_bf16_f32 v80, v80, v81
    v_cvt_pk_bf16_f32 v81, v82, v83
    v_cvt_pk_bf16_f32 v82, v84, v85
    v_cvt_pk_bf16_f32 v83, v86, v87
    buffer_store_dwordx4 v[80:83], v2, s[8:11], s90 offen sc1
    s_add_u32 s90, s90, s100
    v_cvt_pk_bf16_f32 v88, v88, v89
    v_cvt_pk_bf16_f32 v89, v90, v91
    v_cvt_pk_bf16_f32 v90, v92, v93
    v_cvt_pk_bf16_f32 v91, v94, v95
    buffer_store_dwordx4 v[88:91], v2, s[8:11], s90 offen sc1
    s_add_u32 s90, s90, s100
    v_cvt_pk_bf16_f32 v96, v96, v97
    v_cvt_pk_bf16_f32 v97, v98, v99
    v_cvt_pk_bf16_f32 v98, v100, v101
    v_cvt_pk_bf16_f32 v99, v102, v103
    v_accvgpr_write_b32 a128, v96
    v_accvgpr_write_b32 a129, v97
    v_accvgpr_write_b32 a130, v98
    v_accvgpr_write_b32 a131, v99
    v_cvt_pk_bf16_f32 v104, v104, v105
    v_cvt_pk_bf16_f32 v105, v106, v107
    v_cvt_pk_bf16_f32 v106, v108, v109
    v_cvt_pk_bf16_f32 v107, v110, v111
    v_accvgpr_write_b32 a132, v104
    v_accvgpr_write_b32 a133, v105
    v_accvgpr_write_b32 a134, v106
    v_accvgpr_write_b32 a135, v107
    v_cvt_pk_bf16_f32 v112, v112, v113
    v_cvt_pk_bf16_f32 v113, v114, v115
    v_cvt_pk_bf16_f32 v114, v116, v117
    v_cvt_pk_bf16_f32 v115, v118, v119
    v_accvgpr_write_b32 a136, v112
    v_accvgpr_write_b32 a137, v113
    v_accvgpr_write_b32 a138, v114
    v_accvgpr_write_b32 a139, v115
    v_cvt_pk_bf16_f32 v120, v120, v121
    v_cvt_pk_bf16_f32 v121, v122, v123
    v_cvt_pk_bf16_f32 v122, v124, v125
    v_cvt_pk_bf16_f32 v123, v126, v127
    v_accvgpr_write_b32 a140, v120
    v_accvgpr_write_b32 a141, v121
    v_accvgpr_write_b32 a142, v122
    v_accvgpr_write_b32 a143, v123
    v_cvt_pk_bf16_f32 v128, v128, v129
    v_cvt_pk_bf16_f32 v129, v130, v131
    v_cvt_pk_bf16_f32 v130, v132, v133
    v_cvt_pk_bf16_f32 v131, v134, v135
    v_accvgpr_write_b32 a144, v128
    v_accvgpr_write_b32 a145, v129
    v_accvgpr_write_b32 a146, v130
    v_accvgpr_write_b32 a147, v131
    v_cvt_pk_bf16_f32 v136, v136, v137
    v_cvt_pk_bf16_f32 v137, v138, v139
    v_cvt_pk_bf16_f32 v138, v140, v141
    v_cvt_pk_bf16_f32 v139, v142, v143
    v_accvgpr_write_b32 a148, v136
    v_accvgpr_write_b32 a149, v137
    v_accvgpr_write_b32 a150, v138
    v_accvgpr_write_b32 a151, v139
    v_cvt_pk_bf16_f32 v144, v144, v145
    v_cvt_pk_bf16_f32 v145, v146, v147
    v_cvt_pk_bf16_f32 v146, v148, v149
    v_cvt_pk_bf16_f32 v147, v150, v151
    v_accvgpr_write_b32 a152, v144
    v_accvgpr_write_b32 a153, v145
    v_accvgpr_write_b32 a154, v146
    v_accvgpr_write_b32 a155, v147
    v_cvt_pk_bf16_f32 v152, v152, v153
    v_cvt_pk_bf16_f32 v153, v154, v155
    v_cvt_pk_bf16_f32 v154, v156, v157
    v_cvt_pk_bf16_f32 v155, v158, v159
    v_accvgpr_write_b32 a156, v152
    v_accvgpr_write_b32 a157, v153
    v_accvgpr_write_b32 a158, v154
    v_accvgpr_write_b32 a159, v155
    v_cvt_pk_bf16_f32 v160, v160, v161
    v_cvt_pk_bf16_f32 v161, v162, v163
    v_cvt_pk_bf16_f32 v162, v164, v165
    v_cvt_pk_bf16_f32 v163, v166, v167
    v_accvgpr_write_b32 a160, v160
    v_accvgpr_write_b32 a161, v161
    v_accvgpr_write_b32 a162, v162
    v_accvgpr_write_b32 a163, v163
    v_cvt_pk_bf16_f32 v168, v168, v169
    v_cvt_pk_bf16_f32 v169, v170, v171
    v_cvt_pk_bf16_f32 v170, v172, v173
    v_cvt_pk_bf16_f32 v171, v174, v175
    v_accvgpr_write_b32 a164, v168
    v_accvgpr_write_b32 a165, v169
    v_accvgpr_write_b32 a166, v170
    v_accvgpr_write_b32 a167, v171
    v_cvt_pk_bf16_f32 v176, v176, v177
    v_cvt_pk_bf16_f32 v177, v178, v179
    v_cvt_pk_bf16_f32 v178, v180, v181
    v_cvt_pk_bf16_f32 v179, v182, v183
    v_accvgpr_write_b32 a168, v176
    v_accvgpr_write_b32 a169, v177
    v_accvgpr_write_b32 a170, v178
    v_accvgpr_write_b32 a171, v179
    v_cvt_pk_bf16_f32 v184, v184, v185
    v_cvt_pk_bf16_f32 v185, v186, v187
    v_cvt_pk_bf16_f32 v186, v188, v189
    v_cvt_pk_bf16_f32 v187, v190, v191
    v_accvgpr_write_b32 a172, v184
    v_accvgpr_write_b32 a173, v185
    v_accvgpr_write_b32 a174, v186
    v_accvgpr_write_b32 a175, v187
    v_cvt_pk_bf16_f32 v192, v192, v193
    v_cvt_pk_bf16_f32 v193, v194, v195
    v_cvt_pk_bf16_f32 v194, v196, v197
    v_cvt_pk_bf16_f32 v195, v198, v199
    v_accvgpr_write_b32 a176, v192
    v_accvgpr_write_b32 a177, v193
    v_accvgpr_write_b32 a178, v194
    v_accvgpr_write_b32 a179, v195
    v_cvt_pk_bf16_f32 v200, v200, v201
    v_cvt_pk_bf16_f32 v201, v202, v203
    v_cvt_pk_bf16_f32 v202, v204, v205
    v_cvt_pk_bf16_f32 v203, v206, v207
    v_accvgpr_write_b32 a180, v200
    v_accvgpr_write_b32 a181, v201
    v_accvgpr_write_b32 a182, v202
    v_accvgpr_write_b32 a183, v203
    v_cvt_pk_bf16_f32 v208, v208, v209
    v_cvt_pk_bf16_f32 v209, v210, v211
    v_cvt_pk_bf16_f32 v210, v212, v213
    v_cvt_pk_bf16_f32 v211, v214, v215
    v_accvgpr_write_b32 a184, v208
    v_accvgpr_write_b32 a185, v209
    v_accvgpr_write_b32 a186, v210
    v_accvgpr_write_b32 a187, v211
    v_cvt_pk_bf16_f32 v216, v216, v217
    v_cvt_pk_bf16_f32 v217, v218, v219
    v_cvt_pk_bf16_f32 v218, v220, v221
    v_cvt_pk_bf16_f32 v219, v222, v223
    v_accvgpr_write_b32 a188, v216
    v_accvgpr_write_b32 a189, v217
    v_accvgpr_write_b32 a190, v218
    v_accvgpr_write_b32 a191, v219
    v_cvt_pk_bf16_f32 v224, v224, v225
    v_cvt_pk_bf16_f32 v225, v226, v227
    v_cvt_pk_bf16_f32 v226, v228, v229
    v_cvt_pk_bf16_f32 v227, v230, v231
    v_accvgpr_write_b32 a192, v224
    v_accvgpr_write_b32 a193, v225
    v_accvgpr_write_b32 a194, v226
    v_accvgpr_write_b32 a195, v227
    v_cvt_pk_bf16_f32 v232, v232, v233
    v_cvt_pk_bf16_f32 v233, v234, v235
    v_cvt_pk_bf16_f32 v234, v236, v237
    v_cvt_pk_bf16_f32 v235, v238, v239
    v_accvgpr_write_b32 a196, v232
    v_accvgpr_write_b32 a197, v233
    v_accvgpr_write_b32 a198, v234
    v_accvgpr_write_b32 a199, v235
    v_cvt_pk_bf16_f32 v240, v240, v241
    v_cvt_pk_bf16_f32 v241, v242, v243
    v_cvt_pk_bf16_f32 v242, v244, v245
    v_cvt_pk_bf16_f32 v243, v246, v247
    v_accvgpr_write_b32 a200, v240
    v_accvgpr_write_b32 a201, v241
    v_accvgpr_write_b32 a202, v242
    v_accvgpr_write_b32 a203, v243
    v_cvt_pk_bf16_f32 v248, v248, v249
    v_cvt_pk_bf16_f32 v249, v250, v251
    v_cvt_pk_bf16_f32 v250, v252, v253
    v_cvt_pk_bf16_f32 v251, v254, v255
    v_accvgpr_write_b32 a204, v248
    v_accvgpr_write_b32 a205, v249
    v_accvgpr_write_b32 a206, v250
    v_accvgpr_write_b32 a207, v251
    v_accvgpr_read_b32 v24, a224
    v_accvgpr_read_b32 v25, a225
    v_accvgpr_read_b32 v26, a226
    v_accvgpr_read_b32 v27, a227
    v_accvgpr_read_b32 v28, a228
    v_accvgpr_read_b32 v29, a229
    v_accvgpr_read_b32 v30, a230
    v_accvgpr_read_b32 v31, a231
    v_cvt_pk_bf16_f32 v24, v24, v25
    v_cvt_pk_bf16_f32 v25, v26, v27
    v_cvt_pk_bf16_f32 v26, v28, v29
    v_cvt_pk_bf16_f32 v27, v30, v31
    v_accvgpr_write_b32 a208, v24
    v_accvgpr_write_b32 a209, v25
    v_accvgpr_write_b32 a210, v26
    v_accvgpr_write_b32 a211, v27
    v_accvgpr_read_b32 v24, a232
    v_accvgpr_read_b32 v25, a233
    v_accvgpr_read_b32 v26, a234
    v_accvgpr_read_b32 v27, a235
    v_accvgpr_read_b32 v28, a236
    v_accvgpr_read_b32 v29, a237
    v_accvgpr_read_b32 v30, a238
    v_accvgpr_read_b32 v31, a239
    v_cvt_pk_bf16_f32 v24, v24, v25
    v_cvt_pk_bf16_f32 v25, v26, v27
    v_cvt_pk_bf16_f32 v26, v28, v29
    v_cvt_pk_bf16_f32 v27, v30, v31
    v_accvgpr_write_b32 a212, v24
    v_accvgpr_write_b32 a213, v25
    v_accvgpr_write_b32 a214, v26
    v_accvgpr_write_b32 a215, v27
    v_accvgpr_read_b32 v24, a240
    v_accvgpr_read_b32 v25, a241
    v_accvgpr_read_b32 v26, a242
    v_accvgpr_read_b32 v27, a243
    v_accvgpr_read_b32 v28, a244
    v_accvgpr_read_b32 v29, a245
    v_accvgpr_read_b32 v30, a246
    v_accvgpr_read_b32 v31, a247
    v_cvt_pk_bf16_f32 v24, v24, v25
    v_cvt_pk_bf16_f32 v25, v26, v27
    v_cvt_pk_bf16_f32 v26, v28, v29
    v_cvt_pk_bf16_f32 v27, v30, v31
    v_accvgpr_write_b32 a216, v24
    v_accvgpr_write_b32 a217, v25
    v_accvgpr_write_b32 a218, v26
    v_accvgpr_write_b32 a219, v27
    v_accvgpr_read_b32 v24, a248
    v_accvgpr_read_b32 v25, a249
    v_accvgpr_read_b32 v26, a250
    v_accvgpr_read_b32 v27, a251
    v_accvgpr_read_b32 v28, a252
    v_accvgpr_read_b32 v29, a253
    v_accvgpr_read_b32 v30, a254
    v_accvgpr_read_b32 v31, a255
    v_cvt_pk_bf16_f32 v24, v24, v25
    v_cvt_pk_bf16_f32 v25, v26, v27
    v_cvt_pk_bf16_f32 v26, v28, v29
    v_cvt_pk_bf16_f32 v27, v30, v31
    v_accvgpr_write_b32 a220, v24
    v_accvgpr_write_b32 a221, v25
    v_accvgpr_write_b32 a222, v26
    v_accvgpr_write_b32 a223, v27
    s_setpc_b64 s[20:21]
m_epf25:
    s_nop 7
    s_mov_b32 s91, s98
    s_mov_b32 s92, s97
    s_mov_b32 s93, s97
    s_mov_b32 s90, s91
    v_pk_mul_f32 v[32:33], v[32:33], s[92:93]
    v_pk_mul_f32 v[34:35], v[34:35], s[92:93]
    v_pk_mul_f32 v[36:37], v[36:37], s[92:93]
    v_pk_mul_f32 v[38:39], v[38:39], s[92:93]
    v_cvt_pk_bf16_f32 v32, v32, v33
    v_cvt_pk_bf16_f32 v33, v34, v35
    v_cvt_pk_bf16_f32 v34, v36, v37
    v_cvt_pk_bf16_f32 v35, v38, v39
    buffer_store_dwordx4 v[32:35], v2, s[8:11], s90 offen sc1
    s_add_u32 s90, s90, s100
    v_pk_mul_f32 v[40:41], v[40:41], s[92:93]
    v_pk_mul_f32 v[42:43], v[42:43], s[92:93]
    v_pk_mul_f32 v[44:45], v[44:45], s[92:93]
    v_pk_mul_f32 v[46:47], v[46:47], s[92:93]
    v_cvt_pk_bf16_f32 v40, v40, v41
    v_cvt_pk_bf16_f32 v41, v42, v43
    v_cvt_pk_bf16_f32 v42, v44, v45
    v_cvt_pk_bf16_f32 v43, v46, v47
    buffer_store_dwordx4 v[40:43], v2, s[8:11], s90 offen sc1
    s_add_u32 s90, s90, s100
    v_pk_mul_f32 v[48:49], v[48:49], s[92:93]
    v_pk_mul_f32 v[50:51], v[50:51], s[92:93]
    v_pk_mul_f32 v[52:53], v[52:53], s[92:93]
    v_pk_mul_f32 v[54:55], v[54:55], s[92:93]
    v_cvt_pk_bf16_f32 v48, v48, v49
    v_cvt_pk_bf16_f32 v49, v50, v51
    v_cvt_pk_bf16_f32 v50, v52, v53
    v_cvt_pk_bf16_f32 v51, v54, v55
    buffer_store_dwordx4 v[48:51], v2, s[8:11], s90 offen sc1
    s_add_u32 s90, s90, s100
    v_pk_mul_f32 v[56:57], v[56:57], s[92:93]
    v_pk_mul_f32 v[58:59], v[58:59], s[92:93]
    v_pk_mul_f32 v[60:61], v[60:61], s[92:93]
    v_pk_mul_f32 v[62:63], v[62:63], s[92:93]
    v_cvt_pk_bf16_f32 v56, v56, v57
    v_cvt_pk_bf16_f32 v57, v58, v59
    v_cvt_pk_bf16_f32 v58, v60, v61
    v_cvt_pk_bf16_f32 v59, v62, v63
    buffer_store_dwordx4 v[56:59], v2, s[8:11], s90 offen sc1
    s_add_u32 s90, s90, s100
    v_pk_mul_f32 v[64:65], v[64:65], s[92:93]
    v_pk_mul_f32 v[66:67], v[66:67], s[92:93]
    v_pk_mul_f32 v[68:69], v[68:69], s[92:93]
    v_pk_mul_f32 v[70:71], v[70:71], s[92:93]
    v_cvt_pk_bf16_f32 v64, v64, v65
    v_cvt_pk_bf16_f32 v65, v66, v67
    v_cvt_pk_bf16_f32 v66, v68, v69
    v_cvt_pk_bf16_f32 v67, v70, v71
    buffer_store_dwordx4 v[64:67], v2, s[8:11], s90 offen sc1
    s_add_u32 s90, s90, s100
    v_pk_mul_f32 v[72:73], v[72:73], s[92:93]
    v_pk_mul_f32 v[74:75], v[74:75], s[92:93]
    v_pk_mul_f32 v[76:77], v[76:77], s[92:93]
    v_pk_mul_f32 v[78:79], v[78:79], s[92:93]
    v_cvt_pk_bf16_f32 v72, v72, v73
    v_cvt_pk_bf16_f32 v73, v74, v75
    v_cvt_pk_bf16_f32 v74, v76, v77
    v_cvt_pk_bf16_f32 v75, v78, v79
    buffer_store_dwordx4 v[72:75], v2, s[8:11], s90 offen sc1
    s_add_u32 s90, s90, s100
    v_pk_mul_f32 v[80:81], v[80:81], s[92:93]
    v_pk_mul_f32 v[82:83], v[82:83], s[92:93]
    v_pk_mul_f32 v[84:85], v[84:85], s[92:93]
    v_pk_mul_f32 v[86:87], v[86:87], s[92:93]
    v_cvt_pk_bf16_f32 v80, v80, v81
    v_cvt_pk_bf16_f32 v81, v82, v83
    v_cvt_pk_bf16_f32 v82, v84, v85
    v_cvt_pk_bf16_f32 v83, v86, v87
    buffer_store_dwordx4 v[80:83], v2, s[8:11], s90 offen sc1
    s_add_u32 s90, s90, s100
    v_pk_mul_f32 v[88:89], v[88:89], s[92:93]
    v_pk_mul_f32 v[90:91], v[90:91], s[92:93]
    v_pk_mul_f32 v[92:93], v[92:93], s[92:93]
    v_pk_mul_f32 v[94:95], v[94:95], s[92:93]
    v_cvt_pk_bf16_f32 v88, v88, v89
    v_cvt_pk_bf16_f32 v89, v90, v91
    v_cvt_pk_bf16_f32 v90, v92, v93
    v_cvt_pk_bf16_f32 v91, v94, v95
    buffer_store_dwordx4 v[88:91], v2, s[8:11], s90 offen sc1
    s_add_u32 s90, s90, s100
    s_add_u32 s91, s91, s99
    s_mov_b32 s90, s91
    v_pk_mul_f32 v[96:97], v[96:97], s[92:93]
    v_pk_mul_f32 v[98:99], v[98:99], s[92:93]
    v_pk_mul_f32 v[100:101], v[100:101], s[92:93]
    v_pk_mul_f32 v[102:103], v[102:103], s[92:93]
    v_cvt_pk_bf16_f32 v96, v96, v97
    v_cvt_pk_bf16_f32 v97, v98, v99
    v_cvt_pk_bf16_f32 v98, v100, v101
    v_cvt_pk_bf16_f32 v99, v102, v103
    buffer_store_dwordx4 v[96:99], v2, s[8:11], s90 offen sc1
    s_add_u32 s90, s90, s100
    v_pk_mul_f32 v[104:105], v[104:105], s[92:93]
    v_pk_mul_f32 v[106:107], v[106:107], s[92:93]
    v_pk_mul_f32 v[108:109], v[108:109], s[92:93]
    v_pk_mul_f32 v[110:111], v[110:111], s[92:93]
    v_cvt_pk_bf16_f32 v104, v104, v105
    v_cvt_pk_bf16_f32 v105, v106, v107
    v_cvt_pk_bf16_f32 v106, v108, v109
    v_cvt_pk_bf16_f32 v107, v110, v111
    buffer_store_dwordx4 v[104:107], v2, s[8:11], s90 offen sc1
    s_add_u32 s90, s90, s100
    v_pk_mul_f32 v[112:113], v[112:113], s[92:93]
    v_pk_mul_f32 v[114:115], v[114:115], s[92:93]
    v_pk_mul_f32 v[116:117], v[116:117], s[92:93]
    v_pk_mul_f32 v[118:119], v[118:119], s[92:93]
    v_cvt_pk_bf16_f32 v112, v112, v113
    v_cvt_pk_bf16_f32 v113, v114, v115
    v_cvt_pk_bf16_f32 v114, v116, v117
    v_cvt_pk_bf16_f32 v115, v118, v119
    buffer_store_dwordx4 v[112:115], v2, s[8:11], s90 offen sc1
    s_add_u32 s90, s90, s100
    v_pk_mul_f32 v[120:121], v[120:121], s[92:93]
    v_pk_mul_f32 v[122:123], v[122:123], s[92:93]
    v_pk_mul_f32 v[124:125], v[124:125], s[92:93]
    v_pk_mul_f32 v[126:127], v[126:127], s[92:93]
    v_cvt_pk_bf16_f32 v120, v120, v121
    v_cvt_pk_bf16_f32 v121, v122, v123
    v_cvt_pk_bf16_f32 v122, v124, v125
    v_cvt_pk_bf16_f32 v123, v126, v127
    buffer_store_dwordx4 v[120:123], v2, s[8:11], s90 offen sc1
    s_add_u32 s90, s90, s100
    v_pk_mul_f32 v[128:129], v[128:129], s[92:93]
    v_pk_mul_f32 v[130:131], v[130:131], s[92:93]
    v_pk_mul_f32 v[132:133], v[132:133], s[92:93]
    v_pk_mul_f32 v[134:135], v[134:135], s[92:93]
    v_cvt_pk_bf16_f32 v128, v128, v129
    v_cvt_pk_bf16_f32 v129, v130, v131
    v_cvt_pk_bf16_f32 v130, v132, v133
    v_cvt_pk_bf16_f32 v131, v134, v135
    buffer_store_dwordx4 v[128:131], v2, s[8:11], s90 offen sc1
    s_add_u32 s90, s90, s100
    v_pk_mul_f32 v[136:137], v[136:137], s[92:93]
    v_pk_mul_f32 v[138:139], v[138:139], s[92:93]
    v_pk_mul_f32 v[140:141], v[140:141], s[92:93]
    v_pk_mul_f32 v[142:143], v[142:143], s[92:93]
    v_cvt_pk_bf16_f32 v136, v136, v137
    v_cvt_pk_bf16_f32 v137, v138, v139
    v_cvt_pk_bf16_f32 v138, v140, v141
    v_cvt_pk_bf16_f32 v139, v142, v143
    buffer_store_dwordx4 v[136:139], v2, s[8:11], s90 offen sc1
    s_add_u32 s90, s90, s100
    v_pk_mul_f32 v[144:145], v[144:145], s[92:93]
    v_pk_mul_f32 v[146:147], v[146:147], s[92:93]
    v_pk_mul_f32 v[148:149], v[148:149], s[92:93]
    v_pk_mul_f32 v[150:151], v[150:151], s[92:93]
    v_cvt_pk_bf16_f32 v144, v144, v145
    v_cvt_pk_bf16_f32 v145, v146, v147
    v_cvt_pk_bf16_f32 v146, v148, v149
    v_cvt_pk_bf16_f32 v147, v150, v151
    buffer_store_dwordx4 v[144:147], v2, s[8:11], s90 offen sc1
    s_add_u32 s90, s90, s100
    v_pk_mul_f32 v[152:153], v[152:153], s[92:93]
    v_pk_mul_f32 v[154:155], v[154:155], s[92:93]
    v_pk_mul_f32 v[156:157], v[156:157], s[92:93]
    v_pk_mul_f32 v[158:159], v[158:159], s[92:93]
    v_cvt_pk_bf16_f32 v152, v152, v153
    v_cvt_pk_bf16_f32 v153, v154, v155
    v_cvt_pk_bf16_f32 v154, v156, v157
    v_cvt_pk_bf16_f32 v155, v158, v159
    buffer_store_dwordx4 v[152:155], v2, s[8:11], s90 offen sc1
    s_add_u32 s90, s90, s100
    s_add_u32 s91, s91, s99
    s_mov_b32 s90, s91
    v_pk_mul_f32 v[160:161], v[160:161], s[92:93]
    v_pk_mul_f32 v[162:163], v[162:163], s[92:93]
    v_pk_mul_f32 v[164:165], v[164:165], s[92:93]
    v_pk_mul_f32 v[166:167], v[166:167], s[92:93]
    v_cvt_pk_bf16_f32 v160, v160, v161
    v_cvt_pk_bf16_f32 v161, v162, v163
    v_cvt_pk_bf16_f32 v162, v164, v165
    v_cvt_pk_bf16_f32 v163, v166, v167
    buffer_store_dwordx4 v[160:163], v2, s[8:11], s90 offen sc1
    s_add_u32 s90, s90, s100
    v_pk_mul_f32 v[168:169], v[168:169], s[92:93]
    v_pk_mul_f32 v[170:171], v[170:171], s[92:93]
    v_pk_mul_f32 v[172:173], v[172:173], s[92:93]
    v_pk_mul_f32 v[174:175], v[174:175], s[92:93]
    v_cvt_pk_bf16_f32 v168, v168, v169
    v_cvt_pk_bf16_f32 v169, v170, v171
    v_cvt_pk_bf16_f32 v170, v172, v173
    v_cvt_pk_bf16_f32 v171, v174, v175
    buffer_store_dwordx4 v[168:171], v2, s[8:11], s90 offen sc1
    s_add_u32 s90, s90, s100
    v_pk_mul_f32 v[176:177], v[176:177], s[92:93]
    v_pk_mul_f32 v[178:179], v[178:179], s[92:93]
    v_pk_mul_f32 v[180:181], v[180:181], s[92:93]
    v_pk_mul_f32 v[182:183], v[182:183], s[92:93]
    v_cvt_pk_bf16_f32 v176, v176, v177
    v_cvt_pk_bf16_f32 v177, v178, v179
    v_cvt_pk_bf16_f32 v178, v180, v181
    v_cvt_pk_bf16_f32 v179, v182, v183
    buffer_store_dwordx4 v[176:179], v2, s[8:11], s90 offen sc1
    s_add_u32 s90, s90, s100
    v_pk_mul_f32 v[184:185], v[184:185], s[92:93]
    v_pk_mul_f32 v[186:187], v[186:187], s[92:93]
    v_pk_mul_f32 v[188:189], v[188:189], s[92:93]
    v_pk_mul_f32 v[190:191], v[190:191], s[92:93]
    v_cvt_pk_bf16_f32 v184, v184, v185
    v_cvt_pk_bf16_f32 v185, v186, v187
    v_cvt_pk_bf16_f32 v186, v188, v189
    v_cvt_pk_bf16_f32 v187, v190, v191
    buffer_store_dwordx4 v[184:187], v2, s[8:11], s90 offen sc1
    s_add_u32 s90, s90, s100
    v_pk_mul_f32 v[192:193], v[192:193], s[92:93]
    v_pk_mul_f32 v[194:195], v[194:195], s[92:93]
    v_pk_mul_f32 v[196:197], v[196:197], s[92:93]
    v_pk_mul_f32 v[198:199], v[198:199], s[92:93]
    v_cvt_pk_bf16_f32 v192, v192, v193
    v_cvt_pk_bf16_f32 v193, v194, v195
    v_cvt_pk_bf16_f32 v194, v196, v197
    v_cvt_pk_bf16_f32 v195, v198, v199
    buffer_store_dwordx4 v[192:195], v2, s[8:11], s90 offen sc1
    s_add_u32 s90, s90, s100
    v_pk_mul_f32 v[200:201], v[200:201], s[92:93]
    v_pk_mul_f32 v[202:203], v[202:203], s[92:93]
    v_pk_mul_f32 v[204:205], v[204:205], s[92:93]
    v_pk_mul_f32 v[206:207], v[206:207], s[92:93]
    v_cvt_pk_bf16_f32 v200, v200, v201
    v_cvt_pk_bf16_f32 v201, v202, v203
    v_cvt_pk_bf16_f32 v202, v204, v205
    v_cvt_pk_bf16_f32 v203, v206, v207
    buffer_store_dwordx4 v[200:203], v2, s[8:11], s90 offen sc1
    s_add_u32 s90, s90, s100
    v_pk_mul_f32 v[208:209], v[208:209], s[92:93]
    v_pk_mul_f32 v[210:211], v[210:211], s[92:93]
    v_pk_mul_f32 v[212:213], v[212:213], s[92:93]
    v_pk_mul_f32 v[214:215], v[214:215], s[92:93]
    v_cvt_pk_bf16_f32 v208, v208, v209
    v_cvt_pk_bf16_f32 v209, v210, v211
    v_cvt_pk_bf16_f32 v210, v212, v213
    v_cvt_pk_bf16_f32 v211, v214, v215
    buffer_store_dwordx4 v[208:211], v2, s[8:11], s90 offen sc1
    s_add_u32 s90, s90, s100
    v_pk_mul_f32 v[216:217], v[216:217], s[92:93]
    v_pk_mul_f32 v[218:219], v[218:219], s[92:93]
    v_pk_mul_f32 v[220:221], v[220:221], s[92:93]
    v_pk_mul_f32 v[222:223], v[222:223], s[92:93]
    v_cvt_pk_bf16_f32 v216, v216, v217
    v_cvt_pk_bf16_f32 v217, v218, v219
    v_cvt_pk_bf16_f32 v218, v220, v221
    v_cvt_pk_bf16_f32 v219, v222, v223
    buffer_store_dwordx4 v[216:219], v2, s[8:11], s90 offen sc1
    s_add_u32 s90, s90, s100
    s_add_u32 s91, s91, s99
    s_mov_b32 s90, s91
    v_pk_mul_f32 v[224:225], v[224:225], s[92:93]
    v_pk_mul_f32 v[226:227], v[226:227], s[92:93]
    v_pk_mul_f32 v[228:229], v[228:229], s[92:93]
    v_pk_mul_f32 v[230:231], v[230:231], s[92:93]
    v_cvt_pk_bf16_f32 v224, v224, v225
    v_cvt_pk_bf16_f32 v225, v226, v227
    v_cvt_pk_bf16_f32 v226, v228, v229
    v_cvt_pk_bf16_f32 v227, v230, v231
    buffer_store_dwordx4 v[224:227], v2, s[8:11], s90 offen sc1
    s_add_u32 s90, s90, s100
    v_pk_mul_f32 v[232:233], v[232:233], s[92:93]
    v_pk_mul_f32 v[234:235], v[234:235], s[92:93]
    v_pk_mul_f32 v[236:237], v[236:237], s[92:93]
    v_pk_mul_f32 v[238:239], v[238:239], s[92:93]
    v_cvt_pk_bf16_f32 v232, v232, v233
    v_cvt_pk_bf16_f32 v233, v234, v235
    v_cvt_pk_bf16_f32 v234, v236, v237
    v_cvt_pk_bf16_f32 v235, v238, v239
    buffer_store_dwordx4 v[232:235], v2, s[8:11], s90 offen sc1
    s_add_u32 s90, s90, s100
    v_pk_mul_f32 v[240:241], v[240:241], s[92:93]
    v_pk_mul_f32 v[242:243], v[242:243], s[92:93]
    v_pk_mul_f32 v[244:245], v[244:245], s[92:93]
    v_pk_mul_f32 v[246:247], v[246:247], s[92:93]
    v_cvt_pk_bf16_f32 v240, v240, v241
    v_cvt_pk_bf16_f32 v241, v242, v243
    v_cvt_pk_bf16_f32 v242, v244, v245
    v_cvt_pk_bf16_f32 v243, v246, v247
    buffer_store_dwordx4 v[240:243], v2, s[8:11], s90 offen sc1
    s_add_u32 s90, s90, s100
    v_pk_mul_f32 v[248:249], v[248:249], s[92:93]
    v_pk_mul_f32 v[250:251], v[250:251], s[92:93]
    v_pk_mul_f32 v[252:253], v[252:253], s[92:93]
    v_pk_mul_f32 v[254:255], v[254:255], s[92:93]
    v_cvt_pk_bf16_f32 v248, v248, v249
    v_cvt_pk_bf16_f32 v249, v250, v251
    v_cvt_pk_bf16_f32 v250, v252, v253
    v_cvt_pk_bf16_f32 v251, v254, v255
    buffer_store_dwordx4 v[248:251], v2, s[8:11], s90 offen sc1
    s_add_u32 s90, s90, s100
    v_accvgpr_read_b32 v24, a224
    v_accvgpr_read_b32 v25, a225
    v_accvgpr_read_b32 v26, a226
    v_accvgpr_read_b32 v27, a227
    v_accvgpr_read_b32 v28, a228
    v_accvgpr_read_b32 v29, a229
    v_accvgpr_read_b32 v30, a230
    v_accvgpr_read_b32 v31, a231
    v_pk_mul_f32 v[24:25], v[24:25], s[92:93]
    v_pk_mul_f32 v[26:27], v[26:27], s[92:93]
    v_pk_mul_f32 v[28:29], v[28:29], s[92:93]
    v_pk_mul_f32 v[30:31], v[30:31], s[92:93]
    v_cvt_pk_bf16_f32 v24, v24, v25
    v_cvt_pk_bf16_f32 v25, v26, v27
    v_cvt_pk_bf16_f32 v26, v28, v29
    v_cvt_pk_bf16_f32 v27, v30, v31
    buffer_store_dwordx4 v[24:27], v2, s[8:11], s90 offen sc1
    s_add_u32 s90, s90, s100
    s_nop 1
    v_accvgpr_read_b32 v24, a232
    v_accvgpr_read_b32 v25, a233
    v_accvgpr_read_b32 v26, a234
    v_accvgpr_read_b32 v27, a235
    v_accvgpr_read_b32 v28, a236
    v_accvgpr_read_b32 v29, a237
    v_accvgpr_read_b32 v30, a238
    v_accvgpr_read_b32 v31, a239
    v_pk_mul_f32 v[24:25], v[24:25], s[92:93]
    v_pk_mul_f32 v[26:27], v[26:27], s[92:93]
    v_pk_mul_f32 v[28:29], v[28:29], s[92:93]
    v_pk_mul_f32 v[30:31], v[30:31], s[92:93]
    v_cvt_pk_bf16_f32 v24, v24, v25
    v_cvt_pk_bf16_f32 v25, v26, v27
    v_cvt_pk_bf16_f32 v26, v28, v29
    v_cvt_pk_bf16_f32 v27, v30, v31
    buffer_store_dwordx4 v[24:27], v2, s[8:11], s90 offen sc1
    s_add_u32 s90, s90, s100
    s_nop 1
    v_accvgpr_read_b32 v24, a240
    v_accvgpr_read_b32 v25, a241
    v_accvgpr_read_b32 v26, a242
    v_accvgpr_read_b32 v27, a243
    v_accvgpr_read_b32 v28, a244
    v_accvgpr_read_b32 v29, a245
    v_accvgpr_read_b32 v30, a246
    v_accvgpr_read_b32 v31, a247
    v_pk_mul_f32 v[24:25], v[24:25], s[92:93]
    v_pk_mul_f32 v[26:27], v[26:27], s[92:93]
    v_pk_mul_f32 v[28:29], v[28:29], s[92:93]
    v_pk_mul_f32 v[30:31], v[30:31], s[92:93]
    v_cvt_pk_bf16_f32 v24, v24, v25
    v_cvt_pk_bf16_f32 v25, v26, v27
    v_cvt_pk_bf16_f32 v26, v28, v29
    v_cvt_pk_bf16_f32 v27, v30, v31
    buffer_store_dwordx4 v[24:27], v2, s[8:11], s90 offen sc1
    s_add_u32 s90, s90, s100
    s_nop 1
    v_accvgpr_read_b32 v24, a248
    v_accvgpr_read_b32 v25, a249
    v_accvgpr_read_b32 v26, a250
    v_accvgpr_read_b32 v27, a251
    v_accvgpr_read_b32 v28, a252
    v_accvgpr_read_b32 v29, a253
    v_accvgpr_read_b32 v30, a254
    v_accvgpr_read_b32 v31, a255
    v_pk_mul_f32 v[24:25], v[24:25], s[92:93]
    v_pk_mul_f32 v[26:27], v[26:27], s[92:93]
    v_pk_mul_f32 v[28:29], v[28:29], s[92:93]
    v_pk_mul_f32 v[30:31], v[30:31], s[92:93]
    v_cvt_pk_bf16_f32 v24, v24, v25
    v_cvt_pk_bf16_f32 v25, v26, v27
    v_cvt_pk_bf16_f32 v26, v28, v29
    v_cvt_pk_bf16_f32 v27, v30, v31
    buffer_store_dwordx4 v[24:27], v2, s[8:11], s90 offen sc1
    s_add_u32 s90, s90, s100
    s_nop 1
    s_add_u32 s91, s91, s99
    s_setpc_b64 s[20:21]
m_epl63:
    s_mov_b32 s92, s97
    s_mov_b32 s93, s97
    s_cmp_eq_u32 s97, 0
    s_cbranch_scc1 m_ns264
    s_mov_b32 s90, s98
    v_pk_mul_f32 v[32:33], v[32:33], s[92:93]
    v_pk_mul_f32 v[34:35], v[34:35], s[92:93]
    v_pk_mul_f32 v[36:37], v[36:37], s[92:93]
    v_pk_mul_f32 v[38:39], v[38:39], s[92:93]
    v_cvt_pk_bf16_f32 v32, v32, v33
    v_cvt_pk_bf16_f32 v33, v34, v35
    v_cvt_pk_bf16_f32 v34, v36, v37
    v_cvt_pk_bf16_f32 v35, v38, v39
    buffer_store_dwordx4 v[32:35], v2, s[8:11], s90 offen sc1
    s_add_u32 s90, s90, s100
    v_pk_mul_f32 v[40:41], v[40:41], s[92:93]
    v_pk_mul_f32 v[42:43], v[42:43], s[92:93]
    v_pk_mul_f32 v[44:45], v[44:45], s[92:93]
    v_pk_mul_f32 v[46:47], v[46:47], s[92:93]
    v_cvt_pk_bf16_f32 v40, v40, v41
    v_cvt_pk_bf16_f32 v41, v42, v43
    v_cvt_pk_bf16_f32 v42, v44, v45
    v_cvt_pk_bf16_f32 v43, v46, v47
    buffer_store_dwordx4 v[40:43], v2, s[8:11], s90 offen sc1
    s_add_u32 s90, s90, s100
    v_pk_mul_f32 v[48:49], v[48:49], s[92:93]
    v_pk_mul_f32 v[50:51], v[50:51], s[92:93]
    v_pk_mul_f32 v[52:53], v[52:53], s[92:93]
    v_pk_mul_f32 v[54:55], v[54:55], s[92:93]
    v_cvt_pk_bf16_f32 v48, v48, v49
    v_cvt_pk_bf16_f32 v49, v50, v51
    v_cvt_pk_bf16_f32 v50, v52, v53
    v_cvt_pk_bf16_f32 v51, v54, v55
    buffer_store_dwordx4 v[48:51], v2, s[8:11], s90 offen sc1
    s_add_u32 s90, s90, s100
    v_pk_mul_f32 v[56:57], v[56:57], s[92:93]
    v_pk_mul_f32 v[58:59], v[58:59], s[92:93]
    v_pk_mul_f32 v[60:61], v[60:61], s[92:93]
    v_pk_mul_f32 v[62:63], v[62:63], s[92:93]
    v_cvt_pk_bf16_f32 v56, v56, v57
    v_cvt_pk_bf16_f32 v57, v58, v59
    v_cvt_pk_bf16_f32 v58, v60, v61
    v_cvt_pk_bf16_f32 v59, v62, v63
    buffer_store_dwordx4 v[56:59], v2, s[8:11], s90 offen sc1
    s_add_u32 s90, s90, s100
    v_pk_mul_f32 v[64:65], v[64:65], s[92:93]
    v_pk_mul_f32 v[66:67], v[66:67], s[92:93]
    v_pk_mul_f32 v[68:69], v[68:69], s[92:93]
    v_pk_mul_f32 v[70:71], v[70:71], s[92:93]
    v_cvt_pk_bf16_f32 v64, v64, v65
    v_cvt_pk_bf16_f32 v65, v66, v67
    v_cvt_pk_bf16_f32 v66, v68, v69
    v_cvt_pk_bf16_f32 v67, v70, v71
    buffer_store_dwordx4 v[64:67], v2, s[8:11], s90 offen sc1
    s_add_u32 s90, s90, s100
    v_pk_mul_f32 v[72:73], v[72:73], s[92:93]
    v_pk_mul_f32 v[74:75], v[74:75], s[92:93]
    v_pk_mul_f32 v[76:77], v[76:77], s[92:93]
    v_pk_mul_f32 v[78:79], v[78:79], s[92:93]
    v_cvt_pk_bf16_f32 v72, v72, v73
    v_cvt_pk_bf16_f32 v73, v74, v75
    v_cvt_pk_bf16_f32 v74, v76, v77
    v_cvt_pk_bf16_f32 v75, v78, v79
    buffer_store_dwordx4 v[72:75], v2, s[8:11], s90 offen sc1
    s_add_u32 s90, s90, s100
    v_pk_mul_f32 v[80:81], v[80:81], s[92:93]
    v_pk_mul_f32 v[82:83], v[82:83], s[92:93]
    v_pk_mul_f32 v[84:85], v[84:85], s[92:93]
    v_pk_mul_f32 v[86:87], v[86:87], s[92:93]
    v_cvt_pk_bf16_f32 v80, v80, v81
    v_cvt_pk_bf16_f32 v81, v82, v83
    v_cvt_pk_bf16_f32 v82, v84, v85
    v_cvt_pk_bf16_f32 v83, v86, v87
    buffer_store_dwordx4 v[80:83], v2, s[8:11], s90 offen sc1
    s_add_u32 s90, s90, s100
    v_pk_mul_f32 v[88:89], v[88:89], s[92:93]
    v_pk_mul_f32 v[90:91], v[90:91], s[92:93]
    v_pk_mul_f32 v[92:93], v[92:93], s[92:93]
    v_pk_mul_f32 v[94:95], v[94:95], s[92:93]
    v_cvt_pk_bf16_f32 v88, v88, v89
    v_cvt_pk_bf16_f32 v89, v90, v91
    v_cvt_pk_bf16_f32 v90, v92, v93
    v_cvt_pk_bf16_f32 v91, v94, v95
    buffer_store_dwordx4 v[88:91], v2, s[8:11], s90 offen sc1
    s_add_u32 s90, s98, s99
    v_pk_mul_f32 v[96:97], v[96:97], s[92:93]
    v_pk_mul_f32 v[98:99], v[98:99], s[92:93]
    v_pk_mul_f32 v[100:101], v[100:101], s[92:93]
    v_pk_mul_f32 v[102:103], v[102:103], s[92:93]
    v_cvt_pk_bf16_f32 v96, v96, v97
    v_cvt_pk_bf16_f32 v97, v98, v99
    v_cvt_pk_bf16_f32 v98, v100, v101
    v_cvt_pk_bf16_f32 v99, v102, v103
    buffer_store_dwordx4 v[96:99], v2, s[8:11], s90 offen sc1
    s_add_u32 s90, s90, s100
    v_pk_mul_f32 v[104:105], v[104:105], s[92:93]
    v_pk_mul_f32 v[106:107], v[106:107], s[92:93]
    v_pk_mul_f32 v[108:109], v[108:109], s[92:93]
    v_pk_mul_f32 v[110:111], v[110:111], s[92:93]
    v_cvt_pk_bf16_f32 v104, v104, v105
    v_cvt_pk_bf16_f32 v105, v106, v107
    v_cvt_pk_bf16_f32 v106, v108, v109
    v_cvt_pk_bf16_f32 v107, v110, v111
    buffer_store_dwordx4 v[104:107], v2, s[8:11], s90 offen sc1
    s_add_u32 s90, s90, s100
    v_pk_mul_f32 v[112:113], v[112:113], s[92:93]
    v_pk_mul_f32 v[114:115], v[114:115], s[92:93]
    v_pk_mul_f32 v[116:117], v[116:117], s[92:93]
    v_pk_mul_f32 v[118:119], v[118:119], s[92:93]
    v_cvt_pk_bf16_f32 v112, v112, v113
    v_cvt_pk_bf16_f32 v113, v114, v115
    v_cvt_pk_bf16_f32 v114, v116, v117
    v_cvt_pk_bf16_f32 v115, v118, v119
    buffer_store_dwordx4 v[112:115], v2, s[8:11], s90 offen sc1
    s_add_u32 s90, s90, s100
    v_pk_mul_f32 v[120:121], v[120:121], s[92:93]
    v_pk_mul_f32 v[122:123], v[122:123], s[92:93]
    v_pk_mul_f32 v[124:125], v[124:125], s[92:93]
    v_pk_mul_f32 v[126:127], v[126:127], s[92:93]
    v_cvt_pk_bf16_f32 v120, v120, v121
    v_cvt_pk_bf16_f32 v121, v122, v123
    v_cvt_pk_bf16_f32 v122, v124, v125
    v_cvt_pk_bf16_f32 v123, v126, v127
    buffer_store_dwordx4 v[120:123], v2, s[8:11], s90 offen sc1
    s_add_u32 s90, s90, s100
    v_pk_mul_f32 v[128:129], v[128:129], s[92:93]
    v_pk_mul_f32 v[130:131], v[130:131], s[92:93]
    v_pk_mul_f32 v[132:133], v[132:133], s[92:93]
    v_pk_mul_f32 v[134:135], v[134:135], s[92:93]
    v_cvt_pk_bf16_f32 v128, v128, v129
    v_cvt_pk_bf16_f32 v129, v130, v131
    v_cvt_pk_bf16_f32 v130, v132, v133
    v_cvt_pk_bf16_f32 v131, v134, v135
    buffer_store_dwordx4 v[128:131], v2, s[8:11], s90 offen sc1
    s_add_u32 s90, s90, s100
    v_pk_mul_f32 v[136:137], v[136:137], s[92:93]
    v_pk_mul_f32 v[138:139], v[138:139], s[92:93]
    v_pk_mul_f32 v[140:141], v[140:141], s[92:93]
    v_pk_mul_f32 v[142:143], v[142:143], s[92:93]
    v_cvt_pk_bf16_f32 v136, v136, v137
    v_cvt_pk_bf16_f32 v137, v138, v139
    v_cvt_pk_bf16_f32 v138, v140, v141
    v_cvt_pk_bf16_f32 v139, v142, v143
    buffer_store_dwordx4 v[136:139], v2, s[8:11], s90 offen sc1
    s_add_u32 s90, s90, s100
    v_pk_mul_f32 v[144:145], v[144:145], s[92:93]
    v_pk_mul_f32 v[146:147], v[146:147], s[92:93]
    v_pk_mul_f32 v[148:149], v[148:149], s[92:93]
    v_pk_mul_f32 v[150:151], v[150:151], s[92:93]
    v_cvt_pk_bf16_f32 v144, v144, v145
    v_cvt_pk_bf16_f32 v145, v146, v147
    v_cvt_pk_bf16_f32 v146, v148, v149
    v_cvt_pk_bf16_f32 v147, v150, v151
    buffer_store_dwordx4 v[144:147], v2, s[8:11], s90 offen sc1
    s_add_u32 s90, s90, s100
    v_pk_mul_f32 v[152:153], v[152:153], s[92:93]
    v_pk_mul_f32 v[154:155], v[154:155], s[92:93]
    v_pk_mul_f32 v[156:157], v[156:157], s[92:93]
    v_pk_mul_f32 v[158:159], v[158:159], s[92:93]
    v_cvt_pk_bf16_f32 v152, v152, v153
    v_cvt_pk_bf16_f32 v153, v154, v155
    v_cvt_pk_bf16_f32 v154, v156, v157
    v_cvt_pk_bf16_f32 v155, v158, v159
    buffer_store_dwordx4 v[152:155], v2, s[8:11], s90 offen sc1
    s_add_u32 s90, s90, s100
    v_pk_mul_f32 v[192:193], v[192:193], s[92:93]
    v_pk_mul_f32 v[194:195], v[194:195], s[92:93]
    v_pk_mul_f32 v[196:197], v[196:197], s[92:93]
    v_pk_mul_f32 v[198:199], v[198:199], s[92:93]
    v_cvt_pk_bf16_f32 v192, v192, v193
    v_cvt_pk_bf16_f32 v193, v194, v195
    v_cvt_pk_bf16_f32 v194, v196, v197
    v_cvt_pk_bf16_f32 v195, v198, v199
    v_pk_mul_f32 v[200:201], v[200:201], s[92:93]
    v_pk_mul_f32 v[202:203], v[202:203], s[92:93]
    v_pk_mul_f32 v[204:205], v[204:205], s[92:93]
    v_pk_mul_f32 v[206:207], v[206:207], s[92:93]
    v_cvt_pk_bf16_f32 v196, v200, v201
    v_cvt_pk_bf16_f32 v197, v202, v203
    v_cvt_pk_bf16_f32 v198, v204, v205
    v_cvt_pk_bf16_f32 v199, v206, v207
    v_pk_mul_f32 v[208:209], v[208:209], s[92:93]
    v_pk_mul_f32 v[210:211], v[210:211], s[92:93]
    v_pk_mul_f32 v[212:213], v[212:213], s[92:93]
    v_pk_mul_f32 v[214:215], v[214:215], s[92:93]
    v_cvt_pk_bf16_f32 v200, v208, v209
    v_cvt_pk_bf16_f32 v201, v210, v211
    v_cvt_pk_bf16_f32 v202, v212, v213
    v_cvt_pk_bf16_f32 v203, v214, v215
    v_pk_mul_f32 v[216:217], v[216:217], s[92:93]
    v_pk_mul_f32 v[218:219], v[218:219], s[92:93]
    v_pk_mul_f32 v[220:221], v[220:221], s[92:93]
    v_pk_mul_f32 v[222:223], v[222:223], s[92:93]
    v_cvt_pk_bf16_f32 v204, v216, v217
    v_cvt_pk_bf16_f32 v205, v218, v219
    v_cvt_pk_bf16_f32 v206, v220, v221
    v_cvt_pk_bf16_f32 v207, v222, v223
    v_pk_mul_f32 v[224:225], v[224:225], s[92:93]
    v_pk_mul_f32 v[226:227], v[226:227], s[92:93]
    v_pk_mul_f32 v[228:229], v[228:229], s[92:93]
    v_pk_mul_f32 v[230:231], v[230:231], s[92:93]
    v_cvt_pk_bf16_f32 v208, v224, v225
    v_cvt_pk_bf16_f32 v209, v226, v227
    v_cvt_pk_bf16_f32 v210, v228, v229
    v_cvt_pk_bf16_f32 v211, v230, v231
    v_pk_mul_f32 v[232:233], v[232:233], s[92:93]
    v_pk_mul_f32 v[234:235], v[234:235], s[92:93]
    v_pk_mul_f32 v[236:237], v[236:237], s[92:93]
    v_pk_mul_f32 v[238:239], v[238:239], s[92:93]
    v_cvt_pk_bf16_f32 v212, v232, v233
    v_cvt_pk_bf16_f32 v213, v234, v235
    v_cvt_pk_bf16_f32 v214, v236, v237
    v_cvt_pk_bf16_f32 v215, v238, v239
    v_pk_mul_f32 v[240:241], v[240:241], s[92:93]
    v_pk_mul_f32 v[242:243], v[242:243], s[92:93]
    v_pk_mul_f32 v[244:245], v[244:245], s[92:93]
    v_pk_mul_f32 v[246:247], v[246:247], s[92:93]
    v_cvt_pk_bf16_f32 v216, v240, v241
    v_cvt_pk_bf16_f32 v217, v242, v243
    v_cvt_pk_bf16_f32 v218, v244, v245
    v_cvt_pk_bf16_f32 v219, v246, v247
    v_pk_mul_f32 v[248:249], v[248:249], s[92:93]
    v_pk_mul_f32 v[250:251], v[250:251], s[92:93]
    v_pk_mul_f32 v[252:253], v[252:253], s[92:93]
    v_pk_mul_f32 v[254:255], v[254:255], s[92:93]
    v_cvt_pk_bf16_f32 v220, v248, v249
    v_cvt_pk_bf16_f32 v221, v250, v251
    v_cvt_pk_bf16_f32 v222, v252, v253
    v_cvt_pk_bf16_f32 v223, v254, v255
    v_accvgpr_read_b32 v24, a224
    v_accvgpr_read_b32 v25, a225
    v_accvgpr_read_b32 v26, a226
    v_accvgpr_read_b32 v27, a227
    v_accvgpr_read_b32 v28, a228
    v_accvgpr_read_b32 v29, a229
    v_accvgpr_read_b32 v30, a230
    v_accvgpr_read_b32 v31, a231
    v_pk_mul_f32 v[24:25], v[24:25], s[92:93]
    v_pk_mul_f32 v[26:27], v[26:27], s[92:93]
    v_pk_mul_f32 v[28:29], v[28:29], s[92:93]
    v_pk_mul_f32 v[30:31], v[30:31], s[92:93]
    v_cvt_pk_bf16_f32 v224, v24, v25
    v_cvt_pk_bf16_f32 v225, v26, v27
    v_cvt_pk_bf16_f32 v226, v28, v29
    v_cvt_pk_bf16_f32 v227, v30, v31
    v_accvgpr_read_b32 v24, a232
    v_accvgpr_read_b32 v25, a233
    v_accvgpr_read_b32 v26, a234
    v_accvgpr_read_b32 v27, a235
    v_accvgpr_read_b32 v28, a236
    v_accvgpr_read_b32 v29, a237
    v_accvgpr_read_b32 v30, a238
    v_accvgpr_read_b32 v31, a239
    v_pk_mul_f32 v[24:25], v[24:25], s[92:93]
    v_pk_mul_f32 v[26:27], v[26:27], s[92:93]
    v_pk_mul_f32 v[28:29], v[28:29], s[92:93]
    v_pk_mul_f32 v[30:31], v[30:31], s[92:93]
    v_cvt_pk_bf16_f32 v228, v24, v25
    v_cvt_pk_bf16_f32 v229, v26, v27
    v_cvt_pk_bf16_f32 v230, v28, v29
    v_cvt_pk_bf16_f32 v231, v30, v31
    v_accvgpr_read_b32 v24, a240
    v_accvgpr_read_b32 v25, a241
    v_accvgpr_read_b32 v26, a242
    v_accvgpr_read_b32 v27, a243
    v_accvgpr_read_b32 v28, a244
    v_accvgpr_read_b32 v29, a245
    v_accvgpr_read_b32 v30, a246
    v_accvgpr_read_b32 v31, a247
    v_pk_mul_f32 v[24:25], v[24:25], s[92:93]
    v_pk_mul_f32 v[26:27], v[26:27], s[92:93]
    v_pk_mul_f32 v[28:29], v[28:29], s[92:93]
    v_pk_mul_f32 v[30:31], v[30:31], s[92:93]
    v_cvt_pk_bf16_f32 v232, v24, v25
    v_cvt_pk_bf16_f32 v233, v26, v27
    v_cvt_pk_bf16_f32 v234, v28, v29
    v_cvt_pk_bf16_f32 v235, v30, v31
    v_accvgpr_read_b32 v24, a248
    v_accvgpr_read_b32 v25, a249
    v_accvgpr_read_b32 v26, a250
    v_accvgpr_read_b32 v27, a251
    v_accvgpr_read_b32 v28, a252
    v_accvgpr_read_b32 v29, a253
    v_accvgpr_read_b32 v30, a254
    v_accvgpr_read_b32 v31, a255
    v_pk_mul_f32 v[24:25], v[24:25], s[92:93]
    v_pk_mul_f32 v[26:27], v[26:27], s[92:93]
    v_pk_mul_f32 v[28:29], v[28:29], s[92:93]
    v_pk_mul_f32 v[30:31], v[30:31], s[92:93]
    v_cvt_pk_bf16_f32 v236, v24, v25
    v_cvt_pk_bf16_f32 v237, v26, v27
    v_cvt_pk_bf16_f32 v238, v28, v29
    v_cvt_pk_bf16_f32 v239, v30, v31
    v_pk_mul_f32 v[160:161], v[160:161], s[92:93]
    v_pk_mul_f32 v[162:163], v[162:163], s[92:93]
    v_pk_mul_f32 v[164:165], v[164:165], s[92:93]
    v_pk_mul_f32 v[166:167], v[166:167], s[92:93]
    v_cvt_pk_bf16_f32 v240, v160, v161
    v_cvt_pk_bf16_f32 v241, v162, v163
    v_cvt_pk_bf16_f32 v242, v164, v165
    v_cvt_pk_bf16_f32 v243, v166, v167
    v_pk_mul_f32 v[168:169], v[168:169], s[92:93]
    v_pk_mul_f32 v[170:171], v[170:171], s[92:93]
    v_pk_mul_f32 v[172:173], v[172:173], s[92:93]
    v_pk_mul_f32 v[174:175], v[174:175], s[92:93]
    v_cvt_pk_bf16_f32 v244, v168, v169
    v_cvt_pk_bf16_f32 v245, v170, v171
    v_cvt_pk_bf16_f32 v246, v172, v173
    v_cvt_pk_bf16_f32 v247, v174, v175
    v_pk_mul_f32 v[176:177], v[176:177], s[92:93]
    v_pk_mul_f32 v[178:179], v[178:179], s[92:93]
    v_pk_mul_f32 v[180:181], v[180:181], s[92:93]
    v_pk_mul_f32 v[182:183], v[182:183], s[92:93]
    v_cvt_pk_bf16_f32 v248, v176, v177
    v_cvt_pk_bf16_f32 v249, v178, v179
    v_cvt_pk_bf16_f32 v250, v180, v181
    v_cvt_pk_bf16_f32 v251, v182, v183
    v_pk_mul_f32 v[184:185], v[184:185], s[92:93]
    v_pk_mul_f32 v[186:187], v[186:187], s[92:93]
    v_pk_mul_f32 v[188:189], v[188:189], s[92:93]
    v_pk_mul_f32 v[190:191], v[190:191], s[92:93]
    v_cvt_pk_bf16_f32 v252, v184, v185
    v_cvt_pk_bf16_f32 v253, v186, v187
    v_cvt_pk_bf16_f32 v254, v188, v189
    v_cvt_pk_bf16_f32 v255, v190, v191
    s_setpc_b64 s[20:21]
m_ns264:
    s_mov_b32 s90, s98
    v_cvt_pk_bf16_f32 v32, v32, v33
    v_cvt_pk_bf16_f32 v33, v34, v35
    v_cvt_pk_bf16_f32 v34, v36, v37
    v_cvt_pk_bf16_f32 v35, v38, v39
    buffer_store_dwordx4 v[32:35], v2, s[8:11], s90 offen sc1
    s_add_u32 s90, s90, s100
    v_cvt_pk_bf16_f32 v40, v40, v41
    v_cvt_pk_bf16_f32 v41, v42, v43
    v_cvt_pk_bf16_f32 v42, v44, v45
    v_cvt_pk_bf16_f32 v43, v46, v47
    buffer_store_dwordx4 v[40:43], v2, s[8:11], s90 offen sc1
    s_add_u32 s90, s90, s100
    v_cvt_pk_bf16_f32 v48, v48, v49
    v_cvt_pk_bf16_f32 v49, v50, v51
    v_cvt_pk_bf16_f32 v50, v52, v53
    v_cvt_pk_bf16_f32 v51, v54, v55
    buffer_store_dwordx4 v[48:51], v2, s[8:11], s90 offen sc1
    s_add_u32 s90, s90, s100
    v_cvt_pk_bf16_f32 v56, v56, v57
    v_cvt_pk_bf16_f32 v57, v58, v59
    v_cvt_pk_bf16_f32 v58, v60, v61
    v_cvt_pk_bf16_f32 v59, v62, v63
    buffer_store_dwordx4 v[56:59], v2, s[8:11], s90 offen sc1
    s_add_u32 s90, s90, s100
    v_cvt_pk_bf16_f32 v64, v64, v65
    v_cvt_pk_bf16_f32 v65, v66, v67
    v_cvt_pk_bf16_f32 v66, v68, v69
    v_cvt_pk_bf16_f32 v67, v70, v71
    buffer_store_dwordx4 v[64:67], v2, s[8:11], s90 offen sc1
    s_add_u32 s90, s90, s100
    v_cvt_pk_bf16_f32 v72, v72, v73
    v_cvt_pk_bf16_f32 v73, v74, v75
    v_cvt_pk_bf16_f32 v74, v76, v77
    v_cvt_pk_bf16_f32 v75, v78, v79
    buffer_store_dwordx4 v[72:75], v2, s[8:11], s90 offen sc1
    s_add_u32 s90, s90, s100
    v_cvt_pk_bf16_f32 v80, v80, v81
    v_cvt_pk_bf16_f32 v81, v82, v83
    v_cvt_pk_bf16_f32 v82, v84, v85
    v_cvt_pk_bf16_f32 v83, v86, v87
    buffer_store_dwordx4 v[80:83], v2, s[8:11], s90 offen sc1
    s_add_u32 s90, s90, s100
    v_cvt_pk_bf16_f32 v88, v88, v89
    v_cvt_pk_bf16_f32 v89, v90, v91
    v_cvt_pk_bf16_f32 v90, v92, v93
    v_cvt_pk_bf16_f32 v91, v94, v95
    buffer_store_dwordx4 v[88:91], v2, s[8:11], s90 offen sc1
    s_add_u32 s90, s98, s99
    v_cvt_pk_bf16_f32 v96, v96, v97
    v_cvt_pk_bf16_f32 v97, v98, v99
    v_cvt_pk_bf16_f32 v98, v100, v101
    v_cvt_pk_bf16_f32 v99, v102, v103
    buffer_store_dwordx4 v[96:99], v2, s[8:11], s90 offen sc1
    s_add_u32 s90, s90, s100
    v_cvt_pk_bf16_f32 v104, v104, v105
    v_cvt_pk_bf16_f32 v105, v106, v107
    v_cvt_pk_bf16_f32 v106, v108, v109
    v_cvt_pk_bf16_f32 v107, v110, v111
    buffer_store_dwordx4 v[104:107], v2, s[8:11], s90 offen sc1
    s_add_u32 s90, s90, s100
    v_cvt_pk_bf16_f32 v112, v112, v113
    v_cvt_pk_bf16_f32 v113, v114, v115
    v_cvt_pk_bf16_f32 v114, v116, v117
    v_cvt_pk_bf16_f32 v115, v118, v119
    buffer_store_dwordx4 v[112:115], v2, s[8:11], s90 offen sc1
    s_add_u32 s90, s90, s100
    v_cvt_pk_bf16_f32 v120, v120, v121
    v_cvt_pk_bf16_f32 v121, v122, v123
    v_cvt_pk_bf16_f32 v122, v124, v125
    v_cvt_pk_bf16_f32 v123, v126, v127
    buffer_store_dwordx4 v[120:123], v2, s[8:11], s90 offen sc1
    s_add_u32 s90, s90, s100
    v_cvt_pk_bf16_f32 v128, v128, v129
    v_cvt_pk_bf16_f32 v129, v130, v131
    v_cvt_pk_bf16_f32 v130, v132, v133
    v_cvt_pk_bf16_f32 v131, v134, v135
    buffer_store_dwordx4 v[128:131], v2, s[8:11], s90 offen sc1
    s_add_u32 s90, s90, s100
    v_cvt_pk_bf16_f32 v136, v136, v137
    v_cvt_pk_bf16_f32 v137, v138, v139
    v_cvt_pk_bf16_f32 v138, v140, v141
    v_cvt_pk_bf16_f32 v139, v142, v143
    buffer_store_dwordx4 v[136:139], v2, s[8:11], s90 offen sc1
    s_add_u32 s90, s90, s100
    v_cvt_pk_bf16_f32 v144, v144, v145
    v_cvt_pk_bf16_f32 v145, v146, v147
    v_cvt_pk_bf16_f32 v146, v148, v149
    v_cvt_pk_bf16_f32 v147, v150, v151
    buffer_store_dwordx4 v[144:147], v2, s[8:11], s90 offen sc1
    s_add_u32 s90, s90, s100
    v_cvt_pk_bf16_f32 v152, v152, v153
    v_cvt_pk_bf16_f32 v153, v154, v155
    v_cvt_pk_bf16_f32 v154, v156, v157
    v_cvt_pk_bf16_f32 v155, v158, v159
    buffer_store_dwordx4 v[152:155], v2, s[8:11], s90 offen sc1
    s_add_u32 s90, s90, s100
    v_cvt_pk_bf16_f32 v192, v192, v193
    v_cvt_pk_bf16_f32 v193, v194, v195
    v_cvt_pk_bf16_f32 v194, v196, v197
    v_cvt_pk_bf16_f32 v195, v198, v199
    v_cvt_pk_bf16_f32 v196, v200, v201
    v_cvt_pk_bf16_f32 v197, v202, v203
    v_cvt_pk_bf16_f32 v198, v204, v205
    v_cvt_pk_bf16_f32 v199, v206, v207
    v_cvt_pk_bf16_f32 v200, v208, v209
    v_cvt_pk_bf16_f32 v201, v210, v211
    v_cvt_pk_bf16_f32 v202, v212, v213
    v_cvt_pk_bf16_f32 v203, v214, v215
    v_cvt_pk_bf16_f32 v204, v216, v217
    v_cvt_pk_bf16_f32 v205, v218, v219
    v_cvt_pk_bf16_f32 v206, v220, v221
    v_cvt_pk_bf16_f32 v207, v222, v223
    v_cvt_pk_bf16_f32 v208, v224, v225
    v_cvt_pk_bf16_f32 v209, v226, v227
    v_cvt_pk_bf16_f32 v210, v228, v229
    v_cvt_pk_bf16_f32 v211, v230, v231
    v_cvt_pk_bf16_f32 v212, v232, v233
    v_cvt_pk_bf16_f32 v213, v234, v235
    v_cvt_pk_bf16_f32 v214, v236, v237
    v_cvt_pk_bf16_f32 v215, v238, v239
    v_cvt_pk_bf16_f32 v216, v240, v241
    v_cvt_pk_bf16_f32 v217, v242, v243
    v_cvt_pk_bf16_f32 v218, v244, v245
    v_cvt_pk_bf16_f32 v219, v246, v247
    v_cvt_pk_bf16_f32 v220, v248, v249
    v_cvt_pk_bf16_f32 v221, v250, v251
    v_cvt_pk_bf16_f32 v222, v252, v253
    v_cvt_pk_bf16_f32 v223, v254, v255
    v_accvgpr_read_b32 v24, a224
    v_accvgpr_read_b32 v25, a225
    v_accvgpr_read_b32 v26, a226
    v_accvgpr_read_b32 v27, a227
    v_accvgpr_read_b32 v28, a228
    v_accvgpr_read_b32 v29, a229
    v_accvgpr_read_b32 v30, a230
    v_accvgpr_read_b32 v31, a231
    v_cvt_pk_bf16_f32 v224, v24, v25
    v_cvt_pk_bf16_f32 v225, v26, v27
    v_cvt_pk_bf16_f32 v226, v28, v29
    v_cvt_pk_bf16_f32 v227, v30, v31
    v_accvgpr_read_b32 v24, a232
    v_accvgpr_read_b32 v25, a233
    v_accvgpr_read_b32 v26, a234
    v_accvgpr_read_b32 v27, a235
    v_accvgpr_read_b32 v28, a236
    v_accvgpr_read_b32 v29, a237
    v_accvgpr_read_b32 v30, a238
    v_accvgpr_read_b32 v31, a239
    v_cvt_pk_bf16_f32 v228, v24, v25
    v_cvt_pk_bf16_f32 v229, v26, v27
    v_cvt_pk_bf16_f32 v230, v28, v29
    v_cvt_pk_bf16_f32 v231, v30, v31
    v_accvgpr_read_b32 v24, a240
    v_accvgpr_read_b32 v25, a241
    v_accvgpr_read_b32 v26, a242
    v_accvgpr_read_b32 v27, a243
    v_accvgpr_read_b32 v28, a244
    v_accvgpr_read_b32 v29, a245
    v_accvgpr_read_b32 v30, a246
    v_accvgpr_read_b32 v31, a247
    v_cvt_pk_bf16_f32 v232, v24, v25
    v_cvt_pk_bf16_f32 v233, v26, v27
    v_cvt_pk_bf16_f32 v234, v28, v29
    v_cvt_pk_bf16_f32 v235, v30, v31
    v_accvgpr_read_b32 v24, a248
    v_accvgpr_read_b32 v25, a249
    v_accvgpr_read_b32 v26, a250
    v_accvgpr_read_b32 v27, a251
    v_accvgpr_read_b32 v28, a252
    v_accvgpr_read_b32 v29, a253
    v_accvgpr_read_b32 v30, a254
    v_accvgpr_read_b32 v31, a255
    v_cvt_pk_bf16_f32 v236, v24, v25
    v_cvt_pk_bf16_f32 v237, v26, v27
    v_cvt_pk_bf16_f32 v238, v28, v29
    v_cvt_pk_bf16_f32 v239, v30, v31
    v_cvt_pk_bf16_f32 v240, v160, v161
    v_cvt_pk_bf16_f32 v241, v162, v163
    v_cvt_pk_bf16_f32 v242, v164, v165
    v_cvt_pk_bf16_f32 v243, v166, v167
    v_cvt_pk_bf16_f32 v244, v168, v169
    v_cvt_pk_bf16_f32 v245, v170, v171
    v_cvt_pk_bf16_f32 v246, v172, v173
    v_cvt_pk_bf16_f32 v247, v174, v175
    v_cvt_pk_bf16_f32 v248, v176, v177
    v_cvt_pk_bf16_f32 v249, v178, v179
    v_cvt_pk_bf16_f32 v250, v180, v181
    v_cvt_pk_bf16_f32 v251, v182, v183
    v_cvt_pk_bf16_f32 v252, v184, v185
    v_cvt_pk_bf16_f32 v253, v186, v187
    v_cvt_pk_bf16_f32 v254, v188, v189
    v_cvt_pk_bf16_f32 v255, v190, v191
    s_setpc_b64 s[20:21]
m_pf7:
    s_mov_b32 s15, 0x20000
    s_sub_u32 s93, s2, 224
    s_lshl_b32 s93, s93, 2
    s_add_u32 s93, s93, s16
    v_lshlrev_b32 v24, 7, v1
    v_lshrrev_b32 v25, 3, v1
    v_lshlrev_b32 v25, 11, v25
    v_and_b32 v26, 7, v1
    v_lshl_add_u32 v25, v26, 7, v25
    s_lshl_b32 s92, s93, 13
    s_lshl_b32 s93, s93, 14
    s_add_u32 s93, s93, 1024
    s_mov_b32 s12, s26
    s_mov_b32 s13, s27
    s_mov_b32 s14, 6291456
    s_add_u32 s90, s92, 0
    buffer_load_dword v22, v24, s[12:15], s90 offen
    s_add_u32 s90, s92, 1048576
    buffer_load_dword v22, v24, s[12:15], s90 offen
    s_mov_b32 s12, s24
    s_mov_b32 s13, s25
    s_mov_b32 s14, 4194304
    s_add_u32 s90, s92, 0
    buffer_load_dword v22, v24, s[12:15], s90 offen
    s_add_u32 s90, s92, 1048576
    buffer_load_dword v22, v24, s[12:15], s90 offen
    s_add_u32 s90, s92, 2097152
    buffer_load_dword v22, v24, s[12:15], s90 offen
    s_add_u32 s90, s92, 3145728
    buffer_load_dword v22, v24, s[12:15], s90 offen
    s_mov_b32 s12, s34
    s_mov_b32 s13, s35
    s_mov_b32 s14, 8388608
    s_add_u32 s90, s92, 4194304
    buffer_load_dword v22, v24, s[12:15], s90 offen
    s_add_u32 s90, s92, 5242880
    buffer_load_dword v22, v24, s[12:15], s90 offen
    s_mov_b32 s12, s30
    s_mov_b32 s13, s31
    s_mov_b32 s14, 4194304
    s_add_u32 s90, s93, 0
    buffer_load_dword v22, v25, s[12:15], s90 offen
    s_add_u32 s90, s93, 2097152
    buffer_load_dword v22, v25, s[12:15], s90 offen
    s_mov_b32 s12, s26
    s_mov_b32 s13, s27
    s_mov_b32 s14, 6291456
    s_add_u32 s90, s92, 2097152
    buffer_load_dword v22, v24, s[12:15], s90 offen
    s_mov_b32 s12, s34
    s_mov_b32 s13, s35
    s_mov_b32 s14, 8388608
    s_add_u32 s90, s92, 6291456
    buffer_load_dword v22, v24, s[12:15], s90 offen
    s_add_u32 s90, s92, 7340032
    buffer_load_dword v22, v24, s[12:15], s90 offen
    s_mov_b32 s12, s26
    s_mov_b32 s13, s27
    s_mov_b32 s14, 6291456
    s_add_u32 s90, s92, 3145728
    buffer_load_dword v22, v24, s[12:15], s90 offen
    s_add_u32 s90, s92, 4194304
    buffer_load_dword v22, v24, s[12:15], s90 offen
    s_add_u32 s90, s92, 5242880
    buffer_load_dword v22, v24, s[12:15], s90 offen
    s_mov_b32 s12, s32
    s_mov_b32 s13, s33
    s_mov_b32 s14, 2097152
    s_add_u32 s90, s92, 1048576
    buffer_load_dword v22, v24, s[12:15], s90 offen
    s_add_u32 s61, s61, 32768
    s_branch m_nopf6
concat_heads__sliding_local_dilated__compressed_kv_cla__prompt_kernel_end:
.section .rodata,"a"
.p2align 6
.amdhsa_kernel concat_heads__sliding_local_dilated__compressed_kv_cla__prompt_kernel
  .amdhsa_next_free_vgpr 512
  .amdhsa_next_free_sgpr 102
  .amdhsa_accum_offset 256
  .amdhsa_group_segment_fixed_size 0
  .amdhsa_kernarg_size 96
  .amdhsa_user_sgpr_count 2
  .amdhsa_user_sgpr_kernarg_segment_ptr 1
  .amdhsa_system_sgpr_workgroup_id_x 1
.end_amdhsa_kernel
```

```asm
; @launch grid=(256,1,1) block=(256,1,1) lds=163840
.amdgcn_target "amdgcn-amd-amdhsa--gfx950"
.text
.globl concat_heads__sliding_local_dilated__compressed_kv_cla__prompt_kernel
.p2align 8
.type concat_heads__sliding_local_dilated__compressed_kv_cla__prompt_kernel,@function
concat_heads__sliding_local_dilated__compressed_kv_cla__prompt_kernel:
    s_cmp_ge_u32 s2, 256
    s_cbranch_scc1 m_end1
    s_load_dwordx16 s[24:39], s[0:1], 0
    s_load_dwordx4 s[4:7], s[0:1], 80
    v_and_b32 v1, 63, v0
    v_lshrrev_b32 v24, 6, v0
    s_nop 0
    v_readfirstlane_b32 s16, v24
    s_lshr_b32 s68, s2, 3
    s_lshr_b32 s57, s16, 1
    s_and_b32 s58, s16, 1
    s_mov_b32 s43, 0x20000
    s_mov_b32 s47, 0x20000
    s_cmp_lt_u32 s68, 28
    s_cbranch_scc1 m_ncp2
    s_sub_u32 s91, s68, 28
    s_lshl_b32 s91, s91, 2
    s_add_u32 s91, s91, s16
    s_getpc_b64 s[8:9]
m_pc3:
    s_sub_u32 s8, s8, m_pc3-concat_heads__sliding_local_dilated__compressed_kv_cla__prompt_kernel
    s_subb_u32 s9, s9, 0
    s_lshl_b32 s90, s91, 13
    v_lshlrev_b32 v24, 7, v1
    v_add_u32 v24, s90, v24
    v_min_u32 v24, concat_heads__sliding_local_dilated__compressed_kv_cla__prompt_kernel_end-concat_heads__sliding_local_dilated__compressed_kv_cla__prompt_kernel-4, v24
    v_mov_b32 v25, s9
    v_add_co_u32 v24, vcc, s8, v24
    s_nop 1
    v_addc_co_u32 v25, vcc, 0, v25, vcc
    global_load_dword v22, v[24:25], off
m_ncp2:
    s_lshl_b32 s61, s16, 13
    s_add_u32 s62, s61, 98304
    s_cmp_ge_u32 s68, 16
    s_cbranch_scc1 m_typea4
    s_and_b32 s69, s68, 3
    s_and_b32 s90, s2, 1
    s_lshl_b32 s90, s90, 2
    s_add_u32 s69, s69, s90
    s_bfe_u32 s90, s2, 0x20001
    s_mul_i32 s90, s90, 4
    s_bfe_u32 s91, s68, 0x20002
    s_add_u32 s90, s90, s91
    s_mov_b32 s76, 8388608
    s_mov_b32 s78, 8192
    s_mov_b32 s81, 0
    s_mov_b32 s73, 4194304
    s_mov_b32 s77, 2048
    s_mov_b32 s82, 16
    s_lshl_b32 s80, s90, 9
    s_lshl_b32 s79, s69, 19
    s_lshl_b32 s88, s90, 4
    s_add_u32 s88, s88, s69
    s_lshl_b32 s88, s88, 3
    s_mov_b32 s83, 0
    s_mov_b32 s84, 1040356334
    s_lshl_b32 s91, s90, 1
    s_add_u32 s91, s91, s58
    s_lshl_b32 s91, s91, 19
    s_lshl_b32 s92, s69, 1
    s_add_u32 s92, s92, s57
    s_lshl_b32 s92, s92, 15
    s_add_u32 s85, s91, s92
    s_add_u32 s85, s85, 0
    s_mov_b32 s86, 1024
    s_mov_b32 s87, 4096
    s_branch m_go15
m_typea4:
    s_bfe_u32 s69, s68, 0x20002
    s_add_u32 s69, s69, 0
    s_and_b32 s90, s2, 7
    s_lshl_b32 s90, s90, 2
    s_and_b32 s91, s68, 3
    s_add_u32 s90, s90, s91
    s_cmp_lt_u32 s90, 16
    s_cselect_b32 s83, 0, 1
    s_mov_b32 s91, 33554432
    s_cselect_b32 s85, 16777216, s91
    s_mov_b32 s91, 8192
    s_cselect_b32 s86, 1024, s91
    s_mov_b32 s91, 1024
    s_cselect_b32 s87, 4096, s91
    s_mov_b32 s73, 2097152
    s_mov_b32 s77, 1024
    s_mov_b32 s82, 8
    s_mov_b32 s81, 0
    s_mov_b32 s76, 4194304
    s_mov_b32 s78, 8192
    s_mov_b32 s84, 0
    s_and_b32 s90, s90, 15
    s_lshl_b32 s80, s90, 9
    s_lshl_b32 s79, s69, 18
    s_lshl_b32 s91, s83, 2
    s_add_u32 s91, s91, s69
    s_cmp_ge_u32 s69, 4
    s_cselect_b32 s92, 508, 8
    s_add_u32 s91, s91, s92
    s_lshl_b32 s88, s90, 4
    s_add_u32 s88, s88, s91
    s_lshl_b32 s88, s88, 3
    s_lshl_b32 s91, s90, 1
    s_add_u32 s91, s91, s58
    s_lshl_b32 s91, s91, 19
    s_lshl_b32 s92, s69, 1
    s_add_u32 s92, s92, s57
    s_lshl_b32 s92, s92, 15
    s_add_u32 s85, s85, s91
    s_add_u32 s85, s85, s92
m_go15:
    s_mov_b32 s42, s73
    s_lshl_b32 s90, s77, 4
    s_lshl_b32 s90, s90, s81
    s_mov_b32 s48, s79
    s_mul_i32 s91, s90, 1
    s_add_u32 s49, s91, s79
    s_sub_u32 s49, s49, 2048
    s_mul_i32 s91, s90, 2
    s_add_u32 s50, s91, s79
    s_mul_i32 s91, s90, 3
    s_add_u32 s51, s91, s79
    s_sub_u32 s51, s51, 2048
    s_lshl_b32 s90, s58, 7
    s_add_u32 s90, s90, s57
    s_lshl_b32 s91, s16, 6
    s_cmp_eq_u32 s81, 1
    s_cselect_b32 s90, s90, s91
    v_lshrrev_b32 v24, 3, v1
    v_lshlrev_b32 v24, s81, v24
    v_add_u32 v24, s90, v24
    v_mul_lo_u32 v24, v24, s77
    v_lshrrev_b32 v25, 4, v1
    v_and_b32 v26, 7, v1
    v_xor_b32 v25, v25, v26
    v_lshl_add_u32 v16, v25, 4, v24
    v_xor_b32 v25, 4, v25
    v_lshl_add_u32 v17, v25, 4, v24
    s_lshl_b32 s90, s77, 3
    s_lshl_b32 s90, s90, s81
    s_sub_u32 s90, s90, 1024
    v_add_u32 v17, s90, v17
    s_mov_b32 s46, s76
    s_mov_b32 s52, s80
    s_lshl_b32 s90, s78, 2
    s_mul_i32 s91, s90, 1
    s_add_u32 s53, s91, s80
    s_sub_u32 s53, s53, 2048
    s_mul_i32 s91, s90, 2
    s_add_u32 s54, s91, s80
    s_mul_i32 s91, s90, 3
    s_add_u32 s55, s91, s80
    s_sub_u32 s55, s55, 2048
    s_lshl_b32 s56, s78, 6
    v_lshrrev_b32 v24, 5, v1
    s_lshl_b32 s90, s16, 4
    v_add_u32 v25, s90, v24
    v_mul_lo_u32 v25, v25, s78
    v_lshlrev_b32 v24, 1, v24
    v_and_b32 v26, 31, v1
    v_xor_b32 v24, v24, v26
    s_lshl_b32 s90, s78, 1
    s_sub_u32 s90, s90, 1024
    v_add_u32 v27, s90, v25
    v_xor_b32 v26, 0, v24
    v_lshl_add_u32 v18, v26, 4, v25
    v_xor_b32 v26, 4, v24
    v_lshl_add_u32 v19, v26, 4, v27
    v_xor_b32 v26, 8, v24
    v_lshl_add_u32 v20, v26, 4, v25
    v_xor_b32 v26, 12, v24
    v_lshl_add_u32 v21, v26, 4, v27
    s_cmp_eq_u32 s83, 0
    s_waitcnt lgkmcnt(0)
    s_cselect_b32 s44, s36, s38
    s_cselect_b32 s45, s37, s39
    s_cmp_lt_u32 s68, 16
    s_cselect_b32 s44, s34, s44
    s_cselect_b32 s45, s35, s45
    s_cselect_b32 s40, s30, s32
    s_cselect_b32 s41, s31, s33
    s_cmp_ge_u32 s68, 28
    s_cselect_b32 s70, 1, 0
    s_cbranch_scc1 m_pf7
m_nopf6:
    s_add_u32 m0, s61, 0
    s_nop 0
    buffer_load_dwordx4 v16, s[40:43], s48 offen offset:0 sc1 lds
    buffer_load_dwordx4 v17, s[40:43], s48 offen offset:1024 sc1 lds
    s_add_u32 s48, s48, 128
    buffer_load_dwordx4 v16, s[40:43], s49 offen offset:2048 sc1 lds
    buffer_load_dwordx4 v17, s[40:43], s49 offen offset:3072 sc1 lds
    s_add_u32 s49, s49, 128
    s_add_u32 m0, s61, 4096
    s_nop 0
    buffer_load_dwordx4 v16, s[40:43], s50 offen offset:0 sc1 lds
    buffer_load_dwordx4 v17, s[40:43], s50 offen offset:1024 sc1 lds
    s_add_u32 s50, s50, 128
    buffer_load_dwordx4 v16, s[40:43], s51 offen offset:2048 sc1 lds
    buffer_load_dwordx4 v17, s[40:43], s51 offen offset:3072 sc1 lds
    s_add_u32 s51, s51, 128
    s_add_u32 s61, s61, 32768
    s_cmp_ge_u32 s61, 98304
    s_cselect_b32 s90, 98304, 0
    s_sub_u32 s61, s61, s90
    s_add_u32 m0, s62, 0
    s_nop 0
    buffer_load_dwordx4 v18, s[44:47], s52 offen offset:0 sc1 lds
    buffer_load_dwordx4 v19, s[44:47], s52 offen offset:1024 sc1 lds
    s_add_u32 s52, s52, s56
    buffer_load_dwordx4 v18, s[44:47], s53 offen offset:2048 sc1 lds
    buffer_load_dwordx4 v19, s[44:47], s53 offen offset:3072 sc1 lds
    s_add_u32 s53, s53, s56
    s_add_u32 m0, s62, 4096
    s_nop 0
    buffer_load_dwordx4 v20, s[44:47], s54 offen offset:0 sc1 lds
    buffer_load_dwordx4 v21, s[44:47], s54 offen offset:1024 sc1 lds
    s_add_u32 s54, s54, s56
    buffer_load_dwordx4 v20, s[44:47], s55 offen offset:2048 sc1 lds
    buffer_load_dwordx4 v21, s[44:47], s55 offen offset:3072 sc1 lds
    s_add_u32 s55, s55, s56
    s_xor_b32 s62, s62, 229376
    s_mov_b32 s95, s82
    s_mov_b32 s96, s83
    s_mov_b32 s97, s84
    s_mov_b32 s98, s85
    s_mov_b32 s99, s86
    s_mov_b32 s100, s87
    s_mov_b32 s101, s88
    v_and_b32 v24, 15, v1
    v_lshrrev_b32 v25, 4, v1
    v_bfe_u32 v26, v1, 1, 3
    v_xor_b32 v26, v26, v25
    s_lshl_b32 s90, s57, 14
    v_lshlrev_b32 v27, 7, v24
    v_add_u32 v27, s90, v27
    v_xor_b32 v28, 0, v26
    v_lshl_add_u32 v6, v28, 4, v27
    v_xor_b32 v28, 4, v26
    v_lshl_add_u32 v7, v28, 4, v27
    v_bfe_u32 v26, v1, 2, 2
    v_lshl_add_u32 v27, v25, 3, v26
    v_lshlrev_b32 v27, 9, v27
    v_and_b32 v28, 3, v1
    v_lshlrev_b32 v28, 3, v28
    v_add_u32 v27, v27, v28
    s_lshl_b32 s90, s58, 8
    s_add_u32 s90, s90, 98304
    v_add_u32 v27, s90, v27
    v_bfe_u32 v26, v1, 2, 3
    v_xor_b32 v28, 0, v26
    v_lshl_add_u32 v8, v28, 5, v27
    v_xor_b32 v28, 1, v26
    v_lshl_add_u32 v9, v28, 5, v27
    v_xor_b32 v28, 2, v26
    v_lshl_add_u32 v10, v28, 5, v27
    v_xor_b32 v28, 3, v26
    v_lshl_add_u32 v11, v28, 5, v27
    v_xor_b32 v28, 4, v26
    v_lshl_add_u32 v12, v28, 5, v27
    v_xor_b32 v28, 5, v26
    v_lshl_add_u32 v13, v28, 5, v27
    v_xor_b32 v28, 6, v26
    v_lshl_add_u32 v14, v28, 5, v27
    v_xor_b32 v28, 7, v26
    v_lshl_add_u32 v15, v28, 5, v27
    v_lshlrev_b32 v2, 4, v1
    s_mov_b32 s64, 0
    s_mov_b32 s59, 32768
    s_mov_b32 s60, 229376
    s_mov_b32 s8, s6
    s_mov_b32 s9, s7
    s_mov_b32 s10, 268435456
    s_mov_b32 s11, 0x20000
    s_cmp_ge_u32 s68, 16
    s_cbranch_scc1 m_typea8
    s_bfe_u32 s69, s68, 0x20002
    s_add_u32 s69, s69, 4
    s_and_b32 s90, s2, 7
    s_lshl_b32 s90, s90, 2
    s_and_b32 s91, s68, 3
    s_add_u32 s90, s90, s91
    s_cmp_lt_u32 s90, 16
    s_cselect_b32 s83, 0, 1
    s_mov_b32 s91, 33554432
    s_cselect_b32 s85, 16777216, s91
    s_mov_b32 s91, 8192
    s_cselect_b32 s86, 1024, s91
    s_mov_b32 s91, 1024
    s_cselect_b32 s87, 4096, s91
    s_cselect_b32 s74, s36, s38
    s_cselect_b32 s75, s37, s39
    s_mov_b32 s71, s32
    s_mov_b32 s72, s33
    s_mov_b32 s73, 2097152
    s_mov_b32 s77, 1024
    s_mov_b32 s82, 8
    s_mov_b32 s81, 0
    s_mov_b32 s76, 4194304
    s_mov_b32 s78, 8192
    s_mov_b32 s84, 0
    s_and_b32 s90, s90, 15
    s_lshl_b32 s80, s90, 9
    s_lshl_b32 s79, s69, 18
    s_lshl_b32 s91, s83, 2
    s_add_u32 s91, s91, s69
    s_cmp_ge_u32 s69, 4
    s_cselect_b32 s92, 508, 8
    s_add_u32 s91, s91, s92
    s_lshl_b32 s88, s90, 4
    s_add_u32 s88, s88, s91
    s_lshl_b32 s88, s88, 3
    s_lshl_b32 s91, s90, 1
    s_add_u32 s91, s91, s58
    s_lshl_b32 s91, s91, 19
    s_lshl_b32 s92, s69, 1
    s_add_u32 s92, s92, s57
    s_lshl_b32 s92, s92, 15
    s_add_u32 s85, s85, s91
    s_add_u32 s85, s85, s92
    s_branch m_go29
m_typea8:
    s_and_b32 s69, s68, 3
    s_and_b32 s90, s2, 1
    s_lshl_b32 s90, s90, 2
    s_add_u32 s69, s69, s90
    s_bfe_u32 s90, s2, 0x20001
    s_mul_i32 s90, s90, 3
    s_bfe_u32 s91, s68, 0x20002
    s_add_u32 s90, s90, s91
    s_mov_b32 s76, 6291456
    s_mov_b32 s78, 6144
    s_mov_b32 s81, 1
    s_mov_b32 s73, 4194304
    s_mov_b32 s77, 2048
    s_mov_b32 s82, 16
    s_lshl_b32 s80, s90, 9
    s_lshl_b32 s79, s69, 19
    s_and_b32 s92, s90, 3
    s_lshr_b32 s91, s90, 2
    s_lshl_b32 s88, s92, 2
    s_add_u32 s88, s88, s91
    s_lshl_b32 s88, s88, 3
    s_add_u32 s88, s88, s69
    s_lshl_b32 s88, s88, 3
    s_add_u32 s88, s88, 6144
    s_cmp_eq_u32 s91, 0
    s_cselect_b32 s84, 1048744942, 0
    s_lshl_b32 s93, s91, 22
    s_add_u32 s85, s93, 50331648
    s_lshl_b32 s92, s92, 1
    s_add_u32 s92, s92, s58
    s_lshl_b32 s92, s92, 19
    s_add_u32 s85, s85, s92
    s_lshl_b32 s92, s57, 3
    s_add_u32 s92, s92, s69
    s_cmp_eq_u32 s91, 2
    s_cselect_b32 s83, 1, 0
    s_cselect_b32 s93, 12, 13
    s_mov_b32 s91, 131072
    s_cselect_b32 s86, 1024, s91
    s_mov_b32 s91, 1024
    s_cselect_b32 s87, 65536, s91
    s_lshl_b32 s92, s92, s93
    s_add_u32 s85, s85, s92
    s_mov_b32 s71, s24
    s_mov_b32 s72, s25
    s_mov_b32 s74, s26
    s_mov_b32 s75, s27
m_go29:
    s_xor_b32 s94, s70, 1
    s_add_u32 s67, s70, 3
    s_mov_b32 s17, -1
    s_mul_i32 s64, s70, 32768
    v_add_u32 v6, s64, v6
    v_add_u32 v7, s64, v7
    s_mov_b32 s12, s4
    s_mov_b32 s13, s5
    s_mov_b32 s14, 256
    s_mov_b32 s15, 0x20000
    s_lshl_b32 s90, s2, 2
    s_add_u32 s90, s90, s16
    s_cmp_lg_u32 s90, 0
    s_cbranch_scc1 m_tok10
    s_memrealtime s[92:93]
    s_waitcnt lgkmcnt(0)
    s_or_b32 s92, s92, 1
    v_mov_b32 v4, s92
    v_mov_b32 v5, s93
    s_mov_b64 exec, 1
    buffer_store_dwordx2 v[4:5], off, s[12:15], 0 sc1
    s_mov_b64 exec, -1
m_tok10:
    s_cmp_eq_u32 s70, 0
    s_cbranch_scc1 m_tok11
    buffer_load_dwordx2 v[4:5], off, s[12:15], 0 sc1
    s_waitcnt vmcnt(0)
    s_mov_b32 s3, 1048576
m_spin12:
    v_readfirstlane_b32 s4, v4
    v_readfirstlane_b32 s5, v5
    s_nop 3
    s_cmp_lg_u32 s4, 0
    s_cbranch_scc1 m_ok13
    s_sub_u32 s3, s3, 1
    s_cbranch_scc1 m_ok13
    s_sleep 32
    buffer_load_dwordx2 v[4:5], off, s[12:15], 0 sc1
    s_waitcnt vmcnt(0)
    s_branch m_spin12
m_ok13:
m_tok11:
    s_add_u32 m0, s61, 0
    s_nop 0
    buffer_load_dwordx4 v16, s[40:43], s48 offen offset:0 sc1 lds
    buffer_load_dwordx4 v17, s[40:43], s48 offen offset:1024 sc1 lds
    s_add_u32 s48, s48, 128
    buffer_load_dwordx4 v16, s[40:43], s49 offen offset:2048 sc1 lds
    buffer_load_dwordx4 v17, s[40:43], s49 offen offset:3072 sc1 lds
    s_add_u32 s49, s49, 128
    s_add_u32 m0, s61, 4096
    s_nop 0
    buffer_load_dwordx4 v16, s[40:43], s50 offen offset:0 sc1 lds
    buffer_load_dwordx4 v17, s[40:43], s50 offen offset:1024 sc1 lds
    s_add_u32 s50, s50, 128
    buffer_load_dwordx4 v16, s[40:43], s51 offen offset:2048 sc1 lds
    buffer_load_dwordx4 v17, s[40:43], s51 offen offset:3072 sc1 lds
    s_add_u32 s51, s51, 128
    s_add_u32 s61, s61, 32768
    s_cmp_ge_u32 s61, 98304
    s_cselect_b32 s90, 98304, 0
    s_sub_u32 s61, s61, s90
    s_add_u32 m0, s62, 0
    s_nop 0
    buffer_load_dwordx4 v18, s[44:47], s52 offen offset:0 sc1 lds
    buffer_load_dwordx4 v19, s[44:47], s52 offen offset:1024 sc1 lds
    s_add_u32 s52, s52, s56
    buffer_load_dwordx4 v18, s[44:47], s53 offen offset:2048 sc1 lds
    buffer_load_dwordx4 v19, s[44:47], s53 offen offset:3072 sc1 lds
    s_add_u32 s53, s53, s56
    s_add_u32 m0, s62, 4096
    s_nop 0
    buffer_load_dwordx4 v20, s[44:47], s54 offen offset:0 sc1 lds
    buffer_load_dwordx4 v21, s[44:47], s54 offen offset:1024 sc1 lds
    s_add_u32 s54, s54, s56
    buffer_load_dwordx4 v20, s[44:47], s55 offen offset:2048 sc1 lds
    buffer_load_dwordx4 v21, s[44:47], s55 offen offset:3072 sc1 lds
    s_add_u32 s55, s55, s56
    s_xor_b32 s62, s62, 229376
    s_waitcnt vmcnt(16)
    s_barrier
    ds_read_b64_tr_b16 a[64:65], v8 offset:0
    ds_read_b64_tr_b16 a[66:67], v8 offset:2048
    ds_read_b64_tr_b16 a[68:69], v8 offset:16384
    ds_read_b64_tr_b16 a[70:71], v8 offset:18432
    ds_read_b64_tr_b16 a[72:73], v9 offset:0
    ds_read_b64_tr_b16 a[74:75], v9 offset:2048
    ds_read_b64_tr_b16 a[76:77], v9 offset:16384
    ds_read_b64_tr_b16 a[78:79], v9 offset:18432
    ds_read_b64_tr_b16 a[80:81], v10 offset:0
    ds_read_b64_tr_b16 a[82:83], v10 offset:2048
    ds_read_b64_tr_b16 a[84:85], v10 offset:16384
    ds_read_b64_tr_b16 a[86:87], v10 offset:18432
    ds_read_b64_tr_b16 a[88:89], v11 offset:0
    ds_read_b64_tr_b16 a[90:91], v11 offset:2048
    ds_read_b64_tr_b16 a[92:93], v11 offset:16384
    ds_read_b64_tr_b16 a[94:95], v11 offset:18432
    ds_read_b64_tr_b16 a[96:97], v12 offset:0
    ds_read_b128 a[0:3], v6 offset:0
    ds_read_b128 a[4:7], v7 offset:0
    ds_read_b64_tr_b16 a[98:99], v12 offset:2048
    ds_read_b128 a[8:11], v6 offset:2048
    ds_read_b128 a[12:15], v7 offset:2048
    ds_read_b64_tr_b16 a[100:101], v12 offset:16384
    ds_read_b128 a[16:19], v6 offset:4096
    ds_read_b128 a[20:23], v7 offset:4096
    ds_read_b64_tr_b16 a[102:103], v12 offset:18432
    ds_read_b128 a[24:27], v6 offset:6144
    ds_read_b128 a[28:31], v7 offset:6144
    ds_read_b64_tr_b16 a[104:105], v13 offset:0
    ds_read_b128 a[32:35], v6 offset:8192
    ds_read_b128 a[36:39], v7 offset:8192
    ds_read_b64_tr_b16 a[106:107], v13 offset:2048
    ds_read_b128 a[40:43], v6 offset:10240
    ds_read_b128 a[44:47], v7 offset:10240
    ds_read_b64_tr_b16 a[108:109], v13 offset:16384
    ds_read_b128 a[48:51], v6 offset:12288
    ds_read_b128 a[52:55], v7 offset:12288
    ds_read_b64_tr_b16 a[110:111], v13 offset:18432
    ds_read_b128 a[56:59], v6 offset:14336
    ds_read_b128 a[60:63], v7 offset:14336
    s_add_u32 m0, s61, 0
    s_nop 0
    buffer_load_dwordx4 v16, s[40:43], s48 offen offset:0 sc1 lds
    buffer_load_dwordx4 v17, s[40:43], s48 offen offset:1024 sc1 lds
    s_add_u32 s48, s48, 128
    buffer_load_dwordx4 v16, s[40:43], s49 offen offset:2048 sc1 lds
    buffer_load_dwordx4 v17, s[40:43], s49 offen offset:3072 sc1 lds
    s_add_u32 s49, s49, 128
    s_add_u32 m0, s61, 4096
    s_nop 0
    buffer_load_dwordx4 v16, s[40:43], s50 offen offset:0 sc1 lds
    buffer_load_dwordx4 v17, s[40:43], s50 offen offset:1024 sc1 lds
    s_add_u32 s50, s50, 128
    buffer_load_dwordx4 v16, s[40:43], s51 offen offset:2048 sc1 lds
    buffer_load_dwordx4 v17, s[40:43], s51 offen offset:3072 sc1 lds
    s_add_u32 s51, s51, 128
    s_add_u32 s61, s61, 32768
    s_cmp_ge_u32 s61, 98304
    s_cselect_b32 s90, 98304, 0
    s_sub_u32 s61, s61, s90
    s_mov_b32 s66, 1
    s_mov_b32 s24, s6
    s_mov_b32 s25, s7
    s_mov_b32 s26, 0
    s_mov_b32 s27, 0x20000
    s_mov_b32 s28, 0
    s_mov_b32 s29, 0
    s_mov_b32 s30, 0
    s_mov_b32 s31, 0
m_tile14:
    s_mov_b32 s65, s95
    s_cmp_eq_u32 s96, 1
    s_cbranch_scc1 m_swp16
    s_waitcnt lgkmcnt(15)
    v_mfma_f32_16x16x32_bf16 v[32:35], a[64:67], a[0:3], 0
    ds_read_b64_tr_b16 a[112:113], v14 offset:0
    v_mfma_f32_16x16x32_bf16 v[32:35], a[68:71], a[4:7], v[32:35]
    ds_read_b64_tr_b16 a[114:115], v14 offset:2048
    v_mfma_f32_16x16x32_bf16 v[36:39], a[76:79], a[4:7], 0
    ds_read_b64_tr_b16 a[116:117], v14 offset:16384
    v_mfma_f32_16x16x32_bf16 v[36:39], a[72:75], a[0:3], v[36:39]
    ds_read_b64_tr_b16 a[118:119], v14 offset:18432
    v_mfma_f32_16x16x32_bf16 v[44:47], a[72:75], a[8:11], 0
    ds_read_b64_tr_b16 a[120:121], v15 offset:0
    v_mfma_f32_16x16x32_bf16 v[44:47], a[76:79], a[12:15], v[44:47]
    ds_read_b64_tr_b16 a[122:123], v15 offset:2048
    v_mfma_f32_16x16x32_bf16 v[40:43], a[68:71], a[12:15], 0
    ds_read_b64_tr_b16 a[124:125], v15 offset:16384
    v_mfma_f32_16x16x32_bf16 v[40:43], a[64:67], a[8:11], v[40:43]
    ds_read_b64_tr_b16 a[126:127], v15 offset:18432
    v_mfma_f32_16x16x32_bf16 v[48:51], a[64:67], a[16:19], 0
    v_mfma_f32_16x16x32_bf16 v[48:51], a[68:71], a[20:23], v[48:51]
    v_mfma_f32_16x16x32_bf16 v[52:55], a[76:79], a[20:23], 0
    buffer_store_dwordx4 a[128:131], v2, s[24:27], s28 offen sc1
    v_mfma_f32_16x16x32_bf16 v[52:55], a[72:75], a[16:19], v[52:55]
    s_add_u32 s28, s28, s31
    s_waitcnt lgkmcnt(15)
    v_mfma_f32_16x16x32_bf16 v[60:63], a[72:75], a[24:27], 0
    v_xor_b32 v8, s60, v8
    v_xor_b32 v9, s60, v9
    v_mfma_f32_16x16x32_bf16 v[60:63], a[76:79], a[28:31], v[60:63]
    v_xor_b32 v10, s60, v10
    v_xor_b32 v11, s60, v11
    v_mfma_f32_16x16x32_bf16 v[56:59], a[68:71], a[28:31], 0
    v_xor_b32 v12, s60, v12
    v_xor_b32 v13, s60, v13
    v_mfma_f32_16x16x32_bf16 v[56:59], a[64:67], a[24:27], v[56:59]
    v_xor_b32 v14, s60, v14
    v_xor_b32 v15, s60, v15
    v_mfma_f32_16x16x32_bf16 v[64:67], a[64:67], a[32:35], 0
    buffer_store_dwordx4 a[132:135], v2, s[24:27], s28 offen sc1
    v_mfma_f32_16x16x32_bf16 v[64:67], a[68:71], a[36:39], v[64:67]
    s_add_u32 s28, s28, s31
    v_mfma_f32_16x16x32_bf16 v[68:71], a[76:79], a[36:39], 0
    v_mfma_f32_16x16x32_bf16 v[68:71], a[72:75], a[32:35], v[68:71]
    s_waitcnt lgkmcnt(14)
    v_mfma_f32_16x16x32_bf16 v[76:79], a[72:75], a[40:43], 0
    v_mfma_f32_16x16x32_bf16 v[76:79], a[76:79], a[44:47], v[76:79]
    v_mfma_f32_16x16x32_bf16 v[72:75], a[68:71], a[44:47], 0
    buffer_store_dwordx4 a[136:139], v2, s[24:27], s28 offen sc1
    v_mfma_f32_16x16x32_bf16 v[72:75], a[64:67], a[40:43], v[72:75]
    s_add_u32 s28, s28, s31
    s_waitcnt lgkmcnt(11)
    v_mfma_f32_16x16x32_bf16 v[80:83], a[64:67], a[48:51], 0
    v_mfma_f32_16x16x32_bf16 v[80:83], a[68:71], a[52:55], v[80:83]
    v_mfma_f32_16x16x32_bf16 v[84:87], a[76:79], a[52:55], 0
    v_mfma_f32_16x16x32_bf16 v[84:87], a[72:75], a[48:51], v[84:87]
    s_waitcnt lgkmcnt(8)
    v_mfma_f32_16x16x32_bf16 v[92:95], a[72:75], a[56:59], 0
    buffer_store_dwordx4 a[140:143], v2, s[24:27], s28 offen sc1
    v_mfma_f32_16x16x32_bf16 v[92:95], a[76:79], a[60:63], v[92:95]
    s_add_u32 s28, s28, s31
    v_mfma_f32_16x16x32_bf16 v[88:91], a[68:71], a[60:63], 0
    s_waitcnt vmcnt(12) lgkmcnt(0)
    v_mfma_f32_16x16x32_bf16 v[88:91], a[64:67], a[56:59], v[88:91]
    s_barrier
    v_mfma_f32_16x16x32_bf16 v[96:99], a[80:83], a[0:3], 0
    ds_read_b64_tr_b16 a[64:65], v8 offset:0
    v_mfma_f32_16x16x32_bf16 v[96:99], a[84:87], a[4:7], v[96:99]
    s_add_u32 m0, s62, 0
    v_mfma_f32_16x16x32_bf16 v[100:103], a[92:95], a[4:7], 0
    buffer_load_dwordx4 v18, s[44:47], s52 offen offset:0 sc1 lds
    v_mfma_f32_16x16x32_bf16 v[100:103], a[88:91], a[0:3], v[100:103]
    ds_read_b64_tr_b16 a[66:67], v8 offset:2048
    v_mfma_f32_16x16x32_bf16 v[108:111], a[88:91], a[8:11], 0
    s_add_u32 s64, s64, 32768
    v_mfma_f32_16x16x32_bf16 v[108:111], a[92:95], a[12:15], v[108:111]
    s_cmp_ge_u32 s64, 98304
    s_cselect_b32 s63, 4294901760, s59
    s_cselect_b32 s64, 0, s64
    v_mfma_f32_16x16x32_bf16 v[104:107], a[84:87], a[12:15], 0
    buffer_load_dwordx4 v19, s[44:47], s52 offen offset:1024 sc1 lds
    v_mfma_f32_16x16x32_bf16 v[104:107], a[80:83], a[8:11], v[104:107]
    s_add_u32 s52, s52, s56
    ds_read_b64_tr_b16 a[68:69], v8 offset:16384
    v_mfma_f32_16x16x32_bf16 v[112:115], a[80:83], a[16:19], 0
    v_mfma_f32_16x16x32_bf16 v[112:115], a[84:87], a[20:23], v[112:115]
    v_mfma_f32_16x16x32_bf16 v[116:119], a[92:95], a[20:23], 0
    buffer_load_dwordx4 v18, s[44:47], s53 offen offset:2048 sc1 lds
    v_mfma_f32_16x16x32_bf16 v[116:119], a[88:91], a[16:19], v[116:119]
    ds_read_b64_tr_b16 a[70:71], v8 offset:18432
    v_mfma_f32_16x16x32_bf16 v[124:127], a[88:91], a[24:27], 0
    v_mfma_f32_16x16x32_bf16 v[124:127], a[92:95], a[28:31], v[124:127]
    v_mfma_f32_16x16x32_bf16 v[120:123], a[84:87], a[28:31], 0
    buffer_load_dwordx4 v19, s[44:47], s53 offen offset:3072 sc1 lds
    v_mfma_f32_16x16x32_bf16 v[120:123], a[80:83], a[24:27], v[120:123]
    s_add_u32 s53, s53, s56
    ds_read_b64_tr_b16 a[72:73], v9 offset:0
    v_mfma_f32_16x16x32_bf16 v[128:131], a[80:83], a[32:35], 0
    v_mfma_f32_16x16x32_bf16 v[128:131], a[84:87], a[36:39], v[128:131]
    s_add_u32 m0, s62, 4096
    v_mfma_f32_16x16x32_bf16 v[132:135], a[92:95], a[36:39], 0
    buffer_load_dwordx4 v20, s[44:47], s54 offen offset:0 sc1 lds
    v_mfma_f32_16x16x32_bf16 v[132:135], a[88:91], a[32:35], v[132:135]
    s_xor_b32 s62, s62, 229376
    ds_read_b64_tr_b16 a[74:75], v9 offset:2048
    v_mfma_f32_16x16x32_bf16 v[140:143], a[88:91], a[40:43], 0
    v_mfma_f32_16x16x32_bf16 v[140:143], a[92:95], a[44:47], v[140:143]
    v_mfma_f32_16x16x32_bf16 v[136:139], a[84:87], a[44:47], 0
    buffer_load_dwordx4 v21, s[44:47], s54 offen offset:1024 sc1 lds
    v_mfma_f32_16x16x32_bf16 v[136:139], a[80:83], a[40:43], v[136:139]
    s_add_u32 s54, s54, s56
    ds_read_b64_tr_b16 a[76:77], v9 offset:16384
    v_mfma_f32_16x16x32_bf16 v[144:147], a[80:83], a[48:51], 0
    v_mfma_f32_16x16x32_bf16 v[144:147], a[84:87], a[52:55], v[144:147]
    v_mfma_f32_16x16x32_bf16 v[148:151], a[92:95], a[52:55], 0
    buffer_load_dwordx4 v20, s[44:47], s55 offen offset:2048 sc1 lds
    v_mfma_f32_16x16x32_bf16 v[148:151], a[88:91], a[48:51], v[148:151]
    ds_read_b64_tr_b16 a[78:79], v9 offset:18432
    v_mfma_f32_16x16x32_bf16 v[156:159], a[88:91], a[56:59], 0
    v_add_u32 v6, s63, v6
    v_add_u32 v7, s63, v7
    v_mfma_f32_16x16x32_bf16 v[156:159], a[92:95], a[60:63], v[156:159]
    v_mfma_f32_16x16x32_bf16 v[152:155], a[84:87], a[60:63], 0
    buffer_load_dwordx4 v21, s[44:47], s55 offen offset:3072 sc1 lds
    v_mfma_f32_16x16x32_bf16 v[152:155], a[80:83], a[56:59], v[152:155]
    s_add_u32 s55, s55, s56
    v_mfma_f32_16x16x32_bf16 v[160:163], a[96:99], a[0:3], 0
    ds_read_b64_tr_b16 a[80:81], v10 offset:0
    v_mfma_f32_16x16x32_bf16 v[160:163], a[100:103], a[4:7], v[160:163]
    v_mfma_f32_16x16x32_bf16 v[164:167], a[108:111], a[4:7], 0
    v_mfma_f32_16x16x32_bf16 v[164:167], a[104:107], a[0:3], v[164:167]
    s_add_u32 m0, s61, 0
    ds_read_b64_tr_b16 a[82:83], v10 offset:2048
    v_mfma_f32_16x16x32_bf16 v[172:175], a[104:107], a[8:11], 0
    buffer_load_dwordx4 v16, s[40:43], s48 offen offset:0 sc1 lds
    v_mfma_f32_16x16x32_bf16 v[172:175], a[108:111], a[12:15], v[172:175]
    v_mfma_f32_16x16x32_bf16 v[168:171], a[100:103], a[12:15], 0
    ds_read_b64_tr_b16 a[84:85], v10 offset:16384
    v_mfma_f32_16x16x32_bf16 v[168:171], a[96:99], a[8:11], v[168:171]
    v_mfma_f32_16x16x32_bf16 v[176:179], a[96:99], a[16:19], 0
    buffer_store_dwordx4 a[144:147], v2, s[24:27], s28 offen sc1
    v_mfma_f32_16x16x32_bf16 v[176:179], a[100:103], a[20:23], v[176:179]
    s_add_u32 s28, s28, s31
    ds_read_b64_tr_b16 a[86:87], v10 offset:18432
    v_mfma_f32_16x16x32_bf16 v[180:183], a[108:111], a[20:23], 0
    v_mfma_f32_16x16x32_bf16 v[180:183], a[104:107], a[16:19], v[180:183]
    v_mfma_f32_16x16x32_bf16 v[188:191], a[104:107], a[24:27], 0
    buffer_load_dwordx4 v17, s[40:43], s48 offen offset:1024 sc1 lds
    v_mfma_f32_16x16x32_bf16 v[188:191], a[108:111], a[28:31], v[188:191]
    s_add_u32 s48, s48, 128
    ds_read_b64_tr_b16 a[88:89], v11 offset:0
    v_mfma_f32_16x16x32_bf16 v[184:187], a[100:103], a[28:31], 0
    v_mfma_f32_16x16x32_bf16 v[184:187], a[96:99], a[24:27], v[184:187]
    v_mfma_f32_16x16x32_bf16 v[192:195], a[96:99], a[32:35], 0
    buffer_store_dwordx4 a[148:151], v2, s[24:27], s28 offen sc1
    v_mfma_f32_16x16x32_bf16 v[192:195], a[100:103], a[36:39], v[192:195]
    s_add_u32 s28, s28, s31
    ds_read_b64_tr_b16 a[90:91], v11 offset:2048
    v_mfma_f32_16x16x32_bf16 v[196:199], a[108:111], a[36:39], 0
    v_mfma_f32_16x16x32_bf16 v[196:199], a[104:107], a[32:35], v[196:199]
    v_mfma_f32_16x16x32_bf16 v[204:207], a[104:107], a[40:43], 0
    buffer_load_dwordx4 v16, s[40:43], s49 offen offset:2048 sc1 lds
    v_mfma_f32_16x16x32_bf16 v[204:207], a[108:111], a[44:47], v[204:207]
    ds_read_b64_tr_b16 a[92:93], v11 offset:16384
    v_mfma_f32_16x16x32_bf16 v[200:203], a[100:103], a[44:47], 0
    v_mfma_f32_16x16x32_bf16 v[200:203], a[96:99], a[40:43], v[200:203]
    v_mfma_f32_16x16x32_bf16 v[208:211], a[96:99], a[48:51], 0
    buffer_store_dwordx4 a[152:155], v2, s[24:27], s28 offen sc1
    v_mfma_f32_16x16x32_bf16 v[208:211], a[100:103], a[52:55], v[208:211]
    s_add_u32 s28, s28, s31
    ds_read_b64_tr_b16 a[94:95], v11 offset:18432
    v_mfma_f32_16x16x32_bf16 v[212:215], a[108:111], a[52:55], 0
    v_mfma_f32_16x16x32_bf16 v[212:215], a[104:107], a[48:51], v[212:215]
    v_mfma_f32_16x16x32_bf16 v[220:223], a[104:107], a[56:59], 0
    buffer_load_dwordx4 v17, s[40:43], s49 offen offset:3072 sc1 lds
    v_mfma_f32_16x16x32_bf16 v[220:223], a[108:111], a[60:63], v[220:223]
    s_add_u32 s49, s49, 128
    v_mfma_f32_16x16x32_bf16 v[216:219], a[100:103], a[60:63], 0
    buffer_store_dwordx4 a[156:159], v2, s[24:27], s28 offen sc1
    v_mfma_f32_16x16x32_bf16 v[216:219], a[96:99], a[56:59], v[216:219]
    s_add_u32 s29, s29, s30
    s_mov_b32 s28, s29
    v_mfma_f32_16x16x32_bf16 v[224:227], a[112:115], a[0:3], 0
    v_mfma_f32_16x16x32_bf16 v[224:227], a[116:119], a[4:7], v[224:227]
    ds_read_b64_tr_b16 a[96:97], v12 offset:0
    v_mfma_f32_16x16x32_bf16 v[228:231], a[124:127], a[4:7], 0
    v_mfma_f32_16x16x32_bf16 v[228:231], a[120:123], a[0:3], v[228:231]
    s_add_u32 m0, s61, 4096
    ds_read_b128 a[0:3], v6 offset:0
    v_mfma_f32_16x16x32_bf16 v[236:239], a[120:123], a[8:11], 0
    buffer_load_dwordx4 v16, s[40:43], s50 offen offset:0 sc1 lds
    v_mfma_f32_16x16x32_bf16 v[236:239], a[124:127], a[12:15], v[236:239]
    s_add_u32 s61, s61, 32768
    ds_read_b128 a[4:7], v7 offset:0
    v_mfma_f32_16x16x32_bf16 v[232:235], a[116:119], a[12:15], 0
    s_cmp_ge_u32 s61, 98304
    s_cselect_b32 s90, 98304, 0
    ds_read_b64_tr_b16 a[98:99], v12 offset:2048
    v_mfma_f32_16x16x32_bf16 v[232:235], a[112:115], a[8:11], v[232:235]
    s_sub_u32 s61, s61, s90
    ds_read_b128 a[8:11], v6 offset:2048
    v_mfma_f32_16x16x32_bf16 v[240:243], a[112:115], a[16:19], 0
    ds_read_b128 a[12:15], v7 offset:2048
    v_mfma_f32_16x16x32_bf16 v[240:243], a[116:119], a[20:23], v[240:243]
    ds_read_b64_tr_b16 a[100:101], v12 offset:16384
    v_mfma_f32_16x16x32_bf16 v[244:247], a[124:127], a[20:23], 0
    v_mfma_f32_16x16x32_bf16 v[244:247], a[120:123], a[16:19], v[244:247]
    ds_read_b128 a[16:19], v6 offset:4096
    v_mfma_f32_16x16x32_bf16 v[252:255], a[120:123], a[24:27], 0
    buffer_load_dwordx4 v17, s[40:43], s50 offen offset:1024 sc1 lds
    v_mfma_f32_16x16x32_bf16 v[252:255], a[124:127], a[28:31], v[252:255]
    s_add_u32 s50, s50, 128
    ds_read_b128 a[20:23], v7 offset:4096
    v_mfma_f32_16x16x32_bf16 v[248:251], a[116:119], a[28:31], 0
    ds_read_b64_tr_b16 a[102:103], v12 offset:18432
    v_mfma_f32_16x16x32_bf16 v[248:251], a[112:115], a[24:27], v[248:251]
    ds_read_b128 a[24:27], v6 offset:6144
    v_mfma_f32_16x16x32_bf16 a[224:227], a[112:115], a[32:35], 0
    s_sub_u32 s65, s65, 1
    ds_read_b128 a[28:31], v7 offset:6144
    v_mfma_f32_16x16x32_bf16 a[224:227], a[116:119], a[36:39], a[224:227]
    ds_read_b64_tr_b16 a[104:105], v13 offset:0
    v_mfma_f32_16x16x32_bf16 a[228:231], a[124:127], a[36:39], 0
    v_mfma_f32_16x16x32_bf16 a[228:231], a[120:123], a[32:35], a[228:231]
    ds_read_b128 a[32:35], v6 offset:8192
    v_mfma_f32_16x16x32_bf16 a[236:239], a[120:123], a[40:43], 0
    buffer_load_dwordx4 v16, s[40:43], s51 offen offset:2048 sc1 lds
    v_mfma_f32_16x16x32_bf16 a[236:239], a[124:127], a[44:47], a[236:239]
    ds_read_b128 a[36:39], v7 offset:8192
    v_mfma_f32_16x16x32_bf16 a[232:235], a[116:119], a[44:47], 0
    ds_read_b64_tr_b16 a[106:107], v13 offset:2048
    v_mfma_f32_16x16x32_bf16 a[232:235], a[112:115], a[40:43], a[232:235]
    ds_read_b128 a[40:43], v6 offset:10240
    v_mfma_f32_16x16x32_bf16 a[240:243], a[112:115], a[48:51], 0
    ds_read_b128 a[44:47], v7 offset:10240
    v_mfma_f32_16x16x32_bf16 a[240:243], a[116:119], a[52:55], a[240:243]
    ds_read_b64_tr_b16 a[108:109], v13 offset:16384
    v_mfma_f32_16x16x32_bf16 a[244:247], a[124:127], a[52:55], 0
    v_mfma_f32_16x16x32_bf16 a[244:247], a[120:123], a[48:51], a[244:247]
    ds_read_b128 a[48:51], v6 offset:12288
    v_mfma_f32_16x16x32_bf16 a[252:255], a[120:123], a[56:59], 0
    buffer_load_dwordx4 v17, s[40:43], s51 offen offset:3072 sc1 lds
    v_mfma_f32_16x16x32_bf16 a[252:255], a[124:127], a[60:63], a[252:255]
    s_add_u32 s51, s51, 128
    ds_read_b128 a[52:55], v7 offset:12288
    v_mfma_f32_16x16x32_bf16 a[248:251], a[116:119], a[60:63], 0
    ds_read_b64_tr_b16 a[110:111], v13 offset:18432
    v_mfma_f32_16x16x32_bf16 a[248:251], a[112:115], a[56:59], a[248:251]
    ds_read_b128 a[56:59], v6 offset:14336
    ds_read_b128 a[60:63], v7 offset:14336
    s_waitcnt lgkmcnt(15)
    v_mfma_f32_16x16x32_bf16 v[32:35], a[64:67], a[0:3], v[32:35]
    ds_read_b64_tr_b16 a[112:113], v14 offset:0
    v_mfma_f32_16x16x32_bf16 v[32:35], a[68:71], a[4:7], v[32:35]
    ds_read_b64_tr_b16 a[114:115], v14 offset:2048
    v_mfma_f32_16x16x32_bf16 v[36:39], a[76:79], a[4:7], v[36:39]
    ds_read_b64_tr_b16 a[116:117], v14 offset:16384
    v_mfma_f32_16x16x32_bf16 v[36:39], a[72:75], a[0:3], v[36:39]
    ds_read_b64_tr_b16 a[118:119], v14 offset:18432
    v_mfma_f32_16x16x32_bf16 v[44:47], a[72:75], a[8:11], v[44:47]
    ds_read_b64_tr_b16 a[120:121], v15 offset:0
    v_mfma_f32_16x16x32_bf16 v[44:47], a[76:79], a[12:15], v[44:47]
    ds_read_b64_tr_b16 a[122:123], v15 offset:2048
    v_mfma_f32_16x16x32_bf16 v[40:43], a[68:71], a[12:15], v[40:43]
    ds_read_b64_tr_b16 a[124:125], v15 offset:16384
    v_mfma_f32_16x16x32_bf16 v[40:43], a[64:67], a[8:11], v[40:43]
    ds_read_b64_tr_b16 a[126:127], v15 offset:18432
    v_mfma_f32_16x16x32_bf16 v[48:51], a[64:67], a[16:19], v[48:51]
    v_mfma_f32_16x16x32_bf16 v[48:51], a[68:71], a[20:23], v[48:51]
    v_mfma_f32_16x16x32_bf16 v[52:55], a[76:79], a[20:23], v[52:55]
    buffer_store_dwordx4 a[160:163], v2, s[24:27], s28 offen sc1
    v_mfma_f32_16x16x32_bf16 v[52:55], a[72:75], a[16:19], v[52:55]
    s_add_u32 s28, s28, s31
    s_waitcnt lgkmcnt(15)
    v_mfma_f32_16x16x32_bf16 v[60:63], a[72:75], a[24:27], v[60:63]
    v_xor_b32 v8, s60, v8
    v_xor_b32 v9, s60, v9
    v_mfma_f32_16x16x32_bf16 v[60:63], a[76:79], a[28:31], v[60:63]
    v_xor_b32 v10, s60, v10
    v_xor_b32 v11, s60, v11
    v_mfma_f32_16x16x32_bf16 v[56:59], a[68:71], a[28:31], v[56:59]
    v_xor_b32 v12, s60, v12
    v_xor_b32 v13, s60, v13
    v_mfma_f32_16x16x32_bf16 v[56:59], a[64:67], a[24:27], v[56:59]
    v_xor_b32 v14, s60, v14
    v_xor_b32 v15, s60, v15
    v_mfma_f32_16x16x32_bf16 v[64:67], a[64:67], a[32:35], v[64:67]
    buffer_store_dwordx4 a[164:167], v2, s[24:27], s28 offen sc1
    v_mfma_f32_16x16x32_bf16 v[64:67], a[68:71], a[36:39], v[64:67]
    s_add_u32 s28, s28, s31
    v_mfma_f32_16x16x32_bf16 v[68:71], a[76:79], a[36:39], v[68:71]
    v_mfma_f32_16x16x32_bf16 v[68:71], a[72:75], a[32:35], v[68:71]
    s_waitcnt lgkmcnt(14)
    v_mfma_f32_16x16x32_bf16 v[76:79], a[72:75], a[40:43], v[76:79]
    v_mfma_f32_16x16x32_bf16 v[76:79], a[76:79], a[44:47], v[76:79]
    v_mfma_f32_16x16x32_bf16 v[72:75], a[68:71], a[44:47], v[72:75]
    buffer_store_dwordx4 a[168:171], v2, s[24:27], s28 offen sc1
    v_mfma_f32_16x16x32_bf16 v[72:75], a[64:67], a[40:43], v[72:75]
    s_add_u32 s28, s28, s31
    s_waitcnt lgkmcnt(11)
    v_mfma_f32_16x16x32_bf16 v[80:83], a[64:67], a[48:51], v[80:83]
    v_mfma_f32_16x16x32_bf16 v[80:83], a[68:71], a[52:55], v[80:83]
    v_mfma_f32_16x16x32_bf16 v[84:87], a[76:79], a[52:55], v[84:87]
    v_mfma_f32_16x16x32_bf16 v[84:87], a[72:75], a[48:51], v[84:87]
    s_waitcnt lgkmcnt(8)
    v_mfma_f32_16x16x32_bf16 v[92:95], a[72:75], a[56:59], v[92:95]
    buffer_store_dwordx4 a[172:175], v2, s[24:27], s28 offen sc1
    v_mfma_f32_16x16x32_bf16 v[92:95], a[76:79], a[60:63], v[92:95]
    s_add_u32 s28, s28, s31
    v_mfma_f32_16x16x32_bf16 v[88:91], a[68:71], a[60:63], v[88:91]
    s_waitcnt vmcnt(16) lgkmcnt(0)
    v_mfma_f32_16x16x32_bf16 v[88:91], a[64:67], a[56:59], v[88:91]
    s_barrier
    v_mfma_f32_16x16x32_bf16 v[96:99], a[80:83], a[0:3], v[96:99]
    ds_read_b64_tr_b16 a[64:65], v8 offset:0
    v_mfma_f32_16x16x32_bf16 v[96:99], a[84:87], a[4:7], v[96:99]
    s_add_u32 m0, s62, 0
    v_mfma_f32_16x16x32_bf16 v[100:103], a[92:95], a[4:7], v[100:103]
    buffer_load_dwordx4 v18, s[44:47], s52 offen offset:0 sc1 lds
    v_mfma_f32_16x16x32_bf16 v[100:103], a[88:91], a[0:3], v[100:103]
    ds_read_b64_tr_b16 a[66:67], v8 offset:2048
    v_mfma_f32_16x16x32_bf16 v[108:111], a[88:91], a[8:11], v[108:111]
    s_add_u32 s64, s64, 32768
    v_mfma_f32_16x16x32_bf16 v[108:111], a[92:95], a[12:15], v[108:111]
    s_cmp_ge_u32 s64, 98304
    s_cselect_b32 s63, 4294901760, s59
    s_cselect_b32 s64, 0, s64
    v_mfma_f32_16x16x32_bf16 v[104:107], a[84:87], a[12:15], v[104:107]
    buffer_load_dwordx4 v19, s[44:47], s52 offen offset:1024 sc1 lds
    v_mfma_f32_16x16x32_bf16 v[104:107], a[80:83], a[8:11], v[104:107]
    s_add_u32 s52, s52, s56
    ds_read_b64_tr_b16 a[68:69], v8 offset:16384
    v_mfma_f32_16x16x32_bf16 v[112:115], a[80:83], a[16:19], v[112:115]
    v_mfma_f32_16x16x32_bf16 v[112:115], a[84:87], a[20:23], v[112:115]
    v_mfma_f32_16x16x32_bf16 v[116:119], a[92:95], a[20:23], v[116:119]
    buffer_load_dwordx4 v18, s[44:47], s53 offen offset:2048 sc1 lds
    v_mfma_f32_16x16x32_bf16 v[116:119], a[88:91], a[16:19], v[116:119]
    ds_read_b64_tr_b16 a[70:71], v8 offset:18432
    v_mfma_f32_16x16x32_bf16 v[124:127], a[88:91], a[24:27], v[124:127]
    v_mfma_f32_16x16x32_bf16 v[124:127], a[92:95], a[28:31], v[124:127]
    v_mfma_f32_16x16x32_bf16 v[120:123], a[84:87], a[28:31], v[120:123]
    buffer_load_dwordx4 v19, s[44:47], s53 offen offset:3072 sc1 lds
    v_mfma_f32_16x16x32_bf16 v[120:123], a[80:83], a[24:27], v[120:123]
    s_add_u32 s53, s53, s56
    ds_read_b64_tr_b16 a[72:73], v9 offset:0
    v_mfma_f32_16x16x32_bf16 v[128:131], a[80:83], a[32:35], v[128:131]
    v_mfma_f32_16x16x32_bf16 v[128:131], a[84:87], a[36:39], v[128:131]
    s_add_u32 m0, s62, 4096
    v_mfma_f32_16x16x32_bf16 v[132:135], a[92:95], a[36:39], v[132:135]
    buffer_load_dwordx4 v20, s[44:47], s54 offen offset:0 sc1 lds
    v_mfma_f32_16x16x32_bf16 v[132:135], a[88:91], a[32:35], v[132:135]
    s_xor_b32 s62, s62, 229376
    ds_read_b64_tr_b16 a[74:75], v9 offset:2048
    v_mfma_f32_16x16x32_bf16 v[140:143], a[88:91], a[40:43], v[140:143]
    v_mfma_f32_16x16x32_bf16 v[140:143], a[92:95], a[44:47], v[140:143]
    v_mfma_f32_16x16x32_bf16 v[136:139], a[84:87], a[44:47], v[136:139]
    buffer_load_dwordx4 v21, s[44:47], s54 offen offset:1024 sc1 lds
    v_mfma_f32_16x16x32_bf16 v[136:139], a[80:83], a[40:43], v[136:139]
    s_add_u32 s54, s54, s56
    ds_read_b64_tr_b16 a[76:77], v9 offset:16384
    v_mfma_f32_16x16x32_bf16 v[144:147], a[80:83], a[48:51], v[144:147]
    v_mfma_f32_16x16x32_bf16 v[144:147], a[84:87], a[52:55], v[144:147]
    v_mfma_f32_16x16x32_bf16 v[148:151], a[92:95], a[52:55], v[148:151]
    buffer_load_dwordx4 v20, s[44:47], s55 offen offset:2048 sc1 lds
    v_mfma_f32_16x16x32_bf16 v[148:151], a[88:91], a[48:51], v[148:151]
    ds_read_b64_tr_b16 a[78:79], v9 offset:18432
    v_mfma_f32_16x16x32_bf16 v[156:159], a[88:91], a[56:59], v[156:159]
    v_add_u32 v6, s63, v6
    v_add_u32 v7, s63, v7
    v_mfma_f32_16x16x32_bf16 v[156:159], a[92:95], a[60:63], v[156:159]
    v_mfma_f32_16x16x32_bf16 v[152:155], a[84:87], a[60:63], v[152:155]
    buffer_load_dwordx4 v21, s[44:47], s55 offen offset:3072 sc1 lds
    v_mfma_f32_16x16x32_bf16 v[152:155], a[80:83], a[56:59], v[152:155]
    s_add_u32 s55, s55, s56
    v_mfma_f32_16x16x32_bf16 v[160:163], a[96:99], a[0:3], v[160:163]
    ds_read_b64_tr_b16 a[80:81], v10 offset:0
    v_mfma_f32_16x16x32_bf16 v[160:163], a[100:103], a[4:7], v[160:163]
    v_mfma_f32_16x16x32_bf16 v[164:167], a[108:111], a[4:7], v[164:167]
    v_mfma_f32_16x16x32_bf16 v[164:167], a[104:107], a[0:3], v[164:167]
    s_add_u32 m0, s61, 0
    ds_read_b64_tr_b16 a[82:83], v10 offset:2048
    v_mfma_f32_16x16x32_bf16 v[172:175], a[104:107], a[8:11], v[172:175]
    buffer_load_dwordx4 v16, s[40:43], s48 offen offset:0 sc1 lds
    v_mfma_f32_16x16x32_bf16 v[172:175], a[108:111], a[12:15], v[172:175]
    v_mfma_f32_16x16x32_bf16 v[168:171], a[100:103], a[12:15], v[168:171]
    ds_read_b64_tr_b16 a[84:85], v10 offset:16384
    v_mfma_f32_16x16x32_bf16 v[168:171], a[96:99], a[8:11], v[168:171]
    v_mfma_f32_16x16x32_bf16 v[176:179], a[96:99], a[16:19], v[176:179]
    buffer_store_dwordx4 a[176:179], v2, s[24:27], s28 offen sc1
    v_mfma_f32_16x16x32_bf16 v[176:179], a[100:103], a[20:23], v[176:179]
    s_add_u32 s28, s28, s31
    ds_read_b64_tr_b16 a[86:87], v10 offset:18432
    v_mfma_f32_16x16x32_bf16 v[180:183], a[108:111], a[20:23], v[180:183]
    v_mfma_f32_16x16x32_bf16 v[180:183], a[104:107], a[16:19], v[180:183]
    v_mfma_f32_16x16x32_bf16 v[188:191], a[104:107], a[24:27], v[188:191]
    buffer_load_dwordx4 v17, s[40:43], s48 offen offset:1024 sc1 lds
    v_mfma_f32_16x16x32_bf16 v[188:191], a[108:111], a[28:31], v[188:191]
    s_add_u32 s48, s48, 128
    ds_read_b64_tr_b16 a[88:89], v11 offset:0
    v_mfma_f32_16x16x32_bf16 v[184:187], a[100:103], a[28:31], v[184:187]
    v_mfma_f32_16x16x32_bf16 v[184:187], a[96:99], a[24:27], v[184:187]
    v_mfma_f32_16x16x32_bf16 v[192:195], a[96:99], a[32:35], v[192:195]
    buffer_store_dwordx4 a[180:183], v2, s[24:27], s28 offen sc1
    v_mfma_f32_16x16x32_bf16 v[192:195], a[100:103], a[36:39], v[192:195]
    s_add_u32 s28, s28, s31
    ds_read_b64_tr_b16 a[90:91], v11 offset:2048
    v_mfma_f32_16x16x32_bf16 v[196:199], a[108:111], a[36:39], v[196:199]
    v_mfma_f32_16x16x32_bf16 v[196:199], a[104:107], a[32:35], v[196:199]
    v_mfma_f32_16x16x32_bf16 v[204:207], a[104:107], a[40:43], v[204:207]
    buffer_load_dwordx4 v16, s[40:43], s49 offen offset:2048 sc1 lds
    v_mfma_f32_16x16x32_bf16 v[204:207], a[108:111], a[44:47], v[204:207]
    ds_read_b64_tr_b16 a[92:93], v11 offset:16384
    v_mfma_f32_16x16x32_bf16 v[200:203], a[100:103], a[44:47], v[200:203]
    v_mfma_f32_16x16x32_bf16 v[200:203], a[96:99], a[40:43], v[200:203]
    v_mfma_f32_16x16x32_bf16 v[208:211], a[96:99], a[48:51], v[208:211]
    buffer_store_dwordx4 a[184:187], v2, s[24:27], s28 offen sc1
    v_mfma_f32_16x16x32_bf16 v[208:211], a[100:103], a[52:55], v[208:211]
    s_add_u32 s28, s28, s31
    ds_read_b64_tr_b16 a[94:95], v11 offset:18432
    v_mfma_f32_16x16x32_bf16 v[212:215], a[108:111], a[52:55], v[212:215]
    v_mfma_f32_16x16x32_bf16 v[212:215], a[104:107], a[48:51], v[212:215]
    v_mfma_f32_16x16x32_bf16 v[220:223], a[104:107], a[56:59], v[220:223]
    buffer_load_dwordx4 v17, s[40:43], s49 offen offset:3072 sc1 lds
    v_mfma_f32_16x16x32_bf16 v[220:223], a[108:111], a[60:63], v[220:223]
    s_add_u32 s49, s49, 128
    v_mfma_f32_16x16x32_bf16 v[216:219], a[100:103], a[60:63], v[216:219]
    buffer_store_dwordx4 a[188:191], v2, s[24:27], s28 offen sc1
    v_mfma_f32_16x16x32_bf16 v[216:219], a[96:99], a[56:59], v[216:219]
    s_add_u32 s29, s29, s30
    s_mov_b32 s28, s29
    v_mfma_f32_16x16x32_bf16 v[224:227], a[112:115], a[0:3], v[224:227]
    v_mfma_f32_16x16x32_bf16 v[224:227], a[116:119], a[4:7], v[224:227]
    ds_read_b64_tr_b16 a[96:97], v12 offset:0
    v_mfma_f32_16x16x32_bf16 v[228:231], a[124:127], a[4:7], v[228:231]
    v_mfma_f32_16x16x32_bf16 v[228:231], a[120:123], a[0:3], v[228:231]
    s_add_u32 m0, s61, 4096
    ds_read_b128 a[0:3], v6 offset:0
    v_mfma_f32_16x16x32_bf16 v[236:239], a[120:123], a[8:11], v[236:239]
    buffer_load_dwordx4 v16, s[40:43], s50 offen offset:0 sc1 lds
    v_mfma_f32_16x16x32_bf16 v[236:239], a[124:127], a[12:15], v[236:239]
    s_add_u32 s61, s61, 32768
    ds_read_b128 a[4:7], v7 offset:0
    v_mfma_f32_16x16x32_bf16 v[232:235], a[116:119], a[12:15], v[232:235]
    s_cmp_ge_u32 s61, 98304
    s_cselect_b32 s90, 98304, 0
    ds_read_b64_tr_b16 a[98:99], v12 offset:2048
    v_mfma_f32_16x16x32_bf16 v[232:235], a[112:115], a[8:11], v[232:235]
    s_sub_u32 s61, s61, s90
    ds_read_b128 a[8:11], v6 offset:2048
    v_mfma_f32_16x16x32_bf16 v[240:243], a[112:115], a[16:19], v[240:243]
    ds_read_b128 a[12:15], v7 offset:2048
    v_mfma_f32_16x16x32_bf16 v[240:243], a[116:119], a[20:23], v[240:243]
    ds_read_b64_tr_b16 a[100:101], v12 offset:16384
    v_mfma_f32_16x16x32_bf16 v[244:247], a[124:127], a[20:23], v[244:247]
    v_mfma_f32_16x16x32_bf16 v[244:247], a[120:123], a[16:19], v[244:247]
    ds_read_b128 a[16:19], v6 offset:4096
    v_mfma_f32_16x16x32_bf16 v[252:255], a[120:123], a[24:27], v[252:255]
    buffer_load_dwordx4 v17, s[40:43], s50 offen offset:1024 sc1 lds
    v_mfma_f32_16x16x32_bf16 v[252:255], a[124:127], a[28:31], v[252:255]
    s_add_u32 s50, s50, 128
    ds_read_b128 a[20:23], v7 offset:4096
    v_mfma_f32_16x16x32_bf16 v[248:251], a[116:119], a[28:31], v[248:251]
    ds_read_b64_tr_b16 a[102:103], v12 offset:18432
    v_mfma_f32_16x16x32_bf16 v[248:251], a[112:115], a[24:27], v[248:251]
    ds_read_b128 a[24:27], v6 offset:6144
    v_mfma_f32_16x16x32_bf16 a[224:227], a[112:115], a[32:35], a[224:227]
    s_sub_u32 s65, s65, 1
    ds_read_b128 a[28:31], v7 offset:6144
    v_mfma_f32_16x16x32_bf16 a[224:227], a[116:119], a[36:39], a[224:227]
    ds_read_b64_tr_b16 a[104:105], v13 offset:0
    v_mfma_f32_16x16x32_bf16 a[228:231], a[124:127], a[36:39], a[228:231]
    v_mfma_f32_16x16x32_bf16 a[228:231], a[120:123], a[32:35], a[228:231]
    ds_read_b128 a[32:35], v6 offset:8192
    v_mfma_f32_16x16x32_bf16 a[236:239], a[120:123], a[40:43], a[236:239]
    buffer_load_dwordx4 v16, s[40:43], s51 offen offset:2048 sc1 lds
    v_mfma_f32_16x16x32_bf16 a[236:239], a[124:127], a[44:47], a[236:239]
    ds_read_b128 a[36:39], v7 offset:8192
    v_mfma_f32_16x16x32_bf16 a[232:235], a[116:119], a[44:47], a[232:235]
    ds_read_b64_tr_b16 a[106:107], v13 offset:2048
    v_mfma_f32_16x16x32_bf16 a[232:235], a[112:115], a[40:43], a[232:235]
    ds_read_b128 a[40:43], v6 offset:10240
    v_mfma_f32_16x16x32_bf16 a[240:243], a[112:115], a[48:51], a[240:243]
    ds_read_b128 a[44:47], v7 offset:10240
    v_mfma_f32_16x16x32_bf16 a[240:243], a[116:119], a[52:55], a[240:243]
    ds_read_b64_tr_b16 a[108:109], v13 offset:16384
    v_mfma_f32_16x16x32_bf16 a[244:247], a[124:127], a[52:55], a[244:247]
    v_mfma_f32_16x16x32_bf16 a[244:247], a[120:123], a[48:51], a[244:247]
    ds_read_b128 a[48:51], v6 offset:12288
    v_mfma_f32_16x16x32_bf16 a[252:255], a[120:123], a[56:59], a[252:255]
    buffer_load_dwordx4 v17, s[40:43], s51 offen offset:3072 sc1 lds
    v_mfma_f32_16x16x32_bf16 a[252:255], a[124:127], a[60:63], a[252:255]
    s_add_u32 s51, s51, 128
    ds_read_b128 a[52:55], v7 offset:12288
    v_mfma_f32_16x16x32_bf16 a[248:251], a[116:119], a[60:63], a[248:251]
    ds_read_b64_tr_b16 a[110:111], v13 offset:18432
    v_mfma_f32_16x16x32_bf16 a[248:251], a[112:115], a[56:59], a[248:251]
    ds_read_b128 a[56:59], v6 offset:14336
    ds_read_b128 a[60:63], v7 offset:14336
    s_cmp_eq_u32 s66, 2
    s_cbranch_scc1 m_hook17
m_hookr18:
    s_waitcnt lgkmcnt(15)
    v_mfma_f32_16x16x32_bf16 v[32:35], a[64:67], a[0:3], v[32:35]
    ds_read_b64_tr_b16 a[112:113], v14 offset:0
    v_mfma_f32_16x16x32_bf16 v[32:35], a[68:71], a[4:7], v[32:35]
    ds_read_b64_tr_b16 a[114:115], v14 offset:2048
    v_mfma_f32_16x16x32_bf16 v[36:39], a[76:79], a[4:7], v[36:39]
    ds_read_b64_tr_b16 a[116:117], v14 offset:16384
    v_mfma_f32_16x16x32_bf16 v[36:39], a[72:75], a[0:3], v[36:39]
    ds_read_b64_tr_b16 a[118:119], v14 offset:18432
    v_mfma_f32_16x16x32_bf16 v[44:47], a[72:75], a[8:11], v[44:47]
    ds_read_b64_tr_b16 a[120:121], v15 offset:0
    v_mfma_f32_16x16x32_bf16 v[44:47], a[76:79], a[12:15], v[44:47]
    ds_read_b64_tr_b16 a[122:123], v15 offset:2048
    v_mfma_f32_16x16x32_bf16 v[40:43], a[68:71], a[12:15], v[40:43]
    ds_read_b64_tr_b16 a[124:125], v15 offset:16384
    v_mfma_f32_16x16x32_bf16 v[40:43], a[64:67], a[8:11], v[40:43]
    ds_read_b64_tr_b16 a[126:127], v15 offset:18432
    v_mfma_f32_16x16x32_bf16 v[48:51], a[64:67], a[16:19], v[48:51]
    v_mfma_f32_16x16x32_bf16 v[48:51], a[68:71], a[20:23], v[48:51]
    v_mfma_f32_16x16x32_bf16 v[52:55], a[76:79], a[20:23], v[52:55]
    buffer_store_dwordx4 a[192:195], v2, s[24:27], s28 offen sc1
    v_mfma_f32_16x16x32_bf16 v[52:55], a[72:75], a[16:19], v[52:55]
    s_add_u32 s28, s28, s31
    s_waitcnt lgkmcnt(15)
    v_mfma_f32_16x16x32_bf16 v[60:63], a[72:75], a[24:27], v[60:63]
    v_xor_b32 v8, s60, v8
    v_xor_b32 v9, s60, v9
    v_mfma_f32_16x16x32_bf16 v[60:63], a[76:79], a[28:31], v[60:63]
    v_xor_b32 v10, s60, v10
    v_xor_b32 v11, s60, v11
    v_mfma_f32_16x16x32_bf16 v[56:59], a[68:71], a[28:31], v[56:59]
    v_xor_b32 v12, s60, v12
    v_xor_b32 v13, s60, v13
    v_mfma_f32_16x16x32_bf16 v[56:59], a[64:67], a[24:27], v[56:59]
    v_xor_b32 v14, s60, v14
    v_xor_b32 v15, s60, v15
    v_mfma_f32_16x16x32_bf16 v[64:67], a[64:67], a[32:35], v[64:67]
    buffer_store_dwordx4 a[196:199], v2, s[24:27], s28 offen sc1
    v_mfma_f32_16x16x32_bf16 v[64:67], a[68:71], a[36:39], v[64:67]
    s_add_u32 s28, s28, s31
    v_mfma_f32_16x16x32_bf16 v[68:71], a[76:79], a[36:39], v[68:71]
    v_mfma_f32_16x16x32_bf16 v[68:71], a[72:75], a[32:35], v[68:71]
    s_waitcnt lgkmcnt(14)
    v_mfma_f32_16x16x32_bf16 v[76:79], a[72:75], a[40:43], v[76:79]
    v_mfma_f32_16x16x32_bf16 v[76:79], a[76:79], a[44:47], v[76:79]
    v_mfma_f32_16x16x32_bf16 v[72:75], a[68:71], a[44:47], v[72:75]
    buffer_store_dwordx4 a[200:203], v2, s[24:27], s28 offen sc1
    v_mfma_f32_16x16x32_bf16 v[72:75], a[64:67], a[40:43], v[72:75]
    s_add_u32 s28, s28, s31
    s_waitcnt lgkmcnt(11)
    v_mfma_f32_16x16x32_bf16 v[80:83], a[64:67], a[48:51], v[80:83]
    v_mfma_f32_16x16x32_bf16 v[80:83], a[68:71], a[52:55], v[80:83]
    v_mfma_f32_16x16x32_bf16 v[84:87], a[76:79], a[52:55], v[84:87]
    v_mfma_f32_16x16x32_bf16 v[84:87], a[72:75], a[48:51], v[84:87]
    s_waitcnt lgkmcnt(8)
    v_mfma_f32_16x16x32_bf16 v[92:95], a[72:75], a[56:59], v[92:95]
    buffer_store_dwordx4 a[204:207], v2, s[24:27], s28 offen sc1
    v_mfma_f32_16x16x32_bf16 v[92:95], a[76:79], a[60:63], v[92:95]
    s_add_u32 s28, s28, s31
    v_mfma_f32_16x16x32_bf16 v[88:91], a[68:71], a[60:63], v[88:91]
    s_waitcnt vmcnt(16) lgkmcnt(0)
    v_mfma_f32_16x16x32_bf16 v[88:91], a[64:67], a[56:59], v[88:91]
    s_barrier
    v_mfma_f32_16x16x32_bf16 v[96:99], a[80:83], a[0:3], v[96:99]
    ds_read_b64_tr_b16 a[64:65], v8 offset:0
    v_mfma_f32_16x16x32_bf16 v[96:99], a[84:87], a[4:7], v[96:99]
    s_add_u32 m0, s62, 0
    v_mfma_f32_16x16x32_bf16 v[100:103], a[92:95], a[4:7], v[100:103]
    buffer_load_dwordx4 v18, s[44:47], s52 offen offset:0 sc1 lds
    v_mfma_f32_16x16x32_bf16 v[100:103], a[88:91], a[0:3], v[100:103]
    ds_read_b64_tr_b16 a[66:67], v8 offset:2048
    v_mfma_f32_16x16x32_bf16 v[108:111], a[88:91], a[8:11], v[108:111]
    s_add_u32 s64, s64, 32768
    v_mfma_f32_16x16x32_bf16 v[108:111], a[92:95], a[12:15], v[108:111]
    s_cmp_ge_u32 s64, 98304
    s_cselect_b32 s63, 4294901760, s59
    s_cselect_b32 s64, 0, s64
    v_mfma_f32_16x16x32_bf16 v[104:107], a[84:87], a[12:15], v[104:107]
    buffer_load_dwordx4 v19, s[44:47], s52 offen offset:1024 sc1 lds
    v_mfma_f32_16x16x32_bf16 v[104:107], a[80:83], a[8:11], v[104:107]
    s_add_u32 s52, s52, s56
    ds_read_b64_tr_b16 a[68:69], v8 offset:16384
    v_mfma_f32_16x16x32_bf16 v[112:115], a[80:83], a[16:19], v[112:115]
    v_mfma_f32_16x16x32_bf16 v[112:115], a[84:87], a[20:23], v[112:115]
    v_mfma_f32_16x16x32_bf16 v[116:119], a[92:95], a[20:23], v[116:119]
    buffer_load_dwordx4 v18, s[44:47], s53 offen offset:2048 sc1 lds
    v_mfma_f32_16x16x32_bf16 v[116:119], a[88:91], a[16:19], v[116:119]
    ds_read_b64_tr_b16 a[70:71], v8 offset:18432
    v_mfma_f32_16x16x32_bf16 v[124:127], a[88:91], a[24:27], v[124:127]
    v_mfma_f32_16x16x32_bf16 v[124:127], a[92:95], a[28:31], v[124:127]
    v_mfma_f32_16x16x32_bf16 v[120:123], a[84:87], a[28:31], v[120:123]
    buffer_load_dwordx4 v19, s[44:47], s53 offen offset:3072 sc1 lds
    v_mfma_f32_16x16x32_bf16 v[120:123], a[80:83], a[24:27], v[120:123]
    s_add_u32 s53, s53, s56
    ds_read_b64_tr_b16 a[72:73], v9 offset:0
    v_mfma_f32_16x16x32_bf16 v[128:131], a[80:83], a[32:35], v[128:131]
    v_mfma_f32_16x16x32_bf16 v[128:131], a[84:87], a[36:39], v[128:131]
    s_add_u32 m0, s62, 4096
    v_mfma_f32_16x16x32_bf16 v[132:135], a[92:95], a[36:39], v[132:135]
    buffer_load_dwordx4 v20, s[44:47], s54 offen offset:0 sc1 lds
    v_mfma_f32_16x16x32_bf16 v[132:135], a[88:91], a[32:35], v[132:135]
    s_xor_b32 s62, s62, 229376
    ds_read_b64_tr_b16 a[74:75], v9 offset:2048
    v_mfma_f32_16x16x32_bf16 v[140:143], a[88:91], a[40:43], v[140:143]
    v_mfma_f32_16x16x32_bf16 v[140:143], a[92:95], a[44:47], v[140:143]
    v_mfma_f32_16x16x32_bf16 v[136:139], a[84:87], a[44:47], v[136:139]
    buffer_load_dwordx4 v21, s[44:47], s54 offen offset:1024 sc1 lds
    v_mfma_f32_16x16x32_bf16 v[136:139], a[80:83], a[40:43], v[136:139]
    s_add_u32 s54, s54, s56
    ds_read_b64_tr_b16 a[76:77], v9 offset:16384
    v_mfma_f32_16x16x32_bf16 v[144:147], a[80:83], a[48:51], v[144:147]
    v_mfma_f32_16x16x32_bf16 v[144:147], a[84:87], a[52:55], v[144:147]
    v_mfma_f32_16x16x32_bf16 v[148:151], a[92:95], a[52:55], v[148:151]
    buffer_load_dwordx4 v20, s[44:47], s55 offen offset:2048 sc1 lds
    v_mfma_f32_16x16x32_bf16 v[148:151], a[88:91], a[48:51], v[148:151]
    ds_read_b64_tr_b16 a[78:79], v9 offset:18432
    v_mfma_f32_16x16x32_bf16 v[156:159], a[88:91], a[56:59], v[156:159]
    v_add_u32 v6, s63, v6
    v_add_u32 v7, s63, v7
    v_mfma_f32_16x16x32_bf16 v[156:159], a[92:95], a[60:63], v[156:159]
    v_mfma_f32_16x16x32_bf16 v[152:155], a[84:87], a[60:63], v[152:155]
    buffer_load_dwordx4 v21, s[44:47], s55 offen offset:3072 sc1 lds
    v_mfma_f32_16x16x32_bf16 v[152:155], a[80:83], a[56:59], v[152:155]
    s_add_u32 s55, s55, s56
    v_mfma_f32_16x16x32_bf16 v[160:163], a[96:99], a[0:3], v[160:163]
    ds_read_b64_tr_b16 a[80:81], v10 offset:0
    v_mfma_f32_16x16x32_bf16 v[160:163], a[100:103], a[4:7], v[160:163]
    v_mfma_f32_16x16x32_bf16 v[164:167], a[108:111], a[4:7], v[164:167]
    v_mfma_f32_16x16x32_bf16 v[164:167], a[104:107], a[0:3], v[164:167]
    s_add_u32 m0, s61, 0
    ds_read_b64_tr_b16 a[82:83], v10 offset:2048
    v_mfma_f32_16x16x32_bf16 v[172:175], a[104:107], a[8:11], v[172:175]
    buffer_load_dwordx4 v16, s[40:43], s48 offen offset:0 sc1 lds
    v_mfma_f32_16x16x32_bf16 v[172:175], a[108:111], a[12:15], v[172:175]
    v_mfma_f32_16x16x32_bf16 v[168:171], a[100:103], a[12:15], v[168:171]
    ds_read_b64_tr_b16 a[84:85], v10 offset:16384
    v_mfma_f32_16x16x32_bf16 v[168:171], a[96:99], a[8:11], v[168:171]
    v_mfma_f32_16x16x32_bf16 v[176:179], a[96:99], a[16:19], v[176:179]
    buffer_store_dwordx4 a[208:211], v2, s[24:27], s28 offen sc1
    v_mfma_f32_16x16x32_bf16 v[176:179], a[100:103], a[20:23], v[176:179]
    s_add_u32 s28, s28, s31
    ds_read_b64_tr_b16 a[86:87], v10 offset:18432
    v_mfma_f32_16x16x32_bf16 v[180:183], a[108:111], a[20:23], v[180:183]
    v_mfma_f32_16x16x32_bf16 v[180:183], a[104:107], a[16:19], v[180:183]
    v_mfma_f32_16x16x32_bf16 v[188:191], a[104:107], a[24:27], v[188:191]
    buffer_load_dwordx4 v17, s[40:43], s48 offen offset:1024 sc1 lds
    v_mfma_f32_16x16x32_bf16 v[188:191], a[108:111], a[28:31], v[188:191]
    s_add_u32 s48, s48, 128
    ds_read_b64_tr_b16 a[88:89], v11 offset:0
    v_mfma_f32_16x16x32_bf16 v[184:187], a[100:103], a[28:31], v[184:187]
    v_mfma_f32_16x16x32_bf16 v[184:187], a[96:99], a[24:27], v[184:187]
    v_mfma_f32_16x16x32_bf16 v[192:195], a[96:99], a[32:35], v[192:195]
    buffer_store_dwordx4 a[212:215], v2, s[24:27], s28 offen sc1
    v_mfma_f32_16x16x32_bf16 v[192:195], a[100:103], a[36:39], v[192:195]
    s_add_u32 s28, s28, s31
    ds_read_b64_tr_b16 a[90:91], v11 offset:2048
    v_mfma_f32_16x16x32_bf16 v[196:199], a[108:111], a[36:39], v[196:199]
    v_mfma_f32_16x16x32_bf16 v[196:199], a[104:107], a[32:35], v[196:199]
    v_mfma_f32_16x16x32_bf16 v[204:207], a[104:107], a[40:43], v[204:207]
    buffer_load_dwordx4 v16, s[40:43], s49 offen offset:2048 sc1 lds
    v_mfma_f32_16x16x32_bf16 v[204:207], a[108:111], a[44:47], v[204:207]
    ds_read_b64_tr_b16 a[92:93], v11 offset:16384
    v_mfma_f32_16x16x32_bf16 v[200:203], a[100:103], a[44:47], v[200:203]
    v_mfma_f32_16x16x32_bf16 v[200:203], a[96:99], a[40:43], v[200:203]
    v_mfma_f32_16x16x32_bf16 v[208:211], a[96:99], a[48:51], v[208:211]
    buffer_store_dwordx4 a[216:219], v2, s[24:27], s28 offen sc1
    v_mfma_f32_16x16x32_bf16 v[208:211], a[100:103], a[52:55], v[208:211]
    s_add_u32 s28, s28, s31
    ds_read_b64_tr_b16 a[94:95], v11 offset:18432
    v_mfma_f32_16x16x32_bf16 v[212:215], a[108:111], a[52:55], v[212:215]
    v_mfma_f32_16x16x32_bf16 v[212:215], a[104:107], a[48:51], v[212:215]
    v_mfma_f32_16x16x32_bf16 v[220:223], a[104:107], a[56:59], v[220:223]
    buffer_load_dwordx4 v17, s[40:43], s49 offen offset:3072 sc1 lds
    v_mfma_f32_16x16x32_bf16 v[220:223], a[108:111], a[60:63], v[220:223]
    s_add_u32 s49, s49, 128
    v_mfma_f32_16x16x32_bf16 v[216:219], a[100:103], a[60:63], v[216:219]
    buffer_store_dwordx4 a[220:223], v2, s[24:27], s28 offen sc1
    v_mfma_f32_16x16x32_bf16 v[216:219], a[96:99], a[56:59], v[216:219]
    s_add_u32 s29, s29, s30
    s_mov_b32 s28, s29
    v_mfma_f32_16x16x32_bf16 v[224:227], a[112:115], a[0:3], v[224:227]
    v_mfma_f32_16x16x32_bf16 v[224:227], a[116:119], a[4:7], v[224:227]
    ds_read_b64_tr_b16 a[96:97], v12 offset:0
    v_mfma_f32_16x16x32_bf16 v[228:231], a[124:127], a[4:7], v[228:231]
    v_mfma_f32_16x16x32_bf16 v[228:231], a[120:123], a[0:3], v[228:231]
    s_add_u32 m0, s61, 4096
    ds_read_b128 a[0:3], v6 offset:0
    v_mfma_f32_16x16x32_bf16 v[236:239], a[120:123], a[8:11], v[236:239]
    buffer_load_dwordx4 v16, s[40:43], s50 offen offset:0 sc1 lds
    v_mfma_f32_16x16x32_bf16 v[236:239], a[124:127], a[12:15], v[236:239]
    s_add_u32 s61, s61, 32768
    ds_read_b128 a[4:7], v7 offset:0
    v_mfma_f32_16x16x32_bf16 v[232:235], a[116:119], a[12:15], v[232:235]
    s_cmp_ge_u32 s61, 98304
    s_cselect_b32 s90, 98304, 0
    ds_read_b64_tr_b16 a[98:99], v12 offset:2048
    v_mfma_f32_16x16x32_bf16 v[232:235], a[112:115], a[8:11], v[232:235]
    s_sub_u32 s61, s61, s90
    ds_read_b128 a[8:11], v6 offset:2048
    v_mfma_f32_16x16x32_bf16 v[240:243], a[112:115], a[16:19], v[240:243]
    ds_read_b128 a[12:15], v7 offset:2048
    v_mfma_f32_16x16x32_bf16 v[240:243], a[116:119], a[20:23], v[240:243]
    ds_read_b64_tr_b16 a[100:101], v12 offset:16384
    v_mfma_f32_16x16x32_bf16 v[244:247], a[124:127], a[20:23], v[244:247]
    v_mfma_f32_16x16x32_bf16 v[244:247], a[120:123], a[16:19], v[244:247]
    ds_read_b128 a[16:19], v6 offset:4096
    v_mfma_f32_16x16x32_bf16 v[252:255], a[120:123], a[24:27], v[252:255]
    buffer_load_dwordx4 v17, s[40:43], s50 offen offset:1024 sc1 lds
    v_mfma_f32_16x16x32_bf16 v[252:255], a[124:127], a[28:31], v[252:255]
    s_add_u32 s50, s50, 128
    ds_read_b128 a[20:23], v7 offset:4096
    v_mfma_f32_16x16x32_bf16 v[248:251], a[116:119], a[28:31], v[248:251]
    ds_read_b64_tr_b16 a[102:103], v12 offset:18432
    v_mfma_f32_16x16x32_bf16 v[248:251], a[112:115], a[24:27], v[248:251]
    ds_read_b128 a[24:27], v6 offset:6144
    v_mfma_f32_16x16x32_bf16 a[224:227], a[112:115], a[32:35], a[224:227]
    s_sub_u32 s65, s65, 1
    ds_read_b128 a[28:31], v7 offset:6144
    v_mfma_f32_16x16x32_bf16 a[224:227], a[116:119], a[36:39], a[224:227]
    ds_read_b64_tr_b16 a[104:105], v13 offset:0
    v_mfma_f32_16x16x32_bf16 a[228:231], a[124:127], a[36:39], a[228:231]
    v_mfma_f32_16x16x32_bf16 a[228:231], a[120:123], a[32:35], a[228:231]
    ds_read_b128 a[32:35], v6 offset:8192
    v_mfma_f32_16x16x32_bf16 a[236:239], a[120:123], a[40:43], a[236:239]
    buffer_load_dwordx4 v16, s[40:43], s51 offen offset:2048 sc1 lds
    v_mfma_f32_16x16x32_bf16 a[236:239], a[124:127], a[44:47], a[236:239]
    ds_read_b128 a[36:39], v7 offset:8192
    v_mfma_f32_16x16x32_bf16 a[232:235], a[116:119], a[44:47], a[232:235]
    ds_read_b64_tr_b16 a[106:107], v13 offset:2048
    v_mfma_f32_16x16x32_bf16 a[232:235], a[112:115], a[40:43], a[232:235]
    ds_read_b128 a[40:43], v6 offset:10240
    v_mfma_f32_16x16x32_bf16 a[240:243], a[112:115], a[48:51], a[240:243]
    ds_read_b128 a[44:47], v7 offset:10240
    v_mfma_f32_16x16x32_bf16 a[240:243], a[116:119], a[52:55], a[240:243]
    ds_read_b64_tr_b16 a[108:109], v13 offset:16384
    v_mfma_f32_16x16x32_bf16 a[244:247], a[124:127], a[52:55], a[244:247]
    v_mfma_f32_16x16x32_bf16 a[244:247], a[120:123], a[48:51], a[244:247]
    ds_read_b128 a[48:51], v6 offset:12288
    v_mfma_f32_16x16x32_bf16 a[252:255], a[120:123], a[56:59], a[252:255]
    buffer_load_dwordx4 v17, s[40:43], s51 offen offset:3072 sc1 lds
    v_mfma_f32_16x16x32_bf16 a[252:255], a[124:127], a[60:63], a[252:255]
    s_add_u32 s51, s51, 128
    ds_read_b128 a[52:55], v7 offset:12288
    v_mfma_f32_16x16x32_bf16 a[248:251], a[116:119], a[60:63], a[248:251]
    ds_read_b64_tr_b16 a[110:111], v13 offset:18432
    v_mfma_f32_16x16x32_bf16 a[248:251], a[112:115], a[56:59], a[248:251]
    ds_read_b128 a[56:59], v6 offset:14336
    ds_read_b128 a[60:63], v7 offset:14336
.p2align 3
m_loop19:
    s_waitcnt lgkmcnt(15)
    v_mfma_f32_16x16x32_bf16 v[32:35], a[64:67], a[0:3], v[32:35]
    ds_read_b64_tr_b16 a[112:113], v14 offset:0
    v_mfma_f32_16x16x32_bf16 v[32:35], a[68:71], a[4:7], v[32:35]
    ds_read_b64_tr_b16 a[114:115], v14 offset:2048
    v_mfma_f32_16x16x32_bf16 v[36:39], a[76:79], a[4:7], v[36:39]
    ds_read_b64_tr_b16 a[116:117], v14 offset:16384
    v_mfma_f32_16x16x32_bf16 v[36:39], a[72:75], a[0:3], v[36:39]
    ds_read_b64_tr_b16 a[118:119], v14 offset:18432
    v_mfma_f32_16x16x32_bf16 v[44:47], a[72:75], a[8:11], v[44:47]
    ds_read_b64_tr_b16 a[120:121], v15 offset:0
    v_mfma_f32_16x16x32_bf16 v[44:47], a[76:79], a[12:15], v[44:47]
    ds_read_b64_tr_b16 a[122:123], v15 offset:2048
    v_mfma_f32_16x16x32_bf16 v[40:43], a[68:71], a[12:15], v[40:43]
    ds_read_b64_tr_b16 a[124:125], v15 offset:16384
    v_mfma_f32_16x16x32_bf16 v[40:43], a[64:67], a[8:11], v[40:43]
    ds_read_b64_tr_b16 a[126:127], v15 offset:18432
    v_mfma_f32_16x16x32_bf16 v[48:51], a[64:67], a[16:19], v[48:51]
    v_mfma_f32_16x16x32_bf16 v[48:51], a[68:71], a[20:23], v[48:51]
    v_mfma_f32_16x16x32_bf16 v[52:55], a[76:79], a[20:23], v[52:55]
    v_mfma_f32_16x16x32_bf16 v[52:55], a[72:75], a[16:19], v[52:55]
    s_waitcnt lgkmcnt(15)
    v_mfma_f32_16x16x32_bf16 v[60:63], a[72:75], a[24:27], v[60:63]
    v_xor_b32 v8, s60, v8
    v_xor_b32 v9, s60, v9
    v_mfma_f32_16x16x32_bf16 v[60:63], a[76:79], a[28:31], v[60:63]
    v_xor_b32 v10, s60, v10
    v_xor_b32 v11, s60, v11
    v_mfma_f32_16x16x32_bf16 v[56:59], a[68:71], a[28:31], v[56:59]
    v_xor_b32 v12, s60, v12
    v_xor_b32 v13, s60, v13
    v_mfma_f32_16x16x32_bf16 v[56:59], a[64:67], a[24:27], v[56:59]
    v_xor_b32 v14, s60, v14
    v_xor_b32 v15, s60, v15
    v_mfma_f32_16x16x32_bf16 v[64:67], a[64:67], a[32:35], v[64:67]
    v_mfma_f32_16x16x32_bf16 v[64:67], a[68:71], a[36:39], v[64:67]
    v_mfma_f32_16x16x32_bf16 v[68:71], a[76:79], a[36:39], v[68:71]
    v_mfma_f32_16x16x32_bf16 v[68:71], a[72:75], a[32:35], v[68:71]
    s_waitcnt lgkmcnt(14)
    v_mfma_f32_16x16x32_bf16 v[76:79], a[72:75], a[40:43], v[76:79]
    v_mfma_f32_16x16x32_bf16 v[76:79], a[76:79], a[44:47], v[76:79]
    v_mfma_f32_16x16x32_bf16 v[72:75], a[68:71], a[44:47], v[72:75]
    v_mfma_f32_16x16x32_bf16 v[72:75], a[64:67], a[40:43], v[72:75]
    s_waitcnt lgkmcnt(11)
    v_mfma_f32_16x16x32_bf16 v[80:83], a[64:67], a[48:51], v[80:83]
    v_mfma_f32_16x16x32_bf16 v[80:83], a[68:71], a[52:55], v[80:83]
    v_mfma_f32_16x16x32_bf16 v[84:87], a[76:79], a[52:55], v[84:87]
    v_mfma_f32_16x16x32_bf16 v[84:87], a[72:75], a[48:51], v[84:87]
    s_waitcnt lgkmcnt(8)
    v_mfma_f32_16x16x32_bf16 v[92:95], a[72:75], a[56:59], v[92:95]
    v_mfma_f32_16x16x32_bf16 v[92:95], a[76:79], a[60:63], v[92:95]
    v_mfma_f32_16x16x32_bf16 v[88:91], a[68:71], a[60:63], v[88:91]
    s_waitcnt vmcnt(8) lgkmcnt(0)
    v_mfma_f32_16x16x32_bf16 v[88:91], a[64:67], a[56:59], v[88:91]
    s_barrier
    v_mfma_f32_16x16x32_bf16 v[96:99], a[80:83], a[0:3], v[96:99]
    ds_read_b64_tr_b16 a[64:65], v8 offset:0
    v_mfma_f32_16x16x32_bf16 v[96:99], a[84:87], a[4:7], v[96:99]
    s_add_u32 m0, s62, 0
    v_mfma_f32_16x16x32_bf16 v[100:103], a[92:95], a[4:7], v[100:103]
    buffer_load_dwordx4 v18, s[44:47], s52 offen offset:0 sc1 lds
    v_mfma_f32_16x16x32_bf16 v[100:103], a[88:91], a[0:3], v[100:103]
    ds_read_b64_tr_b16 a[66:67], v8 offset:2048
    v_mfma_f32_16x16x32_bf16 v[108:111], a[88:91], a[8:11], v[108:111]
    s_add_u32 s64, s64, 32768
    v_mfma_f32_16x16x32_bf16 v[108:111], a[92:95], a[12:15], v[108:111]
    s_cmp_ge_u32 s64, 98304
    s_cselect_b32 s63, 4294901760, s59
    s_cselect_b32 s64, 0, s64
    v_mfma_f32_16x16x32_bf16 v[104:107], a[84:87], a[12:15], v[104:107]
    buffer_load_dwordx4 v19, s[44:47], s52 offen offset:1024 sc1 lds
    v_mfma_f32_16x16x32_bf16 v[104:107], a[80:83], a[8:11], v[104:107]
    s_add_u32 s52, s52, s56
    ds_read_b64_tr_b16 a[68:69], v8 offset:16384
    v_mfma_f32_16x16x32_bf16 v[112:115], a[80:83], a[16:19], v[112:115]
    v_mfma_f32_16x16x32_bf16 v[112:115], a[84:87], a[20:23], v[112:115]
    v_mfma_f32_16x16x32_bf16 v[116:119], a[92:95], a[20:23], v[116:119]
    buffer_load_dwordx4 v18, s[44:47], s53 offen offset:2048 sc1 lds
    v_mfma_f32_16x16x32_bf16 v[116:119], a[88:91], a[16:19], v[116:119]
    ds_read_b64_tr_b16 a[70:71], v8 offset:18432
    v_mfma_f32_16x16x32_bf16 v[124:127], a[88:91], a[24:27], v[124:127]
    v_mfma_f32_16x16x32_bf16 v[124:127], a[92:95], a[28:31], v[124:127]
    v_mfma_f32_16x16x32_bf16 v[120:123], a[84:87], a[28:31], v[120:123]
    buffer_load_dwordx4 v19, s[44:47], s53 offen offset:3072 sc1 lds
    v_mfma_f32_16x16x32_bf16 v[120:123], a[80:83], a[24:27], v[120:123]
    s_add_u32 s53, s53, s56
    ds_read_b64_tr_b16 a[72:73], v9 offset:0
    v_mfma_f32_16x16x32_bf16 v[128:131], a[80:83], a[32:35], v[128:131]
    v_mfma_f32_16x16x32_bf16 v[128:131], a[84:87], a[36:39], v[128:131]
    s_add_u32 m0, s62, 4096
    v_mfma_f32_16x16x32_bf16 v[132:135], a[92:95], a[36:39], v[132:135]
    buffer_load_dwordx4 v20, s[44:47], s54 offen offset:0 sc1 lds
    v_mfma_f32_16x16x32_bf16 v[132:135], a[88:91], a[32:35], v[132:135]
    s_xor_b32 s62, s62, 229376
    ds_read_b64_tr_b16 a[74:75], v9 offset:2048
    v_mfma_f32_16x16x32_bf16 v[140:143], a[88:91], a[40:43], v[140:143]
    v_mfma_f32_16x16x32_bf16 v[140:143], a[92:95], a[44:47], v[140:143]
    v_mfma_f32_16x16x32_bf16 v[136:139], a[84:87], a[44:47], v[136:139]
    buffer_load_dwordx4 v21, s[44:47], s54 offen offset:1024 sc1 lds
    v_mfma_f32_16x16x32_bf16 v[136:139], a[80:83], a[40:43], v[136:139]
    s_add_u32 s54, s54, s56
    ds_read_b64_tr_b16 a[76:77], v9 offset:16384
    v_mfma_f32_16x16x32_bf16 v[144:147], a[80:83], a[48:51], v[144:147]
    v_mfma_f32_16x16x32_bf16 v[144:147], a[84:87], a[52:55], v[144:147]
    v_mfma_f32_16x16x32_bf16 v[148:151], a[92:95], a[52:55], v[148:151]
    buffer_load_dwordx4 v20, s[44:47], s55 offen offset:2048 sc1 lds
    v_mfma_f32_16x16x32_bf16 v[148:151], a[88:91], a[48:51], v[148:151]
    ds_read_b64_tr_b16 a[78:79], v9 offset:18432
    v_mfma_f32_16x16x32_bf16 v[156:159], a[88:91], a[56:59], v[156:159]
    v_add_u32 v6, s63, v6
    v_add_u32 v7, s63, v7
    v_mfma_f32_16x16x32_bf16 v[156:159], a[92:95], a[60:63], v[156:159]
    v_mfma_f32_16x16x32_bf16 v[152:155], a[84:87], a[60:63], v[152:155]
    buffer_load_dwordx4 v21, s[44:47], s55 offen offset:3072 sc1 lds
    v_mfma_f32_16x16x32_bf16 v[152:155], a[80:83], a[56:59], v[152:155]
    s_add_u32 s55, s55, s56
    v_mfma_f32_16x16x32_bf16 v[160:163], a[96:99], a[0:3], v[160:163]
    ds_read_b64_tr_b16 a[80:81], v10 offset:0
    v_mfma_f32_16x16x32_bf16 v[160:163], a[100:103], a[4:7], v[160:163]
    v_mfma_f32_16x16x32_bf16 v[164:167], a[108:111], a[4:7], v[164:167]
    v_mfma_f32_16x16x32_bf16 v[164:167], a[104:107], a[0:3], v[164:167]
    s_add_u32 m0, s61, 0
    ds_read_b64_tr_b16 a[82:83], v10 offset:2048
    v_mfma_f32_16x16x32_bf16 v[172:175], a[104:107], a[8:11], v[172:175]
    buffer_load_dwordx4 v16, s[40:43], s48 offen offset:0 sc1 lds
    v_mfma_f32_16x16x32_bf16 v[172:175], a[108:111], a[12:15], v[172:175]
    v_mfma_f32_16x16x32_bf16 v[168:171], a[100:103], a[12:15], v[168:171]
    ds_read_b64_tr_b16 a[84:85], v10 offset:16384
    v_mfma_f32_16x16x32_bf16 v[168:171], a[96:99], a[8:11], v[168:171]
    v_mfma_f32_16x16x32_bf16 v[176:179], a[96:99], a[16:19], v[176:179]
    v_mfma_f32_16x16x32_bf16 v[176:179], a[100:103], a[20:23], v[176:179]
    ds_read_b64_tr_b16 a[86:87], v10 offset:18432
    v_mfma_f32_16x16x32_bf16 v[180:183], a[108:111], a[20:23], v[180:183]
    v_mfma_f32_16x16x32_bf16 v[180:183], a[104:107], a[16:19], v[180:183]
    v_mfma_f32_16x16x32_bf16 v[188:191], a[104:107], a[24:27], v[188:191]
    buffer_load_dwordx4 v17, s[40:43], s48 offen offset:1024 sc1 lds
    v_mfma_f32_16x16x32_bf16 v[188:191], a[108:111], a[28:31], v[188:191]
    s_add_u32 s48, s48, 128
    ds_read_b64_tr_b16 a[88:89], v11 offset:0
    v_mfma_f32_16x16x32_bf16 v[184:187], a[100:103], a[28:31], v[184:187]
    v_mfma_f32_16x16x32_bf16 v[184:187], a[96:99], a[24:27], v[184:187]
    v_mfma_f32_16x16x32_bf16 v[192:195], a[96:99], a[32:35], v[192:195]
    v_mfma_f32_16x16x32_bf16 v[192:195], a[100:103], a[36:39], v[192:195]
    ds_read_b64_tr_b16 a[90:91], v11 offset:2048
    v_mfma_f32_16x16x32_bf16 v[196:199], a[108:111], a[36:39], v[196:199]
    v_mfma_f32_16x16x32_bf16 v[196:199], a[104:107], a[32:35], v[196:199]
    v_mfma_f32_16x16x32_bf16 v[204:207], a[104:107], a[40:43], v[204:207]
    buffer_load_dwordx4 v16, s[40:43], s49 offen offset:2048 sc1 lds
    v_mfma_f32_16x16x32_bf16 v[204:207], a[108:111], a[44:47], v[204:207]
    ds_read_b64_tr_b16 a[92:93], v11 offset:16384
    v_mfma_f32_16x16x32_bf16 v[200:203], a[100:103], a[44:47], v[200:203]
    v_mfma_f32_16x16x32_bf16 v[200:203], a[96:99], a[40:43], v[200:203]
    v_mfma_f32_16x16x32_bf16 v[208:211], a[96:99], a[48:51], v[208:211]
    v_mfma_f32_16x16x32_bf16 v[208:211], a[100:103], a[52:55], v[208:211]
    ds_read_b64_tr_b16 a[94:95], v11 offset:18432
    v_mfma_f32_16x16x32_bf16 v[212:215], a[108:111], a[52:55], v[212:215]
    v_mfma_f32_16x16x32_bf16 v[212:215], a[104:107], a[48:51], v[212:215]
    v_mfma_f32_16x16x32_bf16 v[220:223], a[104:107], a[56:59], v[220:223]
    buffer_load_dwordx4 v17, s[40:43], s49 offen offset:3072 sc1 lds
    v_mfma_f32_16x16x32_bf16 v[220:223], a[108:111], a[60:63], v[220:223]
    s_add_u32 s49, s49, 128
    v_mfma_f32_16x16x32_bf16 v[216:219], a[100:103], a[60:63], v[216:219]
    v_mfma_f32_16x16x32_bf16 v[216:219], a[96:99], a[56:59], v[216:219]
    v_mfma_f32_16x16x32_bf16 v[224:227], a[112:115], a[0:3], v[224:227]
    v_mfma_f32_16x16x32_bf16 v[224:227], a[116:119], a[4:7], v[224:227]
    ds_read_b64_tr_b16 a[96:97], v12 offset:0
    v_mfma_f32_16x16x32_bf16 v[228:231], a[124:127], a[4:7], v[228:231]
    v_mfma_f32_16x16x32_bf16 v[228:231], a[120:123], a[0:3], v[228:231]
    s_add_u32 m0, s61, 4096
    ds_read_b128 a[0:3], v6 offset:0
    v_mfma_f32_16x16x32_bf16 v[236:239], a[120:123], a[8:11], v[236:239]
    buffer_load_dwordx4 v16, s[40:43], s50 offen offset:0 sc1 lds
    v_mfma_f32_16x16x32_bf16 v[236:239], a[124:127], a[12:15], v[236:239]
    s_add_u32 s61, s61, 32768
    ds_read_b128 a[4:7], v7 offset:0
    v_mfma_f32_16x16x32_bf16 v[232:235], a[116:119], a[12:15], v[232:235]
    s_cmp_ge_u32 s61, 98304
    s_cselect_b32 s90, 98304, 0
    ds_read_b64_tr_b16 a[98:99], v12 offset:2048
    v_mfma_f32_16x16x32_bf16 v[232:235], a[112:115], a[8:11], v[232:235]
    s_sub_u32 s61, s61, s90
    ds_read_b128 a[8:11], v6 offset:2048
    v_mfma_f32_16x16x32_bf16 v[240:243], a[112:115], a[16:19], v[240:243]
    ds_read_b128 a[12:15], v7 offset:2048
    v_mfma_f32_16x16x32_bf16 v[240:243], a[116:119], a[20:23], v[240:243]
    ds_read_b64_tr_b16 a[100:101], v12 offset:16384
    v_mfma_f32_16x16x32_bf16 v[244:247], a[124:127], a[20:23], v[244:247]
    v_mfma_f32_16x16x32_bf16 v[244:247], a[120:123], a[16:19], v[244:247]
    ds_read_b128 a[16:19], v6 offset:4096
    v_mfma_f32_16x16x32_bf16 v[252:255], a[120:123], a[24:27], v[252:255]
    buffer_load_dwordx4 v17, s[40:43], s50 offen offset:1024 sc1 lds
    v_mfma_f32_16x16x32_bf16 v[252:255], a[124:127], a[28:31], v[252:255]
    s_add_u32 s50, s50, 128
    ds_read_b128 a[20:23], v7 offset:4096
    v_mfma_f32_16x16x32_bf16 v[248:251], a[116:119], a[28:31], v[248:251]
    ds_read_b64_tr_b16 a[102:103], v12 offset:18432
    v_mfma_f32_16x16x32_bf16 v[248:251], a[112:115], a[24:27], v[248:251]
    ds_read_b128 a[24:27], v6 offset:6144
    v_mfma_f32_16x16x32_bf16 a[224:227], a[112:115], a[32:35], a[224:227]
    s_sub_u32 s65, s65, 1
    ds_read_b128 a[28:31], v7 offset:6144
    v_mfma_f32_16x16x32_bf16 a[224:227], a[116:119], a[36:39], a[224:227]
    ds_read_b64_tr_b16 a[104:105], v13 offset:0
    v_mfma_f32_16x16x32_bf16 a[228:231], a[124:127], a[36:39], a[228:231]
    v_mfma_f32_16x16x32_bf16 a[228:231], a[120:123], a[32:35], a[228:231]
    ds_read_b128 a[32:35], v6 offset:8192
    v_mfma_f32_16x16x32_bf16 a[236:239], a[120:123], a[40:43], a[236:239]
    buffer_load_dwordx4 v16, s[40:43], s51 offen offset:2048 sc1 lds
    v_mfma_f32_16x16x32_bf16 a[236:239], a[124:127], a[44:47], a[236:239]
    ds_read_b128 a[36:39], v7 offset:8192
    v_mfma_f32_16x16x32_bf16 a[232:235], a[116:119], a[44:47], a[232:235]
    ds_read_b64_tr_b16 a[106:107], v13 offset:2048
    v_mfma_f32_16x16x32_bf16 a[232:235], a[112:115], a[40:43], a[232:235]
    ds_read_b128 a[40:43], v6 offset:10240
    v_mfma_f32_16x16x32_bf16 a[240:243], a[112:115], a[48:51], a[240:243]
    ds_read_b128 a[44:47], v7 offset:10240
    v_mfma_f32_16x16x32_bf16 a[240:243], a[116:119], a[52:55], a[240:243]
    ds_read_b64_tr_b16 a[108:109], v13 offset:16384
    v_mfma_f32_16x16x32_bf16 a[244:247], a[124:127], a[52:55], a[244:247]
    v_mfma_f32_16x16x32_bf16 a[244:247], a[120:123], a[48:51], a[244:247]
    ds_read_b128 a[48:51], v6 offset:12288
    v_mfma_f32_16x16x32_bf16 a[252:255], a[120:123], a[56:59], a[252:255]
    buffer_load_dwordx4 v17, s[40:43], s51 offen offset:3072 sc1 lds
    v_mfma_f32_16x16x32_bf16 a[252:255], a[124:127], a[60:63], a[252:255]
    s_add_u32 s51, s51, 128
    ds_read_b128 a[52:55], v7 offset:12288
    v_mfma_f32_16x16x32_bf16 a[248:251], a[116:119], a[60:63], a[248:251]
    s_cmp_gt_u32 s65, s67
    ds_read_b64_tr_b16 a[110:111], v13 offset:18432
    v_mfma_f32_16x16x32_bf16 a[248:251], a[112:115], a[56:59], a[248:251]
    ds_read_b128 a[56:59], v6 offset:14336
    ds_read_b128 a[60:63], v7 offset:14336
    s_cbranch_scc1 m_loop19
    s_cmp_lg_u32 s65, 0
    s_cbranch_scc1 m_dosw20
    s_branch m_epi15
m_swp16:
    s_waitcnt lgkmcnt(15)
    v_mfma_f32_16x16x32_bf16 v[32:35], a[0:3], a[64:67], 0
    ds_read_b64_tr_b16 a[112:113], v14 offset:0
    v_mfma_f32_16x16x32_bf16 v[32:35], a[4:7], a[68:71], v[32:35]
    ds_read_b64_tr_b16 a[114:115], v14 offset:2048
    v_mfma_f32_16x16x32_bf16 v[40:43], a[4:7], a[76:79], 0
    ds_read_b64_tr_b16 a[116:117], v14 offset:16384
    v_mfma_f32_16x16x32_bf16 v[40:43], a[0:3], a[72:75], v[40:43]
    ds_read_b64_tr_b16 a[118:119], v14 offset:18432
    v_mfma_f32_16x16x32_bf16 v[44:47], a[8:11], a[72:75], 0
    ds_read_b64_tr_b16 a[120:121], v15 offset:0
    v_mfma_f32_16x16x32_bf16 v[44:47], a[12:15], a[76:79], v[44:47]
    ds_read_b64_tr_b16 a[122:123], v15 offset:2048
    v_mfma_f32_16x16x32_bf16 v[36:39], a[12:15], a[68:71], 0
    ds_read_b64_tr_b16 a[124:125], v15 offset:16384
    v_mfma_f32_16x16x32_bf16 v[36:39], a[8:11], a[64:67], v[36:39]
    ds_read_b64_tr_b16 a[126:127], v15 offset:18432
    v_mfma_f32_16x16x32_bf16 v[96:99], a[16:19], a[64:67], 0
    v_mfma_f32_16x16x32_bf16 v[96:99], a[20:23], a[68:71], v[96:99]
    v_mfma_f32_16x16x32_bf16 v[104:107], a[20:23], a[76:79], 0
    buffer_store_dwordx4 a[128:131], v2, s[24:27], s28 offen sc1
    v_mfma_f32_16x16x32_bf16 v[104:107], a[16:19], a[72:75], v[104:107]
    s_add_u32 s28, s28, s31
    s_waitcnt lgkmcnt(15)
    v_mfma_f32_16x16x32_bf16 v[108:111], a[24:27], a[72:75], 0
    v_xor_b32 v8, s60, v8
    v_xor_b32 v9, s60, v9
    v_mfma_f32_16x16x32_bf16 v[108:111], a[28:31], a[76:79], v[108:111]
    v_xor_b32 v10, s60, v10
    v_xor_b32 v11, s60, v11
    v_mfma_f32_16x16x32_bf16 v[100:103], a[28:31], a[68:71], 0
    v_xor_b32 v12, s60, v12
    v_xor_b32 v13, s60, v13
    v_mfma_f32_16x16x32_bf16 v[100:103], a[24:27], a[64:67], v[100:103]
    v_xor_b32 v14, s60, v14
    v_xor_b32 v15, s60, v15
    v_mfma_f32_16x16x32_bf16 v[160:163], a[32:35], a[64:67], 0
    buffer_store_dwordx4 a[132:135], v2, s[24:27], s28 offen sc1
    v_mfma_f32_16x16x32_bf16 v[160:163], a[36:39], a[68:71], v[160:163]
    s_add_u32 s28, s28, s31
    v_mfma_f32_16x16x32_bf16 v[168:171], a[36:39], a[76:79], 0
    v_mfma_f32_16x16x32_bf16 v[168:171], a[32:35], a[72:75], v[168:171]
    s_waitcnt lgkmcnt(14)
    v_mfma_f32_16x16x32_bf16 v[172:175], a[40:43], a[72:75], 0
    v_mfma_f32_16x16x32_bf16 v[172:175], a[44:47], a[76:79], v[172:175]
    v_mfma_f32_16x16x32_bf16 v[164:167], a[44:47], a[68:71], 0
    buffer_store_dwordx4 a[136:139], v2, s[24:27], s28 offen sc1
    v_mfma_f32_16x16x32_bf16 v[164:167], a[40:43], a[64:67], v[164:167]
    s_add_u32 s28, s28, s31
    s_waitcnt lgkmcnt(11)
    v_mfma_f32_16x16x32_bf16 v[224:227], a[48:51], a[64:67], 0
    v_mfma_f32_16x16x32_bf16 v[224:227], a[52:55], a[68:71], v[224:227]
    v_mfma_f32_16x16x32_bf16 v[232:235], a[52:55], a[76:79], 0
    v_mfma_f32_16x16x32_bf16 v[232:235], a[48:51], a[72:75], v[232:235]
    s_waitcnt lgkmcnt(8)
    v_mfma_f32_16x16x32_bf16 v[236:239], a[56:59], a[72:75], 0
    buffer_store_dwordx4 a[140:143], v2, s[24:27], s28 offen sc1
    v_mfma_f32_16x16x32_bf16 v[236:239], a[60:63], a[76:79], v[236:239]
    s_add_u32 s28, s28, s31
    v_mfma_f32_16x16x32_bf16 v[228:231], a[60:63], a[68:71], 0
    s_waitcnt vmcnt(12) lgkmcnt(0)
    v_mfma_f32_16x16x32_bf16 v[228:231], a[56:59], a[64:67], v[228:231]
    s_barrier
    v_mfma_f32_16x16x32_bf16 v[48:51], a[0:3], a[80:83], 0
    ds_read_b64_tr_b16 a[64:65], v8 offset:0
    v_mfma_f32_16x16x32_bf16 v[48:51], a[4:7], a[84:87], v[48:51]
    s_add_u32 m0, s62, 0
    v_mfma_f32_16x16x32_bf16 v[56:59], a[4:7], a[92:95], 0
    buffer_load_dwordx4 v18, s[44:47], s52 offen offset:0 sc1 lds
    v_mfma_f32_16x16x32_bf16 v[56:59], a[0:3], a[88:91], v[56:59]
    ds_read_b64_tr_b16 a[66:67], v8 offset:2048
    v_mfma_f32_16x16x32_bf16 v[60:63], a[8:11], a[88:91], 0
    s_add_u32 s64, s64, 32768
    v_mfma_f32_16x16x32_bf16 v[60:63], a[12:15], a[92:95], v[60:63]
    s_cmp_ge_u32 s64, 98304
    s_cselect_b32 s63, 4294901760, s59
    s_cselect_b32 s64, 0, s64
    v_mfma_f32_16x16x32_bf16 v[52:55], a[12:15], a[84:87], 0
    buffer_load_dwordx4 v19, s[44:47], s52 offen offset:1024 sc1 lds
    v_mfma_f32_16x16x32_bf16 v[52:55], a[8:11], a[80:83], v[52:55]
    s_add_u32 s52, s52, s56
    ds_read_b64_tr_b16 a[68:69], v8 offset:16384
    v_mfma_f32_16x16x32_bf16 v[112:115], a[16:19], a[80:83], 0
    v_mfma_f32_16x16x32_bf16 v[112:115], a[20:23], a[84:87], v[112:115]
    v_mfma_f32_16x16x32_bf16 v[120:123], a[20:23], a[92:95], 0
    buffer_load_dwordx4 v18, s[44:47], s53 offen offset:2048 sc1 lds
    v_mfma_f32_16x16x32_bf16 v[120:123], a[16:19], a[88:91], v[120:123]
    ds_read_b64_tr_b16 a[70:71], v8 offset:18432
    v_mfma_f32_16x16x32_bf16 v[124:127], a[24:27], a[88:91], 0
    v_mfma_f32_16x16x32_bf16 v[124:127], a[28:31], a[92:95], v[124:127]
    v_mfma_f32_16x16x32_bf16 v[116:119], a[28:31], a[84:87], 0
    buffer_load_dwordx4 v19, s[44:47], s53 offen offset:3072 sc1 lds
    v_mfma_f32_16x16x32_bf16 v[116:119], a[24:27], a[80:83], v[116:119]
    s_add_u32 s53, s53, s56
    ds_read_b64_tr_b16 a[72:73], v9 offset:0
    v_mfma_f32_16x16x32_bf16 v[176:179], a[32:35], a[80:83], 0
    v_mfma_f32_16x16x32_bf16 v[176:179], a[36:39], a[84:87], v[176:179]
    s_add_u32 m0, s62, 4096
    v_mfma_f32_16x16x32_bf16 v[184:187], a[36:39], a[92:95], 0
    buffer_load_dwordx4 v20, s[44:47], s54 offen offset:0 sc1 lds
    v_mfma_f32_16x16x32_bf16 v[184:187], a[32:35], a[88:91], v[184:187]
    s_xor_b32 s62, s62, 229376
    ds_read_b64_tr_b16 a[74:75], v9 offset:2048
    v_mfma_f32_16x16x32_bf16 v[188:191], a[40:43], a[88:91], 0
    v_mfma_f32_16x16x32_bf16 v[188:191], a[44:47], a[92:95], v[188:191]
    v_mfma_f32_16x16x32_bf16 v[180:183], a[44:47], a[84:87], 0
    buffer_load_dwordx4 v21, s[44:47], s54 offen offset:1024 sc1 lds
    v_mfma_f32_16x16x32_bf16 v[180:183], a[40:43], a[80:83], v[180:183]
    s_add_u32 s54, s54, s56
    ds_read_b64_tr_b16 a[76:77], v9 offset:16384
    v_mfma_f32_16x16x32_bf16 v[240:243], a[48:51], a[80:83], 0
    v_mfma_f32_16x16x32_bf16 v[240:243], a[52:55], a[84:87], v[240:243]
    v_mfma_f32_16x16x32_bf16 v[248:251], a[52:55], a[92:95], 0
    buffer_load_dwordx4 v20, s[44:47], s55 offen offset:2048 sc1 lds
    v_mfma_f32_16x16x32_bf16 v[248:251], a[48:51], a[88:91], v[248:251]
    ds_read_b64_tr_b16 a[78:79], v9 offset:18432
    v_mfma_f32_16x16x32_bf16 v[252:255], a[56:59], a[88:91], 0
    v_add_u32 v6, s63, v6
    v_add_u32 v7, s63, v7
    v_mfma_f32_16x16x32_bf16 v[252:255], a[60:63], a[92:95], v[252:255]
    v_mfma_f32_16x16x32_bf16 v[244:247], a[60:63], a[84:87], 0
    buffer_load_dwordx4 v21, s[44:47], s55 offen offset:3072 sc1 lds
    v_mfma_f32_16x16x32_bf16 v[244:247], a[56:59], a[80:83], v[244:247]
    s_add_u32 s55, s55, s56
    v_mfma_f32_16x16x32_bf16 v[64:67], a[0:3], a[96:99], 0
    ds_read_b64_tr_b16 a[80:81], v10 offset:0
    v_mfma_f32_16x16x32_bf16 v[64:67], a[4:7], a[100:103], v[64:67]
    v_mfma_f32_16x16x32_bf16 v[72:75], a[4:7], a[108:111], 0
    v_mfma_f32_16x16x32_bf16 v[72:75], a[0:3], a[104:107], v[72:75]
    s_add_u32 m0, s61, 0
    ds_read_b64_tr_b16 a[82:83], v10 offset:2048
    v_mfma_f32_16x16x32_bf16 v[76:79], a[8:11], a[104:107], 0
    buffer_load_dwordx4 v16, s[40:43], s48 offen offset:0 sc1 lds
    v_mfma_f32_16x16x32_bf16 v[76:79], a[12:15], a[108:111], v[76:79]
    v_mfma_f32_16x16x32_bf16 v[68:71], a[12:15], a[100:103], 0
    ds_read_b64_tr_b16 a[84:85], v10 offset:16384
    v_mfma_f32_16x16x32_bf16 v[68:71], a[8:11], a[96:99], v[68:71]
    v_mfma_f32_16x16x32_bf16 v[128:131], a[16:19], a[96:99], 0
    buffer_store_dwordx4 a[144:147], v2, s[24:27], s28 offen sc1
    v_mfma_f32_16x16x32_bf16 v[128:131], a[20:23], a[100:103], v[128:131]
    s_add_u32 s28, s28, s31
    ds_read_b64_tr_b16 a[86:87], v10 offset:18432
    v_mfma_f32_16x16x32_bf16 v[136:139], a[20:23], a[108:111], 0
    v_mfma_f32_16x16x32_bf16 v[136:139], a[16:19], a[104:107], v[136:139]
    v_mfma_f32_16x16x32_bf16 v[140:143], a[24:27], a[104:107], 0
    buffer_load_dwordx4 v17, s[40:43], s48 offen offset:1024 sc1 lds
    v_mfma_f32_16x16x32_bf16 v[140:143], a[28:31], a[108:111], v[140:143]
    s_add_u32 s48, s48, 128
    ds_read_b64_tr_b16 a[88:89], v11 offset:0
    v_mfma_f32_16x16x32_bf16 v[132:135], a[28:31], a[100:103], 0
    v_mfma_f32_16x16x32_bf16 v[132:135], a[24:27], a[96:99], v[132:135]
    v_mfma_f32_16x16x32_bf16 v[192:195], a[32:35], a[96:99], 0
    buffer_store_dwordx4 a[148:151], v2, s[24:27], s28 offen sc1
    v_mfma_f32_16x16x32_bf16 v[192:195], a[36:39], a[100:103], v[192:195]
    s_add_u32 s28, s28, s31
    ds_read_b64_tr_b16 a[90:91], v11 offset:2048
    v_mfma_f32_16x16x32_bf16 v[200:203], a[36:39], a[108:111], 0
    v_mfma_f32_16x16x32_bf16 v[200:203], a[32:35], a[104:107], v[200:203]
    v_mfma_f32_16x16x32_bf16 v[204:207], a[40:43], a[104:107], 0
    buffer_load_dwordx4 v16, s[40:43], s49 offen offset:2048 sc1 lds
    v_mfma_f32_16x16x32_bf16 v[204:207], a[44:47], a[108:111], v[204:207]
    ds_read_b64_tr_b16 a[92:93], v11 offset:16384
    v_mfma_f32_16x16x32_bf16 v[196:199], a[44:47], a[100:103], 0
    v_mfma_f32_16x16x32_bf16 v[196:199], a[40:43], a[96:99], v[196:199]
    v_mfma_f32_16x16x32_bf16 a[224:227], a[48:51], a[96:99], 0
    buffer_store_dwordx4 a[152:155], v2, s[24:27], s28 offen sc1
    v_mfma_f32_16x16x32_bf16 a[224:227], a[52:55], a[100:103], a[224:227]
    s_add_u32 s28, s28, s31
    ds_read_b64_tr_b16 a[94:95], v11 offset:18432
    v_mfma_f32_16x16x32_bf16 a[232:235], a[52:55], a[108:111], 0
    v_mfma_f32_16x16x32_bf16 a[232:235], a[48:51], a[104:107], a[232:235]
    v_mfma_f32_16x16x32_bf16 a[236:239], a[56:59], a[104:107], 0
    buffer_load_dwordx4 v17, s[40:43], s49 offen offset:3072 sc1 lds
    v_mfma_f32_16x16x32_bf16 a[236:239], a[60:63], a[108:111], a[236:239]
    s_add_u32 s49, s49, 128
    v_mfma_f32_16x16x32_bf16 a[228:231], a[60:63], a[100:103], 0
    buffer_store_dwordx4 a[156:159], v2, s[24:27], s28 offen sc1
    v_mfma_f32_16x16x32_bf16 a[228:231], a[56:59], a[96:99], a[228:231]
    s_add_u32 s29, s29, s30
    s_mov_b32 s28, s29
    v_mfma_f32_16x16x32_bf16 v[80:83], a[0:3], a[112:115], 0
    v_mfma_f32_16x16x32_bf16 v[80:83], a[4:7], a[116:119], v[80:83]
    ds_read_b64_tr_b16 a[96:97], v12 offset:0
    v_mfma_f32_16x16x32_bf16 v[88:91], a[4:7], a[124:127], 0
    v_mfma_f32_16x16x32_bf16 v[88:91], a[0:3], a[120:123], v[88:91]
    s_add_u32 m0, s61, 4096
    ds_read_b128 a[0:3], v6 offset:0
    v_mfma_f32_16x16x32_bf16 v[92:95], a[8:11], a[120:123], 0
    buffer_load_dwordx4 v16, s[40:43], s50 offen offset:0 sc1 lds
    v_mfma_f32_16x16x32_bf16 v[92:95], a[12:15], a[124:127], v[92:95]
    s_add_u32 s61, s61, 32768
    ds_read_b128 a[4:7], v7 offset:0
    v_mfma_f32_16x16x32_bf16 v[84:87], a[12:15], a[116:119], 0
    s_cmp_ge_u32 s61, 98304
    s_cselect_b32 s90, 98304, 0
    ds_read_b64_tr_b16 a[98:99], v12 offset:2048
    v_mfma_f32_16x16x32_bf16 v[84:87], a[8:11], a[112:115], v[84:87]
    s_sub_u32 s61, s61, s90
    ds_read_b128 a[8:11], v6 offset:2048
    v_mfma_f32_16x16x32_bf16 v[144:147], a[16:19], a[112:115], 0
    ds_read_b128 a[12:15], v7 offset:2048
    v_mfma_f32_16x16x32_bf16 v[144:147], a[20:23], a[116:119], v[144:147]
    ds_read_b64_tr_b16 a[100:101], v12 offset:16384
    v_mfma_f32_16x16x32_bf16 v[152:155], a[20:23], a[124:127], 0
    v_mfma_f32_16x16x32_bf16 v[152:155], a[16:19], a[120:123], v[152:155]
    ds_read_b128 a[16:19], v6 offset:4096
    v_mfma_f32_16x16x32_bf16 v[156:159], a[24:27], a[120:123], 0
    buffer_load_dwordx4 v17, s[40:43], s50 offen offset:1024 sc1 lds
    v_mfma_f32_16x16x32_bf16 v[156:159], a[28:31], a[124:127], v[156:159]
    s_add_u32 s50, s50, 128
    ds_read_b128 a[20:23], v7 offset:4096
    v_mfma_f32_16x16x32_bf16 v[148:151], a[28:31], a[116:119], 0
    ds_read_b64_tr_b16 a[102:103], v12 offset:18432
    v_mfma_f32_16x16x32_bf16 v[148:151], a[24:27], a[112:115], v[148:151]
    ds_read_b128 a[24:27], v6 offset:6144
    v_mfma_f32_16x16x32_bf16 v[208:211], a[32:35], a[112:115], 0
    s_sub_u32 s65, s65, 1
    ds_read_b128 a[28:31], v7 offset:6144
    v_mfma_f32_16x16x32_bf16 v[208:211], a[36:39], a[116:119], v[208:211]
    ds_read_b64_tr_b16 a[104:105], v13 offset:0
    v_mfma_f32_16x16x32_bf16 v[216:219], a[36:39], a[124:127], 0
    v_mfma_f32_16x16x32_bf16 v[216:219], a[32:35], a[120:123], v[216:219]
    ds_read_b128 a[32:35], v6 offset:8192
    v_mfma_f32_16x16x32_bf16 v[220:223], a[40:43], a[120:123], 0
    buffer_load_dwordx4 v16, s[40:43], s51 offen offset:2048 sc1 lds
    v_mfma_f32_16x16x32_bf16 v[220:223], a[44:47], a[124:127], v[220:223]
    ds_read_b128 a[36:39], v7 offset:8192
    v_mfma_f32_16x16x32_bf16 v[212:215], a[44:47], a[116:119], 0
    ds_read_b64_tr_b16 a[106:107], v13 offset:2048
    v_mfma_f32_16x16x32_bf16 v[212:215], a[40:43], a[112:115], v[212:215]
    ds_read_b128 a[40:43], v6 offset:10240
    v_mfma_f32_16x16x32_bf16 a[240:243], a[48:51], a[112:115], 0
    ds_read_b128 a[44:47], v7 offset:10240
    v_mfma_f32_16x16x32_bf16 a[240:243], a[52:55], a[116:119], a[240:243]
    ds_read_b64_tr_b16 a[108:109], v13 offset:16384
    v_mfma_f32_16x16x32_bf16 a[248:251], a[52:55], a[124:127], 0
    v_mfma_f32_16x16x32_bf16 a[248:251], a[48:51], a[120:123], a[248:251]
    ds_read_b128 a[48:51], v6 offset:12288
    v_mfma_f32_16x16x32_bf16 a[252:255], a[56:59], a[120:123], 0
    buffer_load_dwordx4 v17, s[40:43], s51 offen offset:3072 sc1 lds
    v_mfma_f32_16x16x32_bf16 a[252:255], a[60:63], a[124:127], a[252:255]
    s_add_u32 s51, s51, 128
    ds_read_b128 a[52:55], v7 offset:12288
    v_mfma_f32_16x16x32_bf16 a[244:247], a[60:63], a[116:119], 0
    ds_read_b64_tr_b16 a[110:111], v13 offset:18432
    v_mfma_f32_16x16x32_bf16 a[244:247], a[56:59], a[112:115], a[244:247]
    ds_read_b128 a[56:59], v6 offset:14336
    ds_read_b128 a[60:63], v7 offset:14336
    s_waitcnt lgkmcnt(15)
    v_mfma_f32_16x16x32_bf16 v[32:35], a[0:3], a[64:67], v[32:35]
    ds_read_b64_tr_b16 a[112:113], v14 offset:0
    v_mfma_f32_16x16x32_bf16 v[32:35], a[4:7], a[68:71], v[32:35]
    ds_read_b64_tr_b16 a[114:115], v14 offset:2048
    v_mfma_f32_16x16x32_bf16 v[40:43], a[4:7], a[76:79], v[40:43]
    ds_read_b64_tr_b16 a[116:117], v14 offset:16384
    v_mfma_f32_16x16x32_bf16 v[40:43], a[0:3], a[72:75], v[40:43]
    ds_read_b64_tr_b16 a[118:119], v14 offset:18432
    v_mfma_f32_16x16x32_bf16 v[44:47], a[8:11], a[72:75], v[44:47]
    ds_read_b64_tr_b16 a[120:121], v15 offset:0
    v_mfma_f32_16x16x32_bf16 v[44:47], a[12:15], a[76:79], v[44:47]
    ds_read_b64_tr_b16 a[122:123], v15 offset:2048
    v_mfma_f32_16x16x32_bf16 v[36:39], a[12:15], a[68:71], v[36:39]
    ds_read_b64_tr_b16 a[124:125], v15 offset:16384
    v_mfma_f32_16x16x32_bf16 v[36:39], a[8:11], a[64:67], v[36:39]
    ds_read_b64_tr_b16 a[126:127], v15 offset:18432
    v_mfma_f32_16x16x32_bf16 v[96:99], a[16:19], a[64:67], v[96:99]
    v_mfma_f32_16x16x32_bf16 v[96:99], a[20:23], a[68:71], v[96:99]
    v_mfma_f32_16x16x32_bf16 v[104:107], a[20:23], a[76:79], v[104:107]
    buffer_store_dwordx4 a[160:163], v2, s[24:27], s28 offen sc1
    v_mfma_f32_16x16x32_bf16 v[104:107], a[16:19], a[72:75], v[104:107]
    s_add_u32 s28, s28, s31
    s_waitcnt lgkmcnt(15)
    v_mfma_f32_16x16x32_bf16 v[108:111], a[24:27], a[72:75], v[108:111]
    v_xor_b32 v8, s60, v8
    v_xor_b32 v9, s60, v9
    v_mfma_f32_16x16x32_bf16 v[108:111], a[28:31], a[76:79], v[108:111]
    v_xor_b32 v10, s60, v10
    v_xor_b32 v11, s60, v11
    v_mfma_f32_16x16x32_bf16 v[100:103], a[28:31], a[68:71], v[100:103]
    v_xor_b32 v12, s60, v12
    v_xor_b32 v13, s60, v13
    v_mfma_f32_16x16x32_bf16 v[100:103], a[24:27], a[64:67], v[100:103]
    v_xor_b32 v14, s60, v14
    v_xor_b32 v15, s60, v15
    v_mfma_f32_16x16x32_bf16 v[160:163], a[32:35], a[64:67], v[160:163]
    buffer_store_dwordx4 a[164:167], v2, s[24:27], s28 offen sc1
    v_mfma_f32_16x16x32_bf16 v[160:163], a[36:39], a[68:71], v[160:163]
    s_add_u32 s28, s28, s31
    v_mfma_f32_16x16x32_bf16 v[168:171], a[36:39], a[76:79], v[168:171]
    v_mfma_f32_16x16x32_bf16 v[168:171], a[32:35], a[72:75], v[168:171]
    s_waitcnt lgkmcnt(14)
    v_mfma_f32_16x16x32_bf16 v[172:175], a[40:43], a[72:75], v[172:175]
    v_mfma_f32_16x16x32_bf16 v[172:175], a[44:47], a[76:79], v[172:175]
    v_mfma_f32_16x16x32_bf16 v[164:167], a[44:47], a[68:71], v[164:167]
    buffer_store_dwordx4 a[168:171], v2, s[24:27], s28 offen sc1
    v_mfma_f32_16x16x32_bf16 v[164:167], a[40:43], a[64:67], v[164:167]
    s_add_u32 s28, s28, s31
    s_waitcnt lgkmcnt(11)
    v_mfma_f32_16x16x32_bf16 v[224:227], a[48:51], a[64:67], v[224:227]
    v_mfma_f32_16x16x32_bf16 v[224:227], a[52:55], a[68:71], v[224:227]
    v_mfma_f32_16x16x32_bf16 v[232:235], a[52:55], a[76:79], v[232:235]
    v_mfma_f32_16x16x32_bf16 v[232:235], a[48:51], a[72:75], v[232:235]
    s_waitcnt lgkmcnt(8)
    v_mfma_f32_16x16x32_bf16 v[236:239], a[56:59], a[72:75], v[236:239]
    buffer_store_dwordx4 a[172:175], v2, s[24:27], s28 offen sc1
    v_mfma_f32_16x16x32_bf16 v[236:239], a[60:63], a[76:79], v[236:239]
    s_add_u32 s28, s28, s31
    v_mfma_f32_16x16x32_bf16 v[228:231], a[60:63], a[68:71], v[228:231]
    s_waitcnt vmcnt(16) lgkmcnt(0)
    v_mfma_f32_16x16x32_bf16 v[228:231], a[56:59], a[64:67], v[228:231]
    s_barrier
    v_mfma_f32_16x16x32_bf16 v[48:51], a[0:3], a[80:83], v[48:51]
    ds_read_b64_tr_b16 a[64:65], v8 offset:0
    v_mfma_f32_16x16x32_bf16 v[48:51], a[4:7], a[84:87], v[48:51]
    s_add_u32 m0, s62, 0
    v_mfma_f32_16x16x32_bf16 v[56:59], a[4:7], a[92:95], v[56:59]
    buffer_load_dwordx4 v18, s[44:47], s52 offen offset:0 sc1 lds
    v_mfma_f32_16x16x32_bf16 v[56:59], a[0:3], a[88:91], v[56:59]
    ds_read_b64_tr_b16 a[66:67], v8 offset:2048
    v_mfma_f32_16x16x32_bf16 v[60:63], a[8:11], a[88:91], v[60:63]
    s_add_u32 s64, s64, 32768
    v_mfma_f32_16x16x32_bf16 v[60:63], a[12:15], a[92:95], v[60:63]
    s_cmp_ge_u32 s64, 98304
    s_cselect_b32 s63, 4294901760, s59
    s_cselect_b32 s64, 0, s64
    v_mfma_f32_16x16x32_bf16 v[52:55], a[12:15], a[84:87], v[52:55]
    buffer_load_dwordx4 v19, s[44:47], s52 offen offset:1024 sc1 lds
    v_mfma_f32_16x16x32_bf16 v[52:55], a[8:11], a[80:83], v[52:55]
    s_add_u32 s52, s52, s56
    ds_read_b64_tr_b16 a[68:69], v8 offset:16384
    v_mfma_f32_16x16x32_bf16 v[112:115], a[16:19], a[80:83], v[112:115]
    v_mfma_f32_16x16x32_bf16 v[112:115], a[20:23], a[84:87], v[112:115]
    v_mfma_f32_16x16x32_bf16 v[120:123], a[20:23], a[92:95], v[120:123]
    buffer_load_dwordx4 v18, s[44:47], s53 offen offset:2048 sc1 lds
    v_mfma_f32_16x16x32_bf16 v[120:123], a[16:19], a[88:91], v[120:123]
    ds_read_b64_tr_b16 a[70:71], v8 offset:18432
    v_mfma_f32_16x16x32_bf16 v[124:127], a[24:27], a[88:91], v[124:127]
    v_mfma_f32_16x16x32_bf16 v[124:127], a[28:31], a[92:95], v[124:127]
    v_mfma_f32_16x16x32_bf16 v[116:119], a[28:31], a[84:87], v[116:119]
    buffer_load_dwordx4 v19, s[44:47], s53 offen offset:3072 sc1 lds
    v_mfma_f32_16x16x32_bf16 v[116:119], a[24:27], a[80:83], v[116:119]
    s_add_u32 s53, s53, s56
    ds_read_b64_tr_b16 a[72:73], v9 offset:0
    v_mfma_f32_16x16x32_bf16 v[176:179], a[32:35], a[80:83], v[176:179]
    v_mfma_f32_16x16x32_bf16 v[176:179], a[36:39], a[84:87], v[176:179]
    s_add_u32 m0, s62, 4096
    v_mfma_f32_16x16x32_bf16 v[184:187], a[36:39], a[92:95], v[184:187]
    buffer_load_dwordx4 v20, s[44:47], s54 offen offset:0 sc1 lds
    v_mfma_f32_16x16x32_bf16 v[184:187], a[32:35], a[88:91], v[184:187]
    s_xor_b32 s62, s62, 229376
    ds_read_b64_tr_b16 a[74:75], v9 offset:2048
    v_mfma_f32_16x16x32_bf16 v[188:191], a[40:43], a[88:91], v[188:191]
    v_mfma_f32_16x16x32_bf16 v[188:191], a[44:47], a[92:95], v[188:191]
    v_mfma_f32_16x16x32_bf16 v[180:183], a[44:47], a[84:87], v[180:183]
    buffer_load_dwordx4 v21, s[44:47], s54 offen offset:1024 sc1 lds
    v_mfma_f32_16x16x32_bf16 v[180:183], a[40:43], a[80:83], v[180:183]
    s_add_u32 s54, s54, s56
    ds_read_b64_tr_b16 a[76:77], v9 offset:16384
    v_mfma_f32_16x16x32_bf16 v[240:243], a[48:51], a[80:83], v[240:243]
    v_mfma_f32_16x16x32_bf16 v[240:243], a[52:55], a[84:87], v[240:243]
    v_mfma_f32_16x16x32_bf16 v[248:251], a[52:55], a[92:95], v[248:251]
    buffer_load_dwordx4 v20, s[44:47], s55 offen offset:2048 sc1 lds
    v_mfma_f32_16x16x32_bf16 v[248:251], a[48:51], a[88:91], v[248:251]
    ds_read_b64_tr_b16 a[78:79], v9 offset:18432
    v_mfma_f32_16x16x32_bf16 v[252:255], a[56:59], a[88:91], v[252:255]
    v_add_u32 v6, s63, v6
    v_add_u32 v7, s63, v7
    v_mfma_f32_16x16x32_bf16 v[252:255], a[60:63], a[92:95], v[252:255]
    v_mfma_f32_16x16x32_bf16 v[244:247], a[60:63], a[84:87], v[244:247]
    buffer_load_dwordx4 v21, s[44:47], s55 offen offset:3072 sc1 lds
    v_mfma_f32_16x16x32_bf16 v[244:247], a[56:59], a[80:83], v[244:247]
    s_add_u32 s55, s55, s56
    v_mfma_f32_16x16x32_bf16 v[64:67], a[0:3], a[96:99], v[64:67]
    ds_read_b64_tr_b16 a[80:81], v10 offset:0
    v_mfma_f32_16x16x32_bf16 v[64:67], a[4:7], a[100:103], v[64:67]
    v_mfma_f32_16x16x32_bf16 v[72:75], a[4:7], a[108:111], v[72:75]
    v_mfma_f32_16x16x32_bf16 v[72:75], a[0:3], a[104:107], v[72:75]
    s_add_u32 m0, s61, 0
    ds_read_b64_tr_b16 a[82:83], v10 offset:2048
    v_mfma_f32_16x16x32_bf16 v[76:79], a[8:11], a[104:107], v[76:79]
    buffer_load_dwordx4 v16, s[40:43], s48 offen offset:0 sc1 lds
    v_mfma_f32_16x16x32_bf16 v[76:79], a[12:15], a[108:111], v[76:79]
    v_mfma_f32_16x16x32_bf16 v[68:71], a[12:15], a[100:103], v[68:71]
    ds_read_b64_tr_b16 a[84:85], v10 offset:16384
    v_mfma_f32_16x16x32_bf16 v[68:71], a[8:11], a[96:99], v[68:71]
    v_mfma_f32_16x16x32_bf16 v[128:131], a[16:19], a[96:99], v[128:131]
    buffer_store_dwordx4 a[176:179], v2, s[24:27], s28 offen sc1
    v_mfma_f32_16x16x32_bf16 v[128:131], a[20:23], a[100:103], v[128:131]
    s_add_u32 s28, s28, s31
    ds_read_b64_tr_b16 a[86:87], v10 offset:18432
    v_mfma_f32_16x16x32_bf16 v[136:139], a[20:23], a[108:111], v[136:139]
    v_mfma_f32_16x16x32_bf16 v[136:139], a[16:19], a[104:107], v[136:139]
    v_mfma_f32_16x16x32_bf16 v[140:143], a[24:27], a[104:107], v[140:143]
    buffer_load_dwordx4 v17, s[40:43], s48 offen offset:1024 sc1 lds
    v_mfma_f32_16x16x32_bf16 v[140:143], a[28:31], a[108:111], v[140:143]
    s_add_u32 s48, s48, 128
    ds_read_b64_tr_b16 a[88:89], v11 offset:0
    v_mfma_f32_16x16x32_bf16 v[132:135], a[28:31], a[100:103], v[132:135]
    v_mfma_f32_16x16x32_bf16 v[132:135], a[24:27], a[96:99], v[132:135]
    v_mfma_f32_16x16x32_bf16 v[192:195], a[32:35], a[96:99], v[192:195]
    buffer_store_dwordx4 a[180:183], v2, s[24:27], s28 offen sc1
    v_mfma_f32_16x16x32_bf16 v[192:195], a[36:39], a[100:103], v[192:195]
    s_add_u32 s28, s28, s31
    ds_read_b64_tr_b16 a[90:91], v11 offset:2048
    v_mfma_f32_16x16x32_bf16 v[200:203], a[36:39], a[108:111], v[200:203]
    v_mfma_f32_16x16x32_bf16 v[200:203], a[32:35], a[104:107], v[200:203]
    v_mfma_f32_16x16x32_bf16 v[204:207], a[40:43], a[104:107], v[204:207]
    buffer_load_dwordx4 v16, s[40:43], s49 offen offset:2048 sc1 lds
    v_mfma_f32_16x16x32_bf16 v[204:207], a[44:47], a[108:111], v[204:207]
    ds_read_b64_tr_b16 a[92:93], v11 offset:16384
    v_mfma_f32_16x16x32_bf16 v[196:199], a[44:47], a[100:103], v[196:199]
    v_mfma_f32_16x16x32_bf16 v[196:199], a[40:43], a[96:99], v[196:199]
    v_mfma_f32_16x16x32_bf16 a[224:227], a[48:51], a[96:99], a[224:227]
    buffer_store_dwordx4 a[184:187], v2, s[24:27], s28 offen sc1
    v_mfma_f32_16x16x32_bf16 a[224:227], a[52:55], a[100:103], a[224:227]
    s_add_u32 s28, s28, s31
    ds_read_b64_tr_b16 a[94:95], v11 offset:18432
    v_mfma_f32_16x16x32_bf16 a[232:235], a[52:55], a[108:111], a[232:235]
    v_mfma_f32_16x16x32_bf16 a[232:235], a[48:51], a[104:107], a[232:235]
    v_mfma_f32_16x16x32_bf16 a[236:239], a[56:59], a[104:107], a[236:239]
    buffer_load_dwordx4 v17, s[40:43], s49 offen offset:3072 sc1 lds
    v_mfma_f32_16x16x32_bf16 a[236:239], a[60:63], a[108:111], a[236:239]
    s_add_u32 s49, s49, 128
    v_mfma_f32_16x16x32_bf16 a[228:231], a[60:63], a[100:103], a[228:231]
    buffer_store_dwordx4 a[188:191], v2, s[24:27], s28 offen sc1
    v_mfma_f32_16x16x32_bf16 a[228:231], a[56:59], a[96:99], a[228:231]
    s_add_u32 s29, s29, s30
    s_mov_b32 s28, s29
    v_mfma_f32_16x16x32_bf16 v[80:83], a[0:3], a[112:115], v[80:83]
    v_mfma_f32_16x16x32_bf16 v[80:83], a[4:7], a[116:119], v[80:83]
    ds_read_b64_tr_b16 a[96:97], v12 offset:0
    v_mfma_f32_16x16x32_bf16 v[88:91], a[4:7], a[124:127], v[88:91]
    v_mfma_f32_16x16x32_bf16 v[88:91], a[0:3], a[120:123], v[88:91]
    s_add_u32 m0, s61, 4096
    ds_read_b128 a[0:3], v6 offset:0
    v_mfma_f32_16x16x32_bf16 v[92:95], a[8:11], a[120:123], v[92:95]
    buffer_load_dwordx4 v16, s[40:43], s50 offen offset:0 sc1 lds
    v_mfma_f32_16x16x32_bf16 v[92:95], a[12:15], a[124:127], v[92:95]
    s_add_u32 s61, s61, 32768
    ds_read_b128 a[4:7], v7 offset:0
    v_mfma_f32_16x16x32_bf16 v[84:87], a[12:15], a[116:119], v[84:87]
    s_cmp_ge_u32 s61, 98304
    s_cselect_b32 s90, 98304, 0
    ds_read_b64_tr_b16 a[98:99], v12 offset:2048
    v_mfma_f32_16x16x32_bf16 v[84:87], a[8:11], a[112:115], v[84:87]
    s_sub_u32 s61, s61, s90
    ds_read_b128 a[8:11], v6 offset:2048
    v_mfma_f32_16x16x32_bf16 v[144:147], a[16:19], a[112:115], v[144:147]
    ds_read_b128 a[12:15], v7 offset:2048
    v_mfma_f32_16x16x32_bf16 v[144:147], a[20:23], a[116:119], v[144:147]
    ds_read_b64_tr_b16 a[100:101], v12 offset:16384
    v_mfma_f32_16x16x32_bf16 v[152:155], a[20:23], a[124:127], v[152:155]
    v_mfma_f32_16x16x32_bf16 v[152:155], a[16:19], a[120:123], v[152:155]
    ds_read_b128 a[16:19], v6 offset:4096
    v_mfma_f32_16x16x32_bf16 v[156:159], a[24:27], a[120:123], v[156:159]
    buffer_load_dwordx4 v17, s[40:43], s50 offen offset:1024 sc1 lds
    v_mfma_f32_16x16x32_bf16 v[156:159], a[28:31], a[124:127], v[156:159]
    s_add_u32 s50, s50, 128
    ds_read_b128 a[20:23], v7 offset:4096
    v_mfma_f32_16x16x32_bf16 v[148:151], a[28:31], a[116:119], v[148:151]
    ds_read_b64_tr_b16 a[102:103], v12 offset:18432
    v_mfma_f32_16x16x32_bf16 v[148:151], a[24:27], a[112:115], v[148:151]
    ds_read_b128 a[24:27], v6 offset:6144
    v_mfma_f32_16x16x32_bf16 v[208:211], a[32:35], a[112:115], v[208:211]
    s_sub_u32 s65, s65, 1
    ds_read_b128 a[28:31], v7 offset:6144
    v_mfma_f32_16x16x32_bf16 v[208:211], a[36:39], a[116:119], v[208:211]
    ds_read_b64_tr_b16 a[104:105], v13 offset:0
    v_mfma_f32_16x16x32_bf16 v[216:219], a[36:39], a[124:127], v[216:219]
    v_mfma_f32_16x16x32_bf16 v[216:219], a[32:35], a[120:123], v[216:219]
    ds_read_b128 a[32:35], v6 offset:8192
    v_mfma_f32_16x16x32_bf16 v[220:223], a[40:43], a[120:123], v[220:223]
    buffer_load_dwordx4 v16, s[40:43], s51 offen offset:2048 sc1 lds
    v_mfma_f32_16x16x32_bf16 v[220:223], a[44:47], a[124:127], v[220:223]
    ds_read_b128 a[36:39], v7 offset:8192
    v_mfma_f32_16x16x32_bf16 v[212:215], a[44:47], a[116:119], v[212:215]
    ds_read_b64_tr_b16 a[106:107], v13 offset:2048
    v_mfma_f32_16x16x32_bf16 v[212:215], a[40:43], a[112:115], v[212:215]
    ds_read_b128 a[40:43], v6 offset:10240
    v_mfma_f32_16x16x32_bf16 a[240:243], a[48:51], a[112:115], a[240:243]
    ds_read_b128 a[44:47], v7 offset:10240
    v_mfma_f32_16x16x32_bf16 a[240:243], a[52:55], a[116:119], a[240:243]
    ds_read_b64_tr_b16 a[108:109], v13 offset:16384
    v_mfma_f32_16x16x32_bf16 a[248:251], a[52:55], a[124:127], a[248:251]
    v_mfma_f32_16x16x32_bf16 a[248:251], a[48:51], a[120:123], a[248:251]
    ds_read_b128 a[48:51], v6 offset:12288
    v_mfma_f32_16x16x32_bf16 a[252:255], a[56:59], a[120:123], a[252:255]
    buffer_load_dwordx4 v17, s[40:43], s51 offen offset:3072 sc1 lds
    v_mfma_f32_16x16x32_bf16 a[252:255], a[60:63], a[124:127], a[252:255]
    s_add_u32 s51, s51, 128
    ds_read_b128 a[52:55], v7 offset:12288
    v_mfma_f32_16x16x32_bf16 a[244:247], a[60:63], a[116:119], a[244:247]
    ds_read_b64_tr_b16 a[110:111], v13 offset:18432
    v_mfma_f32_16x16x32_bf16 a[244:247], a[56:59], a[112:115], a[244:247]
    ds_read_b128 a[56:59], v6 offset:14336
    ds_read_b128 a[60:63], v7 offset:14336
    s_cmp_eq_u32 s66, 2
    s_cbranch_scc1 m_hook21
m_hookr22:
    s_waitcnt lgkmcnt(15)
    v_mfma_f32_16x16x32_bf16 v[32:35], a[0:3], a[64:67], v[32:35]
    ds_read_b64_tr_b16 a[112:113], v14 offset:0
    v_mfma_f32_16x16x32_bf16 v[32:35], a[4:7], a[68:71], v[32:35]
    ds_read_b64_tr_b16 a[114:115], v14 offset:2048
    v_mfma_f32_16x16x32_bf16 v[40:43], a[4:7], a[76:79], v[40:43]
    ds_read_b64_tr_b16 a[116:117], v14 offset:16384
    v_mfma_f32_16x16x32_bf16 v[40:43], a[0:3], a[72:75], v[40:43]
    ds_read_b64_tr_b16 a[118:119], v14 offset:18432
    v_mfma_f32_16x16x32_bf16 v[44:47], a[8:11], a[72:75], v[44:47]
    ds_read_b64_tr_b16 a[120:121], v15 offset:0
    v_mfma_f32_16x16x32_bf16 v[44:47], a[12:15], a[76:79], v[44:47]
    ds_read_b64_tr_b16 a[122:123], v15 offset:2048
    v_mfma_f32_16x16x32_bf16 v[36:39], a[12:15], a[68:71], v[36:39]
    ds_read_b64_tr_b16 a[124:125], v15 offset:16384
    v_mfma_f32_16x16x32_bf16 v[36:39], a[8:11], a[64:67], v[36:39]
    ds_read_b64_tr_b16 a[126:127], v15 offset:18432
    v_mfma_f32_16x16x32_bf16 v[96:99], a[16:19], a[64:67], v[96:99]
    v_mfma_f32_16x16x32_bf16 v[96:99], a[20:23], a[68:71], v[96:99]
    v_mfma_f32_16x16x32_bf16 v[104:107], a[20:23], a[76:79], v[104:107]
    buffer_store_dwordx4 a[192:195], v2, s[24:27], s28 offen sc1
    v_mfma_f32_16x16x32_bf16 v[104:107], a[16:19], a[72:75], v[104:107]
    s_add_u32 s28, s28, s31
    s_waitcnt lgkmcnt(15)
    v_mfma_f32_16x16x32_bf16 v[108:111], a[24:27], a[72:75], v[108:111]
    v_xor_b32 v8, s60, v8
    v_xor_b32 v9, s60, v9
    v_mfma_f32_16x16x32_bf16 v[108:111], a[28:31], a[76:79], v[108:111]
    v_xor_b32 v10, s60, v10
    v_xor_b32 v11, s60, v11
    v_mfma_f32_16x16x32_bf16 v[100:103], a[28:31], a[68:71], v[100:103]
    v_xor_b32 v12, s60, v12
    v_xor_b32 v13, s60, v13
    v_mfma_f32_16x16x32_bf16 v[100:103], a[24:27], a[64:67], v[100:103]
    v_xor_b32 v14, s60, v14
    v_xor_b32 v15, s60, v15
    v_mfma_f32_16x16x32_bf16 v[160:163], a[32:35], a[64:67], v[160:163]
    buffer_store_dwordx4 a[196:199], v2, s[24:27], s28 offen sc1
    v_mfma_f32_16x16x32_bf16 v[160:163], a[36:39], a[68:71], v[160:163]
    s_add_u32 s28, s28, s31
    v_mfma_f32_16x16x32_bf16 v[168:171], a[36:39], a[76:79], v[168:171]
    v_mfma_f32_16x16x32_bf16 v[168:171], a[32:35], a[72:75], v[168:171]
    s_waitcnt lgkmcnt(14)
    v_mfma_f32_16x16x32_bf16 v[172:175], a[40:43], a[72:75], v[172:175]
    v_mfma_f32_16x16x32_bf16 v[172:175], a[44:47], a[76:79], v[172:175]
    v_mfma_f32_16x16x32_bf16 v[164:167], a[44:47], a[68:71], v[164:167]
    buffer_store_dwordx4 a[200:203], v2, s[24:27], s28 offen sc1
    v_mfma_f32_16x16x32_bf16 v[164:167], a[40:43], a[64:67], v[164:167]
    s_add_u32 s28, s28, s31
    s_waitcnt lgkmcnt(11)
    v_mfma_f32_16x16x32_bf16 v[224:227], a[48:51], a[64:67], v[224:227]
    v_mfma_f32_16x16x32_bf16 v[224:227], a[52:55], a[68:71], v[224:227]
    v_mfma_f32_16x16x32_bf16 v[232:235], a[52:55], a[76:79], v[232:235]
    v_mfma_f32_16x16x32_bf16 v[232:235], a[48:51], a[72:75], v[232:235]
    s_waitcnt lgkmcnt(8)
    v_mfma_f32_16x16x32_bf16 v[236:239], a[56:59], a[72:75], v[236:239]
    buffer_store_dwordx4 a[204:207], v2, s[24:27], s28 offen sc1
    v_mfma_f32_16x16x32_bf16 v[236:239], a[60:63], a[76:79], v[236:239]
    s_add_u32 s28, s28, s31
    v_mfma_f32_16x16x32_bf16 v[228:231], a[60:63], a[68:71], v[228:231]
    s_waitcnt vmcnt(16) lgkmcnt(0)
    v_mfma_f32_16x16x32_bf16 v[228:231], a[56:59], a[64:67], v[228:231]
    s_barrier
    v_mfma_f32_16x16x32_bf16 v[48:51], a[0:3], a[80:83], v[48:51]
    ds_read_b64_tr_b16 a[64:65], v8 offset:0
    v_mfma_f32_16x16x32_bf16 v[48:51], a[4:7], a[84:87], v[48:51]
    s_add_u32 m0, s62, 0
    v_mfma_f32_16x16x32_bf16 v[56:59], a[4:7], a[92:95], v[56:59]
    buffer_load_dwordx4 v18, s[44:47], s52 offen offset:0 sc1 lds
    v_mfma_f32_16x16x32_bf16 v[56:59], a[0:3], a[88:91], v[56:59]
    ds_read_b64_tr_b16 a[66:67], v8 offset:2048
    v_mfma_f32_16x16x32_bf16 v[60:63], a[8:11], a[88:91], v[60:63]
    s_add_u32 s64, s64, 32768
    v_mfma_f32_16x16x32_bf16 v[60:63], a[12:15], a[92:95], v[60:63]
    s_cmp_ge_u32 s64, 98304
    s_cselect_b32 s63, 4294901760, s59
    s_cselect_b32 s64, 0, s64
    v_mfma_f32_16x16x32_bf16 v[52:55], a[12:15], a[84:87], v[52:55]
    buffer_load_dwordx4 v19, s[44:47], s52 offen offset:1024 sc1 lds
    v_mfma_f32_16x16x32_bf16 v[52:55], a[8:11], a[80:83], v[52:55]
    s_add_u32 s52, s52, s56
    ds_read_b64_tr_b16 a[68:69], v8 offset:16384
    v_mfma_f32_16x16x32_bf16 v[112:115], a[16:19], a[80:83], v[112:115]
    v_mfma_f32_16x16x32_bf16 v[112:115], a[20:23], a[84:87], v[112:115]
    v_mfma_f32_16x16x32_bf16 v[120:123], a[20:23], a[92:95], v[120:123]
    buffer_load_dwordx4 v18, s[44:47], s53 offen offset:2048 sc1 lds
    v_mfma_f32_16x16x32_bf16 v[120:123], a[16:19], a[88:91], v[120:123]
    ds_read_b64_tr_b16 a[70:71], v8 offset:18432
    v_mfma_f32_16x16x32_bf16 v[124:127], a[24:27], a[88:91], v[124:127]
    v_mfma_f32_16x16x32_bf16 v[124:127], a[28:31], a[92:95], v[124:127]
    v_mfma_f32_16x16x32_bf16 v[116:119], a[28:31], a[84:87], v[116:119]
    buffer_load_dwordx4 v19, s[44:47], s53 offen offset:3072 sc1 lds
    v_mfma_f32_16x16x32_bf16 v[116:119], a[24:27], a[80:83], v[116:119]
    s_add_u32 s53, s53, s56
    ds_read_b64_tr_b16 a[72:73], v9 offset:0
    v_mfma_f32_16x16x32_bf16 v[176:179], a[32:35], a[80:83], v[176:179]
    v_mfma_f32_16x16x32_bf16 v[176:179], a[36:39], a[84:87], v[176:179]
    s_add_u32 m0, s62, 4096
    v_mfma_f32_16x16x32_bf16 v[184:187], a[36:39], a[92:95], v[184:187]
    buffer_load_dwordx4 v20, s[44:47], s54 offen offset:0 sc1 lds
    v_mfma_f32_16x16x32_bf16 v[184:187], a[32:35], a[88:91], v[184:187]
    s_xor_b32 s62, s62, 229376
    ds_read_b64_tr_b16 a[74:75], v9 offset:2048
    v_mfma_f32_16x16x32_bf16 v[188:191], a[40:43], a[88:91], v[188:191]
    v_mfma_f32_16x16x32_bf16 v[188:191], a[44:47], a[92:95], v[188:191]
    v_mfma_f32_16x16x32_bf16 v[180:183], a[44:47], a[84:87], v[180:183]
    buffer_load_dwordx4 v21, s[44:47], s54 offen offset:1024 sc1 lds
    v_mfma_f32_16x16x32_bf16 v[180:183], a[40:43], a[80:83], v[180:183]
    s_add_u32 s54, s54, s56
    ds_read_b64_tr_b16 a[76:77], v9 offset:16384
    v_mfma_f32_16x16x32_bf16 v[240:243], a[48:51], a[80:83], v[240:243]
    v_mfma_f32_16x16x32_bf16 v[240:243], a[52:55], a[84:87], v[240:243]
    v_mfma_f32_16x16x32_bf16 v[248:251], a[52:55], a[92:95], v[248:251]
    buffer_load_dwordx4 v20, s[44:47], s55 offen offset:2048 sc1 lds
    v_mfma_f32_16x16x32_bf16 v[248:251], a[48:51], a[88:91], v[248:251]
    ds_read_b64_tr_b16 a[78:79], v9 offset:18432
    v_mfma_f32_16x16x32_bf16 v[252:255], a[56:59], a[88:91], v[252:255]
    v_add_u32 v6, s63, v6
    v_add_u32 v7, s63, v7
    v_mfma_f32_16x16x32_bf16 v[252:255], a[60:63], a[92:95], v[252:255]
    v_mfma_f32_16x16x32_bf16 v[244:247], a[60:63], a[84:87], v[244:247]
    buffer_load_dwordx4 v21, s[44:47], s55 offen offset:3072 sc1 lds
    v_mfma_f32_16x16x32_bf16 v[244:247], a[56:59], a[80:83], v[244:247]
    s_add_u32 s55, s55, s56
    v_mfma_f32_16x16x32_bf16 v[64:67], a[0:3], a[96:99], v[64:67]
    ds_read_b64_tr_b16 a[80:81], v10 offset:0
    v_mfma_f32_16x16x32_bf16 v[64:67], a[4:7], a[100:103], v[64:67]
    v_mfma_f32_16x16x32_bf16 v[72:75], a[4:7], a[108:111], v[72:75]
    v_mfma_f32_16x16x32_bf16 v[72:75], a[0:3], a[104:107], v[72:75]
    s_add_u32 m0, s61, 0
    ds_read_b64_tr_b16 a[82:83], v10 offset:2048
    v_mfma_f32_16x16x32_bf16 v[76:79], a[8:11], a[104:107], v[76:79]
    buffer_load_dwordx4 v16, s[40:43], s48 offen offset:0 sc1 lds
    v_mfma_f32_16x16x32_bf16 v[76:79], a[12:15], a[108:111], v[76:79]
    v_mfma_f32_16x16x32_bf16 v[68:71], a[12:15], a[100:103], v[68:71]
    ds_read_b64_tr_b16 a[84:85], v10 offset:16384
    v_mfma_f32_16x16x32_bf16 v[68:71], a[8:11], a[96:99], v[68:71]
    v_mfma_f32_16x16x32_bf16 v[128:131], a[16:19], a[96:99], v[128:131]
    buffer_store_dwordx4 a[208:211], v2, s[24:27], s28 offen sc1
    v_mfma_f32_16x16x32_bf16 v[128:131], a[20:23], a[100:103], v[128:131]
    s_add_u32 s28, s28, s31
    ds_read_b64_tr_b16 a[86:87], v10 offset:18432
    v_mfma_f32_16x16x32_bf16 v[136:139], a[20:23], a[108:111], v[136:139]
    v_mfma_f32_16x16x32_bf16 v[136:139], a[16:19], a[104:107], v[136:139]
    v_mfma_f32_16x16x32_bf16 v[140:143], a[24:27], a[104:107], v[140:143]
    buffer_load_dwordx4 v17, s[40:43], s48 offen offset:1024 sc1 lds
    v_mfma_f32_16x16x32_bf16 v[140:143], a[28:31], a[108:111], v[140:143]
    s_add_u32 s48, s48, 128
    ds_read_b64_tr_b16 a[88:89], v11 offset:0
    v_mfma_f32_16x16x32_bf16 v[132:135], a[28:31], a[100:103], v[132:135]
    v_mfma_f32_16x16x32_bf16 v[132:135], a[24:27], a[96:99], v[132:135]
    v_mfma_f32_16x16x32_bf16 v[192:195], a[32:35], a[96:99], v[192:195]
    buffer_store_dwordx4 a[212:215], v2, s[24:27], s28 offen sc1
    v_mfma_f32_16x16x32_bf16 v[192:195], a[36:39], a[100:103], v[192:195]
    s_add_u32 s28, s28, s31
    ds_read_b64_tr_b16 a[90:91], v11 offset:2048
    v_mfma_f32_16x16x32_bf16 v[200:203], a[36:39], a[108:111], v[200:203]
    v_mfma_f32_16x16x32_bf16 v[200:203], a[32:35], a[104:107], v[200:203]
    v_mfma_f32_16x16x32_bf16 v[204:207], a[40:43], a[104:107], v[204:207]
    buffer_load_dwordx4 v16, s[40:43], s49 offen offset:2048 sc1 lds
    v_mfma_f32_16x16x32_bf16 v[204:207], a[44:47], a[108:111], v[204:207]
    ds_read_b64_tr_b16 a[92:93], v11 offset:16384
    v_mfma_f32_16x16x32_bf16 v[196:199], a[44:47], a[100:103], v[196:199]
    v_mfma_f32_16x16x32_bf16 v[196:199], a[40:43], a[96:99], v[196:199]
    v_mfma_f32_16x16x32_bf16 a[224:227], a[48:51], a[96:99], a[224:227]
    buffer_store_dwordx4 a[216:219], v2, s[24:27], s28 offen sc1
    v_mfma_f32_16x16x32_bf16 a[224:227], a[52:55], a[100:103], a[224:227]
    s_add_u32 s28, s28, s31
    ds_read_b64_tr_b16 a[94:95], v11 offset:18432
    v_mfma_f32_16x16x32_bf16 a[232:235], a[52:55], a[108:111], a[232:235]
    v_mfma_f32_16x16x32_bf16 a[232:235], a[48:51], a[104:107], a[232:235]
    v_mfma_f32_16x16x32_bf16 a[236:239], a[56:59], a[104:107], a[236:239]
    buffer_load_dwordx4 v17, s[40:43], s49 offen offset:3072 sc1 lds
    v_mfma_f32_16x16x32_bf16 a[236:239], a[60:63], a[108:111], a[236:239]
    s_add_u32 s49, s49, 128
    v_mfma_f32_16x16x32_bf16 a[228:231], a[60:63], a[100:103], a[228:231]
    buffer_store_dwordx4 a[220:223], v2, s[24:27], s28 offen sc1
    v_mfma_f32_16x16x32_bf16 a[228:231], a[56:59], a[96:99], a[228:231]
    s_add_u32 s29, s29, s30
    s_mov_b32 s28, s29
    v_mfma_f32_16x16x32_bf16 v[80:83], a[0:3], a[112:115], v[80:83]
    v_mfma_f32_16x16x32_bf16 v[80:83], a[4:7], a[116:119], v[80:83]
    ds_read_b64_tr_b16 a[96:97], v12 offset:0
    v_mfma_f32_16x16x32_bf16 v[88:91], a[4:7], a[124:127], v[88:91]
    v_mfma_f32_16x16x32_bf16 v[88:91], a[0:3], a[120:123], v[88:91]
    s_add_u32 m0, s61, 4096
    ds_read_b128 a[0:3], v6 offset:0
    v_mfma_f32_16x16x32_bf16 v[92:95], a[8:11], a[120:123], v[92:95]
    buffer_load_dwordx4 v16, s[40:43], s50 offen offset:0 sc1 lds
    v_mfma_f32_16x16x32_bf16 v[92:95], a[12:15], a[124:127], v[92:95]
    s_add_u32 s61, s61, 32768
    ds_read_b128 a[4:7], v7 offset:0
    v_mfma_f32_16x16x32_bf16 v[84:87], a[12:15], a[116:119], v[84:87]
    s_cmp_ge_u32 s61, 98304
    s_cselect_b32 s90, 98304, 0
    ds_read_b64_tr_b16 a[98:99], v12 offset:2048
    v_mfma_f32_16x16x32_bf16 v[84:87], a[8:11], a[112:115], v[84:87]
    s_sub_u32 s61, s61, s90
    ds_read_b128 a[8:11], v6 offset:2048
    v_mfma_f32_16x16x32_bf16 v[144:147], a[16:19], a[112:115], v[144:147]
    ds_read_b128 a[12:15], v7 offset:2048
    v_mfma_f32_16x16x32_bf16 v[144:147], a[20:23], a[116:119], v[144:147]
    ds_read_b64_tr_b16 a[100:101], v12 offset:16384
    v_mfma_f32_16x16x32_bf16 v[152:155], a[20:23], a[124:127], v[152:155]
    v_mfma_f32_16x16x32_bf16 v[152:155], a[16:19], a[120:123], v[152:155]
    ds_read_b128 a[16:19], v6 offset:4096
    v_mfma_f32_16x16x32_bf16 v[156:159], a[24:27], a[120:123], v[156:159]
    buffer_load_dwordx4 v17, s[40:43], s50 offen offset:1024 sc1 lds
    v_mfma_f32_16x16x32_bf16 v[156:159], a[28:31], a[124:127], v[156:159]
    s_add_u32 s50, s50, 128
    ds_read_b128 a[20:23], v7 offset:4096
    v_mfma_f32_16x16x32_bf16 v[148:151], a[28:31], a[116:119], v[148:151]
    ds_read_b64_tr_b16 a[102:103], v12 offset:18432
    v_mfma_f32_16x16x32_bf16 v[148:151], a[24:27], a[112:115], v[148:151]
    ds_read_b128 a[24:27], v6 offset:6144
    v_mfma_f32_16x16x32_bf16 v[208:211], a[32:35], a[112:115], v[208:211]
    s_sub_u32 s65, s65, 1
    ds_read_b128 a[28:31], v7 offset:6144
    v_mfma_f32_16x16x32_bf16 v[208:211], a[36:39], a[116:119], v[208:211]
    ds_read_b64_tr_b16 a[104:105], v13 offset:0
    v_mfma_f32_16x16x32_bf16 v[216:219], a[36:39], a[124:127], v[216:219]
    v_mfma_f32_16x16x32_bf16 v[216:219], a[32:35], a[120:123], v[216:219]
    ds_read_b128 a[32:35], v6 offset:8192
    v_mfma_f32_16x16x32_bf16 v[220:223], a[40:43], a[120:123], v[220:223]
    buffer_load_dwordx4 v16, s[40:43], s51 offen offset:2048 sc1 lds
    v_mfma_f32_16x16x32_bf16 v[220:223], a[44:47], a[124:127], v[220:223]
    ds_read_b128 a[36:39], v7 offset:8192
    v_mfma_f32_16x16x32_bf16 v[212:215], a[44:47], a[116:119], v[212:215]
    ds_read_b64_tr_b16 a[106:107], v13 offset:2048
    v_mfma_f32_16x16x32_bf16 v[212:215], a[40:43], a[112:115], v[212:215]
    ds_read_b128 a[40:43], v6 offset:10240
    v_mfma_f32_16x16x32_bf16 a[240:243], a[48:51], a[112:115], a[240:243]
    ds_read_b128 a[44:47], v7 offset:10240
    v_mfma_f32_16x16x32_bf16 a[240:243], a[52:55], a[116:119], a[240:243]
    ds_read_b64_tr_b16 a[108:109], v13 offset:16384
    v_mfma_f32_16x16x32_bf16 a[248:251], a[52:55], a[124:127], a[248:251]
    v_mfma_f32_16x16x32_bf16 a[248:251], a[48:51], a[120:123], a[248:251]
    ds_read_b128 a[48:51], v6 offset:12288
    v_mfma_f32_16x16x32_bf16 a[252:255], a[56:59], a[120:123], a[252:255]
    buffer_load_dwordx4 v17, s[40:43], s51 offen offset:3072 sc1 lds
    v_mfma_f32_16x16x32_bf16 a[252:255], a[60:63], a[124:127], a[252:255]
    s_add_u32 s51, s51, 128
    ds_read_b128 a[52:55], v7 offset:12288
    v_mfma_f32_16x16x32_bf16 a[244:247], a[60:63], a[116:119], a[244:247]
    ds_read_b64_tr_b16 a[110:111], v13 offset:18432
    v_mfma_f32_16x16x32_bf16 a[244:247], a[56:59], a[112:115], a[244:247]
    ds_read_b128 a[56:59], v6 offset:14336
    ds_read_b128 a[60:63], v7 offset:14336
.p2align 3
m_loop23:
    s_waitcnt lgkmcnt(15)
    v_mfma_f32_16x16x32_bf16 v[32:35], a[0:3], a[64:67], v[32:35]
    ds_read_b64_tr_b16 a[112:113], v14 offset:0
    v_mfma_f32_16x16x32_bf16 v[32:35], a[4:7], a[68:71], v[32:35]
    ds_read_b64_tr_b16 a[114:115], v14 offset:2048
    v_mfma_f32_16x16x32_bf16 v[40:43], a[4:7], a[76:79], v[40:43]
    ds_read_b64_tr_b16 a[116:117], v14 offset:16384
    v_mfma_f32_16x16x32_bf16 v[40:43], a[0:3], a[72:75], v[40:43]
    ds_read_b64_tr_b16 a[118:119], v14 offset:18432
    v_mfma_f32_16x16x32_bf16 v[44:47], a[8:11], a[72:75], v[44:47]
    ds_read_b64_tr_b16 a[120:121], v15 offset:0
    v_mfma_f32_16x16x32_bf16 v[44:47], a[12:15], a[76:79], v[44:47]
    ds_read_b64_tr_b16 a[122:123], v15 offset:2048
    v_mfma_f32_16x16x32_bf16 v[36:39], a[12:15], a[68:71], v[36:39]
    ds_read_b64_tr_b16 a[124:125], v15 offset:16384
    v_mfma_f32_16x16x32_bf16 v[36:39], a[8:11], a[64:67], v[36:39]
    ds_read_b64_tr_b16 a[126:127], v15 offset:18432
    v_mfma_f32_16x16x32_bf16 v[96:99], a[16:19], a[64:67], v[96:99]
    v_mfma_f32_16x16x32_bf16 v[96:99], a[20:23], a[68:71], v[96:99]
    v_mfma_f32_16x16x32_bf16 v[104:107], a[20:23], a[76:79], v[104:107]
    v_mfma_f32_16x16x32_bf16 v[104:107], a[16:19], a[72:75], v[104:107]
    s_waitcnt lgkmcnt(15)
    v_mfma_f32_16x16x32_bf16 v[108:111], a[24:27], a[72:75], v[108:111]
    v_xor_b32 v8, s60, v8
    v_xor_b32 v9, s60, v9
    v_mfma_f32_16x16x32_bf16 v[108:111], a[28:31], a[76:79], v[108:111]
    v_xor_b32 v10, s60, v10
    v_xor_b32 v11, s60, v11
    v_mfma_f32_16x16x32_bf16 v[100:103], a[28:31], a[68:71], v[100:103]
    v_xor_b32 v12, s60, v12
    v_xor_b32 v13, s60, v13
    v_mfma_f32_16x16x32_bf16 v[100:103], a[24:27], a[64:67], v[100:103]
    v_xor_b32 v14, s60, v14
    v_xor_b32 v15, s60, v15
    v_mfma_f32_16x16x32_bf16 v[160:163], a[32:35], a[64:67], v[160:163]
    v_mfma_f32_16x16x32_bf16 v[160:163], a[36:39], a[68:71], v[160:163]
    v_mfma_f32_16x16x32_bf16 v[168:171], a[36:39], a[76:79], v[168:171]
    v_mfma_f32_16x16x32_bf16 v[168:171], a[32:35], a[72:75], v[168:171]
    s_waitcnt lgkmcnt(14)
    v_mfma_f32_16x16x32_bf16 v[172:175], a[40:43], a[72:75], v[172:175]
    v_mfma_f32_16x16x32_bf16 v[172:175], a[44:47], a[76:79], v[172:175]
    v_mfma_f32_16x16x32_bf16 v[164:167], a[44:47], a[68:71], v[164:167]
    v_mfma_f32_16x16x32_bf16 v[164:167], a[40:43], a[64:67], v[164:167]
    s_waitcnt lgkmcnt(11)
    v_mfma_f32_16x16x32_bf16 v[224:227], a[48:51], a[64:67], v[224:227]
    v_mfma_f32_16x16x32_bf16 v[224:227], a[52:55], a[68:71], v[224:227]
    v_mfma_f32_16x16x32_bf16 v[232:235], a[52:55], a[76:79], v[232:235]
    v_mfma_f32_16x16x32_bf16 v[232:235], a[48:51], a[72:75], v[232:235]
    s_waitcnt lgkmcnt(8)
    v_mfma_f32_16x16x32_bf16 v[236:239], a[56:59], a[72:75], v[236:239]
    v_mfma_f32_16x16x32_bf16 v[236:239], a[60:63], a[76:79], v[236:239]
    v_mfma_f32_16x16x32_bf16 v[228:231], a[60:63], a[68:71], v[228:231]
    s_waitcnt vmcnt(8) lgkmcnt(0)
    v_mfma_f32_16x16x32_bf16 v[228:231], a[56:59], a[64:67], v[228:231]
    s_barrier
    v_mfma_f32_16x16x32_bf16 v[48:51], a[0:3], a[80:83], v[48:51]
    ds_read_b64_tr_b16 a[64:65], v8 offset:0
    v_mfma_f32_16x16x32_bf16 v[48:51], a[4:7], a[84:87], v[48:51]
    s_add_u32 m0, s62, 0
    v_mfma_f32_16x16x32_bf16 v[56:59], a[4:7], a[92:95], v[56:59]
    buffer_load_dwordx4 v18, s[44:47], s52 offen offset:0 sc1 lds
    v_mfma_f32_16x16x32_bf16 v[56:59], a[0:3], a[88:91], v[56:59]
    ds_read_b64_tr_b16 a[66:67], v8 offset:2048
    v_mfma_f32_16x16x32_bf16 v[60:63], a[8:11], a[88:91], v[60:63]
    s_add_u32 s64, s64, 32768
    v_mfma_f32_16x16x32_bf16 v[60:63], a[12:15], a[92:95], v[60:63]
    s_cmp_ge_u32 s64, 98304
    s_cselect_b32 s63, 4294901760, s59
    s_cselect_b32 s64, 0, s64
    v_mfma_f32_16x16x32_bf16 v[52:55], a[12:15], a[84:87], v[52:55]
    buffer_load_dwordx4 v19, s[44:47], s52 offen offset:1024 sc1 lds
    v_mfma_f32_16x16x32_bf16 v[52:55], a[8:11], a[80:83], v[52:55]
    s_add_u32 s52, s52, s56
    ds_read_b64_tr_b16 a[68:69], v8 offset:16384
    v_mfma_f32_16x16x32_bf16 v[112:115], a[16:19], a[80:83], v[112:115]
    v_mfma_f32_16x16x32_bf16 v[112:115], a[20:23], a[84:87], v[112:115]
    v_mfma_f32_16x16x32_bf16 v[120:123], a[20:23], a[92:95], v[120:123]
    buffer_load_dwordx4 v18, s[44:47], s53 offen offset:2048 sc1 lds
    v_mfma_f32_16x16x32_bf16 v[120:123], a[16:19], a[88:91], v[120:123]
    ds_read_b64_tr_b16 a[70:71], v8 offset:18432
    v_mfma_f32_16x16x32_bf16 v[124:127], a[24:27], a[88:91], v[124:127]
    v_mfma_f32_16x16x32_bf16 v[124:127], a[28:31], a[92:95], v[124:127]
    v_mfma_f32_16x16x32_bf16 v[116:119], a[28:31], a[84:87], v[116:119]
    buffer_load_dwordx4 v19, s[44:47], s53 offen offset:3072 sc1 lds
    v_mfma_f32_16x16x32_bf16 v[116:119], a[24:27], a[80:83], v[116:119]
    s_add_u32 s53, s53, s56
    ds_read_b64_tr_b16 a[72:73], v9 offset:0
    v_mfma_f32_16x16x32_bf16 v[176:179], a[32:35], a[80:83], v[176:179]
    v_mfma_f32_16x16x32_bf16 v[176:179], a[36:39], a[84:87], v[176:179]
    s_add_u32 m0, s62, 4096
    v_mfma_f32_16x16x32_bf16 v[184:187], a[36:39], a[92:95], v[184:187]
    buffer_load_dwordx4 v20, s[44:47], s54 offen offset:0 sc1 lds
    v_mfma_f32_16x16x32_bf16 v[184:187], a[32:35], a[88:91], v[184:187]
    s_xor_b32 s62, s62, 229376
    ds_read_b64_tr_b16 a[74:75], v9 offset:2048
    v_mfma_f32_16x16x32_bf16 v[188:191], a[40:43], a[88:91], v[188:191]
    v_mfma_f32_16x16x32_bf16 v[188:191], a[44:47], a[92:95], v[188:191]
    v_mfma_f32_16x16x32_bf16 v[180:183], a[44:47], a[84:87], v[180:183]
    buffer_load_dwordx4 v21, s[44:47], s54 offen offset:1024 sc1 lds
    v_mfma_f32_16x16x32_bf16 v[180:183], a[40:43], a[80:83], v[180:183]
    s_add_u32 s54, s54, s56
    ds_read_b64_tr_b16 a[76:77], v9 offset:16384
    v_mfma_f32_16x16x32_bf16 v[240:243], a[48:51], a[80:83], v[240:243]
    v_mfma_f32_16x16x32_bf16 v[240:243], a[52:55], a[84:87], v[240:243]
    v_mfma_f32_16x16x32_bf16 v[248:251], a[52:55], a[92:95], v[248:251]
    buffer_load_dwordx4 v20, s[44:47], s55 offen offset:2048 sc1 lds
    v_mfma_f32_16x16x32_bf16 v[248:251], a[48:51], a[88:91], v[248:251]
    ds_read_b64_tr_b16 a[78:79], v9 offset:18432
    v_mfma_f32_16x16x32_bf16 v[252:255], a[56:59], a[88:91], v[252:255]
    v_add_u32 v6, s63, v6
    v_add_u32 v7, s63, v7
    v_mfma_f32_16x16x32_bf16 v[252:255], a[60:63], a[92:95], v[252:255]
    v_mfma_f32_16x16x32_bf16 v[244:247], a[60:63], a[84:87], v[244:247]
    buffer_load_dwordx4 v21, s[44:47], s55 offen offset:3072 sc1 lds
    v_mfma_f32_16x16x32_bf16 v[244:247], a[56:59], a[80:83], v[244:247]
    s_add_u32 s55, s55, s56
    v_mfma_f32_16x16x32_bf16 v[64:67], a[0:3], a[96:99], v[64:67]
    ds_read_b64_tr_b16 a[80:81], v10 offset:0
    v_mfma_f32_16x16x32_bf16 v[64:67], a[4:7], a[100:103], v[64:67]
    v_mfma_f32_16x16x32_bf16 v[72:75], a[4:7], a[108:111], v[72:75]
    v_mfma_f32_16x16x32_bf16 v[72:75], a[0:3], a[104:107], v[72:75]
    s_add_u32 m0, s61, 0
    ds_read_b64_tr_b16 a[82:83], v10 offset:2048
    v_mfma_f32_16x16x32_bf16 v[76:79], a[8:11], a[104:107], v[76:79]
    buffer_load_dwordx4 v16, s[40:43], s48 offen offset:0 sc1 lds
    v_mfma_f32_16x16x32_bf16 v[76:79], a[12:15], a[108:111], v[76:79]
    v_mfma_f32_16x16x32_bf16 v[68:71], a[12:15], a[100:103], v[68:71]
    ds_read_b64_tr_b16 a[84:85], v10 offset:16384
    v_mfma_f32_16x16x32_bf16 v[68:71], a[8:11], a[96:99], v[68:71]
    v_mfma_f32_16x16x32_bf16 v[128:131], a[16:19], a[96:99], v[128:131]
    v_mfma_f32_16x16x32_bf16 v[128:131], a[20:23], a[100:103], v[128:131]
    ds_read_b64_tr_b16 a[86:87], v10 offset:18432
    v_mfma_f32_16x16x32_bf16 v[136:139], a[20:23], a[108:111], v[136:139]
    v_mfma_f32_16x16x32_bf16 v[136:139], a[16:19], a[104:107], v[136:139]
    v_mfma_f32_16x16x32_bf16 v[140:143], a[24:27], a[104:107], v[140:143]
    buffer_load_dwordx4 v17, s[40:43], s48 offen offset:1024 sc1 lds
    v_mfma_f32_16x16x32_bf16 v[140:143], a[28:31], a[108:111], v[140:143]
    s_add_u32 s48, s48, 128
    ds_read_b64_tr_b16 a[88:89], v11 offset:0
    v_mfma_f32_16x16x32_bf16 v[132:135], a[28:31], a[100:103], v[132:135]
    v_mfma_f32_16x16x32_bf16 v[132:135], a[24:27], a[96:99], v[132:135]
    v_mfma_f32_16x16x32_bf16 v[192:195], a[32:35], a[96:99], v[192:195]
    v_mfma_f32_16x16x32_bf16 v[192:195], a[36:39], a[100:103], v[192:195]
    ds_read_b64_tr_b16 a[90:91], v11 offset:2048
    v_mfma_f32_16x16x32_bf16 v[200:203], a[36:39], a[108:111], v[200:203]
    v_mfma_f32_16x16x32_bf16 v[200:203], a[32:35], a[104:107], v[200:203]
    v_mfma_f32_16x16x32_bf16 v[204:207], a[40:43], a[104:107], v[204:207]
    buffer_load_dwordx4 v16, s[40:43], s49 offen offset:2048 sc1 lds
    v_mfma_f32_16x16x32_bf16 v[204:207], a[44:47], a[108:111], v[204:207]
    ds_read_b64_tr_b16 a[92:93], v11 offset:16384
    v_mfma_f32_16x16x32_bf16 v[196:199], a[44:47], a[100:103], v[196:199]
    v_mfma_f32_16x16x32_bf16 v[196:199], a[40:43], a[96:99], v[196:199]
    v_mfma_f32_16x16x32_bf16 a[224:227], a[48:51], a[96:99], a[224:227]
    v_mfma_f32_16x16x32_bf16 a[224:227], a[52:55], a[100:103], a[224:227]
    ds_read_b64_tr_b16 a[94:95], v11 offset:18432
    v_mfma_f32_16x16x32_bf16 a[232:235], a[52:55], a[108:111], a[232:235]
    v_mfma_f32_16x16x32_bf16 a[232:235], a[48:51], a[104:107], a[232:235]
    v_mfma_f32_16x16x32_bf16 a[236:239], a[56:59], a[104:107], a[236:239]
    buffer_load_dwordx4 v17, s[40:43], s49 offen offset:3072 sc1 lds
    v_mfma_f32_16x16x32_bf16 a[236:239], a[60:63], a[108:111], a[236:239]
    s_add_u32 s49, s49, 128
    v_mfma_f32_16x16x32_bf16 a[228:231], a[60:63], a[100:103], a[228:231]
    v_mfma_f32_16x16x32_bf16 a[228:231], a[56:59], a[96:99], a[228:231]
    v_mfma_f32_16x16x32_bf16 v[80:83], a[0:3], a[112:115], v[80:83]
    v_mfma_f32_16x16x32_bf16 v[80:83], a[4:7], a[116:119], v[80:83]
    ds_read_b64_tr_b16 a[96:97], v12 offset:0
    v_mfma_f32_16x16x32_bf16 v[88:91], a[4:7], a[124:127], v[88:91]
    v_mfma_f32_16x16x32_bf16 v[88:91], a[0:3], a[120:123], v[88:91]
    s_add_u32 m0, s61, 4096
    ds_read_b128 a[0:3], v6 offset:0
    v_mfma_f32_16x16x32_bf16 v[92:95], a[8:11], a[120:123], v[92:95]
    buffer_load_dwordx4 v16, s[40:43], s50 offen offset:0 sc1 lds
    v_mfma_f32_16x16x32_bf16 v[92:95], a[12:15], a[124:127], v[92:95]
    s_add_u32 s61, s61, 32768
    ds_read_b128 a[4:7], v7 offset:0
    v_mfma_f32_16x16x32_bf16 v[84:87], a[12:15], a[116:119], v[84:87]
    s_cmp_ge_u32 s61, 98304
    s_cselect_b32 s90, 98304, 0
    ds_read_b64_tr_b16 a[98:99], v12 offset:2048
    v_mfma_f32_16x16x32_bf16 v[84:87], a[8:11], a[112:115], v[84:87]
    s_sub_u32 s61, s61, s90
    ds_read_b128 a[8:11], v6 offset:2048
    v_mfma_f32_16x16x32_bf16 v[144:147], a[16:19], a[112:115], v[144:147]
    ds_read_b128 a[12:15], v7 offset:2048
    v_mfma_f32_16x16x32_bf16 v[144:147], a[20:23], a[116:119], v[144:147]
    ds_read_b64_tr_b16 a[100:101], v12 offset:16384
    v_mfma_f32_16x16x32_bf16 v[152:155], a[20:23], a[124:127], v[152:155]
    v_mfma_f32_16x16x32_bf16 v[152:155], a[16:19], a[120:123], v[152:155]
    ds_read_b128 a[16:19], v6 offset:4096
    v_mfma_f32_16x16x32_bf16 v[156:159], a[24:27], a[120:123], v[156:159]
    buffer_load_dwordx4 v17, s[40:43], s50 offen offset:1024 sc1 lds
    v_mfma_f32_16x16x32_bf16 v[156:159], a[28:31], a[124:127], v[156:159]
    s_add_u32 s50, s50, 128
    ds_read_b128 a[20:23], v7 offset:4096
    v_mfma_f32_16x16x32_bf16 v[148:151], a[28:31], a[116:119], v[148:151]
    ds_read_b64_tr_b16 a[102:103], v12 offset:18432
    v_mfma_f32_16x16x32_bf16 v[148:151], a[24:27], a[112:115], v[148:151]
    ds_read_b128 a[24:27], v6 offset:6144
    v_mfma_f32_16x16x32_bf16 v[208:211], a[32:35], a[112:115], v[208:211]
    s_sub_u32 s65, s65, 1
    ds_read_b128 a[28:31], v7 offset:6144
    v_mfma_f32_16x16x32_bf16 v[208:211], a[36:39], a[116:119], v[208:211]
    ds_read_b64_tr_b16 a[104:105], v13 offset:0
    v_mfma_f32_16x16x32_bf16 v[216:219], a[36:39], a[124:127], v[216:219]
    v_mfma_f32_16x16x32_bf16 v[216:219], a[32:35], a[120:123], v[216:219]
    ds_read_b128 a[32:35], v6 offset:8192
    v_mfma_f32_16x16x32_bf16 v[220:223], a[40:43], a[120:123], v[220:223]
    buffer_load_dwordx4 v16, s[40:43], s51 offen offset:2048 sc1 lds
    v_mfma_f32_16x16x32_bf16 v[220:223], a[44:47], a[124:127], v[220:223]
    ds_read_b128 a[36:39], v7 offset:8192
    v_mfma_f32_16x16x32_bf16 v[212:215], a[44:47], a[116:119], v[212:215]
    ds_read_b64_tr_b16 a[106:107], v13 offset:2048
    v_mfma_f32_16x16x32_bf16 v[212:215], a[40:43], a[112:115], v[212:215]
    ds_read_b128 a[40:43], v6 offset:10240
    v_mfma_f32_16x16x32_bf16 a[240:243], a[48:51], a[112:115], a[240:243]
    ds_read_b128 a[44:47], v7 offset:10240
    v_mfma_f32_16x16x32_bf16 a[240:243], a[52:55], a[116:119], a[240:243]
    ds_read_b64_tr_b16 a[108:109], v13 offset:16384
    v_mfma_f32_16x16x32_bf16 a[248:251], a[52:55], a[124:127], a[248:251]
    v_mfma_f32_16x16x32_bf16 a[248:251], a[48:51], a[120:123], a[248:251]
    ds_read_b128 a[48:51], v6 offset:12288
    v_mfma_f32_16x16x32_bf16 a[252:255], a[56:59], a[120:123], a[252:255]
    buffer_load_dwordx4 v17, s[40:43], s51 offen offset:3072 sc1 lds
    v_mfma_f32_16x16x32_bf16 a[252:255], a[60:63], a[124:127], a[252:255]
    s_add_u32 s51, s51, 128
    ds_read_b128 a[52:55], v7 offset:12288
    v_mfma_f32_16x16x32_bf16 a[244:247], a[60:63], a[116:119], a[244:247]
    s_cmp_gt_u32 s65, s67
    ds_read_b64_tr_b16 a[110:111], v13 offset:18432
    v_mfma_f32_16x16x32_bf16 a[244:247], a[56:59], a[112:115], a[244:247]
    ds_read_b128 a[56:59], v6 offset:14336
    ds_read_b128 a[60:63], v7 offset:14336
    s_cbranch_scc1 m_loop23
    s_cmp_lg_u32 s65, 0
    s_cbranch_scc1 m_dosw24
m_epi15:
    s_cmp_eq_u32 s94, 0
    s_cbranch_scc1 m_last27
    s_mov_b32 s3, 1048576
m_spin31:
    v_readfirstlane_b32 s4, v4
    v_readfirstlane_b32 s5, v5
    s_nop 3
    s_cmp_lg_u32 s4, 0
    s_cbranch_scc1 m_ok32
    s_sub_u32 s3, s3, 1
    s_cbranch_scc1 m_ok32
    s_sleep 32
    buffer_load_dwordx2 v[4:5], off, s[12:15], 0 sc1
    s_waitcnt vmcnt(0)
    s_branch m_spin31
m_ok32:
    s_cmp_ge_u32 s68, 16
    s_cbranch_scc1 m_q034
    s_call_b64 s[20:21], m_epf25
    s_mov_b32 s17, s101
    s_mov_b32 s66, 2
    s_branch m_q133
m_q034:
    s_call_b64 s[20:21], m_eps26
    s_mov_b32 s17, s101
    s_add_u32 s28, s98, s99
    s_mov_b32 s29, s28
    s_mov_b32 s30, s99
    s_mov_b32 s31, s100
    s_mov_b32 s26, 268435456
m_q133:
    s_mov_b32 s95, s82
    s_mov_b32 s96, s83
    s_mov_b32 s97, s84
    s_mov_b32 s98, s85
    s_mov_b32 s99, s86
    s_mov_b32 s100, s87
    s_mov_b32 s101, s88
    s_sub_u32 s67, s95, 5
    s_max_u32 s67, s67, 4
    s_mov_b32 s94, 0
    s_branch m_tile14
m_last27:
m_kvl30:
    s_waitcnt lgkmcnt(0)
    s_and_b32 s92, s2, 7
    s_lshl_b32 s92, s92, 2
    s_bfe_u32 s93, s2, 0x20003
    s_add_u32 s92, s92, s93
    s_lshr_b32 s93, s2, 5
    s_lshl_b32 s93, s93, 2
    s_or_b32 s93, s93, 0x40000
    s_mov_b32 s32, s92
    s_bfe_u32 s33, 4225681832, s93
    s_add_u32 s33, s33, 1
    s_bfe_u32 s34, 873473623, s93
    s_add_u32 s34, s34, 1
    s_lshl_b32 s60, s16, 12
    v_add_u32 v7, s60, v2
    s_lshl_b32 s90, s34, 2
    s_lshl_b32 s91, s33, 2
    s_lshl_b32 s26, s91, 13
    s_mov_b32 s30, s26
    s_sub_u32 s67, s90, 4
    s_add_u32 s67, s67, s16
    s_add_u32 s68, s67, 1
    s_mov_b32 s69, s90
    s_sub_u32 s70, s91, 4
    s_add_u32 s70, s70, s16
    s_add_u32 s71, s70, 1
    s_mov_b32 s72, s91
    s_cmp_lt_u32 s16, 2
    s_cselect_b32 s90, 2, 0
    s_sub_u32 s72, s72, s90
    s_mov_b32 s27, 0x20000
    s_mov_b32 s31, 0x20000
    s_lshl_b32 s82, s32, 19
    s_add_u32 s90, s82, 16777216
    s_add_u32 s24, s6, s90
    s_addc_u32 s25, s7, 0
    s_add_u32 s90, s82, 33554432
    s_add_u32 s28, s6, s90
    s_addc_u32 s29, s7, 0
    s_call_b64 s[20:21], m_epl63
    s_mov_b32 s17, s101
    s_mov_b32 s38, 268435456
m_init29:
    s_mov_b32 s56, 81920
    s_mov_b32 s57, 65536
    s_nop 1
    v_mov_b32 v9, 0xff800000
    s_mov_b32 s65, 1233125376
    s_lshl_b32 s91, s16, 1
    s_sub_u32 s91, s91, 8
    s_lshl_b32 s78, s33, 3
    s_add_u32 s78, s78, s91
    s_lshl_b32 s79, s34, 3
    s_add_u32 s79, s79, s91
    s_mov_b32 s36, s6
    s_mov_b32 s37, s7
    s_mov_b32 s39, 0x20000
    s_load_dwordx2 s[48:49], s[0:1], 64
    s_load_dwordx2 s[50:51], s[0:1], 16
    s_load_dwordx2 s[54:55], s[0:1], 72
    s_mov_b32 s47, 0x20000
    s_lshl_b32 s90, s99, 1
    s_add_u32 s98, s98, s90
    s_lshl_b32 s90, s100, 2
    s_add_u32 s40, s98, s90
    s_lshr_b32 s90, s32, 1
    s_lshl_b32 s90, s90, 7
    s_add_u32 s90, s90, 117444608
    s_lshr_b32 s91, s2, 6
    s_lshl_b32 s91, s91, 8
    s_add_u32 s91, s91, 117446592
    v_min_u32 v10, 31, v1
    v_lshlrev_b32 v10, 3, v10
    v_mov_b32 v11, s90
    v_mov_b32 v8, s91
    v_cmp_gt_u32 vcc, 8, v1
    s_nop 1
    v_cndmask_b32 v11, v8, v11, vcc
    v_add_u32 v10, v10, v11
    s_mov_b32 s58, 0
    v_mov_b32 v6, v2
    v_accvgpr_write_b32 a0, 0
    v_accvgpr_write_b32 a1, 0
    v_accvgpr_write_b32 a2, 0
    v_accvgpr_write_b32 a3, 0
    v_accvgpr_write_b32 a4, 0
    v_accvgpr_write_b32 a5, 0
    v_accvgpr_write_b32 a6, 0
    v_accvgpr_write_b32 a7, 0
    v_accvgpr_write_b32 a8, 0
    v_accvgpr_write_b32 a9, 0
    v_accvgpr_write_b32 a10, 0
    v_accvgpr_write_b32 a11, 0
    v_accvgpr_write_b32 a12, 0
    v_accvgpr_write_b32 a13, 0
    v_accvgpr_write_b32 a14, 0
    v_accvgpr_write_b32 a15, 0
    v_accvgpr_write_b32 a16, 0
    v_accvgpr_write_b32 a17, 0
    v_accvgpr_write_b32 a18, 0
    v_accvgpr_write_b32 a19, 0
    v_accvgpr_write_b32 a20, 0
    v_accvgpr_write_b32 a21, 0
    v_accvgpr_write_b32 a22, 0
    v_accvgpr_write_b32 a23, 0
    v_accvgpr_write_b32 a24, 0
    v_accvgpr_write_b32 a25, 0
    v_accvgpr_write_b32 a26, 0
    v_accvgpr_write_b32 a27, 0
    v_accvgpr_write_b32 a28, 0
    v_accvgpr_write_b32 a29, 0
    v_accvgpr_write_b32 a30, 0
    v_accvgpr_write_b32 a31, 0
    v_accvgpr_write_b32 a32, 0
    v_accvgpr_write_b32 a33, 0
    v_accvgpr_write_b32 a34, 0
    v_accvgpr_write_b32 a35, 0
    v_accvgpr_write_b32 a36, 0
    v_accvgpr_write_b32 a37, 0
    v_accvgpr_write_b32 a38, 0
    v_accvgpr_write_b32 a39, 0
    v_accvgpr_write_b32 a40, 0
    v_accvgpr_write_b32 a41, 0
    v_accvgpr_write_b32 a42, 0
    v_accvgpr_write_b32 a43, 0
    v_accvgpr_write_b32 a44, 0
    v_accvgpr_write_b32 a45, 0
    v_accvgpr_write_b32 a46, 0
    v_accvgpr_write_b32 a47, 0
    v_accvgpr_write_b32 a48, 0
    v_accvgpr_write_b32 a49, 0
    v_accvgpr_write_b32 a50, 0
    v_accvgpr_write_b32 a51, 0
    v_accvgpr_write_b32 a52, 0
    v_accvgpr_write_b32 a53, 0
    v_accvgpr_write_b32 a54, 0
    v_accvgpr_write_b32 a55, 0
    v_accvgpr_write_b32 a56, 0
    v_accvgpr_write_b32 a57, 0
    v_accvgpr_write_b32 a58, 0
    v_accvgpr_write_b32 a59, 0
    v_accvgpr_write_b32 a60, 0
    v_accvgpr_write_b32 a61, 0
    v_accvgpr_write_b32 a62, 0
    v_accvgpr_write_b32 a63, 0
    v_accvgpr_write_b32 a64, 0
    v_accvgpr_write_b32 a65, 0
    v_accvgpr_write_b32 a66, 0
    v_accvgpr_write_b32 a67, 0
    v_accvgpr_write_b32 a68, 0
    v_accvgpr_write_b32 a69, 0
    v_accvgpr_write_b32 a70, 0
    v_accvgpr_write_b32 a71, 0
    v_accvgpr_write_b32 a72, 0
    v_accvgpr_write_b32 a73, 0
    v_accvgpr_write_b32 a74, 0
    v_accvgpr_write_b32 a75, 0
    v_accvgpr_write_b32 a76, 0
    v_accvgpr_write_b32 a77, 0
    v_accvgpr_write_b32 a78, 0
    v_accvgpr_write_b32 a79, 0
    v_mov_b64 v[160:161], 0
    v_mov_b64 v[162:163], 0
    v_mov_b64 v[164:165], 0
    v_mov_b64 v[166:167], 0
    v_mov_b64 v[168:169], 0
    v_mov_b64 v[170:171], 0
    v_mov_b64 v[172:173], 0
    v_mov_b64 v[174:175], 0
    v_mov_b64 v[176:177], 0
    v_mov_b64 v[178:179], 0
    v_mov_b64 v[180:181], 0
    v_mov_b64 v[182:183], 0
    v_mov_b64 v[184:185], 0
    v_mov_b64 v[186:187], 0
    v_mov_b64 v[188:189], 0
    v_mov_b64 v[190:191], 0
    v_mov_b32 v12, 0
    v_mov_b32 v28, 0
    v_mov_b32 v44, 0x3f803f80
    v_mov_b32 v13, 0
    v_mov_b32 v32, 0
    v_mov_b32 v45, 0x3f803f80
    v_mov_b32 v14, 0
    v_mov_b32 v36, 0
    v_mov_b32 v46, 0x3f803f80
    v_mov_b32 v15, 0
    v_mov_b32 v40, 0
    v_mov_b32 v47, 0x3f803f80
    s_and_b32 s90, s2, 7
    s_lshl_b32 s90, s90, 4
    s_lshl_b32 s91, s16, 2
    s_add_u32 s80, s90, s91
    s_lshr_b32 s92, s2, 3
    s_lshl_b32 s92, s92, 17
    s_lshl_b32 s90, s80, 10
    s_add_u32 s90, s90, s92
    s_add_u32 s83, s90, 50331648
    s_add_u32 s84, s90, 54525952
    s_and_b32 s81, s80, 63
    s_cmp_eq_u32 s81, 0
    s_cselect_b32 s93, 0, 1024
    s_sub_u32 s85, s84, s93
    s_lshl_b32 s90, s80, 9
    s_add_u32 s90, s90, s92
    s_add_u32 s86, s90, 58720256
    s_sub_u32 s87, s86, s93
    s_add_u32 s88, s86, 65536
    s_add_u32 s89, s87, 65536
    v_and_b32 v48, 15, v1
    v_lshrrev_b32 v49, 4, v1
    v_lshlrev_b32 v49, 2, v49
    v_sub_u32 v48, v48, v49
    v_cmp_le_i32 vcc, 0, v48
    s_nop 1
    v_cndmask_b32 v16, v9, 0, vcc
    v_cmp_le_i32 vcc, 1, v48
    s_nop 1
    v_cndmask_b32 v17, v9, 0, vcc
    v_cmp_le_i32 vcc, 2, v48
    s_nop 1
    v_cndmask_b32 v18, v9, 0, vcc
    v_cmp_le_i32 vcc, 3, v48
    s_nop 1
    v_cndmask_b32 v19, v9, 0, vcc
    s_mov_b32 s62, 8945792
    s_mov_b32 s63, 0
    s_sub_u32 s90, s67, 1
    s_bitset1_b64 s[62:63], s90
    s_sub_u32 s90, s68, 1
    s_bitset1_b64 s[62:63], s90
    s_sub_u32 s90, s69, 1
    s_bitset1_b64 s[62:63], s90
    s_sub_u32 s90, s70, 1
    s_bitset1_b64 s[62:63], s90
    s_sub_u32 s90, s71, 1
    s_bitset1_b64 s[62:63], s90
    s_sub_u32 s90, s72, 1
    s_bitset1_b64 s[62:63], s90
    s_add_u32 s53, s69, 8
    s_sub_u32 s90, s53, 1
    s_bitset1_b64 s[62:63], s90
    s_mov_b32 s64, 0
    s_cmp_lg_u32 s64, s67
    s_cbranch_scc1 m_e69
    v_add_f32 v176, v176, v16
    v_mov_b32 v180, v9
    v_add_f32 v188, v188, v16
    v_add_f32 v177, v177, v17
    v_mov_b32 v181, v9
    v_add_f32 v189, v189, v17
    v_add_f32 v178, v178, v18
    v_mov_b32 v182, v9
    v_add_f32 v190, v190, v18
    v_add_f32 v179, v179, v19
    v_mov_b32 v183, v9
    v_add_f32 v191, v191, v19
    s_nop 0
m_e69:
    s_waitcnt vmcnt(32) lgkmcnt(0)
    s_barrier
    ds_read_b128 a[192:195], v6 offset:0
    ds_read_b128 a[196:199], v6 offset:1024
    ds_read_b128 a[200:203], v6 offset:2048
    ds_read_b128 a[204:207], v6 offset:3072
    ds_read_b128 a[208:211], v6 offset:4096
    ds_read_b128 a[212:215], v6 offset:5120
    ds_read_b128 a[216:219], v6 offset:6144
    ds_read_b128 a[220:223], v6 offset:7168
    s_waitcnt lgkmcnt(0)
    v_mfma_f32_16x16x32_bf16 v[64:67], a[192:195], a[128:131], v[160:163]
    v_accvgpr_write_b32 a80, 0
    v_accvgpr_write_b32 a81, 0
    v_mfma_f32_16x16x32_bf16 v[64:67], a[196:199], a[132:135], v[64:67]
    buffer_store_dwordx4 v[192:195], v2, s[36:39], s40 offen sc1
    s_add_u32 s40, s40, s100
    v_mfma_f32_16x16x32_bf16 v[64:67], a[200:203], a[136:139], v[64:67]
    v_accvgpr_write_b32 a82, 0
    v_accvgpr_write_b32 a83, 0
    v_mfma_f32_16x16x32_bf16 v[64:67], a[204:207], a[140:143], v[64:67]
    v_accvgpr_write_b32 a84, 0
    v_accvgpr_write_b32 a85, 0
    v_mfma_f32_16x16x32_bf16 v[72:75], a[204:207], a[156:159], v[168:171]
    v_accvgpr_write_b32 a86, 0
    v_accvgpr_write_b32 a87, 0
    v_mfma_f32_16x16x32_bf16 v[72:75], a[200:203], a[152:155], v[72:75]
    buffer_store_dwordx4 v[196:199], v2, s[36:39], s40 offen sc1
    s_add_u32 s40, s40, s100
    v_mfma_f32_16x16x32_bf16 v[72:75], a[196:199], a[148:151], v[72:75]
    v_accvgpr_write_b32 a88, 0
    v_accvgpr_write_b32 a89, 0
    v_mfma_f32_16x16x32_bf16 v[72:75], a[192:195], a[144:147], v[72:75]
    v_accvgpr_write_b32 a90, 0
    v_accvgpr_write_b32 a91, 0
    v_mfma_f32_16x16x32_bf16 v[80:83], a[192:195], a[160:163], v[176:179]
    v_accvgpr_write_b32 a92, 0
    v_accvgpr_write_b32 a93, 0
    v_mfma_f32_16x16x32_bf16 v[80:83], a[196:199], a[164:167], v[80:83]
    buffer_store_dwordx4 v[200:203], v2, s[36:39], s40 offen sc1
    s_add_u32 s40, s40, s100
    v_mfma_f32_16x16x32_bf16 v[80:83], a[200:203], a[168:171], v[80:83]
    v_accvgpr_write_b32 a94, 0
    v_accvgpr_write_b32 a95, 0
    v_mfma_f32_16x16x32_bf16 v[80:83], a[204:207], a[172:175], v[80:83]
    v_accvgpr_write_b32 a96, 0
    v_accvgpr_write_b32 a97, 0
    v_mfma_f32_16x16x32_bf16 v[88:91], a[204:207], a[188:191], v[184:187]
    v_accvgpr_write_b32 a98, 0
    v_accvgpr_write_b32 a99, 0
    v_mfma_f32_16x16x32_bf16 v[88:91], a[200:203], a[184:187], v[88:91]
    buffer_store_dwordx4 v[204:207], v2, s[36:39], s40 offen sc1
    s_add_u32 s40, s98, s99
    v_mfma_f32_16x16x32_bf16 v[88:91], a[196:199], a[180:183], v[88:91]
    v_accvgpr_write_b32 a100, 0
    v_accvgpr_write_b32 a101, 0
    v_mfma_f32_16x16x32_bf16 v[88:91], a[192:195], a[176:179], v[88:91]
    v_accvgpr_write_b32 a102, 0
    v_accvgpr_write_b32 a103, 0
    v_mfma_f32_16x16x32_bf16 v[92:95], a[208:211], a[176:179], v[188:191]
    ds_read_b128 a[192:195], v6 offset:8192
    v_accvgpr_write_b32 a104, 0
    v_accvgpr_write_b32 a105, 0
    v_mfma_f32_16x16x32_bf16 v[92:95], a[212:215], a[180:183], v[92:95]
    buffer_store_dwordx4 v[208:211], v2, s[36:39], s40 offen sc1
    s_add_u32 s40, s40, s100
    ds_read_b128 a[196:199], v6 offset:9216
    v_mfma_f32_16x16x32_bf16 v[92:95], a[216:219], a[184:187], v[92:95]
    ds_read_b128 a[200:203], v6 offset:10240
    v_accvgpr_write_b32 a106, 0
    v_accvgpr_write_b32 a107, 0
    v_mfma_f32_16x16x32_bf16 v[92:95], a[220:223], a[188:191], v[92:95]
    ds_read_b128 a[204:207], v6 offset:11264
    v_accvgpr_write_b32 a108, 0
    v_accvgpr_write_b32 a109, 0
    v_mfma_f32_16x16x32_bf16 v[84:87], a[220:223], a[172:175], v[180:183]
    v_accvgpr_write_b32 a110, 0
    v_accvgpr_write_b32 a111, 0
    v_mfma_f32_16x16x32_bf16 v[84:87], a[216:219], a[168:171], v[84:87]
    buffer_store_dwordx4 v[212:215], v2, s[36:39], s40 offen sc1
    s_add_u32 s40, s40, s100
    v_mfma_f32_16x16x32_bf16 v[84:87], a[212:215], a[164:167], v[84:87]
    v_accvgpr_write_b32 a112, 0
    v_accvgpr_write_b32 a113, 0
    v_mfma_f32_16x16x32_bf16 v[84:87], a[208:211], a[160:163], v[84:87]
    v_accvgpr_write_b32 a114, 0
    v_accvgpr_write_b32 a115, 0
    v_mfma_f32_16x16x32_bf16 v[76:79], a[208:211], a[144:147], v[172:175]
    v_accvgpr_write_b32 a116, 0
    v_accvgpr_write_b32 a117, 0
    v_mfma_f32_16x16x32_bf16 v[76:79], a[212:215], a[148:151], v[76:79]
    buffer_store_dwordx4 v[216:219], v2, s[36:39], s40 offen sc1
    s_add_u32 s40, s40, s100
    v_mfma_f32_16x16x32_bf16 v[76:79], a[216:219], a[152:155], v[76:79]
    v_accvgpr_write_b32 a118, 0
    v_accvgpr_write_b32 a119, 0
    v_mfma_f32_16x16x32_bf16 v[76:79], a[220:223], a[156:159], v[76:79]
    v_accvgpr_write_b32 a120, 0
    v_accvgpr_write_b32 a121, 0
    v_mfma_f32_16x16x32_bf16 v[68:71], a[220:223], a[140:143], v[164:167]
    v_accvgpr_write_b32 a122, 0
    v_accvgpr_write_b32 a123, 0
    v_mfma_f32_16x16x32_bf16 v[68:71], a[216:219], a[136:139], v[68:71]
    buffer_store_dwordx4 v[220:223], v2, s[36:39], s40 offen sc1
    s_add_u32 s40, s40, s100
    v_mfma_f32_16x16x32_bf16 v[68:71], a[212:215], a[132:135], v[68:71]
    v_accvgpr_write_b32 a124, 0
    v_accvgpr_write_b32 a125, 0
    v_mfma_f32_16x16x32_bf16 v[68:71], a[208:211], a[128:131], v[68:71]
    v_accvgpr_write_b32 a126, 0
    v_accvgpr_write_b32 a127, 0
    ds_read_b128 a[208:211], v6 offset:12288
    ds_read_b128 a[212:215], v6 offset:13312
    ds_read_b128 a[216:219], v6 offset:14336
    ds_read_b128 a[220:223], v6 offset:15360
    s_mov_b32 s64, 1
    s_nop 0
    s_nop 3
    v_max3_f32 v48, v64, v65, v66
    v_max3_f32 v49, v72, v73, v74
    v_max3_f32 v50, v80, v81, v82
    v_max3_f32 v51, v88, v89, v90
    v_max3_f32 v48, v48, v67, v68
    v_max3_f32 v49, v49, v75, v76
    v_max3_f32 v50, v50, v83, v84
    v_max3_f32 v51, v51, v91, v92
    v_max3_f32 v48, v48, v69, v70
    v_max3_f32 v49, v49, v77, v78
    v_max3_f32 v50, v50, v85, v86
    v_max3_f32 v51, v51, v93, v94
    v_max_f32 v48, v48, v71
    v_max_f32 v49, v49, v79
    v_max_f32 v50, v50, v87
    v_max_f32 v51, v51, v95
    v_mov_b32 v52, v48
    v_mov_b32 v53, v49
    v_mov_b32 v54, v50
    v_mov_b32 v55, v51
    s_nop 1
    v_permlane32_swap_b32 v48, v52
    v_permlane32_swap_b32 v49, v53
    v_permlane32_swap_b32 v50, v54
    v_permlane32_swap_b32 v51, v55
    s_nop 1
    v_max_f32 v48, v48, v52
    v_max_f32 v49, v49, v53
    v_max_f32 v50, v50, v54
    v_max_f32 v51, v51, v55
    v_mov_b32 v52, v48
    v_mov_b32 v53, v49
    v_mov_b32 v54, v50
    v_mov_b32 v55, v51
    s_nop 1
    v_permlane16_swap_b32 v48, v52
    v_permlane16_swap_b32 v49, v53
    v_permlane16_swap_b32 v50, v54
    v_permlane16_swap_b32 v51, v55
    s_nop 1
    v_max_f32 v48, v48, v52
    v_max_f32 v49, v49, v53
    v_max_f32 v50, v50, v54
    v_max_f32 v51, v51, v55
    v_sub_f32 v160, v160, v48
    v_sub_f32 v161, v161, v48
    v_sub_f32 v162, v162, v48
    v_sub_f32 v163, v163, v48
    v_sub_f32 v164, v164, v48
    v_sub_f32 v165, v165, v48
    v_sub_f32 v166, v166, v48
    v_sub_f32 v167, v167, v48
    v_sub_f32 v168, v168, v49
    v_sub_f32 v169, v169, v49
    v_sub_f32 v170, v170, v49
    v_sub_f32 v171, v171, v49
    v_sub_f32 v172, v172, v49
    v_sub_f32 v173, v173, v49
    v_sub_f32 v174, v174, v49
    v_sub_f32 v175, v175, v49
    v_sub_f32 v176, v176, v50
    v_sub_f32 v177, v177, v50
    v_sub_f32 v178, v178, v50
    v_sub_f32 v179, v179, v50
    v_sub_f32 v180, v180, v50
    v_sub_f32 v181, v181, v50
    v_sub_f32 v182, v182, v50
    v_sub_f32 v183, v183, v50
    v_sub_f32 v184, v184, v51
    v_sub_f32 v185, v185, v51
    v_sub_f32 v186, v186, v51
    v_sub_f32 v187, v187, v51
    v_sub_f32 v188, v188, v51
    v_sub_f32 v189, v189, v51
    v_sub_f32 v190, v190, v51
    v_sub_f32 v191, v191, v51
    v_sub_f32 v64, v64, v48
    v_sub_f32 v65, v65, v48
    v_sub_f32 v66, v66, v48
    v_sub_f32 v67, v67, v48
    v_sub_f32 v68, v68, v48
    v_sub_f32 v69, v69, v48
    v_sub_f32 v70, v70, v48
    v_sub_f32 v71, v71, v48
    v_sub_f32 v72, v72, v49
    v_sub_f32 v73, v73, v49
    v_sub_f32 v74, v74, v49
    v_sub_f32 v75, v75, v49
    v_sub_f32 v76, v76, v49
    v_sub_f32 v77, v77, v49
    v_sub_f32 v78, v78, v49
    v_sub_f32 v79, v79, v49
    v_sub_f32 v80, v80, v50
    v_sub_f32 v81, v81, v50
    v_sub_f32 v82, v82, v50
    v_sub_f32 v83, v83, v50
    v_sub_f32 v84, v84, v50
    v_sub_f32 v85, v85, v50
    v_sub_f32 v86, v86, v50
    v_sub_f32 v87, v87, v50
    v_sub_f32 v88, v88, v51
    v_sub_f32 v89, v89, v51
    v_sub_f32 v90, v90, v51
    v_sub_f32 v91, v91, v51
    v_sub_f32 v92, v92, v51
    v_sub_f32 v93, v93, v51
    v_sub_f32 v94, v94, v51
    v_sub_f32 v95, v95, v51
    s_cmp_lg_u32 s64, s67
    s_cbranch_scc1 m_e70
    v_add_f32 v176, v176, v16
    v_mov_b32 v180, v9
    v_add_f32 v188, v188, v16
    v_add_f32 v177, v177, v17
    v_mov_b32 v181, v9
    v_add_f32 v189, v189, v17
    v_add_f32 v178, v178, v18
    v_mov_b32 v182, v9
    v_add_f32 v190, v190, v18
    v_add_f32 v179, v179, v19
    v_mov_b32 v183, v9
    v_add_f32 v191, v191, v19
    s_nop 0
m_e70:
    s_cmp_lg_u32 s64, s68
    s_cbranch_scc1 m_e71
    v_mov_b32 v176, v9
    v_mov_b32 v184, v9
    v_mov_b32 v188, v9
    v_mov_b32 v177, v9
    v_mov_b32 v185, v9
    v_mov_b32 v189, v9
    v_mov_b32 v178, v9
    v_mov_b32 v186, v9
    v_mov_b32 v190, v9
    v_mov_b32 v179, v9
    v_mov_b32 v187, v9
    v_mov_b32 v191, v9
    s_nop 0
m_e71:
    s_waitcnt lgkmcnt(0)
    v_mfma_f32_16x16x32_bf16 v[96:99], a[192:195], a[128:131], v[160:163]
    s_bitcmp1_b64 s[62:63], s64
    s_cselect_b32 s66, -1.0, s65
    v_exp_f32 v20, v64
    v_mfma_f32_16x16x32_bf16 v[96:99], a[196:199], a[132:135], v[96:99]
    s_add_u32 s64, s64, 1
    v_exp_f32 v21, v65
    v_exp_f32 v22, v66
    v_mfma_f32_16x16x32_bf16 v[96:99], a[200:203], a[136:139], v[96:99]
    buffer_store_dwordx4 v[224:227], v2, s[36:39], s40 offen sc1
    v_cvt_pk_bf16_f32 v128, v20, v21
    v_mfma_f32_16x16x32_bf16 v[96:99], a[204:207], a[140:143], v[96:99]
    s_add_u32 s40, s40, s100
    v_add_f32 v12, v12, v28
    v_exp_f32 v23, v67
    v_mfma_f32_16x16x32_bf16 v[104:107], a[204:207], a[156:159], v[168:171]
    v_exp_f32 v24, v68
    v_cvt_pk_bf16_f32 v129, v22, v23
    v_mfma_f32_16x16x32_bf16 v[104:107], a[200:203], a[152:155], v[104:107]
    buffer_store_dwordx4 v[228:231], v2, s[36:39], s40 offen sc1
    v_exp_f32 v25, v69
    v_mfma_f32_16x16x32_bf16 v[104:107], a[196:199], a[148:151], v[104:107]
    s_add_u32 s40, s40, s100
    v_exp_f32 v26, v70
    v_cvt_pk_bf16_f32 v130, v24, v25
    v_mfma_f32_16x16x32_bf16 v[104:107], a[192:195], a[144:147], v[104:107]
    v_exp_f32 v27, v71
    v_add_f32 v13, v13, v32
    v_mfma_f32_16x16x32_bf16 v[112:115], a[192:195], a[160:163], v[176:179]
    v_exp_f32 v20, v72
    v_cvt_pk_bf16_f32 v131, v26, v27
    v_mfma_f32_16x16x32_bf16 v[112:115], a[196:199], a[164:167], v[112:115]
    buffer_store_dwordx4 v[232:235], v2, s[36:39], s40 offen sc1
    v_exp_f32 v21, v73
    v_mfma_f32_16x16x32_bf16 v[28:31], v[44:47], v[128:131], 0
    v_exp_f32 v22, v74
    v_cvt_pk_bf16_f32 v132, v20, v21
    v_mfma_f32_16x16x32_bf16 v[112:115], a[200:203], a[168:171], v[112:115]
    s_add_u32 s40, s40, s100
    v_exp_f32 v23, v75
    v_add_f32 v14, v14, v36
    v_mfma_f32_16x16x32_bf16 v[112:115], a[204:207], a[172:175], v[112:115]
    v_exp_f32 v24, v76
    v_cvt_pk_bf16_f32 v133, v22, v23
    v_mfma_f32_16x16x32_bf16 v[120:123], a[204:207], a[188:191], v[184:187]
    buffer_store_dwordx4 v[236:239], v2, s[36:39], s40 offen sc1
    v_exp_f32 v25, v77
    v_mfma_f32_16x16x32_bf16 v[120:123], a[200:203], a[184:187], v[120:123]
    s_mov_b32 s40, s98
    v_exp_f32 v26, v78
    v_cvt_pk_bf16_f32 v134, v24, v25
    v_mfma_f32_16x16x32_bf16 v[120:123], a[196:199], a[180:183], v[120:123]
    v_exp_f32 v27, v79
    v_add_f32 v15, v15, v40
    v_mfma_f32_16x16x32_bf16 v[120:123], a[192:195], a[176:179], v[120:123]
    s_waitcnt lgkmcnt(0)
    v_exp_f32 v20, v80
    v_cvt_pk_bf16_f32 v135, v26, v27
    v_mfma_f32_16x16x32_bf16 v[124:127], a[208:211], a[176:179], v[188:191]
    v_exp_f32 v21, v81
    v_exp_f32 v22, v82
    v_mfma_f32_16x16x32_bf16 v[32:35], v[44:47], v[132:135], 0
    v_cvt_pk_bf16_f32 v136, v20, v21
    v_exp_f32 v23, v83
    v_mfma_f32_16x16x32_bf16 v[124:127], a[212:215], a[180:183], v[124:127]
    buffer_store_dwordx4 v[240:243], v2, s[36:39], s40 offen sc1
    v_cvt_pk_bf16_f32 v137, v22, v23
    v_mfma_f32_16x16x32_bf16 v[124:127], a[216:219], a[184:187], v[124:127]
    s_add_u32 s40, s40, s100
    v_exp_f32 v24, v84
    v_mfma_f32_16x16x32_bf16 v[124:127], a[220:223], a[188:191], v[124:127]
    v_exp_f32 v25, v85
    v_exp_f32 v26, v86
    v_cvt_pk_bf16_f32 v138, v24, v25
    v_mfma_f32_16x16x32_bf16 v[116:119], a[220:223], a[172:175], v[180:183]
    buffer_store_dwordx4 v[244:247], v2, s[36:39], s40 offen sc1
    v_mfma_f32_16x16x32_bf16 v[116:119], a[216:219], a[168:171], v[116:119]
    s_add_u32 s40, s40, s100
    v_exp_f32 v27, v87
    v_exp_f32 v20, v88
    v_mfma_f32_16x16x32_bf16 v[116:119], a[212:215], a[164:167], v[116:119]
    v_cvt_pk_bf16_f32 v139, v26, v27
    v_exp_f32 v21, v89
    v_mfma_f32_16x16x32_bf16 v[116:119], a[208:211], a[160:163], v[116:119]
    buffer_store_dwordx4 v[248:251], v2, s[36:39], s40 offen sc1
    v_exp_f32 v22, v90
    v_mfma_f32_16x16x32_bf16 v[36:39], v[44:47], v[136:139], 0
    v_cvt_pk_bf16_f32 v140, v20, v21
    v_exp_f32 v23, v91
    v_mfma_f32_16x16x32_bf16 v[108:111], a[208:211], a[144:147], v[172:175]
    s_add_u32 s40, s40, s100
    v_exp_f32 v24, v92
    v_cvt_pk_bf16_f32 v141, v22, v23
    v_mfma_f32_16x16x32_bf16 v[108:111], a[212:215], a[148:151], v[108:111]
    v_exp_f32 v25, v93
    v_mfma_f32_16x16x32_bf16 v[108:111], a[216:219], a[152:155], v[108:111]
    buffer_store_dwordx4 v[252:255], v2, s[36:39], s40 offen sc1
    v_exp_f32 v26, v94
    v_cvt_pk_bf16_f32 v142, v24, v25
    v_mfma_f32_16x16x32_bf16 v[108:111], a[220:223], a[156:159], v[108:111]
    s_add_u32 s40, s40, s100
    v_exp_f32 v27, v95
    s_nop 0
    v_cvt_pk_bf16_f32 v143, v26, v27
    s_nop 1
    v_mfma_f32_16x16x32_bf16 v[40:43], v[44:47], v[140:143], 0
    s_nop 2
    v_mfma_f32_16x16x32_bf16 v[100:103], a[220:223], a[140:143], v[164:167]
    s_nop 2
    v_mfma_f32_16x16x32_bf16 v[100:103], a[216:219], a[136:139], v[100:103]
    v_max3_f32 v8, v28, v32, v36
    v_max_f32 v8, v8, v40
    v_mfma_f32_16x16x32_bf16 v[100:103], a[212:215], a[132:135], v[100:103]
    v_cmp_nge_f32 vcc, s66, v8
    v_mfma_f32_16x16x32_bf16 v[100:103], a[208:211], a[128:131], v[100:103]
    s_waitcnt vmcnt(48) lgkmcnt(0)
    s_barrier
    s_add_u32 s59, s58, s60
    s_add_u32 s58, s58, 32768
    s_cmp_ge_u32 s58, 163840
    s_cselect_b32 s58, 0, s58
    v_add_u32 v6, s58, v2
    ds_read_b128 a[192:195], v6 offset:0
    ds_read_b128 a[196:199], v6 offset:1024
    ds_read_b128 a[200:203], v6 offset:2048
    ds_read_b128 a[204:207], v6 offset:3072
    ds_read_b128 a[208:211], v6 offset:4096
    ds_read_b128 a[212:215], v6 offset:5120
    ds_read_b128 a[216:219], v6 offset:6144
    ds_read_b128 a[220:223], v6 offset:7168
    s_waitcnt lgkmcnt(0)
    s_cbranch_vccnz m_stub72
m_ret73:
.p2align 3
m_dual74:
    v_mfma_f32_16x16x32_bf16 v[64:67], a[192:195], a[128:131], v[160:163]
    s_bitcmp1_b64 s[62:63], s64
    s_cselect_b32 s66, -1.0, s65
    v_add_f32 v12, v12, v28
    v_mfma_f32_16x16x32_bf16 v[64:67], a[196:199], a[132:135], v[64:67]
    s_add_u32 s64, s64, 1
    ds_read_b128 a[224:227], v6 offset:16384
    v_add_f32 v13, v13, v32
    v_mfma_f32_16x16x32_bf16 v[64:67], a[200:203], a[136:139], v[64:67]
    v_exp_f32 v20, v96
    v_mfma_f32_16x16x32_bf16 v[64:67], a[204:207], a[140:143], v[64:67]
    v_exp_f32 v21, v97
    v_mfma_f32_16x16x32_bf16 v[72:75], a[204:207], a[156:159], v[168:171]
    s_mov_b32 m0, s59
    ds_read_b128 a[228:231], v6 offset:17408
    v_cvt_pk_bf16_f32 v144, v20, v21
    v_mfma_f32_16x16x32_bf16 v[72:75], a[200:203], a[152:155], v[72:75]
    buffer_load_dwordx4 v7, s[24:27], s56 offen offset:0 sc1 lds
    v_mfma_f32_16x16x32_bf16 v[72:75], a[196:199], a[148:151], v[72:75]
    v_exp_f32 v22, v98
    v_mfma_f32_16x16x32_bf16 v[72:75], a[192:195], a[144:147], v[72:75]
    ds_read_b128 a[232:235], v6 offset:18432
    v_add_f32 v14, v14, v36
    v_mfma_f32_16x16x32_bf16 v[80:83], a[192:195], a[160:163], v[176:179]
    v_exp_f32 v23, v99
    v_mfma_f32_16x16x32_bf16 v[80:83], a[196:199], a[164:167], v[80:83]
    v_exp_f32 v24, v100
    v_mfma_f32_16x16x32_bf16 v[80:83], a[200:203], a[168:171], v[80:83]
    ds_read_b128 a[236:239], v6 offset:19456
    v_cvt_pk_bf16_f32 v145, v22, v23
    v_mfma_f32_16x16x32_bf16 v[80:83], a[204:207], a[172:175], v[80:83]
    v_exp_f32 v25, v101
    v_mfma_f32_16x16x32_bf16 v[88:91], a[204:207], a[188:191], v[184:187]
    v_exp_f32 v26, v102
    v_mfma_f32_16x16x32_bf16 v[88:91], a[200:203], a[184:187], v[88:91]
    ds_read_b128 a[240:243], v6 offset:20480
    v_cvt_pk_bf16_f32 v146, v24, v25
    v_mfma_f32_16x16x32_bf16 v[88:91], a[196:199], a[180:183], v[88:91]
    v_exp_f32 v27, v103
    v_mfma_f32_16x16x32_bf16 v[88:91], a[192:195], a[176:179], v[88:91]
    s_waitcnt lgkmcnt(5)
    v_exp_f32 v20, v104
    v_mfma_f32_16x16x32_bf16 v[92:95], a[208:211], a[176:179], v[188:191]
    ds_read_b128 a[244:247], v6 offset:21504
    v_cvt_pk_bf16_f32 v147, v26, v27
    v_mfma_f32_16x16x32_bf16 v[92:95], a[212:215], a[180:183], v[92:95]
    v_exp_f32 v21, v105
    v_mfma_f32_16x16x32_bf16 v[28:31], v[44:47], v[144:147], 0
    v_exp_f32 v22, v106
    v_mfma_f32_16x16x32_bf16 v[92:95], a[216:219], a[184:187], v[92:95]
    buffer_load_dwordx4 v7, s[24:27], s56 offen offset:1024 sc1 lds
    v_mfma_f32_16x16x32_bf16 v[92:95], a[220:223], a[188:191], v[92:95]
    ds_read_b128 a[248:251], v6 offset:22528
    v_cvt_pk_bf16_f32 v148, v20, v21
    v_mfma_f32_16x16x32_bf16 v[84:87], a[220:223], a[172:175], v[180:183]
    v_exp_f32 v23, v107
    v_mfma_f32_16x16x32_bf16 v[84:87], a[216:219], a[168:171], v[84:87]
    v_exp_f32 v24, v108
    v_mfma_f32_16x16x32_bf16 v[84:87], a[212:215], a[164:167], v[84:87]
    ds_read_b128 a[252:255], v6 offset:23552
    v_cvt_pk_bf16_f32 v149, v22, v23
    v_mfma_f32_16x16x32_bf16 v[84:87], a[208:211], a[160:163], v[84:87]
    v_exp_f32 v25, v109
    v_mfma_f32_16x16x32_bf16 v[76:79], a[208:211], a[144:147], v[172:175]
    v_exp_f32 v26, v110
    v_mfma_f32_16x16x32_bf16 v[76:79], a[212:215], a[148:151], v[76:79]
    v_cvt_pk_bf16_f32 v150, v24, v25
    v_add_f32 v15, v15, v40
    v_mfma_f32_16x16x32_bf16 v[76:79], a[216:219], a[152:155], v[76:79]
    v_exp_f32 v27, v111
    v_mfma_f32_16x16x32_bf16 v[76:79], a[220:223], a[156:159], v[76:79]
    buffer_load_dwordx4 v7, s[24:27], s56 offen offset:2048 sc1 lds
    v_mfma_f32_16x16x32_bf16 v[68:71], a[220:223], a[140:143], v[164:167]
    v_exp_f32 v20, v112
    v_mfma_f32_16x16x32_bf16 v[68:71], a[216:219], a[136:139], v[68:71]
    v_cvt_pk_bf16_f32 v151, v26, v27
    v_mfma_f32_16x16x32_bf16 v[68:71], a[212:215], a[132:135], v[68:71]
    v_exp_f32 v21, v113
    v_mfma_f32_16x16x32_bf16 v[32:35], v[44:47], v[148:151], 0
    v_exp_f32 v22, v114
    v_mfma_f32_16x16x32_bf16 v[68:71], a[208:211], a[128:131], v[68:71]
    s_waitcnt lgkmcnt(0)
    v_cvt_pk_bf16_f32 v152, v20, v21
    v_mfma_f32_16x16x32_bf16 a[0:3], a[224:227], v[128:131], a[0:3]
    ds_read_b128 a[192:195], v6 offset:8192
    v_mfma_f32_16x16x32_bf16 a[32:35], a[224:227], v[132:135], a[32:35]
    v_exp_f32 v23, v115
    v_mfma_f32_16x16x32_bf16 a[64:67], a[224:227], v[136:139], a[64:67]
    v_exp_f32 v24, v116
    v_mfma_f32_16x16x32_bf16 a[96:99], a[224:227], v[140:143], a[96:99]
    ds_read_b128 a[196:199], v6 offset:9216
    v_cvt_pk_bf16_f32 v153, v22, v23
    v_mfma_f32_16x16x32_bf16 a[100:103], a[228:231], v[140:143], a[100:103]
    v_exp_f32 v25, v117
    v_mfma_f32_16x16x32_bf16 a[68:71], a[228:231], v[136:139], a[68:71]
    v_exp_f32 v26, v118
    v_mfma_f32_16x16x32_bf16 a[36:39], a[228:231], v[132:135], a[36:39]
    ds_read_b128 a[200:203], v6 offset:10240
    v_cvt_pk_bf16_f32 v154, v24, v25
    v_mfma_f32_16x16x32_bf16 a[4:7], a[228:231], v[128:131], a[4:7]
    v_exp_f32 v27, v119
    v_mfma_f32_16x16x32_bf16 a[8:11], a[232:235], v[128:131], a[8:11]
    v_exp_f32 v20, v120
    v_mfma_f32_16x16x32_bf16 a[40:43], a[232:235], v[132:135], a[40:43]
    ds_read_b128 a[204:207], v6 offset:11264
    v_cvt_pk_bf16_f32 v155, v26, v27
    v_mfma_f32_16x16x32_bf16 a[72:75], a[232:235], v[136:139], a[72:75]
    v_exp_f32 v21, v121
    v_mfma_f32_16x16x32_bf16 v[36:39], v[44:47], v[152:155], 0
    v_exp_f32 v22, v122
    v_mfma_f32_16x16x32_bf16 a[104:107], a[232:235], v[140:143], a[104:107]
    buffer_load_dwordx4 v7, s[24:27], s56 offen offset:3072 sc1 lds
    v_mfma_f32_16x16x32_bf16 a[108:111], a[236:239], v[140:143], a[108:111]
    s_add_u32 s56, s56, 16384
    v_cvt_pk_bf16_f32 v156, v20, v21
    v_mfma_f32_16x16x32_bf16 a[76:79], a[236:239], v[136:139], a[76:79]
    v_exp_f32 v23, v123
    v_mfma_f32_16x16x32_bf16 a[44:47], a[236:239], v[132:135], a[44:47]
    v_exp_f32 v24, v124
    v_mfma_f32_16x16x32_bf16 a[12:15], a[236:239], v[128:131], a[12:15]
    v_cvt_pk_bf16_f32 v157, v22, v23
    v_mfma_f32_16x16x32_bf16 a[16:19], a[240:243], v[128:131], a[16:19]
    v_exp_f32 v25, v125
    v_mfma_f32_16x16x32_bf16 a[48:51], a[240:243], v[132:135], a[48:51]
    v_exp_f32 v26, v126
    v_mfma_f32_16x16x32_bf16 a[80:83], a[240:243], v[136:139], a[80:83]
    v_cvt_pk_bf16_f32 v158, v24, v25
    v_mfma_f32_16x16x32_bf16 a[112:115], a[240:243], v[140:143], a[112:115]
    s_add_u32 m0, s59, 16384
    v_exp_f32 v27, v127
    v_mfma_f32_16x16x32_bf16 a[116:119], a[244:247], v[140:143], a[116:119]
    buffer_load_dwordx4 v7, s[28:31], s57 offen offset:0 sc1 lds
    v_mfma_f32_16x16x32_bf16 a[84:87], a[244:247], v[136:139], a[84:87]
    v_cvt_pk_bf16_f32 v159, v26, v27
    v_mfma_f32_16x16x32_bf16 a[52:55], a[244:247], v[132:135], a[52:55]
    v_mfma_f32_16x16x32_bf16 a[20:23], a[244:247], v[128:131], a[20:23]
    v_mfma_f32_16x16x32_bf16 v[40:43], v[44:47], v[156:159], 0
    s_nop 2
    v_mfma_f32_16x16x32_bf16 a[24:27], a[248:251], v[128:131], a[24:27]
    s_nop 2
    v_mfma_f32_16x16x32_bf16 a[56:59], a[248:251], v[132:135], a[56:59]
    v_max3_f32 v8, v28, v32, v36
    v_max_f32 v8, v8, v40
    v_mfma_f32_16x16x32_bf16 a[88:91], a[248:251], v[136:139], a[88:91]
    v_cmp_nge_f32 vcc, s66, v8
    v_mfma_f32_16x16x32_bf16 a[120:123], a[248:251], v[140:143], a[120:123]
    ds_read_b128 a[208:211], v6 offset:12288
    v_mfma_f32_16x16x32_bf16 a[124:127], a[252:255], v[140:143], a[124:127]
    ds_read_b128 a[212:215], v6 offset:13312
    v_mfma_f32_16x16x32_bf16 a[92:95], a[252:255], v[136:139], a[92:95]
    ds_read_b128 a[216:219], v6 offset:14336
    v_mfma_f32_16x16x32_bf16 a[60:63], a[252:255], v[132:135], a[60:63]
    ds_read_b128 a[220:223], v6 offset:15360
    v_mfma_f32_16x16x32_bf16 a[28:31], a[252:255], v[128:131], a[28:31]
    s_waitcnt lgkmcnt(4)
    s_cbranch_vccnz m_stub75
m_ret76:
    v_mfma_f32_16x16x32_bf16 v[96:99], a[192:195], a[128:131], v[160:163]
    s_add_u32 s59, s58, s60
    v_exp_f32 v20, v64
    v_mfma_f32_16x16x32_bf16 v[96:99], a[196:199], a[132:135], v[96:99]
    s_add_u32 s58, s58, 32768
    ds_read_b128 a[224:227], v6 offset:24576
    v_add_f32 v12, v12, v28
    v_mfma_f32_16x16x32_bf16 v[96:99], a[200:203], a[136:139], v[96:99]
    s_cmp_ge_u32 s58, 163840
    s_cselect_b32 s58, 0, s58
    v_exp_f32 v21, v65
    v_mfma_f32_16x16x32_bf16 v[96:99], a[204:207], a[140:143], v[96:99]
    s_bitcmp1_b64 s[62:63], s64
    s_cselect_b32 s66, -1.0, s65
    v_cvt_pk_bf16_f32 v128, v20, v21
    v_mfma_f32_16x16x32_bf16 v[104:107], a[204:207], a[156:159], v[168:171]
    s_add_u32 s64, s64, 1
    ds_read_b128 a[228:231], v6 offset:25600
    v_add_f32 v13, v13, v32
    v_mfma_f32_16x16x32_bf16 v[104:107], a[200:203], a[152:155], v[104:107]
    v_exp_f32 v22, v66
    v_mfma_f32_16x16x32_bf16 v[104:107], a[196:199], a[148:151], v[104:107]
    buffer_load_dwordx4 v7, s[28:31], s57 offen offset:1024 sc1 lds
    v_mfma_f32_16x16x32_bf16 v[104:107], a[192:195], a[144:147], v[104:107]
    ds_read_b128 a[232:235], v6 offset:26624
    v_add_f32 v14, v14, v36
    v_mfma_f32_16x16x32_bf16 v[112:115], a[192:195], a[160:163], v[176:179]
    v_exp_f32 v23, v67
    v_mfma_f32_16x16x32_bf16 v[112:115], a[196:199], a[164:167], v[112:115]
    v_exp_f32 v24, v68
    v_mfma_f32_16x16x32_bf16 v[112:115], a[200:203], a[168:171], v[112:115]
    ds_read_b128 a[236:239], v6 offset:27648
    v_cvt_pk_bf16_f32 v129, v22, v23
    v_mfma_f32_16x16x32_bf16 v[112:115], a[204:207], a[172:175], v[112:115]
    v_exp_f32 v25, v69
    v_mfma_f32_16x16x32_bf16 v[120:123], a[204:207], a[188:191], v[184:187]
    v_exp_f32 v26, v70
    v_mfma_f32_16x16x32_bf16 v[120:123], a[200:203], a[184:187], v[120:123]
    ds_read_b128 a[240:243], v6 offset:28672
    v_cvt_pk_bf16_f32 v130, v24, v25
    v_mfma_f32_16x16x32_bf16 v[120:123], a[196:199], a[180:183], v[120:123]
    v_exp_f32 v27, v71
    v_mfma_f32_16x16x32_bf16 v[120:123], a[192:195], a[176:179], v[120:123]
    s_waitcnt lgkmcnt(5)
    v_exp_f32 v20, v72
    v_mfma_f32_16x16x32_bf16 v[124:127], a[208:211], a[176:179], v[188:191]
    ds_read_b128 a[244:247], v6 offset:29696
    v_cvt_pk_bf16_f32 v131, v26, v27
    v_mfma_f32_16x16x32_bf16 v[124:127], a[212:215], a[180:183], v[124:127]
    v_exp_f32 v21, v73
    v_mfma_f32_16x16x32_bf16 v[28:31], v[44:47], v[128:131], 0
    v_exp_f32 v22, v74
    v_mfma_f32_16x16x32_bf16 v[124:127], a[216:219], a[184:187], v[124:127]
    buffer_load_dwordx4 v7, s[28:31], s57 offen offset:2048 sc1 lds
    v_mfma_f32_16x16x32_bf16 v[124:127], a[220:223], a[188:191], v[124:127]
    ds_read_b128 a[248:251], v6 offset:30720
    v_cvt_pk_bf16_f32 v132, v20, v21
    v_mfma_f32_16x16x32_bf16 v[116:119], a[220:223], a[172:175], v[180:183]
    v_exp_f32 v23, v75
    v_mfma_f32_16x16x32_bf16 v[116:119], a[216:219], a[168:171], v[116:119]
    v_exp_f32 v24, v76
    v_mfma_f32_16x16x32_bf16 v[116:119], a[212:215], a[164:167], v[116:119]
    ds_read_b128 a[252:255], v6 offset:31744
    v_cvt_pk_bf16_f32 v133, v22, v23
    v_mfma_f32_16x16x32_bf16 v[116:119], a[208:211], a[160:163], v[116:119]
    v_exp_f32 v25, v77
    v_mfma_f32_16x16x32_bf16 v[108:111], a[208:211], a[144:147], v[172:175]
    v_exp_f32 v26, v78
    v_mfma_f32_16x16x32_bf16 v[108:111], a[212:215], a[148:151], v[108:111]
    v_cvt_pk_bf16_f32 v134, v24, v25
    v_add_f32 v15, v15, v40
    v_mfma_f32_16x16x32_bf16 v[108:111], a[216:219], a[152:155], v[108:111]
    v_exp_f32 v27, v79
    v_mfma_f32_16x16x32_bf16 v[108:111], a[220:223], a[156:159], v[108:111]
    buffer_load_dwordx4 v7, s[28:31], s57 offen offset:3072 sc1 lds
    v_mfma_f32_16x16x32_bf16 v[100:103], a[220:223], a[140:143], v[164:167]
    s_add_u32 s57, s57, 16384
    v_exp_f32 v20, v80
    v_mfma_f32_16x16x32_bf16 v[100:103], a[216:219], a[136:139], v[100:103]
    v_cvt_pk_bf16_f32 v135, v26, v27
    v_mfma_f32_16x16x32_bf16 v[100:103], a[212:215], a[132:135], v[100:103]
    v_exp_f32 v21, v81
    v_mfma_f32_16x16x32_bf16 v[32:35], v[44:47], v[132:135], 0
    v_exp_f32 v22, v82
    v_mfma_f32_16x16x32_bf16 v[100:103], a[208:211], a[128:131], v[100:103]
    s_waitcnt vmcnt(24) lgkmcnt(0)
    v_add_u32 v6, s58, v2
    v_cvt_pk_bf16_f32 v136, v20, v21
    v_mfma_f32_16x16x32_bf16 a[0:3], a[224:227], v[144:147], a[0:3]
    s_barrier
    v_mfma_f32_16x16x32_bf16 a[32:35], a[224:227], v[148:151], a[32:35]
    ds_read_b128 a[192:195], v6 offset:0
    v_mfma_f32_16x16x32_bf16 a[64:67], a[224:227], v[152:155], a[64:67]
    v_exp_f32 v23, v83
    v_mfma_f32_16x16x32_bf16 a[96:99], a[224:227], v[156:159], a[96:99]
    v_exp_f32 v24, v84
    v_mfma_f32_16x16x32_bf16 a[100:103], a[228:231], v[156:159], a[100:103]
    ds_read_b128 a[196:199], v6 offset:1024
    v_cvt_pk_bf16_f32 v137, v22, v23
    v_mfma_f32_16x16x32_bf16 a[68:71], a[228:231], v[152:155], a[68:71]
    v_exp_f32 v25, v85
    v_mfma_f32_16x16x32_bf16 a[36:39], a[228:231], v[148:151], a[36:39]
    v_exp_f32 v26, v86
    v_mfma_f32_16x16x32_bf16 a[4:7], a[228:231], v[144:147], a[4:7]
    ds_read_b128 a[200:203], v6 offset:2048
    v_cvt_pk_bf16_f32 v138, v24, v25
    v_mfma_f32_16x16x32_bf16 a[8:11], a[232:235], v[144:147], a[8:11]
    v_exp_f32 v27, v87
    v_mfma_f32_16x16x32_bf16 a[40:43], a[232:235], v[148:151], a[40:43]
    v_exp_f32 v20, v88
    v_mfma_f32_16x16x32_bf16 a[72:75], a[232:235], v[152:155], a[72:75]
    ds_read_b128 a[204:207], v6 offset:3072
    v_cvt_pk_bf16_f32 v139, v26, v27
    v_mfma_f32_16x16x32_bf16 a[104:107], a[232:235], v[156:159], a[104:107]
    v_exp_f32 v21, v89
    v_mfma_f32_16x16x32_bf16 v[36:39], v[44:47], v[136:139], 0
    v_exp_f32 v22, v90
    v_mfma_f32_16x16x32_bf16 a[108:111], a[236:239], v[156:159], a[108:111]
    v_cvt_pk_bf16_f32 v140, v20, v21
    v_mfma_f32_16x16x32_bf16 a[76:79], a[236:239], v[152:155], a[76:79]
    v_exp_f32 v23, v91
    v_mfma_f32_16x16x32_bf16 a[44:47], a[236:239], v[148:151], a[44:47]
    v_exp_f32 v24, v92
    v_mfma_f32_16x16x32_bf16 a[12:15], a[236:239], v[144:147], a[12:15]
    v_cvt_pk_bf16_f32 v141, v22, v23
    v_mfma_f32_16x16x32_bf16 a[16:19], a[240:243], v[144:147], a[16:19]
    v_exp_f32 v25, v93
    v_mfma_f32_16x16x32_bf16 a[48:51], a[240:243], v[148:151], a[48:51]
    v_exp_f32 v26, v94
    v_mfma_f32_16x16x32_bf16 a[80:83], a[240:243], v[152:155], a[80:83]
    v_cvt_pk_bf16_f32 v142, v24, v25
    v_mfma_f32_16x16x32_bf16 a[112:115], a[240:243], v[156:159], a[112:115]
    v_exp_f32 v27, v95
    v_mfma_f32_16x16x32_bf16 a[116:119], a[244:247], v[156:159], a[116:119]
    v_cvt_pk_bf16_f32 v143, v26, v27
    v_mfma_f32_16x16x32_bf16 a[84:87], a[244:247], v[152:155], a[84:87]
    v_mfma_f32_16x16x32_bf16 a[52:55], a[244:247], v[148:151], a[52:55]
    v_mfma_f32_16x16x32_bf16 v[40:43], v[44:47], v[140:143], 0
    s_nop 2
    v_mfma_f32_16x16x32_bf16 a[20:23], a[244:247], v[144:147], a[20:23]
    s_nop 2
    v_mfma_f32_16x16x32_bf16 a[24:27], a[248:251], v[144:147], a[24:27]
    v_max3_f32 v8, v28, v32, v36
    v_max_f32 v8, v8, v40
    v_mfma_f32_16x16x32_bf16 a[56:59], a[248:251], v[148:151], a[56:59]
    v_cmp_nge_f32 vcc, s66, v8
    v_mfma_f32_16x16x32_bf16 a[88:91], a[248:251], v[152:155], a[88:91]
    v_mfma_f32_16x16x32_bf16 a[120:123], a[248:251], v[156:159], a[120:123]
    ds_read_b128 a[208:211], v6 offset:4096
    v_mfma_f32_16x16x32_bf16 a[124:127], a[252:255], v[156:159], a[124:127]
    ds_read_b128 a[212:215], v6 offset:5120
    v_mfma_f32_16x16x32_bf16 a[92:95], a[252:255], v[152:155], a[92:95]
    ds_read_b128 a[216:219], v6 offset:6144
    v_mfma_f32_16x16x32_bf16 a[60:63], a[252:255], v[148:151], a[60:63]
    ds_read_b128 a[220:223], v6 offset:7168
    v_mfma_f32_16x16x32_bf16 a[28:31], a[252:255], v[144:147], a[28:31]
    s_waitcnt lgkmcnt(4)
    s_cbranch_vccz m_dual74
    v_cmp_lt_f32 vcc, s65, v8
    s_cmp_lg_u32 s64, s67
    s_cbranch_scc1 m_e78
    v_add_f32 v176, v176, v16
    v_mov_b32 v180, v9
    v_add_f32 v188, v188, v16
    v_add_f32 v177, v177, v17
    v_mov_b32 v181, v9
    v_add_f32 v189, v189, v17
    v_add_f32 v178, v178, v18
    v_mov_b32 v182, v9
    v_add_f32 v190, v190, v18
    v_add_f32 v179, v179, v19
    v_mov_b32 v183, v9
    v_add_f32 v191, v191, v19
    s_nop 0
m_e78:
    s_cmp_lg_u32 s64, s68
    s_cbranch_scc1 m_e79
    v_mov_b32 v176, v9
    v_mov_b32 v184, v9
    v_mov_b32 v188, v9
    v_mov_b32 v177, v9
    v_mov_b32 v185, v9
    v_mov_b32 v189, v9
    v_mov_b32 v178, v9
    v_mov_b32 v186, v9
    v_mov_b32 v190, v9
    v_mov_b32 v179, v9
    v_mov_b32 v187, v9
    v_mov_b32 v191, v9
    s_nop 0
m_e79:
    s_cmp_lg_u32 s64, s70
    s_cbranch_scc1 m_e80
    v_add_f32 v160, v160, v16
    v_mov_b32 v164, v9
    v_add_f32 v172, v172, v16
    v_add_f32 v161, v161, v17
    v_mov_b32 v165, v9
    v_add_f32 v173, v173, v17
    v_add_f32 v162, v162, v18
    v_mov_b32 v166, v9
    v_add_f32 v174, v174, v18
    v_add_f32 v163, v163, v19
    v_mov_b32 v167, v9
    v_add_f32 v175, v175, v19
    s_nop 0
m_e80:
    s_cmp_lg_u32 s64, s53
    s_cbranch_scc1 m_e83
    s_cmp_lg_u32 s16, 0
    s_cbranch_scc1 m_np84
    v_mov_b32 v60, s4
    v_mov_b32 v61, s5
    s_add_u32 s90, s101, 117440512
    s_mov_b64 exec, 1
    buffer_store_dwordx2 v[60:61], off, s[8:11], s90 sc1
    s_mov_b64 exec, -1
m_np84:
    s_mov_b32 s101, -1
m_e83:
    s_cmp_gt_u32 s64, 24
    s_cbranch_scc1 m_e81
    s_cmp_lg_u32 s64, 8
    s_cbranch_scc1 m_e85
    s_lshr_b32 s90, s32, 1
    s_lshl_b32 s90, s90, 7
    s_add_u32 s90, s90, 117440600
    v_min_u32 v0, 1, v1
    v_lshlrev_b32 v0, 5, v0
    buffer_load_dwordx2 v[4:5], v0, s[8:11], s90 offen sc1
    s_cmp_eq_u32 s17, -1
    s_cbranch_scc1 m_e81
    s_cmp_lg_u32 s16, 0
    s_cbranch_scc1 m_np86
    v_mov_b32 v60, s4
    v_mov_b32 v61, s5
    s_add_u32 s90, s17, 117440512
    s_mov_b64 exec, 1
    buffer_store_dwordx2 v[60:61], off, s[8:11], s90 sc1
    s_mov_b64 exec, -1
m_np86:
    s_branch m_e81
m_e85:
    s_cmp_lg_u32 s64, 16
    s_cbranch_scc1 m_e87
    s_waitcnt vmcnt(18)
    s_mov_b32 s3, 1048576
m_spin88:
    v_cmp_ne_u64 s[76:77], s[4:5], v[4:5]
    s_nop 3
    s_cmp_eq_u64 s[76:77], 0
    s_cbranch_scc1 m_e81
    s_sub_u32 s3, s3, 1
    s_cbranch_scc1 m_e81
    s_sleep 32
    s_lshr_b32 s90, s32, 1
    s_lshl_b32 s90, s90, 7
    s_add_u32 s90, s90, 117440600
    v_min_u32 v0, 1, v1
    v_lshlrev_b32 v0, 5, v0
    buffer_load_dwordx2 v[4:5], v0, s[8:11], s90 offen sc1
    s_waitcnt vmcnt(0)
    s_branch m_spin88
    s_branch m_e81
m_e87:
    s_cmp_lg_u32 s64, 20
    s_cbranch_scc1 m_e89
    buffer_load_dwordx2 v[4:5], v10, s[8:11], 0 offen sc1
    s_mov_b32 s44, s48
    s_mov_b32 s45, s49
    s_mov_b32 s46, 8388608
    s_lshl_b32 s90, s2, 2
    s_add_u32 s90, s90, s16
    s_lshl_b32 s90, s90, 13
    v_lshlrev_b32 v62, 7, v1
    buffer_load_dword v255, v62, s[44:47], s90 offen
    s_branch m_e81
m_e89:
    s_cmp_lg_u32 s64, 24
    s_cbranch_scc1 m_e90
    s_mov_b32 s44, s50
    s_mov_b32 s45, s51
    s_mov_b32 s46, 2097152
    s_lshl_b32 s90, s2, 2
    s_add_u32 s90, s90, s16
    s_lshl_b32 s90, s90, 13
    v_lshlrev_b32 v62, 7, v1
    buffer_load_dword v255, v62, s[44:47], s90 offen
    s_waitcnt vmcnt(18)
    s_mov_b32 s3, 1048576
m_spin91:
    v_cmp_ne_u64 s[76:77], s[4:5], v[4:5]
    s_nop 3
    s_cmp_eq_u64 s[76:77], 0
    s_cbranch_scc1 m_e81
    s_sub_u32 s3, s3, 1
    s_cbranch_scc1 m_e81
    s_sleep 32
    buffer_load_dwordx2 v[4:5], v10, s[8:11], 0 offen sc1
    s_waitcnt vmcnt(0)
    s_branch m_spin91
    s_branch m_e81
m_e90:
m_e81:
    s_cbranch_vccnz m_rc92
m_sp77:
    s_cmp_lg_u32 s64, s69
    s_cbranch_scc1 m_dual74
    v_mfma_f32_16x16x32_bf16 v[64:67], a[192:195], a[128:131], v[160:163]
    s_bitcmp1_b64 s[62:63], s64
    s_cselect_b32 s66, -1.0, s65
    v_add_f32 v12, v12, v28
    v_mfma_f32_16x16x32_bf16 v[64:67], a[196:199], a[132:135], v[64:67]
    s_add_u32 s64, s64, 1
    ds_read_b128 a[224:227], v6 offset:16384
    v_exp_f32 v20, v96
    v_mfma_f32_16x16x32_bf16 v[64:67], a[200:203], a[136:139], v[64:67]
    s_mov_b32 m0, s59
    ds_read_b128 a[228:231], v6 offset:17408
    v_add_f32 v13, v13, v32
    v_mfma_f32_16x16x32_bf16 v[64:67], a[204:207], a[140:143], v[64:67]
    buffer_load_dwordx4 v7, s[24:27], s56 offen offset:0 sc1 lds
    v_mfma_f32_16x16x32_bf16 v[72:75], a[204:207], a[156:159], v[168:171]
    ds_read_b128 a[232:235], v6 offset:18432
    v_add_f32 v14, v14, v36
    v_mfma_f32_16x16x32_bf16 v[72:75], a[200:203], a[152:155], v[72:75]
    ds_read_b128 a[236:239], v6 offset:19456
    v_exp_f32 v21, v97
    v_mfma_f32_16x16x32_bf16 v[72:75], a[196:199], a[148:151], v[72:75]
    ds_read_b128 a[240:243], v6 offset:20480
    v_cvt_pk_bf16_f32 v144, v20, v21
    v_mfma_f32_16x16x32_bf16 v[72:75], a[192:195], a[144:147], v[72:75]
    s_waitcnt lgkmcnt(5)
    ds_read_b128 a[244:247], v6 offset:21504
    v_add_f32 v15, v15, v40
    v_mfma_f32_16x16x32_bf16 v[76:79], a[208:211], a[144:147], v[172:175]
    ds_read_b128 a[248:251], v6 offset:22528
    v_exp_f32 v22, v98
    v_mfma_f32_16x16x32_bf16 v[76:79], a[212:215], a[148:151], v[76:79]
    ds_read_b128 a[252:255], v6 offset:23552
    v_exp_f32 v23, v99
    v_mfma_f32_16x16x32_bf16 v[76:79], a[216:219], a[152:155], v[76:79]
    v_exp_f32 v24, v100
    v_mfma_f32_16x16x32_bf16 v[76:79], a[220:223], a[156:159], v[76:79]
    buffer_load_dwordx4 v7, s[24:27], s56 offen offset:1024 sc1 lds
    v_mfma_f32_16x16x32_bf16 v[68:71], a[220:223], a[140:143], v[164:167]
    v_cvt_pk_bf16_f32 v145, v22, v23
    v_exp_f32 v25, v101
    v_mfma_f32_16x16x32_bf16 v[68:71], a[216:219], a[136:139], v[68:71]
    v_exp_f32 v26, v102
    v_mfma_f32_16x16x32_bf16 v[68:71], a[212:215], a[132:135], v[68:71]
    v_cvt_pk_bf16_f32 v146, v24, v25
    v_exp_f32 v27, v103
    v_mfma_f32_16x16x32_bf16 v[68:71], a[208:211], a[128:131], v[68:71]
    s_waitcnt lgkmcnt(0)
    v_exp_f32 v20, v104
    v_mfma_f32_16x16x32_bf16 a[0:3], a[224:227], v[128:131], a[0:3]
    ds_read_b128 a[192:195], v6 offset:8192
    v_cvt_pk_bf16_f32 v147, v26, v27
    v_mfma_f32_16x16x32_bf16 a[32:35], a[224:227], v[132:135], a[32:35]
    v_exp_f32 v21, v105
    v_mfma_f32_16x16x32_bf16 v[28:31], v[44:47], v[144:147], 0
    v_exp_f32 v22, v106
    v_mfma_f32_16x16x32_bf16 a[64:67], a[224:227], v[136:139], a[64:67]
    v_cvt_pk_bf16_f32 v148, v20, v21
    v_exp_f32 v23, v107
    v_mfma_f32_16x16x32_bf16 a[96:99], a[224:227], v[140:143], a[96:99]
    ds_read_b128 a[196:199], v6 offset:9216
    v_cvt_pk_bf16_f32 v149, v22, v23
    v_mfma_f32_16x16x32_bf16 a[100:103], a[228:231], v[140:143], a[100:103]
    v_exp_f32 v24, v108
    v_mfma_f32_16x16x32_bf16 a[68:71], a[228:231], v[136:139], a[68:71]
    buffer_load_dwordx4 v7, s[24:27], s56 offen offset:2048 sc1 lds
    v_mfma_f32_16x16x32_bf16 a[36:39], a[228:231], v[132:135], a[36:39]
    ds_read_b128 a[200:203], v6 offset:10240
    v_exp_f32 v25, v109
    v_mfma_f32_16x16x32_bf16 a[4:7], a[228:231], v[128:131], a[4:7]
    v_exp_f32 v26, v110
    v_mfma_f32_16x16x32_bf16 a[8:11], a[232:235], v[128:131], a[8:11]
    v_cvt_pk_bf16_f32 v150, v24, v25
    v_exp_f32 v27, v111
    v_mfma_f32_16x16x32_bf16 a[40:43], a[232:235], v[132:135], a[40:43]
    ds_read_b128 a[204:207], v6 offset:11264
    v_cvt_pk_bf16_f32 v151, v26, v27
    v_mfma_f32_16x16x32_bf16 a[72:75], a[232:235], v[136:139], a[72:75]
    v_exp_f32 v20, v112
    v_mfma_f32_16x16x32_bf16 v[32:35], v[44:47], v[148:151], 0
    v_exp_f32 v21, v113
    v_mfma_f32_16x16x32_bf16 a[104:107], a[232:235], v[140:143], a[104:107]
    v_exp_f32 v22, v114
    v_mfma_f32_16x16x32_bf16 a[108:111], a[236:239], v[140:143], a[108:111]
    v_cvt_pk_bf16_f32 v152, v20, v21
    v_exp_f32 v23, v115
    v_mfma_f32_16x16x32_bf16 a[76:79], a[236:239], v[136:139], a[76:79]
    v_exp_f32 v24, v116
    v_mfma_f32_16x16x32_bf16 a[44:47], a[236:239], v[132:135], a[44:47]
    v_cvt_pk_bf16_f32 v153, v22, v23
    v_exp_f32 v25, v117
    v_mfma_f32_16x16x32_bf16 a[12:15], a[236:239], v[128:131], a[12:15]
    buffer_load_dwordx4 v7, s[24:27], s56 offen offset:3072 sc1 lds
    v_mfma_f32_16x16x32_bf16 a[16:19], a[240:243], v[128:131], a[16:19]
    s_add_u32 s56, s56, 16384
    v_exp_f32 v26, v118
    v_mfma_f32_16x16x32_bf16 a[48:51], a[240:243], v[132:135], a[48:51]
    v_cvt_pk_bf16_f32 v154, v24, v25
    v_exp_f32 v27, v119
    v_mfma_f32_16x16x32_bf16 a[80:83], a[240:243], v[136:139], a[80:83]
    v_exp_f32 v20, v120
    v_mfma_f32_16x16x32_bf16 a[112:115], a[240:243], v[140:143], a[112:115]
    v_cvt_pk_bf16_f32 v155, v26, v27
    v_exp_f32 v21, v121
    v_mfma_f32_16x16x32_bf16 a[116:119], a[244:247], v[140:143], a[116:119]
    v_exp_f32 v22, v122
    v_mfma_f32_16x16x32_bf16 v[36:39], v[44:47], v[152:155], 0
    v_cvt_pk_bf16_f32 v156, v20, v21
    v_mfma_f32_16x16x32_bf16 a[84:87], a[244:247], v[136:139], a[84:87]
    v_exp_f32 v23, v123
    v_mfma_f32_16x16x32_bf16 a[52:55], a[244:247], v[132:135], a[52:55]
    v_exp_f32 v24, v124
    v_cvt_pk_bf16_f32 v157, v22, v23
    v_mfma_f32_16x16x32_bf16 a[20:23], a[244:247], v[128:131], a[20:23]
    v_exp_f32 v25, v125
    v_mfma_f32_16x16x32_bf16 a[24:27], a[248:251], v[128:131], a[24:27]
    s_add_u32 m0, s59, 16384
    v_exp_f32 v26, v126
    v_mfma_f32_16x16x32_bf16 a[56:59], a[248:251], v[132:135], a[56:59]
    buffer_load_dwordx4 v7, s[28:31], s57 offen offset:0 sc1 lds
    v_mfma_f32_16x16x32_bf16 a[88:91], a[248:251], v[136:139], a[88:91]
    v_cvt_pk_bf16_f32 v158, v24, v25
    v_exp_f32 v27, v127
    v_mfma_f32_16x16x32_bf16 a[120:123], a[248:251], v[140:143], a[120:123]
    ds_read_b128 a[208:211], v6 offset:12288
    v_cvt_pk_bf16_f32 v159, v26, v27
    s_nop 1
    v_mfma_f32_16x16x32_bf16 v[40:43], v[44:47], v[156:159], 0
    s_nop 2
    v_mfma_f32_16x16x32_bf16 a[124:127], a[252:255], v[140:143], a[124:127]
    ds_read_b128 a[212:215], v6 offset:13312
    s_nop 0
    v_mfma_f32_16x16x32_bf16 a[92:95], a[252:255], v[136:139], a[92:95]
    ds_read_b128 a[216:219], v6 offset:14336
    v_max3_f32 v8, v28, v32, v36
    v_mfma_f32_16x16x32_bf16 a[60:63], a[252:255], v[132:135], a[60:63]
    ds_read_b128 a[220:223], v6 offset:15360
    v_max_f32 v8, v8, v40
    v_cmp_nge_f32 vcc, s66, v8
    v_mfma_f32_16x16x32_bf16 a[28:31], a[252:255], v[128:131], a[28:31]
    s_waitcnt lgkmcnt(4)
    s_cbranch_vccnz m_stub93
m_ret94:
    v_mfma_f32_16x16x32_bf16 v[96:99], a[192:195], a[128:131], v[160:163]
    s_add_u32 s59, s58, s60
    v_exp_f32 v20, v64
    v_mfma_f32_16x16x32_bf16 v[96:99], a[196:199], a[132:135], v[96:99]
    s_add_u32 s58, s58, 32768
    ds_read_b128 a[224:227], v6 offset:24576
    v_add_f32 v12, v12, v28
    v_mfma_f32_16x16x32_bf16 v[96:99], a[200:203], a[136:139], v[96:99]
    s_cmp_ge_u32 s58, 163840
    s_cselect_b32 s58, 0, s58
    ds_read_b128 a[228:231], v6 offset:25600
    v_add_f32 v13, v13, v32
    v_mfma_f32_16x16x32_bf16 v[96:99], a[204:207], a[140:143], v[96:99]
    buffer_load_dwordx4 v7, s[28:31], s57 offen offset:1024 sc1 lds
    v_mfma_f32_16x16x32_bf16 v[104:107], a[204:207], a[156:159], v[168:171]
    s_bitcmp1_b64 s[62:63], s64
    s_cselect_b32 s66, -1.0, s65
    ds_read_b128 a[232:235], v6 offset:26624
    v_mfma_f32_16x16x32_bf16 v[104:107], a[200:203], a[152:155], v[104:107]
    s_add_u32 s64, s64, 1
    ds_read_b128 a[236:239], v6 offset:27648
    v_mfma_f32_16x16x32_bf16 v[104:107], a[196:199], a[148:151], v[104:107]
    ds_read_b128 a[240:243], v6 offset:28672
    v_mfma_f32_16x16x32_bf16 v[104:107], a[192:195], a[144:147], v[104:107]
    s_waitcnt lgkmcnt(5)
    ds_read_b128 a[244:247], v6 offset:29696
    v_mfma_f32_16x16x32_bf16 v[108:111], a[208:211], a[144:147], v[172:175]
    buffer_load_dwordx4 v7, s[28:31], s57 offen offset:2048 sc1 lds
    v_mfma_f32_16x16x32_bf16 v[108:111], a[212:215], a[148:151], v[108:111]
    ds_read_b128 a[248:251], v6 offset:30720
    v_mfma_f32_16x16x32_bf16 v[108:111], a[216:219], a[152:155], v[108:111]
    ds_read_b128 a[252:255], v6 offset:31744
    v_mfma_f32_16x16x32_bf16 v[108:111], a[220:223], a[156:159], v[108:111]
    v_exp_f32 v21, v65
    v_mfma_f32_16x16x32_bf16 v[100:103], a[220:223], a[140:143], v[164:167]
    v_exp_f32 v22, v66
    v_mfma_f32_16x16x32_bf16 v[100:103], a[216:219], a[136:139], v[100:103]
    buffer_load_dwordx4 v7, s[28:31], s57 offen offset:3072 sc1 lds
    v_mfma_f32_16x16x32_bf16 v[100:103], a[212:215], a[132:135], v[100:103]
    s_add_u32 s57, s57, 16384
    v_cvt_pk_bf16_f32 v128, v20, v21
    v_mfma_f32_16x16x32_bf16 v[100:103], a[208:211], a[128:131], v[100:103]
    s_waitcnt vmcnt(24) lgkmcnt(0)
    v_add_u32 v6, s58, v2
    v_mfma_f32_16x16x32_bf16 a[0:3], a[224:227], v[144:147], a[0:3]
    s_barrier
    v_mfma_f32_16x16x32_bf16 a[32:35], a[224:227], v[148:151], a[32:35]
    ds_read_b128 a[192:195], v6 offset:0
    v_mfma_f32_16x16x32_bf16 a[64:67], a[224:227], v[152:155], a[64:67]
    v_exp_f32 v23, v67
    v_mfma_f32_16x16x32_bf16 a[96:99], a[224:227], v[156:159], a[96:99]
    v_exp_f32 v24, v68
    v_mfma_f32_16x16x32_bf16 a[100:103], a[228:231], v[156:159], a[100:103]
    ds_read_b128 a[196:199], v6 offset:1024
    v_cvt_pk_bf16_f32 v129, v22, v23
    v_mfma_f32_16x16x32_bf16 a[68:71], a[228:231], v[152:155], a[68:71]
    v_exp_f32 v25, v69
    v_mfma_f32_16x16x32_bf16 a[36:39], a[228:231], v[148:151], a[36:39]
    v_exp_f32 v26, v70
    v_mfma_f32_16x16x32_bf16 a[4:7], a[228:231], v[144:147], a[4:7]
    ds_read_b128 a[200:203], v6 offset:2048
    v_cvt_pk_bf16_f32 v130, v24, v25
    v_mfma_f32_16x16x32_bf16 a[8:11], a[232:235], v[144:147], a[8:11]
    v_exp_f32 v27, v71
    v_mfma_f32_16x16x32_bf16 a[40:43], a[232:235], v[148:151], a[40:43]
    v_exp_f32 v20, v72
    v_mfma_f32_16x16x32_bf16 a[72:75], a[232:235], v[152:155], a[72:75]
    ds_read_b128 a[204:207], v6 offset:3072
    v_cvt_pk_bf16_f32 v131, v26, v27
    v_mfma_f32_16x16x32_bf16 a[104:107], a[232:235], v[156:159], a[104:107]
    v_exp_f32 v21, v73
    v_mfma_f32_16x16x32_bf16 v[28:31], v[44:47], v[128:131], 0
    v_exp_f32 v22, v74
    v_mfma_f32_16x16x32_bf16 a[108:111], a[236:239], v[156:159], a[108:111]
    v_cvt_pk_bf16_f32 v132, v20, v21
    v_mfma_f32_16x16x32_bf16 a[76:79], a[236:239], v[152:155], a[76:79]
    v_exp_f32 v23, v75
    v_mfma_f32_16x16x32_bf16 a[44:47], a[236:239], v[148:151], a[44:47]
    v_exp_f32 v24, v76
    v_mfma_f32_16x16x32_bf16 a[12:15], a[236:239], v[144:147], a[12:15]
    v_cvt_pk_bf16_f32 v133, v22, v23
    v_mfma_f32_16x16x32_bf16 a[16:19], a[240:243], v[144:147], a[16:19]
    v_exp_f32 v25, v77
    v_mfma_f32_16x16x32_bf16 a[48:51], a[240:243], v[148:151], a[48:51]
    v_exp_f32 v26, v78
    v_mfma_f32_16x16x32_bf16 a[80:83], a[240:243], v[152:155], a[80:83]
    v_cvt_pk_bf16_f32 v134, v24, v25
    v_mfma_f32_16x16x32_bf16 a[112:115], a[240:243], v[156:159], a[112:115]
    v_exp_f32 v27, v79
    v_mfma_f32_16x16x32_bf16 a[116:119], a[244:247], v[156:159], a[116:119]
    v_cvt_pk_bf16_f32 v135, v26, v27
    v_mfma_f32_16x16x32_bf16 a[84:87], a[244:247], v[152:155], a[84:87]
    v_mfma_f32_16x16x32_bf16 a[52:55], a[244:247], v[148:151], a[52:55]
    v_mfma_f32_16x16x32_bf16 v[32:35], v[44:47], v[132:135], 0
    s_nop 2
    v_mfma_f32_16x16x32_bf16 a[20:23], a[244:247], v[144:147], a[20:23]
    s_nop 2
    v_mfma_f32_16x16x32_bf16 a[24:27], a[248:251], v[144:147], a[24:27]
    v_max_f32 v8, v28, v32
    v_cmp_nge_f32 vcc, s66, v8
    v_mfma_f32_16x16x32_bf16 a[56:59], a[248:251], v[148:151], a[56:59]
    v_mfma_f32_16x16x32_bf16 a[88:91], a[248:251], v[152:155], a[88:91]
    v_mfma_f32_16x16x32_bf16 a[120:123], a[248:251], v[156:159], a[120:123]
    ds_read_b128 a[208:211], v6 offset:4096
    v_mfma_f32_16x16x32_bf16 a[124:127], a[252:255], v[156:159], a[124:127]
    ds_read_b128 a[212:215], v6 offset:5120
    v_mfma_f32_16x16x32_bf16 a[92:95], a[252:255], v[152:155], a[92:95]
    ds_read_b128 a[216:219], v6 offset:6144
    v_mfma_f32_16x16x32_bf16 a[60:63], a[252:255], v[148:151], a[60:63]
    ds_read_b128 a[220:223], v6 offset:7168
    v_mfma_f32_16x16x32_bf16 a[28:31], a[252:255], v[144:147], a[28:31]
    s_waitcnt lgkmcnt(4)
    s_cbranch_vccnz m_stub95
m_ret96:
    v_add_f32 v20, v14, v36
    v_add_f32 v21, v15, v40
    s_nop 3
    v_rcp_f32 v20, v20
    v_rcp_f32 v21, v21
    s_lshl_b32 s90, s79, 10
    s_add_u32 s90, s90, s82
    s_add_u32 s90, s90, 67108864
    v_accvgpr_read_b32 v48, a64
    v_accvgpr_read_b32 v49, a65
    v_accvgpr_read_b32 v50, a66
    v_accvgpr_read_b32 v51, a67
    v_accvgpr_read_b32 v52, a68
    v_accvgpr_read_b32 v53, a69
    v_accvgpr_read_b32 v54, a70
    v_accvgpr_read_b32 v55, a71
    v_mul_f32 v48, v20, v48
    v_mul_f32 v49, v20, v49
    v_mul_f32 v50, v20, v50
    v_mul_f32 v51, v20, v51
    v_mul_f32 v52, v20, v52
    v_mul_f32 v53, v20, v53
    v_mul_f32 v54, v20, v54
    v_mul_f32 v55, v20, v55
    v_cvt_pk_bf16_f32 v48, v48, v49
    v_cvt_pk_bf16_f32 v49, v50, v51
    v_cvt_pk_bf16_f32 v50, v52, v53
    v_cvt_pk_bf16_f32 v51, v54, v55
    buffer_store_dwordx4 v[48:51], v2, s[8:11], s90 offen offset:0 sc1
    v_accvgpr_read_b32 v56, a96
    v_accvgpr_read_b32 v57, a97
    v_accvgpr_read_b32 v58, a98
    v_accvgpr_read_b32 v59, a99
    v_accvgpr_read_b32 v60, a100
    v_accvgpr_read_b32 v61, a101
    v_accvgpr_read_b32 v62, a102
    v_accvgpr_read_b32 v63, a103
    v_mul_f32 v56, v21, v56
    v_mul_f32 v57, v21, v57
    v_mul_f32 v58, v21, v58
    v_mul_f32 v59, v21, v59
    v_mul_f32 v60, v21, v60
    v_mul_f32 v61, v21, v61
    v_mul_f32 v62, v21, v62
    v_mul_f32 v63, v21, v63
    v_cvt_pk_bf16_f32 v56, v56, v57
    v_cvt_pk_bf16_f32 v57, v58, v59
    v_cvt_pk_bf16_f32 v58, v60, v61
    v_cvt_pk_bf16_f32 v59, v62, v63
    buffer_store_dwordx4 v[56:59], v2, s[8:11], s90 offen offset:1024 sc1
    s_add_u32 s90, s90, 131072
    v_accvgpr_read_b32 v48, a72
    v_accvgpr_read_b32 v49, a73
    v_accvgpr_read_b32 v50, a74
    v_accvgpr_read_b32 v51, a75
    v_accvgpr_read_b32 v52, a76
    v_accvgpr_read_b32 v53, a77
    v_accvgpr_read_b32 v54, a78
    v_accvgpr_read_b32 v55, a79
    v_mul_f32 v48, v20, v48
    v_mul_f32 v49, v20, v49
    v_mul_f32 v50, v20, v50
    v_mul_f32 v51, v20, v51
    v_mul_f32 v52, v20, v52
    v_mul_f32 v53, v20, v53
    v_mul_f32 v54, v20, v54
    v_mul_f32 v55, v20, v55
    v_cvt_pk_bf16_f32 v48, v48, v49
    v_cvt_pk_bf16_f32 v49, v50, v51
    v_cvt_pk_bf16_f32 v50, v52, v53
    v_cvt_pk_bf16_f32 v51, v54, v55
    buffer_store_dwordx4 v[48:51], v2, s[8:11], s90 offen offset:0 sc1
    v_accvgpr_read_b32 v56, a104
    v_accvgpr_read_b32 v57, a105
    v_accvgpr_read_b32 v58, a106
    v_accvgpr_read_b32 v59, a107
    v_accvgpr_read_b32 v60, a108
    v_accvgpr_read_b32 v61, a109
    v_accvgpr_read_b32 v62, a110
    v_accvgpr_read_b32 v63, a111
    v_mul_f32 v56, v21, v56
    v_mul_f32 v57, v21, v57
    v_mul_f32 v58, v21, v58
    v_mul_f32 v59, v21, v59
    v_mul_f32 v60, v21, v60
    v_mul_f32 v61, v21, v61
    v_mul_f32 v62, v21, v62
    v_mul_f32 v63, v21, v63
    v_cvt_pk_bf16_f32 v56, v56, v57
    v_cvt_pk_bf16_f32 v57, v58, v59
    v_cvt_pk_bf16_f32 v58, v60, v61
    v_cvt_pk_bf16_f32 v59, v62, v63
    buffer_store_dwordx4 v[56:59], v2, s[8:11], s90 offen offset:1024 sc1
    s_add_u32 s90, s90, 131072
    v_accvgpr_read_b32 v48, a80
    v_accvgpr_read_b32 v49, a81
    v_accvgpr_read_b32 v50, a82
    v_accvgpr_read_b32 v51, a83
    v_accvgpr_read_b32 v52, a84
    v_accvgpr_read_b32 v53, a85
    v_accvgpr_read_b32 v54, a86
    v_accvgpr_read_b32 v55, a87
    v_mul_f32 v48, v20, v48
    v_mul_f32 v49, v20, v49
    v_mul_f32 v50, v20, v50
    v_mul_f32 v51, v20, v51
    v_mul_f32 v52, v20, v52
    v_mul_f32 v53, v20, v53
    v_mul_f32 v54, v20, v54
    v_mul_f32 v55, v20, v55
    v_cvt_pk_bf16_f32 v48, v48, v49
    v_cvt_pk_bf16_f32 v49, v50, v51
    v_cvt_pk_bf16_f32 v50, v52, v53
    v_cvt_pk_bf16_f32 v51, v54, v55
    buffer_store_dwordx4 v[48:51], v2, s[8:11], s90 offen offset:0 sc1
    v_accvgpr_read_b32 v56, a112
    v_accvgpr_read_b32 v57, a113
    v_accvgpr_read_b32 v58, a114
    v_accvgpr_read_b32 v59, a115
    v_accvgpr_read_b32 v60, a116
    v_accvgpr_read_b32 v61, a117
    v_accvgpr_read_b32 v62, a118
    v_accvgpr_read_b32 v63, a119
    v_mul_f32 v56, v21, v56
    v_mul_f32 v57, v21, v57
    v_mul_f32 v58, v21, v58
    v_mul_f32 v59, v21, v59
    v_mul_f32 v60, v21, v60
    v_mul_f32 v61, v21, v61
    v_mul_f32 v62, v21, v62
    v_mul_f32 v63, v21, v63
    v_cvt_pk_bf16_f32 v56, v56, v57
    v_cvt_pk_bf16_f32 v57, v58, v59
    v_cvt_pk_bf16_f32 v58, v60, v61
    v_cvt_pk_bf16_f32 v59, v62, v63
    buffer_store_dwordx4 v[56:59], v2, s[8:11], s90 offen offset:1024 sc1
    s_add_u32 s90, s90, 131072
    v_accvgpr_read_b32 v48, a88
    v_accvgpr_read_b32 v49, a89
    v_accvgpr_read_b32 v50, a90
    v_accvgpr_read_b32 v51, a91
    v_accvgpr_read_b32 v52, a92
    v_accvgpr_read_b32 v53, a93
    v_accvgpr_read_b32 v54, a94
    v_accvgpr_read_b32 v55, a95
    v_mul_f32 v48, v20, v48
    v_mul_f32 v49, v20, v49
    v_mul_f32 v50, v20, v50
    v_mul_f32 v51, v20, v51
    v_mul_f32 v52, v20, v52
    v_mul_f32 v53, v20, v53
    v_mul_f32 v54, v20, v54
    v_mul_f32 v55, v20, v55
    v_cvt_pk_bf16_f32 v48, v48, v49
    v_cvt_pk_bf16_f32 v49, v50, v51
    v_cvt_pk_bf16_f32 v50, v52, v53
    v_cvt_pk_bf16_f32 v51, v54, v55
    buffer_store_dwordx4 v[48:51], v2, s[8:11], s90 offen offset:0 sc1
    v_accvgpr_read_b32 v56, a120
    v_accvgpr_read_b32 v57, a121
    v_accvgpr_read_b32 v58, a122
    v_accvgpr_read_b32 v59, a123
    v_accvgpr_read_b32 v60, a124
    v_accvgpr_read_b32 v61, a125
    v_accvgpr_read_b32 v62, a126
    v_accvgpr_read_b32 v63, a127
    v_mul_f32 v56, v21, v56
    v_mul_f32 v57, v21, v57
    v_mul_f32 v58, v21, v58
    v_mul_f32 v59, v21, v59
    v_mul_f32 v60, v21, v60
    v_mul_f32 v61, v21, v61
    v_mul_f32 v62, v21, v62
    v_mul_f32 v63, v21, v63
    v_cvt_pk_bf16_f32 v56, v56, v57
    v_cvt_pk_bf16_f32 v57, v58, v59
    v_cvt_pk_bf16_f32 v58, v60, v61
    v_cvt_pk_bf16_f32 v59, v62, v63
    buffer_store_dwordx4 v[56:59], v2, s[8:11], s90 offen offset:1024 sc1
    s_add_u32 s90, s90, 131072
    s_lshl_b32 s101, s34, 5
    s_add_u32 s101, s101, s32
    s_lshl_b32 s101, s101, 3
    s_add_u32 s101, s101, 7936
    s_cmp_eq_u32 s64, s72
    s_cbranch_scc1 m_singlex98
.p2align 3
m_single97:
    v_mfma_f32_16x16x32_bf16 v[64:67], a[192:195], a[128:131], v[160:163]
    s_bitcmp1_b64 s[62:63], s64
    s_cselect_b32 s66, -1.0, s65
    v_add_f32 v12, v12, v28
    v_mfma_f32_16x16x32_bf16 v[64:67], a[196:199], a[132:135], v[64:67]
    s_mov_b32 m0, s59
    ds_read_b128 a[224:227], v6 offset:16384
    v_add_f32 v13, v13, v32
    v_mfma_f32_16x16x32_bf16 v[64:67], a[200:203], a[136:139], v[64:67]
    buffer_load_dwordx4 v7, s[24:27], s56 offen offset:0 sc1 lds
    v_mfma_f32_16x16x32_bf16 v[64:67], a[204:207], a[140:143], v[64:67]
    s_add_u32 s64, s64, 1
    ds_read_b128 a[228:231], v6 offset:17408
    v_exp_f32 v20, v96
    v_mfma_f32_16x16x32_bf16 v[72:75], a[204:207], a[156:159], v[168:171]
    ds_read_b128 a[232:235], v6 offset:18432
    v_exp_f32 v21, v97
    v_mfma_f32_16x16x32_bf16 v[72:75], a[200:203], a[152:155], v[72:75]
    ds_read_b128 a[236:239], v6 offset:19456
    v_cvt_pk_bf16_f32 v144, v20, v21
    v_mfma_f32_16x16x32_bf16 v[72:75], a[196:199], a[148:151], v[72:75]
    ds_read_b128 a[240:243], v6 offset:20480
    v_exp_f32 v22, v98
    v_mfma_f32_16x16x32_bf16 v[72:75], a[192:195], a[144:147], v[72:75]
    s_waitcnt lgkmcnt(5)
    ds_read_b128 a[244:247], v6 offset:21504
    v_mfma_f32_16x16x32_bf16 v[76:79], a[208:211], a[144:147], v[172:175]
    ds_read_b128 a[248:251], v6 offset:22528
    v_exp_f32 v23, v99
    v_mfma_f32_16x16x32_bf16 v[76:79], a[212:215], a[148:151], v[76:79]
    ds_read_b128 a[252:255], v6 offset:23552
    v_cvt_pk_bf16_f32 v145, v22, v23
    v_mfma_f32_16x16x32_bf16 v[76:79], a[216:219], a[152:155], v[76:79]
    buffer_load_dwordx4 v7, s[24:27], s56 offen offset:1024 sc1 lds
    v_mfma_f32_16x16x32_bf16 v[76:79], a[220:223], a[156:159], v[76:79]
    v_exp_f32 v24, v100
    v_mfma_f32_16x16x32_bf16 v[68:71], a[220:223], a[140:143], v[164:167]
    v_exp_f32 v25, v101
    v_mfma_f32_16x16x32_bf16 v[68:71], a[216:219], a[136:139], v[68:71]
    v_exp_f32 v26, v102
    v_mfma_f32_16x16x32_bf16 v[68:71], a[212:215], a[132:135], v[68:71]
    buffer_load_dwordx4 v7, s[24:27], s56 offen offset:2048 sc1 lds
    v_cvt_pk_bf16_f32 v146, v24, v25
    v_mfma_f32_16x16x32_bf16 v[68:71], a[208:211], a[128:131], v[68:71]
    s_waitcnt lgkmcnt(0)
    v_exp_f32 v27, v103
    v_mfma_f32_16x16x32_bf16 a[0:3], a[224:227], v[128:131], a[0:3]
    ds_read_b128 a[192:195], v6 offset:8192
    v_cvt_pk_bf16_f32 v147, v26, v27
    v_mfma_f32_16x16x32_bf16 a[32:35], a[224:227], v[132:135], a[32:35]
    v_exp_f32 v20, v104
    v_mfma_f32_16x16x32_bf16 v[28:31], v[44:47], v[144:147], 0
    v_exp_f32 v21, v105
    v_mfma_f32_16x16x32_bf16 a[36:39], a[228:231], v[132:135], a[36:39]
    ds_read_b128 a[196:199], v6 offset:9216
    v_exp_f32 v22, v106
    v_mfma_f32_16x16x32_bf16 a[4:7], a[228:231], v[128:131], a[4:7]
    buffer_load_dwordx4 v7, s[24:27], s56 offen offset:3072 sc1 lds
    v_mfma_f32_16x16x32_bf16 a[8:11], a[232:235], v[128:131], a[8:11]
    s_add_u32 s56, s56, 16384
    ds_read_b128 a[200:203], v6 offset:10240
    v_cvt_pk_bf16_f32 v148, v20, v21
    v_mfma_f32_16x16x32_bf16 a[40:43], a[232:235], v[132:135], a[40:43]
    v_exp_f32 v23, v107
    v_mfma_f32_16x16x32_bf16 a[44:47], a[236:239], v[132:135], a[44:47]
    ds_read_b128 a[204:207], v6 offset:11264
    v_exp_f32 v24, v108
    v_mfma_f32_16x16x32_bf16 a[12:15], a[236:239], v[128:131], a[12:15]
    v_cvt_pk_bf16_f32 v149, v22, v23
    v_exp_f32 v25, v109
    v_mfma_f32_16x16x32_bf16 a[16:19], a[240:243], v[128:131], a[16:19]
    v_exp_f32 v26, v110
    v_mfma_f32_16x16x32_bf16 a[48:51], a[240:243], v[132:135], a[48:51]
    v_cvt_pk_bf16_f32 v150, v24, v25
    v_exp_f32 v27, v111
    v_mfma_f32_16x16x32_bf16 a[52:55], a[244:247], v[132:135], a[52:55]
    ds_read_b128 a[208:211], v6 offset:12288
    v_cvt_pk_bf16_f32 v151, v26, v27
    v_mfma_f32_16x16x32_bf16 a[20:23], a[244:247], v[128:131], a[20:23]
    s_add_u32 m0, s59, 16384
    ds_read_b128 a[212:215], v6 offset:13312
    v_mfma_f32_16x16x32_bf16 v[32:35], v[44:47], v[148:151], 0
    s_nop 2
    v_mfma_f32_16x16x32_bf16 a[24:27], a[248:251], v[128:131], a[24:27]
    buffer_load_dwordx4 v7, s[28:31], s57 offen offset:0 sc1 lds
    v_mfma_f32_16x16x32_bf16 a[56:59], a[248:251], v[132:135], a[56:59]
    ds_read_b128 a[216:219], v6 offset:14336
    s_nop 0
    v_mfma_f32_16x16x32_bf16 a[60:63], a[252:255], v[132:135], a[60:63]
    ds_read_b128 a[220:223], v6 offset:15360
    v_max_f32 v8, v28, v32
    v_cmp_nge_f32 vcc, s66, v8
    v_mfma_f32_16x16x32_bf16 a[28:31], a[252:255], v[128:131], a[28:31]
    s_waitcnt lgkmcnt(4)
    s_cbranch_vccnz m_stub99
m_ret100:
    v_mfma_f32_16x16x32_bf16 v[96:99], a[192:195], a[128:131], v[160:163]
    s_add_u32 s59, s58, s60
    v_exp_f32 v20, v64
    v_mfma_f32_16x16x32_bf16 v[96:99], a[196:199], a[132:135], v[96:99]
    s_add_u32 s58, s58, 32768
    ds_read_b128 a[224:227], v6 offset:24576
    v_add_f32 v12, v12, v28
    v_mfma_f32_16x16x32_bf16 v[96:99], a[200:203], a[136:139], v[96:99]
    s_cmp_ge_u32 s58, 163840
    s_cselect_b32 s58, 0, s58
    ds_read_b128 a[228:231], v6 offset:25600
    v_exp_f32 v21, v65
    v_mfma_f32_16x16x32_bf16 v[96:99], a[204:207], a[140:143], v[96:99]
    s_bitcmp1_b64 s[62:63], s64
    s_cselect_b32 s66, -1.0, s65
    ds_read_b128 a[232:235], v6 offset:26624
    v_mfma_f32_16x16x32_bf16 v[104:107], a[204:207], a[156:159], v[168:171]
    buffer_load_dwordx4 v7, s[28:31], s57 offen offset:1024 sc1 lds
    v_mfma_f32_16x16x32_bf16 v[104:107], a[200:203], a[152:155], v[104:107]
    s_add_u32 s64, s64, 1
    ds_read_b128 a[236:239], v6 offset:27648
    v_cvt_pk_bf16_f32 v128, v20, v21
    v_mfma_f32_16x16x32_bf16 v[104:107], a[196:199], a[148:151], v[104:107]
    ds_read_b128 a[240:243], v6 offset:28672
    v_exp_f32 v22, v66
    v_mfma_f32_16x16x32_bf16 v[104:107], a[192:195], a[144:147], v[104:107]
    s_waitcnt lgkmcnt(5)
    ds_read_b128 a[244:247], v6 offset:29696
    v_add_f32 v13, v13, v32
    v_mfma_f32_16x16x32_bf16 v[108:111], a[208:211], a[144:147], v[172:175]
    ds_read_b128 a[248:251], v6 offset:30720
    v_exp_f32 v23, v67
    v_mfma_f32_16x16x32_bf16 v[108:111], a[212:215], a[148:151], v[108:111]
    buffer_load_dwordx4 v7, s[28:31], s57 offen offset:2048 sc1 lds
    v_mfma_f32_16x16x32_bf16 v[108:111], a[216:219], a[152:155], v[108:111]
    ds_read_b128 a[252:255], v6 offset:31744
    v_cvt_pk_bf16_f32 v129, v22, v23
    v_mfma_f32_16x16x32_bf16 v[108:111], a[220:223], a[156:159], v[108:111]
    v_exp_f32 v24, v68
    v_mfma_f32_16x16x32_bf16 v[100:103], a[220:223], a[140:143], v[164:167]
    v_exp_f32 v25, v69
    v_mfma_f32_16x16x32_bf16 v[100:103], a[216:219], a[136:139], v[100:103]
    buffer_load_dwordx4 v7, s[28:31], s57 offen offset:3072 sc1 lds
    v_mfma_f32_16x16x32_bf16 v[100:103], a[212:215], a[132:135], v[100:103]
    s_add_u32 s57, s57, 16384
    v_exp_f32 v26, v70
    v_cvt_pk_bf16_f32 v130, v24, v25
    v_mfma_f32_16x16x32_bf16 v[100:103], a[208:211], a[128:131], v[100:103]
    s_waitcnt vmcnt(24) lgkmcnt(0)
    v_add_u32 v6, s58, v2
    v_exp_f32 v27, v71
    v_mfma_f32_16x16x32_bf16 a[0:3], a[224:227], v[144:147], a[0:3]
    s_barrier
    v_mfma_f32_16x16x32_bf16 a[32:35], a[224:227], v[148:151], a[32:35]
    ds_read_b128 a[192:195], v6 offset:0
    v_cvt_pk_bf16_f32 v131, v26, v27
    v_mfma_f32_16x16x32_bf16 a[36:39], a[228:231], v[148:151], a[36:39]
    v_exp_f32 v20, v72
    v_mfma_f32_16x16x32_bf16 v[28:31], v[44:47], v[128:131], 0
    v_exp_f32 v21, v73
    v_mfma_f32_16x16x32_bf16 a[4:7], a[228:231], v[144:147], a[4:7]
    ds_read_b128 a[196:199], v6 offset:1024
    v_cvt_pk_bf16_f32 v132, v20, v21
    v_mfma_f32_16x16x32_bf16 a[8:11], a[232:235], v[144:147], a[8:11]
    v_exp_f32 v22, v74
    v_mfma_f32_16x16x32_bf16 a[40:43], a[232:235], v[148:151], a[40:43]
    ds_read_b128 a[200:203], v6 offset:2048
    v_exp_f32 v23, v75
    v_mfma_f32_16x16x32_bf16 a[44:47], a[236:239], v[148:151], a[44:47]
    v_exp_f32 v24, v76
    v_mfma_f32_16x16x32_bf16 a[12:15], a[236:239], v[144:147], a[12:15]
    ds_read_b128 a[204:207], v6 offset:3072
    v_cvt_pk_bf16_f32 v133, v22, v23
    v_mfma_f32_16x16x32_bf16 a[16:19], a[240:243], v[144:147], a[16:19]
    v_exp_f32 v25, v77
    v_mfma_f32_16x16x32_bf16 a[48:51], a[240:243], v[148:151], a[48:51]
    v_exp_f32 v26, v78
    v_cvt_pk_bf16_f32 v134, v24, v25
    v_mfma_f32_16x16x32_bf16 a[52:55], a[244:247], v[148:151], a[52:55]
    v_exp_f32 v27, v79
    v_mfma_f32_16x16x32_bf16 a[20:23], a[244:247], v[144:147], a[20:23]
    ds_read_b128 a[208:211], v6 offset:4096
    v_cvt_pk_bf16_f32 v135, v26, v27
    s_nop 1
    v_mfma_f32_16x16x32_bf16 v[32:35], v[44:47], v[132:135], 0
    s_nop 2
    v_mfma_f32_16x16x32_bf16 a[24:27], a[248:251], v[144:147], a[24:27]
    ds_read_b128 a[212:215], v6 offset:5120
    s_nop 0
    v_mfma_f32_16x16x32_bf16 a[56:59], a[248:251], v[148:151], a[56:59]
    ds_read_b128 a[216:219], v6 offset:6144
    v_max_f32 v8, v28, v32
    v_mfma_f32_16x16x32_bf16 a[60:63], a[252:255], v[148:151], a[60:63]
    ds_read_b128 a[220:223], v6 offset:7168
    v_cmp_nge_f32 vcc, s66, v8
    v_mfma_f32_16x16x32_bf16 a[28:31], a[252:255], v[144:147], a[28:31]
    s_waitcnt lgkmcnt(4)
    s_cbranch_vccz m_single97
    v_cmp_lt_f32 vcc, s65, v8
    s_cmp_lg_u32 s64, s70
    s_cbranch_scc1 m_e102
    v_add_f32 v160, v160, v16
    v_mov_b32 v164, v9
    v_add_f32 v172, v172, v16
    v_add_f32 v161, v161, v17
    v_mov_b32 v165, v9
    v_add_f32 v173, v173, v17
    v_add_f32 v162, v162, v18
    v_mov_b32 v166, v9
    v_add_f32 v174, v174, v18
    v_add_f32 v163, v163, v19
    v_mov_b32 v167, v9
    v_add_f32 v175, v175, v19
    s_nop 0
m_e102:
    s_cmp_lg_u32 s64, s71
    s_cbranch_scc1 m_e103
    v_mov_b32 v160, v9
    v_mov_b32 v168, v9
    v_mov_b32 v172, v9
    v_mov_b32 v161, v9
    v_mov_b32 v169, v9
    v_mov_b32 v173, v9
    v_mov_b32 v162, v9
    v_mov_b32 v170, v9
    v_mov_b32 v174, v9
    v_mov_b32 v163, v9
    v_mov_b32 v171, v9
    v_mov_b32 v175, v9
    s_nop 0
m_e103:
    s_cmp_lg_u32 s64, s53
    s_cbranch_scc1 m_e106
    s_cmp_lg_u32 s16, 0
    s_cbranch_scc1 m_np107
    v_mov_b32 v60, s4
    v_mov_b32 v61, s5
    s_add_u32 s90, s101, 117440512
    s_mov_b64 exec, 1
    buffer_store_dwordx2 v[60:61], off, s[8:11], s90 sc1
    s_mov_b64 exec, -1
m_np107:
    s_mov_b32 s101, -1
m_e106:
    s_cmp_gt_u32 s64, 24
    s_cbranch_scc1 m_e104
    s_cmp_lg_u32 s64, 8
    s_cbranch_scc1 m_e108
    s_lshr_b32 s90, s32, 1
    s_lshl_b32 s90, s90, 7
    s_add_u32 s90, s90, 117440600
    v_min_u32 v0, 1, v1
    v_lshlrev_b32 v0, 5, v0
    buffer_load_dwordx2 v[4:5], v0, s[8:11], s90 offen sc1
    s_cmp_eq_u32 s17, -1
    s_cbranch_scc1 m_e104
    s_cmp_lg_u32 s16, 0
    s_cbranch_scc1 m_np109
    v_mov_b32 v60, s4
    v_mov_b32 v61, s5
    s_add_u32 s90, s17, 117440512
    s_mov_b64 exec, 1
    buffer_store_dwordx2 v[60:61], off, s[8:11], s90 sc1
    s_mov_b64 exec, -1
m_np109:
    s_branch m_e104
m_e108:
    s_cmp_lg_u32 s64, 16
    s_cbranch_scc1 m_e110
    s_waitcnt vmcnt(18)
    s_mov_b32 s3, 1048576
m_spin111:
    v_cmp_ne_u64 s[76:77], s[4:5], v[4:5]
    s_nop 3
    s_cmp_eq_u64 s[76:77], 0
    s_cbranch_scc1 m_e104
    s_sub_u32 s3, s3, 1
    s_cbranch_scc1 m_e104
    s_sleep 32
    s_lshr_b32 s90, s32, 1
    s_lshl_b32 s90, s90, 7
    s_add_u32 s90, s90, 117440600
    v_min_u32 v0, 1, v1
    v_lshlrev_b32 v0, 5, v0
    buffer_load_dwordx2 v[4:5], v0, s[8:11], s90 offen sc1
    s_waitcnt vmcnt(0)
    s_branch m_spin111
    s_branch m_e104
m_e110:
    s_cmp_lg_u32 s64, 20
    s_cbranch_scc1 m_e112
    buffer_load_dwordx2 v[4:5], v10, s[8:11], 0 offen sc1
    s_mov_b32 s44, s48
    s_mov_b32 s45, s49
    s_mov_b32 s46, 8388608
    s_lshl_b32 s90, s2, 2
    s_add_u32 s90, s90, s16
    s_lshl_b32 s90, s90, 13
    v_lshlrev_b32 v62, 7, v1
    buffer_load_dword v255, v62, s[44:47], s90 offen
    s_branch m_e104
m_e112:
    s_cmp_lg_u32 s64, 24
    s_cbranch_scc1 m_e113
    s_mov_b32 s44, s50
    s_mov_b32 s45, s51
    s_mov_b32 s46, 2097152
    s_lshl_b32 s90, s2, 2
    s_add_u32 s90, s90, s16
    s_lshl_b32 s90, s90, 13
    v_lshlrev_b32 v62, 7, v1
    buffer_load_dword v255, v62, s[44:47], s90 offen
    s_waitcnt vmcnt(18)
    s_mov_b32 s3, 1048576
m_spin114:
    v_cmp_ne_u64 s[76:77], s[4:5], v[4:5]
    s_nop 3
    s_cmp_eq_u64 s[76:77], 0
    s_cbranch_scc1 m_e104
    s_sub_u32 s3, s3, 1
    s_cbranch_scc1 m_e104
    s_sleep 32
    buffer_load_dwordx2 v[4:5], v10, s[8:11], 0 offen sc1
    s_waitcnt vmcnt(0)
    s_branch m_spin114
    s_branch m_e104
m_e113:
m_e104:
    s_cbranch_vccnz m_rc115
m_sp101:
    s_cmp_lg_u32 s64, s72
    s_cbranch_scc1 m_single97
m_singlex98:
    s_bfe_u32 s95, s2, 0x10002
    s_and_b32 s90, s2, 7
    s_bitcmp1_b32 0x63, s90
    s_cselect_b32 s96, s33, s34
    s_sub_u32 s96, s96, 1
    s_and_b32 s90, s2, 1
    s_lshl_b32 s90, s90, 2
    s_bfe_u32 s91, s2, 0x20003
    s_add_u32 s97, s90, s91
    v_and_b32 v10, 31, v1
    v_lshlrev_b32 v10, 3, v10
    s_lshl_b32 s52, s96, 8
    s_add_u32 s52, s52, 117448704
    buffer_load_dwordx2 v[4:5], v10, s[8:11], s52 offen sc1
    ds_read_b128 a[224:227], v6 offset:16384
    ds_read_b128 a[228:231], v6 offset:17408
    ds_read_b128 a[232:235], v6 offset:18432
    ds_read_b128 a[236:239], v6 offset:19456
    ds_read_b128 a[240:243], v6 offset:20480
    ds_read_b128 a[244:247], v6 offset:21504
    ds_read_b128 a[248:251], v6 offset:22528
    ds_read_b128 a[252:255], v6 offset:23552
    s_waitcnt lgkmcnt(0)
    v_mfma_f32_16x16x32_bf16 a[0:3], a[224:227], v[128:131], a[0:3]
    buffer_load_dwordx4 v[192:195], v2, s[8:11], s83 offen offset:0 sc1
    v_exp_f32 v20, v96
    v_mfma_f32_16x16x32_bf16 a[32:35], a[224:227], v[132:135], a[32:35]
    v_exp_f32 v21, v97
    v_exp_f32 v22, v98
    v_mfma_f32_16x16x32_bf16 a[36:39], a[228:231], v[132:135], a[36:39]
    buffer_load_dwordx4 v[196:199], v2, s[8:11], s83 offen offset:1024 sc1
    v_cvt_pk_bf16_f32 v144, v20, v21
    v_add_f32 v12, v12, v28
    v_mfma_f32_16x16x32_bf16 a[4:7], a[228:231], v[128:131], a[4:7]
    v_exp_f32 v23, v99
    v_exp_f32 v24, v100
    v_cvt_pk_bf16_f32 v145, v22, v23
    v_mfma_f32_16x16x32_bf16 a[8:11], a[232:235], v[128:131], a[8:11]
    buffer_load_dwordx4 v[200:203], v2, s[8:11], s83 offen offset:2048 sc1
    v_exp_f32 v25, v101
    v_mfma_f32_16x16x32_bf16 a[40:43], a[232:235], v[132:135], a[40:43]
    v_exp_f32 v26, v102
    v_cvt_pk_bf16_f32 v146, v24, v25
    v_add_f32 v13, v13, v32
    v_mfma_f32_16x16x32_bf16 a[44:47], a[236:239], v[132:135], a[44:47]
    buffer_load_dwordx4 v[204:207], v2, s[8:11], s83 offen offset:3072 sc1
    v_exp_f32 v27, v103
    v_mfma_f32_16x16x32_bf16 a[12:15], a[236:239], v[128:131], a[12:15]
    v_exp_f32 v20, v104
    v_cvt_pk_bf16_f32 v147, v26, v27
    v_mfma_f32_16x16x32_bf16 a[16:19], a[240:243], v[128:131], a[16:19]
    buffer_load_dwordx4 v[212:215], v2, s[8:11], s84 offen offset:0 sc1
    v_exp_f32 v21, v105
    v_mfma_f32_16x16x32_bf16 v[28:31], v[44:47], v[144:147], 0
    v_exp_f32 v22, v106
    v_cvt_pk_bf16_f32 v148, v20, v21
    v_exp_f32 v23, v107
    v_mfma_f32_16x16x32_bf16 a[48:51], a[240:243], v[132:135], a[48:51]
    v_exp_f32 v24, v108
    v_cvt_pk_bf16_f32 v149, v22, v23
    v_exp_f32 v25, v109
    v_mfma_f32_16x16x32_bf16 a[52:55], a[244:247], v[132:135], a[52:55]
    buffer_load_dwordx4 v[216:219], v2, s[8:11], s84 offen offset:1024 sc1
    v_exp_f32 v26, v110
    v_mfma_f32_16x16x32_bf16 a[20:23], a[244:247], v[128:131], a[20:23]
    v_cvt_pk_bf16_f32 v150, v24, v25
    v_exp_f32 v27, v111
    s_nop 0
    v_cvt_pk_bf16_f32 v151, v26, v27
    s_nop 1
    v_mfma_f32_16x16x32_bf16 v[32:35], v[44:47], v[148:151], 0
    s_nop 2
    v_mfma_f32_16x16x32_bf16 a[24:27], a[248:251], v[128:131], a[24:27]
    buffer_load_dwordx4 v[220:223], v2, s[8:11], s84 offen offset:2048 sc1
    v_mfma_f32_16x16x32_bf16 a[56:59], a[248:251], v[132:135], a[56:59]
    s_nop 2
    v_mfma_f32_16x16x32_bf16 a[60:63], a[252:255], v[132:135], a[60:63]
    v_max_f32 v8, v28, v32
    v_cmp_nge_f32 vcc, s65, v8
    v_mfma_f32_16x16x32_bf16 a[28:31], a[252:255], v[128:131], a[28:31]
    s_cbranch_vccnz m_stub116
m_ret117:
    s_nop 1
    s_cmp_ge_u32 s16, 2
    s_cbranch_scc1 m_xb118
    s_waitcnt vmcnt(24)
    s_barrier
m_xb118:
    ds_read_b128 a[224:227], v6 offset:24576
    ds_read_b128 a[228:231], v6 offset:25600
    ds_read_b128 a[232:235], v6 offset:26624
    ds_read_b128 a[236:239], v6 offset:27648
    ds_read_b128 a[240:243], v6 offset:28672
    ds_read_b128 a[244:247], v6 offset:29696
    ds_read_b128 a[248:251], v6 offset:30720
    ds_read_b128 a[252:255], v6 offset:31744
    s_waitcnt lgkmcnt(0)
    v_mfma_f32_16x16x32_bf16 a[0:3], a[224:227], v[144:147], a[0:3]
    buffer_load_dwordx4 v[224:227], v2, s[8:11], s84 offen offset:3072 sc1
    v_mfma_f32_16x16x32_bf16 a[32:35], a[224:227], v[148:151], a[32:35]
    v_mfma_f32_16x16x32_bf16 a[36:39], a[228:231], v[148:151], a[36:39]
    buffer_load_dwordx4 v[208:211], v2, s[8:11], s85 offen offset:0 sc1
    v_mfma_f32_16x16x32_bf16 a[4:7], a[228:231], v[144:147], a[4:7]
    v_mfma_f32_16x16x32_bf16 a[8:11], a[232:235], v[144:147], a[8:11]
    buffer_load_dwordx4 v[232:235], v2, s[8:11], s86 offen offset:0 sc1
    v_mfma_f32_16x16x32_bf16 a[40:43], a[232:235], v[148:151], a[40:43]
    v_mfma_f32_16x16x32_bf16 a[44:47], a[236:239], v[148:151], a[44:47]
    buffer_load_dwordx4 v[236:239], v2, s[8:11], s86 offen offset:1024 sc1
    v_mfma_f32_16x16x32_bf16 a[12:15], a[236:239], v[144:147], a[12:15]
    v_mfma_f32_16x16x32_bf16 a[16:19], a[240:243], v[144:147], a[16:19]
    buffer_load_dwordx4 v[228:231], v2, s[8:11], s87 offen offset:0 sc1
    v_mfma_f32_16x16x32_bf16 a[48:51], a[240:243], v[148:151], a[48:51]
    v_mfma_f32_16x16x32_bf16 a[52:55], a[244:247], v[148:151], a[52:55]
    buffer_load_dwordx4 v[244:247], v2, s[8:11], s88 offen offset:0 sc1
    v_mfma_f32_16x16x32_bf16 a[20:23], a[244:247], v[144:147], a[20:23]
    v_mfma_f32_16x16x32_bf16 a[24:27], a[248:251], v[144:147], a[24:27]
    buffer_load_dwordx4 v[248:251], v2, s[8:11], s88 offen offset:1024 sc1
    v_mfma_f32_16x16x32_bf16 a[56:59], a[248:251], v[148:151], a[56:59]
    v_mfma_f32_16x16x32_bf16 a[60:63], a[252:255], v[148:151], a[60:63]
    buffer_load_dwordx4 v[240:243], v2, s[8:11], s89 offen offset:0 sc1
    v_mfma_f32_16x16x32_bf16 a[28:31], a[252:255], v[144:147], a[28:31]
    v_add_f32 v20, v12, v28
    v_add_f32 v21, v13, v32
    s_nop 3
    v_rcp_f32 v20, v20
    v_rcp_f32 v21, v21
    s_lshl_b32 s90, s78, 10
    s_add_u32 s90, s90, s82
    s_add_u32 s90, s90, 67108864
    v_accvgpr_read_b32 v48, a0
    v_accvgpr_read_b32 v49, a1
    v_accvgpr_read_b32 v50, a2
    v_accvgpr_read_b32 v51, a3
    v_accvgpr_read_b32 v52, a4
    v_accvgpr_read_b32 v53, a5
    v_accvgpr_read_b32 v54, a6
    v_accvgpr_read_b32 v55, a7
    v_mul_f32 v48, v20, v48
    v_mul_f32 v49, v20, v49
    v_mul_f32 v50, v20, v50
    v_mul_f32 v51, v20, v51
    v_mul_f32 v52, v20, v52
    v_mul_f32 v53, v20, v53
    v_mul_f32 v54, v20, v54
    v_mul_f32 v55, v20, v55
    v_cvt_pk_bf16_f32 v48, v48, v49
    v_cvt_pk_bf16_f32 v49, v50, v51
    v_cvt_pk_bf16_f32 v50, v52, v53
    v_cvt_pk_bf16_f32 v51, v54, v55
    buffer_store_dwordx4 v[48:51], v2, s[8:11], s90 offen offset:0 sc1
    v_accvgpr_read_b32 v56, a32
    v_accvgpr_read_b32 v57, a33
    v_accvgpr_read_b32 v58, a34
    v_accvgpr_read_b32 v59, a35
    v_accvgpr_read_b32 v60, a36
    v_accvgpr_read_b32 v61, a37
    v_accvgpr_read_b32 v62, a38
    v_accvgpr_read_b32 v63, a39
    v_mul_f32 v56, v21, v56
    v_mul_f32 v57, v21, v57
    v_mul_f32 v58, v21, v58
    v_mul_f32 v59, v21, v59
    v_mul_f32 v60, v21, v60
    v_mul_f32 v61, v21, v61
    v_mul_f32 v62, v21, v62
    v_mul_f32 v63, v21, v63
    v_cvt_pk_bf16_f32 v56, v56, v57
    v_cvt_pk_bf16_f32 v57, v58, v59
    v_cvt_pk_bf16_f32 v58, v60, v61
    v_cvt_pk_bf16_f32 v59, v62, v63
    buffer_store_dwordx4 v[56:59], v2, s[8:11], s90 offen offset:1024 sc1
    s_add_u32 s90, s90, 131072
    v_accvgpr_read_b32 v48, a8
    v_accvgpr_read_b32 v49, a9
    v_accvgpr_read_b32 v50, a10
    v_accvgpr_read_b32 v51, a11
    v_accvgpr_read_b32 v52, a12
    v_accvgpr_read_b32 v53, a13
    v_accvgpr_read_b32 v54, a14
    v_accvgpr_read_b32 v55, a15
    v_mul_f32 v48, v20, v48
    v_mul_f32 v49, v20, v49
    v_mul_f32 v50, v20, v50
    v_mul_f32 v51, v20, v51
    v_mul_f32 v52, v20, v52
    v_mul_f32 v53, v20, v53
    v_mul_f32 v54, v20, v54
    v_mul_f32 v55, v20, v55
    v_cvt_pk_bf16_f32 v48, v48, v49
    v_cvt_pk_bf16_f32 v49, v50, v51
    v_cvt_pk_bf16_f32 v50, v52, v53
    v_cvt_pk_bf16_f32 v51, v54, v55
    buffer_store_dwordx4 v[48:51], v2, s[8:11], s90 offen offset:0 sc1
    v_accvgpr_read_b32 v56, a40
    v_accvgpr_read_b32 v57, a41
    v_accvgpr_read_b32 v58, a42
    v_accvgpr_read_b32 v59, a43
    v_accvgpr_read_b32 v60, a44
    v_accvgpr_read_b32 v61, a45
    v_accvgpr_read_b32 v62, a46
    v_accvgpr_read_b32 v63, a47
    v_mul_f32 v56, v21, v56
    v_mul_f32 v57, v21, v57
    v_mul_f32 v58, v21, v58
    v_mul_f32 v59, v21, v59
    v_mul_f32 v60, v21, v60
    v_mul_f32 v61, v21, v61
    v_mul_f32 v62, v21, v62
    v_mul_f32 v63, v21, v63
    v_cvt_pk_bf16_f32 v56, v56, v57
    v_cvt_pk_bf16_f32 v57, v58, v59
    v_cvt_pk_bf16_f32 v58, v60, v61
    v_cvt_pk_bf16_f32 v59, v62, v63
    buffer_store_dwordx4 v[56:59], v2, s[8:11], s90 offen offset:1024 sc1
    s_add_u32 s90, s90, 131072
    v_accvgpr_read_b32 v48, a16
    v_accvgpr_read_b32 v49, a17
    v_accvgpr_read_b32 v50, a18
    v_accvgpr_read_b32 v51, a19
    v_accvgpr_read_b32 v52, a20
    v_accvgpr_read_b32 v53, a21
    v_accvgpr_read_b32 v54, a22
    v_accvgpr_read_b32 v55, a23
    v_mul_f32 v48, v20, v48
    v_mul_f32 v49, v20, v49
    v_mul_f32 v50, v20, v50
    v_mul_f32 v51, v20, v51
    v_mul_f32 v52, v20, v52
    v_mul_f32 v53, v20, v53
    v_mul_f32 v54, v20, v54
    v_mul_f32 v55, v20, v55
    v_cvt_pk_bf16_f32 v48, v48, v49
    v_cvt_pk_bf16_f32 v49, v50, v51
    v_cvt_pk_bf16_f32 v50, v52, v53
    v_cvt_pk_bf16_f32 v51, v54, v55
    buffer_store_dwordx4 v[48:51], v2, s[8:11], s90 offen offset:0 sc1
    v_accvgpr_read_b32 v56, a48
    v_accvgpr_read_b32 v57, a49
    v_accvgpr_read_b32 v58, a50
    v_accvgpr_read_b32 v59, a51
    v_accvgpr_read_b32 v60, a52
    v_accvgpr_read_b32 v61, a53
    v_accvgpr_read_b32 v62, a54
    v_accvgpr_read_b32 v63, a55
    v_mul_f32 v56, v21, v56
    v_mul_f32 v57, v21, v57
    v_mul_f32 v58, v21, v58
    v_mul_f32 v59, v21, v59
    v_mul_f32 v60, v21, v60
    v_mul_f32 v61, v21, v61
    v_mul_f32 v62, v21, v62
    v_mul_f32 v63, v21, v63
    v_cvt_pk_bf16_f32 v56, v56, v57
    v_cvt_pk_bf16_f32 v57, v58, v59
    v_cvt_pk_bf16_f32 v58, v60, v61
    v_cvt_pk_bf16_f32 v59, v62, v63
    buffer_store_dwordx4 v[56:59], v2, s[8:11], s90 offen offset:1024 sc1
    s_add_u32 s90, s90, 131072
    v_accvgpr_read_b32 v48, a24
    v_accvgpr_read_b32 v49, a25
    v_accvgpr_read_b32 v50, a26
    v_accvgpr_read_b32 v51, a27
    v_accvgpr_read_b32 v52, a28
    v_accvgpr_read_b32 v53, a29
    v_accvgpr_read_b32 v54, a30
    v_accvgpr_read_b32 v55, a31
    v_mul_f32 v48, v20, v48
    v_mul_f32 v49, v20, v49
    v_mul_f32 v50, v20, v50
    v_mul_f32 v51, v20, v51
    v_mul_f32 v52, v20, v52
    v_mul_f32 v53, v20, v53
    v_mul_f32 v54, v20, v54
    v_mul_f32 v55, v20, v55
    v_cvt_pk_bf16_f32 v48, v48, v49
    v_cvt_pk_bf16_f32 v49, v50, v51
    v_cvt_pk_bf16_f32 v50, v52, v53
    v_cvt_pk_bf16_f32 v51, v54, v55
    buffer_store_dwordx4 v[48:51], v2, s[8:11], s90 offen offset:0 sc1
    v_accvgpr_read_b32 v56, a56
    v_accvgpr_read_b32 v57, a57
    v_accvgpr_read_b32 v58, a58
    v_accvgpr_read_b32 v59, a59
    v_accvgpr_read_b32 v60, a60
    v_accvgpr_read_b32 v61, a61
    v_accvgpr_read_b32 v62, a62
    v_accvgpr_read_b32 v63, a63
    v_mul_f32 v56, v21, v56
    v_mul_f32 v57, v21, v57
    v_mul_f32 v58, v21, v58
    v_mul_f32 v59, v21, v59
    v_mul_f32 v60, v21, v60
    v_mul_f32 v61, v21, v61
    v_mul_f32 v62, v21, v62
    v_mul_f32 v63, v21, v63
    v_cvt_pk_bf16_f32 v56, v56, v57
    v_cvt_pk_bf16_f32 v57, v58, v59
    v_cvt_pk_bf16_f32 v58, v60, v61
    v_cvt_pk_bf16_f32 v59, v62, v63
    buffer_store_dwordx4 v[56:59], v2, s[8:11], s90 offen offset:1024 sc1
    s_add_u32 s90, s90, 131072
    s_lshr_b32 s53, s16, 1
    s_and_b32 s40, s16, 1
    s_mul_i32 s90, s95, 5242880
    s_lshl_b32 s57, s97, 8
    s_add_u32 s57, s57, s90
    v_lshrrev_b32 v20, 4, v1
    s_lshl_b32 s90, s16, 4
    v_add_u32 v21, s90, v20
    v_lshlrev_b32 v21, 11, v21
    v_lshlrev_b32 v20, 1, v20
    v_and_b32 v22, 15, v1
    v_xor_b32 v20, v20, v22
    v_xor_b32 v22, 0, v20
    v_lshl_add_u32 v16, v22, 4, v21
    v_xor_b32 v22, 8, v20
    v_lshl_add_u32 v17, v22, 4, v21
    v_add_u32 v17, 7168, v17
    v_xor_b32 v22, 0, v20
    v_lshl_add_u32 v18, v22, 4, v21
    v_add_u32 v18, 14336, v18
    v_xor_b32 v22, 8, v20
    v_lshl_add_u32 v19, v22, 4, v21
    v_add_u32 v19, 21504, v19
    s_mov_b32 s24, s48
    s_mov_b32 s25, s49
    s_mov_b32 s26, 8388608
    s_mov_b32 s38, 268435456
    s_mov_b32 s28, s54
    s_mov_b32 s29, s55
    s_mov_b32 s30, 8388608
    s_lshl_b32 s90, s96, 13
    s_lshl_b32 s91, s40, 12
    s_add_u32 s90, s90, s91
    s_lshl_b32 s91, s53, 17
    s_add_u32 s69, s90, s91
    s_mul_i32 s90, s95, 10485760
    s_add_u32 s56, s69, s90
    s_add_u32 s56, s56, 67108864
    s_add_u32 s69, s69, 83886080
    s_lshl_b32 s90, s53, 12
    v_add_u32 v6, s90, v2
    v_lshrrev_b32 v48, 2, v1
    v_lshlrev_b32 v48, 8, v48
    v_and_b32 v49, 3, v1
    v_lshl_add_u32 v48, v49, 3, v48
    v_add_u32 v48, 16384, v48
    v_bfe_u32 v49, v1, 2, 3
    s_lshl_b32 s90, s40, 2
    v_xor_b32 v49, s90, v49
    v_xor_b32 v50, 0, v49
    v_lshl_add_u32 v12, v50, 5, v48
    v_xor_b32 v50, 1, v49
    v_lshl_add_u32 v13, v50, 5, v48
    v_xor_b32 v50, 2, v49
    v_lshl_add_u32 v14, v50, 5, v48
    v_xor_b32 v50, 3, v49
    v_lshl_add_u32 v15, v50, 5, v48
    v_and_b32 v48, 15, v1
    v_lshlrev_b32 v48, 12, v48
    v_lshlrev_b32 v48, s95, v48
    v_bfe_u32 v49, v1, 4, 1
    v_lshl_add_u32 v48, v49, 5, v48
    v_lshrrev_b32 v49, 5, v1
    v_lshl_add_u32 v7, v49, 4, v48
    s_lshl_b32 s90, s96, 3
    s_lshl_b32 s91, s53, 2
    s_add_u32 s90, s90, s91
    s_lshl_b32 s91, s90, 16
    s_add_u32 s91, s91, 2048
    s_and_b32 s92, s90, 63
    s_lshl_b32 s92, s92, 17
    s_lshr_b32 s93, s90, 6
    s_lshl_b32 s93, s93, 12
    s_add_u32 s92, s92, s93
    s_cmp_eq_u32 s95, 1
    s_cselect_b32 s71, s92, s91
    s_lshl_b32 s72, 0x10000, s95
    s_lshl_b32 s92, s97, 8
    s_lshl_b32 s93, s40, 7
    s_add_u32 s71, s71, s92
    s_add_u32 s71, s71, s93
    v_mov_b64 v[64:65], 0
    v_mov_b64 v[66:67], 0
    v_mov_b64 v[68:69], 0
    v_mov_b64 v[70:71], 0
    v_mov_b64 v[72:73], 0
    v_mov_b64 v[74:75], 0
    v_mov_b64 v[76:77], 0
    v_mov_b64 v[78:79], 0
    v_mov_b64 v[80:81], 0
    v_mov_b64 v[82:83], 0
    v_mov_b64 v[84:85], 0
    v_mov_b64 v[86:87], 0
    v_mov_b64 v[88:89], 0
    v_mov_b64 v[90:91], 0
    v_mov_b64 v[92:93], 0
    v_mov_b64 v[94:95], 0
    v_mov_b64 v[96:97], 0
    v_mov_b64 v[98:99], 0
    v_mov_b64 v[100:101], 0
    v_mov_b64 v[102:103], 0
    v_mov_b64 v[104:105], 0
    v_mov_b64 v[106:107], 0
    v_mov_b64 v[108:109], 0
    v_mov_b64 v[110:111], 0
    v_mov_b64 v[112:113], 0
    v_mov_b64 v[114:115], 0
    v_mov_b64 v[116:117], 0
    v_mov_b64 v[118:119], 0
    v_mov_b64 v[120:121], 0
    v_mov_b64 v[122:123], 0
    v_mov_b64 v[124:125], 0
    v_mov_b64 v[126:127], 0
    v_and_b32 v48, 15, v1
    v_lshrrev_b32 v49, 4, v1
    v_lshlrev_b32 v49, 2, v49
    v_sub_u32 v48, v48, v49
    v_cmp_ge_i32 vcc, -9, v48
    v_subrev_u32 v50, 0, v48
    v_cmp_ge_u32 s[76:77], 7, v50
    s_nop 0
    v_cndmask_b32 v128, v9, 0, vcc
    v_cndmask_b32 v132, v9, 0, s[76:77]
    v_cmp_ge_i32 vcc, -8, v48
    v_subrev_u32 v50, 1, v48
    v_cmp_ge_u32 s[76:77], 7, v50
    s_nop 0
    v_cndmask_b32 v129, v9, 0, vcc
    v_cndmask_b32 v133, v9, 0, s[76:77]
    v_cmp_ge_i32 vcc, -7, v48
    v_subrev_u32 v50, 2, v48
    v_cmp_ge_u32 s[76:77], 7, v50
    s_nop 0
    v_cndmask_b32 v130, v9, 0, vcc
    v_cndmask_b32 v134, v9, 0, s[76:77]
    v_cmp_ge_i32 vcc, -6, v48
    v_subrev_u32 v50, 3, v48
    v_cmp_ge_u32 s[76:77], 7, v50
    s_nop 0
    v_cndmask_b32 v131, v9, 0, vcc
    v_cndmask_b32 v135, v9, 0, s[76:77]
    s_cmp_eq_u32 s81, 0
    s_cselect_b64 vcc, -1, 0
    s_nop 0
    v_cndmask_b32 v136, v128, v9, vcc
    v_cndmask_b32 v137, v129, v9, vcc
    v_cndmask_b32 v138, v130, v9, vcc
    v_cndmask_b32 v139, v131, v9, vcc
    s_lshl_b32 s90, s80, 10
    s_lshr_b32 s91, s2, 3
    s_lshl_b32 s91, s91, 17
    s_add_u32 s90, s90, s91
    s_add_u32 s80, s90, 83886080
    s_add_u32 s59, s60, 131072
    s_mov_b32 s58, 0
    s_mov_b32 s100, 32768
    s_mov_b32 s64, 0
    s_mov_b32 s67, 0
    s_waitcnt vmcnt(0)
    s_barrier
    s_lshl_b32 s91, s33, 5
    s_add_u32 s91, s91, s32
    s_lshl_b32 s91, s91, 3
    s_add_u32 s91, s91, 7936
    s_cmp_lg_u32 s16, 0
    s_cbranch_scc1 m_np119
    v_mov_b32 v60, s4
    v_mov_b32 v61, s5
    s_add_u32 s90, s91, 117440512
    s_mov_b64 exec, 1
    buffer_store_dwordx2 v[60:61], off, s[8:11], s90 sc1
    s_mov_b64 exec, -1
m_np119:
    s_cmp_eq_u32 s101, -1
    s_cbranch_scc1 m_pb120
    s_cmp_lg_u32 s16, 0
    s_cbranch_scc1 m_np122
    v_mov_b32 v60, s4
    v_mov_b32 v61, s5
    s_add_u32 s90, s101, 117440512
    s_mov_b64 exec, 1
    buffer_store_dwordx2 v[60:61], off, s[8:11], s90 sc1
    s_mov_b64 exec, -1
m_np122:
m_pb120:
    v_cmp_ne_u64 s[76:77], s[4:5], v[4:5]
    s_mul_i32 s91, s95, 20
    s_nop 2
    s_lshr_b32 s90, s76, s91
    s_ff1_i32_b32 s90, s90
    s_lshl_b32 s68, s90, 1
    s_mul_i32 s91, s95, 0
    s_sub_i32 s68, s68, s91
    s_cmp_lt_i32 s90, 0
    s_cselect_b32 s68, 1000, s68
    s_add_u32 m0, s60, 16384
    s_nop 0
    buffer_load_dwordx4 v16, s[24:27], s57 offen offset:0 sc1 lds
    buffer_load_dwordx4 v17, s[24:27], s57 offen offset:1024 sc1 lds
    buffer_load_dwordx4 v18, s[24:27], s57 offen offset:2048 sc1 lds
    buffer_load_dwordx4 v19, s[24:27], s57 offen offset:3072 sc1 lds
    s_add_u32 s57, s57, 131072
    s_add_u32 m0, s60, 49152
    s_nop 0
    buffer_load_dwordx4 v16, s[24:27], s57 offen offset:0 sc1 lds
    buffer_load_dwordx4 v17, s[24:27], s57 offen offset:1024 sc1 lds
    buffer_load_dwordx4 v18, s[24:27], s57 offen offset:2048 sc1 lds
    buffer_load_dwordx4 v19, s[24:27], s57 offen offset:3072 sc1 lds
    s_add_u32 s57, s57, 131072
    s_add_u32 m0, s60, 81920
    s_nop 0
    buffer_load_dwordx4 v16, s[24:27], s57 offen offset:0 sc1 lds
    buffer_load_dwordx4 v17, s[24:27], s57 offen offset:1024 sc1 lds
    buffer_load_dwordx4 v18, s[24:27], s57 offen offset:2048 sc1 lds
    buffer_load_dwordx4 v19, s[24:27], s57 offen offset:3072 sc1 lds
    s_add_u32 s57, s57, 131072
    s_add_u32 m0, s60, 114688
    s_nop 0
    buffer_load_dwordx4 v16, s[24:27], s57 offen offset:0 sc1 lds
    buffer_load_dwordx4 v17, s[24:27], s57 offen offset:1024 sc1 lds
    buffer_load_dwordx4 v18, s[24:27], s57 offen offset:2048 sc1 lds
    buffer_load_dwordx4 v19, s[24:27], s57 offen offset:3072 sc1 lds
    s_add_u32 s57, s57, 131072
    s_cmp_gt_i32 s68, 4
    s_cbranch_scc1 m_x3121
    s_mov_b32 s3, 1048576
m_spin123:
    buffer_load_dwordx2 v[4:5], v10, s[8:11], s52 offen sc1
    s_waitcnt vmcnt(0)
    v_cmp_ne_u64 s[76:77], s[4:5], v[4:5]
    s_mul_i32 s91, s95, 20
    s_nop 2
    s_lshr_b32 s90, s76, s91
    s_ff1_i32_b32 s90, s90
    s_lshl_b32 s68, s90, 1
    s_mul_i32 s91, s95, 0
    s_sub_i32 s68, s68, s91
    s_cmp_lt_i32 s90, 0
    s_cselect_b32 s68, 1000, s68
    s_cmp_gt_i32 s68, 4
    s_cbranch_scc1 m_ok124
    s_sub_u32 s3, s3, 1
    s_cbranch_scc1 m_ok124
    s_sleep 4
    s_branch m_spin123
m_ok124:
m_x3121:
    s_add_u32 m0, s60, 0
    s_nop 0
    buffer_load_dwordx4 v2, s[36:39], s56 offen offset:0 sc1 lds
    buffer_load_dwordx4 v2, s[36:39], s56 offen offset:1024 sc1 lds
    buffer_load_dwordx4 v2, s[36:39], s56 offen offset:2048 sc1 lds
    buffer_load_dwordx4 v2, s[36:39], s56 offen offset:3072 sc1 lds
    s_add_u32 s56, s56, 262144
    s_add_u32 m0, s60, 32768
    s_nop 0
    buffer_load_dwordx4 v2, s[36:39], s56 offen offset:0 sc1 lds
    buffer_load_dwordx4 v2, s[36:39], s56 offen offset:1024 sc1 lds
    buffer_load_dwordx4 v2, s[36:39], s56 offen offset:2048 sc1 lds
    buffer_load_dwordx4 v2, s[36:39], s56 offen offset:3072 sc1 lds
    s_add_u32 s56, s56, 262144
    s_add_u32 m0, s60, 65536
    s_nop 0
    buffer_load_dwordx4 v2, s[36:39], s56 offen offset:0 sc1 lds
    buffer_load_dwordx4 v2, s[36:39], s56 offen offset:1024 sc1 lds
    buffer_load_dwordx4 v2, s[36:39], s56 offen offset:2048 sc1 lds
    buffer_load_dwordx4 v2, s[36:39], s56 offen offset:3072 sc1 lds
    s_add_u32 s56, s56, 262144
    s_add_u32 m0, s60, 98304
    s_nop 0
    buffer_load_dwordx4 v2, s[36:39], s56 offen offset:0 sc1 lds
    buffer_load_dwordx4 v2, s[36:39], s56 offen offset:1024 sc1 lds
    buffer_load_dwordx4 v2, s[36:39], s56 offen offset:2048 sc1 lds
    buffer_load_dwordx4 v2, s[36:39], s56 offen offset:3072 sc1 lds
    s_add_u32 s56, s56, 262144
    s_add_u32 m0, s60, 131072
    s_nop 0
    buffer_load_dwordx4 v2, s[36:39], s56 offen offset:0 sc1 lds
    buffer_load_dwordx4 v2, s[36:39], s56 offen offset:1024 sc1 lds
    buffer_load_dwordx4 v2, s[36:39], s56 offen offset:2048 sc1 lds
    buffer_load_dwordx4 v2, s[36:39], s56 offen offset:3072 sc1 lds
    s_add_u32 s56, s56, 262144
    s_waitcnt vmcnt(16)
    s_barrier
    ds_read_b128 a[0:3], v6 offset:0
    ds_read_b64_tr_b16 a[16:17], v12 offset:0
    ds_read_b64_tr_b16 a[18:19], v12 offset:4096
    ds_read_b128 a[4:7], v6 offset:1024
    ds_read_b128 a[8:11], v6 offset:2048
    ds_read_b128 a[12:15], v6 offset:3072
    ds_read_b64_tr_b16 a[20:21], v13 offset:0
    ds_read_b64_tr_b16 a[22:23], v13 offset:4096
    ds_read_b64_tr_b16 a[24:25], v14 offset:0
    ds_read_b64_tr_b16 a[26:27], v14 offset:4096
    ds_read_b64_tr_b16 a[28:29], v15 offset:0
    ds_read_b64_tr_b16 a[30:31], v15 offset:4096
    s_cmp_gt_i32 s68, 5
    s_cbranch_scc0 m_lp130
m_lr131:
    s_waitcnt lgkmcnt(9)
    v_mfma_f32_16x16x32_bf16 v[64:67], a[16:19], a[0:3], v[64:67]
    s_add_u32 m0, s59, 16384
    ds_read_b128 a[32:35], v6 offset:8192
    v_mfma_f32_16x16x32_bf16 v[148:151], v[208:211], v[192:195], v[136:139]
    v_mfma_f32_16x16x32_bf16 v[152:155], v[212:215], v[192:195], v[132:135]
    s_waitcnt lgkmcnt(9)
    v_mfma_f32_16x16x32_bf16 v[72:75], a[16:19], a[4:7], v[72:75]
    ds_read_b64_tr_b16 a[48:49], v12 offset:8192
    buffer_load_dwordx4 v16, s[24:27], s57 offen offset:0 sc1 lds
    v_mfma_f32_16x16x32_bf16 v[156:159], v[212:215], v[196:199], v[128:131]
    s_waitcnt lgkmcnt(9)
    v_mfma_f32_16x16x32_bf16 v[80:83], a[16:19], a[8:11], v[80:83]
    s_add_u32 s59, s58, s60
    ds_read_b64_tr_b16 a[50:51], v12 offset:12288
    v_mfma_f32_16x16x32_bf16 v[160:163], v[216:219], v[196:199], v[132:135]
    v_mfma_f32_16x16x32_bf16 v[164:167], v[216:219], v[200:203], v[128:131]
    s_waitcnt lgkmcnt(9)
    v_mfma_f32_16x16x32_bf16 v[88:91], a[16:19], a[12:15], v[88:91]
    s_add_u32 s58, s58, 32768
    ds_read_b128 a[36:39], v6 offset:9216
    v_mfma_f32_16x16x32_bf16 v[168:171], v[220:223], v[200:203], v[132:135]
    v_mfma_f32_16x16x32_bf16 v[172:175], v[220:223], v[204:207], v[128:131]
    s_waitcnt lgkmcnt(8)
    v_mfma_f32_16x16x32_bf16 v[68:71], a[20:23], a[0:3], v[68:71]
    s_cmp_ge_u32 s58, 163840
    ds_read_b128 a[40:43], v6 offset:10240
    v_mfma_f32_16x16x32_bf16 v[176:179], v[224:227], v[204:207], v[132:135]
    s_nop 1
    v_mfma_f32_16x16x32_bf16 v[76:79], a[20:23], a[4:7], v[76:79]
    ds_read_b128 a[44:47], v6 offset:11264
    buffer_load_dwordx4 v17, s[24:27], s57 offen offset:1024 sc1 lds
    s_nop 1
    v_mfma_f32_16x16x32_bf16 v[84:87], a[20:23], a[8:11], v[84:87]
    s_cselect_b32 s66, 4294836224, s100
    ds_read_b64_tr_b16 a[52:53], v13 offset:8192
    s_nop 1
    s_nop 1
    v_mfma_f32_16x16x32_bf16 v[92:95], a[20:23], a[12:15], v[92:95]
    s_cselect_b32 s58, 0, s58
    ds_read_b64_tr_b16 a[54:55], v13 offset:12288
    v_max3_f32 v140, v148, v149, v150
    v_max3_f32 v141, v156, v157, v158
    s_waitcnt lgkmcnt(10)
    v_mfma_f32_16x16x32_bf16 v[96:99], a[24:27], a[0:3], v[96:99]
    ds_read_b64_tr_b16 a[56:57], v14 offset:8192
    v_max3_f32 v142, v164, v165, v166
    v_max3_f32 v143, v172, v173, v174
    v_mfma_f32_16x16x32_bf16 v[104:107], a[24:27], a[4:7], v[104:107]
    ds_read_b64_tr_b16 a[58:59], v14 offset:12288
    buffer_load_dwordx4 v18, s[24:27], s57 offen offset:2048 sc1 lds
    v_max3_f32 v140, v140, v151, v152
    v_mfma_f32_16x16x32_bf16 v[112:115], a[24:27], a[8:11], v[112:115]
    ds_read_b64_tr_b16 a[60:61], v15 offset:8192
    v_max3_f32 v141, v141, v159, v160
    v_max3_f32 v142, v142, v167, v168
    v_mfma_f32_16x16x32_bf16 v[120:123], a[24:27], a[12:15], v[120:123]
    ds_read_b64_tr_b16 a[62:63], v15 offset:12288
    v_max3_f32 v143, v143, v175, v176
    v_max3_f32 v140, v140, v153, v154
    s_waitcnt lgkmcnt(12)
    v_mfma_f32_16x16x32_bf16 v[100:103], a[28:31], a[0:3], v[100:103]
    v_add_u32 v6, s66, v6
    v_add_u32 v12, s66, v12
    v_max3_f32 v141, v141, v161, v162
    v_mfma_f32_16x16x32_bf16 v[108:111], a[28:31], a[4:7], v[108:111]
    buffer_load_dwordx4 v19, s[24:27], s57 offen offset:3072 sc1 lds
    v_max3_f32 v142, v142, v169, v170
    v_mfma_f32_16x16x32_bf16 v[116:119], a[28:31], a[8:11], v[116:119]
    s_add_u32 s57, s57, 131072
    v_add_u32 v13, s66, v13
    v_add_u32 v14, s66, v14
    v_max3_f32 v143, v143, v177, v178
    v_mfma_f32_16x16x32_bf16 v[124:127], a[28:31], a[12:15], v[124:127]
    s_mov_b32 m0, s59
    v_add_u32 v15, s66, v15
    v_max_f32 v140, v140, v155
    s_waitcnt vmcnt(16) lgkmcnt(0)
    v_mfma_f32_16x16x32_bf16 v[64:67], a[48:51], a[32:35], v[64:67]
    s_barrier
    v_max_f32 v141, v141, v163
    v_max_f32 v142, v142, v171
    v_mfma_f32_16x16x32_bf16 v[72:75], a[48:51], a[36:39], v[72:75]
    ds_read_b128 a[0:3], v6 offset:0
    buffer_load_dwordx4 v2, s[36:39], s56 offen offset:0 sc1 lds
    v_max_f32 v143, v143, v179
    v_mfma_f32_16x16x32_bf16 v[80:83], a[48:51], a[40:43], v[80:83]
    ds_read_b64_tr_b16 a[16:17], v12 offset:0
    v_mov_b32 v144, v140
    v_mov_b32 v145, v141
    v_mfma_f32_16x16x32_bf16 v[88:91], a[48:51], a[44:47], v[88:91]
    ds_read_b64_tr_b16 a[18:19], v12 offset:4096
    v_mov_b32 v146, v142
    v_mov_b32 v147, v143
    v_mfma_f32_16x16x32_bf16 v[68:71], a[52:55], a[32:35], v[68:71]
    ds_read_b128 a[4:7], v6 offset:1024
    s_nop 1
    v_permlane32_swap_b32 v140, v144
    v_mfma_f32_16x16x32_bf16 v[76:79], a[52:55], a[36:39], v[76:79]
    ds_read_b128 a[8:11], v6 offset:2048
    buffer_load_dwordx4 v2, s[36:39], s56 offen offset:1024 sc1 lds
    v_permlane32_swap_b32 v141, v145
    v_mfma_f32_16x16x32_bf16 v[84:87], a[52:55], a[40:43], v[84:87]
    ds_read_b128 a[12:15], v6 offset:3072
    v_permlane32_swap_b32 v142, v146
    v_permlane32_swap_b32 v143, v147
    v_mfma_f32_16x16x32_bf16 v[92:95], a[52:55], a[44:47], v[92:95]
    ds_read_b64_tr_b16 a[20:21], v13 offset:0
    s_nop 1
    v_max_f32 v140, v140, v144
    v_mfma_f32_16x16x32_bf16 v[96:99], a[56:59], a[32:35], v[96:99]
    ds_read_b64_tr_b16 a[22:23], v13 offset:4096
    v_max_f32 v141, v141, v145
    v_max_f32 v142, v142, v146
    v_mfma_f32_16x16x32_bf16 v[104:107], a[56:59], a[36:39], v[104:107]
    ds_read_b64_tr_b16 a[24:25], v14 offset:0
    buffer_load_dwordx4 v2, s[36:39], s56 offen offset:2048 sc1 lds
    v_max_f32 v143, v143, v147
    v_mfma_f32_16x16x32_bf16 v[112:115], a[56:59], a[40:43], v[112:115]
    ds_read_b64_tr_b16 a[26:27], v14 offset:4096
    v_mov_b32 v144, v140
    v_mov_b32 v145, v141
    v_mfma_f32_16x16x32_bf16 v[120:123], a[56:59], a[44:47], v[120:123]
    ds_read_b64_tr_b16 a[28:29], v15 offset:0
    v_mov_b32 v146, v142
    v_mov_b32 v147, v143
    v_mfma_f32_16x16x32_bf16 v[100:103], a[60:63], a[32:35], v[100:103]
    s_add_u32 s64, s64, 1
    ds_read_b64_tr_b16 a[30:31], v15 offset:4096
    s_nop 1
    v_permlane16_swap_b32 v140, v144
    v_mfma_f32_16x16x32_bf16 v[108:111], a[60:63], a[36:39], v[108:111]
    buffer_load_dwordx4 v2, s[36:39], s56 offen offset:3072 sc1 lds
    v_permlane16_swap_b32 v141, v145
    v_mfma_f32_16x16x32_bf16 v[116:119], a[60:63], a[40:43], v[116:119]
    s_add_u32 s56, s56, 262144
    v_permlane16_swap_b32 v142, v146
    v_permlane16_swap_b32 v143, v147
    v_mfma_f32_16x16x32_bf16 v[124:127], a[60:63], a[44:47], v[124:127]
    s_nop 1
    v_max_f32 v140, v140, v144
    s_cmp_gt_i32 s68, 6
    s_cbranch_scc0 m_lp132
m_lr133:
    s_waitcnt lgkmcnt(9)
    v_mfma_f32_16x16x32_bf16 v[64:67], a[16:19], a[0:3], v[64:67]
    s_add_u32 m0, s59, 16384
    ds_read_b128 a[32:35], v6 offset:8192
    v_max_f32 v141, v141, v145
    v_max_f32 v142, v142, v146
    s_waitcnt lgkmcnt(9)
    v_mfma_f32_16x16x32_bf16 v[72:75], a[16:19], a[4:7], v[72:75]
    ds_read_b64_tr_b16 a[48:49], v12 offset:8192
    buffer_load_dwordx4 v16, s[24:27], s57 offen offset:0 sc1 lds
    v_max_f32 v143, v143, v147
    s_waitcnt lgkmcnt(9)
    v_mfma_f32_16x16x32_bf16 v[80:83], a[16:19], a[8:11], v[80:83]
    s_add_u32 s59, s58, s60
    ds_read_b64_tr_b16 a[50:51], v12 offset:12288
    v_sub_f32 v148, v148, v140
    v_sub_f32 v149, v149, v140
    s_waitcnt lgkmcnt(9)
    v_mfma_f32_16x16x32_bf16 v[88:91], a[16:19], a[12:15], v[88:91]
    s_add_u32 s58, s58, 32768
    ds_read_b128 a[36:39], v6 offset:9216
    v_sub_f32 v150, v150, v140
    v_sub_f32 v151, v151, v140
    s_waitcnt lgkmcnt(8)
    v_mfma_f32_16x16x32_bf16 v[68:71], a[20:23], a[0:3], v[68:71]
    s_cmp_ge_u32 s58, 163840
    ds_read_b128 a[40:43], v6 offset:10240
    v_sub_f32 v152, v152, v140
    v_sub_f32 v153, v153, v140
    v_mfma_f32_16x16x32_bf16 v[76:79], a[20:23], a[4:7], v[76:79]
    ds_read_b128 a[44:47], v6 offset:11264
    buffer_load_dwordx4 v17, s[24:27], s57 offen offset:1024 sc1 lds
    v_sub_f32 v154, v154, v140
    v_mfma_f32_16x16x32_bf16 v[84:87], a[20:23], a[8:11], v[84:87]
    s_cselect_b32 s66, 4294836224, s100
    ds_read_b64_tr_b16 a[52:53], v13 offset:8192
    v_sub_f32 v155, v155, v140
    v_sub_f32 v156, v156, v141
    v_mfma_f32_16x16x32_bf16 v[92:95], a[20:23], a[12:15], v[92:95]
    s_cselect_b32 s58, 0, s58
    ds_read_b64_tr_b16 a[54:55], v13 offset:12288
    v_sub_f32 v157, v157, v141
    v_sub_f32 v158, v158, v141
    s_waitcnt lgkmcnt(10)
    v_mfma_f32_16x16x32_bf16 v[96:99], a[24:27], a[0:3], v[96:99]
    ds_read_b64_tr_b16 a[56:57], v14 offset:8192
    v_sub_f32 v159, v159, v141
    v_sub_f32 v160, v160, v141
    v_mfma_f32_16x16x32_bf16 v[104:107], a[24:27], a[4:7], v[104:107]
    ds_read_b64_tr_b16 a[58:59], v14 offset:12288
    buffer_load_dwordx4 v18, s[24:27], s57 offen offset:2048 sc1 lds
    v_sub_f32 v161, v161, v141
    v_mfma_f32_16x16x32_bf16 v[112:115], a[24:27], a[8:11], v[112:115]
    ds_read_b64_tr_b16 a[60:61], v15 offset:8192
    v_sub_f32 v162, v162, v141
    v_sub_f32 v163, v163, v141
    v_mfma_f32_16x16x32_bf16 v[120:123], a[24:27], a[12:15], v[120:123]
    ds_read_b64_tr_b16 a[62:63], v15 offset:12288
    v_sub_f32 v164, v164, v142
    v_sub_f32 v165, v165, v142
    s_waitcnt lgkmcnt(12)
    v_mfma_f32_16x16x32_bf16 v[100:103], a[28:31], a[0:3], v[100:103]
    v_add_u32 v6, s66, v6
    v_add_u32 v12, s66, v12
    v_sub_f32 v166, v166, v142
    v_mfma_f32_16x16x32_bf16 v[108:111], a[28:31], a[4:7], v[108:111]
    buffer_load_dwordx4 v19, s[24:27], s57 offen offset:3072 sc1 lds
    v_sub_f32 v167, v167, v142
    v_mfma_f32_16x16x32_bf16 v[116:119], a[28:31], a[8:11], v[116:119]
    s_add_u32 s57, s57, 131072
    v_add_u32 v13, s66, v13
    v_add_u32 v14, s66, v14
    v_sub_f32 v168, v168, v142
    v_mfma_f32_16x16x32_bf16 v[124:127], a[28:31], a[12:15], v[124:127]
    s_mov_b32 m0, s59
    v_add_u32 v15, s66, v15
    v_sub_f32 v169, v169, v142
    s_waitcnt vmcnt(20) lgkmcnt(0)
    v_mfma_f32_16x16x32_bf16 v[64:67], a[48:51], a[32:35], v[64:67]
    s_barrier
    v_sub_f32 v170, v170, v142
    v_sub_f32 v171, v171, v142
    v_mfma_f32_16x16x32_bf16 v[72:75], a[48:51], a[36:39], v[72:75]
    ds_read_b128 a[0:3], v6 offset:0
    buffer_load_dwordx4 v2, s[36:39], s56 offen offset:0 sc1 lds
    v_sub_f32 v172, v172, v143
    v_mfma_f32_16x16x32_bf16 v[80:83], a[48:51], a[40:43], v[80:83]
    ds_read_b64_tr_b16 a[16:17], v12 offset:0
    v_sub_f32 v173, v173, v143
    v_sub_f32 v174, v174, v143
    v_mfma_f32_16x16x32_bf16 v[88:91], a[48:51], a[44:47], v[88:91]
    ds_read_b64_tr_b16 a[18:19], v12 offset:4096
    v_sub_f32 v175, v175, v143
    v_sub_f32 v176, v176, v143
    v_mfma_f32_16x16x32_bf16 v[68:71], a[52:55], a[32:35], v[68:71]
    ds_read_b128 a[4:7], v6 offset:1024
    v_sub_f32 v177, v177, v143
    v_sub_f32 v178, v178, v143
    v_mfma_f32_16x16x32_bf16 v[76:79], a[52:55], a[36:39], v[76:79]
    ds_read_b128 a[8:11], v6 offset:2048
    buffer_load_dwordx4 v2, s[36:39], s56 offen offset:1024 sc1 lds
    v_sub_f32 v179, v179, v143
    v_mfma_f32_16x16x32_bf16 v[84:87], a[52:55], a[40:43], v[84:87]
    ds_read_b128 a[12:15], v6 offset:3072
    v_exp_f32 v148, v148
    v_exp_f32 v149, v149
    v_mfma_f32_16x16x32_bf16 v[92:95], a[52:55], a[44:47], v[92:95]
    ds_read_b64_tr_b16 a[20:21], v13 offset:0
    v_exp_f32 v150, v150
    v_exp_f32 v151, v151
    v_mfma_f32_16x16x32_bf16 v[96:99], a[56:59], a[32:35], v[96:99]
    ds_read_b64_tr_b16 a[22:23], v13 offset:4096
    v_exp_f32 v152, v152
    v_exp_f32 v153, v153
    v_mfma_f32_16x16x32_bf16 v[104:107], a[56:59], a[36:39], v[104:107]
    ds_read_b64_tr_b16 a[24:25], v14 offset:0
    buffer_load_dwordx4 v2, s[36:39], s56 offen offset:2048 sc1 lds
    v_exp_f32 v154, v154
    v_mfma_f32_16x16x32_bf16 v[112:115], a[56:59], a[40:43], v[112:115]
    ds_read_b64_tr_b16 a[26:27], v14 offset:4096
    v_exp_f32 v155, v155
    v_exp_f32 v156, v156
    v_mfma_f32_16x16x32_bf16 v[120:123], a[56:59], a[44:47], v[120:123]
    ds_read_b64_tr_b16 a[28:29], v15 offset:0
    v_exp_f32 v157, v157
    v_exp_f32 v158, v158
    v_mfma_f32_16x16x32_bf16 v[100:103], a[60:63], a[32:35], v[100:103]
    s_add_u32 s64, s64, 1
    ds_read_b64_tr_b16 a[30:31], v15 offset:4096
    v_exp_f32 v159, v159
    v_exp_f32 v160, v160
    v_mfma_f32_16x16x32_bf16 v[108:111], a[60:63], a[36:39], v[108:111]
    buffer_load_dwordx4 v2, s[36:39], s56 offen offset:3072 sc1 lds
    v_exp_f32 v161, v161
    v_mfma_f32_16x16x32_bf16 v[116:119], a[60:63], a[40:43], v[116:119]
    s_add_u32 s56, s56, 262144
    v_exp_f32 v162, v162
    v_exp_f32 v163, v163
    v_mfma_f32_16x16x32_bf16 v[124:127], a[60:63], a[44:47], v[124:127]
    v_exp_f32 v164, v164
    v_exp_f32 v165, v165
    s_cmp_gt_i32 s68, 7
    s_cbranch_scc0 m_lp134
m_lr135:
    s_waitcnt lgkmcnt(9)
    v_mfma_f32_16x16x32_bf16 v[64:67], a[16:19], a[0:3], v[64:67]
    s_add_u32 m0, s59, 16384
    ds_read_b128 a[32:35], v6 offset:8192
    v_exp_f32 v166, v166
    v_exp_f32 v167, v167
    s_waitcnt lgkmcnt(9)
    v_mfma_f32_16x16x32_bf16 v[72:75], a[16:19], a[4:7], v[72:75]
    ds_read_b64_tr_b16 a[48:49], v12 offset:8192
    buffer_load_dwordx4 v16, s[24:27], s57 offen offset:0 sc1 lds
    v_exp_f32 v168, v168
    s_waitcnt lgkmcnt(9)
    v_mfma_f32_16x16x32_bf16 v[80:83], a[16:19], a[8:11], v[80:83]
    s_add_u32 s59, s58, s60
    ds_read_b64_tr_b16 a[50:51], v12 offset:12288
    v_exp_f32 v169, v169
    v_exp_f32 v170, v170
    s_waitcnt lgkmcnt(9)
    v_mfma_f32_16x16x32_bf16 v[88:91], a[16:19], a[12:15], v[88:91]
    s_add_u32 s58, s58, 32768
    ds_read_b128 a[36:39], v6 offset:9216
    v_exp_f32 v171, v171
    v_exp_f32 v172, v172
    s_waitcnt lgkmcnt(8)
    v_mfma_f32_16x16x32_bf16 v[68:71], a[20:23], a[0:3], v[68:71]
    s_cmp_ge_u32 s58, 163840
    ds_read_b128 a[40:43], v6 offset:10240
    v_exp_f32 v173, v173
    v_exp_f32 v174, v174
    v_mfma_f32_16x16x32_bf16 v[76:79], a[20:23], a[4:7], v[76:79]
    ds_read_b128 a[44:47], v6 offset:11264
    buffer_load_dwordx4 v17, s[24:27], s57 offen offset:1024 sc1 lds
    v_exp_f32 v175, v175
    v_mfma_f32_16x16x32_bf16 v[84:87], a[20:23], a[8:11], v[84:87]
    s_cselect_b32 s66, 4294836224, s100
    ds_read_b64_tr_b16 a[52:53], v13 offset:8192
    v_exp_f32 v176, v176
    v_exp_f32 v177, v177
    v_mfma_f32_16x16x32_bf16 v[92:95], a[20:23], a[12:15], v[92:95]
    s_cselect_b32 s58, 0, s58
    ds_read_b64_tr_b16 a[54:55], v13 offset:12288
    v_exp_f32 v178, v178
    v_exp_f32 v179, v179
    s_waitcnt lgkmcnt(10)
    v_mfma_f32_16x16x32_bf16 v[96:99], a[24:27], a[0:3], v[96:99]
    ds_read_b64_tr_b16 a[56:57], v14 offset:8192
    v_cvt_pk_bf16_f32 v192, v148, v149
    v_cvt_pk_bf16_f32 v193, v150, v151
    v_mfma_f32_16x16x32_bf16 v[104:107], a[24:27], a[4:7], v[104:107]
    ds_read_b64_tr_b16 a[58:59], v14 offset:12288
    buffer_load_dwordx4 v18, s[24:27], s57 offen offset:2048 sc1 lds
    v_cvt_pk_bf16_f32 v194, v152, v153
    v_mfma_f32_16x16x32_bf16 v[112:115], a[24:27], a[8:11], v[112:115]
    ds_read_b64_tr_b16 a[60:61], v15 offset:8192
    v_cvt_pk_bf16_f32 v195, v154, v155
    v_cvt_pk_bf16_f32 v196, v156, v157
    v_mfma_f32_16x16x32_bf16 v[120:123], a[24:27], a[12:15], v[120:123]
    ds_read_b64_tr_b16 a[62:63], v15 offset:12288
    v_cvt_pk_bf16_f32 v197, v158, v159
    v_cvt_pk_bf16_f32 v198, v160, v161
    s_waitcnt lgkmcnt(12)
    v_mfma_f32_16x16x32_bf16 v[100:103], a[28:31], a[0:3], v[100:103]
    v_add_u32 v6, s66, v6
    v_add_u32 v12, s66, v12
    v_cvt_pk_bf16_f32 v199, v162, v163
    v_mfma_f32_16x16x32_bf16 v[108:111], a[28:31], a[4:7], v[108:111]
    buffer_load_dwordx4 v19, s[24:27], s57 offen offset:3072 sc1 lds
    v_cvt_pk_bf16_f32 v200, v164, v165
    v_mfma_f32_16x16x32_bf16 v[116:119], a[28:31], a[8:11], v[116:119]
    s_add_u32 s57, s57, 131072
    v_add_u32 v13, s66, v13
    v_add_u32 v14, s66, v14
    v_cvt_pk_bf16_f32 v201, v166, v167
    v_mfma_f32_16x16x32_bf16 v[124:127], a[28:31], a[12:15], v[124:127]
    s_mov_b32 m0, s59
    v_add_u32 v15, s66, v15
    v_cvt_pk_bf16_f32 v202, v168, v169
    s_waitcnt vmcnt(24) lgkmcnt(0)
    v_mfma_f32_16x16x32_bf16 v[64:67], a[48:51], a[32:35], v[64:67]
    s_barrier
    v_cvt_pk_bf16_f32 v203, v170, v171
    v_cvt_pk_bf16_f32 v204, v172, v173
    v_mfma_f32_16x16x32_bf16 v[72:75], a[48:51], a[36:39], v[72:75]
    ds_read_b128 a[0:3], v6 offset:0
    buffer_load_dwordx4 v2, s[36:39], s56 offen offset:0 sc1 lds
    v_cvt_pk_bf16_f32 v205, v174, v175
    v_mfma_f32_16x16x32_bf16 v[80:83], a[48:51], a[40:43], v[80:83]
    ds_read_b64_tr_b16 a[16:17], v12 offset:0
    v_cvt_pk_bf16_f32 v206, v176, v177
    v_cvt_pk_bf16_f32 v207, v178, v179
    v_mfma_f32_16x16x32_bf16 v[88:91], a[48:51], a[44:47], v[88:91]
    ds_read_b64_tr_b16 a[18:19], v12 offset:4096
    s_nop 1
    v_mfma_f32_16x16x32_bf16 v[20:23], v[44:47], v[192:195], 0
    v_mfma_f32_16x16x32_bf16 v[68:71], a[52:55], a[32:35], v[68:71]
    ds_read_b128 a[4:7], v6 offset:1024
    v_mfma_f32_16x16x32_bf16 v[24:27], v[44:47], v[196:199], 0
    v_mfma_f32_16x16x32_bf16 v[28:31], v[44:47], v[200:203], 0
    v_mfma_f32_16x16x32_bf16 v[76:79], a[52:55], a[36:39], v[76:79]
    ds_read_b128 a[8:11], v6 offset:2048
    buffer_load_dwordx4 v2, s[36:39], s56 offen offset:1024 sc1 lds
    v_mfma_f32_16x16x32_bf16 v[32:35], v[44:47], v[204:207], 0
    v_mfma_f32_16x16x32_bf16 v[84:87], a[52:55], a[40:43], v[84:87]
    ds_read_b128 a[12:15], v6 offset:3072
    v_mfma_f32_16x16x32_bf16 v[148:151], v[230:233], v[192:195], 0
    v_mfma_f32_16x16x32_bf16 v[152:155], v[242:245], v[192:195], 0
    v_mfma_f32_16x16x32_bf16 v[92:95], a[52:55], a[44:47], v[92:95]
    ds_read_b64_tr_b16 a[20:21], v13 offset:0
    v_mfma_f32_16x16x32_bf16 v[156:159], v[232:235], v[196:199], 0
    v_mfma_f32_16x16x32_bf16 v[160:163], v[244:247], v[196:199], 0
    v_mfma_f32_16x16x32_bf16 v[96:99], a[56:59], a[32:35], v[96:99]
    ds_read_b64_tr_b16 a[22:23], v13 offset:4096
    v_mfma_f32_16x16x32_bf16 v[164:167], v[234:237], v[200:203], 0
    v_mfma_f32_16x16x32_bf16 v[168:171], v[246:249], v[200:203], 0
    v_mfma_f32_16x16x32_bf16 v[104:107], a[56:59], a[36:39], v[104:107]
    ds_read_b64_tr_b16 a[24:25], v14 offset:0
    buffer_load_dwordx4 v2, s[36:39], s56 offen offset:2048 sc1 lds
    v_mfma_f32_16x16x32_bf16 v[172:175], v[236:239], v[204:207], 0
    v_mfma_f32_16x16x32_bf16 v[112:115], a[56:59], a[40:43], v[112:115]
    ds_read_b64_tr_b16 a[26:27], v14 offset:4096
    v_mfma_f32_16x16x32_bf16 v[176:179], v[248:251], v[204:207], 0
    v_rcp_f32 v140, v20
    v_mfma_f32_16x16x32_bf16 v[120:123], a[56:59], a[44:47], v[120:123]
    ds_read_b64_tr_b16 a[28:29], v15 offset:0
    v_rcp_f32 v141, v24
    v_rcp_f32 v142, v28
    v_mfma_f32_16x16x32_bf16 v[100:103], a[60:63], a[32:35], v[100:103]
    s_add_u32 s64, s64, 1
    ds_read_b64_tr_b16 a[30:31], v15 offset:4096
    v_rcp_f32 v143, v32
    s_nop 1
    v_mfma_f32_16x16x32_bf16 v[108:111], a[60:63], a[36:39], v[108:111]
    buffer_load_dwordx4 v2, s[36:39], s56 offen offset:3072 sc1 lds
    s_nop 1
    v_mfma_f32_16x16x32_bf16 v[116:119], a[60:63], a[40:43], v[116:119]
    s_add_u32 s56, s56, 262144
    v_mul_f32 v148, v148, v140
    v_mul_f32 v149, v149, v140
    v_mfma_f32_16x16x32_bf16 v[124:127], a[60:63], a[44:47], v[124:127]
    v_mul_f32 v150, v150, v140
    v_mul_f32 v151, v151, v140
    s_cmp_gt_i32 s68, 8
    s_cbranch_scc0 m_lp136
m_lr137:
    s_waitcnt lgkmcnt(9)
    v_mfma_f32_16x16x32_bf16 v[64:67], a[16:19], a[0:3], v[64:67]
    s_add_u32 m0, s59, 16384
    ds_read_b128 a[32:35], v6 offset:8192
    v_mul_f32 v152, v152, v140
    v_mul_f32 v153, v153, v140
    s_waitcnt lgkmcnt(9)
    v_mfma_f32_16x16x32_bf16 v[72:75], a[16:19], a[4:7], v[72:75]
    ds_read_b64_tr_b16 a[48:49], v12 offset:8192
    buffer_load_dwordx4 v16, s[24:27], s57 offen offset:0 sc1 lds
    v_mul_f32 v154, v154, v140
    s_waitcnt lgkmcnt(9)
    v_mfma_f32_16x16x32_bf16 v[80:83], a[16:19], a[8:11], v[80:83]
    s_add_u32 s59, s58, s60
    ds_read_b64_tr_b16 a[50:51], v12 offset:12288
    v_mul_f32 v155, v155, v140
    v_cvt_pk_bf16_f32 v148, v148, v149
    s_waitcnt lgkmcnt(9)
    v_mfma_f32_16x16x32_bf16 v[88:91], a[16:19], a[12:15], v[88:91]
    s_add_u32 s58, s58, 32768
    ds_read_b128 a[36:39], v6 offset:9216
    v_cvt_pk_bf16_f32 v149, v150, v151
    v_cvt_pk_bf16_f32 v150, v152, v153
    s_waitcnt lgkmcnt(8)
    v_mfma_f32_16x16x32_bf16 v[68:71], a[20:23], a[0:3], v[68:71]
    s_cmp_ge_u32 s58, 163840
    ds_read_b128 a[40:43], v6 offset:10240
    v_cvt_pk_bf16_f32 v151, v154, v155
    buffer_store_dwordx4 v[148:151], v2, s[8:11], s80 offen offset:0 sc1
    v_mfma_f32_16x16x32_bf16 v[76:79], a[20:23], a[4:7], v[76:79]
    ds_read_b128 a[44:47], v6 offset:11264
    buffer_load_dwordx4 v17, s[24:27], s57 offen offset:1024 sc1 lds
    v_mul_f32 v156, v156, v141
    v_mfma_f32_16x16x32_bf16 v[84:87], a[20:23], a[8:11], v[84:87]
    s_cselect_b32 s66, 4294836224, s100
    ds_read_b64_tr_b16 a[52:53], v13 offset:8192
    v_mul_f32 v157, v157, v141
    v_mul_f32 v158, v158, v141
    v_mfma_f32_16x16x32_bf16 v[92:95], a[20:23], a[12:15], v[92:95]
    s_cselect_b32 s58, 0, s58
    ds_read_b64_tr_b16 a[54:55], v13 offset:12288
    v_mul_f32 v159, v159, v141
    v_mul_f32 v160, v160, v141
    s_waitcnt lgkmcnt(10)
    v_mfma_f32_16x16x32_bf16 v[96:99], a[24:27], a[0:3], v[96:99]
    ds_read_b64_tr_b16 a[56:57], v14 offset:8192
    v_mul_f32 v161, v161, v141
    v_mul_f32 v162, v162, v141
    v_mfma_f32_16x16x32_bf16 v[104:107], a[24:27], a[4:7], v[104:107]
    ds_read_b64_tr_b16 a[58:59], v14 offset:12288
    buffer_load_dwordx4 v18, s[24:27], s57 offen offset:2048 sc1 lds
    v_mul_f32 v163, v163, v141
    v_mfma_f32_16x16x32_bf16 v[112:115], a[24:27], a[8:11], v[112:115]
    ds_read_b64_tr_b16 a[60:61], v15 offset:8192
    v_cvt_pk_bf16_f32 v156, v156, v157
    v_cvt_pk_bf16_f32 v157, v158, v159
    v_mfma_f32_16x16x32_bf16 v[120:123], a[24:27], a[12:15], v[120:123]
    ds_read_b64_tr_b16 a[62:63], v15 offset:12288
    v_cvt_pk_bf16_f32 v158, v160, v161
    v_cvt_pk_bf16_f32 v159, v162, v163
    s_waitcnt lgkmcnt(12)
    v_mfma_f32_16x16x32_bf16 v[100:103], a[28:31], a[0:3], v[100:103]
    v_add_u32 v6, s66, v6
    v_add_u32 v12, s66, v12
    buffer_store_dwordx4 v[156:159], v2, s[8:11], s80 offen offset:1024 sc1
    v_mfma_f32_16x16x32_bf16 v[108:111], a[28:31], a[4:7], v[108:111]
    buffer_load_dwordx4 v19, s[24:27], s57 offen offset:3072 sc1 lds
    v_mul_f32 v164, v164, v142
    v_mfma_f32_16x16x32_bf16 v[116:119], a[28:31], a[8:11], v[116:119]
    s_add_u32 s57, s57, 131072
    v_add_u32 v13, s66, v13
    v_add_u32 v14, s66, v14
    v_mul_f32 v165, v165, v142
    v_mfma_f32_16x16x32_bf16 v[124:127], a[28:31], a[12:15], v[124:127]
    s_mov_b32 m0, s59
    v_add_u32 v15, s66, v15
    v_mul_f32 v166, v166, v142
    s_waitcnt vmcnt(24) lgkmcnt(0)
    v_mfma_f32_16x16x32_bf16 v[64:67], a[48:51], a[32:35], v[64:67]
    s_barrier
    v_mul_f32 v167, v167, v142
    v_mul_f32 v168, v168, v142
    v_mfma_f32_16x16x32_bf16 v[72:75], a[48:51], a[36:39], v[72:75]
    ds_read_b128 a[0:3], v6 offset:0
    buffer_load_dwordx4 v2, s[36:39], s56 offen offset:0 sc1 lds
    v_mul_f32 v169, v169, v142
    v_mfma_f32_16x16x32_bf16 v[80:83], a[48:51], a[40:43], v[80:83]
    ds_read_b64_tr_b16 a[16:17], v12 offset:0
    v_mul_f32 v170, v170, v142
    v_mul_f32 v171, v171, v142
    v_mfma_f32_16x16x32_bf16 v[88:91], a[48:51], a[44:47], v[88:91]
    ds_read_b64_tr_b16 a[18:19], v12 offset:4096
    v_cvt_pk_bf16_f32 v164, v164, v165
    v_cvt_pk_bf16_f32 v165, v166, v167
    v_mfma_f32_16x16x32_bf16 v[68:71], a[52:55], a[32:35], v[68:71]
    ds_read_b128 a[4:7], v6 offset:1024
    v_cvt_pk_bf16_f32 v166, v168, v169
    v_cvt_pk_bf16_f32 v167, v170, v171
    v_mfma_f32_16x16x32_bf16 v[76:79], a[52:55], a[36:39], v[76:79]
    ds_read_b128 a[8:11], v6 offset:2048
    buffer_load_dwordx4 v2, s[36:39], s56 offen offset:1024 sc1 lds
    buffer_store_dwordx4 v[164:167], v2, s[8:11], s80 offen offset:2048 sc1
    v_mfma_f32_16x16x32_bf16 v[84:87], a[52:55], a[40:43], v[84:87]
    ds_read_b128 a[12:15], v6 offset:3072
    v_mul_f32 v172, v172, v143
    v_mul_f32 v173, v173, v143
    v_mfma_f32_16x16x32_bf16 v[92:95], a[52:55], a[44:47], v[92:95]
    ds_read_b64_tr_b16 a[20:21], v13 offset:0
    v_mul_f32 v174, v174, v143
    v_mul_f32 v175, v175, v143
    v_mfma_f32_16x16x32_bf16 v[96:99], a[56:59], a[32:35], v[96:99]
    ds_read_b64_tr_b16 a[22:23], v13 offset:4096
    v_mul_f32 v176, v176, v143
    v_mul_f32 v177, v177, v143
    v_mfma_f32_16x16x32_bf16 v[104:107], a[56:59], a[36:39], v[104:107]
    ds_read_b64_tr_b16 a[24:25], v14 offset:0
    buffer_load_dwordx4 v2, s[36:39], s56 offen offset:2048 sc1 lds
    v_mul_f32 v178, v178, v143
    v_mfma_f32_16x16x32_bf16 v[112:115], a[56:59], a[40:43], v[112:115]
    ds_read_b64_tr_b16 a[26:27], v14 offset:4096
    v_mul_f32 v179, v179, v143
    v_cvt_pk_bf16_f32 v172, v172, v173
    v_mfma_f32_16x16x32_bf16 v[120:123], a[56:59], a[44:47], v[120:123]
    ds_read_b64_tr_b16 a[28:29], v15 offset:0
    v_cvt_pk_bf16_f32 v173, v174, v175
    v_cvt_pk_bf16_f32 v174, v176, v177
    v_mfma_f32_16x16x32_bf16 v[100:103], a[60:63], a[32:35], v[100:103]
    s_add_u32 s64, s64, 1
    ds_read_b64_tr_b16 a[30:31], v15 offset:4096
    v_cvt_pk_bf16_f32 v175, v178, v179
    buffer_store_dwordx4 v[172:175], v2, s[8:11], s80 offen offset:3072 sc1
    v_mfma_f32_16x16x32_bf16 v[108:111], a[60:63], a[36:39], v[108:111]
    buffer_load_dwordx4 v2, s[36:39], s56 offen offset:3072 sc1 lds
    v_mfma_f32_16x16x32_bf16 v[116:119], a[60:63], a[40:43], v[116:119]
    s_add_u32 s56, s56, 262144
    v_mfma_f32_16x16x32_bf16 v[124:127], a[60:63], a[44:47], v[124:127]
    s_branch m_l3e126
m_lp130:
    s_mov_b32 s3, 1048576
m_spin138:
    buffer_load_dwordx2 v[4:5], v10, s[8:11], s52 offen sc1
    s_waitcnt vmcnt(0)
    v_cmp_ne_u64 s[76:77], s[4:5], v[4:5]
    s_mul_i32 s91, s95, 20
    s_nop 2
    s_lshr_b32 s90, s76, s91
    s_ff1_i32_b32 s90, s90
    s_lshl_b32 s68, s90, 1
    s_mul_i32 s91, s95, 0
    s_sub_i32 s68, s68, s91
    s_cmp_lt_i32 s90, 0
    s_cselect_b32 s68, 1000, s68
    s_cmp_gt_i32 s68, 5
    s_cbranch_scc1 m_ok139
    s_sub_u32 s3, s3, 1
    s_cbranch_scc1 m_ok139
    s_sleep 4
    s_branch m_spin138
m_ok139:
    s_branch m_lr131
m_lp132:
    s_mov_b32 s3, 1048576
m_spin140:
    buffer_load_dwordx2 v[4:5], v10, s[8:11], s52 offen sc1
    s_waitcnt vmcnt(0)
    v_cmp_ne_u64 s[76:77], s[4:5], v[4:5]
    s_mul_i32 s91, s95, 20
    s_nop 2
    s_lshr_b32 s90, s76, s91
    s_ff1_i32_b32 s90, s90
    s_lshl_b32 s68, s90, 1
    s_mul_i32 s91, s95, 0
    s_sub_i32 s68, s68, s91
    s_cmp_lt_i32 s90, 0
    s_cselect_b32 s68, 1000, s68
    s_cmp_gt_i32 s68, 6
    s_cbranch_scc1 m_ok141
    s_sub_u32 s3, s3, 1
    s_cbranch_scc1 m_ok141
    s_sleep 4
    s_branch m_spin140
m_ok141:
    s_branch m_lr133
m_lp134:
    s_mov_b32 s3, 1048576
m_spin142:
    buffer_load_dwordx2 v[4:5], v10, s[8:11], s52 offen sc1
    s_waitcnt vmcnt(0)
    v_cmp_ne_u64 s[76:77], s[4:5], v[4:5]
    s_mul_i32 s91, s95, 20
    s_nop 2
    s_lshr_b32 s90, s76, s91
    s_ff1_i32_b32 s90, s90
    s_lshl_b32 s68, s90, 1
    s_mul_i32 s91, s95, 0
    s_sub_i32 s68, s68, s91
    s_cmp_lt_i32 s90, 0
    s_cselect_b32 s68, 1000, s68
    s_cmp_gt_i32 s68, 7
    s_cbranch_scc1 m_ok143
    s_sub_u32 s3, s3, 1
    s_cbranch_scc1 m_ok143
    s_sleep 4
    s_branch m_spin142
m_ok143:
    s_branch m_lr135
m_lp136:
    s_mov_b32 s3, 1048576
m_spin144:
    buffer_load_dwordx2 v[4:5], v10, s[8:11], s52 offen sc1
    s_waitcnt vmcnt(0)
    v_cmp_ne_u64 s[76:77], s[4:5], v[4:5]
    s_mul_i32 s91, s95, 20
    s_nop 2
    s_lshr_b32 s90, s76, s91
    s_ff1_i32_b32 s90, s90
    s_lshl_b32 s68, s90, 1
    s_mul_i32 s91, s95, 0
    s_sub_i32 s68, s68, s91
    s_cmp_lt_i32 s90, 0
    s_cselect_b32 s68, 1000, s68
    s_cmp_gt_i32 s68, 8
    s_cbranch_scc1 m_ok145
    s_sub_u32 s3, s3, 1
    s_cbranch_scc1 m_ok145
    s_sleep 4
    s_branch m_spin144
m_ok145:
    s_branch m_lr137
.p2align 3
m_l3125:
    s_waitcnt lgkmcnt(9)
    v_mfma_f32_16x16x32_bf16 v[64:67], a[16:19], a[0:3], v[64:67]
    s_add_u32 m0, s59, 16384
    ds_read_b128 a[32:35], v6 offset:8192
    s_waitcnt lgkmcnt(9)
    v_mfma_f32_16x16x32_bf16 v[72:75], a[16:19], a[4:7], v[72:75]
    ds_read_b64_tr_b16 a[48:49], v12 offset:8192
    buffer_load_dwordx4 v16, s[24:27], s57 offen offset:0 sc1 lds
    s_waitcnt lgkmcnt(9)
    v_mfma_f32_16x16x32_bf16 v[80:83], a[16:19], a[8:11], v[80:83]
    s_add_u32 s59, s58, s60
    ds_read_b64_tr_b16 a[50:51], v12 offset:12288
    s_waitcnt lgkmcnt(9)
    v_mfma_f32_16x16x32_bf16 v[88:91], a[16:19], a[12:15], v[88:91]
    s_add_u32 s58, s58, 32768
    ds_read_b128 a[36:39], v6 offset:9216
    s_waitcnt lgkmcnt(8)
    v_mfma_f32_16x16x32_bf16 v[68:71], a[20:23], a[0:3], v[68:71]
    s_cmp_ge_u32 s58, 163840
    ds_read_b128 a[40:43], v6 offset:10240
    v_mfma_f32_16x16x32_bf16 v[76:79], a[20:23], a[4:7], v[76:79]
    ds_read_b128 a[44:47], v6 offset:11264
    buffer_load_dwordx4 v17, s[24:27], s57 offen offset:1024 sc1 lds
    v_mfma_f32_16x16x32_bf16 v[84:87], a[20:23], a[8:11], v[84:87]
    s_cselect_b32 s66, 4294836224, s100
    ds_read_b64_tr_b16 a[52:53], v13 offset:8192
    v_mfma_f32_16x16x32_bf16 v[92:95], a[20:23], a[12:15], v[92:95]
    s_cselect_b32 s58, 0, s58
    ds_read_b64_tr_b16 a[54:55], v13 offset:12288
    s_waitcnt lgkmcnt(10)
    v_mfma_f32_16x16x32_bf16 v[96:99], a[24:27], a[0:3], v[96:99]
    ds_read_b64_tr_b16 a[56:57], v14 offset:8192
    v_mfma_f32_16x16x32_bf16 v[104:107], a[24:27], a[4:7], v[104:107]
    ds_read_b64_tr_b16 a[58:59], v14 offset:12288
    buffer_load_dwordx4 v18, s[24:27], s57 offen offset:2048 sc1 lds
    v_mfma_f32_16x16x32_bf16 v[112:115], a[24:27], a[8:11], v[112:115]
    ds_read_b64_tr_b16 a[60:61], v15 offset:8192
    v_mfma_f32_16x16x32_bf16 v[120:123], a[24:27], a[12:15], v[120:123]
    ds_read_b64_tr_b16 a[62:63], v15 offset:12288
    s_waitcnt lgkmcnt(12)
    v_mfma_f32_16x16x32_bf16 v[100:103], a[28:31], a[0:3], v[100:103]
    v_add_u32 v6, s66, v6
    v_add_u32 v12, s66, v12
    v_mfma_f32_16x16x32_bf16 v[108:111], a[28:31], a[4:7], v[108:111]
    buffer_load_dwordx4 v19, s[24:27], s57 offen offset:3072 sc1 lds
    v_mfma_f32_16x16x32_bf16 v[116:119], a[28:31], a[8:11], v[116:119]
    s_add_u32 s57, s57, 131072
    v_add_u32 v13, s66, v13
    v_add_u32 v14, s66, v14
    v_mfma_f32_16x16x32_bf16 v[124:127], a[28:31], a[12:15], v[124:127]
    s_mov_b32 m0, s59
    v_add_u32 v15, s66, v15
    s_waitcnt vmcnt(24) lgkmcnt(0)
    v_mfma_f32_16x16x32_bf16 v[64:67], a[48:51], a[32:35], v[64:67]
    s_barrier
    v_mfma_f32_16x16x32_bf16 v[72:75], a[48:51], a[36:39], v[72:75]
    ds_read_b128 a[0:3], v6 offset:0
    buffer_load_dwordx4 v2, s[36:39], s56 offen offset:0 sc1 lds
    v_mfma_f32_16x16x32_bf16 v[80:83], a[48:51], a[40:43], v[80:83]
    ds_read_b64_tr_b16 a[16:17], v12 offset:0
    v_mfma_f32_16x16x32_bf16 v[88:91], a[48:51], a[44:47], v[88:91]
    ds_read_b64_tr_b16 a[18:19], v12 offset:4096
    v_mfma_f32_16x16x32_bf16 v[68:71], a[52:55], a[32:35], v[68:71]
    ds_read_b128 a[4:7], v6 offset:1024
    v_mfma_f32_16x16x32_bf16 v[76:79], a[52:55], a[36:39], v[76:79]
    ds_read_b128 a[8:11], v6 offset:2048
    buffer_load_dwordx4 v2, s[36:39], s56 offen offset:1024 sc1 lds
    v_mfma_f32_16x16x32_bf16 v[84:87], a[52:55], a[40:43], v[84:87]
    ds_read_b128 a[12:15], v6 offset:3072
    v_mfma_f32_16x16x32_bf16 v[92:95], a[52:55], a[44:47], v[92:95]
    ds_read_b64_tr_b16 a[20:21], v13 offset:0
    v_mfma_f32_16x16x32_bf16 v[96:99], a[56:59], a[32:35], v[96:99]
    ds_read_b64_tr_b16 a[22:23], v13 offset:4096
    v_mfma_f32_16x16x32_bf16 v[104:107], a[56:59], a[36:39], v[104:107]
    ds_read_b64_tr_b16 a[24:25], v14 offset:0
    buffer_load_dwordx4 v2, s[36:39], s56 offen offset:2048 sc1 lds
    v_mfma_f32_16x16x32_bf16 v[112:115], a[56:59], a[40:43], v[112:115]
    ds_read_b64_tr_b16 a[26:27], v14 offset:4096
    v_mfma_f32_16x16x32_bf16 v[120:123], a[56:59], a[44:47], v[120:123]
    ds_read_b64_tr_b16 a[28:29], v15 offset:0
    v_mfma_f32_16x16x32_bf16 v[100:103], a[60:63], a[32:35], v[100:103]
    s_add_u32 s64, s64, 1
    ds_read_b64_tr_b16 a[30:31], v15 offset:4096
    v_mfma_f32_16x16x32_bf16 v[108:111], a[60:63], a[36:39], v[108:111]
    buffer_load_dwordx4 v2, s[36:39], s56 offen offset:3072 sc1 lds
    v_mfma_f32_16x16x32_bf16 v[116:119], a[60:63], a[40:43], v[116:119]
    s_add_u32 s56, s56, 262144
    s_cmp_lt_u32 s64, s67
    v_mfma_f32_16x16x32_bf16 v[124:127], a[60:63], a[44:47], v[124:127]
    s_cbranch_scc1 m_l3125
m_l3e126:
    s_add_u32 s92, s64, 5
    s_cmp_gt_i32 s68, s92
    s_cbranch_scc1 m_rdy146
    s_mov_b32 s3, 1048576
m_spin147:
    buffer_load_dwordx2 v[4:5], v10, s[8:11], s52 offen sc1
    s_waitcnt vmcnt(0)
    v_cmp_ne_u64 s[76:77], s[4:5], v[4:5]
    s_mul_i32 s91, s95, 20
    s_nop 2
    s_lshr_b32 s90, s76, s91
    s_ff1_i32_b32 s90, s90
    s_lshl_b32 s68, s90, 1
    s_mul_i32 s91, s95, 0
    s_sub_i32 s68, s68, s91
    s_cmp_lt_i32 s90, 0
    s_cselect_b32 s68, 1000, s68
    s_cmp_gt_i32 s68, s92
    s_cbranch_scc1 m_ok148
    s_sub_u32 s3, s3, 1
    s_cbranch_scc1 m_ok148
    s_sleep 4
    s_branch m_spin147
m_ok148:
m_rdy146:
    s_mov_b32 s67, 8
    s_cmp_lt_u32 s64, 8
    s_cbranch_scc1 m_l3n129
    s_cmp_eq_u32 s64, 8
    s_cbranch_scc1 m_o1149
m_o2150:
    s_cmp_eq_u32 s95, 0
    s_cbranch_scc1 m_l3c128
    s_mov_b32 s67, 18
    s_cmp_lt_u32 s64, 18
    s_cbranch_scc1 m_l3n129
    s_cmp_lg_u32 s64, 18
    s_cbranch_scc1 m_n151
    s_mov_b32 s68, 1000
    s_lshr_b32 s90, s96, 1
    s_lshl_b32 s90, s90, 8
    s_add_u32 s90, s90, 117452800
    buffer_load_dwordx2 v[4:5], v10, s[8:11], s90 offen sc1
    s_mov_b32 s67, 19
    s_branch m_l3125
m_n151:
    s_cmp_lg_u32 s64, 19
    s_cbranch_scc1 m_n152
    s_waitcnt vmcnt(8)
    s_waitcnt vmcnt(16)
    s_mov_b32 s3, 1048576
m_spin153:
    v_cmp_ne_u64 s[76:77], s[4:5], v[4:5]
    s_nop 3
    s_cmp_eq_u64 s[76:77], 0
    s_cbranch_scc1 m_ok154
    s_sub_u32 s3, s3, 1
    s_cbranch_scc1 m_ok154
    s_sleep 8
    s_lshr_b32 s90, s96, 1
    s_lshl_b32 s90, s90, 8
    s_add_u32 s90, s90, 117452800
    buffer_load_dwordx2 v[4:5], v10, s[8:11], s90 offen sc1
    s_waitcnt vmcnt(0)
    s_branch m_spin153
m_ok154:
    s_mov_b32 s56, s69
    s_mov_b32 s67, 20
    s_branch m_l3125
m_n152:
    s_cmp_lg_u32 s64, 20
    s_cbranch_scc1 m_n155
    s_mov_b32 s24, s50
    s_mov_b32 s25, s51
    s_mov_b32 s26, 2097152
    s_lshl_b32 s57, s97, 8
    s_mov_b32 s67, 24
    s_branch m_l3125
m_n155:
    s_cmp_lg_u32 s64, 24
    s_cbranch_scc1 m_n156
    s_lshl_b32 s90, s96, 3
    s_add_u32 s90, s90, s97
    s_lshl_b32 s90, s90, 15
    s_lshl_b32 s91, s16, 13
    s_add_u32 s90, s90, s91
    s_add_u32 s70, s90, 100663296
    s_nop 3
    v_cvt_pk_bf16_f32 v128, v64, v65
    v_cvt_pk_bf16_f32 v129, v66, v67
    v_cvt_pk_bf16_f32 v130, v68, v69
    v_cvt_pk_bf16_f32 v131, v70, v71
    v_cvt_pk_bf16_f32 v132, v72, v73
    v_cvt_pk_bf16_f32 v133, v74, v75
    v_cvt_pk_bf16_f32 v134, v76, v77
    v_cvt_pk_bf16_f32 v135, v78, v79
    v_cvt_pk_bf16_f32 v136, v80, v81
    v_cvt_pk_bf16_f32 v137, v82, v83
    v_cvt_pk_bf16_f32 v138, v84, v85
    v_cvt_pk_bf16_f32 v139, v86, v87
    v_cvt_pk_bf16_f32 v140, v88, v89
    v_cvt_pk_bf16_f32 v141, v90, v91
    v_cvt_pk_bf16_f32 v142, v92, v93
    v_cvt_pk_bf16_f32 v143, v94, v95
    v_cvt_pk_bf16_f32 v144, v96, v97
    v_cvt_pk_bf16_f32 v145, v98, v99
    v_cvt_pk_bf16_f32 v146, v100, v101
    v_cvt_pk_bf16_f32 v147, v102, v103
    v_cvt_pk_bf16_f32 v148, v104, v105
    v_cvt_pk_bf16_f32 v149, v106, v107
    v_cvt_pk_bf16_f32 v150, v108, v109
    v_cvt_pk_bf16_f32 v151, v110, v111
    v_cvt_pk_bf16_f32 v152, v112, v113
    v_cvt_pk_bf16_f32 v153, v114, v115
    v_cvt_pk_bf16_f32 v154, v116, v117
    v_cvt_pk_bf16_f32 v155, v118, v119
    v_cvt_pk_bf16_f32 v156, v120, v121
    v_cvt_pk_bf16_f32 v157, v122, v123
    v_cvt_pk_bf16_f32 v158, v124, v125
    v_cvt_pk_bf16_f32 v159, v126, v127
    v_mov_b64 v[64:65], 0
    v_mov_b64 v[66:67], 0
    v_mov_b64 v[68:69], 0
    v_mov_b64 v[70:71], 0
    v_mov_b64 v[72:73], 0
    v_mov_b64 v[74:75], 0
    v_mov_b64 v[76:77], 0
    v_mov_b64 v[78:79], 0
    v_mov_b64 v[80:81], 0
    v_mov_b64 v[82:83], 0
    v_mov_b64 v[84:85], 0
    v_mov_b64 v[86:87], 0
    v_mov_b64 v[88:89], 0
    v_mov_b64 v[90:91], 0
    v_mov_b64 v[92:93], 0
    v_mov_b64 v[94:95], 0
    v_mov_b64 v[96:97], 0
    v_mov_b64 v[98:99], 0
    v_mov_b64 v[100:101], 0
    v_mov_b64 v[102:103], 0
    v_mov_b64 v[104:105], 0
    v_mov_b64 v[106:107], 0
    v_mov_b64 v[108:109], 0
    v_mov_b64 v[110:111], 0
    v_mov_b64 v[112:113], 0
    v_mov_b64 v[114:115], 0
    v_mov_b64 v[116:117], 0
    v_mov_b64 v[118:119], 0
    v_mov_b64 v[120:121], 0
    v_mov_b64 v[122:123], 0
    v_mov_b64 v[124:125], 0
    v_mov_b64 v[126:127], 0
    s_nop 1
    s_waitcnt lgkmcnt(9)
    v_mfma_f32_16x16x32_bf16 v[64:67], a[16:19], a[0:3], v[64:67]
    s_add_u32 m0, s59, 16384
    ds_read_b128 a[32:35], v6 offset:8192
    s_waitcnt lgkmcnt(9)
    v_mfma_f32_16x16x32_bf16 v[72:75], a[16:19], a[4:7], v[72:75]
    ds_read_b64_tr_b16 a[48:49], v12 offset:8192
    buffer_load_dwordx4 v16, s[24:27], s57 offen offset:0 sc1 lds
    s_waitcnt lgkmcnt(9)
    v_mfma_f32_16x16x32_bf16 v[80:83], a[16:19], a[8:11], v[80:83]
    s_add_u32 s59, s58, s60
    ds_read_b64_tr_b16 a[50:51], v12 offset:12288
    s_waitcnt lgkmcnt(9)
    v_mfma_f32_16x16x32_bf16 v[88:91], a[16:19], a[12:15], v[88:91]
    s_add_u32 s58, s58, 32768
    ds_read_b128 a[36:39], v6 offset:9216
    s_waitcnt lgkmcnt(8)
    v_mfma_f32_16x16x32_bf16 v[68:71], a[20:23], a[0:3], v[68:71]
    s_cmp_ge_u32 s58, 163840
    ds_read_b128 a[40:43], v6 offset:10240
    v_mfma_f32_16x16x32_bf16 v[76:79], a[20:23], a[4:7], v[76:79]
    ds_read_b128 a[44:47], v6 offset:11264
    buffer_load_dwordx4 v17, s[24:27], s57 offen offset:1024 sc1 lds
    v_mfma_f32_16x16x32_bf16 v[84:87], a[20:23], a[8:11], v[84:87]
    s_cselect_b32 s66, 4294836224, s100
    ds_read_b64_tr_b16 a[52:53], v13 offset:8192
    v_mfma_f32_16x16x32_bf16 v[92:95], a[20:23], a[12:15], v[92:95]
    s_cselect_b32 s58, 0, s58
    ds_read_b64_tr_b16 a[54:55], v13 offset:12288
    s_waitcnt lgkmcnt(10)
    v_mfma_f32_16x16x32_bf16 v[96:99], a[24:27], a[0:3], v[96:99]
    ds_read_b64_tr_b16 a[56:57], v14 offset:8192
    v_mfma_f32_16x16x32_bf16 v[104:107], a[24:27], a[4:7], v[104:107]
    ds_read_b64_tr_b16 a[58:59], v14 offset:12288
    buffer_load_dwordx4 v18, s[24:27], s57 offen offset:2048 sc1 lds
    v_mfma_f32_16x16x32_bf16 v[112:115], a[24:27], a[8:11], v[112:115]
    ds_read_b64_tr_b16 a[60:61], v15 offset:8192
    v_mfma_f32_16x16x32_bf16 v[120:123], a[24:27], a[12:15], v[120:123]
    ds_read_b64_tr_b16 a[62:63], v15 offset:12288
    buffer_store_dwordx4 v[128:131], v2, s[8:11], s70 offen offset:0 sc1
    s_waitcnt lgkmcnt(12)
    v_mfma_f32_16x16x32_bf16 v[100:103], a[28:31], a[0:3], v[100:103]
    v_add_u32 v6, s66, v6
    v_add_u32 v12, s66, v12
    v_mfma_f32_16x16x32_bf16 v[108:111], a[28:31], a[4:7], v[108:111]
    buffer_load_dwordx4 v19, s[24:27], s57 offen offset:3072 sc1 lds
    v_mfma_f32_16x16x32_bf16 v[116:119], a[28:31], a[8:11], v[116:119]
    s_add_u32 s57, s57, 131072
    v_add_u32 v13, s66, v13
    v_add_u32 v14, s66, v14
    v_mfma_f32_16x16x32_bf16 v[124:127], a[28:31], a[12:15], v[124:127]
    s_mov_b32 m0, s59
    v_add_u32 v15, s66, v15
    s_waitcnt vmcnt(24) lgkmcnt(0)
    v_mfma_f32_16x16x32_bf16 v[64:67], a[48:51], a[32:35], v[64:67]
    s_barrier
    v_mfma_f32_16x16x32_bf16 v[72:75], a[48:51], a[36:39], v[72:75]
    ds_read_b128 a[0:3], v6 offset:0
    buffer_load_dwordx4 v2, s[36:39], s56 offen offset:0 sc1 lds
    v_mfma_f32_16x16x32_bf16 v[80:83], a[48:51], a[40:43], v[80:83]
    ds_read_b64_tr_b16 a[16:17], v12 offset:0
    v_mfma_f32_16x16x32_bf16 v[88:91], a[48:51], a[44:47], v[88:91]
    ds_read_b64_tr_b16 a[18:19], v12 offset:4096
    v_mfma_f32_16x16x32_bf16 v[68:71], a[52:55], a[32:35], v[68:71]
    ds_read_b128 a[4:7], v6 offset:1024
    v_mfma_f32_16x16x32_bf16 v[76:79], a[52:55], a[36:39], v[76:79]
    ds_read_b128 a[8:11], v6 offset:2048
    buffer_load_dwordx4 v2, s[36:39], s56 offen offset:1024 sc1 lds
    v_mfma_f32_16x16x32_bf16 v[84:87], a[52:55], a[40:43], v[84:87]
    ds_read_b128 a[12:15], v6 offset:3072
    v_mfma_f32_16x16x32_bf16 v[92:95], a[52:55], a[44:47], v[92:95]
    ds_read_b64_tr_b16 a[20:21], v13 offset:0
    v_mfma_f32_16x16x32_bf16 v[96:99], a[56:59], a[32:35], v[96:99]
    ds_read_b64_tr_b16 a[22:23], v13 offset:4096
    v_mfma_f32_16x16x32_bf16 v[104:107], a[56:59], a[36:39], v[104:107]
    ds_read_b64_tr_b16 a[24:25], v14 offset:0
    buffer_load_dwordx4 v2, s[36:39], s56 offen offset:2048 sc1 lds
    v_mfma_f32_16x16x32_bf16 v[112:115], a[56:59], a[40:43], v[112:115]
    ds_read_b64_tr_b16 a[26:27], v14 offset:4096
    v_mfma_f32_16x16x32_bf16 v[120:123], a[56:59], a[44:47], v[120:123]
    ds_read_b64_tr_b16 a[28:29], v15 offset:0
    buffer_store_dwordx4 v[132:135], v2, s[8:11], s70 offen offset:1024 sc1
    v_mfma_f32_16x16x32_bf16 v[100:103], a[60:63], a[32:35], v[100:103]
    s_add_u32 s64, s64, 1
    ds_read_b64_tr_b16 a[30:31], v15 offset:4096
    v_mfma_f32_16x16x32_bf16 v[108:111], a[60:63], a[36:39], v[108:111]
    buffer_load_dwordx4 v2, s[36:39], s56 offen offset:3072 sc1 lds
    v_mfma_f32_16x16x32_bf16 v[116:119], a[60:63], a[40:43], v[116:119]
    s_add_u32 s56, s56, 262144
    v_mfma_f32_16x16x32_bf16 v[124:127], a[60:63], a[44:47], v[124:127]
    s_waitcnt lgkmcnt(9)
    v_mfma_f32_16x16x32_bf16 v[64:67], a[16:19], a[0:3], v[64:67]
    s_add_u32 m0, s59, 16384
    ds_read_b128 a[32:35], v6 offset:8192
    s_waitcnt lgkmcnt(9)
    v_mfma_f32_16x16x32_bf16 v[72:75], a[16:19], a[4:7], v[72:75]
    ds_read_b64_tr_b16 a[48:49], v12 offset:8192
    buffer_load_dwordx4 v16, s[24:27], s57 offen offset:0 sc1 lds
    s_waitcnt lgkmcnt(9)
    v_mfma_f32_16x16x32_bf16 v[80:83], a[16:19], a[8:11], v[80:83]
    s_add_u32 s59, s58, s60
    ds_read_b64_tr_b16 a[50:51], v12 offset:12288
    s_waitcnt lgkmcnt(9)
    v_mfma_f32_16x16x32_bf16 v[88:91], a[16:19], a[12:15], v[88:91]
    s_add_u32 s58, s58, 32768
    ds_read_b128 a[36:39], v6 offset:9216
    s_waitcnt lgkmcnt(8)
    v_mfma_f32_16x16x32_bf16 v[68:71], a[20:23], a[0:3], v[68:71]
    s_cmp_ge_u32 s58, 163840
    ds_read_b128 a[40:43], v6 offset:10240
    v_mfma_f32_16x16x32_bf16 v[76:79], a[20:23], a[4:7], v[76:79]
    ds_read_b128 a[44:47], v6 offset:11264
    buffer_load_dwordx4 v17, s[24:27], s57 offen offset:1024 sc1 lds
    v_mfma_f32_16x16x32_bf16 v[84:87], a[20:23], a[8:11], v[84:87]
    s_cselect_b32 s66, 4294836224, s100
    ds_read_b64_tr_b16 a[52:53], v13 offset:8192
    v_mfma_f32_16x16x32_bf16 v[92:95], a[20:23], a[12:15], v[92:95]
    s_cselect_b32 s58, 0, s58
    ds_read_b64_tr_b16 a[54:55], v13 offset:12288
    s_waitcnt lgkmcnt(10)
    v_mfma_f32_16x16x32_bf16 v[96:99], a[24:27], a[0:3], v[96:99]
    ds_read_b64_tr_b16 a[56:57], v14 offset:8192
    v_mfma_f32_16x16x32_bf16 v[104:107], a[24:27], a[4:7], v[104:107]
    ds_read_b64_tr_b16 a[58:59], v14 offset:12288
    buffer_load_dwordx4 v18, s[24:27], s57 offen offset:2048 sc1 lds
    v_mfma_f32_16x16x32_bf16 v[112:115], a[24:27], a[8:11], v[112:115]
    ds_read_b64_tr_b16 a[60:61], v15 offset:8192
    v_mfma_f32_16x16x32_bf16 v[120:123], a[24:27], a[12:15], v[120:123]
    ds_read_b64_tr_b16 a[62:63], v15 offset:12288
    buffer_store_dwordx4 v[136:139], v2, s[8:11], s70 offen offset:2048 sc1
    s_waitcnt lgkmcnt(12)
    v_mfma_f32_16x16x32_bf16 v[100:103], a[28:31], a[0:3], v[100:103]
    v_add_u32 v6, s66, v6
    v_add_u32 v12, s66, v12
    v_mfma_f32_16x16x32_bf16 v[108:111], a[28:31], a[4:7], v[108:111]
    buffer_load_dwordx4 v19, s[24:27], s57 offen offset:3072 sc1 lds
    v_mfma_f32_16x16x32_bf16 v[116:119], a[28:31], a[8:11], v[116:119]
    s_add_u32 s57, s57, 131072
    v_add_u32 v13, s66, v13
    v_add_u32 v14, s66, v14
    v_mfma_f32_16x16x32_bf16 v[124:127], a[28:31], a[12:15], v[124:127]
    s_mov_b32 m0, s59
    v_add_u32 v15, s66, v15
    s_waitcnt vmcnt(24) lgkmcnt(0)
    v_mfma_f32_16x16x32_bf16 v[64:67], a[48:51], a[32:35], v[64:67]
    s_barrier
    v_mfma_f32_16x16x32_bf16 v[72:75], a[48:51], a[36:39], v[72:75]
    ds_read_b128 a[0:3], v6 offset:0
    buffer_load_dwordx4 v2, s[36:39], s56 offen offset:0 sc1 lds
    v_mfma_f32_16x16x32_bf16 v[80:83], a[48:51], a[40:43], v[80:83]
    ds_read_b64_tr_b16 a[16:17], v12 offset:0
    v_mfma_f32_16x16x32_bf16 v[88:91], a[48:51], a[44:47], v[88:91]
    ds_read_b64_tr_b16 a[18:19], v12 offset:4096
    v_mfma_f32_16x16x32_bf16 v[68:71], a[52:55], a[32:35], v[68:71]
    ds_read_b128 a[4:7], v6 offset:1024
    v_mfma_f32_16x16x32_bf16 v[76:79], a[52:55], a[36:39], v[76:79]
    ds_read_b128 a[8:11], v6 offset:2048
    buffer_load_dwordx4 v2, s[36:39], s56 offen offset:1024 sc1 lds
    v_mfma_f32_16x16x32_bf16 v[84:87], a[52:55], a[40:43], v[84:87]
    ds_read_b128 a[12:15], v6 offset:3072
    v_mfma_f32_16x16x32_bf16 v[92:95], a[52:55], a[44:47], v[92:95]
    ds_read_b64_tr_b16 a[20:21], v13 offset:0
    v_mfma_f32_16x16x32_bf16 v[96:99], a[56:59], a[32:35], v[96:99]
    ds_read_b64_tr_b16 a[22:23], v13 offset:4096
    v_mfma_f32_16x16x32_bf16 v[104:107], a[56:59], a[36:39], v[104:107]
    ds_read_b64_tr_b16 a[24:25], v14 offset:0
    buffer_load_dwordx4 v2, s[36:39], s56 offen offset:2048 sc1 lds
    v_mfma_f32_16x16x32_bf16 v[112:115], a[56:59], a[40:43], v[112:115]
    ds_read_b64_tr_b16 a[26:27], v14 offset:4096
    v_mfma_f32_16x16x32_bf16 v[120:123], a[56:59], a[44:47], v[120:123]
    ds_read_b64_tr_b16 a[28:29], v15 offset:0
    buffer_store_dwordx4 v[140:143], v2, s[8:11], s70 offen offset:3072 sc1
    s_add_u32 s70, s70, 4096
    v_mfma_f32_16x16x32_bf16 v[100:103], a[60:63], a[32:35], v[100:103]
    s_add_u32 s64, s64, 1
    ds_read_b64_tr_b16 a[30:31], v15 offset:4096
    v_mfma_f32_16x16x32_bf16 v[108:111], a[60:63], a[36:39], v[108:111]
    buffer_load_dwordx4 v2, s[36:39], s56 offen offset:3072 sc1 lds
    v_mfma_f32_16x16x32_bf16 v[116:119], a[60:63], a[40:43], v[116:119]
    s_add_u32 s56, s56, 262144
    v_mfma_f32_16x16x32_bf16 v[124:127], a[60:63], a[44:47], v[124:127]
    s_waitcnt lgkmcnt(9)
    v_mfma_f32_16x16x32_bf16 v[64:67], a[16:19], a[0:3], v[64:67]
    s_add_u32 m0, s59, 16384
    ds_read_b128 a[32:35], v6 offset:8192
    s_waitcnt lgkmcnt(9)
    v_mfma_f32_16x16x32_bf16 v[72:75], a[16:19], a[4:7], v[72:75]
    ds_read_b64_tr_b16 a[48:49], v12 offset:8192
    buffer_load_dwordx4 v16, s[24:27], s57 offen offset:0 sc1 lds
    s_waitcnt lgkmcnt(9)
    v_mfma_f32_16x16x32_bf16 v[80:83], a[16:19], a[8:11], v[80:83]
    s_add_u32 s59, s58, s60
    ds_read_b64_tr_b16 a[50:51], v12 offset:12288
    s_waitcnt lgkmcnt(9)
    v_mfma_f32_16x16x32_bf16 v[88:91], a[16:19], a[12:15], v[88:91]
    s_add_u32 s58, s58, 32768
    ds_read_b128 a[36:39], v6 offset:9216
    s_waitcnt lgkmcnt(8)
    v_mfma_f32_16x16x32_bf16 v[68:71], a[20:23], a[0:3], v[68:71]
    s_cmp_ge_u32 s58, 163840
    ds_read_b128 a[40:43], v6 offset:10240
    v_mfma_f32_16x16x32_bf16 v[76:79], a[20:23], a[4:7], v[76:79]
    ds_read_b128 a[44:47], v6 offset:11264
    buffer_load_dwordx4 v17, s[24:27], s57 offen offset:1024 sc1 lds
    v_mfma_f32_16x16x32_bf16 v[84:87], a[20:23], a[8:11], v[84:87]
    s_cselect_b32 s66, 4294836224, s100
    ds_read_b64_tr_b16 a[52:53], v13 offset:8192
    v_mfma_f32_16x16x32_bf16 v[92:95], a[20:23], a[12:15], v[92:95]
    s_cselect_b32 s58, 0, s58
    ds_read_b64_tr_b16 a[54:55], v13 offset:12288
    s_waitcnt lgkmcnt(10)
    v_mfma_f32_16x16x32_bf16 v[96:99], a[24:27], a[0:3], v[96:99]
    ds_read_b64_tr_b16 a[56:57], v14 offset:8192
    v_mfma_f32_16x16x32_bf16 v[104:107], a[24:27], a[4:7], v[104:107]
    ds_read_b64_tr_b16 a[58:59], v14 offset:12288
    buffer_load_dwordx4 v18, s[24:27], s57 offen offset:2048 sc1 lds
    v_mfma_f32_16x16x32_bf16 v[112:115], a[24:27], a[8:11], v[112:115]
    ds_read_b64_tr_b16 a[60:61], v15 offset:8192
    v_mfma_f32_16x16x32_bf16 v[120:123], a[24:27], a[12:15], v[120:123]
    ds_read_b64_tr_b16 a[62:63], v15 offset:12288
    buffer_store_dwordx4 v[144:147], v2, s[8:11], s70 offen offset:0 sc1
    s_waitcnt lgkmcnt(12)
    v_mfma_f32_16x16x32_bf16 v[100:103], a[28:31], a[0:3], v[100:103]
    v_add_u32 v6, s66, v6
    v_add_u32 v12, s66, v12
    v_mfma_f32_16x16x32_bf16 v[108:111], a[28:31], a[4:7], v[108:111]
    buffer_load_dwordx4 v19, s[24:27], s57 offen offset:3072 sc1 lds
    v_mfma_f32_16x16x32_bf16 v[116:119], a[28:31], a[8:11], v[116:119]
    s_add_u32 s57, s57, 131072
    v_add_u32 v13, s66, v13
    v_add_u32 v14, s66, v14
    v_mfma_f32_16x16x32_bf16 v[124:127], a[28:31], a[12:15], v[124:127]
    s_mov_b32 m0, s59
    v_add_u32 v15, s66, v15
    s_waitcnt vmcnt(24) lgkmcnt(0)
    v_mfma_f32_16x16x32_bf16 v[64:67], a[48:51], a[32:35], v[64:67]
    s_barrier
    v_mfma_f32_16x16x32_bf16 v[72:75], a[48:51], a[36:39], v[72:75]
    ds_read_b128 a[0:3], v6 offset:0
    buffer_load_dwordx4 v2, s[36:39], s56 offen offset:0 sc1 lds
    v_mfma_f32_16x16x32_bf16 v[80:83], a[48:51], a[40:43], v[80:83]
    ds_read_b64_tr_b16 a[16:17], v12 offset:0
    v_mfma_f32_16x16x32_bf16 v[88:91], a[48:51], a[44:47], v[88:91]
    ds_read_b64_tr_b16 a[18:19], v12 offset:4096
    v_mfma_f32_16x16x32_bf16 v[68:71], a[52:55], a[32:35], v[68:71]
    ds_read_b128 a[4:7], v6 offset:1024
    v_mfma_f32_16x16x32_bf16 v[76:79], a[52:55], a[36:39], v[76:79]
    ds_read_b128 a[8:11], v6 offset:2048
    buffer_load_dwordx4 v2, s[36:39], s56 offen offset:1024 sc1 lds
    v_mfma_f32_16x16x32_bf16 v[84:87], a[52:55], a[40:43], v[84:87]
    ds_read_b128 a[12:15], v6 offset:3072
    v_mfma_f32_16x16x32_bf16 v[92:95], a[52:55], a[44:47], v[92:95]
    ds_read_b64_tr_b16 a[20:21], v13 offset:0
    v_mfma_f32_16x16x32_bf16 v[96:99], a[56:59], a[32:35], v[96:99]
    ds_read_b64_tr_b16 a[22:23], v13 offset:4096
    v_mfma_f32_16x16x32_bf16 v[104:107], a[56:59], a[36:39], v[104:107]
    ds_read_b64_tr_b16 a[24:25], v14 offset:0
    buffer_load_dwordx4 v2, s[36:39], s56 offen offset:2048 sc1 lds
    v_mfma_f32_16x16x32_bf16 v[112:115], a[56:59], a[40:43], v[112:115]
    ds_read_b64_tr_b16 a[26:27], v14 offset:4096
    v_mfma_f32_16x16x32_bf16 v[120:123], a[56:59], a[44:47], v[120:123]
    ds_read_b64_tr_b16 a[28:29], v15 offset:0
    buffer_store_dwordx4 v[148:151], v2, s[8:11], s70 offen offset:1024 sc1
    v_mfma_f32_16x16x32_bf16 v[100:103], a[60:63], a[32:35], v[100:103]
    s_add_u32 s64, s64, 1
    ds_read_b64_tr_b16 a[30:31], v15 offset:4096
    v_mfma_f32_16x16x32_bf16 v[108:111], a[60:63], a[36:39], v[108:111]
    buffer_load_dwordx4 v2, s[36:39], s56 offen offset:3072 sc1 lds
    v_mfma_f32_16x16x32_bf16 v[116:119], a[60:63], a[40:43], v[116:119]
    s_add_u32 s56, s56, 262144
    v_mfma_f32_16x16x32_bf16 v[124:127], a[60:63], a[44:47], v[124:127]
    s_waitcnt lgkmcnt(9)
    v_mfma_f32_16x16x32_bf16 v[64:67], a[16:19], a[0:3], v[64:67]
    s_add_u32 m0, s59, 16384
    ds_read_b128 a[32:35], v6 offset:8192
    s_waitcnt lgkmcnt(9)
    v_mfma_f32_16x16x32_bf16 v[72:75], a[16:19], a[4:7], v[72:75]
    ds_read_b64_tr_b16 a[48:49], v12 offset:8192
    buffer_load_dwordx4 v16, s[24:27], s57 offen offset:0 sc1 lds
    s_waitcnt lgkmcnt(9)
    v_mfma_f32_16x16x32_bf16 v[80:83], a[16:19], a[8:11], v[80:83]
    s_add_u32 s59, s58, s60
    ds_read_b64_tr_b16 a[50:51], v12 offset:12288
    s_waitcnt lgkmcnt(9)
    v_mfma_f32_16x16x32_bf16 v[88:91], a[16:19], a[12:15], v[88:91]
    s_add_u32 s58, s58, 32768
    ds_read_b128 a[36:39], v6 offset:9216
    s_waitcnt lgkmcnt(8)
    v_mfma_f32_16x16x32_bf16 v[68:71], a[20:23], a[0:3], v[68:71]
    s_cmp_ge_u32 s58, 163840
    ds_read_b128 a[40:43], v6 offset:10240
    v_mfma_f32_16x16x32_bf16 v[76:79], a[20:23], a[4:7], v[76:79]
    ds_read_b128 a[44:47], v6 offset:11264
    buffer_load_dwordx4 v17, s[24:27], s57 offen offset:1024 sc1 lds
    v_mfma_f32_16x16x32_bf16 v[84:87], a[20:23], a[8:11], v[84:87]
    s_cselect_b32 s66, 4294836224, s100
    ds_read_b64_tr_b16 a[52:53], v13 offset:8192
    v_mfma_f32_16x16x32_bf16 v[92:95], a[20:23], a[12:15], v[92:95]
    s_cselect_b32 s58, 0, s58
    ds_read_b64_tr_b16 a[54:55], v13 offset:12288
    s_waitcnt lgkmcnt(10)
    v_mfma_f32_16x16x32_bf16 v[96:99], a[24:27], a[0:3], v[96:99]
    ds_read_b64_tr_b16 a[56:57], v14 offset:8192
    v_mfma_f32_16x16x32_bf16 v[104:107], a[24:27], a[4:7], v[104:107]
    ds_read_b64_tr_b16 a[58:59], v14 offset:12288
    buffer_load_dwordx4 v18, s[24:27], s57 offen offset:2048 sc1 lds
    v_mfma_f32_16x16x32_bf16 v[112:115], a[24:27], a[8:11], v[112:115]
    ds_read_b64_tr_b16 a[60:61], v15 offset:8192
    v_mfma_f32_16x16x32_bf16 v[120:123], a[24:27], a[12:15], v[120:123]
    ds_read_b64_tr_b16 a[62:63], v15 offset:12288
    buffer_store_dwordx4 v[152:155], v2, s[8:11], s70 offen offset:2048 sc1
    s_waitcnt lgkmcnt(12)
    v_mfma_f32_16x16x32_bf16 v[100:103], a[28:31], a[0:3], v[100:103]
    v_add_u32 v6, s66, v6
    v_add_u32 v12, s66, v12
    v_mfma_f32_16x16x32_bf16 v[108:111], a[28:31], a[4:7], v[108:111]
    buffer_load_dwordx4 v19, s[24:27], s57 offen offset:3072 sc1 lds
    v_mfma_f32_16x16x32_bf16 v[116:119], a[28:31], a[8:11], v[116:119]
    s_add_u32 s57, s57, 131072
    v_add_u32 v13, s66, v13
    v_add_u32 v14, s66, v14
    v_mfma_f32_16x16x32_bf16 v[124:127], a[28:31], a[12:15], v[124:127]
    s_mov_b32 m0, s59
    v_add_u32 v15, s66, v15
    s_waitcnt vmcnt(24) lgkmcnt(0)
    v_mfma_f32_16x16x32_bf16 v[64:67], a[48:51], a[32:35], v[64:67]
    s_barrier
    v_mfma_f32_16x16x32_bf16 v[72:75], a[48:51], a[36:39], v[72:75]
    ds_read_b128 a[0:3], v6 offset:0
    buffer_load_dwordx4 v2, s[36:39], s56 offen offset:0 sc1 lds
    v_mfma_f32_16x16x32_bf16 v[80:83], a[48:51], a[40:43], v[80:83]
    ds_read_b64_tr_b16 a[16:17], v12 offset:0
    v_mfma_f32_16x16x32_bf16 v[88:91], a[48:51], a[44:47], v[88:91]
    ds_read_b64_tr_b16 a[18:19], v12 offset:4096
    v_mfma_f32_16x16x32_bf16 v[68:71], a[52:55], a[32:35], v[68:71]
    ds_read_b128 a[4:7], v6 offset:1024
    v_mfma_f32_16x16x32_bf16 v[76:79], a[52:55], a[36:39], v[76:79]
    ds_read_b128 a[8:11], v6 offset:2048
    buffer_load_dwordx4 v2, s[36:39], s56 offen offset:1024 sc1 lds
    v_mfma_f32_16x16x32_bf16 v[84:87], a[52:55], a[40:43], v[84:87]
    ds_read_b128 a[12:15], v6 offset:3072
    v_mfma_f32_16x16x32_bf16 v[92:95], a[52:55], a[44:47], v[92:95]
    ds_read_b64_tr_b16 a[20:21], v13 offset:0
    v_mfma_f32_16x16x32_bf16 v[96:99], a[56:59], a[32:35], v[96:99]
    ds_read_b64_tr_b16 a[22:23], v13 offset:4096
    v_mfma_f32_16x16x32_bf16 v[104:107], a[56:59], a[36:39], v[104:107]
    ds_read_b64_tr_b16 a[24:25], v14 offset:0
    buffer_load_dwordx4 v2, s[36:39], s56 offen offset:2048 sc1 lds
    v_mfma_f32_16x16x32_bf16 v[112:115], a[56:59], a[40:43], v[112:115]
    ds_read_b64_tr_b16 a[26:27], v14 offset:4096
    v_mfma_f32_16x16x32_bf16 v[120:123], a[56:59], a[44:47], v[120:123]
    ds_read_b64_tr_b16 a[28:29], v15 offset:0
    buffer_store_dwordx4 v[156:159], v2, s[8:11], s70 offen offset:3072 sc1
    s_add_u32 s70, s70, 4096
    v_mfma_f32_16x16x32_bf16 v[100:103], a[60:63], a[32:35], v[100:103]
    s_add_u32 s64, s64, 1
    ds_read_b64_tr_b16 a[30:31], v15 offset:4096
    v_mfma_f32_16x16x32_bf16 v[108:111], a[60:63], a[36:39], v[108:111]
    buffer_load_dwordx4 v2, s[36:39], s56 offen offset:3072 sc1 lds
    v_mfma_f32_16x16x32_bf16 v[116:119], a[60:63], a[40:43], v[116:119]
    s_add_u32 s56, s56, 262144
    v_mfma_f32_16x16x32_bf16 v[124:127], a[60:63], a[44:47], v[124:127]
    s_mov_b32 s67, 32
    s_branch m_l3125
m_n156:
    s_cmp_lg_u32 s64, 32
    s_cbranch_scc1 m_n157
    s_lshl_b32 s91, s96, 3
    s_add_u32 s91, s91, s97
    s_lshl_b32 s91, s91, 7
    s_add_u32 s91, s91, 16384
    s_cmp_lg_u32 s16, 0
    s_cbranch_scc1 m_np158
    v_mov_b32 v60, s4
    v_mov_b32 v61, s5
    s_add_u32 s90, s91, 117440512
    s_mov_b64 exec, 1
    buffer_store_dwordx2 v[60:61], off, s[8:11], s90 sc1
    s_mov_b64 exec, -1
m_np158:
    s_mov_b32 s67, 35
    s_branch m_l3125
m_n157:
    s_cmp_lg_u32 s64, 35
    s_cbranch_scc1 m_n159
    s_mov_b32 s38, 0
    s_mov_b32 s67, 40
    s_branch m_l3125
m_n159:
    s_branch m_l3x127
m_l3c128:
    s_mov_b32 s67, 34
    s_cmp_lt_u32 s64, 34
    s_cbranch_scc1 m_l3n129
    s_cmp_lg_u32 s64, 34
    s_cbranch_scc1 m_n161
    s_mov_b32 s68, 1000
    s_mov_b32 s67, 35
    s_branch m_l3125
m_n161:
    s_cmp_lg_u32 s64, 35
    s_cbranch_scc1 m_n162
    s_mov_b32 s38, 0
    s_lshl_b32 s91, s96, 3
    s_add_u32 s91, s91, s97
    s_lshl_b32 s91, s91, 7
    s_add_u32 s91, s91, 16384
    s_add_u32 s52, s91, 117440512
    buffer_load_dwordx2 v[4:5], off, s[8:11], s52 sc1
    s_mov_b32 s67, 36
    s_branch m_l3125
m_n162:
    s_cmp_lg_u32 s64, 36
    s_cbranch_scc1 m_n163
    s_mov_b32 s26, 0
    s_mov_b32 s67, 37
    s_branch m_l3125
m_n163:
    s_cmp_lg_u32 s64, 37
    s_cbranch_scc1 m_n164
    s_waitcnt vmcnt(16)
    s_mov_b32 s3, 1048576
m_spin165:
    v_cmp_ne_u64 s[76:77], s[4:5], v[4:5]
    s_nop 3
    s_cmp_eq_u64 s[76:77], 0
    s_cbranch_scc1 m_ok166
    s_sub_u32 s3, s3, 1
    s_cbranch_scc1 m_ok166
    s_sleep 8
    buffer_load_dwordx2 v[4:5], off, s[8:11], s52 sc1
    s_waitcnt vmcnt(0)
    s_branch m_spin165
m_ok166:
    s_lshl_b32 s90, s96, 3
    s_add_u32 s90, s90, s97
    s_lshl_b32 s90, s90, 15
    s_lshl_b32 s91, s16, 13
    s_add_u32 s90, s90, s91
    s_add_u32 s70, s90, 100663296
    buffer_load_dwordx4 v[128:131], v2, s[8:11], s70 offen offset:0 sc1
    buffer_load_dwordx4 v[132:135], v2, s[8:11], s70 offen offset:1024 sc1
    buffer_load_dwordx4 v[136:139], v2, s[8:11], s70 offen offset:2048 sc1
    buffer_load_dwordx4 v[140:143], v2, s[8:11], s70 offen offset:3072 sc1
    s_add_u32 s70, s70, 4096
    buffer_load_dwordx4 v[144:147], v2, s[8:11], s70 offen offset:0 sc1
    buffer_load_dwordx4 v[148:151], v2, s[8:11], s70 offen offset:1024 sc1
    buffer_load_dwordx4 v[152:155], v2, s[8:11], s70 offen offset:2048 sc1
    buffer_load_dwordx4 v[156:159], v2, s[8:11], s70 offen offset:3072 sc1
    s_mov_b32 s67, 40
    s_branch m_l3125
m_n164:
    s_branch m_l3x127
m_o1149:
    s_and_b32 s91, s2, 7
    s_lshl_b32 s91, s91, 5
    s_lshr_b32 s92, s2, 3
    s_add_u32 s91, s91, s92
    s_lshl_b32 s91, s91, 3
    s_add_u32 s91, s91, 12288
    s_cmp_lg_u32 s16, 0
    s_cbranch_scc1 m_np168
    v_mov_b32 v60, s4
    v_mov_b32 v61, s5
    s_add_u32 s90, s91, 117440512
    s_mov_b64 exec, 1
    buffer_store_dwordx2 v[60:61], off, s[8:11], s90 sc1
    s_mov_b64 exec, -1
m_np168:
    s_branch m_o2150
m_l3n129:
    s_sub_u32 s90, s68, 5
    s_min_u32 s67, s67, s90
    s_branch m_l3125
m_l3x127:
    s_cmp_eq_u32 s95, 1
    s_cbranch_scc1 m_noadd169
    s_waitcnt vmcnt(0)
    v_lshlrev_b32 v160, 16, v128
    v_and_b32 v161, 0xffff0000, v128
    v_lshlrev_b32 v162, 16, v129
    v_and_b32 v163, 0xffff0000, v129
    v_lshlrev_b32 v164, 16, v130
    v_and_b32 v165, 0xffff0000, v130
    v_lshlrev_b32 v166, 16, v131
    v_and_b32 v167, 0xffff0000, v131
    v_lshlrev_b32 v168, 16, v132
    v_and_b32 v169, 0xffff0000, v132
    v_lshlrev_b32 v170, 16, v133
    v_and_b32 v171, 0xffff0000, v133
    v_lshlrev_b32 v172, 16, v134
    v_and_b32 v173, 0xffff0000, v134
    v_lshlrev_b32 v174, 16, v135
    v_and_b32 v175, 0xffff0000, v135
    v_lshlrev_b32 v176, 16, v136
    v_and_b32 v177, 0xffff0000, v136
    v_lshlrev_b32 v178, 16, v137
    v_and_b32 v179, 0xffff0000, v137
    v_lshlrev_b32 v180, 16, v138
    v_and_b32 v181, 0xffff0000, v138
    v_lshlrev_b32 v182, 16, v139
    v_and_b32 v183, 0xffff0000, v139
    v_lshlrev_b32 v184, 16, v140
    v_and_b32 v185, 0xffff0000, v140
    v_lshlrev_b32 v186, 16, v141
    v_and_b32 v187, 0xffff0000, v141
    v_lshlrev_b32 v188, 16, v142
    v_and_b32 v189, 0xffff0000, v142
    v_lshlrev_b32 v190, 16, v143
    v_and_b32 v191, 0xffff0000, v143
    v_lshlrev_b32 v192, 16, v144
    v_and_b32 v193, 0xffff0000, v144
    v_lshlrev_b32 v194, 16, v145
    v_and_b32 v195, 0xffff0000, v145
    v_lshlrev_b32 v196, 16, v146
    v_and_b32 v197, 0xffff0000, v146
    v_lshlrev_b32 v198, 16, v147
    v_and_b32 v199, 0xffff0000, v147
    v_lshlrev_b32 v200, 16, v148
    v_and_b32 v201, 0xffff0000, v148
    v_lshlrev_b32 v202, 16, v149
    v_and_b32 v203, 0xffff0000, v149
    v_lshlrev_b32 v204, 16, v150
    v_and_b32 v205, 0xffff0000, v150
    v_lshlrev_b32 v206, 16, v151
    v_and_b32 v207, 0xffff0000, v151
    v_lshlrev_b32 v208, 16, v152
    v_and_b32 v209, 0xffff0000, v152
    v_lshlrev_b32 v210, 16, v153
    v_and_b32 v211, 0xffff0000, v153
    v_lshlrev_b32 v212, 16, v154
    v_and_b32 v213, 0xffff0000, v154
    v_lshlrev_b32 v214, 16, v155
    v_and_b32 v215, 0xffff0000, v155
    v_lshlrev_b32 v216, 16, v156
    v_and_b32 v217, 0xffff0000, v156
    v_lshlrev_b32 v218, 16, v157
    v_and_b32 v219, 0xffff0000, v157
    v_lshlrev_b32 v220, 16, v158
    v_and_b32 v221, 0xffff0000, v158
    v_lshlrev_b32 v222, 16, v159
    v_and_b32 v223, 0xffff0000, v159
    v_pk_add_f32 v[64:65], v[64:65], v[160:161]
    v_pk_add_f32 v[66:67], v[66:67], v[162:163]
    v_pk_add_f32 v[68:69], v[68:69], v[164:165]
    v_pk_add_f32 v[70:71], v[70:71], v[166:167]
    v_pk_add_f32 v[72:73], v[72:73], v[168:169]
    v_pk_add_f32 v[74:75], v[74:75], v[170:171]
    v_pk_add_f32 v[76:77], v[76:77], v[172:173]
    v_pk_add_f32 v[78:79], v[78:79], v[174:175]
    v_pk_add_f32 v[80:81], v[80:81], v[176:177]
    v_pk_add_f32 v[82:83], v[82:83], v[178:179]
    v_pk_add_f32 v[84:85], v[84:85], v[180:181]
    v_pk_add_f32 v[86:87], v[86:87], v[182:183]
    v_pk_add_f32 v[88:89], v[88:89], v[184:185]
    v_pk_add_f32 v[90:91], v[90:91], v[186:187]
    v_pk_add_f32 v[92:93], v[92:93], v[188:189]
    v_pk_add_f32 v[94:95], v[94:95], v[190:191]
    v_pk_add_f32 v[96:97], v[96:97], v[192:193]
    v_pk_add_f32 v[98:99], v[98:99], v[194:195]
    v_pk_add_f32 v[100:101], v[100:101], v[196:197]
    v_pk_add_f32 v[102:103], v[102:103], v[198:199]
    v_pk_add_f32 v[104:105], v[104:105], v[200:201]
    v_pk_add_f32 v[106:107], v[106:107], v[202:203]
    v_pk_add_f32 v[108:109], v[108:109], v[204:205]
    v_pk_add_f32 v[110:111], v[110:111], v[206:207]
    v_pk_add_f32 v[112:113], v[112:113], v[208:209]
    v_pk_add_f32 v[114:115], v[114:115], v[210:211]
    v_pk_add_f32 v[116:117], v[116:117], v[212:213]
    v_pk_add_f32 v[118:119], v[118:119], v[214:215]
    v_pk_add_f32 v[120:121], v[120:121], v[216:217]
    v_pk_add_f32 v[122:123], v[122:123], v[218:219]
    v_pk_add_f32 v[124:125], v[124:125], v[220:221]
    v_pk_add_f32 v[126:127], v[126:127], v[222:223]
m_noadd169:
    v_cvt_pk_bf16_f32 v64, v64, v65
    v_cvt_pk_bf16_f32 v65, v66, v67
    v_cvt_pk_bf16_f32 v66, v68, v69
    v_cvt_pk_bf16_f32 v67, v70, v71
    v_cvt_pk_bf16_f32 v96, v96, v97
    v_cvt_pk_bf16_f32 v97, v98, v99
    v_cvt_pk_bf16_f32 v98, v100, v101
    v_cvt_pk_bf16_f32 v99, v102, v103
    s_nop 1
    v_permlane16_swap_b32 v64, v66
    v_permlane16_swap_b32 v65, v67
    v_permlane16_swap_b32 v96, v98
    v_permlane16_swap_b32 v97, v99
    buffer_store_dwordx4 v[64:67], v7, s[28:31], s71 offen offset:0 sc1
    buffer_store_dwordx4 v[96:99], v7, s[28:31], s71 offen offset:64 sc1
    s_add_u32 s71, s71, s72
    v_cvt_pk_bf16_f32 v72, v72, v73
    v_cvt_pk_bf16_f32 v73, v74, v75
    v_cvt_pk_bf16_f32 v74, v76, v77
    v_cvt_pk_bf16_f32 v75, v78, v79
    v_cvt_pk_bf16_f32 v104, v104, v105
    v_cvt_pk_bf16_f32 v105, v106, v107
    v_cvt_pk_bf16_f32 v106, v108, v109
    v_cvt_pk_bf16_f32 v107, v110, v111
    s_nop 1
    v_permlane16_swap_b32 v72, v74
    v_permlane16_swap_b32 v73, v75
    v_permlane16_swap_b32 v104, v106
    v_permlane16_swap_b32 v105, v107
    buffer_store_dwordx4 v[72:75], v7, s[28:31], s71 offen offset:0 sc1
    buffer_store_dwordx4 v[104:107], v7, s[28:31], s71 offen offset:64 sc1
    s_add_u32 s71, s71, s72
    v_cvt_pk_bf16_f32 v80, v80, v81
    v_cvt_pk_bf16_f32 v81, v82, v83
    v_cvt_pk_bf16_f32 v82, v84, v85
    v_cvt_pk_bf16_f32 v83, v86, v87
    v_cvt_pk_bf16_f32 v112, v112, v113
    v_cvt_pk_bf16_f32 v113, v114, v115
    v_cvt_pk_bf16_f32 v114, v116, v117
    v_cvt_pk_bf16_f32 v115, v118, v119
    s_nop 1
    v_permlane16_swap_b32 v80, v82
    v_permlane16_swap_b32 v81, v83
    v_permlane16_swap_b32 v112, v114
    v_permlane16_swap_b32 v113, v115
    buffer_store_dwordx4 v[80:83], v7, s[28:31], s71 offen offset:0 sc1
    buffer_store_dwordx4 v[112:115], v7, s[28:31], s71 offen offset:64 sc1
    s_add_u32 s71, s71, s72
    v_cvt_pk_bf16_f32 v88, v88, v89
    v_cvt_pk_bf16_f32 v89, v90, v91
    v_cvt_pk_bf16_f32 v90, v92, v93
    v_cvt_pk_bf16_f32 v91, v94, v95
    v_cvt_pk_bf16_f32 v120, v120, v121
    v_cvt_pk_bf16_f32 v121, v122, v123
    v_cvt_pk_bf16_f32 v122, v124, v125
    v_cvt_pk_bf16_f32 v123, v126, v127
    s_nop 1
    v_permlane16_swap_b32 v88, v90
    v_permlane16_swap_b32 v89, v91
    v_permlane16_swap_b32 v120, v122
    v_permlane16_swap_b32 v121, v123
    buffer_store_dwordx4 v[88:91], v7, s[28:31], s71 offen offset:0 sc1
    buffer_store_dwordx4 v[120:123], v7, s[28:31], s71 offen offset:64 sc1
    s_add_u32 s71, s71, s72
m_end1:
    s_endpgm
m_stub72:
    v_cmp_lt_f32 vcc, s65, v8
    s_cmp_lg_u32 s64, s67
    s_cbranch_scc1 m_e171
    v_add_f32 v176, v176, v16
    v_mov_b32 v180, v9
    v_add_f32 v188, v188, v16
    v_add_f32 v177, v177, v17
    v_mov_b32 v181, v9
    v_add_f32 v189, v189, v17
    v_add_f32 v178, v178, v18
    v_mov_b32 v182, v9
    v_add_f32 v190, v190, v18
    v_add_f32 v179, v179, v19
    v_mov_b32 v183, v9
    v_add_f32 v191, v191, v19
    s_nop 0
m_e171:
    s_cmp_lg_u32 s64, s68
    s_cbranch_scc1 m_e172
    v_mov_b32 v176, v9
    v_mov_b32 v184, v9
    v_mov_b32 v188, v9
    v_mov_b32 v177, v9
    v_mov_b32 v185, v9
    v_mov_b32 v189, v9
    v_mov_b32 v178, v9
    v_mov_b32 v186, v9
    v_mov_b32 v190, v9
    v_mov_b32 v179, v9
    v_mov_b32 v187, v9
    v_mov_b32 v191, v9
    s_nop 0
m_e172:
    s_cbranch_vccnz m_rc173
m_sp170:
    s_branch m_ret73
m_stub75:
    v_cmp_lt_f32 vcc, s65, v8
    s_cmp_lg_u32 s64, s67
    s_cbranch_scc1 m_e175
    v_add_f32 v176, v176, v16
    v_mov_b32 v180, v9
    v_add_f32 v188, v188, v16
    v_add_f32 v177, v177, v17
    v_mov_b32 v181, v9
    v_add_f32 v189, v189, v17
    v_add_f32 v178, v178, v18
    v_mov_b32 v182, v9
    v_add_f32 v190, v190, v18
    v_add_f32 v179, v179, v19
    v_mov_b32 v183, v9
    v_add_f32 v191, v191, v19
    s_nop 0
m_e175:
    s_cmp_lg_u32 s64, s68
    s_cbranch_scc1 m_e176
    v_mov_b32 v176, v9
    v_mov_b32 v184, v9
    v_mov_b32 v188, v9
    v_mov_b32 v177, v9
    v_mov_b32 v185, v9
    v_mov_b32 v189, v9
    v_mov_b32 v178, v9
    v_mov_b32 v186, v9
    v_mov_b32 v190, v9
    v_mov_b32 v179, v9
    v_mov_b32 v187, v9
    v_mov_b32 v191, v9
    s_nop 0
m_e176:
    s_cbranch_vccnz m_rc177
m_sp174:
    s_branch m_ret76
m_stub93:
    v_cmp_lt_f32 vcc, s65, v8
    s_cmp_lg_u32 s64, s70
    s_cbranch_scc1 m_e179
    v_add_f32 v160, v160, v16
    v_mov_b32 v164, v9
    v_add_f32 v172, v172, v16
    v_add_f32 v161, v161, v17
    v_mov_b32 v165, v9
    v_add_f32 v173, v173, v17
    v_add_f32 v162, v162, v18
    v_mov_b32 v166, v9
    v_add_f32 v174, v174, v18
    v_add_f32 v163, v163, v19
    v_mov_b32 v167, v9
    v_add_f32 v175, v175, v19
    s_nop 0
m_e179:
    s_cmp_lg_u32 s64, s71
    s_cbranch_scc1 m_e180
    v_mov_b32 v160, v9
    v_mov_b32 v168, v9
    v_mov_b32 v172, v9
    v_mov_b32 v161, v9
    v_mov_b32 v169, v9
    v_mov_b32 v173, v9
    v_mov_b32 v162, v9
    v_mov_b32 v170, v9
    v_mov_b32 v174, v9
    v_mov_b32 v163, v9
    v_mov_b32 v171, v9
    v_mov_b32 v175, v9
    s_nop 0
m_e180:
    s_cbranch_vccnz m_rc181
m_sp178:
    s_branch m_ret94
m_stub95:
    v_cmp_lt_f32 vcc, s65, v8
    s_cmp_lg_u32 s64, s70
    s_cbranch_scc1 m_e183
    v_add_f32 v160, v160, v16
    v_mov_b32 v164, v9
    v_add_f32 v172, v172, v16
    v_add_f32 v161, v161, v17
    v_mov_b32 v165, v9
    v_add_f32 v173, v173, v17
    v_add_f32 v162, v162, v18
    v_mov_b32 v166, v9
    v_add_f32 v174, v174, v18
    v_add_f32 v163, v163, v19
    v_mov_b32 v167, v9
    v_add_f32 v175, v175, v19
    s_nop 0
m_e183:
    s_cmp_lg_u32 s64, s71
    s_cbranch_scc1 m_e184
    v_mov_b32 v160, v9
    v_mov_b32 v168, v9
    v_mov_b32 v172, v9
    v_mov_b32 v161, v9
    v_mov_b32 v169, v9
    v_mov_b32 v173, v9
    v_mov_b32 v162, v9
    v_mov_b32 v170, v9
    v_mov_b32 v174, v9
    v_mov_b32 v163, v9
    v_mov_b32 v171, v9
    v_mov_b32 v175, v9
    s_nop 0
m_e184:
    s_cmp_lg_u32 s64, s53
    s_cbranch_scc1 m_e187
    s_cmp_lg_u32 s16, 0
    s_cbranch_scc1 m_np188
    v_mov_b32 v60, s4
    v_mov_b32 v61, s5
    s_add_u32 s90, s101, 117440512
    s_mov_b64 exec, 1
    buffer_store_dwordx2 v[60:61], off, s[8:11], s90 sc1
    s_mov_b64 exec, -1
m_np188:
    s_mov_b32 s101, -1
m_e187:
    s_cmp_gt_u32 s64, 24
    s_cbranch_scc1 m_e185
    s_cmp_lg_u32 s64, 8
    s_cbranch_scc1 m_e189
    s_lshr_b32 s90, s32, 1
    s_lshl_b32 s90, s90, 7
    s_add_u32 s90, s90, 117440600
    v_min_u32 v0, 1, v1
    v_lshlrev_b32 v0, 5, v0
    buffer_load_dwordx2 v[4:5], v0, s[8:11], s90 offen sc1
    s_cmp_eq_u32 s17, -1
    s_cbranch_scc1 m_e185
    s_cmp_lg_u32 s16, 0
    s_cbranch_scc1 m_np190
    v_mov_b32 v60, s4
    v_mov_b32 v61, s5
    s_add_u32 s90, s17, 117440512
    s_mov_b64 exec, 1
    buffer_store_dwordx2 v[60:61], off, s[8:11], s90 sc1
    s_mov_b64 exec, -1
m_np190:
    s_branch m_e185
m_e189:
    s_cmp_lg_u32 s64, 16
    s_cbranch_scc1 m_e191
    s_waitcnt vmcnt(18)
    s_mov_b32 s3, 1048576
m_spin192:
    v_cmp_ne_u64 s[76:77], s[4:5], v[4:5]
    s_nop 3
    s_cmp_eq_u64 s[76:77], 0
    s_cbranch_scc1 m_e185
    s_sub_u32 s3, s3, 1
    s_cbranch_scc1 m_e185
    s_sleep 32
    s_lshr_b32 s90, s32, 1
    s_lshl_b32 s90, s90, 7
    s_add_u32 s90, s90, 117440600
    v_min_u32 v0, 1, v1
    v_lshlrev_b32 v0, 5, v0
    buffer_load_dwordx2 v[4:5], v0, s[8:11], s90 offen sc1
    s_waitcnt vmcnt(0)
    s_branch m_spin192
    s_branch m_e185
m_e191:
    s_cmp_lg_u32 s64, 20
    s_cbranch_scc1 m_e193
    buffer_load_dwordx2 v[4:5], v10, s[8:11], 0 offen sc1
    s_mov_b32 s44, s48
    s_mov_b32 s45, s49
    s_mov_b32 s46, 8388608
    s_lshl_b32 s90, s2, 2
    s_add_u32 s90, s90, s16
    s_lshl_b32 s90, s90, 13
    v_lshlrev_b32 v62, 7, v1
    buffer_load_dword v255, v62, s[44:47], s90 offen
    s_branch m_e185
m_e193:
    s_cmp_lg_u32 s64, 24
    s_cbranch_scc1 m_e194
    s_mov_b32 s44, s50
    s_mov_b32 s45, s51
    s_mov_b32 s46, 2097152
    s_lshl_b32 s90, s2, 2
    s_add_u32 s90, s90, s16
    s_lshl_b32 s90, s90, 13
    v_lshlrev_b32 v62, 7, v1
    buffer_load_dword v255, v62, s[44:47], s90 offen
    s_waitcnt vmcnt(18)
    s_mov_b32 s3, 1048576
m_spin195:
    v_cmp_ne_u64 s[76:77], s[4:5], v[4:5]
    s_nop 3
    s_cmp_eq_u64 s[76:77], 0
    s_cbranch_scc1 m_e185
    s_sub_u32 s3, s3, 1
    s_cbranch_scc1 m_e185
    s_sleep 32
    buffer_load_dwordx2 v[4:5], v10, s[8:11], 0 offen sc1
    s_waitcnt vmcnt(0)
    s_branch m_spin195
    s_branch m_e185
m_e194:
m_e185:
    s_cbranch_vccnz m_rc196
m_sp182:
    s_branch m_ret96
m_stub99:
    v_cmp_lt_f32 vcc, s65, v8
    s_cmp_lg_u32 s64, s70
    s_cbranch_scc1 m_e198
    v_add_f32 v160, v160, v16
    v_mov_b32 v164, v9
    v_add_f32 v172, v172, v16
    v_add_f32 v161, v161, v17
    v_mov_b32 v165, v9
    v_add_f32 v173, v173, v17
    v_add_f32 v162, v162, v18
    v_mov_b32 v166, v9
    v_add_f32 v174, v174, v18
    v_add_f32 v163, v163, v19
    v_mov_b32 v167, v9
    v_add_f32 v175, v175, v19
    s_nop 0
m_e198:
    s_cmp_lg_u32 s64, s71
    s_cbranch_scc1 m_e199
    v_mov_b32 v160, v9
    v_mov_b32 v168, v9
    v_mov_b32 v172, v9
    v_mov_b32 v161, v9
    v_mov_b32 v169, v9
    v_mov_b32 v173, v9
    v_mov_b32 v162, v9
    v_mov_b32 v170, v9
    v_mov_b32 v174, v9
    v_mov_b32 v163, v9
    v_mov_b32 v171, v9
    v_mov_b32 v175, v9
    s_nop 0
m_e199:
    s_cbranch_vccnz m_rc200
m_sp197:
    s_branch m_ret100
m_stub116:
    v_cmp_lt_f32 vcc, s65, v8
    s_cbranch_vccnz m_rc202
m_sp201:
    s_branch m_ret117
m_rc92:
    s_call_b64 s[74:75], m_rs0466
    s_branch m_sp77
m_rc115:
    s_call_b64 s[74:75], m_rs0265
    s_branch m_sp101
m_rc173:
    s_call_b64 s[74:75], m_rs0466
    s_branch m_sp170
m_rc177:
    s_call_b64 s[74:75], m_rs1468
    s_branch m_sp174
m_rc181:
    s_call_b64 s[74:75], m_rs1468
    s_branch m_sp178
m_rc196:
    s_call_b64 s[74:75], m_rs0265
    s_branch m_sp182
m_rc200:
    s_call_b64 s[74:75], m_rs1267
    s_branch m_sp197
m_rc202:
    s_call_b64 s[74:75], m_rs1267
    s_branch m_sp201
m_rs0265:
    s_nop 15
    v_max3_f32 v48, v64, v65, v66
    v_max3_f32 v48, v48, v67, v68
    v_max3_f32 v48, v48, v69, v70
    v_max3_f32 v48, v48, v71, 0
    v_mov_b32 v49, v48
    s_nop 1
    v_permlane32_swap_b32 v48, v49
    s_nop 1
    v_max_f32 v48, v48, v49
    v_mov_b32 v49, v48
    s_nop 1
    v_permlane16_swap_b32 v48, v49
    s_nop 1
    v_max_f32 v48, v48, v49
    v_exp_f32 v49, -v48
    v_sub_f32 v64, v64, v48
    v_sub_f32 v65, v65, v48
    v_sub_f32 v66, v66, v48
    v_sub_f32 v67, v67, v48
    v_sub_f32 v68, v68, v48
    v_sub_f32 v69, v69, v48
    v_sub_f32 v70, v70, v48
    v_sub_f32 v71, v71, v48
    v_sub_f32 v96, v96, v48
    v_sub_f32 v97, v97, v48
    v_sub_f32 v98, v98, v48
    v_sub_f32 v99, v99, v48
    v_sub_f32 v100, v100, v48
    v_sub_f32 v101, v101, v48
    v_sub_f32 v102, v102, v48
    v_sub_f32 v103, v103, v48
    v_sub_f32 v160, v160, v48
    v_sub_f32 v161, v161, v48
    v_sub_f32 v162, v162, v48
    v_sub_f32 v163, v163, v48
    v_sub_f32 v164, v164, v48
    v_sub_f32 v165, v165, v48
    v_sub_f32 v166, v166, v48
    v_sub_f32 v167, v167, v48
    v_mul_f32 v12, v12, v49
    v_accvgpr_read_b32 v52, a0
    v_accvgpr_read_b32 v53, a1
    v_accvgpr_read_b32 v54, a2
    v_accvgpr_read_b32 v55, a3
    v_accvgpr_read_b32 v56, a4
    v_accvgpr_read_b32 v57, a5
    v_accvgpr_read_b32 v58, a6
    v_accvgpr_read_b32 v59, a7
    v_mul_f32 v52, v52, v49
    v_mul_f32 v53, v53, v49
    v_mul_f32 v54, v54, v49
    v_mul_f32 v55, v55, v49
    v_mul_f32 v56, v56, v49
    v_mul_f32 v57, v57, v49
    v_mul_f32 v58, v58, v49
    v_mul_f32 v59, v59, v49
    v_accvgpr_write_b32 a0, v52
    v_accvgpr_write_b32 a1, v53
    v_accvgpr_write_b32 a2, v54
    v_accvgpr_write_b32 a3, v55
    v_accvgpr_write_b32 a4, v56
    v_accvgpr_write_b32 a5, v57
    v_accvgpr_write_b32 a6, v58
    v_accvgpr_write_b32 a7, v59
    v_accvgpr_read_b32 v52, a8
    v_accvgpr_read_b32 v53, a9
    v_accvgpr_read_b32 v54, a10
    v_accvgpr_read_b32 v55, a11
    v_accvgpr_read_b32 v56, a12
    v_accvgpr_read_b32 v57, a13
    v_accvgpr_read_b32 v58, a14
    v_accvgpr_read_b32 v59, a15
    v_mul_f32 v52, v52, v49
    v_mul_f32 v53, v53, v49
    v_mul_f32 v54, v54, v49
    v_mul_f32 v55, v55, v49
    v_mul_f32 v56, v56, v49
    v_mul_f32 v57, v57, v49
    v_mul_f32 v58, v58, v49
    v_mul_f32 v59, v59, v49
    v_accvgpr_write_b32 a8, v52
    v_accvgpr_write_b32 a9, v53
    v_accvgpr_write_b32 a10, v54
    v_accvgpr_write_b32 a11, v55
    v_accvgpr_write_b32 a12, v56
    v_accvgpr_write_b32 a13, v57
    v_accvgpr_write_b32 a14, v58
    v_accvgpr_write_b32 a15, v59
    v_accvgpr_read_b32 v52, a16
    v_accvgpr_read_b32 v53, a17
    v_accvgpr_read_b32 v54, a18
    v_accvgpr_read_b32 v55, a19
    v_accvgpr_read_b32 v56, a20
    v_accvgpr_read_b32 v57, a21
    v_accvgpr_read_b32 v58, a22
    v_accvgpr_read_b32 v59, a23
    v_mul_f32 v52, v52, v49
    v_mul_f32 v53, v53, v49
    v_mul_f32 v54, v54, v49
    v_mul_f32 v55, v55, v49
    v_mul_f32 v56, v56, v49
    v_mul_f32 v57, v57, v49
    v_mul_f32 v58, v58, v49
    v_mul_f32 v59, v59, v49
    v_accvgpr_write_b32 a16, v52
    v_accvgpr_write_b32 a17, v53
    v_accvgpr_write_b32 a18, v54
    v_accvgpr_write_b32 a19, v55
    v_accvgpr_write_b32 a20, v56
    v_accvgpr_write_b32 a21, v57
    v_accvgpr_write_b32 a22, v58
    v_accvgpr_write_b32 a23, v59
    v_accvgpr_read_b32 v52, a24
    v_accvgpr_read_b32 v53, a25
    v_accvgpr_read_b32 v54, a26
    v_accvgpr_read_b32 v55, a27
    v_accvgpr_read_b32 v56, a28
    v_accvgpr_read_b32 v57, a29
    v_accvgpr_read_b32 v58, a30
    v_accvgpr_read_b32 v59, a31
    v_mul_f32 v52, v52, v49
    v_mul_f32 v53, v53, v49
    v_mul_f32 v54, v54, v49
    v_mul_f32 v55, v55, v49
    v_mul_f32 v56, v56, v49
    v_mul_f32 v57, v57, v49
    v_mul_f32 v58, v58, v49
    v_mul_f32 v59, v59, v49
    v_accvgpr_write_b32 a24, v52
    v_accvgpr_write_b32 a25, v53
    v_accvgpr_write_b32 a26, v54
    v_accvgpr_write_b32 a27, v55
    v_accvgpr_write_b32 a28, v56
    v_accvgpr_write_b32 a29, v57
    v_accvgpr_write_b32 a30, v58
    v_accvgpr_write_b32 a31, v59
    v_exp_f32 v52, v64
    v_exp_f32 v53, v65
    v_exp_f32 v54, v66
    v_exp_f32 v55, v67
    v_exp_f32 v56, v68
    v_exp_f32 v57, v69
    v_exp_f32 v58, v70
    v_exp_f32 v59, v71
    s_nop 0
    v_cvt_pk_bf16_f32 v128, v52, v53
    v_cvt_pk_bf16_f32 v129, v54, v55
    v_cvt_pk_bf16_f32 v130, v56, v57
    v_cvt_pk_bf16_f32 v131, v58, v59
    s_nop 1
    v_mfma_f32_16x16x32_bf16 v[28:31], v[44:47], v[128:131], 0
    v_max3_f32 v48, v72, v73, v74
    v_max3_f32 v48, v48, v75, v76
    v_max3_f32 v48, v48, v77, v78
    v_max3_f32 v48, v48, v79, 0
    v_mov_b32 v49, v48
    s_nop 1
    v_permlane32_swap_b32 v48, v49
    s_nop 1
    v_max_f32 v48, v48, v49
    v_mov_b32 v49, v48
    s_nop 1
    v_permlane16_swap_b32 v48, v49
    s_nop 1
    v_max_f32 v48, v48, v49
    v_exp_f32 v49, -v48
    v_sub_f32 v72, v72, v48
    v_sub_f32 v73, v73, v48
    v_sub_f32 v74, v74, v48
    v_sub_f32 v75, v75, v48
    v_sub_f32 v76, v76, v48
    v_sub_f32 v77, v77, v48
    v_sub_f32 v78, v78, v48
    v_sub_f32 v79, v79, v48
    v_sub_f32 v104, v104, v48
    v_sub_f32 v105, v105, v48
    v_sub_f32 v106, v106, v48
    v_sub_f32 v107, v107, v48
    v_sub_f32 v108, v108, v48
    v_sub_f32 v109, v109, v48
    v_sub_f32 v110, v110, v48
    v_sub_f32 v111, v111, v48
    v_sub_f32 v168, v168, v48
    v_sub_f32 v169, v169, v48
    v_sub_f32 v170, v170, v48
    v_sub_f32 v171, v171, v48
    v_sub_f32 v172, v172, v48
    v_sub_f32 v173, v173, v48
    v_sub_f32 v174, v174, v48
    v_sub_f32 v175, v175, v48
    v_mul_f32 v13, v13, v49
    v_accvgpr_read_b32 v52, a32
    v_accvgpr_read_b32 v53, a33
    v_accvgpr_read_b32 v54, a34
    v_accvgpr_read_b32 v55, a35
    v_accvgpr_read_b32 v56, a36
    v_accvgpr_read_b32 v57, a37
    v_accvgpr_read_b32 v58, a38
    v_accvgpr_read_b32 v59, a39
    v_mul_f32 v52, v52, v49
    v_mul_f32 v53, v53, v49
    v_mul_f32 v54, v54, v49
    v_mul_f32 v55, v55, v49
    v_mul_f32 v56, v56, v49
    v_mul_f32 v57, v57, v49
    v_mul_f32 v58, v58, v49
    v_mul_f32 v59, v59, v49
    v_accvgpr_write_b32 a32, v52
    v_accvgpr_write_b32 a33, v53
    v_accvgpr_write_b32 a34, v54
    v_accvgpr_write_b32 a35, v55
    v_accvgpr_write_b32 a36, v56
    v_accvgpr_write_b32 a37, v57
    v_accvgpr_write_b32 a38, v58
    v_accvgpr_write_b32 a39, v59
    v_accvgpr_read_b32 v52, a40
    v_accvgpr_read_b32 v53, a41
    v_accvgpr_read_b32 v54, a42
    v_accvgpr_read_b32 v55, a43
    v_accvgpr_read_b32 v56, a44
    v_accvgpr_read_b32 v57, a45
    v_accvgpr_read_b32 v58, a46
    v_accvgpr_read_b32 v59, a47
    v_mul_f32 v52, v52, v49
    v_mul_f32 v53, v53, v49
    v_mul_f32 v54, v54, v49
    v_mul_f32 v55, v55, v49
    v_mul_f32 v56, v56, v49
    v_mul_f32 v57, v57, v49
    v_mul_f32 v58, v58, v49
    v_mul_f32 v59, v59, v49
    v_accvgpr_write_b32 a40, v52
    v_accvgpr_write_b32 a41, v53
    v_accvgpr_write_b32 a42, v54
    v_accvgpr_write_b32 a43, v55
    v_accvgpr_write_b32 a44, v56
    v_accvgpr_write_b32 a45, v57
    v_accvgpr_write_b32 a46, v58
    v_accvgpr_write_b32 a47, v59
    v_accvgpr_read_b32 v52, a48
    v_accvgpr_read_b32 v53, a49
    v_accvgpr_read_b32 v54, a50
    v_accvgpr_read_b32 v55, a51
    v_accvgpr_read_b32 v56, a52
    v_accvgpr_read_b32 v57, a53
    v_accvgpr_read_b32 v58, a54
    v_accvgpr_read_b32 v59, a55
    v_mul_f32 v52, v52, v49
    v_mul_f32 v53, v53, v49
    v_mul_f32 v54, v54, v49
    v_mul_f32 v55, v55, v49
    v_mul_f32 v56, v56, v49
    v_mul_f32 v57, v57, v49
    v_mul_f32 v58, v58, v49
    v_mul_f32 v59, v59, v49
    v_accvgpr_write_b32 a48, v52
    v_accvgpr_write_b32 a49, v53
    v_accvgpr_write_b32 a50, v54
    v_accvgpr_write_b32 a51, v55
    v_accvgpr_write_b32 a52, v56
    v_accvgpr_write_b32 a53, v57
    v_accvgpr_write_b32 a54, v58
    v_accvgpr_write_b32 a55, v59
    v_accvgpr_read_b32 v52, a56
    v_accvgpr_read_b32 v53, a57
    v_accvgpr_read_b32 v54, a58
    v_accvgpr_read_b32 v55, a59
    v_accvgpr_read_b32 v56, a60
    v_accvgpr_read_b32 v57, a61
    v_accvgpr_read_b32 v58, a62
    v_accvgpr_read_b32 v59, a63
    v_mul_f32 v52, v52, v49
    v_mul_f32 v53, v53, v49
    v_mul_f32 v54, v54, v49
    v_mul_f32 v55, v55, v49
    v_mul_f32 v56, v56, v49
    v_mul_f32 v57, v57, v49
    v_mul_f32 v58, v58, v49
    v_mul_f32 v59, v59, v49
    v_accvgpr_write_b32 a56, v52
    v_accvgpr_write_b32 a57, v53
    v_accvgpr_write_b32 a58, v54
    v_accvgpr_write_b32 a59, v55
    v_accvgpr_write_b32 a60, v56
    v_accvgpr_write_b32 a61, v57
    v_accvgpr_write_b32 a62, v58
    v_accvgpr_write_b32 a63, v59
    v_exp_f32 v52, v72
    v_exp_f32 v53, v73
    v_exp_f32 v54, v74
    v_exp_f32 v55, v75
    v_exp_f32 v56, v76
    v_exp_f32 v57, v77
    v_exp_f32 v58, v78
    v_exp_f32 v59, v79
    s_nop 0
    v_cvt_pk_bf16_f32 v132, v52, v53
    v_cvt_pk_bf16_f32 v133, v54, v55
    v_cvt_pk_bf16_f32 v134, v56, v57
    v_cvt_pk_bf16_f32 v135, v58, v59
    s_nop 1
    v_mfma_f32_16x16x32_bf16 v[32:35], v[44:47], v[132:135], 0
    s_nop 7
    s_setpc_b64 s[74:75]
m_rs0466:
    s_nop 15
    v_max3_f32 v48, v64, v65, v66
    v_max3_f32 v48, v48, v67, v68
    v_max3_f32 v48, v48, v69, v70
    v_max3_f32 v48, v48, v71, 0
    v_mov_b32 v49, v48
    s_nop 1
    v_permlane32_swap_b32 v48, v49
    s_nop 1
    v_max_f32 v48, v48, v49
    v_mov_b32 v49, v48
    s_nop 1
    v_permlane16_swap_b32 v48, v49
    s_nop 1
    v_max_f32 v48, v48, v49
    v_exp_f32 v49, -v48
    v_sub_f32 v64, v64, v48
    v_sub_f32 v65, v65, v48
    v_sub_f32 v66, v66, v48
    v_sub_f32 v67, v67, v48
    v_sub_f32 v68, v68, v48
    v_sub_f32 v69, v69, v48
    v_sub_f32 v70, v70, v48
    v_sub_f32 v71, v71, v48
    v_sub_f32 v96, v96, v48
    v_sub_f32 v97, v97, v48
    v_sub_f32 v98, v98, v48
    v_sub_f32 v99, v99, v48
    v_sub_f32 v100, v100, v48
    v_sub_f32 v101, v101, v48
    v_sub_f32 v102, v102, v48
    v_sub_f32 v103, v103, v48
    v_sub_f32 v160, v160, v48
    v_sub_f32 v161, v161, v48
    v_sub_f32 v162, v162, v48
    v_sub_f32 v163, v163, v48
    v_sub_f32 v164, v164, v48
    v_sub_f32 v165, v165, v48
    v_sub_f32 v166, v166, v48
    v_sub_f32 v167, v167, v48
    v_mul_f32 v12, v12, v49
    v_accvgpr_read_b32 v52, a0
    v_accvgpr_read_b32 v53, a1
    v_accvgpr_read_b32 v54, a2
    v_accvgpr_read_b32 v55, a3
    v_accvgpr_read_b32 v56, a4
    v_accvgpr_read_b32 v57, a5
    v_accvgpr_read_b32 v58, a6
    v_accvgpr_read_b32 v59, a7
    v_mul_f32 v52, v52, v49
    v_mul_f32 v53, v53, v49
    v_mul_f32 v54, v54, v49
    v_mul_f32 v55, v55, v49
    v_mul_f32 v56, v56, v49
    v_mul_f32 v57, v57, v49
    v_mul_f32 v58, v58, v49
    v_mul_f32 v59, v59, v49
    v_accvgpr_write_b32 a0, v52
    v_accvgpr_write_b32 a1, v53
    v_accvgpr_write_b32 a2, v54
    v_accvgpr_write_b32 a3, v55
    v_accvgpr_write_b32 a4, v56
    v_accvgpr_write_b32 a5, v57
    v_accvgpr_write_b32 a6, v58
    v_accvgpr_write_b32 a7, v59
    v_accvgpr_read_b32 v52, a8
    v_accvgpr_read_b32 v53, a9
    v_accvgpr_read_b32 v54, a10
    v_accvgpr_read_b32 v55, a11
    v_accvgpr_read_b32 v56, a12
    v_accvgpr_read_b32 v57, a13
    v_accvgpr_read_b32 v58, a14
    v_accvgpr_read_b32 v59, a15
    v_mul_f32 v52, v52, v49
    v_mul_f32 v53, v53, v49
    v_mul_f32 v54, v54, v49
    v_mul_f32 v55, v55, v49
    v_mul_f32 v56, v56, v49
    v_mul_f32 v57, v57, v49
    v_mul_f32 v58, v58, v49
    v_mul_f32 v59, v59, v49
    v_accvgpr_write_b32 a8, v52
    v_accvgpr_write_b32 a9, v53
    v_accvgpr_write_b32 a10, v54
    v_accvgpr_write_b32 a11, v55
    v_accvgpr_write_b32 a12, v56
    v_accvgpr_write_b32 a13, v57
    v_accvgpr_write_b32 a14, v58
    v_accvgpr_write_b32 a15, v59
    v_accvgpr_read_b32 v52, a16
    v_accvgpr_read_b32 v53, a17
    v_accvgpr_read_b32 v54, a18
    v_accvgpr_read_b32 v55, a19
    v_accvgpr_read_b32 v56, a20
    v_accvgpr_read_b32 v57, a21
    v_accvgpr_read_b32 v58, a22
    v_accvgpr_read_b32 v59, a23
    v_mul_f32 v52, v52, v49
    v_mul_f32 v53, v53, v49
    v_mul_f32 v54, v54, v49
    v_mul_f32 v55, v55, v49
    v_mul_f32 v56, v56, v49
    v_mul_f32 v57, v57, v49
    v_mul_f32 v58, v58, v49
    v_mul_f32 v59, v59, v49
    v_accvgpr_write_b32 a16, v52
    v_accvgpr_write_b32 a17, v53
    v_accvgpr_write_b32 a18, v54
    v_accvgpr_write_b32 a19, v55
    v_accvgpr_write_b32 a20, v56
    v_accvgpr_write_b32 a21, v57
    v_accvgpr_write_b32 a22, v58
    v_accvgpr_write_b32 a23, v59
    v_accvgpr_read_b32 v52, a24
    v_accvgpr_read_b32 v53, a25
    v_accvgpr_read_b32 v54, a26
    v_accvgpr_read_b32 v55, a27
    v_accvgpr_read_b32 v56, a28
    v_accvgpr_read_b32 v57, a29
    v_accvgpr_read_b32 v58, a30
    v_accvgpr_read_b32 v59, a31
    v_mul_f32 v52, v52, v49
    v_mul_f32 v53, v53, v49
    v_mul_f32 v54, v54, v49
    v_mul_f32 v55, v55, v49
    v_mul_f32 v56, v56, v49
    v_mul_f32 v57, v57, v49
    v_mul_f32 v58, v58, v49
    v_mul_f32 v59, v59, v49
    v_accvgpr_write_b32 a24, v52
    v_accvgpr_write_b32 a25, v53
    v_accvgpr_write_b32 a26, v54
    v_accvgpr_write_b32 a27, v55
    v_accvgpr_write_b32 a28, v56
    v_accvgpr_write_b32 a29, v57
    v_accvgpr_write_b32 a30, v58
    v_accvgpr_write_b32 a31, v59
    v_exp_f32 v52, v64
    v_exp_f32 v53, v65
    v_exp_f32 v54, v66
    v_exp_f32 v55, v67
    v_exp_f32 v56, v68
    v_exp_f32 v57, v69
    v_exp_f32 v58, v70
    v_exp_f32 v59, v71
    s_nop 0
    v_cvt_pk_bf16_f32 v128, v52, v53
    v_cvt_pk_bf16_f32 v129, v54, v55
    v_cvt_pk_bf16_f32 v130, v56, v57
    v_cvt_pk_bf16_f32 v131, v58, v59
    s_nop 1
    v_mfma_f32_16x16x32_bf16 v[28:31], v[44:47], v[128:131], 0
    v_max3_f32 v48, v72, v73, v74
    v_max3_f32 v48, v48, v75, v76
    v_max3_f32 v48, v48, v77, v78
    v_max3_f32 v48, v48, v79, 0
    v_mov_b32 v49, v48
    s_nop 1
    v_permlane32_swap_b32 v48, v49
    s_nop 1
    v_max_f32 v48, v48, v49
    v_mov_b32 v49, v48
    s_nop 1
    v_permlane16_swap_b32 v48, v49
    s_nop 1
    v_max_f32 v48, v48, v49
    v_exp_f32 v49, -v48
    v_sub_f32 v72, v72, v48
    v_sub_f32 v73, v73, v48
    v_sub_f32 v74, v74, v48
    v_sub_f32 v75, v75, v48
    v_sub_f32 v76, v76, v48
    v_sub_f32 v77, v77, v48
    v_sub_f32 v78, v78, v48
    v_sub_f32 v79, v79, v48
    v_sub_f32 v104, v104, v48
    v_sub_f32 v105, v105, v48
    v_sub_f32 v106, v106, v48
    v_sub_f32 v107, v107, v48
    v_sub_f32 v108, v108, v48
    v_sub_f32 v109, v109, v48
    v_sub_f32 v110, v110, v48
    v_sub_f32 v111, v111, v48
    v_sub_f32 v168, v168, v48
    v_sub_f32 v169, v169, v48
    v_sub_f32 v170, v170, v48
    v_sub_f32 v171, v171, v48
    v_sub_f32 v172, v172, v48
    v_sub_f32 v173, v173, v48
    v_sub_f32 v174, v174, v48
    v_sub_f32 v175, v175, v48
    v_mul_f32 v13, v13, v49
    v_accvgpr_read_b32 v52, a32
    v_accvgpr_read_b32 v53, a33
    v_accvgpr_read_b32 v54, a34
    v_accvgpr_read_b32 v55, a35
    v_accvgpr_read_b32 v56, a36
    v_accvgpr_read_b32 v57, a37
    v_accvgpr_read_b32 v58, a38
    v_accvgpr_read_b32 v59, a39
    v_mul_f32 v52, v52, v49
    v_mul_f32 v53, v53, v49
    v_mul_f32 v54, v54, v49
    v_mul_f32 v55, v55, v49
    v_mul_f32 v56, v56, v49
    v_mul_f32 v57, v57, v49
    v_mul_f32 v58, v58, v49
    v_mul_f32 v59, v59, v49
    v_accvgpr_write_b32 a32, v52
    v_accvgpr_write_b32 a33, v53
    v_accvgpr_write_b32 a34, v54
    v_accvgpr_write_b32 a35, v55
    v_accvgpr_write_b32 a36, v56
    v_accvgpr_write_b32 a37, v57
    v_accvgpr_write_b32 a38, v58
    v_accvgpr_write_b32 a39, v59
    v_accvgpr_read_b32 v52, a40
    v_accvgpr_read_b32 v53, a41
    v_accvgpr_read_b32 v54, a42
    v_accvgpr_read_b32 v55, a43
    v_accvgpr_read_b32 v56, a44
    v_accvgpr_read_b32 v57, a45
    v_accvgpr_read_b32 v58, a46
    v_accvgpr_read_b32 v59, a47
    v_mul_f32 v52, v52, v49
    v_mul_f32 v53, v53, v49
    v_mul_f32 v54, v54, v49
    v_mul_f32 v55, v55, v49
    v_mul_f32 v56, v56, v49
    v_mul_f32 v57, v57, v49
    v_mul_f32 v58, v58, v49
    v_mul_f32 v59, v59, v49
    v_accvgpr_write_b32 a40, v52
    v_accvgpr_write_b32 a41, v53
    v_accvgpr_write_b32 a42, v54
    v_accvgpr_write_b32 a43, v55
    v_accvgpr_write_b32 a44, v56
    v_accvgpr_write_b32 a45, v57
    v_accvgpr_write_b32 a46, v58
    v_accvgpr_write_b32 a47, v59
    v_accvgpr_read_b32 v52, a48
    v_accvgpr_read_b32 v53, a49
    v_accvgpr_read_b32 v54, a50
    v_accvgpr_read_b32 v55, a51
    v_accvgpr_read_b32 v56, a52
    v_accvgpr_read_b32 v57, a53
    v_accvgpr_read_b32 v58, a54
    v_accvgpr_read_b32 v59, a55
    v_mul_f32 v52, v52, v49
    v_mul_f32 v53, v53, v49
    v_mul_f32 v54, v54, v49
    v_mul_f32 v55, v55, v49
    v_mul_f32 v56, v56, v49
    v_mul_f32 v57, v57, v49
    v_mul_f32 v58, v58, v49
    v_mul_f32 v59, v59, v49
    v_accvgpr_write_b32 a48, v52
    v_accvgpr_write_b32 a49, v53
    v_accvgpr_write_b32 a50, v54
    v_accvgpr_write_b32 a51, v55
    v_accvgpr_write_b32 a52, v56
    v_accvgpr_write_b32 a53, v57
    v_accvgpr_write_b32 a54, v58
    v_accvgpr_write_b32 a55, v59
    v_accvgpr_read_b32 v52, a56
    v_accvgpr_read_b32 v53, a57
    v_accvgpr_read_b32 v54, a58
    v_accvgpr_read_b32 v55, a59
    v_accvgpr_read_b32 v56, a60
    v_accvgpr_read_b32 v57, a61
    v_accvgpr_read_b32 v58, a62
    v_accvgpr_read_b32 v59, a63
    v_mul_f32 v52, v52, v49
    v_mul_f32 v53, v53, v49
    v_mul_f32 v54, v54, v49
    v_mul_f32 v55, v55, v49
    v_mul_f32 v56, v56, v49
    v_mul_f32 v57, v57, v49
    v_mul_f32 v58, v58, v49
    v_mul_f32 v59, v59, v49
    v_accvgpr_write_b32 a56, v52
    v_accvgpr_write_b32 a57, v53
    v_accvgpr_write_b32 a58, v54
    v_accvgpr_write_b32 a59, v55
    v_accvgpr_write_b32 a60, v56
    v_accvgpr_write_b32 a61, v57
    v_accvgpr_write_b32 a62, v58
    v_accvgpr_write_b32 a63, v59
    v_exp_f32 v52, v72
    v_exp_f32 v53, v73
    v_exp_f32 v54, v74
    v_exp_f32 v55, v75
    v_exp_f32 v56, v76
    v_exp_f32 v57, v77
    v_exp_f32 v58, v78
    v_exp_f32 v59, v79
    s_nop 0
    v_cvt_pk_bf16_f32 v132, v52, v53
    v_cvt_pk_bf16_f32 v133, v54, v55
    v_cvt_pk_bf16_f32 v134, v56, v57
    v_cvt_pk_bf16_f32 v135, v58, v59
    s_nop 1
    v_mfma_f32_16x16x32_bf16 v[32:35], v[44:47], v[132:135], 0
    v_max3_f32 v48, v80, v81, v82
    v_max3_f32 v48, v48, v83, v84
    v_max3_f32 v48, v48, v85, v86
    v_max3_f32 v48, v48, v87, 0
    v_mov_b32 v49, v48
    s_nop 1
    v_permlane32_swap_b32 v48, v49
    s_nop 1
    v_max_f32 v48, v48, v49
    v_mov_b32 v49, v48
    s_nop 1
    v_permlane16_swap_b32 v48, v49
    s_nop 1
    v_max_f32 v48, v48, v49
    v_exp_f32 v49, -v48
    v_sub_f32 v80, v80, v48
    v_sub_f32 v81, v81, v48
    v_sub_f32 v82, v82, v48
    v_sub_f32 v83, v83, v48
    v_sub_f32 v84, v84, v48
    v_sub_f32 v85, v85, v48
    v_sub_f32 v86, v86, v48
    v_sub_f32 v87, v87, v48
    v_sub_f32 v112, v112, v48
    v_sub_f32 v113, v113, v48
    v_sub_f32 v114, v114, v48
    v_sub_f32 v115, v115, v48
    v_sub_f32 v116, v116, v48
    v_sub_f32 v117, v117, v48
    v_sub_f32 v118, v118, v48
    v_sub_f32 v119, v119, v48
    v_sub_f32 v176, v176, v48
    v_sub_f32 v177, v177, v48
    v_sub_f32 v178, v178, v48
    v_sub_f32 v179, v179, v48
    v_sub_f32 v180, v180, v48
    v_sub_f32 v181, v181, v48
    v_sub_f32 v182, v182, v48
    v_sub_f32 v183, v183, v48
    v_mul_f32 v14, v14, v49
    v_accvgpr_read_b32 v52, a64
    v_accvgpr_read_b32 v53, a65
    v_accvgpr_read_b32 v54, a66
    v_accvgpr_read_b32 v55, a67
    v_accvgpr_read_b32 v56, a68
    v_accvgpr_read_b32 v57, a69
    v_accvgpr_read_b32 v58, a70
    v_accvgpr_read_b32 v59, a71
    v_mul_f32 v52, v52, v49
    v_mul_f32 v53, v53, v49
    v_mul_f32 v54, v54, v49
    v_mul_f32 v55, v55, v49
    v_mul_f32 v56, v56, v49
    v_mul_f32 v57, v57, v49
    v_mul_f32 v58, v58, v49
    v_mul_f32 v59, v59, v49
    v_accvgpr_write_b32 a64, v52
    v_accvgpr_write_b32 a65, v53
    v_accvgpr_write_b32 a66, v54
    v_accvgpr_write_b32 a67, v55
    v_accvgpr_write_b32 a68, v56
    v_accvgpr_write_b32 a69, v57
    v_accvgpr_write_b32 a70, v58
    v_accvgpr_write_b32 a71, v59
    v_accvgpr_read_b32 v52, a72
    v_accvgpr_read_b32 v53, a73
    v_accvgpr_read_b32 v54, a74
    v_accvgpr_read_b32 v55, a75
    v_accvgpr_read_b32 v56, a76
    v_accvgpr_read_b32 v57, a77
    v_accvgpr_read_b32 v58, a78
    v_accvgpr_read_b32 v59, a79
    v_mul_f32 v52, v52, v49
    v_mul_f32 v53, v53, v49
    v_mul_f32 v54, v54, v49
    v_mul_f32 v55, v55, v49
    v_mul_f32 v56, v56, v49
    v_mul_f32 v57, v57, v49
    v_mul_f32 v58, v58, v49
    v_mul_f32 v59, v59, v49
    v_accvgpr_write_b32 a72, v52
    v_accvgpr_write_b32 a73, v53
    v_accvgpr_write_b32 a74, v54
    v_accvgpr_write_b32 a75, v55
    v_accvgpr_write_b32 a76, v56
    v_accvgpr_write_b32 a77, v57
    v_accvgpr_write_b32 a78, v58
    v_accvgpr_write_b32 a79, v59
    v_accvgpr_read_b32 v52, a80
    v_accvgpr_read_b32 v53, a81
    v_accvgpr_read_b32 v54, a82
    v_accvgpr_read_b32 v55, a83
    v_accvgpr_read_b32 v56, a84
    v_accvgpr_read_b32 v57, a85
    v_accvgpr_read_b32 v58, a86
    v_accvgpr_read_b32 v59, a87
    v_mul_f32 v52, v52, v49
    v_mul_f32 v53, v53, v49
    v_mul_f32 v54, v54, v49
    v_mul_f32 v55, v55, v49
    v_mul_f32 v56, v56, v49
    v_mul_f32 v57, v57, v49
    v_mul_f32 v58, v58, v49
    v_mul_f32 v59, v59, v49
    v_accvgpr_write_b32 a80, v52
    v_accvgpr_write_b32 a81, v53
    v_accvgpr_write_b32 a82, v54
    v_accvgpr_write_b32 a83, v55
    v_accvgpr_write_b32 a84, v56
    v_accvgpr_write_b32 a85, v57
    v_accvgpr_write_b32 a86, v58
    v_accvgpr_write_b32 a87, v59
    v_accvgpr_read_b32 v52, a88
    v_accvgpr_read_b32 v53, a89
    v_accvgpr_read_b32 v54, a90
    v_accvgpr_read_b32 v55, a91
    v_accvgpr_read_b32 v56, a92
    v_accvgpr_read_b32 v57, a93
    v_accvgpr_read_b32 v58, a94
    v_accvgpr_read_b32 v59, a95
    v_mul_f32 v52, v52, v49
    v_mul_f32 v53, v53, v49
    v_mul_f32 v54, v54, v49
    v_mul_f32 v55, v55, v49
    v_mul_f32 v56, v56, v49
    v_mul_f32 v57, v57, v49
    v_mul_f32 v58, v58, v49
    v_mul_f32 v59, v59, v49
    v_accvgpr_write_b32 a88, v52
    v_accvgpr_write_b32 a89, v53
    v_accvgpr_write_b32 a90, v54
    v_accvgpr_write_b32 a91, v55
    v_accvgpr_write_b32 a92, v56
    v_accvgpr_write_b32 a93, v57
    v_accvgpr_write_b32 a94, v58
    v_accvgpr_write_b32 a95, v59
    v_exp_f32 v52, v80
    v_exp_f32 v53, v81
    v_exp_f32 v54, v82
    v_exp_f32 v55, v83
    v_exp_f32 v56, v84
    v_exp_f32 v57, v85
    v_exp_f32 v58, v86
    v_exp_f32 v59, v87
    s_nop 0
    v_cvt_pk_bf16_f32 v136, v52, v53
    v_cvt_pk_bf16_f32 v137, v54, v55
    v_cvt_pk_bf16_f32 v138, v56, v57
    v_cvt_pk_bf16_f32 v139, v58, v59
    s_nop 1
    v_mfma_f32_16x16x32_bf16 v[36:39], v[44:47], v[136:139], 0
    v_max3_f32 v48, v88, v89, v90
    v_max3_f32 v48, v48, v91, v92
    v_max3_f32 v48, v48, v93, v94
    v_max3_f32 v48, v48, v95, 0
    v_mov_b32 v49, v48
    s_nop 1
    v_permlane32_swap_b32 v48, v49
    s_nop 1
    v_max_f32 v48, v48, v49
    v_mov_b32 v49, v48
    s_nop 1
    v_permlane16_swap_b32 v48, v49
    s_nop 1
    v_max_f32 v48, v48, v49
    v_exp_f32 v49, -v48
    v_sub_f32 v88, v88, v48
    v_sub_f32 v89, v89, v48
    v_sub_f32 v90, v90, v48
    v_sub_f32 v91, v91, v48
    v_sub_f32 v92, v92, v48
    v_sub_f32 v93, v93, v48
    v_sub_f32 v94, v94, v48
    v_sub_f32 v95, v95, v48
    v_sub_f32 v120, v120, v48
    v_sub_f32 v121, v121, v48
    v_sub_f32 v122, v122, v48
    v_sub_f32 v123, v123, v48
    v_sub_f32 v124, v124, v48
    v_sub_f32 v125, v125, v48
    v_sub_f32 v126, v126, v48
    v_sub_f32 v127, v127, v48
    v_sub_f32 v184, v184, v48
    v_sub_f32 v185, v185, v48
    v_sub_f32 v186, v186, v48
    v_sub_f32 v187, v187, v48
    v_sub_f32 v188, v188, v48
    v_sub_f32 v189, v189, v48
    v_sub_f32 v190, v190, v48
    v_sub_f32 v191, v191, v48
    v_mul_f32 v15, v15, v49
    v_accvgpr_read_b32 v52, a96
    v_accvgpr_read_b32 v53, a97
    v_accvgpr_read_b32 v54, a98
    v_accvgpr_read_b32 v55, a99
    v_accvgpr_read_b32 v56, a100
    v_accvgpr_read_b32 v57, a101
    v_accvgpr_read_b32 v58, a102
    v_accvgpr_read_b32 v59, a103
    v_mul_f32 v52, v52, v49
    v_mul_f32 v53, v53, v49
    v_mul_f32 v54, v54, v49
    v_mul_f32 v55, v55, v49
    v_mul_f32 v56, v56, v49
    v_mul_f32 v57, v57, v49
    v_mul_f32 v58, v58, v49
    v_mul_f32 v59, v59, v49
    v_accvgpr_write_b32 a96, v52
    v_accvgpr_write_b32 a97, v53
    v_accvgpr_write_b32 a98, v54
    v_accvgpr_write_b32 a99, v55
    v_accvgpr_write_b32 a100, v56
    v_accvgpr_write_b32 a101, v57
    v_accvgpr_write_b32 a102, v58
    v_accvgpr_write_b32 a103, v59
    v_accvgpr_read_b32 v52, a104
    v_accvgpr_read_b32 v53, a105
    v_accvgpr_read_b32 v54, a106
    v_accvgpr_read_b32 v55, a107
    v_accvgpr_read_b32 v56, a108
    v_accvgpr_read_b32 v57, a109
    v_accvgpr_read_b32 v58, a110
    v_accvgpr_read_b32 v59, a111
    v_mul_f32 v52, v52, v49
    v_mul_f32 v53, v53, v49
    v_mul_f32 v54, v54, v49
    v_mul_f32 v55, v55, v49
    v_mul_f32 v56, v56, v49
    v_mul_f32 v57, v57, v49
    v_mul_f32 v58, v58, v49
    v_mul_f32 v59, v59, v49
    v_accvgpr_write_b32 a104, v52
    v_accvgpr_write_b32 a105, v53
    v_accvgpr_write_b32 a106, v54
    v_accvgpr_write_b32 a107, v55
    v_accvgpr_write_b32 a108, v56
    v_accvgpr_write_b32 a109, v57
    v_accvgpr_write_b32 a110, v58
    v_accvgpr_write_b32 a111, v59
    v_accvgpr_read_b32 v52, a112
    v_accvgpr_read_b32 v53, a113
    v_accvgpr_read_b32 v54, a114
    v_accvgpr_read_b32 v55, a115
    v_accvgpr_read_b32 v56, a116
    v_accvgpr_read_b32 v57, a117
    v_accvgpr_read_b32 v58, a118
    v_accvgpr_read_b32 v59, a119
    v_mul_f32 v52, v52, v49
    v_mul_f32 v53, v53, v49
    v_mul_f32 v54, v54, v49
    v_mul_f32 v55, v55, v49
    v_mul_f32 v56, v56, v49
    v_mul_f32 v57, v57, v49
    v_mul_f32 v58, v58, v49
    v_mul_f32 v59, v59, v49
    v_accvgpr_write_b32 a112, v52
    v_accvgpr_write_b32 a113, v53
    v_accvgpr_write_b32 a114, v54
    v_accvgpr_write_b32 a115, v55
    v_accvgpr_write_b32 a116, v56
    v_accvgpr_write_b32 a117, v57
    v_accvgpr_write_b32 a118, v58
    v_accvgpr_write_b32 a119, v59
    v_accvgpr_read_b32 v52, a120
    v_accvgpr_read_b32 v53, a121
    v_accvgpr_read_b32 v54, a122
    v_accvgpr_read_b32 v55, a123
    v_accvgpr_read_b32 v56, a124
    v_accvgpr_read_b32 v57, a125
    v_accvgpr_read_b32 v58, a126
    v_accvgpr_read_b32 v59, a127
    v_mul_f32 v52, v52, v49
    v_mul_f32 v53, v53, v49
    v_mul_f32 v54, v54, v49
    v_mul_f32 v55, v55, v49
    v_mul_f32 v56, v56, v49
    v_mul_f32 v57, v57, v49
    v_mul_f32 v58, v58, v49
    v_mul_f32 v59, v59, v49
    v_accvgpr_write_b32 a120, v52
    v_accvgpr_write_b32 a121, v53
    v_accvgpr_write_b32 a122, v54
    v_accvgpr_write_b32 a123, v55
    v_accvgpr_write_b32 a124, v56
    v_accvgpr_write_b32 a125, v57
    v_accvgpr_write_b32 a126, v58
    v_accvgpr_write_b32 a127, v59
    v_exp_f32 v52, v88
    v_exp_f32 v53, v89
    v_exp_f32 v54, v90
    v_exp_f32 v55, v91
    v_exp_f32 v56, v92
    v_exp_f32 v57, v93
    v_exp_f32 v58, v94
    v_exp_f32 v59, v95
    s_nop 0
    v_cvt_pk_bf16_f32 v140, v52, v53
    v_cvt_pk_bf16_f32 v141, v54, v55
    v_cvt_pk_bf16_f32 v142, v56, v57
    v_cvt_pk_bf16_f32 v143, v58, v59
    s_nop 1
    v_mfma_f32_16x16x32_bf16 v[40:43], v[44:47], v[140:143], 0
    s_nop 7
    s_setpc_b64 s[74:75]
m_rs1267:
    s_nop 15
    v_max3_f32 v48, v96, v97, v98
    v_max3_f32 v48, v48, v99, v100
    v_max3_f32 v48, v48, v101, v102
    v_max3_f32 v48, v48, v103, 0
    v_mov_b32 v49, v48
    s_nop 1
    v_permlane32_swap_b32 v48, v49
    s_nop 1
    v_max_f32 v48, v48, v49
    v_mov_b32 v49, v48
    s_nop 1
    v_permlane16_swap_b32 v48, v49
    s_nop 1
    v_max_f32 v48, v48, v49
    v_exp_f32 v49, -v48
    v_sub_f32 v96, v96, v48
    v_sub_f32 v97, v97, v48
    v_sub_f32 v98, v98, v48
    v_sub_f32 v99, v99, v48
    v_sub_f32 v100, v100, v48
    v_sub_f32 v101, v101, v48
    v_sub_f32 v102, v102, v48
    v_sub_f32 v103, v103, v48
    v_sub_f32 v64, v64, v48
    v_sub_f32 v65, v65, v48
    v_sub_f32 v66, v66, v48
    v_sub_f32 v67, v67, v48
    v_sub_f32 v68, v68, v48
    v_sub_f32 v69, v69, v48
    v_sub_f32 v70, v70, v48
    v_sub_f32 v71, v71, v48
    v_sub_f32 v160, v160, v48
    v_sub_f32 v161, v161, v48
    v_sub_f32 v162, v162, v48
    v_sub_f32 v163, v163, v48
    v_sub_f32 v164, v164, v48
    v_sub_f32 v165, v165, v48
    v_sub_f32 v166, v166, v48
    v_sub_f32 v167, v167, v48
    v_mul_f32 v12, v12, v49
    v_accvgpr_read_b32 v52, a0
    v_accvgpr_read_b32 v53, a1
    v_accvgpr_read_b32 v54, a2
    v_accvgpr_read_b32 v55, a3
    v_accvgpr_read_b32 v56, a4
    v_accvgpr_read_b32 v57, a5
    v_accvgpr_read_b32 v58, a6
    v_accvgpr_read_b32 v59, a7
    v_mul_f32 v52, v52, v49
    v_mul_f32 v53, v53, v49
    v_mul_f32 v54, v54, v49
    v_mul_f32 v55, v55, v49
    v_mul_f32 v56, v56, v49
    v_mul_f32 v57, v57, v49
    v_mul_f32 v58, v58, v49
    v_mul_f32 v59, v59, v49
    v_accvgpr_write_b32 a0, v52
    v_accvgpr_write_b32 a1, v53
    v_accvgpr_write_b32 a2, v54
    v_accvgpr_write_b32 a3, v55
    v_accvgpr_write_b32 a4, v56
    v_accvgpr_write_b32 a5, v57
    v_accvgpr_write_b32 a6, v58
    v_accvgpr_write_b32 a7, v59
    v_accvgpr_read_b32 v52, a8
    v_accvgpr_read_b32 v53, a9
    v_accvgpr_read_b32 v54, a10
    v_accvgpr_read_b32 v55, a11
    v_accvgpr_read_b32 v56, a12
    v_accvgpr_read_b32 v57, a13
    v_accvgpr_read_b32 v58, a14
    v_accvgpr_read_b32 v59, a15
    v_mul_f32 v52, v52, v49
    v_mul_f32 v53, v53, v49
    v_mul_f32 v54, v54, v49
    v_mul_f32 v55, v55, v49
    v_mul_f32 v56, v56, v49
    v_mul_f32 v57, v57, v49
    v_mul_f32 v58, v58, v49
    v_mul_f32 v59, v59, v49
    v_accvgpr_write_b32 a8, v52
    v_accvgpr_write_b32 a9, v53
    v_accvgpr_write_b32 a10, v54
    v_accvgpr_write_b32 a11, v55
    v_accvgpr_write_b32 a12, v56
    v_accvgpr_write_b32 a13, v57
    v_accvgpr_write_b32 a14, v58
    v_accvgpr_write_b32 a15, v59
    v_accvgpr_read_b32 v52, a16
    v_accvgpr_read_b32 v53, a17
    v_accvgpr_read_b32 v54, a18
    v_accvgpr_read_b32 v55, a19
    v_accvgpr_read_b32 v56, a20
    v_accvgpr_read_b32 v57, a21
    v_accvgpr_read_b32 v58, a22
    v_accvgpr_read_b32 v59, a23
    v_mul_f32 v52, v52, v49
    v_mul_f32 v53, v53, v49
    v_mul_f32 v54, v54, v49
    v_mul_f32 v55, v55, v49
    v_mul_f32 v56, v56, v49
    v_mul_f32 v57, v57, v49
    v_mul_f32 v58, v58, v49
    v_mul_f32 v59, v59, v49
    v_accvgpr_write_b32 a16, v52
    v_accvgpr_write_b32 a17, v53
    v_accvgpr_write_b32 a18, v54
    v_accvgpr_write_b32 a19, v55
    v_accvgpr_write_b32 a20, v56
    v_accvgpr_write_b32 a21, v57
    v_accvgpr_write_b32 a22, v58
    v_accvgpr_write_b32 a23, v59
    v_accvgpr_read_b32 v52, a24
    v_accvgpr_read_b32 v53, a25
    v_accvgpr_read_b32 v54, a26
    v_accvgpr_read_b32 v55, a27
    v_accvgpr_read_b32 v56, a28
    v_accvgpr_read_b32 v57, a29
    v_accvgpr_read_b32 v58, a30
    v_accvgpr_read_b32 v59, a31
    v_mul_f32 v52, v52, v49
    v_mul_f32 v53, v53, v49
    v_mul_f32 v54, v54, v49
    v_mul_f32 v55, v55, v49
    v_mul_f32 v56, v56, v49
    v_mul_f32 v57, v57, v49
    v_mul_f32 v58, v58, v49
    v_mul_f32 v59, v59, v49
    v_accvgpr_write_b32 a24, v52
    v_accvgpr_write_b32 a25, v53
    v_accvgpr_write_b32 a26, v54
    v_accvgpr_write_b32 a27, v55
    v_accvgpr_write_b32 a28, v56
    v_accvgpr_write_b32 a29, v57
    v_accvgpr_write_b32 a30, v58
    v_accvgpr_write_b32 a31, v59
    v_exp_f32 v52, v96
    v_exp_f32 v53, v97
    v_exp_f32 v54, v98
    v_exp_f32 v55, v99
    v_exp_f32 v56, v100
    v_exp_f32 v57, v101
    v_exp_f32 v58, v102
    v_exp_f32 v59, v103
    s_nop 0
    v_cvt_pk_bf16_f32 v144, v52, v53
    v_cvt_pk_bf16_f32 v145, v54, v55
    v_cvt_pk_bf16_f32 v146, v56, v57
    v_cvt_pk_bf16_f32 v147, v58, v59
    s_nop 1
    v_mfma_f32_16x16x32_bf16 v[28:31], v[44:47], v[144:147], 0
    v_max3_f32 v48, v104, v105, v106
    v_max3_f32 v48, v48, v107, v108
    v_max3_f32 v48, v48, v109, v110
    v_max3_f32 v48, v48, v111, 0
    v_mov_b32 v49, v48
    s_nop 1
    v_permlane32_swap_b32 v48, v49
    s_nop 1
    v_max_f32 v48, v48, v49
    v_mov_b32 v49, v48
    s_nop 1
    v_permlane16_swap_b32 v48, v49
    s_nop 1
    v_max_f32 v48, v48, v49
    v_exp_f32 v49, -v48
    v_sub_f32 v104, v104, v48
    v_sub_f32 v105, v105, v48
    v_sub_f32 v106, v106, v48
    v_sub_f32 v107, v107, v48
    v_sub_f32 v108, v108, v48
    v_sub_f32 v109, v109, v48
    v_sub_f32 v110, v110, v48
    v_sub_f32 v111, v111, v48
    v_sub_f32 v72, v72, v48
    v_sub_f32 v73, v73, v48
    v_sub_f32 v74, v74, v48
    v_sub_f32 v75, v75, v48
    v_sub_f32 v76, v76, v48
    v_sub_f32 v77, v77, v48
    v_sub_f32 v78, v78, v48
    v_sub_f32 v79, v79, v48
    v_sub_f32 v168, v168, v48
    v_sub_f32 v169, v169, v48
    v_sub_f32 v170, v170, v48
    v_sub_f32 v171, v171, v48
    v_sub_f32 v172, v172, v48
    v_sub_f32 v173, v173, v48
    v_sub_f32 v174, v174, v48
    v_sub_f32 v175, v175, v48
    v_mul_f32 v13, v13, v49
    v_accvgpr_read_b32 v52, a32
    v_accvgpr_read_b32 v53, a33
    v_accvgpr_read_b32 v54, a34
    v_accvgpr_read_b32 v55, a35
    v_accvgpr_read_b32 v56, a36
    v_accvgpr_read_b32 v57, a37
    v_accvgpr_read_b32 v58, a38
    v_accvgpr_read_b32 v59, a39
    v_mul_f32 v52, v52, v49
    v_mul_f32 v53, v53, v49
    v_mul_f32 v54, v54, v49
    v_mul_f32 v55, v55, v49
    v_mul_f32 v56, v56, v49
    v_mul_f32 v57, v57, v49
    v_mul_f32 v58, v58, v49
    v_mul_f32 v59, v59, v49
    v_accvgpr_write_b32 a32, v52
    v_accvgpr_write_b32 a33, v53
    v_accvgpr_write_b32 a34, v54
    v_accvgpr_write_b32 a35, v55
    v_accvgpr_write_b32 a36, v56
    v_accvgpr_write_b32 a37, v57
    v_accvgpr_write_b32 a38, v58
    v_accvgpr_write_b32 a39, v59
    v_accvgpr_read_b32 v52, a40
    v_accvgpr_read_b32 v53, a41
    v_accvgpr_read_b32 v54, a42
    v_accvgpr_read_b32 v55, a43
    v_accvgpr_read_b32 v56, a44
    v_accvgpr_read_b32 v57, a45
    v_accvgpr_read_b32 v58, a46
    v_accvgpr_read_b32 v59, a47
    v_mul_f32 v52, v52, v49
    v_mul_f32 v53, v53, v49
    v_mul_f32 v54, v54, v49
    v_mul_f32 v55, v55, v49
    v_mul_f32 v56, v56, v49
    v_mul_f32 v57, v57, v49
    v_mul_f32 v58, v58, v49
    v_mul_f32 v59, v59, v49
    v_accvgpr_write_b32 a40, v52
    v_accvgpr_write_b32 a41, v53
    v_accvgpr_write_b32 a42, v54
    v_accvgpr_write_b32 a43, v55
    v_accvgpr_write_b32 a44, v56
    v_accvgpr_write_b32 a45, v57
    v_accvgpr_write_b32 a46, v58
    v_accvgpr_write_b32 a47, v59
    v_accvgpr_read_b32 v52, a48
    v_accvgpr_read_b32 v53, a49
    v_accvgpr_read_b32 v54, a50
    v_accvgpr_read_b32 v55, a51
    v_accvgpr_read_b32 v56, a52
    v_accvgpr_read_b32 v57, a53
    v_accvgpr_read_b32 v58, a54
    v_accvgpr_read_b32 v59, a55
    v_mul_f32 v52, v52, v49
    v_mul_f32 v53, v53, v49
    v_mul_f32 v54, v54, v49
    v_mul_f32 v55, v55, v49
    v_mul_f32 v56, v56, v49
    v_mul_f32 v57, v57, v49
    v_mul_f32 v58, v58, v49
    v_mul_f32 v59, v59, v49
    v_accvgpr_write_b32 a48, v52
    v_accvgpr_write_b32 a49, v53
    v_accvgpr_write_b32 a50, v54
    v_accvgpr_write_b32 a51, v55
    v_accvgpr_write_b32 a52, v56
    v_accvgpr_write_b32 a53, v57
    v_accvgpr_write_b32 a54, v58
    v_accvgpr_write_b32 a55, v59
    v_accvgpr_read_b32 v52, a56
    v_accvgpr_read_b32 v53, a57
    v_accvgpr_read_b32 v54, a58
    v_accvgpr_read_b32 v55, a59
    v_accvgpr_read_b32 v56, a60
    v_accvgpr_read_b32 v57, a61
    v_accvgpr_read_b32 v58, a62
    v_accvgpr_read_b32 v59, a63
    v_mul_f32 v52, v52, v49
    v_mul_f32 v53, v53, v49
    v_mul_f32 v54, v54, v49
    v_mul_f32 v55, v55, v49
    v_mul_f32 v56, v56, v49
    v_mul_f32 v57, v57, v49
    v_mul_f32 v58, v58, v49
    v_mul_f32 v59, v59, v49
    v_accvgpr_write_b32 a56, v52
    v_accvgpr_write_b32 a57, v53
    v_accvgpr_write_b32 a58, v54
    v_accvgpr_write_b32 a59, v55
    v_accvgpr_write_b32 a60, v56
    v_accvgpr_write_b32 a61, v57
    v_accvgpr_write_b32 a62, v58
    v_accvgpr_write_b32 a63, v59
    v_exp_f32 v52, v104
    v_exp_f32 v53, v105
    v_exp_f32 v54, v106
    v_exp_f32 v55, v107
    v_exp_f32 v56, v108
    v_exp_f32 v57, v109
    v_exp_f32 v58, v110
    v_exp_f32 v59, v111
    s_nop 0
    v_cvt_pk_bf16_f32 v148, v52, v53
    v_cvt_pk_bf16_f32 v149, v54, v55
    v_cvt_pk_bf16_f32 v150, v56, v57
    v_cvt_pk_bf16_f32 v151, v58, v59
    s_nop 1
    v_mfma_f32_16x16x32_bf16 v[32:35], v[44:47], v[148:151], 0
    s_nop 7
    s_setpc_b64 s[74:75]
m_rs1468:
    s_nop 15
    v_max3_f32 v48, v96, v97, v98
    v_max3_f32 v48, v48, v99, v100
    v_max3_f32 v48, v48, v101, v102
    v_max3_f32 v48, v48, v103, 0
    v_mov_b32 v49, v48
    s_nop 1
    v_permlane32_swap_b32 v48, v49
    s_nop 1
    v_max_f32 v48, v48, v49
    v_mov_b32 v49, v48
    s_nop 1
    v_permlane16_swap_b32 v48, v49
    s_nop 1
    v_max_f32 v48, v48, v49
    v_exp_f32 v49, -v48
    v_sub_f32 v96, v96, v48
    v_sub_f32 v97, v97, v48
    v_sub_f32 v98, v98, v48
    v_sub_f32 v99, v99, v48
    v_sub_f32 v100, v100, v48
    v_sub_f32 v101, v101, v48
    v_sub_f32 v102, v102, v48
    v_sub_f32 v103, v103, v48
    v_sub_f32 v64, v64, v48
    v_sub_f32 v65, v65, v48
    v_sub_f32 v66, v66, v48
    v_sub_f32 v67, v67, v48
    v_sub_f32 v68, v68, v48
    v_sub_f32 v69, v69, v48
    v_sub_f32 v70, v70, v48
    v_sub_f32 v71, v71, v48
    v_sub_f32 v160, v160, v48
    v_sub_f32 v161, v161, v48
    v_sub_f32 v162, v162, v48
    v_sub_f32 v163, v163, v48
    v_sub_f32 v164, v164, v48
    v_sub_f32 v165, v165, v48
    v_sub_f32 v166, v166, v48
    v_sub_f32 v167, v167, v48
    v_mul_f32 v12, v12, v49
    v_accvgpr_read_b32 v52, a0
    v_accvgpr_read_b32 v53, a1
    v_accvgpr_read_b32 v54, a2
    v_accvgpr_read_b32 v55, a3
    v_accvgpr_read_b32 v56, a4
    v_accvgpr_read_b32 v57, a5
    v_accvgpr_read_b32 v58, a6
    v_accvgpr_read_b32 v59, a7
    v_mul_f32 v52, v52, v49
    v_mul_f32 v53, v53, v49
    v_mul_f32 v54, v54, v49
    v_mul_f32 v55, v55, v49
    v_mul_f32 v56, v56, v49
    v_mul_f32 v57, v57, v49
    v_mul_f32 v58, v58, v49
    v_mul_f32 v59, v59, v49
    v_accvgpr_write_b32 a0, v52
    v_accvgpr_write_b32 a1, v53
    v_accvgpr_write_b32 a2, v54
    v_accvgpr_write_b32 a3, v55
    v_accvgpr_write_b32 a4, v56
    v_accvgpr_write_b32 a5, v57
    v_accvgpr_write_b32 a6, v58
    v_accvgpr_write_b32 a7, v59
    v_accvgpr_read_b32 v52, a8
    v_accvgpr_read_b32 v53, a9
    v_accvgpr_read_b32 v54, a10
    v_accvgpr_read_b32 v55, a11
    v_accvgpr_read_b32 v56, a12
    v_accvgpr_read_b32 v57, a13
    v_accvgpr_read_b32 v58, a14
    v_accvgpr_read_b32 v59, a15
    v_mul_f32 v52, v52, v49
    v_mul_f32 v53, v53, v49
    v_mul_f32 v54, v54, v49
    v_mul_f32 v55, v55, v49
    v_mul_f32 v56, v56, v49
    v_mul_f32 v57, v57, v49
    v_mul_f32 v58, v58, v49
    v_mul_f32 v59, v59, v49
    v_accvgpr_write_b32 a8, v52
    v_accvgpr_write_b32 a9, v53
    v_accvgpr_write_b32 a10, v54
    v_accvgpr_write_b32 a11, v55
    v_accvgpr_write_b32 a12, v56
    v_accvgpr_write_b32 a13, v57
    v_accvgpr_write_b32 a14, v58
    v_accvgpr_write_b32 a15, v59
    v_accvgpr_read_b32 v52, a16
    v_accvgpr_read_b32 v53, a17
    v_accvgpr_read_b32 v54, a18
    v_accvgpr_read_b32 v55, a19
    v_accvgpr_read_b32 v56, a20
    v_accvgpr_read_b32 v57, a21
    v_accvgpr_read_b32 v58, a22
    v_accvgpr_read_b32 v59, a23
    v_mul_f32 v52, v52, v49
    v_mul_f32 v53, v53, v49
    v_mul_f32 v54, v54, v49
    v_mul_f32 v55, v55, v49
    v_mul_f32 v56, v56, v49
    v_mul_f32 v57, v57, v49
    v_mul_f32 v58, v58, v49
    v_mul_f32 v59, v59, v49
    v_accvgpr_write_b32 a16, v52
    v_accvgpr_write_b32 a17, v53
    v_accvgpr_write_b32 a18, v54
    v_accvgpr_write_b32 a19, v55
    v_accvgpr_write_b32 a20, v56
    v_accvgpr_write_b32 a21, v57
    v_accvgpr_write_b32 a22, v58
    v_accvgpr_write_b32 a23, v59
    v_accvgpr_read_b32 v52, a24
    v_accvgpr_read_b32 v53, a25
    v_accvgpr_read_b32 v54, a26
    v_accvgpr_read_b32 v55, a27
    v_accvgpr_read_b32 v56, a28
    v_accvgpr_read_b32 v57, a29
    v_accvgpr_read_b32 v58, a30
    v_accvgpr_read_b32 v59, a31
    v_mul_f32 v52, v52, v49
    v_mul_f32 v53, v53, v49
    v_mul_f32 v54, v54, v49
    v_mul_f32 v55, v55, v49
    v_mul_f32 v56, v56, v49
    v_mul_f32 v57, v57, v49
    v_mul_f32 v58, v58, v49
    v_mul_f32 v59, v59, v49
    v_accvgpr_write_b32 a24, v52
    v_accvgpr_write_b32 a25, v53
    v_accvgpr_write_b32 a26, v54
    v_accvgpr_write_b32 a27, v55
    v_accvgpr_write_b32 a28, v56
    v_accvgpr_write_b32 a29, v57
    v_accvgpr_write_b32 a30, v58
    v_accvgpr_write_b32 a31, v59
    v_exp_f32 v52, v96
    v_exp_f32 v53, v97
    v_exp_f32 v54, v98
    v_exp_f32 v55, v99
    v_exp_f32 v56, v100
    v_exp_f32 v57, v101
    v_exp_f32 v58, v102
    v_exp_f32 v59, v103
    s_nop 0
    v_cvt_pk_bf16_f32 v144, v52, v53
    v_cvt_pk_bf16_f32 v145, v54, v55
    v_cvt_pk_bf16_f32 v146, v56, v57
    v_cvt_pk_bf16_f32 v147, v58, v59
    s_nop 1
    v_mfma_f32_16x16x32_bf16 v[28:31], v[44:47], v[144:147], 0
    v_max3_f32 v48, v104, v105, v106
    v_max3_f32 v48, v48, v107, v108
    v_max3_f32 v48, v48, v109, v110
    v_max3_f32 v48, v48, v111, 0
    v_mov_b32 v49, v48
    s_nop 1
    v_permlane32_swap_b32 v48, v49
    s_nop 1
    v_max_f32 v48, v48, v49
    v_mov_b32 v49, v48
    s_nop 1
    v_permlane16_swap_b32 v48, v49
    s_nop 1
    v_max_f32 v48, v48, v49
    v_exp_f32 v49, -v48
    v_sub_f32 v104, v104, v48
    v_sub_f32 v105, v105, v48
    v_sub_f32 v106, v106, v48
    v_sub_f32 v107, v107, v48
    v_sub_f32 v108, v108, v48
    v_sub_f32 v109, v109, v48
    v_sub_f32 v110, v110, v48
    v_sub_f32 v111, v111, v48
    v_sub_f32 v72, v72, v48
    v_sub_f32 v73, v73, v48
    v_sub_f32 v74, v74, v48
    v_sub_f32 v75, v75, v48
    v_sub_f32 v76, v76, v48
    v_sub_f32 v77, v77, v48
    v_sub_f32 v78, v78, v48
    v_sub_f32 v79, v79, v48
    v_sub_f32 v168, v168, v48
    v_sub_f32 v169, v169, v48
    v_sub_f32 v170, v170, v48
    v_sub_f32 v171, v171, v48
    v_sub_f32 v172, v172, v48
    v_sub_f32 v173, v173, v48
    v_sub_f32 v174, v174, v48
    v_sub_f32 v175, v175, v48
    v_mul_f32 v13, v13, v49
    v_accvgpr_read_b32 v52, a32
    v_accvgpr_read_b32 v53, a33
    v_accvgpr_read_b32 v54, a34
    v_accvgpr_read_b32 v55, a35
    v_accvgpr_read_b32 v56, a36
    v_accvgpr_read_b32 v57, a37
    v_accvgpr_read_b32 v58, a38
    v_accvgpr_read_b32 v59, a39
    v_mul_f32 v52, v52, v49
    v_mul_f32 v53, v53, v49
    v_mul_f32 v54, v54, v49
    v_mul_f32 v55, v55, v49
    v_mul_f32 v56, v56, v49
    v_mul_f32 v57, v57, v49
    v_mul_f32 v58, v58, v49
    v_mul_f32 v59, v59, v49
    v_accvgpr_write_b32 a32, v52
    v_accvgpr_write_b32 a33, v53
    v_accvgpr_write_b32 a34, v54
    v_accvgpr_write_b32 a35, v55
    v_accvgpr_write_b32 a36, v56
    v_accvgpr_write_b32 a37, v57
    v_accvgpr_write_b32 a38, v58
    v_accvgpr_write_b32 a39, v59
    v_accvgpr_read_b32 v52, a40
    v_accvgpr_read_b32 v53, a41
    v_accvgpr_read_b32 v54, a42
    v_accvgpr_read_b32 v55, a43
    v_accvgpr_read_b32 v56, a44
    v_accvgpr_read_b32 v57, a45
    v_accvgpr_read_b32 v58, a46
    v_accvgpr_read_b32 v59, a47
    v_mul_f32 v52, v52, v49
    v_mul_f32 v53, v53, v49
    v_mul_f32 v54, v54, v49
    v_mul_f32 v55, v55, v49
    v_mul_f32 v56, v56, v49
    v_mul_f32 v57, v57, v49
    v_mul_f32 v58, v58, v49
    v_mul_f32 v59, v59, v49
    v_accvgpr_write_b32 a40, v52
    v_accvgpr_write_b32 a41, v53
    v_accvgpr_write_b32 a42, v54
    v_accvgpr_write_b32 a43, v55
    v_accvgpr_write_b32 a44, v56
    v_accvgpr_write_b32 a45, v57
    v_accvgpr_write_b32 a46, v58
    v_accvgpr_write_b32 a47, v59
    v_accvgpr_read_b32 v52, a48
    v_accvgpr_read_b32 v53, a49
    v_accvgpr_read_b32 v54, a50
    v_accvgpr_read_b32 v55, a51
    v_accvgpr_read_b32 v56, a52
    v_accvgpr_read_b32 v57, a53
    v_accvgpr_read_b32 v58, a54
    v_accvgpr_read_b32 v59, a55
    v_mul_f32 v52, v52, v49
    v_mul_f32 v53, v53, v49
    v_mul_f32 v54, v54, v49
    v_mul_f32 v55, v55, v49
    v_mul_f32 v56, v56, v49
    v_mul_f32 v57, v57, v49
    v_mul_f32 v58, v58, v49
    v_mul_f32 v59, v59, v49
    v_accvgpr_write_b32 a48, v52
    v_accvgpr_write_b32 a49, v53
    v_accvgpr_write_b32 a50, v54
    v_accvgpr_write_b32 a51, v55
    v_accvgpr_write_b32 a52, v56
    v_accvgpr_write_b32 a53, v57
    v_accvgpr_write_b32 a54, v58
    v_accvgpr_write_b32 a55, v59
    v_accvgpr_read_b32 v52, a56
    v_accvgpr_read_b32 v53, a57
    v_accvgpr_read_b32 v54, a58
    v_accvgpr_read_b32 v55, a59
    v_accvgpr_read_b32 v56, a60
    v_accvgpr_read_b32 v57, a61
    v_accvgpr_read_b32 v58, a62
    v_accvgpr_read_b32 v59, a63
    v_mul_f32 v52, v52, v49
    v_mul_f32 v53, v53, v49
    v_mul_f32 v54, v54, v49
    v_mul_f32 v55, v55, v49
    v_mul_f32 v56, v56, v49
    v_mul_f32 v57, v57, v49
    v_mul_f32 v58, v58, v49
    v_mul_f32 v59, v59, v49
    v_accvgpr_write_b32 a56, v52
    v_accvgpr_write_b32 a57, v53
    v_accvgpr_write_b32 a58, v54
    v_accvgpr_write_b32 a59, v55
    v_accvgpr_write_b32 a60, v56
    v_accvgpr_write_b32 a61, v57
    v_accvgpr_write_b32 a62, v58
    v_accvgpr_write_b32 a63, v59
    v_exp_f32 v52, v104
    v_exp_f32 v53, v105
    v_exp_f32 v54, v106
    v_exp_f32 v55, v107
    v_exp_f32 v56, v108
    v_exp_f32 v57, v109
    v_exp_f32 v58, v110
    v_exp_f32 v59, v111
    s_nop 0
    v_cvt_pk_bf16_f32 v148, v52, v53
    v_cvt_pk_bf16_f32 v149, v54, v55
    v_cvt_pk_bf16_f32 v150, v56, v57
    v_cvt_pk_bf16_f32 v151, v58, v59
    s_nop 1
    v_mfma_f32_16x16x32_bf16 v[32:35], v[44:47], v[148:151], 0
    v_max3_f32 v48, v112, v113, v114
    v_max3_f32 v48, v48, v115, v116
    v_max3_f32 v48, v48, v117, v118
    v_max3_f32 v48, v48, v119, 0
    v_mov_b32 v49, v48
    s_nop 1
    v_permlane32_swap_b32 v48, v49
    s_nop 1
    v_max_f32 v48, v48, v49
    v_mov_b32 v49, v48
    s_nop 1
    v_permlane16_swap_b32 v48, v49
    s_nop 1
    v_max_f32 v48, v48, v49
    v_exp_f32 v49, -v48
    v_sub_f32 v112, v112, v48
    v_sub_f32 v113, v113, v48
    v_sub_f32 v114, v114, v48
    v_sub_f32 v115, v115, v48
    v_sub_f32 v116, v116, v48
    v_sub_f32 v117, v117, v48
    v_sub_f32 v118, v118, v48
    v_sub_f32 v119, v119, v48
    v_sub_f32 v80, v80, v48
    v_sub_f32 v81, v81, v48
    v_sub_f32 v82, v82, v48
    v_sub_f32 v83, v83, v48
    v_sub_f32 v84, v84, v48
    v_sub_f32 v85, v85, v48
    v_sub_f32 v86, v86, v48
    v_sub_f32 v87, v87, v48
    v_sub_f32 v176, v176, v48
    v_sub_f32 v177, v177, v48
    v_sub_f32 v178, v178, v48
    v_sub_f32 v179, v179, v48
    v_sub_f32 v180, v180, v48
    v_sub_f32 v181, v181, v48
    v_sub_f32 v182, v182, v48
    v_sub_f32 v183, v183, v48
    v_mul_f32 v14, v14, v49
    v_accvgpr_read_b32 v52, a64
    v_accvgpr_read_b32 v53, a65
    v_accvgpr_read_b32 v54, a66
    v_accvgpr_read_b32 v55, a67
    v_accvgpr_read_b32 v56, a68
    v_accvgpr_read_b32 v57, a69
    v_accvgpr_read_b32 v58, a70
    v_accvgpr_read_b32 v59, a71
    v_mul_f32 v52, v52, v49
    v_mul_f32 v53, v53, v49
    v_mul_f32 v54, v54, v49
    v_mul_f32 v55, v55, v49
    v_mul_f32 v56, v56, v49
    v_mul_f32 v57, v57, v49
    v_mul_f32 v58, v58, v49
    v_mul_f32 v59, v59, v49
    v_accvgpr_write_b32 a64, v52
    v_accvgpr_write_b32 a65, v53
    v_accvgpr_write_b32 a66, v54
    v_accvgpr_write_b32 a67, v55
    v_accvgpr_write_b32 a68, v56
    v_accvgpr_write_b32 a69, v57
    v_accvgpr_write_b32 a70, v58
    v_accvgpr_write_b32 a71, v59
    v_accvgpr_read_b32 v52, a72
    v_accvgpr_read_b32 v53, a73
    v_accvgpr_read_b32 v54, a74
    v_accvgpr_read_b32 v55, a75
    v_accvgpr_read_b32 v56, a76
    v_accvgpr_read_b32 v57, a77
    v_accvgpr_read_b32 v58, a78
    v_accvgpr_read_b32 v59, a79
    v_mul_f32 v52, v52, v49
    v_mul_f32 v53, v53, v49
    v_mul_f32 v54, v54, v49
    v_mul_f32 v55, v55, v49
    v_mul_f32 v56, v56, v49
    v_mul_f32 v57, v57, v49
    v_mul_f32 v58, v58, v49
    v_mul_f32 v59, v59, v49
    v_accvgpr_write_b32 a72, v52
    v_accvgpr_write_b32 a73, v53
    v_accvgpr_write_b32 a74, v54
    v_accvgpr_write_b32 a75, v55
    v_accvgpr_write_b32 a76, v56
    v_accvgpr_write_b32 a77, v57
    v_accvgpr_write_b32 a78, v58
    v_accvgpr_write_b32 a79, v59
    v_accvgpr_read_b32 v52, a80
    v_accvgpr_read_b32 v53, a81
    v_accvgpr_read_b32 v54, a82
    v_accvgpr_read_b32 v55, a83
    v_accvgpr_read_b32 v56, a84
    v_accvgpr_read_b32 v57, a85
    v_accvgpr_read_b32 v58, a86
    v_accvgpr_read_b32 v59, a87
    v_mul_f32 v52, v52, v49
    v_mul_f32 v53, v53, v49
    v_mul_f32 v54, v54, v49
    v_mul_f32 v55, v55, v49
    v_mul_f32 v56, v56, v49
    v_mul_f32 v57, v57, v49
    v_mul_f32 v58, v58, v49
    v_mul_f32 v59, v59, v49
    v_accvgpr_write_b32 a80, v52
    v_accvgpr_write_b32 a81, v53
    v_accvgpr_write_b32 a82, v54
    v_accvgpr_write_b32 a83, v55
    v_accvgpr_write_b32 a84, v56
    v_accvgpr_write_b32 a85, v57
    v_accvgpr_write_b32 a86, v58
    v_accvgpr_write_b32 a87, v59
    v_accvgpr_read_b32 v52, a88
    v_accvgpr_read_b32 v53, a89
    v_accvgpr_read_b32 v54, a90
    v_accvgpr_read_b32 v55, a91
    v_accvgpr_read_b32 v56, a92
    v_accvgpr_read_b32 v57, a93
    v_accvgpr_read_b32 v58, a94
    v_accvgpr_read_b32 v59, a95
    v_mul_f32 v52, v52, v49
    v_mul_f32 v53, v53, v49
    v_mul_f32 v54, v54, v49
    v_mul_f32 v55, v55, v49
    v_mul_f32 v56, v56, v49
    v_mul_f32 v57, v57, v49
    v_mul_f32 v58, v58, v49
    v_mul_f32 v59, v59, v49
    v_accvgpr_write_b32 a88, v52
    v_accvgpr_write_b32 a89, v53
    v_accvgpr_write_b32 a90, v54
    v_accvgpr_write_b32 a91, v55
    v_accvgpr_write_b32 a92, v56
    v_accvgpr_write_b32 a93, v57
    v_accvgpr_write_b32 a94, v58
    v_accvgpr_write_b32 a95, v59
    v_exp_f32 v52, v112
    v_exp_f32 v53, v113
    v_exp_f32 v54, v114
    v_exp_f32 v55, v115
    v_exp_f32 v56, v116
    v_exp_f32 v57, v117
    v_exp_f32 v58, v118
    v_exp_f32 v59, v119
    s_nop 0
    v_cvt_pk_bf16_f32 v152, v52, v53
    v_cvt_pk_bf16_f32 v153, v54, v55
    v_cvt_pk_bf16_f32 v154, v56, v57
    v_cvt_pk_bf16_f32 v155, v58, v59
    s_nop 1
    v_mfma_f32_16x16x32_bf16 v[36:39], v[44:47], v[152:155], 0
    v_max3_f32 v48, v120, v121, v122
    v_max3_f32 v48, v48, v123, v124
    v_max3_f32 v48, v48, v125, v126
    v_max3_f32 v48, v48, v127, 0
    v_mov_b32 v49, v48
    s_nop 1
    v_permlane32_swap_b32 v48, v49
    s_nop 1
    v_max_f32 v48, v48, v49
    v_mov_b32 v49, v48
    s_nop 1
    v_permlane16_swap_b32 v48, v49
    s_nop 1
    v_max_f32 v48, v48, v49
    v_exp_f32 v49, -v48
    v_sub_f32 v120, v120, v48
    v_sub_f32 v121, v121, v48
    v_sub_f32 v122, v122, v48
    v_sub_f32 v123, v123, v48
    v_sub_f32 v124, v124, v48
    v_sub_f32 v125, v125, v48
    v_sub_f32 v126, v126, v48
    v_sub_f32 v127, v127, v48
    v_sub_f32 v88, v88, v48
    v_sub_f32 v89, v89, v48
    v_sub_f32 v90, v90, v48
    v_sub_f32 v91, v91, v48
    v_sub_f32 v92, v92, v48
    v_sub_f32 v93, v93, v48
    v_sub_f32 v94, v94, v48
    v_sub_f32 v95, v95, v48
    v_sub_f32 v184, v184, v48
    v_sub_f32 v185, v185, v48
    v_sub_f32 v186, v186, v48
    v_sub_f32 v187, v187, v48
    v_sub_f32 v188, v188, v48
    v_sub_f32 v189, v189, v48
    v_sub_f32 v190, v190, v48
    v_sub_f32 v191, v191, v48
    v_mul_f32 v15, v15, v49
    v_accvgpr_read_b32 v52, a96
    v_accvgpr_read_b32 v53, a97
    v_accvgpr_read_b32 v54, a98
    v_accvgpr_read_b32 v55, a99
    v_accvgpr_read_b32 v56, a100
    v_accvgpr_read_b32 v57, a101
    v_accvgpr_read_b32 v58, a102
    v_accvgpr_read_b32 v59, a103
    v_mul_f32 v52, v52, v49
    v_mul_f32 v53, v53, v49
    v_mul_f32 v54, v54, v49
    v_mul_f32 v55, v55, v49
    v_mul_f32 v56, v56, v49
    v_mul_f32 v57, v57, v49
    v_mul_f32 v58, v58, v49
    v_mul_f32 v59, v59, v49
    v_accvgpr_write_b32 a96, v52
    v_accvgpr_write_b32 a97, v53
    v_accvgpr_write_b32 a98, v54
    v_accvgpr_write_b32 a99, v55
    v_accvgpr_write_b32 a100, v56
    v_accvgpr_write_b32 a101, v57
    v_accvgpr_write_b32 a102, v58
    v_accvgpr_write_b32 a103, v59
    v_accvgpr_read_b32 v52, a104
    v_accvgpr_read_b32 v53, a105
    v_accvgpr_read_b32 v54, a106
    v_accvgpr_read_b32 v55, a107
    v_accvgpr_read_b32 v56, a108
    v_accvgpr_read_b32 v57, a109
    v_accvgpr_read_b32 v58, a110
    v_accvgpr_read_b32 v59, a111
    v_mul_f32 v52, v52, v49
    v_mul_f32 v53, v53, v49
    v_mul_f32 v54, v54, v49
    v_mul_f32 v55, v55, v49
    v_mul_f32 v56, v56, v49
    v_mul_f32 v57, v57, v49
    v_mul_f32 v58, v58, v49
    v_mul_f32 v59, v59, v49
    v_accvgpr_write_b32 a104, v52
    v_accvgpr_write_b32 a105, v53
    v_accvgpr_write_b32 a106, v54
    v_accvgpr_write_b32 a107, v55
    v_accvgpr_write_b32 a108, v56
    v_accvgpr_write_b32 a109, v57
    v_accvgpr_write_b32 a110, v58
    v_accvgpr_write_b32 a111, v59
    v_accvgpr_read_b32 v52, a112
    v_accvgpr_read_b32 v53, a113
    v_accvgpr_read_b32 v54, a114
    v_accvgpr_read_b32 v55, a115
    v_accvgpr_read_b32 v56, a116
    v_accvgpr_read_b32 v57, a117
    v_accvgpr_read_b32 v58, a118
    v_accvgpr_read_b32 v59, a119
    v_mul_f32 v52, v52, v49
    v_mul_f32 v53, v53, v49
    v_mul_f32 v54, v54, v49
    v_mul_f32 v55, v55, v49
    v_mul_f32 v56, v56, v49
    v_mul_f32 v57, v57, v49
    v_mul_f32 v58, v58, v49
    v_mul_f32 v59, v59, v49
    v_accvgpr_write_b32 a112, v52
    v_accvgpr_write_b32 a113, v53
    v_accvgpr_write_b32 a114, v54
    v_accvgpr_write_b32 a115, v55
    v_accvgpr_write_b32 a116, v56
    v_accvgpr_write_b32 a117, v57
    v_accvgpr_write_b32 a118, v58
    v_accvgpr_write_b32 a119, v59
    v_accvgpr_read_b32 v52, a120
    v_accvgpr_read_b32 v53, a121
    v_accvgpr_read_b32 v54, a122
    v_accvgpr_read_b32 v55, a123
    v_accvgpr_read_b32 v56, a124
    v_accvgpr_read_b32 v57, a125
    v_accvgpr_read_b32 v58, a126
    v_accvgpr_read_b32 v59, a127
    v_mul_f32 v52, v52, v49
    v_mul_f32 v53, v53, v49
    v_mul_f32 v54, v54, v49
    v_mul_f32 v55, v55, v49
    v_mul_f32 v56, v56, v49
    v_mul_f32 v57, v57, v49
    v_mul_f32 v58, v58, v49
    v_mul_f32 v59, v59, v49
    v_accvgpr_write_b32 a120, v52
    v_accvgpr_write_b32 a121, v53
    v_accvgpr_write_b32 a122, v54
    v_accvgpr_write_b32 a123, v55
    v_accvgpr_write_b32 a124, v56
    v_accvgpr_write_b32 a125, v57
    v_accvgpr_write_b32 a126, v58
    v_accvgpr_write_b32 a127, v59
    v_exp_f32 v52, v120
    v_exp_f32 v53, v121
    v_exp_f32 v54, v122
    v_exp_f32 v55, v123
    v_exp_f32 v56, v124
    v_exp_f32 v57, v125
    v_exp_f32 v58, v126
    v_exp_f32 v59, v127
    s_nop 0
    v_cvt_pk_bf16_f32 v156, v52, v53
    v_cvt_pk_bf16_f32 v157, v54, v55
    v_cvt_pk_bf16_f32 v158, v56, v57
    v_cvt_pk_bf16_f32 v159, v58, v59
    s_nop 1
    v_mfma_f32_16x16x32_bf16 v[40:43], v[44:47], v[156:159], 0
    s_nop 7
    s_setpc_b64 s[74:75]
m_hook17:
    s_cmp_lg_u32 s16, 0
    s_cbranch_scc1 m_np35
    v_mov_b32 v4, s4
    v_mov_b32 v5, s5
    s_add_u32 s90, s17, 117440512
    s_mov_b64 exec, 1
    buffer_store_dwordx2 v[4:5], off, s[8:11], s90 sc1
    s_mov_b64 exec, -1
m_np35:
    s_mov_b32 s17, -1
    s_branch m_hookr18
m_hook21:
    s_cmp_lg_u32 s16, 0
    s_cbranch_scc1 m_np36
    v_mov_b32 v4, s4
    v_mov_b32 v5, s5
    s_add_u32 s90, s17, 117440512
    s_mov_b64 exec, 1
    buffer_store_dwordx2 v[4:5], off, s[8:11], s90 sc1
    s_mov_b64 exec, -1
m_np36:
    s_mov_b32 s17, -1
    s_branch m_hookr22
m_dosw20:
    s_cmp_eq_u32 s94, 0
    s_cbranch_scc1 m_x37
    s_cmp_lg_u32 s65, 3
    s_cbranch_scc1 m_x43
    s_mov_b32 s42, s73
    s_lshl_b32 s90, s77, 4
    s_lshl_b32 s90, s90, s81
    s_mov_b32 s48, s79
    s_mul_i32 s91, s90, 1
    s_add_u32 s49, s91, s79
    s_sub_u32 s49, s49, 2048
    s_mul_i32 s91, s90, 2
    s_add_u32 s50, s91, s79
    s_mul_i32 s91, s90, 3
    s_add_u32 s51, s91, s79
    s_sub_u32 s51, s51, 2048
    s_lshl_b32 s90, s58, 7
    s_add_u32 s90, s90, s57
    s_lshl_b32 s91, s16, 6
    s_cmp_eq_u32 s81, 1
    s_cselect_b32 s90, s90, s91
    v_lshrrev_b32 v24, 3, v1
    v_lshlrev_b32 v24, s81, v24
    v_add_u32 v24, s90, v24
    v_mul_lo_u32 v24, v24, s77
    v_lshrrev_b32 v25, 4, v1
    v_and_b32 v26, 7, v1
    v_xor_b32 v25, v25, v26
    v_lshl_add_u32 v16, v25, 4, v24
    v_xor_b32 v25, 4, v25
    v_lshl_add_u32 v17, v25, 4, v24
    s_lshl_b32 s90, s77, 3
    s_lshl_b32 s90, s90, s81
    s_sub_u32 s90, s90, 1024
    v_add_u32 v17, s90, v17
    s_mov_b32 s40, s71
    s_mov_b32 s41, s72
    buffer_load_dwordx2 v[4:5], off, s[12:15], 0 sc1
    s_branch m_loop19
m_x43:
    s_mov_b32 s46, s76
    s_mov_b32 s52, s80
    s_lshl_b32 s90, s78, 2
    s_mul_i32 s91, s90, 1
    s_add_u32 s53, s91, s80
    s_sub_u32 s53, s53, 2048
    s_mul_i32 s91, s90, 2
    s_add_u32 s54, s91, s80
    s_mul_i32 s91, s90, 3
    s_add_u32 s55, s91, s80
    s_sub_u32 s55, s55, 2048
    s_lshl_b32 s56, s78, 6
    v_lshrrev_b32 v24, 5, v1
    s_lshl_b32 s90, s16, 4
    v_add_u32 v25, s90, v24
    v_mul_lo_u32 v25, v25, s78
    v_lshlrev_b32 v24, 1, v24
    v_and_b32 v26, 31, v1
    v_xor_b32 v24, v24, v26
    s_lshl_b32 s90, s78, 1
    s_sub_u32 s90, s90, 1024
    v_add_u32 v27, s90, v25
    v_xor_b32 v26, 0, v24
    v_lshl_add_u32 v18, v26, 4, v25
    v_xor_b32 v26, 4, v24
    v_lshl_add_u32 v19, v26, 4, v27
    v_xor_b32 v26, 8, v24
    v_lshl_add_u32 v20, v26, 4, v25
    v_xor_b32 v26, 12, v24
    v_lshl_add_u32 v21, v26, 4, v27
    s_mov_b32 s44, s74
    s_mov_b32 s45, s75
    s_mov_b32 s67, 0
    s_branch m_loop19
m_x37:
    s_cmp_le_u32 s65, 4
    s_cbranch_scc1 m_x38
    s_cmp_lg_u32 s16, 0
    s_cbranch_scc1 m_np44
    v_mov_b32 v4, s4
    v_mov_b32 v5, s5
    s_add_u32 s90, s17, 117440512
    s_mov_b64 exec, 1
    buffer_store_dwordx2 v[4:5], off, s[8:11], s90 sc1
    s_mov_b64 exec, -1
m_np44:
    s_mov_b32 s17, -1
    s_mov_b32 s67, 4
    s_branch m_loop19
m_x38:
    s_cmp_lg_u32 s65, 4
    s_cbranch_scc1 m_x39
    s_and_b32 s92, s2, 7
    s_lshl_b32 s92, s92, 2
    s_bfe_u32 s93, s2, 0x20003
    s_add_u32 s92, s92, s93
    s_lshr_b32 s93, s2, 5
    s_lshl_b32 s93, s93, 2
    s_or_b32 s93, s93, 0x40000
    s_lshr_b32 s90, s92, 1
    s_lshl_b32 s90, s90, 7
    s_add_u32 s90, s90, 117440512
    v_and_b32 v0, 3, v1
    v_min_u32 v0, 2, v0
    v_and_b32 v4, 4, v1
    v_add3_u32 v0, v0, v4, 8
    v_lshlrev_b32 v0, 3, v0
    buffer_load_dwordx2 v[4:5], v0, s[8:11], s90 offen sc1
    s_branch m_loop19
m_x39:
    s_waitcnt vmcnt(16)
    s_cmp_lg_u32 s65, 3
    s_cbranch_scc1 m_x40
    s_mov_b32 s3, 1048576
m_spin45:
    v_cmp_ne_u64 s[22:23], s[4:5], v[4:5]
    s_nop 3
    s_cmp_eq_u64 s[22:23], 0
    s_cbranch_scc1 m_ok46
    s_sub_u32 s3, s3, 1
    s_cbranch_scc1 m_ok46
    s_sleep 16
    s_and_b32 s92, s2, 7
    s_lshl_b32 s92, s92, 2
    s_bfe_u32 s93, s2, 0x20003
    s_add_u32 s92, s92, s93
    s_lshr_b32 s93, s2, 5
    s_lshl_b32 s93, s93, 2
    s_or_b32 s93, s93, 0x40000
    s_lshr_b32 s90, s92, 1
    s_lshl_b32 s90, s90, 7
    s_add_u32 s90, s90, 117440512
    v_and_b32 v0, 3, v1
    v_min_u32 v0, 2, v0
    v_and_b32 v4, 4, v1
    v_add3_u32 v0, v0, v4, 8
    v_lshlrev_b32 v0, 3, v0
    buffer_load_dwordx2 v[4:5], v0, s[8:11], s90 offen sc1
    s_waitcnt vmcnt(0)
    s_branch m_spin45
m_ok46:
    s_and_b32 s92, s2, 7
    s_lshl_b32 s92, s92, 2
    s_bfe_u32 s93, s2, 0x20003
    s_add_u32 s92, s92, s93
    s_lshr_b32 s93, s2, 5
    s_lshl_b32 s93, s93, 2
    s_or_b32 s93, s93, 0x40000
    s_lshl_b32 s90, s92, 19
    s_lshl_b32 s91, s58, 13
    s_add_u32 s90, s90, s91
    s_cmp_eq_u32 s57, 0
    s_mov_b32 s91, 33554432
    s_cselect_b32 s91, 16777216, s91
    s_mov_b32 s42, 0
    s_cselect_b32 s42, 268435456, s42
    s_add_u32 s48, s90, s91
    s_mov_b32 s49, s48
    s_add_u32 s50, s48, 4096
    s_mov_b32 s51, s50
    s_mov_b32 s40, s6
    s_mov_b32 s41, s7
    v_mov_b32 v16, v2
    v_mov_b32 v17, v2
    s_branch m_loop19
m_x40:
    s_cmp_lg_u32 s65, 2
    s_cbranch_scc1 m_x41
    s_and_b32 s92, s2, 7
    s_lshl_b32 s92, s92, 2
    s_bfe_u32 s93, s2, 0x20003
    s_add_u32 s92, s92, s93
    s_lshr_b32 s93, s2, 5
    s_lshl_b32 s93, s93, 2
    s_or_b32 s93, s93, 0x40000
    s_lshr_b32 s90, s92, 1
    s_lshl_b32 s90, s90, 7
    s_add_u32 s90, s90, 117440512
    s_bfe_u32 s91, 873473623, s93
    s_lshr_b32 s91, s91, 1
    v_mov_b32 v0, s91
    s_bfe_u32 s91, 4225681832, s93
    s_lshr_b32 s91, s91, 1
    v_writelane_b32 v0, s91, 8
    v_lshlrev_b32 v0, 3, v0
    buffer_load_dwordx2 v[4:5], v0, s[8:11], s90 offen sc1
    s_lshl_b32 s90, s92, 19
    s_lshl_b32 s91, s58, 13
    s_add_u32 s90, s90, s91
    s_cmp_eq_u32 s57, 0
    s_mov_b32 s91, 33554432
    s_cselect_b32 s91, 16793600, s91
    s_mov_b32 s42, 268435456
    s_cselect_b32 s42, 268435456, s42
    s_add_u32 s48, s90, s91
    s_mov_b32 s49, s48
    s_add_u32 s50, s48, 4096
    s_mov_b32 s51, s50
    s_mov_b32 s40, s6
    s_mov_b32 s41, s7
    s_lshl_b32 s90, s92, 19
    s_lshl_b32 s91, s58, 13
    s_add_u32 s90, s90, s91
    s_cmp_eq_u32 s57, 0
    s_mov_b32 s91, 33587200
    s_cselect_b32 s91, 16826368, s91
    s_mov_b32 s46, 268435456
    s_cselect_b32 s46, 268435456, s46
    s_add_u32 s52, s90, s91
    s_mov_b32 s53, s52
    s_add_u32 s54, s52, 4096
    s_mov_b32 s55, s54
    s_mov_b32 s44, s6
    s_mov_b32 s45, s7
    v_mov_b32 v18, v2
    v_mov_b32 v19, v2
    v_mov_b32 v20, v2
    v_mov_b32 v21, v2
    s_branch m_loop19
m_x41:
    s_mov_b32 s3, 1048576
m_spin47:
    v_cmp_ne_u64 s[22:23], s[4:5], v[4:5]
    s_nop 3
    s_cmp_eq_u64 s[22:23], 0
    s_cbranch_scc1 m_ok48
    s_sub_u32 s3, s3, 1
    s_cbranch_scc1 m_ok48
    s_sleep 16
    s_and_b32 s92, s2, 7
    s_lshl_b32 s92, s92, 2
    s_bfe_u32 s93, s2, 0x20003
    s_add_u32 s92, s92, s93
    s_lshr_b32 s93, s2, 5
    s_lshl_b32 s93, s93, 2
    s_or_b32 s93, s93, 0x40000
    s_lshr_b32 s90, s92, 1
    s_lshl_b32 s90, s90, 7
    s_add_u32 s90, s90, 117440512
    s_bfe_u32 s91, 873473623, s93
    s_lshr_b32 s91, s91, 1
    v_mov_b32 v0, s91
    s_bfe_u32 s91, 4225681832, s93
    s_lshr_b32 s91, s91, 1
    v_writelane_b32 v0, s91, 8
    v_lshlrev_b32 v0, 3, v0
    buffer_load_dwordx2 v[4:5], v0, s[8:11], s90 offen sc1
    s_waitcnt vmcnt(0)
    s_branch m_spin47
m_ok48:
    s_and_b32 s92, s2, 7
    s_lshl_b32 s92, s92, 2
    s_bfe_u32 s93, s2, 0x20003
    s_add_u32 s92, s92, s93
    s_lshr_b32 s93, s2, 5
    s_lshl_b32 s93, s93, 2
    s_or_b32 s93, s93, 0x40000
    s_bfe_u32 s90, 4225681832, s93
    s_lshl_b32 s90, s90, 3
    s_lshl_b32 s91, s16, 1
    s_add_u32 s90, s90, s91
    s_lshl_b32 s90, s90, 12
    s_lshl_b32 s91, s92, 19
    s_add_u32 s90, s90, s91
    s_add_u32 s90, s90, 0
    buffer_load_dwordx4 a[128:131], v2, s[8:11], s90 offen offset:0 sc1
    buffer_load_dwordx4 a[132:135], v2, s[8:11], s90 offen offset:1024 sc1
    buffer_load_dwordx4 a[136:139], v2, s[8:11], s90 offen offset:2048 sc1
    buffer_load_dwordx4 a[140:143], v2, s[8:11], s90 offen offset:3072 sc1
    s_bfe_u32 s90, 4225681832, s93
    s_lshl_b32 s90, s90, 3
    s_lshl_b32 s91, s16, 1
    s_add_u32 s90, s90, s91
    s_lshl_b32 s90, s90, 12
    s_lshl_b32 s91, s92, 19
    s_add_u32 s90, s90, s91
    s_add_u32 s90, s90, 4096
    buffer_load_dwordx4 a[144:147], v2, s[8:11], s90 offen offset:0 sc1
    buffer_load_dwordx4 a[148:151], v2, s[8:11], s90 offen offset:1024 sc1
    buffer_load_dwordx4 a[152:155], v2, s[8:11], s90 offen offset:2048 sc1
    buffer_load_dwordx4 a[156:159], v2, s[8:11], s90 offen offset:3072 sc1
    s_bfe_u32 s90, 873473623, s93
    s_lshl_b32 s90, s90, 3
    s_lshl_b32 s91, s16, 1
    s_add_u32 s90, s90, s91
    s_lshl_b32 s90, s90, 12
    s_lshl_b32 s91, s92, 19
    s_add_u32 s90, s90, s91
    s_add_u32 s90, s90, 0
    buffer_load_dwordx4 a[160:163], v2, s[8:11], s90 offen offset:0 sc1
    buffer_load_dwordx4 a[164:167], v2, s[8:11], s90 offen offset:1024 sc1
    buffer_load_dwordx4 a[168:171], v2, s[8:11], s90 offen offset:2048 sc1
    buffer_load_dwordx4 a[172:175], v2, s[8:11], s90 offen offset:3072 sc1
    s_bfe_u32 s90, 873473623, s93
    s_lshl_b32 s90, s90, 3
    s_lshl_b32 s91, s16, 1
    s_add_u32 s90, s90, s91
    s_lshl_b32 s90, s90, 12
    s_lshl_b32 s91, s92, 19
    s_add_u32 s90, s90, s91
    s_add_u32 s90, s90, 4096
    buffer_load_dwordx4 a[176:179], v2, s[8:11], s90 offen offset:0 sc1
    buffer_load_dwordx4 a[180:183], v2, s[8:11], s90 offen offset:1024 sc1
    buffer_load_dwordx4 a[184:187], v2, s[8:11], s90 offen offset:2048 sc1
    buffer_load_dwordx4 a[188:191], v2, s[8:11], s90 offen offset:3072 sc1
    s_lshl_b32 s90, s92, 19
    s_lshl_b32 s91, s58, 13
    s_add_u32 s90, s90, s91
    s_cmp_eq_u32 s57, 0
    s_mov_b32 s91, 33570816
    s_cselect_b32 s91, 16809984, s91
    s_mov_b32 s42, 268435456
    s_cselect_b32 s42, 268435456, s42
    s_add_u32 s48, s90, s91
    s_mov_b32 s49, s48
    s_add_u32 s50, s48, 4096
    s_mov_b32 s51, s50
    s_mov_b32 s40, s6
    s_mov_b32 s41, s7
    s_lshl_b32 s90, s92, 19
    s_lshl_b32 s91, s58, 13
    s_add_u32 s90, s90, s91
    s_cmp_eq_u32 s57, 0
    s_mov_b32 s91, 33603584
    s_cselect_b32 s91, 16842752, s91
    s_mov_b32 s46, 268435456
    s_cselect_b32 s46, 268435456, s46
    s_add_u32 s52, s90, s91
    s_mov_b32 s53, s52
    s_add_u32 s54, s52, 4096
    s_mov_b32 s55, s54
    s_mov_b32 s44, s6
    s_mov_b32 s45, s7
    s_branch m_loop19
m_dosw24:
    s_cmp_eq_u32 s94, 0
    s_cbranch_scc1 m_x49
    s_cmp_lg_u32 s65, 3
    s_cbranch_scc1 m_x55
    s_mov_b32 s42, s73
    s_lshl_b32 s90, s77, 4
    s_lshl_b32 s90, s90, s81
    s_mov_b32 s48, s79
    s_mul_i32 s91, s90, 1
    s_add_u32 s49, s91, s79
    s_sub_u32 s49, s49, 2048
    s_mul_i32 s91, s90, 2
    s_add_u32 s50, s91, s79
    s_mul_i32 s91, s90, 3
    s_add_u32 s51, s91, s79
    s_sub_u32 s51, s51, 2048
    s_lshl_b32 s90, s58, 7
    s_add_u32 s90, s90, s57
    s_lshl_b32 s91, s16, 6
    s_cmp_eq_u32 s81, 1
    s_cselect_b32 s90, s90, s91
    v_lshrrev_b32 v24, 3, v1
    v_lshlrev_b32 v24, s81, v24
    v_add_u32 v24, s90, v24
    v_mul_lo_u32 v24, v24, s77
    v_lshrrev_b32 v25, 4, v1
    v_and_b32 v26, 7, v1
    v_xor_b32 v25, v25, v26
    v_lshl_add_u32 v16, v25, 4, v24
    v_xor_b32 v25, 4, v25
    v_lshl_add_u32 v17, v25, 4, v24
    s_lshl_b32 s90, s77, 3
    s_lshl_b32 s90, s90, s81
    s_sub_u32 s90, s90, 1024
    v_add_u32 v17, s90, v17
    s_mov_b32 s40, s71
    s_mov_b32 s41, s72
    buffer_load_dwordx2 v[4:5], off, s[12:15], 0 sc1
    s_branch m_loop23
m_x55:
    s_mov_b32 s46, s76
    s_mov_b32 s52, s80
    s_lshl_b32 s90, s78, 2
    s_mul_i32 s91, s90, 1
    s_add_u32 s53, s91, s80
    s_sub_u32 s53, s53, 2048
    s_mul_i32 s91, s90, 2
    s_add_u32 s54, s91, s80
    s_mul_i32 s91, s90, 3
    s_add_u32 s55, s91, s80
    s_sub_u32 s55, s55, 2048
    s_lshl_b32 s56, s78, 6
    v_lshrrev_b32 v24, 5, v1
    s_lshl_b32 s90, s16, 4
    v_add_u32 v25, s90, v24
    v_mul_lo_u32 v25, v25, s78
    v_lshlrev_b32 v24, 1, v24
    v_and_b32 v26, 31, v1
    v_xor_b32 v24, v24, v26
    s_lshl_b32 s90, s78, 1
    s_sub_u32 s90, s90, 1024
    v_add_u32 v27, s90, v25
    v_xor_b32 v26, 0, v24
    v_lshl_add_u32 v18, v26, 4, v25
    v_xor_b32 v26, 4, v24
    v_lshl_add_u32 v19, v26, 4, v27
    v_xor_b32 v26, 8, v24
    v_lshl_add_u32 v20, v26, 4, v25
    v_xor_b32 v26, 12, v24
    v_lshl_add_u32 v21, v26, 4, v27
    s_mov_b32 s44, s74
    s_mov_b32 s45, s75
    s_mov_b32 s67, 0
    s_branch m_loop23
m_x49:
    s_cmp_le_u32 s65, 4
    s_cbranch_scc1 m_x50
    s_cmp_lg_u32 s16, 0
    s_cbranch_scc1 m_np56
    v_mov_b32 v4, s4
    v_mov_b32 v5, s5
    s_add_u32 s90, s17, 117440512
    s_mov_b64 exec, 1
    buffer_store_dwordx2 v[4:5], off, s[8:11], s90 sc1
    s_mov_b64 exec, -1
m_np56:
    s_mov_b32 s17, -1
    s_mov_b32 s67, 4
    s_branch m_loop23
m_x50:
    s_cmp_lg_u32 s65, 4
    s_cbranch_scc1 m_x51
    s_and_b32 s92, s2, 7
    s_lshl_b32 s92, s92, 2
    s_bfe_u32 s93, s2, 0x20003
    s_add_u32 s92, s92, s93
    s_lshr_b32 s93, s2, 5
    s_lshl_b32 s93, s93, 2
    s_or_b32 s93, s93, 0x40000
    s_lshr_b32 s90, s92, 1
    s_lshl_b32 s90, s90, 7
    s_add_u32 s90, s90, 117440512
    v_and_b32 v0, 3, v1
    v_min_u32 v0, 2, v0
    v_and_b32 v4, 4, v1
    v_add3_u32 v0, v0, v4, 8
    v_lshlrev_b32 v0, 3, v0
    buffer_load_dwordx2 v[4:5], v0, s[8:11], s90 offen sc1
    s_branch m_loop23
m_x51:
    s_waitcnt vmcnt(16)
    s_cmp_lg_u32 s65, 3
    s_cbranch_scc1 m_x52
    s_mov_b32 s3, 1048576
m_spin57:
    v_cmp_ne_u64 s[22:23], s[4:5], v[4:5]
    s_nop 3
    s_cmp_eq_u64 s[22:23], 0
    s_cbranch_scc1 m_ok58
    s_sub_u32 s3, s3, 1
    s_cbranch_scc1 m_ok58
    s_sleep 16
    s_and_b32 s92, s2, 7
    s_lshl_b32 s92, s92, 2
    s_bfe_u32 s93, s2, 0x20003
    s_add_u32 s92, s92, s93
    s_lshr_b32 s93, s2, 5
    s_lshl_b32 s93, s93, 2
    s_or_b32 s93, s93, 0x40000
    s_lshr_b32 s90, s92, 1
    s_lshl_b32 s90, s90, 7
    s_add_u32 s90, s90, 117440512
    v_and_b32 v0, 3, v1
    v_min_u32 v0, 2, v0
    v_and_b32 v4, 4, v1
    v_add3_u32 v0, v0, v4, 8
    v_lshlrev_b32 v0, 3, v0
    buffer_load_dwordx2 v[4:5], v0, s[8:11], s90 offen sc1
    s_waitcnt vmcnt(0)
    s_branch m_spin57
m_ok58:
    s_and_b32 s92, s2, 7
    s_lshl_b32 s92, s92, 2
    s_bfe_u32 s93, s2, 0x20003
    s_add_u32 s92, s92, s93
    s_lshr_b32 s93, s2, 5
    s_lshl_b32 s93, s93, 2
    s_or_b32 s93, s93, 0x40000
    s_lshl_b32 s90, s92, 19
    s_lshl_b32 s91, s58, 13
    s_add_u32 s90, s90, s91
    s_cmp_eq_u32 s57, 0
    s_mov_b32 s91, 33554432
    s_cselect_b32 s91, 16777216, s91
    s_mov_b32 s42, 0
    s_cselect_b32 s42, 268435456, s42
    s_add_u32 s48, s90, s91
    s_mov_b32 s49, s48
    s_add_u32 s50, s48, 4096
    s_mov_b32 s51, s50
    s_mov_b32 s40, s6
    s_mov_b32 s41, s7
    v_mov_b32 v16, v2
    v_mov_b32 v17, v2
    s_branch m_loop23
m_x52:
    s_cmp_lg_u32 s65, 2
    s_cbranch_scc1 m_x53
    s_and_b32 s92, s2, 7
    s_lshl_b32 s92, s92, 2
    s_bfe_u32 s93, s2, 0x20003
    s_add_u32 s92, s92, s93
    s_lshr_b32 s93, s2, 5
    s_lshl_b32 s93, s93, 2
    s_or_b32 s93, s93, 0x40000
    s_lshr_b32 s90, s92, 1
    s_lshl_b32 s90, s90, 7
    s_add_u32 s90, s90, 117440512
    s_bfe_u32 s91, 873473623, s93
    s_lshr_b32 s91, s91, 1
    v_mov_b32 v0, s91
    s_bfe_u32 s91, 4225681832, s93
    s_lshr_b32 s91, s91, 1
    v_writelane_b32 v0, s91, 8
    v_lshlrev_b32 v0, 3, v0
    buffer_load_dwordx2 v[4:5], v0, s[8:11], s90 offen sc1
    s_lshl_b32 s90, s92, 19
    s_lshl_b32 s91, s58, 13
    s_add_u32 s90, s90, s91
    s_cmp_eq_u32 s57, 0
    s_mov_b32 s91, 33554432
    s_cselect_b32 s91, 16793600, s91
    s_mov_b32 s42, 268435456
    s_cselect_b32 s42, 268435456, s42
    s_add_u32 s48, s90, s91
    s_mov_b32 s49, s48
    s_add_u32 s50, s48, 4096
    s_mov_b32 s51, s50
    s_mov_b32 s40, s6
    s_mov_b32 s41, s7
    s_lshl_b32 s90, s92, 19
    s_lshl_b32 s91, s58, 13
    s_add_u32 s90, s90, s91
    s_cmp_eq_u32 s57, 0
    s_mov_b32 s91, 33587200
    s_cselect_b32 s91, 16826368, s91
    s_mov_b32 s46, 268435456
    s_cselect_b32 s46, 268435456, s46
    s_add_u32 s52, s90, s91
    s_mov_b32 s53, s52
    s_add_u32 s54, s52, 4096
    s_mov_b32 s55, s54
    s_mov_b32 s44, s6
    s_mov_b32 s45, s7
    v_mov_b32 v18, v2
    v_mov_b32 v19, v2
    v_mov_b32 v20, v2
    v_mov_b32 v21, v2
    s_branch m_loop23
m_x53:
    s_mov_b32 s3, 1048576
m_spin59:
    v_cmp_ne_u64 s[22:23], s[4:5], v[4:5]
    s_nop 3
    s_cmp_eq_u64 s[22:23], 0
    s_cbranch_scc1 m_ok60
    s_sub_u32 s3, s3, 1
    s_cbranch_scc1 m_ok60
    s_sleep 16
    s_and_b32 s92, s2, 7
    s_lshl_b32 s92, s92, 2
    s_bfe_u32 s93, s2, 0x20003
    s_add_u32 s92, s92, s93
    s_lshr_b32 s93, s2, 5
    s_lshl_b32 s93, s93, 2
    s_or_b32 s93, s93, 0x40000
    s_lshr_b32 s90, s92, 1
    s_lshl_b32 s90, s90, 7
    s_add_u32 s90, s90, 117440512
    s_bfe_u32 s91, 873473623, s93
    s_lshr_b32 s91, s91, 1
    v_mov_b32 v0, s91
    s_bfe_u32 s91, 4225681832, s93
    s_lshr_b32 s91, s91, 1
    v_writelane_b32 v0, s91, 8
    v_lshlrev_b32 v0, 3, v0
    buffer_load_dwordx2 v[4:5], v0, s[8:11], s90 offen sc1
    s_waitcnt vmcnt(0)
    s_branch m_spin59
m_ok60:
    s_and_b32 s92, s2, 7
    s_lshl_b32 s92, s92, 2
    s_bfe_u32 s93, s2, 0x20003
    s_add_u32 s92, s92, s93
    s_lshr_b32 s93, s2, 5
    s_lshl_b32 s93, s93, 2
    s_or_b32 s93, s93, 0x40000
    s_bfe_u32 s90, 4225681832, s93
    s_lshl_b32 s90, s90, 3
    s_lshl_b32 s91, s16, 1
    s_add_u32 s90, s90, s91
    s_lshl_b32 s90, s90, 12
    s_lshl_b32 s91, s92, 19
    s_add_u32 s90, s90, s91
    s_add_u32 s90, s90, 0
    buffer_load_dwordx4 a[128:131], v2, s[8:11], s90 offen offset:0 sc1
    buffer_load_dwordx4 a[132:135], v2, s[8:11], s90 offen offset:1024 sc1
    buffer_load_dwordx4 a[136:139], v2, s[8:11], s90 offen offset:2048 sc1
    buffer_load_dwordx4 a[140:143], v2, s[8:11], s90 offen offset:3072 sc1
    s_bfe_u32 s90, 4225681832, s93
    s_lshl_b32 s90, s90, 3
    s_lshl_b32 s91, s16, 1
    s_add_u32 s90, s90, s91
    s_lshl_b32 s90, s90, 12
    s_lshl_b32 s91, s92, 19
    s_add_u32 s90, s90, s91
    s_add_u32 s90, s90, 4096
    buffer_load_dwordx4 a[144:147], v2, s[8:11], s90 offen offset:0 sc1
    buffer_load_dwordx4 a[148:151], v2, s[8:11], s90 offen offset:1024 sc1
    buffer_load_dwordx4 a[152:155], v2, s[8:11], s90 offen offset:2048 sc1
    buffer_load_dwordx4 a[156:159], v2, s[8:11], s90 offen offset:3072 sc1
    s_bfe_u32 s90, 873473623, s93
    s_lshl_b32 s90, s90, 3
    s_lshl_b32 s91, s16, 1
    s_add_u32 s90, s90, s91
    s_lshl_b32 s90, s90, 12
    s_lshl_b32 s91, s92, 19
    s_add_u32 s90, s90, s91
    s_add_u32 s90, s90, 0
    buffer_load_dwordx4 a[160:163], v2, s[8:11], s90 offen offset:0 sc1
    buffer_load_dwordx4 a[164:167], v2, s[8:11], s90 offen offset:1024 sc1
    buffer_load_dwordx4 a[168:171], v2, s[8:11], s90 offen offset:2048 sc1
    buffer_load_dwordx4 a[172:175], v2, s[8:11], s90 offen offset:3072 sc1
    s_bfe_u32 s90, 873473623, s93
    s_lshl_b32 s90, s90, 3
    s_lshl_b32 s91, s16, 1
    s_add_u32 s90, s90, s91
    s_lshl_b32 s90, s90, 12
    s_lshl_b32 s91, s92, 19
    s_add_u32 s90, s90, s91
    s_add_u32 s90, s90, 4096
    buffer_load_dwordx4 a[176:179], v2, s[8:11], s90 offen offset:0 sc1
    buffer_load_dwordx4 a[180:183], v2, s[8:11], s90 offen offset:1024 sc1
    buffer_load_dwordx4 a[184:187], v2, s[8:11], s90 offen offset:2048 sc1
    buffer_load_dwordx4 a[188:191], v2, s[8:11], s90 offen offset:3072 sc1
    s_lshl_b32 s90, s92, 19
    s_lshl_b32 s91, s58, 13
    s_add_u32 s90, s90, s91
    s_cmp_eq_u32 s57, 0
    s_mov_b32 s91, 33570816
    s_cselect_b32 s91, 16809984, s91
    s_mov_b32 s42, 268435456
    s_cselect_b32 s42, 268435456, s42
    s_add_u32 s48, s90, s91
    s_mov_b32 s49, s48
    s_add_u32 s50, s48, 4096
    s_mov_b32 s51, s50
    s_mov_b32 s40, s6
    s_mov_b32 s41, s7
    s_lshl_b32 s90, s92, 19
    s_lshl_b32 s91, s58, 13
    s_add_u32 s90, s90, s91
    s_cmp_eq_u32 s57, 0
    s_mov_b32 s91, 33603584
    s_cselect_b32 s91, 16842752, s91
    s_mov_b32 s46, 268435456
    s_cselect_b32 s46, 268435456, s46
    s_add_u32 s52, s90, s91
    s_mov_b32 s53, s52
    s_add_u32 s54, s52, 4096
    s_mov_b32 s55, s54
    s_mov_b32 s44, s6
    s_mov_b32 s45, s7
    s_branch m_loop23
m_eps26:
    s_nop 3
    s_mov_b32 s90, s98
    v_cvt_pk_bf16_f32 v32, v32, v33
    v_cvt_pk_bf16_f32 v33, v34, v35
    v_cvt_pk_bf16_f32 v34, v36, v37
    v_cvt_pk_bf16_f32 v35, v38, v39
    buffer_store_dwordx4 v[32:35], v2, s[8:11], s90 offen sc1
    s_add_u32 s90, s90, s100
    v_cvt_pk_bf16_f32 v40, v40, v41
    v_cvt_pk_bf16_f32 v41, v42, v43
    v_cvt_pk_bf16_f32 v42, v44, v45
    v_cvt_pk_bf16_f32 v43, v46, v47
    buffer_store_dwordx4 v[40:43], v2, s[8:11], s90 offen sc1
    s_add_u32 s90, s90, s100
    v_cvt_pk_bf16_f32 v48, v48, v49
    v_cvt_pk_bf16_f32 v49, v50, v51
    v_cvt_pk_bf16_f32 v50, v52, v53
    v_cvt_pk_bf16_f32 v51, v54, v55
    buffer_store_dwordx4 v[48:51], v2, s[8:11], s90 offen sc1
    s_add_u32 s90, s90, s100
    v_cvt_pk_bf16_f32 v56, v56, v57
    v_cvt_pk_bf16_f32 v57, v58, v59
    v_cvt_pk_bf16_f32 v58, v60, v61
    v_cvt_pk_bf16_f32 v59, v62, v63
    buffer_store_dwordx4 v[56:59], v2, s[8:11], s90 offen sc1
    s_add_u32 s90, s90, s100
    v_cvt_pk_bf16_f32 v64, v64, v65
    v_cvt_pk_bf16_f32 v65, v66, v67
    v_cvt_pk_bf16_f32 v66, v68, v69
    v_cvt_pk_bf16_f32 v67, v70, v71
    buffer_store_dwordx4 v[64:67], v2, s[8:11], s90 offen sc1
    s_add_u32 s90, s90, s100
    v_cvt_pk_bf16_f32 v72, v72, v73
    v_cvt_pk_bf16_f32 v73, v74, v75
    v_cvt_pk_bf16_f32 v74, v76, v77
    v_cvt_pk_bf16_f32 v75, v78, v79
    buffer_store_dwordx4 v[72:75], v2, s[8:11], s90 offen sc1
    s_add_u32 s90, s90, s100
    v_cvt_pk_bf16_f32 v80, v80, v81
    v_cvt_pk_bf16_f32 v81, v82, v83
    v_cvt_pk_bf16_f32 v82, v84, v85
    v_cvt_pk_bf16_f32 v83, v86, v87
    buffer_store_dwordx4 v[80:83], v2, s[8:11], s90 offen sc1
    s_add_u32 s90, s90, s100
    v_cvt_pk_bf16_f32 v88, v88, v89
    v_cvt_pk_bf16_f32 v89, v90, v91
    v_cvt_pk_bf16_f32 v90, v92, v93
    v_cvt_pk_bf16_f32 v91, v94, v95
    buffer_store_dwordx4 v[88:91], v2, s[8:11], s90 offen sc1
    s_add_u32 s90, s90, s100
    v_cvt_pk_bf16_f32 v96, v96, v97
    v_cvt_pk_bf16_f32 v97, v98, v99
    v_cvt_pk_bf16_f32 v98, v100, v101
    v_cvt_pk_bf16_f32 v99, v102, v103
    v_accvgpr_write_b32 a128, v96
    v_accvgpr_write_b32 a129, v97
    v_accvgpr_write_b32 a130, v98
    v_accvgpr_write_b32 a131, v99
    v_cvt_pk_bf16_f32 v104, v104, v105
    v_cvt_pk_bf16_f32 v105, v106, v107
    v_cvt_pk_bf16_f32 v106, v108, v109
    v_cvt_pk_bf16_f32 v107, v110, v111
    v_accvgpr_write_b32 a132, v104
    v_accvgpr_write_b32 a133, v105
    v_accvgpr_write_b32 a134, v106
    v_accvgpr_write_b32 a135, v107
    v_cvt_pk_bf16_f32 v112, v112, v113
    v_cvt_pk_bf16_f32 v113, v114, v115
    v_cvt_pk_bf16_f32 v114, v116, v117
    v_cvt_pk_bf16_f32 v115, v118, v119
    v_accvgpr_write_b32 a136, v112
    v_accvgpr_write_b32 a137, v113
    v_accvgpr_write_b32 a138, v114
    v_accvgpr_write_b32 a139, v115
    v_cvt_pk_bf16_f32 v120, v120, v121
    v_cvt_pk_bf16_f32 v121, v122, v123
    v_cvt_pk_bf16_f32 v122, v124, v125
    v_cvt_pk_bf16_f32 v123, v126, v127
    v_accvgpr_write_b32 a140, v120
    v_accvgpr_write_b32 a141, v121
    v_accvgpr_write_b32 a142, v122
    v_accvgpr_write_b32 a143, v123
    v_cvt_pk_bf16_f32 v128, v128, v129
    v_cvt_pk_bf16_f32 v129, v130, v131
    v_cvt_pk_bf16_f32 v130, v132, v133
    v_cvt_pk_bf16_f32 v131, v134, v135
    v_accvgpr_write_b32 a144, v128
    v_accvgpr_write_b32 a145, v129
    v_accvgpr_write_b32 a146, v130
    v_accvgpr_write_b32 a147, v131
    v_cvt_pk_bf16_f32 v136, v136, v137
    v_cvt_pk_bf16_f32 v137, v138, v139
    v_cvt_pk_bf16_f32 v138, v140, v141
    v_cvt_pk_bf16_f32 v139, v142, v143
    v_accvgpr_write_b32 a148, v136
    v_accvgpr_write_b32 a149, v137
    v_accvgpr_write_b32 a150, v138
    v_accvgpr_write_b32 a151, v139
    v_cvt_pk_bf16_f32 v144, v144, v145
    v_cvt_pk_bf16_f32 v145, v146, v147
    v_cvt_pk_bf16_f32 v146, v148, v149
    v_cvt_pk_bf16_f32 v147, v150, v151
    v_accvgpr_write_b32 a152, v144
    v_accvgpr_write_b32 a153, v145
    v_accvgpr_write_b32 a154, v146
    v_accvgpr_write_b32 a155, v147
    v_cvt_pk_bf16_f32 v152, v152, v153
    v_cvt_pk_bf16_f32 v153, v154, v155
    v_cvt_pk_bf16_f32 v154, v156, v157
    v_cvt_pk_bf16_f32 v155, v158, v159
    v_accvgpr_write_b32 a156, v152
    v_accvgpr_write_b32 a157, v153
    v_accvgpr_write_b32 a158, v154
    v_accvgpr_write_b32 a159, v155
    v_cvt_pk_bf16_f32 v160, v160, v161
    v_cvt_pk_bf16_f32 v161, v162, v163
    v_cvt_pk_bf16_f32 v162, v164, v165
    v_cvt_pk_bf16_f32 v163, v166, v167
    v_accvgpr_write_b32 a160, v160
    v_accvgpr_write_b32 a161, v161
    v_accvgpr_write_b32 a162, v162
    v_accvgpr_write_b32 a163, v163
    v_cvt_pk_bf16_f32 v168, v168, v169
    v_cvt_pk_bf16_f32 v169, v170, v171
    v_cvt_pk_bf16_f32 v170, v172, v173
    v_cvt_pk_bf16_f32 v171, v174, v175
    v_accvgpr_write_b32 a164, v168
    v_accvgpr_write_b32 a165, v169
    v_accvgpr_write_b32 a166, v170
    v_accvgpr_write_b32 a167, v171
    v_cvt_pk_bf16_f32 v176, v176, v177
    v_cvt_pk_bf16_f32 v177, v178, v179
    v_cvt_pk_bf16_f32 v178, v180, v181
    v_cvt_pk_bf16_f32 v179, v182, v183
    v_accvgpr_write_b32 a168, v176
    v_accvgpr_write_b32 a169, v177
    v_accvgpr_write_b32 a170, v178
    v_accvgpr_write_b32 a171, v179
    v_cvt_pk_bf16_f32 v184, v184, v185
    v_cvt_pk_bf16_f32 v185, v186, v187
    v_cvt_pk_bf16_f32 v186, v188, v189
    v_cvt_pk_bf16_f32 v187, v190, v191
    v_accvgpr_write_b32 a172, v184
    v_accvgpr_write_b32 a173, v185
    v_accvgpr_write_b32 a174, v186
    v_accvgpr_write_b32 a175, v187
    v_cvt_pk_bf16_f32 v192, v192, v193
    v_cvt_pk_bf16_f32 v193, v194, v195
    v_cvt_pk_bf16_f32 v194, v196, v197
    v_cvt_pk_bf16_f32 v195, v198, v199
    v_accvgpr_write_b32 a176, v192
    v_accvgpr_write_b32 a177, v193
    v_accvgpr_write_b32 a178, v194
    v_accvgpr_write_b32 a179, v195
    v_cvt_pk_bf16_f32 v200, v200, v201
    v_cvt_pk_bf16_f32 v201, v202, v203
    v_cvt_pk_bf16_f32 v202, v204, v205
    v_cvt_pk_bf16_f32 v203, v206, v207
    v_accvgpr_write_b32 a180, v200
    v_accvgpr_write_b32 a181, v201
    v_accvgpr_write_b32 a182, v202
    v_accvgpr_write_b32 a183, v203
    v_cvt_pk_bf16_f32 v208, v208, v209
    v_cvt_pk_bf16_f32 v209, v210, v211
    v_cvt_pk_bf16_f32 v210, v212, v213
    v_cvt_pk_bf16_f32 v211, v214, v215
    v_accvgpr_write_b32 a184, v208
    v_accvgpr_write_b32 a185, v209
    v_accvgpr_write_b32 a186, v210
    v_accvgpr_write_b32 a187, v211
    v_cvt_pk_bf16_f32 v216, v216, v217
    v_cvt_pk_bf16_f32 v217, v218, v219
    v_cvt_pk_bf16_f32 v218, v220, v221
    v_cvt_pk_bf16_f32 v219, v222, v223
    v_accvgpr_write_b32 a188, v216
    v_accvgpr_write_b32 a189, v217
    v_accvgpr_write_b32 a190, v218
    v_accvgpr_write_b32 a191, v219
    v_cvt_pk_bf16_f32 v224, v224, v225
    v_cvt_pk_bf16_f32 v225, v226, v227
    v_cvt_pk_bf16_f32 v226, v228, v229
    v_cvt_pk_bf16_f32 v227, v230, v231
    v_accvgpr_write_b32 a192, v224
    v_accvgpr_write_b32 a193, v225
    v_accvgpr_write_b32 a194, v226
    v_accvgpr_write_b32 a195, v227
    v_cvt_pk_bf16_f32 v232, v232, v233
    v_cvt_pk_bf16_f32 v233, v234, v235
    v_cvt_pk_bf16_f32 v234, v236, v237
    v_cvt_pk_bf16_f32 v235, v238, v239
    v_accvgpr_write_b32 a196, v232
    v_accvgpr_write_b32 a197, v233
    v_accvgpr_write_b32 a198, v234
    v_accvgpr_write_b32 a199, v235
    v_cvt_pk_bf16_f32 v240, v240, v241
    v_cvt_pk_bf16_f32 v241, v242, v243
    v_cvt_pk_bf16_f32 v242, v244, v245
    v_cvt_pk_bf16_f32 v243, v246, v247
    v_accvgpr_write_b32 a200, v240
    v_accvgpr_write_b32 a201, v241
    v_accvgpr_write_b32 a202, v242
    v_accvgpr_write_b32 a203, v243
    v_cvt_pk_bf16_f32 v248, v248, v249
    v_cvt_pk_bf16_f32 v249, v250, v251
    v_cvt_pk_bf16_f32 v250, v252, v253
    v_cvt_pk_bf16_f32 v251, v254, v255
    v_accvgpr_write_b32 a204, v248
    v_accvgpr_write_b32 a205, v249
    v_accvgpr_write_b32 a206, v250
    v_accvgpr_write_b32 a207, v251
    v_accvgpr_read_b32 v24, a224
    v_accvgpr_read_b32 v25, a225
    v_accvgpr_read_b32 v26, a226
    v_accvgpr_read_b32 v27, a227
    v_accvgpr_read_b32 v28, a228
    v_accvgpr_read_b32 v29, a229
    v_accvgpr_read_b32 v30, a230
    v_accvgpr_read_b32 v31, a231
    v_cvt_pk_bf16_f32 v24, v24, v25
    v_cvt_pk_bf16_f32 v25, v26, v27
    v_cvt_pk_bf16_f32 v26, v28, v29
    v_cvt_pk_bf16_f32 v27, v30, v31
    v_accvgpr_write_b32 a208, v24
    v_accvgpr_write_b32 a209, v25
    v_accvgpr_write_b32 a210, v26
    v_accvgpr_write_b32 a211, v27
    v_accvgpr_read_b32 v24, a232
    v_accvgpr_read_b32 v25, a233
    v_accvgpr_read_b32 v26, a234
    v_accvgpr_read_b32 v27, a235
    v_accvgpr_read_b32 v28, a236
    v_accvgpr_read_b32 v29, a237
    v_accvgpr_read_b32 v30, a238
    v_accvgpr_read_b32 v31, a239
    v_cvt_pk_bf16_f32 v24, v24, v25
    v_cvt_pk_bf16_f32 v25, v26, v27
    v_cvt_pk_bf16_f32 v26, v28, v29
    v_cvt_pk_bf16_f32 v27, v30, v31
    v_accvgpr_write_b32 a212, v24
    v_accvgpr_write_b32 a213, v25
    v_accvgpr_write_b32 a214, v26
    v_accvgpr_write_b32 a215, v27
    v_accvgpr_read_b32 v24, a240
    v_accvgpr_read_b32 v25, a241
    v_accvgpr_read_b32 v26, a242
    v_accvgpr_read_b32 v27, a243
    v_accvgpr_read_b32 v28, a244
    v_accvgpr_read_b32 v29, a245
    v_accvgpr_read_b32 v30, a246
    v_accvgpr_read_b32 v31, a247
    v_cvt_pk_bf16_f32 v24, v24, v25
    v_cvt_pk_bf16_f32 v25, v26, v27
    v_cvt_pk_bf16_f32 v26, v28, v29
    v_cvt_pk_bf16_f32 v27, v30, v31
    v_accvgpr_write_b32 a216, v24
    v_accvgpr_write_b32 a217, v25
    v_accvgpr_write_b32 a218, v26
    v_accvgpr_write_b32 a219, v27
    v_accvgpr_read_b32 v24, a248
    v_accvgpr_read_b32 v25, a249
    v_accvgpr_read_b32 v26, a250
    v_accvgpr_read_b32 v27, a251
    v_accvgpr_read_b32 v28, a252
    v_accvgpr_read_b32 v29, a253
    v_accvgpr_read_b32 v30, a254
    v_accvgpr_read_b32 v31, a255
    v_cvt_pk_bf16_f32 v24, v24, v25
    v_cvt_pk_bf16_f32 v25, v26, v27
    v_cvt_pk_bf16_f32 v26, v28, v29
    v_cvt_pk_bf16_f32 v27, v30, v31
    v_accvgpr_write_b32 a220, v24
    v_accvgpr_write_b32 a221, v25
    v_accvgpr_write_b32 a222, v26
    v_accvgpr_write_b32 a223, v27
    s_setpc_b64 s[20:21]
m_epf25:
    s_nop 7
    s_mov_b32 s91, s98
    s_mov_b32 s92, s97
    s_mov_b32 s93, s97
    s_mov_b32 s90, s91
    v_pk_mul_f32 v[32:33], v[32:33], s[92:93]
    v_pk_mul_f32 v[34:35], v[34:35], s[92:93]
    v_pk_mul_f32 v[36:37], v[36:37], s[92:93]
    v_pk_mul_f32 v[38:39], v[38:39], s[92:93]
    v_cvt_pk_bf16_f32 v32, v32, v33
    v_cvt_pk_bf16_f32 v33, v34, v35
    v_cvt_pk_bf16_f32 v34, v36, v37
    v_cvt_pk_bf16_f32 v35, v38, v39
    buffer_store_dwordx4 v[32:35], v2, s[8:11], s90 offen sc1
    s_add_u32 s90, s90, s100
    v_pk_mul_f32 v[40:41], v[40:41], s[92:93]
    v_pk_mul_f32 v[42:43], v[42:43], s[92:93]
    v_pk_mul_f32 v[44:45], v[44:45], s[92:93]
    v_pk_mul_f32 v[46:47], v[46:47], s[92:93]
    v_cvt_pk_bf16_f32 v40, v40, v41
    v_cvt_pk_bf16_f32 v41, v42, v43
    v_cvt_pk_bf16_f32 v42, v44, v45
    v_cvt_pk_bf16_f32 v43, v46, v47
    buffer_store_dwordx4 v[40:43], v2, s[8:11], s90 offen sc1
    s_add_u32 s90, s90, s100
    v_pk_mul_f32 v[48:49], v[48:49], s[92:93]
    v_pk_mul_f32 v[50:51], v[50:51], s[92:93]
    v_pk_mul_f32 v[52:53], v[52:53], s[92:93]
    v_pk_mul_f32 v[54:55], v[54:55], s[92:93]
    v_cvt_pk_bf16_f32 v48, v48, v49
    v_cvt_pk_bf16_f32 v49, v50, v51
    v_cvt_pk_bf16_f32 v50, v52, v53
    v_cvt_pk_bf16_f32 v51, v54, v55
    buffer_store_dwordx4 v[48:51], v2, s[8:11], s90 offen sc1
    s_add_u32 s90, s90, s100
    v_pk_mul_f32 v[56:57], v[56:57], s[92:93]
    v_pk_mul_f32 v[58:59], v[58:59], s[92:93]
    v_pk_mul_f32 v[60:61], v[60:61], s[92:93]
    v_pk_mul_f32 v[62:63], v[62:63], s[92:93]
    v_cvt_pk_bf16_f32 v56, v56, v57
    v_cvt_pk_bf16_f32 v57, v58, v59
    v_cvt_pk_bf16_f32 v58, v60, v61
    v_cvt_pk_bf16_f32 v59, v62, v63
    buffer_store_dwordx4 v[56:59], v2, s[8:11], s90 offen sc1
    s_add_u32 s90, s90, s100
    v_pk_mul_f32 v[64:65], v[64:65], s[92:93]
    v_pk_mul_f32 v[66:67], v[66:67], s[92:93]
    v_pk_mul_f32 v[68:69], v[68:69], s[92:93]
    v_pk_mul_f32 v[70:71], v[70:71], s[92:93]
    v_cvt_pk_bf16_f32 v64, v64, v65
    v_cvt_pk_bf16_f32 v65, v66, v67
    v_cvt_pk_bf16_f32 v66, v68, v69
    v_cvt_pk_bf16_f32 v67, v70, v71
    buffer_store_dwordx4 v[64:67], v2, s[8:11], s90 offen sc1
    s_add_u32 s90, s90, s100
    v_pk_mul_f32 v[72:73], v[72:73], s[92:93]
    v_pk_mul_f32 v[74:75], v[74:75], s[92:93]
    v_pk_mul_f32 v[76:77], v[76:77], s[92:93]
    v_pk_mul_f32 v[78:79], v[78:79], s[92:93]
    v_cvt_pk_bf16_f32 v72, v72, v73
    v_cvt_pk_bf16_f32 v73, v74, v75
    v_cvt_pk_bf16_f32 v74, v76, v77
    v_cvt_pk_bf16_f32 v75, v78, v79
    buffer_store_dwordx4 v[72:75], v2, s[8:11], s90 offen sc1
    s_add_u32 s90, s90, s100
    v_pk_mul_f32 v[80:81], v[80:81], s[92:93]
    v_pk_mul_f32 v[82:83], v[82:83], s[92:93]
    v_pk_mul_f32 v[84:85], v[84:85], s[92:93]
    v_pk_mul_f32 v[86:87], v[86:87], s[92:93]
    v_cvt_pk_bf16_f32 v80, v80, v81
    v_cvt_pk_bf16_f32 v81, v82, v83
    v_cvt_pk_bf16_f32 v82, v84, v85
    v_cvt_pk_bf16_f32 v83, v86, v87
    buffer_store_dwordx4 v[80:83], v2, s[8:11], s90 offen sc1
    s_add_u32 s90, s90, s100
    v_pk_mul_f32 v[88:89], v[88:89], s[92:93]
    v_pk_mul_f32 v[90:91], v[90:91], s[92:93]
    v_pk_mul_f32 v[92:93], v[92:93], s[92:93]
    v_pk_mul_f32 v[94:95], v[94:95], s[92:93]
    v_cvt_pk_bf16_f32 v88, v88, v89
    v_cvt_pk_bf16_f32 v89, v90, v91
    v_cvt_pk_bf16_f32 v90, v92, v93
    v_cvt_pk_bf16_f32 v91, v94, v95
    buffer_store_dwordx4 v[88:91], v2, s[8:11], s90 offen sc1
    s_add_u32 s90, s90, s100
    s_add_u32 s91, s91, s99
    s_mov_b32 s90, s91
    v_pk_mul_f32 v[96:97], v[96:97], s[92:93]
    v_pk_mul_f32 v[98:99], v[98:99], s[92:93]
    v_pk_mul_f32 v[100:101], v[100:101], s[92:93]
    v_pk_mul_f32 v[102:103], v[102:103], s[92:93]
    v_cvt_pk_bf16_f32 v96, v96, v97
    v_cvt_pk_bf16_f32 v97, v98, v99
    v_cvt_pk_bf16_f32 v98, v100, v101
    v_cvt_pk_bf16_f32 v99, v102, v103
    buffer_store_dwordx4 v[96:99], v2, s[8:11], s90 offen sc1
    s_add_u32 s90, s90, s100
    v_pk_mul_f32 v[104:105], v[104:105], s[92:93]
    v_pk_mul_f32 v[106:107], v[106:107], s[92:93]
    v_pk_mul_f32 v[108:109], v[108:109], s[92:93]
    v_pk_mul_f32 v[110:111], v[110:111], s[92:93]
    v_cvt_pk_bf16_f32 v104, v104, v105
    v_cvt_pk_bf16_f32 v105, v106, v107
    v_cvt_pk_bf16_f32 v106, v108, v109
    v_cvt_pk_bf16_f32 v107, v110, v111
    buffer_store_dwordx4 v[104:107], v2, s[8:11], s90 offen sc1
    s_add_u32 s90, s90, s100
    v_pk_mul_f32 v[112:113], v[112:113], s[92:93]
    v_pk_mul_f32 v[114:115], v[114:115], s[92:93]
    v_pk_mul_f32 v[116:117], v[116:117], s[92:93]
    v_pk_mul_f32 v[118:119], v[118:119], s[92:93]
    v_cvt_pk_bf16_f32 v112, v112, v113
    v_cvt_pk_bf16_f32 v113, v114, v115
    v_cvt_pk_bf16_f32 v114, v116, v117
    v_cvt_pk_bf16_f32 v115, v118, v119
    buffer_store_dwordx4 v[112:115], v2, s[8:11], s90 offen sc1
    s_add_u32 s90, s90, s100
    v_pk_mul_f32 v[120:121], v[120:121], s[92:93]
    v_pk_mul_f32 v[122:123], v[122:123], s[92:93]
    v_pk_mul_f32 v[124:125], v[124:125], s[92:93]
    v_pk_mul_f32 v[126:127], v[126:127], s[92:93]
    v_cvt_pk_bf16_f32 v120, v120, v121
    v_cvt_pk_bf16_f32 v121, v122, v123
    v_cvt_pk_bf16_f32 v122, v124, v125
    v_cvt_pk_bf16_f32 v123, v126, v127
    buffer_store_dwordx4 v[120:123], v2, s[8:11], s90 offen sc1
    s_add_u32 s90, s90, s100
    v_pk_mul_f32 v[128:129], v[128:129], s[92:93]
    v_pk_mul_f32 v[130:131], v[130:131], s[92:93]
    v_pk_mul_f32 v[132:133], v[132:133], s[92:93]
    v_pk_mul_f32 v[134:135], v[134:135], s[92:93]
    v_cvt_pk_bf16_f32 v128, v128, v129
    v_cvt_pk_bf16_f32 v129, v130, v131
    v_cvt_pk_bf16_f32 v130, v132, v133
    v_cvt_pk_bf16_f32 v131, v134, v135
    buffer_store_dwordx4 v[128:131], v2, s[8:11], s90 offen sc1
    s_add_u32 s90, s90, s100
    v_pk_mul_f32 v[136:137], v[136:137], s[92:93]
    v_pk_mul_f32 v[138:139], v[138:139], s[92:93]
    v_pk_mul_f32 v[140:141], v[140:141], s[92:93]
    v_pk_mul_f32 v[142:143], v[142:143], s[92:93]
    v_cvt_pk_bf16_f32 v136, v136, v137
    v_cvt_pk_bf16_f32 v137, v138, v139
    v_cvt_pk_bf16_f32 v138, v140, v141
    v_cvt_pk_bf16_f32 v139, v142, v143
    buffer_store_dwordx4 v[136:139], v2, s[8:11], s90 offen sc1
    s_add_u32 s90, s90, s100
    v_pk_mul_f32 v[144:145], v[144:145], s[92:93]
    v_pk_mul_f32 v[146:147], v[146:147], s[92:93]
    v_pk_mul_f32 v[148:149], v[148:149], s[92:93]
    v_pk_mul_f32 v[150:151], v[150:151], s[92:93]
    v_cvt_pk_bf16_f32 v144, v144, v145
    v_cvt_pk_bf16_f32 v145, v146, v147
    v_cvt_pk_bf16_f32 v146, v148, v149
    v_cvt_pk_bf16_f32 v147, v150, v151
    buffer_store_dwordx4 v[144:147], v2, s[8:11], s90 offen sc1
    s_add_u32 s90, s90, s100
    v_pk_mul_f32 v[152:153], v[152:153], s[92:93]
    v_pk_mul_f32 v[154:155], v[154:155], s[92:93]
    v_pk_mul_f32 v[156:157], v[156:157], s[92:93]
    v_pk_mul_f32 v[158:159], v[158:159], s[92:93]
    v_cvt_pk_bf16_f32 v152, v152, v153
    v_cvt_pk_bf16_f32 v153, v154, v155
    v_cvt_pk_bf16_f32 v154, v156, v157
    v_cvt_pk_bf16_f32 v155, v158, v159
    buffer_store_dwordx4 v[152:155], v2, s[8:11], s90 offen sc1
    s_add_u32 s90, s90, s100
    s_add_u32 s91, s91, s99
    s_mov_b32 s90, s91
    v_pk_mul_f32 v[160:161], v[160:161], s[92:93]
    v_pk_mul_f32 v[162:163], v[162:163], s[92:93]
    v_pk_mul_f32 v[164:165], v[164:165], s[92:93]
    v_pk_mul_f32 v[166:167], v[166:167], s[92:93]
    v_cvt_pk_bf16_f32 v160, v160, v161
    v_cvt_pk_bf16_f32 v161, v162, v163
    v_cvt_pk_bf16_f32 v162, v164, v165
    v_cvt_pk_bf16_f32 v163, v166, v167
    buffer_store_dwordx4 v[160:163], v2, s[8:11], s90 offen sc1
    s_add_u32 s90, s90, s100
    v_pk_mul_f32 v[168:169], v[168:169], s[92:93]
    v_pk_mul_f32 v[170:171], v[170:171], s[92:93]
    v_pk_mul_f32 v[172:173], v[172:173], s[92:93]
    v_pk_mul_f32 v[174:175], v[174:175], s[92:93]
    v_cvt_pk_bf16_f32 v168, v168, v169
    v_cvt_pk_bf16_f32 v169, v170, v171
    v_cvt_pk_bf16_f32 v170, v172, v173
    v_cvt_pk_bf16_f32 v171, v174, v175
    buffer_store_dwordx4 v[168:171], v2, s[8:11], s90 offen sc1
    s_add_u32 s90, s90, s100
    v_pk_mul_f32 v[176:177], v[176:177], s[92:93]
    v_pk_mul_f32 v[178:179], v[178:179], s[92:93]
    v_pk_mul_f32 v[180:181], v[180:181], s[92:93]
    v_pk_mul_f32 v[182:183], v[182:183], s[92:93]
    v_cvt_pk_bf16_f32 v176, v176, v177
    v_cvt_pk_bf16_f32 v177, v178, v179
    v_cvt_pk_bf16_f32 v178, v180, v181
    v_cvt_pk_bf16_f32 v179, v182, v183
    buffer_store_dwordx4 v[176:179], v2, s[8:11], s90 offen sc1
    s_add_u32 s90, s90, s100
    v_pk_mul_f32 v[184:185], v[184:185], s[92:93]
    v_pk_mul_f32 v[186:187], v[186:187], s[92:93]
    v_pk_mul_f32 v[188:189], v[188:189], s[92:93]
    v_pk_mul_f32 v[190:191], v[190:191], s[92:93]
    v_cvt_pk_bf16_f32 v184, v184, v185
    v_cvt_pk_bf16_f32 v185, v186, v187
    v_cvt_pk_bf16_f32 v186, v188, v189
    v_cvt_pk_bf16_f32 v187, v190, v191
    buffer_store_dwordx4 v[184:187], v2, s[8:11], s90 offen sc1
    s_add_u32 s90, s90, s100
    v_pk_mul_f32 v[192:193], v[192:193], s[92:93]
    v_pk_mul_f32 v[194:195], v[194:195], s[92:93]
    v_pk_mul_f32 v[196:197], v[196:197], s[92:93]
    v_pk_mul_f32 v[198:199], v[198:199], s[92:93]
    v_cvt_pk_bf16_f32 v192, v192, v193
    v_cvt_pk_bf16_f32 v193, v194, v195
    v_cvt_pk_bf16_f32 v194, v196, v197
    v_cvt_pk_bf16_f32 v195, v198, v199
    buffer_store_dwordx4 v[192:195], v2, s[8:11], s90 offen sc1
    s_add_u32 s90, s90, s100
    v_pk_mul_f32 v[200:201], v[200:201], s[92:93]
    v_pk_mul_f32 v[202:203], v[202:203], s[92:93]
    v_pk_mul_f32 v[204:205], v[204:205], s[92:93]
    v_pk_mul_f32 v[206:207], v[206:207], s[92:93]
    v_cvt_pk_bf16_f32 v200, v200, v201
    v_cvt_pk_bf16_f32 v201, v202, v203
    v_cvt_pk_bf16_f32 v202, v204, v205
    v_cvt_pk_bf16_f32 v203, v206, v207
    buffer_store_dwordx4 v[200:203], v2, s[8:11], s90 offen sc1
    s_add_u32 s90, s90, s100
    v_pk_mul_f32 v[208:209], v[208:209], s[92:93]
    v_pk_mul_f32 v[210:211], v[210:211], s[92:93]
    v_pk_mul_f32 v[212:213], v[212:213], s[92:93]
    v_pk_mul_f32 v[214:215], v[214:215], s[92:93]
    v_cvt_pk_bf16_f32 v208, v208, v209
    v_cvt_pk_bf16_f32 v209, v210, v211
    v_cvt_pk_bf16_f32 v210, v212, v213
    v_cvt_pk_bf16_f32 v211, v214, v215
    buffer_store_dwordx4 v[208:211], v2, s[8:11], s90 offen sc1
    s_add_u32 s90, s90, s100
    v_pk_mul_f32 v[216:217], v[216:217], s[92:93]
    v_pk_mul_f32 v[218:219], v[218:219], s[92:93]
    v_pk_mul_f32 v[220:221], v[220:221], s[92:93]
    v_pk_mul_f32 v[222:223], v[222:223], s[92:93]
    v_cvt_pk_bf16_f32 v216, v216, v217
    v_cvt_pk_bf16_f32 v217, v218, v219
    v_cvt_pk_bf16_f32 v218, v220, v221
    v_cvt_pk_bf16_f32 v219, v222, v223
    buffer_store_dwordx4 v[216:219], v2, s[8:11], s90 offen sc1
    s_add_u32 s90, s90, s100
    s_add_u32 s91, s91, s99
    s_mov_b32 s90, s91
    v_pk_mul_f32 v[224:225], v[224:225], s[92:93]
    v_pk_mul_f32 v[226:227], v[226:227], s[92:93]
    v_pk_mul_f32 v[228:229], v[228:229], s[92:93]
    v_pk_mul_f32 v[230:231], v[230:231], s[92:93]
    v_cvt_pk_bf16_f32 v224, v224, v225
    v_cvt_pk_bf16_f32 v225, v226, v227
    v_cvt_pk_bf16_f32 v226, v228, v229
    v_cvt_pk_bf16_f32 v227, v230, v231
    buffer_store_dwordx4 v[224:227], v2, s[8:11], s90 offen sc1
    s_add_u32 s90, s90, s100
    v_pk_mul_f32 v[232:233], v[232:233], s[92:93]
    v_pk_mul_f32 v[234:235], v[234:235], s[92:93]
    v_pk_mul_f32 v[236:237], v[236:237], s[92:93]
    v_pk_mul_f32 v[238:239], v[238:239], s[92:93]
    v_cvt_pk_bf16_f32 v232, v232, v233
    v_cvt_pk_bf16_f32 v233, v234, v235
    v_cvt_pk_bf16_f32 v234, v236, v237
    v_cvt_pk_bf16_f32 v235, v238, v239
    buffer_store_dwordx4 v[232:235], v2, s[8:11], s90 offen sc1
    s_add_u32 s90, s90, s100
    v_pk_mul_f32 v[240:241], v[240:241], s[92:93]
    v_pk_mul_f32 v[242:243], v[242:243], s[92:93]
    v_pk_mul_f32 v[244:245], v[244:245], s[92:93]
    v_pk_mul_f32 v[246:247], v[246:247], s[92:93]
    v_cvt_pk_bf16_f32 v240, v240, v241
    v_cvt_pk_bf16_f32 v241, v242, v243
    v_cvt_pk_bf16_f32 v242, v244, v245
    v_cvt_pk_bf16_f32 v243, v246, v247
    buffer_store_dwordx4 v[240:243], v2, s[8:11], s90 offen sc1
    s_add_u32 s90, s90, s100
    v_pk_mul_f32 v[248:249], v[248:249], s[92:93]
    v_pk_mul_f32 v[250:251], v[250:251], s[92:93]
    v_pk_mul_f32 v[252:253], v[252:253], s[92:93]
    v_pk_mul_f32 v[254:255], v[254:255], s[92:93]
    v_cvt_pk_bf16_f32 v248, v248, v249
    v_cvt_pk_bf16_f32 v249, v250, v251
    v_cvt_pk_bf16_f32 v250, v252, v253
    v_cvt_pk_bf16_f32 v251, v254, v255
    buffer_store_dwordx4 v[248:251], v2, s[8:11], s90 offen sc1
    s_add_u32 s90, s90, s100
    v_accvgpr_read_b32 v24, a224
    v_accvgpr_read_b32 v25, a225
    v_accvgpr_read_b32 v26, a226
    v_accvgpr_read_b32 v27, a227
    v_accvgpr_read_b32 v28, a228
    v_accvgpr_read_b32 v29, a229
    v_accvgpr_read_b32 v30, a230
    v_accvgpr_read_b32 v31, a231
    v_pk_mul_f32 v[24:25], v[24:25], s[92:93]
    v_pk_mul_f32 v[26:27], v[26:27], s[92:93]
    v_pk_mul_f32 v[28:29], v[28:29], s[92:93]
    v_pk_mul_f32 v[30:31], v[30:31], s[92:93]
    v_cvt_pk_bf16_f32 v24, v24, v25
    v_cvt_pk_bf16_f32 v25, v26, v27
    v_cvt_pk_bf16_f32 v26, v28, v29
    v_cvt_pk_bf16_f32 v27, v30, v31
    buffer_store_dwordx4 v[24:27], v2, s[8:11], s90 offen sc1
    s_add_u32 s90, s90, s100
    s_nop 1
    v_accvgpr_read_b32 v24, a232
    v_accvgpr_read_b32 v25, a233
    v_accvgpr_read_b32 v26, a234
    v_accvgpr_read_b32 v27, a235
    v_accvgpr_read_b32 v28, a236
    v_accvgpr_read_b32 v29, a237
    v_accvgpr_read_b32 v30, a238
    v_accvgpr_read_b32 v31, a239
    v_pk_mul_f32 v[24:25], v[24:25], s[92:93]
    v_pk_mul_f32 v[26:27], v[26:27], s[92:93]
    v_pk_mul_f32 v[28:29], v[28:29], s[92:93]
    v_pk_mul_f32 v[30:31], v[30:31], s[92:93]
    v_cvt_pk_bf16_f32 v24, v24, v25
    v_cvt_pk_bf16_f32 v25, v26, v27
    v_cvt_pk_bf16_f32 v26, v28, v29
    v_cvt_pk_bf16_f32 v27, v30, v31
    buffer_store_dwordx4 v[24:27], v2, s[8:11], s90 offen sc1
    s_add_u32 s90, s90, s100
    s_nop 1
    v_accvgpr_read_b32 v24, a240
    v_accvgpr_read_b32 v25, a241
    v_accvgpr_read_b32 v26, a242
    v_accvgpr_read_b32 v27, a243
    v_accvgpr_read_b32 v28, a244
    v_accvgpr_read_b32 v29, a245
    v_accvgpr_read_b32 v30, a246
    v_accvgpr_read_b32 v31, a247
    v_pk_mul_f32 v[24:25], v[24:25], s[92:93]
    v_pk_mul_f32 v[26:27], v[26:27], s[92:93]
    v_pk_mul_f32 v[28:29], v[28:29], s[92:93]
    v_pk_mul_f32 v[30:31], v[30:31], s[92:93]
    v_cvt_pk_bf16_f32 v24, v24, v25
    v_cvt_pk_bf16_f32 v25, v26, v27
    v_cvt_pk_bf16_f32 v26, v28, v29
    v_cvt_pk_bf16_f32 v27, v30, v31
    buffer_store_dwordx4 v[24:27], v2, s[8:11], s90 offen sc1
    s_add_u32 s90, s90, s100
    s_nop 1
    v_accvgpr_read_b32 v24, a248
    v_accvgpr_read_b32 v25, a249
    v_accvgpr_read_b32 v26, a250
    v_accvgpr_read_b32 v27, a251
    v_accvgpr_read_b32 v28, a252
    v_accvgpr_read_b32 v29, a253
    v_accvgpr_read_b32 v30, a254
    v_accvgpr_read_b32 v31, a255
    v_pk_mul_f32 v[24:25], v[24:25], s[92:93]
    v_pk_mul_f32 v[26:27], v[26:27], s[92:93]
    v_pk_mul_f32 v[28:29], v[28:29], s[92:93]
    v_pk_mul_f32 v[30:31], v[30:31], s[92:93]
    v_cvt_pk_bf16_f32 v24, v24, v25
    v_cvt_pk_bf16_f32 v25, v26, v27
    v_cvt_pk_bf16_f32 v26, v28, v29
    v_cvt_pk_bf16_f32 v27, v30, v31
    buffer_store_dwordx4 v[24:27], v2, s[8:11], s90 offen sc1
    s_add_u32 s90, s90, s100
    s_nop 1
    s_add_u32 s91, s91, s99
    s_setpc_b64 s[20:21]
m_epl63:
    s_mov_b32 s92, s97
    s_mov_b32 s93, s97
    s_cmp_eq_u32 s97, 0
    s_cbranch_scc1 m_ns264
    s_mov_b32 s90, s98
    v_pk_mul_f32 v[32:33], v[32:33], s[92:93]
    v_pk_mul_f32 v[34:35], v[34:35], s[92:93]
    v_pk_mul_f32 v[36:37], v[36:37], s[92:93]
    v_pk_mul_f32 v[38:39], v[38:39], s[92:93]
    v_cvt_pk_bf16_f32 v32, v32, v33
    v_cvt_pk_bf16_f32 v33, v34, v35
    v_cvt_pk_bf16_f32 v34, v36, v37
    v_cvt_pk_bf16_f32 v35, v38, v39
    buffer_store_dwordx4 v[32:35], v2, s[8:11], s90 offen sc1
    s_add_u32 s90, s90, s100
    v_pk_mul_f32 v[40:41], v[40:41], s[92:93]
    v_pk_mul_f32 v[42:43], v[42:43], s[92:93]
    v_pk_mul_f32 v[44:45], v[44:45], s[92:93]
    v_pk_mul_f32 v[46:47], v[46:47], s[92:93]
    v_cvt_pk_bf16_f32 v40, v40, v41
    v_cvt_pk_bf16_f32 v41, v42, v43
    v_cvt_pk_bf16_f32 v42, v44, v45
    v_cvt_pk_bf16_f32 v43, v46, v47
    buffer_store_dwordx4 v[40:43], v2, s[8:11], s90 offen sc1
    s_add_u32 s90, s90, s100
    v_pk_mul_f32 v[48:49], v[48:49], s[92:93]
    v_pk_mul_f32 v[50:51], v[50:51], s[92:93]
    v_pk_mul_f32 v[52:53], v[52:53], s[92:93]
    v_pk_mul_f32 v[54:55], v[54:55], s[92:93]
    v_cvt_pk_bf16_f32 v48, v48, v49
    v_cvt_pk_bf16_f32 v49, v50, v51
    v_cvt_pk_bf16_f32 v50, v52, v53
    v_cvt_pk_bf16_f32 v51, v54, v55
    buffer_store_dwordx4 v[48:51], v2, s[8:11], s90 offen sc1
    s_add_u32 s90, s90, s100
    v_pk_mul_f32 v[56:57], v[56:57], s[92:93]
    v_pk_mul_f32 v[58:59], v[58:59], s[92:93]
    v_pk_mul_f32 v[60:61], v[60:61], s[92:93]
    v_pk_mul_f32 v[62:63], v[62:63], s[92:93]
    v_cvt_pk_bf16_f32 v56, v56, v57
    v_cvt_pk_bf16_f32 v57, v58, v59
    v_cvt_pk_bf16_f32 v58, v60, v61
    v_cvt_pk_bf16_f32 v59, v62, v63
    buffer_store_dwordx4 v[56:59], v2, s[8:11], s90 offen sc1
    s_add_u32 s90, s90, s100
    v_pk_mul_f32 v[64:65], v[64:65], s[92:93]
    v_pk_mul_f32 v[66:67], v[66:67], s[92:93]
    v_pk_mul_f32 v[68:69], v[68:69], s[92:93]
    v_pk_mul_f32 v[70:71], v[70:71], s[92:93]
    v_cvt_pk_bf16_f32 v64, v64, v65
    v_cvt_pk_bf16_f32 v65, v66, v67
    v_cvt_pk_bf16_f32 v66, v68, v69
    v_cvt_pk_bf16_f32 v67, v70, v71
    buffer_store_dwordx4 v[64:67], v2, s[8:11], s90 offen sc1
    s_add_u32 s90, s90, s100
    v_pk_mul_f32 v[72:73], v[72:73], s[92:93]
    v_pk_mul_f32 v[74:75], v[74:75], s[92:93]
    v_pk_mul_f32 v[76:77], v[76:77], s[92:93]
    v_pk_mul_f32 v[78:79], v[78:79], s[92:93]
    v_cvt_pk_bf16_f32 v72, v72, v73
    v_cvt_pk_bf16_f32 v73, v74, v75
    v_cvt_pk_bf16_f32 v74, v76, v77
    v_cvt_pk_bf16_f32 v75, v78, v79
    buffer_store_dwordx4 v[72:75], v2, s[8:11], s90 offen sc1
    s_add_u32 s90, s90, s100
    v_pk_mul_f32 v[80:81], v[80:81], s[92:93]
    v_pk_mul_f32 v[82:83], v[82:83], s[92:93]
    v_pk_mul_f32 v[84:85], v[84:85], s[92:93]
    v_pk_mul_f32 v[86:87], v[86:87], s[92:93]
    v_cvt_pk_bf16_f32 v80, v80, v81
    v_cvt_pk_bf16_f32 v81, v82, v83
    v_cvt_pk_bf16_f32 v82, v84, v85
    v_cvt_pk_bf16_f32 v83, v86, v87
    buffer_store_dwordx4 v[80:83], v2, s[8:11], s90 offen sc1
    s_add_u32 s90, s90, s100
    v_pk_mul_f32 v[88:89], v[88:89], s[92:93]
    v_pk_mul_f32 v[90:91], v[90:91], s[92:93]
    v_pk_mul_f32 v[92:93], v[92:93], s[92:93]
    v_pk_mul_f32 v[94:95], v[94:95], s[92:93]
    v_cvt_pk_bf16_f32 v88, v88, v89
    v_cvt_pk_bf16_f32 v89, v90, v91
    v_cvt_pk_bf16_f32 v90, v92, v93
    v_cvt_pk_bf16_f32 v91, v94, v95
    buffer_store_dwordx4 v[88:91], v2, s[8:11], s90 offen sc1
    s_add_u32 s90, s98, s99
    v_pk_mul_f32 v[96:97], v[96:97], s[92:93]
    v_pk_mul_f32 v[98:99], v[98:99], s[92:93]
    v_pk_mul_f32 v[100:101], v[100:101], s[92:93]
    v_pk_mul_f32 v[102:103], v[102:103], s[92:93]
    v_cvt_pk_bf16_f32 v96, v96, v97
    v_cvt_pk_bf16_f32 v97, v98, v99
    v_cvt_pk_bf16_f32 v98, v100, v101
    v_cvt_pk_bf16_f32 v99, v102, v103
    buffer_store_dwordx4 v[96:99], v2, s[8:11], s90 offen sc1
    s_add_u32 s90, s90, s100
    v_pk_mul_f32 v[104:105], v[104:105], s[92:93]
    v_pk_mul_f32 v[106:107], v[106:107], s[92:93]
    v_pk_mul_f32 v[108:109], v[108:109], s[92:93]
    v_pk_mul_f32 v[110:111], v[110:111], s[92:93]
    v_cvt_pk_bf16_f32 v104, v104, v105
    v_cvt_pk_bf16_f32 v105, v106, v107
    v_cvt_pk_bf16_f32 v106, v108, v109
    v_cvt_pk_bf16_f32 v107, v110, v111
    buffer_store_dwordx4 v[104:107], v2, s[8:11], s90 offen sc1
    s_add_u32 s90, s90, s100
    v_pk_mul_f32 v[112:113], v[112:113], s[92:93]
    v_pk_mul_f32 v[114:115], v[114:115], s[92:93]
    v_pk_mul_f32 v[116:117], v[116:117], s[92:93]
    v_pk_mul_f32 v[118:119], v[118:119], s[92:93]
    v_cvt_pk_bf16_f32 v112, v112, v113
    v_cvt_pk_bf16_f32 v113, v114, v115
    v_cvt_pk_bf16_f32 v114, v116, v117
    v_cvt_pk_bf16_f32 v115, v118, v119
    buffer_store_dwordx4 v[112:115], v2, s[8:11], s90 offen sc1
    s_add_u32 s90, s90, s100
    v_pk_mul_f32 v[120:121], v[120:121], s[92:93]
    v_pk_mul_f32 v[122:123], v[122:123], s[92:93]
    v_pk_mul_f32 v[124:125], v[124:125], s[92:93]
    v_pk_mul_f32 v[126:127], v[126:127], s[92:93]
    v_cvt_pk_bf16_f32 v120, v120, v121
    v_cvt_pk_bf16_f32 v121, v122, v123
    v_cvt_pk_bf16_f32 v122, v124, v125
    v_cvt_pk_bf16_f32 v123, v126, v127
    buffer_store_dwordx4 v[120:123], v2, s[8:11], s90 offen sc1
    s_add_u32 s90, s90, s100
    v_pk_mul_f32 v[128:129], v[128:129], s[92:93]
    v_pk_mul_f32 v[130:131], v[130:131], s[92:93]
    v_pk_mul_f32 v[132:133], v[132:133], s[92:93]
    v_pk_mul_f32 v[134:135], v[134:135], s[92:93]
    v_cvt_pk_bf16_f32 v128, v128, v129
    v_cvt_pk_bf16_f32 v129, v130, v131
    v_cvt_pk_bf16_f32 v130, v132, v133
    v_cvt_pk_bf16_f32 v131, v134, v135
    buffer_store_dwordx4 v[128:131], v2, s[8:11], s90 offen sc1
    s_add_u32 s90, s90, s100
    v_pk_mul_f32 v[136:137], v[136:137], s[92:93]
    v_pk_mul_f32 v[138:139], v[138:139], s[92:93]
    v_pk_mul_f32 v[140:141], v[140:141], s[92:93]
    v_pk_mul_f32 v[142:143], v[142:143], s[92:93]
    v_cvt_pk_bf16_f32 v136, v136, v137
    v_cvt_pk_bf16_f32 v137, v138, v139
    v_cvt_pk_bf16_f32 v138, v140, v141
    v_cvt_pk_bf16_f32 v139, v142, v143
    buffer_store_dwordx4 v[136:139], v2, s[8:11], s90 offen sc1
    s_add_u32 s90, s90, s100
    v_pk_mul_f32 v[144:145], v[144:145], s[92:93]
    v_pk_mul_f32 v[146:147], v[146:147], s[92:93]
    v_pk_mul_f32 v[148:149], v[148:149], s[92:93]
    v_pk_mul_f32 v[150:151], v[150:151], s[92:93]
    v_cvt_pk_bf16_f32 v144, v144, v145
    v_cvt_pk_bf16_f32 v145, v146, v147
    v_cvt_pk_bf16_f32 v146, v148, v149
    v_cvt_pk_bf16_f32 v147, v150, v151
    buffer_store_dwordx4 v[144:147], v2, s[8:11], s90 offen sc1
    s_add_u32 s90, s90, s100
    v_pk_mul_f32 v[152:153], v[152:153], s[92:93]
    v_pk_mul_f32 v[154:155], v[154:155], s[92:93]
    v_pk_mul_f32 v[156:157], v[156:157], s[92:93]
    v_pk_mul_f32 v[158:159], v[158:159], s[92:93]
    v_cvt_pk_bf16_f32 v152, v152, v153
    v_cvt_pk_bf16_f32 v153, v154, v155
    v_cvt_pk_bf16_f32 v154, v156, v157
    v_cvt_pk_bf16_f32 v155, v158, v159
    buffer_store_dwordx4 v[152:155], v2, s[8:11], s90 offen sc1
    s_add_u32 s90, s90, s100
    v_pk_mul_f32 v[192:193], v[192:193], s[92:93]
    v_pk_mul_f32 v[194:195], v[194:195], s[92:93]
    v_pk_mul_f32 v[196:197], v[196:197], s[92:93]
    v_pk_mul_f32 v[198:199], v[198:199], s[92:93]
    v_cvt_pk_bf16_f32 v192, v192, v193
    v_cvt_pk_bf16_f32 v193, v194, v195
    v_cvt_pk_bf16_f32 v194, v196, v197
    v_cvt_pk_bf16_f32 v195, v198, v199
    v_pk_mul_f32 v[200:201], v[200:201], s[92:93]
    v_pk_mul_f32 v[202:203], v[202:203], s[92:93]
    v_pk_mul_f32 v[204:205], v[204:205], s[92:93]
    v_pk_mul_f32 v[206:207], v[206:207], s[92:93]
    v_cvt_pk_bf16_f32 v196, v200, v201
    v_cvt_pk_bf16_f32 v197, v202, v203
    v_cvt_pk_bf16_f32 v198, v204, v205
    v_cvt_pk_bf16_f32 v199, v206, v207
    v_pk_mul_f32 v[208:209], v[208:209], s[92:93]
    v_pk_mul_f32 v[210:211], v[210:211], s[92:93]
    v_pk_mul_f32 v[212:213], v[212:213], s[92:93]
    v_pk_mul_f32 v[214:215], v[214:215], s[92:93]
    v_cvt_pk_bf16_f32 v200, v208, v209
    v_cvt_pk_bf16_f32 v201, v210, v211
    v_cvt_pk_bf16_f32 v202, v212, v213
    v_cvt_pk_bf16_f32 v203, v214, v215
    v_pk_mul_f32 v[216:217], v[216:217], s[92:93]
    v_pk_mul_f32 v[218:219], v[218:219], s[92:93]
    v_pk_mul_f32 v[220:221], v[220:221], s[92:93]
    v_pk_mul_f32 v[222:223], v[222:223], s[92:93]
    v_cvt_pk_bf16_f32 v204, v216, v217
    v_cvt_pk_bf16_f32 v205, v218, v219
    v_cvt_pk_bf16_f32 v206, v220, v221
    v_cvt_pk_bf16_f32 v207, v222, v223
    v_pk_mul_f32 v[224:225], v[224:225], s[92:93]
    v_pk_mul_f32 v[226:227], v[226:227], s[92:93]
    v_pk_mul_f32 v[228:229], v[228:229], s[92:93]
    v_pk_mul_f32 v[230:231], v[230:231], s[92:93]
    v_cvt_pk_bf16_f32 v208, v224, v225
    v_cvt_pk_bf16_f32 v209, v226, v227
    v_cvt_pk_bf16_f32 v210, v228, v229
    v_cvt_pk_bf16_f32 v211, v230, v231
    v_pk_mul_f32 v[232:233], v[232:233], s[92:93]
    v_pk_mul_f32 v[234:235], v[234:235], s[92:93]
    v_pk_mul_f32 v[236:237], v[236:237], s[92:93]
    v_pk_mul_f32 v[238:239], v[238:239], s[92:93]
    v_cvt_pk_bf16_f32 v212, v232, v233
    v_cvt_pk_bf16_f32 v213, v234, v235
    v_cvt_pk_bf16_f32 v214, v236, v237
    v_cvt_pk_bf16_f32 v215, v238, v239
    v_pk_mul_f32 v[240:241], v[240:241], s[92:93]
    v_pk_mul_f32 v[242:243], v[242:243], s[92:93]
    v_pk_mul_f32 v[244:245], v[244:245], s[92:93]
    v_pk_mul_f32 v[246:247], v[246:247], s[92:93]
    v_cvt_pk_bf16_f32 v216, v240, v241
    v_cvt_pk_bf16_f32 v217, v242, v243
    v_cvt_pk_bf16_f32 v218, v244, v245
    v_cvt_pk_bf16_f32 v219, v246, v247
    v_pk_mul_f32 v[248:249], v[248:249], s[92:93]
    v_pk_mul_f32 v[250:251], v[250:251], s[92:93]
    v_pk_mul_f32 v[252:253], v[252:253], s[92:93]
    v_pk_mul_f32 v[254:255], v[254:255], s[92:93]
    v_cvt_pk_bf16_f32 v220, v248, v249
    v_cvt_pk_bf16_f32 v221, v250, v251
    v_cvt_pk_bf16_f32 v222, v252, v253
    v_cvt_pk_bf16_f32 v223, v254, v255
    v_accvgpr_read_b32 v24, a224
    v_accvgpr_read_b32 v25, a225
    v_accvgpr_read_b32 v26, a226
    v_accvgpr_read_b32 v27, a227
    v_accvgpr_read_b32 v28, a228
    v_accvgpr_read_b32 v29, a229
    v_accvgpr_read_b32 v30, a230
    v_accvgpr_read_b32 v31, a231
    v_pk_mul_f32 v[24:25], v[24:25], s[92:93]
    v_pk_mul_f32 v[26:27], v[26:27], s[92:93]
    v_pk_mul_f32 v[28:29], v[28:29], s[92:93]
    v_pk_mul_f32 v[30:31], v[30:31], s[92:93]
    v_cvt_pk_bf16_f32 v224, v24, v25
    v_cvt_pk_bf16_f32 v225, v26, v27
    v_cvt_pk_bf16_f32 v226, v28, v29
    v_cvt_pk_bf16_f32 v227, v30, v31
    v_accvgpr_read_b32 v24, a232
    v_accvgpr_read_b32 v25, a233
    v_accvgpr_read_b32 v26, a234
    v_accvgpr_read_b32 v27, a235
    v_accvgpr_read_b32 v28, a236
    v_accvgpr_read_b32 v29, a237
    v_accvgpr_read_b32 v30, a238
    v_accvgpr_read_b32 v31, a239
    v_pk_mul_f32 v[24:25], v[24:25], s[92:93]
    v_pk_mul_f32 v[26:27], v[26:27], s[92:93]
    v_pk_mul_f32 v[28:29], v[28:29], s[92:93]
    v_pk_mul_f32 v[30:31], v[30:31], s[92:93]
    v_cvt_pk_bf16_f32 v228, v24, v25
    v_cvt_pk_bf16_f32 v229, v26, v27
    v_cvt_pk_bf16_f32 v230, v28, v29
    v_cvt_pk_bf16_f32 v231, v30, v31
    v_accvgpr_read_b32 v24, a240
    v_accvgpr_read_b32 v25, a241
    v_accvgpr_read_b32 v26, a242
    v_accvgpr_read_b32 v27, a243
    v_accvgpr_read_b32 v28, a244
    v_accvgpr_read_b32 v29, a245
    v_accvgpr_read_b32 v30, a246
    v_accvgpr_read_b32 v31, a247
    v_pk_mul_f32 v[24:25], v[24:25], s[92:93]
    v_pk_mul_f32 v[26:27], v[26:27], s[92:93]
    v_pk_mul_f32 v[28:29], v[28:29], s[92:93]
    v_pk_mul_f32 v[30:31], v[30:31], s[92:93]
    v_cvt_pk_bf16_f32 v232, v24, v25
    v_cvt_pk_bf16_f32 v233, v26, v27
    v_cvt_pk_bf16_f32 v234, v28, v29
    v_cvt_pk_bf16_f32 v235, v30, v31
    v_accvgpr_read_b32 v24, a248
    v_accvgpr_read_b32 v25, a249
    v_accvgpr_read_b32 v26, a250
    v_accvgpr_read_b32 v27, a251
    v_accvgpr_read_b32 v28, a252
    v_accvgpr_read_b32 v29, a253
    v_accvgpr_read_b32 v30, a254
    v_accvgpr_read_b32 v31, a255
    v_pk_mul_f32 v[24:25], v[24:25], s[92:93]
    v_pk_mul_f32 v[26:27], v[26:27], s[92:93]
    v_pk_mul_f32 v[28:29], v[28:29], s[92:93]
    v_pk_mul_f32 v[30:31], v[30:31], s[92:93]
    v_cvt_pk_bf16_f32 v236, v24, v25
    v_cvt_pk_bf16_f32 v237, v26, v27
    v_cvt_pk_bf16_f32 v238, v28, v29
    v_cvt_pk_bf16_f32 v239, v30, v31
    v_pk_mul_f32 v[160:161], v[160:161], s[92:93]
    v_pk_mul_f32 v[162:163], v[162:163], s[92:93]
    v_pk_mul_f32 v[164:165], v[164:165], s[92:93]
    v_pk_mul_f32 v[166:167], v[166:167], s[92:93]
    v_cvt_pk_bf16_f32 v240, v160, v161
    v_cvt_pk_bf16_f32 v241, v162, v163
    v_cvt_pk_bf16_f32 v242, v164, v165
    v_cvt_pk_bf16_f32 v243, v166, v167
    v_pk_mul_f32 v[168:169], v[168:169], s[92:93]
    v_pk_mul_f32 v[170:171], v[170:171], s[92:93]
    v_pk_mul_f32 v[172:173], v[172:173], s[92:93]
    v_pk_mul_f32 v[174:175], v[174:175], s[92:93]
    v_cvt_pk_bf16_f32 v244, v168, v169
    v_cvt_pk_bf16_f32 v245, v170, v171
    v_cvt_pk_bf16_f32 v246, v172, v173
    v_cvt_pk_bf16_f32 v247, v174, v175
    v_pk_mul_f32 v[176:177], v[176:177], s[92:93]
    v_pk_mul_f32 v[178:179], v[178:179], s[92:93]
    v_pk_mul_f32 v[180:181], v[180:181], s[92:93]
    v_pk_mul_f32 v[182:183], v[182:183], s[92:93]
    v_cvt_pk_bf16_f32 v248, v176, v177
    v_cvt_pk_bf16_f32 v249, v178, v179
    v_cvt_pk_bf16_f32 v250, v180, v181
    v_cvt_pk_bf16_f32 v251, v182, v183
    v_pk_mul_f32 v[184:185], v[184:185], s[92:93]
    v_pk_mul_f32 v[186:187], v[186:187], s[92:93]
    v_pk_mul_f32 v[188:189], v[188:189], s[92:93]
    v_pk_mul_f32 v[190:191], v[190:191], s[92:93]
    v_cvt_pk_bf16_f32 v252, v184, v185
    v_cvt_pk_bf16_f32 v253, v186, v187
    v_cvt_pk_bf16_f32 v254, v188, v189
    v_cvt_pk_bf16_f32 v255, v190, v191
    s_setpc_b64 s[20:21]
m_ns264:
    s_mov_b32 s90, s98
    v_cvt_pk_bf16_f32 v32, v32, v33
    v_cvt_pk_bf16_f32 v33, v34, v35
    v_cvt_pk_bf16_f32 v34, v36, v37
    v_cvt_pk_bf16_f32 v35, v38, v39
    buffer_store_dwordx4 v[32:35], v2, s[8:11], s90 offen sc1
    s_add_u32 s90, s90, s100
    v_cvt_pk_bf16_f32 v40, v40, v41
    v_cvt_pk_bf16_f32 v41, v42, v43
    v_cvt_pk_bf16_f32 v42, v44, v45
    v_cvt_pk_bf16_f32 v43, v46, v47
    buffer_store_dwordx4 v[40:43], v2, s[8:11], s90 offen sc1
    s_add_u32 s90, s90, s100
    v_cvt_pk_bf16_f32 v48, v48, v49
    v_cvt_pk_bf16_f32 v49, v50, v51
    v_cvt_pk_bf16_f32 v50, v52, v53
    v_cvt_pk_bf16_f32 v51, v54, v55
    buffer_store_dwordx4 v[48:51], v2, s[8:11], s90 offen sc1
    s_add_u32 s90, s90, s100
    v_cvt_pk_bf16_f32 v56, v56, v57
    v_cvt_pk_bf16_f32 v57, v58, v59
    v_cvt_pk_bf16_f32 v58, v60, v61
    v_cvt_pk_bf16_f32 v59, v62, v63
    buffer_store_dwordx4 v[56:59], v2, s[8:11], s90 offen sc1
    s_add_u32 s90, s90, s100
    v_cvt_pk_bf16_f32 v64, v64, v65
    v_cvt_pk_bf16_f32 v65, v66, v67
    v_cvt_pk_bf16_f32 v66, v68, v69
    v_cvt_pk_bf16_f32 v67, v70, v71
    buffer_store_dwordx4 v[64:67], v2, s[8:11], s90 offen sc1
    s_add_u32 s90, s90, s100
    v_cvt_pk_bf16_f32 v72, v72, v73
    v_cvt_pk_bf16_f32 v73, v74, v75
    v_cvt_pk_bf16_f32 v74, v76, v77
    v_cvt_pk_bf16_f32 v75, v78, v79
    buffer_store_dwordx4 v[72:75], v2, s[8:11], s90 offen sc1
    s_add_u32 s90, s90, s100
    v_cvt_pk_bf16_f32 v80, v80, v81
    v_cvt_pk_bf16_f32 v81, v82, v83
    v_cvt_pk_bf16_f32 v82, v84, v85
    v_cvt_pk_bf16_f32 v83, v86, v87
    buffer_store_dwordx4 v[80:83], v2, s[8:11], s90 offen sc1
    s_add_u32 s90, s90, s100
    v_cvt_pk_bf16_f32 v88, v88, v89
    v_cvt_pk_bf16_f32 v89, v90, v91
    v_cvt_pk_bf16_f32 v90, v92, v93
    v_cvt_pk_bf16_f32 v91, v94, v95
    buffer_store_dwordx4 v[88:91], v2, s[8:11], s90 offen sc1
    s_add_u32 s90, s98, s99
    v_cvt_pk_bf16_f32 v96, v96, v97
    v_cvt_pk_bf16_f32 v97, v98, v99
    v_cvt_pk_bf16_f32 v98, v100, v101
    v_cvt_pk_bf16_f32 v99, v102, v103
    buffer_store_dwordx4 v[96:99], v2, s[8:11], s90 offen sc1
    s_add_u32 s90, s90, s100
    v_cvt_pk_bf16_f32 v104, v104, v105
    v_cvt_pk_bf16_f32 v105, v106, v107
    v_cvt_pk_bf16_f32 v106, v108, v109
    v_cvt_pk_bf16_f32 v107, v110, v111
    buffer_store_dwordx4 v[104:107], v2, s[8:11], s90 offen sc1
    s_add_u32 s90, s90, s100
    v_cvt_pk_bf16_f32 v112, v112, v113
    v_cvt_pk_bf16_f32 v113, v114, v115
    v_cvt_pk_bf16_f32 v114, v116, v117
    v_cvt_pk_bf16_f32 v115, v118, v119
    buffer_store_dwordx4 v[112:115], v2, s[8:11], s90 offen sc1
    s_add_u32 s90, s90, s100
    v_cvt_pk_bf16_f32 v120, v120, v121
    v_cvt_pk_bf16_f32 v121, v122, v123
    v_cvt_pk_bf16_f32 v122, v124, v125
    v_cvt_pk_bf16_f32 v123, v126, v127
    buffer_store_dwordx4 v[120:123], v2, s[8:11], s90 offen sc1
    s_add_u32 s90, s90, s100
    v_cvt_pk_bf16_f32 v128, v128, v129
    v_cvt_pk_bf16_f32 v129, v130, v131
    v_cvt_pk_bf16_f32 v130, v132, v133
    v_cvt_pk_bf16_f32 v131, v134, v135
    buffer_store_dwordx4 v[128:131], v2, s[8:11], s90 offen sc1
    s_add_u32 s90, s90, s100
    v_cvt_pk_bf16_f32 v136, v136, v137
    v_cvt_pk_bf16_f32 v137, v138, v139
    v_cvt_pk_bf16_f32 v138, v140, v141
    v_cvt_pk_bf16_f32 v139, v142, v143
    buffer_store_dwordx4 v[136:139], v2, s[8:11], s90 offen sc1
    s_add_u32 s90, s90, s100
    v_cvt_pk_bf16_f32 v144, v144, v145
    v_cvt_pk_bf16_f32 v145, v146, v147
    v_cvt_pk_bf16_f32 v146, v148, v149
    v_cvt_pk_bf16_f32 v147, v150, v151
    buffer_store_dwordx4 v[144:147], v2, s[8:11], s90 offen sc1
    s_add_u32 s90, s90, s100
    v_cvt_pk_bf16_f32 v152, v152, v153
    v_cvt_pk_bf16_f32 v153, v154, v155
    v_cvt_pk_bf16_f32 v154, v156, v157
    v_cvt_pk_bf16_f32 v155, v158, v159
    buffer_store_dwordx4 v[152:155], v2, s[8:11], s90 offen sc1
    s_add_u32 s90, s90, s100
    v_cvt_pk_bf16_f32 v192, v192, v193
    v_cvt_pk_bf16_f32 v193, v194, v195
    v_cvt_pk_bf16_f32 v194, v196, v197
    v_cvt_pk_bf16_f32 v195, v198, v199
    v_cvt_pk_bf16_f32 v196, v200, v201
    v_cvt_pk_bf16_f32 v197, v202, v203
    v_cvt_pk_bf16_f32 v198, v204, v205
    v_cvt_pk_bf16_f32 v199, v206, v207
    v_cvt_pk_bf16_f32 v200, v208, v209
    v_cvt_pk_bf16_f32 v201, v210, v211
    v_cvt_pk_bf16_f32 v202, v212, v213
    v_cvt_pk_bf16_f32 v203, v214, v215
    v_cvt_pk_bf16_f32 v204, v216, v217
    v_cvt_pk_bf16_f32 v205, v218, v219
    v_cvt_pk_bf16_f32 v206, v220, v221
    v_cvt_pk_bf16_f32 v207, v222, v223
    v_cvt_pk_bf16_f32 v208, v224, v225
    v_cvt_pk_bf16_f32 v209, v226, v227
    v_cvt_pk_bf16_f32 v210, v228, v229
    v_cvt_pk_bf16_f32 v211, v230, v231
    v_cvt_pk_bf16_f32 v212, v232, v233
    v_cvt_pk_bf16_f32 v213, v234, v235
    v_cvt_pk_bf16_f32 v214, v236, v237
    v_cvt_pk_bf16_f32 v215, v238, v239
    v_cvt_pk_bf16_f32 v216, v240, v241
    v_cvt_pk_bf16_f32 v217, v242, v243
    v_cvt_pk_bf16_f32 v218, v244, v245
    v_cvt_pk_bf16_f32 v219, v246, v247
    v_cvt_pk_bf16_f32 v220, v248, v249
    v_cvt_pk_bf16_f32 v221, v250, v251
    v_cvt_pk_bf16_f32 v222, v252, v253
    v_cvt_pk_bf16_f32 v223, v254, v255
    v_accvgpr_read_b32 v24, a224
    v_accvgpr_read_b32 v25, a225
    v_accvgpr_read_b32 v26, a226
    v_accvgpr_read_b32 v27, a227
    v_accvgpr_read_b32 v28, a228
    v_accvgpr_read_b32 v29, a229
    v_accvgpr_read_b32 v30, a230
    v_accvgpr_read_b32 v31, a231
    v_cvt_pk_bf16_f32 v224, v24, v25
    v_cvt_pk_bf16_f32 v225, v26, v27
    v_cvt_pk_bf16_f32 v226, v28, v29
    v_cvt_pk_bf16_f32 v227, v30, v31
    v_accvgpr_read_b32 v24, a232
    v_accvgpr_read_b32 v25, a233
    v_accvgpr_read_b32 v26, a234
    v_accvgpr_read_b32 v27, a235
    v_accvgpr_read_b32 v28, a236
    v_accvgpr_read_b32 v29, a237
    v_accvgpr_read_b32 v30, a238
    v_accvgpr_read_b32 v31, a239
    v_cvt_pk_bf16_f32 v228, v24, v25
    v_cvt_pk_bf16_f32 v229, v26, v27
    v_cvt_pk_bf16_f32 v230, v28, v29
    v_cvt_pk_bf16_f32 v231, v30, v31
    v_accvgpr_read_b32 v24, a240
    v_accvgpr_read_b32 v25, a241
    v_accvgpr_read_b32 v26, a242
    v_accvgpr_read_b32 v27, a243
    v_accvgpr_read_b32 v28, a244
    v_accvgpr_read_b32 v29, a245
    v_accvgpr_read_b32 v30, a246
    v_accvgpr_read_b32 v31, a247
    v_cvt_pk_bf16_f32 v232, v24, v25
    v_cvt_pk_bf16_f32 v233, v26, v27
    v_cvt_pk_bf16_f32 v234, v28, v29
    v_cvt_pk_bf16_f32 v235, v30, v31
    v_accvgpr_read_b32 v24, a248
    v_accvgpr_read_b32 v25, a249
    v_accvgpr_read_b32 v26, a250
    v_accvgpr_read_b32 v27, a251
    v_accvgpr_read_b32 v28, a252
    v_accvgpr_read_b32 v29, a253
    v_accvgpr_read_b32 v30, a254
    v_accvgpr_read_b32 v31, a255
    v_cvt_pk_bf16_f32 v236, v24, v25
    v_cvt_pk_bf16_f32 v237, v26, v27
    v_cvt_pk_bf16_f32 v238, v28, v29
    v_cvt_pk_bf16_f32 v239, v30, v31
    v_cvt_pk_bf16_f32 v240, v160, v161
    v_cvt_pk_bf16_f32 v241, v162, v163
    v_cvt_pk_bf16_f32 v242, v164, v165
    v_cvt_pk_bf16_f32 v243, v166, v167
    v_cvt_pk_bf16_f32 v244, v168, v169
    v_cvt_pk_bf16_f32 v245, v170, v171
    v_cvt_pk_bf16_f32 v246, v172, v173
    v_cvt_pk_bf16_f32 v247, v174, v175
    v_cvt_pk_bf16_f32 v248, v176, v177
    v_cvt_pk_bf16_f32 v249, v178, v179
    v_cvt_pk_bf16_f32 v250, v180, v181
    v_cvt_pk_bf16_f32 v251, v182, v183
    v_cvt_pk_bf16_f32 v252, v184, v185
    v_cvt_pk_bf16_f32 v253, v186, v187
    v_cvt_pk_bf16_f32 v254, v188, v189
    v_cvt_pk_bf16_f32 v255, v190, v191
    s_setpc_b64 s[20:21]
m_pf7:
    s_mov_b32 s15, 0x20000
    s_sub_u32 s93, s2, 224
    s_lshl_b32 s93, s93, 2
    s_add_u32 s93, s93, s16
    v_lshlrev_b32 v24, 7, v1
    v_lshrrev_b32 v25, 3, v1
    v_lshlrev_b32 v25, 11, v25
    v_and_b32 v26, 7, v1
    v_lshl_add_u32 v25, v26, 7, v25
    s_lshl_b32 s92, s93, 13
    s_lshl_b32 s93, s93, 14
    s_add_u32 s93, s93, 1024
    s_mov_b32 s12, s26
    s_mov_b32 s13, s27
    s_mov_b32 s14, 6291456
    s_add_u32 s90, s92, 0
    buffer_load_dword v22, v24, s[12:15], s90 offen
    s_add_u32 s90, s92, 1048576
    buffer_load_dword v22, v24, s[12:15], s90 offen
    s_mov_b32 s12, s24
    s_mov_b32 s13, s25
    s_mov_b32 s14, 4194304
    s_add_u32 s90, s92, 0
    buffer_load_dword v22, v24, s[12:15], s90 offen
    s_add_u32 s90, s92, 1048576
    buffer_load_dword v22, v24, s[12:15], s90 offen
    s_add_u32 s90, s92, 2097152
    buffer_load_dword v22, v24, s[12:15], s90 offen
    s_add_u32 s90, s92, 3145728
    buffer_load_dword v22, v24, s[12:15], s90 offen
    s_mov_b32 s12, s34
    s_mov_b32 s13, s35
    s_mov_b32 s14, 8388608
    s_add_u32 s90, s92, 4194304
    buffer_load_dword v22, v24, s[12:15], s90 offen
    s_add_u32 s90, s92, 5242880
    buffer_load_dword v22, v24, s[12:15], s90 offen
    s_mov_b32 s12, s30
    s_mov_b32 s13, s31
    s_mov_b32 s14, 4194304
    s_add_u32 s90, s93, 0
    buffer_load_dword v22, v25, s[12:15], s90 offen
    s_add_u32 s90, s93, 2097152
    buffer_load_dword v22, v25, s[12:15], s90 offen
    s_mov_b32 s12, s26
    s_mov_b32 s13, s27
    s_mov_b32 s14, 6291456
    s_add_u32 s90, s92, 2097152
    buffer_load_dword v22, v24, s[12:15], s90 offen
    s_mov_b32 s12, s34
    s_mov_b32 s13, s35
    s_mov_b32 s14, 8388608
    s_add_u32 s90, s92, 6291456
    buffer_load_dword v22, v24, s[12:15], s90 offen
    s_add_u32 s90, s92, 7340032
    buffer_load_dword v22, v24, s[12:15], s90 offen
    s_mov_b32 s12, s26
    s_mov_b32 s13, s27
    s_mov_b32 s14, 6291456
    s_add_u32 s90, s92, 3145728
    buffer_load_dword v22, v24, s[12:15], s90 offen
    s_add_u32 s90, s92, 4194304
    buffer_load_dword v22, v24, s[12:15], s90 offen
    s_add_u32 s90, s92, 5242880
    buffer_load_dword v22, v24, s[12:15], s90 offen
    s_mov_b32 s12, s32
    s_mov_b32 s13, s33
    s_mov_b32 s14, 2097152
    s_add_u32 s90, s92, 1048576
    buffer_load_dword v22, v24, s[12:15], s90 offen
    s_add_u32 s61, s61, 32768
    s_branch m_nopf6
concat_heads__sliding_local_dilated__compressed_kv_cla__prompt_kernel_end:
.section .rodata,"a"
.p2align 6
.amdhsa_kernel concat_heads__sliding_local_dilated__compressed_kv_cla__prompt_kernel
  .amdhsa_next_free_vgpr 512
  .amdhsa_next_free_sgpr 102
  .amdhsa_accum_offset 256
  .amdhsa_group_segment_fixed_size 0
  .amdhsa_kernarg_size 96
  .amdhsa_user_sgpr_count 2
  .amdhsa_user_sgpr_kernarg_segment_ptr 1
  .amdhsa_system_sgpr_workgroup_id_x 1
.end_amdhsa_kernel
```

```asm
; @launch grid=(256,1,1) block=(256,1,1) lds=163840
.amdgcn_target "amdgcn-amd-amdhsa--gfx950"
.text
.globl concat_heads__sliding_local_dilated__compressed_kv_cla__prompt_kernel
.p2align 8
.type concat_heads__sliding_local_dilated__compressed_kv_cla__prompt_kernel,@function
concat_heads__sliding_local_dilated__compressed_kv_cla__prompt_kernel:
    s_cmp_ge_u32 s2, 256
    s_cbranch_scc1 m_end1
    s_load_dwordx16 s[24:39], s[0:1], 0
    s_load_dwordx4 s[4:7], s[0:1], 80
    v_and_b32 v1, 63, v0
    v_lshrrev_b32 v24, 6, v0
    s_nop 0
    v_readfirstlane_b32 s16, v24
    s_lshr_b32 s68, s2, 3
    s_lshr_b32 s57, s16, 1
    s_and_b32 s58, s16, 1
    s_mov_b32 s43, 0x20000
    s_mov_b32 s47, 0x20000
    s_cmp_lt_u32 s68, 28
    s_cbranch_scc1 m_ncp2
    s_sub_u32 s91, s68, 28
    s_lshl_b32 s91, s91, 2
    s_add_u32 s91, s91, s16
    s_getpc_b64 s[8:9]
m_pc3:
    s_sub_u32 s8, s8, m_pc3-concat_heads__sliding_local_dilated__compressed_kv_cla__prompt_kernel
    s_subb_u32 s9, s9, 0
    s_lshl_b32 s90, s91, 13
    v_lshlrev_b32 v24, 7, v1
    v_add_u32 v24, s90, v24
    v_min_u32 v24, concat_heads__sliding_local_dilated__compressed_kv_cla__prompt_kernel_end-concat_heads__sliding_local_dilated__compressed_kv_cla__prompt_kernel-4, v24
    v_mov_b32 v25, s9
    v_add_co_u32 v24, vcc, s8, v24
    s_nop 1
    v_addc_co_u32 v25, vcc, 0, v25, vcc
    global_load_dword v22, v[24:25], off
m_ncp2:
    s_lshl_b32 s61, s16, 13
    s_add_u32 s62, s61, 98304
    s_cmp_ge_u32 s68, 16
    s_cbranch_scc1 m_typea4
    s_and_b32 s69, s68, 3
    s_and_b32 s90, s2, 1
    s_lshl_b32 s90, s90, 2
    s_add_u32 s69, s69, s90
    s_bfe_u32 s90, s2, 0x20001
    s_mul_i32 s90, s90, 4
    s_bfe_u32 s91, s68, 0x20002
    s_add_u32 s90, s90, s91
    s_mov_b32 s76, 8388608
    s_mov_b32 s78, 8192
    s_mov_b32 s81, 0
    s_mov_b32 s73, 4194304
    s_mov_b32 s77, 2048
    s_mov_b32 s82, 16
    s_lshl_b32 s80, s90, 9
    s_lshl_b32 s79, s69, 19
    s_lshl_b32 s88, s90, 4
    s_add_u32 s88, s88, s69
    s_lshl_b32 s88, s88, 3
    s_mov_b32 s83, 0
    s_mov_b32 s84, 1040356334
    s_lshl_b32 s91, s90, 1
    s_add_u32 s91, s91, s58
    s_lshl_b32 s91, s91, 19
    s_lshl_b32 s92, s69, 1
    s_add_u32 s92, s92, s57
    s_lshl_b32 s92, s92, 15
    s_add_u32 s85, s91, s92
    s_add_u32 s85, s85, 0
    s_mov_b32 s86, 1024
    s_mov_b32 s87, 4096
    s_branch m_go15
m_typea4:
    s_bfe_u32 s69, s68, 0x20002
    s_add_u32 s69, s69, 0
    s_and_b32 s90, s2, 7
    s_lshl_b32 s90, s90, 2
    s_and_b32 s91, s68, 3
    s_add_u32 s90, s90, s91
    s_cmp_lt_u32 s90, 16
    s_cselect_b32 s83, 0, 1
    s_mov_b32 s91, 33554432
    s_cselect_b32 s85, 16777216, s91
    s_mov_b32 s91, 8192
    s_cselect_b32 s86, 1024, s91
    s_mov_b32 s91, 1024
    s_cselect_b32 s87, 4096, s91
    s_mov_b32 s73, 2097152
    s_mov_b32 s77, 1024
    s_mov_b32 s82, 8
    s_mov_b32 s81, 0
    s_mov_b32 s76, 4194304
    s_mov_b32 s78, 8192
    s_mov_b32 s84, 0
    s_and_b32 s90, s90, 15
    s_lshl_b32 s80, s90, 9
    s_lshl_b32 s79, s69, 18
    s_lshl_b32 s91, s83, 2
    s_add_u32 s91, s91, s69
    s_cmp_ge_u32 s69, 4
    s_cselect_b32 s92, 508, 8
    s_add_u32 s91, s91, s92
    s_lshl_b32 s88, s90, 4
    s_add_u32 s88, s88, s91
    s_lshl_b32 s88, s88, 3
    s_lshl_b32 s91, s90, 1
    s_add_u32 s91, s91, s58
    s_lshl_b32 s91, s91, 19
    s_lshl_b32 s92, s69, 1
    s_add_u32 s92, s92, s57
    s_lshl_b32 s92, s92, 15
    s_add_u32 s85, s85, s91
    s_add_u32 s85, s85, s92
m_go15:
    s_mov_b32 s42, s73
    s_lshl_b32 s90, s77, 4
    s_lshl_b32 s90, s90, s81
    s_mov_b32 s48, s79
    s_mul_i32 s91, s90, 1
    s_add_u32 s49, s91, s79
    s_sub_u32 s49, s49, 2048
    s_mul_i32 s91, s90, 2
    s_add_u32 s50, s91, s79
    s_mul_i32 s91, s90, 3
    s_add_u32 s51, s91, s79
    s_sub_u32 s51, s51, 2048
    s_lshl_b32 s90, s58, 7
    s_add_u32 s90, s90, s57
    s_lshl_b32 s91, s16, 6
    s_cmp_eq_u32 s81, 1
    s_cselect_b32 s90, s90, s91
    v_lshrrev_b32 v24, 3, v1
    v_lshlrev_b32 v24, s81, v24
    v_add_u32 v24, s90, v24
    v_mul_lo_u32 v24, v24, s77
    v_lshrrev_b32 v25, 4, v1
    v_and_b32 v26, 7, v1
    v_xor_b32 v25, v25, v26
    v_lshl_add_u32 v16, v25, 4, v24
    v_xor_b32 v25, 4, v25
    v_lshl_add_u32 v17, v25, 4, v24
    s_lshl_b32 s90, s77, 3
    s_lshl_b32 s90, s90, s81
    s_sub_u32 s90, s90, 1024
    v_add_u32 v17, s90, v17
    s_mov_b32 s46, s76
    s_mov_b32 s52, s80
    s_lshl_b32 s90, s78, 2
    s_mul_i32 s91, s90, 1
    s_add_u32 s53, s91, s80
    s_sub_u32 s53, s53, 2048
    s_mul_i32 s91, s90, 2
    s_add_u32 s54, s91, s80
    s_mul_i32 s91, s90, 3
    s_add_u32 s55, s91, s80
    s_sub_u32 s55, s55, 2048
    s_lshl_b32 s56, s78, 6
    v_lshrrev_b32 v24, 5, v1
    s_lshl_b32 s90, s16, 4
    v_add_u32 v25, s90, v24
    v_mul_lo_u32 v25, v25, s78
    v_lshlrev_b32 v24, 1, v24
    v_and_b32 v26, 31, v1
    v_xor_b32 v24, v24, v26
    s_lshl_b32 s90, s78, 1
    s_sub_u32 s90, s90, 1024
    v_add_u32 v27, s90, v25
    v_xor_b32 v26, 0, v24
    v_lshl_add_u32 v18, v26, 4, v25
    v_xor_b32 v26, 4, v24
    v_lshl_add_u32 v19, v26, 4, v27
    v_xor_b32 v26, 8, v24
    v_lshl_add_u32 v20, v26, 4, v25
    v_xor_b32 v26, 12, v24
    v_lshl_add_u32 v21, v26, 4, v27
    s_cmp_eq_u32 s83, 0
    s_waitcnt lgkmcnt(0)
    s_cselect_b32 s44, s36, s38
    s_cselect_b32 s45, s37, s39
    s_cmp_lt_u32 s68, 16
    s_cselect_b32 s44, s34, s44
    s_cselect_b32 s45, s35, s45
    s_cselect_b32 s40, s30, s32
    s_cselect_b32 s41, s31, s33
    s_cmp_ge_u32 s68, 28
    s_cselect_b32 s70, 1, 0
    s_cbranch_scc1 m_pf7
m_nopf6:
    s_add_u32 m0, s61, 0
    s_nop 0
    buffer_load_dwordx4 v16, s[40:43], s48 offen offset:0 sc1 lds
    buffer_load_dwordx4 v17, s[40:43], s48 offen offset:1024 sc1 lds
    s_add_u32 s48, s48, 128
    buffer_load_dwordx4 v16, s[40:43], s49 offen offset:2048 sc1 lds
    buffer_load_dwordx4 v17, s[40:43], s49 offen offset:3072 sc1 lds
    s_add_u32 s49, s49, 128
    s_add_u32 m0, s61, 4096
    s_nop 0
    buffer_load_dwordx4 v16, s[40:43], s50 offen offset:0 sc1 lds
    buffer_load_dwordx4 v17, s[40:43], s50 offen offset:1024 sc1 lds
    s_add_u32 s50, s50, 128
    buffer_load_dwordx4 v16, s[40:43], s51 offen offset:2048 sc1 lds
    buffer_load_dwordx4 v17, s[40:43], s51 offen offset:3072 sc1 lds
    s_add_u32 s51, s51, 128
    s_add_u32 s61, s61, 32768
    s_cmp_ge_u32 s61, 98304
    s_cselect_b32 s90, 98304, 0
    s_sub_u32 s61, s61, s90
    s_add_u32 m0, s62, 0
    s_nop 0
    buffer_load_dwordx4 v18, s[44:47], s52 offen offset:0 sc1 lds
    buffer_load_dwordx4 v19, s[44:47], s52 offen offset:1024 sc1 lds
    s_add_u32 s52, s52, s56
    buffer_load_dwordx4 v18, s[44:47], s53 offen offset:2048 sc1 lds
    buffer_load_dwordx4 v19, s[44:47], s53 offen offset:3072 sc1 lds
    s_add_u32 s53, s53, s56
    s_add_u32 m0, s62, 4096
    s_nop 0
    buffer_load_dwordx4 v20, s[44:47], s54 offen offset:0 sc1 lds
    buffer_load_dwordx4 v21, s[44:47], s54 offen offset:1024 sc1 lds
    s_add_u32 s54, s54, s56
    buffer_load_dwordx4 v20, s[44:47], s55 offen offset:2048 sc1 lds
    buffer_load_dwordx4 v21, s[44:47], s55 offen offset:3072 sc1 lds
    s_add_u32 s55, s55, s56
    s_xor_b32 s62, s62, 229376
    s_mov_b32 s95, s82
    s_mov_b32 s96, s83
    s_mov_b32 s97, s84
    s_mov_b32 s98, s85
    s_mov_b32 s99, s86
    s_mov_b32 s100, s87
    s_mov_b32 s101, s88
    v_and_b32 v24, 15, v1
    v_lshrrev_b32 v25, 4, v1
    v_bfe_u32 v26, v1, 1, 3
    v_xor_b32 v26, v26, v25
    s_lshl_b32 s90, s57, 14
    v_lshlrev_b32 v27, 7, v24
    v_add_u32 v27, s90, v27
    v_xor_b32 v28, 0, v26
    v_lshl_add_u32 v6, v28, 4, v27
    v_xor_b32 v28, 4, v26
    v_lshl_add_u32 v7, v28, 4, v27
    v_bfe_u32 v26, v1, 2, 2
    v_lshl_add_u32 v27, v25, 3, v26
    v_lshlrev_b32 v27, 9, v27
    v_and_b32 v28, 3, v1
    v_lshlrev_b32 v28, 3, v28
    v_add_u32 v27, v27, v28
    s_lshl_b32 s90, s58, 8
    s_add_u32 s90, s90, 98304
    v_add_u32 v27, s90, v27
    v_bfe_u32 v26, v1, 2, 3
    v_xor_b32 v28, 0, v26
    v_lshl_add_u32 v8, v28, 5, v27
    v_xor_b32 v28, 1, v26
    v_lshl_add_u32 v9, v28, 5, v27
    v_xor_b32 v28, 2, v26
    v_lshl_add_u32 v10, v28, 5, v27
    v_xor_b32 v28, 3, v26
    v_lshl_add_u32 v11, v28, 5, v27
    v_xor_b32 v28, 4, v26
    v_lshl_add_u32 v12, v28, 5, v27
    v_xor_b32 v28, 5, v26
    v_lshl_add_u32 v13, v28, 5, v27
    v_xor_b32 v28, 6, v26
    v_lshl_add_u32 v14, v28, 5, v27
    v_xor_b32 v28, 7, v26
    v_lshl_add_u32 v15, v28, 5, v27
    v_lshlrev_b32 v2, 4, v1
    s_mov_b32 s64, 0
    s_mov_b32 s59, 32768
    s_mov_b32 s60, 229376
    s_mov_b32 s8, s6
    s_mov_b32 s9, s7
    s_mov_b32 s10, 268435456
    s_mov_b32 s11, 0x20000
    s_cmp_ge_u32 s68, 16
    s_cbranch_scc1 m_typea8
    s_bfe_u32 s69, s68, 0x20002
    s_add_u32 s69, s69, 4
    s_and_b32 s90, s2, 7
    s_lshl_b32 s90, s90, 2
    s_and_b32 s91, s68, 3
    s_add_u32 s90, s90, s91
    s_cmp_lt_u32 s90, 16
    s_cselect_b32 s83, 0, 1
    s_mov_b32 s91, 33554432
    s_cselect_b32 s85, 16777216, s91
    s_mov_b32 s91, 8192
    s_cselect_b32 s86, 1024, s91
    s_mov_b32 s91, 1024
    s_cselect_b32 s87, 4096, s91
    s_cselect_b32 s74, s36, s38
    s_cselect_b32 s75, s37, s39
    s_mov_b32 s71, s32
    s_mov_b32 s72, s33
    s_mov_b32 s73, 2097152
    s_mov_b32 s77, 1024
    s_mov_b32 s82, 8
    s_mov_b32 s81, 0
    s_mov_b32 s76, 4194304
    s_mov_b32 s78, 8192
    s_mov_b32 s84, 0
    s_and_b32 s90, s90, 15
    s_lshl_b32 s80, s90, 9
    s_lshl_b32 s79, s69, 18
    s_lshl_b32 s91, s83, 2
    s_add_u32 s91, s91, s69
    s_cmp_ge_u32 s69, 4
    s_cselect_b32 s92, 508, 8
    s_add_u32 s91, s91, s92
    s_lshl_b32 s88, s90, 4
    s_add_u32 s88, s88, s91
    s_lshl_b32 s88, s88, 3
    s_lshl_b32 s91, s90, 1
    s_add_u32 s91, s91, s58
    s_lshl_b32 s91, s91, 19
    s_lshl_b32 s92, s69, 1
    s_add_u32 s92, s92, s57
    s_lshl_b32 s92, s92, 15
    s_add_u32 s85, s85, s91
    s_add_u32 s85, s85, s92
    s_branch m_go29
m_typea8:
    s_and_b32 s69, s68, 3
    s_and_b32 s90, s2, 1
    s_lshl_b32 s90, s90, 2
    s_add_u32 s69, s69, s90
    s_bfe_u32 s90, s2, 0x20001
    s_mul_i32 s90, s90, 3
    s_bfe_u32 s91, s68, 0x20002
    s_add_u32 s90, s90, s91
    s_mov_b32 s76, 6291456
    s_mov_b32 s78, 6144
    s_mov_b32 s81, 1
    s_mov_b32 s73, 4194304
    s_mov_b32 s77, 2048
    s_mov_b32 s82, 16
    s_lshl_b32 s80, s90, 9
    s_lshl_b32 s79, s69, 19
    s_and_b32 s92, s90, 3
    s_lshr_b32 s91, s90, 2
    s_lshl_b32 s88, s92, 2
    s_add_u32 s88, s88, s91
    s_lshl_b32 s88, s88, 3
    s_add_u32 s88, s88, s69
    s_lshl_b32 s88, s88, 3
    s_add_u32 s88, s88, 6144
    s_cmp_eq_u32 s91, 0
    s_cselect_b32 s84, 1048744942, 0
    s_lshl_b32 s93, s91, 22
    s_add_u32 s85, s93, 50331648
    s_lshl_b32 s92, s92, 1
    s_add_u32 s92, s92, s58
    s_lshl_b32 s92, s92, 19
    s_add_u32 s85, s85, s92
    s_lshl_b32 s92, s57, 3
    s_add_u32 s92, s92, s69
    s_cmp_eq_u32 s91, 2
    s_cselect_b32 s83, 1, 0
    s_cselect_b32 s93, 12, 13
    s_mov_b32 s91, 131072
    s_cselect_b32 s86, 1024, s91
    s_mov_b32 s91, 1024
    s_cselect_b32 s87, 65536, s91
    s_lshl_b32 s92, s92, s93
    s_add_u32 s85, s85, s92
    s_mov_b32 s71, s24
    s_mov_b32 s72, s25
    s_mov_b32 s74, s26
    s_mov_b32 s75, s27
m_go29:
    s_xor_b32 s94, s70, 1
    s_add_u32 s67, s70, 3
    s_mov_b32 s17, -1
    s_mul_i32 s64, s70, 32768
    v_add_u32 v6, s64, v6
    v_add_u32 v7, s64, v7
    s_mov_b32 s12, s4
    s_mov_b32 s13, s5
    s_mov_b32 s14, 256
    s_mov_b32 s15, 0x20000
    s_lshl_b32 s90, s2, 2
    s_add_u32 s90, s90, s16
    s_cmp_lg_u32 s90, 0
    s_cbranch_scc1 m_tok10
    s_memrealtime s[92:93]
    s_waitcnt lgkmcnt(0)
    s_or_b32 s92, s92, 1
    v_mov_b32 v4, s92
    v_mov_b32 v5, s93
    s_mov_b64 exec, 1
    buffer_store_dwordx2 v[4:5], off, s[12:15], 0 sc1
    s_mov_b64 exec, -1
m_tok10:
    s_cmp_eq_u32 s70, 0
    s_cbranch_scc1 m_tok11
    buffer_load_dwordx2 v[4:5], off, s[12:15], 0 sc1
    s_waitcnt vmcnt(0)
    s_mov_b32 s3, 1048576
m_spin12:
    v_readfirstlane_b32 s4, v4
    v_readfirstlane_b32 s5, v5
    s_nop 3
    s_cmp_lg_u32 s4, 0
    s_cbranch_scc1 m_ok13
    s_sub_u32 s3, s3, 1
    s_cbranch_scc1 m_ok13
    s_sleep 32
    buffer_load_dwordx2 v[4:5], off, s[12:15], 0 sc1
    s_waitcnt vmcnt(0)
    s_branch m_spin12
m_ok13:
m_tok11:
    s_add_u32 m0, s61, 0
    s_nop 0
    buffer_load_dwordx4 v16, s[40:43], s48 offen offset:0 sc1 lds
    buffer_load_dwordx4 v17, s[40:43], s48 offen offset:1024 sc1 lds
    s_add_u32 s48, s48, 128
    buffer_load_dwordx4 v16, s[40:43], s49 offen offset:2048 sc1 lds
    buffer_load_dwordx4 v17, s[40:43], s49 offen offset:3072 sc1 lds
    s_add_u32 s49, s49, 128
    s_add_u32 m0, s61, 4096
    s_nop 0
    buffer_load_dwordx4 v16, s[40:43], s50 offen offset:0 sc1 lds
    buffer_load_dwordx4 v17, s[40:43], s50 offen offset:1024 sc1 lds
    s_add_u32 s50, s50, 128
    buffer_load_dwordx4 v16, s[40:43], s51 offen offset:2048 sc1 lds
    buffer_load_dwordx4 v17, s[40:43], s51 offen offset:3072 sc1 lds
    s_add_u32 s51, s51, 128
    s_add_u32 s61, s61, 32768
    s_cmp_ge_u32 s61, 98304
    s_cselect_b32 s90, 98304, 0
    s_sub_u32 s61, s61, s90
    s_add_u32 m0, s62, 0
    s_nop 0
    buffer_load_dwordx4 v18, s[44:47], s52 offen offset:0 sc1 lds
    buffer_load_dwordx4 v19, s[44:47], s52 offen offset:1024 sc1 lds
    s_add_u32 s52, s52, s56
    buffer_load_dwordx4 v18, s[44:47], s53 offen offset:2048 sc1 lds
    buffer_load_dwordx4 v19, s[44:47], s53 offen offset:3072 sc1 lds
    s_add_u32 s53, s53, s56
    s_add_u32 m0, s62, 4096
    s_nop 0
    buffer_load_dwordx4 v20, s[44:47], s54 offen offset:0 sc1 lds
    buffer_load_dwordx4 v21, s[44:47], s54 offen offset:1024 sc1 lds
    s_add_u32 s54, s54, s56
    buffer_load_dwordx4 v20, s[44:47], s55 offen offset:2048 sc1 lds
    buffer_load_dwordx4 v21, s[44:47], s55 offen offset:3072 sc1 lds
    s_add_u32 s55, s55, s56
    s_xor_b32 s62, s62, 229376
    s_waitcnt vmcnt(16)
    s_barrier
    ds_read_b64_tr_b16 a[64:65], v8 offset:0
    ds_read_b64_tr_b16 a[66:67], v8 offset:2048
    ds_read_b64_tr_b16 a[68:69], v8 offset:16384
    ds_read_b64_tr_b16 a[70:71], v8 offset:18432
    ds_read_b64_tr_b16 a[72:73], v9 offset:0
    ds_read_b64_tr_b16 a[74:75], v9 offset:2048
    ds_read_b64_tr_b16 a[76:77], v9 offset:16384
    ds_read_b64_tr_b16 a[78:79], v9 offset:18432
    ds_read_b64_tr_b16 a[80:81], v10 offset:0
    ds_read_b64_tr_b16 a[82:83], v10 offset:2048
    ds_read_b64_tr_b16 a[84:85], v10 offset:16384
    ds_read_b64_tr_b16 a[86:87], v10 offset:18432
    ds_read_b64_tr_b16 a[88:89], v11 offset:0
    ds_read_b64_tr_b16 a[90:91], v11 offset:2048
    ds_read_b64_tr_b16 a[92:93], v11 offset:16384
    ds_read_b64_tr_b16 a[94:95], v11 offset:18432
    ds_read_b64_tr_b16 a[96:97], v12 offset:0
    ds_read_b128 a[0:3], v6 offset:0
    ds_read_b128 a[4:7], v7 offset:0
    ds_read_b64_tr_b16 a[98:99], v12 offset:2048
    ds_read_b128 a[8:11], v6 offset:2048
    ds_read_b128 a[12:15], v7 offset:2048
    ds_read_b64_tr_b16 a[100:101], v12 offset:16384
    ds_read_b128 a[16:19], v6 offset:4096
    ds_read_b128 a[20:23], v7 offset:4096
    ds_read_b64_tr_b16 a[102:103], v12 offset:18432
    ds_read_b128 a[24:27], v6 offset:6144
    ds_read_b128 a[28:31], v7 offset:6144
    ds_read_b64_tr_b16 a[104:105], v13 offset:0
    ds_read_b128 a[32:35], v6 offset:8192
    ds_read_b128 a[36:39], v7 offset:8192
    ds_read_b64_tr_b16 a[106:107], v13 offset:2048
    ds_read_b128 a[40:43], v6 offset:10240
    ds_read_b128 a[44:47], v7 offset:10240
    ds_read_b64_tr_b16 a[108:109], v13 offset:16384
    ds_read_b128 a[48:51], v6 offset:12288
    ds_read_b128 a[52:55], v7 offset:12288
    ds_read_b64_tr_b16 a[110:111], v13 offset:18432
    ds_read_b128 a[56:59], v6 offset:14336
    ds_read_b128 a[60:63], v7 offset:14336
    s_add_u32 m0, s61, 0
    s_nop 0
    buffer_load_dwordx4 v16, s[40:43], s48 offen offset:0 sc1 lds
    buffer_load_dwordx4 v17, s[40:43], s48 offen offset:1024 sc1 lds
    s_add_u32 s48, s48, 128
    buffer_load_dwordx4 v16, s[40:43], s49 offen offset:2048 sc1 lds
    buffer_load_dwordx4 v17, s[40:43], s49 offen offset:3072 sc1 lds
    s_add_u32 s49, s49, 128
    s_add_u32 m0, s61, 4096
    s_nop 0
    buffer_load_dwordx4 v16, s[40:43], s50 offen offset:0 sc1 lds
    buffer_load_dwordx4 v17, s[40:43], s50 offen offset:1024 sc1 lds
    s_add_u32 s50, s50, 128
    buffer_load_dwordx4 v16, s[40:43], s51 offen offset:2048 sc1 lds
    buffer_load_dwordx4 v17, s[40:43], s51 offen offset:3072 sc1 lds
    s_add_u32 s51, s51, 128
    s_add_u32 s61, s61, 32768
    s_cmp_ge_u32 s61, 98304
    s_cselect_b32 s90, 98304, 0
    s_sub_u32 s61, s61, s90
    s_mov_b32 s66, 1
    s_mov_b32 s24, s6
    s_mov_b32 s25, s7
    s_mov_b32 s26, 0
    s_mov_b32 s27, 0x20000
    s_mov_b32 s28, 0
    s_mov_b32 s29, 0
    s_mov_b32 s30, 0
    s_mov_b32 s31, 0
m_tile14:
    s_mov_b32 s65, s95
    s_cmp_eq_u32 s96, 1
    s_cbranch_scc1 m_swp16
    s_waitcnt lgkmcnt(15)
    v_mfma_f32_16x16x32_bf16 v[32:35], a[64:67], a[0:3], 0
    ds_read_b64_tr_b16 a[112:113], v14 offset:0
    v_mfma_f32_16x16x32_bf16 v[32:35], a[68:71], a[4:7], v[32:35]
    ds_read_b64_tr_b16 a[114:115], v14 offset:2048
    v_mfma_f32_16x16x32_bf16 v[36:39], a[76:79], a[4:7], 0
    ds_read_b64_tr_b16 a[116:117], v14 offset:16384
    v_mfma_f32_16x16x32_bf16 v[36:39], a[72:75], a[0:3], v[36:39]
    ds_read_b64_tr_b16 a[118:119], v14 offset:18432
    v_mfma_f32_16x16x32_bf16 v[44:47], a[72:75], a[8:11], 0
    ds_read_b64_tr_b16 a[120:121], v15 offset:0
    v_mfma_f32_16x16x32_bf16 v[44:47], a[76:79], a[12:15], v[44:47]
    ds_read_b64_tr_b16 a[122:123], v15 offset:2048
    v_mfma_f32_16x16x32_bf16 v[40:43], a[68:71], a[12:15], 0
    ds_read_b64_tr_b16 a[124:125], v15 offset:16384
    v_mfma_f32_16x16x32_bf16 v[40:43], a[64:67], a[8:11], v[40:43]
    ds_read_b64_tr_b16 a[126:127], v15 offset:18432
    v_mfma_f32_16x16x32_bf16 v[48:51], a[64:67], a[16:19], 0
    v_mfma_f32_16x16x32_bf16 v[48:51], a[68:71], a[20:23], v[48:51]
    v_mfma_f32_16x16x32_bf16 v[52:55], a[76:79], a[20:23], 0
    buffer_store_dwordx4 a[128:131], v2, s[24:27], s28 offen sc1
    v_mfma_f32_16x16x32_bf16 v[52:55], a[72:75], a[16:19], v[52:55]
    s_add_u32 s28, s28, s31
    s_waitcnt lgkmcnt(15)
    v_mfma_f32_16x16x32_bf16 v[60:63], a[72:75], a[24:27], 0
    v_xor_b32 v8, s60, v8
    v_xor_b32 v9, s60, v9
    v_mfma_f32_16x16x32_bf16 v[60:63], a[76:79], a[28:31], v[60:63]
    v_xor_b32 v10, s60, v10
    v_xor_b32 v11, s60, v11
    v_mfma_f32_16x16x32_bf16 v[56:59], a[68:71], a[28:31], 0
    v_xor_b32 v12, s60, v12
    v_xor_b32 v13, s60, v13
    v_mfma_f32_16x16x32_bf16 v[56:59], a[64:67], a[24:27], v[56:59]
    v_xor_b32 v14, s60, v14
    v_xor_b32 v15, s60, v15
    v_mfma_f32_16x16x32_bf16 v[64:67], a[64:67], a[32:35], 0
    buffer_store_dwordx4 a[132:135], v2, s[24:27], s28 offen sc1
    v_mfma_f32_16x16x32_bf16 v[64:67], a[68:71], a[36:39], v[64:67]
    s_add_u32 s28, s28, s31
    v_mfma_f32_16x16x32_bf16 v[68:71], a[76:79], a[36:39], 0
    v_mfma_f32_16x16x32_bf16 v[68:71], a[72:75], a[32:35], v[68:71]
    s_waitcnt lgkmcnt(14)
    v_mfma_f32_16x16x32_bf16 v[76:79], a[72:75], a[40:43], 0
    v_mfma_f32_16x16x32_bf16 v[76:79], a[76:79], a[44:47], v[76:79]
    v_mfma_f32_16x16x32_bf16 v[72:75], a[68:71], a[44:47], 0
    buffer_store_dwordx4 a[136:139], v2, s[24:27], s28 offen sc1
    v_mfma_f32_16x16x32_bf16 v[72:75], a[64:67], a[40:43], v[72:75]
    s_add_u32 s28, s28, s31
    s_waitcnt lgkmcnt(11)
    v_mfma_f32_16x16x32_bf16 v[80:83], a[64:67], a[48:51], 0
    v_mfma_f32_16x16x32_bf16 v[80:83], a[68:71], a[52:55], v[80:83]
    v_mfma_f32_16x16x32_bf16 v[84:87], a[76:79], a[52:55], 0
    v_mfma_f32_16x16x32_bf16 v[84:87], a[72:75], a[48:51], v[84:87]
    s_waitcnt lgkmcnt(8)
    v_mfma_f32_16x16x32_bf16 v[92:95], a[72:75], a[56:59], 0
    buffer_store_dwordx4 a[140:143], v2, s[24:27], s28 offen sc1
    v_mfma_f32_16x16x32_bf16 v[92:95], a[76:79], a[60:63], v[92:95]
    s_add_u32 s28, s28, s31
    v_mfma_f32_16x16x32_bf16 v[88:91], a[68:71], a[60:63], 0
    s_waitcnt vmcnt(44) lgkmcnt(0)
    s_cmp_eq_u32 s66, 2
    s_cbranch_scc1 m_w17
    s_waitcnt vmcnt(12)
m_w17:
    v_mfma_f32_16x16x32_bf16 v[88:91], a[64:67], a[56:59], v[88:91]
    s_barrier
    v_mfma_f32_16x16x32_bf16 v[96:99], a[80:83], a[0:3], 0
    ds_read_b64_tr_b16 a[64:65], v8 offset:0
    v_mfma_f32_16x16x32_bf16 v[96:99], a[84:87], a[4:7], v[96:99]
    s_add_u32 m0, s62, 0
    v_mfma_f32_16x16x32_bf16 v[100:103], a[92:95], a[4:7], 0
    buffer_load_dwordx4 v18, s[44:47], s52 offen offset:0 sc1 lds
    v_mfma_f32_16x16x32_bf16 v[100:103], a[88:91], a[0:3], v[100:103]
    ds_read_b64_tr_b16 a[66:67], v8 offset:2048
    v_mfma_f32_16x16x32_bf16 v[108:111], a[88:91], a[8:11], 0
    s_add_u32 s64, s64, 32768
    v_mfma_f32_16x16x32_bf16 v[108:111], a[92:95], a[12:15], v[108:111]
    s_cmp_ge_u32 s64, 98304
    s_cselect_b32 s63, 4294901760, s59
    s_cselect_b32 s64, 0, s64
    v_mfma_f32_16x16x32_bf16 v[104:107], a[84:87], a[12:15], 0
    buffer_load_dwordx4 v19, s[44:47], s52 offen offset:1024 sc1 lds
    v_mfma_f32_16x16x32_bf16 v[104:107], a[80:83], a[8:11], v[104:107]
    s_add_u32 s52, s52, s56
    ds_read_b64_tr_b16 a[68:69], v8 offset:16384
    v_mfma_f32_16x16x32_bf16 v[112:115], a[80:83], a[16:19], 0
    v_mfma_f32_16x16x32_bf16 v[112:115], a[84:87], a[20:23], v[112:115]
    v_mfma_f32_16x16x32_bf16 v[116:119], a[92:95], a[20:23], 0
    buffer_load_dwordx4 v18, s[44:47], s53 offen offset:2048 sc1 lds
    v_mfma_f32_16x16x32_bf16 v[116:119], a[88:91], a[16:19], v[116:119]
    ds_read_b64_tr_b16 a[70:71], v8 offset:18432
    v_mfma_f32_16x16x32_bf16 v[124:127], a[88:91], a[24:27], 0
    v_mfma_f32_16x16x32_bf16 v[124:127], a[92:95], a[28:31], v[124:127]
    v_mfma_f32_16x16x32_bf16 v[120:123], a[84:87], a[28:31], 0
    buffer_load_dwordx4 v19, s[44:47], s53 offen offset:3072 sc1 lds
    v_mfma_f32_16x16x32_bf16 v[120:123], a[80:83], a[24:27], v[120:123]
    s_add_u32 s53, s53, s56
    ds_read_b64_tr_b16 a[72:73], v9 offset:0
    v_mfma_f32_16x16x32_bf16 v[128:131], a[80:83], a[32:35], 0
    v_mfma_f32_16x16x32_bf16 v[128:131], a[84:87], a[36:39], v[128:131]
    s_add_u32 m0, s62, 4096
    v_mfma_f32_16x16x32_bf16 v[132:135], a[92:95], a[36:39], 0
    buffer_load_dwordx4 v20, s[44:47], s54 offen offset:0 sc1 lds
    v_mfma_f32_16x16x32_bf16 v[132:135], a[88:91], a[32:35], v[132:135]
    s_xor_b32 s62, s62, 229376
    ds_read_b64_tr_b16 a[74:75], v9 offset:2048
    v_mfma_f32_16x16x32_bf16 v[140:143], a[88:91], a[40:43], 0
    v_mfma_f32_16x16x32_bf16 v[140:143], a[92:95], a[44:47], v[140:143]
    v_mfma_f32_16x16x32_bf16 v[136:139], a[84:87], a[44:47], 0
    buffer_load_dwordx4 v21, s[44:47], s54 offen offset:1024 sc1 lds
    v_mfma_f32_16x16x32_bf16 v[136:139], a[80:83], a[40:43], v[136:139]
    s_add_u32 s54, s54, s56
    ds_read_b64_tr_b16 a[76:77], v9 offset:16384
    v_mfma_f32_16x16x32_bf16 v[144:147], a[80:83], a[48:51], 0
    v_mfma_f32_16x16x32_bf16 v[144:147], a[84:87], a[52:55], v[144:147]
    v_mfma_f32_16x16x32_bf16 v[148:151], a[92:95], a[52:55], 0
    buffer_load_dwordx4 v20, s[44:47], s55 offen offset:2048 sc1 lds
    v_mfma_f32_16x16x32_bf16 v[148:151], a[88:91], a[48:51], v[148:151]
    ds_read_b64_tr_b16 a[78:79], v9 offset:18432
    v_mfma_f32_16x16x32_bf16 v[156:159], a[88:91], a[56:59], 0
    v_add_u32 v6, s63, v6
    v_add_u32 v7, s63, v7
    v_mfma_f32_16x16x32_bf16 v[156:159], a[92:95], a[60:63], v[156:159]
    v_mfma_f32_16x16x32_bf16 v[152:155], a[84:87], a[60:63], 0
    buffer_load_dwordx4 v21, s[44:47], s55 offen offset:3072 sc1 lds
    v_mfma_f32_16x16x32_bf16 v[152:155], a[80:83], a[56:59], v[152:155]
    s_add_u32 s55, s55, s56
    v_mfma_f32_16x16x32_bf16 v[160:163], a[96:99], a[0:3], 0
    ds_read_b64_tr_b16 a[80:81], v10 offset:0
    v_mfma_f32_16x16x32_bf16 v[160:163], a[100:103], a[4:7], v[160:163]
    v_mfma_f32_16x16x32_bf16 v[164:167], a[108:111], a[4:7], 0
    v_mfma_f32_16x16x32_bf16 v[164:167], a[104:107], a[0:3], v[164:167]
    s_add_u32 m0, s61, 0
    ds_read_b64_tr_b16 a[82:83], v10 offset:2048
    v_mfma_f32_16x16x32_bf16 v[172:175], a[104:107], a[8:11], 0
    buffer_load_dwordx4 v16, s[40:43], s48 offen offset:0 sc1 lds
    v_mfma_f32_16x16x32_bf16 v[172:175], a[108:111], a[12:15], v[172:175]
    v_mfma_f32_16x16x32_bf16 v[168:171], a[100:103], a[12:15], 0
    ds_read_b64_tr_b16 a[84:85], v10 offset:16384
    v_mfma_f32_16x16x32_bf16 v[168:171], a[96:99], a[8:11], v[168:171]
    v_mfma_f32_16x16x32_bf16 v[176:179], a[96:99], a[16:19], 0
    buffer_store_dwordx4 a[144:147], v2, s[24:27], s28 offen sc1
    v_mfma_f32_16x16x32_bf16 v[176:179], a[100:103], a[20:23], v[176:179]
    s_add_u32 s28, s28, s31
    ds_read_b64_tr_b16 a[86:87], v10 offset:18432
    v_mfma_f32_16x16x32_bf16 v[180:183], a[108:111], a[20:23], 0
    v_mfma_f32_16x16x32_bf16 v[180:183], a[104:107], a[16:19], v[180:183]
    v_mfma_f32_16x16x32_bf16 v[188:191], a[104:107], a[24:27], 0
    buffer_load_dwordx4 v17, s[40:43], s48 offen offset:1024 sc1 lds
    v_mfma_f32_16x16x32_bf16 v[188:191], a[108:111], a[28:31], v[188:191]
    s_add_u32 s48, s48, 128
    ds_read_b64_tr_b16 a[88:89], v11 offset:0
    v_mfma_f32_16x16x32_bf16 v[184:187], a[100:103], a[28:31], 0
    v_mfma_f32_16x16x32_bf16 v[184:187], a[96:99], a[24:27], v[184:187]
    v_mfma_f32_16x16x32_bf16 v[192:195], a[96:99], a[32:35], 0
    buffer_store_dwordx4 a[148:151], v2, s[24:27], s28 offen sc1
    v_mfma_f32_16x16x32_bf16 v[192:195], a[100:103], a[36:39], v[192:195]
    s_add_u32 s28, s28, s31
    ds_read_b64_tr_b16 a[90:91], v11 offset:2048
    v_mfma_f32_16x16x32_bf16 v[196:199], a[108:111], a[36:39], 0
    v_mfma_f32_16x16x32_bf16 v[196:199], a[104:107], a[32:35], v[196:199]
    v_mfma_f32_16x16x32_bf16 v[204:207], a[104:107], a[40:43], 0
    buffer_load_dwordx4 v16, s[40:43], s49 offen offset:2048 sc1 lds
    v_mfma_f32_16x16x32_bf16 v[204:207], a[108:111], a[44:47], v[204:207]
    ds_read_b64_tr_b16 a[92:93], v11 offset:16384
    v_mfma_f32_16x16x32_bf16 v[200:203], a[100:103], a[44:47], 0
    v_mfma_f32_16x16x32_bf16 v[200:203], a[96:99], a[40:43], v[200:203]
    v_mfma_f32_16x16x32_bf16 v[208:211], a[96:99], a[48:51], 0
    buffer_store_dwordx4 a[152:155], v2, s[24:27], s28 offen sc1
    v_mfma_f32_16x16x32_bf16 v[208:211], a[100:103], a[52:55], v[208:211]
    s_add_u32 s28, s28, s31
    ds_read_b64_tr_b16 a[94:95], v11 offset:18432
    v_mfma_f32_16x16x32_bf16 v[212:215], a[108:111], a[52:55], 0
    v_mfma_f32_16x16x32_bf16 v[212:215], a[104:107], a[48:51], v[212:215]
    v_mfma_f32_16x16x32_bf16 v[220:223], a[104:107], a[56:59], 0
    buffer_load_dwordx4 v17, s[40:43], s49 offen offset:3072 sc1 lds
    v_mfma_f32_16x16x32_bf16 v[220:223], a[108:111], a[60:63], v[220:223]
    s_add_u32 s49, s49, 128
    v_mfma_f32_16x16x32_bf16 v[216:219], a[100:103], a[60:63], 0
    buffer_store_dwordx4 a[156:159], v2, s[24:27], s28 offen sc1
    v_mfma_f32_16x16x32_bf16 v[216:219], a[96:99], a[56:59], v[216:219]
    s_add_u32 s29, s29, s30
    s_mov_b32 s28, s29
    v_mfma_f32_16x16x32_bf16 v[224:227], a[112:115], a[0:3], 0
    v_mfma_f32_16x16x32_bf16 v[224:227], a[116:119], a[4:7], v[224:227]
    ds_read_b64_tr_b16 a[96:97], v12 offset:0
    v_mfma_f32_16x16x32_bf16 v[228:231], a[124:127], a[4:7], 0
    v_mfma_f32_16x16x32_bf16 v[228:231], a[120:123], a[0:3], v[228:231]
    s_add_u32 m0, s61, 4096
    ds_read_b128 a[0:3], v6 offset:0
    v_mfma_f32_16x16x32_bf16 v[236:239], a[120:123], a[8:11], 0
    buffer_load_dwordx4 v16, s[40:43], s50 offen offset:0 sc1 lds
    v_mfma_f32_16x16x32_bf16 v[236:239], a[124:127], a[12:15], v[236:239]
    s_add_u32 s61, s61, 32768
    ds_read_b128 a[4:7], v7 offset:0
    v_mfma_f32_16x16x32_bf16 v[232:235], a[116:119], a[12:15], 0
    s_cmp_ge_u32 s61, 98304
    s_cselect_b32 s90, 98304, 0
    ds_read_b64_tr_b16 a[98:99], v12 offset:2048
    v_mfma_f32_16x16x32_bf16 v[232:235], a[112:115], a[8:11], v[232:235]
    s_sub_u32 s61, s61, s90
    ds_read_b128 a[8:11], v6 offset:2048
    v_mfma_f32_16x16x32_bf16 v[240:243], a[112:115], a[16:19], 0
    ds_read_b128 a[12:15], v7 offset:2048
    v_mfma_f32_16x16x32_bf16 v[240:243], a[116:119], a[20:23], v[240:243]
    ds_read_b64_tr_b16 a[100:101], v12 offset:16384
    v_mfma_f32_16x16x32_bf16 v[244:247], a[124:127], a[20:23], 0
    v_mfma_f32_16x16x32_bf16 v[244:247], a[120:123], a[16:19], v[244:247]
    ds_read_b128 a[16:19], v6 offset:4096
    v_mfma_f32_16x16x32_bf16 v[252:255], a[120:123], a[24:27], 0
    buffer_load_dwordx4 v17, s[40:43], s50 offen offset:1024 sc1 lds
    v_mfma_f32_16x16x32_bf16 v[252:255], a[124:127], a[28:31], v[252:255]
    s_add_u32 s50, s50, 128
    ds_read_b128 a[20:23], v7 offset:4096
    v_mfma_f32_16x16x32_bf16 v[248:251], a[116:119], a[28:31], 0
    ds_read_b64_tr_b16 a[102:103], v12 offset:18432
    v_mfma_f32_16x16x32_bf16 v[248:251], a[112:115], a[24:27], v[248:251]
    ds_read_b128 a[24:27], v6 offset:6144
    v_mfma_f32_16x16x32_bf16 a[224:227], a[112:115], a[32:35], 0
    s_sub_u32 s65, s65, 1
    ds_read_b128 a[28:31], v7 offset:6144
    v_mfma_f32_16x16x32_bf16 a[224:227], a[116:119], a[36:39], a[224:227]
    ds_read_b64_tr_b16 a[104:105], v13 offset:0
    v_mfma_f32_16x16x32_bf16 a[228:231], a[124:127], a[36:39], 0
    v_mfma_f32_16x16x32_bf16 a[228:231], a[120:123], a[32:35], a[228:231]
    ds_read_b128 a[32:35], v6 offset:8192
    v_mfma_f32_16x16x32_bf16 a[236:239], a[120:123], a[40:43], 0
    buffer_load_dwordx4 v16, s[40:43], s51 offen offset:2048 sc1 lds
    v_mfma_f32_16x16x32_bf16 a[236:239], a[124:127], a[44:47], a[236:239]
    ds_read_b128 a[36:39], v7 offset:8192
    v_mfma_f32_16x16x32_bf16 a[232:235], a[116:119], a[44:47], 0
    ds_read_b64_tr_b16 a[106:107], v13 offset:2048
    v_mfma_f32_16x16x32_bf16 a[232:235], a[112:115], a[40:43], a[232:235]
    ds_read_b128 a[40:43], v6 offset:10240
    v_mfma_f32_16x16x32_bf16 a[240:243], a[112:115], a[48:51], 0
    ds_read_b128 a[44:47], v7 offset:10240
    v_mfma_f32_16x16x32_bf16 a[240:243], a[116:119], a[52:55], a[240:243]
    ds_read_b64_tr_b16 a[108:109], v13 offset:16384
    v_mfma_f32_16x16x32_bf16 a[244:247], a[124:127], a[52:55], 0
    v_mfma_f32_16x16x32_bf16 a[244:247], a[120:123], a[48:51], a[244:247]
    ds_read_b128 a[48:51], v6 offset:12288
    v_mfma_f32_16x16x32_bf16 a[252:255], a[120:123], a[56:59], 0
    buffer_load_dwordx4 v17, s[40:43], s51 offen offset:3072 sc1 lds
    v_mfma_f32_16x16x32_bf16 a[252:255], a[124:127], a[60:63], a[252:255]
    s_add_u32 s51, s51, 128
    ds_read_b128 a[52:55], v7 offset:12288
    v_mfma_f32_16x16x32_bf16 a[248:251], a[116:119], a[60:63], 0
    ds_read_b64_tr_b16 a[110:111], v13 offset:18432
    v_mfma_f32_16x16x32_bf16 a[248:251], a[112:115], a[56:59], a[248:251]
    ds_read_b128 a[56:59], v6 offset:14336
    ds_read_b128 a[60:63], v7 offset:14336
    s_waitcnt lgkmcnt(15)
    v_mfma_f32_16x16x32_bf16 v[32:35], a[64:67], a[0:3], v[32:35]
    ds_read_b64_tr_b16 a[112:113], v14 offset:0
    v_mfma_f32_16x16x32_bf16 v[32:35], a[68:71], a[4:7], v[32:35]
    ds_read_b64_tr_b16 a[114:115], v14 offset:2048
    v_mfma_f32_16x16x32_bf16 v[36:39], a[76:79], a[4:7], v[36:39]
    ds_read_b64_tr_b16 a[116:117], v14 offset:16384
    v_mfma_f32_16x16x32_bf16 v[36:39], a[72:75], a[0:3], v[36:39]
    ds_read_b64_tr_b16 a[118:119], v14 offset:18432
    v_mfma_f32_16x16x32_bf16 v[44:47], a[72:75], a[8:11], v[44:47]
    ds_read_b64_tr_b16 a[120:121], v15 offset:0
    v_mfma_f32_16x16x32_bf16 v[44:47], a[76:79], a[12:15], v[44:47]
    ds_read_b64_tr_b16 a[122:123], v15 offset:2048
    v_mfma_f32_16x16x32_bf16 v[40:43], a[68:71], a[12:15], v[40:43]
    ds_read_b64_tr_b16 a[124:125], v15 offset:16384
    v_mfma_f32_16x16x32_bf16 v[40:43], a[64:67], a[8:11], v[40:43]
    ds_read_b64_tr_b16 a[126:127], v15 offset:18432
    v_mfma_f32_16x16x32_bf16 v[48:51], a[64:67], a[16:19], v[48:51]
    v_mfma_f32_16x16x32_bf16 v[48:51], a[68:71], a[20:23], v[48:51]
    v_mfma_f32_16x16x32_bf16 v[52:55], a[76:79], a[20:23], v[52:55]
    buffer_store_dwordx4 a[160:163], v2, s[24:27], s28 offen sc1
    v_mfma_f32_16x16x32_bf16 v[52:55], a[72:75], a[16:19], v[52:55]
    s_add_u32 s28, s28, s31
    s_waitcnt lgkmcnt(15)
    v_mfma_f32_16x16x32_bf16 v[60:63], a[72:75], a[24:27], v[60:63]
    v_xor_b32 v8, s60, v8
    v_xor_b32 v9, s60, v9
    v_mfma_f32_16x16x32_bf16 v[60:63], a[76:79], a[28:31], v[60:63]
    v_xor_b32 v10, s60, v10
    v_xor_b32 v11, s60, v11
    v_mfma_f32_16x16x32_bf16 v[56:59], a[68:71], a[28:31], v[56:59]
    v_xor_b32 v12, s60, v12
    v_xor_b32 v13, s60, v13
    v_mfma_f32_16x16x32_bf16 v[56:59], a[64:67], a[24:27], v[56:59]
    v_xor_b32 v14, s60, v14
    v_xor_b32 v15, s60, v15
    v_mfma_f32_16x16x32_bf16 v[64:67], a[64:67], a[32:35], v[64:67]
    buffer_store_dwordx4 a[164:167], v2, s[24:27], s28 offen sc1
    v_mfma_f32_16x16x32_bf16 v[64:67], a[68:71], a[36:39], v[64:67]
    s_add_u32 s28, s28, s31
    v_mfma_f32_16x16x32_bf16 v[68:71], a[76:79], a[36:39], v[68:71]
    v_mfma_f32_16x16x32_bf16 v[68:71], a[72:75], a[32:35], v[68:71]
    s_waitcnt lgkmcnt(14)
    v_mfma_f32_16x16x32_bf16 v[76:79], a[72:75], a[40:43], v[76:79]
    v_mfma_f32_16x16x32_bf16 v[76:79], a[76:79], a[44:47], v[76:79]
    v_mfma_f32_16x16x32_bf16 v[72:75], a[68:71], a[44:47], v[72:75]
    buffer_store_dwordx4 a[168:171], v2, s[24:27], s28 offen sc1
    v_mfma_f32_16x16x32_bf16 v[72:75], a[64:67], a[40:43], v[72:75]
    s_add_u32 s28, s28, s31
    s_waitcnt lgkmcnt(11)
    v_mfma_f32_16x16x32_bf16 v[80:83], a[64:67], a[48:51], v[80:83]
    v_mfma_f32_16x16x32_bf16 v[80:83], a[68:71], a[52:55], v[80:83]
    v_mfma_f32_16x16x32_bf16 v[84:87], a[76:79], a[52:55], v[84:87]
    v_mfma_f32_16x16x32_bf16 v[84:87], a[72:75], a[48:51], v[84:87]
    s_waitcnt lgkmcnt(8)
    v_mfma_f32_16x16x32_bf16 v[92:95], a[72:75], a[56:59], v[92:95]
    buffer_store_dwordx4 a[172:175], v2, s[24:27], s28 offen sc1
    v_mfma_f32_16x16x32_bf16 v[92:95], a[76:79], a[60:63], v[92:95]
    s_add_u32 s28, s28, s31
    v_mfma_f32_16x16x32_bf16 v[88:91], a[68:71], a[60:63], v[88:91]
    s_waitcnt vmcnt(16) lgkmcnt(0)
    v_mfma_f32_16x16x32_bf16 v[88:91], a[64:67], a[56:59], v[88:91]
    s_barrier
    v_mfma_f32_16x16x32_bf16 v[96:99], a[80:83], a[0:3], v[96:99]
    ds_read_b64_tr_b16 a[64:65], v8 offset:0
    v_mfma_f32_16x16x32_bf16 v[96:99], a[84:87], a[4:7], v[96:99]
    s_add_u32 m0, s62, 0
    v_mfma_f32_16x16x32_bf16 v[100:103], a[92:95], a[4:7], v[100:103]
    buffer_load_dwordx4 v18, s[44:47], s52 offen offset:0 sc1 lds
    v_mfma_f32_16x16x32_bf16 v[100:103], a[88:91], a[0:3], v[100:103]
    ds_read_b64_tr_b16 a[66:67], v8 offset:2048
    v_mfma_f32_16x16x32_bf16 v[108:111], a[88:91], a[8:11], v[108:111]
    s_add_u32 s64, s64, 32768
    v_mfma_f32_16x16x32_bf16 v[108:111], a[92:95], a[12:15], v[108:111]
    s_cmp_ge_u32 s64, 98304
    s_cselect_b32 s63, 4294901760, s59
    s_cselect_b32 s64, 0, s64
    v_mfma_f32_16x16x32_bf16 v[104:107], a[84:87], a[12:15], v[104:107]
    buffer_load_dwordx4 v19, s[44:47], s52 offen offset:1024 sc1 lds
    v_mfma_f32_16x16x32_bf16 v[104:107], a[80:83], a[8:11], v[104:107]
    s_add_u32 s52, s52, s56
    ds_read_b64_tr_b16 a[68:69], v8 offset:16384
    v_mfma_f32_16x16x32_bf16 v[112:115], a[80:83], a[16:19], v[112:115]
    v_mfma_f32_16x16x32_bf16 v[112:115], a[84:87], a[20:23], v[112:115]
    v_mfma_f32_16x16x32_bf16 v[116:119], a[92:95], a[20:23], v[116:119]
    buffer_load_dwordx4 v18, s[44:47], s53 offen offset:2048 sc1 lds
    v_mfma_f32_16x16x32_bf16 v[116:119], a[88:91], a[16:19], v[116:119]
    ds_read_b64_tr_b16 a[70:71], v8 offset:18432
    v_mfma_f32_16x16x32_bf16 v[124:127], a[88:91], a[24:27], v[124:127]
    v_mfma_f32_16x16x32_bf16 v[124:127], a[92:95], a[28:31], v[124:127]
    v_mfma_f32_16x16x32_bf16 v[120:123], a[84:87], a[28:31], v[120:123]
    buffer_load_dwordx4 v19, s[44:47], s53 offen offset:3072 sc1 lds
    v_mfma_f32_16x16x32_bf16 v[120:123], a[80:83], a[24:27], v[120:123]
    s_add_u32 s53, s53, s56
    ds_read_b64_tr_b16 a[72:73], v9 offset:0
    v_mfma_f32_16x16x32_bf16 v[128:131], a[80:83], a[32:35], v[128:131]
    v_mfma_f32_16x16x32_bf16 v[128:131], a[84:87], a[36:39], v[128:131]
    s_add_u32 m0, s62, 4096
    v_mfma_f32_16x16x32_bf16 v[132:135], a[92:95], a[36:39], v[132:135]
    buffer_load_dwordx4 v20, s[44:47], s54 offen offset:0 sc1 lds
    v_mfma_f32_16x16x32_bf16 v[132:135], a[88:91], a[32:35], v[132:135]
    s_xor_b32 s62, s62, 229376
    ds_read_b64_tr_b16 a[74:75], v9 offset:2048
    v_mfma_f32_16x16x32_bf16 v[140:143], a[88:91], a[40:43], v[140:143]
    v_mfma_f32_16x16x32_bf16 v[140:143], a[92:95], a[44:47], v[140:143]
    v_mfma_f32_16x16x32_bf16 v[136:139], a[84:87], a[44:47], v[136:139]
    buffer_load_dwordx4 v21, s[44:47], s54 offen offset:1024 sc1 lds
    v_mfma_f32_16x16x32_bf16 v[136:139], a[80:83], a[40:43], v[136:139]
    s_add_u32 s54, s54, s56
    ds_read_b64_tr_b16 a[76:77], v9 offset:16384
    v_mfma_f32_16x16x32_bf16 v[144:147], a[80:83], a[48:51], v[144:147]
    v_mfma_f32_16x16x32_bf16 v[144:147], a[84:87], a[52:55], v[144:147]
    v_mfma_f32_16x16x32_bf16 v[148:151], a[92:95], a[52:55], v[148:151]
    buffer_load_dwordx4 v20, s[44:47], s55 offen offset:2048 sc1 lds
    v_mfma_f32_16x16x32_bf16 v[148:151], a[88:91], a[48:51], v[148:151]
    ds_read_b64_tr_b16 a[78:79], v9 offset:18432
    v_mfma_f32_16x16x32_bf16 v[156:159], a[88:91], a[56:59], v[156:159]
    v_add_u32 v6, s63, v6
    v_add_u32 v7, s63, v7
    v_mfma_f32_16x16x32_bf16 v[156:159], a[92:95], a[60:63], v[156:159]
    v_mfma_f32_16x16x32_bf16 v[152:155], a[84:87], a[60:63], v[152:155]
    buffer_load_dwordx4 v21, s[44:47], s55 offen offset:3072 sc1 lds
    v_mfma_f32_16x16x32_bf16 v[152:155], a[80:83], a[56:59], v[152:155]
    s_add_u32 s55, s55, s56
    v_mfma_f32_16x16x32_bf16 v[160:163], a[96:99], a[0:3], v[160:163]
    ds_read_b64_tr_b16 a[80:81], v10 offset:0
    v_mfma_f32_16x16x32_bf16 v[160:163], a[100:103], a[4:7], v[160:163]
    v_mfma_f32_16x16x32_bf16 v[164:167], a[108:111], a[4:7], v[164:167]
    v_mfma_f32_16x16x32_bf16 v[164:167], a[104:107], a[0:3], v[164:167]
    s_add_u32 m0, s61, 0
    ds_read_b64_tr_b16 a[82:83], v10 offset:2048
    v_mfma_f32_16x16x32_bf16 v[172:175], a[104:107], a[8:11], v[172:175]
    buffer_load_dwordx4 v16, s[40:43], s48 offen offset:0 sc1 lds
    v_mfma_f32_16x16x32_bf16 v[172:175], a[108:111], a[12:15], v[172:175]
    v_mfma_f32_16x16x32_bf16 v[168:171], a[100:103], a[12:15], v[168:171]
    ds_read_b64_tr_b16 a[84:85], v10 offset:16384
    v_mfma_f32_16x16x32_bf16 v[168:171], a[96:99], a[8:11], v[168:171]
    v_mfma_f32_16x16x32_bf16 v[176:179], a[96:99], a[16:19], v[176:179]
    buffer_store_dwordx4 a[176:179], v2, s[24:27], s28 offen sc1
    v_mfma_f32_16x16x32_bf16 v[176:179], a[100:103], a[20:23], v[176:179]
    s_add_u32 s28, s28, s31
    ds_read_b64_tr_b16 a[86:87], v10 offset:18432
    v_mfma_f32_16x16x32_bf16 v[180:183], a[108:111], a[20:23], v[180:183]
    v_mfma_f32_16x16x32_bf16 v[180:183], a[104:107], a[16:19], v[180:183]
    v_mfma_f32_16x16x32_bf16 v[188:191], a[104:107], a[24:27], v[188:191]
    buffer_load_dwordx4 v17, s[40:43], s48 offen offset:1024 sc1 lds
    v_mfma_f32_16x16x32_bf16 v[188:191], a[108:111], a[28:31], v[188:191]
    s_add_u32 s48, s48, 128
    ds_read_b64_tr_b16 a[88:89], v11 offset:0
    v_mfma_f32_16x16x32_bf16 v[184:187], a[100:103], a[28:31], v[184:187]
    v_mfma_f32_16x16x32_bf16 v[184:187], a[96:99], a[24:27], v[184:187]
    v_mfma_f32_16x16x32_bf16 v[192:195], a[96:99], a[32:35], v[192:195]
    buffer_store_dwordx4 a[180:183], v2, s[24:27], s28 offen sc1
    v_mfma_f32_16x16x32_bf16 v[192:195], a[100:103], a[36:39], v[192:195]
    s_add_u32 s28, s28, s31
    ds_read_b64_tr_b16 a[90:91], v11 offset:2048
    v_mfma_f32_16x16x32_bf16 v[196:199], a[108:111], a[36:39], v[196:199]
    v_mfma_f32_16x16x32_bf16 v[196:199], a[104:107], a[32:35], v[196:199]
    v_mfma_f32_16x16x32_bf16 v[204:207], a[104:107], a[40:43], v[204:207]
    buffer_load_dwordx4 v16, s[40:43], s49 offen offset:2048 sc1 lds
    v_mfma_f32_16x16x32_bf16 v[204:207], a[108:111], a[44:47], v[204:207]
    ds_read_b64_tr_b16 a[92:93], v11 offset:16384
    v_mfma_f32_16x16x32_bf16 v[200:203], a[100:103], a[44:47], v[200:203]
    v_mfma_f32_16x16x32_bf16 v[200:203], a[96:99], a[40:43], v[200:203]
    v_mfma_f32_16x16x32_bf16 v[208:211], a[96:99], a[48:51], v[208:211]
    buffer_store_dwordx4 a[184:187], v2, s[24:27], s28 offen sc1
    v_mfma_f32_16x16x32_bf16 v[208:211], a[100:103], a[52:55], v[208:211]
    s_add_u32 s28, s28, s31
    ds_read_b64_tr_b16 a[94:95], v11 offset:18432
    v_mfma_f32_16x16x32_bf16 v[212:215], a[108:111], a[52:55], v[212:215]
    v_mfma_f32_16x16x32_bf16 v[212:215], a[104:107], a[48:51], v[212:215]
    v_mfma_f32_16x16x32_bf16 v[220:223], a[104:107], a[56:59], v[220:223]
    buffer_load_dwordx4 v17, s[40:43], s49 offen offset:3072 sc1 lds
    v_mfma_f32_16x16x32_bf16 v[220:223], a[108:111], a[60:63], v[220:223]
    s_add_u32 s49, s49, 128
    v_mfma_f32_16x16x32_bf16 v[216:219], a[100:103], a[60:63], v[216:219]
    buffer_store_dwordx4 a[188:191], v2, s[24:27], s28 offen sc1
    v_mfma_f32_16x16x32_bf16 v[216:219], a[96:99], a[56:59], v[216:219]
    s_add_u32 s29, s29, s30
    s_mov_b32 s28, s29
    v_mfma_f32_16x16x32_bf16 v[224:227], a[112:115], a[0:3], v[224:227]
    v_mfma_f32_16x16x32_bf16 v[224:227], a[116:119], a[4:7], v[224:227]
    ds_read_b64_tr_b16 a[96:97], v12 offset:0
    v_mfma_f32_16x16x32_bf16 v[228:231], a[124:127], a[4:7], v[228:231]
    v_mfma_f32_16x16x32_bf16 v[228:231], a[120:123], a[0:3], v[228:231]
    s_add_u32 m0, s61, 4096
    ds_read_b128 a[0:3], v6 offset:0
    v_mfma_f32_16x16x32_bf16 v[236:239], a[120:123], a[8:11], v[236:239]
    buffer_load_dwordx4 v16, s[40:43], s50 offen offset:0 sc1 lds
    v_mfma_f32_16x16x32_bf16 v[236:239], a[124:127], a[12:15], v[236:239]
    s_add_u32 s61, s61, 32768
    ds_read_b128 a[4:7], v7 offset:0
    v_mfma_f32_16x16x32_bf16 v[232:235], a[116:119], a[12:15], v[232:235]
    s_cmp_ge_u32 s61, 98304
    s_cselect_b32 s90, 98304, 0
    ds_read_b64_tr_b16 a[98:99], v12 offset:2048
    v_mfma_f32_16x16x32_bf16 v[232:235], a[112:115], a[8:11], v[232:235]
    s_sub_u32 s61, s61, s90
    ds_read_b128 a[8:11], v6 offset:2048
    v_mfma_f32_16x16x32_bf16 v[240:243], a[112:115], a[16:19], v[240:243]
    ds_read_b128 a[12:15], v7 offset:2048
    v_mfma_f32_16x16x32_bf16 v[240:243], a[116:119], a[20:23], v[240:243]
    ds_read_b64_tr_b16 a[100:101], v12 offset:16384
    v_mfma_f32_16x16x32_bf16 v[244:247], a[124:127], a[20:23], v[244:247]
    v_mfma_f32_16x16x32_bf16 v[244:247], a[120:123], a[16:19], v[244:247]
    ds_read_b128 a[16:19], v6 offset:4096
    v_mfma_f32_16x16x32_bf16 v[252:255], a[120:123], a[24:27], v[252:255]
    buffer_load_dwordx4 v17, s[40:43], s50 offen offset:1024 sc1 lds
    v_mfma_f32_16x16x32_bf16 v[252:255], a[124:127], a[28:31], v[252:255]
    s_add_u32 s50, s50, 128
    ds_read_b128 a[20:23], v7 offset:4096
    v_mfma_f32_16x16x32_bf16 v[248:251], a[116:119], a[28:31], v[248:251]
    ds_read_b64_tr_b16 a[102:103], v12 offset:18432
    v_mfma_f32_16x16x32_bf16 v[248:251], a[112:115], a[24:27], v[248:251]
    ds_read_b128 a[24:27], v6 offset:6144
    v_mfma_f32_16x16x32_bf16 a[224:227], a[112:115], a[32:35], a[224:227]
    s_sub_u32 s65, s65, 1
    ds_read_b128 a[28:31], v7 offset:6144
    v_mfma_f32_16x16x32_bf16 a[224:227], a[116:119], a[36:39], a[224:227]
    ds_read_b64_tr_b16 a[104:105], v13 offset:0
    v_mfma_f32_16x16x32_bf16 a[228:231], a[124:127], a[36:39], a[228:231]
    v_mfma_f32_16x16x32_bf16 a[228:231], a[120:123], a[32:35], a[228:231]
    ds_read_b128 a[32:35], v6 offset:8192
    v_mfma_f32_16x16x32_bf16 a[236:239], a[120:123], a[40:43], a[236:239]
    buffer_load_dwordx4 v16, s[40:43], s51 offen offset:2048 sc1 lds
    v_mfma_f32_16x16x32_bf16 a[236:239], a[124:127], a[44:47], a[236:239]
    ds_read_b128 a[36:39], v7 offset:8192
    v_mfma_f32_16x16x32_bf16 a[232:235], a[116:119], a[44:47], a[232:235]
    ds_read_b64_tr_b16 a[106:107], v13 offset:2048
    v_mfma_f32_16x16x32_bf16 a[232:235], a[112:115], a[40:43], a[232:235]
    ds_read_b128 a[40:43], v6 offset:10240
    v_mfma_f32_16x16x32_bf16 a[240:243], a[112:115], a[48:51], a[240:243]
    ds_read_b128 a[44:47], v7 offset:10240
    v_mfma_f32_16x16x32_bf16 a[240:243], a[116:119], a[52:55], a[240:243]
    ds_read_b64_tr_b16 a[108:109], v13 offset:16384
    v_mfma_f32_16x16x32_bf16 a[244:247], a[124:127], a[52:55], a[244:247]
    v_mfma_f32_16x16x32_bf16 a[244:247], a[120:123], a[48:51], a[244:247]
    ds_read_b128 a[48:51], v6 offset:12288
    v_mfma_f32_16x16x32_bf16 a[252:255], a[120:123], a[56:59], a[252:255]
    buffer_load_dwordx4 v17, s[40:43], s51 offen offset:3072 sc1 lds
    v_mfma_f32_16x16x32_bf16 a[252:255], a[124:127], a[60:63], a[252:255]
    s_add_u32 s51, s51, 128
    ds_read_b128 a[52:55], v7 offset:12288
    v_mfma_f32_16x16x32_bf16 a[248:251], a[116:119], a[60:63], a[248:251]
    ds_read_b64_tr_b16 a[110:111], v13 offset:18432
    v_mfma_f32_16x16x32_bf16 a[248:251], a[112:115], a[56:59], a[248:251]
    ds_read_b128 a[56:59], v6 offset:14336
    ds_read_b128 a[60:63], v7 offset:14336
    s_cmp_eq_u32 s66, 2
    s_cbranch_scc1 m_hook18
m_hookr19:
    s_waitcnt lgkmcnt(15)
    v_mfma_f32_16x16x32_bf16 v[32:35], a[64:67], a[0:3], v[32:35]
    ds_read_b64_tr_b16 a[112:113], v14 offset:0
    v_mfma_f32_16x16x32_bf16 v[32:35], a[68:71], a[4:7], v[32:35]
    ds_read_b64_tr_b16 a[114:115], v14 offset:2048
    v_mfma_f32_16x16x32_bf16 v[36:39], a[76:79], a[4:7], v[36:39]
    ds_read_b64_tr_b16 a[116:117], v14 offset:16384
    v_mfma_f32_16x16x32_bf16 v[36:39], a[72:75], a[0:3], v[36:39]
    ds_read_b64_tr_b16 a[118:119], v14 offset:18432
    v_mfma_f32_16x16x32_bf16 v[44:47], a[72:75], a[8:11], v[44:47]
    ds_read_b64_tr_b16 a[120:121], v15 offset:0
    v_mfma_f32_16x16x32_bf16 v[44:47], a[76:79], a[12:15], v[44:47]
    ds_read_b64_tr_b16 a[122:123], v15 offset:2048
    v_mfma_f32_16x16x32_bf16 v[40:43], a[68:71], a[12:15], v[40:43]
    ds_read_b64_tr_b16 a[124:125], v15 offset:16384
    v_mfma_f32_16x16x32_bf16 v[40:43], a[64:67], a[8:11], v[40:43]
    ds_read_b64_tr_b16 a[126:127], v15 offset:18432
    v_mfma_f32_16x16x32_bf16 v[48:51], a[64:67], a[16:19], v[48:51]
    v_mfma_f32_16x16x32_bf16 v[48:51], a[68:71], a[20:23], v[48:51]
    v_mfma_f32_16x16x32_bf16 v[52:55], a[76:79], a[20:23], v[52:55]
    buffer_store_dwordx4 a[192:195], v2, s[24:27], s28 offen sc1
    v_mfma_f32_16x16x32_bf16 v[52:55], a[72:75], a[16:19], v[52:55]
    s_add_u32 s28, s28, s31
    s_waitcnt lgkmcnt(15)
    v_mfma_f32_16x16x32_bf16 v[60:63], a[72:75], a[24:27], v[60:63]
    v_xor_b32 v8, s60, v8
    v_xor_b32 v9, s60, v9
    v_mfma_f32_16x16x32_bf16 v[60:63], a[76:79], a[28:31], v[60:63]
    v_xor_b32 v10, s60, v10
    v_xor_b32 v11, s60, v11
    v_mfma_f32_16x16x32_bf16 v[56:59], a[68:71], a[28:31], v[56:59]
    v_xor_b32 v12, s60, v12
    v_xor_b32 v13, s60, v13
    v_mfma_f32_16x16x32_bf16 v[56:59], a[64:67], a[24:27], v[56:59]
    v_xor_b32 v14, s60, v14
    v_xor_b32 v15, s60, v15
    v_mfma_f32_16x16x32_bf16 v[64:67], a[64:67], a[32:35], v[64:67]
    buffer_store_dwordx4 a[196:199], v2, s[24:27], s28 offen sc1
    v_mfma_f32_16x16x32_bf16 v[64:67], a[68:71], a[36:39], v[64:67]
    s_add_u32 s28, s28, s31
    v_mfma_f32_16x16x32_bf16 v[68:71], a[76:79], a[36:39], v[68:71]
    v_mfma_f32_16x16x32_bf16 v[68:71], a[72:75], a[32:35], v[68:71]
    s_waitcnt lgkmcnt(14)
    v_mfma_f32_16x16x32_bf16 v[76:79], a[72:75], a[40:43], v[76:79]
    v_mfma_f32_16x16x32_bf16 v[76:79], a[76:79], a[44:47], v[76:79]
    v_mfma_f32_16x16x32_bf16 v[72:75], a[68:71], a[44:47], v[72:75]
    buffer_store_dwordx4 a[200:203], v2, s[24:27], s28 offen sc1
    v_mfma_f32_16x16x32_bf16 v[72:75], a[64:67], a[40:43], v[72:75]
    s_add_u32 s28, s28, s31
    s_waitcnt lgkmcnt(11)
    v_mfma_f32_16x16x32_bf16 v[80:83], a[64:67], a[48:51], v[80:83]
    v_mfma_f32_16x16x32_bf16 v[80:83], a[68:71], a[52:55], v[80:83]
    v_mfma_f32_16x16x32_bf16 v[84:87], a[76:79], a[52:55], v[84:87]
    v_mfma_f32_16x16x32_bf16 v[84:87], a[72:75], a[48:51], v[84:87]
    s_waitcnt lgkmcnt(8)
    v_mfma_f32_16x16x32_bf16 v[92:95], a[72:75], a[56:59], v[92:95]
    buffer_store_dwordx4 a[204:207], v2, s[24:27], s28 offen sc1
    v_mfma_f32_16x16x32_bf16 v[92:95], a[76:79], a[60:63], v[92:95]
    s_add_u32 s28, s28, s31
    v_mfma_f32_16x16x32_bf16 v[88:91], a[68:71], a[60:63], v[88:91]
    s_waitcnt vmcnt(16) lgkmcnt(0)
    v_mfma_f32_16x16x32_bf16 v[88:91], a[64:67], a[56:59], v[88:91]
    s_barrier
    v_mfma_f32_16x16x32_bf16 v[96:99], a[80:83], a[0:3], v[96:99]
    ds_read_b64_tr_b16 a[64:65], v8 offset:0
    v_mfma_f32_16x16x32_bf16 v[96:99], a[84:87], a[4:7], v[96:99]
    s_add_u32 m0, s62, 0
    v_mfma_f32_16x16x32_bf16 v[100:103], a[92:95], a[4:7], v[100:103]
    buffer_load_dwordx4 v18, s[44:47], s52 offen offset:0 sc1 lds
    v_mfma_f32_16x16x32_bf16 v[100:103], a[88:91], a[0:3], v[100:103]
    ds_read_b64_tr_b16 a[66:67], v8 offset:2048
    v_mfma_f32_16x16x32_bf16 v[108:111], a[88:91], a[8:11], v[108:111]
    s_add_u32 s64, s64, 32768
    v_mfma_f32_16x16x32_bf16 v[108:111], a[92:95], a[12:15], v[108:111]
    s_cmp_ge_u32 s64, 98304
    s_cselect_b32 s63, 4294901760, s59
    s_cselect_b32 s64, 0, s64
    v_mfma_f32_16x16x32_bf16 v[104:107], a[84:87], a[12:15], v[104:107]
    buffer_load_dwordx4 v19, s[44:47], s52 offen offset:1024 sc1 lds
    v_mfma_f32_16x16x32_bf16 v[104:107], a[80:83], a[8:11], v[104:107]
    s_add_u32 s52, s52, s56
    ds_read_b64_tr_b16 a[68:69], v8 offset:16384
    v_mfma_f32_16x16x32_bf16 v[112:115], a[80:83], a[16:19], v[112:115]
    v_mfma_f32_16x16x32_bf16 v[112:115], a[84:87], a[20:23], v[112:115]
    v_mfma_f32_16x16x32_bf16 v[116:119], a[92:95], a[20:23], v[116:119]
    buffer_load_dwordx4 v18, s[44:47], s53 offen offset:2048 sc1 lds
    v_mfma_f32_16x16x32_bf16 v[116:119], a[88:91], a[16:19], v[116:119]
    ds_read_b64_tr_b16 a[70:71], v8 offset:18432
    v_mfma_f32_16x16x32_bf16 v[124:127], a[88:91], a[24:27], v[124:127]
    v_mfma_f32_16x16x32_bf16 v[124:127], a[92:95], a[28:31], v[124:127]
    v_mfma_f32_16x16x32_bf16 v[120:123], a[84:87], a[28:31], v[120:123]
    buffer_load_dwordx4 v19, s[44:47], s53 offen offset:3072 sc1 lds
    v_mfma_f32_16x16x32_bf16 v[120:123], a[80:83], a[24:27], v[120:123]
    s_add_u32 s53, s53, s56
    ds_read_b64_tr_b16 a[72:73], v9 offset:0
    v_mfma_f32_16x16x32_bf16 v[128:131], a[80:83], a[32:35], v[128:131]
    v_mfma_f32_16x16x32_bf16 v[128:131], a[84:87], a[36:39], v[128:131]
    s_add_u32 m0, s62, 4096
    v_mfma_f32_16x16x32_bf16 v[132:135], a[92:95], a[36:39], v[132:135]
    buffer_load_dwordx4 v20, s[44:47], s54 offen offset:0 sc1 lds
    v_mfma_f32_16x16x32_bf16 v[132:135], a[88:91], a[32:35], v[132:135]
    s_xor_b32 s62, s62, 229376
    ds_read_b64_tr_b16 a[74:75], v9 offset:2048
    v_mfma_f32_16x16x32_bf16 v[140:143], a[88:91], a[40:43], v[140:143]
    v_mfma_f32_16x16x32_bf16 v[140:143], a[92:95], a[44:47], v[140:143]
    v_mfma_f32_16x16x32_bf16 v[136:139], a[84:87], a[44:47], v[136:139]
    buffer_load_dwordx4 v21, s[44:47], s54 offen offset:1024 sc1 lds
    v_mfma_f32_16x16x32_bf16 v[136:139], a[80:83], a[40:43], v[136:139]
    s_add_u32 s54, s54, s56
    ds_read_b64_tr_b16 a[76:77], v9 offset:16384
    v_mfma_f32_16x16x32_bf16 v[144:147], a[80:83], a[48:51], v[144:147]
    v_mfma_f32_16x16x32_bf16 v[144:147], a[84:87], a[52:55], v[144:147]
    v_mfma_f32_16x16x32_bf16 v[148:151], a[92:95], a[52:55], v[148:151]
    buffer_load_dwordx4 v20, s[44:47], s55 offen offset:2048 sc1 lds
    v_mfma_f32_16x16x32_bf16 v[148:151], a[88:91], a[48:51], v[148:151]
    ds_read_b64_tr_b16 a[78:79], v9 offset:18432
    v_mfma_f32_16x16x32_bf16 v[156:159], a[88:91], a[56:59], v[156:159]
    v_add_u32 v6, s63, v6
    v_add_u32 v7, s63, v7
    v_mfma_f32_16x16x32_bf16 v[156:159], a[92:95], a[60:63], v[156:159]
    v_mfma_f32_16x16x32_bf16 v[152:155], a[84:87], a[60:63], v[152:155]
    buffer_load_dwordx4 v21, s[44:47], s55 offen offset:3072 sc1 lds
    v_mfma_f32_16x16x32_bf16 v[152:155], a[80:83], a[56:59], v[152:155]
    s_add_u32 s55, s55, s56
    v_mfma_f32_16x16x32_bf16 v[160:163], a[96:99], a[0:3], v[160:163]
    ds_read_b64_tr_b16 a[80:81], v10 offset:0
    v_mfma_f32_16x16x32_bf16 v[160:163], a[100:103], a[4:7], v[160:163]
    v_mfma_f32_16x16x32_bf16 v[164:167], a[108:111], a[4:7], v[164:167]
    v_mfma_f32_16x16x32_bf16 v[164:167], a[104:107], a[0:3], v[164:167]
    s_add_u32 m0, s61, 0
    ds_read_b64_tr_b16 a[82:83], v10 offset:2048
    v_mfma_f32_16x16x32_bf16 v[172:175], a[104:107], a[8:11], v[172:175]
    buffer_load_dwordx4 v16, s[40:43], s48 offen offset:0 sc1 lds
    v_mfma_f32_16x16x32_bf16 v[172:175], a[108:111], a[12:15], v[172:175]
    v_mfma_f32_16x16x32_bf16 v[168:171], a[100:103], a[12:15], v[168:171]
    ds_read_b64_tr_b16 a[84:85], v10 offset:16384
    v_mfma_f32_16x16x32_bf16 v[168:171], a[96:99], a[8:11], v[168:171]
    v_mfma_f32_16x16x32_bf16 v[176:179], a[96:99], a[16:19], v[176:179]
    buffer_store_dwordx4 a[208:211], v2, s[24:27], s28 offen sc1
    v_mfma_f32_16x16x32_bf16 v[176:179], a[100:103], a[20:23], v[176:179]
    s_add_u32 s28, s28, s31
    ds_read_b64_tr_b16 a[86:87], v10 offset:18432
    v_mfma_f32_16x16x32_bf16 v[180:183], a[108:111], a[20:23], v[180:183]
    v_mfma_f32_16x16x32_bf16 v[180:183], a[104:107], a[16:19], v[180:183]
    v_mfma_f32_16x16x32_bf16 v[188:191], a[104:107], a[24:27], v[188:191]
    buffer_load_dwordx4 v17, s[40:43], s48 offen offset:1024 sc1 lds
    v_mfma_f32_16x16x32_bf16 v[188:191], a[108:111], a[28:31], v[188:191]
    s_add_u32 s48, s48, 128
    ds_read_b64_tr_b16 a[88:89], v11 offset:0
    v_mfma_f32_16x16x32_bf16 v[184:187], a[100:103], a[28:31], v[184:187]
    v_mfma_f32_16x16x32_bf16 v[184:187], a[96:99], a[24:27], v[184:187]
    v_mfma_f32_16x16x32_bf16 v[192:195], a[96:99], a[32:35], v[192:195]
    buffer_store_dwordx4 a[212:215], v2, s[24:27], s28 offen sc1
    v_mfma_f32_16x16x32_bf16 v[192:195], a[100:103], a[36:39], v[192:195]
    s_add_u32 s28, s28, s31
    ds_read_b64_tr_b16 a[90:91], v11 offset:2048
    v_mfma_f32_16x16x32_bf16 v[196:199], a[108:111], a[36:39], v[196:199]
    v_mfma_f32_16x16x32_bf16 v[196:199], a[104:107], a[32:35], v[196:199]
    v_mfma_f32_16x16x32_bf16 v[204:207], a[104:107], a[40:43], v[204:207]
    buffer_load_dwordx4 v16, s[40:43], s49 offen offset:2048 sc1 lds
    v_mfma_f32_16x16x32_bf16 v[204:207], a[108:111], a[44:47], v[204:207]
    ds_read_b64_tr_b16 a[92:93], v11 offset:16384
    v_mfma_f32_16x16x32_bf16 v[200:203], a[100:103], a[44:47], v[200:203]
    v_mfma_f32_16x16x32_bf16 v[200:203], a[96:99], a[40:43], v[200:203]
    v_mfma_f32_16x16x32_bf16 v[208:211], a[96:99], a[48:51], v[208:211]
    buffer_store_dwordx4 a[216:219], v2, s[24:27], s28 offen sc1
    v_mfma_f32_16x16x32_bf16 v[208:211], a[100:103], a[52:55], v[208:211]
    s_add_u32 s28, s28, s31
    ds_read_b64_tr_b16 a[94:95], v11 offset:18432
    v_mfma_f32_16x16x32_bf16 v[212:215], a[108:111], a[52:55], v[212:215]
    v_mfma_f32_16x16x32_bf16 v[212:215], a[104:107], a[48:51], v[212:215]
    v_mfma_f32_16x16x32_bf16 v[220:223], a[104:107], a[56:59], v[220:223]
    buffer_load_dwordx4 v17, s[40:43], s49 offen offset:3072 sc1 lds
    v_mfma_f32_16x16x32_bf16 v[220:223], a[108:111], a[60:63], v[220:223]
    s_add_u32 s49, s49, 128
    v_mfma_f32_16x16x32_bf16 v[216:219], a[100:103], a[60:63], v[216:219]
    buffer_store_dwordx4 a[220:223], v2, s[24:27], s28 offen sc1
    v_mfma_f32_16x16x32_bf16 v[216:219], a[96:99], a[56:59], v[216:219]
    s_add_u32 s29, s29, s30
    s_mov_b32 s28, s29
    v_mfma_f32_16x16x32_bf16 v[224:227], a[112:115], a[0:3], v[224:227]
    v_mfma_f32_16x16x32_bf16 v[224:227], a[116:119], a[4:7], v[224:227]
    ds_read_b64_tr_b16 a[96:97], v12 offset:0
    v_mfma_f32_16x16x32_bf16 v[228:231], a[124:127], a[4:7], v[228:231]
    v_mfma_f32_16x16x32_bf16 v[228:231], a[120:123], a[0:3], v[228:231]
    s_add_u32 m0, s61, 4096
    ds_read_b128 a[0:3], v6 offset:0
    v_mfma_f32_16x16x32_bf16 v[236:239], a[120:123], a[8:11], v[236:239]
    buffer_load_dwordx4 v16, s[40:43], s50 offen offset:0 sc1 lds
    v_mfma_f32_16x16x32_bf16 v[236:239], a[124:127], a[12:15], v[236:239]
    s_add_u32 s61, s61, 32768
    ds_read_b128 a[4:7], v7 offset:0
    v_mfma_f32_16x16x32_bf16 v[232:235], a[116:119], a[12:15], v[232:235]
    s_cmp_ge_u32 s61, 98304
    s_cselect_b32 s90, 98304, 0
    ds_read_b64_tr_b16 a[98:99], v12 offset:2048
    v_mfma_f32_16x16x32_bf16 v[232:235], a[112:115], a[8:11], v[232:235]
    s_sub_u32 s61, s61, s90
    ds_read_b128 a[8:11], v6 offset:2048
    v_mfma_f32_16x16x32_bf16 v[240:243], a[112:115], a[16:19], v[240:243]
    ds_read_b128 a[12:15], v7 offset:2048
    v_mfma_f32_16x16x32_bf16 v[240:243], a[116:119], a[20:23], v[240:243]
    ds_read_b64_tr_b16 a[100:101], v12 offset:16384
    v_mfma_f32_16x16x32_bf16 v[244:247], a[124:127], a[20:23], v[244:247]
    v_mfma_f32_16x16x32_bf16 v[244:247], a[120:123], a[16:19], v[244:247]
    ds_read_b128 a[16:19], v6 offset:4096
    v_mfma_f32_16x16x32_bf16 v[252:255], a[120:123], a[24:27], v[252:255]
    buffer_load_dwordx4 v17, s[40:43], s50 offen offset:1024 sc1 lds
    v_mfma_f32_16x16x32_bf16 v[252:255], a[124:127], a[28:31], v[252:255]
    s_add_u32 s50, s50, 128
    ds_read_b128 a[20:23], v7 offset:4096
    v_mfma_f32_16x16x32_bf16 v[248:251], a[116:119], a[28:31], v[248:251]
    ds_read_b64_tr_b16 a[102:103], v12 offset:18432
    v_mfma_f32_16x16x32_bf16 v[248:251], a[112:115], a[24:27], v[248:251]
    ds_read_b128 a[24:27], v6 offset:6144
    v_mfma_f32_16x16x32_bf16 a[224:227], a[112:115], a[32:35], a[224:227]
    s_sub_u32 s65, s65, 1
    ds_read_b128 a[28:31], v7 offset:6144
    v_mfma_f32_16x16x32_bf16 a[224:227], a[116:119], a[36:39], a[224:227]
    ds_read_b64_tr_b16 a[104:105], v13 offset:0
    v_mfma_f32_16x16x32_bf16 a[228:231], a[124:127], a[36:39], a[228:231]
    v_mfma_f32_16x16x32_bf16 a[228:231], a[120:123], a[32:35], a[228:231]
    ds_read_b128 a[32:35], v6 offset:8192
    v_mfma_f32_16x16x32_bf16 a[236:239], a[120:123], a[40:43], a[236:239]
    buffer_load_dwordx4 v16, s[40:43], s51 offen offset:2048 sc1 lds
    v_mfma_f32_16x16x32_bf16 a[236:239], a[124:127], a[44:47], a[236:239]
    ds_read_b128 a[36:39], v7 offset:8192
    v_mfma_f32_16x16x32_bf16 a[232:235], a[116:119], a[44:47], a[232:235]
    ds_read_b64_tr_b16 a[106:107], v13 offset:2048
    v_mfma_f32_16x16x32_bf16 a[232:235], a[112:115], a[40:43], a[232:235]
    ds_read_b128 a[40:43], v6 offset:10240
    v_mfma_f32_16x16x32_bf16 a[240:243], a[112:115], a[48:51], a[240:243]
    ds_read_b128 a[44:47], v7 offset:10240
    v_mfma_f32_16x16x32_bf16 a[240:243], a[116:119], a[52:55], a[240:243]
    ds_read_b64_tr_b16 a[108:109], v13 offset:16384
    v_mfma_f32_16x16x32_bf16 a[244:247], a[124:127], a[52:55], a[244:247]
    v_mfma_f32_16x16x32_bf16 a[244:247], a[120:123], a[48:51], a[244:247]
    ds_read_b128 a[48:51], v6 offset:12288
    v_mfma_f32_16x16x32_bf16 a[252:255], a[120:123], a[56:59], a[252:255]
    buffer_load_dwordx4 v17, s[40:43], s51 offen offset:3072 sc1 lds
    v_mfma_f32_16x16x32_bf16 a[252:255], a[124:127], a[60:63], a[252:255]
    s_add_u32 s51, s51, 128
    ds_read_b128 a[52:55], v7 offset:12288
    v_mfma_f32_16x16x32_bf16 a[248:251], a[116:119], a[60:63], a[248:251]
    ds_read_b64_tr_b16 a[110:111], v13 offset:18432
    v_mfma_f32_16x16x32_bf16 a[248:251], a[112:115], a[56:59], a[248:251]
    ds_read_b128 a[56:59], v6 offset:14336
    ds_read_b128 a[60:63], v7 offset:14336
.p2align 3
m_loop20:
    s_waitcnt lgkmcnt(15)
    v_mfma_f32_16x16x32_bf16 v[32:35], a[64:67], a[0:3], v[32:35]
    ds_read_b64_tr_b16 a[112:113], v14 offset:0
    v_mfma_f32_16x16x32_bf16 v[32:35], a[68:71], a[4:7], v[32:35]
    ds_read_b64_tr_b16 a[114:115], v14 offset:2048
    v_mfma_f32_16x16x32_bf16 v[36:39], a[76:79], a[4:7], v[36:39]
    ds_read_b64_tr_b16 a[116:117], v14 offset:16384
    v_mfma_f32_16x16x32_bf16 v[36:39], a[72:75], a[0:3], v[36:39]
    ds_read_b64_tr_b16 a[118:119], v14 offset:18432
    v_mfma_f32_16x16x32_bf16 v[44:47], a[72:75], a[8:11], v[44:47]
    ds_read_b64_tr_b16 a[120:121], v15 offset:0
    v_mfma_f32_16x16x32_bf16 v[44:47], a[76:79], a[12:15], v[44:47]
    ds_read_b64_tr_b16 a[122:123], v15 offset:2048
    v_mfma_f32_16x16x32_bf16 v[40:43], a[68:71], a[12:15], v[40:43]
    ds_read_b64_tr_b16 a[124:125], v15 offset:16384
    v_mfma_f32_16x16x32_bf16 v[40:43], a[64:67], a[8:11], v[40:43]
    ds_read_b64_tr_b16 a[126:127], v15 offset:18432
    v_mfma_f32_16x16x32_bf16 v[48:51], a[64:67], a[16:19], v[48:51]
    v_mfma_f32_16x16x32_bf16 v[48:51], a[68:71], a[20:23], v[48:51]
    v_mfma_f32_16x16x32_bf16 v[52:55], a[76:79], a[20:23], v[52:55]
    v_mfma_f32_16x16x32_bf16 v[52:55], a[72:75], a[16:19], v[52:55]
    s_waitcnt lgkmcnt(15)
    v_mfma_f32_16x16x32_bf16 v[60:63], a[72:75], a[24:27], v[60:63]
    v_xor_b32 v8, s60, v8
    v_xor_b32 v9, s60, v9
    v_mfma_f32_16x16x32_bf16 v[60:63], a[76:79], a[28:31], v[60:63]
    v_xor_b32 v10, s60, v10
    v_xor_b32 v11, s60, v11
    v_mfma_f32_16x16x32_bf16 v[56:59], a[68:71], a[28:31], v[56:59]
    v_xor_b32 v12, s60, v12
    v_xor_b32 v13, s60, v13
    v_mfma_f32_16x16x32_bf16 v[56:59], a[64:67], a[24:27], v[56:59]
    v_xor_b32 v14, s60, v14
    v_xor_b32 v15, s60, v15
    v_mfma_f32_16x16x32_bf16 v[64:67], a[64:67], a[32:35], v[64:67]
    v_mfma_f32_16x16x32_bf16 v[64:67], a[68:71], a[36:39], v[64:67]
    v_mfma_f32_16x16x32_bf16 v[68:71], a[76:79], a[36:39], v[68:71]
    v_mfma_f32_16x16x32_bf16 v[68:71], a[72:75], a[32:35], v[68:71]
    s_waitcnt lgkmcnt(14)
    v_mfma_f32_16x16x32_bf16 v[76:79], a[72:75], a[40:43], v[76:79]
    v_mfma_f32_16x16x32_bf16 v[76:79], a[76:79], a[44:47], v[76:79]
    v_mfma_f32_16x16x32_bf16 v[72:75], a[68:71], a[44:47], v[72:75]
    v_mfma_f32_16x16x32_bf16 v[72:75], a[64:67], a[40:43], v[72:75]
    s_waitcnt lgkmcnt(11)
    v_mfma_f32_16x16x32_bf16 v[80:83], a[64:67], a[48:51], v[80:83]
    v_mfma_f32_16x16x32_bf16 v[80:83], a[68:71], a[52:55], v[80:83]
    v_mfma_f32_16x16x32_bf16 v[84:87], a[76:79], a[52:55], v[84:87]
    v_mfma_f32_16x16x32_bf16 v[84:87], a[72:75], a[48:51], v[84:87]
    s_waitcnt lgkmcnt(8)
    v_mfma_f32_16x16x32_bf16 v[92:95], a[72:75], a[56:59], v[92:95]
    v_mfma_f32_16x16x32_bf16 v[92:95], a[76:79], a[60:63], v[92:95]
    v_mfma_f32_16x16x32_bf16 v[88:91], a[68:71], a[60:63], v[88:91]
    s_waitcnt vmcnt(8) lgkmcnt(0)
    v_mfma_f32_16x16x32_bf16 v[88:91], a[64:67], a[56:59], v[88:91]
    s_barrier
    v_mfma_f32_16x16x32_bf16 v[96:99], a[80:83], a[0:3], v[96:99]
    ds_read_b64_tr_b16 a[64:65], v8 offset:0
    v_mfma_f32_16x16x32_bf16 v[96:99], a[84:87], a[4:7], v[96:99]
    s_add_u32 m0, s62, 0
    v_mfma_f32_16x16x32_bf16 v[100:103], a[92:95], a[4:7], v[100:103]
    buffer_load_dwordx4 v18, s[44:47], s52 offen offset:0 sc1 lds
    v_mfma_f32_16x16x32_bf16 v[100:103], a[88:91], a[0:3], v[100:103]
    ds_read_b64_tr_b16 a[66:67], v8 offset:2048
    v_mfma_f32_16x16x32_bf16 v[108:111], a[88:91], a[8:11], v[108:111]
    s_add_u32 s64, s64, 32768
    v_mfma_f32_16x16x32_bf16 v[108:111], a[92:95], a[12:15], v[108:111]
    s_cmp_ge_u32 s64, 98304
    s_cselect_b32 s63, 4294901760, s59
    s_cselect_b32 s64, 0, s64
    v_mfma_f32_16x16x32_bf16 v[104:107], a[84:87], a[12:15], v[104:107]
    buffer_load_dwordx4 v19, s[44:47], s52 offen offset:1024 sc1 lds
    v_mfma_f32_16x16x32_bf16 v[104:107], a[80:83], a[8:11], v[104:107]
    s_add_u32 s52, s52, s56
    ds_read_b64_tr_b16 a[68:69], v8 offset:16384
    v_mfma_f32_16x16x32_bf16 v[112:115], a[80:83], a[16:19], v[112:115]
    v_mfma_f32_16x16x32_bf16 v[112:115], a[84:87], a[20:23], v[112:115]
    v_mfma_f32_16x16x32_bf16 v[116:119], a[92:95], a[20:23], v[116:119]
    buffer_load_dwordx4 v18, s[44:47], s53 offen offset:2048 sc1 lds
    v_mfma_f32_16x16x32_bf16 v[116:119], a[88:91], a[16:19], v[116:119]
    ds_read_b64_tr_b16 a[70:71], v8 offset:18432
    v_mfma_f32_16x16x32_bf16 v[124:127], a[88:91], a[24:27], v[124:127]
    v_mfma_f32_16x16x32_bf16 v[124:127], a[92:95], a[28:31], v[124:127]
    v_mfma_f32_16x16x32_bf16 v[120:123], a[84:87], a[28:31], v[120:123]
    buffer_load_dwordx4 v19, s[44:47], s53 offen offset:3072 sc1 lds
    v_mfma_f32_16x16x32_bf16 v[120:123], a[80:83], a[24:27], v[120:123]
    s_add_u32 s53, s53, s56
    ds_read_b64_tr_b16 a[72:73], v9 offset:0
    v_mfma_f32_16x16x32_bf16 v[128:131], a[80:83], a[32:35], v[128:131]
    v_mfma_f32_16x16x32_bf16 v[128:131], a[84:87], a[36:39], v[128:131]
    s_add_u32 m0, s62, 4096
    v_mfma_f32_16x16x32_bf16 v[132:135], a[92:95], a[36:39], v[132:135]
    buffer_load_dwordx4 v20, s[44:47], s54 offen offset:0 sc1 lds
    v_mfma_f32_16x16x32_bf16 v[132:135], a[88:91], a[32:35], v[132:135]
    s_xor_b32 s62, s62, 229376
    ds_read_b64_tr_b16 a[74:75], v9 offset:2048
    v_mfma_f32_16x16x32_bf16 v[140:143], a[88:91], a[40:43], v[140:143]
    v_mfma_f32_16x16x32_bf16 v[140:143], a[92:95], a[44:47], v[140:143]
    v_mfma_f32_16x16x32_bf16 v[136:139], a[84:87], a[44:47], v[136:139]
    buffer_load_dwordx4 v21, s[44:47], s54 offen offset:1024 sc1 lds
    v_mfma_f32_16x16x32_bf16 v[136:139], a[80:83], a[40:43], v[136:139]
    s_add_u32 s54, s54, s56
    ds_read_b64_tr_b16 a[76:77], v9 offset:16384
    v_mfma_f32_16x16x32_bf16 v[144:147], a[80:83], a[48:51], v[144:147]
    v_mfma_f32_16x16x32_bf16 v[144:147], a[84:87], a[52:55], v[144:147]
    v_mfma_f32_16x16x32_bf16 v[148:151], a[92:95], a[52:55], v[148:151]
    buffer_load_dwordx4 v20, s[44:47], s55 offen offset:2048 sc1 lds
    v_mfma_f32_16x16x32_bf16 v[148:151], a[88:91], a[48:51], v[148:151]
    ds_read_b64_tr_b16 a[78:79], v9 offset:18432
    v_mfma_f32_16x16x32_bf16 v[156:159], a[88:91], a[56:59], v[156:159]
    v_add_u32 v6, s63, v6
    v_add_u32 v7, s63, v7
    v_mfma_f32_16x16x32_bf16 v[156:159], a[92:95], a[60:63], v[156:159]
    v_mfma_f32_16x16x32_bf16 v[152:155], a[84:87], a[60:63], v[152:155]
    buffer_load_dwordx4 v21, s[44:47], s55 offen offset:3072 sc1 lds
    v_mfma_f32_16x16x32_bf16 v[152:155], a[80:83], a[56:59], v[152:155]
    s_add_u32 s55, s55, s56
    v_mfma_f32_16x16x32_bf16 v[160:163], a[96:99], a[0:3], v[160:163]
    ds_read_b64_tr_b16 a[80:81], v10 offset:0
    v_mfma_f32_16x16x32_bf16 v[160:163], a[100:103], a[4:7], v[160:163]
    v_mfma_f32_16x16x32_bf16 v[164:167], a[108:111], a[4:7], v[164:167]
    v_mfma_f32_16x16x32_bf16 v[164:167], a[104:107], a[0:3], v[164:167]
    s_add_u32 m0, s61, 0
    ds_read_b64_tr_b16 a[82:83], v10 offset:2048
    v_mfma_f32_16x16x32_bf16 v[172:175], a[104:107], a[8:11], v[172:175]
    buffer_load_dwordx4 v16, s[40:43], s48 offen offset:0 sc1 lds
    v_mfma_f32_16x16x32_bf16 v[172:175], a[108:111], a[12:15], v[172:175]
    v_mfma_f32_16x16x32_bf16 v[168:171], a[100:103], a[12:15], v[168:171]
    ds_read_b64_tr_b16 a[84:85], v10 offset:16384
    v_mfma_f32_16x16x32_bf16 v[168:171], a[96:99], a[8:11], v[168:171]
    v_mfma_f32_16x16x32_bf16 v[176:179], a[96:99], a[16:19], v[176:179]
    v_mfma_f32_16x16x32_bf16 v[176:179], a[100:103], a[20:23], v[176:179]
    ds_read_b64_tr_b16 a[86:87], v10 offset:18432
    v_mfma_f32_16x16x32_bf16 v[180:183], a[108:111], a[20:23], v[180:183]
    v_mfma_f32_16x16x32_bf16 v[180:183], a[104:107], a[16:19], v[180:183]
    v_mfma_f32_16x16x32_bf16 v[188:191], a[104:107], a[24:27], v[188:191]
    buffer_load_dwordx4 v17, s[40:43], s48 offen offset:1024 sc1 lds
    v_mfma_f32_16x16x32_bf16 v[188:191], a[108:111], a[28:31], v[188:191]
    s_add_u32 s48, s48, 128
    ds_read_b64_tr_b16 a[88:89], v11 offset:0
    v_mfma_f32_16x16x32_bf16 v[184:187], a[100:103], a[28:31], v[184:187]
    v_mfma_f32_16x16x32_bf16 v[184:187], a[96:99], a[24:27], v[184:187]
    v_mfma_f32_16x16x32_bf16 v[192:195], a[96:99], a[32:35], v[192:195]
    v_mfma_f32_16x16x32_bf16 v[192:195], a[100:103], a[36:39], v[192:195]
    ds_read_b64_tr_b16 a[90:91], v11 offset:2048
    v_mfma_f32_16x16x32_bf16 v[196:199], a[108:111], a[36:39], v[196:199]
    v_mfma_f32_16x16x32_bf16 v[196:199], a[104:107], a[32:35], v[196:199]
    v_mfma_f32_16x16x32_bf16 v[204:207], a[104:107], a[40:43], v[204:207]
    buffer_load_dwordx4 v16, s[40:43], s49 offen offset:2048 sc1 lds
    v_mfma_f32_16x16x32_bf16 v[204:207], a[108:111], a[44:47], v[204:207]
    ds_read_b64_tr_b16 a[92:93], v11 offset:16384
    v_mfma_f32_16x16x32_bf16 v[200:203], a[100:103], a[44:47], v[200:203]
    v_mfma_f32_16x16x32_bf16 v[200:203], a[96:99], a[40:43], v[200:203]
    v_mfma_f32_16x16x32_bf16 v[208:211], a[96:99], a[48:51], v[208:211]
    v_mfma_f32_16x16x32_bf16 v[208:211], a[100:103], a[52:55], v[208:211]
    ds_read_b64_tr_b16 a[94:95], v11 offset:18432
    v_mfma_f32_16x16x32_bf16 v[212:215], a[108:111], a[52:55], v[212:215]
    v_mfma_f32_16x16x32_bf16 v[212:215], a[104:107], a[48:51], v[212:215]
    v_mfma_f32_16x16x32_bf16 v[220:223], a[104:107], a[56:59], v[220:223]
    buffer_load_dwordx4 v17, s[40:43], s49 offen offset:3072 sc1 lds
    v_mfma_f32_16x16x32_bf16 v[220:223], a[108:111], a[60:63], v[220:223]
    s_add_u32 s49, s49, 128
    v_mfma_f32_16x16x32_bf16 v[216:219], a[100:103], a[60:63], v[216:219]
    v_mfma_f32_16x16x32_bf16 v[216:219], a[96:99], a[56:59], v[216:219]
    v_mfma_f32_16x16x32_bf16 v[224:227], a[112:115], a[0:3], v[224:227]
    v_mfma_f32_16x16x32_bf16 v[224:227], a[116:119], a[4:7], v[224:227]
    ds_read_b64_tr_b16 a[96:97], v12 offset:0
    v_mfma_f32_16x16x32_bf16 v[228:231], a[124:127], a[4:7], v[228:231]
    v_mfma_f32_16x16x32_bf16 v[228:231], a[120:123], a[0:3], v[228:231]
    s_add_u32 m0, s61, 4096
    ds_read_b128 a[0:3], v6 offset:0
    v_mfma_f32_16x16x32_bf16 v[236:239], a[120:123], a[8:11], v[236:239]
    buffer_load_dwordx4 v16, s[40:43], s50 offen offset:0 sc1 lds
    v_mfma_f32_16x16x32_bf16 v[236:239], a[124:127], a[12:15], v[236:239]
    s_add_u32 s61, s61, 32768
    ds_read_b128 a[4:7], v7 offset:0
    v_mfma_f32_16x16x32_bf16 v[232:235], a[116:119], a[12:15], v[232:235]
    s_cmp_ge_u32 s61, 98304
    s_cselect_b32 s90, 98304, 0
    ds_read_b64_tr_b16 a[98:99], v12 offset:2048
    v_mfma_f32_16x16x32_bf16 v[232:235], a[112:115], a[8:11], v[232:235]
    s_sub_u32 s61, s61, s90
    ds_read_b128 a[8:11], v6 offset:2048
    v_mfma_f32_16x16x32_bf16 v[240:243], a[112:115], a[16:19], v[240:243]
    ds_read_b128 a[12:15], v7 offset:2048
    v_mfma_f32_16x16x32_bf16 v[240:243], a[116:119], a[20:23], v[240:243]
    ds_read_b64_tr_b16 a[100:101], v12 offset:16384
    v_mfma_f32_16x16x32_bf16 v[244:247], a[124:127], a[20:23], v[244:247]
    v_mfma_f32_16x16x32_bf16 v[244:247], a[120:123], a[16:19], v[244:247]
    ds_read_b128 a[16:19], v6 offset:4096
    v_mfma_f32_16x16x32_bf16 v[252:255], a[120:123], a[24:27], v[252:255]
    buffer_load_dwordx4 v17, s[40:43], s50 offen offset:1024 sc1 lds
    v_mfma_f32_16x16x32_bf16 v[252:255], a[124:127], a[28:31], v[252:255]
    s_add_u32 s50, s50, 128
    ds_read_b128 a[20:23], v7 offset:4096
    v_mfma_f32_16x16x32_bf16 v[248:251], a[116:119], a[28:31], v[248:251]
    ds_read_b64_tr_b16 a[102:103], v12 offset:18432
    v_mfma_f32_16x16x32_bf16 v[248:251], a[112:115], a[24:27], v[248:251]
    ds_read_b128 a[24:27], v6 offset:6144
    v_mfma_f32_16x16x32_bf16 a[224:227], a[112:115], a[32:35], a[224:227]
    s_sub_u32 s65, s65, 1
    ds_read_b128 a[28:31], v7 offset:6144
    v_mfma_f32_16x16x32_bf16 a[224:227], a[116:119], a[36:39], a[224:227]
    ds_read_b64_tr_b16 a[104:105], v13 offset:0
    v_mfma_f32_16x16x32_bf16 a[228:231], a[124:127], a[36:39], a[228:231]
    v_mfma_f32_16x16x32_bf16 a[228:231], a[120:123], a[32:35], a[228:231]
    ds_read_b128 a[32:35], v6 offset:8192
    v_mfma_f32_16x16x32_bf16 a[236:239], a[120:123], a[40:43], a[236:239]
    buffer_load_dwordx4 v16, s[40:43], s51 offen offset:2048 sc1 lds
    v_mfma_f32_16x16x32_bf16 a[236:239], a[124:127], a[44:47], a[236:239]
    ds_read_b128 a[36:39], v7 offset:8192
    v_mfma_f32_16x16x32_bf16 a[232:235], a[116:119], a[44:47], a[232:235]
    ds_read_b64_tr_b16 a[106:107], v13 offset:2048
    v_mfma_f32_16x16x32_bf16 a[232:235], a[112:115], a[40:43], a[232:235]
    ds_read_b128 a[40:43], v6 offset:10240
    v_mfma_f32_16x16x32_bf16 a[240:243], a[112:115], a[48:51], a[240:243]
    ds_read_b128 a[44:47], v7 offset:10240
    v_mfma_f32_16x16x32_bf16 a[240:243], a[116:119], a[52:55], a[240:243]
    ds_read_b64_tr_b16 a[108:109], v13 offset:16384
    v_mfma_f32_16x16x32_bf16 a[244:247], a[124:127], a[52:55], a[244:247]
    v_mfma_f32_16x16x32_bf16 a[244:247], a[120:123], a[48:51], a[244:247]
    ds_read_b128 a[48:51], v6 offset:12288
    v_mfma_f32_16x16x32_bf16 a[252:255], a[120:123], a[56:59], a[252:255]
    buffer_load_dwordx4 v17, s[40:43], s51 offen offset:3072 sc1 lds
    v_mfma_f32_16x16x32_bf16 a[252:255], a[124:127], a[60:63], a[252:255]
    s_add_u32 s51, s51, 128
    ds_read_b128 a[52:55], v7 offset:12288
    v_mfma_f32_16x16x32_bf16 a[248:251], a[116:119], a[60:63], a[248:251]
    s_cmp_gt_u32 s65, s67
    ds_read_b64_tr_b16 a[110:111], v13 offset:18432
    v_mfma_f32_16x16x32_bf16 a[248:251], a[112:115], a[56:59], a[248:251]
    ds_read_b128 a[56:59], v6 offset:14336
    ds_read_b128 a[60:63], v7 offset:14336
    s_cbranch_scc1 m_loop20
    s_cmp_eq_u32 s65, 0
    s_cbranch_scc1 m_epi15
m_dosw21:
    s_cmp_eq_u32 s94, 0
    s_cbranch_scc1 m_x39
    s_cmp_lg_u32 s65, 3
    s_cbranch_scc1 m_x45
    s_mov_b32 s42, s73
    s_lshl_b32 s90, s77, 4
    s_lshl_b32 s90, s90, s81
    s_mov_b32 s48, s79
    s_mul_i32 s91, s90, 1
    s_add_u32 s49, s91, s79
    s_sub_u32 s49, s49, 2048
    s_mul_i32 s91, s90, 2
    s_add_u32 s50, s91, s79
    s_mul_i32 s91, s90, 3
    s_add_u32 s51, s91, s79
    s_sub_u32 s51, s51, 2048
    s_lshl_b32 s90, s58, 7
    s_add_u32 s90, s90, s57
    s_lshl_b32 s91, s16, 6
    s_cmp_eq_u32 s81, 1
    s_cselect_b32 s90, s90, s91
    v_lshrrev_b32 v24, 3, v1
    v_lshlrev_b32 v24, s81, v24
    v_add_u32 v24, s90, v24
    v_mul_lo_u32 v24, v24, s77
    v_lshrrev_b32 v25, 4, v1
    v_and_b32 v26, 7, v1
    v_xor_b32 v25, v25, v26
    v_lshl_add_u32 v16, v25, 4, v24
    v_xor_b32 v25, 4, v25
    v_lshl_add_u32 v17, v25, 4, v24
    s_lshl_b32 s90, s77, 3
    s_lshl_b32 s90, s90, s81
    s_sub_u32 s90, s90, 1024
    v_add_u32 v17, s90, v17
    s_mov_b32 s40, s71
    s_mov_b32 s41, s72
    buffer_load_dwordx2 v[4:5], off, s[12:15], 0 sc1
    s_branch m_loop20
m_x45:
    s_mov_b32 s46, s76
    s_mov_b32 s52, s80
    s_lshl_b32 s90, s78, 2
    s_mul_i32 s91, s90, 1
    s_add_u32 s53, s91, s80
    s_sub_u32 s53, s53, 2048
    s_mul_i32 s91, s90, 2
    s_add_u32 s54, s91, s80
    s_mul_i32 s91, s90, 3
    s_add_u32 s55, s91, s80
    s_sub_u32 s55, s55, 2048
    s_lshl_b32 s56, s78, 6
    v_lshrrev_b32 v24, 5, v1
    s_lshl_b32 s90, s16, 4
    v_add_u32 v25, s90, v24
    v_mul_lo_u32 v25, v25, s78
    v_lshlrev_b32 v24, 1, v24
    v_and_b32 v26, 31, v1
    v_xor_b32 v24, v24, v26
    s_lshl_b32 s90, s78, 1
    s_sub_u32 s90, s90, 1024
    v_add_u32 v27, s90, v25
    v_xor_b32 v26, 0, v24
    v_lshl_add_u32 v18, v26, 4, v25
    v_xor_b32 v26, 4, v24
    v_lshl_add_u32 v19, v26, 4, v27
    v_xor_b32 v26, 8, v24
    v_lshl_add_u32 v20, v26, 4, v25
    v_xor_b32 v26, 12, v24
    v_lshl_add_u32 v21, v26, 4, v27
    s_mov_b32 s44, s74
    s_mov_b32 s45, s75
    s_mov_b32 s67, 0
    s_branch m_loop20
m_x39:
    s_cmp_le_u32 s65, 4
    s_cbranch_scc1 m_x40
    s_cmp_lg_u32 s16, 0
    s_cbranch_scc1 m_np46
    v_mov_b32 v4, s4
    v_mov_b32 v5, s5
    s_add_u32 s90, s17, 117440512
    s_mov_b64 exec, 1
    buffer_store_dwordx2 v[4:5], off, s[8:11], s90 sc1
    s_mov_b64 exec, -1
m_np46:
    s_mov_b32 s17, -1
    s_mov_b32 s67, 4
    s_branch m_loop20
m_x40:
    s_cmp_lg_u32 s65, 4
    s_cbranch_scc1 m_x41
    s_cmp_eq_u32 s70, 1
    s_cbranch_scc1 m_ea47
    s_and_b32 s92, s2, 7
    s_lshl_b32 s92, s92, 2
    s_bfe_u32 s93, s2, 0x20003
    s_add_u32 s92, s92, s93
    s_lshr_b32 s93, s2, 5
    s_lshl_b32 s93, s93, 2
    s_or_b32 s93, s93, 0x40000
    s_lshr_b32 s90, s92, 1
    s_lshl_b32 s90, s90, 7
    s_add_u32 s90, s90, 117440512
    s_bfe_u32 s91, 873473623, s93
    s_lshr_b32 s91, s91, 1
    v_mov_b32 v0, s91
    v_and_b32 v4, 3, v1
    v_min_u32 v4, 2, v4
    v_and_b32 v5, 4, v1
    v_add3_u32 v4, v4, v5, 8
    v_cmp_gt_u32 vcc, 8, v1
    s_nop 1
    v_cndmask_b32 v0, v0, v4, vcc
    s_bfe_u32 s91, 4225681832, s93
    s_lshr_b32 s91, s91, 1
    v_writelane_b32 v0, s91, 8
    v_lshlrev_b32 v0, 3, v0
    buffer_load_dwordx2 v[4:5], v0, s[8:11], s90 offen sc1
m_eb48:
    s_branch m_loop20
m_x41:
    s_waitcnt vmcnt(16)
    s_cmp_lg_u32 s65, 3
    s_cbranch_scc1 m_x42
    s_cmp_eq_u32 s70, 1
    s_cbranch_scc1 m_ea49
    s_mov_b32 s3, 1048576
m_spin51:
    v_cmp_ne_u64 s[22:23], s[4:5], v[4:5]
    s_nop 3
    s_cmp_eq_u64 s[22:23], 0
    s_cbranch_scc1 m_ok52
    s_sub_u32 s3, s3, 1
    s_cbranch_scc1 m_ok52
    s_sleep 16
    s_and_b32 s92, s2, 7
    s_lshl_b32 s92, s92, 2
    s_bfe_u32 s93, s2, 0x20003
    s_add_u32 s92, s92, s93
    s_lshr_b32 s93, s2, 5
    s_lshl_b32 s93, s93, 2
    s_or_b32 s93, s93, 0x40000
    s_lshr_b32 s90, s92, 1
    s_lshl_b32 s90, s90, 7
    s_add_u32 s90, s90, 117440512
    s_bfe_u32 s91, 873473623, s93
    s_lshr_b32 s91, s91, 1
    v_mov_b32 v0, s91
    v_and_b32 v4, 3, v1
    v_min_u32 v4, 2, v4
    v_and_b32 v5, 4, v1
    v_add3_u32 v4, v4, v5, 8
    v_cmp_gt_u32 vcc, 8, v1
    s_nop 1
    v_cndmask_b32 v0, v0, v4, vcc
    s_bfe_u32 s91, 4225681832, s93
    s_lshr_b32 s91, s91, 1
    v_writelane_b32 v0, s91, 8
    v_lshlrev_b32 v0, 3, v0
    buffer_load_dwordx2 v[4:5], v0, s[8:11], s90 offen sc1
    s_waitcnt vmcnt(0)
    s_branch m_spin51
m_ok52:
    s_and_b32 s92, s2, 7
    s_lshl_b32 s92, s92, 2
    s_bfe_u32 s93, s2, 0x20003
    s_add_u32 s92, s92, s93
    s_lshr_b32 s93, s2, 5
    s_lshl_b32 s93, s93, 2
    s_or_b32 s93, s93, 0x40000
    s_bfe_u32 s90, 4225681832, s93
    s_lshl_b32 s90, s90, 3
    s_lshl_b32 s91, s16, 1
    s_add_u32 s90, s90, s91
    s_lshl_b32 s90, s90, 12
    s_lshl_b32 s91, s92, 19
    s_add_u32 s90, s90, s91
    s_add_u32 s90, s90, 0
    buffer_load_dwordx4 a[128:131], v2, s[8:11], s90 offen offset:0 sc1
    buffer_load_dwordx4 a[132:135], v2, s[8:11], s90 offen offset:1024 sc1
    buffer_load_dwordx4 a[136:139], v2, s[8:11], s90 offen offset:2048 sc1
    buffer_load_dwordx4 a[140:143], v2, s[8:11], s90 offen offset:3072 sc1
    s_bfe_u32 s90, 4225681832, s93
    s_lshl_b32 s90, s90, 3
    s_lshl_b32 s91, s16, 1
    s_add_u32 s90, s90, s91
    s_lshl_b32 s90, s90, 12
    s_lshl_b32 s91, s92, 19
    s_add_u32 s90, s90, s91
    s_add_u32 s90, s90, 4096
    buffer_load_dwordx4 a[144:147], v2, s[8:11], s90 offen offset:0 sc1
    buffer_load_dwordx4 a[148:151], v2, s[8:11], s90 offen offset:1024 sc1
m_eb50:
    s_lshl_b32 s90, s92, 19
    s_lshl_b32 s91, s58, 13
    s_add_u32 s90, s90, s91
    s_cmp_eq_u32 s57, 0
    s_mov_b32 s91, 33554432
    s_cselect_b32 s91, 16777216, s91
    s_mov_b32 s42, 0
    s_cselect_b32 s42, 268435456, s42
    s_add_u32 s48, s90, s91
    s_mov_b32 s49, s48
    s_add_u32 s50, s48, 4096
    s_mov_b32 s51, s50
    s_mov_b32 s40, s6
    s_mov_b32 s41, s7
    v_mov_b32 v16, v2
    v_mov_b32 v17, v2
    s_branch m_loop20
m_x42:
    s_cmp_lg_u32 s65, 2
    s_cbranch_scc1 m_x43
    s_cmp_eq_u32 s70, 1
    s_cbranch_scc1 m_ea53
    s_and_b32 s92, s2, 7
    s_lshl_b32 s92, s92, 2
    s_bfe_u32 s93, s2, 0x20003
    s_add_u32 s92, s92, s93
    s_lshr_b32 s93, s2, 5
    s_lshl_b32 s93, s93, 2
    s_or_b32 s93, s93, 0x40000
    s_bfe_u32 s90, 4225681832, s93
    s_lshl_b32 s90, s90, 3
    s_lshl_b32 s91, s16, 1
    s_add_u32 s90, s90, s91
    s_lshl_b32 s90, s90, 12
    s_lshl_b32 s91, s92, 19
    s_add_u32 s90, s90, s91
    s_add_u32 s90, s90, 4096
    buffer_load_dwordx4 a[152:155], v2, s[8:11], s90 offen offset:2048 sc1
    buffer_load_dwordx4 a[156:159], v2, s[8:11], s90 offen offset:3072 sc1
    s_bfe_u32 s90, 873473623, s93
    s_lshl_b32 s90, s90, 3
    s_lshl_b32 s91, s16, 1
    s_add_u32 s90, s90, s91
    s_lshl_b32 s90, s90, 12
    s_lshl_b32 s91, s92, 19
    s_add_u32 s90, s90, s91
    s_add_u32 s90, s90, 0
    buffer_load_dwordx4 a[160:163], v2, s[8:11], s90 offen offset:0 sc1
    buffer_load_dwordx4 a[164:167], v2, s[8:11], s90 offen offset:1024 sc1
    buffer_load_dwordx4 a[168:171], v2, s[8:11], s90 offen offset:2048 sc1
m_eb54:
    s_lshl_b32 s90, s92, 19
    s_lshl_b32 s91, s58, 13
    s_add_u32 s90, s90, s91
    s_cmp_eq_u32 s57, 0
    s_mov_b32 s91, 33554432
    s_cselect_b32 s91, 16793600, s91
    s_mov_b32 s42, 268435456
    s_cselect_b32 s42, 268435456, s42
    s_add_u32 s48, s90, s91
    s_mov_b32 s49, s48
    s_add_u32 s50, s48, 4096
    s_mov_b32 s51, s50
    s_mov_b32 s40, s6
    s_mov_b32 s41, s7
    s_lshl_b32 s90, s92, 19
    s_lshl_b32 s91, s58, 13
    s_add_u32 s90, s90, s91
    s_cmp_eq_u32 s57, 0
    s_mov_b32 s91, 33587200
    s_cselect_b32 s91, 16826368, s91
    s_mov_b32 s46, 268435456
    s_cselect_b32 s46, 268435456, s46
    s_add_u32 s52, s90, s91
    s_mov_b32 s53, s52
    s_add_u32 s54, s52, 4096
    s_mov_b32 s55, s54
    s_mov_b32 s44, s6
    s_mov_b32 s45, s7
    v_mov_b32 v18, v2
    v_mov_b32 v19, v2
    v_mov_b32 v20, v2
    v_mov_b32 v21, v2
    s_branch m_loop20
m_x43:
    s_cmp_eq_u32 s70, 1
    s_cbranch_scc1 m_ea55
    s_and_b32 s92, s2, 7
    s_lshl_b32 s92, s92, 2
    s_bfe_u32 s93, s2, 0x20003
    s_add_u32 s92, s92, s93
    s_lshr_b32 s93, s2, 5
    s_lshl_b32 s93, s93, 2
    s_or_b32 s93, s93, 0x40000
    s_bfe_u32 s90, 873473623, s93
    s_lshl_b32 s90, s90, 3
    s_lshl_b32 s91, s16, 1
    s_add_u32 s90, s90, s91
    s_lshl_b32 s90, s90, 12
    s_lshl_b32 s91, s92, 19
    s_add_u32 s90, s90, s91
    s_add_u32 s90, s90, 0
    buffer_load_dwordx4 a[172:175], v2, s[8:11], s90 offen offset:3072 sc1
    s_bfe_u32 s90, 873473623, s93
    s_lshl_b32 s90, s90, 3
    s_lshl_b32 s91, s16, 1
    s_add_u32 s90, s90, s91
    s_lshl_b32 s90, s90, 12
    s_lshl_b32 s91, s92, 19
    s_add_u32 s90, s90, s91
    s_add_u32 s90, s90, 4096
    buffer_load_dwordx4 a[176:179], v2, s[8:11], s90 offen offset:0 sc1
    buffer_load_dwordx4 a[180:183], v2, s[8:11], s90 offen offset:1024 sc1
    buffer_load_dwordx4 a[184:187], v2, s[8:11], s90 offen offset:2048 sc1
    buffer_load_dwordx4 a[188:191], v2, s[8:11], s90 offen offset:3072 sc1
m_eb56:
    s_lshl_b32 s90, s92, 19
    s_lshl_b32 s91, s58, 13
    s_add_u32 s90, s90, s91
    s_cmp_eq_u32 s57, 0
    s_mov_b32 s91, 33570816
    s_cselect_b32 s91, 16809984, s91
    s_mov_b32 s42, 268435456
    s_cselect_b32 s42, 268435456, s42
    s_add_u32 s48, s90, s91
    s_mov_b32 s49, s48
    s_add_u32 s50, s48, 4096
    s_mov_b32 s51, s50
    s_mov_b32 s40, s6
    s_mov_b32 s41, s7
    s_lshl_b32 s90, s92, 19
    s_lshl_b32 s91, s58, 13
    s_add_u32 s90, s90, s91
    s_cmp_eq_u32 s57, 0
    s_mov_b32 s91, 33603584
    s_cselect_b32 s91, 16842752, s91
    s_mov_b32 s46, 268435456
    s_cselect_b32 s46, 268435456, s46
    s_add_u32 s52, s90, s91
    s_mov_b32 s53, s52
    s_add_u32 s54, s52, 4096
    s_mov_b32 s55, s54
    s_mov_b32 s44, s6
    s_mov_b32 s45, s7
    s_branch m_loop20
m_ea47:
    s_and_b32 s92, s2, 7
    s_lshl_b32 s92, s92, 2
    s_bfe_u32 s93, s2, 0x20003
    s_add_u32 s92, s92, s93
    s_lshr_b32 s93, s2, 5
    s_lshl_b32 s93, s93, 2
    s_or_b32 s93, s93, 0x40000
    s_lshr_b32 s90, s92, 1
    s_lshl_b32 s90, s90, 7
    s_add_u32 s90, s90, 117440512
    v_and_b32 v0, 3, v1
    v_min_u32 v0, 2, v0
    v_and_b32 v4, 4, v1
    v_add3_u32 v0, v0, v4, 8
    v_lshlrev_b32 v0, 3, v0
    buffer_load_dwordx2 v[4:5], v0, s[8:11], s90 offen sc1
    s_branch m_eb48
m_ea49:
    s_mov_b32 s3, 1048576
m_spin57:
    v_cmp_ne_u64 s[22:23], s[4:5], v[4:5]
    s_nop 3
    s_cmp_eq_u64 s[22:23], 0
    s_cbranch_scc1 m_ok58
    s_sub_u32 s3, s3, 1
    s_cbranch_scc1 m_ok58
    s_sleep 16
    s_and_b32 s92, s2, 7
    s_lshl_b32 s92, s92, 2
    s_bfe_u32 s93, s2, 0x20003
    s_add_u32 s92, s92, s93
    s_lshr_b32 s93, s2, 5
    s_lshl_b32 s93, s93, 2
    s_or_b32 s93, s93, 0x40000
    s_lshr_b32 s90, s92, 1
    s_lshl_b32 s90, s90, 7
    s_add_u32 s90, s90, 117440512
    v_and_b32 v0, 3, v1
    v_min_u32 v0, 2, v0
    v_and_b32 v4, 4, v1
    v_add3_u32 v0, v0, v4, 8
    v_lshlrev_b32 v0, 3, v0
    buffer_load_dwordx2 v[4:5], v0, s[8:11], s90 offen sc1
    s_waitcnt vmcnt(0)
    s_branch m_spin57
m_ok58:
    s_and_b32 s92, s2, 7
    s_lshl_b32 s92, s92, 2
    s_bfe_u32 s93, s2, 0x20003
    s_add_u32 s92, s92, s93
    s_lshr_b32 s93, s2, 5
    s_lshl_b32 s93, s93, 2
    s_or_b32 s93, s93, 0x40000
    s_branch m_eb50
m_ea53:
    s_and_b32 s92, s2, 7
    s_lshl_b32 s92, s92, 2
    s_bfe_u32 s93, s2, 0x20003
    s_add_u32 s92, s92, s93
    s_lshr_b32 s93, s2, 5
    s_lshl_b32 s93, s93, 2
    s_or_b32 s93, s93, 0x40000
    s_lshr_b32 s90, s92, 1
    s_lshl_b32 s90, s90, 7
    s_add_u32 s90, s90, 117440512
    s_bfe_u32 s91, 873473623, s93
    s_lshr_b32 s91, s91, 1
    v_mov_b32 v0, s91
    s_bfe_u32 s91, 4225681832, s93
    s_lshr_b32 s91, s91, 1
    v_writelane_b32 v0, s91, 8
    v_lshlrev_b32 v0, 3, v0
    buffer_load_dwordx2 v[4:5], v0, s[8:11], s90 offen sc1
    s_branch m_eb54
m_ea55:
    s_mov_b32 s3, 1048576
m_spin59:
    v_cmp_ne_u64 s[22:23], s[4:5], v[4:5]
    s_nop 3
    s_cmp_eq_u64 s[22:23], 0
    s_cbranch_scc1 m_ok60
    s_sub_u32 s3, s3, 1
    s_cbranch_scc1 m_ok60
    s_sleep 16
    s_and_b32 s92, s2, 7
    s_lshl_b32 s92, s92, 2
    s_bfe_u32 s93, s2, 0x20003
    s_add_u32 s92, s92, s93
    s_lshr_b32 s93, s2, 5
    s_lshl_b32 s93, s93, 2
    s_or_b32 s93, s93, 0x40000
    s_lshr_b32 s90, s92, 1
    s_lshl_b32 s90, s90, 7
    s_add_u32 s90, s90, 117440512
    s_bfe_u32 s91, 873473623, s93
    s_lshr_b32 s91, s91, 1
    v_mov_b32 v0, s91
    s_bfe_u32 s91, 4225681832, s93
    s_lshr_b32 s91, s91, 1
    v_writelane_b32 v0, s91, 8
    v_lshlrev_b32 v0, 3, v0
    buffer_load_dwordx2 v[4:5], v0, s[8:11], s90 offen sc1
    s_waitcnt vmcnt(0)
    s_branch m_spin59
m_ok60:
    s_and_b32 s92, s2, 7
    s_lshl_b32 s92, s92, 2
    s_bfe_u32 s93, s2, 0x20003
    s_add_u32 s92, s92, s93
    s_lshr_b32 s93, s2, 5
    s_lshl_b32 s93, s93, 2
    s_or_b32 s93, s93, 0x40000
    s_bfe_u32 s90, 4225681832, s93
    s_lshl_b32 s90, s90, 3
    s_lshl_b32 s91, s16, 1
    s_add_u32 s90, s90, s91
    s_lshl_b32 s90, s90, 12
    s_lshl_b32 s91, s92, 19
    s_add_u32 s90, s90, s91
    s_add_u32 s90, s90, 0
    buffer_load_dwordx4 a[128:131], v2, s[8:11], s90 offen offset:0 sc1
    buffer_load_dwordx4 a[132:135], v2, s[8:11], s90 offen offset:1024 sc1
    buffer_load_dwordx4 a[136:139], v2, s[8:11], s90 offen offset:2048 sc1
    buffer_load_dwordx4 a[140:143], v2, s[8:11], s90 offen offset:3072 sc1
    s_bfe_u32 s90, 4225681832, s93
    s_lshl_b32 s90, s90, 3
    s_lshl_b32 s91, s16, 1
    s_add_u32 s90, s90, s91
    s_lshl_b32 s90, s90, 12
    s_lshl_b32 s91, s92, 19
    s_add_u32 s90, s90, s91
    s_add_u32 s90, s90, 4096
    buffer_load_dwordx4 a[144:147], v2, s[8:11], s90 offen offset:0 sc1
    buffer_load_dwordx4 a[148:151], v2, s[8:11], s90 offen offset:1024 sc1
    buffer_load_dwordx4 a[152:155], v2, s[8:11], s90 offen offset:2048 sc1
    buffer_load_dwordx4 a[156:159], v2, s[8:11], s90 offen offset:3072 sc1
    s_bfe_u32 s90, 873473623, s93
    s_lshl_b32 s90, s90, 3
    s_lshl_b32 s91, s16, 1
    s_add_u32 s90, s90, s91
    s_lshl_b32 s90, s90, 12
    s_lshl_b32 s91, s92, 19
    s_add_u32 s90, s90, s91
    s_add_u32 s90, s90, 0
    buffer_load_dwordx4 a[160:163], v2, s[8:11], s90 offen offset:0 sc1
    buffer_load_dwordx4 a[164:167], v2, s[8:11], s90 offen offset:1024 sc1
    buffer_load_dwordx4 a[168:171], v2, s[8:11], s90 offen offset:2048 sc1
    buffer_load_dwordx4 a[172:175], v2, s[8:11], s90 offen offset:3072 sc1
    s_bfe_u32 s90, 873473623, s93
    s_lshl_b32 s90, s90, 3
    s_lshl_b32 s91, s16, 1
    s_add_u32 s90, s90, s91
    s_lshl_b32 s90, s90, 12
    s_lshl_b32 s91, s92, 19
    s_add_u32 s90, s90, s91
    s_add_u32 s90, s90, 4096
    buffer_load_dwordx4 a[176:179], v2, s[8:11], s90 offen offset:0 sc1
    buffer_load_dwordx4 a[180:183], v2, s[8:11], s90 offen offset:1024 sc1
    buffer_load_dwordx4 a[184:187], v2, s[8:11], s90 offen offset:2048 sc1
    buffer_load_dwordx4 a[188:191], v2, s[8:11], s90 offen offset:3072 sc1
    s_branch m_eb56
m_swp16:
    s_waitcnt lgkmcnt(15)
    v_mfma_f32_16x16x32_bf16 v[32:35], a[0:3], a[64:67], 0
    ds_read_b64_tr_b16 a[112:113], v14 offset:0
    v_mfma_f32_16x16x32_bf16 v[32:35], a[4:7], a[68:71], v[32:35]
    ds_read_b64_tr_b16 a[114:115], v14 offset:2048
    v_mfma_f32_16x16x32_bf16 v[40:43], a[4:7], a[76:79], 0
    ds_read_b64_tr_b16 a[116:117], v14 offset:16384
    v_mfma_f32_16x16x32_bf16 v[40:43], a[0:3], a[72:75], v[40:43]
    ds_read_b64_tr_b16 a[118:119], v14 offset:18432
    v_mfma_f32_16x16x32_bf16 v[44:47], a[8:11], a[72:75], 0
    ds_read_b64_tr_b16 a[120:121], v15 offset:0
    v_mfma_f32_16x16x32_bf16 v[44:47], a[12:15], a[76:79], v[44:47]
    ds_read_b64_tr_b16 a[122:123], v15 offset:2048
    v_mfma_f32_16x16x32_bf16 v[36:39], a[12:15], a[68:71], 0
    ds_read_b64_tr_b16 a[124:125], v15 offset:16384
    v_mfma_f32_16x16x32_bf16 v[36:39], a[8:11], a[64:67], v[36:39]
    ds_read_b64_tr_b16 a[126:127], v15 offset:18432
    v_mfma_f32_16x16x32_bf16 v[96:99], a[16:19], a[64:67], 0
    v_mfma_f32_16x16x32_bf16 v[96:99], a[20:23], a[68:71], v[96:99]
    v_mfma_f32_16x16x32_bf16 v[104:107], a[20:23], a[76:79], 0
    buffer_store_dwordx4 a[128:131], v2, s[24:27], s28 offen sc1
    v_mfma_f32_16x16x32_bf16 v[104:107], a[16:19], a[72:75], v[104:107]
    s_add_u32 s28, s28, s31
    s_waitcnt lgkmcnt(15)
    v_mfma_f32_16x16x32_bf16 v[108:111], a[24:27], a[72:75], 0
    v_xor_b32 v8, s60, v8
    v_xor_b32 v9, s60, v9
    v_mfma_f32_16x16x32_bf16 v[108:111], a[28:31], a[76:79], v[108:111]
    v_xor_b32 v10, s60, v10
    v_xor_b32 v11, s60, v11
    v_mfma_f32_16x16x32_bf16 v[100:103], a[28:31], a[68:71], 0
    v_xor_b32 v12, s60, v12
    v_xor_b32 v13, s60, v13
    v_mfma_f32_16x16x32_bf16 v[100:103], a[24:27], a[64:67], v[100:103]
    v_xor_b32 v14, s60, v14
    v_xor_b32 v15, s60, v15
    v_mfma_f32_16x16x32_bf16 v[160:163], a[32:35], a[64:67], 0
    buffer_store_dwordx4 a[132:135], v2, s[24:27], s28 offen sc1
    v_mfma_f32_16x16x32_bf16 v[160:163], a[36:39], a[68:71], v[160:163]
    s_add_u32 s28, s28, s31
    v_mfma_f32_16x16x32_bf16 v[168:171], a[36:39], a[76:79], 0
    v_mfma_f32_16x16x32_bf16 v[168:171], a[32:35], a[72:75], v[168:171]
    s_waitcnt lgkmcnt(14)
    v_mfma_f32_16x16x32_bf16 v[172:175], a[40:43], a[72:75], 0
    v_mfma_f32_16x16x32_bf16 v[172:175], a[44:47], a[76:79], v[172:175]
    v_mfma_f32_16x16x32_bf16 v[164:167], a[44:47], a[68:71], 0
    buffer_store_dwordx4 a[136:139], v2, s[24:27], s28 offen sc1
    v_mfma_f32_16x16x32_bf16 v[164:167], a[40:43], a[64:67], v[164:167]
    s_add_u32 s28, s28, s31
    s_waitcnt lgkmcnt(11)
    v_mfma_f32_16x16x32_bf16 v[224:227], a[48:51], a[64:67], 0
    v_mfma_f32_16x16x32_bf16 v[224:227], a[52:55], a[68:71], v[224:227]
    v_mfma_f32_16x16x32_bf16 v[232:235], a[52:55], a[76:79], 0
    v_mfma_f32_16x16x32_bf16 v[232:235], a[48:51], a[72:75], v[232:235]
    s_waitcnt lgkmcnt(8)
    v_mfma_f32_16x16x32_bf16 v[236:239], a[56:59], a[72:75], 0
    buffer_store_dwordx4 a[140:143], v2, s[24:27], s28 offen sc1
    v_mfma_f32_16x16x32_bf16 v[236:239], a[60:63], a[76:79], v[236:239]
    s_add_u32 s28, s28, s31
    v_mfma_f32_16x16x32_bf16 v[228:231], a[60:63], a[68:71], 0
    s_waitcnt vmcnt(44) lgkmcnt(0)
    s_cmp_eq_u32 s66, 2
    s_cbranch_scc1 m_w22
    s_waitcnt vmcnt(12)
m_w22:
    v_mfma_f32_16x16x32_bf16 v[228:231], a[56:59], a[64:67], v[228:231]
    s_barrier
    v_mfma_f32_16x16x32_bf16 v[48:51], a[0:3], a[80:83], 0
    ds_read_b64_tr_b16 a[64:65], v8 offset:0
    v_mfma_f32_16x16x32_bf16 v[48:51], a[4:7], a[84:87], v[48:51]
    s_add_u32 m0, s62, 0
    v_mfma_f32_16x16x32_bf16 v[56:59], a[4:7], a[92:95], 0
    buffer_load_dwordx4 v18, s[44:47], s52 offen offset:0 sc1 lds
    v_mfma_f32_16x16x32_bf16 v[56:59], a[0:3], a[88:91], v[56:59]
    ds_read_b64_tr_b16 a[66:67], v8 offset:2048
    v_mfma_f32_16x16x32_bf16 v[60:63], a[8:11], a[88:91], 0
    s_add_u32 s64, s64, 32768
    v_mfma_f32_16x16x32_bf16 v[60:63], a[12:15], a[92:95], v[60:63]
    s_cmp_ge_u32 s64, 98304
    s_cselect_b32 s63, 4294901760, s59
    s_cselect_b32 s64, 0, s64
    v_mfma_f32_16x16x32_bf16 v[52:55], a[12:15], a[84:87], 0
    buffer_load_dwordx4 v19, s[44:47], s52 offen offset:1024 sc1 lds
    v_mfma_f32_16x16x32_bf16 v[52:55], a[8:11], a[80:83], v[52:55]
    s_add_u32 s52, s52, s56
    ds_read_b64_tr_b16 a[68:69], v8 offset:16384
    v_mfma_f32_16x16x32_bf16 v[112:115], a[16:19], a[80:83], 0
    v_mfma_f32_16x16x32_bf16 v[112:115], a[20:23], a[84:87], v[112:115]
    v_mfma_f32_16x16x32_bf16 v[120:123], a[20:23], a[92:95], 0
    buffer_load_dwordx4 v18, s[44:47], s53 offen offset:2048 sc1 lds
    v_mfma_f32_16x16x32_bf16 v[120:123], a[16:19], a[88:91], v[120:123]
    ds_read_b64_tr_b16 a[70:71], v8 offset:18432
    v_mfma_f32_16x16x32_bf16 v[124:127], a[24:27], a[88:91], 0
    v_mfma_f32_16x16x32_bf16 v[124:127], a[28:31], a[92:95], v[124:127]
    v_mfma_f32_16x16x32_bf16 v[116:119], a[28:31], a[84:87], 0
    buffer_load_dwordx4 v19, s[44:47], s53 offen offset:3072 sc1 lds
    v_mfma_f32_16x16x32_bf16 v[116:119], a[24:27], a[80:83], v[116:119]
    s_add_u32 s53, s53, s56
    ds_read_b64_tr_b16 a[72:73], v9 offset:0
    v_mfma_f32_16x16x32_bf16 v[176:179], a[32:35], a[80:83], 0
    v_mfma_f32_16x16x32_bf16 v[176:179], a[36:39], a[84:87], v[176:179]
    s_add_u32 m0, s62, 4096
    v_mfma_f32_16x16x32_bf16 v[184:187], a[36:39], a[92:95], 0
    buffer_load_dwordx4 v20, s[44:47], s54 offen offset:0 sc1 lds
    v_mfma_f32_16x16x32_bf16 v[184:187], a[32:35], a[88:91], v[184:187]
    s_xor_b32 s62, s62, 229376
    ds_read_b64_tr_b16 a[74:75], v9 offset:2048
    v_mfma_f32_16x16x32_bf16 v[188:191], a[40:43], a[88:91], 0
    v_mfma_f32_16x16x32_bf16 v[188:191], a[44:47], a[92:95], v[188:191]
    v_mfma_f32_16x16x32_bf16 v[180:183], a[44:47], a[84:87], 0
    buffer_load_dwordx4 v21, s[44:47], s54 offen offset:1024 sc1 lds
    v_mfma_f32_16x16x32_bf16 v[180:183], a[40:43], a[80:83], v[180:183]
    s_add_u32 s54, s54, s56
    ds_read_b64_tr_b16 a[76:77], v9 offset:16384
    v_mfma_f32_16x16x32_bf16 v[240:243], a[48:51], a[80:83], 0
    v_mfma_f32_16x16x32_bf16 v[240:243], a[52:55], a[84:87], v[240:243]
    v_mfma_f32_16x16x32_bf16 v[248:251], a[52:55], a[92:95], 0
    buffer_load_dwordx4 v20, s[44:47], s55 offen offset:2048 sc1 lds
    v_mfma_f32_16x16x32_bf16 v[248:251], a[48:51], a[88:91], v[248:251]
    ds_read_b64_tr_b16 a[78:79], v9 offset:18432
    v_mfma_f32_16x16x32_bf16 v[252:255], a[56:59], a[88:91], 0
    v_add_u32 v6, s63, v6
    v_add_u32 v7, s63, v7
    v_mfma_f32_16x16x32_bf16 v[252:255], a[60:63], a[92:95], v[252:255]
    v_mfma_f32_16x16x32_bf16 v[244:247], a[60:63], a[84:87], 0
    buffer_load_dwordx4 v21, s[44:47], s55 offen offset:3072 sc1 lds
    v_mfma_f32_16x16x32_bf16 v[244:247], a[56:59], a[80:83], v[244:247]
    s_add_u32 s55, s55, s56
    v_mfma_f32_16x16x32_bf16 v[64:67], a[0:3], a[96:99], 0
    ds_read_b64_tr_b16 a[80:81], v10 offset:0
    v_mfma_f32_16x16x32_bf16 v[64:67], a[4:7], a[100:103], v[64:67]
    v_mfma_f32_16x16x32_bf16 v[72:75], a[4:7], a[108:111], 0
    v_mfma_f32_16x16x32_bf16 v[72:75], a[0:3], a[104:107], v[72:75]
    s_add_u32 m0, s61, 0
    ds_read_b64_tr_b16 a[82:83], v10 offset:2048
    v_mfma_f32_16x16x32_bf16 v[76:79], a[8:11], a[104:107], 0
    buffer_load_dwordx4 v16, s[40:43], s48 offen offset:0 sc1 lds
    v_mfma_f32_16x16x32_bf16 v[76:79], a[12:15], a[108:111], v[76:79]
    v_mfma_f32_16x16x32_bf16 v[68:71], a[12:15], a[100:103], 0
    ds_read_b64_tr_b16 a[84:85], v10 offset:16384
    v_mfma_f32_16x16x32_bf16 v[68:71], a[8:11], a[96:99], v[68:71]
    v_mfma_f32_16x16x32_bf16 v[128:131], a[16:19], a[96:99], 0
    buffer_store_dwordx4 a[144:147], v2, s[24:27], s28 offen sc1
    v_mfma_f32_16x16x32_bf16 v[128:131], a[20:23], a[100:103], v[128:131]
    s_add_u32 s28, s28, s31
    ds_read_b64_tr_b16 a[86:87], v10 offset:18432
    v_mfma_f32_16x16x32_bf16 v[136:139], a[20:23], a[108:111], 0
    v_mfma_f32_16x16x32_bf16 v[136:139], a[16:19], a[104:107], v[136:139]
    v_mfma_f32_16x16x32_bf16 v[140:143], a[24:27], a[104:107], 0
    buffer_load_dwordx4 v17, s[40:43], s48 offen offset:1024 sc1 lds
    v_mfma_f32_16x16x32_bf16 v[140:143], a[28:31], a[108:111], v[140:143]
    s_add_u32 s48, s48, 128
    ds_read_b64_tr_b16 a[88:89], v11 offset:0
    v_mfma_f32_16x16x32_bf16 v[132:135], a[28:31], a[100:103], 0
    v_mfma_f32_16x16x32_bf16 v[132:135], a[24:27], a[96:99], v[132:135]
    v_mfma_f32_16x16x32_bf16 v[192:195], a[32:35], a[96:99], 0
    buffer_store_dwordx4 a[148:151], v2, s[24:27], s28 offen sc1
    v_mfma_f32_16x16x32_bf16 v[192:195], a[36:39], a[100:103], v[192:195]
    s_add_u32 s28, s28, s31
    ds_read_b64_tr_b16 a[90:91], v11 offset:2048
    v_mfma_f32_16x16x32_bf16 v[200:203], a[36:39], a[108:111], 0
    v_mfma_f32_16x16x32_bf16 v[200:203], a[32:35], a[104:107], v[200:203]
    v_mfma_f32_16x16x32_bf16 v[204:207], a[40:43], a[104:107], 0
    buffer_load_dwordx4 v16, s[40:43], s49 offen offset:2048 sc1 lds
    v_mfma_f32_16x16x32_bf16 v[204:207], a[44:47], a[108:111], v[204:207]
    ds_read_b64_tr_b16 a[92:93], v11 offset:16384
    v_mfma_f32_16x16x32_bf16 v[196:199], a[44:47], a[100:103], 0
    v_mfma_f32_16x16x32_bf16 v[196:199], a[40:43], a[96:99], v[196:199]
    v_mfma_f32_16x16x32_bf16 a[224:227], a[48:51], a[96:99], 0
    buffer_store_dwordx4 a[152:155], v2, s[24:27], s28 offen sc1
    v_mfma_f32_16x16x32_bf16 a[224:227], a[52:55], a[100:103], a[224:227]
    s_add_u32 s28, s28, s31
    ds_read_b64_tr_b16 a[94:95], v11 offset:18432
    v_mfma_f32_16x16x32_bf16 a[232:235], a[52:55], a[108:111], 0
    v_mfma_f32_16x16x32_bf16 a[232:235], a[48:51], a[104:107], a[232:235]
    v_mfma_f32_16x16x32_bf16 a[236:239], a[56:59], a[104:107], 0
    buffer_load_dwordx4 v17, s[40:43], s49 offen offset:3072 sc1 lds
    v_mfma_f32_16x16x32_bf16 a[236:239], a[60:63], a[108:111], a[236:239]
    s_add_u32 s49, s49, 128
    v_mfma_f32_16x16x32_bf16 a[228:231], a[60:63], a[100:103], 0
    buffer_store_dwordx4 a[156:159], v2, s[24:27], s28 offen sc1
    v_mfma_f32_16x16x32_bf16 a[228:231], a[56:59], a[96:99], a[228:231]
    s_add_u32 s29, s29, s30
    s_mov_b32 s28, s29
    v_mfma_f32_16x16x32_bf16 v[80:83], a[0:3], a[112:115], 0
    v_mfma_f32_16x16x32_bf16 v[80:83], a[4:7], a[116:119], v[80:83]
    ds_read_b64_tr_b16 a[96:97], v12 offset:0
    v_mfma_f32_16x16x32_bf16 v[88:91], a[4:7], a[124:127], 0
    v_mfma_f32_16x16x32_bf16 v[88:91], a[0:3], a[120:123], v[88:91]
    s_add_u32 m0, s61, 4096
    ds_read_b128 a[0:3], v6 offset:0
    v_mfma_f32_16x16x32_bf16 v[92:95], a[8:11], a[120:123], 0
    buffer_load_dwordx4 v16, s[40:43], s50 offen offset:0 sc1 lds
    v_mfma_f32_16x16x32_bf16 v[92:95], a[12:15], a[124:127], v[92:95]
    s_add_u32 s61, s61, 32768
    ds_read_b128 a[4:7], v7 offset:0
    v_mfma_f32_16x16x32_bf16 v[84:87], a[12:15], a[116:119], 0
    s_cmp_ge_u32 s61, 98304
    s_cselect_b32 s90, 98304, 0
    ds_read_b64_tr_b16 a[98:99], v12 offset:2048
    v_mfma_f32_16x16x32_bf16 v[84:87], a[8:11], a[112:115], v[84:87]
    s_sub_u32 s61, s61, s90
    ds_read_b128 a[8:11], v6 offset:2048
    v_mfma_f32_16x16x32_bf16 v[144:147], a[16:19], a[112:115], 0
    ds_read_b128 a[12:15], v7 offset:2048
    v_mfma_f32_16x16x32_bf16 v[144:147], a[20:23], a[116:119], v[144:147]
    ds_read_b64_tr_b16 a[100:101], v12 offset:16384
    v_mfma_f32_16x16x32_bf16 v[152:155], a[20:23], a[124:127], 0
    v_mfma_f32_16x16x32_bf16 v[152:155], a[16:19], a[120:123], v[152:155]
    ds_read_b128 a[16:19], v6 offset:4096
    v_mfma_f32_16x16x32_bf16 v[156:159], a[24:27], a[120:123], 0
    buffer_load_dwordx4 v17, s[40:43], s50 offen offset:1024 sc1 lds
    v_mfma_f32_16x16x32_bf16 v[156:159], a[28:31], a[124:127], v[156:159]
    s_add_u32 s50, s50, 128
    ds_read_b128 a[20:23], v7 offset:4096
    v_mfma_f32_16x16x32_bf16 v[148:151], a[28:31], a[116:119], 0
    ds_read_b64_tr_b16 a[102:103], v12 offset:18432
    v_mfma_f32_16x16x32_bf16 v[148:151], a[24:27], a[112:115], v[148:151]
    ds_read_b128 a[24:27], v6 offset:6144
    v_mfma_f32_16x16x32_bf16 v[208:211], a[32:35], a[112:115], 0
    s_sub_u32 s65, s65, 1
    ds_read_b128 a[28:31], v7 offset:6144
    v_mfma_f32_16x16x32_bf16 v[208:211], a[36:39], a[116:119], v[208:211]
    ds_read_b64_tr_b16 a[104:105], v13 offset:0
    v_mfma_f32_16x16x32_bf16 v[216:219], a[36:39], a[124:127], 0
    v_mfma_f32_16x16x32_bf16 v[216:219], a[32:35], a[120:123], v[216:219]
    ds_read_b128 a[32:35], v6 offset:8192
    v_mfma_f32_16x16x32_bf16 v[220:223], a[40:43], a[120:123], 0
    buffer_load_dwordx4 v16, s[40:43], s51 offen offset:2048 sc1 lds
    v_mfma_f32_16x16x32_bf16 v[220:223], a[44:47], a[124:127], v[220:223]
    ds_read_b128 a[36:39], v7 offset:8192
    v_mfma_f32_16x16x32_bf16 v[212:215], a[44:47], a[116:119], 0
    ds_read_b64_tr_b16 a[106:107], v13 offset:2048
    v_mfma_f32_16x16x32_bf16 v[212:215], a[40:43], a[112:115], v[212:215]
    ds_read_b128 a[40:43], v6 offset:10240
    v_mfma_f32_16x16x32_bf16 a[240:243], a[48:51], a[112:115], 0
    ds_read_b128 a[44:47], v7 offset:10240
    v_mfma_f32_16x16x32_bf16 a[240:243], a[52:55], a[116:119], a[240:243]
    ds_read_b64_tr_b16 a[108:109], v13 offset:16384
    v_mfma_f32_16x16x32_bf16 a[248:251], a[52:55], a[124:127], 0
    v_mfma_f32_16x16x32_bf16 a[248:251], a[48:51], a[120:123], a[248:251]
    ds_read_b128 a[48:51], v6 offset:12288
    v_mfma_f32_16x16x32_bf16 a[252:255], a[56:59], a[120:123], 0
    buffer_load_dwordx4 v17, s[40:43], s51 offen offset:3072 sc1 lds
    v_mfma_f32_16x16x32_bf16 a[252:255], a[60:63], a[124:127], a[252:255]
    s_add_u32 s51, s51, 128
    ds_read_b128 a[52:55], v7 offset:12288
    v_mfma_f32_16x16x32_bf16 a[244:247], a[60:63], a[116:119], 0
    ds_read_b64_tr_b16 a[110:111], v13 offset:18432
    v_mfma_f32_16x16x32_bf16 a[244:247], a[56:59], a[112:115], a[244:247]
    ds_read_b128 a[56:59], v6 offset:14336
    ds_read_b128 a[60:63], v7 offset:14336
    s_waitcnt lgkmcnt(15)
    v_mfma_f32_16x16x32_bf16 v[32:35], a[0:3], a[64:67], v[32:35]
    ds_read_b64_tr_b16 a[112:113], v14 offset:0
    v_mfma_f32_16x16x32_bf16 v[32:35], a[4:7], a[68:71], v[32:35]
    ds_read_b64_tr_b16 a[114:115], v14 offset:2048
    v_mfma_f32_16x16x32_bf16 v[40:43], a[4:7], a[76:79], v[40:43]
    ds_read_b64_tr_b16 a[116:117], v14 offset:16384
    v_mfma_f32_16x16x32_bf16 v[40:43], a[0:3], a[72:75], v[40:43]
    ds_read_b64_tr_b16 a[118:119], v14 offset:18432
    v_mfma_f32_16x16x32_bf16 v[44:47], a[8:11], a[72:75], v[44:47]
    ds_read_b64_tr_b16 a[120:121], v15 offset:0
    v_mfma_f32_16x16x32_bf16 v[44:47], a[12:15], a[76:79], v[44:47]
    ds_read_b64_tr_b16 a[122:123], v15 offset:2048
    v_mfma_f32_16x16x32_bf16 v[36:39], a[12:15], a[68:71], v[36:39]
    ds_read_b64_tr_b16 a[124:125], v15 offset:16384
    v_mfma_f32_16x16x32_bf16 v[36:39], a[8:11], a[64:67], v[36:39]
    ds_read_b64_tr_b16 a[126:127], v15 offset:18432
    v_mfma_f32_16x16x32_bf16 v[96:99], a[16:19], a[64:67], v[96:99]
    v_mfma_f32_16x16x32_bf16 v[96:99], a[20:23], a[68:71], v[96:99]
    v_mfma_f32_16x16x32_bf16 v[104:107], a[20:23], a[76:79], v[104:107]
    buffer_store_dwordx4 a[160:163], v2, s[24:27], s28 offen sc1
    v_mfma_f32_16x16x32_bf16 v[104:107], a[16:19], a[72:75], v[104:107]
    s_add_u32 s28, s28, s31
    s_waitcnt lgkmcnt(15)
    v_mfma_f32_16x16x32_bf16 v[108:111], a[24:27], a[72:75], v[108:111]
    v_xor_b32 v8, s60, v8
    v_xor_b32 v9, s60, v9
    v_mfma_f32_16x16x32_bf16 v[108:111], a[28:31], a[76:79], v[108:111]
    v_xor_b32 v10, s60, v10
    v_xor_b32 v11, s60, v11
    v_mfma_f32_16x16x32_bf16 v[100:103], a[28:31], a[68:71], v[100:103]
    v_xor_b32 v12, s60, v12
    v_xor_b32 v13, s60, v13
    v_mfma_f32_16x16x32_bf16 v[100:103], a[24:27], a[64:67], v[100:103]
    v_xor_b32 v14, s60, v14
    v_xor_b32 v15, s60, v15
    v_mfma_f32_16x16x32_bf16 v[160:163], a[32:35], a[64:67], v[160:163]
    buffer_store_dwordx4 a[164:167], v2, s[24:27], s28 offen sc1
    v_mfma_f32_16x16x32_bf16 v[160:163], a[36:39], a[68:71], v[160:163]
    s_add_u32 s28, s28, s31
    v_mfma_f32_16x16x32_bf16 v[168:171], a[36:39], a[76:79], v[168:171]
    v_mfma_f32_16x16x32_bf16 v[168:171], a[32:35], a[72:75], v[168:171]
    s_waitcnt lgkmcnt(14)
    v_mfma_f32_16x16x32_bf16 v[172:175], a[40:43], a[72:75], v[172:175]
    v_mfma_f32_16x16x32_bf16 v[172:175], a[44:47], a[76:79], v[172:175]
    v_mfma_f32_16x16x32_bf16 v[164:167], a[44:47], a[68:71], v[164:167]
    buffer_store_dwordx4 a[168:171], v2, s[24:27], s28 offen sc1
    v_mfma_f32_16x16x32_bf16 v[164:167], a[40:43], a[64:67], v[164:167]
    s_add_u32 s28, s28, s31
    s_waitcnt lgkmcnt(11)
    v_mfma_f32_16x16x32_bf16 v[224:227], a[48:51], a[64:67], v[224:227]
    v_mfma_f32_16x16x32_bf16 v[224:227], a[52:55], a[68:71], v[224:227]
    v_mfma_f32_16x16x32_bf16 v[232:235], a[52:55], a[76:79], v[232:235]
    v_mfma_f32_16x16x32_bf16 v[232:235], a[48:51], a[72:75], v[232:235]
    s_waitcnt lgkmcnt(8)
    v_mfma_f32_16x16x32_bf16 v[236:239], a[56:59], a[72:75], v[236:239]
    buffer_store_dwordx4 a[172:175], v2, s[24:27], s28 offen sc1
    v_mfma_f32_16x16x32_bf16 v[236:239], a[60:63], a[76:79], v[236:239]
    s_add_u32 s28, s28, s31
    v_mfma_f32_16x16x32_bf16 v[228:231], a[60:63], a[68:71], v[228:231]
    s_waitcnt vmcnt(16) lgkmcnt(0)
    v_mfma_f32_16x16x32_bf16 v[228:231], a[56:59], a[64:67], v[228:231]
    s_barrier
    v_mfma_f32_16x16x32_bf16 v[48:51], a[0:3], a[80:83], v[48:51]
    ds_read_b64_tr_b16 a[64:65], v8 offset:0
    v_mfma_f32_16x16x32_bf16 v[48:51], a[4:7], a[84:87], v[48:51]
    s_add_u32 m0, s62, 0
    v_mfma_f32_16x16x32_bf16 v[56:59], a[4:7], a[92:95], v[56:59]
    buffer_load_dwordx4 v18, s[44:47], s52 offen offset:0 sc1 lds
    v_mfma_f32_16x16x32_bf16 v[56:59], a[0:3], a[88:91], v[56:59]
    ds_read_b64_tr_b16 a[66:67], v8 offset:2048
    v_mfma_f32_16x16x32_bf16 v[60:63], a[8:11], a[88:91], v[60:63]
    s_add_u32 s64, s64, 32768
    v_mfma_f32_16x16x32_bf16 v[60:63], a[12:15], a[92:95], v[60:63]
    s_cmp_ge_u32 s64, 98304
    s_cselect_b32 s63, 4294901760, s59
    s_cselect_b32 s64, 0, s64
    v_mfma_f32_16x16x32_bf16 v[52:55], a[12:15], a[84:87], v[52:55]
    buffer_load_dwordx4 v19, s[44:47], s52 offen offset:1024 sc1 lds
    v_mfma_f32_16x16x32_bf16 v[52:55], a[8:11], a[80:83], v[52:55]
    s_add_u32 s52, s52, s56
    ds_read_b64_tr_b16 a[68:69], v8 offset:16384
    v_mfma_f32_16x16x32_bf16 v[112:115], a[16:19], a[80:83], v[112:115]
    v_mfma_f32_16x16x32_bf16 v[112:115], a[20:23], a[84:87], v[112:115]
    v_mfma_f32_16x16x32_bf16 v[120:123], a[20:23], a[92:95], v[120:123]
    buffer_load_dwordx4 v18, s[44:47], s53 offen offset:2048 sc1 lds
    v_mfma_f32_16x16x32_bf16 v[120:123], a[16:19], a[88:91], v[120:123]
    ds_read_b64_tr_b16 a[70:71], v8 offset:18432
    v_mfma_f32_16x16x32_bf16 v[124:127], a[24:27], a[88:91], v[124:127]
    v_mfma_f32_16x16x32_bf16 v[124:127], a[28:31], a[92:95], v[124:127]
    v_mfma_f32_16x16x32_bf16 v[116:119], a[28:31], a[84:87], v[116:119]
    buffer_load_dwordx4 v19, s[44:47], s53 offen offset:3072 sc1 lds
    v_mfma_f32_16x16x32_bf16 v[116:119], a[24:27], a[80:83], v[116:119]
    s_add_u32 s53, s53, s56
    ds_read_b64_tr_b16 a[72:73], v9 offset:0
    v_mfma_f32_16x16x32_bf16 v[176:179], a[32:35], a[80:83], v[176:179]
    v_mfma_f32_16x16x32_bf16 v[176:179], a[36:39], a[84:87], v[176:179]
    s_add_u32 m0, s62, 4096
    v_mfma_f32_16x16x32_bf16 v[184:187], a[36:39], a[92:95], v[184:187]
    buffer_load_dwordx4 v20, s[44:47], s54 offen offset:0 sc1 lds
    v_mfma_f32_16x16x32_bf16 v[184:187], a[32:35], a[88:91], v[184:187]
    s_xor_b32 s62, s62, 229376
    ds_read_b64_tr_b16 a[74:75], v9 offset:2048
    v_mfma_f32_16x16x32_bf16 v[188:191], a[40:43], a[88:91], v[188:191]
    v_mfma_f32_16x16x32_bf16 v[188:191], a[44:47], a[92:95], v[188:191]
    v_mfma_f32_16x16x32_bf16 v[180:183], a[44:47], a[84:87], v[180:183]
    buffer_load_dwordx4 v21, s[44:47], s54 offen offset:1024 sc1 lds
    v_mfma_f32_16x16x32_bf16 v[180:183], a[40:43], a[80:83], v[180:183]
    s_add_u32 s54, s54, s56
    ds_read_b64_tr_b16 a[76:77], v9 offset:16384
    v_mfma_f32_16x16x32_bf16 v[240:243], a[48:51], a[80:83], v[240:243]
    v_mfma_f32_16x16x32_bf16 v[240:243], a[52:55], a[84:87], v[240:243]
    v_mfma_f32_16x16x32_bf16 v[248:251], a[52:55], a[92:95], v[248:251]
    buffer_load_dwordx4 v20, s[44:47], s55 offen offset:2048 sc1 lds
    v_mfma_f32_16x16x32_bf16 v[248:251], a[48:51], a[88:91], v[248:251]
    ds_read_b64_tr_b16 a[78:79], v9 offset:18432
    v_mfma_f32_16x16x32_bf16 v[252:255], a[56:59], a[88:91], v[252:255]
    v_add_u32 v6, s63, v6
    v_add_u32 v7, s63, v7
    v_mfma_f32_16x16x32_bf16 v[252:255], a[60:63], a[92:95], v[252:255]
    v_mfma_f32_16x16x32_bf16 v[244:247], a[60:63], a[84:87], v[244:247]
    buffer_load_dwordx4 v21, s[44:47], s55 offen offset:3072 sc1 lds
    v_mfma_f32_16x16x32_bf16 v[244:247], a[56:59], a[80:83], v[244:247]
    s_add_u32 s55, s55, s56
    v_mfma_f32_16x16x32_bf16 v[64:67], a[0:3], a[96:99], v[64:67]
    ds_read_b64_tr_b16 a[80:81], v10 offset:0
    v_mfma_f32_16x16x32_bf16 v[64:67], a[4:7], a[100:103], v[64:67]
    v_mfma_f32_16x16x32_bf16 v[72:75], a[4:7], a[108:111], v[72:75]
    v_mfma_f32_16x16x32_bf16 v[72:75], a[0:3], a[104:107], v[72:75]
    s_add_u32 m0, s61, 0
    ds_read_b64_tr_b16 a[82:83], v10 offset:2048
    v_mfma_f32_16x16x32_bf16 v[76:79], a[8:11], a[104:107], v[76:79]
    buffer_load_dwordx4 v16, s[40:43], s48 offen offset:0 sc1 lds
    v_mfma_f32_16x16x32_bf16 v[76:79], a[12:15], a[108:111], v[76:79]
    v_mfma_f32_16x16x32_bf16 v[68:71], a[12:15], a[100:103], v[68:71]
    ds_read_b64_tr_b16 a[84:85], v10 offset:16384
    v_mfma_f32_16x16x32_bf16 v[68:71], a[8:11], a[96:99], v[68:71]
    v_mfma_f32_16x16x32_bf16 v[128:131], a[16:19], a[96:99], v[128:131]
    buffer_store_dwordx4 a[176:179], v2, s[24:27], s28 offen sc1
    v_mfma_f32_16x16x32_bf16 v[128:131], a[20:23], a[100:103], v[128:131]
    s_add_u32 s28, s28, s31
    ds_read_b64_tr_b16 a[86:87], v10 offset:18432
    v_mfma_f32_16x16x32_bf16 v[136:139], a[20:23], a[108:111], v[136:139]
    v_mfma_f32_16x16x32_bf16 v[136:139], a[16:19], a[104:107], v[136:139]
    v_mfma_f32_16x16x32_bf16 v[140:143], a[24:27], a[104:107], v[140:143]
    buffer_load_dwordx4 v17, s[40:43], s48 offen offset:1024 sc1 lds
    v_mfma_f32_16x16x32_bf16 v[140:143], a[28:31], a[108:111], v[140:143]
    s_add_u32 s48, s48, 128
    ds_read_b64_tr_b16 a[88:89], v11 offset:0
    v_mfma_f32_16x16x32_bf16 v[132:135], a[28:31], a[100:103], v[132:135]
    v_mfma_f32_16x16x32_bf16 v[132:135], a[24:27], a[96:99], v[132:135]
    v_mfma_f32_16x16x32_bf16 v[192:195], a[32:35], a[96:99], v[192:195]
    buffer_store_dwordx4 a[180:183], v2, s[24:27], s28 offen sc1
    v_mfma_f32_16x16x32_bf16 v[192:195], a[36:39], a[100:103], v[192:195]
    s_add_u32 s28, s28, s31
    ds_read_b64_tr_b16 a[90:91], v11 offset:2048
    v_mfma_f32_16x16x32_bf16 v[200:203], a[36:39], a[108:111], v[200:203]
    v_mfma_f32_16x16x32_bf16 v[200:203], a[32:35], a[104:107], v[200:203]
    v_mfma_f32_16x16x32_bf16 v[204:207], a[40:43], a[104:107], v[204:207]
    buffer_load_dwordx4 v16, s[40:43], s49 offen offset:2048 sc1 lds
    v_mfma_f32_16x16x32_bf16 v[204:207], a[44:47], a[108:111], v[204:207]
    ds_read_b64_tr_b16 a[92:93], v11 offset:16384
    v_mfma_f32_16x16x32_bf16 v[196:199], a[44:47], a[100:103], v[196:199]
    v_mfma_f32_16x16x32_bf16 v[196:199], a[40:43], a[96:99], v[196:199]
    v_mfma_f32_16x16x32_bf16 a[224:227], a[48:51], a[96:99], a[224:227]
    buffer_store_dwordx4 a[184:187], v2, s[24:27], s28 offen sc1
    v_mfma_f32_16x16x32_bf16 a[224:227], a[52:55], a[100:103], a[224:227]
    s_add_u32 s28, s28, s31
    ds_read_b64_tr_b16 a[94:95], v11 offset:18432
    v_mfma_f32_16x16x32_bf16 a[232:235], a[52:55], a[108:111], a[232:235]
    v_mfma_f32_16x16x32_bf16 a[232:235], a[48:51], a[104:107], a[232:235]
    v_mfma_f32_16x16x32_bf16 a[236:239], a[56:59], a[104:107], a[236:239]
    buffer_load_dwordx4 v17, s[40:43], s49 offen offset:3072 sc1 lds
    v_mfma_f32_16x16x32_bf16 a[236:239], a[60:63], a[108:111], a[236:239]
    s_add_u32 s49, s49, 128
    v_mfma_f32_16x16x32_bf16 a[228:231], a[60:63], a[100:103], a[228:231]
    buffer_store_dwordx4 a[188:191], v2, s[24:27], s28 offen sc1
    v_mfma_f32_16x16x32_bf16 a[228:231], a[56:59], a[96:99], a[228:231]
    s_add_u32 s29, s29, s30
    s_mov_b32 s28, s29
    v_mfma_f32_16x16x32_bf16 v[80:83], a[0:3], a[112:115], v[80:83]
    v_mfma_f32_16x16x32_bf16 v[80:83], a[4:7], a[116:119], v[80:83]
    ds_read_b64_tr_b16 a[96:97], v12 offset:0
    v_mfma_f32_16x16x32_bf16 v[88:91], a[4:7], a[124:127], v[88:91]
    v_mfma_f32_16x16x32_bf16 v[88:91], a[0:3], a[120:123], v[88:91]
    s_add_u32 m0, s61, 4096
    ds_read_b128 a[0:3], v6 offset:0
    v_mfma_f32_16x16x32_bf16 v[92:95], a[8:11], a[120:123], v[92:95]
    buffer_load_dwordx4 v16, s[40:43], s50 offen offset:0 sc1 lds
    v_mfma_f32_16x16x32_bf16 v[92:95], a[12:15], a[124:127], v[92:95]
    s_add_u32 s61, s61, 32768
    ds_read_b128 a[4:7], v7 offset:0
    v_mfma_f32_16x16x32_bf16 v[84:87], a[12:15], a[116:119], v[84:87]
    s_cmp_ge_u32 s61, 98304
    s_cselect_b32 s90, 98304, 0
    ds_read_b64_tr_b16 a[98:99], v12 offset:2048
    v_mfma_f32_16x16x32_bf16 v[84:87], a[8:11], a[112:115], v[84:87]
    s_sub_u32 s61, s61, s90
    ds_read_b128 a[8:11], v6 offset:2048
    v_mfma_f32_16x16x32_bf16 v[144:147], a[16:19], a[112:115], v[144:147]
    ds_read_b128 a[12:15], v7 offset:2048
    v_mfma_f32_16x16x32_bf16 v[144:147], a[20:23], a[116:119], v[144:147]
    ds_read_b64_tr_b16 a[100:101], v12 offset:16384
    v_mfma_f32_16x16x32_bf16 v[152:155], a[20:23], a[124:127], v[152:155]
    v_mfma_f32_16x16x32_bf16 v[152:155], a[16:19], a[120:123], v[152:155]
    ds_read_b128 a[16:19], v6 offset:4096
    v_mfma_f32_16x16x32_bf16 v[156:159], a[24:27], a[120:123], v[156:159]
    buffer_load_dwordx4 v17, s[40:43], s50 offen offset:1024 sc1 lds
    v_mfma_f32_16x16x32_bf16 v[156:159], a[28:31], a[124:127], v[156:159]
    s_add_u32 s50, s50, 128
    ds_read_b128 a[20:23], v7 offset:4096
    v_mfma_f32_16x16x32_bf16 v[148:151], a[28:31], a[116:119], v[148:151]
    ds_read_b64_tr_b16 a[102:103], v12 offset:18432
    v_mfma_f32_16x16x32_bf16 v[148:151], a[24:27], a[112:115], v[148:151]
    ds_read_b128 a[24:27], v6 offset:6144
    v_mfma_f32_16x16x32_bf16 v[208:211], a[32:35], a[112:115], v[208:211]
    s_sub_u32 s65, s65, 1
    ds_read_b128 a[28:31], v7 offset:6144
    v_mfma_f32_16x16x32_bf16 v[208:211], a[36:39], a[116:119], v[208:211]
    ds_read_b64_tr_b16 a[104:105], v13 offset:0
    v_mfma_f32_16x16x32_bf16 v[216:219], a[36:39], a[124:127], v[216:219]
    v_mfma_f32_16x16x32_bf16 v[216:219], a[32:35], a[120:123], v[216:219]
    ds_read_b128 a[32:35], v6 offset:8192
    v_mfma_f32_16x16x32_bf16 v[220:223], a[40:43], a[120:123], v[220:223]
    buffer_load_dwordx4 v16, s[40:43], s51 offen offset:2048 sc1 lds
    v_mfma_f32_16x16x32_bf16 v[220:223], a[44:47], a[124:127], v[220:223]
    ds_read_b128 a[36:39], v7 offset:8192
    v_mfma_f32_16x16x32_bf16 v[212:215], a[44:47], a[116:119], v[212:215]
    ds_read_b64_tr_b16 a[106:107], v13 offset:2048
    v_mfma_f32_16x16x32_bf16 v[212:215], a[40:43], a[112:115], v[212:215]
    ds_read_b128 a[40:43], v6 offset:10240
    v_mfma_f32_16x16x32_bf16 a[240:243], a[48:51], a[112:115], a[240:243]
    ds_read_b128 a[44:47], v7 offset:10240
    v_mfma_f32_16x16x32_bf16 a[240:243], a[52:55], a[116:119], a[240:243]
    ds_read_b64_tr_b16 a[108:109], v13 offset:16384
    v_mfma_f32_16x16x32_bf16 a[248:251], a[52:55], a[124:127], a[248:251]
    v_mfma_f32_16x16x32_bf16 a[248:251], a[48:51], a[120:123], a[248:251]
    ds_read_b128 a[48:51], v6 offset:12288
    v_mfma_f32_16x16x32_bf16 a[252:255], a[56:59], a[120:123], a[252:255]
    buffer_load_dwordx4 v17, s[40:43], s51 offen offset:3072 sc1 lds
    v_mfma_f32_16x16x32_bf16 a[252:255], a[60:63], a[124:127], a[252:255]
    s_add_u32 s51, s51, 128
    ds_read_b128 a[52:55], v7 offset:12288
    v_mfma_f32_16x16x32_bf16 a[244:247], a[60:63], a[116:119], a[244:247]
    ds_read_b64_tr_b16 a[110:111], v13 offset:18432
    v_mfma_f32_16x16x32_bf16 a[244:247], a[56:59], a[112:115], a[244:247]
    ds_read_b128 a[56:59], v6 offset:14336
    ds_read_b128 a[60:63], v7 offset:14336
    s_cmp_eq_u32 s66, 2
    s_cbranch_scc1 m_hook23
m_hookr24:
    s_waitcnt lgkmcnt(15)
    v_mfma_f32_16x16x32_bf16 v[32:35], a[0:3], a[64:67], v[32:35]
    ds_read_b64_tr_b16 a[112:113], v14 offset:0
    v_mfma_f32_16x16x32_bf16 v[32:35], a[4:7], a[68:71], v[32:35]
    ds_read_b64_tr_b16 a[114:115], v14 offset:2048
    v_mfma_f32_16x16x32_bf16 v[40:43], a[4:7], a[76:79], v[40:43]
    ds_read_b64_tr_b16 a[116:117], v14 offset:16384
    v_mfma_f32_16x16x32_bf16 v[40:43], a[0:3], a[72:75], v[40:43]
    ds_read_b64_tr_b16 a[118:119], v14 offset:18432
    v_mfma_f32_16x16x32_bf16 v[44:47], a[8:11], a[72:75], v[44:47]
    ds_read_b64_tr_b16 a[120:121], v15 offset:0
    v_mfma_f32_16x16x32_bf16 v[44:47], a[12:15], a[76:79], v[44:47]
    ds_read_b64_tr_b16 a[122:123], v15 offset:2048
    v_mfma_f32_16x16x32_bf16 v[36:39], a[12:15], a[68:71], v[36:39]
    ds_read_b64_tr_b16 a[124:125], v15 offset:16384
    v_mfma_f32_16x16x32_bf16 v[36:39], a[8:11], a[64:67], v[36:39]
    ds_read_b64_tr_b16 a[126:127], v15 offset:18432
    v_mfma_f32_16x16x32_bf16 v[96:99], a[16:19], a[64:67], v[96:99]
    v_mfma_f32_16x16x32_bf16 v[96:99], a[20:23], a[68:71], v[96:99]
    v_mfma_f32_16x16x32_bf16 v[104:107], a[20:23], a[76:79], v[104:107]
    buffer_store_dwordx4 a[192:195], v2, s[24:27], s28 offen sc1
    v_mfma_f32_16x16x32_bf16 v[104:107], a[16:19], a[72:75], v[104:107]
    s_add_u32 s28, s28, s31
    s_waitcnt lgkmcnt(15)
    v_mfma_f32_16x16x32_bf16 v[108:111], a[24:27], a[72:75], v[108:111]
    v_xor_b32 v8, s60, v8
    v_xor_b32 v9, s60, v9
    v_mfma_f32_16x16x32_bf16 v[108:111], a[28:31], a[76:79], v[108:111]
    v_xor_b32 v10, s60, v10
    v_xor_b32 v11, s60, v11
    v_mfma_f32_16x16x32_bf16 v[100:103], a[28:31], a[68:71], v[100:103]
    v_xor_b32 v12, s60, v12
    v_xor_b32 v13, s60, v13
    v_mfma_f32_16x16x32_bf16 v[100:103], a[24:27], a[64:67], v[100:103]
    v_xor_b32 v14, s60, v14
    v_xor_b32 v15, s60, v15
    v_mfma_f32_16x16x32_bf16 v[160:163], a[32:35], a[64:67], v[160:163]
    buffer_store_dwordx4 a[196:199], v2, s[24:27], s28 offen sc1
    v_mfma_f32_16x16x32_bf16 v[160:163], a[36:39], a[68:71], v[160:163]
    s_add_u32 s28, s28, s31
    v_mfma_f32_16x16x32_bf16 v[168:171], a[36:39], a[76:79], v[168:171]
    v_mfma_f32_16x16x32_bf16 v[168:171], a[32:35], a[72:75], v[168:171]
    s_waitcnt lgkmcnt(14)
    v_mfma_f32_16x16x32_bf16 v[172:175], a[40:43], a[72:75], v[172:175]
    v_mfma_f32_16x16x32_bf16 v[172:175], a[44:47], a[76:79], v[172:175]
    v_mfma_f32_16x16x32_bf16 v[164:167], a[44:47], a[68:71], v[164:167]
    buffer_store_dwordx4 a[200:203], v2, s[24:27], s28 offen sc1
    v_mfma_f32_16x16x32_bf16 v[164:167], a[40:43], a[64:67], v[164:167]
    s_add_u32 s28, s28, s31
    s_waitcnt lgkmcnt(11)
    v_mfma_f32_16x16x32_bf16 v[224:227], a[48:51], a[64:67], v[224:227]
    v_mfma_f32_16x16x32_bf16 v[224:227], a[52:55], a[68:71], v[224:227]
    v_mfma_f32_16x16x32_bf16 v[232:235], a[52:55], a[76:79], v[232:235]
    v_mfma_f32_16x16x32_bf16 v[232:235], a[48:51], a[72:75], v[232:235]
    s_waitcnt lgkmcnt(8)
    v_mfma_f32_16x16x32_bf16 v[236:239], a[56:59], a[72:75], v[236:239]
    buffer_store_dwordx4 a[204:207], v2, s[24:27], s28 offen sc1
    v_mfma_f32_16x16x32_bf16 v[236:239], a[60:63], a[76:79], v[236:239]
    s_add_u32 s28, s28, s31
    v_mfma_f32_16x16x32_bf16 v[228:231], a[60:63], a[68:71], v[228:231]
    s_waitcnt vmcnt(16) lgkmcnt(0)
    v_mfma_f32_16x16x32_bf16 v[228:231], a[56:59], a[64:67], v[228:231]
    s_barrier
    v_mfma_f32_16x16x32_bf16 v[48:51], a[0:3], a[80:83], v[48:51]
    ds_read_b64_tr_b16 a[64:65], v8 offset:0
    v_mfma_f32_16x16x32_bf16 v[48:51], a[4:7], a[84:87], v[48:51]
    s_add_u32 m0, s62, 0
    v_mfma_f32_16x16x32_bf16 v[56:59], a[4:7], a[92:95], v[56:59]
    buffer_load_dwordx4 v18, s[44:47], s52 offen offset:0 sc1 lds
    v_mfma_f32_16x16x32_bf16 v[56:59], a[0:3], a[88:91], v[56:59]
    ds_read_b64_tr_b16 a[66:67], v8 offset:2048
    v_mfma_f32_16x16x32_bf16 v[60:63], a[8:11], a[88:91], v[60:63]
    s_add_u32 s64, s64, 32768
    v_mfma_f32_16x16x32_bf16 v[60:63], a[12:15], a[92:95], v[60:63]
    s_cmp_ge_u32 s64, 98304
    s_cselect_b32 s63, 4294901760, s59
    s_cselect_b32 s64, 0, s64
    v_mfma_f32_16x16x32_bf16 v[52:55], a[12:15], a[84:87], v[52:55]
    buffer_load_dwordx4 v19, s[44:47], s52 offen offset:1024 sc1 lds
    v_mfma_f32_16x16x32_bf16 v[52:55], a[8:11], a[80:83], v[52:55]
    s_add_u32 s52, s52, s56
    ds_read_b64_tr_b16 a[68:69], v8 offset:16384
    v_mfma_f32_16x16x32_bf16 v[112:115], a[16:19], a[80:83], v[112:115]
    v_mfma_f32_16x16x32_bf16 v[112:115], a[20:23], a[84:87], v[112:115]
    v_mfma_f32_16x16x32_bf16 v[120:123], a[20:23], a[92:95], v[120:123]
    buffer_load_dwordx4 v18, s[44:47], s53 offen offset:2048 sc1 lds
    v_mfma_f32_16x16x32_bf16 v[120:123], a[16:19], a[88:91], v[120:123]
    ds_read_b64_tr_b16 a[70:71], v8 offset:18432
    v_mfma_f32_16x16x32_bf16 v[124:127], a[24:27], a[88:91], v[124:127]
    v_mfma_f32_16x16x32_bf16 v[124:127], a[28:31], a[92:95], v[124:127]
    v_mfma_f32_16x16x32_bf16 v[116:119], a[28:31], a[84:87], v[116:119]
    buffer_load_dwordx4 v19, s[44:47], s53 offen offset:3072 sc1 lds
    v_mfma_f32_16x16x32_bf16 v[116:119], a[24:27], a[80:83], v[116:119]
    s_add_u32 s53, s53, s56
    ds_read_b64_tr_b16 a[72:73], v9 offset:0
    v_mfma_f32_16x16x32_bf16 v[176:179], a[32:35], a[80:83], v[176:179]
    v_mfma_f32_16x16x32_bf16 v[176:179], a[36:39], a[84:87], v[176:179]
    s_add_u32 m0, s62, 4096
    v_mfma_f32_16x16x32_bf16 v[184:187], a[36:39], a[92:95], v[184:187]
    buffer_load_dwordx4 v20, s[44:47], s54 offen offset:0 sc1 lds
    v_mfma_f32_16x16x32_bf16 v[184:187], a[32:35], a[88:91], v[184:187]
    s_xor_b32 s62, s62, 229376
    ds_read_b64_tr_b16 a[74:75], v9 offset:2048
    v_mfma_f32_16x16x32_bf16 v[188:191], a[40:43], a[88:91], v[188:191]
    v_mfma_f32_16x16x32_bf16 v[188:191], a[44:47], a[92:95], v[188:191]
    v_mfma_f32_16x16x32_bf16 v[180:183], a[44:47], a[84:87], v[180:183]
    buffer_load_dwordx4 v21, s[44:47], s54 offen offset:1024 sc1 lds
    v_mfma_f32_16x16x32_bf16 v[180:183], a[40:43], a[80:83], v[180:183]
    s_add_u32 s54, s54, s56
    ds_read_b64_tr_b16 a[76:77], v9 offset:16384
    v_mfma_f32_16x16x32_bf16 v[240:243], a[48:51], a[80:83], v[240:243]
    v_mfma_f32_16x16x32_bf16 v[240:243], a[52:55], a[84:87], v[240:243]
    v_mfma_f32_16x16x32_bf16 v[248:251], a[52:55], a[92:95], v[248:251]
    buffer_load_dwordx4 v20, s[44:47], s55 offen offset:2048 sc1 lds
    v_mfma_f32_16x16x32_bf16 v[248:251], a[48:51], a[88:91], v[248:251]
    ds_read_b64_tr_b16 a[78:79], v9 offset:18432
    v_mfma_f32_16x16x32_bf16 v[252:255], a[56:59], a[88:91], v[252:255]
    v_add_u32 v6, s63, v6
    v_add_u32 v7, s63, v7
    v_mfma_f32_16x16x32_bf16 v[252:255], a[60:63], a[92:95], v[252:255]
    v_mfma_f32_16x16x32_bf16 v[244:247], a[60:63], a[84:87], v[244:247]
    buffer_load_dwordx4 v21, s[44:47], s55 offen offset:3072 sc1 lds
    v_mfma_f32_16x16x32_bf16 v[244:247], a[56:59], a[80:83], v[244:247]
    s_add_u32 s55, s55, s56
    v_mfma_f32_16x16x32_bf16 v[64:67], a[0:3], a[96:99], v[64:67]
    ds_read_b64_tr_b16 a[80:81], v10 offset:0
    v_mfma_f32_16x16x32_bf16 v[64:67], a[4:7], a[100:103], v[64:67]
    v_mfma_f32_16x16x32_bf16 v[72:75], a[4:7], a[108:111], v[72:75]
    v_mfma_f32_16x16x32_bf16 v[72:75], a[0:3], a[104:107], v[72:75]
    s_add_u32 m0, s61, 0
    ds_read_b64_tr_b16 a[82:83], v10 offset:2048
    v_mfma_f32_16x16x32_bf16 v[76:79], a[8:11], a[104:107], v[76:79]
    buffer_load_dwordx4 v16, s[40:43], s48 offen offset:0 sc1 lds
    v_mfma_f32_16x16x32_bf16 v[76:79], a[12:15], a[108:111], v[76:79]
    v_mfma_f32_16x16x32_bf16 v[68:71], a[12:15], a[100:103], v[68:71]
    ds_read_b64_tr_b16 a[84:85], v10 offset:16384
    v_mfma_f32_16x16x32_bf16 v[68:71], a[8:11], a[96:99], v[68:71]
    v_mfma_f32_16x16x32_bf16 v[128:131], a[16:19], a[96:99], v[128:131]
    buffer_store_dwordx4 a[208:211], v2, s[24:27], s28 offen sc1
    v_mfma_f32_16x16x32_bf16 v[128:131], a[20:23], a[100:103], v[128:131]
    s_add_u32 s28, s28, s31
    ds_read_b64_tr_b16 a[86:87], v10 offset:18432
    v_mfma_f32_16x16x32_bf16 v[136:139], a[20:23], a[108:111], v[136:139]
    v_mfma_f32_16x16x32_bf16 v[136:139], a[16:19], a[104:107], v[136:139]
    v_mfma_f32_16x16x32_bf16 v[140:143], a[24:27], a[104:107], v[140:143]
    buffer_load_dwordx4 v17, s[40:43], s48 offen offset:1024 sc1 lds
    v_mfma_f32_16x16x32_bf16 v[140:143], a[28:31], a[108:111], v[140:143]
    s_add_u32 s48, s48, 128
    ds_read_b64_tr_b16 a[88:89], v11 offset:0
    v_mfma_f32_16x16x32_bf16 v[132:135], a[28:31], a[100:103], v[132:135]
    v_mfma_f32_16x16x32_bf16 v[132:135], a[24:27], a[96:99], v[132:135]
    v_mfma_f32_16x16x32_bf16 v[192:195], a[32:35], a[96:99], v[192:195]
    buffer_store_dwordx4 a[212:215], v2, s[24:27], s28 offen sc1
    v_mfma_f32_16x16x32_bf16 v[192:195], a[36:39], a[100:103], v[192:195]
    s_add_u32 s28, s28, s31
    ds_read_b64_tr_b16 a[90:91], v11 offset:2048
    v_mfma_f32_16x16x32_bf16 v[200:203], a[36:39], a[108:111], v[200:203]
    v_mfma_f32_16x16x32_bf16 v[200:203], a[32:35], a[104:107], v[200:203]
    v_mfma_f32_16x16x32_bf16 v[204:207], a[40:43], a[104:107], v[204:207]
    buffer_load_dwordx4 v16, s[40:43], s49 offen offset:2048 sc1 lds
    v_mfma_f32_16x16x32_bf16 v[204:207], a[44:47], a[108:111], v[204:207]
    ds_read_b64_tr_b16 a[92:93], v11 offset:16384
    v_mfma_f32_16x16x32_bf16 v[196:199], a[44:47], a[100:103], v[196:199]
    v_mfma_f32_16x16x32_bf16 v[196:199], a[40:43], a[96:99], v[196:199]
    v_mfma_f32_16x16x32_bf16 a[224:227], a[48:51], a[96:99], a[224:227]
    buffer_store_dwordx4 a[216:219], v2, s[24:27], s28 offen sc1
    v_mfma_f32_16x16x32_bf16 a[224:227], a[52:55], a[100:103], a[224:227]
    s_add_u32 s28, s28, s31
    ds_read_b64_tr_b16 a[94:95], v11 offset:18432
    v_mfma_f32_16x16x32_bf16 a[232:235], a[52:55], a[108:111], a[232:235]
    v_mfma_f32_16x16x32_bf16 a[232:235], a[48:51], a[104:107], a[232:235]
    v_mfma_f32_16x16x32_bf16 a[236:239], a[56:59], a[104:107], a[236:239]
    buffer_load_dwordx4 v17, s[40:43], s49 offen offset:3072 sc1 lds
    v_mfma_f32_16x16x32_bf16 a[236:239], a[60:63], a[108:111], a[236:239]
    s_add_u32 s49, s49, 128
    v_mfma_f32_16x16x32_bf16 a[228:231], a[60:63], a[100:103], a[228:231]
    buffer_store_dwordx4 a[220:223], v2, s[24:27], s28 offen sc1
    v_mfma_f32_16x16x32_bf16 a[228:231], a[56:59], a[96:99], a[228:231]
    s_add_u32 s29, s29, s30
    s_mov_b32 s28, s29
    v_mfma_f32_16x16x32_bf16 v[80:83], a[0:3], a[112:115], v[80:83]
    v_mfma_f32_16x16x32_bf16 v[80:83], a[4:7], a[116:119], v[80:83]
    ds_read_b64_tr_b16 a[96:97], v12 offset:0
    v_mfma_f32_16x16x32_bf16 v[88:91], a[4:7], a[124:127], v[88:91]
    v_mfma_f32_16x16x32_bf16 v[88:91], a[0:3], a[120:123], v[88:91]
    s_add_u32 m0, s61, 4096
    ds_read_b128 a[0:3], v6 offset:0
    v_mfma_f32_16x16x32_bf16 v[92:95], a[8:11], a[120:123], v[92:95]
    buffer_load_dwordx4 v16, s[40:43], s50 offen offset:0 sc1 lds
    v_mfma_f32_16x16x32_bf16 v[92:95], a[12:15], a[124:127], v[92:95]
    s_add_u32 s61, s61, 32768
    ds_read_b128 a[4:7], v7 offset:0
    v_mfma_f32_16x16x32_bf16 v[84:87], a[12:15], a[116:119], v[84:87]
    s_cmp_ge_u32 s61, 98304
    s_cselect_b32 s90, 98304, 0
    ds_read_b64_tr_b16 a[98:99], v12 offset:2048
    v_mfma_f32_16x16x32_bf16 v[84:87], a[8:11], a[112:115], v[84:87]
    s_sub_u32 s61, s61, s90
    ds_read_b128 a[8:11], v6 offset:2048
    v_mfma_f32_16x16x32_bf16 v[144:147], a[16:19], a[112:115], v[144:147]
    ds_read_b128 a[12:15], v7 offset:2048
    v_mfma_f32_16x16x32_bf16 v[144:147], a[20:23], a[116:119], v[144:147]
    ds_read_b64_tr_b16 a[100:101], v12 offset:16384
    v_mfma_f32_16x16x32_bf16 v[152:155], a[20:23], a[124:127], v[152:155]
    v_mfma_f32_16x16x32_bf16 v[152:155], a[16:19], a[120:123], v[152:155]
    ds_read_b128 a[16:19], v6 offset:4096
    v_mfma_f32_16x16x32_bf16 v[156:159], a[24:27], a[120:123], v[156:159]
    buffer_load_dwordx4 v17, s[40:43], s50 offen offset:1024 sc1 lds
    v_mfma_f32_16x16x32_bf16 v[156:159], a[28:31], a[124:127], v[156:159]
    s_add_u32 s50, s50, 128
    ds_read_b128 a[20:23], v7 offset:4096
    v_mfma_f32_16x16x32_bf16 v[148:151], a[28:31], a[116:119], v[148:151]
    ds_read_b64_tr_b16 a[102:103], v12 offset:18432
    v_mfma_f32_16x16x32_bf16 v[148:151], a[24:27], a[112:115], v[148:151]
    ds_read_b128 a[24:27], v6 offset:6144
    v_mfma_f32_16x16x32_bf16 v[208:211], a[32:35], a[112:115], v[208:211]
    s_sub_u32 s65, s65, 1
    ds_read_b128 a[28:31], v7 offset:6144
    v_mfma_f32_16x16x32_bf16 v[208:211], a[36:39], a[116:119], v[208:211]
    ds_read_b64_tr_b16 a[104:105], v13 offset:0
    v_mfma_f32_16x16x32_bf16 v[216:219], a[36:39], a[124:127], v[216:219]
    v_mfma_f32_16x16x32_bf16 v[216:219], a[32:35], a[120:123], v[216:219]
    ds_read_b128 a[32:35], v6 offset:8192
    v_mfma_f32_16x16x32_bf16 v[220:223], a[40:43], a[120:123], v[220:223]
    buffer_load_dwordx4 v16, s[40:43], s51 offen offset:2048 sc1 lds
    v_mfma_f32_16x16x32_bf16 v[220:223], a[44:47], a[124:127], v[220:223]
    ds_read_b128 a[36:39], v7 offset:8192
    v_mfma_f32_16x16x32_bf16 v[212:215], a[44:47], a[116:119], v[212:215]
    ds_read_b64_tr_b16 a[106:107], v13 offset:2048
    v_mfma_f32_16x16x32_bf16 v[212:215], a[40:43], a[112:115], v[212:215]
    ds_read_b128 a[40:43], v6 offset:10240
    v_mfma_f32_16x16x32_bf16 a[240:243], a[48:51], a[112:115], a[240:243]
    ds_read_b128 a[44:47], v7 offset:10240
    v_mfma_f32_16x16x32_bf16 a[240:243], a[52:55], a[116:119], a[240:243]
    ds_read_b64_tr_b16 a[108:109], v13 offset:16384
    v_mfma_f32_16x16x32_bf16 a[248:251], a[52:55], a[124:127], a[248:251]
    v_mfma_f32_16x16x32_bf16 a[248:251], a[48:51], a[120:123], a[248:251]
    ds_read_b128 a[48:51], v6 offset:12288
    v_mfma_f32_16x16x32_bf16 a[252:255], a[56:59], a[120:123], a[252:255]
    buffer_load_dwordx4 v17, s[40:43], s51 offen offset:3072 sc1 lds
    v_mfma_f32_16x16x32_bf16 a[252:255], a[60:63], a[124:127], a[252:255]
    s_add_u32 s51, s51, 128
    ds_read_b128 a[52:55], v7 offset:12288
    v_mfma_f32_16x16x32_bf16 a[244:247], a[60:63], a[116:119], a[244:247]
    ds_read_b64_tr_b16 a[110:111], v13 offset:18432
    v_mfma_f32_16x16x32_bf16 a[244:247], a[56:59], a[112:115], a[244:247]
    ds_read_b128 a[56:59], v6 offset:14336
    ds_read_b128 a[60:63], v7 offset:14336
.p2align 3
m_loop25:
    s_waitcnt lgkmcnt(15)
    v_mfma_f32_16x16x32_bf16 v[32:35], a[0:3], a[64:67], v[32:35]
    ds_read_b64_tr_b16 a[112:113], v14 offset:0
    v_mfma_f32_16x16x32_bf16 v[32:35], a[4:7], a[68:71], v[32:35]
    ds_read_b64_tr_b16 a[114:115], v14 offset:2048
    v_mfma_f32_16x16x32_bf16 v[40:43], a[4:7], a[76:79], v[40:43]
    ds_read_b64_tr_b16 a[116:117], v14 offset:16384
    v_mfma_f32_16x16x32_bf16 v[40:43], a[0:3], a[72:75], v[40:43]
    ds_read_b64_tr_b16 a[118:119], v14 offset:18432
    v_mfma_f32_16x16x32_bf16 v[44:47], a[8:11], a[72:75], v[44:47]
    ds_read_b64_tr_b16 a[120:121], v15 offset:0
    v_mfma_f32_16x16x32_bf16 v[44:47], a[12:15], a[76:79], v[44:47]
    ds_read_b64_tr_b16 a[122:123], v15 offset:2048
    v_mfma_f32_16x16x32_bf16 v[36:39], a[12:15], a[68:71], v[36:39]
    ds_read_b64_tr_b16 a[124:125], v15 offset:16384
    v_mfma_f32_16x16x32_bf16 v[36:39], a[8:11], a[64:67], v[36:39]
    ds_read_b64_tr_b16 a[126:127], v15 offset:18432
    v_mfma_f32_16x16x32_bf16 v[96:99], a[16:19], a[64:67], v[96:99]
    v_mfma_f32_16x16x32_bf16 v[96:99], a[20:23], a[68:71], v[96:99]
    v_mfma_f32_16x16x32_bf16 v[104:107], a[20:23], a[76:79], v[104:107]
    v_mfma_f32_16x16x32_bf16 v[104:107], a[16:19], a[72:75], v[104:107]
    s_waitcnt lgkmcnt(15)
    v_mfma_f32_16x16x32_bf16 v[108:111], a[24:27], a[72:75], v[108:111]
    v_xor_b32 v8, s60, v8
    v_xor_b32 v9, s60, v9
    v_mfma_f32_16x16x32_bf16 v[108:111], a[28:31], a[76:79], v[108:111]
    v_xor_b32 v10, s60, v10
    v_xor_b32 v11, s60, v11
    v_mfma_f32_16x16x32_bf16 v[100:103], a[28:31], a[68:71], v[100:103]
    v_xor_b32 v12, s60, v12
    v_xor_b32 v13, s60, v13
    v_mfma_f32_16x16x32_bf16 v[100:103], a[24:27], a[64:67], v[100:103]
    v_xor_b32 v14, s60, v14
    v_xor_b32 v15, s60, v15
    v_mfma_f32_16x16x32_bf16 v[160:163], a[32:35], a[64:67], v[160:163]
    v_mfma_f32_16x16x32_bf16 v[160:163], a[36:39], a[68:71], v[160:163]
    v_mfma_f32_16x16x32_bf16 v[168:171], a[36:39], a[76:79], v[168:171]
    v_mfma_f32_16x16x32_bf16 v[168:171], a[32:35], a[72:75], v[168:171]
    s_waitcnt lgkmcnt(14)
    v_mfma_f32_16x16x32_bf16 v[172:175], a[40:43], a[72:75], v[172:175]
    v_mfma_f32_16x16x32_bf16 v[172:175], a[44:47], a[76:79], v[172:175]
    v_mfma_f32_16x16x32_bf16 v[164:167], a[44:47], a[68:71], v[164:167]
    v_mfma_f32_16x16x32_bf16 v[164:167], a[40:43], a[64:67], v[164:167]
    s_waitcnt lgkmcnt(11)
    v_mfma_f32_16x16x32_bf16 v[224:227], a[48:51], a[64:67], v[224:227]
    v_mfma_f32_16x16x32_bf16 v[224:227], a[52:55], a[68:71], v[224:227]
    v_mfma_f32_16x16x32_bf16 v[232:235], a[52:55], a[76:79], v[232:235]
    v_mfma_f32_16x16x32_bf16 v[232:235], a[48:51], a[72:75], v[232:235]
    s_waitcnt lgkmcnt(8)
    v_mfma_f32_16x16x32_bf16 v[236:239], a[56:59], a[72:75], v[236:239]
    v_mfma_f32_16x16x32_bf16 v[236:239], a[60:63], a[76:79], v[236:239]
    v_mfma_f32_16x16x32_bf16 v[228:231], a[60:63], a[68:71], v[228:231]
    s_waitcnt vmcnt(8) lgkmcnt(0)
    v_mfma_f32_16x16x32_bf16 v[228:231], a[56:59], a[64:67], v[228:231]
    s_barrier
    v_mfma_f32_16x16x32_bf16 v[48:51], a[0:3], a[80:83], v[48:51]
    ds_read_b64_tr_b16 a[64:65], v8 offset:0
    v_mfma_f32_16x16x32_bf16 v[48:51], a[4:7], a[84:87], v[48:51]
    s_add_u32 m0, s62, 0
    v_mfma_f32_16x16x32_bf16 v[56:59], a[4:7], a[92:95], v[56:59]
    buffer_load_dwordx4 v18, s[44:47], s52 offen offset:0 sc1 lds
    v_mfma_f32_16x16x32_bf16 v[56:59], a[0:3], a[88:91], v[56:59]
    ds_read_b64_tr_b16 a[66:67], v8 offset:2048
    v_mfma_f32_16x16x32_bf16 v[60:63], a[8:11], a[88:91], v[60:63]
    s_add_u32 s64, s64, 32768
    v_mfma_f32_16x16x32_bf16 v[60:63], a[12:15], a[92:95], v[60:63]
    s_cmp_ge_u32 s64, 98304
    s_cselect_b32 s63, 4294901760, s59
    s_cselect_b32 s64, 0, s64
    v_mfma_f32_16x16x32_bf16 v[52:55], a[12:15], a[84:87], v[52:55]
    buffer_load_dwordx4 v19, s[44:47], s52 offen offset:1024 sc1 lds
    v_mfma_f32_16x16x32_bf16 v[52:55], a[8:11], a[80:83], v[52:55]
    s_add_u32 s52, s52, s56
    ds_read_b64_tr_b16 a[68:69], v8 offset:16384
    v_mfma_f32_16x16x32_bf16 v[112:115], a[16:19], a[80:83], v[112:115]
    v_mfma_f32_16x16x32_bf16 v[112:115], a[20:23], a[84:87], v[112:115]
    v_mfma_f32_16x16x32_bf16 v[120:123], a[20:23], a[92:95], v[120:123]
    buffer_load_dwordx4 v18, s[44:47], s53 offen offset:2048 sc1 lds
    v_mfma_f32_16x16x32_bf16 v[120:123], a[16:19], a[88:91], v[120:123]
    ds_read_b64_tr_b16 a[70:71], v8 offset:18432
    v_mfma_f32_16x16x32_bf16 v[124:127], a[24:27], a[88:91], v[124:127]
    v_mfma_f32_16x16x32_bf16 v[124:127], a[28:31], a[92:95], v[124:127]
    v_mfma_f32_16x16x32_bf16 v[116:119], a[28:31], a[84:87], v[116:119]
    buffer_load_dwordx4 v19, s[44:47], s53 offen offset:3072 sc1 lds
    v_mfma_f32_16x16x32_bf16 v[116:119], a[24:27], a[80:83], v[116:119]
    s_add_u32 s53, s53, s56
    ds_read_b64_tr_b16 a[72:73], v9 offset:0
    v_mfma_f32_16x16x32_bf16 v[176:179], a[32:35], a[80:83], v[176:179]
    v_mfma_f32_16x16x32_bf16 v[176:179], a[36:39], a[84:87], v[176:179]
    s_add_u32 m0, s62, 4096
    v_mfma_f32_16x16x32_bf16 v[184:187], a[36:39], a[92:95], v[184:187]
    buffer_load_dwordx4 v20, s[44:47], s54 offen offset:0 sc1 lds
    v_mfma_f32_16x16x32_bf16 v[184:187], a[32:35], a[88:91], v[184:187]
    s_xor_b32 s62, s62, 229376
    ds_read_b64_tr_b16 a[74:75], v9 offset:2048
    v_mfma_f32_16x16x32_bf16 v[188:191], a[40:43], a[88:91], v[188:191]
    v_mfma_f32_16x16x32_bf16 v[188:191], a[44:47], a[92:95], v[188:191]
    v_mfma_f32_16x16x32_bf16 v[180:183], a[44:47], a[84:87], v[180:183]
    buffer_load_dwordx4 v21, s[44:47], s54 offen offset:1024 sc1 lds
    v_mfma_f32_16x16x32_bf16 v[180:183], a[40:43], a[80:83], v[180:183]
    s_add_u32 s54, s54, s56
    ds_read_b64_tr_b16 a[76:77], v9 offset:16384
    v_mfma_f32_16x16x32_bf16 v[240:243], a[48:51], a[80:83], v[240:243]
    v_mfma_f32_16x16x32_bf16 v[240:243], a[52:55], a[84:87], v[240:243]
    v_mfma_f32_16x16x32_bf16 v[248:251], a[52:55], a[92:95], v[248:251]
    buffer_load_dwordx4 v20, s[44:47], s55 offen offset:2048 sc1 lds
    v_mfma_f32_16x16x32_bf16 v[248:251], a[48:51], a[88:91], v[248:251]
    ds_read_b64_tr_b16 a[78:79], v9 offset:18432
    v_mfma_f32_16x16x32_bf16 v[252:255], a[56:59], a[88:91], v[252:255]
    v_add_u32 v6, s63, v6
    v_add_u32 v7, s63, v7
    v_mfma_f32_16x16x32_bf16 v[252:255], a[60:63], a[92:95], v[252:255]
    v_mfma_f32_16x16x32_bf16 v[244:247], a[60:63], a[84:87], v[244:247]
    buffer_load_dwordx4 v21, s[44:47], s55 offen offset:3072 sc1 lds
    v_mfma_f32_16x16x32_bf16 v[244:247], a[56:59], a[80:83], v[244:247]
    s_add_u32 s55, s55, s56
    v_mfma_f32_16x16x32_bf16 v[64:67], a[0:3], a[96:99], v[64:67]
    ds_read_b64_tr_b16 a[80:81], v10 offset:0
    v_mfma_f32_16x16x32_bf16 v[64:67], a[4:7], a[100:103], v[64:67]
    v_mfma_f32_16x16x32_bf16 v[72:75], a[4:7], a[108:111], v[72:75]
    v_mfma_f32_16x16x32_bf16 v[72:75], a[0:3], a[104:107], v[72:75]
    s_add_u32 m0, s61, 0
    ds_read_b64_tr_b16 a[82:83], v10 offset:2048
    v_mfma_f32_16x16x32_bf16 v[76:79], a[8:11], a[104:107], v[76:79]
    buffer_load_dwordx4 v16, s[40:43], s48 offen offset:0 sc1 lds
    v_mfma_f32_16x16x32_bf16 v[76:79], a[12:15], a[108:111], v[76:79]
    v_mfma_f32_16x16x32_bf16 v[68:71], a[12:15], a[100:103], v[68:71]
    ds_read_b64_tr_b16 a[84:85], v10 offset:16384
    v_mfma_f32_16x16x32_bf16 v[68:71], a[8:11], a[96:99], v[68:71]
    v_mfma_f32_16x16x32_bf16 v[128:131], a[16:19], a[96:99], v[128:131]
    v_mfma_f32_16x16x32_bf16 v[128:131], a[20:23], a[100:103], v[128:131]
    ds_read_b64_tr_b16 a[86:87], v10 offset:18432
    v_mfma_f32_16x16x32_bf16 v[136:139], a[20:23], a[108:111], v[136:139]
    v_mfma_f32_16x16x32_bf16 v[136:139], a[16:19], a[104:107], v[136:139]
    v_mfma_f32_16x16x32_bf16 v[140:143], a[24:27], a[104:107], v[140:143]
    buffer_load_dwordx4 v17, s[40:43], s48 offen offset:1024 sc1 lds
    v_mfma_f32_16x16x32_bf16 v[140:143], a[28:31], a[108:111], v[140:143]
    s_add_u32 s48, s48, 128
    ds_read_b64_tr_b16 a[88:89], v11 offset:0
    v_mfma_f32_16x16x32_bf16 v[132:135], a[28:31], a[100:103], v[132:135]
    v_mfma_f32_16x16x32_bf16 v[132:135], a[24:27], a[96:99], v[132:135]
    v_mfma_f32_16x16x32_bf16 v[192:195], a[32:35], a[96:99], v[192:195]
    v_mfma_f32_16x16x32_bf16 v[192:195], a[36:39], a[100:103], v[192:195]
    ds_read_b64_tr_b16 a[90:91], v11 offset:2048
    v_mfma_f32_16x16x32_bf16 v[200:203], a[36:39], a[108:111], v[200:203]
    v_mfma_f32_16x16x32_bf16 v[200:203], a[32:35], a[104:107], v[200:203]
    v_mfma_f32_16x16x32_bf16 v[204:207], a[40:43], a[104:107], v[204:207]
    buffer_load_dwordx4 v16, s[40:43], s49 offen offset:2048 sc1 lds
    v_mfma_f32_16x16x32_bf16 v[204:207], a[44:47], a[108:111], v[204:207]
    ds_read_b64_tr_b16 a[92:93], v11 offset:16384
    v_mfma_f32_16x16x32_bf16 v[196:199], a[44:47], a[100:103], v[196:199]
    v_mfma_f32_16x16x32_bf16 v[196:199], a[40:43], a[96:99], v[196:199]
    v_mfma_f32_16x16x32_bf16 a[224:227], a[48:51], a[96:99], a[224:227]
    v_mfma_f32_16x16x32_bf16 a[224:227], a[52:55], a[100:103], a[224:227]
    ds_read_b64_tr_b16 a[94:95], v11 offset:18432
    v_mfma_f32_16x16x32_bf16 a[232:235], a[52:55], a[108:111], a[232:235]
    v_mfma_f32_16x16x32_bf16 a[232:235], a[48:51], a[104:107], a[232:235]
    v_mfma_f32_16x16x32_bf16 a[236:239], a[56:59], a[104:107], a[236:239]
    buffer_load_dwordx4 v17, s[40:43], s49 offen offset:3072 sc1 lds
    v_mfma_f32_16x16x32_bf16 a[236:239], a[60:63], a[108:111], a[236:239]
    s_add_u32 s49, s49, 128
    v_mfma_f32_16x16x32_bf16 a[228:231], a[60:63], a[100:103], a[228:231]
    v_mfma_f32_16x16x32_bf16 a[228:231], a[56:59], a[96:99], a[228:231]
    v_mfma_f32_16x16x32_bf16 v[80:83], a[0:3], a[112:115], v[80:83]
    v_mfma_f32_16x16x32_bf16 v[80:83], a[4:7], a[116:119], v[80:83]
    ds_read_b64_tr_b16 a[96:97], v12 offset:0
    v_mfma_f32_16x16x32_bf16 v[88:91], a[4:7], a[124:127], v[88:91]
    v_mfma_f32_16x16x32_bf16 v[88:91], a[0:3], a[120:123], v[88:91]
    s_add_u32 m0, s61, 4096
    ds_read_b128 a[0:3], v6 offset:0
    v_mfma_f32_16x16x32_bf16 v[92:95], a[8:11], a[120:123], v[92:95]
    buffer_load_dwordx4 v16, s[40:43], s50 offen offset:0 sc1 lds
    v_mfma_f32_16x16x32_bf16 v[92:95], a[12:15], a[124:127], v[92:95]
    s_add_u32 s61, s61, 32768
    ds_read_b128 a[4:7], v7 offset:0
    v_mfma_f32_16x16x32_bf16 v[84:87], a[12:15], a[116:119], v[84:87]
    s_cmp_ge_u32 s61, 98304
    s_cselect_b32 s90, 98304, 0
    ds_read_b64_tr_b16 a[98:99], v12 offset:2048
    v_mfma_f32_16x16x32_bf16 v[84:87], a[8:11], a[112:115], v[84:87]
    s_sub_u32 s61, s61, s90
    ds_read_b128 a[8:11], v6 offset:2048
    v_mfma_f32_16x16x32_bf16 v[144:147], a[16:19], a[112:115], v[144:147]
    ds_read_b128 a[12:15], v7 offset:2048
    v_mfma_f32_16x16x32_bf16 v[144:147], a[20:23], a[116:119], v[144:147]
    ds_read_b64_tr_b16 a[100:101], v12 offset:16384
    v_mfma_f32_16x16x32_bf16 v[152:155], a[20:23], a[124:127], v[152:155]
    v_mfma_f32_16x16x32_bf16 v[152:155], a[16:19], a[120:123], v[152:155]
    ds_read_b128 a[16:19], v6 offset:4096
    v_mfma_f32_16x16x32_bf16 v[156:159], a[24:27], a[120:123], v[156:159]
    buffer_load_dwordx4 v17, s[40:43], s50 offen offset:1024 sc1 lds
    v_mfma_f32_16x16x32_bf16 v[156:159], a[28:31], a[124:127], v[156:159]
    s_add_u32 s50, s50, 128
    ds_read_b128 a[20:23], v7 offset:4096
    v_mfma_f32_16x16x32_bf16 v[148:151], a[28:31], a[116:119], v[148:151]
    ds_read_b64_tr_b16 a[102:103], v12 offset:18432
    v_mfma_f32_16x16x32_bf16 v[148:151], a[24:27], a[112:115], v[148:151]
    ds_read_b128 a[24:27], v6 offset:6144
    v_mfma_f32_16x16x32_bf16 v[208:211], a[32:35], a[112:115], v[208:211]
    s_sub_u32 s65, s65, 1
    ds_read_b128 a[28:31], v7 offset:6144
    v_mfma_f32_16x16x32_bf16 v[208:211], a[36:39], a[116:119], v[208:211]
    ds_read_b64_tr_b16 a[104:105], v13 offset:0
    v_mfma_f32_16x16x32_bf16 v[216:219], a[36:39], a[124:127], v[216:219]
    v_mfma_f32_16x16x32_bf16 v[216:219], a[32:35], a[120:123], v[216:219]
    ds_read_b128 a[32:35], v6 offset:8192
    v_mfma_f32_16x16x32_bf16 v[220:223], a[40:43], a[120:123], v[220:223]
    buffer_load_dwordx4 v16, s[40:43], s51 offen offset:2048 sc1 lds
    v_mfma_f32_16x16x32_bf16 v[220:223], a[44:47], a[124:127], v[220:223]
    ds_read_b128 a[36:39], v7 offset:8192
    v_mfma_f32_16x16x32_bf16 v[212:215], a[44:47], a[116:119], v[212:215]
    ds_read_b64_tr_b16 a[106:107], v13 offset:2048
    v_mfma_f32_16x16x32_bf16 v[212:215], a[40:43], a[112:115], v[212:215]
    ds_read_b128 a[40:43], v6 offset:10240
    v_mfma_f32_16x16x32_bf16 a[240:243], a[48:51], a[112:115], a[240:243]
    ds_read_b128 a[44:47], v7 offset:10240
    v_mfma_f32_16x16x32_bf16 a[240:243], a[52:55], a[116:119], a[240:243]
    ds_read_b64_tr_b16 a[108:109], v13 offset:16384
    v_mfma_f32_16x16x32_bf16 a[248:251], a[52:55], a[124:127], a[248:251]
    v_mfma_f32_16x16x32_bf16 a[248:251], a[48:51], a[120:123], a[248:251]
    ds_read_b128 a[48:51], v6 offset:12288
    v_mfma_f32_16x16x32_bf16 a[252:255], a[56:59], a[120:123], a[252:255]
    buffer_load_dwordx4 v17, s[40:43], s51 offen offset:3072 sc1 lds
    v_mfma_f32_16x16x32_bf16 a[252:255], a[60:63], a[124:127], a[252:255]
    s_add_u32 s51, s51, 128
    ds_read_b128 a[52:55], v7 offset:12288
    v_mfma_f32_16x16x32_bf16 a[244:247], a[60:63], a[116:119], a[244:247]
    s_cmp_gt_u32 s65, s67
    ds_read_b64_tr_b16 a[110:111], v13 offset:18432
    v_mfma_f32_16x16x32_bf16 a[244:247], a[56:59], a[112:115], a[244:247]
    ds_read_b128 a[56:59], v6 offset:14336
    ds_read_b128 a[60:63], v7 offset:14336
    s_cbranch_scc1 m_loop25
    s_cmp_eq_u32 s65, 0
    s_cbranch_scc1 m_epi15
m_dosw26:
    s_cmp_eq_u32 s94, 0
    s_cbranch_scc1 m_x61
    s_cmp_lg_u32 s65, 3
    s_cbranch_scc1 m_x67
    s_mov_b32 s42, s73
    s_lshl_b32 s90, s77, 4
    s_lshl_b32 s90, s90, s81
    s_mov_b32 s48, s79
    s_mul_i32 s91, s90, 1
    s_add_u32 s49, s91, s79
    s_sub_u32 s49, s49, 2048
    s_mul_i32 s91, s90, 2
    s_add_u32 s50, s91, s79
    s_mul_i32 s91, s90, 3
    s_add_u32 s51, s91, s79
    s_sub_u32 s51, s51, 2048
    s_lshl_b32 s90, s58, 7
    s_add_u32 s90, s90, s57
    s_lshl_b32 s91, s16, 6
    s_cmp_eq_u32 s81, 1
    s_cselect_b32 s90, s90, s91
    v_lshrrev_b32 v24, 3, v1
    v_lshlrev_b32 v24, s81, v24
    v_add_u32 v24, s90, v24
    v_mul_lo_u32 v24, v24, s77
    v_lshrrev_b32 v25, 4, v1
    v_and_b32 v26, 7, v1
    v_xor_b32 v25, v25, v26
    v_lshl_add_u32 v16, v25, 4, v24
    v_xor_b32 v25, 4, v25
    v_lshl_add_u32 v17, v25, 4, v24
    s_lshl_b32 s90, s77, 3
    s_lshl_b32 s90, s90, s81
    s_sub_u32 s90, s90, 1024
    v_add_u32 v17, s90, v17
    s_mov_b32 s40, s71
    s_mov_b32 s41, s72
    buffer_load_dwordx2 v[4:5], off, s[12:15], 0 sc1
    s_branch m_loop25
m_x67:
    s_mov_b32 s46, s76
    s_mov_b32 s52, s80
    s_lshl_b32 s90, s78, 2
    s_mul_i32 s91, s90, 1
    s_add_u32 s53, s91, s80
    s_sub_u32 s53, s53, 2048
    s_mul_i32 s91, s90, 2
    s_add_u32 s54, s91, s80
    s_mul_i32 s91, s90, 3
    s_add_u32 s55, s91, s80
    s_sub_u32 s55, s55, 2048
    s_lshl_b32 s56, s78, 6
    v_lshrrev_b32 v24, 5, v1
    s_lshl_b32 s90, s16, 4
    v_add_u32 v25, s90, v24
    v_mul_lo_u32 v25, v25, s78
    v_lshlrev_b32 v24, 1, v24
    v_and_b32 v26, 31, v1
    v_xor_b32 v24, v24, v26
    s_lshl_b32 s90, s78, 1
    s_sub_u32 s90, s90, 1024
    v_add_u32 v27, s90, v25
    v_xor_b32 v26, 0, v24
    v_lshl_add_u32 v18, v26, 4, v25
    v_xor_b32 v26, 4, v24
    v_lshl_add_u32 v19, v26, 4, v27
    v_xor_b32 v26, 8, v24
    v_lshl_add_u32 v20, v26, 4, v25
    v_xor_b32 v26, 12, v24
    v_lshl_add_u32 v21, v26, 4, v27
    s_mov_b32 s44, s74
    s_mov_b32 s45, s75
    s_mov_b32 s67, 0
    s_branch m_loop25
m_x61:
    s_cmp_le_u32 s65, 4
    s_cbranch_scc1 m_x62
    s_cmp_lg_u32 s16, 0
    s_cbranch_scc1 m_np68
    v_mov_b32 v4, s4
    v_mov_b32 v5, s5
    s_add_u32 s90, s17, 117440512
    s_mov_b64 exec, 1
    buffer_store_dwordx2 v[4:5], off, s[8:11], s90 sc1
    s_mov_b64 exec, -1
m_np68:
    s_mov_b32 s17, -1
    s_mov_b32 s67, 4
    s_branch m_loop25
m_x62:
    s_cmp_lg_u32 s65, 4
    s_cbranch_scc1 m_x63
    s_cmp_eq_u32 s70, 1
    s_cbranch_scc1 m_ea69
    s_and_b32 s92, s2, 7
    s_lshl_b32 s92, s92, 2
    s_bfe_u32 s93, s2, 0x20003
    s_add_u32 s92, s92, s93
    s_lshr_b32 s93, s2, 5
    s_lshl_b32 s93, s93, 2
    s_or_b32 s93, s93, 0x40000
    s_lshr_b32 s90, s92, 1
    s_lshl_b32 s90, s90, 7
    s_add_u32 s90, s90, 117440512
    s_bfe_u32 s91, 873473623, s93
    s_lshr_b32 s91, s91, 1
    v_mov_b32 v0, s91
    v_and_b32 v4, 3, v1
    v_min_u32 v4, 2, v4
    v_and_b32 v5, 4, v1
    v_add3_u32 v4, v4, v5, 8
    v_cmp_gt_u32 vcc, 8, v1
    s_nop 1
    v_cndmask_b32 v0, v0, v4, vcc
    s_bfe_u32 s91, 4225681832, s93
    s_lshr_b32 s91, s91, 1
    v_writelane_b32 v0, s91, 8
    v_lshlrev_b32 v0, 3, v0
    buffer_load_dwordx2 v[4:5], v0, s[8:11], s90 offen sc1
m_eb70:
    s_branch m_loop25
m_x63:
    s_waitcnt vmcnt(16)
    s_cmp_lg_u32 s65, 3
    s_cbranch_scc1 m_x64
    s_cmp_eq_u32 s70, 1
    s_cbranch_scc1 m_ea71
    s_mov_b32 s3, 1048576
m_spin73:
    v_cmp_ne_u64 s[22:23], s[4:5], v[4:5]
    s_nop 3
    s_cmp_eq_u64 s[22:23], 0
    s_cbranch_scc1 m_ok74
    s_sub_u32 s3, s3, 1
    s_cbranch_scc1 m_ok74
    s_sleep 16
    s_and_b32 s92, s2, 7
    s_lshl_b32 s92, s92, 2
    s_bfe_u32 s93, s2, 0x20003
    s_add_u32 s92, s92, s93
    s_lshr_b32 s93, s2, 5
    s_lshl_b32 s93, s93, 2
    s_or_b32 s93, s93, 0x40000
    s_lshr_b32 s90, s92, 1
    s_lshl_b32 s90, s90, 7
    s_add_u32 s90, s90, 117440512
    s_bfe_u32 s91, 873473623, s93
    s_lshr_b32 s91, s91, 1
    v_mov_b32 v0, s91
    v_and_b32 v4, 3, v1
    v_min_u32 v4, 2, v4
    v_and_b32 v5, 4, v1
    v_add3_u32 v4, v4, v5, 8
    v_cmp_gt_u32 vcc, 8, v1
    s_nop 1
    v_cndmask_b32 v0, v0, v4, vcc
    s_bfe_u32 s91, 4225681832, s93
    s_lshr_b32 s91, s91, 1
    v_writelane_b32 v0, s91, 8
    v_lshlrev_b32 v0, 3, v0
    buffer_load_dwordx2 v[4:5], v0, s[8:11], s90 offen sc1
    s_waitcnt vmcnt(0)
    s_branch m_spin73
m_ok74:
    s_and_b32 s92, s2, 7
    s_lshl_b32 s92, s92, 2
    s_bfe_u32 s93, s2, 0x20003
    s_add_u32 s92, s92, s93
    s_lshr_b32 s93, s2, 5
    s_lshl_b32 s93, s93, 2
    s_or_b32 s93, s93, 0x40000
    s_bfe_u32 s90, 4225681832, s93
    s_lshl_b32 s90, s90, 3
    s_lshl_b32 s91, s16, 1
    s_add_u32 s90, s90, s91
    s_lshl_b32 s90, s90, 12
    s_lshl_b32 s91, s92, 19
    s_add_u32 s90, s90, s91
    s_add_u32 s90, s90, 0
    buffer_load_dwordx4 a[128:131], v2, s[8:11], s90 offen offset:0 sc1
    buffer_load_dwordx4 a[132:135], v2, s[8:11], s90 offen offset:1024 sc1
    buffer_load_dwordx4 a[136:139], v2, s[8:11], s90 offen offset:2048 sc1
    buffer_load_dwordx4 a[140:143], v2, s[8:11], s90 offen offset:3072 sc1
    s_bfe_u32 s90, 4225681832, s93
    s_lshl_b32 s90, s90, 3
    s_lshl_b32 s91, s16, 1
    s_add_u32 s90, s90, s91
    s_lshl_b32 s90, s90, 12
    s_lshl_b32 s91, s92, 19
    s_add_u32 s90, s90, s91
    s_add_u32 s90, s90, 4096
    buffer_load_dwordx4 a[144:147], v2, s[8:11], s90 offen offset:0 sc1
    buffer_load_dwordx4 a[148:151], v2, s[8:11], s90 offen offset:1024 sc1
m_eb72:
    s_lshl_b32 s90, s92, 19
    s_lshl_b32 s91, s58, 13
    s_add_u32 s90, s90, s91
    s_cmp_eq_u32 s57, 0
    s_mov_b32 s91, 33554432
    s_cselect_b32 s91, 16777216, s91
    s_mov_b32 s42, 0
    s_cselect_b32 s42, 268435456, s42
    s_add_u32 s48, s90, s91
    s_mov_b32 s49, s48
    s_add_u32 s50, s48, 4096
    s_mov_b32 s51, s50
    s_mov_b32 s40, s6
    s_mov_b32 s41, s7
    v_mov_b32 v16, v2
    v_mov_b32 v17, v2
    s_branch m_loop25
m_x64:
    s_cmp_lg_u32 s65, 2
    s_cbranch_scc1 m_x65
    s_cmp_eq_u32 s70, 1
    s_cbranch_scc1 m_ea75
    s_and_b32 s92, s2, 7
    s_lshl_b32 s92, s92, 2
    s_bfe_u32 s93, s2, 0x20003
    s_add_u32 s92, s92, s93
    s_lshr_b32 s93, s2, 5
    s_lshl_b32 s93, s93, 2
    s_or_b32 s93, s93, 0x40000
    s_bfe_u32 s90, 4225681832, s93
    s_lshl_b32 s90, s90, 3
    s_lshl_b32 s91, s16, 1
    s_add_u32 s90, s90, s91
    s_lshl_b32 s90, s90, 12
    s_lshl_b32 s91, s92, 19
    s_add_u32 s90, s90, s91
    s_add_u32 s90, s90, 4096
    buffer_load_dwordx4 a[152:155], v2, s[8:11], s90 offen offset:2048 sc1
    buffer_load_dwordx4 a[156:159], v2, s[8:11], s90 offen offset:3072 sc1
    s_bfe_u32 s90, 873473623, s93
    s_lshl_b32 s90, s90, 3
    s_lshl_b32 s91, s16, 1
    s_add_u32 s90, s90, s91
    s_lshl_b32 s90, s90, 12
    s_lshl_b32 s91, s92, 19
    s_add_u32 s90, s90, s91
    s_add_u32 s90, s90, 0
    buffer_load_dwordx4 a[160:163], v2, s[8:11], s90 offen offset:0 sc1
    buffer_load_dwordx4 a[164:167], v2, s[8:11], s90 offen offset:1024 sc1
    buffer_load_dwordx4 a[168:171], v2, s[8:11], s90 offen offset:2048 sc1
m_eb76:
    s_lshl_b32 s90, s92, 19
    s_lshl_b32 s91, s58, 13
    s_add_u32 s90, s90, s91
    s_cmp_eq_u32 s57, 0
    s_mov_b32 s91, 33554432
    s_cselect_b32 s91, 16793600, s91
    s_mov_b32 s42, 268435456
    s_cselect_b32 s42, 268435456, s42
    s_add_u32 s48, s90, s91
    s_mov_b32 s49, s48
    s_add_u32 s50, s48, 4096
    s_mov_b32 s51, s50
    s_mov_b32 s40, s6
    s_mov_b32 s41, s7
    s_lshl_b32 s90, s92, 19
    s_lshl_b32 s91, s58, 13
    s_add_u32 s90, s90, s91
    s_cmp_eq_u32 s57, 0
    s_mov_b32 s91, 33587200
    s_cselect_b32 s91, 16826368, s91
    s_mov_b32 s46, 268435456
    s_cselect_b32 s46, 268435456, s46
    s_add_u32 s52, s90, s91
    s_mov_b32 s53, s52
    s_add_u32 s54, s52, 4096
    s_mov_b32 s55, s54
    s_mov_b32 s44, s6
    s_mov_b32 s45, s7
    v_mov_b32 v18, v2
    v_mov_b32 v19, v2
    v_mov_b32 v20, v2
    v_mov_b32 v21, v2
    s_branch m_loop25
m_x65:
    s_cmp_eq_u32 s70, 1
    s_cbranch_scc1 m_ea77
    s_and_b32 s92, s2, 7
    s_lshl_b32 s92, s92, 2
    s_bfe_u32 s93, s2, 0x20003
    s_add_u32 s92, s92, s93
    s_lshr_b32 s93, s2, 5
    s_lshl_b32 s93, s93, 2
    s_or_b32 s93, s93, 0x40000
    s_bfe_u32 s90, 873473623, s93
    s_lshl_b32 s90, s90, 3
    s_lshl_b32 s91, s16, 1
    s_add_u32 s90, s90, s91
    s_lshl_b32 s90, s90, 12
    s_lshl_b32 s91, s92, 19
    s_add_u32 s90, s90, s91
    s_add_u32 s90, s90, 0
    buffer_load_dwordx4 a[172:175], v2, s[8:11], s90 offen offset:3072 sc1
    s_bfe_u32 s90, 873473623, s93
    s_lshl_b32 s90, s90, 3
    s_lshl_b32 s91, s16, 1
    s_add_u32 s90, s90, s91
    s_lshl_b32 s90, s90, 12
    s_lshl_b32 s91, s92, 19
    s_add_u32 s90, s90, s91
    s_add_u32 s90, s90, 4096
    buffer_load_dwordx4 a[176:179], v2, s[8:11], s90 offen offset:0 sc1
    buffer_load_dwordx4 a[180:183], v2, s[8:11], s90 offen offset:1024 sc1
    buffer_load_dwordx4 a[184:187], v2, s[8:11], s90 offen offset:2048 sc1
    buffer_load_dwordx4 a[188:191], v2, s[8:11], s90 offen offset:3072 sc1
m_eb78:
    s_lshl_b32 s90, s92, 19
    s_lshl_b32 s91, s58, 13
    s_add_u32 s90, s90, s91
    s_cmp_eq_u32 s57, 0
    s_mov_b32 s91, 33570816
    s_cselect_b32 s91, 16809984, s91
    s_mov_b32 s42, 268435456
    s_cselect_b32 s42, 268435456, s42
    s_add_u32 s48, s90, s91
    s_mov_b32 s49, s48
    s_add_u32 s50, s48, 4096
    s_mov_b32 s51, s50
    s_mov_b32 s40, s6
    s_mov_b32 s41, s7
    s_lshl_b32 s90, s92, 19
    s_lshl_b32 s91, s58, 13
    s_add_u32 s90, s90, s91
    s_cmp_eq_u32 s57, 0
    s_mov_b32 s91, 33603584
    s_cselect_b32 s91, 16842752, s91
    s_mov_b32 s46, 268435456
    s_cselect_b32 s46, 268435456, s46
    s_add_u32 s52, s90, s91
    s_mov_b32 s53, s52
    s_add_u32 s54, s52, 4096
    s_mov_b32 s55, s54
    s_mov_b32 s44, s6
    s_mov_b32 s45, s7
    s_branch m_loop25
m_ea69:
    s_and_b32 s92, s2, 7
    s_lshl_b32 s92, s92, 2
    s_bfe_u32 s93, s2, 0x20003
    s_add_u32 s92, s92, s93
    s_lshr_b32 s93, s2, 5
    s_lshl_b32 s93, s93, 2
    s_or_b32 s93, s93, 0x40000
    s_lshr_b32 s90, s92, 1
    s_lshl_b32 s90, s90, 7
    s_add_u32 s90, s90, 117440512
    v_and_b32 v0, 3, v1
    v_min_u32 v0, 2, v0
    v_and_b32 v4, 4, v1
    v_add3_u32 v0, v0, v4, 8
    v_lshlrev_b32 v0, 3, v0
    buffer_load_dwordx2 v[4:5], v0, s[8:11], s90 offen sc1
    s_branch m_eb70
m_ea71:
    s_mov_b32 s3, 1048576
m_spin79:
    v_cmp_ne_u64 s[22:23], s[4:5], v[4:5]
    s_nop 3
    s_cmp_eq_u64 s[22:23], 0
    s_cbranch_scc1 m_ok80
    s_sub_u32 s3, s3, 1
    s_cbranch_scc1 m_ok80
    s_sleep 16
    s_and_b32 s92, s2, 7
    s_lshl_b32 s92, s92, 2
    s_bfe_u32 s93, s2, 0x20003
    s_add_u32 s92, s92, s93
    s_lshr_b32 s93, s2, 5
    s_lshl_b32 s93, s93, 2
    s_or_b32 s93, s93, 0x40000
    s_lshr_b32 s90, s92, 1
    s_lshl_b32 s90, s90, 7
    s_add_u32 s90, s90, 117440512
    v_and_b32 v0, 3, v1
    v_min_u32 v0, 2, v0
    v_and_b32 v4, 4, v1
    v_add3_u32 v0, v0, v4, 8
    v_lshlrev_b32 v0, 3, v0
    buffer_load_dwordx2 v[4:5], v0, s[8:11], s90 offen sc1
    s_waitcnt vmcnt(0)
    s_branch m_spin79
m_ok80:
    s_and_b32 s92, s2, 7
    s_lshl_b32 s92, s92, 2
    s_bfe_u32 s93, s2, 0x20003
    s_add_u32 s92, s92, s93
    s_lshr_b32 s93, s2, 5
    s_lshl_b32 s93, s93, 2
    s_or_b32 s93, s93, 0x40000
    s_branch m_eb72
m_ea75:
    s_and_b32 s92, s2, 7
    s_lshl_b32 s92, s92, 2
    s_bfe_u32 s93, s2, 0x20003
    s_add_u32 s92, s92, s93
    s_lshr_b32 s93, s2, 5
    s_lshl_b32 s93, s93, 2
    s_or_b32 s93, s93, 0x40000
    s_lshr_b32 s90, s92, 1
    s_lshl_b32 s90, s90, 7
    s_add_u32 s90, s90, 117440512
    s_bfe_u32 s91, 873473623, s93
    s_lshr_b32 s91, s91, 1
    v_mov_b32 v0, s91
    s_bfe_u32 s91, 4225681832, s93
    s_lshr_b32 s91, s91, 1
    v_writelane_b32 v0, s91, 8
    v_lshlrev_b32 v0, 3, v0
    buffer_load_dwordx2 v[4:5], v0, s[8:11], s90 offen sc1
    s_branch m_eb76
m_ea77:
    s_mov_b32 s3, 1048576
m_spin81:
    v_cmp_ne_u64 s[22:23], s[4:5], v[4:5]
    s_nop 3
    s_cmp_eq_u64 s[22:23], 0
    s_cbranch_scc1 m_ok82
    s_sub_u32 s3, s3, 1
    s_cbranch_scc1 m_ok82
    s_sleep 16
    s_and_b32 s92, s2, 7
    s_lshl_b32 s92, s92, 2
    s_bfe_u32 s93, s2, 0x20003
    s_add_u32 s92, s92, s93
    s_lshr_b32 s93, s2, 5
    s_lshl_b32 s93, s93, 2
    s_or_b32 s93, s93, 0x40000
    s_lshr_b32 s90, s92, 1
    s_lshl_b32 s90, s90, 7
    s_add_u32 s90, s90, 117440512
    s_bfe_u32 s91, 873473623, s93
    s_lshr_b32 s91, s91, 1
    v_mov_b32 v0, s91
    s_bfe_u32 s91, 4225681832, s93
    s_lshr_b32 s91, s91, 1
    v_writelane_b32 v0, s91, 8
    v_lshlrev_b32 v0, 3, v0
    buffer_load_dwordx2 v[4:5], v0, s[8:11], s90 offen sc1
    s_waitcnt vmcnt(0)
    s_branch m_spin81
m_ok82:
    s_and_b32 s92, s2, 7
    s_lshl_b32 s92, s92, 2
    s_bfe_u32 s93, s2, 0x20003
    s_add_u32 s92, s92, s93
    s_lshr_b32 s93, s2, 5
    s_lshl_b32 s93, s93, 2
    s_or_b32 s93, s93, 0x40000
    s_bfe_u32 s90, 4225681832, s93
    s_lshl_b32 s90, s90, 3
    s_lshl_b32 s91, s16, 1
    s_add_u32 s90, s90, s91
    s_lshl_b32 s90, s90, 12
    s_lshl_b32 s91, s92, 19
    s_add_u32 s90, s90, s91
    s_add_u32 s90, s90, 0
    buffer_load_dwordx4 a[128:131], v2, s[8:11], s90 offen offset:0 sc1
    buffer_load_dwordx4 a[132:135], v2, s[8:11], s90 offen offset:1024 sc1
    buffer_load_dwordx4 a[136:139], v2, s[8:11], s90 offen offset:2048 sc1
    buffer_load_dwordx4 a[140:143], v2, s[8:11], s90 offen offset:3072 sc1
    s_bfe_u32 s90, 4225681832, s93
    s_lshl_b32 s90, s90, 3
    s_lshl_b32 s91, s16, 1
    s_add_u32 s90, s90, s91
    s_lshl_b32 s90, s90, 12
    s_lshl_b32 s91, s92, 19
    s_add_u32 s90, s90, s91
    s_add_u32 s90, s90, 4096
    buffer_load_dwordx4 a[144:147], v2, s[8:11], s90 offen offset:0 sc1
    buffer_load_dwordx4 a[148:151], v2, s[8:11], s90 offen offset:1024 sc1
    buffer_load_dwordx4 a[152:155], v2, s[8:11], s90 offen offset:2048 sc1
    buffer_load_dwordx4 a[156:159], v2, s[8:11], s90 offen offset:3072 sc1
    s_bfe_u32 s90, 873473623, s93
    s_lshl_b32 s90, s90, 3
    s_lshl_b32 s91, s16, 1
    s_add_u32 s90, s90, s91
    s_lshl_b32 s90, s90, 12
    s_lshl_b32 s91, s92, 19
    s_add_u32 s90, s90, s91
    s_add_u32 s90, s90, 0
    buffer_load_dwordx4 a[160:163], v2, s[8:11], s90 offen offset:0 sc1
    buffer_load_dwordx4 a[164:167], v2, s[8:11], s90 offen offset:1024 sc1
    buffer_load_dwordx4 a[168:171], v2, s[8:11], s90 offen offset:2048 sc1
    buffer_load_dwordx4 a[172:175], v2, s[8:11], s90 offen offset:3072 sc1
    s_bfe_u32 s90, 873473623, s93
    s_lshl_b32 s90, s90, 3
    s_lshl_b32 s91, s16, 1
    s_add_u32 s90, s90, s91
    s_lshl_b32 s90, s90, 12
    s_lshl_b32 s91, s92, 19
    s_add_u32 s90, s90, s91
    s_add_u32 s90, s90, 4096
    buffer_load_dwordx4 a[176:179], v2, s[8:11], s90 offen offset:0 sc1
    buffer_load_dwordx4 a[180:183], v2, s[8:11], s90 offen offset:1024 sc1
    buffer_load_dwordx4 a[184:187], v2, s[8:11], s90 offen offset:2048 sc1
    buffer_load_dwordx4 a[188:191], v2, s[8:11], s90 offen offset:3072 sc1
    s_branch m_eb78
m_epi15:
    s_cmp_eq_u32 s94, 0
    s_cbranch_scc1 m_last29
    s_mov_b32 s3, 1048576
m_spin33:
    v_readfirstlane_b32 s4, v4
    v_readfirstlane_b32 s5, v5
    s_nop 3
    s_cmp_lg_u32 s4, 0
    s_cbranch_scc1 m_ok34
    s_sub_u32 s3, s3, 1
    s_cbranch_scc1 m_ok34
    s_sleep 32
    buffer_load_dwordx2 v[4:5], off, s[12:15], 0 sc1
    s_waitcnt vmcnt(0)
    s_branch m_spin33
m_ok34:
    s_cmp_ge_u32 s68, 16
    s_cbranch_scc1 m_q036
m_epf27:
    s_nop 7
    s_mov_b32 s91, s98
    s_mov_b32 s92, s97
    s_mov_b32 s93, s97
    s_mov_b32 s90, s91
    v_pk_mul_f32 v[32:33], v[32:33], s[92:93]
    v_pk_mul_f32 v[34:35], v[34:35], s[92:93]
    v_pk_mul_f32 v[36:37], v[36:37], s[92:93]
    v_pk_mul_f32 v[38:39], v[38:39], s[92:93]
    v_cvt_pk_bf16_f32 v32, v32, v33
    v_cvt_pk_bf16_f32 v33, v34, v35
    v_cvt_pk_bf16_f32 v34, v36, v37
    v_cvt_pk_bf16_f32 v35, v38, v39
    buffer_store_dwordx4 v[32:35], v2, s[8:11], s90 offen sc1
    s_add_u32 s90, s90, s100
    v_pk_mul_f32 v[40:41], v[40:41], s[92:93]
    v_pk_mul_f32 v[42:43], v[42:43], s[92:93]
    v_pk_mul_f32 v[44:45], v[44:45], s[92:93]
    v_pk_mul_f32 v[46:47], v[46:47], s[92:93]
    v_cvt_pk_bf16_f32 v40, v40, v41
    v_cvt_pk_bf16_f32 v41, v42, v43
    v_cvt_pk_bf16_f32 v42, v44, v45
    v_cvt_pk_bf16_f32 v43, v46, v47
    buffer_store_dwordx4 v[40:43], v2, s[8:11], s90 offen sc1
    s_add_u32 s90, s90, s100
    v_pk_mul_f32 v[48:49], v[48:49], s[92:93]
    v_pk_mul_f32 v[50:51], v[50:51], s[92:93]
    v_pk_mul_f32 v[52:53], v[52:53], s[92:93]
    v_pk_mul_f32 v[54:55], v[54:55], s[92:93]
    v_cvt_pk_bf16_f32 v48, v48, v49
    v_cvt_pk_bf16_f32 v49, v50, v51
    v_cvt_pk_bf16_f32 v50, v52, v53
    v_cvt_pk_bf16_f32 v51, v54, v55
    buffer_store_dwordx4 v[48:51], v2, s[8:11], s90 offen sc1
    s_add_u32 s90, s90, s100
    v_pk_mul_f32 v[56:57], v[56:57], s[92:93]
    v_pk_mul_f32 v[58:59], v[58:59], s[92:93]
    v_pk_mul_f32 v[60:61], v[60:61], s[92:93]
    v_pk_mul_f32 v[62:63], v[62:63], s[92:93]
    v_cvt_pk_bf16_f32 v56, v56, v57
    v_cvt_pk_bf16_f32 v57, v58, v59
    v_cvt_pk_bf16_f32 v58, v60, v61
    v_cvt_pk_bf16_f32 v59, v62, v63
    buffer_store_dwordx4 v[56:59], v2, s[8:11], s90 offen sc1
    s_add_u32 s90, s90, s100
    v_pk_mul_f32 v[64:65], v[64:65], s[92:93]
    v_pk_mul_f32 v[66:67], v[66:67], s[92:93]
    v_pk_mul_f32 v[68:69], v[68:69], s[92:93]
    v_pk_mul_f32 v[70:71], v[70:71], s[92:93]
    v_cvt_pk_bf16_f32 v64, v64, v65
    v_cvt_pk_bf16_f32 v65, v66, v67
    v_cvt_pk_bf16_f32 v66, v68, v69
    v_cvt_pk_bf16_f32 v67, v70, v71
    buffer_store_dwordx4 v[64:67], v2, s[8:11], s90 offen sc1
    s_add_u32 s90, s90, s100
    v_pk_mul_f32 v[72:73], v[72:73], s[92:93]
    v_pk_mul_f32 v[74:75], v[74:75], s[92:93]
    v_pk_mul_f32 v[76:77], v[76:77], s[92:93]
    v_pk_mul_f32 v[78:79], v[78:79], s[92:93]
    v_cvt_pk_bf16_f32 v72, v72, v73
    v_cvt_pk_bf16_f32 v73, v74, v75
    v_cvt_pk_bf16_f32 v74, v76, v77
    v_cvt_pk_bf16_f32 v75, v78, v79
    buffer_store_dwordx4 v[72:75], v2, s[8:11], s90 offen sc1
    s_add_u32 s90, s90, s100
    v_pk_mul_f32 v[80:81], v[80:81], s[92:93]
    v_pk_mul_f32 v[82:83], v[82:83], s[92:93]
    v_pk_mul_f32 v[84:85], v[84:85], s[92:93]
    v_pk_mul_f32 v[86:87], v[86:87], s[92:93]
    v_cvt_pk_bf16_f32 v80, v80, v81
    v_cvt_pk_bf16_f32 v81, v82, v83
    v_cvt_pk_bf16_f32 v82, v84, v85
    v_cvt_pk_bf16_f32 v83, v86, v87
    buffer_store_dwordx4 v[80:83], v2, s[8:11], s90 offen sc1
    s_add_u32 s90, s90, s100
    v_pk_mul_f32 v[88:89], v[88:89], s[92:93]
    v_pk_mul_f32 v[90:91], v[90:91], s[92:93]
    v_pk_mul_f32 v[92:93], v[92:93], s[92:93]
    v_pk_mul_f32 v[94:95], v[94:95], s[92:93]
    v_cvt_pk_bf16_f32 v88, v88, v89
    v_cvt_pk_bf16_f32 v89, v90, v91
    v_cvt_pk_bf16_f32 v90, v92, v93
    v_cvt_pk_bf16_f32 v91, v94, v95
    buffer_store_dwordx4 v[88:91], v2, s[8:11], s90 offen sc1
    s_add_u32 s90, s90, s100
    s_add_u32 s91, s91, s99
    s_mov_b32 s90, s91
    v_pk_mul_f32 v[96:97], v[96:97], s[92:93]
    v_pk_mul_f32 v[98:99], v[98:99], s[92:93]
    v_pk_mul_f32 v[100:101], v[100:101], s[92:93]
    v_pk_mul_f32 v[102:103], v[102:103], s[92:93]
    v_cvt_pk_bf16_f32 v96, v96, v97
    v_cvt_pk_bf16_f32 v97, v98, v99
    v_cvt_pk_bf16_f32 v98, v100, v101
    v_cvt_pk_bf16_f32 v99, v102, v103
    buffer_store_dwordx4 v[96:99], v2, s[8:11], s90 offen sc1
    s_add_u32 s90, s90, s100
    v_pk_mul_f32 v[104:105], v[104:105], s[92:93]
    v_pk_mul_f32 v[106:107], v[106:107], s[92:93]
    v_pk_mul_f32 v[108:109], v[108:109], s[92:93]
    v_pk_mul_f32 v[110:111], v[110:111], s[92:93]
    v_cvt_pk_bf16_f32 v104, v104, v105
    v_cvt_pk_bf16_f32 v105, v106, v107
    v_cvt_pk_bf16_f32 v106, v108, v109
    v_cvt_pk_bf16_f32 v107, v110, v111
    buffer_store_dwordx4 v[104:107], v2, s[8:11], s90 offen sc1
    s_add_u32 s90, s90, s100
    v_pk_mul_f32 v[112:113], v[112:113], s[92:93]
    v_pk_mul_f32 v[114:115], v[114:115], s[92:93]
    v_pk_mul_f32 v[116:117], v[116:117], s[92:93]
    v_pk_mul_f32 v[118:119], v[118:119], s[92:93]
    v_cvt_pk_bf16_f32 v112, v112, v113
    v_cvt_pk_bf16_f32 v113, v114, v115
    v_cvt_pk_bf16_f32 v114, v116, v117
    v_cvt_pk_bf16_f32 v115, v118, v119
    buffer_store_dwordx4 v[112:115], v2, s[8:11], s90 offen sc1
    s_add_u32 s90, s90, s100
    v_pk_mul_f32 v[120:121], v[120:121], s[92:93]
    v_pk_mul_f32 v[122:123], v[122:123], s[92:93]
    v_pk_mul_f32 v[124:125], v[124:125], s[92:93]
    v_pk_mul_f32 v[126:127], v[126:127], s[92:93]
    v_cvt_pk_bf16_f32 v120, v120, v121
    v_cvt_pk_bf16_f32 v121, v122, v123
    v_cvt_pk_bf16_f32 v122, v124, v125
    v_cvt_pk_bf16_f32 v123, v126, v127
    buffer_store_dwordx4 v[120:123], v2, s[8:11], s90 offen sc1
    s_add_u32 s90, s90, s100
    v_pk_mul_f32 v[128:129], v[128:129], s[92:93]
    v_pk_mul_f32 v[130:131], v[130:131], s[92:93]
    v_pk_mul_f32 v[132:133], v[132:133], s[92:93]
    v_pk_mul_f32 v[134:135], v[134:135], s[92:93]
    v_cvt_pk_bf16_f32 v128, v128, v129
    v_cvt_pk_bf16_f32 v129, v130, v131
    v_cvt_pk_bf16_f32 v130, v132, v133
    v_cvt_pk_bf16_f32 v131, v134, v135
    buffer_store_dwordx4 v[128:131], v2, s[8:11], s90 offen sc1
    s_add_u32 s90, s90, s100
    v_pk_mul_f32 v[136:137], v[136:137], s[92:93]
    v_pk_mul_f32 v[138:139], v[138:139], s[92:93]
    v_pk_mul_f32 v[140:141], v[140:141], s[92:93]
    v_pk_mul_f32 v[142:143], v[142:143], s[92:93]
    v_cvt_pk_bf16_f32 v136, v136, v137
    v_cvt_pk_bf16_f32 v137, v138, v139
    v_cvt_pk_bf16_f32 v138, v140, v141
    v_cvt_pk_bf16_f32 v139, v142, v143
    buffer_store_dwordx4 v[136:139], v2, s[8:11], s90 offen sc1
    s_add_u32 s90, s90, s100
    v_pk_mul_f32 v[144:145], v[144:145], s[92:93]
    v_pk_mul_f32 v[146:147], v[146:147], s[92:93]
    v_pk_mul_f32 v[148:149], v[148:149], s[92:93]
    v_pk_mul_f32 v[150:151], v[150:151], s[92:93]
    v_cvt_pk_bf16_f32 v144, v144, v145
    v_cvt_pk_bf16_f32 v145, v146, v147
    v_cvt_pk_bf16_f32 v146, v148, v149
    v_cvt_pk_bf16_f32 v147, v150, v151
    buffer_store_dwordx4 v[144:147], v2, s[8:11], s90 offen sc1
    s_add_u32 s90, s90, s100
    v_pk_mul_f32 v[152:153], v[152:153], s[92:93]
    v_pk_mul_f32 v[154:155], v[154:155], s[92:93]
    v_pk_mul_f32 v[156:157], v[156:157], s[92:93]
    v_pk_mul_f32 v[158:159], v[158:159], s[92:93]
    v_cvt_pk_bf16_f32 v152, v152, v153
    v_cvt_pk_bf16_f32 v153, v154, v155
    v_cvt_pk_bf16_f32 v154, v156, v157
    v_cvt_pk_bf16_f32 v155, v158, v159
    buffer_store_dwordx4 v[152:155], v2, s[8:11], s90 offen sc1
    s_add_u32 s90, s90, s100
    s_add_u32 s91, s91, s99
    s_mov_b32 s90, s91
    v_pk_mul_f32 v[160:161], v[160:161], s[92:93]
    v_pk_mul_f32 v[162:163], v[162:163], s[92:93]
    v_pk_mul_f32 v[164:165], v[164:165], s[92:93]
    v_pk_mul_f32 v[166:167], v[166:167], s[92:93]
    v_cvt_pk_bf16_f32 v160, v160, v161
    v_cvt_pk_bf16_f32 v161, v162, v163
    v_cvt_pk_bf16_f32 v162, v164, v165
    v_cvt_pk_bf16_f32 v163, v166, v167
    buffer_store_dwordx4 v[160:163], v2, s[8:11], s90 offen sc1
    s_add_u32 s90, s90, s100
    v_pk_mul_f32 v[168:169], v[168:169], s[92:93]
    v_pk_mul_f32 v[170:171], v[170:171], s[92:93]
    v_pk_mul_f32 v[172:173], v[172:173], s[92:93]
    v_pk_mul_f32 v[174:175], v[174:175], s[92:93]
    v_cvt_pk_bf16_f32 v168, v168, v169
    v_cvt_pk_bf16_f32 v169, v170, v171
    v_cvt_pk_bf16_f32 v170, v172, v173
    v_cvt_pk_bf16_f32 v171, v174, v175
    buffer_store_dwordx4 v[168:171], v2, s[8:11], s90 offen sc1
    s_add_u32 s90, s90, s100
    v_pk_mul_f32 v[176:177], v[176:177], s[92:93]
    v_pk_mul_f32 v[178:179], v[178:179], s[92:93]
    v_pk_mul_f32 v[180:181], v[180:181], s[92:93]
    v_pk_mul_f32 v[182:183], v[182:183], s[92:93]
    v_cvt_pk_bf16_f32 v176, v176, v177
    v_cvt_pk_bf16_f32 v177, v178, v179
    v_cvt_pk_bf16_f32 v178, v180, v181
    v_cvt_pk_bf16_f32 v179, v182, v183
    buffer_store_dwordx4 v[176:179], v2, s[8:11], s90 offen sc1
    s_add_u32 s90, s90, s100
    v_pk_mul_f32 v[184:185], v[184:185], s[92:93]
    v_pk_mul_f32 v[186:187], v[186:187], s[92:93]
    v_pk_mul_f32 v[188:189], v[188:189], s[92:93]
    v_pk_mul_f32 v[190:191], v[190:191], s[92:93]
    v_cvt_pk_bf16_f32 v184, v184, v185
    v_cvt_pk_bf16_f32 v185, v186, v187
    v_cvt_pk_bf16_f32 v186, v188, v189
    v_cvt_pk_bf16_f32 v187, v190, v191
    buffer_store_dwordx4 v[184:187], v2, s[8:11], s90 offen sc1
    s_add_u32 s90, s90, s100
    v_pk_mul_f32 v[192:193], v[192:193], s[92:93]
    v_pk_mul_f32 v[194:195], v[194:195], s[92:93]
    v_pk_mul_f32 v[196:197], v[196:197], s[92:93]
    v_pk_mul_f32 v[198:199], v[198:199], s[92:93]
    v_cvt_pk_bf16_f32 v192, v192, v193
    v_cvt_pk_bf16_f32 v193, v194, v195
    v_cvt_pk_bf16_f32 v194, v196, v197
    v_cvt_pk_bf16_f32 v195, v198, v199
    buffer_store_dwordx4 v[192:195], v2, s[8:11], s90 offen sc1
    s_add_u32 s90, s90, s100
    v_pk_mul_f32 v[200:201], v[200:201], s[92:93]
    v_pk_mul_f32 v[202:203], v[202:203], s[92:93]
    v_pk_mul_f32 v[204:205], v[204:205], s[92:93]
    v_pk_mul_f32 v[206:207], v[206:207], s[92:93]
    v_cvt_pk_bf16_f32 v200, v200, v201
    v_cvt_pk_bf16_f32 v201, v202, v203
    v_cvt_pk_bf16_f32 v202, v204, v205
    v_cvt_pk_bf16_f32 v203, v206, v207
    buffer_store_dwordx4 v[200:203], v2, s[8:11], s90 offen sc1
    s_add_u32 s90, s90, s100
    v_pk_mul_f32 v[208:209], v[208:209], s[92:93]
    v_pk_mul_f32 v[210:211], v[210:211], s[92:93]
    v_pk_mul_f32 v[212:213], v[212:213], s[92:93]
    v_pk_mul_f32 v[214:215], v[214:215], s[92:93]
    v_cvt_pk_bf16_f32 v208, v208, v209
    v_cvt_pk_bf16_f32 v209, v210, v211
    v_cvt_pk_bf16_f32 v210, v212, v213
    v_cvt_pk_bf16_f32 v211, v214, v215
    buffer_store_dwordx4 v[208:211], v2, s[8:11], s90 offen sc1
    s_add_u32 s90, s90, s100
    v_pk_mul_f32 v[216:217], v[216:217], s[92:93]
    v_pk_mul_f32 v[218:219], v[218:219], s[92:93]
    v_pk_mul_f32 v[220:221], v[220:221], s[92:93]
    v_pk_mul_f32 v[222:223], v[222:223], s[92:93]
    v_cvt_pk_bf16_f32 v216, v216, v217
    v_cvt_pk_bf16_f32 v217, v218, v219
    v_cvt_pk_bf16_f32 v218, v220, v221
    v_cvt_pk_bf16_f32 v219, v222, v223
    buffer_store_dwordx4 v[216:219], v2, s[8:11], s90 offen sc1
    s_add_u32 s90, s90, s100
    s_add_u32 s91, s91, s99
    s_mov_b32 s90, s91
    v_pk_mul_f32 v[224:225], v[224:225], s[92:93]
    v_pk_mul_f32 v[226:227], v[226:227], s[92:93]
    v_pk_mul_f32 v[228:229], v[228:229], s[92:93]
    v_pk_mul_f32 v[230:231], v[230:231], s[92:93]
    v_cvt_pk_bf16_f32 v224, v224, v225
    v_cvt_pk_bf16_f32 v225, v226, v227
    v_cvt_pk_bf16_f32 v226, v228, v229
    v_cvt_pk_bf16_f32 v227, v230, v231
    buffer_store_dwordx4 v[224:227], v2, s[8:11], s90 offen sc1
    s_add_u32 s90, s90, s100
    v_pk_mul_f32 v[232:233], v[232:233], s[92:93]
    v_pk_mul_f32 v[234:235], v[234:235], s[92:93]
    v_pk_mul_f32 v[236:237], v[236:237], s[92:93]
    v_pk_mul_f32 v[238:239], v[238:239], s[92:93]
    v_cvt_pk_bf16_f32 v232, v232, v233
    v_cvt_pk_bf16_f32 v233, v234, v235
    v_cvt_pk_bf16_f32 v234, v236, v237
    v_cvt_pk_bf16_f32 v235, v238, v239
    buffer_store_dwordx4 v[232:235], v2, s[8:11], s90 offen sc1
    s_add_u32 s90, s90, s100
    v_pk_mul_f32 v[240:241], v[240:241], s[92:93]
    v_pk_mul_f32 v[242:243], v[242:243], s[92:93]
    v_pk_mul_f32 v[244:245], v[244:245], s[92:93]
    v_pk_mul_f32 v[246:247], v[246:247], s[92:93]
    v_cvt_pk_bf16_f32 v240, v240, v241
    v_cvt_pk_bf16_f32 v241, v242, v243
    v_cvt_pk_bf16_f32 v242, v244, v245
    v_cvt_pk_bf16_f32 v243, v246, v247
    buffer_store_dwordx4 v[240:243], v2, s[8:11], s90 offen sc1
    s_add_u32 s90, s90, s100
    v_pk_mul_f32 v[248:249], v[248:249], s[92:93]
    v_pk_mul_f32 v[250:251], v[250:251], s[92:93]
    v_pk_mul_f32 v[252:253], v[252:253], s[92:93]
    v_pk_mul_f32 v[254:255], v[254:255], s[92:93]
    v_cvt_pk_bf16_f32 v248, v248, v249
    v_cvt_pk_bf16_f32 v249, v250, v251
    v_cvt_pk_bf16_f32 v250, v252, v253
    v_cvt_pk_bf16_f32 v251, v254, v255
    buffer_store_dwordx4 v[248:251], v2, s[8:11], s90 offen sc1
    s_add_u32 s90, s90, s100
    v_accvgpr_read_b32 v24, a224
    v_accvgpr_read_b32 v25, a225
    v_accvgpr_read_b32 v26, a226
    v_accvgpr_read_b32 v27, a227
    v_accvgpr_read_b32 v28, a228
    v_accvgpr_read_b32 v29, a229
    v_accvgpr_read_b32 v30, a230
    v_accvgpr_read_b32 v31, a231
    v_pk_mul_f32 v[24:25], v[24:25], s[92:93]
    v_pk_mul_f32 v[26:27], v[26:27], s[92:93]
    v_pk_mul_f32 v[28:29], v[28:29], s[92:93]
    v_pk_mul_f32 v[30:31], v[30:31], s[92:93]
    v_cvt_pk_bf16_f32 v24, v24, v25
    v_cvt_pk_bf16_f32 v25, v26, v27
    v_cvt_pk_bf16_f32 v26, v28, v29
    v_cvt_pk_bf16_f32 v27, v30, v31
    buffer_store_dwordx4 v[24:27], v2, s[8:11], s90 offen sc1
    s_add_u32 s90, s90, s100
    s_nop 1
    v_accvgpr_read_b32 v24, a232
    v_accvgpr_read_b32 v25, a233
    v_accvgpr_read_b32 v26, a234
    v_accvgpr_read_b32 v27, a235
    v_accvgpr_read_b32 v28, a236
    v_accvgpr_read_b32 v29, a237
    v_accvgpr_read_b32 v30, a238
    v_accvgpr_read_b32 v31, a239
    v_pk_mul_f32 v[24:25], v[24:25], s[92:93]
    v_pk_mul_f32 v[26:27], v[26:27], s[92:93]
    v_pk_mul_f32 v[28:29], v[28:29], s[92:93]
    v_pk_mul_f32 v[30:31], v[30:31], s[92:93]
    v_cvt_pk_bf16_f32 v24, v24, v25
    v_cvt_pk_bf16_f32 v25, v26, v27
    v_cvt_pk_bf16_f32 v26, v28, v29
    v_cvt_pk_bf16_f32 v27, v30, v31
    buffer_store_dwordx4 v[24:27], v2, s[8:11], s90 offen sc1
    s_add_u32 s90, s90, s100
    s_nop 1
    v_accvgpr_read_b32 v24, a240
    v_accvgpr_read_b32 v25, a241
    v_accvgpr_read_b32 v26, a242
    v_accvgpr_read_b32 v27, a243
    v_accvgpr_read_b32 v28, a244
    v_accvgpr_read_b32 v29, a245
    v_accvgpr_read_b32 v30, a246
    v_accvgpr_read_b32 v31, a247
    v_pk_mul_f32 v[24:25], v[24:25], s[92:93]
    v_pk_mul_f32 v[26:27], v[26:27], s[92:93]
    v_pk_mul_f32 v[28:29], v[28:29], s[92:93]
    v_pk_mul_f32 v[30:31], v[30:31], s[92:93]
    v_cvt_pk_bf16_f32 v24, v24, v25
    v_cvt_pk_bf16_f32 v25, v26, v27
    v_cvt_pk_bf16_f32 v26, v28, v29
    v_cvt_pk_bf16_f32 v27, v30, v31
    buffer_store_dwordx4 v[24:27], v2, s[8:11], s90 offen sc1
    s_add_u32 s90, s90, s100
    s_nop 1
    v_accvgpr_read_b32 v24, a248
    v_accvgpr_read_b32 v25, a249
    v_accvgpr_read_b32 v26, a250
    v_accvgpr_read_b32 v27, a251
    v_accvgpr_read_b32 v28, a252
    v_accvgpr_read_b32 v29, a253
    v_accvgpr_read_b32 v30, a254
    v_accvgpr_read_b32 v31, a255
    v_pk_mul_f32 v[24:25], v[24:25], s[92:93]
    v_pk_mul_f32 v[26:27], v[26:27], s[92:93]
    v_pk_mul_f32 v[28:29], v[28:29], s[92:93]
    v_pk_mul_f32 v[30:31], v[30:31], s[92:93]
    v_cvt_pk_bf16_f32 v24, v24, v25
    v_cvt_pk_bf16_f32 v25, v26, v27
    v_cvt_pk_bf16_f32 v26, v28, v29
    v_cvt_pk_bf16_f32 v27, v30, v31
    buffer_store_dwordx4 v[24:27], v2, s[8:11], s90 offen sc1
    s_add_u32 s90, s90, s100
    s_nop 1
    s_add_u32 s91, s91, s99
m_epf27_r:
    s_mov_b32 s17, s101
    s_mov_b32 s66, 2
    s_branch m_q135
m_q036:
m_eps28:
    s_nop 3
    s_mov_b32 s90, s98
    v_cvt_pk_bf16_f32 v32, v32, v33
    v_cvt_pk_bf16_f32 v33, v34, v35
    v_cvt_pk_bf16_f32 v34, v36, v37
    v_cvt_pk_bf16_f32 v35, v38, v39
    buffer_store_dwordx4 v[32:35], v2, s[8:11], s90 offen sc1
    s_add_u32 s90, s90, s100
    v_cvt_pk_bf16_f32 v40, v40, v41
    v_cvt_pk_bf16_f32 v41, v42, v43
    v_cvt_pk_bf16_f32 v42, v44, v45
    v_cvt_pk_bf16_f32 v43, v46, v47
    buffer_store_dwordx4 v[40:43], v2, s[8:11], s90 offen sc1
    s_add_u32 s90, s90, s100
    v_cvt_pk_bf16_f32 v48, v48, v49
    v_cvt_pk_bf16_f32 v49, v50, v51
    v_cvt_pk_bf16_f32 v50, v52, v53
    v_cvt_pk_bf16_f32 v51, v54, v55
    buffer_store_dwordx4 v[48:51], v2, s[8:11], s90 offen sc1
    s_add_u32 s90, s90, s100
    v_cvt_pk_bf16_f32 v56, v56, v57
    v_cvt_pk_bf16_f32 v57, v58, v59
    v_cvt_pk_bf16_f32 v58, v60, v61
    v_cvt_pk_bf16_f32 v59, v62, v63
    buffer_store_dwordx4 v[56:59], v2, s[8:11], s90 offen sc1
    s_add_u32 s90, s90, s100
    v_cvt_pk_bf16_f32 v64, v64, v65
    v_cvt_pk_bf16_f32 v65, v66, v67
    v_cvt_pk_bf16_f32 v66, v68, v69
    v_cvt_pk_bf16_f32 v67, v70, v71
    buffer_store_dwordx4 v[64:67], v2, s[8:11], s90 offen sc1
    s_add_u32 s90, s90, s100
    v_cvt_pk_bf16_f32 v72, v72, v73
    v_cvt_pk_bf16_f32 v73, v74, v75
    v_cvt_pk_bf16_f32 v74, v76, v77
    v_cvt_pk_bf16_f32 v75, v78, v79
    buffer_store_dwordx4 v[72:75], v2, s[8:11], s90 offen sc1
    s_add_u32 s90, s90, s100
    v_cvt_pk_bf16_f32 v80, v80, v81
    v_cvt_pk_bf16_f32 v81, v82, v83
    v_cvt_pk_bf16_f32 v82, v84, v85
    v_cvt_pk_bf16_f32 v83, v86, v87
    buffer_store_dwordx4 v[80:83], v2, s[8:11], s90 offen sc1
    s_add_u32 s90, s90, s100
    v_cvt_pk_bf16_f32 v88, v88, v89
    v_cvt_pk_bf16_f32 v89, v90, v91
    v_cvt_pk_bf16_f32 v90, v92, v93
    v_cvt_pk_bf16_f32 v91, v94, v95
    buffer_store_dwordx4 v[88:91], v2, s[8:11], s90 offen sc1
    s_add_u32 s90, s90, s100
    v_cvt_pk_bf16_f32 v96, v96, v97
    v_cvt_pk_bf16_f32 v97, v98, v99
    v_cvt_pk_bf16_f32 v98, v100, v101
    v_cvt_pk_bf16_f32 v99, v102, v103
    v_accvgpr_write_b32 a128, v96
    v_accvgpr_write_b32 a129, v97
    v_accvgpr_write_b32 a130, v98
    v_accvgpr_write_b32 a131, v99
    v_cvt_pk_bf16_f32 v104, v104, v105
    v_cvt_pk_bf16_f32 v105, v106, v107
    v_cvt_pk_bf16_f32 v106, v108, v109
    v_cvt_pk_bf16_f32 v107, v110, v111
    v_accvgpr_write_b32 a132, v104
    v_accvgpr_write_b32 a133, v105
    v_accvgpr_write_b32 a134, v106
    v_accvgpr_write_b32 a135, v107
    v_cvt_pk_bf16_f32 v112, v112, v113
    v_cvt_pk_bf16_f32 v113, v114, v115
    v_cvt_pk_bf16_f32 v114, v116, v117
    v_cvt_pk_bf16_f32 v115, v118, v119
    v_accvgpr_write_b32 a136, v112
    v_accvgpr_write_b32 a137, v113
    v_accvgpr_write_b32 a138, v114
    v_accvgpr_write_b32 a139, v115
    v_cvt_pk_bf16_f32 v120, v120, v121
    v_cvt_pk_bf16_f32 v121, v122, v123
    v_cvt_pk_bf16_f32 v122, v124, v125
    v_cvt_pk_bf16_f32 v123, v126, v127
    v_accvgpr_write_b32 a140, v120
    v_accvgpr_write_b32 a141, v121
    v_accvgpr_write_b32 a142, v122
    v_accvgpr_write_b32 a143, v123
    v_cvt_pk_bf16_f32 v128, v128, v129
    v_cvt_pk_bf16_f32 v129, v130, v131
    v_cvt_pk_bf16_f32 v130, v132, v133
    v_cvt_pk_bf16_f32 v131, v134, v135
    v_accvgpr_write_b32 a144, v128
    v_accvgpr_write_b32 a145, v129
    v_accvgpr_write_b32 a146, v130
    v_accvgpr_write_b32 a147, v131
    v_cvt_pk_bf16_f32 v136, v136, v137
    v_cvt_pk_bf16_f32 v137, v138, v139
    v_cvt_pk_bf16_f32 v138, v140, v141
    v_cvt_pk_bf16_f32 v139, v142, v143
    v_accvgpr_write_b32 a148, v136
    v_accvgpr_write_b32 a149, v137
    v_accvgpr_write_b32 a150, v138
    v_accvgpr_write_b32 a151, v139
    v_cvt_pk_bf16_f32 v144, v144, v145
    v_cvt_pk_bf16_f32 v145, v146, v147
    v_cvt_pk_bf16_f32 v146, v148, v149
    v_cvt_pk_bf16_f32 v147, v150, v151
    v_accvgpr_write_b32 a152, v144
    v_accvgpr_write_b32 a153, v145
    v_accvgpr_write_b32 a154, v146
    v_accvgpr_write_b32 a155, v147
    v_cvt_pk_bf16_f32 v152, v152, v153
    v_cvt_pk_bf16_f32 v153, v154, v155
    v_cvt_pk_bf16_f32 v154, v156, v157
    v_cvt_pk_bf16_f32 v155, v158, v159
    v_accvgpr_write_b32 a156, v152
    v_accvgpr_write_b32 a157, v153
    v_accvgpr_write_b32 a158, v154
    v_accvgpr_write_b32 a159, v155
    v_cvt_pk_bf16_f32 v160, v160, v161
    v_cvt_pk_bf16_f32 v161, v162, v163
    v_cvt_pk_bf16_f32 v162, v164, v165
    v_cvt_pk_bf16_f32 v163, v166, v167
    v_accvgpr_write_b32 a160, v160
    v_accvgpr_write_b32 a161, v161
    v_accvgpr_write_b32 a162, v162
    v_accvgpr_write_b32 a163, v163
    v_cvt_pk_bf16_f32 v168, v168, v169
    v_cvt_pk_bf16_f32 v169, v170, v171
    v_cvt_pk_bf16_f32 v170, v172, v173
    v_cvt_pk_bf16_f32 v171, v174, v175
    v_accvgpr_write_b32 a164, v168
    v_accvgpr_write_b32 a165, v169
    v_accvgpr_write_b32 a166, v170
    v_accvgpr_write_b32 a167, v171
    v_cvt_pk_bf16_f32 v176, v176, v177
    v_cvt_pk_bf16_f32 v177, v178, v179
    v_cvt_pk_bf16_f32 v178, v180, v181
    v_cvt_pk_bf16_f32 v179, v182, v183
    v_accvgpr_write_b32 a168, v176
    v_accvgpr_write_b32 a169, v177
    v_accvgpr_write_b32 a170, v178
    v_accvgpr_write_b32 a171, v179
    v_cvt_pk_bf16_f32 v184, v184, v185
    v_cvt_pk_bf16_f32 v185, v186, v187
    v_cvt_pk_bf16_f32 v186, v188, v189
    v_cvt_pk_bf16_f32 v187, v190, v191
    v_accvgpr_write_b32 a172, v184
    v_accvgpr_write_b32 a173, v185
    v_accvgpr_write_b32 a174, v186
    v_accvgpr_write_b32 a175, v187
    v_cvt_pk_bf16_f32 v192, v192, v193
    v_cvt_pk_bf16_f32 v193, v194, v195
    v_cvt_pk_bf16_f32 v194, v196, v197
    v_cvt_pk_bf16_f32 v195, v198, v199
    v_accvgpr_write_b32 a176, v192
    v_accvgpr_write_b32 a177, v193
    v_accvgpr_write_b32 a178, v194
    v_accvgpr_write_b32 a179, v195
    v_cvt_pk_bf16_f32 v200, v200, v201
    v_cvt_pk_bf16_f32 v201, v202, v203
    v_cvt_pk_bf16_f32 v202, v204, v205
    v_cvt_pk_bf16_f32 v203, v206, v207
    v_accvgpr_write_b32 a180, v200
    v_accvgpr_write_b32 a181, v201
    v_accvgpr_write_b32 a182, v202
    v_accvgpr_write_b32 a183, v203
    v_cvt_pk_bf16_f32 v208, v208, v209
    v_cvt_pk_bf16_f32 v209, v210, v211
    v_cvt_pk_bf16_f32 v210, v212, v213
    v_cvt_pk_bf16_f32 v211, v214, v215
    v_accvgpr_write_b32 a184, v208
    v_accvgpr_write_b32 a185, v209
    v_accvgpr_write_b32 a186, v210
    v_accvgpr_write_b32 a187, v211
    v_cvt_pk_bf16_f32 v216, v216, v217
    v_cvt_pk_bf16_f32 v217, v218, v219
    v_cvt_pk_bf16_f32 v218, v220, v221
    v_cvt_pk_bf16_f32 v219, v222, v223
    v_accvgpr_write_b32 a188, v216
    v_accvgpr_write_b32 a189, v217
    v_accvgpr_write_b32 a190, v218
    v_accvgpr_write_b32 a191, v219
    v_cvt_pk_bf16_f32 v224, v224, v225
    v_cvt_pk_bf16_f32 v225, v226, v227
    v_cvt_pk_bf16_f32 v226, v228, v229
    v_cvt_pk_bf16_f32 v227, v230, v231
    v_accvgpr_write_b32 a192, v224
    v_accvgpr_write_b32 a193, v225
    v_accvgpr_write_b32 a194, v226
    v_accvgpr_write_b32 a195, v227
    v_cvt_pk_bf16_f32 v232, v232, v233
    v_cvt_pk_bf16_f32 v233, v234, v235
    v_cvt_pk_bf16_f32 v234, v236, v237
    v_cvt_pk_bf16_f32 v235, v238, v239
    v_accvgpr_write_b32 a196, v232
    v_accvgpr_write_b32 a197, v233
    v_accvgpr_write_b32 a198, v234
    v_accvgpr_write_b32 a199, v235
    v_cvt_pk_bf16_f32 v240, v240, v241
    v_cvt_pk_bf16_f32 v241, v242, v243
    v_cvt_pk_bf16_f32 v242, v244, v245
    v_cvt_pk_bf16_f32 v243, v246, v247
    v_accvgpr_write_b32 a200, v240
    v_accvgpr_write_b32 a201, v241
    v_accvgpr_write_b32 a202, v242
    v_accvgpr_write_b32 a203, v243
    v_cvt_pk_bf16_f32 v248, v248, v249
    v_cvt_pk_bf16_f32 v249, v250, v251
    v_cvt_pk_bf16_f32 v250, v252, v253
    v_cvt_pk_bf16_f32 v251, v254, v255
    v_accvgpr_write_b32 a204, v248
    v_accvgpr_write_b32 a205, v249
    v_accvgpr_write_b32 a206, v250
    v_accvgpr_write_b32 a207, v251
    v_accvgpr_read_b32 v24, a224
    v_accvgpr_read_b32 v25, a225
    v_accvgpr_read_b32 v26, a226
    v_accvgpr_read_b32 v27, a227
    v_accvgpr_read_b32 v28, a228
    v_accvgpr_read_b32 v29, a229
    v_accvgpr_read_b32 v30, a230
    v_accvgpr_read_b32 v31, a231
    v_cvt_pk_bf16_f32 v24, v24, v25
    v_cvt_pk_bf16_f32 v25, v26, v27
    v_cvt_pk_bf16_f32 v26, v28, v29
    v_cvt_pk_bf16_f32 v27, v30, v31
    v_accvgpr_write_b32 a208, v24
    v_accvgpr_write_b32 a209, v25
    v_accvgpr_write_b32 a210, v26
    v_accvgpr_write_b32 a211, v27
    v_accvgpr_read_b32 v24, a232
    v_accvgpr_read_b32 v25, a233
    v_accvgpr_read_b32 v26, a234
    v_accvgpr_read_b32 v27, a235
    v_accvgpr_read_b32 v28, a236
    v_accvgpr_read_b32 v29, a237
    v_accvgpr_read_b32 v30, a238
    v_accvgpr_read_b32 v31, a239
    v_cvt_pk_bf16_f32 v24, v24, v25
    v_cvt_pk_bf16_f32 v25, v26, v27
    v_cvt_pk_bf16_f32 v26, v28, v29
    v_cvt_pk_bf16_f32 v27, v30, v31
    v_accvgpr_write_b32 a212, v24
    v_accvgpr_write_b32 a213, v25
    v_accvgpr_write_b32 a214, v26
    v_accvgpr_write_b32 a215, v27
    v_accvgpr_read_b32 v24, a240
    v_accvgpr_read_b32 v25, a241
    v_accvgpr_read_b32 v26, a242
    v_accvgpr_read_b32 v27, a243
    v_accvgpr_read_b32 v28, a244
    v_accvgpr_read_b32 v29, a245
    v_accvgpr_read_b32 v30, a246
    v_accvgpr_read_b32 v31, a247
    v_cvt_pk_bf16_f32 v24, v24, v25
    v_cvt_pk_bf16_f32 v25, v26, v27
    v_cvt_pk_bf16_f32 v26, v28, v29
    v_cvt_pk_bf16_f32 v27, v30, v31
    v_accvgpr_write_b32 a216, v24
    v_accvgpr_write_b32 a217, v25
    v_accvgpr_write_b32 a218, v26
    v_accvgpr_write_b32 a219, v27
    v_accvgpr_read_b32 v24, a248
    v_accvgpr_read_b32 v25, a249
    v_accvgpr_read_b32 v26, a250
    v_accvgpr_read_b32 v27, a251
    v_accvgpr_read_b32 v28, a252
    v_accvgpr_read_b32 v29, a253
    v_accvgpr_read_b32 v30, a254
    v_accvgpr_read_b32 v31, a255
    v_cvt_pk_bf16_f32 v24, v24, v25
    v_cvt_pk_bf16_f32 v25, v26, v27
    v_cvt_pk_bf16_f32 v26, v28, v29
    v_cvt_pk_bf16_f32 v27, v30, v31
    v_accvgpr_write_b32 a220, v24
    v_accvgpr_write_b32 a221, v25
    v_accvgpr_write_b32 a222, v26
    v_accvgpr_write_b32 a223, v27
m_eps28_r:
    s_mov_b32 s17, s101
    s_add_u32 s28, s98, s99
    s_mov_b32 s29, s28
    s_mov_b32 s30, s99
    s_mov_b32 s31, s100
    s_mov_b32 s26, 268435456
m_q135:
    s_mov_b32 s95, s82
    s_mov_b32 s96, s83
    s_mov_b32 s97, s84
    s_mov_b32 s98, s85
    s_mov_b32 s99, s86
    s_mov_b32 s100, s87
    s_mov_b32 s101, s88
    s_sub_u32 s67, s95, 5
    s_max_u32 s67, s67, 4
    s_mov_b32 s94, 0
    s_branch m_tile14
m_last29:
m_kvl32:
    s_waitcnt lgkmcnt(0)
    s_and_b32 s92, s2, 7
    s_lshl_b32 s92, s92, 2
    s_bfe_u32 s93, s2, 0x20003
    s_add_u32 s92, s92, s93
    s_lshr_b32 s93, s2, 5
    s_lshl_b32 s93, s93, 2
    s_or_b32 s93, s93, 0x40000
    s_mov_b32 s32, s92
    s_bfe_u32 s33, 4225681832, s93
    s_add_u32 s33, s33, 1
    s_bfe_u32 s34, 873473623, s93
    s_add_u32 s34, s34, 1
    s_lshl_b32 s60, s16, 12
    v_add_u32 v7, s60, v2
    s_lshl_b32 s90, s34, 2
    s_lshl_b32 s91, s33, 2
    s_lshl_b32 s26, s91, 13
    s_mov_b32 s30, s26
    s_sub_u32 s67, s90, 4
    s_add_u32 s67, s67, s16
    s_add_u32 s68, s67, 1
    s_mov_b32 s69, s90
    s_sub_u32 s70, s91, 4
    s_add_u32 s70, s70, s16
    s_add_u32 s71, s70, 1
    s_mov_b32 s72, s91
    s_cmp_lt_u32 s16, 2
    s_cselect_b32 s90, 2, 0
    s_sub_u32 s72, s72, s90
    s_mov_b32 s27, 0x20000
    s_mov_b32 s31, 0x20000
    s_lshl_b32 s82, s32, 19
    s_add_u32 s90, s82, 16777216
    s_add_u32 s24, s6, s90
    s_addc_u32 s25, s7, 0
    s_add_u32 s90, s82, 33554432
    s_add_u32 s28, s6, s90
    s_addc_u32 s29, s7, 0
    s_load_dwordx2 s[48:49], s[0:1], 64
    s_load_dwordx2 s[50:51], s[0:1], 16
    s_load_dwordx2 s[54:55], s[0:1], 72
    s_mov_b32 s47, 0x20000
m_epl85:
    s_mov_b32 s92, s97
    s_mov_b32 s93, s97
    s_cmp_eq_u32 s97, 0
    s_cbranch_scc1 m_ns286
    s_mov_b32 s90, s98
    v_pk_mul_f32 v[32:33], v[32:33], s[92:93]
    v_pk_mul_f32 v[34:35], v[34:35], s[92:93]
    v_pk_mul_f32 v[36:37], v[36:37], s[92:93]
    v_pk_mul_f32 v[38:39], v[38:39], s[92:93]
    v_cvt_pk_bf16_f32 v32, v32, v33
    v_cvt_pk_bf16_f32 v33, v34, v35
    v_cvt_pk_bf16_f32 v34, v36, v37
    v_cvt_pk_bf16_f32 v35, v38, v39
    buffer_store_dwordx4 v[32:35], v2, s[8:11], s90 offen sc1
    s_add_u32 s90, s90, s100
    v_accvgpr_write_b32 a0, 0
    v_accvgpr_write_b32 a1, 0
    v_accvgpr_write_b32 a2, 0
    v_accvgpr_write_b32 a3, 0
    v_accvgpr_write_b32 a4, 0
    v_accvgpr_write_b32 a5, 0
    v_accvgpr_write_b32 a6, 0
    v_accvgpr_write_b32 a7, 0
    v_pk_mul_f32 v[192:193], v[192:193], s[92:93]
    v_pk_mul_f32 v[194:195], v[194:195], s[92:93]
    v_pk_mul_f32 v[196:197], v[196:197], s[92:93]
    v_pk_mul_f32 v[198:199], v[198:199], s[92:93]
    v_cvt_pk_bf16_f32 v192, v192, v193
    v_cvt_pk_bf16_f32 v193, v194, v195
    v_cvt_pk_bf16_f32 v194, v196, v197
    v_cvt_pk_bf16_f32 v195, v198, v199
    v_pk_mul_f32 v[40:41], v[40:41], s[92:93]
    v_pk_mul_f32 v[42:43], v[42:43], s[92:93]
    v_pk_mul_f32 v[44:45], v[44:45], s[92:93]
    v_pk_mul_f32 v[46:47], v[46:47], s[92:93]
    v_cvt_pk_bf16_f32 v40, v40, v41
    v_cvt_pk_bf16_f32 v41, v42, v43
    v_cvt_pk_bf16_f32 v42, v44, v45
    v_cvt_pk_bf16_f32 v43, v46, v47
    buffer_store_dwordx4 v[40:43], v2, s[8:11], s90 offen sc1
    s_add_u32 s90, s90, s100
    v_accvgpr_write_b32 a8, 0
    v_accvgpr_write_b32 a9, 0
    v_accvgpr_write_b32 a10, 0
    v_accvgpr_write_b32 a11, 0
    v_accvgpr_write_b32 a12, 0
    v_accvgpr_write_b32 a13, 0
    v_accvgpr_write_b32 a14, 0
    v_accvgpr_write_b32 a15, 0
    v_pk_mul_f32 v[200:201], v[200:201], s[92:93]
    v_pk_mul_f32 v[202:203], v[202:203], s[92:93]
    v_pk_mul_f32 v[204:205], v[204:205], s[92:93]
    v_pk_mul_f32 v[206:207], v[206:207], s[92:93]
    v_cvt_pk_bf16_f32 v196, v200, v201
    v_cvt_pk_bf16_f32 v197, v202, v203
    v_cvt_pk_bf16_f32 v198, v204, v205
    v_cvt_pk_bf16_f32 v199, v206, v207
    v_pk_mul_f32 v[48:49], v[48:49], s[92:93]
    v_pk_mul_f32 v[50:51], v[50:51], s[92:93]
    v_pk_mul_f32 v[52:53], v[52:53], s[92:93]
    v_pk_mul_f32 v[54:55], v[54:55], s[92:93]
    v_cvt_pk_bf16_f32 v48, v48, v49
    v_cvt_pk_bf16_f32 v49, v50, v51
    v_cvt_pk_bf16_f32 v50, v52, v53
    v_cvt_pk_bf16_f32 v51, v54, v55
    buffer_store_dwordx4 v[48:51], v2, s[8:11], s90 offen sc1
    s_add_u32 s90, s90, s100
    v_accvgpr_write_b32 a16, 0
    v_accvgpr_write_b32 a17, 0
    v_accvgpr_write_b32 a18, 0
    v_accvgpr_write_b32 a19, 0
    v_accvgpr_write_b32 a20, 0
    v_accvgpr_write_b32 a21, 0
    v_accvgpr_write_b32 a22, 0
    v_accvgpr_write_b32 a23, 0
    v_pk_mul_f32 v[208:209], v[208:209], s[92:93]
    v_pk_mul_f32 v[210:211], v[210:211], s[92:93]
    v_pk_mul_f32 v[212:213], v[212:213], s[92:93]
    v_pk_mul_f32 v[214:215], v[214:215], s[92:93]
    v_cvt_pk_bf16_f32 v200, v208, v209
    v_cvt_pk_bf16_f32 v201, v210, v211
    v_cvt_pk_bf16_f32 v202, v212, v213
    v_cvt_pk_bf16_f32 v203, v214, v215
    v_pk_mul_f32 v[56:57], v[56:57], s[92:93]
    v_pk_mul_f32 v[58:59], v[58:59], s[92:93]
    v_pk_mul_f32 v[60:61], v[60:61], s[92:93]
    v_pk_mul_f32 v[62:63], v[62:63], s[92:93]
    v_cvt_pk_bf16_f32 v56, v56, v57
    v_cvt_pk_bf16_f32 v57, v58, v59
    v_cvt_pk_bf16_f32 v58, v60, v61
    v_cvt_pk_bf16_f32 v59, v62, v63
    buffer_store_dwordx4 v[56:59], v2, s[8:11], s90 offen sc1
    s_add_u32 s90, s90, s100
    v_accvgpr_write_b32 a24, 0
    v_accvgpr_write_b32 a25, 0
    v_accvgpr_write_b32 a26, 0
    v_accvgpr_write_b32 a27, 0
    v_accvgpr_write_b32 a28, 0
    v_accvgpr_write_b32 a29, 0
    v_accvgpr_write_b32 a30, 0
    v_accvgpr_write_b32 a31, 0
    v_pk_mul_f32 v[216:217], v[216:217], s[92:93]
    v_pk_mul_f32 v[218:219], v[218:219], s[92:93]
    v_pk_mul_f32 v[220:221], v[220:221], s[92:93]
    v_pk_mul_f32 v[222:223], v[222:223], s[92:93]
    v_cvt_pk_bf16_f32 v204, v216, v217
    v_cvt_pk_bf16_f32 v205, v218, v219
    v_cvt_pk_bf16_f32 v206, v220, v221
    v_cvt_pk_bf16_f32 v207, v222, v223
    v_pk_mul_f32 v[64:65], v[64:65], s[92:93]
    v_pk_mul_f32 v[66:67], v[66:67], s[92:93]
    v_pk_mul_f32 v[68:69], v[68:69], s[92:93]
    v_pk_mul_f32 v[70:71], v[70:71], s[92:93]
    v_cvt_pk_bf16_f32 v64, v64, v65
    v_cvt_pk_bf16_f32 v65, v66, v67
    v_cvt_pk_bf16_f32 v66, v68, v69
    v_cvt_pk_bf16_f32 v67, v70, v71
    buffer_store_dwordx4 v[64:67], v2, s[8:11], s90 offen sc1
    s_add_u32 s90, s90, s100
    v_accvgpr_write_b32 a32, 0
    v_accvgpr_write_b32 a33, 0
    v_accvgpr_write_b32 a34, 0
    v_accvgpr_write_b32 a35, 0
    v_accvgpr_write_b32 a36, 0
    v_accvgpr_write_b32 a37, 0
    v_accvgpr_write_b32 a38, 0
    v_accvgpr_write_b32 a39, 0
    v_pk_mul_f32 v[224:225], v[224:225], s[92:93]
    v_pk_mul_f32 v[226:227], v[226:227], s[92:93]
    v_pk_mul_f32 v[228:229], v[228:229], s[92:93]
    v_pk_mul_f32 v[230:231], v[230:231], s[92:93]
    v_cvt_pk_bf16_f32 v208, v224, v225
    v_cvt_pk_bf16_f32 v209, v226, v227
    v_cvt_pk_bf16_f32 v210, v228, v229
    v_cvt_pk_bf16_f32 v211, v230, v231
    v_pk_mul_f32 v[72:73], v[72:73], s[92:93]
    v_pk_mul_f32 v[74:75], v[74:75], s[92:93]
    v_pk_mul_f32 v[76:77], v[76:77], s[92:93]
    v_pk_mul_f32 v[78:79], v[78:79], s[92:93]
    v_cvt_pk_bf16_f32 v72, v72, v73
    v_cvt_pk_bf16_f32 v73, v74, v75
    v_cvt_pk_bf16_f32 v74, v76, v77
    v_cvt_pk_bf16_f32 v75, v78, v79
    buffer_store_dwordx4 v[72:75], v2, s[8:11], s90 offen sc1
    s_add_u32 s90, s90, s100
    v_accvgpr_write_b32 a40, 0
    v_accvgpr_write_b32 a41, 0
    v_accvgpr_write_b32 a42, 0
    v_accvgpr_write_b32 a43, 0
    v_accvgpr_write_b32 a44, 0
    v_accvgpr_write_b32 a45, 0
    v_accvgpr_write_b32 a46, 0
    v_accvgpr_write_b32 a47, 0
    v_pk_mul_f32 v[232:233], v[232:233], s[92:93]
    v_pk_mul_f32 v[234:235], v[234:235], s[92:93]
    v_pk_mul_f32 v[236:237], v[236:237], s[92:93]
    v_pk_mul_f32 v[238:239], v[238:239], s[92:93]
    v_cvt_pk_bf16_f32 v212, v232, v233
    v_cvt_pk_bf16_f32 v213, v234, v235
    v_cvt_pk_bf16_f32 v214, v236, v237
    v_cvt_pk_bf16_f32 v215, v238, v239
    v_pk_mul_f32 v[80:81], v[80:81], s[92:93]
    v_pk_mul_f32 v[82:83], v[82:83], s[92:93]
    v_pk_mul_f32 v[84:85], v[84:85], s[92:93]
    v_pk_mul_f32 v[86:87], v[86:87], s[92:93]
    v_cvt_pk_bf16_f32 v80, v80, v81
    v_cvt_pk_bf16_f32 v81, v82, v83
    v_cvt_pk_bf16_f32 v82, v84, v85
    v_cvt_pk_bf16_f32 v83, v86, v87
    buffer_store_dwordx4 v[80:83], v2, s[8:11], s90 offen sc1
    s_add_u32 s90, s90, s100
    v_accvgpr_write_b32 a48, 0
    v_accvgpr_write_b32 a49, 0
    v_accvgpr_write_b32 a50, 0
    v_accvgpr_write_b32 a51, 0
    v_accvgpr_write_b32 a52, 0
    v_accvgpr_write_b32 a53, 0
    v_accvgpr_write_b32 a54, 0
    v_accvgpr_write_b32 a55, 0
    v_pk_mul_f32 v[240:241], v[240:241], s[92:93]
    v_pk_mul_f32 v[242:243], v[242:243], s[92:93]
    v_pk_mul_f32 v[244:245], v[244:245], s[92:93]
    v_pk_mul_f32 v[246:247], v[246:247], s[92:93]
    v_cvt_pk_bf16_f32 v216, v240, v241
    v_cvt_pk_bf16_f32 v217, v242, v243
    v_cvt_pk_bf16_f32 v218, v244, v245
    v_cvt_pk_bf16_f32 v219, v246, v247
    v_pk_mul_f32 v[88:89], v[88:89], s[92:93]
    v_pk_mul_f32 v[90:91], v[90:91], s[92:93]
    v_pk_mul_f32 v[92:93], v[92:93], s[92:93]
    v_pk_mul_f32 v[94:95], v[94:95], s[92:93]
    v_cvt_pk_bf16_f32 v88, v88, v89
    v_cvt_pk_bf16_f32 v89, v90, v91
    v_cvt_pk_bf16_f32 v90, v92, v93
    v_cvt_pk_bf16_f32 v91, v94, v95
    buffer_store_dwordx4 v[88:91], v2, s[8:11], s90 offen sc1
    s_add_u32 s90, s98, s99
    v_accvgpr_write_b32 a56, 0
    v_accvgpr_write_b32 a57, 0
    v_accvgpr_write_b32 a58, 0
    v_accvgpr_write_b32 a59, 0
    v_accvgpr_write_b32 a60, 0
    v_accvgpr_write_b32 a61, 0
    v_accvgpr_write_b32 a62, 0
    v_accvgpr_write_b32 a63, 0
    v_pk_mul_f32 v[248:249], v[248:249], s[92:93]
    v_pk_mul_f32 v[250:251], v[250:251], s[92:93]
    v_pk_mul_f32 v[252:253], v[252:253], s[92:93]
    v_pk_mul_f32 v[254:255], v[254:255], s[92:93]
    v_cvt_pk_bf16_f32 v220, v248, v249
    v_cvt_pk_bf16_f32 v221, v250, v251
    v_cvt_pk_bf16_f32 v222, v252, v253
    v_cvt_pk_bf16_f32 v223, v254, v255
    v_pk_mul_f32 v[96:97], v[96:97], s[92:93]
    v_pk_mul_f32 v[98:99], v[98:99], s[92:93]
    v_pk_mul_f32 v[100:101], v[100:101], s[92:93]
    v_pk_mul_f32 v[102:103], v[102:103], s[92:93]
    v_cvt_pk_bf16_f32 v96, v96, v97
    v_cvt_pk_bf16_f32 v97, v98, v99
    v_cvt_pk_bf16_f32 v98, v100, v101
    v_cvt_pk_bf16_f32 v99, v102, v103
    buffer_store_dwordx4 v[96:99], v2, s[8:11], s90 offen sc1
    s_add_u32 s90, s90, s100
    v_accvgpr_write_b32 a64, 0
    v_accvgpr_write_b32 a65, 0
    v_accvgpr_write_b32 a66, 0
    v_accvgpr_write_b32 a67, 0
    v_accvgpr_write_b32 a68, 0
    v_accvgpr_write_b32 a69, 0
    v_accvgpr_write_b32 a70, 0
    v_accvgpr_write_b32 a71, 0
    v_accvgpr_read_b32 v24, a224
    v_accvgpr_read_b32 v25, a225
    v_accvgpr_read_b32 v26, a226
    v_accvgpr_read_b32 v27, a227
    v_accvgpr_read_b32 v28, a228
    v_accvgpr_read_b32 v29, a229
    v_accvgpr_read_b32 v30, a230
    v_accvgpr_read_b32 v31, a231
    v_pk_mul_f32 v[24:25], v[24:25], s[92:93]
    v_pk_mul_f32 v[26:27], v[26:27], s[92:93]
    v_pk_mul_f32 v[28:29], v[28:29], s[92:93]
    v_pk_mul_f32 v[30:31], v[30:31], s[92:93]
    v_cvt_pk_bf16_f32 v224, v24, v25
    v_cvt_pk_bf16_f32 v225, v26, v27
    v_cvt_pk_bf16_f32 v226, v28, v29
    v_cvt_pk_bf16_f32 v227, v30, v31
    v_pk_mul_f32 v[104:105], v[104:105], s[92:93]
    v_pk_mul_f32 v[106:107], v[106:107], s[92:93]
    v_pk_mul_f32 v[108:109], v[108:109], s[92:93]
    v_pk_mul_f32 v[110:111], v[110:111], s[92:93]
    v_cvt_pk_bf16_f32 v104, v104, v105
    v_cvt_pk_bf16_f32 v105, v106, v107
    v_cvt_pk_bf16_f32 v106, v108, v109
    v_cvt_pk_bf16_f32 v107, v110, v111
    buffer_store_dwordx4 v[104:107], v2, s[8:11], s90 offen sc1
    s_add_u32 s90, s90, s100
    v_accvgpr_write_b32 a72, 0
    v_accvgpr_write_b32 a73, 0
    v_accvgpr_write_b32 a74, 0
    v_accvgpr_write_b32 a75, 0
    v_accvgpr_write_b32 a76, 0
    v_accvgpr_write_b32 a77, 0
    v_accvgpr_write_b32 a78, 0
    v_accvgpr_write_b32 a79, 0
    v_accvgpr_read_b32 v24, a232
    v_accvgpr_read_b32 v25, a233
    v_accvgpr_read_b32 v26, a234
    v_accvgpr_read_b32 v27, a235
    v_accvgpr_read_b32 v28, a236
    v_accvgpr_read_b32 v29, a237
    v_accvgpr_read_b32 v30, a238
    v_accvgpr_read_b32 v31, a239
    v_pk_mul_f32 v[24:25], v[24:25], s[92:93]
    v_pk_mul_f32 v[26:27], v[26:27], s[92:93]
    v_pk_mul_f32 v[28:29], v[28:29], s[92:93]
    v_pk_mul_f32 v[30:31], v[30:31], s[92:93]
    v_cvt_pk_bf16_f32 v228, v24, v25
    v_cvt_pk_bf16_f32 v229, v26, v27
    v_cvt_pk_bf16_f32 v230, v28, v29
    v_cvt_pk_bf16_f32 v231, v30, v31
    v_pk_mul_f32 v[112:113], v[112:113], s[92:93]
    v_pk_mul_f32 v[114:115], v[114:115], s[92:93]
    v_pk_mul_f32 v[116:117], v[116:117], s[92:93]
    v_pk_mul_f32 v[118:119], v[118:119], s[92:93]
    v_cvt_pk_bf16_f32 v112, v112, v113
    v_cvt_pk_bf16_f32 v113, v114, v115
    v_cvt_pk_bf16_f32 v114, v116, v117
    v_cvt_pk_bf16_f32 v115, v118, v119
    buffer_store_dwordx4 v[112:115], v2, s[8:11], s90 offen sc1
    s_add_u32 s90, s90, s100
    v_accvgpr_write_b32 a80, 0
    v_accvgpr_write_b32 a81, 0
    v_accvgpr_write_b32 a82, 0
    v_accvgpr_write_b32 a83, 0
    v_accvgpr_write_b32 a84, 0
    v_accvgpr_write_b32 a85, 0
    v_accvgpr_write_b32 a86, 0
    v_accvgpr_write_b32 a87, 0
    v_accvgpr_read_b32 v24, a240
    v_accvgpr_read_b32 v25, a241
    v_accvgpr_read_b32 v26, a242
    v_accvgpr_read_b32 v27, a243
    v_accvgpr_read_b32 v28, a244
    v_accvgpr_read_b32 v29, a245
    v_accvgpr_read_b32 v30, a246
    v_accvgpr_read_b32 v31, a247
    v_pk_mul_f32 v[24:25], v[24:25], s[92:93]
    v_pk_mul_f32 v[26:27], v[26:27], s[92:93]
    v_pk_mul_f32 v[28:29], v[28:29], s[92:93]
    v_pk_mul_f32 v[30:31], v[30:31], s[92:93]
    v_cvt_pk_bf16_f32 v232, v24, v25
    v_cvt_pk_bf16_f32 v233, v26, v27
    v_cvt_pk_bf16_f32 v234, v28, v29
    v_cvt_pk_bf16_f32 v235, v30, v31
    v_pk_mul_f32 v[120:121], v[120:121], s[92:93]
    v_pk_mul_f32 v[122:123], v[122:123], s[92:93]
    v_pk_mul_f32 v[124:125], v[124:125], s[92:93]
    v_pk_mul_f32 v[126:127], v[126:127], s[92:93]
    v_cvt_pk_bf16_f32 v120, v120, v121
    v_cvt_pk_bf16_f32 v121, v122, v123
    v_cvt_pk_bf16_f32 v122, v124, v125
    v_cvt_pk_bf16_f32 v123, v126, v127
    buffer_store_dwordx4 v[120:123], v2, s[8:11], s90 offen sc1
    s_add_u32 s90, s90, s100
    v_accvgpr_write_b32 a88, 0
    v_accvgpr_write_b32 a89, 0
    v_accvgpr_write_b32 a90, 0
    v_accvgpr_write_b32 a91, 0
    v_accvgpr_write_b32 a92, 0
    v_accvgpr_write_b32 a93, 0
    v_accvgpr_write_b32 a94, 0
    v_accvgpr_write_b32 a95, 0
    v_accvgpr_read_b32 v24, a248
    v_accvgpr_read_b32 v25, a249
    v_accvgpr_read_b32 v26, a250
    v_accvgpr_read_b32 v27, a251
    v_accvgpr_read_b32 v28, a252
    v_accvgpr_read_b32 v29, a253
    v_accvgpr_read_b32 v30, a254
    v_accvgpr_read_b32 v31, a255
    v_pk_mul_f32 v[24:25], v[24:25], s[92:93]
    v_pk_mul_f32 v[26:27], v[26:27], s[92:93]
    v_pk_mul_f32 v[28:29], v[28:29], s[92:93]
    v_pk_mul_f32 v[30:31], v[30:31], s[92:93]
    v_cvt_pk_bf16_f32 v236, v24, v25
    v_cvt_pk_bf16_f32 v237, v26, v27
    v_cvt_pk_bf16_f32 v238, v28, v29
    v_cvt_pk_bf16_f32 v239, v30, v31
    v_pk_mul_f32 v[128:129], v[128:129], s[92:93]
    v_pk_mul_f32 v[130:131], v[130:131], s[92:93]
    v_pk_mul_f32 v[132:133], v[132:133], s[92:93]
    v_pk_mul_f32 v[134:135], v[134:135], s[92:93]
    v_cvt_pk_bf16_f32 v128, v128, v129
    v_cvt_pk_bf16_f32 v129, v130, v131
    v_cvt_pk_bf16_f32 v130, v132, v133
    v_cvt_pk_bf16_f32 v131, v134, v135
    buffer_store_dwordx4 v[128:131], v2, s[8:11], s90 offen sc1
    s_add_u32 s90, s90, s100
    v_accvgpr_write_b32 a96, 0
    v_accvgpr_write_b32 a97, 0
    v_accvgpr_write_b32 a98, 0
    v_accvgpr_write_b32 a99, 0
    v_accvgpr_write_b32 a100, 0
    v_accvgpr_write_b32 a101, 0
    v_accvgpr_write_b32 a102, 0
    v_accvgpr_write_b32 a103, 0
    v_pk_mul_f32 v[160:161], v[160:161], s[92:93]
    v_pk_mul_f32 v[162:163], v[162:163], s[92:93]
    v_pk_mul_f32 v[164:165], v[164:165], s[92:93]
    v_pk_mul_f32 v[166:167], v[166:167], s[92:93]
    v_cvt_pk_bf16_f32 v240, v160, v161
    v_cvt_pk_bf16_f32 v241, v162, v163
    v_cvt_pk_bf16_f32 v242, v164, v165
    v_cvt_pk_bf16_f32 v243, v166, v167
    v_pk_mul_f32 v[136:137], v[136:137], s[92:93]
    v_pk_mul_f32 v[138:139], v[138:139], s[92:93]
    v_pk_mul_f32 v[140:141], v[140:141], s[92:93]
    v_pk_mul_f32 v[142:143], v[142:143], s[92:93]
    v_cvt_pk_bf16_f32 v136, v136, v137
    v_cvt_pk_bf16_f32 v137, v138, v139
    v_cvt_pk_bf16_f32 v138, v140, v141
    v_cvt_pk_bf16_f32 v139, v142, v143
    buffer_store_dwordx4 v[136:139], v2, s[8:11], s90 offen sc1
    s_add_u32 s90, s90, s100
    v_accvgpr_write_b32 a104, 0
    v_accvgpr_write_b32 a105, 0
    v_accvgpr_write_b32 a106, 0
    v_accvgpr_write_b32 a107, 0
    v_accvgpr_write_b32 a108, 0
    v_accvgpr_write_b32 a109, 0
    v_accvgpr_write_b32 a110, 0
    v_accvgpr_write_b32 a111, 0
    v_pk_mul_f32 v[168:169], v[168:169], s[92:93]
    v_pk_mul_f32 v[170:171], v[170:171], s[92:93]
    v_pk_mul_f32 v[172:173], v[172:173], s[92:93]
    v_pk_mul_f32 v[174:175], v[174:175], s[92:93]
    v_cvt_pk_bf16_f32 v244, v168, v169
    v_cvt_pk_bf16_f32 v245, v170, v171
    v_cvt_pk_bf16_f32 v246, v172, v173
    v_cvt_pk_bf16_f32 v247, v174, v175
    v_pk_mul_f32 v[144:145], v[144:145], s[92:93]
    v_pk_mul_f32 v[146:147], v[146:147], s[92:93]
    v_pk_mul_f32 v[148:149], v[148:149], s[92:93]
    v_pk_mul_f32 v[150:151], v[150:151], s[92:93]
    v_cvt_pk_bf16_f32 v144, v144, v145
    v_cvt_pk_bf16_f32 v145, v146, v147
    v_cvt_pk_bf16_f32 v146, v148, v149
    v_cvt_pk_bf16_f32 v147, v150, v151
    buffer_store_dwordx4 v[144:147], v2, s[8:11], s90 offen sc1
    s_add_u32 s90, s90, s100
    v_accvgpr_write_b32 a112, 0
    v_accvgpr_write_b32 a113, 0
    v_accvgpr_write_b32 a114, 0
    v_accvgpr_write_b32 a115, 0
    v_accvgpr_write_b32 a116, 0
    v_accvgpr_write_b32 a117, 0
    v_accvgpr_write_b32 a118, 0
    v_accvgpr_write_b32 a119, 0
    v_pk_mul_f32 v[176:177], v[176:177], s[92:93]
    v_pk_mul_f32 v[178:179], v[178:179], s[92:93]
    v_pk_mul_f32 v[180:181], v[180:181], s[92:93]
    v_pk_mul_f32 v[182:183], v[182:183], s[92:93]
    v_cvt_pk_bf16_f32 v248, v176, v177
    v_cvt_pk_bf16_f32 v249, v178, v179
    v_cvt_pk_bf16_f32 v250, v180, v181
    v_cvt_pk_bf16_f32 v251, v182, v183
    v_pk_mul_f32 v[152:153], v[152:153], s[92:93]
    v_pk_mul_f32 v[154:155], v[154:155], s[92:93]
    v_pk_mul_f32 v[156:157], v[156:157], s[92:93]
    v_pk_mul_f32 v[158:159], v[158:159], s[92:93]
    v_cvt_pk_bf16_f32 v152, v152, v153
    v_cvt_pk_bf16_f32 v153, v154, v155
    v_cvt_pk_bf16_f32 v154, v156, v157
    v_cvt_pk_bf16_f32 v155, v158, v159
    buffer_store_dwordx4 v[152:155], v2, s[8:11], s90 offen sc1
    s_add_u32 s90, s90, s100
    v_accvgpr_write_b32 a120, 0
    v_accvgpr_write_b32 a121, 0
    v_accvgpr_write_b32 a122, 0
    v_accvgpr_write_b32 a123, 0
    v_accvgpr_write_b32 a124, 0
    v_accvgpr_write_b32 a125, 0
    v_accvgpr_write_b32 a126, 0
    v_accvgpr_write_b32 a127, 0
    v_pk_mul_f32 v[184:185], v[184:185], s[92:93]
    v_pk_mul_f32 v[186:187], v[186:187], s[92:93]
    v_pk_mul_f32 v[188:189], v[188:189], s[92:93]
    v_pk_mul_f32 v[190:191], v[190:191], s[92:93]
    v_cvt_pk_bf16_f32 v252, v184, v185
    v_cvt_pk_bf16_f32 v253, v186, v187
    v_cvt_pk_bf16_f32 v254, v188, v189
    v_cvt_pk_bf16_f32 v255, v190, v191
    s_branch m_epl85_r
m_ns286:
    s_mov_b32 s90, s98
    v_cvt_pk_bf16_f32 v32, v32, v33
    v_cvt_pk_bf16_f32 v33, v34, v35
    v_cvt_pk_bf16_f32 v34, v36, v37
    v_cvt_pk_bf16_f32 v35, v38, v39
    buffer_store_dwordx4 v[32:35], v2, s[8:11], s90 offen sc1
    s_add_u32 s90, s90, s100
    v_accvgpr_write_b32 a0, 0
    v_accvgpr_write_b32 a1, 0
    v_accvgpr_write_b32 a2, 0
    v_accvgpr_write_b32 a3, 0
    v_accvgpr_write_b32 a4, 0
    v_accvgpr_write_b32 a5, 0
    v_accvgpr_write_b32 a6, 0
    v_accvgpr_write_b32 a7, 0
    v_cvt_pk_bf16_f32 v192, v192, v193
    v_cvt_pk_bf16_f32 v193, v194, v195
    v_cvt_pk_bf16_f32 v194, v196, v197
    v_cvt_pk_bf16_f32 v195, v198, v199
    v_cvt_pk_bf16_f32 v40, v40, v41
    v_cvt_pk_bf16_f32 v41, v42, v43
    v_cvt_pk_bf16_f32 v42, v44, v45
    v_cvt_pk_bf16_f32 v43, v46, v47
    buffer_store_dwordx4 v[40:43], v2, s[8:11], s90 offen sc1
    s_add_u32 s90, s90, s100
    v_accvgpr_write_b32 a8, 0
    v_accvgpr_write_b32 a9, 0
    v_accvgpr_write_b32 a10, 0
    v_accvgpr_write_b32 a11, 0
    v_accvgpr_write_b32 a12, 0
    v_accvgpr_write_b32 a13, 0
    v_accvgpr_write_b32 a14, 0
    v_accvgpr_write_b32 a15, 0
    v_cvt_pk_bf16_f32 v196, v200, v201
    v_cvt_pk_bf16_f32 v197, v202, v203
    v_cvt_pk_bf16_f32 v198, v204, v205
    v_cvt_pk_bf16_f32 v199, v206, v207
    v_cvt_pk_bf16_f32 v48, v48, v49
    v_cvt_pk_bf16_f32 v49, v50, v51
    v_cvt_pk_bf16_f32 v50, v52, v53
    v_cvt_pk_bf16_f32 v51, v54, v55
    buffer_store_dwordx4 v[48:51], v2, s[8:11], s90 offen sc1
    s_add_u32 s90, s90, s100
    v_accvgpr_write_b32 a16, 0
    v_accvgpr_write_b32 a17, 0
    v_accvgpr_write_b32 a18, 0
    v_accvgpr_write_b32 a19, 0
    v_accvgpr_write_b32 a20, 0
    v_accvgpr_write_b32 a21, 0
    v_accvgpr_write_b32 a22, 0
    v_accvgpr_write_b32 a23, 0
    v_cvt_pk_bf16_f32 v200, v208, v209
    v_cvt_pk_bf16_f32 v201, v210, v211
    v_cvt_pk_bf16_f32 v202, v212, v213
    v_cvt_pk_bf16_f32 v203, v214, v215
    v_cvt_pk_bf16_f32 v56, v56, v57
    v_cvt_pk_bf16_f32 v57, v58, v59
    v_cvt_pk_bf16_f32 v58, v60, v61
    v_cvt_pk_bf16_f32 v59, v62, v63
    buffer_store_dwordx4 v[56:59], v2, s[8:11], s90 offen sc1
    s_add_u32 s90, s90, s100
    v_accvgpr_write_b32 a24, 0
    v_accvgpr_write_b32 a25, 0
    v_accvgpr_write_b32 a26, 0
    v_accvgpr_write_b32 a27, 0
    v_accvgpr_write_b32 a28, 0
    v_accvgpr_write_b32 a29, 0
    v_accvgpr_write_b32 a30, 0
    v_accvgpr_write_b32 a31, 0
    v_cvt_pk_bf16_f32 v204, v216, v217
    v_cvt_pk_bf16_f32 v205, v218, v219
    v_cvt_pk_bf16_f32 v206, v220, v221
    v_cvt_pk_bf16_f32 v207, v222, v223
    v_cvt_pk_bf16_f32 v64, v64, v65
    v_cvt_pk_bf16_f32 v65, v66, v67
    v_cvt_pk_bf16_f32 v66, v68, v69
    v_cvt_pk_bf16_f32 v67, v70, v71
    buffer_store_dwordx4 v[64:67], v2, s[8:11], s90 offen sc1
    s_add_u32 s90, s90, s100
    v_accvgpr_write_b32 a32, 0
    v_accvgpr_write_b32 a33, 0
    v_accvgpr_write_b32 a34, 0
    v_accvgpr_write_b32 a35, 0
    v_accvgpr_write_b32 a36, 0
    v_accvgpr_write_b32 a37, 0
    v_accvgpr_write_b32 a38, 0
    v_accvgpr_write_b32 a39, 0
    v_cvt_pk_bf16_f32 v208, v224, v225
    v_cvt_pk_bf16_f32 v209, v226, v227
    v_cvt_pk_bf16_f32 v210, v228, v229
    v_cvt_pk_bf16_f32 v211, v230, v231
    v_cvt_pk_bf16_f32 v72, v72, v73
    v_cvt_pk_bf16_f32 v73, v74, v75
    v_cvt_pk_bf16_f32 v74, v76, v77
    v_cvt_pk_bf16_f32 v75, v78, v79
    buffer_store_dwordx4 v[72:75], v2, s[8:11], s90 offen sc1
    s_add_u32 s90, s90, s100
    v_accvgpr_write_b32 a40, 0
    v_accvgpr_write_b32 a41, 0
    v_accvgpr_write_b32 a42, 0
    v_accvgpr_write_b32 a43, 0
    v_accvgpr_write_b32 a44, 0
    v_accvgpr_write_b32 a45, 0
    v_accvgpr_write_b32 a46, 0
    v_accvgpr_write_b32 a47, 0
    v_cvt_pk_bf16_f32 v212, v232, v233
    v_cvt_pk_bf16_f32 v213, v234, v235
    v_cvt_pk_bf16_f32 v214, v236, v237
    v_cvt_pk_bf16_f32 v215, v238, v239
    v_cvt_pk_bf16_f32 v80, v80, v81
    v_cvt_pk_bf16_f32 v81, v82, v83
    v_cvt_pk_bf16_f32 v82, v84, v85
    v_cvt_pk_bf16_f32 v83, v86, v87
    buffer_store_dwordx4 v[80:83], v2, s[8:11], s90 offen sc1
    s_add_u32 s90, s90, s100
    v_accvgpr_write_b32 a48, 0
    v_accvgpr_write_b32 a49, 0
    v_accvgpr_write_b32 a50, 0
    v_accvgpr_write_b32 a51, 0
    v_accvgpr_write_b32 a52, 0
    v_accvgpr_write_b32 a53, 0
    v_accvgpr_write_b32 a54, 0
    v_accvgpr_write_b32 a55, 0
    v_cvt_pk_bf16_f32 v216, v240, v241
    v_cvt_pk_bf16_f32 v217, v242, v243
    v_cvt_pk_bf16_f32 v218, v244, v245
    v_cvt_pk_bf16_f32 v219, v246, v247
    v_cvt_pk_bf16_f32 v88, v88, v89
    v_cvt_pk_bf16_f32 v89, v90, v91
    v_cvt_pk_bf16_f32 v90, v92, v93
    v_cvt_pk_bf16_f32 v91, v94, v95
    buffer_store_dwordx4 v[88:91], v2, s[8:11], s90 offen sc1
    s_add_u32 s90, s98, s99
    v_accvgpr_write_b32 a56, 0
    v_accvgpr_write_b32 a57, 0
    v_accvgpr_write_b32 a58, 0
    v_accvgpr_write_b32 a59, 0
    v_accvgpr_write_b32 a60, 0
    v_accvgpr_write_b32 a61, 0
    v_accvgpr_write_b32 a62, 0
    v_accvgpr_write_b32 a63, 0
    v_cvt_pk_bf16_f32 v220, v248, v249
    v_cvt_pk_bf16_f32 v221, v250, v251
    v_cvt_pk_bf16_f32 v222, v252, v253
    v_cvt_pk_bf16_f32 v223, v254, v255
    v_cvt_pk_bf16_f32 v96, v96, v97
    v_cvt_pk_bf16_f32 v97, v98, v99
    v_cvt_pk_bf16_f32 v98, v100, v101
    v_cvt_pk_bf16_f32 v99, v102, v103
    buffer_store_dwordx4 v[96:99], v2, s[8:11], s90 offen sc1
    s_add_u32 s90, s90, s100
    v_accvgpr_write_b32 a64, 0
    v_accvgpr_write_b32 a65, 0
    v_accvgpr_write_b32 a66, 0
    v_accvgpr_write_b32 a67, 0
    v_accvgpr_write_b32 a68, 0
    v_accvgpr_write_b32 a69, 0
    v_accvgpr_write_b32 a70, 0
    v_accvgpr_write_b32 a71, 0
    v_accvgpr_read_b32 v24, a224
    v_accvgpr_read_b32 v25, a225
    v_accvgpr_read_b32 v26, a226
    v_accvgpr_read_b32 v27, a227
    v_accvgpr_read_b32 v28, a228
    v_accvgpr_read_b32 v29, a229
    v_accvgpr_read_b32 v30, a230
    v_accvgpr_read_b32 v31, a231
    v_cvt_pk_bf16_f32 v224, v24, v25
    v_cvt_pk_bf16_f32 v225, v26, v27
    v_cvt_pk_bf16_f32 v226, v28, v29
    v_cvt_pk_bf16_f32 v227, v30, v31
    v_cvt_pk_bf16_f32 v104, v104, v105
    v_cvt_pk_bf16_f32 v105, v106, v107
    v_cvt_pk_bf16_f32 v106, v108, v109
    v_cvt_pk_bf16_f32 v107, v110, v111
    buffer_store_dwordx4 v[104:107], v2, s[8:11], s90 offen sc1
    s_add_u32 s90, s90, s100
    v_accvgpr_write_b32 a72, 0
    v_accvgpr_write_b32 a73, 0
    v_accvgpr_write_b32 a74, 0
    v_accvgpr_write_b32 a75, 0
    v_accvgpr_write_b32 a76, 0
    v_accvgpr_write_b32 a77, 0
    v_accvgpr_write_b32 a78, 0
    v_accvgpr_write_b32 a79, 0
    v_accvgpr_read_b32 v24, a232
    v_accvgpr_read_b32 v25, a233
    v_accvgpr_read_b32 v26, a234
    v_accvgpr_read_b32 v27, a235
    v_accvgpr_read_b32 v28, a236
    v_accvgpr_read_b32 v29, a237
    v_accvgpr_read_b32 v30, a238
    v_accvgpr_read_b32 v31, a239
    v_cvt_pk_bf16_f32 v228, v24, v25
    v_cvt_pk_bf16_f32 v229, v26, v27
    v_cvt_pk_bf16_f32 v230, v28, v29
    v_cvt_pk_bf16_f32 v231, v30, v31
    v_cvt_pk_bf16_f32 v112, v112, v113
    v_cvt_pk_bf16_f32 v113, v114, v115
    v_cvt_pk_bf16_f32 v114, v116, v117
    v_cvt_pk_bf16_f32 v115, v118, v119
    buffer_store_dwordx4 v[112:115], v2, s[8:11], s90 offen sc1
    s_add_u32 s90, s90, s100
    v_accvgpr_write_b32 a80, 0
    v_accvgpr_write_b32 a81, 0
    v_accvgpr_write_b32 a82, 0
    v_accvgpr_write_b32 a83, 0
    v_accvgpr_write_b32 a84, 0
    v_accvgpr_write_b32 a85, 0
    v_accvgpr_write_b32 a86, 0
    v_accvgpr_write_b32 a87, 0
    v_accvgpr_read_b32 v24, a240
    v_accvgpr_read_b32 v25, a241
    v_accvgpr_read_b32 v26, a242
    v_accvgpr_read_b32 v27, a243
    v_accvgpr_read_b32 v28, a244
    v_accvgpr_read_b32 v29, a245
    v_accvgpr_read_b32 v30, a246
    v_accvgpr_read_b32 v31, a247
    v_cvt_pk_bf16_f32 v232, v24, v25
    v_cvt_pk_bf16_f32 v233, v26, v27
    v_cvt_pk_bf16_f32 v234, v28, v29
    v_cvt_pk_bf16_f32 v235, v30, v31
    v_cvt_pk_bf16_f32 v120, v120, v121
    v_cvt_pk_bf16_f32 v121, v122, v123
    v_cvt_pk_bf16_f32 v122, v124, v125
    v_cvt_pk_bf16_f32 v123, v126, v127
    buffer_store_dwordx4 v[120:123], v2, s[8:11], s90 offen sc1
    s_add_u32 s90, s90, s100
    v_accvgpr_write_b32 a88, 0
    v_accvgpr_write_b32 a89, 0
    v_accvgpr_write_b32 a90, 0
    v_accvgpr_write_b32 a91, 0
    v_accvgpr_write_b32 a92, 0
    v_accvgpr_write_b32 a93, 0
    v_accvgpr_write_b32 a94, 0
    v_accvgpr_write_b32 a95, 0
    v_accvgpr_read_b32 v24, a248
    v_accvgpr_read_b32 v25, a249
    v_accvgpr_read_b32 v26, a250
    v_accvgpr_read_b32 v27, a251
    v_accvgpr_read_b32 v28, a252
    v_accvgpr_read_b32 v29, a253
    v_accvgpr_read_b32 v30, a254
    v_accvgpr_read_b32 v31, a255
    v_cvt_pk_bf16_f32 v236, v24, v25
    v_cvt_pk_bf16_f32 v237, v26, v27
    v_cvt_pk_bf16_f32 v238, v28, v29
    v_cvt_pk_bf16_f32 v239, v30, v31
    v_cvt_pk_bf16_f32 v128, v128, v129
    v_cvt_pk_bf16_f32 v129, v130, v131
    v_cvt_pk_bf16_f32 v130, v132, v133
    v_cvt_pk_bf16_f32 v131, v134, v135
    buffer_store_dwordx4 v[128:131], v2, s[8:11], s90 offen sc1
    s_add_u32 s90, s90, s100
    v_accvgpr_write_b32 a96, 0
    v_accvgpr_write_b32 a97, 0
    v_accvgpr_write_b32 a98, 0
    v_accvgpr_write_b32 a99, 0
    v_accvgpr_write_b32 a100, 0
    v_accvgpr_write_b32 a101, 0
    v_accvgpr_write_b32 a102, 0
    v_accvgpr_write_b32 a103, 0
    v_cvt_pk_bf16_f32 v240, v160, v161
    v_cvt_pk_bf16_f32 v241, v162, v163
    v_cvt_pk_bf16_f32 v242, v164, v165
    v_cvt_pk_bf16_f32 v243, v166, v167
    v_cvt_pk_bf16_f32 v136, v136, v137
    v_cvt_pk_bf16_f32 v137, v138, v139
    v_cvt_pk_bf16_f32 v138, v140, v141
    v_cvt_pk_bf16_f32 v139, v142, v143
    buffer_store_dwordx4 v[136:139], v2, s[8:11], s90 offen sc1
    s_add_u32 s90, s90, s100
    v_accvgpr_write_b32 a104, 0
    v_accvgpr_write_b32 a105, 0
    v_accvgpr_write_b32 a106, 0
    v_accvgpr_write_b32 a107, 0
    v_accvgpr_write_b32 a108, 0
    v_accvgpr_write_b32 a109, 0
    v_accvgpr_write_b32 a110, 0
    v_accvgpr_write_b32 a111, 0
    v_cvt_pk_bf16_f32 v244, v168, v169
    v_cvt_pk_bf16_f32 v245, v170, v171
    v_cvt_pk_bf16_f32 v246, v172, v173
    v_cvt_pk_bf16_f32 v247, v174, v175
    v_cvt_pk_bf16_f32 v144, v144, v145
    v_cvt_pk_bf16_f32 v145, v146, v147
    v_cvt_pk_bf16_f32 v146, v148, v149
    v_cvt_pk_bf16_f32 v147, v150, v151
    buffer_store_dwordx4 v[144:147], v2, s[8:11], s90 offen sc1
    s_add_u32 s90, s90, s100
    v_accvgpr_write_b32 a112, 0
    v_accvgpr_write_b32 a113, 0
    v_accvgpr_write_b32 a114, 0
    v_accvgpr_write_b32 a115, 0
    v_accvgpr_write_b32 a116, 0
    v_accvgpr_write_b32 a117, 0
    v_accvgpr_write_b32 a118, 0
    v_accvgpr_write_b32 a119, 0
    v_cvt_pk_bf16_f32 v248, v176, v177
    v_cvt_pk_bf16_f32 v249, v178, v179
    v_cvt_pk_bf16_f32 v250, v180, v181
    v_cvt_pk_bf16_f32 v251, v182, v183
    v_cvt_pk_bf16_f32 v152, v152, v153
    v_cvt_pk_bf16_f32 v153, v154, v155
    v_cvt_pk_bf16_f32 v154, v156, v157
    v_cvt_pk_bf16_f32 v155, v158, v159
    buffer_store_dwordx4 v[152:155], v2, s[8:11], s90 offen sc1
    s_add_u32 s90, s90, s100
    v_accvgpr_write_b32 a120, 0
    v_accvgpr_write_b32 a121, 0
    v_accvgpr_write_b32 a122, 0
    v_accvgpr_write_b32 a123, 0
    v_accvgpr_write_b32 a124, 0
    v_accvgpr_write_b32 a125, 0
    v_accvgpr_write_b32 a126, 0
    v_accvgpr_write_b32 a127, 0
    v_cvt_pk_bf16_f32 v252, v184, v185
    v_cvt_pk_bf16_f32 v253, v186, v187
    v_cvt_pk_bf16_f32 v254, v188, v189
    v_cvt_pk_bf16_f32 v255, v190, v191
m_epl85_r:
    s_mov_b32 s17, s101
    s_mov_b32 s38, 268435456
m_init31:
    s_mov_b32 s56, 81920
    s_mov_b32 s57, 65536
    s_nop 1
    v_mov_b32 v9, 0xff800000
    s_mov_b32 s65, 1233125376
    s_lshl_b32 s91, s16, 1
    s_sub_u32 s91, s91, 8
    s_lshl_b32 s78, s33, 3
    s_add_u32 s78, s78, s91
    s_lshl_b32 s79, s34, 3
    s_add_u32 s79, s79, s91
    s_mov_b32 s36, s6
    s_mov_b32 s37, s7
    s_mov_b32 s39, 0x20000
    s_lshl_b32 s90, s99, 1
    s_add_u32 s98, s98, s90
    s_lshl_b32 s90, s100, 2
    s_add_u32 s40, s98, s90
    s_lshr_b32 s90, s32, 1
    s_lshl_b32 s90, s90, 7
    s_add_u32 s90, s90, 117444608
    s_lshr_b32 s91, s2, 6
    s_lshl_b32 s91, s91, 8
    s_add_u32 s91, s91, 117446592
    v_min_u32 v10, 31, v1
    v_lshlrev_b32 v10, 3, v10
    v_mov_b32 v11, s90
    v_mov_b32 v8, s91
    v_cmp_gt_u32 vcc, 8, v1
    s_nop 1
    v_cndmask_b32 v11, v8, v11, vcc
    v_add_u32 v10, v10, v11
    s_mov_b32 s58, 0
    v_mov_b32 v6, v2
    v_mov_b64 v[160:161], 0
    v_mov_b64 v[162:163], 0
    v_mov_b64 v[164:165], 0
    v_mov_b64 v[166:167], 0
    v_mov_b64 v[168:169], 0
    v_mov_b64 v[170:171], 0
    v_mov_b64 v[172:173], 0
    v_mov_b64 v[174:175], 0
    v_mov_b64 v[176:177], 0
    v_mov_b64 v[178:179], 0
    v_mov_b64 v[180:181], 0
    v_mov_b64 v[182:183], 0
    v_mov_b64 v[184:185], 0
    v_mov_b64 v[186:187], 0
    v_mov_b64 v[188:189], 0
    v_mov_b64 v[190:191], 0
    v_mov_b32 v12, 0
    v_mov_b32 v28, 0
    v_mov_b32 v44, 0x3f803f80
    v_mov_b32 v13, 0
    v_mov_b32 v32, 0
    v_mov_b32 v45, 0x3f803f80
    v_mov_b32 v14, 0
    v_mov_b32 v36, 0
    v_mov_b32 v46, 0x3f803f80
    v_mov_b32 v15, 0
    v_mov_b32 v40, 0
    v_mov_b32 v47, 0x3f803f80
    s_and_b32 s90, s2, 7
    s_lshl_b32 s90, s90, 4
    s_lshl_b32 s91, s16, 2
    s_add_u32 s80, s90, s91
    s_lshr_b32 s92, s2, 3
    s_lshl_b32 s92, s92, 17
    s_lshl_b32 s90, s80, 10
    s_add_u32 s90, s90, s92
    s_add_u32 s83, s90, 50331648
    s_add_u32 s84, s90, 54525952
    s_and_b32 s81, s80, 63
    s_cmp_eq_u32 s81, 0
    s_cselect_b32 s93, 0, 1024
    s_sub_u32 s85, s84, s93
    s_lshl_b32 s90, s80, 9
    s_add_u32 s90, s90, s92
    s_add_u32 s86, s90, 58720256
    s_sub_u32 s87, s86, s93
    s_add_u32 s88, s86, 65536
    s_add_u32 s89, s87, 65536
    v_and_b32 v48, 15, v1
    v_lshrrev_b32 v49, 4, v1
    v_lshlrev_b32 v49, 2, v49
    v_sub_u32 v48, v48, v49
    v_cmp_le_i32 vcc, 0, v48
    s_nop 1
    v_cndmask_b32 v16, v9, 0, vcc
    v_cmp_le_i32 vcc, 1, v48
    s_nop 1
    v_cndmask_b32 v17, v9, 0, vcc
    v_cmp_le_i32 vcc, 2, v48
    s_nop 1
    v_cndmask_b32 v18, v9, 0, vcc
    v_cmp_le_i32 vcc, 3, v48
    s_nop 1
    v_cndmask_b32 v19, v9, 0, vcc
    s_mov_b32 s62, 8945792
    s_mov_b32 s63, 0
    s_sub_u32 s90, s67, 1
    s_bitset1_b64 s[62:63], s90
    s_sub_u32 s90, s68, 1
    s_bitset1_b64 s[62:63], s90
    s_sub_u32 s90, s69, 1
    s_bitset1_b64 s[62:63], s90
    s_sub_u32 s90, s70, 1
    s_bitset1_b64 s[62:63], s90
    s_sub_u32 s90, s71, 1
    s_bitset1_b64 s[62:63], s90
    s_sub_u32 s90, s72, 1
    s_bitset1_b64 s[62:63], s90
    s_add_u32 s53, s69, 8
    s_sub_u32 s90, s53, 1
    s_bitset1_b64 s[62:63], s90
    s_mov_b32 s64, 0
    s_cmp_lg_u32 s64, s67
    s_cbranch_scc1 m_e91
    v_add_f32 v176, v176, v16
    v_mov_b32 v180, v9
    v_add_f32 v188, v188, v16
    v_add_f32 v177, v177, v17
    v_mov_b32 v181, v9
    v_add_f32 v189, v189, v17
    v_add_f32 v178, v178, v18
    v_mov_b32 v182, v9
    v_add_f32 v190, v190, v18
    v_add_f32 v179, v179, v19
    v_mov_b32 v183, v9
    v_add_f32 v191, v191, v19
    s_nop 0
m_e91:
    s_waitcnt vmcnt(32) lgkmcnt(0)
    s_barrier
    ds_read_b128 a[192:195], v6 offset:0
    ds_read_b128 a[196:199], v6 offset:1024
    ds_read_b128 a[200:203], v6 offset:2048
    ds_read_b128 a[204:207], v6 offset:3072
    ds_read_b128 a[208:211], v6 offset:4096
    ds_read_b128 a[212:215], v6 offset:5120
    ds_read_b128 a[216:219], v6 offset:6144
    ds_read_b128 a[220:223], v6 offset:7168
    s_waitcnt lgkmcnt(0)
    v_mfma_f32_16x16x32_bf16 v[64:67], a[192:195], a[128:131], v[160:163]
    v_mfma_f32_16x16x32_bf16 v[64:67], a[196:199], a[132:135], v[64:67]
    buffer_store_dwordx4 v[192:195], v2, s[36:39], s40 offen sc1
    s_add_u32 s40, s40, s100
    v_mfma_f32_16x16x32_bf16 v[64:67], a[200:203], a[136:139], v[64:67]
    v_mfma_f32_16x16x32_bf16 v[64:67], a[204:207], a[140:143], v[64:67]
    v_mfma_f32_16x16x32_bf16 v[72:75], a[204:207], a[156:159], v[168:171]
    v_mfma_f32_16x16x32_bf16 v[72:75], a[200:203], a[152:155], v[72:75]
    buffer_store_dwordx4 v[196:199], v2, s[36:39], s40 offen sc1
    s_add_u32 s40, s40, s100
    v_mfma_f32_16x16x32_bf16 v[72:75], a[196:199], a[148:151], v[72:75]
    v_mfma_f32_16x16x32_bf16 v[72:75], a[192:195], a[144:147], v[72:75]
    v_mfma_f32_16x16x32_bf16 v[80:83], a[192:195], a[160:163], v[176:179]
    v_mfma_f32_16x16x32_bf16 v[80:83], a[196:199], a[164:167], v[80:83]
    buffer_store_dwordx4 v[200:203], v2, s[36:39], s40 offen sc1
    s_add_u32 s40, s40, s100
    v_mfma_f32_16x16x32_bf16 v[80:83], a[200:203], a[168:171], v[80:83]
    v_mfma_f32_16x16x32_bf16 v[80:83], a[204:207], a[172:175], v[80:83]
    v_mfma_f32_16x16x32_bf16 v[88:91], a[204:207], a[188:191], v[184:187]
    v_mfma_f32_16x16x32_bf16 v[88:91], a[200:203], a[184:187], v[88:91]
    buffer_store_dwordx4 v[204:207], v2, s[36:39], s40 offen sc1
    s_add_u32 s40, s98, s99
    v_mfma_f32_16x16x32_bf16 v[88:91], a[196:199], a[180:183], v[88:91]
    v_mfma_f32_16x16x32_bf16 v[88:91], a[192:195], a[176:179], v[88:91]
    v_mfma_f32_16x16x32_bf16 v[92:95], a[208:211], a[176:179], v[188:191]
    ds_read_b128 a[192:195], v6 offset:8192
    v_mfma_f32_16x16x32_bf16 v[92:95], a[212:215], a[180:183], v[92:95]
    buffer_store_dwordx4 v[208:211], v2, s[36:39], s40 offen sc1
    s_add_u32 s40, s40, s100
    ds_read_b128 a[196:199], v6 offset:9216
    v_mfma_f32_16x16x32_bf16 v[92:95], a[216:219], a[184:187], v[92:95]
    ds_read_b128 a[200:203], v6 offset:10240
    v_mfma_f32_16x16x32_bf16 v[92:95], a[220:223], a[188:191], v[92:95]
    ds_read_b128 a[204:207], v6 offset:11264
    v_mfma_f32_16x16x32_bf16 v[84:87], a[220:223], a[172:175], v[180:183]
    v_mfma_f32_16x16x32_bf16 v[84:87], a[216:219], a[168:171], v[84:87]
    buffer_store_dwordx4 v[212:215], v2, s[36:39], s40 offen sc1
    s_add_u32 s40, s40, s100
    v_mfma_f32_16x16x32_bf16 v[84:87], a[212:215], a[164:167], v[84:87]
    v_mfma_f32_16x16x32_bf16 v[84:87], a[208:211], a[160:163], v[84:87]
    v_mfma_f32_16x16x32_bf16 v[76:79], a[208:211], a[144:147], v[172:175]
    v_mfma_f32_16x16x32_bf16 v[76:79], a[212:215], a[148:151], v[76:79]
    buffer_store_dwordx4 v[216:219], v2, s[36:39], s40 offen sc1
    s_add_u32 s40, s40, s100
    v_mfma_f32_16x16x32_bf16 v[76:79], a[216:219], a[152:155], v[76:79]
    v_mfma_f32_16x16x32_bf16 v[76:79], a[220:223], a[156:159], v[76:79]
    v_mfma_f32_16x16x32_bf16 v[68:71], a[220:223], a[140:143], v[164:167]
    v_mfma_f32_16x16x32_bf16 v[68:71], a[216:219], a[136:139], v[68:71]
    buffer_store_dwordx4 v[220:223], v2, s[36:39], s40 offen sc1
    s_add_u32 s40, s40, s100
    v_mfma_f32_16x16x32_bf16 v[68:71], a[212:215], a[132:135], v[68:71]
    v_mfma_f32_16x16x32_bf16 v[68:71], a[208:211], a[128:131], v[68:71]
    ds_read_b128 a[208:211], v6 offset:12288
    ds_read_b128 a[212:215], v6 offset:13312
    ds_read_b128 a[216:219], v6 offset:14336
    ds_read_b128 a[220:223], v6 offset:15360
    s_mov_b32 s64, 1
    s_nop 0
    s_nop 3
    v_max3_f32 v48, v64, v65, v66
    v_max3_f32 v49, v72, v73, v74
    v_max3_f32 v50, v80, v81, v82
    v_max3_f32 v51, v88, v89, v90
    v_max3_f32 v48, v48, v67, v68
    v_max3_f32 v49, v49, v75, v76
    v_max3_f32 v50, v50, v83, v84
    v_max3_f32 v51, v51, v91, v92
    v_max3_f32 v48, v48, v69, v70
    v_max3_f32 v49, v49, v77, v78
    v_max3_f32 v50, v50, v85, v86
    v_max3_f32 v51, v51, v93, v94
    v_max_f32 v48, v48, v71
    v_max_f32 v49, v49, v79
    v_max_f32 v50, v50, v87
    v_max_f32 v51, v51, v95
    v_mov_b32 v52, v48
    v_mov_b32 v53, v49
    v_mov_b32 v54, v50
    v_mov_b32 v55, v51
    s_nop 1
    v_permlane32_swap_b32 v48, v52
    v_permlane32_swap_b32 v49, v53
    v_permlane32_swap_b32 v50, v54
    v_permlane32_swap_b32 v51, v55
    s_nop 1
    v_max_f32 v48, v48, v52
    v_max_f32 v49, v49, v53
    v_max_f32 v50, v50, v54
    v_max_f32 v51, v51, v55
    v_mov_b32 v52, v48
    v_mov_b32 v53, v49
    v_mov_b32 v54, v50
    v_mov_b32 v55, v51
    s_nop 1
    v_permlane16_swap_b32 v48, v52
    v_permlane16_swap_b32 v49, v53
    v_permlane16_swap_b32 v50, v54
    v_permlane16_swap_b32 v51, v55
    s_nop 1
    v_max_f32 v48, v48, v52
    v_max_f32 v49, v49, v53
    v_max_f32 v50, v50, v54
    v_max_f32 v51, v51, v55
    v_sub_f32 v160, v160, v48
    v_sub_f32 v161, v161, v48
    v_sub_f32 v162, v162, v48
    v_sub_f32 v163, v163, v48
    v_sub_f32 v164, v164, v48
    v_sub_f32 v165, v165, v48
    v_sub_f32 v166, v166, v48
    v_sub_f32 v167, v167, v48
    v_sub_f32 v168, v168, v49
    v_sub_f32 v169, v169, v49
    v_sub_f32 v170, v170, v49
    v_sub_f32 v171, v171, v49
    v_sub_f32 v172, v172, v49
    v_sub_f32 v173, v173, v49
    v_sub_f32 v174, v174, v49
    v_sub_f32 v175, v175, v49
    v_sub_f32 v176, v176, v50
    v_sub_f32 v177, v177, v50
    v_sub_f32 v178, v178, v50
    v_sub_f32 v179, v179, v50
    v_sub_f32 v180, v180, v50
    v_sub_f32 v181, v181, v50
    v_sub_f32 v182, v182, v50
    v_sub_f32 v183, v183, v50
    v_sub_f32 v184, v184, v51
    v_sub_f32 v185, v185, v51
    v_sub_f32 v186, v186, v51
    v_sub_f32 v187, v187, v51
    v_sub_f32 v188, v188, v51
    v_sub_f32 v189, v189, v51
    v_sub_f32 v190, v190, v51
    v_sub_f32 v191, v191, v51
    v_sub_f32 v64, v64, v48
    v_sub_f32 v65, v65, v48
    v_sub_f32 v66, v66, v48
    v_sub_f32 v67, v67, v48
    v_sub_f32 v68, v68, v48
    v_sub_f32 v69, v69, v48
    v_sub_f32 v70, v70, v48
    v_sub_f32 v71, v71, v48
    v_sub_f32 v72, v72, v49
    v_sub_f32 v73, v73, v49
    v_sub_f32 v74, v74, v49
    v_sub_f32 v75, v75, v49
    v_sub_f32 v76, v76, v49
    v_sub_f32 v77, v77, v49
    v_sub_f32 v78, v78, v49
    v_sub_f32 v79, v79, v49
    v_sub_f32 v80, v80, v50
    v_sub_f32 v81, v81, v50
    v_sub_f32 v82, v82, v50
    v_sub_f32 v83, v83, v50
    v_sub_f32 v84, v84, v50
    v_sub_f32 v85, v85, v50
    v_sub_f32 v86, v86, v50
    v_sub_f32 v87, v87, v50
    v_sub_f32 v88, v88, v51
    v_sub_f32 v89, v89, v51
    v_sub_f32 v90, v90, v51
    v_sub_f32 v91, v91, v51
    v_sub_f32 v92, v92, v51
    v_sub_f32 v93, v93, v51
    v_sub_f32 v94, v94, v51
    v_sub_f32 v95, v95, v51
    s_cmp_lg_u32 s64, s67
    s_cbranch_scc1 m_e92
    v_add_f32 v176, v176, v16
    v_mov_b32 v180, v9
    v_add_f32 v188, v188, v16
    v_add_f32 v177, v177, v17
    v_mov_b32 v181, v9
    v_add_f32 v189, v189, v17
    v_add_f32 v178, v178, v18
    v_mov_b32 v182, v9
    v_add_f32 v190, v190, v18
    v_add_f32 v179, v179, v19
    v_mov_b32 v183, v9
    v_add_f32 v191, v191, v19
    s_nop 0
m_e92:
    s_cmp_lg_u32 s64, s68
    s_cbranch_scc1 m_e93
    v_mov_b32 v176, v9
    v_mov_b32 v184, v9
    v_mov_b32 v188, v9
    v_mov_b32 v177, v9
    v_mov_b32 v185, v9
    v_mov_b32 v189, v9
    v_mov_b32 v178, v9
    v_mov_b32 v186, v9
    v_mov_b32 v190, v9
    v_mov_b32 v179, v9
    v_mov_b32 v187, v9
    v_mov_b32 v191, v9
    s_nop 0
m_e93:
    s_waitcnt lgkmcnt(0)
    v_mfma_f32_16x16x32_bf16 v[96:99], a[192:195], a[128:131], v[160:163]
    s_bitcmp1_b64 s[62:63], s64
    s_cselect_b32 s66, -1.0, s65
    v_exp_f32 v20, v64
    v_mfma_f32_16x16x32_bf16 v[96:99], a[196:199], a[132:135], v[96:99]
    s_add_u32 s64, s64, 1
    v_exp_f32 v21, v65
    v_exp_f32 v22, v66
    v_mfma_f32_16x16x32_bf16 v[96:99], a[200:203], a[136:139], v[96:99]
    buffer_store_dwordx4 v[224:227], v2, s[36:39], s40 offen sc1
    v_cvt_pk_bf16_f32 v128, v20, v21
    v_mfma_f32_16x16x32_bf16 v[96:99], a[204:207], a[140:143], v[96:99]
    s_add_u32 s40, s40, s100
    v_add_f32 v12, v12, v28
    v_exp_f32 v23, v67
    v_mfma_f32_16x16x32_bf16 v[104:107], a[204:207], a[156:159], v[168:171]
    v_exp_f32 v24, v68
    v_cvt_pk_bf16_f32 v129, v22, v23
    v_mfma_f32_16x16x32_bf16 v[104:107], a[200:203], a[152:155], v[104:107]
    buffer_store_dwordx4 v[228:231], v2, s[36:39], s40 offen sc1
    v_exp_f32 v25, v69
    v_mfma_f32_16x16x32_bf16 v[104:107], a[196:199], a[148:151], v[104:107]
    s_add_u32 s40, s40, s100
    v_exp_f32 v26, v70
    v_cvt_pk_bf16_f32 v130, v24, v25
    v_mfma_f32_16x16x32_bf16 v[104:107], a[192:195], a[144:147], v[104:107]
    v_exp_f32 v27, v71
    v_add_f32 v13, v13, v32
    v_mfma_f32_16x16x32_bf16 v[112:115], a[192:195], a[160:163], v[176:179]
    v_exp_f32 v20, v72
    v_cvt_pk_bf16_f32 v131, v26, v27
    v_mfma_f32_16x16x32_bf16 v[112:115], a[196:199], a[164:167], v[112:115]
    buffer_store_dwordx4 v[232:235], v2, s[36:39], s40 offen sc1
    v_exp_f32 v21, v73
    v_mfma_f32_16x16x32_bf16 v[28:31], v[44:47], v[128:131], 0
    v_exp_f32 v22, v74
    v_cvt_pk_bf16_f32 v132, v20, v21
    v_mfma_f32_16x16x32_bf16 v[112:115], a[200:203], a[168:171], v[112:115]
    s_add_u32 s40, s40, s100
    v_exp_f32 v23, v75
    v_add_f32 v14, v14, v36
    v_mfma_f32_16x16x32_bf16 v[112:115], a[204:207], a[172:175], v[112:115]
    v_exp_f32 v24, v76
    v_cvt_pk_bf16_f32 v133, v22, v23
    v_mfma_f32_16x16x32_bf16 v[120:123], a[204:207], a[188:191], v[184:187]
    buffer_store_dwordx4 v[236:239], v2, s[36:39], s40 offen sc1
    v_exp_f32 v25, v77
    v_mfma_f32_16x16x32_bf16 v[120:123], a[200:203], a[184:187], v[120:123]
    s_mov_b32 s40, s98
    v_exp_f32 v26, v78
    v_cvt_pk_bf16_f32 v134, v24, v25
    v_mfma_f32_16x16x32_bf16 v[120:123], a[196:199], a[180:183], v[120:123]
    v_exp_f32 v27, v79
    v_add_f32 v15, v15, v40
    v_mfma_f32_16x16x32_bf16 v[120:123], a[192:195], a[176:179], v[120:123]
    s_waitcnt lgkmcnt(0)
    v_exp_f32 v20, v80
    v_cvt_pk_bf16_f32 v135, v26, v27
    v_mfma_f32_16x16x32_bf16 v[124:127], a[208:211], a[176:179], v[188:191]
    v_exp_f32 v21, v81
    v_exp_f32 v22, v82
    v_mfma_f32_16x16x32_bf16 v[32:35], v[44:47], v[132:135], 0
    v_cvt_pk_bf16_f32 v136, v20, v21
    v_exp_f32 v23, v83
    v_mfma_f32_16x16x32_bf16 v[124:127], a[212:215], a[180:183], v[124:127]
    buffer_store_dwordx4 v[240:243], v2, s[36:39], s40 offen sc1
    v_cvt_pk_bf16_f32 v137, v22, v23
    v_mfma_f32_16x16x32_bf16 v[124:127], a[216:219], a[184:187], v[124:127]
    s_add_u32 s40, s40, s100
    v_exp_f32 v24, v84
    v_mfma_f32_16x16x32_bf16 v[124:127], a[220:223], a[188:191], v[124:127]
    v_exp_f32 v25, v85
    v_exp_f32 v26, v86
    v_cvt_pk_bf16_f32 v138, v24, v25
    v_mfma_f32_16x16x32_bf16 v[116:119], a[220:223], a[172:175], v[180:183]
    buffer_store_dwordx4 v[244:247], v2, s[36:39], s40 offen sc1
    v_mfma_f32_16x16x32_bf16 v[116:119], a[216:219], a[168:171], v[116:119]
    s_add_u32 s40, s40, s100
    v_exp_f32 v27, v87
    v_exp_f32 v20, v88
    v_mfma_f32_16x16x32_bf16 v[116:119], a[212:215], a[164:167], v[116:119]
    v_cvt_pk_bf16_f32 v139, v26, v27
    v_exp_f32 v21, v89
    v_mfma_f32_16x16x32_bf16 v[116:119], a[208:211], a[160:163], v[116:119]
    buffer_store_dwordx4 v[248:251], v2, s[36:39], s40 offen sc1
    v_exp_f32 v22, v90
    v_mfma_f32_16x16x32_bf16 v[36:39], v[44:47], v[136:139], 0
    v_cvt_pk_bf16_f32 v140, v20, v21
    v_exp_f32 v23, v91
    v_mfma_f32_16x16x32_bf16 v[108:111], a[208:211], a[144:147], v[172:175]
    s_add_u32 s40, s40, s100
    v_exp_f32 v24, v92
    v_cvt_pk_bf16_f32 v141, v22, v23
    v_mfma_f32_16x16x32_bf16 v[108:111], a[212:215], a[148:151], v[108:111]
    v_exp_f32 v25, v93
    v_mfma_f32_16x16x32_bf16 v[108:111], a[216:219], a[152:155], v[108:111]
    buffer_store_dwordx4 v[252:255], v2, s[36:39], s40 offen sc1
    v_exp_f32 v26, v94
    v_cvt_pk_bf16_f32 v142, v24, v25
    v_mfma_f32_16x16x32_bf16 v[108:111], a[220:223], a[156:159], v[108:111]
    s_add_u32 s40, s40, s100
    v_exp_f32 v27, v95
    s_nop 0
    v_cvt_pk_bf16_f32 v143, v26, v27
    s_nop 1
    v_mfma_f32_16x16x32_bf16 v[40:43], v[44:47], v[140:143], 0
    s_nop 2
    v_mfma_f32_16x16x32_bf16 v[100:103], a[220:223], a[140:143], v[164:167]
    s_nop 2
    v_mfma_f32_16x16x32_bf16 v[100:103], a[216:219], a[136:139], v[100:103]
    v_max3_f32 v8, v28, v32, v36
    v_max_f32 v8, v8, v40
    v_mfma_f32_16x16x32_bf16 v[100:103], a[212:215], a[132:135], v[100:103]
    v_cmp_nge_f32 vcc, s66, v8
    v_mfma_f32_16x16x32_bf16 v[100:103], a[208:211], a[128:131], v[100:103]
    s_waitcnt vmcnt(48) lgkmcnt(0)
    s_barrier
    s_add_u32 s59, s58, s60
    s_add_u32 s58, s58, 32768
    s_cmp_ge_u32 s58, 163840
    s_cselect_b32 s58, 0, s58
    v_add_u32 v6, s58, v2
    ds_read_b128 a[192:195], v6 offset:0
    ds_read_b128 a[196:199], v6 offset:1024
    ds_read_b128 a[200:203], v6 offset:2048
    ds_read_b128 a[204:207], v6 offset:3072
    ds_read_b128 a[208:211], v6 offset:4096
    ds_read_b128 a[212:215], v6 offset:5120
    ds_read_b128 a[216:219], v6 offset:6144
    ds_read_b128 a[220:223], v6 offset:7168
    s_waitcnt lgkmcnt(0)
    s_cbranch_vccnz m_stub94
m_ret95:
.p2align 3
m_dual96:
    v_mfma_f32_16x16x32_bf16 v[64:67], a[192:195], a[128:131], v[160:163]
    s_bitcmp1_b64 s[62:63], s64
    s_cselect_b32 s66, -1.0, s65
    v_add_f32 v12, v12, v28
    v_mfma_f32_16x16x32_bf16 v[64:67], a[196:199], a[132:135], v[64:67]
    s_add_u32 s64, s64, 1
    ds_read_b128 a[224:227], v6 offset:16384
    v_add_f32 v13, v13, v32
    v_mfma_f32_16x16x32_bf16 v[64:67], a[200:203], a[136:139], v[64:67]
    v_exp_f32 v20, v96
    v_mfma_f32_16x16x32_bf16 v[64:67], a[204:207], a[140:143], v[64:67]
    v_exp_f32 v21, v97
    v_mfma_f32_16x16x32_bf16 v[72:75], a[204:207], a[156:159], v[168:171]
    s_mov_b32 m0, s59
    ds_read_b128 a[228:231], v6 offset:17408
    v_cvt_pk_bf16_f32 v144, v20, v21
    v_mfma_f32_16x16x32_bf16 v[72:75], a[200:203], a[152:155], v[72:75]
    buffer_load_dwordx4 v7, s[24:27], s56 offen offset:0 sc1 lds
    v_mfma_f32_16x16x32_bf16 v[72:75], a[196:199], a[148:151], v[72:75]
    v_exp_f32 v22, v98
    v_mfma_f32_16x16x32_bf16 v[72:75], a[192:195], a[144:147], v[72:75]
    ds_read_b128 a[232:235], v6 offset:18432
    v_add_f32 v14, v14, v36
    v_mfma_f32_16x16x32_bf16 v[80:83], a[192:195], a[160:163], v[176:179]
    v_exp_f32 v23, v99
    v_mfma_f32_16x16x32_bf16 v[80:83], a[196:199], a[164:167], v[80:83]
    v_exp_f32 v24, v100
    v_mfma_f32_16x16x32_bf16 v[80:83], a[200:203], a[168:171], v[80:83]
    ds_read_b128 a[236:239], v6 offset:19456
    v_cvt_pk_bf16_f32 v145, v22, v23
    v_mfma_f32_16x16x32_bf16 v[80:83], a[204:207], a[172:175], v[80:83]
    v_exp_f32 v25, v101
    v_mfma_f32_16x16x32_bf16 v[88:91], a[204:207], a[188:191], v[184:187]
    v_exp_f32 v26, v102
    v_mfma_f32_16x16x32_bf16 v[88:91], a[200:203], a[184:187], v[88:91]
    ds_read_b128 a[240:243], v6 offset:20480
    v_cvt_pk_bf16_f32 v146, v24, v25
    v_mfma_f32_16x16x32_bf16 v[88:91], a[196:199], a[180:183], v[88:91]
    v_exp_f32 v27, v103
    v_mfma_f32_16x16x32_bf16 v[88:91], a[192:195], a[176:179], v[88:91]
    s_waitcnt lgkmcnt(5)
    v_exp_f32 v20, v104
    v_mfma_f32_16x16x32_bf16 v[92:95], a[208:211], a[176:179], v[188:191]
    ds_read_b128 a[244:247], v6 offset:21504
    v_cvt_pk_bf16_f32 v147, v26, v27
    v_mfma_f32_16x16x32_bf16 v[92:95], a[212:215], a[180:183], v[92:95]
    v_exp_f32 v21, v105
    v_mfma_f32_16x16x32_bf16 v[28:31], v[44:47], v[144:147], 0
    v_exp_f32 v22, v106
    v_mfma_f32_16x16x32_bf16 v[92:95], a[216:219], a[184:187], v[92:95]
    buffer_load_dwordx4 v7, s[24:27], s56 offen offset:1024 sc1 lds
    v_mfma_f32_16x16x32_bf16 v[92:95], a[220:223], a[188:191], v[92:95]
    ds_read_b128 a[248:251], v6 offset:22528
    v_cvt_pk_bf16_f32 v148, v20, v21
    v_mfma_f32_16x16x32_bf16 v[84:87], a[220:223], a[172:175], v[180:183]
    v_exp_f32 v23, v107
    v_mfma_f32_16x16x32_bf16 v[84:87], a[216:219], a[168:171], v[84:87]
    v_exp_f32 v24, v108
    v_mfma_f32_16x16x32_bf16 v[84:87], a[212:215], a[164:167], v[84:87]
    ds_read_b128 a[252:255], v6 offset:23552
    v_cvt_pk_bf16_f32 v149, v22, v23
    v_mfma_f32_16x16x32_bf16 v[84:87], a[208:211], a[160:163], v[84:87]
    v_exp_f32 v25, v109
    v_mfma_f32_16x16x32_bf16 v[76:79], a[208:211], a[144:147], v[172:175]
    v_exp_f32 v26, v110
    v_mfma_f32_16x16x32_bf16 v[76:79], a[212:215], a[148:151], v[76:79]
    v_cvt_pk_bf16_f32 v150, v24, v25
    v_add_f32 v15, v15, v40
    v_mfma_f32_16x16x32_bf16 v[76:79], a[216:219], a[152:155], v[76:79]
    v_exp_f32 v27, v111
    v_mfma_f32_16x16x32_bf16 v[76:79], a[220:223], a[156:159], v[76:79]
    buffer_load_dwordx4 v7, s[24:27], s56 offen offset:2048 sc1 lds
    v_mfma_f32_16x16x32_bf16 v[68:71], a[220:223], a[140:143], v[164:167]
    v_exp_f32 v20, v112
    v_mfma_f32_16x16x32_bf16 v[68:71], a[216:219], a[136:139], v[68:71]
    v_cvt_pk_bf16_f32 v151, v26, v27
    v_mfma_f32_16x16x32_bf16 v[68:71], a[212:215], a[132:135], v[68:71]
    v_exp_f32 v21, v113
    v_mfma_f32_16x16x32_bf16 v[32:35], v[44:47], v[148:151], 0
    v_exp_f32 v22, v114
    v_mfma_f32_16x16x32_bf16 v[68:71], a[208:211], a[128:131], v[68:71]
    s_waitcnt lgkmcnt(0)
    v_cvt_pk_bf16_f32 v152, v20, v21
    v_mfma_f32_16x16x32_bf16 a[0:3], a[224:227], v[128:131], a[0:3]
    ds_read_b128 a[192:195], v6 offset:8192
    v_mfma_f32_16x16x32_bf16 a[32:35], a[224:227], v[132:135], a[32:35]
    v_exp_f32 v23, v115
    v_mfma_f32_16x16x32_bf16 a[64:67], a[224:227], v[136:139], a[64:67]
    v_exp_f32 v24, v116
    v_mfma_f32_16x16x32_bf16 a[96:99], a[224:227], v[140:143], a[96:99]
    ds_read_b128 a[196:199], v6 offset:9216
    v_cvt_pk_bf16_f32 v153, v22, v23
    v_mfma_f32_16x16x32_bf16 a[100:103], a[228:231], v[140:143], a[100:103]
    v_exp_f32 v25, v117
    v_mfma_f32_16x16x32_bf16 a[68:71], a[228:231], v[136:139], a[68:71]
    v_exp_f32 v26, v118
    v_mfma_f32_16x16x32_bf16 a[36:39], a[228:231], v[132:135], a[36:39]
    ds_read_b128 a[200:203], v6 offset:10240
    v_cvt_pk_bf16_f32 v154, v24, v25
    v_mfma_f32_16x16x32_bf16 a[4:7], a[228:231], v[128:131], a[4:7]
    v_exp_f32 v27, v119
    v_mfma_f32_16x16x32_bf16 a[8:11], a[232:235], v[128:131], a[8:11]
    v_exp_f32 v20, v120
    v_mfma_f32_16x16x32_bf16 a[40:43], a[232:235], v[132:135], a[40:43]
    ds_read_b128 a[204:207], v6 offset:11264
    v_cvt_pk_bf16_f32 v155, v26, v27
    v_mfma_f32_16x16x32_bf16 a[72:75], a[232:235], v[136:139], a[72:75]
    v_exp_f32 v21, v121
    v_mfma_f32_16x16x32_bf16 v[36:39], v[44:47], v[152:155], 0
    v_exp_f32 v22, v122
    v_mfma_f32_16x16x32_bf16 a[104:107], a[232:235], v[140:143], a[104:107]
    buffer_load_dwordx4 v7, s[24:27], s56 offen offset:3072 sc1 lds
    v_mfma_f32_16x16x32_bf16 a[108:111], a[236:239], v[140:143], a[108:111]
    s_add_u32 s56, s56, 16384
    v_cvt_pk_bf16_f32 v156, v20, v21
    v_mfma_f32_16x16x32_bf16 a[76:79], a[236:239], v[136:139], a[76:79]
    v_exp_f32 v23, v123
    v_mfma_f32_16x16x32_bf16 a[44:47], a[236:239], v[132:135], a[44:47]
    v_exp_f32 v24, v124
    v_mfma_f32_16x16x32_bf16 a[12:15], a[236:239], v[128:131], a[12:15]
    v_cvt_pk_bf16_f32 v157, v22, v23
    v_mfma_f32_16x16x32_bf16 a[16:19], a[240:243], v[128:131], a[16:19]
    v_exp_f32 v25, v125
    v_mfma_f32_16x16x32_bf16 a[48:51], a[240:243], v[132:135], a[48:51]
    v_exp_f32 v26, v126
    v_mfma_f32_16x16x32_bf16 a[80:83], a[240:243], v[136:139], a[80:83]
    v_cvt_pk_bf16_f32 v158, v24, v25
    v_mfma_f32_16x16x32_bf16 a[112:115], a[240:243], v[140:143], a[112:115]
    s_add_u32 m0, s59, 16384
    v_exp_f32 v27, v127
    v_mfma_f32_16x16x32_bf16 a[116:119], a[244:247], v[140:143], a[116:119]
    buffer_load_dwordx4 v7, s[28:31], s57 offen offset:0 sc1 lds
    v_mfma_f32_16x16x32_bf16 a[84:87], a[244:247], v[136:139], a[84:87]
    v_cvt_pk_bf16_f32 v159, v26, v27
    v_mfma_f32_16x16x32_bf16 a[52:55], a[244:247], v[132:135], a[52:55]
    v_mfma_f32_16x16x32_bf16 a[20:23], a[244:247], v[128:131], a[20:23]
    v_mfma_f32_16x16x32_bf16 v[40:43], v[44:47], v[156:159], 0
    s_nop 2
    v_mfma_f32_16x16x32_bf16 a[24:27], a[248:251], v[128:131], a[24:27]
    s_nop 2
    v_mfma_f32_16x16x32_bf16 a[56:59], a[248:251], v[132:135], a[56:59]
    v_max3_f32 v8, v28, v32, v36
    v_max_f32 v8, v8, v40
    v_mfma_f32_16x16x32_bf16 a[88:91], a[248:251], v[136:139], a[88:91]
    v_cmp_nge_f32 vcc, s66, v8
    v_mfma_f32_16x16x32_bf16 a[120:123], a[248:251], v[140:143], a[120:123]
    ds_read_b128 a[208:211], v6 offset:12288
    v_mfma_f32_16x16x32_bf16 a[124:127], a[252:255], v[140:143], a[124:127]
    ds_read_b128 a[212:215], v6 offset:13312
    v_mfma_f32_16x16x32_bf16 a[92:95], a[252:255], v[136:139], a[92:95]
    ds_read_b128 a[216:219], v6 offset:14336
    v_mfma_f32_16x16x32_bf16 a[60:63], a[252:255], v[132:135], a[60:63]
    ds_read_b128 a[220:223], v6 offset:15360
    v_mfma_f32_16x16x32_bf16 a[28:31], a[252:255], v[128:131], a[28:31]
    s_waitcnt lgkmcnt(4)
    s_cbranch_vccnz m_stub97
m_ret98:
    v_mfma_f32_16x16x32_bf16 v[96:99], a[192:195], a[128:131], v[160:163]
    s_add_u32 s59, s58, s60
    v_exp_f32 v20, v64
    v_mfma_f32_16x16x32_bf16 v[96:99], a[196:199], a[132:135], v[96:99]
    s_add_u32 s58, s58, 32768
    ds_read_b128 a[224:227], v6 offset:24576
    v_add_f32 v12, v12, v28
    v_mfma_f32_16x16x32_bf16 v[96:99], a[200:203], a[136:139], v[96:99]
    s_cmp_ge_u32 s58, 163840
    s_cselect_b32 s58, 0, s58
    v_exp_f32 v21, v65
    v_mfma_f32_16x16x32_bf16 v[96:99], a[204:207], a[140:143], v[96:99]
    s_bitcmp1_b64 s[62:63], s64
    s_cselect_b32 s66, -1.0, s65
    v_cvt_pk_bf16_f32 v128, v20, v21
    v_mfma_f32_16x16x32_bf16 v[104:107], a[204:207], a[156:159], v[168:171]
    s_add_u32 s64, s64, 1
    ds_read_b128 a[228:231], v6 offset:25600
    v_add_f32 v13, v13, v32
    v_mfma_f32_16x16x32_bf16 v[104:107], a[200:203], a[152:155], v[104:107]
    v_exp_f32 v22, v66
    v_mfma_f32_16x16x32_bf16 v[104:107], a[196:199], a[148:151], v[104:107]
    buffer_load_dwordx4 v7, s[28:31], s57 offen offset:1024 sc1 lds
    v_mfma_f32_16x16x32_bf16 v[104:107], a[192:195], a[144:147], v[104:107]
    ds_read_b128 a[232:235], v6 offset:26624
    v_add_f32 v14, v14, v36
    v_mfma_f32_16x16x32_bf16 v[112:115], a[192:195], a[160:163], v[176:179]
    v_exp_f32 v23, v67
    v_mfma_f32_16x16x32_bf16 v[112:115], a[196:199], a[164:167], v[112:115]
    v_exp_f32 v24, v68
    v_mfma_f32_16x16x32_bf16 v[112:115], a[200:203], a[168:171], v[112:115]
    ds_read_b128 a[236:239], v6 offset:27648
    v_cvt_pk_bf16_f32 v129, v22, v23
    v_mfma_f32_16x16x32_bf16 v[112:115], a[204:207], a[172:175], v[112:115]
    v_exp_f32 v25, v69
    v_mfma_f32_16x16x32_bf16 v[120:123], a[204:207], a[188:191], v[184:187]
    v_exp_f32 v26, v70
    v_mfma_f32_16x16x32_bf16 v[120:123], a[200:203], a[184:187], v[120:123]
    ds_read_b128 a[240:243], v6 offset:28672
    v_cvt_pk_bf16_f32 v130, v24, v25
    v_mfma_f32_16x16x32_bf16 v[120:123], a[196:199], a[180:183], v[120:123]
    v_exp_f32 v27, v71
    v_mfma_f32_16x16x32_bf16 v[120:123], a[192:195], a[176:179], v[120:123]
    s_waitcnt lgkmcnt(5)
    v_exp_f32 v20, v72
    v_mfma_f32_16x16x32_bf16 v[124:127], a[208:211], a[176:179], v[188:191]
    ds_read_b128 a[244:247], v6 offset:29696
    v_cvt_pk_bf16_f32 v131, v26, v27
    v_mfma_f32_16x16x32_bf16 v[124:127], a[212:215], a[180:183], v[124:127]
    v_exp_f32 v21, v73
    v_mfma_f32_16x16x32_bf16 v[28:31], v[44:47], v[128:131], 0
    v_exp_f32 v22, v74
    v_mfma_f32_16x16x32_bf16 v[124:127], a[216:219], a[184:187], v[124:127]
    buffer_load_dwordx4 v7, s[28:31], s57 offen offset:2048 sc1 lds
    v_mfma_f32_16x16x32_bf16 v[124:127], a[220:223], a[188:191], v[124:127]
    ds_read_b128 a[248:251], v6 offset:30720
    v_cvt_pk_bf16_f32 v132, v20, v21
    v_mfma_f32_16x16x32_bf16 v[116:119], a[220:223], a[172:175], v[180:183]
    v_exp_f32 v23, v75
    v_mfma_f32_16x16x32_bf16 v[116:119], a[216:219], a[168:171], v[116:119]
    v_exp_f32 v24, v76
    v_mfma_f32_16x16x32_bf16 v[116:119], a[212:215], a[164:167], v[116:119]
    ds_read_b128 a[252:255], v6 offset:31744
    v_cvt_pk_bf16_f32 v133, v22, v23
    v_mfma_f32_16x16x32_bf16 v[116:119], a[208:211], a[160:163], v[116:119]
    v_exp_f32 v25, v77
    v_mfma_f32_16x16x32_bf16 v[108:111], a[208:211], a[144:147], v[172:175]
    v_exp_f32 v26, v78
    v_mfma_f32_16x16x32_bf16 v[108:111], a[212:215], a[148:151], v[108:111]
    v_cvt_pk_bf16_f32 v134, v24, v25
    v_add_f32 v15, v15, v40
    v_mfma_f32_16x16x32_bf16 v[108:111], a[216:219], a[152:155], v[108:111]
    v_exp_f32 v27, v79
    v_mfma_f32_16x16x32_bf16 v[108:111], a[220:223], a[156:159], v[108:111]
    buffer_load_dwordx4 v7, s[28:31], s57 offen offset:3072 sc1 lds
    v_mfma_f32_16x16x32_bf16 v[100:103], a[220:223], a[140:143], v[164:167]
    s_add_u32 s57, s57, 16384
    v_exp_f32 v20, v80
    v_mfma_f32_16x16x32_bf16 v[100:103], a[216:219], a[136:139], v[100:103]
    v_cvt_pk_bf16_f32 v135, v26, v27
    v_mfma_f32_16x16x32_bf16 v[100:103], a[212:215], a[132:135], v[100:103]
    v_exp_f32 v21, v81
    v_mfma_f32_16x16x32_bf16 v[32:35], v[44:47], v[132:135], 0
    v_exp_f32 v22, v82
    v_mfma_f32_16x16x32_bf16 v[100:103], a[208:211], a[128:131], v[100:103]
    s_waitcnt vmcnt(24) lgkmcnt(0)
    v_add_u32 v6, s58, v2
    v_cvt_pk_bf16_f32 v136, v20, v21
    v_mfma_f32_16x16x32_bf16 a[0:3], a[224:227], v[144:147], a[0:3]
    s_barrier
    v_mfma_f32_16x16x32_bf16 a[32:35], a[224:227], v[148:151], a[32:35]
    ds_read_b128 a[192:195], v6 offset:0
    v_mfma_f32_16x16x32_bf16 a[64:67], a[224:227], v[152:155], a[64:67]
    v_exp_f32 v23, v83
    v_mfma_f32_16x16x32_bf16 a[96:99], a[224:227], v[156:159], a[96:99]
    v_exp_f32 v24, v84
    v_mfma_f32_16x16x32_bf16 a[100:103], a[228:231], v[156:159], a[100:103]
    ds_read_b128 a[196:199], v6 offset:1024
    v_cvt_pk_bf16_f32 v137, v22, v23
    v_mfma_f32_16x16x32_bf16 a[68:71], a[228:231], v[152:155], a[68:71]
    v_exp_f32 v25, v85
    v_mfma_f32_16x16x32_bf16 a[36:39], a[228:231], v[148:151], a[36:39]
    v_exp_f32 v26, v86
    v_mfma_f32_16x16x32_bf16 a[4:7], a[228:231], v[144:147], a[4:7]
    ds_read_b128 a[200:203], v6 offset:2048
    v_cvt_pk_bf16_f32 v138, v24, v25
    v_mfma_f32_16x16x32_bf16 a[8:11], a[232:235], v[144:147], a[8:11]
    v_exp_f32 v27, v87
    v_mfma_f32_16x16x32_bf16 a[40:43], a[232:235], v[148:151], a[40:43]
    v_exp_f32 v20, v88
    v_mfma_f32_16x16x32_bf16 a[72:75], a[232:235], v[152:155], a[72:75]
    ds_read_b128 a[204:207], v6 offset:3072
    v_cvt_pk_bf16_f32 v139, v26, v27
    v_mfma_f32_16x16x32_bf16 a[104:107], a[232:235], v[156:159], a[104:107]
    v_exp_f32 v21, v89
    v_mfma_f32_16x16x32_bf16 v[36:39], v[44:47], v[136:139], 0
    v_exp_f32 v22, v90
    v_mfma_f32_16x16x32_bf16 a[108:111], a[236:239], v[156:159], a[108:111]
    v_cvt_pk_bf16_f32 v140, v20, v21
    v_mfma_f32_16x16x32_bf16 a[76:79], a[236:239], v[152:155], a[76:79]
    v_exp_f32 v23, v91
    v_mfma_f32_16x16x32_bf16 a[44:47], a[236:239], v[148:151], a[44:47]
    v_exp_f32 v24, v92
    v_mfma_f32_16x16x32_bf16 a[12:15], a[236:239], v[144:147], a[12:15]
    v_cvt_pk_bf16_f32 v141, v22, v23
    v_mfma_f32_16x16x32_bf16 a[16:19], a[240:243], v[144:147], a[16:19]
    v_exp_f32 v25, v93
    v_mfma_f32_16x16x32_bf16 a[48:51], a[240:243], v[148:151], a[48:51]
    v_exp_f32 v26, v94
    v_mfma_f32_16x16x32_bf16 a[80:83], a[240:243], v[152:155], a[80:83]
    v_cvt_pk_bf16_f32 v142, v24, v25
    v_mfma_f32_16x16x32_bf16 a[112:115], a[240:243], v[156:159], a[112:115]
    v_exp_f32 v27, v95
    v_mfma_f32_16x16x32_bf16 a[116:119], a[244:247], v[156:159], a[116:119]
    v_cvt_pk_bf16_f32 v143, v26, v27
    v_mfma_f32_16x16x32_bf16 a[84:87], a[244:247], v[152:155], a[84:87]
    v_mfma_f32_16x16x32_bf16 a[52:55], a[244:247], v[148:151], a[52:55]
    v_mfma_f32_16x16x32_bf16 v[40:43], v[44:47], v[140:143], 0
    s_nop 2
    v_mfma_f32_16x16x32_bf16 a[20:23], a[244:247], v[144:147], a[20:23]
    s_nop 2
    v_mfma_f32_16x16x32_bf16 a[24:27], a[248:251], v[144:147], a[24:27]
    v_max3_f32 v8, v28, v32, v36
    v_max_f32 v8, v8, v40
    v_mfma_f32_16x16x32_bf16 a[56:59], a[248:251], v[148:151], a[56:59]
    v_cmp_nge_f32 vcc, s66, v8
    v_mfma_f32_16x16x32_bf16 a[88:91], a[248:251], v[152:155], a[88:91]
    v_mfma_f32_16x16x32_bf16 a[120:123], a[248:251], v[156:159], a[120:123]
    ds_read_b128 a[208:211], v6 offset:4096
    v_mfma_f32_16x16x32_bf16 a[124:127], a[252:255], v[156:159], a[124:127]
    ds_read_b128 a[212:215], v6 offset:5120
    v_mfma_f32_16x16x32_bf16 a[92:95], a[252:255], v[152:155], a[92:95]
    ds_read_b128 a[216:219], v6 offset:6144
    v_mfma_f32_16x16x32_bf16 a[60:63], a[252:255], v[148:151], a[60:63]
    ds_read_b128 a[220:223], v6 offset:7168
    v_mfma_f32_16x16x32_bf16 a[28:31], a[252:255], v[144:147], a[28:31]
    s_waitcnt lgkmcnt(4)
    s_cbranch_vccz m_dual96
    v_cmp_lt_f32 vcc, s65, v8
    s_cmp_lg_u32 s64, s67
    s_cbranch_scc1 m_e100
    v_add_f32 v176, v176, v16
    v_mov_b32 v180, v9
    v_add_f32 v188, v188, v16
    v_add_f32 v177, v177, v17
    v_mov_b32 v181, v9
    v_add_f32 v189, v189, v17
    v_add_f32 v178, v178, v18
    v_mov_b32 v182, v9
    v_add_f32 v190, v190, v18
    v_add_f32 v179, v179, v19
    v_mov_b32 v183, v9
    v_add_f32 v191, v191, v19
    s_nop 0
m_e100:
    s_cmp_lg_u32 s64, s68
    s_cbranch_scc1 m_e101
    v_mov_b32 v176, v9
    v_mov_b32 v184, v9
    v_mov_b32 v188, v9
    v_mov_b32 v177, v9
    v_mov_b32 v185, v9
    v_mov_b32 v189, v9
    v_mov_b32 v178, v9
    v_mov_b32 v186, v9
    v_mov_b32 v190, v9
    v_mov_b32 v179, v9
    v_mov_b32 v187, v9
    v_mov_b32 v191, v9
    s_nop 0
m_e101:
    s_cmp_lg_u32 s64, s70
    s_cbranch_scc1 m_e102
    v_add_f32 v160, v160, v16
    v_mov_b32 v164, v9
    v_add_f32 v172, v172, v16
    v_add_f32 v161, v161, v17
    v_mov_b32 v165, v9
    v_add_f32 v173, v173, v17
    v_add_f32 v162, v162, v18
    v_mov_b32 v166, v9
    v_add_f32 v174, v174, v18
    v_add_f32 v163, v163, v19
    v_mov_b32 v167, v9
    v_add_f32 v175, v175, v19
    s_nop 0
m_e102:
    s_cmp_lg_u32 s64, s53
    s_cbranch_scc1 m_e105
    s_cmp_lg_u32 s16, 0
    s_cbranch_scc1 m_np106
    v_mov_b32 v60, s4
    v_mov_b32 v61, s5
    s_add_u32 s90, s101, 117440512
    s_mov_b64 exec, 1
    buffer_store_dwordx2 v[60:61], off, s[8:11], s90 sc1
    s_mov_b64 exec, -1
m_np106:
    s_mov_b32 s101, -1
m_e105:
    s_cmp_gt_u32 s64, 24
    s_cbranch_scc1 m_e103
    s_cmp_lg_u32 s64, 8
    s_cbranch_scc1 m_e107
    s_lshr_b32 s90, s32, 1
    s_lshl_b32 s90, s90, 7
    s_add_u32 s90, s90, 117440600
    v_min_u32 v0, 1, v1
    v_lshlrev_b32 v0, 5, v0
    buffer_load_dwordx2 v[4:5], v0, s[8:11], s90 offen sc1
    s_cmp_eq_u32 s17, -1
    s_cbranch_scc1 m_e103
    s_cmp_lg_u32 s16, 0
    s_cbranch_scc1 m_np108
    v_mov_b32 v60, s4
    v_mov_b32 v61, s5
    s_add_u32 s90, s17, 117440512
    s_mov_b64 exec, 1
    buffer_store_dwordx2 v[60:61], off, s[8:11], s90 sc1
    s_mov_b64 exec, -1
m_np108:
    s_branch m_e103
m_e107:
    s_cmp_lg_u32 s64, 16
    s_cbranch_scc1 m_e109
    s_waitcnt vmcnt(18)
    s_mov_b32 s3, 1048576
m_spin110:
    v_cmp_ne_u64 s[76:77], s[4:5], v[4:5]
    s_nop 3
    s_cmp_eq_u64 s[76:77], 0
    s_cbranch_scc1 m_e103
    s_sub_u32 s3, s3, 1
    s_cbranch_scc1 m_e103
    s_sleep 32
    s_lshr_b32 s90, s32, 1
    s_lshl_b32 s90, s90, 7
    s_add_u32 s90, s90, 117440600
    v_min_u32 v0, 1, v1
    v_lshlrev_b32 v0, 5, v0
    buffer_load_dwordx2 v[4:5], v0, s[8:11], s90 offen sc1
    s_waitcnt vmcnt(0)
    s_branch m_spin110
    s_branch m_e103
m_e109:
    s_cmp_lg_u32 s64, 20
    s_cbranch_scc1 m_e111
    buffer_load_dwordx2 v[4:5], v10, s[8:11], 0 offen sc1
    s_mov_b32 s44, s48
    s_mov_b32 s45, s49
    s_mov_b32 s46, 8388608
    s_lshl_b32 s90, s2, 2
    s_add_u32 s90, s90, s16
    s_lshl_b32 s90, s90, 13
    v_lshlrev_b32 v62, 7, v1
    buffer_load_dword v255, v62, s[44:47], s90 offen
    s_branch m_e103
m_e111:
    s_cmp_lg_u32 s64, 24
    s_cbranch_scc1 m_e112
    s_mov_b32 s44, s50
    s_mov_b32 s45, s51
    s_mov_b32 s46, 2097152
    s_lshl_b32 s90, s2, 2
    s_add_u32 s90, s90, s16
    s_lshl_b32 s90, s90, 13
    v_lshlrev_b32 v62, 7, v1
    buffer_load_dword v255, v62, s[44:47], s90 offen
    s_waitcnt vmcnt(18)
    s_mov_b32 s3, 1048576
m_spin113:
    v_cmp_ne_u64 s[76:77], s[4:5], v[4:5]
    s_nop 3
    s_cmp_eq_u64 s[76:77], 0
    s_cbranch_scc1 m_e103
    s_sub_u32 s3, s3, 1
    s_cbranch_scc1 m_e103
    s_sleep 32
    buffer_load_dwordx2 v[4:5], v10, s[8:11], 0 offen sc1
    s_waitcnt vmcnt(0)
    s_branch m_spin113
    s_branch m_e103
m_e112:
m_e103:
    s_cbranch_vccnz m_rc114
m_sp99:
    s_cmp_lg_u32 s64, s69
    s_cbranch_scc1 m_dual96
    v_mfma_f32_16x16x32_bf16 v[64:67], a[192:195], a[128:131], v[160:163]
    s_bitcmp1_b64 s[62:63], s64
    s_cselect_b32 s66, -1.0, s65
    v_add_f32 v12, v12, v28
    v_mfma_f32_16x16x32_bf16 v[64:67], a[196:199], a[132:135], v[64:67]
    s_add_u32 s64, s64, 1
    ds_read_b128 a[224:227], v6 offset:16384
    v_exp_f32 v20, v96
    v_mfma_f32_16x16x32_bf16 v[64:67], a[200:203], a[136:139], v[64:67]
    s_mov_b32 m0, s59
    ds_read_b128 a[228:231], v6 offset:17408
    v_add_f32 v13, v13, v32
    v_mfma_f32_16x16x32_bf16 v[64:67], a[204:207], a[140:143], v[64:67]
    buffer_load_dwordx4 v7, s[24:27], s56 offen offset:0 sc1 lds
    v_mfma_f32_16x16x32_bf16 v[72:75], a[204:207], a[156:159], v[168:171]
    ds_read_b128 a[232:235], v6 offset:18432
    v_add_f32 v14, v14, v36
    v_mfma_f32_16x16x32_bf16 v[72:75], a[200:203], a[152:155], v[72:75]
    ds_read_b128 a[236:239], v6 offset:19456
    v_exp_f32 v21, v97
    v_mfma_f32_16x16x32_bf16 v[72:75], a[196:199], a[148:151], v[72:75]
    ds_read_b128 a[240:243], v6 offset:20480
    v_cvt_pk_bf16_f32 v144, v20, v21
    v_mfma_f32_16x16x32_bf16 v[72:75], a[192:195], a[144:147], v[72:75]
    s_waitcnt lgkmcnt(5)
    ds_read_b128 a[244:247], v6 offset:21504
    v_add_f32 v15, v15, v40
    v_mfma_f32_16x16x32_bf16 v[76:79], a[208:211], a[144:147], v[172:175]
    ds_read_b128 a[248:251], v6 offset:22528
    v_exp_f32 v22, v98
    v_mfma_f32_16x16x32_bf16 v[76:79], a[212:215], a[148:151], v[76:79]
    ds_read_b128 a[252:255], v6 offset:23552
    v_exp_f32 v23, v99
    v_mfma_f32_16x16x32_bf16 v[76:79], a[216:219], a[152:155], v[76:79]
    v_exp_f32 v24, v100
    v_mfma_f32_16x16x32_bf16 v[76:79], a[220:223], a[156:159], v[76:79]
    buffer_load_dwordx4 v7, s[24:27], s56 offen offset:1024 sc1 lds
    v_mfma_f32_16x16x32_bf16 v[68:71], a[220:223], a[140:143], v[164:167]
    v_cvt_pk_bf16_f32 v145, v22, v23
    v_exp_f32 v25, v101
    v_mfma_f32_16x16x32_bf16 v[68:71], a[216:219], a[136:139], v[68:71]
    v_exp_f32 v26, v102
    v_mfma_f32_16x16x32_bf16 v[68:71], a[212:215], a[132:135], v[68:71]
    v_cvt_pk_bf16_f32 v146, v24, v25
    v_exp_f32 v27, v103
    v_mfma_f32_16x16x32_bf16 v[68:71], a[208:211], a[128:131], v[68:71]
    s_waitcnt lgkmcnt(0)
    v_exp_f32 v20, v104
    v_mfma_f32_16x16x32_bf16 a[0:3], a[224:227], v[128:131], a[0:3]
    ds_read_b128 a[192:195], v6 offset:8192
    v_cvt_pk_bf16_f32 v147, v26, v27
    v_mfma_f32_16x16x32_bf16 a[32:35], a[224:227], v[132:135], a[32:35]
    v_exp_f32 v21, v105
    v_mfma_f32_16x16x32_bf16 v[28:31], v[44:47], v[144:147], 0
    v_exp_f32 v22, v106
    v_mfma_f32_16x16x32_bf16 a[64:67], a[224:227], v[136:139], a[64:67]
    v_cvt_pk_bf16_f32 v148, v20, v21
    v_exp_f32 v23, v107
    v_mfma_f32_16x16x32_bf16 a[96:99], a[224:227], v[140:143], a[96:99]
    ds_read_b128 a[196:199], v6 offset:9216
    v_cvt_pk_bf16_f32 v149, v22, v23
    v_mfma_f32_16x16x32_bf16 a[100:103], a[228:231], v[140:143], a[100:103]
    v_exp_f32 v24, v108
    v_mfma_f32_16x16x32_bf16 a[68:71], a[228:231], v[136:139], a[68:71]
    buffer_load_dwordx4 v7, s[24:27], s56 offen offset:2048 sc1 lds
    v_mfma_f32_16x16x32_bf16 a[36:39], a[228:231], v[132:135], a[36:39]
    ds_read_b128 a[200:203], v6 offset:10240
    v_exp_f32 v25, v109
    v_mfma_f32_16x16x32_bf16 a[4:7], a[228:231], v[128:131], a[4:7]
    v_exp_f32 v26, v110
    v_mfma_f32_16x16x32_bf16 a[8:11], a[232:235], v[128:131], a[8:11]
    v_cvt_pk_bf16_f32 v150, v24, v25
    v_exp_f32 v27, v111
    v_mfma_f32_16x16x32_bf16 a[40:43], a[232:235], v[132:135], a[40:43]
    ds_read_b128 a[204:207], v6 offset:11264
    v_cvt_pk_bf16_f32 v151, v26, v27
    v_mfma_f32_16x16x32_bf16 a[72:75], a[232:235], v[136:139], a[72:75]
    v_exp_f32 v20, v112
    v_mfma_f32_16x16x32_bf16 v[32:35], v[44:47], v[148:151], 0
    v_exp_f32 v21, v113
    v_mfma_f32_16x16x32_bf16 a[104:107], a[232:235], v[140:143], a[104:107]
    v_exp_f32 v22, v114
    v_mfma_f32_16x16x32_bf16 a[108:111], a[236:239], v[140:143], a[108:111]
    v_cvt_pk_bf16_f32 v152, v20, v21
    v_exp_f32 v23, v115
    v_mfma_f32_16x16x32_bf16 a[76:79], a[236:239], v[136:139], a[76:79]
    v_exp_f32 v24, v116
    v_mfma_f32_16x16x32_bf16 a[44:47], a[236:239], v[132:135], a[44:47]
    v_cvt_pk_bf16_f32 v153, v22, v23
    v_exp_f32 v25, v117
    v_mfma_f32_16x16x32_bf16 a[12:15], a[236:239], v[128:131], a[12:15]
    buffer_load_dwordx4 v7, s[24:27], s56 offen offset:3072 sc1 lds
    v_mfma_f32_16x16x32_bf16 a[16:19], a[240:243], v[128:131], a[16:19]
    s_add_u32 s56, s56, 16384
    v_exp_f32 v26, v118
    v_mfma_f32_16x16x32_bf16 a[48:51], a[240:243], v[132:135], a[48:51]
    v_cvt_pk_bf16_f32 v154, v24, v25
    v_exp_f32 v27, v119
    v_mfma_f32_16x16x32_bf16 a[80:83], a[240:243], v[136:139], a[80:83]
    v_exp_f32 v20, v120
    v_mfma_f32_16x16x32_bf16 a[112:115], a[240:243], v[140:143], a[112:115]
    v_cvt_pk_bf16_f32 v155, v26, v27
    v_exp_f32 v21, v121
    v_mfma_f32_16x16x32_bf16 a[116:119], a[244:247], v[140:143], a[116:119]
    v_exp_f32 v22, v122
    v_mfma_f32_16x16x32_bf16 v[36:39], v[44:47], v[152:155], 0
    v_cvt_pk_bf16_f32 v156, v20, v21
    v_mfma_f32_16x16x32_bf16 a[84:87], a[244:247], v[136:139], a[84:87]
    v_exp_f32 v23, v123
    v_mfma_f32_16x16x32_bf16 a[52:55], a[244:247], v[132:135], a[52:55]
    v_exp_f32 v24, v124
    v_cvt_pk_bf16_f32 v157, v22, v23
    v_mfma_f32_16x16x32_bf16 a[20:23], a[244:247], v[128:131], a[20:23]
    v_exp_f32 v25, v125
    v_mfma_f32_16x16x32_bf16 a[24:27], a[248:251], v[128:131], a[24:27]
    s_add_u32 m0, s59, 16384
    v_exp_f32 v26, v126
    v_mfma_f32_16x16x32_bf16 a[56:59], a[248:251], v[132:135], a[56:59]
    buffer_load_dwordx4 v7, s[28:31], s57 offen offset:0 sc1 lds
    v_mfma_f32_16x16x32_bf16 a[88:91], a[248:251], v[136:139], a[88:91]
    v_cvt_pk_bf16_f32 v158, v24, v25
    v_exp_f32 v27, v127
    v_mfma_f32_16x16x32_bf16 a[120:123], a[248:251], v[140:143], a[120:123]
    ds_read_b128 a[208:211], v6 offset:12288
    v_cvt_pk_bf16_f32 v159, v26, v27
    s_nop 1
    v_mfma_f32_16x16x32_bf16 v[40:43], v[44:47], v[156:159], 0
    s_nop 2
    v_mfma_f32_16x16x32_bf16 a[124:127], a[252:255], v[140:143], a[124:127]
    ds_read_b128 a[212:215], v6 offset:13312
    s_nop 0
    v_mfma_f32_16x16x32_bf16 a[92:95], a[252:255], v[136:139], a[92:95]
    ds_read_b128 a[216:219], v6 offset:14336
    v_max3_f32 v8, v28, v32, v36
    v_mfma_f32_16x16x32_bf16 a[60:63], a[252:255], v[132:135], a[60:63]
    ds_read_b128 a[220:223], v6 offset:15360
    v_max_f32 v8, v8, v40
    v_cmp_nge_f32 vcc, s66, v8
    v_mfma_f32_16x16x32_bf16 a[28:31], a[252:255], v[128:131], a[28:31]
    s_waitcnt lgkmcnt(4)
    s_cbranch_vccnz m_stub115
m_ret116:
    v_mfma_f32_16x16x32_bf16 v[96:99], a[192:195], a[128:131], v[160:163]
    s_add_u32 s59, s58, s60
    v_exp_f32 v20, v64
    v_mfma_f32_16x16x32_bf16 v[96:99], a[196:199], a[132:135], v[96:99]
    s_add_u32 s58, s58, 32768
    ds_read_b128 a[224:227], v6 offset:24576
    v_add_f32 v12, v12, v28
    v_mfma_f32_16x16x32_bf16 v[96:99], a[200:203], a[136:139], v[96:99]
    s_cmp_ge_u32 s58, 163840
    s_cselect_b32 s58, 0, s58
    ds_read_b128 a[228:231], v6 offset:25600
    v_add_f32 v13, v13, v32
    v_mfma_f32_16x16x32_bf16 v[96:99], a[204:207], a[140:143], v[96:99]
    buffer_load_dwordx4 v7, s[28:31], s57 offen offset:1024 sc1 lds
    v_mfma_f32_16x16x32_bf16 v[104:107], a[204:207], a[156:159], v[168:171]
    s_bitcmp1_b64 s[62:63], s64
    s_cselect_b32 s66, -1.0, s65
    ds_read_b128 a[232:235], v6 offset:26624
    v_mfma_f32_16x16x32_bf16 v[104:107], a[200:203], a[152:155], v[104:107]
    s_add_u32 s64, s64, 1
    ds_read_b128 a[236:239], v6 offset:27648
    v_mfma_f32_16x16x32_bf16 v[104:107], a[196:199], a[148:151], v[104:107]
    ds_read_b128 a[240:243], v6 offset:28672
    v_mfma_f32_16x16x32_bf16 v[104:107], a[192:195], a[144:147], v[104:107]
    s_waitcnt lgkmcnt(5)
    ds_read_b128 a[244:247], v6 offset:29696
    v_mfma_f32_16x16x32_bf16 v[108:111], a[208:211], a[144:147], v[172:175]
    buffer_load_dwordx4 v7, s[28:31], s57 offen offset:2048 sc1 lds
    v_mfma_f32_16x16x32_bf16 v[108:111], a[212:215], a[148:151], v[108:111]
    ds_read_b128 a[248:251], v6 offset:30720
    v_mfma_f32_16x16x32_bf16 v[108:111], a[216:219], a[152:155], v[108:111]
    ds_read_b128 a[252:255], v6 offset:31744
    v_mfma_f32_16x16x32_bf16 v[108:111], a[220:223], a[156:159], v[108:111]
    v_exp_f32 v21, v65
    v_mfma_f32_16x16x32_bf16 v[100:103], a[220:223], a[140:143], v[164:167]
    v_exp_f32 v22, v66
    v_mfma_f32_16x16x32_bf16 v[100:103], a[216:219], a[136:139], v[100:103]
    buffer_load_dwordx4 v7, s[28:31], s57 offen offset:3072 sc1 lds
    v_mfma_f32_16x16x32_bf16 v[100:103], a[212:215], a[132:135], v[100:103]
    s_add_u32 s57, s57, 16384
    v_cvt_pk_bf16_f32 v128, v20, v21
    v_mfma_f32_16x16x32_bf16 v[100:103], a[208:211], a[128:131], v[100:103]
    s_waitcnt vmcnt(24) lgkmcnt(0)
    v_add_u32 v6, s58, v2
    v_mfma_f32_16x16x32_bf16 a[0:3], a[224:227], v[144:147], a[0:3]
    s_barrier
    v_mfma_f32_16x16x32_bf16 a[32:35], a[224:227], v[148:151], a[32:35]
    ds_read_b128 a[192:195], v6 offset:0
    v_mfma_f32_16x16x32_bf16 a[64:67], a[224:227], v[152:155], a[64:67]
    v_exp_f32 v23, v67
    v_mfma_f32_16x16x32_bf16 a[96:99], a[224:227], v[156:159], a[96:99]
    v_exp_f32 v24, v68
    v_mfma_f32_16x16x32_bf16 a[100:103], a[228:231], v[156:159], a[100:103]
    ds_read_b128 a[196:199], v6 offset:1024
    v_cvt_pk_bf16_f32 v129, v22, v23
    v_mfma_f32_16x16x32_bf16 a[68:71], a[228:231], v[152:155], a[68:71]
    v_exp_f32 v25, v69
    v_mfma_f32_16x16x32_bf16 a[36:39], a[228:231], v[148:151], a[36:39]
    v_exp_f32 v26, v70
    v_mfma_f32_16x16x32_bf16 a[4:7], a[228:231], v[144:147], a[4:7]
    ds_read_b128 a[200:203], v6 offset:2048
    v_cvt_pk_bf16_f32 v130, v24, v25
    v_mfma_f32_16x16x32_bf16 a[8:11], a[232:235], v[144:147], a[8:11]
    v_exp_f32 v27, v71
    v_mfma_f32_16x16x32_bf16 a[40:43], a[232:235], v[148:151], a[40:43]
    v_exp_f32 v20, v72
    v_mfma_f32_16x16x32_bf16 a[72:75], a[232:235], v[152:155], a[72:75]
    ds_read_b128 a[204:207], v6 offset:3072
    v_cvt_pk_bf16_f32 v131, v26, v27
    v_mfma_f32_16x16x32_bf16 a[104:107], a[232:235], v[156:159], a[104:107]
    v_exp_f32 v21, v73
    v_mfma_f32_16x16x32_bf16 v[28:31], v[44:47], v[128:131], 0
    v_exp_f32 v22, v74
    v_mfma_f32_16x16x32_bf16 a[108:111], a[236:239], v[156:159], a[108:111]
    v_cvt_pk_bf16_f32 v132, v20, v21
    v_mfma_f32_16x16x32_bf16 a[76:79], a[236:239], v[152:155], a[76:79]
    v_exp_f32 v23, v75
    v_mfma_f32_16x16x32_bf16 a[44:47], a[236:239], v[148:151], a[44:47]
    v_exp_f32 v24, v76
    v_mfma_f32_16x16x32_bf16 a[12:15], a[236:239], v[144:147], a[12:15]
    v_cvt_pk_bf16_f32 v133, v22, v23
    v_mfma_f32_16x16x32_bf16 a[16:19], a[240:243], v[144:147], a[16:19]
    v_exp_f32 v25, v77
    v_mfma_f32_16x16x32_bf16 a[48:51], a[240:243], v[148:151], a[48:51]
    v_exp_f32 v26, v78
    v_mfma_f32_16x16x32_bf16 a[80:83], a[240:243], v[152:155], a[80:83]
    v_cvt_pk_bf16_f32 v134, v24, v25
    v_mfma_f32_16x16x32_bf16 a[112:115], a[240:243], v[156:159], a[112:115]
    v_exp_f32 v27, v79
    v_mfma_f32_16x16x32_bf16 a[116:119], a[244:247], v[156:159], a[116:119]
    v_cvt_pk_bf16_f32 v135, v26, v27
    v_mfma_f32_16x16x32_bf16 a[84:87], a[244:247], v[152:155], a[84:87]
    v_mfma_f32_16x16x32_bf16 a[52:55], a[244:247], v[148:151], a[52:55]
    v_mfma_f32_16x16x32_bf16 v[32:35], v[44:47], v[132:135], 0
    s_nop 2
    v_mfma_f32_16x16x32_bf16 a[20:23], a[244:247], v[144:147], a[20:23]
    s_nop 2
    v_mfma_f32_16x16x32_bf16 a[24:27], a[248:251], v[144:147], a[24:27]
    v_max_f32 v8, v28, v32
    v_cmp_nge_f32 vcc, s66, v8
    v_mfma_f32_16x16x32_bf16 a[56:59], a[248:251], v[148:151], a[56:59]
    v_mfma_f32_16x16x32_bf16 a[88:91], a[248:251], v[152:155], a[88:91]
    v_mfma_f32_16x16x32_bf16 a[120:123], a[248:251], v[156:159], a[120:123]
    ds_read_b128 a[208:211], v6 offset:4096
    v_mfma_f32_16x16x32_bf16 a[124:127], a[252:255], v[156:159], a[124:127]
    ds_read_b128 a[212:215], v6 offset:5120
    v_mfma_f32_16x16x32_bf16 a[92:95], a[252:255], v[152:155], a[92:95]
    ds_read_b128 a[216:219], v6 offset:6144
    v_mfma_f32_16x16x32_bf16 a[60:63], a[252:255], v[148:151], a[60:63]
    ds_read_b128 a[220:223], v6 offset:7168
    v_mfma_f32_16x16x32_bf16 a[28:31], a[252:255], v[144:147], a[28:31]
    s_waitcnt lgkmcnt(4)
    s_cbranch_vccnz m_stub117
m_ret118:
    v_add_f32 v20, v14, v36
    v_add_f32 v21, v15, v40
    s_nop 3
    v_rcp_f32 v20, v20
    v_rcp_f32 v21, v21
    s_lshl_b32 s90, s79, 10
    s_add_u32 s90, s90, s82
    s_add_u32 s90, s90, 67108864
    v_accvgpr_read_b32 v48, a64
    v_accvgpr_read_b32 v49, a65
    v_accvgpr_read_b32 v50, a66
    v_accvgpr_read_b32 v51, a67
    v_accvgpr_read_b32 v52, a68
    v_accvgpr_read_b32 v53, a69
    v_accvgpr_read_b32 v54, a70
    v_accvgpr_read_b32 v55, a71
    v_mul_f32 v48, v20, v48
    v_mul_f32 v49, v20, v49
    v_mul_f32 v50, v20, v50
    v_mul_f32 v51, v20, v51
    v_mul_f32 v52, v20, v52
    v_mul_f32 v53, v20, v53
    v_mul_f32 v54, v20, v54
    v_mul_f32 v55, v20, v55
    v_cvt_pk_bf16_f32 v48, v48, v49
    v_cvt_pk_bf16_f32 v49, v50, v51
    v_cvt_pk_bf16_f32 v50, v52, v53
    v_cvt_pk_bf16_f32 v51, v54, v55
    buffer_store_dwordx4 v[48:51], v2, s[8:11], s90 offen offset:0 sc1
    v_accvgpr_read_b32 v56, a96
    v_accvgpr_read_b32 v57, a97
    v_accvgpr_read_b32 v58, a98
    v_accvgpr_read_b32 v59, a99
    v_accvgpr_read_b32 v60, a100
    v_accvgpr_read_b32 v61, a101
    v_accvgpr_read_b32 v62, a102
    v_accvgpr_read_b32 v63, a103
    v_mul_f32 v56, v21, v56
    v_mul_f32 v57, v21, v57
    v_mul_f32 v58, v21, v58
    v_mul_f32 v59, v21, v59
    v_mul_f32 v60, v21, v60
    v_mul_f32 v61, v21, v61
    v_mul_f32 v62, v21, v62
    v_mul_f32 v63, v21, v63
    v_cvt_pk_bf16_f32 v56, v56, v57
    v_cvt_pk_bf16_f32 v57, v58, v59
    v_cvt_pk_bf16_f32 v58, v60, v61
    v_cvt_pk_bf16_f32 v59, v62, v63
    buffer_store_dwordx4 v[56:59], v2, s[8:11], s90 offen offset:1024 sc1
    s_add_u32 s90, s90, 131072
    v_accvgpr_read_b32 v48, a72
    v_accvgpr_read_b32 v49, a73
    v_accvgpr_read_b32 v50, a74
    v_accvgpr_read_b32 v51, a75
    v_accvgpr_read_b32 v52, a76
    v_accvgpr_read_b32 v53, a77
    v_accvgpr_read_b32 v54, a78
    v_accvgpr_read_b32 v55, a79
    v_mul_f32 v48, v20, v48
    v_mul_f32 v49, v20, v49
    v_mul_f32 v50, v20, v50
    v_mul_f32 v51, v20, v51
    v_mul_f32 v52, v20, v52
    v_mul_f32 v53, v20, v53
    v_mul_f32 v54, v20, v54
    v_mul_f32 v55, v20, v55
    v_cvt_pk_bf16_f32 v48, v48, v49
    v_cvt_pk_bf16_f32 v49, v50, v51
    v_cvt_pk_bf16_f32 v50, v52, v53
    v_cvt_pk_bf16_f32 v51, v54, v55
    buffer_store_dwordx4 v[48:51], v2, s[8:11], s90 offen offset:0 sc1
    v_accvgpr_read_b32 v56, a104
    v_accvgpr_read_b32 v57, a105
    v_accvgpr_read_b32 v58, a106
    v_accvgpr_read_b32 v59, a107
    v_accvgpr_read_b32 v60, a108
    v_accvgpr_read_b32 v61, a109
    v_accvgpr_read_b32 v62, a110
    v_accvgpr_read_b32 v63, a111
    v_mul_f32 v56, v21, v56
    v_mul_f32 v57, v21, v57
    v_mul_f32 v58, v21, v58
    v_mul_f32 v59, v21, v59
    v_mul_f32 v60, v21, v60
    v_mul_f32 v61, v21, v61
    v_mul_f32 v62, v21, v62
    v_mul_f32 v63, v21, v63
    v_cvt_pk_bf16_f32 v56, v56, v57
    v_cvt_pk_bf16_f32 v57, v58, v59
    v_cvt_pk_bf16_f32 v58, v60, v61
    v_cvt_pk_bf16_f32 v59, v62, v63
    buffer_store_dwordx4 v[56:59], v2, s[8:11], s90 offen offset:1024 sc1
    s_add_u32 s90, s90, 131072
    v_accvgpr_read_b32 v48, a80
    v_accvgpr_read_b32 v49, a81
    v_accvgpr_read_b32 v50, a82
    v_accvgpr_read_b32 v51, a83
    v_accvgpr_read_b32 v52, a84
    v_accvgpr_read_b32 v53, a85
    v_accvgpr_read_b32 v54, a86
    v_accvgpr_read_b32 v55, a87
    v_mul_f32 v48, v20, v48
    v_mul_f32 v49, v20, v49
    v_mul_f32 v50, v20, v50
    v_mul_f32 v51, v20, v51
    v_mul_f32 v52, v20, v52
    v_mul_f32 v53, v20, v53
    v_mul_f32 v54, v20, v54
    v_mul_f32 v55, v20, v55
    v_cvt_pk_bf16_f32 v48, v48, v49
    v_cvt_pk_bf16_f32 v49, v50, v51
    v_cvt_pk_bf16_f32 v50, v52, v53
    v_cvt_pk_bf16_f32 v51, v54, v55
    buffer_store_dwordx4 v[48:51], v2, s[8:11], s90 offen offset:0 sc1
    v_accvgpr_read_b32 v56, a112
    v_accvgpr_read_b32 v57, a113
    v_accvgpr_read_b32 v58, a114
    v_accvgpr_read_b32 v59, a115
    v_accvgpr_read_b32 v60, a116
    v_accvgpr_read_b32 v61, a117
    v_accvgpr_read_b32 v62, a118
    v_accvgpr_read_b32 v63, a119
    v_mul_f32 v56, v21, v56
    v_mul_f32 v57, v21, v57
    v_mul_f32 v58, v21, v58
    v_mul_f32 v59, v21, v59
    v_mul_f32 v60, v21, v60
    v_mul_f32 v61, v21, v61
    v_mul_f32 v62, v21, v62
    v_mul_f32 v63, v21, v63
    v_cvt_pk_bf16_f32 v56, v56, v57
    v_cvt_pk_bf16_f32 v57, v58, v59
    v_cvt_pk_bf16_f32 v58, v60, v61
    v_cvt_pk_bf16_f32 v59, v62, v63
    buffer_store_dwordx4 v[56:59], v2, s[8:11], s90 offen offset:1024 sc1
    s_add_u32 s90, s90, 131072
    v_accvgpr_read_b32 v48, a88
    v_accvgpr_read_b32 v49, a89
    v_accvgpr_read_b32 v50, a90
    v_accvgpr_read_b32 v51, a91
    v_accvgpr_read_b32 v52, a92
    v_accvgpr_read_b32 v53, a93
    v_accvgpr_read_b32 v54, a94
    v_accvgpr_read_b32 v55, a95
    v_mul_f32 v48, v20, v48
    v_mul_f32 v49, v20, v49
    v_mul_f32 v50, v20, v50
    v_mul_f32 v51, v20, v51
    v_mul_f32 v52, v20, v52
    v_mul_f32 v53, v20, v53
    v_mul_f32 v54, v20, v54
    v_mul_f32 v55, v20, v55
    v_cvt_pk_bf16_f32 v48, v48, v49
    v_cvt_pk_bf16_f32 v49, v50, v51
    v_cvt_pk_bf16_f32 v50, v52, v53
    v_cvt_pk_bf16_f32 v51, v54, v55
    buffer_store_dwordx4 v[48:51], v2, s[8:11], s90 offen offset:0 sc1
    v_accvgpr_read_b32 v56, a120
    v_accvgpr_read_b32 v57, a121
    v_accvgpr_read_b32 v58, a122
    v_accvgpr_read_b32 v59, a123
    v_accvgpr_read_b32 v60, a124
    v_accvgpr_read_b32 v61, a125
    v_accvgpr_read_b32 v62, a126
    v_accvgpr_read_b32 v63, a127
    v_mul_f32 v56, v21, v56
    v_mul_f32 v57, v21, v57
    v_mul_f32 v58, v21, v58
    v_mul_f32 v59, v21, v59
    v_mul_f32 v60, v21, v60
    v_mul_f32 v61, v21, v61
    v_mul_f32 v62, v21, v62
    v_mul_f32 v63, v21, v63
    v_cvt_pk_bf16_f32 v56, v56, v57
    v_cvt_pk_bf16_f32 v57, v58, v59
    v_cvt_pk_bf16_f32 v58, v60, v61
    v_cvt_pk_bf16_f32 v59, v62, v63
    buffer_store_dwordx4 v[56:59], v2, s[8:11], s90 offen offset:1024 sc1
    s_add_u32 s90, s90, 131072
    s_lshl_b32 s101, s34, 5
    s_add_u32 s101, s101, s32
    s_lshl_b32 s101, s101, 3
    s_add_u32 s101, s101, 7936
    s_cmp_eq_u32 s64, s72
    s_cbranch_scc1 m_singlex120
.p2align 3
m_single119:
    v_mfma_f32_16x16x32_bf16 v[64:67], a[192:195], a[128:131], v[160:163]
    s_bitcmp1_b64 s[62:63], s64
    s_cselect_b32 s66, -1.0, s65
    v_add_f32 v12, v12, v28
    v_mfma_f32_16x16x32_bf16 v[64:67], a[196:199], a[132:135], v[64:67]
    s_mov_b32 m0, s59
    ds_read_b128 a[224:227], v6 offset:16384
    v_add_f32 v13, v13, v32
    v_mfma_f32_16x16x32_bf16 v[64:67], a[200:203], a[136:139], v[64:67]
    buffer_load_dwordx4 v7, s[24:27], s56 offen offset:0 sc1 lds
    v_mfma_f32_16x16x32_bf16 v[64:67], a[204:207], a[140:143], v[64:67]
    s_add_u32 s64, s64, 1
    ds_read_b128 a[228:231], v6 offset:17408
    v_exp_f32 v20, v96
    v_mfma_f32_16x16x32_bf16 v[72:75], a[204:207], a[156:159], v[168:171]
    ds_read_b128 a[232:235], v6 offset:18432
    v_exp_f32 v21, v97
    v_mfma_f32_16x16x32_bf16 v[72:75], a[200:203], a[152:155], v[72:75]
    ds_read_b128 a[236:239], v6 offset:19456
    v_cvt_pk_bf16_f32 v144, v20, v21
    v_mfma_f32_16x16x32_bf16 v[72:75], a[196:199], a[148:151], v[72:75]
    ds_read_b128 a[240:243], v6 offset:20480
    v_exp_f32 v22, v98
    v_mfma_f32_16x16x32_bf16 v[72:75], a[192:195], a[144:147], v[72:75]
    s_waitcnt lgkmcnt(5)
    ds_read_b128 a[244:247], v6 offset:21504
    v_mfma_f32_16x16x32_bf16 v[76:79], a[208:211], a[144:147], v[172:175]
    ds_read_b128 a[248:251], v6 offset:22528
    v_exp_f32 v23, v99
    v_mfma_f32_16x16x32_bf16 v[76:79], a[212:215], a[148:151], v[76:79]
    ds_read_b128 a[252:255], v6 offset:23552
    v_cvt_pk_bf16_f32 v145, v22, v23
    v_mfma_f32_16x16x32_bf16 v[76:79], a[216:219], a[152:155], v[76:79]
    buffer_load_dwordx4 v7, s[24:27], s56 offen offset:1024 sc1 lds
    v_mfma_f32_16x16x32_bf16 v[76:79], a[220:223], a[156:159], v[76:79]
    v_exp_f32 v24, v100
    v_mfma_f32_16x16x32_bf16 v[68:71], a[220:223], a[140:143], v[164:167]
    v_exp_f32 v25, v101
    v_mfma_f32_16x16x32_bf16 v[68:71], a[216:219], a[136:139], v[68:71]
    v_exp_f32 v26, v102
    v_mfma_f32_16x16x32_bf16 v[68:71], a[212:215], a[132:135], v[68:71]
    buffer_load_dwordx4 v7, s[24:27], s56 offen offset:2048 sc1 lds
    v_cvt_pk_bf16_f32 v146, v24, v25
    v_mfma_f32_16x16x32_bf16 v[68:71], a[208:211], a[128:131], v[68:71]
    s_waitcnt lgkmcnt(0)
    v_exp_f32 v27, v103
    v_mfma_f32_16x16x32_bf16 a[0:3], a[224:227], v[128:131], a[0:3]
    ds_read_b128 a[192:195], v6 offset:8192
    v_cvt_pk_bf16_f32 v147, v26, v27
    v_mfma_f32_16x16x32_bf16 a[32:35], a[224:227], v[132:135], a[32:35]
    v_exp_f32 v20, v104
    v_mfma_f32_16x16x32_bf16 v[28:31], v[44:47], v[144:147], 0
    v_exp_f32 v21, v105
    v_mfma_f32_16x16x32_bf16 a[36:39], a[228:231], v[132:135], a[36:39]
    ds_read_b128 a[196:199], v6 offset:9216
    v_exp_f32 v22, v106
    v_mfma_f32_16x16x32_bf16 a[4:7], a[228:231], v[128:131], a[4:7]
    buffer_load_dwordx4 v7, s[24:27], s56 offen offset:3072 sc1 lds
    v_mfma_f32_16x16x32_bf16 a[8:11], a[232:235], v[128:131], a[8:11]
    s_add_u32 s56, s56, 16384
    ds_read_b128 a[200:203], v6 offset:10240
    v_cvt_pk_bf16_f32 v148, v20, v21
    v_mfma_f32_16x16x32_bf16 a[40:43], a[232:235], v[132:135], a[40:43]
    v_exp_f32 v23, v107
    v_mfma_f32_16x16x32_bf16 a[44:47], a[236:239], v[132:135], a[44:47]
    ds_read_b128 a[204:207], v6 offset:11264
    v_exp_f32 v24, v108
    v_mfma_f32_16x16x32_bf16 a[12:15], a[236:239], v[128:131], a[12:15]
    v_cvt_pk_bf16_f32 v149, v22, v23
    v_exp_f32 v25, v109
    v_mfma_f32_16x16x32_bf16 a[16:19], a[240:243], v[128:131], a[16:19]
    v_exp_f32 v26, v110
    v_mfma_f32_16x16x32_bf16 a[48:51], a[240:243], v[132:135], a[48:51]
    v_cvt_pk_bf16_f32 v150, v24, v25
    v_exp_f32 v27, v111
    v_mfma_f32_16x16x32_bf16 a[52:55], a[244:247], v[132:135], a[52:55]
    ds_read_b128 a[208:211], v6 offset:12288
    v_cvt_pk_bf16_f32 v151, v26, v27
    v_mfma_f32_16x16x32_bf16 a[20:23], a[244:247], v[128:131], a[20:23]
    s_add_u32 m0, s59, 16384
    ds_read_b128 a[212:215], v6 offset:13312
    v_mfma_f32_16x16x32_bf16 v[32:35], v[44:47], v[148:151], 0
    s_nop 2
    v_mfma_f32_16x16x32_bf16 a[24:27], a[248:251], v[128:131], a[24:27]
    buffer_load_dwordx4 v7, s[28:31], s57 offen offset:0 sc1 lds
    v_mfma_f32_16x16x32_bf16 a[56:59], a[248:251], v[132:135], a[56:59]
    ds_read_b128 a[216:219], v6 offset:14336
    s_nop 0
    v_mfma_f32_16x16x32_bf16 a[60:63], a[252:255], v[132:135], a[60:63]
    ds_read_b128 a[220:223], v6 offset:15360
    v_max_f32 v8, v28, v32
    v_cmp_nge_f32 vcc, s66, v8
    v_mfma_f32_16x16x32_bf16 a[28:31], a[252:255], v[128:131], a[28:31]
    s_waitcnt lgkmcnt(4)
    s_cbranch_vccnz m_stub121
m_ret122:
    v_mfma_f32_16x16x32_bf16 v[96:99], a[192:195], a[128:131], v[160:163]
    s_add_u32 s59, s58, s60
    v_exp_f32 v20, v64
    v_mfma_f32_16x16x32_bf16 v[96:99], a[196:199], a[132:135], v[96:99]
    s_add_u32 s58, s58, 32768
    ds_read_b128 a[224:227], v6 offset:24576
    v_add_f32 v12, v12, v28
    v_mfma_f32_16x16x32_bf16 v[96:99], a[200:203], a[136:139], v[96:99]
    s_cmp_ge_u32 s58, 163840
    s_cselect_b32 s58, 0, s58
    ds_read_b128 a[228:231], v6 offset:25600
    v_exp_f32 v21, v65
    v_mfma_f32_16x16x32_bf16 v[96:99], a[204:207], a[140:143], v[96:99]
    s_bitcmp1_b64 s[62:63], s64
    s_cselect_b32 s66, -1.0, s65
    ds_read_b128 a[232:235], v6 offset:26624
    v_mfma_f32_16x16x32_bf16 v[104:107], a[204:207], a[156:159], v[168:171]
    buffer_load_dwordx4 v7, s[28:31], s57 offen offset:1024 sc1 lds
    v_mfma_f32_16x16x32_bf16 v[104:107], a[200:203], a[152:155], v[104:107]
    s_add_u32 s64, s64, 1
    ds_read_b128 a[236:239], v6 offset:27648
    v_cvt_pk_bf16_f32 v128, v20, v21
    v_mfma_f32_16x16x32_bf16 v[104:107], a[196:199], a[148:151], v[104:107]
    ds_read_b128 a[240:243], v6 offset:28672
    v_exp_f32 v22, v66
    v_mfma_f32_16x16x32_bf16 v[104:107], a[192:195], a[144:147], v[104:107]
    s_waitcnt lgkmcnt(5)
    ds_read_b128 a[244:247], v6 offset:29696
    v_add_f32 v13, v13, v32
    v_mfma_f32_16x16x32_bf16 v[108:111], a[208:211], a[144:147], v[172:175]
    ds_read_b128 a[248:251], v6 offset:30720
    v_exp_f32 v23, v67
    v_mfma_f32_16x16x32_bf16 v[108:111], a[212:215], a[148:151], v[108:111]
    buffer_load_dwordx4 v7, s[28:31], s57 offen offset:2048 sc1 lds
    v_mfma_f32_16x16x32_bf16 v[108:111], a[216:219], a[152:155], v[108:111]
    ds_read_b128 a[252:255], v6 offset:31744
    v_cvt_pk_bf16_f32 v129, v22, v23
    v_mfma_f32_16x16x32_bf16 v[108:111], a[220:223], a[156:159], v[108:111]
    v_exp_f32 v24, v68
    v_mfma_f32_16x16x32_bf16 v[100:103], a[220:223], a[140:143], v[164:167]
    v_exp_f32 v25, v69
    v_mfma_f32_16x16x32_bf16 v[100:103], a[216:219], a[136:139], v[100:103]
    buffer_load_dwordx4 v7, s[28:31], s57 offen offset:3072 sc1 lds
    v_mfma_f32_16x16x32_bf16 v[100:103], a[212:215], a[132:135], v[100:103]
    s_add_u32 s57, s57, 16384
    v_exp_f32 v26, v70
    v_cvt_pk_bf16_f32 v130, v24, v25
    v_mfma_f32_16x16x32_bf16 v[100:103], a[208:211], a[128:131], v[100:103]
    s_waitcnt vmcnt(24) lgkmcnt(0)
    v_add_u32 v6, s58, v2
    v_exp_f32 v27, v71
    v_mfma_f32_16x16x32_bf16 a[0:3], a[224:227], v[144:147], a[0:3]
    s_barrier
    v_mfma_f32_16x16x32_bf16 a[32:35], a[224:227], v[148:151], a[32:35]
    ds_read_b128 a[192:195], v6 offset:0
    v_cvt_pk_bf16_f32 v131, v26, v27
    v_mfma_f32_16x16x32_bf16 a[36:39], a[228:231], v[148:151], a[36:39]
    v_exp_f32 v20, v72
    v_mfma_f32_16x16x32_bf16 v[28:31], v[44:47], v[128:131], 0
    v_exp_f32 v21, v73
    v_mfma_f32_16x16x32_bf16 a[4:7], a[228:231], v[144:147], a[4:7]
    ds_read_b128 a[196:199], v6 offset:1024
    v_cvt_pk_bf16_f32 v132, v20, v21
    v_mfma_f32_16x16x32_bf16 a[8:11], a[232:235], v[144:147], a[8:11]
    v_exp_f32 v22, v74
    v_mfma_f32_16x16x32_bf16 a[40:43], a[232:235], v[148:151], a[40:43]
    ds_read_b128 a[200:203], v6 offset:2048
    v_exp_f32 v23, v75
    v_mfma_f32_16x16x32_bf16 a[44:47], a[236:239], v[148:151], a[44:47]
    v_exp_f32 v24, v76
    v_mfma_f32_16x16x32_bf16 a[12:15], a[236:239], v[144:147], a[12:15]
    ds_read_b128 a[204:207], v6 offset:3072
    v_cvt_pk_bf16_f32 v133, v22, v23
    v_mfma_f32_16x16x32_bf16 a[16:19], a[240:243], v[144:147], a[16:19]
    v_exp_f32 v25, v77
    v_mfma_f32_16x16x32_bf16 a[48:51], a[240:243], v[148:151], a[48:51]
    v_exp_f32 v26, v78
    v_cvt_pk_bf16_f32 v134, v24, v25
    v_mfma_f32_16x16x32_bf16 a[52:55], a[244:247], v[148:151], a[52:55]
    v_exp_f32 v27, v79
    v_mfma_f32_16x16x32_bf16 a[20:23], a[244:247], v[144:147], a[20:23]
    ds_read_b128 a[208:211], v6 offset:4096
    v_cvt_pk_bf16_f32 v135, v26, v27
    s_nop 1
    v_mfma_f32_16x16x32_bf16 v[32:35], v[44:47], v[132:135], 0
    s_nop 2
    v_mfma_f32_16x16x32_bf16 a[24:27], a[248:251], v[144:147], a[24:27]
    ds_read_b128 a[212:215], v6 offset:5120
    s_nop 0
    v_mfma_f32_16x16x32_bf16 a[56:59], a[248:251], v[148:151], a[56:59]
    ds_read_b128 a[216:219], v6 offset:6144
    v_max_f32 v8, v28, v32
    v_mfma_f32_16x16x32_bf16 a[60:63], a[252:255], v[148:151], a[60:63]
    ds_read_b128 a[220:223], v6 offset:7168
    v_cmp_nge_f32 vcc, s66, v8
    v_mfma_f32_16x16x32_bf16 a[28:31], a[252:255], v[144:147], a[28:31]
    s_waitcnt lgkmcnt(4)
    s_cbranch_vccz m_single119
    v_cmp_lt_f32 vcc, s65, v8
    s_cmp_lg_u32 s64, s70
    s_cbranch_scc1 m_e124
    v_add_f32 v160, v160, v16
    v_mov_b32 v164, v9
    v_add_f32 v172, v172, v16
    v_add_f32 v161, v161, v17
    v_mov_b32 v165, v9
    v_add_f32 v173, v173, v17
    v_add_f32 v162, v162, v18
    v_mov_b32 v166, v9
    v_add_f32 v174, v174, v18
    v_add_f32 v163, v163, v19
    v_mov_b32 v167, v9
    v_add_f32 v175, v175, v19
    s_nop 0
m_e124:
    s_cmp_lg_u32 s64, s71
    s_cbranch_scc1 m_e125
    v_mov_b32 v160, v9
    v_mov_b32 v168, v9
    v_mov_b32 v172, v9
    v_mov_b32 v161, v9
    v_mov_b32 v169, v9
    v_mov_b32 v173, v9
    v_mov_b32 v162, v9
    v_mov_b32 v170, v9
    v_mov_b32 v174, v9
    v_mov_b32 v163, v9
    v_mov_b32 v171, v9
    v_mov_b32 v175, v9
    s_nop 0
m_e125:
    s_cmp_lg_u32 s64, s53
    s_cbranch_scc1 m_e128
    s_cmp_lg_u32 s16, 0
    s_cbranch_scc1 m_np129
    v_mov_b32 v60, s4
    v_mov_b32 v61, s5
    s_add_u32 s90, s101, 117440512
    s_mov_b64 exec, 1
    buffer_store_dwordx2 v[60:61], off, s[8:11], s90 sc1
    s_mov_b64 exec, -1
m_np129:
    s_mov_b32 s101, -1
m_e128:
    s_cmp_gt_u32 s64, 24
    s_cbranch_scc1 m_e126
    s_cmp_lg_u32 s64, 8
    s_cbranch_scc1 m_e130
    s_lshr_b32 s90, s32, 1
    s_lshl_b32 s90, s90, 7
    s_add_u32 s90, s90, 117440600
    v_min_u32 v0, 1, v1
    v_lshlrev_b32 v0, 5, v0
    buffer_load_dwordx2 v[4:5], v0, s[8:11], s90 offen sc1
    s_cmp_eq_u32 s17, -1
    s_cbranch_scc1 m_e126
    s_cmp_lg_u32 s16, 0
    s_cbranch_scc1 m_np131
    v_mov_b32 v60, s4
    v_mov_b32 v61, s5
    s_add_u32 s90, s17, 117440512
    s_mov_b64 exec, 1
    buffer_store_dwordx2 v[60:61], off, s[8:11], s90 sc1
    s_mov_b64 exec, -1
m_np131:
    s_branch m_e126
m_e130:
    s_cmp_lg_u32 s64, 16
    s_cbranch_scc1 m_e132
    s_waitcnt vmcnt(18)
    s_mov_b32 s3, 1048576
m_spin133:
    v_cmp_ne_u64 s[76:77], s[4:5], v[4:5]
    s_nop 3
    s_cmp_eq_u64 s[76:77], 0
    s_cbranch_scc1 m_e126
    s_sub_u32 s3, s3, 1
    s_cbranch_scc1 m_e126
    s_sleep 32
    s_lshr_b32 s90, s32, 1
    s_lshl_b32 s90, s90, 7
    s_add_u32 s90, s90, 117440600
    v_min_u32 v0, 1, v1
    v_lshlrev_b32 v0, 5, v0
    buffer_load_dwordx2 v[4:5], v0, s[8:11], s90 offen sc1
    s_waitcnt vmcnt(0)
    s_branch m_spin133
    s_branch m_e126
m_e132:
    s_cmp_lg_u32 s64, 20
    s_cbranch_scc1 m_e134
    buffer_load_dwordx2 v[4:5], v10, s[8:11], 0 offen sc1
    s_mov_b32 s44, s48
    s_mov_b32 s45, s49
    s_mov_b32 s46, 8388608
    s_lshl_b32 s90, s2, 2
    s_add_u32 s90, s90, s16
    s_lshl_b32 s90, s90, 13
    v_lshlrev_b32 v62, 7, v1
    buffer_load_dword v255, v62, s[44:47], s90 offen
    s_branch m_e126
m_e134:
    s_cmp_lg_u32 s64, 24
    s_cbranch_scc1 m_e135
    s_mov_b32 s44, s50
    s_mov_b32 s45, s51
    s_mov_b32 s46, 2097152
    s_lshl_b32 s90, s2, 2
    s_add_u32 s90, s90, s16
    s_lshl_b32 s90, s90, 13
    v_lshlrev_b32 v62, 7, v1
    buffer_load_dword v255, v62, s[44:47], s90 offen
    s_waitcnt vmcnt(18)
    s_mov_b32 s3, 1048576
m_spin136:
    v_cmp_ne_u64 s[76:77], s[4:5], v[4:5]
    s_nop 3
    s_cmp_eq_u64 s[76:77], 0
    s_cbranch_scc1 m_e126
    s_sub_u32 s3, s3, 1
    s_cbranch_scc1 m_e126
    s_sleep 32
    buffer_load_dwordx2 v[4:5], v10, s[8:11], 0 offen sc1
    s_waitcnt vmcnt(0)
    s_branch m_spin136
    s_branch m_e126
m_e135:
m_e126:
    s_cbranch_vccnz m_rc137
m_sp123:
    s_cmp_lg_u32 s64, s72
    s_cbranch_scc1 m_single119
m_singlex120:
    s_bfe_u32 s95, s2, 0x10002
    s_and_b32 s90, s2, 7
    s_bitcmp1_b32 0x63, s90
    s_cselect_b32 s96, s33, s34
    s_sub_u32 s96, s96, 1
    s_and_b32 s90, s2, 1
    s_lshl_b32 s90, s90, 2
    s_bfe_u32 s91, s2, 0x20003
    s_add_u32 s97, s90, s91
    v_and_b32 v10, 31, v1
    v_lshlrev_b32 v10, 3, v10
    s_lshl_b32 s52, s96, 8
    s_add_u32 s52, s52, 117448704
    buffer_load_dwordx2 v[4:5], v10, s[8:11], s52 offen sc1
    ds_read_b128 a[224:227], v6 offset:16384
    ds_read_b128 a[228:231], v6 offset:17408
    ds_read_b128 a[232:235], v6 offset:18432
    ds_read_b128 a[236:239], v6 offset:19456
    ds_read_b128 a[240:243], v6 offset:20480
    ds_read_b128 a[244:247], v6 offset:21504
    ds_read_b128 a[248:251], v6 offset:22528
    ds_read_b128 a[252:255], v6 offset:23552
    s_waitcnt lgkmcnt(0)
    v_mfma_f32_16x16x32_bf16 a[0:3], a[224:227], v[128:131], a[0:3]
    buffer_load_dwordx4 v[192:195], v2, s[8:11], s83 offen offset:0 sc1
    v_exp_f32 v20, v96
    v_mfma_f32_16x16x32_bf16 a[32:35], a[224:227], v[132:135], a[32:35]
    v_exp_f32 v21, v97
    v_exp_f32 v22, v98
    v_mfma_f32_16x16x32_bf16 a[36:39], a[228:231], v[132:135], a[36:39]
    buffer_load_dwordx4 v[196:199], v2, s[8:11], s83 offen offset:1024 sc1
    v_cvt_pk_bf16_f32 v144, v20, v21
    v_add_f32 v12, v12, v28
    v_mfma_f32_16x16x32_bf16 a[4:7], a[228:231], v[128:131], a[4:7]
    v_exp_f32 v23, v99
    v_exp_f32 v24, v100
    v_cvt_pk_bf16_f32 v145, v22, v23
    v_mfma_f32_16x16x32_bf16 a[8:11], a[232:235], v[128:131], a[8:11]
    buffer_load_dwordx4 v[200:203], v2, s[8:11], s83 offen offset:2048 sc1
    v_exp_f32 v25, v101
    v_mfma_f32_16x16x32_bf16 a[40:43], a[232:235], v[132:135], a[40:43]
    v_exp_f32 v26, v102
    v_cvt_pk_bf16_f32 v146, v24, v25
    v_add_f32 v13, v13, v32
    v_mfma_f32_16x16x32_bf16 a[44:47], a[236:239], v[132:135], a[44:47]
    buffer_load_dwordx4 v[204:207], v2, s[8:11], s83 offen offset:3072 sc1
    v_exp_f32 v27, v103
    v_mfma_f32_16x16x32_bf16 a[12:15], a[236:239], v[128:131], a[12:15]
    v_exp_f32 v20, v104
    v_cvt_pk_bf16_f32 v147, v26, v27
    v_mfma_f32_16x16x32_bf16 a[16:19], a[240:243], v[128:131], a[16:19]
    buffer_load_dwordx4 v[212:215], v2, s[8:11], s84 offen offset:0 sc1
    v_exp_f32 v21, v105
    v_mfma_f32_16x16x32_bf16 v[28:31], v[44:47], v[144:147], 0
    v_exp_f32 v22, v106
    v_cvt_pk_bf16_f32 v148, v20, v21
    v_exp_f32 v23, v107
    v_mfma_f32_16x16x32_bf16 a[48:51], a[240:243], v[132:135], a[48:51]
    v_exp_f32 v24, v108
    v_cvt_pk_bf16_f32 v149, v22, v23
    v_exp_f32 v25, v109
    v_mfma_f32_16x16x32_bf16 a[52:55], a[244:247], v[132:135], a[52:55]
    buffer_load_dwordx4 v[216:219], v2, s[8:11], s84 offen offset:1024 sc1
    v_exp_f32 v26, v110
    v_mfma_f32_16x16x32_bf16 a[20:23], a[244:247], v[128:131], a[20:23]
    v_cvt_pk_bf16_f32 v150, v24, v25
    v_exp_f32 v27, v111
    s_nop 0
    v_cvt_pk_bf16_f32 v151, v26, v27
    s_nop 1
    v_mfma_f32_16x16x32_bf16 v[32:35], v[44:47], v[148:151], 0
    s_nop 2
    v_mfma_f32_16x16x32_bf16 a[24:27], a[248:251], v[128:131], a[24:27]
    buffer_load_dwordx4 v[220:223], v2, s[8:11], s84 offen offset:2048 sc1
    v_mfma_f32_16x16x32_bf16 a[56:59], a[248:251], v[132:135], a[56:59]
    s_nop 2
    v_mfma_f32_16x16x32_bf16 a[60:63], a[252:255], v[132:135], a[60:63]
    v_max_f32 v8, v28, v32
    v_cmp_nge_f32 vcc, s65, v8
    v_mfma_f32_16x16x32_bf16 a[28:31], a[252:255], v[128:131], a[28:31]
    s_cbranch_vccnz m_stub138
m_ret139:
    s_nop 1
    s_cmp_ge_u32 s16, 2
    s_cbranch_scc1 m_xb140
    s_waitcnt vmcnt(24)
    s_barrier
m_xb140:
    ds_read_b128 a[224:227], v6 offset:24576
    ds_read_b128 a[228:231], v6 offset:25600
    ds_read_b128 a[232:235], v6 offset:26624
    ds_read_b128 a[236:239], v6 offset:27648
    ds_read_b128 a[240:243], v6 offset:28672
    ds_read_b128 a[244:247], v6 offset:29696
    ds_read_b128 a[248:251], v6 offset:30720
    ds_read_b128 a[252:255], v6 offset:31744
    s_waitcnt lgkmcnt(0)
    v_mfma_f32_16x16x32_bf16 a[0:3], a[224:227], v[144:147], a[0:3]
    buffer_load_dwordx4 v[224:227], v2, s[8:11], s84 offen offset:3072 sc1
    v_mfma_f32_16x16x32_bf16 a[32:35], a[224:227], v[148:151], a[32:35]
    v_mfma_f32_16x16x32_bf16 a[36:39], a[228:231], v[148:151], a[36:39]
    buffer_load_dwordx4 v[208:211], v2, s[8:11], s85 offen offset:0 sc1
    v_mfma_f32_16x16x32_bf16 a[4:7], a[228:231], v[144:147], a[4:7]
    v_mfma_f32_16x16x32_bf16 a[8:11], a[232:235], v[144:147], a[8:11]
    buffer_load_dwordx4 v[232:235], v2, s[8:11], s86 offen offset:0 sc1
    v_mfma_f32_16x16x32_bf16 a[40:43], a[232:235], v[148:151], a[40:43]
    v_mfma_f32_16x16x32_bf16 a[44:47], a[236:239], v[148:151], a[44:47]
    buffer_load_dwordx4 v[236:239], v2, s[8:11], s86 offen offset:1024 sc1
    v_mfma_f32_16x16x32_bf16 a[12:15], a[236:239], v[144:147], a[12:15]
    v_mfma_f32_16x16x32_bf16 a[16:19], a[240:243], v[144:147], a[16:19]
    buffer_load_dwordx4 v[228:231], v2, s[8:11], s87 offen offset:0 sc1
    v_mfma_f32_16x16x32_bf16 a[48:51], a[240:243], v[148:151], a[48:51]
    v_mfma_f32_16x16x32_bf16 a[52:55], a[244:247], v[148:151], a[52:55]
    buffer_load_dwordx4 v[244:247], v2, s[8:11], s88 offen offset:0 sc1
    v_mfma_f32_16x16x32_bf16 a[20:23], a[244:247], v[144:147], a[20:23]
    v_mfma_f32_16x16x32_bf16 a[24:27], a[248:251], v[144:147], a[24:27]
    buffer_load_dwordx4 v[248:251], v2, s[8:11], s88 offen offset:1024 sc1
    v_mfma_f32_16x16x32_bf16 a[56:59], a[248:251], v[148:151], a[56:59]
    v_mfma_f32_16x16x32_bf16 a[60:63], a[252:255], v[148:151], a[60:63]
    buffer_load_dwordx4 v[240:243], v2, s[8:11], s89 offen offset:0 sc1
    v_mfma_f32_16x16x32_bf16 a[28:31], a[252:255], v[144:147], a[28:31]
    v_add_f32 v20, v12, v28
    v_add_f32 v21, v13, v32
    s_nop 3
    v_rcp_f32 v20, v20
    v_rcp_f32 v21, v21
    s_lshl_b32 s90, s78, 10
    s_add_u32 s90, s90, s82
    s_add_u32 s90, s90, 67108864
    v_accvgpr_read_b32 v48, a0
    v_accvgpr_read_b32 v49, a1
    v_accvgpr_read_b32 v50, a2
    v_accvgpr_read_b32 v51, a3
    v_accvgpr_read_b32 v52, a4
    v_accvgpr_read_b32 v53, a5
    v_accvgpr_read_b32 v54, a6
    v_accvgpr_read_b32 v55, a7
    v_mul_f32 v48, v20, v48
    v_mul_f32 v49, v20, v49
    v_mul_f32 v50, v20, v50
    v_mul_f32 v51, v20, v51
    v_mul_f32 v52, v20, v52
    v_mul_f32 v53, v20, v53
    v_mul_f32 v54, v20, v54
    v_mul_f32 v55, v20, v55
    v_cvt_pk_bf16_f32 v48, v48, v49
    v_cvt_pk_bf16_f32 v49, v50, v51
    v_cvt_pk_bf16_f32 v50, v52, v53
    v_cvt_pk_bf16_f32 v51, v54, v55
    buffer_store_dwordx4 v[48:51], v2, s[8:11], s90 offen offset:0 sc1
    v_accvgpr_read_b32 v56, a32
    v_accvgpr_read_b32 v57, a33
    v_accvgpr_read_b32 v58, a34
    v_accvgpr_read_b32 v59, a35
    v_accvgpr_read_b32 v60, a36
    v_accvgpr_read_b32 v61, a37
    v_accvgpr_read_b32 v62, a38
    v_accvgpr_read_b32 v63, a39
    v_mul_f32 v56, v21, v56
    v_mul_f32 v57, v21, v57
    v_mul_f32 v58, v21, v58
    v_mul_f32 v59, v21, v59
    v_mul_f32 v60, v21, v60
    v_mul_f32 v61, v21, v61
    v_mul_f32 v62, v21, v62
    v_mul_f32 v63, v21, v63
    v_cvt_pk_bf16_f32 v56, v56, v57
    v_cvt_pk_bf16_f32 v57, v58, v59
    v_cvt_pk_bf16_f32 v58, v60, v61
    v_cvt_pk_bf16_f32 v59, v62, v63
    buffer_store_dwordx4 v[56:59], v2, s[8:11], s90 offen offset:1024 sc1
    s_add_u32 s90, s90, 131072
    v_accvgpr_read_b32 v48, a8
    v_accvgpr_read_b32 v49, a9
    v_accvgpr_read_b32 v50, a10
    v_accvgpr_read_b32 v51, a11
    v_accvgpr_read_b32 v52, a12
    v_accvgpr_read_b32 v53, a13
    v_accvgpr_read_b32 v54, a14
    v_accvgpr_read_b32 v55, a15
    v_mul_f32 v48, v20, v48
    v_mul_f32 v49, v20, v49
    v_mul_f32 v50, v20, v50
    v_mul_f32 v51, v20, v51
    v_mul_f32 v52, v20, v52
    v_mul_f32 v53, v20, v53
    v_mul_f32 v54, v20, v54
    v_mul_f32 v55, v20, v55
    v_cvt_pk_bf16_f32 v48, v48, v49
    v_cvt_pk_bf16_f32 v49, v50, v51
    v_cvt_pk_bf16_f32 v50, v52, v53
    v_cvt_pk_bf16_f32 v51, v54, v55
    buffer_store_dwordx4 v[48:51], v2, s[8:11], s90 offen offset:0 sc1
    v_accvgpr_read_b32 v56, a40
    v_accvgpr_read_b32 v57, a41
    v_accvgpr_read_b32 v58, a42
    v_accvgpr_read_b32 v59, a43
    v_accvgpr_read_b32 v60, a44
    v_accvgpr_read_b32 v61, a45
    v_accvgpr_read_b32 v62, a46
    v_accvgpr_read_b32 v63, a47
    v_mul_f32 v56, v21, v56
    v_mul_f32 v57, v21, v57
    v_mul_f32 v58, v21, v58
    v_mul_f32 v59, v21, v59
    v_mul_f32 v60, v21, v60
    v_mul_f32 v61, v21, v61
    v_mul_f32 v62, v21, v62
    v_mul_f32 v63, v21, v63
    v_cvt_pk_bf16_f32 v56, v56, v57
    v_cvt_pk_bf16_f32 v57, v58, v59
    v_cvt_pk_bf16_f32 v58, v60, v61
    v_cvt_pk_bf16_f32 v59, v62, v63
    buffer_store_dwordx4 v[56:59], v2, s[8:11], s90 offen offset:1024 sc1
    s_add_u32 s90, s90, 131072
    v_accvgpr_read_b32 v48, a16
    v_accvgpr_read_b32 v49, a17
    v_accvgpr_read_b32 v50, a18
    v_accvgpr_read_b32 v51, a19
    v_accvgpr_read_b32 v52, a20
    v_accvgpr_read_b32 v53, a21
    v_accvgpr_read_b32 v54, a22
    v_accvgpr_read_b32 v55, a23
    v_mul_f32 v48, v20, v48
    v_mul_f32 v49, v20, v49
    v_mul_f32 v50, v20, v50
    v_mul_f32 v51, v20, v51
    v_mul_f32 v52, v20, v52
    v_mul_f32 v53, v20, v53
    v_mul_f32 v54, v20, v54
    v_mul_f32 v55, v20, v55
    v_cvt_pk_bf16_f32 v48, v48, v49
    v_cvt_pk_bf16_f32 v49, v50, v51
    v_cvt_pk_bf16_f32 v50, v52, v53
    v_cvt_pk_bf16_f32 v51, v54, v55
    buffer_store_dwordx4 v[48:51], v2, s[8:11], s90 offen offset:0 sc1
    v_accvgpr_read_b32 v56, a48
    v_accvgpr_read_b32 v57, a49
    v_accvgpr_read_b32 v58, a50
    v_accvgpr_read_b32 v59, a51
    v_accvgpr_read_b32 v60, a52
    v_accvgpr_read_b32 v61, a53
    v_accvgpr_read_b32 v62, a54
    v_accvgpr_read_b32 v63, a55
    v_mul_f32 v56, v21, v56
    v_mul_f32 v57, v21, v57
    v_mul_f32 v58, v21, v58
    v_mul_f32 v59, v21, v59
    v_mul_f32 v60, v21, v60
    v_mul_f32 v61, v21, v61
    v_mul_f32 v62, v21, v62
    v_mul_f32 v63, v21, v63
    v_cvt_pk_bf16_f32 v56, v56, v57
    v_cvt_pk_bf16_f32 v57, v58, v59
    v_cvt_pk_bf16_f32 v58, v60, v61
    v_cvt_pk_bf16_f32 v59, v62, v63
    buffer_store_dwordx4 v[56:59], v2, s[8:11], s90 offen offset:1024 sc1
    s_add_u32 s90, s90, 131072
    v_accvgpr_read_b32 v48, a24
    v_accvgpr_read_b32 v49, a25
    v_accvgpr_read_b32 v50, a26
    v_accvgpr_read_b32 v51, a27
    v_accvgpr_read_b32 v52, a28
    v_accvgpr_read_b32 v53, a29
    v_accvgpr_read_b32 v54, a30
    v_accvgpr_read_b32 v55, a31
    v_mul_f32 v48, v20, v48
    v_mul_f32 v49, v20, v49
    v_mul_f32 v50, v20, v50
    v_mul_f32 v51, v20, v51
    v_mul_f32 v52, v20, v52
    v_mul_f32 v53, v20, v53
    v_mul_f32 v54, v20, v54
    v_mul_f32 v55, v20, v55
    v_cvt_pk_bf16_f32 v48, v48, v49
    v_cvt_pk_bf16_f32 v49, v50, v51
    v_cvt_pk_bf16_f32 v50, v52, v53
    v_cvt_pk_bf16_f32 v51, v54, v55
    buffer_store_dwordx4 v[48:51], v2, s[8:11], s90 offen offset:0 sc1
    v_accvgpr_read_b32 v56, a56
    v_accvgpr_read_b32 v57, a57
    v_accvgpr_read_b32 v58, a58
    v_accvgpr_read_b32 v59, a59
    v_accvgpr_read_b32 v60, a60
    v_accvgpr_read_b32 v61, a61
    v_accvgpr_read_b32 v62, a62
    v_accvgpr_read_b32 v63, a63
    v_mul_f32 v56, v21, v56
    v_mul_f32 v57, v21, v57
    v_mul_f32 v58, v21, v58
    v_mul_f32 v59, v21, v59
    v_mul_f32 v60, v21, v60
    v_mul_f32 v61, v21, v61
    v_mul_f32 v62, v21, v62
    v_mul_f32 v63, v21, v63
    v_cvt_pk_bf16_f32 v56, v56, v57
    v_cvt_pk_bf16_f32 v57, v58, v59
    v_cvt_pk_bf16_f32 v58, v60, v61
    v_cvt_pk_bf16_f32 v59, v62, v63
    buffer_store_dwordx4 v[56:59], v2, s[8:11], s90 offen offset:1024 sc1
    s_add_u32 s90, s90, 131072
    s_lshr_b32 s53, s16, 1
    s_and_b32 s40, s16, 1
    s_mul_i32 s90, s95, 5242880
    s_lshl_b32 s57, s97, 8
    s_add_u32 s57, s57, s90
    v_lshrrev_b32 v20, 4, v1
    s_lshl_b32 s90, s16, 4
    v_add_u32 v21, s90, v20
    v_lshlrev_b32 v21, 11, v21
    v_lshlrev_b32 v20, 1, v20
    v_and_b32 v22, 15, v1
    v_xor_b32 v20, v20, v22
    v_xor_b32 v22, 0, v20
    v_lshl_add_u32 v16, v22, 4, v21
    v_xor_b32 v22, 8, v20
    v_lshl_add_u32 v17, v22, 4, v21
    v_add_u32 v17, 7168, v17
    v_xor_b32 v22, 0, v20
    v_lshl_add_u32 v18, v22, 4, v21
    v_add_u32 v18, 14336, v18
    v_xor_b32 v22, 8, v20
    v_lshl_add_u32 v19, v22, 4, v21
    v_add_u32 v19, 21504, v19
    s_mov_b32 s24, s48
    s_mov_b32 s25, s49
    s_mov_b32 s26, 8388608
    s_mov_b32 s38, 268435456
    s_mov_b32 s28, s54
    s_mov_b32 s29, s55
    s_mov_b32 s30, 8388608
    s_lshl_b32 s90, s96, 13
    s_lshl_b32 s91, s40, 12
    s_add_u32 s90, s90, s91
    s_lshl_b32 s91, s53, 17
    s_add_u32 s69, s90, s91
    s_mul_i32 s90, s95, 10485760
    s_add_u32 s56, s69, s90
    s_add_u32 s56, s56, 67108864
    s_add_u32 s69, s69, 83886080
    s_lshl_b32 s90, s53, 12
    v_add_u32 v6, s90, v2
    v_lshrrev_b32 v48, 2, v1
    v_lshlrev_b32 v48, 8, v48
    v_and_b32 v49, 3, v1
    v_lshl_add_u32 v48, v49, 3, v48
    v_add_u32 v48, 16384, v48
    v_bfe_u32 v49, v1, 2, 3
    s_lshl_b32 s90, s40, 2
    v_xor_b32 v49, s90, v49
    v_xor_b32 v50, 0, v49
    v_lshl_add_u32 v12, v50, 5, v48
    v_xor_b32 v50, 1, v49
    v_lshl_add_u32 v13, v50, 5, v48
    v_xor_b32 v50, 2, v49
    v_lshl_add_u32 v14, v50, 5, v48
    v_xor_b32 v50, 3, v49
    v_lshl_add_u32 v15, v50, 5, v48
    v_and_b32 v48, 15, v1
    v_lshlrev_b32 v48, 12, v48
    v_lshlrev_b32 v48, s95, v48
    v_bfe_u32 v49, v1, 4, 1
    v_lshl_add_u32 v48, v49, 5, v48
    v_lshrrev_b32 v49, 5, v1
    v_lshl_add_u32 v7, v49, 4, v48
    s_lshl_b32 s90, s96, 3
    s_lshl_b32 s91, s53, 2
    s_add_u32 s90, s90, s91
    s_lshl_b32 s91, s90, 16
    s_add_u32 s91, s91, 2048
    s_and_b32 s92, s90, 63
    s_lshl_b32 s92, s92, 17
    s_lshr_b32 s93, s90, 6
    s_lshl_b32 s93, s93, 12
    s_add_u32 s92, s92, s93
    s_cmp_eq_u32 s95, 1
    s_cselect_b32 s71, s92, s91
    s_lshl_b32 s72, 0x10000, s95
    s_lshl_b32 s92, s97, 8
    s_lshl_b32 s93, s40, 7
    s_add_u32 s71, s71, s92
    s_add_u32 s71, s71, s93
    v_mov_b64 v[64:65], 0
    v_mov_b64 v[66:67], 0
    v_mov_b64 v[68:69], 0
    v_mov_b64 v[70:71], 0
    v_mov_b64 v[72:73], 0
    v_mov_b64 v[74:75], 0
    v_mov_b64 v[76:77], 0
    v_mov_b64 v[78:79], 0
    v_mov_b64 v[80:81], 0
    v_mov_b64 v[82:83], 0
    v_mov_b64 v[84:85], 0
    v_mov_b64 v[86:87], 0
    v_mov_b64 v[88:89], 0
    v_mov_b64 v[90:91], 0
    v_mov_b64 v[92:93], 0
    v_mov_b64 v[94:95], 0
    v_mov_b64 v[96:97], 0
    v_mov_b64 v[98:99], 0
    v_mov_b64 v[100:101], 0
    v_mov_b64 v[102:103], 0
    v_mov_b64 v[104:105], 0
    v_mov_b64 v[106:107], 0
    v_mov_b64 v[108:109], 0
    v_mov_b64 v[110:111], 0
    v_mov_b64 v[112:113], 0
    v_mov_b64 v[114:115], 0
    v_mov_b64 v[116:117], 0
    v_mov_b64 v[118:119], 0
    v_mov_b64 v[120:121], 0
    v_mov_b64 v[122:123], 0
    v_mov_b64 v[124:125], 0
    v_mov_b64 v[126:127], 0
    v_and_b32 v48, 15, v1
    v_lshrrev_b32 v49, 4, v1
    v_lshlrev_b32 v49, 2, v49
    v_sub_u32 v48, v48, v49
    v_cmp_ge_i32 vcc, -9, v48
    v_subrev_u32 v50, 0, v48
    v_cmp_ge_u32 s[76:77], 7, v50
    s_nop 0
    v_cndmask_b32 v128, v9, 0, vcc
    v_cndmask_b32 v132, v9, 0, s[76:77]
    v_cmp_ge_i32 vcc, -8, v48
    v_subrev_u32 v50, 1, v48
    v_cmp_ge_u32 s[76:77], 7, v50
    s_nop 0
    v_cndmask_b32 v129, v9, 0, vcc
    v_cndmask_b32 v133, v9, 0, s[76:77]
    v_cmp_ge_i32 vcc, -7, v48
    v_subrev_u32 v50, 2, v48
    v_cmp_ge_u32 s[76:77], 7, v50
    s_nop 0
    v_cndmask_b32 v130, v9, 0, vcc
    v_cndmask_b32 v134, v9, 0, s[76:77]
    v_cmp_ge_i32 vcc, -6, v48
    v_subrev_u32 v50, 3, v48
    v_cmp_ge_u32 s[76:77], 7, v50
    s_nop 0
    v_cndmask_b32 v131, v9, 0, vcc
    v_cndmask_b32 v135, v9, 0, s[76:77]
    s_cmp_eq_u32 s81, 0
    s_cselect_b64 vcc, -1, 0
    s_nop 0
    v_cndmask_b32 v136, v128, v9, vcc
    v_cndmask_b32 v137, v129, v9, vcc
    v_cndmask_b32 v138, v130, v9, vcc
    v_cndmask_b32 v139, v131, v9, vcc
    s_lshl_b32 s90, s80, 10
    s_lshr_b32 s91, s2, 3
    s_lshl_b32 s91, s91, 17
    s_add_u32 s90, s90, s91
    s_add_u32 s80, s90, 83886080
    s_add_u32 s59, s60, 131072
    s_mov_b32 s58, 0
    s_mov_b32 s100, 32768
    s_mov_b32 s64, 0
    s_mov_b32 s67, 0
    s_waitcnt vmcnt(0)
    s_barrier
    s_lshl_b32 s91, s33, 5
    s_add_u32 s91, s91, s32
    s_lshl_b32 s91, s91, 3
    s_add_u32 s91, s91, 7936
    s_cmp_lg_u32 s16, 0
    s_cbranch_scc1 m_np141
    v_mov_b32 v60, s4
    v_mov_b32 v61, s5
    s_add_u32 s90, s91, 117440512
    s_mov_b64 exec, 1
    buffer_store_dwordx2 v[60:61], off, s[8:11], s90 sc1
    s_mov_b64 exec, -1
m_np141:
    s_cmp_eq_u32 s101, -1
    s_cbranch_scc1 m_pb142
    s_cmp_lg_u32 s16, 0
    s_cbranch_scc1 m_np144
    v_mov_b32 v60, s4
    v_mov_b32 v61, s5
    s_add_u32 s90, s101, 117440512
    s_mov_b64 exec, 1
    buffer_store_dwordx2 v[60:61], off, s[8:11], s90 sc1
    s_mov_b64 exec, -1
m_np144:
m_pb142:
    v_cmp_ne_u64 s[76:77], s[4:5], v[4:5]
    s_mul_i32 s91, s95, 20
    s_nop 2
    s_lshr_b32 s90, s76, s91
    s_ff1_i32_b32 s90, s90
    s_lshl_b32 s68, s90, 1
    s_mul_i32 s91, s95, 0
    s_sub_i32 s68, s68, s91
    s_cmp_lt_i32 s90, 0
    s_cselect_b32 s68, 1000, s68
    s_add_u32 m0, s60, 16384
    s_nop 0
    buffer_load_dwordx4 v16, s[24:27], s57 offen offset:0 sc1 lds
    buffer_load_dwordx4 v17, s[24:27], s57 offen offset:1024 sc1 lds
    buffer_load_dwordx4 v18, s[24:27], s57 offen offset:2048 sc1 lds
    buffer_load_dwordx4 v19, s[24:27], s57 offen offset:3072 sc1 lds
    s_add_u32 s57, s57, 131072
    s_add_u32 m0, s60, 49152
    s_nop 0
    buffer_load_dwordx4 v16, s[24:27], s57 offen offset:0 sc1 lds
    buffer_load_dwordx4 v17, s[24:27], s57 offen offset:1024 sc1 lds
    buffer_load_dwordx4 v18, s[24:27], s57 offen offset:2048 sc1 lds
    buffer_load_dwordx4 v19, s[24:27], s57 offen offset:3072 sc1 lds
    s_add_u32 s57, s57, 131072
    s_add_u32 m0, s60, 81920
    s_nop 0
    buffer_load_dwordx4 v16, s[24:27], s57 offen offset:0 sc1 lds
    buffer_load_dwordx4 v17, s[24:27], s57 offen offset:1024 sc1 lds
    buffer_load_dwordx4 v18, s[24:27], s57 offen offset:2048 sc1 lds
    buffer_load_dwordx4 v19, s[24:27], s57 offen offset:3072 sc1 lds
    s_add_u32 s57, s57, 131072
    s_add_u32 m0, s60, 114688
    s_nop 0
    buffer_load_dwordx4 v16, s[24:27], s57 offen offset:0 sc1 lds
    buffer_load_dwordx4 v17, s[24:27], s57 offen offset:1024 sc1 lds
    buffer_load_dwordx4 v18, s[24:27], s57 offen offset:2048 sc1 lds
    buffer_load_dwordx4 v19, s[24:27], s57 offen offset:3072 sc1 lds
    s_add_u32 s57, s57, 131072
    s_cmp_gt_i32 s68, 4
    s_cbranch_scc1 m_x3143
    s_mov_b32 s3, 1048576
m_spin145:
    buffer_load_dwordx2 v[4:5], v10, s[8:11], s52 offen sc1
    s_waitcnt vmcnt(0)
    v_cmp_ne_u64 s[76:77], s[4:5], v[4:5]
    s_mul_i32 s91, s95, 20
    s_nop 2
    s_lshr_b32 s90, s76, s91
    s_ff1_i32_b32 s90, s90
    s_lshl_b32 s68, s90, 1
    s_mul_i32 s91, s95, 0
    s_sub_i32 s68, s68, s91
    s_cmp_lt_i32 s90, 0
    s_cselect_b32 s68, 1000, s68
    s_cmp_gt_i32 s68, 4
    s_cbranch_scc1 m_ok146
    s_sub_u32 s3, s3, 1
    s_cbranch_scc1 m_ok146
    s_sleep 4
    s_branch m_spin145
m_ok146:
m_x3143:
    s_add_u32 m0, s60, 0
    s_nop 0
    buffer_load_dwordx4 v2, s[36:39], s56 offen offset:0 sc1 lds
    buffer_load_dwordx4 v2, s[36:39], s56 offen offset:1024 sc1 lds
    buffer_load_dwordx4 v2, s[36:39], s56 offen offset:2048 sc1 lds
    buffer_load_dwordx4 v2, s[36:39], s56 offen offset:3072 sc1 lds
    s_add_u32 s56, s56, 262144
    s_add_u32 m0, s60, 32768
    s_nop 0
    buffer_load_dwordx4 v2, s[36:39], s56 offen offset:0 sc1 lds
    buffer_load_dwordx4 v2, s[36:39], s56 offen offset:1024 sc1 lds
    buffer_load_dwordx4 v2, s[36:39], s56 offen offset:2048 sc1 lds
    buffer_load_dwordx4 v2, s[36:39], s56 offen offset:3072 sc1 lds
    s_add_u32 s56, s56, 262144
    s_add_u32 m0, s60, 65536
    s_nop 0
    buffer_load_dwordx4 v2, s[36:39], s56 offen offset:0 sc1 lds
    buffer_load_dwordx4 v2, s[36:39], s56 offen offset:1024 sc1 lds
    buffer_load_dwordx4 v2, s[36:39], s56 offen offset:2048 sc1 lds
    buffer_load_dwordx4 v2, s[36:39], s56 offen offset:3072 sc1 lds
    s_add_u32 s56, s56, 262144
    s_add_u32 m0, s60, 98304
    s_nop 0
    buffer_load_dwordx4 v2, s[36:39], s56 offen offset:0 sc1 lds
    buffer_load_dwordx4 v2, s[36:39], s56 offen offset:1024 sc1 lds
    buffer_load_dwordx4 v2, s[36:39], s56 offen offset:2048 sc1 lds
    buffer_load_dwordx4 v2, s[36:39], s56 offen offset:3072 sc1 lds
    s_add_u32 s56, s56, 262144
    s_add_u32 m0, s60, 131072
    s_nop 0
    buffer_load_dwordx4 v2, s[36:39], s56 offen offset:0 sc1 lds
    buffer_load_dwordx4 v2, s[36:39], s56 offen offset:1024 sc1 lds
    buffer_load_dwordx4 v2, s[36:39], s56 offen offset:2048 sc1 lds
    buffer_load_dwordx4 v2, s[36:39], s56 offen offset:3072 sc1 lds
    s_add_u32 s56, s56, 262144
    s_waitcnt vmcnt(16)
    s_barrier
    ds_read_b128 a[0:3], v6 offset:0
    ds_read_b64_tr_b16 a[16:17], v12 offset:0
    ds_read_b64_tr_b16 a[18:19], v12 offset:4096
    ds_read_b128 a[4:7], v6 offset:1024
    ds_read_b128 a[8:11], v6 offset:2048
    ds_read_b128 a[12:15], v6 offset:3072
    ds_read_b64_tr_b16 a[20:21], v13 offset:0
    ds_read_b64_tr_b16 a[22:23], v13 offset:4096
    ds_read_b64_tr_b16 a[24:25], v14 offset:0
    ds_read_b64_tr_b16 a[26:27], v14 offset:4096
    ds_read_b64_tr_b16 a[28:29], v15 offset:0
    ds_read_b64_tr_b16 a[30:31], v15 offset:4096
    s_cmp_gt_i32 s68, 5
    s_cbranch_scc0 m_lp152
m_lr153:
    s_waitcnt lgkmcnt(9)
    v_mfma_f32_16x16x32_bf16 v[64:67], a[16:19], a[0:3], v[64:67]
    s_add_u32 m0, s59, 16384
    ds_read_b128 a[32:35], v6 offset:8192
    v_mfma_f32_16x16x32_bf16 v[148:151], v[208:211], v[192:195], v[136:139]
    v_mfma_f32_16x16x32_bf16 v[152:155], v[212:215], v[192:195], v[132:135]
    s_waitcnt lgkmcnt(9)
    v_mfma_f32_16x16x32_bf16 v[72:75], a[16:19], a[4:7], v[72:75]
    ds_read_b64_tr_b16 a[48:49], v12 offset:8192
    buffer_load_dwordx4 v16, s[24:27], s57 offen offset:0 sc1 lds
    v_mfma_f32_16x16x32_bf16 v[156:159], v[212:215], v[196:199], v[128:131]
    s_waitcnt lgkmcnt(9)
    v_mfma_f32_16x16x32_bf16 v[80:83], a[16:19], a[8:11], v[80:83]
    s_add_u32 s59, s58, s60
    ds_read_b64_tr_b16 a[50:51], v12 offset:12288
    v_mfma_f32_16x16x32_bf16 v[160:163], v[216:219], v[196:199], v[132:135]
    v_mfma_f32_16x16x32_bf16 v[164:167], v[216:219], v[200:203], v[128:131]
    s_waitcnt lgkmcnt(9)
    v_mfma_f32_16x16x32_bf16 v[88:91], a[16:19], a[12:15], v[88:91]
    s_add_u32 s58, s58, 32768
    ds_read_b128 a[36:39], v6 offset:9216
    v_mfma_f32_16x16x32_bf16 v[168:171], v[220:223], v[200:203], v[132:135]
    v_mfma_f32_16x16x32_bf16 v[172:175], v[220:223], v[204:207], v[128:131]
    s_waitcnt lgkmcnt(8)
    v_mfma_f32_16x16x32_bf16 v[68:71], a[20:23], a[0:3], v[68:71]
    s_cmp_ge_u32 s58, 163840
    ds_read_b128 a[40:43], v6 offset:10240
    v_mfma_f32_16x16x32_bf16 v[176:179], v[224:227], v[204:207], v[132:135]
    s_nop 1
    v_mfma_f32_16x16x32_bf16 v[76:79], a[20:23], a[4:7], v[76:79]
    ds_read_b128 a[44:47], v6 offset:11264
    buffer_load_dwordx4 v17, s[24:27], s57 offen offset:1024 sc1 lds
    s_nop 1
    v_mfma_f32_16x16x32_bf16 v[84:87], a[20:23], a[8:11], v[84:87]
    s_cselect_b32 s66, 4294836224, s100
    ds_read_b64_tr_b16 a[52:53], v13 offset:8192
    s_nop 1
    s_nop 1
    v_mfma_f32_16x16x32_bf16 v[92:95], a[20:23], a[12:15], v[92:95]
    s_cselect_b32 s58, 0, s58
    ds_read_b64_tr_b16 a[54:55], v13 offset:12288
    v_max3_f32 v140, v148, v149, v150
    v_max3_f32 v141, v156, v157, v158
    s_waitcnt lgkmcnt(10)
    v_mfma_f32_16x16x32_bf16 v[96:99], a[24:27], a[0:3], v[96:99]
    ds_read_b64_tr_b16 a[56:57], v14 offset:8192
    v_max3_f32 v142, v164, v165, v166
    v_max3_f32 v143, v172, v173, v174
    v_mfma_f32_16x16x32_bf16 v[104:107], a[24:27], a[4:7], v[104:107]
    ds_read_b64_tr_b16 a[58:59], v14 offset:12288
    buffer_load_dwordx4 v18, s[24:27], s57 offen offset:2048 sc1 lds
    v_max3_f32 v140, v140, v151, v152
    v_mfma_f32_16x16x32_bf16 v[112:115], a[24:27], a[8:11], v[112:115]
    ds_read_b64_tr_b16 a[60:61], v15 offset:8192
    v_max3_f32 v141, v141, v159, v160
    v_max3_f32 v142, v142, v167, v168
    v_mfma_f32_16x16x32_bf16 v[120:123], a[24:27], a[12:15], v[120:123]
    ds_read_b64_tr_b16 a[62:63], v15 offset:12288
    v_max3_f32 v143, v143, v175, v176
    v_max3_f32 v140, v140, v153, v154
    s_waitcnt lgkmcnt(12)
    v_mfma_f32_16x16x32_bf16 v[100:103], a[28:31], a[0:3], v[100:103]
    v_add_u32 v6, s66, v6
    v_add_u32 v12, s66, v12
    v_max3_f32 v141, v141, v161, v162
    v_mfma_f32_16x16x32_bf16 v[108:111], a[28:31], a[4:7], v[108:111]
    buffer_load_dwordx4 v19, s[24:27], s57 offen offset:3072 sc1 lds
    v_max3_f32 v142, v142, v169, v170
    v_mfma_f32_16x16x32_bf16 v[116:119], a[28:31], a[8:11], v[116:119]
    s_add_u32 s57, s57, 131072
    v_add_u32 v13, s66, v13
    v_add_u32 v14, s66, v14
    v_max3_f32 v143, v143, v177, v178
    v_mfma_f32_16x16x32_bf16 v[124:127], a[28:31], a[12:15], v[124:127]
    s_mov_b32 m0, s59
    v_add_u32 v15, s66, v15
    v_max_f32 v140, v140, v155
    s_waitcnt vmcnt(16) lgkmcnt(0)
    v_mfma_f32_16x16x32_bf16 v[64:67], a[48:51], a[32:35], v[64:67]
    s_barrier
    v_max_f32 v141, v141, v163
    v_max_f32 v142, v142, v171
    v_mfma_f32_16x16x32_bf16 v[72:75], a[48:51], a[36:39], v[72:75]
    ds_read_b128 a[0:3], v6 offset:0
    buffer_load_dwordx4 v2, s[36:39], s56 offen offset:0 sc1 lds
    v_max_f32 v143, v143, v179
    v_mfma_f32_16x16x32_bf16 v[80:83], a[48:51], a[40:43], v[80:83]
    ds_read_b64_tr_b16 a[16:17], v12 offset:0
    v_mov_b32 v144, v140
    v_mov_b32 v145, v141
    v_mfma_f32_16x16x32_bf16 v[88:91], a[48:51], a[44:47], v[88:91]
    ds_read_b64_tr_b16 a[18:19], v12 offset:4096
    v_mov_b32 v146, v142
    v_mov_b32 v147, v143
    v_mfma_f32_16x16x32_bf16 v[68:71], a[52:55], a[32:35], v[68:71]
    ds_read_b128 a[4:7], v6 offset:1024
    s_nop 1
    v_permlane32_swap_b32 v140, v144
    v_mfma_f32_16x16x32_bf16 v[76:79], a[52:55], a[36:39], v[76:79]
    ds_read_b128 a[8:11], v6 offset:2048
    buffer_load_dwordx4 v2, s[36:39], s56 offen offset:1024 sc1 lds
    v_permlane32_swap_b32 v141, v145
    v_mfma_f32_16x16x32_bf16 v[84:87], a[52:55], a[40:43], v[84:87]
    ds_read_b128 a[12:15], v6 offset:3072
    v_permlane32_swap_b32 v142, v146
    v_permlane32_swap_b32 v143, v147
    v_mfma_f32_16x16x32_bf16 v[92:95], a[52:55], a[44:47], v[92:95]
    ds_read_b64_tr_b16 a[20:21], v13 offset:0
    s_nop 1
    v_max_f32 v140, v140, v144
    v_mfma_f32_16x16x32_bf16 v[96:99], a[56:59], a[32:35], v[96:99]
    ds_read_b64_tr_b16 a[22:23], v13 offset:4096
    v_max_f32 v141, v141, v145
    v_max_f32 v142, v142, v146
    v_mfma_f32_16x16x32_bf16 v[104:107], a[56:59], a[36:39], v[104:107]
    ds_read_b64_tr_b16 a[24:25], v14 offset:0
    buffer_load_dwordx4 v2, s[36:39], s56 offen offset:2048 sc1 lds
    v_max_f32 v143, v143, v147
    v_mfma_f32_16x16x32_bf16 v[112:115], a[56:59], a[40:43], v[112:115]
    ds_read_b64_tr_b16 a[26:27], v14 offset:4096
    v_mov_b32 v144, v140
    v_mov_b32 v145, v141
    v_mfma_f32_16x16x32_bf16 v[120:123], a[56:59], a[44:47], v[120:123]
    ds_read_b64_tr_b16 a[28:29], v15 offset:0
    v_mov_b32 v146, v142
    v_mov_b32 v147, v143
    v_mfma_f32_16x16x32_bf16 v[100:103], a[60:63], a[32:35], v[100:103]
    s_add_u32 s64, s64, 1
    ds_read_b64_tr_b16 a[30:31], v15 offset:4096
    s_nop 1
    v_permlane16_swap_b32 v140, v144
    v_mfma_f32_16x16x32_bf16 v[108:111], a[60:63], a[36:39], v[108:111]
    buffer_load_dwordx4 v2, s[36:39], s56 offen offset:3072 sc1 lds
    v_permlane16_swap_b32 v141, v145
    v_mfma_f32_16x16x32_bf16 v[116:119], a[60:63], a[40:43], v[116:119]
    s_add_u32 s56, s56, 262144
    v_permlane16_swap_b32 v142, v146
    v_permlane16_swap_b32 v143, v147
    v_mfma_f32_16x16x32_bf16 v[124:127], a[60:63], a[44:47], v[124:127]
    s_nop 1
    v_max_f32 v140, v140, v144
    s_cmp_gt_i32 s68, 6
    s_cbranch_scc0 m_lp154
m_lr155:
    s_waitcnt lgkmcnt(9)
    v_mfma_f32_16x16x32_bf16 v[64:67], a[16:19], a[0:3], v[64:67]
    s_add_u32 m0, s59, 16384
    ds_read_b128 a[32:35], v6 offset:8192
    v_max_f32 v141, v141, v145
    v_max_f32 v142, v142, v146
    s_waitcnt lgkmcnt(9)
    v_mfma_f32_16x16x32_bf16 v[72:75], a[16:19], a[4:7], v[72:75]
    ds_read_b64_tr_b16 a[48:49], v12 offset:8192
    buffer_load_dwordx4 v16, s[24:27], s57 offen offset:0 sc1 lds
    v_max_f32 v143, v143, v147
    s_waitcnt lgkmcnt(9)
    v_mfma_f32_16x16x32_bf16 v[80:83], a[16:19], a[8:11], v[80:83]
    s_add_u32 s59, s58, s60
    ds_read_b64_tr_b16 a[50:51], v12 offset:12288
    v_sub_f32 v148, v148, v140
    v_sub_f32 v149, v149, v140
    s_waitcnt lgkmcnt(9)
    v_mfma_f32_16x16x32_bf16 v[88:91], a[16:19], a[12:15], v[88:91]
    s_add_u32 s58, s58, 32768
    ds_read_b128 a[36:39], v6 offset:9216
    v_sub_f32 v150, v150, v140
    v_sub_f32 v151, v151, v140
    s_waitcnt lgkmcnt(8)
    v_mfma_f32_16x16x32_bf16 v[68:71], a[20:23], a[0:3], v[68:71]
    s_cmp_ge_u32 s58, 163840
    ds_read_b128 a[40:43], v6 offset:10240
    v_sub_f32 v152, v152, v140
    v_sub_f32 v153, v153, v140
    v_mfma_f32_16x16x32_bf16 v[76:79], a[20:23], a[4:7], v[76:79]
    ds_read_b128 a[44:47], v6 offset:11264
    buffer_load_dwordx4 v17, s[24:27], s57 offen offset:1024 sc1 lds
    v_sub_f32 v154, v154, v140
    v_mfma_f32_16x16x32_bf16 v[84:87], a[20:23], a[8:11], v[84:87]
    s_cselect_b32 s66, 4294836224, s100
    ds_read_b64_tr_b16 a[52:53], v13 offset:8192
    v_sub_f32 v155, v155, v140
    v_sub_f32 v156, v156, v141
    v_mfma_f32_16x16x32_bf16 v[92:95], a[20:23], a[12:15], v[92:95]
    s_cselect_b32 s58, 0, s58
    ds_read_b64_tr_b16 a[54:55], v13 offset:12288
    v_sub_f32 v157, v157, v141
    v_sub_f32 v158, v158, v141
    s_waitcnt lgkmcnt(10)
    v_mfma_f32_16x16x32_bf16 v[96:99], a[24:27], a[0:3], v[96:99]
    ds_read_b64_tr_b16 a[56:57], v14 offset:8192
    v_sub_f32 v159, v159, v141
    v_sub_f32 v160, v160, v141
    v_mfma_f32_16x16x32_bf16 v[104:107], a[24:27], a[4:7], v[104:107]
    ds_read_b64_tr_b16 a[58:59], v14 offset:12288
    buffer_load_dwordx4 v18, s[24:27], s57 offen offset:2048 sc1 lds
    v_sub_f32 v161, v161, v141
    v_mfma_f32_16x16x32_bf16 v[112:115], a[24:27], a[8:11], v[112:115]
    ds_read_b64_tr_b16 a[60:61], v15 offset:8192
    v_sub_f32 v162, v162, v141
    v_sub_f32 v163, v163, v141
    v_mfma_f32_16x16x32_bf16 v[120:123], a[24:27], a[12:15], v[120:123]
    ds_read_b64_tr_b16 a[62:63], v15 offset:12288
    v_sub_f32 v164, v164, v142
    v_sub_f32 v165, v165, v142
    s_waitcnt lgkmcnt(12)
    v_mfma_f32_16x16x32_bf16 v[100:103], a[28:31], a[0:3], v[100:103]
    v_add_u32 v6, s66, v6
    v_add_u32 v12, s66, v12
    v_sub_f32 v166, v166, v142
    v_mfma_f32_16x16x32_bf16 v[108:111], a[28:31], a[4:7], v[108:111]
    buffer_load_dwordx4 v19, s[24:27], s57 offen offset:3072 sc1 lds
    v_sub_f32 v167, v167, v142
    v_mfma_f32_16x16x32_bf16 v[116:119], a[28:31], a[8:11], v[116:119]
    s_add_u32 s57, s57, 131072
    v_add_u32 v13, s66, v13
    v_add_u32 v14, s66, v14
    v_sub_f32 v168, v168, v142
    v_mfma_f32_16x16x32_bf16 v[124:127], a[28:31], a[12:15], v[124:127]
    s_mov_b32 m0, s59
    v_add_u32 v15, s66, v15
    v_sub_f32 v169, v169, v142
    s_waitcnt vmcnt(20) lgkmcnt(0)
    v_mfma_f32_16x16x32_bf16 v[64:67], a[48:51], a[32:35], v[64:67]
    s_barrier
    v_sub_f32 v170, v170, v142
    v_sub_f32 v171, v171, v142
    v_mfma_f32_16x16x32_bf16 v[72:75], a[48:51], a[36:39], v[72:75]
    ds_read_b128 a[0:3], v6 offset:0
    buffer_load_dwordx4 v2, s[36:39], s56 offen offset:0 sc1 lds
    v_sub_f32 v172, v172, v143
    v_mfma_f32_16x16x32_bf16 v[80:83], a[48:51], a[40:43], v[80:83]
    ds_read_b64_tr_b16 a[16:17], v12 offset:0
    v_sub_f32 v173, v173, v143
    v_sub_f32 v174, v174, v143
    v_mfma_f32_16x16x32_bf16 v[88:91], a[48:51], a[44:47], v[88:91]
    ds_read_b64_tr_b16 a[18:19], v12 offset:4096
    v_sub_f32 v175, v175, v143
    v_sub_f32 v176, v176, v143
    v_mfma_f32_16x16x32_bf16 v[68:71], a[52:55], a[32:35], v[68:71]
    ds_read_b128 a[4:7], v6 offset:1024
    v_sub_f32 v177, v177, v143
    v_sub_f32 v178, v178, v143
    v_mfma_f32_16x16x32_bf16 v[76:79], a[52:55], a[36:39], v[76:79]
    ds_read_b128 a[8:11], v6 offset:2048
    buffer_load_dwordx4 v2, s[36:39], s56 offen offset:1024 sc1 lds
    v_sub_f32 v179, v179, v143
    v_mfma_f32_16x16x32_bf16 v[84:87], a[52:55], a[40:43], v[84:87]
    ds_read_b128 a[12:15], v6 offset:3072
    v_exp_f32 v148, v148
    v_exp_f32 v149, v149
    v_mfma_f32_16x16x32_bf16 v[92:95], a[52:55], a[44:47], v[92:95]
    ds_read_b64_tr_b16 a[20:21], v13 offset:0
    v_exp_f32 v150, v150
    v_exp_f32 v151, v151
    v_mfma_f32_16x16x32_bf16 v[96:99], a[56:59], a[32:35], v[96:99]
    ds_read_b64_tr_b16 a[22:23], v13 offset:4096
    v_exp_f32 v152, v152
    v_exp_f32 v153, v153
    v_mfma_f32_16x16x32_bf16 v[104:107], a[56:59], a[36:39], v[104:107]
    ds_read_b64_tr_b16 a[24:25], v14 offset:0
    buffer_load_dwordx4 v2, s[36:39], s56 offen offset:2048 sc1 lds
    v_exp_f32 v154, v154
    v_mfma_f32_16x16x32_bf16 v[112:115], a[56:59], a[40:43], v[112:115]
    ds_read_b64_tr_b16 a[26:27], v14 offset:4096
    v_exp_f32 v155, v155
    v_exp_f32 v156, v156
    v_mfma_f32_16x16x32_bf16 v[120:123], a[56:59], a[44:47], v[120:123]
    ds_read_b64_tr_b16 a[28:29], v15 offset:0
    v_exp_f32 v157, v157
    v_exp_f32 v158, v158
    v_mfma_f32_16x16x32_bf16 v[100:103], a[60:63], a[32:35], v[100:103]
    s_add_u32 s64, s64, 1
    ds_read_b64_tr_b16 a[30:31], v15 offset:4096
    v_exp_f32 v159, v159
    v_exp_f32 v160, v160
    v_mfma_f32_16x16x32_bf16 v[108:111], a[60:63], a[36:39], v[108:111]
    buffer_load_dwordx4 v2, s[36:39], s56 offen offset:3072 sc1 lds
    v_exp_f32 v161, v161
    v_mfma_f32_16x16x32_bf16 v[116:119], a[60:63], a[40:43], v[116:119]
    s_add_u32 s56, s56, 262144
    v_exp_f32 v162, v162
    v_exp_f32 v163, v163
    v_mfma_f32_16x16x32_bf16 v[124:127], a[60:63], a[44:47], v[124:127]
    v_exp_f32 v164, v164
    v_exp_f32 v165, v165
    s_cmp_gt_i32 s68, 7
    s_cbranch_scc0 m_lp156
m_lr157:
    s_waitcnt lgkmcnt(9)
    v_mfma_f32_16x16x32_bf16 v[64:67], a[16:19], a[0:3], v[64:67]
    s_add_u32 m0, s59, 16384
    ds_read_b128 a[32:35], v6 offset:8192
    v_exp_f32 v166, v166
    v_exp_f32 v167, v167
    s_waitcnt lgkmcnt(9)
    v_mfma_f32_16x16x32_bf16 v[72:75], a[16:19], a[4:7], v[72:75]
    ds_read_b64_tr_b16 a[48:49], v12 offset:8192
    buffer_load_dwordx4 v16, s[24:27], s57 offen offset:0 sc1 lds
    v_exp_f32 v168, v168
    s_waitcnt lgkmcnt(9)
    v_mfma_f32_16x16x32_bf16 v[80:83], a[16:19], a[8:11], v[80:83]
    s_add_u32 s59, s58, s60
    ds_read_b64_tr_b16 a[50:51], v12 offset:12288
    v_exp_f32 v169, v169
    v_exp_f32 v170, v170
    s_waitcnt lgkmcnt(9)
    v_mfma_f32_16x16x32_bf16 v[88:91], a[16:19], a[12:15], v[88:91]
    s_add_u32 s58, s58, 32768
    ds_read_b128 a[36:39], v6 offset:9216
    v_exp_f32 v171, v171
    v_exp_f32 v172, v172
    s_waitcnt lgkmcnt(8)
    v_mfma_f32_16x16x32_bf16 v[68:71], a[20:23], a[0:3], v[68:71]
    s_cmp_ge_u32 s58, 163840
    ds_read_b128 a[40:43], v6 offset:10240
    v_exp_f32 v173, v173
    v_exp_f32 v174, v174
    v_mfma_f32_16x16x32_bf16 v[76:79], a[20:23], a[4:7], v[76:79]
    ds_read_b128 a[44:47], v6 offset:11264
    buffer_load_dwordx4 v17, s[24:27], s57 offen offset:1024 sc1 lds
    v_exp_f32 v175, v175
    v_mfma_f32_16x16x32_bf16 v[84:87], a[20:23], a[8:11], v[84:87]
    s_cselect_b32 s66, 4294836224, s100
    ds_read_b64_tr_b16 a[52:53], v13 offset:8192
    v_exp_f32 v176, v176
    v_exp_f32 v177, v177
    v_mfma_f32_16x16x32_bf16 v[92:95], a[20:23], a[12:15], v[92:95]
    s_cselect_b32 s58, 0, s58
    ds_read_b64_tr_b16 a[54:55], v13 offset:12288
    v_exp_f32 v178, v178
    v_exp_f32 v179, v179
    s_waitcnt lgkmcnt(10)
    v_mfma_f32_16x16x32_bf16 v[96:99], a[24:27], a[0:3], v[96:99]
    ds_read_b64_tr_b16 a[56:57], v14 offset:8192
    v_cvt_pk_bf16_f32 v192, v148, v149
    v_cvt_pk_bf16_f32 v193, v150, v151
    v_mfma_f32_16x16x32_bf16 v[104:107], a[24:27], a[4:7], v[104:107]
    ds_read_b64_tr_b16 a[58:59], v14 offset:12288
    buffer_load_dwordx4 v18, s[24:27], s57 offen offset:2048 sc1 lds
    v_cvt_pk_bf16_f32 v194, v152, v153
    v_mfma_f32_16x16x32_bf16 v[112:115], a[24:27], a[8:11], v[112:115]
    ds_read_b64_tr_b16 a[60:61], v15 offset:8192
    v_cvt_pk_bf16_f32 v195, v154, v155
    v_cvt_pk_bf16_f32 v196, v156, v157
    v_mfma_f32_16x16x32_bf16 v[120:123], a[24:27], a[12:15], v[120:123]
    ds_read_b64_tr_b16 a[62:63], v15 offset:12288
    v_cvt_pk_bf16_f32 v197, v158, v159
    v_cvt_pk_bf16_f32 v198, v160, v161
    s_waitcnt lgkmcnt(12)
    v_mfma_f32_16x16x32_bf16 v[100:103], a[28:31], a[0:3], v[100:103]
    v_add_u32 v6, s66, v6
    v_add_u32 v12, s66, v12
    v_cvt_pk_bf16_f32 v199, v162, v163
    v_mfma_f32_16x16x32_bf16 v[108:111], a[28:31], a[4:7], v[108:111]
    buffer_load_dwordx4 v19, s[24:27], s57 offen offset:3072 sc1 lds
    v_cvt_pk_bf16_f32 v200, v164, v165
    v_mfma_f32_16x16x32_bf16 v[116:119], a[28:31], a[8:11], v[116:119]
    s_add_u32 s57, s57, 131072
    v_add_u32 v13, s66, v13
    v_add_u32 v14, s66, v14
    v_cvt_pk_bf16_f32 v201, v166, v167
    v_mfma_f32_16x16x32_bf16 v[124:127], a[28:31], a[12:15], v[124:127]
    s_mov_b32 m0, s59
    v_add_u32 v15, s66, v15
    v_cvt_pk_bf16_f32 v202, v168, v169
    s_waitcnt vmcnt(24) lgkmcnt(0)
    v_mfma_f32_16x16x32_bf16 v[64:67], a[48:51], a[32:35], v[64:67]
    s_barrier
    v_cvt_pk_bf16_f32 v203, v170, v171
    v_cvt_pk_bf16_f32 v204, v172, v173
    v_mfma_f32_16x16x32_bf16 v[72:75], a[48:51], a[36:39], v[72:75]
    ds_read_b128 a[0:3], v6 offset:0
    buffer_load_dwordx4 v2, s[36:39], s56 offen offset:0 sc1 lds
    v_cvt_pk_bf16_f32 v205, v174, v175
    v_mfma_f32_16x16x32_bf16 v[80:83], a[48:51], a[40:43], v[80:83]
    ds_read_b64_tr_b16 a[16:17], v12 offset:0
    v_cvt_pk_bf16_f32 v206, v176, v177
    v_cvt_pk_bf16_f32 v207, v178, v179
    v_mfma_f32_16x16x32_bf16 v[88:91], a[48:51], a[44:47], v[88:91]
    ds_read_b64_tr_b16 a[18:19], v12 offset:4096
    s_nop 1
    v_mfma_f32_16x16x32_bf16 v[20:23], v[44:47], v[192:195], 0
    v_mfma_f32_16x16x32_bf16 v[68:71], a[52:55], a[32:35], v[68:71]
    ds_read_b128 a[4:7], v6 offset:1024
    v_mfma_f32_16x16x32_bf16 v[24:27], v[44:47], v[196:199], 0
    v_mfma_f32_16x16x32_bf16 v[28:31], v[44:47], v[200:203], 0
    v_mfma_f32_16x16x32_bf16 v[76:79], a[52:55], a[36:39], v[76:79]
    ds_read_b128 a[8:11], v6 offset:2048
    buffer_load_dwordx4 v2, s[36:39], s56 offen offset:1024 sc1 lds
    v_mfma_f32_16x16x32_bf16 v[32:35], v[44:47], v[204:207], 0
    v_mfma_f32_16x16x32_bf16 v[84:87], a[52:55], a[40:43], v[84:87]
    ds_read_b128 a[12:15], v6 offset:3072
    v_mfma_f32_16x16x32_bf16 v[148:151], v[230:233], v[192:195], 0
    v_mfma_f32_16x16x32_bf16 v[152:155], v[242:245], v[192:195], 0
    v_mfma_f32_16x16x32_bf16 v[92:95], a[52:55], a[44:47], v[92:95]
    ds_read_b64_tr_b16 a[20:21], v13 offset:0
    v_mfma_f32_16x16x32_bf16 v[156:159], v[232:235], v[196:199], 0
    v_mfma_f32_16x16x32_bf16 v[160:163], v[244:247], v[196:199], 0
    v_mfma_f32_16x16x32_bf16 v[96:99], a[56:59], a[32:35], v[96:99]
    ds_read_b64_tr_b16 a[22:23], v13 offset:4096
    v_mfma_f32_16x16x32_bf16 v[164:167], v[234:237], v[200:203], 0
    v_mfma_f32_16x16x32_bf16 v[168:171], v[246:249], v[200:203], 0
    v_mfma_f32_16x16x32_bf16 v[104:107], a[56:59], a[36:39], v[104:107]
    ds_read_b64_tr_b16 a[24:25], v14 offset:0
    buffer_load_dwordx4 v2, s[36:39], s56 offen offset:2048 sc1 lds
    v_mfma_f32_16x16x32_bf16 v[172:175], v[236:239], v[204:207], 0
    v_mfma_f32_16x16x32_bf16 v[112:115], a[56:59], a[40:43], v[112:115]
    ds_read_b64_tr_b16 a[26:27], v14 offset:4096
    v_mfma_f32_16x16x32_bf16 v[176:179], v[248:251], v[204:207], 0
    v_rcp_f32 v140, v20
    v_mfma_f32_16x16x32_bf16 v[120:123], a[56:59], a[44:47], v[120:123]
    ds_read_b64_tr_b16 a[28:29], v15 offset:0
    v_rcp_f32 v141, v24
    v_rcp_f32 v142, v28
    v_mfma_f32_16x16x32_bf16 v[100:103], a[60:63], a[32:35], v[100:103]
    s_add_u32 s64, s64, 1
    ds_read_b64_tr_b16 a[30:31], v15 offset:4096
    v_rcp_f32 v143, v32
    s_nop 1
    v_mfma_f32_16x16x32_bf16 v[108:111], a[60:63], a[36:39], v[108:111]
    buffer_load_dwordx4 v2, s[36:39], s56 offen offset:3072 sc1 lds
    s_nop 1
    v_mfma_f32_16x16x32_bf16 v[116:119], a[60:63], a[40:43], v[116:119]
    s_add_u32 s56, s56, 262144
    v_mul_f32 v148, v148, v140
    v_mul_f32 v149, v149, v140
    v_mfma_f32_16x16x32_bf16 v[124:127], a[60:63], a[44:47], v[124:127]
    v_mul_f32 v150, v150, v140
    v_mul_f32 v151, v151, v140
    s_cmp_gt_i32 s68, 8
    s_cbranch_scc0 m_lp158
m_lr159:
    s_waitcnt lgkmcnt(9)
    v_mfma_f32_16x16x32_bf16 v[64:67], a[16:19], a[0:3], v[64:67]
    s_add_u32 m0, s59, 16384
    ds_read_b128 a[32:35], v6 offset:8192
    v_mul_f32 v152, v152, v140
    v_mul_f32 v153, v153, v140
    s_waitcnt lgkmcnt(9)
    v_mfma_f32_16x16x32_bf16 v[72:75], a[16:19], a[4:7], v[72:75]
    ds_read_b64_tr_b16 a[48:49], v12 offset:8192
    buffer_load_dwordx4 v16, s[24:27], s57 offen offset:0 sc1 lds
    v_mul_f32 v154, v154, v140
    s_waitcnt lgkmcnt(9)
    v_mfma_f32_16x16x32_bf16 v[80:83], a[16:19], a[8:11], v[80:83]
    s_add_u32 s59, s58, s60
    ds_read_b64_tr_b16 a[50:51], v12 offset:12288
    v_mul_f32 v155, v155, v140
    v_cvt_pk_bf16_f32 v148, v148, v149
    s_waitcnt lgkmcnt(9)
    v_mfma_f32_16x16x32_bf16 v[88:91], a[16:19], a[12:15], v[88:91]
    s_add_u32 s58, s58, 32768
    ds_read_b128 a[36:39], v6 offset:9216
    v_cvt_pk_bf16_f32 v149, v150, v151
    v_cvt_pk_bf16_f32 v150, v152, v153
    s_waitcnt lgkmcnt(8)
    v_mfma_f32_16x16x32_bf16 v[68:71], a[20:23], a[0:3], v[68:71]
    s_cmp_ge_u32 s58, 163840
    ds_read_b128 a[40:43], v6 offset:10240
    v_cvt_pk_bf16_f32 v151, v154, v155
    buffer_store_dwordx4 v[148:151], v2, s[8:11], s80 offen offset:0 sc1
    v_mfma_f32_16x16x32_bf16 v[76:79], a[20:23], a[4:7], v[76:79]
    ds_read_b128 a[44:47], v6 offset:11264
    buffer_load_dwordx4 v17, s[24:27], s57 offen offset:1024 sc1 lds
    v_mul_f32 v156, v156, v141
    v_mfma_f32_16x16x32_bf16 v[84:87], a[20:23], a[8:11], v[84:87]
    s_cselect_b32 s66, 4294836224, s100
    ds_read_b64_tr_b16 a[52:53], v13 offset:8192
    v_mul_f32 v157, v157, v141
    v_mul_f32 v158, v158, v141
    v_mfma_f32_16x16x32_bf16 v[92:95], a[20:23], a[12:15], v[92:95]
    s_cselect_b32 s58, 0, s58
    ds_read_b64_tr_b16 a[54:55], v13 offset:12288
    v_mul_f32 v159, v159, v141
    v_mul_f32 v160, v160, v141
    s_waitcnt lgkmcnt(10)
    v_mfma_f32_16x16x32_bf16 v[96:99], a[24:27], a[0:3], v[96:99]
    ds_read_b64_tr_b16 a[56:57], v14 offset:8192
    v_mul_f32 v161, v161, v141
    v_mul_f32 v162, v162, v141
    v_mfma_f32_16x16x32_bf16 v[104:107], a[24:27], a[4:7], v[104:107]
    ds_read_b64_tr_b16 a[58:59], v14 offset:12288
    buffer_load_dwordx4 v18, s[24:27], s57 offen offset:2048 sc1 lds
    v_mul_f32 v163, v163, v141
    v_mfma_f32_16x16x32_bf16 v[112:115], a[24:27], a[8:11], v[112:115]
    ds_read_b64_tr_b16 a[60:61], v15 offset:8192
    v_cvt_pk_bf16_f32 v156, v156, v157
    v_cvt_pk_bf16_f32 v157, v158, v159
    v_mfma_f32_16x16x32_bf16 v[120:123], a[24:27], a[12:15], v[120:123]
    ds_read_b64_tr_b16 a[62:63], v15 offset:12288
    v_cvt_pk_bf16_f32 v158, v160, v161
    v_cvt_pk_bf16_f32 v159, v162, v163
    s_waitcnt lgkmcnt(12)
    v_mfma_f32_16x16x32_bf16 v[100:103], a[28:31], a[0:3], v[100:103]
    v_add_u32 v6, s66, v6
    v_add_u32 v12, s66, v12
    buffer_store_dwordx4 v[156:159], v2, s[8:11], s80 offen offset:1024 sc1
    v_mfma_f32_16x16x32_bf16 v[108:111], a[28:31], a[4:7], v[108:111]
    buffer_load_dwordx4 v19, s[24:27], s57 offen offset:3072 sc1 lds
    v_mul_f32 v164, v164, v142
    v_mfma_f32_16x16x32_bf16 v[116:119], a[28:31], a[8:11], v[116:119]
    s_add_u32 s57, s57, 131072
    v_add_u32 v13, s66, v13
    v_add_u32 v14, s66, v14
    v_mul_f32 v165, v165, v142
    v_mfma_f32_16x16x32_bf16 v[124:127], a[28:31], a[12:15], v[124:127]
    s_mov_b32 m0, s59
    v_add_u32 v15, s66, v15
    v_mul_f32 v166, v166, v142
    s_waitcnt vmcnt(24) lgkmcnt(0)
    v_mfma_f32_16x16x32_bf16 v[64:67], a[48:51], a[32:35], v[64:67]
    s_barrier
    v_mul_f32 v167, v167, v142
    v_mul_f32 v168, v168, v142
    v_mfma_f32_16x16x32_bf16 v[72:75], a[48:51], a[36:39], v[72:75]
    ds_read_b128 a[0:3], v6 offset:0
    buffer_load_dwordx4 v2, s[36:39], s56 offen offset:0 sc1 lds
    v_mul_f32 v169, v169, v142
    v_mfma_f32_16x16x32_bf16 v[80:83], a[48:51], a[40:43], v[80:83]
    ds_read_b64_tr_b16 a[16:17], v12 offset:0
    v_mul_f32 v170, v170, v142
    v_mul_f32 v171, v171, v142
    v_mfma_f32_16x16x32_bf16 v[88:91], a[48:51], a[44:47], v[88:91]
    ds_read_b64_tr_b16 a[18:19], v12 offset:4096
    v_cvt_pk_bf16_f32 v164, v164, v165
    v_cvt_pk_bf16_f32 v165, v166, v167
    v_mfma_f32_16x16x32_bf16 v[68:71], a[52:55], a[32:35], v[68:71]
    ds_read_b128 a[4:7], v6 offset:1024
    v_cvt_pk_bf16_f32 v166, v168, v169
    v_cvt_pk_bf16_f32 v167, v170, v171
    v_mfma_f32_16x16x32_bf16 v[76:79], a[52:55], a[36:39], v[76:79]
    ds_read_b128 a[8:11], v6 offset:2048
    buffer_load_dwordx4 v2, s[36:39], s56 offen offset:1024 sc1 lds
    buffer_store_dwordx4 v[164:167], v2, s[8:11], s80 offen offset:2048 sc1
    v_mfma_f32_16x16x32_bf16 v[84:87], a[52:55], a[40:43], v[84:87]
    ds_read_b128 a[12:15], v6 offset:3072
    v_mul_f32 v172, v172, v143
    v_mul_f32 v173, v173, v143
    v_mfma_f32_16x16x32_bf16 v[92:95], a[52:55], a[44:47], v[92:95]
    ds_read_b64_tr_b16 a[20:21], v13 offset:0
    v_mul_f32 v174, v174, v143
    v_mul_f32 v175, v175, v143
    v_mfma_f32_16x16x32_bf16 v[96:99], a[56:59], a[32:35], v[96:99]
    ds_read_b64_tr_b16 a[22:23], v13 offset:4096
    v_mul_f32 v176, v176, v143
    v_mul_f32 v177, v177, v143
    v_mfma_f32_16x16x32_bf16 v[104:107], a[56:59], a[36:39], v[104:107]
    ds_read_b64_tr_b16 a[24:25], v14 offset:0
    buffer_load_dwordx4 v2, s[36:39], s56 offen offset:2048 sc1 lds
    v_mul_f32 v178, v178, v143
    v_mfma_f32_16x16x32_bf16 v[112:115], a[56:59], a[40:43], v[112:115]
    ds_read_b64_tr_b16 a[26:27], v14 offset:4096
    v_mul_f32 v179, v179, v143
    v_cvt_pk_bf16_f32 v172, v172, v173
    v_mfma_f32_16x16x32_bf16 v[120:123], a[56:59], a[44:47], v[120:123]
    ds_read_b64_tr_b16 a[28:29], v15 offset:0
    v_cvt_pk_bf16_f32 v173, v174, v175
    v_cvt_pk_bf16_f32 v174, v176, v177
    v_mfma_f32_16x16x32_bf16 v[100:103], a[60:63], a[32:35], v[100:103]
    s_add_u32 s64, s64, 1
    ds_read_b64_tr_b16 a[30:31], v15 offset:4096
    v_cvt_pk_bf16_f32 v175, v178, v179
    buffer_store_dwordx4 v[172:175], v2, s[8:11], s80 offen offset:3072 sc1
    v_mfma_f32_16x16x32_bf16 v[108:111], a[60:63], a[36:39], v[108:111]
    buffer_load_dwordx4 v2, s[36:39], s56 offen offset:3072 sc1 lds
    v_mfma_f32_16x16x32_bf16 v[116:119], a[60:63], a[40:43], v[116:119]
    s_add_u32 s56, s56, 262144
    v_mfma_f32_16x16x32_bf16 v[124:127], a[60:63], a[44:47], v[124:127]
    s_branch m_l3e148
m_lp152:
    s_mov_b32 s3, 1048576
m_spin160:
    buffer_load_dwordx2 v[4:5], v10, s[8:11], s52 offen sc1
    s_waitcnt vmcnt(0)
    v_cmp_ne_u64 s[76:77], s[4:5], v[4:5]
    s_mul_i32 s91, s95, 20
    s_nop 2
    s_lshr_b32 s90, s76, s91
    s_ff1_i32_b32 s90, s90
    s_lshl_b32 s68, s90, 1
    s_mul_i32 s91, s95, 0
    s_sub_i32 s68, s68, s91
    s_cmp_lt_i32 s90, 0
    s_cselect_b32 s68, 1000, s68
    s_cmp_gt_i32 s68, 5
    s_cbranch_scc1 m_ok161
    s_sub_u32 s3, s3, 1
    s_cbranch_scc1 m_ok161
    s_sleep 4
    s_branch m_spin160
m_ok161:
    s_branch m_lr153
m_lp154:
    s_mov_b32 s3, 1048576
m_spin162:
    buffer_load_dwordx2 v[4:5], v10, s[8:11], s52 offen sc1
    s_waitcnt vmcnt(0)
    v_cmp_ne_u64 s[76:77], s[4:5], v[4:5]
    s_mul_i32 s91, s95, 20
    s_nop 2
    s_lshr_b32 s90, s76, s91
    s_ff1_i32_b32 s90, s90
    s_lshl_b32 s68, s90, 1
    s_mul_i32 s91, s95, 0
    s_sub_i32 s68, s68, s91
    s_cmp_lt_i32 s90, 0
    s_cselect_b32 s68, 1000, s68
    s_cmp_gt_i32 s68, 6
    s_cbranch_scc1 m_ok163
    s_sub_u32 s3, s3, 1
    s_cbranch_scc1 m_ok163
    s_sleep 4
    s_branch m_spin162
m_ok163:
    s_branch m_lr155
m_lp156:
    s_mov_b32 s3, 1048576
m_spin164:
    buffer_load_dwordx2 v[4:5], v10, s[8:11], s52 offen sc1
    s_waitcnt vmcnt(0)
    v_cmp_ne_u64 s[76:77], s[4:5], v[4:5]
    s_mul_i32 s91, s95, 20
    s_nop 2
    s_lshr_b32 s90, s76, s91
    s_ff1_i32_b32 s90, s90
    s_lshl_b32 s68, s90, 1
    s_mul_i32 s91, s95, 0
    s_sub_i32 s68, s68, s91
    s_cmp_lt_i32 s90, 0
    s_cselect_b32 s68, 1000, s68
    s_cmp_gt_i32 s68, 7
    s_cbranch_scc1 m_ok165
    s_sub_u32 s3, s3, 1
    s_cbranch_scc1 m_ok165
    s_sleep 4
    s_branch m_spin164
m_ok165:
    s_branch m_lr157
m_lp158:
    s_mov_b32 s3, 1048576
m_spin166:
    buffer_load_dwordx2 v[4:5], v10, s[8:11], s52 offen sc1
    s_waitcnt vmcnt(0)
    v_cmp_ne_u64 s[76:77], s[4:5], v[4:5]
    s_mul_i32 s91, s95, 20
    s_nop 2
    s_lshr_b32 s90, s76, s91
    s_ff1_i32_b32 s90, s90
    s_lshl_b32 s68, s90, 1
    s_mul_i32 s91, s95, 0
    s_sub_i32 s68, s68, s91
    s_cmp_lt_i32 s90, 0
    s_cselect_b32 s68, 1000, s68
    s_cmp_gt_i32 s68, 8
    s_cbranch_scc1 m_ok167
    s_sub_u32 s3, s3, 1
    s_cbranch_scc1 m_ok167
    s_sleep 4
    s_branch m_spin166
m_ok167:
    s_branch m_lr159
.p2align 3
m_l3147:
    s_waitcnt lgkmcnt(9)
    v_mfma_f32_16x16x32_bf16 v[64:67], a[16:19], a[0:3], v[64:67]
    s_add_u32 m0, s59, 16384
    ds_read_b128 a[32:35], v6 offset:8192
    s_waitcnt lgkmcnt(9)
    v_mfma_f32_16x16x32_bf16 v[72:75], a[16:19], a[4:7], v[72:75]
    ds_read_b64_tr_b16 a[48:49], v12 offset:8192
    buffer_load_dwordx4 v16, s[24:27], s57 offen offset:0 sc1 lds
    s_waitcnt lgkmcnt(9)
    v_mfma_f32_16x16x32_bf16 v[80:83], a[16:19], a[8:11], v[80:83]
    s_add_u32 s59, s58, s60
    ds_read_b64_tr_b16 a[50:51], v12 offset:12288
    s_waitcnt lgkmcnt(9)
    v_mfma_f32_16x16x32_bf16 v[88:91], a[16:19], a[12:15], v[88:91]
    s_add_u32 s58, s58, 32768
    ds_read_b128 a[36:39], v6 offset:9216
    s_waitcnt lgkmcnt(8)
    v_mfma_f32_16x16x32_bf16 v[68:71], a[20:23], a[0:3], v[68:71]
    s_cmp_ge_u32 s58, 163840
    ds_read_b128 a[40:43], v6 offset:10240
    v_mfma_f32_16x16x32_bf16 v[76:79], a[20:23], a[4:7], v[76:79]
    ds_read_b128 a[44:47], v6 offset:11264
    buffer_load_dwordx4 v17, s[24:27], s57 offen offset:1024 sc1 lds
    v_mfma_f32_16x16x32_bf16 v[84:87], a[20:23], a[8:11], v[84:87]
    s_cselect_b32 s66, 4294836224, s100
    ds_read_b64_tr_b16 a[52:53], v13 offset:8192
    v_mfma_f32_16x16x32_bf16 v[92:95], a[20:23], a[12:15], v[92:95]
    s_cselect_b32 s58, 0, s58
    ds_read_b64_tr_b16 a[54:55], v13 offset:12288
    s_waitcnt lgkmcnt(10)
    v_mfma_f32_16x16x32_bf16 v[96:99], a[24:27], a[0:3], v[96:99]
    ds_read_b64_tr_b16 a[56:57], v14 offset:8192
    v_mfma_f32_16x16x32_bf16 v[104:107], a[24:27], a[4:7], v[104:107]
    ds_read_b64_tr_b16 a[58:59], v14 offset:12288
    buffer_load_dwordx4 v18, s[24:27], s57 offen offset:2048 sc1 lds
    v_mfma_f32_16x16x32_bf16 v[112:115], a[24:27], a[8:11], v[112:115]
    ds_read_b64_tr_b16 a[60:61], v15 offset:8192
    v_mfma_f32_16x16x32_bf16 v[120:123], a[24:27], a[12:15], v[120:123]
    ds_read_b64_tr_b16 a[62:63], v15 offset:12288
    s_waitcnt lgkmcnt(12)
    v_mfma_f32_16x16x32_bf16 v[100:103], a[28:31], a[0:3], v[100:103]
    v_add_u32 v6, s66, v6
    v_add_u32 v12, s66, v12
    v_mfma_f32_16x16x32_bf16 v[108:111], a[28:31], a[4:7], v[108:111]
    buffer_load_dwordx4 v19, s[24:27], s57 offen offset:3072 sc1 lds
    v_mfma_f32_16x16x32_bf16 v[116:119], a[28:31], a[8:11], v[116:119]
    s_add_u32 s57, s57, 131072
    v_add_u32 v13, s66, v13
    v_add_u32 v14, s66, v14
    v_mfma_f32_16x16x32_bf16 v[124:127], a[28:31], a[12:15], v[124:127]
    s_mov_b32 m0, s59
    v_add_u32 v15, s66, v15
    s_waitcnt vmcnt(24) lgkmcnt(0)
    v_mfma_f32_16x16x32_bf16 v[64:67], a[48:51], a[32:35], v[64:67]
    s_barrier
    v_mfma_f32_16x16x32_bf16 v[72:75], a[48:51], a[36:39], v[72:75]
    ds_read_b128 a[0:3], v6 offset:0
    buffer_load_dwordx4 v2, s[36:39], s56 offen offset:0 sc1 lds
    v_mfma_f32_16x16x32_bf16 v[80:83], a[48:51], a[40:43], v[80:83]
    ds_read_b64_tr_b16 a[16:17], v12 offset:0
    v_mfma_f32_16x16x32_bf16 v[88:91], a[48:51], a[44:47], v[88:91]
    ds_read_b64_tr_b16 a[18:19], v12 offset:4096
    v_mfma_f32_16x16x32_bf16 v[68:71], a[52:55], a[32:35], v[68:71]
    ds_read_b128 a[4:7], v6 offset:1024
    v_mfma_f32_16x16x32_bf16 v[76:79], a[52:55], a[36:39], v[76:79]
    ds_read_b128 a[8:11], v6 offset:2048
    buffer_load_dwordx4 v2, s[36:39], s56 offen offset:1024 sc1 lds
    v_mfma_f32_16x16x32_bf16 v[84:87], a[52:55], a[40:43], v[84:87]
    ds_read_b128 a[12:15], v6 offset:3072
    v_mfma_f32_16x16x32_bf16 v[92:95], a[52:55], a[44:47], v[92:95]
    ds_read_b64_tr_b16 a[20:21], v13 offset:0
    v_mfma_f32_16x16x32_bf16 v[96:99], a[56:59], a[32:35], v[96:99]
    ds_read_b64_tr_b16 a[22:23], v13 offset:4096
    v_mfma_f32_16x16x32_bf16 v[104:107], a[56:59], a[36:39], v[104:107]
    ds_read_b64_tr_b16 a[24:25], v14 offset:0
    buffer_load_dwordx4 v2, s[36:39], s56 offen offset:2048 sc1 lds
    v_mfma_f32_16x16x32_bf16 v[112:115], a[56:59], a[40:43], v[112:115]
    ds_read_b64_tr_b16 a[26:27], v14 offset:4096
    v_mfma_f32_16x16x32_bf16 v[120:123], a[56:59], a[44:47], v[120:123]
    ds_read_b64_tr_b16 a[28:29], v15 offset:0
    v_mfma_f32_16x16x32_bf16 v[100:103], a[60:63], a[32:35], v[100:103]
    s_add_u32 s64, s64, 1
    ds_read_b64_tr_b16 a[30:31], v15 offset:4096
    v_mfma_f32_16x16x32_bf16 v[108:111], a[60:63], a[36:39], v[108:111]
    buffer_load_dwordx4 v2, s[36:39], s56 offen offset:3072 sc1 lds
    v_mfma_f32_16x16x32_bf16 v[116:119], a[60:63], a[40:43], v[116:119]
    s_add_u32 s56, s56, 262144
    s_cmp_lt_u32 s64, s67
    v_mfma_f32_16x16x32_bf16 v[124:127], a[60:63], a[44:47], v[124:127]
    s_cbranch_scc1 m_l3147
m_l3e148:
    s_add_u32 s92, s64, 5
    s_cmp_gt_i32 s68, s92
    s_cbranch_scc1 m_rdy168
    s_mov_b32 s3, 1048576
m_spin169:
    buffer_load_dwordx2 v[4:5], v10, s[8:11], s52 offen sc1
    s_waitcnt vmcnt(0)
    v_cmp_ne_u64 s[76:77], s[4:5], v[4:5]
    s_mul_i32 s91, s95, 20
    s_nop 2
    s_lshr_b32 s90, s76, s91
    s_ff1_i32_b32 s90, s90
    s_lshl_b32 s68, s90, 1
    s_mul_i32 s91, s95, 0
    s_sub_i32 s68, s68, s91
    s_cmp_lt_i32 s90, 0
    s_cselect_b32 s68, 1000, s68
    s_cmp_gt_i32 s68, s92
    s_cbranch_scc1 m_ok170
    s_sub_u32 s3, s3, 1
    s_cbranch_scc1 m_ok170
    s_sleep 4
    s_branch m_spin169
m_ok170:
m_rdy168:
    s_mov_b32 s67, 8
    s_cmp_lt_u32 s64, 8
    s_cbranch_scc1 m_l3n151
    s_cmp_eq_u32 s64, 8
    s_cbranch_scc1 m_o1171
m_o2172:
    s_cmp_eq_u32 s95, 0
    s_cbranch_scc1 m_l3c150
    s_mov_b32 s67, 18
    s_cmp_lt_u32 s64, 18
    s_cbranch_scc1 m_l3n151
    s_cmp_lg_u32 s64, 18
    s_cbranch_scc1 m_n173
    s_mov_b32 s68, 1000
    s_lshr_b32 s90, s96, 1
    s_lshl_b32 s90, s90, 8
    s_add_u32 s90, s90, 117452800
    buffer_load_dwordx2 v[4:5], v10, s[8:11], s90 offen sc1
    s_mov_b32 s67, 19
    s_branch m_l3147
m_n173:
    s_cmp_lg_u32 s64, 19
    s_cbranch_scc1 m_n174
    s_waitcnt vmcnt(8)
    s_waitcnt vmcnt(16)
    s_mov_b32 s3, 1048576
m_spin175:
    v_cmp_ne_u64 s[76:77], s[4:5], v[4:5]
    s_nop 3
    s_cmp_eq_u64 s[76:77], 0
    s_cbranch_scc1 m_ok176
    s_sub_u32 s3, s3, 1
    s_cbranch_scc1 m_ok176
    s_sleep 8
    s_lshr_b32 s90, s96, 1
    s_lshl_b32 s90, s90, 8
    s_add_u32 s90, s90, 117452800
    buffer_load_dwordx2 v[4:5], v10, s[8:11], s90 offen sc1
    s_waitcnt vmcnt(0)
    s_branch m_spin175
m_ok176:
    s_mov_b32 s56, s69
    s_mov_b32 s67, 20
    s_branch m_l3147
m_n174:
    s_cmp_lg_u32 s64, 20
    s_cbranch_scc1 m_n177
    s_mov_b32 s24, s50
    s_mov_b32 s25, s51
    s_mov_b32 s26, 2097152
    s_lshl_b32 s57, s97, 8
    s_mov_b32 s67, 24
    s_branch m_l3147
m_n177:
    s_cmp_lg_u32 s64, 24
    s_cbranch_scc1 m_n178
    s_lshl_b32 s90, s96, 3
    s_add_u32 s90, s90, s97
    s_lshl_b32 s90, s90, 15
    s_lshl_b32 s91, s16, 13
    s_add_u32 s90, s90, s91
    s_add_u32 s70, s90, 100663296
    s_nop 3
    v_cvt_pk_bf16_f32 v128, v64, v65
    v_cvt_pk_bf16_f32 v129, v66, v67
    v_cvt_pk_bf16_f32 v130, v68, v69
    v_cvt_pk_bf16_f32 v131, v70, v71
    v_cvt_pk_bf16_f32 v132, v72, v73
    v_cvt_pk_bf16_f32 v133, v74, v75
    v_cvt_pk_bf16_f32 v134, v76, v77
    v_cvt_pk_bf16_f32 v135, v78, v79
    v_cvt_pk_bf16_f32 v136, v80, v81
    v_cvt_pk_bf16_f32 v137, v82, v83
    v_cvt_pk_bf16_f32 v138, v84, v85
    v_cvt_pk_bf16_f32 v139, v86, v87
    v_cvt_pk_bf16_f32 v140, v88, v89
    v_cvt_pk_bf16_f32 v141, v90, v91
    v_cvt_pk_bf16_f32 v142, v92, v93
    v_cvt_pk_bf16_f32 v143, v94, v95
    v_cvt_pk_bf16_f32 v144, v96, v97
    v_cvt_pk_bf16_f32 v145, v98, v99
    v_cvt_pk_bf16_f32 v146, v100, v101
    v_cvt_pk_bf16_f32 v147, v102, v103
    v_cvt_pk_bf16_f32 v148, v104, v105
    v_cvt_pk_bf16_f32 v149, v106, v107
    v_cvt_pk_bf16_f32 v150, v108, v109
    v_cvt_pk_bf16_f32 v151, v110, v111
    v_cvt_pk_bf16_f32 v152, v112, v113
    v_cvt_pk_bf16_f32 v153, v114, v115
    v_cvt_pk_bf16_f32 v154, v116, v117
    v_cvt_pk_bf16_f32 v155, v118, v119
    v_cvt_pk_bf16_f32 v156, v120, v121
    v_cvt_pk_bf16_f32 v157, v122, v123
    v_cvt_pk_bf16_f32 v158, v124, v125
    v_cvt_pk_bf16_f32 v159, v126, v127
    v_mov_b64 v[64:65], 0
    v_mov_b64 v[66:67], 0
    v_mov_b64 v[68:69], 0
    v_mov_b64 v[70:71], 0
    v_mov_b64 v[72:73], 0
    v_mov_b64 v[74:75], 0
    v_mov_b64 v[76:77], 0
    v_mov_b64 v[78:79], 0
    v_mov_b64 v[80:81], 0
    v_mov_b64 v[82:83], 0
    v_mov_b64 v[84:85], 0
    v_mov_b64 v[86:87], 0
    v_mov_b64 v[88:89], 0
    v_mov_b64 v[90:91], 0
    v_mov_b64 v[92:93], 0
    v_mov_b64 v[94:95], 0
    v_mov_b64 v[96:97], 0
    v_mov_b64 v[98:99], 0
    v_mov_b64 v[100:101], 0
    v_mov_b64 v[102:103], 0
    v_mov_b64 v[104:105], 0
    v_mov_b64 v[106:107], 0
    v_mov_b64 v[108:109], 0
    v_mov_b64 v[110:111], 0
    v_mov_b64 v[112:113], 0
    v_mov_b64 v[114:115], 0
    v_mov_b64 v[116:117], 0
    v_mov_b64 v[118:119], 0
    v_mov_b64 v[120:121], 0
    v_mov_b64 v[122:123], 0
    v_mov_b64 v[124:125], 0
    v_mov_b64 v[126:127], 0
    s_nop 1
    s_waitcnt lgkmcnt(9)
    v_mfma_f32_16x16x32_bf16 v[64:67], a[16:19], a[0:3], v[64:67]
    s_add_u32 m0, s59, 16384
    ds_read_b128 a[32:35], v6 offset:8192
    s_waitcnt lgkmcnt(9)
    v_mfma_f32_16x16x32_bf16 v[72:75], a[16:19], a[4:7], v[72:75]
    ds_read_b64_tr_b16 a[48:49], v12 offset:8192
    buffer_load_dwordx4 v16, s[24:27], s57 offen offset:0 sc1 lds
    s_waitcnt lgkmcnt(9)
    v_mfma_f32_16x16x32_bf16 v[80:83], a[16:19], a[8:11], v[80:83]
    s_add_u32 s59, s58, s60
    ds_read_b64_tr_b16 a[50:51], v12 offset:12288
    s_waitcnt lgkmcnt(9)
    v_mfma_f32_16x16x32_bf16 v[88:91], a[16:19], a[12:15], v[88:91]
    s_add_u32 s58, s58, 32768
    ds_read_b128 a[36:39], v6 offset:9216
    s_waitcnt lgkmcnt(8)
    v_mfma_f32_16x16x32_bf16 v[68:71], a[20:23], a[0:3], v[68:71]
    s_cmp_ge_u32 s58, 163840
    ds_read_b128 a[40:43], v6 offset:10240
    v_mfma_f32_16x16x32_bf16 v[76:79], a[20:23], a[4:7], v[76:79]
    ds_read_b128 a[44:47], v6 offset:11264
    buffer_load_dwordx4 v17, s[24:27], s57 offen offset:1024 sc1 lds
    v_mfma_f32_16x16x32_bf16 v[84:87], a[20:23], a[8:11], v[84:87]
    s_cselect_b32 s66, 4294836224, s100
    ds_read_b64_tr_b16 a[52:53], v13 offset:8192
    v_mfma_f32_16x16x32_bf16 v[92:95], a[20:23], a[12:15], v[92:95]
    s_cselect_b32 s58, 0, s58
    ds_read_b64_tr_b16 a[54:55], v13 offset:12288
    s_waitcnt lgkmcnt(10)
    v_mfma_f32_16x16x32_bf16 v[96:99], a[24:27], a[0:3], v[96:99]
    ds_read_b64_tr_b16 a[56:57], v14 offset:8192
    v_mfma_f32_16x16x32_bf16 v[104:107], a[24:27], a[4:7], v[104:107]
    ds_read_b64_tr_b16 a[58:59], v14 offset:12288
    buffer_load_dwordx4 v18, s[24:27], s57 offen offset:2048 sc1 lds
    v_mfma_f32_16x16x32_bf16 v[112:115], a[24:27], a[8:11], v[112:115]
    ds_read_b64_tr_b16 a[60:61], v15 offset:8192
    v_mfma_f32_16x16x32_bf16 v[120:123], a[24:27], a[12:15], v[120:123]
    ds_read_b64_tr_b16 a[62:63], v15 offset:12288
    buffer_store_dwordx4 v[128:131], v2, s[8:11], s70 offen offset:0 sc1
    s_waitcnt lgkmcnt(12)
    v_mfma_f32_16x16x32_bf16 v[100:103], a[28:31], a[0:3], v[100:103]
    v_add_u32 v6, s66, v6
    v_add_u32 v12, s66, v12
    v_mfma_f32_16x16x32_bf16 v[108:111], a[28:31], a[4:7], v[108:111]
    buffer_load_dwordx4 v19, s[24:27], s57 offen offset:3072 sc1 lds
    v_mfma_f32_16x16x32_bf16 v[116:119], a[28:31], a[8:11], v[116:119]
    s_add_u32 s57, s57, 131072
    v_add_u32 v13, s66, v13
    v_add_u32 v14, s66, v14
    v_mfma_f32_16x16x32_bf16 v[124:127], a[28:31], a[12:15], v[124:127]
    s_mov_b32 m0, s59
    v_add_u32 v15, s66, v15
    s_waitcnt vmcnt(24) lgkmcnt(0)
    v_mfma_f32_16x16x32_bf16 v[64:67], a[48:51], a[32:35], v[64:67]
    s_barrier
    v_mfma_f32_16x16x32_bf16 v[72:75], a[48:51], a[36:39], v[72:75]
    ds_read_b128 a[0:3], v6 offset:0
    buffer_load_dwordx4 v2, s[36:39], s56 offen offset:0 sc1 lds
    v_mfma_f32_16x16x32_bf16 v[80:83], a[48:51], a[40:43], v[80:83]
    ds_read_b64_tr_b16 a[16:17], v12 offset:0
    v_mfma_f32_16x16x32_bf16 v[88:91], a[48:51], a[44:47], v[88:91]
    ds_read_b64_tr_b16 a[18:19], v12 offset:4096
    v_mfma_f32_16x16x32_bf16 v[68:71], a[52:55], a[32:35], v[68:71]
    ds_read_b128 a[4:7], v6 offset:1024
    v_mfma_f32_16x16x32_bf16 v[76:79], a[52:55], a[36:39], v[76:79]
    ds_read_b128 a[8:11], v6 offset:2048
    buffer_load_dwordx4 v2, s[36:39], s56 offen offset:1024 sc1 lds
    v_mfma_f32_16x16x32_bf16 v[84:87], a[52:55], a[40:43], v[84:87]
    ds_read_b128 a[12:15], v6 offset:3072
    v_mfma_f32_16x16x32_bf16 v[92:95], a[52:55], a[44:47], v[92:95]
    ds_read_b64_tr_b16 a[20:21], v13 offset:0
    v_mfma_f32_16x16x32_bf16 v[96:99], a[56:59], a[32:35], v[96:99]
    ds_read_b64_tr_b16 a[22:23], v13 offset:4096
    v_mfma_f32_16x16x32_bf16 v[104:107], a[56:59], a[36:39], v[104:107]
    ds_read_b64_tr_b16 a[24:25], v14 offset:0
    buffer_load_dwordx4 v2, s[36:39], s56 offen offset:2048 sc1 lds
    v_mfma_f32_16x16x32_bf16 v[112:115], a[56:59], a[40:43], v[112:115]
    ds_read_b64_tr_b16 a[26:27], v14 offset:4096
    v_mfma_f32_16x16x32_bf16 v[120:123], a[56:59], a[44:47], v[120:123]
    ds_read_b64_tr_b16 a[28:29], v15 offset:0
    buffer_store_dwordx4 v[132:135], v2, s[8:11], s70 offen offset:1024 sc1
    v_mfma_f32_16x16x32_bf16 v[100:103], a[60:63], a[32:35], v[100:103]
    s_add_u32 s64, s64, 1
    ds_read_b64_tr_b16 a[30:31], v15 offset:4096
    v_mfma_f32_16x16x32_bf16 v[108:111], a[60:63], a[36:39], v[108:111]
    buffer_load_dwordx4 v2, s[36:39], s56 offen offset:3072 sc1 lds
    v_mfma_f32_16x16x32_bf16 v[116:119], a[60:63], a[40:43], v[116:119]
    s_add_u32 s56, s56, 262144
    v_mfma_f32_16x16x32_bf16 v[124:127], a[60:63], a[44:47], v[124:127]
    s_waitcnt lgkmcnt(9)
    v_mfma_f32_16x16x32_bf16 v[64:67], a[16:19], a[0:3], v[64:67]
    s_add_u32 m0, s59, 16384
    ds_read_b128 a[32:35], v6 offset:8192
    s_waitcnt lgkmcnt(9)
    v_mfma_f32_16x16x32_bf16 v[72:75], a[16:19], a[4:7], v[72:75]
    ds_read_b64_tr_b16 a[48:49], v12 offset:8192
    buffer_load_dwordx4 v16, s[24:27], s57 offen offset:0 sc1 lds
    s_waitcnt lgkmcnt(9)
    v_mfma_f32_16x16x32_bf16 v[80:83], a[16:19], a[8:11], v[80:83]
    s_add_u32 s59, s58, s60
    ds_read_b64_tr_b16 a[50:51], v12 offset:12288
    s_waitcnt lgkmcnt(9)
    v_mfma_f32_16x16x32_bf16 v[88:91], a[16:19], a[12:15], v[88:91]
    s_add_u32 s58, s58, 32768
    ds_read_b128 a[36:39], v6 offset:9216
    s_waitcnt lgkmcnt(8)
    v_mfma_f32_16x16x32_bf16 v[68:71], a[20:23], a[0:3], v[68:71]
    s_cmp_ge_u32 s58, 163840
    ds_read_b128 a[40:43], v6 offset:10240
    v_mfma_f32_16x16x32_bf16 v[76:79], a[20:23], a[4:7], v[76:79]
    ds_read_b128 a[44:47], v6 offset:11264
    buffer_load_dwordx4 v17, s[24:27], s57 offen offset:1024 sc1 lds
    v_mfma_f32_16x16x32_bf16 v[84:87], a[20:23], a[8:11], v[84:87]
    s_cselect_b32 s66, 4294836224, s100
    ds_read_b64_tr_b16 a[52:53], v13 offset:8192
    v_mfma_f32_16x16x32_bf16 v[92:95], a[20:23], a[12:15], v[92:95]
    s_cselect_b32 s58, 0, s58
    ds_read_b64_tr_b16 a[54:55], v13 offset:12288
    s_waitcnt lgkmcnt(10)
    v_mfma_f32_16x16x32_bf16 v[96:99], a[24:27], a[0:3], v[96:99]
    ds_read_b64_tr_b16 a[56:57], v14 offset:8192
    v_mfma_f32_16x16x32_bf16 v[104:107], a[24:27], a[4:7], v[104:107]
    ds_read_b64_tr_b16 a[58:59], v14 offset:12288
    buffer_load_dwordx4 v18, s[24:27], s57 offen offset:2048 sc1 lds
    v_mfma_f32_16x16x32_bf16 v[112:115], a[24:27], a[8:11], v[112:115]
    ds_read_b64_tr_b16 a[60:61], v15 offset:8192
    v_mfma_f32_16x16x32_bf16 v[120:123], a[24:27], a[12:15], v[120:123]
    ds_read_b64_tr_b16 a[62:63], v15 offset:12288
    buffer_store_dwordx4 v[136:139], v2, s[8:11], s70 offen offset:2048 sc1
    s_waitcnt lgkmcnt(12)
    v_mfma_f32_16x16x32_bf16 v[100:103], a[28:31], a[0:3], v[100:103]
    v_add_u32 v6, s66, v6
    v_add_u32 v12, s66, v12
    v_mfma_f32_16x16x32_bf16 v[108:111], a[28:31], a[4:7], v[108:111]
    buffer_load_dwordx4 v19, s[24:27], s57 offen offset:3072 sc1 lds
    v_mfma_f32_16x16x32_bf16 v[116:119], a[28:31], a[8:11], v[116:119]
    s_add_u32 s57, s57, 131072
    v_add_u32 v13, s66, v13
    v_add_u32 v14, s66, v14
    v_mfma_f32_16x16x32_bf16 v[124:127], a[28:31], a[12:15], v[124:127]
    s_mov_b32 m0, s59
    v_add_u32 v15, s66, v15
    s_waitcnt vmcnt(24) lgkmcnt(0)
    v_mfma_f32_16x16x32_bf16 v[64:67], a[48:51], a[32:35], v[64:67]
    s_barrier
    v_mfma_f32_16x16x32_bf16 v[72:75], a[48:51], a[36:39], v[72:75]
    ds_read_b128 a[0:3], v6 offset:0
    buffer_load_dwordx4 v2, s[36:39], s56 offen offset:0 sc1 lds
    v_mfma_f32_16x16x32_bf16 v[80:83], a[48:51], a[40:43], v[80:83]
    ds_read_b64_tr_b16 a[16:17], v12 offset:0
    v_mfma_f32_16x16x32_bf16 v[88:91], a[48:51], a[44:47], v[88:91]
    ds_read_b64_tr_b16 a[18:19], v12 offset:4096
    v_mfma_f32_16x16x32_bf16 v[68:71], a[52:55], a[32:35], v[68:71]
    ds_read_b128 a[4:7], v6 offset:1024
    v_mfma_f32_16x16x32_bf16 v[76:79], a[52:55], a[36:39], v[76:79]
    ds_read_b128 a[8:11], v6 offset:2048
    buffer_load_dwordx4 v2, s[36:39], s56 offen offset:1024 sc1 lds
    v_mfma_f32_16x16x32_bf16 v[84:87], a[52:55], a[40:43], v[84:87]
    ds_read_b128 a[12:15], v6 offset:3072
    v_mfma_f32_16x16x32_bf16 v[92:95], a[52:55], a[44:47], v[92:95]
    ds_read_b64_tr_b16 a[20:21], v13 offset:0
    v_mfma_f32_16x16x32_bf16 v[96:99], a[56:59], a[32:35], v[96:99]
    ds_read_b64_tr_b16 a[22:23], v13 offset:4096
    v_mfma_f32_16x16x32_bf16 v[104:107], a[56:59], a[36:39], v[104:107]
    ds_read_b64_tr_b16 a[24:25], v14 offset:0
    buffer_load_dwordx4 v2, s[36:39], s56 offen offset:2048 sc1 lds
    v_mfma_f32_16x16x32_bf16 v[112:115], a[56:59], a[40:43], v[112:115]
    ds_read_b64_tr_b16 a[26:27], v14 offset:4096
    v_mfma_f32_16x16x32_bf16 v[120:123], a[56:59], a[44:47], v[120:123]
    ds_read_b64_tr_b16 a[28:29], v15 offset:0
    buffer_store_dwordx4 v[140:143], v2, s[8:11], s70 offen offset:3072 sc1
    s_add_u32 s70, s70, 4096
    v_mfma_f32_16x16x32_bf16 v[100:103], a[60:63], a[32:35], v[100:103]
    s_add_u32 s64, s64, 1
    ds_read_b64_tr_b16 a[30:31], v15 offset:4096
    v_mfma_f32_16x16x32_bf16 v[108:111], a[60:63], a[36:39], v[108:111]
    buffer_load_dwordx4 v2, s[36:39], s56 offen offset:3072 sc1 lds
    v_mfma_f32_16x16x32_bf16 v[116:119], a[60:63], a[40:43], v[116:119]
    s_add_u32 s56, s56, 262144
    v_mfma_f32_16x16x32_bf16 v[124:127], a[60:63], a[44:47], v[124:127]
    s_waitcnt lgkmcnt(9)
    v_mfma_f32_16x16x32_bf16 v[64:67], a[16:19], a[0:3], v[64:67]
    s_add_u32 m0, s59, 16384
    ds_read_b128 a[32:35], v6 offset:8192
    s_waitcnt lgkmcnt(9)
    v_mfma_f32_16x16x32_bf16 v[72:75], a[16:19], a[4:7], v[72:75]
    ds_read_b64_tr_b16 a[48:49], v12 offset:8192
    buffer_load_dwordx4 v16, s[24:27], s57 offen offset:0 sc1 lds
    s_waitcnt lgkmcnt(9)
    v_mfma_f32_16x16x32_bf16 v[80:83], a[16:19], a[8:11], v[80:83]
    s_add_u32 s59, s58, s60
    ds_read_b64_tr_b16 a[50:51], v12 offset:12288
    s_waitcnt lgkmcnt(9)
    v_mfma_f32_16x16x32_bf16 v[88:91], a[16:19], a[12:15], v[88:91]
    s_add_u32 s58, s58, 32768
    ds_read_b128 a[36:39], v6 offset:9216
    s_waitcnt lgkmcnt(8)
    v_mfma_f32_16x16x32_bf16 v[68:71], a[20:23], a[0:3], v[68:71]
    s_cmp_ge_u32 s58, 163840
    ds_read_b128 a[40:43], v6 offset:10240
    v_mfma_f32_16x16x32_bf16 v[76:79], a[20:23], a[4:7], v[76:79]
    ds_read_b128 a[44:47], v6 offset:11264
    buffer_load_dwordx4 v17, s[24:27], s57 offen offset:1024 sc1 lds
    v_mfma_f32_16x16x32_bf16 v[84:87], a[20:23], a[8:11], v[84:87]
    s_cselect_b32 s66, 4294836224, s100
    ds_read_b64_tr_b16 a[52:53], v13 offset:8192
    v_mfma_f32_16x16x32_bf16 v[92:95], a[20:23], a[12:15], v[92:95]
    s_cselect_b32 s58, 0, s58
    ds_read_b64_tr_b16 a[54:55], v13 offset:12288
    s_waitcnt lgkmcnt(10)
    v_mfma_f32_16x16x32_bf16 v[96:99], a[24:27], a[0:3], v[96:99]
    ds_read_b64_tr_b16 a[56:57], v14 offset:8192
    v_mfma_f32_16x16x32_bf16 v[104:107], a[24:27], a[4:7], v[104:107]
    ds_read_b64_tr_b16 a[58:59], v14 offset:12288
    buffer_load_dwordx4 v18, s[24:27], s57 offen offset:2048 sc1 lds
    v_mfma_f32_16x16x32_bf16 v[112:115], a[24:27], a[8:11], v[112:115]
    ds_read_b64_tr_b16 a[60:61], v15 offset:8192
    v_mfma_f32_16x16x32_bf16 v[120:123], a[24:27], a[12:15], v[120:123]
    ds_read_b64_tr_b16 a[62:63], v15 offset:12288
    buffer_store_dwordx4 v[144:147], v2, s[8:11], s70 offen offset:0 sc1
    s_waitcnt lgkmcnt(12)
    v_mfma_f32_16x16x32_bf16 v[100:103], a[28:31], a[0:3], v[100:103]
    v_add_u32 v6, s66, v6
    v_add_u32 v12, s66, v12
    v_mfma_f32_16x16x32_bf16 v[108:111], a[28:31], a[4:7], v[108:111]
    buffer_load_dwordx4 v19, s[24:27], s57 offen offset:3072 sc1 lds
    v_mfma_f32_16x16x32_bf16 v[116:119], a[28:31], a[8:11], v[116:119]
    s_add_u32 s57, s57, 131072
    v_add_u32 v13, s66, v13
    v_add_u32 v14, s66, v14
    v_mfma_f32_16x16x32_bf16 v[124:127], a[28:31], a[12:15], v[124:127]
    s_mov_b32 m0, s59
    v_add_u32 v15, s66, v15
    s_waitcnt vmcnt(24) lgkmcnt(0)
    v_mfma_f32_16x16x32_bf16 v[64:67], a[48:51], a[32:35], v[64:67]
    s_barrier
    v_mfma_f32_16x16x32_bf16 v[72:75], a[48:51], a[36:39], v[72:75]
    ds_read_b128 a[0:3], v6 offset:0
    buffer_load_dwordx4 v2, s[36:39], s56 offen offset:0 sc1 lds
    v_mfma_f32_16x16x32_bf16 v[80:83], a[48:51], a[40:43], v[80:83]
    ds_read_b64_tr_b16 a[16:17], v12 offset:0
    v_mfma_f32_16x16x32_bf16 v[88:91], a[48:51], a[44:47], v[88:91]
    ds_read_b64_tr_b16 a[18:19], v12 offset:4096
    v_mfma_f32_16x16x32_bf16 v[68:71], a[52:55], a[32:35], v[68:71]
    ds_read_b128 a[4:7], v6 offset:1024
    v_mfma_f32_16x16x32_bf16 v[76:79], a[52:55], a[36:39], v[76:79]
    ds_read_b128 a[8:11], v6 offset:2048
    buffer_load_dwordx4 v2, s[36:39], s56 offen offset:1024 sc1 lds
    v_mfma_f32_16x16x32_bf16 v[84:87], a[52:55], a[40:43], v[84:87]
    ds_read_b128 a[12:15], v6 offset:3072
    v_mfma_f32_16x16x32_bf16 v[92:95], a[52:55], a[44:47], v[92:95]
    ds_read_b64_tr_b16 a[20:21], v13 offset:0
    v_mfma_f32_16x16x32_bf16 v[96:99], a[56:59], a[32:35], v[96:99]
    ds_read_b64_tr_b16 a[22:23], v13 offset:4096
    v_mfma_f32_16x16x32_bf16 v[104:107], a[56:59], a[36:39], v[104:107]
    ds_read_b64_tr_b16 a[24:25], v14 offset:0
    buffer_load_dwordx4 v2, s[36:39], s56 offen offset:2048 sc1 lds
    v_mfma_f32_16x16x32_bf16 v[112:115], a[56:59], a[40:43], v[112:115]
    ds_read_b64_tr_b16 a[26:27], v14 offset:4096
    v_mfma_f32_16x16x32_bf16 v[120:123], a[56:59], a[44:47], v[120:123]
    ds_read_b64_tr_b16 a[28:29], v15 offset:0
    buffer_store_dwordx4 v[148:151], v2, s[8:11], s70 offen offset:1024 sc1
    v_mfma_f32_16x16x32_bf16 v[100:103], a[60:63], a[32:35], v[100:103]
    s_add_u32 s64, s64, 1
    ds_read_b64_tr_b16 a[30:31], v15 offset:4096
    v_mfma_f32_16x16x32_bf16 v[108:111], a[60:63], a[36:39], v[108:111]
    buffer_load_dwordx4 v2, s[36:39], s56 offen offset:3072 sc1 lds
    v_mfma_f32_16x16x32_bf16 v[116:119], a[60:63], a[40:43], v[116:119]
    s_add_u32 s56, s56, 262144
    v_mfma_f32_16x16x32_bf16 v[124:127], a[60:63], a[44:47], v[124:127]
    s_waitcnt lgkmcnt(9)
    v_mfma_f32_16x16x32_bf16 v[64:67], a[16:19], a[0:3], v[64:67]
    s_add_u32 m0, s59, 16384
    ds_read_b128 a[32:35], v6 offset:8192
    s_waitcnt lgkmcnt(9)
    v_mfma_f32_16x16x32_bf16 v[72:75], a[16:19], a[4:7], v[72:75]
    ds_read_b64_tr_b16 a[48:49], v12 offset:8192
    buffer_load_dwordx4 v16, s[24:27], s57 offen offset:0 sc1 lds
    s_waitcnt lgkmcnt(9)
    v_mfma_f32_16x16x32_bf16 v[80:83], a[16:19], a[8:11], v[80:83]
    s_add_u32 s59, s58, s60
    ds_read_b64_tr_b16 a[50:51], v12 offset:12288
    s_waitcnt lgkmcnt(9)
    v_mfma_f32_16x16x32_bf16 v[88:91], a[16:19], a[12:15], v[88:91]
    s_add_u32 s58, s58, 32768
    ds_read_b128 a[36:39], v6 offset:9216
    s_waitcnt lgkmcnt(8)
    v_mfma_f32_16x16x32_bf16 v[68:71], a[20:23], a[0:3], v[68:71]
    s_cmp_ge_u32 s58, 163840
    ds_read_b128 a[40:43], v6 offset:10240
    v_mfma_f32_16x16x32_bf16 v[76:79], a[20:23], a[4:7], v[76:79]
    ds_read_b128 a[44:47], v6 offset:11264
    buffer_load_dwordx4 v17, s[24:27], s57 offen offset:1024 sc1 lds
    v_mfma_f32_16x16x32_bf16 v[84:87], a[20:23], a[8:11], v[84:87]
    s_cselect_b32 s66, 4294836224, s100
    ds_read_b64_tr_b16 a[52:53], v13 offset:8192
    v_mfma_f32_16x16x32_bf16 v[92:95], a[20:23], a[12:15], v[92:95]
    s_cselect_b32 s58, 0, s58
    ds_read_b64_tr_b16 a[54:55], v13 offset:12288
    s_waitcnt lgkmcnt(10)
    v_mfma_f32_16x16x32_bf16 v[96:99], a[24:27], a[0:3], v[96:99]
    ds_read_b64_tr_b16 a[56:57], v14 offset:8192
    v_mfma_f32_16x16x32_bf16 v[104:107], a[24:27], a[4:7], v[104:107]
    ds_read_b64_tr_b16 a[58:59], v14 offset:12288
    buffer_load_dwordx4 v18, s[24:27], s57 offen offset:2048 sc1 lds
    v_mfma_f32_16x16x32_bf16 v[112:115], a[24:27], a[8:11], v[112:115]
    ds_read_b64_tr_b16 a[60:61], v15 offset:8192
    v_mfma_f32_16x16x32_bf16 v[120:123], a[24:27], a[12:15], v[120:123]
    ds_read_b64_tr_b16 a[62:63], v15 offset:12288
    buffer_store_dwordx4 v[152:155], v2, s[8:11], s70 offen offset:2048 sc1
    s_waitcnt lgkmcnt(12)
    v_mfma_f32_16x16x32_bf16 v[100:103], a[28:31], a[0:3], v[100:103]
    v_add_u32 v6, s66, v6
    v_add_u32 v12, s66, v12
    v_mfma_f32_16x16x32_bf16 v[108:111], a[28:31], a[4:7], v[108:111]
    buffer_load_dwordx4 v19, s[24:27], s57 offen offset:3072 sc1 lds
    v_mfma_f32_16x16x32_bf16 v[116:119], a[28:31], a[8:11], v[116:119]
    s_add_u32 s57, s57, 131072
    v_add_u32 v13, s66, v13
    v_add_u32 v14, s66, v14
    v_mfma_f32_16x16x32_bf16 v[124:127], a[28:31], a[12:15], v[124:127]
    s_mov_b32 m0, s59
    v_add_u32 v15, s66, v15
    s_waitcnt vmcnt(24) lgkmcnt(0)
    v_mfma_f32_16x16x32_bf16 v[64:67], a[48:51], a[32:35], v[64:67]
    s_barrier
    v_mfma_f32_16x16x32_bf16 v[72:75], a[48:51], a[36:39], v[72:75]
    ds_read_b128 a[0:3], v6 offset:0
    buffer_load_dwordx4 v2, s[36:39], s56 offen offset:0 sc1 lds
    v_mfma_f32_16x16x32_bf16 v[80:83], a[48:51], a[40:43], v[80:83]
    ds_read_b64_tr_b16 a[16:17], v12 offset:0
    v_mfma_f32_16x16x32_bf16 v[88:91], a[48:51], a[44:47], v[88:91]
    ds_read_b64_tr_b16 a[18:19], v12 offset:4096
    v_mfma_f32_16x16x32_bf16 v[68:71], a[52:55], a[32:35], v[68:71]
    ds_read_b128 a[4:7], v6 offset:1024
    v_mfma_f32_16x16x32_bf16 v[76:79], a[52:55], a[36:39], v[76:79]
    ds_read_b128 a[8:11], v6 offset:2048
    buffer_load_dwordx4 v2, s[36:39], s56 offen offset:1024 sc1 lds
    v_mfma_f32_16x16x32_bf16 v[84:87], a[52:55], a[40:43], v[84:87]
    ds_read_b128 a[12:15], v6 offset:3072
    v_mfma_f32_16x16x32_bf16 v[92:95], a[52:55], a[44:47], v[92:95]
    ds_read_b64_tr_b16 a[20:21], v13 offset:0
    v_mfma_f32_16x16x32_bf16 v[96:99], a[56:59], a[32:35], v[96:99]
    ds_read_b64_tr_b16 a[22:23], v13 offset:4096
    v_mfma_f32_16x16x32_bf16 v[104:107], a[56:59], a[36:39], v[104:107]
    ds_read_b64_tr_b16 a[24:25], v14 offset:0
    buffer_load_dwordx4 v2, s[36:39], s56 offen offset:2048 sc1 lds
    v_mfma_f32_16x16x32_bf16 v[112:115], a[56:59], a[40:43], v[112:115]
    ds_read_b64_tr_b16 a[26:27], v14 offset:4096
    v_mfma_f32_16x16x32_bf16 v[120:123], a[56:59], a[44:47], v[120:123]
    ds_read_b64_tr_b16 a[28:29], v15 offset:0
    buffer_store_dwordx4 v[156:159], v2, s[8:11], s70 offen offset:3072 sc1
    s_add_u32 s70, s70, 4096
    v_mfma_f32_16x16x32_bf16 v[100:103], a[60:63], a[32:35], v[100:103]
    s_add_u32 s64, s64, 1
    ds_read_b64_tr_b16 a[30:31], v15 offset:4096
    v_mfma_f32_16x16x32_bf16 v[108:111], a[60:63], a[36:39], v[108:111]
    buffer_load_dwordx4 v2, s[36:39], s56 offen offset:3072 sc1 lds
    v_mfma_f32_16x16x32_bf16 v[116:119], a[60:63], a[40:43], v[116:119]
    s_add_u32 s56, s56, 262144
    v_mfma_f32_16x16x32_bf16 v[124:127], a[60:63], a[44:47], v[124:127]
    s_mov_b32 s67, 32
    s_branch m_l3147
m_n178:
    s_cmp_lg_u32 s64, 32
    s_cbranch_scc1 m_n179
    s_lshl_b32 s91, s96, 3
    s_add_u32 s91, s91, s97
    s_lshl_b32 s91, s91, 7
    s_add_u32 s91, s91, 16384
    s_cmp_lg_u32 s16, 0
    s_cbranch_scc1 m_np180
    v_mov_b32 v60, s4
    v_mov_b32 v61, s5
    s_add_u32 s90, s91, 117440512
    s_mov_b64 exec, 1
    buffer_store_dwordx2 v[60:61], off, s[8:11], s90 sc1
    s_mov_b64 exec, -1
m_np180:
    s_mov_b32 s67, 35
    s_branch m_l3147
m_n179:
    s_cmp_lg_u32 s64, 35
    s_cbranch_scc1 m_n181
    s_mov_b32 s38, 0
    s_mov_b32 s67, 40
    s_branch m_l3147
m_n181:
    s_branch m_l3x149
m_l3c150:
    s_mov_b32 s67, 34
    s_cmp_lt_u32 s64, 34
    s_cbranch_scc1 m_l3n151
    s_cmp_lg_u32 s64, 34
    s_cbranch_scc1 m_n183
    s_mov_b32 s68, 1000
    s_mov_b32 s67, 35
    s_branch m_l3147
m_n183:
    s_cmp_lg_u32 s64, 35
    s_cbranch_scc1 m_n184
    s_mov_b32 s38, 0
    s_lshl_b32 s91, s96, 3
    s_add_u32 s91, s91, s97
    s_lshl_b32 s91, s91, 7
    s_add_u32 s91, s91, 16384
    s_add_u32 s52, s91, 117440512
    buffer_load_dwordx2 v[4:5], off, s[8:11], s52 sc1
    s_mov_b32 s67, 36
    s_branch m_l3147
m_n184:
    s_cmp_lg_u32 s64, 36
    s_cbranch_scc1 m_n185
    s_mov_b32 s26, 0
    s_mov_b32 s67, 37
    s_branch m_l3147
m_n185:
    s_cmp_lg_u32 s64, 37
    s_cbranch_scc1 m_n186
    s_waitcnt vmcnt(16)
    s_mov_b32 s3, 1048576
m_spin187:
    v_cmp_ne_u64 s[76:77], s[4:5], v[4:5]
    s_nop 3
    s_cmp_eq_u64 s[76:77], 0
    s_cbranch_scc1 m_ok188
    s_sub_u32 s3, s3, 1
    s_cbranch_scc1 m_ok188
    s_sleep 8
    buffer_load_dwordx2 v[4:5], off, s[8:11], s52 sc1
    s_waitcnt vmcnt(0)
    s_branch m_spin187
m_ok188:
    s_lshl_b32 s90, s96, 3
    s_add_u32 s90, s90, s97
    s_lshl_b32 s90, s90, 15
    s_lshl_b32 s91, s16, 13
    s_add_u32 s90, s90, s91
    s_add_u32 s70, s90, 100663296
    buffer_load_dwordx4 v[128:131], v2, s[8:11], s70 offen offset:0 sc1
    buffer_load_dwordx4 v[132:135], v2, s[8:11], s70 offen offset:1024 sc1
    buffer_load_dwordx4 v[136:139], v2, s[8:11], s70 offen offset:2048 sc1
    buffer_load_dwordx4 v[140:143], v2, s[8:11], s70 offen offset:3072 sc1
    s_add_u32 s70, s70, 4096
    buffer_load_dwordx4 v[144:147], v2, s[8:11], s70 offen offset:0 sc1
    buffer_load_dwordx4 v[148:151], v2, s[8:11], s70 offen offset:1024 sc1
    buffer_load_dwordx4 v[152:155], v2, s[8:11], s70 offen offset:2048 sc1
    buffer_load_dwordx4 v[156:159], v2, s[8:11], s70 offen offset:3072 sc1
    s_mov_b32 s67, 40
    s_branch m_l3147
m_n186:
    s_branch m_l3x149
m_o1171:
    s_and_b32 s91, s2, 7
    s_lshl_b32 s91, s91, 5
    s_lshr_b32 s92, s2, 3
    s_add_u32 s91, s91, s92
    s_lshl_b32 s91, s91, 3
    s_add_u32 s91, s91, 12288
    s_cmp_lg_u32 s16, 0
    s_cbranch_scc1 m_np190
    v_mov_b32 v60, s4
    v_mov_b32 v61, s5
    s_add_u32 s90, s91, 117440512
    s_mov_b64 exec, 1
    buffer_store_dwordx2 v[60:61], off, s[8:11], s90 sc1
    s_mov_b64 exec, -1
m_np190:
    s_branch m_o2172
m_l3n151:
    s_sub_u32 s90, s68, 5
    s_min_u32 s67, s67, s90
    s_branch m_l3147
m_l3x149:
    s_cmp_eq_u32 s95, 1
    s_cbranch_scc1 m_noadd191
    s_waitcnt vmcnt(0)
    v_lshlrev_b32 v160, 16, v128
    v_and_b32 v161, 0xffff0000, v128
    v_lshlrev_b32 v162, 16, v129
    v_and_b32 v163, 0xffff0000, v129
    v_lshlrev_b32 v164, 16, v130
    v_and_b32 v165, 0xffff0000, v130
    v_lshlrev_b32 v166, 16, v131
    v_and_b32 v167, 0xffff0000, v131
    v_lshlrev_b32 v168, 16, v132
    v_and_b32 v169, 0xffff0000, v132
    v_lshlrev_b32 v170, 16, v133
    v_and_b32 v171, 0xffff0000, v133
    v_lshlrev_b32 v172, 16, v134
    v_and_b32 v173, 0xffff0000, v134
    v_lshlrev_b32 v174, 16, v135
    v_and_b32 v175, 0xffff0000, v135
    v_lshlrev_b32 v176, 16, v136
    v_and_b32 v177, 0xffff0000, v136
    v_lshlrev_b32 v178, 16, v137
    v_and_b32 v179, 0xffff0000, v137
    v_lshlrev_b32 v180, 16, v138
    v_and_b32 v181, 0xffff0000, v138
    v_lshlrev_b32 v182, 16, v139
    v_and_b32 v183, 0xffff0000, v139
    v_lshlrev_b32 v184, 16, v140
    v_and_b32 v185, 0xffff0000, v140
    v_lshlrev_b32 v186, 16, v141
    v_and_b32 v187, 0xffff0000, v141
    v_lshlrev_b32 v188, 16, v142
    v_and_b32 v189, 0xffff0000, v142
    v_lshlrev_b32 v190, 16, v143
    v_and_b32 v191, 0xffff0000, v143
    v_lshlrev_b32 v192, 16, v144
    v_and_b32 v193, 0xffff0000, v144
    v_lshlrev_b32 v194, 16, v145
    v_and_b32 v195, 0xffff0000, v145
    v_lshlrev_b32 v196, 16, v146
    v_and_b32 v197, 0xffff0000, v146
    v_lshlrev_b32 v198, 16, v147
    v_and_b32 v199, 0xffff0000, v147
    v_lshlrev_b32 v200, 16, v148
    v_and_b32 v201, 0xffff0000, v148
    v_lshlrev_b32 v202, 16, v149
    v_and_b32 v203, 0xffff0000, v149
    v_lshlrev_b32 v204, 16, v150
    v_and_b32 v205, 0xffff0000, v150
    v_lshlrev_b32 v206, 16, v151
    v_and_b32 v207, 0xffff0000, v151
    v_lshlrev_b32 v208, 16, v152
    v_and_b32 v209, 0xffff0000, v152
    v_lshlrev_b32 v210, 16, v153
    v_and_b32 v211, 0xffff0000, v153
    v_lshlrev_b32 v212, 16, v154
    v_and_b32 v213, 0xffff0000, v154
    v_lshlrev_b32 v214, 16, v155
    v_and_b32 v215, 0xffff0000, v155
    v_lshlrev_b32 v216, 16, v156
    v_and_b32 v217, 0xffff0000, v156
    v_lshlrev_b32 v218, 16, v157
    v_and_b32 v219, 0xffff0000, v157
    v_lshlrev_b32 v220, 16, v158
    v_and_b32 v221, 0xffff0000, v158
    v_lshlrev_b32 v222, 16, v159
    v_and_b32 v223, 0xffff0000, v159
    v_pk_add_f32 v[64:65], v[64:65], v[160:161]
    v_pk_add_f32 v[66:67], v[66:67], v[162:163]
    v_pk_add_f32 v[68:69], v[68:69], v[164:165]
    v_pk_add_f32 v[70:71], v[70:71], v[166:167]
    v_pk_add_f32 v[72:73], v[72:73], v[168:169]
    v_pk_add_f32 v[74:75], v[74:75], v[170:171]
    v_pk_add_f32 v[76:77], v[76:77], v[172:173]
    v_pk_add_f32 v[78:79], v[78:79], v[174:175]
    v_pk_add_f32 v[80:81], v[80:81], v[176:177]
    v_pk_add_f32 v[82:83], v[82:83], v[178:179]
    v_pk_add_f32 v[84:85], v[84:85], v[180:181]
    v_pk_add_f32 v[86:87], v[86:87], v[182:183]
    v_pk_add_f32 v[88:89], v[88:89], v[184:185]
    v_pk_add_f32 v[90:91], v[90:91], v[186:187]
    v_pk_add_f32 v[92:93], v[92:93], v[188:189]
    v_pk_add_f32 v[94:95], v[94:95], v[190:191]
    v_pk_add_f32 v[96:97], v[96:97], v[192:193]
    v_pk_add_f32 v[98:99], v[98:99], v[194:195]
    v_pk_add_f32 v[100:101], v[100:101], v[196:197]
    v_pk_add_f32 v[102:103], v[102:103], v[198:199]
    v_pk_add_f32 v[104:105], v[104:105], v[200:201]
    v_pk_add_f32 v[106:107], v[106:107], v[202:203]
    v_pk_add_f32 v[108:109], v[108:109], v[204:205]
    v_pk_add_f32 v[110:111], v[110:111], v[206:207]
    v_pk_add_f32 v[112:113], v[112:113], v[208:209]
    v_pk_add_f32 v[114:115], v[114:115], v[210:211]
    v_pk_add_f32 v[116:117], v[116:117], v[212:213]
    v_pk_add_f32 v[118:119], v[118:119], v[214:215]
    v_pk_add_f32 v[120:121], v[120:121], v[216:217]
    v_pk_add_f32 v[122:123], v[122:123], v[218:219]
    v_pk_add_f32 v[124:125], v[124:125], v[220:221]
    v_pk_add_f32 v[126:127], v[126:127], v[222:223]
m_noadd191:
    v_cvt_pk_bf16_f32 v64, v64, v65
    v_cvt_pk_bf16_f32 v65, v66, v67
    v_cvt_pk_bf16_f32 v66, v68, v69
    v_cvt_pk_bf16_f32 v67, v70, v71
    v_cvt_pk_bf16_f32 v96, v96, v97
    v_cvt_pk_bf16_f32 v97, v98, v99
    v_cvt_pk_bf16_f32 v98, v100, v101
    v_cvt_pk_bf16_f32 v99, v102, v103
    s_nop 1
    v_permlane16_swap_b32 v64, v66
    v_permlane16_swap_b32 v65, v67
    v_permlane16_swap_b32 v96, v98
    v_permlane16_swap_b32 v97, v99
    buffer_store_dwordx4 v[64:67], v7, s[28:31], s71 offen offset:0 sc1
    buffer_store_dwordx4 v[96:99], v7, s[28:31], s71 offen offset:64 sc1
    s_add_u32 s71, s71, s72
    v_cvt_pk_bf16_f32 v72, v72, v73
    v_cvt_pk_bf16_f32 v73, v74, v75
    v_cvt_pk_bf16_f32 v74, v76, v77
    v_cvt_pk_bf16_f32 v75, v78, v79
    v_cvt_pk_bf16_f32 v104, v104, v105
    v_cvt_pk_bf16_f32 v105, v106, v107
    v_cvt_pk_bf16_f32 v106, v108, v109
    v_cvt_pk_bf16_f32 v107, v110, v111
    s_nop 1
    v_permlane16_swap_b32 v72, v74
    v_permlane16_swap_b32 v73, v75
    v_permlane16_swap_b32 v104, v106
    v_permlane16_swap_b32 v105, v107
    buffer_store_dwordx4 v[72:75], v7, s[28:31], s71 offen offset:0 sc1
    buffer_store_dwordx4 v[104:107], v7, s[28:31], s71 offen offset:64 sc1
    s_add_u32 s71, s71, s72
    v_cvt_pk_bf16_f32 v80, v80, v81
    v_cvt_pk_bf16_f32 v81, v82, v83
    v_cvt_pk_bf16_f32 v82, v84, v85
    v_cvt_pk_bf16_f32 v83, v86, v87
    v_cvt_pk_bf16_f32 v112, v112, v113
    v_cvt_pk_bf16_f32 v113, v114, v115
    v_cvt_pk_bf16_f32 v114, v116, v117
    v_cvt_pk_bf16_f32 v115, v118, v119
    s_nop 1
    v_permlane16_swap_b32 v80, v82
    v_permlane16_swap_b32 v81, v83
    v_permlane16_swap_b32 v112, v114
    v_permlane16_swap_b32 v113, v115
    buffer_store_dwordx4 v[80:83], v7, s[28:31], s71 offen offset:0 sc1
    buffer_store_dwordx4 v[112:115], v7, s[28:31], s71 offen offset:64 sc1
    s_add_u32 s71, s71, s72
    v_cvt_pk_bf16_f32 v88, v88, v89
    v_cvt_pk_bf16_f32 v89, v90, v91
    v_cvt_pk_bf16_f32 v90, v92, v93
    v_cvt_pk_bf16_f32 v91, v94, v95
    v_cvt_pk_bf16_f32 v120, v120, v121
    v_cvt_pk_bf16_f32 v121, v122, v123
    v_cvt_pk_bf16_f32 v122, v124, v125
    v_cvt_pk_bf16_f32 v123, v126, v127
    s_nop 1
    v_permlane16_swap_b32 v88, v90
    v_permlane16_swap_b32 v89, v91
    v_permlane16_swap_b32 v120, v122
    v_permlane16_swap_b32 v121, v123
    buffer_store_dwordx4 v[88:91], v7, s[28:31], s71 offen offset:0 sc1
    buffer_store_dwordx4 v[120:123], v7, s[28:31], s71 offen offset:64 sc1
    s_add_u32 s71, s71, s72
m_end1:
    s_endpgm
m_stub94:
    v_cmp_lt_f32 vcc, s65, v8
    s_cmp_lg_u32 s64, s67
    s_cbranch_scc1 m_e193
    v_add_f32 v176, v176, v16
    v_mov_b32 v180, v9
    v_add_f32 v188, v188, v16
    v_add_f32 v177, v177, v17
    v_mov_b32 v181, v9
    v_add_f32 v189, v189, v17
    v_add_f32 v178, v178, v18
    v_mov_b32 v182, v9
    v_add_f32 v190, v190, v18
    v_add_f32 v179, v179, v19
    v_mov_b32 v183, v9
    v_add_f32 v191, v191, v19
    s_nop 0
m_e193:
    s_cmp_lg_u32 s64, s68
    s_cbranch_scc1 m_e194
    v_mov_b32 v176, v9
    v_mov_b32 v184, v9
    v_mov_b32 v188, v9
    v_mov_b32 v177, v9
    v_mov_b32 v185, v9
    v_mov_b32 v189, v9
    v_mov_b32 v178, v9
    v_mov_b32 v186, v9
    v_mov_b32 v190, v9
    v_mov_b32 v179, v9
    v_mov_b32 v187, v9
    v_mov_b32 v191, v9
    s_nop 0
m_e194:
    s_cbranch_vccnz m_rc195
m_sp192:
    s_branch m_ret95
m_stub97:
    v_cmp_lt_f32 vcc, s65, v8
    s_cmp_lg_u32 s64, s67
    s_cbranch_scc1 m_e197
    v_add_f32 v176, v176, v16
    v_mov_b32 v180, v9
    v_add_f32 v188, v188, v16
    v_add_f32 v177, v177, v17
    v_mov_b32 v181, v9
    v_add_f32 v189, v189, v17
    v_add_f32 v178, v178, v18
    v_mov_b32 v182, v9
    v_add_f32 v190, v190, v18
    v_add_f32 v179, v179, v19
    v_mov_b32 v183, v9
    v_add_f32 v191, v191, v19
    s_nop 0
m_e197:
    s_cmp_lg_u32 s64, s68
    s_cbranch_scc1 m_e198
    v_mov_b32 v176, v9
    v_mov_b32 v184, v9
    v_mov_b32 v188, v9
    v_mov_b32 v177, v9
    v_mov_b32 v185, v9
    v_mov_b32 v189, v9
    v_mov_b32 v178, v9
    v_mov_b32 v186, v9
    v_mov_b32 v190, v9
    v_mov_b32 v179, v9
    v_mov_b32 v187, v9
    v_mov_b32 v191, v9
    s_nop 0
m_e198:
    s_cbranch_vccnz m_rc199
m_sp196:
    s_branch m_ret98
m_stub115:
    v_cmp_lt_f32 vcc, s65, v8
    s_cmp_lg_u32 s64, s70
    s_cbranch_scc1 m_e201
    v_add_f32 v160, v160, v16
    v_mov_b32 v164, v9
    v_add_f32 v172, v172, v16
    v_add_f32 v161, v161, v17
    v_mov_b32 v165, v9
    v_add_f32 v173, v173, v17
    v_add_f32 v162, v162, v18
    v_mov_b32 v166, v9
    v_add_f32 v174, v174, v18
    v_add_f32 v163, v163, v19
    v_mov_b32 v167, v9
    v_add_f32 v175, v175, v19
    s_nop 0
m_e201:
    s_cmp_lg_u32 s64, s71
    s_cbranch_scc1 m_e202
    v_mov_b32 v160, v9
    v_mov_b32 v168, v9
    v_mov_b32 v172, v9
    v_mov_b32 v161, v9
    v_mov_b32 v169, v9
    v_mov_b32 v173, v9
    v_mov_b32 v162, v9
    v_mov_b32 v170, v9
    v_mov_b32 v174, v9
    v_mov_b32 v163, v9
    v_mov_b32 v171, v9
    v_mov_b32 v175, v9
    s_nop 0
m_e202:
    s_cbranch_vccnz m_rc203
m_sp200:
    s_branch m_ret116
m_stub117:
    v_cmp_lt_f32 vcc, s65, v8
    s_cmp_lg_u32 s64, s70
    s_cbranch_scc1 m_e205
    v_add_f32 v160, v160, v16
    v_mov_b32 v164, v9
    v_add_f32 v172, v172, v16
    v_add_f32 v161, v161, v17
    v_mov_b32 v165, v9
    v_add_f32 v173, v173, v17
    v_add_f32 v162, v162, v18
    v_mov_b32 v166, v9
    v_add_f32 v174, v174, v18
    v_add_f32 v163, v163, v19
    v_mov_b32 v167, v9
    v_add_f32 v175, v175, v19
    s_nop 0
m_e205:
    s_cmp_lg_u32 s64, s71
    s_cbranch_scc1 m_e206
    v_mov_b32 v160, v9
    v_mov_b32 v168, v9
    v_mov_b32 v172, v9
    v_mov_b32 v161, v9
    v_mov_b32 v169, v9
    v_mov_b32 v173, v9
    v_mov_b32 v162, v9
    v_mov_b32 v170, v9
    v_mov_b32 v174, v9
    v_mov_b32 v163, v9
    v_mov_b32 v171, v9
    v_mov_b32 v175, v9
    s_nop 0
m_e206:
    s_cmp_lg_u32 s64, s53
    s_cbranch_scc1 m_e209
    s_cmp_lg_u32 s16, 0
    s_cbranch_scc1 m_np210
    v_mov_b32 v60, s4
    v_mov_b32 v61, s5
    s_add_u32 s90, s101, 117440512
    s_mov_b64 exec, 1
    buffer_store_dwordx2 v[60:61], off, s[8:11], s90 sc1
    s_mov_b64 exec, -1
m_np210:
    s_mov_b32 s101, -1
m_e209:
    s_cmp_gt_u32 s64, 24
    s_cbranch_scc1 m_e207
    s_cmp_lg_u32 s64, 8
    s_cbranch_scc1 m_e211
    s_lshr_b32 s90, s32, 1
    s_lshl_b32 s90, s90, 7
    s_add_u32 s90, s90, 117440600
    v_min_u32 v0, 1, v1
    v_lshlrev_b32 v0, 5, v0
    buffer_load_dwordx2 v[4:5], v0, s[8:11], s90 offen sc1
    s_cmp_eq_u32 s17, -1
    s_cbranch_scc1 m_e207
    s_cmp_lg_u32 s16, 0
    s_cbranch_scc1 m_np212
    v_mov_b32 v60, s4
    v_mov_b32 v61, s5
    s_add_u32 s90, s17, 117440512
    s_mov_b64 exec, 1
    buffer_store_dwordx2 v[60:61], off, s[8:11], s90 sc1
    s_mov_b64 exec, -1
m_np212:
    s_branch m_e207
m_e211:
    s_cmp_lg_u32 s64, 16
    s_cbranch_scc1 m_e213
    s_waitcnt vmcnt(18)
    s_mov_b32 s3, 1048576
m_spin214:
    v_cmp_ne_u64 s[76:77], s[4:5], v[4:5]
    s_nop 3
    s_cmp_eq_u64 s[76:77], 0
    s_cbranch_scc1 m_e207
    s_sub_u32 s3, s3, 1
    s_cbranch_scc1 m_e207
    s_sleep 32
    s_lshr_b32 s90, s32, 1
    s_lshl_b32 s90, s90, 7
    s_add_u32 s90, s90, 117440600
    v_min_u32 v0, 1, v1
    v_lshlrev_b32 v0, 5, v0
    buffer_load_dwordx2 v[4:5], v0, s[8:11], s90 offen sc1
    s_waitcnt vmcnt(0)
    s_branch m_spin214
    s_branch m_e207
m_e213:
    s_cmp_lg_u32 s64, 20
    s_cbranch_scc1 m_e215
    buffer_load_dwordx2 v[4:5], v10, s[8:11], 0 offen sc1
    s_mov_b32 s44, s48
    s_mov_b32 s45, s49
    s_mov_b32 s46, 8388608
    s_lshl_b32 s90, s2, 2
    s_add_u32 s90, s90, s16
    s_lshl_b32 s90, s90, 13
    v_lshlrev_b32 v62, 7, v1
    buffer_load_dword v255, v62, s[44:47], s90 offen
    s_branch m_e207
m_e215:
    s_cmp_lg_u32 s64, 24
    s_cbranch_scc1 m_e216
    s_mov_b32 s44, s50
    s_mov_b32 s45, s51
    s_mov_b32 s46, 2097152
    s_lshl_b32 s90, s2, 2
    s_add_u32 s90, s90, s16
    s_lshl_b32 s90, s90, 13
    v_lshlrev_b32 v62, 7, v1
    buffer_load_dword v255, v62, s[44:47], s90 offen
    s_waitcnt vmcnt(18)
    s_mov_b32 s3, 1048576
m_spin217:
    v_cmp_ne_u64 s[76:77], s[4:5], v[4:5]
    s_nop 3
    s_cmp_eq_u64 s[76:77], 0
    s_cbranch_scc1 m_e207
    s_sub_u32 s3, s3, 1
    s_cbranch_scc1 m_e207
    s_sleep 32
    buffer_load_dwordx2 v[4:5], v10, s[8:11], 0 offen sc1
    s_waitcnt vmcnt(0)
    s_branch m_spin217
    s_branch m_e207
m_e216:
m_e207:
    s_cbranch_vccnz m_rc218
m_sp204:
    s_branch m_ret118
m_stub121:
    v_cmp_lt_f32 vcc, s65, v8
    s_cmp_lg_u32 s64, s70
    s_cbranch_scc1 m_e220
    v_add_f32 v160, v160, v16
    v_mov_b32 v164, v9
    v_add_f32 v172, v172, v16
    v_add_f32 v161, v161, v17
    v_mov_b32 v165, v9
    v_add_f32 v173, v173, v17
    v_add_f32 v162, v162, v18
    v_mov_b32 v166, v9
    v_add_f32 v174, v174, v18
    v_add_f32 v163, v163, v19
    v_mov_b32 v167, v9
    v_add_f32 v175, v175, v19
    s_nop 0
m_e220:
    s_cmp_lg_u32 s64, s71
    s_cbranch_scc1 m_e221
    v_mov_b32 v160, v9
    v_mov_b32 v168, v9
    v_mov_b32 v172, v9
    v_mov_b32 v161, v9
    v_mov_b32 v169, v9
    v_mov_b32 v173, v9
    v_mov_b32 v162, v9
    v_mov_b32 v170, v9
    v_mov_b32 v174, v9
    v_mov_b32 v163, v9
    v_mov_b32 v171, v9
    v_mov_b32 v175, v9
    s_nop 0
m_e221:
    s_cbranch_vccnz m_rc222
m_sp219:
    s_branch m_ret122
m_stub138:
    v_cmp_lt_f32 vcc, s65, v8
    s_cbranch_vccnz m_rc224
m_sp223:
    s_branch m_ret139
m_rc114:
    s_call_b64 s[74:75], m_rs0488
    s_branch m_sp99
m_rc137:
    s_call_b64 s[74:75], m_rs0287
    s_branch m_sp123
m_rc195:
    s_call_b64 s[74:75], m_rs0488
    s_branch m_sp192
m_rc199:
    s_call_b64 s[74:75], m_rs1490
    s_branch m_sp196
m_rc203:
    s_call_b64 s[74:75], m_rs1490
    s_branch m_sp200
m_rc218:
    s_call_b64 s[74:75], m_rs0287
    s_branch m_sp204
m_rc222:
    s_call_b64 s[74:75], m_rs1289
    s_branch m_sp219
m_rc224:
    s_call_b64 s[74:75], m_rs1289
    s_branch m_sp223
m_rs0287:
    s_nop 15
    v_max3_f32 v48, v64, v65, v66
    v_max3_f32 v48, v48, v67, v68
    v_max3_f32 v48, v48, v69, v70
    v_max3_f32 v48, v48, v71, 0
    v_mov_b32 v49, v48
    s_nop 1
    v_permlane32_swap_b32 v48, v49
    s_nop 1
    v_max_f32 v48, v48, v49
    v_mov_b32 v49, v48
    s_nop 1
    v_permlane16_swap_b32 v48, v49
    s_nop 1
    v_max_f32 v48, v48, v49
    v_exp_f32 v49, -v48
    v_sub_f32 v64, v64, v48
    v_sub_f32 v65, v65, v48
    v_sub_f32 v66, v66, v48
    v_sub_f32 v67, v67, v48
    v_sub_f32 v68, v68, v48
    v_sub_f32 v69, v69, v48
    v_sub_f32 v70, v70, v48
    v_sub_f32 v71, v71, v48
    v_sub_f32 v96, v96, v48
    v_sub_f32 v97, v97, v48
    v_sub_f32 v98, v98, v48
    v_sub_f32 v99, v99, v48
    v_sub_f32 v100, v100, v48
    v_sub_f32 v101, v101, v48
    v_sub_f32 v102, v102, v48
    v_sub_f32 v103, v103, v48
    v_sub_f32 v160, v160, v48
    v_sub_f32 v161, v161, v48
    v_sub_f32 v162, v162, v48
    v_sub_f32 v163, v163, v48
    v_sub_f32 v164, v164, v48
    v_sub_f32 v165, v165, v48
    v_sub_f32 v166, v166, v48
    v_sub_f32 v167, v167, v48
    v_mul_f32 v12, v12, v49
    v_accvgpr_read_b32 v52, a0
    v_accvgpr_read_b32 v53, a1
    v_accvgpr_read_b32 v54, a2
    v_accvgpr_read_b32 v55, a3
    v_accvgpr_read_b32 v56, a4
    v_accvgpr_read_b32 v57, a5
    v_accvgpr_read_b32 v58, a6
    v_accvgpr_read_b32 v59, a7
    v_mul_f32 v52, v52, v49
    v_mul_f32 v53, v53, v49
    v_mul_f32 v54, v54, v49
    v_mul_f32 v55, v55, v49
    v_mul_f32 v56, v56, v49
    v_mul_f32 v57, v57, v49
    v_mul_f32 v58, v58, v49
    v_mul_f32 v59, v59, v49
    v_accvgpr_write_b32 a0, v52
    v_accvgpr_write_b32 a1, v53
    v_accvgpr_write_b32 a2, v54
    v_accvgpr_write_b32 a3, v55
    v_accvgpr_write_b32 a4, v56
    v_accvgpr_write_b32 a5, v57
    v_accvgpr_write_b32 a6, v58
    v_accvgpr_write_b32 a7, v59
    v_accvgpr_read_b32 v52, a8
    v_accvgpr_read_b32 v53, a9
    v_accvgpr_read_b32 v54, a10
    v_accvgpr_read_b32 v55, a11
    v_accvgpr_read_b32 v56, a12
    v_accvgpr_read_b32 v57, a13
    v_accvgpr_read_b32 v58, a14
    v_accvgpr_read_b32 v59, a15
    v_mul_f32 v52, v52, v49
    v_mul_f32 v53, v53, v49
    v_mul_f32 v54, v54, v49
    v_mul_f32 v55, v55, v49
    v_mul_f32 v56, v56, v49
    v_mul_f32 v57, v57, v49
    v_mul_f32 v58, v58, v49
    v_mul_f32 v59, v59, v49
    v_accvgpr_write_b32 a8, v52
    v_accvgpr_write_b32 a9, v53
    v_accvgpr_write_b32 a10, v54
    v_accvgpr_write_b32 a11, v55
    v_accvgpr_write_b32 a12, v56
    v_accvgpr_write_b32 a13, v57
    v_accvgpr_write_b32 a14, v58
    v_accvgpr_write_b32 a15, v59
    v_accvgpr_read_b32 v52, a16
    v_accvgpr_read_b32 v53, a17
    v_accvgpr_read_b32 v54, a18
    v_accvgpr_read_b32 v55, a19
    v_accvgpr_read_b32 v56, a20
    v_accvgpr_read_b32 v57, a21
    v_accvgpr_read_b32 v58, a22
    v_accvgpr_read_b32 v59, a23
    v_mul_f32 v52, v52, v49
    v_mul_f32 v53, v53, v49
    v_mul_f32 v54, v54, v49
    v_mul_f32 v55, v55, v49
    v_mul_f32 v56, v56, v49
    v_mul_f32 v57, v57, v49
    v_mul_f32 v58, v58, v49
    v_mul_f32 v59, v59, v49
    v_accvgpr_write_b32 a16, v52
    v_accvgpr_write_b32 a17, v53
    v_accvgpr_write_b32 a18, v54
    v_accvgpr_write_b32 a19, v55
    v_accvgpr_write_b32 a20, v56
    v_accvgpr_write_b32 a21, v57
    v_accvgpr_write_b32 a22, v58
    v_accvgpr_write_b32 a23, v59
    v_accvgpr_read_b32 v52, a24
    v_accvgpr_read_b32 v53, a25
    v_accvgpr_read_b32 v54, a26
    v_accvgpr_read_b32 v55, a27
    v_accvgpr_read_b32 v56, a28
    v_accvgpr_read_b32 v57, a29
    v_accvgpr_read_b32 v58, a30
    v_accvgpr_read_b32 v59, a31
    v_mul_f32 v52, v52, v49
    v_mul_f32 v53, v53, v49
    v_mul_f32 v54, v54, v49
    v_mul_f32 v55, v55, v49
    v_mul_f32 v56, v56, v49
    v_mul_f32 v57, v57, v49
    v_mul_f32 v58, v58, v49
    v_mul_f32 v59, v59, v49
    v_accvgpr_write_b32 a24, v52
    v_accvgpr_write_b32 a25, v53
    v_accvgpr_write_b32 a26, v54
    v_accvgpr_write_b32 a27, v55
    v_accvgpr_write_b32 a28, v56
    v_accvgpr_write_b32 a29, v57
    v_accvgpr_write_b32 a30, v58
    v_accvgpr_write_b32 a31, v59
    v_exp_f32 v52, v64
    v_exp_f32 v53, v65
    v_exp_f32 v54, v66
    v_exp_f32 v55, v67
    v_exp_f32 v56, v68
    v_exp_f32 v57, v69
    v_exp_f32 v58, v70
    v_exp_f32 v59, v71
    s_nop 0
    v_cvt_pk_bf16_f32 v128, v52, v53
    v_cvt_pk_bf16_f32 v129, v54, v55
    v_cvt_pk_bf16_f32 v130, v56, v57
    v_cvt_pk_bf16_f32 v131, v58, v59
    s_nop 1
    v_mfma_f32_16x16x32_bf16 v[28:31], v[44:47], v[128:131], 0
    v_max3_f32 v48, v72, v73, v74
    v_max3_f32 v48, v48, v75, v76
    v_max3_f32 v48, v48, v77, v78
    v_max3_f32 v48, v48, v79, 0
    v_mov_b32 v49, v48
    s_nop 1
    v_permlane32_swap_b32 v48, v49
    s_nop 1
    v_max_f32 v48, v48, v49
    v_mov_b32 v49, v48
    s_nop 1
    v_permlane16_swap_b32 v48, v49
    s_nop 1
    v_max_f32 v48, v48, v49
    v_exp_f32 v49, -v48
    v_sub_f32 v72, v72, v48
    v_sub_f32 v73, v73, v48
    v_sub_f32 v74, v74, v48
    v_sub_f32 v75, v75, v48
    v_sub_f32 v76, v76, v48
    v_sub_f32 v77, v77, v48
    v_sub_f32 v78, v78, v48
    v_sub_f32 v79, v79, v48
    v_sub_f32 v104, v104, v48
    v_sub_f32 v105, v105, v48
    v_sub_f32 v106, v106, v48
    v_sub_f32 v107, v107, v48
    v_sub_f32 v108, v108, v48
    v_sub_f32 v109, v109, v48
    v_sub_f32 v110, v110, v48
    v_sub_f32 v111, v111, v48
    v_sub_f32 v168, v168, v48
    v_sub_f32 v169, v169, v48
    v_sub_f32 v170, v170, v48
    v_sub_f32 v171, v171, v48
    v_sub_f32 v172, v172, v48
    v_sub_f32 v173, v173, v48
    v_sub_f32 v174, v174, v48
    v_sub_f32 v175, v175, v48
    v_mul_f32 v13, v13, v49
    v_accvgpr_read_b32 v52, a32
    v_accvgpr_read_b32 v53, a33
    v_accvgpr_read_b32 v54, a34
    v_accvgpr_read_b32 v55, a35
    v_accvgpr_read_b32 v56, a36
    v_accvgpr_read_b32 v57, a37
    v_accvgpr_read_b32 v58, a38
    v_accvgpr_read_b32 v59, a39
    v_mul_f32 v52, v52, v49
    v_mul_f32 v53, v53, v49
    v_mul_f32 v54, v54, v49
    v_mul_f32 v55, v55, v49
    v_mul_f32 v56, v56, v49
    v_mul_f32 v57, v57, v49
    v_mul_f32 v58, v58, v49
    v_mul_f32 v59, v59, v49
    v_accvgpr_write_b32 a32, v52
    v_accvgpr_write_b32 a33, v53
    v_accvgpr_write_b32 a34, v54
    v_accvgpr_write_b32 a35, v55
    v_accvgpr_write_b32 a36, v56
    v_accvgpr_write_b32 a37, v57
    v_accvgpr_write_b32 a38, v58
    v_accvgpr_write_b32 a39, v59
    v_accvgpr_read_b32 v52, a40
    v_accvgpr_read_b32 v53, a41
    v_accvgpr_read_b32 v54, a42
    v_accvgpr_read_b32 v55, a43
    v_accvgpr_read_b32 v56, a44
    v_accvgpr_read_b32 v57, a45
    v_accvgpr_read_b32 v58, a46
    v_accvgpr_read_b32 v59, a47
    v_mul_f32 v52, v52, v49
    v_mul_f32 v53, v53, v49
    v_mul_f32 v54, v54, v49
    v_mul_f32 v55, v55, v49
    v_mul_f32 v56, v56, v49
    v_mul_f32 v57, v57, v49
    v_mul_f32 v58, v58, v49
    v_mul_f32 v59, v59, v49
    v_accvgpr_write_b32 a40, v52
    v_accvgpr_write_b32 a41, v53
    v_accvgpr_write_b32 a42, v54
    v_accvgpr_write_b32 a43, v55
    v_accvgpr_write_b32 a44, v56
    v_accvgpr_write_b32 a45, v57
    v_accvgpr_write_b32 a46, v58
    v_accvgpr_write_b32 a47, v59
    v_accvgpr_read_b32 v52, a48
    v_accvgpr_read_b32 v53, a49
    v_accvgpr_read_b32 v54, a50
    v_accvgpr_read_b32 v55, a51
    v_accvgpr_read_b32 v56, a52
    v_accvgpr_read_b32 v57, a53
    v_accvgpr_read_b32 v58, a54
    v_accvgpr_read_b32 v59, a55
    v_mul_f32 v52, v52, v49
    v_mul_f32 v53, v53, v49
    v_mul_f32 v54, v54, v49
    v_mul_f32 v55, v55, v49
    v_mul_f32 v56, v56, v49
    v_mul_f32 v57, v57, v49
    v_mul_f32 v58, v58, v49
    v_mul_f32 v59, v59, v49
    v_accvgpr_write_b32 a48, v52
    v_accvgpr_write_b32 a49, v53
    v_accvgpr_write_b32 a50, v54
    v_accvgpr_write_b32 a51, v55
    v_accvgpr_write_b32 a52, v56
    v_accvgpr_write_b32 a53, v57
    v_accvgpr_write_b32 a54, v58
    v_accvgpr_write_b32 a55, v59
    v_accvgpr_read_b32 v52, a56
    v_accvgpr_read_b32 v53, a57
    v_accvgpr_read_b32 v54, a58
    v_accvgpr_read_b32 v55, a59
    v_accvgpr_read_b32 v56, a60
    v_accvgpr_read_b32 v57, a61
    v_accvgpr_read_b32 v58, a62
    v_accvgpr_read_b32 v59, a63
    v_mul_f32 v52, v52, v49
    v_mul_f32 v53, v53, v49
    v_mul_f32 v54, v54, v49
    v_mul_f32 v55, v55, v49
    v_mul_f32 v56, v56, v49
    v_mul_f32 v57, v57, v49
    v_mul_f32 v58, v58, v49
    v_mul_f32 v59, v59, v49
    v_accvgpr_write_b32 a56, v52
    v_accvgpr_write_b32 a57, v53
    v_accvgpr_write_b32 a58, v54
    v_accvgpr_write_b32 a59, v55
    v_accvgpr_write_b32 a60, v56
    v_accvgpr_write_b32 a61, v57
    v_accvgpr_write_b32 a62, v58
    v_accvgpr_write_b32 a63, v59
    v_exp_f32 v52, v72
    v_exp_f32 v53, v73
    v_exp_f32 v54, v74
    v_exp_f32 v55, v75
    v_exp_f32 v56, v76
    v_exp_f32 v57, v77
    v_exp_f32 v58, v78
    v_exp_f32 v59, v79
    s_nop 0
    v_cvt_pk_bf16_f32 v132, v52, v53
    v_cvt_pk_bf16_f32 v133, v54, v55
    v_cvt_pk_bf16_f32 v134, v56, v57
    v_cvt_pk_bf16_f32 v135, v58, v59
    s_nop 1
    v_mfma_f32_16x16x32_bf16 v[32:35], v[44:47], v[132:135], 0
    s_nop 7
    s_setpc_b64 s[74:75]
m_rs0488:
    s_nop 15
    v_max3_f32 v48, v64, v65, v66
    v_max3_f32 v48, v48, v67, v68
    v_max3_f32 v48, v48, v69, v70
    v_max3_f32 v48, v48, v71, 0
    v_mov_b32 v49, v48
    s_nop 1
    v_permlane32_swap_b32 v48, v49
    s_nop 1
    v_max_f32 v48, v48, v49
    v_mov_b32 v49, v48
    s_nop 1
    v_permlane16_swap_b32 v48, v49
    s_nop 1
    v_max_f32 v48, v48, v49
    v_exp_f32 v49, -v48
    v_sub_f32 v64, v64, v48
    v_sub_f32 v65, v65, v48
    v_sub_f32 v66, v66, v48
    v_sub_f32 v67, v67, v48
    v_sub_f32 v68, v68, v48
    v_sub_f32 v69, v69, v48
    v_sub_f32 v70, v70, v48
    v_sub_f32 v71, v71, v48
    v_sub_f32 v96, v96, v48
    v_sub_f32 v97, v97, v48
    v_sub_f32 v98, v98, v48
    v_sub_f32 v99, v99, v48
    v_sub_f32 v100, v100, v48
    v_sub_f32 v101, v101, v48
    v_sub_f32 v102, v102, v48
    v_sub_f32 v103, v103, v48
    v_sub_f32 v160, v160, v48
    v_sub_f32 v161, v161, v48
    v_sub_f32 v162, v162, v48
    v_sub_f32 v163, v163, v48
    v_sub_f32 v164, v164, v48
    v_sub_f32 v165, v165, v48
    v_sub_f32 v166, v166, v48
    v_sub_f32 v167, v167, v48
    v_mul_f32 v12, v12, v49
    v_accvgpr_read_b32 v52, a0
    v_accvgpr_read_b32 v53, a1
    v_accvgpr_read_b32 v54, a2
    v_accvgpr_read_b32 v55, a3
    v_accvgpr_read_b32 v56, a4
    v_accvgpr_read_b32 v57, a5
    v_accvgpr_read_b32 v58, a6
    v_accvgpr_read_b32 v59, a7
    v_mul_f32 v52, v52, v49
    v_mul_f32 v53, v53, v49
    v_mul_f32 v54, v54, v49
    v_mul_f32 v55, v55, v49
    v_mul_f32 v56, v56, v49
    v_mul_f32 v57, v57, v49
    v_mul_f32 v58, v58, v49
    v_mul_f32 v59, v59, v49
    v_accvgpr_write_b32 a0, v52
    v_accvgpr_write_b32 a1, v53
    v_accvgpr_write_b32 a2, v54
    v_accvgpr_write_b32 a3, v55
    v_accvgpr_write_b32 a4, v56
    v_accvgpr_write_b32 a5, v57
    v_accvgpr_write_b32 a6, v58
    v_accvgpr_write_b32 a7, v59
    v_accvgpr_read_b32 v52, a8
    v_accvgpr_read_b32 v53, a9
    v_accvgpr_read_b32 v54, a10
    v_accvgpr_read_b32 v55, a11
    v_accvgpr_read_b32 v56, a12
    v_accvgpr_read_b32 v57, a13
    v_accvgpr_read_b32 v58, a14
    v_accvgpr_read_b32 v59, a15
    v_mul_f32 v52, v52, v49
    v_mul_f32 v53, v53, v49
    v_mul_f32 v54, v54, v49
    v_mul_f32 v55, v55, v49
    v_mul_f32 v56, v56, v49
    v_mul_f32 v57, v57, v49
    v_mul_f32 v58, v58, v49
    v_mul_f32 v59, v59, v49
    v_accvgpr_write_b32 a8, v52
    v_accvgpr_write_b32 a9, v53
    v_accvgpr_write_b32 a10, v54
    v_accvgpr_write_b32 a11, v55
    v_accvgpr_write_b32 a12, v56
    v_accvgpr_write_b32 a13, v57
    v_accvgpr_write_b32 a14, v58
    v_accvgpr_write_b32 a15, v59
    v_accvgpr_read_b32 v52, a16
    v_accvgpr_read_b32 v53, a17
    v_accvgpr_read_b32 v54, a18
    v_accvgpr_read_b32 v55, a19
    v_accvgpr_read_b32 v56, a20
    v_accvgpr_read_b32 v57, a21
    v_accvgpr_read_b32 v58, a22
    v_accvgpr_read_b32 v59, a23
    v_mul_f32 v52, v52, v49
    v_mul_f32 v53, v53, v49
    v_mul_f32 v54, v54, v49
    v_mul_f32 v55, v55, v49
    v_mul_f32 v56, v56, v49
    v_mul_f32 v57, v57, v49
    v_mul_f32 v58, v58, v49
    v_mul_f32 v59, v59, v49
    v_accvgpr_write_b32 a16, v52
    v_accvgpr_write_b32 a17, v53
    v_accvgpr_write_b32 a18, v54
    v_accvgpr_write_b32 a19, v55
    v_accvgpr_write_b32 a20, v56
    v_accvgpr_write_b32 a21, v57
    v_accvgpr_write_b32 a22, v58
    v_accvgpr_write_b32 a23, v59
    v_accvgpr_read_b32 v52, a24
    v_accvgpr_read_b32 v53, a25
    v_accvgpr_read_b32 v54, a26
    v_accvgpr_read_b32 v55, a27
    v_accvgpr_read_b32 v56, a28
    v_accvgpr_read_b32 v57, a29
    v_accvgpr_read_b32 v58, a30
    v_accvgpr_read_b32 v59, a31
    v_mul_f32 v52, v52, v49
    v_mul_f32 v53, v53, v49
    v_mul_f32 v54, v54, v49
    v_mul_f32 v55, v55, v49
    v_mul_f32 v56, v56, v49
    v_mul_f32 v57, v57, v49
    v_mul_f32 v58, v58, v49
    v_mul_f32 v59, v59, v49
    v_accvgpr_write_b32 a24, v52
    v_accvgpr_write_b32 a25, v53
    v_accvgpr_write_b32 a26, v54
    v_accvgpr_write_b32 a27, v55
    v_accvgpr_write_b32 a28, v56
    v_accvgpr_write_b32 a29, v57
    v_accvgpr_write_b32 a30, v58
    v_accvgpr_write_b32 a31, v59
    v_exp_f32 v52, v64
    v_exp_f32 v53, v65
    v_exp_f32 v54, v66
    v_exp_f32 v55, v67
    v_exp_f32 v56, v68
    v_exp_f32 v57, v69
    v_exp_f32 v58, v70
    v_exp_f32 v59, v71
    s_nop 0
    v_cvt_pk_bf16_f32 v128, v52, v53
    v_cvt_pk_bf16_f32 v129, v54, v55
    v_cvt_pk_bf16_f32 v130, v56, v57
    v_cvt_pk_bf16_f32 v131, v58, v59
    s_nop 1
    v_mfma_f32_16x16x32_bf16 v[28:31], v[44:47], v[128:131], 0
    v_max3_f32 v48, v72, v73, v74
    v_max3_f32 v48, v48, v75, v76
    v_max3_f32 v48, v48, v77, v78
    v_max3_f32 v48, v48, v79, 0
    v_mov_b32 v49, v48
    s_nop 1
    v_permlane32_swap_b32 v48, v49
    s_nop 1
    v_max_f32 v48, v48, v49
    v_mov_b32 v49, v48
    s_nop 1
    v_permlane16_swap_b32 v48, v49
    s_nop 1
    v_max_f32 v48, v48, v49
    v_exp_f32 v49, -v48
    v_sub_f32 v72, v72, v48
    v_sub_f32 v73, v73, v48
    v_sub_f32 v74, v74, v48
    v_sub_f32 v75, v75, v48
    v_sub_f32 v76, v76, v48
    v_sub_f32 v77, v77, v48
    v_sub_f32 v78, v78, v48
    v_sub_f32 v79, v79, v48
    v_sub_f32 v104, v104, v48
    v_sub_f32 v105, v105, v48
    v_sub_f32 v106, v106, v48
    v_sub_f32 v107, v107, v48
    v_sub_f32 v108, v108, v48
    v_sub_f32 v109, v109, v48
    v_sub_f32 v110, v110, v48
    v_sub_f32 v111, v111, v48
    v_sub_f32 v168, v168, v48
    v_sub_f32 v169, v169, v48
    v_sub_f32 v170, v170, v48
    v_sub_f32 v171, v171, v48
    v_sub_f32 v172, v172, v48
    v_sub_f32 v173, v173, v48
    v_sub_f32 v174, v174, v48
    v_sub_f32 v175, v175, v48
    v_mul_f32 v13, v13, v49
    v_accvgpr_read_b32 v52, a32
    v_accvgpr_read_b32 v53, a33
    v_accvgpr_read_b32 v54, a34
    v_accvgpr_read_b32 v55, a35
    v_accvgpr_read_b32 v56, a36
    v_accvgpr_read_b32 v57, a37
    v_accvgpr_read_b32 v58, a38
    v_accvgpr_read_b32 v59, a39
    v_mul_f32 v52, v52, v49
    v_mul_f32 v53, v53, v49
    v_mul_f32 v54, v54, v49
    v_mul_f32 v55, v55, v49
    v_mul_f32 v56, v56, v49
    v_mul_f32 v57, v57, v49
    v_mul_f32 v58, v58, v49
    v_mul_f32 v59, v59, v49
    v_accvgpr_write_b32 a32, v52
    v_accvgpr_write_b32 a33, v53
    v_accvgpr_write_b32 a34, v54
    v_accvgpr_write_b32 a35, v55
    v_accvgpr_write_b32 a36, v56
    v_accvgpr_write_b32 a37, v57
    v_accvgpr_write_b32 a38, v58
    v_accvgpr_write_b32 a39, v59
    v_accvgpr_read_b32 v52, a40
    v_accvgpr_read_b32 v53, a41
    v_accvgpr_read_b32 v54, a42
    v_accvgpr_read_b32 v55, a43
    v_accvgpr_read_b32 v56, a44
    v_accvgpr_read_b32 v57, a45
    v_accvgpr_read_b32 v58, a46
    v_accvgpr_read_b32 v59, a47
    v_mul_f32 v52, v52, v49
    v_mul_f32 v53, v53, v49
    v_mul_f32 v54, v54, v49
    v_mul_f32 v55, v55, v49
    v_mul_f32 v56, v56, v49
    v_mul_f32 v57, v57, v49
    v_mul_f32 v58, v58, v49
    v_mul_f32 v59, v59, v49
    v_accvgpr_write_b32 a40, v52
    v_accvgpr_write_b32 a41, v53
    v_accvgpr_write_b32 a42, v54
    v_accvgpr_write_b32 a43, v55
    v_accvgpr_write_b32 a44, v56
    v_accvgpr_write_b32 a45, v57
    v_accvgpr_write_b32 a46, v58
    v_accvgpr_write_b32 a47, v59
    v_accvgpr_read_b32 v52, a48
    v_accvgpr_read_b32 v53, a49
    v_accvgpr_read_b32 v54, a50
    v_accvgpr_read_b32 v55, a51
    v_accvgpr_read_b32 v56, a52
    v_accvgpr_read_b32 v57, a53
    v_accvgpr_read_b32 v58, a54
    v_accvgpr_read_b32 v59, a55
    v_mul_f32 v52, v52, v49
    v_mul_f32 v53, v53, v49
    v_mul_f32 v54, v54, v49
    v_mul_f32 v55, v55, v49
    v_mul_f32 v56, v56, v49
    v_mul_f32 v57, v57, v49
    v_mul_f32 v58, v58, v49
    v_mul_f32 v59, v59, v49
    v_accvgpr_write_b32 a48, v52
    v_accvgpr_write_b32 a49, v53
    v_accvgpr_write_b32 a50, v54
    v_accvgpr_write_b32 a51, v55
    v_accvgpr_write_b32 a52, v56
    v_accvgpr_write_b32 a53, v57
    v_accvgpr_write_b32 a54, v58
    v_accvgpr_write_b32 a55, v59
    v_accvgpr_read_b32 v52, a56
    v_accvgpr_read_b32 v53, a57
    v_accvgpr_read_b32 v54, a58
    v_accvgpr_read_b32 v55, a59
    v_accvgpr_read_b32 v56, a60
    v_accvgpr_read_b32 v57, a61
    v_accvgpr_read_b32 v58, a62
    v_accvgpr_read_b32 v59, a63
    v_mul_f32 v52, v52, v49
    v_mul_f32 v53, v53, v49
    v_mul_f32 v54, v54, v49
    v_mul_f32 v55, v55, v49
    v_mul_f32 v56, v56, v49
    v_mul_f32 v57, v57, v49
    v_mul_f32 v58, v58, v49
    v_mul_f32 v59, v59, v49
    v_accvgpr_write_b32 a56, v52
    v_accvgpr_write_b32 a57, v53
    v_accvgpr_write_b32 a58, v54
    v_accvgpr_write_b32 a59, v55
    v_accvgpr_write_b32 a60, v56
    v_accvgpr_write_b32 a61, v57
    v_accvgpr_write_b32 a62, v58
    v_accvgpr_write_b32 a63, v59
    v_exp_f32 v52, v72
    v_exp_f32 v53, v73
    v_exp_f32 v54, v74
    v_exp_f32 v55, v75
    v_exp_f32 v56, v76
    v_exp_f32 v57, v77
    v_exp_f32 v58, v78
    v_exp_f32 v59, v79
    s_nop 0
    v_cvt_pk_bf16_f32 v132, v52, v53
    v_cvt_pk_bf16_f32 v133, v54, v55
    v_cvt_pk_bf16_f32 v134, v56, v57
    v_cvt_pk_bf16_f32 v135, v58, v59
    s_nop 1
    v_mfma_f32_16x16x32_bf16 v[32:35], v[44:47], v[132:135], 0
    v_max3_f32 v48, v80, v81, v82
    v_max3_f32 v48, v48, v83, v84
    v_max3_f32 v48, v48, v85, v86
    v_max3_f32 v48, v48, v87, 0
    v_mov_b32 v49, v48
    s_nop 1
    v_permlane32_swap_b32 v48, v49
    s_nop 1
    v_max_f32 v48, v48, v49
    v_mov_b32 v49, v48
    s_nop 1
    v_permlane16_swap_b32 v48, v49
    s_nop 1
    v_max_f32 v48, v48, v49
    v_exp_f32 v49, -v48
    v_sub_f32 v80, v80, v48
    v_sub_f32 v81, v81, v48
    v_sub_f32 v82, v82, v48
    v_sub_f32 v83, v83, v48
    v_sub_f32 v84, v84, v48
    v_sub_f32 v85, v85, v48
    v_sub_f32 v86, v86, v48
    v_sub_f32 v87, v87, v48
    v_sub_f32 v112, v112, v48
    v_sub_f32 v113, v113, v48
    v_sub_f32 v114, v114, v48
    v_sub_f32 v115, v115, v48
    v_sub_f32 v116, v116, v48
    v_sub_f32 v117, v117, v48
    v_sub_f32 v118, v118, v48
    v_sub_f32 v119, v119, v48
    v_sub_f32 v176, v176, v48
    v_sub_f32 v177, v177, v48
    v_sub_f32 v178, v178, v48
    v_sub_f32 v179, v179, v48
    v_sub_f32 v180, v180, v48
    v_sub_f32 v181, v181, v48
    v_sub_f32 v182, v182, v48
    v_sub_f32 v183, v183, v48
    v_mul_f32 v14, v14, v49
    v_accvgpr_read_b32 v52, a64
    v_accvgpr_read_b32 v53, a65
    v_accvgpr_read_b32 v54, a66
    v_accvgpr_read_b32 v55, a67
    v_accvgpr_read_b32 v56, a68
    v_accvgpr_read_b32 v57, a69
    v_accvgpr_read_b32 v58, a70
    v_accvgpr_read_b32 v59, a71
    v_mul_f32 v52, v52, v49
    v_mul_f32 v53, v53, v49
    v_mul_f32 v54, v54, v49
    v_mul_f32 v55, v55, v49
    v_mul_f32 v56, v56, v49
    v_mul_f32 v57, v57, v49
    v_mul_f32 v58, v58, v49
    v_mul_f32 v59, v59, v49
    v_accvgpr_write_b32 a64, v52
    v_accvgpr_write_b32 a65, v53
    v_accvgpr_write_b32 a66, v54
    v_accvgpr_write_b32 a67, v55
    v_accvgpr_write_b32 a68, v56
    v_accvgpr_write_b32 a69, v57
    v_accvgpr_write_b32 a70, v58
    v_accvgpr_write_b32 a71, v59
    v_accvgpr_read_b32 v52, a72
    v_accvgpr_read_b32 v53, a73
    v_accvgpr_read_b32 v54, a74
    v_accvgpr_read_b32 v55, a75
    v_accvgpr_read_b32 v56, a76
    v_accvgpr_read_b32 v57, a77
    v_accvgpr_read_b32 v58, a78
    v_accvgpr_read_b32 v59, a79
    v_mul_f32 v52, v52, v49
    v_mul_f32 v53, v53, v49
    v_mul_f32 v54, v54, v49
    v_mul_f32 v55, v55, v49
    v_mul_f32 v56, v56, v49
    v_mul_f32 v57, v57, v49
    v_mul_f32 v58, v58, v49
    v_mul_f32 v59, v59, v49
    v_accvgpr_write_b32 a72, v52
    v_accvgpr_write_b32 a73, v53
    v_accvgpr_write_b32 a74, v54
    v_accvgpr_write_b32 a75, v55
    v_accvgpr_write_b32 a76, v56
    v_accvgpr_write_b32 a77, v57
    v_accvgpr_write_b32 a78, v58
    v_accvgpr_write_b32 a79, v59
    v_accvgpr_read_b32 v52, a80
    v_accvgpr_read_b32 v53, a81
    v_accvgpr_read_b32 v54, a82
    v_accvgpr_read_b32 v55, a83
    v_accvgpr_read_b32 v56, a84
    v_accvgpr_read_b32 v57, a85
    v_accvgpr_read_b32 v58, a86
    v_accvgpr_read_b32 v59, a87
    v_mul_f32 v52, v52, v49
    v_mul_f32 v53, v53, v49
    v_mul_f32 v54, v54, v49
    v_mul_f32 v55, v55, v49
    v_mul_f32 v56, v56, v49
    v_mul_f32 v57, v57, v49
    v_mul_f32 v58, v58, v49
    v_mul_f32 v59, v59, v49
    v_accvgpr_write_b32 a80, v52
    v_accvgpr_write_b32 a81, v53
    v_accvgpr_write_b32 a82, v54
    v_accvgpr_write_b32 a83, v55
    v_accvgpr_write_b32 a84, v56
    v_accvgpr_write_b32 a85, v57
    v_accvgpr_write_b32 a86, v58
    v_accvgpr_write_b32 a87, v59
    v_accvgpr_read_b32 v52, a88
    v_accvgpr_read_b32 v53, a89
    v_accvgpr_read_b32 v54, a90
    v_accvgpr_read_b32 v55, a91
    v_accvgpr_read_b32 v56, a92
    v_accvgpr_read_b32 v57, a93
    v_accvgpr_read_b32 v58, a94
    v_accvgpr_read_b32 v59, a95
    v_mul_f32 v52, v52, v49
    v_mul_f32 v53, v53, v49
    v_mul_f32 v54, v54, v49
    v_mul_f32 v55, v55, v49
    v_mul_f32 v56, v56, v49
    v_mul_f32 v57, v57, v49
    v_mul_f32 v58, v58, v49
    v_mul_f32 v59, v59, v49
    v_accvgpr_write_b32 a88, v52
    v_accvgpr_write_b32 a89, v53
    v_accvgpr_write_b32 a90, v54
    v_accvgpr_write_b32 a91, v55
    v_accvgpr_write_b32 a92, v56
    v_accvgpr_write_b32 a93, v57
    v_accvgpr_write_b32 a94, v58
    v_accvgpr_write_b32 a95, v59
    v_exp_f32 v52, v80
    v_exp_f32 v53, v81
    v_exp_f32 v54, v82
    v_exp_f32 v55, v83
    v_exp_f32 v56, v84
    v_exp_f32 v57, v85
    v_exp_f32 v58, v86
    v_exp_f32 v59, v87
    s_nop 0
    v_cvt_pk_bf16_f32 v136, v52, v53
    v_cvt_pk_bf16_f32 v137, v54, v55
    v_cvt_pk_bf16_f32 v138, v56, v57
    v_cvt_pk_bf16_f32 v139, v58, v59
    s_nop 1
    v_mfma_f32_16x16x32_bf16 v[36:39], v[44:47], v[136:139], 0
    v_max3_f32 v48, v88, v89, v90
    v_max3_f32 v48, v48, v91, v92
    v_max3_f32 v48, v48, v93, v94
    v_max3_f32 v48, v48, v95, 0
    v_mov_b32 v49, v48
    s_nop 1
    v_permlane32_swap_b32 v48, v49
    s_nop 1
    v_max_f32 v48, v48, v49
    v_mov_b32 v49, v48
    s_nop 1
    v_permlane16_swap_b32 v48, v49
    s_nop 1
    v_max_f32 v48, v48, v49
    v_exp_f32 v49, -v48
    v_sub_f32 v88, v88, v48
    v_sub_f32 v89, v89, v48
    v_sub_f32 v90, v90, v48
    v_sub_f32 v91, v91, v48
    v_sub_f32 v92, v92, v48
    v_sub_f32 v93, v93, v48
    v_sub_f32 v94, v94, v48
    v_sub_f32 v95, v95, v48
    v_sub_f32 v120, v120, v48
    v_sub_f32 v121, v121, v48
    v_sub_f32 v122, v122, v48
    v_sub_f32 v123, v123, v48
    v_sub_f32 v124, v124, v48
    v_sub_f32 v125, v125, v48
    v_sub_f32 v126, v126, v48
    v_sub_f32 v127, v127, v48
    v_sub_f32 v184, v184, v48
    v_sub_f32 v185, v185, v48
    v_sub_f32 v186, v186, v48
    v_sub_f32 v187, v187, v48
    v_sub_f32 v188, v188, v48
    v_sub_f32 v189, v189, v48
    v_sub_f32 v190, v190, v48
    v_sub_f32 v191, v191, v48
    v_mul_f32 v15, v15, v49
    v_accvgpr_read_b32 v52, a96
    v_accvgpr_read_b32 v53, a97
    v_accvgpr_read_b32 v54, a98
    v_accvgpr_read_b32 v55, a99
    v_accvgpr_read_b32 v56, a100
    v_accvgpr_read_b32 v57, a101
    v_accvgpr_read_b32 v58, a102
    v_accvgpr_read_b32 v59, a103
    v_mul_f32 v52, v52, v49
    v_mul_f32 v53, v53, v49
    v_mul_f32 v54, v54, v49
    v_mul_f32 v55, v55, v49
    v_mul_f32 v56, v56, v49
    v_mul_f32 v57, v57, v49
    v_mul_f32 v58, v58, v49
    v_mul_f32 v59, v59, v49
    v_accvgpr_write_b32 a96, v52
    v_accvgpr_write_b32 a97, v53
    v_accvgpr_write_b32 a98, v54
    v_accvgpr_write_b32 a99, v55
    v_accvgpr_write_b32 a100, v56
    v_accvgpr_write_b32 a101, v57
    v_accvgpr_write_b32 a102, v58
    v_accvgpr_write_b32 a103, v59
    v_accvgpr_read_b32 v52, a104
    v_accvgpr_read_b32 v53, a105
    v_accvgpr_read_b32 v54, a106
    v_accvgpr_read_b32 v55, a107
    v_accvgpr_read_b32 v56, a108
    v_accvgpr_read_b32 v57, a109
    v_accvgpr_read_b32 v58, a110
    v_accvgpr_read_b32 v59, a111
    v_mul_f32 v52, v52, v49
    v_mul_f32 v53, v53, v49
    v_mul_f32 v54, v54, v49
    v_mul_f32 v55, v55, v49
    v_mul_f32 v56, v56, v49
    v_mul_f32 v57, v57, v49
    v_mul_f32 v58, v58, v49
    v_mul_f32 v59, v59, v49
    v_accvgpr_write_b32 a104, v52
    v_accvgpr_write_b32 a105, v53
    v_accvgpr_write_b32 a106, v54
    v_accvgpr_write_b32 a107, v55
    v_accvgpr_write_b32 a108, v56
    v_accvgpr_write_b32 a109, v57
    v_accvgpr_write_b32 a110, v58
    v_accvgpr_write_b32 a111, v59
    v_accvgpr_read_b32 v52, a112
    v_accvgpr_read_b32 v53, a113
    v_accvgpr_read_b32 v54, a114
    v_accvgpr_read_b32 v55, a115
    v_accvgpr_read_b32 v56, a116
    v_accvgpr_read_b32 v57, a117
    v_accvgpr_read_b32 v58, a118
    v_accvgpr_read_b32 v59, a119
    v_mul_f32 v52, v52, v49
    v_mul_f32 v53, v53, v49
    v_mul_f32 v54, v54, v49
    v_mul_f32 v55, v55, v49
    v_mul_f32 v56, v56, v49
    v_mul_f32 v57, v57, v49
    v_mul_f32 v58, v58, v49
    v_mul_f32 v59, v59, v49
    v_accvgpr_write_b32 a112, v52
    v_accvgpr_write_b32 a113, v53
    v_accvgpr_write_b32 a114, v54
    v_accvgpr_write_b32 a115, v55
    v_accvgpr_write_b32 a116, v56
    v_accvgpr_write_b32 a117, v57
    v_accvgpr_write_b32 a118, v58
    v_accvgpr_write_b32 a119, v59
    v_accvgpr_read_b32 v52, a120
    v_accvgpr_read_b32 v53, a121
    v_accvgpr_read_b32 v54, a122
    v_accvgpr_read_b32 v55, a123
    v_accvgpr_read_b32 v56, a124
    v_accvgpr_read_b32 v57, a125
    v_accvgpr_read_b32 v58, a126
    v_accvgpr_read_b32 v59, a127
    v_mul_f32 v52, v52, v49
    v_mul_f32 v53, v53, v49
    v_mul_f32 v54, v54, v49
    v_mul_f32 v55, v55, v49
    v_mul_f32 v56, v56, v49
    v_mul_f32 v57, v57, v49
    v_mul_f32 v58, v58, v49
    v_mul_f32 v59, v59, v49
    v_accvgpr_write_b32 a120, v52
    v_accvgpr_write_b32 a121, v53
    v_accvgpr_write_b32 a122, v54
    v_accvgpr_write_b32 a123, v55
    v_accvgpr_write_b32 a124, v56
    v_accvgpr_write_b32 a125, v57
    v_accvgpr_write_b32 a126, v58
    v_accvgpr_write_b32 a127, v59
    v_exp_f32 v52, v88
    v_exp_f32 v53, v89
    v_exp_f32 v54, v90
    v_exp_f32 v55, v91
    v_exp_f32 v56, v92
    v_exp_f32 v57, v93
    v_exp_f32 v58, v94
    v_exp_f32 v59, v95
    s_nop 0
    v_cvt_pk_bf16_f32 v140, v52, v53
    v_cvt_pk_bf16_f32 v141, v54, v55
    v_cvt_pk_bf16_f32 v142, v56, v57
    v_cvt_pk_bf16_f32 v143, v58, v59
    s_nop 1
    v_mfma_f32_16x16x32_bf16 v[40:43], v[44:47], v[140:143], 0
    s_nop 7
    s_setpc_b64 s[74:75]
m_rs1289:
    s_nop 15
    v_max3_f32 v48, v96, v97, v98
    v_max3_f32 v48, v48, v99, v100
    v_max3_f32 v48, v48, v101, v102
    v_max3_f32 v48, v48, v103, 0
    v_mov_b32 v49, v48
    s_nop 1
    v_permlane32_swap_b32 v48, v49
    s_nop 1
    v_max_f32 v48, v48, v49
    v_mov_b32 v49, v48
    s_nop 1
    v_permlane16_swap_b32 v48, v49
    s_nop 1
    v_max_f32 v48, v48, v49
    v_exp_f32 v49, -v48
    v_sub_f32 v96, v96, v48
    v_sub_f32 v97, v97, v48
    v_sub_f32 v98, v98, v48
    v_sub_f32 v99, v99, v48
    v_sub_f32 v100, v100, v48
    v_sub_f32 v101, v101, v48
    v_sub_f32 v102, v102, v48
    v_sub_f32 v103, v103, v48
    v_sub_f32 v64, v64, v48
    v_sub_f32 v65, v65, v48
    v_sub_f32 v66, v66, v48
    v_sub_f32 v67, v67, v48
    v_sub_f32 v68, v68, v48
    v_sub_f32 v69, v69, v48
    v_sub_f32 v70, v70, v48
    v_sub_f32 v71, v71, v48
    v_sub_f32 v160, v160, v48
    v_sub_f32 v161, v161, v48
    v_sub_f32 v162, v162, v48
    v_sub_f32 v163, v163, v48
    v_sub_f32 v164, v164, v48
    v_sub_f32 v165, v165, v48
    v_sub_f32 v166, v166, v48
    v_sub_f32 v167, v167, v48
    v_mul_f32 v12, v12, v49
    v_accvgpr_read_b32 v52, a0
    v_accvgpr_read_b32 v53, a1
    v_accvgpr_read_b32 v54, a2
    v_accvgpr_read_b32 v55, a3
    v_accvgpr_read_b32 v56, a4
    v_accvgpr_read_b32 v57, a5
    v_accvgpr_read_b32 v58, a6
    v_accvgpr_read_b32 v59, a7
    v_mul_f32 v52, v52, v49
    v_mul_f32 v53, v53, v49
    v_mul_f32 v54, v54, v49
    v_mul_f32 v55, v55, v49
    v_mul_f32 v56, v56, v49
    v_mul_f32 v57, v57, v49
    v_mul_f32 v58, v58, v49
    v_mul_f32 v59, v59, v49
    v_accvgpr_write_b32 a0, v52
    v_accvgpr_write_b32 a1, v53
    v_accvgpr_write_b32 a2, v54
    v_accvgpr_write_b32 a3, v55
    v_accvgpr_write_b32 a4, v56
    v_accvgpr_write_b32 a5, v57
    v_accvgpr_write_b32 a6, v58
    v_accvgpr_write_b32 a7, v59
    v_accvgpr_read_b32 v52, a8
    v_accvgpr_read_b32 v53, a9
    v_accvgpr_read_b32 v54, a10
    v_accvgpr_read_b32 v55, a11
    v_accvgpr_read_b32 v56, a12
    v_accvgpr_read_b32 v57, a13
    v_accvgpr_read_b32 v58, a14
    v_accvgpr_read_b32 v59, a15
    v_mul_f32 v52, v52, v49
    v_mul_f32 v53, v53, v49
    v_mul_f32 v54, v54, v49
    v_mul_f32 v55, v55, v49
    v_mul_f32 v56, v56, v49
    v_mul_f32 v57, v57, v49
    v_mul_f32 v58, v58, v49
    v_mul_f32 v59, v59, v49
    v_accvgpr_write_b32 a8, v52
    v_accvgpr_write_b32 a9, v53
    v_accvgpr_write_b32 a10, v54
    v_accvgpr_write_b32 a11, v55
    v_accvgpr_write_b32 a12, v56
    v_accvgpr_write_b32 a13, v57
    v_accvgpr_write_b32 a14, v58
    v_accvgpr_write_b32 a15, v59
    v_accvgpr_read_b32 v52, a16
    v_accvgpr_read_b32 v53, a17
    v_accvgpr_read_b32 v54, a18
    v_accvgpr_read_b32 v55, a19
    v_accvgpr_read_b32 v56, a20
    v_accvgpr_read_b32 v57, a21
    v_accvgpr_read_b32 v58, a22
    v_accvgpr_read_b32 v59, a23
    v_mul_f32 v52, v52, v49
    v_mul_f32 v53, v53, v49
    v_mul_f32 v54, v54, v49
    v_mul_f32 v55, v55, v49
    v_mul_f32 v56, v56, v49
    v_mul_f32 v57, v57, v49
    v_mul_f32 v58, v58, v49
    v_mul_f32 v59, v59, v49
    v_accvgpr_write_b32 a16, v52
    v_accvgpr_write_b32 a17, v53
    v_accvgpr_write_b32 a18, v54
    v_accvgpr_write_b32 a19, v55
    v_accvgpr_write_b32 a20, v56
    v_accvgpr_write_b32 a21, v57
    v_accvgpr_write_b32 a22, v58
    v_accvgpr_write_b32 a23, v59
    v_accvgpr_read_b32 v52, a24
    v_accvgpr_read_b32 v53, a25
    v_accvgpr_read_b32 v54, a26
    v_accvgpr_read_b32 v55, a27
    v_accvgpr_read_b32 v56, a28
    v_accvgpr_read_b32 v57, a29
    v_accvgpr_read_b32 v58, a30
    v_accvgpr_read_b32 v59, a31
    v_mul_f32 v52, v52, v49
    v_mul_f32 v53, v53, v49
    v_mul_f32 v54, v54, v49
    v_mul_f32 v55, v55, v49
    v_mul_f32 v56, v56, v49
    v_mul_f32 v57, v57, v49
    v_mul_f32 v58, v58, v49
    v_mul_f32 v59, v59, v49
    v_accvgpr_write_b32 a24, v52
    v_accvgpr_write_b32 a25, v53
    v_accvgpr_write_b32 a26, v54
    v_accvgpr_write_b32 a27, v55
    v_accvgpr_write_b32 a28, v56
    v_accvgpr_write_b32 a29, v57
    v_accvgpr_write_b32 a30, v58
    v_accvgpr_write_b32 a31, v59
    v_exp_f32 v52, v96
    v_exp_f32 v53, v97
    v_exp_f32 v54, v98
    v_exp_f32 v55, v99
    v_exp_f32 v56, v100
    v_exp_f32 v57, v101
    v_exp_f32 v58, v102
    v_exp_f32 v59, v103
    s_nop 0
    v_cvt_pk_bf16_f32 v144, v52, v53
    v_cvt_pk_bf16_f32 v145, v54, v55
    v_cvt_pk_bf16_f32 v146, v56, v57
    v_cvt_pk_bf16_f32 v147, v58, v59
    s_nop 1
    v_mfma_f32_16x16x32_bf16 v[28:31], v[44:47], v[144:147], 0
    v_max3_f32 v48, v104, v105, v106
    v_max3_f32 v48, v48, v107, v108
    v_max3_f32 v48, v48, v109, v110
    v_max3_f32 v48, v48, v111, 0
    v_mov_b32 v49, v48
    s_nop 1
    v_permlane32_swap_b32 v48, v49
    s_nop 1
    v_max_f32 v48, v48, v49
    v_mov_b32 v49, v48
    s_nop 1
    v_permlane16_swap_b32 v48, v49
    s_nop 1
    v_max_f32 v48, v48, v49
    v_exp_f32 v49, -v48
    v_sub_f32 v104, v104, v48
    v_sub_f32 v105, v105, v48
    v_sub_f32 v106, v106, v48
    v_sub_f32 v107, v107, v48
    v_sub_f32 v108, v108, v48
    v_sub_f32 v109, v109, v48
    v_sub_f32 v110, v110, v48
    v_sub_f32 v111, v111, v48
    v_sub_f32 v72, v72, v48
    v_sub_f32 v73, v73, v48
    v_sub_f32 v74, v74, v48
    v_sub_f32 v75, v75, v48
    v_sub_f32 v76, v76, v48
    v_sub_f32 v77, v77, v48
    v_sub_f32 v78, v78, v48
    v_sub_f32 v79, v79, v48
    v_sub_f32 v168, v168, v48
    v_sub_f32 v169, v169, v48
    v_sub_f32 v170, v170, v48
    v_sub_f32 v171, v171, v48
    v_sub_f32 v172, v172, v48
    v_sub_f32 v173, v173, v48
    v_sub_f32 v174, v174, v48
    v_sub_f32 v175, v175, v48
    v_mul_f32 v13, v13, v49
    v_accvgpr_read_b32 v52, a32
    v_accvgpr_read_b32 v53, a33
    v_accvgpr_read_b32 v54, a34
    v_accvgpr_read_b32 v55, a35
    v_accvgpr_read_b32 v56, a36
    v_accvgpr_read_b32 v57, a37
    v_accvgpr_read_b32 v58, a38
    v_accvgpr_read_b32 v59, a39
    v_mul_f32 v52, v52, v49
    v_mul_f32 v53, v53, v49
    v_mul_f32 v54, v54, v49
    v_mul_f32 v55, v55, v49
    v_mul_f32 v56, v56, v49
    v_mul_f32 v57, v57, v49
    v_mul_f32 v58, v58, v49
    v_mul_f32 v59, v59, v49
    v_accvgpr_write_b32 a32, v52
    v_accvgpr_write_b32 a33, v53
    v_accvgpr_write_b32 a34, v54
    v_accvgpr_write_b32 a35, v55
    v_accvgpr_write_b32 a36, v56
    v_accvgpr_write_b32 a37, v57
    v_accvgpr_write_b32 a38, v58
    v_accvgpr_write_b32 a39, v59
    v_accvgpr_read_b32 v52, a40
    v_accvgpr_read_b32 v53, a41
    v_accvgpr_read_b32 v54, a42
    v_accvgpr_read_b32 v55, a43
    v_accvgpr_read_b32 v56, a44
    v_accvgpr_read_b32 v57, a45
    v_accvgpr_read_b32 v58, a46
    v_accvgpr_read_b32 v59, a47
    v_mul_f32 v52, v52, v49
    v_mul_f32 v53, v53, v49
    v_mul_f32 v54, v54, v49
    v_mul_f32 v55, v55, v49
    v_mul_f32 v56, v56, v49
    v_mul_f32 v57, v57, v49
    v_mul_f32 v58, v58, v49
    v_mul_f32 v59, v59, v49
    v_accvgpr_write_b32 a40, v52
    v_accvgpr_write_b32 a41, v53
    v_accvgpr_write_b32 a42, v54
    v_accvgpr_write_b32 a43, v55
    v_accvgpr_write_b32 a44, v56
    v_accvgpr_write_b32 a45, v57
    v_accvgpr_write_b32 a46, v58
    v_accvgpr_write_b32 a47, v59
    v_accvgpr_read_b32 v52, a48
    v_accvgpr_read_b32 v53, a49
    v_accvgpr_read_b32 v54, a50
    v_accvgpr_read_b32 v55, a51
    v_accvgpr_read_b32 v56, a52
    v_accvgpr_read_b32 v57, a53
    v_accvgpr_read_b32 v58, a54
    v_accvgpr_read_b32 v59, a55
    v_mul_f32 v52, v52, v49
    v_mul_f32 v53, v53, v49
    v_mul_f32 v54, v54, v49
    v_mul_f32 v55, v55, v49
    v_mul_f32 v56, v56, v49
    v_mul_f32 v57, v57, v49
    v_mul_f32 v58, v58, v49
    v_mul_f32 v59, v59, v49
    v_accvgpr_write_b32 a48, v52
    v_accvgpr_write_b32 a49, v53
    v_accvgpr_write_b32 a50, v54
    v_accvgpr_write_b32 a51, v55
    v_accvgpr_write_b32 a52, v56
    v_accvgpr_write_b32 a53, v57
    v_accvgpr_write_b32 a54, v58
    v_accvgpr_write_b32 a55, v59
    v_accvgpr_read_b32 v52, a56
    v_accvgpr_read_b32 v53, a57
    v_accvgpr_read_b32 v54, a58
    v_accvgpr_read_b32 v55, a59
    v_accvgpr_read_b32 v56, a60
    v_accvgpr_read_b32 v57, a61
    v_accvgpr_read_b32 v58, a62
    v_accvgpr_read_b32 v59, a63
    v_mul_f32 v52, v52, v49
    v_mul_f32 v53, v53, v49
    v_mul_f32 v54, v54, v49
    v_mul_f32 v55, v55, v49
    v_mul_f32 v56, v56, v49
    v_mul_f32 v57, v57, v49
    v_mul_f32 v58, v58, v49
    v_mul_f32 v59, v59, v49
    v_accvgpr_write_b32 a56, v52
    v_accvgpr_write_b32 a57, v53
    v_accvgpr_write_b32 a58, v54
    v_accvgpr_write_b32 a59, v55
    v_accvgpr_write_b32 a60, v56
    v_accvgpr_write_b32 a61, v57
    v_accvgpr_write_b32 a62, v58
    v_accvgpr_write_b32 a63, v59
    v_exp_f32 v52, v104
    v_exp_f32 v53, v105
    v_exp_f32 v54, v106
    v_exp_f32 v55, v107
    v_exp_f32 v56, v108
    v_exp_f32 v57, v109
    v_exp_f32 v58, v110
    v_exp_f32 v59, v111
    s_nop 0
    v_cvt_pk_bf16_f32 v148, v52, v53
    v_cvt_pk_bf16_f32 v149, v54, v55
    v_cvt_pk_bf16_f32 v150, v56, v57
    v_cvt_pk_bf16_f32 v151, v58, v59
    s_nop 1
    v_mfma_f32_16x16x32_bf16 v[32:35], v[44:47], v[148:151], 0
    s_nop 7
    s_setpc_b64 s[74:75]
m_rs1490:
    s_nop 15
    v_max3_f32 v48, v96, v97, v98
    v_max3_f32 v48, v48, v99, v100
    v_max3_f32 v48, v48, v101, v102
    v_max3_f32 v48, v48, v103, 0
    v_mov_b32 v49, v48
    s_nop 1
    v_permlane32_swap_b32 v48, v49
    s_nop 1
    v_max_f32 v48, v48, v49
    v_mov_b32 v49, v48
    s_nop 1
    v_permlane16_swap_b32 v48, v49
    s_nop 1
    v_max_f32 v48, v48, v49
    v_exp_f32 v49, -v48
    v_sub_f32 v96, v96, v48
    v_sub_f32 v97, v97, v48
    v_sub_f32 v98, v98, v48
    v_sub_f32 v99, v99, v48
    v_sub_f32 v100, v100, v48
    v_sub_f32 v101, v101, v48
    v_sub_f32 v102, v102, v48
    v_sub_f32 v103, v103, v48
    v_sub_f32 v64, v64, v48
    v_sub_f32 v65, v65, v48
    v_sub_f32 v66, v66, v48
    v_sub_f32 v67, v67, v48
    v_sub_f32 v68, v68, v48
    v_sub_f32 v69, v69, v48
    v_sub_f32 v70, v70, v48
    v_sub_f32 v71, v71, v48
    v_sub_f32 v160, v160, v48
    v_sub_f32 v161, v161, v48
    v_sub_f32 v162, v162, v48
    v_sub_f32 v163, v163, v48
    v_sub_f32 v164, v164, v48
    v_sub_f32 v165, v165, v48
    v_sub_f32 v166, v166, v48
    v_sub_f32 v167, v167, v48
    v_mul_f32 v12, v12, v49
    v_accvgpr_read_b32 v52, a0
    v_accvgpr_read_b32 v53, a1
    v_accvgpr_read_b32 v54, a2
    v_accvgpr_read_b32 v55, a3
    v_accvgpr_read_b32 v56, a4
    v_accvgpr_read_b32 v57, a5
    v_accvgpr_read_b32 v58, a6
    v_accvgpr_read_b32 v59, a7
    v_mul_f32 v52, v52, v49
    v_mul_f32 v53, v53, v49
    v_mul_f32 v54, v54, v49
    v_mul_f32 v55, v55, v49
    v_mul_f32 v56, v56, v49
    v_mul_f32 v57, v57, v49
    v_mul_f32 v58, v58, v49
    v_mul_f32 v59, v59, v49
    v_accvgpr_write_b32 a0, v52
    v_accvgpr_write_b32 a1, v53
    v_accvgpr_write_b32 a2, v54
    v_accvgpr_write_b32 a3, v55
    v_accvgpr_write_b32 a4, v56
    v_accvgpr_write_b32 a5, v57
    v_accvgpr_write_b32 a6, v58
    v_accvgpr_write_b32 a7, v59
    v_accvgpr_read_b32 v52, a8
    v_accvgpr_read_b32 v53, a9
    v_accvgpr_read_b32 v54, a10
    v_accvgpr_read_b32 v55, a11
    v_accvgpr_read_b32 v56, a12
    v_accvgpr_read_b32 v57, a13
    v_accvgpr_read_b32 v58, a14
    v_accvgpr_read_b32 v59, a15
    v_mul_f32 v52, v52, v49
    v_mul_f32 v53, v53, v49
    v_mul_f32 v54, v54, v49
    v_mul_f32 v55, v55, v49
    v_mul_f32 v56, v56, v49
    v_mul_f32 v57, v57, v49
    v_mul_f32 v58, v58, v49
    v_mul_f32 v59, v59, v49
    v_accvgpr_write_b32 a8, v52
    v_accvgpr_write_b32 a9, v53
    v_accvgpr_write_b32 a10, v54
    v_accvgpr_write_b32 a11, v55
    v_accvgpr_write_b32 a12, v56
    v_accvgpr_write_b32 a13, v57
    v_accvgpr_write_b32 a14, v58
    v_accvgpr_write_b32 a15, v59
    v_accvgpr_read_b32 v52, a16
    v_accvgpr_read_b32 v53, a17
    v_accvgpr_read_b32 v54, a18
    v_accvgpr_read_b32 v55, a19
    v_accvgpr_read_b32 v56, a20
    v_accvgpr_read_b32 v57, a21
    v_accvgpr_read_b32 v58, a22
    v_accvgpr_read_b32 v59, a23
    v_mul_f32 v52, v52, v49
    v_mul_f32 v53, v53, v49
    v_mul_f32 v54, v54, v49
    v_mul_f32 v55, v55, v49
    v_mul_f32 v56, v56, v49
    v_mul_f32 v57, v57, v49
    v_mul_f32 v58, v58, v49
    v_mul_f32 v59, v59, v49
    v_accvgpr_write_b32 a16, v52
    v_accvgpr_write_b32 a17, v53
    v_accvgpr_write_b32 a18, v54
    v_accvgpr_write_b32 a19, v55
    v_accvgpr_write_b32 a20, v56
    v_accvgpr_write_b32 a21, v57
    v_accvgpr_write_b32 a22, v58
    v_accvgpr_write_b32 a23, v59
    v_accvgpr_read_b32 v52, a24
    v_accvgpr_read_b32 v53, a25
    v_accvgpr_read_b32 v54, a26
    v_accvgpr_read_b32 v55, a27
    v_accvgpr_read_b32 v56, a28
    v_accvgpr_read_b32 v57, a29
    v_accvgpr_read_b32 v58, a30
    v_accvgpr_read_b32 v59, a31
    v_mul_f32 v52, v52, v49
    v_mul_f32 v53, v53, v49
    v_mul_f32 v54, v54, v49
    v_mul_f32 v55, v55, v49
    v_mul_f32 v56, v56, v49
    v_mul_f32 v57, v57, v49
    v_mul_f32 v58, v58, v49
    v_mul_f32 v59, v59, v49
    v_accvgpr_write_b32 a24, v52
    v_accvgpr_write_b32 a25, v53
    v_accvgpr_write_b32 a26, v54
    v_accvgpr_write_b32 a27, v55
    v_accvgpr_write_b32 a28, v56
    v_accvgpr_write_b32 a29, v57
    v_accvgpr_write_b32 a30, v58
    v_accvgpr_write_b32 a31, v59
    v_exp_f32 v52, v96
    v_exp_f32 v53, v97
    v_exp_f32 v54, v98
    v_exp_f32 v55, v99
    v_exp_f32 v56, v100
    v_exp_f32 v57, v101
    v_exp_f32 v58, v102
    v_exp_f32 v59, v103
    s_nop 0
    v_cvt_pk_bf16_f32 v144, v52, v53
    v_cvt_pk_bf16_f32 v145, v54, v55
    v_cvt_pk_bf16_f32 v146, v56, v57
    v_cvt_pk_bf16_f32 v147, v58, v59
    s_nop 1
    v_mfma_f32_16x16x32_bf16 v[28:31], v[44:47], v[144:147], 0
    v_max3_f32 v48, v104, v105, v106
    v_max3_f32 v48, v48, v107, v108
    v_max3_f32 v48, v48, v109, v110
    v_max3_f32 v48, v48, v111, 0
    v_mov_b32 v49, v48
    s_nop 1
    v_permlane32_swap_b32 v48, v49
    s_nop 1
    v_max_f32 v48, v48, v49
    v_mov_b32 v49, v48
    s_nop 1
    v_permlane16_swap_b32 v48, v49
    s_nop 1
    v_max_f32 v48, v48, v49
    v_exp_f32 v49, -v48
    v_sub_f32 v104, v104, v48
    v_sub_f32 v105, v105, v48
    v_sub_f32 v106, v106, v48
    v_sub_f32 v107, v107, v48
    v_sub_f32 v108, v108, v48
    v_sub_f32 v109, v109, v48
    v_sub_f32 v110, v110, v48
    v_sub_f32 v111, v111, v48
    v_sub_f32 v72, v72, v48
    v_sub_f32 v73, v73, v48
    v_sub_f32 v74, v74, v48
    v_sub_f32 v75, v75, v48
    v_sub_f32 v76, v76, v48
    v_sub_f32 v77, v77, v48
    v_sub_f32 v78, v78, v48
    v_sub_f32 v79, v79, v48
    v_sub_f32 v168, v168, v48
    v_sub_f32 v169, v169, v48
    v_sub_f32 v170, v170, v48
    v_sub_f32 v171, v171, v48
    v_sub_f32 v172, v172, v48
    v_sub_f32 v173, v173, v48
    v_sub_f32 v174, v174, v48
    v_sub_f32 v175, v175, v48
    v_mul_f32 v13, v13, v49
    v_accvgpr_read_b32 v52, a32
    v_accvgpr_read_b32 v53, a33
    v_accvgpr_read_b32 v54, a34
    v_accvgpr_read_b32 v55, a35
    v_accvgpr_read_b32 v56, a36
    v_accvgpr_read_b32 v57, a37
    v_accvgpr_read_b32 v58, a38
    v_accvgpr_read_b32 v59, a39
    v_mul_f32 v52, v52, v49
    v_mul_f32 v53, v53, v49
    v_mul_f32 v54, v54, v49
    v_mul_f32 v55, v55, v49
    v_mul_f32 v56, v56, v49
    v_mul_f32 v57, v57, v49
    v_mul_f32 v58, v58, v49
    v_mul_f32 v59, v59, v49
    v_accvgpr_write_b32 a32, v52
    v_accvgpr_write_b32 a33, v53
    v_accvgpr_write_b32 a34, v54
    v_accvgpr_write_b32 a35, v55
    v_accvgpr_write_b32 a36, v56
    v_accvgpr_write_b32 a37, v57
    v_accvgpr_write_b32 a38, v58
    v_accvgpr_write_b32 a39, v59
    v_accvgpr_read_b32 v52, a40
    v_accvgpr_read_b32 v53, a41
    v_accvgpr_read_b32 v54, a42
    v_accvgpr_read_b32 v55, a43
    v_accvgpr_read_b32 v56, a44
    v_accvgpr_read_b32 v57, a45
    v_accvgpr_read_b32 v58, a46
    v_accvgpr_read_b32 v59, a47
    v_mul_f32 v52, v52, v49
    v_mul_f32 v53, v53, v49
    v_mul_f32 v54, v54, v49
    v_mul_f32 v55, v55, v49
    v_mul_f32 v56, v56, v49
    v_mul_f32 v57, v57, v49
    v_mul_f32 v58, v58, v49
    v_mul_f32 v59, v59, v49
    v_accvgpr_write_b32 a40, v52
    v_accvgpr_write_b32 a41, v53
    v_accvgpr_write_b32 a42, v54
    v_accvgpr_write_b32 a43, v55
    v_accvgpr_write_b32 a44, v56
    v_accvgpr_write_b32 a45, v57
    v_accvgpr_write_b32 a46, v58
    v_accvgpr_write_b32 a47, v59
    v_accvgpr_read_b32 v52, a48
    v_accvgpr_read_b32 v53, a49
    v_accvgpr_read_b32 v54, a50
    v_accvgpr_read_b32 v55, a51
    v_accvgpr_read_b32 v56, a52
    v_accvgpr_read_b32 v57, a53
    v_accvgpr_read_b32 v58, a54
    v_accvgpr_read_b32 v59, a55
    v_mul_f32 v52, v52, v49
    v_mul_f32 v53, v53, v49
    v_mul_f32 v54, v54, v49
    v_mul_f32 v55, v55, v49
    v_mul_f32 v56, v56, v49
    v_mul_f32 v57, v57, v49
    v_mul_f32 v58, v58, v49
    v_mul_f32 v59, v59, v49
    v_accvgpr_write_b32 a48, v52
    v_accvgpr_write_b32 a49, v53
    v_accvgpr_write_b32 a50, v54
    v_accvgpr_write_b32 a51, v55
    v_accvgpr_write_b32 a52, v56
    v_accvgpr_write_b32 a53, v57
    v_accvgpr_write_b32 a54, v58
    v_accvgpr_write_b32 a55, v59
    v_accvgpr_read_b32 v52, a56
    v_accvgpr_read_b32 v53, a57
    v_accvgpr_read_b32 v54, a58
    v_accvgpr_read_b32 v55, a59
    v_accvgpr_read_b32 v56, a60
    v_accvgpr_read_b32 v57, a61
    v_accvgpr_read_b32 v58, a62
    v_accvgpr_read_b32 v59, a63
    v_mul_f32 v52, v52, v49
    v_mul_f32 v53, v53, v49
    v_mul_f32 v54, v54, v49
    v_mul_f32 v55, v55, v49
    v_mul_f32 v56, v56, v49
    v_mul_f32 v57, v57, v49
    v_mul_f32 v58, v58, v49
    v_mul_f32 v59, v59, v49
    v_accvgpr_write_b32 a56, v52
    v_accvgpr_write_b32 a57, v53
    v_accvgpr_write_b32 a58, v54
    v_accvgpr_write_b32 a59, v55
    v_accvgpr_write_b32 a60, v56
    v_accvgpr_write_b32 a61, v57
    v_accvgpr_write_b32 a62, v58
    v_accvgpr_write_b32 a63, v59
    v_exp_f32 v52, v104
    v_exp_f32 v53, v105
    v_exp_f32 v54, v106
    v_exp_f32 v55, v107
    v_exp_f32 v56, v108
    v_exp_f32 v57, v109
    v_exp_f32 v58, v110
    v_exp_f32 v59, v111
    s_nop 0
    v_cvt_pk_bf16_f32 v148, v52, v53
    v_cvt_pk_bf16_f32 v149, v54, v55
    v_cvt_pk_bf16_f32 v150, v56, v57
    v_cvt_pk_bf16_f32 v151, v58, v59
    s_nop 1
    v_mfma_f32_16x16x32_bf16 v[32:35], v[44:47], v[148:151], 0
    v_max3_f32 v48, v112, v113, v114
    v_max3_f32 v48, v48, v115, v116
    v_max3_f32 v48, v48, v117, v118
    v_max3_f32 v48, v48, v119, 0
    v_mov_b32 v49, v48
    s_nop 1
    v_permlane32_swap_b32 v48, v49
    s_nop 1
    v_max_f32 v48, v48, v49
    v_mov_b32 v49, v48
    s_nop 1
    v_permlane16_swap_b32 v48, v49
    s_nop 1
    v_max_f32 v48, v48, v49
    v_exp_f32 v49, -v48
    v_sub_f32 v112, v112, v48
    v_sub_f32 v113, v113, v48
    v_sub_f32 v114, v114, v48
    v_sub_f32 v115, v115, v48
    v_sub_f32 v116, v116, v48
    v_sub_f32 v117, v117, v48
    v_sub_f32 v118, v118, v48
    v_sub_f32 v119, v119, v48
    v_sub_f32 v80, v80, v48
    v_sub_f32 v81, v81, v48
    v_sub_f32 v82, v82, v48
    v_sub_f32 v83, v83, v48
    v_sub_f32 v84, v84, v48
    v_sub_f32 v85, v85, v48
    v_sub_f32 v86, v86, v48
    v_sub_f32 v87, v87, v48
    v_sub_f32 v176, v176, v48
    v_sub_f32 v177, v177, v48
    v_sub_f32 v178, v178, v48
    v_sub_f32 v179, v179, v48
    v_sub_f32 v180, v180, v48
    v_sub_f32 v181, v181, v48
    v_sub_f32 v182, v182, v48
    v_sub_f32 v183, v183, v48
    v_mul_f32 v14, v14, v49
    v_accvgpr_read_b32 v52, a64
    v_accvgpr_read_b32 v53, a65
    v_accvgpr_read_b32 v54, a66
    v_accvgpr_read_b32 v55, a67
    v_accvgpr_read_b32 v56, a68
    v_accvgpr_read_b32 v57, a69
    v_accvgpr_read_b32 v58, a70
    v_accvgpr_read_b32 v59, a71
    v_mul_f32 v52, v52, v49
    v_mul_f32 v53, v53, v49
    v_mul_f32 v54, v54, v49
    v_mul_f32 v55, v55, v49
    v_mul_f32 v56, v56, v49
    v_mul_f32 v57, v57, v49
    v_mul_f32 v58, v58, v49
    v_mul_f32 v59, v59, v49
    v_accvgpr_write_b32 a64, v52
    v_accvgpr_write_b32 a65, v53
    v_accvgpr_write_b32 a66, v54
    v_accvgpr_write_b32 a67, v55
    v_accvgpr_write_b32 a68, v56
    v_accvgpr_write_b32 a69, v57
    v_accvgpr_write_b32 a70, v58
    v_accvgpr_write_b32 a71, v59
    v_accvgpr_read_b32 v52, a72
    v_accvgpr_read_b32 v53, a73
    v_accvgpr_read_b32 v54, a74
    v_accvgpr_read_b32 v55, a75
    v_accvgpr_read_b32 v56, a76
    v_accvgpr_read_b32 v57, a77
    v_accvgpr_read_b32 v58, a78
    v_accvgpr_read_b32 v59, a79
    v_mul_f32 v52, v52, v49
    v_mul_f32 v53, v53, v49
    v_mul_f32 v54, v54, v49
    v_mul_f32 v55, v55, v49
    v_mul_f32 v56, v56, v49
    v_mul_f32 v57, v57, v49
    v_mul_f32 v58, v58, v49
    v_mul_f32 v59, v59, v49
    v_accvgpr_write_b32 a72, v52
    v_accvgpr_write_b32 a73, v53
    v_accvgpr_write_b32 a74, v54
    v_accvgpr_write_b32 a75, v55
    v_accvgpr_write_b32 a76, v56
    v_accvgpr_write_b32 a77, v57
    v_accvgpr_write_b32 a78, v58
    v_accvgpr_write_b32 a79, v59
    v_accvgpr_read_b32 v52, a80
    v_accvgpr_read_b32 v53, a81
    v_accvgpr_read_b32 v54, a82
    v_accvgpr_read_b32 v55, a83
    v_accvgpr_read_b32 v56, a84
    v_accvgpr_read_b32 v57, a85
    v_accvgpr_read_b32 v58, a86
    v_accvgpr_read_b32 v59, a87
    v_mul_f32 v52, v52, v49
    v_mul_f32 v53, v53, v49
    v_mul_f32 v54, v54, v49
    v_mul_f32 v55, v55, v49
    v_mul_f32 v56, v56, v49
    v_mul_f32 v57, v57, v49
    v_mul_f32 v58, v58, v49
    v_mul_f32 v59, v59, v49
    v_accvgpr_write_b32 a80, v52
    v_accvgpr_write_b32 a81, v53
    v_accvgpr_write_b32 a82, v54
    v_accvgpr_write_b32 a83, v55
    v_accvgpr_write_b32 a84, v56
    v_accvgpr_write_b32 a85, v57
    v_accvgpr_write_b32 a86, v58
    v_accvgpr_write_b32 a87, v59
    v_accvgpr_read_b32 v52, a88
    v_accvgpr_read_b32 v53, a89
    v_accvgpr_read_b32 v54, a90
    v_accvgpr_read_b32 v55, a91
    v_accvgpr_read_b32 v56, a92
    v_accvgpr_read_b32 v57, a93
    v_accvgpr_read_b32 v58, a94
    v_accvgpr_read_b32 v59, a95
    v_mul_f32 v52, v52, v49
    v_mul_f32 v53, v53, v49
    v_mul_f32 v54, v54, v49
    v_mul_f32 v55, v55, v49
    v_mul_f32 v56, v56, v49
    v_mul_f32 v57, v57, v49
    v_mul_f32 v58, v58, v49
    v_mul_f32 v59, v59, v49
    v_accvgpr_write_b32 a88, v52
    v_accvgpr_write_b32 a89, v53
    v_accvgpr_write_b32 a90, v54
    v_accvgpr_write_b32 a91, v55
    v_accvgpr_write_b32 a92, v56
    v_accvgpr_write_b32 a93, v57
    v_accvgpr_write_b32 a94, v58
    v_accvgpr_write_b32 a95, v59
    v_exp_f32 v52, v112
    v_exp_f32 v53, v113
    v_exp_f32 v54, v114
    v_exp_f32 v55, v115
    v_exp_f32 v56, v116
    v_exp_f32 v57, v117
    v_exp_f32 v58, v118
    v_exp_f32 v59, v119
    s_nop 0
    v_cvt_pk_bf16_f32 v152, v52, v53
    v_cvt_pk_bf16_f32 v153, v54, v55
    v_cvt_pk_bf16_f32 v154, v56, v57
    v_cvt_pk_bf16_f32 v155, v58, v59
    s_nop 1
    v_mfma_f32_16x16x32_bf16 v[36:39], v[44:47], v[152:155], 0
    v_max3_f32 v48, v120, v121, v122
    v_max3_f32 v48, v48, v123, v124
    v_max3_f32 v48, v48, v125, v126
    v_max3_f32 v48, v48, v127, 0
    v_mov_b32 v49, v48
    s_nop 1
    v_permlane32_swap_b32 v48, v49
    s_nop 1
    v_max_f32 v48, v48, v49
    v_mov_b32 v49, v48
    s_nop 1
    v_permlane16_swap_b32 v48, v49
    s_nop 1
    v_max_f32 v48, v48, v49
    v_exp_f32 v49, -v48
    v_sub_f32 v120, v120, v48
    v_sub_f32 v121, v121, v48
    v_sub_f32 v122, v122, v48
    v_sub_f32 v123, v123, v48
    v_sub_f32 v124, v124, v48
    v_sub_f32 v125, v125, v48
    v_sub_f32 v126, v126, v48
    v_sub_f32 v127, v127, v48
    v_sub_f32 v88, v88, v48
    v_sub_f32 v89, v89, v48
    v_sub_f32 v90, v90, v48
    v_sub_f32 v91, v91, v48
    v_sub_f32 v92, v92, v48
    v_sub_f32 v93, v93, v48
    v_sub_f32 v94, v94, v48
    v_sub_f32 v95, v95, v48
    v_sub_f32 v184, v184, v48
    v_sub_f32 v185, v185, v48
    v_sub_f32 v186, v186, v48
    v_sub_f32 v187, v187, v48
    v_sub_f32 v188, v188, v48
    v_sub_f32 v189, v189, v48
    v_sub_f32 v190, v190, v48
    v_sub_f32 v191, v191, v48
    v_mul_f32 v15, v15, v49
    v_accvgpr_read_b32 v52, a96
    v_accvgpr_read_b32 v53, a97
    v_accvgpr_read_b32 v54, a98
    v_accvgpr_read_b32 v55, a99
    v_accvgpr_read_b32 v56, a100
    v_accvgpr_read_b32 v57, a101
    v_accvgpr_read_b32 v58, a102
    v_accvgpr_read_b32 v59, a103
    v_mul_f32 v52, v52, v49
    v_mul_f32 v53, v53, v49
    v_mul_f32 v54, v54, v49
    v_mul_f32 v55, v55, v49
    v_mul_f32 v56, v56, v49
    v_mul_f32 v57, v57, v49
    v_mul_f32 v58, v58, v49
    v_mul_f32 v59, v59, v49
    v_accvgpr_write_b32 a96, v52
    v_accvgpr_write_b32 a97, v53
    v_accvgpr_write_b32 a98, v54
    v_accvgpr_write_b32 a99, v55
    v_accvgpr_write_b32 a100, v56
    v_accvgpr_write_b32 a101, v57
    v_accvgpr_write_b32 a102, v58
    v_accvgpr_write_b32 a103, v59
    v_accvgpr_read_b32 v52, a104
    v_accvgpr_read_b32 v53, a105
    v_accvgpr_read_b32 v54, a106
    v_accvgpr_read_b32 v55, a107
    v_accvgpr_read_b32 v56, a108
    v_accvgpr_read_b32 v57, a109
    v_accvgpr_read_b32 v58, a110
    v_accvgpr_read_b32 v59, a111
    v_mul_f32 v52, v52, v49
    v_mul_f32 v53, v53, v49
    v_mul_f32 v54, v54, v49
    v_mul_f32 v55, v55, v49
    v_mul_f32 v56, v56, v49
    v_mul_f32 v57, v57, v49
    v_mul_f32 v58, v58, v49
    v_mul_f32 v59, v59, v49
    v_accvgpr_write_b32 a104, v52
    v_accvgpr_write_b32 a105, v53
    v_accvgpr_write_b32 a106, v54
    v_accvgpr_write_b32 a107, v55
    v_accvgpr_write_b32 a108, v56
    v_accvgpr_write_b32 a109, v57
    v_accvgpr_write_b32 a110, v58
    v_accvgpr_write_b32 a111, v59
    v_accvgpr_read_b32 v52, a112
    v_accvgpr_read_b32 v53, a113
    v_accvgpr_read_b32 v54, a114
    v_accvgpr_read_b32 v55, a115
    v_accvgpr_read_b32 v56, a116
    v_accvgpr_read_b32 v57, a117
    v_accvgpr_read_b32 v58, a118
    v_accvgpr_read_b32 v59, a119
    v_mul_f32 v52, v52, v49
    v_mul_f32 v53, v53, v49
    v_mul_f32 v54, v54, v49
    v_mul_f32 v55, v55, v49
    v_mul_f32 v56, v56, v49
    v_mul_f32 v57, v57, v49
    v_mul_f32 v58, v58, v49
    v_mul_f32 v59, v59, v49
    v_accvgpr_write_b32 a112, v52
    v_accvgpr_write_b32 a113, v53
    v_accvgpr_write_b32 a114, v54
    v_accvgpr_write_b32 a115, v55
    v_accvgpr_write_b32 a116, v56
    v_accvgpr_write_b32 a117, v57
    v_accvgpr_write_b32 a118, v58
    v_accvgpr_write_b32 a119, v59
    v_accvgpr_read_b32 v52, a120
    v_accvgpr_read_b32 v53, a121
    v_accvgpr_read_b32 v54, a122
    v_accvgpr_read_b32 v55, a123
    v_accvgpr_read_b32 v56, a124
    v_accvgpr_read_b32 v57, a125
    v_accvgpr_read_b32 v58, a126
    v_accvgpr_read_b32 v59, a127
    v_mul_f32 v52, v52, v49
    v_mul_f32 v53, v53, v49
    v_mul_f32 v54, v54, v49
    v_mul_f32 v55, v55, v49
    v_mul_f32 v56, v56, v49
    v_mul_f32 v57, v57, v49
    v_mul_f32 v58, v58, v49
    v_mul_f32 v59, v59, v49
    v_accvgpr_write_b32 a120, v52
    v_accvgpr_write_b32 a121, v53
    v_accvgpr_write_b32 a122, v54
    v_accvgpr_write_b32 a123, v55
    v_accvgpr_write_b32 a124, v56
    v_accvgpr_write_b32 a125, v57
    v_accvgpr_write_b32 a126, v58
    v_accvgpr_write_b32 a127, v59
    v_exp_f32 v52, v120
    v_exp_f32 v53, v121
    v_exp_f32 v54, v122
    v_exp_f32 v55, v123
    v_exp_f32 v56, v124
    v_exp_f32 v57, v125
    v_exp_f32 v58, v126
    v_exp_f32 v59, v127
    s_nop 0
    v_cvt_pk_bf16_f32 v156, v52, v53
    v_cvt_pk_bf16_f32 v157, v54, v55
    v_cvt_pk_bf16_f32 v158, v56, v57
    v_cvt_pk_bf16_f32 v159, v58, v59
    s_nop 1
    v_mfma_f32_16x16x32_bf16 v[40:43], v[44:47], v[156:159], 0
    s_nop 7
    s_setpc_b64 s[74:75]
m_hook18:
    s_cmp_lg_u32 s16, 0
    s_cbranch_scc1 m_np37
    v_mov_b32 v4, s4
    v_mov_b32 v5, s5
    s_add_u32 s90, s17, 117440512
    s_mov_b64 exec, 1
    buffer_store_dwordx2 v[4:5], off, s[8:11], s90 sc1
    s_mov_b64 exec, -1
m_np37:
    s_mov_b32 s17, -1
    s_branch m_hookr19
m_hook23:
    s_cmp_lg_u32 s16, 0
    s_cbranch_scc1 m_np38
    v_mov_b32 v4, s4
    v_mov_b32 v5, s5
    s_add_u32 s90, s17, 117440512
    s_mov_b64 exec, 1
    buffer_store_dwordx2 v[4:5], off, s[8:11], s90 sc1
    s_mov_b64 exec, -1
m_np38:
    s_mov_b32 s17, -1
    s_branch m_hookr24
m_pf7:
    s_mov_b32 s15, 0x20000
    s_sub_u32 s93, s2, 224
    s_lshl_b32 s93, s93, 2
    s_add_u32 s93, s93, s16
    v_lshlrev_b32 v24, 7, v1
    v_lshrrev_b32 v25, 3, v1
    v_lshlrev_b32 v25, 11, v25
    v_and_b32 v26, 7, v1
    v_lshl_add_u32 v25, v26, 7, v25
    s_lshl_b32 s92, s93, 13
    s_lshl_b32 s93, s93, 14
    s_add_u32 s93, s93, 1024
    s_mov_b32 s12, s26
    s_mov_b32 s13, s27
    s_mov_b32 s14, 6291456
    s_add_u32 s90, s92, 0
    buffer_load_dword v22, v24, s[12:15], s90 offen
    s_add_u32 s90, s92, 1048576
    buffer_load_dword v22, v24, s[12:15], s90 offen
    s_mov_b32 s12, s24
    s_mov_b32 s13, s25
    s_mov_b32 s14, 4194304
    s_add_u32 s90, s92, 0
    buffer_load_dword v22, v24, s[12:15], s90 offen
    s_add_u32 s90, s92, 1048576
    buffer_load_dword v22, v24, s[12:15], s90 offen
    s_add_u32 s90, s92, 2097152
    buffer_load_dword v22, v24, s[12:15], s90 offen
    s_add_u32 s90, s92, 3145728
    buffer_load_dword v22, v24, s[12:15], s90 offen
    s_mov_b32 s12, s34
    s_mov_b32 s13, s35
    s_mov_b32 s14, 8388608
    s_add_u32 s90, s92, 4194304
    buffer_load_dword v22, v24, s[12:15], s90 offen
    s_add_u32 s90, s92, 5242880
    buffer_load_dword v22, v24, s[12:15], s90 offen
    s_mov_b32 s12, s30
    s_mov_b32 s13, s31
    s_mov_b32 s14, 4194304
    s_add_u32 s90, s93, 0
    buffer_load_dword v22, v25, s[12:15], s90 offen
    s_add_u32 s90, s93, 2097152
    buffer_load_dword v22, v25, s[12:15], s90 offen
    s_mov_b32 s12, s26
    s_mov_b32 s13, s27
    s_mov_b32 s14, 6291456
    s_add_u32 s90, s92, 2097152
    buffer_load_dword v22, v24, s[12:15], s90 offen
    s_mov_b32 s12, s34
    s_mov_b32 s13, s35
    s_mov_b32 s14, 8388608
    s_add_u32 s90, s92, 6291456
    buffer_load_dword v22, v24, s[12:15], s90 offen
    s_add_u32 s90, s92, 7340032
    buffer_load_dword v22, v24, s[12:15], s90 offen
    s_mov_b32 s12, s26
    s_mov_b32 s13, s27
    s_mov_b32 s14, 6291456
    s_add_u32 s90, s92, 3145728
    buffer_load_dword v22, v24, s[12:15], s90 offen
    s_add_u32 s90, s92, 4194304
    buffer_load_dword v22, v24, s[12:15], s90 offen
    s_add_u32 s90, s92, 5242880
    buffer_load_dword v22, v24, s[12:15], s90 offen
    s_mov_b32 s12, s32
    s_mov_b32 s13, s33
    s_mov_b32 s14, 2097152
    s_add_u32 s90, s92, 1048576
    buffer_load_dword v22, v24, s[12:15], s90 offen
    s_add_u32 s61, s61, 32768
    s_branch m_nopf6
concat_heads__sliding_local_dilated__compressed_kv_cla__prompt_kernel_end:
.section .rodata,"a"
.p2align 6
.amdhsa_kernel concat_heads__sliding_local_dilated__compressed_kv_cla__prompt_kernel
  .amdhsa_next_free_vgpr 512
  .amdhsa_next_free_sgpr 102
  .amdhsa_accum_offset 256
  .amdhsa_group_segment_fixed_size 0
  .amdhsa_kernarg_size 96
  .amdhsa_user_sgpr_count 2
  .amdhsa_user_sgpr_kernarg_segment_ptr 1
  .amdhsa_system_sgpr_workgroup_id_x 1
.end_amdhsa_kernel
```

```asm
; @launch grid=(256,1,1) block=(256,1,1) lds=163840
.amdgcn_target "amdgcn-amd-amdhsa--gfx950"
.text
.globl concat_heads__sliding_local_dilated__compressed_kv_cla__prompt_kernel
.p2align 8
.type concat_heads__sliding_local_dilated__compressed_kv_cla__prompt_kernel,@function
concat_heads__sliding_local_dilated__compressed_kv_cla__prompt_kernel:
    s_cmp_ge_u32 s2, 256
    s_cbranch_scc1 m_end1
    s_load_dwordx16 s[24:39], s[0:1], 0
    s_load_dwordx4 s[4:7], s[0:1], 80
    v_and_b32 v1, 63, v0
    v_lshrrev_b32 v24, 6, v0
    s_nop 0
    v_readfirstlane_b32 s16, v24
    s_lshr_b32 s68, s2, 3
    s_lshr_b32 s57, s16, 1
    s_and_b32 s58, s16, 1
    s_mov_b32 s43, 0x20000
    s_mov_b32 s47, 0x20000
    s_cmp_lt_u32 s68, 28
    s_cbranch_scc1 m_ncp2
    s_sub_u32 s91, s68, 28
    s_lshl_b32 s91, s91, 2
    s_add_u32 s91, s91, s16
    s_getpc_b64 s[8:9]
m_pc3:
    s_sub_u32 s8, s8, m_pc3-concat_heads__sliding_local_dilated__compressed_kv_cla__prompt_kernel
    s_subb_u32 s9, s9, 0
    s_lshl_b32 s90, s91, 13
    v_lshlrev_b32 v24, 7, v1
    v_add_u32 v24, s90, v24
    v_min_u32 v24, concat_heads__sliding_local_dilated__compressed_kv_cla__prompt_kernel_end-concat_heads__sliding_local_dilated__compressed_kv_cla__prompt_kernel-4, v24
    v_mov_b32 v25, s9
    v_add_co_u32 v24, vcc, s8, v24
    s_nop 1
    v_addc_co_u32 v25, vcc, 0, v25, vcc
    global_load_dword v22, v[24:25], off
m_ncp2:
    s_lshl_b32 s61, s16, 13
    s_add_u32 s62, s61, 98304
    s_cmp_ge_u32 s68, 16
    s_cbranch_scc1 m_typea4
    s_and_b32 s69, s68, 3
    s_and_b32 s90, s2, 1
    s_lshl_b32 s90, s90, 2
    s_add_u32 s69, s69, s90
    s_bfe_u32 s90, s2, 0x20001
    s_mul_i32 s90, s90, 4
    s_bfe_u32 s91, s68, 0x20002
    s_add_u32 s90, s90, s91
    s_mov_b32 s76, 8388608
    s_mov_b32 s78, 8192
    s_mov_b32 s81, 0
    s_mov_b32 s73, 4194304
    s_mov_b32 s77, 2048
    s_mov_b32 s82, 16
    s_lshl_b32 s80, s90, 9
    s_lshl_b32 s79, s69, 19
    s_lshl_b32 s88, s90, 4
    s_add_u32 s88, s88, s69
    s_lshl_b32 s88, s88, 3
    s_mov_b32 s83, 0
    s_mov_b32 s84, 1040356334
    s_lshl_b32 s91, s90, 1
    s_add_u32 s91, s91, s58
    s_lshl_b32 s91, s91, 19
    s_lshl_b32 s92, s69, 1
    s_add_u32 s92, s92, s57
    s_lshl_b32 s92, s92, 15
    s_add_u32 s85, s91, s92
    s_add_u32 s85, s85, 0
    s_mov_b32 s86, 1024
    s_mov_b32 s87, 4096
    s_branch m_go15
m_typea4:
    s_bfe_u32 s69, s68, 0x20002
    s_add_u32 s69, s69, 0
    s_and_b32 s90, s2, 7
    s_lshl_b32 s90, s90, 2
    s_and_b32 s91, s68, 3
    s_add_u32 s90, s90, s91
    s_cmp_lt_u32 s90, 16
    s_cselect_b32 s83, 0, 1
    s_mov_b32 s91, 33554432
    s_cselect_b32 s85, 16777216, s91
    s_mov_b32 s91, 8192
    s_cselect_b32 s86, 1024, s91
    s_mov_b32 s91, 1024
    s_cselect_b32 s87, 4096, s91
    s_mov_b32 s73, 2097152
    s_mov_b32 s77, 1024
    s_mov_b32 s82, 8
    s_mov_b32 s81, 0
    s_mov_b32 s76, 4194304
    s_mov_b32 s78, 8192
    s_mov_b32 s84, 0
    s_and_b32 s90, s90, 15
    s_lshl_b32 s80, s90, 9
    s_lshl_b32 s79, s69, 18
    s_lshl_b32 s91, s83, 2
    s_add_u32 s91, s91, s69
    s_cmp_ge_u32 s69, 4
    s_cselect_b32 s92, 508, 8
    s_add_u32 s91, s91, s92
    s_lshl_b32 s88, s90, 4
    s_add_u32 s88, s88, s91
    s_lshl_b32 s88, s88, 3
    s_lshl_b32 s91, s90, 1
    s_add_u32 s91, s91, s58
    s_lshl_b32 s91, s91, 19
    s_lshl_b32 s92, s69, 1
    s_add_u32 s92, s92, s57
    s_lshl_b32 s92, s92, 15
    s_add_u32 s85, s85, s91
    s_add_u32 s85, s85, s92
m_go15:
    s_mov_b32 s42, s73
    s_lshl_b32 s90, s77, 4
    s_lshl_b32 s90, s90, s81
    s_mov_b32 s48, s79
    s_mul_i32 s91, s90, 1
    s_add_u32 s49, s91, s79
    s_sub_u32 s49, s49, 2048
    s_mul_i32 s91, s90, 2
    s_add_u32 s50, s91, s79
    s_mul_i32 s91, s90, 3
    s_add_u32 s51, s91, s79
    s_sub_u32 s51, s51, 2048
    s_lshl_b32 s90, s58, 7
    s_add_u32 s90, s90, s57
    s_lshl_b32 s91, s16, 6
    s_cmp_eq_u32 s81, 1
    s_cselect_b32 s90, s90, s91
    v_lshrrev_b32 v24, 3, v1
    v_lshlrev_b32 v24, s81, v24
    v_add_u32 v24, s90, v24
    v_mul_lo_u32 v24, v24, s77
    v_lshrrev_b32 v25, 4, v1
    v_and_b32 v26, 7, v1
    v_xor_b32 v25, v25, v26
    v_lshl_add_u32 v16, v25, 4, v24
    v_xor_b32 v25, 4, v25
    v_lshl_add_u32 v17, v25, 4, v24
    s_lshl_b32 s90, s77, 3
    s_lshl_b32 s90, s90, s81
    s_sub_u32 s90, s90, 1024
    v_add_u32 v17, s90, v17
    s_mov_b32 s46, s76
    s_mov_b32 s52, s80
    s_lshl_b32 s90, s78, 2
    s_mul_i32 s91, s90, 1
    s_add_u32 s53, s91, s80
    s_sub_u32 s53, s53, 2048
    s_mul_i32 s91, s90, 2
    s_add_u32 s54, s91, s80
    s_mul_i32 s91, s90, 3
    s_add_u32 s55, s91, s80
    s_sub_u32 s55, s55, 2048
    s_lshl_b32 s56, s78, 6
    v_lshrrev_b32 v24, 5, v1
    s_lshl_b32 s90, s16, 4
    v_add_u32 v25, s90, v24
    v_mul_lo_u32 v25, v25, s78
    v_lshlrev_b32 v24, 1, v24
    v_and_b32 v26, 31, v1
    v_xor_b32 v24, v24, v26
    s_lshl_b32 s90, s78, 1
    s_sub_u32 s90, s90, 1024
    v_add_u32 v27, s90, v25
    v_xor_b32 v26, 0, v24
    v_lshl_add_u32 v18, v26, 4, v25
    v_xor_b32 v26, 4, v24
    v_lshl_add_u32 v19, v26, 4, v27
    v_xor_b32 v26, 8, v24
    v_lshl_add_u32 v20, v26, 4, v25
    v_xor_b32 v26, 12, v24
    v_lshl_add_u32 v21, v26, 4, v27
    s_cmp_eq_u32 s83, 0
    s_waitcnt lgkmcnt(0)
    s_cselect_b32 s44, s36, s38
    s_cselect_b32 s45, s37, s39
    s_cmp_lt_u32 s68, 16
    s_cselect_b32 s44, s34, s44
    s_cselect_b32 s45, s35, s45
    s_cselect_b32 s40, s30, s32
    s_cselect_b32 s41, s31, s33
    s_cmp_ge_u32 s68, 28
    s_cselect_b32 s70, 1, 0
    s_cbranch_scc1 m_pf7
m_nopf6:
    s_add_u32 m0, s61, 0
    s_nop 0
    buffer_load_dwordx4 v16, s[40:43], s48 offen offset:0 sc1 lds
    buffer_load_dwordx4 v17, s[40:43], s48 offen offset:1024 sc1 lds
    s_add_u32 s48, s48, 128
    buffer_load_dwordx4 v16, s[40:43], s49 offen offset:2048 sc1 lds
    buffer_load_dwordx4 v17, s[40:43], s49 offen offset:3072 sc1 lds
    s_add_u32 s49, s49, 128
    s_add_u32 m0, s61, 4096
    s_nop 0
    buffer_load_dwordx4 v16, s[40:43], s50 offen offset:0 sc1 lds
    buffer_load_dwordx4 v17, s[40:43], s50 offen offset:1024 sc1 lds
    s_add_u32 s50, s50, 128
    buffer_load_dwordx4 v16, s[40:43], s51 offen offset:2048 sc1 lds
    buffer_load_dwordx4 v17, s[40:43], s51 offen offset:3072 sc1 lds
    s_add_u32 s51, s51, 128
    s_add_u32 s61, s61, 32768
    s_cmp_ge_u32 s61, 98304
    s_cselect_b32 s90, 98304, 0
    s_sub_u32 s61, s61, s90
    s_add_u32 m0, s62, 0
    s_nop 0
    buffer_load_dwordx4 v18, s[44:47], s52 offen offset:0 sc1 lds
    buffer_load_dwordx4 v19, s[44:47], s52 offen offset:1024 sc1 lds
    s_add_u32 s52, s52, s56
    buffer_load_dwordx4 v18, s[44:47], s53 offen offset:2048 sc1 lds
    buffer_load_dwordx4 v19, s[44:47], s53 offen offset:3072 sc1 lds
    s_add_u32 s53, s53, s56
    s_add_u32 m0, s62, 4096
    s_nop 0
    buffer_load_dwordx4 v20, s[44:47], s54 offen offset:0 sc1 lds
    buffer_load_dwordx4 v21, s[44:47], s54 offen offset:1024 sc1 lds
    s_add_u32 s54, s54, s56
    buffer_load_dwordx4 v20, s[44:47], s55 offen offset:2048 sc1 lds
    buffer_load_dwordx4 v21, s[44:47], s55 offen offset:3072 sc1 lds
    s_add_u32 s55, s55, s56
    s_xor_b32 s62, s62, 229376
    s_mov_b32 s95, s82
    s_mov_b32 s96, s83
    s_mov_b32 s97, s84
    s_mov_b32 s98, s85
    s_mov_b32 s99, s86
    s_mov_b32 s100, s87
    s_mov_b32 s101, s88
    v_and_b32 v24, 15, v1
    v_lshrrev_b32 v25, 4, v1
    v_bfe_u32 v26, v1, 1, 3
    v_xor_b32 v26, v26, v25
    s_lshl_b32 s90, s57, 14
    v_lshlrev_b32 v27, 7, v24
    v_add_u32 v27, s90, v27
    v_xor_b32 v28, 0, v26
    v_lshl_add_u32 v6, v28, 4, v27
    v_xor_b32 v28, 4, v26
    v_lshl_add_u32 v7, v28, 4, v27
    v_bfe_u32 v26, v1, 2, 2
    v_lshl_add_u32 v27, v25, 3, v26
    v_lshlrev_b32 v27, 9, v27
    v_and_b32 v28, 3, v1
    v_lshlrev_b32 v28, 3, v28
    v_add_u32 v27, v27, v28
    s_lshl_b32 s90, s58, 8
    s_add_u32 s90, s90, 98304
    v_add_u32 v27, s90, v27
    v_bfe_u32 v26, v1, 2, 3
    v_xor_b32 v28, 0, v26
    v_lshl_add_u32 v8, v28, 5, v27
    v_xor_b32 v28, 1, v26
    v_lshl_add_u32 v9, v28, 5, v27
    v_xor_b32 v28, 2, v26
    v_lshl_add_u32 v10, v28, 5, v27
    v_xor_b32 v28, 3, v26
    v_lshl_add_u32 v11, v28, 5, v27
    v_xor_b32 v28, 4, v26
    v_lshl_add_u32 v12, v28, 5, v27
    v_xor_b32 v28, 5, v26
    v_lshl_add_u32 v13, v28, 5, v27
    v_xor_b32 v28, 6, v26
    v_lshl_add_u32 v14, v28, 5, v27
    v_xor_b32 v28, 7, v26
    v_lshl_add_u32 v15, v28, 5, v27
    v_lshlrev_b32 v2, 4, v1
    s_mov_b32 s64, 0
    s_mov_b32 s59, 32768
    s_mov_b32 s60, 229376
    s_mov_b32 s8, s6
    s_mov_b32 s9, s7
    s_mov_b32 s10, 268435456
    s_mov_b32 s11, 0x20000
    s_cmp_ge_u32 s68, 16
    s_cbranch_scc1 m_typea8
    s_bfe_u32 s69, s68, 0x20002
    s_add_u32 s69, s69, 4
    s_and_b32 s90, s2, 7
    s_lshl_b32 s90, s90, 2
    s_and_b32 s91, s68, 3
    s_add_u32 s90, s90, s91
    s_cmp_lt_u32 s90, 16
    s_cselect_b32 s83, 0, 1
    s_mov_b32 s91, 33554432
    s_cselect_b32 s85, 16777216, s91
    s_mov_b32 s91, 8192
    s_cselect_b32 s86, 1024, s91
    s_mov_b32 s91, 1024
    s_cselect_b32 s87, 4096, s91
    s_cselect_b32 s74, s36, s38
    s_cselect_b32 s75, s37, s39
    s_mov_b32 s71, s32
    s_mov_b32 s72, s33
    s_mov_b32 s73, 2097152
    s_mov_b32 s77, 1024
    s_mov_b32 s82, 8
    s_mov_b32 s81, 0
    s_mov_b32 s76, 4194304
    s_mov_b32 s78, 8192
    s_mov_b32 s84, 0
    s_and_b32 s90, s90, 15
    s_lshl_b32 s80, s90, 9
    s_lshl_b32 s79, s69, 18
    s_lshl_b32 s91, s83, 2
    s_add_u32 s91, s91, s69
    s_cmp_ge_u32 s69, 4
    s_cselect_b32 s92, 508, 8
    s_add_u32 s91, s91, s92
    s_lshl_b32 s88, s90, 4
    s_add_u32 s88, s88, s91
    s_lshl_b32 s88, s88, 3
    s_lshl_b32 s91, s90, 1
    s_add_u32 s91, s91, s58
    s_lshl_b32 s91, s91, 19
    s_lshl_b32 s92, s69, 1
    s_add_u32 s92, s92, s57
    s_lshl_b32 s92, s92, 15
    s_add_u32 s85, s85, s91
    s_add_u32 s85, s85, s92
    s_branch m_go29
m_typea8:
    s_and_b32 s69, s68, 3
    s_and_b32 s90, s2, 1
    s_lshl_b32 s90, s90, 2
    s_add_u32 s69, s69, s90
    s_bfe_u32 s90, s2, 0x20001
    s_mul_i32 s90, s90, 3
    s_bfe_u32 s91, s68, 0x20002
    s_add_u32 s90, s90, s91
    s_mov_b32 s76, 6291456
    s_mov_b32 s78, 6144
    s_mov_b32 s81, 1
    s_mov_b32 s73, 4194304
    s_mov_b32 s77, 2048
    s_mov_b32 s82, 16
    s_lshl_b32 s80, s90, 9
    s_lshl_b32 s79, s69, 19
    s_and_b32 s92, s90, 3
    s_lshr_b32 s91, s90, 2
    s_lshl_b32 s88, s92, 2
    s_add_u32 s88, s88, s91
    s_lshl_b32 s88, s88, 3
    s_add_u32 s88, s88, s69
    s_lshl_b32 s88, s88, 3
    s_add_u32 s88, s88, 6144
    s_cmp_eq_u32 s91, 0
    s_cselect_b32 s84, 1048744942, 0
    s_lshl_b32 s93, s91, 22
    s_add_u32 s85, s93, 50331648
    s_lshl_b32 s92, s92, 1
    s_add_u32 s92, s92, s58
    s_lshl_b32 s92, s92, 19
    s_add_u32 s85, s85, s92
    s_lshl_b32 s92, s57, 3
    s_add_u32 s92, s92, s69
    s_cmp_eq_u32 s91, 2
    s_cselect_b32 s83, 1, 0
    s_cselect_b32 s93, 12, 13
    s_mov_b32 s91, 131072
    s_cselect_b32 s86, 1024, s91
    s_mov_b32 s91, 1024
    s_cselect_b32 s87, 65536, s91
    s_lshl_b32 s92, s92, s93
    s_add_u32 s85, s85, s92
    s_mov_b32 s71, s24
    s_mov_b32 s72, s25
    s_mov_b32 s74, s26
    s_mov_b32 s75, s27
m_go29:
    s_and_b32 s92, s2, 7
    s_lshl_b32 s92, s92, 2
    s_bfe_u32 s93, s2, 0x20003
    s_add_u32 s92, s92, s93
    s_lshr_b32 s93, s2, 5
    s_lshl_b32 s93, s93, 2
    s_or_b32 s93, s93, 0x40000
    s_lshr_b32 s37, s92, 1
    s_lshl_b32 s37, s37, 7
    s_add_u32 s37, s37, 117440512
    s_lshl_b32 s92, s92, 19
    s_lshl_b32 s91, s58, 13
    s_add_u32 s90, s92, s91
    s_cmp_eq_u32 s57, 0
    s_mov_b32 s91, 33538048
    s_cselect_b32 s91, 16777216, s91
    s_add_u32 s32, s90, s91
    s_bfe_u32 s90, 4225681832, s93
    s_lshl_b32 s90, s90, 3
    s_lshl_b32 s91, s16, 1
    s_add_u32 s90, s90, s91
    s_lshl_b32 s90, s90, 12
    s_add_u32 s90, s90, s92
    s_add_u32 s33, s90, 0
    s_add_u32 s34, s90, 4096
    s_bfe_u32 s90, 873473623, s93
    s_lshl_b32 s90, s90, 3
    s_lshl_b32 s91, s16, 1
    s_add_u32 s90, s90, s91
    s_lshl_b32 s90, s90, 12
    s_add_u32 s90, s90, s92
    s_add_u32 s35, s90, 0
    s_add_u32 s36, s90, 4096
    s_bfe_u32 s91, 873473623, s93
    s_lshr_b32 s91, s91, 1
    v_mov_b32 v0, s91
    v_and_b32 v24, 3, v1
    v_min_u32 v24, 2, v24
    v_and_b32 v25, 4, v1
    v_add3_u32 v24, v24, v25, 8
    v_cmp_gt_u32 vcc, 8, v1
    s_nop 1
    v_cndmask_b32 v0, v0, v24, vcc
    s_bfe_u32 s91, 4225681832, s93
    s_lshr_b32 s91, s91, 1
    v_writelane_b32 v0, s91, 8
    v_lshlrev_b32 v0, 3, v0
    s_xor_b32 s94, s70, 1
    s_add_u32 s67, s70, 3
    s_mov_b32 s17, -1
    s_mul_i32 s64, s70, 32768
    v_add_u32 v6, s64, v6
    v_add_u32 v7, s64, v7
    s_mov_b32 s12, s4
    s_mov_b32 s13, s5
    s_mov_b32 s14, 256
    s_mov_b32 s15, 0x20000
    s_lshl_b32 s90, s2, 2
    s_add_u32 s90, s90, s16
    s_cmp_lg_u32 s90, 0
    s_cbranch_scc1 m_tok10
    s_memrealtime s[92:93]
    s_waitcnt lgkmcnt(0)
    s_or_b32 s92, s92, 1
    v_mov_b32 v4, s92
    v_mov_b32 v5, s93
    s_mov_b64 exec, 1
    buffer_store_dwordx2 v[4:5], off, s[12:15], 0 sc1
    s_mov_b64 exec, -1
m_tok10:
    s_cmp_eq_u32 s70, 0
    s_cbranch_scc1 m_tok11
    buffer_load_dwordx2 v[4:5], off, s[12:15], 0 sc1
    s_waitcnt vmcnt(0)
    s_mov_b32 s3, 1048576
m_spin12:
    v_readfirstlane_b32 s4, v4
    v_readfirstlane_b32 s5, v5
    s_nop 3
    s_cmp_lg_u32 s4, 0
    s_cbranch_scc1 m_ok13
    s_sub_u32 s3, s3, 1
    s_cbranch_scc1 m_ok13
    s_sleep 32
    buffer_load_dwordx2 v[4:5], off, s[12:15], 0 sc1
    s_waitcnt vmcnt(0)
    s_branch m_spin12
m_ok13:
m_tok11:
    s_add_u32 m0, s61, 0
    s_nop 0
    buffer_load_dwordx4 v16, s[40:43], s48 offen offset:0 sc1 lds
    buffer_load_dwordx4 v17, s[40:43], s48 offen offset:1024 sc1 lds
    s_add_u32 s48, s48, 128
    buffer_load_dwordx4 v16, s[40:43], s49 offen offset:2048 sc1 lds
    buffer_load_dwordx4 v17, s[40:43], s49 offen offset:3072 sc1 lds
    s_add_u32 s49, s49, 128
    s_add_u32 m0, s61, 4096
    s_nop 0
    buffer_load_dwordx4 v16, s[40:43], s50 offen offset:0 sc1 lds
    buffer_load_dwordx4 v17, s[40:43], s50 offen offset:1024 sc1 lds
    s_add_u32 s50, s50, 128
    buffer_load_dwordx4 v16, s[40:43], s51 offen offset:2048 sc1 lds
    buffer_load_dwordx4 v17, s[40:43], s51 offen offset:3072 sc1 lds
    s_add_u32 s51, s51, 128
    s_add_u32 s61, s61, 32768
    s_cmp_ge_u32 s61, 98304
    s_cselect_b32 s90, 98304, 0
    s_sub_u32 s61, s61, s90
    s_add_u32 m0, s62, 0
    s_nop 0
    buffer_load_dwordx4 v18, s[44:47], s52 offen offset:0 sc1 lds
    buffer_load_dwordx4 v19, s[44:47], s52 offen offset:1024 sc1 lds
    s_add_u32 s52, s52, s56
    buffer_load_dwordx4 v18, s[44:47], s53 offen offset:2048 sc1 lds
    buffer_load_dwordx4 v19, s[44:47], s53 offen offset:3072 sc1 lds
    s_add_u32 s53, s53, s56
    s_add_u32 m0, s62, 4096
    s_nop 0
    buffer_load_dwordx4 v20, s[44:47], s54 offen offset:0 sc1 lds
    buffer_load_dwordx4 v21, s[44:47], s54 offen offset:1024 sc1 lds
    s_add_u32 s54, s54, s56
    buffer_load_dwordx4 v20, s[44:47], s55 offen offset:2048 sc1 lds
    buffer_load_dwordx4 v21, s[44:47], s55 offen offset:3072 sc1 lds
    s_add_u32 s55, s55, s56
    s_xor_b32 s62, s62, 229376
    s_waitcnt vmcnt(16)
    s_barrier
    ds_read_b64_tr_b16 a[64:65], v8 offset:0
    ds_read_b64_tr_b16 a[66:67], v8 offset:2048
    ds_read_b64_tr_b16 a[68:69], v8 offset:16384
    ds_read_b64_tr_b16 a[70:71], v8 offset:18432
    ds_read_b64_tr_b16 a[72:73], v9 offset:0
    ds_read_b64_tr_b16 a[74:75], v9 offset:2048
    ds_read_b64_tr_b16 a[76:77], v9 offset:16384
    ds_read_b64_tr_b16 a[78:79], v9 offset:18432
    ds_read_b64_tr_b16 a[80:81], v10 offset:0
    ds_read_b64_tr_b16 a[82:83], v10 offset:2048
    ds_read_b64_tr_b16 a[84:85], v10 offset:16384
    ds_read_b64_tr_b16 a[86:87], v10 offset:18432
    ds_read_b64_tr_b16 a[88:89], v11 offset:0
    ds_read_b64_tr_b16 a[90:91], v11 offset:2048
    ds_read_b64_tr_b16 a[92:93], v11 offset:16384
    ds_read_b64_tr_b16 a[94:95], v11 offset:18432
    ds_read_b64_tr_b16 a[96:97], v12 offset:0
    ds_read_b128 a[0:3], v6 offset:0
    ds_read_b128 a[4:7], v7 offset:0
    ds_read_b64_tr_b16 a[98:99], v12 offset:2048
    ds_read_b128 a[8:11], v6 offset:2048
    ds_read_b128 a[12:15], v7 offset:2048
    ds_read_b64_tr_b16 a[100:101], v12 offset:16384
    ds_read_b128 a[16:19], v6 offset:4096
    ds_read_b128 a[20:23], v7 offset:4096
    ds_read_b64_tr_b16 a[102:103], v12 offset:18432
    ds_read_b128 a[24:27], v6 offset:6144
    ds_read_b128 a[28:31], v7 offset:6144
    ds_read_b64_tr_b16 a[104:105], v13 offset:0
    ds_read_b128 a[32:35], v6 offset:8192
    ds_read_b128 a[36:39], v7 offset:8192
    ds_read_b64_tr_b16 a[106:107], v13 offset:2048
    ds_read_b128 a[40:43], v6 offset:10240
    ds_read_b128 a[44:47], v7 offset:10240
    ds_read_b64_tr_b16 a[108:109], v13 offset:16384
    ds_read_b128 a[48:51], v6 offset:12288
    ds_read_b128 a[52:55], v7 offset:12288
    ds_read_b64_tr_b16 a[110:111], v13 offset:18432
    ds_read_b128 a[56:59], v6 offset:14336
    ds_read_b128 a[60:63], v7 offset:14336
    s_add_u32 m0, s61, 0
    s_nop 0
    buffer_load_dwordx4 v16, s[40:43], s48 offen offset:0 sc1 lds
    buffer_load_dwordx4 v17, s[40:43], s48 offen offset:1024 sc1 lds
    s_add_u32 s48, s48, 128
    buffer_load_dwordx4 v16, s[40:43], s49 offen offset:2048 sc1 lds
    buffer_load_dwordx4 v17, s[40:43], s49 offen offset:3072 sc1 lds
    s_add_u32 s49, s49, 128
    s_add_u32 m0, s61, 4096
    s_nop 0
    buffer_load_dwordx4 v16, s[40:43], s50 offen offset:0 sc1 lds
    buffer_load_dwordx4 v17, s[40:43], s50 offen offset:1024 sc1 lds
    s_add_u32 s50, s50, 128
    buffer_load_dwordx4 v16, s[40:43], s51 offen offset:2048 sc1 lds
    buffer_load_dwordx4 v17, s[40:43], s51 offen offset:3072 sc1 lds
    s_add_u32 s51, s51, 128
    s_add_u32 s61, s61, 32768
    s_cmp_ge_u32 s61, 98304
    s_cselect_b32 s90, 98304, 0
    s_sub_u32 s61, s61, s90
    s_mov_b32 s66, 1
    s_mov_b32 s24, s6
    s_mov_b32 s25, s7
    s_mov_b32 s26, 0
    s_mov_b32 s27, 0x20000
    s_mov_b32 s28, 0
    s_mov_b32 s29, 0
    s_mov_b32 s30, 0
    s_mov_b32 s31, 0
m_tile14:
    s_mov_b32 s65, s95
    s_cmp_eq_u32 s96, 1
    s_cbranch_scc1 m_swp16
    s_waitcnt lgkmcnt(15)
    v_mfma_f32_16x16x32_bf16 v[32:35], a[64:67], a[0:3], 0
    ds_read_b64_tr_b16 a[112:113], v14 offset:0
    v_mfma_f32_16x16x32_bf16 v[32:35], a[68:71], a[4:7], v[32:35]
    ds_read_b64_tr_b16 a[114:115], v14 offset:2048
    v_mfma_f32_16x16x32_bf16 v[36:39], a[76:79], a[4:7], 0
    ds_read_b64_tr_b16 a[116:117], v14 offset:16384
    v_mfma_f32_16x16x32_bf16 v[36:39], a[72:75], a[0:3], v[36:39]
    ds_read_b64_tr_b16 a[118:119], v14 offset:18432
    v_mfma_f32_16x16x32_bf16 v[44:47], a[72:75], a[8:11], 0
    ds_read_b64_tr_b16 a[120:121], v15 offset:0
    v_mfma_f32_16x16x32_bf16 v[44:47], a[76:79], a[12:15], v[44:47]
    ds_read_b64_tr_b16 a[122:123], v15 offset:2048
    v_mfma_f32_16x16x32_bf16 v[40:43], a[68:71], a[12:15], 0
    ds_read_b64_tr_b16 a[124:125], v15 offset:16384
    v_mfma_f32_16x16x32_bf16 v[40:43], a[64:67], a[8:11], v[40:43]
    ds_read_b64_tr_b16 a[126:127], v15 offset:18432
    v_mfma_f32_16x16x32_bf16 v[48:51], a[64:67], a[16:19], 0
    v_mfma_f32_16x16x32_bf16 v[48:51], a[68:71], a[20:23], v[48:51]
    v_mfma_f32_16x16x32_bf16 v[52:55], a[76:79], a[20:23], 0
    buffer_store_dwordx4 a[128:131], v2, s[24:27], s28 offen sc1
    v_mfma_f32_16x16x32_bf16 v[52:55], a[72:75], a[16:19], v[52:55]
    s_add_u32 s28, s28, s31
    s_waitcnt lgkmcnt(15)
    v_mfma_f32_16x16x32_bf16 v[60:63], a[72:75], a[24:27], 0
    v_xor_b32 v8, s60, v8
    v_xor_b32 v9, s60, v9
    v_mfma_f32_16x16x32_bf16 v[60:63], a[76:79], a[28:31], v[60:63]
    v_xor_b32 v10, s60, v10
    v_xor_b32 v11, s60, v11
    v_mfma_f32_16x16x32_bf16 v[56:59], a[68:71], a[28:31], 0
    v_xor_b32 v12, s60, v12
    v_xor_b32 v13, s60, v13
    v_mfma_f32_16x16x32_bf16 v[56:59], a[64:67], a[24:27], v[56:59]
    v_xor_b32 v14, s60, v14
    v_xor_b32 v15, s60, v15
    v_mfma_f32_16x16x32_bf16 v[64:67], a[64:67], a[32:35], 0
    buffer_store_dwordx4 a[132:135], v2, s[24:27], s28 offen sc1
    v_mfma_f32_16x16x32_bf16 v[64:67], a[68:71], a[36:39], v[64:67]
    s_add_u32 s28, s28, s31
    v_mfma_f32_16x16x32_bf16 v[68:71], a[76:79], a[36:39], 0
    v_mfma_f32_16x16x32_bf16 v[68:71], a[72:75], a[32:35], v[68:71]
    s_waitcnt lgkmcnt(14)
    v_mfma_f32_16x16x32_bf16 v[76:79], a[72:75], a[40:43], 0
    v_mfma_f32_16x16x32_bf16 v[76:79], a[76:79], a[44:47], v[76:79]
    v_mfma_f32_16x16x32_bf16 v[72:75], a[68:71], a[44:47], 0
    buffer_store_dwordx4 a[136:139], v2, s[24:27], s28 offen sc1
    v_mfma_f32_16x16x32_bf16 v[72:75], a[64:67], a[40:43], v[72:75]
    s_add_u32 s28, s28, s31
    s_waitcnt lgkmcnt(11)
    v_mfma_f32_16x16x32_bf16 v[80:83], a[64:67], a[48:51], 0
    v_mfma_f32_16x16x32_bf16 v[80:83], a[68:71], a[52:55], v[80:83]
    v_mfma_f32_16x16x32_bf16 v[84:87], a[76:79], a[52:55], 0
    v_mfma_f32_16x16x32_bf16 v[84:87], a[72:75], a[48:51], v[84:87]
    s_waitcnt lgkmcnt(8)
    v_mfma_f32_16x16x32_bf16 v[92:95], a[72:75], a[56:59], 0
    buffer_store_dwordx4 a[140:143], v2, s[24:27], s28 offen sc1
    v_mfma_f32_16x16x32_bf16 v[92:95], a[76:79], a[60:63], v[92:95]
    s_add_u32 s28, s28, s31
    v_mfma_f32_16x16x32_bf16 v[88:91], a[68:71], a[60:63], 0
    s_waitcnt vmcnt(44) lgkmcnt(0)
    s_cmp_eq_u32 s66, 2
    s_cbranch_scc1 m_w17
    s_waitcnt vmcnt(12)
m_w17:
    v_mfma_f32_16x16x32_bf16 v[88:91], a[64:67], a[56:59], v[88:91]
    s_barrier
    v_mfma_f32_16x16x32_bf16 v[96:99], a[80:83], a[0:3], 0
    ds_read_b64_tr_b16 a[64:65], v8 offset:0
    v_mfma_f32_16x16x32_bf16 v[96:99], a[84:87], a[4:7], v[96:99]
    s_add_u32 m0, s62, 0
    v_mfma_f32_16x16x32_bf16 v[100:103], a[92:95], a[4:7], 0
    buffer_load_dwordx4 v18, s[44:47], s52 offen offset:0 sc1 lds
    v_mfma_f32_16x16x32_bf16 v[100:103], a[88:91], a[0:3], v[100:103]
    ds_read_b64_tr_b16 a[66:67], v8 offset:2048
    v_mfma_f32_16x16x32_bf16 v[108:111], a[88:91], a[8:11], 0
    s_add_u32 s64, s64, 32768
    v_mfma_f32_16x16x32_bf16 v[108:111], a[92:95], a[12:15], v[108:111]
    s_cmp_ge_u32 s64, 98304
    s_cselect_b32 s63, 4294901760, s59
    s_cselect_b32 s64, 0, s64
    v_mfma_f32_16x16x32_bf16 v[104:107], a[84:87], a[12:15], 0
    buffer_load_dwordx4 v19, s[44:47], s52 offen offset:1024 sc1 lds
    v_mfma_f32_16x16x32_bf16 v[104:107], a[80:83], a[8:11], v[104:107]
    s_add_u32 s52, s52, s56
    ds_read_b64_tr_b16 a[68:69], v8 offset:16384
    v_mfma_f32_16x16x32_bf16 v[112:115], a[80:83], a[16:19], 0
    v_mfma_f32_16x16x32_bf16 v[112:115], a[84:87], a[20:23], v[112:115]
    v_mfma_f32_16x16x32_bf16 v[116:119], a[92:95], a[20:23], 0
    buffer_load_dwordx4 v18, s[44:47], s53 offen offset:2048 sc1 lds
    v_mfma_f32_16x16x32_bf16 v[116:119], a[88:91], a[16:19], v[116:119]
    ds_read_b64_tr_b16 a[70:71], v8 offset:18432
    v_mfma_f32_16x16x32_bf16 v[124:127], a[88:91], a[24:27], 0
    v_mfma_f32_16x16x32_bf16 v[124:127], a[92:95], a[28:31], v[124:127]
    v_mfma_f32_16x16x32_bf16 v[120:123], a[84:87], a[28:31], 0
    buffer_load_dwordx4 v19, s[44:47], s53 offen offset:3072 sc1 lds
    v_mfma_f32_16x16x32_bf16 v[120:123], a[80:83], a[24:27], v[120:123]
    s_add_u32 s53, s53, s56
    ds_read_b64_tr_b16 a[72:73], v9 offset:0
    v_mfma_f32_16x16x32_bf16 v[128:131], a[80:83], a[32:35], 0
    v_mfma_f32_16x16x32_bf16 v[128:131], a[84:87], a[36:39], v[128:131]
    s_add_u32 m0, s62, 4096
    v_mfma_f32_16x16x32_bf16 v[132:135], a[92:95], a[36:39], 0
    buffer_load_dwordx4 v20, s[44:47], s54 offen offset:0 sc1 lds
    v_mfma_f32_16x16x32_bf16 v[132:135], a[88:91], a[32:35], v[132:135]
    s_xor_b32 s62, s62, 229376
    ds_read_b64_tr_b16 a[74:75], v9 offset:2048
    v_mfma_f32_16x16x32_bf16 v[140:143], a[88:91], a[40:43], 0
    v_mfma_f32_16x16x32_bf16 v[140:143], a[92:95], a[44:47], v[140:143]
    v_mfma_f32_16x16x32_bf16 v[136:139], a[84:87], a[44:47], 0
    buffer_load_dwordx4 v21, s[44:47], s54 offen offset:1024 sc1 lds
    v_mfma_f32_16x16x32_bf16 v[136:139], a[80:83], a[40:43], v[136:139]
    s_add_u32 s54, s54, s56
    ds_read_b64_tr_b16 a[76:77], v9 offset:16384
    v_mfma_f32_16x16x32_bf16 v[144:147], a[80:83], a[48:51], 0
    v_mfma_f32_16x16x32_bf16 v[144:147], a[84:87], a[52:55], v[144:147]
    v_mfma_f32_16x16x32_bf16 v[148:151], a[92:95], a[52:55], 0
    buffer_load_dwordx4 v20, s[44:47], s55 offen offset:2048 sc1 lds
    v_mfma_f32_16x16x32_bf16 v[148:151], a[88:91], a[48:51], v[148:151]
    ds_read_b64_tr_b16 a[78:79], v9 offset:18432
    v_mfma_f32_16x16x32_bf16 v[156:159], a[88:91], a[56:59], 0
    v_add_u32 v6, s63, v6
    v_add_u32 v7, s63, v7
    v_mfma_f32_16x16x32_bf16 v[156:159], a[92:95], a[60:63], v[156:159]
    v_mfma_f32_16x16x32_bf16 v[152:155], a[84:87], a[60:63], 0
    buffer_load_dwordx4 v21, s[44:47], s55 offen offset:3072 sc1 lds
    v_mfma_f32_16x16x32_bf16 v[152:155], a[80:83], a[56:59], v[152:155]
    s_add_u32 s55, s55, s56
    v_mfma_f32_16x16x32_bf16 v[160:163], a[96:99], a[0:3], 0
    ds_read_b64_tr_b16 a[80:81], v10 offset:0
    v_mfma_f32_16x16x32_bf16 v[160:163], a[100:103], a[4:7], v[160:163]
    v_mfma_f32_16x16x32_bf16 v[164:167], a[108:111], a[4:7], 0
    v_mfma_f32_16x16x32_bf16 v[164:167], a[104:107], a[0:3], v[164:167]
    s_add_u32 m0, s61, 0
    ds_read_b64_tr_b16 a[82:83], v10 offset:2048
    v_mfma_f32_16x16x32_bf16 v[172:175], a[104:107], a[8:11], 0
    buffer_load_dwordx4 v16, s[40:43], s48 offen offset:0 sc1 lds
    v_mfma_f32_16x16x32_bf16 v[172:175], a[108:111], a[12:15], v[172:175]
    v_mfma_f32_16x16x32_bf16 v[168:171], a[100:103], a[12:15], 0
    ds_read_b64_tr_b16 a[84:85], v10 offset:16384
    v_mfma_f32_16x16x32_bf16 v[168:171], a[96:99], a[8:11], v[168:171]
    v_mfma_f32_16x16x32_bf16 v[176:179], a[96:99], a[16:19], 0
    buffer_store_dwordx4 a[144:147], v2, s[24:27], s28 offen sc1
    v_mfma_f32_16x16x32_bf16 v[176:179], a[100:103], a[20:23], v[176:179]
    s_add_u32 s28, s28, s31
    ds_read_b64_tr_b16 a[86:87], v10 offset:18432
    v_mfma_f32_16x16x32_bf16 v[180:183], a[108:111], a[20:23], 0
    v_mfma_f32_16x16x32_bf16 v[180:183], a[104:107], a[16:19], v[180:183]
    v_mfma_f32_16x16x32_bf16 v[188:191], a[104:107], a[24:27], 0
    buffer_load_dwordx4 v17, s[40:43], s48 offen offset:1024 sc1 lds
    v_mfma_f32_16x16x32_bf16 v[188:191], a[108:111], a[28:31], v[188:191]
    s_add_u32 s48, s48, 128
    ds_read_b64_tr_b16 a[88:89], v11 offset:0
    v_mfma_f32_16x16x32_bf16 v[184:187], a[100:103], a[28:31], 0
    v_mfma_f32_16x16x32_bf16 v[184:187], a[96:99], a[24:27], v[184:187]
    v_mfma_f32_16x16x32_bf16 v[192:195], a[96:99], a[32:35], 0
    buffer_store_dwordx4 a[148:151], v2, s[24:27], s28 offen sc1
    v_mfma_f32_16x16x32_bf16 v[192:195], a[100:103], a[36:39], v[192:195]
    s_add_u32 s28, s28, s31
    ds_read_b64_tr_b16 a[90:91], v11 offset:2048
    v_mfma_f32_16x16x32_bf16 v[196:199], a[108:111], a[36:39], 0
    v_mfma_f32_16x16x32_bf16 v[196:199], a[104:107], a[32:35], v[196:199]
    v_mfma_f32_16x16x32_bf16 v[204:207], a[104:107], a[40:43], 0
    buffer_load_dwordx4 v16, s[40:43], s49 offen offset:2048 sc1 lds
    v_mfma_f32_16x16x32_bf16 v[204:207], a[108:111], a[44:47], v[204:207]
    ds_read_b64_tr_b16 a[92:93], v11 offset:16384
    v_mfma_f32_16x16x32_bf16 v[200:203], a[100:103], a[44:47], 0
    v_mfma_f32_16x16x32_bf16 v[200:203], a[96:99], a[40:43], v[200:203]
    v_mfma_f32_16x16x32_bf16 v[208:211], a[96:99], a[48:51], 0
    buffer_store_dwordx4 a[152:155], v2, s[24:27], s28 offen sc1
    v_mfma_f32_16x16x32_bf16 v[208:211], a[100:103], a[52:55], v[208:211]
    s_add_u32 s28, s28, s31
    ds_read_b64_tr_b16 a[94:95], v11 offset:18432
    v_mfma_f32_16x16x32_bf16 v[212:215], a[108:111], a[52:55], 0
    v_mfma_f32_16x16x32_bf16 v[212:215], a[104:107], a[48:51], v[212:215]
    v_mfma_f32_16x16x32_bf16 v[220:223], a[104:107], a[56:59], 0
    buffer_load_dwordx4 v17, s[40:43], s49 offen offset:3072 sc1 lds
    v_mfma_f32_16x16x32_bf16 v[220:223], a[108:111], a[60:63], v[220:223]
    s_add_u32 s49, s49, 128
    v_mfma_f32_16x16x32_bf16 v[216:219], a[100:103], a[60:63], 0
    buffer_store_dwordx4 a[156:159], v2, s[24:27], s28 offen sc1
    v_mfma_f32_16x16x32_bf16 v[216:219], a[96:99], a[56:59], v[216:219]
    s_add_u32 s29, s29, s30
    s_mov_b32 s28, s29
    v_mfma_f32_16x16x32_bf16 v[224:227], a[112:115], a[0:3], 0
    v_mfma_f32_16x16x32_bf16 v[224:227], a[116:119], a[4:7], v[224:227]
    ds_read_b64_tr_b16 a[96:97], v12 offset:0
    v_mfma_f32_16x16x32_bf16 v[228:231], a[124:127], a[4:7], 0
    v_mfma_f32_16x16x32_bf16 v[228:231], a[120:123], a[0:3], v[228:231]
    s_add_u32 m0, s61, 4096
    ds_read_b128 a[0:3], v6 offset:0
    v_mfma_f32_16x16x32_bf16 v[236:239], a[120:123], a[8:11], 0
    buffer_load_dwordx4 v16, s[40:43], s50 offen offset:0 sc1 lds
    v_mfma_f32_16x16x32_bf16 v[236:239], a[124:127], a[12:15], v[236:239]
    s_add_u32 s61, s61, 32768
    ds_read_b128 a[4:7], v7 offset:0
    v_mfma_f32_16x16x32_bf16 v[232:235], a[116:119], a[12:15], 0
    s_cmp_ge_u32 s61, 98304
    s_cselect_b32 s90, 98304, 0
    ds_read_b64_tr_b16 a[98:99], v12 offset:2048
    v_mfma_f32_16x16x32_bf16 v[232:235], a[112:115], a[8:11], v[232:235]
    s_sub_u32 s61, s61, s90
    ds_read_b128 a[8:11], v6 offset:2048
    v_mfma_f32_16x16x32_bf16 v[240:243], a[112:115], a[16:19], 0
    ds_read_b128 a[12:15], v7 offset:2048
    v_mfma_f32_16x16x32_bf16 v[240:243], a[116:119], a[20:23], v[240:243]
    ds_read_b64_tr_b16 a[100:101], v12 offset:16384
    v_mfma_f32_16x16x32_bf16 v[244:247], a[124:127], a[20:23], 0
    v_mfma_f32_16x16x32_bf16 v[244:247], a[120:123], a[16:19], v[244:247]
    ds_read_b128 a[16:19], v6 offset:4096
    v_mfma_f32_16x16x32_bf16 v[252:255], a[120:123], a[24:27], 0
    buffer_load_dwordx4 v17, s[40:43], s50 offen offset:1024 sc1 lds
    v_mfma_f32_16x16x32_bf16 v[252:255], a[124:127], a[28:31], v[252:255]
    s_add_u32 s50, s50, 128
    ds_read_b128 a[20:23], v7 offset:4096
    v_mfma_f32_16x16x32_bf16 v[248:251], a[116:119], a[28:31], 0
    ds_read_b64_tr_b16 a[102:103], v12 offset:18432
    v_mfma_f32_16x16x32_bf16 v[248:251], a[112:115], a[24:27], v[248:251]
    ds_read_b128 a[24:27], v6 offset:6144
    v_mfma_f32_16x16x32_bf16 a[224:227], a[112:115], a[32:35], 0
    s_sub_u32 s65, s65, 1
    ds_read_b128 a[28:31], v7 offset:6144
    v_mfma_f32_16x16x32_bf16 a[224:227], a[116:119], a[36:39], a[224:227]
    ds_read_b64_tr_b16 a[104:105], v13 offset:0
    v_mfma_f32_16x16x32_bf16 a[228:231], a[124:127], a[36:39], 0
    v_mfma_f32_16x16x32_bf16 a[228:231], a[120:123], a[32:35], a[228:231]
    ds_read_b128 a[32:35], v6 offset:8192
    v_mfma_f32_16x16x32_bf16 a[236:239], a[120:123], a[40:43], 0
    buffer_load_dwordx4 v16, s[40:43], s51 offen offset:2048 sc1 lds
    v_mfma_f32_16x16x32_bf16 a[236:239], a[124:127], a[44:47], a[236:239]
    ds_read_b128 a[36:39], v7 offset:8192
    v_mfma_f32_16x16x32_bf16 a[232:235], a[116:119], a[44:47], 0
    ds_read_b64_tr_b16 a[106:107], v13 offset:2048
    v_mfma_f32_16x16x32_bf16 a[232:235], a[112:115], a[40:43], a[232:235]
    ds_read_b128 a[40:43], v6 offset:10240
    v_mfma_f32_16x16x32_bf16 a[240:243], a[112:115], a[48:51], 0
    ds_read_b128 a[44:47], v7 offset:10240
    v_mfma_f32_16x16x32_bf16 a[240:243], a[116:119], a[52:55], a[240:243]
    ds_read_b64_tr_b16 a[108:109], v13 offset:16384
    v_mfma_f32_16x16x32_bf16 a[244:247], a[124:127], a[52:55], 0
    v_mfma_f32_16x16x32_bf16 a[244:247], a[120:123], a[48:51], a[244:247]
    ds_read_b128 a[48:51], v6 offset:12288
    v_mfma_f32_16x16x32_bf16 a[252:255], a[120:123], a[56:59], 0
    buffer_load_dwordx4 v17, s[40:43], s51 offen offset:3072 sc1 lds
    v_mfma_f32_16x16x32_bf16 a[252:255], a[124:127], a[60:63], a[252:255]
    s_add_u32 s51, s51, 128
    ds_read_b128 a[52:55], v7 offset:12288
    v_mfma_f32_16x16x32_bf16 a[248:251], a[116:119], a[60:63], 0
    ds_read_b64_tr_b16 a[110:111], v13 offset:18432
    v_mfma_f32_16x16x32_bf16 a[248:251], a[112:115], a[56:59], a[248:251]
    ds_read_b128 a[56:59], v6 offset:14336
    ds_read_b128 a[60:63], v7 offset:14336
    s_waitcnt lgkmcnt(15)
    v_mfma_f32_16x16x32_bf16 v[32:35], a[64:67], a[0:3], v[32:35]
    ds_read_b64_tr_b16 a[112:113], v14 offset:0
    v_mfma_f32_16x16x32_bf16 v[32:35], a[68:71], a[4:7], v[32:35]
    ds_read_b64_tr_b16 a[114:115], v14 offset:2048
    v_mfma_f32_16x16x32_bf16 v[36:39], a[76:79], a[4:7], v[36:39]
    ds_read_b64_tr_b16 a[116:117], v14 offset:16384
    v_mfma_f32_16x16x32_bf16 v[36:39], a[72:75], a[0:3], v[36:39]
    ds_read_b64_tr_b16 a[118:119], v14 offset:18432
    v_mfma_f32_16x16x32_bf16 v[44:47], a[72:75], a[8:11], v[44:47]
    ds_read_b64_tr_b16 a[120:121], v15 offset:0
    v_mfma_f32_16x16x32_bf16 v[44:47], a[76:79], a[12:15], v[44:47]
    ds_read_b64_tr_b16 a[122:123], v15 offset:2048
    v_mfma_f32_16x16x32_bf16 v[40:43], a[68:71], a[12:15], v[40:43]
    ds_read_b64_tr_b16 a[124:125], v15 offset:16384
    v_mfma_f32_16x16x32_bf16 v[40:43], a[64:67], a[8:11], v[40:43]
    ds_read_b64_tr_b16 a[126:127], v15 offset:18432
    v_mfma_f32_16x16x32_bf16 v[48:51], a[64:67], a[16:19], v[48:51]
    v_mfma_f32_16x16x32_bf16 v[48:51], a[68:71], a[20:23], v[48:51]
    v_mfma_f32_16x16x32_bf16 v[52:55], a[76:79], a[20:23], v[52:55]
    buffer_store_dwordx4 a[160:163], v2, s[24:27], s28 offen sc1
    v_mfma_f32_16x16x32_bf16 v[52:55], a[72:75], a[16:19], v[52:55]
    s_add_u32 s28, s28, s31
    s_waitcnt lgkmcnt(15)
    v_mfma_f32_16x16x32_bf16 v[60:63], a[72:75], a[24:27], v[60:63]
    v_xor_b32 v8, s60, v8
    v_xor_b32 v9, s60, v9
    v_mfma_f32_16x16x32_bf16 v[60:63], a[76:79], a[28:31], v[60:63]
    v_xor_b32 v10, s60, v10
    v_xor_b32 v11, s60, v11
    v_mfma_f32_16x16x32_bf16 v[56:59], a[68:71], a[28:31], v[56:59]
    v_xor_b32 v12, s60, v12
    v_xor_b32 v13, s60, v13
    v_mfma_f32_16x16x32_bf16 v[56:59], a[64:67], a[24:27], v[56:59]
    v_xor_b32 v14, s60, v14
    v_xor_b32 v15, s60, v15
    v_mfma_f32_16x16x32_bf16 v[64:67], a[64:67], a[32:35], v[64:67]
    buffer_store_dwordx4 a[164:167], v2, s[24:27], s28 offen sc1
    v_mfma_f32_16x16x32_bf16 v[64:67], a[68:71], a[36:39], v[64:67]
    s_add_u32 s28, s28, s31
    v_mfma_f32_16x16x32_bf16 v[68:71], a[76:79], a[36:39], v[68:71]
    v_mfma_f32_16x16x32_bf16 v[68:71], a[72:75], a[32:35], v[68:71]
    s_waitcnt lgkmcnt(14)
    v_mfma_f32_16x16x32_bf16 v[76:79], a[72:75], a[40:43], v[76:79]
    v_mfma_f32_16x16x32_bf16 v[76:79], a[76:79], a[44:47], v[76:79]
    v_mfma_f32_16x16x32_bf16 v[72:75], a[68:71], a[44:47], v[72:75]
    buffer_store_dwordx4 a[168:171], v2, s[24:27], s28 offen sc1
    v_mfma_f32_16x16x32_bf16 v[72:75], a[64:67], a[40:43], v[72:75]
    s_add_u32 s28, s28, s31
    s_waitcnt lgkmcnt(11)
    v_mfma_f32_16x16x32_bf16 v[80:83], a[64:67], a[48:51], v[80:83]
    v_mfma_f32_16x16x32_bf16 v[80:83], a[68:71], a[52:55], v[80:83]
    v_mfma_f32_16x16x32_bf16 v[84:87], a[76:79], a[52:55], v[84:87]
    v_mfma_f32_16x16x32_bf16 v[84:87], a[72:75], a[48:51], v[84:87]
    s_waitcnt lgkmcnt(8)
    v_mfma_f32_16x16x32_bf16 v[92:95], a[72:75], a[56:59], v[92:95]
    buffer_store_dwordx4 a[172:175], v2, s[24:27], s28 offen sc1
    v_mfma_f32_16x16x32_bf16 v[92:95], a[76:79], a[60:63], v[92:95]
    s_add_u32 s28, s28, s31
    v_mfma_f32_16x16x32_bf16 v[88:91], a[68:71], a[60:63], v[88:91]
    s_waitcnt vmcnt(16) lgkmcnt(0)
    v_mfma_f32_16x16x32_bf16 v[88:91], a[64:67], a[56:59], v[88:91]
    s_barrier
    v_mfma_f32_16x16x32_bf16 v[96:99], a[80:83], a[0:3], v[96:99]
    ds_read_b64_tr_b16 a[64:65], v8 offset:0
    v_mfma_f32_16x16x32_bf16 v[96:99], a[84:87], a[4:7], v[96:99]
    s_add_u32 m0, s62, 0
    v_mfma_f32_16x16x32_bf16 v[100:103], a[92:95], a[4:7], v[100:103]
    buffer_load_dwordx4 v18, s[44:47], s52 offen offset:0 sc1 lds
    v_mfma_f32_16x16x32_bf16 v[100:103], a[88:91], a[0:3], v[100:103]
    ds_read_b64_tr_b16 a[66:67], v8 offset:2048
    v_mfma_f32_16x16x32_bf16 v[108:111], a[88:91], a[8:11], v[108:111]
    s_add_u32 s64, s64, 32768
    v_mfma_f32_16x16x32_bf16 v[108:111], a[92:95], a[12:15], v[108:111]
    s_cmp_ge_u32 s64, 98304
    s_cselect_b32 s63, 4294901760, s59
    s_cselect_b32 s64, 0, s64
    v_mfma_f32_16x16x32_bf16 v[104:107], a[84:87], a[12:15], v[104:107]
    buffer_load_dwordx4 v19, s[44:47], s52 offen offset:1024 sc1 lds
    v_mfma_f32_16x16x32_bf16 v[104:107], a[80:83], a[8:11], v[104:107]
    s_add_u32 s52, s52, s56
    ds_read_b64_tr_b16 a[68:69], v8 offset:16384
    v_mfma_f32_16x16x32_bf16 v[112:115], a[80:83], a[16:19], v[112:115]
    v_mfma_f32_16x16x32_bf16 v[112:115], a[84:87], a[20:23], v[112:115]
    v_mfma_f32_16x16x32_bf16 v[116:119], a[92:95], a[20:23], v[116:119]
    buffer_load_dwordx4 v18, s[44:47], s53 offen offset:2048 sc1 lds
    v_mfma_f32_16x16x32_bf16 v[116:119], a[88:91], a[16:19], v[116:119]
    ds_read_b64_tr_b16 a[70:71], v8 offset:18432
    v_mfma_f32_16x16x32_bf16 v[124:127], a[88:91], a[24:27], v[124:127]
    v_mfma_f32_16x16x32_bf16 v[124:127], a[92:95], a[28:31], v[124:127]
    v_mfma_f32_16x16x32_bf16 v[120:123], a[84:87], a[28:31], v[120:123]
    buffer_load_dwordx4 v19, s[44:47], s53 offen offset:3072 sc1 lds
    v_mfma_f32_16x16x32_bf16 v[120:123], a[80:83], a[24:27], v[120:123]
    s_add_u32 s53, s53, s56
    ds_read_b64_tr_b16 a[72:73], v9 offset:0
    v_mfma_f32_16x16x32_bf16 v[128:131], a[80:83], a[32:35], v[128:131]
    v_mfma_f32_16x16x32_bf16 v[128:131], a[84:87], a[36:39], v[128:131]
    s_add_u32 m0, s62, 4096
    v_mfma_f32_16x16x32_bf16 v[132:135], a[92:95], a[36:39], v[132:135]
    buffer_load_dwordx4 v20, s[44:47], s54 offen offset:0 sc1 lds
    v_mfma_f32_16x16x32_bf16 v[132:135], a[88:91], a[32:35], v[132:135]
    s_xor_b32 s62, s62, 229376
    ds_read_b64_tr_b16 a[74:75], v9 offset:2048
    v_mfma_f32_16x16x32_bf16 v[140:143], a[88:91], a[40:43], v[140:143]
    v_mfma_f32_16x16x32_bf16 v[140:143], a[92:95], a[44:47], v[140:143]
    v_mfma_f32_16x16x32_bf16 v[136:139], a[84:87], a[44:47], v[136:139]
    buffer_load_dwordx4 v21, s[44:47], s54 offen offset:1024 sc1 lds
    v_mfma_f32_16x16x32_bf16 v[136:139], a[80:83], a[40:43], v[136:139]
    s_add_u32 s54, s54, s56
    ds_read_b64_tr_b16 a[76:77], v9 offset:16384
    v_mfma_f32_16x16x32_bf16 v[144:147], a[80:83], a[48:51], v[144:147]
    v_mfma_f32_16x16x32_bf16 v[144:147], a[84:87], a[52:55], v[144:147]
    v_mfma_f32_16x16x32_bf16 v[148:151], a[92:95], a[52:55], v[148:151]
    buffer_load_dwordx4 v20, s[44:47], s55 offen offset:2048 sc1 lds
    v_mfma_f32_16x16x32_bf16 v[148:151], a[88:91], a[48:51], v[148:151]
    ds_read_b64_tr_b16 a[78:79], v9 offset:18432
    v_mfma_f32_16x16x32_bf16 v[156:159], a[88:91], a[56:59], v[156:159]
    v_add_u32 v6, s63, v6
    v_add_u32 v7, s63, v7
    v_mfma_f32_16x16x32_bf16 v[156:159], a[92:95], a[60:63], v[156:159]
    v_mfma_f32_16x16x32_bf16 v[152:155], a[84:87], a[60:63], v[152:155]
    buffer_load_dwordx4 v21, s[44:47], s55 offen offset:3072 sc1 lds
    v_mfma_f32_16x16x32_bf16 v[152:155], a[80:83], a[56:59], v[152:155]
    s_add_u32 s55, s55, s56
    v_mfma_f32_16x16x32_bf16 v[160:163], a[96:99], a[0:3], v[160:163]
    ds_read_b64_tr_b16 a[80:81], v10 offset:0
    v_mfma_f32_16x16x32_bf16 v[160:163], a[100:103], a[4:7], v[160:163]
    v_mfma_f32_16x16x32_bf16 v[164:167], a[108:111], a[4:7], v[164:167]
    v_mfma_f32_16x16x32_bf16 v[164:167], a[104:107], a[0:3], v[164:167]
    s_add_u32 m0, s61, 0
    ds_read_b64_tr_b16 a[82:83], v10 offset:2048
    v_mfma_f32_16x16x32_bf16 v[172:175], a[104:107], a[8:11], v[172:175]
    buffer_load_dwordx4 v16, s[40:43], s48 offen offset:0 sc1 lds
    v_mfma_f32_16x16x32_bf16 v[172:175], a[108:111], a[12:15], v[172:175]
    v_mfma_f32_16x16x32_bf16 v[168:171], a[100:103], a[12:15], v[168:171]
    ds_read_b64_tr_b16 a[84:85], v10 offset:16384
    v_mfma_f32_16x16x32_bf16 v[168:171], a[96:99], a[8:11], v[168:171]
    v_mfma_f32_16x16x32_bf16 v[176:179], a[96:99], a[16:19], v[176:179]
    buffer_store_dwordx4 a[176:179], v2, s[24:27], s28 offen sc1
    v_mfma_f32_16x16x32_bf16 v[176:179], a[100:103], a[20:23], v[176:179]
    s_add_u32 s28, s28, s31
    ds_read_b64_tr_b16 a[86:87], v10 offset:18432
    v_mfma_f32_16x16x32_bf16 v[180:183], a[108:111], a[20:23], v[180:183]
    v_mfma_f32_16x16x32_bf16 v[180:183], a[104:107], a[16:19], v[180:183]
    v_mfma_f32_16x16x32_bf16 v[188:191], a[104:107], a[24:27], v[188:191]
    buffer_load_dwordx4 v17, s[40:43], s48 offen offset:1024 sc1 lds
    v_mfma_f32_16x16x32_bf16 v[188:191], a[108:111], a[28:31], v[188:191]
    s_add_u32 s48, s48, 128
    ds_read_b64_tr_b16 a[88:89], v11 offset:0
    v_mfma_f32_16x16x32_bf16 v[184:187], a[100:103], a[28:31], v[184:187]
    v_mfma_f32_16x16x32_bf16 v[184:187], a[96:99], a[24:27], v[184:187]
    v_mfma_f32_16x16x32_bf16 v[192:195], a[96:99], a[32:35], v[192:195]
    buffer_store_dwordx4 a[180:183], v2, s[24:27], s28 offen sc1
    v_mfma_f32_16x16x32_bf16 v[192:195], a[100:103], a[36:39], v[192:195]
    s_add_u32 s28, s28, s31
    ds_read_b64_tr_b16 a[90:91], v11 offset:2048
    v_mfma_f32_16x16x32_bf16 v[196:199], a[108:111], a[36:39], v[196:199]
    v_mfma_f32_16x16x32_bf16 v[196:199], a[104:107], a[32:35], v[196:199]
    v_mfma_f32_16x16x32_bf16 v[204:207], a[104:107], a[40:43], v[204:207]
    buffer_load_dwordx4 v16, s[40:43], s49 offen offset:2048 sc1 lds
    v_mfma_f32_16x16x32_bf16 v[204:207], a[108:111], a[44:47], v[204:207]
    ds_read_b64_tr_b16 a[92:93], v11 offset:16384
    v_mfma_f32_16x16x32_bf16 v[200:203], a[100:103], a[44:47], v[200:203]
    v_mfma_f32_16x16x32_bf16 v[200:203], a[96:99], a[40:43], v[200:203]
    v_mfma_f32_16x16x32_bf16 v[208:211], a[96:99], a[48:51], v[208:211]
    buffer_store_dwordx4 a[184:187], v2, s[24:27], s28 offen sc1
    v_mfma_f32_16x16x32_bf16 v[208:211], a[100:103], a[52:55], v[208:211]
    s_add_u32 s28, s28, s31
    ds_read_b64_tr_b16 a[94:95], v11 offset:18432
    v_mfma_f32_16x16x32_bf16 v[212:215], a[108:111], a[52:55], v[212:215]
    v_mfma_f32_16x16x32_bf16 v[212:215], a[104:107], a[48:51], v[212:215]
    v_mfma_f32_16x16x32_bf16 v[220:223], a[104:107], a[56:59], v[220:223]
    buffer_load_dwordx4 v17, s[40:43], s49 offen offset:3072 sc1 lds
    v_mfma_f32_16x16x32_bf16 v[220:223], a[108:111], a[60:63], v[220:223]
    s_add_u32 s49, s49, 128
    v_mfma_f32_16x16x32_bf16 v[216:219], a[100:103], a[60:63], v[216:219]
    buffer_store_dwordx4 a[188:191], v2, s[24:27], s28 offen sc1
    v_mfma_f32_16x16x32_bf16 v[216:219], a[96:99], a[56:59], v[216:219]
    s_add_u32 s29, s29, s30
    s_mov_b32 s28, s29
    v_mfma_f32_16x16x32_bf16 v[224:227], a[112:115], a[0:3], v[224:227]
    v_mfma_f32_16x16x32_bf16 v[224:227], a[116:119], a[4:7], v[224:227]
    ds_read_b64_tr_b16 a[96:97], v12 offset:0
    v_mfma_f32_16x16x32_bf16 v[228:231], a[124:127], a[4:7], v[228:231]
    v_mfma_f32_16x16x32_bf16 v[228:231], a[120:123], a[0:3], v[228:231]
    s_add_u32 m0, s61, 4096
    ds_read_b128 a[0:3], v6 offset:0
    v_mfma_f32_16x16x32_bf16 v[236:239], a[120:123], a[8:11], v[236:239]
    buffer_load_dwordx4 v16, s[40:43], s50 offen offset:0 sc1 lds
    v_mfma_f32_16x16x32_bf16 v[236:239], a[124:127], a[12:15], v[236:239]
    s_add_u32 s61, s61, 32768
    ds_read_b128 a[4:7], v7 offset:0
    v_mfma_f32_16x16x32_bf16 v[232:235], a[116:119], a[12:15], v[232:235]
    s_cmp_ge_u32 s61, 98304
    s_cselect_b32 s90, 98304, 0
    ds_read_b64_tr_b16 a[98:99], v12 offset:2048
    v_mfma_f32_16x16x32_bf16 v[232:235], a[112:115], a[8:11], v[232:235]
    s_sub_u32 s61, s61, s90
    ds_read_b128 a[8:11], v6 offset:2048
    v_mfma_f32_16x16x32_bf16 v[240:243], a[112:115], a[16:19], v[240:243]
    ds_read_b128 a[12:15], v7 offset:2048
    v_mfma_f32_16x16x32_bf16 v[240:243], a[116:119], a[20:23], v[240:243]
    ds_read_b64_tr_b16 a[100:101], v12 offset:16384
    v_mfma_f32_16x16x32_bf16 v[244:247], a[124:127], a[20:23], v[244:247]
    v_mfma_f32_16x16x32_bf16 v[244:247], a[120:123], a[16:19], v[244:247]
    ds_read_b128 a[16:19], v6 offset:4096
    v_mfma_f32_16x16x32_bf16 v[252:255], a[120:123], a[24:27], v[252:255]
    buffer_load_dwordx4 v17, s[40:43], s50 offen offset:1024 sc1 lds
    v_mfma_f32_16x16x32_bf16 v[252:255], a[124:127], a[28:31], v[252:255]
    s_add_u32 s50, s50, 128
    ds_read_b128 a[20:23], v7 offset:4096
    v_mfma_f32_16x16x32_bf16 v[248:251], a[116:119], a[28:31], v[248:251]
    ds_read_b64_tr_b16 a[102:103], v12 offset:18432
    v_mfma_f32_16x16x32_bf16 v[248:251], a[112:115], a[24:27], v[248:251]
    ds_read_b128 a[24:27], v6 offset:6144
    v_mfma_f32_16x16x32_bf16 a[224:227], a[112:115], a[32:35], a[224:227]
    s_sub_u32 s65, s65, 1
    ds_read_b128 a[28:31], v7 offset:6144
    v_mfma_f32_16x16x32_bf16 a[224:227], a[116:119], a[36:39], a[224:227]
    ds_read_b64_tr_b16 a[104:105], v13 offset:0
    v_mfma_f32_16x16x32_bf16 a[228:231], a[124:127], a[36:39], a[228:231]
    v_mfma_f32_16x16x32_bf16 a[228:231], a[120:123], a[32:35], a[228:231]
    ds_read_b128 a[32:35], v6 offset:8192
    v_mfma_f32_16x16x32_bf16 a[236:239], a[120:123], a[40:43], a[236:239]
    buffer_load_dwordx4 v16, s[40:43], s51 offen offset:2048 sc1 lds
    v_mfma_f32_16x16x32_bf16 a[236:239], a[124:127], a[44:47], a[236:239]
    ds_read_b128 a[36:39], v7 offset:8192
    v_mfma_f32_16x16x32_bf16 a[232:235], a[116:119], a[44:47], a[232:235]
    ds_read_b64_tr_b16 a[106:107], v13 offset:2048
    v_mfma_f32_16x16x32_bf16 a[232:235], a[112:115], a[40:43], a[232:235]
    ds_read_b128 a[40:43], v6 offset:10240
    v_mfma_f32_16x16x32_bf16 a[240:243], a[112:115], a[48:51], a[240:243]
    ds_read_b128 a[44:47], v7 offset:10240
    v_mfma_f32_16x16x32_bf16 a[240:243], a[116:119], a[52:55], a[240:243]
    ds_read_b64_tr_b16 a[108:109], v13 offset:16384
    v_mfma_f32_16x16x32_bf16 a[244:247], a[124:127], a[52:55], a[244:247]
    v_mfma_f32_16x16x32_bf16 a[244:247], a[120:123], a[48:51], a[244:247]
    ds_read_b128 a[48:51], v6 offset:12288
    v_mfma_f32_16x16x32_bf16 a[252:255], a[120:123], a[56:59], a[252:255]
    buffer_load_dwordx4 v17, s[40:43], s51 offen offset:3072 sc1 lds
    v_mfma_f32_16x16x32_bf16 a[252:255], a[124:127], a[60:63], a[252:255]
    s_add_u32 s51, s51, 128
    ds_read_b128 a[52:55], v7 offset:12288
    v_mfma_f32_16x16x32_bf16 a[248:251], a[116:119], a[60:63], a[248:251]
    ds_read_b64_tr_b16 a[110:111], v13 offset:18432
    v_mfma_f32_16x16x32_bf16 a[248:251], a[112:115], a[56:59], a[248:251]
    ds_read_b128 a[56:59], v6 offset:14336
    ds_read_b128 a[60:63], v7 offset:14336
    s_cmp_eq_u32 s66, 2
    s_cbranch_scc1 m_hook18
m_hookr19:
    s_waitcnt lgkmcnt(15)
    v_mfma_f32_16x16x32_bf16 v[32:35], a[64:67], a[0:3], v[32:35]
    ds_read_b64_tr_b16 a[112:113], v14 offset:0
    v_mfma_f32_16x16x32_bf16 v[32:35], a[68:71], a[4:7], v[32:35]
    ds_read_b64_tr_b16 a[114:115], v14 offset:2048
    v_mfma_f32_16x16x32_bf16 v[36:39], a[76:79], a[4:7], v[36:39]
    ds_read_b64_tr_b16 a[116:117], v14 offset:16384
    v_mfma_f32_16x16x32_bf16 v[36:39], a[72:75], a[0:3], v[36:39]
    ds_read_b64_tr_b16 a[118:119], v14 offset:18432
    v_mfma_f32_16x16x32_bf16 v[44:47], a[72:75], a[8:11], v[44:47]
    ds_read_b64_tr_b16 a[120:121], v15 offset:0
    v_mfma_f32_16x16x32_bf16 v[44:47], a[76:79], a[12:15], v[44:47]
    ds_read_b64_tr_b16 a[122:123], v15 offset:2048
    v_mfma_f32_16x16x32_bf16 v[40:43], a[68:71], a[12:15], v[40:43]
    ds_read_b64_tr_b16 a[124:125], v15 offset:16384
    v_mfma_f32_16x16x32_bf16 v[40:43], a[64:67], a[8:11], v[40:43]
    ds_read_b64_tr_b16 a[126:127], v15 offset:18432
    v_mfma_f32_16x16x32_bf16 v[48:51], a[64:67], a[16:19], v[48:51]
    v_mfma_f32_16x16x32_bf16 v[48:51], a[68:71], a[20:23], v[48:51]
    v_mfma_f32_16x16x32_bf16 v[52:55], a[76:79], a[20:23], v[52:55]
    buffer_store_dwordx4 a[192:195], v2, s[24:27], s28 offen sc1
    v_mfma_f32_16x16x32_bf16 v[52:55], a[72:75], a[16:19], v[52:55]
    s_add_u32 s28, s28, s31
    s_waitcnt lgkmcnt(15)
    v_mfma_f32_16x16x32_bf16 v[60:63], a[72:75], a[24:27], v[60:63]
    v_xor_b32 v8, s60, v8
    v_xor_b32 v9, s60, v9
    v_mfma_f32_16x16x32_bf16 v[60:63], a[76:79], a[28:31], v[60:63]
    v_xor_b32 v10, s60, v10
    v_xor_b32 v11, s60, v11
    v_mfma_f32_16x16x32_bf16 v[56:59], a[68:71], a[28:31], v[56:59]
    v_xor_b32 v12, s60, v12
    v_xor_b32 v13, s60, v13
    v_mfma_f32_16x16x32_bf16 v[56:59], a[64:67], a[24:27], v[56:59]
    v_xor_b32 v14, s60, v14
    v_xor_b32 v15, s60, v15
    v_mfma_f32_16x16x32_bf16 v[64:67], a[64:67], a[32:35], v[64:67]
    buffer_store_dwordx4 a[196:199], v2, s[24:27], s28 offen sc1
    v_mfma_f32_16x16x32_bf16 v[64:67], a[68:71], a[36:39], v[64:67]
    s_add_u32 s28, s28, s31
    v_mfma_f32_16x16x32_bf16 v[68:71], a[76:79], a[36:39], v[68:71]
    v_mfma_f32_16x16x32_bf16 v[68:71], a[72:75], a[32:35], v[68:71]
    s_waitcnt lgkmcnt(14)
    v_mfma_f32_16x16x32_bf16 v[76:79], a[72:75], a[40:43], v[76:79]
    v_mfma_f32_16x16x32_bf16 v[76:79], a[76:79], a[44:47], v[76:79]
    v_mfma_f32_16x16x32_bf16 v[72:75], a[68:71], a[44:47], v[72:75]
    buffer_store_dwordx4 a[200:203], v2, s[24:27], s28 offen sc1
    v_mfma_f32_16x16x32_bf16 v[72:75], a[64:67], a[40:43], v[72:75]
    s_add_u32 s28, s28, s31
    s_waitcnt lgkmcnt(11)
    v_mfma_f32_16x16x32_bf16 v[80:83], a[64:67], a[48:51], v[80:83]
    v_mfma_f32_16x16x32_bf16 v[80:83], a[68:71], a[52:55], v[80:83]
    v_mfma_f32_16x16x32_bf16 v[84:87], a[76:79], a[52:55], v[84:87]
    v_mfma_f32_16x16x32_bf16 v[84:87], a[72:75], a[48:51], v[84:87]
    s_waitcnt lgkmcnt(8)
    v_mfma_f32_16x16x32_bf16 v[92:95], a[72:75], a[56:59], v[92:95]
    buffer_store_dwordx4 a[204:207], v2, s[24:27], s28 offen sc1
    v_mfma_f32_16x16x32_bf16 v[92:95], a[76:79], a[60:63], v[92:95]
    s_add_u32 s28, s28, s31
    v_mfma_f32_16x16x32_bf16 v[88:91], a[68:71], a[60:63], v[88:91]
    s_waitcnt vmcnt(16) lgkmcnt(0)
    v_mfma_f32_16x16x32_bf16 v[88:91], a[64:67], a[56:59], v[88:91]
    s_barrier
    v_mfma_f32_16x16x32_bf16 v[96:99], a[80:83], a[0:3], v[96:99]
    ds_read_b64_tr_b16 a[64:65], v8 offset:0
    v_mfma_f32_16x16x32_bf16 v[96:99], a[84:87], a[4:7], v[96:99]
    s_add_u32 m0, s62, 0
    v_mfma_f32_16x16x32_bf16 v[100:103], a[92:95], a[4:7], v[100:103]
    buffer_load_dwordx4 v18, s[44:47], s52 offen offset:0 sc1 lds
    v_mfma_f32_16x16x32_bf16 v[100:103], a[88:91], a[0:3], v[100:103]
    ds_read_b64_tr_b16 a[66:67], v8 offset:2048
    v_mfma_f32_16x16x32_bf16 v[108:111], a[88:91], a[8:11], v[108:111]
    s_add_u32 s64, s64, 32768
    v_mfma_f32_16x16x32_bf16 v[108:111], a[92:95], a[12:15], v[108:111]
    s_cmp_ge_u32 s64, 98304
    s_cselect_b32 s63, 4294901760, s59
    s_cselect_b32 s64, 0, s64
    v_mfma_f32_16x16x32_bf16 v[104:107], a[84:87], a[12:15], v[104:107]
    buffer_load_dwordx4 v19, s[44:47], s52 offen offset:1024 sc1 lds
    v_mfma_f32_16x16x32_bf16 v[104:107], a[80:83], a[8:11], v[104:107]
    s_add_u32 s52, s52, s56
    ds_read_b64_tr_b16 a[68:69], v8 offset:16384
    v_mfma_f32_16x16x32_bf16 v[112:115], a[80:83], a[16:19], v[112:115]
    v_mfma_f32_16x16x32_bf16 v[112:115], a[84:87], a[20:23], v[112:115]
    v_mfma_f32_16x16x32_bf16 v[116:119], a[92:95], a[20:23], v[116:119]
    buffer_load_dwordx4 v18, s[44:47], s53 offen offset:2048 sc1 lds
    v_mfma_f32_16x16x32_bf16 v[116:119], a[88:91], a[16:19], v[116:119]
    ds_read_b64_tr_b16 a[70:71], v8 offset:18432
    v_mfma_f32_16x16x32_bf16 v[124:127], a[88:91], a[24:27], v[124:127]
    v_mfma_f32_16x16x32_bf16 v[124:127], a[92:95], a[28:31], v[124:127]
    v_mfma_f32_16x16x32_bf16 v[120:123], a[84:87], a[28:31], v[120:123]
    buffer_load_dwordx4 v19, s[44:47], s53 offen offset:3072 sc1 lds
    v_mfma_f32_16x16x32_bf16 v[120:123], a[80:83], a[24:27], v[120:123]
    s_add_u32 s53, s53, s56
    ds_read_b64_tr_b16 a[72:73], v9 offset:0
    v_mfma_f32_16x16x32_bf16 v[128:131], a[80:83], a[32:35], v[128:131]
    v_mfma_f32_16x16x32_bf16 v[128:131], a[84:87], a[36:39], v[128:131]
    s_add_u32 m0, s62, 4096
    v_mfma_f32_16x16x32_bf16 v[132:135], a[92:95], a[36:39], v[132:135]
    buffer_load_dwordx4 v20, s[44:47], s54 offen offset:0 sc1 lds
    v_mfma_f32_16x16x32_bf16 v[132:135], a[88:91], a[32:35], v[132:135]
    s_xor_b32 s62, s62, 229376
    ds_read_b64_tr_b16 a[74:75], v9 offset:2048
    v_mfma_f32_16x16x32_bf16 v[140:143], a[88:91], a[40:43], v[140:143]
    v_mfma_f32_16x16x32_bf16 v[140:143], a[92:95], a[44:47], v[140:143]
    v_mfma_f32_16x16x32_bf16 v[136:139], a[84:87], a[44:47], v[136:139]
    buffer_load_dwordx4 v21, s[44:47], s54 offen offset:1024 sc1 lds
    v_mfma_f32_16x16x32_bf16 v[136:139], a[80:83], a[40:43], v[136:139]
    s_add_u32 s54, s54, s56
    ds_read_b64_tr_b16 a[76:77], v9 offset:16384
    v_mfma_f32_16x16x32_bf16 v[144:147], a[80:83], a[48:51], v[144:147]
    v_mfma_f32_16x16x32_bf16 v[144:147], a[84:87], a[52:55], v[144:147]
    v_mfma_f32_16x16x32_bf16 v[148:151], a[92:95], a[52:55], v[148:151]
    buffer_load_dwordx4 v20, s[44:47], s55 offen offset:2048 sc1 lds
    v_mfma_f32_16x16x32_bf16 v[148:151], a[88:91], a[48:51], v[148:151]
    ds_read_b64_tr_b16 a[78:79], v9 offset:18432
    v_mfma_f32_16x16x32_bf16 v[156:159], a[88:91], a[56:59], v[156:159]
    v_add_u32 v6, s63, v6
    v_add_u32 v7, s63, v7
    v_mfma_f32_16x16x32_bf16 v[156:159], a[92:95], a[60:63], v[156:159]
    v_mfma_f32_16x16x32_bf16 v[152:155], a[84:87], a[60:63], v[152:155]
    buffer_load_dwordx4 v21, s[44:47], s55 offen offset:3072 sc1 lds
    v_mfma_f32_16x16x32_bf16 v[152:155], a[80:83], a[56:59], v[152:155]
    s_add_u32 s55, s55, s56
    v_mfma_f32_16x16x32_bf16 v[160:163], a[96:99], a[0:3], v[160:163]
    ds_read_b64_tr_b16 a[80:81], v10 offset:0
    v_mfma_f32_16x16x32_bf16 v[160:163], a[100:103], a[4:7], v[160:163]
    v_mfma_f32_16x16x32_bf16 v[164:167], a[108:111], a[4:7], v[164:167]
    v_mfma_f32_16x16x32_bf16 v[164:167], a[104:107], a[0:3], v[164:167]
    s_add_u32 m0, s61, 0
    ds_read_b64_tr_b16 a[82:83], v10 offset:2048
    v_mfma_f32_16x16x32_bf16 v[172:175], a[104:107], a[8:11], v[172:175]
    buffer_load_dwordx4 v16, s[40:43], s48 offen offset:0 sc1 lds
    v_mfma_f32_16x16x32_bf16 v[172:175], a[108:111], a[12:15], v[172:175]
    v_mfma_f32_16x16x32_bf16 v[168:171], a[100:103], a[12:15], v[168:171]
    ds_read_b64_tr_b16 a[84:85], v10 offset:16384
    v_mfma_f32_16x16x32_bf16 v[168:171], a[96:99], a[8:11], v[168:171]
    v_mfma_f32_16x16x32_bf16 v[176:179], a[96:99], a[16:19], v[176:179]
    buffer_store_dwordx4 a[208:211], v2, s[24:27], s28 offen sc1
    v_mfma_f32_16x16x32_bf16 v[176:179], a[100:103], a[20:23], v[176:179]
    s_add_u32 s28, s28, s31
    ds_read_b64_tr_b16 a[86:87], v10 offset:18432
    v_mfma_f32_16x16x32_bf16 v[180:183], a[108:111], a[20:23], v[180:183]
    v_mfma_f32_16x16x32_bf16 v[180:183], a[104:107], a[16:19], v[180:183]
    v_mfma_f32_16x16x32_bf16 v[188:191], a[104:107], a[24:27], v[188:191]
    buffer_load_dwordx4 v17, s[40:43], s48 offen offset:1024 sc1 lds
    v_mfma_f32_16x16x32_bf16 v[188:191], a[108:111], a[28:31], v[188:191]
    s_add_u32 s48, s48, 128
    ds_read_b64_tr_b16 a[88:89], v11 offset:0
    v_mfma_f32_16x16x32_bf16 v[184:187], a[100:103], a[28:31], v[184:187]
    v_mfma_f32_16x16x32_bf16 v[184:187], a[96:99], a[24:27], v[184:187]
    v_mfma_f32_16x16x32_bf16 v[192:195], a[96:99], a[32:35], v[192:195]
    buffer_store_dwordx4 a[212:215], v2, s[24:27], s28 offen sc1
    v_mfma_f32_16x16x32_bf16 v[192:195], a[100:103], a[36:39], v[192:195]
    s_add_u32 s28, s28, s31
    ds_read_b64_tr_b16 a[90:91], v11 offset:2048
    v_mfma_f32_16x16x32_bf16 v[196:199], a[108:111], a[36:39], v[196:199]
    v_mfma_f32_16x16x32_bf16 v[196:199], a[104:107], a[32:35], v[196:199]
    v_mfma_f32_16x16x32_bf16 v[204:207], a[104:107], a[40:43], v[204:207]
    buffer_load_dwordx4 v16, s[40:43], s49 offen offset:2048 sc1 lds
    v_mfma_f32_16x16x32_bf16 v[204:207], a[108:111], a[44:47], v[204:207]
    ds_read_b64_tr_b16 a[92:93], v11 offset:16384
    v_mfma_f32_16x16x32_bf16 v[200:203], a[100:103], a[44:47], v[200:203]
    v_mfma_f32_16x16x32_bf16 v[200:203], a[96:99], a[40:43], v[200:203]
    v_mfma_f32_16x16x32_bf16 v[208:211], a[96:99], a[48:51], v[208:211]
    buffer_store_dwordx4 a[216:219], v2, s[24:27], s28 offen sc1
    v_mfma_f32_16x16x32_bf16 v[208:211], a[100:103], a[52:55], v[208:211]
    s_add_u32 s28, s28, s31
    ds_read_b64_tr_b16 a[94:95], v11 offset:18432
    v_mfma_f32_16x16x32_bf16 v[212:215], a[108:111], a[52:55], v[212:215]
    v_mfma_f32_16x16x32_bf16 v[212:215], a[104:107], a[48:51], v[212:215]
    v_mfma_f32_16x16x32_bf16 v[220:223], a[104:107], a[56:59], v[220:223]
    buffer_load_dwordx4 v17, s[40:43], s49 offen offset:3072 sc1 lds
    v_mfma_f32_16x16x32_bf16 v[220:223], a[108:111], a[60:63], v[220:223]
    s_add_u32 s49, s49, 128
    v_mfma_f32_16x16x32_bf16 v[216:219], a[100:103], a[60:63], v[216:219]
    buffer_store_dwordx4 a[220:223], v2, s[24:27], s28 offen sc1
    v_mfma_f32_16x16x32_bf16 v[216:219], a[96:99], a[56:59], v[216:219]
    s_add_u32 s29, s29, s30
    s_mov_b32 s28, s29
    v_mfma_f32_16x16x32_bf16 v[224:227], a[112:115], a[0:3], v[224:227]
    v_mfma_f32_16x16x32_bf16 v[224:227], a[116:119], a[4:7], v[224:227]
    ds_read_b64_tr_b16 a[96:97], v12 offset:0
    v_mfma_f32_16x16x32_bf16 v[228:231], a[124:127], a[4:7], v[228:231]
    v_mfma_f32_16x16x32_bf16 v[228:231], a[120:123], a[0:3], v[228:231]
    s_add_u32 m0, s61, 4096
    ds_read_b128 a[0:3], v6 offset:0
    v_mfma_f32_16x16x32_bf16 v[236:239], a[120:123], a[8:11], v[236:239]
    buffer_load_dwordx4 v16, s[40:43], s50 offen offset:0 sc1 lds
    v_mfma_f32_16x16x32_bf16 v[236:239], a[124:127], a[12:15], v[236:239]
    s_add_u32 s61, s61, 32768
    ds_read_b128 a[4:7], v7 offset:0
    v_mfma_f32_16x16x32_bf16 v[232:235], a[116:119], a[12:15], v[232:235]
    s_cmp_ge_u32 s61, 98304
    s_cselect_b32 s90, 98304, 0
    ds_read_b64_tr_b16 a[98:99], v12 offset:2048
    v_mfma_f32_16x16x32_bf16 v[232:235], a[112:115], a[8:11], v[232:235]
    s_sub_u32 s61, s61, s90
    ds_read_b128 a[8:11], v6 offset:2048
    v_mfma_f32_16x16x32_bf16 v[240:243], a[112:115], a[16:19], v[240:243]
    ds_read_b128 a[12:15], v7 offset:2048
    v_mfma_f32_16x16x32_bf16 v[240:243], a[116:119], a[20:23], v[240:243]
    ds_read_b64_tr_b16 a[100:101], v12 offset:16384
    v_mfma_f32_16x16x32_bf16 v[244:247], a[124:127], a[20:23], v[244:247]
    v_mfma_f32_16x16x32_bf16 v[244:247], a[120:123], a[16:19], v[244:247]
    ds_read_b128 a[16:19], v6 offset:4096
    v_mfma_f32_16x16x32_bf16 v[252:255], a[120:123], a[24:27], v[252:255]
    buffer_load_dwordx4 v17, s[40:43], s50 offen offset:1024 sc1 lds
    v_mfma_f32_16x16x32_bf16 v[252:255], a[124:127], a[28:31], v[252:255]
    s_add_u32 s50, s50, 128
    ds_read_b128 a[20:23], v7 offset:4096
    v_mfma_f32_16x16x32_bf16 v[248:251], a[116:119], a[28:31], v[248:251]
    ds_read_b64_tr_b16 a[102:103], v12 offset:18432
    v_mfma_f32_16x16x32_bf16 v[248:251], a[112:115], a[24:27], v[248:251]
    ds_read_b128 a[24:27], v6 offset:6144
    v_mfma_f32_16x16x32_bf16 a[224:227], a[112:115], a[32:35], a[224:227]
    s_sub_u32 s65, s65, 1
    ds_read_b128 a[28:31], v7 offset:6144
    v_mfma_f32_16x16x32_bf16 a[224:227], a[116:119], a[36:39], a[224:227]
    ds_read_b64_tr_b16 a[104:105], v13 offset:0
    v_mfma_f32_16x16x32_bf16 a[228:231], a[124:127], a[36:39], a[228:231]
    v_mfma_f32_16x16x32_bf16 a[228:231], a[120:123], a[32:35], a[228:231]
    ds_read_b128 a[32:35], v6 offset:8192
    v_mfma_f32_16x16x32_bf16 a[236:239], a[120:123], a[40:43], a[236:239]
    buffer_load_dwordx4 v16, s[40:43], s51 offen offset:2048 sc1 lds
    v_mfma_f32_16x16x32_bf16 a[236:239], a[124:127], a[44:47], a[236:239]
    ds_read_b128 a[36:39], v7 offset:8192
    v_mfma_f32_16x16x32_bf16 a[232:235], a[116:119], a[44:47], a[232:235]
    ds_read_b64_tr_b16 a[106:107], v13 offset:2048
    v_mfma_f32_16x16x32_bf16 a[232:235], a[112:115], a[40:43], a[232:235]
    ds_read_b128 a[40:43], v6 offset:10240
    v_mfma_f32_16x16x32_bf16 a[240:243], a[112:115], a[48:51], a[240:243]
    ds_read_b128 a[44:47], v7 offset:10240
    v_mfma_f32_16x16x32_bf16 a[240:243], a[116:119], a[52:55], a[240:243]
    ds_read_b64_tr_b16 a[108:109], v13 offset:16384
    v_mfma_f32_16x16x32_bf16 a[244:247], a[124:127], a[52:55], a[244:247]
    v_mfma_f32_16x16x32_bf16 a[244:247], a[120:123], a[48:51], a[244:247]
    ds_read_b128 a[48:51], v6 offset:12288
    v_mfma_f32_16x16x32_bf16 a[252:255], a[120:123], a[56:59], a[252:255]
    buffer_load_dwordx4 v17, s[40:43], s51 offen offset:3072 sc1 lds
    v_mfma_f32_16x16x32_bf16 a[252:255], a[124:127], a[60:63], a[252:255]
    s_add_u32 s51, s51, 128
    ds_read_b128 a[52:55], v7 offset:12288
    v_mfma_f32_16x16x32_bf16 a[248:251], a[116:119], a[60:63], a[248:251]
    ds_read_b64_tr_b16 a[110:111], v13 offset:18432
    v_mfma_f32_16x16x32_bf16 a[248:251], a[112:115], a[56:59], a[248:251]
    ds_read_b128 a[56:59], v6 offset:14336
    ds_read_b128 a[60:63], v7 offset:14336
.p2align 3
m_loop20:
    s_waitcnt lgkmcnt(15)
    v_mfma_f32_16x16x32_bf16 v[32:35], a[64:67], a[0:3], v[32:35]
    ds_read_b64_tr_b16 a[112:113], v14 offset:0
    v_mfma_f32_16x16x32_bf16 v[32:35], a[68:71], a[4:7], v[32:35]
    ds_read_b64_tr_b16 a[114:115], v14 offset:2048
    v_mfma_f32_16x16x32_bf16 v[36:39], a[76:79], a[4:7], v[36:39]
    ds_read_b64_tr_b16 a[116:117], v14 offset:16384
    v_mfma_f32_16x16x32_bf16 v[36:39], a[72:75], a[0:3], v[36:39]
    ds_read_b64_tr_b16 a[118:119], v14 offset:18432
    v_mfma_f32_16x16x32_bf16 v[44:47], a[72:75], a[8:11], v[44:47]
    ds_read_b64_tr_b16 a[120:121], v15 offset:0
    v_mfma_f32_16x16x32_bf16 v[44:47], a[76:79], a[12:15], v[44:47]
    ds_read_b64_tr_b16 a[122:123], v15 offset:2048
    v_mfma_f32_16x16x32_bf16 v[40:43], a[68:71], a[12:15], v[40:43]
    ds_read_b64_tr_b16 a[124:125], v15 offset:16384
    v_mfma_f32_16x16x32_bf16 v[40:43], a[64:67], a[8:11], v[40:43]
    ds_read_b64_tr_b16 a[126:127], v15 offset:18432
    v_mfma_f32_16x16x32_bf16 v[48:51], a[64:67], a[16:19], v[48:51]
    v_mfma_f32_16x16x32_bf16 v[48:51], a[68:71], a[20:23], v[48:51]
    v_mfma_f32_16x16x32_bf16 v[52:55], a[76:79], a[20:23], v[52:55]
    v_mfma_f32_16x16x32_bf16 v[52:55], a[72:75], a[16:19], v[52:55]
    s_waitcnt lgkmcnt(15)
    v_mfma_f32_16x16x32_bf16 v[60:63], a[72:75], a[24:27], v[60:63]
    v_xor_b32 v8, s60, v8
    v_xor_b32 v9, s60, v9
    v_mfma_f32_16x16x32_bf16 v[60:63], a[76:79], a[28:31], v[60:63]
    v_xor_b32 v10, s60, v10
    v_xor_b32 v11, s60, v11
    v_mfma_f32_16x16x32_bf16 v[56:59], a[68:71], a[28:31], v[56:59]
    v_xor_b32 v12, s60, v12
    v_xor_b32 v13, s60, v13
    v_mfma_f32_16x16x32_bf16 v[56:59], a[64:67], a[24:27], v[56:59]
    v_xor_b32 v14, s60, v14
    v_xor_b32 v15, s60, v15
    v_mfma_f32_16x16x32_bf16 v[64:67], a[64:67], a[32:35], v[64:67]
    v_mfma_f32_16x16x32_bf16 v[64:67], a[68:71], a[36:39], v[64:67]
    v_mfma_f32_16x16x32_bf16 v[68:71], a[76:79], a[36:39], v[68:71]
    v_mfma_f32_16x16x32_bf16 v[68:71], a[72:75], a[32:35], v[68:71]
    s_waitcnt lgkmcnt(14)
    v_mfma_f32_16x16x32_bf16 v[76:79], a[72:75], a[40:43], v[76:79]
    v_mfma_f32_16x16x32_bf16 v[76:79], a[76:79], a[44:47], v[76:79]
    v_mfma_f32_16x16x32_bf16 v[72:75], a[68:71], a[44:47], v[72:75]
    v_mfma_f32_16x16x32_bf16 v[72:75], a[64:67], a[40:43], v[72:75]
    s_waitcnt lgkmcnt(11)
    v_mfma_f32_16x16x32_bf16 v[80:83], a[64:67], a[48:51], v[80:83]
    v_mfma_f32_16x16x32_bf16 v[80:83], a[68:71], a[52:55], v[80:83]
    v_mfma_f32_16x16x32_bf16 v[84:87], a[76:79], a[52:55], v[84:87]
    v_mfma_f32_16x16x32_bf16 v[84:87], a[72:75], a[48:51], v[84:87]
    s_waitcnt lgkmcnt(8)
    v_mfma_f32_16x16x32_bf16 v[92:95], a[72:75], a[56:59], v[92:95]
    v_mfma_f32_16x16x32_bf16 v[92:95], a[76:79], a[60:63], v[92:95]
    v_mfma_f32_16x16x32_bf16 v[88:91], a[68:71], a[60:63], v[88:91]
    s_waitcnt vmcnt(8) lgkmcnt(0)
    v_mfma_f32_16x16x32_bf16 v[88:91], a[64:67], a[56:59], v[88:91]
    s_barrier
    v_mfma_f32_16x16x32_bf16 v[96:99], a[80:83], a[0:3], v[96:99]
    ds_read_b64_tr_b16 a[64:65], v8 offset:0
    v_mfma_f32_16x16x32_bf16 v[96:99], a[84:87], a[4:7], v[96:99]
    s_add_u32 m0, s62, 0
    v_mfma_f32_16x16x32_bf16 v[100:103], a[92:95], a[4:7], v[100:103]
    buffer_load_dwordx4 v18, s[44:47], s52 offen offset:0 sc1 lds
    v_mfma_f32_16x16x32_bf16 v[100:103], a[88:91], a[0:3], v[100:103]
    ds_read_b64_tr_b16 a[66:67], v8 offset:2048
    v_mfma_f32_16x16x32_bf16 v[108:111], a[88:91], a[8:11], v[108:111]
    s_add_u32 s64, s64, 32768
    v_mfma_f32_16x16x32_bf16 v[108:111], a[92:95], a[12:15], v[108:111]
    s_cmp_ge_u32 s64, 98304
    s_cselect_b32 s63, 4294901760, s59
    s_cselect_b32 s64, 0, s64
    v_mfma_f32_16x16x32_bf16 v[104:107], a[84:87], a[12:15], v[104:107]
    buffer_load_dwordx4 v19, s[44:47], s52 offen offset:1024 sc1 lds
    v_mfma_f32_16x16x32_bf16 v[104:107], a[80:83], a[8:11], v[104:107]
    s_add_u32 s52, s52, s56
    ds_read_b64_tr_b16 a[68:69], v8 offset:16384
    v_mfma_f32_16x16x32_bf16 v[112:115], a[80:83], a[16:19], v[112:115]
    v_mfma_f32_16x16x32_bf16 v[112:115], a[84:87], a[20:23], v[112:115]
    v_mfma_f32_16x16x32_bf16 v[116:119], a[92:95], a[20:23], v[116:119]
    buffer_load_dwordx4 v18, s[44:47], s53 offen offset:2048 sc1 lds
    v_mfma_f32_16x16x32_bf16 v[116:119], a[88:91], a[16:19], v[116:119]
    ds_read_b64_tr_b16 a[70:71], v8 offset:18432
    v_mfma_f32_16x16x32_bf16 v[124:127], a[88:91], a[24:27], v[124:127]
    v_mfma_f32_16x16x32_bf16 v[124:127], a[92:95], a[28:31], v[124:127]
    v_mfma_f32_16x16x32_bf16 v[120:123], a[84:87], a[28:31], v[120:123]
    buffer_load_dwordx4 v19, s[44:47], s53 offen offset:3072 sc1 lds
    v_mfma_f32_16x16x32_bf16 v[120:123], a[80:83], a[24:27], v[120:123]
    s_add_u32 s53, s53, s56
    ds_read_b64_tr_b16 a[72:73], v9 offset:0
    v_mfma_f32_16x16x32_bf16 v[128:131], a[80:83], a[32:35], v[128:131]
    v_mfma_f32_16x16x32_bf16 v[128:131], a[84:87], a[36:39], v[128:131]
    s_add_u32 m0, s62, 4096
    v_mfma_f32_16x16x32_bf16 v[132:135], a[92:95], a[36:39], v[132:135]
    buffer_load_dwordx4 v20, s[44:47], s54 offen offset:0 sc1 lds
    v_mfma_f32_16x16x32_bf16 v[132:135], a[88:91], a[32:35], v[132:135]
    s_xor_b32 s62, s62, 229376
    ds_read_b64_tr_b16 a[74:75], v9 offset:2048
    v_mfma_f32_16x16x32_bf16 v[140:143], a[88:91], a[40:43], v[140:143]
    v_mfma_f32_16x16x32_bf16 v[140:143], a[92:95], a[44:47], v[140:143]
    v_mfma_f32_16x16x32_bf16 v[136:139], a[84:87], a[44:47], v[136:139]
    buffer_load_dwordx4 v21, s[44:47], s54 offen offset:1024 sc1 lds
    v_mfma_f32_16x16x32_bf16 v[136:139], a[80:83], a[40:43], v[136:139]
    s_add_u32 s54, s54, s56
    ds_read_b64_tr_b16 a[76:77], v9 offset:16384
    v_mfma_f32_16x16x32_bf16 v[144:147], a[80:83], a[48:51], v[144:147]
    v_mfma_f32_16x16x32_bf16 v[144:147], a[84:87], a[52:55], v[144:147]
    v_mfma_f32_16x16x32_bf16 v[148:151], a[92:95], a[52:55], v[148:151]
    buffer_load_dwordx4 v20, s[44:47], s55 offen offset:2048 sc1 lds
    v_mfma_f32_16x16x32_bf16 v[148:151], a[88:91], a[48:51], v[148:151]
    ds_read_b64_tr_b16 a[78:79], v9 offset:18432
    v_mfma_f32_16x16x32_bf16 v[156:159], a[88:91], a[56:59], v[156:159]
    v_add_u32 v6, s63, v6
    v_add_u32 v7, s63, v7
    v_mfma_f32_16x16x32_bf16 v[156:159], a[92:95], a[60:63], v[156:159]
    v_mfma_f32_16x16x32_bf16 v[152:155], a[84:87], a[60:63], v[152:155]
    buffer_load_dwordx4 v21, s[44:47], s55 offen offset:3072 sc1 lds
    v_mfma_f32_16x16x32_bf16 v[152:155], a[80:83], a[56:59], v[152:155]
    s_add_u32 s55, s55, s56
    v_mfma_f32_16x16x32_bf16 v[160:163], a[96:99], a[0:3], v[160:163]
    ds_read_b64_tr_b16 a[80:81], v10 offset:0
    v_mfma_f32_16x16x32_bf16 v[160:163], a[100:103], a[4:7], v[160:163]
    v_mfma_f32_16x16x32_bf16 v[164:167], a[108:111], a[4:7], v[164:167]
    v_mfma_f32_16x16x32_bf16 v[164:167], a[104:107], a[0:3], v[164:167]
    s_add_u32 m0, s61, 0
    ds_read_b64_tr_b16 a[82:83], v10 offset:2048
    v_mfma_f32_16x16x32_bf16 v[172:175], a[104:107], a[8:11], v[172:175]
    buffer_load_dwordx4 v16, s[40:43], s48 offen offset:0 sc1 lds
    v_mfma_f32_16x16x32_bf16 v[172:175], a[108:111], a[12:15], v[172:175]
    v_mfma_f32_16x16x32_bf16 v[168:171], a[100:103], a[12:15], v[168:171]
    ds_read_b64_tr_b16 a[84:85], v10 offset:16384
    v_mfma_f32_16x16x32_bf16 v[168:171], a[96:99], a[8:11], v[168:171]
    v_mfma_f32_16x16x32_bf16 v[176:179], a[96:99], a[16:19], v[176:179]
    v_mfma_f32_16x16x32_bf16 v[176:179], a[100:103], a[20:23], v[176:179]
    ds_read_b64_tr_b16 a[86:87], v10 offset:18432
    v_mfma_f32_16x16x32_bf16 v[180:183], a[108:111], a[20:23], v[180:183]
    v_mfma_f32_16x16x32_bf16 v[180:183], a[104:107], a[16:19], v[180:183]
    v_mfma_f32_16x16x32_bf16 v[188:191], a[104:107], a[24:27], v[188:191]
    buffer_load_dwordx4 v17, s[40:43], s48 offen offset:1024 sc1 lds
    v_mfma_f32_16x16x32_bf16 v[188:191], a[108:111], a[28:31], v[188:191]
    s_add_u32 s48, s48, 128
    ds_read_b64_tr_b16 a[88:89], v11 offset:0
    v_mfma_f32_16x16x32_bf16 v[184:187], a[100:103], a[28:31], v[184:187]
    v_mfma_f32_16x16x32_bf16 v[184:187], a[96:99], a[24:27], v[184:187]
    v_mfma_f32_16x16x32_bf16 v[192:195], a[96:99], a[32:35], v[192:195]
    v_mfma_f32_16x16x32_bf16 v[192:195], a[100:103], a[36:39], v[192:195]
    ds_read_b64_tr_b16 a[90:91], v11 offset:2048
    v_mfma_f32_16x16x32_bf16 v[196:199], a[108:111], a[36:39], v[196:199]
    v_mfma_f32_16x16x32_bf16 v[196:199], a[104:107], a[32:35], v[196:199]
    v_mfma_f32_16x16x32_bf16 v[204:207], a[104:107], a[40:43], v[204:207]
    buffer_load_dwordx4 v16, s[40:43], s49 offen offset:2048 sc1 lds
    v_mfma_f32_16x16x32_bf16 v[204:207], a[108:111], a[44:47], v[204:207]
    ds_read_b64_tr_b16 a[92:93], v11 offset:16384
    v_mfma_f32_16x16x32_bf16 v[200:203], a[100:103], a[44:47], v[200:203]
    v_mfma_f32_16x16x32_bf16 v[200:203], a[96:99], a[40:43], v[200:203]
    v_mfma_f32_16x16x32_bf16 v[208:211], a[96:99], a[48:51], v[208:211]
    v_mfma_f32_16x16x32_bf16 v[208:211], a[100:103], a[52:55], v[208:211]
    ds_read_b64_tr_b16 a[94:95], v11 offset:18432
    v_mfma_f32_16x16x32_bf16 v[212:215], a[108:111], a[52:55], v[212:215]
    v_mfma_f32_16x16x32_bf16 v[212:215], a[104:107], a[48:51], v[212:215]
    v_mfma_f32_16x16x32_bf16 v[220:223], a[104:107], a[56:59], v[220:223]
    buffer_load_dwordx4 v17, s[40:43], s49 offen offset:3072 sc1 lds
    v_mfma_f32_16x16x32_bf16 v[220:223], a[108:111], a[60:63], v[220:223]
    s_add_u32 s49, s49, 128
    v_mfma_f32_16x16x32_bf16 v[216:219], a[100:103], a[60:63], v[216:219]
    v_mfma_f32_16x16x32_bf16 v[216:219], a[96:99], a[56:59], v[216:219]
    v_mfma_f32_16x16x32_bf16 v[224:227], a[112:115], a[0:3], v[224:227]
    v_mfma_f32_16x16x32_bf16 v[224:227], a[116:119], a[4:7], v[224:227]
    ds_read_b64_tr_b16 a[96:97], v12 offset:0
    v_mfma_f32_16x16x32_bf16 v[228:231], a[124:127], a[4:7], v[228:231]
    v_mfma_f32_16x16x32_bf16 v[228:231], a[120:123], a[0:3], v[228:231]
    s_add_u32 m0, s61, 4096
    ds_read_b128 a[0:3], v6 offset:0
    v_mfma_f32_16x16x32_bf16 v[236:239], a[120:123], a[8:11], v[236:239]
    buffer_load_dwordx4 v16, s[40:43], s50 offen offset:0 sc1 lds
    v_mfma_f32_16x16x32_bf16 v[236:239], a[124:127], a[12:15], v[236:239]
    s_add_u32 s61, s61, 32768
    ds_read_b128 a[4:7], v7 offset:0
    v_mfma_f32_16x16x32_bf16 v[232:235], a[116:119], a[12:15], v[232:235]
    s_cmp_ge_u32 s61, 98304
    s_cselect_b32 s90, 98304, 0
    ds_read_b64_tr_b16 a[98:99], v12 offset:2048
    v_mfma_f32_16x16x32_bf16 v[232:235], a[112:115], a[8:11], v[232:235]
    s_sub_u32 s61, s61, s90
    ds_read_b128 a[8:11], v6 offset:2048
    v_mfma_f32_16x16x32_bf16 v[240:243], a[112:115], a[16:19], v[240:243]
    ds_read_b128 a[12:15], v7 offset:2048
    v_mfma_f32_16x16x32_bf16 v[240:243], a[116:119], a[20:23], v[240:243]
    ds_read_b64_tr_b16 a[100:101], v12 offset:16384
    v_mfma_f32_16x16x32_bf16 v[244:247], a[124:127], a[20:23], v[244:247]
    v_mfma_f32_16x16x32_bf16 v[244:247], a[120:123], a[16:19], v[244:247]
    ds_read_b128 a[16:19], v6 offset:4096
    v_mfma_f32_16x16x32_bf16 v[252:255], a[120:123], a[24:27], v[252:255]
    buffer_load_dwordx4 v17, s[40:43], s50 offen offset:1024 sc1 lds
    v_mfma_f32_16x16x32_bf16 v[252:255], a[124:127], a[28:31], v[252:255]
    s_add_u32 s50, s50, 128
    ds_read_b128 a[20:23], v7 offset:4096
    v_mfma_f32_16x16x32_bf16 v[248:251], a[116:119], a[28:31], v[248:251]
    ds_read_b64_tr_b16 a[102:103], v12 offset:18432
    v_mfma_f32_16x16x32_bf16 v[248:251], a[112:115], a[24:27], v[248:251]
    ds_read_b128 a[24:27], v6 offset:6144
    v_mfma_f32_16x16x32_bf16 a[224:227], a[112:115], a[32:35], a[224:227]
    s_sub_u32 s65, s65, 1
    ds_read_b128 a[28:31], v7 offset:6144
    v_mfma_f32_16x16x32_bf16 a[224:227], a[116:119], a[36:39], a[224:227]
    ds_read_b64_tr_b16 a[104:105], v13 offset:0
    v_mfma_f32_16x16x32_bf16 a[228:231], a[124:127], a[36:39], a[228:231]
    v_mfma_f32_16x16x32_bf16 a[228:231], a[120:123], a[32:35], a[228:231]
    ds_read_b128 a[32:35], v6 offset:8192
    v_mfma_f32_16x16x32_bf16 a[236:239], a[120:123], a[40:43], a[236:239]
    buffer_load_dwordx4 v16, s[40:43], s51 offen offset:2048 sc1 lds
    v_mfma_f32_16x16x32_bf16 a[236:239], a[124:127], a[44:47], a[236:239]
    ds_read_b128 a[36:39], v7 offset:8192
    v_mfma_f32_16x16x32_bf16 a[232:235], a[116:119], a[44:47], a[232:235]
    ds_read_b64_tr_b16 a[106:107], v13 offset:2048
    v_mfma_f32_16x16x32_bf16 a[232:235], a[112:115], a[40:43], a[232:235]
    ds_read_b128 a[40:43], v6 offset:10240
    v_mfma_f32_16x16x32_bf16 a[240:243], a[112:115], a[48:51], a[240:243]
    ds_read_b128 a[44:47], v7 offset:10240
    v_mfma_f32_16x16x32_bf16 a[240:243], a[116:119], a[52:55], a[240:243]
    ds_read_b64_tr_b16 a[108:109], v13 offset:16384
    v_mfma_f32_16x16x32_bf16 a[244:247], a[124:127], a[52:55], a[244:247]
    v_mfma_f32_16x16x32_bf16 a[244:247], a[120:123], a[48:51], a[244:247]
    ds_read_b128 a[48:51], v6 offset:12288
    v_mfma_f32_16x16x32_bf16 a[252:255], a[120:123], a[56:59], a[252:255]
    buffer_load_dwordx4 v17, s[40:43], s51 offen offset:3072 sc1 lds
    v_mfma_f32_16x16x32_bf16 a[252:255], a[124:127], a[60:63], a[252:255]
    s_add_u32 s51, s51, 128
    ds_read_b128 a[52:55], v7 offset:12288
    v_mfma_f32_16x16x32_bf16 a[248:251], a[116:119], a[60:63], a[248:251]
    s_cmp_gt_u32 s65, s67
    ds_read_b64_tr_b16 a[110:111], v13 offset:18432
    v_mfma_f32_16x16x32_bf16 a[248:251], a[112:115], a[56:59], a[248:251]
    ds_read_b128 a[56:59], v6 offset:14336
    ds_read_b128 a[60:63], v7 offset:14336
    s_cbranch_scc1 m_loop20
    s_cmp_eq_u32 s65, 0
    s_cbranch_scc1 m_epi15
m_dosw21:
    s_cmp_eq_u32 s94, 0
    s_cbranch_scc1 m_x39
    s_cmp_lg_u32 s65, 3
    s_cbranch_scc1 m_x45
    s_mov_b32 s42, s73
    s_lshl_b32 s90, s77, 4
    s_lshl_b32 s90, s90, s81
    s_mov_b32 s48, s79
    s_mul_i32 s91, s90, 1
    s_add_u32 s49, s91, s79
    s_sub_u32 s49, s49, 2048
    s_mul_i32 s91, s90, 2
    s_add_u32 s50, s91, s79
    s_mul_i32 s91, s90, 3
    s_add_u32 s51, s91, s79
    s_sub_u32 s51, s51, 2048
    s_lshl_b32 s90, s58, 7
    s_add_u32 s90, s90, s57
    s_lshl_b32 s91, s16, 6
    s_cmp_eq_u32 s81, 1
    s_cselect_b32 s90, s90, s91
    v_lshrrev_b32 v24, 3, v1
    v_lshlrev_b32 v24, s81, v24
    v_add_u32 v24, s90, v24
    v_mul_lo_u32 v24, v24, s77
    v_lshrrev_b32 v25, 4, v1
    v_and_b32 v26, 7, v1
    v_xor_b32 v25, v25, v26
    v_lshl_add_u32 v16, v25, 4, v24
    v_xor_b32 v25, 4, v25
    v_lshl_add_u32 v17, v25, 4, v24
    s_lshl_b32 s90, s77, 3
    s_lshl_b32 s90, s90, s81
    s_sub_u32 s90, s90, 1024
    v_add_u32 v17, s90, v17
    s_mov_b32 s40, s71
    s_mov_b32 s41, s72
    buffer_load_dwordx2 v[4:5], off, s[12:15], 0 sc1
    s_branch m_loop20
m_x45:
    s_mov_b32 s46, s76
    s_mov_b32 s52, s80
    s_lshl_b32 s90, s78, 2
    s_mul_i32 s91, s90, 1
    s_add_u32 s53, s91, s80
    s_sub_u32 s53, s53, 2048
    s_mul_i32 s91, s90, 2
    s_add_u32 s54, s91, s80
    s_mul_i32 s91, s90, 3
    s_add_u32 s55, s91, s80
    s_sub_u32 s55, s55, 2048
    s_lshl_b32 s56, s78, 6
    v_lshrrev_b32 v24, 5, v1
    s_lshl_b32 s90, s16, 4
    v_add_u32 v25, s90, v24
    v_mul_lo_u32 v25, v25, s78
    v_lshlrev_b32 v24, 1, v24
    v_and_b32 v26, 31, v1
    v_xor_b32 v24, v24, v26
    s_lshl_b32 s90, s78, 1
    s_sub_u32 s90, s90, 1024
    v_add_u32 v27, s90, v25
    v_xor_b32 v26, 0, v24
    v_lshl_add_u32 v18, v26, 4, v25
    v_xor_b32 v26, 4, v24
    v_lshl_add_u32 v19, v26, 4, v27
    v_xor_b32 v26, 8, v24
    v_lshl_add_u32 v20, v26, 4, v25
    v_xor_b32 v26, 12, v24
    v_lshl_add_u32 v21, v26, 4, v27
    s_mov_b32 s44, s74
    s_mov_b32 s45, s75
    s_mov_b32 s67, 0
    s_branch m_loop20
m_x39:
    s_cmp_le_u32 s65, 4
    s_cbranch_scc1 m_x40
    s_cmp_lg_u32 s16, 0
    s_cbranch_scc1 m_np46
    v_mov_b32 v4, s4
    v_mov_b32 v5, s5
    s_add_u32 s90, s17, 117440512
    s_mov_b64 exec, 1
    buffer_store_dwordx2 v[4:5], off, s[8:11], s90 sc1
    s_mov_b64 exec, -1
m_np46:
    s_mov_b32 s17, -1
    s_mov_b32 s67, 4
    s_branch m_loop20
m_x40:
    s_cmp_lg_u32 s65, 4
    s_cbranch_scc1 m_x41
    s_cmp_eq_u32 s70, 1
    s_cbranch_scc1 m_ea47
    buffer_load_dwordx2 v[4:5], v0, s[8:11], s37 offen sc1
m_eb48:
    s_branch m_loop20
m_x41:
    s_waitcnt vmcnt(16)
    s_cmp_lg_u32 s65, 3
    s_cbranch_scc1 m_x42
    s_cmp_eq_u32 s70, 1
    s_cbranch_scc1 m_ea49
    s_mov_b32 s3, 1048576
m_spin51:
    v_cmp_ne_u64 s[22:23], s[4:5], v[4:5]
    s_nop 3
    s_cmp_eq_u64 s[22:23], 0
    s_cbranch_scc1 m_ok52
    s_sub_u32 s3, s3, 1
    s_cbranch_scc1 m_ok52
    s_sleep 16
    buffer_load_dwordx2 v[4:5], v0, s[8:11], s37 offen sc1
    s_waitcnt vmcnt(0)
    s_branch m_spin51
m_ok52:
    buffer_load_dwordx4 a[128:131], v2, s[8:11], s33 offen offset:0 sc1
    buffer_load_dwordx4 a[132:135], v2, s[8:11], s33 offen offset:1024 sc1
    buffer_load_dwordx4 a[136:139], v2, s[8:11], s33 offen offset:2048 sc1
    buffer_load_dwordx4 a[140:143], v2, s[8:11], s33 offen offset:3072 sc1
    buffer_load_dwordx4 a[144:147], v2, s[8:11], s34 offen offset:0 sc1
    buffer_load_dwordx4 a[148:151], v2, s[8:11], s34 offen offset:1024 sc1
m_eb50:
    s_add_u32 s48, s32, 0
    s_mov_b32 s49, s48
    s_add_u32 s50, s48, 4096
    s_mov_b32 s51, s50
    s_cmp_eq_u32 s57, 0
    s_cselect_b32 s42, 268435456, 0
    s_mov_b32 s40, s6
    s_mov_b32 s41, s7
    v_mov_b32 v16, v2
    v_mov_b32 v17, v2
    s_branch m_loop20
m_x42:
    s_cmp_lg_u32 s65, 2
    s_cbranch_scc1 m_x43
    s_cmp_eq_u32 s70, 1
    s_cbranch_scc1 m_ea53
    buffer_load_dwordx4 a[152:155], v2, s[8:11], s34 offen offset:2048 sc1
    buffer_load_dwordx4 a[156:159], v2, s[8:11], s34 offen offset:3072 sc1
    buffer_load_dwordx4 a[160:163], v2, s[8:11], s35 offen offset:0 sc1
    buffer_load_dwordx4 a[164:167], v2, s[8:11], s35 offen offset:1024 sc1
    buffer_load_dwordx4 a[168:171], v2, s[8:11], s35 offen offset:2048 sc1
m_eb54:
    s_add_u32 s48, s32, 16384
    s_mov_b32 s49, s48
    s_add_u32 s50, s48, 4096
    s_mov_b32 s51, s50
    s_mov_b32 s42, 268435456
    s_add_u32 s52, s32, 49152
    s_mov_b32 s53, s52
    s_add_u32 s54, s52, 4096
    s_mov_b32 s55, s54
    s_mov_b32 s46, 268435456
    s_mov_b32 s44, s6
    s_mov_b32 s45, s7
    v_mov_b32 v18, v2
    v_mov_b32 v19, v2
    v_mov_b32 v20, v2
    v_mov_b32 v21, v2
    s_branch m_loop20
m_x43:
    s_cmp_eq_u32 s70, 1
    s_cbranch_scc1 m_ea55
    buffer_load_dwordx4 a[172:175], v2, s[8:11], s35 offen offset:3072 sc1
    buffer_load_dwordx4 a[176:179], v2, s[8:11], s36 offen offset:0 sc1
    buffer_load_dwordx4 a[180:183], v2, s[8:11], s36 offen offset:1024 sc1
    buffer_load_dwordx4 a[184:187], v2, s[8:11], s36 offen offset:2048 sc1
    buffer_load_dwordx4 a[188:191], v2, s[8:11], s36 offen offset:3072 sc1
m_eb56:
    s_add_u32 s48, s32, 32768
    s_mov_b32 s49, s48
    s_add_u32 s50, s48, 4096
    s_mov_b32 s51, s50
    s_add_u32 s52, s32, 65536
    s_mov_b32 s53, s52
    s_add_u32 s54, s52, 4096
    s_mov_b32 s55, s54
    s_branch m_loop20
m_ea47:
    s_and_b32 s92, s2, 7
    s_lshl_b32 s92, s92, 2
    s_bfe_u32 s93, s2, 0x20003
    s_add_u32 s92, s92, s93
    s_lshr_b32 s93, s2, 5
    s_lshl_b32 s93, s93, 2
    s_or_b32 s93, s93, 0x40000
    v_and_b32 v0, 3, v1
    v_min_u32 v0, 2, v0
    v_and_b32 v24, 4, v1
    v_add3_u32 v0, v0, v24, 8
    v_lshlrev_b32 v0, 3, v0
    buffer_load_dwordx2 v[4:5], v0, s[8:11], s37 offen sc1
    s_branch m_eb48
m_ea49:
    s_mov_b32 s3, 1048576
m_spin57:
    v_cmp_ne_u64 s[22:23], s[4:5], v[4:5]
    s_nop 3
    s_cmp_eq_u64 s[22:23], 0
    s_cbranch_scc1 m_ok58
    s_sub_u32 s3, s3, 1
    s_cbranch_scc1 m_ok58
    s_sleep 16
    buffer_load_dwordx2 v[4:5], v0, s[8:11], s37 offen sc1
    s_waitcnt vmcnt(0)
    s_branch m_spin57
m_ok58:
    s_branch m_eb50
m_ea53:
    s_and_b32 s92, s2, 7
    s_lshl_b32 s92, s92, 2
    s_bfe_u32 s93, s2, 0x20003
    s_add_u32 s92, s92, s93
    s_lshr_b32 s93, s2, 5
    s_lshl_b32 s93, s93, 2
    s_or_b32 s93, s93, 0x40000
    s_bfe_u32 s91, 873473623, s93
    s_lshr_b32 s91, s91, 1
    v_mov_b32 v0, s91
    s_bfe_u32 s91, 4225681832, s93
    s_lshr_b32 s91, s91, 1
    v_writelane_b32 v0, s91, 8
    v_lshlrev_b32 v0, 3, v0
    buffer_load_dwordx2 v[4:5], v0, s[8:11], s37 offen sc1
    s_branch m_eb54
m_ea55:
    s_mov_b32 s3, 1048576
m_spin59:
    v_cmp_ne_u64 s[22:23], s[4:5], v[4:5]
    s_nop 3
    s_cmp_eq_u64 s[22:23], 0
    s_cbranch_scc1 m_ok60
    s_sub_u32 s3, s3, 1
    s_cbranch_scc1 m_ok60
    s_sleep 16
    buffer_load_dwordx2 v[4:5], v0, s[8:11], s37 offen sc1
    s_waitcnt vmcnt(0)
    s_branch m_spin59
m_ok60:
    buffer_load_dwordx4 a[128:131], v2, s[8:11], s33 offen offset:0 sc1
    buffer_load_dwordx4 a[132:135], v2, s[8:11], s33 offen offset:1024 sc1
    buffer_load_dwordx4 a[136:139], v2, s[8:11], s33 offen offset:2048 sc1
    buffer_load_dwordx4 a[140:143], v2, s[8:11], s33 offen offset:3072 sc1
    buffer_load_dwordx4 a[144:147], v2, s[8:11], s34 offen offset:0 sc1
    buffer_load_dwordx4 a[148:151], v2, s[8:11], s34 offen offset:1024 sc1
    buffer_load_dwordx4 a[152:155], v2, s[8:11], s34 offen offset:2048 sc1
    buffer_load_dwordx4 a[156:159], v2, s[8:11], s34 offen offset:3072 sc1
    buffer_load_dwordx4 a[160:163], v2, s[8:11], s35 offen offset:0 sc1
    buffer_load_dwordx4 a[164:167], v2, s[8:11], s35 offen offset:1024 sc1
    buffer_load_dwordx4 a[168:171], v2, s[8:11], s35 offen offset:2048 sc1
    buffer_load_dwordx4 a[172:175], v2, s[8:11], s35 offen offset:3072 sc1
    buffer_load_dwordx4 a[176:179], v2, s[8:11], s36 offen offset:0 sc1
    buffer_load_dwordx4 a[180:183], v2, s[8:11], s36 offen offset:1024 sc1
    buffer_load_dwordx4 a[184:187], v2, s[8:11], s36 offen offset:2048 sc1
    buffer_load_dwordx4 a[188:191], v2, s[8:11], s36 offen offset:3072 sc1
    s_branch m_eb56
m_swp16:
    s_waitcnt lgkmcnt(15)
    v_mfma_f32_16x16x32_bf16 v[32:35], a[0:3], a[64:67], 0
    ds_read_b64_tr_b16 a[112:113], v14 offset:0
    v_mfma_f32_16x16x32_bf16 v[32:35], a[4:7], a[68:71], v[32:35]
    ds_read_b64_tr_b16 a[114:115], v14 offset:2048
    v_mfma_f32_16x16x32_bf16 v[40:43], a[4:7], a[76:79], 0
    ds_read_b64_tr_b16 a[116:117], v14 offset:16384
    v_mfma_f32_16x16x32_bf16 v[40:43], a[0:3], a[72:75], v[40:43]
    ds_read_b64_tr_b16 a[118:119], v14 offset:18432
    v_mfma_f32_16x16x32_bf16 v[44:47], a[8:11], a[72:75], 0
    ds_read_b64_tr_b16 a[120:121], v15 offset:0
    v_mfma_f32_16x16x32_bf16 v[44:47], a[12:15], a[76:79], v[44:47]
    ds_read_b64_tr_b16 a[122:123], v15 offset:2048
    v_mfma_f32_16x16x32_bf16 v[36:39], a[12:15], a[68:71], 0
    ds_read_b64_tr_b16 a[124:125], v15 offset:16384
    v_mfma_f32_16x16x32_bf16 v[36:39], a[8:11], a[64:67], v[36:39]
    ds_read_b64_tr_b16 a[126:127], v15 offset:18432
    v_mfma_f32_16x16x32_bf16 v[96:99], a[16:19], a[64:67], 0
    v_mfma_f32_16x16x32_bf16 v[96:99], a[20:23], a[68:71], v[96:99]
    v_mfma_f32_16x16x32_bf16 v[104:107], a[20:23], a[76:79], 0
    buffer_store_dwordx4 a[128:131], v2, s[24:27], s28 offen sc1
    v_mfma_f32_16x16x32_bf16 v[104:107], a[16:19], a[72:75], v[104:107]
    s_add_u32 s28, s28, s31
    s_waitcnt lgkmcnt(15)
    v_mfma_f32_16x16x32_bf16 v[108:111], a[24:27], a[72:75], 0
    v_xor_b32 v8, s60, v8
    v_xor_b32 v9, s60, v9
    v_mfma_f32_16x16x32_bf16 v[108:111], a[28:31], a[76:79], v[108:111]
    v_xor_b32 v10, s60, v10
    v_xor_b32 v11, s60, v11
    v_mfma_f32_16x16x32_bf16 v[100:103], a[28:31], a[68:71], 0
    v_xor_b32 v12, s60, v12
    v_xor_b32 v13, s60, v13
    v_mfma_f32_16x16x32_bf16 v[100:103], a[24:27], a[64:67], v[100:103]
    v_xor_b32 v14, s60, v14
    v_xor_b32 v15, s60, v15
    v_mfma_f32_16x16x32_bf16 v[160:163], a[32:35], a[64:67], 0
    buffer_store_dwordx4 a[132:135], v2, s[24:27], s28 offen sc1
    v_mfma_f32_16x16x32_bf16 v[160:163], a[36:39], a[68:71], v[160:163]
    s_add_u32 s28, s28, s31
    v_mfma_f32_16x16x32_bf16 v[168:171], a[36:39], a[76:79], 0
    v_mfma_f32_16x16x32_bf16 v[168:171], a[32:35], a[72:75], v[168:171]
    s_waitcnt lgkmcnt(14)
    v_mfma_f32_16x16x32_bf16 v[172:175], a[40:43], a[72:75], 0
    v_mfma_f32_16x16x32_bf16 v[172:175], a[44:47], a[76:79], v[172:175]
    v_mfma_f32_16x16x32_bf16 v[164:167], a[44:47], a[68:71], 0
    buffer_store_dwordx4 a[136:139], v2, s[24:27], s28 offen sc1
    v_mfma_f32_16x16x32_bf16 v[164:167], a[40:43], a[64:67], v[164:167]
    s_add_u32 s28, s28, s31
    s_waitcnt lgkmcnt(11)
    v_mfma_f32_16x16x32_bf16 v[224:227], a[48:51], a[64:67], 0
    v_mfma_f32_16x16x32_bf16 v[224:227], a[52:55], a[68:71], v[224:227]
    v_mfma_f32_16x16x32_bf16 v[232:235], a[52:55], a[76:79], 0
    v_mfma_f32_16x16x32_bf16 v[232:235], a[48:51], a[72:75], v[232:235]
    s_waitcnt lgkmcnt(8)
    v_mfma_f32_16x16x32_bf16 v[236:239], a[56:59], a[72:75], 0
    buffer_store_dwordx4 a[140:143], v2, s[24:27], s28 offen sc1
    v_mfma_f32_16x16x32_bf16 v[236:239], a[60:63], a[76:79], v[236:239]
    s_add_u32 s28, s28, s31
    v_mfma_f32_16x16x32_bf16 v[228:231], a[60:63], a[68:71], 0
    s_waitcnt vmcnt(44) lgkmcnt(0)
    s_cmp_eq_u32 s66, 2
    s_cbranch_scc1 m_w22
    s_waitcnt vmcnt(12)
m_w22:
    v_mfma_f32_16x16x32_bf16 v[228:231], a[56:59], a[64:67], v[228:231]
    s_barrier
    v_mfma_f32_16x16x32_bf16 v[48:51], a[0:3], a[80:83], 0
    ds_read_b64_tr_b16 a[64:65], v8 offset:0
    v_mfma_f32_16x16x32_bf16 v[48:51], a[4:7], a[84:87], v[48:51]
    s_add_u32 m0, s62, 0
    v_mfma_f32_16x16x32_bf16 v[56:59], a[4:7], a[92:95], 0
    buffer_load_dwordx4 v18, s[44:47], s52 offen offset:0 sc1 lds
    v_mfma_f32_16x16x32_bf16 v[56:59], a[0:3], a[88:91], v[56:59]
    ds_read_b64_tr_b16 a[66:67], v8 offset:2048
    v_mfma_f32_16x16x32_bf16 v[60:63], a[8:11], a[88:91], 0
    s_add_u32 s64, s64, 32768
    v_mfma_f32_16x16x32_bf16 v[60:63], a[12:15], a[92:95], v[60:63]
    s_cmp_ge_u32 s64, 98304
    s_cselect_b32 s63, 4294901760, s59
    s_cselect_b32 s64, 0, s64
    v_mfma_f32_16x16x32_bf16 v[52:55], a[12:15], a[84:87], 0
    buffer_load_dwordx4 v19, s[44:47], s52 offen offset:1024 sc1 lds
    v_mfma_f32_16x16x32_bf16 v[52:55], a[8:11], a[80:83], v[52:55]
    s_add_u32 s52, s52, s56
    ds_read_b64_tr_b16 a[68:69], v8 offset:16384
    v_mfma_f32_16x16x32_bf16 v[112:115], a[16:19], a[80:83], 0
    v_mfma_f32_16x16x32_bf16 v[112:115], a[20:23], a[84:87], v[112:115]
    v_mfma_f32_16x16x32_bf16 v[120:123], a[20:23], a[92:95], 0
    buffer_load_dwordx4 v18, s[44:47], s53 offen offset:2048 sc1 lds
    v_mfma_f32_16x16x32_bf16 v[120:123], a[16:19], a[88:91], v[120:123]
    ds_read_b64_tr_b16 a[70:71], v8 offset:18432
    v_mfma_f32_16x16x32_bf16 v[124:127], a[24:27], a[88:91], 0
    v_mfma_f32_16x16x32_bf16 v[124:127], a[28:31], a[92:95], v[124:127]
    v_mfma_f32_16x16x32_bf16 v[116:119], a[28:31], a[84:87], 0
    buffer_load_dwordx4 v19, s[44:47], s53 offen offset:3072 sc1 lds
    v_mfma_f32_16x16x32_bf16 v[116:119], a[24:27], a[80:83], v[116:119]
    s_add_u32 s53, s53, s56
    ds_read_b64_tr_b16 a[72:73], v9 offset:0
    v_mfma_f32_16x16x32_bf16 v[176:179], a[32:35], a[80:83], 0
    v_mfma_f32_16x16x32_bf16 v[176:179], a[36:39], a[84:87], v[176:179]
    s_add_u32 m0, s62, 4096
    v_mfma_f32_16x16x32_bf16 v[184:187], a[36:39], a[92:95], 0
    buffer_load_dwordx4 v20, s[44:47], s54 offen offset:0 sc1 lds
    v_mfma_f32_16x16x32_bf16 v[184:187], a[32:35], a[88:91], v[184:187]
    s_xor_b32 s62, s62, 229376
    ds_read_b64_tr_b16 a[74:75], v9 offset:2048
    v_mfma_f32_16x16x32_bf16 v[188:191], a[40:43], a[88:91], 0
    v_mfma_f32_16x16x32_bf16 v[188:191], a[44:47], a[92:95], v[188:191]
    v_mfma_f32_16x16x32_bf16 v[180:183], a[44:47], a[84:87], 0
    buffer_load_dwordx4 v21, s[44:47], s54 offen offset:1024 sc1 lds
    v_mfma_f32_16x16x32_bf16 v[180:183], a[40:43], a[80:83], v[180:183]
    s_add_u32 s54, s54, s56
    ds_read_b64_tr_b16 a[76:77], v9 offset:16384
    v_mfma_f32_16x16x32_bf16 v[240:243], a[48:51], a[80:83], 0
    v_mfma_f32_16x16x32_bf16 v[240:243], a[52:55], a[84:87], v[240:243]
    v_mfma_f32_16x16x32_bf16 v[248:251], a[52:55], a[92:95], 0
    buffer_load_dwordx4 v20, s[44:47], s55 offen offset:2048 sc1 lds
    v_mfma_f32_16x16x32_bf16 v[248:251], a[48:51], a[88:91], v[248:251]
    ds_read_b64_tr_b16 a[78:79], v9 offset:18432
    v_mfma_f32_16x16x32_bf16 v[252:255], a[56:59], a[88:91], 0
    v_add_u32 v6, s63, v6
    v_add_u32 v7, s63, v7
    v_mfma_f32_16x16x32_bf16 v[252:255], a[60:63], a[92:95], v[252:255]
    v_mfma_f32_16x16x32_bf16 v[244:247], a[60:63], a[84:87], 0
    buffer_load_dwordx4 v21, s[44:47], s55 offen offset:3072 sc1 lds
    v_mfma_f32_16x16x32_bf16 v[244:247], a[56:59], a[80:83], v[244:247]
    s_add_u32 s55, s55, s56
    v_mfma_f32_16x16x32_bf16 v[64:67], a[0:3], a[96:99], 0
    ds_read_b64_tr_b16 a[80:81], v10 offset:0
    v_mfma_f32_16x16x32_bf16 v[64:67], a[4:7], a[100:103], v[64:67]
    v_mfma_f32_16x16x32_bf16 v[72:75], a[4:7], a[108:111], 0
    v_mfma_f32_16x16x32_bf16 v[72:75], a[0:3], a[104:107], v[72:75]
    s_add_u32 m0, s61, 0
    ds_read_b64_tr_b16 a[82:83], v10 offset:2048
    v_mfma_f32_16x16x32_bf16 v[76:79], a[8:11], a[104:107], 0
    buffer_load_dwordx4 v16, s[40:43], s48 offen offset:0 sc1 lds
    v_mfma_f32_16x16x32_bf16 v[76:79], a[12:15], a[108:111], v[76:79]
    v_mfma_f32_16x16x32_bf16 v[68:71], a[12:15], a[100:103], 0
    ds_read_b64_tr_b16 a[84:85], v10 offset:16384
    v_mfma_f32_16x16x32_bf16 v[68:71], a[8:11], a[96:99], v[68:71]
    v_mfma_f32_16x16x32_bf16 v[128:131], a[16:19], a[96:99], 0
    buffer_store_dwordx4 a[144:147], v2, s[24:27], s28 offen sc1
    v_mfma_f32_16x16x32_bf16 v[128:131], a[20:23], a[100:103], v[128:131]
    s_add_u32 s28, s28, s31
    ds_read_b64_tr_b16 a[86:87], v10 offset:18432
    v_mfma_f32_16x16x32_bf16 v[136:139], a[20:23], a[108:111], 0
    v_mfma_f32_16x16x32_bf16 v[136:139], a[16:19], a[104:107], v[136:139]
    v_mfma_f32_16x16x32_bf16 v[140:143], a[24:27], a[104:107], 0
    buffer_load_dwordx4 v17, s[40:43], s48 offen offset:1024 sc1 lds
    v_mfma_f32_16x16x32_bf16 v[140:143], a[28:31], a[108:111], v[140:143]
    s_add_u32 s48, s48, 128
    ds_read_b64_tr_b16 a[88:89], v11 offset:0
    v_mfma_f32_16x16x32_bf16 v[132:135], a[28:31], a[100:103], 0
    v_mfma_f32_16x16x32_bf16 v[132:135], a[24:27], a[96:99], v[132:135]
    v_mfma_f32_16x16x32_bf16 v[192:195], a[32:35], a[96:99], 0
    buffer_store_dwordx4 a[148:151], v2, s[24:27], s28 offen sc1
    v_mfma_f32_16x16x32_bf16 v[192:195], a[36:39], a[100:103], v[192:195]
    s_add_u32 s28, s28, s31
    ds_read_b64_tr_b16 a[90:91], v11 offset:2048
    v_mfma_f32_16x16x32_bf16 v[200:203], a[36:39], a[108:111], 0
    v_mfma_f32_16x16x32_bf16 v[200:203], a[32:35], a[104:107], v[200:203]
    v_mfma_f32_16x16x32_bf16 v[204:207], a[40:43], a[104:107], 0
    buffer_load_dwordx4 v16, s[40:43], s49 offen offset:2048 sc1 lds
    v_mfma_f32_16x16x32_bf16 v[204:207], a[44:47], a[108:111], v[204:207]
    ds_read_b64_tr_b16 a[92:93], v11 offset:16384
    v_mfma_f32_16x16x32_bf16 v[196:199], a[44:47], a[100:103], 0
    v_mfma_f32_16x16x32_bf16 v[196:199], a[40:43], a[96:99], v[196:199]
    v_mfma_f32_16x16x32_bf16 a[224:227], a[48:51], a[96:99], 0
    buffer_store_dwordx4 a[152:155], v2, s[24:27], s28 offen sc1
    v_mfma_f32_16x16x32_bf16 a[224:227], a[52:55], a[100:103], a[224:227]
    s_add_u32 s28, s28, s31
    ds_read_b64_tr_b16 a[94:95], v11 offset:18432
    v_mfma_f32_16x16x32_bf16 a[232:235], a[52:55], a[108:111], 0
    v_mfma_f32_16x16x32_bf16 a[232:235], a[48:51], a[104:107], a[232:235]
    v_mfma_f32_16x16x32_bf16 a[236:239], a[56:59], a[104:107], 0
    buffer_load_dwordx4 v17, s[40:43], s49 offen offset:3072 sc1 lds
    v_mfma_f32_16x16x32_bf16 a[236:239], a[60:63], a[108:111], a[236:239]
    s_add_u32 s49, s49, 128
    v_mfma_f32_16x16x32_bf16 a[228:231], a[60:63], a[100:103], 0
    buffer_store_dwordx4 a[156:159], v2, s[24:27], s28 offen sc1
    v_mfma_f32_16x16x32_bf16 a[228:231], a[56:59], a[96:99], a[228:231]
    s_add_u32 s29, s29, s30
    s_mov_b32 s28, s29
    v_mfma_f32_16x16x32_bf16 v[80:83], a[0:3], a[112:115], 0
    v_mfma_f32_16x16x32_bf16 v[80:83], a[4:7], a[116:119], v[80:83]
    ds_read_b64_tr_b16 a[96:97], v12 offset:0
    v_mfma_f32_16x16x32_bf16 v[88:91], a[4:7], a[124:127], 0
    v_mfma_f32_16x16x32_bf16 v[88:91], a[0:3], a[120:123], v[88:91]
    s_add_u32 m0, s61, 4096
    ds_read_b128 a[0:3], v6 offset:0
    v_mfma_f32_16x16x32_bf16 v[92:95], a[8:11], a[120:123], 0
    buffer_load_dwordx4 v16, s[40:43], s50 offen offset:0 sc1 lds
    v_mfma_f32_16x16x32_bf16 v[92:95], a[12:15], a[124:127], v[92:95]
    s_add_u32 s61, s61, 32768
    ds_read_b128 a[4:7], v7 offset:0
    v_mfma_f32_16x16x32_bf16 v[84:87], a[12:15], a[116:119], 0
    s_cmp_ge_u32 s61, 98304
    s_cselect_b32 s90, 98304, 0
    ds_read_b64_tr_b16 a[98:99], v12 offset:2048
    v_mfma_f32_16x16x32_bf16 v[84:87], a[8:11], a[112:115], v[84:87]
    s_sub_u32 s61, s61, s90
    ds_read_b128 a[8:11], v6 offset:2048
    v_mfma_f32_16x16x32_bf16 v[144:147], a[16:19], a[112:115], 0
    ds_read_b128 a[12:15], v7 offset:2048
    v_mfma_f32_16x16x32_bf16 v[144:147], a[20:23], a[116:119], v[144:147]
    ds_read_b64_tr_b16 a[100:101], v12 offset:16384
    v_mfma_f32_16x16x32_bf16 v[152:155], a[20:23], a[124:127], 0
    v_mfma_f32_16x16x32_bf16 v[152:155], a[16:19], a[120:123], v[152:155]
    ds_read_b128 a[16:19], v6 offset:4096
    v_mfma_f32_16x16x32_bf16 v[156:159], a[24:27], a[120:123], 0
    buffer_load_dwordx4 v17, s[40:43], s50 offen offset:1024 sc1 lds
    v_mfma_f32_16x16x32_bf16 v[156:159], a[28:31], a[124:127], v[156:159]
    s_add_u32 s50, s50, 128
    ds_read_b128 a[20:23], v7 offset:4096
    v_mfma_f32_16x16x32_bf16 v[148:151], a[28:31], a[116:119], 0
    ds_read_b64_tr_b16 a[102:103], v12 offset:18432
    v_mfma_f32_16x16x32_bf16 v[148:151], a[24:27], a[112:115], v[148:151]
    ds_read_b128 a[24:27], v6 offset:6144
    v_mfma_f32_16x16x32_bf16 v[208:211], a[32:35], a[112:115], 0
    s_sub_u32 s65, s65, 1
    ds_read_b128 a[28:31], v7 offset:6144
    v_mfma_f32_16x16x32_bf16 v[208:211], a[36:39], a[116:119], v[208:211]
    ds_read_b64_tr_b16 a[104:105], v13 offset:0
    v_mfma_f32_16x16x32_bf16 v[216:219], a[36:39], a[124:127], 0
    v_mfma_f32_16x16x32_bf16 v[216:219], a[32:35], a[120:123], v[216:219]
    ds_read_b128 a[32:35], v6 offset:8192
    v_mfma_f32_16x16x32_bf16 v[220:223], a[40:43], a[120:123], 0
    buffer_load_dwordx4 v16, s[40:43], s51 offen offset:2048 sc1 lds
    v_mfma_f32_16x16x32_bf16 v[220:223], a[44:47], a[124:127], v[220:223]
    ds_read_b128 a[36:39], v7 offset:8192
    v_mfma_f32_16x16x32_bf16 v[212:215], a[44:47], a[116:119], 0
    ds_read_b64_tr_b16 a[106:107], v13 offset:2048
    v_mfma_f32_16x16x32_bf16 v[212:215], a[40:43], a[112:115], v[212:215]
    ds_read_b128 a[40:43], v6 offset:10240
    v_mfma_f32_16x16x32_bf16 a[240:243], a[48:51], a[112:115], 0
    ds_read_b128 a[44:47], v7 offset:10240
    v_mfma_f32_16x16x32_bf16 a[240:243], a[52:55], a[116:119], a[240:243]
    ds_read_b64_tr_b16 a[108:109], v13 offset:16384
    v_mfma_f32_16x16x32_bf16 a[248:251], a[52:55], a[124:127], 0
    v_mfma_f32_16x16x32_bf16 a[248:251], a[48:51], a[120:123], a[248:251]
    ds_read_b128 a[48:51], v6 offset:12288
    v_mfma_f32_16x16x32_bf16 a[252:255], a[56:59], a[120:123], 0
    buffer_load_dwordx4 v17, s[40:43], s51 offen offset:3072 sc1 lds
    v_mfma_f32_16x16x32_bf16 a[252:255], a[60:63], a[124:127], a[252:255]
    s_add_u32 s51, s51, 128
    ds_read_b128 a[52:55], v7 offset:12288
    v_mfma_f32_16x16x32_bf16 a[244:247], a[60:63], a[116:119], 0
    ds_read_b64_tr_b16 a[110:111], v13 offset:18432
    v_mfma_f32_16x16x32_bf16 a[244:247], a[56:59], a[112:115], a[244:247]
    ds_read_b128 a[56:59], v6 offset:14336
    ds_read_b128 a[60:63], v7 offset:14336
    s_waitcnt lgkmcnt(15)
    v_mfma_f32_16x16x32_bf16 v[32:35], a[0:3], a[64:67], v[32:35]
    ds_read_b64_tr_b16 a[112:113], v14 offset:0
    v_mfma_f32_16x16x32_bf16 v[32:35], a[4:7], a[68:71], v[32:35]
    ds_read_b64_tr_b16 a[114:115], v14 offset:2048
    v_mfma_f32_16x16x32_bf16 v[40:43], a[4:7], a[76:79], v[40:43]
    ds_read_b64_tr_b16 a[116:117], v14 offset:16384
    v_mfma_f32_16x16x32_bf16 v[40:43], a[0:3], a[72:75], v[40:43]
    ds_read_b64_tr_b16 a[118:119], v14 offset:18432
    v_mfma_f32_16x16x32_bf16 v[44:47], a[8:11], a[72:75], v[44:47]
    ds_read_b64_tr_b16 a[120:121], v15 offset:0
    v_mfma_f32_16x16x32_bf16 v[44:47], a[12:15], a[76:79], v[44:47]
    ds_read_b64_tr_b16 a[122:123], v15 offset:2048
    v_mfma_f32_16x16x32_bf16 v[36:39], a[12:15], a[68:71], v[36:39]
    ds_read_b64_tr_b16 a[124:125], v15 offset:16384
    v_mfma_f32_16x16x32_bf16 v[36:39], a[8:11], a[64:67], v[36:39]
    ds_read_b64_tr_b16 a[126:127], v15 offset:18432
    v_mfma_f32_16x16x32_bf16 v[96:99], a[16:19], a[64:67], v[96:99]
    v_mfma_f32_16x16x32_bf16 v[96:99], a[20:23], a[68:71], v[96:99]
    v_mfma_f32_16x16x32_bf16 v[104:107], a[20:23], a[76:79], v[104:107]
    buffer_store_dwordx4 a[160:163], v2, s[24:27], s28 offen sc1
    v_mfma_f32_16x16x32_bf16 v[104:107], a[16:19], a[72:75], v[104:107]
    s_add_u32 s28, s28, s31
    s_waitcnt lgkmcnt(15)
    v_mfma_f32_16x16x32_bf16 v[108:111], a[24:27], a[72:75], v[108:111]
    v_xor_b32 v8, s60, v8
    v_xor_b32 v9, s60, v9
    v_mfma_f32_16x16x32_bf16 v[108:111], a[28:31], a[76:79], v[108:111]
    v_xor_b32 v10, s60, v10
    v_xor_b32 v11, s60, v11
    v_mfma_f32_16x16x32_bf16 v[100:103], a[28:31], a[68:71], v[100:103]
    v_xor_b32 v12, s60, v12
    v_xor_b32 v13, s60, v13
    v_mfma_f32_16x16x32_bf16 v[100:103], a[24:27], a[64:67], v[100:103]
    v_xor_b32 v14, s60, v14
    v_xor_b32 v15, s60, v15
    v_mfma_f32_16x16x32_bf16 v[160:163], a[32:35], a[64:67], v[160:163]
    buffer_store_dwordx4 a[164:167], v2, s[24:27], s28 offen sc1
    v_mfma_f32_16x16x32_bf16 v[160:163], a[36:39], a[68:71], v[160:163]
    s_add_u32 s28, s28, s31
    v_mfma_f32_16x16x32_bf16 v[168:171], a[36:39], a[76:79], v[168:171]
    v_mfma_f32_16x16x32_bf16 v[168:171], a[32:35], a[72:75], v[168:171]
    s_waitcnt lgkmcnt(14)
    v_mfma_f32_16x16x32_bf16 v[172:175], a[40:43], a[72:75], v[172:175]
    v_mfma_f32_16x16x32_bf16 v[172:175], a[44:47], a[76:79], v[172:175]
    v_mfma_f32_16x16x32_bf16 v[164:167], a[44:47], a[68:71], v[164:167]
    buffer_store_dwordx4 a[168:171], v2, s[24:27], s28 offen sc1
    v_mfma_f32_16x16x32_bf16 v[164:167], a[40:43], a[64:67], v[164:167]
    s_add_u32 s28, s28, s31
    s_waitcnt lgkmcnt(11)
    v_mfma_f32_16x16x32_bf16 v[224:227], a[48:51], a[64:67], v[224:227]
    v_mfma_f32_16x16x32_bf16 v[224:227], a[52:55], a[68:71], v[224:227]
    v_mfma_f32_16x16x32_bf16 v[232:235], a[52:55], a[76:79], v[232:235]
    v_mfma_f32_16x16x32_bf16 v[232:235], a[48:51], a[72:75], v[232:235]
    s_waitcnt lgkmcnt(8)
    v_mfma_f32_16x16x32_bf16 v[236:239], a[56:59], a[72:75], v[236:239]
    buffer_store_dwordx4 a[172:175], v2, s[24:27], s28 offen sc1
    v_mfma_f32_16x16x32_bf16 v[236:239], a[60:63], a[76:79], v[236:239]
    s_add_u32 s28, s28, s31
    v_mfma_f32_16x16x32_bf16 v[228:231], a[60:63], a[68:71], v[228:231]
    s_waitcnt vmcnt(16) lgkmcnt(0)
    v_mfma_f32_16x16x32_bf16 v[228:231], a[56:59], a[64:67], v[228:231]
    s_barrier
    v_mfma_f32_16x16x32_bf16 v[48:51], a[0:3], a[80:83], v[48:51]
    ds_read_b64_tr_b16 a[64:65], v8 offset:0
    v_mfma_f32_16x16x32_bf16 v[48:51], a[4:7], a[84:87], v[48:51]
    s_add_u32 m0, s62, 0
    v_mfma_f32_16x16x32_bf16 v[56:59], a[4:7], a[92:95], v[56:59]
    buffer_load_dwordx4 v18, s[44:47], s52 offen offset:0 sc1 lds
    v_mfma_f32_16x16x32_bf16 v[56:59], a[0:3], a[88:91], v[56:59]
    ds_read_b64_tr_b16 a[66:67], v8 offset:2048
    v_mfma_f32_16x16x32_bf16 v[60:63], a[8:11], a[88:91], v[60:63]
    s_add_u32 s64, s64, 32768
    v_mfma_f32_16x16x32_bf16 v[60:63], a[12:15], a[92:95], v[60:63]
    s_cmp_ge_u32 s64, 98304
    s_cselect_b32 s63, 4294901760, s59
    s_cselect_b32 s64, 0, s64
    v_mfma_f32_16x16x32_bf16 v[52:55], a[12:15], a[84:87], v[52:55]
    buffer_load_dwordx4 v19, s[44:47], s52 offen offset:1024 sc1 lds
    v_mfma_f32_16x16x32_bf16 v[52:55], a[8:11], a[80:83], v[52:55]
    s_add_u32 s52, s52, s56
    ds_read_b64_tr_b16 a[68:69], v8 offset:16384
    v_mfma_f32_16x16x32_bf16 v[112:115], a[16:19], a[80:83], v[112:115]
    v_mfma_f32_16x16x32_bf16 v[112:115], a[20:23], a[84:87], v[112:115]
    v_mfma_f32_16x16x32_bf16 v[120:123], a[20:23], a[92:95], v[120:123]
    buffer_load_dwordx4 v18, s[44:47], s53 offen offset:2048 sc1 lds
    v_mfma_f32_16x16x32_bf16 v[120:123], a[16:19], a[88:91], v[120:123]
    ds_read_b64_tr_b16 a[70:71], v8 offset:18432
    v_mfma_f32_16x16x32_bf16 v[124:127], a[24:27], a[88:91], v[124:127]
    v_mfma_f32_16x16x32_bf16 v[124:127], a[28:31], a[92:95], v[124:127]
    v_mfma_f32_16x16x32_bf16 v[116:119], a[28:31], a[84:87], v[116:119]
    buffer_load_dwordx4 v19, s[44:47], s53 offen offset:3072 sc1 lds
    v_mfma_f32_16x16x32_bf16 v[116:119], a[24:27], a[80:83], v[116:119]
    s_add_u32 s53, s53, s56
    ds_read_b64_tr_b16 a[72:73], v9 offset:0
    v_mfma_f32_16x16x32_bf16 v[176:179], a[32:35], a[80:83], v[176:179]
    v_mfma_f32_16x16x32_bf16 v[176:179], a[36:39], a[84:87], v[176:179]
    s_add_u32 m0, s62, 4096
    v_mfma_f32_16x16x32_bf16 v[184:187], a[36:39], a[92:95], v[184:187]
    buffer_load_dwordx4 v20, s[44:47], s54 offen offset:0 sc1 lds
    v_mfma_f32_16x16x32_bf16 v[184:187], a[32:35], a[88:91], v[184:187]
    s_xor_b32 s62, s62, 229376
    ds_read_b64_tr_b16 a[74:75], v9 offset:2048
    v_mfma_f32_16x16x32_bf16 v[188:191], a[40:43], a[88:91], v[188:191]
    v_mfma_f32_16x16x32_bf16 v[188:191], a[44:47], a[92:95], v[188:191]
    v_mfma_f32_16x16x32_bf16 v[180:183], a[44:47], a[84:87], v[180:183]
    buffer_load_dwordx4 v21, s[44:47], s54 offen offset:1024 sc1 lds
    v_mfma_f32_16x16x32_bf16 v[180:183], a[40:43], a[80:83], v[180:183]
    s_add_u32 s54, s54, s56
    ds_read_b64_tr_b16 a[76:77], v9 offset:16384
    v_mfma_f32_16x16x32_bf16 v[240:243], a[48:51], a[80:83], v[240:243]
    v_mfma_f32_16x16x32_bf16 v[240:243], a[52:55], a[84:87], v[240:243]
    v_mfma_f32_16x16x32_bf16 v[248:251], a[52:55], a[92:95], v[248:251]
    buffer_load_dwordx4 v20, s[44:47], s55 offen offset:2048 sc1 lds
    v_mfma_f32_16x16x32_bf16 v[248:251], a[48:51], a[88:91], v[248:251]
    ds_read_b64_tr_b16 a[78:79], v9 offset:18432
    v_mfma_f32_16x16x32_bf16 v[252:255], a[56:59], a[88:91], v[252:255]
    v_add_u32 v6, s63, v6
    v_add_u32 v7, s63, v7
    v_mfma_f32_16x16x32_bf16 v[252:255], a[60:63], a[92:95], v[252:255]
    v_mfma_f32_16x16x32_bf16 v[244:247], a[60:63], a[84:87], v[244:247]
    buffer_load_dwordx4 v21, s[44:47], s55 offen offset:3072 sc1 lds
    v_mfma_f32_16x16x32_bf16 v[244:247], a[56:59], a[80:83], v[244:247]
    s_add_u32 s55, s55, s56
    v_mfma_f32_16x16x32_bf16 v[64:67], a[0:3], a[96:99], v[64:67]
    ds_read_b64_tr_b16 a[80:81], v10 offset:0
    v_mfma_f32_16x16x32_bf16 v[64:67], a[4:7], a[100:103], v[64:67]
    v_mfma_f32_16x16x32_bf16 v[72:75], a[4:7], a[108:111], v[72:75]
    v_mfma_f32_16x16x32_bf16 v[72:75], a[0:3], a[104:107], v[72:75]
    s_add_u32 m0, s61, 0
    ds_read_b64_tr_b16 a[82:83], v10 offset:2048
    v_mfma_f32_16x16x32_bf16 v[76:79], a[8:11], a[104:107], v[76:79]
    buffer_load_dwordx4 v16, s[40:43], s48 offen offset:0 sc1 lds
    v_mfma_f32_16x16x32_bf16 v[76:79], a[12:15], a[108:111], v[76:79]
    v_mfma_f32_16x16x32_bf16 v[68:71], a[12:15], a[100:103], v[68:71]
    ds_read_b64_tr_b16 a[84:85], v10 offset:16384
    v_mfma_f32_16x16x32_bf16 v[68:71], a[8:11], a[96:99], v[68:71]
    v_mfma_f32_16x16x32_bf16 v[128:131], a[16:19], a[96:99], v[128:131]
    buffer_store_dwordx4 a[176:179], v2, s[24:27], s28 offen sc1
    v_mfma_f32_16x16x32_bf16 v[128:131], a[20:23], a[100:103], v[128:131]
    s_add_u32 s28, s28, s31
    ds_read_b64_tr_b16 a[86:87], v10 offset:18432
    v_mfma_f32_16x16x32_bf16 v[136:139], a[20:23], a[108:111], v[136:139]
    v_mfma_f32_16x16x32_bf16 v[136:139], a[16:19], a[104:107], v[136:139]
    v_mfma_f32_16x16x32_bf16 v[140:143], a[24:27], a[104:107], v[140:143]
    buffer_load_dwordx4 v17, s[40:43], s48 offen offset:1024 sc1 lds
    v_mfma_f32_16x16x32_bf16 v[140:143], a[28:31], a[108:111], v[140:143]
    s_add_u32 s48, s48, 128
    ds_read_b64_tr_b16 a[88:89], v11 offset:0
    v_mfma_f32_16x16x32_bf16 v[132:135], a[28:31], a[100:103], v[132:135]
    v_mfma_f32_16x16x32_bf16 v[132:135], a[24:27], a[96:99], v[132:135]
    v_mfma_f32_16x16x32_bf16 v[192:195], a[32:35], a[96:99], v[192:195]
    buffer_store_dwordx4 a[180:183], v2, s[24:27], s28 offen sc1
    v_mfma_f32_16x16x32_bf16 v[192:195], a[36:39], a[100:103], v[192:195]
    s_add_u32 s28, s28, s31
    ds_read_b64_tr_b16 a[90:91], v11 offset:2048
    v_mfma_f32_16x16x32_bf16 v[200:203], a[36:39], a[108:111], v[200:203]
    v_mfma_f32_16x16x32_bf16 v[200:203], a[32:35], a[104:107], v[200:203]
    v_mfma_f32_16x16x32_bf16 v[204:207], a[40:43], a[104:107], v[204:207]
    buffer_load_dwordx4 v16, s[40:43], s49 offen offset:2048 sc1 lds
    v_mfma_f32_16x16x32_bf16 v[204:207], a[44:47], a[108:111], v[204:207]
    ds_read_b64_tr_b16 a[92:93], v11 offset:16384
    v_mfma_f32_16x16x32_bf16 v[196:199], a[44:47], a[100:103], v[196:199]
    v_mfma_f32_16x16x32_bf16 v[196:199], a[40:43], a[96:99], v[196:199]
    v_mfma_f32_16x16x32_bf16 a[224:227], a[48:51], a[96:99], a[224:227]
    buffer_store_dwordx4 a[184:187], v2, s[24:27], s28 offen sc1
    v_mfma_f32_16x16x32_bf16 a[224:227], a[52:55], a[100:103], a[224:227]
    s_add_u32 s28, s28, s31
    ds_read_b64_tr_b16 a[94:95], v11 offset:18432
    v_mfma_f32_16x16x32_bf16 a[232:235], a[52:55], a[108:111], a[232:235]
    v_mfma_f32_16x16x32_bf16 a[232:235], a[48:51], a[104:107], a[232:235]
    v_mfma_f32_16x16x32_bf16 a[236:239], a[56:59], a[104:107], a[236:239]
    buffer_load_dwordx4 v17, s[40:43], s49 offen offset:3072 sc1 lds
    v_mfma_f32_16x16x32_bf16 a[236:239], a[60:63], a[108:111], a[236:239]
    s_add_u32 s49, s49, 128
    v_mfma_f32_16x16x32_bf16 a[228:231], a[60:63], a[100:103], a[228:231]
    buffer_store_dwordx4 a[188:191], v2, s[24:27], s28 offen sc1
    v_mfma_f32_16x16x32_bf16 a[228:231], a[56:59], a[96:99], a[228:231]
    s_add_u32 s29, s29, s30
    s_mov_b32 s28, s29
    v_mfma_f32_16x16x32_bf16 v[80:83], a[0:3], a[112:115], v[80:83]
    v_mfma_f32_16x16x32_bf16 v[80:83], a[4:7], a[116:119], v[80:83]
    ds_read_b64_tr_b16 a[96:97], v12 offset:0
    v_mfma_f32_16x16x32_bf16 v[88:91], a[4:7], a[124:127], v[88:91]
    v_mfma_f32_16x16x32_bf16 v[88:91], a[0:3], a[120:123], v[88:91]
    s_add_u32 m0, s61, 4096
    ds_read_b128 a[0:3], v6 offset:0
    v_mfma_f32_16x16x32_bf16 v[92:95], a[8:11], a[120:123], v[92:95]
    buffer_load_dwordx4 v16, s[40:43], s50 offen offset:0 sc1 lds
    v_mfma_f32_16x16x32_bf16 v[92:95], a[12:15], a[124:127], v[92:95]
    s_add_u32 s61, s61, 32768
    ds_read_b128 a[4:7], v7 offset:0
    v_mfma_f32_16x16x32_bf16 v[84:87], a[12:15], a[116:119], v[84:87]
    s_cmp_ge_u32 s61, 98304
    s_cselect_b32 s90, 98304, 0
    ds_read_b64_tr_b16 a[98:99], v12 offset:2048
    v_mfma_f32_16x16x32_bf16 v[84:87], a[8:11], a[112:115], v[84:87]
    s_sub_u32 s61, s61, s90
    ds_read_b128 a[8:11], v6 offset:2048
    v_mfma_f32_16x16x32_bf16 v[144:147], a[16:19], a[112:115], v[144:147]
    ds_read_b128 a[12:15], v7 offset:2048
    v_mfma_f32_16x16x32_bf16 v[144:147], a[20:23], a[116:119], v[144:147]
    ds_read_b64_tr_b16 a[100:101], v12 offset:16384
    v_mfma_f32_16x16x32_bf16 v[152:155], a[20:23], a[124:127], v[152:155]
    v_mfma_f32_16x16x32_bf16 v[152:155], a[16:19], a[120:123], v[152:155]
    ds_read_b128 a[16:19], v6 offset:4096
    v_mfma_f32_16x16x32_bf16 v[156:159], a[24:27], a[120:123], v[156:159]
    buffer_load_dwordx4 v17, s[40:43], s50 offen offset:1024 sc1 lds
    v_mfma_f32_16x16x32_bf16 v[156:159], a[28:31], a[124:127], v[156:159]
    s_add_u32 s50, s50, 128
    ds_read_b128 a[20:23], v7 offset:4096
    v_mfma_f32_16x16x32_bf16 v[148:151], a[28:31], a[116:119], v[148:151]
    ds_read_b64_tr_b16 a[102:103], v12 offset:18432
    v_mfma_f32_16x16x32_bf16 v[148:151], a[24:27], a[112:115], v[148:151]
    ds_read_b128 a[24:27], v6 offset:6144
    v_mfma_f32_16x16x32_bf16 v[208:211], a[32:35], a[112:115], v[208:211]
    s_sub_u32 s65, s65, 1
    ds_read_b128 a[28:31], v7 offset:6144
    v_mfma_f32_16x16x32_bf16 v[208:211], a[36:39], a[116:119], v[208:211]
    ds_read_b64_tr_b16 a[104:105], v13 offset:0
    v_mfma_f32_16x16x32_bf16 v[216:219], a[36:39], a[124:127], v[216:219]
    v_mfma_f32_16x16x32_bf16 v[216:219], a[32:35], a[120:123], v[216:219]
    ds_read_b128 a[32:35], v6 offset:8192
    v_mfma_f32_16x16x32_bf16 v[220:223], a[40:43], a[120:123], v[220:223]
    buffer_load_dwordx4 v16, s[40:43], s51 offen offset:2048 sc1 lds
    v_mfma_f32_16x16x32_bf16 v[220:223], a[44:47], a[124:127], v[220:223]
    ds_read_b128 a[36:39], v7 offset:8192
    v_mfma_f32_16x16x32_bf16 v[212:215], a[44:47], a[116:119], v[212:215]
    ds_read_b64_tr_b16 a[106:107], v13 offset:2048
    v_mfma_f32_16x16x32_bf16 v[212:215], a[40:43], a[112:115], v[212:215]
    ds_read_b128 a[40:43], v6 offset:10240
    v_mfma_f32_16x16x32_bf16 a[240:243], a[48:51], a[112:115], a[240:243]
    ds_read_b128 a[44:47], v7 offset:10240
    v_mfma_f32_16x16x32_bf16 a[240:243], a[52:55], a[116:119], a[240:243]
    ds_read_b64_tr_b16 a[108:109], v13 offset:16384
    v_mfma_f32_16x16x32_bf16 a[248:251], a[52:55], a[124:127], a[248:251]
    v_mfma_f32_16x16x32_bf16 a[248:251], a[48:51], a[120:123], a[248:251]
    ds_read_b128 a[48:51], v6 offset:12288
    v_mfma_f32_16x16x32_bf16 a[252:255], a[56:59], a[120:123], a[252:255]
    buffer_load_dwordx4 v17, s[40:43], s51 offen offset:3072 sc1 lds
    v_mfma_f32_16x16x32_bf16 a[252:255], a[60:63], a[124:127], a[252:255]
    s_add_u32 s51, s51, 128
    ds_read_b128 a[52:55], v7 offset:12288
    v_mfma_f32_16x16x32_bf16 a[244:247], a[60:63], a[116:119], a[244:247]
    ds_read_b64_tr_b16 a[110:111], v13 offset:18432
    v_mfma_f32_16x16x32_bf16 a[244:247], a[56:59], a[112:115], a[244:247]
    ds_read_b128 a[56:59], v6 offset:14336
    ds_read_b128 a[60:63], v7 offset:14336
    s_cmp_eq_u32 s66, 2
    s_cbranch_scc1 m_hook23
m_hookr24:
    s_waitcnt lgkmcnt(15)
    v_mfma_f32_16x16x32_bf16 v[32:35], a[0:3], a[64:67], v[32:35]
    ds_read_b64_tr_b16 a[112:113], v14 offset:0
    v_mfma_f32_16x16x32_bf16 v[32:35], a[4:7], a[68:71], v[32:35]
    ds_read_b64_tr_b16 a[114:115], v14 offset:2048
    v_mfma_f32_16x16x32_bf16 v[40:43], a[4:7], a[76:79], v[40:43]
    ds_read_b64_tr_b16 a[116:117], v14 offset:16384
    v_mfma_f32_16x16x32_bf16 v[40:43], a[0:3], a[72:75], v[40:43]
    ds_read_b64_tr_b16 a[118:119], v14 offset:18432
    v_mfma_f32_16x16x32_bf16 v[44:47], a[8:11], a[72:75], v[44:47]
    ds_read_b64_tr_b16 a[120:121], v15 offset:0
    v_mfma_f32_16x16x32_bf16 v[44:47], a[12:15], a[76:79], v[44:47]
    ds_read_b64_tr_b16 a[122:123], v15 offset:2048
    v_mfma_f32_16x16x32_bf16 v[36:39], a[12:15], a[68:71], v[36:39]
    ds_read_b64_tr_b16 a[124:125], v15 offset:16384
    v_mfma_f32_16x16x32_bf16 v[36:39], a[8:11], a[64:67], v[36:39]
    ds_read_b64_tr_b16 a[126:127], v15 offset:18432
    v_mfma_f32_16x16x32_bf16 v[96:99], a[16:19], a[64:67], v[96:99]
    v_mfma_f32_16x16x32_bf16 v[96:99], a[20:23], a[68:71], v[96:99]
    v_mfma_f32_16x16x32_bf16 v[104:107], a[20:23], a[76:79], v[104:107]
    buffer_store_dwordx4 a[192:195], v2, s[24:27], s28 offen sc1
    v_mfma_f32_16x16x32_bf16 v[104:107], a[16:19], a[72:75], v[104:107]
    s_add_u32 s28, s28, s31
    s_waitcnt lgkmcnt(15)
    v_mfma_f32_16x16x32_bf16 v[108:111], a[24:27], a[72:75], v[108:111]
    v_xor_b32 v8, s60, v8
    v_xor_b32 v9, s60, v9
    v_mfma_f32_16x16x32_bf16 v[108:111], a[28:31], a[76:79], v[108:111]
    v_xor_b32 v10, s60, v10
    v_xor_b32 v11, s60, v11
    v_mfma_f32_16x16x32_bf16 v[100:103], a[28:31], a[68:71], v[100:103]
    v_xor_b32 v12, s60, v12
    v_xor_b32 v13, s60, v13
    v_mfma_f32_16x16x32_bf16 v[100:103], a[24:27], a[64:67], v[100:103]
    v_xor_b32 v14, s60, v14
    v_xor_b32 v15, s60, v15
    v_mfma_f32_16x16x32_bf16 v[160:163], a[32:35], a[64:67], v[160:163]
    buffer_store_dwordx4 a[196:199], v2, s[24:27], s28 offen sc1
    v_mfma_f32_16x16x32_bf16 v[160:163], a[36:39], a[68:71], v[160:163]
    s_add_u32 s28, s28, s31
    v_mfma_f32_16x16x32_bf16 v[168:171], a[36:39], a[76:79], v[168:171]
    v_mfma_f32_16x16x32_bf16 v[168:171], a[32:35], a[72:75], v[168:171]
    s_waitcnt lgkmcnt(14)
    v_mfma_f32_16x16x32_bf16 v[172:175], a[40:43], a[72:75], v[172:175]
    v_mfma_f32_16x16x32_bf16 v[172:175], a[44:47], a[76:79], v[172:175]
    v_mfma_f32_16x16x32_bf16 v[164:167], a[44:47], a[68:71], v[164:167]
    buffer_store_dwordx4 a[200:203], v2, s[24:27], s28 offen sc1
    v_mfma_f32_16x16x32_bf16 v[164:167], a[40:43], a[64:67], v[164:167]
    s_add_u32 s28, s28, s31
    s_waitcnt lgkmcnt(11)
    v_mfma_f32_16x16x32_bf16 v[224:227], a[48:51], a[64:67], v[224:227]
    v_mfma_f32_16x16x32_bf16 v[224:227], a[52:55], a[68:71], v[224:227]
    v_mfma_f32_16x16x32_bf16 v[232:235], a[52:55], a[76:79], v[232:235]
    v_mfma_f32_16x16x32_bf16 v[232:235], a[48:51], a[72:75], v[232:235]
    s_waitcnt lgkmcnt(8)
    v_mfma_f32_16x16x32_bf16 v[236:239], a[56:59], a[72:75], v[236:239]
    buffer_store_dwordx4 a[204:207], v2, s[24:27], s28 offen sc1
    v_mfma_f32_16x16x32_bf16 v[236:239], a[60:63], a[76:79], v[236:239]
    s_add_u32 s28, s28, s31
    v_mfma_f32_16x16x32_bf16 v[228:231], a[60:63], a[68:71], v[228:231]
    s_waitcnt vmcnt(16) lgkmcnt(0)
    v_mfma_f32_16x16x32_bf16 v[228:231], a[56:59], a[64:67], v[228:231]
    s_barrier
    v_mfma_f32_16x16x32_bf16 v[48:51], a[0:3], a[80:83], v[48:51]
    ds_read_b64_tr_b16 a[64:65], v8 offset:0
    v_mfma_f32_16x16x32_bf16 v[48:51], a[4:7], a[84:87], v[48:51]
    s_add_u32 m0, s62, 0
    v_mfma_f32_16x16x32_bf16 v[56:59], a[4:7], a[92:95], v[56:59]
    buffer_load_dwordx4 v18, s[44:47], s52 offen offset:0 sc1 lds
    v_mfma_f32_16x16x32_bf16 v[56:59], a[0:3], a[88:91], v[56:59]
    ds_read_b64_tr_b16 a[66:67], v8 offset:2048
    v_mfma_f32_16x16x32_bf16 v[60:63], a[8:11], a[88:91], v[60:63]
    s_add_u32 s64, s64, 32768
    v_mfma_f32_16x16x32_bf16 v[60:63], a[12:15], a[92:95], v[60:63]
    s_cmp_ge_u32 s64, 98304
    s_cselect_b32 s63, 4294901760, s59
    s_cselect_b32 s64, 0, s64
    v_mfma_f32_16x16x32_bf16 v[52:55], a[12:15], a[84:87], v[52:55]
    buffer_load_dwordx4 v19, s[44:47], s52 offen offset:1024 sc1 lds
    v_mfma_f32_16x16x32_bf16 v[52:55], a[8:11], a[80:83], v[52:55]
    s_add_u32 s52, s52, s56
    ds_read_b64_tr_b16 a[68:69], v8 offset:16384
    v_mfma_f32_16x16x32_bf16 v[112:115], a[16:19], a[80:83], v[112:115]
    v_mfma_f32_16x16x32_bf16 v[112:115], a[20:23], a[84:87], v[112:115]
    v_mfma_f32_16x16x32_bf16 v[120:123], a[20:23], a[92:95], v[120:123]
    buffer_load_dwordx4 v18, s[44:47], s53 offen offset:2048 sc1 lds
    v_mfma_f32_16x16x32_bf16 v[120:123], a[16:19], a[88:91], v[120:123]
    ds_read_b64_tr_b16 a[70:71], v8 offset:18432
    v_mfma_f32_16x16x32_bf16 v[124:127], a[24:27], a[88:91], v[124:127]
    v_mfma_f32_16x16x32_bf16 v[124:127], a[28:31], a[92:95], v[124:127]
    v_mfma_f32_16x16x32_bf16 v[116:119], a[28:31], a[84:87], v[116:119]
    buffer_load_dwordx4 v19, s[44:47], s53 offen offset:3072 sc1 lds
    v_mfma_f32_16x16x32_bf16 v[116:119], a[24:27], a[80:83], v[116:119]
    s_add_u32 s53, s53, s56
    ds_read_b64_tr_b16 a[72:73], v9 offset:0
    v_mfma_f32_16x16x32_bf16 v[176:179], a[32:35], a[80:83], v[176:179]
    v_mfma_f32_16x16x32_bf16 v[176:179], a[36:39], a[84:87], v[176:179]
    s_add_u32 m0, s62, 4096
    v_mfma_f32_16x16x32_bf16 v[184:187], a[36:39], a[92:95], v[184:187]
    buffer_load_dwordx4 v20, s[44:47], s54 offen offset:0 sc1 lds
    v_mfma_f32_16x16x32_bf16 v[184:187], a[32:35], a[88:91], v[184:187]
    s_xor_b32 s62, s62, 229376
    ds_read_b64_tr_b16 a[74:75], v9 offset:2048
    v_mfma_f32_16x16x32_bf16 v[188:191], a[40:43], a[88:91], v[188:191]
    v_mfma_f32_16x16x32_bf16 v[188:191], a[44:47], a[92:95], v[188:191]
    v_mfma_f32_16x16x32_bf16 v[180:183], a[44:47], a[84:87], v[180:183]
    buffer_load_dwordx4 v21, s[44:47], s54 offen offset:1024 sc1 lds
    v_mfma_f32_16x16x32_bf16 v[180:183], a[40:43], a[80:83], v[180:183]
    s_add_u32 s54, s54, s56
    ds_read_b64_tr_b16 a[76:77], v9 offset:16384
    v_mfma_f32_16x16x32_bf16 v[240:243], a[48:51], a[80:83], v[240:243]
    v_mfma_f32_16x16x32_bf16 v[240:243], a[52:55], a[84:87], v[240:243]
    v_mfma_f32_16x16x32_bf16 v[248:251], a[52:55], a[92:95], v[248:251]
    buffer_load_dwordx4 v20, s[44:47], s55 offen offset:2048 sc1 lds
    v_mfma_f32_16x16x32_bf16 v[248:251], a[48:51], a[88:91], v[248:251]
    ds_read_b64_tr_b16 a[78:79], v9 offset:18432
    v_mfma_f32_16x16x32_bf16 v[252:255], a[56:59], a[88:91], v[252:255]
    v_add_u32 v6, s63, v6
    v_add_u32 v7, s63, v7
    v_mfma_f32_16x16x32_bf16 v[252:255], a[60:63], a[92:95], v[252:255]
    v_mfma_f32_16x16x32_bf16 v[244:247], a[60:63], a[84:87], v[244:247]
    buffer_load_dwordx4 v21, s[44:47], s55 offen offset:3072 sc1 lds
    v_mfma_f32_16x16x32_bf16 v[244:247], a[56:59], a[80:83], v[244:247]
    s_add_u32 s55, s55, s56
    v_mfma_f32_16x16x32_bf16 v[64:67], a[0:3], a[96:99], v[64:67]
    ds_read_b64_tr_b16 a[80:81], v10 offset:0
    v_mfma_f32_16x16x32_bf16 v[64:67], a[4:7], a[100:103], v[64:67]
    v_mfma_f32_16x16x32_bf16 v[72:75], a[4:7], a[108:111], v[72:75]
    v_mfma_f32_16x16x32_bf16 v[72:75], a[0:3], a[104:107], v[72:75]
    s_add_u32 m0, s61, 0
    ds_read_b64_tr_b16 a[82:83], v10 offset:2048
    v_mfma_f32_16x16x32_bf16 v[76:79], a[8:11], a[104:107], v[76:79]
    buffer_load_dwordx4 v16, s[40:43], s48 offen offset:0 sc1 lds
    v_mfma_f32_16x16x32_bf16 v[76:79], a[12:15], a[108:111], v[76:79]
    v_mfma_f32_16x16x32_bf16 v[68:71], a[12:15], a[100:103], v[68:71]
    ds_read_b64_tr_b16 a[84:85], v10 offset:16384
    v_mfma_f32_16x16x32_bf16 v[68:71], a[8:11], a[96:99], v[68:71]
    v_mfma_f32_16x16x32_bf16 v[128:131], a[16:19], a[96:99], v[128:131]
    buffer_store_dwordx4 a[208:211], v2, s[24:27], s28 offen sc1
    v_mfma_f32_16x16x32_bf16 v[128:131], a[20:23], a[100:103], v[128:131]
    s_add_u32 s28, s28, s31
    ds_read_b64_tr_b16 a[86:87], v10 offset:18432
    v_mfma_f32_16x16x32_bf16 v[136:139], a[20:23], a[108:111], v[136:139]
    v_mfma_f32_16x16x32_bf16 v[136:139], a[16:19], a[104:107], v[136:139]
    v_mfma_f32_16x16x32_bf16 v[140:143], a[24:27], a[104:107], v[140:143]
    buffer_load_dwordx4 v17, s[40:43], s48 offen offset:1024 sc1 lds
    v_mfma_f32_16x16x32_bf16 v[140:143], a[28:31], a[108:111], v[140:143]
    s_add_u32 s48, s48, 128
    ds_read_b64_tr_b16 a[88:89], v11 offset:0
    v_mfma_f32_16x16x32_bf16 v[132:135], a[28:31], a[100:103], v[132:135]
    v_mfma_f32_16x16x32_bf16 v[132:135], a[24:27], a[96:99], v[132:135]
    v_mfma_f32_16x16x32_bf16 v[192:195], a[32:35], a[96:99], v[192:195]
    buffer_store_dwordx4 a[212:215], v2, s[24:27], s28 offen sc1
    v_mfma_f32_16x16x32_bf16 v[192:195], a[36:39], a[100:103], v[192:195]
    s_add_u32 s28, s28, s31
    ds_read_b64_tr_b16 a[90:91], v11 offset:2048
    v_mfma_f32_16x16x32_bf16 v[200:203], a[36:39], a[108:111], v[200:203]
    v_mfma_f32_16x16x32_bf16 v[200:203], a[32:35], a[104:107], v[200:203]
    v_mfma_f32_16x16x32_bf16 v[204:207], a[40:43], a[104:107], v[204:207]
    buffer_load_dwordx4 v16, s[40:43], s49 offen offset:2048 sc1 lds
    v_mfma_f32_16x16x32_bf16 v[204:207], a[44:47], a[108:111], v[204:207]
    ds_read_b64_tr_b16 a[92:93], v11 offset:16384
    v_mfma_f32_16x16x32_bf16 v[196:199], a[44:47], a[100:103], v[196:199]
    v_mfma_f32_16x16x32_bf16 v[196:199], a[40:43], a[96:99], v[196:199]
    v_mfma_f32_16x16x32_bf16 a[224:227], a[48:51], a[96:99], a[224:227]
    buffer_store_dwordx4 a[216:219], v2, s[24:27], s28 offen sc1
    v_mfma_f32_16x16x32_bf16 a[224:227], a[52:55], a[100:103], a[224:227]
    s_add_u32 s28, s28, s31
    ds_read_b64_tr_b16 a[94:95], v11 offset:18432
    v_mfma_f32_16x16x32_bf16 a[232:235], a[52:55], a[108:111], a[232:235]
    v_mfma_f32_16x16x32_bf16 a[232:235], a[48:51], a[104:107], a[232:235]
    v_mfma_f32_16x16x32_bf16 a[236:239], a[56:59], a[104:107], a[236:239]
    buffer_load_dwordx4 v17, s[40:43], s49 offen offset:3072 sc1 lds
    v_mfma_f32_16x16x32_bf16 a[236:239], a[60:63], a[108:111], a[236:239]
    s_add_u32 s49, s49, 128
    v_mfma_f32_16x16x32_bf16 a[228:231], a[60:63], a[100:103], a[228:231]
    buffer_store_dwordx4 a[220:223], v2, s[24:27], s28 offen sc1
    v_mfma_f32_16x16x32_bf16 a[228:231], a[56:59], a[96:99], a[228:231]
    s_add_u32 s29, s29, s30
    s_mov_b32 s28, s29
    v_mfma_f32_16x16x32_bf16 v[80:83], a[0:3], a[112:115], v[80:83]
    v_mfma_f32_16x16x32_bf16 v[80:83], a[4:7], a[116:119], v[80:83]
    ds_read_b64_tr_b16 a[96:97], v12 offset:0
    v_mfma_f32_16x16x32_bf16 v[88:91], a[4:7], a[124:127], v[88:91]
    v_mfma_f32_16x16x32_bf16 v[88:91], a[0:3], a[120:123], v[88:91]
    s_add_u32 m0, s61, 4096
    ds_read_b128 a[0:3], v6 offset:0
    v_mfma_f32_16x16x32_bf16 v[92:95], a[8:11], a[120:123], v[92:95]
    buffer_load_dwordx4 v16, s[40:43], s50 offen offset:0 sc1 lds
    v_mfma_f32_16x16x32_bf16 v[92:95], a[12:15], a[124:127], v[92:95]
    s_add_u32 s61, s61, 32768
    ds_read_b128 a[4:7], v7 offset:0
    v_mfma_f32_16x16x32_bf16 v[84:87], a[12:15], a[116:119], v[84:87]
    s_cmp_ge_u32 s61, 98304
    s_cselect_b32 s90, 98304, 0
    ds_read_b64_tr_b16 a[98:99], v12 offset:2048
    v_mfma_f32_16x16x32_bf16 v[84:87], a[8:11], a[112:115], v[84:87]
    s_sub_u32 s61, s61, s90
    ds_read_b128 a[8:11], v6 offset:2048
    v_mfma_f32_16x16x32_bf16 v[144:147], a[16:19], a[112:115], v[144:147]
    ds_read_b128 a[12:15], v7 offset:2048
    v_mfma_f32_16x16x32_bf16 v[144:147], a[20:23], a[116:119], v[144:147]
    ds_read_b64_tr_b16 a[100:101], v12 offset:16384
    v_mfma_f32_16x16x32_bf16 v[152:155], a[20:23], a[124:127], v[152:155]
    v_mfma_f32_16x16x32_bf16 v[152:155], a[16:19], a[120:123], v[152:155]
    ds_read_b128 a[16:19], v6 offset:4096
    v_mfma_f32_16x16x32_bf16 v[156:159], a[24:27], a[120:123], v[156:159]
    buffer_load_dwordx4 v17, s[40:43], s50 offen offset:1024 sc1 lds
    v_mfma_f32_16x16x32_bf16 v[156:159], a[28:31], a[124:127], v[156:159]
    s_add_u32 s50, s50, 128
    ds_read_b128 a[20:23], v7 offset:4096
    v_mfma_f32_16x16x32_bf16 v[148:151], a[28:31], a[116:119], v[148:151]
    ds_read_b64_tr_b16 a[102:103], v12 offset:18432
    v_mfma_f32_16x16x32_bf16 v[148:151], a[24:27], a[112:115], v[148:151]
    ds_read_b128 a[24:27], v6 offset:6144
    v_mfma_f32_16x16x32_bf16 v[208:211], a[32:35], a[112:115], v[208:211]
    s_sub_u32 s65, s65, 1
    ds_read_b128 a[28:31], v7 offset:6144
    v_mfma_f32_16x16x32_bf16 v[208:211], a[36:39], a[116:119], v[208:211]
    ds_read_b64_tr_b16 a[104:105], v13 offset:0
    v_mfma_f32_16x16x32_bf16 v[216:219], a[36:39], a[124:127], v[216:219]
    v_mfma_f32_16x16x32_bf16 v[216:219], a[32:35], a[120:123], v[216:219]
    ds_read_b128 a[32:35], v6 offset:8192
    v_mfma_f32_16x16x32_bf16 v[220:223], a[40:43], a[120:123], v[220:223]
    buffer_load_dwordx4 v16, s[40:43], s51 offen offset:2048 sc1 lds
    v_mfma_f32_16x16x32_bf16 v[220:223], a[44:47], a[124:127], v[220:223]
    ds_read_b128 a[36:39], v7 offset:8192
    v_mfma_f32_16x16x32_bf16 v[212:215], a[44:47], a[116:119], v[212:215]
    ds_read_b64_tr_b16 a[106:107], v13 offset:2048
    v_mfma_f32_16x16x32_bf16 v[212:215], a[40:43], a[112:115], v[212:215]
    ds_read_b128 a[40:43], v6 offset:10240
    v_mfma_f32_16x16x32_bf16 a[240:243], a[48:51], a[112:115], a[240:243]
    ds_read_b128 a[44:47], v7 offset:10240
    v_mfma_f32_16x16x32_bf16 a[240:243], a[52:55], a[116:119], a[240:243]
    ds_read_b64_tr_b16 a[108:109], v13 offset:16384
    v_mfma_f32_16x16x32_bf16 a[248:251], a[52:55], a[124:127], a[248:251]
    v_mfma_f32_16x16x32_bf16 a[248:251], a[48:51], a[120:123], a[248:251]
    ds_read_b128 a[48:51], v6 offset:12288
    v_mfma_f32_16x16x32_bf16 a[252:255], a[56:59], a[120:123], a[252:255]
    buffer_load_dwordx4 v17, s[40:43], s51 offen offset:3072 sc1 lds
    v_mfma_f32_16x16x32_bf16 a[252:255], a[60:63], a[124:127], a[252:255]
    s_add_u32 s51, s51, 128
    ds_read_b128 a[52:55], v7 offset:12288
    v_mfma_f32_16x16x32_bf16 a[244:247], a[60:63], a[116:119], a[244:247]
    ds_read_b64_tr_b16 a[110:111], v13 offset:18432
    v_mfma_f32_16x16x32_bf16 a[244:247], a[56:59], a[112:115], a[244:247]
    ds_read_b128 a[56:59], v6 offset:14336
    ds_read_b128 a[60:63], v7 offset:14336
.p2align 3
m_loop25:
    s_waitcnt lgkmcnt(15)
    v_mfma_f32_16x16x32_bf16 v[32:35], a[0:3], a[64:67], v[32:35]
    ds_read_b64_tr_b16 a[112:113], v14 offset:0
    v_mfma_f32_16x16x32_bf16 v[32:35], a[4:7], a[68:71], v[32:35]
    ds_read_b64_tr_b16 a[114:115], v14 offset:2048
    v_mfma_f32_16x16x32_bf16 v[40:43], a[4:7], a[76:79], v[40:43]
    ds_read_b64_tr_b16 a[116:117], v14 offset:16384
    v_mfma_f32_16x16x32_bf16 v[40:43], a[0:3], a[72:75], v[40:43]
    ds_read_b64_tr_b16 a[118:119], v14 offset:18432
    v_mfma_f32_16x16x32_bf16 v[44:47], a[8:11], a[72:75], v[44:47]
    ds_read_b64_tr_b16 a[120:121], v15 offset:0
    v_mfma_f32_16x16x32_bf16 v[44:47], a[12:15], a[76:79], v[44:47]
    ds_read_b64_tr_b16 a[122:123], v15 offset:2048
    v_mfma_f32_16x16x32_bf16 v[36:39], a[12:15], a[68:71], v[36:39]
    ds_read_b64_tr_b16 a[124:125], v15 offset:16384
    v_mfma_f32_16x16x32_bf16 v[36:39], a[8:11], a[64:67], v[36:39]
    ds_read_b64_tr_b16 a[126:127], v15 offset:18432
    v_mfma_f32_16x16x32_bf16 v[96:99], a[16:19], a[64:67], v[96:99]
    v_mfma_f32_16x16x32_bf16 v[96:99], a[20:23], a[68:71], v[96:99]
    v_mfma_f32_16x16x32_bf16 v[104:107], a[20:23], a[76:79], v[104:107]
    v_mfma_f32_16x16x32_bf16 v[104:107], a[16:19], a[72:75], v[104:107]
    s_waitcnt lgkmcnt(15)
    v_mfma_f32_16x16x32_bf16 v[108:111], a[24:27], a[72:75], v[108:111]
    v_xor_b32 v8, s60, v8
    v_xor_b32 v9, s60, v9
    v_mfma_f32_16x16x32_bf16 v[108:111], a[28:31], a[76:79], v[108:111]
    v_xor_b32 v10, s60, v10
    v_xor_b32 v11, s60, v11
    v_mfma_f32_16x16x32_bf16 v[100:103], a[28:31], a[68:71], v[100:103]
    v_xor_b32 v12, s60, v12
    v_xor_b32 v13, s60, v13
    v_mfma_f32_16x16x32_bf16 v[100:103], a[24:27], a[64:67], v[100:103]
    v_xor_b32 v14, s60, v14
    v_xor_b32 v15, s60, v15
    v_mfma_f32_16x16x32_bf16 v[160:163], a[32:35], a[64:67], v[160:163]
    v_mfma_f32_16x16x32_bf16 v[160:163], a[36:39], a[68:71], v[160:163]
    v_mfma_f32_16x16x32_bf16 v[168:171], a[36:39], a[76:79], v[168:171]
    v_mfma_f32_16x16x32_bf16 v[168:171], a[32:35], a[72:75], v[168:171]
    s_waitcnt lgkmcnt(14)
    v_mfma_f32_16x16x32_bf16 v[172:175], a[40:43], a[72:75], v[172:175]
    v_mfma_f32_16x16x32_bf16 v[172:175], a[44:47], a[76:79], v[172:175]
    v_mfma_f32_16x16x32_bf16 v[164:167], a[44:47], a[68:71], v[164:167]
    v_mfma_f32_16x16x32_bf16 v[164:167], a[40:43], a[64:67], v[164:167]
    s_waitcnt lgkmcnt(11)
    v_mfma_f32_16x16x32_bf16 v[224:227], a[48:51], a[64:67], v[224:227]
    v_mfma_f32_16x16x32_bf16 v[224:227], a[52:55], a[68:71], v[224:227]
    v_mfma_f32_16x16x32_bf16 v[232:235], a[52:55], a[76:79], v[232:235]
    v_mfma_f32_16x16x32_bf16 v[232:235], a[48:51], a[72:75], v[232:235]
    s_waitcnt lgkmcnt(8)
    v_mfma_f32_16x16x32_bf16 v[236:239], a[56:59], a[72:75], v[236:239]
    v_mfma_f32_16x16x32_bf16 v[236:239], a[60:63], a[76:79], v[236:239]
    v_mfma_f32_16x16x32_bf16 v[228:231], a[60:63], a[68:71], v[228:231]
    s_waitcnt vmcnt(8) lgkmcnt(0)
    v_mfma_f32_16x16x32_bf16 v[228:231], a[56:59], a[64:67], v[228:231]
    s_barrier
    v_mfma_f32_16x16x32_bf16 v[48:51], a[0:3], a[80:83], v[48:51]
    ds_read_b64_tr_b16 a[64:65], v8 offset:0
    v_mfma_f32_16x16x32_bf16 v[48:51], a[4:7], a[84:87], v[48:51]
    s_add_u32 m0, s62, 0
    v_mfma_f32_16x16x32_bf16 v[56:59], a[4:7], a[92:95], v[56:59]
    buffer_load_dwordx4 v18, s[44:47], s52 offen offset:0 sc1 lds
    v_mfma_f32_16x16x32_bf16 v[56:59], a[0:3], a[88:91], v[56:59]
    ds_read_b64_tr_b16 a[66:67], v8 offset:2048
    v_mfma_f32_16x16x32_bf16 v[60:63], a[8:11], a[88:91], v[60:63]
    s_add_u32 s64, s64, 32768
    v_mfma_f32_16x16x32_bf16 v[60:63], a[12:15], a[92:95], v[60:63]
    s_cmp_ge_u32 s64, 98304
    s_cselect_b32 s63, 4294901760, s59
    s_cselect_b32 s64, 0, s64
    v_mfma_f32_16x16x32_bf16 v[52:55], a[12:15], a[84:87], v[52:55]
    buffer_load_dwordx4 v19, s[44:47], s52 offen offset:1024 sc1 lds
    v_mfma_f32_16x16x32_bf16 v[52:55], a[8:11], a[80:83], v[52:55]
    s_add_u32 s52, s52, s56
    ds_read_b64_tr_b16 a[68:69], v8 offset:16384
    v_mfma_f32_16x16x32_bf16 v[112:115], a[16:19], a[80:83], v[112:115]
    v_mfma_f32_16x16x32_bf16 v[112:115], a[20:23], a[84:87], v[112:115]
    v_mfma_f32_16x16x32_bf16 v[120:123], a[20:23], a[92:95], v[120:123]
    buffer_load_dwordx4 v18, s[44:47], s53 offen offset:2048 sc1 lds
    v_mfma_f32_16x16x32_bf16 v[120:123], a[16:19], a[88:91], v[120:123]
    ds_read_b64_tr_b16 a[70:71], v8 offset:18432
    v_mfma_f32_16x16x32_bf16 v[124:127], a[24:27], a[88:91], v[124:127]
    v_mfma_f32_16x16x32_bf16 v[124:127], a[28:31], a[92:95], v[124:127]
    v_mfma_f32_16x16x32_bf16 v[116:119], a[28:31], a[84:87], v[116:119]
    buffer_load_dwordx4 v19, s[44:47], s53 offen offset:3072 sc1 lds
    v_mfma_f32_16x16x32_bf16 v[116:119], a[24:27], a[80:83], v[116:119]
    s_add_u32 s53, s53, s56
    ds_read_b64_tr_b16 a[72:73], v9 offset:0
    v_mfma_f32_16x16x32_bf16 v[176:179], a[32:35], a[80:83], v[176:179]
    v_mfma_f32_16x16x32_bf16 v[176:179], a[36:39], a[84:87], v[176:179]
    s_add_u32 m0, s62, 4096
    v_mfma_f32_16x16x32_bf16 v[184:187], a[36:39], a[92:95], v[184:187]
    buffer_load_dwordx4 v20, s[44:47], s54 offen offset:0 sc1 lds
    v_mfma_f32_16x16x32_bf16 v[184:187], a[32:35], a[88:91], v[184:187]
    s_xor_b32 s62, s62, 229376
    ds_read_b64_tr_b16 a[74:75], v9 offset:2048
    v_mfma_f32_16x16x32_bf16 v[188:191], a[40:43], a[88:91], v[188:191]
    v_mfma_f32_16x16x32_bf16 v[188:191], a[44:47], a[92:95], v[188:191]
    v_mfma_f32_16x16x32_bf16 v[180:183], a[44:47], a[84:87], v[180:183]
    buffer_load_dwordx4 v21, s[44:47], s54 offen offset:1024 sc1 lds
    v_mfma_f32_16x16x32_bf16 v[180:183], a[40:43], a[80:83], v[180:183]
    s_add_u32 s54, s54, s56
    ds_read_b64_tr_b16 a[76:77], v9 offset:16384
    v_mfma_f32_16x16x32_bf16 v[240:243], a[48:51], a[80:83], v[240:243]
    v_mfma_f32_16x16x32_bf16 v[240:243], a[52:55], a[84:87], v[240:243]
    v_mfma_f32_16x16x32_bf16 v[248:251], a[52:55], a[92:95], v[248:251]
    buffer_load_dwordx4 v20, s[44:47], s55 offen offset:2048 sc1 lds
    v_mfma_f32_16x16x32_bf16 v[248:251], a[48:51], a[88:91], v[248:251]
    ds_read_b64_tr_b16 a[78:79], v9 offset:18432
    v_mfma_f32_16x16x32_bf16 v[252:255], a[56:59], a[88:91], v[252:255]
    v_add_u32 v6, s63, v6
    v_add_u32 v7, s63, v7
    v_mfma_f32_16x16x32_bf16 v[252:255], a[60:63], a[92:95], v[252:255]
    v_mfma_f32_16x16x32_bf16 v[244:247], a[60:63], a[84:87], v[244:247]
    buffer_load_dwordx4 v21, s[44:47], s55 offen offset:3072 sc1 lds
    v_mfma_f32_16x16x32_bf16 v[244:247], a[56:59], a[80:83], v[244:247]
    s_add_u32 s55, s55, s56
    v_mfma_f32_16x16x32_bf16 v[64:67], a[0:3], a[96:99], v[64:67]
    ds_read_b64_tr_b16 a[80:81], v10 offset:0
    v_mfma_f32_16x16x32_bf16 v[64:67], a[4:7], a[100:103], v[64:67]
    v_mfma_f32_16x16x32_bf16 v[72:75], a[4:7], a[108:111], v[72:75]
    v_mfma_f32_16x16x32_bf16 v[72:75], a[0:3], a[104:107], v[72:75]
    s_add_u32 m0, s61, 0
    ds_read_b64_tr_b16 a[82:83], v10 offset:2048
    v_mfma_f32_16x16x32_bf16 v[76:79], a[8:11], a[104:107], v[76:79]
    buffer_load_dwordx4 v16, s[40:43], s48 offen offset:0 sc1 lds
    v_mfma_f32_16x16x32_bf16 v[76:79], a[12:15], a[108:111], v[76:79]
    v_mfma_f32_16x16x32_bf16 v[68:71], a[12:15], a[100:103], v[68:71]
    ds_read_b64_tr_b16 a[84:85], v10 offset:16384
    v_mfma_f32_16x16x32_bf16 v[68:71], a[8:11], a[96:99], v[68:71]
    v_mfma_f32_16x16x32_bf16 v[128:131], a[16:19], a[96:99], v[128:131]
    v_mfma_f32_16x16x32_bf16 v[128:131], a[20:23], a[100:103], v[128:131]
    ds_read_b64_tr_b16 a[86:87], v10 offset:18432
    v_mfma_f32_16x16x32_bf16 v[136:139], a[20:23], a[108:111], v[136:139]
    v_mfma_f32_16x16x32_bf16 v[136:139], a[16:19], a[104:107], v[136:139]
    v_mfma_f32_16x16x32_bf16 v[140:143], a[24:27], a[104:107], v[140:143]
    buffer_load_dwordx4 v17, s[40:43], s48 offen offset:1024 sc1 lds
    v_mfma_f32_16x16x32_bf16 v[140:143], a[28:31], a[108:111], v[140:143]
    s_add_u32 s48, s48, 128
    ds_read_b64_tr_b16 a[88:89], v11 offset:0
    v_mfma_f32_16x16x32_bf16 v[132:135], a[28:31], a[100:103], v[132:135]
    v_mfma_f32_16x16x32_bf16 v[132:135], a[24:27], a[96:99], v[132:135]
    v_mfma_f32_16x16x32_bf16 v[192:195], a[32:35], a[96:99], v[192:195]
    v_mfma_f32_16x16x32_bf16 v[192:195], a[36:39], a[100:103], v[192:195]
    ds_read_b64_tr_b16 a[90:91], v11 offset:2048
    v_mfma_f32_16x16x32_bf16 v[200:203], a[36:39], a[108:111], v[200:203]
    v_mfma_f32_16x16x32_bf16 v[200:203], a[32:35], a[104:107], v[200:203]
    v_mfma_f32_16x16x32_bf16 v[204:207], a[40:43], a[104:107], v[204:207]
    buffer_load_dwordx4 v16, s[40:43], s49 offen offset:2048 sc1 lds
    v_mfma_f32_16x16x32_bf16 v[204:207], a[44:47], a[108:111], v[204:207]
    ds_read_b64_tr_b16 a[92:93], v11 offset:16384
    v_mfma_f32_16x16x32_bf16 v[196:199], a[44:47], a[100:103], v[196:199]
    v_mfma_f32_16x16x32_bf16 v[196:199], a[40:43], a[96:99], v[196:199]
    v_mfma_f32_16x16x32_bf16 a[224:227], a[48:51], a[96:99], a[224:227]
    v_mfma_f32_16x16x32_bf16 a[224:227], a[52:55], a[100:103], a[224:227]
    ds_read_b64_tr_b16 a[94:95], v11 offset:18432
    v_mfma_f32_16x16x32_bf16 a[232:235], a[52:55], a[108:111], a[232:235]
    v_mfma_f32_16x16x32_bf16 a[232:235], a[48:51], a[104:107], a[232:235]
    v_mfma_f32_16x16x32_bf16 a[236:239], a[56:59], a[104:107], a[236:239]
    buffer_load_dwordx4 v17, s[40:43], s49 offen offset:3072 sc1 lds
    v_mfma_f32_16x16x32_bf16 a[236:239], a[60:63], a[108:111], a[236:239]
    s_add_u32 s49, s49, 128
    v_mfma_f32_16x16x32_bf16 a[228:231], a[60:63], a[100:103], a[228:231]
    v_mfma_f32_16x16x32_bf16 a[228:231], a[56:59], a[96:99], a[228:231]
    v_mfma_f32_16x16x32_bf16 v[80:83], a[0:3], a[112:115], v[80:83]
    v_mfma_f32_16x16x32_bf16 v[80:83], a[4:7], a[116:119], v[80:83]
    ds_read_b64_tr_b16 a[96:97], v12 offset:0
    v_mfma_f32_16x16x32_bf16 v[88:91], a[4:7], a[124:127], v[88:91]
    v_mfma_f32_16x16x32_bf16 v[88:91], a[0:3], a[120:123], v[88:91]
    s_add_u32 m0, s61, 4096
    ds_read_b128 a[0:3], v6 offset:0
    v_mfma_f32_16x16x32_bf16 v[92:95], a[8:11], a[120:123], v[92:95]
    buffer_load_dwordx4 v16, s[40:43], s50 offen offset:0 sc1 lds
    v_mfma_f32_16x16x32_bf16 v[92:95], a[12:15], a[124:127], v[92:95]
    s_add_u32 s61, s61, 32768
    ds_read_b128 a[4:7], v7 offset:0
    v_mfma_f32_16x16x32_bf16 v[84:87], a[12:15], a[116:119], v[84:87]
    s_cmp_ge_u32 s61, 98304
    s_cselect_b32 s90, 98304, 0
    ds_read_b64_tr_b16 a[98:99], v12 offset:2048
    v_mfma_f32_16x16x32_bf16 v[84:87], a[8:11], a[112:115], v[84:87]
    s_sub_u32 s61, s61, s90
    ds_read_b128 a[8:11], v6 offset:2048
    v_mfma_f32_16x16x32_bf16 v[144:147], a[16:19], a[112:115], v[144:147]
    ds_read_b128 a[12:15], v7 offset:2048
    v_mfma_f32_16x16x32_bf16 v[144:147], a[20:23], a[116:119], v[144:147]
    ds_read_b64_tr_b16 a[100:101], v12 offset:16384
    v_mfma_f32_16x16x32_bf16 v[152:155], a[20:23], a[124:127], v[152:155]
    v_mfma_f32_16x16x32_bf16 v[152:155], a[16:19], a[120:123], v[152:155]
    ds_read_b128 a[16:19], v6 offset:4096
    v_mfma_f32_16x16x32_bf16 v[156:159], a[24:27], a[120:123], v[156:159]
    buffer_load_dwordx4 v17, s[40:43], s50 offen offset:1024 sc1 lds
    v_mfma_f32_16x16x32_bf16 v[156:159], a[28:31], a[124:127], v[156:159]
    s_add_u32 s50, s50, 128
    ds_read_b128 a[20:23], v7 offset:4096
    v_mfma_f32_16x16x32_bf16 v[148:151], a[28:31], a[116:119], v[148:151]
    ds_read_b64_tr_b16 a[102:103], v12 offset:18432
    v_mfma_f32_16x16x32_bf16 v[148:151], a[24:27], a[112:115], v[148:151]
    ds_read_b128 a[24:27], v6 offset:6144
    v_mfma_f32_16x16x32_bf16 v[208:211], a[32:35], a[112:115], v[208:211]
    s_sub_u32 s65, s65, 1
    ds_read_b128 a[28:31], v7 offset:6144
    v_mfma_f32_16x16x32_bf16 v[208:211], a[36:39], a[116:119], v[208:211]
    ds_read_b64_tr_b16 a[104:105], v13 offset:0
    v_mfma_f32_16x16x32_bf16 v[216:219], a[36:39], a[124:127], v[216:219]
    v_mfma_f32_16x16x32_bf16 v[216:219], a[32:35], a[120:123], v[216:219]
    ds_read_b128 a[32:35], v6 offset:8192
    v_mfma_f32_16x16x32_bf16 v[220:223], a[40:43], a[120:123], v[220:223]
    buffer_load_dwordx4 v16, s[40:43], s51 offen offset:2048 sc1 lds
    v_mfma_f32_16x16x32_bf16 v[220:223], a[44:47], a[124:127], v[220:223]
    ds_read_b128 a[36:39], v7 offset:8192
    v_mfma_f32_16x16x32_bf16 v[212:215], a[44:47], a[116:119], v[212:215]
    ds_read_b64_tr_b16 a[106:107], v13 offset:2048
    v_mfma_f32_16x16x32_bf16 v[212:215], a[40:43], a[112:115], v[212:215]
    ds_read_b128 a[40:43], v6 offset:10240
    v_mfma_f32_16x16x32_bf16 a[240:243], a[48:51], a[112:115], a[240:243]
    ds_read_b128 a[44:47], v7 offset:10240
    v_mfma_f32_16x16x32_bf16 a[240:243], a[52:55], a[116:119], a[240:243]
    ds_read_b64_tr_b16 a[108:109], v13 offset:16384
    v_mfma_f32_16x16x32_bf16 a[248:251], a[52:55], a[124:127], a[248:251]
    v_mfma_f32_16x16x32_bf16 a[248:251], a[48:51], a[120:123], a[248:251]
    ds_read_b128 a[48:51], v6 offset:12288
    v_mfma_f32_16x16x32_bf16 a[252:255], a[56:59], a[120:123], a[252:255]
    buffer_load_dwordx4 v17, s[40:43], s51 offen offset:3072 sc1 lds
    v_mfma_f32_16x16x32_bf16 a[252:255], a[60:63], a[124:127], a[252:255]
    s_add_u32 s51, s51, 128
    ds_read_b128 a[52:55], v7 offset:12288
    v_mfma_f32_16x16x32_bf16 a[244:247], a[60:63], a[116:119], a[244:247]
    s_cmp_gt_u32 s65, s67
    ds_read_b64_tr_b16 a[110:111], v13 offset:18432
    v_mfma_f32_16x16x32_bf16 a[244:247], a[56:59], a[112:115], a[244:247]
    ds_read_b128 a[56:59], v6 offset:14336
    ds_read_b128 a[60:63], v7 offset:14336
    s_cbranch_scc1 m_loop25
    s_cmp_eq_u32 s65, 0
    s_cbranch_scc1 m_epi15
m_dosw26:
    s_cmp_eq_u32 s94, 0
    s_cbranch_scc1 m_x61
    s_cmp_lg_u32 s65, 3
    s_cbranch_scc1 m_x67
    s_mov_b32 s42, s73
    s_lshl_b32 s90, s77, 4
    s_lshl_b32 s90, s90, s81
    s_mov_b32 s48, s79
    s_mul_i32 s91, s90, 1
    s_add_u32 s49, s91, s79
    s_sub_u32 s49, s49, 2048
    s_mul_i32 s91, s90, 2
    s_add_u32 s50, s91, s79
    s_mul_i32 s91, s90, 3
    s_add_u32 s51, s91, s79
    s_sub_u32 s51, s51, 2048
    s_lshl_b32 s90, s58, 7
    s_add_u32 s90, s90, s57
    s_lshl_b32 s91, s16, 6
    s_cmp_eq_u32 s81, 1
    s_cselect_b32 s90, s90, s91
    v_lshrrev_b32 v24, 3, v1
    v_lshlrev_b32 v24, s81, v24
    v_add_u32 v24, s90, v24
    v_mul_lo_u32 v24, v24, s77
    v_lshrrev_b32 v25, 4, v1
    v_and_b32 v26, 7, v1
    v_xor_b32 v25, v25, v26
    v_lshl_add_u32 v16, v25, 4, v24
    v_xor_b32 v25, 4, v25
    v_lshl_add_u32 v17, v25, 4, v24
    s_lshl_b32 s90, s77, 3
    s_lshl_b32 s90, s90, s81
    s_sub_u32 s90, s90, 1024
    v_add_u32 v17, s90, v17
    s_mov_b32 s40, s71
    s_mov_b32 s41, s72
    buffer_load_dwordx2 v[4:5], off, s[12:15], 0 sc1
    s_branch m_loop25
m_x67:
    s_mov_b32 s46, s76
    s_mov_b32 s52, s80
    s_lshl_b32 s90, s78, 2
    s_mul_i32 s91, s90, 1
    s_add_u32 s53, s91, s80
    s_sub_u32 s53, s53, 2048
    s_mul_i32 s91, s90, 2
    s_add_u32 s54, s91, s80
    s_mul_i32 s91, s90, 3
    s_add_u32 s55, s91, s80
    s_sub_u32 s55, s55, 2048
    s_lshl_b32 s56, s78, 6
    v_lshrrev_b32 v24, 5, v1
    s_lshl_b32 s90, s16, 4
    v_add_u32 v25, s90, v24
    v_mul_lo_u32 v25, v25, s78
    v_lshlrev_b32 v24, 1, v24
    v_and_b32 v26, 31, v1
    v_xor_b32 v24, v24, v26
    s_lshl_b32 s90, s78, 1
    s_sub_u32 s90, s90, 1024
    v_add_u32 v27, s90, v25
    v_xor_b32 v26, 0, v24
    v_lshl_add_u32 v18, v26, 4, v25
    v_xor_b32 v26, 4, v24
    v_lshl_add_u32 v19, v26, 4, v27
    v_xor_b32 v26, 8, v24
    v_lshl_add_u32 v20, v26, 4, v25
    v_xor_b32 v26, 12, v24
    v_lshl_add_u32 v21, v26, 4, v27
    s_mov_b32 s44, s74
    s_mov_b32 s45, s75
    s_mov_b32 s67, 0
    s_branch m_loop25
m_x61:
    s_cmp_le_u32 s65, 4
    s_cbranch_scc1 m_x62
    s_cmp_lg_u32 s16, 0
    s_cbranch_scc1 m_np68
    v_mov_b32 v4, s4
    v_mov_b32 v5, s5
    s_add_u32 s90, s17, 117440512
    s_mov_b64 exec, 1
    buffer_store_dwordx2 v[4:5], off, s[8:11], s90 sc1
    s_mov_b64 exec, -1
m_np68:
    s_mov_b32 s17, -1
    s_mov_b32 s67, 4
    s_branch m_loop25
m_x62:
    s_cmp_lg_u32 s65, 4
    s_cbranch_scc1 m_x63
    s_cmp_eq_u32 s70, 1
    s_cbranch_scc1 m_ea69
    buffer_load_dwordx2 v[4:5], v0, s[8:11], s37 offen sc1
m_eb70:
    s_branch m_loop25
m_x63:
    s_waitcnt vmcnt(16)
    s_cmp_lg_u32 s65, 3
    s_cbranch_scc1 m_x64
    s_cmp_eq_u32 s70, 1
    s_cbranch_scc1 m_ea71
    s_mov_b32 s3, 1048576
m_spin73:
    v_cmp_ne_u64 s[22:23], s[4:5], v[4:5]
    s_nop 3
    s_cmp_eq_u64 s[22:23], 0
    s_cbranch_scc1 m_ok74
    s_sub_u32 s3, s3, 1
    s_cbranch_scc1 m_ok74
    s_sleep 16
    buffer_load_dwordx2 v[4:5], v0, s[8:11], s37 offen sc1
    s_waitcnt vmcnt(0)
    s_branch m_spin73
m_ok74:
    buffer_load_dwordx4 a[128:131], v2, s[8:11], s33 offen offset:0 sc1
    buffer_load_dwordx4 a[132:135], v2, s[8:11], s33 offen offset:1024 sc1
    buffer_load_dwordx4 a[136:139], v2, s[8:11], s33 offen offset:2048 sc1
    buffer_load_dwordx4 a[140:143], v2, s[8:11], s33 offen offset:3072 sc1
    buffer_load_dwordx4 a[144:147], v2, s[8:11], s34 offen offset:0 sc1
    buffer_load_dwordx4 a[148:151], v2, s[8:11], s34 offen offset:1024 sc1
m_eb72:
    s_add_u32 s48, s32, 0
    s_mov_b32 s49, s48
    s_add_u32 s50, s48, 4096
    s_mov_b32 s51, s50
    s_cmp_eq_u32 s57, 0
    s_cselect_b32 s42, 268435456, 0
    s_mov_b32 s40, s6
    s_mov_b32 s41, s7
    v_mov_b32 v16, v2
    v_mov_b32 v17, v2
    s_branch m_loop25
m_x64:
    s_cmp_lg_u32 s65, 2
    s_cbranch_scc1 m_x65
    s_cmp_eq_u32 s70, 1
    s_cbranch_scc1 m_ea75
    buffer_load_dwordx4 a[152:155], v2, s[8:11], s34 offen offset:2048 sc1
    buffer_load_dwordx4 a[156:159], v2, s[8:11], s34 offen offset:3072 sc1
    buffer_load_dwordx4 a[160:163], v2, s[8:11], s35 offen offset:0 sc1
    buffer_load_dwordx4 a[164:167], v2, s[8:11], s35 offen offset:1024 sc1
    buffer_load_dwordx4 a[168:171], v2, s[8:11], s35 offen offset:2048 sc1
m_eb76:
    s_add_u32 s48, s32, 16384
    s_mov_b32 s49, s48
    s_add_u32 s50, s48, 4096
    s_mov_b32 s51, s50
    s_mov_b32 s42, 268435456
    s_add_u32 s52, s32, 49152
    s_mov_b32 s53, s52
    s_add_u32 s54, s52, 4096
    s_mov_b32 s55, s54
    s_mov_b32 s46, 268435456
    s_mov_b32 s44, s6
    s_mov_b32 s45, s7
    v_mov_b32 v18, v2
    v_mov_b32 v19, v2
    v_mov_b32 v20, v2
    v_mov_b32 v21, v2
    s_branch m_loop25
m_x65:
    s_cmp_eq_u32 s70, 1
    s_cbranch_scc1 m_ea77
    buffer_load_dwordx4 a[172:175], v2, s[8:11], s35 offen offset:3072 sc1
    buffer_load_dwordx4 a[176:179], v2, s[8:11], s36 offen offset:0 sc1
    buffer_load_dwordx4 a[180:183], v2, s[8:11], s36 offen offset:1024 sc1
    buffer_load_dwordx4 a[184:187], v2, s[8:11], s36 offen offset:2048 sc1
    buffer_load_dwordx4 a[188:191], v2, s[8:11], s36 offen offset:3072 sc1
m_eb78:
    s_add_u32 s48, s32, 32768
    s_mov_b32 s49, s48
    s_add_u32 s50, s48, 4096
    s_mov_b32 s51, s50
    s_add_u32 s52, s32, 65536
    s_mov_b32 s53, s52
    s_add_u32 s54, s52, 4096
    s_mov_b32 s55, s54
    s_branch m_loop25
m_ea69:
    s_and_b32 s92, s2, 7
    s_lshl_b32 s92, s92, 2
    s_bfe_u32 s93, s2, 0x20003
    s_add_u32 s92, s92, s93
    s_lshr_b32 s93, s2, 5
    s_lshl_b32 s93, s93, 2
    s_or_b32 s93, s93, 0x40000
    v_and_b32 v0, 3, v1
    v_min_u32 v0, 2, v0
    v_and_b32 v24, 4, v1
    v_add3_u32 v0, v0, v24, 8
    v_lshlrev_b32 v0, 3, v0
    buffer_load_dwordx2 v[4:5], v0, s[8:11], s37 offen sc1
    s_branch m_eb70
m_ea71:
    s_mov_b32 s3, 1048576
m_spin79:
    v_cmp_ne_u64 s[22:23], s[4:5], v[4:5]
    s_nop 3
    s_cmp_eq_u64 s[22:23], 0
    s_cbranch_scc1 m_ok80
    s_sub_u32 s3, s3, 1
    s_cbranch_scc1 m_ok80
    s_sleep 16
    buffer_load_dwordx2 v[4:5], v0, s[8:11], s37 offen sc1
    s_waitcnt vmcnt(0)
    s_branch m_spin79
m_ok80:
    s_branch m_eb72
m_ea75:
    s_and_b32 s92, s2, 7
    s_lshl_b32 s92, s92, 2
    s_bfe_u32 s93, s2, 0x20003
    s_add_u32 s92, s92, s93
    s_lshr_b32 s93, s2, 5
    s_lshl_b32 s93, s93, 2
    s_or_b32 s93, s93, 0x40000
    s_bfe_u32 s91, 873473623, s93
    s_lshr_b32 s91, s91, 1
    v_mov_b32 v0, s91
    s_bfe_u32 s91, 4225681832, s93
    s_lshr_b32 s91, s91, 1
    v_writelane_b32 v0, s91, 8
    v_lshlrev_b32 v0, 3, v0
    buffer_load_dwordx2 v[4:5], v0, s[8:11], s37 offen sc1
    s_branch m_eb76
m_ea77:
    s_mov_b32 s3, 1048576
m_spin81:
    v_cmp_ne_u64 s[22:23], s[4:5], v[4:5]
    s_nop 3
    s_cmp_eq_u64 s[22:23], 0
    s_cbranch_scc1 m_ok82
    s_sub_u32 s3, s3, 1
    s_cbranch_scc1 m_ok82
    s_sleep 16
    buffer_load_dwordx2 v[4:5], v0, s[8:11], s37 offen sc1
    s_waitcnt vmcnt(0)
    s_branch m_spin81
m_ok82:
    buffer_load_dwordx4 a[128:131], v2, s[8:11], s33 offen offset:0 sc1
    buffer_load_dwordx4 a[132:135], v2, s[8:11], s33 offen offset:1024 sc1
    buffer_load_dwordx4 a[136:139], v2, s[8:11], s33 offen offset:2048 sc1
    buffer_load_dwordx4 a[140:143], v2, s[8:11], s33 offen offset:3072 sc1
    buffer_load_dwordx4 a[144:147], v2, s[8:11], s34 offen offset:0 sc1
    buffer_load_dwordx4 a[148:151], v2, s[8:11], s34 offen offset:1024 sc1
    buffer_load_dwordx4 a[152:155], v2, s[8:11], s34 offen offset:2048 sc1
    buffer_load_dwordx4 a[156:159], v2, s[8:11], s34 offen offset:3072 sc1
    buffer_load_dwordx4 a[160:163], v2, s[8:11], s35 offen offset:0 sc1
    buffer_load_dwordx4 a[164:167], v2, s[8:11], s35 offen offset:1024 sc1
    buffer_load_dwordx4 a[168:171], v2, s[8:11], s35 offen offset:2048 sc1
    buffer_load_dwordx4 a[172:175], v2, s[8:11], s35 offen offset:3072 sc1
    buffer_load_dwordx4 a[176:179], v2, s[8:11], s36 offen offset:0 sc1
    buffer_load_dwordx4 a[180:183], v2, s[8:11], s36 offen offset:1024 sc1
    buffer_load_dwordx4 a[184:187], v2, s[8:11], s36 offen offset:2048 sc1
    buffer_load_dwordx4 a[188:191], v2, s[8:11], s36 offen offset:3072 sc1
    s_branch m_eb78
m_epi15:
    s_cmp_eq_u32 s94, 0
    s_cbranch_scc1 m_last29
    s_mov_b32 s3, 1048576
m_spin33:
    v_readfirstlane_b32 s4, v4
    v_readfirstlane_b32 s5, v5
    s_nop 3
    s_cmp_lg_u32 s4, 0
    s_cbranch_scc1 m_ok34
    s_sub_u32 s3, s3, 1
    s_cbranch_scc1 m_ok34
    s_sleep 32
    buffer_load_dwordx2 v[4:5], off, s[12:15], 0 sc1
    s_waitcnt vmcnt(0)
    s_branch m_spin33
m_ok34:
    s_cmp_ge_u32 s68, 16
    s_cbranch_scc1 m_q036
m_epf27:
    s_nop 7
    s_mov_b32 s91, s98
    s_mov_b32 s92, s97
    s_mov_b32 s93, s97
    s_mov_b32 s90, s91
    v_pk_mul_f32 v[32:33], v[32:33], s[92:93]
    v_pk_mul_f32 v[34:35], v[34:35], s[92:93]
    v_pk_mul_f32 v[36:37], v[36:37], s[92:93]
    v_pk_mul_f32 v[38:39], v[38:39], s[92:93]
    v_cvt_pk_bf16_f32 v32, v32, v33
    v_cvt_pk_bf16_f32 v33, v34, v35
    v_cvt_pk_bf16_f32 v34, v36, v37
    v_cvt_pk_bf16_f32 v35, v38, v39
    buffer_store_dwordx4 v[32:35], v2, s[8:11], s90 offen sc1
    s_add_u32 s90, s90, s100
    v_pk_mul_f32 v[40:41], v[40:41], s[92:93]
    v_pk_mul_f32 v[42:43], v[42:43], s[92:93]
    v_pk_mul_f32 v[44:45], v[44:45], s[92:93]
    v_pk_mul_f32 v[46:47], v[46:47], s[92:93]
    v_cvt_pk_bf16_f32 v40, v40, v41
    v_cvt_pk_bf16_f32 v41, v42, v43
    v_cvt_pk_bf16_f32 v42, v44, v45
    v_cvt_pk_bf16_f32 v43, v46, v47
    buffer_store_dwordx4 v[40:43], v2, s[8:11], s90 offen sc1
    s_add_u32 s90, s90, s100
    v_pk_mul_f32 v[48:49], v[48:49], s[92:93]
    v_pk_mul_f32 v[50:51], v[50:51], s[92:93]
    v_pk_mul_f32 v[52:53], v[52:53], s[92:93]
    v_pk_mul_f32 v[54:55], v[54:55], s[92:93]
    v_cvt_pk_bf16_f32 v48, v48, v49
    v_cvt_pk_bf16_f32 v49, v50, v51
    v_cvt_pk_bf16_f32 v50, v52, v53
    v_cvt_pk_bf16_f32 v51, v54, v55
    buffer_store_dwordx4 v[48:51], v2, s[8:11], s90 offen sc1
    s_add_u32 s90, s90, s100
    v_pk_mul_f32 v[56:57], v[56:57], s[92:93]
    v_pk_mul_f32 v[58:59], v[58:59], s[92:93]
    v_pk_mul_f32 v[60:61], v[60:61], s[92:93]
    v_pk_mul_f32 v[62:63], v[62:63], s[92:93]
    v_cvt_pk_bf16_f32 v56, v56, v57
    v_cvt_pk_bf16_f32 v57, v58, v59
    v_cvt_pk_bf16_f32 v58, v60, v61
    v_cvt_pk_bf16_f32 v59, v62, v63
    buffer_store_dwordx4 v[56:59], v2, s[8:11], s90 offen sc1
    s_add_u32 s90, s90, s100
    v_pk_mul_f32 v[64:65], v[64:65], s[92:93]
    v_pk_mul_f32 v[66:67], v[66:67], s[92:93]
    v_pk_mul_f32 v[68:69], v[68:69], s[92:93]
    v_pk_mul_f32 v[70:71], v[70:71], s[92:93]
    v_cvt_pk_bf16_f32 v64, v64, v65
    v_cvt_pk_bf16_f32 v65, v66, v67
    v_cvt_pk_bf16_f32 v66, v68, v69
    v_cvt_pk_bf16_f32 v67, v70, v71
    buffer_store_dwordx4 v[64:67], v2, s[8:11], s90 offen sc1
    s_add_u32 s90, s90, s100
    v_pk_mul_f32 v[72:73], v[72:73], s[92:93]
    v_pk_mul_f32 v[74:75], v[74:75], s[92:93]
    v_pk_mul_f32 v[76:77], v[76:77], s[92:93]
    v_pk_mul_f32 v[78:79], v[78:79], s[92:93]
    v_cvt_pk_bf16_f32 v72, v72, v73
    v_cvt_pk_bf16_f32 v73, v74, v75
    v_cvt_pk_bf16_f32 v74, v76, v77
    v_cvt_pk_bf16_f32 v75, v78, v79
    buffer_store_dwordx4 v[72:75], v2, s[8:11], s90 offen sc1
    s_add_u32 s90, s90, s100
    v_pk_mul_f32 v[80:81], v[80:81], s[92:93]
    v_pk_mul_f32 v[82:83], v[82:83], s[92:93]
    v_pk_mul_f32 v[84:85], v[84:85], s[92:93]
    v_pk_mul_f32 v[86:87], v[86:87], s[92:93]
    v_cvt_pk_bf16_f32 v80, v80, v81
    v_cvt_pk_bf16_f32 v81, v82, v83
    v_cvt_pk_bf16_f32 v82, v84, v85
    v_cvt_pk_bf16_f32 v83, v86, v87
    buffer_store_dwordx4 v[80:83], v2, s[8:11], s90 offen sc1
    s_add_u32 s90, s90, s100
    v_pk_mul_f32 v[88:89], v[88:89], s[92:93]
    v_pk_mul_f32 v[90:91], v[90:91], s[92:93]
    v_pk_mul_f32 v[92:93], v[92:93], s[92:93]
    v_pk_mul_f32 v[94:95], v[94:95], s[92:93]
    v_cvt_pk_bf16_f32 v88, v88, v89
    v_cvt_pk_bf16_f32 v89, v90, v91
    v_cvt_pk_bf16_f32 v90, v92, v93
    v_cvt_pk_bf16_f32 v91, v94, v95
    buffer_store_dwordx4 v[88:91], v2, s[8:11], s90 offen sc1
    s_add_u32 s90, s90, s100
    s_add_u32 s91, s91, s99
    s_mov_b32 s90, s91
    v_pk_mul_f32 v[96:97], v[96:97], s[92:93]
    v_pk_mul_f32 v[98:99], v[98:99], s[92:93]
    v_pk_mul_f32 v[100:101], v[100:101], s[92:93]
    v_pk_mul_f32 v[102:103], v[102:103], s[92:93]
    v_cvt_pk_bf16_f32 v96, v96, v97
    v_cvt_pk_bf16_f32 v97, v98, v99
    v_cvt_pk_bf16_f32 v98, v100, v101
    v_cvt_pk_bf16_f32 v99, v102, v103
    buffer_store_dwordx4 v[96:99], v2, s[8:11], s90 offen sc1
    s_add_u32 s90, s90, s100
    v_pk_mul_f32 v[104:105], v[104:105], s[92:93]
    v_pk_mul_f32 v[106:107], v[106:107], s[92:93]
    v_pk_mul_f32 v[108:109], v[108:109], s[92:93]
    v_pk_mul_f32 v[110:111], v[110:111], s[92:93]
    v_cvt_pk_bf16_f32 v104, v104, v105
    v_cvt_pk_bf16_f32 v105, v106, v107
    v_cvt_pk_bf16_f32 v106, v108, v109
    v_cvt_pk_bf16_f32 v107, v110, v111
    buffer_store_dwordx4 v[104:107], v2, s[8:11], s90 offen sc1
    s_add_u32 s90, s90, s100
    v_pk_mul_f32 v[112:113], v[112:113], s[92:93]
    v_pk_mul_f32 v[114:115], v[114:115], s[92:93]
    v_pk_mul_f32 v[116:117], v[116:117], s[92:93]
    v_pk_mul_f32 v[118:119], v[118:119], s[92:93]
    v_cvt_pk_bf16_f32 v112, v112, v113
    v_cvt_pk_bf16_f32 v113, v114, v115
    v_cvt_pk_bf16_f32 v114, v116, v117
    v_cvt_pk_bf16_f32 v115, v118, v119
    buffer_store_dwordx4 v[112:115], v2, s[8:11], s90 offen sc1
    s_add_u32 s90, s90, s100
    v_pk_mul_f32 v[120:121], v[120:121], s[92:93]
    v_pk_mul_f32 v[122:123], v[122:123], s[92:93]
    v_pk_mul_f32 v[124:125], v[124:125], s[92:93]
    v_pk_mul_f32 v[126:127], v[126:127], s[92:93]
    v_cvt_pk_bf16_f32 v120, v120, v121
    v_cvt_pk_bf16_f32 v121, v122, v123
    v_cvt_pk_bf16_f32 v122, v124, v125
    v_cvt_pk_bf16_f32 v123, v126, v127
    buffer_store_dwordx4 v[120:123], v2, s[8:11], s90 offen sc1
    s_add_u32 s90, s90, s100
    v_pk_mul_f32 v[128:129], v[128:129], s[92:93]
    v_pk_mul_f32 v[130:131], v[130:131], s[92:93]
    v_pk_mul_f32 v[132:133], v[132:133], s[92:93]
    v_pk_mul_f32 v[134:135], v[134:135], s[92:93]
    v_cvt_pk_bf16_f32 v128, v128, v129
    v_cvt_pk_bf16_f32 v129, v130, v131
    v_cvt_pk_bf16_f32 v130, v132, v133
    v_cvt_pk_bf16_f32 v131, v134, v135
    buffer_store_dwordx4 v[128:131], v2, s[8:11], s90 offen sc1
    s_add_u32 s90, s90, s100
    v_pk_mul_f32 v[136:137], v[136:137], s[92:93]
    v_pk_mul_f32 v[138:139], v[138:139], s[92:93]
    v_pk_mul_f32 v[140:141], v[140:141], s[92:93]
    v_pk_mul_f32 v[142:143], v[142:143], s[92:93]
    v_cvt_pk_bf16_f32 v136, v136, v137
    v_cvt_pk_bf16_f32 v137, v138, v139
    v_cvt_pk_bf16_f32 v138, v140, v141
    v_cvt_pk_bf16_f32 v139, v142, v143
    buffer_store_dwordx4 v[136:139], v2, s[8:11], s90 offen sc1
    s_add_u32 s90, s90, s100
    v_pk_mul_f32 v[144:145], v[144:145], s[92:93]
    v_pk_mul_f32 v[146:147], v[146:147], s[92:93]
    v_pk_mul_f32 v[148:149], v[148:149], s[92:93]
    v_pk_mul_f32 v[150:151], v[150:151], s[92:93]
    v_cvt_pk_bf16_f32 v144, v144, v145
    v_cvt_pk_bf16_f32 v145, v146, v147
    v_cvt_pk_bf16_f32 v146, v148, v149
    v_cvt_pk_bf16_f32 v147, v150, v151
    buffer_store_dwordx4 v[144:147], v2, s[8:11], s90 offen sc1
    s_add_u32 s90, s90, s100
    v_pk_mul_f32 v[152:153], v[152:153], s[92:93]
    v_pk_mul_f32 v[154:155], v[154:155], s[92:93]
    v_pk_mul_f32 v[156:157], v[156:157], s[92:93]
    v_pk_mul_f32 v[158:159], v[158:159], s[92:93]
    v_cvt_pk_bf16_f32 v152, v152, v153
    v_cvt_pk_bf16_f32 v153, v154, v155
    v_cvt_pk_bf16_f32 v154, v156, v157
    v_cvt_pk_bf16_f32 v155, v158, v159
    buffer_store_dwordx4 v[152:155], v2, s[8:11], s90 offen sc1
    s_add_u32 s90, s90, s100
    s_add_u32 s91, s91, s99
    s_mov_b32 s90, s91
    v_pk_mul_f32 v[160:161], v[160:161], s[92:93]
    v_pk_mul_f32 v[162:163], v[162:163], s[92:93]
    v_pk_mul_f32 v[164:165], v[164:165], s[92:93]
    v_pk_mul_f32 v[166:167], v[166:167], s[92:93]
    v_cvt_pk_bf16_f32 v160, v160, v161
    v_cvt_pk_bf16_f32 v161, v162, v163
    v_cvt_pk_bf16_f32 v162, v164, v165
    v_cvt_pk_bf16_f32 v163, v166, v167
    buffer_store_dwordx4 v[160:163], v2, s[8:11], s90 offen sc1
    s_add_u32 s90, s90, s100
    v_pk_mul_f32 v[168:169], v[168:169], s[92:93]
    v_pk_mul_f32 v[170:171], v[170:171], s[92:93]
    v_pk_mul_f32 v[172:173], v[172:173], s[92:93]
    v_pk_mul_f32 v[174:175], v[174:175], s[92:93]
    v_cvt_pk_bf16_f32 v168, v168, v169
    v_cvt_pk_bf16_f32 v169, v170, v171
    v_cvt_pk_bf16_f32 v170, v172, v173
    v_cvt_pk_bf16_f32 v171, v174, v175
    buffer_store_dwordx4 v[168:171], v2, s[8:11], s90 offen sc1
    s_add_u32 s90, s90, s100
    v_pk_mul_f32 v[176:177], v[176:177], s[92:93]
    v_pk_mul_f32 v[178:179], v[178:179], s[92:93]
    v_pk_mul_f32 v[180:181], v[180:181], s[92:93]
    v_pk_mul_f32 v[182:183], v[182:183], s[92:93]
    v_cvt_pk_bf16_f32 v176, v176, v177
    v_cvt_pk_bf16_f32 v177, v178, v179
    v_cvt_pk_bf16_f32 v178, v180, v181
    v_cvt_pk_bf16_f32 v179, v182, v183
    buffer_store_dwordx4 v[176:179], v2, s[8:11], s90 offen sc1
    s_add_u32 s90, s90, s100
    v_pk_mul_f32 v[184:185], v[184:185], s[92:93]
    v_pk_mul_f32 v[186:187], v[186:187], s[92:93]
    v_pk_mul_f32 v[188:189], v[188:189], s[92:93]
    v_pk_mul_f32 v[190:191], v[190:191], s[92:93]
    v_cvt_pk_bf16_f32 v184, v184, v185
    v_cvt_pk_bf16_f32 v185, v186, v187
    v_cvt_pk_bf16_f32 v186, v188, v189
    v_cvt_pk_bf16_f32 v187, v190, v191
    buffer_store_dwordx4 v[184:187], v2, s[8:11], s90 offen sc1
    s_add_u32 s90, s90, s100
    v_pk_mul_f32 v[192:193], v[192:193], s[92:93]
    v_pk_mul_f32 v[194:195], v[194:195], s[92:93]
    v_pk_mul_f32 v[196:197], v[196:197], s[92:93]
    v_pk_mul_f32 v[198:199], v[198:199], s[92:93]
    v_cvt_pk_bf16_f32 v192, v192, v193
    v_cvt_pk_bf16_f32 v193, v194, v195
    v_cvt_pk_bf16_f32 v194, v196, v197
    v_cvt_pk_bf16_f32 v195, v198, v199
    buffer_store_dwordx4 v[192:195], v2, s[8:11], s90 offen sc1
    s_add_u32 s90, s90, s100
    v_pk_mul_f32 v[200:201], v[200:201], s[92:93]
    v_pk_mul_f32 v[202:203], v[202:203], s[92:93]
    v_pk_mul_f32 v[204:205], v[204:205], s[92:93]
    v_pk_mul_f32 v[206:207], v[206:207], s[92:93]
    v_cvt_pk_bf16_f32 v200, v200, v201
    v_cvt_pk_bf16_f32 v201, v202, v203
    v_cvt_pk_bf16_f32 v202, v204, v205
    v_cvt_pk_bf16_f32 v203, v206, v207
    buffer_store_dwordx4 v[200:203], v2, s[8:11], s90 offen sc1
    s_add_u32 s90, s90, s100
    v_pk_mul_f32 v[208:209], v[208:209], s[92:93]
    v_pk_mul_f32 v[210:211], v[210:211], s[92:93]
    v_pk_mul_f32 v[212:213], v[212:213], s[92:93]
    v_pk_mul_f32 v[214:215], v[214:215], s[92:93]
    v_cvt_pk_bf16_f32 v208, v208, v209
    v_cvt_pk_bf16_f32 v209, v210, v211
    v_cvt_pk_bf16_f32 v210, v212, v213
    v_cvt_pk_bf16_f32 v211, v214, v215
    buffer_store_dwordx4 v[208:211], v2, s[8:11], s90 offen sc1
    s_add_u32 s90, s90, s100
    v_pk_mul_f32 v[216:217], v[216:217], s[92:93]
    v_pk_mul_f32 v[218:219], v[218:219], s[92:93]
    v_pk_mul_f32 v[220:221], v[220:221], s[92:93]
    v_pk_mul_f32 v[222:223], v[222:223], s[92:93]
    v_cvt_pk_bf16_f32 v216, v216, v217
    v_cvt_pk_bf16_f32 v217, v218, v219
    v_cvt_pk_bf16_f32 v218, v220, v221
    v_cvt_pk_bf16_f32 v219, v222, v223
    buffer_store_dwordx4 v[216:219], v2, s[8:11], s90 offen sc1
    s_add_u32 s90, s90, s100
    s_add_u32 s91, s91, s99
    s_mov_b32 s90, s91
    v_pk_mul_f32 v[224:225], v[224:225], s[92:93]
    v_pk_mul_f32 v[226:227], v[226:227], s[92:93]
    v_pk_mul_f32 v[228:229], v[228:229], s[92:93]
    v_pk_mul_f32 v[230:231], v[230:231], s[92:93]
    v_cvt_pk_bf16_f32 v224, v224, v225
    v_cvt_pk_bf16_f32 v225, v226, v227
    v_cvt_pk_bf16_f32 v226, v228, v229
    v_cvt_pk_bf16_f32 v227, v230, v231
    buffer_store_dwordx4 v[224:227], v2, s[8:11], s90 offen sc1
    s_add_u32 s90, s90, s100
    v_pk_mul_f32 v[232:233], v[232:233], s[92:93]
    v_pk_mul_f32 v[234:235], v[234:235], s[92:93]
    v_pk_mul_f32 v[236:237], v[236:237], s[92:93]
    v_pk_mul_f32 v[238:239], v[238:239], s[92:93]
    v_cvt_pk_bf16_f32 v232, v232, v233
    v_cvt_pk_bf16_f32 v233, v234, v235
    v_cvt_pk_bf16_f32 v234, v236, v237
    v_cvt_pk_bf16_f32 v235, v238, v239
    buffer_store_dwordx4 v[232:235], v2, s[8:11], s90 offen sc1
    s_add_u32 s90, s90, s100
    v_pk_mul_f32 v[240:241], v[240:241], s[92:93]
    v_pk_mul_f32 v[242:243], v[242:243], s[92:93]
    v_pk_mul_f32 v[244:245], v[244:245], s[92:93]
    v_pk_mul_f32 v[246:247], v[246:247], s[92:93]
    v_cvt_pk_bf16_f32 v240, v240, v241
    v_cvt_pk_bf16_f32 v241, v242, v243
    v_cvt_pk_bf16_f32 v242, v244, v245
    v_cvt_pk_bf16_f32 v243, v246, v247
    buffer_store_dwordx4 v[240:243], v2, s[8:11], s90 offen sc1
    s_add_u32 s90, s90, s100
    v_pk_mul_f32 v[248:249], v[248:249], s[92:93]
    v_pk_mul_f32 v[250:251], v[250:251], s[92:93]
    v_pk_mul_f32 v[252:253], v[252:253], s[92:93]
    v_pk_mul_f32 v[254:255], v[254:255], s[92:93]
    v_cvt_pk_bf16_f32 v248, v248, v249
    v_cvt_pk_bf16_f32 v249, v250, v251
    v_cvt_pk_bf16_f32 v250, v252, v253
    v_cvt_pk_bf16_f32 v251, v254, v255
    buffer_store_dwordx4 v[248:251], v2, s[8:11], s90 offen sc1
    s_add_u32 s90, s90, s100
    v_accvgpr_read_b32 v24, a224
    v_accvgpr_read_b32 v25, a225
    v_accvgpr_read_b32 v26, a226
    v_accvgpr_read_b32 v27, a227
    v_accvgpr_read_b32 v28, a228
    v_accvgpr_read_b32 v29, a229
    v_accvgpr_read_b32 v30, a230
    v_accvgpr_read_b32 v31, a231
    v_pk_mul_f32 v[24:25], v[24:25], s[92:93]
    v_pk_mul_f32 v[26:27], v[26:27], s[92:93]
    v_pk_mul_f32 v[28:29], v[28:29], s[92:93]
    v_pk_mul_f32 v[30:31], v[30:31], s[92:93]
    v_cvt_pk_bf16_f32 v24, v24, v25
    v_cvt_pk_bf16_f32 v25, v26, v27
    v_cvt_pk_bf16_f32 v26, v28, v29
    v_cvt_pk_bf16_f32 v27, v30, v31
    buffer_store_dwordx4 v[24:27], v2, s[8:11], s90 offen sc1
    s_add_u32 s90, s90, s100
    s_nop 1
    v_accvgpr_read_b32 v24, a232
    v_accvgpr_read_b32 v25, a233
    v_accvgpr_read_b32 v26, a234
    v_accvgpr_read_b32 v27, a235
    v_accvgpr_read_b32 v28, a236
    v_accvgpr_read_b32 v29, a237
    v_accvgpr_read_b32 v30, a238
    v_accvgpr_read_b32 v31, a239
    v_pk_mul_f32 v[24:25], v[24:25], s[92:93]
    v_pk_mul_f32 v[26:27], v[26:27], s[92:93]
    v_pk_mul_f32 v[28:29], v[28:29], s[92:93]
    v_pk_mul_f32 v[30:31], v[30:31], s[92:93]
    v_cvt_pk_bf16_f32 v24, v24, v25
    v_cvt_pk_bf16_f32 v25, v26, v27
    v_cvt_pk_bf16_f32 v26, v28, v29
    v_cvt_pk_bf16_f32 v27, v30, v31
    buffer_store_dwordx4 v[24:27], v2, s[8:11], s90 offen sc1
    s_add_u32 s90, s90, s100
    s_nop 1
    v_accvgpr_read_b32 v24, a240
    v_accvgpr_read_b32 v25, a241
    v_accvgpr_read_b32 v26, a242
    v_accvgpr_read_b32 v27, a243
    v_accvgpr_read_b32 v28, a244
    v_accvgpr_read_b32 v29, a245
    v_accvgpr_read_b32 v30, a246
    v_accvgpr_read_b32 v31, a247
    v_pk_mul_f32 v[24:25], v[24:25], s[92:93]
    v_pk_mul_f32 v[26:27], v[26:27], s[92:93]
    v_pk_mul_f32 v[28:29], v[28:29], s[92:93]
    v_pk_mul_f32 v[30:31], v[30:31], s[92:93]
    v_cvt_pk_bf16_f32 v24, v24, v25
    v_cvt_pk_bf16_f32 v25, v26, v27
    v_cvt_pk_bf16_f32 v26, v28, v29
    v_cvt_pk_bf16_f32 v27, v30, v31
    buffer_store_dwordx4 v[24:27], v2, s[8:11], s90 offen sc1
    s_add_u32 s90, s90, s100
    s_nop 1
    v_accvgpr_read_b32 v24, a248
    v_accvgpr_read_b32 v25, a249
    v_accvgpr_read_b32 v26, a250
    v_accvgpr_read_b32 v27, a251
    v_accvgpr_read_b32 v28, a252
    v_accvgpr_read_b32 v29, a253
    v_accvgpr_read_b32 v30, a254
    v_accvgpr_read_b32 v31, a255
    v_pk_mul_f32 v[24:25], v[24:25], s[92:93]
    v_pk_mul_f32 v[26:27], v[26:27], s[92:93]
    v_pk_mul_f32 v[28:29], v[28:29], s[92:93]
    v_pk_mul_f32 v[30:31], v[30:31], s[92:93]
    v_cvt_pk_bf16_f32 v24, v24, v25
    v_cvt_pk_bf16_f32 v25, v26, v27
    v_cvt_pk_bf16_f32 v26, v28, v29
    v_cvt_pk_bf16_f32 v27, v30, v31
    buffer_store_dwordx4 v[24:27], v2, s[8:11], s90 offen sc1
    s_add_u32 s90, s90, s100
    s_nop 1
    s_add_u32 s91, s91, s99
m_epf27_r:
    s_mov_b32 s17, s101
    s_mov_b32 s66, 2
    s_branch m_q135
m_q036:
m_eps28:
    s_nop 3
    s_mov_b32 s90, s98
    v_cvt_pk_bf16_f32 v32, v32, v33
    v_cvt_pk_bf16_f32 v33, v34, v35
    v_cvt_pk_bf16_f32 v34, v36, v37
    v_cvt_pk_bf16_f32 v35, v38, v39
    buffer_store_dwordx4 v[32:35], v2, s[8:11], s90 offen sc1
    s_add_u32 s90, s90, s100
    v_cvt_pk_bf16_f32 v40, v40, v41
    v_cvt_pk_bf16_f32 v41, v42, v43
    v_cvt_pk_bf16_f32 v42, v44, v45
    v_cvt_pk_bf16_f32 v43, v46, v47
    buffer_store_dwordx4 v[40:43], v2, s[8:11], s90 offen sc1
    s_add_u32 s90, s90, s100
    v_cvt_pk_bf16_f32 v48, v48, v49
    v_cvt_pk_bf16_f32 v49, v50, v51
    v_cvt_pk_bf16_f32 v50, v52, v53
    v_cvt_pk_bf16_f32 v51, v54, v55
    buffer_store_dwordx4 v[48:51], v2, s[8:11], s90 offen sc1
    s_add_u32 s90, s90, s100
    v_cvt_pk_bf16_f32 v56, v56, v57
    v_cvt_pk_bf16_f32 v57, v58, v59
    v_cvt_pk_bf16_f32 v58, v60, v61
    v_cvt_pk_bf16_f32 v59, v62, v63
    buffer_store_dwordx4 v[56:59], v2, s[8:11], s90 offen sc1
    s_add_u32 s90, s90, s100
    v_cvt_pk_bf16_f32 v64, v64, v65
    v_cvt_pk_bf16_f32 v65, v66, v67
    v_cvt_pk_bf16_f32 v66, v68, v69
    v_cvt_pk_bf16_f32 v67, v70, v71
    buffer_store_dwordx4 v[64:67], v2, s[8:11], s90 offen sc1
    s_add_u32 s90, s90, s100
    v_cvt_pk_bf16_f32 v72, v72, v73
    v_cvt_pk_bf16_f32 v73, v74, v75
    v_cvt_pk_bf16_f32 v74, v76, v77
    v_cvt_pk_bf16_f32 v75, v78, v79
    buffer_store_dwordx4 v[72:75], v2, s[8:11], s90 offen sc1
    s_add_u32 s90, s90, s100
    v_cvt_pk_bf16_f32 v80, v80, v81
    v_cvt_pk_bf16_f32 v81, v82, v83
    v_cvt_pk_bf16_f32 v82, v84, v85
    v_cvt_pk_bf16_f32 v83, v86, v87
    buffer_store_dwordx4 v[80:83], v2, s[8:11], s90 offen sc1
    s_add_u32 s90, s90, s100
    v_cvt_pk_bf16_f32 v88, v88, v89
    v_cvt_pk_bf16_f32 v89, v90, v91
    v_cvt_pk_bf16_f32 v90, v92, v93
    v_cvt_pk_bf16_f32 v91, v94, v95
    buffer_store_dwordx4 v[88:91], v2, s[8:11], s90 offen sc1
    s_add_u32 s90, s90, s100
    v_cvt_pk_bf16_f32 v96, v96, v97
    v_cvt_pk_bf16_f32 v97, v98, v99
    v_cvt_pk_bf16_f32 v98, v100, v101
    v_cvt_pk_bf16_f32 v99, v102, v103
    v_accvgpr_write_b32 a128, v96
    v_accvgpr_write_b32 a129, v97
    v_accvgpr_write_b32 a130, v98
    v_accvgpr_write_b32 a131, v99
    v_cvt_pk_bf16_f32 v104, v104, v105
    v_cvt_pk_bf16_f32 v105, v106, v107
    v_cvt_pk_bf16_f32 v106, v108, v109
    v_cvt_pk_bf16_f32 v107, v110, v111
    v_accvgpr_write_b32 a132, v104
    v_accvgpr_write_b32 a133, v105
    v_accvgpr_write_b32 a134, v106
    v_accvgpr_write_b32 a135, v107
    v_cvt_pk_bf16_f32 v112, v112, v113
    v_cvt_pk_bf16_f32 v113, v114, v115
    v_cvt_pk_bf16_f32 v114, v116, v117
    v_cvt_pk_bf16_f32 v115, v118, v119
    v_accvgpr_write_b32 a136, v112
    v_accvgpr_write_b32 a137, v113
    v_accvgpr_write_b32 a138, v114
    v_accvgpr_write_b32 a139, v115
    v_cvt_pk_bf16_f32 v120, v120, v121
    v_cvt_pk_bf16_f32 v121, v122, v123
    v_cvt_pk_bf16_f32 v122, v124, v125
    v_cvt_pk_bf16_f32 v123, v126, v127
    v_accvgpr_write_b32 a140, v120
    v_accvgpr_write_b32 a141, v121
    v_accvgpr_write_b32 a142, v122
    v_accvgpr_write_b32 a143, v123
    v_cvt_pk_bf16_f32 v128, v128, v129
    v_cvt_pk_bf16_f32 v129, v130, v131
    v_cvt_pk_bf16_f32 v130, v132, v133
    v_cvt_pk_bf16_f32 v131, v134, v135
    v_accvgpr_write_b32 a144, v128
    v_accvgpr_write_b32 a145, v129
    v_accvgpr_write_b32 a146, v130
    v_accvgpr_write_b32 a147, v131
    v_cvt_pk_bf16_f32 v136, v136, v137
    v_cvt_pk_bf16_f32 v137, v138, v139
    v_cvt_pk_bf16_f32 v138, v140, v141
    v_cvt_pk_bf16_f32 v139, v142, v143
    v_accvgpr_write_b32 a148, v136
    v_accvgpr_write_b32 a149, v137
    v_accvgpr_write_b32 a150, v138
    v_accvgpr_write_b32 a151, v139
    v_cvt_pk_bf16_f32 v144, v144, v145
    v_cvt_pk_bf16_f32 v145, v146, v147
    v_cvt_pk_bf16_f32 v146, v148, v149
    v_cvt_pk_bf16_f32 v147, v150, v151
    v_accvgpr_write_b32 a152, v144
    v_accvgpr_write_b32 a153, v145
    v_accvgpr_write_b32 a154, v146
    v_accvgpr_write_b32 a155, v147
    v_cvt_pk_bf16_f32 v152, v152, v153
    v_cvt_pk_bf16_f32 v153, v154, v155
    v_cvt_pk_bf16_f32 v154, v156, v157
    v_cvt_pk_bf16_f32 v155, v158, v159
    v_accvgpr_write_b32 a156, v152
    v_accvgpr_write_b32 a157, v153
    v_accvgpr_write_b32 a158, v154
    v_accvgpr_write_b32 a159, v155
    v_cvt_pk_bf16_f32 v160, v160, v161
    v_cvt_pk_bf16_f32 v161, v162, v163
    v_cvt_pk_bf16_f32 v162, v164, v165
    v_cvt_pk_bf16_f32 v163, v166, v167
    v_accvgpr_write_b32 a160, v160
    v_accvgpr_write_b32 a161, v161
    v_accvgpr_write_b32 a162, v162
    v_accvgpr_write_b32 a163, v163
    v_cvt_pk_bf16_f32 v168, v168, v169
    v_cvt_pk_bf16_f32 v169, v170, v171
    v_cvt_pk_bf16_f32 v170, v172, v173
    v_cvt_pk_bf16_f32 v171, v174, v175
    v_accvgpr_write_b32 a164, v168
    v_accvgpr_write_b32 a165, v169
    v_accvgpr_write_b32 a166, v170
    v_accvgpr_write_b32 a167, v171
    v_cvt_pk_bf16_f32 v176, v176, v177
    v_cvt_pk_bf16_f32 v177, v178, v179
    v_cvt_pk_bf16_f32 v178, v180, v181
    v_cvt_pk_bf16_f32 v179, v182, v183
    v_accvgpr_write_b32 a168, v176
    v_accvgpr_write_b32 a169, v177
    v_accvgpr_write_b32 a170, v178
    v_accvgpr_write_b32 a171, v179
    v_cvt_pk_bf16_f32 v184, v184, v185
    v_cvt_pk_bf16_f32 v185, v186, v187
    v_cvt_pk_bf16_f32 v186, v188, v189
    v_cvt_pk_bf16_f32 v187, v190, v191
    v_accvgpr_write_b32 a172, v184
    v_accvgpr_write_b32 a173, v185
    v_accvgpr_write_b32 a174, v186
    v_accvgpr_write_b32 a175, v187
    v_cvt_pk_bf16_f32 v192, v192, v193
    v_cvt_pk_bf16_f32 v193, v194, v195
    v_cvt_pk_bf16_f32 v194, v196, v197
    v_cvt_pk_bf16_f32 v195, v198, v199
    v_accvgpr_write_b32 a176, v192
    v_accvgpr_write_b32 a177, v193
    v_accvgpr_write_b32 a178, v194
    v_accvgpr_write_b32 a179, v195
    v_cvt_pk_bf16_f32 v200, v200, v201
    v_cvt_pk_bf16_f32 v201, v202, v203
    v_cvt_pk_bf16_f32 v202, v204, v205
    v_cvt_pk_bf16_f32 v203, v206, v207
    v_accvgpr_write_b32 a180, v200
    v_accvgpr_write_b32 a181, v201
    v_accvgpr_write_b32 a182, v202
    v_accvgpr_write_b32 a183, v203
    v_cvt_pk_bf16_f32 v208, v208, v209
    v_cvt_pk_bf16_f32 v209, v210, v211
    v_cvt_pk_bf16_f32 v210, v212, v213
    v_cvt_pk_bf16_f32 v211, v214, v215
    v_accvgpr_write_b32 a184, v208
    v_accvgpr_write_b32 a185, v209
    v_accvgpr_write_b32 a186, v210
    v_accvgpr_write_b32 a187, v211
    v_cvt_pk_bf16_f32 v216, v216, v217
    v_cvt_pk_bf16_f32 v217, v218, v219
    v_cvt_pk_bf16_f32 v218, v220, v221
    v_cvt_pk_bf16_f32 v219, v222, v223
    v_accvgpr_write_b32 a188, v216
    v_accvgpr_write_b32 a189, v217
    v_accvgpr_write_b32 a190, v218
    v_accvgpr_write_b32 a191, v219
    v_cvt_pk_bf16_f32 v224, v224, v225
    v_cvt_pk_bf16_f32 v225, v226, v227
    v_cvt_pk_bf16_f32 v226, v228, v229
    v_cvt_pk_bf16_f32 v227, v230, v231
    v_accvgpr_write_b32 a192, v224
    v_accvgpr_write_b32 a193, v225
    v_accvgpr_write_b32 a194, v226
    v_accvgpr_write_b32 a195, v227
    v_cvt_pk_bf16_f32 v232, v232, v233
    v_cvt_pk_bf16_f32 v233, v234, v235
    v_cvt_pk_bf16_f32 v234, v236, v237
    v_cvt_pk_bf16_f32 v235, v238, v239
    v_accvgpr_write_b32 a196, v232
    v_accvgpr_write_b32 a197, v233
    v_accvgpr_write_b32 a198, v234
    v_accvgpr_write_b32 a199, v235
    v_cvt_pk_bf16_f32 v240, v240, v241
    v_cvt_pk_bf16_f32 v241, v242, v243
    v_cvt_pk_bf16_f32 v242, v244, v245
    v_cvt_pk_bf16_f32 v243, v246, v247
    v_accvgpr_write_b32 a200, v240
    v_accvgpr_write_b32 a201, v241
    v_accvgpr_write_b32 a202, v242
    v_accvgpr_write_b32 a203, v243
    v_cvt_pk_bf16_f32 v248, v248, v249
    v_cvt_pk_bf16_f32 v249, v250, v251
    v_cvt_pk_bf16_f32 v250, v252, v253
    v_cvt_pk_bf16_f32 v251, v254, v255
    v_accvgpr_write_b32 a204, v248
    v_accvgpr_write_b32 a205, v249
    v_accvgpr_write_b32 a206, v250
    v_accvgpr_write_b32 a207, v251
    v_accvgpr_read_b32 v24, a224
    v_accvgpr_read_b32 v25, a225
    v_accvgpr_read_b32 v26, a226
    v_accvgpr_read_b32 v27, a227
    v_accvgpr_read_b32 v28, a228
    v_accvgpr_read_b32 v29, a229
    v_accvgpr_read_b32 v30, a230
    v_accvgpr_read_b32 v31, a231
    v_cvt_pk_bf16_f32 v24, v24, v25
    v_cvt_pk_bf16_f32 v25, v26, v27
    v_cvt_pk_bf16_f32 v26, v28, v29
    v_cvt_pk_bf16_f32 v27, v30, v31
    v_accvgpr_write_b32 a208, v24
    v_accvgpr_write_b32 a209, v25
    v_accvgpr_write_b32 a210, v26
    v_accvgpr_write_b32 a211, v27
    v_accvgpr_read_b32 v24, a232
    v_accvgpr_read_b32 v25, a233
    v_accvgpr_read_b32 v26, a234
    v_accvgpr_read_b32 v27, a235
    v_accvgpr_read_b32 v28, a236
    v_accvgpr_read_b32 v29, a237
    v_accvgpr_read_b32 v30, a238
    v_accvgpr_read_b32 v31, a239
    v_cvt_pk_bf16_f32 v24, v24, v25
    v_cvt_pk_bf16_f32 v25, v26, v27
    v_cvt_pk_bf16_f32 v26, v28, v29
    v_cvt_pk_bf16_f32 v27, v30, v31
    v_accvgpr_write_b32 a212, v24
    v_accvgpr_write_b32 a213, v25
    v_accvgpr_write_b32 a214, v26
    v_accvgpr_write_b32 a215, v27
    v_accvgpr_read_b32 v24, a240
    v_accvgpr_read_b32 v25, a241
    v_accvgpr_read_b32 v26, a242
    v_accvgpr_read_b32 v27, a243
    v_accvgpr_read_b32 v28, a244
    v_accvgpr_read_b32 v29, a245
    v_accvgpr_read_b32 v30, a246
    v_accvgpr_read_b32 v31, a247
    v_cvt_pk_bf16_f32 v24, v24, v25
    v_cvt_pk_bf16_f32 v25, v26, v27
    v_cvt_pk_bf16_f32 v26, v28, v29
    v_cvt_pk_bf16_f32 v27, v30, v31
    v_accvgpr_write_b32 a216, v24
    v_accvgpr_write_b32 a217, v25
    v_accvgpr_write_b32 a218, v26
    v_accvgpr_write_b32 a219, v27
    v_accvgpr_read_b32 v24, a248
    v_accvgpr_read_b32 v25, a249
    v_accvgpr_read_b32 v26, a250
    v_accvgpr_read_b32 v27, a251
    v_accvgpr_read_b32 v28, a252
    v_accvgpr_read_b32 v29, a253
    v_accvgpr_read_b32 v30, a254
    v_accvgpr_read_b32 v31, a255
    v_cvt_pk_bf16_f32 v24, v24, v25
    v_cvt_pk_bf16_f32 v25, v26, v27
    v_cvt_pk_bf16_f32 v26, v28, v29
    v_cvt_pk_bf16_f32 v27, v30, v31
    v_accvgpr_write_b32 a220, v24
    v_accvgpr_write_b32 a221, v25
    v_accvgpr_write_b32 a222, v26
    v_accvgpr_write_b32 a223, v27
m_eps28_r:
    s_mov_b32 s17, s101
    s_add_u32 s28, s98, s99
    s_mov_b32 s29, s28
    s_mov_b32 s30, s99
    s_mov_b32 s31, s100
    s_mov_b32 s26, 268435456
m_q135:
    s_mov_b32 s95, s82
    s_mov_b32 s96, s83
    s_mov_b32 s97, s84
    s_mov_b32 s98, s85
    s_mov_b32 s99, s86
    s_mov_b32 s100, s87
    s_mov_b32 s101, s88
    s_sub_u32 s67, s95, 5
    s_max_u32 s67, s67, 4
    s_mov_b32 s94, 0
    s_branch m_tile14
m_last29:
m_kvl32:
    s_waitcnt lgkmcnt(0)
    s_and_b32 s92, s2, 7
    s_lshl_b32 s92, s92, 2
    s_bfe_u32 s93, s2, 0x20003
    s_add_u32 s92, s92, s93
    s_lshr_b32 s93, s2, 5
    s_lshl_b32 s93, s93, 2
    s_or_b32 s93, s93, 0x40000
    s_mov_b32 s32, s92
    s_bfe_u32 s33, 4225681832, s93
    s_add_u32 s33, s33, 1
    s_bfe_u32 s34, 873473623, s93
    s_add_u32 s34, s34, 1
    s_lshl_b32 s60, s16, 12
    v_add_u32 v7, s60, v2
    s_lshl_b32 s90, s34, 2
    s_lshl_b32 s91, s33, 2
    s_lshl_b32 s26, s91, 13
    s_mov_b32 s30, s26
    s_sub_u32 s67, s90, 4
    s_add_u32 s67, s67, s16
    s_add_u32 s68, s67, 1
    s_mov_b32 s69, s90
    s_sub_u32 s70, s91, 4
    s_add_u32 s70, s70, s16
    s_add_u32 s71, s70, 1
    s_mov_b32 s72, s91
    s_cmp_lt_u32 s16, 2
    s_cselect_b32 s90, 2, 0
    s_sub_u32 s72, s72, s90
    s_mov_b32 s27, 0x20000
    s_mov_b32 s31, 0x20000
    s_lshl_b32 s82, s32, 19
    s_add_u32 s90, s82, 16777216
    s_add_u32 s24, s6, s90
    s_addc_u32 s25, s7, 0
    s_add_u32 s90, s82, 33554432
    s_add_u32 s28, s6, s90
    s_addc_u32 s29, s7, 0
    s_load_dwordx2 s[48:49], s[0:1], 64
    s_load_dwordx2 s[50:51], s[0:1], 16
    s_load_dwordx2 s[54:55], s[0:1], 72
    s_mov_b32 s47, 0x20000
m_epl85:
    s_mov_b32 s92, s97
    s_mov_b32 s93, s97
    s_cmp_eq_u32 s97, 0
    s_cbranch_scc1 m_ns286
    s_mov_b32 s90, s98
    v_pk_mul_f32 v[32:33], v[32:33], s[92:93]
    v_pk_mul_f32 v[34:35], v[34:35], s[92:93]
    v_pk_mul_f32 v[36:37], v[36:37], s[92:93]
    v_pk_mul_f32 v[38:39], v[38:39], s[92:93]
    v_cvt_pk_bf16_f32 v32, v32, v33
    v_cvt_pk_bf16_f32 v33, v34, v35
    v_cvt_pk_bf16_f32 v34, v36, v37
    v_cvt_pk_bf16_f32 v35, v38, v39
    buffer_store_dwordx4 v[32:35], v2, s[8:11], s90 offen sc1
    s_add_u32 s90, s90, s100
    v_accvgpr_write_b32 a0, 0
    v_accvgpr_write_b32 a1, 0
    v_accvgpr_write_b32 a2, 0
    v_accvgpr_write_b32 a3, 0
    v_accvgpr_write_b32 a4, 0
    v_accvgpr_write_b32 a5, 0
    v_accvgpr_write_b32 a6, 0
    v_accvgpr_write_b32 a7, 0
    v_pk_mul_f32 v[192:193], v[192:193], s[92:93]
    v_pk_mul_f32 v[194:195], v[194:195], s[92:93]
    v_pk_mul_f32 v[196:197], v[196:197], s[92:93]
    v_pk_mul_f32 v[198:199], v[198:199], s[92:93]
    v_cvt_pk_bf16_f32 v192, v192, v193
    v_cvt_pk_bf16_f32 v193, v194, v195
    v_cvt_pk_bf16_f32 v194, v196, v197
    v_cvt_pk_bf16_f32 v195, v198, v199
    v_pk_mul_f32 v[40:41], v[40:41], s[92:93]
    v_pk_mul_f32 v[42:43], v[42:43], s[92:93]
    v_pk_mul_f32 v[44:45], v[44:45], s[92:93]
    v_pk_mul_f32 v[46:47], v[46:47], s[92:93]
    v_cvt_pk_bf16_f32 v40, v40, v41
    v_cvt_pk_bf16_f32 v41, v42, v43
    v_cvt_pk_bf16_f32 v42, v44, v45
    v_cvt_pk_bf16_f32 v43, v46, v47
    buffer_store_dwordx4 v[40:43], v2, s[8:11], s90 offen sc1
    s_add_u32 s90, s90, s100
    v_accvgpr_write_b32 a8, 0
    v_accvgpr_write_b32 a9, 0
    v_accvgpr_write_b32 a10, 0
    v_accvgpr_write_b32 a11, 0
    v_accvgpr_write_b32 a12, 0
    v_accvgpr_write_b32 a13, 0
    v_accvgpr_write_b32 a14, 0
    v_accvgpr_write_b32 a15, 0
    v_pk_mul_f32 v[200:201], v[200:201], s[92:93]
    v_pk_mul_f32 v[202:203], v[202:203], s[92:93]
    v_pk_mul_f32 v[204:205], v[204:205], s[92:93]
    v_pk_mul_f32 v[206:207], v[206:207], s[92:93]
    v_cvt_pk_bf16_f32 v196, v200, v201
    v_cvt_pk_bf16_f32 v197, v202, v203
    v_cvt_pk_bf16_f32 v198, v204, v205
    v_cvt_pk_bf16_f32 v199, v206, v207
    v_pk_mul_f32 v[48:49], v[48:49], s[92:93]
    v_pk_mul_f32 v[50:51], v[50:51], s[92:93]
    v_pk_mul_f32 v[52:53], v[52:53], s[92:93]
    v_pk_mul_f32 v[54:55], v[54:55], s[92:93]
    v_cvt_pk_bf16_f32 v48, v48, v49
    v_cvt_pk_bf16_f32 v49, v50, v51
    v_cvt_pk_bf16_f32 v50, v52, v53
    v_cvt_pk_bf16_f32 v51, v54, v55
    buffer_store_dwordx4 v[48:51], v2, s[8:11], s90 offen sc1
    s_add_u32 s90, s90, s100
    v_accvgpr_write_b32 a16, 0
    v_accvgpr_write_b32 a17, 0
    v_accvgpr_write_b32 a18, 0
    v_accvgpr_write_b32 a19, 0
    v_accvgpr_write_b32 a20, 0
    v_accvgpr_write_b32 a21, 0
    v_accvgpr_write_b32 a22, 0
    v_accvgpr_write_b32 a23, 0
    v_pk_mul_f32 v[208:209], v[208:209], s[92:93]
    v_pk_mul_f32 v[210:211], v[210:211], s[92:93]
    v_pk_mul_f32 v[212:213], v[212:213], s[92:93]
    v_pk_mul_f32 v[214:215], v[214:215], s[92:93]
    v_cvt_pk_bf16_f32 v200, v208, v209
    v_cvt_pk_bf16_f32 v201, v210, v211
    v_cvt_pk_bf16_f32 v202, v212, v213
    v_cvt_pk_bf16_f32 v203, v214, v215
    v_pk_mul_f32 v[56:57], v[56:57], s[92:93]
    v_pk_mul_f32 v[58:59], v[58:59], s[92:93]
    v_pk_mul_f32 v[60:61], v[60:61], s[92:93]
    v_pk_mul_f32 v[62:63], v[62:63], s[92:93]
    v_cvt_pk_bf16_f32 v56, v56, v57
    v_cvt_pk_bf16_f32 v57, v58, v59
    v_cvt_pk_bf16_f32 v58, v60, v61
    v_cvt_pk_bf16_f32 v59, v62, v63
    buffer_store_dwordx4 v[56:59], v2, s[8:11], s90 offen sc1
    s_add_u32 s90, s90, s100
    v_accvgpr_write_b32 a24, 0
    v_accvgpr_write_b32 a25, 0
    v_accvgpr_write_b32 a26, 0
    v_accvgpr_write_b32 a27, 0
    v_accvgpr_write_b32 a28, 0
    v_accvgpr_write_b32 a29, 0
    v_accvgpr_write_b32 a30, 0
    v_accvgpr_write_b32 a31, 0
    v_pk_mul_f32 v[216:217], v[216:217], s[92:93]
    v_pk_mul_f32 v[218:219], v[218:219], s[92:93]
    v_pk_mul_f32 v[220:221], v[220:221], s[92:93]
    v_pk_mul_f32 v[222:223], v[222:223], s[92:93]
    v_cvt_pk_bf16_f32 v204, v216, v217
    v_cvt_pk_bf16_f32 v205, v218, v219
    v_cvt_pk_bf16_f32 v206, v220, v221
    v_cvt_pk_bf16_f32 v207, v222, v223
    v_pk_mul_f32 v[64:65], v[64:65], s[92:93]
    v_pk_mul_f32 v[66:67], v[66:67], s[92:93]
    v_pk_mul_f32 v[68:69], v[68:69], s[92:93]
    v_pk_mul_f32 v[70:71], v[70:71], s[92:93]
    v_cvt_pk_bf16_f32 v64, v64, v65
    v_cvt_pk_bf16_f32 v65, v66, v67
    v_cvt_pk_bf16_f32 v66, v68, v69
    v_cvt_pk_bf16_f32 v67, v70, v71
    buffer_store_dwordx4 v[64:67], v2, s[8:11], s90 offen sc1
    s_add_u32 s90, s90, s100
    v_accvgpr_write_b32 a32, 0
    v_accvgpr_write_b32 a33, 0
    v_accvgpr_write_b32 a34, 0
    v_accvgpr_write_b32 a35, 0
    v_accvgpr_write_b32 a36, 0
    v_accvgpr_write_b32 a37, 0
    v_accvgpr_write_b32 a38, 0
    v_accvgpr_write_b32 a39, 0
    v_pk_mul_f32 v[224:225], v[224:225], s[92:93]
    v_pk_mul_f32 v[226:227], v[226:227], s[92:93]
    v_pk_mul_f32 v[228:229], v[228:229], s[92:93]
    v_pk_mul_f32 v[230:231], v[230:231], s[92:93]
    v_cvt_pk_bf16_f32 v208, v224, v225
    v_cvt_pk_bf16_f32 v209, v226, v227
    v_cvt_pk_bf16_f32 v210, v228, v229
    v_cvt_pk_bf16_f32 v211, v230, v231
    v_pk_mul_f32 v[72:73], v[72:73], s[92:93]
    v_pk_mul_f32 v[74:75], v[74:75], s[92:93]
    v_pk_mul_f32 v[76:77], v[76:77], s[92:93]
    v_pk_mul_f32 v[78:79], v[78:79], s[92:93]
    v_cvt_pk_bf16_f32 v72, v72, v73
    v_cvt_pk_bf16_f32 v73, v74, v75
    v_cvt_pk_bf16_f32 v74, v76, v77
    v_cvt_pk_bf16_f32 v75, v78, v79
    buffer_store_dwordx4 v[72:75], v2, s[8:11], s90 offen sc1
    s_add_u32 s90, s90, s100
    v_accvgpr_write_b32 a40, 0
    v_accvgpr_write_b32 a41, 0
    v_accvgpr_write_b32 a42, 0
    v_accvgpr_write_b32 a43, 0
    v_accvgpr_write_b32 a44, 0
    v_accvgpr_write_b32 a45, 0
    v_accvgpr_write_b32 a46, 0
    v_accvgpr_write_b32 a47, 0
    v_pk_mul_f32 v[232:233], v[232:233], s[92:93]
    v_pk_mul_f32 v[234:235], v[234:235], s[92:93]
    v_pk_mul_f32 v[236:237], v[236:237], s[92:93]
    v_pk_mul_f32 v[238:239], v[238:239], s[92:93]
    v_cvt_pk_bf16_f32 v212, v232, v233
    v_cvt_pk_bf16_f32 v213, v234, v235
    v_cvt_pk_bf16_f32 v214, v236, v237
    v_cvt_pk_bf16_f32 v215, v238, v239
    v_pk_mul_f32 v[80:81], v[80:81], s[92:93]
    v_pk_mul_f32 v[82:83], v[82:83], s[92:93]
    v_pk_mul_f32 v[84:85], v[84:85], s[92:93]
    v_pk_mul_f32 v[86:87], v[86:87], s[92:93]
    v_cvt_pk_bf16_f32 v80, v80, v81
    v_cvt_pk_bf16_f32 v81, v82, v83
    v_cvt_pk_bf16_f32 v82, v84, v85
    v_cvt_pk_bf16_f32 v83, v86, v87
    buffer_store_dwordx4 v[80:83], v2, s[8:11], s90 offen sc1
    s_add_u32 s90, s90, s100
    v_accvgpr_write_b32 a48, 0
    v_accvgpr_write_b32 a49, 0
    v_accvgpr_write_b32 a50, 0
    v_accvgpr_write_b32 a51, 0
    v_accvgpr_write_b32 a52, 0
    v_accvgpr_write_b32 a53, 0
    v_accvgpr_write_b32 a54, 0
    v_accvgpr_write_b32 a55, 0
    v_pk_mul_f32 v[240:241], v[240:241], s[92:93]
    v_pk_mul_f32 v[242:243], v[242:243], s[92:93]
    v_pk_mul_f32 v[244:245], v[244:245], s[92:93]
    v_pk_mul_f32 v[246:247], v[246:247], s[92:93]
    v_cvt_pk_bf16_f32 v216, v240, v241
    v_cvt_pk_bf16_f32 v217, v242, v243
    v_cvt_pk_bf16_f32 v218, v244, v245
    v_cvt_pk_bf16_f32 v219, v246, v247
    v_pk_mul_f32 v[88:89], v[88:89], s[92:93]
    v_pk_mul_f32 v[90:91], v[90:91], s[92:93]
    v_pk_mul_f32 v[92:93], v[92:93], s[92:93]
    v_pk_mul_f32 v[94:95], v[94:95], s[92:93]
    v_cvt_pk_bf16_f32 v88, v88, v89
    v_cvt_pk_bf16_f32 v89, v90, v91
    v_cvt_pk_bf16_f32 v90, v92, v93
    v_cvt_pk_bf16_f32 v91, v94, v95
    buffer_store_dwordx4 v[88:91], v2, s[8:11], s90 offen sc1
    s_add_u32 s90, s98, s99
    v_accvgpr_write_b32 a56, 0
    v_accvgpr_write_b32 a57, 0
    v_accvgpr_write_b32 a58, 0
    v_accvgpr_write_b32 a59, 0
    v_accvgpr_write_b32 a60, 0
    v_accvgpr_write_b32 a61, 0
    v_accvgpr_write_b32 a62, 0
    v_accvgpr_write_b32 a63, 0
    v_pk_mul_f32 v[248:249], v[248:249], s[92:93]
    v_pk_mul_f32 v[250:251], v[250:251], s[92:93]
    v_pk_mul_f32 v[252:253], v[252:253], s[92:93]
    v_pk_mul_f32 v[254:255], v[254:255], s[92:93]
    v_cvt_pk_bf16_f32 v220, v248, v249
    v_cvt_pk_bf16_f32 v221, v250, v251
    v_cvt_pk_bf16_f32 v222, v252, v253
    v_cvt_pk_bf16_f32 v223, v254, v255
    v_pk_mul_f32 v[96:97], v[96:97], s[92:93]
    v_pk_mul_f32 v[98:99], v[98:99], s[92:93]
    v_pk_mul_f32 v[100:101], v[100:101], s[92:93]
    v_pk_mul_f32 v[102:103], v[102:103], s[92:93]
    v_cvt_pk_bf16_f32 v96, v96, v97
    v_cvt_pk_bf16_f32 v97, v98, v99
    v_cvt_pk_bf16_f32 v98, v100, v101
    v_cvt_pk_bf16_f32 v99, v102, v103
    buffer_store_dwordx4 v[96:99], v2, s[8:11], s90 offen sc1
    s_add_u32 s90, s90, s100
    v_accvgpr_write_b32 a64, 0
    v_accvgpr_write_b32 a65, 0
    v_accvgpr_write_b32 a66, 0
    v_accvgpr_write_b32 a67, 0
    v_accvgpr_write_b32 a68, 0
    v_accvgpr_write_b32 a69, 0
    v_accvgpr_write_b32 a70, 0
    v_accvgpr_write_b32 a71, 0
    v_accvgpr_read_b32 v24, a224
    v_accvgpr_read_b32 v25, a225
    v_accvgpr_read_b32 v26, a226
    v_accvgpr_read_b32 v27, a227
    v_accvgpr_read_b32 v28, a228
    v_accvgpr_read_b32 v29, a229
    v_accvgpr_read_b32 v30, a230
    v_accvgpr_read_b32 v31, a231
    v_pk_mul_f32 v[24:25], v[24:25], s[92:93]
    v_pk_mul_f32 v[26:27], v[26:27], s[92:93]
    v_pk_mul_f32 v[28:29], v[28:29], s[92:93]
    v_pk_mul_f32 v[30:31], v[30:31], s[92:93]
    v_cvt_pk_bf16_f32 v224, v24, v25
    v_cvt_pk_bf16_f32 v225, v26, v27
    v_cvt_pk_bf16_f32 v226, v28, v29
    v_cvt_pk_bf16_f32 v227, v30, v31
    v_pk_mul_f32 v[104:105], v[104:105], s[92:93]
    v_pk_mul_f32 v[106:107], v[106:107], s[92:93]
    v_pk_mul_f32 v[108:109], v[108:109], s[92:93]
    v_pk_mul_f32 v[110:111], v[110:111], s[92:93]
    v_cvt_pk_bf16_f32 v104, v104, v105
    v_cvt_pk_bf16_f32 v105, v106, v107
    v_cvt_pk_bf16_f32 v106, v108, v109
    v_cvt_pk_bf16_f32 v107, v110, v111
    buffer_store_dwordx4 v[104:107], v2, s[8:11], s90 offen sc1
    s_add_u32 s90, s90, s100
    v_accvgpr_write_b32 a72, 0
    v_accvgpr_write_b32 a73, 0
    v_accvgpr_write_b32 a74, 0
    v_accvgpr_write_b32 a75, 0
    v_accvgpr_write_b32 a76, 0
    v_accvgpr_write_b32 a77, 0
    v_accvgpr_write_b32 a78, 0
    v_accvgpr_write_b32 a79, 0
    v_accvgpr_read_b32 v24, a232
    v_accvgpr_read_b32 v25, a233
    v_accvgpr_read_b32 v26, a234
    v_accvgpr_read_b32 v27, a235
    v_accvgpr_read_b32 v28, a236
    v_accvgpr_read_b32 v29, a237
    v_accvgpr_read_b32 v30, a238
    v_accvgpr_read_b32 v31, a239
    v_pk_mul_f32 v[24:25], v[24:25], s[92:93]
    v_pk_mul_f32 v[26:27], v[26:27], s[92:93]
    v_pk_mul_f32 v[28:29], v[28:29], s[92:93]
    v_pk_mul_f32 v[30:31], v[30:31], s[92:93]
    v_cvt_pk_bf16_f32 v228, v24, v25
    v_cvt_pk_bf16_f32 v229, v26, v27
    v_cvt_pk_bf16_f32 v230, v28, v29
    v_cvt_pk_bf16_f32 v231, v30, v31
    v_pk_mul_f32 v[112:113], v[112:113], s[92:93]
    v_pk_mul_f32 v[114:115], v[114:115], s[92:93]
    v_pk_mul_f32 v[116:117], v[116:117], s[92:93]
    v_pk_mul_f32 v[118:119], v[118:119], s[92:93]
    v_cvt_pk_bf16_f32 v112, v112, v113
    v_cvt_pk_bf16_f32 v113, v114, v115
    v_cvt_pk_bf16_f32 v114, v116, v117
    v_cvt_pk_bf16_f32 v115, v118, v119
    buffer_store_dwordx4 v[112:115], v2, s[8:11], s90 offen sc1
    s_add_u32 s90, s90, s100
    v_accvgpr_write_b32 a80, 0
    v_accvgpr_write_b32 a81, 0
    v_accvgpr_write_b32 a82, 0
    v_accvgpr_write_b32 a83, 0
    v_accvgpr_write_b32 a84, 0
    v_accvgpr_write_b32 a85, 0
    v_accvgpr_write_b32 a86, 0
    v_accvgpr_write_b32 a87, 0
    v_accvgpr_read_b32 v24, a240
    v_accvgpr_read_b32 v25, a241
    v_accvgpr_read_b32 v26, a242
    v_accvgpr_read_b32 v27, a243
    v_accvgpr_read_b32 v28, a244
    v_accvgpr_read_b32 v29, a245
    v_accvgpr_read_b32 v30, a246
    v_accvgpr_read_b32 v31, a247
    v_pk_mul_f32 v[24:25], v[24:25], s[92:93]
    v_pk_mul_f32 v[26:27], v[26:27], s[92:93]
    v_pk_mul_f32 v[28:29], v[28:29], s[92:93]
    v_pk_mul_f32 v[30:31], v[30:31], s[92:93]
    v_cvt_pk_bf16_f32 v232, v24, v25
    v_cvt_pk_bf16_f32 v233, v26, v27
    v_cvt_pk_bf16_f32 v234, v28, v29
    v_cvt_pk_bf16_f32 v235, v30, v31
    v_pk_mul_f32 v[120:121], v[120:121], s[92:93]
    v_pk_mul_f32 v[122:123], v[122:123], s[92:93]
    v_pk_mul_f32 v[124:125], v[124:125], s[92:93]
    v_pk_mul_f32 v[126:127], v[126:127], s[92:93]
    v_cvt_pk_bf16_f32 v120, v120, v121
    v_cvt_pk_bf16_f32 v121, v122, v123
    v_cvt_pk_bf16_f32 v122, v124, v125
    v_cvt_pk_bf16_f32 v123, v126, v127
    buffer_store_dwordx4 v[120:123], v2, s[8:11], s90 offen sc1
    s_add_u32 s90, s90, s100
    v_accvgpr_write_b32 a88, 0
    v_accvgpr_write_b32 a89, 0
    v_accvgpr_write_b32 a90, 0
    v_accvgpr_write_b32 a91, 0
    v_accvgpr_write_b32 a92, 0
    v_accvgpr_write_b32 a93, 0
    v_accvgpr_write_b32 a94, 0
    v_accvgpr_write_b32 a95, 0
    v_accvgpr_read_b32 v24, a248
    v_accvgpr_read_b32 v25, a249
    v_accvgpr_read_b32 v26, a250
    v_accvgpr_read_b32 v27, a251
    v_accvgpr_read_b32 v28, a252
    v_accvgpr_read_b32 v29, a253
    v_accvgpr_read_b32 v30, a254
    v_accvgpr_read_b32 v31, a255
    v_pk_mul_f32 v[24:25], v[24:25], s[92:93]
    v_pk_mul_f32 v[26:27], v[26:27], s[92:93]
    v_pk_mul_f32 v[28:29], v[28:29], s[92:93]
    v_pk_mul_f32 v[30:31], v[30:31], s[92:93]
    v_cvt_pk_bf16_f32 v236, v24, v25
    v_cvt_pk_bf16_f32 v237, v26, v27
    v_cvt_pk_bf16_f32 v238, v28, v29
    v_cvt_pk_bf16_f32 v239, v30, v31
    v_pk_mul_f32 v[128:129], v[128:129], s[92:93]
    v_pk_mul_f32 v[130:131], v[130:131], s[92:93]
    v_pk_mul_f32 v[132:133], v[132:133], s[92:93]
    v_pk_mul_f32 v[134:135], v[134:135], s[92:93]
    v_cvt_pk_bf16_f32 v128, v128, v129
    v_cvt_pk_bf16_f32 v129, v130, v131
    v_cvt_pk_bf16_f32 v130, v132, v133
    v_cvt_pk_bf16_f32 v131, v134, v135
    buffer_store_dwordx4 v[128:131], v2, s[8:11], s90 offen sc1
    s_add_u32 s90, s90, s100
    v_accvgpr_write_b32 a96, 0
    v_accvgpr_write_b32 a97, 0
    v_accvgpr_write_b32 a98, 0
    v_accvgpr_write_b32 a99, 0
    v_accvgpr_write_b32 a100, 0
    v_accvgpr_write_b32 a101, 0
    v_accvgpr_write_b32 a102, 0
    v_accvgpr_write_b32 a103, 0
    v_pk_mul_f32 v[160:161], v[160:161], s[92:93]
    v_pk_mul_f32 v[162:163], v[162:163], s[92:93]
    v_pk_mul_f32 v[164:165], v[164:165], s[92:93]
    v_pk_mul_f32 v[166:167], v[166:167], s[92:93]
    v_cvt_pk_bf16_f32 v240, v160, v161
    v_cvt_pk_bf16_f32 v241, v162, v163
    v_cvt_pk_bf16_f32 v242, v164, v165
    v_cvt_pk_bf16_f32 v243, v166, v167
    v_pk_mul_f32 v[136:137], v[136:137], s[92:93]
    v_pk_mul_f32 v[138:139], v[138:139], s[92:93]
    v_pk_mul_f32 v[140:141], v[140:141], s[92:93]
    v_pk_mul_f32 v[142:143], v[142:143], s[92:93]
    v_cvt_pk_bf16_f32 v136, v136, v137
    v_cvt_pk_bf16_f32 v137, v138, v139
    v_cvt_pk_bf16_f32 v138, v140, v141
    v_cvt_pk_bf16_f32 v139, v142, v143
    buffer_store_dwordx4 v[136:139], v2, s[8:11], s90 offen sc1
    s_add_u32 s90, s90, s100
    v_accvgpr_write_b32 a104, 0
    v_accvgpr_write_b32 a105, 0
    v_accvgpr_write_b32 a106, 0
    v_accvgpr_write_b32 a107, 0
    v_accvgpr_write_b32 a108, 0
    v_accvgpr_write_b32 a109, 0
    v_accvgpr_write_b32 a110, 0
    v_accvgpr_write_b32 a111, 0
    v_pk_mul_f32 v[168:169], v[168:169], s[92:93]
    v_pk_mul_f32 v[170:171], v[170:171], s[92:93]
    v_pk_mul_f32 v[172:173], v[172:173], s[92:93]
    v_pk_mul_f32 v[174:175], v[174:175], s[92:93]
    v_cvt_pk_bf16_f32 v244, v168, v169
    v_cvt_pk_bf16_f32 v245, v170, v171
    v_cvt_pk_bf16_f32 v246, v172, v173
    v_cvt_pk_bf16_f32 v247, v174, v175
    v_pk_mul_f32 v[144:145], v[144:145], s[92:93]
    v_pk_mul_f32 v[146:147], v[146:147], s[92:93]
    v_pk_mul_f32 v[148:149], v[148:149], s[92:93]
    v_pk_mul_f32 v[150:151], v[150:151], s[92:93]
    v_cvt_pk_bf16_f32 v144, v144, v145
    v_cvt_pk_bf16_f32 v145, v146, v147
    v_cvt_pk_bf16_f32 v146, v148, v149
    v_cvt_pk_bf16_f32 v147, v150, v151
    buffer_store_dwordx4 v[144:147], v2, s[8:11], s90 offen sc1
    s_add_u32 s90, s90, s100
    v_accvgpr_write_b32 a112, 0
    v_accvgpr_write_b32 a113, 0
    v_accvgpr_write_b32 a114, 0
    v_accvgpr_write_b32 a115, 0
    v_accvgpr_write_b32 a116, 0
    v_accvgpr_write_b32 a117, 0
    v_accvgpr_write_b32 a118, 0
    v_accvgpr_write_b32 a119, 0
    v_pk_mul_f32 v[176:177], v[176:177], s[92:93]
    v_pk_mul_f32 v[178:179], v[178:179], s[92:93]
    v_pk_mul_f32 v[180:181], v[180:181], s[92:93]
    v_pk_mul_f32 v[182:183], v[182:183], s[92:93]
    v_cvt_pk_bf16_f32 v248, v176, v177
    v_cvt_pk_bf16_f32 v249, v178, v179
    v_cvt_pk_bf16_f32 v250, v180, v181
    v_cvt_pk_bf16_f32 v251, v182, v183
    v_pk_mul_f32 v[152:153], v[152:153], s[92:93]
    v_pk_mul_f32 v[154:155], v[154:155], s[92:93]
    v_pk_mul_f32 v[156:157], v[156:157], s[92:93]
    v_pk_mul_f32 v[158:159], v[158:159], s[92:93]
    v_cvt_pk_bf16_f32 v152, v152, v153
    v_cvt_pk_bf16_f32 v153, v154, v155
    v_cvt_pk_bf16_f32 v154, v156, v157
    v_cvt_pk_bf16_f32 v155, v158, v159
    buffer_store_dwordx4 v[152:155], v2, s[8:11], s90 offen sc1
    s_add_u32 s90, s90, s100
    v_accvgpr_write_b32 a120, 0
    v_accvgpr_write_b32 a121, 0
    v_accvgpr_write_b32 a122, 0
    v_accvgpr_write_b32 a123, 0
    v_accvgpr_write_b32 a124, 0
    v_accvgpr_write_b32 a125, 0
    v_accvgpr_write_b32 a126, 0
    v_accvgpr_write_b32 a127, 0
    v_pk_mul_f32 v[184:185], v[184:185], s[92:93]
    v_pk_mul_f32 v[186:187], v[186:187], s[92:93]
    v_pk_mul_f32 v[188:189], v[188:189], s[92:93]
    v_pk_mul_f32 v[190:191], v[190:191], s[92:93]
    v_cvt_pk_bf16_f32 v252, v184, v185
    v_cvt_pk_bf16_f32 v253, v186, v187
    v_cvt_pk_bf16_f32 v254, v188, v189
    v_cvt_pk_bf16_f32 v255, v190, v191
    s_branch m_epl85_r
m_ns286:
    s_mov_b32 s90, s98
    v_cvt_pk_bf16_f32 v32, v32, v33
    v_cvt_pk_bf16_f32 v33, v34, v35
    v_cvt_pk_bf16_f32 v34, v36, v37
    v_cvt_pk_bf16_f32 v35, v38, v39
    buffer_store_dwordx4 v[32:35], v2, s[8:11], s90 offen sc1
    s_add_u32 s90, s90, s100
    v_accvgpr_write_b32 a0, 0
    v_accvgpr_write_b32 a1, 0
    v_accvgpr_write_b32 a2, 0
    v_accvgpr_write_b32 a3, 0
    v_accvgpr_write_b32 a4, 0
    v_accvgpr_write_b32 a5, 0
    v_accvgpr_write_b32 a6, 0
    v_accvgpr_write_b32 a7, 0
    v_cvt_pk_bf16_f32 v192, v192, v193
    v_cvt_pk_bf16_f32 v193, v194, v195
    v_cvt_pk_bf16_f32 v194, v196, v197
    v_cvt_pk_bf16_f32 v195, v198, v199
    v_cvt_pk_bf16_f32 v40, v40, v41
    v_cvt_pk_bf16_f32 v41, v42, v43
    v_cvt_pk_bf16_f32 v42, v44, v45
    v_cvt_pk_bf16_f32 v43, v46, v47
    buffer_store_dwordx4 v[40:43], v2, s[8:11], s90 offen sc1
    s_add_u32 s90, s90, s100
    v_accvgpr_write_b32 a8, 0
    v_accvgpr_write_b32 a9, 0
    v_accvgpr_write_b32 a10, 0
    v_accvgpr_write_b32 a11, 0
    v_accvgpr_write_b32 a12, 0
    v_accvgpr_write_b32 a13, 0
    v_accvgpr_write_b32 a14, 0
    v_accvgpr_write_b32 a15, 0
    v_cvt_pk_bf16_f32 v196, v200, v201
    v_cvt_pk_bf16_f32 v197, v202, v203
    v_cvt_pk_bf16_f32 v198, v204, v205
    v_cvt_pk_bf16_f32 v199, v206, v207
    v_cvt_pk_bf16_f32 v48, v48, v49
    v_cvt_pk_bf16_f32 v49, v50, v51
    v_cvt_pk_bf16_f32 v50, v52, v53
    v_cvt_pk_bf16_f32 v51, v54, v55
    buffer_store_dwordx4 v[48:51], v2, s[8:11], s90 offen sc1
    s_add_u32 s90, s90, s100
    v_accvgpr_write_b32 a16, 0
    v_accvgpr_write_b32 a17, 0
    v_accvgpr_write_b32 a18, 0
    v_accvgpr_write_b32 a19, 0
    v_accvgpr_write_b32 a20, 0
    v_accvgpr_write_b32 a21, 0
    v_accvgpr_write_b32 a22, 0
    v_accvgpr_write_b32 a23, 0
    v_cvt_pk_bf16_f32 v200, v208, v209
    v_cvt_pk_bf16_f32 v201, v210, v211
    v_cvt_pk_bf16_f32 v202, v212, v213
    v_cvt_pk_bf16_f32 v203, v214, v215
    v_cvt_pk_bf16_f32 v56, v56, v57
    v_cvt_pk_bf16_f32 v57, v58, v59
    v_cvt_pk_bf16_f32 v58, v60, v61
    v_cvt_pk_bf16_f32 v59, v62, v63
    buffer_store_dwordx4 v[56:59], v2, s[8:11], s90 offen sc1
    s_add_u32 s90, s90, s100
    v_accvgpr_write_b32 a24, 0
    v_accvgpr_write_b32 a25, 0
    v_accvgpr_write_b32 a26, 0
    v_accvgpr_write_b32 a27, 0
    v_accvgpr_write_b32 a28, 0
    v_accvgpr_write_b32 a29, 0
    v_accvgpr_write_b32 a30, 0
    v_accvgpr_write_b32 a31, 0
    v_cvt_pk_bf16_f32 v204, v216, v217
    v_cvt_pk_bf16_f32 v205, v218, v219
    v_cvt_pk_bf16_f32 v206, v220, v221
    v_cvt_pk_bf16_f32 v207, v222, v223
    v_cvt_pk_bf16_f32 v64, v64, v65
    v_cvt_pk_bf16_f32 v65, v66, v67
    v_cvt_pk_bf16_f32 v66, v68, v69
    v_cvt_pk_bf16_f32 v67, v70, v71
    buffer_store_dwordx4 v[64:67], v2, s[8:11], s90 offen sc1
    s_add_u32 s90, s90, s100
    v_accvgpr_write_b32 a32, 0
    v_accvgpr_write_b32 a33, 0
    v_accvgpr_write_b32 a34, 0
    v_accvgpr_write_b32 a35, 0
    v_accvgpr_write_b32 a36, 0
    v_accvgpr_write_b32 a37, 0
    v_accvgpr_write_b32 a38, 0
    v_accvgpr_write_b32 a39, 0
    v_cvt_pk_bf16_f32 v208, v224, v225
    v_cvt_pk_bf16_f32 v209, v226, v227
    v_cvt_pk_bf16_f32 v210, v228, v229
    v_cvt_pk_bf16_f32 v211, v230, v231
    v_cvt_pk_bf16_f32 v72, v72, v73
    v_cvt_pk_bf16_f32 v73, v74, v75
    v_cvt_pk_bf16_f32 v74, v76, v77
    v_cvt_pk_bf16_f32 v75, v78, v79
    buffer_store_dwordx4 v[72:75], v2, s[8:11], s90 offen sc1
    s_add_u32 s90, s90, s100
    v_accvgpr_write_b32 a40, 0
    v_accvgpr_write_b32 a41, 0
    v_accvgpr_write_b32 a42, 0
    v_accvgpr_write_b32 a43, 0
    v_accvgpr_write_b32 a44, 0
    v_accvgpr_write_b32 a45, 0
    v_accvgpr_write_b32 a46, 0
    v_accvgpr_write_b32 a47, 0
    v_cvt_pk_bf16_f32 v212, v232, v233
    v_cvt_pk_bf16_f32 v213, v234, v235
    v_cvt_pk_bf16_f32 v214, v236, v237
    v_cvt_pk_bf16_f32 v215, v238, v239
    v_cvt_pk_bf16_f32 v80, v80, v81
    v_cvt_pk_bf16_f32 v81, v82, v83
    v_cvt_pk_bf16_f32 v82, v84, v85
    v_cvt_pk_bf16_f32 v83, v86, v87
    buffer_store_dwordx4 v[80:83], v2, s[8:11], s90 offen sc1
    s_add_u32 s90, s90, s100
    v_accvgpr_write_b32 a48, 0
    v_accvgpr_write_b32 a49, 0
    v_accvgpr_write_b32 a50, 0
    v_accvgpr_write_b32 a51, 0
    v_accvgpr_write_b32 a52, 0
    v_accvgpr_write_b32 a53, 0
    v_accvgpr_write_b32 a54, 0
    v_accvgpr_write_b32 a55, 0
    v_cvt_pk_bf16_f32 v216, v240, v241
    v_cvt_pk_bf16_f32 v217, v242, v243
    v_cvt_pk_bf16_f32 v218, v244, v245
    v_cvt_pk_bf16_f32 v219, v246, v247
    v_cvt_pk_bf16_f32 v88, v88, v89
    v_cvt_pk_bf16_f32 v89, v90, v91
    v_cvt_pk_bf16_f32 v90, v92, v93
    v_cvt_pk_bf16_f32 v91, v94, v95
    buffer_store_dwordx4 v[88:91], v2, s[8:11], s90 offen sc1
    s_add_u32 s90, s98, s99
    v_accvgpr_write_b32 a56, 0
    v_accvgpr_write_b32 a57, 0
    v_accvgpr_write_b32 a58, 0
    v_accvgpr_write_b32 a59, 0
    v_accvgpr_write_b32 a60, 0
    v_accvgpr_write_b32 a61, 0
    v_accvgpr_write_b32 a62, 0
    v_accvgpr_write_b32 a63, 0
    v_cvt_pk_bf16_f32 v220, v248, v249
    v_cvt_pk_bf16_f32 v221, v250, v251
    v_cvt_pk_bf16_f32 v222, v252, v253
    v_cvt_pk_bf16_f32 v223, v254, v255
    v_cvt_pk_bf16_f32 v96, v96, v97
    v_cvt_pk_bf16_f32 v97, v98, v99
    v_cvt_pk_bf16_f32 v98, v100, v101
    v_cvt_pk_bf16_f32 v99, v102, v103
    buffer_store_dwordx4 v[96:99], v2, s[8:11], s90 offen sc1
    s_add_u32 s90, s90, s100
    v_accvgpr_write_b32 a64, 0
    v_accvgpr_write_b32 a65, 0
    v_accvgpr_write_b32 a66, 0
    v_accvgpr_write_b32 a67, 0
    v_accvgpr_write_b32 a68, 0
    v_accvgpr_write_b32 a69, 0
    v_accvgpr_write_b32 a70, 0
    v_accvgpr_write_b32 a71, 0
    v_accvgpr_read_b32 v24, a224
    v_accvgpr_read_b32 v25, a225
    v_accvgpr_read_b32 v26, a226
    v_accvgpr_read_b32 v27, a227
    v_accvgpr_read_b32 v28, a228
    v_accvgpr_read_b32 v29, a229
    v_accvgpr_read_b32 v30, a230
    v_accvgpr_read_b32 v31, a231
    v_cvt_pk_bf16_f32 v224, v24, v25
    v_cvt_pk_bf16_f32 v225, v26, v27
    v_cvt_pk_bf16_f32 v226, v28, v29
    v_cvt_pk_bf16_f32 v227, v30, v31
    v_cvt_pk_bf16_f32 v104, v104, v105
    v_cvt_pk_bf16_f32 v105, v106, v107
    v_cvt_pk_bf16_f32 v106, v108, v109
    v_cvt_pk_bf16_f32 v107, v110, v111
    buffer_store_dwordx4 v[104:107], v2, s[8:11], s90 offen sc1
    s_add_u32 s90, s90, s100
    v_accvgpr_write_b32 a72, 0
    v_accvgpr_write_b32 a73, 0
    v_accvgpr_write_b32 a74, 0
    v_accvgpr_write_b32 a75, 0
    v_accvgpr_write_b32 a76, 0
    v_accvgpr_write_b32 a77, 0
    v_accvgpr_write_b32 a78, 0
    v_accvgpr_write_b32 a79, 0
    v_accvgpr_read_b32 v24, a232
    v_accvgpr_read_b32 v25, a233
    v_accvgpr_read_b32 v26, a234
    v_accvgpr_read_b32 v27, a235
    v_accvgpr_read_b32 v28, a236
    v_accvgpr_read_b32 v29, a237
    v_accvgpr_read_b32 v30, a238
    v_accvgpr_read_b32 v31, a239
    v_cvt_pk_bf16_f32 v228, v24, v25
    v_cvt_pk_bf16_f32 v229, v26, v27
    v_cvt_pk_bf16_f32 v230, v28, v29
    v_cvt_pk_bf16_f32 v231, v30, v31
    v_cvt_pk_bf16_f32 v112, v112, v113
    v_cvt_pk_bf16_f32 v113, v114, v115
    v_cvt_pk_bf16_f32 v114, v116, v117
    v_cvt_pk_bf16_f32 v115, v118, v119
    buffer_store_dwordx4 v[112:115], v2, s[8:11], s90 offen sc1
    s_add_u32 s90, s90, s100
    v_accvgpr_write_b32 a80, 0
    v_accvgpr_write_b32 a81, 0
    v_accvgpr_write_b32 a82, 0
    v_accvgpr_write_b32 a83, 0
    v_accvgpr_write_b32 a84, 0
    v_accvgpr_write_b32 a85, 0
    v_accvgpr_write_b32 a86, 0
    v_accvgpr_write_b32 a87, 0
    v_accvgpr_read_b32 v24, a240
    v_accvgpr_read_b32 v25, a241
    v_accvgpr_read_b32 v26, a242
    v_accvgpr_read_b32 v27, a243
    v_accvgpr_read_b32 v28, a244
    v_accvgpr_read_b32 v29, a245
    v_accvgpr_read_b32 v30, a246
    v_accvgpr_read_b32 v31, a247
    v_cvt_pk_bf16_f32 v232, v24, v25
    v_cvt_pk_bf16_f32 v233, v26, v27
    v_cvt_pk_bf16_f32 v234, v28, v29
    v_cvt_pk_bf16_f32 v235, v30, v31
    v_cvt_pk_bf16_f32 v120, v120, v121
    v_cvt_pk_bf16_f32 v121, v122, v123
    v_cvt_pk_bf16_f32 v122, v124, v125
    v_cvt_pk_bf16_f32 v123, v126, v127
    buffer_store_dwordx4 v[120:123], v2, s[8:11], s90 offen sc1
    s_add_u32 s90, s90, s100
    v_accvgpr_write_b32 a88, 0
    v_accvgpr_write_b32 a89, 0
    v_accvgpr_write_b32 a90, 0
    v_accvgpr_write_b32 a91, 0
    v_accvgpr_write_b32 a92, 0
    v_accvgpr_write_b32 a93, 0
    v_accvgpr_write_b32 a94, 0
    v_accvgpr_write_b32 a95, 0
    v_accvgpr_read_b32 v24, a248
    v_accvgpr_read_b32 v25, a249
    v_accvgpr_read_b32 v26, a250
    v_accvgpr_read_b32 v27, a251
    v_accvgpr_read_b32 v28, a252
    v_accvgpr_read_b32 v29, a253
    v_accvgpr_read_b32 v30, a254
    v_accvgpr_read_b32 v31, a255
    v_cvt_pk_bf16_f32 v236, v24, v25
    v_cvt_pk_bf16_f32 v237, v26, v27
    v_cvt_pk_bf16_f32 v238, v28, v29
    v_cvt_pk_bf16_f32 v239, v30, v31
    v_cvt_pk_bf16_f32 v128, v128, v129
    v_cvt_pk_bf16_f32 v129, v130, v131
    v_cvt_pk_bf16_f32 v130, v132, v133
    v_cvt_pk_bf16_f32 v131, v134, v135
    buffer_store_dwordx4 v[128:131], v2, s[8:11], s90 offen sc1
    s_add_u32 s90, s90, s100
    v_accvgpr_write_b32 a96, 0
    v_accvgpr_write_b32 a97, 0
    v_accvgpr_write_b32 a98, 0
    v_accvgpr_write_b32 a99, 0
    v_accvgpr_write_b32 a100, 0
    v_accvgpr_write_b32 a101, 0
    v_accvgpr_write_b32 a102, 0
    v_accvgpr_write_b32 a103, 0
    v_cvt_pk_bf16_f32 v240, v160, v161
    v_cvt_pk_bf16_f32 v241, v162, v163
    v_cvt_pk_bf16_f32 v242, v164, v165
    v_cvt_pk_bf16_f32 v243, v166, v167
    v_cvt_pk_bf16_f32 v136, v136, v137
    v_cvt_pk_bf16_f32 v137, v138, v139
    v_cvt_pk_bf16_f32 v138, v140, v141
    v_cvt_pk_bf16_f32 v139, v142, v143
    buffer_store_dwordx4 v[136:139], v2, s[8:11], s90 offen sc1
    s_add_u32 s90, s90, s100
    v_accvgpr_write_b32 a104, 0
    v_accvgpr_write_b32 a105, 0
    v_accvgpr_write_b32 a106, 0
    v_accvgpr_write_b32 a107, 0
    v_accvgpr_write_b32 a108, 0
    v_accvgpr_write_b32 a109, 0
    v_accvgpr_write_b32 a110, 0
    v_accvgpr_write_b32 a111, 0
    v_cvt_pk_bf16_f32 v244, v168, v169
    v_cvt_pk_bf16_f32 v245, v170, v171
    v_cvt_pk_bf16_f32 v246, v172, v173
    v_cvt_pk_bf16_f32 v247, v174, v175
    v_cvt_pk_bf16_f32 v144, v144, v145
    v_cvt_pk_bf16_f32 v145, v146, v147
    v_cvt_pk_bf16_f32 v146, v148, v149
    v_cvt_pk_bf16_f32 v147, v150, v151
    buffer_store_dwordx4 v[144:147], v2, s[8:11], s90 offen sc1
    s_add_u32 s90, s90, s100
    v_accvgpr_write_b32 a112, 0
    v_accvgpr_write_b32 a113, 0
    v_accvgpr_write_b32 a114, 0
    v_accvgpr_write_b32 a115, 0
    v_accvgpr_write_b32 a116, 0
    v_accvgpr_write_b32 a117, 0
    v_accvgpr_write_b32 a118, 0
    v_accvgpr_write_b32 a119, 0
    v_cvt_pk_bf16_f32 v248, v176, v177
    v_cvt_pk_bf16_f32 v249, v178, v179
    v_cvt_pk_bf16_f32 v250, v180, v181
    v_cvt_pk_bf16_f32 v251, v182, v183
    v_cvt_pk_bf16_f32 v152, v152, v153
    v_cvt_pk_bf16_f32 v153, v154, v155
    v_cvt_pk_bf16_f32 v154, v156, v157
    v_cvt_pk_bf16_f32 v155, v158, v159
    buffer_store_dwordx4 v[152:155], v2, s[8:11], s90 offen sc1
    s_add_u32 s90, s90, s100
    v_accvgpr_write_b32 a120, 0
    v_accvgpr_write_b32 a121, 0
    v_accvgpr_write_b32 a122, 0
    v_accvgpr_write_b32 a123, 0
    v_accvgpr_write_b32 a124, 0
    v_accvgpr_write_b32 a125, 0
    v_accvgpr_write_b32 a126, 0
    v_accvgpr_write_b32 a127, 0
    v_cvt_pk_bf16_f32 v252, v184, v185
    v_cvt_pk_bf16_f32 v253, v186, v187
    v_cvt_pk_bf16_f32 v254, v188, v189
    v_cvt_pk_bf16_f32 v255, v190, v191
m_epl85_r:
    s_mov_b32 s17, s101
    s_mov_b32 s38, 268435456
m_init31:
    s_mov_b32 s56, 81920
    s_mov_b32 s57, 65536
    s_nop 1
    v_mov_b32 v9, 0xff800000
    s_mov_b32 s65, 1233125376
    s_lshl_b32 s91, s16, 1
    s_sub_u32 s91, s91, 8
    s_lshl_b32 s78, s33, 3
    s_add_u32 s78, s78, s91
    s_lshl_b32 s79, s34, 3
    s_add_u32 s79, s79, s91
    s_mov_b32 s36, s6
    s_mov_b32 s37, s7
    s_mov_b32 s39, 0x20000
    s_lshl_b32 s90, s99, 1
    s_add_u32 s98, s98, s90
    s_lshl_b32 s90, s100, 2
    s_add_u32 s40, s98, s90
    s_lshr_b32 s90, s32, 1
    s_lshl_b32 s90, s90, 7
    s_add_u32 s90, s90, 117444608
    s_lshr_b32 s91, s2, 6
    s_lshl_b32 s91, s91, 8
    s_add_u32 s91, s91, 117446592
    v_min_u32 v10, 31, v1
    v_lshlrev_b32 v10, 3, v10
    v_mov_b32 v11, s90
    v_mov_b32 v8, s91
    v_cmp_gt_u32 vcc, 8, v1
    s_nop 1
    v_cndmask_b32 v11, v8, v11, vcc
    v_add_u32 v10, v10, v11
    s_mov_b32 s58, 0
    v_mov_b32 v6, v2
    v_mov_b64 v[160:161], 0
    v_mov_b64 v[162:163], 0
    v_mov_b64 v[164:165], 0
    v_mov_b64 v[166:167], 0
    v_mov_b64 v[168:169], 0
    v_mov_b64 v[170:171], 0
    v_mov_b64 v[172:173], 0
    v_mov_b64 v[174:175], 0
    v_mov_b64 v[176:177], 0
    v_mov_b64 v[178:179], 0
    v_mov_b64 v[180:181], 0
    v_mov_b64 v[182:183], 0
    v_mov_b64 v[184:185], 0
    v_mov_b64 v[186:187], 0
    v_mov_b64 v[188:189], 0
    v_mov_b64 v[190:191], 0
    v_mov_b32 v12, 0
    v_mov_b32 v28, 0
    v_mov_b32 v44, 0x3f803f80
    v_mov_b32 v13, 0
    v_mov_b32 v32, 0
    v_mov_b32 v45, 0x3f803f80
    v_mov_b32 v14, 0
    v_mov_b32 v36, 0
    v_mov_b32 v46, 0x3f803f80
    v_mov_b32 v15, 0
    v_mov_b32 v40, 0
    v_mov_b32 v47, 0x3f803f80
    s_and_b32 s90, s2, 7
    s_lshl_b32 s90, s90, 4
    s_lshl_b32 s91, s16, 2
    s_add_u32 s80, s90, s91
    s_lshr_b32 s92, s2, 3
    s_lshl_b32 s92, s92, 17
    s_lshl_b32 s90, s80, 10
    s_add_u32 s90, s90, s92
    s_add_u32 s83, s90, 50331648
    s_add_u32 s84, s90, 54525952
    s_and_b32 s81, s80, 63
    s_cmp_eq_u32 s81, 0
    s_cselect_b32 s93, 0, 1024
    s_sub_u32 s85, s84, s93
    s_lshl_b32 s90, s80, 9
    s_add_u32 s90, s90, s92
    s_add_u32 s86, s90, 58720256
    s_sub_u32 s87, s86, s93
    s_add_u32 s88, s86, 65536
    s_add_u32 s89, s87, 65536
    v_and_b32 v48, 15, v1
    v_lshrrev_b32 v49, 4, v1
    v_lshlrev_b32 v49, 2, v49
    v_sub_u32 v48, v48, v49
    v_cmp_le_i32 vcc, 0, v48
    s_nop 1
    v_cndmask_b32 v16, v9, 0, vcc
    v_cmp_le_i32 vcc, 1, v48
    s_nop 1
    v_cndmask_b32 v17, v9, 0, vcc
    v_cmp_le_i32 vcc, 2, v48
    s_nop 1
    v_cndmask_b32 v18, v9, 0, vcc
    v_cmp_le_i32 vcc, 3, v48
    s_nop 1
    v_cndmask_b32 v19, v9, 0, vcc
    s_mov_b32 s62, 8945792
    s_mov_b32 s63, 0
    s_sub_u32 s90, s67, 1
    s_bitset1_b64 s[62:63], s90
    s_sub_u32 s90, s68, 1
    s_bitset1_b64 s[62:63], s90
    s_sub_u32 s90, s69, 1
    s_bitset1_b64 s[62:63], s90
    s_sub_u32 s90, s70, 1
    s_bitset1_b64 s[62:63], s90
    s_sub_u32 s90, s71, 1
    s_bitset1_b64 s[62:63], s90
    s_sub_u32 s90, s72, 1
    s_bitset1_b64 s[62:63], s90
    s_add_u32 s53, s69, 8
    s_sub_u32 s90, s53, 1
    s_bitset1_b64 s[62:63], s90
    s_mov_b32 s64, 0
    s_cmp_lg_u32 s64, s67
    s_cbranch_scc1 m_e91
    v_add_f32 v176, v176, v16
    v_mov_b32 v180, v9
    v_add_f32 v188, v188, v16
    v_add_f32 v177, v177, v17
    v_mov_b32 v181, v9
    v_add_f32 v189, v189, v17
    v_add_f32 v178, v178, v18
    v_mov_b32 v182, v9
    v_add_f32 v190, v190, v18
    v_add_f32 v179, v179, v19
    v_mov_b32 v183, v9
    v_add_f32 v191, v191, v19
    s_nop 0
m_e91:
    s_waitcnt vmcnt(32) lgkmcnt(0)
    s_barrier
    ds_read_b128 a[192:195], v6 offset:0
    ds_read_b128 a[196:199], v6 offset:1024
    ds_read_b128 a[200:203], v6 offset:2048
    ds_read_b128 a[204:207], v6 offset:3072
    ds_read_b128 a[208:211], v6 offset:4096
    ds_read_b128 a[212:215], v6 offset:5120
    ds_read_b128 a[216:219], v6 offset:6144
    ds_read_b128 a[220:223], v6 offset:7168
    s_waitcnt lgkmcnt(0)
    v_mfma_f32_16x16x32_bf16 v[64:67], a[192:195], a[128:131], v[160:163]
    v_mfma_f32_16x16x32_bf16 v[64:67], a[196:199], a[132:135], v[64:67]
    buffer_store_dwordx4 v[192:195], v2, s[36:39], s40 offen sc1
    s_add_u32 s40, s40, s100
    v_mfma_f32_16x16x32_bf16 v[64:67], a[200:203], a[136:139], v[64:67]
    v_mfma_f32_16x16x32_bf16 v[64:67], a[204:207], a[140:143], v[64:67]
    v_mfma_f32_16x16x32_bf16 v[72:75], a[204:207], a[156:159], v[168:171]
    v_mfma_f32_16x16x32_bf16 v[72:75], a[200:203], a[152:155], v[72:75]
    buffer_store_dwordx4 v[196:199], v2, s[36:39], s40 offen sc1
    s_add_u32 s40, s40, s100
    v_mfma_f32_16x16x32_bf16 v[72:75], a[196:199], a[148:151], v[72:75]
    v_mfma_f32_16x16x32_bf16 v[72:75], a[192:195], a[144:147], v[72:75]
    v_mfma_f32_16x16x32_bf16 v[80:83], a[192:195], a[160:163], v[176:179]
    v_mfma_f32_16x16x32_bf16 v[80:83], a[196:199], a[164:167], v[80:83]
    buffer_store_dwordx4 v[200:203], v2, s[36:39], s40 offen sc1
    s_add_u32 s40, s40, s100
    v_mfma_f32_16x16x32_bf16 v[80:83], a[200:203], a[168:171], v[80:83]
    v_mfma_f32_16x16x32_bf16 v[80:83], a[204:207], a[172:175], v[80:83]
    v_mfma_f32_16x16x32_bf16 v[88:91], a[204:207], a[188:191], v[184:187]
    v_mfma_f32_16x16x32_bf16 v[88:91], a[200:203], a[184:187], v[88:91]
    buffer_store_dwordx4 v[204:207], v2, s[36:39], s40 offen sc1
    s_add_u32 s40, s98, s99
    v_mfma_f32_16x16x32_bf16 v[88:91], a[196:199], a[180:183], v[88:91]
    v_mfma_f32_16x16x32_bf16 v[88:91], a[192:195], a[176:179], v[88:91]
    v_mfma_f32_16x16x32_bf16 v[92:95], a[208:211], a[176:179], v[188:191]
    ds_read_b128 a[192:195], v6 offset:8192
    v_mfma_f32_16x16x32_bf16 v[92:95], a[212:215], a[180:183], v[92:95]
    buffer_store_dwordx4 v[208:211], v2, s[36:39], s40 offen sc1
    s_add_u32 s40, s40, s100
    ds_read_b128 a[196:199], v6 offset:9216
    v_mfma_f32_16x16x32_bf16 v[92:95], a[216:219], a[184:187], v[92:95]
    ds_read_b128 a[200:203], v6 offset:10240
    v_mfma_f32_16x16x32_bf16 v[92:95], a[220:223], a[188:191], v[92:95]
    ds_read_b128 a[204:207], v6 offset:11264
    v_mfma_f32_16x16x32_bf16 v[84:87], a[220:223], a[172:175], v[180:183]
    v_mfma_f32_16x16x32_bf16 v[84:87], a[216:219], a[168:171], v[84:87]
    buffer_store_dwordx4 v[212:215], v2, s[36:39], s40 offen sc1
    s_add_u32 s40, s40, s100
    v_mfma_f32_16x16x32_bf16 v[84:87], a[212:215], a[164:167], v[84:87]
    v_mfma_f32_16x16x32_bf16 v[84:87], a[208:211], a[160:163], v[84:87]
    v_mfma_f32_16x16x32_bf16 v[76:79], a[208:211], a[144:147], v[172:175]
    v_mfma_f32_16x16x32_bf16 v[76:79], a[212:215], a[148:151], v[76:79]
    buffer_store_dwordx4 v[216:219], v2, s[36:39], s40 offen sc1
    s_add_u32 s40, s40, s100
    v_mfma_f32_16x16x32_bf16 v[76:79], a[216:219], a[152:155], v[76:79]
    v_mfma_f32_16x16x32_bf16 v[76:79], a[220:223], a[156:159], v[76:79]
    v_mfma_f32_16x16x32_bf16 v[68:71], a[220:223], a[140:143], v[164:167]
    v_mfma_f32_16x16x32_bf16 v[68:71], a[216:219], a[136:139], v[68:71]
    buffer_store_dwordx4 v[220:223], v2, s[36:39], s40 offen sc1
    s_add_u32 s40, s40, s100
    v_mfma_f32_16x16x32_bf16 v[68:71], a[212:215], a[132:135], v[68:71]
    v_mfma_f32_16x16x32_bf16 v[68:71], a[208:211], a[128:131], v[68:71]
    ds_read_b128 a[208:211], v6 offset:12288
    ds_read_b128 a[212:215], v6 offset:13312
    ds_read_b128 a[216:219], v6 offset:14336
    ds_read_b128 a[220:223], v6 offset:15360
    s_mov_b32 s64, 1
    s_nop 0
    s_nop 3
    v_max3_f32 v48, v64, v65, v66
    v_max3_f32 v49, v72, v73, v74
    v_max3_f32 v50, v80, v81, v82
    v_max3_f32 v51, v88, v89, v90
    v_max3_f32 v48, v48, v67, v68
    v_max3_f32 v49, v49, v75, v76
    v_max3_f32 v50, v50, v83, v84
    v_max3_f32 v51, v51, v91, v92
    v_max3_f32 v48, v48, v69, v70
    v_max3_f32 v49, v49, v77, v78
    v_max3_f32 v50, v50, v85, v86
    v_max3_f32 v51, v51, v93, v94
    v_max_f32 v48, v48, v71
    v_max_f32 v49, v49, v79
    v_max_f32 v50, v50, v87
    v_max_f32 v51, v51, v95
    v_mov_b32 v52, v48
    v_mov_b32 v53, v49
    v_mov_b32 v54, v50
    v_mov_b32 v55, v51
    s_nop 1
    v_permlane32_swap_b32 v48, v52
    v_permlane32_swap_b32 v49, v53
    v_permlane32_swap_b32 v50, v54
    v_permlane32_swap_b32 v51, v55
    s_nop 1
    v_max_f32 v48, v48, v52
    v_max_f32 v49, v49, v53
    v_max_f32 v50, v50, v54
    v_max_f32 v51, v51, v55
    v_mov_b32 v52, v48
    v_mov_b32 v53, v49
    v_mov_b32 v54, v50
    v_mov_b32 v55, v51
    s_nop 1
    v_permlane16_swap_b32 v48, v52
    v_permlane16_swap_b32 v49, v53
    v_permlane16_swap_b32 v50, v54
    v_permlane16_swap_b32 v51, v55
    s_nop 1
    v_max_f32 v48, v48, v52
    v_max_f32 v49, v49, v53
    v_max_f32 v50, v50, v54
    v_max_f32 v51, v51, v55
    v_sub_f32 v160, v160, v48
    v_sub_f32 v161, v161, v48
    v_sub_f32 v162, v162, v48
    v_sub_f32 v163, v163, v48
    v_sub_f32 v164, v164, v48
    v_sub_f32 v165, v165, v48
    v_sub_f32 v166, v166, v48
    v_sub_f32 v167, v167, v48
    v_sub_f32 v168, v168, v49
    v_sub_f32 v169, v169, v49
    v_sub_f32 v170, v170, v49
    v_sub_f32 v171, v171, v49
    v_sub_f32 v172, v172, v49
    v_sub_f32 v173, v173, v49
    v_sub_f32 v174, v174, v49
    v_sub_f32 v175, v175, v49
    v_sub_f32 v176, v176, v50
    v_sub_f32 v177, v177, v50
    v_sub_f32 v178, v178, v50
    v_sub_f32 v179, v179, v50
    v_sub_f32 v180, v180, v50
    v_sub_f32 v181, v181, v50
    v_sub_f32 v182, v182, v50
    v_sub_f32 v183, v183, v50
    v_sub_f32 v184, v184, v51
    v_sub_f32 v185, v185, v51
    v_sub_f32 v186, v186, v51
    v_sub_f32 v187, v187, v51
    v_sub_f32 v188, v188, v51
    v_sub_f32 v189, v189, v51
    v_sub_f32 v190, v190, v51
    v_sub_f32 v191, v191, v51
    v_sub_f32 v64, v64, v48
    v_sub_f32 v65, v65, v48
    v_sub_f32 v66, v66, v48
    v_sub_f32 v67, v67, v48
    v_sub_f32 v68, v68, v48
    v_sub_f32 v69, v69, v48
    v_sub_f32 v70, v70, v48
    v_sub_f32 v71, v71, v48
    v_sub_f32 v72, v72, v49
    v_sub_f32 v73, v73, v49
    v_sub_f32 v74, v74, v49
    v_sub_f32 v75, v75, v49
    v_sub_f32 v76, v76, v49
    v_sub_f32 v77, v77, v49
    v_sub_f32 v78, v78, v49
    v_sub_f32 v79, v79, v49
    v_sub_f32 v80, v80, v50
    v_sub_f32 v81, v81, v50
    v_sub_f32 v82, v82, v50
    v_sub_f32 v83, v83, v50
    v_sub_f32 v84, v84, v50
    v_sub_f32 v85, v85, v50
    v_sub_f32 v86, v86, v50
    v_sub_f32 v87, v87, v50
    v_sub_f32 v88, v88, v51
    v_sub_f32 v89, v89, v51
    v_sub_f32 v90, v90, v51
    v_sub_f32 v91, v91, v51
    v_sub_f32 v92, v92, v51
    v_sub_f32 v93, v93, v51
    v_sub_f32 v94, v94, v51
    v_sub_f32 v95, v95, v51
    s_cmp_lg_u32 s64, s67
    s_cbranch_scc1 m_e92
    v_add_f32 v176, v176, v16
    v_mov_b32 v180, v9
    v_add_f32 v188, v188, v16
    v_add_f32 v177, v177, v17
    v_mov_b32 v181, v9
    v_add_f32 v189, v189, v17
    v_add_f32 v178, v178, v18
    v_mov_b32 v182, v9
    v_add_f32 v190, v190, v18
    v_add_f32 v179, v179, v19
    v_mov_b32 v183, v9
    v_add_f32 v191, v191, v19
    s_nop 0
m_e92:
    s_cmp_lg_u32 s64, s68
    s_cbranch_scc1 m_e93
    v_mov_b32 v176, v9
    v_mov_b32 v184, v9
    v_mov_b32 v188, v9
    v_mov_b32 v177, v9
    v_mov_b32 v185, v9
    v_mov_b32 v189, v9
    v_mov_b32 v178, v9
    v_mov_b32 v186, v9
    v_mov_b32 v190, v9
    v_mov_b32 v179, v9
    v_mov_b32 v187, v9
    v_mov_b32 v191, v9
    s_nop 0
m_e93:
    s_waitcnt lgkmcnt(0)
    v_mfma_f32_16x16x32_bf16 v[96:99], a[192:195], a[128:131], v[160:163]
    s_bitcmp1_b64 s[62:63], s64
    s_cselect_b32 s66, -1.0, s65
    v_exp_f32 v20, v64
    v_mfma_f32_16x16x32_bf16 v[96:99], a[196:199], a[132:135], v[96:99]
    s_add_u32 s64, s64, 1
    v_exp_f32 v21, v65
    v_exp_f32 v22, v66
    v_mfma_f32_16x16x32_bf16 v[96:99], a[200:203], a[136:139], v[96:99]
    buffer_store_dwordx4 v[224:227], v2, s[36:39], s40 offen sc1
    v_cvt_pk_bf16_f32 v128, v20, v21
    v_mfma_f32_16x16x32_bf16 v[96:99], a[204:207], a[140:143], v[96:99]
    s_add_u32 s40, s40, s100
    v_add_f32 v12, v12, v28
    v_exp_f32 v23, v67
    v_mfma_f32_16x16x32_bf16 v[104:107], a[204:207], a[156:159], v[168:171]
    v_exp_f32 v24, v68
    v_cvt_pk_bf16_f32 v129, v22, v23
    v_mfma_f32_16x16x32_bf16 v[104:107], a[200:203], a[152:155], v[104:107]
    buffer_store_dwordx4 v[228:231], v2, s[36:39], s40 offen sc1
    v_exp_f32 v25, v69
    v_mfma_f32_16x16x32_bf16 v[104:107], a[196:199], a[148:151], v[104:107]
    s_add_u32 s40, s40, s100
    v_exp_f32 v26, v70
    v_cvt_pk_bf16_f32 v130, v24, v25
    v_mfma_f32_16x16x32_bf16 v[104:107], a[192:195], a[144:147], v[104:107]
    v_exp_f32 v27, v71
    v_add_f32 v13, v13, v32
    v_mfma_f32_16x16x32_bf16 v[112:115], a[192:195], a[160:163], v[176:179]
    v_exp_f32 v20, v72
    v_cvt_pk_bf16_f32 v131, v26, v27
    v_mfma_f32_16x16x32_bf16 v[112:115], a[196:199], a[164:167], v[112:115]
    buffer_store_dwordx4 v[232:235], v2, s[36:39], s40 offen sc1
    v_exp_f32 v21, v73
    v_mfma_f32_16x16x32_bf16 v[28:31], v[44:47], v[128:131], 0
    v_exp_f32 v22, v74
    v_cvt_pk_bf16_f32 v132, v20, v21
    v_mfma_f32_16x16x32_bf16 v[112:115], a[200:203], a[168:171], v[112:115]
    s_add_u32 s40, s40, s100
    v_exp_f32 v23, v75
    v_add_f32 v14, v14, v36
    v_mfma_f32_16x16x32_bf16 v[112:115], a[204:207], a[172:175], v[112:115]
    v_exp_f32 v24, v76
    v_cvt_pk_bf16_f32 v133, v22, v23
    v_mfma_f32_16x16x32_bf16 v[120:123], a[204:207], a[188:191], v[184:187]
    buffer_store_dwordx4 v[236:239], v2, s[36:39], s40 offen sc1
    v_exp_f32 v25, v77
    v_mfma_f32_16x16x32_bf16 v[120:123], a[200:203], a[184:187], v[120:123]
    s_mov_b32 s40, s98
    v_exp_f32 v26, v78
    v_cvt_pk_bf16_f32 v134, v24, v25
    v_mfma_f32_16x16x32_bf16 v[120:123], a[196:199], a[180:183], v[120:123]
    v_exp_f32 v27, v79
    v_add_f32 v15, v15, v40
    v_mfma_f32_16x16x32_bf16 v[120:123], a[192:195], a[176:179], v[120:123]
    s_waitcnt lgkmcnt(0)
    v_exp_f32 v20, v80
    v_cvt_pk_bf16_f32 v135, v26, v27
    v_mfma_f32_16x16x32_bf16 v[124:127], a[208:211], a[176:179], v[188:191]
    v_exp_f32 v21, v81
    v_exp_f32 v22, v82
    v_mfma_f32_16x16x32_bf16 v[32:35], v[44:47], v[132:135], 0
    v_cvt_pk_bf16_f32 v136, v20, v21
    v_exp_f32 v23, v83
    v_mfma_f32_16x16x32_bf16 v[124:127], a[212:215], a[180:183], v[124:127]
    buffer_store_dwordx4 v[240:243], v2, s[36:39], s40 offen sc1
    v_cvt_pk_bf16_f32 v137, v22, v23
    v_mfma_f32_16x16x32_bf16 v[124:127], a[216:219], a[184:187], v[124:127]
    s_add_u32 s40, s40, s100
    v_exp_f32 v24, v84
    v_mfma_f32_16x16x32_bf16 v[124:127], a[220:223], a[188:191], v[124:127]
    v_exp_f32 v25, v85
    v_exp_f32 v26, v86
    v_cvt_pk_bf16_f32 v138, v24, v25
    v_mfma_f32_16x16x32_bf16 v[116:119], a[220:223], a[172:175], v[180:183]
    buffer_store_dwordx4 v[244:247], v2, s[36:39], s40 offen sc1
    v_mfma_f32_16x16x32_bf16 v[116:119], a[216:219], a[168:171], v[116:119]
    s_add_u32 s40, s40, s100
    v_exp_f32 v27, v87
    v_exp_f32 v20, v88
    v_mfma_f32_16x16x32_bf16 v[116:119], a[212:215], a[164:167], v[116:119]
    v_cvt_pk_bf16_f32 v139, v26, v27
    v_exp_f32 v21, v89
    v_mfma_f32_16x16x32_bf16 v[116:119], a[208:211], a[160:163], v[116:119]
    buffer_store_dwordx4 v[248:251], v2, s[36:39], s40 offen sc1
    v_exp_f32 v22, v90
    v_mfma_f32_16x16x32_bf16 v[36:39], v[44:47], v[136:139], 0
    v_cvt_pk_bf16_f32 v140, v20, v21
    v_exp_f32 v23, v91
    v_mfma_f32_16x16x32_bf16 v[108:111], a[208:211], a[144:147], v[172:175]
    s_add_u32 s40, s40, s100
    v_exp_f32 v24, v92
    v_cvt_pk_bf16_f32 v141, v22, v23
    v_mfma_f32_16x16x32_bf16 v[108:111], a[212:215], a[148:151], v[108:111]
    v_exp_f32 v25, v93
    v_mfma_f32_16x16x32_bf16 v[108:111], a[216:219], a[152:155], v[108:111]
    buffer_store_dwordx4 v[252:255], v2, s[36:39], s40 offen sc1
    v_exp_f32 v26, v94
    v_cvt_pk_bf16_f32 v142, v24, v25
    v_mfma_f32_16x16x32_bf16 v[108:111], a[220:223], a[156:159], v[108:111]
    s_add_u32 s40, s40, s100
    v_exp_f32 v27, v95
    s_nop 0
    v_cvt_pk_bf16_f32 v143, v26, v27
    s_nop 1
    v_mfma_f32_16x16x32_bf16 v[40:43], v[44:47], v[140:143], 0
    s_nop 2
    v_mfma_f32_16x16x32_bf16 v[100:103], a[220:223], a[140:143], v[164:167]
    s_nop 2
    v_mfma_f32_16x16x32_bf16 v[100:103], a[216:219], a[136:139], v[100:103]
    v_max3_f32 v8, v28, v32, v36
    v_max_f32 v8, v8, v40
    v_mfma_f32_16x16x32_bf16 v[100:103], a[212:215], a[132:135], v[100:103]
    v_cmp_nge_f32 vcc, s66, v8
    v_mfma_f32_16x16x32_bf16 v[100:103], a[208:211], a[128:131], v[100:103]
    s_waitcnt vmcnt(48) lgkmcnt(0)
    s_barrier
    s_add_u32 s59, s58, s60
    s_add_u32 s58, s58, 32768
    s_cmp_ge_u32 s58, 163840
    s_cselect_b32 s58, 0, s58
    v_add_u32 v6, s58, v2
    ds_read_b128 a[192:195], v6 offset:0
    ds_read_b128 a[196:199], v6 offset:1024
    ds_read_b128 a[200:203], v6 offset:2048
    ds_read_b128 a[204:207], v6 offset:3072
    ds_read_b128 a[208:211], v6 offset:4096
    ds_read_b128 a[212:215], v6 offset:5120
    ds_read_b128 a[216:219], v6 offset:6144
    ds_read_b128 a[220:223], v6 offset:7168
    s_waitcnt lgkmcnt(0)
    s_cbranch_vccnz m_stub94
m_ret95:
.p2align 3
m_dual96:
    v_mfma_f32_16x16x32_bf16 v[64:67], a[192:195], a[128:131], v[160:163]
    s_bitcmp1_b64 s[62:63], s64
    s_cselect_b32 s66, -1.0, s65
    v_add_f32 v12, v12, v28
    v_mfma_f32_16x16x32_bf16 v[64:67], a[196:199], a[132:135], v[64:67]
    s_add_u32 s64, s64, 1
    ds_read_b128 a[224:227], v6 offset:16384
    v_add_f32 v13, v13, v32
    v_mfma_f32_16x16x32_bf16 v[64:67], a[200:203], a[136:139], v[64:67]
    v_exp_f32 v20, v96
    v_mfma_f32_16x16x32_bf16 v[64:67], a[204:207], a[140:143], v[64:67]
    v_exp_f32 v21, v97
    v_mfma_f32_16x16x32_bf16 v[72:75], a[204:207], a[156:159], v[168:171]
    s_mov_b32 m0, s59
    ds_read_b128 a[228:231], v6 offset:17408
    v_cvt_pk_bf16_f32 v144, v20, v21
    v_mfma_f32_16x16x32_bf16 v[72:75], a[200:203], a[152:155], v[72:75]
    buffer_load_dwordx4 v7, s[24:27], s56 offen offset:0 sc1 lds
    v_mfma_f32_16x16x32_bf16 v[72:75], a[196:199], a[148:151], v[72:75]
    v_exp_f32 v22, v98
    v_mfma_f32_16x16x32_bf16 v[72:75], a[192:195], a[144:147], v[72:75]
    ds_read_b128 a[232:235], v6 offset:18432
    v_add_f32 v14, v14, v36
    v_mfma_f32_16x16x32_bf16 v[80:83], a[192:195], a[160:163], v[176:179]
    v_exp_f32 v23, v99
    v_mfma_f32_16x16x32_bf16 v[80:83], a[196:199], a[164:167], v[80:83]
    v_exp_f32 v24, v100
    v_mfma_f32_16x16x32_bf16 v[80:83], a[200:203], a[168:171], v[80:83]
    ds_read_b128 a[236:239], v6 offset:19456
    v_cvt_pk_bf16_f32 v145, v22, v23
    v_mfma_f32_16x16x32_bf16 v[80:83], a[204:207], a[172:175], v[80:83]
    v_exp_f32 v25, v101
    v_mfma_f32_16x16x32_bf16 v[88:91], a[204:207], a[188:191], v[184:187]
    v_exp_f32 v26, v102
    v_mfma_f32_16x16x32_bf16 v[88:91], a[200:203], a[184:187], v[88:91]
    ds_read_b128 a[240:243], v6 offset:20480
    v_cvt_pk_bf16_f32 v146, v24, v25
    v_mfma_f32_16x16x32_bf16 v[88:91], a[196:199], a[180:183], v[88:91]
    v_exp_f32 v27, v103
    v_mfma_f32_16x16x32_bf16 v[88:91], a[192:195], a[176:179], v[88:91]
    s_waitcnt lgkmcnt(5)
    v_exp_f32 v20, v104
    v_mfma_f32_16x16x32_bf16 v[92:95], a[208:211], a[176:179], v[188:191]
    ds_read_b128 a[244:247], v6 offset:21504
    v_cvt_pk_bf16_f32 v147, v26, v27
    v_mfma_f32_16x16x32_bf16 v[92:95], a[212:215], a[180:183], v[92:95]
    v_exp_f32 v21, v105
    v_mfma_f32_16x16x32_bf16 v[28:31], v[44:47], v[144:147], 0
    v_exp_f32 v22, v106
    v_mfma_f32_16x16x32_bf16 v[92:95], a[216:219], a[184:187], v[92:95]
    buffer_load_dwordx4 v7, s[24:27], s56 offen offset:1024 sc1 lds
    v_mfma_f32_16x16x32_bf16 v[92:95], a[220:223], a[188:191], v[92:95]
    ds_read_b128 a[248:251], v6 offset:22528
    v_cvt_pk_bf16_f32 v148, v20, v21
    v_mfma_f32_16x16x32_bf16 v[84:87], a[220:223], a[172:175], v[180:183]
    v_exp_f32 v23, v107
    v_mfma_f32_16x16x32_bf16 v[84:87], a[216:219], a[168:171], v[84:87]
    v_exp_f32 v24, v108
    v_mfma_f32_16x16x32_bf16 v[84:87], a[212:215], a[164:167], v[84:87]
    ds_read_b128 a[252:255], v6 offset:23552
    v_cvt_pk_bf16_f32 v149, v22, v23
    v_mfma_f32_16x16x32_bf16 v[84:87], a[208:211], a[160:163], v[84:87]
    v_exp_f32 v25, v109
    v_mfma_f32_16x16x32_bf16 v[76:79], a[208:211], a[144:147], v[172:175]
    v_exp_f32 v26, v110
    v_mfma_f32_16x16x32_bf16 v[76:79], a[212:215], a[148:151], v[76:79]
    v_cvt_pk_bf16_f32 v150, v24, v25
    v_add_f32 v15, v15, v40
    v_mfma_f32_16x16x32_bf16 v[76:79], a[216:219], a[152:155], v[76:79]
    v_exp_f32 v27, v111
    v_mfma_f32_16x16x32_bf16 v[76:79], a[220:223], a[156:159], v[76:79]
    buffer_load_dwordx4 v7, s[24:27], s56 offen offset:2048 sc1 lds
    v_mfma_f32_16x16x32_bf16 v[68:71], a[220:223], a[140:143], v[164:167]
    v_exp_f32 v20, v112
    v_mfma_f32_16x16x32_bf16 v[68:71], a[216:219], a[136:139], v[68:71]
    v_cvt_pk_bf16_f32 v151, v26, v27
    v_mfma_f32_16x16x32_bf16 v[68:71], a[212:215], a[132:135], v[68:71]
    v_exp_f32 v21, v113
    v_mfma_f32_16x16x32_bf16 v[32:35], v[44:47], v[148:151], 0
    v_exp_f32 v22, v114
    v_mfma_f32_16x16x32_bf16 v[68:71], a[208:211], a[128:131], v[68:71]
    s_waitcnt lgkmcnt(0)
    v_cvt_pk_bf16_f32 v152, v20, v21
    v_mfma_f32_16x16x32_bf16 a[0:3], a[224:227], v[128:131], a[0:3]
    ds_read_b128 a[192:195], v6 offset:8192
    v_mfma_f32_16x16x32_bf16 a[32:35], a[224:227], v[132:135], a[32:35]
    v_exp_f32 v23, v115
    v_mfma_f32_16x16x32_bf16 a[64:67], a[224:227], v[136:139], a[64:67]
    v_exp_f32 v24, v116
    v_mfma_f32_16x16x32_bf16 a[96:99], a[224:227], v[140:143], a[96:99]
    ds_read_b128 a[196:199], v6 offset:9216
    v_cvt_pk_bf16_f32 v153, v22, v23
    v_mfma_f32_16x16x32_bf16 a[100:103], a[228:231], v[140:143], a[100:103]
    v_exp_f32 v25, v117
    v_mfma_f32_16x16x32_bf16 a[68:71], a[228:231], v[136:139], a[68:71]
    v_exp_f32 v26, v118
    v_mfma_f32_16x16x32_bf16 a[36:39], a[228:231], v[132:135], a[36:39]
    ds_read_b128 a[200:203], v6 offset:10240
    v_cvt_pk_bf16_f32 v154, v24, v25
    v_mfma_f32_16x16x32_bf16 a[4:7], a[228:231], v[128:131], a[4:7]
    v_exp_f32 v27, v119
    v_mfma_f32_16x16x32_bf16 a[8:11], a[232:235], v[128:131], a[8:11]
    v_exp_f32 v20, v120
    v_mfma_f32_16x16x32_bf16 a[40:43], a[232:235], v[132:135], a[40:43]
    ds_read_b128 a[204:207], v6 offset:11264
    v_cvt_pk_bf16_f32 v155, v26, v27
    v_mfma_f32_16x16x32_bf16 a[72:75], a[232:235], v[136:139], a[72:75]
    v_exp_f32 v21, v121
    v_mfma_f32_16x16x32_bf16 v[36:39], v[44:47], v[152:155], 0
    v_exp_f32 v22, v122
    v_mfma_f32_16x16x32_bf16 a[104:107], a[232:235], v[140:143], a[104:107]
    buffer_load_dwordx4 v7, s[24:27], s56 offen offset:3072 sc1 lds
    v_mfma_f32_16x16x32_bf16 a[108:111], a[236:239], v[140:143], a[108:111]
    s_add_u32 s56, s56, 16384
    v_cvt_pk_bf16_f32 v156, v20, v21
    v_mfma_f32_16x16x32_bf16 a[76:79], a[236:239], v[136:139], a[76:79]
    v_exp_f32 v23, v123
    v_mfma_f32_16x16x32_bf16 a[44:47], a[236:239], v[132:135], a[44:47]
    v_exp_f32 v24, v124
    v_mfma_f32_16x16x32_bf16 a[12:15], a[236:239], v[128:131], a[12:15]
    v_cvt_pk_bf16_f32 v157, v22, v23
    v_mfma_f32_16x16x32_bf16 a[16:19], a[240:243], v[128:131], a[16:19]
    v_exp_f32 v25, v125
    v_mfma_f32_16x16x32_bf16 a[48:51], a[240:243], v[132:135], a[48:51]
    v_exp_f32 v26, v126
    v_mfma_f32_16x16x32_bf16 a[80:83], a[240:243], v[136:139], a[80:83]
    v_cvt_pk_bf16_f32 v158, v24, v25
    v_mfma_f32_16x16x32_bf16 a[112:115], a[240:243], v[140:143], a[112:115]
    s_add_u32 m0, s59, 16384
    v_exp_f32 v27, v127
    v_mfma_f32_16x16x32_bf16 a[116:119], a[244:247], v[140:143], a[116:119]
    buffer_load_dwordx4 v7, s[28:31], s57 offen offset:0 sc1 lds
    v_mfma_f32_16x16x32_bf16 a[84:87], a[244:247], v[136:139], a[84:87]
    v_cvt_pk_bf16_f32 v159, v26, v27
    v_mfma_f32_16x16x32_bf16 a[52:55], a[244:247], v[132:135], a[52:55]
    v_mfma_f32_16x16x32_bf16 a[20:23], a[244:247], v[128:131], a[20:23]
    v_mfma_f32_16x16x32_bf16 v[40:43], v[44:47], v[156:159], 0
    s_nop 2
    v_mfma_f32_16x16x32_bf16 a[24:27], a[248:251], v[128:131], a[24:27]
    s_nop 2
    v_mfma_f32_16x16x32_bf16 a[56:59], a[248:251], v[132:135], a[56:59]
    v_max3_f32 v8, v28, v32, v36
    v_max_f32 v8, v8, v40
    v_mfma_f32_16x16x32_bf16 a[88:91], a[248:251], v[136:139], a[88:91]
    v_cmp_nge_f32 vcc, s66, v8
    v_mfma_f32_16x16x32_bf16 a[120:123], a[248:251], v[140:143], a[120:123]
    ds_read_b128 a[208:211], v6 offset:12288
    v_mfma_f32_16x16x32_bf16 a[124:127], a[252:255], v[140:143], a[124:127]
    ds_read_b128 a[212:215], v6 offset:13312
    v_mfma_f32_16x16x32_bf16 a[92:95], a[252:255], v[136:139], a[92:95]
    ds_read_b128 a[216:219], v6 offset:14336
    v_mfma_f32_16x16x32_bf16 a[60:63], a[252:255], v[132:135], a[60:63]
    ds_read_b128 a[220:223], v6 offset:15360
    v_mfma_f32_16x16x32_bf16 a[28:31], a[252:255], v[128:131], a[28:31]
    s_waitcnt lgkmcnt(4)
    s_cbranch_vccnz m_stub97
m_ret98:
    v_mfma_f32_16x16x32_bf16 v[96:99], a[192:195], a[128:131], v[160:163]
    s_add_u32 s59, s58, s60
    v_exp_f32 v20, v64
    v_mfma_f32_16x16x32_bf16 v[96:99], a[196:199], a[132:135], v[96:99]
    s_add_u32 s58, s58, 32768
    ds_read_b128 a[224:227], v6 offset:24576
    v_add_f32 v12, v12, v28
    v_mfma_f32_16x16x32_bf16 v[96:99], a[200:203], a[136:139], v[96:99]
    s_cmp_ge_u32 s58, 163840
    s_cselect_b32 s58, 0, s58
    v_exp_f32 v21, v65
    v_mfma_f32_16x16x32_bf16 v[96:99], a[204:207], a[140:143], v[96:99]
    s_bitcmp1_b64 s[62:63], s64
    s_cselect_b32 s66, -1.0, s65
    v_cvt_pk_bf16_f32 v128, v20, v21
    v_mfma_f32_16x16x32_bf16 v[104:107], a[204:207], a[156:159], v[168:171]
    s_add_u32 s64, s64, 1
    ds_read_b128 a[228:231], v6 offset:25600
    v_add_f32 v13, v13, v32
    v_mfma_f32_16x16x32_bf16 v[104:107], a[200:203], a[152:155], v[104:107]
    v_exp_f32 v22, v66
    v_mfma_f32_16x16x32_bf16 v[104:107], a[196:199], a[148:151], v[104:107]
    buffer_load_dwordx4 v7, s[28:31], s57 offen offset:1024 sc1 lds
    v_mfma_f32_16x16x32_bf16 v[104:107], a[192:195], a[144:147], v[104:107]
    ds_read_b128 a[232:235], v6 offset:26624
    v_add_f32 v14, v14, v36
    v_mfma_f32_16x16x32_bf16 v[112:115], a[192:195], a[160:163], v[176:179]
    v_exp_f32 v23, v67
    v_mfma_f32_16x16x32_bf16 v[112:115], a[196:199], a[164:167], v[112:115]
    v_exp_f32 v24, v68
    v_mfma_f32_16x16x32_bf16 v[112:115], a[200:203], a[168:171], v[112:115]
    ds_read_b128 a[236:239], v6 offset:27648
    v_cvt_pk_bf16_f32 v129, v22, v23
    v_mfma_f32_16x16x32_bf16 v[112:115], a[204:207], a[172:175], v[112:115]
    v_exp_f32 v25, v69
    v_mfma_f32_16x16x32_bf16 v[120:123], a[204:207], a[188:191], v[184:187]
    v_exp_f32 v26, v70
    v_mfma_f32_16x16x32_bf16 v[120:123], a[200:203], a[184:187], v[120:123]
    ds_read_b128 a[240:243], v6 offset:28672
    v_cvt_pk_bf16_f32 v130, v24, v25
    v_mfma_f32_16x16x32_bf16 v[120:123], a[196:199], a[180:183], v[120:123]
    v_exp_f32 v27, v71
    v_mfma_f32_16x16x32_bf16 v[120:123], a[192:195], a[176:179], v[120:123]
    s_waitcnt lgkmcnt(5)
    v_exp_f32 v20, v72
    v_mfma_f32_16x16x32_bf16 v[124:127], a[208:211], a[176:179], v[188:191]
    ds_read_b128 a[244:247], v6 offset:29696
    v_cvt_pk_bf16_f32 v131, v26, v27
    v_mfma_f32_16x16x32_bf16 v[124:127], a[212:215], a[180:183], v[124:127]
    v_exp_f32 v21, v73
    v_mfma_f32_16x16x32_bf16 v[28:31], v[44:47], v[128:131], 0
    v_exp_f32 v22, v74
    v_mfma_f32_16x16x32_bf16 v[124:127], a[216:219], a[184:187], v[124:127]
    buffer_load_dwordx4 v7, s[28:31], s57 offen offset:2048 sc1 lds
    v_mfma_f32_16x16x32_bf16 v[124:127], a[220:223], a[188:191], v[124:127]
    ds_read_b128 a[248:251], v6 offset:30720
    v_cvt_pk_bf16_f32 v132, v20, v21
    v_mfma_f32_16x16x32_bf16 v[116:119], a[220:223], a[172:175], v[180:183]
    v_exp_f32 v23, v75
    v_mfma_f32_16x16x32_bf16 v[116:119], a[216:219], a[168:171], v[116:119]
    v_exp_f32 v24, v76
    v_mfma_f32_16x16x32_bf16 v[116:119], a[212:215], a[164:167], v[116:119]
    ds_read_b128 a[252:255], v6 offset:31744
    v_cvt_pk_bf16_f32 v133, v22, v23
    v_mfma_f32_16x16x32_bf16 v[116:119], a[208:211], a[160:163], v[116:119]
    v_exp_f32 v25, v77
    v_mfma_f32_16x16x32_bf16 v[108:111], a[208:211], a[144:147], v[172:175]
    v_exp_f32 v26, v78
    v_mfma_f32_16x16x32_bf16 v[108:111], a[212:215], a[148:151], v[108:111]
    v_cvt_pk_bf16_f32 v134, v24, v25
    v_add_f32 v15, v15, v40
    v_mfma_f32_16x16x32_bf16 v[108:111], a[216:219], a[152:155], v[108:111]
    v_exp_f32 v27, v79
    v_mfma_f32_16x16x32_bf16 v[108:111], a[220:223], a[156:159], v[108:111]
    buffer_load_dwordx4 v7, s[28:31], s57 offen offset:3072 sc1 lds
    v_mfma_f32_16x16x32_bf16 v[100:103], a[220:223], a[140:143], v[164:167]
    s_add_u32 s57, s57, 16384
    v_exp_f32 v20, v80
    v_mfma_f32_16x16x32_bf16 v[100:103], a[216:219], a[136:139], v[100:103]
    v_cvt_pk_bf16_f32 v135, v26, v27
    v_mfma_f32_16x16x32_bf16 v[100:103], a[212:215], a[132:135], v[100:103]
    v_exp_f32 v21, v81
    v_mfma_f32_16x16x32_bf16 v[32:35], v[44:47], v[132:135], 0
    v_exp_f32 v22, v82
    v_mfma_f32_16x16x32_bf16 v[100:103], a[208:211], a[128:131], v[100:103]
    s_waitcnt vmcnt(24) lgkmcnt(0)
    v_add_u32 v6, s58, v2
    v_cvt_pk_bf16_f32 v136, v20, v21
    v_mfma_f32_16x16x32_bf16 a[0:3], a[224:227], v[144:147], a[0:3]
    s_barrier
    v_mfma_f32_16x16x32_bf16 a[32:35], a[224:227], v[148:151], a[32:35]
    ds_read_b128 a[192:195], v6 offset:0
    v_mfma_f32_16x16x32_bf16 a[64:67], a[224:227], v[152:155], a[64:67]
    v_exp_f32 v23, v83
    v_mfma_f32_16x16x32_bf16 a[96:99], a[224:227], v[156:159], a[96:99]
    v_exp_f32 v24, v84
    v_mfma_f32_16x16x32_bf16 a[100:103], a[228:231], v[156:159], a[100:103]
    ds_read_b128 a[196:199], v6 offset:1024
    v_cvt_pk_bf16_f32 v137, v22, v23
    v_mfma_f32_16x16x32_bf16 a[68:71], a[228:231], v[152:155], a[68:71]
    v_exp_f32 v25, v85
    v_mfma_f32_16x16x32_bf16 a[36:39], a[228:231], v[148:151], a[36:39]
    v_exp_f32 v26, v86
    v_mfma_f32_16x16x32_bf16 a[4:7], a[228:231], v[144:147], a[4:7]
    ds_read_b128 a[200:203], v6 offset:2048
    v_cvt_pk_bf16_f32 v138, v24, v25
    v_mfma_f32_16x16x32_bf16 a[8:11], a[232:235], v[144:147], a[8:11]
    v_exp_f32 v27, v87
    v_mfma_f32_16x16x32_bf16 a[40:43], a[232:235], v[148:151], a[40:43]
    v_exp_f32 v20, v88
    v_mfma_f32_16x16x32_bf16 a[72:75], a[232:235], v[152:155], a[72:75]
    ds_read_b128 a[204:207], v6 offset:3072
    v_cvt_pk_bf16_f32 v139, v26, v27
    v_mfma_f32_16x16x32_bf16 a[104:107], a[232:235], v[156:159], a[104:107]
    v_exp_f32 v21, v89
    v_mfma_f32_16x16x32_bf16 v[36:39], v[44:47], v[136:139], 0
    v_exp_f32 v22, v90
    v_mfma_f32_16x16x32_bf16 a[108:111], a[236:239], v[156:159], a[108:111]
    v_cvt_pk_bf16_f32 v140, v20, v21
    v_mfma_f32_16x16x32_bf16 a[76:79], a[236:239], v[152:155], a[76:79]
    v_exp_f32 v23, v91
    v_mfma_f32_16x16x32_bf16 a[44:47], a[236:239], v[148:151], a[44:47]
    v_exp_f32 v24, v92
    v_mfma_f32_16x16x32_bf16 a[12:15], a[236:239], v[144:147], a[12:15]
    v_cvt_pk_bf16_f32 v141, v22, v23
    v_mfma_f32_16x16x32_bf16 a[16:19], a[240:243], v[144:147], a[16:19]
    v_exp_f32 v25, v93
    v_mfma_f32_16x16x32_bf16 a[48:51], a[240:243], v[148:151], a[48:51]
    v_exp_f32 v26, v94
    v_mfma_f32_16x16x32_bf16 a[80:83], a[240:243], v[152:155], a[80:83]
    v_cvt_pk_bf16_f32 v142, v24, v25
    v_mfma_f32_16x16x32_bf16 a[112:115], a[240:243], v[156:159], a[112:115]
    v_exp_f32 v27, v95
    v_mfma_f32_16x16x32_bf16 a[116:119], a[244:247], v[156:159], a[116:119]
    v_cvt_pk_bf16_f32 v143, v26, v27
    v_mfma_f32_16x16x32_bf16 a[84:87], a[244:247], v[152:155], a[84:87]
    v_mfma_f32_16x16x32_bf16 a[52:55], a[244:247], v[148:151], a[52:55]
    v_mfma_f32_16x16x32_bf16 v[40:43], v[44:47], v[140:143], 0
    s_nop 2
    v_mfma_f32_16x16x32_bf16 a[20:23], a[244:247], v[144:147], a[20:23]
    s_nop 2
    v_mfma_f32_16x16x32_bf16 a[24:27], a[248:251], v[144:147], a[24:27]
    v_max3_f32 v8, v28, v32, v36
    v_max_f32 v8, v8, v40
    v_mfma_f32_16x16x32_bf16 a[56:59], a[248:251], v[148:151], a[56:59]
    v_cmp_nge_f32 vcc, s66, v8
    v_mfma_f32_16x16x32_bf16 a[88:91], a[248:251], v[152:155], a[88:91]
    v_mfma_f32_16x16x32_bf16 a[120:123], a[248:251], v[156:159], a[120:123]
    ds_read_b128 a[208:211], v6 offset:4096
    v_mfma_f32_16x16x32_bf16 a[124:127], a[252:255], v[156:159], a[124:127]
    ds_read_b128 a[212:215], v6 offset:5120
    v_mfma_f32_16x16x32_bf16 a[92:95], a[252:255], v[152:155], a[92:95]
    ds_read_b128 a[216:219], v6 offset:6144
    v_mfma_f32_16x16x32_bf16 a[60:63], a[252:255], v[148:151], a[60:63]
    ds_read_b128 a[220:223], v6 offset:7168
    v_mfma_f32_16x16x32_bf16 a[28:31], a[252:255], v[144:147], a[28:31]
    s_waitcnt lgkmcnt(4)
    s_cbranch_vccz m_dual96
    v_cmp_lt_f32 vcc, s65, v8
    s_cmp_lg_u32 s64, s67
    s_cbranch_scc1 m_e100
    v_add_f32 v176, v176, v16
    v_mov_b32 v180, v9
    v_add_f32 v188, v188, v16
    v_add_f32 v177, v177, v17
    v_mov_b32 v181, v9
    v_add_f32 v189, v189, v17
    v_add_f32 v178, v178, v18
    v_mov_b32 v182, v9
    v_add_f32 v190, v190, v18
    v_add_f32 v179, v179, v19
    v_mov_b32 v183, v9
    v_add_f32 v191, v191, v19
    s_nop 0
m_e100:
    s_cmp_lg_u32 s64, s68
    s_cbranch_scc1 m_e101
    v_mov_b32 v176, v9
    v_mov_b32 v184, v9
    v_mov_b32 v188, v9
    v_mov_b32 v177, v9
    v_mov_b32 v185, v9
    v_mov_b32 v189, v9
    v_mov_b32 v178, v9
    v_mov_b32 v186, v9
    v_mov_b32 v190, v9
    v_mov_b32 v179, v9
    v_mov_b32 v187, v9
    v_mov_b32 v191, v9
    s_nop 0
m_e101:
    s_cmp_lg_u32 s64, s70
    s_cbranch_scc1 m_e102
    v_add_f32 v160, v160, v16
    v_mov_b32 v164, v9
    v_add_f32 v172, v172, v16
    v_add_f32 v161, v161, v17
    v_mov_b32 v165, v9
    v_add_f32 v173, v173, v17
    v_add_f32 v162, v162, v18
    v_mov_b32 v166, v9
    v_add_f32 v174, v174, v18
    v_add_f32 v163, v163, v19
    v_mov_b32 v167, v9
    v_add_f32 v175, v175, v19
    s_nop 0
m_e102:
    s_cmp_lg_u32 s64, s53
    s_cbranch_scc1 m_e105
    s_cmp_lg_u32 s16, 0
    s_cbranch_scc1 m_np106
    v_mov_b32 v60, s4
    v_mov_b32 v61, s5
    s_add_u32 s90, s101, 117440512
    s_mov_b64 exec, 1
    buffer_store_dwordx2 v[60:61], off, s[8:11], s90 sc1
    s_mov_b64 exec, -1
m_np106:
    s_mov_b32 s101, -1
m_e105:
    s_cmp_gt_u32 s64, 24
    s_cbranch_scc1 m_e103
    s_cmp_lg_u32 s64, 8
    s_cbranch_scc1 m_e107
    s_lshr_b32 s90, s32, 1
    s_lshl_b32 s90, s90, 7
    s_add_u32 s90, s90, 117440600
    v_min_u32 v0, 1, v1
    v_lshlrev_b32 v0, 5, v0
    buffer_load_dwordx2 v[4:5], v0, s[8:11], s90 offen sc1
    s_cmp_eq_u32 s17, -1
    s_cbranch_scc1 m_e103
    s_cmp_lg_u32 s16, 0
    s_cbranch_scc1 m_np108
    v_mov_b32 v60, s4
    v_mov_b32 v61, s5
    s_add_u32 s90, s17, 117440512
    s_mov_b64 exec, 1
    buffer_store_dwordx2 v[60:61], off, s[8:11], s90 sc1
    s_mov_b64 exec, -1
m_np108:
    s_branch m_e103
m_e107:
    s_cmp_lg_u32 s64, 16
    s_cbranch_scc1 m_e109
    s_waitcnt vmcnt(18)
    s_mov_b32 s3, 1048576
m_spin110:
    v_cmp_ne_u64 s[76:77], s[4:5], v[4:5]
    s_nop 3
    s_cmp_eq_u64 s[76:77], 0
    s_cbranch_scc1 m_e103
    s_sub_u32 s3, s3, 1
    s_cbranch_scc1 m_e103
    s_sleep 32
    s_lshr_b32 s90, s32, 1
    s_lshl_b32 s90, s90, 7
    s_add_u32 s90, s90, 117440600
    v_min_u32 v0, 1, v1
    v_lshlrev_b32 v0, 5, v0
    buffer_load_dwordx2 v[4:5], v0, s[8:11], s90 offen sc1
    s_waitcnt vmcnt(0)
    s_branch m_spin110
    s_branch m_e103
m_e109:
    s_cmp_lg_u32 s64, 20
    s_cbranch_scc1 m_e111
    buffer_load_dwordx2 v[4:5], v10, s[8:11], 0 offen sc1
    s_mov_b32 s44, s48
    s_mov_b32 s45, s49
    s_mov_b32 s46, 8388608
    s_lshl_b32 s90, s2, 2
    s_add_u32 s90, s90, s16
    s_lshl_b32 s90, s90, 13
    v_lshlrev_b32 v62, 7, v1
    buffer_load_dword v255, v62, s[44:47], s90 offen
    s_branch m_e103
m_e111:
    s_cmp_lg_u32 s64, 24
    s_cbranch_scc1 m_e112
    s_mov_b32 s44, s50
    s_mov_b32 s45, s51
    s_mov_b32 s46, 2097152
    s_lshl_b32 s90, s2, 2
    s_add_u32 s90, s90, s16
    s_lshl_b32 s90, s90, 13
    v_lshlrev_b32 v62, 7, v1
    buffer_load_dword v255, v62, s[44:47], s90 offen
    s_waitcnt vmcnt(18)
    s_mov_b32 s3, 1048576
m_spin113:
    v_cmp_ne_u64 s[76:77], s[4:5], v[4:5]
    s_nop 3
    s_cmp_eq_u64 s[76:77], 0
    s_cbranch_scc1 m_e103
    s_sub_u32 s3, s3, 1
    s_cbranch_scc1 m_e103
    s_sleep 32
    buffer_load_dwordx2 v[4:5], v10, s[8:11], 0 offen sc1
    s_waitcnt vmcnt(0)
    s_branch m_spin113
    s_branch m_e103
m_e112:
m_e103:
    s_cbranch_vccnz m_rc114
m_sp99:
    s_cmp_lg_u32 s64, s69
    s_cbranch_scc1 m_dual96
    v_mfma_f32_16x16x32_bf16 v[64:67], a[192:195], a[128:131], v[160:163]
    s_bitcmp1_b64 s[62:63], s64
    s_cselect_b32 s66, -1.0, s65
    v_add_f32 v12, v12, v28
    v_mfma_f32_16x16x32_bf16 v[64:67], a[196:199], a[132:135], v[64:67]
    s_add_u32 s64, s64, 1
    ds_read_b128 a[224:227], v6 offset:16384
    v_exp_f32 v20, v96
    v_mfma_f32_16x16x32_bf16 v[64:67], a[200:203], a[136:139], v[64:67]
    s_mov_b32 m0, s59
    ds_read_b128 a[228:231], v6 offset:17408
    v_add_f32 v13, v13, v32
    v_mfma_f32_16x16x32_bf16 v[64:67], a[204:207], a[140:143], v[64:67]
    buffer_load_dwordx4 v7, s[24:27], s56 offen offset:0 sc1 lds
    v_mfma_f32_16x16x32_bf16 v[72:75], a[204:207], a[156:159], v[168:171]
    ds_read_b128 a[232:235], v6 offset:18432
    v_add_f32 v14, v14, v36
    v_mfma_f32_16x16x32_bf16 v[72:75], a[200:203], a[152:155], v[72:75]
    ds_read_b128 a[236:239], v6 offset:19456
    v_exp_f32 v21, v97
    v_mfma_f32_16x16x32_bf16 v[72:75], a[196:199], a[148:151], v[72:75]
    ds_read_b128 a[240:243], v6 offset:20480
    v_cvt_pk_bf16_f32 v144, v20, v21
    v_mfma_f32_16x16x32_bf16 v[72:75], a[192:195], a[144:147], v[72:75]
    s_waitcnt lgkmcnt(5)
    ds_read_b128 a[244:247], v6 offset:21504
    v_add_f32 v15, v15, v40
    v_mfma_f32_16x16x32_bf16 v[76:79], a[208:211], a[144:147], v[172:175]
    ds_read_b128 a[248:251], v6 offset:22528
    v_exp_f32 v22, v98
    v_mfma_f32_16x16x32_bf16 v[76:79], a[212:215], a[148:151], v[76:79]
    ds_read_b128 a[252:255], v6 offset:23552
    v_exp_f32 v23, v99
    v_mfma_f32_16x16x32_bf16 v[76:79], a[216:219], a[152:155], v[76:79]
    v_exp_f32 v24, v100
    v_mfma_f32_16x16x32_bf16 v[76:79], a[220:223], a[156:159], v[76:79]
    buffer_load_dwordx4 v7, s[24:27], s56 offen offset:1024 sc1 lds
    v_mfma_f32_16x16x32_bf16 v[68:71], a[220:223], a[140:143], v[164:167]
    v_cvt_pk_bf16_f32 v145, v22, v23
    v_exp_f32 v25, v101
    v_mfma_f32_16x16x32_bf16 v[68:71], a[216:219], a[136:139], v[68:71]
    v_exp_f32 v26, v102
    v_mfma_f32_16x16x32_bf16 v[68:71], a[212:215], a[132:135], v[68:71]
    v_cvt_pk_bf16_f32 v146, v24, v25
    v_exp_f32 v27, v103
    v_mfma_f32_16x16x32_bf16 v[68:71], a[208:211], a[128:131], v[68:71]
    s_waitcnt lgkmcnt(0)
    v_exp_f32 v20, v104
    v_mfma_f32_16x16x32_bf16 a[0:3], a[224:227], v[128:131], a[0:3]
    ds_read_b128 a[192:195], v6 offset:8192
    v_cvt_pk_bf16_f32 v147, v26, v27
    v_mfma_f32_16x16x32_bf16 a[32:35], a[224:227], v[132:135], a[32:35]
    v_exp_f32 v21, v105
    v_mfma_f32_16x16x32_bf16 v[28:31], v[44:47], v[144:147], 0
    v_exp_f32 v22, v106
    v_mfma_f32_16x16x32_bf16 a[64:67], a[224:227], v[136:139], a[64:67]
    v_cvt_pk_bf16_f32 v148, v20, v21
    v_exp_f32 v23, v107
    v_mfma_f32_16x16x32_bf16 a[96:99], a[224:227], v[140:143], a[96:99]
    ds_read_b128 a[196:199], v6 offset:9216
    v_cvt_pk_bf16_f32 v149, v22, v23
    v_mfma_f32_16x16x32_bf16 a[100:103], a[228:231], v[140:143], a[100:103]
    v_exp_f32 v24, v108
    v_mfma_f32_16x16x32_bf16 a[68:71], a[228:231], v[136:139], a[68:71]
    buffer_load_dwordx4 v7, s[24:27], s56 offen offset:2048 sc1 lds
    v_mfma_f32_16x16x32_bf16 a[36:39], a[228:231], v[132:135], a[36:39]
    ds_read_b128 a[200:203], v6 offset:10240
    v_exp_f32 v25, v109
    v_mfma_f32_16x16x32_bf16 a[4:7], a[228:231], v[128:131], a[4:7]
    v_exp_f32 v26, v110
    v_mfma_f32_16x16x32_bf16 a[8:11], a[232:235], v[128:131], a[8:11]
    v_cvt_pk_bf16_f32 v150, v24, v25
    v_exp_f32 v27, v111
    v_mfma_f32_16x16x32_bf16 a[40:43], a[232:235], v[132:135], a[40:43]
    ds_read_b128 a[204:207], v6 offset:11264
    v_cvt_pk_bf16_f32 v151, v26, v27
    v_mfma_f32_16x16x32_bf16 a[72:75], a[232:235], v[136:139], a[72:75]
    v_exp_f32 v20, v112
    v_mfma_f32_16x16x32_bf16 v[32:35], v[44:47], v[148:151], 0
    v_exp_f32 v21, v113
    v_mfma_f32_16x16x32_bf16 a[104:107], a[232:235], v[140:143], a[104:107]
    v_exp_f32 v22, v114
    v_mfma_f32_16x16x32_bf16 a[108:111], a[236:239], v[140:143], a[108:111]
    v_cvt_pk_bf16_f32 v152, v20, v21
    v_exp_f32 v23, v115
    v_mfma_f32_16x16x32_bf16 a[76:79], a[236:239], v[136:139], a[76:79]
    v_exp_f32 v24, v116
    v_mfma_f32_16x16x32_bf16 a[44:47], a[236:239], v[132:135], a[44:47]
    v_cvt_pk_bf16_f32 v153, v22, v23
    v_exp_f32 v25, v117
    v_mfma_f32_16x16x32_bf16 a[12:15], a[236:239], v[128:131], a[12:15]
    buffer_load_dwordx4 v7, s[24:27], s56 offen offset:3072 sc1 lds
    v_mfma_f32_16x16x32_bf16 a[16:19], a[240:243], v[128:131], a[16:19]
    s_add_u32 s56, s56, 16384
    v_exp_f32 v26, v118
    v_mfma_f32_16x16x32_bf16 a[48:51], a[240:243], v[132:135], a[48:51]
    v_cvt_pk_bf16_f32 v154, v24, v25
    v_exp_f32 v27, v119
    v_mfma_f32_16x16x32_bf16 a[80:83], a[240:243], v[136:139], a[80:83]
    v_exp_f32 v20, v120
    v_mfma_f32_16x16x32_bf16 a[112:115], a[240:243], v[140:143], a[112:115]
    v_cvt_pk_bf16_f32 v155, v26, v27
    v_exp_f32 v21, v121
    v_mfma_f32_16x16x32_bf16 a[116:119], a[244:247], v[140:143], a[116:119]
    v_exp_f32 v22, v122
    v_mfma_f32_16x16x32_bf16 v[36:39], v[44:47], v[152:155], 0
    v_cvt_pk_bf16_f32 v156, v20, v21
    v_mfma_f32_16x16x32_bf16 a[84:87], a[244:247], v[136:139], a[84:87]
    v_exp_f32 v23, v123
    v_mfma_f32_16x16x32_bf16 a[52:55], a[244:247], v[132:135], a[52:55]
    v_exp_f32 v24, v124
    v_cvt_pk_bf16_f32 v157, v22, v23
    v_mfma_f32_16x16x32_bf16 a[20:23], a[244:247], v[128:131], a[20:23]
    v_exp_f32 v25, v125
    v_mfma_f32_16x16x32_bf16 a[24:27], a[248:251], v[128:131], a[24:27]
    s_add_u32 m0, s59, 16384
    v_exp_f32 v26, v126
    v_mfma_f32_16x16x32_bf16 a[56:59], a[248:251], v[132:135], a[56:59]
    buffer_load_dwordx4 v7, s[28:31], s57 offen offset:0 sc1 lds
    v_mfma_f32_16x16x32_bf16 a[88:91], a[248:251], v[136:139], a[88:91]
    v_cvt_pk_bf16_f32 v158, v24, v25
    v_exp_f32 v27, v127
    v_mfma_f32_16x16x32_bf16 a[120:123], a[248:251], v[140:143], a[120:123]
    ds_read_b128 a[208:211], v6 offset:12288
    v_cvt_pk_bf16_f32 v159, v26, v27
    s_nop 1
    v_mfma_f32_16x16x32_bf16 v[40:43], v[44:47], v[156:159], 0
    s_nop 2
    v_mfma_f32_16x16x32_bf16 a[124:127], a[252:255], v[140:143], a[124:127]
    ds_read_b128 a[212:215], v6 offset:13312
    s_nop 0
    v_mfma_f32_16x16x32_bf16 a[92:95], a[252:255], v[136:139], a[92:95]
    ds_read_b128 a[216:219], v6 offset:14336
    v_max3_f32 v8, v28, v32, v36
    v_mfma_f32_16x16x32_bf16 a[60:63], a[252:255], v[132:135], a[60:63]
    ds_read_b128 a[220:223], v6 offset:15360
    v_max_f32 v8, v8, v40
    v_cmp_nge_f32 vcc, s66, v8
    v_mfma_f32_16x16x32_bf16 a[28:31], a[252:255], v[128:131], a[28:31]
    s_waitcnt lgkmcnt(4)
    s_cbranch_vccnz m_stub115
m_ret116:
    v_mfma_f32_16x16x32_bf16 v[96:99], a[192:195], a[128:131], v[160:163]
    s_add_u32 s59, s58, s60
    v_exp_f32 v20, v64
    v_mfma_f32_16x16x32_bf16 v[96:99], a[196:199], a[132:135], v[96:99]
    s_add_u32 s58, s58, 32768
    ds_read_b128 a[224:227], v6 offset:24576
    v_add_f32 v12, v12, v28
    v_mfma_f32_16x16x32_bf16 v[96:99], a[200:203], a[136:139], v[96:99]
    s_cmp_ge_u32 s58, 163840
    s_cselect_b32 s58, 0, s58
    ds_read_b128 a[228:231], v6 offset:25600
    v_add_f32 v13, v13, v32
    v_mfma_f32_16x16x32_bf16 v[96:99], a[204:207], a[140:143], v[96:99]
    buffer_load_dwordx4 v7, s[28:31], s57 offen offset:1024 sc1 lds
    v_mfma_f32_16x16x32_bf16 v[104:107], a[204:207], a[156:159], v[168:171]
    s_bitcmp1_b64 s[62:63], s64
    s_cselect_b32 s66, -1.0, s65
    ds_read_b128 a[232:235], v6 offset:26624
    v_mfma_f32_16x16x32_bf16 v[104:107], a[200:203], a[152:155], v[104:107]
    s_add_u32 s64, s64, 1
    ds_read_b128 a[236:239], v6 offset:27648
    v_mfma_f32_16x16x32_bf16 v[104:107], a[196:199], a[148:151], v[104:107]
    ds_read_b128 a[240:243], v6 offset:28672
    v_mfma_f32_16x16x32_bf16 v[104:107], a[192:195], a[144:147], v[104:107]
    s_waitcnt lgkmcnt(5)
    ds_read_b128 a[244:247], v6 offset:29696
    v_mfma_f32_16x16x32_bf16 v[108:111], a[208:211], a[144:147], v[172:175]
    buffer_load_dwordx4 v7, s[28:31], s57 offen offset:2048 sc1 lds
    v_mfma_f32_16x16x32_bf16 v[108:111], a[212:215], a[148:151], v[108:111]
    ds_read_b128 a[248:251], v6 offset:30720
    v_mfma_f32_16x16x32_bf16 v[108:111], a[216:219], a[152:155], v[108:111]
    ds_read_b128 a[252:255], v6 offset:31744
    v_mfma_f32_16x16x32_bf16 v[108:111], a[220:223], a[156:159], v[108:111]
    v_exp_f32 v21, v65
    v_mfma_f32_16x16x32_bf16 v[100:103], a[220:223], a[140:143], v[164:167]
    v_exp_f32 v22, v66
    v_mfma_f32_16x16x32_bf16 v[100:103], a[216:219], a[136:139], v[100:103]
    buffer_load_dwordx4 v7, s[28:31], s57 offen offset:3072 sc1 lds
    v_mfma_f32_16x16x32_bf16 v[100:103], a[212:215], a[132:135], v[100:103]
    s_add_u32 s57, s57, 16384
    v_cvt_pk_bf16_f32 v128, v20, v21
    v_mfma_f32_16x16x32_bf16 v[100:103], a[208:211], a[128:131], v[100:103]
    s_waitcnt vmcnt(24) lgkmcnt(0)
    v_add_u32 v6, s58, v2
    v_mfma_f32_16x16x32_bf16 a[0:3], a[224:227], v[144:147], a[0:3]
    s_barrier
    v_mfma_f32_16x16x32_bf16 a[32:35], a[224:227], v[148:151], a[32:35]
    ds_read_b128 a[192:195], v6 offset:0
    v_mfma_f32_16x16x32_bf16 a[64:67], a[224:227], v[152:155], a[64:67]
    v_exp_f32 v23, v67
    v_mfma_f32_16x16x32_bf16 a[96:99], a[224:227], v[156:159], a[96:99]
    v_exp_f32 v24, v68
    v_mfma_f32_16x16x32_bf16 a[100:103], a[228:231], v[156:159], a[100:103]
    ds_read_b128 a[196:199], v6 offset:1024
    v_cvt_pk_bf16_f32 v129, v22, v23
    v_mfma_f32_16x16x32_bf16 a[68:71], a[228:231], v[152:155], a[68:71]
    v_exp_f32 v25, v69
    v_mfma_f32_16x16x32_bf16 a[36:39], a[228:231], v[148:151], a[36:39]
    v_exp_f32 v26, v70
    v_mfma_f32_16x16x32_bf16 a[4:7], a[228:231], v[144:147], a[4:7]
    ds_read_b128 a[200:203], v6 offset:2048
    v_cvt_pk_bf16_f32 v130, v24, v25
    v_mfma_f32_16x16x32_bf16 a[8:11], a[232:235], v[144:147], a[8:11]
    v_exp_f32 v27, v71
    v_mfma_f32_16x16x32_bf16 a[40:43], a[232:235], v[148:151], a[40:43]
    v_exp_f32 v20, v72
    v_mfma_f32_16x16x32_bf16 a[72:75], a[232:235], v[152:155], a[72:75]
    ds_read_b128 a[204:207], v6 offset:3072
    v_cvt_pk_bf16_f32 v131, v26, v27
    v_mfma_f32_16x16x32_bf16 a[104:107], a[232:235], v[156:159], a[104:107]
    v_exp_f32 v21, v73
    v_mfma_f32_16x16x32_bf16 v[28:31], v[44:47], v[128:131], 0
    v_exp_f32 v22, v74
    v_mfma_f32_16x16x32_bf16 a[108:111], a[236:239], v[156:159], a[108:111]
    v_cvt_pk_bf16_f32 v132, v20, v21
    v_mfma_f32_16x16x32_bf16 a[76:79], a[236:239], v[152:155], a[76:79]
    v_exp_f32 v23, v75
    v_mfma_f32_16x16x32_bf16 a[44:47], a[236:239], v[148:151], a[44:47]
    v_exp_f32 v24, v76
    v_mfma_f32_16x16x32_bf16 a[12:15], a[236:239], v[144:147], a[12:15]
    v_cvt_pk_bf16_f32 v133, v22, v23
    v_mfma_f32_16x16x32_bf16 a[16:19], a[240:243], v[144:147], a[16:19]
    v_exp_f32 v25, v77
    v_mfma_f32_16x16x32_bf16 a[48:51], a[240:243], v[148:151], a[48:51]
    v_exp_f32 v26, v78
    v_mfma_f32_16x16x32_bf16 a[80:83], a[240:243], v[152:155], a[80:83]
    v_cvt_pk_bf16_f32 v134, v24, v25
    v_mfma_f32_16x16x32_bf16 a[112:115], a[240:243], v[156:159], a[112:115]
    v_exp_f32 v27, v79
    v_mfma_f32_16x16x32_bf16 a[116:119], a[244:247], v[156:159], a[116:119]
    v_cvt_pk_bf16_f32 v135, v26, v27
    v_mfma_f32_16x16x32_bf16 a[84:87], a[244:247], v[152:155], a[84:87]
    v_mfma_f32_16x16x32_bf16 a[52:55], a[244:247], v[148:151], a[52:55]
    v_mfma_f32_16x16x32_bf16 v[32:35], v[44:47], v[132:135], 0
    s_nop 2
    v_mfma_f32_16x16x32_bf16 a[20:23], a[244:247], v[144:147], a[20:23]
    s_nop 2
    v_mfma_f32_16x16x32_bf16 a[24:27], a[248:251], v[144:147], a[24:27]
    v_max_f32 v8, v28, v32
    v_cmp_nge_f32 vcc, s66, v8
    v_mfma_f32_16x16x32_bf16 a[56:59], a[248:251], v[148:151], a[56:59]
    v_mfma_f32_16x16x32_bf16 a[88:91], a[248:251], v[152:155], a[88:91]
    v_mfma_f32_16x16x32_bf16 a[120:123], a[248:251], v[156:159], a[120:123]
    ds_read_b128 a[208:211], v6 offset:4096
    v_mfma_f32_16x16x32_bf16 a[124:127], a[252:255], v[156:159], a[124:127]
    ds_read_b128 a[212:215], v6 offset:5120
    v_mfma_f32_16x16x32_bf16 a[92:95], a[252:255], v[152:155], a[92:95]
    ds_read_b128 a[216:219], v6 offset:6144
    v_mfma_f32_16x16x32_bf16 a[60:63], a[252:255], v[148:151], a[60:63]
    ds_read_b128 a[220:223], v6 offset:7168
    v_mfma_f32_16x16x32_bf16 a[28:31], a[252:255], v[144:147], a[28:31]
    s_waitcnt lgkmcnt(4)
    s_cbranch_vccnz m_stub117
m_ret118:
    v_add_f32 v20, v14, v36
    v_add_f32 v21, v15, v40
    s_nop 3
    v_rcp_f32 v20, v20
    v_rcp_f32 v21, v21
    s_lshl_b32 s90, s79, 10
    s_add_u32 s90, s90, s82
    s_add_u32 s90, s90, 67108864
    v_accvgpr_read_b32 v48, a64
    v_accvgpr_read_b32 v49, a65
    v_accvgpr_read_b32 v50, a66
    v_accvgpr_read_b32 v51, a67
    v_accvgpr_read_b32 v52, a68
    v_accvgpr_read_b32 v53, a69
    v_accvgpr_read_b32 v54, a70
    v_accvgpr_read_b32 v55, a71
    v_mul_f32 v48, v20, v48
    v_mul_f32 v49, v20, v49
    v_mul_f32 v50, v20, v50
    v_mul_f32 v51, v20, v51
    v_mul_f32 v52, v20, v52
    v_mul_f32 v53, v20, v53
    v_mul_f32 v54, v20, v54
    v_mul_f32 v55, v20, v55
    v_cvt_pk_bf16_f32 v48, v48, v49
    v_cvt_pk_bf16_f32 v49, v50, v51
    v_cvt_pk_bf16_f32 v50, v52, v53
    v_cvt_pk_bf16_f32 v51, v54, v55
    buffer_store_dwordx4 v[48:51], v2, s[8:11], s90 offen offset:0 sc1
    v_accvgpr_read_b32 v56, a96
    v_accvgpr_read_b32 v57, a97
    v_accvgpr_read_b32 v58, a98
    v_accvgpr_read_b32 v59, a99
    v_accvgpr_read_b32 v60, a100
    v_accvgpr_read_b32 v61, a101
    v_accvgpr_read_b32 v62, a102
    v_accvgpr_read_b32 v63, a103
    v_mul_f32 v56, v21, v56
    v_mul_f32 v57, v21, v57
    v_mul_f32 v58, v21, v58
    v_mul_f32 v59, v21, v59
    v_mul_f32 v60, v21, v60
    v_mul_f32 v61, v21, v61
    v_mul_f32 v62, v21, v62
    v_mul_f32 v63, v21, v63
    v_cvt_pk_bf16_f32 v56, v56, v57
    v_cvt_pk_bf16_f32 v57, v58, v59
    v_cvt_pk_bf16_f32 v58, v60, v61
    v_cvt_pk_bf16_f32 v59, v62, v63
    buffer_store_dwordx4 v[56:59], v2, s[8:11], s90 offen offset:1024 sc1
    s_add_u32 s90, s90, 131072
    v_accvgpr_read_b32 v48, a72
    v_accvgpr_read_b32 v49, a73
    v_accvgpr_read_b32 v50, a74
    v_accvgpr_read_b32 v51, a75
    v_accvgpr_read_b32 v52, a76
    v_accvgpr_read_b32 v53, a77
    v_accvgpr_read_b32 v54, a78
    v_accvgpr_read_b32 v55, a79
    v_mul_f32 v48, v20, v48
    v_mul_f32 v49, v20, v49
    v_mul_f32 v50, v20, v50
    v_mul_f32 v51, v20, v51
    v_mul_f32 v52, v20, v52
    v_mul_f32 v53, v20, v53
    v_mul_f32 v54, v20, v54
    v_mul_f32 v55, v20, v55
    v_cvt_pk_bf16_f32 v48, v48, v49
    v_cvt_pk_bf16_f32 v49, v50, v51
    v_cvt_pk_bf16_f32 v50, v52, v53
    v_cvt_pk_bf16_f32 v51, v54, v55
    buffer_store_dwordx4 v[48:51], v2, s[8:11], s90 offen offset:0 sc1
    v_accvgpr_read_b32 v56, a104
    v_accvgpr_read_b32 v57, a105
    v_accvgpr_read_b32 v58, a106
    v_accvgpr_read_b32 v59, a107
    v_accvgpr_read_b32 v60, a108
    v_accvgpr_read_b32 v61, a109
    v_accvgpr_read_b32 v62, a110
    v_accvgpr_read_b32 v63, a111
    v_mul_f32 v56, v21, v56
    v_mul_f32 v57, v21, v57
    v_mul_f32 v58, v21, v58
    v_mul_f32 v59, v21, v59
    v_mul_f32 v60, v21, v60
    v_mul_f32 v61, v21, v61
    v_mul_f32 v62, v21, v62
    v_mul_f32 v63, v21, v63
    v_cvt_pk_bf16_f32 v56, v56, v57
    v_cvt_pk_bf16_f32 v57, v58, v59
    v_cvt_pk_bf16_f32 v58, v60, v61
    v_cvt_pk_bf16_f32 v59, v62, v63
    buffer_store_dwordx4 v[56:59], v2, s[8:11], s90 offen offset:1024 sc1
    s_add_u32 s90, s90, 131072
    v_accvgpr_read_b32 v48, a80
    v_accvgpr_read_b32 v49, a81
    v_accvgpr_read_b32 v50, a82
    v_accvgpr_read_b32 v51, a83
    v_accvgpr_read_b32 v52, a84
    v_accvgpr_read_b32 v53, a85
    v_accvgpr_read_b32 v54, a86
    v_accvgpr_read_b32 v55, a87
    v_mul_f32 v48, v20, v48
    v_mul_f32 v49, v20, v49
    v_mul_f32 v50, v20, v50
    v_mul_f32 v51, v20, v51
    v_mul_f32 v52, v20, v52
    v_mul_f32 v53, v20, v53
    v_mul_f32 v54, v20, v54
    v_mul_f32 v55, v20, v55
    v_cvt_pk_bf16_f32 v48, v48, v49
    v_cvt_pk_bf16_f32 v49, v50, v51
    v_cvt_pk_bf16_f32 v50, v52, v53
    v_cvt_pk_bf16_f32 v51, v54, v55
    buffer_store_dwordx4 v[48:51], v2, s[8:11], s90 offen offset:0 sc1
    v_accvgpr_read_b32 v56, a112
    v_accvgpr_read_b32 v57, a113
    v_accvgpr_read_b32 v58, a114
    v_accvgpr_read_b32 v59, a115
    v_accvgpr_read_b32 v60, a116
    v_accvgpr_read_b32 v61, a117
    v_accvgpr_read_b32 v62, a118
    v_accvgpr_read_b32 v63, a119
    v_mul_f32 v56, v21, v56
    v_mul_f32 v57, v21, v57
    v_mul_f32 v58, v21, v58
    v_mul_f32 v59, v21, v59
    v_mul_f32 v60, v21, v60
    v_mul_f32 v61, v21, v61
    v_mul_f32 v62, v21, v62
    v_mul_f32 v63, v21, v63
    v_cvt_pk_bf16_f32 v56, v56, v57
    v_cvt_pk_bf16_f32 v57, v58, v59
    v_cvt_pk_bf16_f32 v58, v60, v61
    v_cvt_pk_bf16_f32 v59, v62, v63
    buffer_store_dwordx4 v[56:59], v2, s[8:11], s90 offen offset:1024 sc1
    s_add_u32 s90, s90, 131072
    v_accvgpr_read_b32 v48, a88
    v_accvgpr_read_b32 v49, a89
    v_accvgpr_read_b32 v50, a90
    v_accvgpr_read_b32 v51, a91
    v_accvgpr_read_b32 v52, a92
    v_accvgpr_read_b32 v53, a93
    v_accvgpr_read_b32 v54, a94
    v_accvgpr_read_b32 v55, a95
    v_mul_f32 v48, v20, v48
    v_mul_f32 v49, v20, v49
    v_mul_f32 v50, v20, v50
    v_mul_f32 v51, v20, v51
    v_mul_f32 v52, v20, v52
    v_mul_f32 v53, v20, v53
    v_mul_f32 v54, v20, v54
    v_mul_f32 v55, v20, v55
    v_cvt_pk_bf16_f32 v48, v48, v49
    v_cvt_pk_bf16_f32 v49, v50, v51
    v_cvt_pk_bf16_f32 v50, v52, v53
    v_cvt_pk_bf16_f32 v51, v54, v55
    buffer_store_dwordx4 v[48:51], v2, s[8:11], s90 offen offset:0 sc1
    v_accvgpr_read_b32 v56, a120
    v_accvgpr_read_b32 v57, a121
    v_accvgpr_read_b32 v58, a122
    v_accvgpr_read_b32 v59, a123
    v_accvgpr_read_b32 v60, a124
    v_accvgpr_read_b32 v61, a125
    v_accvgpr_read_b32 v62, a126
    v_accvgpr_read_b32 v63, a127
    v_mul_f32 v56, v21, v56
    v_mul_f32 v57, v21, v57
    v_mul_f32 v58, v21, v58
    v_mul_f32 v59, v21, v59
    v_mul_f32 v60, v21, v60
    v_mul_f32 v61, v21, v61
    v_mul_f32 v62, v21, v62
    v_mul_f32 v63, v21, v63
    v_cvt_pk_bf16_f32 v56, v56, v57
    v_cvt_pk_bf16_f32 v57, v58, v59
    v_cvt_pk_bf16_f32 v58, v60, v61
    v_cvt_pk_bf16_f32 v59, v62, v63
    buffer_store_dwordx4 v[56:59], v2, s[8:11], s90 offen offset:1024 sc1
    s_add_u32 s90, s90, 131072
    s_lshl_b32 s101, s34, 5
    s_add_u32 s101, s101, s32
    s_lshl_b32 s101, s101, 3
    s_add_u32 s101, s101, 7936
    s_cmp_eq_u32 s64, s72
    s_cbranch_scc1 m_singlex120
.p2align 3
m_single119:
    v_mfma_f32_16x16x32_bf16 v[64:67], a[192:195], a[128:131], v[160:163]
    s_bitcmp1_b64 s[62:63], s64
    s_cselect_b32 s66, -1.0, s65
    v_add_f32 v12, v12, v28
    v_mfma_f32_16x16x32_bf16 v[64:67], a[196:199], a[132:135], v[64:67]
    s_mov_b32 m0, s59
    ds_read_b128 a[224:227], v6 offset:16384
    v_add_f32 v13, v13, v32
    v_mfma_f32_16x16x32_bf16 v[64:67], a[200:203], a[136:139], v[64:67]
    buffer_load_dwordx4 v7, s[24:27], s56 offen offset:0 sc1 lds
    v_mfma_f32_16x16x32_bf16 v[64:67], a[204:207], a[140:143], v[64:67]
    s_add_u32 s64, s64, 1
    ds_read_b128 a[228:231], v6 offset:17408
    v_exp_f32 v20, v96
    v_mfma_f32_16x16x32_bf16 v[72:75], a[204:207], a[156:159], v[168:171]
    ds_read_b128 a[232:235], v6 offset:18432
    v_exp_f32 v21, v97
    v_mfma_f32_16x16x32_bf16 v[72:75], a[200:203], a[152:155], v[72:75]
    ds_read_b128 a[236:239], v6 offset:19456
    v_cvt_pk_bf16_f32 v144, v20, v21
    v_mfma_f32_16x16x32_bf16 v[72:75], a[196:199], a[148:151], v[72:75]
    ds_read_b128 a[240:243], v6 offset:20480
    v_exp_f32 v22, v98
    v_mfma_f32_16x16x32_bf16 v[72:75], a[192:195], a[144:147], v[72:75]
    s_waitcnt lgkmcnt(5)
    ds_read_b128 a[244:247], v6 offset:21504
    v_mfma_f32_16x16x32_bf16 v[76:79], a[208:211], a[144:147], v[172:175]
    ds_read_b128 a[248:251], v6 offset:22528
    v_exp_f32 v23, v99
    v_mfma_f32_16x16x32_bf16 v[76:79], a[212:215], a[148:151], v[76:79]
    ds_read_b128 a[252:255], v6 offset:23552
    v_cvt_pk_bf16_f32 v145, v22, v23
    v_mfma_f32_16x16x32_bf16 v[76:79], a[216:219], a[152:155], v[76:79]
    buffer_load_dwordx4 v7, s[24:27], s56 offen offset:1024 sc1 lds
    v_mfma_f32_16x16x32_bf16 v[76:79], a[220:223], a[156:159], v[76:79]
    v_exp_f32 v24, v100
    v_mfma_f32_16x16x32_bf16 v[68:71], a[220:223], a[140:143], v[164:167]
    v_exp_f32 v25, v101
    v_mfma_f32_16x16x32_bf16 v[68:71], a[216:219], a[136:139], v[68:71]
    v_exp_f32 v26, v102
    v_mfma_f32_16x16x32_bf16 v[68:71], a[212:215], a[132:135], v[68:71]
    buffer_load_dwordx4 v7, s[24:27], s56 offen offset:2048 sc1 lds
    v_cvt_pk_bf16_f32 v146, v24, v25
    v_mfma_f32_16x16x32_bf16 v[68:71], a[208:211], a[128:131], v[68:71]
    s_waitcnt lgkmcnt(0)
    v_exp_f32 v27, v103
    v_mfma_f32_16x16x32_bf16 a[0:3], a[224:227], v[128:131], a[0:3]
    ds_read_b128 a[192:195], v6 offset:8192
    v_cvt_pk_bf16_f32 v147, v26, v27
    v_mfma_f32_16x16x32_bf16 a[32:35], a[224:227], v[132:135], a[32:35]
    v_exp_f32 v20, v104
    v_mfma_f32_16x16x32_bf16 v[28:31], v[44:47], v[144:147], 0
    v_exp_f32 v21, v105
    v_mfma_f32_16x16x32_bf16 a[36:39], a[228:231], v[132:135], a[36:39]
    ds_read_b128 a[196:199], v6 offset:9216
    v_exp_f32 v22, v106
    v_mfma_f32_16x16x32_bf16 a[4:7], a[228:231], v[128:131], a[4:7]
    buffer_load_dwordx4 v7, s[24:27], s56 offen offset:3072 sc1 lds
    v_mfma_f32_16x16x32_bf16 a[8:11], a[232:235], v[128:131], a[8:11]
    s_add_u32 s56, s56, 16384
    ds_read_b128 a[200:203], v6 offset:10240
    v_cvt_pk_bf16_f32 v148, v20, v21
    v_mfma_f32_16x16x32_bf16 a[40:43], a[232:235], v[132:135], a[40:43]
    v_exp_f32 v23, v107
    v_mfma_f32_16x16x32_bf16 a[44:47], a[236:239], v[132:135], a[44:47]
    ds_read_b128 a[204:207], v6 offset:11264
    v_exp_f32 v24, v108
    v_mfma_f32_16x16x32_bf16 a[12:15], a[236:239], v[128:131], a[12:15]
    v_cvt_pk_bf16_f32 v149, v22, v23
    v_exp_f32 v25, v109
    v_mfma_f32_16x16x32_bf16 a[16:19], a[240:243], v[128:131], a[16:19]
    v_exp_f32 v26, v110
    v_mfma_f32_16x16x32_bf16 a[48:51], a[240:243], v[132:135], a[48:51]
    v_cvt_pk_bf16_f32 v150, v24, v25
    v_exp_f32 v27, v111
    v_mfma_f32_16x16x32_bf16 a[52:55], a[244:247], v[132:135], a[52:55]
    ds_read_b128 a[208:211], v6 offset:12288
    v_cvt_pk_bf16_f32 v151, v26, v27
    v_mfma_f32_16x16x32_bf16 a[20:23], a[244:247], v[128:131], a[20:23]
    s_add_u32 m0, s59, 16384
    ds_read_b128 a[212:215], v6 offset:13312
    v_mfma_f32_16x16x32_bf16 v[32:35], v[44:47], v[148:151], 0
    s_nop 2
    v_mfma_f32_16x16x32_bf16 a[24:27], a[248:251], v[128:131], a[24:27]
    buffer_load_dwordx4 v7, s[28:31], s57 offen offset:0 sc1 lds
    v_mfma_f32_16x16x32_bf16 a[56:59], a[248:251], v[132:135], a[56:59]
    ds_read_b128 a[216:219], v6 offset:14336
    s_nop 0
    v_mfma_f32_16x16x32_bf16 a[60:63], a[252:255], v[132:135], a[60:63]
    ds_read_b128 a[220:223], v6 offset:15360
    v_max_f32 v8, v28, v32
    v_cmp_nge_f32 vcc, s66, v8
    v_mfma_f32_16x16x32_bf16 a[28:31], a[252:255], v[128:131], a[28:31]
    s_waitcnt lgkmcnt(4)
    s_cbranch_vccnz m_stub121
m_ret122:
    v_mfma_f32_16x16x32_bf16 v[96:99], a[192:195], a[128:131], v[160:163]
    s_add_u32 s59, s58, s60
    v_exp_f32 v20, v64
    v_mfma_f32_16x16x32_bf16 v[96:99], a[196:199], a[132:135], v[96:99]
    s_add_u32 s58, s58, 32768
    ds_read_b128 a[224:227], v6 offset:24576
    v_add_f32 v12, v12, v28
    v_mfma_f32_16x16x32_bf16 v[96:99], a[200:203], a[136:139], v[96:99]
    s_cmp_ge_u32 s58, 163840
    s_cselect_b32 s58, 0, s58
    ds_read_b128 a[228:231], v6 offset:25600
    v_exp_f32 v21, v65
    v_mfma_f32_16x16x32_bf16 v[96:99], a[204:207], a[140:143], v[96:99]
    s_bitcmp1_b64 s[62:63], s64
    s_cselect_b32 s66, -1.0, s65
    ds_read_b128 a[232:235], v6 offset:26624
    v_mfma_f32_16x16x32_bf16 v[104:107], a[204:207], a[156:159], v[168:171]
    buffer_load_dwordx4 v7, s[28:31], s57 offen offset:1024 sc1 lds
    v_mfma_f32_16x16x32_bf16 v[104:107], a[200:203], a[152:155], v[104:107]
    s_add_u32 s64, s64, 1
    ds_read_b128 a[236:239], v6 offset:27648
    v_cvt_pk_bf16_f32 v128, v20, v21
    v_mfma_f32_16x16x32_bf16 v[104:107], a[196:199], a[148:151], v[104:107]
    ds_read_b128 a[240:243], v6 offset:28672
    v_exp_f32 v22, v66
    v_mfma_f32_16x16x32_bf16 v[104:107], a[192:195], a[144:147], v[104:107]
    s_waitcnt lgkmcnt(5)
    ds_read_b128 a[244:247], v6 offset:29696
    v_add_f32 v13, v13, v32
    v_mfma_f32_16x16x32_bf16 v[108:111], a[208:211], a[144:147], v[172:175]
    ds_read_b128 a[248:251], v6 offset:30720
    v_exp_f32 v23, v67
    v_mfma_f32_16x16x32_bf16 v[108:111], a[212:215], a[148:151], v[108:111]
    buffer_load_dwordx4 v7, s[28:31], s57 offen offset:2048 sc1 lds
    v_mfma_f32_16x16x32_bf16 v[108:111], a[216:219], a[152:155], v[108:111]
    ds_read_b128 a[252:255], v6 offset:31744
    v_cvt_pk_bf16_f32 v129, v22, v23
    v_mfma_f32_16x16x32_bf16 v[108:111], a[220:223], a[156:159], v[108:111]
    v_exp_f32 v24, v68
    v_mfma_f32_16x16x32_bf16 v[100:103], a[220:223], a[140:143], v[164:167]
    v_exp_f32 v25, v69
    v_mfma_f32_16x16x32_bf16 v[100:103], a[216:219], a[136:139], v[100:103]
    buffer_load_dwordx4 v7, s[28:31], s57 offen offset:3072 sc1 lds
    v_mfma_f32_16x16x32_bf16 v[100:103], a[212:215], a[132:135], v[100:103]
    s_add_u32 s57, s57, 16384
    v_exp_f32 v26, v70
    v_cvt_pk_bf16_f32 v130, v24, v25
    v_mfma_f32_16x16x32_bf16 v[100:103], a[208:211], a[128:131], v[100:103]
    s_waitcnt vmcnt(24) lgkmcnt(0)
    v_add_u32 v6, s58, v2
    v_exp_f32 v27, v71
    v_mfma_f32_16x16x32_bf16 a[0:3], a[224:227], v[144:147], a[0:3]
    s_barrier
    v_mfma_f32_16x16x32_bf16 a[32:35], a[224:227], v[148:151], a[32:35]
    ds_read_b128 a[192:195], v6 offset:0
    v_cvt_pk_bf16_f32 v131, v26, v27
    v_mfma_f32_16x16x32_bf16 a[36:39], a[228:231], v[148:151], a[36:39]
    v_exp_f32 v20, v72
    v_mfma_f32_16x16x32_bf16 v[28:31], v[44:47], v[128:131], 0
    v_exp_f32 v21, v73
    v_mfma_f32_16x16x32_bf16 a[4:7], a[228:231], v[144:147], a[4:7]
    ds_read_b128 a[196:199], v6 offset:1024
    v_cvt_pk_bf16_f32 v132, v20, v21
    v_mfma_f32_16x16x32_bf16 a[8:11], a[232:235], v[144:147], a[8:11]
    v_exp_f32 v22, v74
    v_mfma_f32_16x16x32_bf16 a[40:43], a[232:235], v[148:151], a[40:43]
    ds_read_b128 a[200:203], v6 offset:2048
    v_exp_f32 v23, v75
    v_mfma_f32_16x16x32_bf16 a[44:47], a[236:239], v[148:151], a[44:47]
    v_exp_f32 v24, v76
    v_mfma_f32_16x16x32_bf16 a[12:15], a[236:239], v[144:147], a[12:15]
    ds_read_b128 a[204:207], v6 offset:3072
    v_cvt_pk_bf16_f32 v133, v22, v23
    v_mfma_f32_16x16x32_bf16 a[16:19], a[240:243], v[144:147], a[16:19]
    v_exp_f32 v25, v77
    v_mfma_f32_16x16x32_bf16 a[48:51], a[240:243], v[148:151], a[48:51]
    v_exp_f32 v26, v78
    v_cvt_pk_bf16_f32 v134, v24, v25
    v_mfma_f32_16x16x32_bf16 a[52:55], a[244:247], v[148:151], a[52:55]
    v_exp_f32 v27, v79
    v_mfma_f32_16x16x32_bf16 a[20:23], a[244:247], v[144:147], a[20:23]
    ds_read_b128 a[208:211], v6 offset:4096
    v_cvt_pk_bf16_f32 v135, v26, v27
    s_nop 1
    v_mfma_f32_16x16x32_bf16 v[32:35], v[44:47], v[132:135], 0
    s_nop 2
    v_mfma_f32_16x16x32_bf16 a[24:27], a[248:251], v[144:147], a[24:27]
    ds_read_b128 a[212:215], v6 offset:5120
    s_nop 0
    v_mfma_f32_16x16x32_bf16 a[56:59], a[248:251], v[148:151], a[56:59]
    ds_read_b128 a[216:219], v6 offset:6144
    v_max_f32 v8, v28, v32
    v_mfma_f32_16x16x32_bf16 a[60:63], a[252:255], v[148:151], a[60:63]
    ds_read_b128 a[220:223], v6 offset:7168
    v_cmp_nge_f32 vcc, s66, v8
    v_mfma_f32_16x16x32_bf16 a[28:31], a[252:255], v[144:147], a[28:31]
    s_waitcnt lgkmcnt(4)
    s_cbranch_vccz m_single119
    v_cmp_lt_f32 vcc, s65, v8
    s_cmp_lg_u32 s64, s70
    s_cbranch_scc1 m_e124
    v_add_f32 v160, v160, v16
    v_mov_b32 v164, v9
    v_add_f32 v172, v172, v16
    v_add_f32 v161, v161, v17
    v_mov_b32 v165, v9
    v_add_f32 v173, v173, v17
    v_add_f32 v162, v162, v18
    v_mov_b32 v166, v9
    v_add_f32 v174, v174, v18
    v_add_f32 v163, v163, v19
    v_mov_b32 v167, v9
    v_add_f32 v175, v175, v19
    s_nop 0
m_e124:
    s_cmp_lg_u32 s64, s71
    s_cbranch_scc1 m_e125
    v_mov_b32 v160, v9
    v_mov_b32 v168, v9
    v_mov_b32 v172, v9
    v_mov_b32 v161, v9
    v_mov_b32 v169, v9
    v_mov_b32 v173, v9
    v_mov_b32 v162, v9
    v_mov_b32 v170, v9
    v_mov_b32 v174, v9
    v_mov_b32 v163, v9
    v_mov_b32 v171, v9
    v_mov_b32 v175, v9
    s_nop 0
m_e125:
    s_cmp_lg_u32 s64, s53
    s_cbranch_scc1 m_e128
    s_cmp_lg_u32 s16, 0
    s_cbranch_scc1 m_np129
    v_mov_b32 v60, s4
    v_mov_b32 v61, s5
    s_add_u32 s90, s101, 117440512
    s_mov_b64 exec, 1
    buffer_store_dwordx2 v[60:61], off, s[8:11], s90 sc1
    s_mov_b64 exec, -1
m_np129:
    s_mov_b32 s101, -1
m_e128:
    s_cmp_gt_u32 s64, 24
    s_cbranch_scc1 m_e126
    s_cmp_lg_u32 s64, 8
    s_cbranch_scc1 m_e130
    s_lshr_b32 s90, s32, 1
    s_lshl_b32 s90, s90, 7
    s_add_u32 s90, s90, 117440600
    v_min_u32 v0, 1, v1
    v_lshlrev_b32 v0, 5, v0
    buffer_load_dwordx2 v[4:5], v0, s[8:11], s90 offen sc1
    s_cmp_eq_u32 s17, -1
    s_cbranch_scc1 m_e126
    s_cmp_lg_u32 s16, 0
    s_cbranch_scc1 m_np131
    v_mov_b32 v60, s4
    v_mov_b32 v61, s5
    s_add_u32 s90, s17, 117440512
    s_mov_b64 exec, 1
    buffer_store_dwordx2 v[60:61], off, s[8:11], s90 sc1
    s_mov_b64 exec, -1
m_np131:
    s_branch m_e126
m_e130:
    s_cmp_lg_u32 s64, 16
    s_cbranch_scc1 m_e132
    s_waitcnt vmcnt(18)
    s_mov_b32 s3, 1048576
m_spin133:
    v_cmp_ne_u64 s[76:77], s[4:5], v[4:5]
    s_nop 3
    s_cmp_eq_u64 s[76:77], 0
    s_cbranch_scc1 m_e126
    s_sub_u32 s3, s3, 1
    s_cbranch_scc1 m_e126
    s_sleep 32
    s_lshr_b32 s90, s32, 1
    s_lshl_b32 s90, s90, 7
    s_add_u32 s90, s90, 117440600
    v_min_u32 v0, 1, v1
    v_lshlrev_b32 v0, 5, v0
    buffer_load_dwordx2 v[4:5], v0, s[8:11], s90 offen sc1
    s_waitcnt vmcnt(0)
    s_branch m_spin133
    s_branch m_e126
m_e132:
    s_cmp_lg_u32 s64, 20
    s_cbranch_scc1 m_e134
    buffer_load_dwordx2 v[4:5], v10, s[8:11], 0 offen sc1
    s_mov_b32 s44, s48
    s_mov_b32 s45, s49
    s_mov_b32 s46, 8388608
    s_lshl_b32 s90, s2, 2
    s_add_u32 s90, s90, s16
    s_lshl_b32 s90, s90, 13
    v_lshlrev_b32 v62, 7, v1
    buffer_load_dword v255, v62, s[44:47], s90 offen
    s_branch m_e126
m_e134:
    s_cmp_lg_u32 s64, 24
    s_cbranch_scc1 m_e135
    s_mov_b32 s44, s50
    s_mov_b32 s45, s51
    s_mov_b32 s46, 2097152
    s_lshl_b32 s90, s2, 2
    s_add_u32 s90, s90, s16
    s_lshl_b32 s90, s90, 13
    v_lshlrev_b32 v62, 7, v1
    buffer_load_dword v255, v62, s[44:47], s90 offen
    s_waitcnt vmcnt(18)
    s_mov_b32 s3, 1048576
m_spin136:
    v_cmp_ne_u64 s[76:77], s[4:5], v[4:5]
    s_nop 3
    s_cmp_eq_u64 s[76:77], 0
    s_cbranch_scc1 m_e126
    s_sub_u32 s3, s3, 1
    s_cbranch_scc1 m_e126
    s_sleep 32
    buffer_load_dwordx2 v[4:5], v10, s[8:11], 0 offen sc1
    s_waitcnt vmcnt(0)
    s_branch m_spin136
    s_branch m_e126
m_e135:
m_e126:
    s_cbranch_vccnz m_rc137
m_sp123:
    s_cmp_lg_u32 s64, s72
    s_cbranch_scc1 m_single119
m_singlex120:
    s_bfe_u32 s95, s2, 0x10002
    s_and_b32 s90, s2, 7
    s_bitcmp1_b32 0x63, s90
    s_cselect_b32 s96, s33, s34
    s_sub_u32 s96, s96, 1
    s_and_b32 s90, s2, 1
    s_lshl_b32 s90, s90, 2
    s_bfe_u32 s91, s2, 0x20003
    s_add_u32 s97, s90, s91
    v_and_b32 v10, 31, v1
    v_lshlrev_b32 v10, 3, v10
    s_lshl_b32 s52, s96, 8
    s_add_u32 s52, s52, 117448704
    buffer_load_dwordx2 v[4:5], v10, s[8:11], s52 offen sc1
    ds_read_b128 a[224:227], v6 offset:16384
    ds_read_b128 a[228:231], v6 offset:17408
    ds_read_b128 a[232:235], v6 offset:18432
    ds_read_b128 a[236:239], v6 offset:19456
    ds_read_b128 a[240:243], v6 offset:20480
    ds_read_b128 a[244:247], v6 offset:21504
    ds_read_b128 a[248:251], v6 offset:22528
    ds_read_b128 a[252:255], v6 offset:23552
    s_waitcnt lgkmcnt(0)
    v_mfma_f32_16x16x32_bf16 a[0:3], a[224:227], v[128:131], a[0:3]
    buffer_load_dwordx4 v[192:195], v2, s[8:11], s83 offen offset:0 sc1
    v_exp_f32 v20, v96
    v_mfma_f32_16x16x32_bf16 a[32:35], a[224:227], v[132:135], a[32:35]
    v_exp_f32 v21, v97
    v_exp_f32 v22, v98
    v_mfma_f32_16x16x32_bf16 a[36:39], a[228:231], v[132:135], a[36:39]
    buffer_load_dwordx4 v[196:199], v2, s[8:11], s83 offen offset:1024 sc1
    v_cvt_pk_bf16_f32 v144, v20, v21
    v_add_f32 v12, v12, v28
    v_mfma_f32_16x16x32_bf16 a[4:7], a[228:231], v[128:131], a[4:7]
    v_exp_f32 v23, v99
    v_exp_f32 v24, v100
    v_cvt_pk_bf16_f32 v145, v22, v23
    v_mfma_f32_16x16x32_bf16 a[8:11], a[232:235], v[128:131], a[8:11]
    buffer_load_dwordx4 v[200:203], v2, s[8:11], s83 offen offset:2048 sc1
    v_exp_f32 v25, v101
    v_mfma_f32_16x16x32_bf16 a[40:43], a[232:235], v[132:135], a[40:43]
    v_exp_f32 v26, v102
    v_cvt_pk_bf16_f32 v146, v24, v25
    v_add_f32 v13, v13, v32
    v_mfma_f32_16x16x32_bf16 a[44:47], a[236:239], v[132:135], a[44:47]
    buffer_load_dwordx4 v[204:207], v2, s[8:11], s83 offen offset:3072 sc1
    v_exp_f32 v27, v103
    v_mfma_f32_16x16x32_bf16 a[12:15], a[236:239], v[128:131], a[12:15]
    v_exp_f32 v20, v104
    v_cvt_pk_bf16_f32 v147, v26, v27
    v_mfma_f32_16x16x32_bf16 a[16:19], a[240:243], v[128:131], a[16:19]
    buffer_load_dwordx4 v[212:215], v2, s[8:11], s84 offen offset:0 sc1
    v_exp_f32 v21, v105
    v_mfma_f32_16x16x32_bf16 v[28:31], v[44:47], v[144:147], 0
    v_exp_f32 v22, v106
    v_cvt_pk_bf16_f32 v148, v20, v21
    v_exp_f32 v23, v107
    v_mfma_f32_16x16x32_bf16 a[48:51], a[240:243], v[132:135], a[48:51]
    v_exp_f32 v24, v108
    v_cvt_pk_bf16_f32 v149, v22, v23
    v_exp_f32 v25, v109
    v_mfma_f32_16x16x32_bf16 a[52:55], a[244:247], v[132:135], a[52:55]
    buffer_load_dwordx4 v[216:219], v2, s[8:11], s84 offen offset:1024 sc1
    v_exp_f32 v26, v110
    v_mfma_f32_16x16x32_bf16 a[20:23], a[244:247], v[128:131], a[20:23]
    v_cvt_pk_bf16_f32 v150, v24, v25
    v_exp_f32 v27, v111
    s_nop 0
    v_cvt_pk_bf16_f32 v151, v26, v27
    s_nop 1
    v_mfma_f32_16x16x32_bf16 v[32:35], v[44:47], v[148:151], 0
    s_nop 2
    v_mfma_f32_16x16x32_bf16 a[24:27], a[248:251], v[128:131], a[24:27]
    buffer_load_dwordx4 v[220:223], v2, s[8:11], s84 offen offset:2048 sc1
    v_mfma_f32_16x16x32_bf16 a[56:59], a[248:251], v[132:135], a[56:59]
    s_nop 2
    v_mfma_f32_16x16x32_bf16 a[60:63], a[252:255], v[132:135], a[60:63]
    v_max_f32 v8, v28, v32
    v_cmp_nge_f32 vcc, s65, v8
    v_mfma_f32_16x16x32_bf16 a[28:31], a[252:255], v[128:131], a[28:31]
    s_cbranch_vccnz m_stub138
m_ret139:
    s_nop 1
    s_cmp_ge_u32 s16, 2
    s_cbranch_scc1 m_xb140
    s_waitcnt vmcnt(24)
    s_barrier
m_xb140:
    ds_read_b128 a[224:227], v6 offset:24576
    ds_read_b128 a[228:231], v6 offset:25600
    ds_read_b128 a[232:235], v6 offset:26624
    ds_read_b128 a[236:239], v6 offset:27648
    ds_read_b128 a[240:243], v6 offset:28672
    ds_read_b128 a[244:247], v6 offset:29696
    ds_read_b128 a[248:251], v6 offset:30720
    ds_read_b128 a[252:255], v6 offset:31744
    s_waitcnt lgkmcnt(0)
    v_mfma_f32_16x16x32_bf16 a[0:3], a[224:227], v[144:147], a[0:3]
    buffer_load_dwordx4 v[224:227], v2, s[8:11], s84 offen offset:3072 sc1
    v_mfma_f32_16x16x32_bf16 a[32:35], a[224:227], v[148:151], a[32:35]
    v_mfma_f32_16x16x32_bf16 a[36:39], a[228:231], v[148:151], a[36:39]
    buffer_load_dwordx4 v[208:211], v2, s[8:11], s85 offen offset:0 sc1
    v_mfma_f32_16x16x32_bf16 a[4:7], a[228:231], v[144:147], a[4:7]
    v_mfma_f32_16x16x32_bf16 a[8:11], a[232:235], v[144:147], a[8:11]
    buffer_load_dwordx4 v[232:235], v2, s[8:11], s86 offen offset:0 sc1
    v_mfma_f32_16x16x32_bf16 a[40:43], a[232:235], v[148:151], a[40:43]
    v_mfma_f32_16x16x32_bf16 a[44:47], a[236:239], v[148:151], a[44:47]
    buffer_load_dwordx4 v[236:239], v2, s[8:11], s86 offen offset:1024 sc1
    v_mfma_f32_16x16x32_bf16 a[12:15], a[236:239], v[144:147], a[12:15]
    v_mfma_f32_16x16x32_bf16 a[16:19], a[240:243], v[144:147], a[16:19]
    buffer_load_dwordx4 v[228:231], v2, s[8:11], s87 offen offset:0 sc1
    v_mfma_f32_16x16x32_bf16 a[48:51], a[240:243], v[148:151], a[48:51]
    v_mfma_f32_16x16x32_bf16 a[52:55], a[244:247], v[148:151], a[52:55]
    buffer_load_dwordx4 v[244:247], v2, s[8:11], s88 offen offset:0 sc1
    v_mfma_f32_16x16x32_bf16 a[20:23], a[244:247], v[144:147], a[20:23]
    v_mfma_f32_16x16x32_bf16 a[24:27], a[248:251], v[144:147], a[24:27]
    buffer_load_dwordx4 v[248:251], v2, s[8:11], s88 offen offset:1024 sc1
    v_mfma_f32_16x16x32_bf16 a[56:59], a[248:251], v[148:151], a[56:59]
    v_mfma_f32_16x16x32_bf16 a[60:63], a[252:255], v[148:151], a[60:63]
    buffer_load_dwordx4 v[240:243], v2, s[8:11], s89 offen offset:0 sc1
    v_mfma_f32_16x16x32_bf16 a[28:31], a[252:255], v[144:147], a[28:31]
    v_add_f32 v20, v12, v28
    v_add_f32 v21, v13, v32
    s_nop 3
    v_rcp_f32 v20, v20
    v_rcp_f32 v21, v21
    s_lshl_b32 s90, s78, 10
    s_add_u32 s90, s90, s82
    s_add_u32 s90, s90, 67108864
    v_accvgpr_read_b32 v48, a0
    v_accvgpr_read_b32 v49, a1
    v_accvgpr_read_b32 v50, a2
    v_accvgpr_read_b32 v51, a3
    v_accvgpr_read_b32 v52, a4
    v_accvgpr_read_b32 v53, a5
    v_accvgpr_read_b32 v54, a6
    v_accvgpr_read_b32 v55, a7
    v_mul_f32 v48, v20, v48
    v_mul_f32 v49, v20, v49
    v_mul_f32 v50, v20, v50
    v_mul_f32 v51, v20, v51
    v_mul_f32 v52, v20, v52
    v_mul_f32 v53, v20, v53
    v_mul_f32 v54, v20, v54
    v_mul_f32 v55, v20, v55
    v_cvt_pk_bf16_f32 v48, v48, v49
    v_cvt_pk_bf16_f32 v49, v50, v51
    v_cvt_pk_bf16_f32 v50, v52, v53
    v_cvt_pk_bf16_f32 v51, v54, v55
    buffer_store_dwordx4 v[48:51], v2, s[8:11], s90 offen offset:0 sc1
    v_accvgpr_read_b32 v56, a32
    v_accvgpr_read_b32 v57, a33
    v_accvgpr_read_b32 v58, a34
    v_accvgpr_read_b32 v59, a35
    v_accvgpr_read_b32 v60, a36
    v_accvgpr_read_b32 v61, a37
    v_accvgpr_read_b32 v62, a38
    v_accvgpr_read_b32 v63, a39
    v_mul_f32 v56, v21, v56
    v_mul_f32 v57, v21, v57
    v_mul_f32 v58, v21, v58
    v_mul_f32 v59, v21, v59
    v_mul_f32 v60, v21, v60
    v_mul_f32 v61, v21, v61
    v_mul_f32 v62, v21, v62
    v_mul_f32 v63, v21, v63
    v_cvt_pk_bf16_f32 v56, v56, v57
    v_cvt_pk_bf16_f32 v57, v58, v59
    v_cvt_pk_bf16_f32 v58, v60, v61
    v_cvt_pk_bf16_f32 v59, v62, v63
    buffer_store_dwordx4 v[56:59], v2, s[8:11], s90 offen offset:1024 sc1
    s_add_u32 s90, s90, 131072
    v_accvgpr_read_b32 v48, a8
    v_accvgpr_read_b32 v49, a9
    v_accvgpr_read_b32 v50, a10
    v_accvgpr_read_b32 v51, a11
    v_accvgpr_read_b32 v52, a12
    v_accvgpr_read_b32 v53, a13
    v_accvgpr_read_b32 v54, a14
    v_accvgpr_read_b32 v55, a15
    v_mul_f32 v48, v20, v48
    v_mul_f32 v49, v20, v49
    v_mul_f32 v50, v20, v50
    v_mul_f32 v51, v20, v51
    v_mul_f32 v52, v20, v52
    v_mul_f32 v53, v20, v53
    v_mul_f32 v54, v20, v54
    v_mul_f32 v55, v20, v55
    v_cvt_pk_bf16_f32 v48, v48, v49
    v_cvt_pk_bf16_f32 v49, v50, v51
    v_cvt_pk_bf16_f32 v50, v52, v53
    v_cvt_pk_bf16_f32 v51, v54, v55
    buffer_store_dwordx4 v[48:51], v2, s[8:11], s90 offen offset:0 sc1
    v_accvgpr_read_b32 v56, a40
    v_accvgpr_read_b32 v57, a41
    v_accvgpr_read_b32 v58, a42
    v_accvgpr_read_b32 v59, a43
    v_accvgpr_read_b32 v60, a44
    v_accvgpr_read_b32 v61, a45
    v_accvgpr_read_b32 v62, a46
    v_accvgpr_read_b32 v63, a47
    v_mul_f32 v56, v21, v56
    v_mul_f32 v57, v21, v57
    v_mul_f32 v58, v21, v58
    v_mul_f32 v59, v21, v59
    v_mul_f32 v60, v21, v60
    v_mul_f32 v61, v21, v61
    v_mul_f32 v62, v21, v62
    v_mul_f32 v63, v21, v63
    v_cvt_pk_bf16_f32 v56, v56, v57
    v_cvt_pk_bf16_f32 v57, v58, v59
    v_cvt_pk_bf16_f32 v58, v60, v61
    v_cvt_pk_bf16_f32 v59, v62, v63
    buffer_store_dwordx4 v[56:59], v2, s[8:11], s90 offen offset:1024 sc1
    s_add_u32 s90, s90, 131072
    v_accvgpr_read_b32 v48, a16
    v_accvgpr_read_b32 v49, a17
    v_accvgpr_read_b32 v50, a18
    v_accvgpr_read_b32 v51, a19
    v_accvgpr_read_b32 v52, a20
    v_accvgpr_read_b32 v53, a21
    v_accvgpr_read_b32 v54, a22
    v_accvgpr_read_b32 v55, a23
    v_mul_f32 v48, v20, v48
    v_mul_f32 v49, v20, v49
    v_mul_f32 v50, v20, v50
    v_mul_f32 v51, v20, v51
    v_mul_f32 v52, v20, v52
    v_mul_f32 v53, v20, v53
    v_mul_f32 v54, v20, v54
    v_mul_f32 v55, v20, v55
    v_cvt_pk_bf16_f32 v48, v48, v49
    v_cvt_pk_bf16_f32 v49, v50, v51
    v_cvt_pk_bf16_f32 v50, v52, v53
    v_cvt_pk_bf16_f32 v51, v54, v55
    buffer_store_dwordx4 v[48:51], v2, s[8:11], s90 offen offset:0 sc1
    v_accvgpr_read_b32 v56, a48
    v_accvgpr_read_b32 v57, a49
    v_accvgpr_read_b32 v58, a50
    v_accvgpr_read_b32 v59, a51
    v_accvgpr_read_b32 v60, a52
    v_accvgpr_read_b32 v61, a53
    v_accvgpr_read_b32 v62, a54
    v_accvgpr_read_b32 v63, a55
    v_mul_f32 v56, v21, v56
    v_mul_f32 v57, v21, v57
    v_mul_f32 v58, v21, v58
    v_mul_f32 v59, v21, v59
    v_mul_f32 v60, v21, v60
    v_mul_f32 v61, v21, v61
    v_mul_f32 v62, v21, v62
    v_mul_f32 v63, v21, v63
    v_cvt_pk_bf16_f32 v56, v56, v57
    v_cvt_pk_bf16_f32 v57, v58, v59
    v_cvt_pk_bf16_f32 v58, v60, v61
    v_cvt_pk_bf16_f32 v59, v62, v63
    buffer_store_dwordx4 v[56:59], v2, s[8:11], s90 offen offset:1024 sc1
    s_add_u32 s90, s90, 131072
    v_accvgpr_read_b32 v48, a24
    v_accvgpr_read_b32 v49, a25
    v_accvgpr_read_b32 v50, a26
    v_accvgpr_read_b32 v51, a27
    v_accvgpr_read_b32 v52, a28
    v_accvgpr_read_b32 v53, a29
    v_accvgpr_read_b32 v54, a30
    v_accvgpr_read_b32 v55, a31
    v_mul_f32 v48, v20, v48
    v_mul_f32 v49, v20, v49
    v_mul_f32 v50, v20, v50
    v_mul_f32 v51, v20, v51
    v_mul_f32 v52, v20, v52
    v_mul_f32 v53, v20, v53
    v_mul_f32 v54, v20, v54
    v_mul_f32 v55, v20, v55
    v_cvt_pk_bf16_f32 v48, v48, v49
    v_cvt_pk_bf16_f32 v49, v50, v51
    v_cvt_pk_bf16_f32 v50, v52, v53
    v_cvt_pk_bf16_f32 v51, v54, v55
    buffer_store_dwordx4 v[48:51], v2, s[8:11], s90 offen offset:0 sc1
    v_accvgpr_read_b32 v56, a56
    v_accvgpr_read_b32 v57, a57
    v_accvgpr_read_b32 v58, a58
    v_accvgpr_read_b32 v59, a59
    v_accvgpr_read_b32 v60, a60
    v_accvgpr_read_b32 v61, a61
    v_accvgpr_read_b32 v62, a62
    v_accvgpr_read_b32 v63, a63
    v_mul_f32 v56, v21, v56
    v_mul_f32 v57, v21, v57
    v_mul_f32 v58, v21, v58
    v_mul_f32 v59, v21, v59
    v_mul_f32 v60, v21, v60
    v_mul_f32 v61, v21, v61
    v_mul_f32 v62, v21, v62
    v_mul_f32 v63, v21, v63
    v_cvt_pk_bf16_f32 v56, v56, v57
    v_cvt_pk_bf16_f32 v57, v58, v59
    v_cvt_pk_bf16_f32 v58, v60, v61
    v_cvt_pk_bf16_f32 v59, v62, v63
    buffer_store_dwordx4 v[56:59], v2, s[8:11], s90 offen offset:1024 sc1
    s_add_u32 s90, s90, 131072
    s_lshr_b32 s53, s16, 1
    s_and_b32 s40, s16, 1
    s_mul_i32 s90, s95, 5242880
    s_lshl_b32 s57, s97, 8
    s_add_u32 s57, s57, s90
    v_lshrrev_b32 v20, 4, v1
    s_lshl_b32 s90, s16, 4
    v_add_u32 v21, s90, v20
    v_lshlrev_b32 v21, 11, v21
    v_lshlrev_b32 v20, 1, v20
    v_and_b32 v22, 15, v1
    v_xor_b32 v20, v20, v22
    v_xor_b32 v22, 0, v20
    v_lshl_add_u32 v16, v22, 4, v21
    v_xor_b32 v22, 8, v20
    v_lshl_add_u32 v17, v22, 4, v21
    v_add_u32 v17, 7168, v17
    v_xor_b32 v22, 0, v20
    v_lshl_add_u32 v18, v22, 4, v21
    v_add_u32 v18, 14336, v18
    v_xor_b32 v22, 8, v20
    v_lshl_add_u32 v19, v22, 4, v21
    v_add_u32 v19, 21504, v19
    s_mov_b32 s24, s48
    s_mov_b32 s25, s49
    s_mov_b32 s26, 8388608
    s_mov_b32 s38, 268435456
    s_mov_b32 s28, s54
    s_mov_b32 s29, s55
    s_mov_b32 s30, 8388608
    s_lshl_b32 s90, s96, 13
    s_lshl_b32 s91, s40, 12
    s_add_u32 s90, s90, s91
    s_lshl_b32 s91, s53, 17
    s_add_u32 s69, s90, s91
    s_mul_i32 s90, s95, 10485760
    s_add_u32 s56, s69, s90
    s_add_u32 s56, s56, 67108864
    s_add_u32 s69, s69, 83886080
    s_lshl_b32 s90, s53, 12
    v_add_u32 v6, s90, v2
    v_lshrrev_b32 v48, 2, v1
    v_lshlrev_b32 v48, 8, v48
    v_and_b32 v49, 3, v1
    v_lshl_add_u32 v48, v49, 3, v48
    v_add_u32 v48, 16384, v48
    v_bfe_u32 v49, v1, 2, 3
    s_lshl_b32 s90, s40, 2
    v_xor_b32 v49, s90, v49
    v_xor_b32 v50, 0, v49
    v_lshl_add_u32 v12, v50, 5, v48
    v_xor_b32 v50, 1, v49
    v_lshl_add_u32 v13, v50, 5, v48
    v_xor_b32 v50, 2, v49
    v_lshl_add_u32 v14, v50, 5, v48
    v_xor_b32 v50, 3, v49
    v_lshl_add_u32 v15, v50, 5, v48
    v_and_b32 v48, 15, v1
    v_lshlrev_b32 v48, 12, v48
    v_lshlrev_b32 v48, s95, v48
    v_bfe_u32 v49, v1, 4, 1
    v_lshl_add_u32 v48, v49, 5, v48
    v_lshrrev_b32 v49, 5, v1
    v_lshl_add_u32 v7, v49, 4, v48
    s_lshl_b32 s90, s96, 3
    s_lshl_b32 s91, s53, 2
    s_add_u32 s90, s90, s91
    s_lshl_b32 s91, s90, 16
    s_add_u32 s91, s91, 2048
    s_and_b32 s92, s90, 63
    s_lshl_b32 s92, s92, 17
    s_lshr_b32 s93, s90, 6
    s_lshl_b32 s93, s93, 12
    s_add_u32 s92, s92, s93
    s_cmp_eq_u32 s95, 1
    s_cselect_b32 s71, s92, s91
    s_lshl_b32 s72, 0x10000, s95
    s_lshl_b32 s92, s97, 8
    s_lshl_b32 s93, s40, 7
    s_add_u32 s71, s71, s92
    s_add_u32 s71, s71, s93
    v_mov_b64 v[64:65], 0
    v_mov_b64 v[66:67], 0
    v_mov_b64 v[68:69], 0
    v_mov_b64 v[70:71], 0
    v_mov_b64 v[72:73], 0
    v_mov_b64 v[74:75], 0
    v_mov_b64 v[76:77], 0
    v_mov_b64 v[78:79], 0
    v_mov_b64 v[80:81], 0
    v_mov_b64 v[82:83], 0
    v_mov_b64 v[84:85], 0
    v_mov_b64 v[86:87], 0
    v_mov_b64 v[88:89], 0
    v_mov_b64 v[90:91], 0
    v_mov_b64 v[92:93], 0
    v_mov_b64 v[94:95], 0
    v_mov_b64 v[96:97], 0
    v_mov_b64 v[98:99], 0
    v_mov_b64 v[100:101], 0
    v_mov_b64 v[102:103], 0
    v_mov_b64 v[104:105], 0
    v_mov_b64 v[106:107], 0
    v_mov_b64 v[108:109], 0
    v_mov_b64 v[110:111], 0
    v_mov_b64 v[112:113], 0
    v_mov_b64 v[114:115], 0
    v_mov_b64 v[116:117], 0
    v_mov_b64 v[118:119], 0
    v_mov_b64 v[120:121], 0
    v_mov_b64 v[122:123], 0
    v_mov_b64 v[124:125], 0
    v_mov_b64 v[126:127], 0
    v_and_b32 v48, 15, v1
    v_lshrrev_b32 v49, 4, v1
    v_lshlrev_b32 v49, 2, v49
    v_sub_u32 v48, v48, v49
    v_cmp_ge_i32 vcc, -9, v48
    v_subrev_u32 v50, 0, v48
    v_cmp_ge_u32 s[76:77], 7, v50
    s_nop 0
    v_cndmask_b32 v128, v9, 0, vcc
    v_cndmask_b32 v132, v9, 0, s[76:77]
    v_cmp_ge_i32 vcc, -8, v48
    v_subrev_u32 v50, 1, v48
    v_cmp_ge_u32 s[76:77], 7, v50
    s_nop 0
    v_cndmask_b32 v129, v9, 0, vcc
    v_cndmask_b32 v133, v9, 0, s[76:77]
    v_cmp_ge_i32 vcc, -7, v48
    v_subrev_u32 v50, 2, v48
    v_cmp_ge_u32 s[76:77], 7, v50
    s_nop 0
    v_cndmask_b32 v130, v9, 0, vcc
    v_cndmask_b32 v134, v9, 0, s[76:77]
    v_cmp_ge_i32 vcc, -6, v48
    v_subrev_u32 v50, 3, v48
    v_cmp_ge_u32 s[76:77], 7, v50
    s_nop 0
    v_cndmask_b32 v131, v9, 0, vcc
    v_cndmask_b32 v135, v9, 0, s[76:77]
    s_cmp_eq_u32 s81, 0
    s_cselect_b64 vcc, -1, 0
    s_nop 0
    v_cndmask_b32 v136, v128, v9, vcc
    v_cndmask_b32 v137, v129, v9, vcc
    v_cndmask_b32 v138, v130, v9, vcc
    v_cndmask_b32 v139, v131, v9, vcc
    s_lshl_b32 s90, s80, 10
    s_lshr_b32 s91, s2, 3
    s_lshl_b32 s91, s91, 17
    s_add_u32 s90, s90, s91
    s_add_u32 s80, s90, 83886080
    s_add_u32 s59, s60, 131072
    s_mov_b32 s58, 0
    s_mov_b32 s100, 32768
    s_mov_b32 s64, 0
    s_mov_b32 s67, 0
    s_waitcnt vmcnt(0)
    s_barrier
    s_lshl_b32 s91, s33, 5
    s_add_u32 s91, s91, s32
    s_lshl_b32 s91, s91, 3
    s_add_u32 s91, s91, 7936
    s_cmp_lg_u32 s16, 0
    s_cbranch_scc1 m_np141
    v_mov_b32 v60, s4
    v_mov_b32 v61, s5
    s_add_u32 s90, s91, 117440512
    s_mov_b64 exec, 1
    buffer_store_dwordx2 v[60:61], off, s[8:11], s90 sc1
    s_mov_b64 exec, -1
m_np141:
    s_cmp_eq_u32 s101, -1
    s_cbranch_scc1 m_pb142
    s_cmp_lg_u32 s16, 0
    s_cbranch_scc1 m_np144
    v_mov_b32 v60, s4
    v_mov_b32 v61, s5
    s_add_u32 s90, s101, 117440512
    s_mov_b64 exec, 1
    buffer_store_dwordx2 v[60:61], off, s[8:11], s90 sc1
    s_mov_b64 exec, -1
m_np144:
m_pb142:
    v_cmp_ne_u64 s[76:77], s[4:5], v[4:5]
    s_mul_i32 s91, s95, 20
    s_nop 2
    s_lshr_b32 s90, s76, s91
    s_ff1_i32_b32 s90, s90
    s_lshl_b32 s68, s90, 1
    s_mul_i32 s91, s95, 0
    s_sub_i32 s68, s68, s91
    s_cmp_lt_i32 s90, 0
    s_cselect_b32 s68, 1000, s68
    s_add_u32 m0, s60, 16384
    s_nop 0
    buffer_load_dwordx4 v16, s[24:27], s57 offen offset:0 sc1 lds
    buffer_load_dwordx4 v17, s[24:27], s57 offen offset:1024 sc1 lds
    buffer_load_dwordx4 v18, s[24:27], s57 offen offset:2048 sc1 lds
    buffer_load_dwordx4 v19, s[24:27], s57 offen offset:3072 sc1 lds
    s_add_u32 s57, s57, 131072
    s_add_u32 m0, s60, 49152
    s_nop 0
    buffer_load_dwordx4 v16, s[24:27], s57 offen offset:0 sc1 lds
    buffer_load_dwordx4 v17, s[24:27], s57 offen offset:1024 sc1 lds
    buffer_load_dwordx4 v18, s[24:27], s57 offen offset:2048 sc1 lds
    buffer_load_dwordx4 v19, s[24:27], s57 offen offset:3072 sc1 lds
    s_add_u32 s57, s57, 131072
    s_add_u32 m0, s60, 81920
    s_nop 0
    buffer_load_dwordx4 v16, s[24:27], s57 offen offset:0 sc1 lds
    buffer_load_dwordx4 v17, s[24:27], s57 offen offset:1024 sc1 lds
    buffer_load_dwordx4 v18, s[24:27], s57 offen offset:2048 sc1 lds
    buffer_load_dwordx4 v19, s[24:27], s57 offen offset:3072 sc1 lds
    s_add_u32 s57, s57, 131072
    s_add_u32 m0, s60, 114688
    s_nop 0
    buffer_load_dwordx4 v16, s[24:27], s57 offen offset:0 sc1 lds
    buffer_load_dwordx4 v17, s[24:27], s57 offen offset:1024 sc1 lds
    buffer_load_dwordx4 v18, s[24:27], s57 offen offset:2048 sc1 lds
    buffer_load_dwordx4 v19, s[24:27], s57 offen offset:3072 sc1 lds
    s_add_u32 s57, s57, 131072
    s_cmp_gt_i32 s68, 4
    s_cbranch_scc1 m_x3143
    s_mov_b32 s3, 1048576
m_spin145:
    buffer_load_dwordx2 v[4:5], v10, s[8:11], s52 offen sc1
    s_waitcnt vmcnt(0)
    v_cmp_ne_u64 s[76:77], s[4:5], v[4:5]
    s_mul_i32 s91, s95, 20
    s_nop 2
    s_lshr_b32 s90, s76, s91
    s_ff1_i32_b32 s90, s90
    s_lshl_b32 s68, s90, 1
    s_mul_i32 s91, s95, 0
    s_sub_i32 s68, s68, s91
    s_cmp_lt_i32 s90, 0
    s_cselect_b32 s68, 1000, s68
    s_cmp_gt_i32 s68, 4
    s_cbranch_scc1 m_ok146
    s_sub_u32 s3, s3, 1
    s_cbranch_scc1 m_ok146
    s_sleep 4
    s_branch m_spin145
m_ok146:
m_x3143:
    s_add_u32 m0, s60, 0
    s_nop 0
    buffer_load_dwordx4 v2, s[36:39], s56 offen offset:0 sc1 lds
    buffer_load_dwordx4 v2, s[36:39], s56 offen offset:1024 sc1 lds
    buffer_load_dwordx4 v2, s[36:39], s56 offen offset:2048 sc1 lds
    buffer_load_dwordx4 v2, s[36:39], s56 offen offset:3072 sc1 lds
    s_add_u32 s56, s56, 262144
    s_add_u32 m0, s60, 32768
    s_nop 0
    buffer_load_dwordx4 v2, s[36:39], s56 offen offset:0 sc1 lds
    buffer_load_dwordx4 v2, s[36:39], s56 offen offset:1024 sc1 lds
    buffer_load_dwordx4 v2, s[36:39], s56 offen offset:2048 sc1 lds
    buffer_load_dwordx4 v2, s[36:39], s56 offen offset:3072 sc1 lds
    s_add_u32 s56, s56, 262144
    s_add_u32 m0, s60, 65536
    s_nop 0
    buffer_load_dwordx4 v2, s[36:39], s56 offen offset:0 sc1 lds
    buffer_load_dwordx4 v2, s[36:39], s56 offen offset:1024 sc1 lds
    buffer_load_dwordx4 v2, s[36:39], s56 offen offset:2048 sc1 lds
    buffer_load_dwordx4 v2, s[36:39], s56 offen offset:3072 sc1 lds
    s_add_u32 s56, s56, 262144
    s_add_u32 m0, s60, 98304
    s_nop 0
    buffer_load_dwordx4 v2, s[36:39], s56 offen offset:0 sc1 lds
    buffer_load_dwordx4 v2, s[36:39], s56 offen offset:1024 sc1 lds
    buffer_load_dwordx4 v2, s[36:39], s56 offen offset:2048 sc1 lds
    buffer_load_dwordx4 v2, s[36:39], s56 offen offset:3072 sc1 lds
    s_add_u32 s56, s56, 262144
    s_add_u32 m0, s60, 131072
    s_nop 0
    buffer_load_dwordx4 v2, s[36:39], s56 offen offset:0 sc1 lds
    buffer_load_dwordx4 v2, s[36:39], s56 offen offset:1024 sc1 lds
    buffer_load_dwordx4 v2, s[36:39], s56 offen offset:2048 sc1 lds
    buffer_load_dwordx4 v2, s[36:39], s56 offen offset:3072 sc1 lds
    s_add_u32 s56, s56, 262144
    s_waitcnt vmcnt(16)
    s_barrier
    ds_read_b128 a[0:3], v6 offset:0
    ds_read_b64_tr_b16 a[16:17], v12 offset:0
    ds_read_b64_tr_b16 a[18:19], v12 offset:4096
    ds_read_b128 a[4:7], v6 offset:1024
    ds_read_b128 a[8:11], v6 offset:2048
    ds_read_b128 a[12:15], v6 offset:3072
    ds_read_b64_tr_b16 a[20:21], v13 offset:0
    ds_read_b64_tr_b16 a[22:23], v13 offset:4096
    ds_read_b64_tr_b16 a[24:25], v14 offset:0
    ds_read_b64_tr_b16 a[26:27], v14 offset:4096
    ds_read_b64_tr_b16 a[28:29], v15 offset:0
    ds_read_b64_tr_b16 a[30:31], v15 offset:4096
    s_cmp_gt_i32 s68, 5
    s_cbranch_scc0 m_lp152
m_lr153:
    s_waitcnt lgkmcnt(9)
    v_mfma_f32_16x16x32_bf16 v[64:67], a[16:19], a[0:3], v[64:67]
    s_add_u32 m0, s59, 16384
    ds_read_b128 a[32:35], v6 offset:8192
    v_mfma_f32_16x16x32_bf16 v[148:151], v[208:211], v[192:195], v[136:139]
    v_mfma_f32_16x16x32_bf16 v[152:155], v[212:215], v[192:195], v[132:135]
    s_waitcnt lgkmcnt(9)
    v_mfma_f32_16x16x32_bf16 v[72:75], a[16:19], a[4:7], v[72:75]
    ds_read_b64_tr_b16 a[48:49], v12 offset:8192
    buffer_load_dwordx4 v16, s[24:27], s57 offen offset:0 sc1 lds
    v_mfma_f32_16x16x32_bf16 v[156:159], v[212:215], v[196:199], v[128:131]
    s_waitcnt lgkmcnt(9)
    v_mfma_f32_16x16x32_bf16 v[80:83], a[16:19], a[8:11], v[80:83]
    s_add_u32 s59, s58, s60
    ds_read_b64_tr_b16 a[50:51], v12 offset:12288
    v_mfma_f32_16x16x32_bf16 v[160:163], v[216:219], v[196:199], v[132:135]
    v_mfma_f32_16x16x32_bf16 v[164:167], v[216:219], v[200:203], v[128:131]
    s_waitcnt lgkmcnt(9)
    v_mfma_f32_16x16x32_bf16 v[88:91], a[16:19], a[12:15], v[88:91]
    s_add_u32 s58, s58, 32768
    ds_read_b128 a[36:39], v6 offset:9216
    v_mfma_f32_16x16x32_bf16 v[168:171], v[220:223], v[200:203], v[132:135]
    v_mfma_f32_16x16x32_bf16 v[172:175], v[220:223], v[204:207], v[128:131]
    s_waitcnt lgkmcnt(8)
    v_mfma_f32_16x16x32_bf16 v[68:71], a[20:23], a[0:3], v[68:71]
    s_cmp_ge_u32 s58, 163840
    ds_read_b128 a[40:43], v6 offset:10240
    v_mfma_f32_16x16x32_bf16 v[176:179], v[224:227], v[204:207], v[132:135]
    s_nop 1
    v_mfma_f32_16x16x32_bf16 v[76:79], a[20:23], a[4:7], v[76:79]
    ds_read_b128 a[44:47], v6 offset:11264
    buffer_load_dwordx4 v17, s[24:27], s57 offen offset:1024 sc1 lds
    s_nop 1
    v_mfma_f32_16x16x32_bf16 v[84:87], a[20:23], a[8:11], v[84:87]
    s_cselect_b32 s66, 4294836224, s100
    ds_read_b64_tr_b16 a[52:53], v13 offset:8192
    s_nop 1
    s_nop 1
    v_mfma_f32_16x16x32_bf16 v[92:95], a[20:23], a[12:15], v[92:95]
    s_cselect_b32 s58, 0, s58
    ds_read_b64_tr_b16 a[54:55], v13 offset:12288
    v_max3_f32 v140, v148, v149, v150
    v_max3_f32 v141, v156, v157, v158
    s_waitcnt lgkmcnt(10)
    v_mfma_f32_16x16x32_bf16 v[96:99], a[24:27], a[0:3], v[96:99]
    ds_read_b64_tr_b16 a[56:57], v14 offset:8192
    v_max3_f32 v142, v164, v165, v166
    v_max3_f32 v143, v172, v173, v174
    v_mfma_f32_16x16x32_bf16 v[104:107], a[24:27], a[4:7], v[104:107]
    ds_read_b64_tr_b16 a[58:59], v14 offset:12288
    buffer_load_dwordx4 v18, s[24:27], s57 offen offset:2048 sc1 lds
    v_max3_f32 v140, v140, v151, v152
    v_mfma_f32_16x16x32_bf16 v[112:115], a[24:27], a[8:11], v[112:115]
    ds_read_b64_tr_b16 a[60:61], v15 offset:8192
    v_max3_f32 v141, v141, v159, v160
    v_max3_f32 v142, v142, v167, v168
    v_mfma_f32_16x16x32_bf16 v[120:123], a[24:27], a[12:15], v[120:123]
    ds_read_b64_tr_b16 a[62:63], v15 offset:12288
    v_max3_f32 v143, v143, v175, v176
    v_max3_f32 v140, v140, v153, v154
    s_waitcnt lgkmcnt(12)
    v_mfma_f32_16x16x32_bf16 v[100:103], a[28:31], a[0:3], v[100:103]
    v_add_u32 v6, s66, v6
    v_add_u32 v12, s66, v12
    v_max3_f32 v141, v141, v161, v162
    v_mfma_f32_16x16x32_bf16 v[108:111], a[28:31], a[4:7], v[108:111]
    buffer_load_dwordx4 v19, s[24:27], s57 offen offset:3072 sc1 lds
    v_max3_f32 v142, v142, v169, v170
    v_mfma_f32_16x16x32_bf16 v[116:119], a[28:31], a[8:11], v[116:119]
    s_add_u32 s57, s57, 131072
    v_add_u32 v13, s66, v13
    v_add_u32 v14, s66, v14
    v_max3_f32 v143, v143, v177, v178
    v_mfma_f32_16x16x32_bf16 v[124:127], a[28:31], a[12:15], v[124:127]
    s_mov_b32 m0, s59
    v_add_u32 v15, s66, v15
    v_max_f32 v140, v140, v155
    s_waitcnt vmcnt(16) lgkmcnt(0)
    v_mfma_f32_16x16x32_bf16 v[64:67], a[48:51], a[32:35], v[64:67]
    s_barrier
    v_max_f32 v141, v141, v163
    v_max_f32 v142, v142, v171
    v_mfma_f32_16x16x32_bf16 v[72:75], a[48:51], a[36:39], v[72:75]
    ds_read_b128 a[0:3], v6 offset:0
    buffer_load_dwordx4 v2, s[36:39], s56 offen offset:0 sc1 lds
    v_max_f32 v143, v143, v179
    v_mfma_f32_16x16x32_bf16 v[80:83], a[48:51], a[40:43], v[80:83]
    ds_read_b64_tr_b16 a[16:17], v12 offset:0
    v_mov_b32 v144, v140
    v_mov_b32 v145, v141
    v_mfma_f32_16x16x32_bf16 v[88:91], a[48:51], a[44:47], v[88:91]
    ds_read_b64_tr_b16 a[18:19], v12 offset:4096
    v_mov_b32 v146, v142
    v_mov_b32 v147, v143
    v_mfma_f32_16x16x32_bf16 v[68:71], a[52:55], a[32:35], v[68:71]
    ds_read_b128 a[4:7], v6 offset:1024
    s_nop 1
    v_permlane32_swap_b32 v140, v144
    v_mfma_f32_16x16x32_bf16 v[76:79], a[52:55], a[36:39], v[76:79]
    ds_read_b128 a[8:11], v6 offset:2048
    buffer_load_dwordx4 v2, s[36:39], s56 offen offset:1024 sc1 lds
    v_permlane32_swap_b32 v141, v145
    v_mfma_f32_16x16x32_bf16 v[84:87], a[52:55], a[40:43], v[84:87]
    ds_read_b128 a[12:15], v6 offset:3072
    v_permlane32_swap_b32 v142, v146
    v_permlane32_swap_b32 v143, v147
    v_mfma_f32_16x16x32_bf16 v[92:95], a[52:55], a[44:47], v[92:95]
    ds_read_b64_tr_b16 a[20:21], v13 offset:0
    s_nop 1
    v_max_f32 v140, v140, v144
    v_mfma_f32_16x16x32_bf16 v[96:99], a[56:59], a[32:35], v[96:99]
    ds_read_b64_tr_b16 a[22:23], v13 offset:4096
    v_max_f32 v141, v141, v145
    v_max_f32 v142, v142, v146
    v_mfma_f32_16x16x32_bf16 v[104:107], a[56:59], a[36:39], v[104:107]
    ds_read_b64_tr_b16 a[24:25], v14 offset:0
    buffer_load_dwordx4 v2, s[36:39], s56 offen offset:2048 sc1 lds
    v_max_f32 v143, v143, v147
    v_mfma_f32_16x16x32_bf16 v[112:115], a[56:59], a[40:43], v[112:115]
    ds_read_b64_tr_b16 a[26:27], v14 offset:4096
    v_mov_b32 v144, v140
    v_mov_b32 v145, v141
    v_mfma_f32_16x16x32_bf16 v[120:123], a[56:59], a[44:47], v[120:123]
    ds_read_b64_tr_b16 a[28:29], v15 offset:0
    v_mov_b32 v146, v142
    v_mov_b32 v147, v143
    v_mfma_f32_16x16x32_bf16 v[100:103], a[60:63], a[32:35], v[100:103]
    s_add_u32 s64, s64, 1
    ds_read_b64_tr_b16 a[30:31], v15 offset:4096
    s_nop 1
    v_permlane16_swap_b32 v140, v144
    v_mfma_f32_16x16x32_bf16 v[108:111], a[60:63], a[36:39], v[108:111]
    buffer_load_dwordx4 v2, s[36:39], s56 offen offset:3072 sc1 lds
    v_permlane16_swap_b32 v141, v145
    v_mfma_f32_16x16x32_bf16 v[116:119], a[60:63], a[40:43], v[116:119]
    s_add_u32 s56, s56, 262144
    v_permlane16_swap_b32 v142, v146
    v_permlane16_swap_b32 v143, v147
    v_mfma_f32_16x16x32_bf16 v[124:127], a[60:63], a[44:47], v[124:127]
    s_nop 1
    v_max_f32 v140, v140, v144
    s_cmp_gt_i32 s68, 6
    s_cbranch_scc0 m_lp154
m_lr155:
    s_waitcnt lgkmcnt(9)
    v_mfma_f32_16x16x32_bf16 v[64:67], a[16:19], a[0:3], v[64:67]
    s_add_u32 m0, s59, 16384
    ds_read_b128 a[32:35], v6 offset:8192
    v_max_f32 v141, v141, v145
    v_max_f32 v142, v142, v146
    s_waitcnt lgkmcnt(9)
    v_mfma_f32_16x16x32_bf16 v[72:75], a[16:19], a[4:7], v[72:75]
    ds_read_b64_tr_b16 a[48:49], v12 offset:8192
    buffer_load_dwordx4 v16, s[24:27], s57 offen offset:0 sc1 lds
    v_max_f32 v143, v143, v147
    s_waitcnt lgkmcnt(9)
    v_mfma_f32_16x16x32_bf16 v[80:83], a[16:19], a[8:11], v[80:83]
    s_add_u32 s59, s58, s60
    ds_read_b64_tr_b16 a[50:51], v12 offset:12288
    v_sub_f32 v148, v148, v140
    v_sub_f32 v149, v149, v140
    s_waitcnt lgkmcnt(9)
    v_mfma_f32_16x16x32_bf16 v[88:91], a[16:19], a[12:15], v[88:91]
    s_add_u32 s58, s58, 32768
    ds_read_b128 a[36:39], v6 offset:9216
    v_sub_f32 v150, v150, v140
    v_sub_f32 v151, v151, v140
    s_waitcnt lgkmcnt(8)
    v_mfma_f32_16x16x32_bf16 v[68:71], a[20:23], a[0:3], v[68:71]
    s_cmp_ge_u32 s58, 163840
    ds_read_b128 a[40:43], v6 offset:10240
    v_sub_f32 v152, v152, v140
    v_sub_f32 v153, v153, v140
    v_mfma_f32_16x16x32_bf16 v[76:79], a[20:23], a[4:7], v[76:79]
    ds_read_b128 a[44:47], v6 offset:11264
    buffer_load_dwordx4 v17, s[24:27], s57 offen offset:1024 sc1 lds
    v_sub_f32 v154, v154, v140
    v_mfma_f32_16x16x32_bf16 v[84:87], a[20:23], a[8:11], v[84:87]
    s_cselect_b32 s66, 4294836224, s100
    ds_read_b64_tr_b16 a[52:53], v13 offset:8192
    v_sub_f32 v155, v155, v140
    v_sub_f32 v156, v156, v141
    v_mfma_f32_16x16x32_bf16 v[92:95], a[20:23], a[12:15], v[92:95]
    s_cselect_b32 s58, 0, s58
    ds_read_b64_tr_b16 a[54:55], v13 offset:12288
    v_sub_f32 v157, v157, v141
    v_sub_f32 v158, v158, v141
    s_waitcnt lgkmcnt(10)
    v_mfma_f32_16x16x32_bf16 v[96:99], a[24:27], a[0:3], v[96:99]
    ds_read_b64_tr_b16 a[56:57], v14 offset:8192
    v_sub_f32 v159, v159, v141
    v_sub_f32 v160, v160, v141
    v_mfma_f32_16x16x32_bf16 v[104:107], a[24:27], a[4:7], v[104:107]
    ds_read_b64_tr_b16 a[58:59], v14 offset:12288
    buffer_load_dwordx4 v18, s[24:27], s57 offen offset:2048 sc1 lds
    v_sub_f32 v161, v161, v141
    v_mfma_f32_16x16x32_bf16 v[112:115], a[24:27], a[8:11], v[112:115]
    ds_read_b64_tr_b16 a[60:61], v15 offset:8192
    v_sub_f32 v162, v162, v141
    v_sub_f32 v163, v163, v141
    v_mfma_f32_16x16x32_bf16 v[120:123], a[24:27], a[12:15], v[120:123]
    ds_read_b64_tr_b16 a[62:63], v15 offset:12288
    v_sub_f32 v164, v164, v142
    v_sub_f32 v165, v165, v142
    s_waitcnt lgkmcnt(12)
    v_mfma_f32_16x16x32_bf16 v[100:103], a[28:31], a[0:3], v[100:103]
    v_add_u32 v6, s66, v6
    v_add_u32 v12, s66, v12
    v_sub_f32 v166, v166, v142
    v_mfma_f32_16x16x32_bf16 v[108:111], a[28:31], a[4:7], v[108:111]
    buffer_load_dwordx4 v19, s[24:27], s57 offen offset:3072 sc1 lds
    v_sub_f32 v167, v167, v142
    v_mfma_f32_16x16x32_bf16 v[116:119], a[28:31], a[8:11], v[116:119]
    s_add_u32 s57, s57, 131072
    v_add_u32 v13, s66, v13
    v_add_u32 v14, s66, v14
    v_sub_f32 v168, v168, v142
    v_mfma_f32_16x16x32_bf16 v[124:127], a[28:31], a[12:15], v[124:127]
    s_mov_b32 m0, s59
    v_add_u32 v15, s66, v15
    v_sub_f32 v169, v169, v142
    s_waitcnt vmcnt(20) lgkmcnt(0)
    v_mfma_f32_16x16x32_bf16 v[64:67], a[48:51], a[32:35], v[64:67]
    s_barrier
    v_sub_f32 v170, v170, v142
    v_sub_f32 v171, v171, v142
    v_mfma_f32_16x16x32_bf16 v[72:75], a[48:51], a[36:39], v[72:75]
    ds_read_b128 a[0:3], v6 offset:0
    buffer_load_dwordx4 v2, s[36:39], s56 offen offset:0 sc1 lds
    v_sub_f32 v172, v172, v143
    v_mfma_f32_16x16x32_bf16 v[80:83], a[48:51], a[40:43], v[80:83]
    ds_read_b64_tr_b16 a[16:17], v12 offset:0
    v_sub_f32 v173, v173, v143
    v_sub_f32 v174, v174, v143
    v_mfma_f32_16x16x32_bf16 v[88:91], a[48:51], a[44:47], v[88:91]
    ds_read_b64_tr_b16 a[18:19], v12 offset:4096
    v_sub_f32 v175, v175, v143
    v_sub_f32 v176, v176, v143
    v_mfma_f32_16x16x32_bf16 v[68:71], a[52:55], a[32:35], v[68:71]
    ds_read_b128 a[4:7], v6 offset:1024
    v_sub_f32 v177, v177, v143
    v_sub_f32 v178, v178, v143
    v_mfma_f32_16x16x32_bf16 v[76:79], a[52:55], a[36:39], v[76:79]
    ds_read_b128 a[8:11], v6 offset:2048
    buffer_load_dwordx4 v2, s[36:39], s56 offen offset:1024 sc1 lds
    v_sub_f32 v179, v179, v143
    v_mfma_f32_16x16x32_bf16 v[84:87], a[52:55], a[40:43], v[84:87]
    ds_read_b128 a[12:15], v6 offset:3072
    v_exp_f32 v148, v148
    v_exp_f32 v149, v149
    v_mfma_f32_16x16x32_bf16 v[92:95], a[52:55], a[44:47], v[92:95]
    ds_read_b64_tr_b16 a[20:21], v13 offset:0
    v_exp_f32 v150, v150
    v_exp_f32 v151, v151
    v_mfma_f32_16x16x32_bf16 v[96:99], a[56:59], a[32:35], v[96:99]
    ds_read_b64_tr_b16 a[22:23], v13 offset:4096
    v_exp_f32 v152, v152
    v_exp_f32 v153, v153
    v_mfma_f32_16x16x32_bf16 v[104:107], a[56:59], a[36:39], v[104:107]
    ds_read_b64_tr_b16 a[24:25], v14 offset:0
    buffer_load_dwordx4 v2, s[36:39], s56 offen offset:2048 sc1 lds
    v_exp_f32 v154, v154
    v_mfma_f32_16x16x32_bf16 v[112:115], a[56:59], a[40:43], v[112:115]
    ds_read_b64_tr_b16 a[26:27], v14 offset:4096
    v_exp_f32 v155, v155
    v_exp_f32 v156, v156
    v_mfma_f32_16x16x32_bf16 v[120:123], a[56:59], a[44:47], v[120:123]
    ds_read_b64_tr_b16 a[28:29], v15 offset:0
    v_exp_f32 v157, v157
    v_exp_f32 v158, v158
    v_mfma_f32_16x16x32_bf16 v[100:103], a[60:63], a[32:35], v[100:103]
    s_add_u32 s64, s64, 1
    ds_read_b64_tr_b16 a[30:31], v15 offset:4096
    v_exp_f32 v159, v159
    v_exp_f32 v160, v160
    v_mfma_f32_16x16x32_bf16 v[108:111], a[60:63], a[36:39], v[108:111]
    buffer_load_dwordx4 v2, s[36:39], s56 offen offset:3072 sc1 lds
    v_exp_f32 v161, v161
    v_mfma_f32_16x16x32_bf16 v[116:119], a[60:63], a[40:43], v[116:119]
    s_add_u32 s56, s56, 262144
    v_exp_f32 v162, v162
    v_exp_f32 v163, v163
    v_mfma_f32_16x16x32_bf16 v[124:127], a[60:63], a[44:47], v[124:127]
    v_exp_f32 v164, v164
    v_exp_f32 v165, v165
    s_cmp_gt_i32 s68, 7
    s_cbranch_scc0 m_lp156
m_lr157:
    s_waitcnt lgkmcnt(9)
    v_mfma_f32_16x16x32_bf16 v[64:67], a[16:19], a[0:3], v[64:67]
    s_add_u32 m0, s59, 16384
    ds_read_b128 a[32:35], v6 offset:8192
    v_exp_f32 v166, v166
    v_exp_f32 v167, v167
    s_waitcnt lgkmcnt(9)
    v_mfma_f32_16x16x32_bf16 v[72:75], a[16:19], a[4:7], v[72:75]
    ds_read_b64_tr_b16 a[48:49], v12 offset:8192
    buffer_load_dwordx4 v16, s[24:27], s57 offen offset:0 sc1 lds
    v_exp_f32 v168, v168
    s_waitcnt lgkmcnt(9)
    v_mfma_f32_16x16x32_bf16 v[80:83], a[16:19], a[8:11], v[80:83]
    s_add_u32 s59, s58, s60
    ds_read_b64_tr_b16 a[50:51], v12 offset:12288
    v_exp_f32 v169, v169
    v_exp_f32 v170, v170
    s_waitcnt lgkmcnt(9)
    v_mfma_f32_16x16x32_bf16 v[88:91], a[16:19], a[12:15], v[88:91]
    s_add_u32 s58, s58, 32768
    ds_read_b128 a[36:39], v6 offset:9216
    v_exp_f32 v171, v171
    v_exp_f32 v172, v172
    s_waitcnt lgkmcnt(8)
    v_mfma_f32_16x16x32_bf16 v[68:71], a[20:23], a[0:3], v[68:71]
    s_cmp_ge_u32 s58, 163840
    ds_read_b128 a[40:43], v6 offset:10240
    v_exp_f32 v173, v173
    v_exp_f32 v174, v174
    v_mfma_f32_16x16x32_bf16 v[76:79], a[20:23], a[4:7], v[76:79]
    ds_read_b128 a[44:47], v6 offset:11264
    buffer_load_dwordx4 v17, s[24:27], s57 offen offset:1024 sc1 lds
    v_exp_f32 v175, v175
    v_mfma_f32_16x16x32_bf16 v[84:87], a[20:23], a[8:11], v[84:87]
    s_cselect_b32 s66, 4294836224, s100
    ds_read_b64_tr_b16 a[52:53], v13 offset:8192
    v_exp_f32 v176, v176
    v_exp_f32 v177, v177
    v_mfma_f32_16x16x32_bf16 v[92:95], a[20:23], a[12:15], v[92:95]
    s_cselect_b32 s58, 0, s58
    ds_read_b64_tr_b16 a[54:55], v13 offset:12288
    v_exp_f32 v178, v178
    v_exp_f32 v179, v179
    s_waitcnt lgkmcnt(10)
    v_mfma_f32_16x16x32_bf16 v[96:99], a[24:27], a[0:3], v[96:99]
    ds_read_b64_tr_b16 a[56:57], v14 offset:8192
    v_cvt_pk_bf16_f32 v192, v148, v149
    v_cvt_pk_bf16_f32 v193, v150, v151
    v_mfma_f32_16x16x32_bf16 v[104:107], a[24:27], a[4:7], v[104:107]
    ds_read_b64_tr_b16 a[58:59], v14 offset:12288
    buffer_load_dwordx4 v18, s[24:27], s57 offen offset:2048 sc1 lds
    v_cvt_pk_bf16_f32 v194, v152, v153
    v_mfma_f32_16x16x32_bf16 v[112:115], a[24:27], a[8:11], v[112:115]
    ds_read_b64_tr_b16 a[60:61], v15 offset:8192
    v_cvt_pk_bf16_f32 v195, v154, v155
    v_cvt_pk_bf16_f32 v196, v156, v157
    v_mfma_f32_16x16x32_bf16 v[120:123], a[24:27], a[12:15], v[120:123]
    ds_read_b64_tr_b16 a[62:63], v15 offset:12288
    v_cvt_pk_bf16_f32 v197, v158, v159
    v_cvt_pk_bf16_f32 v198, v160, v161
    s_waitcnt lgkmcnt(12)
    v_mfma_f32_16x16x32_bf16 v[100:103], a[28:31], a[0:3], v[100:103]
    v_add_u32 v6, s66, v6
    v_add_u32 v12, s66, v12
    v_cvt_pk_bf16_f32 v199, v162, v163
    v_mfma_f32_16x16x32_bf16 v[108:111], a[28:31], a[4:7], v[108:111]
    buffer_load_dwordx4 v19, s[24:27], s57 offen offset:3072 sc1 lds
    v_cvt_pk_bf16_f32 v200, v164, v165
    v_mfma_f32_16x16x32_bf16 v[116:119], a[28:31], a[8:11], v[116:119]
    s_add_u32 s57, s57, 131072
    v_add_u32 v13, s66, v13
    v_add_u32 v14, s66, v14
    v_cvt_pk_bf16_f32 v201, v166, v167
    v_mfma_f32_16x16x32_bf16 v[124:127], a[28:31], a[12:15], v[124:127]
    s_mov_b32 m0, s59
    v_add_u32 v15, s66, v15
    v_cvt_pk_bf16_f32 v202, v168, v169
    s_waitcnt vmcnt(24) lgkmcnt(0)
    v_mfma_f32_16x16x32_bf16 v[64:67], a[48:51], a[32:35], v[64:67]
    s_barrier
    v_cvt_pk_bf16_f32 v203, v170, v171
    v_cvt_pk_bf16_f32 v204, v172, v173
    v_mfma_f32_16x16x32_bf16 v[72:75], a[48:51], a[36:39], v[72:75]
    ds_read_b128 a[0:3], v6 offset:0
    buffer_load_dwordx4 v2, s[36:39], s56 offen offset:0 sc1 lds
    v_cvt_pk_bf16_f32 v205, v174, v175
    v_mfma_f32_16x16x32_bf16 v[80:83], a[48:51], a[40:43], v[80:83]
    ds_read_b64_tr_b16 a[16:17], v12 offset:0
    v_cvt_pk_bf16_f32 v206, v176, v177
    v_cvt_pk_bf16_f32 v207, v178, v179
    v_mfma_f32_16x16x32_bf16 v[88:91], a[48:51], a[44:47], v[88:91]
    ds_read_b64_tr_b16 a[18:19], v12 offset:4096
    s_nop 1
    v_mfma_f32_16x16x32_bf16 v[20:23], v[44:47], v[192:195], 0
    v_mfma_f32_16x16x32_bf16 v[68:71], a[52:55], a[32:35], v[68:71]
    ds_read_b128 a[4:7], v6 offset:1024
    v_mfma_f32_16x16x32_bf16 v[24:27], v[44:47], v[196:199], 0
    v_mfma_f32_16x16x32_bf16 v[28:31], v[44:47], v[200:203], 0
    v_mfma_f32_16x16x32_bf16 v[76:79], a[52:55], a[36:39], v[76:79]
    ds_read_b128 a[8:11], v6 offset:2048
    buffer_load_dwordx4 v2, s[36:39], s56 offen offset:1024 sc1 lds
    v_mfma_f32_16x16x32_bf16 v[32:35], v[44:47], v[204:207], 0
    v_mfma_f32_16x16x32_bf16 v[84:87], a[52:55], a[40:43], v[84:87]
    ds_read_b128 a[12:15], v6 offset:3072
    v_mfma_f32_16x16x32_bf16 v[148:151], v[230:233], v[192:195], 0
    v_mfma_f32_16x16x32_bf16 v[152:155], v[242:245], v[192:195], 0
    v_mfma_f32_16x16x32_bf16 v[92:95], a[52:55], a[44:47], v[92:95]
    ds_read_b64_tr_b16 a[20:21], v13 offset:0
    v_mfma_f32_16x16x32_bf16 v[156:159], v[232:235], v[196:199], 0
    v_mfma_f32_16x16x32_bf16 v[160:163], v[244:247], v[196:199], 0
    v_mfma_f32_16x16x32_bf16 v[96:99], a[56:59], a[32:35], v[96:99]
    ds_read_b64_tr_b16 a[22:23], v13 offset:4096
    v_mfma_f32_16x16x32_bf16 v[164:167], v[234:237], v[200:203], 0
    v_mfma_f32_16x16x32_bf16 v[168:171], v[246:249], v[200:203], 0
    v_mfma_f32_16x16x32_bf16 v[104:107], a[56:59], a[36:39], v[104:107]
    ds_read_b64_tr_b16 a[24:25], v14 offset:0
    buffer_load_dwordx4 v2, s[36:39], s56 offen offset:2048 sc1 lds
    v_mfma_f32_16x16x32_bf16 v[172:175], v[236:239], v[204:207], 0
    v_mfma_f32_16x16x32_bf16 v[112:115], a[56:59], a[40:43], v[112:115]
    ds_read_b64_tr_b16 a[26:27], v14 offset:4096
    v_mfma_f32_16x16x32_bf16 v[176:179], v[248:251], v[204:207], 0
    v_rcp_f32 v140, v20
    v_mfma_f32_16x16x32_bf16 v[120:123], a[56:59], a[44:47], v[120:123]
    ds_read_b64_tr_b16 a[28:29], v15 offset:0
    v_rcp_f32 v141, v24
    v_rcp_f32 v142, v28
    v_mfma_f32_16x16x32_bf16 v[100:103], a[60:63], a[32:35], v[100:103]
    s_add_u32 s64, s64, 1
    ds_read_b64_tr_b16 a[30:31], v15 offset:4096
    v_rcp_f32 v143, v32
    s_nop 1
    v_mfma_f32_16x16x32_bf16 v[108:111], a[60:63], a[36:39], v[108:111]
    buffer_load_dwordx4 v2, s[36:39], s56 offen offset:3072 sc1 lds
    s_nop 1
    v_mfma_f32_16x16x32_bf16 v[116:119], a[60:63], a[40:43], v[116:119]
    s_add_u32 s56, s56, 262144
    v_mul_f32 v148, v148, v140
    v_mul_f32 v149, v149, v140
    v_mfma_f32_16x16x32_bf16 v[124:127], a[60:63], a[44:47], v[124:127]
    v_mul_f32 v150, v150, v140
    v_mul_f32 v151, v151, v140
    s_cmp_gt_i32 s68, 8
    s_cbranch_scc0 m_lp158
m_lr159:
    s_waitcnt lgkmcnt(9)
    v_mfma_f32_16x16x32_bf16 v[64:67], a[16:19], a[0:3], v[64:67]
    s_add_u32 m0, s59, 16384
    ds_read_b128 a[32:35], v6 offset:8192
    v_mul_f32 v152, v152, v140
    v_mul_f32 v153, v153, v140
    s_waitcnt lgkmcnt(9)
    v_mfma_f32_16x16x32_bf16 v[72:75], a[16:19], a[4:7], v[72:75]
    ds_read_b64_tr_b16 a[48:49], v12 offset:8192
    buffer_load_dwordx4 v16, s[24:27], s57 offen offset:0 sc1 lds
    v_mul_f32 v154, v154, v140
    s_waitcnt lgkmcnt(9)
    v_mfma_f32_16x16x32_bf16 v[80:83], a[16:19], a[8:11], v[80:83]
    s_add_u32 s59, s58, s60
    ds_read_b64_tr_b16 a[50:51], v12 offset:12288
    v_mul_f32 v155, v155, v140
    v_cvt_pk_bf16_f32 v148, v148, v149
    s_waitcnt lgkmcnt(9)
    v_mfma_f32_16x16x32_bf16 v[88:91], a[16:19], a[12:15], v[88:91]
    s_add_u32 s58, s58, 32768
    ds_read_b128 a[36:39], v6 offset:9216
    v_cvt_pk_bf16_f32 v149, v150, v151
    v_cvt_pk_bf16_f32 v150, v152, v153
    s_waitcnt lgkmcnt(8)
    v_mfma_f32_16x16x32_bf16 v[68:71], a[20:23], a[0:3], v[68:71]
    s_cmp_ge_u32 s58, 163840
    ds_read_b128 a[40:43], v6 offset:10240
    v_cvt_pk_bf16_f32 v151, v154, v155
    buffer_store_dwordx4 v[148:151], v2, s[8:11], s80 offen offset:0 sc1
    v_mfma_f32_16x16x32_bf16 v[76:79], a[20:23], a[4:7], v[76:79]
    ds_read_b128 a[44:47], v6 offset:11264
    buffer_load_dwordx4 v17, s[24:27], s57 offen offset:1024 sc1 lds
    v_mul_f32 v156, v156, v141
    v_mfma_f32_16x16x32_bf16 v[84:87], a[20:23], a[8:11], v[84:87]
    s_cselect_b32 s66, 4294836224, s100
    ds_read_b64_tr_b16 a[52:53], v13 offset:8192
    v_mul_f32 v157, v157, v141
    v_mul_f32 v158, v158, v141
    v_mfma_f32_16x16x32_bf16 v[92:95], a[20:23], a[12:15], v[92:95]
    s_cselect_b32 s58, 0, s58
    ds_read_b64_tr_b16 a[54:55], v13 offset:12288
    v_mul_f32 v159, v159, v141
    v_mul_f32 v160, v160, v141
    s_waitcnt lgkmcnt(10)
    v_mfma_f32_16x16x32_bf16 v[96:99], a[24:27], a[0:3], v[96:99]
    ds_read_b64_tr_b16 a[56:57], v14 offset:8192
    v_mul_f32 v161, v161, v141
    v_mul_f32 v162, v162, v141
    v_mfma_f32_16x16x32_bf16 v[104:107], a[24:27], a[4:7], v[104:107]
    ds_read_b64_tr_b16 a[58:59], v14 offset:12288
    buffer_load_dwordx4 v18, s[24:27], s57 offen offset:2048 sc1 lds
    v_mul_f32 v163, v163, v141
    v_mfma_f32_16x16x32_bf16 v[112:115], a[24:27], a[8:11], v[112:115]
    ds_read_b64_tr_b16 a[60:61], v15 offset:8192
    v_cvt_pk_bf16_f32 v156, v156, v157
    v_cvt_pk_bf16_f32 v157, v158, v159
    v_mfma_f32_16x16x32_bf16 v[120:123], a[24:27], a[12:15], v[120:123]
    ds_read_b64_tr_b16 a[62:63], v15 offset:12288
    v_cvt_pk_bf16_f32 v158, v160, v161
    v_cvt_pk_bf16_f32 v159, v162, v163
    s_waitcnt lgkmcnt(12)
    v_mfma_f32_16x16x32_bf16 v[100:103], a[28:31], a[0:3], v[100:103]
    v_add_u32 v6, s66, v6
    v_add_u32 v12, s66, v12
    buffer_store_dwordx4 v[156:159], v2, s[8:11], s80 offen offset:1024 sc1
    v_mfma_f32_16x16x32_bf16 v[108:111], a[28:31], a[4:7], v[108:111]
    buffer_load_dwordx4 v19, s[24:27], s57 offen offset:3072 sc1 lds
    v_mul_f32 v164, v164, v142
    v_mfma_f32_16x16x32_bf16 v[116:119], a[28:31], a[8:11], v[116:119]
    s_add_u32 s57, s57, 131072
    v_add_u32 v13, s66, v13
    v_add_u32 v14, s66, v14
    v_mul_f32 v165, v165, v142
    v_mfma_f32_16x16x32_bf16 v[124:127], a[28:31], a[12:15], v[124:127]
    s_mov_b32 m0, s59
    v_add_u32 v15, s66, v15
    v_mul_f32 v166, v166, v142
    s_waitcnt vmcnt(24) lgkmcnt(0)
    v_mfma_f32_16x16x32_bf16 v[64:67], a[48:51], a[32:35], v[64:67]
    s_barrier
    v_mul_f32 v167, v167, v142
    v_mul_f32 v168, v168, v142
    v_mfma_f32_16x16x32_bf16 v[72:75], a[48:51], a[36:39], v[72:75]
    ds_read_b128 a[0:3], v6 offset:0
    buffer_load_dwordx4 v2, s[36:39], s56 offen offset:0 sc1 lds
    v_mul_f32 v169, v169, v142
    v_mfma_f32_16x16x32_bf16 v[80:83], a[48:51], a[40:43], v[80:83]
    ds_read_b64_tr_b16 a[16:17], v12 offset:0
    v_mul_f32 v170, v170, v142
    v_mul_f32 v171, v171, v142
    v_mfma_f32_16x16x32_bf16 v[88:91], a[48:51], a[44:47], v[88:91]
    ds_read_b64_tr_b16 a[18:19], v12 offset:4096
    v_cvt_pk_bf16_f32 v164, v164, v165
    v_cvt_pk_bf16_f32 v165, v166, v167
    v_mfma_f32_16x16x32_bf16 v[68:71], a[52:55], a[32:35], v[68:71]
    ds_read_b128 a[4:7], v6 offset:1024
    v_cvt_pk_bf16_f32 v166, v168, v169
    v_cvt_pk_bf16_f32 v167, v170, v171
    v_mfma_f32_16x16x32_bf16 v[76:79], a[52:55], a[36:39], v[76:79]
    ds_read_b128 a[8:11], v6 offset:2048
    buffer_load_dwordx4 v2, s[36:39], s56 offen offset:1024 sc1 lds
    buffer_store_dwordx4 v[164:167], v2, s[8:11], s80 offen offset:2048 sc1
    v_mfma_f32_16x16x32_bf16 v[84:87], a[52:55], a[40:43], v[84:87]
    ds_read_b128 a[12:15], v6 offset:3072
    v_mul_f32 v172, v172, v143
    v_mul_f32 v173, v173, v143
    v_mfma_f32_16x16x32_bf16 v[92:95], a[52:55], a[44:47], v[92:95]
    ds_read_b64_tr_b16 a[20:21], v13 offset:0
    v_mul_f32 v174, v174, v143
    v_mul_f32 v175, v175, v143
    v_mfma_f32_16x16x32_bf16 v[96:99], a[56:59], a[32:35], v[96:99]
    ds_read_b64_tr_b16 a[22:23], v13 offset:4096
    v_mul_f32 v176, v176, v143
    v_mul_f32 v177, v177, v143
    v_mfma_f32_16x16x32_bf16 v[104:107], a[56:59], a[36:39], v[104:107]
    ds_read_b64_tr_b16 a[24:25], v14 offset:0
    buffer_load_dwordx4 v2, s[36:39], s56 offen offset:2048 sc1 lds
    v_mul_f32 v178, v178, v143
    v_mfma_f32_16x16x32_bf16 v[112:115], a[56:59], a[40:43], v[112:115]
    ds_read_b64_tr_b16 a[26:27], v14 offset:4096
    v_mul_f32 v179, v179, v143
    v_cvt_pk_bf16_f32 v172, v172, v173
    v_mfma_f32_16x16x32_bf16 v[120:123], a[56:59], a[44:47], v[120:123]
    ds_read_b64_tr_b16 a[28:29], v15 offset:0
    v_cvt_pk_bf16_f32 v173, v174, v175
    v_cvt_pk_bf16_f32 v174, v176, v177
    v_mfma_f32_16x16x32_bf16 v[100:103], a[60:63], a[32:35], v[100:103]
    s_add_u32 s64, s64, 1
    ds_read_b64_tr_b16 a[30:31], v15 offset:4096
    v_cvt_pk_bf16_f32 v175, v178, v179
    buffer_store_dwordx4 v[172:175], v2, s[8:11], s80 offen offset:3072 sc1
    v_mfma_f32_16x16x32_bf16 v[108:111], a[60:63], a[36:39], v[108:111]
    buffer_load_dwordx4 v2, s[36:39], s56 offen offset:3072 sc1 lds
    v_mfma_f32_16x16x32_bf16 v[116:119], a[60:63], a[40:43], v[116:119]
    s_add_u32 s56, s56, 262144
    v_mfma_f32_16x16x32_bf16 v[124:127], a[60:63], a[44:47], v[124:127]
    s_branch m_l3e148
m_lp152:
    s_mov_b32 s3, 1048576
m_spin160:
    buffer_load_dwordx2 v[4:5], v10, s[8:11], s52 offen sc1
    s_waitcnt vmcnt(0)
    v_cmp_ne_u64 s[76:77], s[4:5], v[4:5]
    s_mul_i32 s91, s95, 20
    s_nop 2
    s_lshr_b32 s90, s76, s91
    s_ff1_i32_b32 s90, s90
    s_lshl_b32 s68, s90, 1
    s_mul_i32 s91, s95, 0
    s_sub_i32 s68, s68, s91
    s_cmp_lt_i32 s90, 0
    s_cselect_b32 s68, 1000, s68
    s_cmp_gt_i32 s68, 5
    s_cbranch_scc1 m_ok161
    s_sub_u32 s3, s3, 1
    s_cbranch_scc1 m_ok161
    s_sleep 4
    s_branch m_spin160
m_ok161:
    s_branch m_lr153
m_lp154:
    s_mov_b32 s3, 1048576
m_spin162:
    buffer_load_dwordx2 v[4:5], v10, s[8:11], s52 offen sc1
    s_waitcnt vmcnt(0)
    v_cmp_ne_u64 s[76:77], s[4:5], v[4:5]
    s_mul_i32 s91, s95, 20
    s_nop 2
    s_lshr_b32 s90, s76, s91
    s_ff1_i32_b32 s90, s90
    s_lshl_b32 s68, s90, 1
    s_mul_i32 s91, s95, 0
    s_sub_i32 s68, s68, s91
    s_cmp_lt_i32 s90, 0
    s_cselect_b32 s68, 1000, s68
    s_cmp_gt_i32 s68, 6
    s_cbranch_scc1 m_ok163
    s_sub_u32 s3, s3, 1
    s_cbranch_scc1 m_ok163
    s_sleep 4
    s_branch m_spin162
m_ok163:
    s_branch m_lr155
m_lp156:
    s_mov_b32 s3, 1048576
m_spin164:
    buffer_load_dwordx2 v[4:5], v10, s[8:11], s52 offen sc1
    s_waitcnt vmcnt(0)
    v_cmp_ne_u64 s[76:77], s[4:5], v[4:5]
    s_mul_i32 s91, s95, 20
    s_nop 2
    s_lshr_b32 s90, s76, s91
    s_ff1_i32_b32 s90, s90
    s_lshl_b32 s68, s90, 1
    s_mul_i32 s91, s95, 0
    s_sub_i32 s68, s68, s91
    s_cmp_lt_i32 s90, 0
    s_cselect_b32 s68, 1000, s68
    s_cmp_gt_i32 s68, 7
    s_cbranch_scc1 m_ok165
    s_sub_u32 s3, s3, 1
    s_cbranch_scc1 m_ok165
    s_sleep 4
    s_branch m_spin164
m_ok165:
    s_branch m_lr157
m_lp158:
    s_mov_b32 s3, 1048576
m_spin166:
    buffer_load_dwordx2 v[4:5], v10, s[8:11], s52 offen sc1
    s_waitcnt vmcnt(0)
    v_cmp_ne_u64 s[76:77], s[4:5], v[4:5]
    s_mul_i32 s91, s95, 20
    s_nop 2
    s_lshr_b32 s90, s76, s91
    s_ff1_i32_b32 s90, s90
    s_lshl_b32 s68, s90, 1
    s_mul_i32 s91, s95, 0
    s_sub_i32 s68, s68, s91
    s_cmp_lt_i32 s90, 0
    s_cselect_b32 s68, 1000, s68
    s_cmp_gt_i32 s68, 8
    s_cbranch_scc1 m_ok167
    s_sub_u32 s3, s3, 1
    s_cbranch_scc1 m_ok167
    s_sleep 4
    s_branch m_spin166
m_ok167:
    s_branch m_lr159
.p2align 3
m_l3147:
    s_waitcnt lgkmcnt(9)
    v_mfma_f32_16x16x32_bf16 v[64:67], a[16:19], a[0:3], v[64:67]
    s_add_u32 m0, s59, 16384
    ds_read_b128 a[32:35], v6 offset:8192
    s_waitcnt lgkmcnt(9)
    v_mfma_f32_16x16x32_bf16 v[72:75], a[16:19], a[4:7], v[72:75]
    ds_read_b64_tr_b16 a[48:49], v12 offset:8192
    buffer_load_dwordx4 v16, s[24:27], s57 offen offset:0 sc1 lds
    s_waitcnt lgkmcnt(9)
    v_mfma_f32_16x16x32_bf16 v[80:83], a[16:19], a[8:11], v[80:83]
    s_add_u32 s59, s58, s60
    ds_read_b64_tr_b16 a[50:51], v12 offset:12288
    s_waitcnt lgkmcnt(9)
    v_mfma_f32_16x16x32_bf16 v[88:91], a[16:19], a[12:15], v[88:91]
    s_add_u32 s58, s58, 32768
    ds_read_b128 a[36:39], v6 offset:9216
    s_waitcnt lgkmcnt(8)
    v_mfma_f32_16x16x32_bf16 v[68:71], a[20:23], a[0:3], v[68:71]
    s_cmp_ge_u32 s58, 163840
    ds_read_b128 a[40:43], v6 offset:10240
    v_mfma_f32_16x16x32_bf16 v[76:79], a[20:23], a[4:7], v[76:79]
    ds_read_b128 a[44:47], v6 offset:11264
    buffer_load_dwordx4 v17, s[24:27], s57 offen offset:1024 sc1 lds
    v_mfma_f32_16x16x32_bf16 v[84:87], a[20:23], a[8:11], v[84:87]
    s_cselect_b32 s66, 4294836224, s100
    ds_read_b64_tr_b16 a[52:53], v13 offset:8192
    v_mfma_f32_16x16x32_bf16 v[92:95], a[20:23], a[12:15], v[92:95]
    s_cselect_b32 s58, 0, s58
    ds_read_b64_tr_b16 a[54:55], v13 offset:12288
    s_waitcnt lgkmcnt(10)
    v_mfma_f32_16x16x32_bf16 v[96:99], a[24:27], a[0:3], v[96:99]
    ds_read_b64_tr_b16 a[56:57], v14 offset:8192
    v_mfma_f32_16x16x32_bf16 v[104:107], a[24:27], a[4:7], v[104:107]
    ds_read_b64_tr_b16 a[58:59], v14 offset:12288
    buffer_load_dwordx4 v18, s[24:27], s57 offen offset:2048 sc1 lds
    v_mfma_f32_16x16x32_bf16 v[112:115], a[24:27], a[8:11], v[112:115]
    ds_read_b64_tr_b16 a[60:61], v15 offset:8192
    v_mfma_f32_16x16x32_bf16 v[120:123], a[24:27], a[12:15], v[120:123]
    ds_read_b64_tr_b16 a[62:63], v15 offset:12288
    s_waitcnt lgkmcnt(12)
    v_mfma_f32_16x16x32_bf16 v[100:103], a[28:31], a[0:3], v[100:103]
    v_add_u32 v6, s66, v6
    v_add_u32 v12, s66, v12
    v_mfma_f32_16x16x32_bf16 v[108:111], a[28:31], a[4:7], v[108:111]
    buffer_load_dwordx4 v19, s[24:27], s57 offen offset:3072 sc1 lds
    v_mfma_f32_16x16x32_bf16 v[116:119], a[28:31], a[8:11], v[116:119]
    s_add_u32 s57, s57, 131072
    v_add_u32 v13, s66, v13
    v_add_u32 v14, s66, v14
    v_mfma_f32_16x16x32_bf16 v[124:127], a[28:31], a[12:15], v[124:127]
    s_mov_b32 m0, s59
    v_add_u32 v15, s66, v15
    s_waitcnt vmcnt(24) lgkmcnt(0)
    v_mfma_f32_16x16x32_bf16 v[64:67], a[48:51], a[32:35], v[64:67]
    s_barrier
    v_mfma_f32_16x16x32_bf16 v[72:75], a[48:51], a[36:39], v[72:75]
    ds_read_b128 a[0:3], v6 offset:0
    buffer_load_dwordx4 v2, s[36:39], s56 offen offset:0 sc1 lds
    v_mfma_f32_16x16x32_bf16 v[80:83], a[48:51], a[40:43], v[80:83]
    ds_read_b64_tr_b16 a[16:17], v12 offset:0
    v_mfma_f32_16x16x32_bf16 v[88:91], a[48:51], a[44:47], v[88:91]
    ds_read_b64_tr_b16 a[18:19], v12 offset:4096
    v_mfma_f32_16x16x32_bf16 v[68:71], a[52:55], a[32:35], v[68:71]
    ds_read_b128 a[4:7], v6 offset:1024
    v_mfma_f32_16x16x32_bf16 v[76:79], a[52:55], a[36:39], v[76:79]
    ds_read_b128 a[8:11], v6 offset:2048
    buffer_load_dwordx4 v2, s[36:39], s56 offen offset:1024 sc1 lds
    v_mfma_f32_16x16x32_bf16 v[84:87], a[52:55], a[40:43], v[84:87]
    ds_read_b128 a[12:15], v6 offset:3072
    v_mfma_f32_16x16x32_bf16 v[92:95], a[52:55], a[44:47], v[92:95]
    ds_read_b64_tr_b16 a[20:21], v13 offset:0
    v_mfma_f32_16x16x32_bf16 v[96:99], a[56:59], a[32:35], v[96:99]
    ds_read_b64_tr_b16 a[22:23], v13 offset:4096
    v_mfma_f32_16x16x32_bf16 v[104:107], a[56:59], a[36:39], v[104:107]
    ds_read_b64_tr_b16 a[24:25], v14 offset:0
    buffer_load_dwordx4 v2, s[36:39], s56 offen offset:2048 sc1 lds
    v_mfma_f32_16x16x32_bf16 v[112:115], a[56:59], a[40:43], v[112:115]
    ds_read_b64_tr_b16 a[26:27], v14 offset:4096
    v_mfma_f32_16x16x32_bf16 v[120:123], a[56:59], a[44:47], v[120:123]
    ds_read_b64_tr_b16 a[28:29], v15 offset:0
    v_mfma_f32_16x16x32_bf16 v[100:103], a[60:63], a[32:35], v[100:103]
    s_add_u32 s64, s64, 1
    ds_read_b64_tr_b16 a[30:31], v15 offset:4096
    v_mfma_f32_16x16x32_bf16 v[108:111], a[60:63], a[36:39], v[108:111]
    buffer_load_dwordx4 v2, s[36:39], s56 offen offset:3072 sc1 lds
    v_mfma_f32_16x16x32_bf16 v[116:119], a[60:63], a[40:43], v[116:119]
    s_add_u32 s56, s56, 262144
    s_cmp_lt_u32 s64, s67
    v_mfma_f32_16x16x32_bf16 v[124:127], a[60:63], a[44:47], v[124:127]
    s_cbranch_scc1 m_l3147
m_l3e148:
    s_add_u32 s92, s64, 5
    s_cmp_gt_i32 s68, s92
    s_cbranch_scc1 m_rdy168
    s_mov_b32 s3, 1048576
m_spin169:
    buffer_load_dwordx2 v[4:5], v10, s[8:11], s52 offen sc1
    s_waitcnt vmcnt(0)
    v_cmp_ne_u64 s[76:77], s[4:5], v[4:5]
    s_mul_i32 s91, s95, 20
    s_nop 2
    s_lshr_b32 s90, s76, s91
    s_ff1_i32_b32 s90, s90
    s_lshl_b32 s68, s90, 1
    s_mul_i32 s91, s95, 0
    s_sub_i32 s68, s68, s91
    s_cmp_lt_i32 s90, 0
    s_cselect_b32 s68, 1000, s68
    s_cmp_gt_i32 s68, s92
    s_cbranch_scc1 m_ok170
    s_sub_u32 s3, s3, 1
    s_cbranch_scc1 m_ok170
    s_sleep 4
    s_branch m_spin169
m_ok170:
m_rdy168:
    s_mov_b32 s67, 8
    s_cmp_lt_u32 s64, 8
    s_cbranch_scc1 m_l3n151
    s_cmp_eq_u32 s64, 8
    s_cbranch_scc1 m_o1171
m_o2172:
    s_cmp_eq_u32 s95, 0
    s_cbranch_scc1 m_l3c150
    s_mov_b32 s67, 18
    s_cmp_lt_u32 s64, 18
    s_cbranch_scc1 m_l3n151
    s_cmp_lg_u32 s64, 18
    s_cbranch_scc1 m_n173
    s_mov_b32 s68, 1000
    s_lshr_b32 s90, s96, 1
    s_lshl_b32 s90, s90, 8
    s_add_u32 s90, s90, 117452800
    buffer_load_dwordx2 v[4:5], v10, s[8:11], s90 offen sc1
    s_mov_b32 s67, 19
    s_branch m_l3147
m_n173:
    s_cmp_lg_u32 s64, 19
    s_cbranch_scc1 m_n174
    s_waitcnt vmcnt(8)
    s_waitcnt vmcnt(16)
    s_mov_b32 s3, 1048576
m_spin175:
    v_cmp_ne_u64 s[76:77], s[4:5], v[4:5]
    s_nop 3
    s_cmp_eq_u64 s[76:77], 0
    s_cbranch_scc1 m_ok176
    s_sub_u32 s3, s3, 1
    s_cbranch_scc1 m_ok176
    s_sleep 8
    s_lshr_b32 s90, s96, 1
    s_lshl_b32 s90, s90, 8
    s_add_u32 s90, s90, 117452800
    buffer_load_dwordx2 v[4:5], v10, s[8:11], s90 offen sc1
    s_waitcnt vmcnt(0)
    s_branch m_spin175
m_ok176:
    s_mov_b32 s56, s69
    s_mov_b32 s67, 20
    s_branch m_l3147
m_n174:
    s_cmp_lg_u32 s64, 20
    s_cbranch_scc1 m_n177
    s_mov_b32 s24, s50
    s_mov_b32 s25, s51
    s_mov_b32 s26, 2097152
    s_lshl_b32 s57, s97, 8
    s_mov_b32 s67, 24
    s_branch m_l3147
m_n177:
    s_cmp_lg_u32 s64, 24
    s_cbranch_scc1 m_n178
    s_lshl_b32 s90, s96, 3
    s_add_u32 s90, s90, s97
    s_lshl_b32 s90, s90, 15
    s_lshl_b32 s91, s16, 13
    s_add_u32 s90, s90, s91
    s_add_u32 s70, s90, 100663296
    s_nop 3
    v_cvt_pk_bf16_f32 v128, v64, v65
    v_cvt_pk_bf16_f32 v129, v66, v67
    v_cvt_pk_bf16_f32 v130, v68, v69
    v_cvt_pk_bf16_f32 v131, v70, v71
    v_cvt_pk_bf16_f32 v132, v72, v73
    v_cvt_pk_bf16_f32 v133, v74, v75
    v_cvt_pk_bf16_f32 v134, v76, v77
    v_cvt_pk_bf16_f32 v135, v78, v79
    v_cvt_pk_bf16_f32 v136, v80, v81
    v_cvt_pk_bf16_f32 v137, v82, v83
    v_cvt_pk_bf16_f32 v138, v84, v85
    v_cvt_pk_bf16_f32 v139, v86, v87
    v_cvt_pk_bf16_f32 v140, v88, v89
    v_cvt_pk_bf16_f32 v141, v90, v91
    v_cvt_pk_bf16_f32 v142, v92, v93
    v_cvt_pk_bf16_f32 v143, v94, v95
    v_cvt_pk_bf16_f32 v144, v96, v97
    v_cvt_pk_bf16_f32 v145, v98, v99
    v_cvt_pk_bf16_f32 v146, v100, v101
    v_cvt_pk_bf16_f32 v147, v102, v103
    v_cvt_pk_bf16_f32 v148, v104, v105
    v_cvt_pk_bf16_f32 v149, v106, v107
    v_cvt_pk_bf16_f32 v150, v108, v109
    v_cvt_pk_bf16_f32 v151, v110, v111
    v_cvt_pk_bf16_f32 v152, v112, v113
    v_cvt_pk_bf16_f32 v153, v114, v115
    v_cvt_pk_bf16_f32 v154, v116, v117
    v_cvt_pk_bf16_f32 v155, v118, v119
    v_cvt_pk_bf16_f32 v156, v120, v121
    v_cvt_pk_bf16_f32 v157, v122, v123
    v_cvt_pk_bf16_f32 v158, v124, v125
    v_cvt_pk_bf16_f32 v159, v126, v127
    v_mov_b64 v[64:65], 0
    v_mov_b64 v[66:67], 0
    v_mov_b64 v[68:69], 0
    v_mov_b64 v[70:71], 0
    v_mov_b64 v[72:73], 0
    v_mov_b64 v[74:75], 0
    v_mov_b64 v[76:77], 0
    v_mov_b64 v[78:79], 0
    v_mov_b64 v[80:81], 0
    v_mov_b64 v[82:83], 0
    v_mov_b64 v[84:85], 0
    v_mov_b64 v[86:87], 0
    v_mov_b64 v[88:89], 0
    v_mov_b64 v[90:91], 0
    v_mov_b64 v[92:93], 0
    v_mov_b64 v[94:95], 0
    v_mov_b64 v[96:97], 0
    v_mov_b64 v[98:99], 0
    v_mov_b64 v[100:101], 0
    v_mov_b64 v[102:103], 0
    v_mov_b64 v[104:105], 0
    v_mov_b64 v[106:107], 0
    v_mov_b64 v[108:109], 0
    v_mov_b64 v[110:111], 0
    v_mov_b64 v[112:113], 0
    v_mov_b64 v[114:115], 0
    v_mov_b64 v[116:117], 0
    v_mov_b64 v[118:119], 0
    v_mov_b64 v[120:121], 0
    v_mov_b64 v[122:123], 0
    v_mov_b64 v[124:125], 0
    v_mov_b64 v[126:127], 0
    s_nop 1
    s_waitcnt lgkmcnt(9)
    v_mfma_f32_16x16x32_bf16 v[64:67], a[16:19], a[0:3], v[64:67]
    s_add_u32 m0, s59, 16384
    ds_read_b128 a[32:35], v6 offset:8192
    s_waitcnt lgkmcnt(9)
    v_mfma_f32_16x16x32_bf16 v[72:75], a[16:19], a[4:7], v[72:75]
    ds_read_b64_tr_b16 a[48:49], v12 offset:8192
    buffer_load_dwordx4 v16, s[24:27], s57 offen offset:0 sc1 lds
    s_waitcnt lgkmcnt(9)
    v_mfma_f32_16x16x32_bf16 v[80:83], a[16:19], a[8:11], v[80:83]
    s_add_u32 s59, s58, s60
    ds_read_b64_tr_b16 a[50:51], v12 offset:12288
    s_waitcnt lgkmcnt(9)
    v_mfma_f32_16x16x32_bf16 v[88:91], a[16:19], a[12:15], v[88:91]
    s_add_u32 s58, s58, 32768
    ds_read_b128 a[36:39], v6 offset:9216
    s_waitcnt lgkmcnt(8)
    v_mfma_f32_16x16x32_bf16 v[68:71], a[20:23], a[0:3], v[68:71]
    s_cmp_ge_u32 s58, 163840
    ds_read_b128 a[40:43], v6 offset:10240
    v_mfma_f32_16x16x32_bf16 v[76:79], a[20:23], a[4:7], v[76:79]
    ds_read_b128 a[44:47], v6 offset:11264
    buffer_load_dwordx4 v17, s[24:27], s57 offen offset:1024 sc1 lds
    v_mfma_f32_16x16x32_bf16 v[84:87], a[20:23], a[8:11], v[84:87]
    s_cselect_b32 s66, 4294836224, s100
    ds_read_b64_tr_b16 a[52:53], v13 offset:8192
    v_mfma_f32_16x16x32_bf16 v[92:95], a[20:23], a[12:15], v[92:95]
    s_cselect_b32 s58, 0, s58
    ds_read_b64_tr_b16 a[54:55], v13 offset:12288
    s_waitcnt lgkmcnt(10)
    v_mfma_f32_16x16x32_bf16 v[96:99], a[24:27], a[0:3], v[96:99]
    ds_read_b64_tr_b16 a[56:57], v14 offset:8192
    v_mfma_f32_16x16x32_bf16 v[104:107], a[24:27], a[4:7], v[104:107]
    ds_read_b64_tr_b16 a[58:59], v14 offset:12288
    buffer_load_dwordx4 v18, s[24:27], s57 offen offset:2048 sc1 lds
    v_mfma_f32_16x16x32_bf16 v[112:115], a[24:27], a[8:11], v[112:115]
    ds_read_b64_tr_b16 a[60:61], v15 offset:8192
    v_mfma_f32_16x16x32_bf16 v[120:123], a[24:27], a[12:15], v[120:123]
    ds_read_b64_tr_b16 a[62:63], v15 offset:12288
    buffer_store_dwordx4 v[128:131], v2, s[8:11], s70 offen offset:0 sc1
    s_waitcnt lgkmcnt(12)
    v_mfma_f32_16x16x32_bf16 v[100:103], a[28:31], a[0:3], v[100:103]
    v_add_u32 v6, s66, v6
    v_add_u32 v12, s66, v12
    v_mfma_f32_16x16x32_bf16 v[108:111], a[28:31], a[4:7], v[108:111]
    buffer_load_dwordx4 v19, s[24:27], s57 offen offset:3072 sc1 lds
    v_mfma_f32_16x16x32_bf16 v[116:119], a[28:31], a[8:11], v[116:119]
    s_add_u32 s57, s57, 131072
    v_add_u32 v13, s66, v13
    v_add_u32 v14, s66, v14
    v_mfma_f32_16x16x32_bf16 v[124:127], a[28:31], a[12:15], v[124:127]
    s_mov_b32 m0, s59
    v_add_u32 v15, s66, v15
    s_waitcnt vmcnt(24) lgkmcnt(0)
    v_mfma_f32_16x16x32_bf16 v[64:67], a[48:51], a[32:35], v[64:67]
    s_barrier
    v_mfma_f32_16x16x32_bf16 v[72:75], a[48:51], a[36:39], v[72:75]
    ds_read_b128 a[0:3], v6 offset:0
    buffer_load_dwordx4 v2, s[36:39], s56 offen offset:0 sc1 lds
    v_mfma_f32_16x16x32_bf16 v[80:83], a[48:51], a[40:43], v[80:83]
    ds_read_b64_tr_b16 a[16:17], v12 offset:0
    v_mfma_f32_16x16x32_bf16 v[88:91], a[48:51], a[44:47], v[88:91]
    ds_read_b64_tr_b16 a[18:19], v12 offset:4096
    v_mfma_f32_16x16x32_bf16 v[68:71], a[52:55], a[32:35], v[68:71]
    ds_read_b128 a[4:7], v6 offset:1024
    v_mfma_f32_16x16x32_bf16 v[76:79], a[52:55], a[36:39], v[76:79]
    ds_read_b128 a[8:11], v6 offset:2048
    buffer_load_dwordx4 v2, s[36:39], s56 offen offset:1024 sc1 lds
    v_mfma_f32_16x16x32_bf16 v[84:87], a[52:55], a[40:43], v[84:87]
    ds_read_b128 a[12:15], v6 offset:3072
    v_mfma_f32_16x16x32_bf16 v[92:95], a[52:55], a[44:47], v[92:95]
    ds_read_b64_tr_b16 a[20:21], v13 offset:0
    v_mfma_f32_16x16x32_bf16 v[96:99], a[56:59], a[32:35], v[96:99]
    ds_read_b64_tr_b16 a[22:23], v13 offset:4096
    v_mfma_f32_16x16x32_bf16 v[104:107], a[56:59], a[36:39], v[104:107]
    ds_read_b64_tr_b16 a[24:25], v14 offset:0
    buffer_load_dwordx4 v2, s[36:39], s56 offen offset:2048 sc1 lds
    v_mfma_f32_16x16x32_bf16 v[112:115], a[56:59], a[40:43], v[112:115]
    ds_read_b64_tr_b16 a[26:27], v14 offset:4096
    v_mfma_f32_16x16x32_bf16 v[120:123], a[56:59], a[44:47], v[120:123]
    ds_read_b64_tr_b16 a[28:29], v15 offset:0
    buffer_store_dwordx4 v[132:135], v2, s[8:11], s70 offen offset:1024 sc1
    v_mfma_f32_16x16x32_bf16 v[100:103], a[60:63], a[32:35], v[100:103]
    s_add_u32 s64, s64, 1
    ds_read_b64_tr_b16 a[30:31], v15 offset:4096
    v_mfma_f32_16x16x32_bf16 v[108:111], a[60:63], a[36:39], v[108:111]
    buffer_load_dwordx4 v2, s[36:39], s56 offen offset:3072 sc1 lds
    v_mfma_f32_16x16x32_bf16 v[116:119], a[60:63], a[40:43], v[116:119]
    s_add_u32 s56, s56, 262144
    v_mfma_f32_16x16x32_bf16 v[124:127], a[60:63], a[44:47], v[124:127]
    s_waitcnt lgkmcnt(9)
    v_mfma_f32_16x16x32_bf16 v[64:67], a[16:19], a[0:3], v[64:67]
    s_add_u32 m0, s59, 16384
    ds_read_b128 a[32:35], v6 offset:8192
    s_waitcnt lgkmcnt(9)
    v_mfma_f32_16x16x32_bf16 v[72:75], a[16:19], a[4:7], v[72:75]
    ds_read_b64_tr_b16 a[48:49], v12 offset:8192
    buffer_load_dwordx4 v16, s[24:27], s57 offen offset:0 sc1 lds
    s_waitcnt lgkmcnt(9)
    v_mfma_f32_16x16x32_bf16 v[80:83], a[16:19], a[8:11], v[80:83]
    s_add_u32 s59, s58, s60
    ds_read_b64_tr_b16 a[50:51], v12 offset:12288
    s_waitcnt lgkmcnt(9)
    v_mfma_f32_16x16x32_bf16 v[88:91], a[16:19], a[12:15], v[88:91]
    s_add_u32 s58, s58, 32768
    ds_read_b128 a[36:39], v6 offset:9216
    s_waitcnt lgkmcnt(8)
    v_mfma_f32_16x16x32_bf16 v[68:71], a[20:23], a[0:3], v[68:71]
    s_cmp_ge_u32 s58, 163840
    ds_read_b128 a[40:43], v6 offset:10240
    v_mfma_f32_16x16x32_bf16 v[76:79], a[20:23], a[4:7], v[76:79]
    ds_read_b128 a[44:47], v6 offset:11264
    buffer_load_dwordx4 v17, s[24:27], s57 offen offset:1024 sc1 lds
    v_mfma_f32_16x16x32_bf16 v[84:87], a[20:23], a[8:11], v[84:87]
    s_cselect_b32 s66, 4294836224, s100
    ds_read_b64_tr_b16 a[52:53], v13 offset:8192
    v_mfma_f32_16x16x32_bf16 v[92:95], a[20:23], a[12:15], v[92:95]
    s_cselect_b32 s58, 0, s58
    ds_read_b64_tr_b16 a[54:55], v13 offset:12288
    s_waitcnt lgkmcnt(10)
    v_mfma_f32_16x16x32_bf16 v[96:99], a[24:27], a[0:3], v[96:99]
    ds_read_b64_tr_b16 a[56:57], v14 offset:8192
    v_mfma_f32_16x16x32_bf16 v[104:107], a[24:27], a[4:7], v[104:107]
    ds_read_b64_tr_b16 a[58:59], v14 offset:12288
    buffer_load_dwordx4 v18, s[24:27], s57 offen offset:2048 sc1 lds
    v_mfma_f32_16x16x32_bf16 v[112:115], a[24:27], a[8:11], v[112:115]
    ds_read_b64_tr_b16 a[60:61], v15 offset:8192
    v_mfma_f32_16x16x32_bf16 v[120:123], a[24:27], a[12:15], v[120:123]
    ds_read_b64_tr_b16 a[62:63], v15 offset:12288
    buffer_store_dwordx4 v[136:139], v2, s[8:11], s70 offen offset:2048 sc1
    s_waitcnt lgkmcnt(12)
    v_mfma_f32_16x16x32_bf16 v[100:103], a[28:31], a[0:3], v[100:103]
    v_add_u32 v6, s66, v6
    v_add_u32 v12, s66, v12
    v_mfma_f32_16x16x32_bf16 v[108:111], a[28:31], a[4:7], v[108:111]
    buffer_load_dwordx4 v19, s[24:27], s57 offen offset:3072 sc1 lds
    v_mfma_f32_16x16x32_bf16 v[116:119], a[28:31], a[8:11], v[116:119]
    s_add_u32 s57, s57, 131072
    v_add_u32 v13, s66, v13
    v_add_u32 v14, s66, v14
    v_mfma_f32_16x16x32_bf16 v[124:127], a[28:31], a[12:15], v[124:127]
    s_mov_b32 m0, s59
    v_add_u32 v15, s66, v15
    s_waitcnt vmcnt(24) lgkmcnt(0)
    v_mfma_f32_16x16x32_bf16 v[64:67], a[48:51], a[32:35], v[64:67]
    s_barrier
    v_mfma_f32_16x16x32_bf16 v[72:75], a[48:51], a[36:39], v[72:75]
    ds_read_b128 a[0:3], v6 offset:0
    buffer_load_dwordx4 v2, s[36:39], s56 offen offset:0 sc1 lds
    v_mfma_f32_16x16x32_bf16 v[80:83], a[48:51], a[40:43], v[80:83]
    ds_read_b64_tr_b16 a[16:17], v12 offset:0
    v_mfma_f32_16x16x32_bf16 v[88:91], a[48:51], a[44:47], v[88:91]
    ds_read_b64_tr_b16 a[18:19], v12 offset:4096
    v_mfma_f32_16x16x32_bf16 v[68:71], a[52:55], a[32:35], v[68:71]
    ds_read_b128 a[4:7], v6 offset:1024
    v_mfma_f32_16x16x32_bf16 v[76:79], a[52:55], a[36:39], v[76:79]
    ds_read_b128 a[8:11], v6 offset:2048
    buffer_load_dwordx4 v2, s[36:39], s56 offen offset:1024 sc1 lds
    v_mfma_f32_16x16x32_bf16 v[84:87], a[52:55], a[40:43], v[84:87]
    ds_read_b128 a[12:15], v6 offset:3072
    v_mfma_f32_16x16x32_bf16 v[92:95], a[52:55], a[44:47], v[92:95]
    ds_read_b64_tr_b16 a[20:21], v13 offset:0
    v_mfma_f32_16x16x32_bf16 v[96:99], a[56:59], a[32:35], v[96:99]
    ds_read_b64_tr_b16 a[22:23], v13 offset:4096
    v_mfma_f32_16x16x32_bf16 v[104:107], a[56:59], a[36:39], v[104:107]
    ds_read_b64_tr_b16 a[24:25], v14 offset:0
    buffer_load_dwordx4 v2, s[36:39], s56 offen offset:2048 sc1 lds
    v_mfma_f32_16x16x32_bf16 v[112:115], a[56:59], a[40:43], v[112:115]
    ds_read_b64_tr_b16 a[26:27], v14 offset:4096
    v_mfma_f32_16x16x32_bf16 v[120:123], a[56:59], a[44:47], v[120:123]
    ds_read_b64_tr_b16 a[28:29], v15 offset:0
    buffer_store_dwordx4 v[140:143], v2, s[8:11], s70 offen offset:3072 sc1
    s_add_u32 s70, s70, 4096
    v_mfma_f32_16x16x32_bf16 v[100:103], a[60:63], a[32:35], v[100:103]
    s_add_u32 s64, s64, 1
    ds_read_b64_tr_b16 a[30:31], v15 offset:4096
    v_mfma_f32_16x16x32_bf16 v[108:111], a[60:63], a[36:39], v[108:111]
    buffer_load_dwordx4 v2, s[36:39], s56 offen offset:3072 sc1 lds
    v_mfma_f32_16x16x32_bf16 v[116:119], a[60:63], a[40:43], v[116:119]
    s_add_u32 s56, s56, 262144
    v_mfma_f32_16x16x32_bf16 v[124:127], a[60:63], a[44:47], v[124:127]
    s_waitcnt lgkmcnt(9)
    v_mfma_f32_16x16x32_bf16 v[64:67], a[16:19], a[0:3], v[64:67]
    s_add_u32 m0, s59, 16384
    ds_read_b128 a[32:35], v6 offset:8192
    s_waitcnt lgkmcnt(9)
    v_mfma_f32_16x16x32_bf16 v[72:75], a[16:19], a[4:7], v[72:75]
    ds_read_b64_tr_b16 a[48:49], v12 offset:8192
    buffer_load_dwordx4 v16, s[24:27], s57 offen offset:0 sc1 lds
    s_waitcnt lgkmcnt(9)
    v_mfma_f32_16x16x32_bf16 v[80:83], a[16:19], a[8:11], v[80:83]
    s_add_u32 s59, s58, s60
    ds_read_b64_tr_b16 a[50:51], v12 offset:12288
    s_waitcnt lgkmcnt(9)
    v_mfma_f32_16x16x32_bf16 v[88:91], a[16:19], a[12:15], v[88:91]
    s_add_u32 s58, s58, 32768
    ds_read_b128 a[36:39], v6 offset:9216
    s_waitcnt lgkmcnt(8)
    v_mfma_f32_16x16x32_bf16 v[68:71], a[20:23], a[0:3], v[68:71]
    s_cmp_ge_u32 s58, 163840
    ds_read_b128 a[40:43], v6 offset:10240
    v_mfma_f32_16x16x32_bf16 v[76:79], a[20:23], a[4:7], v[76:79]
    ds_read_b128 a[44:47], v6 offset:11264
    buffer_load_dwordx4 v17, s[24:27], s57 offen offset:1024 sc1 lds
    v_mfma_f32_16x16x32_bf16 v[84:87], a[20:23], a[8:11], v[84:87]
    s_cselect_b32 s66, 4294836224, s100
    ds_read_b64_tr_b16 a[52:53], v13 offset:8192
    v_mfma_f32_16x16x32_bf16 v[92:95], a[20:23], a[12:15], v[92:95]
    s_cselect_b32 s58, 0, s58
    ds_read_b64_tr_b16 a[54:55], v13 offset:12288
    s_waitcnt lgkmcnt(10)
    v_mfma_f32_16x16x32_bf16 v[96:99], a[24:27], a[0:3], v[96:99]
    ds_read_b64_tr_b16 a[56:57], v14 offset:8192
    v_mfma_f32_16x16x32_bf16 v[104:107], a[24:27], a[4:7], v[104:107]
    ds_read_b64_tr_b16 a[58:59], v14 offset:12288
    buffer_load_dwordx4 v18, s[24:27], s57 offen offset:2048 sc1 lds
    v_mfma_f32_16x16x32_bf16 v[112:115], a[24:27], a[8:11], v[112:115]
    ds_read_b64_tr_b16 a[60:61], v15 offset:8192
    v_mfma_f32_16x16x32_bf16 v[120:123], a[24:27], a[12:15], v[120:123]
    ds_read_b64_tr_b16 a[62:63], v15 offset:12288
    buffer_store_dwordx4 v[144:147], v2, s[8:11], s70 offen offset:0 sc1
    s_waitcnt lgkmcnt(12)
    v_mfma_f32_16x16x32_bf16 v[100:103], a[28:31], a[0:3], v[100:103]
    v_add_u32 v6, s66, v6
    v_add_u32 v12, s66, v12
    v_mfma_f32_16x16x32_bf16 v[108:111], a[28:31], a[4:7], v[108:111]
    buffer_load_dwordx4 v19, s[24:27], s57 offen offset:3072 sc1 lds
    v_mfma_f32_16x16x32_bf16 v[116:119], a[28:31], a[8:11], v[116:119]
    s_add_u32 s57, s57, 131072
    v_add_u32 v13, s66, v13
    v_add_u32 v14, s66, v14
    v_mfma_f32_16x16x32_bf16 v[124:127], a[28:31], a[12:15], v[124:127]
    s_mov_b32 m0, s59
    v_add_u32 v15, s66, v15
    s_waitcnt vmcnt(24) lgkmcnt(0)
    v_mfma_f32_16x16x32_bf16 v[64:67], a[48:51], a[32:35], v[64:67]
    s_barrier
    v_mfma_f32_16x16x32_bf16 v[72:75], a[48:51], a[36:39], v[72:75]
    ds_read_b128 a[0:3], v6 offset:0
    buffer_load_dwordx4 v2, s[36:39], s56 offen offset:0 sc1 lds
    v_mfma_f32_16x16x32_bf16 v[80:83], a[48:51], a[40:43], v[80:83]
    ds_read_b64_tr_b16 a[16:17], v12 offset:0
    v_mfma_f32_16x16x32_bf16 v[88:91], a[48:51], a[44:47], v[88:91]
    ds_read_b64_tr_b16 a[18:19], v12 offset:4096
    v_mfma_f32_16x16x32_bf16 v[68:71], a[52:55], a[32:35], v[68:71]
    ds_read_b128 a[4:7], v6 offset:1024
    v_mfma_f32_16x16x32_bf16 v[76:79], a[52:55], a[36:39], v[76:79]
    ds_read_b128 a[8:11], v6 offset:2048
    buffer_load_dwordx4 v2, s[36:39], s56 offen offset:1024 sc1 lds
    v_mfma_f32_16x16x32_bf16 v[84:87], a[52:55], a[40:43], v[84:87]
    ds_read_b128 a[12:15], v6 offset:3072
    v_mfma_f32_16x16x32_bf16 v[92:95], a[52:55], a[44:47], v[92:95]
    ds_read_b64_tr_b16 a[20:21], v13 offset:0
    v_mfma_f32_16x16x32_bf16 v[96:99], a[56:59], a[32:35], v[96:99]
    ds_read_b64_tr_b16 a[22:23], v13 offset:4096
    v_mfma_f32_16x16x32_bf16 v[104:107], a[56:59], a[36:39], v[104:107]
    ds_read_b64_tr_b16 a[24:25], v14 offset:0
    buffer_load_dwordx4 v2, s[36:39], s56 offen offset:2048 sc1 lds
    v_mfma_f32_16x16x32_bf16 v[112:115], a[56:59], a[40:43], v[112:115]
    ds_read_b64_tr_b16 a[26:27], v14 offset:4096
    v_mfma_f32_16x16x32_bf16 v[120:123], a[56:59], a[44:47], v[120:123]
    ds_read_b64_tr_b16 a[28:29], v15 offset:0
    buffer_store_dwordx4 v[148:151], v2, s[8:11], s70 offen offset:1024 sc1
    v_mfma_f32_16x16x32_bf16 v[100:103], a[60:63], a[32:35], v[100:103]
    s_add_u32 s64, s64, 1
    ds_read_b64_tr_b16 a[30:31], v15 offset:4096
    v_mfma_f32_16x16x32_bf16 v[108:111], a[60:63], a[36:39], v[108:111]
    buffer_load_dwordx4 v2, s[36:39], s56 offen offset:3072 sc1 lds
    v_mfma_f32_16x16x32_bf16 v[116:119], a[60:63], a[40:43], v[116:119]
    s_add_u32 s56, s56, 262144
    v_mfma_f32_16x16x32_bf16 v[124:127], a[60:63], a[44:47], v[124:127]
    s_waitcnt lgkmcnt(9)
    v_mfma_f32_16x16x32_bf16 v[64:67], a[16:19], a[0:3], v[64:67]
    s_add_u32 m0, s59, 16384
    ds_read_b128 a[32:35], v6 offset:8192
    s_waitcnt lgkmcnt(9)
    v_mfma_f32_16x16x32_bf16 v[72:75], a[16:19], a[4:7], v[72:75]
    ds_read_b64_tr_b16 a[48:49], v12 offset:8192
    buffer_load_dwordx4 v16, s[24:27], s57 offen offset:0 sc1 lds
    s_waitcnt lgkmcnt(9)
    v_mfma_f32_16x16x32_bf16 v[80:83], a[16:19], a[8:11], v[80:83]
    s_add_u32 s59, s58, s60
    ds_read_b64_tr_b16 a[50:51], v12 offset:12288
    s_waitcnt lgkmcnt(9)
    v_mfma_f32_16x16x32_bf16 v[88:91], a[16:19], a[12:15], v[88:91]
    s_add_u32 s58, s58, 32768
    ds_read_b128 a[36:39], v6 offset:9216
    s_waitcnt lgkmcnt(8)
    v_mfma_f32_16x16x32_bf16 v[68:71], a[20:23], a[0:3], v[68:71]
    s_cmp_ge_u32 s58, 163840
    ds_read_b128 a[40:43], v6 offset:10240
    v_mfma_f32_16x16x32_bf16 v[76:79], a[20:23], a[4:7], v[76:79]
    ds_read_b128 a[44:47], v6 offset:11264
    buffer_load_dwordx4 v17, s[24:27], s57 offen offset:1024 sc1 lds
    v_mfma_f32_16x16x32_bf16 v[84:87], a[20:23], a[8:11], v[84:87]
    s_cselect_b32 s66, 4294836224, s100
    ds_read_b64_tr_b16 a[52:53], v13 offset:8192
    v_mfma_f32_16x16x32_bf16 v[92:95], a[20:23], a[12:15], v[92:95]
    s_cselect_b32 s58, 0, s58
    ds_read_b64_tr_b16 a[54:55], v13 offset:12288
    s_waitcnt lgkmcnt(10)
    v_mfma_f32_16x16x32_bf16 v[96:99], a[24:27], a[0:3], v[96:99]
    ds_read_b64_tr_b16 a[56:57], v14 offset:8192
    v_mfma_f32_16x16x32_bf16 v[104:107], a[24:27], a[4:7], v[104:107]
    ds_read_b64_tr_b16 a[58:59], v14 offset:12288
    buffer_load_dwordx4 v18, s[24:27], s57 offen offset:2048 sc1 lds
    v_mfma_f32_16x16x32_bf16 v[112:115], a[24:27], a[8:11], v[112:115]
    ds_read_b64_tr_b16 a[60:61], v15 offset:8192
    v_mfma_f32_16x16x32_bf16 v[120:123], a[24:27], a[12:15], v[120:123]
    ds_read_b64_tr_b16 a[62:63], v15 offset:12288
    buffer_store_dwordx4 v[152:155], v2, s[8:11], s70 offen offset:2048 sc1
    s_waitcnt lgkmcnt(12)
    v_mfma_f32_16x16x32_bf16 v[100:103], a[28:31], a[0:3], v[100:103]
    v_add_u32 v6, s66, v6
    v_add_u32 v12, s66, v12
    v_mfma_f32_16x16x32_bf16 v[108:111], a[28:31], a[4:7], v[108:111]
    buffer_load_dwordx4 v19, s[24:27], s57 offen offset:3072 sc1 lds
    v_mfma_f32_16x16x32_bf16 v[116:119], a[28:31], a[8:11], v[116:119]
    s_add_u32 s57, s57, 131072
    v_add_u32 v13, s66, v13
    v_add_u32 v14, s66, v14
    v_mfma_f32_16x16x32_bf16 v[124:127], a[28:31], a[12:15], v[124:127]
    s_mov_b32 m0, s59
    v_add_u32 v15, s66, v15
    s_waitcnt vmcnt(24) lgkmcnt(0)
    v_mfma_f32_16x16x32_bf16 v[64:67], a[48:51], a[32:35], v[64:67]
    s_barrier
    v_mfma_f32_16x16x32_bf16 v[72:75], a[48:51], a[36:39], v[72:75]
    ds_read_b128 a[0:3], v6 offset:0
    buffer_load_dwordx4 v2, s[36:39], s56 offen offset:0 sc1 lds
    v_mfma_f32_16x16x32_bf16 v[80:83], a[48:51], a[40:43], v[80:83]
    ds_read_b64_tr_b16 a[16:17], v12 offset:0
    v_mfma_f32_16x16x32_bf16 v[88:91], a[48:51], a[44:47], v[88:91]
    ds_read_b64_tr_b16 a[18:19], v12 offset:4096
    v_mfma_f32_16x16x32_bf16 v[68:71], a[52:55], a[32:35], v[68:71]
    ds_read_b128 a[4:7], v6 offset:1024
    v_mfma_f32_16x16x32_bf16 v[76:79], a[52:55], a[36:39], v[76:79]
    ds_read_b128 a[8:11], v6 offset:2048
    buffer_load_dwordx4 v2, s[36:39], s56 offen offset:1024 sc1 lds
    v_mfma_f32_16x16x32_bf16 v[84:87], a[52:55], a[40:43], v[84:87]
    ds_read_b128 a[12:15], v6 offset:3072
    v_mfma_f32_16x16x32_bf16 v[92:95], a[52:55], a[44:47], v[92:95]
    ds_read_b64_tr_b16 a[20:21], v13 offset:0
    v_mfma_f32_16x16x32_bf16 v[96:99], a[56:59], a[32:35], v[96:99]
    ds_read_b64_tr_b16 a[22:23], v13 offset:4096
    v_mfma_f32_16x16x32_bf16 v[104:107], a[56:59], a[36:39], v[104:107]
    ds_read_b64_tr_b16 a[24:25], v14 offset:0
    buffer_load_dwordx4 v2, s[36:39], s56 offen offset:2048 sc1 lds
    v_mfma_f32_16x16x32_bf16 v[112:115], a[56:59], a[40:43], v[112:115]
    ds_read_b64_tr_b16 a[26:27], v14 offset:4096
    v_mfma_f32_16x16x32_bf16 v[120:123], a[56:59], a[44:47], v[120:123]
    ds_read_b64_tr_b16 a[28:29], v15 offset:0
    buffer_store_dwordx4 v[156:159], v2, s[8:11], s70 offen offset:3072 sc1
    s_add_u32 s70, s70, 4096
    v_mfma_f32_16x16x32_bf16 v[100:103], a[60:63], a[32:35], v[100:103]
    s_add_u32 s64, s64, 1
    ds_read_b64_tr_b16 a[30:31], v15 offset:4096
    v_mfma_f32_16x16x32_bf16 v[108:111], a[60:63], a[36:39], v[108:111]
    buffer_load_dwordx4 v2, s[36:39], s56 offen offset:3072 sc1 lds
    v_mfma_f32_16x16x32_bf16 v[116:119], a[60:63], a[40:43], v[116:119]
    s_add_u32 s56, s56, 262144
    v_mfma_f32_16x16x32_bf16 v[124:127], a[60:63], a[44:47], v[124:127]
    s_mov_b32 s67, 32
    s_branch m_l3147
m_n178:
    s_cmp_lg_u32 s64, 32
    s_cbranch_scc1 m_n179
    s_lshl_b32 s91, s96, 3
    s_add_u32 s91, s91, s97
    s_lshl_b32 s91, s91, 7
    s_add_u32 s91, s91, 16384
    s_cmp_lg_u32 s16, 0
    s_cbranch_scc1 m_np180
    v_mov_b32 v60, s4
    v_mov_b32 v61, s5
    s_add_u32 s90, s91, 117440512
    s_mov_b64 exec, 1
    buffer_store_dwordx2 v[60:61], off, s[8:11], s90 sc1
    s_mov_b64 exec, -1
m_np180:
    s_mov_b32 s67, 35
    s_branch m_l3147
m_n179:
    s_cmp_lg_u32 s64, 35
    s_cbranch_scc1 m_n181
    s_mov_b32 s38, 0
    s_mov_b32 s67, 40
    s_branch m_l3147
m_n181:
    s_branch m_l3x149
m_l3c150:
    s_mov_b32 s67, 34
    s_cmp_lt_u32 s64, 34
    s_cbranch_scc1 m_l3n151
    s_cmp_lg_u32 s64, 34
    s_cbranch_scc1 m_n183
    s_mov_b32 s68, 1000
    s_mov_b32 s67, 35
    s_branch m_l3147
m_n183:
    s_cmp_lg_u32 s64, 35
    s_cbranch_scc1 m_n184
    s_mov_b32 s38, 0
    s_lshl_b32 s91, s96, 3
    s_add_u32 s91, s91, s97
    s_lshl_b32 s91, s91, 7
    s_add_u32 s91, s91, 16384
    s_add_u32 s52, s91, 117440512
    buffer_load_dwordx2 v[4:5], off, s[8:11], s52 sc1
    s_mov_b32 s67, 36
    s_branch m_l3147
m_n184:
    s_cmp_lg_u32 s64, 36
    s_cbranch_scc1 m_n185
    s_mov_b32 s26, 0
    s_mov_b32 s67, 37
    s_branch m_l3147
m_n185:
    s_cmp_lg_u32 s64, 37
    s_cbranch_scc1 m_n186
    s_waitcnt vmcnt(16)
    s_mov_b32 s3, 1048576
m_spin187:
    v_cmp_ne_u64 s[76:77], s[4:5], v[4:5]
    s_nop 3
    s_cmp_eq_u64 s[76:77], 0
    s_cbranch_scc1 m_ok188
    s_sub_u32 s3, s3, 1
    s_cbranch_scc1 m_ok188
    s_sleep 8
    buffer_load_dwordx2 v[4:5], off, s[8:11], s52 sc1
    s_waitcnt vmcnt(0)
    s_branch m_spin187
m_ok188:
    s_lshl_b32 s90, s96, 3
    s_add_u32 s90, s90, s97
    s_lshl_b32 s90, s90, 15
    s_lshl_b32 s91, s16, 13
    s_add_u32 s90, s90, s91
    s_add_u32 s70, s90, 100663296
    buffer_load_dwordx4 v[128:131], v2, s[8:11], s70 offen offset:0 sc1
    buffer_load_dwordx4 v[132:135], v2, s[8:11], s70 offen offset:1024 sc1
    buffer_load_dwordx4 v[136:139], v2, s[8:11], s70 offen offset:2048 sc1
    buffer_load_dwordx4 v[140:143], v2, s[8:11], s70 offen offset:3072 sc1
    s_add_u32 s70, s70, 4096
    buffer_load_dwordx4 v[144:147], v2, s[8:11], s70 offen offset:0 sc1
    buffer_load_dwordx4 v[148:151], v2, s[8:11], s70 offen offset:1024 sc1
    buffer_load_dwordx4 v[152:155], v2, s[8:11], s70 offen offset:2048 sc1
    buffer_load_dwordx4 v[156:159], v2, s[8:11], s70 offen offset:3072 sc1
    s_mov_b32 s67, 40
    s_branch m_l3147
m_n186:
    s_branch m_l3x149
m_o1171:
    s_and_b32 s91, s2, 7
    s_lshl_b32 s91, s91, 5
    s_lshr_b32 s92, s2, 3
    s_add_u32 s91, s91, s92
    s_lshl_b32 s91, s91, 3
    s_add_u32 s91, s91, 12288
    s_cmp_lg_u32 s16, 0
    s_cbranch_scc1 m_np190
    v_mov_b32 v60, s4
    v_mov_b32 v61, s5
    s_add_u32 s90, s91, 117440512
    s_mov_b64 exec, 1
    buffer_store_dwordx2 v[60:61], off, s[8:11], s90 sc1
    s_mov_b64 exec, -1
m_np190:
    s_branch m_o2172
m_l3n151:
    s_sub_u32 s90, s68, 5
    s_min_u32 s67, s67, s90
    s_branch m_l3147
m_l3x149:
    s_cmp_eq_u32 s95, 1
    s_cbranch_scc1 m_noadd191
    s_waitcnt vmcnt(0)
    v_lshlrev_b32 v160, 16, v128
    v_and_b32 v161, 0xffff0000, v128
    v_lshlrev_b32 v162, 16, v129
    v_and_b32 v163, 0xffff0000, v129
    v_lshlrev_b32 v164, 16, v130
    v_and_b32 v165, 0xffff0000, v130
    v_lshlrev_b32 v166, 16, v131
    v_and_b32 v167, 0xffff0000, v131
    v_lshlrev_b32 v168, 16, v132
    v_and_b32 v169, 0xffff0000, v132
    v_lshlrev_b32 v170, 16, v133
    v_and_b32 v171, 0xffff0000, v133
    v_lshlrev_b32 v172, 16, v134
    v_and_b32 v173, 0xffff0000, v134
    v_lshlrev_b32 v174, 16, v135
    v_and_b32 v175, 0xffff0000, v135
    v_lshlrev_b32 v176, 16, v136
    v_and_b32 v177, 0xffff0000, v136
    v_lshlrev_b32 v178, 16, v137
    v_and_b32 v179, 0xffff0000, v137
    v_lshlrev_b32 v180, 16, v138
    v_and_b32 v181, 0xffff0000, v138
    v_lshlrev_b32 v182, 16, v139
    v_and_b32 v183, 0xffff0000, v139
    v_lshlrev_b32 v184, 16, v140
    v_and_b32 v185, 0xffff0000, v140
    v_lshlrev_b32 v186, 16, v141
    v_and_b32 v187, 0xffff0000, v141
    v_lshlrev_b32 v188, 16, v142
    v_and_b32 v189, 0xffff0000, v142
    v_lshlrev_b32 v190, 16, v143
    v_and_b32 v191, 0xffff0000, v143
    v_lshlrev_b32 v192, 16, v144
    v_and_b32 v193, 0xffff0000, v144
    v_lshlrev_b32 v194, 16, v145
    v_and_b32 v195, 0xffff0000, v145
    v_lshlrev_b32 v196, 16, v146
    v_and_b32 v197, 0xffff0000, v146
    v_lshlrev_b32 v198, 16, v147
    v_and_b32 v199, 0xffff0000, v147
    v_lshlrev_b32 v200, 16, v148
    v_and_b32 v201, 0xffff0000, v148
    v_lshlrev_b32 v202, 16, v149
    v_and_b32 v203, 0xffff0000, v149
    v_lshlrev_b32 v204, 16, v150
    v_and_b32 v205, 0xffff0000, v150
    v_lshlrev_b32 v206, 16, v151
    v_and_b32 v207, 0xffff0000, v151
    v_lshlrev_b32 v208, 16, v152
    v_and_b32 v209, 0xffff0000, v152
    v_lshlrev_b32 v210, 16, v153
    v_and_b32 v211, 0xffff0000, v153
    v_lshlrev_b32 v212, 16, v154
    v_and_b32 v213, 0xffff0000, v154
    v_lshlrev_b32 v214, 16, v155
    v_and_b32 v215, 0xffff0000, v155
    v_lshlrev_b32 v216, 16, v156
    v_and_b32 v217, 0xffff0000, v156
    v_lshlrev_b32 v218, 16, v157
    v_and_b32 v219, 0xffff0000, v157
    v_lshlrev_b32 v220, 16, v158
    v_and_b32 v221, 0xffff0000, v158
    v_lshlrev_b32 v222, 16, v159
    v_and_b32 v223, 0xffff0000, v159
    v_pk_add_f32 v[64:65], v[64:65], v[160:161]
    v_pk_add_f32 v[66:67], v[66:67], v[162:163]
    v_pk_add_f32 v[68:69], v[68:69], v[164:165]
    v_pk_add_f32 v[70:71], v[70:71], v[166:167]
    v_pk_add_f32 v[72:73], v[72:73], v[168:169]
    v_pk_add_f32 v[74:75], v[74:75], v[170:171]
    v_pk_add_f32 v[76:77], v[76:77], v[172:173]
    v_pk_add_f32 v[78:79], v[78:79], v[174:175]
    v_pk_add_f32 v[80:81], v[80:81], v[176:177]
    v_pk_add_f32 v[82:83], v[82:83], v[178:179]
    v_pk_add_f32 v[84:85], v[84:85], v[180:181]
    v_pk_add_f32 v[86:87], v[86:87], v[182:183]
    v_pk_add_f32 v[88:89], v[88:89], v[184:185]
    v_pk_add_f32 v[90:91], v[90:91], v[186:187]
    v_pk_add_f32 v[92:93], v[92:93], v[188:189]
    v_pk_add_f32 v[94:95], v[94:95], v[190:191]
    v_pk_add_f32 v[96:97], v[96:97], v[192:193]
    v_pk_add_f32 v[98:99], v[98:99], v[194:195]
    v_pk_add_f32 v[100:101], v[100:101], v[196:197]
    v_pk_add_f32 v[102:103], v[102:103], v[198:199]
    v_pk_add_f32 v[104:105], v[104:105], v[200:201]
    v_pk_add_f32 v[106:107], v[106:107], v[202:203]
    v_pk_add_f32 v[108:109], v[108:109], v[204:205]
    v_pk_add_f32 v[110:111], v[110:111], v[206:207]
    v_pk_add_f32 v[112:113], v[112:113], v[208:209]
    v_pk_add_f32 v[114:115], v[114:115], v[210:211]
    v_pk_add_f32 v[116:117], v[116:117], v[212:213]
    v_pk_add_f32 v[118:119], v[118:119], v[214:215]
    v_pk_add_f32 v[120:121], v[120:121], v[216:217]
    v_pk_add_f32 v[122:123], v[122:123], v[218:219]
    v_pk_add_f32 v[124:125], v[124:125], v[220:221]
    v_pk_add_f32 v[126:127], v[126:127], v[222:223]
m_noadd191:
    v_cvt_pk_bf16_f32 v64, v64, v65
    v_cvt_pk_bf16_f32 v65, v66, v67
    v_cvt_pk_bf16_f32 v66, v68, v69
    v_cvt_pk_bf16_f32 v67, v70, v71
    v_cvt_pk_bf16_f32 v96, v96, v97
    v_cvt_pk_bf16_f32 v97, v98, v99
    v_cvt_pk_bf16_f32 v98, v100, v101
    v_cvt_pk_bf16_f32 v99, v102, v103
    s_nop 1
    v_permlane16_swap_b32 v64, v66
    v_permlane16_swap_b32 v65, v67
    v_permlane16_swap_b32 v96, v98
    v_permlane16_swap_b32 v97, v99
    buffer_store_dwordx4 v[64:67], v7, s[28:31], s71 offen offset:0 sc1
    buffer_store_dwordx4 v[96:99], v7, s[28:31], s71 offen offset:64 sc1
    s_add_u32 s71, s71, s72
    v_cvt_pk_bf16_f32 v72, v72, v73
    v_cvt_pk_bf16_f32 v73, v74, v75
    v_cvt_pk_bf16_f32 v74, v76, v77
    v_cvt_pk_bf16_f32 v75, v78, v79
    v_cvt_pk_bf16_f32 v104, v104, v105
    v_cvt_pk_bf16_f32 v105, v106, v107
    v_cvt_pk_bf16_f32 v106, v108, v109
    v_cvt_pk_bf16_f32 v107, v110, v111
    s_nop 1
    v_permlane16_swap_b32 v72, v74
    v_permlane16_swap_b32 v73, v75
    v_permlane16_swap_b32 v104, v106
    v_permlane16_swap_b32 v105, v107
    buffer_store_dwordx4 v[72:75], v7, s[28:31], s71 offen offset:0 sc1
    buffer_store_dwordx4 v[104:107], v7, s[28:31], s71 offen offset:64 sc1
    s_add_u32 s71, s71, s72
    v_cvt_pk_bf16_f32 v80, v80, v81
    v_cvt_pk_bf16_f32 v81, v82, v83
    v_cvt_pk_bf16_f32 v82, v84, v85
    v_cvt_pk_bf16_f32 v83, v86, v87
    v_cvt_pk_bf16_f32 v112, v112, v113
    v_cvt_pk_bf16_f32 v113, v114, v115
    v_cvt_pk_bf16_f32 v114, v116, v117
    v_cvt_pk_bf16_f32 v115, v118, v119
    s_nop 1
    v_permlane16_swap_b32 v80, v82
    v_permlane16_swap_b32 v81, v83
    v_permlane16_swap_b32 v112, v114
    v_permlane16_swap_b32 v113, v115
    buffer_store_dwordx4 v[80:83], v7, s[28:31], s71 offen offset:0 sc1
    buffer_store_dwordx4 v[112:115], v7, s[28:31], s71 offen offset:64 sc1
    s_add_u32 s71, s71, s72
    v_cvt_pk_bf16_f32 v88, v88, v89
    v_cvt_pk_bf16_f32 v89, v90, v91
    v_cvt_pk_bf16_f32 v90, v92, v93
    v_cvt_pk_bf16_f32 v91, v94, v95
    v_cvt_pk_bf16_f32 v120, v120, v121
    v_cvt_pk_bf16_f32 v121, v122, v123
    v_cvt_pk_bf16_f32 v122, v124, v125
    v_cvt_pk_bf16_f32 v123, v126, v127
    s_nop 1
    v_permlane16_swap_b32 v88, v90
    v_permlane16_swap_b32 v89, v91
    v_permlane16_swap_b32 v120, v122
    v_permlane16_swap_b32 v121, v123
    buffer_store_dwordx4 v[88:91], v7, s[28:31], s71 offen offset:0 sc1
    buffer_store_dwordx4 v[120:123], v7, s[28:31], s71 offen offset:64 sc1
    s_add_u32 s71, s71, s72
m_end1:
    s_endpgm
m_stub94:
    v_cmp_lt_f32 vcc, s65, v8
    s_cmp_lg_u32 s64, s67
    s_cbranch_scc1 m_e193
    v_add_f32 v176, v176, v16
    v_mov_b32 v180, v9
    v_add_f32 v188, v188, v16
    v_add_f32 v177, v177, v17
    v_mov_b32 v181, v9
    v_add_f32 v189, v189, v17
    v_add_f32 v178, v178, v18
    v_mov_b32 v182, v9
    v_add_f32 v190, v190, v18
    v_add_f32 v179, v179, v19
    v_mov_b32 v183, v9
    v_add_f32 v191, v191, v19
    s_nop 0
m_e193:
    s_cmp_lg_u32 s64, s68
    s_cbranch_scc1 m_e194
    v_mov_b32 v176, v9
    v_mov_b32 v184, v9
    v_mov_b32 v188, v9
    v_mov_b32 v177, v9
    v_mov_b32 v185, v9
    v_mov_b32 v189, v9
    v_mov_b32 v178, v9
    v_mov_b32 v186, v9
    v_mov_b32 v190, v9
    v_mov_b32 v179, v9
    v_mov_b32 v187, v9
    v_mov_b32 v191, v9
    s_nop 0
m_e194:
    s_cbranch_vccnz m_rc195
m_sp192:
    s_branch m_ret95
m_stub97:
    v_cmp_lt_f32 vcc, s65, v8
    s_cmp_lg_u32 s64, s67
    s_cbranch_scc1 m_e197
    v_add_f32 v176, v176, v16
    v_mov_b32 v180, v9
    v_add_f32 v188, v188, v16
    v_add_f32 v177, v177, v17
    v_mov_b32 v181, v9
    v_add_f32 v189, v189, v17
    v_add_f32 v178, v178, v18
    v_mov_b32 v182, v9
    v_add_f32 v190, v190, v18
    v_add_f32 v179, v179, v19
    v_mov_b32 v183, v9
    v_add_f32 v191, v191, v19
    s_nop 0
m_e197:
    s_cmp_lg_u32 s64, s68
    s_cbranch_scc1 m_e198
    v_mov_b32 v176, v9
    v_mov_b32 v184, v9
    v_mov_b32 v188, v9
    v_mov_b32 v177, v9
    v_mov_b32 v185, v9
    v_mov_b32 v189, v9
    v_mov_b32 v178, v9
    v_mov_b32 v186, v9
    v_mov_b32 v190, v9
    v_mov_b32 v179, v9
    v_mov_b32 v187, v9
    v_mov_b32 v191, v9
    s_nop 0
m_e198:
    s_cbranch_vccnz m_rc199
m_sp196:
    s_branch m_ret98
m_stub115:
    v_cmp_lt_f32 vcc, s65, v8
    s_cmp_lg_u32 s64, s70
    s_cbranch_scc1 m_e201
    v_add_f32 v160, v160, v16
    v_mov_b32 v164, v9
    v_add_f32 v172, v172, v16
    v_add_f32 v161, v161, v17
    v_mov_b32 v165, v9
    v_add_f32 v173, v173, v17
    v_add_f32 v162, v162, v18
    v_mov_b32 v166, v9
    v_add_f32 v174, v174, v18
    v_add_f32 v163, v163, v19
    v_mov_b32 v167, v9
    v_add_f32 v175, v175, v19
    s_nop 0
m_e201:
    s_cmp_lg_u32 s64, s71
    s_cbranch_scc1 m_e202
    v_mov_b32 v160, v9
    v_mov_b32 v168, v9
    v_mov_b32 v172, v9
    v_mov_b32 v161, v9
    v_mov_b32 v169, v9
    v_mov_b32 v173, v9
    v_mov_b32 v162, v9
    v_mov_b32 v170, v9
    v_mov_b32 v174, v9
    v_mov_b32 v163, v9
    v_mov_b32 v171, v9
    v_mov_b32 v175, v9
    s_nop 0
m_e202:
    s_cbranch_vccnz m_rc203
m_sp200:
    s_branch m_ret116
m_stub117:
    v_cmp_lt_f32 vcc, s65, v8
    s_cmp_lg_u32 s64, s70
    s_cbranch_scc1 m_e205
    v_add_f32 v160, v160, v16
    v_mov_b32 v164, v9
    v_add_f32 v172, v172, v16
    v_add_f32 v161, v161, v17
    v_mov_b32 v165, v9
    v_add_f32 v173, v173, v17
    v_add_f32 v162, v162, v18
    v_mov_b32 v166, v9
    v_add_f32 v174, v174, v18
    v_add_f32 v163, v163, v19
    v_mov_b32 v167, v9
    v_add_f32 v175, v175, v19
    s_nop 0
m_e205:
    s_cmp_lg_u32 s64, s71
    s_cbranch_scc1 m_e206
    v_mov_b32 v160, v9
    v_mov_b32 v168, v9
    v_mov_b32 v172, v9
    v_mov_b32 v161, v9
    v_mov_b32 v169, v9
    v_mov_b32 v173, v9
    v_mov_b32 v162, v9
    v_mov_b32 v170, v9
    v_mov_b32 v174, v9
    v_mov_b32 v163, v9
    v_mov_b32 v171, v9
    v_mov_b32 v175, v9
    s_nop 0
m_e206:
    s_cmp_lg_u32 s64, s53
    s_cbranch_scc1 m_e209
    s_cmp_lg_u32 s16, 0
    s_cbranch_scc1 m_np210
    v_mov_b32 v60, s4
    v_mov_b32 v61, s5
    s_add_u32 s90, s101, 117440512
    s_mov_b64 exec, 1
    buffer_store_dwordx2 v[60:61], off, s[8:11], s90 sc1
    s_mov_b64 exec, -1
m_np210:
    s_mov_b32 s101, -1
m_e209:
    s_cmp_gt_u32 s64, 24
    s_cbranch_scc1 m_e207
    s_cmp_lg_u32 s64, 8
    s_cbranch_scc1 m_e211
    s_lshr_b32 s90, s32, 1
    s_lshl_b32 s90, s90, 7
    s_add_u32 s90, s90, 117440600
    v_min_u32 v0, 1, v1
    v_lshlrev_b32 v0, 5, v0
    buffer_load_dwordx2 v[4:5], v0, s[8:11], s90 offen sc1
    s_cmp_eq_u32 s17, -1
    s_cbranch_scc1 m_e207
    s_cmp_lg_u32 s16, 0
    s_cbranch_scc1 m_np212
    v_mov_b32 v60, s4
    v_mov_b32 v61, s5
    s_add_u32 s90, s17, 117440512
    s_mov_b64 exec, 1
    buffer_store_dwordx2 v[60:61], off, s[8:11], s90 sc1
    s_mov_b64 exec, -1
m_np212:
    s_branch m_e207
m_e211:
    s_cmp_lg_u32 s64, 16
    s_cbranch_scc1 m_e213
    s_waitcnt vmcnt(18)
    s_mov_b32 s3, 1048576
m_spin214:
    v_cmp_ne_u64 s[76:77], s[4:5], v[4:5]
    s_nop 3
    s_cmp_eq_u64 s[76:77], 0
    s_cbranch_scc1 m_e207
    s_sub_u32 s3, s3, 1
    s_cbranch_scc1 m_e207
    s_sleep 32
    s_lshr_b32 s90, s32, 1
    s_lshl_b32 s90, s90, 7
    s_add_u32 s90, s90, 117440600
    v_min_u32 v0, 1, v1
    v_lshlrev_b32 v0, 5, v0
    buffer_load_dwordx2 v[4:5], v0, s[8:11], s90 offen sc1
    s_waitcnt vmcnt(0)
    s_branch m_spin214
    s_branch m_e207
m_e213:
    s_cmp_lg_u32 s64, 20
    s_cbranch_scc1 m_e215
    buffer_load_dwordx2 v[4:5], v10, s[8:11], 0 offen sc1
    s_mov_b32 s44, s48
    s_mov_b32 s45, s49
    s_mov_b32 s46, 8388608
    s_lshl_b32 s90, s2, 2
    s_add_u32 s90, s90, s16
    s_lshl_b32 s90, s90, 13
    v_lshlrev_b32 v62, 7, v1
    buffer_load_dword v255, v62, s[44:47], s90 offen
    s_branch m_e207
m_e215:
    s_cmp_lg_u32 s64, 24
    s_cbranch_scc1 m_e216
    s_mov_b32 s44, s50
    s_mov_b32 s45, s51
    s_mov_b32 s46, 2097152
    s_lshl_b32 s90, s2, 2
    s_add_u32 s90, s90, s16
    s_lshl_b32 s90, s90, 13
    v_lshlrev_b32 v62, 7, v1
    buffer_load_dword v255, v62, s[44:47], s90 offen
    s_waitcnt vmcnt(18)
    s_mov_b32 s3, 1048576
m_spin217:
    v_cmp_ne_u64 s[76:77], s[4:5], v[4:5]
    s_nop 3
    s_cmp_eq_u64 s[76:77], 0
    s_cbranch_scc1 m_e207
    s_sub_u32 s3, s3, 1
    s_cbranch_scc1 m_e207
    s_sleep 32
    buffer_load_dwordx2 v[4:5], v10, s[8:11], 0 offen sc1
    s_waitcnt vmcnt(0)
    s_branch m_spin217
    s_branch m_e207
m_e216:
m_e207:
    s_cbranch_vccnz m_rc218
m_sp204:
    s_branch m_ret118
m_stub121:
    v_cmp_lt_f32 vcc, s65, v8
    s_cmp_lg_u32 s64, s70
    s_cbranch_scc1 m_e220
    v_add_f32 v160, v160, v16
    v_mov_b32 v164, v9
    v_add_f32 v172, v172, v16
    v_add_f32 v161, v161, v17
    v_mov_b32 v165, v9
    v_add_f32 v173, v173, v17
    v_add_f32 v162, v162, v18
    v_mov_b32 v166, v9
    v_add_f32 v174, v174, v18
    v_add_f32 v163, v163, v19
    v_mov_b32 v167, v9
    v_add_f32 v175, v175, v19
    s_nop 0
m_e220:
    s_cmp_lg_u32 s64, s71
    s_cbranch_scc1 m_e221
    v_mov_b32 v160, v9
    v_mov_b32 v168, v9
    v_mov_b32 v172, v9
    v_mov_b32 v161, v9
    v_mov_b32 v169, v9
    v_mov_b32 v173, v9
    v_mov_b32 v162, v9
    v_mov_b32 v170, v9
    v_mov_b32 v174, v9
    v_mov_b32 v163, v9
    v_mov_b32 v171, v9
    v_mov_b32 v175, v9
    s_nop 0
m_e221:
    s_cbranch_vccnz m_rc222
m_sp219:
    s_branch m_ret122
m_stub138:
    v_cmp_lt_f32 vcc, s65, v8
    s_cbranch_vccnz m_rc224
m_sp223:
    s_branch m_ret139
m_rc114:
    s_call_b64 s[74:75], m_rs0488
    s_branch m_sp99
m_rc137:
    s_call_b64 s[74:75], m_rs0287
    s_branch m_sp123
m_rc195:
    s_call_b64 s[74:75], m_rs0488
    s_branch m_sp192
m_rc199:
    s_call_b64 s[74:75], m_rs1490
    s_branch m_sp196
m_rc203:
    s_call_b64 s[74:75], m_rs1490
    s_branch m_sp200
m_rc218:
    s_call_b64 s[74:75], m_rs0287
    s_branch m_sp204
m_rc222:
    s_call_b64 s[74:75], m_rs1289
    s_branch m_sp219
m_rc224:
    s_call_b64 s[74:75], m_rs1289
    s_branch m_sp223
m_rs0287:
    s_nop 15
    v_max3_f32 v48, v64, v65, v66
    v_max3_f32 v48, v48, v67, v68
    v_max3_f32 v48, v48, v69, v70
    v_max3_f32 v48, v48, v71, 0
    v_mov_b32 v49, v48
    s_nop 1
    v_permlane32_swap_b32 v48, v49
    s_nop 1
    v_max_f32 v48, v48, v49
    v_mov_b32 v49, v48
    s_nop 1
    v_permlane16_swap_b32 v48, v49
    s_nop 1
    v_max_f32 v48, v48, v49
    v_exp_f32 v49, -v48
    v_sub_f32 v64, v64, v48
    v_sub_f32 v65, v65, v48
    v_sub_f32 v66, v66, v48
    v_sub_f32 v67, v67, v48
    v_sub_f32 v68, v68, v48
    v_sub_f32 v69, v69, v48
    v_sub_f32 v70, v70, v48
    v_sub_f32 v71, v71, v48
    v_sub_f32 v96, v96, v48
    v_sub_f32 v97, v97, v48
    v_sub_f32 v98, v98, v48
    v_sub_f32 v99, v99, v48
    v_sub_f32 v100, v100, v48
    v_sub_f32 v101, v101, v48
    v_sub_f32 v102, v102, v48
    v_sub_f32 v103, v103, v48
    v_sub_f32 v160, v160, v48
    v_sub_f32 v161, v161, v48
    v_sub_f32 v162, v162, v48
    v_sub_f32 v163, v163, v48
    v_sub_f32 v164, v164, v48
    v_sub_f32 v165, v165, v48
    v_sub_f32 v166, v166, v48
    v_sub_f32 v167, v167, v48
    v_mul_f32 v12, v12, v49
    v_accvgpr_read_b32 v52, a0
    v_accvgpr_read_b32 v53, a1
    v_accvgpr_read_b32 v54, a2
    v_accvgpr_read_b32 v55, a3
    v_accvgpr_read_b32 v56, a4
    v_accvgpr_read_b32 v57, a5
    v_accvgpr_read_b32 v58, a6
    v_accvgpr_read_b32 v59, a7
    v_mul_f32 v52, v52, v49
    v_mul_f32 v53, v53, v49
    v_mul_f32 v54, v54, v49
    v_mul_f32 v55, v55, v49
    v_mul_f32 v56, v56, v49
    v_mul_f32 v57, v57, v49
    v_mul_f32 v58, v58, v49
    v_mul_f32 v59, v59, v49
    v_accvgpr_write_b32 a0, v52
    v_accvgpr_write_b32 a1, v53
    v_accvgpr_write_b32 a2, v54
    v_accvgpr_write_b32 a3, v55
    v_accvgpr_write_b32 a4, v56
    v_accvgpr_write_b32 a5, v57
    v_accvgpr_write_b32 a6, v58
    v_accvgpr_write_b32 a7, v59
    v_accvgpr_read_b32 v52, a8
    v_accvgpr_read_b32 v53, a9
    v_accvgpr_read_b32 v54, a10
    v_accvgpr_read_b32 v55, a11
    v_accvgpr_read_b32 v56, a12
    v_accvgpr_read_b32 v57, a13
    v_accvgpr_read_b32 v58, a14
    v_accvgpr_read_b32 v59, a15
    v_mul_f32 v52, v52, v49
    v_mul_f32 v53, v53, v49
    v_mul_f32 v54, v54, v49
    v_mul_f32 v55, v55, v49
    v_mul_f32 v56, v56, v49
    v_mul_f32 v57, v57, v49
    v_mul_f32 v58, v58, v49
    v_mul_f32 v59, v59, v49
    v_accvgpr_write_b32 a8, v52
    v_accvgpr_write_b32 a9, v53
    v_accvgpr_write_b32 a10, v54
    v_accvgpr_write_b32 a11, v55
    v_accvgpr_write_b32 a12, v56
    v_accvgpr_write_b32 a13, v57
    v_accvgpr_write_b32 a14, v58
    v_accvgpr_write_b32 a15, v59
    v_accvgpr_read_b32 v52, a16
    v_accvgpr_read_b32 v53, a17
    v_accvgpr_read_b32 v54, a18
    v_accvgpr_read_b32 v55, a19
    v_accvgpr_read_b32 v56, a20
    v_accvgpr_read_b32 v57, a21
    v_accvgpr_read_b32 v58, a22
    v_accvgpr_read_b32 v59, a23
    v_mul_f32 v52, v52, v49
    v_mul_f32 v53, v53, v49
    v_mul_f32 v54, v54, v49
    v_mul_f32 v55, v55, v49
    v_mul_f32 v56, v56, v49
    v_mul_f32 v57, v57, v49
    v_mul_f32 v58, v58, v49
    v_mul_f32 v59, v59, v49
    v_accvgpr_write_b32 a16, v52
    v_accvgpr_write_b32 a17, v53
    v_accvgpr_write_b32 a18, v54
    v_accvgpr_write_b32 a19, v55
    v_accvgpr_write_b32 a20, v56
    v_accvgpr_write_b32 a21, v57
    v_accvgpr_write_b32 a22, v58
    v_accvgpr_write_b32 a23, v59
    v_accvgpr_read_b32 v52, a24
    v_accvgpr_read_b32 v53, a25
    v_accvgpr_read_b32 v54, a26
    v_accvgpr_read_b32 v55, a27
    v_accvgpr_read_b32 v56, a28
    v_accvgpr_read_b32 v57, a29
    v_accvgpr_read_b32 v58, a30
    v_accvgpr_read_b32 v59, a31
    v_mul_f32 v52, v52, v49
    v_mul_f32 v53, v53, v49
    v_mul_f32 v54, v54, v49
    v_mul_f32 v55, v55, v49
    v_mul_f32 v56, v56, v49
    v_mul_f32 v57, v57, v49
    v_mul_f32 v58, v58, v49
    v_mul_f32 v59, v59, v49
    v_accvgpr_write_b32 a24, v52
    v_accvgpr_write_b32 a25, v53
    v_accvgpr_write_b32 a26, v54
    v_accvgpr_write_b32 a27, v55
    v_accvgpr_write_b32 a28, v56
    v_accvgpr_write_b32 a29, v57
    v_accvgpr_write_b32 a30, v58
    v_accvgpr_write_b32 a31, v59
    v_exp_f32 v52, v64
    v_exp_f32 v53, v65
    v_exp_f32 v54, v66
    v_exp_f32 v55, v67
    v_exp_f32 v56, v68
    v_exp_f32 v57, v69
    v_exp_f32 v58, v70
    v_exp_f32 v59, v71
    s_nop 0
    v_cvt_pk_bf16_f32 v128, v52, v53
    v_cvt_pk_bf16_f32 v129, v54, v55
    v_cvt_pk_bf16_f32 v130, v56, v57
    v_cvt_pk_bf16_f32 v131, v58, v59
    s_nop 1
    v_mfma_f32_16x16x32_bf16 v[28:31], v[44:47], v[128:131], 0
    v_max3_f32 v48, v72, v73, v74
    v_max3_f32 v48, v48, v75, v76
    v_max3_f32 v48, v48, v77, v78
    v_max3_f32 v48, v48, v79, 0
    v_mov_b32 v49, v48
    s_nop 1
    v_permlane32_swap_b32 v48, v49
    s_nop 1
    v_max_f32 v48, v48, v49
    v_mov_b32 v49, v48
    s_nop 1
    v_permlane16_swap_b32 v48, v49
    s_nop 1
    v_max_f32 v48, v48, v49
    v_exp_f32 v49, -v48
    v_sub_f32 v72, v72, v48
    v_sub_f32 v73, v73, v48
    v_sub_f32 v74, v74, v48
    v_sub_f32 v75, v75, v48
    v_sub_f32 v76, v76, v48
    v_sub_f32 v77, v77, v48
    v_sub_f32 v78, v78, v48
    v_sub_f32 v79, v79, v48
    v_sub_f32 v104, v104, v48
    v_sub_f32 v105, v105, v48
    v_sub_f32 v106, v106, v48
    v_sub_f32 v107, v107, v48
    v_sub_f32 v108, v108, v48
    v_sub_f32 v109, v109, v48
    v_sub_f32 v110, v110, v48
    v_sub_f32 v111, v111, v48
    v_sub_f32 v168, v168, v48
    v_sub_f32 v169, v169, v48
    v_sub_f32 v170, v170, v48
    v_sub_f32 v171, v171, v48
    v_sub_f32 v172, v172, v48
    v_sub_f32 v173, v173, v48
    v_sub_f32 v174, v174, v48
    v_sub_f32 v175, v175, v48
    v_mul_f32 v13, v13, v49
    v_accvgpr_read_b32 v52, a32
    v_accvgpr_read_b32 v53, a33
    v_accvgpr_read_b32 v54, a34
    v_accvgpr_read_b32 v55, a35
    v_accvgpr_read_b32 v56, a36
    v_accvgpr_read_b32 v57, a37
    v_accvgpr_read_b32 v58, a38
    v_accvgpr_read_b32 v59, a39
    v_mul_f32 v52, v52, v49
    v_mul_f32 v53, v53, v49
    v_mul_f32 v54, v54, v49
    v_mul_f32 v55, v55, v49
    v_mul_f32 v56, v56, v49
    v_mul_f32 v57, v57, v49
    v_mul_f32 v58, v58, v49
    v_mul_f32 v59, v59, v49
    v_accvgpr_write_b32 a32, v52
    v_accvgpr_write_b32 a33, v53
    v_accvgpr_write_b32 a34, v54
    v_accvgpr_write_b32 a35, v55
    v_accvgpr_write_b32 a36, v56
    v_accvgpr_write_b32 a37, v57
    v_accvgpr_write_b32 a38, v58
    v_accvgpr_write_b32 a39, v59
    v_accvgpr_read_b32 v52, a40
    v_accvgpr_read_b32 v53, a41
    v_accvgpr_read_b32 v54, a42
    v_accvgpr_read_b32 v55, a43
    v_accvgpr_read_b32 v56, a44
    v_accvgpr_read_b32 v57, a45
    v_accvgpr_read_b32 v58, a46
    v_accvgpr_read_b32 v59, a47
    v_mul_f32 v52, v52, v49
    v_mul_f32 v53, v53, v49
    v_mul_f32 v54, v54, v49
    v_mul_f32 v55, v55, v49
    v_mul_f32 v56, v56, v49
    v_mul_f32 v57, v57, v49
    v_mul_f32 v58, v58, v49
    v_mul_f32 v59, v59, v49
    v_accvgpr_write_b32 a40, v52
    v_accvgpr_write_b32 a41, v53
    v_accvgpr_write_b32 a42, v54
    v_accvgpr_write_b32 a43, v55
    v_accvgpr_write_b32 a44, v56
    v_accvgpr_write_b32 a45, v57
    v_accvgpr_write_b32 a46, v58
    v_accvgpr_write_b32 a47, v59
    v_accvgpr_read_b32 v52, a48
    v_accvgpr_read_b32 v53, a49
    v_accvgpr_read_b32 v54, a50
    v_accvgpr_read_b32 v55, a51
    v_accvgpr_read_b32 v56, a52
    v_accvgpr_read_b32 v57, a53
    v_accvgpr_read_b32 v58, a54
    v_accvgpr_read_b32 v59, a55
    v_mul_f32 v52, v52, v49
    v_mul_f32 v53, v53, v49
    v_mul_f32 v54, v54, v49
    v_mul_f32 v55, v55, v49
    v_mul_f32 v56, v56, v49
    v_mul_f32 v57, v57, v49
    v_mul_f32 v58, v58, v49
    v_mul_f32 v59, v59, v49
    v_accvgpr_write_b32 a48, v52
    v_accvgpr_write_b32 a49, v53
    v_accvgpr_write_b32 a50, v54
    v_accvgpr_write_b32 a51, v55
    v_accvgpr_write_b32 a52, v56
    v_accvgpr_write_b32 a53, v57
    v_accvgpr_write_b32 a54, v58
    v_accvgpr_write_b32 a55, v59
    v_accvgpr_read_b32 v52, a56
    v_accvgpr_read_b32 v53, a57
    v_accvgpr_read_b32 v54, a58
    v_accvgpr_read_b32 v55, a59
    v_accvgpr_read_b32 v56, a60
    v_accvgpr_read_b32 v57, a61
    v_accvgpr_read_b32 v58, a62
    v_accvgpr_read_b32 v59, a63
    v_mul_f32 v52, v52, v49
    v_mul_f32 v53, v53, v49
    v_mul_f32 v54, v54, v49
    v_mul_f32 v55, v55, v49
    v_mul_f32 v56, v56, v49
    v_mul_f32 v57, v57, v49
    v_mul_f32 v58, v58, v49
    v_mul_f32 v59, v59, v49
    v_accvgpr_write_b32 a56, v52
    v_accvgpr_write_b32 a57, v53
    v_accvgpr_write_b32 a58, v54
    v_accvgpr_write_b32 a59, v55
    v_accvgpr_write_b32 a60, v56
    v_accvgpr_write_b32 a61, v57
    v_accvgpr_write_b32 a62, v58
    v_accvgpr_write_b32 a63, v59
    v_exp_f32 v52, v72
    v_exp_f32 v53, v73
    v_exp_f32 v54, v74
    v_exp_f32 v55, v75
    v_exp_f32 v56, v76
    v_exp_f32 v57, v77
    v_exp_f32 v58, v78
    v_exp_f32 v59, v79
    s_nop 0
    v_cvt_pk_bf16_f32 v132, v52, v53
    v_cvt_pk_bf16_f32 v133, v54, v55
    v_cvt_pk_bf16_f32 v134, v56, v57
    v_cvt_pk_bf16_f32 v135, v58, v59
    s_nop 1
    v_mfma_f32_16x16x32_bf16 v[32:35], v[44:47], v[132:135], 0
    s_nop 7
    s_setpc_b64 s[74:75]
m_rs0488:
    s_nop 15
    v_max3_f32 v48, v64, v65, v66
    v_max3_f32 v48, v48, v67, v68
    v_max3_f32 v48, v48, v69, v70
    v_max3_f32 v48, v48, v71, 0
    v_mov_b32 v49, v48
    s_nop 1
    v_permlane32_swap_b32 v48, v49
    s_nop 1
    v_max_f32 v48, v48, v49
    v_mov_b32 v49, v48
    s_nop 1
    v_permlane16_swap_b32 v48, v49
    s_nop 1
    v_max_f32 v48, v48, v49
    v_exp_f32 v49, -v48
    v_sub_f32 v64, v64, v48
    v_sub_f32 v65, v65, v48
    v_sub_f32 v66, v66, v48
    v_sub_f32 v67, v67, v48
    v_sub_f32 v68, v68, v48
    v_sub_f32 v69, v69, v48
    v_sub_f32 v70, v70, v48
    v_sub_f32 v71, v71, v48
    v_sub_f32 v96, v96, v48
    v_sub_f32 v97, v97, v48
    v_sub_f32 v98, v98, v48
    v_sub_f32 v99, v99, v48
    v_sub_f32 v100, v100, v48
    v_sub_f32 v101, v101, v48
    v_sub_f32 v102, v102, v48
    v_sub_f32 v103, v103, v48
    v_sub_f32 v160, v160, v48
    v_sub_f32 v161, v161, v48
    v_sub_f32 v162, v162, v48
    v_sub_f32 v163, v163, v48
    v_sub_f32 v164, v164, v48
    v_sub_f32 v165, v165, v48
    v_sub_f32 v166, v166, v48
    v_sub_f32 v167, v167, v48
    v_mul_f32 v12, v12, v49
    v_accvgpr_read_b32 v52, a0
    v_accvgpr_read_b32 v53, a1
    v_accvgpr_read_b32 v54, a2
    v_accvgpr_read_b32 v55, a3
    v_accvgpr_read_b32 v56, a4
    v_accvgpr_read_b32 v57, a5
    v_accvgpr_read_b32 v58, a6
    v_accvgpr_read_b32 v59, a7
    v_mul_f32 v52, v52, v49
    v_mul_f32 v53, v53, v49
    v_mul_f32 v54, v54, v49
    v_mul_f32 v55, v55, v49
    v_mul_f32 v56, v56, v49
    v_mul_f32 v57, v57, v49
    v_mul_f32 v58, v58, v49
    v_mul_f32 v59, v59, v49
    v_accvgpr_write_b32 a0, v52
    v_accvgpr_write_b32 a1, v53
    v_accvgpr_write_b32 a2, v54
    v_accvgpr_write_b32 a3, v55
    v_accvgpr_write_b32 a4, v56
    v_accvgpr_write_b32 a5, v57
    v_accvgpr_write_b32 a6, v58
    v_accvgpr_write_b32 a7, v59
    v_accvgpr_read_b32 v52, a8
    v_accvgpr_read_b32 v53, a9
    v_accvgpr_read_b32 v54, a10
    v_accvgpr_read_b32 v55, a11
    v_accvgpr_read_b32 v56, a12
    v_accvgpr_read_b32 v57, a13
    v_accvgpr_read_b32 v58, a14
    v_accvgpr_read_b32 v59, a15
    v_mul_f32 v52, v52, v49
    v_mul_f32 v53, v53, v49
    v_mul_f32 v54, v54, v49
    v_mul_f32 v55, v55, v49
    v_mul_f32 v56, v56, v49
    v_mul_f32 v57, v57, v49
    v_mul_f32 v58, v58, v49
    v_mul_f32 v59, v59, v49
    v_accvgpr_write_b32 a8, v52
    v_accvgpr_write_b32 a9, v53
    v_accvgpr_write_b32 a10, v54
    v_accvgpr_write_b32 a11, v55
    v_accvgpr_write_b32 a12, v56
    v_accvgpr_write_b32 a13, v57
    v_accvgpr_write_b32 a14, v58
    v_accvgpr_write_b32 a15, v59
    v_accvgpr_read_b32 v52, a16
    v_accvgpr_read_b32 v53, a17
    v_accvgpr_read_b32 v54, a18
    v_accvgpr_read_b32 v55, a19
    v_accvgpr_read_b32 v56, a20
    v_accvgpr_read_b32 v57, a21
    v_accvgpr_read_b32 v58, a22
    v_accvgpr_read_b32 v59, a23
    v_mul_f32 v52, v52, v49
    v_mul_f32 v53, v53, v49
    v_mul_f32 v54, v54, v49
    v_mul_f32 v55, v55, v49
    v_mul_f32 v56, v56, v49
    v_mul_f32 v57, v57, v49
    v_mul_f32 v58, v58, v49
    v_mul_f32 v59, v59, v49
    v_accvgpr_write_b32 a16, v52
    v_accvgpr_write_b32 a17, v53
    v_accvgpr_write_b32 a18, v54
    v_accvgpr_write_b32 a19, v55
    v_accvgpr_write_b32 a20, v56
    v_accvgpr_write_b32 a21, v57
    v_accvgpr_write_b32 a22, v58
    v_accvgpr_write_b32 a23, v59
    v_accvgpr_read_b32 v52, a24
    v_accvgpr_read_b32 v53, a25
    v_accvgpr_read_b32 v54, a26
    v_accvgpr_read_b32 v55, a27
    v_accvgpr_read_b32 v56, a28
    v_accvgpr_read_b32 v57, a29
    v_accvgpr_read_b32 v58, a30
    v_accvgpr_read_b32 v59, a31
    v_mul_f32 v52, v52, v49
    v_mul_f32 v53, v53, v49
    v_mul_f32 v54, v54, v49
    v_mul_f32 v55, v55, v49
    v_mul_f32 v56, v56, v49
    v_mul_f32 v57, v57, v49
    v_mul_f32 v58, v58, v49
    v_mul_f32 v59, v59, v49
    v_accvgpr_write_b32 a24, v52
    v_accvgpr_write_b32 a25, v53
    v_accvgpr_write_b32 a26, v54
    v_accvgpr_write_b32 a27, v55
    v_accvgpr_write_b32 a28, v56
    v_accvgpr_write_b32 a29, v57
    v_accvgpr_write_b32 a30, v58
    v_accvgpr_write_b32 a31, v59
    v_exp_f32 v52, v64
    v_exp_f32 v53, v65
    v_exp_f32 v54, v66
    v_exp_f32 v55, v67
    v_exp_f32 v56, v68
    v_exp_f32 v57, v69
    v_exp_f32 v58, v70
    v_exp_f32 v59, v71
    s_nop 0
    v_cvt_pk_bf16_f32 v128, v52, v53
    v_cvt_pk_bf16_f32 v129, v54, v55
    v_cvt_pk_bf16_f32 v130, v56, v57
    v_cvt_pk_bf16_f32 v131, v58, v59
    s_nop 1
    v_mfma_f32_16x16x32_bf16 v[28:31], v[44:47], v[128:131], 0
    v_max3_f32 v48, v72, v73, v74
    v_max3_f32 v48, v48, v75, v76
    v_max3_f32 v48, v48, v77, v78
    v_max3_f32 v48, v48, v79, 0
    v_mov_b32 v49, v48
    s_nop 1
    v_permlane32_swap_b32 v48, v49
    s_nop 1
    v_max_f32 v48, v48, v49
    v_mov_b32 v49, v48
    s_nop 1
    v_permlane16_swap_b32 v48, v49
    s_nop 1
    v_max_f32 v48, v48, v49
    v_exp_f32 v49, -v48
    v_sub_f32 v72, v72, v48
    v_sub_f32 v73, v73, v48
    v_sub_f32 v74, v74, v48
    v_sub_f32 v75, v75, v48
    v_sub_f32 v76, v76, v48
    v_sub_f32 v77, v77, v48
    v_sub_f32 v78, v78, v48
    v_sub_f32 v79, v79, v48
    v_sub_f32 v104, v104, v48
    v_sub_f32 v105, v105, v48
    v_sub_f32 v106, v106, v48
    v_sub_f32 v107, v107, v48
    v_sub_f32 v108, v108, v48
    v_sub_f32 v109, v109, v48
    v_sub_f32 v110, v110, v48
    v_sub_f32 v111, v111, v48
    v_sub_f32 v168, v168, v48
    v_sub_f32 v169, v169, v48
    v_sub_f32 v170, v170, v48
    v_sub_f32 v171, v171, v48
    v_sub_f32 v172, v172, v48
    v_sub_f32 v173, v173, v48
    v_sub_f32 v174, v174, v48
    v_sub_f32 v175, v175, v48
    v_mul_f32 v13, v13, v49
    v_accvgpr_read_b32 v52, a32
    v_accvgpr_read_b32 v53, a33
    v_accvgpr_read_b32 v54, a34
    v_accvgpr_read_b32 v55, a35
    v_accvgpr_read_b32 v56, a36
    v_accvgpr_read_b32 v57, a37
    v_accvgpr_read_b32 v58, a38
    v_accvgpr_read_b32 v59, a39
    v_mul_f32 v52, v52, v49
    v_mul_f32 v53, v53, v49
    v_mul_f32 v54, v54, v49
    v_mul_f32 v55, v55, v49
    v_mul_f32 v56, v56, v49
    v_mul_f32 v57, v57, v49
    v_mul_f32 v58, v58, v49
    v_mul_f32 v59, v59, v49
    v_accvgpr_write_b32 a32, v52
    v_accvgpr_write_b32 a33, v53
    v_accvgpr_write_b32 a34, v54
    v_accvgpr_write_b32 a35, v55
    v_accvgpr_write_b32 a36, v56
    v_accvgpr_write_b32 a37, v57
    v_accvgpr_write_b32 a38, v58
    v_accvgpr_write_b32 a39, v59
    v_accvgpr_read_b32 v52, a40
    v_accvgpr_read_b32 v53, a41
    v_accvgpr_read_b32 v54, a42
    v_accvgpr_read_b32 v55, a43
    v_accvgpr_read_b32 v56, a44
    v_accvgpr_read_b32 v57, a45
    v_accvgpr_read_b32 v58, a46
    v_accvgpr_read_b32 v59, a47
    v_mul_f32 v52, v52, v49
    v_mul_f32 v53, v53, v49
    v_mul_f32 v54, v54, v49
    v_mul_f32 v55, v55, v49
    v_mul_f32 v56, v56, v49
    v_mul_f32 v57, v57, v49
    v_mul_f32 v58, v58, v49
    v_mul_f32 v59, v59, v49
    v_accvgpr_write_b32 a40, v52
    v_accvgpr_write_b32 a41, v53
    v_accvgpr_write_b32 a42, v54
    v_accvgpr_write_b32 a43, v55
    v_accvgpr_write_b32 a44, v56
    v_accvgpr_write_b32 a45, v57
    v_accvgpr_write_b32 a46, v58
    v_accvgpr_write_b32 a47, v59
    v_accvgpr_read_b32 v52, a48
    v_accvgpr_read_b32 v53, a49
    v_accvgpr_read_b32 v54, a50
    v_accvgpr_read_b32 v55, a51
    v_accvgpr_read_b32 v56, a52
    v_accvgpr_read_b32 v57, a53
    v_accvgpr_read_b32 v58, a54
    v_accvgpr_read_b32 v59, a55
    v_mul_f32 v52, v52, v49
    v_mul_f32 v53, v53, v49
    v_mul_f32 v54, v54, v49
    v_mul_f32 v55, v55, v49
    v_mul_f32 v56, v56, v49
    v_mul_f32 v57, v57, v49
    v_mul_f32 v58, v58, v49
    v_mul_f32 v59, v59, v49
    v_accvgpr_write_b32 a48, v52
    v_accvgpr_write_b32 a49, v53
    v_accvgpr_write_b32 a50, v54
    v_accvgpr_write_b32 a51, v55
    v_accvgpr_write_b32 a52, v56
    v_accvgpr_write_b32 a53, v57
    v_accvgpr_write_b32 a54, v58
    v_accvgpr_write_b32 a55, v59
    v_accvgpr_read_b32 v52, a56
    v_accvgpr_read_b32 v53, a57
    v_accvgpr_read_b32 v54, a58
    v_accvgpr_read_b32 v55, a59
    v_accvgpr_read_b32 v56, a60
    v_accvgpr_read_b32 v57, a61
    v_accvgpr_read_b32 v58, a62
    v_accvgpr_read_b32 v59, a63
    v_mul_f32 v52, v52, v49
    v_mul_f32 v53, v53, v49
    v_mul_f32 v54, v54, v49
    v_mul_f32 v55, v55, v49
    v_mul_f32 v56, v56, v49
    v_mul_f32 v57, v57, v49
    v_mul_f32 v58, v58, v49
    v_mul_f32 v59, v59, v49
    v_accvgpr_write_b32 a56, v52
    v_accvgpr_write_b32 a57, v53
    v_accvgpr_write_b32 a58, v54
    v_accvgpr_write_b32 a59, v55
    v_accvgpr_write_b32 a60, v56
    v_accvgpr_write_b32 a61, v57
    v_accvgpr_write_b32 a62, v58
    v_accvgpr_write_b32 a63, v59
    v_exp_f32 v52, v72
    v_exp_f32 v53, v73
    v_exp_f32 v54, v74
    v_exp_f32 v55, v75
    v_exp_f32 v56, v76
    v_exp_f32 v57, v77
    v_exp_f32 v58, v78
    v_exp_f32 v59, v79
    s_nop 0
    v_cvt_pk_bf16_f32 v132, v52, v53
    v_cvt_pk_bf16_f32 v133, v54, v55
    v_cvt_pk_bf16_f32 v134, v56, v57
    v_cvt_pk_bf16_f32 v135, v58, v59
    s_nop 1
    v_mfma_f32_16x16x32_bf16 v[32:35], v[44:47], v[132:135], 0
    v_max3_f32 v48, v80, v81, v82
    v_max3_f32 v48, v48, v83, v84
    v_max3_f32 v48, v48, v85, v86
    v_max3_f32 v48, v48, v87, 0
    v_mov_b32 v49, v48
    s_nop 1
    v_permlane32_swap_b32 v48, v49
    s_nop 1
    v_max_f32 v48, v48, v49
    v_mov_b32 v49, v48
    s_nop 1
    v_permlane16_swap_b32 v48, v49
    s_nop 1
    v_max_f32 v48, v48, v49
    v_exp_f32 v49, -v48
    v_sub_f32 v80, v80, v48
    v_sub_f32 v81, v81, v48
    v_sub_f32 v82, v82, v48
    v_sub_f32 v83, v83, v48
    v_sub_f32 v84, v84, v48
    v_sub_f32 v85, v85, v48
    v_sub_f32 v86, v86, v48
    v_sub_f32 v87, v87, v48
    v_sub_f32 v112, v112, v48
    v_sub_f32 v113, v113, v48
    v_sub_f32 v114, v114, v48
    v_sub_f32 v115, v115, v48
    v_sub_f32 v116, v116, v48
    v_sub_f32 v117, v117, v48
    v_sub_f32 v118, v118, v48
    v_sub_f32 v119, v119, v48
    v_sub_f32 v176, v176, v48
    v_sub_f32 v177, v177, v48
    v_sub_f32 v178, v178, v48
    v_sub_f32 v179, v179, v48
    v_sub_f32 v180, v180, v48
    v_sub_f32 v181, v181, v48
    v_sub_f32 v182, v182, v48
    v_sub_f32 v183, v183, v48
    v_mul_f32 v14, v14, v49
    v_accvgpr_read_b32 v52, a64
    v_accvgpr_read_b32 v53, a65
    v_accvgpr_read_b32 v54, a66
    v_accvgpr_read_b32 v55, a67
    v_accvgpr_read_b32 v56, a68
    v_accvgpr_read_b32 v57, a69
    v_accvgpr_read_b32 v58, a70
    v_accvgpr_read_b32 v59, a71
    v_mul_f32 v52, v52, v49
    v_mul_f32 v53, v53, v49
    v_mul_f32 v54, v54, v49
    v_mul_f32 v55, v55, v49
    v_mul_f32 v56, v56, v49
    v_mul_f32 v57, v57, v49
    v_mul_f32 v58, v58, v49
    v_mul_f32 v59, v59, v49
    v_accvgpr_write_b32 a64, v52
    v_accvgpr_write_b32 a65, v53
    v_accvgpr_write_b32 a66, v54
    v_accvgpr_write_b32 a67, v55
    v_accvgpr_write_b32 a68, v56
    v_accvgpr_write_b32 a69, v57
    v_accvgpr_write_b32 a70, v58
    v_accvgpr_write_b32 a71, v59
    v_accvgpr_read_b32 v52, a72
    v_accvgpr_read_b32 v53, a73
    v_accvgpr_read_b32 v54, a74
    v_accvgpr_read_b32 v55, a75
    v_accvgpr_read_b32 v56, a76
    v_accvgpr_read_b32 v57, a77
    v_accvgpr_read_b32 v58, a78
    v_accvgpr_read_b32 v59, a79
    v_mul_f32 v52, v52, v49
    v_mul_f32 v53, v53, v49
    v_mul_f32 v54, v54, v49
    v_mul_f32 v55, v55, v49
    v_mul_f32 v56, v56, v49
    v_mul_f32 v57, v57, v49
    v_mul_f32 v58, v58, v49
    v_mul_f32 v59, v59, v49
    v_accvgpr_write_b32 a72, v52
    v_accvgpr_write_b32 a73, v53
    v_accvgpr_write_b32 a74, v54
    v_accvgpr_write_b32 a75, v55
    v_accvgpr_write_b32 a76, v56
    v_accvgpr_write_b32 a77, v57
    v_accvgpr_write_b32 a78, v58
    v_accvgpr_write_b32 a79, v59
    v_accvgpr_read_b32 v52, a80
    v_accvgpr_read_b32 v53, a81
    v_accvgpr_read_b32 v54, a82
    v_accvgpr_read_b32 v55, a83
    v_accvgpr_read_b32 v56, a84
    v_accvgpr_read_b32 v57, a85
    v_accvgpr_read_b32 v58, a86
    v_accvgpr_read_b32 v59, a87
    v_mul_f32 v52, v52, v49
    v_mul_f32 v53, v53, v49
    v_mul_f32 v54, v54, v49
    v_mul_f32 v55, v55, v49
    v_mul_f32 v56, v56, v49
    v_mul_f32 v57, v57, v49
    v_mul_f32 v58, v58, v49
    v_mul_f32 v59, v59, v49
    v_accvgpr_write_b32 a80, v52
    v_accvgpr_write_b32 a81, v53
    v_accvgpr_write_b32 a82, v54
    v_accvgpr_write_b32 a83, v55
    v_accvgpr_write_b32 a84, v56
    v_accvgpr_write_b32 a85, v57
    v_accvgpr_write_b32 a86, v58
    v_accvgpr_write_b32 a87, v59
    v_accvgpr_read_b32 v52, a88
    v_accvgpr_read_b32 v53, a89
    v_accvgpr_read_b32 v54, a90
    v_accvgpr_read_b32 v55, a91
    v_accvgpr_read_b32 v56, a92
    v_accvgpr_read_b32 v57, a93
    v_accvgpr_read_b32 v58, a94
    v_accvgpr_read_b32 v59, a95
    v_mul_f32 v52, v52, v49
    v_mul_f32 v53, v53, v49
    v_mul_f32 v54, v54, v49
    v_mul_f32 v55, v55, v49
    v_mul_f32 v56, v56, v49
    v_mul_f32 v57, v57, v49
    v_mul_f32 v58, v58, v49
    v_mul_f32 v59, v59, v49
    v_accvgpr_write_b32 a88, v52
    v_accvgpr_write_b32 a89, v53
    v_accvgpr_write_b32 a90, v54
    v_accvgpr_write_b32 a91, v55
    v_accvgpr_write_b32 a92, v56
    v_accvgpr_write_b32 a93, v57
    v_accvgpr_write_b32 a94, v58
    v_accvgpr_write_b32 a95, v59
    v_exp_f32 v52, v80
    v_exp_f32 v53, v81
    v_exp_f32 v54, v82
    v_exp_f32 v55, v83
    v_exp_f32 v56, v84
    v_exp_f32 v57, v85
    v_exp_f32 v58, v86
    v_exp_f32 v59, v87
    s_nop 0
    v_cvt_pk_bf16_f32 v136, v52, v53
    v_cvt_pk_bf16_f32 v137, v54, v55
    v_cvt_pk_bf16_f32 v138, v56, v57
    v_cvt_pk_bf16_f32 v139, v58, v59
    s_nop 1
    v_mfma_f32_16x16x32_bf16 v[36:39], v[44:47], v[136:139], 0
    v_max3_f32 v48, v88, v89, v90
    v_max3_f32 v48, v48, v91, v92
    v_max3_f32 v48, v48, v93, v94
    v_max3_f32 v48, v48, v95, 0
    v_mov_b32 v49, v48
    s_nop 1
    v_permlane32_swap_b32 v48, v49
    s_nop 1
    v_max_f32 v48, v48, v49
    v_mov_b32 v49, v48
    s_nop 1
    v_permlane16_swap_b32 v48, v49
    s_nop 1
    v_max_f32 v48, v48, v49
    v_exp_f32 v49, -v48
    v_sub_f32 v88, v88, v48
    v_sub_f32 v89, v89, v48
    v_sub_f32 v90, v90, v48
    v_sub_f32 v91, v91, v48
    v_sub_f32 v92, v92, v48
    v_sub_f32 v93, v93, v48
    v_sub_f32 v94, v94, v48
    v_sub_f32 v95, v95, v48
    v_sub_f32 v120, v120, v48
    v_sub_f32 v121, v121, v48
    v_sub_f32 v122, v122, v48
    v_sub_f32 v123, v123, v48
    v_sub_f32 v124, v124, v48
    v_sub_f32 v125, v125, v48
    v_sub_f32 v126, v126, v48
    v_sub_f32 v127, v127, v48
    v_sub_f32 v184, v184, v48
    v_sub_f32 v185, v185, v48
    v_sub_f32 v186, v186, v48
    v_sub_f32 v187, v187, v48
    v_sub_f32 v188, v188, v48
    v_sub_f32 v189, v189, v48
    v_sub_f32 v190, v190, v48
    v_sub_f32 v191, v191, v48
    v_mul_f32 v15, v15, v49
    v_accvgpr_read_b32 v52, a96
    v_accvgpr_read_b32 v53, a97
    v_accvgpr_read_b32 v54, a98
    v_accvgpr_read_b32 v55, a99
    v_accvgpr_read_b32 v56, a100
    v_accvgpr_read_b32 v57, a101
    v_accvgpr_read_b32 v58, a102
    v_accvgpr_read_b32 v59, a103
    v_mul_f32 v52, v52, v49
    v_mul_f32 v53, v53, v49
    v_mul_f32 v54, v54, v49
    v_mul_f32 v55, v55, v49
    v_mul_f32 v56, v56, v49
    v_mul_f32 v57, v57, v49
    v_mul_f32 v58, v58, v49
    v_mul_f32 v59, v59, v49
    v_accvgpr_write_b32 a96, v52
    v_accvgpr_write_b32 a97, v53
    v_accvgpr_write_b32 a98, v54
    v_accvgpr_write_b32 a99, v55
    v_accvgpr_write_b32 a100, v56
    v_accvgpr_write_b32 a101, v57
    v_accvgpr_write_b32 a102, v58
    v_accvgpr_write_b32 a103, v59
    v_accvgpr_read_b32 v52, a104
    v_accvgpr_read_b32 v53, a105
    v_accvgpr_read_b32 v54, a106
    v_accvgpr_read_b32 v55, a107
    v_accvgpr_read_b32 v56, a108
    v_accvgpr_read_b32 v57, a109
    v_accvgpr_read_b32 v58, a110
    v_accvgpr_read_b32 v59, a111
    v_mul_f32 v52, v52, v49
    v_mul_f32 v53, v53, v49
    v_mul_f32 v54, v54, v49
    v_mul_f32 v55, v55, v49
    v_mul_f32 v56, v56, v49
    v_mul_f32 v57, v57, v49
    v_mul_f32 v58, v58, v49
    v_mul_f32 v59, v59, v49
    v_accvgpr_write_b32 a104, v52
    v_accvgpr_write_b32 a105, v53
    v_accvgpr_write_b32 a106, v54
    v_accvgpr_write_b32 a107, v55
    v_accvgpr_write_b32 a108, v56
    v_accvgpr_write_b32 a109, v57
    v_accvgpr_write_b32 a110, v58
    v_accvgpr_write_b32 a111, v59
    v_accvgpr_read_b32 v52, a112
    v_accvgpr_read_b32 v53, a113
    v_accvgpr_read_b32 v54, a114
    v_accvgpr_read_b32 v55, a115
    v_accvgpr_read_b32 v56, a116
    v_accvgpr_read_b32 v57, a117
    v_accvgpr_read_b32 v58, a118
    v_accvgpr_read_b32 v59, a119
    v_mul_f32 v52, v52, v49
    v_mul_f32 v53, v53, v49
    v_mul_f32 v54, v54, v49
    v_mul_f32 v55, v55, v49
    v_mul_f32 v56, v56, v49
    v_mul_f32 v57, v57, v49
    v_mul_f32 v58, v58, v49
    v_mul_f32 v59, v59, v49
    v_accvgpr_write_b32 a112, v52
    v_accvgpr_write_b32 a113, v53
    v_accvgpr_write_b32 a114, v54
    v_accvgpr_write_b32 a115, v55
    v_accvgpr_write_b32 a116, v56
    v_accvgpr_write_b32 a117, v57
    v_accvgpr_write_b32 a118, v58
    v_accvgpr_write_b32 a119, v59
    v_accvgpr_read_b32 v52, a120
    v_accvgpr_read_b32 v53, a121
    v_accvgpr_read_b32 v54, a122
    v_accvgpr_read_b32 v55, a123
    v_accvgpr_read_b32 v56, a124
    v_accvgpr_read_b32 v57, a125
    v_accvgpr_read_b32 v58, a126
    v_accvgpr_read_b32 v59, a127
    v_mul_f32 v52, v52, v49
    v_mul_f32 v53, v53, v49
    v_mul_f32 v54, v54, v49
    v_mul_f32 v55, v55, v49
    v_mul_f32 v56, v56, v49
    v_mul_f32 v57, v57, v49
    v_mul_f32 v58, v58, v49
    v_mul_f32 v59, v59, v49
    v_accvgpr_write_b32 a120, v52
    v_accvgpr_write_b32 a121, v53
    v_accvgpr_write_b32 a122, v54
    v_accvgpr_write_b32 a123, v55
    v_accvgpr_write_b32 a124, v56
    v_accvgpr_write_b32 a125, v57
    v_accvgpr_write_b32 a126, v58
    v_accvgpr_write_b32 a127, v59
    v_exp_f32 v52, v88
    v_exp_f32 v53, v89
    v_exp_f32 v54, v90
    v_exp_f32 v55, v91
    v_exp_f32 v56, v92
    v_exp_f32 v57, v93
    v_exp_f32 v58, v94
    v_exp_f32 v59, v95
    s_nop 0
    v_cvt_pk_bf16_f32 v140, v52, v53
    v_cvt_pk_bf16_f32 v141, v54, v55
    v_cvt_pk_bf16_f32 v142, v56, v57
    v_cvt_pk_bf16_f32 v143, v58, v59
    s_nop 1
    v_mfma_f32_16x16x32_bf16 v[40:43], v[44:47], v[140:143], 0
    s_nop 7
    s_setpc_b64 s[74:75]
m_rs1289:
    s_nop 15
    v_max3_f32 v48, v96, v97, v98
    v_max3_f32 v48, v48, v99, v100
    v_max3_f32 v48, v48, v101, v102
    v_max3_f32 v48, v48, v103, 0
    v_mov_b32 v49, v48
    s_nop 1
    v_permlane32_swap_b32 v48, v49
    s_nop 1
    v_max_f32 v48, v48, v49
    v_mov_b32 v49, v48
    s_nop 1
    v_permlane16_swap_b32 v48, v49
    s_nop 1
    v_max_f32 v48, v48, v49
    v_exp_f32 v49, -v48
    v_sub_f32 v96, v96, v48
    v_sub_f32 v97, v97, v48
    v_sub_f32 v98, v98, v48
    v_sub_f32 v99, v99, v48
    v_sub_f32 v100, v100, v48
    v_sub_f32 v101, v101, v48
    v_sub_f32 v102, v102, v48
    v_sub_f32 v103, v103, v48
    v_sub_f32 v64, v64, v48
    v_sub_f32 v65, v65, v48
    v_sub_f32 v66, v66, v48
    v_sub_f32 v67, v67, v48
    v_sub_f32 v68, v68, v48
    v_sub_f32 v69, v69, v48
    v_sub_f32 v70, v70, v48
    v_sub_f32 v71, v71, v48
    v_sub_f32 v160, v160, v48
    v_sub_f32 v161, v161, v48
    v_sub_f32 v162, v162, v48
    v_sub_f32 v163, v163, v48
    v_sub_f32 v164, v164, v48
    v_sub_f32 v165, v165, v48
    v_sub_f32 v166, v166, v48
    v_sub_f32 v167, v167, v48
    v_mul_f32 v12, v12, v49
    v_accvgpr_read_b32 v52, a0
    v_accvgpr_read_b32 v53, a1
    v_accvgpr_read_b32 v54, a2
    v_accvgpr_read_b32 v55, a3
    v_accvgpr_read_b32 v56, a4
    v_accvgpr_read_b32 v57, a5
    v_accvgpr_read_b32 v58, a6
    v_accvgpr_read_b32 v59, a7
    v_mul_f32 v52, v52, v49
    v_mul_f32 v53, v53, v49
    v_mul_f32 v54, v54, v49
    v_mul_f32 v55, v55, v49
    v_mul_f32 v56, v56, v49
    v_mul_f32 v57, v57, v49
    v_mul_f32 v58, v58, v49
    v_mul_f32 v59, v59, v49
    v_accvgpr_write_b32 a0, v52
    v_accvgpr_write_b32 a1, v53
    v_accvgpr_write_b32 a2, v54
    v_accvgpr_write_b32 a3, v55
    v_accvgpr_write_b32 a4, v56
    v_accvgpr_write_b32 a5, v57
    v_accvgpr_write_b32 a6, v58
    v_accvgpr_write_b32 a7, v59
    v_accvgpr_read_b32 v52, a8
    v_accvgpr_read_b32 v53, a9
    v_accvgpr_read_b32 v54, a10
    v_accvgpr_read_b32 v55, a11
    v_accvgpr_read_b32 v56, a12
    v_accvgpr_read_b32 v57, a13
    v_accvgpr_read_b32 v58, a14
    v_accvgpr_read_b32 v59, a15
    v_mul_f32 v52, v52, v49
    v_mul_f32 v53, v53, v49
    v_mul_f32 v54, v54, v49
    v_mul_f32 v55, v55, v49
    v_mul_f32 v56, v56, v49
    v_mul_f32 v57, v57, v49
    v_mul_f32 v58, v58, v49
    v_mul_f32 v59, v59, v49
    v_accvgpr_write_b32 a8, v52
    v_accvgpr_write_b32 a9, v53
    v_accvgpr_write_b32 a10, v54
    v_accvgpr_write_b32 a11, v55
    v_accvgpr_write_b32 a12, v56
    v_accvgpr_write_b32 a13, v57
    v_accvgpr_write_b32 a14, v58
    v_accvgpr_write_b32 a15, v59
    v_accvgpr_read_b32 v52, a16
    v_accvgpr_read_b32 v53, a17
    v_accvgpr_read_b32 v54, a18
    v_accvgpr_read_b32 v55, a19
    v_accvgpr_read_b32 v56, a20
    v_accvgpr_read_b32 v57, a21
    v_accvgpr_read_b32 v58, a22
    v_accvgpr_read_b32 v59, a23
    v_mul_f32 v52, v52, v49
    v_mul_f32 v53, v53, v49
    v_mul_f32 v54, v54, v49
    v_mul_f32 v55, v55, v49
    v_mul_f32 v56, v56, v49
    v_mul_f32 v57, v57, v49
    v_mul_f32 v58, v58, v49
    v_mul_f32 v59, v59, v49
    v_accvgpr_write_b32 a16, v52
    v_accvgpr_write_b32 a17, v53
    v_accvgpr_write_b32 a18, v54
    v_accvgpr_write_b32 a19, v55
    v_accvgpr_write_b32 a20, v56
    v_accvgpr_write_b32 a21, v57
    v_accvgpr_write_b32 a22, v58
    v_accvgpr_write_b32 a23, v59
    v_accvgpr_read_b32 v52, a24
    v_accvgpr_read_b32 v53, a25
    v_accvgpr_read_b32 v54, a26
    v_accvgpr_read_b32 v55, a27
    v_accvgpr_read_b32 v56, a28
    v_accvgpr_read_b32 v57, a29
    v_accvgpr_read_b32 v58, a30
    v_accvgpr_read_b32 v59, a31
    v_mul_f32 v52, v52, v49
    v_mul_f32 v53, v53, v49
    v_mul_f32 v54, v54, v49
    v_mul_f32 v55, v55, v49
    v_mul_f32 v56, v56, v49
    v_mul_f32 v57, v57, v49
    v_mul_f32 v58, v58, v49
    v_mul_f32 v59, v59, v49
    v_accvgpr_write_b32 a24, v52
    v_accvgpr_write_b32 a25, v53
    v_accvgpr_write_b32 a26, v54
    v_accvgpr_write_b32 a27, v55
    v_accvgpr_write_b32 a28, v56
    v_accvgpr_write_b32 a29, v57
    v_accvgpr_write_b32 a30, v58
    v_accvgpr_write_b32 a31, v59
    v_exp_f32 v52, v96
    v_exp_f32 v53, v97
    v_exp_f32 v54, v98
    v_exp_f32 v55, v99
    v_exp_f32 v56, v100
    v_exp_f32 v57, v101
    v_exp_f32 v58, v102
    v_exp_f32 v59, v103
    s_nop 0
    v_cvt_pk_bf16_f32 v144, v52, v53
    v_cvt_pk_bf16_f32 v145, v54, v55
    v_cvt_pk_bf16_f32 v146, v56, v57
    v_cvt_pk_bf16_f32 v147, v58, v59
    s_nop 1
    v_mfma_f32_16x16x32_bf16 v[28:31], v[44:47], v[144:147], 0
    v_max3_f32 v48, v104, v105, v106
    v_max3_f32 v48, v48, v107, v108
    v_max3_f32 v48, v48, v109, v110
    v_max3_f32 v48, v48, v111, 0
    v_mov_b32 v49, v48
    s_nop 1
    v_permlane32_swap_b32 v48, v49
    s_nop 1
    v_max_f32 v48, v48, v49
    v_mov_b32 v49, v48
    s_nop 1
    v_permlane16_swap_b32 v48, v49
    s_nop 1
    v_max_f32 v48, v48, v49
    v_exp_f32 v49, -v48
    v_sub_f32 v104, v104, v48
    v_sub_f32 v105, v105, v48
    v_sub_f32 v106, v106, v48
    v_sub_f32 v107, v107, v48
    v_sub_f32 v108, v108, v48
    v_sub_f32 v109, v109, v48
    v_sub_f32 v110, v110, v48
    v_sub_f32 v111, v111, v48
    v_sub_f32 v72, v72, v48
    v_sub_f32 v73, v73, v48
    v_sub_f32 v74, v74, v48
    v_sub_f32 v75, v75, v48
    v_sub_f32 v76, v76, v48
    v_sub_f32 v77, v77, v48
    v_sub_f32 v78, v78, v48
    v_sub_f32 v79, v79, v48
    v_sub_f32 v168, v168, v48
    v_sub_f32 v169, v169, v48
    v_sub_f32 v170, v170, v48
    v_sub_f32 v171, v171, v48
    v_sub_f32 v172, v172, v48
    v_sub_f32 v173, v173, v48
    v_sub_f32 v174, v174, v48
    v_sub_f32 v175, v175, v48
    v_mul_f32 v13, v13, v49
    v_accvgpr_read_b32 v52, a32
    v_accvgpr_read_b32 v53, a33
    v_accvgpr_read_b32 v54, a34
    v_accvgpr_read_b32 v55, a35
    v_accvgpr_read_b32 v56, a36
    v_accvgpr_read_b32 v57, a37
    v_accvgpr_read_b32 v58, a38
    v_accvgpr_read_b32 v59, a39
    v_mul_f32 v52, v52, v49
    v_mul_f32 v53, v53, v49
    v_mul_f32 v54, v54, v49
    v_mul_f32 v55, v55, v49
    v_mul_f32 v56, v56, v49
    v_mul_f32 v57, v57, v49
    v_mul_f32 v58, v58, v49
    v_mul_f32 v59, v59, v49
    v_accvgpr_write_b32 a32, v52
    v_accvgpr_write_b32 a33, v53
    v_accvgpr_write_b32 a34, v54
    v_accvgpr_write_b32 a35, v55
    v_accvgpr_write_b32 a36, v56
    v_accvgpr_write_b32 a37, v57
    v_accvgpr_write_b32 a38, v58
    v_accvgpr_write_b32 a39, v59
    v_accvgpr_read_b32 v52, a40
    v_accvgpr_read_b32 v53, a41
    v_accvgpr_read_b32 v54, a42
    v_accvgpr_read_b32 v55, a43
    v_accvgpr_read_b32 v56, a44
    v_accvgpr_read_b32 v57, a45
    v_accvgpr_read_b32 v58, a46
    v_accvgpr_read_b32 v59, a47
    v_mul_f32 v52, v52, v49
    v_mul_f32 v53, v53, v49
    v_mul_f32 v54, v54, v49
    v_mul_f32 v55, v55, v49
    v_mul_f32 v56, v56, v49
    v_mul_f32 v57, v57, v49
    v_mul_f32 v58, v58, v49
    v_mul_f32 v59, v59, v49
    v_accvgpr_write_b32 a40, v52
    v_accvgpr_write_b32 a41, v53
    v_accvgpr_write_b32 a42, v54
    v_accvgpr_write_b32 a43, v55
    v_accvgpr_write_b32 a44, v56
    v_accvgpr_write_b32 a45, v57
    v_accvgpr_write_b32 a46, v58
    v_accvgpr_write_b32 a47, v59
    v_accvgpr_read_b32 v52, a48
    v_accvgpr_read_b32 v53, a49
    v_accvgpr_read_b32 v54, a50
    v_accvgpr_read_b32 v55, a51
    v_accvgpr_read_b32 v56, a52
    v_accvgpr_read_b32 v57, a53
    v_accvgpr_read_b32 v58, a54
    v_accvgpr_read_b32 v59, a55
    v_mul_f32 v52, v52, v49
    v_mul_f32 v53, v53, v49
    v_mul_f32 v54, v54, v49
    v_mul_f32 v55, v55, v49
    v_mul_f32 v56, v56, v49
    v_mul_f32 v57, v57, v49
    v_mul_f32 v58, v58, v49
    v_mul_f32 v59, v59, v49
    v_accvgpr_write_b32 a48, v52
    v_accvgpr_write_b32 a49, v53
    v_accvgpr_write_b32 a50, v54
    v_accvgpr_write_b32 a51, v55
    v_accvgpr_write_b32 a52, v56
    v_accvgpr_write_b32 a53, v57
    v_accvgpr_write_b32 a54, v58
    v_accvgpr_write_b32 a55, v59
    v_accvgpr_read_b32 v52, a56
    v_accvgpr_read_b32 v53, a57
    v_accvgpr_read_b32 v54, a58
    v_accvgpr_read_b32 v55, a59
    v_accvgpr_read_b32 v56, a60
    v_accvgpr_read_b32 v57, a61
    v_accvgpr_read_b32 v58, a62
    v_accvgpr_read_b32 v59, a63
    v_mul_f32 v52, v52, v49
    v_mul_f32 v53, v53, v49
    v_mul_f32 v54, v54, v49
    v_mul_f32 v55, v55, v49
    v_mul_f32 v56, v56, v49
    v_mul_f32 v57, v57, v49
    v_mul_f32 v58, v58, v49
    v_mul_f32 v59, v59, v49
    v_accvgpr_write_b32 a56, v52
    v_accvgpr_write_b32 a57, v53
    v_accvgpr_write_b32 a58, v54
    v_accvgpr_write_b32 a59, v55
    v_accvgpr_write_b32 a60, v56
    v_accvgpr_write_b32 a61, v57
    v_accvgpr_write_b32 a62, v58
    v_accvgpr_write_b32 a63, v59
    v_exp_f32 v52, v104
    v_exp_f32 v53, v105
    v_exp_f32 v54, v106
    v_exp_f32 v55, v107
    v_exp_f32 v56, v108
    v_exp_f32 v57, v109
    v_exp_f32 v58, v110
    v_exp_f32 v59, v111
    s_nop 0
    v_cvt_pk_bf16_f32 v148, v52, v53
    v_cvt_pk_bf16_f32 v149, v54, v55
    v_cvt_pk_bf16_f32 v150, v56, v57
    v_cvt_pk_bf16_f32 v151, v58, v59
    s_nop 1
    v_mfma_f32_16x16x32_bf16 v[32:35], v[44:47], v[148:151], 0
    s_nop 7
    s_setpc_b64 s[74:75]
m_rs1490:
    s_nop 15
    v_max3_f32 v48, v96, v97, v98
    v_max3_f32 v48, v48, v99, v100
    v_max3_f32 v48, v48, v101, v102
    v_max3_f32 v48, v48, v103, 0
    v_mov_b32 v49, v48
    s_nop 1
    v_permlane32_swap_b32 v48, v49
    s_nop 1
    v_max_f32 v48, v48, v49
    v_mov_b32 v49, v48
    s_nop 1
    v_permlane16_swap_b32 v48, v49
    s_nop 1
    v_max_f32 v48, v48, v49
    v_exp_f32 v49, -v48
    v_sub_f32 v96, v96, v48
    v_sub_f32 v97, v97, v48
    v_sub_f32 v98, v98, v48
    v_sub_f32 v99, v99, v48
    v_sub_f32 v100, v100, v48
    v_sub_f32 v101, v101, v48
    v_sub_f32 v102, v102, v48
    v_sub_f32 v103, v103, v48
    v_sub_f32 v64, v64, v48
    v_sub_f32 v65, v65, v48
    v_sub_f32 v66, v66, v48
    v_sub_f32 v67, v67, v48
    v_sub_f32 v68, v68, v48
    v_sub_f32 v69, v69, v48
    v_sub_f32 v70, v70, v48
    v_sub_f32 v71, v71, v48
    v_sub_f32 v160, v160, v48
    v_sub_f32 v161, v161, v48
    v_sub_f32 v162, v162, v48
    v_sub_f32 v163, v163, v48
    v_sub_f32 v164, v164, v48
    v_sub_f32 v165, v165, v48
    v_sub_f32 v166, v166, v48
    v_sub_f32 v167, v167, v48
    v_mul_f32 v12, v12, v49
    v_accvgpr_read_b32 v52, a0
    v_accvgpr_read_b32 v53, a1
    v_accvgpr_read_b32 v54, a2
    v_accvgpr_read_b32 v55, a3
    v_accvgpr_read_b32 v56, a4
    v_accvgpr_read_b32 v57, a5
    v_accvgpr_read_b32 v58, a6
    v_accvgpr_read_b32 v59, a7
    v_mul_f32 v52, v52, v49
    v_mul_f32 v53, v53, v49
    v_mul_f32 v54, v54, v49
    v_mul_f32 v55, v55, v49
    v_mul_f32 v56, v56, v49
    v_mul_f32 v57, v57, v49
    v_mul_f32 v58, v58, v49
    v_mul_f32 v59, v59, v49
    v_accvgpr_write_b32 a0, v52
    v_accvgpr_write_b32 a1, v53
    v_accvgpr_write_b32 a2, v54
    v_accvgpr_write_b32 a3, v55
    v_accvgpr_write_b32 a4, v56
    v_accvgpr_write_b32 a5, v57
    v_accvgpr_write_b32 a6, v58
    v_accvgpr_write_b32 a7, v59
    v_accvgpr_read_b32 v52, a8
    v_accvgpr_read_b32 v53, a9
    v_accvgpr_read_b32 v54, a10
    v_accvgpr_read_b32 v55, a11
    v_accvgpr_read_b32 v56, a12
    v_accvgpr_read_b32 v57, a13
    v_accvgpr_read_b32 v58, a14
    v_accvgpr_read_b32 v59, a15
    v_mul_f32 v52, v52, v49
    v_mul_f32 v53, v53, v49
    v_mul_f32 v54, v54, v49
    v_mul_f32 v55, v55, v49
    v_mul_f32 v56, v56, v49
    v_mul_f32 v57, v57, v49
    v_mul_f32 v58, v58, v49
    v_mul_f32 v59, v59, v49
    v_accvgpr_write_b32 a8, v52
    v_accvgpr_write_b32 a9, v53
    v_accvgpr_write_b32 a10, v54
    v_accvgpr_write_b32 a11, v55
    v_accvgpr_write_b32 a12, v56
    v_accvgpr_write_b32 a13, v57
    v_accvgpr_write_b32 a14, v58
    v_accvgpr_write_b32 a15, v59
    v_accvgpr_read_b32 v52, a16
    v_accvgpr_read_b32 v53, a17
    v_accvgpr_read_b32 v54, a18
    v_accvgpr_read_b32 v55, a19
    v_accvgpr_read_b32 v56, a20
    v_accvgpr_read_b32 v57, a21
    v_accvgpr_read_b32 v58, a22
    v_accvgpr_read_b32 v59, a23
    v_mul_f32 v52, v52, v49
    v_mul_f32 v53, v53, v49
    v_mul_f32 v54, v54, v49
    v_mul_f32 v55, v55, v49
    v_mul_f32 v56, v56, v49
    v_mul_f32 v57, v57, v49
    v_mul_f32 v58, v58, v49
    v_mul_f32 v59, v59, v49
    v_accvgpr_write_b32 a16, v52
    v_accvgpr_write_b32 a17, v53
    v_accvgpr_write_b32 a18, v54
    v_accvgpr_write_b32 a19, v55
    v_accvgpr_write_b32 a20, v56
    v_accvgpr_write_b32 a21, v57
    v_accvgpr_write_b32 a22, v58
    v_accvgpr_write_b32 a23, v59
    v_accvgpr_read_b32 v52, a24
    v_accvgpr_read_b32 v53, a25
    v_accvgpr_read_b32 v54, a26
    v_accvgpr_read_b32 v55, a27
    v_accvgpr_read_b32 v56, a28
    v_accvgpr_read_b32 v57, a29
    v_accvgpr_read_b32 v58, a30
    v_accvgpr_read_b32 v59, a31
    v_mul_f32 v52, v52, v49
    v_mul_f32 v53, v53, v49
    v_mul_f32 v54, v54, v49
    v_mul_f32 v55, v55, v49
    v_mul_f32 v56, v56, v49
    v_mul_f32 v57, v57, v49
    v_mul_f32 v58, v58, v49
    v_mul_f32 v59, v59, v49
    v_accvgpr_write_b32 a24, v52
    v_accvgpr_write_b32 a25, v53
    v_accvgpr_write_b32 a26, v54
    v_accvgpr_write_b32 a27, v55
    v_accvgpr_write_b32 a28, v56
    v_accvgpr_write_b32 a29, v57
    v_accvgpr_write_b32 a30, v58
    v_accvgpr_write_b32 a31, v59
    v_exp_f32 v52, v96
    v_exp_f32 v53, v97
    v_exp_f32 v54, v98
    v_exp_f32 v55, v99
    v_exp_f32 v56, v100
    v_exp_f32 v57, v101
    v_exp_f32 v58, v102
    v_exp_f32 v59, v103
    s_nop 0
    v_cvt_pk_bf16_f32 v144, v52, v53
    v_cvt_pk_bf16_f32 v145, v54, v55
    v_cvt_pk_bf16_f32 v146, v56, v57
    v_cvt_pk_bf16_f32 v147, v58, v59
    s_nop 1
    v_mfma_f32_16x16x32_bf16 v[28:31], v[44:47], v[144:147], 0
    v_max3_f32 v48, v104, v105, v106
    v_max3_f32 v48, v48, v107, v108
    v_max3_f32 v48, v48, v109, v110
    v_max3_f32 v48, v48, v111, 0
    v_mov_b32 v49, v48
    s_nop 1
    v_permlane32_swap_b32 v48, v49
    s_nop 1
    v_max_f32 v48, v48, v49
    v_mov_b32 v49, v48
    s_nop 1
    v_permlane16_swap_b32 v48, v49
    s_nop 1
    v_max_f32 v48, v48, v49
    v_exp_f32 v49, -v48
    v_sub_f32 v104, v104, v48
    v_sub_f32 v105, v105, v48
    v_sub_f32 v106, v106, v48
    v_sub_f32 v107, v107, v48
    v_sub_f32 v108, v108, v48
    v_sub_f32 v109, v109, v48
    v_sub_f32 v110, v110, v48
    v_sub_f32 v111, v111, v48
    v_sub_f32 v72, v72, v48
    v_sub_f32 v73, v73, v48
    v_sub_f32 v74, v74, v48
    v_sub_f32 v75, v75, v48
    v_sub_f32 v76, v76, v48
    v_sub_f32 v77, v77, v48
    v_sub_f32 v78, v78, v48
    v_sub_f32 v79, v79, v48
    v_sub_f32 v168, v168, v48
    v_sub_f32 v169, v169, v48
    v_sub_f32 v170, v170, v48
    v_sub_f32 v171, v171, v48
    v_sub_f32 v172, v172, v48
    v_sub_f32 v173, v173, v48
    v_sub_f32 v174, v174, v48
    v_sub_f32 v175, v175, v48
    v_mul_f32 v13, v13, v49
    v_accvgpr_read_b32 v52, a32
    v_accvgpr_read_b32 v53, a33
    v_accvgpr_read_b32 v54, a34
    v_accvgpr_read_b32 v55, a35
    v_accvgpr_read_b32 v56, a36
    v_accvgpr_read_b32 v57, a37
    v_accvgpr_read_b32 v58, a38
    v_accvgpr_read_b32 v59, a39
    v_mul_f32 v52, v52, v49
    v_mul_f32 v53, v53, v49
    v_mul_f32 v54, v54, v49
    v_mul_f32 v55, v55, v49
    v_mul_f32 v56, v56, v49
    v_mul_f32 v57, v57, v49
    v_mul_f32 v58, v58, v49
    v_mul_f32 v59, v59, v49
    v_accvgpr_write_b32 a32, v52
    v_accvgpr_write_b32 a33, v53
    v_accvgpr_write_b32 a34, v54
    v_accvgpr_write_b32 a35, v55
    v_accvgpr_write_b32 a36, v56
    v_accvgpr_write_b32 a37, v57
    v_accvgpr_write_b32 a38, v58
    v_accvgpr_write_b32 a39, v59
    v_accvgpr_read_b32 v52, a40
    v_accvgpr_read_b32 v53, a41
    v_accvgpr_read_b32 v54, a42
    v_accvgpr_read_b32 v55, a43
    v_accvgpr_read_b32 v56, a44
    v_accvgpr_read_b32 v57, a45
    v_accvgpr_read_b32 v58, a46
    v_accvgpr_read_b32 v59, a47
    v_mul_f32 v52, v52, v49
    v_mul_f32 v53, v53, v49
    v_mul_f32 v54, v54, v49
    v_mul_f32 v55, v55, v49
    v_mul_f32 v56, v56, v49
    v_mul_f32 v57, v57, v49
    v_mul_f32 v58, v58, v49
    v_mul_f32 v59, v59, v49
    v_accvgpr_write_b32 a40, v52
    v_accvgpr_write_b32 a41, v53
    v_accvgpr_write_b32 a42, v54
    v_accvgpr_write_b32 a43, v55
    v_accvgpr_write_b32 a44, v56
    v_accvgpr_write_b32 a45, v57
    v_accvgpr_write_b32 a46, v58
    v_accvgpr_write_b32 a47, v59
    v_accvgpr_read_b32 v52, a48
    v_accvgpr_read_b32 v53, a49
    v_accvgpr_read_b32 v54, a50
    v_accvgpr_read_b32 v55, a51
    v_accvgpr_read_b32 v56, a52
    v_accvgpr_read_b32 v57, a53
    v_accvgpr_read_b32 v58, a54
    v_accvgpr_read_b32 v59, a55
    v_mul_f32 v52, v52, v49
    v_mul_f32 v53, v53, v49
    v_mul_f32 v54, v54, v49
    v_mul_f32 v55, v55, v49
    v_mul_f32 v56, v56, v49
    v_mul_f32 v57, v57, v49
    v_mul_f32 v58, v58, v49
    v_mul_f32 v59, v59, v49
    v_accvgpr_write_b32 a48, v52
    v_accvgpr_write_b32 a49, v53
    v_accvgpr_write_b32 a50, v54
    v_accvgpr_write_b32 a51, v55
    v_accvgpr_write_b32 a52, v56
    v_accvgpr_write_b32 a53, v57
    v_accvgpr_write_b32 a54, v58
    v_accvgpr_write_b32 a55, v59
    v_accvgpr_read_b32 v52, a56
    v_accvgpr_read_b32 v53, a57
    v_accvgpr_read_b32 v54, a58
    v_accvgpr_read_b32 v55, a59
    v_accvgpr_read_b32 v56, a60
    v_accvgpr_read_b32 v57, a61
    v_accvgpr_read_b32 v58, a62
    v_accvgpr_read_b32 v59, a63
    v_mul_f32 v52, v52, v49
    v_mul_f32 v53, v53, v49
    v_mul_f32 v54, v54, v49
    v_mul_f32 v55, v55, v49
    v_mul_f32 v56, v56, v49
    v_mul_f32 v57, v57, v49
    v_mul_f32 v58, v58, v49
    v_mul_f32 v59, v59, v49
    v_accvgpr_write_b32 a56, v52
    v_accvgpr_write_b32 a57, v53
    v_accvgpr_write_b32 a58, v54
    v_accvgpr_write_b32 a59, v55
    v_accvgpr_write_b32 a60, v56
    v_accvgpr_write_b32 a61, v57
    v_accvgpr_write_b32 a62, v58
    v_accvgpr_write_b32 a63, v59
    v_exp_f32 v52, v104
    v_exp_f32 v53, v105
    v_exp_f32 v54, v106
    v_exp_f32 v55, v107
    v_exp_f32 v56, v108
    v_exp_f32 v57, v109
    v_exp_f32 v58, v110
    v_exp_f32 v59, v111
    s_nop 0
    v_cvt_pk_bf16_f32 v148, v52, v53
    v_cvt_pk_bf16_f32 v149, v54, v55
    v_cvt_pk_bf16_f32 v150, v56, v57
    v_cvt_pk_bf16_f32 v151, v58, v59
    s_nop 1
    v_mfma_f32_16x16x32_bf16 v[32:35], v[44:47], v[148:151], 0
    v_max3_f32 v48, v112, v113, v114
    v_max3_f32 v48, v48, v115, v116
    v_max3_f32 v48, v48, v117, v118
    v_max3_f32 v48, v48, v119, 0
    v_mov_b32 v49, v48
    s_nop 1
    v_permlane32_swap_b32 v48, v49
    s_nop 1
    v_max_f32 v48, v48, v49
    v_mov_b32 v49, v48
    s_nop 1
    v_permlane16_swap_b32 v48, v49
    s_nop 1
    v_max_f32 v48, v48, v49
    v_exp_f32 v49, -v48
    v_sub_f32 v112, v112, v48
    v_sub_f32 v113, v113, v48
    v_sub_f32 v114, v114, v48
    v_sub_f32 v115, v115, v48
    v_sub_f32 v116, v116, v48
    v_sub_f32 v117, v117, v48
    v_sub_f32 v118, v118, v48
    v_sub_f32 v119, v119, v48
    v_sub_f32 v80, v80, v48
    v_sub_f32 v81, v81, v48
    v_sub_f32 v82, v82, v48
    v_sub_f32 v83, v83, v48
    v_sub_f32 v84, v84, v48
    v_sub_f32 v85, v85, v48
    v_sub_f32 v86, v86, v48
    v_sub_f32 v87, v87, v48
    v_sub_f32 v176, v176, v48
    v_sub_f32 v177, v177, v48
    v_sub_f32 v178, v178, v48
    v_sub_f32 v179, v179, v48
    v_sub_f32 v180, v180, v48
    v_sub_f32 v181, v181, v48
    v_sub_f32 v182, v182, v48
    v_sub_f32 v183, v183, v48
    v_mul_f32 v14, v14, v49
    v_accvgpr_read_b32 v52, a64
    v_accvgpr_read_b32 v53, a65
    v_accvgpr_read_b32 v54, a66
    v_accvgpr_read_b32 v55, a67
    v_accvgpr_read_b32 v56, a68
    v_accvgpr_read_b32 v57, a69
    v_accvgpr_read_b32 v58, a70
    v_accvgpr_read_b32 v59, a71
    v_mul_f32 v52, v52, v49
    v_mul_f32 v53, v53, v49
    v_mul_f32 v54, v54, v49
    v_mul_f32 v55, v55, v49
    v_mul_f32 v56, v56, v49
    v_mul_f32 v57, v57, v49
    v_mul_f32 v58, v58, v49
    v_mul_f32 v59, v59, v49
    v_accvgpr_write_b32 a64, v52
    v_accvgpr_write_b32 a65, v53
    v_accvgpr_write_b32 a66, v54
    v_accvgpr_write_b32 a67, v55
    v_accvgpr_write_b32 a68, v56
    v_accvgpr_write_b32 a69, v57
    v_accvgpr_write_b32 a70, v58
    v_accvgpr_write_b32 a71, v59
    v_accvgpr_read_b32 v52, a72
    v_accvgpr_read_b32 v53, a73
    v_accvgpr_read_b32 v54, a74
    v_accvgpr_read_b32 v55, a75
    v_accvgpr_read_b32 v56, a76
    v_accvgpr_read_b32 v57, a77
    v_accvgpr_read_b32 v58, a78
    v_accvgpr_read_b32 v59, a79
    v_mul_f32 v52, v52, v49
    v_mul_f32 v53, v53, v49
    v_mul_f32 v54, v54, v49
    v_mul_f32 v55, v55, v49
    v_mul_f32 v56, v56, v49
    v_mul_f32 v57, v57, v49
    v_mul_f32 v58, v58, v49
    v_mul_f32 v59, v59, v49
    v_accvgpr_write_b32 a72, v52
    v_accvgpr_write_b32 a73, v53
    v_accvgpr_write_b32 a74, v54
    v_accvgpr_write_b32 a75, v55
    v_accvgpr_write_b32 a76, v56
    v_accvgpr_write_b32 a77, v57
    v_accvgpr_write_b32 a78, v58
    v_accvgpr_write_b32 a79, v59
    v_accvgpr_read_b32 v52, a80
    v_accvgpr_read_b32 v53, a81
    v_accvgpr_read_b32 v54, a82
    v_accvgpr_read_b32 v55, a83
    v_accvgpr_read_b32 v56, a84
    v_accvgpr_read_b32 v57, a85
    v_accvgpr_read_b32 v58, a86
    v_accvgpr_read_b32 v59, a87
    v_mul_f32 v52, v52, v49
    v_mul_f32 v53, v53, v49
    v_mul_f32 v54, v54, v49
    v_mul_f32 v55, v55, v49
    v_mul_f32 v56, v56, v49
    v_mul_f32 v57, v57, v49
    v_mul_f32 v58, v58, v49
    v_mul_f32 v59, v59, v49
    v_accvgpr_write_b32 a80, v52
    v_accvgpr_write_b32 a81, v53
    v_accvgpr_write_b32 a82, v54
    v_accvgpr_write_b32 a83, v55
    v_accvgpr_write_b32 a84, v56
    v_accvgpr_write_b32 a85, v57
    v_accvgpr_write_b32 a86, v58
    v_accvgpr_write_b32 a87, v59
    v_accvgpr_read_b32 v52, a88
    v_accvgpr_read_b32 v53, a89
    v_accvgpr_read_b32 v54, a90
    v_accvgpr_read_b32 v55, a91
    v_accvgpr_read_b32 v56, a92
    v_accvgpr_read_b32 v57, a93
    v_accvgpr_read_b32 v58, a94
    v_accvgpr_read_b32 v59, a95
    v_mul_f32 v52, v52, v49
    v_mul_f32 v53, v53, v49
    v_mul_f32 v54, v54, v49
    v_mul_f32 v55, v55, v49
    v_mul_f32 v56, v56, v49
    v_mul_f32 v57, v57, v49
    v_mul_f32 v58, v58, v49
    v_mul_f32 v59, v59, v49
    v_accvgpr_write_b32 a88, v52
    v_accvgpr_write_b32 a89, v53
    v_accvgpr_write_b32 a90, v54
    v_accvgpr_write_b32 a91, v55
    v_accvgpr_write_b32 a92, v56
    v_accvgpr_write_b32 a93, v57
    v_accvgpr_write_b32 a94, v58
    v_accvgpr_write_b32 a95, v59
    v_exp_f32 v52, v112
    v_exp_f32 v53, v113
    v_exp_f32 v54, v114
    v_exp_f32 v55, v115
    v_exp_f32 v56, v116
    v_exp_f32 v57, v117
    v_exp_f32 v58, v118
    v_exp_f32 v59, v119
    s_nop 0
    v_cvt_pk_bf16_f32 v152, v52, v53
    v_cvt_pk_bf16_f32 v153, v54, v55
    v_cvt_pk_bf16_f32 v154, v56, v57
    v_cvt_pk_bf16_f32 v155, v58, v59
    s_nop 1
    v_mfma_f32_16x16x32_bf16 v[36:39], v[44:47], v[152:155], 0
    v_max3_f32 v48, v120, v121, v122
    v_max3_f32 v48, v48, v123, v124
    v_max3_f32 v48, v48, v125, v126
    v_max3_f32 v48, v48, v127, 0
    v_mov_b32 v49, v48
    s_nop 1
    v_permlane32_swap_b32 v48, v49
    s_nop 1
    v_max_f32 v48, v48, v49
    v_mov_b32 v49, v48
    s_nop 1
    v_permlane16_swap_b32 v48, v49
    s_nop 1
    v_max_f32 v48, v48, v49
    v_exp_f32 v49, -v48
    v_sub_f32 v120, v120, v48
    v_sub_f32 v121, v121, v48
    v_sub_f32 v122, v122, v48
    v_sub_f32 v123, v123, v48
    v_sub_f32 v124, v124, v48
    v_sub_f32 v125, v125, v48
    v_sub_f32 v126, v126, v48
    v_sub_f32 v127, v127, v48
    v_sub_f32 v88, v88, v48
    v_sub_f32 v89, v89, v48
    v_sub_f32 v90, v90, v48
    v_sub_f32 v91, v91, v48
    v_sub_f32 v92, v92, v48
    v_sub_f32 v93, v93, v48
    v_sub_f32 v94, v94, v48
    v_sub_f32 v95, v95, v48
    v_sub_f32 v184, v184, v48
    v_sub_f32 v185, v185, v48
    v_sub_f32 v186, v186, v48
    v_sub_f32 v187, v187, v48
    v_sub_f32 v188, v188, v48
    v_sub_f32 v189, v189, v48
    v_sub_f32 v190, v190, v48
    v_sub_f32 v191, v191, v48
    v_mul_f32 v15, v15, v49
    v_accvgpr_read_b32 v52, a96
    v_accvgpr_read_b32 v53, a97
    v_accvgpr_read_b32 v54, a98
    v_accvgpr_read_b32 v55, a99
    v_accvgpr_read_b32 v56, a100
    v_accvgpr_read_b32 v57, a101
    v_accvgpr_read_b32 v58, a102
    v_accvgpr_read_b32 v59, a103
    v_mul_f32 v52, v52, v49
    v_mul_f32 v53, v53, v49
    v_mul_f32 v54, v54, v49
    v_mul_f32 v55, v55, v49
    v_mul_f32 v56, v56, v49
    v_mul_f32 v57, v57, v49
    v_mul_f32 v58, v58, v49
    v_mul_f32 v59, v59, v49
    v_accvgpr_write_b32 a96, v52
    v_accvgpr_write_b32 a97, v53
    v_accvgpr_write_b32 a98, v54
    v_accvgpr_write_b32 a99, v55
    v_accvgpr_write_b32 a100, v56
    v_accvgpr_write_b32 a101, v57
    v_accvgpr_write_b32 a102, v58
    v_accvgpr_write_b32 a103, v59
    v_accvgpr_read_b32 v52, a104
    v_accvgpr_read_b32 v53, a105
    v_accvgpr_read_b32 v54, a106
    v_accvgpr_read_b32 v55, a107
    v_accvgpr_read_b32 v56, a108
    v_accvgpr_read_b32 v57, a109
    v_accvgpr_read_b32 v58, a110
    v_accvgpr_read_b32 v59, a111
    v_mul_f32 v52, v52, v49
    v_mul_f32 v53, v53, v49
    v_mul_f32 v54, v54, v49
    v_mul_f32 v55, v55, v49
    v_mul_f32 v56, v56, v49
    v_mul_f32 v57, v57, v49
    v_mul_f32 v58, v58, v49
    v_mul_f32 v59, v59, v49
    v_accvgpr_write_b32 a104, v52
    v_accvgpr_write_b32 a105, v53
    v_accvgpr_write_b32 a106, v54
    v_accvgpr_write_b32 a107, v55
    v_accvgpr_write_b32 a108, v56
    v_accvgpr_write_b32 a109, v57
    v_accvgpr_write_b32 a110, v58
    v_accvgpr_write_b32 a111, v59
    v_accvgpr_read_b32 v52, a112
    v_accvgpr_read_b32 v53, a113
    v_accvgpr_read_b32 v54, a114
    v_accvgpr_read_b32 v55, a115
    v_accvgpr_read_b32 v56, a116
    v_accvgpr_read_b32 v57, a117
    v_accvgpr_read_b32 v58, a118
    v_accvgpr_read_b32 v59, a119
    v_mul_f32 v52, v52, v49
    v_mul_f32 v53, v53, v49
    v_mul_f32 v54, v54, v49
    v_mul_f32 v55, v55, v49
    v_mul_f32 v56, v56, v49
    v_mul_f32 v57, v57, v49
    v_mul_f32 v58, v58, v49
    v_mul_f32 v59, v59, v49
    v_accvgpr_write_b32 a112, v52
    v_accvgpr_write_b32 a113, v53
    v_accvgpr_write_b32 a114, v54
    v_accvgpr_write_b32 a115, v55
    v_accvgpr_write_b32 a116, v56
    v_accvgpr_write_b32 a117, v57
    v_accvgpr_write_b32 a118, v58
    v_accvgpr_write_b32 a119, v59
    v_accvgpr_read_b32 v52, a120
    v_accvgpr_read_b32 v53, a121
    v_accvgpr_read_b32 v54, a122
    v_accvgpr_read_b32 v55, a123
    v_accvgpr_read_b32 v56, a124
    v_accvgpr_read_b32 v57, a125
    v_accvgpr_read_b32 v58, a126
    v_accvgpr_read_b32 v59, a127
    v_mul_f32 v52, v52, v49
    v_mul_f32 v53, v53, v49
    v_mul_f32 v54, v54, v49
    v_mul_f32 v55, v55, v49
    v_mul_f32 v56, v56, v49
    v_mul_f32 v57, v57, v49
    v_mul_f32 v58, v58, v49
    v_mul_f32 v59, v59, v49
    v_accvgpr_write_b32 a120, v52
    v_accvgpr_write_b32 a121, v53
    v_accvgpr_write_b32 a122, v54
    v_accvgpr_write_b32 a123, v55
    v_accvgpr_write_b32 a124, v56
    v_accvgpr_write_b32 a125, v57
    v_accvgpr_write_b32 a126, v58
    v_accvgpr_write_b32 a127, v59
    v_exp_f32 v52, v120
    v_exp_f32 v53, v121
    v_exp_f32 v54, v122
    v_exp_f32 v55, v123
    v_exp_f32 v56, v124
    v_exp_f32 v57, v125
    v_exp_f32 v58, v126
    v_exp_f32 v59, v127
    s_nop 0
    v_cvt_pk_bf16_f32 v156, v52, v53
    v_cvt_pk_bf16_f32 v157, v54, v55
    v_cvt_pk_bf16_f32 v158, v56, v57
    v_cvt_pk_bf16_f32 v159, v58, v59
    s_nop 1
    v_mfma_f32_16x16x32_bf16 v[40:43], v[44:47], v[156:159], 0
    s_nop 7
    s_setpc_b64 s[74:75]
m_hook18:
    s_cmp_lg_u32 s16, 0
    s_cbranch_scc1 m_np37
    v_mov_b32 v4, s4
    v_mov_b32 v5, s5
    s_add_u32 s90, s17, 117440512
    s_mov_b64 exec, 1
    buffer_store_dwordx2 v[4:5], off, s[8:11], s90 sc1
    s_mov_b64 exec, -1
m_np37:
    s_mov_b32 s17, -1
    s_branch m_hookr19
m_hook23:
    s_cmp_lg_u32 s16, 0
    s_cbranch_scc1 m_np38
    v_mov_b32 v4, s4
    v_mov_b32 v5, s5
    s_add_u32 s90, s17, 117440512
    s_mov_b64 exec, 1
    buffer_store_dwordx2 v[4:5], off, s[8:11], s90 sc1
    s_mov_b64 exec, -1
m_np38:
    s_mov_b32 s17, -1
    s_branch m_hookr24
m_pf7:
    s_mov_b32 s15, 0x20000
    s_sub_u32 s93, s2, 224
    s_lshl_b32 s93, s93, 2
    s_add_u32 s93, s93, s16
    v_lshlrev_b32 v24, 7, v1
    v_lshrrev_b32 v25, 3, v1
    v_lshlrev_b32 v25, 11, v25
    v_and_b32 v26, 7, v1
    v_lshl_add_u32 v25, v26, 7, v25
    s_lshl_b32 s92, s93, 13
    s_lshl_b32 s93, s93, 14
    s_add_u32 s93, s93, 1024
    s_mov_b32 s12, s26
    s_mov_b32 s13, s27
    s_mov_b32 s14, 6291456
    s_add_u32 s90, s92, 0
    buffer_load_dword v22, v24, s[12:15], s90 offen
    s_add_u32 s90, s92, 1048576
    buffer_load_dword v22, v24, s[12:15], s90 offen
    s_mov_b32 s12, s24
    s_mov_b32 s13, s25
    s_mov_b32 s14, 4194304
    s_add_u32 s90, s92, 0
    buffer_load_dword v22, v24, s[12:15], s90 offen
    s_add_u32 s90, s92, 1048576
    buffer_load_dword v22, v24, s[12:15], s90 offen
    s_add_u32 s90, s92, 2097152
    buffer_load_dword v22, v24, s[12:15], s90 offen
    s_add_u32 s90, s92, 3145728
    buffer_load_dword v22, v24, s[12:15], s90 offen
    s_mov_b32 s12, s34
    s_mov_b32 s13, s35
    s_mov_b32 s14, 8388608
    s_add_u32 s90, s92, 4194304
    buffer_load_dword v22, v24, s[12:15], s90 offen
    s_add_u32 s90, s92, 5242880
    buffer_load_dword v22, v24, s[12:15], s90 offen
    s_mov_b32 s12, s30
    s_mov_b32 s13, s31
    s_mov_b32 s14, 4194304
    s_add_u32 s90, s93, 0
    buffer_load_dword v22, v25, s[12:15], s90 offen
    s_add_u32 s90, s93, 2097152
    buffer_load_dword v22, v25, s[12:15], s90 offen
    s_mov_b32 s12, s26
    s_mov_b32 s13, s27
    s_mov_b32 s14, 6291456
    s_add_u32 s90, s92, 2097152
    buffer_load_dword v22, v24, s[12:15], s90 offen
    s_mov_b32 s12, s34
    s_mov_b32 s13, s35
    s_mov_b32 s14, 8388608
    s_add_u32 s90, s92, 6291456
    buffer_load_dword v22, v24, s[12:15], s90 offen
    s_add_u32 s90, s92, 7340032
    buffer_load_dword v22, v24, s[12:15], s90 offen
    s_mov_b32 s12, s26
    s_mov_b32 s13, s27
    s_mov_b32 s14, 6291456
    s_add_u32 s90, s92, 3145728
    buffer_load_dword v22, v24, s[12:15], s90 offen
    s_add_u32 s90, s92, 4194304
    buffer_load_dword v22, v24, s[12:15], s90 offen
    s_add_u32 s90, s92, 5242880
    buffer_load_dword v22, v24, s[12:15], s90 offen
    s_mov_b32 s12, s32
    s_mov_b32 s13, s33
    s_mov_b32 s14, 2097152
    s_add_u32 s90, s92, 1048576
    buffer_load_dword v22, v24, s[12:15], s90 offen
    s_add_u32 s61, s61, 32768
    s_branch m_nopf6
concat_heads__sliding_local_dilated__compressed_kv_cla__prompt_kernel_end:
.section .rodata,"a"
.p2align 6
.amdhsa_kernel concat_heads__sliding_local_dilated__compressed_kv_cla__prompt_kernel
  .amdhsa_next_free_vgpr 512
  .amdhsa_next_free_sgpr 102
  .amdhsa_accum_offset 256
  .amdhsa_group_segment_fixed_size 0
  .amdhsa_kernarg_size 96
  .amdhsa_user_sgpr_count 2
  .amdhsa_user_sgpr_kernarg_segment_ptr 1
  .amdhsa_system_sgpr_workgroup_id_x 1
.end_amdhsa_kernel
```

```asm
; @launch grid=(256,1,1) block=(256,1,1) lds=163840
.amdgcn_target "amdgcn-amd-amdhsa--gfx950"
.text
.globl concat_heads__sliding_local_dilated__compressed_kv_cla__prompt_kernel
.p2align 8
.type concat_heads__sliding_local_dilated__compressed_kv_cla__prompt_kernel,@function
concat_heads__sliding_local_dilated__compressed_kv_cla__prompt_kernel:
    s_cmp_ge_u32 s2, 256
    s_cbranch_scc1 m_end1
    s_load_dwordx16 s[24:39], s[0:1], 0
    s_load_dwordx4 s[4:7], s[0:1], 80
    v_and_b32 v1, 63, v0
    v_lshrrev_b32 v24, 6, v0
    s_nop 0
    v_readfirstlane_b32 s16, v24
    s_lshr_b32 s68, s2, 3
    s_lshr_b32 s57, s16, 1
    s_and_b32 s58, s16, 1
    s_mov_b32 s43, 0x20000
    s_mov_b32 s47, 0x20000
    s_cmp_lt_u32 s68, 28
    s_cbranch_scc1 m_ncp2
    s_sub_u32 s91, s68, 28
    s_lshl_b32 s91, s91, 2
    s_add_u32 s91, s91, s16
    s_getpc_b64 s[8:9]
m_pc3:
    s_sub_u32 s8, s8, m_pc3-concat_heads__sliding_local_dilated__compressed_kv_cla__prompt_kernel
    s_subb_u32 s9, s9, 0
    s_lshl_b32 s90, s91, 13
    v_lshlrev_b32 v24, 7, v1
    v_add_u32 v24, s90, v24
    v_min_u32 v24, concat_heads__sliding_local_dilated__compressed_kv_cla__prompt_kernel_end-concat_heads__sliding_local_dilated__compressed_kv_cla__prompt_kernel-4, v24
    v_mov_b32 v25, s9
    v_add_co_u32 v24, vcc, s8, v24
    s_nop 1
    v_addc_co_u32 v25, vcc, 0, v25, vcc
    global_load_dword v22, v[24:25], off
m_ncp2:
    s_lshl_b32 s61, s16, 13
    s_add_u32 s62, s61, 98304
    s_cmp_ge_u32 s68, 16
    s_cbranch_scc1 m_typea4
    s_and_b32 s69, s68, 3
    s_and_b32 s90, s2, 1
    s_lshl_b32 s90, s90, 2
    s_add_u32 s69, s69, s90
    s_bfe_u32 s90, s2, 0x20001
    s_mul_i32 s90, s90, 4
    s_bfe_u32 s91, s68, 0x20002
    s_add_u32 s90, s90, s91
    s_mov_b32 s76, 8388608
    s_mov_b32 s78, 8192
    s_mov_b32 s81, 0
    s_mov_b32 s73, 4194304
    s_mov_b32 s77, 2048
    s_mov_b32 s82, 16
    s_lshl_b32 s80, s90, 9
    s_lshl_b32 s79, s69, 19
    s_lshl_b32 s88, s90, 4
    s_add_u32 s88, s88, s69
    s_lshl_b32 s88, s88, 3
    s_mov_b32 s83, 0
    s_mov_b32 s84, 1040356334
    s_lshl_b32 s91, s90, 1
    s_add_u32 s91, s91, s58
    s_lshl_b32 s91, s91, 19
    s_lshl_b32 s92, s69, 1
    s_add_u32 s92, s92, s57
    s_lshl_b32 s92, s92, 15
    s_add_u32 s85, s91, s92
    s_add_u32 s85, s85, 0
    s_mov_b32 s86, 1024
    s_mov_b32 s87, 4096
    s_branch m_go15
m_typea4:
    s_bfe_u32 s69, s68, 0x20002
    s_add_u32 s69, s69, 0
    s_and_b32 s90, s2, 7
    s_lshl_b32 s90, s90, 2
    s_and_b32 s91, s68, 3
    s_add_u32 s90, s90, s91
    s_cmp_lt_u32 s90, 16
    s_cselect_b32 s83, 0, 1
    s_mov_b32 s91, 33554432
    s_cselect_b32 s85, 16777216, s91
    s_mov_b32 s91, 8192
    s_cselect_b32 s86, 1024, s91
    s_mov_b32 s91, 1024
    s_cselect_b32 s87, 4096, s91
    s_mov_b32 s73, 2097152
    s_mov_b32 s77, 1024
    s_mov_b32 s82, 8
    s_mov_b32 s81, 0
    s_mov_b32 s76, 4194304
    s_mov_b32 s78, 8192
    s_mov_b32 s84, 0
    s_and_b32 s90, s90, 15
    s_lshl_b32 s80, s90, 9
    s_lshl_b32 s79, s69, 18
    s_lshl_b32 s91, s83, 2
    s_add_u32 s91, s91, s69
    s_cmp_ge_u32 s69, 4
    s_cselect_b32 s92, 508, 8
    s_add_u32 s91, s91, s92
    s_lshl_b32 s88, s90, 4
    s_add_u32 s88, s88, s91
    s_lshl_b32 s88, s88, 3
    s_lshl_b32 s91, s90, 1
    s_add_u32 s91, s91, s58
    s_lshl_b32 s91, s91, 19
    s_lshl_b32 s92, s69, 1
    s_add_u32 s92, s92, s57
    s_lshl_b32 s92, s92, 15
    s_add_u32 s85, s85, s91
    s_add_u32 s85, s85, s92
m_go15:
    s_mov_b32 s42, s73
    s_lshl_b32 s90, s77, 4
    s_lshl_b32 s90, s90, s81
    s_mov_b32 s48, s79
    s_mul_i32 s91, s90, 1
    s_add_u32 s49, s91, s79
    s_sub_u32 s49, s49, 2048
    s_mul_i32 s91, s90, 2
    s_add_u32 s50, s91, s79
    s_mul_i32 s91, s90, 3
    s_add_u32 s51, s91, s79
    s_sub_u32 s51, s51, 2048
    s_lshl_b32 s90, s58, 7
    s_add_u32 s90, s90, s57
    s_lshl_b32 s91, s16, 6
    s_cmp_eq_u32 s81, 1
    s_cselect_b32 s90, s90, s91
    v_lshrrev_b32 v24, 3, v1
    v_lshlrev_b32 v24, s81, v24
    v_add_u32 v24, s90, v24
    v_mul_lo_u32 v24, v24, s77
    v_lshrrev_b32 v25, 4, v1
    v_and_b32 v26, 7, v1
    v_xor_b32 v25, v25, v26
    v_lshl_add_u32 v16, v25, 4, v24
    v_xor_b32 v25, 4, v25
    v_lshl_add_u32 v17, v25, 4, v24
    s_lshl_b32 s90, s77, 3
    s_lshl_b32 s90, s90, s81
    s_sub_u32 s90, s90, 1024
    v_add_u32 v17, s90, v17
    s_mov_b32 s46, s76
    s_mov_b32 s52, s80
    s_lshl_b32 s90, s78, 2
    s_mul_i32 s91, s90, 1
    s_add_u32 s53, s91, s80
    s_sub_u32 s53, s53, 2048
    s_mul_i32 s91, s90, 2
    s_add_u32 s54, s91, s80
    s_mul_i32 s91, s90, 3
    s_add_u32 s55, s91, s80
    s_sub_u32 s55, s55, 2048
    s_lshl_b32 s56, s78, 6
    v_lshrrev_b32 v24, 5, v1
    s_lshl_b32 s90, s16, 4
    v_add_u32 v25, s90, v24
    v_mul_lo_u32 v25, v25, s78
    v_lshlrev_b32 v24, 1, v24
    v_and_b32 v26, 31, v1
    v_xor_b32 v24, v24, v26
    s_lshl_b32 s90, s78, 1
    s_sub_u32 s90, s90, 1024
    v_add_u32 v27, s90, v25
    v_xor_b32 v26, 0, v24
    v_lshl_add_u32 v18, v26, 4, v25
    v_xor_b32 v26, 4, v24
    v_lshl_add_u32 v19, v26, 4, v27
    v_xor_b32 v26, 8, v24
    v_lshl_add_u32 v20, v26, 4, v25
    v_xor_b32 v26, 12, v24
    v_lshl_add_u32 v21, v26, 4, v27
    s_cmp_eq_u32 s83, 0
    s_waitcnt lgkmcnt(0)
    s_cselect_b32 s44, s36, s38
    s_cselect_b32 s45, s37, s39
    s_cmp_lt_u32 s68, 16
    s_cselect_b32 s44, s34, s44
    s_cselect_b32 s45, s35, s45
    s_cselect_b32 s40, s30, s32
    s_cselect_b32 s41, s31, s33
    s_cmp_ge_u32 s68, 28
    s_cselect_b32 s70, 1, 0
    s_cbranch_scc1 m_pf7
m_nopf6:
    s_add_u32 m0, s61, 0
    s_nop 0
    buffer_load_dwordx4 v16, s[40:43], s48 offen offset:0 sc1 lds
    buffer_load_dwordx4 v17, s[40:43], s48 offen offset:1024 sc1 lds
    s_add_u32 s48, s48, 128
    buffer_load_dwordx4 v16, s[40:43], s49 offen offset:2048 sc1 lds
    buffer_load_dwordx4 v17, s[40:43], s49 offen offset:3072 sc1 lds
    s_add_u32 s49, s49, 128
    s_add_u32 m0, s61, 4096
    s_nop 0
    buffer_load_dwordx4 v16, s[40:43], s50 offen offset:0 sc1 lds
    buffer_load_dwordx4 v17, s[40:43], s50 offen offset:1024 sc1 lds
    s_add_u32 s50, s50, 128
    buffer_load_dwordx4 v16, s[40:43], s51 offen offset:2048 sc1 lds
    buffer_load_dwordx4 v17, s[40:43], s51 offen offset:3072 sc1 lds
    s_add_u32 s51, s51, 128
    s_add_u32 s61, s61, 32768
    s_cmp_ge_u32 s61, 98304
    s_cselect_b32 s90, 98304, 0
    s_sub_u32 s61, s61, s90
    s_add_u32 m0, s62, 0
    s_nop 0
    buffer_load_dwordx4 v18, s[44:47], s52 offen offset:0 sc1 lds
    buffer_load_dwordx4 v19, s[44:47], s52 offen offset:1024 sc1 lds
    s_add_u32 s52, s52, s56
    buffer_load_dwordx4 v18, s[44:47], s53 offen offset:2048 sc1 lds
    buffer_load_dwordx4 v19, s[44:47], s53 offen offset:3072 sc1 lds
    s_add_u32 s53, s53, s56
    s_add_u32 m0, s62, 4096
    s_nop 0
    buffer_load_dwordx4 v20, s[44:47], s54 offen offset:0 sc1 lds
    buffer_load_dwordx4 v21, s[44:47], s54 offen offset:1024 sc1 lds
    s_add_u32 s54, s54, s56
    buffer_load_dwordx4 v20, s[44:47], s55 offen offset:2048 sc1 lds
    buffer_load_dwordx4 v21, s[44:47], s55 offen offset:3072 sc1 lds
    s_add_u32 s55, s55, s56
    s_xor_b32 s62, s62, 229376
    s_mov_b32 s95, s82
    s_mov_b32 s96, s83
    s_mov_b32 s97, s84
    s_mov_b32 s98, s85
    s_mov_b32 s99, s86
    s_mov_b32 s100, s87
    s_mov_b32 s101, s88
    v_and_b32 v24, 15, v1
    v_lshrrev_b32 v25, 4, v1
    v_bfe_u32 v26, v1, 1, 3
    v_xor_b32 v26, v26, v25
    s_lshl_b32 s90, s57, 14
    v_lshlrev_b32 v27, 7, v24
    v_add_u32 v27, s90, v27
    v_xor_b32 v28, 0, v26
    v_lshl_add_u32 v6, v28, 4, v27
    v_xor_b32 v28, 4, v26
    v_lshl_add_u32 v7, v28, 4, v27
    v_bfe_u32 v26, v1, 2, 2
    v_lshl_add_u32 v27, v25, 3, v26
    v_lshlrev_b32 v27, 9, v27
    v_and_b32 v28, 3, v1
    v_lshlrev_b32 v28, 3, v28
    v_add_u32 v27, v27, v28
    s_lshl_b32 s90, s58, 8
    s_add_u32 s90, s90, 98304
    v_add_u32 v27, s90, v27
    v_bfe_u32 v26, v1, 2, 3
    v_xor_b32 v28, 0, v26
    v_lshl_add_u32 v8, v28, 5, v27
    v_xor_b32 v28, 1, v26
    v_lshl_add_u32 v9, v28, 5, v27
    v_xor_b32 v28, 2, v26
    v_lshl_add_u32 v10, v28, 5, v27
    v_xor_b32 v28, 3, v26
    v_lshl_add_u32 v11, v28, 5, v27
    v_xor_b32 v28, 4, v26
    v_lshl_add_u32 v12, v28, 5, v27
    v_xor_b32 v28, 5, v26
    v_lshl_add_u32 v13, v28, 5, v27
    v_xor_b32 v28, 6, v26
    v_lshl_add_u32 v14, v28, 5, v27
    v_xor_b32 v28, 7, v26
    v_lshl_add_u32 v15, v28, 5, v27
    v_lshlrev_b32 v2, 4, v1
    s_mov_b32 s64, 0
    s_mov_b32 s59, 32768
    s_mov_b32 s60, 229376
    s_mov_b32 s8, s6
    s_mov_b32 s9, s7
    s_mov_b32 s10, 268435456
    s_mov_b32 s11, 0x20000
    s_cmp_ge_u32 s68, 16
    s_cbranch_scc1 m_typea8
    s_bfe_u32 s69, s68, 0x20002
    s_add_u32 s69, s69, 4
    s_and_b32 s90, s2, 7
    s_lshl_b32 s90, s90, 2
    s_and_b32 s91, s68, 3
    s_add_u32 s90, s90, s91
    s_cmp_lt_u32 s90, 16
    s_cselect_b32 s83, 0, 1
    s_mov_b32 s91, 33554432
    s_cselect_b32 s85, 16777216, s91
    s_mov_b32 s91, 8192
    s_cselect_b32 s86, 1024, s91
    s_mov_b32 s91, 1024
    s_cselect_b32 s87, 4096, s91
    s_cselect_b32 s74, s36, s38
    s_cselect_b32 s75, s37, s39
    s_mov_b32 s71, s32
    s_mov_b32 s72, s33
    s_mov_b32 s73, 2097152
    s_mov_b32 s77, 1024
    s_mov_b32 s82, 8
    s_mov_b32 s81, 0
    s_mov_b32 s76, 4194304
    s_mov_b32 s78, 8192
    s_mov_b32 s84, 0
    s_and_b32 s90, s90, 15
    s_lshl_b32 s80, s90, 9
    s_lshl_b32 s79, s69, 18
    s_lshl_b32 s91, s83, 2
    s_add_u32 s91, s91, s69
    s_cmp_ge_u32 s69, 4
    s_cselect_b32 s92, 508, 8
    s_add_u32 s91, s91, s92
    s_lshl_b32 s88, s90, 4
    s_add_u32 s88, s88, s91
    s_lshl_b32 s88, s88, 3
    s_lshl_b32 s91, s90, 1
    s_add_u32 s91, s91, s58
    s_lshl_b32 s91, s91, 19
    s_lshl_b32 s92, s69, 1
    s_add_u32 s92, s92, s57
    s_lshl_b32 s92, s92, 15
    s_add_u32 s85, s85, s91
    s_add_u32 s85, s85, s92
    s_branch m_go29
m_typea8:
    s_and_b32 s69, s68, 3
    s_and_b32 s90, s2, 1
    s_lshl_b32 s90, s90, 2
    s_add_u32 s69, s69, s90
    s_bfe_u32 s90, s2, 0x20001
    s_mul_i32 s90, s90, 3
    s_bfe_u32 s91, s68, 0x20002
    s_add_u32 s90, s90, s91
    s_mov_b32 s76, 6291456
    s_mov_b32 s78, 6144
    s_mov_b32 s81, 1
    s_mov_b32 s73, 4194304
    s_mov_b32 s77, 2048
    s_mov_b32 s82, 16
    s_lshl_b32 s80, s90, 9
    s_lshl_b32 s79, s69, 19
    s_and_b32 s92, s90, 3
    s_lshr_b32 s91, s90, 2
    s_lshl_b32 s88, s92, 2
    s_add_u32 s88, s88, s91
    s_lshl_b32 s88, s88, 3
    s_add_u32 s88, s88, s69
    s_lshl_b32 s88, s88, 3
    s_add_u32 s88, s88, 6144
    s_cmp_eq_u32 s91, 0
    s_cselect_b32 s84, 1048744942, 0
    s_lshl_b32 s93, s91, 22
    s_add_u32 s85, s93, 50331648
    s_lshl_b32 s92, s92, 1
    s_add_u32 s92, s92, s58
    s_lshl_b32 s92, s92, 19
    s_add_u32 s85, s85, s92
    s_lshl_b32 s92, s57, 3
    s_add_u32 s92, s92, s69
    s_cmp_eq_u32 s91, 2
    s_cselect_b32 s83, 1, 0
    s_cselect_b32 s93, 12, 13
    s_mov_b32 s91, 131072
    s_cselect_b32 s86, 1024, s91
    s_mov_b32 s91, 1024
    s_cselect_b32 s87, 65536, s91
    s_lshl_b32 s92, s92, s93
    s_add_u32 s85, s85, s92
    s_mov_b32 s71, s24
    s_mov_b32 s72, s25
    s_mov_b32 s74, s26
    s_mov_b32 s75, s27
m_go29:
    s_and_b32 s92, s2, 7
    s_lshl_b32 s92, s92, 2
    s_bfe_u32 s93, s2, 0x20003
    s_add_u32 s92, s92, s93
    s_lshr_b32 s93, s2, 5
    s_lshl_b32 s93, s93, 2
    s_or_b32 s93, s93, 0x40000
    s_lshr_b32 s37, s92, 1
    s_lshl_b32 s37, s37, 7
    s_add_u32 s37, s37, 117440512
    s_lshl_b32 s92, s92, 19
    s_lshl_b32 s91, s58, 13
    s_add_u32 s90, s92, s91
    s_cmp_eq_u32 s57, 0
    s_mov_b32 s91, 33538048
    s_cselect_b32 s91, 16777216, s91
    s_add_u32 s32, s90, s91
    s_bfe_u32 s90, 4225674377, s93
    s_lshl_b32 s90, s90, 3
    s_lshl_b32 s91, s16, 1
    s_add_u32 s90, s90, s91
    s_lshl_b32 s90, s90, 12
    s_add_u32 s90, s90, s92
    s_add_u32 s33, s90, 0
    s_add_u32 s34, s90, 4096
    s_bfe_u32 s90, 873484918, s93
    s_lshl_b32 s90, s90, 3
    s_lshl_b32 s91, s16, 1
    s_add_u32 s90, s90, s91
    s_lshl_b32 s90, s90, 12
    s_add_u32 s90, s90, s92
    s_add_u32 s35, s90, 0
    s_add_u32 s36, s90, 4096
    s_bfe_u32 s91, 873484918, s93
    s_lshr_b32 s91, s91, 1
    v_mov_b32 v0, s91
    v_and_b32 v24, 3, v1
    v_min_u32 v24, 2, v24
    v_and_b32 v25, 4, v1
    v_add3_u32 v24, v24, v25, 8
    v_cmp_gt_u32 vcc, 8, v1
    s_nop 1
    v_cndmask_b32 v0, v0, v24, vcc
    s_bfe_u32 s91, 4225674377, s93
    s_lshr_b32 s91, s91, 1
    v_writelane_b32 v0, s91, 8
    v_lshlrev_b32 v0, 3, v0
    s_xor_b32 s94, s70, 1
    s_add_u32 s67, s70, 3
    s_mov_b32 s17, -1
    s_mul_i32 s64, s70, 32768
    v_add_u32 v6, s64, v6
    v_add_u32 v7, s64, v7
    s_mov_b32 s12, s4
    s_mov_b32 s13, s5
    s_mov_b32 s14, 256
    s_mov_b32 s15, 0x20000
    s_lshl_b32 s90, s2, 2
    s_add_u32 s90, s90, s16
    s_cmp_lg_u32 s90, 0
    s_cbranch_scc1 m_tok10
    s_memrealtime s[92:93]
    s_waitcnt lgkmcnt(0)
    s_or_b32 s92, s92, 1
    v_mov_b32 v4, s92
    v_mov_b32 v5, s93
    s_mov_b64 exec, 1
    buffer_store_dwordx2 v[4:5], off, s[12:15], 0 sc1
    s_mov_b64 exec, -1
m_tok10:
    s_cmp_eq_u32 s70, 0
    s_cbranch_scc1 m_tok11
    buffer_load_dwordx2 v[4:5], off, s[12:15], 0 sc1
    s_waitcnt vmcnt(0)
    s_mov_b32 s3, 1048576
m_spin12:
    v_readfirstlane_b32 s4, v4
    v_readfirstlane_b32 s5, v5
    s_nop 3
    s_cmp_lg_u32 s4, 0
    s_cbranch_scc1 m_ok13
    s_sub_u32 s3, s3, 1
    s_cbranch_scc1 m_ok13
    s_sleep 32
    buffer_load_dwordx2 v[4:5], off, s[12:15], 0 sc1
    s_waitcnt vmcnt(0)
    s_branch m_spin12
m_ok13:
m_tok11:
    s_add_u32 m0, s61, 0
    s_nop 0
    buffer_load_dwordx4 v16, s[40:43], s48 offen offset:0 sc1 lds
    buffer_load_dwordx4 v17, s[40:43], s48 offen offset:1024 sc1 lds
    s_add_u32 s48, s48, 128
    buffer_load_dwordx4 v16, s[40:43], s49 offen offset:2048 sc1 lds
    buffer_load_dwordx4 v17, s[40:43], s49 offen offset:3072 sc1 lds
    s_add_u32 s49, s49, 128
    s_add_u32 m0, s61, 4096
    s_nop 0
    buffer_load_dwordx4 v16, s[40:43], s50 offen offset:0 sc1 lds
    buffer_load_dwordx4 v17, s[40:43], s50 offen offset:1024 sc1 lds
    s_add_u32 s50, s50, 128
    buffer_load_dwordx4 v16, s[40:43], s51 offen offset:2048 sc1 lds
    buffer_load_dwordx4 v17, s[40:43], s51 offen offset:3072 sc1 lds
    s_add_u32 s51, s51, 128
    s_add_u32 s61, s61, 32768
    s_cmp_ge_u32 s61, 98304
    s_cselect_b32 s90, 98304, 0
    s_sub_u32 s61, s61, s90
    s_add_u32 m0, s62, 0
    s_nop 0
    buffer_load_dwordx4 v18, s[44:47], s52 offen offset:0 sc1 lds
    buffer_load_dwordx4 v19, s[44:47], s52 offen offset:1024 sc1 lds
    s_add_u32 s52, s52, s56
    buffer_load_dwordx4 v18, s[44:47], s53 offen offset:2048 sc1 lds
    buffer_load_dwordx4 v19, s[44:47], s53 offen offset:3072 sc1 lds
    s_add_u32 s53, s53, s56
    s_add_u32 m0, s62, 4096
    s_nop 0
    buffer_load_dwordx4 v20, s[44:47], s54 offen offset:0 sc1 lds
    buffer_load_dwordx4 v21, s[44:47], s54 offen offset:1024 sc1 lds
    s_add_u32 s54, s54, s56
    buffer_load_dwordx4 v20, s[44:47], s55 offen offset:2048 sc1 lds
    buffer_load_dwordx4 v21, s[44:47], s55 offen offset:3072 sc1 lds
    s_add_u32 s55, s55, s56
    s_xor_b32 s62, s62, 229376
    s_waitcnt vmcnt(16)
    s_barrier
    ds_read_b64_tr_b16 a[64:65], v8 offset:0
    ds_read_b64_tr_b16 a[66:67], v8 offset:2048
    ds_read_b64_tr_b16 a[68:69], v8 offset:16384
    ds_read_b64_tr_b16 a[70:71], v8 offset:18432
    ds_read_b64_tr_b16 a[72:73], v9 offset:0
    ds_read_b64_tr_b16 a[74:75], v9 offset:2048
    ds_read_b64_tr_b16 a[76:77], v9 offset:16384
    ds_read_b64_tr_b16 a[78:79], v9 offset:18432
    ds_read_b64_tr_b16 a[80:81], v10 offset:0
    ds_read_b64_tr_b16 a[82:83], v10 offset:2048
    ds_read_b64_tr_b16 a[84:85], v10 offset:16384
    ds_read_b64_tr_b16 a[86:87], v10 offset:18432
    ds_read_b64_tr_b16 a[88:89], v11 offset:0
    ds_read_b64_tr_b16 a[90:91], v11 offset:2048
    ds_read_b64_tr_b16 a[92:93], v11 offset:16384
    ds_read_b64_tr_b16 a[94:95], v11 offset:18432
    ds_read_b64_tr_b16 a[96:97], v12 offset:0
    ds_read_b128 a[0:3], v6 offset:0
    ds_read_b128 a[4:7], v7 offset:0
    ds_read_b64_tr_b16 a[98:99], v12 offset:2048
    ds_read_b128 a[8:11], v6 offset:2048
    ds_read_b128 a[12:15], v7 offset:2048
    ds_read_b64_tr_b16 a[100:101], v12 offset:16384
    ds_read_b128 a[16:19], v6 offset:4096
    ds_read_b128 a[20:23], v7 offset:4096
    ds_read_b64_tr_b16 a[102:103], v12 offset:18432
    ds_read_b128 a[24:27], v6 offset:6144
    ds_read_b128 a[28:31], v7 offset:6144
    ds_read_b64_tr_b16 a[104:105], v13 offset:0
    ds_read_b128 a[32:35], v6 offset:8192
    ds_read_b128 a[36:39], v7 offset:8192
    ds_read_b64_tr_b16 a[106:107], v13 offset:2048
    ds_read_b128 a[40:43], v6 offset:10240
    ds_read_b128 a[44:47], v7 offset:10240
    ds_read_b64_tr_b16 a[108:109], v13 offset:16384
    ds_read_b128 a[48:51], v6 offset:12288
    ds_read_b128 a[52:55], v7 offset:12288
    ds_read_b64_tr_b16 a[110:111], v13 offset:18432
    ds_read_b128 a[56:59], v6 offset:14336
    ds_read_b128 a[60:63], v7 offset:14336
    s_add_u32 m0, s61, 0
    s_nop 0
    buffer_load_dwordx4 v16, s[40:43], s48 offen offset:0 sc1 lds
    buffer_load_dwordx4 v17, s[40:43], s48 offen offset:1024 sc1 lds
    s_add_u32 s48, s48, 128
    buffer_load_dwordx4 v16, s[40:43], s49 offen offset:2048 sc1 lds
    buffer_load_dwordx4 v17, s[40:43], s49 offen offset:3072 sc1 lds
    s_add_u32 s49, s49, 128
    s_add_u32 m0, s61, 4096
    s_nop 0
    buffer_load_dwordx4 v16, s[40:43], s50 offen offset:0 sc1 lds
    buffer_load_dwordx4 v17, s[40:43], s50 offen offset:1024 sc1 lds
    s_add_u32 s50, s50, 128
    buffer_load_dwordx4 v16, s[40:43], s51 offen offset:2048 sc1 lds
    buffer_load_dwordx4 v17, s[40:43], s51 offen offset:3072 sc1 lds
    s_add_u32 s51, s51, 128
    s_add_u32 s61, s61, 32768
    s_cmp_ge_u32 s61, 98304
    s_cselect_b32 s90, 98304, 0
    s_sub_u32 s61, s61, s90
    s_mov_b32 s66, 1
    s_mov_b32 s24, s6
    s_mov_b32 s25, s7
    s_mov_b32 s26, 0
    s_mov_b32 s27, 0x20000
    s_mov_b32 s28, 0
    s_mov_b32 s29, 0
    s_mov_b32 s30, 0
    s_mov_b32 s31, 0
m_tile14:
    s_mov_b32 s65, s95
    s_cmp_eq_u32 s96, 1
    s_cbranch_scc1 m_swp16
    s_waitcnt lgkmcnt(15)
    v_mfma_f32_16x16x32_bf16 v[32:35], a[64:67], a[0:3], 0
    ds_read_b64_tr_b16 a[112:113], v14 offset:0
    v_mfma_f32_16x16x32_bf16 v[32:35], a[68:71], a[4:7], v[32:35]
    ds_read_b64_tr_b16 a[114:115], v14 offset:2048
    v_mfma_f32_16x16x32_bf16 v[36:39], a[76:79], a[4:7], 0
    ds_read_b64_tr_b16 a[116:117], v14 offset:16384
    v_mfma_f32_16x16x32_bf16 v[36:39], a[72:75], a[0:3], v[36:39]
    ds_read_b64_tr_b16 a[118:119], v14 offset:18432
    v_mfma_f32_16x16x32_bf16 v[44:47], a[72:75], a[8:11], 0
    ds_read_b64_tr_b16 a[120:121], v15 offset:0
    v_mfma_f32_16x16x32_bf16 v[44:47], a[76:79], a[12:15], v[44:47]
    ds_read_b64_tr_b16 a[122:123], v15 offset:2048
    v_mfma_f32_16x16x32_bf16 v[40:43], a[68:71], a[12:15], 0
    ds_read_b64_tr_b16 a[124:125], v15 offset:16384
    v_mfma_f32_16x16x32_bf16 v[40:43], a[64:67], a[8:11], v[40:43]
    ds_read_b64_tr_b16 a[126:127], v15 offset:18432
    v_mfma_f32_16x16x32_bf16 v[48:51], a[64:67], a[16:19], 0
    v_mfma_f32_16x16x32_bf16 v[48:51], a[68:71], a[20:23], v[48:51]
    v_mfma_f32_16x16x32_bf16 v[52:55], a[76:79], a[20:23], 0
    buffer_store_dwordx4 a[128:131], v2, s[24:27], s28 offen sc1
    v_mfma_f32_16x16x32_bf16 v[52:55], a[72:75], a[16:19], v[52:55]
    s_add_u32 s28, s28, s31
    s_waitcnt lgkmcnt(15)
    v_mfma_f32_16x16x32_bf16 v[60:63], a[72:75], a[24:27], 0
    v_xor_b32 v8, s60, v8
    v_xor_b32 v9, s60, v9
    v_mfma_f32_16x16x32_bf16 v[60:63], a[76:79], a[28:31], v[60:63]
    v_xor_b32 v10, s60, v10
    v_xor_b32 v11, s60, v11
    v_mfma_f32_16x16x32_bf16 v[56:59], a[68:71], a[28:31], 0
    v_xor_b32 v12, s60, v12
    v_xor_b32 v13, s60, v13
    v_mfma_f32_16x16x32_bf16 v[56:59], a[64:67], a[24:27], v[56:59]
    v_xor_b32 v14, s60, v14
    v_xor_b32 v15, s60, v15
    v_mfma_f32_16x16x32_bf16 v[64:67], a[64:67], a[32:35], 0
    buffer_store_dwordx4 a[132:135], v2, s[24:27], s28 offen sc1
    v_mfma_f32_16x16x32_bf16 v[64:67], a[68:71], a[36:39], v[64:67]
    s_add_u32 s28, s28, s31
    v_mfma_f32_16x16x32_bf16 v[68:71], a[76:79], a[36:39], 0
    v_mfma_f32_16x16x32_bf16 v[68:71], a[72:75], a[32:35], v[68:71]
    s_waitcnt lgkmcnt(14)
    v_mfma_f32_16x16x32_bf16 v[76:79], a[72:75], a[40:43], 0
    v_mfma_f32_16x16x32_bf16 v[76:79], a[76:79], a[44:47], v[76:79]
    v_mfma_f32_16x16x32_bf16 v[72:75], a[68:71], a[44:47], 0
    buffer_store_dwordx4 a[136:139], v2, s[24:27], s28 offen sc1
    v_mfma_f32_16x16x32_bf16 v[72:75], a[64:67], a[40:43], v[72:75]
    s_add_u32 s28, s28, s31
    s_waitcnt lgkmcnt(11)
    v_mfma_f32_16x16x32_bf16 v[80:83], a[64:67], a[48:51], 0
    v_mfma_f32_16x16x32_bf16 v[80:83], a[68:71], a[52:55], v[80:83]
    v_mfma_f32_16x16x32_bf16 v[84:87], a[76:79], a[52:55], 0
    v_mfma_f32_16x16x32_bf16 v[84:87], a[72:75], a[48:51], v[84:87]
    s_waitcnt lgkmcnt(8)
    v_mfma_f32_16x16x32_bf16 v[92:95], a[72:75], a[56:59], 0
    buffer_store_dwordx4 a[140:143], v2, s[24:27], s28 offen sc1
    v_mfma_f32_16x16x32_bf16 v[92:95], a[76:79], a[60:63], v[92:95]
    s_add_u32 s28, s28, s31
    v_mfma_f32_16x16x32_bf16 v[88:91], a[68:71], a[60:63], 0
    s_waitcnt vmcnt(44) lgkmcnt(0)
    s_cmp_eq_u32 s66, 2
    s_cbranch_scc1 m_w17
    s_waitcnt vmcnt(12)
m_w17:
    v_mfma_f32_16x16x32_bf16 v[88:91], a[64:67], a[56:59], v[88:91]
    s_barrier
    v_mfma_f32_16x16x32_bf16 v[96:99], a[80:83], a[0:3], 0
    ds_read_b64_tr_b16 a[64:65], v8 offset:0
    v_mfma_f32_16x16x32_bf16 v[96:99], a[84:87], a[4:7], v[96:99]
    s_add_u32 m0, s62, 0
    v_mfma_f32_16x16x32_bf16 v[100:103], a[92:95], a[4:7], 0
    buffer_load_dwordx4 v18, s[44:47], s52 offen offset:0 sc1 lds
    v_mfma_f32_16x16x32_bf16 v[100:103], a[88:91], a[0:3], v[100:103]
    ds_read_b64_tr_b16 a[66:67], v8 offset:2048
    v_mfma_f32_16x16x32_bf16 v[108:111], a[88:91], a[8:11], 0
    s_add_u32 s64, s64, 32768
    v_mfma_f32_16x16x32_bf16 v[108:111], a[92:95], a[12:15], v[108:111]
    s_cmp_ge_u32 s64, 98304
    s_cselect_b32 s63, 4294901760, s59
    s_cselect_b32 s64, 0, s64
    v_mfma_f32_16x16x32_bf16 v[104:107], a[84:87], a[12:15], 0
    buffer_load_dwordx4 v19, s[44:47], s52 offen offset:1024 sc1 lds
    v_mfma_f32_16x16x32_bf16 v[104:107], a[80:83], a[8:11], v[104:107]
    s_add_u32 s52, s52, s56
    ds_read_b64_tr_b16 a[68:69], v8 offset:16384
    v_mfma_f32_16x16x32_bf16 v[112:115], a[80:83], a[16:19], 0
    v_mfma_f32_16x16x32_bf16 v[112:115], a[84:87], a[20:23], v[112:115]
    v_mfma_f32_16x16x32_bf16 v[116:119], a[92:95], a[20:23], 0
    buffer_load_dwordx4 v18, s[44:47], s53 offen offset:2048 sc1 lds
    v_mfma_f32_16x16x32_bf16 v[116:119], a[88:91], a[16:19], v[116:119]
    ds_read_b64_tr_b16 a[70:71], v8 offset:18432
    v_mfma_f32_16x16x32_bf16 v[124:127], a[88:91], a[24:27], 0
    v_mfma_f32_16x16x32_bf16 v[124:127], a[92:95], a[28:31], v[124:127]
    v_mfma_f32_16x16x32_bf16 v[120:123], a[84:87], a[28:31], 0
    buffer_load_dwordx4 v19, s[44:47], s53 offen offset:3072 sc1 lds
    v_mfma_f32_16x16x32_bf16 v[120:123], a[80:83], a[24:27], v[120:123]
    s_add_u32 s53, s53, s56
    ds_read_b64_tr_b16 a[72:73], v9 offset:0
    v_mfma_f32_16x16x32_bf16 v[128:131], a[80:83], a[32:35], 0
    v_mfma_f32_16x16x32_bf16 v[128:131], a[84:87], a[36:39], v[128:131]
    s_add_u32 m0, s62, 4096
    v_mfma_f32_16x16x32_bf16 v[132:135], a[92:95], a[36:39], 0
    buffer_load_dwordx4 v20, s[44:47], s54 offen offset:0 sc1 lds
    v_mfma_f32_16x16x32_bf16 v[132:135], a[88:91], a[32:35], v[132:135]
    s_xor_b32 s62, s62, 229376
    ds_read_b64_tr_b16 a[74:75], v9 offset:2048
    v_mfma_f32_16x16x32_bf16 v[140:143], a[88:91], a[40:43], 0
    v_mfma_f32_16x16x32_bf16 v[140:143], a[92:95], a[44:47], v[140:143]
    v_mfma_f32_16x16x32_bf16 v[136:139], a[84:87], a[44:47], 0
    buffer_load_dwordx4 v21, s[44:47], s54 offen offset:1024 sc1 lds
    v_mfma_f32_16x16x32_bf16 v[136:139], a[80:83], a[40:43], v[136:139]
    s_add_u32 s54, s54, s56
    ds_read_b64_tr_b16 a[76:77], v9 offset:16384
    v_mfma_f32_16x16x32_bf16 v[144:147], a[80:83], a[48:51], 0
    v_mfma_f32_16x16x32_bf16 v[144:147], a[84:87], a[52:55], v[144:147]
    v_mfma_f32_16x16x32_bf16 v[148:151], a[92:95], a[52:55], 0
    buffer_load_dwordx4 v20, s[44:47], s55 offen offset:2048 sc1 lds
    v_mfma_f32_16x16x32_bf16 v[148:151], a[88:91], a[48:51], v[148:151]
    ds_read_b64_tr_b16 a[78:79], v9 offset:18432
    v_mfma_f32_16x16x32_bf16 v[156:159], a[88:91], a[56:59], 0
    v_add_u32 v6, s63, v6
    v_add_u32 v7, s63, v7
    v_mfma_f32_16x16x32_bf16 v[156:159], a[92:95], a[60:63], v[156:159]
    v_mfma_f32_16x16x32_bf16 v[152:155], a[84:87], a[60:63], 0
    buffer_load_dwordx4 v21, s[44:47], s55 offen offset:3072 sc1 lds
    v_mfma_f32_16x16x32_bf16 v[152:155], a[80:83], a[56:59], v[152:155]
    s_add_u32 s55, s55, s56
    v_mfma_f32_16x16x32_bf16 v[160:163], a[96:99], a[0:3], 0
    ds_read_b64_tr_b16 a[80:81], v10 offset:0
    v_mfma_f32_16x16x32_bf16 v[160:163], a[100:103], a[4:7], v[160:163]
    v_mfma_f32_16x16x32_bf16 v[164:167], a[108:111], a[4:7], 0
    v_mfma_f32_16x16x32_bf16 v[164:167], a[104:107], a[0:3], v[164:167]
    s_add_u32 m0, s61, 0
    ds_read_b64_tr_b16 a[82:83], v10 offset:2048
    v_mfma_f32_16x16x32_bf16 v[172:175], a[104:107], a[8:11], 0
    buffer_load_dwordx4 v16, s[40:43], s48 offen offset:0 sc1 lds
    v_mfma_f32_16x16x32_bf16 v[172:175], a[108:111], a[12:15], v[172:175]
    v_mfma_f32_16x16x32_bf16 v[168:171], a[100:103], a[12:15], 0
    ds_read_b64_tr_b16 a[84:85], v10 offset:16384
    v_mfma_f32_16x16x32_bf16 v[168:171], a[96:99], a[8:11], v[168:171]
    v_mfma_f32_16x16x32_bf16 v[176:179], a[96:99], a[16:19], 0
    buffer_store_dwordx4 a[144:147], v2, s[24:27], s28 offen sc1
    v_mfma_f32_16x16x32_bf16 v[176:179], a[100:103], a[20:23], v[176:179]
    s_add_u32 s28, s28, s31
    ds_read_b64_tr_b16 a[86:87], v10 offset:18432
    v_mfma_f32_16x16x32_bf16 v[180:183], a[108:111], a[20:23], 0
    v_mfma_f32_16x16x32_bf16 v[180:183], a[104:107], a[16:19], v[180:183]
    v_mfma_f32_16x16x32_bf16 v[188:191], a[104:107], a[24:27], 0
    buffer_load_dwordx4 v17, s[40:43], s48 offen offset:1024 sc1 lds
    v_mfma_f32_16x16x32_bf16 v[188:191], a[108:111], a[28:31], v[188:191]
    s_add_u32 s48, s48, 128
    ds_read_b64_tr_b16 a[88:89], v11 offset:0
    v_mfma_f32_16x16x32_bf16 v[184:187], a[100:103], a[28:31], 0
    v_mfma_f32_16x16x32_bf16 v[184:187], a[96:99], a[24:27], v[184:187]
    v_mfma_f32_16x16x32_bf16 v[192:195], a[96:99], a[32:35], 0
    buffer_store_dwordx4 a[148:151], v2, s[24:27], s28 offen sc1
    v_mfma_f32_16x16x32_bf16 v[192:195], a[100:103], a[36:39], v[192:195]
    s_add_u32 s28, s28, s31
    ds_read_b64_tr_b16 a[90:91], v11 offset:2048
    v_mfma_f32_16x16x32_bf16 v[196:199], a[108:111], a[36:39], 0
    v_mfma_f32_16x16x32_bf16 v[196:199], a[104:107], a[32:35], v[196:199]
    v_mfma_f32_16x16x32_bf16 v[204:207], a[104:107], a[40:43], 0
    buffer_load_dwordx4 v16, s[40:43], s49 offen offset:2048 sc1 lds
    v_mfma_f32_16x16x32_bf16 v[204:207], a[108:111], a[44:47], v[204:207]
    ds_read_b64_tr_b16 a[92:93], v11 offset:16384
    v_mfma_f32_16x16x32_bf16 v[200:203], a[100:103], a[44:47], 0
    v_mfma_f32_16x16x32_bf16 v[200:203], a[96:99], a[40:43], v[200:203]
    v_mfma_f32_16x16x32_bf16 v[208:211], a[96:99], a[48:51], 0
    buffer_store_dwordx4 a[152:155], v2, s[24:27], s28 offen sc1
    v_mfma_f32_16x16x32_bf16 v[208:211], a[100:103], a[52:55], v[208:211]
    s_add_u32 s28, s28, s31
    ds_read_b64_tr_b16 a[94:95], v11 offset:18432
    v_mfma_f32_16x16x32_bf16 v[212:215], a[108:111], a[52:55], 0
    v_mfma_f32_16x16x32_bf16 v[212:215], a[104:107], a[48:51], v[212:215]
    v_mfma_f32_16x16x32_bf16 v[220:223], a[104:107], a[56:59], 0
    buffer_load_dwordx4 v17, s[40:43], s49 offen offset:3072 sc1 lds
    v_mfma_f32_16x16x32_bf16 v[220:223], a[108:111], a[60:63], v[220:223]
    s_add_u32 s49, s49, 128
    v_mfma_f32_16x16x32_bf16 v[216:219], a[100:103], a[60:63], 0
    buffer_store_dwordx4 a[156:159], v2, s[24:27], s28 offen sc1
    v_mfma_f32_16x16x32_bf16 v[216:219], a[96:99], a[56:59], v[216:219]
    s_add_u32 s29, s29, s30
    s_mov_b32 s28, s29
    v_mfma_f32_16x16x32_bf16 v[224:227], a[112:115], a[0:3], 0
    v_mfma_f32_16x16x32_bf16 v[224:227], a[116:119], a[4:7], v[224:227]
    ds_read_b64_tr_b16 a[96:97], v12 offset:0
    v_mfma_f32_16x16x32_bf16 v[228:231], a[124:127], a[4:7], 0
    v_mfma_f32_16x16x32_bf16 v[228:231], a[120:123], a[0:3], v[228:231]
    s_add_u32 m0, s61, 4096
    ds_read_b128 a[0:3], v6 offset:0
    v_mfma_f32_16x16x32_bf16 v[236:239], a[120:123], a[8:11], 0
    buffer_load_dwordx4 v16, s[40:43], s50 offen offset:0 sc1 lds
    v_mfma_f32_16x16x32_bf16 v[236:239], a[124:127], a[12:15], v[236:239]
    s_add_u32 s61, s61, 32768
    ds_read_b128 a[4:7], v7 offset:0
    v_mfma_f32_16x16x32_bf16 v[232:235], a[116:119], a[12:15], 0
    s_cmp_ge_u32 s61, 98304
    s_cselect_b32 s90, 98304, 0
    ds_read_b64_tr_b16 a[98:99], v12 offset:2048
    v_mfma_f32_16x16x32_bf16 v[232:235], a[112:115], a[8:11], v[232:235]
    s_sub_u32 s61, s61, s90
    ds_read_b128 a[8:11], v6 offset:2048
    v_mfma_f32_16x16x32_bf16 v[240:243], a[112:115], a[16:19], 0
    ds_read_b128 a[12:15], v7 offset:2048
    v_mfma_f32_16x16x32_bf16 v[240:243], a[116:119], a[20:23], v[240:243]
    ds_read_b64_tr_b16 a[100:101], v12 offset:16384
    v_mfma_f32_16x16x32_bf16 v[244:247], a[124:127], a[20:23], 0
    v_mfma_f32_16x16x32_bf16 v[244:247], a[120:123], a[16:19], v[244:247]
    ds_read_b128 a[16:19], v6 offset:4096
    v_mfma_f32_16x16x32_bf16 v[252:255], a[120:123], a[24:27], 0
    buffer_load_dwordx4 v17, s[40:43], s50 offen offset:1024 sc1 lds
    v_mfma_f32_16x16x32_bf16 v[252:255], a[124:127], a[28:31], v[252:255]
    s_add_u32 s50, s50, 128
    ds_read_b128 a[20:23], v7 offset:4096
    v_mfma_f32_16x16x32_bf16 v[248:251], a[116:119], a[28:31], 0
    ds_read_b64_tr_b16 a[102:103], v12 offset:18432
    v_mfma_f32_16x16x32_bf16 v[248:251], a[112:115], a[24:27], v[248:251]
    ds_read_b128 a[24:27], v6 offset:6144
    v_mfma_f32_16x16x32_bf16 a[224:227], a[112:115], a[32:35], 0
    s_sub_u32 s65, s65, 1
    ds_read_b128 a[28:31], v7 offset:6144
    v_mfma_f32_16x16x32_bf16 a[224:227], a[116:119], a[36:39], a[224:227]
    ds_read_b64_tr_b16 a[104:105], v13 offset:0
    v_mfma_f32_16x16x32_bf16 a[228:231], a[124:127], a[36:39], 0
    v_mfma_f32_16x16x32_bf16 a[228:231], a[120:123], a[32:35], a[228:231]
    ds_read_b128 a[32:35], v6 offset:8192
    v_mfma_f32_16x16x32_bf16 a[236:239], a[120:123], a[40:43], 0
    buffer_load_dwordx4 v16, s[40:43], s51 offen offset:2048 sc1 lds
    v_mfma_f32_16x16x32_bf16 a[236:239], a[124:127], a[44:47], a[236:239]
    ds_read_b128 a[36:39], v7 offset:8192
    v_mfma_f32_16x16x32_bf16 a[232:235], a[116:119], a[44:47], 0
    ds_read_b64_tr_b16 a[106:107], v13 offset:2048
    v_mfma_f32_16x16x32_bf16 a[232:235], a[112:115], a[40:43], a[232:235]
    ds_read_b128 a[40:43], v6 offset:10240
    v_mfma_f32_16x16x32_bf16 a[240:243], a[112:115], a[48:51], 0
    ds_read_b128 a[44:47], v7 offset:10240
    v_mfma_f32_16x16x32_bf16 a[240:243], a[116:119], a[52:55], a[240:243]
    ds_read_b64_tr_b16 a[108:109], v13 offset:16384
    v_mfma_f32_16x16x32_bf16 a[244:247], a[124:127], a[52:55], 0
    v_mfma_f32_16x16x32_bf16 a[244:247], a[120:123], a[48:51], a[244:247]
    ds_read_b128 a[48:51], v6 offset:12288
    v_mfma_f32_16x16x32_bf16 a[252:255], a[120:123], a[56:59], 0
    buffer_load_dwordx4 v17, s[40:43], s51 offen offset:3072 sc1 lds
    v_mfma_f32_16x16x32_bf16 a[252:255], a[124:127], a[60:63], a[252:255]
    s_add_u32 s51, s51, 128
    ds_read_b128 a[52:55], v7 offset:12288
    v_mfma_f32_16x16x32_bf16 a[248:251], a[116:119], a[60:63], 0
    ds_read_b64_tr_b16 a[110:111], v13 offset:18432
    v_mfma_f32_16x16x32_bf16 a[248:251], a[112:115], a[56:59], a[248:251]
    ds_read_b128 a[56:59], v6 offset:14336
    ds_read_b128 a[60:63], v7 offset:14336
    s_waitcnt lgkmcnt(15)
    v_mfma_f32_16x16x32_bf16 v[32:35], a[64:67], a[0:3], v[32:35]
    ds_read_b64_tr_b16 a[112:113], v14 offset:0
    v_mfma_f32_16x16x32_bf16 v[32:35], a[68:71], a[4:7], v[32:35]
    ds_read_b64_tr_b16 a[114:115], v14 offset:2048
    v_mfma_f32_16x16x32_bf16 v[36:39], a[76:79], a[4:7], v[36:39]
    ds_read_b64_tr_b16 a[116:117], v14 offset:16384
    v_mfma_f32_16x16x32_bf16 v[36:39], a[72:75], a[0:3], v[36:39]
    ds_read_b64_tr_b16 a[118:119], v14 offset:18432
    v_mfma_f32_16x16x32_bf16 v[44:47], a[72:75], a[8:11], v[44:47]
    ds_read_b64_tr_b16 a[120:121], v15 offset:0
    v_mfma_f32_16x16x32_bf16 v[44:47], a[76:79], a[12:15], v[44:47]
    ds_read_b64_tr_b16 a[122:123], v15 offset:2048
    v_mfma_f32_16x16x32_bf16 v[40:43], a[68:71], a[12:15], v[40:43]
    ds_read_b64_tr_b16 a[124:125], v15 offset:16384
    v_mfma_f32_16x16x32_bf16 v[40:43], a[64:67], a[8:11], v[40:43]
    ds_read_b64_tr_b16 a[126:127], v15 offset:18432
    v_mfma_f32_16x16x32_bf16 v[48:51], a[64:67], a[16:19], v[48:51]
    v_mfma_f32_16x16x32_bf16 v[48:51], a[68:71], a[20:23], v[48:51]
    v_mfma_f32_16x16x32_bf16 v[52:55], a[76:79], a[20:23], v[52:55]
    buffer_store_dwordx4 a[160:163], v2, s[24:27], s28 offen sc1
    v_mfma_f32_16x16x32_bf16 v[52:55], a[72:75], a[16:19], v[52:55]
    s_add_u32 s28, s28, s31
    s_waitcnt lgkmcnt(15)
    v_mfma_f32_16x16x32_bf16 v[60:63], a[72:75], a[24:27], v[60:63]
    v_xor_b32 v8, s60, v8
    v_xor_b32 v9, s60, v9
    v_mfma_f32_16x16x32_bf16 v[60:63], a[76:79], a[28:31], v[60:63]
    v_xor_b32 v10, s60, v10
    v_xor_b32 v11, s60, v11
    v_mfma_f32_16x16x32_bf16 v[56:59], a[68:71], a[28:31], v[56:59]
    v_xor_b32 v12, s60, v12
    v_xor_b32 v13, s60, v13
    v_mfma_f32_16x16x32_bf16 v[56:59], a[64:67], a[24:27], v[56:59]
    v_xor_b32 v14, s60, v14
    v_xor_b32 v15, s60, v15
    v_mfma_f32_16x16x32_bf16 v[64:67], a[64:67], a[32:35], v[64:67]
    buffer_store_dwordx4 a[164:167], v2, s[24:27], s28 offen sc1
    v_mfma_f32_16x16x32_bf16 v[64:67], a[68:71], a[36:39], v[64:67]
    s_add_u32 s28, s28, s31
    v_mfma_f32_16x16x32_bf16 v[68:71], a[76:79], a[36:39], v[68:71]
    v_mfma_f32_16x16x32_bf16 v[68:71], a[72:75], a[32:35], v[68:71]
    s_waitcnt lgkmcnt(14)
    v_mfma_f32_16x16x32_bf16 v[76:79], a[72:75], a[40:43], v[76:79]
    v_mfma_f32_16x16x32_bf16 v[76:79], a[76:79], a[44:47], v[76:79]
    v_mfma_f32_16x16x32_bf16 v[72:75], a[68:71], a[44:47], v[72:75]
    buffer_store_dwordx4 a[168:171], v2, s[24:27], s28 offen sc1
    v_mfma_f32_16x16x32_bf16 v[72:75], a[64:67], a[40:43], v[72:75]
    s_add_u32 s28, s28, s31
    s_waitcnt lgkmcnt(11)
    v_mfma_f32_16x16x32_bf16 v[80:83], a[64:67], a[48:51], v[80:83]
    v_mfma_f32_16x16x32_bf16 v[80:83], a[68:71], a[52:55], v[80:83]
    v_mfma_f32_16x16x32_bf16 v[84:87], a[76:79], a[52:55], v[84:87]
    v_mfma_f32_16x16x32_bf16 v[84:87], a[72:75], a[48:51], v[84:87]
    s_waitcnt lgkmcnt(8)
    v_mfma_f32_16x16x32_bf16 v[92:95], a[72:75], a[56:59], v[92:95]
    buffer_store_dwordx4 a[172:175], v2, s[24:27], s28 offen sc1
    v_mfma_f32_16x16x32_bf16 v[92:95], a[76:79], a[60:63], v[92:95]
    s_add_u32 s28, s28, s31
    v_mfma_f32_16x16x32_bf16 v[88:91], a[68:71], a[60:63], v[88:91]
    s_waitcnt vmcnt(16) lgkmcnt(0)
    v_mfma_f32_16x16x32_bf16 v[88:91], a[64:67], a[56:59], v[88:91]
    s_barrier
    v_mfma_f32_16x16x32_bf16 v[96:99], a[80:83], a[0:3], v[96:99]
    ds_read_b64_tr_b16 a[64:65], v8 offset:0
    v_mfma_f32_16x16x32_bf16 v[96:99], a[84:87], a[4:7], v[96:99]
    s_add_u32 m0, s62, 0
    v_mfma_f32_16x16x32_bf16 v[100:103], a[92:95], a[4:7], v[100:103]
    buffer_load_dwordx4 v18, s[44:47], s52 offen offset:0 sc1 lds
    v_mfma_f32_16x16x32_bf16 v[100:103], a[88:91], a[0:3], v[100:103]
    ds_read_b64_tr_b16 a[66:67], v8 offset:2048
    v_mfma_f32_16x16x32_bf16 v[108:111], a[88:91], a[8:11], v[108:111]
    s_add_u32 s64, s64, 32768
    v_mfma_f32_16x16x32_bf16 v[108:111], a[92:95], a[12:15], v[108:111]
    s_cmp_ge_u32 s64, 98304
    s_cselect_b32 s63, 4294901760, s59
    s_cselect_b32 s64, 0, s64
    v_mfma_f32_16x16x32_bf16 v[104:107], a[84:87], a[12:15], v[104:107]
    buffer_load_dwordx4 v19, s[44:47], s52 offen offset:1024 sc1 lds
    v_mfma_f32_16x16x32_bf16 v[104:107], a[80:83], a[8:11], v[104:107]
    s_add_u32 s52, s52, s56
    ds_read_b64_tr_b16 a[68:69], v8 offset:16384
    v_mfma_f32_16x16x32_bf16 v[112:115], a[80:83], a[16:19], v[112:115]
    v_mfma_f32_16x16x32_bf16 v[112:115], a[84:87], a[20:23], v[112:115]
    v_mfma_f32_16x16x32_bf16 v[116:119], a[92:95], a[20:23], v[116:119]
    buffer_load_dwordx4 v18, s[44:47], s53 offen offset:2048 sc1 lds
    v_mfma_f32_16x16x32_bf16 v[116:119], a[88:91], a[16:19], v[116:119]
    ds_read_b64_tr_b16 a[70:71], v8 offset:18432
    v_mfma_f32_16x16x32_bf16 v[124:127], a[88:91], a[24:27], v[124:127]
    v_mfma_f32_16x16x32_bf16 v[124:127], a[92:95], a[28:31], v[124:127]
    v_mfma_f32_16x16x32_bf16 v[120:123], a[84:87], a[28:31], v[120:123]
    buffer_load_dwordx4 v19, s[44:47], s53 offen offset:3072 sc1 lds
    v_mfma_f32_16x16x32_bf16 v[120:123], a[80:83], a[24:27], v[120:123]
    s_add_u32 s53, s53, s56
    ds_read_b64_tr_b16 a[72:73], v9 offset:0
    v_mfma_f32_16x16x32_bf16 v[128:131], a[80:83], a[32:35], v[128:131]
    v_mfma_f32_16x16x32_bf16 v[128:131], a[84:87], a[36:39], v[128:131]
    s_add_u32 m0, s62, 4096
    v_mfma_f32_16x16x32_bf16 v[132:135], a[92:95], a[36:39], v[132:135]
    buffer_load_dwordx4 v20, s[44:47], s54 offen offset:0 sc1 lds
    v_mfma_f32_16x16x32_bf16 v[132:135], a[88:91], a[32:35], v[132:135]
    s_xor_b32 s62, s62, 229376
    ds_read_b64_tr_b16 a[74:75], v9 offset:2048
    v_mfma_f32_16x16x32_bf16 v[140:143], a[88:91], a[40:43], v[140:143]
    v_mfma_f32_16x16x32_bf16 v[140:143], a[92:95], a[44:47], v[140:143]
    v_mfma_f32_16x16x32_bf16 v[136:139], a[84:87], a[44:47], v[136:139]
    buffer_load_dwordx4 v21, s[44:47], s54 offen offset:1024 sc1 lds
    v_mfma_f32_16x16x32_bf16 v[136:139], a[80:83], a[40:43], v[136:139]
    s_add_u32 s54, s54, s56
    ds_read_b64_tr_b16 a[76:77], v9 offset:16384
    v_mfma_f32_16x16x32_bf16 v[144:147], a[80:83], a[48:51], v[144:147]
    v_mfma_f32_16x16x32_bf16 v[144:147], a[84:87], a[52:55], v[144:147]
    v_mfma_f32_16x16x32_bf16 v[148:151], a[92:95], a[52:55], v[148:151]
    buffer_load_dwordx4 v20, s[44:47], s55 offen offset:2048 sc1 lds
    v_mfma_f32_16x16x32_bf16 v[148:151], a[88:91], a[48:51], v[148:151]
    ds_read_b64_tr_b16 a[78:79], v9 offset:18432
    v_mfma_f32_16x16x32_bf16 v[156:159], a[88:91], a[56:59], v[156:159]
    v_add_u32 v6, s63, v6
    v_add_u32 v7, s63, v7
    v_mfma_f32_16x16x32_bf16 v[156:159], a[92:95], a[60:63], v[156:159]
    v_mfma_f32_16x16x32_bf16 v[152:155], a[84:87], a[60:63], v[152:155]
    buffer_load_dwordx4 v21, s[44:47], s55 offen offset:3072 sc1 lds
    v_mfma_f32_16x16x32_bf16 v[152:155], a[80:83], a[56:59], v[152:155]
    s_add_u32 s55, s55, s56
    v_mfma_f32_16x16x32_bf16 v[160:163], a[96:99], a[0:3], v[160:163]
    ds_read_b64_tr_b16 a[80:81], v10 offset:0
    v_mfma_f32_16x16x32_bf16 v[160:163], a[100:103], a[4:7], v[160:163]
    v_mfma_f32_16x16x32_bf16 v[164:167], a[108:111], a[4:7], v[164:167]
    v_mfma_f32_16x16x32_bf16 v[164:167], a[104:107], a[0:3], v[164:167]
    s_add_u32 m0, s61, 0
    ds_read_b64_tr_b16 a[82:83], v10 offset:2048
    v_mfma_f32_16x16x32_bf16 v[172:175], a[104:107], a[8:11], v[172:175]
    buffer_load_dwordx4 v16, s[40:43], s48 offen offset:0 sc1 lds
    v_mfma_f32_16x16x32_bf16 v[172:175], a[108:111], a[12:15], v[172:175]
    v_mfma_f32_16x16x32_bf16 v[168:171], a[100:103], a[12:15], v[168:171]
    ds_read_b64_tr_b16 a[84:85], v10 offset:16384
    v_mfma_f32_16x16x32_bf16 v[168:171], a[96:99], a[8:11], v[168:171]
    v_mfma_f32_16x16x32_bf16 v[176:179], a[96:99], a[16:19], v[176:179]
    buffer_store_dwordx4 a[176:179], v2, s[24:27], s28 offen sc1
    v_mfma_f32_16x16x32_bf16 v[176:179], a[100:103], a[20:23], v[176:179]
    s_add_u32 s28, s28, s31
    ds_read_b64_tr_b16 a[86:87], v10 offset:18432
    v_mfma_f32_16x16x32_bf16 v[180:183], a[108:111], a[20:23], v[180:183]
    v_mfma_f32_16x16x32_bf16 v[180:183], a[104:107], a[16:19], v[180:183]
    v_mfma_f32_16x16x32_bf16 v[188:191], a[104:107], a[24:27], v[188:191]
    buffer_load_dwordx4 v17, s[40:43], s48 offen offset:1024 sc1 lds
    v_mfma_f32_16x16x32_bf16 v[188:191], a[108:111], a[28:31], v[188:191]
    s_add_u32 s48, s48, 128
    ds_read_b64_tr_b16 a[88:89], v11 offset:0
    v_mfma_f32_16x16x32_bf16 v[184:187], a[100:103], a[28:31], v[184:187]
    v_mfma_f32_16x16x32_bf16 v[184:187], a[96:99], a[24:27], v[184:187]
    v_mfma_f32_16x16x32_bf16 v[192:195], a[96:99], a[32:35], v[192:195]
    buffer_store_dwordx4 a[180:183], v2, s[24:27], s28 offen sc1
    v_mfma_f32_16x16x32_bf16 v[192:195], a[100:103], a[36:39], v[192:195]
    s_add_u32 s28, s28, s31
    ds_read_b64_tr_b16 a[90:91], v11 offset:2048
    v_mfma_f32_16x16x32_bf16 v[196:199], a[108:111], a[36:39], v[196:199]
    v_mfma_f32_16x16x32_bf16 v[196:199], a[104:107], a[32:35], v[196:199]
    v_mfma_f32_16x16x32_bf16 v[204:207], a[104:107], a[40:43], v[204:207]
    buffer_load_dwordx4 v16, s[40:43], s49 offen offset:2048 sc1 lds
    v_mfma_f32_16x16x32_bf16 v[204:207], a[108:111], a[44:47], v[204:207]
    ds_read_b64_tr_b16 a[92:93], v11 offset:16384
    v_mfma_f32_16x16x32_bf16 v[200:203], a[100:103], a[44:47], v[200:203]
    v_mfma_f32_16x16x32_bf16 v[200:203], a[96:99], a[40:43], v[200:203]
    v_mfma_f32_16x16x32_bf16 v[208:211], a[96:99], a[48:51], v[208:211]
    buffer_store_dwordx4 a[184:187], v2, s[24:27], s28 offen sc1
    v_mfma_f32_16x16x32_bf16 v[208:211], a[100:103], a[52:55], v[208:211]
    s_add_u32 s28, s28, s31
    ds_read_b64_tr_b16 a[94:95], v11 offset:18432
    v_mfma_f32_16x16x32_bf16 v[212:215], a[108:111], a[52:55], v[212:215]
    v_mfma_f32_16x16x32_bf16 v[212:215], a[104:107], a[48:51], v[212:215]
    v_mfma_f32_16x16x32_bf16 v[220:223], a[104:107], a[56:59], v[220:223]
    buffer_load_dwordx4 v17, s[40:43], s49 offen offset:3072 sc1 lds
    v_mfma_f32_16x16x32_bf16 v[220:223], a[108:111], a[60:63], v[220:223]
    s_add_u32 s49, s49, 128
    v_mfma_f32_16x16x32_bf16 v[216:219], a[100:103], a[60:63], v[216:219]
    buffer_store_dwordx4 a[188:191], v2, s[24:27], s28 offen sc1
    v_mfma_f32_16x16x32_bf16 v[216:219], a[96:99], a[56:59], v[216:219]
    s_add_u32 s29, s29, s30
    s_mov_b32 s28, s29
    v_mfma_f32_16x16x32_bf16 v[224:227], a[112:115], a[0:3], v[224:227]
    v_mfma_f32_16x16x32_bf16 v[224:227], a[116:119], a[4:7], v[224:227]
    ds_read_b64_tr_b16 a[96:97], v12 offset:0
    v_mfma_f32_16x16x32_bf16 v[228:231], a[124:127], a[4:7], v[228:231]
    v_mfma_f32_16x16x32_bf16 v[228:231], a[120:123], a[0:3], v[228:231]
    s_add_u32 m0, s61, 4096
    ds_read_b128 a[0:3], v6 offset:0
    v_mfma_f32_16x16x32_bf16 v[236:239], a[120:123], a[8:11], v[236:239]
    buffer_load_dwordx4 v16, s[40:43], s50 offen offset:0 sc1 lds
    v_mfma_f32_16x16x32_bf16 v[236:239], a[124:127], a[12:15], v[236:239]
    s_add_u32 s61, s61, 32768
    ds_read_b128 a[4:7], v7 offset:0
    v_mfma_f32_16x16x32_bf16 v[232:235], a[116:119], a[12:15], v[232:235]
    s_cmp_ge_u32 s61, 98304
    s_cselect_b32 s90, 98304, 0
    ds_read_b64_tr_b16 a[98:99], v12 offset:2048
    v_mfma_f32_16x16x32_bf16 v[232:235], a[112:115], a[8:11], v[232:235]
    s_sub_u32 s61, s61, s90
    ds_read_b128 a[8:11], v6 offset:2048
    v_mfma_f32_16x16x32_bf16 v[240:243], a[112:115], a[16:19], v[240:243]
    ds_read_b128 a[12:15], v7 offset:2048
    v_mfma_f32_16x16x32_bf16 v[240:243], a[116:119], a[20:23], v[240:243]
    ds_read_b64_tr_b16 a[100:101], v12 offset:16384
    v_mfma_f32_16x16x32_bf16 v[244:247], a[124:127], a[20:23], v[244:247]
    v_mfma_f32_16x16x32_bf16 v[244:247], a[120:123], a[16:19], v[244:247]
    ds_read_b128 a[16:19], v6 offset:4096
    v_mfma_f32_16x16x32_bf16 v[252:255], a[120:123], a[24:27], v[252:255]
    buffer_load_dwordx4 v17, s[40:43], s50 offen offset:1024 sc1 lds
    v_mfma_f32_16x16x32_bf16 v[252:255], a[124:127], a[28:31], v[252:255]
    s_add_u32 s50, s50, 128
    ds_read_b128 a[20:23], v7 offset:4096
    v_mfma_f32_16x16x32_bf16 v[248:251], a[116:119], a[28:31], v[248:251]
    ds_read_b64_tr_b16 a[102:103], v12 offset:18432
    v_mfma_f32_16x16x32_bf16 v[248:251], a[112:115], a[24:27], v[248:251]
    ds_read_b128 a[24:27], v6 offset:6144
    v_mfma_f32_16x16x32_bf16 a[224:227], a[112:115], a[32:35], a[224:227]
    s_sub_u32 s65, s65, 1
    ds_read_b128 a[28:31], v7 offset:6144
    v_mfma_f32_16x16x32_bf16 a[224:227], a[116:119], a[36:39], a[224:227]
    ds_read_b64_tr_b16 a[104:105], v13 offset:0
    v_mfma_f32_16x16x32_bf16 a[228:231], a[124:127], a[36:39], a[228:231]
    v_mfma_f32_16x16x32_bf16 a[228:231], a[120:123], a[32:35], a[228:231]
    ds_read_b128 a[32:35], v6 offset:8192
    v_mfma_f32_16x16x32_bf16 a[236:239], a[120:123], a[40:43], a[236:239]
    buffer_load_dwordx4 v16, s[40:43], s51 offen offset:2048 sc1 lds
    v_mfma_f32_16x16x32_bf16 a[236:239], a[124:127], a[44:47], a[236:239]
    ds_read_b128 a[36:39], v7 offset:8192
    v_mfma_f32_16x16x32_bf16 a[232:235], a[116:119], a[44:47], a[232:235]
    ds_read_b64_tr_b16 a[106:107], v13 offset:2048
    v_mfma_f32_16x16x32_bf16 a[232:235], a[112:115], a[40:43], a[232:235]
    ds_read_b128 a[40:43], v6 offset:10240
    v_mfma_f32_16x16x32_bf16 a[240:243], a[112:115], a[48:51], a[240:243]
    ds_read_b128 a[44:47], v7 offset:10240
    v_mfma_f32_16x16x32_bf16 a[240:243], a[116:119], a[52:55], a[240:243]
    ds_read_b64_tr_b16 a[108:109], v13 offset:16384
    v_mfma_f32_16x16x32_bf16 a[244:247], a[124:127], a[52:55], a[244:247]
    v_mfma_f32_16x16x32_bf16 a[244:247], a[120:123], a[48:51], a[244:247]
    ds_read_b128 a[48:51], v6 offset:12288
    v_mfma_f32_16x16x32_bf16 a[252:255], a[120:123], a[56:59], a[252:255]
    buffer_load_dwordx4 v17, s[40:43], s51 offen offset:3072 sc1 lds
    v_mfma_f32_16x16x32_bf16 a[252:255], a[124:127], a[60:63], a[252:255]
    s_add_u32 s51, s51, 128
    ds_read_b128 a[52:55], v7 offset:12288
    v_mfma_f32_16x16x32_bf16 a[248:251], a[116:119], a[60:63], a[248:251]
    ds_read_b64_tr_b16 a[110:111], v13 offset:18432
    v_mfma_f32_16x16x32_bf16 a[248:251], a[112:115], a[56:59], a[248:251]
    ds_read_b128 a[56:59], v6 offset:14336
    ds_read_b128 a[60:63], v7 offset:14336
    s_cmp_eq_u32 s66, 2
    s_cbranch_scc1 m_hook18
m_hookr19:
    s_waitcnt lgkmcnt(15)
    v_mfma_f32_16x16x32_bf16 v[32:35], a[64:67], a[0:3], v[32:35]
    ds_read_b64_tr_b16 a[112:113], v14 offset:0
    v_mfma_f32_16x16x32_bf16 v[32:35], a[68:71], a[4:7], v[32:35]
    ds_read_b64_tr_b16 a[114:115], v14 offset:2048
    v_mfma_f32_16x16x32_bf16 v[36:39], a[76:79], a[4:7], v[36:39]
    ds_read_b64_tr_b16 a[116:117], v14 offset:16384
    v_mfma_f32_16x16x32_bf16 v[36:39], a[72:75], a[0:3], v[36:39]
    ds_read_b64_tr_b16 a[118:119], v14 offset:18432
    v_mfma_f32_16x16x32_bf16 v[44:47], a[72:75], a[8:11], v[44:47]
    ds_read_b64_tr_b16 a[120:121], v15 offset:0
    v_mfma_f32_16x16x32_bf16 v[44:47], a[76:79], a[12:15], v[44:47]
    ds_read_b64_tr_b16 a[122:123], v15 offset:2048
    v_mfma_f32_16x16x32_bf16 v[40:43], a[68:71], a[12:15], v[40:43]
    ds_read_b64_tr_b16 a[124:125], v15 offset:16384
    v_mfma_f32_16x16x32_bf16 v[40:43], a[64:67], a[8:11], v[40:43]
    ds_read_b64_tr_b16 a[126:127], v15 offset:18432
    v_mfma_f32_16x16x32_bf16 v[48:51], a[64:67], a[16:19], v[48:51]
    v_mfma_f32_16x16x32_bf16 v[48:51], a[68:71], a[20:23], v[48:51]
    v_mfma_f32_16x16x32_bf16 v[52:55], a[76:79], a[20:23], v[52:55]
    buffer_store_dwordx4 a[192:195], v2, s[24:27], s28 offen sc1
    v_mfma_f32_16x16x32_bf16 v[52:55], a[72:75], a[16:19], v[52:55]
    s_add_u32 s28, s28, s31
    s_waitcnt lgkmcnt(15)
    v_mfma_f32_16x16x32_bf16 v[60:63], a[72:75], a[24:27], v[60:63]
    v_xor_b32 v8, s60, v8
    v_xor_b32 v9, s60, v9
    v_mfma_f32_16x16x32_bf16 v[60:63], a[76:79], a[28:31], v[60:63]
    v_xor_b32 v10, s60, v10
    v_xor_b32 v11, s60, v11
    v_mfma_f32_16x16x32_bf16 v[56:59], a[68:71], a[28:31], v[56:59]
    v_xor_b32 v12, s60, v12
    v_xor_b32 v13, s60, v13
    v_mfma_f32_16x16x32_bf16 v[56:59], a[64:67], a[24:27], v[56:59]
    v_xor_b32 v14, s60, v14
    v_xor_b32 v15, s60, v15
    v_mfma_f32_16x16x32_bf16 v[64:67], a[64:67], a[32:35], v[64:67]
    buffer_store_dwordx4 a[196:199], v2, s[24:27], s28 offen sc1
    v_mfma_f32_16x16x32_bf16 v[64:67], a[68:71], a[36:39], v[64:67]
    s_add_u32 s28, s28, s31
    v_mfma_f32_16x16x32_bf16 v[68:71], a[76:79], a[36:39], v[68:71]
    v_mfma_f32_16x16x32_bf16 v[68:71], a[72:75], a[32:35], v[68:71]
    s_waitcnt lgkmcnt(14)
    v_mfma_f32_16x16x32_bf16 v[76:79], a[72:75], a[40:43], v[76:79]
    v_mfma_f32_16x16x32_bf16 v[76:79], a[76:79], a[44:47], v[76:79]
    v_mfma_f32_16x16x32_bf16 v[72:75], a[68:71], a[44:47], v[72:75]
    buffer_store_dwordx4 a[200:203], v2, s[24:27], s28 offen sc1
    v_mfma_f32_16x16x32_bf16 v[72:75], a[64:67], a[40:43], v[72:75]
    s_add_u32 s28, s28, s31
    s_waitcnt lgkmcnt(11)
    v_mfma_f32_16x16x32_bf16 v[80:83], a[64:67], a[48:51], v[80:83]
    v_mfma_f32_16x16x32_bf16 v[80:83], a[68:71], a[52:55], v[80:83]
    v_mfma_f32_16x16x32_bf16 v[84:87], a[76:79], a[52:55], v[84:87]
    v_mfma_f32_16x16x32_bf16 v[84:87], a[72:75], a[48:51], v[84:87]
    s_waitcnt lgkmcnt(8)
    v_mfma_f32_16x16x32_bf16 v[92:95], a[72:75], a[56:59], v[92:95]
    buffer_store_dwordx4 a[204:207], v2, s[24:27], s28 offen sc1
    v_mfma_f32_16x16x32_bf16 v[92:95], a[76:79], a[60:63], v[92:95]
    s_add_u32 s28, s28, s31
    v_mfma_f32_16x16x32_bf16 v[88:91], a[68:71], a[60:63], v[88:91]
    s_waitcnt vmcnt(16) lgkmcnt(0)
    v_mfma_f32_16x16x32_bf16 v[88:91], a[64:67], a[56:59], v[88:91]
    s_barrier
    v_mfma_f32_16x16x32_bf16 v[96:99], a[80:83], a[0:3], v[96:99]
    ds_read_b64_tr_b16 a[64:65], v8 offset:0
    v_mfma_f32_16x16x32_bf16 v[96:99], a[84:87], a[4:7], v[96:99]
    s_add_u32 m0, s62, 0
    v_mfma_f32_16x16x32_bf16 v[100:103], a[92:95], a[4:7], v[100:103]
    buffer_load_dwordx4 v18, s[44:47], s52 offen offset:0 sc1 lds
    v_mfma_f32_16x16x32_bf16 v[100:103], a[88:91], a[0:3], v[100:103]
    ds_read_b64_tr_b16 a[66:67], v8 offset:2048
    v_mfma_f32_16x16x32_bf16 v[108:111], a[88:91], a[8:11], v[108:111]
    s_add_u32 s64, s64, 32768
    v_mfma_f32_16x16x32_bf16 v[108:111], a[92:95], a[12:15], v[108:111]
    s_cmp_ge_u32 s64, 98304
    s_cselect_b32 s63, 4294901760, s59
    s_cselect_b32 s64, 0, s64
    v_mfma_f32_16x16x32_bf16 v[104:107], a[84:87], a[12:15], v[104:107]
    buffer_load_dwordx4 v19, s[44:47], s52 offen offset:1024 sc1 lds
    v_mfma_f32_16x16x32_bf16 v[104:107], a[80:83], a[8:11], v[104:107]
    s_add_u32 s52, s52, s56
    ds_read_b64_tr_b16 a[68:69], v8 offset:16384
    v_mfma_f32_16x16x32_bf16 v[112:115], a[80:83], a[16:19], v[112:115]
    v_mfma_f32_16x16x32_bf16 v[112:115], a[84:87], a[20:23], v[112:115]
    v_mfma_f32_16x16x32_bf16 v[116:119], a[92:95], a[20:23], v[116:119]
    buffer_load_dwordx4 v18, s[44:47], s53 offen offset:2048 sc1 lds
    v_mfma_f32_16x16x32_bf16 v[116:119], a[88:91], a[16:19], v[116:119]
    ds_read_b64_tr_b16 a[70:71], v8 offset:18432
    v_mfma_f32_16x16x32_bf16 v[124:127], a[88:91], a[24:27], v[124:127]
    v_mfma_f32_16x16x32_bf16 v[124:127], a[92:95], a[28:31], v[124:127]
    v_mfma_f32_16x16x32_bf16 v[120:123], a[84:87], a[28:31], v[120:123]
    buffer_load_dwordx4 v19, s[44:47], s53 offen offset:3072 sc1 lds
    v_mfma_f32_16x16x32_bf16 v[120:123], a[80:83], a[24:27], v[120:123]
    s_add_u32 s53, s53, s56
    ds_read_b64_tr_b16 a[72:73], v9 offset:0
    v_mfma_f32_16x16x32_bf16 v[128:131], a[80:83], a[32:35], v[128:131]
    v_mfma_f32_16x16x32_bf16 v[128:131], a[84:87], a[36:39], v[128:131]
    s_add_u32 m0, s62, 4096
    v_mfma_f32_16x16x32_bf16 v[132:135], a[92:95], a[36:39], v[132:135]
    buffer_load_dwordx4 v20, s[44:47], s54 offen offset:0 sc1 lds
    v_mfma_f32_16x16x32_bf16 v[132:135], a[88:91], a[32:35], v[132:135]
    s_xor_b32 s62, s62, 229376
    ds_read_b64_tr_b16 a[74:75], v9 offset:2048
    v_mfma_f32_16x16x32_bf16 v[140:143], a[88:91], a[40:43], v[140:143]
    v_mfma_f32_16x16x32_bf16 v[140:143], a[92:95], a[44:47], v[140:143]
    v_mfma_f32_16x16x32_bf16 v[136:139], a[84:87], a[44:47], v[136:139]
    buffer_load_dwordx4 v21, s[44:47], s54 offen offset:1024 sc1 lds
    v_mfma_f32_16x16x32_bf16 v[136:139], a[80:83], a[40:43], v[136:139]
    s_add_u32 s54, s54, s56
    ds_read_b64_tr_b16 a[76:77], v9 offset:16384
    v_mfma_f32_16x16x32_bf16 v[144:147], a[80:83], a[48:51], v[144:147]
    v_mfma_f32_16x16x32_bf16 v[144:147], a[84:87], a[52:55], v[144:147]
    v_mfma_f32_16x16x32_bf16 v[148:151], a[92:95], a[52:55], v[148:151]
    buffer_load_dwordx4 v20, s[44:47], s55 offen offset:2048 sc1 lds
    v_mfma_f32_16x16x32_bf16 v[148:151], a[88:91], a[48:51], v[148:151]
    ds_read_b64_tr_b16 a[78:79], v9 offset:18432
    v_mfma_f32_16x16x32_bf16 v[156:159], a[88:91], a[56:59], v[156:159]
    v_add_u32 v6, s63, v6
    v_add_u32 v7, s63, v7
    v_mfma_f32_16x16x32_bf16 v[156:159], a[92:95], a[60:63], v[156:159]
    v_mfma_f32_16x16x32_bf16 v[152:155], a[84:87], a[60:63], v[152:155]
    buffer_load_dwordx4 v21, s[44:47], s55 offen offset:3072 sc1 lds
    v_mfma_f32_16x16x32_bf16 v[152:155], a[80:83], a[56:59], v[152:155]
    s_add_u32 s55, s55, s56
    v_mfma_f32_16x16x32_bf16 v[160:163], a[96:99], a[0:3], v[160:163]
    ds_read_b64_tr_b16 a[80:81], v10 offset:0
    v_mfma_f32_16x16x32_bf16 v[160:163], a[100:103], a[4:7], v[160:163]
    v_mfma_f32_16x16x32_bf16 v[164:167], a[108:111], a[4:7], v[164:167]
    v_mfma_f32_16x16x32_bf16 v[164:167], a[104:107], a[0:3], v[164:167]
    s_add_u32 m0, s61, 0
    ds_read_b64_tr_b16 a[82:83], v10 offset:2048
    v_mfma_f32_16x16x32_bf16 v[172:175], a[104:107], a[8:11], v[172:175]
    buffer_load_dwordx4 v16, s[40:43], s48 offen offset:0 sc1 lds
    v_mfma_f32_16x16x32_bf16 v[172:175], a[108:111], a[12:15], v[172:175]
    v_mfma_f32_16x16x32_bf16 v[168:171], a[100:103], a[12:15], v[168:171]
    ds_read_b64_tr_b16 a[84:85], v10 offset:16384
    v_mfma_f32_16x16x32_bf16 v[168:171], a[96:99], a[8:11], v[168:171]
    v_mfma_f32_16x16x32_bf16 v[176:179], a[96:99], a[16:19], v[176:179]
    buffer_store_dwordx4 a[208:211], v2, s[24:27], s28 offen sc1
    v_mfma_f32_16x16x32_bf16 v[176:179], a[100:103], a[20:23], v[176:179]
    s_add_u32 s28, s28, s31
    ds_read_b64_tr_b16 a[86:87], v10 offset:18432
    v_mfma_f32_16x16x32_bf16 v[180:183], a[108:111], a[20:23], v[180:183]
    v_mfma_f32_16x16x32_bf16 v[180:183], a[104:107], a[16:19], v[180:183]
    v_mfma_f32_16x16x32_bf16 v[188:191], a[104:107], a[24:27], v[188:191]
    buffer_load_dwordx4 v17, s[40:43], s48 offen offset:1024 sc1 lds
    v_mfma_f32_16x16x32_bf16 v[188:191], a[108:111], a[28:31], v[188:191]
    s_add_u32 s48, s48, 128
    ds_read_b64_tr_b16 a[88:89], v11 offset:0
    v_mfma_f32_16x16x32_bf16 v[184:187], a[100:103], a[28:31], v[184:187]
    v_mfma_f32_16x16x32_bf16 v[184:187], a[96:99], a[24:27], v[184:187]
    v_mfma_f32_16x16x32_bf16 v[192:195], a[96:99], a[32:35], v[192:195]
    buffer_store_dwordx4 a[212:215], v2, s[24:27], s28 offen sc1
    v_mfma_f32_16x16x32_bf16 v[192:195], a[100:103], a[36:39], v[192:195]
    s_add_u32 s28, s28, s31
    ds_read_b64_tr_b16 a[90:91], v11 offset:2048
    v_mfma_f32_16x16x32_bf16 v[196:199], a[108:111], a[36:39], v[196:199]
    v_mfma_f32_16x16x32_bf16 v[196:199], a[104:107], a[32:35], v[196:199]
    v_mfma_f32_16x16x32_bf16 v[204:207], a[104:107], a[40:43], v[204:207]
    buffer_load_dwordx4 v16, s[40:43], s49 offen offset:2048 sc1 lds
    v_mfma_f32_16x16x32_bf16 v[204:207], a[108:111], a[44:47], v[204:207]
    ds_read_b64_tr_b16 a[92:93], v11 offset:16384
    v_mfma_f32_16x16x32_bf16 v[200:203], a[100:103], a[44:47], v[200:203]
    v_mfma_f32_16x16x32_bf16 v[200:203], a[96:99], a[40:43], v[200:203]
    v_mfma_f32_16x16x32_bf16 v[208:211], a[96:99], a[48:51], v[208:211]
    buffer_store_dwordx4 a[216:219], v2, s[24:27], s28 offen sc1
    v_mfma_f32_16x16x32_bf16 v[208:211], a[100:103], a[52:55], v[208:211]
    s_add_u32 s28, s28, s31
    ds_read_b64_tr_b16 a[94:95], v11 offset:18432
    v_mfma_f32_16x16x32_bf16 v[212:215], a[108:111], a[52:55], v[212:215]
    v_mfma_f32_16x16x32_bf16 v[212:215], a[104:107], a[48:51], v[212:215]
    v_mfma_f32_16x16x32_bf16 v[220:223], a[104:107], a[56:59], v[220:223]
    buffer_load_dwordx4 v17, s[40:43], s49 offen offset:3072 sc1 lds
    v_mfma_f32_16x16x32_bf16 v[220:223], a[108:111], a[60:63], v[220:223]
    s_add_u32 s49, s49, 128
    v_mfma_f32_16x16x32_bf16 v[216:219], a[100:103], a[60:63], v[216:219]
    buffer_store_dwordx4 a[220:223], v2, s[24:27], s28 offen sc1
    v_mfma_f32_16x16x32_bf16 v[216:219], a[96:99], a[56:59], v[216:219]
    s_add_u32 s29, s29, s30
    s_mov_b32 s28, s29
    v_mfma_f32_16x16x32_bf16 v[224:227], a[112:115], a[0:3], v[224:227]
    v_mfma_f32_16x16x32_bf16 v[224:227], a[116:119], a[4:7], v[224:227]
    ds_read_b64_tr_b16 a[96:97], v12 offset:0
    v_mfma_f32_16x16x32_bf16 v[228:231], a[124:127], a[4:7], v[228:231]
    v_mfma_f32_16x16x32_bf16 v[228:231], a[120:123], a[0:3], v[228:231]
    s_add_u32 m0, s61, 4096
    ds_read_b128 a[0:3], v6 offset:0
    v_mfma_f32_16x16x32_bf16 v[236:239], a[120:123], a[8:11], v[236:239]
    buffer_load_dwordx4 v16, s[40:43], s50 offen offset:0 sc1 lds
    v_mfma_f32_16x16x32_bf16 v[236:239], a[124:127], a[12:15], v[236:239]
    s_add_u32 s61, s61, 32768
    ds_read_b128 a[4:7], v7 offset:0
    v_mfma_f32_16x16x32_bf16 v[232:235], a[116:119], a[12:15], v[232:235]
    s_cmp_ge_u32 s61, 98304
    s_cselect_b32 s90, 98304, 0
    ds_read_b64_tr_b16 a[98:99], v12 offset:2048
    v_mfma_f32_16x16x32_bf16 v[232:235], a[112:115], a[8:11], v[232:235]
    s_sub_u32 s61, s61, s90
    ds_read_b128 a[8:11], v6 offset:2048
    v_mfma_f32_16x16x32_bf16 v[240:243], a[112:115], a[16:19], v[240:243]
    ds_read_b128 a[12:15], v7 offset:2048
    v_mfma_f32_16x16x32_bf16 v[240:243], a[116:119], a[20:23], v[240:243]
    ds_read_b64_tr_b16 a[100:101], v12 offset:16384
    v_mfma_f32_16x16x32_bf16 v[244:247], a[124:127], a[20:23], v[244:247]
    v_mfma_f32_16x16x32_bf16 v[244:247], a[120:123], a[16:19], v[244:247]
    ds_read_b128 a[16:19], v6 offset:4096
    v_mfma_f32_16x16x32_bf16 v[252:255], a[120:123], a[24:27], v[252:255]
    buffer_load_dwordx4 v17, s[40:43], s50 offen offset:1024 sc1 lds
    v_mfma_f32_16x16x32_bf16 v[252:255], a[124:127], a[28:31], v[252:255]
    s_add_u32 s50, s50, 128
    ds_read_b128 a[20:23], v7 offset:4096
    v_mfma_f32_16x16x32_bf16 v[248:251], a[116:119], a[28:31], v[248:251]
    ds_read_b64_tr_b16 a[102:103], v12 offset:18432
    v_mfma_f32_16x16x32_bf16 v[248:251], a[112:115], a[24:27], v[248:251]
    ds_read_b128 a[24:27], v6 offset:6144
    v_mfma_f32_16x16x32_bf16 a[224:227], a[112:115], a[32:35], a[224:227]
    s_sub_u32 s65, s65, 1
    ds_read_b128 a[28:31], v7 offset:6144
    v_mfma_f32_16x16x32_bf16 a[224:227], a[116:119], a[36:39], a[224:227]
    ds_read_b64_tr_b16 a[104:105], v13 offset:0
    v_mfma_f32_16x16x32_bf16 a[228:231], a[124:127], a[36:39], a[228:231]
    v_mfma_f32_16x16x32_bf16 a[228:231], a[120:123], a[32:35], a[228:231]
    ds_read_b128 a[32:35], v6 offset:8192
    v_mfma_f32_16x16x32_bf16 a[236:239], a[120:123], a[40:43], a[236:239]
    buffer_load_dwordx4 v16, s[40:43], s51 offen offset:2048 sc1 lds
    v_mfma_f32_16x16x32_bf16 a[236:239], a[124:127], a[44:47], a[236:239]
    ds_read_b128 a[36:39], v7 offset:8192
    v_mfma_f32_16x16x32_bf16 a[232:235], a[116:119], a[44:47], a[232:235]
    ds_read_b64_tr_b16 a[106:107], v13 offset:2048
    v_mfma_f32_16x16x32_bf16 a[232:235], a[112:115], a[40:43], a[232:235]
    ds_read_b128 a[40:43], v6 offset:10240
    v_mfma_f32_16x16x32_bf16 a[240:243], a[112:115], a[48:51], a[240:243]
    ds_read_b128 a[44:47], v7 offset:10240
    v_mfma_f32_16x16x32_bf16 a[240:243], a[116:119], a[52:55], a[240:243]
    ds_read_b64_tr_b16 a[108:109], v13 offset:16384
    v_mfma_f32_16x16x32_bf16 a[244:247], a[124:127], a[52:55], a[244:247]
    v_mfma_f32_16x16x32_bf16 a[244:247], a[120:123], a[48:51], a[244:247]
    ds_read_b128 a[48:51], v6 offset:12288
    v_mfma_f32_16x16x32_bf16 a[252:255], a[120:123], a[56:59], a[252:255]
    buffer_load_dwordx4 v17, s[40:43], s51 offen offset:3072 sc1 lds
    v_mfma_f32_16x16x32_bf16 a[252:255], a[124:127], a[60:63], a[252:255]
    s_add_u32 s51, s51, 128
    ds_read_b128 a[52:55], v7 offset:12288
    v_mfma_f32_16x16x32_bf16 a[248:251], a[116:119], a[60:63], a[248:251]
    ds_read_b64_tr_b16 a[110:111], v13 offset:18432
    v_mfma_f32_16x16x32_bf16 a[248:251], a[112:115], a[56:59], a[248:251]
    ds_read_b128 a[56:59], v6 offset:14336
    ds_read_b128 a[60:63], v7 offset:14336
.p2align 3
m_loop20:
    s_waitcnt lgkmcnt(15)
    v_mfma_f32_16x16x32_bf16 v[32:35], a[64:67], a[0:3], v[32:35]
    ds_read_b64_tr_b16 a[112:113], v14 offset:0
    v_mfma_f32_16x16x32_bf16 v[32:35], a[68:71], a[4:7], v[32:35]
    ds_read_b64_tr_b16 a[114:115], v14 offset:2048
    v_mfma_f32_16x16x32_bf16 v[36:39], a[76:79], a[4:7], v[36:39]
    ds_read_b64_tr_b16 a[116:117], v14 offset:16384
    v_mfma_f32_16x16x32_bf16 v[36:39], a[72:75], a[0:3], v[36:39]
    ds_read_b64_tr_b16 a[118:119], v14 offset:18432
    v_mfma_f32_16x16x32_bf16 v[44:47], a[72:75], a[8:11], v[44:47]
    ds_read_b64_tr_b16 a[120:121], v15 offset:0
    v_mfma_f32_16x16x32_bf16 v[44:47], a[76:79], a[12:15], v[44:47]
    ds_read_b64_tr_b16 a[122:123], v15 offset:2048
    v_mfma_f32_16x16x32_bf16 v[40:43], a[68:71], a[12:15], v[40:43]
    ds_read_b64_tr_b16 a[124:125], v15 offset:16384
    v_mfma_f32_16x16x32_bf16 v[40:43], a[64:67], a[8:11], v[40:43]
    ds_read_b64_tr_b16 a[126:127], v15 offset:18432
    v_mfma_f32_16x16x32_bf16 v[48:51], a[64:67], a[16:19], v[48:51]
    v_mfma_f32_16x16x32_bf16 v[48:51], a[68:71], a[20:23], v[48:51]
    v_mfma_f32_16x16x32_bf16 v[52:55], a[76:79], a[20:23], v[52:55]
    v_mfma_f32_16x16x32_bf16 v[52:55], a[72:75], a[16:19], v[52:55]
    s_waitcnt lgkmcnt(15)
    v_mfma_f32_16x16x32_bf16 v[60:63], a[72:75], a[24:27], v[60:63]
    v_xor_b32 v8, s60, v8
    v_xor_b32 v9, s60, v9
    v_mfma_f32_16x16x32_bf16 v[60:63], a[76:79], a[28:31], v[60:63]
    v_xor_b32 v10, s60, v10
    v_xor_b32 v11, s60, v11
    v_mfma_f32_16x16x32_bf16 v[56:59], a[68:71], a[28:31], v[56:59]
    v_xor_b32 v12, s60, v12
    v_xor_b32 v13, s60, v13
    v_mfma_f32_16x16x32_bf16 v[56:59], a[64:67], a[24:27], v[56:59]
    v_xor_b32 v14, s60, v14
    v_xor_b32 v15, s60, v15
    v_mfma_f32_16x16x32_bf16 v[64:67], a[64:67], a[32:35], v[64:67]
    v_mfma_f32_16x16x32_bf16 v[64:67], a[68:71], a[36:39], v[64:67]
    v_mfma_f32_16x16x32_bf16 v[68:71], a[76:79], a[36:39], v[68:71]
    v_mfma_f32_16x16x32_bf16 v[68:71], a[72:75], a[32:35], v[68:71]
    s_waitcnt lgkmcnt(14)
    v_mfma_f32_16x16x32_bf16 v[76:79], a[72:75], a[40:43], v[76:79]
    v_mfma_f32_16x16x32_bf16 v[76:79], a[76:79], a[44:47], v[76:79]
    v_mfma_f32_16x16x32_bf16 v[72:75], a[68:71], a[44:47], v[72:75]
    v_mfma_f32_16x16x32_bf16 v[72:75], a[64:67], a[40:43], v[72:75]
    s_waitcnt lgkmcnt(11)
    v_mfma_f32_16x16x32_bf16 v[80:83], a[64:67], a[48:51], v[80:83]
    v_mfma_f32_16x16x32_bf16 v[80:83], a[68:71], a[52:55], v[80:83]
    v_mfma_f32_16x16x32_bf16 v[84:87], a[76:79], a[52:55], v[84:87]
    v_mfma_f32_16x16x32_bf16 v[84:87], a[72:75], a[48:51], v[84:87]
    s_waitcnt lgkmcnt(8)
    v_mfma_f32_16x16x32_bf16 v[92:95], a[72:75], a[56:59], v[92:95]
    v_mfma_f32_16x16x32_bf16 v[92:95], a[76:79], a[60:63], v[92:95]
    v_mfma_f32_16x16x32_bf16 v[88:91], a[68:71], a[60:63], v[88:91]
    s_waitcnt vmcnt(8) lgkmcnt(0)
    v_mfma_f32_16x16x32_bf16 v[88:91], a[64:67], a[56:59], v[88:91]
    s_barrier
    v_mfma_f32_16x16x32_bf16 v[96:99], a[80:83], a[0:3], v[96:99]
    ds_read_b64_tr_b16 a[64:65], v8 offset:0
    v_mfma_f32_16x16x32_bf16 v[96:99], a[84:87], a[4:7], v[96:99]
    s_add_u32 m0, s62, 0
    v_mfma_f32_16x16x32_bf16 v[100:103], a[92:95], a[4:7], v[100:103]
    buffer_load_dwordx4 v18, s[44:47], s52 offen offset:0 sc1 lds
    v_mfma_f32_16x16x32_bf16 v[100:103], a[88:91], a[0:3], v[100:103]
    ds_read_b64_tr_b16 a[66:67], v8 offset:2048
    v_mfma_f32_16x16x32_bf16 v[108:111], a[88:91], a[8:11], v[108:111]
    s_add_u32 s64, s64, 32768
    v_mfma_f32_16x16x32_bf16 v[108:111], a[92:95], a[12:15], v[108:111]
    s_cmp_ge_u32 s64, 98304
    s_cselect_b32 s63, 4294901760, s59
    s_cselect_b32 s64, 0, s64
    v_mfma_f32_16x16x32_bf16 v[104:107], a[84:87], a[12:15], v[104:107]
    buffer_load_dwordx4 v19, s[44:47], s52 offen offset:1024 sc1 lds
    v_mfma_f32_16x16x32_bf16 v[104:107], a[80:83], a[8:11], v[104:107]
    s_add_u32 s52, s52, s56
    ds_read_b64_tr_b16 a[68:69], v8 offset:16384
    v_mfma_f32_16x16x32_bf16 v[112:115], a[80:83], a[16:19], v[112:115]
    v_mfma_f32_16x16x32_bf16 v[112:115], a[84:87], a[20:23], v[112:115]
    v_mfma_f32_16x16x32_bf16 v[116:119], a[92:95], a[20:23], v[116:119]
    buffer_load_dwordx4 v18, s[44:47], s53 offen offset:2048 sc1 lds
    v_mfma_f32_16x16x32_bf16 v[116:119], a[88:91], a[16:19], v[116:119]
    ds_read_b64_tr_b16 a[70:71], v8 offset:18432
    v_mfma_f32_16x16x32_bf16 v[124:127], a[88:91], a[24:27], v[124:127]
    v_mfma_f32_16x16x32_bf16 v[124:127], a[92:95], a[28:31], v[124:127]
    v_mfma_f32_16x16x32_bf16 v[120:123], a[84:87], a[28:31], v[120:123]
    buffer_load_dwordx4 v19, s[44:47], s53 offen offset:3072 sc1 lds
    v_mfma_f32_16x16x32_bf16 v[120:123], a[80:83], a[24:27], v[120:123]
    s_add_u32 s53, s53, s56
    ds_read_b64_tr_b16 a[72:73], v9 offset:0
    v_mfma_f32_16x16x32_bf16 v[128:131], a[80:83], a[32:35], v[128:131]
    v_mfma_f32_16x16x32_bf16 v[128:131], a[84:87], a[36:39], v[128:131]
    s_add_u32 m0, s62, 4096
    v_mfma_f32_16x16x32_bf16 v[132:135], a[92:95], a[36:39], v[132:135]
    buffer_load_dwordx4 v20, s[44:47], s54 offen offset:0 sc1 lds
    v_mfma_f32_16x16x32_bf16 v[132:135], a[88:91], a[32:35], v[132:135]
    s_xor_b32 s62, s62, 229376
    ds_read_b64_tr_b16 a[74:75], v9 offset:2048
    v_mfma_f32_16x16x32_bf16 v[140:143], a[88:91], a[40:43], v[140:143]
    v_mfma_f32_16x16x32_bf16 v[140:143], a[92:95], a[44:47], v[140:143]
    v_mfma_f32_16x16x32_bf16 v[136:139], a[84:87], a[44:47], v[136:139]
    buffer_load_dwordx4 v21, s[44:47], s54 offen offset:1024 sc1 lds
    v_mfma_f32_16x16x32_bf16 v[136:139], a[80:83], a[40:43], v[136:139]
    s_add_u32 s54, s54, s56
    ds_read_b64_tr_b16 a[76:77], v9 offset:16384
    v_mfma_f32_16x16x32_bf16 v[144:147], a[80:83], a[48:51], v[144:147]
    v_mfma_f32_16x16x32_bf16 v[144:147], a[84:87], a[52:55], v[144:147]
    v_mfma_f32_16x16x32_bf16 v[148:151], a[92:95], a[52:55], v[148:151]
    buffer_load_dwordx4 v20, s[44:47], s55 offen offset:2048 sc1 lds
    v_mfma_f32_16x16x32_bf16 v[148:151], a[88:91], a[48:51], v[148:151]
    ds_read_b64_tr_b16 a[78:79], v9 offset:18432
    v_mfma_f32_16x16x32_bf16 v[156:159], a[88:91], a[56:59], v[156:159]
    v_add_u32 v6, s63, v6
    v_add_u32 v7, s63, v7
    v_mfma_f32_16x16x32_bf16 v[156:159], a[92:95], a[60:63], v[156:159]
    v_mfma_f32_16x16x32_bf16 v[152:155], a[84:87], a[60:63], v[152:155]
    buffer_load_dwordx4 v21, s[44:47], s55 offen offset:3072 sc1 lds
    v_mfma_f32_16x16x32_bf16 v[152:155], a[80:83], a[56:59], v[152:155]
    s_add_u32 s55, s55, s56
    v_mfma_f32_16x16x32_bf16 v[160:163], a[96:99], a[0:3], v[160:163]
    ds_read_b64_tr_b16 a[80:81], v10 offset:0
    v_mfma_f32_16x16x32_bf16 v[160:163], a[100:103], a[4:7], v[160:163]
    v_mfma_f32_16x16x32_bf16 v[164:167], a[108:111], a[4:7], v[164:167]
    v_mfma_f32_16x16x32_bf16 v[164:167], a[104:107], a[0:3], v[164:167]
    s_add_u32 m0, s61, 0
    ds_read_b64_tr_b16 a[82:83], v10 offset:2048
    v_mfma_f32_16x16x32_bf16 v[172:175], a[104:107], a[8:11], v[172:175]
    buffer_load_dwordx4 v16, s[40:43], s48 offen offset:0 sc1 lds
    v_mfma_f32_16x16x32_bf16 v[172:175], a[108:111], a[12:15], v[172:175]
    v_mfma_f32_16x16x32_bf16 v[168:171], a[100:103], a[12:15], v[168:171]
    ds_read_b64_tr_b16 a[84:85], v10 offset:16384
    v_mfma_f32_16x16x32_bf16 v[168:171], a[96:99], a[8:11], v[168:171]
    v_mfma_f32_16x16x32_bf16 v[176:179], a[96:99], a[16:19], v[176:179]
    v_mfma_f32_16x16x32_bf16 v[176:179], a[100:103], a[20:23], v[176:179]
    ds_read_b64_tr_b16 a[86:87], v10 offset:18432
    v_mfma_f32_16x16x32_bf16 v[180:183], a[108:111], a[20:23], v[180:183]
    v_mfma_f32_16x16x32_bf16 v[180:183], a[104:107], a[16:19], v[180:183]
    v_mfma_f32_16x16x32_bf16 v[188:191], a[104:107], a[24:27], v[188:191]
    buffer_load_dwordx4 v17, s[40:43], s48 offen offset:1024 sc1 lds
    v_mfma_f32_16x16x32_bf16 v[188:191], a[108:111], a[28:31], v[188:191]
    s_add_u32 s48, s48, 128
    ds_read_b64_tr_b16 a[88:89], v11 offset:0
    v_mfma_f32_16x16x32_bf16 v[184:187], a[100:103], a[28:31], v[184:187]
    v_mfma_f32_16x16x32_bf16 v[184:187], a[96:99], a[24:27], v[184:187]
    v_mfma_f32_16x16x32_bf16 v[192:195], a[96:99], a[32:35], v[192:195]
    v_mfma_f32_16x16x32_bf16 v[192:195], a[100:103], a[36:39], v[192:195]
    ds_read_b64_tr_b16 a[90:91], v11 offset:2048
    v_mfma_f32_16x16x32_bf16 v[196:199], a[108:111], a[36:39], v[196:199]
    v_mfma_f32_16x16x32_bf16 v[196:199], a[104:107], a[32:35], v[196:199]
    v_mfma_f32_16x16x32_bf16 v[204:207], a[104:107], a[40:43], v[204:207]
    buffer_load_dwordx4 v16, s[40:43], s49 offen offset:2048 sc1 lds
    v_mfma_f32_16x16x32_bf16 v[204:207], a[108:111], a[44:47], v[204:207]
    ds_read_b64_tr_b16 a[92:93], v11 offset:16384
    v_mfma_f32_16x16x32_bf16 v[200:203], a[100:103], a[44:47], v[200:203]
    v_mfma_f32_16x16x32_bf16 v[200:203], a[96:99], a[40:43], v[200:203]
    v_mfma_f32_16x16x32_bf16 v[208:211], a[96:99], a[48:51], v[208:211]
    v_mfma_f32_16x16x32_bf16 v[208:211], a[100:103], a[52:55], v[208:211]
    ds_read_b64_tr_b16 a[94:95], v11 offset:18432
    v_mfma_f32_16x16x32_bf16 v[212:215], a[108:111], a[52:55], v[212:215]
    v_mfma_f32_16x16x32_bf16 v[212:215], a[104:107], a[48:51], v[212:215]
    v_mfma_f32_16x16x32_bf16 v[220:223], a[104:107], a[56:59], v[220:223]
    buffer_load_dwordx4 v17, s[40:43], s49 offen offset:3072 sc1 lds
    v_mfma_f32_16x16x32_bf16 v[220:223], a[108:111], a[60:63], v[220:223]
    s_add_u32 s49, s49, 128
    v_mfma_f32_16x16x32_bf16 v[216:219], a[100:103], a[60:63], v[216:219]
    v_mfma_f32_16x16x32_bf16 v[216:219], a[96:99], a[56:59], v[216:219]
    v_mfma_f32_16x16x32_bf16 v[224:227], a[112:115], a[0:3], v[224:227]
    v_mfma_f32_16x16x32_bf16 v[224:227], a[116:119], a[4:7], v[224:227]
    ds_read_b64_tr_b16 a[96:97], v12 offset:0
    v_mfma_f32_16x16x32_bf16 v[228:231], a[124:127], a[4:7], v[228:231]
    v_mfma_f32_16x16x32_bf16 v[228:231], a[120:123], a[0:3], v[228:231]
    s_add_u32 m0, s61, 4096
    ds_read_b128 a[0:3], v6 offset:0
    v_mfma_f32_16x16x32_bf16 v[236:239], a[120:123], a[8:11], v[236:239]
    buffer_load_dwordx4 v16, s[40:43], s50 offen offset:0 sc1 lds
    v_mfma_f32_16x16x32_bf16 v[236:239], a[124:127], a[12:15], v[236:239]
    s_add_u32 s61, s61, 32768
    ds_read_b128 a[4:7], v7 offset:0
    v_mfma_f32_16x16x32_bf16 v[232:235], a[116:119], a[12:15], v[232:235]
    s_cmp_ge_u32 s61, 98304
    s_cselect_b32 s90, 98304, 0
    ds_read_b64_tr_b16 a[98:99], v12 offset:2048
    v_mfma_f32_16x16x32_bf16 v[232:235], a[112:115], a[8:11], v[232:235]
    s_sub_u32 s61, s61, s90
    ds_read_b128 a[8:11], v6 offset:2048
    v_mfma_f32_16x16x32_bf16 v[240:243], a[112:115], a[16:19], v[240:243]
    ds_read_b128 a[12:15], v7 offset:2048
    v_mfma_f32_16x16x32_bf16 v[240:243], a[116:119], a[20:23], v[240:243]
    ds_read_b64_tr_b16 a[100:101], v12 offset:16384
    v_mfma_f32_16x16x32_bf16 v[244:247], a[124:127], a[20:23], v[244:247]
    v_mfma_f32_16x16x32_bf16 v[244:247], a[120:123], a[16:19], v[244:247]
    ds_read_b128 a[16:19], v6 offset:4096
    v_mfma_f32_16x16x32_bf16 v[252:255], a[120:123], a[24:27], v[252:255]
    buffer_load_dwordx4 v17, s[40:43], s50 offen offset:1024 sc1 lds
    v_mfma_f32_16x16x32_bf16 v[252:255], a[124:127], a[28:31], v[252:255]
    s_add_u32 s50, s50, 128
    ds_read_b128 a[20:23], v7 offset:4096
    v_mfma_f32_16x16x32_bf16 v[248:251], a[116:119], a[28:31], v[248:251]
    ds_read_b64_tr_b16 a[102:103], v12 offset:18432
    v_mfma_f32_16x16x32_bf16 v[248:251], a[112:115], a[24:27], v[248:251]
    ds_read_b128 a[24:27], v6 offset:6144
    v_mfma_f32_16x16x32_bf16 a[224:227], a[112:115], a[32:35], a[224:227]
    s_sub_u32 s65, s65, 1
    ds_read_b128 a[28:31], v7 offset:6144
    v_mfma_f32_16x16x32_bf16 a[224:227], a[116:119], a[36:39], a[224:227]
    ds_read_b64_tr_b16 a[104:105], v13 offset:0
    v_mfma_f32_16x16x32_bf16 a[228:231], a[124:127], a[36:39], a[228:231]
    v_mfma_f32_16x16x32_bf16 a[228:231], a[120:123], a[32:35], a[228:231]
    ds_read_b128 a[32:35], v6 offset:8192
    v_mfma_f32_16x16x32_bf16 a[236:239], a[120:123], a[40:43], a[236:239]
    buffer_load_dwordx4 v16, s[40:43], s51 offen offset:2048 sc1 lds
    v_mfma_f32_16x16x32_bf16 a[236:239], a[124:127], a[44:47], a[236:239]
    ds_read_b128 a[36:39], v7 offset:8192
    v_mfma_f32_16x16x32_bf16 a[232:235], a[116:119], a[44:47], a[232:235]
    ds_read_b64_tr_b16 a[106:107], v13 offset:2048
    v_mfma_f32_16x16x32_bf16 a[232:235], a[112:115], a[40:43], a[232:235]
    ds_read_b128 a[40:43], v6 offset:10240
    v_mfma_f32_16x16x32_bf16 a[240:243], a[112:115], a[48:51], a[240:243]
    ds_read_b128 a[44:47], v7 offset:10240
    v_mfma_f32_16x16x32_bf16 a[240:243], a[116:119], a[52:55], a[240:243]
    ds_read_b64_tr_b16 a[108:109], v13 offset:16384
    v_mfma_f32_16x16x32_bf16 a[244:247], a[124:127], a[52:55], a[244:247]
    v_mfma_f32_16x16x32_bf16 a[244:247], a[120:123], a[48:51], a[244:247]
    ds_read_b128 a[48:51], v6 offset:12288
    v_mfma_f32_16x16x32_bf16 a[252:255], a[120:123], a[56:59], a[252:255]
    buffer_load_dwordx4 v17, s[40:43], s51 offen offset:3072 sc1 lds
    v_mfma_f32_16x16x32_bf16 a[252:255], a[124:127], a[60:63], a[252:255]
    s_add_u32 s51, s51, 128
    ds_read_b128 a[52:55], v7 offset:12288
    v_mfma_f32_16x16x32_bf16 a[248:251], a[116:119], a[60:63], a[248:251]
    s_cmp_gt_u32 s65, s67
    ds_read_b64_tr_b16 a[110:111], v13 offset:18432
    v_mfma_f32_16x16x32_bf16 a[248:251], a[112:115], a[56:59], a[248:251]
    ds_read_b128 a[56:59], v6 offset:14336
    ds_read_b128 a[60:63], v7 offset:14336
    s_cbranch_scc1 m_loop20
    s_cmp_eq_u32 s65, 0
    s_cbranch_scc1 m_epi15
m_dosw21:
    s_cmp_eq_u32 s94, 0
    s_cbranch_scc1 m_x39
    s_cmp_lg_u32 s65, 3
    s_cbranch_scc1 m_x45
    s_mov_b32 s42, s73
    s_lshl_b32 s90, s77, 4
    s_lshl_b32 s90, s90, s81
    s_mov_b32 s48, s79
    s_mul_i32 s91, s90, 1
    s_add_u32 s49, s91, s79
    s_sub_u32 s49, s49, 2048
    s_mul_i32 s91, s90, 2
    s_add_u32 s50, s91, s79
    s_mul_i32 s91, s90, 3
    s_add_u32 s51, s91, s79
    s_sub_u32 s51, s51, 2048
    s_lshl_b32 s90, s58, 7
    s_add_u32 s90, s90, s57
    s_lshl_b32 s91, s16, 6
    s_cmp_eq_u32 s81, 1
    s_cselect_b32 s90, s90, s91
    v_lshrrev_b32 v24, 3, v1
    v_lshlrev_b32 v24, s81, v24
    v_add_u32 v24, s90, v24
    v_mul_lo_u32 v24, v24, s77
    v_lshrrev_b32 v25, 4, v1
    v_and_b32 v26, 7, v1
    v_xor_b32 v25, v25, v26
    v_lshl_add_u32 v16, v25, 4, v24
    v_xor_b32 v25, 4, v25
    v_lshl_add_u32 v17, v25, 4, v24
    s_lshl_b32 s90, s77, 3
    s_lshl_b32 s90, s90, s81
    s_sub_u32 s90, s90, 1024
    v_add_u32 v17, s90, v17
    s_mov_b32 s40, s71
    s_mov_b32 s41, s72
    buffer_load_dwordx2 v[4:5], off, s[12:15], 0 sc1
    s_branch m_loop20
m_x45:
    s_mov_b32 s46, s76
    s_mov_b32 s52, s80
    s_lshl_b32 s90, s78, 2
    s_mul_i32 s91, s90, 1
    s_add_u32 s53, s91, s80
    s_sub_u32 s53, s53, 2048
    s_mul_i32 s91, s90, 2
    s_add_u32 s54, s91, s80
    s_mul_i32 s91, s90, 3
    s_add_u32 s55, s91, s80
    s_sub_u32 s55, s55, 2048
    s_lshl_b32 s56, s78, 6
    v_lshrrev_b32 v24, 5, v1
    s_lshl_b32 s90, s16, 4
    v_add_u32 v25, s90, v24
    v_mul_lo_u32 v25, v25, s78
    v_lshlrev_b32 v24, 1, v24
    v_and_b32 v26, 31, v1
    v_xor_b32 v24, v24, v26
    s_lshl_b32 s90, s78, 1
    s_sub_u32 s90, s90, 1024
    v_add_u32 v27, s90, v25
    v_xor_b32 v26, 0, v24
    v_lshl_add_u32 v18, v26, 4, v25
    v_xor_b32 v26, 4, v24
    v_lshl_add_u32 v19, v26, 4, v27
    v_xor_b32 v26, 8, v24
    v_lshl_add_u32 v20, v26, 4, v25
    v_xor_b32 v26, 12, v24
    v_lshl_add_u32 v21, v26, 4, v27
    s_mov_b32 s44, s74
    s_mov_b32 s45, s75
    s_mov_b32 s67, 0
    s_branch m_loop20
m_x39:
    s_cmp_le_u32 s65, 4
    s_cbranch_scc1 m_x40
    s_cmp_lg_u32 s16, 0
    s_cbranch_scc1 m_np46
    v_mov_b32 v4, s4
    v_mov_b32 v5, s5
    s_add_u32 s90, s17, 117440512
    s_mov_b64 exec, 1
    buffer_store_dwordx2 v[4:5], off, s[8:11], s90 sc1
    s_mov_b64 exec, -1
m_np46:
    s_mov_b32 s17, -1
    s_mov_b32 s67, 4
    s_branch m_loop20
m_x40:
    s_cmp_lg_u32 s65, 4
    s_cbranch_scc1 m_x41
    s_cmp_eq_u32 s70, 1
    s_cbranch_scc1 m_ea47
    buffer_load_dwordx2 v[4:5], v0, s[8:11], s37 offen sc1
m_eb48:
    s_branch m_loop20
m_x41:
    s_waitcnt vmcnt(16)
    s_cmp_lg_u32 s65, 3
    s_cbranch_scc1 m_x42
    s_cmp_eq_u32 s70, 1
    s_cbranch_scc1 m_ea49
    s_mov_b32 s3, 1048576
m_spin51:
    v_cmp_ne_u64 s[22:23], s[4:5], v[4:5]
    s_nop 3
    s_cmp_eq_u64 s[22:23], 0
    s_cbranch_scc1 m_ok52
    s_sub_u32 s3, s3, 1
    s_cbranch_scc1 m_ok52
    s_sleep 16
    buffer_load_dwordx2 v[4:5], v0, s[8:11], s37 offen sc1
    s_waitcnt vmcnt(0)
    s_branch m_spin51
m_ok52:
    buffer_load_dwordx4 a[128:131], v2, s[8:11], s33 offen offset:0 sc1
    buffer_load_dwordx4 a[132:135], v2, s[8:11], s33 offen offset:1024 sc1
    buffer_load_dwordx4 a[136:139], v2, s[8:11], s33 offen offset:2048 sc1
    buffer_load_dwordx4 a[140:143], v2, s[8:11], s33 offen offset:3072 sc1
    buffer_load_dwordx4 a[144:147], v2, s[8:11], s34 offen offset:0 sc1
    buffer_load_dwordx4 a[148:151], v2, s[8:11], s34 offen offset:1024 sc1
m_eb50:
    s_add_u32 s48, s32, 0
    s_mov_b32 s49, s48
    s_add_u32 s50, s48, 4096
    s_mov_b32 s51, s50
    s_cmp_eq_u32 s57, 0
    s_cselect_b32 s42, 268435456, 0
    s_mov_b32 s40, s6
    s_mov_b32 s41, s7
    v_mov_b32 v16, v2
    v_mov_b32 v17, v2
    s_branch m_loop20
m_x42:
    s_cmp_lg_u32 s65, 2
    s_cbranch_scc1 m_x43
    s_cmp_eq_u32 s70, 1
    s_cbranch_scc1 m_ea53
    buffer_load_dwordx4 a[152:155], v2, s[8:11], s34 offen offset:2048 sc1
    buffer_load_dwordx4 a[156:159], v2, s[8:11], s34 offen offset:3072 sc1
    buffer_load_dwordx4 a[160:163], v2, s[8:11], s35 offen offset:0 sc1
    buffer_load_dwordx4 a[164:167], v2, s[8:11], s35 offen offset:1024 sc1
    buffer_load_dwordx4 a[168:171], v2, s[8:11], s35 offen offset:2048 sc1
m_eb54:
    s_add_u32 s48, s32, 16384
    s_mov_b32 s49, s48
    s_add_u32 s50, s48, 4096
    s_mov_b32 s51, s50
    s_mov_b32 s42, 268435456
    s_add_u32 s52, s32, 49152
    s_mov_b32 s53, s52
    s_add_u32 s54, s52, 4096
    s_mov_b32 s55, s54
    s_mov_b32 s46, 268435456
    s_mov_b32 s44, s6
    s_mov_b32 s45, s7
    v_mov_b32 v18, v2
    v_mov_b32 v19, v2
    v_mov_b32 v20, v2
    v_mov_b32 v21, v2
    s_branch m_loop20
m_x43:
    s_cmp_eq_u32 s70, 1
    s_cbranch_scc1 m_ea55
    buffer_load_dwordx4 a[172:175], v2, s[8:11], s35 offen offset:3072 sc1
    buffer_load_dwordx4 a[176:179], v2, s[8:11], s36 offen offset:0 sc1
    buffer_load_dwordx4 a[180:183], v2, s[8:11], s36 offen offset:1024 sc1
    buffer_load_dwordx4 a[184:187], v2, s[8:11], s36 offen offset:2048 sc1
    buffer_load_dwordx4 a[188:191], v2, s[8:11], s36 offen offset:3072 sc1
m_eb56:
    s_add_u32 s48, s32, 32768
    s_mov_b32 s49, s48
    s_add_u32 s50, s48, 4096
    s_mov_b32 s51, s50
    s_add_u32 s52, s32, 65536
    s_mov_b32 s53, s52
    s_add_u32 s54, s52, 4096
    s_mov_b32 s55, s54
    s_branch m_loop20
m_ea47:
    s_and_b32 s92, s2, 7
    s_lshl_b32 s92, s92, 2
    s_bfe_u32 s93, s2, 0x20003
    s_add_u32 s92, s92, s93
    s_lshr_b32 s93, s2, 5
    s_lshl_b32 s93, s93, 2
    s_or_b32 s93, s93, 0x40000
    v_and_b32 v0, 3, v1
    v_min_u32 v0, 2, v0
    v_and_b32 v24, 4, v1
    v_add3_u32 v0, v0, v24, 8
    v_lshlrev_b32 v0, 3, v0
    buffer_load_dwordx2 v[4:5], v0, s[8:11], s37 offen sc1
    s_branch m_eb48
m_ea49:
    s_mov_b32 s3, 1048576
m_spin57:
    v_cmp_ne_u64 s[22:23], s[4:5], v[4:5]
    s_nop 3
    s_cmp_eq_u64 s[22:23], 0
    s_cbranch_scc1 m_ok58
    s_sub_u32 s3, s3, 1
    s_cbranch_scc1 m_ok58
    s_sleep 16
    buffer_load_dwordx2 v[4:5], v0, s[8:11], s37 offen sc1
    s_waitcnt vmcnt(0)
    s_branch m_spin57
m_ok58:
    s_branch m_eb50
m_ea53:
    s_and_b32 s92, s2, 7
    s_lshl_b32 s92, s92, 2
    s_bfe_u32 s93, s2, 0x20003
    s_add_u32 s92, s92, s93
    s_lshr_b32 s93, s2, 5
    s_lshl_b32 s93, s93, 2
    s_or_b32 s93, s93, 0x40000
    s_bfe_u32 s91, 873484918, s93
    s_lshr_b32 s91, s91, 1
    v_mov_b32 v0, s91
    s_bfe_u32 s91, 4225674377, s93
    s_lshr_b32 s91, s91, 1
    v_writelane_b32 v0, s91, 8
    v_lshlrev_b32 v0, 3, v0
    buffer_load_dwordx2 v[4:5], v0, s[8:11], s37 offen sc1
    s_branch m_eb54
m_ea55:
    s_mov_b32 s3, 1048576
m_spin59:
    v_cmp_ne_u64 s[22:23], s[4:5], v[4:5]
    s_nop 3
    s_cmp_eq_u64 s[22:23], 0
    s_cbranch_scc1 m_ok60
    s_sub_u32 s3, s3, 1
    s_cbranch_scc1 m_ok60
    s_sleep 16
    buffer_load_dwordx2 v[4:5], v0, s[8:11], s37 offen sc1
    s_waitcnt vmcnt(0)
    s_branch m_spin59
m_ok60:
    buffer_load_dwordx4 a[128:131], v2, s[8:11], s33 offen offset:0 sc1
    buffer_load_dwordx4 a[132:135], v2, s[8:11], s33 offen offset:1024 sc1
    buffer_load_dwordx4 a[136:139], v2, s[8:11], s33 offen offset:2048 sc1
    buffer_load_dwordx4 a[140:143], v2, s[8:11], s33 offen offset:3072 sc1
    buffer_load_dwordx4 a[144:147], v2, s[8:11], s34 offen offset:0 sc1
    buffer_load_dwordx4 a[148:151], v2, s[8:11], s34 offen offset:1024 sc1
    buffer_load_dwordx4 a[152:155], v2, s[8:11], s34 offen offset:2048 sc1
    buffer_load_dwordx4 a[156:159], v2, s[8:11], s34 offen offset:3072 sc1
    buffer_load_dwordx4 a[160:163], v2, s[8:11], s35 offen offset:0 sc1
    buffer_load_dwordx4 a[164:167], v2, s[8:11], s35 offen offset:1024 sc1
    buffer_load_dwordx4 a[168:171], v2, s[8:11], s35 offen offset:2048 sc1
    buffer_load_dwordx4 a[172:175], v2, s[8:11], s35 offen offset:3072 sc1
    buffer_load_dwordx4 a[176:179], v2, s[8:11], s36 offen offset:0 sc1
    buffer_load_dwordx4 a[180:183], v2, s[8:11], s36 offen offset:1024 sc1
    buffer_load_dwordx4 a[184:187], v2, s[8:11], s36 offen offset:2048 sc1
    buffer_load_dwordx4 a[188:191], v2, s[8:11], s36 offen offset:3072 sc1
    s_branch m_eb56
m_swp16:
    s_waitcnt lgkmcnt(15)
    v_mfma_f32_16x16x32_bf16 v[32:35], a[0:3], a[64:67], 0
    ds_read_b64_tr_b16 a[112:113], v14 offset:0
    v_mfma_f32_16x16x32_bf16 v[32:35], a[4:7], a[68:71], v[32:35]
    ds_read_b64_tr_b16 a[114:115], v14 offset:2048
    v_mfma_f32_16x16x32_bf16 v[40:43], a[4:7], a[76:79], 0
    ds_read_b64_tr_b16 a[116:117], v14 offset:16384
    v_mfma_f32_16x16x32_bf16 v[40:43], a[0:3], a[72:75], v[40:43]
    ds_read_b64_tr_b16 a[118:119], v14 offset:18432
    v_mfma_f32_16x16x32_bf16 v[44:47], a[8:11], a[72:75], 0
    ds_read_b64_tr_b16 a[120:121], v15 offset:0
    v_mfma_f32_16x16x32_bf16 v[44:47], a[12:15], a[76:79], v[44:47]
    ds_read_b64_tr_b16 a[122:123], v15 offset:2048
    v_mfma_f32_16x16x32_bf16 v[36:39], a[12:15], a[68:71], 0
    ds_read_b64_tr_b16 a[124:125], v15 offset:16384
    v_mfma_f32_16x16x32_bf16 v[36:39], a[8:11], a[64:67], v[36:39]
    ds_read_b64_tr_b16 a[126:127], v15 offset:18432
    v_mfma_f32_16x16x32_bf16 v[96:99], a[16:19], a[64:67], 0
    v_mfma_f32_16x16x32_bf16 v[96:99], a[20:23], a[68:71], v[96:99]
    v_mfma_f32_16x16x32_bf16 v[104:107], a[20:23], a[76:79], 0
    buffer_store_dwordx4 a[128:131], v2, s[24:27], s28 offen sc1
    v_mfma_f32_16x16x32_bf16 v[104:107], a[16:19], a[72:75], v[104:107]
    s_add_u32 s28, s28, s31
    s_waitcnt lgkmcnt(15)
    v_mfma_f32_16x16x32_bf16 v[108:111], a[24:27], a[72:75], 0
    v_xor_b32 v8, s60, v8
    v_xor_b32 v9, s60, v9
    v_mfma_f32_16x16x32_bf16 v[108:111], a[28:31], a[76:79], v[108:111]
    v_xor_b32 v10, s60, v10
    v_xor_b32 v11, s60, v11
    v_mfma_f32_16x16x32_bf16 v[100:103], a[28:31], a[68:71], 0
    v_xor_b32 v12, s60, v12
    v_xor_b32 v13, s60, v13
    v_mfma_f32_16x16x32_bf16 v[100:103], a[24:27], a[64:67], v[100:103]
    v_xor_b32 v14, s60, v14
    v_xor_b32 v15, s60, v15
    v_mfma_f32_16x16x32_bf16 v[160:163], a[32:35], a[64:67], 0
    buffer_store_dwordx4 a[132:135], v2, s[24:27], s28 offen sc1
    v_mfma_f32_16x16x32_bf16 v[160:163], a[36:39], a[68:71], v[160:163]
    s_add_u32 s28, s28, s31
    v_mfma_f32_16x16x32_bf16 v[168:171], a[36:39], a[76:79], 0
    v_mfma_f32_16x16x32_bf16 v[168:171], a[32:35], a[72:75], v[168:171]
    s_waitcnt lgkmcnt(14)
    v_mfma_f32_16x16x32_bf16 v[172:175], a[40:43], a[72:75], 0
    v_mfma_f32_16x16x32_bf16 v[172:175], a[44:47], a[76:79], v[172:175]
    v_mfma_f32_16x16x32_bf16 v[164:167], a[44:47], a[68:71], 0
    buffer_store_dwordx4 a[136:139], v2, s[24:27], s28 offen sc1
    v_mfma_f32_16x16x32_bf16 v[164:167], a[40:43], a[64:67], v[164:167]
    s_add_u32 s28, s28, s31
    s_waitcnt lgkmcnt(11)
    v_mfma_f32_16x16x32_bf16 v[224:227], a[48:51], a[64:67], 0
    v_mfma_f32_16x16x32_bf16 v[224:227], a[52:55], a[68:71], v[224:227]
    v_mfma_f32_16x16x32_bf16 v[232:235], a[52:55], a[76:79], 0
    v_mfma_f32_16x16x32_bf16 v[232:235], a[48:51], a[72:75], v[232:235]
    s_waitcnt lgkmcnt(8)
    v_mfma_f32_16x16x32_bf16 v[236:239], a[56:59], a[72:75], 0
    buffer_store_dwordx4 a[140:143], v2, s[24:27], s28 offen sc1
    v_mfma_f32_16x16x32_bf16 v[236:239], a[60:63], a[76:79], v[236:239]
    s_add_u32 s28, s28, s31
    v_mfma_f32_16x16x32_bf16 v[228:231], a[60:63], a[68:71], 0
    s_waitcnt vmcnt(44) lgkmcnt(0)
    s_cmp_eq_u32 s66, 2
    s_cbranch_scc1 m_w22
    s_waitcnt vmcnt(12)
m_w22:
    v_mfma_f32_16x16x32_bf16 v[228:231], a[56:59], a[64:67], v[228:231]
    s_barrier
    v_mfma_f32_16x16x32_bf16 v[48:51], a[0:3], a[80:83], 0
    ds_read_b64_tr_b16 a[64:65], v8 offset:0
    v_mfma_f32_16x16x32_bf16 v[48:51], a[4:7], a[84:87], v[48:51]
    s_add_u32 m0, s62, 0
    v_mfma_f32_16x16x32_bf16 v[56:59], a[4:7], a[92:95], 0
    buffer_load_dwordx4 v18, s[44:47], s52 offen offset:0 sc1 lds
    v_mfma_f32_16x16x32_bf16 v[56:59], a[0:3], a[88:91], v[56:59]
    ds_read_b64_tr_b16 a[66:67], v8 offset:2048
    v_mfma_f32_16x16x32_bf16 v[60:63], a[8:11], a[88:91], 0
    s_add_u32 s64, s64, 32768
    v_mfma_f32_16x16x32_bf16 v[60:63], a[12:15], a[92:95], v[60:63]
    s_cmp_ge_u32 s64, 98304
    s_cselect_b32 s63, 4294901760, s59
    s_cselect_b32 s64, 0, s64
    v_mfma_f32_16x16x32_bf16 v[52:55], a[12:15], a[84:87], 0
    buffer_load_dwordx4 v19, s[44:47], s52 offen offset:1024 sc1 lds
    v_mfma_f32_16x16x32_bf16 v[52:55], a[8:11], a[80:83], v[52:55]
    s_add_u32 s52, s52, s56
    ds_read_b64_tr_b16 a[68:69], v8 offset:16384
    v_mfma_f32_16x16x32_bf16 v[112:115], a[16:19], a[80:83], 0
    v_mfma_f32_16x16x32_bf16 v[112:115], a[20:23], a[84:87], v[112:115]
    v_mfma_f32_16x16x32_bf16 v[120:123], a[20:23], a[92:95], 0
    buffer_load_dwordx4 v18, s[44:47], s53 offen offset:2048 sc1 lds
    v_mfma_f32_16x16x32_bf16 v[120:123], a[16:19], a[88:91], v[120:123]
    ds_read_b64_tr_b16 a[70:71], v8 offset:18432
    v_mfma_f32_16x16x32_bf16 v[124:127], a[24:27], a[88:91], 0
    v_mfma_f32_16x16x32_bf16 v[124:127], a[28:31], a[92:95], v[124:127]
    v_mfma_f32_16x16x32_bf16 v[116:119], a[28:31], a[84:87], 0
    buffer_load_dwordx4 v19, s[44:47], s53 offen offset:3072 sc1 lds
    v_mfma_f32_16x16x32_bf16 v[116:119], a[24:27], a[80:83], v[116:119]
    s_add_u32 s53, s53, s56
    ds_read_b64_tr_b16 a[72:73], v9 offset:0
    v_mfma_f32_16x16x32_bf16 v[176:179], a[32:35], a[80:83], 0
    v_mfma_f32_16x16x32_bf16 v[176:179], a[36:39], a[84:87], v[176:179]
    s_add_u32 m0, s62, 4096
    v_mfma_f32_16x16x32_bf16 v[184:187], a[36:39], a[92:95], 0
    buffer_load_dwordx4 v20, s[44:47], s54 offen offset:0 sc1 lds
    v_mfma_f32_16x16x32_bf16 v[184:187], a[32:35], a[88:91], v[184:187]
    s_xor_b32 s62, s62, 229376
    ds_read_b64_tr_b16 a[74:75], v9 offset:2048
    v_mfma_f32_16x16x32_bf16 v[188:191], a[40:43], a[88:91], 0
    v_mfma_f32_16x16x32_bf16 v[188:191], a[44:47], a[92:95], v[188:191]
    v_mfma_f32_16x16x32_bf16 v[180:183], a[44:47], a[84:87], 0
    buffer_load_dwordx4 v21, s[44:47], s54 offen offset:1024 sc1 lds
    v_mfma_f32_16x16x32_bf16 v[180:183], a[40:43], a[80:83], v[180:183]
    s_add_u32 s54, s54, s56
    ds_read_b64_tr_b16 a[76:77], v9 offset:16384
    v_mfma_f32_16x16x32_bf16 v[240:243], a[48:51], a[80:83], 0
    v_mfma_f32_16x16x32_bf16 v[240:243], a[52:55], a[84:87], v[240:243]
    v_mfma_f32_16x16x32_bf16 v[248:251], a[52:55], a[92:95], 0
    buffer_load_dwordx4 v20, s[44:47], s55 offen offset:2048 sc1 lds
    v_mfma_f32_16x16x32_bf16 v[248:251], a[48:51], a[88:91], v[248:251]
    ds_read_b64_tr_b16 a[78:79], v9 offset:18432
    v_mfma_f32_16x16x32_bf16 v[252:255], a[56:59], a[88:91], 0
    v_add_u32 v6, s63, v6
    v_add_u32 v7, s63, v7
    v_mfma_f32_16x16x32_bf16 v[252:255], a[60:63], a[92:95], v[252:255]
    v_mfma_f32_16x16x32_bf16 v[244:247], a[60:63], a[84:87], 0
    buffer_load_dwordx4 v21, s[44:47], s55 offen offset:3072 sc1 lds
    v_mfma_f32_16x16x32_bf16 v[244:247], a[56:59], a[80:83], v[244:247]
    s_add_u32 s55, s55, s56
    v_mfma_f32_16x16x32_bf16 v[64:67], a[0:3], a[96:99], 0
    ds_read_b64_tr_b16 a[80:81], v10 offset:0
    v_mfma_f32_16x16x32_bf16 v[64:67], a[4:7], a[100:103], v[64:67]
    v_mfma_f32_16x16x32_bf16 v[72:75], a[4:7], a[108:111], 0
    v_mfma_f32_16x16x32_bf16 v[72:75], a[0:3], a[104:107], v[72:75]
    s_add_u32 m0, s61, 0
    ds_read_b64_tr_b16 a[82:83], v10 offset:2048
    v_mfma_f32_16x16x32_bf16 v[76:79], a[8:11], a[104:107], 0
    buffer_load_dwordx4 v16, s[40:43], s48 offen offset:0 sc1 lds
    v_mfma_f32_16x16x32_bf16 v[76:79], a[12:15], a[108:111], v[76:79]
    v_mfma_f32_16x16x32_bf16 v[68:71], a[12:15], a[100:103], 0
    ds_read_b64_tr_b16 a[84:85], v10 offset:16384
    v_mfma_f32_16x16x32_bf16 v[68:71], a[8:11], a[96:99], v[68:71]
    v_mfma_f32_16x16x32_bf16 v[128:131], a[16:19], a[96:99], 0
    buffer_store_dwordx4 a[144:147], v2, s[24:27], s28 offen sc1
    v_mfma_f32_16x16x32_bf16 v[128:131], a[20:23], a[100:103], v[128:131]
    s_add_u32 s28, s28, s31
    ds_read_b64_tr_b16 a[86:87], v10 offset:18432
    v_mfma_f32_16x16x32_bf16 v[136:139], a[20:23], a[108:111], 0
    v_mfma_f32_16x16x32_bf16 v[136:139], a[16:19], a[104:107], v[136:139]
    v_mfma_f32_16x16x32_bf16 v[140:143], a[24:27], a[104:107], 0
    buffer_load_dwordx4 v17, s[40:43], s48 offen offset:1024 sc1 lds
    v_mfma_f32_16x16x32_bf16 v[140:143], a[28:31], a[108:111], v[140:143]
    s_add_u32 s48, s48, 128
    ds_read_b64_tr_b16 a[88:89], v11 offset:0
    v_mfma_f32_16x16x32_bf16 v[132:135], a[28:31], a[100:103], 0
    v_mfma_f32_16x16x32_bf16 v[132:135], a[24:27], a[96:99], v[132:135]
    v_mfma_f32_16x16x32_bf16 v[192:195], a[32:35], a[96:99], 0
    buffer_store_dwordx4 a[148:151], v2, s[24:27], s28 offen sc1
    v_mfma_f32_16x16x32_bf16 v[192:195], a[36:39], a[100:103], v[192:195]
    s_add_u32 s28, s28, s31
    ds_read_b64_tr_b16 a[90:91], v11 offset:2048
    v_mfma_f32_16x16x32_bf16 v[200:203], a[36:39], a[108:111], 0
    v_mfma_f32_16x16x32_bf16 v[200:203], a[32:35], a[104:107], v[200:203]
    v_mfma_f32_16x16x32_bf16 v[204:207], a[40:43], a[104:107], 0
    buffer_load_dwordx4 v16, s[40:43], s49 offen offset:2048 sc1 lds
    v_mfma_f32_16x16x32_bf16 v[204:207], a[44:47], a[108:111], v[204:207]
    ds_read_b64_tr_b16 a[92:93], v11 offset:16384
    v_mfma_f32_16x16x32_bf16 v[196:199], a[44:47], a[100:103], 0
    v_mfma_f32_16x16x32_bf16 v[196:199], a[40:43], a[96:99], v[196:199]
    v_mfma_f32_16x16x32_bf16 a[224:227], a[48:51], a[96:99], 0
    buffer_store_dwordx4 a[152:155], v2, s[24:27], s28 offen sc1
    v_mfma_f32_16x16x32_bf16 a[224:227], a[52:55], a[100:103], a[224:227]
    s_add_u32 s28, s28, s31
    ds_read_b64_tr_b16 a[94:95], v11 offset:18432
    v_mfma_f32_16x16x32_bf16 a[232:235], a[52:55], a[108:111], 0
    v_mfma_f32_16x16x32_bf16 a[232:235], a[48:51], a[104:107], a[232:235]
    v_mfma_f32_16x16x32_bf16 a[236:239], a[56:59], a[104:107], 0
    buffer_load_dwordx4 v17, s[40:43], s49 offen offset:3072 sc1 lds
    v_mfma_f32_16x16x32_bf16 a[236:239], a[60:63], a[108:111], a[236:239]
    s_add_u32 s49, s49, 128
    v_mfma_f32_16x16x32_bf16 a[228:231], a[60:63], a[100:103], 0
    buffer_store_dwordx4 a[156:159], v2, s[24:27], s28 offen sc1
    v_mfma_f32_16x16x32_bf16 a[228:231], a[56:59], a[96:99], a[228:231]
    s_add_u32 s29, s29, s30
    s_mov_b32 s28, s29
    v_mfma_f32_16x16x32_bf16 v[80:83], a[0:3], a[112:115], 0
    v_mfma_f32_16x16x32_bf16 v[80:83], a[4:7], a[116:119], v[80:83]
    ds_read_b64_tr_b16 a[96:97], v12 offset:0
    v_mfma_f32_16x16x32_bf16 v[88:91], a[4:7], a[124:127], 0
    v_mfma_f32_16x16x32_bf16 v[88:91], a[0:3], a[120:123], v[88:91]
    s_add_u32 m0, s61, 4096
    ds_read_b128 a[0:3], v6 offset:0
    v_mfma_f32_16x16x32_bf16 v[92:95], a[8:11], a[120:123], 0
    buffer_load_dwordx4 v16, s[40:43], s50 offen offset:0 sc1 lds
    v_mfma_f32_16x16x32_bf16 v[92:95], a[12:15], a[124:127], v[92:95]
    s_add_u32 s61, s61, 32768
    ds_read_b128 a[4:7], v7 offset:0
    v_mfma_f32_16x16x32_bf16 v[84:87], a[12:15], a[116:119], 0
    s_cmp_ge_u32 s61, 98304
    s_cselect_b32 s90, 98304, 0
    ds_read_b64_tr_b16 a[98:99], v12 offset:2048
    v_mfma_f32_16x16x32_bf16 v[84:87], a[8:11], a[112:115], v[84:87]
    s_sub_u32 s61, s61, s90
    ds_read_b128 a[8:11], v6 offset:2048
    v_mfma_f32_16x16x32_bf16 v[144:147], a[16:19], a[112:115], 0
    ds_read_b128 a[12:15], v7 offset:2048
    v_mfma_f32_16x16x32_bf16 v[144:147], a[20:23], a[116:119], v[144:147]
    ds_read_b64_tr_b16 a[100:101], v12 offset:16384
    v_mfma_f32_16x16x32_bf16 v[152:155], a[20:23], a[124:127], 0
    v_mfma_f32_16x16x32_bf16 v[152:155], a[16:19], a[120:123], v[152:155]
    ds_read_b128 a[16:19], v6 offset:4096
    v_mfma_f32_16x16x32_bf16 v[156:159], a[24:27], a[120:123], 0
    buffer_load_dwordx4 v17, s[40:43], s50 offen offset:1024 sc1 lds
    v_mfma_f32_16x16x32_bf16 v[156:159], a[28:31], a[124:127], v[156:159]
    s_add_u32 s50, s50, 128
    ds_read_b128 a[20:23], v7 offset:4096
    v_mfma_f32_16x16x32_bf16 v[148:151], a[28:31], a[116:119], 0
    ds_read_b64_tr_b16 a[102:103], v12 offset:18432
    v_mfma_f32_16x16x32_bf16 v[148:151], a[24:27], a[112:115], v[148:151]
    ds_read_b128 a[24:27], v6 offset:6144
    v_mfma_f32_16x16x32_bf16 v[208:211], a[32:35], a[112:115], 0
    s_sub_u32 s65, s65, 1
    ds_read_b128 a[28:31], v7 offset:6144
    v_mfma_f32_16x16x32_bf16 v[208:211], a[36:39], a[116:119], v[208:211]
    ds_read_b64_tr_b16 a[104:105], v13 offset:0
    v_mfma_f32_16x16x32_bf16 v[216:219], a[36:39], a[124:127], 0
    v_mfma_f32_16x16x32_bf16 v[216:219], a[32:35], a[120:123], v[216:219]
    ds_read_b128 a[32:35], v6 offset:8192
    v_mfma_f32_16x16x32_bf16 v[220:223], a[40:43], a[120:123], 0
    buffer_load_dwordx4 v16, s[40:43], s51 offen offset:2048 sc1 lds
    v_mfma_f32_16x16x32_bf16 v[220:223], a[44:47], a[124:127], v[220:223]
    ds_read_b128 a[36:39], v7 offset:8192
    v_mfma_f32_16x16x32_bf16 v[212:215], a[44:47], a[116:119], 0
    ds_read_b64_tr_b16 a[106:107], v13 offset:2048
    v_mfma_f32_16x16x32_bf16 v[212:215], a[40:43], a[112:115], v[212:215]
    ds_read_b128 a[40:43], v6 offset:10240
    v_mfma_f32_16x16x32_bf16 a[240:243], a[48:51], a[112:115], 0
    ds_read_b128 a[44:47], v7 offset:10240
    v_mfma_f32_16x16x32_bf16 a[240:243], a[52:55], a[116:119], a[240:243]
    ds_read_b64_tr_b16 a[108:109], v13 offset:16384
    v_mfma_f32_16x16x32_bf16 a[248:251], a[52:55], a[124:127], 0
    v_mfma_f32_16x16x32_bf16 a[248:251], a[48:51], a[120:123], a[248:251]
    ds_read_b128 a[48:51], v6 offset:12288
    v_mfma_f32_16x16x32_bf16 a[252:255], a[56:59], a[120:123], 0
    buffer_load_dwordx4 v17, s[40:43], s51 offen offset:3072 sc1 lds
    v_mfma_f32_16x16x32_bf16 a[252:255], a[60:63], a[124:127], a[252:255]
    s_add_u32 s51, s51, 128
    ds_read_b128 a[52:55], v7 offset:12288
    v_mfma_f32_16x16x32_bf16 a[244:247], a[60:63], a[116:119], 0
    ds_read_b64_tr_b16 a[110:111], v13 offset:18432
    v_mfma_f32_16x16x32_bf16 a[244:247], a[56:59], a[112:115], a[244:247]
    ds_read_b128 a[56:59], v6 offset:14336
    ds_read_b128 a[60:63], v7 offset:14336
    s_waitcnt lgkmcnt(15)
    v_mfma_f32_16x16x32_bf16 v[32:35], a[0:3], a[64:67], v[32:35]
    ds_read_b64_tr_b16 a[112:113], v14 offset:0
    v_mfma_f32_16x16x32_bf16 v[32:35], a[4:7], a[68:71], v[32:35]
    ds_read_b64_tr_b16 a[114:115], v14 offset:2048
    v_mfma_f32_16x16x32_bf16 v[40:43], a[4:7], a[76:79], v[40:43]
    ds_read_b64_tr_b16 a[116:117], v14 offset:16384
    v_mfma_f32_16x16x32_bf16 v[40:43], a[0:3], a[72:75], v[40:43]
    ds_read_b64_tr_b16 a[118:119], v14 offset:18432
    v_mfma_f32_16x16x32_bf16 v[44:47], a[8:11], a[72:75], v[44:47]
    ds_read_b64_tr_b16 a[120:121], v15 offset:0
    v_mfma_f32_16x16x32_bf16 v[44:47], a[12:15], a[76:79], v[44:47]
    ds_read_b64_tr_b16 a[122:123], v15 offset:2048
    v_mfma_f32_16x16x32_bf16 v[36:39], a[12:15], a[68:71], v[36:39]
    ds_read_b64_tr_b16 a[124:125], v15 offset:16384
    v_mfma_f32_16x16x32_bf16 v[36:39], a[8:11], a[64:67], v[36:39]
    ds_read_b64_tr_b16 a[126:127], v15 offset:18432
    v_mfma_f32_16x16x32_bf16 v[96:99], a[16:19], a[64:67], v[96:99]
    v_mfma_f32_16x16x32_bf16 v[96:99], a[20:23], a[68:71], v[96:99]
    v_mfma_f32_16x16x32_bf16 v[104:107], a[20:23], a[76:79], v[104:107]
    buffer_store_dwordx4 a[160:163], v2, s[24:27], s28 offen sc1
    v_mfma_f32_16x16x32_bf16 v[104:107], a[16:19], a[72:75], v[104:107]
    s_add_u32 s28, s28, s31
    s_waitcnt lgkmcnt(15)
    v_mfma_f32_16x16x32_bf16 v[108:111], a[24:27], a[72:75], v[108:111]
    v_xor_b32 v8, s60, v8
    v_xor_b32 v9, s60, v9
    v_mfma_f32_16x16x32_bf16 v[108:111], a[28:31], a[76:79], v[108:111]
    v_xor_b32 v10, s60, v10
    v_xor_b32 v11, s60, v11
    v_mfma_f32_16x16x32_bf16 v[100:103], a[28:31], a[68:71], v[100:103]
    v_xor_b32 v12, s60, v12
    v_xor_b32 v13, s60, v13
    v_mfma_f32_16x16x32_bf16 v[100:103], a[24:27], a[64:67], v[100:103]
    v_xor_b32 v14, s60, v14
    v_xor_b32 v15, s60, v15
    v_mfma_f32_16x16x32_bf16 v[160:163], a[32:35], a[64:67], v[160:163]
    buffer_store_dwordx4 a[164:167], v2, s[24:27], s28 offen sc1
    v_mfma_f32_16x16x32_bf16 v[160:163], a[36:39], a[68:71], v[160:163]
    s_add_u32 s28, s28, s31
    v_mfma_f32_16x16x32_bf16 v[168:171], a[36:39], a[76:79], v[168:171]
    v_mfma_f32_16x16x32_bf16 v[168:171], a[32:35], a[72:75], v[168:171]
    s_waitcnt lgkmcnt(14)
    v_mfma_f32_16x16x32_bf16 v[172:175], a[40:43], a[72:75], v[172:175]
    v_mfma_f32_16x16x32_bf16 v[172:175], a[44:47], a[76:79], v[172:175]
    v_mfma_f32_16x16x32_bf16 v[164:167], a[44:47], a[68:71], v[164:167]
    buffer_store_dwordx4 a[168:171], v2, s[24:27], s28 offen sc1
    v_mfma_f32_16x16x32_bf16 v[164:167], a[40:43], a[64:67], v[164:167]
    s_add_u32 s28, s28, s31
    s_waitcnt lgkmcnt(11)
    v_mfma_f32_16x16x32_bf16 v[224:227], a[48:51], a[64:67], v[224:227]
    v_mfma_f32_16x16x32_bf16 v[224:227], a[52:55], a[68:71], v[224:227]
    v_mfma_f32_16x16x32_bf16 v[232:235], a[52:55], a[76:79], v[232:235]
    v_mfma_f32_16x16x32_bf16 v[232:235], a[48:51], a[72:75], v[232:235]
    s_waitcnt lgkmcnt(8)
    v_mfma_f32_16x16x32_bf16 v[236:239], a[56:59], a[72:75], v[236:239]
    buffer_store_dwordx4 a[172:175], v2, s[24:27], s28 offen sc1
    v_mfma_f32_16x16x32_bf16 v[236:239], a[60:63], a[76:79], v[236:239]
    s_add_u32 s28, s28, s31
    v_mfma_f32_16x16x32_bf16 v[228:231], a[60:63], a[68:71], v[228:231]
    s_waitcnt vmcnt(16) lgkmcnt(0)
    v_mfma_f32_16x16x32_bf16 v[228:231], a[56:59], a[64:67], v[228:231]
    s_barrier
    v_mfma_f32_16x16x32_bf16 v[48:51], a[0:3], a[80:83], v[48:51]
    ds_read_b64_tr_b16 a[64:65], v8 offset:0
    v_mfma_f32_16x16x32_bf16 v[48:51], a[4:7], a[84:87], v[48:51]
    s_add_u32 m0, s62, 0
    v_mfma_f32_16x16x32_bf16 v[56:59], a[4:7], a[92:95], v[56:59]
    buffer_load_dwordx4 v18, s[44:47], s52 offen offset:0 sc1 lds
    v_mfma_f32_16x16x32_bf16 v[56:59], a[0:3], a[88:91], v[56:59]
    ds_read_b64_tr_b16 a[66:67], v8 offset:2048
    v_mfma_f32_16x16x32_bf16 v[60:63], a[8:11], a[88:91], v[60:63]
    s_add_u32 s64, s64, 32768
    v_mfma_f32_16x16x32_bf16 v[60:63], a[12:15], a[92:95], v[60:63]
    s_cmp_ge_u32 s64, 98304
    s_cselect_b32 s63, 4294901760, s59
    s_cselect_b32 s64, 0, s64
    v_mfma_f32_16x16x32_bf16 v[52:55], a[12:15], a[84:87], v[52:55]
    buffer_load_dwordx4 v19, s[44:47], s52 offen offset:1024 sc1 lds
    v_mfma_f32_16x16x32_bf16 v[52:55], a[8:11], a[80:83], v[52:55]
    s_add_u32 s52, s52, s56
    ds_read_b64_tr_b16 a[68:69], v8 offset:16384
    v_mfma_f32_16x16x32_bf16 v[112:115], a[16:19], a[80:83], v[112:115]
    v_mfma_f32_16x16x32_bf16 v[112:115], a[20:23], a[84:87], v[112:115]
    v_mfma_f32_16x16x32_bf16 v[120:123], a[20:23], a[92:95], v[120:123]
    buffer_load_dwordx4 v18, s[44:47], s53 offen offset:2048 sc1 lds
    v_mfma_f32_16x16x32_bf16 v[120:123], a[16:19], a[88:91], v[120:123]
    ds_read_b64_tr_b16 a[70:71], v8 offset:18432
    v_mfma_f32_16x16x32_bf16 v[124:127], a[24:27], a[88:91], v[124:127]
    v_mfma_f32_16x16x32_bf16 v[124:127], a[28:31], a[92:95], v[124:127]
    v_mfma_f32_16x16x32_bf16 v[116:119], a[28:31], a[84:87], v[116:119]
    buffer_load_dwordx4 v19, s[44:47], s53 offen offset:3072 sc1 lds
    v_mfma_f32_16x16x32_bf16 v[116:119], a[24:27], a[80:83], v[116:119]
    s_add_u32 s53, s53, s56
    ds_read_b64_tr_b16 a[72:73], v9 offset:0
    v_mfma_f32_16x16x32_bf16 v[176:179], a[32:35], a[80:83], v[176:179]
    v_mfma_f32_16x16x32_bf16 v[176:179], a[36:39], a[84:87], v[176:179]
    s_add_u32 m0, s62, 4096
    v_mfma_f32_16x16x32_bf16 v[184:187], a[36:39], a[92:95], v[184:187]
    buffer_load_dwordx4 v20, s[44:47], s54 offen offset:0 sc1 lds
    v_mfma_f32_16x16x32_bf16 v[184:187], a[32:35], a[88:91], v[184:187]
    s_xor_b32 s62, s62, 229376
    ds_read_b64_tr_b16 a[74:75], v9 offset:2048
    v_mfma_f32_16x16x32_bf16 v[188:191], a[40:43], a[88:91], v[188:191]
    v_mfma_f32_16x16x32_bf16 v[188:191], a[44:47], a[92:95], v[188:191]
    v_mfma_f32_16x16x32_bf16 v[180:183], a[44:47], a[84:87], v[180:183]
    buffer_load_dwordx4 v21, s[44:47], s54 offen offset:1024 sc1 lds
    v_mfma_f32_16x16x32_bf16 v[180:183], a[40:43], a[80:83], v[180:183]
    s_add_u32 s54, s54, s56
    ds_read_b64_tr_b16 a[76:77], v9 offset:16384
    v_mfma_f32_16x16x32_bf16 v[240:243], a[48:51], a[80:83], v[240:243]
    v_mfma_f32_16x16x32_bf16 v[240:243], a[52:55], a[84:87], v[240:243]
    v_mfma_f32_16x16x32_bf16 v[248:251], a[52:55], a[92:95], v[248:251]
    buffer_load_dwordx4 v20, s[44:47], s55 offen offset:2048 sc1 lds
    v_mfma_f32_16x16x32_bf16 v[248:251], a[48:51], a[88:91], v[248:251]
    ds_read_b64_tr_b16 a[78:79], v9 offset:18432
    v_mfma_f32_16x16x32_bf16 v[252:255], a[56:59], a[88:91], v[252:255]
    v_add_u32 v6, s63, v6
    v_add_u32 v7, s63, v7
    v_mfma_f32_16x16x32_bf16 v[252:255], a[60:63], a[92:95], v[252:255]
    v_mfma_f32_16x16x32_bf16 v[244:247], a[60:63], a[84:87], v[244:247]
    buffer_load_dwordx4 v21, s[44:47], s55 offen offset:3072 sc1 lds
    v_mfma_f32_16x16x32_bf16 v[244:247], a[56:59], a[80:83], v[244:247]
    s_add_u32 s55, s55, s56
    v_mfma_f32_16x16x32_bf16 v[64:67], a[0:3], a[96:99], v[64:67]
    ds_read_b64_tr_b16 a[80:81], v10 offset:0
    v_mfma_f32_16x16x32_bf16 v[64:67], a[4:7], a[100:103], v[64:67]
    v_mfma_f32_16x16x32_bf16 v[72:75], a[4:7], a[108:111], v[72:75]
    v_mfma_f32_16x16x32_bf16 v[72:75], a[0:3], a[104:107], v[72:75]
    s_add_u32 m0, s61, 0
    ds_read_b64_tr_b16 a[82:83], v10 offset:2048
    v_mfma_f32_16x16x32_bf16 v[76:79], a[8:11], a[104:107], v[76:79]
    buffer_load_dwordx4 v16, s[40:43], s48 offen offset:0 sc1 lds
    v_mfma_f32_16x16x32_bf16 v[76:79], a[12:15], a[108:111], v[76:79]
    v_mfma_f32_16x16x32_bf16 v[68:71], a[12:15], a[100:103], v[68:71]
    ds_read_b64_tr_b16 a[84:85], v10 offset:16384
    v_mfma_f32_16x16x32_bf16 v[68:71], a[8:11], a[96:99], v[68:71]
    v_mfma_f32_16x16x32_bf16 v[128:131], a[16:19], a[96:99], v[128:131]
    buffer_store_dwordx4 a[176:179], v2, s[24:27], s28 offen sc1
    v_mfma_f32_16x16x32_bf16 v[128:131], a[20:23], a[100:103], v[128:131]
    s_add_u32 s28, s28, s31
    ds_read_b64_tr_b16 a[86:87], v10 offset:18432
    v_mfma_f32_16x16x32_bf16 v[136:139], a[20:23], a[108:111], v[136:139]
    v_mfma_f32_16x16x32_bf16 v[136:139], a[16:19], a[104:107], v[136:139]
    v_mfma_f32_16x16x32_bf16 v[140:143], a[24:27], a[104:107], v[140:143]
    buffer_load_dwordx4 v17, s[40:43], s48 offen offset:1024 sc1 lds
    v_mfma_f32_16x16x32_bf16 v[140:143], a[28:31], a[108:111], v[140:143]
    s_add_u32 s48, s48, 128
    ds_read_b64_tr_b16 a[88:89], v11 offset:0
    v_mfma_f32_16x16x32_bf16 v[132:135], a[28:31], a[100:103], v[132:135]
    v_mfma_f32_16x16x32_bf16 v[132:135], a[24:27], a[96:99], v[132:135]
    v_mfma_f32_16x16x32_bf16 v[192:195], a[32:35], a[96:99], v[192:195]
    buffer_store_dwordx4 a[180:183], v2, s[24:27], s28 offen sc1
    v_mfma_f32_16x16x32_bf16 v[192:195], a[36:39], a[100:103], v[192:195]
    s_add_u32 s28, s28, s31
    ds_read_b64_tr_b16 a[90:91], v11 offset:2048
    v_mfma_f32_16x16x32_bf16 v[200:203], a[36:39], a[108:111], v[200:203]
    v_mfma_f32_16x16x32_bf16 v[200:203], a[32:35], a[104:107], v[200:203]
    v_mfma_f32_16x16x32_bf16 v[204:207], a[40:43], a[104:107], v[204:207]
    buffer_load_dwordx4 v16, s[40:43], s49 offen offset:2048 sc1 lds
    v_mfma_f32_16x16x32_bf16 v[204:207], a[44:47], a[108:111], v[204:207]
    ds_read_b64_tr_b16 a[92:93], v11 offset:16384
    v_mfma_f32_16x16x32_bf16 v[196:199], a[44:47], a[100:103], v[196:199]
    v_mfma_f32_16x16x32_bf16 v[196:199], a[40:43], a[96:99], v[196:199]
    v_mfma_f32_16x16x32_bf16 a[224:227], a[48:51], a[96:99], a[224:227]
    buffer_store_dwordx4 a[184:187], v2, s[24:27], s28 offen sc1
    v_mfma_f32_16x16x32_bf16 a[224:227], a[52:55], a[100:103], a[224:227]
    s_add_u32 s28, s28, s31
    ds_read_b64_tr_b16 a[94:95], v11 offset:18432
    v_mfma_f32_16x16x32_bf16 a[232:235], a[52:55], a[108:111], a[232:235]
    v_mfma_f32_16x16x32_bf16 a[232:235], a[48:51], a[104:107], a[232:235]
    v_mfma_f32_16x16x32_bf16 a[236:239], a[56:59], a[104:107], a[236:239]
    buffer_load_dwordx4 v17, s[40:43], s49 offen offset:3072 sc1 lds
    v_mfma_f32_16x16x32_bf16 a[236:239], a[60:63], a[108:111], a[236:239]
    s_add_u32 s49, s49, 128
    v_mfma_f32_16x16x32_bf16 a[228:231], a[60:63], a[100:103], a[228:231]
    buffer_store_dwordx4 a[188:191], v2, s[24:27], s28 offen sc1
    v_mfma_f32_16x16x32_bf16 a[228:231], a[56:59], a[96:99], a[228:231]
    s_add_u32 s29, s29, s30
    s_mov_b32 s28, s29
    v_mfma_f32_16x16x32_bf16 v[80:83], a[0:3], a[112:115], v[80:83]
    v_mfma_f32_16x16x32_bf16 v[80:83], a[4:7], a[116:119], v[80:83]
    ds_read_b64_tr_b16 a[96:97], v12 offset:0
    v_mfma_f32_16x16x32_bf16 v[88:91], a[4:7], a[124:127], v[88:91]
    v_mfma_f32_16x16x32_bf16 v[88:91], a[0:3], a[120:123], v[88:91]
    s_add_u32 m0, s61, 4096
    ds_read_b128 a[0:3], v6 offset:0
    v_mfma_f32_16x16x32_bf16 v[92:95], a[8:11], a[120:123], v[92:95]
    buffer_load_dwordx4 v16, s[40:43], s50 offen offset:0 sc1 lds
    v_mfma_f32_16x16x32_bf16 v[92:95], a[12:15], a[124:127], v[92:95]
    s_add_u32 s61, s61, 32768
    ds_read_b128 a[4:7], v7 offset:0
    v_mfma_f32_16x16x32_bf16 v[84:87], a[12:15], a[116:119], v[84:87]
    s_cmp_ge_u32 s61, 98304
    s_cselect_b32 s90, 98304, 0
    ds_read_b64_tr_b16 a[98:99], v12 offset:2048
    v_mfma_f32_16x16x32_bf16 v[84:87], a[8:11], a[112:115], v[84:87]
    s_sub_u32 s61, s61, s90
    ds_read_b128 a[8:11], v6 offset:2048
    v_mfma_f32_16x16x32_bf16 v[144:147], a[16:19], a[112:115], v[144:147]
    ds_read_b128 a[12:15], v7 offset:2048
    v_mfma_f32_16x16x32_bf16 v[144:147], a[20:23], a[116:119], v[144:147]
    ds_read_b64_tr_b16 a[100:101], v12 offset:16384
    v_mfma_f32_16x16x32_bf16 v[152:155], a[20:23], a[124:127], v[152:155]
    v_mfma_f32_16x16x32_bf16 v[152:155], a[16:19], a[120:123], v[152:155]
    ds_read_b128 a[16:19], v6 offset:4096
    v_mfma_f32_16x16x32_bf16 v[156:159], a[24:27], a[120:123], v[156:159]
    buffer_load_dwordx4 v17, s[40:43], s50 offen offset:1024 sc1 lds
    v_mfma_f32_16x16x32_bf16 v[156:159], a[28:31], a[124:127], v[156:159]
    s_add_u32 s50, s50, 128
    ds_read_b128 a[20:23], v7 offset:4096
    v_mfma_f32_16x16x32_bf16 v[148:151], a[28:31], a[116:119], v[148:151]
    ds_read_b64_tr_b16 a[102:103], v12 offset:18432
    v_mfma_f32_16x16x32_bf16 v[148:151], a[24:27], a[112:115], v[148:151]
    ds_read_b128 a[24:27], v6 offset:6144
    v_mfma_f32_16x16x32_bf16 v[208:211], a[32:35], a[112:115], v[208:211]
    s_sub_u32 s65, s65, 1
    ds_read_b128 a[28:31], v7 offset:6144
    v_mfma_f32_16x16x32_bf16 v[208:211], a[36:39], a[116:119], v[208:211]
    ds_read_b64_tr_b16 a[104:105], v13 offset:0
    v_mfma_f32_16x16x32_bf16 v[216:219], a[36:39], a[124:127], v[216:219]
    v_mfma_f32_16x16x32_bf16 v[216:219], a[32:35], a[120:123], v[216:219]
    ds_read_b128 a[32:35], v6 offset:8192
    v_mfma_f32_16x16x32_bf16 v[220:223], a[40:43], a[120:123], v[220:223]
    buffer_load_dwordx4 v16, s[40:43], s51 offen offset:2048 sc1 lds
    v_mfma_f32_16x16x32_bf16 v[220:223], a[44:47], a[124:127], v[220:223]
    ds_read_b128 a[36:39], v7 offset:8192
    v_mfma_f32_16x16x32_bf16 v[212:215], a[44:47], a[116:119], v[212:215]
    ds_read_b64_tr_b16 a[106:107], v13 offset:2048
    v_mfma_f32_16x16x32_bf16 v[212:215], a[40:43], a[112:115], v[212:215]
    ds_read_b128 a[40:43], v6 offset:10240
    v_mfma_f32_16x16x32_bf16 a[240:243], a[48:51], a[112:115], a[240:243]
    ds_read_b128 a[44:47], v7 offset:10240
    v_mfma_f32_16x16x32_bf16 a[240:243], a[52:55], a[116:119], a[240:243]
    ds_read_b64_tr_b16 a[108:109], v13 offset:16384
    v_mfma_f32_16x16x32_bf16 a[248:251], a[52:55], a[124:127], a[248:251]
    v_mfma_f32_16x16x32_bf16 a[248:251], a[48:51], a[120:123], a[248:251]
    ds_read_b128 a[48:51], v6 offset:12288
    v_mfma_f32_16x16x32_bf16 a[252:255], a[56:59], a[120:123], a[252:255]
    buffer_load_dwordx4 v17, s[40:43], s51 offen offset:3072 sc1 lds
    v_mfma_f32_16x16x32_bf16 a[252:255], a[60:63], a[124:127], a[252:255]
    s_add_u32 s51, s51, 128
    ds_read_b128 a[52:55], v7 offset:12288
    v_mfma_f32_16x16x32_bf16 a[244:247], a[60:63], a[116:119], a[244:247]
    ds_read_b64_tr_b16 a[110:111], v13 offset:18432
    v_mfma_f32_16x16x32_bf16 a[244:247], a[56:59], a[112:115], a[244:247]
    ds_read_b128 a[56:59], v6 offset:14336
    ds_read_b128 a[60:63], v7 offset:14336
    s_cmp_eq_u32 s66, 2
    s_cbranch_scc1 m_hook23
m_hookr24:
    s_waitcnt lgkmcnt(15)
    v_mfma_f32_16x16x32_bf16 v[32:35], a[0:3], a[64:67], v[32:35]
    ds_read_b64_tr_b16 a[112:113], v14 offset:0
    v_mfma_f32_16x16x32_bf16 v[32:35], a[4:7], a[68:71], v[32:35]
    ds_read_b64_tr_b16 a[114:115], v14 offset:2048
    v_mfma_f32_16x16x32_bf16 v[40:43], a[4:7], a[76:79], v[40:43]
    ds_read_b64_tr_b16 a[116:117], v14 offset:16384
    v_mfma_f32_16x16x32_bf16 v[40:43], a[0:3], a[72:75], v[40:43]
    ds_read_b64_tr_b16 a[118:119], v14 offset:18432
    v_mfma_f32_16x16x32_bf16 v[44:47], a[8:11], a[72:75], v[44:47]
    ds_read_b64_tr_b16 a[120:121], v15 offset:0
    v_mfma_f32_16x16x32_bf16 v[44:47], a[12:15], a[76:79], v[44:47]
    ds_read_b64_tr_b16 a[122:123], v15 offset:2048
    v_mfma_f32_16x16x32_bf16 v[36:39], a[12:15], a[68:71], v[36:39]
    ds_read_b64_tr_b16 a[124:125], v15 offset:16384
    v_mfma_f32_16x16x32_bf16 v[36:39], a[8:11], a[64:67], v[36:39]
    ds_read_b64_tr_b16 a[126:127], v15 offset:18432
    v_mfma_f32_16x16x32_bf16 v[96:99], a[16:19], a[64:67], v[96:99]
    v_mfma_f32_16x16x32_bf16 v[96:99], a[20:23], a[68:71], v[96:99]
    v_mfma_f32_16x16x32_bf16 v[104:107], a[20:23], a[76:79], v[104:107]
    buffer_store_dwordx4 a[192:195], v2, s[24:27], s28 offen sc1
    v_mfma_f32_16x16x32_bf16 v[104:107], a[16:19], a[72:75], v[104:107]
    s_add_u32 s28, s28, s31
    s_waitcnt lgkmcnt(15)
    v_mfma_f32_16x16x32_bf16 v[108:111], a[24:27], a[72:75], v[108:111]
    v_xor_b32 v8, s60, v8
    v_xor_b32 v9, s60, v9
    v_mfma_f32_16x16x32_bf16 v[108:111], a[28:31], a[76:79], v[108:111]
    v_xor_b32 v10, s60, v10
    v_xor_b32 v11, s60, v11
    v_mfma_f32_16x16x32_bf16 v[100:103], a[28:31], a[68:71], v[100:103]
    v_xor_b32 v12, s60, v12
    v_xor_b32 v13, s60, v13
    v_mfma_f32_16x16x32_bf16 v[100:103], a[24:27], a[64:67], v[100:103]
    v_xor_b32 v14, s60, v14
    v_xor_b32 v15, s60, v15
    v_mfma_f32_16x16x32_bf16 v[160:163], a[32:35], a[64:67], v[160:163]
    buffer_store_dwordx4 a[196:199], v2, s[24:27], s28 offen sc1
    v_mfma_f32_16x16x32_bf16 v[160:163], a[36:39], a[68:71], v[160:163]
    s_add_u32 s28, s28, s31
    v_mfma_f32_16x16x32_bf16 v[168:171], a[36:39], a[76:79], v[168:171]
    v_mfma_f32_16x16x32_bf16 v[168:171], a[32:35], a[72:75], v[168:171]
    s_waitcnt lgkmcnt(14)
    v_mfma_f32_16x16x32_bf16 v[172:175], a[40:43], a[72:75], v[172:175]
    v_mfma_f32_16x16x32_bf16 v[172:175], a[44:47], a[76:79], v[172:175]
    v_mfma_f32_16x16x32_bf16 v[164:167], a[44:47], a[68:71], v[164:167]
    buffer_store_dwordx4 a[200:203], v2, s[24:27], s28 offen sc1
    v_mfma_f32_16x16x32_bf16 v[164:167], a[40:43], a[64:67], v[164:167]
    s_add_u32 s28, s28, s31
    s_waitcnt lgkmcnt(11)
    v_mfma_f32_16x16x32_bf16 v[224:227], a[48:51], a[64:67], v[224:227]
    v_mfma_f32_16x16x32_bf16 v[224:227], a[52:55], a[68:71], v[224:227]
    v_mfma_f32_16x16x32_bf16 v[232:235], a[52:55], a[76:79], v[232:235]
    v_mfma_f32_16x16x32_bf16 v[232:235], a[48:51], a[72:75], v[232:235]
    s_waitcnt lgkmcnt(8)
    v_mfma_f32_16x16x32_bf16 v[236:239], a[56:59], a[72:75], v[236:239]
    buffer_store_dwordx4 a[204:207], v2, s[24:27], s28 offen sc1
    v_mfma_f32_16x16x32_bf16 v[236:239], a[60:63], a[76:79], v[236:239]
    s_add_u32 s28, s28, s31
    v_mfma_f32_16x16x32_bf16 v[228:231], a[60:63], a[68:71], v[228:231]
    s_waitcnt vmcnt(16) lgkmcnt(0)
    v_mfma_f32_16x16x32_bf16 v[228:231], a[56:59], a[64:67], v[228:231]
    s_barrier
    v_mfma_f32_16x16x32_bf16 v[48:51], a[0:3], a[80:83], v[48:51]
    ds_read_b64_tr_b16 a[64:65], v8 offset:0
    v_mfma_f32_16x16x32_bf16 v[48:51], a[4:7], a[84:87], v[48:51]
    s_add_u32 m0, s62, 0
    v_mfma_f32_16x16x32_bf16 v[56:59], a[4:7], a[92:95], v[56:59]
    buffer_load_dwordx4 v18, s[44:47], s52 offen offset:0 sc1 lds
    v_mfma_f32_16x16x32_bf16 v[56:59], a[0:3], a[88:91], v[56:59]
    ds_read_b64_tr_b16 a[66:67], v8 offset:2048
    v_mfma_f32_16x16x32_bf16 v[60:63], a[8:11], a[88:91], v[60:63]
    s_add_u32 s64, s64, 32768
    v_mfma_f32_16x16x32_bf16 v[60:63], a[12:15], a[92:95], v[60:63]
    s_cmp_ge_u32 s64, 98304
    s_cselect_b32 s63, 4294901760, s59
    s_cselect_b32 s64, 0, s64
    v_mfma_f32_16x16x32_bf16 v[52:55], a[12:15], a[84:87], v[52:55]
    buffer_load_dwordx4 v19, s[44:47], s52 offen offset:1024 sc1 lds
    v_mfma_f32_16x16x32_bf16 v[52:55], a[8:11], a[80:83], v[52:55]
    s_add_u32 s52, s52, s56
    ds_read_b64_tr_b16 a[68:69], v8 offset:16384
    v_mfma_f32_16x16x32_bf16 v[112:115], a[16:19], a[80:83], v[112:115]
    v_mfma_f32_16x16x32_bf16 v[112:115], a[20:23], a[84:87], v[112:115]
    v_mfma_f32_16x16x32_bf16 v[120:123], a[20:23], a[92:95], v[120:123]
    buffer_load_dwordx4 v18, s[44:47], s53 offen offset:2048 sc1 lds
    v_mfma_f32_16x16x32_bf16 v[120:123], a[16:19], a[88:91], v[120:123]
    ds_read_b64_tr_b16 a[70:71], v8 offset:18432
    v_mfma_f32_16x16x32_bf16 v[124:127], a[24:27], a[88:91], v[124:127]
    v_mfma_f32_16x16x32_bf16 v[124:127], a[28:31], a[92:95], v[124:127]
    v_mfma_f32_16x16x32_bf16 v[116:119], a[28:31], a[84:87], v[116:119]
    buffer_load_dwordx4 v19, s[44:47], s53 offen offset:3072 sc1 lds
    v_mfma_f32_16x16x32_bf16 v[116:119], a[24:27], a[80:83], v[116:119]
    s_add_u32 s53, s53, s56
    ds_read_b64_tr_b16 a[72:73], v9 offset:0
    v_mfma_f32_16x16x32_bf16 v[176:179], a[32:35], a[80:83], v[176:179]
    v_mfma_f32_16x16x32_bf16 v[176:179], a[36:39], a[84:87], v[176:179]
    s_add_u32 m0, s62, 4096
    v_mfma_f32_16x16x32_bf16 v[184:187], a[36:39], a[92:95], v[184:187]
    buffer_load_dwordx4 v20, s[44:47], s54 offen offset:0 sc1 lds
    v_mfma_f32_16x16x32_bf16 v[184:187], a[32:35], a[88:91], v[184:187]
    s_xor_b32 s62, s62, 229376
    ds_read_b64_tr_b16 a[74:75], v9 offset:2048
    v_mfma_f32_16x16x32_bf16 v[188:191], a[40:43], a[88:91], v[188:191]
    v_mfma_f32_16x16x32_bf16 v[188:191], a[44:47], a[92:95], v[188:191]
    v_mfma_f32_16x16x32_bf16 v[180:183], a[44:47], a[84:87], v[180:183]
    buffer_load_dwordx4 v21, s[44:47], s54 offen offset:1024 sc1 lds
    v_mfma_f32_16x16x32_bf16 v[180:183], a[40:43], a[80:83], v[180:183]
    s_add_u32 s54, s54, s56
    ds_read_b64_tr_b16 a[76:77], v9 offset:16384
    v_mfma_f32_16x16x32_bf16 v[240:243], a[48:51], a[80:83], v[240:243]
    v_mfma_f32_16x16x32_bf16 v[240:243], a[52:55], a[84:87], v[240:243]
    v_mfma_f32_16x16x32_bf16 v[248:251], a[52:55], a[92:95], v[248:251]
    buffer_load_dwordx4 v20, s[44:47], s55 offen offset:2048 sc1 lds
    v_mfma_f32_16x16x32_bf16 v[248:251], a[48:51], a[88:91], v[248:251]
    ds_read_b64_tr_b16 a[78:79], v9 offset:18432
    v_mfma_f32_16x16x32_bf16 v[252:255], a[56:59], a[88:91], v[252:255]
    v_add_u32 v6, s63, v6
    v_add_u32 v7, s63, v7
    v_mfma_f32_16x16x32_bf16 v[252:255], a[60:63], a[92:95], v[252:255]
    v_mfma_f32_16x16x32_bf16 v[244:247], a[60:63], a[84:87], v[244:247]
    buffer_load_dwordx4 v21, s[44:47], s55 offen offset:3072 sc1 lds
    v_mfma_f32_16x16x32_bf16 v[244:247], a[56:59], a[80:83], v[244:247]
    s_add_u32 s55, s55, s56
    v_mfma_f32_16x16x32_bf16 v[64:67], a[0:3], a[96:99], v[64:67]
    ds_read_b64_tr_b16 a[80:81], v10 offset:0
    v_mfma_f32_16x16x32_bf16 v[64:67], a[4:7], a[100:103], v[64:67]
    v_mfma_f32_16x16x32_bf16 v[72:75], a[4:7], a[108:111], v[72:75]
    v_mfma_f32_16x16x32_bf16 v[72:75], a[0:3], a[104:107], v[72:75]
    s_add_u32 m0, s61, 0
    ds_read_b64_tr_b16 a[82:83], v10 offset:2048
    v_mfma_f32_16x16x32_bf16 v[76:79], a[8:11], a[104:107], v[76:79]
    buffer_load_dwordx4 v16, s[40:43], s48 offen offset:0 sc1 lds
    v_mfma_f32_16x16x32_bf16 v[76:79], a[12:15], a[108:111], v[76:79]
    v_mfma_f32_16x16x32_bf16 v[68:71], a[12:15], a[100:103], v[68:71]
    ds_read_b64_tr_b16 a[84:85], v10 offset:16384
    v_mfma_f32_16x16x32_bf16 v[68:71], a[8:11], a[96:99], v[68:71]
    v_mfma_f32_16x16x32_bf16 v[128:131], a[16:19], a[96:99], v[128:131]
    buffer_store_dwordx4 a[208:211], v2, s[24:27], s28 offen sc1
    v_mfma_f32_16x16x32_bf16 v[128:131], a[20:23], a[100:103], v[128:131]
    s_add_u32 s28, s28, s31
    ds_read_b64_tr_b16 a[86:87], v10 offset:18432
    v_mfma_f32_16x16x32_bf16 v[136:139], a[20:23], a[108:111], v[136:139]
    v_mfma_f32_16x16x32_bf16 v[136:139], a[16:19], a[104:107], v[136:139]
    v_mfma_f32_16x16x32_bf16 v[140:143], a[24:27], a[104:107], v[140:143]
    buffer_load_dwordx4 v17, s[40:43], s48 offen offset:1024 sc1 lds
    v_mfma_f32_16x16x32_bf16 v[140:143], a[28:31], a[108:111], v[140:143]
    s_add_u32 s48, s48, 128
    ds_read_b64_tr_b16 a[88:89], v11 offset:0
    v_mfma_f32_16x16x32_bf16 v[132:135], a[28:31], a[100:103], v[132:135]
    v_mfma_f32_16x16x32_bf16 v[132:135], a[24:27], a[96:99], v[132:135]
    v_mfma_f32_16x16x32_bf16 v[192:195], a[32:35], a[96:99], v[192:195]
    buffer_store_dwordx4 a[212:215], v2, s[24:27], s28 offen sc1
    v_mfma_f32_16x16x32_bf16 v[192:195], a[36:39], a[100:103], v[192:195]
    s_add_u32 s28, s28, s31
    ds_read_b64_tr_b16 a[90:91], v11 offset:2048
    v_mfma_f32_16x16x32_bf16 v[200:203], a[36:39], a[108:111], v[200:203]
    v_mfma_f32_16x16x32_bf16 v[200:203], a[32:35], a[104:107], v[200:203]
    v_mfma_f32_16x16x32_bf16 v[204:207], a[40:43], a[104:107], v[204:207]
    buffer_load_dwordx4 v16, s[40:43], s49 offen offset:2048 sc1 lds
    v_mfma_f32_16x16x32_bf16 v[204:207], a[44:47], a[108:111], v[204:207]
    ds_read_b64_tr_b16 a[92:93], v11 offset:16384
    v_mfma_f32_16x16x32_bf16 v[196:199], a[44:47], a[100:103], v[196:199]
    v_mfma_f32_16x16x32_bf16 v[196:199], a[40:43], a[96:99], v[196:199]
    v_mfma_f32_16x16x32_bf16 a[224:227], a[48:51], a[96:99], a[224:227]
    buffer_store_dwordx4 a[216:219], v2, s[24:27], s28 offen sc1
    v_mfma_f32_16x16x32_bf16 a[224:227], a[52:55], a[100:103], a[224:227]
    s_add_u32 s28, s28, s31
    ds_read_b64_tr_b16 a[94:95], v11 offset:18432
    v_mfma_f32_16x16x32_bf16 a[232:235], a[52:55], a[108:111], a[232:235]
    v_mfma_f32_16x16x32_bf16 a[232:235], a[48:51], a[104:107], a[232:235]
    v_mfma_f32_16x16x32_bf16 a[236:239], a[56:59], a[104:107], a[236:239]
    buffer_load_dwordx4 v17, s[40:43], s49 offen offset:3072 sc1 lds
    v_mfma_f32_16x16x32_bf16 a[236:239], a[60:63], a[108:111], a[236:239]
    s_add_u32 s49, s49, 128
    v_mfma_f32_16x16x32_bf16 a[228:231], a[60:63], a[100:103], a[228:231]
    buffer_store_dwordx4 a[220:223], v2, s[24:27], s28 offen sc1
    v_mfma_f32_16x16x32_bf16 a[228:231], a[56:59], a[96:99], a[228:231]
    s_add_u32 s29, s29, s30
    s_mov_b32 s28, s29
    v_mfma_f32_16x16x32_bf16 v[80:83], a[0:3], a[112:115], v[80:83]
    v_mfma_f32_16x16x32_bf16 v[80:83], a[4:7], a[116:119], v[80:83]
    ds_read_b64_tr_b16 a[96:97], v12 offset:0
    v_mfma_f32_16x16x32_bf16 v[88:91], a[4:7], a[124:127], v[88:91]
    v_mfma_f32_16x16x32_bf16 v[88:91], a[0:3], a[120:123], v[88:91]
    s_add_u32 m0, s61, 4096
    ds_read_b128 a[0:3], v6 offset:0
    v_mfma_f32_16x16x32_bf16 v[92:95], a[8:11], a[120:123], v[92:95]
    buffer_load_dwordx4 v16, s[40:43], s50 offen offset:0 sc1 lds
    v_mfma_f32_16x16x32_bf16 v[92:95], a[12:15], a[124:127], v[92:95]
    s_add_u32 s61, s61, 32768
    ds_read_b128 a[4:7], v7 offset:0
    v_mfma_f32_16x16x32_bf16 v[84:87], a[12:15], a[116:119], v[84:87]
    s_cmp_ge_u32 s61, 98304
    s_cselect_b32 s90, 98304, 0
    ds_read_b64_tr_b16 a[98:99], v12 offset:2048
    v_mfma_f32_16x16x32_bf16 v[84:87], a[8:11], a[112:115], v[84:87]
    s_sub_u32 s61, s61, s90
    ds_read_b128 a[8:11], v6 offset:2048
    v_mfma_f32_16x16x32_bf16 v[144:147], a[16:19], a[112:115], v[144:147]
    ds_read_b128 a[12:15], v7 offset:2048
    v_mfma_f32_16x16x32_bf16 v[144:147], a[20:23], a[116:119], v[144:147]
    ds_read_b64_tr_b16 a[100:101], v12 offset:16384
    v_mfma_f32_16x16x32_bf16 v[152:155], a[20:23], a[124:127], v[152:155]
    v_mfma_f32_16x16x32_bf16 v[152:155], a[16:19], a[120:123], v[152:155]
    ds_read_b128 a[16:19], v6 offset:4096
    v_mfma_f32_16x16x32_bf16 v[156:159], a[24:27], a[120:123], v[156:159]
    buffer_load_dwordx4 v17, s[40:43], s50 offen offset:1024 sc1 lds
    v_mfma_f32_16x16x32_bf16 v[156:159], a[28:31], a[124:127], v[156:159]
    s_add_u32 s50, s50, 128
    ds_read_b128 a[20:23], v7 offset:4096
    v_mfma_f32_16x16x32_bf16 v[148:151], a[28:31], a[116:119], v[148:151]
    ds_read_b64_tr_b16 a[102:103], v12 offset:18432
    v_mfma_f32_16x16x32_bf16 v[148:151], a[24:27], a[112:115], v[148:151]
    ds_read_b128 a[24:27], v6 offset:6144
    v_mfma_f32_16x16x32_bf16 v[208:211], a[32:35], a[112:115], v[208:211]
    s_sub_u32 s65, s65, 1
    ds_read_b128 a[28:31], v7 offset:6144
    v_mfma_f32_16x16x32_bf16 v[208:211], a[36:39], a[116:119], v[208:211]
    ds_read_b64_tr_b16 a[104:105], v13 offset:0
    v_mfma_f32_16x16x32_bf16 v[216:219], a[36:39], a[124:127], v[216:219]
    v_mfma_f32_16x16x32_bf16 v[216:219], a[32:35], a[120:123], v[216:219]
    ds_read_b128 a[32:35], v6 offset:8192
    v_mfma_f32_16x16x32_bf16 v[220:223], a[40:43], a[120:123], v[220:223]
    buffer_load_dwordx4 v16, s[40:43], s51 offen offset:2048 sc1 lds
    v_mfma_f32_16x16x32_bf16 v[220:223], a[44:47], a[124:127], v[220:223]
    ds_read_b128 a[36:39], v7 offset:8192
    v_mfma_f32_16x16x32_bf16 v[212:215], a[44:47], a[116:119], v[212:215]
    ds_read_b64_tr_b16 a[106:107], v13 offset:2048
    v_mfma_f32_16x16x32_bf16 v[212:215], a[40:43], a[112:115], v[212:215]
    ds_read_b128 a[40:43], v6 offset:10240
    v_mfma_f32_16x16x32_bf16 a[240:243], a[48:51], a[112:115], a[240:243]
    ds_read_b128 a[44:47], v7 offset:10240
    v_mfma_f32_16x16x32_bf16 a[240:243], a[52:55], a[116:119], a[240:243]
    ds_read_b64_tr_b16 a[108:109], v13 offset:16384
    v_mfma_f32_16x16x32_bf16 a[248:251], a[52:55], a[124:127], a[248:251]
    v_mfma_f32_16x16x32_bf16 a[248:251], a[48:51], a[120:123], a[248:251]
    ds_read_b128 a[48:51], v6 offset:12288
    v_mfma_f32_16x16x32_bf16 a[252:255], a[56:59], a[120:123], a[252:255]
    buffer_load_dwordx4 v17, s[40:43], s51 offen offset:3072 sc1 lds
    v_mfma_f32_16x16x32_bf16 a[252:255], a[60:63], a[124:127], a[252:255]
    s_add_u32 s51, s51, 128
    ds_read_b128 a[52:55], v7 offset:12288
    v_mfma_f32_16x16x32_bf16 a[244:247], a[60:63], a[116:119], a[244:247]
    ds_read_b64_tr_b16 a[110:111], v13 offset:18432
    v_mfma_f32_16x16x32_bf16 a[244:247], a[56:59], a[112:115], a[244:247]
    ds_read_b128 a[56:59], v6 offset:14336
    ds_read_b128 a[60:63], v7 offset:14336
.p2align 3
m_loop25:
    s_waitcnt lgkmcnt(15)
    v_mfma_f32_16x16x32_bf16 v[32:35], a[0:3], a[64:67], v[32:35]
    ds_read_b64_tr_b16 a[112:113], v14 offset:0
    v_mfma_f32_16x16x32_bf16 v[32:35], a[4:7], a[68:71], v[32:35]
    ds_read_b64_tr_b16 a[114:115], v14 offset:2048
    v_mfma_f32_16x16x32_bf16 v[40:43], a[4:7], a[76:79], v[40:43]
    ds_read_b64_tr_b16 a[116:117], v14 offset:16384
    v_mfma_f32_16x16x32_bf16 v[40:43], a[0:3], a[72:75], v[40:43]
    ds_read_b64_tr_b16 a[118:119], v14 offset:18432
    v_mfma_f32_16x16x32_bf16 v[44:47], a[8:11], a[72:75], v[44:47]
    ds_read_b64_tr_b16 a[120:121], v15 offset:0
    v_mfma_f32_16x16x32_bf16 v[44:47], a[12:15], a[76:79], v[44:47]
    ds_read_b64_tr_b16 a[122:123], v15 offset:2048
    v_mfma_f32_16x16x32_bf16 v[36:39], a[12:15], a[68:71], v[36:39]
    ds_read_b64_tr_b16 a[124:125], v15 offset:16384
    v_mfma_f32_16x16x32_bf16 v[36:39], a[8:11], a[64:67], v[36:39]
    ds_read_b64_tr_b16 a[126:127], v15 offset:18432
    v_mfma_f32_16x16x32_bf16 v[96:99], a[16:19], a[64:67], v[96:99]
    v_mfma_f32_16x16x32_bf16 v[96:99], a[20:23], a[68:71], v[96:99]
    v_mfma_f32_16x16x32_bf16 v[104:107], a[20:23], a[76:79], v[104:107]
    v_mfma_f32_16x16x32_bf16 v[104:107], a[16:19], a[72:75], v[104:107]
    s_waitcnt lgkmcnt(15)
    v_mfma_f32_16x16x32_bf16 v[108:111], a[24:27], a[72:75], v[108:111]
    v_xor_b32 v8, s60, v8
    v_xor_b32 v9, s60, v9
    v_mfma_f32_16x16x32_bf16 v[108:111], a[28:31], a[76:79], v[108:111]
    v_xor_b32 v10, s60, v10
    v_xor_b32 v11, s60, v11
    v_mfma_f32_16x16x32_bf16 v[100:103], a[28:31], a[68:71], v[100:103]
    v_xor_b32 v12, s60, v12
    v_xor_b32 v13, s60, v13
    v_mfma_f32_16x16x32_bf16 v[100:103], a[24:27], a[64:67], v[100:103]
    v_xor_b32 v14, s60, v14
    v_xor_b32 v15, s60, v15
    v_mfma_f32_16x16x32_bf16 v[160:163], a[32:35], a[64:67], v[160:163]
    v_mfma_f32_16x16x32_bf16 v[160:163], a[36:39], a[68:71], v[160:163]
    v_mfma_f32_16x16x32_bf16 v[168:171], a[36:39], a[76:79], v[168:171]
    v_mfma_f32_16x16x32_bf16 v[168:171], a[32:35], a[72:75], v[168:171]
    s_waitcnt lgkmcnt(14)
    v_mfma_f32_16x16x32_bf16 v[172:175], a[40:43], a[72:75], v[172:175]
    v_mfma_f32_16x16x32_bf16 v[172:175], a[44:47], a[76:79], v[172:175]
    v_mfma_f32_16x16x32_bf16 v[164:167], a[44:47], a[68:71], v[164:167]
    v_mfma_f32_16x16x32_bf16 v[164:167], a[40:43], a[64:67], v[164:167]
    s_waitcnt lgkmcnt(11)
    v_mfma_f32_16x16x32_bf16 v[224:227], a[48:51], a[64:67], v[224:227]
    v_mfma_f32_16x16x32_bf16 v[224:227], a[52:55], a[68:71], v[224:227]
    v_mfma_f32_16x16x32_bf16 v[232:235], a[52:55], a[76:79], v[232:235]
    v_mfma_f32_16x16x32_bf16 v[232:235], a[48:51], a[72:75], v[232:235]
    s_waitcnt lgkmcnt(8)
    v_mfma_f32_16x16x32_bf16 v[236:239], a[56:59], a[72:75], v[236:239]
    v_mfma_f32_16x16x32_bf16 v[236:239], a[60:63], a[76:79], v[236:239]
    v_mfma_f32_16x16x32_bf16 v[228:231], a[60:63], a[68:71], v[228:231]
    s_waitcnt vmcnt(8) lgkmcnt(0)
    v_mfma_f32_16x16x32_bf16 v[228:231], a[56:59], a[64:67], v[228:231]
    s_barrier
    v_mfma_f32_16x16x32_bf16 v[48:51], a[0:3], a[80:83], v[48:51]
    ds_read_b64_tr_b16 a[64:65], v8 offset:0
    v_mfma_f32_16x16x32_bf16 v[48:51], a[4:7], a[84:87], v[48:51]
    s_add_u32 m0, s62, 0
    v_mfma_f32_16x16x32_bf16 v[56:59], a[4:7], a[92:95], v[56:59]
    buffer_load_dwordx4 v18, s[44:47], s52 offen offset:0 sc1 lds
    v_mfma_f32_16x16x32_bf16 v[56:59], a[0:3], a[88:91], v[56:59]
    ds_read_b64_tr_b16 a[66:67], v8 offset:2048
    v_mfma_f32_16x16x32_bf16 v[60:63], a[8:11], a[88:91], v[60:63]
    s_add_u32 s64, s64, 32768
    v_mfma_f32_16x16x32_bf16 v[60:63], a[12:15], a[92:95], v[60:63]
    s_cmp_ge_u32 s64, 98304
    s_cselect_b32 s63, 4294901760, s59
    s_cselect_b32 s64, 0, s64
    v_mfma_f32_16x16x32_bf16 v[52:55], a[12:15], a[84:87], v[52:55]
    buffer_load_dwordx4 v19, s[44:47], s52 offen offset:1024 sc1 lds
    v_mfma_f32_16x16x32_bf16 v[52:55], a[8:11], a[80:83], v[52:55]
    s_add_u32 s52, s52, s56
    ds_read_b64_tr_b16 a[68:69], v8 offset:16384
    v_mfma_f32_16x16x32_bf16 v[112:115], a[16:19], a[80:83], v[112:115]
    v_mfma_f32_16x16x32_bf16 v[112:115], a[20:23], a[84:87], v[112:115]
    v_mfma_f32_16x16x32_bf16 v[120:123], a[20:23], a[92:95], v[120:123]
    buffer_load_dwordx4 v18, s[44:47], s53 offen offset:2048 sc1 lds
    v_mfma_f32_16x16x32_bf16 v[120:123], a[16:19], a[88:91], v[120:123]
    ds_read_b64_tr_b16 a[70:71], v8 offset:18432
    v_mfma_f32_16x16x32_bf16 v[124:127], a[24:27], a[88:91], v[124:127]
    v_mfma_f32_16x16x32_bf16 v[124:127], a[28:31], a[92:95], v[124:127]
    v_mfma_f32_16x16x32_bf16 v[116:119], a[28:31], a[84:87], v[116:119]
    buffer_load_dwordx4 v19, s[44:47], s53 offen offset:3072 sc1 lds
    v_mfma_f32_16x16x32_bf16 v[116:119], a[24:27], a[80:83], v[116:119]
    s_add_u32 s53, s53, s56
    ds_read_b64_tr_b16 a[72:73], v9 offset:0
    v_mfma_f32_16x16x32_bf16 v[176:179], a[32:35], a[80:83], v[176:179]
    v_mfma_f32_16x16x32_bf16 v[176:179], a[36:39], a[84:87], v[176:179]
    s_add_u32 m0, s62, 4096
    v_mfma_f32_16x16x32_bf16 v[184:187], a[36:39], a[92:95], v[184:187]
    buffer_load_dwordx4 v20, s[44:47], s54 offen offset:0 sc1 lds
    v_mfma_f32_16x16x32_bf16 v[184:187], a[32:35], a[88:91], v[184:187]
    s_xor_b32 s62, s62, 229376
    ds_read_b64_tr_b16 a[74:75], v9 offset:2048
    v_mfma_f32_16x16x32_bf16 v[188:191], a[40:43], a[88:91], v[188:191]
    v_mfma_f32_16x16x32_bf16 v[188:191], a[44:47], a[92:95], v[188:191]
    v_mfma_f32_16x16x32_bf16 v[180:183], a[44:47], a[84:87], v[180:183]
    buffer_load_dwordx4 v21, s[44:47], s54 offen offset:1024 sc1 lds
    v_mfma_f32_16x16x32_bf16 v[180:183], a[40:43], a[80:83], v[180:183]
    s_add_u32 s54, s54, s56
    ds_read_b64_tr_b16 a[76:77], v9 offset:16384
    v_mfma_f32_16x16x32_bf16 v[240:243], a[48:51], a[80:83], v[240:243]
    v_mfma_f32_16x16x32_bf16 v[240:243], a[52:55], a[84:87], v[240:243]
    v_mfma_f32_16x16x32_bf16 v[248:251], a[52:55], a[92:95], v[248:251]
    buffer_load_dwordx4 v20, s[44:47], s55 offen offset:2048 sc1 lds
    v_mfma_f32_16x16x32_bf16 v[248:251], a[48:51], a[88:91], v[248:251]
    ds_read_b64_tr_b16 a[78:79], v9 offset:18432
    v_mfma_f32_16x16x32_bf16 v[252:255], a[56:59], a[88:91], v[252:255]
    v_add_u32 v6, s63, v6
    v_add_u32 v7, s63, v7
    v_mfma_f32_16x16x32_bf16 v[252:255], a[60:63], a[92:95], v[252:255]
    v_mfma_f32_16x16x32_bf16 v[244:247], a[60:63], a[84:87], v[244:247]
    buffer_load_dwordx4 v21, s[44:47], s55 offen offset:3072 sc1 lds
    v_mfma_f32_16x16x32_bf16 v[244:247], a[56:59], a[80:83], v[244:247]
    s_add_u32 s55, s55, s56
    v_mfma_f32_16x16x32_bf16 v[64:67], a[0:3], a[96:99], v[64:67]
    ds_read_b64_tr_b16 a[80:81], v10 offset:0
    v_mfma_f32_16x16x32_bf16 v[64:67], a[4:7], a[100:103], v[64:67]
    v_mfma_f32_16x16x32_bf16 v[72:75], a[4:7], a[108:111], v[72:75]
    v_mfma_f32_16x16x32_bf16 v[72:75], a[0:3], a[104:107], v[72:75]
    s_add_u32 m0, s61, 0
    ds_read_b64_tr_b16 a[82:83], v10 offset:2048
    v_mfma_f32_16x16x32_bf16 v[76:79], a[8:11], a[104:107], v[76:79]
    buffer_load_dwordx4 v16, s[40:43], s48 offen offset:0 sc1 lds
    v_mfma_f32_16x16x32_bf16 v[76:79], a[12:15], a[108:111], v[76:79]
    v_mfma_f32_16x16x32_bf16 v[68:71], a[12:15], a[100:103], v[68:71]
    ds_read_b64_tr_b16 a[84:85], v10 offset:16384
    v_mfma_f32_16x16x32_bf16 v[68:71], a[8:11], a[96:99], v[68:71]
    v_mfma_f32_16x16x32_bf16 v[128:131], a[16:19], a[96:99], v[128:131]
    v_mfma_f32_16x16x32_bf16 v[128:131], a[20:23], a[100:103], v[128:131]
    ds_read_b64_tr_b16 a[86:87], v10 offset:18432
    v_mfma_f32_16x16x32_bf16 v[136:139], a[20:23], a[108:111], v[136:139]
    v_mfma_f32_16x16x32_bf16 v[136:139], a[16:19], a[104:107], v[136:139]
    v_mfma_f32_16x16x32_bf16 v[140:143], a[24:27], a[104:107], v[140:143]
    buffer_load_dwordx4 v17, s[40:43], s48 offen offset:1024 sc1 lds
    v_mfma_f32_16x16x32_bf16 v[140:143], a[28:31], a[108:111], v[140:143]
    s_add_u32 s48, s48, 128
    ds_read_b64_tr_b16 a[88:89], v11 offset:0
    v_mfma_f32_16x16x32_bf16 v[132:135], a[28:31], a[100:103], v[132:135]
    v_mfma_f32_16x16x32_bf16 v[132:135], a[24:27], a[96:99], v[132:135]
    v_mfma_f32_16x16x32_bf16 v[192:195], a[32:35], a[96:99], v[192:195]
    v_mfma_f32_16x16x32_bf16 v[192:195], a[36:39], a[100:103], v[192:195]
    ds_read_b64_tr_b16 a[90:91], v11 offset:2048
    v_mfma_f32_16x16x32_bf16 v[200:203], a[36:39], a[108:111], v[200:203]
    v_mfma_f32_16x16x32_bf16 v[200:203], a[32:35], a[104:107], v[200:203]
    v_mfma_f32_16x16x32_bf16 v[204:207], a[40:43], a[104:107], v[204:207]
    buffer_load_dwordx4 v16, s[40:43], s49 offen offset:2048 sc1 lds
    v_mfma_f32_16x16x32_bf16 v[204:207], a[44:47], a[108:111], v[204:207]
    ds_read_b64_tr_b16 a[92:93], v11 offset:16384
    v_mfma_f32_16x16x32_bf16 v[196:199], a[44:47], a[100:103], v[196:199]
    v_mfma_f32_16x16x32_bf16 v[196:199], a[40:43], a[96:99], v[196:199]
    v_mfma_f32_16x16x32_bf16 a[224:227], a[48:51], a[96:99], a[224:227]
    v_mfma_f32_16x16x32_bf16 a[224:227], a[52:55], a[100:103], a[224:227]
    ds_read_b64_tr_b16 a[94:95], v11 offset:18432
    v_mfma_f32_16x16x32_bf16 a[232:235], a[52:55], a[108:111], a[232:235]
    v_mfma_f32_16x16x32_bf16 a[232:235], a[48:51], a[104:107], a[232:235]
    v_mfma_f32_16x16x32_bf16 a[236:239], a[56:59], a[104:107], a[236:239]
    buffer_load_dwordx4 v17, s[40:43], s49 offen offset:3072 sc1 lds
    v_mfma_f32_16x16x32_bf16 a[236:239], a[60:63], a[108:111], a[236:239]
    s_add_u32 s49, s49, 128
    v_mfma_f32_16x16x32_bf16 a[228:231], a[60:63], a[100:103], a[228:231]
    v_mfma_f32_16x16x32_bf16 a[228:231], a[56:59], a[96:99], a[228:231]
    v_mfma_f32_16x16x32_bf16 v[80:83], a[0:3], a[112:115], v[80:83]
    v_mfma_f32_16x16x32_bf16 v[80:83], a[4:7], a[116:119], v[80:83]
    ds_read_b64_tr_b16 a[96:97], v12 offset:0
    v_mfma_f32_16x16x32_bf16 v[88:91], a[4:7], a[124:127], v[88:91]
    v_mfma_f32_16x16x32_bf16 v[88:91], a[0:3], a[120:123], v[88:91]
    s_add_u32 m0, s61, 4096
    ds_read_b128 a[0:3], v6 offset:0
    v_mfma_f32_16x16x32_bf16 v[92:95], a[8:11], a[120:123], v[92:95]
    buffer_load_dwordx4 v16, s[40:43], s50 offen offset:0 sc1 lds
    v_mfma_f32_16x16x32_bf16 v[92:95], a[12:15], a[124:127], v[92:95]
    s_add_u32 s61, s61, 32768
    ds_read_b128 a[4:7], v7 offset:0
    v_mfma_f32_16x16x32_bf16 v[84:87], a[12:15], a[116:119], v[84:87]
    s_cmp_ge_u32 s61, 98304
    s_cselect_b32 s90, 98304, 0
    ds_read_b64_tr_b16 a[98:99], v12 offset:2048
    v_mfma_f32_16x16x32_bf16 v[84:87], a[8:11], a[112:115], v[84:87]
    s_sub_u32 s61, s61, s90
    ds_read_b128 a[8:11], v6 offset:2048
    v_mfma_f32_16x16x32_bf16 v[144:147], a[16:19], a[112:115], v[144:147]
    ds_read_b128 a[12:15], v7 offset:2048
    v_mfma_f32_16x16x32_bf16 v[144:147], a[20:23], a[116:119], v[144:147]
    ds_read_b64_tr_b16 a[100:101], v12 offset:16384
    v_mfma_f32_16x16x32_bf16 v[152:155], a[20:23], a[124:127], v[152:155]
    v_mfma_f32_16x16x32_bf16 v[152:155], a[16:19], a[120:123], v[152:155]
    ds_read_b128 a[16:19], v6 offset:4096
    v_mfma_f32_16x16x32_bf16 v[156:159], a[24:27], a[120:123], v[156:159]
    buffer_load_dwordx4 v17, s[40:43], s50 offen offset:1024 sc1 lds
    v_mfma_f32_16x16x32_bf16 v[156:159], a[28:31], a[124:127], v[156:159]
    s_add_u32 s50, s50, 128
    ds_read_b128 a[20:23], v7 offset:4096
    v_mfma_f32_16x16x32_bf16 v[148:151], a[28:31], a[116:119], v[148:151]
    ds_read_b64_tr_b16 a[102:103], v12 offset:18432
    v_mfma_f32_16x16x32_bf16 v[148:151], a[24:27], a[112:115], v[148:151]
    ds_read_b128 a[24:27], v6 offset:6144
    v_mfma_f32_16x16x32_bf16 v[208:211], a[32:35], a[112:115], v[208:211]
    s_sub_u32 s65, s65, 1
    ds_read_b128 a[28:31], v7 offset:6144
    v_mfma_f32_16x16x32_bf16 v[208:211], a[36:39], a[116:119], v[208:211]
    ds_read_b64_tr_b16 a[104:105], v13 offset:0
    v_mfma_f32_16x16x32_bf16 v[216:219], a[36:39], a[124:127], v[216:219]
    v_mfma_f32_16x16x32_bf16 v[216:219], a[32:35], a[120:123], v[216:219]
    ds_read_b128 a[32:35], v6 offset:8192
    v_mfma_f32_16x16x32_bf16 v[220:223], a[40:43], a[120:123], v[220:223]
    buffer_load_dwordx4 v16, s[40:43], s51 offen offset:2048 sc1 lds
    v_mfma_f32_16x16x32_bf16 v[220:223], a[44:47], a[124:127], v[220:223]
    ds_read_b128 a[36:39], v7 offset:8192
    v_mfma_f32_16x16x32_bf16 v[212:215], a[44:47], a[116:119], v[212:215]
    ds_read_b64_tr_b16 a[106:107], v13 offset:2048
    v_mfma_f32_16x16x32_bf16 v[212:215], a[40:43], a[112:115], v[212:215]
    ds_read_b128 a[40:43], v6 offset:10240
    v_mfma_f32_16x16x32_bf16 a[240:243], a[48:51], a[112:115], a[240:243]
    ds_read_b128 a[44:47], v7 offset:10240
    v_mfma_f32_16x16x32_bf16 a[240:243], a[52:55], a[116:119], a[240:243]
    ds_read_b64_tr_b16 a[108:109], v13 offset:16384
    v_mfma_f32_16x16x32_bf16 a[248:251], a[52:55], a[124:127], a[248:251]
    v_mfma_f32_16x16x32_bf16 a[248:251], a[48:51], a[120:123], a[248:251]
    ds_read_b128 a[48:51], v6 offset:12288
    v_mfma_f32_16x16x32_bf16 a[252:255], a[56:59], a[120:123], a[252:255]
    buffer_load_dwordx4 v17, s[40:43], s51 offen offset:3072 sc1 lds
    v_mfma_f32_16x16x32_bf16 a[252:255], a[60:63], a[124:127], a[252:255]
    s_add_u32 s51, s51, 128
    ds_read_b128 a[52:55], v7 offset:12288
    v_mfma_f32_16x16x32_bf16 a[244:247], a[60:63], a[116:119], a[244:247]
    s_cmp_gt_u32 s65, s67
    ds_read_b64_tr_b16 a[110:111], v13 offset:18432
    v_mfma_f32_16x16x32_bf16 a[244:247], a[56:59], a[112:115], a[244:247]
    ds_read_b128 a[56:59], v6 offset:14336
    ds_read_b128 a[60:63], v7 offset:14336
    s_cbranch_scc1 m_loop25
    s_cmp_eq_u32 s65, 0
    s_cbranch_scc1 m_epi15
m_dosw26:
    s_cmp_eq_u32 s94, 0
    s_cbranch_scc1 m_x61
    s_cmp_lg_u32 s65, 3
    s_cbranch_scc1 m_x67
    s_mov_b32 s42, s73
    s_lshl_b32 s90, s77, 4
    s_lshl_b32 s90, s90, s81
    s_mov_b32 s48, s79
    s_mul_i32 s91, s90, 1
    s_add_u32 s49, s91, s79
    s_sub_u32 s49, s49, 2048
    s_mul_i32 s91, s90, 2
    s_add_u32 s50, s91, s79
    s_mul_i32 s91, s90, 3
    s_add_u32 s51, s91, s79
    s_sub_u32 s51, s51, 2048
    s_lshl_b32 s90, s58, 7
    s_add_u32 s90, s90, s57
    s_lshl_b32 s91, s16, 6
    s_cmp_eq_u32 s81, 1
    s_cselect_b32 s90, s90, s91
    v_lshrrev_b32 v24, 3, v1
    v_lshlrev_b32 v24, s81, v24
    v_add_u32 v24, s90, v24
    v_mul_lo_u32 v24, v24, s77
    v_lshrrev_b32 v25, 4, v1
    v_and_b32 v26, 7, v1
    v_xor_b32 v25, v25, v26
    v_lshl_add_u32 v16, v25, 4, v24
    v_xor_b32 v25, 4, v25
    v_lshl_add_u32 v17, v25, 4, v24
    s_lshl_b32 s90, s77, 3
    s_lshl_b32 s90, s90, s81
    s_sub_u32 s90, s90, 1024
    v_add_u32 v17, s90, v17
    s_mov_b32 s40, s71
    s_mov_b32 s41, s72
    buffer_load_dwordx2 v[4:5], off, s[12:15], 0 sc1
    s_branch m_loop25
m_x67:
    s_mov_b32 s46, s76
    s_mov_b32 s52, s80
    s_lshl_b32 s90, s78, 2
    s_mul_i32 s91, s90, 1
    s_add_u32 s53, s91, s80
    s_sub_u32 s53, s53, 2048
    s_mul_i32 s91, s90, 2
    s_add_u32 s54, s91, s80
    s_mul_i32 s91, s90, 3
    s_add_u32 s55, s91, s80
    s_sub_u32 s55, s55, 2048
    s_lshl_b32 s56, s78, 6
    v_lshrrev_b32 v24, 5, v1
    s_lshl_b32 s90, s16, 4
    v_add_u32 v25, s90, v24
    v_mul_lo_u32 v25, v25, s78
    v_lshlrev_b32 v24, 1, v24
    v_and_b32 v26, 31, v1
    v_xor_b32 v24, v24, v26
    s_lshl_b32 s90, s78, 1
    s_sub_u32 s90, s90, 1024
    v_add_u32 v27, s90, v25
    v_xor_b32 v26, 0, v24
    v_lshl_add_u32 v18, v26, 4, v25
    v_xor_b32 v26, 4, v24
    v_lshl_add_u32 v19, v26, 4, v27
    v_xor_b32 v26, 8, v24
    v_lshl_add_u32 v20, v26, 4, v25
    v_xor_b32 v26, 12, v24
    v_lshl_add_u32 v21, v26, 4, v27
    s_mov_b32 s44, s74
    s_mov_b32 s45, s75
    s_mov_b32 s67, 0
    s_branch m_loop25
m_x61:
    s_cmp_le_u32 s65, 4
    s_cbranch_scc1 m_x62
    s_cmp_lg_u32 s16, 0
    s_cbranch_scc1 m_np68
    v_mov_b32 v4, s4
    v_mov_b32 v5, s5
    s_add_u32 s90, s17, 117440512
    s_mov_b64 exec, 1
    buffer_store_dwordx2 v[4:5], off, s[8:11], s90 sc1
    s_mov_b64 exec, -1
m_np68:
    s_mov_b32 s17, -1
    s_mov_b32 s67, 4
    s_branch m_loop25
m_x62:
    s_cmp_lg_u32 s65, 4
    s_cbranch_scc1 m_x63
    s_cmp_eq_u32 s70, 1
    s_cbranch_scc1 m_ea69
    buffer_load_dwordx2 v[4:5], v0, s[8:11], s37 offen sc1
m_eb70:
    s_branch m_loop25
m_x63:
    s_waitcnt vmcnt(16)
    s_cmp_lg_u32 s65, 3
    s_cbranch_scc1 m_x64
    s_cmp_eq_u32 s70, 1
    s_cbranch_scc1 m_ea71
    s_mov_b32 s3, 1048576
m_spin73:
    v_cmp_ne_u64 s[22:23], s[4:5], v[4:5]
    s_nop 3
    s_cmp_eq_u64 s[22:23], 0
    s_cbranch_scc1 m_ok74
    s_sub_u32 s3, s3, 1
    s_cbranch_scc1 m_ok74
    s_sleep 16
    buffer_load_dwordx2 v[4:5], v0, s[8:11], s37 offen sc1
    s_waitcnt vmcnt(0)
    s_branch m_spin73
m_ok74:
    buffer_load_dwordx4 a[128:131], v2, s[8:11], s33 offen offset:0 sc1
    buffer_load_dwordx4 a[132:135], v2, s[8:11], s33 offen offset:1024 sc1
    buffer_load_dwordx4 a[136:139], v2, s[8:11], s33 offen offset:2048 sc1
    buffer_load_dwordx4 a[140:143], v2, s[8:11], s33 offen offset:3072 sc1
    buffer_load_dwordx4 a[144:147], v2, s[8:11], s34 offen offset:0 sc1
    buffer_load_dwordx4 a[148:151], v2, s[8:11], s34 offen offset:1024 sc1
m_eb72:
    s_add_u32 s48, s32, 0
    s_mov_b32 s49, s48
    s_add_u32 s50, s48, 4096
    s_mov_b32 s51, s50
    s_cmp_eq_u32 s57, 0
    s_cselect_b32 s42, 268435456, 0
    s_mov_b32 s40, s6
    s_mov_b32 s41, s7
    v_mov_b32 v16, v2
    v_mov_b32 v17, v2
    s_branch m_loop25
m_x64:
    s_cmp_lg_u32 s65, 2
    s_cbranch_scc1 m_x65
    s_cmp_eq_u32 s70, 1
    s_cbranch_scc1 m_ea75
    buffer_load_dwordx4 a[152:155], v2, s[8:11], s34 offen offset:2048 sc1
    buffer_load_dwordx4 a[156:159], v2, s[8:11], s34 offen offset:3072 sc1
    buffer_load_dwordx4 a[160:163], v2, s[8:11], s35 offen offset:0 sc1
    buffer_load_dwordx4 a[164:167], v2, s[8:11], s35 offen offset:1024 sc1
    buffer_load_dwordx4 a[168:171], v2, s[8:11], s35 offen offset:2048 sc1
m_eb76:
    s_add_u32 s48, s32, 16384
    s_mov_b32 s49, s48
    s_add_u32 s50, s48, 4096
    s_mov_b32 s51, s50
    s_mov_b32 s42, 268435456
    s_add_u32 s52, s32, 49152
    s_mov_b32 s53, s52
    s_add_u32 s54, s52, 4096
    s_mov_b32 s55, s54
    s_mov_b32 s46, 268435456
    s_mov_b32 s44, s6
    s_mov_b32 s45, s7
    v_mov_b32 v18, v2
    v_mov_b32 v19, v2
    v_mov_b32 v20, v2
    v_mov_b32 v21, v2
    s_branch m_loop25
m_x65:
    s_cmp_eq_u32 s70, 1
    s_cbranch_scc1 m_ea77
    buffer_load_dwordx4 a[172:175], v2, s[8:11], s35 offen offset:3072 sc1
    buffer_load_dwordx4 a[176:179], v2, s[8:11], s36 offen offset:0 sc1
    buffer_load_dwordx4 a[180:183], v2, s[8:11], s36 offen offset:1024 sc1
    buffer_load_dwordx4 a[184:187], v2, s[8:11], s36 offen offset:2048 sc1
    buffer_load_dwordx4 a[188:191], v2, s[8:11], s36 offen offset:3072 sc1
m_eb78:
    s_add_u32 s48, s32, 32768
    s_mov_b32 s49, s48
    s_add_u32 s50, s48, 4096
    s_mov_b32 s51, s50
    s_add_u32 s52, s32, 65536
    s_mov_b32 s53, s52
    s_add_u32 s54, s52, 4096
    s_mov_b32 s55, s54
    s_branch m_loop25
m_ea69:
    s_and_b32 s92, s2, 7
    s_lshl_b32 s92, s92, 2
    s_bfe_u32 s93, s2, 0x20003
    s_add_u32 s92, s92, s93
    s_lshr_b32 s93, s2, 5
    s_lshl_b32 s93, s93, 2
    s_or_b32 s93, s93, 0x40000
    v_and_b32 v0, 3, v1
    v_min_u32 v0, 2, v0
    v_and_b32 v24, 4, v1
    v_add3_u32 v0, v0, v24, 8
    v_lshlrev_b32 v0, 3, v0
    buffer_load_dwordx2 v[4:5], v0, s[8:11], s37 offen sc1
    s_branch m_eb70
m_ea71:
    s_mov_b32 s3, 1048576
m_spin79:
    v_cmp_ne_u64 s[22:23], s[4:5], v[4:5]
    s_nop 3
    s_cmp_eq_u64 s[22:23], 0
    s_cbranch_scc1 m_ok80
    s_sub_u32 s3, s3, 1
    s_cbranch_scc1 m_ok80
    s_sleep 16
    buffer_load_dwordx2 v[4:5], v0, s[8:11], s37 offen sc1
    s_waitcnt vmcnt(0)
    s_branch m_spin79
m_ok80:
    s_branch m_eb72
m_ea75:
    s_and_b32 s92, s2, 7
    s_lshl_b32 s92, s92, 2
    s_bfe_u32 s93, s2, 0x20003
    s_add_u32 s92, s92, s93
    s_lshr_b32 s93, s2, 5
    s_lshl_b32 s93, s93, 2
    s_or_b32 s93, s93, 0x40000
    s_bfe_u32 s91, 873484918, s93
    s_lshr_b32 s91, s91, 1
    v_mov_b32 v0, s91
    s_bfe_u32 s91, 4225674377, s93
    s_lshr_b32 s91, s91, 1
    v_writelane_b32 v0, s91, 8
    v_lshlrev_b32 v0, 3, v0
    buffer_load_dwordx2 v[4:5], v0, s[8:11], s37 offen sc1
    s_branch m_eb76
m_ea77:
    s_mov_b32 s3, 1048576
m_spin81:
    v_cmp_ne_u64 s[22:23], s[4:5], v[4:5]
    s_nop 3
    s_cmp_eq_u64 s[22:23], 0
    s_cbranch_scc1 m_ok82
    s_sub_u32 s3, s3, 1
    s_cbranch_scc1 m_ok82
    s_sleep 16
    buffer_load_dwordx2 v[4:5], v0, s[8:11], s37 offen sc1
    s_waitcnt vmcnt(0)
    s_branch m_spin81
m_ok82:
    buffer_load_dwordx4 a[128:131], v2, s[8:11], s33 offen offset:0 sc1
    buffer_load_dwordx4 a[132:135], v2, s[8:11], s33 offen offset:1024 sc1
    buffer_load_dwordx4 a[136:139], v2, s[8:11], s33 offen offset:2048 sc1
    buffer_load_dwordx4 a[140:143], v2, s[8:11], s33 offen offset:3072 sc1
    buffer_load_dwordx4 a[144:147], v2, s[8:11], s34 offen offset:0 sc1
    buffer_load_dwordx4 a[148:151], v2, s[8:11], s34 offen offset:1024 sc1
    buffer_load_dwordx4 a[152:155], v2, s[8:11], s34 offen offset:2048 sc1
    buffer_load_dwordx4 a[156:159], v2, s[8:11], s34 offen offset:3072 sc1
    buffer_load_dwordx4 a[160:163], v2, s[8:11], s35 offen offset:0 sc1
    buffer_load_dwordx4 a[164:167], v2, s[8:11], s35 offen offset:1024 sc1
    buffer_load_dwordx4 a[168:171], v2, s[8:11], s35 offen offset:2048 sc1
    buffer_load_dwordx4 a[172:175], v2, s[8:11], s35 offen offset:3072 sc1
    buffer_load_dwordx4 a[176:179], v2, s[8:11], s36 offen offset:0 sc1
    buffer_load_dwordx4 a[180:183], v2, s[8:11], s36 offen offset:1024 sc1
    buffer_load_dwordx4 a[184:187], v2, s[8:11], s36 offen offset:2048 sc1
    buffer_load_dwordx4 a[188:191], v2, s[8:11], s36 offen offset:3072 sc1
    s_branch m_eb78
m_epi15:
    s_cmp_eq_u32 s94, 0
    s_cbranch_scc1 m_last29
    s_mov_b32 s3, 1048576
m_spin33:
    v_readfirstlane_b32 s4, v4
    v_readfirstlane_b32 s5, v5
    s_nop 3
    s_cmp_lg_u32 s4, 0
    s_cbranch_scc1 m_ok34
    s_sub_u32 s3, s3, 1
    s_cbranch_scc1 m_ok34
    s_sleep 32
    buffer_load_dwordx2 v[4:5], off, s[12:15], 0 sc1
    s_waitcnt vmcnt(0)
    s_branch m_spin33
m_ok34:
    s_cmp_ge_u32 s68, 16
    s_cbranch_scc1 m_q036
m_epf27:
    s_nop 7
    s_mov_b32 s91, s98
    s_mov_b32 s92, s97
    s_mov_b32 s93, s97
    s_mov_b32 s90, s91
    v_pk_mul_f32 v[32:33], v[32:33], s[92:93]
    v_pk_mul_f32 v[34:35], v[34:35], s[92:93]
    v_pk_mul_f32 v[36:37], v[36:37], s[92:93]
    v_pk_mul_f32 v[38:39], v[38:39], s[92:93]
    v_cvt_pk_bf16_f32 v32, v32, v33
    v_cvt_pk_bf16_f32 v33, v34, v35
    v_cvt_pk_bf16_f32 v34, v36, v37
    v_cvt_pk_bf16_f32 v35, v38, v39
    buffer_store_dwordx4 v[32:35], v2, s[8:11], s90 offen sc1
    s_add_u32 s90, s90, s100
    v_pk_mul_f32 v[40:41], v[40:41], s[92:93]
    v_pk_mul_f32 v[42:43], v[42:43], s[92:93]
    v_pk_mul_f32 v[44:45], v[44:45], s[92:93]
    v_pk_mul_f32 v[46:47], v[46:47], s[92:93]
    v_cvt_pk_bf16_f32 v40, v40, v41
    v_cvt_pk_bf16_f32 v41, v42, v43
    v_cvt_pk_bf16_f32 v42, v44, v45
    v_cvt_pk_bf16_f32 v43, v46, v47
    buffer_store_dwordx4 v[40:43], v2, s[8:11], s90 offen sc1
    s_add_u32 s90, s90, s100
    v_pk_mul_f32 v[48:49], v[48:49], s[92:93]
    v_pk_mul_f32 v[50:51], v[50:51], s[92:93]
    v_pk_mul_f32 v[52:53], v[52:53], s[92:93]
    v_pk_mul_f32 v[54:55], v[54:55], s[92:93]
    v_cvt_pk_bf16_f32 v48, v48, v49
    v_cvt_pk_bf16_f32 v49, v50, v51
    v_cvt_pk_bf16_f32 v50, v52, v53
    v_cvt_pk_bf16_f32 v51, v54, v55
    buffer_store_dwordx4 v[48:51], v2, s[8:11], s90 offen sc1
    s_add_u32 s90, s90, s100
    v_pk_mul_f32 v[56:57], v[56:57], s[92:93]
    v_pk_mul_f32 v[58:59], v[58:59], s[92:93]
    v_pk_mul_f32 v[60:61], v[60:61], s[92:93]
    v_pk_mul_f32 v[62:63], v[62:63], s[92:93]
    v_cvt_pk_bf16_f32 v56, v56, v57
    v_cvt_pk_bf16_f32 v57, v58, v59
    v_cvt_pk_bf16_f32 v58, v60, v61
    v_cvt_pk_bf16_f32 v59, v62, v63
    buffer_store_dwordx4 v[56:59], v2, s[8:11], s90 offen sc1
    s_add_u32 s90, s90, s100
    v_pk_mul_f32 v[64:65], v[64:65], s[92:93]
    v_pk_mul_f32 v[66:67], v[66:67], s[92:93]
    v_pk_mul_f32 v[68:69], v[68:69], s[92:93]
    v_pk_mul_f32 v[70:71], v[70:71], s[92:93]
    v_cvt_pk_bf16_f32 v64, v64, v65
    v_cvt_pk_bf16_f32 v65, v66, v67
    v_cvt_pk_bf16_f32 v66, v68, v69
    v_cvt_pk_bf16_f32 v67, v70, v71
    buffer_store_dwordx4 v[64:67], v2, s[8:11], s90 offen sc1
    s_add_u32 s90, s90, s100
    v_pk_mul_f32 v[72:73], v[72:73], s[92:93]
    v_pk_mul_f32 v[74:75], v[74:75], s[92:93]
    v_pk_mul_f32 v[76:77], v[76:77], s[92:93]
    v_pk_mul_f32 v[78:79], v[78:79], s[92:93]
    v_cvt_pk_bf16_f32 v72, v72, v73
    v_cvt_pk_bf16_f32 v73, v74, v75
    v_cvt_pk_bf16_f32 v74, v76, v77
    v_cvt_pk_bf16_f32 v75, v78, v79
    buffer_store_dwordx4 v[72:75], v2, s[8:11], s90 offen sc1
    s_add_u32 s90, s90, s100
    v_pk_mul_f32 v[80:81], v[80:81], s[92:93]
    v_pk_mul_f32 v[82:83], v[82:83], s[92:93]
    v_pk_mul_f32 v[84:85], v[84:85], s[92:93]
    v_pk_mul_f32 v[86:87], v[86:87], s[92:93]
    v_cvt_pk_bf16_f32 v80, v80, v81
    v_cvt_pk_bf16_f32 v81, v82, v83
    v_cvt_pk_bf16_f32 v82, v84, v85
    v_cvt_pk_bf16_f32 v83, v86, v87
    buffer_store_dwordx4 v[80:83], v2, s[8:11], s90 offen sc1
    s_add_u32 s90, s90, s100
    v_pk_mul_f32 v[88:89], v[88:89], s[92:93]
    v_pk_mul_f32 v[90:91], v[90:91], s[92:93]
    v_pk_mul_f32 v[92:93], v[92:93], s[92:93]
    v_pk_mul_f32 v[94:95], v[94:95], s[92:93]
    v_cvt_pk_bf16_f32 v88, v88, v89
    v_cvt_pk_bf16_f32 v89, v90, v91
    v_cvt_pk_bf16_f32 v90, v92, v93
    v_cvt_pk_bf16_f32 v91, v94, v95
    buffer_store_dwordx4 v[88:91], v2, s[8:11], s90 offen sc1
    s_add_u32 s90, s90, s100
    s_add_u32 s91, s91, s99
    s_mov_b32 s90, s91
    v_pk_mul_f32 v[96:97], v[96:97], s[92:93]
    v_pk_mul_f32 v[98:99], v[98:99], s[92:93]
    v_pk_mul_f32 v[100:101], v[100:101], s[92:93]
    v_pk_mul_f32 v[102:103], v[102:103], s[92:93]
    v_cvt_pk_bf16_f32 v96, v96, v97
    v_cvt_pk_bf16_f32 v97, v98, v99
    v_cvt_pk_bf16_f32 v98, v100, v101
    v_cvt_pk_bf16_f32 v99, v102, v103
    buffer_store_dwordx4 v[96:99], v2, s[8:11], s90 offen sc1
    s_add_u32 s90, s90, s100
    v_pk_mul_f32 v[104:105], v[104:105], s[92:93]
    v_pk_mul_f32 v[106:107], v[106:107], s[92:93]
    v_pk_mul_f32 v[108:109], v[108:109], s[92:93]
    v_pk_mul_f32 v[110:111], v[110:111], s[92:93]
    v_cvt_pk_bf16_f32 v104, v104, v105
    v_cvt_pk_bf16_f32 v105, v106, v107
    v_cvt_pk_bf16_f32 v106, v108, v109
    v_cvt_pk_bf16_f32 v107, v110, v111
    buffer_store_dwordx4 v[104:107], v2, s[8:11], s90 offen sc1
    s_add_u32 s90, s90, s100
    v_pk_mul_f32 v[112:113], v[112:113], s[92:93]
    v_pk_mul_f32 v[114:115], v[114:115], s[92:93]
    v_pk_mul_f32 v[116:117], v[116:117], s[92:93]
    v_pk_mul_f32 v[118:119], v[118:119], s[92:93]
    v_cvt_pk_bf16_f32 v112, v112, v113
    v_cvt_pk_bf16_f32 v113, v114, v115
    v_cvt_pk_bf16_f32 v114, v116, v117
    v_cvt_pk_bf16_f32 v115, v118, v119
    buffer_store_dwordx4 v[112:115], v2, s[8:11], s90 offen sc1
    s_add_u32 s90, s90, s100
    v_pk_mul_f32 v[120:121], v[120:121], s[92:93]
    v_pk_mul_f32 v[122:123], v[122:123], s[92:93]
    v_pk_mul_f32 v[124:125], v[124:125], s[92:93]
    v_pk_mul_f32 v[126:127], v[126:127], s[92:93]
    v_cvt_pk_bf16_f32 v120, v120, v121
    v_cvt_pk_bf16_f32 v121, v122, v123
    v_cvt_pk_bf16_f32 v122, v124, v125
    v_cvt_pk_bf16_f32 v123, v126, v127
    buffer_store_dwordx4 v[120:123], v2, s[8:11], s90 offen sc1
    s_add_u32 s90, s90, s100
    v_pk_mul_f32 v[128:129], v[128:129], s[92:93]
    v_pk_mul_f32 v[130:131], v[130:131], s[92:93]
    v_pk_mul_f32 v[132:133], v[132:133], s[92:93]
    v_pk_mul_f32 v[134:135], v[134:135], s[92:93]
    v_cvt_pk_bf16_f32 v128, v128, v129
    v_cvt_pk_bf16_f32 v129, v130, v131
    v_cvt_pk_bf16_f32 v130, v132, v133
    v_cvt_pk_bf16_f32 v131, v134, v135
    buffer_store_dwordx4 v[128:131], v2, s[8:11], s90 offen sc1
    s_add_u32 s90, s90, s100
    v_pk_mul_f32 v[136:137], v[136:137], s[92:93]
    v_pk_mul_f32 v[138:139], v[138:139], s[92:93]
    v_pk_mul_f32 v[140:141], v[140:141], s[92:93]
    v_pk_mul_f32 v[142:143], v[142:143], s[92:93]
    v_cvt_pk_bf16_f32 v136, v136, v137
    v_cvt_pk_bf16_f32 v137, v138, v139
    v_cvt_pk_bf16_f32 v138, v140, v141
    v_cvt_pk_bf16_f32 v139, v142, v143
    buffer_store_dwordx4 v[136:139], v2, s[8:11], s90 offen sc1
    s_add_u32 s90, s90, s100
    v_pk_mul_f32 v[144:145], v[144:145], s[92:93]
    v_pk_mul_f32 v[146:147], v[146:147], s[92:93]
    v_pk_mul_f32 v[148:149], v[148:149], s[92:93]
    v_pk_mul_f32 v[150:151], v[150:151], s[92:93]
    v_cvt_pk_bf16_f32 v144, v144, v145
    v_cvt_pk_bf16_f32 v145, v146, v147
    v_cvt_pk_bf16_f32 v146, v148, v149
    v_cvt_pk_bf16_f32 v147, v150, v151
    buffer_store_dwordx4 v[144:147], v2, s[8:11], s90 offen sc1
    s_add_u32 s90, s90, s100
    v_pk_mul_f32 v[152:153], v[152:153], s[92:93]
    v_pk_mul_f32 v[154:155], v[154:155], s[92:93]
    v_pk_mul_f32 v[156:157], v[156:157], s[92:93]
    v_pk_mul_f32 v[158:159], v[158:159], s[92:93]
    v_cvt_pk_bf16_f32 v152, v152, v153
    v_cvt_pk_bf16_f32 v153, v154, v155
    v_cvt_pk_bf16_f32 v154, v156, v157
    v_cvt_pk_bf16_f32 v155, v158, v159
    buffer_store_dwordx4 v[152:155], v2, s[8:11], s90 offen sc1
    s_add_u32 s90, s90, s100
    s_add_u32 s91, s91, s99
    s_mov_b32 s90, s91
    v_pk_mul_f32 v[160:161], v[160:161], s[92:93]
    v_pk_mul_f32 v[162:163], v[162:163], s[92:93]
    v_pk_mul_f32 v[164:165], v[164:165], s[92:93]
    v_pk_mul_f32 v[166:167], v[166:167], s[92:93]
    v_cvt_pk_bf16_f32 v160, v160, v161
    v_cvt_pk_bf16_f32 v161, v162, v163
    v_cvt_pk_bf16_f32 v162, v164, v165
    v_cvt_pk_bf16_f32 v163, v166, v167
    buffer_store_dwordx4 v[160:163], v2, s[8:11], s90 offen sc1
    s_add_u32 s90, s90, s100
    v_pk_mul_f32 v[168:169], v[168:169], s[92:93]
    v_pk_mul_f32 v[170:171], v[170:171], s[92:93]
    v_pk_mul_f32 v[172:173], v[172:173], s[92:93]
    v_pk_mul_f32 v[174:175], v[174:175], s[92:93]
    v_cvt_pk_bf16_f32 v168, v168, v169
    v_cvt_pk_bf16_f32 v169, v170, v171
    v_cvt_pk_bf16_f32 v170, v172, v173
    v_cvt_pk_bf16_f32 v171, v174, v175
    buffer_store_dwordx4 v[168:171], v2, s[8:11], s90 offen sc1
    s_add_u32 s90, s90, s100
    v_pk_mul_f32 v[176:177], v[176:177], s[92:93]
    v_pk_mul_f32 v[178:179], v[178:179], s[92:93]
    v_pk_mul_f32 v[180:181], v[180:181], s[92:93]
    v_pk_mul_f32 v[182:183], v[182:183], s[92:93]
    v_cvt_pk_bf16_f32 v176, v176, v177
    v_cvt_pk_bf16_f32 v177, v178, v179
    v_cvt_pk_bf16_f32 v178, v180, v181
    v_cvt_pk_bf16_f32 v179, v182, v183
    buffer_store_dwordx4 v[176:179], v2, s[8:11], s90 offen sc1
    s_add_u32 s90, s90, s100
    v_pk_mul_f32 v[184:185], v[184:185], s[92:93]
    v_pk_mul_f32 v[186:187], v[186:187], s[92:93]
    v_pk_mul_f32 v[188:189], v[188:189], s[92:93]
    v_pk_mul_f32 v[190:191], v[190:191], s[92:93]
    v_cvt_pk_bf16_f32 v184, v184, v185
    v_cvt_pk_bf16_f32 v185, v186, v187
    v_cvt_pk_bf16_f32 v186, v188, v189
    v_cvt_pk_bf16_f32 v187, v190, v191
    buffer_store_dwordx4 v[184:187], v2, s[8:11], s90 offen sc1
    s_add_u32 s90, s90, s100
    v_pk_mul_f32 v[192:193], v[192:193], s[92:93]
    v_pk_mul_f32 v[194:195], v[194:195], s[92:93]
    v_pk_mul_f32 v[196:197], v[196:197], s[92:93]
    v_pk_mul_f32 v[198:199], v[198:199], s[92:93]
    v_cvt_pk_bf16_f32 v192, v192, v193
    v_cvt_pk_bf16_f32 v193, v194, v195
    v_cvt_pk_bf16_f32 v194, v196, v197
    v_cvt_pk_bf16_f32 v195, v198, v199
    buffer_store_dwordx4 v[192:195], v2, s[8:11], s90 offen sc1
    s_add_u32 s90, s90, s100
    v_pk_mul_f32 v[200:201], v[200:201], s[92:93]
    v_pk_mul_f32 v[202:203], v[202:203], s[92:93]
    v_pk_mul_f32 v[204:205], v[204:205], s[92:93]
    v_pk_mul_f32 v[206:207], v[206:207], s[92:93]
    v_cvt_pk_bf16_f32 v200, v200, v201
    v_cvt_pk_bf16_f32 v201, v202, v203
    v_cvt_pk_bf16_f32 v202, v204, v205
    v_cvt_pk_bf16_f32 v203, v206, v207
    buffer_store_dwordx4 v[200:203], v2, s[8:11], s90 offen sc1
    s_add_u32 s90, s90, s100
    v_pk_mul_f32 v[208:209], v[208:209], s[92:93]
    v_pk_mul_f32 v[210:211], v[210:211], s[92:93]
    v_pk_mul_f32 v[212:213], v[212:213], s[92:93]
    v_pk_mul_f32 v[214:215], v[214:215], s[92:93]
    v_cvt_pk_bf16_f32 v208, v208, v209
    v_cvt_pk_bf16_f32 v209, v210, v211
    v_cvt_pk_bf16_f32 v210, v212, v213
    v_cvt_pk_bf16_f32 v211, v214, v215
    buffer_store_dwordx4 v[208:211], v2, s[8:11], s90 offen sc1
    s_add_u32 s90, s90, s100
    v_pk_mul_f32 v[216:217], v[216:217], s[92:93]
    v_pk_mul_f32 v[218:219], v[218:219], s[92:93]
    v_pk_mul_f32 v[220:221], v[220:221], s[92:93]
    v_pk_mul_f32 v[222:223], v[222:223], s[92:93]
    v_cvt_pk_bf16_f32 v216, v216, v217
    v_cvt_pk_bf16_f32 v217, v218, v219
    v_cvt_pk_bf16_f32 v218, v220, v221
    v_cvt_pk_bf16_f32 v219, v222, v223
    buffer_store_dwordx4 v[216:219], v2, s[8:11], s90 offen sc1
    s_add_u32 s90, s90, s100
    s_add_u32 s91, s91, s99
    s_mov_b32 s90, s91
    v_pk_mul_f32 v[224:225], v[224:225], s[92:93]
    v_pk_mul_f32 v[226:227], v[226:227], s[92:93]
    v_pk_mul_f32 v[228:229], v[228:229], s[92:93]
    v_pk_mul_f32 v[230:231], v[230:231], s[92:93]
    v_cvt_pk_bf16_f32 v224, v224, v225
    v_cvt_pk_bf16_f32 v225, v226, v227
    v_cvt_pk_bf16_f32 v226, v228, v229
    v_cvt_pk_bf16_f32 v227, v230, v231
    buffer_store_dwordx4 v[224:227], v2, s[8:11], s90 offen sc1
    s_add_u32 s90, s90, s100
    v_pk_mul_f32 v[232:233], v[232:233], s[92:93]
    v_pk_mul_f32 v[234:235], v[234:235], s[92:93]
    v_pk_mul_f32 v[236:237], v[236:237], s[92:93]
    v_pk_mul_f32 v[238:239], v[238:239], s[92:93]
    v_cvt_pk_bf16_f32 v232, v232, v233
    v_cvt_pk_bf16_f32 v233, v234, v235
    v_cvt_pk_bf16_f32 v234, v236, v237
    v_cvt_pk_bf16_f32 v235, v238, v239
    buffer_store_dwordx4 v[232:235], v2, s[8:11], s90 offen sc1
    s_add_u32 s90, s90, s100
    v_pk_mul_f32 v[240:241], v[240:241], s[92:93]
    v_pk_mul_f32 v[242:243], v[242:243], s[92:93]
    v_pk_mul_f32 v[244:245], v[244:245], s[92:93]
    v_pk_mul_f32 v[246:247], v[246:247], s[92:93]
    v_cvt_pk_bf16_f32 v240, v240, v241
    v_cvt_pk_bf16_f32 v241, v242, v243
    v_cvt_pk_bf16_f32 v242, v244, v245
    v_cvt_pk_bf16_f32 v243, v246, v247
    buffer_store_dwordx4 v[240:243], v2, s[8:11], s90 offen sc1
    s_add_u32 s90, s90, s100
    v_pk_mul_f32 v[248:249], v[248:249], s[92:93]
    v_pk_mul_f32 v[250:251], v[250:251], s[92:93]
    v_pk_mul_f32 v[252:253], v[252:253], s[92:93]
    v_pk_mul_f32 v[254:255], v[254:255], s[92:93]
    v_cvt_pk_bf16_f32 v248, v248, v249
    v_cvt_pk_bf16_f32 v249, v250, v251
    v_cvt_pk_bf16_f32 v250, v252, v253
    v_cvt_pk_bf16_f32 v251, v254, v255
    buffer_store_dwordx4 v[248:251], v2, s[8:11], s90 offen sc1
    s_add_u32 s90, s90, s100
    v_accvgpr_read_b32 v24, a224
    v_accvgpr_read_b32 v25, a225
    v_accvgpr_read_b32 v26, a226
    v_accvgpr_read_b32 v27, a227
    v_accvgpr_read_b32 v28, a228
    v_accvgpr_read_b32 v29, a229
    v_accvgpr_read_b32 v30, a230
    v_accvgpr_read_b32 v31, a231
    v_pk_mul_f32 v[24:25], v[24:25], s[92:93]
    v_pk_mul_f32 v[26:27], v[26:27], s[92:93]
    v_pk_mul_f32 v[28:29], v[28:29], s[92:93]
    v_pk_mul_f32 v[30:31], v[30:31], s[92:93]
    v_cvt_pk_bf16_f32 v24, v24, v25
    v_cvt_pk_bf16_f32 v25, v26, v27
    v_cvt_pk_bf16_f32 v26, v28, v29
    v_cvt_pk_bf16_f32 v27, v30, v31
    buffer_store_dwordx4 v[24:27], v2, s[8:11], s90 offen sc1
    s_add_u32 s90, s90, s100
    s_nop 1
    v_accvgpr_read_b32 v24, a232
    v_accvgpr_read_b32 v25, a233
    v_accvgpr_read_b32 v26, a234
    v_accvgpr_read_b32 v27, a235
    v_accvgpr_read_b32 v28, a236
    v_accvgpr_read_b32 v29, a237
    v_accvgpr_read_b32 v30, a238
    v_accvgpr_read_b32 v31, a239
    v_pk_mul_f32 v[24:25], v[24:25], s[92:93]
    v_pk_mul_f32 v[26:27], v[26:27], s[92:93]
    v_pk_mul_f32 v[28:29], v[28:29], s[92:93]
    v_pk_mul_f32 v[30:31], v[30:31], s[92:93]
    v_cvt_pk_bf16_f32 v24, v24, v25
    v_cvt_pk_bf16_f32 v25, v26, v27
    v_cvt_pk_bf16_f32 v26, v28, v29
    v_cvt_pk_bf16_f32 v27, v30, v31
    buffer_store_dwordx4 v[24:27], v2, s[8:11], s90 offen sc1
    s_add_u32 s90, s90, s100
    s_nop 1
    v_accvgpr_read_b32 v24, a240
    v_accvgpr_read_b32 v25, a241
    v_accvgpr_read_b32 v26, a242
    v_accvgpr_read_b32 v27, a243
    v_accvgpr_read_b32 v28, a244
    v_accvgpr_read_b32 v29, a245
    v_accvgpr_read_b32 v30, a246
    v_accvgpr_read_b32 v31, a247
    v_pk_mul_f32 v[24:25], v[24:25], s[92:93]
    v_pk_mul_f32 v[26:27], v[26:27], s[92:93]
    v_pk_mul_f32 v[28:29], v[28:29], s[92:93]
    v_pk_mul_f32 v[30:31], v[30:31], s[92:93]
    v_cvt_pk_bf16_f32 v24, v24, v25
    v_cvt_pk_bf16_f32 v25, v26, v27
    v_cvt_pk_bf16_f32 v26, v28, v29
    v_cvt_pk_bf16_f32 v27, v30, v31
    buffer_store_dwordx4 v[24:27], v2, s[8:11], s90 offen sc1
    s_add_u32 s90, s90, s100
    s_nop 1
    v_accvgpr_read_b32 v24, a248
    v_accvgpr_read_b32 v25, a249
    v_accvgpr_read_b32 v26, a250
    v_accvgpr_read_b32 v27, a251
    v_accvgpr_read_b32 v28, a252
    v_accvgpr_read_b32 v29, a253
    v_accvgpr_read_b32 v30, a254
    v_accvgpr_read_b32 v31, a255
    v_pk_mul_f32 v[24:25], v[24:25], s[92:93]
    v_pk_mul_f32 v[26:27], v[26:27], s[92:93]
    v_pk_mul_f32 v[28:29], v[28:29], s[92:93]
    v_pk_mul_f32 v[30:31], v[30:31], s[92:93]
    v_cvt_pk_bf16_f32 v24, v24, v25
    v_cvt_pk_bf16_f32 v25, v26, v27
    v_cvt_pk_bf16_f32 v26, v28, v29
    v_cvt_pk_bf16_f32 v27, v30, v31
    buffer_store_dwordx4 v[24:27], v2, s[8:11], s90 offen sc1
    s_add_u32 s90, s90, s100
    s_nop 1
    s_add_u32 s91, s91, s99
m_epf27_r:
    s_mov_b32 s17, s101
    s_mov_b32 s66, 2
    s_branch m_q135
m_q036:
m_eps28:
    s_nop 3
    s_mov_b32 s90, s98
    v_cvt_pk_bf16_f32 v32, v32, v33
    v_cvt_pk_bf16_f32 v33, v34, v35
    v_cvt_pk_bf16_f32 v34, v36, v37
    v_cvt_pk_bf16_f32 v35, v38, v39
    buffer_store_dwordx4 v[32:35], v2, s[8:11], s90 offen sc1
    s_add_u32 s90, s90, s100
    v_cvt_pk_bf16_f32 v40, v40, v41
    v_cvt_pk_bf16_f32 v41, v42, v43
    v_cvt_pk_bf16_f32 v42, v44, v45
    v_cvt_pk_bf16_f32 v43, v46, v47
    buffer_store_dwordx4 v[40:43], v2, s[8:11], s90 offen sc1
    s_add_u32 s90, s90, s100
    v_cvt_pk_bf16_f32 v48, v48, v49
    v_cvt_pk_bf16_f32 v49, v50, v51
    v_cvt_pk_bf16_f32 v50, v52, v53
    v_cvt_pk_bf16_f32 v51, v54, v55
    buffer_store_dwordx4 v[48:51], v2, s[8:11], s90 offen sc1
    s_add_u32 s90, s90, s100
    v_cvt_pk_bf16_f32 v56, v56, v57
    v_cvt_pk_bf16_f32 v57, v58, v59
    v_cvt_pk_bf16_f32 v58, v60, v61
    v_cvt_pk_bf16_f32 v59, v62, v63
    buffer_store_dwordx4 v[56:59], v2, s[8:11], s90 offen sc1
    s_add_u32 s90, s90, s100
    v_cvt_pk_bf16_f32 v64, v64, v65
    v_cvt_pk_bf16_f32 v65, v66, v67
    v_cvt_pk_bf16_f32 v66, v68, v69
    v_cvt_pk_bf16_f32 v67, v70, v71
    buffer_store_dwordx4 v[64:67], v2, s[8:11], s90 offen sc1
    s_add_u32 s90, s90, s100
    v_cvt_pk_bf16_f32 v72, v72, v73
    v_cvt_pk_bf16_f32 v73, v74, v75
    v_cvt_pk_bf16_f32 v74, v76, v77
    v_cvt_pk_bf16_f32 v75, v78, v79
    buffer_store_dwordx4 v[72:75], v2, s[8:11], s90 offen sc1
    s_add_u32 s90, s90, s100
    v_cvt_pk_bf16_f32 v80, v80, v81
    v_cvt_pk_bf16_f32 v81, v82, v83
    v_cvt_pk_bf16_f32 v82, v84, v85
    v_cvt_pk_bf16_f32 v83, v86, v87
    buffer_store_dwordx4 v[80:83], v2, s[8:11], s90 offen sc1
    s_add_u32 s90, s90, s100
    v_cvt_pk_bf16_f32 v88, v88, v89
    v_cvt_pk_bf16_f32 v89, v90, v91
    v_cvt_pk_bf16_f32 v90, v92, v93
    v_cvt_pk_bf16_f32 v91, v94, v95
    buffer_store_dwordx4 v[88:91], v2, s[8:11], s90 offen sc1
    s_add_u32 s90, s90, s100
    v_cvt_pk_bf16_f32 v96, v96, v97
    v_cvt_pk_bf16_f32 v97, v98, v99
    v_cvt_pk_bf16_f32 v98, v100, v101
    v_cvt_pk_bf16_f32 v99, v102, v103
    v_accvgpr_write_b32 a128, v96
    v_accvgpr_write_b32 a129, v97
    v_accvgpr_write_b32 a130, v98
    v_accvgpr_write_b32 a131, v99
    v_cvt_pk_bf16_f32 v104, v104, v105
    v_cvt_pk_bf16_f32 v105, v106, v107
    v_cvt_pk_bf16_f32 v106, v108, v109
    v_cvt_pk_bf16_f32 v107, v110, v111
    v_accvgpr_write_b32 a132, v104
    v_accvgpr_write_b32 a133, v105
    v_accvgpr_write_b32 a134, v106
    v_accvgpr_write_b32 a135, v107
    v_cvt_pk_bf16_f32 v112, v112, v113
    v_cvt_pk_bf16_f32 v113, v114, v115
    v_cvt_pk_bf16_f32 v114, v116, v117
    v_cvt_pk_bf16_f32 v115, v118, v119
    v_accvgpr_write_b32 a136, v112
    v_accvgpr_write_b32 a137, v113
    v_accvgpr_write_b32 a138, v114
    v_accvgpr_write_b32 a139, v115
    v_cvt_pk_bf16_f32 v120, v120, v121
    v_cvt_pk_bf16_f32 v121, v122, v123
    v_cvt_pk_bf16_f32 v122, v124, v125
    v_cvt_pk_bf16_f32 v123, v126, v127
    v_accvgpr_write_b32 a140, v120
    v_accvgpr_write_b32 a141, v121
    v_accvgpr_write_b32 a142, v122
    v_accvgpr_write_b32 a143, v123
    v_cvt_pk_bf16_f32 v128, v128, v129
    v_cvt_pk_bf16_f32 v129, v130, v131
    v_cvt_pk_bf16_f32 v130, v132, v133
    v_cvt_pk_bf16_f32 v131, v134, v135
    v_accvgpr_write_b32 a144, v128
    v_accvgpr_write_b32 a145, v129
    v_accvgpr_write_b32 a146, v130
    v_accvgpr_write_b32 a147, v131
    v_cvt_pk_bf16_f32 v136, v136, v137
    v_cvt_pk_bf16_f32 v137, v138, v139
    v_cvt_pk_bf16_f32 v138, v140, v141
    v_cvt_pk_bf16_f32 v139, v142, v143
    v_accvgpr_write_b32 a148, v136
    v_accvgpr_write_b32 a149, v137
    v_accvgpr_write_b32 a150, v138
    v_accvgpr_write_b32 a151, v139
    v_cvt_pk_bf16_f32 v144, v144, v145
    v_cvt_pk_bf16_f32 v145, v146, v147
    v_cvt_pk_bf16_f32 v146, v148, v149
    v_cvt_pk_bf16_f32 v147, v150, v151
    v_accvgpr_write_b32 a152, v144
    v_accvgpr_write_b32 a153, v145
    v_accvgpr_write_b32 a154, v146
    v_accvgpr_write_b32 a155, v147
    v_cvt_pk_bf16_f32 v152, v152, v153
    v_cvt_pk_bf16_f32 v153, v154, v155
    v_cvt_pk_bf16_f32 v154, v156, v157
    v_cvt_pk_bf16_f32 v155, v158, v159
    v_accvgpr_write_b32 a156, v152
    v_accvgpr_write_b32 a157, v153
    v_accvgpr_write_b32 a158, v154
    v_accvgpr_write_b32 a159, v155
    v_cvt_pk_bf16_f32 v160, v160, v161
    v_cvt_pk_bf16_f32 v161, v162, v163
    v_cvt_pk_bf16_f32 v162, v164, v165
    v_cvt_pk_bf16_f32 v163, v166, v167
    v_accvgpr_write_b32 a160, v160
    v_accvgpr_write_b32 a161, v161
    v_accvgpr_write_b32 a162, v162
    v_accvgpr_write_b32 a163, v163
    v_cvt_pk_bf16_f32 v168, v168, v169
    v_cvt_pk_bf16_f32 v169, v170, v171
    v_cvt_pk_bf16_f32 v170, v172, v173
    v_cvt_pk_bf16_f32 v171, v174, v175
    v_accvgpr_write_b32 a164, v168
    v_accvgpr_write_b32 a165, v169
    v_accvgpr_write_b32 a166, v170
    v_accvgpr_write_b32 a167, v171
    v_cvt_pk_bf16_f32 v176, v176, v177
    v_cvt_pk_bf16_f32 v177, v178, v179
    v_cvt_pk_bf16_f32 v178, v180, v181
    v_cvt_pk_bf16_f32 v179, v182, v183
    v_accvgpr_write_b32 a168, v176
    v_accvgpr_write_b32 a169, v177
    v_accvgpr_write_b32 a170, v178
    v_accvgpr_write_b32 a171, v179
    v_cvt_pk_bf16_f32 v184, v184, v185
    v_cvt_pk_bf16_f32 v185, v186, v187
    v_cvt_pk_bf16_f32 v186, v188, v189
    v_cvt_pk_bf16_f32 v187, v190, v191
    v_accvgpr_write_b32 a172, v184
    v_accvgpr_write_b32 a173, v185
    v_accvgpr_write_b32 a174, v186
    v_accvgpr_write_b32 a175, v187
    v_cvt_pk_bf16_f32 v192, v192, v193
    v_cvt_pk_bf16_f32 v193, v194, v195
    v_cvt_pk_bf16_f32 v194, v196, v197
    v_cvt_pk_bf16_f32 v195, v198, v199
    v_accvgpr_write_b32 a176, v192
    v_accvgpr_write_b32 a177, v193
    v_accvgpr_write_b32 a178, v194
    v_accvgpr_write_b32 a179, v195
    v_cvt_pk_bf16_f32 v200, v200, v201
    v_cvt_pk_bf16_f32 v201, v202, v203
    v_cvt_pk_bf16_f32 v202, v204, v205
    v_cvt_pk_bf16_f32 v203, v206, v207
    v_accvgpr_write_b32 a180, v200
    v_accvgpr_write_b32 a181, v201
    v_accvgpr_write_b32 a182, v202
    v_accvgpr_write_b32 a183, v203
    v_cvt_pk_bf16_f32 v208, v208, v209
    v_cvt_pk_bf16_f32 v209, v210, v211
    v_cvt_pk_bf16_f32 v210, v212, v213
    v_cvt_pk_bf16_f32 v211, v214, v215
    v_accvgpr_write_b32 a184, v208
    v_accvgpr_write_b32 a185, v209
    v_accvgpr_write_b32 a186, v210
    v_accvgpr_write_b32 a187, v211
    v_cvt_pk_bf16_f32 v216, v216, v217
    v_cvt_pk_bf16_f32 v217, v218, v219
    v_cvt_pk_bf16_f32 v218, v220, v221
    v_cvt_pk_bf16_f32 v219, v222, v223
    v_accvgpr_write_b32 a188, v216
    v_accvgpr_write_b32 a189, v217
    v_accvgpr_write_b32 a190, v218
    v_accvgpr_write_b32 a191, v219
    v_cvt_pk_bf16_f32 v224, v224, v225
    v_cvt_pk_bf16_f32 v225, v226, v227
    v_cvt_pk_bf16_f32 v226, v228, v229
    v_cvt_pk_bf16_f32 v227, v230, v231
    v_accvgpr_write_b32 a192, v224
    v_accvgpr_write_b32 a193, v225
    v_accvgpr_write_b32 a194, v226
    v_accvgpr_write_b32 a195, v227
    v_cvt_pk_bf16_f32 v232, v232, v233
    v_cvt_pk_bf16_f32 v233, v234, v235
    v_cvt_pk_bf16_f32 v234, v236, v237
    v_cvt_pk_bf16_f32 v235, v238, v239
    v_accvgpr_write_b32 a196, v232
    v_accvgpr_write_b32 a197, v233
    v_accvgpr_write_b32 a198, v234
    v_accvgpr_write_b32 a199, v235
    v_cvt_pk_bf16_f32 v240, v240, v241
    v_cvt_pk_bf16_f32 v241, v242, v243
    v_cvt_pk_bf16_f32 v242, v244, v245
    v_cvt_pk_bf16_f32 v243, v246, v247
    v_accvgpr_write_b32 a200, v240
    v_accvgpr_write_b32 a201, v241
    v_accvgpr_write_b32 a202, v242
    v_accvgpr_write_b32 a203, v243
    v_cvt_pk_bf16_f32 v248, v248, v249
    v_cvt_pk_bf16_f32 v249, v250, v251
    v_cvt_pk_bf16_f32 v250, v252, v253
    v_cvt_pk_bf16_f32 v251, v254, v255
    v_accvgpr_write_b32 a204, v248
    v_accvgpr_write_b32 a205, v249
    v_accvgpr_write_b32 a206, v250
    v_accvgpr_write_b32 a207, v251
    v_accvgpr_read_b32 v24, a224
    v_accvgpr_read_b32 v25, a225
    v_accvgpr_read_b32 v26, a226
    v_accvgpr_read_b32 v27, a227
    v_accvgpr_read_b32 v28, a228
    v_accvgpr_read_b32 v29, a229
    v_accvgpr_read_b32 v30, a230
    v_accvgpr_read_b32 v31, a231
    v_cvt_pk_bf16_f32 v24, v24, v25
    v_cvt_pk_bf16_f32 v25, v26, v27
    v_cvt_pk_bf16_f32 v26, v28, v29
    v_cvt_pk_bf16_f32 v27, v30, v31
    v_accvgpr_write_b32 a208, v24
    v_accvgpr_write_b32 a209, v25
    v_accvgpr_write_b32 a210, v26
    v_accvgpr_write_b32 a211, v27
    v_accvgpr_read_b32 v24, a232
    v_accvgpr_read_b32 v25, a233
    v_accvgpr_read_b32 v26, a234
    v_accvgpr_read_b32 v27, a235
    v_accvgpr_read_b32 v28, a236
    v_accvgpr_read_b32 v29, a237
    v_accvgpr_read_b32 v30, a238
    v_accvgpr_read_b32 v31, a239
    v_cvt_pk_bf16_f32 v24, v24, v25
    v_cvt_pk_bf16_f32 v25, v26, v27
    v_cvt_pk_bf16_f32 v26, v28, v29
    v_cvt_pk_bf16_f32 v27, v30, v31
    v_accvgpr_write_b32 a212, v24
    v_accvgpr_write_b32 a213, v25
    v_accvgpr_write_b32 a214, v26
    v_accvgpr_write_b32 a215, v27
    v_accvgpr_read_b32 v24, a240
    v_accvgpr_read_b32 v25, a241
    v_accvgpr_read_b32 v26, a242
    v_accvgpr_read_b32 v27, a243
    v_accvgpr_read_b32 v28, a244
    v_accvgpr_read_b32 v29, a245
    v_accvgpr_read_b32 v30, a246
    v_accvgpr_read_b32 v31, a247
    v_cvt_pk_bf16_f32 v24, v24, v25
    v_cvt_pk_bf16_f32 v25, v26, v27
    v_cvt_pk_bf16_f32 v26, v28, v29
    v_cvt_pk_bf16_f32 v27, v30, v31
    v_accvgpr_write_b32 a216, v24
    v_accvgpr_write_b32 a217, v25
    v_accvgpr_write_b32 a218, v26
    v_accvgpr_write_b32 a219, v27
    v_accvgpr_read_b32 v24, a248
    v_accvgpr_read_b32 v25, a249
    v_accvgpr_read_b32 v26, a250
    v_accvgpr_read_b32 v27, a251
    v_accvgpr_read_b32 v28, a252
    v_accvgpr_read_b32 v29, a253
    v_accvgpr_read_b32 v30, a254
    v_accvgpr_read_b32 v31, a255
    v_cvt_pk_bf16_f32 v24, v24, v25
    v_cvt_pk_bf16_f32 v25, v26, v27
    v_cvt_pk_bf16_f32 v26, v28, v29
    v_cvt_pk_bf16_f32 v27, v30, v31
    v_accvgpr_write_b32 a220, v24
    v_accvgpr_write_b32 a221, v25
    v_accvgpr_write_b32 a222, v26
    v_accvgpr_write_b32 a223, v27
m_eps28_r:
    s_mov_b32 s17, s101
    s_add_u32 s28, s98, s99
    s_mov_b32 s29, s28
    s_mov_b32 s30, s99
    s_mov_b32 s31, s100
    s_mov_b32 s26, 268435456
m_q135:
    s_mov_b32 s95, s82
    s_mov_b32 s96, s83
    s_mov_b32 s97, s84
    s_mov_b32 s98, s85
    s_mov_b32 s99, s86
    s_mov_b32 s100, s87
    s_mov_b32 s101, s88
    s_sub_u32 s67, s95, 5
    s_max_u32 s67, s67, 4
    s_mov_b32 s94, 0
    s_branch m_tile14
m_last29:
m_kvl32:
    s_waitcnt lgkmcnt(0)
    v_mov_b32 v6, v2
    ds_read_b128 a[192:195], v6 offset:0
    ds_read_b128 a[196:199], v6 offset:1024
    ds_read_b128 a[200:203], v6 offset:2048
    ds_read_b128 a[204:207], v6 offset:3072
    ds_read_b128 a[208:211], v6 offset:4096
    ds_read_b128 a[212:215], v6 offset:5120
    ds_read_b128 a[216:219], v6 offset:6144
    ds_read_b128 a[220:223], v6 offset:7168
    s_load_dwordx2 s[48:49], s[0:1], 64
    s_load_dwordx2 s[50:51], s[0:1], 16
    s_load_dwordx2 s[54:55], s[0:1], 72
    s_mov_b32 s47, 0x20000
m_epl85:
    s_mov_b32 s92, s97
    s_mov_b32 s93, s97
    s_cmp_eq_u32 s97, 0
    s_cbranch_scc1 m_ns286
    s_mov_b32 s90, s98
    v_pk_mul_f32 v[32:33], v[32:33], s[92:93]
    v_pk_mul_f32 v[34:35], v[34:35], s[92:93]
    v_pk_mul_f32 v[36:37], v[36:37], s[92:93]
    v_pk_mul_f32 v[38:39], v[38:39], s[92:93]
    v_cvt_pk_bf16_f32 v32, v32, v33
    v_cvt_pk_bf16_f32 v33, v34, v35
    v_cvt_pk_bf16_f32 v34, v36, v37
    v_cvt_pk_bf16_f32 v35, v38, v39
    buffer_store_dwordx4 v[32:35], v2, s[8:11], s90 offen sc1
    s_add_u32 s90, s90, s100
    v_accvgpr_write_b32 a0, 0
    v_accvgpr_write_b32 a1, 0
    v_accvgpr_write_b32 a2, 0
    v_accvgpr_write_b32 a3, 0
    v_accvgpr_write_b32 a4, 0
    v_accvgpr_write_b32 a5, 0
    v_accvgpr_write_b32 a6, 0
    v_accvgpr_write_b32 a7, 0
    v_pk_mul_f32 v[192:193], v[192:193], s[92:93]
    v_pk_mul_f32 v[194:195], v[194:195], s[92:93]
    v_pk_mul_f32 v[196:197], v[196:197], s[92:93]
    v_pk_mul_f32 v[198:199], v[198:199], s[92:93]
    v_cvt_pk_bf16_f32 v192, v192, v193
    v_cvt_pk_bf16_f32 v193, v194, v195
    v_cvt_pk_bf16_f32 v194, v196, v197
    v_cvt_pk_bf16_f32 v195, v198, v199
    v_pk_mul_f32 v[40:41], v[40:41], s[92:93]
    v_pk_mul_f32 v[42:43], v[42:43], s[92:93]
    v_pk_mul_f32 v[44:45], v[44:45], s[92:93]
    v_pk_mul_f32 v[46:47], v[46:47], s[92:93]
    v_cvt_pk_bf16_f32 v40, v40, v41
    v_cvt_pk_bf16_f32 v41, v42, v43
    v_cvt_pk_bf16_f32 v42, v44, v45
    v_cvt_pk_bf16_f32 v43, v46, v47
    buffer_store_dwordx4 v[40:43], v2, s[8:11], s90 offen sc1
    s_add_u32 s90, s90, s100
    v_accvgpr_write_b32 a8, 0
    v_accvgpr_write_b32 a9, 0
    v_accvgpr_write_b32 a10, 0
    v_accvgpr_write_b32 a11, 0
    v_accvgpr_write_b32 a12, 0
    v_accvgpr_write_b32 a13, 0
    v_accvgpr_write_b32 a14, 0
    v_accvgpr_write_b32 a15, 0
    v_pk_mul_f32 v[200:201], v[200:201], s[92:93]
    v_pk_mul_f32 v[202:203], v[202:203], s[92:93]
    v_pk_mul_f32 v[204:205], v[204:205], s[92:93]
    v_pk_mul_f32 v[206:207], v[206:207], s[92:93]
    v_cvt_pk_bf16_f32 v196, v200, v201
    v_cvt_pk_bf16_f32 v197, v202, v203
    v_cvt_pk_bf16_f32 v198, v204, v205
    v_cvt_pk_bf16_f32 v199, v206, v207
    v_pk_mul_f32 v[48:49], v[48:49], s[92:93]
    v_pk_mul_f32 v[50:51], v[50:51], s[92:93]
    v_pk_mul_f32 v[52:53], v[52:53], s[92:93]
    v_pk_mul_f32 v[54:55], v[54:55], s[92:93]
    v_cvt_pk_bf16_f32 v48, v48, v49
    v_cvt_pk_bf16_f32 v49, v50, v51
    v_cvt_pk_bf16_f32 v50, v52, v53
    v_cvt_pk_bf16_f32 v51, v54, v55
    buffer_store_dwordx4 v[48:51], v2, s[8:11], s90 offen sc1
    s_add_u32 s90, s90, s100
    v_accvgpr_write_b32 a16, 0
    v_accvgpr_write_b32 a17, 0
    v_accvgpr_write_b32 a18, 0
    v_accvgpr_write_b32 a19, 0
    v_accvgpr_write_b32 a20, 0
    v_accvgpr_write_b32 a21, 0
    v_accvgpr_write_b32 a22, 0
    v_accvgpr_write_b32 a23, 0
    v_pk_mul_f32 v[208:209], v[208:209], s[92:93]
    v_pk_mul_f32 v[210:211], v[210:211], s[92:93]
    v_pk_mul_f32 v[212:213], v[212:213], s[92:93]
    v_pk_mul_f32 v[214:215], v[214:215], s[92:93]
    v_cvt_pk_bf16_f32 v200, v208, v209
    v_cvt_pk_bf16_f32 v201, v210, v211
    v_cvt_pk_bf16_f32 v202, v212, v213
    v_cvt_pk_bf16_f32 v203, v214, v215
    v_pk_mul_f32 v[56:57], v[56:57], s[92:93]
    v_pk_mul_f32 v[58:59], v[58:59], s[92:93]
    v_pk_mul_f32 v[60:61], v[60:61], s[92:93]
    v_pk_mul_f32 v[62:63], v[62:63], s[92:93]
    v_cvt_pk_bf16_f32 v56, v56, v57
    v_cvt_pk_bf16_f32 v57, v58, v59
    v_cvt_pk_bf16_f32 v58, v60, v61
    v_cvt_pk_bf16_f32 v59, v62, v63
    buffer_store_dwordx4 v[56:59], v2, s[8:11], s90 offen sc1
    s_add_u32 s90, s90, s100
    v_accvgpr_write_b32 a24, 0
    v_accvgpr_write_b32 a25, 0
    v_accvgpr_write_b32 a26, 0
    v_accvgpr_write_b32 a27, 0
    v_accvgpr_write_b32 a28, 0
    v_accvgpr_write_b32 a29, 0
    v_accvgpr_write_b32 a30, 0
    v_accvgpr_write_b32 a31, 0
    v_pk_mul_f32 v[216:217], v[216:217], s[92:93]
    v_pk_mul_f32 v[218:219], v[218:219], s[92:93]
    v_pk_mul_f32 v[220:221], v[220:221], s[92:93]
    v_pk_mul_f32 v[222:223], v[222:223], s[92:93]
    v_cvt_pk_bf16_f32 v204, v216, v217
    v_cvt_pk_bf16_f32 v205, v218, v219
    v_cvt_pk_bf16_f32 v206, v220, v221
    v_cvt_pk_bf16_f32 v207, v222, v223
    v_pk_mul_f32 v[64:65], v[64:65], s[92:93]
    v_pk_mul_f32 v[66:67], v[66:67], s[92:93]
    v_pk_mul_f32 v[68:69], v[68:69], s[92:93]
    v_pk_mul_f32 v[70:71], v[70:71], s[92:93]
    v_cvt_pk_bf16_f32 v64, v64, v65
    v_cvt_pk_bf16_f32 v65, v66, v67
    v_cvt_pk_bf16_f32 v66, v68, v69
    v_cvt_pk_bf16_f32 v67, v70, v71
    buffer_store_dwordx4 v[64:67], v2, s[8:11], s90 offen sc1
    s_add_u32 s90, s90, s100
    v_accvgpr_write_b32 a32, 0
    v_accvgpr_write_b32 a33, 0
    v_accvgpr_write_b32 a34, 0
    v_accvgpr_write_b32 a35, 0
    v_accvgpr_write_b32 a36, 0
    v_accvgpr_write_b32 a37, 0
    v_accvgpr_write_b32 a38, 0
    v_accvgpr_write_b32 a39, 0
    v_pk_mul_f32 v[224:225], v[224:225], s[92:93]
    v_pk_mul_f32 v[226:227], v[226:227], s[92:93]
    v_pk_mul_f32 v[228:229], v[228:229], s[92:93]
    v_pk_mul_f32 v[230:231], v[230:231], s[92:93]
    v_cvt_pk_bf16_f32 v208, v224, v225
    v_cvt_pk_bf16_f32 v209, v226, v227
    v_cvt_pk_bf16_f32 v210, v228, v229
    v_cvt_pk_bf16_f32 v211, v230, v231
    v_pk_mul_f32 v[72:73], v[72:73], s[92:93]
    v_pk_mul_f32 v[74:75], v[74:75], s[92:93]
    v_pk_mul_f32 v[76:77], v[76:77], s[92:93]
    v_pk_mul_f32 v[78:79], v[78:79], s[92:93]
    v_cvt_pk_bf16_f32 v72, v72, v73
    v_cvt_pk_bf16_f32 v73, v74, v75
    v_cvt_pk_bf16_f32 v74, v76, v77
    v_cvt_pk_bf16_f32 v75, v78, v79
    buffer_store_dwordx4 v[72:75], v2, s[8:11], s90 offen sc1
    s_add_u32 s90, s90, s100
    v_accvgpr_write_b32 a40, 0
    v_accvgpr_write_b32 a41, 0
    v_accvgpr_write_b32 a42, 0
    v_accvgpr_write_b32 a43, 0
    v_accvgpr_write_b32 a44, 0
    v_accvgpr_write_b32 a45, 0
    v_accvgpr_write_b32 a46, 0
    v_accvgpr_write_b32 a47, 0
    v_pk_mul_f32 v[232:233], v[232:233], s[92:93]
    v_pk_mul_f32 v[234:235], v[234:235], s[92:93]
    v_pk_mul_f32 v[236:237], v[236:237], s[92:93]
    v_pk_mul_f32 v[238:239], v[238:239], s[92:93]
    v_cvt_pk_bf16_f32 v212, v232, v233
    v_cvt_pk_bf16_f32 v213, v234, v235
    v_cvt_pk_bf16_f32 v214, v236, v237
    v_cvt_pk_bf16_f32 v215, v238, v239
    v_pk_mul_f32 v[80:81], v[80:81], s[92:93]
    v_pk_mul_f32 v[82:83], v[82:83], s[92:93]
    v_pk_mul_f32 v[84:85], v[84:85], s[92:93]
    v_pk_mul_f32 v[86:87], v[86:87], s[92:93]
    v_cvt_pk_bf16_f32 v80, v80, v81
    v_cvt_pk_bf16_f32 v81, v82, v83
    v_cvt_pk_bf16_f32 v82, v84, v85
    v_cvt_pk_bf16_f32 v83, v86, v87
    buffer_store_dwordx4 v[80:83], v2, s[8:11], s90 offen sc1
    s_add_u32 s90, s90, s100
    v_accvgpr_write_b32 a48, 0
    v_accvgpr_write_b32 a49, 0
    v_accvgpr_write_b32 a50, 0
    v_accvgpr_write_b32 a51, 0
    v_accvgpr_write_b32 a52, 0
    v_accvgpr_write_b32 a53, 0
    v_accvgpr_write_b32 a54, 0
    v_accvgpr_write_b32 a55, 0
    v_pk_mul_f32 v[240:241], v[240:241], s[92:93]
    v_pk_mul_f32 v[242:243], v[242:243], s[92:93]
    v_pk_mul_f32 v[244:245], v[244:245], s[92:93]
    v_pk_mul_f32 v[246:247], v[246:247], s[92:93]
    v_cvt_pk_bf16_f32 v216, v240, v241
    v_cvt_pk_bf16_f32 v217, v242, v243
    v_cvt_pk_bf16_f32 v218, v244, v245
    v_cvt_pk_bf16_f32 v219, v246, v247
    v_pk_mul_f32 v[88:89], v[88:89], s[92:93]
    v_pk_mul_f32 v[90:91], v[90:91], s[92:93]
    v_pk_mul_f32 v[92:93], v[92:93], s[92:93]
    v_pk_mul_f32 v[94:95], v[94:95], s[92:93]
    v_cvt_pk_bf16_f32 v88, v88, v89
    v_cvt_pk_bf16_f32 v89, v90, v91
    v_cvt_pk_bf16_f32 v90, v92, v93
    v_cvt_pk_bf16_f32 v91, v94, v95
    buffer_store_dwordx4 v[88:91], v2, s[8:11], s90 offen sc1
    s_add_u32 s90, s98, s99
    v_accvgpr_write_b32 a56, 0
    v_accvgpr_write_b32 a57, 0
    v_accvgpr_write_b32 a58, 0
    v_accvgpr_write_b32 a59, 0
    v_accvgpr_write_b32 a60, 0
    v_accvgpr_write_b32 a61, 0
    v_accvgpr_write_b32 a62, 0
    v_accvgpr_write_b32 a63, 0
    v_pk_mul_f32 v[248:249], v[248:249], s[92:93]
    v_pk_mul_f32 v[250:251], v[250:251], s[92:93]
    v_pk_mul_f32 v[252:253], v[252:253], s[92:93]
    v_pk_mul_f32 v[254:255], v[254:255], s[92:93]
    v_cvt_pk_bf16_f32 v220, v248, v249
    v_cvt_pk_bf16_f32 v221, v250, v251
    v_cvt_pk_bf16_f32 v222, v252, v253
    v_cvt_pk_bf16_f32 v223, v254, v255
    v_pk_mul_f32 v[96:97], v[96:97], s[92:93]
    v_pk_mul_f32 v[98:99], v[98:99], s[92:93]
    v_pk_mul_f32 v[100:101], v[100:101], s[92:93]
    v_pk_mul_f32 v[102:103], v[102:103], s[92:93]
    v_cvt_pk_bf16_f32 v96, v96, v97
    v_cvt_pk_bf16_f32 v97, v98, v99
    v_cvt_pk_bf16_f32 v98, v100, v101
    v_cvt_pk_bf16_f32 v99, v102, v103
    buffer_store_dwordx4 v[96:99], v2, s[8:11], s90 offen sc1
    s_add_u32 s90, s90, s100
    v_accvgpr_write_b32 a64, 0
    v_accvgpr_write_b32 a65, 0
    v_accvgpr_write_b32 a66, 0
    v_accvgpr_write_b32 a67, 0
    v_accvgpr_write_b32 a68, 0
    v_accvgpr_write_b32 a69, 0
    v_accvgpr_write_b32 a70, 0
    v_accvgpr_write_b32 a71, 0
    v_accvgpr_read_b32 v24, a224
    v_accvgpr_read_b32 v25, a225
    v_accvgpr_read_b32 v26, a226
    v_accvgpr_read_b32 v27, a227
    v_accvgpr_read_b32 v28, a228
    v_accvgpr_read_b32 v29, a229
    v_accvgpr_read_b32 v30, a230
    v_accvgpr_read_b32 v31, a231
    v_pk_mul_f32 v[24:25], v[24:25], s[92:93]
    v_pk_mul_f32 v[26:27], v[26:27], s[92:93]
    v_pk_mul_f32 v[28:29], v[28:29], s[92:93]
    v_pk_mul_f32 v[30:31], v[30:31], s[92:93]
    v_cvt_pk_bf16_f32 v224, v24, v25
    v_cvt_pk_bf16_f32 v225, v26, v27
    v_cvt_pk_bf16_f32 v226, v28, v29
    v_cvt_pk_bf16_f32 v227, v30, v31
    v_pk_mul_f32 v[104:105], v[104:105], s[92:93]
    v_pk_mul_f32 v[106:107], v[106:107], s[92:93]
    v_pk_mul_f32 v[108:109], v[108:109], s[92:93]
    v_pk_mul_f32 v[110:111], v[110:111], s[92:93]
    v_cvt_pk_bf16_f32 v104, v104, v105
    v_cvt_pk_bf16_f32 v105, v106, v107
    v_cvt_pk_bf16_f32 v106, v108, v109
    v_cvt_pk_bf16_f32 v107, v110, v111
    buffer_store_dwordx4 v[104:107], v2, s[8:11], s90 offen sc1
    s_add_u32 s90, s90, s100
    v_accvgpr_write_b32 a72, 0
    v_accvgpr_write_b32 a73, 0
    v_accvgpr_write_b32 a74, 0
    v_accvgpr_write_b32 a75, 0
    v_accvgpr_write_b32 a76, 0
    v_accvgpr_write_b32 a77, 0
    v_accvgpr_write_b32 a78, 0
    v_accvgpr_write_b32 a79, 0
    v_accvgpr_read_b32 v24, a232
    v_accvgpr_read_b32 v25, a233
    v_accvgpr_read_b32 v26, a234
    v_accvgpr_read_b32 v27, a235
    v_accvgpr_read_b32 v28, a236
    v_accvgpr_read_b32 v29, a237
    v_accvgpr_read_b32 v30, a238
    v_accvgpr_read_b32 v31, a239
    v_pk_mul_f32 v[24:25], v[24:25], s[92:93]
    v_pk_mul_f32 v[26:27], v[26:27], s[92:93]
    v_pk_mul_f32 v[28:29], v[28:29], s[92:93]
    v_pk_mul_f32 v[30:31], v[30:31], s[92:93]
    v_cvt_pk_bf16_f32 v228, v24, v25
    v_cvt_pk_bf16_f32 v229, v26, v27
    v_cvt_pk_bf16_f32 v230, v28, v29
    v_cvt_pk_bf16_f32 v231, v30, v31
    v_pk_mul_f32 v[112:113], v[112:113], s[92:93]
    v_pk_mul_f32 v[114:115], v[114:115], s[92:93]
    v_pk_mul_f32 v[116:117], v[116:117], s[92:93]
    v_pk_mul_f32 v[118:119], v[118:119], s[92:93]
    v_cvt_pk_bf16_f32 v112, v112, v113
    v_cvt_pk_bf16_f32 v113, v114, v115
    v_cvt_pk_bf16_f32 v114, v116, v117
    v_cvt_pk_bf16_f32 v115, v118, v119
    buffer_store_dwordx4 v[112:115], v2, s[8:11], s90 offen sc1
    s_add_u32 s90, s90, s100
    v_accvgpr_write_b32 a80, 0
    v_accvgpr_write_b32 a81, 0
    v_accvgpr_write_b32 a82, 0
    v_accvgpr_write_b32 a83, 0
    v_accvgpr_write_b32 a84, 0
    v_accvgpr_write_b32 a85, 0
    v_accvgpr_write_b32 a86, 0
    v_accvgpr_write_b32 a87, 0
    v_accvgpr_read_b32 v24, a240
    v_accvgpr_read_b32 v25, a241
    v_accvgpr_read_b32 v26, a242
    v_accvgpr_read_b32 v27, a243
    v_accvgpr_read_b32 v28, a244
    v_accvgpr_read_b32 v29, a245
    v_accvgpr_read_b32 v30, a246
    v_accvgpr_read_b32 v31, a247
    v_pk_mul_f32 v[24:25], v[24:25], s[92:93]
    v_pk_mul_f32 v[26:27], v[26:27], s[92:93]
    v_pk_mul_f32 v[28:29], v[28:29], s[92:93]
    v_pk_mul_f32 v[30:31], v[30:31], s[92:93]
    v_cvt_pk_bf16_f32 v232, v24, v25
    v_cvt_pk_bf16_f32 v233, v26, v27
    v_cvt_pk_bf16_f32 v234, v28, v29
    v_cvt_pk_bf16_f32 v235, v30, v31
    v_pk_mul_f32 v[120:121], v[120:121], s[92:93]
    v_pk_mul_f32 v[122:123], v[122:123], s[92:93]
    v_pk_mul_f32 v[124:125], v[124:125], s[92:93]
    v_pk_mul_f32 v[126:127], v[126:127], s[92:93]
    v_cvt_pk_bf16_f32 v120, v120, v121
    v_cvt_pk_bf16_f32 v121, v122, v123
    v_cvt_pk_bf16_f32 v122, v124, v125
    v_cvt_pk_bf16_f32 v123, v126, v127
    buffer_store_dwordx4 v[120:123], v2, s[8:11], s90 offen sc1
    s_add_u32 s90, s90, s100
    v_accvgpr_write_b32 a88, 0
    v_accvgpr_write_b32 a89, 0
    v_accvgpr_write_b32 a90, 0
    v_accvgpr_write_b32 a91, 0
    v_accvgpr_write_b32 a92, 0
    v_accvgpr_write_b32 a93, 0
    v_accvgpr_write_b32 a94, 0
    v_accvgpr_write_b32 a95, 0
    v_accvgpr_read_b32 v24, a248
    v_accvgpr_read_b32 v25, a249
    v_accvgpr_read_b32 v26, a250
    v_accvgpr_read_b32 v27, a251
    v_accvgpr_read_b32 v28, a252
    v_accvgpr_read_b32 v29, a253
    v_accvgpr_read_b32 v30, a254
    v_accvgpr_read_b32 v31, a255
    v_pk_mul_f32 v[24:25], v[24:25], s[92:93]
    v_pk_mul_f32 v[26:27], v[26:27], s[92:93]
    v_pk_mul_f32 v[28:29], v[28:29], s[92:93]
    v_pk_mul_f32 v[30:31], v[30:31], s[92:93]
    v_cvt_pk_bf16_f32 v236, v24, v25
    v_cvt_pk_bf16_f32 v237, v26, v27
    v_cvt_pk_bf16_f32 v238, v28, v29
    v_cvt_pk_bf16_f32 v239, v30, v31
    v_pk_mul_f32 v[128:129], v[128:129], s[92:93]
    v_pk_mul_f32 v[130:131], v[130:131], s[92:93]
    v_pk_mul_f32 v[132:133], v[132:133], s[92:93]
    v_pk_mul_f32 v[134:135], v[134:135], s[92:93]
    v_cvt_pk_bf16_f32 v128, v128, v129
    v_cvt_pk_bf16_f32 v129, v130, v131
    v_cvt_pk_bf16_f32 v130, v132, v133
    v_cvt_pk_bf16_f32 v131, v134, v135
    buffer_store_dwordx4 v[128:131], v2, s[8:11], s90 offen sc1
    s_add_u32 s90, s90, s100
    v_accvgpr_write_b32 a96, 0
    v_accvgpr_write_b32 a97, 0
    v_accvgpr_write_b32 a98, 0
    v_accvgpr_write_b32 a99, 0
    v_accvgpr_write_b32 a100, 0
    v_accvgpr_write_b32 a101, 0
    v_accvgpr_write_b32 a102, 0
    v_accvgpr_write_b32 a103, 0
    v_pk_mul_f32 v[160:161], v[160:161], s[92:93]
    v_pk_mul_f32 v[162:163], v[162:163], s[92:93]
    v_pk_mul_f32 v[164:165], v[164:165], s[92:93]
    v_pk_mul_f32 v[166:167], v[166:167], s[92:93]
    v_cvt_pk_bf16_f32 v240, v160, v161
    v_cvt_pk_bf16_f32 v241, v162, v163
    v_cvt_pk_bf16_f32 v242, v164, v165
    v_cvt_pk_bf16_f32 v243, v166, v167
    v_pk_mul_f32 v[136:137], v[136:137], s[92:93]
    v_pk_mul_f32 v[138:139], v[138:139], s[92:93]
    v_pk_mul_f32 v[140:141], v[140:141], s[92:93]
    v_pk_mul_f32 v[142:143], v[142:143], s[92:93]
    v_cvt_pk_bf16_f32 v136, v136, v137
    v_cvt_pk_bf16_f32 v137, v138, v139
    v_cvt_pk_bf16_f32 v138, v140, v141
    v_cvt_pk_bf16_f32 v139, v142, v143
    buffer_store_dwordx4 v[136:139], v2, s[8:11], s90 offen sc1
    s_add_u32 s90, s90, s100
    v_accvgpr_write_b32 a104, 0
    v_accvgpr_write_b32 a105, 0
    v_accvgpr_write_b32 a106, 0
    v_accvgpr_write_b32 a107, 0
    v_accvgpr_write_b32 a108, 0
    v_accvgpr_write_b32 a109, 0
    v_accvgpr_write_b32 a110, 0
    v_accvgpr_write_b32 a111, 0
    v_pk_mul_f32 v[168:169], v[168:169], s[92:93]
    v_pk_mul_f32 v[170:171], v[170:171], s[92:93]
    v_pk_mul_f32 v[172:173], v[172:173], s[92:93]
    v_pk_mul_f32 v[174:175], v[174:175], s[92:93]
    v_cvt_pk_bf16_f32 v244, v168, v169
    v_cvt_pk_bf16_f32 v245, v170, v171
    v_cvt_pk_bf16_f32 v246, v172, v173
    v_cvt_pk_bf16_f32 v247, v174, v175
    v_pk_mul_f32 v[144:145], v[144:145], s[92:93]
    v_pk_mul_f32 v[146:147], v[146:147], s[92:93]
    v_pk_mul_f32 v[148:149], v[148:149], s[92:93]
    v_pk_mul_f32 v[150:151], v[150:151], s[92:93]
    v_cvt_pk_bf16_f32 v144, v144, v145
    v_cvt_pk_bf16_f32 v145, v146, v147
    v_cvt_pk_bf16_f32 v146, v148, v149
    v_cvt_pk_bf16_f32 v147, v150, v151
    buffer_store_dwordx4 v[144:147], v2, s[8:11], s90 offen sc1
    s_add_u32 s90, s90, s100
    v_accvgpr_write_b32 a112, 0
    v_accvgpr_write_b32 a113, 0
    v_accvgpr_write_b32 a114, 0
    v_accvgpr_write_b32 a115, 0
    v_accvgpr_write_b32 a116, 0
    v_accvgpr_write_b32 a117, 0
    v_accvgpr_write_b32 a118, 0
    v_accvgpr_write_b32 a119, 0
    v_pk_mul_f32 v[176:177], v[176:177], s[92:93]
    v_pk_mul_f32 v[178:179], v[178:179], s[92:93]
    v_pk_mul_f32 v[180:181], v[180:181], s[92:93]
    v_pk_mul_f32 v[182:183], v[182:183], s[92:93]
    v_cvt_pk_bf16_f32 v248, v176, v177
    v_cvt_pk_bf16_f32 v249, v178, v179
    v_cvt_pk_bf16_f32 v250, v180, v181
    v_cvt_pk_bf16_f32 v251, v182, v183
    v_pk_mul_f32 v[152:153], v[152:153], s[92:93]
    v_pk_mul_f32 v[154:155], v[154:155], s[92:93]
    v_pk_mul_f32 v[156:157], v[156:157], s[92:93]
    v_pk_mul_f32 v[158:159], v[158:159], s[92:93]
    v_cvt_pk_bf16_f32 v152, v152, v153
    v_cvt_pk_bf16_f32 v153, v154, v155
    v_cvt_pk_bf16_f32 v154, v156, v157
    v_cvt_pk_bf16_f32 v155, v158, v159
    buffer_store_dwordx4 v[152:155], v2, s[8:11], s90 offen sc1
    s_add_u32 s90, s90, s100
    v_accvgpr_write_b32 a120, 0
    v_accvgpr_write_b32 a121, 0
    v_accvgpr_write_b32 a122, 0
    v_accvgpr_write_b32 a123, 0
    v_accvgpr_write_b32 a124, 0
    v_accvgpr_write_b32 a125, 0
    v_accvgpr_write_b32 a126, 0
    v_accvgpr_write_b32 a127, 0
    v_pk_mul_f32 v[184:185], v[184:185], s[92:93]
    v_pk_mul_f32 v[186:187], v[186:187], s[92:93]
    v_pk_mul_f32 v[188:189], v[188:189], s[92:93]
    v_pk_mul_f32 v[190:191], v[190:191], s[92:93]
    v_cvt_pk_bf16_f32 v252, v184, v185
    v_cvt_pk_bf16_f32 v253, v186, v187
    v_cvt_pk_bf16_f32 v254, v188, v189
    v_cvt_pk_bf16_f32 v255, v190, v191
    s_branch m_epl85_r
m_ns286:
    s_mov_b32 s90, s98
    v_cvt_pk_bf16_f32 v32, v32, v33
    v_cvt_pk_bf16_f32 v33, v34, v35
    v_cvt_pk_bf16_f32 v34, v36, v37
    v_cvt_pk_bf16_f32 v35, v38, v39
    buffer_store_dwordx4 v[32:35], v2, s[8:11], s90 offen sc1
    s_add_u32 s90, s90, s100
    v_accvgpr_write_b32 a0, 0
    v_accvgpr_write_b32 a1, 0
    v_accvgpr_write_b32 a2, 0
    v_accvgpr_write_b32 a3, 0
    v_accvgpr_write_b32 a4, 0
    v_accvgpr_write_b32 a5, 0
    v_accvgpr_write_b32 a6, 0
    v_accvgpr_write_b32 a7, 0
    v_cvt_pk_bf16_f32 v192, v192, v193
    v_cvt_pk_bf16_f32 v193, v194, v195
    v_cvt_pk_bf16_f32 v194, v196, v197
    v_cvt_pk_bf16_f32 v195, v198, v199
    v_cvt_pk_bf16_f32 v40, v40, v41
    v_cvt_pk_bf16_f32 v41, v42, v43
    v_cvt_pk_bf16_f32 v42, v44, v45
    v_cvt_pk_bf16_f32 v43, v46, v47
    buffer_store_dwordx4 v[40:43], v2, s[8:11], s90 offen sc1
    s_add_u32 s90, s90, s100
    v_accvgpr_write_b32 a8, 0
    v_accvgpr_write_b32 a9, 0
    v_accvgpr_write_b32 a10, 0
    v_accvgpr_write_b32 a11, 0
    v_accvgpr_write_b32 a12, 0
    v_accvgpr_write_b32 a13, 0
    v_accvgpr_write_b32 a14, 0
    v_accvgpr_write_b32 a15, 0
    v_cvt_pk_bf16_f32 v196, v200, v201
    v_cvt_pk_bf16_f32 v197, v202, v203
    v_cvt_pk_bf16_f32 v198, v204, v205
    v_cvt_pk_bf16_f32 v199, v206, v207
    v_cvt_pk_bf16_f32 v48, v48, v49
    v_cvt_pk_bf16_f32 v49, v50, v51
    v_cvt_pk_bf16_f32 v50, v52, v53
    v_cvt_pk_bf16_f32 v51, v54, v55
    buffer_store_dwordx4 v[48:51], v2, s[8:11], s90 offen sc1
    s_add_u32 s90, s90, s100
    v_accvgpr_write_b32 a16, 0
    v_accvgpr_write_b32 a17, 0
    v_accvgpr_write_b32 a18, 0
    v_accvgpr_write_b32 a19, 0
    v_accvgpr_write_b32 a20, 0
    v_accvgpr_write_b32 a21, 0
    v_accvgpr_write_b32 a22, 0
    v_accvgpr_write_b32 a23, 0
    v_cvt_pk_bf16_f32 v200, v208, v209
    v_cvt_pk_bf16_f32 v201, v210, v211
    v_cvt_pk_bf16_f32 v202, v212, v213
    v_cvt_pk_bf16_f32 v203, v214, v215
    v_cvt_pk_bf16_f32 v56, v56, v57
    v_cvt_pk_bf16_f32 v57, v58, v59
    v_cvt_pk_bf16_f32 v58, v60, v61
    v_cvt_pk_bf16_f32 v59, v62, v63
    buffer_store_dwordx4 v[56:59], v2, s[8:11], s90 offen sc1
    s_add_u32 s90, s90, s100
    v_accvgpr_write_b32 a24, 0
    v_accvgpr_write_b32 a25, 0
    v_accvgpr_write_b32 a26, 0
    v_accvgpr_write_b32 a27, 0
    v_accvgpr_write_b32 a28, 0
    v_accvgpr_write_b32 a29, 0
    v_accvgpr_write_b32 a30, 0
    v_accvgpr_write_b32 a31, 0
    v_cvt_pk_bf16_f32 v204, v216, v217
    v_cvt_pk_bf16_f32 v205, v218, v219
    v_cvt_pk_bf16_f32 v206, v220, v221
    v_cvt_pk_bf16_f32 v207, v222, v223
    v_cvt_pk_bf16_f32 v64, v64, v65
    v_cvt_pk_bf16_f32 v65, v66, v67
    v_cvt_pk_bf16_f32 v66, v68, v69
    v_cvt_pk_bf16_f32 v67, v70, v71
    buffer_store_dwordx4 v[64:67], v2, s[8:11], s90 offen sc1
    s_add_u32 s90, s90, s100
    v_accvgpr_write_b32 a32, 0
    v_accvgpr_write_b32 a33, 0
    v_accvgpr_write_b32 a34, 0
    v_accvgpr_write_b32 a35, 0
    v_accvgpr_write_b32 a36, 0
    v_accvgpr_write_b32 a37, 0
    v_accvgpr_write_b32 a38, 0
    v_accvgpr_write_b32 a39, 0
    v_cvt_pk_bf16_f32 v208, v224, v225
    v_cvt_pk_bf16_f32 v209, v226, v227
    v_cvt_pk_bf16_f32 v210, v228, v229
    v_cvt_pk_bf16_f32 v211, v230, v231
    v_cvt_pk_bf16_f32 v72, v72, v73
    v_cvt_pk_bf16_f32 v73, v74, v75
    v_cvt_pk_bf16_f32 v74, v76, v77
    v_cvt_pk_bf16_f32 v75, v78, v79
    buffer_store_dwordx4 v[72:75], v2, s[8:11], s90 offen sc1
    s_add_u32 s90, s90, s100
    v_accvgpr_write_b32 a40, 0
    v_accvgpr_write_b32 a41, 0
    v_accvgpr_write_b32 a42, 0
    v_accvgpr_write_b32 a43, 0
    v_accvgpr_write_b32 a44, 0
    v_accvgpr_write_b32 a45, 0
    v_accvgpr_write_b32 a46, 0
    v_accvgpr_write_b32 a47, 0
    v_cvt_pk_bf16_f32 v212, v232, v233
    v_cvt_pk_bf16_f32 v213, v234, v235
    v_cvt_pk_bf16_f32 v214, v236, v237
    v_cvt_pk_bf16_f32 v215, v238, v239
    v_cvt_pk_bf16_f32 v80, v80, v81
    v_cvt_pk_bf16_f32 v81, v82, v83
    v_cvt_pk_bf16_f32 v82, v84, v85
    v_cvt_pk_bf16_f32 v83, v86, v87
    buffer_store_dwordx4 v[80:83], v2, s[8:11], s90 offen sc1
    s_add_u32 s90, s90, s100
    v_accvgpr_write_b32 a48, 0
    v_accvgpr_write_b32 a49, 0
    v_accvgpr_write_b32 a50, 0
    v_accvgpr_write_b32 a51, 0
    v_accvgpr_write_b32 a52, 0
    v_accvgpr_write_b32 a53, 0
    v_accvgpr_write_b32 a54, 0
    v_accvgpr_write_b32 a55, 0
    v_cvt_pk_bf16_f32 v216, v240, v241
    v_cvt_pk_bf16_f32 v217, v242, v243
    v_cvt_pk_bf16_f32 v218, v244, v245
    v_cvt_pk_bf16_f32 v219, v246, v247
    v_cvt_pk_bf16_f32 v88, v88, v89
    v_cvt_pk_bf16_f32 v89, v90, v91
    v_cvt_pk_bf16_f32 v90, v92, v93
    v_cvt_pk_bf16_f32 v91, v94, v95
    buffer_store_dwordx4 v[88:91], v2, s[8:11], s90 offen sc1
    s_add_u32 s90, s98, s99
    v_accvgpr_write_b32 a56, 0
    v_accvgpr_write_b32 a57, 0
    v_accvgpr_write_b32 a58, 0
    v_accvgpr_write_b32 a59, 0
    v_accvgpr_write_b32 a60, 0
    v_accvgpr_write_b32 a61, 0
    v_accvgpr_write_b32 a62, 0
    v_accvgpr_write_b32 a63, 0
    v_cvt_pk_bf16_f32 v220, v248, v249
    v_cvt_pk_bf16_f32 v221, v250, v251
    v_cvt_pk_bf16_f32 v222, v252, v253
    v_cvt_pk_bf16_f32 v223, v254, v255
    v_cvt_pk_bf16_f32 v96, v96, v97
    v_cvt_pk_bf16_f32 v97, v98, v99
    v_cvt_pk_bf16_f32 v98, v100, v101
    v_cvt_pk_bf16_f32 v99, v102, v103
    buffer_store_dwordx4 v[96:99], v2, s[8:11], s90 offen sc1
    s_add_u32 s90, s90, s100
    v_accvgpr_write_b32 a64, 0
    v_accvgpr_write_b32 a65, 0
    v_accvgpr_write_b32 a66, 0
    v_accvgpr_write_b32 a67, 0
    v_accvgpr_write_b32 a68, 0
    v_accvgpr_write_b32 a69, 0
    v_accvgpr_write_b32 a70, 0
    v_accvgpr_write_b32 a71, 0
    v_accvgpr_read_b32 v24, a224
    v_accvgpr_read_b32 v25, a225
    v_accvgpr_read_b32 v26, a226
    v_accvgpr_read_b32 v27, a227
    v_accvgpr_read_b32 v28, a228
    v_accvgpr_read_b32 v29, a229
    v_accvgpr_read_b32 v30, a230
    v_accvgpr_read_b32 v31, a231
    v_cvt_pk_bf16_f32 v224, v24, v25
    v_cvt_pk_bf16_f32 v225, v26, v27
    v_cvt_pk_bf16_f32 v226, v28, v29
    v_cvt_pk_bf16_f32 v227, v30, v31
    v_cvt_pk_bf16_f32 v104, v104, v105
    v_cvt_pk_bf16_f32 v105, v106, v107
    v_cvt_pk_bf16_f32 v106, v108, v109
    v_cvt_pk_bf16_f32 v107, v110, v111
    buffer_store_dwordx4 v[104:107], v2, s[8:11], s90 offen sc1
    s_add_u32 s90, s90, s100
    v_accvgpr_write_b32 a72, 0
    v_accvgpr_write_b32 a73, 0
    v_accvgpr_write_b32 a74, 0
    v_accvgpr_write_b32 a75, 0
    v_accvgpr_write_b32 a76, 0
    v_accvgpr_write_b32 a77, 0
    v_accvgpr_write_b32 a78, 0
    v_accvgpr_write_b32 a79, 0
    v_accvgpr_read_b32 v24, a232
    v_accvgpr_read_b32 v25, a233
    v_accvgpr_read_b32 v26, a234
    v_accvgpr_read_b32 v27, a235
    v_accvgpr_read_b32 v28, a236
    v_accvgpr_read_b32 v29, a237
    v_accvgpr_read_b32 v30, a238
    v_accvgpr_read_b32 v31, a239
    v_cvt_pk_bf16_f32 v228, v24, v25
    v_cvt_pk_bf16_f32 v229, v26, v27
    v_cvt_pk_bf16_f32 v230, v28, v29
    v_cvt_pk_bf16_f32 v231, v30, v31
    v_cvt_pk_bf16_f32 v112, v112, v113
    v_cvt_pk_bf16_f32 v113, v114, v115
    v_cvt_pk_bf16_f32 v114, v116, v117
    v_cvt_pk_bf16_f32 v115, v118, v119
    buffer_store_dwordx4 v[112:115], v2, s[8:11], s90 offen sc1
    s_add_u32 s90, s90, s100
    v_accvgpr_write_b32 a80, 0
    v_accvgpr_write_b32 a81, 0
    v_accvgpr_write_b32 a82, 0
    v_accvgpr_write_b32 a83, 0
    v_accvgpr_write_b32 a84, 0
    v_accvgpr_write_b32 a85, 0
    v_accvgpr_write_b32 a86, 0
    v_accvgpr_write_b32 a87, 0
    v_accvgpr_read_b32 v24, a240
    v_accvgpr_read_b32 v25, a241
    v_accvgpr_read_b32 v26, a242
    v_accvgpr_read_b32 v27, a243
    v_accvgpr_read_b32 v28, a244
    v_accvgpr_read_b32 v29, a245
    v_accvgpr_read_b32 v30, a246
    v_accvgpr_read_b32 v31, a247
    v_cvt_pk_bf16_f32 v232, v24, v25
    v_cvt_pk_bf16_f32 v233, v26, v27
    v_cvt_pk_bf16_f32 v234, v28, v29
    v_cvt_pk_bf16_f32 v235, v30, v31
    v_cvt_pk_bf16_f32 v120, v120, v121
    v_cvt_pk_bf16_f32 v121, v122, v123
    v_cvt_pk_bf16_f32 v122, v124, v125
    v_cvt_pk_bf16_f32 v123, v126, v127
    buffer_store_dwordx4 v[120:123], v2, s[8:11], s90 offen sc1
    s_add_u32 s90, s90, s100
    v_accvgpr_write_b32 a88, 0
    v_accvgpr_write_b32 a89, 0
    v_accvgpr_write_b32 a90, 0
    v_accvgpr_write_b32 a91, 0
    v_accvgpr_write_b32 a92, 0
    v_accvgpr_write_b32 a93, 0
    v_accvgpr_write_b32 a94, 0
    v_accvgpr_write_b32 a95, 0
    v_accvgpr_read_b32 v24, a248
    v_accvgpr_read_b32 v25, a249
    v_accvgpr_read_b32 v26, a250
    v_accvgpr_read_b32 v27, a251
    v_accvgpr_read_b32 v28, a252
    v_accvgpr_read_b32 v29, a253
    v_accvgpr_read_b32 v30, a254
    v_accvgpr_read_b32 v31, a255
    v_cvt_pk_bf16_f32 v236, v24, v25
    v_cvt_pk_bf16_f32 v237, v26, v27
    v_cvt_pk_bf16_f32 v238, v28, v29
    v_cvt_pk_bf16_f32 v239, v30, v31
    v_cvt_pk_bf16_f32 v128, v128, v129
    v_cvt_pk_bf16_f32 v129, v130, v131
    v_cvt_pk_bf16_f32 v130, v132, v133
    v_cvt_pk_bf16_f32 v131, v134, v135
    buffer_store_dwordx4 v[128:131], v2, s[8:11], s90 offen sc1
    s_add_u32 s90, s90, s100
    v_accvgpr_write_b32 a96, 0
    v_accvgpr_write_b32 a97, 0
    v_accvgpr_write_b32 a98, 0
    v_accvgpr_write_b32 a99, 0
    v_accvgpr_write_b32 a100, 0
    v_accvgpr_write_b32 a101, 0
    v_accvgpr_write_b32 a102, 0
    v_accvgpr_write_b32 a103, 0
    v_cvt_pk_bf16_f32 v240, v160, v161
    v_cvt_pk_bf16_f32 v241, v162, v163
    v_cvt_pk_bf16_f32 v242, v164, v165
    v_cvt_pk_bf16_f32 v243, v166, v167
    v_cvt_pk_bf16_f32 v136, v136, v137
    v_cvt_pk_bf16_f32 v137, v138, v139
    v_cvt_pk_bf16_f32 v138, v140, v141
    v_cvt_pk_bf16_f32 v139, v142, v143
    buffer_store_dwordx4 v[136:139], v2, s[8:11], s90 offen sc1
    s_add_u32 s90, s90, s100
    v_accvgpr_write_b32 a104, 0
    v_accvgpr_write_b32 a105, 0
    v_accvgpr_write_b32 a106, 0
    v_accvgpr_write_b32 a107, 0
    v_accvgpr_write_b32 a108, 0
    v_accvgpr_write_b32 a109, 0
    v_accvgpr_write_b32 a110, 0
    v_accvgpr_write_b32 a111, 0
    v_cvt_pk_bf16_f32 v244, v168, v169
    v_cvt_pk_bf16_f32 v245, v170, v171
    v_cvt_pk_bf16_f32 v246, v172, v173
    v_cvt_pk_bf16_f32 v247, v174, v175
    v_cvt_pk_bf16_f32 v144, v144, v145
    v_cvt_pk_bf16_f32 v145, v146, v147
    v_cvt_pk_bf16_f32 v146, v148, v149
    v_cvt_pk_bf16_f32 v147, v150, v151
    buffer_store_dwordx4 v[144:147], v2, s[8:11], s90 offen sc1
    s_add_u32 s90, s90, s100
    v_accvgpr_write_b32 a112, 0
    v_accvgpr_write_b32 a113, 0
    v_accvgpr_write_b32 a114, 0
    v_accvgpr_write_b32 a115, 0
    v_accvgpr_write_b32 a116, 0
    v_accvgpr_write_b32 a117, 0
    v_accvgpr_write_b32 a118, 0
    v_accvgpr_write_b32 a119, 0
    v_cvt_pk_bf16_f32 v248, v176, v177
    v_cvt_pk_bf16_f32 v249, v178, v179
    v_cvt_pk_bf16_f32 v250, v180, v181
    v_cvt_pk_bf16_f32 v251, v182, v183
    v_cvt_pk_bf16_f32 v152, v152, v153
    v_cvt_pk_bf16_f32 v153, v154, v155
    v_cvt_pk_bf16_f32 v154, v156, v157
    v_cvt_pk_bf16_f32 v155, v158, v159
    buffer_store_dwordx4 v[152:155], v2, s[8:11], s90 offen sc1
    s_add_u32 s90, s90, s100
    v_accvgpr_write_b32 a120, 0
    v_accvgpr_write_b32 a121, 0
    v_accvgpr_write_b32 a122, 0
    v_accvgpr_write_b32 a123, 0
    v_accvgpr_write_b32 a124, 0
    v_accvgpr_write_b32 a125, 0
    v_accvgpr_write_b32 a126, 0
    v_accvgpr_write_b32 a127, 0
    v_cvt_pk_bf16_f32 v252, v184, v185
    v_cvt_pk_bf16_f32 v253, v186, v187
    v_cvt_pk_bf16_f32 v254, v188, v189
    v_cvt_pk_bf16_f32 v255, v190, v191
m_epl85_r:
    s_mov_b32 s17, s101
    s_mov_b32 s38, 268435456
m_init31:
    s_mov_b32 s36, s6
    s_mov_b32 s37, s7
    s_mov_b32 s39, 0x20000
    s_lshl_b32 s90, s99, 1
    s_add_u32 s98, s98, s90
    s_lshl_b32 s90, s100, 2
    s_add_u32 s40, s98, s90
    s_waitcnt vmcnt(32)
    s_waitcnt lgkmcnt(0)
    v_mfma_f32_16x16x32_bf16 v[64:67], a[192:195], a[128:131], 0
    s_and_b32 s92, s2, 7
    s_lshl_b32 s92, s92, 2
    s_bfe_u32 s93, s2, 0x20003
    s_add_u32 s92, s92, s93
    v_mfma_f32_16x16x32_bf16 v[64:67], a[196:199], a[132:135], v[64:67]
    buffer_store_dwordx4 v[192:195], v2, s[36:39], s40 offen sc1
    s_add_u32 s40, s40, s100
    s_lshr_b32 s93, s2, 5
    v_mfma_f32_16x16x32_bf16 v[64:67], a[200:203], a[136:139], v[64:67]
    s_lshl_b32 s93, s93, 2
    s_or_b32 s93, s93, 0x40000
    s_mov_b32 s32, s92
    s_bfe_u32 s33, 4225674377, s93
    v_mfma_f32_16x16x32_bf16 v[64:67], a[204:207], a[140:143], v[64:67]
    s_add_u32 s33, s33, 1
    s_bfe_u32 s34, 873484918, s93
    s_add_u32 s34, s34, 1
    s_lshl_b32 s60, s16, 12
    v_mfma_f32_16x16x32_bf16 v[72:75], a[204:207], a[156:159], 0
    v_add_u32 v7, s60, v2
    s_lshl_b32 s90, s34, 2
    s_lshl_b32 s91, s33, 2
    s_lshl_b32 s26, s91, 13
    v_mfma_f32_16x16x32_bf16 v[72:75], a[200:203], a[152:155], v[72:75]
    buffer_store_dwordx4 v[196:199], v2, s[36:39], s40 offen sc1
    s_add_u32 s40, s40, s100
    s_mov_b32 s30, s26
    v_mfma_f32_16x16x32_bf16 v[72:75], a[196:199], a[148:151], v[72:75]
    s_sub_u32 s67, s90, 4
    s_add_u32 s67, s67, s16
    s_add_u32 s68, s67, 1
    s_mov_b32 s69, s90
    v_mfma_f32_16x16x32_bf16 v[72:75], a[192:195], a[144:147], v[72:75]
    s_sub_u32 s70, s91, 4
    s_add_u32 s70, s70, s16
    s_add_u32 s71, s70, 1
    s_mov_b32 s72, s91
    v_mfma_f32_16x16x32_bf16 v[80:83], a[192:195], a[160:163], 0
    s_cmp_lt_u32 s16, 2
    s_cselect_b32 s90, 2, 0
    s_sub_u32 s72, s72, s90
    s_mov_b32 s27, 0x20000
    v_mfma_f32_16x16x32_bf16 v[80:83], a[196:199], a[164:167], v[80:83]
    buffer_store_dwordx4 v[200:203], v2, s[36:39], s40 offen sc1
    s_add_u32 s40, s40, s100
    s_mov_b32 s31, 0x20000
    v_mfma_f32_16x16x32_bf16 v[80:83], a[200:203], a[168:171], v[80:83]
    s_lshl_b32 s82, s32, 19
    s_add_u32 s90, s82, 16777216
    s_add_u32 s24, s6, s90
    s_addc_u32 s25, s7, 0
    v_mfma_f32_16x16x32_bf16 v[80:83], a[204:207], a[172:175], v[80:83]
    s_add_u32 s90, s82, 33554432
    s_add_u32 s28, s6, s90
    s_addc_u32 s29, s7, 0
    s_mov_b32 s56, 81920
    v_mfma_f32_16x16x32_bf16 v[88:91], a[204:207], a[188:191], 0
    s_mov_b32 s57, 65536
    v_mov_b32 v9, 0xff800000
    s_mov_b32 s65, 1233125376
    s_lshl_b32 s91, s16, 1
    v_mfma_f32_16x16x32_bf16 v[88:91], a[200:203], a[184:187], v[88:91]
    buffer_store_dwordx4 v[204:207], v2, s[36:39], s40 offen sc1
    s_add_u32 s40, s98, s99
    s_sub_u32 s91, s91, 8
    v_mfma_f32_16x16x32_bf16 v[88:91], a[196:199], a[180:183], v[88:91]
    s_lshl_b32 s78, s33, 3
    s_add_u32 s78, s78, s91
    s_lshl_b32 s79, s34, 3
    s_add_u32 s79, s79, s91
    v_mfma_f32_16x16x32_bf16 v[88:91], a[192:195], a[176:179], v[88:91]
    s_lshr_b32 s90, s32, 1
    s_lshl_b32 s90, s90, 7
    s_add_u32 s90, s90, 117444608
    s_lshr_b32 s91, s2, 6
    v_mfma_f32_16x16x32_bf16 v[92:95], a[208:211], a[176:179], 0
    ds_read_b128 a[192:195], v6 offset:8192
    s_lshl_b32 s91, s91, 8
    s_add_u32 s91, s91, 117446592
    v_min_u32 v10, 31, v1
    v_mfma_f32_16x16x32_bf16 v[92:95], a[212:215], a[180:183], v[92:95]
    buffer_store_dwordx4 v[208:211], v2, s[36:39], s40 offen sc1
    s_add_u32 s40, s40, s100
    ds_read_b128 a[196:199], v6 offset:9216
    v_mfma_f32_16x16x32_bf16 v[92:95], a[216:219], a[184:187], v[92:95]
    ds_read_b128 a[200:203], v6 offset:10240
    v_lshlrev_b32 v10, 3, v10
    v_mov_b32 v11, s90
    v_mov_b32 v8, s91
    v_mfma_f32_16x16x32_bf16 v[92:95], a[220:223], a[188:191], v[92:95]
    ds_read_b128 a[204:207], v6 offset:11264
    v_cmp_gt_u32 vcc, 8, v1
    s_nop 1
    v_cndmask_b32 v11, v8, v11, vcc
    v_mfma_f32_16x16x32_bf16 v[84:87], a[220:223], a[172:175], 0
    v_add_u32 v10, v10, v11
    s_mov_b32 s58, 0
    v_mov_b32 v12, 0
    v_mov_b32 v28, 0
    v_mfma_f32_16x16x32_bf16 v[84:87], a[216:219], a[168:171], v[84:87]
    buffer_store_dwordx4 v[212:215], v2, s[36:39], s40 offen sc1
    s_add_u32 s40, s40, s100
    v_mov_b32 v44, 0x3f803f80
    v_mfma_f32_16x16x32_bf16 v[84:87], a[212:215], a[164:167], v[84:87]
    v_mov_b32 v13, 0
    v_mov_b32 v32, 0
    v_mov_b32 v45, 0x3f803f80
    v_mov_b32 v14, 0
    v_mfma_f32_16x16x32_bf16 v[84:87], a[208:211], a[160:163], v[84:87]
    v_mov_b32 v36, 0
    v_mov_b32 v46, 0x3f803f80
    v_mov_b32 v15, 0
    v_mov_b32 v40, 0
    v_mfma_f32_16x16x32_bf16 v[76:79], a[208:211], a[144:147], 0
    v_mov_b32 v47, 0x3f803f80
    s_and_b32 s90, s2, 7
    s_lshl_b32 s90, s90, 4
    s_lshl_b32 s91, s16, 2
    v_mfma_f32_16x16x32_bf16 v[76:79], a[212:215], a[148:151], v[76:79]
    buffer_store_dwordx4 v[216:219], v2, s[36:39], s40 offen sc1
    s_add_u32 s40, s40, s100
    s_add_u32 s80, s90, s91
    v_mfma_f32_16x16x32_bf16 v[76:79], a[216:219], a[152:155], v[76:79]
    s_lshr_b32 s92, s2, 3
    s_lshl_b32 s92, s92, 17
    s_lshl_b32 s90, s80, 10
    s_add_u32 s90, s90, s92
    v_mfma_f32_16x16x32_bf16 v[76:79], a[220:223], a[156:159], v[76:79]
    s_add_u32 s83, s90, 50331648
    s_add_u32 s84, s90, 54525952
    s_and_b32 s81, s80, 63
    s_cmp_eq_u32 s81, 0
    s_cselect_b32 s93, 0, 1024
    v_mfma_f32_16x16x32_bf16 v[68:71], a[220:223], a[140:143], 0
    s_sub_u32 s85, s84, s93
    s_lshl_b32 s90, s80, 9
    s_add_u32 s90, s90, s92
    s_add_u32 s86, s90, 58720256
    v_mfma_f32_16x16x32_bf16 v[68:71], a[216:219], a[136:139], v[68:71]
    buffer_store_dwordx4 v[220:223], v2, s[36:39], s40 offen sc1
    s_add_u32 s40, s40, s100
    s_sub_u32 s87, s86, s93
    v_mfma_f32_16x16x32_bf16 v[68:71], a[212:215], a[132:135], v[68:71]
    s_add_u32 s88, s86, 65536
    s_add_u32 s89, s87, 65536
    v_and_b32 v48, 15, v1
    v_lshrrev_b32 v49, 4, v1
    v_mfma_f32_16x16x32_bf16 v[68:71], a[208:211], a[128:131], v[68:71]
    v_lshlrev_b32 v49, 2, v49
    v_sub_u32 v48, v48, v49
    v_cmp_le_i32 vcc, 0, v48
    s_nop 1
    v_cndmask_b32 v16, v9, 0, vcc
    ds_read_b128 a[208:211], v6 offset:12288
    ds_read_b128 a[212:215], v6 offset:13312
    ds_read_b128 a[216:219], v6 offset:14336
    ds_read_b128 a[220:223], v6 offset:15360
    v_cmp_le_i32 vcc, 1, v48
    s_nop 1
    v_cndmask_b32 v17, v9, 0, vcc
    v_cmp_le_i32 vcc, 2, v48
    s_nop 1
    v_cndmask_b32 v18, v9, 0, vcc
    v_cmp_le_i32 vcc, 3, v48
    s_nop 1
    v_cndmask_b32 v19, v9, 0, vcc
    s_mov_b32 s62, 8945792
    s_mov_b32 s63, 0
    s_sub_u32 s90, s67, 1
    s_bitset1_b64 s[62:63], s90
    s_sub_u32 s90, s68, 1
    s_bitset1_b64 s[62:63], s90
    s_sub_u32 s90, s69, 1
    s_bitset1_b64 s[62:63], s90
    s_sub_u32 s90, s70, 1
    s_bitset1_b64 s[62:63], s90
    s_sub_u32 s90, s71, 1
    s_bitset1_b64 s[62:63], s90
    s_sub_u32 s90, s72, 1
    s_bitset1_b64 s[62:63], s90
    s_add_u32 s53, s69, 8
    s_sub_u32 s90, s53, 1
    s_bitset1_b64 s[62:63], s90
    s_mov_b32 s64, 1
    s_nop 3
    s_cmp_lg_u32 s67, 0
    s_cbranch_scc1 m_z91
    v_add_f32 v80, v80, v16
    v_mov_b32 v84, v9
    v_add_f32 v92, v92, v16
    v_add_f32 v81, v81, v17
    v_mov_b32 v85, v9
    v_add_f32 v93, v93, v17
    v_add_f32 v82, v82, v18
    v_mov_b32 v86, v9
    v_add_f32 v94, v94, v18
    v_add_f32 v83, v83, v19
    v_mov_b32 v87, v9
    v_add_f32 v95, v95, v19
m_z91:
    v_max3_f32 v48, v64, v65, v66
    v_max3_f32 v49, v72, v73, v74
    v_max3_f32 v50, v80, v81, v82
    v_max3_f32 v51, v88, v89, v90
    v_max3_f32 v48, v48, v67, v68
    v_max3_f32 v49, v49, v75, v76
    v_max3_f32 v50, v50, v83, v84
    v_max3_f32 v51, v51, v91, v92
    v_max3_f32 v48, v48, v69, v70
    v_max3_f32 v49, v49, v77, v78
    v_max3_f32 v50, v50, v85, v86
    v_max3_f32 v51, v51, v93, v94
    v_max_f32 v48, v48, v71
    v_max_f32 v49, v49, v79
    v_max_f32 v50, v50, v87
    v_max_f32 v51, v51, v95
    v_mov_b32 v52, v48
    v_mov_b32 v53, v49
    v_mov_b32 v54, v50
    v_mov_b32 v55, v51
    s_nop 1
    v_permlane32_swap_b32 v48, v52
    v_permlane32_swap_b32 v49, v53
    v_permlane32_swap_b32 v50, v54
    v_permlane32_swap_b32 v51, v55
    s_nop 1
    v_max_f32 v48, v48, v52
    v_max_f32 v49, v49, v53
    v_max_f32 v50, v50, v54
    v_max_f32 v51, v51, v55
    v_mov_b32 v52, v48
    v_mov_b32 v53, v49
    v_mov_b32 v54, v50
    v_mov_b32 v55, v51
    s_nop 1
    v_permlane16_swap_b32 v48, v52
    v_permlane16_swap_b32 v49, v53
    v_permlane16_swap_b32 v50, v54
    v_permlane16_swap_b32 v51, v55
    s_nop 1
    v_max_f32 v48, v48, v52
    v_max_f32 v49, v49, v53
    v_max_f32 v50, v50, v54
    v_max_f32 v51, v51, v55
    v_sub_f32 v160, 0, v48
    v_sub_f32 v161, 0, v48
    v_sub_f32 v168, 0, v49
    v_sub_f32 v169, 0, v49
    v_sub_f32 v176, 0, v50
    v_sub_f32 v177, 0, v50
    v_sub_f32 v184, 0, v51
    v_sub_f32 v185, 0, v51
    v_mov_b64 v[162:163], v[160:161]
    v_mov_b64 v[164:165], v[160:161]
    v_mov_b64 v[166:167], v[160:161]
    v_mov_b64 v[170:171], v[168:169]
    v_mov_b64 v[172:173], v[168:169]
    v_mov_b64 v[174:175], v[168:169]
    v_mov_b64 v[178:179], v[176:177]
    v_mov_b64 v[180:181], v[176:177]
    v_mov_b64 v[182:183], v[176:177]
    v_mov_b64 v[186:187], v[184:185]
    v_mov_b64 v[188:189], v[184:185]
    v_mov_b64 v[190:191], v[184:185]
    v_pk_add_f32 v[64:65], v[64:65], v[160:161]
    v_pk_add_f32 v[66:67], v[66:67], v[160:161]
    v_pk_add_f32 v[68:69], v[68:69], v[160:161]
    v_pk_add_f32 v[70:71], v[70:71], v[160:161]
    v_pk_add_f32 v[72:73], v[72:73], v[168:169]
    v_pk_add_f32 v[74:75], v[74:75], v[168:169]
    v_pk_add_f32 v[76:77], v[76:77], v[168:169]
    v_pk_add_f32 v[78:79], v[78:79], v[168:169]
    v_pk_add_f32 v[80:81], v[80:81], v[176:177]
    v_pk_add_f32 v[82:83], v[82:83], v[176:177]
    v_pk_add_f32 v[84:85], v[84:85], v[176:177]
    v_pk_add_f32 v[86:87], v[86:87], v[176:177]
    v_pk_add_f32 v[88:89], v[88:89], v[184:185]
    v_pk_add_f32 v[90:91], v[90:91], v[184:185]
    v_pk_add_f32 v[92:93], v[92:93], v[184:185]
    v_pk_add_f32 v[94:95], v[94:95], v[184:185]
    s_cmp_lg_u32 s64, s67
    s_cbranch_scc1 m_e92
    v_add_f32 v176, v176, v16
    v_mov_b32 v180, v9
    v_add_f32 v188, v188, v16
    v_add_f32 v177, v177, v17
    v_mov_b32 v181, v9
    v_add_f32 v189, v189, v17
    v_add_f32 v178, v178, v18
    v_mov_b32 v182, v9
    v_add_f32 v190, v190, v18
    v_add_f32 v179, v179, v19
    v_mov_b32 v183, v9
    v_add_f32 v191, v191, v19
    s_nop 0
m_e92:
    s_cmp_lg_u32 s64, s68
    s_cbranch_scc1 m_e93
    v_mov_b32 v176, v9
    v_mov_b32 v184, v9
    v_mov_b32 v188, v9
    v_mov_b32 v180, v9
    v_mov_b32 v177, v9
    v_mov_b32 v185, v9
    v_mov_b32 v189, v9
    v_mov_b32 v181, v9
    v_mov_b32 v178, v9
    v_mov_b32 v186, v9
    v_mov_b32 v190, v9
    v_mov_b32 v182, v9
    v_mov_b32 v179, v9
    v_mov_b32 v187, v9
    v_mov_b32 v191, v9
    v_mov_b32 v183, v9
    s_nop 0
m_e93:
    s_waitcnt lgkmcnt(0)
    v_mfma_f32_16x16x32_bf16 v[96:99], a[192:195], a[128:131], v[160:163]
    s_bitcmp1_b64 s[62:63], s64
    s_cselect_b32 s66, -1.0, s65
    v_exp_f32 v20, v64
    v_mfma_f32_16x16x32_bf16 v[96:99], a[196:199], a[132:135], v[96:99]
    s_add_u32 s64, s64, 1
    v_exp_f32 v21, v65
    v_exp_f32 v22, v66
    v_mfma_f32_16x16x32_bf16 v[96:99], a[200:203], a[136:139], v[96:99]
    buffer_store_dwordx4 v[224:227], v2, s[36:39], s40 offen sc1
    v_cvt_pk_bf16_f32 v128, v20, v21
    v_mfma_f32_16x16x32_bf16 v[96:99], a[204:207], a[140:143], v[96:99]
    s_add_u32 s40, s40, s100
    v_add_f32 v12, v12, v28
    v_exp_f32 v23, v67
    v_mfma_f32_16x16x32_bf16 v[104:107], a[204:207], a[156:159], v[168:171]
    v_exp_f32 v24, v68
    v_cvt_pk_bf16_f32 v129, v22, v23
    v_mfma_f32_16x16x32_bf16 v[104:107], a[200:203], a[152:155], v[104:107]
    buffer_store_dwordx4 v[228:231], v2, s[36:39], s40 offen sc1
    v_exp_f32 v25, v69
    v_mfma_f32_16x16x32_bf16 v[104:107], a[196:199], a[148:151], v[104:107]
    s_add_u32 s40, s40, s100
    v_exp_f32 v26, v70
    v_cvt_pk_bf16_f32 v130, v24, v25
    v_mfma_f32_16x16x32_bf16 v[104:107], a[192:195], a[144:147], v[104:107]
    v_exp_f32 v27, v71
    v_add_f32 v13, v13, v32
    v_mfma_f32_16x16x32_bf16 v[112:115], a[192:195], a[160:163], v[176:179]
    v_exp_f32 v20, v72
    v_cvt_pk_bf16_f32 v131, v26, v27
    v_mfma_f32_16x16x32_bf16 v[112:115], a[196:199], a[164:167], v[112:115]
    buffer_store_dwordx4 v[232:235], v2, s[36:39], s40 offen sc1
    v_exp_f32 v21, v73
    v_mfma_f32_16x16x32_bf16 v[28:31], v[44:47], v[128:131], 0
    v_exp_f32 v22, v74
    v_cvt_pk_bf16_f32 v132, v20, v21
    v_mfma_f32_16x16x32_bf16 v[112:115], a[200:203], a[168:171], v[112:115]
    s_add_u32 s40, s40, s100
    v_exp_f32 v23, v75
    v_add_f32 v14, v14, v36
    v_mfma_f32_16x16x32_bf16 v[112:115], a[204:207], a[172:175], v[112:115]
    v_exp_f32 v24, v76
    v_cvt_pk_bf16_f32 v133, v22, v23
    v_mfma_f32_16x16x32_bf16 v[120:123], a[204:207], a[188:191], v[184:187]
    buffer_store_dwordx4 v[236:239], v2, s[36:39], s40 offen sc1
    v_exp_f32 v25, v77
    v_mfma_f32_16x16x32_bf16 v[120:123], a[200:203], a[184:187], v[120:123]
    s_mov_b32 s40, s98
    v_exp_f32 v26, v78
    v_cvt_pk_bf16_f32 v134, v24, v25
    v_mfma_f32_16x16x32_bf16 v[120:123], a[196:199], a[180:183], v[120:123]
    v_exp_f32 v27, v79
    v_add_f32 v15, v15, v40
    v_mfma_f32_16x16x32_bf16 v[120:123], a[192:195], a[176:179], v[120:123]
    s_waitcnt lgkmcnt(0)
    v_exp_f32 v20, v80
    v_cvt_pk_bf16_f32 v135, v26, v27
    v_mfma_f32_16x16x32_bf16 v[124:127], a[208:211], a[176:179], v[188:191]
    v_exp_f32 v21, v81
    v_exp_f32 v22, v82
    v_mfma_f32_16x16x32_bf16 v[32:35], v[44:47], v[132:135], 0
    v_cvt_pk_bf16_f32 v136, v20, v21
    v_exp_f32 v23, v83
    v_mfma_f32_16x16x32_bf16 v[124:127], a[212:215], a[180:183], v[124:127]
    buffer_store_dwordx4 v[240:243], v2, s[36:39], s40 offen sc1
    v_cvt_pk_bf16_f32 v137, v22, v23
    v_mfma_f32_16x16x32_bf16 v[124:127], a[216:219], a[184:187], v[124:127]
    s_add_u32 s40, s40, s100
    v_exp_f32 v24, v84
    v_mfma_f32_16x16x32_bf16 v[124:127], a[220:223], a[188:191], v[124:127]
    v_exp_f32 v25, v85
    v_exp_f32 v26, v86
    v_cvt_pk_bf16_f32 v138, v24, v25
    v_mfma_f32_16x16x32_bf16 v[116:119], a[220:223], a[172:175], v[180:183]
    buffer_store_dwordx4 v[244:247], v2, s[36:39], s40 offen sc1
    v_mfma_f32_16x16x32_bf16 v[116:119], a[216:219], a[168:171], v[116:119]
    s_add_u32 s40, s40, s100
    v_exp_f32 v27, v87
    v_exp_f32 v20, v88
    v_mfma_f32_16x16x32_bf16 v[116:119], a[212:215], a[164:167], v[116:119]
    v_cvt_pk_bf16_f32 v139, v26, v27
    v_exp_f32 v21, v89
    v_mfma_f32_16x16x32_bf16 v[116:119], a[208:211], a[160:163], v[116:119]
    buffer_store_dwordx4 v[248:251], v2, s[36:39], s40 offen sc1
    v_exp_f32 v22, v90
    v_mfma_f32_16x16x32_bf16 v[36:39], v[44:47], v[136:139], 0
    v_cvt_pk_bf16_f32 v140, v20, v21
    v_exp_f32 v23, v91
    v_mfma_f32_16x16x32_bf16 v[108:111], a[208:211], a[144:147], v[172:175]
    s_add_u32 s40, s40, s100
    v_exp_f32 v24, v92
    v_cvt_pk_bf16_f32 v141, v22, v23
    v_mfma_f32_16x16x32_bf16 v[108:111], a[212:215], a[148:151], v[108:111]
    v_exp_f32 v25, v93
    v_mfma_f32_16x16x32_bf16 v[108:111], a[216:219], a[152:155], v[108:111]
    buffer_store_dwordx4 v[252:255], v2, s[36:39], s40 offen sc1
    v_exp_f32 v26, v94
    v_cvt_pk_bf16_f32 v142, v24, v25
    v_mfma_f32_16x16x32_bf16 v[108:111], a[220:223], a[156:159], v[108:111]
    s_add_u32 s40, s40, s100
    v_exp_f32 v27, v95
    s_nop 0
    v_cvt_pk_bf16_f32 v143, v26, v27
    s_nop 1
    v_mfma_f32_16x16x32_bf16 v[40:43], v[44:47], v[140:143], 0
    s_nop 2
    v_mfma_f32_16x16x32_bf16 v[100:103], a[220:223], a[140:143], v[164:167]
    s_nop 2
    v_mfma_f32_16x16x32_bf16 v[100:103], a[216:219], a[136:139], v[100:103]
    v_max3_f32 v8, v28, v32, v36
    v_max_f32 v8, v8, v40
    v_mfma_f32_16x16x32_bf16 v[100:103], a[212:215], a[132:135], v[100:103]
    v_cmp_nge_f32 vcc, s66, v8
    v_mfma_f32_16x16x32_bf16 v[100:103], a[208:211], a[128:131], v[100:103]
    s_waitcnt vmcnt(48) lgkmcnt(0)
    s_barrier
    s_add_u32 s59, s58, s60
    s_add_u32 s58, s58, 32768
    s_cmp_ge_u32 s58, 163840
    s_cselect_b32 s58, 0, s58
    v_add_u32 v6, s58, v2
    ds_read_b128 a[192:195], v6 offset:0
    ds_read_b128 a[196:199], v6 offset:1024
    ds_read_b128 a[200:203], v6 offset:2048
    ds_read_b128 a[204:207], v6 offset:3072
    ds_read_b128 a[208:211], v6 offset:4096
    ds_read_b128 a[212:215], v6 offset:5120
    ds_read_b128 a[216:219], v6 offset:6144
    ds_read_b128 a[220:223], v6 offset:7168
    s_waitcnt lgkmcnt(0)
    s_cbranch_vccnz m_stub94
m_ret95:
.p2align 3
m_dual96:
    v_mfma_f32_16x16x32_bf16 v[64:67], a[192:195], a[128:131], v[160:163]
    s_bitcmp1_b64 s[62:63], s64
    s_cselect_b32 s66, -1.0, s65
    v_add_f32 v12, v12, v28
    v_mfma_f32_16x16x32_bf16 v[64:67], a[196:199], a[132:135], v[64:67]
    s_add_u32 s64, s64, 1
    ds_read_b128 a[224:227], v6 offset:16384
    v_add_f32 v13, v13, v32
    v_mfma_f32_16x16x32_bf16 v[64:67], a[200:203], a[136:139], v[64:67]
    v_exp_f32 v20, v96
    v_mfma_f32_16x16x32_bf16 v[64:67], a[204:207], a[140:143], v[64:67]
    v_exp_f32 v21, v97
    v_mfma_f32_16x16x32_bf16 v[72:75], a[204:207], a[156:159], v[168:171]
    s_mov_b32 m0, s59
    ds_read_b128 a[228:231], v6 offset:17408
    v_cvt_pk_bf16_f32 v144, v20, v21
    v_mfma_f32_16x16x32_bf16 v[72:75], a[200:203], a[152:155], v[72:75]
    buffer_load_dwordx4 v7, s[24:27], s56 offen offset:0 sc1 lds
    v_mfma_f32_16x16x32_bf16 v[72:75], a[196:199], a[148:151], v[72:75]
    v_exp_f32 v22, v98
    v_mfma_f32_16x16x32_bf16 v[72:75], a[192:195], a[144:147], v[72:75]
    ds_read_b128 a[232:235], v6 offset:18432
    v_add_f32 v14, v14, v36
    v_mfma_f32_16x16x32_bf16 v[80:83], a[192:195], a[160:163], v[176:179]
    v_exp_f32 v23, v99
    v_mfma_f32_16x16x32_bf16 v[80:83], a[196:199], a[164:167], v[80:83]
    v_exp_f32 v24, v100
    v_mfma_f32_16x16x32_bf16 v[80:83], a[200:203], a[168:171], v[80:83]
    ds_read_b128 a[236:239], v6 offset:19456
    v_cvt_pk_bf16_f32 v145, v22, v23
    v_mfma_f32_16x16x32_bf16 v[80:83], a[204:207], a[172:175], v[80:83]
    v_exp_f32 v25, v101
    v_mfma_f32_16x16x32_bf16 v[88:91], a[204:207], a[188:191], v[184:187]
    v_exp_f32 v26, v102
    v_mfma_f32_16x16x32_bf16 v[88:91], a[200:203], a[184:187], v[88:91]
    ds_read_b128 a[240:243], v6 offset:20480
    v_cvt_pk_bf16_f32 v146, v24, v25
    v_mfma_f32_16x16x32_bf16 v[88:91], a[196:199], a[180:183], v[88:91]
    v_exp_f32 v27, v103
    v_mfma_f32_16x16x32_bf16 v[88:91], a[192:195], a[176:179], v[88:91]
    s_waitcnt lgkmcnt(5)
    v_exp_f32 v20, v104
    v_mfma_f32_16x16x32_bf16 v[92:95], a[208:211], a[176:179], v[188:191]
    ds_read_b128 a[244:247], v6 offset:21504
    v_cvt_pk_bf16_f32 v147, v26, v27
    v_mfma_f32_16x16x32_bf16 v[92:95], a[212:215], a[180:183], v[92:95]
    v_exp_f32 v21, v105
    v_mfma_f32_16x16x32_bf16 v[28:31], v[44:47], v[144:147], 0
    v_exp_f32 v22, v106
    v_mfma_f32_16x16x32_bf16 v[92:95], a[216:219], a[184:187], v[92:95]
    buffer_load_dwordx4 v7, s[24:27], s56 offen offset:1024 sc1 lds
    v_mfma_f32_16x16x32_bf16 v[92:95], a[220:223], a[188:191], v[92:95]
    ds_read_b128 a[248:251], v6 offset:22528
    v_cvt_pk_bf16_f32 v148, v20, v21
    v_mfma_f32_16x16x32_bf16 v[84:87], a[220:223], a[172:175], v[180:183]
    v_exp_f32 v23, v107
    v_mfma_f32_16x16x32_bf16 v[84:87], a[216:219], a[168:171], v[84:87]
    v_exp_f32 v24, v108
    v_mfma_f32_16x16x32_bf16 v[84:87], a[212:215], a[164:167], v[84:87]
    ds_read_b128 a[252:255], v6 offset:23552
    v_cvt_pk_bf16_f32 v149, v22, v23
    v_mfma_f32_16x16x32_bf16 v[84:87], a[208:211], a[160:163], v[84:87]
    v_exp_f32 v25, v109
    v_mfma_f32_16x16x32_bf16 v[76:79], a[208:211], a[144:147], v[172:175]
    v_exp_f32 v26, v110
    v_mfma_f32_16x16x32_bf16 v[76:79], a[212:215], a[148:151], v[76:79]
    v_cvt_pk_bf16_f32 v150, v24, v25
    v_add_f32 v15, v15, v40
    v_mfma_f32_16x16x32_bf16 v[76:79], a[216:219], a[152:155], v[76:79]
    v_exp_f32 v27, v111
    v_mfma_f32_16x16x32_bf16 v[76:79], a[220:223], a[156:159], v[76:79]
    buffer_load_dwordx4 v7, s[24:27], s56 offen offset:2048 sc1 lds
    v_mfma_f32_16x16x32_bf16 v[68:71], a[220:223], a[140:143], v[164:167]
    v_exp_f32 v20, v112
    v_mfma_f32_16x16x32_bf16 v[68:71], a[216:219], a[136:139], v[68:71]
    v_cvt_pk_bf16_f32 v151, v26, v27
    v_mfma_f32_16x16x32_bf16 v[68:71], a[212:215], a[132:135], v[68:71]
    v_exp_f32 v21, v113
    v_mfma_f32_16x16x32_bf16 v[32:35], v[44:47], v[148:151], 0
    v_exp_f32 v22, v114
    v_mfma_f32_16x16x32_bf16 v[68:71], a[208:211], a[128:131], v[68:71]
    s_waitcnt lgkmcnt(0)
    v_cvt_pk_bf16_f32 v152, v20, v21
    v_mfma_f32_16x16x32_bf16 a[0:3], a[224:227], v[128:131], a[0:3]
    ds_read_b128 a[192:195], v6 offset:8192
    v_mfma_f32_16x16x32_bf16 a[32:35], a[224:227], v[132:135], a[32:35]
    v_exp_f32 v23, v115
    v_mfma_f32_16x16x32_bf16 a[64:67], a[224:227], v[136:139], a[64:67]
    v_exp_f32 v24, v116
    v_mfma_f32_16x16x32_bf16 a[96:99], a[224:227], v[140:143], a[96:99]
    ds_read_b128 a[196:199], v6 offset:9216
    v_cvt_pk_bf16_f32 v153, v22, v23
    v_mfma_f32_16x16x32_bf16 a[100:103], a[228:231], v[140:143], a[100:103]
    v_exp_f32 v25, v117
    v_mfma_f32_16x16x32_bf16 a[68:71], a[228:231], v[136:139], a[68:71]
    v_exp_f32 v26, v118
    v_mfma_f32_16x16x32_bf16 a[36:39], a[228:231], v[132:135], a[36:39]
    ds_read_b128 a[200:203], v6 offset:10240
    v_cvt_pk_bf16_f32 v154, v24, v25
    v_mfma_f32_16x16x32_bf16 a[4:7], a[228:231], v[128:131], a[4:7]
    v_exp_f32 v27, v119
    v_mfma_f32_16x16x32_bf16 a[8:11], a[232:235], v[128:131], a[8:11]
    v_exp_f32 v20, v120
    v_mfma_f32_16x16x32_bf16 a[40:43], a[232:235], v[132:135], a[40:43]
    ds_read_b128 a[204:207], v6 offset:11264
    v_cvt_pk_bf16_f32 v155, v26, v27
    v_mfma_f32_16x16x32_bf16 a[72:75], a[232:235], v[136:139], a[72:75]
    v_exp_f32 v21, v121
    v_mfma_f32_16x16x32_bf16 v[36:39], v[44:47], v[152:155], 0
    v_exp_f32 v22, v122
    v_mfma_f32_16x16x32_bf16 a[104:107], a[232:235], v[140:143], a[104:107]
    buffer_load_dwordx4 v7, s[24:27], s56 offen offset:3072 sc1 lds
    v_mfma_f32_16x16x32_bf16 a[108:111], a[236:239], v[140:143], a[108:111]
    s_add_u32 s56, s56, 16384
    v_cvt_pk_bf16_f32 v156, v20, v21
    v_mfma_f32_16x16x32_bf16 a[76:79], a[236:239], v[136:139], a[76:79]
    v_exp_f32 v23, v123
    v_mfma_f32_16x16x32_bf16 a[44:47], a[236:239], v[132:135], a[44:47]
    v_exp_f32 v24, v124
    v_mfma_f32_16x16x32_bf16 a[12:15], a[236:239], v[128:131], a[12:15]
    v_cvt_pk_bf16_f32 v157, v22, v23
    v_mfma_f32_16x16x32_bf16 a[16:19], a[240:243], v[128:131], a[16:19]
    v_exp_f32 v25, v125
    v_mfma_f32_16x16x32_bf16 a[48:51], a[240:243], v[132:135], a[48:51]
    v_exp_f32 v26, v126
    v_mfma_f32_16x16x32_bf16 a[80:83], a[240:243], v[136:139], a[80:83]
    v_cvt_pk_bf16_f32 v158, v24, v25
    v_mfma_f32_16x16x32_bf16 a[112:115], a[240:243], v[140:143], a[112:115]
    s_add_u32 m0, s59, 16384
    v_exp_f32 v27, v127
    v_mfma_f32_16x16x32_bf16 a[116:119], a[244:247], v[140:143], a[116:119]
    buffer_load_dwordx4 v7, s[28:31], s57 offen offset:0 sc1 lds
    v_mfma_f32_16x16x32_bf16 a[84:87], a[244:247], v[136:139], a[84:87]
    v_cvt_pk_bf16_f32 v159, v26, v27
    v_mfma_f32_16x16x32_bf16 a[52:55], a[244:247], v[132:135], a[52:55]
    v_mfma_f32_16x16x32_bf16 a[20:23], a[244:247], v[128:131], a[20:23]
    v_mfma_f32_16x16x32_bf16 v[40:43], v[44:47], v[156:159], 0
    s_nop 2
    v_mfma_f32_16x16x32_bf16 a[24:27], a[248:251], v[128:131], a[24:27]
    s_nop 2
    v_mfma_f32_16x16x32_bf16 a[56:59], a[248:251], v[132:135], a[56:59]
    v_max3_f32 v8, v28, v32, v36
    v_max_f32 v8, v8, v40
    v_mfma_f32_16x16x32_bf16 a[88:91], a[248:251], v[136:139], a[88:91]
    v_cmp_nge_f32 vcc, s66, v8
    v_mfma_f32_16x16x32_bf16 a[120:123], a[248:251], v[140:143], a[120:123]
    ds_read_b128 a[208:211], v6 offset:12288
    v_mfma_f32_16x16x32_bf16 a[124:127], a[252:255], v[140:143], a[124:127]
    ds_read_b128 a[212:215], v6 offset:13312
    v_mfma_f32_16x16x32_bf16 a[92:95], a[252:255], v[136:139], a[92:95]
    ds_read_b128 a[216:219], v6 offset:14336
    v_mfma_f32_16x16x32_bf16 a[60:63], a[252:255], v[132:135], a[60:63]
    ds_read_b128 a[220:223], v6 offset:15360
    v_mfma_f32_16x16x32_bf16 a[28:31], a[252:255], v[128:131], a[28:31]
    s_waitcnt lgkmcnt(4)
    s_cbranch_vccnz m_stub97
m_ret98:
    v_mfma_f32_16x16x32_bf16 v[96:99], a[192:195], a[128:131], v[160:163]
    s_add_u32 s59, s58, s60
    v_exp_f32 v20, v64
    v_mfma_f32_16x16x32_bf16 v[96:99], a[196:199], a[132:135], v[96:99]
    s_add_u32 s58, s58, 32768
    ds_read_b128 a[224:227], v6 offset:24576
    v_add_f32 v12, v12, v28
    v_mfma_f32_16x16x32_bf16 v[96:99], a[200:203], a[136:139], v[96:99]
    s_cmp_ge_u32 s58, 163840
    s_cselect_b32 s58, 0, s58
    v_exp_f32 v21, v65
    v_mfma_f32_16x16x32_bf16 v[96:99], a[204:207], a[140:143], v[96:99]
    s_bitcmp1_b64 s[62:63], s64
    s_cselect_b32 s66, -1.0, s65
    v_cvt_pk_bf16_f32 v128, v20, v21
    v_mfma_f32_16x16x32_bf16 v[104:107], a[204:207], a[156:159], v[168:171]
    s_add_u32 s64, s64, 1
    ds_read_b128 a[228:231], v6 offset:25600
    v_add_f32 v13, v13, v32
    v_mfma_f32_16x16x32_bf16 v[104:107], a[200:203], a[152:155], v[104:107]
    v_exp_f32 v22, v66
    v_mfma_f32_16x16x32_bf16 v[104:107], a[196:199], a[148:151], v[104:107]
    buffer_load_dwordx4 v7, s[28:31], s57 offen offset:1024 sc1 lds
    v_mfma_f32_16x16x32_bf16 v[104:107], a[192:195], a[144:147], v[104:107]
    ds_read_b128 a[232:235], v6 offset:26624
    v_add_f32 v14, v14, v36
    v_mfma_f32_16x16x32_bf16 v[112:115], a[192:195], a[160:163], v[176:179]
    v_exp_f32 v23, v67
    v_mfma_f32_16x16x32_bf16 v[112:115], a[196:199], a[164:167], v[112:115]
    v_exp_f32 v24, v68
    v_mfma_f32_16x16x32_bf16 v[112:115], a[200:203], a[168:171], v[112:115]
    ds_read_b128 a[236:239], v6 offset:27648
    v_cvt_pk_bf16_f32 v129, v22, v23
    v_mfma_f32_16x16x32_bf16 v[112:115], a[204:207], a[172:175], v[112:115]
    v_exp_f32 v25, v69
    v_mfma_f32_16x16x32_bf16 v[120:123], a[204:207], a[188:191], v[184:187]
    v_exp_f32 v26, v70
    v_mfma_f32_16x16x32_bf16 v[120:123], a[200:203], a[184:187], v[120:123]
    ds_read_b128 a[240:243], v6 offset:28672
    v_cvt_pk_bf16_f32 v130, v24, v25
    v_mfma_f32_16x16x32_bf16 v[120:123], a[196:199], a[180:183], v[120:123]
    v_exp_f32 v27, v71
    v_mfma_f32_16x16x32_bf16 v[120:123], a[192:195], a[176:179], v[120:123]
    s_waitcnt lgkmcnt(5)
    v_exp_f32 v20, v72
    v_mfma_f32_16x16x32_bf16 v[124:127], a[208:211], a[176:179], v[188:191]
    ds_read_b128 a[244:247], v6 offset:29696
    v_cvt_pk_bf16_f32 v131, v26, v27
    v_mfma_f32_16x16x32_bf16 v[124:127], a[212:215], a[180:183], v[124:127]
    v_exp_f32 v21, v73
    v_mfma_f32_16x16x32_bf16 v[28:31], v[44:47], v[128:131], 0
    v_exp_f32 v22, v74
    v_mfma_f32_16x16x32_bf16 v[124:127], a[216:219], a[184:187], v[124:127]
    buffer_load_dwordx4 v7, s[28:31], s57 offen offset:2048 sc1 lds
    v_mfma_f32_16x16x32_bf16 v[124:127], a[220:223], a[188:191], v[124:127]
    ds_read_b128 a[248:251], v6 offset:30720
    v_cvt_pk_bf16_f32 v132, v20, v21
    v_mfma_f32_16x16x32_bf16 v[116:119], a[220:223], a[172:175], v[180:183]
    v_exp_f32 v23, v75
    v_mfma_f32_16x16x32_bf16 v[116:119], a[216:219], a[168:171], v[116:119]
    v_exp_f32 v24, v76
    v_mfma_f32_16x16x32_bf16 v[116:119], a[212:215], a[164:167], v[116:119]
    ds_read_b128 a[252:255], v6 offset:31744
    v_cvt_pk_bf16_f32 v133, v22, v23
    v_mfma_f32_16x16x32_bf16 v[116:119], a[208:211], a[160:163], v[116:119]
    v_exp_f32 v25, v77
    v_mfma_f32_16x16x32_bf16 v[108:111], a[208:211], a[144:147], v[172:175]
    v_exp_f32 v26, v78
    v_mfma_f32_16x16x32_bf16 v[108:111], a[212:215], a[148:151], v[108:111]
    v_cvt_pk_bf16_f32 v134, v24, v25
    v_add_f32 v15, v15, v40
    v_mfma_f32_16x16x32_bf16 v[108:111], a[216:219], a[152:155], v[108:111]
    v_exp_f32 v27, v79
    v_mfma_f32_16x16x32_bf16 v[108:111], a[220:223], a[156:159], v[108:111]
    buffer_load_dwordx4 v7, s[28:31], s57 offen offset:3072 sc1 lds
    v_mfma_f32_16x16x32_bf16 v[100:103], a[220:223], a[140:143], v[164:167]
    s_add_u32 s57, s57, 16384
    v_exp_f32 v20, v80
    v_mfma_f32_16x16x32_bf16 v[100:103], a[216:219], a[136:139], v[100:103]
    v_cvt_pk_bf16_f32 v135, v26, v27
    v_mfma_f32_16x16x32_bf16 v[100:103], a[212:215], a[132:135], v[100:103]
    v_exp_f32 v21, v81
    v_mfma_f32_16x16x32_bf16 v[32:35], v[44:47], v[132:135], 0
    v_exp_f32 v22, v82
    v_mfma_f32_16x16x32_bf16 v[100:103], a[208:211], a[128:131], v[100:103]
    s_waitcnt vmcnt(24) lgkmcnt(0)
    v_add_u32 v6, s58, v2
    v_cvt_pk_bf16_f32 v136, v20, v21
    v_mfma_f32_16x16x32_bf16 a[0:3], a[224:227], v[144:147], a[0:3]
    s_barrier
    v_mfma_f32_16x16x32_bf16 a[32:35], a[224:227], v[148:151], a[32:35]
    ds_read_b128 a[192:195], v6 offset:0
    v_mfma_f32_16x16x32_bf16 a[64:67], a[224:227], v[152:155], a[64:67]
    v_exp_f32 v23, v83
    v_mfma_f32_16x16x32_bf16 a[96:99], a[224:227], v[156:159], a[96:99]
    v_exp_f32 v24, v84
    v_mfma_f32_16x16x32_bf16 a[100:103], a[228:231], v[156:159], a[100:103]
    ds_read_b128 a[196:199], v6 offset:1024
    v_cvt_pk_bf16_f32 v137, v22, v23
    v_mfma_f32_16x16x32_bf16 a[68:71], a[228:231], v[152:155], a[68:71]
    v_exp_f32 v25, v85
    v_mfma_f32_16x16x32_bf16 a[36:39], a[228:231], v[148:151], a[36:39]
    v_exp_f32 v26, v86
    v_mfma_f32_16x16x32_bf16 a[4:7], a[228:231], v[144:147], a[4:7]
    ds_read_b128 a[200:203], v6 offset:2048
    v_cvt_pk_bf16_f32 v138, v24, v25
    v_mfma_f32_16x16x32_bf16 a[8:11], a[232:235], v[144:147], a[8:11]
    v_exp_f32 v27, v87
    v_mfma_f32_16x16x32_bf16 a[40:43], a[232:235], v[148:151], a[40:43]
    v_exp_f32 v20, v88
    v_mfma_f32_16x16x32_bf16 a[72:75], a[232:235], v[152:155], a[72:75]
    ds_read_b128 a[204:207], v6 offset:3072
    v_cvt_pk_bf16_f32 v139, v26, v27
    v_mfma_f32_16x16x32_bf16 a[104:107], a[232:235], v[156:159], a[104:107]
    v_exp_f32 v21, v89
    v_mfma_f32_16x16x32_bf16 v[36:39], v[44:47], v[136:139], 0
    v_exp_f32 v22, v90
    v_mfma_f32_16x16x32_bf16 a[108:111], a[236:239], v[156:159], a[108:111]
    v_cvt_pk_bf16_f32 v140, v20, v21
    v_mfma_f32_16x16x32_bf16 a[76:79], a[236:239], v[152:155], a[76:79]
    v_exp_f32 v23, v91
    v_mfma_f32_16x16x32_bf16 a[44:47], a[236:239], v[148:151], a[44:47]
    v_exp_f32 v24, v92
    v_mfma_f32_16x16x32_bf16 a[12:15], a[236:239], v[144:147], a[12:15]
    v_cvt_pk_bf16_f32 v141, v22, v23
    v_mfma_f32_16x16x32_bf16 a[16:19], a[240:243], v[144:147], a[16:19]
    v_exp_f32 v25, v93
    v_mfma_f32_16x16x32_bf16 a[48:51], a[240:243], v[148:151], a[48:51]
    v_exp_f32 v26, v94
    v_mfma_f32_16x16x32_bf16 a[80:83], a[240:243], v[152:155], a[80:83]
    v_cvt_pk_bf16_f32 v142, v24, v25
    v_mfma_f32_16x16x32_bf16 a[112:115], a[240:243], v[156:159], a[112:115]
    v_exp_f32 v27, v95
    v_mfma_f32_16x16x32_bf16 a[116:119], a[244:247], v[156:159], a[116:119]
    v_cvt_pk_bf16_f32 v143, v26, v27
    v_mfma_f32_16x16x32_bf16 a[84:87], a[244:247], v[152:155], a[84:87]
    v_mfma_f32_16x16x32_bf16 a[52:55], a[244:247], v[148:151], a[52:55]
    v_mfma_f32_16x16x32_bf16 v[40:43], v[44:47], v[140:143], 0
    s_nop 2
    v_mfma_f32_16x16x32_bf16 a[20:23], a[244:247], v[144:147], a[20:23]
    s_nop 2
    v_mfma_f32_16x16x32_bf16 a[24:27], a[248:251], v[144:147], a[24:27]
    v_max3_f32 v8, v28, v32, v36
    v_max_f32 v8, v8, v40
    v_mfma_f32_16x16x32_bf16 a[56:59], a[248:251], v[148:151], a[56:59]
    v_cmp_nge_f32 vcc, s66, v8
    v_mfma_f32_16x16x32_bf16 a[88:91], a[248:251], v[152:155], a[88:91]
    v_mfma_f32_16x16x32_bf16 a[120:123], a[248:251], v[156:159], a[120:123]
    ds_read_b128 a[208:211], v6 offset:4096
    v_mfma_f32_16x16x32_bf16 a[124:127], a[252:255], v[156:159], a[124:127]
    ds_read_b128 a[212:215], v6 offset:5120
    v_mfma_f32_16x16x32_bf16 a[92:95], a[252:255], v[152:155], a[92:95]
    ds_read_b128 a[216:219], v6 offset:6144
    v_mfma_f32_16x16x32_bf16 a[60:63], a[252:255], v[148:151], a[60:63]
    ds_read_b128 a[220:223], v6 offset:7168
    v_mfma_f32_16x16x32_bf16 a[28:31], a[252:255], v[144:147], a[28:31]
    s_waitcnt lgkmcnt(4)
    s_cbranch_vccz m_dual96
    v_cmp_lt_f32 vcc, s65, v8
    s_cmp_lg_u32 s64, s67
    s_cbranch_scc1 m_e100
    v_add_f32 v176, v176, v16
    v_mov_b32 v180, v9
    v_add_f32 v188, v188, v16
    v_add_f32 v177, v177, v17
    v_mov_b32 v181, v9
    v_add_f32 v189, v189, v17
    v_add_f32 v178, v178, v18
    v_mov_b32 v182, v9
    v_add_f32 v190, v190, v18
    v_add_f32 v179, v179, v19
    v_mov_b32 v183, v9
    v_add_f32 v191, v191, v19
    s_nop 0
m_e100:
    s_cmp_lg_u32 s64, s68
    s_cbranch_scc1 m_e101
    v_mov_b32 v176, v9
    v_mov_b32 v184, v9
    v_mov_b32 v188, v9
    v_mov_b32 v180, v9
    v_mov_b32 v177, v9
    v_mov_b32 v185, v9
    v_mov_b32 v189, v9
    v_mov_b32 v181, v9
    v_mov_b32 v178, v9
    v_mov_b32 v186, v9
    v_mov_b32 v190, v9
    v_mov_b32 v182, v9
    v_mov_b32 v179, v9
    v_mov_b32 v187, v9
    v_mov_b32 v191, v9
    v_mov_b32 v183, v9
    s_nop 0
m_e101:
    s_cmp_lg_u32 s64, s70
    s_cbranch_scc1 m_e102
    v_add_f32 v160, v160, v16
    v_mov_b32 v164, v9
    v_add_f32 v172, v172, v16
    v_add_f32 v161, v161, v17
    v_mov_b32 v165, v9
    v_add_f32 v173, v173, v17
    v_add_f32 v162, v162, v18
    v_mov_b32 v166, v9
    v_add_f32 v174, v174, v18
    v_add_f32 v163, v163, v19
    v_mov_b32 v167, v9
    v_add_f32 v175, v175, v19
    s_nop 0
m_e102:
    s_cmp_lg_u32 s64, s53
    s_cbranch_scc1 m_e105
    s_cmp_lg_u32 s16, 0
    s_cbranch_scc1 m_np106
    v_mov_b32 v60, s4
    v_mov_b32 v61, s5
    s_add_u32 s90, s101, 117440512
    s_mov_b64 exec, 1
    buffer_store_dwordx2 v[60:61], off, s[8:11], s90 sc1
    s_mov_b64 exec, -1
m_np106:
    s_mov_b32 s101, -1
m_e105:
    s_cmp_gt_u32 s64, 24
    s_cbranch_scc1 m_e103
    s_cmp_lg_u32 s64, 8
    s_cbranch_scc1 m_e107
    s_lshr_b32 s90, s32, 1
    s_lshl_b32 s90, s90, 7
    s_add_u32 s90, s90, 117440600
    v_min_u32 v0, 1, v1
    v_lshlrev_b32 v0, 5, v0
    buffer_load_dwordx2 v[4:5], v0, s[8:11], s90 offen sc1
    s_cmp_eq_u32 s17, -1
    s_cbranch_scc1 m_e103
    s_cmp_lg_u32 s16, 0
    s_cbranch_scc1 m_np108
    v_mov_b32 v60, s4
    v_mov_b32 v61, s5
    s_add_u32 s90, s17, 117440512
    s_mov_b64 exec, 1
    buffer_store_dwordx2 v[60:61], off, s[8:11], s90 sc1
    s_mov_b64 exec, -1
m_np108:
    s_branch m_e103
m_e107:
    s_cmp_lg_u32 s64, 16
    s_cbranch_scc1 m_e109
    s_waitcnt vmcnt(18)
    s_mov_b32 s3, 1048576
m_spin110:
    v_cmp_ne_u64 s[76:77], s[4:5], v[4:5]
    s_nop 3
    s_cmp_eq_u64 s[76:77], 0
    s_cbranch_scc1 m_e103
    s_sub_u32 s3, s3, 1
    s_cbranch_scc1 m_e103
    s_sleep 32
    s_lshr_b32 s90, s32, 1
    s_lshl_b32 s90, s90, 7
    s_add_u32 s90, s90, 117440600
    v_min_u32 v0, 1, v1
    v_lshlrev_b32 v0, 5, v0
    buffer_load_dwordx2 v[4:5], v0, s[8:11], s90 offen sc1
    s_waitcnt vmcnt(0)
    s_branch m_spin110
    s_branch m_e103
m_e109:
    s_cmp_lg_u32 s64, 20
    s_cbranch_scc1 m_e111
    buffer_load_dwordx2 v[4:5], v10, s[8:11], 0 offen sc1
    s_mov_b32 s44, s48
    s_mov_b32 s45, s49
    s_mov_b32 s46, 8388608
    s_lshl_b32 s90, s2, 2
    s_add_u32 s90, s90, s16
    s_lshl_b32 s90, s90, 13
    v_lshlrev_b32 v62, 7, v1
    buffer_load_dword v255, v62, s[44:47], s90 offen
    s_branch m_e103
m_e111:
    s_cmp_lg_u32 s64, 24
    s_cbranch_scc1 m_e112
    s_mov_b32 s44, s50
    s_mov_b32 s45, s51
    s_mov_b32 s46, 2097152
    s_lshl_b32 s90, s2, 2
    s_add_u32 s90, s90, s16
    s_lshl_b32 s90, s90, 13
    v_lshlrev_b32 v62, 7, v1
    buffer_load_dword v255, v62, s[44:47], s90 offen
    s_waitcnt vmcnt(18)
    s_mov_b32 s3, 1048576
m_spin113:
    v_cmp_ne_u64 s[76:77], s[4:5], v[4:5]
    s_nop 3
    s_cmp_eq_u64 s[76:77], 0
    s_cbranch_scc1 m_e103
    s_sub_u32 s3, s3, 1
    s_cbranch_scc1 m_e103
    s_sleep 32
    buffer_load_dwordx2 v[4:5], v10, s[8:11], 0 offen sc1
    s_waitcnt vmcnt(0)
    s_branch m_spin113
    s_branch m_e103
m_e112:
m_e103:
    s_cbranch_vccnz m_rc114
m_sp99:
    s_cmp_lg_u32 s64, s69
    s_cbranch_scc1 m_dual96
    v_mfma_f32_16x16x32_bf16 v[64:67], a[192:195], a[128:131], v[160:163]
    s_bitcmp1_b64 s[62:63], s64
    s_cselect_b32 s66, -1.0, s65
    v_add_f32 v12, v12, v28
    v_mfma_f32_16x16x32_bf16 v[64:67], a[196:199], a[132:135], v[64:67]
    s_add_u32 s64, s64, 1
    ds_read_b128 a[224:227], v6 offset:16384
    v_exp_f32 v20, v96
    v_mfma_f32_16x16x32_bf16 v[64:67], a[200:203], a[136:139], v[64:67]
    s_mov_b32 m0, s59
    ds_read_b128 a[228:231], v6 offset:17408
    v_add_f32 v13, v13, v32
    v_mfma_f32_16x16x32_bf16 v[64:67], a[204:207], a[140:143], v[64:67]
    buffer_load_dwordx4 v7, s[24:27], s56 offen offset:0 sc1 lds
    v_mfma_f32_16x16x32_bf16 v[72:75], a[204:207], a[156:159], v[168:171]
    ds_read_b128 a[232:235], v6 offset:18432
    v_add_f32 v14, v14, v36
    v_mfma_f32_16x16x32_bf16 v[72:75], a[200:203], a[152:155], v[72:75]
    ds_read_b128 a[236:239], v6 offset:19456
    v_exp_f32 v21, v97
    v_mfma_f32_16x16x32_bf16 v[72:75], a[196:199], a[148:151], v[72:75]
    ds_read_b128 a[240:243], v6 offset:20480
    v_cvt_pk_bf16_f32 v144, v20, v21
    v_mfma_f32_16x16x32_bf16 v[72:75], a[192:195], a[144:147], v[72:75]
    s_waitcnt lgkmcnt(5)
    ds_read_b128 a[244:247], v6 offset:21504
    v_add_f32 v15, v15, v40
    v_mfma_f32_16x16x32_bf16 v[76:79], a[208:211], a[144:147], v[172:175]
    ds_read_b128 a[248:251], v6 offset:22528
    v_exp_f32 v22, v98
    v_mfma_f32_16x16x32_bf16 v[76:79], a[212:215], a[148:151], v[76:79]
    ds_read_b128 a[252:255], v6 offset:23552
    v_exp_f32 v23, v99
    v_mfma_f32_16x16x32_bf16 v[76:79], a[216:219], a[152:155], v[76:79]
    v_exp_f32 v24, v100
    v_mfma_f32_16x16x32_bf16 v[76:79], a[220:223], a[156:159], v[76:79]
    buffer_load_dwordx4 v7, s[24:27], s56 offen offset:1024 sc1 lds
    v_mfma_f32_16x16x32_bf16 v[68:71], a[220:223], a[140:143], v[164:167]
    v_cvt_pk_bf16_f32 v145, v22, v23
    v_exp_f32 v25, v101
    v_mfma_f32_16x16x32_bf16 v[68:71], a[216:219], a[136:139], v[68:71]
    v_exp_f32 v26, v102
    v_mfma_f32_16x16x32_bf16 v[68:71], a[212:215], a[132:135], v[68:71]
    v_cvt_pk_bf16_f32 v146, v24, v25
    v_exp_f32 v27, v103
    v_mfma_f32_16x16x32_bf16 v[68:71], a[208:211], a[128:131], v[68:71]
    s_waitcnt lgkmcnt(0)
    v_exp_f32 v20, v104
    v_mfma_f32_16x16x32_bf16 a[0:3], a[224:227], v[128:131], a[0:3]
    ds_read_b128 a[192:195], v6 offset:8192
    v_cvt_pk_bf16_f32 v147, v26, v27
    v_mfma_f32_16x16x32_bf16 a[32:35], a[224:227], v[132:135], a[32:35]
    v_exp_f32 v21, v105
    v_mfma_f32_16x16x32_bf16 v[28:31], v[44:47], v[144:147], 0
    v_exp_f32 v22, v106
    v_mfma_f32_16x16x32_bf16 a[64:67], a[224:227], v[136:139], a[64:67]
    v_cvt_pk_bf16_f32 v148, v20, v21
    v_exp_f32 v23, v107
    v_mfma_f32_16x16x32_bf16 a[96:99], a[224:227], v[140:143], a[96:99]
    ds_read_b128 a[196:199], v6 offset:9216
    v_cvt_pk_bf16_f32 v149, v22, v23
    v_mfma_f32_16x16x32_bf16 a[100:103], a[228:231], v[140:143], a[100:103]
    v_exp_f32 v24, v108
    v_mfma_f32_16x16x32_bf16 a[68:71], a[228:231], v[136:139], a[68:71]
    buffer_load_dwordx4 v7, s[24:27], s56 offen offset:2048 sc1 lds
    v_mfma_f32_16x16x32_bf16 a[36:39], a[228:231], v[132:135], a[36:39]
    ds_read_b128 a[200:203], v6 offset:10240
    v_exp_f32 v25, v109
    v_mfma_f32_16x16x32_bf16 a[4:7], a[228:231], v[128:131], a[4:7]
    v_exp_f32 v26, v110
    v_mfma_f32_16x16x32_bf16 a[8:11], a[232:235], v[128:131], a[8:11]
    v_cvt_pk_bf16_f32 v150, v24, v25
    v_exp_f32 v27, v111
    v_mfma_f32_16x16x32_bf16 a[40:43], a[232:235], v[132:135], a[40:43]
    ds_read_b128 a[204:207], v6 offset:11264
    v_cvt_pk_bf16_f32 v151, v26, v27
    v_mfma_f32_16x16x32_bf16 a[72:75], a[232:235], v[136:139], a[72:75]
    v_exp_f32 v20, v112
    v_mfma_f32_16x16x32_bf16 v[32:35], v[44:47], v[148:151], 0
    v_exp_f32 v21, v113
    v_mfma_f32_16x16x32_bf16 a[104:107], a[232:235], v[140:143], a[104:107]
    v_exp_f32 v22, v114
    v_mfma_f32_16x16x32_bf16 a[108:111], a[236:239], v[140:143], a[108:111]
    v_cvt_pk_bf16_f32 v152, v20, v21
    v_exp_f32 v23, v115
    v_mfma_f32_16x16x32_bf16 a[76:79], a[236:239], v[136:139], a[76:79]
    v_exp_f32 v24, v116
    v_mfma_f32_16x16x32_bf16 a[44:47], a[236:239], v[132:135], a[44:47]
    v_cvt_pk_bf16_f32 v153, v22, v23
    v_exp_f32 v25, v117
    v_mfma_f32_16x16x32_bf16 a[12:15], a[236:239], v[128:131], a[12:15]
    buffer_load_dwordx4 v7, s[24:27], s56 offen offset:3072 sc1 lds
    v_mfma_f32_16x16x32_bf16 a[16:19], a[240:243], v[128:131], a[16:19]
    s_add_u32 s56, s56, 16384
    v_exp_f32 v26, v118
    v_mfma_f32_16x16x32_bf16 a[48:51], a[240:243], v[132:135], a[48:51]
    v_cvt_pk_bf16_f32 v154, v24, v25
    v_exp_f32 v27, v119
    v_mfma_f32_16x16x32_bf16 a[80:83], a[240:243], v[136:139], a[80:83]
    v_exp_f32 v20, v120
    v_mfma_f32_16x16x32_bf16 a[112:115], a[240:243], v[140:143], a[112:115]
    v_cvt_pk_bf16_f32 v155, v26, v27
    v_exp_f32 v21, v121
    v_mfma_f32_16x16x32_bf16 a[116:119], a[244:247], v[140:143], a[116:119]
    v_exp_f32 v22, v122
    v_mfma_f32_16x16x32_bf16 v[36:39], v[44:47], v[152:155], 0
    v_cvt_pk_bf16_f32 v156, v20, v21
    v_mfma_f32_16x16x32_bf16 a[84:87], a[244:247], v[136:139], a[84:87]
    v_exp_f32 v23, v123
    v_mfma_f32_16x16x32_bf16 a[52:55], a[244:247], v[132:135], a[52:55]
    v_exp_f32 v24, v124
    v_cvt_pk_bf16_f32 v157, v22, v23
    v_mfma_f32_16x16x32_bf16 a[20:23], a[244:247], v[128:131], a[20:23]
    v_exp_f32 v25, v125
    v_mfma_f32_16x16x32_bf16 a[24:27], a[248:251], v[128:131], a[24:27]
    s_add_u32 m0, s59, 16384
    v_exp_f32 v26, v126
    v_mfma_f32_16x16x32_bf16 a[56:59], a[248:251], v[132:135], a[56:59]
    buffer_load_dwordx4 v7, s[28:31], s57 offen offset:0 sc1 lds
    v_mfma_f32_16x16x32_bf16 a[88:91], a[248:251], v[136:139], a[88:91]
    v_cvt_pk_bf16_f32 v158, v24, v25
    v_exp_f32 v27, v127
    v_mfma_f32_16x16x32_bf16 a[120:123], a[248:251], v[140:143], a[120:123]
    ds_read_b128 a[208:211], v6 offset:12288
    v_cvt_pk_bf16_f32 v159, v26, v27
    s_nop 1
    v_mfma_f32_16x16x32_bf16 v[40:43], v[44:47], v[156:159], 0
    s_nop 2
    v_mfma_f32_16x16x32_bf16 a[124:127], a[252:255], v[140:143], a[124:127]
    ds_read_b128 a[212:215], v6 offset:13312
    s_nop 0
    v_mfma_f32_16x16x32_bf16 a[92:95], a[252:255], v[136:139], a[92:95]
    ds_read_b128 a[216:219], v6 offset:14336
    v_max3_f32 v8, v28, v32, v36
    v_mfma_f32_16x16x32_bf16 a[60:63], a[252:255], v[132:135], a[60:63]
    ds_read_b128 a[220:223], v6 offset:15360
    v_max_f32 v8, v8, v40
    v_cmp_nge_f32 vcc, s66, v8
    v_mfma_f32_16x16x32_bf16 a[28:31], a[252:255], v[128:131], a[28:31]
    s_waitcnt lgkmcnt(4)
    s_cbranch_vccnz m_stub115
m_ret116:
    v_mfma_f32_16x16x32_bf16 v[96:99], a[192:195], a[128:131], v[160:163]
    s_add_u32 s59, s58, s60
    v_exp_f32 v20, v64
    v_mfma_f32_16x16x32_bf16 v[96:99], a[196:199], a[132:135], v[96:99]
    s_add_u32 s58, s58, 32768
    ds_read_b128 a[224:227], v6 offset:24576
    v_add_f32 v12, v12, v28
    v_mfma_f32_16x16x32_bf16 v[96:99], a[200:203], a[136:139], v[96:99]
    s_cmp_ge_u32 s58, 163840
    s_cselect_b32 s58, 0, s58
    ds_read_b128 a[228:231], v6 offset:25600
    v_add_f32 v13, v13, v32
    v_mfma_f32_16x16x32_bf16 v[96:99], a[204:207], a[140:143], v[96:99]
    buffer_load_dwordx4 v7, s[28:31], s57 offen offset:1024 sc1 lds
    v_mfma_f32_16x16x32_bf16 v[104:107], a[204:207], a[156:159], v[168:171]
    s_bitcmp1_b64 s[62:63], s64
    s_cselect_b32 s66, -1.0, s65
    ds_read_b128 a[232:235], v6 offset:26624
    v_mfma_f32_16x16x32_bf16 v[104:107], a[200:203], a[152:155], v[104:107]
    s_add_u32 s64, s64, 1
    ds_read_b128 a[236:239], v6 offset:27648
    v_mfma_f32_16x16x32_bf16 v[104:107], a[196:199], a[148:151], v[104:107]
    ds_read_b128 a[240:243], v6 offset:28672
    v_mfma_f32_16x16x32_bf16 v[104:107], a[192:195], a[144:147], v[104:107]
    s_waitcnt lgkmcnt(5)
    ds_read_b128 a[244:247], v6 offset:29696
    v_mfma_f32_16x16x32_bf16 v[108:111], a[208:211], a[144:147], v[172:175]
    buffer_load_dwordx4 v7, s[28:31], s57 offen offset:2048 sc1 lds
    v_mfma_f32_16x16x32_bf16 v[108:111], a[212:215], a[148:151], v[108:111]
    ds_read_b128 a[248:251], v6 offset:30720
    v_mfma_f32_16x16x32_bf16 v[108:111], a[216:219], a[152:155], v[108:111]
    ds_read_b128 a[252:255], v6 offset:31744
    v_mfma_f32_16x16x32_bf16 v[108:111], a[220:223], a[156:159], v[108:111]
    v_exp_f32 v21, v65
    v_mfma_f32_16x16x32_bf16 v[100:103], a[220:223], a[140:143], v[164:167]
    v_exp_f32 v22, v66
    v_mfma_f32_16x16x32_bf16 v[100:103], a[216:219], a[136:139], v[100:103]
    buffer_load_dwordx4 v7, s[28:31], s57 offen offset:3072 sc1 lds
    v_mfma_f32_16x16x32_bf16 v[100:103], a[212:215], a[132:135], v[100:103]
    s_add_u32 s57, s57, 16384
    v_cvt_pk_bf16_f32 v128, v20, v21
    v_mfma_f32_16x16x32_bf16 v[100:103], a[208:211], a[128:131], v[100:103]
    s_waitcnt vmcnt(24) lgkmcnt(0)
    v_add_u32 v6, s58, v2
    v_mfma_f32_16x16x32_bf16 a[0:3], a[224:227], v[144:147], a[0:3]
    s_barrier
    v_mfma_f32_16x16x32_bf16 a[32:35], a[224:227], v[148:151], a[32:35]
    ds_read_b128 a[192:195], v6 offset:0
    v_mfma_f32_16x16x32_bf16 a[64:67], a[224:227], v[152:155], a[64:67]
    v_exp_f32 v23, v67
    v_mfma_f32_16x16x32_bf16 a[96:99], a[224:227], v[156:159], a[96:99]
    v_exp_f32 v24, v68
    v_mfma_f32_16x16x32_bf16 a[100:103], a[228:231], v[156:159], a[100:103]
    ds_read_b128 a[196:199], v6 offset:1024
    v_cvt_pk_bf16_f32 v129, v22, v23
    v_mfma_f32_16x16x32_bf16 a[68:71], a[228:231], v[152:155], a[68:71]
    v_exp_f32 v25, v69
    v_mfma_f32_16x16x32_bf16 a[36:39], a[228:231], v[148:151], a[36:39]
    v_exp_f32 v26, v70
    v_mfma_f32_16x16x32_bf16 a[4:7], a[228:231], v[144:147], a[4:7]
    ds_read_b128 a[200:203], v6 offset:2048
    v_cvt_pk_bf16_f32 v130, v24, v25
    v_mfma_f32_16x16x32_bf16 a[8:11], a[232:235], v[144:147], a[8:11]
    v_exp_f32 v27, v71
    v_mfma_f32_16x16x32_bf16 a[40:43], a[232:235], v[148:151], a[40:43]
    v_exp_f32 v20, v72
    v_mfma_f32_16x16x32_bf16 a[72:75], a[232:235], v[152:155], a[72:75]
    ds_read_b128 a[204:207], v6 offset:3072
    v_cvt_pk_bf16_f32 v131, v26, v27
    v_mfma_f32_16x16x32_bf16 a[104:107], a[232:235], v[156:159], a[104:107]
    v_exp_f32 v21, v73
    v_mfma_f32_16x16x32_bf16 v[28:31], v[44:47], v[128:131], 0
    v_exp_f32 v22, v74
    v_mfma_f32_16x16x32_bf16 a[108:111], a[236:239], v[156:159], a[108:111]
    v_cvt_pk_bf16_f32 v132, v20, v21
    v_mfma_f32_16x16x32_bf16 a[76:79], a[236:239], v[152:155], a[76:79]
    v_exp_f32 v23, v75
    v_mfma_f32_16x16x32_bf16 a[44:47], a[236:239], v[148:151], a[44:47]
    v_exp_f32 v24, v76
    v_mfma_f32_16x16x32_bf16 a[12:15], a[236:239], v[144:147], a[12:15]
    v_cvt_pk_bf16_f32 v133, v22, v23
    v_mfma_f32_16x16x32_bf16 a[16:19], a[240:243], v[144:147], a[16:19]
    v_exp_f32 v25, v77
    v_mfma_f32_16x16x32_bf16 a[48:51], a[240:243], v[148:151], a[48:51]
    v_exp_f32 v26, v78
    v_mfma_f32_16x16x32_bf16 a[80:83], a[240:243], v[152:155], a[80:83]
    v_cvt_pk_bf16_f32 v134, v24, v25
    v_mfma_f32_16x16x32_bf16 a[112:115], a[240:243], v[156:159], a[112:115]
    v_exp_f32 v27, v79
    v_mfma_f32_16x16x32_bf16 a[116:119], a[244:247], v[156:159], a[116:119]
    v_cvt_pk_bf16_f32 v135, v26, v27
    v_mfma_f32_16x16x32_bf16 a[84:87], a[244:247], v[152:155], a[84:87]
    v_mfma_f32_16x16x32_bf16 a[52:55], a[244:247], v[148:151], a[52:55]
    v_mfma_f32_16x16x32_bf16 v[32:35], v[44:47], v[132:135], 0
    s_nop 2
    v_mfma_f32_16x16x32_bf16 a[20:23], a[244:247], v[144:147], a[20:23]
    s_nop 2
    v_mfma_f32_16x16x32_bf16 a[24:27], a[248:251], v[144:147], a[24:27]
    v_max_f32 v8, v28, v32
    v_cmp_nge_f32 vcc, s66, v8
    v_mfma_f32_16x16x32_bf16 a[56:59], a[248:251], v[148:151], a[56:59]
    v_mfma_f32_16x16x32_bf16 a[88:91], a[248:251], v[152:155], a[88:91]
    v_mfma_f32_16x16x32_bf16 a[120:123], a[248:251], v[156:159], a[120:123]
    ds_read_b128 a[208:211], v6 offset:4096
    v_mfma_f32_16x16x32_bf16 a[124:127], a[252:255], v[156:159], a[124:127]
    ds_read_b128 a[212:215], v6 offset:5120
    v_mfma_f32_16x16x32_bf16 a[92:95], a[252:255], v[152:155], a[92:95]
    ds_read_b128 a[216:219], v6 offset:6144
    v_mfma_f32_16x16x32_bf16 a[60:63], a[252:255], v[148:151], a[60:63]
    ds_read_b128 a[220:223], v6 offset:7168
    v_mfma_f32_16x16x32_bf16 a[28:31], a[252:255], v[144:147], a[28:31]
    s_waitcnt lgkmcnt(4)
    s_cbranch_vccnz m_stub117
m_ret118:
    v_add_f32 v20, v14, v36
    v_add_f32 v21, v15, v40
    s_nop 3
    v_rcp_f32 v22, v21
    v_rcp_f32 v20, v20
    s_lshl_b32 s90, s79, 10
    s_add_u32 s90, s90, s82
    s_add_u32 s90, s90, 67108864
    v_accvgpr_read_b32 v48, a64
    v_accvgpr_read_b32 v49, a65
    v_accvgpr_read_b32 v50, a66
    v_accvgpr_read_b32 v51, a67
    v_accvgpr_read_b32 v52, a68
    v_accvgpr_read_b32 v53, a69
    v_accvgpr_read_b32 v54, a70
    v_accvgpr_read_b32 v55, a71
    v_pk_mul_f32 v[48:49], v[48:49], v[20:21] op_sel_hi:[1,0]
    v_pk_mul_f32 v[50:51], v[50:51], v[20:21] op_sel_hi:[1,0]
    v_pk_mul_f32 v[52:53], v[52:53], v[20:21] op_sel_hi:[1,0]
    v_pk_mul_f32 v[54:55], v[54:55], v[20:21] op_sel_hi:[1,0]
    v_cvt_pk_bf16_f32 v48, v48, v49
    v_cvt_pk_bf16_f32 v49, v50, v51
    v_cvt_pk_bf16_f32 v50, v52, v53
    v_cvt_pk_bf16_f32 v51, v54, v55
    buffer_store_dwordx4 v[48:51], v2, s[8:11], s90 offen offset:0 sc1
    v_accvgpr_read_b32 v56, a96
    v_accvgpr_read_b32 v57, a97
    v_accvgpr_read_b32 v58, a98
    v_accvgpr_read_b32 v59, a99
    v_accvgpr_read_b32 v60, a100
    v_accvgpr_read_b32 v61, a101
    v_accvgpr_read_b32 v62, a102
    v_accvgpr_read_b32 v63, a103
    v_pk_mul_f32 v[56:57], v[56:57], v[22:23] op_sel_hi:[1,0]
    v_pk_mul_f32 v[58:59], v[58:59], v[22:23] op_sel_hi:[1,0]
    v_pk_mul_f32 v[60:61], v[60:61], v[22:23] op_sel_hi:[1,0]
    v_pk_mul_f32 v[62:63], v[62:63], v[22:23] op_sel_hi:[1,0]
    v_cvt_pk_bf16_f32 v56, v56, v57
    v_cvt_pk_bf16_f32 v57, v58, v59
    v_cvt_pk_bf16_f32 v58, v60, v61
    v_cvt_pk_bf16_f32 v59, v62, v63
    buffer_store_dwordx4 v[56:59], v2, s[8:11], s90 offen offset:1024 sc1
    s_add_u32 s90, s90, 131072
    v_accvgpr_read_b32 v48, a72
    v_accvgpr_read_b32 v49, a73
    v_accvgpr_read_b32 v50, a74
    v_accvgpr_read_b32 v51, a75
    v_accvgpr_read_b32 v52, a76
    v_accvgpr_read_b32 v53, a77
    v_accvgpr_read_b32 v54, a78
    v_accvgpr_read_b32 v55, a79
    v_pk_mul_f32 v[48:49], v[48:49], v[20:21] op_sel_hi:[1,0]
    v_pk_mul_f32 v[50:51], v[50:51], v[20:21] op_sel_hi:[1,0]
    v_pk_mul_f32 v[52:53], v[52:53], v[20:21] op_sel_hi:[1,0]
    v_pk_mul_f32 v[54:55], v[54:55], v[20:21] op_sel_hi:[1,0]
    v_cvt_pk_bf16_f32 v48, v48, v49
    v_cvt_pk_bf16_f32 v49, v50, v51
    v_cvt_pk_bf16_f32 v50, v52, v53
    v_cvt_pk_bf16_f32 v51, v54, v55
    buffer_store_dwordx4 v[48:51], v2, s[8:11], s90 offen offset:0 sc1
    v_accvgpr_read_b32 v56, a104
    v_accvgpr_read_b32 v57, a105
    v_accvgpr_read_b32 v58, a106
    v_accvgpr_read_b32 v59, a107
    v_accvgpr_read_b32 v60, a108
    v_accvgpr_read_b32 v61, a109
    v_accvgpr_read_b32 v62, a110
    v_accvgpr_read_b32 v63, a111
    v_pk_mul_f32 v[56:57], v[56:57], v[22:23] op_sel_hi:[1,0]
    v_pk_mul_f32 v[58:59], v[58:59], v[22:23] op_sel_hi:[1,0]
    v_pk_mul_f32 v[60:61], v[60:61], v[22:23] op_sel_hi:[1,0]
    v_pk_mul_f32 v[62:63], v[62:63], v[22:23] op_sel_hi:[1,0]
    v_cvt_pk_bf16_f32 v56, v56, v57
    v_cvt_pk_bf16_f32 v57, v58, v59
    v_cvt_pk_bf16_f32 v58, v60, v61
    v_cvt_pk_bf16_f32 v59, v62, v63
    buffer_store_dwordx4 v[56:59], v2, s[8:11], s90 offen offset:1024 sc1
    s_add_u32 s90, s90, 131072
    v_accvgpr_read_b32 v48, a80
    v_accvgpr_read_b32 v49, a81
    v_accvgpr_read_b32 v50, a82
    v_accvgpr_read_b32 v51, a83
    v_accvgpr_read_b32 v52, a84
    v_accvgpr_read_b32 v53, a85
    v_accvgpr_read_b32 v54, a86
    v_accvgpr_read_b32 v55, a87
    v_pk_mul_f32 v[48:49], v[48:49], v[20:21] op_sel_hi:[1,0]
    v_pk_mul_f32 v[50:51], v[50:51], v[20:21] op_sel_hi:[1,0]
    v_pk_mul_f32 v[52:53], v[52:53], v[20:21] op_sel_hi:[1,0]
    v_pk_mul_f32 v[54:55], v[54:55], v[20:21] op_sel_hi:[1,0]
    v_cvt_pk_bf16_f32 v48, v48, v49
    v_cvt_pk_bf16_f32 v49, v50, v51
    v_cvt_pk_bf16_f32 v50, v52, v53
    v_cvt_pk_bf16_f32 v51, v54, v55
    buffer_store_dwordx4 v[48:51], v2, s[8:11], s90 offen offset:0 sc1
    v_accvgpr_read_b32 v56, a112
    v_accvgpr_read_b32 v57, a113
    v_accvgpr_read_b32 v58, a114
    v_accvgpr_read_b32 v59, a115
    v_accvgpr_read_b32 v60, a116
    v_accvgpr_read_b32 v61, a117
    v_accvgpr_read_b32 v62, a118
    v_accvgpr_read_b32 v63, a119
    v_pk_mul_f32 v[56:57], v[56:57], v[22:23] op_sel_hi:[1,0]
    v_pk_mul_f32 v[58:59], v[58:59], v[22:23] op_sel_hi:[1,0]
    v_pk_mul_f32 v[60:61], v[60:61], v[22:23] op_sel_hi:[1,0]
    v_pk_mul_f32 v[62:63], v[62:63], v[22:23] op_sel_hi:[1,0]
    v_cvt_pk_bf16_f32 v56, v56, v57
    v_cvt_pk_bf16_f32 v57, v58, v59
    v_cvt_pk_bf16_f32 v58, v60, v61
    v_cvt_pk_bf16_f32 v59, v62, v63
    buffer_store_dwordx4 v[56:59], v2, s[8:11], s90 offen offset:1024 sc1
    s_add_u32 s90, s90, 131072
    v_accvgpr_read_b32 v48, a88
    v_accvgpr_read_b32 v49, a89
    v_accvgpr_read_b32 v50, a90
    v_accvgpr_read_b32 v51, a91
    v_accvgpr_read_b32 v52, a92
    v_accvgpr_read_b32 v53, a93
    v_accvgpr_read_b32 v54, a94
    v_accvgpr_read_b32 v55, a95
    v_pk_mul_f32 v[48:49], v[48:49], v[20:21] op_sel_hi:[1,0]
    v_pk_mul_f32 v[50:51], v[50:51], v[20:21] op_sel_hi:[1,0]
    v_pk_mul_f32 v[52:53], v[52:53], v[20:21] op_sel_hi:[1,0]
    v_pk_mul_f32 v[54:55], v[54:55], v[20:21] op_sel_hi:[1,0]
    v_cvt_pk_bf16_f32 v48, v48, v49
    v_cvt_pk_bf16_f32 v49, v50, v51
    v_cvt_pk_bf16_f32 v50, v52, v53
    v_cvt_pk_bf16_f32 v51, v54, v55
    buffer_store_dwordx4 v[48:51], v2, s[8:11], s90 offen offset:0 sc1
    v_accvgpr_read_b32 v56, a120
    v_accvgpr_read_b32 v57, a121
    v_accvgpr_read_b32 v58, a122
    v_accvgpr_read_b32 v59, a123
    v_accvgpr_read_b32 v60, a124
    v_accvgpr_read_b32 v61, a125
    v_accvgpr_read_b32 v62, a126
    v_accvgpr_read_b32 v63, a127
    v_pk_mul_f32 v[56:57], v[56:57], v[22:23] op_sel_hi:[1,0]
    v_pk_mul_f32 v[58:59], v[58:59], v[22:23] op_sel_hi:[1,0]
    v_pk_mul_f32 v[60:61], v[60:61], v[22:23] op_sel_hi:[1,0]
    v_pk_mul_f32 v[62:63], v[62:63], v[22:23] op_sel_hi:[1,0]
    v_cvt_pk_bf16_f32 v56, v56, v57
    v_cvt_pk_bf16_f32 v57, v58, v59
    v_cvt_pk_bf16_f32 v58, v60, v61
    v_cvt_pk_bf16_f32 v59, v62, v63
    buffer_store_dwordx4 v[56:59], v2, s[8:11], s90 offen offset:1024 sc1
    s_add_u32 s90, s90, 131072
    s_lshl_b32 s101, s34, 5
    s_add_u32 s101, s101, s32
    s_lshl_b32 s101, s101, 3
    s_add_u32 s101, s101, 7936
    s_cmp_eq_u32 s64, s72
    s_cbranch_scc1 m_singlex120
.p2align 3
m_single119:
    v_mfma_f32_16x16x32_bf16 v[64:67], a[192:195], a[128:131], v[160:163]
    s_bitcmp1_b64 s[62:63], s64
    s_cselect_b32 s66, -1.0, s65
    v_add_f32 v12, v12, v28
    v_mfma_f32_16x16x32_bf16 v[64:67], a[196:199], a[132:135], v[64:67]
    s_mov_b32 m0, s59
    ds_read_b128 a[224:227], v6 offset:16384
    v_add_f32 v13, v13, v32
    v_mfma_f32_16x16x32_bf16 v[64:67], a[200:203], a[136:139], v[64:67]
    buffer_load_dwordx4 v7, s[24:27], s56 offen offset:0 sc1 lds
    v_mfma_f32_16x16x32_bf16 v[64:67], a[204:207], a[140:143], v[64:67]
    s_add_u32 s64, s64, 1
    ds_read_b128 a[228:231], v6 offset:17408
    v_exp_f32 v20, v96
    v_mfma_f32_16x16x32_bf16 v[72:75], a[204:207], a[156:159], v[168:171]
    ds_read_b128 a[232:235], v6 offset:18432
    v_exp_f32 v21, v97
    v_mfma_f32_16x16x32_bf16 v[72:75], a[200:203], a[152:155], v[72:75]
    ds_read_b128 a[236:239], v6 offset:19456
    v_cvt_pk_bf16_f32 v144, v20, v21
    v_mfma_f32_16x16x32_bf16 v[72:75], a[196:199], a[148:151], v[72:75]
    ds_read_b128 a[240:243], v6 offset:20480
    v_exp_f32 v22, v98
    v_mfma_f32_16x16x32_bf16 v[72:75], a[192:195], a[144:147], v[72:75]
    s_waitcnt lgkmcnt(5)
    ds_read_b128 a[244:247], v6 offset:21504
    v_mfma_f32_16x16x32_bf16 v[76:79], a[208:211], a[144:147], v[172:175]
    ds_read_b128 a[248:251], v6 offset:22528
    v_exp_f32 v23, v99
    v_mfma_f32_16x16x32_bf16 v[76:79], a[212:215], a[148:151], v[76:79]
    ds_read_b128 a[252:255], v6 offset:23552
    v_cvt_pk_bf16_f32 v145, v22, v23
    v_mfma_f32_16x16x32_bf16 v[76:79], a[216:219], a[152:155], v[76:79]
    buffer_load_dwordx4 v7, s[24:27], s56 offen offset:1024 sc1 lds
    v_mfma_f32_16x16x32_bf16 v[76:79], a[220:223], a[156:159], v[76:79]
    v_exp_f32 v24, v100
    v_mfma_f32_16x16x32_bf16 v[68:71], a[220:223], a[140:143], v[164:167]
    v_exp_f32 v25, v101
    v_mfma_f32_16x16x32_bf16 v[68:71], a[216:219], a[136:139], v[68:71]
    v_exp_f32 v26, v102
    v_mfma_f32_16x16x32_bf16 v[68:71], a[212:215], a[132:135], v[68:71]
    buffer_load_dwordx4 v7, s[24:27], s56 offen offset:2048 sc1 lds
    v_cvt_pk_bf16_f32 v146, v24, v25
    v_mfma_f32_16x16x32_bf16 v[68:71], a[208:211], a[128:131], v[68:71]
    s_waitcnt lgkmcnt(0)
    v_exp_f32 v27, v103
    v_mfma_f32_16x16x32_bf16 a[0:3], a[224:227], v[128:131], a[0:3]
    ds_read_b128 a[192:195], v6 offset:8192
    v_cvt_pk_bf16_f32 v147, v26, v27
    v_mfma_f32_16x16x32_bf16 a[32:35], a[224:227], v[132:135], a[32:35]
    v_exp_f32 v20, v104
    v_mfma_f32_16x16x32_bf16 v[28:31], v[44:47], v[144:147], 0
    v_exp_f32 v21, v105
    v_mfma_f32_16x16x32_bf16 a[36:39], a[228:231], v[132:135], a[36:39]
    ds_read_b128 a[196:199], v6 offset:9216
    v_exp_f32 v22, v106
    v_mfma_f32_16x16x32_bf16 a[4:7], a[228:231], v[128:131], a[4:7]
    buffer_load_dwordx4 v7, s[24:27], s56 offen offset:3072 sc1 lds
    v_mfma_f32_16x16x32_bf16 a[8:11], a[232:235], v[128:131], a[8:11]
    s_add_u32 s56, s56, 16384
    ds_read_b128 a[200:203], v6 offset:10240
    v_cvt_pk_bf16_f32 v148, v20, v21
    v_mfma_f32_16x16x32_bf16 a[40:43], a[232:235], v[132:135], a[40:43]
    v_exp_f32 v23, v107
    v_mfma_f32_16x16x32_bf16 a[44:47], a[236:239], v[132:135], a[44:47]
    ds_read_b128 a[204:207], v6 offset:11264
    v_exp_f32 v24, v108
    v_mfma_f32_16x16x32_bf16 a[12:15], a[236:239], v[128:131], a[12:15]
    v_cvt_pk_bf16_f32 v149, v22, v23
    v_exp_f32 v25, v109
    v_mfma_f32_16x16x32_bf16 a[16:19], a[240:243], v[128:131], a[16:19]
    v_exp_f32 v26, v110
    v_mfma_f32_16x16x32_bf16 a[48:51], a[240:243], v[132:135], a[48:51]
    v_cvt_pk_bf16_f32 v150, v24, v25
    v_exp_f32 v27, v111
    v_mfma_f32_16x16x32_bf16 a[52:55], a[244:247], v[132:135], a[52:55]
    ds_read_b128 a[208:211], v6 offset:12288
    v_cvt_pk_bf16_f32 v151, v26, v27
    v_mfma_f32_16x16x32_bf16 a[20:23], a[244:247], v[128:131], a[20:23]
    s_add_u32 m0, s59, 16384
    ds_read_b128 a[212:215], v6 offset:13312
    v_mfma_f32_16x16x32_bf16 v[32:35], v[44:47], v[148:151], 0
    s_nop 2
    v_mfma_f32_16x16x32_bf16 a[24:27], a[248:251], v[128:131], a[24:27]
    buffer_load_dwordx4 v7, s[28:31], s57 offen offset:0 sc1 lds
    v_mfma_f32_16x16x32_bf16 a[56:59], a[248:251], v[132:135], a[56:59]
    ds_read_b128 a[216:219], v6 offset:14336
    s_nop 0
    v_mfma_f32_16x16x32_bf16 a[60:63], a[252:255], v[132:135], a[60:63]
    ds_read_b128 a[220:223], v6 offset:15360
    v_max_f32 v8, v28, v32
    v_cmp_nge_f32 vcc, s66, v8
    v_mfma_f32_16x16x32_bf16 a[28:31], a[252:255], v[128:131], a[28:31]
    s_waitcnt lgkmcnt(4)
    s_cbranch_vccnz m_stub121
m_ret122:
    v_mfma_f32_16x16x32_bf16 v[96:99], a[192:195], a[128:131], v[160:163]
    s_add_u32 s59, s58, s60
    v_exp_f32 v20, v64
    v_mfma_f32_16x16x32_bf16 v[96:99], a[196:199], a[132:135], v[96:99]
    s_add_u32 s58, s58, 32768
    ds_read_b128 a[224:227], v6 offset:24576
    v_add_f32 v12, v12, v28
    v_mfma_f32_16x16x32_bf16 v[96:99], a[200:203], a[136:139], v[96:99]
    s_cmp_ge_u32 s58, 163840
    s_cselect_b32 s58, 0, s58
    ds_read_b128 a[228:231], v6 offset:25600
    v_exp_f32 v21, v65
    v_mfma_f32_16x16x32_bf16 v[96:99], a[204:207], a[140:143], v[96:99]
    s_bitcmp1_b64 s[62:63], s64
    s_cselect_b32 s66, -1.0, s65
    ds_read_b128 a[232:235], v6 offset:26624
    v_mfma_f32_16x16x32_bf16 v[104:107], a[204:207], a[156:159], v[168:171]
    buffer_load_dwordx4 v7, s[28:31], s57 offen offset:1024 sc1 lds
    v_mfma_f32_16x16x32_bf16 v[104:107], a[200:203], a[152:155], v[104:107]
    s_add_u32 s64, s64, 1
    ds_read_b128 a[236:239], v6 offset:27648
    v_cvt_pk_bf16_f32 v128, v20, v21
    v_mfma_f32_16x16x32_bf16 v[104:107], a[196:199], a[148:151], v[104:107]
    ds_read_b128 a[240:243], v6 offset:28672
    v_exp_f32 v22, v66
    v_mfma_f32_16x16x32_bf16 v[104:107], a[192:195], a[144:147], v[104:107]
    s_waitcnt lgkmcnt(5)
    ds_read_b128 a[244:247], v6 offset:29696
    v_add_f32 v13, v13, v32
    v_mfma_f32_16x16x32_bf16 v[108:111], a[208:211], a[144:147], v[172:175]
    ds_read_b128 a[248:251], v6 offset:30720
    v_exp_f32 v23, v67
    v_mfma_f32_16x16x32_bf16 v[108:111], a[212:215], a[148:151], v[108:111]
    buffer_load_dwordx4 v7, s[28:31], s57 offen offset:2048 sc1 lds
    v_mfma_f32_16x16x32_bf16 v[108:111], a[216:219], a[152:155], v[108:111]
    ds_read_b128 a[252:255], v6 offset:31744
    v_cvt_pk_bf16_f32 v129, v22, v23
    v_mfma_f32_16x16x32_bf16 v[108:111], a[220:223], a[156:159], v[108:111]
    v_exp_f32 v24, v68
    v_mfma_f32_16x16x32_bf16 v[100:103], a[220:223], a[140:143], v[164:167]
    v_exp_f32 v25, v69
    v_mfma_f32_16x16x32_bf16 v[100:103], a[216:219], a[136:139], v[100:103]
    buffer_load_dwordx4 v7, s[28:31], s57 offen offset:3072 sc1 lds
    v_mfma_f32_16x16x32_bf16 v[100:103], a[212:215], a[132:135], v[100:103]
    s_add_u32 s57, s57, 16384
    v_exp_f32 v26, v70
    v_cvt_pk_bf16_f32 v130, v24, v25
    v_mfma_f32_16x16x32_bf16 v[100:103], a[208:211], a[128:131], v[100:103]
    s_waitcnt vmcnt(24) lgkmcnt(0)
    v_add_u32 v6, s58, v2
    v_exp_f32 v27, v71
    v_mfma_f32_16x16x32_bf16 a[0:3], a[224:227], v[144:147], a[0:3]
    s_barrier
    v_mfma_f32_16x16x32_bf16 a[32:35], a[224:227], v[148:151], a[32:35]
    ds_read_b128 a[192:195], v6 offset:0
    v_cvt_pk_bf16_f32 v131, v26, v27
    v_mfma_f32_16x16x32_bf16 a[36:39], a[228:231], v[148:151], a[36:39]
    v_exp_f32 v20, v72
    v_mfma_f32_16x16x32_bf16 v[28:31], v[44:47], v[128:131], 0
    v_exp_f32 v21, v73
    v_mfma_f32_16x16x32_bf16 a[4:7], a[228:231], v[144:147], a[4:7]
    ds_read_b128 a[196:199], v6 offset:1024
    v_cvt_pk_bf16_f32 v132, v20, v21
    v_mfma_f32_16x16x32_bf16 a[8:11], a[232:235], v[144:147], a[8:11]
    v_exp_f32 v22, v74
    v_mfma_f32_16x16x32_bf16 a[40:43], a[232:235], v[148:151], a[40:43]
    ds_read_b128 a[200:203], v6 offset:2048
    v_exp_f32 v23, v75
    v_mfma_f32_16x16x32_bf16 a[44:47], a[236:239], v[148:151], a[44:47]
    v_exp_f32 v24, v76
    v_mfma_f32_16x16x32_bf16 a[12:15], a[236:239], v[144:147], a[12:15]
    ds_read_b128 a[204:207], v6 offset:3072
    v_cvt_pk_bf16_f32 v133, v22, v23
    v_mfma_f32_16x16x32_bf16 a[16:19], a[240:243], v[144:147], a[16:19]
    v_exp_f32 v25, v77
    v_mfma_f32_16x16x32_bf16 a[48:51], a[240:243], v[148:151], a[48:51]
    v_exp_f32 v26, v78
    v_cvt_pk_bf16_f32 v134, v24, v25
    v_mfma_f32_16x16x32_bf16 a[52:55], a[244:247], v[148:151], a[52:55]
    v_exp_f32 v27, v79
    v_mfma_f32_16x16x32_bf16 a[20:23], a[244:247], v[144:147], a[20:23]
    ds_read_b128 a[208:211], v6 offset:4096
    v_cvt_pk_bf16_f32 v135, v26, v27
    s_nop 1
    v_mfma_f32_16x16x32_bf16 v[32:35], v[44:47], v[132:135], 0
    s_nop 2
    v_mfma_f32_16x16x32_bf16 a[24:27], a[248:251], v[144:147], a[24:27]
    ds_read_b128 a[212:215], v6 offset:5120
    s_nop 0
    v_mfma_f32_16x16x32_bf16 a[56:59], a[248:251], v[148:151], a[56:59]
    ds_read_b128 a[216:219], v6 offset:6144
    v_max_f32 v8, v28, v32
    v_mfma_f32_16x16x32_bf16 a[60:63], a[252:255], v[148:151], a[60:63]
    ds_read_b128 a[220:223], v6 offset:7168
    v_cmp_nge_f32 vcc, s66, v8
    v_mfma_f32_16x16x32_bf16 a[28:31], a[252:255], v[144:147], a[28:31]
    s_waitcnt lgkmcnt(4)
    s_cbranch_vccz m_single119
    v_cmp_lt_f32 vcc, s65, v8
    s_cmp_lg_u32 s64, s70
    s_cbranch_scc1 m_e124
    v_add_f32 v160, v160, v16
    v_mov_b32 v164, v9
    v_add_f32 v172, v172, v16
    v_add_f32 v161, v161, v17
    v_mov_b32 v165, v9
    v_add_f32 v173, v173, v17
    v_add_f32 v162, v162, v18
    v_mov_b32 v166, v9
    v_add_f32 v174, v174, v18
    v_add_f32 v163, v163, v19
    v_mov_b32 v167, v9
    v_add_f32 v175, v175, v19
    s_nop 0
m_e124:
    s_cmp_lg_u32 s64, s71
    s_cbranch_scc1 m_e125
    v_mov_b32 v160, v9
    v_mov_b32 v168, v9
    v_mov_b32 v172, v9
    v_mov_b32 v164, v9
    v_mov_b32 v161, v9
    v_mov_b32 v169, v9
    v_mov_b32 v173, v9
    v_mov_b32 v165, v9
    v_mov_b32 v162, v9
    v_mov_b32 v170, v9
    v_mov_b32 v174, v9
    v_mov_b32 v166, v9
    v_mov_b32 v163, v9
    v_mov_b32 v171, v9
    v_mov_b32 v175, v9
    v_mov_b32 v167, v9
    s_nop 0
m_e125:
    s_cmp_lg_u32 s64, s53
    s_cbranch_scc1 m_e128
    s_cmp_lg_u32 s16, 0
    s_cbranch_scc1 m_np129
    v_mov_b32 v60, s4
    v_mov_b32 v61, s5
    s_add_u32 s90, s101, 117440512
    s_mov_b64 exec, 1
    buffer_store_dwordx2 v[60:61], off, s[8:11], s90 sc1
    s_mov_b64 exec, -1
m_np129:
    s_mov_b32 s101, -1
m_e128:
    s_cmp_gt_u32 s64, 24
    s_cbranch_scc1 m_e126
    s_cmp_lg_u32 s64, 8
    s_cbranch_scc1 m_e130
    s_lshr_b32 s90, s32, 1
    s_lshl_b32 s90, s90, 7
    s_add_u32 s90, s90, 117440600
    v_min_u32 v0, 1, v1
    v_lshlrev_b32 v0, 5, v0
    buffer_load_dwordx2 v[4:5], v0, s[8:11], s90 offen sc1
    s_cmp_eq_u32 s17, -1
    s_cbranch_scc1 m_e126
    s_cmp_lg_u32 s16, 0
    s_cbranch_scc1 m_np131
    v_mov_b32 v60, s4
    v_mov_b32 v61, s5
    s_add_u32 s90, s17, 117440512
    s_mov_b64 exec, 1
    buffer_store_dwordx2 v[60:61], off, s[8:11], s90 sc1
    s_mov_b64 exec, -1
m_np131:
    s_branch m_e126
m_e130:
    s_cmp_lg_u32 s64, 16
    s_cbranch_scc1 m_e132
    s_waitcnt vmcnt(18)
    s_mov_b32 s3, 1048576
m_spin133:
    v_cmp_ne_u64 s[76:77], s[4:5], v[4:5]
    s_nop 3
    s_cmp_eq_u64 s[76:77], 0
    s_cbranch_scc1 m_e126
    s_sub_u32 s3, s3, 1
    s_cbranch_scc1 m_e126
    s_sleep 32
    s_lshr_b32 s90, s32, 1
    s_lshl_b32 s90, s90, 7
    s_add_u32 s90, s90, 117440600
    v_min_u32 v0, 1, v1
    v_lshlrev_b32 v0, 5, v0
    buffer_load_dwordx2 v[4:5], v0, s[8:11], s90 offen sc1
    s_waitcnt vmcnt(0)
    s_branch m_spin133
    s_branch m_e126
m_e132:
    s_cmp_lg_u32 s64, 20
    s_cbranch_scc1 m_e134
    buffer_load_dwordx2 v[4:5], v10, s[8:11], 0 offen sc1
    s_mov_b32 s44, s48
    s_mov_b32 s45, s49
    s_mov_b32 s46, 8388608
    s_lshl_b32 s90, s2, 2
    s_add_u32 s90, s90, s16
    s_lshl_b32 s90, s90, 13
    v_lshlrev_b32 v62, 7, v1
    buffer_load_dword v255, v62, s[44:47], s90 offen
    s_branch m_e126
m_e134:
    s_cmp_lg_u32 s64, 24
    s_cbranch_scc1 m_e135
    s_mov_b32 s44, s50
    s_mov_b32 s45, s51
    s_mov_b32 s46, 2097152
    s_lshl_b32 s90, s2, 2
    s_add_u32 s90, s90, s16
    s_lshl_b32 s90, s90, 13
    v_lshlrev_b32 v62, 7, v1
    buffer_load_dword v255, v62, s[44:47], s90 offen
    s_waitcnt vmcnt(18)
    s_mov_b32 s3, 1048576
m_spin136:
    v_cmp_ne_u64 s[76:77], s[4:5], v[4:5]
    s_nop 3
    s_cmp_eq_u64 s[76:77], 0
    s_cbranch_scc1 m_e126
    s_sub_u32 s3, s3, 1
    s_cbranch_scc1 m_e126
    s_sleep 32
    buffer_load_dwordx2 v[4:5], v10, s[8:11], 0 offen sc1
    s_waitcnt vmcnt(0)
    s_branch m_spin136
    s_branch m_e126
m_e135:
m_e126:
    s_cbranch_vccnz m_rc137
m_sp123:
    s_cmp_lg_u32 s64, s72
    s_cbranch_scc1 m_single119
m_singlex120:
    s_bfe_u32 s95, s2, 0x10002
    s_and_b32 s90, s2, 7
    s_bitcmp1_b32 0x63, s90
    s_cselect_b32 s96, s33, s34
    s_sub_u32 s96, s96, 1
    s_and_b32 s90, s2, 1
    s_lshl_b32 s90, s90, 2
    s_bfe_u32 s91, s2, 0x20003
    s_add_u32 s97, s90, s91
    v_and_b32 v10, 31, v1
    v_lshlrev_b32 v10, 3, v10
    s_lshl_b32 s52, s96, 8
    s_add_u32 s52, s52, 117448704
    buffer_load_dwordx2 v[4:5], v10, s[8:11], s52 offen sc1
    ds_read_b128 a[224:227], v6 offset:16384
    ds_read_b128 a[228:231], v6 offset:17408
    ds_read_b128 a[232:235], v6 offset:18432
    ds_read_b128 a[236:239], v6 offset:19456
    ds_read_b128 a[240:243], v6 offset:20480
    ds_read_b128 a[244:247], v6 offset:21504
    ds_read_b128 a[248:251], v6 offset:22528
    ds_read_b128 a[252:255], v6 offset:23552
    s_waitcnt lgkmcnt(0)
    v_mfma_f32_16x16x32_bf16 a[0:3], a[224:227], v[128:131], a[0:3]
    buffer_load_dwordx4 v[192:195], v2, s[8:11], s83 offen offset:0 sc1
    v_exp_f32 v20, v96
    v_mfma_f32_16x16x32_bf16 a[32:35], a[224:227], v[132:135], a[32:35]
    v_exp_f32 v21, v97
    v_exp_f32 v22, v98
    v_mfma_f32_16x16x32_bf16 a[36:39], a[228:231], v[132:135], a[36:39]
    buffer_load_dwordx4 v[196:199], v2, s[8:11], s83 offen offset:1024 sc1
    v_cvt_pk_bf16_f32 v144, v20, v21
    v_add_f32 v12, v12, v28
    v_mfma_f32_16x16x32_bf16 a[4:7], a[228:231], v[128:131], a[4:7]
    v_exp_f32 v23, v99
    v_exp_f32 v24, v100
    v_cvt_pk_bf16_f32 v145, v22, v23
    v_mfma_f32_16x16x32_bf16 a[8:11], a[232:235], v[128:131], a[8:11]
    buffer_load_dwordx4 v[200:203], v2, s[8:11], s83 offen offset:2048 sc1
    v_exp_f32 v25, v101
    v_mfma_f32_16x16x32_bf16 a[40:43], a[232:235], v[132:135], a[40:43]
    v_exp_f32 v26, v102
    v_cvt_pk_bf16_f32 v146, v24, v25
    v_add_f32 v13, v13, v32
    v_mfma_f32_16x16x32_bf16 a[44:47], a[236:239], v[132:135], a[44:47]
    buffer_load_dwordx4 v[204:207], v2, s[8:11], s83 offen offset:3072 sc1
    v_exp_f32 v27, v103
    v_mfma_f32_16x16x32_bf16 a[12:15], a[236:239], v[128:131], a[12:15]
    v_exp_f32 v20, v104
    v_cvt_pk_bf16_f32 v147, v26, v27
    v_mfma_f32_16x16x32_bf16 a[16:19], a[240:243], v[128:131], a[16:19]
    buffer_load_dwordx4 v[212:215], v2, s[8:11], s84 offen offset:0 sc1
    v_exp_f32 v21, v105
    v_mfma_f32_16x16x32_bf16 v[28:31], v[44:47], v[144:147], 0
    v_exp_f32 v22, v106
    v_cvt_pk_bf16_f32 v148, v20, v21
    v_exp_f32 v23, v107
    v_mfma_f32_16x16x32_bf16 a[48:51], a[240:243], v[132:135], a[48:51]
    v_exp_f32 v24, v108
    v_cvt_pk_bf16_f32 v149, v22, v23
    v_exp_f32 v25, v109
    v_mfma_f32_16x16x32_bf16 a[52:55], a[244:247], v[132:135], a[52:55]
    buffer_load_dwordx4 v[216:219], v2, s[8:11], s84 offen offset:1024 sc1
    v_exp_f32 v26, v110
    v_mfma_f32_16x16x32_bf16 a[20:23], a[244:247], v[128:131], a[20:23]
    v_cvt_pk_bf16_f32 v150, v24, v25
    v_exp_f32 v27, v111
    s_nop 0
    v_cvt_pk_bf16_f32 v151, v26, v27
    s_nop 1
    v_mfma_f32_16x16x32_bf16 v[32:35], v[44:47], v[148:151], 0
    s_nop 2
    v_mfma_f32_16x16x32_bf16 a[24:27], a[248:251], v[128:131], a[24:27]
    buffer_load_dwordx4 v[220:223], v2, s[8:11], s84 offen offset:2048 sc1
    v_mfma_f32_16x16x32_bf16 a[56:59], a[248:251], v[132:135], a[56:59]
    s_nop 2
    v_mfma_f32_16x16x32_bf16 a[60:63], a[252:255], v[132:135], a[60:63]
    v_max_f32 v8, v28, v32
    v_cmp_nge_f32 vcc, s65, v8
    v_mfma_f32_16x16x32_bf16 a[28:31], a[252:255], v[128:131], a[28:31]
    s_cbranch_vccnz m_stub138
m_ret139:
    s_nop 1
    s_cmp_ge_u32 s16, 2
    s_cbranch_scc1 m_xb140
    s_waitcnt vmcnt(24)
    s_barrier
m_xb140:
    ds_read_b128 a[224:227], v6 offset:24576
    ds_read_b128 a[228:231], v6 offset:25600
    ds_read_b128 a[232:235], v6 offset:26624
    ds_read_b128 a[236:239], v6 offset:27648
    ds_read_b128 a[240:243], v6 offset:28672
    ds_read_b128 a[244:247], v6 offset:29696
    ds_read_b128 a[248:251], v6 offset:30720
    ds_read_b128 a[252:255], v6 offset:31744
    s_waitcnt lgkmcnt(0)
    v_mfma_f32_16x16x32_bf16 a[0:3], a[224:227], v[144:147], a[0:3]
    buffer_load_dwordx4 v[224:227], v2, s[8:11], s84 offen offset:3072 sc1
    v_mfma_f32_16x16x32_bf16 a[32:35], a[224:227], v[148:151], a[32:35]
    v_mfma_f32_16x16x32_bf16 a[36:39], a[228:231], v[148:151], a[36:39]
    buffer_load_dwordx4 v[208:211], v2, s[8:11], s85 offen offset:0 sc1
    v_mfma_f32_16x16x32_bf16 a[4:7], a[228:231], v[144:147], a[4:7]
    v_mfma_f32_16x16x32_bf16 a[8:11], a[232:235], v[144:147], a[8:11]
    buffer_load_dwordx4 v[232:235], v2, s[8:11], s86 offen offset:0 sc1
    v_mfma_f32_16x16x32_bf16 a[40:43], a[232:235], v[148:151], a[40:43]
    v_mfma_f32_16x16x32_bf16 a[44:47], a[236:239], v[148:151], a[44:47]
    buffer_load_dwordx4 v[236:239], v2, s[8:11], s86 offen offset:1024 sc1
    v_mfma_f32_16x16x32_bf16 a[12:15], a[236:239], v[144:147], a[12:15]
    v_mfma_f32_16x16x32_bf16 a[16:19], a[240:243], v[144:147], a[16:19]
    buffer_load_dwordx4 v[228:231], v2, s[8:11], s87 offen offset:0 sc1
    v_mfma_f32_16x16x32_bf16 a[48:51], a[240:243], v[148:151], a[48:51]
    v_mfma_f32_16x16x32_bf16 a[52:55], a[244:247], v[148:151], a[52:55]
    buffer_load_dwordx4 v[244:247], v2, s[8:11], s88 offen offset:0 sc1
    v_mfma_f32_16x16x32_bf16 a[20:23], a[244:247], v[144:147], a[20:23]
    v_mfma_f32_16x16x32_bf16 a[24:27], a[248:251], v[144:147], a[24:27]
    buffer_load_dwordx4 v[248:251], v2, s[8:11], s88 offen offset:1024 sc1
    v_mfma_f32_16x16x32_bf16 a[56:59], a[248:251], v[148:151], a[56:59]
    v_mfma_f32_16x16x32_bf16 a[60:63], a[252:255], v[148:151], a[60:63]
    buffer_load_dwordx4 v[240:243], v2, s[8:11], s89 offen offset:0 sc1
    v_mfma_f32_16x16x32_bf16 a[28:31], a[252:255], v[144:147], a[28:31]
    v_add_f32 v20, v12, v28
    v_add_f32 v21, v13, v32
    s_nop 3
    v_rcp_f32 v22, v21
    v_rcp_f32 v20, v20
    s_lshl_b32 s90, s78, 10
    s_add_u32 s90, s90, s82
    s_add_u32 s90, s90, 67108864
    v_accvgpr_read_b32 v48, a0
    v_accvgpr_read_b32 v49, a1
    v_accvgpr_read_b32 v50, a2
    v_accvgpr_read_b32 v51, a3
    v_accvgpr_read_b32 v52, a4
    v_accvgpr_read_b32 v53, a5
    v_accvgpr_read_b32 v54, a6
    v_accvgpr_read_b32 v55, a7
    v_pk_mul_f32 v[48:49], v[48:49], v[20:21] op_sel_hi:[1,0]
    v_pk_mul_f32 v[50:51], v[50:51], v[20:21] op_sel_hi:[1,0]
    v_pk_mul_f32 v[52:53], v[52:53], v[20:21] op_sel_hi:[1,0]
    v_pk_mul_f32 v[54:55], v[54:55], v[20:21] op_sel_hi:[1,0]
    v_cvt_pk_bf16_f32 v48, v48, v49
    v_cvt_pk_bf16_f32 v49, v50, v51
    v_cvt_pk_bf16_f32 v50, v52, v53
    v_cvt_pk_bf16_f32 v51, v54, v55
    buffer_store_dwordx4 v[48:51], v2, s[8:11], s90 offen offset:0 sc1
    v_accvgpr_read_b32 v56, a32
    v_accvgpr_read_b32 v57, a33
    v_accvgpr_read_b32 v58, a34
    v_accvgpr_read_b32 v59, a35
    v_accvgpr_read_b32 v60, a36
    v_accvgpr_read_b32 v61, a37
    v_accvgpr_read_b32 v62, a38
    v_accvgpr_read_b32 v63, a39
    v_pk_mul_f32 v[56:57], v[56:57], v[22:23] op_sel_hi:[1,0]
    v_pk_mul_f32 v[58:59], v[58:59], v[22:23] op_sel_hi:[1,0]
    v_pk_mul_f32 v[60:61], v[60:61], v[22:23] op_sel_hi:[1,0]
    v_pk_mul_f32 v[62:63], v[62:63], v[22:23] op_sel_hi:[1,0]
    v_cvt_pk_bf16_f32 v56, v56, v57
    v_cvt_pk_bf16_f32 v57, v58, v59
    v_cvt_pk_bf16_f32 v58, v60, v61
    v_cvt_pk_bf16_f32 v59, v62, v63
    buffer_store_dwordx4 v[56:59], v2, s[8:11], s90 offen offset:1024 sc1
    s_add_u32 s90, s90, 131072
    v_accvgpr_read_b32 v48, a8
    v_accvgpr_read_b32 v49, a9
    v_accvgpr_read_b32 v50, a10
    v_accvgpr_read_b32 v51, a11
    v_accvgpr_read_b32 v52, a12
    v_accvgpr_read_b32 v53, a13
    v_accvgpr_read_b32 v54, a14
    v_accvgpr_read_b32 v55, a15
    v_pk_mul_f32 v[48:49], v[48:49], v[20:21] op_sel_hi:[1,0]
    v_pk_mul_f32 v[50:51], v[50:51], v[20:21] op_sel_hi:[1,0]
    v_pk_mul_f32 v[52:53], v[52:53], v[20:21] op_sel_hi:[1,0]
    v_pk_mul_f32 v[54:55], v[54:55], v[20:21] op_sel_hi:[1,0]
    v_cvt_pk_bf16_f32 v48, v48, v49
    v_cvt_pk_bf16_f32 v49, v50, v51
    v_cvt_pk_bf16_f32 v50, v52, v53
    v_cvt_pk_bf16_f32 v51, v54, v55
    buffer_store_dwordx4 v[48:51], v2, s[8:11], s90 offen offset:0 sc1
    v_accvgpr_read_b32 v56, a40
    v_accvgpr_read_b32 v57, a41
    v_accvgpr_read_b32 v58, a42
    v_accvgpr_read_b32 v59, a43
    v_accvgpr_read_b32 v60, a44
    v_accvgpr_read_b32 v61, a45
    v_accvgpr_read_b32 v62, a46
    v_accvgpr_read_b32 v63, a47
    v_pk_mul_f32 v[56:57], v[56:57], v[22:23] op_sel_hi:[1,0]
    v_pk_mul_f32 v[58:59], v[58:59], v[22:23] op_sel_hi:[1,0]
    v_pk_mul_f32 v[60:61], v[60:61], v[22:23] op_sel_hi:[1,0]
    v_pk_mul_f32 v[62:63], v[62:63], v[22:23] op_sel_hi:[1,0]
    v_cvt_pk_bf16_f32 v56, v56, v57
    v_cvt_pk_bf16_f32 v57, v58, v59
    v_cvt_pk_bf16_f32 v58, v60, v61
    v_cvt_pk_bf16_f32 v59, v62, v63
    buffer_store_dwordx4 v[56:59], v2, s[8:11], s90 offen offset:1024 sc1
    s_add_u32 s90, s90, 131072
    v_accvgpr_read_b32 v48, a16
    v_accvgpr_read_b32 v49, a17
    v_accvgpr_read_b32 v50, a18
    v_accvgpr_read_b32 v51, a19
    v_accvgpr_read_b32 v52, a20
    v_accvgpr_read_b32 v53, a21
    v_accvgpr_read_b32 v54, a22
    v_accvgpr_read_b32 v55, a23
    v_pk_mul_f32 v[48:49], v[48:49], v[20:21] op_sel_hi:[1,0]
    v_pk_mul_f32 v[50:51], v[50:51], v[20:21] op_sel_hi:[1,0]
    v_pk_mul_f32 v[52:53], v[52:53], v[20:21] op_sel_hi:[1,0]
    v_pk_mul_f32 v[54:55], v[54:55], v[20:21] op_sel_hi:[1,0]
    v_cvt_pk_bf16_f32 v48, v48, v49
    v_cvt_pk_bf16_f32 v49, v50, v51
    v_cvt_pk_bf16_f32 v50, v52, v53
    v_cvt_pk_bf16_f32 v51, v54, v55
    buffer_store_dwordx4 v[48:51], v2, s[8:11], s90 offen offset:0 sc1
    v_accvgpr_read_b32 v56, a48
    v_accvgpr_read_b32 v57, a49
    v_accvgpr_read_b32 v58, a50
    v_accvgpr_read_b32 v59, a51
    v_accvgpr_read_b32 v60, a52
    v_accvgpr_read_b32 v61, a53
    v_accvgpr_read_b32 v62, a54
    v_accvgpr_read_b32 v63, a55
    v_pk_mul_f32 v[56:57], v[56:57], v[22:23] op_sel_hi:[1,0]
    v_pk_mul_f32 v[58:59], v[58:59], v[22:23] op_sel_hi:[1,0]
    v_pk_mul_f32 v[60:61], v[60:61], v[22:23] op_sel_hi:[1,0]
    v_pk_mul_f32 v[62:63], v[62:63], v[22:23] op_sel_hi:[1,0]
    v_cvt_pk_bf16_f32 v56, v56, v57
    v_cvt_pk_bf16_f32 v57, v58, v59
    v_cvt_pk_bf16_f32 v58, v60, v61
    v_cvt_pk_bf16_f32 v59, v62, v63
    buffer_store_dwordx4 v[56:59], v2, s[8:11], s90 offen offset:1024 sc1
    s_add_u32 s90, s90, 131072
    v_accvgpr_read_b32 v48, a24
    v_accvgpr_read_b32 v49, a25
    v_accvgpr_read_b32 v50, a26
    v_accvgpr_read_b32 v51, a27
    v_accvgpr_read_b32 v52, a28
    v_accvgpr_read_b32 v53, a29
    v_accvgpr_read_b32 v54, a30
    v_accvgpr_read_b32 v55, a31
    v_pk_mul_f32 v[48:49], v[48:49], v[20:21] op_sel_hi:[1,0]
    v_pk_mul_f32 v[50:51], v[50:51], v[20:21] op_sel_hi:[1,0]
    v_pk_mul_f32 v[52:53], v[52:53], v[20:21] op_sel_hi:[1,0]
    v_pk_mul_f32 v[54:55], v[54:55], v[20:21] op_sel_hi:[1,0]
    v_cvt_pk_bf16_f32 v48, v48, v49
    v_cvt_pk_bf16_f32 v49, v50, v51
    v_cvt_pk_bf16_f32 v50, v52, v53
    v_cvt_pk_bf16_f32 v51, v54, v55
    buffer_store_dwordx4 v[48:51], v2, s[8:11], s90 offen offset:0 sc1
    v_accvgpr_read_b32 v56, a56
    v_accvgpr_read_b32 v57, a57
    v_accvgpr_read_b32 v58, a58
    v_accvgpr_read_b32 v59, a59
    v_accvgpr_read_b32 v60, a60
    v_accvgpr_read_b32 v61, a61
    v_accvgpr_read_b32 v62, a62
    v_accvgpr_read_b32 v63, a63
    v_pk_mul_f32 v[56:57], v[56:57], v[22:23] op_sel_hi:[1,0]
    v_pk_mul_f32 v[58:59], v[58:59], v[22:23] op_sel_hi:[1,0]
    v_pk_mul_f32 v[60:61], v[60:61], v[22:23] op_sel_hi:[1,0]
    v_pk_mul_f32 v[62:63], v[62:63], v[22:23] op_sel_hi:[1,0]
    v_cvt_pk_bf16_f32 v56, v56, v57
    v_cvt_pk_bf16_f32 v57, v58, v59
    v_cvt_pk_bf16_f32 v58, v60, v61
    v_cvt_pk_bf16_f32 v59, v62, v63
    buffer_store_dwordx4 v[56:59], v2, s[8:11], s90 offen offset:1024 sc1
    s_add_u32 s90, s90, 131072
    s_lshr_b32 s53, s16, 1
    s_and_b32 s40, s16, 1
    s_mul_i32 s90, s95, 5242880
    s_lshl_b32 s57, s97, 8
    s_add_u32 s57, s57, s90
    v_lshrrev_b32 v20, 4, v1
    s_lshl_b32 s90, s16, 4
    v_add_u32 v21, s90, v20
    v_lshlrev_b32 v21, 11, v21
    v_lshlrev_b32 v20, 1, v20
    v_and_b32 v22, 15, v1
    v_xor_b32 v20, v20, v22
    v_xor_b32 v22, 0, v20
    v_lshl_add_u32 v16, v22, 4, v21
    v_xor_b32 v22, 8, v20
    v_lshl_add_u32 v17, v22, 4, v21
    v_add_u32 v17, 7168, v17
    v_xor_b32 v22, 0, v20
    v_lshl_add_u32 v18, v22, 4, v21
    v_add_u32 v18, 14336, v18
    v_xor_b32 v22, 8, v20
    v_lshl_add_u32 v19, v22, 4, v21
    v_add_u32 v19, 21504, v19
    s_mov_b32 s24, s48
    s_mov_b32 s25, s49
    s_mov_b32 s26, 8388608
    s_mov_b32 s38, 268435456
    s_mov_b32 s28, s54
    s_mov_b32 s29, s55
    s_mov_b32 s30, 8388608
    s_lshl_b32 s90, s96, 13
    s_lshl_b32 s91, s40, 12
    s_add_u32 s90, s90, s91
    s_lshl_b32 s91, s53, 17
    s_add_u32 s69, s90, s91
    s_mul_i32 s90, s95, 10485760
    s_add_u32 s56, s69, s90
    s_add_u32 s56, s56, 67108864
    s_add_u32 s69, s69, 83886080
    s_lshl_b32 s90, s53, 12
    v_add_u32 v6, s90, v2
    v_lshrrev_b32 v48, 2, v1
    v_lshlrev_b32 v48, 8, v48
    v_and_b32 v49, 3, v1
    v_lshl_add_u32 v48, v49, 3, v48
    v_add_u32 v48, 16384, v48
    v_bfe_u32 v49, v1, 2, 3
    s_lshl_b32 s90, s40, 2
    v_xor_b32 v49, s90, v49
    v_xor_b32 v50, 0, v49
    v_lshl_add_u32 v12, v50, 5, v48
    v_xor_b32 v50, 1, v49
    v_lshl_add_u32 v13, v50, 5, v48
    v_xor_b32 v50, 2, v49
    v_lshl_add_u32 v14, v50, 5, v48
    v_xor_b32 v50, 3, v49
    v_lshl_add_u32 v15, v50, 5, v48
    v_and_b32 v48, 15, v1
    v_lshlrev_b32 v48, 12, v48
    v_lshlrev_b32 v48, s95, v48
    v_bfe_u32 v49, v1, 4, 1
    v_lshl_add_u32 v48, v49, 5, v48
    v_lshrrev_b32 v49, 5, v1
    v_lshl_add_u32 v7, v49, 4, v48
    s_lshl_b32 s90, s96, 3
    s_lshl_b32 s91, s53, 2
    s_add_u32 s90, s90, s91
    s_lshl_b32 s91, s90, 16
    s_add_u32 s91, s91, 2048
    s_and_b32 s92, s90, 63
    s_lshl_b32 s92, s92, 17
    s_lshr_b32 s93, s90, 6
    s_lshl_b32 s93, s93, 12
    s_add_u32 s92, s92, s93
    s_cmp_eq_u32 s95, 1
    s_cselect_b32 s71, s92, s91
    s_lshl_b32 s72, 0x10000, s95
    s_lshl_b32 s92, s97, 8
    s_lshl_b32 s93, s40, 7
    s_add_u32 s71, s71, s92
    s_add_u32 s71, s71, s93
    v_mov_b64 v[64:65], 0
    v_mov_b64 v[66:67], 0
    v_mov_b64 v[68:69], 0
    v_mov_b64 v[70:71], 0
    v_mov_b64 v[72:73], 0
    v_mov_b64 v[74:75], 0
    v_mov_b64 v[76:77], 0
    v_mov_b64 v[78:79], 0
    v_mov_b64 v[80:81], 0
    v_mov_b64 v[82:83], 0
    v_mov_b64 v[84:85], 0
    v_mov_b64 v[86:87], 0
    v_mov_b64 v[88:89], 0
    v_mov_b64 v[90:91], 0
    v_mov_b64 v[92:93], 0
    v_mov_b64 v[94:95], 0
    v_mov_b64 v[96:97], 0
    v_mov_b64 v[98:99], 0
    v_mov_b64 v[100:101], 0
    v_mov_b64 v[102:103], 0
    v_mov_b64 v[104:105], 0
    v_mov_b64 v[106:107], 0
    v_mov_b64 v[108:109], 0
    v_mov_b64 v[110:111], 0
    v_mov_b64 v[112:113], 0
    v_mov_b64 v[114:115], 0
    v_mov_b64 v[116:117], 0
    v_mov_b64 v[118:119], 0
    v_mov_b64 v[120:121], 0
    v_mov_b64 v[122:123], 0
    v_mov_b64 v[124:125], 0
    v_mov_b64 v[126:127], 0
    v_and_b32 v48, 15, v1
    v_lshrrev_b32 v49, 4, v1
    v_lshlrev_b32 v49, 2, v49
    v_sub_u32 v48, v48, v49
    v_cmp_ge_i32 vcc, -9, v48
    v_subrev_u32 v50, 0, v48
    v_cmp_ge_u32 s[76:77], 7, v50
    s_nop 0
    v_cndmask_b32 v128, v9, 0, vcc
    v_cndmask_b32 v132, v9, 0, s[76:77]
    v_cmp_ge_i32 vcc, -8, v48
    v_subrev_u32 v50, 1, v48
    v_cmp_ge_u32 s[76:77], 7, v50
    s_nop 0
    v_cndmask_b32 v129, v9, 0, vcc
    v_cndmask_b32 v133, v9, 0, s[76:77]
    v_cmp_ge_i32 vcc, -7, v48
    v_subrev_u32 v50, 2, v48
    v_cmp_ge_u32 s[76:77], 7, v50
    s_nop 0
    v_cndmask_b32 v130, v9, 0, vcc
    v_cndmask_b32 v134, v9, 0, s[76:77]
    v_cmp_ge_i32 vcc, -6, v48
    v_subrev_u32 v50, 3, v48
    v_cmp_ge_u32 s[76:77], 7, v50
    s_nop 0
    v_cndmask_b32 v131, v9, 0, vcc
    v_cndmask_b32 v135, v9, 0, s[76:77]
    s_cmp_eq_u32 s81, 0
    s_cselect_b64 vcc, -1, 0
    s_nop 0
    v_cndmask_b32 v136, v128, v9, vcc
    v_cndmask_b32 v137, v129, v9, vcc
    v_cndmask_b32 v138, v130, v9, vcc
    v_cndmask_b32 v139, v131, v9, vcc
    s_lshl_b32 s90, s80, 10
    s_lshr_b32 s91, s2, 3
    s_lshl_b32 s91, s91, 17
    s_add_u32 s90, s90, s91
    s_add_u32 s80, s90, 83886080
    s_add_u32 s59, s60, 131072
    s_mov_b32 s58, 0
    s_mov_b32 s100, 32768
    s_mov_b32 s64, 0
    s_mov_b32 s67, 0
    s_waitcnt vmcnt(0)
    s_barrier
    s_lshl_b32 s91, s33, 5
    s_add_u32 s91, s91, s32
    s_lshl_b32 s91, s91, 3
    s_add_u32 s91, s91, 7936
    s_cmp_lg_u32 s16, 0
    s_cbranch_scc1 m_np141
    v_mov_b32 v60, s4
    v_mov_b32 v61, s5
    s_add_u32 s90, s91, 117440512
    s_mov_b64 exec, 1
    buffer_store_dwordx2 v[60:61], off, s[8:11], s90 sc1
    s_mov_b64 exec, -1
m_np141:
    s_cmp_eq_u32 s101, -1
    s_cbranch_scc1 m_pb142
    s_cmp_lg_u32 s16, 0
    s_cbranch_scc1 m_np144
    v_mov_b32 v60, s4
    v_mov_b32 v61, s5
    s_add_u32 s90, s101, 117440512
    s_mov_b64 exec, 1
    buffer_store_dwordx2 v[60:61], off, s[8:11], s90 sc1
    s_mov_b64 exec, -1
m_np144:
m_pb142:
    v_cmp_ne_u64 s[76:77], s[4:5], v[4:5]
    s_mul_i32 s91, s95, 20
    s_nop 2
    s_lshr_b32 s90, s76, s91
    s_ff1_i32_b32 s90, s90
    s_lshl_b32 s68, s90, 1
    s_mul_i32 s91, s95, 0
    s_sub_i32 s68, s68, s91
    s_cmp_lt_i32 s90, 0
    s_cselect_b32 s68, 1000, s68
    s_add_u32 m0, s60, 16384
    s_nop 0
    buffer_load_dwordx4 v16, s[24:27], s57 offen offset:0 sc1 lds
    buffer_load_dwordx4 v17, s[24:27], s57 offen offset:1024 sc1 lds
    buffer_load_dwordx4 v18, s[24:27], s57 offen offset:2048 sc1 lds
    buffer_load_dwordx4 v19, s[24:27], s57 offen offset:3072 sc1 lds
    s_add_u32 s57, s57, 131072
    s_add_u32 m0, s60, 49152
    s_nop 0
    buffer_load_dwordx4 v16, s[24:27], s57 offen offset:0 sc1 lds
    buffer_load_dwordx4 v17, s[24:27], s57 offen offset:1024 sc1 lds
    buffer_load_dwordx4 v18, s[24:27], s57 offen offset:2048 sc1 lds
    buffer_load_dwordx4 v19, s[24:27], s57 offen offset:3072 sc1 lds
    s_add_u32 s57, s57, 131072
    s_add_u32 m0, s60, 81920
    s_nop 0
    buffer_load_dwordx4 v16, s[24:27], s57 offen offset:0 sc1 lds
    buffer_load_dwordx4 v17, s[24:27], s57 offen offset:1024 sc1 lds
    buffer_load_dwordx4 v18, s[24:27], s57 offen offset:2048 sc1 lds
    buffer_load_dwordx4 v19, s[24:27], s57 offen offset:3072 sc1 lds
    s_add_u32 s57, s57, 131072
    s_add_u32 m0, s60, 114688
    s_nop 0
    buffer_load_dwordx4 v16, s[24:27], s57 offen offset:0 sc1 lds
    buffer_load_dwordx4 v17, s[24:27], s57 offen offset:1024 sc1 lds
    buffer_load_dwordx4 v18, s[24:27], s57 offen offset:2048 sc1 lds
    buffer_load_dwordx4 v19, s[24:27], s57 offen offset:3072 sc1 lds
    s_add_u32 s57, s57, 131072
    s_cmp_gt_i32 s68, 4
    s_cbranch_scc1 m_x3143
    s_mov_b32 s3, 1048576
m_spin145:
    buffer_load_dwordx2 v[4:5], v10, s[8:11], s52 offen sc1
    s_waitcnt vmcnt(0)
    v_cmp_ne_u64 s[76:77], s[4:5], v[4:5]
    s_mul_i32 s91, s95, 20
    s_nop 2
    s_lshr_b32 s90, s76, s91
    s_ff1_i32_b32 s90, s90
    s_lshl_b32 s68, s90, 1
    s_mul_i32 s91, s95, 0
    s_sub_i32 s68, s68, s91
    s_cmp_lt_i32 s90, 0
    s_cselect_b32 s68, 1000, s68
    s_cmp_gt_i32 s68, 4
    s_cbranch_scc1 m_ok146
    s_sub_u32 s3, s3, 1
    s_cbranch_scc1 m_ok146
    s_sleep 4
    s_branch m_spin145
m_ok146:
m_x3143:
    s_add_u32 m0, s60, 0
    s_nop 0
    buffer_load_dwordx4 v2, s[36:39], s56 offen offset:0 sc1 lds
    buffer_load_dwordx4 v2, s[36:39], s56 offen offset:1024 sc1 lds
    buffer_load_dwordx4 v2, s[36:39], s56 offen offset:2048 sc1 lds
    buffer_load_dwordx4 v2, s[36:39], s56 offen offset:3072 sc1 lds
    s_add_u32 s56, s56, 262144
    s_add_u32 m0, s60, 32768
    s_nop 0
    buffer_load_dwordx4 v2, s[36:39], s56 offen offset:0 sc1 lds
    buffer_load_dwordx4 v2, s[36:39], s56 offen offset:1024 sc1 lds
    buffer_load_dwordx4 v2, s[36:39], s56 offen offset:2048 sc1 lds
    buffer_load_dwordx4 v2, s[36:39], s56 offen offset:3072 sc1 lds
    s_add_u32 s56, s56, 262144
    s_add_u32 m0, s60, 65536
    s_nop 0
    buffer_load_dwordx4 v2, s[36:39], s56 offen offset:0 sc1 lds
    buffer_load_dwordx4 v2, s[36:39], s56 offen offset:1024 sc1 lds
    buffer_load_dwordx4 v2, s[36:39], s56 offen offset:2048 sc1 lds
    buffer_load_dwordx4 v2, s[36:39], s56 offen offset:3072 sc1 lds
    s_add_u32 s56, s56, 262144
    s_add_u32 m0, s60, 98304
    s_nop 0
    buffer_load_dwordx4 v2, s[36:39], s56 offen offset:0 sc1 lds
    buffer_load_dwordx4 v2, s[36:39], s56 offen offset:1024 sc1 lds
    buffer_load_dwordx4 v2, s[36:39], s56 offen offset:2048 sc1 lds
    buffer_load_dwordx4 v2, s[36:39], s56 offen offset:3072 sc1 lds
    s_add_u32 s56, s56, 262144
    s_add_u32 m0, s60, 131072
    s_nop 0
    buffer_load_dwordx4 v2, s[36:39], s56 offen offset:0 sc1 lds
    buffer_load_dwordx4 v2, s[36:39], s56 offen offset:1024 sc1 lds
    buffer_load_dwordx4 v2, s[36:39], s56 offen offset:2048 sc1 lds
    buffer_load_dwordx4 v2, s[36:39], s56 offen offset:3072 sc1 lds
    s_add_u32 s56, s56, 262144
    s_waitcnt vmcnt(16)
    s_barrier
    ds_read_b128 a[0:3], v6 offset:0
    ds_read_b64_tr_b16 a[16:17], v12 offset:0
    ds_read_b64_tr_b16 a[18:19], v12 offset:4096
    ds_read_b128 a[4:7], v6 offset:1024
    ds_read_b128 a[8:11], v6 offset:2048
    ds_read_b128 a[12:15], v6 offset:3072
    ds_read_b64_tr_b16 a[20:21], v13 offset:0
    ds_read_b64_tr_b16 a[22:23], v13 offset:4096
    ds_read_b64_tr_b16 a[24:25], v14 offset:0
    ds_read_b64_tr_b16 a[26:27], v14 offset:4096
    ds_read_b64_tr_b16 a[28:29], v15 offset:0
    ds_read_b64_tr_b16 a[30:31], v15 offset:4096
    s_cmp_gt_i32 s68, 5
    s_cbranch_scc0 m_lp152
m_lr153:
    s_waitcnt lgkmcnt(9)
    v_mfma_f32_16x16x32_bf16 v[64:67], a[16:19], a[0:3], v[64:67]
    s_add_u32 m0, s59, 16384
    ds_read_b128 a[32:35], v6 offset:8192
    v_mfma_f32_16x16x32_bf16 v[148:151], v[208:211], v[192:195], v[136:139]
    v_mfma_f32_16x16x32_bf16 v[152:155], v[212:215], v[192:195], v[132:135]
    s_waitcnt lgkmcnt(9)
    v_mfma_f32_16x16x32_bf16 v[72:75], a[16:19], a[4:7], v[72:75]
    ds_read_b64_tr_b16 a[48:49], v12 offset:8192
    buffer_load_dwordx4 v16, s[24:27], s57 offen offset:0 sc1 lds
    v_mfma_f32_16x16x32_bf16 v[156:159], v[212:215], v[196:199], v[128:131]
    s_waitcnt lgkmcnt(9)
    v_mfma_f32_16x16x32_bf16 v[80:83], a[16:19], a[8:11], v[80:83]
    s_add_u32 s59, s58, s60
    ds_read_b64_tr_b16 a[50:51], v12 offset:12288
    v_mfma_f32_16x16x32_bf16 v[160:163], v[216:219], v[196:199], v[132:135]
    v_mfma_f32_16x16x32_bf16 v[164:167], v[216:219], v[200:203], v[128:131]
    s_waitcnt lgkmcnt(9)
    v_mfma_f32_16x16x32_bf16 v[88:91], a[16:19], a[12:15], v[88:91]
    s_add_u32 s58, s58, 32768
    ds_read_b128 a[36:39], v6 offset:9216
    v_mfma_f32_16x16x32_bf16 v[168:171], v[220:223], v[200:203], v[132:135]
    v_mfma_f32_16x16x32_bf16 v[172:175], v[220:223], v[204:207], v[128:131]
    s_waitcnt lgkmcnt(8)
    v_mfma_f32_16x16x32_bf16 v[68:71], a[20:23], a[0:3], v[68:71]
    s_cmp_ge_u32 s58, 163840
    ds_read_b128 a[40:43], v6 offset:10240
    v_mfma_f32_16x16x32_bf16 v[176:179], v[224:227], v[204:207], v[132:135]
    s_nop 1
    v_mfma_f32_16x16x32_bf16 v[76:79], a[20:23], a[4:7], v[76:79]
    ds_read_b128 a[44:47], v6 offset:11264
    buffer_load_dwordx4 v17, s[24:27], s57 offen offset:1024 sc1 lds
    s_nop 1
    v_mfma_f32_16x16x32_bf16 v[84:87], a[20:23], a[8:11], v[84:87]
    s_cselect_b32 s66, 4294836224, s100
    ds_read_b64_tr_b16 a[52:53], v13 offset:8192
    s_nop 1
    s_nop 1
    v_mfma_f32_16x16x32_bf16 v[92:95], a[20:23], a[12:15], v[92:95]
    s_cselect_b32 s58, 0, s58
    ds_read_b64_tr_b16 a[54:55], v13 offset:12288
    v_max3_f32 v140, v148, v149, v150
    v_max3_f32 v141, v156, v157, v158
    s_waitcnt lgkmcnt(10)
    v_mfma_f32_16x16x32_bf16 v[96:99], a[24:27], a[0:3], v[96:99]
    ds_read_b64_tr_b16 a[56:57], v14 offset:8192
    v_max3_f32 v142, v164, v165, v166
    v_max3_f32 v143, v172, v173, v174
    v_mfma_f32_16x16x32_bf16 v[104:107], a[24:27], a[4:7], v[104:107]
    ds_read_b64_tr_b16 a[58:59], v14 offset:12288
    buffer_load_dwordx4 v18, s[24:27], s57 offen offset:2048 sc1 lds
    v_max3_f32 v140, v140, v151, v152
    v_mfma_f32_16x16x32_bf16 v[112:115], a[24:27], a[8:11], v[112:115]
    ds_read_b64_tr_b16 a[60:61], v15 offset:8192
    v_max3_f32 v141, v141, v159, v160
    v_max3_f32 v142, v142, v167, v168
    v_mfma_f32_16x16x32_bf16 v[120:123], a[24:27], a[12:15], v[120:123]
    ds_read_b64_tr_b16 a[62:63], v15 offset:12288
    v_max3_f32 v143, v143, v175, v176
    v_max3_f32 v140, v140, v153, v154
    s_waitcnt lgkmcnt(12)
    v_mfma_f32_16x16x32_bf16 v[100:103], a[28:31], a[0:3], v[100:103]
    v_add_u32 v6, s66, v6
    v_add_u32 v12, s66, v12
    v_max3_f32 v141, v141, v161, v162
    v_mfma_f32_16x16x32_bf16 v[108:111], a[28:31], a[4:7], v[108:111]
    buffer_load_dwordx4 v19, s[24:27], s57 offen offset:3072 sc1 lds
    v_max3_f32 v142, v142, v169, v170
    v_mfma_f32_16x16x32_bf16 v[116:119], a[28:31], a[8:11], v[116:119]
    s_add_u32 s57, s57, 131072
    v_add_u32 v13, s66, v13
    v_add_u32 v14, s66, v14
    v_max3_f32 v143, v143, v177, v178
    v_mfma_f32_16x16x32_bf16 v[124:127], a[28:31], a[12:15], v[124:127]
    s_mov_b32 m0, s59
    v_add_u32 v15, s66, v15
    v_max_f32 v140, v140, v155
    s_waitcnt vmcnt(16) lgkmcnt(0)
    v_mfma_f32_16x16x32_bf16 v[64:67], a[48:51], a[32:35], v[64:67]
    s_barrier
    v_max_f32 v141, v141, v163
    v_max_f32 v142, v142, v171
    v_mfma_f32_16x16x32_bf16 v[72:75], a[48:51], a[36:39], v[72:75]
    ds_read_b128 a[0:3], v6 offset:0
    buffer_load_dwordx4 v2, s[36:39], s56 offen offset:0 sc1 lds
    v_max_f32 v143, v143, v179
    v_mfma_f32_16x16x32_bf16 v[80:83], a[48:51], a[40:43], v[80:83]
    ds_read_b64_tr_b16 a[16:17], v12 offset:0
    v_mov_b32 v144, v140
    v_mov_b32 v145, v141
    v_mfma_f32_16x16x32_bf16 v[88:91], a[48:51], a[44:47], v[88:91]
    ds_read_b64_tr_b16 a[18:19], v12 offset:4096
    v_mov_b32 v146, v142
    v_mov_b32 v147, v143
    v_mfma_f32_16x16x32_bf16 v[68:71], a[52:55], a[32:35], v[68:71]
    ds_read_b128 a[4:7], v6 offset:1024
    s_nop 1
    v_permlane32_swap_b32 v140, v144
    v_mfma_f32_16x16x32_bf16 v[76:79], a[52:55], a[36:39], v[76:79]
    ds_read_b128 a[8:11], v6 offset:2048
    buffer_load_dwordx4 v2, s[36:39], s56 offen offset:1024 sc1 lds
    v_permlane32_swap_b32 v141, v145
    v_mfma_f32_16x16x32_bf16 v[84:87], a[52:55], a[40:43], v[84:87]
    ds_read_b128 a[12:15], v6 offset:3072
    v_permlane32_swap_b32 v142, v146
    v_permlane32_swap_b32 v143, v147
    v_mfma_f32_16x16x32_bf16 v[92:95], a[52:55], a[44:47], v[92:95]
    ds_read_b64_tr_b16 a[20:21], v13 offset:0
    s_nop 1
    v_max_f32 v140, v140, v144
    v_mfma_f32_16x16x32_bf16 v[96:99], a[56:59], a[32:35], v[96:99]
    ds_read_b64_tr_b16 a[22:23], v13 offset:4096
    v_max_f32 v141, v141, v145
    v_max_f32 v142, v142, v146
    v_mfma_f32_16x16x32_bf16 v[104:107], a[56:59], a[36:39], v[104:107]
    ds_read_b64_tr_b16 a[24:25], v14 offset:0
    buffer_load_dwordx4 v2, s[36:39], s56 offen offset:2048 sc1 lds
    v_max_f32 v143, v143, v147
    v_mfma_f32_16x16x32_bf16 v[112:115], a[56:59], a[40:43], v[112:115]
    ds_read_b64_tr_b16 a[26:27], v14 offset:4096
    v_mov_b32 v144, v140
    v_mov_b32 v145, v141
    v_mfma_f32_16x16x32_bf16 v[120:123], a[56:59], a[44:47], v[120:123]
    ds_read_b64_tr_b16 a[28:29], v15 offset:0
    v_mov_b32 v146, v142
    v_mov_b32 v147, v143
    v_mfma_f32_16x16x32_bf16 v[100:103], a[60:63], a[32:35], v[100:103]
    s_add_u32 s64, s64, 1
    ds_read_b64_tr_b16 a[30:31], v15 offset:4096
    s_nop 1
    v_permlane16_swap_b32 v140, v144
    v_mfma_f32_16x16x32_bf16 v[108:111], a[60:63], a[36:39], v[108:111]
    buffer_load_dwordx4 v2, s[36:39], s56 offen offset:3072 sc1 lds
    v_permlane16_swap_b32 v141, v145
    v_mfma_f32_16x16x32_bf16 v[116:119], a[60:63], a[40:43], v[116:119]
    s_add_u32 s56, s56, 262144
    v_permlane16_swap_b32 v142, v146
    v_permlane16_swap_b32 v143, v147
    v_mfma_f32_16x16x32_bf16 v[124:127], a[60:63], a[44:47], v[124:127]
    s_nop 1
    v_max_f32 v140, v140, v144
    s_cmp_gt_i32 s68, 6
    s_cbranch_scc0 m_lp154
m_lr155:
    s_waitcnt lgkmcnt(9)
    v_mfma_f32_16x16x32_bf16 v[64:67], a[16:19], a[0:3], v[64:67]
    s_add_u32 m0, s59, 16384
    ds_read_b128 a[32:35], v6 offset:8192
    v_max_f32 v141, v141, v145
    v_max_f32 v142, v142, v146
    s_waitcnt lgkmcnt(9)
    v_mfma_f32_16x16x32_bf16 v[72:75], a[16:19], a[4:7], v[72:75]
    ds_read_b64_tr_b16 a[48:49], v12 offset:8192
    buffer_load_dwordx4 v16, s[24:27], s57 offen offset:0 sc1 lds
    v_max_f32 v143, v143, v147
    s_waitcnt lgkmcnt(9)
    v_mfma_f32_16x16x32_bf16 v[80:83], a[16:19], a[8:11], v[80:83]
    s_add_u32 s59, s58, s60
    ds_read_b64_tr_b16 a[50:51], v12 offset:12288
    v_sub_f32 v148, v148, v140
    v_sub_f32 v149, v149, v140
    s_waitcnt lgkmcnt(9)
    v_mfma_f32_16x16x32_bf16 v[88:91], a[16:19], a[12:15], v[88:91]
    s_add_u32 s58, s58, 32768
    ds_read_b128 a[36:39], v6 offset:9216
    v_sub_f32 v150, v150, v140
    v_sub_f32 v151, v151, v140
    s_waitcnt lgkmcnt(8)
    v_mfma_f32_16x16x32_bf16 v[68:71], a[20:23], a[0:3], v[68:71]
    s_cmp_ge_u32 s58, 163840
    ds_read_b128 a[40:43], v6 offset:10240
    v_sub_f32 v152, v152, v140
    v_sub_f32 v153, v153, v140
    v_mfma_f32_16x16x32_bf16 v[76:79], a[20:23], a[4:7], v[76:79]
    ds_read_b128 a[44:47], v6 offset:11264
    buffer_load_dwordx4 v17, s[24:27], s57 offen offset:1024 sc1 lds
    v_sub_f32 v154, v154, v140
    v_mfma_f32_16x16x32_bf16 v[84:87], a[20:23], a[8:11], v[84:87]
    s_cselect_b32 s66, 4294836224, s100
    ds_read_b64_tr_b16 a[52:53], v13 offset:8192
    v_sub_f32 v155, v155, v140
    v_sub_f32 v156, v156, v141
    v_mfma_f32_16x16x32_bf16 v[92:95], a[20:23], a[12:15], v[92:95]
    s_cselect_b32 s58, 0, s58
    ds_read_b64_tr_b16 a[54:55], v13 offset:12288
    v_sub_f32 v157, v157, v141
    v_sub_f32 v158, v158, v141
    s_waitcnt lgkmcnt(10)
    v_mfma_f32_16x16x32_bf16 v[96:99], a[24:27], a[0:3], v[96:99]
    ds_read_b64_tr_b16 a[56:57], v14 offset:8192
    v_sub_f32 v159, v159, v141
    v_sub_f32 v160, v160, v141
    v_mfma_f32_16x16x32_bf16 v[104:107], a[24:27], a[4:7], v[104:107]
    ds_read_b64_tr_b16 a[58:59], v14 offset:12288
    buffer_load_dwordx4 v18, s[24:27], s57 offen offset:2048 sc1 lds
    v_sub_f32 v161, v161, v141
    v_mfma_f32_16x16x32_bf16 v[112:115], a[24:27], a[8:11], v[112:115]
    ds_read_b64_tr_b16 a[60:61], v15 offset:8192
    v_sub_f32 v162, v162, v141
    v_sub_f32 v163, v163, v141
    v_mfma_f32_16x16x32_bf16 v[120:123], a[24:27], a[12:15], v[120:123]
    ds_read_b64_tr_b16 a[62:63], v15 offset:12288
    v_sub_f32 v164, v164, v142
    v_sub_f32 v165, v165, v142
    s_waitcnt lgkmcnt(12)
    v_mfma_f32_16x16x32_bf16 v[100:103], a[28:31], a[0:3], v[100:103]
    v_add_u32 v6, s66, v6
    v_add_u32 v12, s66, v12
    v_sub_f32 v166, v166, v142
    v_mfma_f32_16x16x32_bf16 v[108:111], a[28:31], a[4:7], v[108:111]
    buffer_load_dwordx4 v19, s[24:27], s57 offen offset:3072 sc1 lds
    v_sub_f32 v167, v167, v142
    v_mfma_f32_16x16x32_bf16 v[116:119], a[28:31], a[8:11], v[116:119]
    s_add_u32 s57, s57, 131072
    v_add_u32 v13, s66, v13
    v_add_u32 v14, s66, v14
    v_sub_f32 v168, v168, v142
    v_mfma_f32_16x16x32_bf16 v[124:127], a[28:31], a[12:15], v[124:127]
    s_mov_b32 m0, s59
    v_add_u32 v15, s66, v15
    v_sub_f32 v169, v169, v142
    s_waitcnt vmcnt(20) lgkmcnt(0)
    v_mfma_f32_16x16x32_bf16 v[64:67], a[48:51], a[32:35], v[64:67]
    s_barrier
    v_sub_f32 v170, v170, v142
    v_sub_f32 v171, v171, v142
    v_mfma_f32_16x16x32_bf16 v[72:75], a[48:51], a[36:39], v[72:75]
    ds_read_b128 a[0:3], v6 offset:0
    buffer_load_dwordx4 v2, s[36:39], s56 offen offset:0 sc1 lds
    v_sub_f32 v172, v172, v143
    v_mfma_f32_16x16x32_bf16 v[80:83], a[48:51], a[40:43], v[80:83]
    ds_read_b64_tr_b16 a[16:17], v12 offset:0
    v_sub_f32 v173, v173, v143
    v_sub_f32 v174, v174, v143
    v_mfma_f32_16x16x32_bf16 v[88:91], a[48:51], a[44:47], v[88:91]
    ds_read_b64_tr_b16 a[18:19], v12 offset:4096
    v_sub_f32 v175, v175, v143
    v_sub_f32 v176, v176, v143
    v_mfma_f32_16x16x32_bf16 v[68:71], a[52:55], a[32:35], v[68:71]
    ds_read_b128 a[4:7], v6 offset:1024
    v_sub_f32 v177, v177, v143
    v_sub_f32 v178, v178, v143
    v_mfma_f32_16x16x32_bf16 v[76:79], a[52:55], a[36:39], v[76:79]
    ds_read_b128 a[8:11], v6 offset:2048
    buffer_load_dwordx4 v2, s[36:39], s56 offen offset:1024 sc1 lds
    v_sub_f32 v179, v179, v143
    v_mfma_f32_16x16x32_bf16 v[84:87], a[52:55], a[40:43], v[84:87]
    ds_read_b128 a[12:15], v6 offset:3072
    v_exp_f32 v148, v148
    v_exp_f32 v149, v149
    v_mfma_f32_16x16x32_bf16 v[92:95], a[52:55], a[44:47], v[92:95]
    ds_read_b64_tr_b16 a[20:21], v13 offset:0
    v_exp_f32 v150, v150
    v_exp_f32 v151, v151
    v_mfma_f32_16x16x32_bf16 v[96:99], a[56:59], a[32:35], v[96:99]
    ds_read_b64_tr_b16 a[22:23], v13 offset:4096
    v_exp_f32 v152, v152
    v_exp_f32 v153, v153
    v_mfma_f32_16x16x32_bf16 v[104:107], a[56:59], a[36:39], v[104:107]
    ds_read_b64_tr_b16 a[24:25], v14 offset:0
    buffer_load_dwordx4 v2, s[36:39], s56 offen offset:2048 sc1 lds
    v_exp_f32 v154, v154
    v_mfma_f32_16x16x32_bf16 v[112:115], a[56:59], a[40:43], v[112:115]
    ds_read_b64_tr_b16 a[26:27], v14 offset:4096
    v_exp_f32 v155, v155
    v_exp_f32 v156, v156
    v_mfma_f32_16x16x32_bf16 v[120:123], a[56:59], a[44:47], v[120:123]
    ds_read_b64_tr_b16 a[28:29], v15 offset:0
    v_exp_f32 v157, v157
    v_exp_f32 v158, v158
    v_mfma_f32_16x16x32_bf16 v[100:103], a[60:63], a[32:35], v[100:103]
    s_add_u32 s64, s64, 1
    ds_read_b64_tr_b16 a[30:31], v15 offset:4096
    v_exp_f32 v159, v159
    v_exp_f32 v160, v160
    v_mfma_f32_16x16x32_bf16 v[108:111], a[60:63], a[36:39], v[108:111]
    buffer_load_dwordx4 v2, s[36:39], s56 offen offset:3072 sc1 lds
    v_exp_f32 v161, v161
    v_mfma_f32_16x16x32_bf16 v[116:119], a[60:63], a[40:43], v[116:119]
    s_add_u32 s56, s56, 262144
    v_exp_f32 v162, v162
    v_exp_f32 v163, v163
    v_mfma_f32_16x16x32_bf16 v[124:127], a[60:63], a[44:47], v[124:127]
    v_exp_f32 v164, v164
    v_exp_f32 v165, v165
    s_cmp_gt_i32 s68, 7
    s_cbranch_scc0 m_lp156
m_lr157:
    s_waitcnt lgkmcnt(9)
    v_mfma_f32_16x16x32_bf16 v[64:67], a[16:19], a[0:3], v[64:67]
    s_add_u32 m0, s59, 16384
    ds_read_b128 a[32:35], v6 offset:8192
    v_exp_f32 v166, v166
    v_exp_f32 v167, v167
    s_waitcnt lgkmcnt(9)
    v_mfma_f32_16x16x32_bf16 v[72:75], a[16:19], a[4:7], v[72:75]
    ds_read_b64_tr_b16 a[48:49], v12 offset:8192
    buffer_load_dwordx4 v16, s[24:27], s57 offen offset:0 sc1 lds
    v_exp_f32 v168, v168
    s_waitcnt lgkmcnt(9)
    v_mfma_f32_16x16x32_bf16 v[80:83], a[16:19], a[8:11], v[80:83]
    s_add_u32 s59, s58, s60
    ds_read_b64_tr_b16 a[50:51], v12 offset:12288
    v_exp_f32 v169, v169
    v_exp_f32 v170, v170
    s_waitcnt lgkmcnt(9)
    v_mfma_f32_16x16x32_bf16 v[88:91], a[16:19], a[12:15], v[88:91]
    s_add_u32 s58, s58, 32768
    ds_read_b128 a[36:39], v6 offset:9216
    v_exp_f32 v171, v171
    v_exp_f32 v172, v172
    s_waitcnt lgkmcnt(8)
    v_mfma_f32_16x16x32_bf16 v[68:71], a[20:23], a[0:3], v[68:71]
    s_cmp_ge_u32 s58, 163840
    ds_read_b128 a[40:43], v6 offset:10240
    v_exp_f32 v173, v173
    v_exp_f32 v174, v174
    v_mfma_f32_16x16x32_bf16 v[76:79], a[20:23], a[4:7], v[76:79]
    ds_read_b128 a[44:47], v6 offset:11264
    buffer_load_dwordx4 v17, s[24:27], s57 offen offset:1024 sc1 lds
    v_exp_f32 v175, v175
    v_mfma_f32_16x16x32_bf16 v[84:87], a[20:23], a[8:11], v[84:87]
    s_cselect_b32 s66, 4294836224, s100
    ds_read_b64_tr_b16 a[52:53], v13 offset:8192
    v_exp_f32 v176, v176
    v_exp_f32 v177, v177
    v_mfma_f32_16x16x32_bf16 v[92:95], a[20:23], a[12:15], v[92:95]
    s_cselect_b32 s58, 0, s58
    ds_read_b64_tr_b16 a[54:55], v13 offset:12288
    v_exp_f32 v178, v178
    v_exp_f32 v179, v179
    s_waitcnt lgkmcnt(10)
    v_mfma_f32_16x16x32_bf16 v[96:99], a[24:27], a[0:3], v[96:99]
    ds_read_b64_tr_b16 a[56:57], v14 offset:8192
    v_cvt_pk_bf16_f32 v192, v148, v149
    v_cvt_pk_bf16_f32 v193, v150, v151
    v_mfma_f32_16x16x32_bf16 v[104:107], a[24:27], a[4:7], v[104:107]
    ds_read_b64_tr_b16 a[58:59], v14 offset:12288
    buffer_load_dwordx4 v18, s[24:27], s57 offen offset:2048 sc1 lds
    v_cvt_pk_bf16_f32 v194, v152, v153
    v_mfma_f32_16x16x32_bf16 v[112:115], a[24:27], a[8:11], v[112:115]
    ds_read_b64_tr_b16 a[60:61], v15 offset:8192
    v_cvt_pk_bf16_f32 v195, v154, v155
    v_cvt_pk_bf16_f32 v196, v156, v157
    v_mfma_f32_16x16x32_bf16 v[120:123], a[24:27], a[12:15], v[120:123]
    ds_read_b64_tr_b16 a[62:63], v15 offset:12288
    v_cvt_pk_bf16_f32 v197, v158, v159
    v_cvt_pk_bf16_f32 v198, v160, v161
    s_waitcnt lgkmcnt(12)
    v_mfma_f32_16x16x32_bf16 v[100:103], a[28:31], a[0:3], v[100:103]
    v_add_u32 v6, s66, v6
    v_add_u32 v12, s66, v12
    v_cvt_pk_bf16_f32 v199, v162, v163
    v_mfma_f32_16x16x32_bf16 v[108:111], a[28:31], a[4:7], v[108:111]
    buffer_load_dwordx4 v19, s[24:27], s57 offen offset:3072 sc1 lds
    v_cvt_pk_bf16_f32 v200, v164, v165
    v_mfma_f32_16x16x32_bf16 v[116:119], a[28:31], a[8:11], v[116:119]
    s_add_u32 s57, s57, 131072
    v_add_u32 v13, s66, v13
    v_add_u32 v14, s66, v14
    v_cvt_pk_bf16_f32 v201, v166, v167
    v_mfma_f32_16x16x32_bf16 v[124:127], a[28:31], a[12:15], v[124:127]
    s_mov_b32 m0, s59
    v_add_u32 v15, s66, v15
    v_cvt_pk_bf16_f32 v202, v168, v169
    s_waitcnt vmcnt(24) lgkmcnt(0)
    v_mfma_f32_16x16x32_bf16 v[64:67], a[48:51], a[32:35], v[64:67]
    s_barrier
    v_cvt_pk_bf16_f32 v203, v170, v171
    v_cvt_pk_bf16_f32 v204, v172, v173
    v_mfma_f32_16x16x32_bf16 v[72:75], a[48:51], a[36:39], v[72:75]
    ds_read_b128 a[0:3], v6 offset:0
    buffer_load_dwordx4 v2, s[36:39], s56 offen offset:0 sc1 lds
    v_cvt_pk_bf16_f32 v205, v174, v175
    v_mfma_f32_16x16x32_bf16 v[80:83], a[48:51], a[40:43], v[80:83]
    ds_read_b64_tr_b16 a[16:17], v12 offset:0
    v_cvt_pk_bf16_f32 v206, v176, v177
    v_cvt_pk_bf16_f32 v207, v178, v179
    v_mfma_f32_16x16x32_bf16 v[88:91], a[48:51], a[44:47], v[88:91]
    ds_read_b64_tr_b16 a[18:19], v12 offset:4096
    s_nop 1
    v_mfma_f32_16x16x32_bf16 v[20:23], v[44:47], v[192:195], 0
    v_mfma_f32_16x16x32_bf16 v[68:71], a[52:55], a[32:35], v[68:71]
    ds_read_b128 a[4:7], v6 offset:1024
    v_mfma_f32_16x16x32_bf16 v[24:27], v[44:47], v[196:199], 0
    v_mfma_f32_16x16x32_bf16 v[28:31], v[44:47], v[200:203], 0
    v_mfma_f32_16x16x32_bf16 v[76:79], a[52:55], a[36:39], v[76:79]
    ds_read_b128 a[8:11], v6 offset:2048
    buffer_load_dwordx4 v2, s[36:39], s56 offen offset:1024 sc1 lds
    v_mfma_f32_16x16x32_bf16 v[32:35], v[44:47], v[204:207], 0
    v_mfma_f32_16x16x32_bf16 v[84:87], a[52:55], a[40:43], v[84:87]
    ds_read_b128 a[12:15], v6 offset:3072
    v_mfma_f32_16x16x32_bf16 v[148:151], v[230:233], v[192:195], 0
    v_mfma_f32_16x16x32_bf16 v[152:155], v[242:245], v[192:195], 0
    v_mfma_f32_16x16x32_bf16 v[92:95], a[52:55], a[44:47], v[92:95]
    ds_read_b64_tr_b16 a[20:21], v13 offset:0
    v_mfma_f32_16x16x32_bf16 v[156:159], v[232:235], v[196:199], 0
    v_mfma_f32_16x16x32_bf16 v[160:163], v[244:247], v[196:199], 0
    v_mfma_f32_16x16x32_bf16 v[96:99], a[56:59], a[32:35], v[96:99]
    ds_read_b64_tr_b16 a[22:23], v13 offset:4096
    v_mfma_f32_16x16x32_bf16 v[164:167], v[234:237], v[200:203], 0
    v_mfma_f32_16x16x32_bf16 v[168:171], v[246:249], v[200:203], 0
    v_mfma_f32_16x16x32_bf16 v[104:107], a[56:59], a[36:39], v[104:107]
    ds_read_b64_tr_b16 a[24:25], v14 offset:0
    buffer_load_dwordx4 v2, s[36:39], s56 offen offset:2048 sc1 lds
    v_mfma_f32_16x16x32_bf16 v[172:175], v[236:239], v[204:207], 0
    v_mfma_f32_16x16x32_bf16 v[112:115], a[56:59], a[40:43], v[112:115]
    ds_read_b64_tr_b16 a[26:27], v14 offset:4096
    v_mfma_f32_16x16x32_bf16 v[176:179], v[248:251], v[204:207], 0
    v_rcp_f32 v140, v20
    v_mfma_f32_16x16x32_bf16 v[120:123], a[56:59], a[44:47], v[120:123]
    ds_read_b64_tr_b16 a[28:29], v15 offset:0
    v_rcp_f32 v141, v24
    v_rcp_f32 v142, v28
    v_mfma_f32_16x16x32_bf16 v[100:103], a[60:63], a[32:35], v[100:103]
    s_add_u32 s64, s64, 1
    ds_read_b64_tr_b16 a[30:31], v15 offset:4096
    v_rcp_f32 v143, v32
    s_nop 1
    v_mfma_f32_16x16x32_bf16 v[108:111], a[60:63], a[36:39], v[108:111]
    buffer_load_dwordx4 v2, s[36:39], s56 offen offset:3072 sc1 lds
    s_nop 1
    v_mfma_f32_16x16x32_bf16 v[116:119], a[60:63], a[40:43], v[116:119]
    s_add_u32 s56, s56, 262144
    v_mul_f32 v148, v148, v140
    v_mul_f32 v149, v149, v140
    v_mfma_f32_16x16x32_bf16 v[124:127], a[60:63], a[44:47], v[124:127]
    v_mul_f32 v150, v150, v140
    v_mul_f32 v151, v151, v140
    s_cmp_gt_i32 s68, 8
    s_cbranch_scc0 m_lp158
m_lr159:
    s_waitcnt lgkmcnt(9)
    v_mfma_f32_16x16x32_bf16 v[64:67], a[16:19], a[0:3], v[64:67]
    s_add_u32 m0, s59, 16384
    ds_read_b128 a[32:35], v6 offset:8192
    v_mul_f32 v152, v152, v140
    v_mul_f32 v153, v153, v140
    s_waitcnt lgkmcnt(9)
    v_mfma_f32_16x16x32_bf16 v[72:75], a[16:19], a[4:7], v[72:75]
    ds_read_b64_tr_b16 a[48:49], v12 offset:8192
    buffer_load_dwordx4 v16, s[24:27], s57 offen offset:0 sc1 lds
    v_mul_f32 v154, v154, v140
    s_waitcnt lgkmcnt(9)
    v_mfma_f32_16x16x32_bf16 v[80:83], a[16:19], a[8:11], v[80:83]
    s_add_u32 s59, s58, s60
    ds_read_b64_tr_b16 a[50:51], v12 offset:12288
    v_mul_f32 v155, v155, v140
    v_cvt_pk_bf16_f32 v148, v148, v149
    s_waitcnt lgkmcnt(9)
    v_mfma_f32_16x16x32_bf16 v[88:91], a[16:19], a[12:15], v[88:91]
    s_add_u32 s58, s58, 32768
    ds_read_b128 a[36:39], v6 offset:9216
    v_cvt_pk_bf16_f32 v149, v150, v151
    v_cvt_pk_bf16_f32 v150, v152, v153
    s_waitcnt lgkmcnt(8)
    v_mfma_f32_16x16x32_bf16 v[68:71], a[20:23], a[0:3], v[68:71]
    s_cmp_ge_u32 s58, 163840
    ds_read_b128 a[40:43], v6 offset:10240
    v_cvt_pk_bf16_f32 v151, v154, v155
    buffer_store_dwordx4 v[148:151], v2, s[8:11], s80 offen offset:0 sc1
    v_mfma_f32_16x16x32_bf16 v[76:79], a[20:23], a[4:7], v[76:79]
    ds_read_b128 a[44:47], v6 offset:11264
    buffer_load_dwordx4 v17, s[24:27], s57 offen offset:1024 sc1 lds
    v_mul_f32 v156, v156, v141
    v_mfma_f32_16x16x32_bf16 v[84:87], a[20:23], a[8:11], v[84:87]
    s_cselect_b32 s66, 4294836224, s100
    ds_read_b64_tr_b16 a[52:53], v13 offset:8192
    v_mul_f32 v157, v157, v141
    v_mul_f32 v158, v158, v141
    v_mfma_f32_16x16x32_bf16 v[92:95], a[20:23], a[12:15], v[92:95]
    s_cselect_b32 s58, 0, s58
    ds_read_b64_tr_b16 a[54:55], v13 offset:12288
    v_mul_f32 v159, v159, v141
    v_mul_f32 v160, v160, v141
    s_waitcnt lgkmcnt(10)
    v_mfma_f32_16x16x32_bf16 v[96:99], a[24:27], a[0:3], v[96:99]
    ds_read_b64_tr_b16 a[56:57], v14 offset:8192
    v_mul_f32 v161, v161, v141
    v_mul_f32 v162, v162, v141
    v_mfma_f32_16x16x32_bf16 v[104:107], a[24:27], a[4:7], v[104:107]
    ds_read_b64_tr_b16 a[58:59], v14 offset:12288
    buffer_load_dwordx4 v18, s[24:27], s57 offen offset:2048 sc1 lds
    v_mul_f32 v163, v163, v141
    v_mfma_f32_16x16x32_bf16 v[112:115], a[24:27], a[8:11], v[112:115]
    ds_read_b64_tr_b16 a[60:61], v15 offset:8192
    v_cvt_pk_bf16_f32 v156, v156, v157
    v_cvt_pk_bf16_f32 v157, v158, v159
    v_mfma_f32_16x16x32_bf16 v[120:123], a[24:27], a[12:15], v[120:123]
    ds_read_b64_tr_b16 a[62:63], v15 offset:12288
    v_cvt_pk_bf16_f32 v158, v160, v161
    v_cvt_pk_bf16_f32 v159, v162, v163
    s_waitcnt lgkmcnt(12)
    v_mfma_f32_16x16x32_bf16 v[100:103], a[28:31], a[0:3], v[100:103]
    v_add_u32 v6, s66, v6
    v_add_u32 v12, s66, v12
    buffer_store_dwordx4 v[156:159], v2, s[8:11], s80 offen offset:1024 sc1
    v_mfma_f32_16x16x32_bf16 v[108:111], a[28:31], a[4:7], v[108:111]
    buffer_load_dwordx4 v19, s[24:27], s57 offen offset:3072 sc1 lds
    v_mul_f32 v164, v164, v142
    v_mfma_f32_16x16x32_bf16 v[116:119], a[28:31], a[8:11], v[116:119]
    s_add_u32 s57, s57, 131072
    v_add_u32 v13, s66, v13
    v_add_u32 v14, s66, v14
    v_mul_f32 v165, v165, v142
    v_mfma_f32_16x16x32_bf16 v[124:127], a[28:31], a[12:15], v[124:127]
    s_mov_b32 m0, s59
    v_add_u32 v15, s66, v15
    v_mul_f32 v166, v166, v142
    s_waitcnt vmcnt(24) lgkmcnt(0)
    v_mfma_f32_16x16x32_bf16 v[64:67], a[48:51], a[32:35], v[64:67]
    s_barrier
    v_mul_f32 v167, v167, v142
    v_mul_f32 v168, v168, v142
    v_mfma_f32_16x16x32_bf16 v[72:75], a[48:51], a[36:39], v[72:75]
    ds_read_b128 a[0:3], v6 offset:0
    buffer_load_dwordx4 v2, s[36:39], s56 offen offset:0 sc1 lds
    v_mul_f32 v169, v169, v142
    v_mfma_f32_16x16x32_bf16 v[80:83], a[48:51], a[40:43], v[80:83]
    ds_read_b64_tr_b16 a[16:17], v12 offset:0
    v_mul_f32 v170, v170, v142
    v_mul_f32 v171, v171, v142
    v_mfma_f32_16x16x32_bf16 v[88:91], a[48:51], a[44:47], v[88:91]
    ds_read_b64_tr_b16 a[18:19], v12 offset:4096
    v_cvt_pk_bf16_f32 v164, v164, v165
    v_cvt_pk_bf16_f32 v165, v166, v167
    v_mfma_f32_16x16x32_bf16 v[68:71], a[52:55], a[32:35], v[68:71]
    ds_read_b128 a[4:7], v6 offset:1024
    v_cvt_pk_bf16_f32 v166, v168, v169
    v_cvt_pk_bf16_f32 v167, v170, v171
    v_mfma_f32_16x16x32_bf16 v[76:79], a[52:55], a[36:39], v[76:79]
    ds_read_b128 a[8:11], v6 offset:2048
    buffer_load_dwordx4 v2, s[36:39], s56 offen offset:1024 sc1 lds
    buffer_store_dwordx4 v[164:167], v2, s[8:11], s80 offen offset:2048 sc1
    v_mfma_f32_16x16x32_bf16 v[84:87], a[52:55], a[40:43], v[84:87]
    ds_read_b128 a[12:15], v6 offset:3072
    v_mul_f32 v172, v172, v143
    v_mul_f32 v173, v173, v143
    v_mfma_f32_16x16x32_bf16 v[92:95], a[52:55], a[44:47], v[92:95]
    ds_read_b64_tr_b16 a[20:21], v13 offset:0
    v_mul_f32 v174, v174, v143
    v_mul_f32 v175, v175, v143
    v_mfma_f32_16x16x32_bf16 v[96:99], a[56:59], a[32:35], v[96:99]
    ds_read_b64_tr_b16 a[22:23], v13 offset:4096
    v_mul_f32 v176, v176, v143
    v_mul_f32 v177, v177, v143
    v_mfma_f32_16x16x32_bf16 v[104:107], a[56:59], a[36:39], v[104:107]
    ds_read_b64_tr_b16 a[24:25], v14 offset:0
    buffer_load_dwordx4 v2, s[36:39], s56 offen offset:2048 sc1 lds
    v_mul_f32 v178, v178, v143
    v_mfma_f32_16x16x32_bf16 v[112:115], a[56:59], a[40:43], v[112:115]
    ds_read_b64_tr_b16 a[26:27], v14 offset:4096
    v_mul_f32 v179, v179, v143
    v_cvt_pk_bf16_f32 v172, v172, v173
    v_mfma_f32_16x16x32_bf16 v[120:123], a[56:59], a[44:47], v[120:123]
    ds_read_b64_tr_b16 a[28:29], v15 offset:0
    v_cvt_pk_bf16_f32 v173, v174, v175
    v_cvt_pk_bf16_f32 v174, v176, v177
    v_mfma_f32_16x16x32_bf16 v[100:103], a[60:63], a[32:35], v[100:103]
    s_add_u32 s64, s64, 1
    ds_read_b64_tr_b16 a[30:31], v15 offset:4096
    v_cvt_pk_bf16_f32 v175, v178, v179
    buffer_store_dwordx4 v[172:175], v2, s[8:11], s80 offen offset:3072 sc1
    v_mfma_f32_16x16x32_bf16 v[108:111], a[60:63], a[36:39], v[108:111]
    buffer_load_dwordx4 v2, s[36:39], s56 offen offset:3072 sc1 lds
    v_mfma_f32_16x16x32_bf16 v[116:119], a[60:63], a[40:43], v[116:119]
    s_add_u32 s56, s56, 262144
    v_mfma_f32_16x16x32_bf16 v[124:127], a[60:63], a[44:47], v[124:127]
    s_branch m_l3e148
m_lp152:
    s_mov_b32 s3, 1048576
m_spin160:
    buffer_load_dwordx2 v[4:5], v10, s[8:11], s52 offen sc1
    s_waitcnt vmcnt(0)
    v_cmp_ne_u64 s[76:77], s[4:5], v[4:5]
    s_mul_i32 s91, s95, 20
    s_nop 2
    s_lshr_b32 s90, s76, s91
    s_ff1_i32_b32 s90, s90
    s_lshl_b32 s68, s90, 1
    s_mul_i32 s91, s95, 0
    s_sub_i32 s68, s68, s91
    s_cmp_lt_i32 s90, 0
    s_cselect_b32 s68, 1000, s68
    s_cmp_gt_i32 s68, 5
    s_cbranch_scc1 m_ok161
    s_sub_u32 s3, s3, 1
    s_cbranch_scc1 m_ok161
    s_sleep 4
    s_branch m_spin160
m_ok161:
    s_branch m_lr153
m_lp154:
    s_mov_b32 s3, 1048576
m_spin162:
    buffer_load_dwordx2 v[4:5], v10, s[8:11], s52 offen sc1
    s_waitcnt vmcnt(0)
    v_cmp_ne_u64 s[76:77], s[4:5], v[4:5]
    s_mul_i32 s91, s95, 20
    s_nop 2
    s_lshr_b32 s90, s76, s91
    s_ff1_i32_b32 s90, s90
    s_lshl_b32 s68, s90, 1
    s_mul_i32 s91, s95, 0
    s_sub_i32 s68, s68, s91
    s_cmp_lt_i32 s90, 0
    s_cselect_b32 s68, 1000, s68
    s_cmp_gt_i32 s68, 6
    s_cbranch_scc1 m_ok163
    s_sub_u32 s3, s3, 1
    s_cbranch_scc1 m_ok163
    s_sleep 4
    s_branch m_spin162
m_ok163:
    s_branch m_lr155
m_lp156:
    s_mov_b32 s3, 1048576
m_spin164:
    buffer_load_dwordx2 v[4:5], v10, s[8:11], s52 offen sc1
    s_waitcnt vmcnt(0)
    v_cmp_ne_u64 s[76:77], s[4:5], v[4:5]
    s_mul_i32 s91, s95, 20
    s_nop 2
    s_lshr_b32 s90, s76, s91
    s_ff1_i32_b32 s90, s90
    s_lshl_b32 s68, s90, 1
    s_mul_i32 s91, s95, 0
    s_sub_i32 s68, s68, s91
    s_cmp_lt_i32 s90, 0
    s_cselect_b32 s68, 1000, s68
    s_cmp_gt_i32 s68, 7
    s_cbranch_scc1 m_ok165
    s_sub_u32 s3, s3, 1
    s_cbranch_scc1 m_ok165
    s_sleep 4
    s_branch m_spin164
m_ok165:
    s_branch m_lr157
m_lp158:
    s_mov_b32 s3, 1048576
m_spin166:
    buffer_load_dwordx2 v[4:5], v10, s[8:11], s52 offen sc1
    s_waitcnt vmcnt(0)
    v_cmp_ne_u64 s[76:77], s[4:5], v[4:5]
    s_mul_i32 s91, s95, 20
    s_nop 2
    s_lshr_b32 s90, s76, s91
    s_ff1_i32_b32 s90, s90
    s_lshl_b32 s68, s90, 1
    s_mul_i32 s91, s95, 0
    s_sub_i32 s68, s68, s91
    s_cmp_lt_i32 s90, 0
    s_cselect_b32 s68, 1000, s68
    s_cmp_gt_i32 s68, 8
    s_cbranch_scc1 m_ok167
    s_sub_u32 s3, s3, 1
    s_cbranch_scc1 m_ok167
    s_sleep 4
    s_branch m_spin166
m_ok167:
    s_branch m_lr159
.p2align 3
m_l3147:
    s_waitcnt lgkmcnt(9)
    v_mfma_f32_16x16x32_bf16 v[64:67], a[16:19], a[0:3], v[64:67]
    s_add_u32 m0, s59, 16384
    ds_read_b128 a[32:35], v6 offset:8192
    s_waitcnt lgkmcnt(9)
    v_mfma_f32_16x16x32_bf16 v[72:75], a[16:19], a[4:7], v[72:75]
    ds_read_b64_tr_b16 a[48:49], v12 offset:8192
    buffer_load_dwordx4 v16, s[24:27], s57 offen offset:0 sc1 lds
    s_waitcnt lgkmcnt(9)
    v_mfma_f32_16x16x32_bf16 v[80:83], a[16:19], a[8:11], v[80:83]
    s_add_u32 s59, s58, s60
    ds_read_b64_tr_b16 a[50:51], v12 offset:12288
    s_waitcnt lgkmcnt(9)
    v_mfma_f32_16x16x32_bf16 v[88:91], a[16:19], a[12:15], v[88:91]
    s_add_u32 s58, s58, 32768
    ds_read_b128 a[36:39], v6 offset:9216
    s_waitcnt lgkmcnt(8)
    v_mfma_f32_16x16x32_bf16 v[68:71], a[20:23], a[0:3], v[68:71]
    s_cmp_ge_u32 s58, 163840
    ds_read_b128 a[40:43], v6 offset:10240
    v_mfma_f32_16x16x32_bf16 v[76:79], a[20:23], a[4:7], v[76:79]
    ds_read_b128 a[44:47], v6 offset:11264
    buffer_load_dwordx4 v17, s[24:27], s57 offen offset:1024 sc1 lds
    v_mfma_f32_16x16x32_bf16 v[84:87], a[20:23], a[8:11], v[84:87]
    s_cselect_b32 s66, 4294836224, s100
    ds_read_b64_tr_b16 a[52:53], v13 offset:8192
    v_mfma_f32_16x16x32_bf16 v[92:95], a[20:23], a[12:15], v[92:95]
    s_cselect_b32 s58, 0, s58
    ds_read_b64_tr_b16 a[54:55], v13 offset:12288
    s_waitcnt lgkmcnt(10)
    v_mfma_f32_16x16x32_bf16 v[96:99], a[24:27], a[0:3], v[96:99]
    ds_read_b64_tr_b16 a[56:57], v14 offset:8192
    v_mfma_f32_16x16x32_bf16 v[104:107], a[24:27], a[4:7], v[104:107]
    ds_read_b64_tr_b16 a[58:59], v14 offset:12288
    buffer_load_dwordx4 v18, s[24:27], s57 offen offset:2048 sc1 lds
    v_mfma_f32_16x16x32_bf16 v[112:115], a[24:27], a[8:11], v[112:115]
    ds_read_b64_tr_b16 a[60:61], v15 offset:8192
    v_mfma_f32_16x16x32_bf16 v[120:123], a[24:27], a[12:15], v[120:123]
    ds_read_b64_tr_b16 a[62:63], v15 offset:12288
    s_waitcnt lgkmcnt(12)
    v_mfma_f32_16x16x32_bf16 v[100:103], a[28:31], a[0:3], v[100:103]
    v_add_u32 v6, s66, v6
    v_add_u32 v12, s66, v12
    v_mfma_f32_16x16x32_bf16 v[108:111], a[28:31], a[4:7], v[108:111]
    buffer_load_dwordx4 v19, s[24:27], s57 offen offset:3072 sc1 lds
    v_mfma_f32_16x16x32_bf16 v[116:119], a[28:31], a[8:11], v[116:119]
    s_add_u32 s57, s57, 131072
    v_add_u32 v13, s66, v13
    v_add_u32 v14, s66, v14
    v_mfma_f32_16x16x32_bf16 v[124:127], a[28:31], a[12:15], v[124:127]
    s_mov_b32 m0, s59
    v_add_u32 v15, s66, v15
    s_waitcnt vmcnt(24) lgkmcnt(0)
    v_mfma_f32_16x16x32_bf16 v[64:67], a[48:51], a[32:35], v[64:67]
    s_barrier
    v_mfma_f32_16x16x32_bf16 v[72:75], a[48:51], a[36:39], v[72:75]
    ds_read_b128 a[0:3], v6 offset:0
    buffer_load_dwordx4 v2, s[36:39], s56 offen offset:0 sc1 lds
    v_mfma_f32_16x16x32_bf16 v[80:83], a[48:51], a[40:43], v[80:83]
    ds_read_b64_tr_b16 a[16:17], v12 offset:0
    v_mfma_f32_16x16x32_bf16 v[88:91], a[48:51], a[44:47], v[88:91]
    ds_read_b64_tr_b16 a[18:19], v12 offset:4096
    v_mfma_f32_16x16x32_bf16 v[68:71], a[52:55], a[32:35], v[68:71]
    ds_read_b128 a[4:7], v6 offset:1024
    v_mfma_f32_16x16x32_bf16 v[76:79], a[52:55], a[36:39], v[76:79]
    ds_read_b128 a[8:11], v6 offset:2048
    buffer_load_dwordx4 v2, s[36:39], s56 offen offset:1024 sc1 lds
    v_mfma_f32_16x16x32_bf16 v[84:87], a[52:55], a[40:43], v[84:87]
    ds_read_b128 a[12:15], v6 offset:3072
    v_mfma_f32_16x16x32_bf16 v[92:95], a[52:55], a[44:47], v[92:95]
    ds_read_b64_tr_b16 a[20:21], v13 offset:0
    v_mfma_f32_16x16x32_bf16 v[96:99], a[56:59], a[32:35], v[96:99]
    ds_read_b64_tr_b16 a[22:23], v13 offset:4096
    v_mfma_f32_16x16x32_bf16 v[104:107], a[56:59], a[36:39], v[104:107]
    ds_read_b64_tr_b16 a[24:25], v14 offset:0
    buffer_load_dwordx4 v2, s[36:39], s56 offen offset:2048 sc1 lds
    v_mfma_f32_16x16x32_bf16 v[112:115], a[56:59], a[40:43], v[112:115]
    ds_read_b64_tr_b16 a[26:27], v14 offset:4096
    v_mfma_f32_16x16x32_bf16 v[120:123], a[56:59], a[44:47], v[120:123]
    ds_read_b64_tr_b16 a[28:29], v15 offset:0
    v_mfma_f32_16x16x32_bf16 v[100:103], a[60:63], a[32:35], v[100:103]
    s_add_u32 s64, s64, 1
    ds_read_b64_tr_b16 a[30:31], v15 offset:4096
    v_mfma_f32_16x16x32_bf16 v[108:111], a[60:63], a[36:39], v[108:111]
    buffer_load_dwordx4 v2, s[36:39], s56 offen offset:3072 sc1 lds
    v_mfma_f32_16x16x32_bf16 v[116:119], a[60:63], a[40:43], v[116:119]
    s_add_u32 s56, s56, 262144
    s_cmp_lt_u32 s64, s67
    v_mfma_f32_16x16x32_bf16 v[124:127], a[60:63], a[44:47], v[124:127]
    s_cbranch_scc1 m_l3147
m_l3e148:
    s_add_u32 s92, s64, 5
    s_cmp_gt_i32 s68, s92
    s_cbranch_scc1 m_rdy168
    s_mov_b32 s3, 1048576
m_spin169:
    buffer_load_dwordx2 v[4:5], v10, s[8:11], s52 offen sc1
    s_waitcnt vmcnt(0)
    v_cmp_ne_u64 s[76:77], s[4:5], v[4:5]
    s_mul_i32 s91, s95, 20
    s_nop 2
    s_lshr_b32 s90, s76, s91
    s_ff1_i32_b32 s90, s90
    s_lshl_b32 s68, s90, 1
    s_mul_i32 s91, s95, 0
    s_sub_i32 s68, s68, s91
    s_cmp_lt_i32 s90, 0
    s_cselect_b32 s68, 1000, s68
    s_cmp_gt_i32 s68, s92
    s_cbranch_scc1 m_ok170
    s_sub_u32 s3, s3, 1
    s_cbranch_scc1 m_ok170
    s_sleep 4
    s_branch m_spin169
m_ok170:
m_rdy168:
    s_mov_b32 s67, 8
    s_cmp_lt_u32 s64, 8
    s_cbranch_scc1 m_l3n151
    s_cmp_eq_u32 s64, 8
    s_cbranch_scc1 m_o1171
m_o2172:
    s_cmp_eq_u32 s95, 0
    s_cbranch_scc1 m_l3c150
    s_mov_b32 s67, 18
    s_cmp_lt_u32 s64, 18
    s_cbranch_scc1 m_l3n151
    s_cmp_lg_u32 s64, 18
    s_cbranch_scc1 m_n173
    s_mov_b32 s68, 1000
    s_lshr_b32 s90, s96, 1
    s_lshl_b32 s90, s90, 8
    s_add_u32 s90, s90, 117452800
    buffer_load_dwordx2 v[4:5], v10, s[8:11], s90 offen sc1
    s_mov_b32 s67, 19
    s_branch m_l3147
m_n173:
    s_cmp_lg_u32 s64, 19
    s_cbranch_scc1 m_n174
    s_waitcnt vmcnt(8)
    s_waitcnt vmcnt(16)
    s_mov_b32 s3, 1048576
m_spin175:
    v_cmp_ne_u64 s[76:77], s[4:5], v[4:5]
    s_nop 3
    s_cmp_eq_u64 s[76:77], 0
    s_cbranch_scc1 m_ok176
    s_sub_u32 s3, s3, 1
    s_cbranch_scc1 m_ok176
    s_sleep 8
    s_lshr_b32 s90, s96, 1
    s_lshl_b32 s90, s90, 8
    s_add_u32 s90, s90, 117452800
    buffer_load_dwordx2 v[4:5], v10, s[8:11], s90 offen sc1
    s_waitcnt vmcnt(0)
    s_branch m_spin175
m_ok176:
    s_mov_b32 s56, s69
    s_mov_b32 s67, 20
    s_branch m_l3147
m_n174:
    s_cmp_lg_u32 s64, 20
    s_cbranch_scc1 m_n177
    s_mov_b32 s24, s50
    s_mov_b32 s25, s51
    s_mov_b32 s26, 2097152
    s_lshl_b32 s57, s97, 8
    s_mov_b32 s67, 24
    s_branch m_l3147
m_n177:
    s_cmp_lg_u32 s64, 24
    s_cbranch_scc1 m_n178
    s_lshl_b32 s90, s96, 3
    s_add_u32 s90, s90, s97
    s_lshl_b32 s90, s90, 15
    s_lshl_b32 s91, s16, 13
    s_add_u32 s90, s90, s91
    s_add_u32 s70, s90, 100663296
    s_nop 3
    v_cvt_pk_bf16_f32 v128, v64, v65
    v_cvt_pk_bf16_f32 v129, v66, v67
    v_cvt_pk_bf16_f32 v130, v68, v69
    v_cvt_pk_bf16_f32 v131, v70, v71
    v_cvt_pk_bf16_f32 v132, v72, v73
    v_cvt_pk_bf16_f32 v133, v74, v75
    v_cvt_pk_bf16_f32 v134, v76, v77
    v_cvt_pk_bf16_f32 v135, v78, v79
    v_cvt_pk_bf16_f32 v136, v80, v81
    v_cvt_pk_bf16_f32 v137, v82, v83
    v_cvt_pk_bf16_f32 v138, v84, v85
    v_cvt_pk_bf16_f32 v139, v86, v87
    v_cvt_pk_bf16_f32 v140, v88, v89
    v_cvt_pk_bf16_f32 v141, v90, v91
    v_cvt_pk_bf16_f32 v142, v92, v93
    v_cvt_pk_bf16_f32 v143, v94, v95
    v_cvt_pk_bf16_f32 v144, v96, v97
    v_cvt_pk_bf16_f32 v145, v98, v99
    v_cvt_pk_bf16_f32 v146, v100, v101
    v_cvt_pk_bf16_f32 v147, v102, v103
    v_cvt_pk_bf16_f32 v148, v104, v105
    v_cvt_pk_bf16_f32 v149, v106, v107
    v_cvt_pk_bf16_f32 v150, v108, v109
    v_cvt_pk_bf16_f32 v151, v110, v111
    v_cvt_pk_bf16_f32 v152, v112, v113
    v_cvt_pk_bf16_f32 v153, v114, v115
    v_cvt_pk_bf16_f32 v154, v116, v117
    v_cvt_pk_bf16_f32 v155, v118, v119
    v_cvt_pk_bf16_f32 v156, v120, v121
    v_cvt_pk_bf16_f32 v157, v122, v123
    v_cvt_pk_bf16_f32 v158, v124, v125
    v_cvt_pk_bf16_f32 v159, v126, v127
    v_mov_b64 v[64:65], 0
    v_mov_b64 v[66:67], 0
    v_mov_b64 v[68:69], 0
    v_mov_b64 v[70:71], 0
    v_mov_b64 v[72:73], 0
    v_mov_b64 v[74:75], 0
    v_mov_b64 v[76:77], 0
    v_mov_b64 v[78:79], 0
    v_mov_b64 v[80:81], 0
    v_mov_b64 v[82:83], 0
    v_mov_b64 v[84:85], 0
    v_mov_b64 v[86:87], 0
    v_mov_b64 v[88:89], 0
    v_mov_b64 v[90:91], 0
    v_mov_b64 v[92:93], 0
    v_mov_b64 v[94:95], 0
    v_mov_b64 v[96:97], 0
    v_mov_b64 v[98:99], 0
    v_mov_b64 v[100:101], 0
    v_mov_b64 v[102:103], 0
    v_mov_b64 v[104:105], 0
    v_mov_b64 v[106:107], 0
    v_mov_b64 v[108:109], 0
    v_mov_b64 v[110:111], 0
    v_mov_b64 v[112:113], 0
    v_mov_b64 v[114:115], 0
    v_mov_b64 v[116:117], 0
    v_mov_b64 v[118:119], 0
    v_mov_b64 v[120:121], 0
    v_mov_b64 v[122:123], 0
    v_mov_b64 v[124:125], 0
    v_mov_b64 v[126:127], 0
    s_nop 1
    s_waitcnt lgkmcnt(9)
    v_mfma_f32_16x16x32_bf16 v[64:67], a[16:19], a[0:3], v[64:67]
    s_add_u32 m0, s59, 16384
    ds_read_b128 a[32:35], v6 offset:8192
    s_waitcnt lgkmcnt(9)
    v_mfma_f32_16x16x32_bf16 v[72:75], a[16:19], a[4:7], v[72:75]
    ds_read_b64_tr_b16 a[48:49], v12 offset:8192
    buffer_load_dwordx4 v16, s[24:27], s57 offen offset:0 sc1 lds
    s_waitcnt lgkmcnt(9)
    v_mfma_f32_16x16x32_bf16 v[80:83], a[16:19], a[8:11], v[80:83]
    s_add_u32 s59, s58, s60
    ds_read_b64_tr_b16 a[50:51], v12 offset:12288
    s_waitcnt lgkmcnt(9)
    v_mfma_f32_16x16x32_bf16 v[88:91], a[16:19], a[12:15], v[88:91]
    s_add_u32 s58, s58, 32768
    ds_read_b128 a[36:39], v6 offset:9216
    s_waitcnt lgkmcnt(8)
    v_mfma_f32_16x16x32_bf16 v[68:71], a[20:23], a[0:3], v[68:71]
    s_cmp_ge_u32 s58, 163840
    ds_read_b128 a[40:43], v6 offset:10240
    v_mfma_f32_16x16x32_bf16 v[76:79], a[20:23], a[4:7], v[76:79]
    ds_read_b128 a[44:47], v6 offset:11264
    buffer_load_dwordx4 v17, s[24:27], s57 offen offset:1024 sc1 lds
    v_mfma_f32_16x16x32_bf16 v[84:87], a[20:23], a[8:11], v[84:87]
    s_cselect_b32 s66, 4294836224, s100
    ds_read_b64_tr_b16 a[52:53], v13 offset:8192
    v_mfma_f32_16x16x32_bf16 v[92:95], a[20:23], a[12:15], v[92:95]
    s_cselect_b32 s58, 0, s58
    ds_read_b64_tr_b16 a[54:55], v13 offset:12288
    s_waitcnt lgkmcnt(10)
    v_mfma_f32_16x16x32_bf16 v[96:99], a[24:27], a[0:3], v[96:99]
    ds_read_b64_tr_b16 a[56:57], v14 offset:8192
    v_mfma_f32_16x16x32_bf16 v[104:107], a[24:27], a[4:7], v[104:107]
    ds_read_b64_tr_b16 a[58:59], v14 offset:12288
    buffer_load_dwordx4 v18, s[24:27], s57 offen offset:2048 sc1 lds
    v_mfma_f32_16x16x32_bf16 v[112:115], a[24:27], a[8:11], v[112:115]
    ds_read_b64_tr_b16 a[60:61], v15 offset:8192
    v_mfma_f32_16x16x32_bf16 v[120:123], a[24:27], a[12:15], v[120:123]
    ds_read_b64_tr_b16 a[62:63], v15 offset:12288
    buffer_store_dwordx4 v[128:131], v2, s[8:11], s70 offen offset:0 sc1
    s_waitcnt lgkmcnt(12)
    v_mfma_f32_16x16x32_bf16 v[100:103], a[28:31], a[0:3], v[100:103]
    v_add_u32 v6, s66, v6
    v_add_u32 v12, s66, v12
    v_mfma_f32_16x16x32_bf16 v[108:111], a[28:31], a[4:7], v[108:111]
    buffer_load_dwordx4 v19, s[24:27], s57 offen offset:3072 sc1 lds
    v_mfma_f32_16x16x32_bf16 v[116:119], a[28:31], a[8:11], v[116:119]
    s_add_u32 s57, s57, 131072
    v_add_u32 v13, s66, v13
    v_add_u32 v14, s66, v14
    v_mfma_f32_16x16x32_bf16 v[124:127], a[28:31], a[12:15], v[124:127]
    s_mov_b32 m0, s59
    v_add_u32 v15, s66, v15
    s_waitcnt vmcnt(24) lgkmcnt(0)
    v_mfma_f32_16x16x32_bf16 v[64:67], a[48:51], a[32:35], v[64:67]
    s_barrier
    v_mfma_f32_16x16x32_bf16 v[72:75], a[48:51], a[36:39], v[72:75]
    ds_read_b128 a[0:3], v6 offset:0
    buffer_load_dwordx4 v2, s[36:39], s56 offen offset:0 sc1 lds
    v_mfma_f32_16x16x32_bf16 v[80:83], a[48:51], a[40:43], v[80:83]
    ds_read_b64_tr_b16 a[16:17], v12 offset:0
    v_mfma_f32_16x16x32_bf16 v[88:91], a[48:51], a[44:47], v[88:91]
    ds_read_b64_tr_b16 a[18:19], v12 offset:4096
    v_mfma_f32_16x16x32_bf16 v[68:71], a[52:55], a[32:35], v[68:71]
    ds_read_b128 a[4:7], v6 offset:1024
    v_mfma_f32_16x16x32_bf16 v[76:79], a[52:55], a[36:39], v[76:79]
    ds_read_b128 a[8:11], v6 offset:2048
    buffer_load_dwordx4 v2, s[36:39], s56 offen offset:1024 sc1 lds
    v_mfma_f32_16x16x32_bf16 v[84:87], a[52:55], a[40:43], v[84:87]
    ds_read_b128 a[12:15], v6 offset:3072
    v_mfma_f32_16x16x32_bf16 v[92:95], a[52:55], a[44:47], v[92:95]
    ds_read_b64_tr_b16 a[20:21], v13 offset:0
    v_mfma_f32_16x16x32_bf16 v[96:99], a[56:59], a[32:35], v[96:99]
    ds_read_b64_tr_b16 a[22:23], v13 offset:4096
    v_mfma_f32_16x16x32_bf16 v[104:107], a[56:59], a[36:39], v[104:107]
    ds_read_b64_tr_b16 a[24:25], v14 offset:0
    buffer_load_dwordx4 v2, s[36:39], s56 offen offset:2048 sc1 lds
    v_mfma_f32_16x16x32_bf16 v[112:115], a[56:59], a[40:43], v[112:115]
    ds_read_b64_tr_b16 a[26:27], v14 offset:4096
    v_mfma_f32_16x16x32_bf16 v[120:123], a[56:59], a[44:47], v[120:123]
    ds_read_b64_tr_b16 a[28:29], v15 offset:0
    buffer_store_dwordx4 v[132:135], v2, s[8:11], s70 offen offset:1024 sc1
    v_mfma_f32_16x16x32_bf16 v[100:103], a[60:63], a[32:35], v[100:103]
    s_add_u32 s64, s64, 1
    ds_read_b64_tr_b16 a[30:31], v15 offset:4096
    v_mfma_f32_16x16x32_bf16 v[108:111], a[60:63], a[36:39], v[108:111]
    buffer_load_dwordx4 v2, s[36:39], s56 offen offset:3072 sc1 lds
    v_mfma_f32_16x16x32_bf16 v[116:119], a[60:63], a[40:43], v[116:119]
    s_add_u32 s56, s56, 262144
    v_mfma_f32_16x16x32_bf16 v[124:127], a[60:63], a[44:47], v[124:127]
    s_waitcnt lgkmcnt(9)
    v_mfma_f32_16x16x32_bf16 v[64:67], a[16:19], a[0:3], v[64:67]
    s_add_u32 m0, s59, 16384
    ds_read_b128 a[32:35], v6 offset:8192
    s_waitcnt lgkmcnt(9)
    v_mfma_f32_16x16x32_bf16 v[72:75], a[16:19], a[4:7], v[72:75]
    ds_read_b64_tr_b16 a[48:49], v12 offset:8192
    buffer_load_dwordx4 v16, s[24:27], s57 offen offset:0 sc1 lds
    s_waitcnt lgkmcnt(9)
    v_mfma_f32_16x16x32_bf16 v[80:83], a[16:19], a[8:11], v[80:83]
    s_add_u32 s59, s58, s60
    ds_read_b64_tr_b16 a[50:51], v12 offset:12288
    s_waitcnt lgkmcnt(9)
    v_mfma_f32_16x16x32_bf16 v[88:91], a[16:19], a[12:15], v[88:91]
    s_add_u32 s58, s58, 32768
    ds_read_b128 a[36:39], v6 offset:9216
    s_waitcnt lgkmcnt(8)
    v_mfma_f32_16x16x32_bf16 v[68:71], a[20:23], a[0:3], v[68:71]
    s_cmp_ge_u32 s58, 163840
    ds_read_b128 a[40:43], v6 offset:10240
    v_mfma_f32_16x16x32_bf16 v[76:79], a[20:23], a[4:7], v[76:79]
    ds_read_b128 a[44:47], v6 offset:11264
    buffer_load_dwordx4 v17, s[24:27], s57 offen offset:1024 sc1 lds
    v_mfma_f32_16x16x32_bf16 v[84:87], a[20:23], a[8:11], v[84:87]
    s_cselect_b32 s66, 4294836224, s100
    ds_read_b64_tr_b16 a[52:53], v13 offset:8192
    v_mfma_f32_16x16x32_bf16 v[92:95], a[20:23], a[12:15], v[92:95]
    s_cselect_b32 s58, 0, s58
    ds_read_b64_tr_b16 a[54:55], v13 offset:12288
    s_waitcnt lgkmcnt(10)
    v_mfma_f32_16x16x32_bf16 v[96:99], a[24:27], a[0:3], v[96:99]
    ds_read_b64_tr_b16 a[56:57], v14 offset:8192
    v_mfma_f32_16x16x32_bf16 v[104:107], a[24:27], a[4:7], v[104:107]
    ds_read_b64_tr_b16 a[58:59], v14 offset:12288
    buffer_load_dwordx4 v18, s[24:27], s57 offen offset:2048 sc1 lds
    v_mfma_f32_16x16x32_bf16 v[112:115], a[24:27], a[8:11], v[112:115]
    ds_read_b64_tr_b16 a[60:61], v15 offset:8192
    v_mfma_f32_16x16x32_bf16 v[120:123], a[24:27], a[12:15], v[120:123]
    ds_read_b64_tr_b16 a[62:63], v15 offset:12288
    buffer_store_dwordx4 v[136:139], v2, s[8:11], s70 offen offset:2048 sc1
    s_waitcnt lgkmcnt(12)
    v_mfma_f32_16x16x32_bf16 v[100:103], a[28:31], a[0:3], v[100:103]
    v_add_u32 v6, s66, v6
    v_add_u32 v12, s66, v12
    v_mfma_f32_16x16x32_bf16 v[108:111], a[28:31], a[4:7], v[108:111]
    buffer_load_dwordx4 v19, s[24:27], s57 offen offset:3072 sc1 lds
    v_mfma_f32_16x16x32_bf16 v[116:119], a[28:31], a[8:11], v[116:119]
    s_add_u32 s57, s57, 131072
    v_add_u32 v13, s66, v13
    v_add_u32 v14, s66, v14
    v_mfma_f32_16x16x32_bf16 v[124:127], a[28:31], a[12:15], v[124:127]
    s_mov_b32 m0, s59
    v_add_u32 v15, s66, v15
    s_waitcnt vmcnt(24) lgkmcnt(0)
    v_mfma_f32_16x16x32_bf16 v[64:67], a[48:51], a[32:35], v[64:67]
    s_barrier
    v_mfma_f32_16x16x32_bf16 v[72:75], a[48:51], a[36:39], v[72:75]
    ds_read_b128 a[0:3], v6 offset:0
    buffer_load_dwordx4 v2, s[36:39], s56 offen offset:0 sc1 lds
    v_mfma_f32_16x16x32_bf16 v[80:83], a[48:51], a[40:43], v[80:83]
    ds_read_b64_tr_b16 a[16:17], v12 offset:0
    v_mfma_f32_16x16x32_bf16 v[88:91], a[48:51], a[44:47], v[88:91]
    ds_read_b64_tr_b16 a[18:19], v12 offset:4096
    v_mfma_f32_16x16x32_bf16 v[68:71], a[52:55], a[32:35], v[68:71]
    ds_read_b128 a[4:7], v6 offset:1024
    v_mfma_f32_16x16x32_bf16 v[76:79], a[52:55], a[36:39], v[76:79]
    ds_read_b128 a[8:11], v6 offset:2048
    buffer_load_dwordx4 v2, s[36:39], s56 offen offset:1024 sc1 lds
    v_mfma_f32_16x16x32_bf16 v[84:87], a[52:55], a[40:43], v[84:87]
    ds_read_b128 a[12:15], v6 offset:3072
    v_mfma_f32_16x16x32_bf16 v[92:95], a[52:55], a[44:47], v[92:95]
    ds_read_b64_tr_b16 a[20:21], v13 offset:0
    v_mfma_f32_16x16x32_bf16 v[96:99], a[56:59], a[32:35], v[96:99]
    ds_read_b64_tr_b16 a[22:23], v13 offset:4096
    v_mfma_f32_16x16x32_bf16 v[104:107], a[56:59], a[36:39], v[104:107]
    ds_read_b64_tr_b16 a[24:25], v14 offset:0
    buffer_load_dwordx4 v2, s[36:39], s56 offen offset:2048 sc1 lds
    v_mfma_f32_16x16x32_bf16 v[112:115], a[56:59], a[40:43], v[112:115]
    ds_read_b64_tr_b16 a[26:27], v14 offset:4096
    v_mfma_f32_16x16x32_bf16 v[120:123], a[56:59], a[44:47], v[120:123]
    ds_read_b64_tr_b16 a[28:29], v15 offset:0
    buffer_store_dwordx4 v[140:143], v2, s[8:11], s70 offen offset:3072 sc1
    s_add_u32 s70, s70, 4096
    v_mfma_f32_16x16x32_bf16 v[100:103], a[60:63], a[32:35], v[100:103]
    s_add_u32 s64, s64, 1
    ds_read_b64_tr_b16 a[30:31], v15 offset:4096
    v_mfma_f32_16x16x32_bf16 v[108:111], a[60:63], a[36:39], v[108:111]
    buffer_load_dwordx4 v2, s[36:39], s56 offen offset:3072 sc1 lds
    v_mfma_f32_16x16x32_bf16 v[116:119], a[60:63], a[40:43], v[116:119]
    s_add_u32 s56, s56, 262144
    v_mfma_f32_16x16x32_bf16 v[124:127], a[60:63], a[44:47], v[124:127]
    s_waitcnt lgkmcnt(9)
    v_mfma_f32_16x16x32_bf16 v[64:67], a[16:19], a[0:3], v[64:67]
    s_add_u32 m0, s59, 16384
    ds_read_b128 a[32:35], v6 offset:8192
    s_waitcnt lgkmcnt(9)
    v_mfma_f32_16x16x32_bf16 v[72:75], a[16:19], a[4:7], v[72:75]
    ds_read_b64_tr_b16 a[48:49], v12 offset:8192
    buffer_load_dwordx4 v16, s[24:27], s57 offen offset:0 sc1 lds
    s_waitcnt lgkmcnt(9)
    v_mfma_f32_16x16x32_bf16 v[80:83], a[16:19], a[8:11], v[80:83]
    s_add_u32 s59, s58, s60
    ds_read_b64_tr_b16 a[50:51], v12 offset:12288
    s_waitcnt lgkmcnt(9)
    v_mfma_f32_16x16x32_bf16 v[88:91], a[16:19], a[12:15], v[88:91]
    s_add_u32 s58, s58, 32768
    ds_read_b128 a[36:39], v6 offset:9216
    s_waitcnt lgkmcnt(8)
    v_mfma_f32_16x16x32_bf16 v[68:71], a[20:23], a[0:3], v[68:71]
    s_cmp_ge_u32 s58, 163840
    ds_read_b128 a[40:43], v6 offset:10240
    v_mfma_f32_16x16x32_bf16 v[76:79], a[20:23], a[4:7], v[76:79]
    ds_read_b128 a[44:47], v6 offset:11264
    buffer_load_dwordx4 v17, s[24:27], s57 offen offset:1024 sc1 lds
    v_mfma_f32_16x16x32_bf16 v[84:87], a[20:23], a[8:11], v[84:87]
    s_cselect_b32 s66, 4294836224, s100
    ds_read_b64_tr_b16 a[52:53], v13 offset:8192
    v_mfma_f32_16x16x32_bf16 v[92:95], a[20:23], a[12:15], v[92:95]
    s_cselect_b32 s58, 0, s58
    ds_read_b64_tr_b16 a[54:55], v13 offset:12288
    s_waitcnt lgkmcnt(10)
    v_mfma_f32_16x16x32_bf16 v[96:99], a[24:27], a[0:3], v[96:99]
    ds_read_b64_tr_b16 a[56:57], v14 offset:8192
    v_mfma_f32_16x16x32_bf16 v[104:107], a[24:27], a[4:7], v[104:107]
    ds_read_b64_tr_b16 a[58:59], v14 offset:12288
    buffer_load_dwordx4 v18, s[24:27], s57 offen offset:2048 sc1 lds
    v_mfma_f32_16x16x32_bf16 v[112:115], a[24:27], a[8:11], v[112:115]
    ds_read_b64_tr_b16 a[60:61], v15 offset:8192
    v_mfma_f32_16x16x32_bf16 v[120:123], a[24:27], a[12:15], v[120:123]
    ds_read_b64_tr_b16 a[62:63], v15 offset:12288
    buffer_store_dwordx4 v[144:147], v2, s[8:11], s70 offen offset:0 sc1
    s_waitcnt lgkmcnt(12)
    v_mfma_f32_16x16x32_bf16 v[100:103], a[28:31], a[0:3], v[100:103]
    v_add_u32 v6, s66, v6
    v_add_u32 v12, s66, v12
    v_mfma_f32_16x16x32_bf16 v[108:111], a[28:31], a[4:7], v[108:111]
    buffer_load_dwordx4 v19, s[24:27], s57 offen offset:3072 sc1 lds
    v_mfma_f32_16x16x32_bf16 v[116:119], a[28:31], a[8:11], v[116:119]
    s_add_u32 s57, s57, 131072
    v_add_u32 v13, s66, v13
    v_add_u32 v14, s66, v14
    v_mfma_f32_16x16x32_bf16 v[124:127], a[28:31], a[12:15], v[124:127]
    s_mov_b32 m0, s59
    v_add_u32 v15, s66, v15
    s_waitcnt vmcnt(24) lgkmcnt(0)
    v_mfma_f32_16x16x32_bf16 v[64:67], a[48:51], a[32:35], v[64:67]
    s_barrier
    v_mfma_f32_16x16x32_bf16 v[72:75], a[48:51], a[36:39], v[72:75]
    ds_read_b128 a[0:3], v6 offset:0
    buffer_load_dwordx4 v2, s[36:39], s56 offen offset:0 sc1 lds
    v_mfma_f32_16x16x32_bf16 v[80:83], a[48:51], a[40:43], v[80:83]
    ds_read_b64_tr_b16 a[16:17], v12 offset:0
    v_mfma_f32_16x16x32_bf16 v[88:91], a[48:51], a[44:47], v[88:91]
    ds_read_b64_tr_b16 a[18:19], v12 offset:4096
    v_mfma_f32_16x16x32_bf16 v[68:71], a[52:55], a[32:35], v[68:71]
    ds_read_b128 a[4:7], v6 offset:1024
    v_mfma_f32_16x16x32_bf16 v[76:79], a[52:55], a[36:39], v[76:79]
    ds_read_b128 a[8:11], v6 offset:2048
    buffer_load_dwordx4 v2, s[36:39], s56 offen offset:1024 sc1 lds
    v_mfma_f32_16x16x32_bf16 v[84:87], a[52:55], a[40:43], v[84:87]
    ds_read_b128 a[12:15], v6 offset:3072
    v_mfma_f32_16x16x32_bf16 v[92:95], a[52:55], a[44:47], v[92:95]
    ds_read_b64_tr_b16 a[20:21], v13 offset:0
    v_mfma_f32_16x16x32_bf16 v[96:99], a[56:59], a[32:35], v[96:99]
    ds_read_b64_tr_b16 a[22:23], v13 offset:4096
    v_mfma_f32_16x16x32_bf16 v[104:107], a[56:59], a[36:39], v[104:107]
    ds_read_b64_tr_b16 a[24:25], v14 offset:0
    buffer_load_dwordx4 v2, s[36:39], s56 offen offset:2048 sc1 lds
    v_mfma_f32_16x16x32_bf16 v[112:115], a[56:59], a[40:43], v[112:115]
    ds_read_b64_tr_b16 a[26:27], v14 offset:4096
    v_mfma_f32_16x16x32_bf16 v[120:123], a[56:59], a[44:47], v[120:123]
    ds_read_b64_tr_b16 a[28:29], v15 offset:0
    buffer_store_dwordx4 v[148:151], v2, s[8:11], s70 offen offset:1024 sc1
    v_mfma_f32_16x16x32_bf16 v[100:103], a[60:63], a[32:35], v[100:103]
    s_add_u32 s64, s64, 1
    ds_read_b64_tr_b16 a[30:31], v15 offset:4096
    v_mfma_f32_16x16x32_bf16 v[108:111], a[60:63], a[36:39], v[108:111]
    buffer_load_dwordx4 v2, s[36:39], s56 offen offset:3072 sc1 lds
    v_mfma_f32_16x16x32_bf16 v[116:119], a[60:63], a[40:43], v[116:119]
    s_add_u32 s56, s56, 262144
    v_mfma_f32_16x16x32_bf16 v[124:127], a[60:63], a[44:47], v[124:127]
    s_waitcnt lgkmcnt(9)
    v_mfma_f32_16x16x32_bf16 v[64:67], a[16:19], a[0:3], v[64:67]
    s_add_u32 m0, s59, 16384
    ds_read_b128 a[32:35], v6 offset:8192
    s_waitcnt lgkmcnt(9)
    v_mfma_f32_16x16x32_bf16 v[72:75], a[16:19], a[4:7], v[72:75]
    ds_read_b64_tr_b16 a[48:49], v12 offset:8192
    buffer_load_dwordx4 v16, s[24:27], s57 offen offset:0 sc1 lds
    s_waitcnt lgkmcnt(9)
    v_mfma_f32_16x16x32_bf16 v[80:83], a[16:19], a[8:11], v[80:83]
    s_add_u32 s59, s58, s60
    ds_read_b64_tr_b16 a[50:51], v12 offset:12288
    s_waitcnt lgkmcnt(9)
    v_mfma_f32_16x16x32_bf16 v[88:91], a[16:19], a[12:15], v[88:91]
    s_add_u32 s58, s58, 32768
    ds_read_b128 a[36:39], v6 offset:9216
    s_waitcnt lgkmcnt(8)
    v_mfma_f32_16x16x32_bf16 v[68:71], a[20:23], a[0:3], v[68:71]
    s_cmp_ge_u32 s58, 163840
    ds_read_b128 a[40:43], v6 offset:10240
    v_mfma_f32_16x16x32_bf16 v[76:79], a[20:23], a[4:7], v[76:79]
    ds_read_b128 a[44:47], v6 offset:11264
    buffer_load_dwordx4 v17, s[24:27], s57 offen offset:1024 sc1 lds
    v_mfma_f32_16x16x32_bf16 v[84:87], a[20:23], a[8:11], v[84:87]
    s_cselect_b32 s66, 4294836224, s100
    ds_read_b64_tr_b16 a[52:53], v13 offset:8192
    v_mfma_f32_16x16x32_bf16 v[92:95], a[20:23], a[12:15], v[92:95]
    s_cselect_b32 s58, 0, s58
    ds_read_b64_tr_b16 a[54:55], v13 offset:12288
    s_waitcnt lgkmcnt(10)
    v_mfma_f32_16x16x32_bf16 v[96:99], a[24:27], a[0:3], v[96:99]
    ds_read_b64_tr_b16 a[56:57], v14 offset:8192
    v_mfma_f32_16x16x32_bf16 v[104:107], a[24:27], a[4:7], v[104:107]
    ds_read_b64_tr_b16 a[58:59], v14 offset:12288
    buffer_load_dwordx4 v18, s[24:27], s57 offen offset:2048 sc1 lds
    v_mfma_f32_16x16x32_bf16 v[112:115], a[24:27], a[8:11], v[112:115]
    ds_read_b64_tr_b16 a[60:61], v15 offset:8192
    v_mfma_f32_16x16x32_bf16 v[120:123], a[24:27], a[12:15], v[120:123]
    ds_read_b64_tr_b16 a[62:63], v15 offset:12288
    buffer_store_dwordx4 v[152:155], v2, s[8:11], s70 offen offset:2048 sc1
    s_waitcnt lgkmcnt(12)
    v_mfma_f32_16x16x32_bf16 v[100:103], a[28:31], a[0:3], v[100:103]
    v_add_u32 v6, s66, v6
    v_add_u32 v12, s66, v12
    v_mfma_f32_16x16x32_bf16 v[108:111], a[28:31], a[4:7], v[108:111]
    buffer_load_dwordx4 v19, s[24:27], s57 offen offset:3072 sc1 lds
    v_mfma_f32_16x16x32_bf16 v[116:119], a[28:31], a[8:11], v[116:119]
    s_add_u32 s57, s57, 131072
    v_add_u32 v13, s66, v13
    v_add_u32 v14, s66, v14
    v_mfma_f32_16x16x32_bf16 v[124:127], a[28:31], a[12:15], v[124:127]
    s_mov_b32 m0, s59
    v_add_u32 v15, s66, v15
    s_waitcnt vmcnt(24) lgkmcnt(0)
    v_mfma_f32_16x16x32_bf16 v[64:67], a[48:51], a[32:35], v[64:67]
    s_barrier
    v_mfma_f32_16x16x32_bf16 v[72:75], a[48:51], a[36:39], v[72:75]
    ds_read_b128 a[0:3], v6 offset:0
    buffer_load_dwordx4 v2, s[36:39], s56 offen offset:0 sc1 lds
    v_mfma_f32_16x16x32_bf16 v[80:83], a[48:51], a[40:43], v[80:83]
    ds_read_b64_tr_b16 a[16:17], v12 offset:0
    v_mfma_f32_16x16x32_bf16 v[88:91], a[48:51], a[44:47], v[88:91]
    ds_read_b64_tr_b16 a[18:19], v12 offset:4096
    v_mfma_f32_16x16x32_bf16 v[68:71], a[52:55], a[32:35], v[68:71]
    ds_read_b128 a[4:7], v6 offset:1024
    v_mfma_f32_16x16x32_bf16 v[76:79], a[52:55], a[36:39], v[76:79]
    ds_read_b128 a[8:11], v6 offset:2048
    buffer_load_dwordx4 v2, s[36:39], s56 offen offset:1024 sc1 lds
    v_mfma_f32_16x16x32_bf16 v[84:87], a[52:55], a[40:43], v[84:87]
    ds_read_b128 a[12:15], v6 offset:3072
    v_mfma_f32_16x16x32_bf16 v[92:95], a[52:55], a[44:47], v[92:95]
    ds_read_b64_tr_b16 a[20:21], v13 offset:0
    v_mfma_f32_16x16x32_bf16 v[96:99], a[56:59], a[32:35], v[96:99]
    ds_read_b64_tr_b16 a[22:23], v13 offset:4096
    v_mfma_f32_16x16x32_bf16 v[104:107], a[56:59], a[36:39], v[104:107]
    ds_read_b64_tr_b16 a[24:25], v14 offset:0
    buffer_load_dwordx4 v2, s[36:39], s56 offen offset:2048 sc1 lds
    v_mfma_f32_16x16x32_bf16 v[112:115], a[56:59], a[40:43], v[112:115]
    ds_read_b64_tr_b16 a[26:27], v14 offset:4096
    v_mfma_f32_16x16x32_bf16 v[120:123], a[56:59], a[44:47], v[120:123]
    ds_read_b64_tr_b16 a[28:29], v15 offset:0
    buffer_store_dwordx4 v[156:159], v2, s[8:11], s70 offen offset:3072 sc1
    s_add_u32 s70, s70, 4096
    v_mfma_f32_16x16x32_bf16 v[100:103], a[60:63], a[32:35], v[100:103]
    s_add_u32 s64, s64, 1
    ds_read_b64_tr_b16 a[30:31], v15 offset:4096
    v_mfma_f32_16x16x32_bf16 v[108:111], a[60:63], a[36:39], v[108:111]
    buffer_load_dwordx4 v2, s[36:39], s56 offen offset:3072 sc1 lds
    v_mfma_f32_16x16x32_bf16 v[116:119], a[60:63], a[40:43], v[116:119]
    s_add_u32 s56, s56, 262144
    v_mfma_f32_16x16x32_bf16 v[124:127], a[60:63], a[44:47], v[124:127]
    s_mov_b32 s67, 32
    s_branch m_l3147
m_n178:
    s_cmp_lg_u32 s64, 32
    s_cbranch_scc1 m_n179
    s_lshl_b32 s91, s96, 3
    s_add_u32 s91, s91, s97
    s_lshl_b32 s91, s91, 7
    s_add_u32 s91, s91, 16384
    s_cmp_lg_u32 s16, 0
    s_cbranch_scc1 m_np180
    v_mov_b32 v60, s4
    v_mov_b32 v61, s5
    s_add_u32 s90, s91, 117440512
    s_mov_b64 exec, 1
    buffer_store_dwordx2 v[60:61], off, s[8:11], s90 sc1
    s_mov_b64 exec, -1
m_np180:
    s_mov_b32 s67, 35
    s_branch m_l3147
m_n179:
    s_cmp_lg_u32 s64, 35
    s_cbranch_scc1 m_n181
    s_mov_b32 s38, 0
    s_mov_b32 s67, 40
    s_branch m_l3147
m_n181:
    s_branch m_l3x149
m_l3c150:
    s_mov_b32 s67, 34
    s_cmp_lt_u32 s64, 34
    s_cbranch_scc1 m_l3n151
    s_cmp_lg_u32 s64, 34
    s_cbranch_scc1 m_n183
    s_mov_b32 s68, 1000
    s_mov_b32 s67, 35
    s_branch m_l3147
m_n183:
    s_cmp_lg_u32 s64, 35
    s_cbranch_scc1 m_n184
    s_mov_b32 s38, 0
    s_lshl_b32 s91, s96, 3
    s_add_u32 s91, s91, s97
    s_lshl_b32 s91, s91, 7
    s_add_u32 s91, s91, 16384
    s_add_u32 s52, s91, 117440512
    buffer_load_dwordx2 v[4:5], off, s[8:11], s52 sc1
    s_mov_b32 s67, 36
    s_branch m_l3147
m_n184:
    s_cmp_lg_u32 s64, 36
    s_cbranch_scc1 m_n185
    s_mov_b32 s26, 0
    s_mov_b32 s67, 37
    s_branch m_l3147
m_n185:
    s_cmp_lg_u32 s64, 37
    s_cbranch_scc1 m_n186
    s_waitcnt vmcnt(16)
    s_mov_b32 s3, 1048576
m_spin187:
    v_cmp_ne_u64 s[76:77], s[4:5], v[4:5]
    s_nop 3
    s_cmp_eq_u64 s[76:77], 0
    s_cbranch_scc1 m_ok188
    s_sub_u32 s3, s3, 1
    s_cbranch_scc1 m_ok188
    s_sleep 8
    buffer_load_dwordx2 v[4:5], off, s[8:11], s52 sc1
    s_waitcnt vmcnt(0)
    s_branch m_spin187
m_ok188:
    s_lshl_b32 s90, s96, 3
    s_add_u32 s90, s90, s97
    s_lshl_b32 s90, s90, 15
    s_lshl_b32 s91, s16, 13
    s_add_u32 s90, s90, s91
    s_add_u32 s70, s90, 100663296
    buffer_load_dwordx4 v[128:131], v2, s[8:11], s70 offen offset:0 sc1
    buffer_load_dwordx4 v[132:135], v2, s[8:11], s70 offen offset:1024 sc1
    buffer_load_dwordx4 v[136:139], v2, s[8:11], s70 offen offset:2048 sc1
    buffer_load_dwordx4 v[140:143], v2, s[8:11], s70 offen offset:3072 sc1
    s_add_u32 s70, s70, 4096
    buffer_load_dwordx4 v[144:147], v2, s[8:11], s70 offen offset:0 sc1
    buffer_load_dwordx4 v[148:151], v2, s[8:11], s70 offen offset:1024 sc1
    buffer_load_dwordx4 v[152:155], v2, s[8:11], s70 offen offset:2048 sc1
    buffer_load_dwordx4 v[156:159], v2, s[8:11], s70 offen offset:3072 sc1
    s_mov_b32 s67, 40
    s_branch m_l3147
m_n186:
    s_branch m_l3x149
m_o1171:
    s_and_b32 s91, s2, 7
    s_lshl_b32 s91, s91, 5
    s_lshr_b32 s92, s2, 3
    s_add_u32 s91, s91, s92
    s_lshl_b32 s91, s91, 3
    s_add_u32 s91, s91, 12288
    s_cmp_lg_u32 s16, 0
    s_cbranch_scc1 m_np190
    v_mov_b32 v60, s4
    v_mov_b32 v61, s5
    s_add_u32 s90, s91, 117440512
    s_mov_b64 exec, 1
    buffer_store_dwordx2 v[60:61], off, s[8:11], s90 sc1
    s_mov_b64 exec, -1
m_np190:
    s_branch m_o2172
m_l3n151:
    s_sub_u32 s90, s68, 5
    s_min_u32 s67, s67, s90
    s_branch m_l3147
m_l3x149:
    s_cmp_eq_u32 s95, 1
    s_cbranch_scc1 m_noadd191
    s_waitcnt vmcnt(0)
    v_lshlrev_b32 v160, 16, v128
    v_and_b32 v161, 0xffff0000, v128
    v_lshlrev_b32 v162, 16, v129
    v_and_b32 v163, 0xffff0000, v129
    v_lshlrev_b32 v164, 16, v130
    v_and_b32 v165, 0xffff0000, v130
    v_lshlrev_b32 v166, 16, v131
    v_and_b32 v167, 0xffff0000, v131
    v_lshlrev_b32 v168, 16, v132
    v_and_b32 v169, 0xffff0000, v132
    v_lshlrev_b32 v170, 16, v133
    v_and_b32 v171, 0xffff0000, v133
    v_lshlrev_b32 v172, 16, v134
    v_and_b32 v173, 0xffff0000, v134
    v_lshlrev_b32 v174, 16, v135
    v_and_b32 v175, 0xffff0000, v135
    v_lshlrev_b32 v176, 16, v136
    v_and_b32 v177, 0xffff0000, v136
    v_lshlrev_b32 v178, 16, v137
    v_and_b32 v179, 0xffff0000, v137
    v_lshlrev_b32 v180, 16, v138
    v_and_b32 v181, 0xffff0000, v138
    v_lshlrev_b32 v182, 16, v139
    v_and_b32 v183, 0xffff0000, v139
    v_lshlrev_b32 v184, 16, v140
    v_and_b32 v185, 0xffff0000, v140
    v_lshlrev_b32 v186, 16, v141
    v_and_b32 v187, 0xffff0000, v141
    v_lshlrev_b32 v188, 16, v142
    v_and_b32 v189, 0xffff0000, v142
    v_lshlrev_b32 v190, 16, v143
    v_and_b32 v191, 0xffff0000, v143
    v_lshlrev_b32 v192, 16, v144
    v_and_b32 v193, 0xffff0000, v144
    v_lshlrev_b32 v194, 16, v145
    v_and_b32 v195, 0xffff0000, v145
    v_lshlrev_b32 v196, 16, v146
    v_and_b32 v197, 0xffff0000, v146
    v_lshlrev_b32 v198, 16, v147
    v_and_b32 v199, 0xffff0000, v147
    v_lshlrev_b32 v200, 16, v148
    v_and_b32 v201, 0xffff0000, v148
    v_lshlrev_b32 v202, 16, v149
    v_and_b32 v203, 0xffff0000, v149
    v_lshlrev_b32 v204, 16, v150
    v_and_b32 v205, 0xffff0000, v150
    v_lshlrev_b32 v206, 16, v151
    v_and_b32 v207, 0xffff0000, v151
    v_lshlrev_b32 v208, 16, v152
    v_and_b32 v209, 0xffff0000, v152
    v_lshlrev_b32 v210, 16, v153
    v_and_b32 v211, 0xffff0000, v153
    v_lshlrev_b32 v212, 16, v154
    v_and_b32 v213, 0xffff0000, v154
    v_lshlrev_b32 v214, 16, v155
    v_and_b32 v215, 0xffff0000, v155
    v_lshlrev_b32 v216, 16, v156
    v_and_b32 v217, 0xffff0000, v156
    v_lshlrev_b32 v218, 16, v157
    v_and_b32 v219, 0xffff0000, v157
    v_lshlrev_b32 v220, 16, v158
    v_and_b32 v221, 0xffff0000, v158
    v_lshlrev_b32 v222, 16, v159
    v_and_b32 v223, 0xffff0000, v159
    v_pk_add_f32 v[64:65], v[64:65], v[160:161]
    v_pk_add_f32 v[66:67], v[66:67], v[162:163]
    v_pk_add_f32 v[68:69], v[68:69], v[164:165]
    v_pk_add_f32 v[70:71], v[70:71], v[166:167]
    v_pk_add_f32 v[72:73], v[72:73], v[168:169]
    v_pk_add_f32 v[74:75], v[74:75], v[170:171]
    v_pk_add_f32 v[76:77], v[76:77], v[172:173]
    v_pk_add_f32 v[78:79], v[78:79], v[174:175]
    v_pk_add_f32 v[80:81], v[80:81], v[176:177]
    v_pk_add_f32 v[82:83], v[82:83], v[178:179]
    v_pk_add_f32 v[84:85], v[84:85], v[180:181]
    v_pk_add_f32 v[86:87], v[86:87], v[182:183]
    v_pk_add_f32 v[88:89], v[88:89], v[184:185]
    v_pk_add_f32 v[90:91], v[90:91], v[186:187]
    v_pk_add_f32 v[92:93], v[92:93], v[188:189]
    v_pk_add_f32 v[94:95], v[94:95], v[190:191]
    v_pk_add_f32 v[96:97], v[96:97], v[192:193]
    v_pk_add_f32 v[98:99], v[98:99], v[194:195]
    v_pk_add_f32 v[100:101], v[100:101], v[196:197]
    v_pk_add_f32 v[102:103], v[102:103], v[198:199]
    v_pk_add_f32 v[104:105], v[104:105], v[200:201]
    v_pk_add_f32 v[106:107], v[106:107], v[202:203]
    v_pk_add_f32 v[108:109], v[108:109], v[204:205]
    v_pk_add_f32 v[110:111], v[110:111], v[206:207]
    v_pk_add_f32 v[112:113], v[112:113], v[208:209]
    v_pk_add_f32 v[114:115], v[114:115], v[210:211]
    v_pk_add_f32 v[116:117], v[116:117], v[212:213]
    v_pk_add_f32 v[118:119], v[118:119], v[214:215]
    v_pk_add_f32 v[120:121], v[120:121], v[216:217]
    v_pk_add_f32 v[122:123], v[122:123], v[218:219]
    v_pk_add_f32 v[124:125], v[124:125], v[220:221]
    v_pk_add_f32 v[126:127], v[126:127], v[222:223]
m_noadd191:
    v_cvt_pk_bf16_f32 v64, v64, v65
    v_cvt_pk_bf16_f32 v65, v66, v67
    v_cvt_pk_bf16_f32 v66, v68, v69
    v_cvt_pk_bf16_f32 v67, v70, v71
    v_cvt_pk_bf16_f32 v96, v96, v97
    v_cvt_pk_bf16_f32 v97, v98, v99
    v_cvt_pk_bf16_f32 v98, v100, v101
    v_cvt_pk_bf16_f32 v99, v102, v103
    s_nop 1
    v_permlane16_swap_b32 v64, v66
    v_permlane16_swap_b32 v65, v67
    v_permlane16_swap_b32 v96, v98
    v_permlane16_swap_b32 v97, v99
    buffer_store_dwordx4 v[64:67], v7, s[28:31], s71 offen offset:0 sc1
    buffer_store_dwordx4 v[96:99], v7, s[28:31], s71 offen offset:64 sc1
    s_add_u32 s71, s71, s72
    v_cvt_pk_bf16_f32 v72, v72, v73
    v_cvt_pk_bf16_f32 v73, v74, v75
    v_cvt_pk_bf16_f32 v74, v76, v77
    v_cvt_pk_bf16_f32 v75, v78, v79
    v_cvt_pk_bf16_f32 v104, v104, v105
    v_cvt_pk_bf16_f32 v105, v106, v107
    v_cvt_pk_bf16_f32 v106, v108, v109
    v_cvt_pk_bf16_f32 v107, v110, v111
    s_nop 1
    v_permlane16_swap_b32 v72, v74
    v_permlane16_swap_b32 v73, v75
    v_permlane16_swap_b32 v104, v106
    v_permlane16_swap_b32 v105, v107
    buffer_store_dwordx4 v[72:75], v7, s[28:31], s71 offen offset:0 sc1
    buffer_store_dwordx4 v[104:107], v7, s[28:31], s71 offen offset:64 sc1
    s_add_u32 s71, s71, s72
    v_cvt_pk_bf16_f32 v80, v80, v81
    v_cvt_pk_bf16_f32 v81, v82, v83
    v_cvt_pk_bf16_f32 v82, v84, v85
    v_cvt_pk_bf16_f32 v83, v86, v87
    v_cvt_pk_bf16_f32 v112, v112, v113
    v_cvt_pk_bf16_f32 v113, v114, v115
    v_cvt_pk_bf16_f32 v114, v116, v117
    v_cvt_pk_bf16_f32 v115, v118, v119
    s_nop 1
    v_permlane16_swap_b32 v80, v82
    v_permlane16_swap_b32 v81, v83
    v_permlane16_swap_b32 v112, v114
    v_permlane16_swap_b32 v113, v115
    buffer_store_dwordx4 v[80:83], v7, s[28:31], s71 offen offset:0 sc1
    buffer_store_dwordx4 v[112:115], v7, s[28:31], s71 offen offset:64 sc1
    s_add_u32 s71, s71, s72
    v_cvt_pk_bf16_f32 v88, v88, v89
    v_cvt_pk_bf16_f32 v89, v90, v91
    v_cvt_pk_bf16_f32 v90, v92, v93
    v_cvt_pk_bf16_f32 v91, v94, v95
    v_cvt_pk_bf16_f32 v120, v120, v121
    v_cvt_pk_bf16_f32 v121, v122, v123
    v_cvt_pk_bf16_f32 v122, v124, v125
    v_cvt_pk_bf16_f32 v123, v126, v127
    s_nop 1
    v_permlane16_swap_b32 v88, v90
    v_permlane16_swap_b32 v89, v91
    v_permlane16_swap_b32 v120, v122
    v_permlane16_swap_b32 v121, v123
    buffer_store_dwordx4 v[88:91], v7, s[28:31], s71 offen offset:0 sc1
    buffer_store_dwordx4 v[120:123], v7, s[28:31], s71 offen offset:64 sc1
    s_add_u32 s71, s71, s72
m_end1:
    s_endpgm
m_stub94:
    v_cmp_lt_f32 vcc, s65, v8
    s_cmp_lg_u32 s64, s67
    s_cbranch_scc1 m_e193
    v_add_f32 v176, v176, v16
    v_mov_b32 v180, v9
    v_add_f32 v188, v188, v16
    v_add_f32 v177, v177, v17
    v_mov_b32 v181, v9
    v_add_f32 v189, v189, v17
    v_add_f32 v178, v178, v18
    v_mov_b32 v182, v9
    v_add_f32 v190, v190, v18
    v_add_f32 v179, v179, v19
    v_mov_b32 v183, v9
    v_add_f32 v191, v191, v19
    s_nop 0
m_e193:
    s_cmp_lg_u32 s64, s68
    s_cbranch_scc1 m_e194
    v_mov_b32 v176, v9
    v_mov_b32 v184, v9
    v_mov_b32 v188, v9
    v_mov_b32 v180, v9
    v_mov_b32 v177, v9
    v_mov_b32 v185, v9
    v_mov_b32 v189, v9
    v_mov_b32 v181, v9
    v_mov_b32 v178, v9
    v_mov_b32 v186, v9
    v_mov_b32 v190, v9
    v_mov_b32 v182, v9
    v_mov_b32 v179, v9
    v_mov_b32 v187, v9
    v_mov_b32 v191, v9
    v_mov_b32 v183, v9
    s_nop 0
m_e194:
    s_cbranch_vccnz m_rc195
m_sp192:
    s_branch m_ret95
m_stub97:
    v_cmp_lt_f32 vcc, s65, v8
    s_cmp_lg_u32 s64, s67
    s_cbranch_scc1 m_e197
    v_add_f32 v176, v176, v16
    v_mov_b32 v180, v9
    v_add_f32 v188, v188, v16
    v_add_f32 v177, v177, v17
    v_mov_b32 v181, v9
    v_add_f32 v189, v189, v17
    v_add_f32 v178, v178, v18
    v_mov_b32 v182, v9
    v_add_f32 v190, v190, v18
    v_add_f32 v179, v179, v19
    v_mov_b32 v183, v9
    v_add_f32 v191, v191, v19
    s_nop 0
m_e197:
    s_cmp_lg_u32 s64, s68
    s_cbranch_scc1 m_e198
    v_mov_b32 v176, v9
    v_mov_b32 v184, v9
    v_mov_b32 v188, v9
    v_mov_b32 v180, v9
    v_mov_b32 v177, v9
    v_mov_b32 v185, v9
    v_mov_b32 v189, v9
    v_mov_b32 v181, v9
    v_mov_b32 v178, v9
    v_mov_b32 v186, v9
    v_mov_b32 v190, v9
    v_mov_b32 v182, v9
    v_mov_b32 v179, v9
    v_mov_b32 v187, v9
    v_mov_b32 v191, v9
    v_mov_b32 v183, v9
    s_nop 0
m_e198:
    s_cbranch_vccnz m_rc199
m_sp196:
    s_branch m_ret98
m_stub115:
    v_cmp_lt_f32 vcc, s65, v8
    s_cmp_lg_u32 s64, s70
    s_cbranch_scc1 m_e201
    v_add_f32 v160, v160, v16
    v_mov_b32 v164, v9
    v_add_f32 v172, v172, v16
    v_add_f32 v161, v161, v17
    v_mov_b32 v165, v9
    v_add_f32 v173, v173, v17
    v_add_f32 v162, v162, v18
    v_mov_b32 v166, v9
    v_add_f32 v174, v174, v18
    v_add_f32 v163, v163, v19
    v_mov_b32 v167, v9
    v_add_f32 v175, v175, v19
    s_nop 0
m_e201:
    s_cmp_lg_u32 s64, s71
    s_cbranch_scc1 m_e202
    v_mov_b32 v160, v9
    v_mov_b32 v168, v9
    v_mov_b32 v172, v9
    v_mov_b32 v164, v9
    v_mov_b32 v161, v9
    v_mov_b32 v169, v9
    v_mov_b32 v173, v9
    v_mov_b32 v165, v9
    v_mov_b32 v162, v9
    v_mov_b32 v170, v9
    v_mov_b32 v174, v9
    v_mov_b32 v166, v9
    v_mov_b32 v163, v9
    v_mov_b32 v171, v9
    v_mov_b32 v175, v9
    v_mov_b32 v167, v9
    s_nop 0
m_e202:
    s_cbranch_vccnz m_rc203
m_sp200:
    s_branch m_ret116
m_stub117:
    v_cmp_lt_f32 vcc, s65, v8
    s_cmp_lg_u32 s64, s70
    s_cbranch_scc1 m_e205
    v_add_f32 v160, v160, v16
    v_mov_b32 v164, v9
    v_add_f32 v172, v172, v16
    v_add_f32 v161, v161, v17
    v_mov_b32 v165, v9
    v_add_f32 v173, v173, v17
    v_add_f32 v162, v162, v18
    v_mov_b32 v166, v9
    v_add_f32 v174, v174, v18
    v_add_f32 v163, v163, v19
    v_mov_b32 v167, v9
    v_add_f32 v175, v175, v19
    s_nop 0
m_e205:
    s_cmp_lg_u32 s64, s71
    s_cbranch_scc1 m_e206
    v_mov_b32 v160, v9
    v_mov_b32 v168, v9
    v_mov_b32 v172, v9
    v_mov_b32 v164, v9
    v_mov_b32 v161, v9
    v_mov_b32 v169, v9
    v_mov_b32 v173, v9
    v_mov_b32 v165, v9
    v_mov_b32 v162, v9
    v_mov_b32 v170, v9
    v_mov_b32 v174, v9
    v_mov_b32 v166, v9
    v_mov_b32 v163, v9
    v_mov_b32 v171, v9
    v_mov_b32 v175, v9
    v_mov_b32 v167, v9
    s_nop 0
m_e206:
    s_cmp_lg_u32 s64, s53
    s_cbranch_scc1 m_e209
    s_cmp_lg_u32 s16, 0
    s_cbranch_scc1 m_np210
    v_mov_b32 v60, s4
    v_mov_b32 v61, s5
    s_add_u32 s90, s101, 117440512
    s_mov_b64 exec, 1
    buffer_store_dwordx2 v[60:61], off, s[8:11], s90 sc1
    s_mov_b64 exec, -1
m_np210:
    s_mov_b32 s101, -1
m_e209:
    s_cmp_gt_u32 s64, 24
    s_cbranch_scc1 m_e207
    s_cmp_lg_u32 s64, 8
    s_cbranch_scc1 m_e211
    s_lshr_b32 s90, s32, 1
    s_lshl_b32 s90, s90, 7
    s_add_u32 s90, s90, 117440600
    v_min_u32 v0, 1, v1
    v_lshlrev_b32 v0, 5, v0
    buffer_load_dwordx2 v[4:5], v0, s[8:11], s90 offen sc1
    s_cmp_eq_u32 s17, -1
    s_cbranch_scc1 m_e207
    s_cmp_lg_u32 s16, 0
    s_cbranch_scc1 m_np212
    v_mov_b32 v60, s4
    v_mov_b32 v61, s5
    s_add_u32 s90, s17, 117440512
    s_mov_b64 exec, 1
    buffer_store_dwordx2 v[60:61], off, s[8:11], s90 sc1
    s_mov_b64 exec, -1
m_np212:
    s_branch m_e207
m_e211:
    s_cmp_lg_u32 s64, 16
    s_cbranch_scc1 m_e213
    s_waitcnt vmcnt(18)
    s_mov_b32 s3, 1048576
m_spin214:
    v_cmp_ne_u64 s[76:77], s[4:5], v[4:5]
    s_nop 3
    s_cmp_eq_u64 s[76:77], 0
    s_cbranch_scc1 m_e207
    s_sub_u32 s3, s3, 1
    s_cbranch_scc1 m_e207
    s_sleep 32
    s_lshr_b32 s90, s32, 1
    s_lshl_b32 s90, s90, 7
    s_add_u32 s90, s90, 117440600
    v_min_u32 v0, 1, v1
    v_lshlrev_b32 v0, 5, v0
    buffer_load_dwordx2 v[4:5], v0, s[8:11], s90 offen sc1
    s_waitcnt vmcnt(0)
    s_branch m_spin214
    s_branch m_e207
m_e213:
    s_cmp_lg_u32 s64, 20
    s_cbranch_scc1 m_e215
    buffer_load_dwordx2 v[4:5], v10, s[8:11], 0 offen sc1
    s_mov_b32 s44, s48
    s_mov_b32 s45, s49
    s_mov_b32 s46, 8388608
    s_lshl_b32 s90, s2, 2
    s_add_u32 s90, s90, s16
    s_lshl_b32 s90, s90, 13
    v_lshlrev_b32 v62, 7, v1
    buffer_load_dword v255, v62, s[44:47], s90 offen
    s_branch m_e207
m_e215:
    s_cmp_lg_u32 s64, 24
    s_cbranch_scc1 m_e216
    s_mov_b32 s44, s50
    s_mov_b32 s45, s51
    s_mov_b32 s46, 2097152
    s_lshl_b32 s90, s2, 2
    s_add_u32 s90, s90, s16
    s_lshl_b32 s90, s90, 13
    v_lshlrev_b32 v62, 7, v1
    buffer_load_dword v255, v62, s[44:47], s90 offen
    s_waitcnt vmcnt(18)
    s_mov_b32 s3, 1048576
m_spin217:
    v_cmp_ne_u64 s[76:77], s[4:5], v[4:5]
    s_nop 3
    s_cmp_eq_u64 s[76:77], 0
    s_cbranch_scc1 m_e207
    s_sub_u32 s3, s3, 1
    s_cbranch_scc1 m_e207
    s_sleep 32
    buffer_load_dwordx2 v[4:5], v10, s[8:11], 0 offen sc1
    s_waitcnt vmcnt(0)
    s_branch m_spin217
    s_branch m_e207
m_e216:
m_e207:
    s_cbranch_vccnz m_rc218
m_sp204:
    s_branch m_ret118
m_stub121:
    v_cmp_lt_f32 vcc, s65, v8
    s_cmp_lg_u32 s64, s70
    s_cbranch_scc1 m_e220
    v_add_f32 v160, v160, v16
    v_mov_b32 v164, v9
    v_add_f32 v172, v172, v16
    v_add_f32 v161, v161, v17
    v_mov_b32 v165, v9
    v_add_f32 v173, v173, v17
    v_add_f32 v162, v162, v18
    v_mov_b32 v166, v9
    v_add_f32 v174, v174, v18
    v_add_f32 v163, v163, v19
    v_mov_b32 v167, v9
    v_add_f32 v175, v175, v19
    s_nop 0
m_e220:
    s_cmp_lg_u32 s64, s71
    s_cbranch_scc1 m_e221
    v_mov_b32 v160, v9
    v_mov_b32 v168, v9
    v_mov_b32 v172, v9
    v_mov_b32 v164, v9
    v_mov_b32 v161, v9
    v_mov_b32 v169, v9
    v_mov_b32 v173, v9
    v_mov_b32 v165, v9
    v_mov_b32 v162, v9
    v_mov_b32 v170, v9
    v_mov_b32 v174, v9
    v_mov_b32 v166, v9
    v_mov_b32 v163, v9
    v_mov_b32 v171, v9
    v_mov_b32 v175, v9
    v_mov_b32 v167, v9
    s_nop 0
m_e221:
    s_cbranch_vccnz m_rc222
m_sp219:
    s_branch m_ret122
m_stub138:
    v_cmp_lt_f32 vcc, s65, v8
    s_cbranch_vccnz m_rc224
m_sp223:
    s_branch m_ret139
m_rc114:
    s_call_b64 s[74:75], m_rs0488
    s_branch m_sp99
m_rc137:
    s_call_b64 s[74:75], m_rs0287
    s_branch m_sp123
m_rc195:
    s_call_b64 s[74:75], m_rs0488
    s_branch m_sp192
m_rc199:
    s_call_b64 s[74:75], m_rs1490
    s_branch m_sp196
m_rc203:
    s_call_b64 s[74:75], m_rs1490
    s_branch m_sp200
m_rc218:
    s_call_b64 s[74:75], m_rs0287
    s_branch m_sp204
m_rc222:
    s_call_b64 s[74:75], m_rs1289
    s_branch m_sp219
m_rc224:
    s_call_b64 s[74:75], m_rs1289
    s_branch m_sp223
m_rs0287:
    s_nop 15
    v_max3_f32 v48, v64, v65, v66
    v_max3_f32 v48, v48, v67, v68
    v_max3_f32 v48, v48, v69, v70
    v_max3_f32 v48, v48, v71, 0
    v_mov_b32 v49, v48
    s_nop 1
    v_permlane32_swap_b32 v48, v49
    s_nop 1
    v_max_f32 v48, v48, v49
    v_mov_b32 v49, v48
    s_nop 1
    v_permlane16_swap_b32 v48, v49
    s_nop 1
    v_max_f32 v48, v48, v49
    v_exp_f32 v49, -v48
    v_sub_f32 v64, v64, v48
    v_sub_f32 v65, v65, v48
    v_sub_f32 v66, v66, v48
    v_sub_f32 v67, v67, v48
    v_sub_f32 v68, v68, v48
    v_sub_f32 v69, v69, v48
    v_sub_f32 v70, v70, v48
    v_sub_f32 v71, v71, v48
    v_sub_f32 v96, v96, v48
    v_sub_f32 v97, v97, v48
    v_sub_f32 v98, v98, v48
    v_sub_f32 v99, v99, v48
    v_sub_f32 v100, v100, v48
    v_sub_f32 v101, v101, v48
    v_sub_f32 v102, v102, v48
    v_sub_f32 v103, v103, v48
    v_sub_f32 v160, v160, v48
    v_sub_f32 v161, v161, v48
    v_sub_f32 v162, v162, v48
    v_sub_f32 v163, v163, v48
    v_sub_f32 v164, v164, v48
    v_sub_f32 v165, v165, v48
    v_sub_f32 v166, v166, v48
    v_sub_f32 v167, v167, v48
    v_mul_f32 v12, v12, v49
    v_accvgpr_read_b32 v52, a0
    v_accvgpr_read_b32 v53, a1
    v_accvgpr_read_b32 v54, a2
    v_accvgpr_read_b32 v55, a3
    v_accvgpr_read_b32 v56, a4
    v_accvgpr_read_b32 v57, a5
    v_accvgpr_read_b32 v58, a6
    v_accvgpr_read_b32 v59, a7
    v_mul_f32 v52, v52, v49
    v_mul_f32 v53, v53, v49
    v_mul_f32 v54, v54, v49
    v_mul_f32 v55, v55, v49
    v_mul_f32 v56, v56, v49
    v_mul_f32 v57, v57, v49
    v_mul_f32 v58, v58, v49
    v_mul_f32 v59, v59, v49
    v_accvgpr_write_b32 a0, v52
    v_accvgpr_write_b32 a1, v53
    v_accvgpr_write_b32 a2, v54
    v_accvgpr_write_b32 a3, v55
    v_accvgpr_write_b32 a4, v56
    v_accvgpr_write_b32 a5, v57
    v_accvgpr_write_b32 a6, v58
    v_accvgpr_write_b32 a7, v59
    v_accvgpr_read_b32 v52, a8
    v_accvgpr_read_b32 v53, a9
    v_accvgpr_read_b32 v54, a10
    v_accvgpr_read_b32 v55, a11
    v_accvgpr_read_b32 v56, a12
    v_accvgpr_read_b32 v57, a13
    v_accvgpr_read_b32 v58, a14
    v_accvgpr_read_b32 v59, a15
    v_mul_f32 v52, v52, v49
    v_mul_f32 v53, v53, v49
    v_mul_f32 v54, v54, v49
    v_mul_f32 v55, v55, v49
    v_mul_f32 v56, v56, v49
    v_mul_f32 v57, v57, v49
    v_mul_f32 v58, v58, v49
    v_mul_f32 v59, v59, v49
    v_accvgpr_write_b32 a8, v52
    v_accvgpr_write_b32 a9, v53
    v_accvgpr_write_b32 a10, v54
    v_accvgpr_write_b32 a11, v55
    v_accvgpr_write_b32 a12, v56
    v_accvgpr_write_b32 a13, v57
    v_accvgpr_write_b32 a14, v58
    v_accvgpr_write_b32 a15, v59
    v_accvgpr_read_b32 v52, a16
    v_accvgpr_read_b32 v53, a17
    v_accvgpr_read_b32 v54, a18
    v_accvgpr_read_b32 v55, a19
    v_accvgpr_read_b32 v56, a20
    v_accvgpr_read_b32 v57, a21
    v_accvgpr_read_b32 v58, a22
    v_accvgpr_read_b32 v59, a23
    v_mul_f32 v52, v52, v49
    v_mul_f32 v53, v53, v49
    v_mul_f32 v54, v54, v49
    v_mul_f32 v55, v55, v49
    v_mul_f32 v56, v56, v49
    v_mul_f32 v57, v57, v49
    v_mul_f32 v58, v58, v49
    v_mul_f32 v59, v59, v49
    v_accvgpr_write_b32 a16, v52
    v_accvgpr_write_b32 a17, v53
    v_accvgpr_write_b32 a18, v54
    v_accvgpr_write_b32 a19, v55
    v_accvgpr_write_b32 a20, v56
    v_accvgpr_write_b32 a21, v57
    v_accvgpr_write_b32 a22, v58
    v_accvgpr_write_b32 a23, v59
    v_accvgpr_read_b32 v52, a24
    v_accvgpr_read_b32 v53, a25
    v_accvgpr_read_b32 v54, a26
    v_accvgpr_read_b32 v55, a27
    v_accvgpr_read_b32 v56, a28
    v_accvgpr_read_b32 v57, a29
    v_accvgpr_read_b32 v58, a30
    v_accvgpr_read_b32 v59, a31
    v_mul_f32 v52, v52, v49
    v_mul_f32 v53, v53, v49
    v_mul_f32 v54, v54, v49
    v_mul_f32 v55, v55, v49
    v_mul_f32 v56, v56, v49
    v_mul_f32 v57, v57, v49
    v_mul_f32 v58, v58, v49
    v_mul_f32 v59, v59, v49
    v_accvgpr_write_b32 a24, v52
    v_accvgpr_write_b32 a25, v53
    v_accvgpr_write_b32 a26, v54
    v_accvgpr_write_b32 a27, v55
    v_accvgpr_write_b32 a28, v56
    v_accvgpr_write_b32 a29, v57
    v_accvgpr_write_b32 a30, v58
    v_accvgpr_write_b32 a31, v59
    v_exp_f32 v52, v64
    v_exp_f32 v53, v65
    v_exp_f32 v54, v66
    v_exp_f32 v55, v67
    v_exp_f32 v56, v68
    v_exp_f32 v57, v69
    v_exp_f32 v58, v70
    v_exp_f32 v59, v71
    s_nop 0
    v_cvt_pk_bf16_f32 v128, v52, v53
    v_cvt_pk_bf16_f32 v129, v54, v55
    v_cvt_pk_bf16_f32 v130, v56, v57
    v_cvt_pk_bf16_f32 v131, v58, v59
    s_nop 1
    v_mfma_f32_16x16x32_bf16 v[28:31], v[44:47], v[128:131], 0
    v_max3_f32 v48, v72, v73, v74
    v_max3_f32 v48, v48, v75, v76
    v_max3_f32 v48, v48, v77, v78
    v_max3_f32 v48, v48, v79, 0
    v_mov_b32 v49, v48
    s_nop 1
    v_permlane32_swap_b32 v48, v49
    s_nop 1
    v_max_f32 v48, v48, v49
    v_mov_b32 v49, v48
    s_nop 1
    v_permlane16_swap_b32 v48, v49
    s_nop 1
    v_max_f32 v48, v48, v49
    v_exp_f32 v49, -v48
    v_sub_f32 v72, v72, v48
    v_sub_f32 v73, v73, v48
    v_sub_f32 v74, v74, v48
    v_sub_f32 v75, v75, v48
    v_sub_f32 v76, v76, v48
    v_sub_f32 v77, v77, v48
    v_sub_f32 v78, v78, v48
    v_sub_f32 v79, v79, v48
    v_sub_f32 v104, v104, v48
    v_sub_f32 v105, v105, v48
    v_sub_f32 v106, v106, v48
    v_sub_f32 v107, v107, v48
    v_sub_f32 v108, v108, v48
    v_sub_f32 v109, v109, v48
    v_sub_f32 v110, v110, v48
    v_sub_f32 v111, v111, v48
    v_sub_f32 v168, v168, v48
    v_sub_f32 v169, v169, v48
    v_sub_f32 v170, v170, v48
    v_sub_f32 v171, v171, v48
    v_sub_f32 v172, v172, v48
    v_sub_f32 v173, v173, v48
    v_sub_f32 v174, v174, v48
    v_sub_f32 v175, v175, v48
    v_mul_f32 v13, v13, v49
    v_accvgpr_read_b32 v52, a32
    v_accvgpr_read_b32 v53, a33
    v_accvgpr_read_b32 v54, a34
    v_accvgpr_read_b32 v55, a35
    v_accvgpr_read_b32 v56, a36
    v_accvgpr_read_b32 v57, a37
    v_accvgpr_read_b32 v58, a38
    v_accvgpr_read_b32 v59, a39
    v_mul_f32 v52, v52, v49
    v_mul_f32 v53, v53, v49
    v_mul_f32 v54, v54, v49
    v_mul_f32 v55, v55, v49
    v_mul_f32 v56, v56, v49
    v_mul_f32 v57, v57, v49
    v_mul_f32 v58, v58, v49
    v_mul_f32 v59, v59, v49
    v_accvgpr_write_b32 a32, v52
    v_accvgpr_write_b32 a33, v53
    v_accvgpr_write_b32 a34, v54
    v_accvgpr_write_b32 a35, v55
    v_accvgpr_write_b32 a36, v56
    v_accvgpr_write_b32 a37, v57
    v_accvgpr_write_b32 a38, v58
    v_accvgpr_write_b32 a39, v59
    v_accvgpr_read_b32 v52, a40
    v_accvgpr_read_b32 v53, a41
    v_accvgpr_read_b32 v54, a42
    v_accvgpr_read_b32 v55, a43
    v_accvgpr_read_b32 v56, a44
    v_accvgpr_read_b32 v57, a45
    v_accvgpr_read_b32 v58, a46
    v_accvgpr_read_b32 v59, a47
    v_mul_f32 v52, v52, v49
    v_mul_f32 v53, v53, v49
    v_mul_f32 v54, v54, v49
    v_mul_f32 v55, v55, v49
    v_mul_f32 v56, v56, v49
    v_mul_f32 v57, v57, v49
    v_mul_f32 v58, v58, v49
    v_mul_f32 v59, v59, v49
    v_accvgpr_write_b32 a40, v52
    v_accvgpr_write_b32 a41, v53
    v_accvgpr_write_b32 a42, v54
    v_accvgpr_write_b32 a43, v55
    v_accvgpr_write_b32 a44, v56
    v_accvgpr_write_b32 a45, v57
    v_accvgpr_write_b32 a46, v58
    v_accvgpr_write_b32 a47, v59
    v_accvgpr_read_b32 v52, a48
    v_accvgpr_read_b32 v53, a49
    v_accvgpr_read_b32 v54, a50
    v_accvgpr_read_b32 v55, a51
    v_accvgpr_read_b32 v56, a52
    v_accvgpr_read_b32 v57, a53
    v_accvgpr_read_b32 v58, a54
    v_accvgpr_read_b32 v59, a55
    v_mul_f32 v52, v52, v49
    v_mul_f32 v53, v53, v49
    v_mul_f32 v54, v54, v49
    v_mul_f32 v55, v55, v49
    v_mul_f32 v56, v56, v49
    v_mul_f32 v57, v57, v49
    v_mul_f32 v58, v58, v49
    v_mul_f32 v59, v59, v49
    v_accvgpr_write_b32 a48, v52
    v_accvgpr_write_b32 a49, v53
    v_accvgpr_write_b32 a50, v54
    v_accvgpr_write_b32 a51, v55
    v_accvgpr_write_b32 a52, v56
    v_accvgpr_write_b32 a53, v57
    v_accvgpr_write_b32 a54, v58
    v_accvgpr_write_b32 a55, v59
    v_accvgpr_read_b32 v52, a56
    v_accvgpr_read_b32 v53, a57
    v_accvgpr_read_b32 v54, a58
    v_accvgpr_read_b32 v55, a59
    v_accvgpr_read_b32 v56, a60
    v_accvgpr_read_b32 v57, a61
    v_accvgpr_read_b32 v58, a62
    v_accvgpr_read_b32 v59, a63
    v_mul_f32 v52, v52, v49
    v_mul_f32 v53, v53, v49
    v_mul_f32 v54, v54, v49
    v_mul_f32 v55, v55, v49
    v_mul_f32 v56, v56, v49
    v_mul_f32 v57, v57, v49
    v_mul_f32 v58, v58, v49
    v_mul_f32 v59, v59, v49
    v_accvgpr_write_b32 a56, v52
    v_accvgpr_write_b32 a57, v53
    v_accvgpr_write_b32 a58, v54
    v_accvgpr_write_b32 a59, v55
    v_accvgpr_write_b32 a60, v56
    v_accvgpr_write_b32 a61, v57
    v_accvgpr_write_b32 a62, v58
    v_accvgpr_write_b32 a63, v59
    v_exp_f32 v52, v72
    v_exp_f32 v53, v73
    v_exp_f32 v54, v74
    v_exp_f32 v55, v75
    v_exp_f32 v56, v76
    v_exp_f32 v57, v77
    v_exp_f32 v58, v78
    v_exp_f32 v59, v79
    s_nop 0
    v_cvt_pk_bf16_f32 v132, v52, v53
    v_cvt_pk_bf16_f32 v133, v54, v55
    v_cvt_pk_bf16_f32 v134, v56, v57
    v_cvt_pk_bf16_f32 v135, v58, v59
    s_nop 1
    v_mfma_f32_16x16x32_bf16 v[32:35], v[44:47], v[132:135], 0
    s_nop 7
    s_setpc_b64 s[74:75]
m_rs0488:
    s_nop 15
    v_max3_f32 v48, v64, v65, v66
    v_max3_f32 v48, v48, v67, v68
    v_max3_f32 v48, v48, v69, v70
    v_max3_f32 v48, v48, v71, 0
    v_mov_b32 v49, v48
    s_nop 1
    v_permlane32_swap_b32 v48, v49
    s_nop 1
    v_max_f32 v48, v48, v49
    v_mov_b32 v49, v48
    s_nop 1
    v_permlane16_swap_b32 v48, v49
    s_nop 1
    v_max_f32 v48, v48, v49
    v_exp_f32 v49, -v48
    v_sub_f32 v64, v64, v48
    v_sub_f32 v65, v65, v48
    v_sub_f32 v66, v66, v48
    v_sub_f32 v67, v67, v48
    v_sub_f32 v68, v68, v48
    v_sub_f32 v69, v69, v48
    v_sub_f32 v70, v70, v48
    v_sub_f32 v71, v71, v48
    v_sub_f32 v96, v96, v48
    v_sub_f32 v97, v97, v48
    v_sub_f32 v98, v98, v48
    v_sub_f32 v99, v99, v48
    v_sub_f32 v100, v100, v48
    v_sub_f32 v101, v101, v48
    v_sub_f32 v102, v102, v48
    v_sub_f32 v103, v103, v48
    v_sub_f32 v160, v160, v48
    v_sub_f32 v161, v161, v48
    v_sub_f32 v162, v162, v48
    v_sub_f32 v163, v163, v48
    v_sub_f32 v164, v164, v48
    v_sub_f32 v165, v165, v48
    v_sub_f32 v166, v166, v48
    v_sub_f32 v167, v167, v48
    v_mul_f32 v12, v12, v49
    v_accvgpr_read_b32 v52, a0
    v_accvgpr_read_b32 v53, a1
    v_accvgpr_read_b32 v54, a2
    v_accvgpr_read_b32 v55, a3
    v_accvgpr_read_b32 v56, a4
    v_accvgpr_read_b32 v57, a5
    v_accvgpr_read_b32 v58, a6
    v_accvgpr_read_b32 v59, a7
    v_mul_f32 v52, v52, v49
    v_mul_f32 v53, v53, v49
    v_mul_f32 v54, v54, v49
    v_mul_f32 v55, v55, v49
    v_mul_f32 v56, v56, v49
    v_mul_f32 v57, v57, v49
    v_mul_f32 v58, v58, v49
    v_mul_f32 v59, v59, v49
    v_accvgpr_write_b32 a0, v52
    v_accvgpr_write_b32 a1, v53
    v_accvgpr_write_b32 a2, v54
    v_accvgpr_write_b32 a3, v55
    v_accvgpr_write_b32 a4, v56
    v_accvgpr_write_b32 a5, v57
    v_accvgpr_write_b32 a6, v58
    v_accvgpr_write_b32 a7, v59
    v_accvgpr_read_b32 v52, a8
    v_accvgpr_read_b32 v53, a9
    v_accvgpr_read_b32 v54, a10
    v_accvgpr_read_b32 v55, a11
    v_accvgpr_read_b32 v56, a12
    v_accvgpr_read_b32 v57, a13
    v_accvgpr_read_b32 v58, a14
    v_accvgpr_read_b32 v59, a15
    v_mul_f32 v52, v52, v49
    v_mul_f32 v53, v53, v49
    v_mul_f32 v54, v54, v49
    v_mul_f32 v55, v55, v49
    v_mul_f32 v56, v56, v49
    v_mul_f32 v57, v57, v49
    v_mul_f32 v58, v58, v49
    v_mul_f32 v59, v59, v49
    v_accvgpr_write_b32 a8, v52
    v_accvgpr_write_b32 a9, v53
    v_accvgpr_write_b32 a10, v54
    v_accvgpr_write_b32 a11, v55
    v_accvgpr_write_b32 a12, v56
    v_accvgpr_write_b32 a13, v57
    v_accvgpr_write_b32 a14, v58
    v_accvgpr_write_b32 a15, v59
    v_accvgpr_read_b32 v52, a16
    v_accvgpr_read_b32 v53, a17
    v_accvgpr_read_b32 v54, a18
    v_accvgpr_read_b32 v55, a19
    v_accvgpr_read_b32 v56, a20
    v_accvgpr_read_b32 v57, a21
    v_accvgpr_read_b32 v58, a22
    v_accvgpr_read_b32 v59, a23
    v_mul_f32 v52, v52, v49
    v_mul_f32 v53, v53, v49
    v_mul_f32 v54, v54, v49
    v_mul_f32 v55, v55, v49
    v_mul_f32 v56, v56, v49
    v_mul_f32 v57, v57, v49
    v_mul_f32 v58, v58, v49
    v_mul_f32 v59, v59, v49
    v_accvgpr_write_b32 a16, v52
    v_accvgpr_write_b32 a17, v53
    v_accvgpr_write_b32 a18, v54
    v_accvgpr_write_b32 a19, v55
    v_accvgpr_write_b32 a20, v56
    v_accvgpr_write_b32 a21, v57
    v_accvgpr_write_b32 a22, v58
    v_accvgpr_write_b32 a23, v59
    v_accvgpr_read_b32 v52, a24
    v_accvgpr_read_b32 v53, a25
    v_accvgpr_read_b32 v54, a26
    v_accvgpr_read_b32 v55, a27
    v_accvgpr_read_b32 v56, a28
    v_accvgpr_read_b32 v57, a29
    v_accvgpr_read_b32 v58, a30
    v_accvgpr_read_b32 v59, a31
    v_mul_f32 v52, v52, v49
    v_mul_f32 v53, v53, v49
    v_mul_f32 v54, v54, v49
    v_mul_f32 v55, v55, v49
    v_mul_f32 v56, v56, v49
    v_mul_f32 v57, v57, v49
    v_mul_f32 v58, v58, v49
    v_mul_f32 v59, v59, v49
    v_accvgpr_write_b32 a24, v52
    v_accvgpr_write_b32 a25, v53
    v_accvgpr_write_b32 a26, v54
    v_accvgpr_write_b32 a27, v55
    v_accvgpr_write_b32 a28, v56
    v_accvgpr_write_b32 a29, v57
    v_accvgpr_write_b32 a30, v58
    v_accvgpr_write_b32 a31, v59
    v_exp_f32 v52, v64
    v_exp_f32 v53, v65
    v_exp_f32 v54, v66
    v_exp_f32 v55, v67
    v_exp_f32 v56, v68
    v_exp_f32 v57, v69
    v_exp_f32 v58, v70
    v_exp_f32 v59, v71
    s_nop 0
    v_cvt_pk_bf16_f32 v128, v52, v53
    v_cvt_pk_bf16_f32 v129, v54, v55
    v_cvt_pk_bf16_f32 v130, v56, v57
    v_cvt_pk_bf16_f32 v131, v58, v59
    s_nop 1
    v_mfma_f32_16x16x32_bf16 v[28:31], v[44:47], v[128:131], 0
    v_max3_f32 v48, v72, v73, v74
    v_max3_f32 v48, v48, v75, v76
    v_max3_f32 v48, v48, v77, v78
    v_max3_f32 v48, v48, v79, 0
    v_mov_b32 v49, v48
    s_nop 1
    v_permlane32_swap_b32 v48, v49
    s_nop 1
    v_max_f32 v48, v48, v49
    v_mov_b32 v49, v48
    s_nop 1
    v_permlane16_swap_b32 v48, v49
    s_nop 1
    v_max_f32 v48, v48, v49
    v_exp_f32 v49, -v48
    v_sub_f32 v72, v72, v48
    v_sub_f32 v73, v73, v48
    v_sub_f32 v74, v74, v48
    v_sub_f32 v75, v75, v48
    v_sub_f32 v76, v76, v48
    v_sub_f32 v77, v77, v48
    v_sub_f32 v78, v78, v48
    v_sub_f32 v79, v79, v48
    v_sub_f32 v104, v104, v48
    v_sub_f32 v105, v105, v48
    v_sub_f32 v106, v106, v48
    v_sub_f32 v107, v107, v48
    v_sub_f32 v108, v108, v48
    v_sub_f32 v109, v109, v48
    v_sub_f32 v110, v110, v48
    v_sub_f32 v111, v111, v48
    v_sub_f32 v168, v168, v48
    v_sub_f32 v169, v169, v48
    v_sub_f32 v170, v170, v48
    v_sub_f32 v171, v171, v48
    v_sub_f32 v172, v172, v48
    v_sub_f32 v173, v173, v48
    v_sub_f32 v174, v174, v48
    v_sub_f32 v175, v175, v48
    v_mul_f32 v13, v13, v49
    v_accvgpr_read_b32 v52, a32
    v_accvgpr_read_b32 v53, a33
    v_accvgpr_read_b32 v54, a34
    v_accvgpr_read_b32 v55, a35
    v_accvgpr_read_b32 v56, a36
    v_accvgpr_read_b32 v57, a37
    v_accvgpr_read_b32 v58, a38
    v_accvgpr_read_b32 v59, a39
    v_mul_f32 v52, v52, v49
    v_mul_f32 v53, v53, v49
    v_mul_f32 v54, v54, v49
    v_mul_f32 v55, v55, v49
    v_mul_f32 v56, v56, v49
    v_mul_f32 v57, v57, v49
    v_mul_f32 v58, v58, v49
    v_mul_f32 v59, v59, v49
    v_accvgpr_write_b32 a32, v52
    v_accvgpr_write_b32 a33, v53
    v_accvgpr_write_b32 a34, v54
    v_accvgpr_write_b32 a35, v55
    v_accvgpr_write_b32 a36, v56
    v_accvgpr_write_b32 a37, v57
    v_accvgpr_write_b32 a38, v58
    v_accvgpr_write_b32 a39, v59
    v_accvgpr_read_b32 v52, a40
    v_accvgpr_read_b32 v53, a41
    v_accvgpr_read_b32 v54, a42
    v_accvgpr_read_b32 v55, a43
    v_accvgpr_read_b32 v56, a44
    v_accvgpr_read_b32 v57, a45
    v_accvgpr_read_b32 v58, a46
    v_accvgpr_read_b32 v59, a47
    v_mul_f32 v52, v52, v49
    v_mul_f32 v53, v53, v49
    v_mul_f32 v54, v54, v49
    v_mul_f32 v55, v55, v49
    v_mul_f32 v56, v56, v49
    v_mul_f32 v57, v57, v49
    v_mul_f32 v58, v58, v49
    v_mul_f32 v59, v59, v49
    v_accvgpr_write_b32 a40, v52
    v_accvgpr_write_b32 a41, v53
    v_accvgpr_write_b32 a42, v54
    v_accvgpr_write_b32 a43, v55
    v_accvgpr_write_b32 a44, v56
    v_accvgpr_write_b32 a45, v57
    v_accvgpr_write_b32 a46, v58
    v_accvgpr_write_b32 a47, v59
    v_accvgpr_read_b32 v52, a48
    v_accvgpr_read_b32 v53, a49
    v_accvgpr_read_b32 v54, a50
    v_accvgpr_read_b32 v55, a51
    v_accvgpr_read_b32 v56, a52
    v_accvgpr_read_b32 v57, a53
    v_accvgpr_read_b32 v58, a54
    v_accvgpr_read_b32 v59, a55
    v_mul_f32 v52, v52, v49
    v_mul_f32 v53, v53, v49
    v_mul_f32 v54, v54, v49
    v_mul_f32 v55, v55, v49
    v_mul_f32 v56, v56, v49
    v_mul_f32 v57, v57, v49
    v_mul_f32 v58, v58, v49
    v_mul_f32 v59, v59, v49
    v_accvgpr_write_b32 a48, v52
    v_accvgpr_write_b32 a49, v53
    v_accvgpr_write_b32 a50, v54
    v_accvgpr_write_b32 a51, v55
    v_accvgpr_write_b32 a52, v56
    v_accvgpr_write_b32 a53, v57
    v_accvgpr_write_b32 a54, v58
    v_accvgpr_write_b32 a55, v59
    v_accvgpr_read_b32 v52, a56
    v_accvgpr_read_b32 v53, a57
    v_accvgpr_read_b32 v54, a58
    v_accvgpr_read_b32 v55, a59
    v_accvgpr_read_b32 v56, a60
    v_accvgpr_read_b32 v57, a61
    v_accvgpr_read_b32 v58, a62
    v_accvgpr_read_b32 v59, a63
    v_mul_f32 v52, v52, v49
    v_mul_f32 v53, v53, v49
    v_mul_f32 v54, v54, v49
    v_mul_f32 v55, v55, v49
    v_mul_f32 v56, v56, v49
    v_mul_f32 v57, v57, v49
    v_mul_f32 v58, v58, v49
    v_mul_f32 v59, v59, v49
    v_accvgpr_write_b32 a56, v52
    v_accvgpr_write_b32 a57, v53
    v_accvgpr_write_b32 a58, v54
    v_accvgpr_write_b32 a59, v55
    v_accvgpr_write_b32 a60, v56
    v_accvgpr_write_b32 a61, v57
    v_accvgpr_write_b32 a62, v58
    v_accvgpr_write_b32 a63, v59
    v_exp_f32 v52, v72
    v_exp_f32 v53, v73
    v_exp_f32 v54, v74
    v_exp_f32 v55, v75
    v_exp_f32 v56, v76
    v_exp_f32 v57, v77
    v_exp_f32 v58, v78
    v_exp_f32 v59, v79
    s_nop 0
    v_cvt_pk_bf16_f32 v132, v52, v53
    v_cvt_pk_bf16_f32 v133, v54, v55
    v_cvt_pk_bf16_f32 v134, v56, v57
    v_cvt_pk_bf16_f32 v135, v58, v59
    s_nop 1
    v_mfma_f32_16x16x32_bf16 v[32:35], v[44:47], v[132:135], 0
    v_max3_f32 v48, v80, v81, v82
    v_max3_f32 v48, v48, v83, v84
    v_max3_f32 v48, v48, v85, v86
    v_max3_f32 v48, v48, v87, 0
    v_mov_b32 v49, v48
    s_nop 1
    v_permlane32_swap_b32 v48, v49
    s_nop 1
    v_max_f32 v48, v48, v49
    v_mov_b32 v49, v48
    s_nop 1
    v_permlane16_swap_b32 v48, v49
    s_nop 1
    v_max_f32 v48, v48, v49
    v_exp_f32 v49, -v48
    v_sub_f32 v80, v80, v48
    v_sub_f32 v81, v81, v48
    v_sub_f32 v82, v82, v48
    v_sub_f32 v83, v83, v48
    v_sub_f32 v84, v84, v48
    v_sub_f32 v85, v85, v48
    v_sub_f32 v86, v86, v48
    v_sub_f32 v87, v87, v48
    v_sub_f32 v112, v112, v48
    v_sub_f32 v113, v113, v48
    v_sub_f32 v114, v114, v48
    v_sub_f32 v115, v115, v48
    v_sub_f32 v116, v116, v48
    v_sub_f32 v117, v117, v48
    v_sub_f32 v118, v118, v48
    v_sub_f32 v119, v119, v48
    v_sub_f32 v176, v176, v48
    v_sub_f32 v177, v177, v48
    v_sub_f32 v178, v178, v48
    v_sub_f32 v179, v179, v48
    v_sub_f32 v180, v180, v48
    v_sub_f32 v181, v181, v48
    v_sub_f32 v182, v182, v48
    v_sub_f32 v183, v183, v48
    v_mul_f32 v14, v14, v49
    v_accvgpr_read_b32 v52, a64
    v_accvgpr_read_b32 v53, a65
    v_accvgpr_read_b32 v54, a66
    v_accvgpr_read_b32 v55, a67
    v_accvgpr_read_b32 v56, a68
    v_accvgpr_read_b32 v57, a69
    v_accvgpr_read_b32 v58, a70
    v_accvgpr_read_b32 v59, a71
    v_mul_f32 v52, v52, v49
    v_mul_f32 v53, v53, v49
    v_mul_f32 v54, v54, v49
    v_mul_f32 v55, v55, v49
    v_mul_f32 v56, v56, v49
    v_mul_f32 v57, v57, v49
    v_mul_f32 v58, v58, v49
    v_mul_f32 v59, v59, v49
    v_accvgpr_write_b32 a64, v52
    v_accvgpr_write_b32 a65, v53
    v_accvgpr_write_b32 a66, v54
    v_accvgpr_write_b32 a67, v55
    v_accvgpr_write_b32 a68, v56
    v_accvgpr_write_b32 a69, v57
    v_accvgpr_write_b32 a70, v58
    v_accvgpr_write_b32 a71, v59
    v_accvgpr_read_b32 v52, a72
    v_accvgpr_read_b32 v53, a73
    v_accvgpr_read_b32 v54, a74
    v_accvgpr_read_b32 v55, a75
    v_accvgpr_read_b32 v56, a76
    v_accvgpr_read_b32 v57, a77
    v_accvgpr_read_b32 v58, a78
    v_accvgpr_read_b32 v59, a79
    v_mul_f32 v52, v52, v49
    v_mul_f32 v53, v53, v49
    v_mul_f32 v54, v54, v49
    v_mul_f32 v55, v55, v49
    v_mul_f32 v56, v56, v49
    v_mul_f32 v57, v57, v49
    v_mul_f32 v58, v58, v49
    v_mul_f32 v59, v59, v49
    v_accvgpr_write_b32 a72, v52
    v_accvgpr_write_b32 a73, v53
    v_accvgpr_write_b32 a74, v54
    v_accvgpr_write_b32 a75, v55
    v_accvgpr_write_b32 a76, v56
    v_accvgpr_write_b32 a77, v57
    v_accvgpr_write_b32 a78, v58
    v_accvgpr_write_b32 a79, v59
    v_accvgpr_read_b32 v52, a80
    v_accvgpr_read_b32 v53, a81
    v_accvgpr_read_b32 v54, a82
    v_accvgpr_read_b32 v55, a83
    v_accvgpr_read_b32 v56, a84
    v_accvgpr_read_b32 v57, a85
    v_accvgpr_read_b32 v58, a86
    v_accvgpr_read_b32 v59, a87
    v_mul_f32 v52, v52, v49
    v_mul_f32 v53, v53, v49
    v_mul_f32 v54, v54, v49
    v_mul_f32 v55, v55, v49
    v_mul_f32 v56, v56, v49
    v_mul_f32 v57, v57, v49
    v_mul_f32 v58, v58, v49
    v_mul_f32 v59, v59, v49
    v_accvgpr_write_b32 a80, v52
    v_accvgpr_write_b32 a81, v53
    v_accvgpr_write_b32 a82, v54
    v_accvgpr_write_b32 a83, v55
    v_accvgpr_write_b32 a84, v56
    v_accvgpr_write_b32 a85, v57
    v_accvgpr_write_b32 a86, v58
    v_accvgpr_write_b32 a87, v59
    v_accvgpr_read_b32 v52, a88
    v_accvgpr_read_b32 v53, a89
    v_accvgpr_read_b32 v54, a90
    v_accvgpr_read_b32 v55, a91
    v_accvgpr_read_b32 v56, a92
    v_accvgpr_read_b32 v57, a93
    v_accvgpr_read_b32 v58, a94
    v_accvgpr_read_b32 v59, a95
    v_mul_f32 v52, v52, v49
    v_mul_f32 v53, v53, v49
    v_mul_f32 v54, v54, v49
    v_mul_f32 v55, v55, v49
    v_mul_f32 v56, v56, v49
    v_mul_f32 v57, v57, v49
    v_mul_f32 v58, v58, v49
    v_mul_f32 v59, v59, v49
    v_accvgpr_write_b32 a88, v52
    v_accvgpr_write_b32 a89, v53
    v_accvgpr_write_b32 a90, v54
    v_accvgpr_write_b32 a91, v55
    v_accvgpr_write_b32 a92, v56
    v_accvgpr_write_b32 a93, v57
    v_accvgpr_write_b32 a94, v58
    v_accvgpr_write_b32 a95, v59
    v_exp_f32 v52, v80
    v_exp_f32 v53, v81
    v_exp_f32 v54, v82
    v_exp_f32 v55, v83
    v_exp_f32 v56, v84
    v_exp_f32 v57, v85
    v_exp_f32 v58, v86
    v_exp_f32 v59, v87
    s_nop 0
    v_cvt_pk_bf16_f32 v136, v52, v53
    v_cvt_pk_bf16_f32 v137, v54, v55
    v_cvt_pk_bf16_f32 v138, v56, v57
    v_cvt_pk_bf16_f32 v139, v58, v59
    s_nop 1
    v_mfma_f32_16x16x32_bf16 v[36:39], v[44:47], v[136:139], 0
    v_max3_f32 v48, v88, v89, v90
    v_max3_f32 v48, v48, v91, v92
    v_max3_f32 v48, v48, v93, v94
    v_max3_f32 v48, v48, v95, 0
    v_mov_b32 v49, v48
    s_nop 1
    v_permlane32_swap_b32 v48, v49
    s_nop 1
    v_max_f32 v48, v48, v49
    v_mov_b32 v49, v48
    s_nop 1
    v_permlane16_swap_b32 v48, v49
    s_nop 1
    v_max_f32 v48, v48, v49
    v_exp_f32 v49, -v48
    v_sub_f32 v88, v88, v48
    v_sub_f32 v89, v89, v48
    v_sub_f32 v90, v90, v48
    v_sub_f32 v91, v91, v48
    v_sub_f32 v92, v92, v48
    v_sub_f32 v93, v93, v48
    v_sub_f32 v94, v94, v48
    v_sub_f32 v95, v95, v48
    v_sub_f32 v120, v120, v48
    v_sub_f32 v121, v121, v48
    v_sub_f32 v122, v122, v48
    v_sub_f32 v123, v123, v48
    v_sub_f32 v124, v124, v48
    v_sub_f32 v125, v125, v48
    v_sub_f32 v126, v126, v48
    v_sub_f32 v127, v127, v48
    v_sub_f32 v184, v184, v48
    v_sub_f32 v185, v185, v48
    v_sub_f32 v186, v186, v48
    v_sub_f32 v187, v187, v48
    v_sub_f32 v188, v188, v48
    v_sub_f32 v189, v189, v48
    v_sub_f32 v190, v190, v48
    v_sub_f32 v191, v191, v48
    v_mul_f32 v15, v15, v49
    v_accvgpr_read_b32 v52, a96
    v_accvgpr_read_b32 v53, a97
    v_accvgpr_read_b32 v54, a98
    v_accvgpr_read_b32 v55, a99
    v_accvgpr_read_b32 v56, a100
    v_accvgpr_read_b32 v57, a101
    v_accvgpr_read_b32 v58, a102
    v_accvgpr_read_b32 v59, a103
    v_mul_f32 v52, v52, v49
    v_mul_f32 v53, v53, v49
    v_mul_f32 v54, v54, v49
    v_mul_f32 v55, v55, v49
    v_mul_f32 v56, v56, v49
    v_mul_f32 v57, v57, v49
    v_mul_f32 v58, v58, v49
    v_mul_f32 v59, v59, v49
    v_accvgpr_write_b32 a96, v52
    v_accvgpr_write_b32 a97, v53
    v_accvgpr_write_b32 a98, v54
    v_accvgpr_write_b32 a99, v55
    v_accvgpr_write_b32 a100, v56
    v_accvgpr_write_b32 a101, v57
    v_accvgpr_write_b32 a102, v58
    v_accvgpr_write_b32 a103, v59
    v_accvgpr_read_b32 v52, a104
    v_accvgpr_read_b32 v53, a105
    v_accvgpr_read_b32 v54, a106
    v_accvgpr_read_b32 v55, a107
    v_accvgpr_read_b32 v56, a108
    v_accvgpr_read_b32 v57, a109
    v_accvgpr_read_b32 v58, a110
    v_accvgpr_read_b32 v59, a111
    v_mul_f32 v52, v52, v49
    v_mul_f32 v53, v53, v49
    v_mul_f32 v54, v54, v49
    v_mul_f32 v55, v55, v49
    v_mul_f32 v56, v56, v49
    v_mul_f32 v57, v57, v49
    v_mul_f32 v58, v58, v49
    v_mul_f32 v59, v59, v49
    v_accvgpr_write_b32 a104, v52
    v_accvgpr_write_b32 a105, v53
    v_accvgpr_write_b32 a106, v54
    v_accvgpr_write_b32 a107, v55
    v_accvgpr_write_b32 a108, v56
    v_accvgpr_write_b32 a109, v57
    v_accvgpr_write_b32 a110, v58
    v_accvgpr_write_b32 a111, v59
    v_accvgpr_read_b32 v52, a112
    v_accvgpr_read_b32 v53, a113
    v_accvgpr_read_b32 v54, a114
    v_accvgpr_read_b32 v55, a115
    v_accvgpr_read_b32 v56, a116
    v_accvgpr_read_b32 v57, a117
    v_accvgpr_read_b32 v58, a118
    v_accvgpr_read_b32 v59, a119
    v_mul_f32 v52, v52, v49
    v_mul_f32 v53, v53, v49
    v_mul_f32 v54, v54, v49
    v_mul_f32 v55, v55, v49
    v_mul_f32 v56, v56, v49
    v_mul_f32 v57, v57, v49
    v_mul_f32 v58, v58, v49
    v_mul_f32 v59, v59, v49
    v_accvgpr_write_b32 a112, v52
    v_accvgpr_write_b32 a113, v53
    v_accvgpr_write_b32 a114, v54
    v_accvgpr_write_b32 a115, v55
    v_accvgpr_write_b32 a116, v56
    v_accvgpr_write_b32 a117, v57
    v_accvgpr_write_b32 a118, v58
    v_accvgpr_write_b32 a119, v59
    v_accvgpr_read_b32 v52, a120
    v_accvgpr_read_b32 v53, a121
    v_accvgpr_read_b32 v54, a122
    v_accvgpr_read_b32 v55, a123
    v_accvgpr_read_b32 v56, a124
    v_accvgpr_read_b32 v57, a125
    v_accvgpr_read_b32 v58, a126
    v_accvgpr_read_b32 v59, a127
    v_mul_f32 v52, v52, v49
    v_mul_f32 v53, v53, v49
    v_mul_f32 v54, v54, v49
    v_mul_f32 v55, v55, v49
    v_mul_f32 v56, v56, v49
    v_mul_f32 v57, v57, v49
    v_mul_f32 v58, v58, v49
    v_mul_f32 v59, v59, v49
    v_accvgpr_write_b32 a120, v52
    v_accvgpr_write_b32 a121, v53
    v_accvgpr_write_b32 a122, v54
    v_accvgpr_write_b32 a123, v55
    v_accvgpr_write_b32 a124, v56
    v_accvgpr_write_b32 a125, v57
    v_accvgpr_write_b32 a126, v58
    v_accvgpr_write_b32 a127, v59
    v_exp_f32 v52, v88
    v_exp_f32 v53, v89
    v_exp_f32 v54, v90
    v_exp_f32 v55, v91
    v_exp_f32 v56, v92
    v_exp_f32 v57, v93
    v_exp_f32 v58, v94
    v_exp_f32 v59, v95
    s_nop 0
    v_cvt_pk_bf16_f32 v140, v52, v53
    v_cvt_pk_bf16_f32 v141, v54, v55
    v_cvt_pk_bf16_f32 v142, v56, v57
    v_cvt_pk_bf16_f32 v143, v58, v59
    s_nop 1
    v_mfma_f32_16x16x32_bf16 v[40:43], v[44:47], v[140:143], 0
    s_nop 7
    s_setpc_b64 s[74:75]
m_rs1289:
    s_nop 15
    v_max3_f32 v48, v96, v97, v98
    v_max3_f32 v48, v48, v99, v100
    v_max3_f32 v48, v48, v101, v102
    v_max3_f32 v48, v48, v103, 0
    v_mov_b32 v49, v48
    s_nop 1
    v_permlane32_swap_b32 v48, v49
    s_nop 1
    v_max_f32 v48, v48, v49
    v_mov_b32 v49, v48
    s_nop 1
    v_permlane16_swap_b32 v48, v49
    s_nop 1
    v_max_f32 v48, v48, v49
    v_exp_f32 v49, -v48
    v_sub_f32 v96, v96, v48
    v_sub_f32 v97, v97, v48
    v_sub_f32 v98, v98, v48
    v_sub_f32 v99, v99, v48
    v_sub_f32 v100, v100, v48
    v_sub_f32 v101, v101, v48
    v_sub_f32 v102, v102, v48
    v_sub_f32 v103, v103, v48
    v_sub_f32 v64, v64, v48
    v_sub_f32 v65, v65, v48
    v_sub_f32 v66, v66, v48
    v_sub_f32 v67, v67, v48
    v_sub_f32 v68, v68, v48
    v_sub_f32 v69, v69, v48
    v_sub_f32 v70, v70, v48
    v_sub_f32 v71, v71, v48
    v_sub_f32 v160, v160, v48
    v_sub_f32 v161, v161, v48
    v_sub_f32 v162, v162, v48
    v_sub_f32 v163, v163, v48
    v_sub_f32 v164, v164, v48
    v_sub_f32 v165, v165, v48
    v_sub_f32 v166, v166, v48
    v_sub_f32 v167, v167, v48
    v_mul_f32 v12, v12, v49
    v_accvgpr_read_b32 v52, a0
    v_accvgpr_read_b32 v53, a1
    v_accvgpr_read_b32 v54, a2
    v_accvgpr_read_b32 v55, a3
    v_accvgpr_read_b32 v56, a4
    v_accvgpr_read_b32 v57, a5
    v_accvgpr_read_b32 v58, a6
    v_accvgpr_read_b32 v59, a7
    v_mul_f32 v52, v52, v49
    v_mul_f32 v53, v53, v49
    v_mul_f32 v54, v54, v49
    v_mul_f32 v55, v55, v49
    v_mul_f32 v56, v56, v49
    v_mul_f32 v57, v57, v49
    v_mul_f32 v58, v58, v49
    v_mul_f32 v59, v59, v49
    v_accvgpr_write_b32 a0, v52
    v_accvgpr_write_b32 a1, v53
    v_accvgpr_write_b32 a2, v54
    v_accvgpr_write_b32 a3, v55
    v_accvgpr_write_b32 a4, v56
    v_accvgpr_write_b32 a5, v57
    v_accvgpr_write_b32 a6, v58
    v_accvgpr_write_b32 a7, v59
    v_accvgpr_read_b32 v52, a8
    v_accvgpr_read_b32 v53, a9
    v_accvgpr_read_b32 v54, a10
    v_accvgpr_read_b32 v55, a11
    v_accvgpr_read_b32 v56, a12
    v_accvgpr_read_b32 v57, a13
    v_accvgpr_read_b32 v58, a14
    v_accvgpr_read_b32 v59, a15
    v_mul_f32 v52, v52, v49
    v_mul_f32 v53, v53, v49
    v_mul_f32 v54, v54, v49
    v_mul_f32 v55, v55, v49
    v_mul_f32 v56, v56, v49
    v_mul_f32 v57, v57, v49
    v_mul_f32 v58, v58, v49
    v_mul_f32 v59, v59, v49
    v_accvgpr_write_b32 a8, v52
    v_accvgpr_write_b32 a9, v53
    v_accvgpr_write_b32 a10, v54
    v_accvgpr_write_b32 a11, v55
    v_accvgpr_write_b32 a12, v56
    v_accvgpr_write_b32 a13, v57
    v_accvgpr_write_b32 a14, v58
    v_accvgpr_write_b32 a15, v59
    v_accvgpr_read_b32 v52, a16
    v_accvgpr_read_b32 v53, a17
    v_accvgpr_read_b32 v54, a18
    v_accvgpr_read_b32 v55, a19
    v_accvgpr_read_b32 v56, a20
    v_accvgpr_read_b32 v57, a21
    v_accvgpr_read_b32 v58, a22
    v_accvgpr_read_b32 v59, a23
    v_mul_f32 v52, v52, v49
    v_mul_f32 v53, v53, v49
    v_mul_f32 v54, v54, v49
    v_mul_f32 v55, v55, v49
    v_mul_f32 v56, v56, v49
    v_mul_f32 v57, v57, v49
    v_mul_f32 v58, v58, v49
    v_mul_f32 v59, v59, v49
    v_accvgpr_write_b32 a16, v52
    v_accvgpr_write_b32 a17, v53
    v_accvgpr_write_b32 a18, v54
    v_accvgpr_write_b32 a19, v55
    v_accvgpr_write_b32 a20, v56
    v_accvgpr_write_b32 a21, v57
    v_accvgpr_write_b32 a22, v58
    v_accvgpr_write_b32 a23, v59
    v_accvgpr_read_b32 v52, a24
    v_accvgpr_read_b32 v53, a25
    v_accvgpr_read_b32 v54, a26
    v_accvgpr_read_b32 v55, a27
    v_accvgpr_read_b32 v56, a28
    v_accvgpr_read_b32 v57, a29
    v_accvgpr_read_b32 v58, a30
    v_accvgpr_read_b32 v59, a31
    v_mul_f32 v52, v52, v49
    v_mul_f32 v53, v53, v49
    v_mul_f32 v54, v54, v49
    v_mul_f32 v55, v55, v49
    v_mul_f32 v56, v56, v49
    v_mul_f32 v57, v57, v49
    v_mul_f32 v58, v58, v49
    v_mul_f32 v59, v59, v49
    v_accvgpr_write_b32 a24, v52
    v_accvgpr_write_b32 a25, v53
    v_accvgpr_write_b32 a26, v54
    v_accvgpr_write_b32 a27, v55
    v_accvgpr_write_b32 a28, v56
    v_accvgpr_write_b32 a29, v57
    v_accvgpr_write_b32 a30, v58
    v_accvgpr_write_b32 a31, v59
    v_exp_f32 v52, v96
    v_exp_f32 v53, v97
    v_exp_f32 v54, v98
    v_exp_f32 v55, v99
    v_exp_f32 v56, v100
    v_exp_f32 v57, v101
    v_exp_f32 v58, v102
    v_exp_f32 v59, v103
    s_nop 0
    v_cvt_pk_bf16_f32 v144, v52, v53
    v_cvt_pk_bf16_f32 v145, v54, v55
    v_cvt_pk_bf16_f32 v146, v56, v57
    v_cvt_pk_bf16_f32 v147, v58, v59
    s_nop 1
    v_mfma_f32_16x16x32_bf16 v[28:31], v[44:47], v[144:147], 0
    v_max3_f32 v48, v104, v105, v106
    v_max3_f32 v48, v48, v107, v108
    v_max3_f32 v48, v48, v109, v110
    v_max3_f32 v48, v48, v111, 0
    v_mov_b32 v49, v48
    s_nop 1
    v_permlane32_swap_b32 v48, v49
    s_nop 1
    v_max_f32 v48, v48, v49
    v_mov_b32 v49, v48
    s_nop 1
    v_permlane16_swap_b32 v48, v49
    s_nop 1
    v_max_f32 v48, v48, v49
    v_exp_f32 v49, -v48
    v_sub_f32 v104, v104, v48
    v_sub_f32 v105, v105, v48
    v_sub_f32 v106, v106, v48
    v_sub_f32 v107, v107, v48
    v_sub_f32 v108, v108, v48
    v_sub_f32 v109, v109, v48
    v_sub_f32 v110, v110, v48
    v_sub_f32 v111, v111, v48
    v_sub_f32 v72, v72, v48
    v_sub_f32 v73, v73, v48
    v_sub_f32 v74, v74, v48
    v_sub_f32 v75, v75, v48
    v_sub_f32 v76, v76, v48
    v_sub_f32 v77, v77, v48
    v_sub_f32 v78, v78, v48
    v_sub_f32 v79, v79, v48
    v_sub_f32 v168, v168, v48
    v_sub_f32 v169, v169, v48
    v_sub_f32 v170, v170, v48
    v_sub_f32 v171, v171, v48
    v_sub_f32 v172, v172, v48
    v_sub_f32 v173, v173, v48
    v_sub_f32 v174, v174, v48
    v_sub_f32 v175, v175, v48
    v_mul_f32 v13, v13, v49
    v_accvgpr_read_b32 v52, a32
    v_accvgpr_read_b32 v53, a33
    v_accvgpr_read_b32 v54, a34
    v_accvgpr_read_b32 v55, a35
    v_accvgpr_read_b32 v56, a36
    v_accvgpr_read_b32 v57, a37
    v_accvgpr_read_b32 v58, a38
    v_accvgpr_read_b32 v59, a39
    v_mul_f32 v52, v52, v49
    v_mul_f32 v53, v53, v49
    v_mul_f32 v54, v54, v49
    v_mul_f32 v55, v55, v49
    v_mul_f32 v56, v56, v49
    v_mul_f32 v57, v57, v49
    v_mul_f32 v58, v58, v49
    v_mul_f32 v59, v59, v49
    v_accvgpr_write_b32 a32, v52
    v_accvgpr_write_b32 a33, v53
    v_accvgpr_write_b32 a34, v54
    v_accvgpr_write_b32 a35, v55
    v_accvgpr_write_b32 a36, v56
    v_accvgpr_write_b32 a37, v57
    v_accvgpr_write_b32 a38, v58
    v_accvgpr_write_b32 a39, v59
    v_accvgpr_read_b32 v52, a40
    v_accvgpr_read_b32 v53, a41
    v_accvgpr_read_b32 v54, a42
    v_accvgpr_read_b32 v55, a43
    v_accvgpr_read_b32 v56, a44
    v_accvgpr_read_b32 v57, a45
    v_accvgpr_read_b32 v58, a46
    v_accvgpr_read_b32 v59, a47
    v_mul_f32 v52, v52, v49
    v_mul_f32 v53, v53, v49
    v_mul_f32 v54, v54, v49
    v_mul_f32 v55, v55, v49
    v_mul_f32 v56, v56, v49
    v_mul_f32 v57, v57, v49
    v_mul_f32 v58, v58, v49
    v_mul_f32 v59, v59, v49
    v_accvgpr_write_b32 a40, v52
    v_accvgpr_write_b32 a41, v53
    v_accvgpr_write_b32 a42, v54
    v_accvgpr_write_b32 a43, v55
    v_accvgpr_write_b32 a44, v56
    v_accvgpr_write_b32 a45, v57
    v_accvgpr_write_b32 a46, v58
    v_accvgpr_write_b32 a47, v59
    v_accvgpr_read_b32 v52, a48
    v_accvgpr_read_b32 v53, a49
    v_accvgpr_read_b32 v54, a50
    v_accvgpr_read_b32 v55, a51
    v_accvgpr_read_b32 v56, a52
    v_accvgpr_read_b32 v57, a53
    v_accvgpr_read_b32 v58, a54
    v_accvgpr_read_b32 v59, a55
    v_mul_f32 v52, v52, v49
    v_mul_f32 v53, v53, v49
    v_mul_f32 v54, v54, v49
    v_mul_f32 v55, v55, v49
    v_mul_f32 v56, v56, v49
    v_mul_f32 v57, v57, v49
    v_mul_f32 v58, v58, v49
    v_mul_f32 v59, v59, v49
    v_accvgpr_write_b32 a48, v52
    v_accvgpr_write_b32 a49, v53
    v_accvgpr_write_b32 a50, v54
    v_accvgpr_write_b32 a51, v55
    v_accvgpr_write_b32 a52, v56
    v_accvgpr_write_b32 a53, v57
    v_accvgpr_write_b32 a54, v58
    v_accvgpr_write_b32 a55, v59
    v_accvgpr_read_b32 v52, a56
    v_accvgpr_read_b32 v53, a57
    v_accvgpr_read_b32 v54, a58
    v_accvgpr_read_b32 v55, a59
    v_accvgpr_read_b32 v56, a60
    v_accvgpr_read_b32 v57, a61
    v_accvgpr_read_b32 v58, a62
    v_accvgpr_read_b32 v59, a63
    v_mul_f32 v52, v52, v49
    v_mul_f32 v53, v53, v49
    v_mul_f32 v54, v54, v49
    v_mul_f32 v55, v55, v49
    v_mul_f32 v56, v56, v49
    v_mul_f32 v57, v57, v49
    v_mul_f32 v58, v58, v49
    v_mul_f32 v59, v59, v49
    v_accvgpr_write_b32 a56, v52
    v_accvgpr_write_b32 a57, v53
    v_accvgpr_write_b32 a58, v54
    v_accvgpr_write_b32 a59, v55
    v_accvgpr_write_b32 a60, v56
    v_accvgpr_write_b32 a61, v57
    v_accvgpr_write_b32 a62, v58
    v_accvgpr_write_b32 a63, v59
    v_exp_f32 v52, v104
    v_exp_f32 v53, v105
    v_exp_f32 v54, v106
    v_exp_f32 v55, v107
    v_exp_f32 v56, v108
    v_exp_f32 v57, v109
    v_exp_f32 v58, v110
    v_exp_f32 v59, v111
    s_nop 0
    v_cvt_pk_bf16_f32 v148, v52, v53
    v_cvt_pk_bf16_f32 v149, v54, v55
    v_cvt_pk_bf16_f32 v150, v56, v57
    v_cvt_pk_bf16_f32 v151, v58, v59
    s_nop 1
    v_mfma_f32_16x16x32_bf16 v[32:35], v[44:47], v[148:151], 0
    s_nop 7
    s_setpc_b64 s[74:75]
m_rs1490:
    s_nop 15
    v_max3_f32 v48, v96, v97, v98
    v_max3_f32 v48, v48, v99, v100
    v_max3_f32 v48, v48, v101, v102
    v_max3_f32 v48, v48, v103, 0
    v_mov_b32 v49, v48
    s_nop 1
    v_permlane32_swap_b32 v48, v49
    s_nop 1
    v_max_f32 v48, v48, v49
    v_mov_b32 v49, v48
    s_nop 1
    v_permlane16_swap_b32 v48, v49
    s_nop 1
    v_max_f32 v48, v48, v49
    v_exp_f32 v49, -v48
    v_sub_f32 v96, v96, v48
    v_sub_f32 v97, v97, v48
    v_sub_f32 v98, v98, v48
    v_sub_f32 v99, v99, v48
    v_sub_f32 v100, v100, v48
    v_sub_f32 v101, v101, v48
    v_sub_f32 v102, v102, v48
    v_sub_f32 v103, v103, v48
    v_sub_f32 v64, v64, v48
    v_sub_f32 v65, v65, v48
    v_sub_f32 v66, v66, v48
    v_sub_f32 v67, v67, v48
    v_sub_f32 v68, v68, v48
    v_sub_f32 v69, v69, v48
    v_sub_f32 v70, v70, v48
    v_sub_f32 v71, v71, v48
    v_sub_f32 v160, v160, v48
    v_sub_f32 v161, v161, v48
    v_sub_f32 v162, v162, v48
    v_sub_f32 v163, v163, v48
    v_sub_f32 v164, v164, v48
    v_sub_f32 v165, v165, v48
    v_sub_f32 v166, v166, v48
    v_sub_f32 v167, v167, v48
    v_mul_f32 v12, v12, v49
    v_accvgpr_read_b32 v52, a0
    v_accvgpr_read_b32 v53, a1
    v_accvgpr_read_b32 v54, a2
    v_accvgpr_read_b32 v55, a3
    v_accvgpr_read_b32 v56, a4
    v_accvgpr_read_b32 v57, a5
    v_accvgpr_read_b32 v58, a6
    v_accvgpr_read_b32 v59, a7
    v_mul_f32 v52, v52, v49
    v_mul_f32 v53, v53, v49
    v_mul_f32 v54, v54, v49
    v_mul_f32 v55, v55, v49
    v_mul_f32 v56, v56, v49
    v_mul_f32 v57, v57, v49
    v_mul_f32 v58, v58, v49
    v_mul_f32 v59, v59, v49
    v_accvgpr_write_b32 a0, v52
    v_accvgpr_write_b32 a1, v53
    v_accvgpr_write_b32 a2, v54
    v_accvgpr_write_b32 a3, v55
    v_accvgpr_write_b32 a4, v56
    v_accvgpr_write_b32 a5, v57
    v_accvgpr_write_b32 a6, v58
    v_accvgpr_write_b32 a7, v59
    v_accvgpr_read_b32 v52, a8
    v_accvgpr_read_b32 v53, a9
    v_accvgpr_read_b32 v54, a10
    v_accvgpr_read_b32 v55, a11
    v_accvgpr_read_b32 v56, a12
    v_accvgpr_read_b32 v57, a13
    v_accvgpr_read_b32 v58, a14
    v_accvgpr_read_b32 v59, a15
    v_mul_f32 v52, v52, v49
    v_mul_f32 v53, v53, v49
    v_mul_f32 v54, v54, v49
    v_mul_f32 v55, v55, v49
    v_mul_f32 v56, v56, v49
    v_mul_f32 v57, v57, v49
    v_mul_f32 v58, v58, v49
    v_mul_f32 v59, v59, v49
    v_accvgpr_write_b32 a8, v52
    v_accvgpr_write_b32 a9, v53
    v_accvgpr_write_b32 a10, v54
    v_accvgpr_write_b32 a11, v55
    v_accvgpr_write_b32 a12, v56
    v_accvgpr_write_b32 a13, v57
    v_accvgpr_write_b32 a14, v58
    v_accvgpr_write_b32 a15, v59
    v_accvgpr_read_b32 v52, a16
    v_accvgpr_read_b32 v53, a17
    v_accvgpr_read_b32 v54, a18
    v_accvgpr_read_b32 v55, a19
    v_accvgpr_read_b32 v56, a20
    v_accvgpr_read_b32 v57, a21
    v_accvgpr_read_b32 v58, a22
    v_accvgpr_read_b32 v59, a23
    v_mul_f32 v52, v52, v49
    v_mul_f32 v53, v53, v49
    v_mul_f32 v54, v54, v49
    v_mul_f32 v55, v55, v49
    v_mul_f32 v56, v56, v49
    v_mul_f32 v57, v57, v49
    v_mul_f32 v58, v58, v49
    v_mul_f32 v59, v59, v49
    v_accvgpr_write_b32 a16, v52
    v_accvgpr_write_b32 a17, v53
    v_accvgpr_write_b32 a18, v54
    v_accvgpr_write_b32 a19, v55
    v_accvgpr_write_b32 a20, v56
    v_accvgpr_write_b32 a21, v57
    v_accvgpr_write_b32 a22, v58
    v_accvgpr_write_b32 a23, v59
    v_accvgpr_read_b32 v52, a24
    v_accvgpr_read_b32 v53, a25
    v_accvgpr_read_b32 v54, a26
    v_accvgpr_read_b32 v55, a27
    v_accvgpr_read_b32 v56, a28
    v_accvgpr_read_b32 v57, a29
    v_accvgpr_read_b32 v58, a30
    v_accvgpr_read_b32 v59, a31
    v_mul_f32 v52, v52, v49
    v_mul_f32 v53, v53, v49
    v_mul_f32 v54, v54, v49
    v_mul_f32 v55, v55, v49
    v_mul_f32 v56, v56, v49
    v_mul_f32 v57, v57, v49
    v_mul_f32 v58, v58, v49
    v_mul_f32 v59, v59, v49
    v_accvgpr_write_b32 a24, v52
    v_accvgpr_write_b32 a25, v53
    v_accvgpr_write_b32 a26, v54
    v_accvgpr_write_b32 a27, v55
    v_accvgpr_write_b32 a28, v56
    v_accvgpr_write_b32 a29, v57
    v_accvgpr_write_b32 a30, v58
    v_accvgpr_write_b32 a31, v59
    v_exp_f32 v52, v96
    v_exp_f32 v53, v97
    v_exp_f32 v54, v98
    v_exp_f32 v55, v99
    v_exp_f32 v56, v100
    v_exp_f32 v57, v101
    v_exp_f32 v58, v102
    v_exp_f32 v59, v103
    s_nop 0
    v_cvt_pk_bf16_f32 v144, v52, v53
    v_cvt_pk_bf16_f32 v145, v54, v55
    v_cvt_pk_bf16_f32 v146, v56, v57
    v_cvt_pk_bf16_f32 v147, v58, v59
    s_nop 1
    v_mfma_f32_16x16x32_bf16 v[28:31], v[44:47], v[144:147], 0
    v_max3_f32 v48, v104, v105, v106
    v_max3_f32 v48, v48, v107, v108
    v_max3_f32 v48, v48, v109, v110
    v_max3_f32 v48, v48, v111, 0
    v_mov_b32 v49, v48
    s_nop 1
    v_permlane32_swap_b32 v48, v49
    s_nop 1
    v_max_f32 v48, v48, v49
    v_mov_b32 v49, v48
    s_nop 1
    v_permlane16_swap_b32 v48, v49
    s_nop 1
    v_max_f32 v48, v48, v49
    v_exp_f32 v49, -v48
    v_sub_f32 v104, v104, v48
    v_sub_f32 v105, v105, v48
    v_sub_f32 v106, v106, v48
    v_sub_f32 v107, v107, v48
    v_sub_f32 v108, v108, v48
    v_sub_f32 v109, v109, v48
    v_sub_f32 v110, v110, v48
    v_sub_f32 v111, v111, v48
    v_sub_f32 v72, v72, v48
    v_sub_f32 v73, v73, v48
    v_sub_f32 v74, v74, v48
    v_sub_f32 v75, v75, v48
    v_sub_f32 v76, v76, v48
    v_sub_f32 v77, v77, v48
    v_sub_f32 v78, v78, v48
    v_sub_f32 v79, v79, v48
    v_sub_f32 v168, v168, v48
    v_sub_f32 v169, v169, v48
    v_sub_f32 v170, v170, v48
    v_sub_f32 v171, v171, v48
    v_sub_f32 v172, v172, v48
    v_sub_f32 v173, v173, v48
    v_sub_f32 v174, v174, v48
    v_sub_f32 v175, v175, v48
    v_mul_f32 v13, v13, v49
    v_accvgpr_read_b32 v52, a32
    v_accvgpr_read_b32 v53, a33
    v_accvgpr_read_b32 v54, a34
    v_accvgpr_read_b32 v55, a35
    v_accvgpr_read_b32 v56, a36
    v_accvgpr_read_b32 v57, a37
    v_accvgpr_read_b32 v58, a38
    v_accvgpr_read_b32 v59, a39
    v_mul_f32 v52, v52, v49
    v_mul_f32 v53, v53, v49
    v_mul_f32 v54, v54, v49
    v_mul_f32 v55, v55, v49
    v_mul_f32 v56, v56, v49
    v_mul_f32 v57, v57, v49
    v_mul_f32 v58, v58, v49
    v_mul_f32 v59, v59, v49
    v_accvgpr_write_b32 a32, v52
    v_accvgpr_write_b32 a33, v53
    v_accvgpr_write_b32 a34, v54
    v_accvgpr_write_b32 a35, v55
    v_accvgpr_write_b32 a36, v56
    v_accvgpr_write_b32 a37, v57
    v_accvgpr_write_b32 a38, v58
    v_accvgpr_write_b32 a39, v59
    v_accvgpr_read_b32 v52, a40
    v_accvgpr_read_b32 v53, a41
    v_accvgpr_read_b32 v54, a42
    v_accvgpr_read_b32 v55, a43
    v_accvgpr_read_b32 v56, a44
    v_accvgpr_read_b32 v57, a45
    v_accvgpr_read_b32 v58, a46
    v_accvgpr_read_b32 v59, a47
    v_mul_f32 v52, v52, v49
    v_mul_f32 v53, v53, v49
    v_mul_f32 v54, v54, v49
    v_mul_f32 v55, v55, v49
    v_mul_f32 v56, v56, v49
    v_mul_f32 v57, v57, v49
    v_mul_f32 v58, v58, v49
    v_mul_f32 v59, v59, v49
    v_accvgpr_write_b32 a40, v52
    v_accvgpr_write_b32 a41, v53
    v_accvgpr_write_b32 a42, v54
    v_accvgpr_write_b32 a43, v55
    v_accvgpr_write_b32 a44, v56
    v_accvgpr_write_b32 a45, v57
    v_accvgpr_write_b32 a46, v58
    v_accvgpr_write_b32 a47, v59
    v_accvgpr_read_b32 v52, a48
    v_accvgpr_read_b32 v53, a49
    v_accvgpr_read_b32 v54, a50
    v_accvgpr_read_b32 v55, a51
    v_accvgpr_read_b32 v56, a52
    v_accvgpr_read_b32 v57, a53
    v_accvgpr_read_b32 v58, a54
    v_accvgpr_read_b32 v59, a55
    v_mul_f32 v52, v52, v49
    v_mul_f32 v53, v53, v49
    v_mul_f32 v54, v54, v49
    v_mul_f32 v55, v55, v49
    v_mul_f32 v56, v56, v49
    v_mul_f32 v57, v57, v49
    v_mul_f32 v58, v58, v49
    v_mul_f32 v59, v59, v49
    v_accvgpr_write_b32 a48, v52
    v_accvgpr_write_b32 a49, v53
    v_accvgpr_write_b32 a50, v54
    v_accvgpr_write_b32 a51, v55
    v_accvgpr_write_b32 a52, v56
    v_accvgpr_write_b32 a53, v57
    v_accvgpr_write_b32 a54, v58
    v_accvgpr_write_b32 a55, v59
    v_accvgpr_read_b32 v52, a56
    v_accvgpr_read_b32 v53, a57
    v_accvgpr_read_b32 v54, a58
    v_accvgpr_read_b32 v55, a59
    v_accvgpr_read_b32 v56, a60
    v_accvgpr_read_b32 v57, a61
    v_accvgpr_read_b32 v58, a62
    v_accvgpr_read_b32 v59, a63
    v_mul_f32 v52, v52, v49
    v_mul_f32 v53, v53, v49
    v_mul_f32 v54, v54, v49
    v_mul_f32 v55, v55, v49
    v_mul_f32 v56, v56, v49
    v_mul_f32 v57, v57, v49
    v_mul_f32 v58, v58, v49
    v_mul_f32 v59, v59, v49
    v_accvgpr_write_b32 a56, v52
    v_accvgpr_write_b32 a57, v53
    v_accvgpr_write_b32 a58, v54
    v_accvgpr_write_b32 a59, v55
    v_accvgpr_write_b32 a60, v56
    v_accvgpr_write_b32 a61, v57
    v_accvgpr_write_b32 a62, v58
    v_accvgpr_write_b32 a63, v59
    v_exp_f32 v52, v104
    v_exp_f32 v53, v105
    v_exp_f32 v54, v106
    v_exp_f32 v55, v107
    v_exp_f32 v56, v108
    v_exp_f32 v57, v109
    v_exp_f32 v58, v110
    v_exp_f32 v59, v111
    s_nop 0
    v_cvt_pk_bf16_f32 v148, v52, v53
    v_cvt_pk_bf16_f32 v149, v54, v55
    v_cvt_pk_bf16_f32 v150, v56, v57
    v_cvt_pk_bf16_f32 v151, v58, v59
    s_nop 1
    v_mfma_f32_16x16x32_bf16 v[32:35], v[44:47], v[148:151], 0
    v_max3_f32 v48, v112, v113, v114
    v_max3_f32 v48, v48, v115, v116
    v_max3_f32 v48, v48, v117, v118
    v_max3_f32 v48, v48, v119, 0
    v_mov_b32 v49, v48
    s_nop 1
    v_permlane32_swap_b32 v48, v49
    s_nop 1
    v_max_f32 v48, v48, v49
    v_mov_b32 v49, v48
    s_nop 1
    v_permlane16_swap_b32 v48, v49
    s_nop 1
    v_max_f32 v48, v48, v49
    v_exp_f32 v49, -v48
    v_sub_f32 v112, v112, v48
    v_sub_f32 v113, v113, v48
    v_sub_f32 v114, v114, v48
    v_sub_f32 v115, v115, v48
    v_sub_f32 v116, v116, v48
    v_sub_f32 v117, v117, v48
    v_sub_f32 v118, v118, v48
    v_sub_f32 v119, v119, v48
    v_sub_f32 v80, v80, v48
    v_sub_f32 v81, v81, v48
    v_sub_f32 v82, v82, v48
    v_sub_f32 v83, v83, v48
    v_sub_f32 v84, v84, v48
    v_sub_f32 v85, v85, v48
    v_sub_f32 v86, v86, v48
    v_sub_f32 v87, v87, v48
    v_sub_f32 v176, v176, v48
    v_sub_f32 v177, v177, v48
    v_sub_f32 v178, v178, v48
    v_sub_f32 v179, v179, v48
    v_sub_f32 v180, v180, v48
    v_sub_f32 v181, v181, v48
    v_sub_f32 v182, v182, v48
    v_sub_f32 v183, v183, v48
    v_mul_f32 v14, v14, v49
    v_accvgpr_read_b32 v52, a64
    v_accvgpr_read_b32 v53, a65
    v_accvgpr_read_b32 v54, a66
    v_accvgpr_read_b32 v55, a67
    v_accvgpr_read_b32 v56, a68
    v_accvgpr_read_b32 v57, a69
    v_accvgpr_read_b32 v58, a70
    v_accvgpr_read_b32 v59, a71
    v_mul_f32 v52, v52, v49
    v_mul_f32 v53, v53, v49
    v_mul_f32 v54, v54, v49
    v_mul_f32 v55, v55, v49
    v_mul_f32 v56, v56, v49
    v_mul_f32 v57, v57, v49
    v_mul_f32 v58, v58, v49
    v_mul_f32 v59, v59, v49
    v_accvgpr_write_b32 a64, v52
    v_accvgpr_write_b32 a65, v53
    v_accvgpr_write_b32 a66, v54
    v_accvgpr_write_b32 a67, v55
    v_accvgpr_write_b32 a68, v56
    v_accvgpr_write_b32 a69, v57
    v_accvgpr_write_b32 a70, v58
    v_accvgpr_write_b32 a71, v59
    v_accvgpr_read_b32 v52, a72
    v_accvgpr_read_b32 v53, a73
    v_accvgpr_read_b32 v54, a74
    v_accvgpr_read_b32 v55, a75
    v_accvgpr_read_b32 v56, a76
    v_accvgpr_read_b32 v57, a77
    v_accvgpr_read_b32 v58, a78
    v_accvgpr_read_b32 v59, a79
    v_mul_f32 v52, v52, v49
    v_mul_f32 v53, v53, v49
    v_mul_f32 v54, v54, v49
    v_mul_f32 v55, v55, v49
    v_mul_f32 v56, v56, v49
    v_mul_f32 v57, v57, v49
    v_mul_f32 v58, v58, v49
    v_mul_f32 v59, v59, v49
    v_accvgpr_write_b32 a72, v52
    v_accvgpr_write_b32 a73, v53
    v_accvgpr_write_b32 a74, v54
    v_accvgpr_write_b32 a75, v55
    v_accvgpr_write_b32 a76, v56
    v_accvgpr_write_b32 a77, v57
    v_accvgpr_write_b32 a78, v58
    v_accvgpr_write_b32 a79, v59
    v_accvgpr_read_b32 v52, a80
    v_accvgpr_read_b32 v53, a81
    v_accvgpr_read_b32 v54, a82
    v_accvgpr_read_b32 v55, a83
    v_accvgpr_read_b32 v56, a84
    v_accvgpr_read_b32 v57, a85
    v_accvgpr_read_b32 v58, a86
    v_accvgpr_read_b32 v59, a87
    v_mul_f32 v52, v52, v49
    v_mul_f32 v53, v53, v49
    v_mul_f32 v54, v54, v49
    v_mul_f32 v55, v55, v49
    v_mul_f32 v56, v56, v49
    v_mul_f32 v57, v57, v49
    v_mul_f32 v58, v58, v49
    v_mul_f32 v59, v59, v49
    v_accvgpr_write_b32 a80, v52
    v_accvgpr_write_b32 a81, v53
    v_accvgpr_write_b32 a82, v54
    v_accvgpr_write_b32 a83, v55
    v_accvgpr_write_b32 a84, v56
    v_accvgpr_write_b32 a85, v57
    v_accvgpr_write_b32 a86, v58
    v_accvgpr_write_b32 a87, v59
    v_accvgpr_read_b32 v52, a88
    v_accvgpr_read_b32 v53, a89
    v_accvgpr_read_b32 v54, a90
    v_accvgpr_read_b32 v55, a91
    v_accvgpr_read_b32 v56, a92
    v_accvgpr_read_b32 v57, a93
    v_accvgpr_read_b32 v58, a94
    v_accvgpr_read_b32 v59, a95
    v_mul_f32 v52, v52, v49
    v_mul_f32 v53, v53, v49
    v_mul_f32 v54, v54, v49
    v_mul_f32 v55, v55, v49
    v_mul_f32 v56, v56, v49
    v_mul_f32 v57, v57, v49
    v_mul_f32 v58, v58, v49
    v_mul_f32 v59, v59, v49
    v_accvgpr_write_b32 a88, v52
    v_accvgpr_write_b32 a89, v53
    v_accvgpr_write_b32 a90, v54
    v_accvgpr_write_b32 a91, v55
    v_accvgpr_write_b32 a92, v56
    v_accvgpr_write_b32 a93, v57
    v_accvgpr_write_b32 a94, v58
    v_accvgpr_write_b32 a95, v59
    v_exp_f32 v52, v112
    v_exp_f32 v53, v113
    v_exp_f32 v54, v114
    v_exp_f32 v55, v115
    v_exp_f32 v56, v116
    v_exp_f32 v57, v117
    v_exp_f32 v58, v118
    v_exp_f32 v59, v119
    s_nop 0
    v_cvt_pk_bf16_f32 v152, v52, v53
    v_cvt_pk_bf16_f32 v153, v54, v55
    v_cvt_pk_bf16_f32 v154, v56, v57
    v_cvt_pk_bf16_f32 v155, v58, v59
    s_nop 1
    v_mfma_f32_16x16x32_bf16 v[36:39], v[44:47], v[152:155], 0
    v_max3_f32 v48, v120, v121, v122
    v_max3_f32 v48, v48, v123, v124
    v_max3_f32 v48, v48, v125, v126
    v_max3_f32 v48, v48, v127, 0
    v_mov_b32 v49, v48
    s_nop 1
    v_permlane32_swap_b32 v48, v49
    s_nop 1
    v_max_f32 v48, v48, v49
    v_mov_b32 v49, v48
    s_nop 1
    v_permlane16_swap_b32 v48, v49
    s_nop 1
    v_max_f32 v48, v48, v49
    v_exp_f32 v49, -v48
    v_sub_f32 v120, v120, v48
    v_sub_f32 v121, v121, v48
    v_sub_f32 v122, v122, v48
    v_sub_f32 v123, v123, v48
    v_sub_f32 v124, v124, v48
    v_sub_f32 v125, v125, v48
    v_sub_f32 v126, v126, v48
    v_sub_f32 v127, v127, v48
    v_sub_f32 v88, v88, v48
    v_sub_f32 v89, v89, v48
    v_sub_f32 v90, v90, v48
    v_sub_f32 v91, v91, v48
    v_sub_f32 v92, v92, v48
    v_sub_f32 v93, v93, v48
    v_sub_f32 v94, v94, v48
    v_sub_f32 v95, v95, v48
    v_sub_f32 v184, v184, v48
    v_sub_f32 v185, v185, v48
    v_sub_f32 v186, v186, v48
    v_sub_f32 v187, v187, v48
    v_sub_f32 v188, v188, v48
    v_sub_f32 v189, v189, v48
    v_sub_f32 v190, v190, v48
    v_sub_f32 v191, v191, v48
    v_mul_f32 v15, v15, v49
    v_accvgpr_read_b32 v52, a96
    v_accvgpr_read_b32 v53, a97
    v_accvgpr_read_b32 v54, a98
    v_accvgpr_read_b32 v55, a99
    v_accvgpr_read_b32 v56, a100
    v_accvgpr_read_b32 v57, a101
    v_accvgpr_read_b32 v58, a102
    v_accvgpr_read_b32 v59, a103
    v_mul_f32 v52, v52, v49
    v_mul_f32 v53, v53, v49
    v_mul_f32 v54, v54, v49
    v_mul_f32 v55, v55, v49
    v_mul_f32 v56, v56, v49
    v_mul_f32 v57, v57, v49
    v_mul_f32 v58, v58, v49
    v_mul_f32 v59, v59, v49
    v_accvgpr_write_b32 a96, v52
    v_accvgpr_write_b32 a97, v53
    v_accvgpr_write_b32 a98, v54
    v_accvgpr_write_b32 a99, v55
    v_accvgpr_write_b32 a100, v56
    v_accvgpr_write_b32 a101, v57
    v_accvgpr_write_b32 a102, v58
    v_accvgpr_write_b32 a103, v59
    v_accvgpr_read_b32 v52, a104
    v_accvgpr_read_b32 v53, a105
    v_accvgpr_read_b32 v54, a106
    v_accvgpr_read_b32 v55, a107
    v_accvgpr_read_b32 v56, a108
    v_accvgpr_read_b32 v57, a109
    v_accvgpr_read_b32 v58, a110
    v_accvgpr_read_b32 v59, a111
    v_mul_f32 v52, v52, v49
    v_mul_f32 v53, v53, v49
    v_mul_f32 v54, v54, v49
    v_mul_f32 v55, v55, v49
    v_mul_f32 v56, v56, v49
    v_mul_f32 v57, v57, v49
    v_mul_f32 v58, v58, v49
    v_mul_f32 v59, v59, v49
    v_accvgpr_write_b32 a104, v52
    v_accvgpr_write_b32 a105, v53
    v_accvgpr_write_b32 a106, v54
    v_accvgpr_write_b32 a107, v55
    v_accvgpr_write_b32 a108, v56
    v_accvgpr_write_b32 a109, v57
    v_accvgpr_write_b32 a110, v58
    v_accvgpr_write_b32 a111, v59
    v_accvgpr_read_b32 v52, a112
    v_accvgpr_read_b32 v53, a113
    v_accvgpr_read_b32 v54, a114
    v_accvgpr_read_b32 v55, a115
    v_accvgpr_read_b32 v56, a116
    v_accvgpr_read_b32 v57, a117
    v_accvgpr_read_b32 v58, a118
    v_accvgpr_read_b32 v59, a119
    v_mul_f32 v52, v52, v49
    v_mul_f32 v53, v53, v49
    v_mul_f32 v54, v54, v49
    v_mul_f32 v55, v55, v49
    v_mul_f32 v56, v56, v49
    v_mul_f32 v57, v57, v49
    v_mul_f32 v58, v58, v49
    v_mul_f32 v59, v59, v49
    v_accvgpr_write_b32 a112, v52
    v_accvgpr_write_b32 a113, v53
    v_accvgpr_write_b32 a114, v54
    v_accvgpr_write_b32 a115, v55
    v_accvgpr_write_b32 a116, v56
    v_accvgpr_write_b32 a117, v57
    v_accvgpr_write_b32 a118, v58
    v_accvgpr_write_b32 a119, v59
    v_accvgpr_read_b32 v52, a120
    v_accvgpr_read_b32 v53, a121
    v_accvgpr_read_b32 v54, a122
    v_accvgpr_read_b32 v55, a123
    v_accvgpr_read_b32 v56, a124
    v_accvgpr_read_b32 v57, a125
    v_accvgpr_read_b32 v58, a126
    v_accvgpr_read_b32 v59, a127
    v_mul_f32 v52, v52, v49
    v_mul_f32 v53, v53, v49
    v_mul_f32 v54, v54, v49
    v_mul_f32 v55, v55, v49
    v_mul_f32 v56, v56, v49
    v_mul_f32 v57, v57, v49
    v_mul_f32 v58, v58, v49
    v_mul_f32 v59, v59, v49
    v_accvgpr_write_b32 a120, v52
    v_accvgpr_write_b32 a121, v53
    v_accvgpr_write_b32 a122, v54
    v_accvgpr_write_b32 a123, v55
    v_accvgpr_write_b32 a124, v56
    v_accvgpr_write_b32 a125, v57
    v_accvgpr_write_b32 a126, v58
    v_accvgpr_write_b32 a127, v59
    v_exp_f32 v52, v120
    v_exp_f32 v53, v121
    v_exp_f32 v54, v122
    v_exp_f32 v55, v123
    v_exp_f32 v56, v124
    v_exp_f32 v57, v125
    v_exp_f32 v58, v126
    v_exp_f32 v59, v127
    s_nop 0
    v_cvt_pk_bf16_f32 v156, v52, v53
    v_cvt_pk_bf16_f32 v157, v54, v55
    v_cvt_pk_bf16_f32 v158, v56, v57
    v_cvt_pk_bf16_f32 v159, v58, v59
    s_nop 1
    v_mfma_f32_16x16x32_bf16 v[40:43], v[44:47], v[156:159], 0
    s_nop 7
    s_setpc_b64 s[74:75]
m_hook18:
    s_cmp_lg_u32 s16, 0
    s_cbranch_scc1 m_np37
    v_mov_b32 v4, s4
    v_mov_b32 v5, s5
    s_add_u32 s90, s17, 117440512
    s_mov_b64 exec, 1
    buffer_store_dwordx2 v[4:5], off, s[8:11], s90 sc1
    s_mov_b64 exec, -1
m_np37:
    s_mov_b32 s17, -1
    s_branch m_hookr19
m_hook23:
    s_cmp_lg_u32 s16, 0
    s_cbranch_scc1 m_np38
    v_mov_b32 v4, s4
    v_mov_b32 v5, s5
    s_add_u32 s90, s17, 117440512
    s_mov_b64 exec, 1
    buffer_store_dwordx2 v[4:5], off, s[8:11], s90 sc1
    s_mov_b64 exec, -1
m_np38:
    s_mov_b32 s17, -1
    s_branch m_hookr24
m_pf7:
    s_mov_b32 s15, 0x20000
    s_sub_u32 s93, s2, 224
    s_lshl_b32 s93, s93, 2
    s_add_u32 s93, s93, s16
    v_lshlrev_b32 v24, 7, v1
    v_lshrrev_b32 v25, 3, v1
    v_lshlrev_b32 v25, 11, v25
    v_and_b32 v26, 7, v1
    v_lshl_add_u32 v25, v26, 7, v25
    s_lshl_b32 s92, s93, 13
    s_lshl_b32 s93, s93, 14
    s_add_u32 s93, s93, 1024
    s_mov_b32 s12, s26
    s_mov_b32 s13, s27
    s_mov_b32 s14, 6291456
    s_add_u32 s90, s92, 0
    buffer_load_dword v22, v24, s[12:15], s90 offen
    s_add_u32 s90, s92, 1048576
    buffer_load_dword v22, v24, s[12:15], s90 offen
    s_mov_b32 s12, s24
    s_mov_b32 s13, s25
    s_mov_b32 s14, 4194304
    s_add_u32 s90, s92, 0
    buffer_load_dword v22, v24, s[12:15], s90 offen
    s_add_u32 s90, s92, 1048576
    buffer_load_dword v22, v24, s[12:15], s90 offen
    s_add_u32 s90, s92, 2097152
    buffer_load_dword v22, v24, s[12:15], s90 offen
    s_add_u32 s90, s92, 3145728
    buffer_load_dword v22, v24, s[12:15], s90 offen
    s_mov_b32 s12, s34
    s_mov_b32 s13, s35
    s_mov_b32 s14, 8388608
    s_add_u32 s90, s92, 4194304
    buffer_load_dword v22, v24, s[12:15], s90 offen
    s_add_u32 s90, s92, 5242880
    buffer_load_dword v22, v24, s[12:15], s90 offen
    s_mov_b32 s12, s30
    s_mov_b32 s13, s31
    s_mov_b32 s14, 4194304
    s_add_u32 s90, s93, 0
    buffer_load_dword v22, v25, s[12:15], s90 offen
    s_add_u32 s90, s93, 2097152
    buffer_load_dword v22, v25, s[12:15], s90 offen
    s_mov_b32 s12, s26
    s_mov_b32 s13, s27
    s_mov_b32 s14, 6291456
    s_add_u32 s90, s92, 2097152
    buffer_load_dword v22, v24, s[12:15], s90 offen
    s_mov_b32 s12, s34
    s_mov_b32 s13, s35
    s_mov_b32 s14, 8388608
    s_add_u32 s90, s92, 6291456
    buffer_load_dword v22, v24, s[12:15], s90 offen
    s_add_u32 s90, s92, 7340032
    buffer_load_dword v22, v24, s[12:15], s90 offen
    s_mov_b32 s12, s26
    s_mov_b32 s13, s27
    s_mov_b32 s14, 6291456
    s_add_u32 s90, s92, 3145728
    buffer_load_dword v22, v24, s[12:15], s90 offen
    s_add_u32 s90, s92, 4194304
    buffer_load_dword v22, v24, s[12:15], s90 offen
    s_add_u32 s90, s92, 5242880
    buffer_load_dword v22, v24, s[12:15], s90 offen
    s_mov_b32 s12, s32
    s_mov_b32 s13, s33
    s_mov_b32 s14, 2097152
    s_add_u32 s90, s92, 1048576
    buffer_load_dword v22, v24, s[12:15], s90 offen
    s_add_u32 s61, s61, 32768
    s_branch m_nopf6
concat_heads__sliding_local_dilated__compressed_kv_cla__prompt_kernel_end:
.section .rodata,"a"
.p2align 6
.amdhsa_kernel concat_heads__sliding_local_dilated__compressed_kv_cla__prompt_kernel
  .amdhsa_next_free_vgpr 512
  .amdhsa_next_free_sgpr 102
  .amdhsa_accum_offset 256
  .amdhsa_group_segment_fixed_size 0
  .amdhsa_kernarg_size 96
  .amdhsa_user_sgpr_count 2
  .amdhsa_user_sgpr_kernarg_segment_ptr 1
  .amdhsa_system_sgpr_workgroup_id_x 1
.end_amdhsa_kernel
```

```asm
; @launch grid=(256,1,1) block=(256,1,1) lds=163840
.amdgcn_target "amdgcn-amd-amdhsa--gfx950"
.text
.globl concat_heads__sliding_local_dilated__compressed_kv_cla__prompt_kernel
.p2align 8
.type concat_heads__sliding_local_dilated__compressed_kv_cla__prompt_kernel,@function
concat_heads__sliding_local_dilated__compressed_kv_cla__prompt_kernel:
    s_cmp_ge_u32 s2, 256
    s_cbranch_scc1 m_end1
    s_load_dwordx16 s[24:39], s[0:1], 0
    s_load_dwordx4 s[4:7], s[0:1], 80
    v_and_b32 v1, 63, v0
    v_lshrrev_b32 v24, 6, v0
    s_nop 0
    v_readfirstlane_b32 s16, v24
    s_lshr_b32 s68, s2, 3
    s_lshr_b32 s57, s16, 1
    s_and_b32 s58, s16, 1
    s_mov_b32 s43, 0x20000
    s_mov_b32 s47, 0x20000
    s_cmp_lt_u32 s68, 28
    s_cbranch_scc1 m_ncp2
    s_sub_u32 s91, s68, 28
    s_lshl_b32 s91, s91, 2
    s_add_u32 s91, s91, s16
    s_getpc_b64 s[8:9]
m_pc3:
    s_sub_u32 s8, s8, m_pc3-concat_heads__sliding_local_dilated__compressed_kv_cla__prompt_kernel
    s_subb_u32 s9, s9, 0
    s_lshl_b32 s90, s91, 13
    v_lshlrev_b32 v24, 7, v1
    v_add_u32 v24, s90, v24
    v_min_u32 v24, concat_heads__sliding_local_dilated__compressed_kv_cla__prompt_kernel_end-concat_heads__sliding_local_dilated__compressed_kv_cla__prompt_kernel-4, v24
    v_mov_b32 v25, s9
    v_add_co_u32 v24, vcc, s8, v24
    s_nop 1
    v_addc_co_u32 v25, vcc, 0, v25, vcc
    global_load_dword v22, v[24:25], off
m_ncp2:
    s_lshl_b32 s61, s16, 13
    s_add_u32 s62, s61, 98304
    s_cmp_ge_u32 s68, 16
    s_cbranch_scc1 m_typea4
    s_and_b32 s69, s68, 3
    s_and_b32 s90, s2, 1
    s_lshl_b32 s90, s90, 2
    s_add_u32 s69, s69, s90
    s_bfe_u32 s90, s2, 0x20001
    s_mul_i32 s90, s90, 4
    s_bfe_u32 s91, s68, 0x20002
    s_add_u32 s90, s90, s91
    s_mov_b32 s76, 8388608
    s_mov_b32 s78, 8192
    s_mov_b32 s81, 0
    s_mov_b32 s73, 4194304
    s_mov_b32 s77, 2048
    s_mov_b32 s82, 16
    s_lshl_b32 s80, s90, 9
    s_lshl_b32 s79, s69, 19
    s_lshl_b32 s88, s90, 4
    s_add_u32 s88, s88, s69
    s_lshl_b32 s88, s88, 3
    s_mov_b32 s83, 0
    s_mov_b32 s84, 1040356334
    s_lshl_b32 s91, s90, 1
    s_add_u32 s91, s91, s58
    s_lshl_b32 s91, s91, 19
    s_lshl_b32 s92, s69, 1
    s_add_u32 s92, s92, s57
    s_lshl_b32 s92, s92, 15
    s_add_u32 s85, s91, s92
    s_add_u32 s85, s85, 0
    s_mov_b32 s86, 1024
    s_mov_b32 s87, 4096
    s_branch m_go15
m_typea4:
    s_bfe_u32 s69, s68, 0x20002
    s_add_u32 s69, s69, 0
    s_and_b32 s90, s2, 7
    s_lshl_b32 s90, s90, 2
    s_and_b32 s91, s68, 3
    s_add_u32 s90, s90, s91
    s_cmp_lt_u32 s90, 16
    s_cselect_b32 s83, 0, 1
    s_mov_b32 s91, 33554432
    s_cselect_b32 s85, 16777216, s91
    s_mov_b32 s91, 8192
    s_cselect_b32 s86, 1024, s91
    s_mov_b32 s91, 1024
    s_cselect_b32 s87, 4096, s91
    s_mov_b32 s73, 2097152
    s_mov_b32 s77, 1024
    s_mov_b32 s82, 8
    s_mov_b32 s81, 0
    s_mov_b32 s76, 4194304
    s_mov_b32 s78, 8192
    s_mov_b32 s84, 0
    s_and_b32 s90, s90, 15
    s_lshl_b32 s80, s90, 9
    s_lshl_b32 s79, s69, 18
    s_lshl_b32 s91, s83, 2
    s_add_u32 s91, s91, s69
    s_cmp_ge_u32 s69, 4
    s_cselect_b32 s92, 508, 8
    s_add_u32 s91, s91, s92
    s_lshl_b32 s88, s90, 4
    s_add_u32 s88, s88, s91
    s_lshl_b32 s88, s88, 3
    s_lshl_b32 s91, s90, 1
    s_add_u32 s91, s91, s58
    s_lshl_b32 s91, s91, 19
    s_lshl_b32 s92, s69, 1
    s_add_u32 s92, s92, s57
    s_lshl_b32 s92, s92, 15
    s_add_u32 s85, s85, s91
    s_add_u32 s85, s85, s92
m_go15:
    s_mov_b32 s42, s73
    s_lshl_b32 s90, s77, 4
    s_lshl_b32 s90, s90, s81
    s_mov_b32 s48, s79
    s_mul_i32 s91, s90, 1
    s_add_u32 s49, s91, s79
    s_sub_u32 s49, s49, 2048
    s_mul_i32 s91, s90, 2
    s_add_u32 s50, s91, s79
    s_mul_i32 s91, s90, 3
    s_add_u32 s51, s91, s79
    s_sub_u32 s51, s51, 2048
    s_lshl_b32 s90, s58, 7
    s_add_u32 s90, s90, s57
    s_lshl_b32 s91, s16, 6
    s_cmp_eq_u32 s81, 1
    s_cselect_b32 s90, s90, s91
    v_lshrrev_b32 v24, 3, v1
    v_lshlrev_b32 v24, s81, v24
    v_add_u32 v24, s90, v24
    v_mul_lo_u32 v24, v24, s77
    v_lshrrev_b32 v25, 4, v1
    v_and_b32 v26, 7, v1
    v_xor_b32 v25, v25, v26
    v_lshl_add_u32 v16, v25, 4, v24
    v_xor_b32 v25, 4, v25
    v_lshl_add_u32 v17, v25, 4, v24
    s_lshl_b32 s90, s77, 3
    s_lshl_b32 s90, s90, s81
    s_sub_u32 s90, s90, 1024
    v_add_u32 v17, s90, v17
    s_mov_b32 s46, s76
    s_mov_b32 s52, s80
    s_lshl_b32 s90, s78, 2
    s_mul_i32 s91, s90, 1
    s_add_u32 s53, s91, s80
    s_sub_u32 s53, s53, 2048
    s_mul_i32 s91, s90, 2
    s_add_u32 s54, s91, s80
    s_mul_i32 s91, s90, 3
    s_add_u32 s55, s91, s80
    s_sub_u32 s55, s55, 2048
    s_lshl_b32 s56, s78, 6
    v_lshrrev_b32 v24, 5, v1
    s_lshl_b32 s90, s16, 4
    v_add_u32 v25, s90, v24
    v_mul_lo_u32 v25, v25, s78
    v_lshlrev_b32 v24, 1, v24
    v_and_b32 v26, 31, v1
    v_xor_b32 v24, v24, v26
    s_lshl_b32 s90, s78, 1
    s_sub_u32 s90, s90, 1024
    v_add_u32 v27, s90, v25
    v_xor_b32 v26, 0, v24
    v_lshl_add_u32 v18, v26, 4, v25
    v_xor_b32 v26, 4, v24
    v_lshl_add_u32 v19, v26, 4, v27
    v_xor_b32 v26, 8, v24
    v_lshl_add_u32 v20, v26, 4, v25
    v_xor_b32 v26, 12, v24
    v_lshl_add_u32 v21, v26, 4, v27
    s_cmp_eq_u32 s83, 0
    s_waitcnt lgkmcnt(0)
    s_cselect_b32 s44, s36, s38
    s_cselect_b32 s45, s37, s39
    s_cmp_lt_u32 s68, 16
    s_cselect_b32 s44, s34, s44
    s_cselect_b32 s45, s35, s45
    s_cselect_b32 s40, s30, s32
    s_cselect_b32 s41, s31, s33
    s_cmp_ge_u32 s68, 28
    s_cselect_b32 s70, 1, 0
    s_cbranch_scc1 m_pf7
m_nopf6:
    s_add_u32 m0, s61, 0
    s_nop 0
    buffer_load_dwordx4 v16, s[40:43], s48 offen offset:0 sc1 lds
    buffer_load_dwordx4 v17, s[40:43], s48 offen offset:1024 sc1 lds
    s_add_u32 s48, s48, 128
    buffer_load_dwordx4 v16, s[40:43], s49 offen offset:2048 sc1 lds
    buffer_load_dwordx4 v17, s[40:43], s49 offen offset:3072 sc1 lds
    s_add_u32 s49, s49, 128
    s_add_u32 m0, s61, 4096
    s_nop 0
    buffer_load_dwordx4 v16, s[40:43], s50 offen offset:0 sc1 lds
    buffer_load_dwordx4 v17, s[40:43], s50 offen offset:1024 sc1 lds
    s_add_u32 s50, s50, 128
    buffer_load_dwordx4 v16, s[40:43], s51 offen offset:2048 sc1 lds
    buffer_load_dwordx4 v17, s[40:43], s51 offen offset:3072 sc1 lds
    s_add_u32 s51, s51, 128
    s_add_u32 s61, s61, 32768
    s_cmp_ge_u32 s61, 98304
    s_cselect_b32 s90, 98304, 0
    s_sub_u32 s61, s61, s90
    s_add_u32 m0, s62, 0
    s_nop 0
    buffer_load_dwordx4 v18, s[44:47], s52 offen offset:0 sc1 lds
    buffer_load_dwordx4 v19, s[44:47], s52 offen offset:1024 sc1 lds
    s_add_u32 s52, s52, s56
    buffer_load_dwordx4 v18, s[44:47], s53 offen offset:2048 sc1 lds
    buffer_load_dwordx4 v19, s[44:47], s53 offen offset:3072 sc1 lds
    s_add_u32 s53, s53, s56
    s_add_u32 m0, s62, 4096
    s_nop 0
    buffer_load_dwordx4 v20, s[44:47], s54 offen offset:0 sc1 lds
    buffer_load_dwordx4 v21, s[44:47], s54 offen offset:1024 sc1 lds
    s_add_u32 s54, s54, s56
    buffer_load_dwordx4 v20, s[44:47], s55 offen offset:2048 sc1 lds
    buffer_load_dwordx4 v21, s[44:47], s55 offen offset:3072 sc1 lds
    s_add_u32 s55, s55, s56
    s_xor_b32 s62, s62, 229376
    s_mov_b32 s95, s82
    s_mov_b32 s96, s83
    s_mov_b32 s97, s84
    s_mov_b32 s98, s85
    s_mov_b32 s99, s86
    s_mov_b32 s100, s87
    s_mov_b32 s101, s88
    v_and_b32 v24, 15, v1
    v_lshrrev_b32 v25, 4, v1
    v_bfe_u32 v26, v1, 1, 3
    v_xor_b32 v26, v26, v25
    s_lshl_b32 s90, s57, 14
    v_lshlrev_b32 v27, 7, v24
    v_add_u32 v27, s90, v27
    v_xor_b32 v28, 0, v26
    v_lshl_add_u32 v6, v28, 4, v27
    v_xor_b32 v28, 4, v26
    v_lshl_add_u32 v7, v28, 4, v27
    v_bfe_u32 v26, v1, 2, 2
    v_lshl_add_u32 v27, v25, 3, v26
    v_lshlrev_b32 v27, 9, v27
    v_and_b32 v28, 3, v1
    v_lshlrev_b32 v28, 3, v28
    v_add_u32 v27, v27, v28
    s_lshl_b32 s90, s58, 8
    s_add_u32 s90, s90, 98304
    v_add_u32 v27, s90, v27
    v_bfe_u32 v26, v1, 2, 3
    v_xor_b32 v28, 0, v26
    v_lshl_add_u32 v8, v28, 5, v27
    v_xor_b32 v28, 1, v26
    v_lshl_add_u32 v9, v28, 5, v27
    v_xor_b32 v28, 2, v26
    v_lshl_add_u32 v10, v28, 5, v27
    v_xor_b32 v28, 3, v26
    v_lshl_add_u32 v11, v28, 5, v27
    v_xor_b32 v28, 4, v26
    v_lshl_add_u32 v12, v28, 5, v27
    v_xor_b32 v28, 5, v26
    v_lshl_add_u32 v13, v28, 5, v27
    v_xor_b32 v28, 6, v26
    v_lshl_add_u32 v14, v28, 5, v27
    v_xor_b32 v28, 7, v26
    v_lshl_add_u32 v15, v28, 5, v27
    v_lshlrev_b32 v2, 4, v1
    s_mov_b32 s64, 0
    s_mov_b32 s59, 32768
    s_mov_b32 s60, 229376
    s_mov_b32 s8, s6
    s_mov_b32 s9, s7
    s_mov_b32 s10, 268435456
    s_mov_b32 s11, 0x20000
    s_cmp_ge_u32 s68, 16
    s_cbranch_scc1 m_typea8
    s_bfe_u32 s69, s68, 0x20002
    s_add_u32 s69, s69, 4
    s_and_b32 s90, s2, 7
    s_lshl_b32 s90, s90, 2
    s_and_b32 s91, s68, 3
    s_add_u32 s90, s90, s91
    s_cmp_lt_u32 s90, 16
    s_cselect_b32 s83, 0, 1
    s_mov_b32 s91, 33554432
    s_cselect_b32 s85, 16777216, s91
    s_mov_b32 s91, 8192
    s_cselect_b32 s86, 1024, s91
    s_mov_b32 s91, 1024
    s_cselect_b32 s87, 4096, s91
    s_cselect_b32 s74, s36, s38
    s_cselect_b32 s75, s37, s39
    s_mov_b32 s71, s32
    s_mov_b32 s72, s33
    s_mov_b32 s73, 2097152
    s_mov_b32 s77, 1024
    s_mov_b32 s82, 8
    s_mov_b32 s81, 0
    s_mov_b32 s76, 4194304
    s_mov_b32 s78, 8192
    s_mov_b32 s84, 0
    s_and_b32 s90, s90, 15
    s_lshl_b32 s80, s90, 9
    s_lshl_b32 s79, s69, 18
    s_lshl_b32 s91, s83, 2
    s_add_u32 s91, s91, s69
    s_cmp_ge_u32 s69, 4
    s_cselect_b32 s92, 508, 8
    s_add_u32 s91, s91, s92
    s_lshl_b32 s88, s90, 4
    s_add_u32 s88, s88, s91
    s_lshl_b32 s88, s88, 3
    s_lshl_b32 s91, s90, 1
    s_add_u32 s91, s91, s58
    s_lshl_b32 s91, s91, 19
    s_lshl_b32 s92, s69, 1
    s_add_u32 s92, s92, s57
    s_lshl_b32 s92, s92, 15
    s_add_u32 s85, s85, s91
    s_add_u32 s85, s85, s92
    s_branch m_go29
m_typea8:
    s_and_b32 s69, s68, 3
    s_and_b32 s90, s2, 1
    s_lshl_b32 s90, s90, 2
    s_add_u32 s69, s69, s90
    s_bfe_u32 s90, s2, 0x20001
    s_mul_i32 s90, s90, 3
    s_bfe_u32 s91, s68, 0x20002
    s_add_u32 s90, s90, s91
    s_mov_b32 s76, 6291456
    s_mov_b32 s78, 6144
    s_mov_b32 s81, 1
    s_mov_b32 s73, 4194304
    s_mov_b32 s77, 2048
    s_mov_b32 s82, 16
    s_lshl_b32 s80, s90, 9
    s_lshl_b32 s79, s69, 19
    s_and_b32 s92, s90, 3
    s_lshr_b32 s91, s90, 2
    s_lshl_b32 s88, s92, 2
    s_add_u32 s88, s88, s91
    s_lshl_b32 s88, s88, 3
    s_add_u32 s88, s88, s69
    s_lshl_b32 s88, s88, 3
    s_add_u32 s88, s88, 6144
    s_cmp_eq_u32 s91, 0
    s_cselect_b32 s84, 1048744942, 0
    s_lshl_b32 s93, s91, 22
    s_add_u32 s85, s93, 50331648
    s_lshl_b32 s92, s92, 1
    s_add_u32 s92, s92, s58
    s_lshl_b32 s92, s92, 19
    s_add_u32 s85, s85, s92
    s_lshl_b32 s92, s57, 3
    s_add_u32 s92, s92, s69
    s_cmp_eq_u32 s91, 2
    s_cselect_b32 s83, 1, 0
    s_cselect_b32 s93, 12, 13
    s_mov_b32 s91, 131072
    s_cselect_b32 s86, 1024, s91
    s_mov_b32 s91, 1024
    s_cselect_b32 s87, 65536, s91
    s_lshl_b32 s92, s92, s93
    s_add_u32 s85, s85, s92
    s_mov_b32 s71, s24
    s_mov_b32 s72, s25
    s_mov_b32 s74, s26
    s_mov_b32 s75, s27
m_go29:
    s_and_b32 s92, s2, 7
    s_lshl_b32 s92, s92, 2
    s_bfe_u32 s93, s2, 0x20003
    s_add_u32 s92, s92, s93
    s_lshr_b32 s93, s2, 5
    s_lshl_b32 s93, s93, 2
    s_or_b32 s93, s93, 0x40000
    s_lshr_b32 s37, s92, 1
    s_lshl_b32 s37, s37, 7
    s_add_u32 s37, s37, 117440512
    s_lshl_b32 s92, s92, 19
    s_lshl_b32 s91, s58, 13
    s_add_u32 s90, s92, s91
    s_cmp_eq_u32 s57, 0
    s_mov_b32 s91, 33538048
    s_cselect_b32 s91, 16777216, s91
    s_add_u32 s32, s90, s91
    s_bfe_u32 s90, 4225674377, s93
    s_lshl_b32 s90, s90, 3
    s_lshl_b32 s91, s16, 1
    s_add_u32 s90, s90, s91
    s_lshl_b32 s90, s90, 12
    s_add_u32 s90, s90, s92
    s_add_u32 s33, s90, 0
    s_add_u32 s34, s90, 4096
    s_bfe_u32 s90, 873484918, s93
    s_lshl_b32 s90, s90, 3
    s_lshl_b32 s91, s16, 1
    s_add_u32 s90, s90, s91
    s_lshl_b32 s90, s90, 12
    s_add_u32 s90, s90, s92
    s_add_u32 s35, s90, 0
    s_add_u32 s36, s90, 4096
    s_bfe_u32 s91, 873484918, s93
    s_lshr_b32 s91, s91, 1
    v_mov_b32 v0, s91
    v_and_b32 v24, 3, v1
    v_min_u32 v24, 2, v24
    v_and_b32 v25, 4, v1
    v_add3_u32 v24, v24, v25, 8
    v_cmp_gt_u32 vcc, 8, v1
    s_nop 1
    v_cndmask_b32 v0, v0, v24, vcc
    s_bfe_u32 s91, 4225674377, s93
    s_lshr_b32 s91, s91, 1
    v_writelane_b32 v0, s91, 8
    v_lshlrev_b32 v0, 3, v0
    s_xor_b32 s94, s70, 1
    s_add_u32 s67, s70, 3
    s_mov_b32 s17, -1
    s_mul_i32 s64, s70, 32768
    v_add_u32 v6, s64, v6
    v_add_u32 v7, s64, v7
    s_mov_b32 s12, s4
    s_mov_b32 s13, s5
    s_mov_b32 s14, 256
    s_mov_b32 s15, 0x20000
    s_lshl_b32 s90, s2, 2
    s_add_u32 s90, s90, s16
    s_cmp_lg_u32 s90, 0
    s_cbranch_scc1 m_tok10
    s_memrealtime s[92:93]
    s_waitcnt lgkmcnt(0)
    s_or_b32 s92, s92, 1
    v_mov_b32 v4, s92
    v_mov_b32 v5, s93
    s_mov_b64 exec, 1
    buffer_store_dwordx2 v[4:5], off, s[12:15], 0 sc1
    s_mov_b64 exec, -1
m_tok10:
    s_cmp_eq_u32 s70, 0
    s_cbranch_scc1 m_tok11
    buffer_load_dwordx2 v[4:5], off, s[12:15], 0 sc1
    s_waitcnt vmcnt(0)
    s_mov_b32 s3, 262144
m_spin12:
    v_readfirstlane_b32 s4, v4
    v_readfirstlane_b32 s5, v5
    s_nop 3
    s_cmp_lg_u32 s4, 0
    s_cbranch_scc1 m_ok13
    s_sub_u32 s3, s3, 1
    s_cbranch_scc1 m_ok13
    s_sleep 32
    buffer_load_dwordx2 v[4:5], off, s[12:15], 0 sc1
    s_waitcnt vmcnt(0)
    s_branch m_spin12
m_ok13:
m_tok11:
    s_add_u32 m0, s61, 0
    s_nop 0
    buffer_load_dwordx4 v16, s[40:43], s48 offen offset:0 sc1 lds
    buffer_load_dwordx4 v17, s[40:43], s48 offen offset:1024 sc1 lds
    s_add_u32 s48, s48, 128
    buffer_load_dwordx4 v16, s[40:43], s49 offen offset:2048 sc1 lds
    buffer_load_dwordx4 v17, s[40:43], s49 offen offset:3072 sc1 lds
    s_add_u32 s49, s49, 128
    s_add_u32 m0, s61, 4096
    s_nop 0
    buffer_load_dwordx4 v16, s[40:43], s50 offen offset:0 sc1 lds
    buffer_load_dwordx4 v17, s[40:43], s50 offen offset:1024 sc1 lds
    s_add_u32 s50, s50, 128
    buffer_load_dwordx4 v16, s[40:43], s51 offen offset:2048 sc1 lds
    buffer_load_dwordx4 v17, s[40:43], s51 offen offset:3072 sc1 lds
    s_add_u32 s51, s51, 128
    s_add_u32 s61, s61, 32768
    s_cmp_ge_u32 s61, 98304
    s_cselect_b32 s90, 98304, 0
    s_sub_u32 s61, s61, s90
    s_add_u32 m0, s62, 0
    s_nop 0
    buffer_load_dwordx4 v18, s[44:47], s52 offen offset:0 sc1 lds
    buffer_load_dwordx4 v19, s[44:47], s52 offen offset:1024 sc1 lds
    s_add_u32 s52, s52, s56
    buffer_load_dwordx4 v18, s[44:47], s53 offen offset:2048 sc1 lds
    buffer_load_dwordx4 v19, s[44:47], s53 offen offset:3072 sc1 lds
    s_add_u32 s53, s53, s56
    s_add_u32 m0, s62, 4096
    s_nop 0
    buffer_load_dwordx4 v20, s[44:47], s54 offen offset:0 sc1 lds
    buffer_load_dwordx4 v21, s[44:47], s54 offen offset:1024 sc1 lds
    s_add_u32 s54, s54, s56
    buffer_load_dwordx4 v20, s[44:47], s55 offen offset:2048 sc1 lds
    buffer_load_dwordx4 v21, s[44:47], s55 offen offset:3072 sc1 lds
    s_add_u32 s55, s55, s56
    s_xor_b32 s62, s62, 229376
    s_waitcnt vmcnt(16)
    s_barrier
    ds_read_b64_tr_b16 a[64:65], v8 offset:0
    ds_read_b64_tr_b16 a[66:67], v8 offset:2048
    ds_read_b64_tr_b16 a[68:69], v8 offset:16384
    ds_read_b64_tr_b16 a[70:71], v8 offset:18432
    ds_read_b64_tr_b16 a[72:73], v9 offset:0
    ds_read_b64_tr_b16 a[74:75], v9 offset:2048
    ds_read_b64_tr_b16 a[76:77], v9 offset:16384
    ds_read_b64_tr_b16 a[78:79], v9 offset:18432
    ds_read_b64_tr_b16 a[80:81], v10 offset:0
    ds_read_b64_tr_b16 a[82:83], v10 offset:2048
    ds_read_b64_tr_b16 a[84:85], v10 offset:16384
    ds_read_b64_tr_b16 a[86:87], v10 offset:18432
    ds_read_b64_tr_b16 a[88:89], v11 offset:0
    ds_read_b64_tr_b16 a[90:91], v11 offset:2048
    ds_read_b64_tr_b16 a[92:93], v11 offset:16384
    ds_read_b64_tr_b16 a[94:95], v11 offset:18432
    ds_read_b64_tr_b16 a[96:97], v12 offset:0
    ds_read_b128 a[0:3], v6 offset:0
    ds_read_b128 a[4:7], v7 offset:0
    ds_read_b64_tr_b16 a[98:99], v12 offset:2048
    ds_read_b128 a[8:11], v6 offset:2048
    ds_read_b128 a[12:15], v7 offset:2048
    ds_read_b64_tr_b16 a[100:101], v12 offset:16384
    ds_read_b128 a[16:19], v6 offset:4096
    ds_read_b128 a[20:23], v7 offset:4096
    ds_read_b64_tr_b16 a[102:103], v12 offset:18432
    ds_read_b128 a[24:27], v6 offset:6144
    ds_read_b128 a[28:31], v7 offset:6144
    ds_read_b64_tr_b16 a[104:105], v13 offset:0
    ds_read_b128 a[32:35], v6 offset:8192
    ds_read_b128 a[36:39], v7 offset:8192
    ds_read_b64_tr_b16 a[106:107], v13 offset:2048
    ds_read_b128 a[40:43], v6 offset:10240
    ds_read_b128 a[44:47], v7 offset:10240
    ds_read_b64_tr_b16 a[108:109], v13 offset:16384
    ds_read_b128 a[48:51], v6 offset:12288
    ds_read_b128 a[52:55], v7 offset:12288
    ds_read_b64_tr_b16 a[110:111], v13 offset:18432
    ds_read_b128 a[56:59], v6 offset:14336
    ds_read_b128 a[60:63], v7 offset:14336
    s_add_u32 m0, s61, 0
    s_nop 0
    buffer_load_dwordx4 v16, s[40:43], s48 offen offset:0 sc1 lds
    buffer_load_dwordx4 v17, s[40:43], s48 offen offset:1024 sc1 lds
    s_add_u32 s48, s48, 128
    buffer_load_dwordx4 v16, s[40:43], s49 offen offset:2048 sc1 lds
    buffer_load_dwordx4 v17, s[40:43], s49 offen offset:3072 sc1 lds
    s_add_u32 s49, s49, 128
    s_add_u32 m0, s61, 4096
    s_nop 0
    buffer_load_dwordx4 v16, s[40:43], s50 offen offset:0 sc1 lds
    buffer_load_dwordx4 v17, s[40:43], s50 offen offset:1024 sc1 lds
    s_add_u32 s50, s50, 128
    buffer_load_dwordx4 v16, s[40:43], s51 offen offset:2048 sc1 lds
    buffer_load_dwordx4 v17, s[40:43], s51 offen offset:3072 sc1 lds
    s_add_u32 s51, s51, 128
    s_add_u32 s61, s61, 32768
    s_cmp_ge_u32 s61, 98304
    s_cselect_b32 s90, 98304, 0
    s_sub_u32 s61, s61, s90
    s_mov_b32 s66, 1
    s_mov_b32 s24, s6
    s_mov_b32 s25, s7
    s_mov_b32 s26, 0
    s_mov_b32 s27, 0x20000
    s_mov_b32 s28, 0
    s_mov_b32 s29, 0
    s_mov_b32 s30, 0
    s_mov_b32 s31, 0
m_tile14:
    s_mov_b32 s65, s95
    s_cmp_eq_u32 s96, 1
    s_cbranch_scc1 m_swp16
    s_waitcnt lgkmcnt(15)
    v_mfma_f32_16x16x32_bf16 v[32:35], a[64:67], a[0:3], 0
    ds_read_b64_tr_b16 a[112:113], v14 offset:0
    v_mfma_f32_16x16x32_bf16 v[32:35], a[68:71], a[4:7], v[32:35]
    ds_read_b64_tr_b16 a[114:115], v14 offset:2048
    v_mfma_f32_16x16x32_bf16 v[36:39], a[76:79], a[4:7], 0
    ds_read_b64_tr_b16 a[116:117], v14 offset:16384
    v_mfma_f32_16x16x32_bf16 v[36:39], a[72:75], a[0:3], v[36:39]
    ds_read_b64_tr_b16 a[118:119], v14 offset:18432
    v_mfma_f32_16x16x32_bf16 v[44:47], a[72:75], a[8:11], 0
    ds_read_b64_tr_b16 a[120:121], v15 offset:0
    v_mfma_f32_16x16x32_bf16 v[44:47], a[76:79], a[12:15], v[44:47]
    ds_read_b64_tr_b16 a[122:123], v15 offset:2048
    v_mfma_f32_16x16x32_bf16 v[40:43], a[68:71], a[12:15], 0
    ds_read_b64_tr_b16 a[124:125], v15 offset:16384
    v_mfma_f32_16x16x32_bf16 v[40:43], a[64:67], a[8:11], v[40:43]
    ds_read_b64_tr_b16 a[126:127], v15 offset:18432
    v_mfma_f32_16x16x32_bf16 v[48:51], a[64:67], a[16:19], 0
    v_mfma_f32_16x16x32_bf16 v[48:51], a[68:71], a[20:23], v[48:51]
    v_mfma_f32_16x16x32_bf16 v[52:55], a[76:79], a[20:23], 0
    buffer_store_dwordx4 a[128:131], v2, s[24:27], s28 offen sc1
    v_mfma_f32_16x16x32_bf16 v[52:55], a[72:75], a[16:19], v[52:55]
    s_add_u32 s28, s28, s31
    s_waitcnt lgkmcnt(15)
    v_mfma_f32_16x16x32_bf16 v[60:63], a[72:75], a[24:27], 0
    v_xor_b32 v8, s60, v8
    v_xor_b32 v9, s60, v9
    v_mfma_f32_16x16x32_bf16 v[60:63], a[76:79], a[28:31], v[60:63]
    v_xor_b32 v10, s60, v10
    v_xor_b32 v11, s60, v11
    v_mfma_f32_16x16x32_bf16 v[56:59], a[68:71], a[28:31], 0
    v_xor_b32 v12, s60, v12
    v_xor_b32 v13, s60, v13
    v_mfma_f32_16x16x32_bf16 v[56:59], a[64:67], a[24:27], v[56:59]
    v_xor_b32 v14, s60, v14
    v_xor_b32 v15, s60, v15
    v_mfma_f32_16x16x32_bf16 v[64:67], a[64:67], a[32:35], 0
    buffer_store_dwordx4 a[132:135], v2, s[24:27], s28 offen sc1
    v_mfma_f32_16x16x32_bf16 v[64:67], a[68:71], a[36:39], v[64:67]
    s_add_u32 s28, s28, s31
    v_mfma_f32_16x16x32_bf16 v[68:71], a[76:79], a[36:39], 0
    v_mfma_f32_16x16x32_bf16 v[68:71], a[72:75], a[32:35], v[68:71]
    s_waitcnt lgkmcnt(14)
    v_mfma_f32_16x16x32_bf16 v[76:79], a[72:75], a[40:43], 0
    v_mfma_f32_16x16x32_bf16 v[76:79], a[76:79], a[44:47], v[76:79]
    v_mfma_f32_16x16x32_bf16 v[72:75], a[68:71], a[44:47], 0
    buffer_store_dwordx4 a[136:139], v2, s[24:27], s28 offen sc1
    v_mfma_f32_16x16x32_bf16 v[72:75], a[64:67], a[40:43], v[72:75]
    s_add_u32 s28, s28, s31
    s_waitcnt lgkmcnt(11)
    v_mfma_f32_16x16x32_bf16 v[80:83], a[64:67], a[48:51], 0
    v_mfma_f32_16x16x32_bf16 v[80:83], a[68:71], a[52:55], v[80:83]
    v_mfma_f32_16x16x32_bf16 v[84:87], a[76:79], a[52:55], 0
    v_mfma_f32_16x16x32_bf16 v[84:87], a[72:75], a[48:51], v[84:87]
    s_waitcnt lgkmcnt(8)
    v_mfma_f32_16x16x32_bf16 v[92:95], a[72:75], a[56:59], 0
    buffer_store_dwordx4 a[140:143], v2, s[24:27], s28 offen sc1
    v_mfma_f32_16x16x32_bf16 v[92:95], a[76:79], a[60:63], v[92:95]
    s_add_u32 s28, s28, s31
    v_mfma_f32_16x16x32_bf16 v[88:91], a[68:71], a[60:63], 0
    s_waitcnt vmcnt(44) lgkmcnt(0)
    s_cmp_eq_u32 s66, 2
    s_cbranch_scc1 m_w17
    s_waitcnt vmcnt(12)
m_w17:
    v_mfma_f32_16x16x32_bf16 v[88:91], a[64:67], a[56:59], v[88:91]
    s_barrier
    v_mfma_f32_16x16x32_bf16 v[96:99], a[80:83], a[0:3], 0
    ds_read_b64_tr_b16 a[64:65], v8 offset:0
    v_mfma_f32_16x16x32_bf16 v[96:99], a[84:87], a[4:7], v[96:99]
    s_add_u32 m0, s62, 0
    v_mfma_f32_16x16x32_bf16 v[100:103], a[92:95], a[4:7], 0
    buffer_load_dwordx4 v18, s[44:47], s52 offen offset:0 sc1 lds
    v_mfma_f32_16x16x32_bf16 v[100:103], a[88:91], a[0:3], v[100:103]
    ds_read_b64_tr_b16 a[66:67], v8 offset:2048
    v_mfma_f32_16x16x32_bf16 v[108:111], a[88:91], a[8:11], 0
    s_add_u32 s64, s64, 32768
    v_mfma_f32_16x16x32_bf16 v[108:111], a[92:95], a[12:15], v[108:111]
    s_cmp_ge_u32 s64, 98304
    s_cselect_b32 s63, 4294901760, s59
    s_cselect_b32 s64, 0, s64
    v_mfma_f32_16x16x32_bf16 v[104:107], a[84:87], a[12:15], 0
    buffer_load_dwordx4 v19, s[44:47], s52 offen offset:1024 sc1 lds
    v_mfma_f32_16x16x32_bf16 v[104:107], a[80:83], a[8:11], v[104:107]
    s_add_u32 s52, s52, s56
    ds_read_b64_tr_b16 a[68:69], v8 offset:16384
    v_mfma_f32_16x16x32_bf16 v[112:115], a[80:83], a[16:19], 0
    v_mfma_f32_16x16x32_bf16 v[112:115], a[84:87], a[20:23], v[112:115]
    v_mfma_f32_16x16x32_bf16 v[116:119], a[92:95], a[20:23], 0
    buffer_load_dwordx4 v18, s[44:47], s53 offen offset:2048 sc1 lds
    v_mfma_f32_16x16x32_bf16 v[116:119], a[88:91], a[16:19], v[116:119]
    ds_read_b64_tr_b16 a[70:71], v8 offset:18432
    v_mfma_f32_16x16x32_bf16 v[124:127], a[88:91], a[24:27], 0
    v_mfma_f32_16x16x32_bf16 v[124:127], a[92:95], a[28:31], v[124:127]
    v_mfma_f32_16x16x32_bf16 v[120:123], a[84:87], a[28:31], 0
    buffer_load_dwordx4 v19, s[44:47], s53 offen offset:3072 sc1 lds
    v_mfma_f32_16x16x32_bf16 v[120:123], a[80:83], a[24:27], v[120:123]
    s_add_u32 s53, s53, s56
    ds_read_b64_tr_b16 a[72:73], v9 offset:0
    v_mfma_f32_16x16x32_bf16 v[128:131], a[80:83], a[32:35], 0
    v_mfma_f32_16x16x32_bf16 v[128:131], a[84:87], a[36:39], v[128:131]
    s_add_u32 m0, s62, 4096
    v_mfma_f32_16x16x32_bf16 v[132:135], a[92:95], a[36:39], 0
    buffer_load_dwordx4 v20, s[44:47], s54 offen offset:0 sc1 lds
    v_mfma_f32_16x16x32_bf16 v[132:135], a[88:91], a[32:35], v[132:135]
    s_xor_b32 s62, s62, 229376
    ds_read_b64_tr_b16 a[74:75], v9 offset:2048
    v_mfma_f32_16x16x32_bf16 v[140:143], a[88:91], a[40:43], 0
    v_mfma_f32_16x16x32_bf16 v[140:143], a[92:95], a[44:47], v[140:143]
    v_mfma_f32_16x16x32_bf16 v[136:139], a[84:87], a[44:47], 0
    buffer_load_dwordx4 v21, s[44:47], s54 offen offset:1024 sc1 lds
    v_mfma_f32_16x16x32_bf16 v[136:139], a[80:83], a[40:43], v[136:139]
    s_add_u32 s54, s54, s56
    ds_read_b64_tr_b16 a[76:77], v9 offset:16384
    v_mfma_f32_16x16x32_bf16 v[144:147], a[80:83], a[48:51], 0
    v_mfma_f32_16x16x32_bf16 v[144:147], a[84:87], a[52:55], v[144:147]
    v_mfma_f32_16x16x32_bf16 v[148:151], a[92:95], a[52:55], 0
    buffer_load_dwordx4 v20, s[44:47], s55 offen offset:2048 sc1 lds
    v_mfma_f32_16x16x32_bf16 v[148:151], a[88:91], a[48:51], v[148:151]
    ds_read_b64_tr_b16 a[78:79], v9 offset:18432
    v_mfma_f32_16x16x32_bf16 v[156:159], a[88:91], a[56:59], 0
    v_add_u32 v6, s63, v6
    v_add_u32 v7, s63, v7
    v_mfma_f32_16x16x32_bf16 v[156:159], a[92:95], a[60:63], v[156:159]
    v_mfma_f32_16x16x32_bf16 v[152:155], a[84:87], a[60:63], 0
    buffer_load_dwordx4 v21, s[44:47], s55 offen offset:3072 sc1 lds
    v_mfma_f32_16x16x32_bf16 v[152:155], a[80:83], a[56:59], v[152:155]
    s_add_u32 s55, s55, s56
    v_mfma_f32_16x16x32_bf16 v[160:163], a[96:99], a[0:3], 0
    ds_read_b64_tr_b16 a[80:81], v10 offset:0
    v_mfma_f32_16x16x32_bf16 v[160:163], a[100:103], a[4:7], v[160:163]
    v_mfma_f32_16x16x32_bf16 v[164:167], a[108:111], a[4:7], 0
    v_mfma_f32_16x16x32_bf16 v[164:167], a[104:107], a[0:3], v[164:167]
    s_add_u32 m0, s61, 0
    ds_read_b64_tr_b16 a[82:83], v10 offset:2048
    v_mfma_f32_16x16x32_bf16 v[172:175], a[104:107], a[8:11], 0
    buffer_load_dwordx4 v16, s[40:43], s48 offen offset:0 sc1 lds
    v_mfma_f32_16x16x32_bf16 v[172:175], a[108:111], a[12:15], v[172:175]
    v_mfma_f32_16x16x32_bf16 v[168:171], a[100:103], a[12:15], 0
    ds_read_b64_tr_b16 a[84:85], v10 offset:16384
    v_mfma_f32_16x16x32_bf16 v[168:171], a[96:99], a[8:11], v[168:171]
    v_mfma_f32_16x16x32_bf16 v[176:179], a[96:99], a[16:19], 0
    buffer_store_dwordx4 a[144:147], v2, s[24:27], s28 offen sc1
    v_mfma_f32_16x16x32_bf16 v[176:179], a[100:103], a[20:23], v[176:179]
    s_add_u32 s28, s28, s31
    ds_read_b64_tr_b16 a[86:87], v10 offset:18432
    v_mfma_f32_16x16x32_bf16 v[180:183], a[108:111], a[20:23], 0
    v_mfma_f32_16x16x32_bf16 v[180:183], a[104:107], a[16:19], v[180:183]
    v_mfma_f32_16x16x32_bf16 v[188:191], a[104:107], a[24:27], 0
    buffer_load_dwordx4 v17, s[40:43], s48 offen offset:1024 sc1 lds
    v_mfma_f32_16x16x32_bf16 v[188:191], a[108:111], a[28:31], v[188:191]
    s_add_u32 s48, s48, 128
    ds_read_b64_tr_b16 a[88:89], v11 offset:0
    v_mfma_f32_16x16x32_bf16 v[184:187], a[100:103], a[28:31], 0
    v_mfma_f32_16x16x32_bf16 v[184:187], a[96:99], a[24:27], v[184:187]
    v_mfma_f32_16x16x32_bf16 v[192:195], a[96:99], a[32:35], 0
    buffer_store_dwordx4 a[148:151], v2, s[24:27], s28 offen sc1
    v_mfma_f32_16x16x32_bf16 v[192:195], a[100:103], a[36:39], v[192:195]
    s_add_u32 s28, s28, s31
    ds_read_b64_tr_b16 a[90:91], v11 offset:2048
    v_mfma_f32_16x16x32_bf16 v[196:199], a[108:111], a[36:39], 0
    v_mfma_f32_16x16x32_bf16 v[196:199], a[104:107], a[32:35], v[196:199]
    v_mfma_f32_16x16x32_bf16 v[204:207], a[104:107], a[40:43], 0
    buffer_load_dwordx4 v16, s[40:43], s49 offen offset:2048 sc1 lds
    v_mfma_f32_16x16x32_bf16 v[204:207], a[108:111], a[44:47], v[204:207]
    ds_read_b64_tr_b16 a[92:93], v11 offset:16384
    v_mfma_f32_16x16x32_bf16 v[200:203], a[100:103], a[44:47], 0
    v_mfma_f32_16x16x32_bf16 v[200:203], a[96:99], a[40:43], v[200:203]
    v_mfma_f32_16x16x32_bf16 v[208:211], a[96:99], a[48:51], 0
    buffer_store_dwordx4 a[152:155], v2, s[24:27], s28 offen sc1
    v_mfma_f32_16x16x32_bf16 v[208:211], a[100:103], a[52:55], v[208:211]
    s_add_u32 s28, s28, s31
    ds_read_b64_tr_b16 a[94:95], v11 offset:18432
    v_mfma_f32_16x16x32_bf16 v[212:215], a[108:111], a[52:55], 0
    v_mfma_f32_16x16x32_bf16 v[212:215], a[104:107], a[48:51], v[212:215]
    v_mfma_f32_16x16x32_bf16 v[220:223], a[104:107], a[56:59], 0
    buffer_load_dwordx4 v17, s[40:43], s49 offen offset:3072 sc1 lds
    v_mfma_f32_16x16x32_bf16 v[220:223], a[108:111], a[60:63], v[220:223]
    s_add_u32 s49, s49, 128
    v_mfma_f32_16x16x32_bf16 v[216:219], a[100:103], a[60:63], 0
    buffer_store_dwordx4 a[156:159], v2, s[24:27], s28 offen sc1
    v_mfma_f32_16x16x32_bf16 v[216:219], a[96:99], a[56:59], v[216:219]
    s_add_u32 s29, s29, s30
    s_mov_b32 s28, s29
    v_mfma_f32_16x16x32_bf16 v[224:227], a[112:115], a[0:3], 0
    v_mfma_f32_16x16x32_bf16 v[224:227], a[116:119], a[4:7], v[224:227]
    ds_read_b64_tr_b16 a[96:97], v12 offset:0
    v_mfma_f32_16x16x32_bf16 v[228:231], a[124:127], a[4:7], 0
    v_mfma_f32_16x16x32_bf16 v[228:231], a[120:123], a[0:3], v[228:231]
    s_add_u32 m0, s61, 4096
    ds_read_b128 a[0:3], v6 offset:0
    v_mfma_f32_16x16x32_bf16 v[236:239], a[120:123], a[8:11], 0
    buffer_load_dwordx4 v16, s[40:43], s50 offen offset:0 sc1 lds
    v_mfma_f32_16x16x32_bf16 v[236:239], a[124:127], a[12:15], v[236:239]
    s_add_u32 s61, s61, 32768
    ds_read_b128 a[4:7], v7 offset:0
    v_mfma_f32_16x16x32_bf16 v[232:235], a[116:119], a[12:15], 0
    s_cmp_ge_u32 s61, 98304
    s_cselect_b32 s90, 98304, 0
    ds_read_b64_tr_b16 a[98:99], v12 offset:2048
    v_mfma_f32_16x16x32_bf16 v[232:235], a[112:115], a[8:11], v[232:235]
    s_sub_u32 s61, s61, s90
    ds_read_b128 a[8:11], v6 offset:2048
    v_mfma_f32_16x16x32_bf16 v[240:243], a[112:115], a[16:19], 0
    ds_read_b128 a[12:15], v7 offset:2048
    v_mfma_f32_16x16x32_bf16 v[240:243], a[116:119], a[20:23], v[240:243]
    ds_read_b64_tr_b16 a[100:101], v12 offset:16384
    v_mfma_f32_16x16x32_bf16 v[244:247], a[124:127], a[20:23], 0
    v_mfma_f32_16x16x32_bf16 v[244:247], a[120:123], a[16:19], v[244:247]
    ds_read_b128 a[16:19], v6 offset:4096
    v_mfma_f32_16x16x32_bf16 v[252:255], a[120:123], a[24:27], 0
    buffer_load_dwordx4 v17, s[40:43], s50 offen offset:1024 sc1 lds
    v_mfma_f32_16x16x32_bf16 v[252:255], a[124:127], a[28:31], v[252:255]
    s_add_u32 s50, s50, 128
    ds_read_b128 a[20:23], v7 offset:4096
    v_mfma_f32_16x16x32_bf16 v[248:251], a[116:119], a[28:31], 0
    ds_read_b64_tr_b16 a[102:103], v12 offset:18432
    v_mfma_f32_16x16x32_bf16 v[248:251], a[112:115], a[24:27], v[248:251]
    ds_read_b128 a[24:27], v6 offset:6144
    v_mfma_f32_16x16x32_bf16 a[224:227], a[112:115], a[32:35], 0
    s_sub_u32 s65, s65, 1
    ds_read_b128 a[28:31], v7 offset:6144
    v_mfma_f32_16x16x32_bf16 a[224:227], a[116:119], a[36:39], a[224:227]
    ds_read_b64_tr_b16 a[104:105], v13 offset:0
    v_mfma_f32_16x16x32_bf16 a[228:231], a[124:127], a[36:39], 0
    v_mfma_f32_16x16x32_bf16 a[228:231], a[120:123], a[32:35], a[228:231]
    ds_read_b128 a[32:35], v6 offset:8192
    v_mfma_f32_16x16x32_bf16 a[236:239], a[120:123], a[40:43], 0
    buffer_load_dwordx4 v16, s[40:43], s51 offen offset:2048 sc1 lds
    v_mfma_f32_16x16x32_bf16 a[236:239], a[124:127], a[44:47], a[236:239]
    ds_read_b128 a[36:39], v7 offset:8192
    v_mfma_f32_16x16x32_bf16 a[232:235], a[116:119], a[44:47], 0
    ds_read_b64_tr_b16 a[106:107], v13 offset:2048
    v_mfma_f32_16x16x32_bf16 a[232:235], a[112:115], a[40:43], a[232:235]
    ds_read_b128 a[40:43], v6 offset:10240
    v_mfma_f32_16x16x32_bf16 a[240:243], a[112:115], a[48:51], 0
    ds_read_b128 a[44:47], v7 offset:10240
    v_mfma_f32_16x16x32_bf16 a[240:243], a[116:119], a[52:55], a[240:243]
    ds_read_b64_tr_b16 a[108:109], v13 offset:16384
    v_mfma_f32_16x16x32_bf16 a[244:247], a[124:127], a[52:55], 0
    v_mfma_f32_16x16x32_bf16 a[244:247], a[120:123], a[48:51], a[244:247]
    ds_read_b128 a[48:51], v6 offset:12288
    v_mfma_f32_16x16x32_bf16 a[252:255], a[120:123], a[56:59], 0
    buffer_load_dwordx4 v17, s[40:43], s51 offen offset:3072 sc1 lds
    v_mfma_f32_16x16x32_bf16 a[252:255], a[124:127], a[60:63], a[252:255]
    s_add_u32 s51, s51, 128
    ds_read_b128 a[52:55], v7 offset:12288
    v_mfma_f32_16x16x32_bf16 a[248:251], a[116:119], a[60:63], 0
    ds_read_b64_tr_b16 a[110:111], v13 offset:18432
    v_mfma_f32_16x16x32_bf16 a[248:251], a[112:115], a[56:59], a[248:251]
    ds_read_b128 a[56:59], v6 offset:14336
    ds_read_b128 a[60:63], v7 offset:14336
    s_waitcnt lgkmcnt(15)
    v_mfma_f32_16x16x32_bf16 v[32:35], a[64:67], a[0:3], v[32:35]
    ds_read_b64_tr_b16 a[112:113], v14 offset:0
    v_mfma_f32_16x16x32_bf16 v[32:35], a[68:71], a[4:7], v[32:35]
    ds_read_b64_tr_b16 a[114:115], v14 offset:2048
    v_mfma_f32_16x16x32_bf16 v[36:39], a[76:79], a[4:7], v[36:39]
    ds_read_b64_tr_b16 a[116:117], v14 offset:16384
    v_mfma_f32_16x16x32_bf16 v[36:39], a[72:75], a[0:3], v[36:39]
    ds_read_b64_tr_b16 a[118:119], v14 offset:18432
    v_mfma_f32_16x16x32_bf16 v[44:47], a[72:75], a[8:11], v[44:47]
    ds_read_b64_tr_b16 a[120:121], v15 offset:0
    v_mfma_f32_16x16x32_bf16 v[44:47], a[76:79], a[12:15], v[44:47]
    ds_read_b64_tr_b16 a[122:123], v15 offset:2048
    v_mfma_f32_16x16x32_bf16 v[40:43], a[68:71], a[12:15], v[40:43]
    ds_read_b64_tr_b16 a[124:125], v15 offset:16384
    v_mfma_f32_16x16x32_bf16 v[40:43], a[64:67], a[8:11], v[40:43]
    ds_read_b64_tr_b16 a[126:127], v15 offset:18432
    v_mfma_f32_16x16x32_bf16 v[48:51], a[64:67], a[16:19], v[48:51]
    v_mfma_f32_16x16x32_bf16 v[48:51], a[68:71], a[20:23], v[48:51]
    v_mfma_f32_16x16x32_bf16 v[52:55], a[76:79], a[20:23], v[52:55]
    buffer_store_dwordx4 a[160:163], v2, s[24:27], s28 offen sc1
    v_mfma_f32_16x16x32_bf16 v[52:55], a[72:75], a[16:19], v[52:55]
    s_add_u32 s28, s28, s31
    s_waitcnt lgkmcnt(15)
    v_mfma_f32_16x16x32_bf16 v[60:63], a[72:75], a[24:27], v[60:63]
    v_xor_b32 v8, s60, v8
    v_xor_b32 v9, s60, v9
    v_mfma_f32_16x16x32_bf16 v[60:63], a[76:79], a[28:31], v[60:63]
    v_xor_b32 v10, s60, v10
    v_xor_b32 v11, s60, v11
    v_mfma_f32_16x16x32_bf16 v[56:59], a[68:71], a[28:31], v[56:59]
    v_xor_b32 v12, s60, v12
    v_xor_b32 v13, s60, v13
    v_mfma_f32_16x16x32_bf16 v[56:59], a[64:67], a[24:27], v[56:59]
    v_xor_b32 v14, s60, v14
    v_xor_b32 v15, s60, v15
    v_mfma_f32_16x16x32_bf16 v[64:67], a[64:67], a[32:35], v[64:67]
    buffer_store_dwordx4 a[164:167], v2, s[24:27], s28 offen sc1
    v_mfma_f32_16x16x32_bf16 v[64:67], a[68:71], a[36:39], v[64:67]
    s_add_u32 s28, s28, s31
    v_mfma_f32_16x16x32_bf16 v[68:71], a[76:79], a[36:39], v[68:71]
    v_mfma_f32_16x16x32_bf16 v[68:71], a[72:75], a[32:35], v[68:71]
    s_waitcnt lgkmcnt(14)
    v_mfma_f32_16x16x32_bf16 v[76:79], a[72:75], a[40:43], v[76:79]
    v_mfma_f32_16x16x32_bf16 v[76:79], a[76:79], a[44:47], v[76:79]
    v_mfma_f32_16x16x32_bf16 v[72:75], a[68:71], a[44:47], v[72:75]
    buffer_store_dwordx4 a[168:171], v2, s[24:27], s28 offen sc1
    v_mfma_f32_16x16x32_bf16 v[72:75], a[64:67], a[40:43], v[72:75]
    s_add_u32 s28, s28, s31
    s_waitcnt lgkmcnt(11)
    v_mfma_f32_16x16x32_bf16 v[80:83], a[64:67], a[48:51], v[80:83]
    v_mfma_f32_16x16x32_bf16 v[80:83], a[68:71], a[52:55], v[80:83]
    v_mfma_f32_16x16x32_bf16 v[84:87], a[76:79], a[52:55], v[84:87]
    v_mfma_f32_16x16x32_bf16 v[84:87], a[72:75], a[48:51], v[84:87]
    s_waitcnt lgkmcnt(8)
    v_mfma_f32_16x16x32_bf16 v[92:95], a[72:75], a[56:59], v[92:95]
    buffer_store_dwordx4 a[172:175], v2, s[24:27], s28 offen sc1
    v_mfma_f32_16x16x32_bf16 v[92:95], a[76:79], a[60:63], v[92:95]
    s_add_u32 s28, s28, s31
    v_mfma_f32_16x16x32_bf16 v[88:91], a[68:71], a[60:63], v[88:91]
    s_waitcnt vmcnt(16) lgkmcnt(0)
    v_mfma_f32_16x16x32_bf16 v[88:91], a[64:67], a[56:59], v[88:91]
    s_barrier
    v_mfma_f32_16x16x32_bf16 v[96:99], a[80:83], a[0:3], v[96:99]
    ds_read_b64_tr_b16 a[64:65], v8 offset:0
    v_mfma_f32_16x16x32_bf16 v[96:99], a[84:87], a[4:7], v[96:99]
    s_add_u32 m0, s62, 0
    v_mfma_f32_16x16x32_bf16 v[100:103], a[92:95], a[4:7], v[100:103]
    buffer_load_dwordx4 v18, s[44:47], s52 offen offset:0 sc1 lds
    v_mfma_f32_16x16x32_bf16 v[100:103], a[88:91], a[0:3], v[100:103]
    ds_read_b64_tr_b16 a[66:67], v8 offset:2048
    v_mfma_f32_16x16x32_bf16 v[108:111], a[88:91], a[8:11], v[108:111]
    s_add_u32 s64, s64, 32768
    v_mfma_f32_16x16x32_bf16 v[108:111], a[92:95], a[12:15], v[108:111]
    s_cmp_ge_u32 s64, 98304
    s_cselect_b32 s63, 4294901760, s59
    s_cselect_b32 s64, 0, s64
    v_mfma_f32_16x16x32_bf16 v[104:107], a[84:87], a[12:15], v[104:107]
    buffer_load_dwordx4 v19, s[44:47], s52 offen offset:1024 sc1 lds
    v_mfma_f32_16x16x32_bf16 v[104:107], a[80:83], a[8:11], v[104:107]
    s_add_u32 s52, s52, s56
    ds_read_b64_tr_b16 a[68:69], v8 offset:16384
    v_mfma_f32_16x16x32_bf16 v[112:115], a[80:83], a[16:19], v[112:115]
    v_mfma_f32_16x16x32_bf16 v[112:115], a[84:87], a[20:23], v[112:115]
    v_mfma_f32_16x16x32_bf16 v[116:119], a[92:95], a[20:23], v[116:119]
    buffer_load_dwordx4 v18, s[44:47], s53 offen offset:2048 sc1 lds
    v_mfma_f32_16x16x32_bf16 v[116:119], a[88:91], a[16:19], v[116:119]
    ds_read_b64_tr_b16 a[70:71], v8 offset:18432
    v_mfma_f32_16x16x32_bf16 v[124:127], a[88:91], a[24:27], v[124:127]
    v_mfma_f32_16x16x32_bf16 v[124:127], a[92:95], a[28:31], v[124:127]
    v_mfma_f32_16x16x32_bf16 v[120:123], a[84:87], a[28:31], v[120:123]
    buffer_load_dwordx4 v19, s[44:47], s53 offen offset:3072 sc1 lds
    v_mfma_f32_16x16x32_bf16 v[120:123], a[80:83], a[24:27], v[120:123]
    s_add_u32 s53, s53, s56
    ds_read_b64_tr_b16 a[72:73], v9 offset:0
    v_mfma_f32_16x16x32_bf16 v[128:131], a[80:83], a[32:35], v[128:131]
    v_mfma_f32_16x16x32_bf16 v[128:131], a[84:87], a[36:39], v[128:131]
    s_add_u32 m0, s62, 4096
    v_mfma_f32_16x16x32_bf16 v[132:135], a[92:95], a[36:39], v[132:135]
    buffer_load_dwordx4 v20, s[44:47], s54 offen offset:0 sc1 lds
    v_mfma_f32_16x16x32_bf16 v[132:135], a[88:91], a[32:35], v[132:135]
    s_xor_b32 s62, s62, 229376
    ds_read_b64_tr_b16 a[74:75], v9 offset:2048
    v_mfma_f32_16x16x32_bf16 v[140:143], a[88:91], a[40:43], v[140:143]
    v_mfma_f32_16x16x32_bf16 v[140:143], a[92:95], a[44:47], v[140:143]
    v_mfma_f32_16x16x32_bf16 v[136:139], a[84:87], a[44:47], v[136:139]
    buffer_load_dwordx4 v21, s[44:47], s54 offen offset:1024 sc1 lds
    v_mfma_f32_16x16x32_bf16 v[136:139], a[80:83], a[40:43], v[136:139]
    s_add_u32 s54, s54, s56
    ds_read_b64_tr_b16 a[76:77], v9 offset:16384
    v_mfma_f32_16x16x32_bf16 v[144:147], a[80:83], a[48:51], v[144:147]
    v_mfma_f32_16x16x32_bf16 v[144:147], a[84:87], a[52:55], v[144:147]
    v_mfma_f32_16x16x32_bf16 v[148:151], a[92:95], a[52:55], v[148:151]
    buffer_load_dwordx4 v20, s[44:47], s55 offen offset:2048 sc1 lds
    v_mfma_f32_16x16x32_bf16 v[148:151], a[88:91], a[48:51], v[148:151]
    ds_read_b64_tr_b16 a[78:79], v9 offset:18432
    v_mfma_f32_16x16x32_bf16 v[156:159], a[88:91], a[56:59], v[156:159]
    v_add_u32 v6, s63, v6
    v_add_u32 v7, s63, v7
    v_mfma_f32_16x16x32_bf16 v[156:159], a[92:95], a[60:63], v[156:159]
    v_mfma_f32_16x16x32_bf16 v[152:155], a[84:87], a[60:63], v[152:155]
    buffer_load_dwordx4 v21, s[44:47], s55 offen offset:3072 sc1 lds
    v_mfma_f32_16x16x32_bf16 v[152:155], a[80:83], a[56:59], v[152:155]
    s_add_u32 s55, s55, s56
    v_mfma_f32_16x16x32_bf16 v[160:163], a[96:99], a[0:3], v[160:163]
    ds_read_b64_tr_b16 a[80:81], v10 offset:0
    v_mfma_f32_16x16x32_bf16 v[160:163], a[100:103], a[4:7], v[160:163]
    v_mfma_f32_16x16x32_bf16 v[164:167], a[108:111], a[4:7], v[164:167]
    v_mfma_f32_16x16x32_bf16 v[164:167], a[104:107], a[0:3], v[164:167]
    s_add_u32 m0, s61, 0
    ds_read_b64_tr_b16 a[82:83], v10 offset:2048
    v_mfma_f32_16x16x32_bf16 v[172:175], a[104:107], a[8:11], v[172:175]
    buffer_load_dwordx4 v16, s[40:43], s48 offen offset:0 sc1 lds
    v_mfma_f32_16x16x32_bf16 v[172:175], a[108:111], a[12:15], v[172:175]
    v_mfma_f32_16x16x32_bf16 v[168:171], a[100:103], a[12:15], v[168:171]
    ds_read_b64_tr_b16 a[84:85], v10 offset:16384
    v_mfma_f32_16x16x32_bf16 v[168:171], a[96:99], a[8:11], v[168:171]
    v_mfma_f32_16x16x32_bf16 v[176:179], a[96:99], a[16:19], v[176:179]
    buffer_store_dwordx4 a[176:179], v2, s[24:27], s28 offen sc1
    v_mfma_f32_16x16x32_bf16 v[176:179], a[100:103], a[20:23], v[176:179]
    s_add_u32 s28, s28, s31
    ds_read_b64_tr_b16 a[86:87], v10 offset:18432
    v_mfma_f32_16x16x32_bf16 v[180:183], a[108:111], a[20:23], v[180:183]
    v_mfma_f32_16x16x32_bf16 v[180:183], a[104:107], a[16:19], v[180:183]
    v_mfma_f32_16x16x32_bf16 v[188:191], a[104:107], a[24:27], v[188:191]
    buffer_load_dwordx4 v17, s[40:43], s48 offen offset:1024 sc1 lds
    v_mfma_f32_16x16x32_bf16 v[188:191], a[108:111], a[28:31], v[188:191]
    s_add_u32 s48, s48, 128
    ds_read_b64_tr_b16 a[88:89], v11 offset:0
    v_mfma_f32_16x16x32_bf16 v[184:187], a[100:103], a[28:31], v[184:187]
    v_mfma_f32_16x16x32_bf16 v[184:187], a[96:99], a[24:27], v[184:187]
    v_mfma_f32_16x16x32_bf16 v[192:195], a[96:99], a[32:35], v[192:195]
    buffer_store_dwordx4 a[180:183], v2, s[24:27], s28 offen sc1
    v_mfma_f32_16x16x32_bf16 v[192:195], a[100:103], a[36:39], v[192:195]
    s_add_u32 s28, s28, s31
    ds_read_b64_tr_b16 a[90:91], v11 offset:2048
    v_mfma_f32_16x16x32_bf16 v[196:199], a[108:111], a[36:39], v[196:199]
    v_mfma_f32_16x16x32_bf16 v[196:199], a[104:107], a[32:35], v[196:199]
    v_mfma_f32_16x16x32_bf16 v[204:207], a[104:107], a[40:43], v[204:207]
    buffer_load_dwordx4 v16, s[40:43], s49 offen offset:2048 sc1 lds
    v_mfma_f32_16x16x32_bf16 v[204:207], a[108:111], a[44:47], v[204:207]
    ds_read_b64_tr_b16 a[92:93], v11 offset:16384
    v_mfma_f32_16x16x32_bf16 v[200:203], a[100:103], a[44:47], v[200:203]
    v_mfma_f32_16x16x32_bf16 v[200:203], a[96:99], a[40:43], v[200:203]
    v_mfma_f32_16x16x32_bf16 v[208:211], a[96:99], a[48:51], v[208:211]
    buffer_store_dwordx4 a[184:187], v2, s[24:27], s28 offen sc1
    v_mfma_f32_16x16x32_bf16 v[208:211], a[100:103], a[52:55], v[208:211]
    s_add_u32 s28, s28, s31
    ds_read_b64_tr_b16 a[94:95], v11 offset:18432
    v_mfma_f32_16x16x32_bf16 v[212:215], a[108:111], a[52:55], v[212:215]
    v_mfma_f32_16x16x32_bf16 v[212:215], a[104:107], a[48:51], v[212:215]
    v_mfma_f32_16x16x32_bf16 v[220:223], a[104:107], a[56:59], v[220:223]
    buffer_load_dwordx4 v17, s[40:43], s49 offen offset:3072 sc1 lds
    v_mfma_f32_16x16x32_bf16 v[220:223], a[108:111], a[60:63], v[220:223]
    s_add_u32 s49, s49, 128
    v_mfma_f32_16x16x32_bf16 v[216:219], a[100:103], a[60:63], v[216:219]
    buffer_store_dwordx4 a[188:191], v2, s[24:27], s28 offen sc1
    v_mfma_f32_16x16x32_bf16 v[216:219], a[96:99], a[56:59], v[216:219]
    s_add_u32 s29, s29, s30
    s_mov_b32 s28, s29
    v_mfma_f32_16x16x32_bf16 v[224:227], a[112:115], a[0:3], v[224:227]
    v_mfma_f32_16x16x32_bf16 v[224:227], a[116:119], a[4:7], v[224:227]
    ds_read_b64_tr_b16 a[96:97], v12 offset:0
    v_mfma_f32_16x16x32_bf16 v[228:231], a[124:127], a[4:7], v[228:231]
    v_mfma_f32_16x16x32_bf16 v[228:231], a[120:123], a[0:3], v[228:231]
    s_add_u32 m0, s61, 4096
    ds_read_b128 a[0:3], v6 offset:0
    v_mfma_f32_16x16x32_bf16 v[236:239], a[120:123], a[8:11], v[236:239]
    buffer_load_dwordx4 v16, s[40:43], s50 offen offset:0 sc1 lds
    v_mfma_f32_16x16x32_bf16 v[236:239], a[124:127], a[12:15], v[236:239]
    s_add_u32 s61, s61, 32768
    ds_read_b128 a[4:7], v7 offset:0
    v_mfma_f32_16x16x32_bf16 v[232:235], a[116:119], a[12:15], v[232:235]
    s_cmp_ge_u32 s61, 98304
    s_cselect_b32 s90, 98304, 0
    ds_read_b64_tr_b16 a[98:99], v12 offset:2048
    v_mfma_f32_16x16x32_bf16 v[232:235], a[112:115], a[8:11], v[232:235]
    s_sub_u32 s61, s61, s90
    ds_read_b128 a[8:11], v6 offset:2048
    v_mfma_f32_16x16x32_bf16 v[240:243], a[112:115], a[16:19], v[240:243]
    ds_read_b128 a[12:15], v7 offset:2048
    v_mfma_f32_16x16x32_bf16 v[240:243], a[116:119], a[20:23], v[240:243]
    ds_read_b64_tr_b16 a[100:101], v12 offset:16384
    v_mfma_f32_16x16x32_bf16 v[244:247], a[124:127], a[20:23], v[244:247]
    v_mfma_f32_16x16x32_bf16 v[244:247], a[120:123], a[16:19], v[244:247]
    ds_read_b128 a[16:19], v6 offset:4096
    v_mfma_f32_16x16x32_bf16 v[252:255], a[120:123], a[24:27], v[252:255]
    buffer_load_dwordx4 v17, s[40:43], s50 offen offset:1024 sc1 lds
    v_mfma_f32_16x16x32_bf16 v[252:255], a[124:127], a[28:31], v[252:255]
    s_add_u32 s50, s50, 128
    ds_read_b128 a[20:23], v7 offset:4096
    v_mfma_f32_16x16x32_bf16 v[248:251], a[116:119], a[28:31], v[248:251]
    ds_read_b64_tr_b16 a[102:103], v12 offset:18432
    v_mfma_f32_16x16x32_bf16 v[248:251], a[112:115], a[24:27], v[248:251]
    ds_read_b128 a[24:27], v6 offset:6144
    v_mfma_f32_16x16x32_bf16 a[224:227], a[112:115], a[32:35], a[224:227]
    s_sub_u32 s65, s65, 1
    ds_read_b128 a[28:31], v7 offset:6144
    v_mfma_f32_16x16x32_bf16 a[224:227], a[116:119], a[36:39], a[224:227]
    ds_read_b64_tr_b16 a[104:105], v13 offset:0
    v_mfma_f32_16x16x32_bf16 a[228:231], a[124:127], a[36:39], a[228:231]
    v_mfma_f32_16x16x32_bf16 a[228:231], a[120:123], a[32:35], a[228:231]
    ds_read_b128 a[32:35], v6 offset:8192
    v_mfma_f32_16x16x32_bf16 a[236:239], a[120:123], a[40:43], a[236:239]
    buffer_load_dwordx4 v16, s[40:43], s51 offen offset:2048 sc1 lds
    v_mfma_f32_16x16x32_bf16 a[236:239], a[124:127], a[44:47], a[236:239]
    ds_read_b128 a[36:39], v7 offset:8192
    v_mfma_f32_16x16x32_bf16 a[232:235], a[116:119], a[44:47], a[232:235]
    ds_read_b64_tr_b16 a[106:107], v13 offset:2048
    v_mfma_f32_16x16x32_bf16 a[232:235], a[112:115], a[40:43], a[232:235]
    ds_read_b128 a[40:43], v6 offset:10240
    v_mfma_f32_16x16x32_bf16 a[240:243], a[112:115], a[48:51], a[240:243]
    ds_read_b128 a[44:47], v7 offset:10240
    v_mfma_f32_16x16x32_bf16 a[240:243], a[116:119], a[52:55], a[240:243]
    ds_read_b64_tr_b16 a[108:109], v13 offset:16384
    v_mfma_f32_16x16x32_bf16 a[244:247], a[124:127], a[52:55], a[244:247]
    v_mfma_f32_16x16x32_bf16 a[244:247], a[120:123], a[48:51], a[244:247]
    ds_read_b128 a[48:51], v6 offset:12288
    v_mfma_f32_16x16x32_bf16 a[252:255], a[120:123], a[56:59], a[252:255]
    buffer_load_dwordx4 v17, s[40:43], s51 offen offset:3072 sc1 lds
    v_mfma_f32_16x16x32_bf16 a[252:255], a[124:127], a[60:63], a[252:255]
    s_add_u32 s51, s51, 128
    ds_read_b128 a[52:55], v7 offset:12288
    v_mfma_f32_16x16x32_bf16 a[248:251], a[116:119], a[60:63], a[248:251]
    ds_read_b64_tr_b16 a[110:111], v13 offset:18432
    v_mfma_f32_16x16x32_bf16 a[248:251], a[112:115], a[56:59], a[248:251]
    ds_read_b128 a[56:59], v6 offset:14336
    ds_read_b128 a[60:63], v7 offset:14336
    s_cmp_eq_u32 s66, 2
    s_cbranch_scc1 m_hook18
m_hookr19:
    s_waitcnt lgkmcnt(15)
    v_mfma_f32_16x16x32_bf16 v[32:35], a[64:67], a[0:3], v[32:35]
    ds_read_b64_tr_b16 a[112:113], v14 offset:0
    v_mfma_f32_16x16x32_bf16 v[32:35], a[68:71], a[4:7], v[32:35]
    ds_read_b64_tr_b16 a[114:115], v14 offset:2048
    v_mfma_f32_16x16x32_bf16 v[36:39], a[76:79], a[4:7], v[36:39]
    ds_read_b64_tr_b16 a[116:117], v14 offset:16384
    v_mfma_f32_16x16x32_bf16 v[36:39], a[72:75], a[0:3], v[36:39]
    ds_read_b64_tr_b16 a[118:119], v14 offset:18432
    v_mfma_f32_16x16x32_bf16 v[44:47], a[72:75], a[8:11], v[44:47]
    ds_read_b64_tr_b16 a[120:121], v15 offset:0
    v_mfma_f32_16x16x32_bf16 v[44:47], a[76:79], a[12:15], v[44:47]
    ds_read_b64_tr_b16 a[122:123], v15 offset:2048
    v_mfma_f32_16x16x32_bf16 v[40:43], a[68:71], a[12:15], v[40:43]
    ds_read_b64_tr_b16 a[124:125], v15 offset:16384
    v_mfma_f32_16x16x32_bf16 v[40:43], a[64:67], a[8:11], v[40:43]
    ds_read_b64_tr_b16 a[126:127], v15 offset:18432
    v_mfma_f32_16x16x32_bf16 v[48:51], a[64:67], a[16:19], v[48:51]
    v_mfma_f32_16x16x32_bf16 v[48:51], a[68:71], a[20:23], v[48:51]
    v_mfma_f32_16x16x32_bf16 v[52:55], a[76:79], a[20:23], v[52:55]
    buffer_store_dwordx4 a[192:195], v2, s[24:27], s28 offen sc1
    v_mfma_f32_16x16x32_bf16 v[52:55], a[72:75], a[16:19], v[52:55]
    s_add_u32 s28, s28, s31
    s_waitcnt lgkmcnt(15)
    v_mfma_f32_16x16x32_bf16 v[60:63], a[72:75], a[24:27], v[60:63]
    v_xor_b32 v8, s60, v8
    v_xor_b32 v9, s60, v9
    v_mfma_f32_16x16x32_bf16 v[60:63], a[76:79], a[28:31], v[60:63]
    v_xor_b32 v10, s60, v10
    v_xor_b32 v11, s60, v11
    v_mfma_f32_16x16x32_bf16 v[56:59], a[68:71], a[28:31], v[56:59]
    v_xor_b32 v12, s60, v12
    v_xor_b32 v13, s60, v13
    v_mfma_f32_16x16x32_bf16 v[56:59], a[64:67], a[24:27], v[56:59]
    v_xor_b32 v14, s60, v14
    v_xor_b32 v15, s60, v15
    v_mfma_f32_16x16x32_bf16 v[64:67], a[64:67], a[32:35], v[64:67]
    buffer_store_dwordx4 a[196:199], v2, s[24:27], s28 offen sc1
    v_mfma_f32_16x16x32_bf16 v[64:67], a[68:71], a[36:39], v[64:67]
    s_add_u32 s28, s28, s31
    v_mfma_f32_16x16x32_bf16 v[68:71], a[76:79], a[36:39], v[68:71]
    v_mfma_f32_16x16x32_bf16 v[68:71], a[72:75], a[32:35], v[68:71]
    s_waitcnt lgkmcnt(14)
    v_mfma_f32_16x16x32_bf16 v[76:79], a[72:75], a[40:43], v[76:79]
    v_mfma_f32_16x16x32_bf16 v[76:79], a[76:79], a[44:47], v[76:79]
    v_mfma_f32_16x16x32_bf16 v[72:75], a[68:71], a[44:47], v[72:75]
    buffer_store_dwordx4 a[200:203], v2, s[24:27], s28 offen sc1
    v_mfma_f32_16x16x32_bf16 v[72:75], a[64:67], a[40:43], v[72:75]
    s_add_u32 s28, s28, s31
    s_waitcnt lgkmcnt(11)
    v_mfma_f32_16x16x32_bf16 v[80:83], a[64:67], a[48:51], v[80:83]
    v_mfma_f32_16x16x32_bf16 v[80:83], a[68:71], a[52:55], v[80:83]
    v_mfma_f32_16x16x32_bf16 v[84:87], a[76:79], a[52:55], v[84:87]
    v_mfma_f32_16x16x32_bf16 v[84:87], a[72:75], a[48:51], v[84:87]
    s_waitcnt lgkmcnt(8)
    v_mfma_f32_16x16x32_bf16 v[92:95], a[72:75], a[56:59], v[92:95]
    buffer_store_dwordx4 a[204:207], v2, s[24:27], s28 offen sc1
    v_mfma_f32_16x16x32_bf16 v[92:95], a[76:79], a[60:63], v[92:95]
    s_add_u32 s28, s28, s31
    v_mfma_f32_16x16x32_bf16 v[88:91], a[68:71], a[60:63], v[88:91]
    s_waitcnt vmcnt(16) lgkmcnt(0)
    v_mfma_f32_16x16x32_bf16 v[88:91], a[64:67], a[56:59], v[88:91]
    s_barrier
    v_mfma_f32_16x16x32_bf16 v[96:99], a[80:83], a[0:3], v[96:99]
    ds_read_b64_tr_b16 a[64:65], v8 offset:0
    v_mfma_f32_16x16x32_bf16 v[96:99], a[84:87], a[4:7], v[96:99]
    s_add_u32 m0, s62, 0
    v_mfma_f32_16x16x32_bf16 v[100:103], a[92:95], a[4:7], v[100:103]
    buffer_load_dwordx4 v18, s[44:47], s52 offen offset:0 sc1 lds
    v_mfma_f32_16x16x32_bf16 v[100:103], a[88:91], a[0:3], v[100:103]
    ds_read_b64_tr_b16 a[66:67], v8 offset:2048
    v_mfma_f32_16x16x32_bf16 v[108:111], a[88:91], a[8:11], v[108:111]
    s_add_u32 s64, s64, 32768
    v_mfma_f32_16x16x32_bf16 v[108:111], a[92:95], a[12:15], v[108:111]
    s_cmp_ge_u32 s64, 98304
    s_cselect_b32 s63, 4294901760, s59
    s_cselect_b32 s64, 0, s64
    v_mfma_f32_16x16x32_bf16 v[104:107], a[84:87], a[12:15], v[104:107]
    buffer_load_dwordx4 v19, s[44:47], s52 offen offset:1024 sc1 lds
    v_mfma_f32_16x16x32_bf16 v[104:107], a[80:83], a[8:11], v[104:107]
    s_add_u32 s52, s52, s56
    ds_read_b64_tr_b16 a[68:69], v8 offset:16384
    v_mfma_f32_16x16x32_bf16 v[112:115], a[80:83], a[16:19], v[112:115]
    v_mfma_f32_16x16x32_bf16 v[112:115], a[84:87], a[20:23], v[112:115]
    v_mfma_f32_16x16x32_bf16 v[116:119], a[92:95], a[20:23], v[116:119]
    buffer_load_dwordx4 v18, s[44:47], s53 offen offset:2048 sc1 lds
    v_mfma_f32_16x16x32_bf16 v[116:119], a[88:91], a[16:19], v[116:119]
    ds_read_b64_tr_b16 a[70:71], v8 offset:18432
    v_mfma_f32_16x16x32_bf16 v[124:127], a[88:91], a[24:27], v[124:127]
    v_mfma_f32_16x16x32_bf16 v[124:127], a[92:95], a[28:31], v[124:127]
    v_mfma_f32_16x16x32_bf16 v[120:123], a[84:87], a[28:31], v[120:123]
    buffer_load_dwordx4 v19, s[44:47], s53 offen offset:3072 sc1 lds
    v_mfma_f32_16x16x32_bf16 v[120:123], a[80:83], a[24:27], v[120:123]
    s_add_u32 s53, s53, s56
    ds_read_b64_tr_b16 a[72:73], v9 offset:0
    v_mfma_f32_16x16x32_bf16 v[128:131], a[80:83], a[32:35], v[128:131]
    v_mfma_f32_16x16x32_bf16 v[128:131], a[84:87], a[36:39], v[128:131]
    s_add_u32 m0, s62, 4096
    v_mfma_f32_16x16x32_bf16 v[132:135], a[92:95], a[36:39], v[132:135]
    buffer_load_dwordx4 v20, s[44:47], s54 offen offset:0 sc1 lds
    v_mfma_f32_16x16x32_bf16 v[132:135], a[88:91], a[32:35], v[132:135]
    s_xor_b32 s62, s62, 229376
    ds_read_b64_tr_b16 a[74:75], v9 offset:2048
    v_mfma_f32_16x16x32_bf16 v[140:143], a[88:91], a[40:43], v[140:143]
    v_mfma_f32_16x16x32_bf16 v[140:143], a[92:95], a[44:47], v[140:143]
    v_mfma_f32_16x16x32_bf16 v[136:139], a[84:87], a[44:47], v[136:139]
    buffer_load_dwordx4 v21, s[44:47], s54 offen offset:1024 sc1 lds
    v_mfma_f32_16x16x32_bf16 v[136:139], a[80:83], a[40:43], v[136:139]
    s_add_u32 s54, s54, s56
    ds_read_b64_tr_b16 a[76:77], v9 offset:16384
    v_mfma_f32_16x16x32_bf16 v[144:147], a[80:83], a[48:51], v[144:147]
    v_mfma_f32_16x16x32_bf16 v[144:147], a[84:87], a[52:55], v[144:147]
    v_mfma_f32_16x16x32_bf16 v[148:151], a[92:95], a[52:55], v[148:151]
    buffer_load_dwordx4 v20, s[44:47], s55 offen offset:2048 sc1 lds
    v_mfma_f32_16x16x32_bf16 v[148:151], a[88:91], a[48:51], v[148:151]
    ds_read_b64_tr_b16 a[78:79], v9 offset:18432
    v_mfma_f32_16x16x32_bf16 v[156:159], a[88:91], a[56:59], v[156:159]
    v_add_u32 v6, s63, v6
    v_add_u32 v7, s63, v7
    v_mfma_f32_16x16x32_bf16 v[156:159], a[92:95], a[60:63], v[156:159]
    v_mfma_f32_16x16x32_bf16 v[152:155], a[84:87], a[60:63], v[152:155]
    buffer_load_dwordx4 v21, s[44:47], s55 offen offset:3072 sc1 lds
    v_mfma_f32_16x16x32_bf16 v[152:155], a[80:83], a[56:59], v[152:155]
    s_add_u32 s55, s55, s56
    v_mfma_f32_16x16x32_bf16 v[160:163], a[96:99], a[0:3], v[160:163]
    ds_read_b64_tr_b16 a[80:81], v10 offset:0
    v_mfma_f32_16x16x32_bf16 v[160:163], a[100:103], a[4:7], v[160:163]
    v_mfma_f32_16x16x32_bf16 v[164:167], a[108:111], a[4:7], v[164:167]
    v_mfma_f32_16x16x32_bf16 v[164:167], a[104:107], a[0:3], v[164:167]
    s_add_u32 m0, s61, 0
    ds_read_b64_tr_b16 a[82:83], v10 offset:2048
    v_mfma_f32_16x16x32_bf16 v[172:175], a[104:107], a[8:11], v[172:175]
    buffer_load_dwordx4 v16, s[40:43], s48 offen offset:0 sc1 lds
    v_mfma_f32_16x16x32_bf16 v[172:175], a[108:111], a[12:15], v[172:175]
    v_mfma_f32_16x16x32_bf16 v[168:171], a[100:103], a[12:15], v[168:171]
    ds_read_b64_tr_b16 a[84:85], v10 offset:16384
    v_mfma_f32_16x16x32_bf16 v[168:171], a[96:99], a[8:11], v[168:171]
    v_mfma_f32_16x16x32_bf16 v[176:179], a[96:99], a[16:19], v[176:179]
    buffer_store_dwordx4 a[208:211], v2, s[24:27], s28 offen sc1
    v_mfma_f32_16x16x32_bf16 v[176:179], a[100:103], a[20:23], v[176:179]
    s_add_u32 s28, s28, s31
    ds_read_b64_tr_b16 a[86:87], v10 offset:18432
    v_mfma_f32_16x16x32_bf16 v[180:183], a[108:111], a[20:23], v[180:183]
    v_mfma_f32_16x16x32_bf16 v[180:183], a[104:107], a[16:19], v[180:183]
    v_mfma_f32_16x16x32_bf16 v[188:191], a[104:107], a[24:27], v[188:191]
    buffer_load_dwordx4 v17, s[40:43], s48 offen offset:1024 sc1 lds
    v_mfma_f32_16x16x32_bf16 v[188:191], a[108:111], a[28:31], v[188:191]
    s_add_u32 s48, s48, 128
    ds_read_b64_tr_b16 a[88:89], v11 offset:0
    v_mfma_f32_16x16x32_bf16 v[184:187], a[100:103], a[28:31], v[184:187]
    v_mfma_f32_16x16x32_bf16 v[184:187], a[96:99], a[24:27], v[184:187]
    v_mfma_f32_16x16x32_bf16 v[192:195], a[96:99], a[32:35], v[192:195]
    buffer_store_dwordx4 a[212:215], v2, s[24:27], s28 offen sc1
    v_mfma_f32_16x16x32_bf16 v[192:195], a[100:103], a[36:39], v[192:195]
    s_add_u32 s28, s28, s31
    ds_read_b64_tr_b16 a[90:91], v11 offset:2048
    v_mfma_f32_16x16x32_bf16 v[196:199], a[108:111], a[36:39], v[196:199]
    v_mfma_f32_16x16x32_bf16 v[196:199], a[104:107], a[32:35], v[196:199]
    v_mfma_f32_16x16x32_bf16 v[204:207], a[104:107], a[40:43], v[204:207]
    buffer_load_dwordx4 v16, s[40:43], s49 offen offset:2048 sc1 lds
    v_mfma_f32_16x16x32_bf16 v[204:207], a[108:111], a[44:47], v[204:207]
    ds_read_b64_tr_b16 a[92:93], v11 offset:16384
    v_mfma_f32_16x16x32_bf16 v[200:203], a[100:103], a[44:47], v[200:203]
    v_mfma_f32_16x16x32_bf16 v[200:203], a[96:99], a[40:43], v[200:203]
    v_mfma_f32_16x16x32_bf16 v[208:211], a[96:99], a[48:51], v[208:211]
    buffer_store_dwordx4 a[216:219], v2, s[24:27], s28 offen sc1
    v_mfma_f32_16x16x32_bf16 v[208:211], a[100:103], a[52:55], v[208:211]
    s_add_u32 s28, s28, s31
    ds_read_b64_tr_b16 a[94:95], v11 offset:18432
    v_mfma_f32_16x16x32_bf16 v[212:215], a[108:111], a[52:55], v[212:215]
    v_mfma_f32_16x16x32_bf16 v[212:215], a[104:107], a[48:51], v[212:215]
    v_mfma_f32_16x16x32_bf16 v[220:223], a[104:107], a[56:59], v[220:223]
    buffer_load_dwordx4 v17, s[40:43], s49 offen offset:3072 sc1 lds
    v_mfma_f32_16x16x32_bf16 v[220:223], a[108:111], a[60:63], v[220:223]
    s_add_u32 s49, s49, 128
    v_mfma_f32_16x16x32_bf16 v[216:219], a[100:103], a[60:63], v[216:219]
    buffer_store_dwordx4 a[220:223], v2, s[24:27], s28 offen sc1
    v_mfma_f32_16x16x32_bf16 v[216:219], a[96:99], a[56:59], v[216:219]
    s_add_u32 s29, s29, s30
    s_mov_b32 s28, s29
    v_mfma_f32_16x16x32_bf16 v[224:227], a[112:115], a[0:3], v[224:227]
    v_mfma_f32_16x16x32_bf16 v[224:227], a[116:119], a[4:7], v[224:227]
    ds_read_b64_tr_b16 a[96:97], v12 offset:0
    v_mfma_f32_16x16x32_bf16 v[228:231], a[124:127], a[4:7], v[228:231]
    v_mfma_f32_16x16x32_bf16 v[228:231], a[120:123], a[0:3], v[228:231]
    s_add_u32 m0, s61, 4096
    ds_read_b128 a[0:3], v6 offset:0
    v_mfma_f32_16x16x32_bf16 v[236:239], a[120:123], a[8:11], v[236:239]
    buffer_load_dwordx4 v16, s[40:43], s50 offen offset:0 sc1 lds
    v_mfma_f32_16x16x32_bf16 v[236:239], a[124:127], a[12:15], v[236:239]
    s_add_u32 s61, s61, 32768
    ds_read_b128 a[4:7], v7 offset:0
    v_mfma_f32_16x16x32_bf16 v[232:235], a[116:119], a[12:15], v[232:235]
    s_cmp_ge_u32 s61, 98304
    s_cselect_b32 s90, 98304, 0
    ds_read_b64_tr_b16 a[98:99], v12 offset:2048
    v_mfma_f32_16x16x32_bf16 v[232:235], a[112:115], a[8:11], v[232:235]
    s_sub_u32 s61, s61, s90
    ds_read_b128 a[8:11], v6 offset:2048
    v_mfma_f32_16x16x32_bf16 v[240:243], a[112:115], a[16:19], v[240:243]
    ds_read_b128 a[12:15], v7 offset:2048
    v_mfma_f32_16x16x32_bf16 v[240:243], a[116:119], a[20:23], v[240:243]
    ds_read_b64_tr_b16 a[100:101], v12 offset:16384
    v_mfma_f32_16x16x32_bf16 v[244:247], a[124:127], a[20:23], v[244:247]
    v_mfma_f32_16x16x32_bf16 v[244:247], a[120:123], a[16:19], v[244:247]
    ds_read_b128 a[16:19], v6 offset:4096
    v_mfma_f32_16x16x32_bf16 v[252:255], a[120:123], a[24:27], v[252:255]
    buffer_load_dwordx4 v17, s[40:43], s50 offen offset:1024 sc1 lds
    v_mfma_f32_16x16x32_bf16 v[252:255], a[124:127], a[28:31], v[252:255]
    s_add_u32 s50, s50, 128
    ds_read_b128 a[20:23], v7 offset:4096
    v_mfma_f32_16x16x32_bf16 v[248:251], a[116:119], a[28:31], v[248:251]
    ds_read_b64_tr_b16 a[102:103], v12 offset:18432
    v_mfma_f32_16x16x32_bf16 v[248:251], a[112:115], a[24:27], v[248:251]
    ds_read_b128 a[24:27], v6 offset:6144
    v_mfma_f32_16x16x32_bf16 a[224:227], a[112:115], a[32:35], a[224:227]
    s_sub_u32 s65, s65, 1
    ds_read_b128 a[28:31], v7 offset:6144
    v_mfma_f32_16x16x32_bf16 a[224:227], a[116:119], a[36:39], a[224:227]
    ds_read_b64_tr_b16 a[104:105], v13 offset:0
    v_mfma_f32_16x16x32_bf16 a[228:231], a[124:127], a[36:39], a[228:231]
    v_mfma_f32_16x16x32_bf16 a[228:231], a[120:123], a[32:35], a[228:231]
    ds_read_b128 a[32:35], v6 offset:8192
    v_mfma_f32_16x16x32_bf16 a[236:239], a[120:123], a[40:43], a[236:239]
    buffer_load_dwordx4 v16, s[40:43], s51 offen offset:2048 sc1 lds
    v_mfma_f32_16x16x32_bf16 a[236:239], a[124:127], a[44:47], a[236:239]
    ds_read_b128 a[36:39], v7 offset:8192
    v_mfma_f32_16x16x32_bf16 a[232:235], a[116:119], a[44:47], a[232:235]
    ds_read_b64_tr_b16 a[106:107], v13 offset:2048
    v_mfma_f32_16x16x32_bf16 a[232:235], a[112:115], a[40:43], a[232:235]
    ds_read_b128 a[40:43], v6 offset:10240
    v_mfma_f32_16x16x32_bf16 a[240:243], a[112:115], a[48:51], a[240:243]
    ds_read_b128 a[44:47], v7 offset:10240
    v_mfma_f32_16x16x32_bf16 a[240:243], a[116:119], a[52:55], a[240:243]
    ds_read_b64_tr_b16 a[108:109], v13 offset:16384
    v_mfma_f32_16x16x32_bf16 a[244:247], a[124:127], a[52:55], a[244:247]
    v_mfma_f32_16x16x32_bf16 a[244:247], a[120:123], a[48:51], a[244:247]
    ds_read_b128 a[48:51], v6 offset:12288
    v_mfma_f32_16x16x32_bf16 a[252:255], a[120:123], a[56:59], a[252:255]
    buffer_load_dwordx4 v17, s[40:43], s51 offen offset:3072 sc1 lds
    v_mfma_f32_16x16x32_bf16 a[252:255], a[124:127], a[60:63], a[252:255]
    s_add_u32 s51, s51, 128
    ds_read_b128 a[52:55], v7 offset:12288
    v_mfma_f32_16x16x32_bf16 a[248:251], a[116:119], a[60:63], a[248:251]
    ds_read_b64_tr_b16 a[110:111], v13 offset:18432
    v_mfma_f32_16x16x32_bf16 a[248:251], a[112:115], a[56:59], a[248:251]
    ds_read_b128 a[56:59], v6 offset:14336
    ds_read_b128 a[60:63], v7 offset:14336
.p2align 3
m_loop20:
    s_waitcnt lgkmcnt(15)
    v_mfma_f32_16x16x32_bf16 v[32:35], a[64:67], a[0:3], v[32:35]
    ds_read_b64_tr_b16 a[112:113], v14 offset:0
    v_mfma_f32_16x16x32_bf16 v[32:35], a[68:71], a[4:7], v[32:35]
    ds_read_b64_tr_b16 a[114:115], v14 offset:2048
    v_mfma_f32_16x16x32_bf16 v[36:39], a[76:79], a[4:7], v[36:39]
    ds_read_b64_tr_b16 a[116:117], v14 offset:16384
    v_mfma_f32_16x16x32_bf16 v[36:39], a[72:75], a[0:3], v[36:39]
    ds_read_b64_tr_b16 a[118:119], v14 offset:18432
    v_mfma_f32_16x16x32_bf16 v[44:47], a[72:75], a[8:11], v[44:47]
    ds_read_b64_tr_b16 a[120:121], v15 offset:0
    v_mfma_f32_16x16x32_bf16 v[44:47], a[76:79], a[12:15], v[44:47]
    ds_read_b64_tr_b16 a[122:123], v15 offset:2048
    v_mfma_f32_16x16x32_bf16 v[40:43], a[68:71], a[12:15], v[40:43]
    ds_read_b64_tr_b16 a[124:125], v15 offset:16384
    v_mfma_f32_16x16x32_bf16 v[40:43], a[64:67], a[8:11], v[40:43]
    ds_read_b64_tr_b16 a[126:127], v15 offset:18432
    v_mfma_f32_16x16x32_bf16 v[48:51], a[64:67], a[16:19], v[48:51]
    v_mfma_f32_16x16x32_bf16 v[48:51], a[68:71], a[20:23], v[48:51]
    v_mfma_f32_16x16x32_bf16 v[52:55], a[76:79], a[20:23], v[52:55]
    v_mfma_f32_16x16x32_bf16 v[52:55], a[72:75], a[16:19], v[52:55]
    s_waitcnt lgkmcnt(15)
    v_mfma_f32_16x16x32_bf16 v[60:63], a[72:75], a[24:27], v[60:63]
    v_xor_b32 v8, s60, v8
    v_xor_b32 v9, s60, v9
    v_mfma_f32_16x16x32_bf16 v[60:63], a[76:79], a[28:31], v[60:63]
    v_xor_b32 v10, s60, v10
    v_xor_b32 v11, s60, v11
    v_mfma_f32_16x16x32_bf16 v[56:59], a[68:71], a[28:31], v[56:59]
    v_xor_b32 v12, s60, v12
    v_xor_b32 v13, s60, v13
    v_mfma_f32_16x16x32_bf16 v[56:59], a[64:67], a[24:27], v[56:59]
    v_xor_b32 v14, s60, v14
    v_xor_b32 v15, s60, v15
    v_mfma_f32_16x16x32_bf16 v[64:67], a[64:67], a[32:35], v[64:67]
    v_mfma_f32_16x16x32_bf16 v[64:67], a[68:71], a[36:39], v[64:67]
    v_mfma_f32_16x16x32_bf16 v[68:71], a[76:79], a[36:39], v[68:71]
    v_mfma_f32_16x16x32_bf16 v[68:71], a[72:75], a[32:35], v[68:71]
    s_waitcnt lgkmcnt(14)
    v_mfma_f32_16x16x32_bf16 v[76:79], a[72:75], a[40:43], v[76:79]
    v_mfma_f32_16x16x32_bf16 v[76:79], a[76:79], a[44:47], v[76:79]
    v_mfma_f32_16x16x32_bf16 v[72:75], a[68:71], a[44:47], v[72:75]
    v_mfma_f32_16x16x32_bf16 v[72:75], a[64:67], a[40:43], v[72:75]
    s_waitcnt lgkmcnt(11)
    v_mfma_f32_16x16x32_bf16 v[80:83], a[64:67], a[48:51], v[80:83]
    v_mfma_f32_16x16x32_bf16 v[80:83], a[68:71], a[52:55], v[80:83]
    v_mfma_f32_16x16x32_bf16 v[84:87], a[76:79], a[52:55], v[84:87]
    v_mfma_f32_16x16x32_bf16 v[84:87], a[72:75], a[48:51], v[84:87]
    s_waitcnt lgkmcnt(8)
    v_mfma_f32_16x16x32_bf16 v[92:95], a[72:75], a[56:59], v[92:95]
    v_mfma_f32_16x16x32_bf16 v[92:95], a[76:79], a[60:63], v[92:95]
    v_mfma_f32_16x16x32_bf16 v[88:91], a[68:71], a[60:63], v[88:91]
    s_waitcnt vmcnt(8) lgkmcnt(0)
    v_mfma_f32_16x16x32_bf16 v[88:91], a[64:67], a[56:59], v[88:91]
    s_barrier
    v_mfma_f32_16x16x32_bf16 v[96:99], a[80:83], a[0:3], v[96:99]
    ds_read_b64_tr_b16 a[64:65], v8 offset:0
    v_mfma_f32_16x16x32_bf16 v[96:99], a[84:87], a[4:7], v[96:99]
    s_add_u32 m0, s62, 0
    v_mfma_f32_16x16x32_bf16 v[100:103], a[92:95], a[4:7], v[100:103]
    buffer_load_dwordx4 v18, s[44:47], s52 offen offset:0 sc1 lds
    v_mfma_f32_16x16x32_bf16 v[100:103], a[88:91], a[0:3], v[100:103]
    ds_read_b64_tr_b16 a[66:67], v8 offset:2048
    v_mfma_f32_16x16x32_bf16 v[108:111], a[88:91], a[8:11], v[108:111]
    s_add_u32 s64, s64, 32768
    v_mfma_f32_16x16x32_bf16 v[108:111], a[92:95], a[12:15], v[108:111]
    s_cmp_ge_u32 s64, 98304
    s_cselect_b32 s63, 4294901760, s59
    s_cselect_b32 s64, 0, s64
    v_mfma_f32_16x16x32_bf16 v[104:107], a[84:87], a[12:15], v[104:107]
    buffer_load_dwordx4 v19, s[44:47], s52 offen offset:1024 sc1 lds
    v_mfma_f32_16x16x32_bf16 v[104:107], a[80:83], a[8:11], v[104:107]
    s_add_u32 s52, s52, s56
    ds_read_b64_tr_b16 a[68:69], v8 offset:16384
    v_mfma_f32_16x16x32_bf16 v[112:115], a[80:83], a[16:19], v[112:115]
    v_mfma_f32_16x16x32_bf16 v[112:115], a[84:87], a[20:23], v[112:115]
    v_mfma_f32_16x16x32_bf16 v[116:119], a[92:95], a[20:23], v[116:119]
    buffer_load_dwordx4 v18, s[44:47], s53 offen offset:2048 sc1 lds
    v_mfma_f32_16x16x32_bf16 v[116:119], a[88:91], a[16:19], v[116:119]
    ds_read_b64_tr_b16 a[70:71], v8 offset:18432
    v_mfma_f32_16x16x32_bf16 v[124:127], a[88:91], a[24:27], v[124:127]
    v_mfma_f32_16x16x32_bf16 v[124:127], a[92:95], a[28:31], v[124:127]
    v_mfma_f32_16x16x32_bf16 v[120:123], a[84:87], a[28:31], v[120:123]
    buffer_load_dwordx4 v19, s[44:47], s53 offen offset:3072 sc1 lds
    v_mfma_f32_16x16x32_bf16 v[120:123], a[80:83], a[24:27], v[120:123]
    s_add_u32 s53, s53, s56
    ds_read_b64_tr_b16 a[72:73], v9 offset:0
    v_mfma_f32_16x16x32_bf16 v[128:131], a[80:83], a[32:35], v[128:131]
    v_mfma_f32_16x16x32_bf16 v[128:131], a[84:87], a[36:39], v[128:131]
    s_add_u32 m0, s62, 4096
    v_mfma_f32_16x16x32_bf16 v[132:135], a[92:95], a[36:39], v[132:135]
    buffer_load_dwordx4 v20, s[44:47], s54 offen offset:0 sc1 lds
    v_mfma_f32_16x16x32_bf16 v[132:135], a[88:91], a[32:35], v[132:135]
    s_xor_b32 s62, s62, 229376
    ds_read_b64_tr_b16 a[74:75], v9 offset:2048
    v_mfma_f32_16x16x32_bf16 v[140:143], a[88:91], a[40:43], v[140:143]
    v_mfma_f32_16x16x32_bf16 v[140:143], a[92:95], a[44:47], v[140:143]
    v_mfma_f32_16x16x32_bf16 v[136:139], a[84:87], a[44:47], v[136:139]
    buffer_load_dwordx4 v21, s[44:47], s54 offen offset:1024 sc1 lds
    v_mfma_f32_16x16x32_bf16 v[136:139], a[80:83], a[40:43], v[136:139]
    s_add_u32 s54, s54, s56
    ds_read_b64_tr_b16 a[76:77], v9 offset:16384
    v_mfma_f32_16x16x32_bf16 v[144:147], a[80:83], a[48:51], v[144:147]
    v_mfma_f32_16x16x32_bf16 v[144:147], a[84:87], a[52:55], v[144:147]
    v_mfma_f32_16x16x32_bf16 v[148:151], a[92:95], a[52:55], v[148:151]
    buffer_load_dwordx4 v20, s[44:47], s55 offen offset:2048 sc1 lds
    v_mfma_f32_16x16x32_bf16 v[148:151], a[88:91], a[48:51], v[148:151]
    ds_read_b64_tr_b16 a[78:79], v9 offset:18432
    v_mfma_f32_16x16x32_bf16 v[156:159], a[88:91], a[56:59], v[156:159]
    v_add_u32 v6, s63, v6
    v_add_u32 v7, s63, v7
    v_mfma_f32_16x16x32_bf16 v[156:159], a[92:95], a[60:63], v[156:159]
    v_mfma_f32_16x16x32_bf16 v[152:155], a[84:87], a[60:63], v[152:155]
    buffer_load_dwordx4 v21, s[44:47], s55 offen offset:3072 sc1 lds
    v_mfma_f32_16x16x32_bf16 v[152:155], a[80:83], a[56:59], v[152:155]
    s_add_u32 s55, s55, s56
    v_mfma_f32_16x16x32_bf16 v[160:163], a[96:99], a[0:3], v[160:163]
    ds_read_b64_tr_b16 a[80:81], v10 offset:0
    v_mfma_f32_16x16x32_bf16 v[160:163], a[100:103], a[4:7], v[160:163]
    v_mfma_f32_16x16x32_bf16 v[164:167], a[108:111], a[4:7], v[164:167]
    v_mfma_f32_16x16x32_bf16 v[164:167], a[104:107], a[0:3], v[164:167]
    s_add_u32 m0, s61, 0
    ds_read_b64_tr_b16 a[82:83], v10 offset:2048
    v_mfma_f32_16x16x32_bf16 v[172:175], a[104:107], a[8:11], v[172:175]
    buffer_load_dwordx4 v16, s[40:43], s48 offen offset:0 sc1 lds
    v_mfma_f32_16x16x32_bf16 v[172:175], a[108:111], a[12:15], v[172:175]
    v_mfma_f32_16x16x32_bf16 v[168:171], a[100:103], a[12:15], v[168:171]
    ds_read_b64_tr_b16 a[84:85], v10 offset:16384
    v_mfma_f32_16x16x32_bf16 v[168:171], a[96:99], a[8:11], v[168:171]
    v_mfma_f32_16x16x32_bf16 v[176:179], a[96:99], a[16:19], v[176:179]
    v_mfma_f32_16x16x32_bf16 v[176:179], a[100:103], a[20:23], v[176:179]
    ds_read_b64_tr_b16 a[86:87], v10 offset:18432
    v_mfma_f32_16x16x32_bf16 v[180:183], a[108:111], a[20:23], v[180:183]
    v_mfma_f32_16x16x32_bf16 v[180:183], a[104:107], a[16:19], v[180:183]
    v_mfma_f32_16x16x32_bf16 v[188:191], a[104:107], a[24:27], v[188:191]
    buffer_load_dwordx4 v17, s[40:43], s48 offen offset:1024 sc1 lds
    v_mfma_f32_16x16x32_bf16 v[188:191], a[108:111], a[28:31], v[188:191]
    s_add_u32 s48, s48, 128
    ds_read_b64_tr_b16 a[88:89], v11 offset:0
    v_mfma_f32_16x16x32_bf16 v[184:187], a[100:103], a[28:31], v[184:187]
    v_mfma_f32_16x16x32_bf16 v[184:187], a[96:99], a[24:27], v[184:187]
    v_mfma_f32_16x16x32_bf16 v[192:195], a[96:99], a[32:35], v[192:195]
    v_mfma_f32_16x16x32_bf16 v[192:195], a[100:103], a[36:39], v[192:195]
    ds_read_b64_tr_b16 a[90:91], v11 offset:2048
    v_mfma_f32_16x16x32_bf16 v[196:199], a[108:111], a[36:39], v[196:199]
    v_mfma_f32_16x16x32_bf16 v[196:199], a[104:107], a[32:35], v[196:199]
    v_mfma_f32_16x16x32_bf16 v[204:207], a[104:107], a[40:43], v[204:207]
    buffer_load_dwordx4 v16, s[40:43], s49 offen offset:2048 sc1 lds
    v_mfma_f32_16x16x32_bf16 v[204:207], a[108:111], a[44:47], v[204:207]
    ds_read_b64_tr_b16 a[92:93], v11 offset:16384
    v_mfma_f32_16x16x32_bf16 v[200:203], a[100:103], a[44:47], v[200:203]
    v_mfma_f32_16x16x32_bf16 v[200:203], a[96:99], a[40:43], v[200:203]
    v_mfma_f32_16x16x32_bf16 v[208:211], a[96:99], a[48:51], v[208:211]
    v_mfma_f32_16x16x32_bf16 v[208:211], a[100:103], a[52:55], v[208:211]
    ds_read_b64_tr_b16 a[94:95], v11 offset:18432
    v_mfma_f32_16x16x32_bf16 v[212:215], a[108:111], a[52:55], v[212:215]
    v_mfma_f32_16x16x32_bf16 v[212:215], a[104:107], a[48:51], v[212:215]
    v_mfma_f32_16x16x32_bf16 v[220:223], a[104:107], a[56:59], v[220:223]
    buffer_load_dwordx4 v17, s[40:43], s49 offen offset:3072 sc1 lds
    v_mfma_f32_16x16x32_bf16 v[220:223], a[108:111], a[60:63], v[220:223]
    s_add_u32 s49, s49, 128
    v_mfma_f32_16x16x32_bf16 v[216:219], a[100:103], a[60:63], v[216:219]
    v_mfma_f32_16x16x32_bf16 v[216:219], a[96:99], a[56:59], v[216:219]
    v_mfma_f32_16x16x32_bf16 v[224:227], a[112:115], a[0:3], v[224:227]
    v_mfma_f32_16x16x32_bf16 v[224:227], a[116:119], a[4:7], v[224:227]
    ds_read_b64_tr_b16 a[96:97], v12 offset:0
    v_mfma_f32_16x16x32_bf16 v[228:231], a[124:127], a[4:7], v[228:231]
    v_mfma_f32_16x16x32_bf16 v[228:231], a[120:123], a[0:3], v[228:231]
    s_add_u32 m0, s61, 4096
    ds_read_b128 a[0:3], v6 offset:0
    v_mfma_f32_16x16x32_bf16 v[236:239], a[120:123], a[8:11], v[236:239]
    buffer_load_dwordx4 v16, s[40:43], s50 offen offset:0 sc1 lds
    v_mfma_f32_16x16x32_bf16 v[236:239], a[124:127], a[12:15], v[236:239]
    s_add_u32 s61, s61, 32768
    ds_read_b128 a[4:7], v7 offset:0
    v_mfma_f32_16x16x32_bf16 v[232:235], a[116:119], a[12:15], v[232:235]
    s_cmp_ge_u32 s61, 98304
    s_cselect_b32 s90, 98304, 0
    ds_read_b64_tr_b16 a[98:99], v12 offset:2048
    v_mfma_f32_16x16x32_bf16 v[232:235], a[112:115], a[8:11], v[232:235]
    s_sub_u32 s61, s61, s90
    ds_read_b128 a[8:11], v6 offset:2048
    v_mfma_f32_16x16x32_bf16 v[240:243], a[112:115], a[16:19], v[240:243]
    ds_read_b128 a[12:15], v7 offset:2048
    v_mfma_f32_16x16x32_bf16 v[240:243], a[116:119], a[20:23], v[240:243]
    ds_read_b64_tr_b16 a[100:101], v12 offset:16384
    v_mfma_f32_16x16x32_bf16 v[244:247], a[124:127], a[20:23], v[244:247]
    v_mfma_f32_16x16x32_bf16 v[244:247], a[120:123], a[16:19], v[244:247]
    ds_read_b128 a[16:19], v6 offset:4096
    v_mfma_f32_16x16x32_bf16 v[252:255], a[120:123], a[24:27], v[252:255]
    buffer_load_dwordx4 v17, s[40:43], s50 offen offset:1024 sc1 lds
    v_mfma_f32_16x16x32_bf16 v[252:255], a[124:127], a[28:31], v[252:255]
    s_add_u32 s50, s50, 128
    ds_read_b128 a[20:23], v7 offset:4096
    v_mfma_f32_16x16x32_bf16 v[248:251], a[116:119], a[28:31], v[248:251]
    ds_read_b64_tr_b16 a[102:103], v12 offset:18432
    v_mfma_f32_16x16x32_bf16 v[248:251], a[112:115], a[24:27], v[248:251]
    ds_read_b128 a[24:27], v6 offset:6144
    v_mfma_f32_16x16x32_bf16 a[224:227], a[112:115], a[32:35], a[224:227]
    s_sub_u32 s65, s65, 1
    ds_read_b128 a[28:31], v7 offset:6144
    v_mfma_f32_16x16x32_bf16 a[224:227], a[116:119], a[36:39], a[224:227]
    ds_read_b64_tr_b16 a[104:105], v13 offset:0
    v_mfma_f32_16x16x32_bf16 a[228:231], a[124:127], a[36:39], a[228:231]
    v_mfma_f32_16x16x32_bf16 a[228:231], a[120:123], a[32:35], a[228:231]
    ds_read_b128 a[32:35], v6 offset:8192
    v_mfma_f32_16x16x32_bf16 a[236:239], a[120:123], a[40:43], a[236:239]
    buffer_load_dwordx4 v16, s[40:43], s51 offen offset:2048 sc1 lds
    v_mfma_f32_16x16x32_bf16 a[236:239], a[124:127], a[44:47], a[236:239]
    ds_read_b128 a[36:39], v7 offset:8192
    v_mfma_f32_16x16x32_bf16 a[232:235], a[116:119], a[44:47], a[232:235]
    ds_read_b64_tr_b16 a[106:107], v13 offset:2048
    v_mfma_f32_16x16x32_bf16 a[232:235], a[112:115], a[40:43], a[232:235]
    ds_read_b128 a[40:43], v6 offset:10240
    v_mfma_f32_16x16x32_bf16 a[240:243], a[112:115], a[48:51], a[240:243]
    ds_read_b128 a[44:47], v7 offset:10240
    v_mfma_f32_16x16x32_bf16 a[240:243], a[116:119], a[52:55], a[240:243]
    ds_read_b64_tr_b16 a[108:109], v13 offset:16384
    v_mfma_f32_16x16x32_bf16 a[244:247], a[124:127], a[52:55], a[244:247]
    v_mfma_f32_16x16x32_bf16 a[244:247], a[120:123], a[48:51], a[244:247]
    ds_read_b128 a[48:51], v6 offset:12288
    v_mfma_f32_16x16x32_bf16 a[252:255], a[120:123], a[56:59], a[252:255]
    buffer_load_dwordx4 v17, s[40:43], s51 offen offset:3072 sc1 lds
    v_mfma_f32_16x16x32_bf16 a[252:255], a[124:127], a[60:63], a[252:255]
    s_add_u32 s51, s51, 128
    ds_read_b128 a[52:55], v7 offset:12288
    v_mfma_f32_16x16x32_bf16 a[248:251], a[116:119], a[60:63], a[248:251]
    s_cmp_gt_u32 s65, s67
    ds_read_b64_tr_b16 a[110:111], v13 offset:18432
    v_mfma_f32_16x16x32_bf16 a[248:251], a[112:115], a[56:59], a[248:251]
    ds_read_b128 a[56:59], v6 offset:14336
    ds_read_b128 a[60:63], v7 offset:14336
    s_cbranch_scc1 m_loop20
    s_cmp_eq_u32 s65, 0
    s_cbranch_scc1 m_epi15
m_dosw21:
    s_cmp_eq_u32 s94, 0
    s_cbranch_scc1 m_x39
    s_cmp_lg_u32 s65, 3
    s_cbranch_scc1 m_x45
    s_mov_b32 s42, s73
    s_lshl_b32 s90, s77, 4
    s_lshl_b32 s90, s90, s81
    s_mov_b32 s48, s79
    s_mul_i32 s91, s90, 1
    s_add_u32 s49, s91, s79
    s_sub_u32 s49, s49, 2048
    s_mul_i32 s91, s90, 2
    s_add_u32 s50, s91, s79
    s_mul_i32 s91, s90, 3
    s_add_u32 s51, s91, s79
    s_sub_u32 s51, s51, 2048
    s_lshl_b32 s90, s58, 7
    s_add_u32 s90, s90, s57
    s_lshl_b32 s91, s16, 6
    s_cmp_eq_u32 s81, 1
    s_cselect_b32 s90, s90, s91
    v_lshrrev_b32 v24, 3, v1
    v_lshlrev_b32 v24, s81, v24
    v_add_u32 v24, s90, v24
    v_mul_lo_u32 v24, v24, s77
    v_lshrrev_b32 v25, 4, v1
    v_and_b32 v26, 7, v1
    v_xor_b32 v25, v25, v26
    v_lshl_add_u32 v16, v25, 4, v24
    v_xor_b32 v25, 4, v25
    v_lshl_add_u32 v17, v25, 4, v24
    s_lshl_b32 s90, s77, 3
    s_lshl_b32 s90, s90, s81
    s_sub_u32 s90, s90, 1024
    v_add_u32 v17, s90, v17
    s_mov_b32 s40, s71
    s_mov_b32 s41, s72
    buffer_load_dwordx2 v[4:5], off, s[12:15], 0 sc1
    s_branch m_loop20
m_x45:
    s_mov_b32 s46, s76
    s_mov_b32 s52, s80
    s_lshl_b32 s90, s78, 2
    s_mul_i32 s91, s90, 1
    s_add_u32 s53, s91, s80
    s_sub_u32 s53, s53, 2048
    s_mul_i32 s91, s90, 2
    s_add_u32 s54, s91, s80
    s_mul_i32 s91, s90, 3
    s_add_u32 s55, s91, s80
    s_sub_u32 s55, s55, 2048
    s_lshl_b32 s56, s78, 6
    v_lshrrev_b32 v24, 5, v1
    s_lshl_b32 s90, s16, 4
    v_add_u32 v25, s90, v24
    v_mul_lo_u32 v25, v25, s78
    v_lshlrev_b32 v24, 1, v24
    v_and_b32 v26, 31, v1
    v_xor_b32 v24, v24, v26
    s_lshl_b32 s90, s78, 1
    s_sub_u32 s90, s90, 1024
    v_add_u32 v27, s90, v25
    v_xor_b32 v26, 0, v24
    v_lshl_add_u32 v18, v26, 4, v25
    v_xor_b32 v26, 4, v24
    v_lshl_add_u32 v19, v26, 4, v27
    v_xor_b32 v26, 8, v24
    v_lshl_add_u32 v20, v26, 4, v25
    v_xor_b32 v26, 12, v24
    v_lshl_add_u32 v21, v26, 4, v27
    s_mov_b32 s44, s74
    s_mov_b32 s45, s75
    s_mov_b32 s67, 0
    s_branch m_loop20
m_x39:
    s_cmp_le_u32 s65, 4
    s_cbranch_scc1 m_x40
    s_cmp_lg_u32 s16, 0
    s_cbranch_scc1 m_np46
    v_mov_b32 v4, s4
    v_mov_b32 v5, s5
    s_add_u32 s90, s17, 117440512
    s_mov_b64 exec, 1
    buffer_store_dwordx2 v[4:5], off, s[8:11], s90 sc1
    s_mov_b64 exec, -1
m_np46:
    s_mov_b32 s17, -1
    s_mov_b32 s67, 4
    s_branch m_loop20
m_x40:
    s_cmp_lg_u32 s65, 4
    s_cbranch_scc1 m_x41
    s_cmp_eq_u32 s70, 1
    s_cbranch_scc1 m_ea47
    buffer_load_dwordx2 v[4:5], v0, s[8:11], s37 offen sc1
m_eb48:
    s_branch m_loop20
m_x41:
    s_waitcnt vmcnt(16)
    s_cmp_lg_u32 s65, 3
    s_cbranch_scc1 m_x42
    s_cmp_eq_u32 s70, 1
    s_cbranch_scc1 m_ea49
    s_mov_b32 s3, 262144
m_spin51:
    v_cmp_ne_u64 s[22:23], s[4:5], v[4:5]
    s_nop 3
    s_cmp_eq_u64 s[22:23], 0
    s_cbranch_scc1 m_ok52
    s_sub_u32 s3, s3, 1
    s_cbranch_scc1 m_ok52
    s_sleep 16
    buffer_load_dwordx2 v[4:5], v0, s[8:11], s37 offen sc1
    s_waitcnt vmcnt(0)
    s_branch m_spin51
m_ok52:
    buffer_load_dwordx4 a[128:131], v2, s[8:11], s33 offen offset:0 sc1
    buffer_load_dwordx4 a[132:135], v2, s[8:11], s33 offen offset:1024 sc1
    buffer_load_dwordx4 a[136:139], v2, s[8:11], s33 offen offset:2048 sc1
    buffer_load_dwordx4 a[140:143], v2, s[8:11], s33 offen offset:3072 sc1
    buffer_load_dwordx4 a[144:147], v2, s[8:11], s34 offen offset:0 sc1
    buffer_load_dwordx4 a[148:151], v2, s[8:11], s34 offen offset:1024 sc1
m_eb50:
    s_add_u32 s48, s32, 0
    s_mov_b32 s49, s48
    s_add_u32 s50, s48, 4096
    s_mov_b32 s51, s50
    s_cmp_eq_u32 s57, 0
    s_cselect_b32 s42, 268435456, 0
    s_mov_b32 s40, s6
    s_mov_b32 s41, s7
    v_mov_b32 v16, v2
    v_mov_b32 v17, v2
    s_branch m_loop20
m_x42:
    s_cmp_lg_u32 s65, 2
    s_cbranch_scc1 m_x43
    s_cmp_eq_u32 s70, 1
    s_cbranch_scc1 m_ea53
    buffer_load_dwordx4 a[152:155], v2, s[8:11], s34 offen offset:2048 sc1
    buffer_load_dwordx4 a[156:159], v2, s[8:11], s34 offen offset:3072 sc1
    buffer_load_dwordx4 a[160:163], v2, s[8:11], s35 offen offset:0 sc1
    buffer_load_dwordx4 a[164:167], v2, s[8:11], s35 offen offset:1024 sc1
    buffer_load_dwordx4 a[168:171], v2, s[8:11], s35 offen offset:2048 sc1
m_eb54:
    s_add_u32 s48, s32, 16384
    s_mov_b32 s49, s48
    s_add_u32 s50, s48, 4096
    s_mov_b32 s51, s50
    s_mov_b32 s42, 268435456
    s_add_u32 s52, s32, 49152
    s_mov_b32 s53, s52
    s_add_u32 s54, s52, 4096
    s_mov_b32 s55, s54
    s_mov_b32 s46, 268435456
    s_mov_b32 s44, s6
    s_mov_b32 s45, s7
    v_mov_b32 v18, v2
    v_mov_b32 v19, v2
    v_mov_b32 v20, v2
    v_mov_b32 v21, v2
    s_branch m_loop20
m_x43:
    s_cmp_eq_u32 s70, 1
    s_cbranch_scc1 m_ea55
    buffer_load_dwordx4 a[172:175], v2, s[8:11], s35 offen offset:3072 sc1
    buffer_load_dwordx4 a[176:179], v2, s[8:11], s36 offen offset:0 sc1
    buffer_load_dwordx4 a[180:183], v2, s[8:11], s36 offen offset:1024 sc1
    buffer_load_dwordx4 a[184:187], v2, s[8:11], s36 offen offset:2048 sc1
    buffer_load_dwordx4 a[188:191], v2, s[8:11], s36 offen offset:3072 sc1
m_eb56:
    s_add_u32 s48, s32, 32768
    s_mov_b32 s49, s48
    s_add_u32 s50, s48, 4096
    s_mov_b32 s51, s50
    s_add_u32 s52, s32, 65536
    s_mov_b32 s53, s52
    s_add_u32 s54, s52, 4096
    s_mov_b32 s55, s54
    s_branch m_loop20
m_ea47:
    s_and_b32 s92, s2, 7
    s_lshl_b32 s92, s92, 2
    s_bfe_u32 s93, s2, 0x20003
    s_add_u32 s92, s92, s93
    s_lshr_b32 s93, s2, 5
    s_lshl_b32 s93, s93, 2
    s_or_b32 s93, s93, 0x40000
    v_and_b32 v0, 3, v1
    v_min_u32 v0, 2, v0
    v_and_b32 v24, 4, v1
    v_add3_u32 v0, v0, v24, 8
    v_lshlrev_b32 v0, 3, v0
    buffer_load_dwordx2 v[4:5], v0, s[8:11], s37 offen sc1
    s_branch m_eb48
m_ea49:
    s_mov_b32 s3, 262144
m_spin57:
    v_cmp_ne_u64 s[22:23], s[4:5], v[4:5]
    s_nop 3
    s_cmp_eq_u64 s[22:23], 0
    s_cbranch_scc1 m_ok58
    s_sub_u32 s3, s3, 1
    s_cbranch_scc1 m_ok58
    s_sleep 16
    buffer_load_dwordx2 v[4:5], v0, s[8:11], s37 offen sc1
    s_waitcnt vmcnt(0)
    s_branch m_spin57
m_ok58:
    s_branch m_eb50
m_ea53:
    s_and_b32 s92, s2, 7
    s_lshl_b32 s92, s92, 2
    s_bfe_u32 s93, s2, 0x20003
    s_add_u32 s92, s92, s93
    s_lshr_b32 s93, s2, 5
    s_lshl_b32 s93, s93, 2
    s_or_b32 s93, s93, 0x40000
    s_bfe_u32 s91, 873484918, s93
    s_lshr_b32 s91, s91, 1
    v_mov_b32 v0, s91
    s_bfe_u32 s91, 4225674377, s93
    s_lshr_b32 s91, s91, 1
    v_writelane_b32 v0, s91, 8
    v_lshlrev_b32 v0, 3, v0
    buffer_load_dwordx2 v[4:5], v0, s[8:11], s37 offen sc1
    s_branch m_eb54
m_ea55:
    s_mov_b32 s3, 262144
m_spin59:
    v_cmp_ne_u64 s[22:23], s[4:5], v[4:5]
    s_nop 3
    s_cmp_eq_u64 s[22:23], 0
    s_cbranch_scc1 m_ok60
    s_sub_u32 s3, s3, 1
    s_cbranch_scc1 m_ok60
    s_sleep 16
    buffer_load_dwordx2 v[4:5], v0, s[8:11], s37 offen sc1
    s_waitcnt vmcnt(0)
    s_branch m_spin59
m_ok60:
    buffer_load_dwordx4 a[128:131], v2, s[8:11], s33 offen offset:0 sc1
    buffer_load_dwordx4 a[132:135], v2, s[8:11], s33 offen offset:1024 sc1
    buffer_load_dwordx4 a[136:139], v2, s[8:11], s33 offen offset:2048 sc1
    buffer_load_dwordx4 a[140:143], v2, s[8:11], s33 offen offset:3072 sc1
    buffer_load_dwordx4 a[144:147], v2, s[8:11], s34 offen offset:0 sc1
    buffer_load_dwordx4 a[148:151], v2, s[8:11], s34 offen offset:1024 sc1
    buffer_load_dwordx4 a[152:155], v2, s[8:11], s34 offen offset:2048 sc1
    buffer_load_dwordx4 a[156:159], v2, s[8:11], s34 offen offset:3072 sc1
    buffer_load_dwordx4 a[160:163], v2, s[8:11], s35 offen offset:0 sc1
    buffer_load_dwordx4 a[164:167], v2, s[8:11], s35 offen offset:1024 sc1
    buffer_load_dwordx4 a[168:171], v2, s[8:11], s35 offen offset:2048 sc1
    buffer_load_dwordx4 a[172:175], v2, s[8:11], s35 offen offset:3072 sc1
    buffer_load_dwordx4 a[176:179], v2, s[8:11], s36 offen offset:0 sc1
    buffer_load_dwordx4 a[180:183], v2, s[8:11], s36 offen offset:1024 sc1
    buffer_load_dwordx4 a[184:187], v2, s[8:11], s36 offen offset:2048 sc1
    buffer_load_dwordx4 a[188:191], v2, s[8:11], s36 offen offset:3072 sc1
    s_branch m_eb56
m_swp16:
    s_waitcnt lgkmcnt(15)
    v_mfma_f32_16x16x32_bf16 v[32:35], a[0:3], a[64:67], 0
    ds_read_b64_tr_b16 a[112:113], v14 offset:0
    v_mfma_f32_16x16x32_bf16 v[32:35], a[4:7], a[68:71], v[32:35]
    ds_read_b64_tr_b16 a[114:115], v14 offset:2048
    v_mfma_f32_16x16x32_bf16 v[40:43], a[4:7], a[76:79], 0
    ds_read_b64_tr_b16 a[116:117], v14 offset:16384
    v_mfma_f32_16x16x32_bf16 v[40:43], a[0:3], a[72:75], v[40:43]
    ds_read_b64_tr_b16 a[118:119], v14 offset:18432
    v_mfma_f32_16x16x32_bf16 v[44:47], a[8:11], a[72:75], 0
    ds_read_b64_tr_b16 a[120:121], v15 offset:0
    v_mfma_f32_16x16x32_bf16 v[44:47], a[12:15], a[76:79], v[44:47]
    ds_read_b64_tr_b16 a[122:123], v15 offset:2048
    v_mfma_f32_16x16x32_bf16 v[36:39], a[12:15], a[68:71], 0
    ds_read_b64_tr_b16 a[124:125], v15 offset:16384
    v_mfma_f32_16x16x32_bf16 v[36:39], a[8:11], a[64:67], v[36:39]
    ds_read_b64_tr_b16 a[126:127], v15 offset:18432
    v_mfma_f32_16x16x32_bf16 v[96:99], a[16:19], a[64:67], 0
    v_mfma_f32_16x16x32_bf16 v[96:99], a[20:23], a[68:71], v[96:99]
    v_mfma_f32_16x16x32_bf16 v[104:107], a[20:23], a[76:79], 0
    buffer_store_dwordx4 a[128:131], v2, s[24:27], s28 offen sc1
    v_mfma_f32_16x16x32_bf16 v[104:107], a[16:19], a[72:75], v[104:107]
    s_add_u32 s28, s28, s31
    s_waitcnt lgkmcnt(15)
    v_mfma_f32_16x16x32_bf16 v[108:111], a[24:27], a[72:75], 0
    v_xor_b32 v8, s60, v8
    v_xor_b32 v9, s60, v9
    v_mfma_f32_16x16x32_bf16 v[108:111], a[28:31], a[76:79], v[108:111]
    v_xor_b32 v10, s60, v10
    v_xor_b32 v11, s60, v11
    v_mfma_f32_16x16x32_bf16 v[100:103], a[28:31], a[68:71], 0
    v_xor_b32 v12, s60, v12
    v_xor_b32 v13, s60, v13
    v_mfma_f32_16x16x32_bf16 v[100:103], a[24:27], a[64:67], v[100:103]
    v_xor_b32 v14, s60, v14
    v_xor_b32 v15, s60, v15
    v_mfma_f32_16x16x32_bf16 v[160:163], a[32:35], a[64:67], 0
    buffer_store_dwordx4 a[132:135], v2, s[24:27], s28 offen sc1
    v_mfma_f32_16x16x32_bf16 v[160:163], a[36:39], a[68:71], v[160:163]
    s_add_u32 s28, s28, s31
    v_mfma_f32_16x16x32_bf16 v[168:171], a[36:39], a[76:79], 0
    v_mfma_f32_16x16x32_bf16 v[168:171], a[32:35], a[72:75], v[168:171]
    s_waitcnt lgkmcnt(14)
    v_mfma_f32_16x16x32_bf16 v[172:175], a[40:43], a[72:75], 0
    v_mfma_f32_16x16x32_bf16 v[172:175], a[44:47], a[76:79], v[172:175]
    v_mfma_f32_16x16x32_bf16 v[164:167], a[44:47], a[68:71], 0
    buffer_store_dwordx4 a[136:139], v2, s[24:27], s28 offen sc1
    v_mfma_f32_16x16x32_bf16 v[164:167], a[40:43], a[64:67], v[164:167]
    s_add_u32 s28, s28, s31
    s_waitcnt lgkmcnt(11)
    v_mfma_f32_16x16x32_bf16 v[224:227], a[48:51], a[64:67], 0
    v_mfma_f32_16x16x32_bf16 v[224:227], a[52:55], a[68:71], v[224:227]
    v_mfma_f32_16x16x32_bf16 v[232:235], a[52:55], a[76:79], 0
    v_mfma_f32_16x16x32_bf16 v[232:235], a[48:51], a[72:75], v[232:235]
    s_waitcnt lgkmcnt(8)
    v_mfma_f32_16x16x32_bf16 v[236:239], a[56:59], a[72:75], 0
    buffer_store_dwordx4 a[140:143], v2, s[24:27], s28 offen sc1
    v_mfma_f32_16x16x32_bf16 v[236:239], a[60:63], a[76:79], v[236:239]
    s_add_u32 s28, s28, s31
    v_mfma_f32_16x16x32_bf16 v[228:231], a[60:63], a[68:71], 0
    s_waitcnt vmcnt(44) lgkmcnt(0)
    s_cmp_eq_u32 s66, 2
    s_cbranch_scc1 m_w22
    s_waitcnt vmcnt(12)
m_w22:
    v_mfma_f32_16x16x32_bf16 v[228:231], a[56:59], a[64:67], v[228:231]
    s_barrier
    v_mfma_f32_16x16x32_bf16 v[48:51], a[0:3], a[80:83], 0
    ds_read_b64_tr_b16 a[64:65], v8 offset:0
    v_mfma_f32_16x16x32_bf16 v[48:51], a[4:7], a[84:87], v[48:51]
    s_add_u32 m0, s62, 0
    v_mfma_f32_16x16x32_bf16 v[56:59], a[4:7], a[92:95], 0
    buffer_load_dwordx4 v18, s[44:47], s52 offen offset:0 sc1 lds
    v_mfma_f32_16x16x32_bf16 v[56:59], a[0:3], a[88:91], v[56:59]
    ds_read_b64_tr_b16 a[66:67], v8 offset:2048
    v_mfma_f32_16x16x32_bf16 v[60:63], a[8:11], a[88:91], 0
    s_add_u32 s64, s64, 32768
    v_mfma_f32_16x16x32_bf16 v[60:63], a[12:15], a[92:95], v[60:63]
    s_cmp_ge_u32 s64, 98304
    s_cselect_b32 s63, 4294901760, s59
    s_cselect_b32 s64, 0, s64
    v_mfma_f32_16x16x32_bf16 v[52:55], a[12:15], a[84:87], 0
    buffer_load_dwordx4 v19, s[44:47], s52 offen offset:1024 sc1 lds
    v_mfma_f32_16x16x32_bf16 v[52:55], a[8:11], a[80:83], v[52:55]
    s_add_u32 s52, s52, s56
    ds_read_b64_tr_b16 a[68:69], v8 offset:16384
    v_mfma_f32_16x16x32_bf16 v[112:115], a[16:19], a[80:83], 0
    v_mfma_f32_16x16x32_bf16 v[112:115], a[20:23], a[84:87], v[112:115]
    v_mfma_f32_16x16x32_bf16 v[120:123], a[20:23], a[92:95], 0
    buffer_load_dwordx4 v18, s[44:47], s53 offen offset:2048 sc1 lds
    v_mfma_f32_16x16x32_bf16 v[120:123], a[16:19], a[88:91], v[120:123]
    ds_read_b64_tr_b16 a[70:71], v8 offset:18432
    v_mfma_f32_16x16x32_bf16 v[124:127], a[24:27], a[88:91], 0
    v_mfma_f32_16x16x32_bf16 v[124:127], a[28:31], a[92:95], v[124:127]
    v_mfma_f32_16x16x32_bf16 v[116:119], a[28:31], a[84:87], 0
    buffer_load_dwordx4 v19, s[44:47], s53 offen offset:3072 sc1 lds
    v_mfma_f32_16x16x32_bf16 v[116:119], a[24:27], a[80:83], v[116:119]
    s_add_u32 s53, s53, s56
    ds_read_b64_tr_b16 a[72:73], v9 offset:0
    v_mfma_f32_16x16x32_bf16 v[176:179], a[32:35], a[80:83], 0
    v_mfma_f32_16x16x32_bf16 v[176:179], a[36:39], a[84:87], v[176:179]
    s_add_u32 m0, s62, 4096
    v_mfma_f32_16x16x32_bf16 v[184:187], a[36:39], a[92:95], 0
    buffer_load_dwordx4 v20, s[44:47], s54 offen offset:0 sc1 lds
    v_mfma_f32_16x16x32_bf16 v[184:187], a[32:35], a[88:91], v[184:187]
    s_xor_b32 s62, s62, 229376
    ds_read_b64_tr_b16 a[74:75], v9 offset:2048
    v_mfma_f32_16x16x32_bf16 v[188:191], a[40:43], a[88:91], 0
    v_mfma_f32_16x16x32_bf16 v[188:191], a[44:47], a[92:95], v[188:191]
    v_mfma_f32_16x16x32_bf16 v[180:183], a[44:47], a[84:87], 0
    buffer_load_dwordx4 v21, s[44:47], s54 offen offset:1024 sc1 lds
    v_mfma_f32_16x16x32_bf16 v[180:183], a[40:43], a[80:83], v[180:183]
    s_add_u32 s54, s54, s56
    ds_read_b64_tr_b16 a[76:77], v9 offset:16384
    v_mfma_f32_16x16x32_bf16 v[240:243], a[48:51], a[80:83], 0
    v_mfma_f32_16x16x32_bf16 v[240:243], a[52:55], a[84:87], v[240:243]
    v_mfma_f32_16x16x32_bf16 v[248:251], a[52:55], a[92:95], 0
    buffer_load_dwordx4 v20, s[44:47], s55 offen offset:2048 sc1 lds
    v_mfma_f32_16x16x32_bf16 v[248:251], a[48:51], a[88:91], v[248:251]
    ds_read_b64_tr_b16 a[78:79], v9 offset:18432
    v_mfma_f32_16x16x32_bf16 v[252:255], a[56:59], a[88:91], 0
    v_add_u32 v6, s63, v6
    v_add_u32 v7, s63, v7
    v_mfma_f32_16x16x32_bf16 v[252:255], a[60:63], a[92:95], v[252:255]
    v_mfma_f32_16x16x32_bf16 v[244:247], a[60:63], a[84:87], 0
    buffer_load_dwordx4 v21, s[44:47], s55 offen offset:3072 sc1 lds
    v_mfma_f32_16x16x32_bf16 v[244:247], a[56:59], a[80:83], v[244:247]
    s_add_u32 s55, s55, s56
    v_mfma_f32_16x16x32_bf16 v[64:67], a[0:3], a[96:99], 0
    ds_read_b64_tr_b16 a[80:81], v10 offset:0
    v_mfma_f32_16x16x32_bf16 v[64:67], a[4:7], a[100:103], v[64:67]
    v_mfma_f32_16x16x32_bf16 v[72:75], a[4:7], a[108:111], 0
    v_mfma_f32_16x16x32_bf16 v[72:75], a[0:3], a[104:107], v[72:75]
    s_add_u32 m0, s61, 0
    ds_read_b64_tr_b16 a[82:83], v10 offset:2048
    v_mfma_f32_16x16x32_bf16 v[76:79], a[8:11], a[104:107], 0
    buffer_load_dwordx4 v16, s[40:43], s48 offen offset:0 sc1 lds
    v_mfma_f32_16x16x32_bf16 v[76:79], a[12:15], a[108:111], v[76:79]
    v_mfma_f32_16x16x32_bf16 v[68:71], a[12:15], a[100:103], 0
    ds_read_b64_tr_b16 a[84:85], v10 offset:16384
    v_mfma_f32_16x16x32_bf16 v[68:71], a[8:11], a[96:99], v[68:71]
    v_mfma_f32_16x16x32_bf16 v[128:131], a[16:19], a[96:99], 0
    buffer_store_dwordx4 a[144:147], v2, s[24:27], s28 offen sc1
    v_mfma_f32_16x16x32_bf16 v[128:131], a[20:23], a[100:103], v[128:131]
    s_add_u32 s28, s28, s31
    ds_read_b64_tr_b16 a[86:87], v10 offset:18432
    v_mfma_f32_16x16x32_bf16 v[136:139], a[20:23], a[108:111], 0
    v_mfma_f32_16x16x32_bf16 v[136:139], a[16:19], a[104:107], v[136:139]
    v_mfma_f32_16x16x32_bf16 v[140:143], a[24:27], a[104:107], 0
    buffer_load_dwordx4 v17, s[40:43], s48 offen offset:1024 sc1 lds
    v_mfma_f32_16x16x32_bf16 v[140:143], a[28:31], a[108:111], v[140:143]
    s_add_u32 s48, s48, 128
    ds_read_b64_tr_b16 a[88:89], v11 offset:0
    v_mfma_f32_16x16x32_bf16 v[132:135], a[28:31], a[100:103], 0
    v_mfma_f32_16x16x32_bf16 v[132:135], a[24:27], a[96:99], v[132:135]
    v_mfma_f32_16x16x32_bf16 v[192:195], a[32:35], a[96:99], 0
    buffer_store_dwordx4 a[148:151], v2, s[24:27], s28 offen sc1
    v_mfma_f32_16x16x32_bf16 v[192:195], a[36:39], a[100:103], v[192:195]
    s_add_u32 s28, s28, s31
    ds_read_b64_tr_b16 a[90:91], v11 offset:2048
    v_mfma_f32_16x16x32_bf16 v[200:203], a[36:39], a[108:111], 0
    v_mfma_f32_16x16x32_bf16 v[200:203], a[32:35], a[104:107], v[200:203]
    v_mfma_f32_16x16x32_bf16 v[204:207], a[40:43], a[104:107], 0
    buffer_load_dwordx4 v16, s[40:43], s49 offen offset:2048 sc1 lds
    v_mfma_f32_16x16x32_bf16 v[204:207], a[44:47], a[108:111], v[204:207]
    ds_read_b64_tr_b16 a[92:93], v11 offset:16384
    v_mfma_f32_16x16x32_bf16 v[196:199], a[44:47], a[100:103], 0
    v_mfma_f32_16x16x32_bf16 v[196:199], a[40:43], a[96:99], v[196:199]
    v_mfma_f32_16x16x32_bf16 a[224:227], a[48:51], a[96:99], 0
    buffer_store_dwordx4 a[152:155], v2, s[24:27], s28 offen sc1
    v_mfma_f32_16x16x32_bf16 a[224:227], a[52:55], a[100:103], a[224:227]
    s_add_u32 s28, s28, s31
    ds_read_b64_tr_b16 a[94:95], v11 offset:18432
    v_mfma_f32_16x16x32_bf16 a[232:235], a[52:55], a[108:111], 0
    v_mfma_f32_16x16x32_bf16 a[232:235], a[48:51], a[104:107], a[232:235]
    v_mfma_f32_16x16x32_bf16 a[236:239], a[56:59], a[104:107], 0
    buffer_load_dwordx4 v17, s[40:43], s49 offen offset:3072 sc1 lds
    v_mfma_f32_16x16x32_bf16 a[236:239], a[60:63], a[108:111], a[236:239]
    s_add_u32 s49, s49, 128
    v_mfma_f32_16x16x32_bf16 a[228:231], a[60:63], a[100:103], 0
    buffer_store_dwordx4 a[156:159], v2, s[24:27], s28 offen sc1
    v_mfma_f32_16x16x32_bf16 a[228:231], a[56:59], a[96:99], a[228:231]
    s_add_u32 s29, s29, s30
    s_mov_b32 s28, s29
    v_mfma_f32_16x16x32_bf16 v[80:83], a[0:3], a[112:115], 0
    v_mfma_f32_16x16x32_bf16 v[80:83], a[4:7], a[116:119], v[80:83]
    ds_read_b64_tr_b16 a[96:97], v12 offset:0
    v_mfma_f32_16x16x32_bf16 v[88:91], a[4:7], a[124:127], 0
    v_mfma_f32_16x16x32_bf16 v[88:91], a[0:3], a[120:123], v[88:91]
    s_add_u32 m0, s61, 4096
    ds_read_b128 a[0:3], v6 offset:0
    v_mfma_f32_16x16x32_bf16 v[92:95], a[8:11], a[120:123], 0
    buffer_load_dwordx4 v16, s[40:43], s50 offen offset:0 sc1 lds
    v_mfma_f32_16x16x32_bf16 v[92:95], a[12:15], a[124:127], v[92:95]
    s_add_u32 s61, s61, 32768
    ds_read_b128 a[4:7], v7 offset:0
    v_mfma_f32_16x16x32_bf16 v[84:87], a[12:15], a[116:119], 0
    s_cmp_ge_u32 s61, 98304
    s_cselect_b32 s90, 98304, 0
    ds_read_b64_tr_b16 a[98:99], v12 offset:2048
    v_mfma_f32_16x16x32_bf16 v[84:87], a[8:11], a[112:115], v[84:87]
    s_sub_u32 s61, s61, s90
    ds_read_b128 a[8:11], v6 offset:2048
    v_mfma_f32_16x16x32_bf16 v[144:147], a[16:19], a[112:115], 0
    ds_read_b128 a[12:15], v7 offset:2048
    v_mfma_f32_16x16x32_bf16 v[144:147], a[20:23], a[116:119], v[144:147]
    ds_read_b64_tr_b16 a[100:101], v12 offset:16384
    v_mfma_f32_16x16x32_bf16 v[152:155], a[20:23], a[124:127], 0
    v_mfma_f32_16x16x32_bf16 v[152:155], a[16:19], a[120:123], v[152:155]
    ds_read_b128 a[16:19], v6 offset:4096
    v_mfma_f32_16x16x32_bf16 v[156:159], a[24:27], a[120:123], 0
    buffer_load_dwordx4 v17, s[40:43], s50 offen offset:1024 sc1 lds
    v_mfma_f32_16x16x32_bf16 v[156:159], a[28:31], a[124:127], v[156:159]
    s_add_u32 s50, s50, 128
    ds_read_b128 a[20:23], v7 offset:4096
    v_mfma_f32_16x16x32_bf16 v[148:151], a[28:31], a[116:119], 0
    ds_read_b64_tr_b16 a[102:103], v12 offset:18432
    v_mfma_f32_16x16x32_bf16 v[148:151], a[24:27], a[112:115], v[148:151]
    ds_read_b128 a[24:27], v6 offset:6144
    v_mfma_f32_16x16x32_bf16 v[208:211], a[32:35], a[112:115], 0
    s_sub_u32 s65, s65, 1
    ds_read_b128 a[28:31], v7 offset:6144
    v_mfma_f32_16x16x32_bf16 v[208:211], a[36:39], a[116:119], v[208:211]
    ds_read_b64_tr_b16 a[104:105], v13 offset:0
    v_mfma_f32_16x16x32_bf16 v[216:219], a[36:39], a[124:127], 0
    v_mfma_f32_16x16x32_bf16 v[216:219], a[32:35], a[120:123], v[216:219]
    ds_read_b128 a[32:35], v6 offset:8192
    v_mfma_f32_16x16x32_bf16 v[220:223], a[40:43], a[120:123], 0
    buffer_load_dwordx4 v16, s[40:43], s51 offen offset:2048 sc1 lds
    v_mfma_f32_16x16x32_bf16 v[220:223], a[44:47], a[124:127], v[220:223]
    ds_read_b128 a[36:39], v7 offset:8192
    v_mfma_f32_16x16x32_bf16 v[212:215], a[44:47], a[116:119], 0
    ds_read_b64_tr_b16 a[106:107], v13 offset:2048
    v_mfma_f32_16x16x32_bf16 v[212:215], a[40:43], a[112:115], v[212:215]
    ds_read_b128 a[40:43], v6 offset:10240
    v_mfma_f32_16x16x32_bf16 a[240:243], a[48:51], a[112:115], 0
    ds_read_b128 a[44:47], v7 offset:10240
    v_mfma_f32_16x16x32_bf16 a[240:243], a[52:55], a[116:119], a[240:243]
    ds_read_b64_tr_b16 a[108:109], v13 offset:16384
    v_mfma_f32_16x16x32_bf16 a[248:251], a[52:55], a[124:127], 0
    v_mfma_f32_16x16x32_bf16 a[248:251], a[48:51], a[120:123], a[248:251]
    ds_read_b128 a[48:51], v6 offset:12288
    v_mfma_f32_16x16x32_bf16 a[252:255], a[56:59], a[120:123], 0
    buffer_load_dwordx4 v17, s[40:43], s51 offen offset:3072 sc1 lds
    v_mfma_f32_16x16x32_bf16 a[252:255], a[60:63], a[124:127], a[252:255]
    s_add_u32 s51, s51, 128
    ds_read_b128 a[52:55], v7 offset:12288
    v_mfma_f32_16x16x32_bf16 a[244:247], a[60:63], a[116:119], 0
    ds_read_b64_tr_b16 a[110:111], v13 offset:18432
    v_mfma_f32_16x16x32_bf16 a[244:247], a[56:59], a[112:115], a[244:247]
    ds_read_b128 a[56:59], v6 offset:14336
    ds_read_b128 a[60:63], v7 offset:14336
    s_waitcnt lgkmcnt(15)
    v_mfma_f32_16x16x32_bf16 v[32:35], a[0:3], a[64:67], v[32:35]
    ds_read_b64_tr_b16 a[112:113], v14 offset:0
    v_mfma_f32_16x16x32_bf16 v[32:35], a[4:7], a[68:71], v[32:35]
    ds_read_b64_tr_b16 a[114:115], v14 offset:2048
    v_mfma_f32_16x16x32_bf16 v[40:43], a[4:7], a[76:79], v[40:43]
    ds_read_b64_tr_b16 a[116:117], v14 offset:16384
    v_mfma_f32_16x16x32_bf16 v[40:43], a[0:3], a[72:75], v[40:43]
    ds_read_b64_tr_b16 a[118:119], v14 offset:18432
    v_mfma_f32_16x16x32_bf16 v[44:47], a[8:11], a[72:75], v[44:47]
    ds_read_b64_tr_b16 a[120:121], v15 offset:0
    v_mfma_f32_16x16x32_bf16 v[44:47], a[12:15], a[76:79], v[44:47]
    ds_read_b64_tr_b16 a[122:123], v15 offset:2048
    v_mfma_f32_16x16x32_bf16 v[36:39], a[12:15], a[68:71], v[36:39]
    ds_read_b64_tr_b16 a[124:125], v15 offset:16384
    v_mfma_f32_16x16x32_bf16 v[36:39], a[8:11], a[64:67], v[36:39]
    ds_read_b64_tr_b16 a[126:127], v15 offset:18432
    v_mfma_f32_16x16x32_bf16 v[96:99], a[16:19], a[64:67], v[96:99]
    v_mfma_f32_16x16x32_bf16 v[96:99], a[20:23], a[68:71], v[96:99]
    v_mfma_f32_16x16x32_bf16 v[104:107], a[20:23], a[76:79], v[104:107]
    buffer_store_dwordx4 a[160:163], v2, s[24:27], s28 offen sc1
    v_mfma_f32_16x16x32_bf16 v[104:107], a[16:19], a[72:75], v[104:107]
    s_add_u32 s28, s28, s31
    s_waitcnt lgkmcnt(15)
    v_mfma_f32_16x16x32_bf16 v[108:111], a[24:27], a[72:75], v[108:111]
    v_xor_b32 v8, s60, v8
    v_xor_b32 v9, s60, v9
    v_mfma_f32_16x16x32_bf16 v[108:111], a[28:31], a[76:79], v[108:111]
    v_xor_b32 v10, s60, v10
    v_xor_b32 v11, s60, v11
    v_mfma_f32_16x16x32_bf16 v[100:103], a[28:31], a[68:71], v[100:103]
    v_xor_b32 v12, s60, v12
    v_xor_b32 v13, s60, v13
    v_mfma_f32_16x16x32_bf16 v[100:103], a[24:27], a[64:67], v[100:103]
    v_xor_b32 v14, s60, v14
    v_xor_b32 v15, s60, v15
    v_mfma_f32_16x16x32_bf16 v[160:163], a[32:35], a[64:67], v[160:163]
    buffer_store_dwordx4 a[164:167], v2, s[24:27], s28 offen sc1
    v_mfma_f32_16x16x32_bf16 v[160:163], a[36:39], a[68:71], v[160:163]
    s_add_u32 s28, s28, s31
    v_mfma_f32_16x16x32_bf16 v[168:171], a[36:39], a[76:79], v[168:171]
    v_mfma_f32_16x16x32_bf16 v[168:171], a[32:35], a[72:75], v[168:171]
    s_waitcnt lgkmcnt(14)
    v_mfma_f32_16x16x32_bf16 v[172:175], a[40:43], a[72:75], v[172:175]
    v_mfma_f32_16x16x32_bf16 v[172:175], a[44:47], a[76:79], v[172:175]
    v_mfma_f32_16x16x32_bf16 v[164:167], a[44:47], a[68:71], v[164:167]
    buffer_store_dwordx4 a[168:171], v2, s[24:27], s28 offen sc1
    v_mfma_f32_16x16x32_bf16 v[164:167], a[40:43], a[64:67], v[164:167]
    s_add_u32 s28, s28, s31
    s_waitcnt lgkmcnt(11)
    v_mfma_f32_16x16x32_bf16 v[224:227], a[48:51], a[64:67], v[224:227]
    v_mfma_f32_16x16x32_bf16 v[224:227], a[52:55], a[68:71], v[224:227]
    v_mfma_f32_16x16x32_bf16 v[232:235], a[52:55], a[76:79], v[232:235]
    v_mfma_f32_16x16x32_bf16 v[232:235], a[48:51], a[72:75], v[232:235]
    s_waitcnt lgkmcnt(8)
    v_mfma_f32_16x16x32_bf16 v[236:239], a[56:59], a[72:75], v[236:239]
    buffer_store_dwordx4 a[172:175], v2, s[24:27], s28 offen sc1
    v_mfma_f32_16x16x32_bf16 v[236:239], a[60:63], a[76:79], v[236:239]
    s_add_u32 s28, s28, s31
    v_mfma_f32_16x16x32_bf16 v[228:231], a[60:63], a[68:71], v[228:231]
    s_waitcnt vmcnt(16) lgkmcnt(0)
    v_mfma_f32_16x16x32_bf16 v[228:231], a[56:59], a[64:67], v[228:231]
    s_barrier
    v_mfma_f32_16x16x32_bf16 v[48:51], a[0:3], a[80:83], v[48:51]
    ds_read_b64_tr_b16 a[64:65], v8 offset:0
    v_mfma_f32_16x16x32_bf16 v[48:51], a[4:7], a[84:87], v[48:51]
    s_add_u32 m0, s62, 0
    v_mfma_f32_16x16x32_bf16 v[56:59], a[4:7], a[92:95], v[56:59]
    buffer_load_dwordx4 v18, s[44:47], s52 offen offset:0 sc1 lds
    v_mfma_f32_16x16x32_bf16 v[56:59], a[0:3], a[88:91], v[56:59]
    ds_read_b64_tr_b16 a[66:67], v8 offset:2048
    v_mfma_f32_16x16x32_bf16 v[60:63], a[8:11], a[88:91], v[60:63]
    s_add_u32 s64, s64, 32768
    v_mfma_f32_16x16x32_bf16 v[60:63], a[12:15], a[92:95], v[60:63]
    s_cmp_ge_u32 s64, 98304
    s_cselect_b32 s63, 4294901760, s59
    s_cselect_b32 s64, 0, s64
    v_mfma_f32_16x16x32_bf16 v[52:55], a[12:15], a[84:87], v[52:55]
    buffer_load_dwordx4 v19, s[44:47], s52 offen offset:1024 sc1 lds
    v_mfma_f32_16x16x32_bf16 v[52:55], a[8:11], a[80:83], v[52:55]
    s_add_u32 s52, s52, s56
    ds_read_b64_tr_b16 a[68:69], v8 offset:16384
    v_mfma_f32_16x16x32_bf16 v[112:115], a[16:19], a[80:83], v[112:115]
    v_mfma_f32_16x16x32_bf16 v[112:115], a[20:23], a[84:87], v[112:115]
    v_mfma_f32_16x16x32_bf16 v[120:123], a[20:23], a[92:95], v[120:123]
    buffer_load_dwordx4 v18, s[44:47], s53 offen offset:2048 sc1 lds
    v_mfma_f32_16x16x32_bf16 v[120:123], a[16:19], a[88:91], v[120:123]
    ds_read_b64_tr_b16 a[70:71], v8 offset:18432
    v_mfma_f32_16x16x32_bf16 v[124:127], a[24:27], a[88:91], v[124:127]
    v_mfma_f32_16x16x32_bf16 v[124:127], a[28:31], a[92:95], v[124:127]
    v_mfma_f32_16x16x32_bf16 v[116:119], a[28:31], a[84:87], v[116:119]
    buffer_load_dwordx4 v19, s[44:47], s53 offen offset:3072 sc1 lds
    v_mfma_f32_16x16x32_bf16 v[116:119], a[24:27], a[80:83], v[116:119]
    s_add_u32 s53, s53, s56
    ds_read_b64_tr_b16 a[72:73], v9 offset:0
    v_mfma_f32_16x16x32_bf16 v[176:179], a[32:35], a[80:83], v[176:179]
    v_mfma_f32_16x16x32_bf16 v[176:179], a[36:39], a[84:87], v[176:179]
    s_add_u32 m0, s62, 4096
    v_mfma_f32_16x16x32_bf16 v[184:187], a[36:39], a[92:95], v[184:187]
    buffer_load_dwordx4 v20, s[44:47], s54 offen offset:0 sc1 lds
    v_mfma_f32_16x16x32_bf16 v[184:187], a[32:35], a[88:91], v[184:187]
    s_xor_b32 s62, s62, 229376
    ds_read_b64_tr_b16 a[74:75], v9 offset:2048
    v_mfma_f32_16x16x32_bf16 v[188:191], a[40:43], a[88:91], v[188:191]
    v_mfma_f32_16x16x32_bf16 v[188:191], a[44:47], a[92:95], v[188:191]
    v_mfma_f32_16x16x32_bf16 v[180:183], a[44:47], a[84:87], v[180:183]
    buffer_load_dwordx4 v21, s[44:47], s54 offen offset:1024 sc1 lds
    v_mfma_f32_16x16x32_bf16 v[180:183], a[40:43], a[80:83], v[180:183]
    s_add_u32 s54, s54, s56
    ds_read_b64_tr_b16 a[76:77], v9 offset:16384
    v_mfma_f32_16x16x32_bf16 v[240:243], a[48:51], a[80:83], v[240:243]
    v_mfma_f32_16x16x32_bf16 v[240:243], a[52:55], a[84:87], v[240:243]
    v_mfma_f32_16x16x32_bf16 v[248:251], a[52:55], a[92:95], v[248:251]
    buffer_load_dwordx4 v20, s[44:47], s55 offen offset:2048 sc1 lds
    v_mfma_f32_16x16x32_bf16 v[248:251], a[48:51], a[88:91], v[248:251]
    ds_read_b64_tr_b16 a[78:79], v9 offset:18432
    v_mfma_f32_16x16x32_bf16 v[252:255], a[56:59], a[88:91], v[252:255]
    v_add_u32 v6, s63, v6
    v_add_u32 v7, s63, v7
    v_mfma_f32_16x16x32_bf16 v[252:255], a[60:63], a[92:95], v[252:255]
    v_mfma_f32_16x16x32_bf16 v[244:247], a[60:63], a[84:87], v[244:247]
    buffer_load_dwordx4 v21, s[44:47], s55 offen offset:3072 sc1 lds
    v_mfma_f32_16x16x32_bf16 v[244:247], a[56:59], a[80:83], v[244:247]
    s_add_u32 s55, s55, s56
    v_mfma_f32_16x16x32_bf16 v[64:67], a[0:3], a[96:99], v[64:67]
    ds_read_b64_tr_b16 a[80:81], v10 offset:0
    v_mfma_f32_16x16x32_bf16 v[64:67], a[4:7], a[100:103], v[64:67]
    v_mfma_f32_16x16x32_bf16 v[72:75], a[4:7], a[108:111], v[72:75]
    v_mfma_f32_16x16x32_bf16 v[72:75], a[0:3], a[104:107], v[72:75]
    s_add_u32 m0, s61, 0
    ds_read_b64_tr_b16 a[82:83], v10 offset:2048
    v_mfma_f32_16x16x32_bf16 v[76:79], a[8:11], a[104:107], v[76:79]
    buffer_load_dwordx4 v16, s[40:43], s48 offen offset:0 sc1 lds
    v_mfma_f32_16x16x32_bf16 v[76:79], a[12:15], a[108:111], v[76:79]
    v_mfma_f32_16x16x32_bf16 v[68:71], a[12:15], a[100:103], v[68:71]
    ds_read_b64_tr_b16 a[84:85], v10 offset:16384
    v_mfma_f32_16x16x32_bf16 v[68:71], a[8:11], a[96:99], v[68:71]
    v_mfma_f32_16x16x32_bf16 v[128:131], a[16:19], a[96:99], v[128:131]
    buffer_store_dwordx4 a[176:179], v2, s[24:27], s28 offen sc1
    v_mfma_f32_16x16x32_bf16 v[128:131], a[20:23], a[100:103], v[128:131]
    s_add_u32 s28, s28, s31
    ds_read_b64_tr_b16 a[86:87], v10 offset:18432
    v_mfma_f32_16x16x32_bf16 v[136:139], a[20:23], a[108:111], v[136:139]
    v_mfma_f32_16x16x32_bf16 v[136:139], a[16:19], a[104:107], v[136:139]
    v_mfma_f32_16x16x32_bf16 v[140:143], a[24:27], a[104:107], v[140:143]
    buffer_load_dwordx4 v17, s[40:43], s48 offen offset:1024 sc1 lds
    v_mfma_f32_16x16x32_bf16 v[140:143], a[28:31], a[108:111], v[140:143]
    s_add_u32 s48, s48, 128
    ds_read_b64_tr_b16 a[88:89], v11 offset:0
    v_mfma_f32_16x16x32_bf16 v[132:135], a[28:31], a[100:103], v[132:135]
    v_mfma_f32_16x16x32_bf16 v[132:135], a[24:27], a[96:99], v[132:135]
    v_mfma_f32_16x16x32_bf16 v[192:195], a[32:35], a[96:99], v[192:195]
    buffer_store_dwordx4 a[180:183], v2, s[24:27], s28 offen sc1
    v_mfma_f32_16x16x32_bf16 v[192:195], a[36:39], a[100:103], v[192:195]
    s_add_u32 s28, s28, s31
    ds_read_b64_tr_b16 a[90:91], v11 offset:2048
    v_mfma_f32_16x16x32_bf16 v[200:203], a[36:39], a[108:111], v[200:203]
    v_mfma_f32_16x16x32_bf16 v[200:203], a[32:35], a[104:107], v[200:203]
    v_mfma_f32_16x16x32_bf16 v[204:207], a[40:43], a[104:107], v[204:207]
    buffer_load_dwordx4 v16, s[40:43], s49 offen offset:2048 sc1 lds
    v_mfma_f32_16x16x32_bf16 v[204:207], a[44:47], a[108:111], v[204:207]
    ds_read_b64_tr_b16 a[92:93], v11 offset:16384
    v_mfma_f32_16x16x32_bf16 v[196:199], a[44:47], a[100:103], v[196:199]
    v_mfma_f32_16x16x32_bf16 v[196:199], a[40:43], a[96:99], v[196:199]
    v_mfma_f32_16x16x32_bf16 a[224:227], a[48:51], a[96:99], a[224:227]
    buffer_store_dwordx4 a[184:187], v2, s[24:27], s28 offen sc1
    v_mfma_f32_16x16x32_bf16 a[224:227], a[52:55], a[100:103], a[224:227]
    s_add_u32 s28, s28, s31
    ds_read_b64_tr_b16 a[94:95], v11 offset:18432
    v_mfma_f32_16x16x32_bf16 a[232:235], a[52:55], a[108:111], a[232:235]
    v_mfma_f32_16x16x32_bf16 a[232:235], a[48:51], a[104:107], a[232:235]
    v_mfma_f32_16x16x32_bf16 a[236:239], a[56:59], a[104:107], a[236:239]
    buffer_load_dwordx4 v17, s[40:43], s49 offen offset:3072 sc1 lds
    v_mfma_f32_16x16x32_bf16 a[236:239], a[60:63], a[108:111], a[236:239]
    s_add_u32 s49, s49, 128
    v_mfma_f32_16x16x32_bf16 a[228:231], a[60:63], a[100:103], a[228:231]
    buffer_store_dwordx4 a[188:191], v2, s[24:27], s28 offen sc1
    v_mfma_f32_16x16x32_bf16 a[228:231], a[56:59], a[96:99], a[228:231]
    s_add_u32 s29, s29, s30
    s_mov_b32 s28, s29
    v_mfma_f32_16x16x32_bf16 v[80:83], a[0:3], a[112:115], v[80:83]
    v_mfma_f32_16x16x32_bf16 v[80:83], a[4:7], a[116:119], v[80:83]
    ds_read_b64_tr_b16 a[96:97], v12 offset:0
    v_mfma_f32_16x16x32_bf16 v[88:91], a[4:7], a[124:127], v[88:91]
    v_mfma_f32_16x16x32_bf16 v[88:91], a[0:3], a[120:123], v[88:91]
    s_add_u32 m0, s61, 4096
    ds_read_b128 a[0:3], v6 offset:0
    v_mfma_f32_16x16x32_bf16 v[92:95], a[8:11], a[120:123], v[92:95]
    buffer_load_dwordx4 v16, s[40:43], s50 offen offset:0 sc1 lds
    v_mfma_f32_16x16x32_bf16 v[92:95], a[12:15], a[124:127], v[92:95]
    s_add_u32 s61, s61, 32768
    ds_read_b128 a[4:7], v7 offset:0
    v_mfma_f32_16x16x32_bf16 v[84:87], a[12:15], a[116:119], v[84:87]
    s_cmp_ge_u32 s61, 98304
    s_cselect_b32 s90, 98304, 0
    ds_read_b64_tr_b16 a[98:99], v12 offset:2048
    v_mfma_f32_16x16x32_bf16 v[84:87], a[8:11], a[112:115], v[84:87]
    s_sub_u32 s61, s61, s90
    ds_read_b128 a[8:11], v6 offset:2048
    v_mfma_f32_16x16x32_bf16 v[144:147], a[16:19], a[112:115], v[144:147]
    ds_read_b128 a[12:15], v7 offset:2048
    v_mfma_f32_16x16x32_bf16 v[144:147], a[20:23], a[116:119], v[144:147]
    ds_read_b64_tr_b16 a[100:101], v12 offset:16384
    v_mfma_f32_16x16x32_bf16 v[152:155], a[20:23], a[124:127], v[152:155]
    v_mfma_f32_16x16x32_bf16 v[152:155], a[16:19], a[120:123], v[152:155]
    ds_read_b128 a[16:19], v6 offset:4096
    v_mfma_f32_16x16x32_bf16 v[156:159], a[24:27], a[120:123], v[156:159]
    buffer_load_dwordx4 v17, s[40:43], s50 offen offset:1024 sc1 lds
    v_mfma_f32_16x16x32_bf16 v[156:159], a[28:31], a[124:127], v[156:159]
    s_add_u32 s50, s50, 128
    ds_read_b128 a[20:23], v7 offset:4096
    v_mfma_f32_16x16x32_bf16 v[148:151], a[28:31], a[116:119], v[148:151]
    ds_read_b64_tr_b16 a[102:103], v12 offset:18432
    v_mfma_f32_16x16x32_bf16 v[148:151], a[24:27], a[112:115], v[148:151]
    ds_read_b128 a[24:27], v6 offset:6144
    v_mfma_f32_16x16x32_bf16 v[208:211], a[32:35], a[112:115], v[208:211]
    s_sub_u32 s65, s65, 1
    ds_read_b128 a[28:31], v7 offset:6144
    v_mfma_f32_16x16x32_bf16 v[208:211], a[36:39], a[116:119], v[208:211]
    ds_read_b64_tr_b16 a[104:105], v13 offset:0
    v_mfma_f32_16x16x32_bf16 v[216:219], a[36:39], a[124:127], v[216:219]
    v_mfma_f32_16x16x32_bf16 v[216:219], a[32:35], a[120:123], v[216:219]
    ds_read_b128 a[32:35], v6 offset:8192
    v_mfma_f32_16x16x32_bf16 v[220:223], a[40:43], a[120:123], v[220:223]
    buffer_load_dwordx4 v16, s[40:43], s51 offen offset:2048 sc1 lds
    v_mfma_f32_16x16x32_bf16 v[220:223], a[44:47], a[124:127], v[220:223]
    ds_read_b128 a[36:39], v7 offset:8192
    v_mfma_f32_16x16x32_bf16 v[212:215], a[44:47], a[116:119], v[212:215]
    ds_read_b64_tr_b16 a[106:107], v13 offset:2048
    v_mfma_f32_16x16x32_bf16 v[212:215], a[40:43], a[112:115], v[212:215]
    ds_read_b128 a[40:43], v6 offset:10240
    v_mfma_f32_16x16x32_bf16 a[240:243], a[48:51], a[112:115], a[240:243]
    ds_read_b128 a[44:47], v7 offset:10240
    v_mfma_f32_16x16x32_bf16 a[240:243], a[52:55], a[116:119], a[240:243]
    ds_read_b64_tr_b16 a[108:109], v13 offset:16384
    v_mfma_f32_16x16x32_bf16 a[248:251], a[52:55], a[124:127], a[248:251]
    v_mfma_f32_16x16x32_bf16 a[248:251], a[48:51], a[120:123], a[248:251]
    ds_read_b128 a[48:51], v6 offset:12288
    v_mfma_f32_16x16x32_bf16 a[252:255], a[56:59], a[120:123], a[252:255]
    buffer_load_dwordx4 v17, s[40:43], s51 offen offset:3072 sc1 lds
    v_mfma_f32_16x16x32_bf16 a[252:255], a[60:63], a[124:127], a[252:255]
    s_add_u32 s51, s51, 128
    ds_read_b128 a[52:55], v7 offset:12288
    v_mfma_f32_16x16x32_bf16 a[244:247], a[60:63], a[116:119], a[244:247]
    ds_read_b64_tr_b16 a[110:111], v13 offset:18432
    v_mfma_f32_16x16x32_bf16 a[244:247], a[56:59], a[112:115], a[244:247]
    ds_read_b128 a[56:59], v6 offset:14336
    ds_read_b128 a[60:63], v7 offset:14336
    s_cmp_eq_u32 s66, 2
    s_cbranch_scc1 m_hook23
m_hookr24:
    s_waitcnt lgkmcnt(15)
    v_mfma_f32_16x16x32_bf16 v[32:35], a[0:3], a[64:67], v[32:35]
    ds_read_b64_tr_b16 a[112:113], v14 offset:0
    v_mfma_f32_16x16x32_bf16 v[32:35], a[4:7], a[68:71], v[32:35]
    ds_read_b64_tr_b16 a[114:115], v14 offset:2048
    v_mfma_f32_16x16x32_bf16 v[40:43], a[4:7], a[76:79], v[40:43]
    ds_read_b64_tr_b16 a[116:117], v14 offset:16384
    v_mfma_f32_16x16x32_bf16 v[40:43], a[0:3], a[72:75], v[40:43]
    ds_read_b64_tr_b16 a[118:119], v14 offset:18432
    v_mfma_f32_16x16x32_bf16 v[44:47], a[8:11], a[72:75], v[44:47]
    ds_read_b64_tr_b16 a[120:121], v15 offset:0
    v_mfma_f32_16x16x32_bf16 v[44:47], a[12:15], a[76:79], v[44:47]
    ds_read_b64_tr_b16 a[122:123], v15 offset:2048
    v_mfma_f32_16x16x32_bf16 v[36:39], a[12:15], a[68:71], v[36:39]
    ds_read_b64_tr_b16 a[124:125], v15 offset:16384
    v_mfma_f32_16x16x32_bf16 v[36:39], a[8:11], a[64:67], v[36:39]
    ds_read_b64_tr_b16 a[126:127], v15 offset:18432
    v_mfma_f32_16x16x32_bf16 v[96:99], a[16:19], a[64:67], v[96:99]
    v_mfma_f32_16x16x32_bf16 v[96:99], a[20:23], a[68:71], v[96:99]
    v_mfma_f32_16x16x32_bf16 v[104:107], a[20:23], a[76:79], v[104:107]
    buffer_store_dwordx4 a[192:195], v2, s[24:27], s28 offen sc1
    v_mfma_f32_16x16x32_bf16 v[104:107], a[16:19], a[72:75], v[104:107]
    s_add_u32 s28, s28, s31
    s_waitcnt lgkmcnt(15)
    v_mfma_f32_16x16x32_bf16 v[108:111], a[24:27], a[72:75], v[108:111]
    v_xor_b32 v8, s60, v8
    v_xor_b32 v9, s60, v9
    v_mfma_f32_16x16x32_bf16 v[108:111], a[28:31], a[76:79], v[108:111]
    v_xor_b32 v10, s60, v10
    v_xor_b32 v11, s60, v11
    v_mfma_f32_16x16x32_bf16 v[100:103], a[28:31], a[68:71], v[100:103]
    v_xor_b32 v12, s60, v12
    v_xor_b32 v13, s60, v13
    v_mfma_f32_16x16x32_bf16 v[100:103], a[24:27], a[64:67], v[100:103]
    v_xor_b32 v14, s60, v14
    v_xor_b32 v15, s60, v15
    v_mfma_f32_16x16x32_bf16 v[160:163], a[32:35], a[64:67], v[160:163]
    buffer_store_dwordx4 a[196:199], v2, s[24:27], s28 offen sc1
    v_mfma_f32_16x16x32_bf16 v[160:163], a[36:39], a[68:71], v[160:163]
    s_add_u32 s28, s28, s31
    v_mfma_f32_16x16x32_bf16 v[168:171], a[36:39], a[76:79], v[168:171]
    v_mfma_f32_16x16x32_bf16 v[168:171], a[32:35], a[72:75], v[168:171]
    s_waitcnt lgkmcnt(14)
    v_mfma_f32_16x16x32_bf16 v[172:175], a[40:43], a[72:75], v[172:175]
    v_mfma_f32_16x16x32_bf16 v[172:175], a[44:47], a[76:79], v[172:175]
    v_mfma_f32_16x16x32_bf16 v[164:167], a[44:47], a[68:71], v[164:167]
    buffer_store_dwordx4 a[200:203], v2, s[24:27], s28 offen sc1
    v_mfma_f32_16x16x32_bf16 v[164:167], a[40:43], a[64:67], v[164:167]
    s_add_u32 s28, s28, s31
    s_waitcnt lgkmcnt(11)
    v_mfma_f32_16x16x32_bf16 v[224:227], a[48:51], a[64:67], v[224:227]
    v_mfma_f32_16x16x32_bf16 v[224:227], a[52:55], a[68:71], v[224:227]
    v_mfma_f32_16x16x32_bf16 v[232:235], a[52:55], a[76:79], v[232:235]
    v_mfma_f32_16x16x32_bf16 v[232:235], a[48:51], a[72:75], v[232:235]
    s_waitcnt lgkmcnt(8)
    v_mfma_f32_16x16x32_bf16 v[236:239], a[56:59], a[72:75], v[236:239]
    buffer_store_dwordx4 a[204:207], v2, s[24:27], s28 offen sc1
    v_mfma_f32_16x16x32_bf16 v[236:239], a[60:63], a[76:79], v[236:239]
    s_add_u32 s28, s28, s31
    v_mfma_f32_16x16x32_bf16 v[228:231], a[60:63], a[68:71], v[228:231]
    s_waitcnt vmcnt(16) lgkmcnt(0)
    v_mfma_f32_16x16x32_bf16 v[228:231], a[56:59], a[64:67], v[228:231]
    s_barrier
    v_mfma_f32_16x16x32_bf16 v[48:51], a[0:3], a[80:83], v[48:51]
    ds_read_b64_tr_b16 a[64:65], v8 offset:0
    v_mfma_f32_16x16x32_bf16 v[48:51], a[4:7], a[84:87], v[48:51]
    s_add_u32 m0, s62, 0
    v_mfma_f32_16x16x32_bf16 v[56:59], a[4:7], a[92:95], v[56:59]
    buffer_load_dwordx4 v18, s[44:47], s52 offen offset:0 sc1 lds
    v_mfma_f32_16x16x32_bf16 v[56:59], a[0:3], a[88:91], v[56:59]
    ds_read_b64_tr_b16 a[66:67], v8 offset:2048
    v_mfma_f32_16x16x32_bf16 v[60:63], a[8:11], a[88:91], v[60:63]
    s_add_u32 s64, s64, 32768
    v_mfma_f32_16x16x32_bf16 v[60:63], a[12:15], a[92:95], v[60:63]
    s_cmp_ge_u32 s64, 98304
    s_cselect_b32 s63, 4294901760, s59
    s_cselect_b32 s64, 0, s64
    v_mfma_f32_16x16x32_bf16 v[52:55], a[12:15], a[84:87], v[52:55]
    buffer_load_dwordx4 v19, s[44:47], s52 offen offset:1024 sc1 lds
    v_mfma_f32_16x16x32_bf16 v[52:55], a[8:11], a[80:83], v[52:55]
    s_add_u32 s52, s52, s56
    ds_read_b64_tr_b16 a[68:69], v8 offset:16384
    v_mfma_f32_16x16x32_bf16 v[112:115], a[16:19], a[80:83], v[112:115]
    v_mfma_f32_16x16x32_bf16 v[112:115], a[20:23], a[84:87], v[112:115]
    v_mfma_f32_16x16x32_bf16 v[120:123], a[20:23], a[92:95], v[120:123]
    buffer_load_dwordx4 v18, s[44:47], s53 offen offset:2048 sc1 lds
    v_mfma_f32_16x16x32_bf16 v[120:123], a[16:19], a[88:91], v[120:123]
    ds_read_b64_tr_b16 a[70:71], v8 offset:18432
    v_mfma_f32_16x16x32_bf16 v[124:127], a[24:27], a[88:91], v[124:127]
    v_mfma_f32_16x16x32_bf16 v[124:127], a[28:31], a[92:95], v[124:127]
    v_mfma_f32_16x16x32_bf16 v[116:119], a[28:31], a[84:87], v[116:119]
    buffer_load_dwordx4 v19, s[44:47], s53 offen offset:3072 sc1 lds
    v_mfma_f32_16x16x32_bf16 v[116:119], a[24:27], a[80:83], v[116:119]
    s_add_u32 s53, s53, s56
    ds_read_b64_tr_b16 a[72:73], v9 offset:0
    v_mfma_f32_16x16x32_bf16 v[176:179], a[32:35], a[80:83], v[176:179]
    v_mfma_f32_16x16x32_bf16 v[176:179], a[36:39], a[84:87], v[176:179]
    s_add_u32 m0, s62, 4096
    v_mfma_f32_16x16x32_bf16 v[184:187], a[36:39], a[92:95], v[184:187]
    buffer_load_dwordx4 v20, s[44:47], s54 offen offset:0 sc1 lds
    v_mfma_f32_16x16x32_bf16 v[184:187], a[32:35], a[88:91], v[184:187]
    s_xor_b32 s62, s62, 229376
    ds_read_b64_tr_b16 a[74:75], v9 offset:2048
    v_mfma_f32_16x16x32_bf16 v[188:191], a[40:43], a[88:91], v[188:191]
    v_mfma_f32_16x16x32_bf16 v[188:191], a[44:47], a[92:95], v[188:191]
    v_mfma_f32_16x16x32_bf16 v[180:183], a[44:47], a[84:87], v[180:183]
    buffer_load_dwordx4 v21, s[44:47], s54 offen offset:1024 sc1 lds
    v_mfma_f32_16x16x32_bf16 v[180:183], a[40:43], a[80:83], v[180:183]
    s_add_u32 s54, s54, s56
    ds_read_b64_tr_b16 a[76:77], v9 offset:16384
    v_mfma_f32_16x16x32_bf16 v[240:243], a[48:51], a[80:83], v[240:243]
    v_mfma_f32_16x16x32_bf16 v[240:243], a[52:55], a[84:87], v[240:243]
    v_mfma_f32_16x16x32_bf16 v[248:251], a[52:55], a[92:95], v[248:251]
    buffer_load_dwordx4 v20, s[44:47], s55 offen offset:2048 sc1 lds
    v_mfma_f32_16x16x32_bf16 v[248:251], a[48:51], a[88:91], v[248:251]
    ds_read_b64_tr_b16 a[78:79], v9 offset:18432
    v_mfma_f32_16x16x32_bf16 v[252:255], a[56:59], a[88:91], v[252:255]
    v_add_u32 v6, s63, v6
    v_add_u32 v7, s63, v7
    v_mfma_f32_16x16x32_bf16 v[252:255], a[60:63], a[92:95], v[252:255]
    v_mfma_f32_16x16x32_bf16 v[244:247], a[60:63], a[84:87], v[244:247]
    buffer_load_dwordx4 v21, s[44:47], s55 offen offset:3072 sc1 lds
    v_mfma_f32_16x16x32_bf16 v[244:247], a[56:59], a[80:83], v[244:247]
    s_add_u32 s55, s55, s56
    v_mfma_f32_16x16x32_bf16 v[64:67], a[0:3], a[96:99], v[64:67]
    ds_read_b64_tr_b16 a[80:81], v10 offset:0
    v_mfma_f32_16x16x32_bf16 v[64:67], a[4:7], a[100:103], v[64:67]
    v_mfma_f32_16x16x32_bf16 v[72:75], a[4:7], a[108:111], v[72:75]
    v_mfma_f32_16x16x32_bf16 v[72:75], a[0:3], a[104:107], v[72:75]
    s_add_u32 m0, s61, 0
    ds_read_b64_tr_b16 a[82:83], v10 offset:2048
    v_mfma_f32_16x16x32_bf16 v[76:79], a[8:11], a[104:107], v[76:79]
    buffer_load_dwordx4 v16, s[40:43], s48 offen offset:0 sc1 lds
    v_mfma_f32_16x16x32_bf16 v[76:79], a[12:15], a[108:111], v[76:79]
    v_mfma_f32_16x16x32_bf16 v[68:71], a[12:15], a[100:103], v[68:71]
    ds_read_b64_tr_b16 a[84:85], v10 offset:16384
    v_mfma_f32_16x16x32_bf16 v[68:71], a[8:11], a[96:99], v[68:71]
    v_mfma_f32_16x16x32_bf16 v[128:131], a[16:19], a[96:99], v[128:131]
    buffer_store_dwordx4 a[208:211], v2, s[24:27], s28 offen sc1
    v_mfma_f32_16x16x32_bf16 v[128:131], a[20:23], a[100:103], v[128:131]
    s_add_u32 s28, s28, s31
    ds_read_b64_tr_b16 a[86:87], v10 offset:18432
    v_mfma_f32_16x16x32_bf16 v[136:139], a[20:23], a[108:111], v[136:139]
    v_mfma_f32_16x16x32_bf16 v[136:139], a[16:19], a[104:107], v[136:139]
    v_mfma_f32_16x16x32_bf16 v[140:143], a[24:27], a[104:107], v[140:143]
    buffer_load_dwordx4 v17, s[40:43], s48 offen offset:1024 sc1 lds
    v_mfma_f32_16x16x32_bf16 v[140:143], a[28:31], a[108:111], v[140:143]
    s_add_u32 s48, s48, 128
    ds_read_b64_tr_b16 a[88:89], v11 offset:0
    v_mfma_f32_16x16x32_bf16 v[132:135], a[28:31], a[100:103], v[132:135]
    v_mfma_f32_16x16x32_bf16 v[132:135], a[24:27], a[96:99], v[132:135]
    v_mfma_f32_16x16x32_bf16 v[192:195], a[32:35], a[96:99], v[192:195]
    buffer_store_dwordx4 a[212:215], v2, s[24:27], s28 offen sc1
    v_mfma_f32_16x16x32_bf16 v[192:195], a[36:39], a[100:103], v[192:195]
    s_add_u32 s28, s28, s31
    ds_read_b64_tr_b16 a[90:91], v11 offset:2048
    v_mfma_f32_16x16x32_bf16 v[200:203], a[36:39], a[108:111], v[200:203]
    v_mfma_f32_16x16x32_bf16 v[200:203], a[32:35], a[104:107], v[200:203]
    v_mfma_f32_16x16x32_bf16 v[204:207], a[40:43], a[104:107], v[204:207]
    buffer_load_dwordx4 v16, s[40:43], s49 offen offset:2048 sc1 lds
    v_mfma_f32_16x16x32_bf16 v[204:207], a[44:47], a[108:111], v[204:207]
    ds_read_b64_tr_b16 a[92:93], v11 offset:16384
    v_mfma_f32_16x16x32_bf16 v[196:199], a[44:47], a[100:103], v[196:199]
    v_mfma_f32_16x16x32_bf16 v[196:199], a[40:43], a[96:99], v[196:199]
    v_mfma_f32_16x16x32_bf16 a[224:227], a[48:51], a[96:99], a[224:227]
    buffer_store_dwordx4 a[216:219], v2, s[24:27], s28 offen sc1
    v_mfma_f32_16x16x32_bf16 a[224:227], a[52:55], a[100:103], a[224:227]
    s_add_u32 s28, s28, s31
    ds_read_b64_tr_b16 a[94:95], v11 offset:18432
    v_mfma_f32_16x16x32_bf16 a[232:235], a[52:55], a[108:111], a[232:235]
    v_mfma_f32_16x16x32_bf16 a[232:235], a[48:51], a[104:107], a[232:235]
    v_mfma_f32_16x16x32_bf16 a[236:239], a[56:59], a[104:107], a[236:239]
    buffer_load_dwordx4 v17, s[40:43], s49 offen offset:3072 sc1 lds
    v_mfma_f32_16x16x32_bf16 a[236:239], a[60:63], a[108:111], a[236:239]
    s_add_u32 s49, s49, 128
    v_mfma_f32_16x16x32_bf16 a[228:231], a[60:63], a[100:103], a[228:231]
    buffer_store_dwordx4 a[220:223], v2, s[24:27], s28 offen sc1
    v_mfma_f32_16x16x32_bf16 a[228:231], a[56:59], a[96:99], a[228:231]
    s_add_u32 s29, s29, s30
    s_mov_b32 s28, s29
    v_mfma_f32_16x16x32_bf16 v[80:83], a[0:3], a[112:115], v[80:83]
    v_mfma_f32_16x16x32_bf16 v[80:83], a[4:7], a[116:119], v[80:83]
    ds_read_b64_tr_b16 a[96:97], v12 offset:0
    v_mfma_f32_16x16x32_bf16 v[88:91], a[4:7], a[124:127], v[88:91]
    v_mfma_f32_16x16x32_bf16 v[88:91], a[0:3], a[120:123], v[88:91]
    s_add_u32 m0, s61, 4096
    ds_read_b128 a[0:3], v6 offset:0
    v_mfma_f32_16x16x32_bf16 v[92:95], a[8:11], a[120:123], v[92:95]
    buffer_load_dwordx4 v16, s[40:43], s50 offen offset:0 sc1 lds
    v_mfma_f32_16x16x32_bf16 v[92:95], a[12:15], a[124:127], v[92:95]
    s_add_u32 s61, s61, 32768
    ds_read_b128 a[4:7], v7 offset:0
    v_mfma_f32_16x16x32_bf16 v[84:87], a[12:15], a[116:119], v[84:87]
    s_cmp_ge_u32 s61, 98304
    s_cselect_b32 s90, 98304, 0
    ds_read_b64_tr_b16 a[98:99], v12 offset:2048
    v_mfma_f32_16x16x32_bf16 v[84:87], a[8:11], a[112:115], v[84:87]
    s_sub_u32 s61, s61, s90
    ds_read_b128 a[8:11], v6 offset:2048
    v_mfma_f32_16x16x32_bf16 v[144:147], a[16:19], a[112:115], v[144:147]
    ds_read_b128 a[12:15], v7 offset:2048
    v_mfma_f32_16x16x32_bf16 v[144:147], a[20:23], a[116:119], v[144:147]
    ds_read_b64_tr_b16 a[100:101], v12 offset:16384
    v_mfma_f32_16x16x32_bf16 v[152:155], a[20:23], a[124:127], v[152:155]
    v_mfma_f32_16x16x32_bf16 v[152:155], a[16:19], a[120:123], v[152:155]
    ds_read_b128 a[16:19], v6 offset:4096
    v_mfma_f32_16x16x32_bf16 v[156:159], a[24:27], a[120:123], v[156:159]
    buffer_load_dwordx4 v17, s[40:43], s50 offen offset:1024 sc1 lds
    v_mfma_f32_16x16x32_bf16 v[156:159], a[28:31], a[124:127], v[156:159]
    s_add_u32 s50, s50, 128
    ds_read_b128 a[20:23], v7 offset:4096
    v_mfma_f32_16x16x32_bf16 v[148:151], a[28:31], a[116:119], v[148:151]
    ds_read_b64_tr_b16 a[102:103], v12 offset:18432
    v_mfma_f32_16x16x32_bf16 v[148:151], a[24:27], a[112:115], v[148:151]
    ds_read_b128 a[24:27], v6 offset:6144
    v_mfma_f32_16x16x32_bf16 v[208:211], a[32:35], a[112:115], v[208:211]
    s_sub_u32 s65, s65, 1
    ds_read_b128 a[28:31], v7 offset:6144
    v_mfma_f32_16x16x32_bf16 v[208:211], a[36:39], a[116:119], v[208:211]
    ds_read_b64_tr_b16 a[104:105], v13 offset:0
    v_mfma_f32_16x16x32_bf16 v[216:219], a[36:39], a[124:127], v[216:219]
    v_mfma_f32_16x16x32_bf16 v[216:219], a[32:35], a[120:123], v[216:219]
    ds_read_b128 a[32:35], v6 offset:8192
    v_mfma_f32_16x16x32_bf16 v[220:223], a[40:43], a[120:123], v[220:223]
    buffer_load_dwordx4 v16, s[40:43], s51 offen offset:2048 sc1 lds
    v_mfma_f32_16x16x32_bf16 v[220:223], a[44:47], a[124:127], v[220:223]
    ds_read_b128 a[36:39], v7 offset:8192
    v_mfma_f32_16x16x32_bf16 v[212:215], a[44:47], a[116:119], v[212:215]
    ds_read_b64_tr_b16 a[106:107], v13 offset:2048
    v_mfma_f32_16x16x32_bf16 v[212:215], a[40:43], a[112:115], v[212:215]
    ds_read_b128 a[40:43], v6 offset:10240
    v_mfma_f32_16x16x32_bf16 a[240:243], a[48:51], a[112:115], a[240:243]
    ds_read_b128 a[44:47], v7 offset:10240
    v_mfma_f32_16x16x32_bf16 a[240:243], a[52:55], a[116:119], a[240:243]
    ds_read_b64_tr_b16 a[108:109], v13 offset:16384
    v_mfma_f32_16x16x32_bf16 a[248:251], a[52:55], a[124:127], a[248:251]
    v_mfma_f32_16x16x32_bf16 a[248:251], a[48:51], a[120:123], a[248:251]
    ds_read_b128 a[48:51], v6 offset:12288
    v_mfma_f32_16x16x32_bf16 a[252:255], a[56:59], a[120:123], a[252:255]
    buffer_load_dwordx4 v17, s[40:43], s51 offen offset:3072 sc1 lds
    v_mfma_f32_16x16x32_bf16 a[252:255], a[60:63], a[124:127], a[252:255]
    s_add_u32 s51, s51, 128
    ds_read_b128 a[52:55], v7 offset:12288
    v_mfma_f32_16x16x32_bf16 a[244:247], a[60:63], a[116:119], a[244:247]
    ds_read_b64_tr_b16 a[110:111], v13 offset:18432
    v_mfma_f32_16x16x32_bf16 a[244:247], a[56:59], a[112:115], a[244:247]
    ds_read_b128 a[56:59], v6 offset:14336
    ds_read_b128 a[60:63], v7 offset:14336
.p2align 3
m_loop25:
    s_waitcnt lgkmcnt(15)
    v_mfma_f32_16x16x32_bf16 v[32:35], a[0:3], a[64:67], v[32:35]
    ds_read_b64_tr_b16 a[112:113], v14 offset:0
    v_mfma_f32_16x16x32_bf16 v[32:35], a[4:7], a[68:71], v[32:35]
    ds_read_b64_tr_b16 a[114:115], v14 offset:2048
    v_mfma_f32_16x16x32_bf16 v[40:43], a[4:7], a[76:79], v[40:43]
    ds_read_b64_tr_b16 a[116:117], v14 offset:16384
    v_mfma_f32_16x16x32_bf16 v[40:43], a[0:3], a[72:75], v[40:43]
    ds_read_b64_tr_b16 a[118:119], v14 offset:18432
    v_mfma_f32_16x16x32_bf16 v[44:47], a[8:11], a[72:75], v[44:47]
    ds_read_b64_tr_b16 a[120:121], v15 offset:0
    v_mfma_f32_16x16x32_bf16 v[44:47], a[12:15], a[76:79], v[44:47]
    ds_read_b64_tr_b16 a[122:123], v15 offset:2048
    v_mfma_f32_16x16x32_bf16 v[36:39], a[12:15], a[68:71], v[36:39]
    ds_read_b64_tr_b16 a[124:125], v15 offset:16384
    v_mfma_f32_16x16x32_bf16 v[36:39], a[8:11], a[64:67], v[36:39]
    ds_read_b64_tr_b16 a[126:127], v15 offset:18432
    v_mfma_f32_16x16x32_bf16 v[96:99], a[16:19], a[64:67], v[96:99]
    v_mfma_f32_16x16x32_bf16 v[96:99], a[20:23], a[68:71], v[96:99]
    v_mfma_f32_16x16x32_bf16 v[104:107], a[20:23], a[76:79], v[104:107]
    v_mfma_f32_16x16x32_bf16 v[104:107], a[16:19], a[72:75], v[104:107]
    s_waitcnt lgkmcnt(15)
    v_mfma_f32_16x16x32_bf16 v[108:111], a[24:27], a[72:75], v[108:111]
    v_xor_b32 v8, s60, v8
    v_xor_b32 v9, s60, v9
    v_mfma_f32_16x16x32_bf16 v[108:111], a[28:31], a[76:79], v[108:111]
    v_xor_b32 v10, s60, v10
    v_xor_b32 v11, s60, v11
    v_mfma_f32_16x16x32_bf16 v[100:103], a[28:31], a[68:71], v[100:103]
    v_xor_b32 v12, s60, v12
    v_xor_b32 v13, s60, v13
    v_mfma_f32_16x16x32_bf16 v[100:103], a[24:27], a[64:67], v[100:103]
    v_xor_b32 v14, s60, v14
    v_xor_b32 v15, s60, v15
    v_mfma_f32_16x16x32_bf16 v[160:163], a[32:35], a[64:67], v[160:163]
    v_mfma_f32_16x16x32_bf16 v[160:163], a[36:39], a[68:71], v[160:163]
    v_mfma_f32_16x16x32_bf16 v[168:171], a[36:39], a[76:79], v[168:171]
    v_mfma_f32_16x16x32_bf16 v[168:171], a[32:35], a[72:75], v[168:171]
    s_waitcnt lgkmcnt(14)
    v_mfma_f32_16x16x32_bf16 v[172:175], a[40:43], a[72:75], v[172:175]
    v_mfma_f32_16x16x32_bf16 v[172:175], a[44:47], a[76:79], v[172:175]
    v_mfma_f32_16x16x32_bf16 v[164:167], a[44:47], a[68:71], v[164:167]
    v_mfma_f32_16x16x32_bf16 v[164:167], a[40:43], a[64:67], v[164:167]
    s_waitcnt lgkmcnt(11)
    v_mfma_f32_16x16x32_bf16 v[224:227], a[48:51], a[64:67], v[224:227]
    v_mfma_f32_16x16x32_bf16 v[224:227], a[52:55], a[68:71], v[224:227]
    v_mfma_f32_16x16x32_bf16 v[232:235], a[52:55], a[76:79], v[232:235]
    v_mfma_f32_16x16x32_bf16 v[232:235], a[48:51], a[72:75], v[232:235]
    s_waitcnt lgkmcnt(8)
    v_mfma_f32_16x16x32_bf16 v[236:239], a[56:59], a[72:75], v[236:239]
    v_mfma_f32_16x16x32_bf16 v[236:239], a[60:63], a[76:79], v[236:239]
    v_mfma_f32_16x16x32_bf16 v[228:231], a[60:63], a[68:71], v[228:231]
    s_waitcnt vmcnt(8) lgkmcnt(0)
    v_mfma_f32_16x16x32_bf16 v[228:231], a[56:59], a[64:67], v[228:231]
    s_barrier
    v_mfma_f32_16x16x32_bf16 v[48:51], a[0:3], a[80:83], v[48:51]
    ds_read_b64_tr_b16 a[64:65], v8 offset:0
    v_mfma_f32_16x16x32_bf16 v[48:51], a[4:7], a[84:87], v[48:51]
    s_add_u32 m0, s62, 0
    v_mfma_f32_16x16x32_bf16 v[56:59], a[4:7], a[92:95], v[56:59]
    buffer_load_dwordx4 v18, s[44:47], s52 offen offset:0 sc1 lds
    v_mfma_f32_16x16x32_bf16 v[56:59], a[0:3], a[88:91], v[56:59]
    ds_read_b64_tr_b16 a[66:67], v8 offset:2048
    v_mfma_f32_16x16x32_bf16 v[60:63], a[8:11], a[88:91], v[60:63]
    s_add_u32 s64, s64, 32768
    v_mfma_f32_16x16x32_bf16 v[60:63], a[12:15], a[92:95], v[60:63]
    s_cmp_ge_u32 s64, 98304
    s_cselect_b32 s63, 4294901760, s59
    s_cselect_b32 s64, 0, s64
    v_mfma_f32_16x16x32_bf16 v[52:55], a[12:15], a[84:87], v[52:55]
    buffer_load_dwordx4 v19, s[44:47], s52 offen offset:1024 sc1 lds
    v_mfma_f32_16x16x32_bf16 v[52:55], a[8:11], a[80:83], v[52:55]
    s_add_u32 s52, s52, s56
    ds_read_b64_tr_b16 a[68:69], v8 offset:16384
    v_mfma_f32_16x16x32_bf16 v[112:115], a[16:19], a[80:83], v[112:115]
    v_mfma_f32_16x16x32_bf16 v[112:115], a[20:23], a[84:87], v[112:115]
    v_mfma_f32_16x16x32_bf16 v[120:123], a[20:23], a[92:95], v[120:123]
    buffer_load_dwordx4 v18, s[44:47], s53 offen offset:2048 sc1 lds
    v_mfma_f32_16x16x32_bf16 v[120:123], a[16:19], a[88:91], v[120:123]
    ds_read_b64_tr_b16 a[70:71], v8 offset:18432
    v_mfma_f32_16x16x32_bf16 v[124:127], a[24:27], a[88:91], v[124:127]
    v_mfma_f32_16x16x32_bf16 v[124:127], a[28:31], a[92:95], v[124:127]
    v_mfma_f32_16x16x32_bf16 v[116:119], a[28:31], a[84:87], v[116:119]
    buffer_load_dwordx4 v19, s[44:47], s53 offen offset:3072 sc1 lds
    v_mfma_f32_16x16x32_bf16 v[116:119], a[24:27], a[80:83], v[116:119]
    s_add_u32 s53, s53, s56
    ds_read_b64_tr_b16 a[72:73], v9 offset:0
    v_mfma_f32_16x16x32_bf16 v[176:179], a[32:35], a[80:83], v[176:179]
    v_mfma_f32_16x16x32_bf16 v[176:179], a[36:39], a[84:87], v[176:179]
    s_add_u32 m0, s62, 4096
    v_mfma_f32_16x16x32_bf16 v[184:187], a[36:39], a[92:95], v[184:187]
    buffer_load_dwordx4 v20, s[44:47], s54 offen offset:0 sc1 lds
    v_mfma_f32_16x16x32_bf16 v[184:187], a[32:35], a[88:91], v[184:187]
    s_xor_b32 s62, s62, 229376
    ds_read_b64_tr_b16 a[74:75], v9 offset:2048
    v_mfma_f32_16x16x32_bf16 v[188:191], a[40:43], a[88:91], v[188:191]
    v_mfma_f32_16x16x32_bf16 v[188:191], a[44:47], a[92:95], v[188:191]
    v_mfma_f32_16x16x32_bf16 v[180:183], a[44:47], a[84:87], v[180:183]
    buffer_load_dwordx4 v21, s[44:47], s54 offen offset:1024 sc1 lds
    v_mfma_f32_16x16x32_bf16 v[180:183], a[40:43], a[80:83], v[180:183]
    s_add_u32 s54, s54, s56
    ds_read_b64_tr_b16 a[76:77], v9 offset:16384
    v_mfma_f32_16x16x32_bf16 v[240:243], a[48:51], a[80:83], v[240:243]
    v_mfma_f32_16x16x32_bf16 v[240:243], a[52:55], a[84:87], v[240:243]
    v_mfma_f32_16x16x32_bf16 v[248:251], a[52:55], a[92:95], v[248:251]
    buffer_load_dwordx4 v20, s[44:47], s55 offen offset:2048 sc1 lds
    v_mfma_f32_16x16x32_bf16 v[248:251], a[48:51], a[88:91], v[248:251]
    ds_read_b64_tr_b16 a[78:79], v9 offset:18432
    v_mfma_f32_16x16x32_bf16 v[252:255], a[56:59], a[88:91], v[252:255]
    v_add_u32 v6, s63, v6
    v_add_u32 v7, s63, v7
    v_mfma_f32_16x16x32_bf16 v[252:255], a[60:63], a[92:95], v[252:255]
    v_mfma_f32_16x16x32_bf16 v[244:247], a[60:63], a[84:87], v[244:247]
    buffer_load_dwordx4 v21, s[44:47], s55 offen offset:3072 sc1 lds
    v_mfma_f32_16x16x32_bf16 v[244:247], a[56:59], a[80:83], v[244:247]
    s_add_u32 s55, s55, s56
    v_mfma_f32_16x16x32_bf16 v[64:67], a[0:3], a[96:99], v[64:67]
    ds_read_b64_tr_b16 a[80:81], v10 offset:0
    v_mfma_f32_16x16x32_bf16 v[64:67], a[4:7], a[100:103], v[64:67]
    v_mfma_f32_16x16x32_bf16 v[72:75], a[4:7], a[108:111], v[72:75]
    v_mfma_f32_16x16x32_bf16 v[72:75], a[0:3], a[104:107], v[72:75]
    s_add_u32 m0, s61, 0
    ds_read_b64_tr_b16 a[82:83], v10 offset:2048
    v_mfma_f32_16x16x32_bf16 v[76:79], a[8:11], a[104:107], v[76:79]
    buffer_load_dwordx4 v16, s[40:43], s48 offen offset:0 sc1 lds
    v_mfma_f32_16x16x32_bf16 v[76:79], a[12:15], a[108:111], v[76:79]
    v_mfma_f32_16x16x32_bf16 v[68:71], a[12:15], a[100:103], v[68:71]
    ds_read_b64_tr_b16 a[84:85], v10 offset:16384
    v_mfma_f32_16x16x32_bf16 v[68:71], a[8:11], a[96:99], v[68:71]
    v_mfma_f32_16x16x32_bf16 v[128:131], a[16:19], a[96:99], v[128:131]
    v_mfma_f32_16x16x32_bf16 v[128:131], a[20:23], a[100:103], v[128:131]
    ds_read_b64_tr_b16 a[86:87], v10 offset:18432
    v_mfma_f32_16x16x32_bf16 v[136:139], a[20:23], a[108:111], v[136:139]
    v_mfma_f32_16x16x32_bf16 v[136:139], a[16:19], a[104:107], v[136:139]
    v_mfma_f32_16x16x32_bf16 v[140:143], a[24:27], a[104:107], v[140:143]
    buffer_load_dwordx4 v17, s[40:43], s48 offen offset:1024 sc1 lds
    v_mfma_f32_16x16x32_bf16 v[140:143], a[28:31], a[108:111], v[140:143]
    s_add_u32 s48, s48, 128
    ds_read_b64_tr_b16 a[88:89], v11 offset:0
    v_mfma_f32_16x16x32_bf16 v[132:135], a[28:31], a[100:103], v[132:135]
    v_mfma_f32_16x16x32_bf16 v[132:135], a[24:27], a[96:99], v[132:135]
    v_mfma_f32_16x16x32_bf16 v[192:195], a[32:35], a[96:99], v[192:195]
    v_mfma_f32_16x16x32_bf16 v[192:195], a[36:39], a[100:103], v[192:195]
    ds_read_b64_tr_b16 a[90:91], v11 offset:2048
    v_mfma_f32_16x16x32_bf16 v[200:203], a[36:39], a[108:111], v[200:203]
    v_mfma_f32_16x16x32_bf16 v[200:203], a[32:35], a[104:107], v[200:203]
    v_mfma_f32_16x16x32_bf16 v[204:207], a[40:43], a[104:107], v[204:207]
    buffer_load_dwordx4 v16, s[40:43], s49 offen offset:2048 sc1 lds
    v_mfma_f32_16x16x32_bf16 v[204:207], a[44:47], a[108:111], v[204:207]
    ds_read_b64_tr_b16 a[92:93], v11 offset:16384
    v_mfma_f32_16x16x32_bf16 v[196:199], a[44:47], a[100:103], v[196:199]
    v_mfma_f32_16x16x32_bf16 v[196:199], a[40:43], a[96:99], v[196:199]
    v_mfma_f32_16x16x32_bf16 a[224:227], a[48:51], a[96:99], a[224:227]
    v_mfma_f32_16x16x32_bf16 a[224:227], a[52:55], a[100:103], a[224:227]
    ds_read_b64_tr_b16 a[94:95], v11 offset:18432
    v_mfma_f32_16x16x32_bf16 a[232:235], a[52:55], a[108:111], a[232:235]
    v_mfma_f32_16x16x32_bf16 a[232:235], a[48:51], a[104:107], a[232:235]
    v_mfma_f32_16x16x32_bf16 a[236:239], a[56:59], a[104:107], a[236:239]
    buffer_load_dwordx4 v17, s[40:43], s49 offen offset:3072 sc1 lds
    v_mfma_f32_16x16x32_bf16 a[236:239], a[60:63], a[108:111], a[236:239]
    s_add_u32 s49, s49, 128
    v_mfma_f32_16x16x32_bf16 a[228:231], a[60:63], a[100:103], a[228:231]
    v_mfma_f32_16x16x32_bf16 a[228:231], a[56:59], a[96:99], a[228:231]
    v_mfma_f32_16x16x32_bf16 v[80:83], a[0:3], a[112:115], v[80:83]
    v_mfma_f32_16x16x32_bf16 v[80:83], a[4:7], a[116:119], v[80:83]
    ds_read_b64_tr_b16 a[96:97], v12 offset:0
    v_mfma_f32_16x16x32_bf16 v[88:91], a[4:7], a[124:127], v[88:91]
    v_mfma_f32_16x16x32_bf16 v[88:91], a[0:3], a[120:123], v[88:91]
    s_add_u32 m0, s61, 4096
    ds_read_b128 a[0:3], v6 offset:0
    v_mfma_f32_16x16x32_bf16 v[92:95], a[8:11], a[120:123], v[92:95]
    buffer_load_dwordx4 v16, s[40:43], s50 offen offset:0 sc1 lds
    v_mfma_f32_16x16x32_bf16 v[92:95], a[12:15], a[124:127], v[92:95]
    s_add_u32 s61, s61, 32768
    ds_read_b128 a[4:7], v7 offset:0
    v_mfma_f32_16x16x32_bf16 v[84:87], a[12:15], a[116:119], v[84:87]
    s_cmp_ge_u32 s61, 98304
    s_cselect_b32 s90, 98304, 0
    ds_read_b64_tr_b16 a[98:99], v12 offset:2048
    v_mfma_f32_16x16x32_bf16 v[84:87], a[8:11], a[112:115], v[84:87]
    s_sub_u32 s61, s61, s90
    ds_read_b128 a[8:11], v6 offset:2048
    v_mfma_f32_16x16x32_bf16 v[144:147], a[16:19], a[112:115], v[144:147]
    ds_read_b128 a[12:15], v7 offset:2048
    v_mfma_f32_16x16x32_bf16 v[144:147], a[20:23], a[116:119], v[144:147]
    ds_read_b64_tr_b16 a[100:101], v12 offset:16384
    v_mfma_f32_16x16x32_bf16 v[152:155], a[20:23], a[124:127], v[152:155]
    v_mfma_f32_16x16x32_bf16 v[152:155], a[16:19], a[120:123], v[152:155]
    ds_read_b128 a[16:19], v6 offset:4096
    v_mfma_f32_16x16x32_bf16 v[156:159], a[24:27], a[120:123], v[156:159]
    buffer_load_dwordx4 v17, s[40:43], s50 offen offset:1024 sc1 lds
    v_mfma_f32_16x16x32_bf16 v[156:159], a[28:31], a[124:127], v[156:159]
    s_add_u32 s50, s50, 128
    ds_read_b128 a[20:23], v7 offset:4096
    v_mfma_f32_16x16x32_bf16 v[148:151], a[28:31], a[116:119], v[148:151]
    ds_read_b64_tr_b16 a[102:103], v12 offset:18432
    v_mfma_f32_16x16x32_bf16 v[148:151], a[24:27], a[112:115], v[148:151]
    ds_read_b128 a[24:27], v6 offset:6144
    v_mfma_f32_16x16x32_bf16 v[208:211], a[32:35], a[112:115], v[208:211]
    s_sub_u32 s65, s65, 1
    ds_read_b128 a[28:31], v7 offset:6144
    v_mfma_f32_16x16x32_bf16 v[208:211], a[36:39], a[116:119], v[208:211]
    ds_read_b64_tr_b16 a[104:105], v13 offset:0
    v_mfma_f32_16x16x32_bf16 v[216:219], a[36:39], a[124:127], v[216:219]
    v_mfma_f32_16x16x32_bf16 v[216:219], a[32:35], a[120:123], v[216:219]
    ds_read_b128 a[32:35], v6 offset:8192
    v_mfma_f32_16x16x32_bf16 v[220:223], a[40:43], a[120:123], v[220:223]
    buffer_load_dwordx4 v16, s[40:43], s51 offen offset:2048 sc1 lds
    v_mfma_f32_16x16x32_bf16 v[220:223], a[44:47], a[124:127], v[220:223]
    ds_read_b128 a[36:39], v7 offset:8192
    v_mfma_f32_16x16x32_bf16 v[212:215], a[44:47], a[116:119], v[212:215]
    ds_read_b64_tr_b16 a[106:107], v13 offset:2048
    v_mfma_f32_16x16x32_bf16 v[212:215], a[40:43], a[112:115], v[212:215]
    ds_read_b128 a[40:43], v6 offset:10240
    v_mfma_f32_16x16x32_bf16 a[240:243], a[48:51], a[112:115], a[240:243]
    ds_read_b128 a[44:47], v7 offset:10240
    v_mfma_f32_16x16x32_bf16 a[240:243], a[52:55], a[116:119], a[240:243]
    ds_read_b64_tr_b16 a[108:109], v13 offset:16384
    v_mfma_f32_16x16x32_bf16 a[248:251], a[52:55], a[124:127], a[248:251]
    v_mfma_f32_16x16x32_bf16 a[248:251], a[48:51], a[120:123], a[248:251]
    ds_read_b128 a[48:51], v6 offset:12288
    v_mfma_f32_16x16x32_bf16 a[252:255], a[56:59], a[120:123], a[252:255]
    buffer_load_dwordx4 v17, s[40:43], s51 offen offset:3072 sc1 lds
    v_mfma_f32_16x16x32_bf16 a[252:255], a[60:63], a[124:127], a[252:255]
    s_add_u32 s51, s51, 128
    ds_read_b128 a[52:55], v7 offset:12288
    v_mfma_f32_16x16x32_bf16 a[244:247], a[60:63], a[116:119], a[244:247]
    s_cmp_gt_u32 s65, s67
    ds_read_b64_tr_b16 a[110:111], v13 offset:18432
    v_mfma_f32_16x16x32_bf16 a[244:247], a[56:59], a[112:115], a[244:247]
    ds_read_b128 a[56:59], v6 offset:14336
    ds_read_b128 a[60:63], v7 offset:14336
    s_cbranch_scc1 m_loop25
    s_cmp_eq_u32 s65, 0
    s_cbranch_scc1 m_epi15
m_dosw26:
    s_cmp_eq_u32 s94, 0
    s_cbranch_scc1 m_x61
    s_cmp_lg_u32 s65, 3
    s_cbranch_scc1 m_x67
    s_mov_b32 s42, s73
    s_lshl_b32 s90, s77, 4
    s_lshl_b32 s90, s90, s81
    s_mov_b32 s48, s79
    s_mul_i32 s91, s90, 1
    s_add_u32 s49, s91, s79
    s_sub_u32 s49, s49, 2048
    s_mul_i32 s91, s90, 2
    s_add_u32 s50, s91, s79
    s_mul_i32 s91, s90, 3
    s_add_u32 s51, s91, s79
    s_sub_u32 s51, s51, 2048
    s_lshl_b32 s90, s58, 7
    s_add_u32 s90, s90, s57
    s_lshl_b32 s91, s16, 6
    s_cmp_eq_u32 s81, 1
    s_cselect_b32 s90, s90, s91
    v_lshrrev_b32 v24, 3, v1
    v_lshlrev_b32 v24, s81, v24
    v_add_u32 v24, s90, v24
    v_mul_lo_u32 v24, v24, s77
    v_lshrrev_b32 v25, 4, v1
    v_and_b32 v26, 7, v1
    v_xor_b32 v25, v25, v26
    v_lshl_add_u32 v16, v25, 4, v24
    v_xor_b32 v25, 4, v25
    v_lshl_add_u32 v17, v25, 4, v24
    s_lshl_b32 s90, s77, 3
    s_lshl_b32 s90, s90, s81
    s_sub_u32 s90, s90, 1024
    v_add_u32 v17, s90, v17
    s_mov_b32 s40, s71
    s_mov_b32 s41, s72
    buffer_load_dwordx2 v[4:5], off, s[12:15], 0 sc1
    s_branch m_loop25
m_x67:
    s_mov_b32 s46, s76
    s_mov_b32 s52, s80
    s_lshl_b32 s90, s78, 2
    s_mul_i32 s91, s90, 1
    s_add_u32 s53, s91, s80
    s_sub_u32 s53, s53, 2048
    s_mul_i32 s91, s90, 2
    s_add_u32 s54, s91, s80
    s_mul_i32 s91, s90, 3
    s_add_u32 s55, s91, s80
    s_sub_u32 s55, s55, 2048
    s_lshl_b32 s56, s78, 6
    v_lshrrev_b32 v24, 5, v1
    s_lshl_b32 s90, s16, 4
    v_add_u32 v25, s90, v24
    v_mul_lo_u32 v25, v25, s78
    v_lshlrev_b32 v24, 1, v24
    v_and_b32 v26, 31, v1
    v_xor_b32 v24, v24, v26
    s_lshl_b32 s90, s78, 1
    s_sub_u32 s90, s90, 1024
    v_add_u32 v27, s90, v25
    v_xor_b32 v26, 0, v24
    v_lshl_add_u32 v18, v26, 4, v25
    v_xor_b32 v26, 4, v24
    v_lshl_add_u32 v19, v26, 4, v27
    v_xor_b32 v26, 8, v24
    v_lshl_add_u32 v20, v26, 4, v25
    v_xor_b32 v26, 12, v24
    v_lshl_add_u32 v21, v26, 4, v27
    s_mov_b32 s44, s74
    s_mov_b32 s45, s75
    s_mov_b32 s67, 0
    s_branch m_loop25
m_x61:
    s_cmp_le_u32 s65, 4
    s_cbranch_scc1 m_x62
    s_cmp_lg_u32 s16, 0
    s_cbranch_scc1 m_np68
    v_mov_b32 v4, s4
    v_mov_b32 v5, s5
    s_add_u32 s90, s17, 117440512
    s_mov_b64 exec, 1
    buffer_store_dwordx2 v[4:5], off, s[8:11], s90 sc1
    s_mov_b64 exec, -1
m_np68:
    s_mov_b32 s17, -1
    s_mov_b32 s67, 4
    s_branch m_loop25
m_x62:
    s_cmp_lg_u32 s65, 4
    s_cbranch_scc1 m_x63
    s_cmp_eq_u32 s70, 1
    s_cbranch_scc1 m_ea69
    buffer_load_dwordx2 v[4:5], v0, s[8:11], s37 offen sc1
m_eb70:
    s_branch m_loop25
m_x63:
    s_waitcnt vmcnt(16)
    s_cmp_lg_u32 s65, 3
    s_cbranch_scc1 m_x64
    s_cmp_eq_u32 s70, 1
    s_cbranch_scc1 m_ea71
    s_mov_b32 s3, 262144
m_spin73:
    v_cmp_ne_u64 s[22:23], s[4:5], v[4:5]
    s_nop 3
    s_cmp_eq_u64 s[22:23], 0
    s_cbranch_scc1 m_ok74
    s_sub_u32 s3, s3, 1
    s_cbranch_scc1 m_ok74
    s_sleep 16
    buffer_load_dwordx2 v[4:5], v0, s[8:11], s37 offen sc1
    s_waitcnt vmcnt(0)
    s_branch m_spin73
m_ok74:
    buffer_load_dwordx4 a[128:131], v2, s[8:11], s33 offen offset:0 sc1
    buffer_load_dwordx4 a[132:135], v2, s[8:11], s33 offen offset:1024 sc1
    buffer_load_dwordx4 a[136:139], v2, s[8:11], s33 offen offset:2048 sc1
    buffer_load_dwordx4 a[140:143], v2, s[8:11], s33 offen offset:3072 sc1
    buffer_load_dwordx4 a[144:147], v2, s[8:11], s34 offen offset:0 sc1
    buffer_load_dwordx4 a[148:151], v2, s[8:11], s34 offen offset:1024 sc1
m_eb72:
    s_add_u32 s48, s32, 0
    s_mov_b32 s49, s48
    s_add_u32 s50, s48, 4096
    s_mov_b32 s51, s50
    s_cmp_eq_u32 s57, 0
    s_cselect_b32 s42, 268435456, 0
    s_mov_b32 s40, s6
    s_mov_b32 s41, s7
    v_mov_b32 v16, v2
    v_mov_b32 v17, v2
    s_branch m_loop25
m_x64:
    s_cmp_lg_u32 s65, 2
    s_cbranch_scc1 m_x65
    s_cmp_eq_u32 s70, 1
    s_cbranch_scc1 m_ea75
    buffer_load_dwordx4 a[152:155], v2, s[8:11], s34 offen offset:2048 sc1
    buffer_load_dwordx4 a[156:159], v2, s[8:11], s34 offen offset:3072 sc1
    buffer_load_dwordx4 a[160:163], v2, s[8:11], s35 offen offset:0 sc1
    buffer_load_dwordx4 a[164:167], v2, s[8:11], s35 offen offset:1024 sc1
    buffer_load_dwordx4 a[168:171], v2, s[8:11], s35 offen offset:2048 sc1
m_eb76:
    s_add_u32 s48, s32, 16384
    s_mov_b32 s49, s48
    s_add_u32 s50, s48, 4096
    s_mov_b32 s51, s50
    s_mov_b32 s42, 268435456
    s_add_u32 s52, s32, 49152
    s_mov_b32 s53, s52
    s_add_u32 s54, s52, 4096
    s_mov_b32 s55, s54
    s_mov_b32 s46, 268435456
    s_mov_b32 s44, s6
    s_mov_b32 s45, s7
    v_mov_b32 v18, v2
    v_mov_b32 v19, v2
    v_mov_b32 v20, v2
    v_mov_b32 v21, v2
    s_branch m_loop25
m_x65:
    s_cmp_eq_u32 s70, 1
    s_cbranch_scc1 m_ea77
    buffer_load_dwordx4 a[172:175], v2, s[8:11], s35 offen offset:3072 sc1
    buffer_load_dwordx4 a[176:179], v2, s[8:11], s36 offen offset:0 sc1
    buffer_load_dwordx4 a[180:183], v2, s[8:11], s36 offen offset:1024 sc1
    buffer_load_dwordx4 a[184:187], v2, s[8:11], s36 offen offset:2048 sc1
    buffer_load_dwordx4 a[188:191], v2, s[8:11], s36 offen offset:3072 sc1
m_eb78:
    s_add_u32 s48, s32, 32768
    s_mov_b32 s49, s48
    s_add_u32 s50, s48, 4096
    s_mov_b32 s51, s50
    s_add_u32 s52, s32, 65536
    s_mov_b32 s53, s52
    s_add_u32 s54, s52, 4096
    s_mov_b32 s55, s54
    s_branch m_loop25
m_ea69:
    s_and_b32 s92, s2, 7
    s_lshl_b32 s92, s92, 2
    s_bfe_u32 s93, s2, 0x20003
    s_add_u32 s92, s92, s93
    s_lshr_b32 s93, s2, 5
    s_lshl_b32 s93, s93, 2
    s_or_b32 s93, s93, 0x40000
    v_and_b32 v0, 3, v1
    v_min_u32 v0, 2, v0
    v_and_b32 v24, 4, v1
    v_add3_u32 v0, v0, v24, 8
    v_lshlrev_b32 v0, 3, v0
    buffer_load_dwordx2 v[4:5], v0, s[8:11], s37 offen sc1
    s_branch m_eb70
m_ea71:
    s_mov_b32 s3, 262144
m_spin79:
    v_cmp_ne_u64 s[22:23], s[4:5], v[4:5]
    s_nop 3
    s_cmp_eq_u64 s[22:23], 0
    s_cbranch_scc1 m_ok80
    s_sub_u32 s3, s3, 1
    s_cbranch_scc1 m_ok80
    s_sleep 16
    buffer_load_dwordx2 v[4:5], v0, s[8:11], s37 offen sc1
    s_waitcnt vmcnt(0)
    s_branch m_spin79
m_ok80:
    s_branch m_eb72
m_ea75:
    s_and_b32 s92, s2, 7
    s_lshl_b32 s92, s92, 2
    s_bfe_u32 s93, s2, 0x20003
    s_add_u32 s92, s92, s93
    s_lshr_b32 s93, s2, 5
    s_lshl_b32 s93, s93, 2
    s_or_b32 s93, s93, 0x40000
    s_bfe_u32 s91, 873484918, s93
    s_lshr_b32 s91, s91, 1
    v_mov_b32 v0, s91
    s_bfe_u32 s91, 4225674377, s93
    s_lshr_b32 s91, s91, 1
    v_writelane_b32 v0, s91, 8
    v_lshlrev_b32 v0, 3, v0
    buffer_load_dwordx2 v[4:5], v0, s[8:11], s37 offen sc1
    s_branch m_eb76
m_ea77:
    s_mov_b32 s3, 262144
m_spin81:
    v_cmp_ne_u64 s[22:23], s[4:5], v[4:5]
    s_nop 3
    s_cmp_eq_u64 s[22:23], 0
    s_cbranch_scc1 m_ok82
    s_sub_u32 s3, s3, 1
    s_cbranch_scc1 m_ok82
    s_sleep 16
    buffer_load_dwordx2 v[4:5], v0, s[8:11], s37 offen sc1
    s_waitcnt vmcnt(0)
    s_branch m_spin81
m_ok82:
    buffer_load_dwordx4 a[128:131], v2, s[8:11], s33 offen offset:0 sc1
    buffer_load_dwordx4 a[132:135], v2, s[8:11], s33 offen offset:1024 sc1
    buffer_load_dwordx4 a[136:139], v2, s[8:11], s33 offen offset:2048 sc1
    buffer_load_dwordx4 a[140:143], v2, s[8:11], s33 offen offset:3072 sc1
    buffer_load_dwordx4 a[144:147], v2, s[8:11], s34 offen offset:0 sc1
    buffer_load_dwordx4 a[148:151], v2, s[8:11], s34 offen offset:1024 sc1
    buffer_load_dwordx4 a[152:155], v2, s[8:11], s34 offen offset:2048 sc1
    buffer_load_dwordx4 a[156:159], v2, s[8:11], s34 offen offset:3072 sc1
    buffer_load_dwordx4 a[160:163], v2, s[8:11], s35 offen offset:0 sc1
    buffer_load_dwordx4 a[164:167], v2, s[8:11], s35 offen offset:1024 sc1
    buffer_load_dwordx4 a[168:171], v2, s[8:11], s35 offen offset:2048 sc1
    buffer_load_dwordx4 a[172:175], v2, s[8:11], s35 offen offset:3072 sc1
    buffer_load_dwordx4 a[176:179], v2, s[8:11], s36 offen offset:0 sc1
    buffer_load_dwordx4 a[180:183], v2, s[8:11], s36 offen offset:1024 sc1
    buffer_load_dwordx4 a[184:187], v2, s[8:11], s36 offen offset:2048 sc1
    buffer_load_dwordx4 a[188:191], v2, s[8:11], s36 offen offset:3072 sc1
    s_branch m_eb78
m_epi15:
    s_cmp_eq_u32 s94, 0
    s_cbranch_scc1 m_last29
    s_mov_b32 s3, 262144
m_spin33:
    v_readfirstlane_b32 s4, v4
    v_readfirstlane_b32 s5, v5
    s_nop 3
    s_cmp_lg_u32 s4, 0
    s_cbranch_scc1 m_ok34
    s_sub_u32 s3, s3, 1
    s_cbranch_scc1 m_ok34
    s_sleep 32
    buffer_load_dwordx2 v[4:5], off, s[12:15], 0 sc1
    s_waitcnt vmcnt(0)
    s_branch m_spin33
m_ok34:
    s_cmp_ge_u32 s68, 16
    s_cbranch_scc1 m_q036
m_epf27:
    s_nop 7
    s_mov_b32 s91, s98
    s_mov_b32 s92, s97
    s_mov_b32 s93, s97
    s_mov_b32 s90, s91
    v_pk_mul_f32 v[32:33], v[32:33], s[92:93]
    v_pk_mul_f32 v[34:35], v[34:35], s[92:93]
    v_pk_mul_f32 v[36:37], v[36:37], s[92:93]
    v_pk_mul_f32 v[38:39], v[38:39], s[92:93]
    v_cvt_pk_bf16_f32 v32, v32, v33
    v_cvt_pk_bf16_f32 v33, v34, v35
    v_cvt_pk_bf16_f32 v34, v36, v37
    v_cvt_pk_bf16_f32 v35, v38, v39
    buffer_store_dwordx4 v[32:35], v2, s[8:11], s90 offen sc1
    s_add_u32 s90, s90, s100
    v_pk_mul_f32 v[40:41], v[40:41], s[92:93]
    v_pk_mul_f32 v[42:43], v[42:43], s[92:93]
    v_pk_mul_f32 v[44:45], v[44:45], s[92:93]
    v_pk_mul_f32 v[46:47], v[46:47], s[92:93]
    v_cvt_pk_bf16_f32 v40, v40, v41
    v_cvt_pk_bf16_f32 v41, v42, v43
    v_cvt_pk_bf16_f32 v42, v44, v45
    v_cvt_pk_bf16_f32 v43, v46, v47
    buffer_store_dwordx4 v[40:43], v2, s[8:11], s90 offen sc1
    s_add_u32 s90, s90, s100
    v_pk_mul_f32 v[48:49], v[48:49], s[92:93]
    v_pk_mul_f32 v[50:51], v[50:51], s[92:93]
    v_pk_mul_f32 v[52:53], v[52:53], s[92:93]
    v_pk_mul_f32 v[54:55], v[54:55], s[92:93]
    v_cvt_pk_bf16_f32 v48, v48, v49
    v_cvt_pk_bf16_f32 v49, v50, v51
    v_cvt_pk_bf16_f32 v50, v52, v53
    v_cvt_pk_bf16_f32 v51, v54, v55
    buffer_store_dwordx4 v[48:51], v2, s[8:11], s90 offen sc1
    s_add_u32 s90, s90, s100
    v_pk_mul_f32 v[56:57], v[56:57], s[92:93]
    v_pk_mul_f32 v[58:59], v[58:59], s[92:93]
    v_pk_mul_f32 v[60:61], v[60:61], s[92:93]
    v_pk_mul_f32 v[62:63], v[62:63], s[92:93]
    v_cvt_pk_bf16_f32 v56, v56, v57
    v_cvt_pk_bf16_f32 v57, v58, v59
    v_cvt_pk_bf16_f32 v58, v60, v61
    v_cvt_pk_bf16_f32 v59, v62, v63
    buffer_store_dwordx4 v[56:59], v2, s[8:11], s90 offen sc1
    s_add_u32 s90, s90, s100
    v_pk_mul_f32 v[64:65], v[64:65], s[92:93]
    v_pk_mul_f32 v[66:67], v[66:67], s[92:93]
    v_pk_mul_f32 v[68:69], v[68:69], s[92:93]
    v_pk_mul_f32 v[70:71], v[70:71], s[92:93]
    v_cvt_pk_bf16_f32 v64, v64, v65
    v_cvt_pk_bf16_f32 v65, v66, v67
    v_cvt_pk_bf16_f32 v66, v68, v69
    v_cvt_pk_bf16_f32 v67, v70, v71
    buffer_store_dwordx4 v[64:67], v2, s[8:11], s90 offen sc1
    s_add_u32 s90, s90, s100
    v_pk_mul_f32 v[72:73], v[72:73], s[92:93]
    v_pk_mul_f32 v[74:75], v[74:75], s[92:93]
    v_pk_mul_f32 v[76:77], v[76:77], s[92:93]
    v_pk_mul_f32 v[78:79], v[78:79], s[92:93]
    v_cvt_pk_bf16_f32 v72, v72, v73
    v_cvt_pk_bf16_f32 v73, v74, v75
    v_cvt_pk_bf16_f32 v74, v76, v77
    v_cvt_pk_bf16_f32 v75, v78, v79
    buffer_store_dwordx4 v[72:75], v2, s[8:11], s90 offen sc1
    s_add_u32 s90, s90, s100
    v_pk_mul_f32 v[80:81], v[80:81], s[92:93]
    v_pk_mul_f32 v[82:83], v[82:83], s[92:93]
    v_pk_mul_f32 v[84:85], v[84:85], s[92:93]
    v_pk_mul_f32 v[86:87], v[86:87], s[92:93]
    v_cvt_pk_bf16_f32 v80, v80, v81
    v_cvt_pk_bf16_f32 v81, v82, v83
    v_cvt_pk_bf16_f32 v82, v84, v85
    v_cvt_pk_bf16_f32 v83, v86, v87
    buffer_store_dwordx4 v[80:83], v2, s[8:11], s90 offen sc1
    s_add_u32 s90, s90, s100
    v_pk_mul_f32 v[88:89], v[88:89], s[92:93]
    v_pk_mul_f32 v[90:91], v[90:91], s[92:93]
    v_pk_mul_f32 v[92:93], v[92:93], s[92:93]
    v_pk_mul_f32 v[94:95], v[94:95], s[92:93]
    v_cvt_pk_bf16_f32 v88, v88, v89
    v_cvt_pk_bf16_f32 v89, v90, v91
    v_cvt_pk_bf16_f32 v90, v92, v93
    v_cvt_pk_bf16_f32 v91, v94, v95
    buffer_store_dwordx4 v[88:91], v2, s[8:11], s90 offen sc1
    s_add_u32 s90, s90, s100
    s_add_u32 s91, s91, s99
    s_mov_b32 s90, s91
    v_pk_mul_f32 v[96:97], v[96:97], s[92:93]
    v_pk_mul_f32 v[98:99], v[98:99], s[92:93]
    v_pk_mul_f32 v[100:101], v[100:101], s[92:93]
    v_pk_mul_f32 v[102:103], v[102:103], s[92:93]
    v_cvt_pk_bf16_f32 v96, v96, v97
    v_cvt_pk_bf16_f32 v97, v98, v99
    v_cvt_pk_bf16_f32 v98, v100, v101
    v_cvt_pk_bf16_f32 v99, v102, v103
    buffer_store_dwordx4 v[96:99], v2, s[8:11], s90 offen sc1
    s_add_u32 s90, s90, s100
    v_pk_mul_f32 v[104:105], v[104:105], s[92:93]
    v_pk_mul_f32 v[106:107], v[106:107], s[92:93]
    v_pk_mul_f32 v[108:109], v[108:109], s[92:93]
    v_pk_mul_f32 v[110:111], v[110:111], s[92:93]
    v_cvt_pk_bf16_f32 v104, v104, v105
    v_cvt_pk_bf16_f32 v105, v106, v107
    v_cvt_pk_bf16_f32 v106, v108, v109
    v_cvt_pk_bf16_f32 v107, v110, v111
    buffer_store_dwordx4 v[104:107], v2, s[8:11], s90 offen sc1
    s_add_u32 s90, s90, s100
    v_pk_mul_f32 v[112:113], v[112:113], s[92:93]
    v_pk_mul_f32 v[114:115], v[114:115], s[92:93]
    v_pk_mul_f32 v[116:117], v[116:117], s[92:93]
    v_pk_mul_f32 v[118:119], v[118:119], s[92:93]
    v_cvt_pk_bf16_f32 v112, v112, v113
    v_cvt_pk_bf16_f32 v113, v114, v115
    v_cvt_pk_bf16_f32 v114, v116, v117
    v_cvt_pk_bf16_f32 v115, v118, v119
    buffer_store_dwordx4 v[112:115], v2, s[8:11], s90 offen sc1
    s_add_u32 s90, s90, s100
    v_pk_mul_f32 v[120:121], v[120:121], s[92:93]
    v_pk_mul_f32 v[122:123], v[122:123], s[92:93]
    v_pk_mul_f32 v[124:125], v[124:125], s[92:93]
    v_pk_mul_f32 v[126:127], v[126:127], s[92:93]
    v_cvt_pk_bf16_f32 v120, v120, v121
    v_cvt_pk_bf16_f32 v121, v122, v123
    v_cvt_pk_bf16_f32 v122, v124, v125
    v_cvt_pk_bf16_f32 v123, v126, v127
    buffer_store_dwordx4 v[120:123], v2, s[8:11], s90 offen sc1
    s_add_u32 s90, s90, s100
    v_pk_mul_f32 v[128:129], v[128:129], s[92:93]
    v_pk_mul_f32 v[130:131], v[130:131], s[92:93]
    v_pk_mul_f32 v[132:133], v[132:133], s[92:93]
    v_pk_mul_f32 v[134:135], v[134:135], s[92:93]
    v_cvt_pk_bf16_f32 v128, v128, v129
    v_cvt_pk_bf16_f32 v129, v130, v131
    v_cvt_pk_bf16_f32 v130, v132, v133
    v_cvt_pk_bf16_f32 v131, v134, v135
    buffer_store_dwordx4 v[128:131], v2, s[8:11], s90 offen sc1
    s_add_u32 s90, s90, s100
    v_pk_mul_f32 v[136:137], v[136:137], s[92:93]
    v_pk_mul_f32 v[138:139], v[138:139], s[92:93]
    v_pk_mul_f32 v[140:141], v[140:141], s[92:93]
    v_pk_mul_f32 v[142:143], v[142:143], s[92:93]
    v_cvt_pk_bf16_f32 v136, v136, v137
    v_cvt_pk_bf16_f32 v137, v138, v139
    v_cvt_pk_bf16_f32 v138, v140, v141
    v_cvt_pk_bf16_f32 v139, v142, v143
    buffer_store_dwordx4 v[136:139], v2, s[8:11], s90 offen sc1
    s_add_u32 s90, s90, s100
    v_pk_mul_f32 v[144:145], v[144:145], s[92:93]
    v_pk_mul_f32 v[146:147], v[146:147], s[92:93]
    v_pk_mul_f32 v[148:149], v[148:149], s[92:93]
    v_pk_mul_f32 v[150:151], v[150:151], s[92:93]
    v_cvt_pk_bf16_f32 v144, v144, v145
    v_cvt_pk_bf16_f32 v145, v146, v147
    v_cvt_pk_bf16_f32 v146, v148, v149
    v_cvt_pk_bf16_f32 v147, v150, v151
    buffer_store_dwordx4 v[144:147], v2, s[8:11], s90 offen sc1
    s_add_u32 s90, s90, s100
    v_pk_mul_f32 v[152:153], v[152:153], s[92:93]
    v_pk_mul_f32 v[154:155], v[154:155], s[92:93]
    v_pk_mul_f32 v[156:157], v[156:157], s[92:93]
    v_pk_mul_f32 v[158:159], v[158:159], s[92:93]
    v_cvt_pk_bf16_f32 v152, v152, v153
    v_cvt_pk_bf16_f32 v153, v154, v155
    v_cvt_pk_bf16_f32 v154, v156, v157
    v_cvt_pk_bf16_f32 v155, v158, v159
    buffer_store_dwordx4 v[152:155], v2, s[8:11], s90 offen sc1
    s_add_u32 s90, s90, s100
    s_add_u32 s91, s91, s99
    s_mov_b32 s90, s91
    v_pk_mul_f32 v[160:161], v[160:161], s[92:93]
    v_pk_mul_f32 v[162:163], v[162:163], s[92:93]
    v_pk_mul_f32 v[164:165], v[164:165], s[92:93]
    v_pk_mul_f32 v[166:167], v[166:167], s[92:93]
    v_cvt_pk_bf16_f32 v160, v160, v161
    v_cvt_pk_bf16_f32 v161, v162, v163
    v_cvt_pk_bf16_f32 v162, v164, v165
    v_cvt_pk_bf16_f32 v163, v166, v167
    buffer_store_dwordx4 v[160:163], v2, s[8:11], s90 offen sc1
    s_add_u32 s90, s90, s100
    v_pk_mul_f32 v[168:169], v[168:169], s[92:93]
    v_pk_mul_f32 v[170:171], v[170:171], s[92:93]
    v_pk_mul_f32 v[172:173], v[172:173], s[92:93]
    v_pk_mul_f32 v[174:175], v[174:175], s[92:93]
    v_cvt_pk_bf16_f32 v168, v168, v169
    v_cvt_pk_bf16_f32 v169, v170, v171
    v_cvt_pk_bf16_f32 v170, v172, v173
    v_cvt_pk_bf16_f32 v171, v174, v175
    buffer_store_dwordx4 v[168:171], v2, s[8:11], s90 offen sc1
    s_add_u32 s90, s90, s100
    v_pk_mul_f32 v[176:177], v[176:177], s[92:93]
    v_pk_mul_f32 v[178:179], v[178:179], s[92:93]
    v_pk_mul_f32 v[180:181], v[180:181], s[92:93]
    v_pk_mul_f32 v[182:183], v[182:183], s[92:93]
    v_cvt_pk_bf16_f32 v176, v176, v177
    v_cvt_pk_bf16_f32 v177, v178, v179
    v_cvt_pk_bf16_f32 v178, v180, v181
    v_cvt_pk_bf16_f32 v179, v182, v183
    buffer_store_dwordx4 v[176:179], v2, s[8:11], s90 offen sc1
    s_add_u32 s90, s90, s100
    v_pk_mul_f32 v[184:185], v[184:185], s[92:93]
    v_pk_mul_f32 v[186:187], v[186:187], s[92:93]
    v_pk_mul_f32 v[188:189], v[188:189], s[92:93]
    v_pk_mul_f32 v[190:191], v[190:191], s[92:93]
    v_cvt_pk_bf16_f32 v184, v184, v185
    v_cvt_pk_bf16_f32 v185, v186, v187
    v_cvt_pk_bf16_f32 v186, v188, v189
    v_cvt_pk_bf16_f32 v187, v190, v191
    buffer_store_dwordx4 v[184:187], v2, s[8:11], s90 offen sc1
    s_add_u32 s90, s90, s100
    v_pk_mul_f32 v[192:193], v[192:193], s[92:93]
    v_pk_mul_f32 v[194:195], v[194:195], s[92:93]
    v_pk_mul_f32 v[196:197], v[196:197], s[92:93]
    v_pk_mul_f32 v[198:199], v[198:199], s[92:93]
    v_cvt_pk_bf16_f32 v192, v192, v193
    v_cvt_pk_bf16_f32 v193, v194, v195
    v_cvt_pk_bf16_f32 v194, v196, v197
    v_cvt_pk_bf16_f32 v195, v198, v199
    buffer_store_dwordx4 v[192:195], v2, s[8:11], s90 offen sc1
    s_add_u32 s90, s90, s100
    v_pk_mul_f32 v[200:201], v[200:201], s[92:93]
    v_pk_mul_f32 v[202:203], v[202:203], s[92:93]
    v_pk_mul_f32 v[204:205], v[204:205], s[92:93]
    v_pk_mul_f32 v[206:207], v[206:207], s[92:93]
    v_cvt_pk_bf16_f32 v200, v200, v201
    v_cvt_pk_bf16_f32 v201, v202, v203
    v_cvt_pk_bf16_f32 v202, v204, v205
    v_cvt_pk_bf16_f32 v203, v206, v207
    buffer_store_dwordx4 v[200:203], v2, s[8:11], s90 offen sc1
    s_add_u32 s90, s90, s100
    v_pk_mul_f32 v[208:209], v[208:209], s[92:93]
    v_pk_mul_f32 v[210:211], v[210:211], s[92:93]
    v_pk_mul_f32 v[212:213], v[212:213], s[92:93]
    v_pk_mul_f32 v[214:215], v[214:215], s[92:93]
    v_cvt_pk_bf16_f32 v208, v208, v209
    v_cvt_pk_bf16_f32 v209, v210, v211
    v_cvt_pk_bf16_f32 v210, v212, v213
    v_cvt_pk_bf16_f32 v211, v214, v215
    buffer_store_dwordx4 v[208:211], v2, s[8:11], s90 offen sc1
    s_add_u32 s90, s90, s100
    v_pk_mul_f32 v[216:217], v[216:217], s[92:93]
    v_pk_mul_f32 v[218:219], v[218:219], s[92:93]
    v_pk_mul_f32 v[220:221], v[220:221], s[92:93]
    v_pk_mul_f32 v[222:223], v[222:223], s[92:93]
    v_cvt_pk_bf16_f32 v216, v216, v217
    v_cvt_pk_bf16_f32 v217, v218, v219
    v_cvt_pk_bf16_f32 v218, v220, v221
    v_cvt_pk_bf16_f32 v219, v222, v223
    buffer_store_dwordx4 v[216:219], v2, s[8:11], s90 offen sc1
    s_add_u32 s90, s90, s100
    s_add_u32 s91, s91, s99
    s_mov_b32 s90, s91
    v_pk_mul_f32 v[224:225], v[224:225], s[92:93]
    v_pk_mul_f32 v[226:227], v[226:227], s[92:93]
    v_pk_mul_f32 v[228:229], v[228:229], s[92:93]
    v_pk_mul_f32 v[230:231], v[230:231], s[92:93]
    v_cvt_pk_bf16_f32 v224, v224, v225
    v_cvt_pk_bf16_f32 v225, v226, v227
    v_cvt_pk_bf16_f32 v226, v228, v229
    v_cvt_pk_bf16_f32 v227, v230, v231
    buffer_store_dwordx4 v[224:227], v2, s[8:11], s90 offen sc1
    s_add_u32 s90, s90, s100
    v_pk_mul_f32 v[232:233], v[232:233], s[92:93]
    v_pk_mul_f32 v[234:235], v[234:235], s[92:93]
    v_pk_mul_f32 v[236:237], v[236:237], s[92:93]
    v_pk_mul_f32 v[238:239], v[238:239], s[92:93]
    v_cvt_pk_bf16_f32 v232, v232, v233
    v_cvt_pk_bf16_f32 v233, v234, v235
    v_cvt_pk_bf16_f32 v234, v236, v237
    v_cvt_pk_bf16_f32 v235, v238, v239
    buffer_store_dwordx4 v[232:235], v2, s[8:11], s90 offen sc1
    s_add_u32 s90, s90, s100
    v_pk_mul_f32 v[240:241], v[240:241], s[92:93]
    v_pk_mul_f32 v[242:243], v[242:243], s[92:93]
    v_pk_mul_f32 v[244:245], v[244:245], s[92:93]
    v_pk_mul_f32 v[246:247], v[246:247], s[92:93]
    v_cvt_pk_bf16_f32 v240, v240, v241
    v_cvt_pk_bf16_f32 v241, v242, v243
    v_cvt_pk_bf16_f32 v242, v244, v245
    v_cvt_pk_bf16_f32 v243, v246, v247
    buffer_store_dwordx4 v[240:243], v2, s[8:11], s90 offen sc1
    s_add_u32 s90, s90, s100
    v_pk_mul_f32 v[248:249], v[248:249], s[92:93]
    v_pk_mul_f32 v[250:251], v[250:251], s[92:93]
    v_pk_mul_f32 v[252:253], v[252:253], s[92:93]
    v_pk_mul_f32 v[254:255], v[254:255], s[92:93]
    v_cvt_pk_bf16_f32 v248, v248, v249
    v_cvt_pk_bf16_f32 v249, v250, v251
    v_cvt_pk_bf16_f32 v250, v252, v253
    v_cvt_pk_bf16_f32 v251, v254, v255
    buffer_store_dwordx4 v[248:251], v2, s[8:11], s90 offen sc1
    s_add_u32 s90, s90, s100
    v_accvgpr_read_b32 v24, a224
    v_accvgpr_read_b32 v25, a225
    v_accvgpr_read_b32 v26, a226
    v_accvgpr_read_b32 v27, a227
    v_accvgpr_read_b32 v28, a228
    v_accvgpr_read_b32 v29, a229
    v_accvgpr_read_b32 v30, a230
    v_accvgpr_read_b32 v31, a231
    v_pk_mul_f32 v[24:25], v[24:25], s[92:93]
    v_pk_mul_f32 v[26:27], v[26:27], s[92:93]
    v_pk_mul_f32 v[28:29], v[28:29], s[92:93]
    v_pk_mul_f32 v[30:31], v[30:31], s[92:93]
    v_cvt_pk_bf16_f32 v24, v24, v25
    v_cvt_pk_bf16_f32 v25, v26, v27
    v_cvt_pk_bf16_f32 v26, v28, v29
    v_cvt_pk_bf16_f32 v27, v30, v31
    buffer_store_dwordx4 v[24:27], v2, s[8:11], s90 offen sc1
    s_add_u32 s90, s90, s100
    s_nop 1
    v_accvgpr_read_b32 v24, a232
    v_accvgpr_read_b32 v25, a233
    v_accvgpr_read_b32 v26, a234
    v_accvgpr_read_b32 v27, a235
    v_accvgpr_read_b32 v28, a236
    v_accvgpr_read_b32 v29, a237
    v_accvgpr_read_b32 v30, a238
    v_accvgpr_read_b32 v31, a239
    v_pk_mul_f32 v[24:25], v[24:25], s[92:93]
    v_pk_mul_f32 v[26:27], v[26:27], s[92:93]
    v_pk_mul_f32 v[28:29], v[28:29], s[92:93]
    v_pk_mul_f32 v[30:31], v[30:31], s[92:93]
    v_cvt_pk_bf16_f32 v24, v24, v25
    v_cvt_pk_bf16_f32 v25, v26, v27
    v_cvt_pk_bf16_f32 v26, v28, v29
    v_cvt_pk_bf16_f32 v27, v30, v31
    buffer_store_dwordx4 v[24:27], v2, s[8:11], s90 offen sc1
    s_add_u32 s90, s90, s100
    s_nop 1
    v_accvgpr_read_b32 v24, a240
    v_accvgpr_read_b32 v25, a241
    v_accvgpr_read_b32 v26, a242
    v_accvgpr_read_b32 v27, a243
    v_accvgpr_read_b32 v28, a244
    v_accvgpr_read_b32 v29, a245
    v_accvgpr_read_b32 v30, a246
    v_accvgpr_read_b32 v31, a247
    v_pk_mul_f32 v[24:25], v[24:25], s[92:93]
    v_pk_mul_f32 v[26:27], v[26:27], s[92:93]
    v_pk_mul_f32 v[28:29], v[28:29], s[92:93]
    v_pk_mul_f32 v[30:31], v[30:31], s[92:93]
    v_cvt_pk_bf16_f32 v24, v24, v25
    v_cvt_pk_bf16_f32 v25, v26, v27
    v_cvt_pk_bf16_f32 v26, v28, v29
    v_cvt_pk_bf16_f32 v27, v30, v31
    buffer_store_dwordx4 v[24:27], v2, s[8:11], s90 offen sc1
    s_add_u32 s90, s90, s100
    s_nop 1
    v_accvgpr_read_b32 v24, a248
    v_accvgpr_read_b32 v25, a249
    v_accvgpr_read_b32 v26, a250
    v_accvgpr_read_b32 v27, a251
    v_accvgpr_read_b32 v28, a252
    v_accvgpr_read_b32 v29, a253
    v_accvgpr_read_b32 v30, a254
    v_accvgpr_read_b32 v31, a255
    v_pk_mul_f32 v[24:25], v[24:25], s[92:93]
    v_pk_mul_f32 v[26:27], v[26:27], s[92:93]
    v_pk_mul_f32 v[28:29], v[28:29], s[92:93]
    v_pk_mul_f32 v[30:31], v[30:31], s[92:93]
    v_cvt_pk_bf16_f32 v24, v24, v25
    v_cvt_pk_bf16_f32 v25, v26, v27
    v_cvt_pk_bf16_f32 v26, v28, v29
    v_cvt_pk_bf16_f32 v27, v30, v31
    buffer_store_dwordx4 v[24:27], v2, s[8:11], s90 offen sc1
    s_add_u32 s90, s90, s100
    s_nop 1
    s_add_u32 s91, s91, s99
m_epf27_r:
    s_mov_b32 s17, s101
    s_mov_b32 s66, 2
    s_branch m_q135
m_q036:
m_eps28:
    s_nop 3
    s_mov_b32 s90, s98
    v_cvt_pk_bf16_f32 v32, v32, v33
    v_cvt_pk_bf16_f32 v33, v34, v35
    v_cvt_pk_bf16_f32 v34, v36, v37
    v_cvt_pk_bf16_f32 v35, v38, v39
    buffer_store_dwordx4 v[32:35], v2, s[8:11], s90 offen sc1
    s_add_u32 s90, s90, s100
    v_cvt_pk_bf16_f32 v40, v40, v41
    v_cvt_pk_bf16_f32 v41, v42, v43
    v_cvt_pk_bf16_f32 v42, v44, v45
    v_cvt_pk_bf16_f32 v43, v46, v47
    buffer_store_dwordx4 v[40:43], v2, s[8:11], s90 offen sc1
    s_add_u32 s90, s90, s100
    v_cvt_pk_bf16_f32 v48, v48, v49
    v_cvt_pk_bf16_f32 v49, v50, v51
    v_cvt_pk_bf16_f32 v50, v52, v53
    v_cvt_pk_bf16_f32 v51, v54, v55
    buffer_store_dwordx4 v[48:51], v2, s[8:11], s90 offen sc1
    s_add_u32 s90, s90, s100
    v_cvt_pk_bf16_f32 v56, v56, v57
    v_cvt_pk_bf16_f32 v57, v58, v59
    v_cvt_pk_bf16_f32 v58, v60, v61
    v_cvt_pk_bf16_f32 v59, v62, v63
    buffer_store_dwordx4 v[56:59], v2, s[8:11], s90 offen sc1
    s_add_u32 s90, s90, s100
    v_cvt_pk_bf16_f32 v64, v64, v65
    v_cvt_pk_bf16_f32 v65, v66, v67
    v_cvt_pk_bf16_f32 v66, v68, v69
    v_cvt_pk_bf16_f32 v67, v70, v71
    buffer_store_dwordx4 v[64:67], v2, s[8:11], s90 offen sc1
    s_add_u32 s90, s90, s100
    v_cvt_pk_bf16_f32 v72, v72, v73
    v_cvt_pk_bf16_f32 v73, v74, v75
    v_cvt_pk_bf16_f32 v74, v76, v77
    v_cvt_pk_bf16_f32 v75, v78, v79
    buffer_store_dwordx4 v[72:75], v2, s[8:11], s90 offen sc1
    s_add_u32 s90, s90, s100
    v_cvt_pk_bf16_f32 v80, v80, v81
    v_cvt_pk_bf16_f32 v81, v82, v83
    v_cvt_pk_bf16_f32 v82, v84, v85
    v_cvt_pk_bf16_f32 v83, v86, v87
    buffer_store_dwordx4 v[80:83], v2, s[8:11], s90 offen sc1
    s_add_u32 s90, s90, s100
    v_cvt_pk_bf16_f32 v88, v88, v89
    v_cvt_pk_bf16_f32 v89, v90, v91
    v_cvt_pk_bf16_f32 v90, v92, v93
    v_cvt_pk_bf16_f32 v91, v94, v95
    buffer_store_dwordx4 v[88:91], v2, s[8:11], s90 offen sc1
    s_add_u32 s90, s90, s100
    v_cvt_pk_bf16_f32 v96, v96, v97
    v_cvt_pk_bf16_f32 v97, v98, v99
    v_cvt_pk_bf16_f32 v98, v100, v101
    v_cvt_pk_bf16_f32 v99, v102, v103
    v_accvgpr_write_b32 a128, v96
    v_accvgpr_write_b32 a129, v97
    v_accvgpr_write_b32 a130, v98
    v_accvgpr_write_b32 a131, v99
    v_cvt_pk_bf16_f32 v104, v104, v105
    v_cvt_pk_bf16_f32 v105, v106, v107
    v_cvt_pk_bf16_f32 v106, v108, v109
    v_cvt_pk_bf16_f32 v107, v110, v111
    v_accvgpr_write_b32 a132, v104
    v_accvgpr_write_b32 a133, v105
    v_accvgpr_write_b32 a134, v106
    v_accvgpr_write_b32 a135, v107
    v_cvt_pk_bf16_f32 v112, v112, v113
    v_cvt_pk_bf16_f32 v113, v114, v115
    v_cvt_pk_bf16_f32 v114, v116, v117
    v_cvt_pk_bf16_f32 v115, v118, v119
    v_accvgpr_write_b32 a136, v112
    v_accvgpr_write_b32 a137, v113
    v_accvgpr_write_b32 a138, v114
    v_accvgpr_write_b32 a139, v115
    v_cvt_pk_bf16_f32 v120, v120, v121
    v_cvt_pk_bf16_f32 v121, v122, v123
    v_cvt_pk_bf16_f32 v122, v124, v125
    v_cvt_pk_bf16_f32 v123, v126, v127
    v_accvgpr_write_b32 a140, v120
    v_accvgpr_write_b32 a141, v121
    v_accvgpr_write_b32 a142, v122
    v_accvgpr_write_b32 a143, v123
    v_cvt_pk_bf16_f32 v128, v128, v129
    v_cvt_pk_bf16_f32 v129, v130, v131
    v_cvt_pk_bf16_f32 v130, v132, v133
    v_cvt_pk_bf16_f32 v131, v134, v135
    v_accvgpr_write_b32 a144, v128
    v_accvgpr_write_b32 a145, v129
    v_accvgpr_write_b32 a146, v130
    v_accvgpr_write_b32 a147, v131
    v_cvt_pk_bf16_f32 v136, v136, v137
    v_cvt_pk_bf16_f32 v137, v138, v139
    v_cvt_pk_bf16_f32 v138, v140, v141
    v_cvt_pk_bf16_f32 v139, v142, v143
    v_accvgpr_write_b32 a148, v136
    v_accvgpr_write_b32 a149, v137
    v_accvgpr_write_b32 a150, v138
    v_accvgpr_write_b32 a151, v139
    v_cvt_pk_bf16_f32 v144, v144, v145
    v_cvt_pk_bf16_f32 v145, v146, v147
    v_cvt_pk_bf16_f32 v146, v148, v149
    v_cvt_pk_bf16_f32 v147, v150, v151
    v_accvgpr_write_b32 a152, v144
    v_accvgpr_write_b32 a153, v145
    v_accvgpr_write_b32 a154, v146
    v_accvgpr_write_b32 a155, v147
    v_cvt_pk_bf16_f32 v152, v152, v153
    v_cvt_pk_bf16_f32 v153, v154, v155
    v_cvt_pk_bf16_f32 v154, v156, v157
    v_cvt_pk_bf16_f32 v155, v158, v159
    v_accvgpr_write_b32 a156, v152
    v_accvgpr_write_b32 a157, v153
    v_accvgpr_write_b32 a158, v154
    v_accvgpr_write_b32 a159, v155
    v_cvt_pk_bf16_f32 v160, v160, v161
    v_cvt_pk_bf16_f32 v161, v162, v163
    v_cvt_pk_bf16_f32 v162, v164, v165
    v_cvt_pk_bf16_f32 v163, v166, v167
    v_accvgpr_write_b32 a160, v160
    v_accvgpr_write_b32 a161, v161
    v_accvgpr_write_b32 a162, v162
    v_accvgpr_write_b32 a163, v163
    v_cvt_pk_bf16_f32 v168, v168, v169
    v_cvt_pk_bf16_f32 v169, v170, v171
    v_cvt_pk_bf16_f32 v170, v172, v173
    v_cvt_pk_bf16_f32 v171, v174, v175
    v_accvgpr_write_b32 a164, v168
    v_accvgpr_write_b32 a165, v169
    v_accvgpr_write_b32 a166, v170
    v_accvgpr_write_b32 a167, v171
    v_cvt_pk_bf16_f32 v176, v176, v177
    v_cvt_pk_bf16_f32 v177, v178, v179
    v_cvt_pk_bf16_f32 v178, v180, v181
    v_cvt_pk_bf16_f32 v179, v182, v183
    v_accvgpr_write_b32 a168, v176
    v_accvgpr_write_b32 a169, v177
    v_accvgpr_write_b32 a170, v178
    v_accvgpr_write_b32 a171, v179
    v_cvt_pk_bf16_f32 v184, v184, v185
    v_cvt_pk_bf16_f32 v185, v186, v187
    v_cvt_pk_bf16_f32 v186, v188, v189
    v_cvt_pk_bf16_f32 v187, v190, v191
    v_accvgpr_write_b32 a172, v184
    v_accvgpr_write_b32 a173, v185
    v_accvgpr_write_b32 a174, v186
    v_accvgpr_write_b32 a175, v187
    v_cvt_pk_bf16_f32 v192, v192, v193
    v_cvt_pk_bf16_f32 v193, v194, v195
    v_cvt_pk_bf16_f32 v194, v196, v197
    v_cvt_pk_bf16_f32 v195, v198, v199
    v_accvgpr_write_b32 a176, v192
    v_accvgpr_write_b32 a177, v193
    v_accvgpr_write_b32 a178, v194
    v_accvgpr_write_b32 a179, v195
    v_cvt_pk_bf16_f32 v200, v200, v201
    v_cvt_pk_bf16_f32 v201, v202, v203
    v_cvt_pk_bf16_f32 v202, v204, v205
    v_cvt_pk_bf16_f32 v203, v206, v207
    v_accvgpr_write_b32 a180, v200
    v_accvgpr_write_b32 a181, v201
    v_accvgpr_write_b32 a182, v202
    v_accvgpr_write_b32 a183, v203
    v_cvt_pk_bf16_f32 v208, v208, v209
    v_cvt_pk_bf16_f32 v209, v210, v211
    v_cvt_pk_bf16_f32 v210, v212, v213
    v_cvt_pk_bf16_f32 v211, v214, v215
    v_accvgpr_write_b32 a184, v208
    v_accvgpr_write_b32 a185, v209
    v_accvgpr_write_b32 a186, v210
    v_accvgpr_write_b32 a187, v211
    v_cvt_pk_bf16_f32 v216, v216, v217
    v_cvt_pk_bf16_f32 v217, v218, v219
    v_cvt_pk_bf16_f32 v218, v220, v221
    v_cvt_pk_bf16_f32 v219, v222, v223
    v_accvgpr_write_b32 a188, v216
    v_accvgpr_write_b32 a189, v217
    v_accvgpr_write_b32 a190, v218
    v_accvgpr_write_b32 a191, v219
    v_cvt_pk_bf16_f32 v224, v224, v225
    v_cvt_pk_bf16_f32 v225, v226, v227
    v_cvt_pk_bf16_f32 v226, v228, v229
    v_cvt_pk_bf16_f32 v227, v230, v231
    v_accvgpr_write_b32 a192, v224
    v_accvgpr_write_b32 a193, v225
    v_accvgpr_write_b32 a194, v226
    v_accvgpr_write_b32 a195, v227
    v_cvt_pk_bf16_f32 v232, v232, v233
    v_cvt_pk_bf16_f32 v233, v234, v235
    v_cvt_pk_bf16_f32 v234, v236, v237
    v_cvt_pk_bf16_f32 v235, v238, v239
    v_accvgpr_write_b32 a196, v232
    v_accvgpr_write_b32 a197, v233
    v_accvgpr_write_b32 a198, v234
    v_accvgpr_write_b32 a199, v235
    v_cvt_pk_bf16_f32 v240, v240, v241
    v_cvt_pk_bf16_f32 v241, v242, v243
    v_cvt_pk_bf16_f32 v242, v244, v245
    v_cvt_pk_bf16_f32 v243, v246, v247
    v_accvgpr_write_b32 a200, v240
    v_accvgpr_write_b32 a201, v241
    v_accvgpr_write_b32 a202, v242
    v_accvgpr_write_b32 a203, v243
    v_cvt_pk_bf16_f32 v248, v248, v249
    v_cvt_pk_bf16_f32 v249, v250, v251
    v_cvt_pk_bf16_f32 v250, v252, v253
    v_cvt_pk_bf16_f32 v251, v254, v255
    v_accvgpr_write_b32 a204, v248
    v_accvgpr_write_b32 a205, v249
    v_accvgpr_write_b32 a206, v250
    v_accvgpr_write_b32 a207, v251
    v_accvgpr_read_b32 v24, a224
    v_accvgpr_read_b32 v25, a225
    v_accvgpr_read_b32 v26, a226
    v_accvgpr_read_b32 v27, a227
    v_accvgpr_read_b32 v28, a228
    v_accvgpr_read_b32 v29, a229
    v_accvgpr_read_b32 v30, a230
    v_accvgpr_read_b32 v31, a231
    v_cvt_pk_bf16_f32 v24, v24, v25
    v_cvt_pk_bf16_f32 v25, v26, v27
    v_cvt_pk_bf16_f32 v26, v28, v29
    v_cvt_pk_bf16_f32 v27, v30, v31
    v_accvgpr_write_b32 a208, v24
    v_accvgpr_write_b32 a209, v25
    v_accvgpr_write_b32 a210, v26
    v_accvgpr_write_b32 a211, v27
    v_accvgpr_read_b32 v24, a232
    v_accvgpr_read_b32 v25, a233
    v_accvgpr_read_b32 v26, a234
    v_accvgpr_read_b32 v27, a235
    v_accvgpr_read_b32 v28, a236
    v_accvgpr_read_b32 v29, a237
    v_accvgpr_read_b32 v30, a238
    v_accvgpr_read_b32 v31, a239
    v_cvt_pk_bf16_f32 v24, v24, v25
    v_cvt_pk_bf16_f32 v25, v26, v27
    v_cvt_pk_bf16_f32 v26, v28, v29
    v_cvt_pk_bf16_f32 v27, v30, v31
    v_accvgpr_write_b32 a212, v24
    v_accvgpr_write_b32 a213, v25
    v_accvgpr_write_b32 a214, v26
    v_accvgpr_write_b32 a215, v27
    v_accvgpr_read_b32 v24, a240
    v_accvgpr_read_b32 v25, a241
    v_accvgpr_read_b32 v26, a242
    v_accvgpr_read_b32 v27, a243
    v_accvgpr_read_b32 v28, a244
    v_accvgpr_read_b32 v29, a245
    v_accvgpr_read_b32 v30, a246
    v_accvgpr_read_b32 v31, a247
    v_cvt_pk_bf16_f32 v24, v24, v25
    v_cvt_pk_bf16_f32 v25, v26, v27
    v_cvt_pk_bf16_f32 v26, v28, v29
    v_cvt_pk_bf16_f32 v27, v30, v31
    v_accvgpr_write_b32 a216, v24
    v_accvgpr_write_b32 a217, v25
    v_accvgpr_write_b32 a218, v26
    v_accvgpr_write_b32 a219, v27
    v_accvgpr_read_b32 v24, a248
    v_accvgpr_read_b32 v25, a249
    v_accvgpr_read_b32 v26, a250
    v_accvgpr_read_b32 v27, a251
    v_accvgpr_read_b32 v28, a252
    v_accvgpr_read_b32 v29, a253
    v_accvgpr_read_b32 v30, a254
    v_accvgpr_read_b32 v31, a255
    v_cvt_pk_bf16_f32 v24, v24, v25
    v_cvt_pk_bf16_f32 v25, v26, v27
    v_cvt_pk_bf16_f32 v26, v28, v29
    v_cvt_pk_bf16_f32 v27, v30, v31
    v_accvgpr_write_b32 a220, v24
    v_accvgpr_write_b32 a221, v25
    v_accvgpr_write_b32 a222, v26
    v_accvgpr_write_b32 a223, v27
m_eps28_r:
    s_mov_b32 s17, s101
    s_add_u32 s28, s98, s99
    s_mov_b32 s29, s28
    s_mov_b32 s30, s99
    s_mov_b32 s31, s100
    s_mov_b32 s26, 268435456
m_q135:
    s_mov_b32 s95, s82
    s_mov_b32 s96, s83
    s_mov_b32 s97, s84
    s_mov_b32 s98, s85
    s_mov_b32 s99, s86
    s_mov_b32 s100, s87
    s_mov_b32 s101, s88
    s_sub_u32 s67, s95, 5
    s_max_u32 s67, s67, 4
    s_mov_b32 s94, 0
    s_branch m_tile14
m_last29:
m_kvl32:
    s_waitcnt lgkmcnt(0)
    v_mov_b32 v6, v2
    ds_read_b128 a[192:195], v6 offset:0
    ds_read_b128 a[196:199], v6 offset:1024
    ds_read_b128 a[200:203], v6 offset:2048
    ds_read_b128 a[204:207], v6 offset:3072
    ds_read_b128 a[208:211], v6 offset:4096
    ds_read_b128 a[212:215], v6 offset:5120
    ds_read_b128 a[216:219], v6 offset:6144
    ds_read_b128 a[220:223], v6 offset:7168
    s_load_dwordx2 s[48:49], s[0:1], 64
    s_load_dwordx2 s[50:51], s[0:1], 16
    s_load_dwordx2 s[54:55], s[0:1], 72
    s_mov_b32 s47, 0x20000
m_epl85:
    s_mov_b32 s92, s97
    s_mov_b32 s93, s97
    s_cmp_eq_u32 s97, 0
    s_cbranch_scc1 m_ns286
    s_mov_b32 s90, s98
    v_pk_mul_f32 v[32:33], v[32:33], s[92:93]
    v_pk_mul_f32 v[34:35], v[34:35], s[92:93]
    v_pk_mul_f32 v[36:37], v[36:37], s[92:93]
    v_pk_mul_f32 v[38:39], v[38:39], s[92:93]
    v_cvt_pk_bf16_f32 v32, v32, v33
    v_cvt_pk_bf16_f32 v33, v34, v35
    v_cvt_pk_bf16_f32 v34, v36, v37
    v_cvt_pk_bf16_f32 v35, v38, v39
    buffer_store_dwordx4 v[32:35], v2, s[8:11], s90 offen sc1
    s_add_u32 s90, s90, s100
    v_accvgpr_write_b32 a0, 0
    v_accvgpr_write_b32 a1, 0
    v_accvgpr_write_b32 a2, 0
    v_accvgpr_write_b32 a3, 0
    v_accvgpr_write_b32 a4, 0
    v_accvgpr_write_b32 a5, 0
    v_accvgpr_write_b32 a6, 0
    v_accvgpr_write_b32 a7, 0
    v_pk_mul_f32 v[192:193], v[192:193], s[92:93]
    v_pk_mul_f32 v[194:195], v[194:195], s[92:93]
    v_pk_mul_f32 v[196:197], v[196:197], s[92:93]
    v_pk_mul_f32 v[198:199], v[198:199], s[92:93]
    v_cvt_pk_bf16_f32 v192, v192, v193
    v_cvt_pk_bf16_f32 v193, v194, v195
    v_cvt_pk_bf16_f32 v194, v196, v197
    v_cvt_pk_bf16_f32 v195, v198, v199
    v_pk_mul_f32 v[40:41], v[40:41], s[92:93]
    v_pk_mul_f32 v[42:43], v[42:43], s[92:93]
    v_pk_mul_f32 v[44:45], v[44:45], s[92:93]
    v_pk_mul_f32 v[46:47], v[46:47], s[92:93]
    v_cvt_pk_bf16_f32 v40, v40, v41
    v_cvt_pk_bf16_f32 v41, v42, v43
    v_cvt_pk_bf16_f32 v42, v44, v45
    v_cvt_pk_bf16_f32 v43, v46, v47
    buffer_store_dwordx4 v[40:43], v2, s[8:11], s90 offen sc1
    s_add_u32 s90, s90, s100
    v_accvgpr_write_b32 a8, 0
    v_accvgpr_write_b32 a9, 0
    v_accvgpr_write_b32 a10, 0
    v_accvgpr_write_b32 a11, 0
    v_accvgpr_write_b32 a12, 0
    v_accvgpr_write_b32 a13, 0
    v_accvgpr_write_b32 a14, 0
    v_accvgpr_write_b32 a15, 0
    v_pk_mul_f32 v[200:201], v[200:201], s[92:93]
    v_pk_mul_f32 v[202:203], v[202:203], s[92:93]
    v_pk_mul_f32 v[204:205], v[204:205], s[92:93]
    v_pk_mul_f32 v[206:207], v[206:207], s[92:93]
    v_cvt_pk_bf16_f32 v196, v200, v201
    v_cvt_pk_bf16_f32 v197, v202, v203
    v_cvt_pk_bf16_f32 v198, v204, v205
    v_cvt_pk_bf16_f32 v199, v206, v207
    v_pk_mul_f32 v[48:49], v[48:49], s[92:93]
    v_pk_mul_f32 v[50:51], v[50:51], s[92:93]
    v_pk_mul_f32 v[52:53], v[52:53], s[92:93]
    v_pk_mul_f32 v[54:55], v[54:55], s[92:93]
    v_cvt_pk_bf16_f32 v48, v48, v49
    v_cvt_pk_bf16_f32 v49, v50, v51
    v_cvt_pk_bf16_f32 v50, v52, v53
    v_cvt_pk_bf16_f32 v51, v54, v55
    buffer_store_dwordx4 v[48:51], v2, s[8:11], s90 offen sc1
    s_add_u32 s90, s90, s100
    v_accvgpr_write_b32 a16, 0
    v_accvgpr_write_b32 a17, 0
    v_accvgpr_write_b32 a18, 0
    v_accvgpr_write_b32 a19, 0
    v_accvgpr_write_b32 a20, 0
    v_accvgpr_write_b32 a21, 0
    v_accvgpr_write_b32 a22, 0
    v_accvgpr_write_b32 a23, 0
    v_pk_mul_f32 v[208:209], v[208:209], s[92:93]
    v_pk_mul_f32 v[210:211], v[210:211], s[92:93]
    v_pk_mul_f32 v[212:213], v[212:213], s[92:93]
    v_pk_mul_f32 v[214:215], v[214:215], s[92:93]
    v_cvt_pk_bf16_f32 v200, v208, v209
    v_cvt_pk_bf16_f32 v201, v210, v211
    v_cvt_pk_bf16_f32 v202, v212, v213
    v_cvt_pk_bf16_f32 v203, v214, v215
    v_pk_mul_f32 v[56:57], v[56:57], s[92:93]
    v_pk_mul_f32 v[58:59], v[58:59], s[92:93]
    v_pk_mul_f32 v[60:61], v[60:61], s[92:93]
    v_pk_mul_f32 v[62:63], v[62:63], s[92:93]
    v_cvt_pk_bf16_f32 v56, v56, v57
    v_cvt_pk_bf16_f32 v57, v58, v59
    v_cvt_pk_bf16_f32 v58, v60, v61
    v_cvt_pk_bf16_f32 v59, v62, v63
    buffer_store_dwordx4 v[56:59], v2, s[8:11], s90 offen sc1
    s_add_u32 s90, s90, s100
    v_accvgpr_write_b32 a24, 0
    v_accvgpr_write_b32 a25, 0
    v_accvgpr_write_b32 a26, 0
    v_accvgpr_write_b32 a27, 0
    v_accvgpr_write_b32 a28, 0
    v_accvgpr_write_b32 a29, 0
    v_accvgpr_write_b32 a30, 0
    v_accvgpr_write_b32 a31, 0
    v_pk_mul_f32 v[216:217], v[216:217], s[92:93]
    v_pk_mul_f32 v[218:219], v[218:219], s[92:93]
    v_pk_mul_f32 v[220:221], v[220:221], s[92:93]
    v_pk_mul_f32 v[222:223], v[222:223], s[92:93]
    v_cvt_pk_bf16_f32 v204, v216, v217
    v_cvt_pk_bf16_f32 v205, v218, v219
    v_cvt_pk_bf16_f32 v206, v220, v221
    v_cvt_pk_bf16_f32 v207, v222, v223
    v_pk_mul_f32 v[64:65], v[64:65], s[92:93]
    v_pk_mul_f32 v[66:67], v[66:67], s[92:93]
    v_pk_mul_f32 v[68:69], v[68:69], s[92:93]
    v_pk_mul_f32 v[70:71], v[70:71], s[92:93]
    v_cvt_pk_bf16_f32 v64, v64, v65
    v_cvt_pk_bf16_f32 v65, v66, v67
    v_cvt_pk_bf16_f32 v66, v68, v69
    v_cvt_pk_bf16_f32 v67, v70, v71
    buffer_store_dwordx4 v[64:67], v2, s[8:11], s90 offen sc1
    s_add_u32 s90, s90, s100
    v_accvgpr_write_b32 a32, 0
    v_accvgpr_write_b32 a33, 0
    v_accvgpr_write_b32 a34, 0
    v_accvgpr_write_b32 a35, 0
    v_accvgpr_write_b32 a36, 0
    v_accvgpr_write_b32 a37, 0
    v_accvgpr_write_b32 a38, 0
    v_accvgpr_write_b32 a39, 0
    v_pk_mul_f32 v[224:225], v[224:225], s[92:93]
    v_pk_mul_f32 v[226:227], v[226:227], s[92:93]
    v_pk_mul_f32 v[228:229], v[228:229], s[92:93]
    v_pk_mul_f32 v[230:231], v[230:231], s[92:93]
    v_cvt_pk_bf16_f32 v208, v224, v225
    v_cvt_pk_bf16_f32 v209, v226, v227
    v_cvt_pk_bf16_f32 v210, v228, v229
    v_cvt_pk_bf16_f32 v211, v230, v231
    v_pk_mul_f32 v[72:73], v[72:73], s[92:93]
    v_pk_mul_f32 v[74:75], v[74:75], s[92:93]
    v_pk_mul_f32 v[76:77], v[76:77], s[92:93]
    v_pk_mul_f32 v[78:79], v[78:79], s[92:93]
    v_cvt_pk_bf16_f32 v72, v72, v73
    v_cvt_pk_bf16_f32 v73, v74, v75
    v_cvt_pk_bf16_f32 v74, v76, v77
    v_cvt_pk_bf16_f32 v75, v78, v79
    buffer_store_dwordx4 v[72:75], v2, s[8:11], s90 offen sc1
    s_add_u32 s90, s90, s100
    v_accvgpr_write_b32 a40, 0
    v_accvgpr_write_b32 a41, 0
    v_accvgpr_write_b32 a42, 0
    v_accvgpr_write_b32 a43, 0
    v_accvgpr_write_b32 a44, 0
    v_accvgpr_write_b32 a45, 0
    v_accvgpr_write_b32 a46, 0
    v_accvgpr_write_b32 a47, 0
    v_pk_mul_f32 v[232:233], v[232:233], s[92:93]
    v_pk_mul_f32 v[234:235], v[234:235], s[92:93]
    v_pk_mul_f32 v[236:237], v[236:237], s[92:93]
    v_pk_mul_f32 v[238:239], v[238:239], s[92:93]
    v_cvt_pk_bf16_f32 v212, v232, v233
    v_cvt_pk_bf16_f32 v213, v234, v235
    v_cvt_pk_bf16_f32 v214, v236, v237
    v_cvt_pk_bf16_f32 v215, v238, v239
    v_pk_mul_f32 v[80:81], v[80:81], s[92:93]
    v_pk_mul_f32 v[82:83], v[82:83], s[92:93]
    v_pk_mul_f32 v[84:85], v[84:85], s[92:93]
    v_pk_mul_f32 v[86:87], v[86:87], s[92:93]
    v_cvt_pk_bf16_f32 v80, v80, v81
    v_cvt_pk_bf16_f32 v81, v82, v83
    v_cvt_pk_bf16_f32 v82, v84, v85
    v_cvt_pk_bf16_f32 v83, v86, v87
    buffer_store_dwordx4 v[80:83], v2, s[8:11], s90 offen sc1
    s_add_u32 s90, s90, s100
    v_accvgpr_write_b32 a48, 0
    v_accvgpr_write_b32 a49, 0
    v_accvgpr_write_b32 a50, 0
    v_accvgpr_write_b32 a51, 0
    v_accvgpr_write_b32 a52, 0
    v_accvgpr_write_b32 a53, 0
    v_accvgpr_write_b32 a54, 0
    v_accvgpr_write_b32 a55, 0
    v_pk_mul_f32 v[240:241], v[240:241], s[92:93]
    v_pk_mul_f32 v[242:243], v[242:243], s[92:93]
    v_pk_mul_f32 v[244:245], v[244:245], s[92:93]
    v_pk_mul_f32 v[246:247], v[246:247], s[92:93]
    v_cvt_pk_bf16_f32 v216, v240, v241
    v_cvt_pk_bf16_f32 v217, v242, v243
    v_cvt_pk_bf16_f32 v218, v244, v245
    v_cvt_pk_bf16_f32 v219, v246, v247
    v_pk_mul_f32 v[88:89], v[88:89], s[92:93]
    v_pk_mul_f32 v[90:91], v[90:91], s[92:93]
    v_pk_mul_f32 v[92:93], v[92:93], s[92:93]
    v_pk_mul_f32 v[94:95], v[94:95], s[92:93]
    v_cvt_pk_bf16_f32 v88, v88, v89
    v_cvt_pk_bf16_f32 v89, v90, v91
    v_cvt_pk_bf16_f32 v90, v92, v93
    v_cvt_pk_bf16_f32 v91, v94, v95
    buffer_store_dwordx4 v[88:91], v2, s[8:11], s90 offen sc1
    s_add_u32 s90, s98, s99
    v_accvgpr_write_b32 a56, 0
    v_accvgpr_write_b32 a57, 0
    v_accvgpr_write_b32 a58, 0
    v_accvgpr_write_b32 a59, 0
    v_accvgpr_write_b32 a60, 0
    v_accvgpr_write_b32 a61, 0
    v_accvgpr_write_b32 a62, 0
    v_accvgpr_write_b32 a63, 0
    v_pk_mul_f32 v[248:249], v[248:249], s[92:93]
    v_pk_mul_f32 v[250:251], v[250:251], s[92:93]
    v_pk_mul_f32 v[252:253], v[252:253], s[92:93]
    v_pk_mul_f32 v[254:255], v[254:255], s[92:93]
    v_cvt_pk_bf16_f32 v220, v248, v249
    v_cvt_pk_bf16_f32 v221, v250, v251
    v_cvt_pk_bf16_f32 v222, v252, v253
    v_cvt_pk_bf16_f32 v223, v254, v255
    v_pk_mul_f32 v[96:97], v[96:97], s[92:93]
    v_pk_mul_f32 v[98:99], v[98:99], s[92:93]
    v_pk_mul_f32 v[100:101], v[100:101], s[92:93]
    v_pk_mul_f32 v[102:103], v[102:103], s[92:93]
    v_cvt_pk_bf16_f32 v96, v96, v97
    v_cvt_pk_bf16_f32 v97, v98, v99
    v_cvt_pk_bf16_f32 v98, v100, v101
    v_cvt_pk_bf16_f32 v99, v102, v103
    buffer_store_dwordx4 v[96:99], v2, s[8:11], s90 offen sc1
    s_add_u32 s90, s90, s100
    v_accvgpr_write_b32 a64, 0
    v_accvgpr_write_b32 a65, 0
    v_accvgpr_write_b32 a66, 0
    v_accvgpr_write_b32 a67, 0
    v_accvgpr_write_b32 a68, 0
    v_accvgpr_write_b32 a69, 0
    v_accvgpr_write_b32 a70, 0
    v_accvgpr_write_b32 a71, 0
    v_accvgpr_read_b32 v24, a224
    v_accvgpr_read_b32 v25, a225
    v_accvgpr_read_b32 v26, a226
    v_accvgpr_read_b32 v27, a227
    v_accvgpr_read_b32 v28, a228
    v_accvgpr_read_b32 v29, a229
    v_accvgpr_read_b32 v30, a230
    v_accvgpr_read_b32 v31, a231
    v_pk_mul_f32 v[24:25], v[24:25], s[92:93]
    v_pk_mul_f32 v[26:27], v[26:27], s[92:93]
    v_pk_mul_f32 v[28:29], v[28:29], s[92:93]
    v_pk_mul_f32 v[30:31], v[30:31], s[92:93]
    v_cvt_pk_bf16_f32 v224, v24, v25
    v_cvt_pk_bf16_f32 v225, v26, v27
    v_cvt_pk_bf16_f32 v226, v28, v29
    v_cvt_pk_bf16_f32 v227, v30, v31
    v_pk_mul_f32 v[104:105], v[104:105], s[92:93]
    v_pk_mul_f32 v[106:107], v[106:107], s[92:93]
    v_pk_mul_f32 v[108:109], v[108:109], s[92:93]
    v_pk_mul_f32 v[110:111], v[110:111], s[92:93]
    v_cvt_pk_bf16_f32 v104, v104, v105
    v_cvt_pk_bf16_f32 v105, v106, v107
    v_cvt_pk_bf16_f32 v106, v108, v109
    v_cvt_pk_bf16_f32 v107, v110, v111
    buffer_store_dwordx4 v[104:107], v2, s[8:11], s90 offen sc1
    s_add_u32 s90, s90, s100
    v_accvgpr_write_b32 a72, 0
    v_accvgpr_write_b32 a73, 0
    v_accvgpr_write_b32 a74, 0
    v_accvgpr_write_b32 a75, 0
    v_accvgpr_write_b32 a76, 0
    v_accvgpr_write_b32 a77, 0
    v_accvgpr_write_b32 a78, 0
    v_accvgpr_write_b32 a79, 0
    v_accvgpr_read_b32 v24, a232
    v_accvgpr_read_b32 v25, a233
    v_accvgpr_read_b32 v26, a234
    v_accvgpr_read_b32 v27, a235
    v_accvgpr_read_b32 v28, a236
    v_accvgpr_read_b32 v29, a237
    v_accvgpr_read_b32 v30, a238
    v_accvgpr_read_b32 v31, a239
    v_pk_mul_f32 v[24:25], v[24:25], s[92:93]
    v_pk_mul_f32 v[26:27], v[26:27], s[92:93]
    v_pk_mul_f32 v[28:29], v[28:29], s[92:93]
    v_pk_mul_f32 v[30:31], v[30:31], s[92:93]
    v_cvt_pk_bf16_f32 v228, v24, v25
    v_cvt_pk_bf16_f32 v229, v26, v27
    v_cvt_pk_bf16_f32 v230, v28, v29
    v_cvt_pk_bf16_f32 v231, v30, v31
    v_pk_mul_f32 v[112:113], v[112:113], s[92:93]
    v_pk_mul_f32 v[114:115], v[114:115], s[92:93]
    v_pk_mul_f32 v[116:117], v[116:117], s[92:93]
    v_pk_mul_f32 v[118:119], v[118:119], s[92:93]
    v_cvt_pk_bf16_f32 v112, v112, v113
    v_cvt_pk_bf16_f32 v113, v114, v115
    v_cvt_pk_bf16_f32 v114, v116, v117
    v_cvt_pk_bf16_f32 v115, v118, v119
    buffer_store_dwordx4 v[112:115], v2, s[8:11], s90 offen sc1
    s_add_u32 s90, s90, s100
    v_accvgpr_write_b32 a80, 0
    v_accvgpr_write_b32 a81, 0
    v_accvgpr_write_b32 a82, 0
    v_accvgpr_write_b32 a83, 0
    v_accvgpr_write_b32 a84, 0
    v_accvgpr_write_b32 a85, 0
    v_accvgpr_write_b32 a86, 0
    v_accvgpr_write_b32 a87, 0
    v_accvgpr_read_b32 v24, a240
    v_accvgpr_read_b32 v25, a241
    v_accvgpr_read_b32 v26, a242
    v_accvgpr_read_b32 v27, a243
    v_accvgpr_read_b32 v28, a244
    v_accvgpr_read_b32 v29, a245
    v_accvgpr_read_b32 v30, a246
    v_accvgpr_read_b32 v31, a247
    v_pk_mul_f32 v[24:25], v[24:25], s[92:93]
    v_pk_mul_f32 v[26:27], v[26:27], s[92:93]
    v_pk_mul_f32 v[28:29], v[28:29], s[92:93]
    v_pk_mul_f32 v[30:31], v[30:31], s[92:93]
    v_cvt_pk_bf16_f32 v232, v24, v25
    v_cvt_pk_bf16_f32 v233, v26, v27
    v_cvt_pk_bf16_f32 v234, v28, v29
    v_cvt_pk_bf16_f32 v235, v30, v31
    v_pk_mul_f32 v[120:121], v[120:121], s[92:93]
    v_pk_mul_f32 v[122:123], v[122:123], s[92:93]
    v_pk_mul_f32 v[124:125], v[124:125], s[92:93]
    v_pk_mul_f32 v[126:127], v[126:127], s[92:93]
    v_cvt_pk_bf16_f32 v120, v120, v121
    v_cvt_pk_bf16_f32 v121, v122, v123
    v_cvt_pk_bf16_f32 v122, v124, v125
    v_cvt_pk_bf16_f32 v123, v126, v127
    buffer_store_dwordx4 v[120:123], v2, s[8:11], s90 offen sc1
    s_add_u32 s90, s90, s100
    v_accvgpr_write_b32 a88, 0
    v_accvgpr_write_b32 a89, 0
    v_accvgpr_write_b32 a90, 0
    v_accvgpr_write_b32 a91, 0
    v_accvgpr_write_b32 a92, 0
    v_accvgpr_write_b32 a93, 0
    v_accvgpr_write_b32 a94, 0
    v_accvgpr_write_b32 a95, 0
    v_accvgpr_read_b32 v24, a248
    v_accvgpr_read_b32 v25, a249
    v_accvgpr_read_b32 v26, a250
    v_accvgpr_read_b32 v27, a251
    v_accvgpr_read_b32 v28, a252
    v_accvgpr_read_b32 v29, a253
    v_accvgpr_read_b32 v30, a254
    v_accvgpr_read_b32 v31, a255
    v_pk_mul_f32 v[24:25], v[24:25], s[92:93]
    v_pk_mul_f32 v[26:27], v[26:27], s[92:93]
    v_pk_mul_f32 v[28:29], v[28:29], s[92:93]
    v_pk_mul_f32 v[30:31], v[30:31], s[92:93]
    v_cvt_pk_bf16_f32 v236, v24, v25
    v_cvt_pk_bf16_f32 v237, v26, v27
    v_cvt_pk_bf16_f32 v238, v28, v29
    v_cvt_pk_bf16_f32 v239, v30, v31
    v_pk_mul_f32 v[128:129], v[128:129], s[92:93]
    v_pk_mul_f32 v[130:131], v[130:131], s[92:93]
    v_pk_mul_f32 v[132:133], v[132:133], s[92:93]
    v_pk_mul_f32 v[134:135], v[134:135], s[92:93]
    v_cvt_pk_bf16_f32 v128, v128, v129
    v_cvt_pk_bf16_f32 v129, v130, v131
    v_cvt_pk_bf16_f32 v130, v132, v133
    v_cvt_pk_bf16_f32 v131, v134, v135
    buffer_store_dwordx4 v[128:131], v2, s[8:11], s90 offen sc1
    s_add_u32 s90, s90, s100
    v_accvgpr_write_b32 a96, 0
    v_accvgpr_write_b32 a97, 0
    v_accvgpr_write_b32 a98, 0
    v_accvgpr_write_b32 a99, 0
    v_accvgpr_write_b32 a100, 0
    v_accvgpr_write_b32 a101, 0
    v_accvgpr_write_b32 a102, 0
    v_accvgpr_write_b32 a103, 0
    v_pk_mul_f32 v[160:161], v[160:161], s[92:93]
    v_pk_mul_f32 v[162:163], v[162:163], s[92:93]
    v_pk_mul_f32 v[164:165], v[164:165], s[92:93]
    v_pk_mul_f32 v[166:167], v[166:167], s[92:93]
    v_cvt_pk_bf16_f32 v240, v160, v161
    v_cvt_pk_bf16_f32 v241, v162, v163
    v_cvt_pk_bf16_f32 v242, v164, v165
    v_cvt_pk_bf16_f32 v243, v166, v167
    v_pk_mul_f32 v[136:137], v[136:137], s[92:93]
    v_pk_mul_f32 v[138:139], v[138:139], s[92:93]
    v_pk_mul_f32 v[140:141], v[140:141], s[92:93]
    v_pk_mul_f32 v[142:143], v[142:143], s[92:93]
    v_cvt_pk_bf16_f32 v136, v136, v137
    v_cvt_pk_bf16_f32 v137, v138, v139
    v_cvt_pk_bf16_f32 v138, v140, v141
    v_cvt_pk_bf16_f32 v139, v142, v143
    buffer_store_dwordx4 v[136:139], v2, s[8:11], s90 offen sc1
    s_add_u32 s90, s90, s100
    v_accvgpr_write_b32 a104, 0
    v_accvgpr_write_b32 a105, 0
    v_accvgpr_write_b32 a106, 0
    v_accvgpr_write_b32 a107, 0
    v_accvgpr_write_b32 a108, 0
    v_accvgpr_write_b32 a109, 0
    v_accvgpr_write_b32 a110, 0
    v_accvgpr_write_b32 a111, 0
    v_pk_mul_f32 v[168:169], v[168:169], s[92:93]
    v_pk_mul_f32 v[170:171], v[170:171], s[92:93]
    v_pk_mul_f32 v[172:173], v[172:173], s[92:93]
    v_pk_mul_f32 v[174:175], v[174:175], s[92:93]
    v_cvt_pk_bf16_f32 v244, v168, v169
    v_cvt_pk_bf16_f32 v245, v170, v171
    v_cvt_pk_bf16_f32 v246, v172, v173
    v_cvt_pk_bf16_f32 v247, v174, v175
    v_pk_mul_f32 v[144:145], v[144:145], s[92:93]
    v_pk_mul_f32 v[146:147], v[146:147], s[92:93]
    v_pk_mul_f32 v[148:149], v[148:149], s[92:93]
    v_pk_mul_f32 v[150:151], v[150:151], s[92:93]
    v_cvt_pk_bf16_f32 v144, v144, v145
    v_cvt_pk_bf16_f32 v145, v146, v147
    v_cvt_pk_bf16_f32 v146, v148, v149
    v_cvt_pk_bf16_f32 v147, v150, v151
    buffer_store_dwordx4 v[144:147], v2, s[8:11], s90 offen sc1
    s_add_u32 s90, s90, s100
    v_accvgpr_write_b32 a112, 0
    v_accvgpr_write_b32 a113, 0
    v_accvgpr_write_b32 a114, 0
    v_accvgpr_write_b32 a115, 0
    v_accvgpr_write_b32 a116, 0
    v_accvgpr_write_b32 a117, 0
    v_accvgpr_write_b32 a118, 0
    v_accvgpr_write_b32 a119, 0
    v_pk_mul_f32 v[176:177], v[176:177], s[92:93]
    v_pk_mul_f32 v[178:179], v[178:179], s[92:93]
    v_pk_mul_f32 v[180:181], v[180:181], s[92:93]
    v_pk_mul_f32 v[182:183], v[182:183], s[92:93]
    v_cvt_pk_bf16_f32 v248, v176, v177
    v_cvt_pk_bf16_f32 v249, v178, v179
    v_cvt_pk_bf16_f32 v250, v180, v181
    v_cvt_pk_bf16_f32 v251, v182, v183
    v_pk_mul_f32 v[152:153], v[152:153], s[92:93]
    v_pk_mul_f32 v[154:155], v[154:155], s[92:93]
    v_pk_mul_f32 v[156:157], v[156:157], s[92:93]
    v_pk_mul_f32 v[158:159], v[158:159], s[92:93]
    v_cvt_pk_bf16_f32 v152, v152, v153
    v_cvt_pk_bf16_f32 v153, v154, v155
    v_cvt_pk_bf16_f32 v154, v156, v157
    v_cvt_pk_bf16_f32 v155, v158, v159
    buffer_store_dwordx4 v[152:155], v2, s[8:11], s90 offen sc1
    s_add_u32 s90, s90, s100
    v_accvgpr_write_b32 a120, 0
    v_accvgpr_write_b32 a121, 0
    v_accvgpr_write_b32 a122, 0
    v_accvgpr_write_b32 a123, 0
    v_accvgpr_write_b32 a124, 0
    v_accvgpr_write_b32 a125, 0
    v_accvgpr_write_b32 a126, 0
    v_accvgpr_write_b32 a127, 0
    v_pk_mul_f32 v[184:185], v[184:185], s[92:93]
    v_pk_mul_f32 v[186:187], v[186:187], s[92:93]
    v_pk_mul_f32 v[188:189], v[188:189], s[92:93]
    v_pk_mul_f32 v[190:191], v[190:191], s[92:93]
    v_cvt_pk_bf16_f32 v252, v184, v185
    v_cvt_pk_bf16_f32 v253, v186, v187
    v_cvt_pk_bf16_f32 v254, v188, v189
    v_cvt_pk_bf16_f32 v255, v190, v191
    s_branch m_epl85_r
m_ns286:
    s_mov_b32 s90, s98
    v_cvt_pk_bf16_f32 v32, v32, v33
    v_cvt_pk_bf16_f32 v33, v34, v35
    v_cvt_pk_bf16_f32 v34, v36, v37
    v_cvt_pk_bf16_f32 v35, v38, v39
    buffer_store_dwordx4 v[32:35], v2, s[8:11], s90 offen sc1
    s_add_u32 s90, s90, s100
    v_accvgpr_write_b32 a0, 0
    v_accvgpr_write_b32 a1, 0
    v_accvgpr_write_b32 a2, 0
    v_accvgpr_write_b32 a3, 0
    v_accvgpr_write_b32 a4, 0
    v_accvgpr_write_b32 a5, 0
    v_accvgpr_write_b32 a6, 0
    v_accvgpr_write_b32 a7, 0
    v_cvt_pk_bf16_f32 v192, v192, v193
    v_cvt_pk_bf16_f32 v193, v194, v195
    v_cvt_pk_bf16_f32 v194, v196, v197
    v_cvt_pk_bf16_f32 v195, v198, v199
    v_cvt_pk_bf16_f32 v40, v40, v41
    v_cvt_pk_bf16_f32 v41, v42, v43
    v_cvt_pk_bf16_f32 v42, v44, v45
    v_cvt_pk_bf16_f32 v43, v46, v47
    buffer_store_dwordx4 v[40:43], v2, s[8:11], s90 offen sc1
    s_add_u32 s90, s90, s100
    v_accvgpr_write_b32 a8, 0
    v_accvgpr_write_b32 a9, 0
    v_accvgpr_write_b32 a10, 0
    v_accvgpr_write_b32 a11, 0
    v_accvgpr_write_b32 a12, 0
    v_accvgpr_write_b32 a13, 0
    v_accvgpr_write_b32 a14, 0
    v_accvgpr_write_b32 a15, 0
    v_cvt_pk_bf16_f32 v196, v200, v201
    v_cvt_pk_bf16_f32 v197, v202, v203
    v_cvt_pk_bf16_f32 v198, v204, v205
    v_cvt_pk_bf16_f32 v199, v206, v207
    v_cvt_pk_bf16_f32 v48, v48, v49
    v_cvt_pk_bf16_f32 v49, v50, v51
    v_cvt_pk_bf16_f32 v50, v52, v53
    v_cvt_pk_bf16_f32 v51, v54, v55
    buffer_store_dwordx4 v[48:51], v2, s[8:11], s90 offen sc1
    s_add_u32 s90, s90, s100
    v_accvgpr_write_b32 a16, 0
    v_accvgpr_write_b32 a17, 0
    v_accvgpr_write_b32 a18, 0
    v_accvgpr_write_b32 a19, 0
    v_accvgpr_write_b32 a20, 0
    v_accvgpr_write_b32 a21, 0
    v_accvgpr_write_b32 a22, 0
    v_accvgpr_write_b32 a23, 0
    v_cvt_pk_bf16_f32 v200, v208, v209
    v_cvt_pk_bf16_f32 v201, v210, v211
    v_cvt_pk_bf16_f32 v202, v212, v213
    v_cvt_pk_bf16_f32 v203, v214, v215
    v_cvt_pk_bf16_f32 v56, v56, v57
    v_cvt_pk_bf16_f32 v57, v58, v59
    v_cvt_pk_bf16_f32 v58, v60, v61
    v_cvt_pk_bf16_f32 v59, v62, v63
    buffer_store_dwordx4 v[56:59], v2, s[8:11], s90 offen sc1
    s_add_u32 s90, s90, s100
    v_accvgpr_write_b32 a24, 0
    v_accvgpr_write_b32 a25, 0
    v_accvgpr_write_b32 a26, 0
    v_accvgpr_write_b32 a27, 0
    v_accvgpr_write_b32 a28, 0
    v_accvgpr_write_b32 a29, 0
    v_accvgpr_write_b32 a30, 0
    v_accvgpr_write_b32 a31, 0
    v_cvt_pk_bf16_f32 v204, v216, v217
    v_cvt_pk_bf16_f32 v205, v218, v219
    v_cvt_pk_bf16_f32 v206, v220, v221
    v_cvt_pk_bf16_f32 v207, v222, v223
    v_cvt_pk_bf16_f32 v64, v64, v65
    v_cvt_pk_bf16_f32 v65, v66, v67
    v_cvt_pk_bf16_f32 v66, v68, v69
    v_cvt_pk_bf16_f32 v67, v70, v71
    buffer_store_dwordx4 v[64:67], v2, s[8:11], s90 offen sc1
    s_add_u32 s90, s90, s100
    v_accvgpr_write_b32 a32, 0
    v_accvgpr_write_b32 a33, 0
    v_accvgpr_write_b32 a34, 0
    v_accvgpr_write_b32 a35, 0
    v_accvgpr_write_b32 a36, 0
    v_accvgpr_write_b32 a37, 0
    v_accvgpr_write_b32 a38, 0
    v_accvgpr_write_b32 a39, 0
    v_cvt_pk_bf16_f32 v208, v224, v225
    v_cvt_pk_bf16_f32 v209, v226, v227
    v_cvt_pk_bf16_f32 v210, v228, v229
    v_cvt_pk_bf16_f32 v211, v230, v231
    v_cvt_pk_bf16_f32 v72, v72, v73
    v_cvt_pk_bf16_f32 v73, v74, v75
    v_cvt_pk_bf16_f32 v74, v76, v77
    v_cvt_pk_bf16_f32 v75, v78, v79
    buffer_store_dwordx4 v[72:75], v2, s[8:11], s90 offen sc1
    s_add_u32 s90, s90, s100
    v_accvgpr_write_b32 a40, 0
    v_accvgpr_write_b32 a41, 0
    v_accvgpr_write_b32 a42, 0
    v_accvgpr_write_b32 a43, 0
    v_accvgpr_write_b32 a44, 0
    v_accvgpr_write_b32 a45, 0
    v_accvgpr_write_b32 a46, 0
    v_accvgpr_write_b32 a47, 0
    v_cvt_pk_bf16_f32 v212, v232, v233
    v_cvt_pk_bf16_f32 v213, v234, v235
    v_cvt_pk_bf16_f32 v214, v236, v237
    v_cvt_pk_bf16_f32 v215, v238, v239
    v_cvt_pk_bf16_f32 v80, v80, v81
    v_cvt_pk_bf16_f32 v81, v82, v83
    v_cvt_pk_bf16_f32 v82, v84, v85
    v_cvt_pk_bf16_f32 v83, v86, v87
    buffer_store_dwordx4 v[80:83], v2, s[8:11], s90 offen sc1
    s_add_u32 s90, s90, s100
    v_accvgpr_write_b32 a48, 0
    v_accvgpr_write_b32 a49, 0
    v_accvgpr_write_b32 a50, 0
    v_accvgpr_write_b32 a51, 0
    v_accvgpr_write_b32 a52, 0
    v_accvgpr_write_b32 a53, 0
    v_accvgpr_write_b32 a54, 0
    v_accvgpr_write_b32 a55, 0
    v_cvt_pk_bf16_f32 v216, v240, v241
    v_cvt_pk_bf16_f32 v217, v242, v243
    v_cvt_pk_bf16_f32 v218, v244, v245
    v_cvt_pk_bf16_f32 v219, v246, v247
    v_cvt_pk_bf16_f32 v88, v88, v89
    v_cvt_pk_bf16_f32 v89, v90, v91
    v_cvt_pk_bf16_f32 v90, v92, v93
    v_cvt_pk_bf16_f32 v91, v94, v95
    buffer_store_dwordx4 v[88:91], v2, s[8:11], s90 offen sc1
    s_add_u32 s90, s98, s99
    v_accvgpr_write_b32 a56, 0
    v_accvgpr_write_b32 a57, 0
    v_accvgpr_write_b32 a58, 0
    v_accvgpr_write_b32 a59, 0
    v_accvgpr_write_b32 a60, 0
    v_accvgpr_write_b32 a61, 0
    v_accvgpr_write_b32 a62, 0
    v_accvgpr_write_b32 a63, 0
    v_cvt_pk_bf16_f32 v220, v248, v249
    v_cvt_pk_bf16_f32 v221, v250, v251
    v_cvt_pk_bf16_f32 v222, v252, v253
    v_cvt_pk_bf16_f32 v223, v254, v255
    v_cvt_pk_bf16_f32 v96, v96, v97
    v_cvt_pk_bf16_f32 v97, v98, v99
    v_cvt_pk_bf16_f32 v98, v100, v101
    v_cvt_pk_bf16_f32 v99, v102, v103
    buffer_store_dwordx4 v[96:99], v2, s[8:11], s90 offen sc1
    s_add_u32 s90, s90, s100
    v_accvgpr_write_b32 a64, 0
    v_accvgpr_write_b32 a65, 0
    v_accvgpr_write_b32 a66, 0
    v_accvgpr_write_b32 a67, 0
    v_accvgpr_write_b32 a68, 0
    v_accvgpr_write_b32 a69, 0
    v_accvgpr_write_b32 a70, 0
    v_accvgpr_write_b32 a71, 0
    v_accvgpr_read_b32 v24, a224
    v_accvgpr_read_b32 v25, a225
    v_accvgpr_read_b32 v26, a226
    v_accvgpr_read_b32 v27, a227
    v_accvgpr_read_b32 v28, a228
    v_accvgpr_read_b32 v29, a229
    v_accvgpr_read_b32 v30, a230
    v_accvgpr_read_b32 v31, a231
    v_cvt_pk_bf16_f32 v224, v24, v25
    v_cvt_pk_bf16_f32 v225, v26, v27
    v_cvt_pk_bf16_f32 v226, v28, v29
    v_cvt_pk_bf16_f32 v227, v30, v31
    v_cvt_pk_bf16_f32 v104, v104, v105
    v_cvt_pk_bf16_f32 v105, v106, v107
    v_cvt_pk_bf16_f32 v106, v108, v109
    v_cvt_pk_bf16_f32 v107, v110, v111
    buffer_store_dwordx4 v[104:107], v2, s[8:11], s90 offen sc1
    s_add_u32 s90, s90, s100
    v_accvgpr_write_b32 a72, 0
    v_accvgpr_write_b32 a73, 0
    v_accvgpr_write_b32 a74, 0
    v_accvgpr_write_b32 a75, 0
    v_accvgpr_write_b32 a76, 0
    v_accvgpr_write_b32 a77, 0
    v_accvgpr_write_b32 a78, 0
    v_accvgpr_write_b32 a79, 0
    v_accvgpr_read_b32 v24, a232
    v_accvgpr_read_b32 v25, a233
    v_accvgpr_read_b32 v26, a234
    v_accvgpr_read_b32 v27, a235
    v_accvgpr_read_b32 v28, a236
    v_accvgpr_read_b32 v29, a237
    v_accvgpr_read_b32 v30, a238
    v_accvgpr_read_b32 v31, a239
    v_cvt_pk_bf16_f32 v228, v24, v25
    v_cvt_pk_bf16_f32 v229, v26, v27
    v_cvt_pk_bf16_f32 v230, v28, v29
    v_cvt_pk_bf16_f32 v231, v30, v31
    v_cvt_pk_bf16_f32 v112, v112, v113
    v_cvt_pk_bf16_f32 v113, v114, v115
    v_cvt_pk_bf16_f32 v114, v116, v117
    v_cvt_pk_bf16_f32 v115, v118, v119
    buffer_store_dwordx4 v[112:115], v2, s[8:11], s90 offen sc1
    s_add_u32 s90, s90, s100
    v_accvgpr_write_b32 a80, 0
    v_accvgpr_write_b32 a81, 0
    v_accvgpr_write_b32 a82, 0
    v_accvgpr_write_b32 a83, 0
    v_accvgpr_write_b32 a84, 0
    v_accvgpr_write_b32 a85, 0
    v_accvgpr_write_b32 a86, 0
    v_accvgpr_write_b32 a87, 0
    v_accvgpr_read_b32 v24, a240
    v_accvgpr_read_b32 v25, a241
    v_accvgpr_read_b32 v26, a242
    v_accvgpr_read_b32 v27, a243
    v_accvgpr_read_b32 v28, a244
    v_accvgpr_read_b32 v29, a245
    v_accvgpr_read_b32 v30, a246
    v_accvgpr_read_b32 v31, a247
    v_cvt_pk_bf16_f32 v232, v24, v25
    v_cvt_pk_bf16_f32 v233, v26, v27
    v_cvt_pk_bf16_f32 v234, v28, v29
    v_cvt_pk_bf16_f32 v235, v30, v31
    v_cvt_pk_bf16_f32 v120, v120, v121
    v_cvt_pk_bf16_f32 v121, v122, v123
    v_cvt_pk_bf16_f32 v122, v124, v125
    v_cvt_pk_bf16_f32 v123, v126, v127
    buffer_store_dwordx4 v[120:123], v2, s[8:11], s90 offen sc1
    s_add_u32 s90, s90, s100
    v_accvgpr_write_b32 a88, 0
    v_accvgpr_write_b32 a89, 0
    v_accvgpr_write_b32 a90, 0
    v_accvgpr_write_b32 a91, 0
    v_accvgpr_write_b32 a92, 0
    v_accvgpr_write_b32 a93, 0
    v_accvgpr_write_b32 a94, 0
    v_accvgpr_write_b32 a95, 0
    v_accvgpr_read_b32 v24, a248
    v_accvgpr_read_b32 v25, a249
    v_accvgpr_read_b32 v26, a250
    v_accvgpr_read_b32 v27, a251
    v_accvgpr_read_b32 v28, a252
    v_accvgpr_read_b32 v29, a253
    v_accvgpr_read_b32 v30, a254
    v_accvgpr_read_b32 v31, a255
    v_cvt_pk_bf16_f32 v236, v24, v25
    v_cvt_pk_bf16_f32 v237, v26, v27
    v_cvt_pk_bf16_f32 v238, v28, v29
    v_cvt_pk_bf16_f32 v239, v30, v31
    v_cvt_pk_bf16_f32 v128, v128, v129
    v_cvt_pk_bf16_f32 v129, v130, v131
    v_cvt_pk_bf16_f32 v130, v132, v133
    v_cvt_pk_bf16_f32 v131, v134, v135
    buffer_store_dwordx4 v[128:131], v2, s[8:11], s90 offen sc1
    s_add_u32 s90, s90, s100
    v_accvgpr_write_b32 a96, 0
    v_accvgpr_write_b32 a97, 0
    v_accvgpr_write_b32 a98, 0
    v_accvgpr_write_b32 a99, 0
    v_accvgpr_write_b32 a100, 0
    v_accvgpr_write_b32 a101, 0
    v_accvgpr_write_b32 a102, 0
    v_accvgpr_write_b32 a103, 0
    v_cvt_pk_bf16_f32 v240, v160, v161
    v_cvt_pk_bf16_f32 v241, v162, v163
    v_cvt_pk_bf16_f32 v242, v164, v165
    v_cvt_pk_bf16_f32 v243, v166, v167
    v_cvt_pk_bf16_f32 v136, v136, v137
    v_cvt_pk_bf16_f32 v137, v138, v139
    v_cvt_pk_bf16_f32 v138, v140, v141
    v_cvt_pk_bf16_f32 v139, v142, v143
    buffer_store_dwordx4 v[136:139], v2, s[8:11], s90 offen sc1
    s_add_u32 s90, s90, s100
    v_accvgpr_write_b32 a104, 0
    v_accvgpr_write_b32 a105, 0
    v_accvgpr_write_b32 a106, 0
    v_accvgpr_write_b32 a107, 0
    v_accvgpr_write_b32 a108, 0
    v_accvgpr_write_b32 a109, 0
    v_accvgpr_write_b32 a110, 0
    v_accvgpr_write_b32 a111, 0
    v_cvt_pk_bf16_f32 v244, v168, v169
    v_cvt_pk_bf16_f32 v245, v170, v171
    v_cvt_pk_bf16_f32 v246, v172, v173
    v_cvt_pk_bf16_f32 v247, v174, v175
    v_cvt_pk_bf16_f32 v144, v144, v145
    v_cvt_pk_bf16_f32 v145, v146, v147
    v_cvt_pk_bf16_f32 v146, v148, v149
    v_cvt_pk_bf16_f32 v147, v150, v151
    buffer_store_dwordx4 v[144:147], v2, s[8:11], s90 offen sc1
    s_add_u32 s90, s90, s100
    v_accvgpr_write_b32 a112, 0
    v_accvgpr_write_b32 a113, 0
    v_accvgpr_write_b32 a114, 0
    v_accvgpr_write_b32 a115, 0
    v_accvgpr_write_b32 a116, 0
    v_accvgpr_write_b32 a117, 0
    v_accvgpr_write_b32 a118, 0
    v_accvgpr_write_b32 a119, 0
    v_cvt_pk_bf16_f32 v248, v176, v177
    v_cvt_pk_bf16_f32 v249, v178, v179
    v_cvt_pk_bf16_f32 v250, v180, v181
    v_cvt_pk_bf16_f32 v251, v182, v183
    v_cvt_pk_bf16_f32 v152, v152, v153
    v_cvt_pk_bf16_f32 v153, v154, v155
    v_cvt_pk_bf16_f32 v154, v156, v157
    v_cvt_pk_bf16_f32 v155, v158, v159
    buffer_store_dwordx4 v[152:155], v2, s[8:11], s90 offen sc1
    s_add_u32 s90, s90, s100
    v_accvgpr_write_b32 a120, 0
    v_accvgpr_write_b32 a121, 0
    v_accvgpr_write_b32 a122, 0
    v_accvgpr_write_b32 a123, 0
    v_accvgpr_write_b32 a124, 0
    v_accvgpr_write_b32 a125, 0
    v_accvgpr_write_b32 a126, 0
    v_accvgpr_write_b32 a127, 0
    v_cvt_pk_bf16_f32 v252, v184, v185
    v_cvt_pk_bf16_f32 v253, v186, v187
    v_cvt_pk_bf16_f32 v254, v188, v189
    v_cvt_pk_bf16_f32 v255, v190, v191
m_epl85_r:
    s_mov_b32 s17, s101
    s_mov_b32 s38, 268435456
m_init31:
    s_mov_b32 s36, s6
    s_mov_b32 s37, s7
    s_mov_b32 s39, 0x20000
    s_lshl_b32 s90, s99, 1
    s_add_u32 s98, s98, s90
    s_lshl_b32 s90, s100, 2
    s_add_u32 s40, s98, s90
    s_waitcnt vmcnt(32)
    s_waitcnt lgkmcnt(0)
    v_mfma_f32_16x16x32_bf16 v[64:67], a[192:195], a[128:131], 0
    s_and_b32 s92, s2, 7
    s_lshl_b32 s92, s92, 2
    s_bfe_u32 s93, s2, 0x20003
    s_add_u32 s92, s92, s93
    v_mfma_f32_16x16x32_bf16 v[64:67], a[196:199], a[132:135], v[64:67]
    buffer_store_dwordx4 v[192:195], v2, s[36:39], s40 offen sc1
    s_add_u32 s40, s40, s100
    s_lshr_b32 s93, s2, 5
    v_mfma_f32_16x16x32_bf16 v[64:67], a[200:203], a[136:139], v[64:67]
    s_lshl_b32 s93, s93, 2
    s_or_b32 s93, s93, 0x40000
    s_mov_b32 s32, s92
    s_bfe_u32 s33, 4225674377, s93
    v_mfma_f32_16x16x32_bf16 v[64:67], a[204:207], a[140:143], v[64:67]
    s_add_u32 s33, s33, 1
    s_bfe_u32 s34, 873484918, s93
    s_add_u32 s34, s34, 1
    s_lshl_b32 s60, s16, 12
    v_mfma_f32_16x16x32_bf16 v[72:75], a[204:207], a[156:159], 0
    v_add_u32 v7, s60, v2
    s_lshl_b32 s90, s34, 2
    s_lshl_b32 s91, s33, 2
    s_lshl_b32 s26, s91, 13
    v_mfma_f32_16x16x32_bf16 v[72:75], a[200:203], a[152:155], v[72:75]
    buffer_store_dwordx4 v[196:199], v2, s[36:39], s40 offen sc1
    s_add_u32 s40, s40, s100
    s_mov_b32 s30, s26
    v_mfma_f32_16x16x32_bf16 v[72:75], a[196:199], a[148:151], v[72:75]
    s_sub_u32 s67, s90, 4
    s_add_u32 s67, s67, s16
    s_add_u32 s68, s67, 1
    s_mov_b32 s69, s90
    v_mfma_f32_16x16x32_bf16 v[72:75], a[192:195], a[144:147], v[72:75]
    s_sub_u32 s70, s91, 4
    s_add_u32 s70, s70, s16
    s_add_u32 s71, s70, 1
    s_mov_b32 s72, s91
    v_mfma_f32_16x16x32_bf16 v[80:83], a[192:195], a[160:163], 0
    s_cmp_lt_u32 s16, 2
    s_cselect_b32 s90, 2, 0
    s_sub_u32 s72, s72, s90
    s_mov_b32 s27, 0x20000
    v_mfma_f32_16x16x32_bf16 v[80:83], a[196:199], a[164:167], v[80:83]
    buffer_store_dwordx4 v[200:203], v2, s[36:39], s40 offen sc1
    s_add_u32 s40, s40, s100
    s_mov_b32 s31, 0x20000
    v_mfma_f32_16x16x32_bf16 v[80:83], a[200:203], a[168:171], v[80:83]
    s_lshl_b32 s82, s32, 19
    s_add_u32 s90, s82, 16777216
    s_add_u32 s24, s6, s90
    s_addc_u32 s25, s7, 0
    v_mfma_f32_16x16x32_bf16 v[80:83], a[204:207], a[172:175], v[80:83]
    s_add_u32 s90, s82, 33554432
    s_add_u32 s28, s6, s90
    s_addc_u32 s29, s7, 0
    s_mov_b32 s56, 81920
    v_mfma_f32_16x16x32_bf16 v[88:91], a[204:207], a[188:191], 0
    s_mov_b32 s57, 65536
    v_mov_b32 v9, 0xff800000
    s_mov_b32 s65, 1233125376
    s_lshl_b32 s91, s16, 1
    v_mfma_f32_16x16x32_bf16 v[88:91], a[200:203], a[184:187], v[88:91]
    buffer_store_dwordx4 v[204:207], v2, s[36:39], s40 offen sc1
    s_add_u32 s40, s98, s99
    s_sub_u32 s91, s91, 8
    v_mfma_f32_16x16x32_bf16 v[88:91], a[196:199], a[180:183], v[88:91]
    s_lshl_b32 s78, s33, 3
    s_add_u32 s78, s78, s91
    s_lshl_b32 s79, s34, 3
    s_add_u32 s79, s79, s91
    v_mfma_f32_16x16x32_bf16 v[88:91], a[192:195], a[176:179], v[88:91]
    s_lshr_b32 s90, s32, 1
    s_lshl_b32 s90, s90, 7
    s_add_u32 s90, s90, 117444608
    s_lshr_b32 s91, s2, 6
    v_mfma_f32_16x16x32_bf16 v[92:95], a[208:211], a[176:179], 0
    ds_read_b128 a[192:195], v6 offset:8192
    s_lshl_b32 s91, s91, 8
    s_add_u32 s91, s91, 117446592
    v_min_u32 v10, 31, v1
    v_mfma_f32_16x16x32_bf16 v[92:95], a[212:215], a[180:183], v[92:95]
    buffer_store_dwordx4 v[208:211], v2, s[36:39], s40 offen sc1
    s_add_u32 s40, s40, s100
    ds_read_b128 a[196:199], v6 offset:9216
    v_mfma_f32_16x16x32_bf16 v[92:95], a[216:219], a[184:187], v[92:95]
    ds_read_b128 a[200:203], v6 offset:10240
    v_lshlrev_b32 v10, 3, v10
    v_mov_b32 v11, s90
    v_mov_b32 v8, s91
    v_mfma_f32_16x16x32_bf16 v[92:95], a[220:223], a[188:191], v[92:95]
    ds_read_b128 a[204:207], v6 offset:11264
    v_cmp_gt_u32 vcc, 8, v1
    s_nop 1
    v_cndmask_b32 v11, v8, v11, vcc
    v_mfma_f32_16x16x32_bf16 v[84:87], a[220:223], a[172:175], 0
    v_add_u32 v10, v10, v11
    s_mov_b32 s58, 0
    v_mov_b32 v12, 0
    v_mov_b32 v28, 0
    v_mfma_f32_16x16x32_bf16 v[84:87], a[216:219], a[168:171], v[84:87]
    buffer_store_dwordx4 v[212:215], v2, s[36:39], s40 offen sc1
    s_add_u32 s40, s40, s100
    v_mov_b32 v44, 0x3f803f80
    v_mfma_f32_16x16x32_bf16 v[84:87], a[212:215], a[164:167], v[84:87]
    v_mov_b32 v13, 0
    v_mov_b32 v32, 0
    v_mov_b32 v45, 0x3f803f80
    v_mov_b32 v14, 0
    v_mfma_f32_16x16x32_bf16 v[84:87], a[208:211], a[160:163], v[84:87]
    v_mov_b32 v36, 0
    v_mov_b32 v46, 0x3f803f80
    v_mov_b32 v15, 0
    v_mov_b32 v40, 0
    v_mfma_f32_16x16x32_bf16 v[76:79], a[208:211], a[144:147], 0
    v_mov_b32 v47, 0x3f803f80
    s_and_b32 s90, s2, 7
    s_lshl_b32 s90, s90, 4
    s_lshl_b32 s91, s16, 2
    v_mfma_f32_16x16x32_bf16 v[76:79], a[212:215], a[148:151], v[76:79]
    buffer_store_dwordx4 v[216:219], v2, s[36:39], s40 offen sc1
    s_add_u32 s40, s40, s100
    s_add_u32 s80, s90, s91
    v_mfma_f32_16x16x32_bf16 v[76:79], a[216:219], a[152:155], v[76:79]
    s_lshr_b32 s92, s2, 3
    s_lshl_b32 s92, s92, 17
    s_lshl_b32 s90, s80, 10
    s_add_u32 s90, s90, s92
    v_mfma_f32_16x16x32_bf16 v[76:79], a[220:223], a[156:159], v[76:79]
    s_add_u32 s83, s90, 50331648
    s_add_u32 s84, s90, 54525952
    s_and_b32 s81, s80, 63
    s_cmp_eq_u32 s81, 0
    s_cselect_b32 s93, 0, 1024
    v_mfma_f32_16x16x32_bf16 v[68:71], a[220:223], a[140:143], 0
    s_sub_u32 s85, s84, s93
    s_lshl_b32 s90, s80, 9
    s_add_u32 s90, s90, s92
    s_add_u32 s86, s90, 58720256
    v_mfma_f32_16x16x32_bf16 v[68:71], a[216:219], a[136:139], v[68:71]
    buffer_store_dwordx4 v[220:223], v2, s[36:39], s40 offen sc1
    s_add_u32 s40, s40, s100
    s_sub_u32 s87, s86, s93
    v_mfma_f32_16x16x32_bf16 v[68:71], a[212:215], a[132:135], v[68:71]
    s_add_u32 s88, s86, 65536
    s_add_u32 s89, s87, 65536
    v_and_b32 v48, 15, v1
    v_lshrrev_b32 v49, 4, v1
    v_mfma_f32_16x16x32_bf16 v[68:71], a[208:211], a[128:131], v[68:71]
    v_lshlrev_b32 v49, 2, v49
    v_sub_u32 v48, v48, v49
    v_cmp_le_i32 vcc, 0, v48
    s_nop 1
    v_cndmask_b32 v16, v9, 0, vcc
    ds_read_b128 a[208:211], v6 offset:12288
    ds_read_b128 a[212:215], v6 offset:13312
    ds_read_b128 a[216:219], v6 offset:14336
    ds_read_b128 a[220:223], v6 offset:15360
    v_cmp_le_i32 vcc, 1, v48
    s_nop 1
    v_cndmask_b32 v17, v9, 0, vcc
    v_cmp_le_i32 vcc, 2, v48
    s_nop 1
    v_cndmask_b32 v18, v9, 0, vcc
    v_cmp_le_i32 vcc, 3, v48
    s_nop 1
    v_cndmask_b32 v19, v9, 0, vcc
    s_mov_b32 s62, 8945792
    s_mov_b32 s63, 0
    s_sub_u32 s90, s67, 1
    s_bitset1_b64 s[62:63], s90
    s_sub_u32 s90, s68, 1
    s_bitset1_b64 s[62:63], s90
    s_sub_u32 s90, s69, 1
    s_bitset1_b64 s[62:63], s90
    s_sub_u32 s90, s70, 1
    s_bitset1_b64 s[62:63], s90
    s_sub_u32 s90, s71, 1
    s_bitset1_b64 s[62:63], s90
    s_sub_u32 s90, s72, 1
    s_bitset1_b64 s[62:63], s90
    s_add_u32 s53, s69, 8
    s_sub_u32 s90, s53, 1
    s_bitset1_b64 s[62:63], s90
    s_mov_b32 s64, 1
    s_nop 3
    s_cmp_lg_u32 s67, 0
    s_cbranch_scc1 m_z91
    v_add_f32 v80, v80, v16
    v_mov_b32 v84, v9
    v_add_f32 v92, v92, v16
    v_add_f32 v81, v81, v17
    v_mov_b32 v85, v9
    v_add_f32 v93, v93, v17
    v_add_f32 v82, v82, v18
    v_mov_b32 v86, v9
    v_add_f32 v94, v94, v18
    v_add_f32 v83, v83, v19
    v_mov_b32 v87, v9
    v_add_f32 v95, v95, v19
m_z91:
    v_max3_f32 v48, v64, v65, v66
    v_max3_f32 v49, v72, v73, v74
    v_max3_f32 v50, v80, v81, v82
    v_max3_f32 v51, v88, v89, v90
    v_max3_f32 v48, v48, v67, v68
    v_max3_f32 v49, v49, v75, v76
    v_max3_f32 v50, v50, v83, v84
    v_max3_f32 v51, v51, v91, v92
    v_max3_f32 v48, v48, v69, v70
    v_max3_f32 v49, v49, v77, v78
    v_max3_f32 v50, v50, v85, v86
    v_max3_f32 v51, v51, v93, v94
    v_max_f32 v48, v48, v71
    v_max_f32 v49, v49, v79
    v_max_f32 v50, v50, v87
    v_max_f32 v51, v51, v95
    v_mov_b32 v52, v48
    v_mov_b32 v53, v49
    v_mov_b32 v54, v50
    v_mov_b32 v55, v51
    s_nop 1
    v_permlane32_swap_b32 v48, v52
    v_permlane32_swap_b32 v49, v53
    v_permlane32_swap_b32 v50, v54
    v_permlane32_swap_b32 v51, v55
    s_nop 1
    v_max_f32 v48, v48, v52
    v_max_f32 v49, v49, v53
    v_max_f32 v50, v50, v54
    v_max_f32 v51, v51, v55
    v_mov_b32 v52, v48
    v_mov_b32 v53, v49
    v_mov_b32 v54, v50
    v_mov_b32 v55, v51
    s_nop 1
    v_permlane16_swap_b32 v48, v52
    v_permlane16_swap_b32 v49, v53
    v_permlane16_swap_b32 v50, v54
    v_permlane16_swap_b32 v51, v55
    s_nop 1
    v_max_f32 v48, v48, v52
    v_max_f32 v49, v49, v53
    v_max_f32 v50, v50, v54
    v_max_f32 v51, v51, v55
    v_sub_f32 v160, 0, v48
    v_sub_f32 v161, 0, v48
    v_sub_f32 v168, 0, v49
    v_sub_f32 v169, 0, v49
    v_sub_f32 v176, 0, v50
    v_sub_f32 v177, 0, v50
    v_sub_f32 v184, 0, v51
    v_sub_f32 v185, 0, v51
    v_mov_b64 v[162:163], v[160:161]
    v_mov_b64 v[164:165], v[160:161]
    v_mov_b64 v[166:167], v[160:161]
    v_mov_b64 v[170:171], v[168:169]
    v_mov_b64 v[172:173], v[168:169]
    v_mov_b64 v[174:175], v[168:169]
    v_mov_b64 v[178:179], v[176:177]
    v_mov_b64 v[180:181], v[176:177]
    v_mov_b64 v[182:183], v[176:177]
    v_mov_b64 v[186:187], v[184:185]
    v_mov_b64 v[188:189], v[184:185]
    v_mov_b64 v[190:191], v[184:185]
    v_pk_add_f32 v[64:65], v[64:65], v[160:161]
    v_pk_add_f32 v[66:67], v[66:67], v[160:161]
    v_pk_add_f32 v[68:69], v[68:69], v[160:161]
    v_pk_add_f32 v[70:71], v[70:71], v[160:161]
    v_pk_add_f32 v[72:73], v[72:73], v[168:169]
    v_pk_add_f32 v[74:75], v[74:75], v[168:169]
    v_pk_add_f32 v[76:77], v[76:77], v[168:169]
    v_pk_add_f32 v[78:79], v[78:79], v[168:169]
    v_pk_add_f32 v[80:81], v[80:81], v[176:177]
    v_pk_add_f32 v[82:83], v[82:83], v[176:177]
    v_pk_add_f32 v[84:85], v[84:85], v[176:177]
    v_pk_add_f32 v[86:87], v[86:87], v[176:177]
    v_pk_add_f32 v[88:89], v[88:89], v[184:185]
    v_pk_add_f32 v[90:91], v[90:91], v[184:185]
    v_pk_add_f32 v[92:93], v[92:93], v[184:185]
    v_pk_add_f32 v[94:95], v[94:95], v[184:185]
    s_cmp_lg_u32 s64, s67
    s_cbranch_scc1 m_e92
    v_add_f32 v176, v176, v16
    v_mov_b32 v180, v9
    v_add_f32 v188, v188, v16
    v_add_f32 v177, v177, v17
    v_mov_b32 v181, v9
    v_add_f32 v189, v189, v17
    v_add_f32 v178, v178, v18
    v_mov_b32 v182, v9
    v_add_f32 v190, v190, v18
    v_add_f32 v179, v179, v19
    v_mov_b32 v183, v9
    v_add_f32 v191, v191, v19
    s_nop 0
m_e92:
    s_cmp_lg_u32 s64, s68
    s_cbranch_scc1 m_e93
    v_mov_b32 v176, v9
    v_mov_b32 v184, v9
    v_mov_b32 v188, v9
    v_mov_b32 v180, v9
    v_mov_b32 v177, v9
    v_mov_b32 v185, v9
    v_mov_b32 v189, v9
    v_mov_b32 v181, v9
    v_mov_b32 v178, v9
    v_mov_b32 v186, v9
    v_mov_b32 v190, v9
    v_mov_b32 v182, v9
    v_mov_b32 v179, v9
    v_mov_b32 v187, v9
    v_mov_b32 v191, v9
    v_mov_b32 v183, v9
    s_nop 0
m_e93:
    s_waitcnt lgkmcnt(0)
    v_mfma_f32_16x16x32_bf16 v[96:99], a[192:195], a[128:131], v[160:163]
    s_bitcmp1_b64 s[62:63], s64
    s_cselect_b32 s66, -1.0, s65
    v_exp_f32 v20, v64
    v_mfma_f32_16x16x32_bf16 v[96:99], a[196:199], a[132:135], v[96:99]
    s_add_u32 s64, s64, 1
    v_exp_f32 v21, v65
    v_exp_f32 v22, v66
    v_mfma_f32_16x16x32_bf16 v[96:99], a[200:203], a[136:139], v[96:99]
    buffer_store_dwordx4 v[224:227], v2, s[36:39], s40 offen sc1
    v_cvt_pk_bf16_f32 v128, v20, v21
    v_mfma_f32_16x16x32_bf16 v[96:99], a[204:207], a[140:143], v[96:99]
    s_add_u32 s40, s40, s100
    v_add_f32 v12, v12, v28
    v_exp_f32 v23, v67
    v_mfma_f32_16x16x32_bf16 v[104:107], a[204:207], a[156:159], v[168:171]
    v_exp_f32 v24, v68
    v_cvt_pk_bf16_f32 v129, v22, v23
    v_mfma_f32_16x16x32_bf16 v[104:107], a[200:203], a[152:155], v[104:107]
    buffer_store_dwordx4 v[228:231], v2, s[36:39], s40 offen sc1
    v_exp_f32 v25, v69
    v_mfma_f32_16x16x32_bf16 v[104:107], a[196:199], a[148:151], v[104:107]
    s_add_u32 s40, s40, s100
    v_exp_f32 v26, v70
    v_cvt_pk_bf16_f32 v130, v24, v25
    v_mfma_f32_16x16x32_bf16 v[104:107], a[192:195], a[144:147], v[104:107]
    v_exp_f32 v27, v71
    v_add_f32 v13, v13, v32
    v_mfma_f32_16x16x32_bf16 v[112:115], a[192:195], a[160:163], v[176:179]
    v_exp_f32 v20, v72
    v_cvt_pk_bf16_f32 v131, v26, v27
    v_mfma_f32_16x16x32_bf16 v[112:115], a[196:199], a[164:167], v[112:115]
    buffer_store_dwordx4 v[232:235], v2, s[36:39], s40 offen sc1
    v_exp_f32 v21, v73
    v_mfma_f32_16x16x32_bf16 v[28:31], v[44:47], v[128:131], 0
    v_exp_f32 v22, v74
    v_cvt_pk_bf16_f32 v132, v20, v21
    v_mfma_f32_16x16x32_bf16 v[112:115], a[200:203], a[168:171], v[112:115]
    s_add_u32 s40, s40, s100
    v_exp_f32 v23, v75
    v_add_f32 v14, v14, v36
    v_mfma_f32_16x16x32_bf16 v[112:115], a[204:207], a[172:175], v[112:115]
    v_exp_f32 v24, v76
    v_cvt_pk_bf16_f32 v133, v22, v23
    v_mfma_f32_16x16x32_bf16 v[120:123], a[204:207], a[188:191], v[184:187]
    buffer_store_dwordx4 v[236:239], v2, s[36:39], s40 offen sc1
    v_exp_f32 v25, v77
    v_mfma_f32_16x16x32_bf16 v[120:123], a[200:203], a[184:187], v[120:123]
    s_mov_b32 s40, s98
    v_exp_f32 v26, v78
    v_cvt_pk_bf16_f32 v134, v24, v25
    v_mfma_f32_16x16x32_bf16 v[120:123], a[196:199], a[180:183], v[120:123]
    v_exp_f32 v27, v79
    v_add_f32 v15, v15, v40
    v_mfma_f32_16x16x32_bf16 v[120:123], a[192:195], a[176:179], v[120:123]
    s_waitcnt lgkmcnt(0)
    v_exp_f32 v20, v80
    v_cvt_pk_bf16_f32 v135, v26, v27
    v_mfma_f32_16x16x32_bf16 v[124:127], a[208:211], a[176:179], v[188:191]
    v_exp_f32 v21, v81
    v_exp_f32 v22, v82
    v_mfma_f32_16x16x32_bf16 v[32:35], v[44:47], v[132:135], 0
    v_cvt_pk_bf16_f32 v136, v20, v21
    v_exp_f32 v23, v83
    v_mfma_f32_16x16x32_bf16 v[124:127], a[212:215], a[180:183], v[124:127]
    buffer_store_dwordx4 v[240:243], v2, s[36:39], s40 offen sc1
    v_cvt_pk_bf16_f32 v137, v22, v23
    v_mfma_f32_16x16x32_bf16 v[124:127], a[216:219], a[184:187], v[124:127]
    s_add_u32 s40, s40, s100
    v_exp_f32 v24, v84
    v_mfma_f32_16x16x32_bf16 v[124:127], a[220:223], a[188:191], v[124:127]
    v_exp_f32 v25, v85
    v_exp_f32 v26, v86
    v_cvt_pk_bf16_f32 v138, v24, v25
    v_mfma_f32_16x16x32_bf16 v[116:119], a[220:223], a[172:175], v[180:183]
    buffer_store_dwordx4 v[244:247], v2, s[36:39], s40 offen sc1
    v_mfma_f32_16x16x32_bf16 v[116:119], a[216:219], a[168:171], v[116:119]
    s_add_u32 s40, s40, s100
    v_exp_f32 v27, v87
    v_exp_f32 v20, v88
    v_mfma_f32_16x16x32_bf16 v[116:119], a[212:215], a[164:167], v[116:119]
    v_cvt_pk_bf16_f32 v139, v26, v27
    v_exp_f32 v21, v89
    v_mfma_f32_16x16x32_bf16 v[116:119], a[208:211], a[160:163], v[116:119]
    buffer_store_dwordx4 v[248:251], v2, s[36:39], s40 offen sc1
    v_exp_f32 v22, v90
    v_mfma_f32_16x16x32_bf16 v[36:39], v[44:47], v[136:139], 0
    v_cvt_pk_bf16_f32 v140, v20, v21
    v_exp_f32 v23, v91
    v_mfma_f32_16x16x32_bf16 v[108:111], a[208:211], a[144:147], v[172:175]
    s_add_u32 s40, s40, s100
    v_exp_f32 v24, v92
    v_cvt_pk_bf16_f32 v141, v22, v23
    v_mfma_f32_16x16x32_bf16 v[108:111], a[212:215], a[148:151], v[108:111]
    v_exp_f32 v25, v93
    v_mfma_f32_16x16x32_bf16 v[108:111], a[216:219], a[152:155], v[108:111]
    buffer_store_dwordx4 v[252:255], v2, s[36:39], s40 offen sc1
    v_exp_f32 v26, v94
    v_cvt_pk_bf16_f32 v142, v24, v25
    v_mfma_f32_16x16x32_bf16 v[108:111], a[220:223], a[156:159], v[108:111]
    s_add_u32 s40, s40, s100
    v_exp_f32 v27, v95
    s_nop 0
    v_cvt_pk_bf16_f32 v143, v26, v27
    s_nop 1
    v_mfma_f32_16x16x32_bf16 v[40:43], v[44:47], v[140:143], 0
    s_nop 2
    v_mfma_f32_16x16x32_bf16 v[100:103], a[220:223], a[140:143], v[164:167]
    s_nop 2
    v_mfma_f32_16x16x32_bf16 v[100:103], a[216:219], a[136:139], v[100:103]
    v_max3_f32 v8, v28, v32, v36
    v_max_f32 v8, v8, v40
    v_mfma_f32_16x16x32_bf16 v[100:103], a[212:215], a[132:135], v[100:103]
    v_cmp_nge_f32 vcc, s66, v8
    v_mfma_f32_16x16x32_bf16 v[100:103], a[208:211], a[128:131], v[100:103]
    s_waitcnt vmcnt(48) lgkmcnt(0)
    s_barrier
    s_add_u32 s59, s58, s60
    s_add_u32 s58, s58, 32768
    s_cmp_ge_u32 s58, 163840
    s_cselect_b32 s58, 0, s58
    v_add_u32 v6, s58, v2
    ds_read_b128 a[192:195], v6 offset:0
    ds_read_b128 a[196:199], v6 offset:1024
    ds_read_b128 a[200:203], v6 offset:2048
    ds_read_b128 a[204:207], v6 offset:3072
    ds_read_b128 a[208:211], v6 offset:4096
    ds_read_b128 a[212:215], v6 offset:5120
    ds_read_b128 a[216:219], v6 offset:6144
    ds_read_b128 a[220:223], v6 offset:7168
    s_waitcnt lgkmcnt(0)
    s_cbranch_vccnz m_stub94
m_ret95:
.p2align 3
m_dual96:
    v_mfma_f32_16x16x32_bf16 v[64:67], a[192:195], a[128:131], v[160:163]
    s_bitcmp1_b64 s[62:63], s64
    s_cselect_b32 s66, -1.0, s65
    v_add_f32 v12, v12, v28
    v_mfma_f32_16x16x32_bf16 v[64:67], a[196:199], a[132:135], v[64:67]
    s_add_u32 s64, s64, 1
    ds_read_b128 a[224:227], v6 offset:16384
    v_add_f32 v13, v13, v32
    v_mfma_f32_16x16x32_bf16 v[64:67], a[200:203], a[136:139], v[64:67]
    v_exp_f32 v20, v96
    v_mfma_f32_16x16x32_bf16 v[64:67], a[204:207], a[140:143], v[64:67]
    v_exp_f32 v21, v97
    v_mfma_f32_16x16x32_bf16 v[72:75], a[204:207], a[156:159], v[168:171]
    s_mov_b32 m0, s59
    ds_read_b128 a[228:231], v6 offset:17408
    v_cvt_pk_bf16_f32 v144, v20, v21
    v_mfma_f32_16x16x32_bf16 v[72:75], a[200:203], a[152:155], v[72:75]
    buffer_load_dwordx4 v7, s[24:27], s56 offen offset:0 sc1 lds
    v_mfma_f32_16x16x32_bf16 v[72:75], a[196:199], a[148:151], v[72:75]
    v_exp_f32 v22, v98
    v_mfma_f32_16x16x32_bf16 v[72:75], a[192:195], a[144:147], v[72:75]
    ds_read_b128 a[232:235], v6 offset:18432
    v_add_f32 v14, v14, v36
    v_mfma_f32_16x16x32_bf16 v[80:83], a[192:195], a[160:163], v[176:179]
    v_exp_f32 v23, v99
    v_mfma_f32_16x16x32_bf16 v[80:83], a[196:199], a[164:167], v[80:83]
    v_exp_f32 v24, v100
    v_mfma_f32_16x16x32_bf16 v[80:83], a[200:203], a[168:171], v[80:83]
    ds_read_b128 a[236:239], v6 offset:19456
    v_cvt_pk_bf16_f32 v145, v22, v23
    v_mfma_f32_16x16x32_bf16 v[80:83], a[204:207], a[172:175], v[80:83]
    v_exp_f32 v25, v101
    v_mfma_f32_16x16x32_bf16 v[88:91], a[204:207], a[188:191], v[184:187]
    v_exp_f32 v26, v102
    v_mfma_f32_16x16x32_bf16 v[88:91], a[200:203], a[184:187], v[88:91]
    ds_read_b128 a[240:243], v6 offset:20480
    v_cvt_pk_bf16_f32 v146, v24, v25
    v_mfma_f32_16x16x32_bf16 v[88:91], a[196:199], a[180:183], v[88:91]
    v_exp_f32 v27, v103
    v_mfma_f32_16x16x32_bf16 v[88:91], a[192:195], a[176:179], v[88:91]
    s_waitcnt lgkmcnt(5)
    v_exp_f32 v20, v104
    v_mfma_f32_16x16x32_bf16 v[92:95], a[208:211], a[176:179], v[188:191]
    ds_read_b128 a[244:247], v6 offset:21504
    v_cvt_pk_bf16_f32 v147, v26, v27
    v_mfma_f32_16x16x32_bf16 v[92:95], a[212:215], a[180:183], v[92:95]
    v_exp_f32 v21, v105
    v_mfma_f32_16x16x32_bf16 v[28:31], v[44:47], v[144:147], 0
    v_exp_f32 v22, v106
    v_mfma_f32_16x16x32_bf16 v[92:95], a[216:219], a[184:187], v[92:95]
    buffer_load_dwordx4 v7, s[24:27], s56 offen offset:1024 sc1 lds
    v_mfma_f32_16x16x32_bf16 v[92:95], a[220:223], a[188:191], v[92:95]
    ds_read_b128 a[248:251], v6 offset:22528
    v_cvt_pk_bf16_f32 v148, v20, v21
    v_mfma_f32_16x16x32_bf16 v[84:87], a[220:223], a[172:175], v[180:183]
    v_exp_f32 v23, v107
    v_mfma_f32_16x16x32_bf16 v[84:87], a[216:219], a[168:171], v[84:87]
    v_exp_f32 v24, v108
    v_mfma_f32_16x16x32_bf16 v[84:87], a[212:215], a[164:167], v[84:87]
    ds_read_b128 a[252:255], v6 offset:23552
    v_cvt_pk_bf16_f32 v149, v22, v23
    v_mfma_f32_16x16x32_bf16 v[84:87], a[208:211], a[160:163], v[84:87]
    v_exp_f32 v25, v109
    v_mfma_f32_16x16x32_bf16 v[76:79], a[208:211], a[144:147], v[172:175]
    v_exp_f32 v26, v110
    v_mfma_f32_16x16x32_bf16 v[76:79], a[212:215], a[148:151], v[76:79]
    v_cvt_pk_bf16_f32 v150, v24, v25
    v_add_f32 v15, v15, v40
    v_mfma_f32_16x16x32_bf16 v[76:79], a[216:219], a[152:155], v[76:79]
    v_exp_f32 v27, v111
    v_mfma_f32_16x16x32_bf16 v[76:79], a[220:223], a[156:159], v[76:79]
    buffer_load_dwordx4 v7, s[24:27], s56 offen offset:2048 sc1 lds
    v_mfma_f32_16x16x32_bf16 v[68:71], a[220:223], a[140:143], v[164:167]
    v_exp_f32 v20, v112
    v_mfma_f32_16x16x32_bf16 v[68:71], a[216:219], a[136:139], v[68:71]
    v_cvt_pk_bf16_f32 v151, v26, v27
    v_mfma_f32_16x16x32_bf16 v[68:71], a[212:215], a[132:135], v[68:71]
    v_exp_f32 v21, v113
    v_mfma_f32_16x16x32_bf16 v[32:35], v[44:47], v[148:151], 0
    v_exp_f32 v22, v114
    v_mfma_f32_16x16x32_bf16 v[68:71], a[208:211], a[128:131], v[68:71]
    s_waitcnt lgkmcnt(0)
    v_cvt_pk_bf16_f32 v152, v20, v21
    v_mfma_f32_16x16x32_bf16 a[0:3], a[224:227], v[128:131], a[0:3]
    ds_read_b128 a[192:195], v6 offset:8192
    v_mfma_f32_16x16x32_bf16 a[32:35], a[224:227], v[132:135], a[32:35]
    v_exp_f32 v23, v115
    v_mfma_f32_16x16x32_bf16 a[64:67], a[224:227], v[136:139], a[64:67]
    v_exp_f32 v24, v116
    v_mfma_f32_16x16x32_bf16 a[96:99], a[224:227], v[140:143], a[96:99]
    ds_read_b128 a[196:199], v6 offset:9216
    v_cvt_pk_bf16_f32 v153, v22, v23
    v_mfma_f32_16x16x32_bf16 a[100:103], a[228:231], v[140:143], a[100:103]
    v_exp_f32 v25, v117
    v_mfma_f32_16x16x32_bf16 a[68:71], a[228:231], v[136:139], a[68:71]
    v_exp_f32 v26, v118
    v_mfma_f32_16x16x32_bf16 a[36:39], a[228:231], v[132:135], a[36:39]
    ds_read_b128 a[200:203], v6 offset:10240
    v_cvt_pk_bf16_f32 v154, v24, v25
    v_mfma_f32_16x16x32_bf16 a[4:7], a[228:231], v[128:131], a[4:7]
    v_exp_f32 v27, v119
    v_mfma_f32_16x16x32_bf16 a[8:11], a[232:235], v[128:131], a[8:11]
    v_exp_f32 v20, v120
    v_mfma_f32_16x16x32_bf16 a[40:43], a[232:235], v[132:135], a[40:43]
    ds_read_b128 a[204:207], v6 offset:11264
    v_cvt_pk_bf16_f32 v155, v26, v27
    v_mfma_f32_16x16x32_bf16 a[72:75], a[232:235], v[136:139], a[72:75]
    v_exp_f32 v21, v121
    v_mfma_f32_16x16x32_bf16 v[36:39], v[44:47], v[152:155], 0
    v_exp_f32 v22, v122
    v_mfma_f32_16x16x32_bf16 a[104:107], a[232:235], v[140:143], a[104:107]
    buffer_load_dwordx4 v7, s[24:27], s56 offen offset:3072 sc1 lds
    v_mfma_f32_16x16x32_bf16 a[108:111], a[236:239], v[140:143], a[108:111]
    s_add_u32 s56, s56, 16384
    v_cvt_pk_bf16_f32 v156, v20, v21
    v_mfma_f32_16x16x32_bf16 a[76:79], a[236:239], v[136:139], a[76:79]
    v_exp_f32 v23, v123
    v_mfma_f32_16x16x32_bf16 a[44:47], a[236:239], v[132:135], a[44:47]
    v_exp_f32 v24, v124
    v_mfma_f32_16x16x32_bf16 a[12:15], a[236:239], v[128:131], a[12:15]
    v_cvt_pk_bf16_f32 v157, v22, v23
    v_mfma_f32_16x16x32_bf16 a[16:19], a[240:243], v[128:131], a[16:19]
    v_exp_f32 v25, v125
    v_mfma_f32_16x16x32_bf16 a[48:51], a[240:243], v[132:135], a[48:51]
    v_exp_f32 v26, v126
    v_mfma_f32_16x16x32_bf16 a[80:83], a[240:243], v[136:139], a[80:83]
    v_cvt_pk_bf16_f32 v158, v24, v25
    v_mfma_f32_16x16x32_bf16 a[112:115], a[240:243], v[140:143], a[112:115]
    s_add_u32 m0, s59, 16384
    v_exp_f32 v27, v127
    v_mfma_f32_16x16x32_bf16 a[116:119], a[244:247], v[140:143], a[116:119]
    buffer_load_dwordx4 v7, s[28:31], s57 offen offset:0 sc1 lds
    v_mfma_f32_16x16x32_bf16 a[84:87], a[244:247], v[136:139], a[84:87]
    v_cvt_pk_bf16_f32 v159, v26, v27
    v_mfma_f32_16x16x32_bf16 a[52:55], a[244:247], v[132:135], a[52:55]
    v_mfma_f32_16x16x32_bf16 a[20:23], a[244:247], v[128:131], a[20:23]
    v_mfma_f32_16x16x32_bf16 v[40:43], v[44:47], v[156:159], 0
    s_nop 2
    v_mfma_f32_16x16x32_bf16 a[24:27], a[248:251], v[128:131], a[24:27]
    s_nop 2
    v_mfma_f32_16x16x32_bf16 a[56:59], a[248:251], v[132:135], a[56:59]
    v_max3_f32 v8, v28, v32, v36
    v_max_f32 v8, v8, v40
    v_mfma_f32_16x16x32_bf16 a[88:91], a[248:251], v[136:139], a[88:91]
    v_cmp_nge_f32 vcc, s66, v8
    v_mfma_f32_16x16x32_bf16 a[120:123], a[248:251], v[140:143], a[120:123]
    ds_read_b128 a[208:211], v6 offset:12288
    v_mfma_f32_16x16x32_bf16 a[124:127], a[252:255], v[140:143], a[124:127]
    ds_read_b128 a[212:215], v6 offset:13312
    v_mfma_f32_16x16x32_bf16 a[92:95], a[252:255], v[136:139], a[92:95]
    ds_read_b128 a[216:219], v6 offset:14336
    v_mfma_f32_16x16x32_bf16 a[60:63], a[252:255], v[132:135], a[60:63]
    ds_read_b128 a[220:223], v6 offset:15360
    v_mfma_f32_16x16x32_bf16 a[28:31], a[252:255], v[128:131], a[28:31]
    s_waitcnt lgkmcnt(4)
    s_cbranch_vccnz m_stub97
m_ret98:
    v_mfma_f32_16x16x32_bf16 v[96:99], a[192:195], a[128:131], v[160:163]
    s_add_u32 s59, s58, s60
    v_exp_f32 v20, v64
    v_mfma_f32_16x16x32_bf16 v[96:99], a[196:199], a[132:135], v[96:99]
    s_add_u32 s58, s58, 32768
    ds_read_b128 a[224:227], v6 offset:24576
    v_add_f32 v12, v12, v28
    v_mfma_f32_16x16x32_bf16 v[96:99], a[200:203], a[136:139], v[96:99]
    s_cmp_ge_u32 s58, 163840
    s_cselect_b32 s58, 0, s58
    v_exp_f32 v21, v65
    v_mfma_f32_16x16x32_bf16 v[96:99], a[204:207], a[140:143], v[96:99]
    s_bitcmp1_b64 s[62:63], s64
    s_cselect_b32 s66, -1.0, s65
    v_cvt_pk_bf16_f32 v128, v20, v21
    v_mfma_f32_16x16x32_bf16 v[104:107], a[204:207], a[156:159], v[168:171]
    s_add_u32 s64, s64, 1
    ds_read_b128 a[228:231], v6 offset:25600
    v_add_f32 v13, v13, v32
    v_mfma_f32_16x16x32_bf16 v[104:107], a[200:203], a[152:155], v[104:107]
    v_exp_f32 v22, v66
    v_mfma_f32_16x16x32_bf16 v[104:107], a[196:199], a[148:151], v[104:107]
    buffer_load_dwordx4 v7, s[28:31], s57 offen offset:1024 sc1 lds
    v_mfma_f32_16x16x32_bf16 v[104:107], a[192:195], a[144:147], v[104:107]
    ds_read_b128 a[232:235], v6 offset:26624
    v_add_f32 v14, v14, v36
    v_mfma_f32_16x16x32_bf16 v[112:115], a[192:195], a[160:163], v[176:179]
    v_exp_f32 v23, v67
    v_mfma_f32_16x16x32_bf16 v[112:115], a[196:199], a[164:167], v[112:115]
    v_exp_f32 v24, v68
    v_mfma_f32_16x16x32_bf16 v[112:115], a[200:203], a[168:171], v[112:115]
    ds_read_b128 a[236:239], v6 offset:27648
    v_cvt_pk_bf16_f32 v129, v22, v23
    v_mfma_f32_16x16x32_bf16 v[112:115], a[204:207], a[172:175], v[112:115]
    v_exp_f32 v25, v69
    v_mfma_f32_16x16x32_bf16 v[120:123], a[204:207], a[188:191], v[184:187]
    v_exp_f32 v26, v70
    v_mfma_f32_16x16x32_bf16 v[120:123], a[200:203], a[184:187], v[120:123]
    ds_read_b128 a[240:243], v6 offset:28672
    v_cvt_pk_bf16_f32 v130, v24, v25
    v_mfma_f32_16x16x32_bf16 v[120:123], a[196:199], a[180:183], v[120:123]
    v_exp_f32 v27, v71
    v_mfma_f32_16x16x32_bf16 v[120:123], a[192:195], a[176:179], v[120:123]
    s_waitcnt lgkmcnt(5)
    v_exp_f32 v20, v72
    v_mfma_f32_16x16x32_bf16 v[124:127], a[208:211], a[176:179], v[188:191]
    ds_read_b128 a[244:247], v6 offset:29696
    v_cvt_pk_bf16_f32 v131, v26, v27
    v_mfma_f32_16x16x32_bf16 v[124:127], a[212:215], a[180:183], v[124:127]
    v_exp_f32 v21, v73
    v_mfma_f32_16x16x32_bf16 v[28:31], v[44:47], v[128:131], 0
    v_exp_f32 v22, v74
    v_mfma_f32_16x16x32_bf16 v[124:127], a[216:219], a[184:187], v[124:127]
    buffer_load_dwordx4 v7, s[28:31], s57 offen offset:2048 sc1 lds
    v_mfma_f32_16x16x32_bf16 v[124:127], a[220:223], a[188:191], v[124:127]
    ds_read_b128 a[248:251], v6 offset:30720
    v_cvt_pk_bf16_f32 v132, v20, v21
    v_mfma_f32_16x16x32_bf16 v[116:119], a[220:223], a[172:175], v[180:183]
    v_exp_f32 v23, v75
    v_mfma_f32_16x16x32_bf16 v[116:119], a[216:219], a[168:171], v[116:119]
    v_exp_f32 v24, v76
    v_mfma_f32_16x16x32_bf16 v[116:119], a[212:215], a[164:167], v[116:119]
    ds_read_b128 a[252:255], v6 offset:31744
    v_cvt_pk_bf16_f32 v133, v22, v23
    v_mfma_f32_16x16x32_bf16 v[116:119], a[208:211], a[160:163], v[116:119]
    v_exp_f32 v25, v77
    v_mfma_f32_16x16x32_bf16 v[108:111], a[208:211], a[144:147], v[172:175]
    v_exp_f32 v26, v78
    v_mfma_f32_16x16x32_bf16 v[108:111], a[212:215], a[148:151], v[108:111]
    v_cvt_pk_bf16_f32 v134, v24, v25
    v_add_f32 v15, v15, v40
    v_mfma_f32_16x16x32_bf16 v[108:111], a[216:219], a[152:155], v[108:111]
    v_exp_f32 v27, v79
    v_mfma_f32_16x16x32_bf16 v[108:111], a[220:223], a[156:159], v[108:111]
    buffer_load_dwordx4 v7, s[28:31], s57 offen offset:3072 sc1 lds
    v_mfma_f32_16x16x32_bf16 v[100:103], a[220:223], a[140:143], v[164:167]
    s_add_u32 s57, s57, 16384
    v_exp_f32 v20, v80
    v_mfma_f32_16x16x32_bf16 v[100:103], a[216:219], a[136:139], v[100:103]
    v_cvt_pk_bf16_f32 v135, v26, v27
    v_mfma_f32_16x16x32_bf16 v[100:103], a[212:215], a[132:135], v[100:103]
    v_exp_f32 v21, v81
    v_mfma_f32_16x16x32_bf16 v[32:35], v[44:47], v[132:135], 0
    v_exp_f32 v22, v82
    v_mfma_f32_16x16x32_bf16 v[100:103], a[208:211], a[128:131], v[100:103]
    s_waitcnt vmcnt(24) lgkmcnt(0)
    v_add_u32 v6, s58, v2
    v_cvt_pk_bf16_f32 v136, v20, v21
    v_mfma_f32_16x16x32_bf16 a[0:3], a[224:227], v[144:147], a[0:3]
    s_barrier
    v_mfma_f32_16x16x32_bf16 a[32:35], a[224:227], v[148:151], a[32:35]
    ds_read_b128 a[192:195], v6 offset:0
    v_mfma_f32_16x16x32_bf16 a[64:67], a[224:227], v[152:155], a[64:67]
    v_exp_f32 v23, v83
    v_mfma_f32_16x16x32_bf16 a[96:99], a[224:227], v[156:159], a[96:99]
    v_exp_f32 v24, v84
    v_mfma_f32_16x16x32_bf16 a[100:103], a[228:231], v[156:159], a[100:103]
    ds_read_b128 a[196:199], v6 offset:1024
    v_cvt_pk_bf16_f32 v137, v22, v23
    v_mfma_f32_16x16x32_bf16 a[68:71], a[228:231], v[152:155], a[68:71]
    v_exp_f32 v25, v85
    v_mfma_f32_16x16x32_bf16 a[36:39], a[228:231], v[148:151], a[36:39]
    v_exp_f32 v26, v86
    v_mfma_f32_16x16x32_bf16 a[4:7], a[228:231], v[144:147], a[4:7]
    ds_read_b128 a[200:203], v6 offset:2048
    v_cvt_pk_bf16_f32 v138, v24, v25
    v_mfma_f32_16x16x32_bf16 a[8:11], a[232:235], v[144:147], a[8:11]
    v_exp_f32 v27, v87
    v_mfma_f32_16x16x32_bf16 a[40:43], a[232:235], v[148:151], a[40:43]
    v_exp_f32 v20, v88
    v_mfma_f32_16x16x32_bf16 a[72:75], a[232:235], v[152:155], a[72:75]
    ds_read_b128 a[204:207], v6 offset:3072
    v_cvt_pk_bf16_f32 v139, v26, v27
    v_mfma_f32_16x16x32_bf16 a[104:107], a[232:235], v[156:159], a[104:107]
    v_exp_f32 v21, v89
    v_mfma_f32_16x16x32_bf16 v[36:39], v[44:47], v[136:139], 0
    v_exp_f32 v22, v90
    v_mfma_f32_16x16x32_bf16 a[108:111], a[236:239], v[156:159], a[108:111]
    v_cvt_pk_bf16_f32 v140, v20, v21
    v_mfma_f32_16x16x32_bf16 a[76:79], a[236:239], v[152:155], a[76:79]
    v_exp_f32 v23, v91
    v_mfma_f32_16x16x32_bf16 a[44:47], a[236:239], v[148:151], a[44:47]
    v_exp_f32 v24, v92
    v_mfma_f32_16x16x32_bf16 a[12:15], a[236:239], v[144:147], a[12:15]
    v_cvt_pk_bf16_f32 v141, v22, v23
    v_mfma_f32_16x16x32_bf16 a[16:19], a[240:243], v[144:147], a[16:19]
    v_exp_f32 v25, v93
    v_mfma_f32_16x16x32_bf16 a[48:51], a[240:243], v[148:151], a[48:51]
    v_exp_f32 v26, v94
    v_mfma_f32_16x16x32_bf16 a[80:83], a[240:243], v[152:155], a[80:83]
    v_cvt_pk_bf16_f32 v142, v24, v25
    v_mfma_f32_16x16x32_bf16 a[112:115], a[240:243], v[156:159], a[112:115]
    v_exp_f32 v27, v95
    v_mfma_f32_16x16x32_bf16 a[116:119], a[244:247], v[156:159], a[116:119]
    v_cvt_pk_bf16_f32 v143, v26, v27
    v_mfma_f32_16x16x32_bf16 a[84:87], a[244:247], v[152:155], a[84:87]
    v_mfma_f32_16x16x32_bf16 a[52:55], a[244:247], v[148:151], a[52:55]
    v_mfma_f32_16x16x32_bf16 v[40:43], v[44:47], v[140:143], 0
    s_nop 2
    v_mfma_f32_16x16x32_bf16 a[20:23], a[244:247], v[144:147], a[20:23]
    s_nop 2
    v_mfma_f32_16x16x32_bf16 a[24:27], a[248:251], v[144:147], a[24:27]
    v_max3_f32 v8, v28, v32, v36
    v_max_f32 v8, v8, v40
    v_mfma_f32_16x16x32_bf16 a[56:59], a[248:251], v[148:151], a[56:59]
    v_cmp_nge_f32 vcc, s66, v8
    v_mfma_f32_16x16x32_bf16 a[88:91], a[248:251], v[152:155], a[88:91]
    v_mfma_f32_16x16x32_bf16 a[120:123], a[248:251], v[156:159], a[120:123]
    ds_read_b128 a[208:211], v6 offset:4096
    v_mfma_f32_16x16x32_bf16 a[124:127], a[252:255], v[156:159], a[124:127]
    ds_read_b128 a[212:215], v6 offset:5120
    v_mfma_f32_16x16x32_bf16 a[92:95], a[252:255], v[152:155], a[92:95]
    ds_read_b128 a[216:219], v6 offset:6144
    v_mfma_f32_16x16x32_bf16 a[60:63], a[252:255], v[148:151], a[60:63]
    ds_read_b128 a[220:223], v6 offset:7168
    v_mfma_f32_16x16x32_bf16 a[28:31], a[252:255], v[144:147], a[28:31]
    s_waitcnt lgkmcnt(4)
    s_cbranch_vccz m_dual96
    v_cmp_lt_f32 vcc, s65, v8
    s_cmp_lg_u32 s64, s67
    s_cbranch_scc1 m_e100
    v_add_f32 v176, v176, v16
    v_mov_b32 v180, v9
    v_add_f32 v188, v188, v16
    v_add_f32 v177, v177, v17
    v_mov_b32 v181, v9
    v_add_f32 v189, v189, v17
    v_add_f32 v178, v178, v18
    v_mov_b32 v182, v9
    v_add_f32 v190, v190, v18
    v_add_f32 v179, v179, v19
    v_mov_b32 v183, v9
    v_add_f32 v191, v191, v19
    s_nop 0
m_e100:
    s_cmp_lg_u32 s64, s68
    s_cbranch_scc1 m_e101
    v_mov_b32 v176, v9
    v_mov_b32 v184, v9
    v_mov_b32 v188, v9
    v_mov_b32 v180, v9
    v_mov_b32 v177, v9
    v_mov_b32 v185, v9
    v_mov_b32 v189, v9
    v_mov_b32 v181, v9
    v_mov_b32 v178, v9
    v_mov_b32 v186, v9
    v_mov_b32 v190, v9
    v_mov_b32 v182, v9
    v_mov_b32 v179, v9
    v_mov_b32 v187, v9
    v_mov_b32 v191, v9
    v_mov_b32 v183, v9
    s_nop 0
m_e101:
    s_cmp_lg_u32 s64, s70
    s_cbranch_scc1 m_e102
    v_add_f32 v160, v160, v16
    v_mov_b32 v164, v9
    v_add_f32 v172, v172, v16
    v_add_f32 v161, v161, v17
    v_mov_b32 v165, v9
    v_add_f32 v173, v173, v17
    v_add_f32 v162, v162, v18
    v_mov_b32 v166, v9
    v_add_f32 v174, v174, v18
    v_add_f32 v163, v163, v19
    v_mov_b32 v167, v9
    v_add_f32 v175, v175, v19
    s_nop 0
m_e102:
    s_cmp_lg_u32 s64, s53
    s_cbranch_scc1 m_e105
    s_cmp_lg_u32 s16, 0
    s_cbranch_scc1 m_np106
    v_mov_b32 v60, s4
    v_mov_b32 v61, s5
    s_add_u32 s90, s101, 117440512
    s_mov_b64 exec, 1
    buffer_store_dwordx2 v[60:61], off, s[8:11], s90 sc1
    s_mov_b64 exec, -1
m_np106:
    s_mov_b32 s101, -1
m_e105:
    s_cmp_gt_u32 s64, 24
    s_cbranch_scc1 m_e103
    s_cmp_lg_u32 s64, 8
    s_cbranch_scc1 m_e107
    s_lshr_b32 s90, s32, 1
    s_lshl_b32 s90, s90, 7
    s_add_u32 s90, s90, 117440600
    v_min_u32 v0, 1, v1
    v_lshlrev_b32 v0, 5, v0
    buffer_load_dwordx2 v[4:5], v0, s[8:11], s90 offen sc1
    s_cmp_eq_u32 s17, -1
    s_cbranch_scc1 m_e103
    s_cmp_lg_u32 s16, 0
    s_cbranch_scc1 m_np108
    v_mov_b32 v60, s4
    v_mov_b32 v61, s5
    s_add_u32 s90, s17, 117440512
    s_mov_b64 exec, 1
    buffer_store_dwordx2 v[60:61], off, s[8:11], s90 sc1
    s_mov_b64 exec, -1
m_np108:
    s_branch m_e103
m_e107:
    s_cmp_lg_u32 s64, 16
    s_cbranch_scc1 m_e109
    s_waitcnt vmcnt(18)
    s_mov_b32 s3, 262144
m_spin110:
    v_cmp_ne_u64 s[76:77], s[4:5], v[4:5]
    s_nop 3
    s_cmp_eq_u64 s[76:77], 0
    s_cbranch_scc1 m_e103
    s_sub_u32 s3, s3, 1
    s_cbranch_scc1 m_e103
    s_sleep 32
    s_lshr_b32 s90, s32, 1
    s_lshl_b32 s90, s90, 7
    s_add_u32 s90, s90, 117440600
    v_min_u32 v0, 1, v1
    v_lshlrev_b32 v0, 5, v0
    buffer_load_dwordx2 v[4:5], v0, s[8:11], s90 offen sc1
    s_waitcnt vmcnt(0)
    s_branch m_spin110
    s_branch m_e103
m_e109:
    s_cmp_lg_u32 s64, 20
    s_cbranch_scc1 m_e111
    buffer_load_dwordx2 v[4:5], v10, s[8:11], 0 offen sc1
    s_mov_b32 s44, s48
    s_mov_b32 s45, s49
    s_mov_b32 s46, 8388608
    s_lshl_b32 s90, s2, 2
    s_add_u32 s90, s90, s16
    s_lshl_b32 s90, s90, 13
    v_lshlrev_b32 v62, 7, v1
    buffer_load_dword v255, v62, s[44:47], s90 offen
    s_branch m_e103
m_e111:
    s_cmp_lg_u32 s64, 24
    s_cbranch_scc1 m_e112
    s_mov_b32 s44, s50
    s_mov_b32 s45, s51
    s_mov_b32 s46, 2097152
    s_lshl_b32 s90, s2, 2
    s_add_u32 s90, s90, s16
    s_lshl_b32 s90, s90, 13
    v_lshlrev_b32 v62, 7, v1
    buffer_load_dword v255, v62, s[44:47], s90 offen
    s_waitcnt vmcnt(18)
    s_mov_b32 s3, 262144
m_spin113:
    v_cmp_ne_u64 s[76:77], s[4:5], v[4:5]
    s_nop 3
    s_cmp_eq_u64 s[76:77], 0
    s_cbranch_scc1 m_e103
    s_sub_u32 s3, s3, 1
    s_cbranch_scc1 m_e103
    s_sleep 32
    buffer_load_dwordx2 v[4:5], v10, s[8:11], 0 offen sc1
    s_waitcnt vmcnt(0)
    s_branch m_spin113
    s_branch m_e103
m_e112:
m_e103:
    s_cbranch_vccnz m_rc114
m_sp99:
    s_cmp_lg_u32 s64, s69
    s_cbranch_scc1 m_dual96
    v_mfma_f32_16x16x32_bf16 v[64:67], a[192:195], a[128:131], v[160:163]
    s_bitcmp1_b64 s[62:63], s64
    s_cselect_b32 s66, -1.0, s65
    v_add_f32 v12, v12, v28
    v_mfma_f32_16x16x32_bf16 v[64:67], a[196:199], a[132:135], v[64:67]
    s_add_u32 s64, s64, 1
    ds_read_b128 a[224:227], v6 offset:16384
    v_exp_f32 v20, v96
    v_mfma_f32_16x16x32_bf16 v[64:67], a[200:203], a[136:139], v[64:67]
    s_mov_b32 m0, s59
    ds_read_b128 a[228:231], v6 offset:17408
    v_add_f32 v13, v13, v32
    v_mfma_f32_16x16x32_bf16 v[64:67], a[204:207], a[140:143], v[64:67]
    buffer_load_dwordx4 v7, s[24:27], s56 offen offset:0 sc1 lds
    v_mfma_f32_16x16x32_bf16 v[72:75], a[204:207], a[156:159], v[168:171]
    ds_read_b128 a[232:235], v6 offset:18432
    v_add_f32 v14, v14, v36
    v_mfma_f32_16x16x32_bf16 v[72:75], a[200:203], a[152:155], v[72:75]
    ds_read_b128 a[236:239], v6 offset:19456
    v_exp_f32 v21, v97
    v_mfma_f32_16x16x32_bf16 v[72:75], a[196:199], a[148:151], v[72:75]
    ds_read_b128 a[240:243], v6 offset:20480
    v_cvt_pk_bf16_f32 v144, v20, v21
    v_mfma_f32_16x16x32_bf16 v[72:75], a[192:195], a[144:147], v[72:75]
    s_waitcnt lgkmcnt(5)
    ds_read_b128 a[244:247], v6 offset:21504
    v_add_f32 v15, v15, v40
    v_mfma_f32_16x16x32_bf16 v[76:79], a[208:211], a[144:147], v[172:175]
    ds_read_b128 a[248:251], v6 offset:22528
    v_exp_f32 v22, v98
    v_mfma_f32_16x16x32_bf16 v[76:79], a[212:215], a[148:151], v[76:79]
    ds_read_b128 a[252:255], v6 offset:23552
    v_exp_f32 v23, v99
    v_mfma_f32_16x16x32_bf16 v[76:79], a[216:219], a[152:155], v[76:79]
    v_exp_f32 v24, v100
    v_mfma_f32_16x16x32_bf16 v[76:79], a[220:223], a[156:159], v[76:79]
    buffer_load_dwordx4 v7, s[24:27], s56 offen offset:1024 sc1 lds
    v_mfma_f32_16x16x32_bf16 v[68:71], a[220:223], a[140:143], v[164:167]
    v_cvt_pk_bf16_f32 v145, v22, v23
    v_exp_f32 v25, v101
    v_mfma_f32_16x16x32_bf16 v[68:71], a[216:219], a[136:139], v[68:71]
    v_exp_f32 v26, v102
    v_mfma_f32_16x16x32_bf16 v[68:71], a[212:215], a[132:135], v[68:71]
    v_cvt_pk_bf16_f32 v146, v24, v25
    v_exp_f32 v27, v103
    v_mfma_f32_16x16x32_bf16 v[68:71], a[208:211], a[128:131], v[68:71]
    s_waitcnt lgkmcnt(0)
    v_exp_f32 v20, v104
    v_mfma_f32_16x16x32_bf16 a[0:3], a[224:227], v[128:131], a[0:3]
    ds_read_b128 a[192:195], v6 offset:8192
    v_cvt_pk_bf16_f32 v147, v26, v27
    v_mfma_f32_16x16x32_bf16 a[32:35], a[224:227], v[132:135], a[32:35]
    v_exp_f32 v21, v105
    v_mfma_f32_16x16x32_bf16 v[28:31], v[44:47], v[144:147], 0
    v_exp_f32 v22, v106
    v_mfma_f32_16x16x32_bf16 a[64:67], a[224:227], v[136:139], a[64:67]
    v_cvt_pk_bf16_f32 v148, v20, v21
    v_exp_f32 v23, v107
    v_mfma_f32_16x16x32_bf16 a[96:99], a[224:227], v[140:143], a[96:99]
    ds_read_b128 a[196:199], v6 offset:9216
    v_cvt_pk_bf16_f32 v149, v22, v23
    v_mfma_f32_16x16x32_bf16 a[100:103], a[228:231], v[140:143], a[100:103]
    v_exp_f32 v24, v108
    v_mfma_f32_16x16x32_bf16 a[68:71], a[228:231], v[136:139], a[68:71]
    buffer_load_dwordx4 v7, s[24:27], s56 offen offset:2048 sc1 lds
    v_mfma_f32_16x16x32_bf16 a[36:39], a[228:231], v[132:135], a[36:39]
    ds_read_b128 a[200:203], v6 offset:10240
    v_exp_f32 v25, v109
    v_mfma_f32_16x16x32_bf16 a[4:7], a[228:231], v[128:131], a[4:7]
    v_exp_f32 v26, v110
    v_mfma_f32_16x16x32_bf16 a[8:11], a[232:235], v[128:131], a[8:11]
    v_cvt_pk_bf16_f32 v150, v24, v25
    v_exp_f32 v27, v111
    v_mfma_f32_16x16x32_bf16 a[40:43], a[232:235], v[132:135], a[40:43]
    ds_read_b128 a[204:207], v6 offset:11264
    v_cvt_pk_bf16_f32 v151, v26, v27
    v_mfma_f32_16x16x32_bf16 a[72:75], a[232:235], v[136:139], a[72:75]
    v_exp_f32 v20, v112
    v_mfma_f32_16x16x32_bf16 v[32:35], v[44:47], v[148:151], 0
    v_exp_f32 v21, v113
    v_mfma_f32_16x16x32_bf16 a[104:107], a[232:235], v[140:143], a[104:107]
    v_exp_f32 v22, v114
    v_mfma_f32_16x16x32_bf16 a[108:111], a[236:239], v[140:143], a[108:111]
    v_cvt_pk_bf16_f32 v152, v20, v21
    v_exp_f32 v23, v115
    v_mfma_f32_16x16x32_bf16 a[76:79], a[236:239], v[136:139], a[76:79]
    v_exp_f32 v24, v116
    v_mfma_f32_16x16x32_bf16 a[44:47], a[236:239], v[132:135], a[44:47]
    v_cvt_pk_bf16_f32 v153, v22, v23
    v_exp_f32 v25, v117
    v_mfma_f32_16x16x32_bf16 a[12:15], a[236:239], v[128:131], a[12:15]
    buffer_load_dwordx4 v7, s[24:27], s56 offen offset:3072 sc1 lds
    v_mfma_f32_16x16x32_bf16 a[16:19], a[240:243], v[128:131], a[16:19]
    s_add_u32 s56, s56, 16384
    v_exp_f32 v26, v118
    v_mfma_f32_16x16x32_bf16 a[48:51], a[240:243], v[132:135], a[48:51]
    v_cvt_pk_bf16_f32 v154, v24, v25
    v_exp_f32 v27, v119
    v_mfma_f32_16x16x32_bf16 a[80:83], a[240:243], v[136:139], a[80:83]
    v_exp_f32 v20, v120
    v_mfma_f32_16x16x32_bf16 a[112:115], a[240:243], v[140:143], a[112:115]
    v_cvt_pk_bf16_f32 v155, v26, v27
    v_exp_f32 v21, v121
    v_mfma_f32_16x16x32_bf16 a[116:119], a[244:247], v[140:143], a[116:119]
    v_exp_f32 v22, v122
    v_mfma_f32_16x16x32_bf16 v[36:39], v[44:47], v[152:155], 0
    v_cvt_pk_bf16_f32 v156, v20, v21
    v_mfma_f32_16x16x32_bf16 a[84:87], a[244:247], v[136:139], a[84:87]
    v_exp_f32 v23, v123
    v_mfma_f32_16x16x32_bf16 a[52:55], a[244:247], v[132:135], a[52:55]
    v_exp_f32 v24, v124
    v_cvt_pk_bf16_f32 v157, v22, v23
    v_mfma_f32_16x16x32_bf16 a[20:23], a[244:247], v[128:131], a[20:23]
    v_exp_f32 v25, v125
    v_mfma_f32_16x16x32_bf16 a[24:27], a[248:251], v[128:131], a[24:27]
    s_add_u32 m0, s59, 16384
    v_exp_f32 v26, v126
    v_mfma_f32_16x16x32_bf16 a[56:59], a[248:251], v[132:135], a[56:59]
    buffer_load_dwordx4 v7, s[28:31], s57 offen offset:0 sc1 lds
    v_mfma_f32_16x16x32_bf16 a[88:91], a[248:251], v[136:139], a[88:91]
    v_cvt_pk_bf16_f32 v158, v24, v25
    v_exp_f32 v27, v127
    v_mfma_f32_16x16x32_bf16 a[120:123], a[248:251], v[140:143], a[120:123]
    ds_read_b128 a[208:211], v6 offset:12288
    v_cvt_pk_bf16_f32 v159, v26, v27
    s_nop 1
    v_mfma_f32_16x16x32_bf16 v[40:43], v[44:47], v[156:159], 0
    s_nop 2
    v_mfma_f32_16x16x32_bf16 a[124:127], a[252:255], v[140:143], a[124:127]
    ds_read_b128 a[212:215], v6 offset:13312
    s_nop 0
    v_mfma_f32_16x16x32_bf16 a[92:95], a[252:255], v[136:139], a[92:95]
    ds_read_b128 a[216:219], v6 offset:14336
    v_max3_f32 v8, v28, v32, v36
    v_mfma_f32_16x16x32_bf16 a[60:63], a[252:255], v[132:135], a[60:63]
    ds_read_b128 a[220:223], v6 offset:15360
    v_max_f32 v8, v8, v40
    v_cmp_nge_f32 vcc, s66, v8
    v_mfma_f32_16x16x32_bf16 a[28:31], a[252:255], v[128:131], a[28:31]
    s_waitcnt lgkmcnt(4)
    s_cbranch_vccnz m_stub115
m_ret116:
    v_mfma_f32_16x16x32_bf16 v[96:99], a[192:195], a[128:131], v[160:163]
    s_add_u32 s59, s58, s60
    v_exp_f32 v20, v64
    v_mfma_f32_16x16x32_bf16 v[96:99], a[196:199], a[132:135], v[96:99]
    s_add_u32 s58, s58, 32768
    ds_read_b128 a[224:227], v6 offset:24576
    v_add_f32 v12, v12, v28
    v_mfma_f32_16x16x32_bf16 v[96:99], a[200:203], a[136:139], v[96:99]
    s_cmp_ge_u32 s58, 163840
    s_cselect_b32 s58, 0, s58
    ds_read_b128 a[228:231], v6 offset:25600
    v_add_f32 v13, v13, v32
    v_mfma_f32_16x16x32_bf16 v[96:99], a[204:207], a[140:143], v[96:99]
    buffer_load_dwordx4 v7, s[28:31], s57 offen offset:1024 sc1 lds
    v_mfma_f32_16x16x32_bf16 v[104:107], a[204:207], a[156:159], v[168:171]
    s_bitcmp1_b64 s[62:63], s64
    s_cselect_b32 s66, -1.0, s65
    ds_read_b128 a[232:235], v6 offset:26624
    v_mfma_f32_16x16x32_bf16 v[104:107], a[200:203], a[152:155], v[104:107]
    s_add_u32 s64, s64, 1
    ds_read_b128 a[236:239], v6 offset:27648
    v_mfma_f32_16x16x32_bf16 v[104:107], a[196:199], a[148:151], v[104:107]
    ds_read_b128 a[240:243], v6 offset:28672
    v_mfma_f32_16x16x32_bf16 v[104:107], a[192:195], a[144:147], v[104:107]
    s_waitcnt lgkmcnt(5)
    ds_read_b128 a[244:247], v6 offset:29696
    v_mfma_f32_16x16x32_bf16 v[108:111], a[208:211], a[144:147], v[172:175]
    buffer_load_dwordx4 v7, s[28:31], s57 offen offset:2048 sc1 lds
    v_mfma_f32_16x16x32_bf16 v[108:111], a[212:215], a[148:151], v[108:111]
    ds_read_b128 a[248:251], v6 offset:30720
    v_mfma_f32_16x16x32_bf16 v[108:111], a[216:219], a[152:155], v[108:111]
    ds_read_b128 a[252:255], v6 offset:31744
    v_mfma_f32_16x16x32_bf16 v[108:111], a[220:223], a[156:159], v[108:111]
    v_exp_f32 v21, v65
    v_mfma_f32_16x16x32_bf16 v[100:103], a[220:223], a[140:143], v[164:167]
    v_exp_f32 v22, v66
    v_mfma_f32_16x16x32_bf16 v[100:103], a[216:219], a[136:139], v[100:103]
    buffer_load_dwordx4 v7, s[28:31], s57 offen offset:3072 sc1 lds
    v_mfma_f32_16x16x32_bf16 v[100:103], a[212:215], a[132:135], v[100:103]
    s_add_u32 s57, s57, 16384
    v_cvt_pk_bf16_f32 v128, v20, v21
    v_mfma_f32_16x16x32_bf16 v[100:103], a[208:211], a[128:131], v[100:103]
    s_waitcnt vmcnt(24) lgkmcnt(0)
    v_add_u32 v6, s58, v2
    v_mfma_f32_16x16x32_bf16 a[0:3], a[224:227], v[144:147], a[0:3]
    s_barrier
    v_mfma_f32_16x16x32_bf16 a[32:35], a[224:227], v[148:151], a[32:35]
    ds_read_b128 a[192:195], v6 offset:0
    v_mfma_f32_16x16x32_bf16 a[64:67], a[224:227], v[152:155], a[64:67]
    v_exp_f32 v23, v67
    v_mfma_f32_16x16x32_bf16 a[96:99], a[224:227], v[156:159], a[96:99]
    v_exp_f32 v24, v68
    v_mfma_f32_16x16x32_bf16 a[100:103], a[228:231], v[156:159], a[100:103]
    ds_read_b128 a[196:199], v6 offset:1024
    v_cvt_pk_bf16_f32 v129, v22, v23
    v_mfma_f32_16x16x32_bf16 a[68:71], a[228:231], v[152:155], a[68:71]
    v_exp_f32 v25, v69
    v_mfma_f32_16x16x32_bf16 a[36:39], a[228:231], v[148:151], a[36:39]
    v_exp_f32 v26, v70
    v_mfma_f32_16x16x32_bf16 a[4:7], a[228:231], v[144:147], a[4:7]
    ds_read_b128 a[200:203], v6 offset:2048
    v_cvt_pk_bf16_f32 v130, v24, v25
    v_mfma_f32_16x16x32_bf16 a[8:11], a[232:235], v[144:147], a[8:11]
    v_exp_f32 v27, v71
    v_mfma_f32_16x16x32_bf16 a[40:43], a[232:235], v[148:151], a[40:43]
    v_exp_f32 v20, v72
    v_mfma_f32_16x16x32_bf16 a[72:75], a[232:235], v[152:155], a[72:75]
    ds_read_b128 a[204:207], v6 offset:3072
    v_cvt_pk_bf16_f32 v131, v26, v27
    v_mfma_f32_16x16x32_bf16 a[104:107], a[232:235], v[156:159], a[104:107]
    v_exp_f32 v21, v73
    v_mfma_f32_16x16x32_bf16 v[28:31], v[44:47], v[128:131], 0
    v_exp_f32 v22, v74
    v_mfma_f32_16x16x32_bf16 a[108:111], a[236:239], v[156:159], a[108:111]
    v_cvt_pk_bf16_f32 v132, v20, v21
    v_mfma_f32_16x16x32_bf16 a[76:79], a[236:239], v[152:155], a[76:79]
    v_exp_f32 v23, v75
    v_mfma_f32_16x16x32_bf16 a[44:47], a[236:239], v[148:151], a[44:47]
    v_exp_f32 v24, v76
    v_mfma_f32_16x16x32_bf16 a[12:15], a[236:239], v[144:147], a[12:15]
    v_cvt_pk_bf16_f32 v133, v22, v23
    v_mfma_f32_16x16x32_bf16 a[16:19], a[240:243], v[144:147], a[16:19]
    v_exp_f32 v25, v77
    v_mfma_f32_16x16x32_bf16 a[48:51], a[240:243], v[148:151], a[48:51]
    v_exp_f32 v26, v78
    v_mfma_f32_16x16x32_bf16 a[80:83], a[240:243], v[152:155], a[80:83]
    v_cvt_pk_bf16_f32 v134, v24, v25
    v_mfma_f32_16x16x32_bf16 a[112:115], a[240:243], v[156:159], a[112:115]
    v_exp_f32 v27, v79
    v_mfma_f32_16x16x32_bf16 a[116:119], a[244:247], v[156:159], a[116:119]
    v_cvt_pk_bf16_f32 v135, v26, v27
    v_mfma_f32_16x16x32_bf16 a[84:87], a[244:247], v[152:155], a[84:87]
    v_mfma_f32_16x16x32_bf16 a[52:55], a[244:247], v[148:151], a[52:55]
    v_mfma_f32_16x16x32_bf16 v[32:35], v[44:47], v[132:135], 0
    s_nop 2
    v_mfma_f32_16x16x32_bf16 a[20:23], a[244:247], v[144:147], a[20:23]
    s_nop 2
    v_mfma_f32_16x16x32_bf16 a[24:27], a[248:251], v[144:147], a[24:27]
    v_max_f32 v8, v28, v32
    v_cmp_nge_f32 vcc, s66, v8
    v_mfma_f32_16x16x32_bf16 a[56:59], a[248:251], v[148:151], a[56:59]
    v_mfma_f32_16x16x32_bf16 a[88:91], a[248:251], v[152:155], a[88:91]
    v_mfma_f32_16x16x32_bf16 a[120:123], a[248:251], v[156:159], a[120:123]
    ds_read_b128 a[208:211], v6 offset:4096
    v_mfma_f32_16x16x32_bf16 a[124:127], a[252:255], v[156:159], a[124:127]
    ds_read_b128 a[212:215], v6 offset:5120
    v_mfma_f32_16x16x32_bf16 a[92:95], a[252:255], v[152:155], a[92:95]
    ds_read_b128 a[216:219], v6 offset:6144
    v_mfma_f32_16x16x32_bf16 a[60:63], a[252:255], v[148:151], a[60:63]
    ds_read_b128 a[220:223], v6 offset:7168
    v_mfma_f32_16x16x32_bf16 a[28:31], a[252:255], v[144:147], a[28:31]
    s_waitcnt lgkmcnt(4)
    s_cbranch_vccnz m_stub117
m_ret118:
    v_add_f32 v20, v14, v36
    v_add_f32 v21, v15, v40
    s_nop 3
    v_rcp_f32 v22, v21
    v_rcp_f32 v20, v20
    s_lshl_b32 s90, s79, 10
    s_add_u32 s90, s90, s82
    s_add_u32 s90, s90, 67108864
    v_accvgpr_read_b32 v48, a64
    v_accvgpr_read_b32 v49, a65
    v_accvgpr_read_b32 v50, a66
    v_accvgpr_read_b32 v51, a67
    v_accvgpr_read_b32 v52, a68
    v_accvgpr_read_b32 v53, a69
    v_accvgpr_read_b32 v54, a70
    v_accvgpr_read_b32 v55, a71
    v_pk_mul_f32 v[48:49], v[48:49], v[20:21] op_sel_hi:[1,0]
    v_pk_mul_f32 v[50:51], v[50:51], v[20:21] op_sel_hi:[1,0]
    v_pk_mul_f32 v[52:53], v[52:53], v[20:21] op_sel_hi:[1,0]
    v_pk_mul_f32 v[54:55], v[54:55], v[20:21] op_sel_hi:[1,0]
    v_cvt_pk_bf16_f32 v48, v48, v49
    v_cvt_pk_bf16_f32 v49, v50, v51
    v_cvt_pk_bf16_f32 v50, v52, v53
    v_cvt_pk_bf16_f32 v51, v54, v55
    buffer_store_dwordx4 v[48:51], v2, s[8:11], s90 offen offset:0 sc1
    v_accvgpr_read_b32 v56, a96
    v_accvgpr_read_b32 v57, a97
    v_accvgpr_read_b32 v58, a98
    v_accvgpr_read_b32 v59, a99
    v_accvgpr_read_b32 v60, a100
    v_accvgpr_read_b32 v61, a101
    v_accvgpr_read_b32 v62, a102
    v_accvgpr_read_b32 v63, a103
    v_pk_mul_f32 v[56:57], v[56:57], v[22:23] op_sel_hi:[1,0]
    v_pk_mul_f32 v[58:59], v[58:59], v[22:23] op_sel_hi:[1,0]
    v_pk_mul_f32 v[60:61], v[60:61], v[22:23] op_sel_hi:[1,0]
    v_pk_mul_f32 v[62:63], v[62:63], v[22:23] op_sel_hi:[1,0]
    v_cvt_pk_bf16_f32 v56, v56, v57
    v_cvt_pk_bf16_f32 v57, v58, v59
    v_cvt_pk_bf16_f32 v58, v60, v61
    v_cvt_pk_bf16_f32 v59, v62, v63
    buffer_store_dwordx4 v[56:59], v2, s[8:11], s90 offen offset:1024 sc1
    s_add_u32 s90, s90, 131072
    v_accvgpr_read_b32 v48, a72
    v_accvgpr_read_b32 v49, a73
    v_accvgpr_read_b32 v50, a74
    v_accvgpr_read_b32 v51, a75
    v_accvgpr_read_b32 v52, a76
    v_accvgpr_read_b32 v53, a77
    v_accvgpr_read_b32 v54, a78
    v_accvgpr_read_b32 v55, a79
    v_pk_mul_f32 v[48:49], v[48:49], v[20:21] op_sel_hi:[1,0]
    v_pk_mul_f32 v[50:51], v[50:51], v[20:21] op_sel_hi:[1,0]
    v_pk_mul_f32 v[52:53], v[52:53], v[20:21] op_sel_hi:[1,0]
    v_pk_mul_f32 v[54:55], v[54:55], v[20:21] op_sel_hi:[1,0]
    v_cvt_pk_bf16_f32 v48, v48, v49
    v_cvt_pk_bf16_f32 v49, v50, v51
    v_cvt_pk_bf16_f32 v50, v52, v53
    v_cvt_pk_bf16_f32 v51, v54, v55
    buffer_store_dwordx4 v[48:51], v2, s[8:11], s90 offen offset:0 sc1
    v_accvgpr_read_b32 v56, a104
    v_accvgpr_read_b32 v57, a105
    v_accvgpr_read_b32 v58, a106
    v_accvgpr_read_b32 v59, a107
    v_accvgpr_read_b32 v60, a108
    v_accvgpr_read_b32 v61, a109
    v_accvgpr_read_b32 v62, a110
    v_accvgpr_read_b32 v63, a111
    v_pk_mul_f32 v[56:57], v[56:57], v[22:23] op_sel_hi:[1,0]
    v_pk_mul_f32 v[58:59], v[58:59], v[22:23] op_sel_hi:[1,0]
    v_pk_mul_f32 v[60:61], v[60:61], v[22:23] op_sel_hi:[1,0]
    v_pk_mul_f32 v[62:63], v[62:63], v[22:23] op_sel_hi:[1,0]
    v_cvt_pk_bf16_f32 v56, v56, v57
    v_cvt_pk_bf16_f32 v57, v58, v59
    v_cvt_pk_bf16_f32 v58, v60, v61
    v_cvt_pk_bf16_f32 v59, v62, v63
    buffer_store_dwordx4 v[56:59], v2, s[8:11], s90 offen offset:1024 sc1
    s_add_u32 s90, s90, 131072
    v_accvgpr_read_b32 v48, a80
    v_accvgpr_read_b32 v49, a81
    v_accvgpr_read_b32 v50, a82
    v_accvgpr_read_b32 v51, a83
    v_accvgpr_read_b32 v52, a84
    v_accvgpr_read_b32 v53, a85
    v_accvgpr_read_b32 v54, a86
    v_accvgpr_read_b32 v55, a87
    v_pk_mul_f32 v[48:49], v[48:49], v[20:21] op_sel_hi:[1,0]
    v_pk_mul_f32 v[50:51], v[50:51], v[20:21] op_sel_hi:[1,0]
    v_pk_mul_f32 v[52:53], v[52:53], v[20:21] op_sel_hi:[1,0]
    v_pk_mul_f32 v[54:55], v[54:55], v[20:21] op_sel_hi:[1,0]
    v_cvt_pk_bf16_f32 v48, v48, v49
    v_cvt_pk_bf16_f32 v49, v50, v51
    v_cvt_pk_bf16_f32 v50, v52, v53
    v_cvt_pk_bf16_f32 v51, v54, v55
    buffer_store_dwordx4 v[48:51], v2, s[8:11], s90 offen offset:0 sc1
    v_accvgpr_read_b32 v56, a112
    v_accvgpr_read_b32 v57, a113
    v_accvgpr_read_b32 v58, a114
    v_accvgpr_read_b32 v59, a115
    v_accvgpr_read_b32 v60, a116
    v_accvgpr_read_b32 v61, a117
    v_accvgpr_read_b32 v62, a118
    v_accvgpr_read_b32 v63, a119
    v_pk_mul_f32 v[56:57], v[56:57], v[22:23] op_sel_hi:[1,0]
    v_pk_mul_f32 v[58:59], v[58:59], v[22:23] op_sel_hi:[1,0]
    v_pk_mul_f32 v[60:61], v[60:61], v[22:23] op_sel_hi:[1,0]
    v_pk_mul_f32 v[62:63], v[62:63], v[22:23] op_sel_hi:[1,0]
    v_cvt_pk_bf16_f32 v56, v56, v57
    v_cvt_pk_bf16_f32 v57, v58, v59
    v_cvt_pk_bf16_f32 v58, v60, v61
    v_cvt_pk_bf16_f32 v59, v62, v63
    buffer_store_dwordx4 v[56:59], v2, s[8:11], s90 offen offset:1024 sc1
    s_add_u32 s90, s90, 131072
    v_accvgpr_read_b32 v48, a88
    v_accvgpr_read_b32 v49, a89
    v_accvgpr_read_b32 v50, a90
    v_accvgpr_read_b32 v51, a91
    v_accvgpr_read_b32 v52, a92
    v_accvgpr_read_b32 v53, a93
    v_accvgpr_read_b32 v54, a94
    v_accvgpr_read_b32 v55, a95
    v_pk_mul_f32 v[48:49], v[48:49], v[20:21] op_sel_hi:[1,0]
    v_pk_mul_f32 v[50:51], v[50:51], v[20:21] op_sel_hi:[1,0]
    v_pk_mul_f32 v[52:53], v[52:53], v[20:21] op_sel_hi:[1,0]
    v_pk_mul_f32 v[54:55], v[54:55], v[20:21] op_sel_hi:[1,0]
    v_cvt_pk_bf16_f32 v48, v48, v49
    v_cvt_pk_bf16_f32 v49, v50, v51
    v_cvt_pk_bf16_f32 v50, v52, v53
    v_cvt_pk_bf16_f32 v51, v54, v55
    buffer_store_dwordx4 v[48:51], v2, s[8:11], s90 offen offset:0 sc1
    v_accvgpr_read_b32 v56, a120
    v_accvgpr_read_b32 v57, a121
    v_accvgpr_read_b32 v58, a122
    v_accvgpr_read_b32 v59, a123
    v_accvgpr_read_b32 v60, a124
    v_accvgpr_read_b32 v61, a125
    v_accvgpr_read_b32 v62, a126
    v_accvgpr_read_b32 v63, a127
    v_pk_mul_f32 v[56:57], v[56:57], v[22:23] op_sel_hi:[1,0]
    v_pk_mul_f32 v[58:59], v[58:59], v[22:23] op_sel_hi:[1,0]
    v_pk_mul_f32 v[60:61], v[60:61], v[22:23] op_sel_hi:[1,0]
    v_pk_mul_f32 v[62:63], v[62:63], v[22:23] op_sel_hi:[1,0]
    v_cvt_pk_bf16_f32 v56, v56, v57
    v_cvt_pk_bf16_f32 v57, v58, v59
    v_cvt_pk_bf16_f32 v58, v60, v61
    v_cvt_pk_bf16_f32 v59, v62, v63
    buffer_store_dwordx4 v[56:59], v2, s[8:11], s90 offen offset:1024 sc1
    s_add_u32 s90, s90, 131072
    s_lshl_b32 s101, s34, 5
    s_add_u32 s101, s101, s32
    s_lshl_b32 s101, s101, 3
    s_add_u32 s101, s101, 7936
    s_cmp_eq_u32 s64, s72
    s_cbranch_scc1 m_singlex120
.p2align 3
m_single119:
    v_mfma_f32_16x16x32_bf16 v[64:67], a[192:195], a[128:131], v[160:163]
    s_bitcmp1_b64 s[62:63], s64
    s_cselect_b32 s66, -1.0, s65
    v_add_f32 v12, v12, v28
    v_mfma_f32_16x16x32_bf16 v[64:67], a[196:199], a[132:135], v[64:67]
    s_mov_b32 m0, s59
    ds_read_b128 a[224:227], v6 offset:16384
    v_add_f32 v13, v13, v32
    v_mfma_f32_16x16x32_bf16 v[64:67], a[200:203], a[136:139], v[64:67]
    buffer_load_dwordx4 v7, s[24:27], s56 offen offset:0 sc1 lds
    v_mfma_f32_16x16x32_bf16 v[64:67], a[204:207], a[140:143], v[64:67]
    s_add_u32 s64, s64, 1
    ds_read_b128 a[228:231], v6 offset:17408
    v_exp_f32 v20, v96
    v_mfma_f32_16x16x32_bf16 v[72:75], a[204:207], a[156:159], v[168:171]
    ds_read_b128 a[232:235], v6 offset:18432
    v_exp_f32 v21, v97
    v_mfma_f32_16x16x32_bf16 v[72:75], a[200:203], a[152:155], v[72:75]
    ds_read_b128 a[236:239], v6 offset:19456
    v_cvt_pk_bf16_f32 v144, v20, v21
    v_mfma_f32_16x16x32_bf16 v[72:75], a[196:199], a[148:151], v[72:75]
    ds_read_b128 a[240:243], v6 offset:20480
    v_exp_f32 v22, v98
    v_mfma_f32_16x16x32_bf16 v[72:75], a[192:195], a[144:147], v[72:75]
    s_waitcnt lgkmcnt(5)
    ds_read_b128 a[244:247], v6 offset:21504
    v_mfma_f32_16x16x32_bf16 v[76:79], a[208:211], a[144:147], v[172:175]
    ds_read_b128 a[248:251], v6 offset:22528
    v_exp_f32 v23, v99
    v_mfma_f32_16x16x32_bf16 v[76:79], a[212:215], a[148:151], v[76:79]
    ds_read_b128 a[252:255], v6 offset:23552
    v_cvt_pk_bf16_f32 v145, v22, v23
    v_mfma_f32_16x16x32_bf16 v[76:79], a[216:219], a[152:155], v[76:79]
    buffer_load_dwordx4 v7, s[24:27], s56 offen offset:1024 sc1 lds
    v_mfma_f32_16x16x32_bf16 v[76:79], a[220:223], a[156:159], v[76:79]
    v_exp_f32 v24, v100
    v_mfma_f32_16x16x32_bf16 v[68:71], a[220:223], a[140:143], v[164:167]
    v_exp_f32 v25, v101
    v_mfma_f32_16x16x32_bf16 v[68:71], a[216:219], a[136:139], v[68:71]
    v_exp_f32 v26, v102
    v_mfma_f32_16x16x32_bf16 v[68:71], a[212:215], a[132:135], v[68:71]
    buffer_load_dwordx4 v7, s[24:27], s56 offen offset:2048 sc1 lds
    v_cvt_pk_bf16_f32 v146, v24, v25
    v_mfma_f32_16x16x32_bf16 v[68:71], a[208:211], a[128:131], v[68:71]
    s_waitcnt lgkmcnt(0)
    v_exp_f32 v27, v103
    v_mfma_f32_16x16x32_bf16 a[0:3], a[224:227], v[128:131], a[0:3]
    ds_read_b128 a[192:195], v6 offset:8192
    v_cvt_pk_bf16_f32 v147, v26, v27
    v_mfma_f32_16x16x32_bf16 a[32:35], a[224:227], v[132:135], a[32:35]
    v_exp_f32 v20, v104
    v_mfma_f32_16x16x32_bf16 v[28:31], v[44:47], v[144:147], 0
    v_exp_f32 v21, v105
    v_mfma_f32_16x16x32_bf16 a[36:39], a[228:231], v[132:135], a[36:39]
    ds_read_b128 a[196:199], v6 offset:9216
    v_exp_f32 v22, v106
    v_mfma_f32_16x16x32_bf16 a[4:7], a[228:231], v[128:131], a[4:7]
    buffer_load_dwordx4 v7, s[24:27], s56 offen offset:3072 sc1 lds
    v_mfma_f32_16x16x32_bf16 a[8:11], a[232:235], v[128:131], a[8:11]
    s_add_u32 s56, s56, 16384
    ds_read_b128 a[200:203], v6 offset:10240
    v_cvt_pk_bf16_f32 v148, v20, v21
    v_mfma_f32_16x16x32_bf16 a[40:43], a[232:235], v[132:135], a[40:43]
    v_exp_f32 v23, v107
    v_mfma_f32_16x16x32_bf16 a[44:47], a[236:239], v[132:135], a[44:47]
    ds_read_b128 a[204:207], v6 offset:11264
    v_exp_f32 v24, v108
    v_mfma_f32_16x16x32_bf16 a[12:15], a[236:239], v[128:131], a[12:15]
    v_cvt_pk_bf16_f32 v149, v22, v23
    v_exp_f32 v25, v109
    v_mfma_f32_16x16x32_bf16 a[16:19], a[240:243], v[128:131], a[16:19]
    v_exp_f32 v26, v110
    v_mfma_f32_16x16x32_bf16 a[48:51], a[240:243], v[132:135], a[48:51]
    v_cvt_pk_bf16_f32 v150, v24, v25
    v_exp_f32 v27, v111
    v_mfma_f32_16x16x32_bf16 a[52:55], a[244:247], v[132:135], a[52:55]
    ds_read_b128 a[208:211], v6 offset:12288
    v_cvt_pk_bf16_f32 v151, v26, v27
    v_mfma_f32_16x16x32_bf16 a[20:23], a[244:247], v[128:131], a[20:23]
    s_add_u32 m0, s59, 16384
    ds_read_b128 a[212:215], v6 offset:13312
    v_mfma_f32_16x16x32_bf16 v[32:35], v[44:47], v[148:151], 0
    s_nop 2
    v_mfma_f32_16x16x32_bf16 a[24:27], a[248:251], v[128:131], a[24:27]
    buffer_load_dwordx4 v7, s[28:31], s57 offen offset:0 sc1 lds
    v_mfma_f32_16x16x32_bf16 a[56:59], a[248:251], v[132:135], a[56:59]
    ds_read_b128 a[216:219], v6 offset:14336
    s_nop 0
    v_mfma_f32_16x16x32_bf16 a[60:63], a[252:255], v[132:135], a[60:63]
    ds_read_b128 a[220:223], v6 offset:15360
    v_max_f32 v8, v28, v32
    v_cmp_nge_f32 vcc, s66, v8
    v_mfma_f32_16x16x32_bf16 a[28:31], a[252:255], v[128:131], a[28:31]
    s_waitcnt lgkmcnt(4)
    s_cbranch_vccnz m_stub121
m_ret122:
    v_mfma_f32_16x16x32_bf16 v[96:99], a[192:195], a[128:131], v[160:163]
    s_add_u32 s59, s58, s60
    v_exp_f32 v20, v64
    v_mfma_f32_16x16x32_bf16 v[96:99], a[196:199], a[132:135], v[96:99]
    s_add_u32 s58, s58, 32768
    ds_read_b128 a[224:227], v6 offset:24576
    v_add_f32 v12, v12, v28
    v_mfma_f32_16x16x32_bf16 v[96:99], a[200:203], a[136:139], v[96:99]
    s_cmp_ge_u32 s58, 163840
    s_cselect_b32 s58, 0, s58
    ds_read_b128 a[228:231], v6 offset:25600
    v_exp_f32 v21, v65
    v_mfma_f32_16x16x32_bf16 v[96:99], a[204:207], a[140:143], v[96:99]
    s_bitcmp1_b64 s[62:63], s64
    s_cselect_b32 s66, -1.0, s65
    ds_read_b128 a[232:235], v6 offset:26624
    v_mfma_f32_16x16x32_bf16 v[104:107], a[204:207], a[156:159], v[168:171]
    buffer_load_dwordx4 v7, s[28:31], s57 offen offset:1024 sc1 lds
    v_mfma_f32_16x16x32_bf16 v[104:107], a[200:203], a[152:155], v[104:107]
    s_add_u32 s64, s64, 1
    ds_read_b128 a[236:239], v6 offset:27648
    v_cvt_pk_bf16_f32 v128, v20, v21
    v_mfma_f32_16x16x32_bf16 v[104:107], a[196:199], a[148:151], v[104:107]
    ds_read_b128 a[240:243], v6 offset:28672
    v_exp_f32 v22, v66
    v_mfma_f32_16x16x32_bf16 v[104:107], a[192:195], a[144:147], v[104:107]
    s_waitcnt lgkmcnt(5)
    ds_read_b128 a[244:247], v6 offset:29696
    v_add_f32 v13, v13, v32
    v_mfma_f32_16x16x32_bf16 v[108:111], a[208:211], a[144:147], v[172:175]
    ds_read_b128 a[248:251], v6 offset:30720
    v_exp_f32 v23, v67
    v_mfma_f32_16x16x32_bf16 v[108:111], a[212:215], a[148:151], v[108:111]
    buffer_load_dwordx4 v7, s[28:31], s57 offen offset:2048 sc1 lds
    v_mfma_f32_16x16x32_bf16 v[108:111], a[216:219], a[152:155], v[108:111]
    ds_read_b128 a[252:255], v6 offset:31744
    v_cvt_pk_bf16_f32 v129, v22, v23
    v_mfma_f32_16x16x32_bf16 v[108:111], a[220:223], a[156:159], v[108:111]
    v_exp_f32 v24, v68
    v_mfma_f32_16x16x32_bf16 v[100:103], a[220:223], a[140:143], v[164:167]
    v_exp_f32 v25, v69
    v_mfma_f32_16x16x32_bf16 v[100:103], a[216:219], a[136:139], v[100:103]
    buffer_load_dwordx4 v7, s[28:31], s57 offen offset:3072 sc1 lds
    v_mfma_f32_16x16x32_bf16 v[100:103], a[212:215], a[132:135], v[100:103]
    s_add_u32 s57, s57, 16384
    v_exp_f32 v26, v70
    v_cvt_pk_bf16_f32 v130, v24, v25
    v_mfma_f32_16x16x32_bf16 v[100:103], a[208:211], a[128:131], v[100:103]
    s_waitcnt vmcnt(24) lgkmcnt(0)
    v_add_u32 v6, s58, v2
    v_exp_f32 v27, v71
    v_mfma_f32_16x16x32_bf16 a[0:3], a[224:227], v[144:147], a[0:3]
    s_barrier
    v_mfma_f32_16x16x32_bf16 a[32:35], a[224:227], v[148:151], a[32:35]
    ds_read_b128 a[192:195], v6 offset:0
    v_cvt_pk_bf16_f32 v131, v26, v27
    v_mfma_f32_16x16x32_bf16 a[36:39], a[228:231], v[148:151], a[36:39]
    v_exp_f32 v20, v72
    v_mfma_f32_16x16x32_bf16 v[28:31], v[44:47], v[128:131], 0
    v_exp_f32 v21, v73
    v_mfma_f32_16x16x32_bf16 a[4:7], a[228:231], v[144:147], a[4:7]
    ds_read_b128 a[196:199], v6 offset:1024
    v_cvt_pk_bf16_f32 v132, v20, v21
    v_mfma_f32_16x16x32_bf16 a[8:11], a[232:235], v[144:147], a[8:11]
    v_exp_f32 v22, v74
    v_mfma_f32_16x16x32_bf16 a[40:43], a[232:235], v[148:151], a[40:43]
    ds_read_b128 a[200:203], v6 offset:2048
    v_exp_f32 v23, v75
    v_mfma_f32_16x16x32_bf16 a[44:47], a[236:239], v[148:151], a[44:47]
    v_exp_f32 v24, v76
    v_mfma_f32_16x16x32_bf16 a[12:15], a[236:239], v[144:147], a[12:15]
    ds_read_b128 a[204:207], v6 offset:3072
    v_cvt_pk_bf16_f32 v133, v22, v23
    v_mfma_f32_16x16x32_bf16 a[16:19], a[240:243], v[144:147], a[16:19]
    v_exp_f32 v25, v77
    v_mfma_f32_16x16x32_bf16 a[48:51], a[240:243], v[148:151], a[48:51]
    v_exp_f32 v26, v78
    v_cvt_pk_bf16_f32 v134, v24, v25
    v_mfma_f32_16x16x32_bf16 a[52:55], a[244:247], v[148:151], a[52:55]
    v_exp_f32 v27, v79
    v_mfma_f32_16x16x32_bf16 a[20:23], a[244:247], v[144:147], a[20:23]
    ds_read_b128 a[208:211], v6 offset:4096
    v_cvt_pk_bf16_f32 v135, v26, v27
    s_nop 1
    v_mfma_f32_16x16x32_bf16 v[32:35], v[44:47], v[132:135], 0
    s_nop 2
    v_mfma_f32_16x16x32_bf16 a[24:27], a[248:251], v[144:147], a[24:27]
    ds_read_b128 a[212:215], v6 offset:5120
    s_nop 0
    v_mfma_f32_16x16x32_bf16 a[56:59], a[248:251], v[148:151], a[56:59]
    ds_read_b128 a[216:219], v6 offset:6144
    v_max_f32 v8, v28, v32
    v_mfma_f32_16x16x32_bf16 a[60:63], a[252:255], v[148:151], a[60:63]
    ds_read_b128 a[220:223], v6 offset:7168
    v_cmp_nge_f32 vcc, s66, v8
    v_mfma_f32_16x16x32_bf16 a[28:31], a[252:255], v[144:147], a[28:31]
    s_waitcnt lgkmcnt(4)
    s_cbranch_vccz m_single119
    v_cmp_lt_f32 vcc, s65, v8
    s_cmp_lg_u32 s64, s70
    s_cbranch_scc1 m_e124
    v_add_f32 v160, v160, v16
    v_mov_b32 v164, v9
    v_add_f32 v172, v172, v16
    v_add_f32 v161, v161, v17
    v_mov_b32 v165, v9
    v_add_f32 v173, v173, v17
    v_add_f32 v162, v162, v18
    v_mov_b32 v166, v9
    v_add_f32 v174, v174, v18
    v_add_f32 v163, v163, v19
    v_mov_b32 v167, v9
    v_add_f32 v175, v175, v19
    s_nop 0
m_e124:
    s_cmp_lg_u32 s64, s71
    s_cbranch_scc1 m_e125
    v_mov_b32 v160, v9
    v_mov_b32 v168, v9
    v_mov_b32 v172, v9
    v_mov_b32 v164, v9
    v_mov_b32 v161, v9
    v_mov_b32 v169, v9
    v_mov_b32 v173, v9
    v_mov_b32 v165, v9
    v_mov_b32 v162, v9
    v_mov_b32 v170, v9
    v_mov_b32 v174, v9
    v_mov_b32 v166, v9
    v_mov_b32 v163, v9
    v_mov_b32 v171, v9
    v_mov_b32 v175, v9
    v_mov_b32 v167, v9
    s_nop 0
m_e125:
    s_cmp_lg_u32 s64, s53
    s_cbranch_scc1 m_e128
    s_cmp_lg_u32 s16, 0
    s_cbranch_scc1 m_np129
    v_mov_b32 v60, s4
    v_mov_b32 v61, s5
    s_add_u32 s90, s101, 117440512
    s_mov_b64 exec, 1
    buffer_store_dwordx2 v[60:61], off, s[8:11], s90 sc1
    s_mov_b64 exec, -1
m_np129:
    s_mov_b32 s101, -1
m_e128:
    s_cmp_gt_u32 s64, 24
    s_cbranch_scc1 m_e126
    s_cmp_lg_u32 s64, 8
    s_cbranch_scc1 m_e130
    s_lshr_b32 s90, s32, 1
    s_lshl_b32 s90, s90, 7
    s_add_u32 s90, s90, 117440600
    v_min_u32 v0, 1, v1
    v_lshlrev_b32 v0, 5, v0
    buffer_load_dwordx2 v[4:5], v0, s[8:11], s90 offen sc1
    s_cmp_eq_u32 s17, -1
    s_cbranch_scc1 m_e126
    s_cmp_lg_u32 s16, 0
    s_cbranch_scc1 m_np131
    v_mov_b32 v60, s4
    v_mov_b32 v61, s5
    s_add_u32 s90, s17, 117440512
    s_mov_b64 exec, 1
    buffer_store_dwordx2 v[60:61], off, s[8:11], s90 sc1
    s_mov_b64 exec, -1
m_np131:
    s_branch m_e126
m_e130:
    s_cmp_lg_u32 s64, 16
    s_cbranch_scc1 m_e132
    s_waitcnt vmcnt(18)
    s_mov_b32 s3, 262144
m_spin133:
    v_cmp_ne_u64 s[76:77], s[4:5], v[4:5]
    s_nop 3
    s_cmp_eq_u64 s[76:77], 0
    s_cbranch_scc1 m_e126
    s_sub_u32 s3, s3, 1
    s_cbranch_scc1 m_e126
    s_sleep 32
    s_lshr_b32 s90, s32, 1
    s_lshl_b32 s90, s90, 7
    s_add_u32 s90, s90, 117440600
    v_min_u32 v0, 1, v1
    v_lshlrev_b32 v0, 5, v0
    buffer_load_dwordx2 v[4:5], v0, s[8:11], s90 offen sc1
    s_waitcnt vmcnt(0)
    s_branch m_spin133
    s_branch m_e126
m_e132:
    s_cmp_lg_u32 s64, 20
    s_cbranch_scc1 m_e134
    buffer_load_dwordx2 v[4:5], v10, s[8:11], 0 offen sc1
    s_mov_b32 s44, s48
    s_mov_b32 s45, s49
    s_mov_b32 s46, 8388608
    s_lshl_b32 s90, s2, 2
    s_add_u32 s90, s90, s16
    s_lshl_b32 s90, s90, 13
    v_lshlrev_b32 v62, 7, v1
    buffer_load_dword v255, v62, s[44:47], s90 offen
    s_branch m_e126
m_e134:
    s_cmp_lg_u32 s64, 24
    s_cbranch_scc1 m_e135
    s_mov_b32 s44, s50
    s_mov_b32 s45, s51
    s_mov_b32 s46, 2097152
    s_lshl_b32 s90, s2, 2
    s_add_u32 s90, s90, s16
    s_lshl_b32 s90, s90, 13
    v_lshlrev_b32 v62, 7, v1
    buffer_load_dword v255, v62, s[44:47], s90 offen
    s_waitcnt vmcnt(18)
    s_mov_b32 s3, 262144
m_spin136:
    v_cmp_ne_u64 s[76:77], s[4:5], v[4:5]
    s_nop 3
    s_cmp_eq_u64 s[76:77], 0
    s_cbranch_scc1 m_e126
    s_sub_u32 s3, s3, 1
    s_cbranch_scc1 m_e126
    s_sleep 32
    buffer_load_dwordx2 v[4:5], v10, s[8:11], 0 offen sc1
    s_waitcnt vmcnt(0)
    s_branch m_spin136
    s_branch m_e126
m_e135:
m_e126:
    s_cbranch_vccnz m_rc137
m_sp123:
    s_cmp_lg_u32 s64, s72
    s_cbranch_scc1 m_single119
m_singlex120:
    s_bfe_u32 s95, s2, 0x10002
    s_and_b32 s90, s2, 7
    s_bitcmp1_b32 0x63, s90
    s_cselect_b32 s96, s33, s34
    s_sub_u32 s96, s96, 1
    s_and_b32 s90, s2, 1
    s_lshl_b32 s90, s90, 2
    s_bfe_u32 s91, s2, 0x20003
    s_add_u32 s97, s90, s91
    v_and_b32 v10, 31, v1
    v_lshlrev_b32 v10, 3, v10
    s_lshl_b32 s52, s96, 8
    s_add_u32 s52, s52, 117448704
    buffer_load_dwordx2 v[4:5], v10, s[8:11], s52 offen sc1
    ds_read_b128 a[224:227], v6 offset:16384
    ds_read_b128 a[228:231], v6 offset:17408
    ds_read_b128 a[232:235], v6 offset:18432
    ds_read_b128 a[236:239], v6 offset:19456
    ds_read_b128 a[240:243], v6 offset:20480
    ds_read_b128 a[244:247], v6 offset:21504
    ds_read_b128 a[248:251], v6 offset:22528
    ds_read_b128 a[252:255], v6 offset:23552
    s_waitcnt lgkmcnt(0)
    v_mfma_f32_16x16x32_bf16 a[0:3], a[224:227], v[128:131], a[0:3]
    buffer_load_dwordx4 v[192:195], v2, s[8:11], s83 offen offset:0 sc1
    v_exp_f32 v20, v96
    v_mfma_f32_16x16x32_bf16 a[32:35], a[224:227], v[132:135], a[32:35]
    v_exp_f32 v21, v97
    v_exp_f32 v22, v98
    v_mfma_f32_16x16x32_bf16 a[36:39], a[228:231], v[132:135], a[36:39]
    buffer_load_dwordx4 v[196:199], v2, s[8:11], s83 offen offset:1024 sc1
    v_cvt_pk_bf16_f32 v144, v20, v21
    v_add_f32 v12, v12, v28
    v_mfma_f32_16x16x32_bf16 a[4:7], a[228:231], v[128:131], a[4:7]
    v_exp_f32 v23, v99
    v_exp_f32 v24, v100
    v_cvt_pk_bf16_f32 v145, v22, v23
    v_mfma_f32_16x16x32_bf16 a[8:11], a[232:235], v[128:131], a[8:11]
    buffer_load_dwordx4 v[200:203], v2, s[8:11], s83 offen offset:2048 sc1
    v_exp_f32 v25, v101
    v_mfma_f32_16x16x32_bf16 a[40:43], a[232:235], v[132:135], a[40:43]
    v_exp_f32 v26, v102
    v_cvt_pk_bf16_f32 v146, v24, v25
    v_add_f32 v13, v13, v32
    v_mfma_f32_16x16x32_bf16 a[44:47], a[236:239], v[132:135], a[44:47]
    buffer_load_dwordx4 v[204:207], v2, s[8:11], s83 offen offset:3072 sc1
    v_exp_f32 v27, v103
    v_mfma_f32_16x16x32_bf16 a[12:15], a[236:239], v[128:131], a[12:15]
    v_exp_f32 v20, v104
    v_cvt_pk_bf16_f32 v147, v26, v27
    v_mfma_f32_16x16x32_bf16 a[16:19], a[240:243], v[128:131], a[16:19]
    buffer_load_dwordx4 v[212:215], v2, s[8:11], s84 offen offset:0 sc1
    v_exp_f32 v21, v105
    v_mfma_f32_16x16x32_bf16 v[28:31], v[44:47], v[144:147], 0
    v_exp_f32 v22, v106
    v_cvt_pk_bf16_f32 v148, v20, v21
    v_exp_f32 v23, v107
    v_mfma_f32_16x16x32_bf16 a[48:51], a[240:243], v[132:135], a[48:51]
    v_exp_f32 v24, v108
    v_cvt_pk_bf16_f32 v149, v22, v23
    v_exp_f32 v25, v109
    v_mfma_f32_16x16x32_bf16 a[52:55], a[244:247], v[132:135], a[52:55]
    buffer_load_dwordx4 v[216:219], v2, s[8:11], s84 offen offset:1024 sc1
    v_exp_f32 v26, v110
    v_mfma_f32_16x16x32_bf16 a[20:23], a[244:247], v[128:131], a[20:23]
    v_cvt_pk_bf16_f32 v150, v24, v25
    v_exp_f32 v27, v111
    s_nop 0
    v_cvt_pk_bf16_f32 v151, v26, v27
    s_nop 1
    v_mfma_f32_16x16x32_bf16 v[32:35], v[44:47], v[148:151], 0
    s_nop 2
    v_mfma_f32_16x16x32_bf16 a[24:27], a[248:251], v[128:131], a[24:27]
    buffer_load_dwordx4 v[220:223], v2, s[8:11], s84 offen offset:2048 sc1
    v_mfma_f32_16x16x32_bf16 a[56:59], a[248:251], v[132:135], a[56:59]
    s_nop 2
    v_mfma_f32_16x16x32_bf16 a[60:63], a[252:255], v[132:135], a[60:63]
    v_max_f32 v8, v28, v32
    v_cmp_nge_f32 vcc, s65, v8
    v_mfma_f32_16x16x32_bf16 a[28:31], a[252:255], v[128:131], a[28:31]
    s_cbranch_vccnz m_stub138
m_ret139:
    s_nop 1
    s_cmp_ge_u32 s16, 2
    s_cbranch_scc1 m_xb140
    s_waitcnt vmcnt(24)
    s_barrier
m_xb140:
    ds_read_b128 a[224:227], v6 offset:24576
    ds_read_b128 a[228:231], v6 offset:25600
    ds_read_b128 a[232:235], v6 offset:26624
    ds_read_b128 a[236:239], v6 offset:27648
    ds_read_b128 a[240:243], v6 offset:28672
    ds_read_b128 a[244:247], v6 offset:29696
    ds_read_b128 a[248:251], v6 offset:30720
    ds_read_b128 a[252:255], v6 offset:31744
    s_waitcnt lgkmcnt(0)
    v_mfma_f32_16x16x32_bf16 a[0:3], a[224:227], v[144:147], a[0:3]
    buffer_load_dwordx4 v[224:227], v2, s[8:11], s84 offen offset:3072 sc1
    v_mfma_f32_16x16x32_bf16 a[32:35], a[224:227], v[148:151], a[32:35]
    v_mfma_f32_16x16x32_bf16 a[36:39], a[228:231], v[148:151], a[36:39]
    buffer_load_dwordx4 v[208:211], v2, s[8:11], s85 offen offset:0 sc1
    v_mfma_f32_16x16x32_bf16 a[4:7], a[228:231], v[144:147], a[4:7]
    v_mfma_f32_16x16x32_bf16 a[8:11], a[232:235], v[144:147], a[8:11]
    buffer_load_dwordx4 v[232:235], v2, s[8:11], s86 offen offset:0 sc1
    v_mfma_f32_16x16x32_bf16 a[40:43], a[232:235], v[148:151], a[40:43]
    v_mfma_f32_16x16x32_bf16 a[44:47], a[236:239], v[148:151], a[44:47]
    buffer_load_dwordx4 v[236:239], v2, s[8:11], s86 offen offset:1024 sc1
    v_mfma_f32_16x16x32_bf16 a[12:15], a[236:239], v[144:147], a[12:15]
    v_mfma_f32_16x16x32_bf16 a[16:19], a[240:243], v[144:147], a[16:19]
    buffer_load_dwordx4 v[228:231], v2, s[8:11], s87 offen offset:0 sc1
    v_mfma_f32_16x16x32_bf16 a[48:51], a[240:243], v[148:151], a[48:51]
    v_mfma_f32_16x16x32_bf16 a[52:55], a[244:247], v[148:151], a[52:55]
    buffer_load_dwordx4 v[244:247], v2, s[8:11], s88 offen offset:0 sc1
    v_mfma_f32_16x16x32_bf16 a[20:23], a[244:247], v[144:147], a[20:23]
    v_mfma_f32_16x16x32_bf16 a[24:27], a[248:251], v[144:147], a[24:27]
    buffer_load_dwordx4 v[248:251], v2, s[8:11], s88 offen offset:1024 sc1
    v_mfma_f32_16x16x32_bf16 a[56:59], a[248:251], v[148:151], a[56:59]
    v_mfma_f32_16x16x32_bf16 a[60:63], a[252:255], v[148:151], a[60:63]
    buffer_load_dwordx4 v[240:243], v2, s[8:11], s89 offen offset:0 sc1
    v_mfma_f32_16x16x32_bf16 a[28:31], a[252:255], v[144:147], a[28:31]
    v_add_f32 v20, v12, v28
    v_add_f32 v21, v13, v32
    s_nop 3
    v_rcp_f32 v22, v21
    v_rcp_f32 v20, v20
    s_lshl_b32 s90, s78, 10
    s_add_u32 s90, s90, s82
    s_add_u32 s90, s90, 67108864
    v_accvgpr_read_b32 v48, a0
    v_accvgpr_read_b32 v49, a1
    v_accvgpr_read_b32 v50, a2
    v_accvgpr_read_b32 v51, a3
    v_accvgpr_read_b32 v52, a4
    v_accvgpr_read_b32 v53, a5
    v_accvgpr_read_b32 v54, a6
    v_accvgpr_read_b32 v55, a7
    v_pk_mul_f32 v[48:49], v[48:49], v[20:21] op_sel_hi:[1,0]
    v_pk_mul_f32 v[50:51], v[50:51], v[20:21] op_sel_hi:[1,0]
    v_pk_mul_f32 v[52:53], v[52:53], v[20:21] op_sel_hi:[1,0]
    v_pk_mul_f32 v[54:55], v[54:55], v[20:21] op_sel_hi:[1,0]
    v_cvt_pk_bf16_f32 v48, v48, v49
    v_cvt_pk_bf16_f32 v49, v50, v51
    v_cvt_pk_bf16_f32 v50, v52, v53
    v_cvt_pk_bf16_f32 v51, v54, v55
    buffer_store_dwordx4 v[48:51], v2, s[8:11], s90 offen offset:0 sc1
    v_accvgpr_read_b32 v56, a32
    v_accvgpr_read_b32 v57, a33
    v_accvgpr_read_b32 v58, a34
    v_accvgpr_read_b32 v59, a35
    v_accvgpr_read_b32 v60, a36
    v_accvgpr_read_b32 v61, a37
    v_accvgpr_read_b32 v62, a38
    v_accvgpr_read_b32 v63, a39
    v_pk_mul_f32 v[56:57], v[56:57], v[22:23] op_sel_hi:[1,0]
    v_pk_mul_f32 v[58:59], v[58:59], v[22:23] op_sel_hi:[1,0]
    v_pk_mul_f32 v[60:61], v[60:61], v[22:23] op_sel_hi:[1,0]
    v_pk_mul_f32 v[62:63], v[62:63], v[22:23] op_sel_hi:[1,0]
    v_cvt_pk_bf16_f32 v56, v56, v57
    v_cvt_pk_bf16_f32 v57, v58, v59
    v_cvt_pk_bf16_f32 v58, v60, v61
    v_cvt_pk_bf16_f32 v59, v62, v63
    buffer_store_dwordx4 v[56:59], v2, s[8:11], s90 offen offset:1024 sc1
    s_add_u32 s90, s90, 131072
    v_accvgpr_read_b32 v48, a8
    v_accvgpr_read_b32 v49, a9
    v_accvgpr_read_b32 v50, a10
    v_accvgpr_read_b32 v51, a11
    v_accvgpr_read_b32 v52, a12
    v_accvgpr_read_b32 v53, a13
    v_accvgpr_read_b32 v54, a14
    v_accvgpr_read_b32 v55, a15
    v_pk_mul_f32 v[48:49], v[48:49], v[20:21] op_sel_hi:[1,0]
    v_pk_mul_f32 v[50:51], v[50:51], v[20:21] op_sel_hi:[1,0]
    v_pk_mul_f32 v[52:53], v[52:53], v[20:21] op_sel_hi:[1,0]
    v_pk_mul_f32 v[54:55], v[54:55], v[20:21] op_sel_hi:[1,0]
    v_cvt_pk_bf16_f32 v48, v48, v49
    v_cvt_pk_bf16_f32 v49, v50, v51
    v_cvt_pk_bf16_f32 v50, v52, v53
    v_cvt_pk_bf16_f32 v51, v54, v55
    buffer_store_dwordx4 v[48:51], v2, s[8:11], s90 offen offset:0 sc1
    v_accvgpr_read_b32 v56, a40
    v_accvgpr_read_b32 v57, a41
    v_accvgpr_read_b32 v58, a42
    v_accvgpr_read_b32 v59, a43
    v_accvgpr_read_b32 v60, a44
    v_accvgpr_read_b32 v61, a45
    v_accvgpr_read_b32 v62, a46
    v_accvgpr_read_b32 v63, a47
    v_pk_mul_f32 v[56:57], v[56:57], v[22:23] op_sel_hi:[1,0]
    v_pk_mul_f32 v[58:59], v[58:59], v[22:23] op_sel_hi:[1,0]
    v_pk_mul_f32 v[60:61], v[60:61], v[22:23] op_sel_hi:[1,0]
    v_pk_mul_f32 v[62:63], v[62:63], v[22:23] op_sel_hi:[1,0]
    v_cvt_pk_bf16_f32 v56, v56, v57
    v_cvt_pk_bf16_f32 v57, v58, v59
    v_cvt_pk_bf16_f32 v58, v60, v61
    v_cvt_pk_bf16_f32 v59, v62, v63
    buffer_store_dwordx4 v[56:59], v2, s[8:11], s90 offen offset:1024 sc1
    s_add_u32 s90, s90, 131072
    v_accvgpr_read_b32 v48, a16
    v_accvgpr_read_b32 v49, a17
    v_accvgpr_read_b32 v50, a18
    v_accvgpr_read_b32 v51, a19
    v_accvgpr_read_b32 v52, a20
    v_accvgpr_read_b32 v53, a21
    v_accvgpr_read_b32 v54, a22
    v_accvgpr_read_b32 v55, a23
    v_pk_mul_f32 v[48:49], v[48:49], v[20:21] op_sel_hi:[1,0]
    v_pk_mul_f32 v[50:51], v[50:51], v[20:21] op_sel_hi:[1,0]
    v_pk_mul_f32 v[52:53], v[52:53], v[20:21] op_sel_hi:[1,0]
    v_pk_mul_f32 v[54:55], v[54:55], v[20:21] op_sel_hi:[1,0]
    v_cvt_pk_bf16_f32 v48, v48, v49
    v_cvt_pk_bf16_f32 v49, v50, v51
    v_cvt_pk_bf16_f32 v50, v52, v53
    v_cvt_pk_bf16_f32 v51, v54, v55
    buffer_store_dwordx4 v[48:51], v2, s[8:11], s90 offen offset:0 sc1
    v_accvgpr_read_b32 v56, a48
    v_accvgpr_read_b32 v57, a49
    v_accvgpr_read_b32 v58, a50
    v_accvgpr_read_b32 v59, a51
    v_accvgpr_read_b32 v60, a52
    v_accvgpr_read_b32 v61, a53
    v_accvgpr_read_b32 v62, a54
    v_accvgpr_read_b32 v63, a55
    v_pk_mul_f32 v[56:57], v[56:57], v[22:23] op_sel_hi:[1,0]
    v_pk_mul_f32 v[58:59], v[58:59], v[22:23] op_sel_hi:[1,0]
    v_pk_mul_f32 v[60:61], v[60:61], v[22:23] op_sel_hi:[1,0]
    v_pk_mul_f32 v[62:63], v[62:63], v[22:23] op_sel_hi:[1,0]
    v_cvt_pk_bf16_f32 v56, v56, v57
    v_cvt_pk_bf16_f32 v57, v58, v59
    v_cvt_pk_bf16_f32 v58, v60, v61
    v_cvt_pk_bf16_f32 v59, v62, v63
    buffer_store_dwordx4 v[56:59], v2, s[8:11], s90 offen offset:1024 sc1
    s_add_u32 s90, s90, 131072
    v_accvgpr_read_b32 v48, a24
    v_accvgpr_read_b32 v49, a25
    v_accvgpr_read_b32 v50, a26
    v_accvgpr_read_b32 v51, a27
    v_accvgpr_read_b32 v52, a28
    v_accvgpr_read_b32 v53, a29
    v_accvgpr_read_b32 v54, a30
    v_accvgpr_read_b32 v55, a31
    v_pk_mul_f32 v[48:49], v[48:49], v[20:21] op_sel_hi:[1,0]
    v_pk_mul_f32 v[50:51], v[50:51], v[20:21] op_sel_hi:[1,0]
    v_pk_mul_f32 v[52:53], v[52:53], v[20:21] op_sel_hi:[1,0]
    v_pk_mul_f32 v[54:55], v[54:55], v[20:21] op_sel_hi:[1,0]
    v_cvt_pk_bf16_f32 v48, v48, v49
    v_cvt_pk_bf16_f32 v49, v50, v51
    v_cvt_pk_bf16_f32 v50, v52, v53
    v_cvt_pk_bf16_f32 v51, v54, v55
    buffer_store_dwordx4 v[48:51], v2, s[8:11], s90 offen offset:0 sc1
    v_accvgpr_read_b32 v56, a56
    v_accvgpr_read_b32 v57, a57
    v_accvgpr_read_b32 v58, a58
    v_accvgpr_read_b32 v59, a59
    v_accvgpr_read_b32 v60, a60
    v_accvgpr_read_b32 v61, a61
    v_accvgpr_read_b32 v62, a62
    v_accvgpr_read_b32 v63, a63
    v_pk_mul_f32 v[56:57], v[56:57], v[22:23] op_sel_hi:[1,0]
    v_pk_mul_f32 v[58:59], v[58:59], v[22:23] op_sel_hi:[1,0]
    v_pk_mul_f32 v[60:61], v[60:61], v[22:23] op_sel_hi:[1,0]
    v_pk_mul_f32 v[62:63], v[62:63], v[22:23] op_sel_hi:[1,0]
    v_cvt_pk_bf16_f32 v56, v56, v57
    v_cvt_pk_bf16_f32 v57, v58, v59
    v_cvt_pk_bf16_f32 v58, v60, v61
    v_cvt_pk_bf16_f32 v59, v62, v63
    buffer_store_dwordx4 v[56:59], v2, s[8:11], s90 offen offset:1024 sc1
    s_add_u32 s90, s90, 131072
    s_lshr_b32 s53, s16, 1
    s_and_b32 s40, s16, 1
    s_mul_i32 s90, s95, 5242880
    s_lshl_b32 s57, s97, 8
    s_add_u32 s57, s57, s90
    v_lshrrev_b32 v20, 4, v1
    s_lshl_b32 s90, s16, 4
    v_add_u32 v21, s90, v20
    v_lshlrev_b32 v21, 11, v21
    v_lshlrev_b32 v20, 1, v20
    v_and_b32 v22, 15, v1
    v_xor_b32 v20, v20, v22
    v_xor_b32 v22, 0, v20
    v_lshl_add_u32 v16, v22, 4, v21
    v_xor_b32 v22, 8, v20
    v_lshl_add_u32 v17, v22, 4, v21
    v_add_u32 v17, 7168, v17
    v_xor_b32 v22, 0, v20
    v_lshl_add_u32 v18, v22, 4, v21
    v_add_u32 v18, 14336, v18
    v_xor_b32 v22, 8, v20
    v_lshl_add_u32 v19, v22, 4, v21
    v_add_u32 v19, 21504, v19
    s_mov_b32 s24, s48
    s_mov_b32 s25, s49
    s_mov_b32 s26, 8388608
    s_mov_b32 s38, 268435456
    s_mov_b32 s28, s54
    s_mov_b32 s29, s55
    s_mov_b32 s30, 8388608
    s_lshl_b32 s90, s96, 13
    s_lshl_b32 s91, s40, 12
    s_add_u32 s90, s90, s91
    s_lshl_b32 s91, s53, 17
    s_add_u32 s69, s90, s91
    s_mul_i32 s90, s95, 10485760
    s_add_u32 s56, s69, s90
    s_add_u32 s56, s56, 67108864
    s_add_u32 s69, s69, 83886080
    s_lshl_b32 s90, s53, 12
    v_add_u32 v6, s90, v2
    v_lshrrev_b32 v48, 2, v1
    v_lshlrev_b32 v48, 8, v48
    v_and_b32 v49, 3, v1
    v_lshl_add_u32 v48, v49, 3, v48
    v_add_u32 v48, 16384, v48
    v_bfe_u32 v49, v1, 2, 3
    s_lshl_b32 s90, s40, 2
    v_xor_b32 v49, s90, v49
    v_xor_b32 v50, 0, v49
    v_lshl_add_u32 v12, v50, 5, v48
    v_xor_b32 v50, 1, v49
    v_lshl_add_u32 v13, v50, 5, v48
    v_xor_b32 v50, 2, v49
    v_lshl_add_u32 v14, v50, 5, v48
    v_xor_b32 v50, 3, v49
    v_lshl_add_u32 v15, v50, 5, v48
    v_and_b32 v48, 15, v1
    v_lshlrev_b32 v48, 12, v48
    v_lshlrev_b32 v48, s95, v48
    v_bfe_u32 v49, v1, 4, 1
    v_lshl_add_u32 v48, v49, 5, v48
    v_lshrrev_b32 v49, 5, v1
    v_lshl_add_u32 v7, v49, 4, v48
    s_lshl_b32 s90, s96, 3
    s_lshl_b32 s91, s53, 2
    s_add_u32 s90, s90, s91
    s_lshl_b32 s91, s90, 16
    s_add_u32 s91, s91, 2048
    s_and_b32 s92, s90, 63
    s_lshl_b32 s92, s92, 17
    s_lshr_b32 s93, s90, 6
    s_lshl_b32 s93, s93, 12
    s_add_u32 s92, s92, s93
    s_cmp_eq_u32 s95, 1
    s_cselect_b32 s71, s92, s91
    s_lshl_b32 s72, 0x10000, s95
    s_lshl_b32 s92, s97, 8
    s_lshl_b32 s93, s40, 7
    s_add_u32 s71, s71, s92
    s_add_u32 s71, s71, s93
    v_mov_b64 v[64:65], 0
    v_mov_b64 v[66:67], 0
    v_mov_b64 v[68:69], 0
    v_mov_b64 v[70:71], 0
    v_mov_b64 v[72:73], 0
    v_mov_b64 v[74:75], 0
    v_mov_b64 v[76:77], 0
    v_mov_b64 v[78:79], 0
    v_mov_b64 v[80:81], 0
    v_mov_b64 v[82:83], 0
    v_mov_b64 v[84:85], 0
    v_mov_b64 v[86:87], 0
    v_mov_b64 v[88:89], 0
    v_mov_b64 v[90:91], 0
    v_mov_b64 v[92:93], 0
    v_mov_b64 v[94:95], 0
    v_mov_b64 v[96:97], 0
    v_mov_b64 v[98:99], 0
    v_mov_b64 v[100:101], 0
    v_mov_b64 v[102:103], 0
    v_mov_b64 v[104:105], 0
    v_mov_b64 v[106:107], 0
    v_mov_b64 v[108:109], 0
    v_mov_b64 v[110:111], 0
    v_mov_b64 v[112:113], 0
    v_mov_b64 v[114:115], 0
    v_mov_b64 v[116:117], 0
    v_mov_b64 v[118:119], 0
    v_mov_b64 v[120:121], 0
    v_mov_b64 v[122:123], 0
    v_mov_b64 v[124:125], 0
    v_mov_b64 v[126:127], 0
    v_and_b32 v48, 15, v1
    v_lshrrev_b32 v49, 4, v1
    v_lshlrev_b32 v49, 2, v49
    v_sub_u32 v48, v48, v49
    v_cmp_ge_i32 vcc, -9, v48
    v_subrev_u32 v50, 0, v48
    v_cmp_ge_u32 s[76:77], 7, v50
    s_nop 0
    v_cndmask_b32 v128, v9, 0, vcc
    v_cndmask_b32 v132, v9, 0, s[76:77]
    v_cmp_ge_i32 vcc, -8, v48
    v_subrev_u32 v50, 1, v48
    v_cmp_ge_u32 s[76:77], 7, v50
    s_nop 0
    v_cndmask_b32 v129, v9, 0, vcc
    v_cndmask_b32 v133, v9, 0, s[76:77]
    v_cmp_ge_i32 vcc, -7, v48
    v_subrev_u32 v50, 2, v48
    v_cmp_ge_u32 s[76:77], 7, v50
    s_nop 0
    v_cndmask_b32 v130, v9, 0, vcc
    v_cndmask_b32 v134, v9, 0, s[76:77]
    v_cmp_ge_i32 vcc, -6, v48
    v_subrev_u32 v50, 3, v48
    v_cmp_ge_u32 s[76:77], 7, v50
    s_nop 0
    v_cndmask_b32 v131, v9, 0, vcc
    v_cndmask_b32 v135, v9, 0, s[76:77]
    s_cmp_eq_u32 s81, 0
    s_cselect_b64 vcc, -1, 0
    s_nop 0
    v_cndmask_b32 v136, v128, v9, vcc
    v_cndmask_b32 v137, v129, v9, vcc
    v_cndmask_b32 v138, v130, v9, vcc
    v_cndmask_b32 v139, v131, v9, vcc
    s_lshl_b32 s90, s80, 10
    s_lshr_b32 s91, s2, 3
    s_lshl_b32 s91, s91, 17
    s_add_u32 s90, s90, s91
    s_add_u32 s80, s90, 83886080
    s_add_u32 s59, s60, 131072
    s_mov_b32 s58, 0
    s_mov_b32 s100, 32768
    s_mov_b32 s64, 0
    s_mov_b32 s67, 0
    s_waitcnt vmcnt(0)
    s_barrier
    s_lshl_b32 s91, s33, 5
    s_add_u32 s91, s91, s32
    s_lshl_b32 s91, s91, 3
    s_add_u32 s91, s91, 7936
    s_cmp_lg_u32 s16, 0
    s_cbranch_scc1 m_np141
    v_mov_b32 v60, s4
    v_mov_b32 v61, s5
    s_add_u32 s90, s91, 117440512
    s_mov_b64 exec, 1
    buffer_store_dwordx2 v[60:61], off, s[8:11], s90 sc1
    s_mov_b64 exec, -1
m_np141:
    s_cmp_eq_u32 s101, -1
    s_cbranch_scc1 m_pb142
    s_cmp_lg_u32 s16, 0
    s_cbranch_scc1 m_np144
    v_mov_b32 v60, s4
    v_mov_b32 v61, s5
    s_add_u32 s90, s101, 117440512
    s_mov_b64 exec, 1
    buffer_store_dwordx2 v[60:61], off, s[8:11], s90 sc1
    s_mov_b64 exec, -1
m_np144:
m_pb142:
    v_cmp_ne_u64 s[76:77], s[4:5], v[4:5]
    s_mul_i32 s91, s95, 20
    s_nop 2
    s_lshr_b32 s90, s76, s91
    s_ff1_i32_b32 s90, s90
    s_lshl_b32 s68, s90, 1
    s_mul_i32 s91, s95, 0
    s_sub_i32 s68, s68, s91
    s_cmp_lt_i32 s90, 0
    s_cselect_b32 s68, 1000, s68
    s_add_u32 m0, s60, 16384
    s_nop 0
    buffer_load_dwordx4 v16, s[24:27], s57 offen offset:0 sc1 lds
    buffer_load_dwordx4 v17, s[24:27], s57 offen offset:1024 sc1 lds
    buffer_load_dwordx4 v18, s[24:27], s57 offen offset:2048 sc1 lds
    buffer_load_dwordx4 v19, s[24:27], s57 offen offset:3072 sc1 lds
    s_add_u32 s57, s57, 131072
    s_add_u32 m0, s60, 49152
    s_nop 0
    buffer_load_dwordx4 v16, s[24:27], s57 offen offset:0 sc1 lds
    buffer_load_dwordx4 v17, s[24:27], s57 offen offset:1024 sc1 lds
    buffer_load_dwordx4 v18, s[24:27], s57 offen offset:2048 sc1 lds
    buffer_load_dwordx4 v19, s[24:27], s57 offen offset:3072 sc1 lds
    s_add_u32 s57, s57, 131072
    s_add_u32 m0, s60, 81920
    s_nop 0
    buffer_load_dwordx4 v16, s[24:27], s57 offen offset:0 sc1 lds
    buffer_load_dwordx4 v17, s[24:27], s57 offen offset:1024 sc1 lds
    buffer_load_dwordx4 v18, s[24:27], s57 offen offset:2048 sc1 lds
    buffer_load_dwordx4 v19, s[24:27], s57 offen offset:3072 sc1 lds
    s_add_u32 s57, s57, 131072
    s_add_u32 m0, s60, 114688
    s_nop 0
    buffer_load_dwordx4 v16, s[24:27], s57 offen offset:0 sc1 lds
    buffer_load_dwordx4 v17, s[24:27], s57 offen offset:1024 sc1 lds
    buffer_load_dwordx4 v18, s[24:27], s57 offen offset:2048 sc1 lds
    buffer_load_dwordx4 v19, s[24:27], s57 offen offset:3072 sc1 lds
    s_add_u32 s57, s57, 131072
    s_cmp_gt_i32 s68, 4
    s_cbranch_scc1 m_x3143
    s_mov_b32 s3, 262144
m_spin145:
    buffer_load_dwordx2 v[4:5], v10, s[8:11], s52 offen sc1
    s_waitcnt vmcnt(0)
    v_cmp_ne_u64 s[76:77], s[4:5], v[4:5]
    s_mul_i32 s91, s95, 20
    s_nop 2
    s_lshr_b32 s90, s76, s91
    s_ff1_i32_b32 s90, s90
    s_lshl_b32 s68, s90, 1
    s_mul_i32 s91, s95, 0
    s_sub_i32 s68, s68, s91
    s_cmp_lt_i32 s90, 0
    s_cselect_b32 s68, 1000, s68
    s_cmp_gt_i32 s68, 4
    s_cbranch_scc1 m_ok146
    s_sub_u32 s3, s3, 1
    s_cbranch_scc1 m_ok146
    s_sleep 4
    s_branch m_spin145
m_ok146:
m_x3143:
    s_add_u32 m0, s60, 0
    s_nop 0
    buffer_load_dwordx4 v2, s[36:39], s56 offen offset:0 sc1 lds
    buffer_load_dwordx4 v2, s[36:39], s56 offen offset:1024 sc1 lds
    buffer_load_dwordx4 v2, s[36:39], s56 offen offset:2048 sc1 lds
    buffer_load_dwordx4 v2, s[36:39], s56 offen offset:3072 sc1 lds
    s_add_u32 s56, s56, 262144
    s_add_u32 m0, s60, 32768
    s_nop 0
    buffer_load_dwordx4 v2, s[36:39], s56 offen offset:0 sc1 lds
    buffer_load_dwordx4 v2, s[36:39], s56 offen offset:1024 sc1 lds
    buffer_load_dwordx4 v2, s[36:39], s56 offen offset:2048 sc1 lds
    buffer_load_dwordx4 v2, s[36:39], s56 offen offset:3072 sc1 lds
    s_add_u32 s56, s56, 262144
    s_add_u32 m0, s60, 65536
    s_nop 0
    buffer_load_dwordx4 v2, s[36:39], s56 offen offset:0 sc1 lds
    buffer_load_dwordx4 v2, s[36:39], s56 offen offset:1024 sc1 lds
    buffer_load_dwordx4 v2, s[36:39], s56 offen offset:2048 sc1 lds
    buffer_load_dwordx4 v2, s[36:39], s56 offen offset:3072 sc1 lds
    s_add_u32 s56, s56, 262144
    s_add_u32 m0, s60, 98304
    s_nop 0
    buffer_load_dwordx4 v2, s[36:39], s56 offen offset:0 sc1 lds
    buffer_load_dwordx4 v2, s[36:39], s56 offen offset:1024 sc1 lds
    buffer_load_dwordx4 v2, s[36:39], s56 offen offset:2048 sc1 lds
    buffer_load_dwordx4 v2, s[36:39], s56 offen offset:3072 sc1 lds
    s_add_u32 s56, s56, 262144
    s_add_u32 m0, s60, 131072
    s_nop 0
    buffer_load_dwordx4 v2, s[36:39], s56 offen offset:0 sc1 lds
    buffer_load_dwordx4 v2, s[36:39], s56 offen offset:1024 sc1 lds
    buffer_load_dwordx4 v2, s[36:39], s56 offen offset:2048 sc1 lds
    buffer_load_dwordx4 v2, s[36:39], s56 offen offset:3072 sc1 lds
    s_add_u32 s56, s56, 262144
    s_waitcnt vmcnt(16)
    s_barrier
    ds_read_b128 a[0:3], v6 offset:0
    ds_read_b64_tr_b16 a[16:17], v12 offset:0
    ds_read_b64_tr_b16 a[18:19], v12 offset:4096
    ds_read_b128 a[4:7], v6 offset:1024
    ds_read_b128 a[8:11], v6 offset:2048
    ds_read_b128 a[12:15], v6 offset:3072
    ds_read_b64_tr_b16 a[20:21], v13 offset:0
    ds_read_b64_tr_b16 a[22:23], v13 offset:4096
    ds_read_b64_tr_b16 a[24:25], v14 offset:0
    ds_read_b64_tr_b16 a[26:27], v14 offset:4096
    ds_read_b64_tr_b16 a[28:29], v15 offset:0
    ds_read_b64_tr_b16 a[30:31], v15 offset:4096
    s_cmp_gt_i32 s68, 5
    s_cbranch_scc0 m_lp152
m_lr153:
    s_waitcnt lgkmcnt(9)
    v_mfma_f32_16x16x32_bf16 v[64:67], a[16:19], a[0:3], v[64:67]
    s_add_u32 m0, s59, 16384
    ds_read_b128 a[32:35], v6 offset:8192
    v_mfma_f32_16x16x32_bf16 v[148:151], v[208:211], v[192:195], v[136:139]
    v_mfma_f32_16x16x32_bf16 v[152:155], v[212:215], v[192:195], v[132:135]
    s_waitcnt lgkmcnt(9)
    v_mfma_f32_16x16x32_bf16 v[72:75], a[16:19], a[4:7], v[72:75]
    ds_read_b64_tr_b16 a[48:49], v12 offset:8192
    buffer_load_dwordx4 v16, s[24:27], s57 offen offset:0 sc1 lds
    v_mfma_f32_16x16x32_bf16 v[156:159], v[212:215], v[196:199], v[128:131]
    s_waitcnt lgkmcnt(9)
    v_mfma_f32_16x16x32_bf16 v[80:83], a[16:19], a[8:11], v[80:83]
    s_add_u32 s59, s58, s60
    ds_read_b64_tr_b16 a[50:51], v12 offset:12288
    v_mfma_f32_16x16x32_bf16 v[160:163], v[216:219], v[196:199], v[132:135]
    v_mfma_f32_16x16x32_bf16 v[164:167], v[216:219], v[200:203], v[128:131]
    s_waitcnt lgkmcnt(9)
    v_mfma_f32_16x16x32_bf16 v[88:91], a[16:19], a[12:15], v[88:91]
    s_add_u32 s58, s58, 32768
    ds_read_b128 a[36:39], v6 offset:9216
    v_mfma_f32_16x16x32_bf16 v[168:171], v[220:223], v[200:203], v[132:135]
    v_mfma_f32_16x16x32_bf16 v[172:175], v[220:223], v[204:207], v[128:131]
    s_waitcnt lgkmcnt(8)
    v_mfma_f32_16x16x32_bf16 v[68:71], a[20:23], a[0:3], v[68:71]
    s_cmp_ge_u32 s58, 163840
    ds_read_b128 a[40:43], v6 offset:10240
    v_mfma_f32_16x16x32_bf16 v[176:179], v[224:227], v[204:207], v[132:135]
    s_nop 1
    v_mfma_f32_16x16x32_bf16 v[76:79], a[20:23], a[4:7], v[76:79]
    ds_read_b128 a[44:47], v6 offset:11264
    buffer_load_dwordx4 v17, s[24:27], s57 offen offset:1024 sc1 lds
    s_nop 1
    v_mfma_f32_16x16x32_bf16 v[84:87], a[20:23], a[8:11], v[84:87]
    s_cselect_b32 s66, 4294836224, s100
    ds_read_b64_tr_b16 a[52:53], v13 offset:8192
    s_nop 1
    s_nop 1
    v_mfma_f32_16x16x32_bf16 v[92:95], a[20:23], a[12:15], v[92:95]
    s_cselect_b32 s58, 0, s58
    ds_read_b64_tr_b16 a[54:55], v13 offset:12288
    v_max3_f32 v140, v148, v149, v150
    v_max3_f32 v141, v156, v157, v158
    s_waitcnt lgkmcnt(10)
    v_mfma_f32_16x16x32_bf16 v[96:99], a[24:27], a[0:3], v[96:99]
    ds_read_b64_tr_b16 a[56:57], v14 offset:8192
    v_max3_f32 v142, v164, v165, v166
    v_max3_f32 v143, v172, v173, v174
    v_mfma_f32_16x16x32_bf16 v[104:107], a[24:27], a[4:7], v[104:107]
    ds_read_b64_tr_b16 a[58:59], v14 offset:12288
    buffer_load_dwordx4 v18, s[24:27], s57 offen offset:2048 sc1 lds
    v_max3_f32 v140, v140, v151, v152
    v_mfma_f32_16x16x32_bf16 v[112:115], a[24:27], a[8:11], v[112:115]
    ds_read_b64_tr_b16 a[60:61], v15 offset:8192
    v_max3_f32 v141, v141, v159, v160
    v_max3_f32 v142, v142, v167, v168
    v_mfma_f32_16x16x32_bf16 v[120:123], a[24:27], a[12:15], v[120:123]
    ds_read_b64_tr_b16 a[62:63], v15 offset:12288
    v_max3_f32 v143, v143, v175, v176
    v_max3_f32 v140, v140, v153, v154
    s_waitcnt lgkmcnt(12)
    v_mfma_f32_16x16x32_bf16 v[100:103], a[28:31], a[0:3], v[100:103]
    v_add_u32 v6, s66, v6
    v_add_u32 v12, s66, v12
    v_max3_f32 v141, v141, v161, v162
    v_mfma_f32_16x16x32_bf16 v[108:111], a[28:31], a[4:7], v[108:111]
    buffer_load_dwordx4 v19, s[24:27], s57 offen offset:3072 sc1 lds
    v_max3_f32 v142, v142, v169, v170
    v_mfma_f32_16x16x32_bf16 v[116:119], a[28:31], a[8:11], v[116:119]
    s_add_u32 s57, s57, 131072
    v_add_u32 v13, s66, v13
    v_add_u32 v14, s66, v14
    v_max3_f32 v143, v143, v177, v178
    v_mfma_f32_16x16x32_bf16 v[124:127], a[28:31], a[12:15], v[124:127]
    s_mov_b32 m0, s59
    v_add_u32 v15, s66, v15
    v_max_f32 v140, v140, v155
    s_waitcnt vmcnt(16) lgkmcnt(0)
    v_mfma_f32_16x16x32_bf16 v[64:67], a[48:51], a[32:35], v[64:67]
    s_barrier
    v_max_f32 v141, v141, v163
    v_max_f32 v142, v142, v171
    v_mfma_f32_16x16x32_bf16 v[72:75], a[48:51], a[36:39], v[72:75]
    ds_read_b128 a[0:3], v6 offset:0
    buffer_load_dwordx4 v2, s[36:39], s56 offen offset:0 sc1 lds
    v_max_f32 v143, v143, v179
    v_mfma_f32_16x16x32_bf16 v[80:83], a[48:51], a[40:43], v[80:83]
    ds_read_b64_tr_b16 a[16:17], v12 offset:0
    v_mov_b32 v144, v140
    v_mov_b32 v145, v141
    v_mfma_f32_16x16x32_bf16 v[88:91], a[48:51], a[44:47], v[88:91]
    ds_read_b64_tr_b16 a[18:19], v12 offset:4096
    v_mov_b32 v146, v142
    v_mov_b32 v147, v143
    v_mfma_f32_16x16x32_bf16 v[68:71], a[52:55], a[32:35], v[68:71]
    ds_read_b128 a[4:7], v6 offset:1024
    s_nop 1
    v_permlane32_swap_b32 v140, v144
    v_mfma_f32_16x16x32_bf16 v[76:79], a[52:55], a[36:39], v[76:79]
    ds_read_b128 a[8:11], v6 offset:2048
    buffer_load_dwordx4 v2, s[36:39], s56 offen offset:1024 sc1 lds
    v_permlane32_swap_b32 v141, v145
    v_mfma_f32_16x16x32_bf16 v[84:87], a[52:55], a[40:43], v[84:87]
    ds_read_b128 a[12:15], v6 offset:3072
    v_permlane32_swap_b32 v142, v146
    v_permlane32_swap_b32 v143, v147
    v_mfma_f32_16x16x32_bf16 v[92:95], a[52:55], a[44:47], v[92:95]
    ds_read_b64_tr_b16 a[20:21], v13 offset:0
    s_nop 1
    v_max_f32 v140, v140, v144
    v_mfma_f32_16x16x32_bf16 v[96:99], a[56:59], a[32:35], v[96:99]
    ds_read_b64_tr_b16 a[22:23], v13 offset:4096
    v_max_f32 v141, v141, v145
    v_max_f32 v142, v142, v146
    v_mfma_f32_16x16x32_bf16 v[104:107], a[56:59], a[36:39], v[104:107]
    ds_read_b64_tr_b16 a[24:25], v14 offset:0
    buffer_load_dwordx4 v2, s[36:39], s56 offen offset:2048 sc1 lds
    v_max_f32 v143, v143, v147
    v_mfma_f32_16x16x32_bf16 v[112:115], a[56:59], a[40:43], v[112:115]
    ds_read_b64_tr_b16 a[26:27], v14 offset:4096
    v_mov_b32 v144, v140
    v_mov_b32 v145, v141
    v_mfma_f32_16x16x32_bf16 v[120:123], a[56:59], a[44:47], v[120:123]
    ds_read_b64_tr_b16 a[28:29], v15 offset:0
    v_mov_b32 v146, v142
    v_mov_b32 v147, v143
    v_mfma_f32_16x16x32_bf16 v[100:103], a[60:63], a[32:35], v[100:103]
    s_add_u32 s64, s64, 1
    ds_read_b64_tr_b16 a[30:31], v15 offset:4096
    s_nop 1
    v_permlane16_swap_b32 v140, v144
    v_mfma_f32_16x16x32_bf16 v[108:111], a[60:63], a[36:39], v[108:111]
    buffer_load_dwordx4 v2, s[36:39], s56 offen offset:3072 sc1 lds
    v_permlane16_swap_b32 v141, v145
    v_mfma_f32_16x16x32_bf16 v[116:119], a[60:63], a[40:43], v[116:119]
    s_add_u32 s56, s56, 262144
    v_permlane16_swap_b32 v142, v146
    v_permlane16_swap_b32 v143, v147
    v_mfma_f32_16x16x32_bf16 v[124:127], a[60:63], a[44:47], v[124:127]
    s_nop 1
    v_max_f32 v140, v140, v144
    s_cmp_gt_i32 s68, 6
    s_cbranch_scc0 m_lp154
m_lr155:
    s_waitcnt lgkmcnt(9)
    v_mfma_f32_16x16x32_bf16 v[64:67], a[16:19], a[0:3], v[64:67]
    s_add_u32 m0, s59, 16384
    ds_read_b128 a[32:35], v6 offset:8192
    v_max_f32 v141, v141, v145
    v_max_f32 v142, v142, v146
    s_waitcnt lgkmcnt(9)
    v_mfma_f32_16x16x32_bf16 v[72:75], a[16:19], a[4:7], v[72:75]
    ds_read_b64_tr_b16 a[48:49], v12 offset:8192
    buffer_load_dwordx4 v16, s[24:27], s57 offen offset:0 sc1 lds
    v_max_f32 v143, v143, v147
    s_waitcnt lgkmcnt(9)
    v_mfma_f32_16x16x32_bf16 v[80:83], a[16:19], a[8:11], v[80:83]
    s_add_u32 s59, s58, s60
    ds_read_b64_tr_b16 a[50:51], v12 offset:12288
    v_sub_f32 v148, v148, v140
    v_sub_f32 v149, v149, v140
    s_waitcnt lgkmcnt(9)
    v_mfma_f32_16x16x32_bf16 v[88:91], a[16:19], a[12:15], v[88:91]
    s_add_u32 s58, s58, 32768
    ds_read_b128 a[36:39], v6 offset:9216
    v_sub_f32 v150, v150, v140
    v_sub_f32 v151, v151, v140
    s_waitcnt lgkmcnt(8)
    v_mfma_f32_16x16x32_bf16 v[68:71], a[20:23], a[0:3], v[68:71]
    s_cmp_ge_u32 s58, 163840
    ds_read_b128 a[40:43], v6 offset:10240
    v_sub_f32 v152, v152, v140
    v_sub_f32 v153, v153, v140
    v_mfma_f32_16x16x32_bf16 v[76:79], a[20:23], a[4:7], v[76:79]
    ds_read_b128 a[44:47], v6 offset:11264
    buffer_load_dwordx4 v17, s[24:27], s57 offen offset:1024 sc1 lds
    v_sub_f32 v154, v154, v140
    v_mfma_f32_16x16x32_bf16 v[84:87], a[20:23], a[8:11], v[84:87]
    s_cselect_b32 s66, 4294836224, s100
    ds_read_b64_tr_b16 a[52:53], v13 offset:8192
    v_sub_f32 v155, v155, v140
    v_sub_f32 v156, v156, v141
    v_mfma_f32_16x16x32_bf16 v[92:95], a[20:23], a[12:15], v[92:95]
    s_cselect_b32 s58, 0, s58
    ds_read_b64_tr_b16 a[54:55], v13 offset:12288
    v_sub_f32 v157, v157, v141
    v_sub_f32 v158, v158, v141
    s_waitcnt lgkmcnt(10)
    v_mfma_f32_16x16x32_bf16 v[96:99], a[24:27], a[0:3], v[96:99]
    ds_read_b64_tr_b16 a[56:57], v14 offset:8192
    v_sub_f32 v159, v159, v141
    v_sub_f32 v160, v160, v141
    v_mfma_f32_16x16x32_bf16 v[104:107], a[24:27], a[4:7], v[104:107]
    ds_read_b64_tr_b16 a[58:59], v14 offset:12288
    buffer_load_dwordx4 v18, s[24:27], s57 offen offset:2048 sc1 lds
    v_sub_f32 v161, v161, v141
    v_mfma_f32_16x16x32_bf16 v[112:115], a[24:27], a[8:11], v[112:115]
    ds_read_b64_tr_b16 a[60:61], v15 offset:8192
    v_sub_f32 v162, v162, v141
    v_sub_f32 v163, v163, v141
    v_mfma_f32_16x16x32_bf16 v[120:123], a[24:27], a[12:15], v[120:123]
    ds_read_b64_tr_b16 a[62:63], v15 offset:12288
    v_sub_f32 v164, v164, v142
    v_sub_f32 v165, v165, v142
    s_waitcnt lgkmcnt(12)
    v_mfma_f32_16x16x32_bf16 v[100:103], a[28:31], a[0:3], v[100:103]
    v_add_u32 v6, s66, v6
    v_add_u32 v12, s66, v12
    v_sub_f32 v166, v166, v142
    v_mfma_f32_16x16x32_bf16 v[108:111], a[28:31], a[4:7], v[108:111]
    buffer_load_dwordx4 v19, s[24:27], s57 offen offset:3072 sc1 lds
    v_sub_f32 v167, v167, v142
    v_mfma_f32_16x16x32_bf16 v[116:119], a[28:31], a[8:11], v[116:119]
    s_add_u32 s57, s57, 131072
    v_add_u32 v13, s66, v13
    v_add_u32 v14, s66, v14
    v_sub_f32 v168, v168, v142
    v_mfma_f32_16x16x32_bf16 v[124:127], a[28:31], a[12:15], v[124:127]
    s_mov_b32 m0, s59
    v_add_u32 v15, s66, v15
    v_sub_f32 v169, v169, v142
    s_waitcnt vmcnt(20) lgkmcnt(0)
    v_mfma_f32_16x16x32_bf16 v[64:67], a[48:51], a[32:35], v[64:67]
    s_barrier
    v_sub_f32 v170, v170, v142
    v_sub_f32 v171, v171, v142
    v_mfma_f32_16x16x32_bf16 v[72:75], a[48:51], a[36:39], v[72:75]
    ds_read_b128 a[0:3], v6 offset:0
    buffer_load_dwordx4 v2, s[36:39], s56 offen offset:0 sc1 lds
    v_sub_f32 v172, v172, v143
    v_mfma_f32_16x16x32_bf16 v[80:83], a[48:51], a[40:43], v[80:83]
    ds_read_b64_tr_b16 a[16:17], v12 offset:0
    v_sub_f32 v173, v173, v143
    v_sub_f32 v174, v174, v143
    v_mfma_f32_16x16x32_bf16 v[88:91], a[48:51], a[44:47], v[88:91]
    ds_read_b64_tr_b16 a[18:19], v12 offset:4096
    v_sub_f32 v175, v175, v143
    v_sub_f32 v176, v176, v143
    v_mfma_f32_16x16x32_bf16 v[68:71], a[52:55], a[32:35], v[68:71]
    ds_read_b128 a[4:7], v6 offset:1024
    v_sub_f32 v177, v177, v143
    v_sub_f32 v178, v178, v143
    v_mfma_f32_16x16x32_bf16 v[76:79], a[52:55], a[36:39], v[76:79]
    ds_read_b128 a[8:11], v6 offset:2048
    buffer_load_dwordx4 v2, s[36:39], s56 offen offset:1024 sc1 lds
    v_sub_f32 v179, v179, v143
    v_mfma_f32_16x16x32_bf16 v[84:87], a[52:55], a[40:43], v[84:87]
    ds_read_b128 a[12:15], v6 offset:3072
    v_exp_f32 v148, v148
    v_exp_f32 v149, v149
    v_mfma_f32_16x16x32_bf16 v[92:95], a[52:55], a[44:47], v[92:95]
    ds_read_b64_tr_b16 a[20:21], v13 offset:0
    v_exp_f32 v150, v150
    v_exp_f32 v151, v151
    v_mfma_f32_16x16x32_bf16 v[96:99], a[56:59], a[32:35], v[96:99]
    ds_read_b64_tr_b16 a[22:23], v13 offset:4096
    v_exp_f32 v152, v152
    v_exp_f32 v153, v153
    v_mfma_f32_16x16x32_bf16 v[104:107], a[56:59], a[36:39], v[104:107]
    ds_read_b64_tr_b16 a[24:25], v14 offset:0
    buffer_load_dwordx4 v2, s[36:39], s56 offen offset:2048 sc1 lds
    v_exp_f32 v154, v154
    v_mfma_f32_16x16x32_bf16 v[112:115], a[56:59], a[40:43], v[112:115]
    ds_read_b64_tr_b16 a[26:27], v14 offset:4096
    v_exp_f32 v155, v155
    v_exp_f32 v156, v156
    v_mfma_f32_16x16x32_bf16 v[120:123], a[56:59], a[44:47], v[120:123]
    ds_read_b64_tr_b16 a[28:29], v15 offset:0
    v_exp_f32 v157, v157
    v_exp_f32 v158, v158
    v_mfma_f32_16x16x32_bf16 v[100:103], a[60:63], a[32:35], v[100:103]
    s_add_u32 s64, s64, 1
    ds_read_b64_tr_b16 a[30:31], v15 offset:4096
    v_exp_f32 v159, v159
    v_exp_f32 v160, v160
    v_mfma_f32_16x16x32_bf16 v[108:111], a[60:63], a[36:39], v[108:111]
    buffer_load_dwordx4 v2, s[36:39], s56 offen offset:3072 sc1 lds
    v_exp_f32 v161, v161
    v_mfma_f32_16x16x32_bf16 v[116:119], a[60:63], a[40:43], v[116:119]
    s_add_u32 s56, s56, 262144
    v_exp_f32 v162, v162
    v_exp_f32 v163, v163
    v_mfma_f32_16x16x32_bf16 v[124:127], a[60:63], a[44:47], v[124:127]
    v_exp_f32 v164, v164
    v_exp_f32 v165, v165
    s_cmp_gt_i32 s68, 7
    s_cbranch_scc0 m_lp156
m_lr157:
    s_waitcnt lgkmcnt(9)
    v_mfma_f32_16x16x32_bf16 v[64:67], a[16:19], a[0:3], v[64:67]
    s_add_u32 m0, s59, 16384
    ds_read_b128 a[32:35], v6 offset:8192
    v_exp_f32 v166, v166
    v_exp_f32 v167, v167
    s_waitcnt lgkmcnt(9)
    v_mfma_f32_16x16x32_bf16 v[72:75], a[16:19], a[4:7], v[72:75]
    ds_read_b64_tr_b16 a[48:49], v12 offset:8192
    buffer_load_dwordx4 v16, s[24:27], s57 offen offset:0 sc1 lds
    v_exp_f32 v168, v168
    s_waitcnt lgkmcnt(9)
    v_mfma_f32_16x16x32_bf16 v[80:83], a[16:19], a[8:11], v[80:83]
    s_add_u32 s59, s58, s60
    ds_read_b64_tr_b16 a[50:51], v12 offset:12288
    v_exp_f32 v169, v169
    v_exp_f32 v170, v170
    s_waitcnt lgkmcnt(9)
    v_mfma_f32_16x16x32_bf16 v[88:91], a[16:19], a[12:15], v[88:91]
    s_add_u32 s58, s58, 32768
    ds_read_b128 a[36:39], v6 offset:9216
    v_exp_f32 v171, v171
    v_exp_f32 v172, v172
    s_waitcnt lgkmcnt(8)
    v_mfma_f32_16x16x32_bf16 v[68:71], a[20:23], a[0:3], v[68:71]
    s_cmp_ge_u32 s58, 163840
    ds_read_b128 a[40:43], v6 offset:10240
    v_exp_f32 v173, v173
    v_exp_f32 v174, v174
    v_mfma_f32_16x16x32_bf16 v[76:79], a[20:23], a[4:7], v[76:79]
    ds_read_b128 a[44:47], v6 offset:11264
    buffer_load_dwordx4 v17, s[24:27], s57 offen offset:1024 sc1 lds
    v_exp_f32 v175, v175
    v_mfma_f32_16x16x32_bf16 v[84:87], a[20:23], a[8:11], v[84:87]
    s_cselect_b32 s66, 4294836224, s100
    ds_read_b64_tr_b16 a[52:53], v13 offset:8192
    v_exp_f32 v176, v176
    v_exp_f32 v177, v177
    v_mfma_f32_16x16x32_bf16 v[92:95], a[20:23], a[12:15], v[92:95]
    s_cselect_b32 s58, 0, s58
    ds_read_b64_tr_b16 a[54:55], v13 offset:12288
    v_exp_f32 v178, v178
    v_exp_f32 v179, v179
    s_waitcnt lgkmcnt(10)
    v_mfma_f32_16x16x32_bf16 v[96:99], a[24:27], a[0:3], v[96:99]
    ds_read_b64_tr_b16 a[56:57], v14 offset:8192
    v_cvt_pk_bf16_f32 v192, v148, v149
    v_cvt_pk_bf16_f32 v193, v150, v151
    v_mfma_f32_16x16x32_bf16 v[104:107], a[24:27], a[4:7], v[104:107]
    ds_read_b64_tr_b16 a[58:59], v14 offset:12288
    buffer_load_dwordx4 v18, s[24:27], s57 offen offset:2048 sc1 lds
    v_cvt_pk_bf16_f32 v194, v152, v153
    v_mfma_f32_16x16x32_bf16 v[112:115], a[24:27], a[8:11], v[112:115]
    ds_read_b64_tr_b16 a[60:61], v15 offset:8192
    v_cvt_pk_bf16_f32 v195, v154, v155
    v_cvt_pk_bf16_f32 v196, v156, v157
    v_mfma_f32_16x16x32_bf16 v[120:123], a[24:27], a[12:15], v[120:123]
    ds_read_b64_tr_b16 a[62:63], v15 offset:12288
    v_cvt_pk_bf16_f32 v197, v158, v159
    v_cvt_pk_bf16_f32 v198, v160, v161
    s_waitcnt lgkmcnt(12)
    v_mfma_f32_16x16x32_bf16 v[100:103], a[28:31], a[0:3], v[100:103]
    v_add_u32 v6, s66, v6
    v_add_u32 v12, s66, v12
    v_cvt_pk_bf16_f32 v199, v162, v163
    v_mfma_f32_16x16x32_bf16 v[108:111], a[28:31], a[4:7], v[108:111]
    buffer_load_dwordx4 v19, s[24:27], s57 offen offset:3072 sc1 lds
    v_cvt_pk_bf16_f32 v200, v164, v165
    v_mfma_f32_16x16x32_bf16 v[116:119], a[28:31], a[8:11], v[116:119]
    s_add_u32 s57, s57, 131072
    v_add_u32 v13, s66, v13
    v_add_u32 v14, s66, v14
    v_cvt_pk_bf16_f32 v201, v166, v167
    v_mfma_f32_16x16x32_bf16 v[124:127], a[28:31], a[12:15], v[124:127]
    s_mov_b32 m0, s59
    v_add_u32 v15, s66, v15
    v_cvt_pk_bf16_f32 v202, v168, v169
    s_waitcnt vmcnt(24) lgkmcnt(0)
    v_mfma_f32_16x16x32_bf16 v[64:67], a[48:51], a[32:35], v[64:67]
    s_barrier
    v_cvt_pk_bf16_f32 v203, v170, v171
    v_cvt_pk_bf16_f32 v204, v172, v173
    v_mfma_f32_16x16x32_bf16 v[72:75], a[48:51], a[36:39], v[72:75]
    ds_read_b128 a[0:3], v6 offset:0
    buffer_load_dwordx4 v2, s[36:39], s56 offen offset:0 sc1 lds
    v_cvt_pk_bf16_f32 v205, v174, v175
    v_mfma_f32_16x16x32_bf16 v[80:83], a[48:51], a[40:43], v[80:83]
    ds_read_b64_tr_b16 a[16:17], v12 offset:0
    v_cvt_pk_bf16_f32 v206, v176, v177
    v_cvt_pk_bf16_f32 v207, v178, v179
    v_mfma_f32_16x16x32_bf16 v[88:91], a[48:51], a[44:47], v[88:91]
    ds_read_b64_tr_b16 a[18:19], v12 offset:4096
    s_nop 1
    v_mfma_f32_16x16x32_bf16 v[20:23], v[44:47], v[192:195], 0
    v_mfma_f32_16x16x32_bf16 v[68:71], a[52:55], a[32:35], v[68:71]
    ds_read_b128 a[4:7], v6 offset:1024
    v_mfma_f32_16x16x32_bf16 v[24:27], v[44:47], v[196:199], 0
    v_mfma_f32_16x16x32_bf16 v[28:31], v[44:47], v[200:203], 0
    v_mfma_f32_16x16x32_bf16 v[76:79], a[52:55], a[36:39], v[76:79]
    ds_read_b128 a[8:11], v6 offset:2048
    buffer_load_dwordx4 v2, s[36:39], s56 offen offset:1024 sc1 lds
    v_mfma_f32_16x16x32_bf16 v[32:35], v[44:47], v[204:207], 0
    v_mfma_f32_16x16x32_bf16 v[84:87], a[52:55], a[40:43], v[84:87]
    ds_read_b128 a[12:15], v6 offset:3072
    v_mfma_f32_16x16x32_bf16 v[148:151], v[230:233], v[192:195], 0
    v_mfma_f32_16x16x32_bf16 v[152:155], v[242:245], v[192:195], 0
    v_mfma_f32_16x16x32_bf16 v[92:95], a[52:55], a[44:47], v[92:95]
    ds_read_b64_tr_b16 a[20:21], v13 offset:0
    v_mfma_f32_16x16x32_bf16 v[156:159], v[232:235], v[196:199], 0
    v_mfma_f32_16x16x32_bf16 v[160:163], v[244:247], v[196:199], 0
    v_mfma_f32_16x16x32_bf16 v[96:99], a[56:59], a[32:35], v[96:99]
    ds_read_b64_tr_b16 a[22:23], v13 offset:4096
    v_mfma_f32_16x16x32_bf16 v[164:167], v[234:237], v[200:203], 0
    v_mfma_f32_16x16x32_bf16 v[168:171], v[246:249], v[200:203], 0
    v_mfma_f32_16x16x32_bf16 v[104:107], a[56:59], a[36:39], v[104:107]
    ds_read_b64_tr_b16 a[24:25], v14 offset:0
    buffer_load_dwordx4 v2, s[36:39], s56 offen offset:2048 sc1 lds
    v_mfma_f32_16x16x32_bf16 v[172:175], v[236:239], v[204:207], 0
    v_mfma_f32_16x16x32_bf16 v[112:115], a[56:59], a[40:43], v[112:115]
    ds_read_b64_tr_b16 a[26:27], v14 offset:4096
    v_mfma_f32_16x16x32_bf16 v[176:179], v[248:251], v[204:207], 0
    v_rcp_f32 v140, v20
    v_mfma_f32_16x16x32_bf16 v[120:123], a[56:59], a[44:47], v[120:123]
    ds_read_b64_tr_b16 a[28:29], v15 offset:0
    v_rcp_f32 v141, v24
    v_rcp_f32 v142, v28
    v_mfma_f32_16x16x32_bf16 v[100:103], a[60:63], a[32:35], v[100:103]
    s_add_u32 s64, s64, 1
    ds_read_b64_tr_b16 a[30:31], v15 offset:4096
    v_rcp_f32 v143, v32
    s_nop 1
    v_mfma_f32_16x16x32_bf16 v[108:111], a[60:63], a[36:39], v[108:111]
    buffer_load_dwordx4 v2, s[36:39], s56 offen offset:3072 sc1 lds
    s_nop 1
    v_mfma_f32_16x16x32_bf16 v[116:119], a[60:63], a[40:43], v[116:119]
    s_add_u32 s56, s56, 262144
    v_mul_f32 v148, v148, v140
    v_mul_f32 v149, v149, v140
    v_mfma_f32_16x16x32_bf16 v[124:127], a[60:63], a[44:47], v[124:127]
    v_mul_f32 v150, v150, v140
    v_mul_f32 v151, v151, v140
    s_cmp_gt_i32 s68, 8
    s_cbranch_scc0 m_lp158
m_lr159:
    s_waitcnt lgkmcnt(9)
    v_mfma_f32_16x16x32_bf16 v[64:67], a[16:19], a[0:3], v[64:67]
    s_add_u32 m0, s59, 16384
    ds_read_b128 a[32:35], v6 offset:8192
    v_mul_f32 v152, v152, v140
    v_mul_f32 v153, v153, v140
    s_waitcnt lgkmcnt(9)
    v_mfma_f32_16x16x32_bf16 v[72:75], a[16:19], a[4:7], v[72:75]
    ds_read_b64_tr_b16 a[48:49], v12 offset:8192
    buffer_load_dwordx4 v16, s[24:27], s57 offen offset:0 sc1 lds
    v_mul_f32 v154, v154, v140
    s_waitcnt lgkmcnt(9)
    v_mfma_f32_16x16x32_bf16 v[80:83], a[16:19], a[8:11], v[80:83]
    s_add_u32 s59, s58, s60
    ds_read_b64_tr_b16 a[50:51], v12 offset:12288
    v_mul_f32 v155, v155, v140
    v_cvt_pk_bf16_f32 v148, v148, v149
    s_waitcnt lgkmcnt(9)
    v_mfma_f32_16x16x32_bf16 v[88:91], a[16:19], a[12:15], v[88:91]
    s_add_u32 s58, s58, 32768
    ds_read_b128 a[36:39], v6 offset:9216
    v_cvt_pk_bf16_f32 v149, v150, v151
    v_cvt_pk_bf16_f32 v150, v152, v153
    s_waitcnt lgkmcnt(8)
    v_mfma_f32_16x16x32_bf16 v[68:71], a[20:23], a[0:3], v[68:71]
    s_cmp_ge_u32 s58, 163840
    ds_read_b128 a[40:43], v6 offset:10240
    v_cvt_pk_bf16_f32 v151, v154, v155
    buffer_store_dwordx4 v[148:151], v2, s[8:11], s80 offen offset:0 sc1
    v_mfma_f32_16x16x32_bf16 v[76:79], a[20:23], a[4:7], v[76:79]
    ds_read_b128 a[44:47], v6 offset:11264
    buffer_load_dwordx4 v17, s[24:27], s57 offen offset:1024 sc1 lds
    v_mul_f32 v156, v156, v141
    v_mfma_f32_16x16x32_bf16 v[84:87], a[20:23], a[8:11], v[84:87]
    s_cselect_b32 s66, 4294836224, s100
    ds_read_b64_tr_b16 a[52:53], v13 offset:8192
    v_mul_f32 v157, v157, v141
    v_mul_f32 v158, v158, v141
    v_mfma_f32_16x16x32_bf16 v[92:95], a[20:23], a[12:15], v[92:95]
    s_cselect_b32 s58, 0, s58
    ds_read_b64_tr_b16 a[54:55], v13 offset:12288
    v_mul_f32 v159, v159, v141
    v_mul_f32 v160, v160, v141
    s_waitcnt lgkmcnt(10)
    v_mfma_f32_16x16x32_bf16 v[96:99], a[24:27], a[0:3], v[96:99]
    ds_read_b64_tr_b16 a[56:57], v14 offset:8192
    v_mul_f32 v161, v161, v141
    v_mul_f32 v162, v162, v141
    v_mfma_f32_16x16x32_bf16 v[104:107], a[24:27], a[4:7], v[104:107]
    ds_read_b64_tr_b16 a[58:59], v14 offset:12288
    buffer_load_dwordx4 v18, s[24:27], s57 offen offset:2048 sc1 lds
    v_mul_f32 v163, v163, v141
    v_mfma_f32_16x16x32_bf16 v[112:115], a[24:27], a[8:11], v[112:115]
    ds_read_b64_tr_b16 a[60:61], v15 offset:8192
    v_cvt_pk_bf16_f32 v156, v156, v157
    v_cvt_pk_bf16_f32 v157, v158, v159
    v_mfma_f32_16x16x32_bf16 v[120:123], a[24:27], a[12:15], v[120:123]
    ds_read_b64_tr_b16 a[62:63], v15 offset:12288
    v_cvt_pk_bf16_f32 v158, v160, v161
    v_cvt_pk_bf16_f32 v159, v162, v163
    s_waitcnt lgkmcnt(12)
    v_mfma_f32_16x16x32_bf16 v[100:103], a[28:31], a[0:3], v[100:103]
    v_add_u32 v6, s66, v6
    v_add_u32 v12, s66, v12
    buffer_store_dwordx4 v[156:159], v2, s[8:11], s80 offen offset:1024 sc1
    v_mfma_f32_16x16x32_bf16 v[108:111], a[28:31], a[4:7], v[108:111]
    buffer_load_dwordx4 v19, s[24:27], s57 offen offset:3072 sc1 lds
    v_mul_f32 v164, v164, v142
    v_mfma_f32_16x16x32_bf16 v[116:119], a[28:31], a[8:11], v[116:119]
    s_add_u32 s57, s57, 131072
    v_add_u32 v13, s66, v13
    v_add_u32 v14, s66, v14
    v_mul_f32 v165, v165, v142
    v_mfma_f32_16x16x32_bf16 v[124:127], a[28:31], a[12:15], v[124:127]
    s_mov_b32 m0, s59
    v_add_u32 v15, s66, v15
    v_mul_f32 v166, v166, v142
    s_waitcnt vmcnt(24) lgkmcnt(0)
    v_mfma_f32_16x16x32_bf16 v[64:67], a[48:51], a[32:35], v[64:67]
    s_barrier
    v_mul_f32 v167, v167, v142
    v_mul_f32 v168, v168, v142
    v_mfma_f32_16x16x32_bf16 v[72:75], a[48:51], a[36:39], v[72:75]
    ds_read_b128 a[0:3], v6 offset:0
    buffer_load_dwordx4 v2, s[36:39], s56 offen offset:0 sc1 lds
    v_mul_f32 v169, v169, v142
    v_mfma_f32_16x16x32_bf16 v[80:83], a[48:51], a[40:43], v[80:83]
    ds_read_b64_tr_b16 a[16:17], v12 offset:0
    v_mul_f32 v170, v170, v142
    v_mul_f32 v171, v171, v142
    v_mfma_f32_16x16x32_bf16 v[88:91], a[48:51], a[44:47], v[88:91]
    ds_read_b64_tr_b16 a[18:19], v12 offset:4096
    v_cvt_pk_bf16_f32 v164, v164, v165
    v_cvt_pk_bf16_f32 v165, v166, v167
    v_mfma_f32_16x16x32_bf16 v[68:71], a[52:55], a[32:35], v[68:71]
    ds_read_b128 a[4:7], v6 offset:1024
    v_cvt_pk_bf16_f32 v166, v168, v169
    v_cvt_pk_bf16_f32 v167, v170, v171
    v_mfma_f32_16x16x32_bf16 v[76:79], a[52:55], a[36:39], v[76:79]
    ds_read_b128 a[8:11], v6 offset:2048
    buffer_load_dwordx4 v2, s[36:39], s56 offen offset:1024 sc1 lds
    buffer_store_dwordx4 v[164:167], v2, s[8:11], s80 offen offset:2048 sc1
    v_mfma_f32_16x16x32_bf16 v[84:87], a[52:55], a[40:43], v[84:87]
    ds_read_b128 a[12:15], v6 offset:3072
    v_mul_f32 v172, v172, v143
    v_mul_f32 v173, v173, v143
    v_mfma_f32_16x16x32_bf16 v[92:95], a[52:55], a[44:47], v[92:95]
    ds_read_b64_tr_b16 a[20:21], v13 offset:0
    v_mul_f32 v174, v174, v143
    v_mul_f32 v175, v175, v143
    v_mfma_f32_16x16x32_bf16 v[96:99], a[56:59], a[32:35], v[96:99]
    ds_read_b64_tr_b16 a[22:23], v13 offset:4096
    v_mul_f32 v176, v176, v143
    v_mul_f32 v177, v177, v143
    v_mfma_f32_16x16x32_bf16 v[104:107], a[56:59], a[36:39], v[104:107]
    ds_read_b64_tr_b16 a[24:25], v14 offset:0
    buffer_load_dwordx4 v2, s[36:39], s56 offen offset:2048 sc1 lds
    v_mul_f32 v178, v178, v143
    v_mfma_f32_16x16x32_bf16 v[112:115], a[56:59], a[40:43], v[112:115]
    ds_read_b64_tr_b16 a[26:27], v14 offset:4096
    v_mul_f32 v179, v179, v143
    v_cvt_pk_bf16_f32 v172, v172, v173
    v_mfma_f32_16x16x32_bf16 v[120:123], a[56:59], a[44:47], v[120:123]
    ds_read_b64_tr_b16 a[28:29], v15 offset:0
    v_cvt_pk_bf16_f32 v173, v174, v175
    v_cvt_pk_bf16_f32 v174, v176, v177
    v_mfma_f32_16x16x32_bf16 v[100:103], a[60:63], a[32:35], v[100:103]
    s_add_u32 s64, s64, 1
    ds_read_b64_tr_b16 a[30:31], v15 offset:4096
    v_cvt_pk_bf16_f32 v175, v178, v179
    buffer_store_dwordx4 v[172:175], v2, s[8:11], s80 offen offset:3072 sc1
    v_mfma_f32_16x16x32_bf16 v[108:111], a[60:63], a[36:39], v[108:111]
    buffer_load_dwordx4 v2, s[36:39], s56 offen offset:3072 sc1 lds
    v_mfma_f32_16x16x32_bf16 v[116:119], a[60:63], a[40:43], v[116:119]
    s_add_u32 s56, s56, 262144
    v_mfma_f32_16x16x32_bf16 v[124:127], a[60:63], a[44:47], v[124:127]
    s_branch m_l3e148
m_lp152:
    s_mov_b32 s3, 262144
m_spin160:
    buffer_load_dwordx2 v[4:5], v10, s[8:11], s52 offen sc1
    s_waitcnt vmcnt(0)
    v_cmp_ne_u64 s[76:77], s[4:5], v[4:5]
    s_mul_i32 s91, s95, 20
    s_nop 2
    s_lshr_b32 s90, s76, s91
    s_ff1_i32_b32 s90, s90
    s_lshl_b32 s68, s90, 1
    s_mul_i32 s91, s95, 0
    s_sub_i32 s68, s68, s91
    s_cmp_lt_i32 s90, 0
    s_cselect_b32 s68, 1000, s68
    s_cmp_gt_i32 s68, 5
    s_cbranch_scc1 m_ok161
    s_sub_u32 s3, s3, 1
    s_cbranch_scc1 m_ok161
    s_sleep 4
    s_branch m_spin160
m_ok161:
    s_branch m_lr153
m_lp154:
    s_mov_b32 s3, 262144
m_spin162:
    buffer_load_dwordx2 v[4:5], v10, s[8:11], s52 offen sc1
    s_waitcnt vmcnt(0)
    v_cmp_ne_u64 s[76:77], s[4:5], v[4:5]
    s_mul_i32 s91, s95, 20
    s_nop 2
    s_lshr_b32 s90, s76, s91
    s_ff1_i32_b32 s90, s90
    s_lshl_b32 s68, s90, 1
    s_mul_i32 s91, s95, 0
    s_sub_i32 s68, s68, s91
    s_cmp_lt_i32 s90, 0
    s_cselect_b32 s68, 1000, s68
    s_cmp_gt_i32 s68, 6
    s_cbranch_scc1 m_ok163
    s_sub_u32 s3, s3, 1
    s_cbranch_scc1 m_ok163
    s_sleep 4
    s_branch m_spin162
m_ok163:
    s_branch m_lr155
m_lp156:
    s_mov_b32 s3, 262144
m_spin164:
    buffer_load_dwordx2 v[4:5], v10, s[8:11], s52 offen sc1
    s_waitcnt vmcnt(0)
    v_cmp_ne_u64 s[76:77], s[4:5], v[4:5]
    s_mul_i32 s91, s95, 20
    s_nop 2
    s_lshr_b32 s90, s76, s91
    s_ff1_i32_b32 s90, s90
    s_lshl_b32 s68, s90, 1
    s_mul_i32 s91, s95, 0
    s_sub_i32 s68, s68, s91
    s_cmp_lt_i32 s90, 0
    s_cselect_b32 s68, 1000, s68
    s_cmp_gt_i32 s68, 7
    s_cbranch_scc1 m_ok165
    s_sub_u32 s3, s3, 1
    s_cbranch_scc1 m_ok165
    s_sleep 4
    s_branch m_spin164
m_ok165:
    s_branch m_lr157
m_lp158:
    s_mov_b32 s3, 262144
m_spin166:
    buffer_load_dwordx2 v[4:5], v10, s[8:11], s52 offen sc1
    s_waitcnt vmcnt(0)
    v_cmp_ne_u64 s[76:77], s[4:5], v[4:5]
    s_mul_i32 s91, s95, 20
    s_nop 2
    s_lshr_b32 s90, s76, s91
    s_ff1_i32_b32 s90, s90
    s_lshl_b32 s68, s90, 1
    s_mul_i32 s91, s95, 0
    s_sub_i32 s68, s68, s91
    s_cmp_lt_i32 s90, 0
    s_cselect_b32 s68, 1000, s68
    s_cmp_gt_i32 s68, 8
    s_cbranch_scc1 m_ok167
    s_sub_u32 s3, s3, 1
    s_cbranch_scc1 m_ok167
    s_sleep 4
    s_branch m_spin166
m_ok167:
    s_branch m_lr159
.p2align 3
m_l3147:
    s_waitcnt lgkmcnt(9)
    v_mfma_f32_16x16x32_bf16 v[64:67], a[16:19], a[0:3], v[64:67]
    s_add_u32 m0, s59, 16384
    ds_read_b128 a[32:35], v6 offset:8192
    s_waitcnt lgkmcnt(9)
    v_mfma_f32_16x16x32_bf16 v[72:75], a[16:19], a[4:7], v[72:75]
    ds_read_b64_tr_b16 a[48:49], v12 offset:8192
    buffer_load_dwordx4 v16, s[24:27], s57 offen offset:0 sc1 lds
    s_waitcnt lgkmcnt(9)
    v_mfma_f32_16x16x32_bf16 v[80:83], a[16:19], a[8:11], v[80:83]
    s_add_u32 s59, s58, s60
    ds_read_b64_tr_b16 a[50:51], v12 offset:12288
    s_waitcnt lgkmcnt(9)
    v_mfma_f32_16x16x32_bf16 v[88:91], a[16:19], a[12:15], v[88:91]
    s_add_u32 s58, s58, 32768
    ds_read_b128 a[36:39], v6 offset:9216
    s_waitcnt lgkmcnt(8)
    v_mfma_f32_16x16x32_bf16 v[68:71], a[20:23], a[0:3], v[68:71]
    s_cmp_ge_u32 s58, 163840
    ds_read_b128 a[40:43], v6 offset:10240
    v_mfma_f32_16x16x32_bf16 v[76:79], a[20:23], a[4:7], v[76:79]
    ds_read_b128 a[44:47], v6 offset:11264
    buffer_load_dwordx4 v17, s[24:27], s57 offen offset:1024 sc1 lds
    v_mfma_f32_16x16x32_bf16 v[84:87], a[20:23], a[8:11], v[84:87]
    s_cselect_b32 s66, 4294836224, s100
    ds_read_b64_tr_b16 a[52:53], v13 offset:8192
    v_mfma_f32_16x16x32_bf16 v[92:95], a[20:23], a[12:15], v[92:95]
    s_cselect_b32 s58, 0, s58
    ds_read_b64_tr_b16 a[54:55], v13 offset:12288
    s_waitcnt lgkmcnt(10)
    v_mfma_f32_16x16x32_bf16 v[96:99], a[24:27], a[0:3], v[96:99]
    ds_read_b64_tr_b16 a[56:57], v14 offset:8192
    v_mfma_f32_16x16x32_bf16 v[104:107], a[24:27], a[4:7], v[104:107]
    ds_read_b64_tr_b16 a[58:59], v14 offset:12288
    buffer_load_dwordx4 v18, s[24:27], s57 offen offset:2048 sc1 lds
    v_mfma_f32_16x16x32_bf16 v[112:115], a[24:27], a[8:11], v[112:115]
    ds_read_b64_tr_b16 a[60:61], v15 offset:8192
    v_mfma_f32_16x16x32_bf16 v[120:123], a[24:27], a[12:15], v[120:123]
    ds_read_b64_tr_b16 a[62:63], v15 offset:12288
    s_waitcnt lgkmcnt(12)
    v_mfma_f32_16x16x32_bf16 v[100:103], a[28:31], a[0:3], v[100:103]
    v_add_u32 v6, s66, v6
    v_add_u32 v12, s66, v12
    v_mfma_f32_16x16x32_bf16 v[108:111], a[28:31], a[4:7], v[108:111]
    buffer_load_dwordx4 v19, s[24:27], s57 offen offset:3072 sc1 lds
    v_mfma_f32_16x16x32_bf16 v[116:119], a[28:31], a[8:11], v[116:119]
    s_add_u32 s57, s57, 131072
    v_add_u32 v13, s66, v13
    v_add_u32 v14, s66, v14
    v_mfma_f32_16x16x32_bf16 v[124:127], a[28:31], a[12:15], v[124:127]
    s_mov_b32 m0, s59
    v_add_u32 v15, s66, v15
    s_waitcnt vmcnt(24) lgkmcnt(0)
    v_mfma_f32_16x16x32_bf16 v[64:67], a[48:51], a[32:35], v[64:67]
    s_barrier
    v_mfma_f32_16x16x32_bf16 v[72:75], a[48:51], a[36:39], v[72:75]
    ds_read_b128 a[0:3], v6 offset:0
    buffer_load_dwordx4 v2, s[36:39], s56 offen offset:0 sc1 lds
    v_mfma_f32_16x16x32_bf16 v[80:83], a[48:51], a[40:43], v[80:83]
    ds_read_b64_tr_b16 a[16:17], v12 offset:0
    v_mfma_f32_16x16x32_bf16 v[88:91], a[48:51], a[44:47], v[88:91]
    ds_read_b64_tr_b16 a[18:19], v12 offset:4096
    v_mfma_f32_16x16x32_bf16 v[68:71], a[52:55], a[32:35], v[68:71]
    ds_read_b128 a[4:7], v6 offset:1024
    v_mfma_f32_16x16x32_bf16 v[76:79], a[52:55], a[36:39], v[76:79]
    ds_read_b128 a[8:11], v6 offset:2048
    buffer_load_dwordx4 v2, s[36:39], s56 offen offset:1024 sc1 lds
    v_mfma_f32_16x16x32_bf16 v[84:87], a[52:55], a[40:43], v[84:87]
    ds_read_b128 a[12:15], v6 offset:3072
    v_mfma_f32_16x16x32_bf16 v[92:95], a[52:55], a[44:47], v[92:95]
    ds_read_b64_tr_b16 a[20:21], v13 offset:0
    v_mfma_f32_16x16x32_bf16 v[96:99], a[56:59], a[32:35], v[96:99]
    ds_read_b64_tr_b16 a[22:23], v13 offset:4096
    v_mfma_f32_16x16x32_bf16 v[104:107], a[56:59], a[36:39], v[104:107]
    ds_read_b64_tr_b16 a[24:25], v14 offset:0
    buffer_load_dwordx4 v2, s[36:39], s56 offen offset:2048 sc1 lds
    v_mfma_f32_16x16x32_bf16 v[112:115], a[56:59], a[40:43], v[112:115]
    ds_read_b64_tr_b16 a[26:27], v14 offset:4096
    v_mfma_f32_16x16x32_bf16 v[120:123], a[56:59], a[44:47], v[120:123]
    ds_read_b64_tr_b16 a[28:29], v15 offset:0
    v_mfma_f32_16x16x32_bf16 v[100:103], a[60:63], a[32:35], v[100:103]
    s_add_u32 s64, s64, 1
    ds_read_b64_tr_b16 a[30:31], v15 offset:4096
    v_mfma_f32_16x16x32_bf16 v[108:111], a[60:63], a[36:39], v[108:111]
    buffer_load_dwordx4 v2, s[36:39], s56 offen offset:3072 sc1 lds
    v_mfma_f32_16x16x32_bf16 v[116:119], a[60:63], a[40:43], v[116:119]
    s_add_u32 s56, s56, 262144
    s_cmp_lt_u32 s64, s67
    v_mfma_f32_16x16x32_bf16 v[124:127], a[60:63], a[44:47], v[124:127]
    s_cbranch_scc1 m_l3147
m_l3e148:
    s_add_u32 s92, s64, 5
    s_cmp_gt_i32 s68, s92
    s_cbranch_scc1 m_rdy168
    s_mov_b32 s3, 262144
m_spin169:
    buffer_load_dwordx2 v[4:5], v10, s[8:11], s52 offen sc1
    s_waitcnt vmcnt(0)
    v_cmp_ne_u64 s[76:77], s[4:5], v[4:5]
    s_mul_i32 s91, s95, 20
    s_nop 2
    s_lshr_b32 s90, s76, s91
    s_ff1_i32_b32 s90, s90
    s_lshl_b32 s68, s90, 1
    s_mul_i32 s91, s95, 0
    s_sub_i32 s68, s68, s91
    s_cmp_lt_i32 s90, 0
    s_cselect_b32 s68, 1000, s68
    s_cmp_gt_i32 s68, s92
    s_cbranch_scc1 m_ok170
    s_sub_u32 s3, s3, 1
    s_cbranch_scc1 m_ok170
    s_sleep 4
    s_branch m_spin169
m_ok170:
m_rdy168:
    s_mov_b32 s67, 8
    s_cmp_lt_u32 s64, 8
    s_cbranch_scc1 m_l3n151
    s_cmp_eq_u32 s64, 8
    s_cbranch_scc1 m_o1171
m_o2172:
    s_cmp_eq_u32 s95, 0
    s_cbranch_scc1 m_l3c150
    s_mov_b32 s67, 18
    s_cmp_lt_u32 s64, 18
    s_cbranch_scc1 m_l3n151
    s_cmp_lg_u32 s64, 18
    s_cbranch_scc1 m_n173
    s_mov_b32 s68, 1000
    s_lshr_b32 s90, s96, 1
    s_lshl_b32 s90, s90, 8
    s_add_u32 s90, s90, 117452800
    buffer_load_dwordx2 v[4:5], v10, s[8:11], s90 offen sc1
    s_mov_b32 s67, 19
    s_branch m_l3147
m_n173:
    s_cmp_lg_u32 s64, 19
    s_cbranch_scc1 m_n174
    s_waitcnt vmcnt(8)
    s_waitcnt vmcnt(16)
    s_mov_b32 s3, 262144
m_spin175:
    v_cmp_ne_u64 s[76:77], s[4:5], v[4:5]
    s_nop 3
    s_cmp_eq_u64 s[76:77], 0
    s_cbranch_scc1 m_ok176
    s_sub_u32 s3, s3, 1
    s_cbranch_scc1 m_ok176
    s_sleep 8
    s_lshr_b32 s90, s96, 1
    s_lshl_b32 s90, s90, 8
    s_add_u32 s90, s90, 117452800
    buffer_load_dwordx2 v[4:5], v10, s[8:11], s90 offen sc1
    s_waitcnt vmcnt(0)
    s_branch m_spin175
m_ok176:
    s_mov_b32 s56, s69
    s_mov_b32 s67, 20
    s_branch m_l3147
m_n174:
    s_cmp_lg_u32 s64, 20
    s_cbranch_scc1 m_n177
    s_mov_b32 s24, s50
    s_mov_b32 s25, s51
    s_mov_b32 s26, 2097152
    s_lshl_b32 s57, s97, 8
    s_mov_b32 s67, 24
    s_branch m_l3147
m_n177:
    s_cmp_lg_u32 s64, 24
    s_cbranch_scc1 m_n178
    s_lshl_b32 s90, s96, 3
    s_add_u32 s90, s90, s97
    s_lshl_b32 s90, s90, 15
    s_lshl_b32 s91, s16, 13
    s_add_u32 s90, s90, s91
    s_add_u32 s70, s90, 100663296
    s_nop 3
    v_cvt_pk_bf16_f32 v128, v64, v65
    v_cvt_pk_bf16_f32 v129, v66, v67
    v_cvt_pk_bf16_f32 v130, v68, v69
    v_cvt_pk_bf16_f32 v131, v70, v71
    v_cvt_pk_bf16_f32 v132, v72, v73
    v_cvt_pk_bf16_f32 v133, v74, v75
    v_cvt_pk_bf16_f32 v134, v76, v77
    v_cvt_pk_bf16_f32 v135, v78, v79
    v_cvt_pk_bf16_f32 v136, v80, v81
    v_cvt_pk_bf16_f32 v137, v82, v83
    v_cvt_pk_bf16_f32 v138, v84, v85
    v_cvt_pk_bf16_f32 v139, v86, v87
    v_cvt_pk_bf16_f32 v140, v88, v89
    v_cvt_pk_bf16_f32 v141, v90, v91
    v_cvt_pk_bf16_f32 v142, v92, v93
    v_cvt_pk_bf16_f32 v143, v94, v95
    v_cvt_pk_bf16_f32 v144, v96, v97
    v_cvt_pk_bf16_f32 v145, v98, v99
    v_cvt_pk_bf16_f32 v146, v100, v101
    v_cvt_pk_bf16_f32 v147, v102, v103
    v_cvt_pk_bf16_f32 v148, v104, v105
    v_cvt_pk_bf16_f32 v149, v106, v107
    v_cvt_pk_bf16_f32 v150, v108, v109
    v_cvt_pk_bf16_f32 v151, v110, v111
    v_cvt_pk_bf16_f32 v152, v112, v113
    v_cvt_pk_bf16_f32 v153, v114, v115
    v_cvt_pk_bf16_f32 v154, v116, v117
    v_cvt_pk_bf16_f32 v155, v118, v119
    v_cvt_pk_bf16_f32 v156, v120, v121
    v_cvt_pk_bf16_f32 v157, v122, v123
    v_cvt_pk_bf16_f32 v158, v124, v125
    v_cvt_pk_bf16_f32 v159, v126, v127
    v_mov_b64 v[64:65], 0
    v_mov_b64 v[66:67], 0
    v_mov_b64 v[68:69], 0
    v_mov_b64 v[70:71], 0
    v_mov_b64 v[72:73], 0
    v_mov_b64 v[74:75], 0
    v_mov_b64 v[76:77], 0
    v_mov_b64 v[78:79], 0
    v_mov_b64 v[80:81], 0
    v_mov_b64 v[82:83], 0
    v_mov_b64 v[84:85], 0
    v_mov_b64 v[86:87], 0
    v_mov_b64 v[88:89], 0
    v_mov_b64 v[90:91], 0
    v_mov_b64 v[92:93], 0
    v_mov_b64 v[94:95], 0
    v_mov_b64 v[96:97], 0
    v_mov_b64 v[98:99], 0
    v_mov_b64 v[100:101], 0
    v_mov_b64 v[102:103], 0
    v_mov_b64 v[104:105], 0
    v_mov_b64 v[106:107], 0
    v_mov_b64 v[108:109], 0
    v_mov_b64 v[110:111], 0
    v_mov_b64 v[112:113], 0
    v_mov_b64 v[114:115], 0
    v_mov_b64 v[116:117], 0
    v_mov_b64 v[118:119], 0
    v_mov_b64 v[120:121], 0
    v_mov_b64 v[122:123], 0
    v_mov_b64 v[124:125], 0
    v_mov_b64 v[126:127], 0
    s_nop 1
    s_waitcnt lgkmcnt(9)
    v_mfma_f32_16x16x32_bf16 v[64:67], a[16:19], a[0:3], v[64:67]
    s_add_u32 m0, s59, 16384
    ds_read_b128 a[32:35], v6 offset:8192
    s_waitcnt lgkmcnt(9)
    v_mfma_f32_16x16x32_bf16 v[72:75], a[16:19], a[4:7], v[72:75]
    ds_read_b64_tr_b16 a[48:49], v12 offset:8192
    buffer_load_dwordx4 v16, s[24:27], s57 offen offset:0 sc1 lds
    s_waitcnt lgkmcnt(9)
    v_mfma_f32_16x16x32_bf16 v[80:83], a[16:19], a[8:11], v[80:83]
    s_add_u32 s59, s58, s60
    ds_read_b64_tr_b16 a[50:51], v12 offset:12288
    s_waitcnt lgkmcnt(9)
    v_mfma_f32_16x16x32_bf16 v[88:91], a[16:19], a[12:15], v[88:91]
    s_add_u32 s58, s58, 32768
    ds_read_b128 a[36:39], v6 offset:9216
    s_waitcnt lgkmcnt(8)
    v_mfma_f32_16x16x32_bf16 v[68:71], a[20:23], a[0:3], v[68:71]
    s_cmp_ge_u32 s58, 163840
    ds_read_b128 a[40:43], v6 offset:10240
    v_mfma_f32_16x16x32_bf16 v[76:79], a[20:23], a[4:7], v[76:79]
    ds_read_b128 a[44:47], v6 offset:11264
    buffer_load_dwordx4 v17, s[24:27], s57 offen offset:1024 sc1 lds
    v_mfma_f32_16x16x32_bf16 v[84:87], a[20:23], a[8:11], v[84:87]
    s_cselect_b32 s66, 4294836224, s100
    ds_read_b64_tr_b16 a[52:53], v13 offset:8192
    v_mfma_f32_16x16x32_bf16 v[92:95], a[20:23], a[12:15], v[92:95]
    s_cselect_b32 s58, 0, s58
    ds_read_b64_tr_b16 a[54:55], v13 offset:12288
    s_waitcnt lgkmcnt(10)
    v_mfma_f32_16x16x32_bf16 v[96:99], a[24:27], a[0:3], v[96:99]
    ds_read_b64_tr_b16 a[56:57], v14 offset:8192
    v_mfma_f32_16x16x32_bf16 v[104:107], a[24:27], a[4:7], v[104:107]
    ds_read_b64_tr_b16 a[58:59], v14 offset:12288
    buffer_load_dwordx4 v18, s[24:27], s57 offen offset:2048 sc1 lds
    v_mfma_f32_16x16x32_bf16 v[112:115], a[24:27], a[8:11], v[112:115]
    ds_read_b64_tr_b16 a[60:61], v15 offset:8192
    v_mfma_f32_16x16x32_bf16 v[120:123], a[24:27], a[12:15], v[120:123]
    ds_read_b64_tr_b16 a[62:63], v15 offset:12288
    buffer_store_dwordx4 v[128:131], v2, s[8:11], s70 offen offset:0 sc1
    s_waitcnt lgkmcnt(12)
    v_mfma_f32_16x16x32_bf16 v[100:103], a[28:31], a[0:3], v[100:103]
    v_add_u32 v6, s66, v6
    v_add_u32 v12, s66, v12
    v_mfma_f32_16x16x32_bf16 v[108:111], a[28:31], a[4:7], v[108:111]
    buffer_load_dwordx4 v19, s[24:27], s57 offen offset:3072 sc1 lds
    v_mfma_f32_16x16x32_bf16 v[116:119], a[28:31], a[8:11], v[116:119]
    s_add_u32 s57, s57, 131072
    v_add_u32 v13, s66, v13
    v_add_u32 v14, s66, v14
    v_mfma_f32_16x16x32_bf16 v[124:127], a[28:31], a[12:15], v[124:127]
    s_mov_b32 m0, s59
    v_add_u32 v15, s66, v15
    s_waitcnt vmcnt(24) lgkmcnt(0)
    v_mfma_f32_16x16x32_bf16 v[64:67], a[48:51], a[32:35], v[64:67]
    s_barrier
    v_mfma_f32_16x16x32_bf16 v[72:75], a[48:51], a[36:39], v[72:75]
    ds_read_b128 a[0:3], v6 offset:0
    buffer_load_dwordx4 v2, s[36:39], s56 offen offset:0 sc1 lds
    v_mfma_f32_16x16x32_bf16 v[80:83], a[48:51], a[40:43], v[80:83]
    ds_read_b64_tr_b16 a[16:17], v12 offset:0
    v_mfma_f32_16x16x32_bf16 v[88:91], a[48:51], a[44:47], v[88:91]
    ds_read_b64_tr_b16 a[18:19], v12 offset:4096
    v_mfma_f32_16x16x32_bf16 v[68:71], a[52:55], a[32:35], v[68:71]
    ds_read_b128 a[4:7], v6 offset:1024
    v_mfma_f32_16x16x32_bf16 v[76:79], a[52:55], a[36:39], v[76:79]
    ds_read_b128 a[8:11], v6 offset:2048
    buffer_load_dwordx4 v2, s[36:39], s56 offen offset:1024 sc1 lds
    v_mfma_f32_16x16x32_bf16 v[84:87], a[52:55], a[40:43], v[84:87]
    ds_read_b128 a[12:15], v6 offset:3072
    v_mfma_f32_16x16x32_bf16 v[92:95], a[52:55], a[44:47], v[92:95]
    ds_read_b64_tr_b16 a[20:21], v13 offset:0
    v_mfma_f32_16x16x32_bf16 v[96:99], a[56:59], a[32:35], v[96:99]
    ds_read_b64_tr_b16 a[22:23], v13 offset:4096
    v_mfma_f32_16x16x32_bf16 v[104:107], a[56:59], a[36:39], v[104:107]
    ds_read_b64_tr_b16 a[24:25], v14 offset:0
    buffer_load_dwordx4 v2, s[36:39], s56 offen offset:2048 sc1 lds
    v_mfma_f32_16x16x32_bf16 v[112:115], a[56:59], a[40:43], v[112:115]
    ds_read_b64_tr_b16 a[26:27], v14 offset:4096
    v_mfma_f32_16x16x32_bf16 v[120:123], a[56:59], a[44:47], v[120:123]
    ds_read_b64_tr_b16 a[28:29], v15 offset:0
    buffer_store_dwordx4 v[132:135], v2, s[8:11], s70 offen offset:1024 sc1
    v_mfma_f32_16x16x32_bf16 v[100:103], a[60:63], a[32:35], v[100:103]
    s_add_u32 s64, s64, 1
    ds_read_b64_tr_b16 a[30:31], v15 offset:4096
    v_mfma_f32_16x16x32_bf16 v[108:111], a[60:63], a[36:39], v[108:111]
    buffer_load_dwordx4 v2, s[36:39], s56 offen offset:3072 sc1 lds
    v_mfma_f32_16x16x32_bf16 v[116:119], a[60:63], a[40:43], v[116:119]
    s_add_u32 s56, s56, 262144
    v_mfma_f32_16x16x32_bf16 v[124:127], a[60:63], a[44:47], v[124:127]
    s_waitcnt lgkmcnt(9)
    v_mfma_f32_16x16x32_bf16 v[64:67], a[16:19], a[0:3], v[64:67]
    s_add_u32 m0, s59, 16384
    ds_read_b128 a[32:35], v6 offset:8192
    s_waitcnt lgkmcnt(9)
    v_mfma_f32_16x16x32_bf16 v[72:75], a[16:19], a[4:7], v[72:75]
    ds_read_b64_tr_b16 a[48:49], v12 offset:8192
    buffer_load_dwordx4 v16, s[24:27], s57 offen offset:0 sc1 lds
    s_waitcnt lgkmcnt(9)
    v_mfma_f32_16x16x32_bf16 v[80:83], a[16:19], a[8:11], v[80:83]
    s_add_u32 s59, s58, s60
    ds_read_b64_tr_b16 a[50:51], v12 offset:12288
    s_waitcnt lgkmcnt(9)
    v_mfma_f32_16x16x32_bf16 v[88:91], a[16:19], a[12:15], v[88:91]
    s_add_u32 s58, s58, 32768
    ds_read_b128 a[36:39], v6 offset:9216
    s_waitcnt lgkmcnt(8)
    v_mfma_f32_16x16x32_bf16 v[68:71], a[20:23], a[0:3], v[68:71]
    s_cmp_ge_u32 s58, 163840
    ds_read_b128 a[40:43], v6 offset:10240
    v_mfma_f32_16x16x32_bf16 v[76:79], a[20:23], a[4:7], v[76:79]
    ds_read_b128 a[44:47], v6 offset:11264
    buffer_load_dwordx4 v17, s[24:27], s57 offen offset:1024 sc1 lds
    v_mfma_f32_16x16x32_bf16 v[84:87], a[20:23], a[8:11], v[84:87]
    s_cselect_b32 s66, 4294836224, s100
    ds_read_b64_tr_b16 a[52:53], v13 offset:8192
    v_mfma_f32_16x16x32_bf16 v[92:95], a[20:23], a[12:15], v[92:95]
    s_cselect_b32 s58, 0, s58
    ds_read_b64_tr_b16 a[54:55], v13 offset:12288
    s_waitcnt lgkmcnt(10)
    v_mfma_f32_16x16x32_bf16 v[96:99], a[24:27], a[0:3], v[96:99]
    ds_read_b64_tr_b16 a[56:57], v14 offset:8192
    v_mfma_f32_16x16x32_bf16 v[104:107], a[24:27], a[4:7], v[104:107]
    ds_read_b64_tr_b16 a[58:59], v14 offset:12288
    buffer_load_dwordx4 v18, s[24:27], s57 offen offset:2048 sc1 lds
    v_mfma_f32_16x16x32_bf16 v[112:115], a[24:27], a[8:11], v[112:115]
    ds_read_b64_tr_b16 a[60:61], v15 offset:8192
    v_mfma_f32_16x16x32_bf16 v[120:123], a[24:27], a[12:15], v[120:123]
    ds_read_b64_tr_b16 a[62:63], v15 offset:12288
    buffer_store_dwordx4 v[136:139], v2, s[8:11], s70 offen offset:2048 sc1
    s_waitcnt lgkmcnt(12)
    v_mfma_f32_16x16x32_bf16 v[100:103], a[28:31], a[0:3], v[100:103]
    v_add_u32 v6, s66, v6
    v_add_u32 v12, s66, v12
    v_mfma_f32_16x16x32_bf16 v[108:111], a[28:31], a[4:7], v[108:111]
    buffer_load_dwordx4 v19, s[24:27], s57 offen offset:3072 sc1 lds
    v_mfma_f32_16x16x32_bf16 v[116:119], a[28:31], a[8:11], v[116:119]
    s_add_u32 s57, s57, 131072
    v_add_u32 v13, s66, v13
    v_add_u32 v14, s66, v14
    v_mfma_f32_16x16x32_bf16 v[124:127], a[28:31], a[12:15], v[124:127]
    s_mov_b32 m0, s59
    v_add_u32 v15, s66, v15
    s_waitcnt vmcnt(24) lgkmcnt(0)
    v_mfma_f32_16x16x32_bf16 v[64:67], a[48:51], a[32:35], v[64:67]
    s_barrier
    v_mfma_f32_16x16x32_bf16 v[72:75], a[48:51], a[36:39], v[72:75]
    ds_read_b128 a[0:3], v6 offset:0
    buffer_load_dwordx4 v2, s[36:39], s56 offen offset:0 sc1 lds
    v_mfma_f32_16x16x32_bf16 v[80:83], a[48:51], a[40:43], v[80:83]
    ds_read_b64_tr_b16 a[16:17], v12 offset:0
    v_mfma_f32_16x16x32_bf16 v[88:91], a[48:51], a[44:47], v[88:91]
    ds_read_b64_tr_b16 a[18:19], v12 offset:4096
    v_mfma_f32_16x16x32_bf16 v[68:71], a[52:55], a[32:35], v[68:71]
    ds_read_b128 a[4:7], v6 offset:1024
    v_mfma_f32_16x16x32_bf16 v[76:79], a[52:55], a[36:39], v[76:79]
    ds_read_b128 a[8:11], v6 offset:2048
    buffer_load_dwordx4 v2, s[36:39], s56 offen offset:1024 sc1 lds
    v_mfma_f32_16x16x32_bf16 v[84:87], a[52:55], a[40:43], v[84:87]
    ds_read_b128 a[12:15], v6 offset:3072
    v_mfma_f32_16x16x32_bf16 v[92:95], a[52:55], a[44:47], v[92:95]
    ds_read_b64_tr_b16 a[20:21], v13 offset:0
    v_mfma_f32_16x16x32_bf16 v[96:99], a[56:59], a[32:35], v[96:99]
    ds_read_b64_tr_b16 a[22:23], v13 offset:4096
    v_mfma_f32_16x16x32_bf16 v[104:107], a[56:59], a[36:39], v[104:107]
    ds_read_b64_tr_b16 a[24:25], v14 offset:0
    buffer_load_dwordx4 v2, s[36:39], s56 offen offset:2048 sc1 lds
    v_mfma_f32_16x16x32_bf16 v[112:115], a[56:59], a[40:43], v[112:115]
    ds_read_b64_tr_b16 a[26:27], v14 offset:4096
    v_mfma_f32_16x16x32_bf16 v[120:123], a[56:59], a[44:47], v[120:123]
    ds_read_b64_tr_b16 a[28:29], v15 offset:0
    buffer_store_dwordx4 v[140:143], v2, s[8:11], s70 offen offset:3072 sc1
    s_add_u32 s70, s70, 4096
    v_mfma_f32_16x16x32_bf16 v[100:103], a[60:63], a[32:35], v[100:103]
    s_add_u32 s64, s64, 1
    ds_read_b64_tr_b16 a[30:31], v15 offset:4096
    v_mfma_f32_16x16x32_bf16 v[108:111], a[60:63], a[36:39], v[108:111]
    buffer_load_dwordx4 v2, s[36:39], s56 offen offset:3072 sc1 lds
    v_mfma_f32_16x16x32_bf16 v[116:119], a[60:63], a[40:43], v[116:119]
    s_add_u32 s56, s56, 262144
    v_mfma_f32_16x16x32_bf16 v[124:127], a[60:63], a[44:47], v[124:127]
    s_waitcnt lgkmcnt(9)
    v_mfma_f32_16x16x32_bf16 v[64:67], a[16:19], a[0:3], v[64:67]
    s_add_u32 m0, s59, 16384
    ds_read_b128 a[32:35], v6 offset:8192
    s_waitcnt lgkmcnt(9)
    v_mfma_f32_16x16x32_bf16 v[72:75], a[16:19], a[4:7], v[72:75]
    ds_read_b64_tr_b16 a[48:49], v12 offset:8192
    buffer_load_dwordx4 v16, s[24:27], s57 offen offset:0 sc1 lds
    s_waitcnt lgkmcnt(9)
    v_mfma_f32_16x16x32_bf16 v[80:83], a[16:19], a[8:11], v[80:83]
    s_add_u32 s59, s58, s60
    ds_read_b64_tr_b16 a[50:51], v12 offset:12288
    s_waitcnt lgkmcnt(9)
    v_mfma_f32_16x16x32_bf16 v[88:91], a[16:19], a[12:15], v[88:91]
    s_add_u32 s58, s58, 32768
    ds_read_b128 a[36:39], v6 offset:9216
    s_waitcnt lgkmcnt(8)
    v_mfma_f32_16x16x32_bf16 v[68:71], a[20:23], a[0:3], v[68:71]
    s_cmp_ge_u32 s58, 163840
    ds_read_b128 a[40:43], v6 offset:10240
    v_mfma_f32_16x16x32_bf16 v[76:79], a[20:23], a[4:7], v[76:79]
    ds_read_b128 a[44:47], v6 offset:11264
    buffer_load_dwordx4 v17, s[24:27], s57 offen offset:1024 sc1 lds
    v_mfma_f32_16x16x32_bf16 v[84:87], a[20:23], a[8:11], v[84:87]
    s_cselect_b32 s66, 4294836224, s100
    ds_read_b64_tr_b16 a[52:53], v13 offset:8192
    v_mfma_f32_16x16x32_bf16 v[92:95], a[20:23], a[12:15], v[92:95]
    s_cselect_b32 s58, 0, s58
    ds_read_b64_tr_b16 a[54:55], v13 offset:12288
    s_waitcnt lgkmcnt(10)
    v_mfma_f32_16x16x32_bf16 v[96:99], a[24:27], a[0:3], v[96:99]
    ds_read_b64_tr_b16 a[56:57], v14 offset:8192
    v_mfma_f32_16x16x32_bf16 v[104:107], a[24:27], a[4:7], v[104:107]
    ds_read_b64_tr_b16 a[58:59], v14 offset:12288
    buffer_load_dwordx4 v18, s[24:27], s57 offen offset:2048 sc1 lds
    v_mfma_f32_16x16x32_bf16 v[112:115], a[24:27], a[8:11], v[112:115]
    ds_read_b64_tr_b16 a[60:61], v15 offset:8192
    v_mfma_f32_16x16x32_bf16 v[120:123], a[24:27], a[12:15], v[120:123]
    ds_read_b64_tr_b16 a[62:63], v15 offset:12288
    buffer_store_dwordx4 v[144:147], v2, s[8:11], s70 offen offset:0 sc1
    s_waitcnt lgkmcnt(12)
    v_mfma_f32_16x16x32_bf16 v[100:103], a[28:31], a[0:3], v[100:103]
    v_add_u32 v6, s66, v6
    v_add_u32 v12, s66, v12
    v_mfma_f32_16x16x32_bf16 v[108:111], a[28:31], a[4:7], v[108:111]
    buffer_load_dwordx4 v19, s[24:27], s57 offen offset:3072 sc1 lds
    v_mfma_f32_16x16x32_bf16 v[116:119], a[28:31], a[8:11], v[116:119]
    s_add_u32 s57, s57, 131072
    v_add_u32 v13, s66, v13
    v_add_u32 v14, s66, v14
    v_mfma_f32_16x16x32_bf16 v[124:127], a[28:31], a[12:15], v[124:127]
    s_mov_b32 m0, s59
    v_add_u32 v15, s66, v15
    s_waitcnt vmcnt(24) lgkmcnt(0)
    v_mfma_f32_16x16x32_bf16 v[64:67], a[48:51], a[32:35], v[64:67]
    s_barrier
    v_mfma_f32_16x16x32_bf16 v[72:75], a[48:51], a[36:39], v[72:75]
    ds_read_b128 a[0:3], v6 offset:0
    buffer_load_dwordx4 v2, s[36:39], s56 offen offset:0 sc1 lds
    v_mfma_f32_16x16x32_bf16 v[80:83], a[48:51], a[40:43], v[80:83]
    ds_read_b64_tr_b16 a[16:17], v12 offset:0
    v_mfma_f32_16x16x32_bf16 v[88:91], a[48:51], a[44:47], v[88:91]
    ds_read_b64_tr_b16 a[18:19], v12 offset:4096
    v_mfma_f32_16x16x32_bf16 v[68:71], a[52:55], a[32:35], v[68:71]
    ds_read_b128 a[4:7], v6 offset:1024
    v_mfma_f32_16x16x32_bf16 v[76:79], a[52:55], a[36:39], v[76:79]
    ds_read_b128 a[8:11], v6 offset:2048
    buffer_load_dwordx4 v2, s[36:39], s56 offen offset:1024 sc1 lds
    v_mfma_f32_16x16x32_bf16 v[84:87], a[52:55], a[40:43], v[84:87]
    ds_read_b128 a[12:15], v6 offset:3072
    v_mfma_f32_16x16x32_bf16 v[92:95], a[52:55], a[44:47], v[92:95]
    ds_read_b64_tr_b16 a[20:21], v13 offset:0
    v_mfma_f32_16x16x32_bf16 v[96:99], a[56:59], a[32:35], v[96:99]
    ds_read_b64_tr_b16 a[22:23], v13 offset:4096
    v_mfma_f32_16x16x32_bf16 v[104:107], a[56:59], a[36:39], v[104:107]
    ds_read_b64_tr_b16 a[24:25], v14 offset:0
    buffer_load_dwordx4 v2, s[36:39], s56 offen offset:2048 sc1 lds
    v_mfma_f32_16x16x32_bf16 v[112:115], a[56:59], a[40:43], v[112:115]
    ds_read_b64_tr_b16 a[26:27], v14 offset:4096
    v_mfma_f32_16x16x32_bf16 v[120:123], a[56:59], a[44:47], v[120:123]
    ds_read_b64_tr_b16 a[28:29], v15 offset:0
    buffer_store_dwordx4 v[148:151], v2, s[8:11], s70 offen offset:1024 sc1
    v_mfma_f32_16x16x32_bf16 v[100:103], a[60:63], a[32:35], v[100:103]
    s_add_u32 s64, s64, 1
    ds_read_b64_tr_b16 a[30:31], v15 offset:4096
    v_mfma_f32_16x16x32_bf16 v[108:111], a[60:63], a[36:39], v[108:111]
    buffer_load_dwordx4 v2, s[36:39], s56 offen offset:3072 sc1 lds
    v_mfma_f32_16x16x32_bf16 v[116:119], a[60:63], a[40:43], v[116:119]
    s_add_u32 s56, s56, 262144
    v_mfma_f32_16x16x32_bf16 v[124:127], a[60:63], a[44:47], v[124:127]
    s_waitcnt lgkmcnt(9)
    v_mfma_f32_16x16x32_bf16 v[64:67], a[16:19], a[0:3], v[64:67]
    s_add_u32 m0, s59, 16384
    ds_read_b128 a[32:35], v6 offset:8192
    s_waitcnt lgkmcnt(9)
    v_mfma_f32_16x16x32_bf16 v[72:75], a[16:19], a[4:7], v[72:75]
    ds_read_b64_tr_b16 a[48:49], v12 offset:8192
    buffer_load_dwordx4 v16, s[24:27], s57 offen offset:0 sc1 lds
    s_waitcnt lgkmcnt(9)
    v_mfma_f32_16x16x32_bf16 v[80:83], a[16:19], a[8:11], v[80:83]
    s_add_u32 s59, s58, s60
    ds_read_b64_tr_b16 a[50:51], v12 offset:12288
    s_waitcnt lgkmcnt(9)
    v_mfma_f32_16x16x32_bf16 v[88:91], a[16:19], a[12:15], v[88:91]
    s_add_u32 s58, s58, 32768
    ds_read_b128 a[36:39], v6 offset:9216
    s_waitcnt lgkmcnt(8)
    v_mfma_f32_16x16x32_bf16 v[68:71], a[20:23], a[0:3], v[68:71]
    s_cmp_ge_u32 s58, 163840
    ds_read_b128 a[40:43], v6 offset:10240
    v_mfma_f32_16x16x32_bf16 v[76:79], a[20:23], a[4:7], v[76:79]
    ds_read_b128 a[44:47], v6 offset:11264
    buffer_load_dwordx4 v17, s[24:27], s57 offen offset:1024 sc1 lds
    v_mfma_f32_16x16x32_bf16 v[84:87], a[20:23], a[8:11], v[84:87]
    s_cselect_b32 s66, 4294836224, s100
    ds_read_b64_tr_b16 a[52:53], v13 offset:8192
    v_mfma_f32_16x16x32_bf16 v[92:95], a[20:23], a[12:15], v[92:95]
    s_cselect_b32 s58, 0, s58
    ds_read_b64_tr_b16 a[54:55], v13 offset:12288
    s_waitcnt lgkmcnt(10)
    v_mfma_f32_16x16x32_bf16 v[96:99], a[24:27], a[0:3], v[96:99]
    ds_read_b64_tr_b16 a[56:57], v14 offset:8192
    v_mfma_f32_16x16x32_bf16 v[104:107], a[24:27], a[4:7], v[104:107]
    ds_read_b64_tr_b16 a[58:59], v14 offset:12288
    buffer_load_dwordx4 v18, s[24:27], s57 offen offset:2048 sc1 lds
    v_mfma_f32_16x16x32_bf16 v[112:115], a[24:27], a[8:11], v[112:115]
    ds_read_b64_tr_b16 a[60:61], v15 offset:8192
    v_mfma_f32_16x16x32_bf16 v[120:123], a[24:27], a[12:15], v[120:123]
    ds_read_b64_tr_b16 a[62:63], v15 offset:12288
    buffer_store_dwordx4 v[152:155], v2, s[8:11], s70 offen offset:2048 sc1
    s_waitcnt lgkmcnt(12)
    v_mfma_f32_16x16x32_bf16 v[100:103], a[28:31], a[0:3], v[100:103]
    v_add_u32 v6, s66, v6
    v_add_u32 v12, s66, v12
    v_mfma_f32_16x16x32_bf16 v[108:111], a[28:31], a[4:7], v[108:111]
    buffer_load_dwordx4 v19, s[24:27], s57 offen offset:3072 sc1 lds
    v_mfma_f32_16x16x32_bf16 v[116:119], a[28:31], a[8:11], v[116:119]
    s_add_u32 s57, s57, 131072
    v_add_u32 v13, s66, v13
    v_add_u32 v14, s66, v14
    v_mfma_f32_16x16x32_bf16 v[124:127], a[28:31], a[12:15], v[124:127]
    s_mov_b32 m0, s59
    v_add_u32 v15, s66, v15
    s_waitcnt vmcnt(24) lgkmcnt(0)
    v_mfma_f32_16x16x32_bf16 v[64:67], a[48:51], a[32:35], v[64:67]
    s_barrier
    v_mfma_f32_16x16x32_bf16 v[72:75], a[48:51], a[36:39], v[72:75]
    ds_read_b128 a[0:3], v6 offset:0
    buffer_load_dwordx4 v2, s[36:39], s56 offen offset:0 sc1 lds
    v_mfma_f32_16x16x32_bf16 v[80:83], a[48:51], a[40:43], v[80:83]
    ds_read_b64_tr_b16 a[16:17], v12 offset:0
    v_mfma_f32_16x16x32_bf16 v[88:91], a[48:51], a[44:47], v[88:91]
    ds_read_b64_tr_b16 a[18:19], v12 offset:4096
    v_mfma_f32_16x16x32_bf16 v[68:71], a[52:55], a[32:35], v[68:71]
    ds_read_b128 a[4:7], v6 offset:1024
    v_mfma_f32_16x16x32_bf16 v[76:79], a[52:55], a[36:39], v[76:79]
    ds_read_b128 a[8:11], v6 offset:2048
    buffer_load_dwordx4 v2, s[36:39], s56 offen offset:1024 sc1 lds
    v_mfma_f32_16x16x32_bf16 v[84:87], a[52:55], a[40:43], v[84:87]
    ds_read_b128 a[12:15], v6 offset:3072
    v_mfma_f32_16x16x32_bf16 v[92:95], a[52:55], a[44:47], v[92:95]
    ds_read_b64_tr_b16 a[20:21], v13 offset:0
    v_mfma_f32_16x16x32_bf16 v[96:99], a[56:59], a[32:35], v[96:99]
    ds_read_b64_tr_b16 a[22:23], v13 offset:4096
    v_mfma_f32_16x16x32_bf16 v[104:107], a[56:59], a[36:39], v[104:107]
    ds_read_b64_tr_b16 a[24:25], v14 offset:0
    buffer_load_dwordx4 v2, s[36:39], s56 offen offset:2048 sc1 lds
    v_mfma_f32_16x16x32_bf16 v[112:115], a[56:59], a[40:43], v[112:115]
    ds_read_b64_tr_b16 a[26:27], v14 offset:4096
    v_mfma_f32_16x16x32_bf16 v[120:123], a[56:59], a[44:47], v[120:123]
    ds_read_b64_tr_b16 a[28:29], v15 offset:0
    buffer_store_dwordx4 v[156:159], v2, s[8:11], s70 offen offset:3072 sc1
    s_add_u32 s70, s70, 4096
    v_mfma_f32_16x16x32_bf16 v[100:103], a[60:63], a[32:35], v[100:103]
    s_add_u32 s64, s64, 1
    ds_read_b64_tr_b16 a[30:31], v15 offset:4096
    v_mfma_f32_16x16x32_bf16 v[108:111], a[60:63], a[36:39], v[108:111]
    buffer_load_dwordx4 v2, s[36:39], s56 offen offset:3072 sc1 lds
    v_mfma_f32_16x16x32_bf16 v[116:119], a[60:63], a[40:43], v[116:119]
    s_add_u32 s56, s56, 262144
    v_mfma_f32_16x16x32_bf16 v[124:127], a[60:63], a[44:47], v[124:127]
    s_mov_b32 s67, 32
    s_branch m_l3147
m_n178:
    s_cmp_lg_u32 s64, 32
    s_cbranch_scc1 m_n179
    s_lshl_b32 s91, s96, 3
    s_add_u32 s91, s91, s97
    s_lshl_b32 s91, s91, 7
    s_add_u32 s91, s91, 16384
    s_cmp_lg_u32 s16, 0
    s_cbranch_scc1 m_np180
    v_mov_b32 v60, s4
    v_mov_b32 v61, s5
    s_add_u32 s90, s91, 117440512
    s_mov_b64 exec, 1
    buffer_store_dwordx2 v[60:61], off, s[8:11], s90 sc1
    s_mov_b64 exec, -1
m_np180:
    s_mov_b32 s67, 35
    s_branch m_l3147
m_n179:
    s_cmp_lg_u32 s64, 35
    s_cbranch_scc1 m_n181
    s_mov_b32 s38, 0
    s_mov_b32 s67, 40
    s_branch m_l3147
m_n181:
    s_branch m_l3x149
m_l3c150:
    s_mov_b32 s67, 34
    s_cmp_lt_u32 s64, 34
    s_cbranch_scc1 m_l3n151
    s_cmp_lg_u32 s64, 34
    s_cbranch_scc1 m_n183
    s_mov_b32 s68, 1000
    s_mov_b32 s67, 35
    s_branch m_l3147
m_n183:
    s_cmp_lg_u32 s64, 35
    s_cbranch_scc1 m_n184
    s_mov_b32 s38, 0
    s_lshl_b32 s91, s96, 3
    s_add_u32 s91, s91, s97
    s_lshl_b32 s91, s91, 7
    s_add_u32 s91, s91, 16384
    s_add_u32 s52, s91, 117440512
    buffer_load_dwordx2 v[4:5], off, s[8:11], s52 sc1
    s_mov_b32 s67, 36
    s_branch m_l3147
m_n184:
    s_cmp_lg_u32 s64, 36
    s_cbranch_scc1 m_n185
    s_mov_b32 s26, 0
    s_mov_b32 s67, 37
    s_branch m_l3147
m_n185:
    s_cmp_lg_u32 s64, 37
    s_cbranch_scc1 m_n186
    s_waitcnt vmcnt(16)
    s_mov_b32 s3, 262144
m_spin187:
    v_cmp_ne_u64 s[76:77], s[4:5], v[4:5]
    s_nop 3
    s_cmp_eq_u64 s[76:77], 0
    s_cbranch_scc1 m_ok188
    s_sub_u32 s3, s3, 1
    s_cbranch_scc1 m_ok188
    s_sleep 8
    buffer_load_dwordx2 v[4:5], off, s[8:11], s52 sc1
    s_waitcnt vmcnt(0)
    s_branch m_spin187
m_ok188:
    s_lshl_b32 s90, s96, 3
    s_add_u32 s90, s90, s97
    s_lshl_b32 s90, s90, 15
    s_lshl_b32 s91, s16, 13
    s_add_u32 s90, s90, s91
    s_add_u32 s70, s90, 100663296
    buffer_load_dwordx4 v[128:131], v2, s[8:11], s70 offen offset:0 sc1
    buffer_load_dwordx4 v[132:135], v2, s[8:11], s70 offen offset:1024 sc1
    buffer_load_dwordx4 v[136:139], v2, s[8:11], s70 offen offset:2048 sc1
    buffer_load_dwordx4 v[140:143], v2, s[8:11], s70 offen offset:3072 sc1
    s_add_u32 s70, s70, 4096
    buffer_load_dwordx4 v[144:147], v2, s[8:11], s70 offen offset:0 sc1
    buffer_load_dwordx4 v[148:151], v2, s[8:11], s70 offen offset:1024 sc1
    buffer_load_dwordx4 v[152:155], v2, s[8:11], s70 offen offset:2048 sc1
    buffer_load_dwordx4 v[156:159], v2, s[8:11], s70 offen offset:3072 sc1
    s_mov_b32 s67, 40
    s_branch m_l3147
m_n186:
    s_branch m_l3x149
m_o1171:
    s_and_b32 s91, s2, 7
    s_lshl_b32 s91, s91, 5
    s_lshr_b32 s92, s2, 3
    s_add_u32 s91, s91, s92
    s_lshl_b32 s91, s91, 3
    s_add_u32 s91, s91, 12288
    s_cmp_lg_u32 s16, 0
    s_cbranch_scc1 m_np190
    v_mov_b32 v60, s4
    v_mov_b32 v61, s5
    s_add_u32 s90, s91, 117440512
    s_mov_b64 exec, 1
    buffer_store_dwordx2 v[60:61], off, s[8:11], s90 sc1
    s_mov_b64 exec, -1
m_np190:
    s_branch m_o2172
m_l3n151:
    s_sub_u32 s90, s68, 5
    s_min_u32 s67, s67, s90
    s_branch m_l3147
m_l3x149:
    s_cmp_eq_u32 s95, 1
    s_cbranch_scc1 m_noadd191
    s_waitcnt vmcnt(0)
    v_lshlrev_b32 v160, 16, v128
    v_and_b32 v161, 0xffff0000, v128
    v_lshlrev_b32 v162, 16, v129
    v_and_b32 v163, 0xffff0000, v129
    v_lshlrev_b32 v164, 16, v130
    v_and_b32 v165, 0xffff0000, v130
    v_lshlrev_b32 v166, 16, v131
    v_and_b32 v167, 0xffff0000, v131
    v_lshlrev_b32 v168, 16, v132
    v_and_b32 v169, 0xffff0000, v132
    v_lshlrev_b32 v170, 16, v133
    v_and_b32 v171, 0xffff0000, v133
    v_lshlrev_b32 v172, 16, v134
    v_and_b32 v173, 0xffff0000, v134
    v_lshlrev_b32 v174, 16, v135
    v_and_b32 v175, 0xffff0000, v135
    v_lshlrev_b32 v176, 16, v136
    v_and_b32 v177, 0xffff0000, v136
    v_lshlrev_b32 v178, 16, v137
    v_and_b32 v179, 0xffff0000, v137
    v_lshlrev_b32 v180, 16, v138
    v_and_b32 v181, 0xffff0000, v138
    v_lshlrev_b32 v182, 16, v139
    v_and_b32 v183, 0xffff0000, v139
    v_lshlrev_b32 v184, 16, v140
    v_and_b32 v185, 0xffff0000, v140
    v_lshlrev_b32 v186, 16, v141
    v_and_b32 v187, 0xffff0000, v141
    v_lshlrev_b32 v188, 16, v142
    v_and_b32 v189, 0xffff0000, v142
    v_lshlrev_b32 v190, 16, v143
    v_and_b32 v191, 0xffff0000, v143
    v_lshlrev_b32 v192, 16, v144
    v_and_b32 v193, 0xffff0000, v144
    v_lshlrev_b32 v194, 16, v145
    v_and_b32 v195, 0xffff0000, v145
    v_lshlrev_b32 v196, 16, v146
    v_and_b32 v197, 0xffff0000, v146
    v_lshlrev_b32 v198, 16, v147
    v_and_b32 v199, 0xffff0000, v147
    v_lshlrev_b32 v200, 16, v148
    v_and_b32 v201, 0xffff0000, v148
    v_lshlrev_b32 v202, 16, v149
    v_and_b32 v203, 0xffff0000, v149
    v_lshlrev_b32 v204, 16, v150
    v_and_b32 v205, 0xffff0000, v150
    v_lshlrev_b32 v206, 16, v151
    v_and_b32 v207, 0xffff0000, v151
    v_lshlrev_b32 v208, 16, v152
    v_and_b32 v209, 0xffff0000, v152
    v_lshlrev_b32 v210, 16, v153
    v_and_b32 v211, 0xffff0000, v153
    v_lshlrev_b32 v212, 16, v154
    v_and_b32 v213, 0xffff0000, v154
    v_lshlrev_b32 v214, 16, v155
    v_and_b32 v215, 0xffff0000, v155
    v_lshlrev_b32 v216, 16, v156
    v_and_b32 v217, 0xffff0000, v156
    v_lshlrev_b32 v218, 16, v157
    v_and_b32 v219, 0xffff0000, v157
    v_lshlrev_b32 v220, 16, v158
    v_and_b32 v221, 0xffff0000, v158
    v_lshlrev_b32 v222, 16, v159
    v_and_b32 v223, 0xffff0000, v159
    v_pk_add_f32 v[64:65], v[64:65], v[160:161]
    v_pk_add_f32 v[66:67], v[66:67], v[162:163]
    v_pk_add_f32 v[68:69], v[68:69], v[164:165]
    v_pk_add_f32 v[70:71], v[70:71], v[166:167]
    v_pk_add_f32 v[72:73], v[72:73], v[168:169]
    v_pk_add_f32 v[74:75], v[74:75], v[170:171]
    v_pk_add_f32 v[76:77], v[76:77], v[172:173]
    v_pk_add_f32 v[78:79], v[78:79], v[174:175]
    v_pk_add_f32 v[80:81], v[80:81], v[176:177]
    v_pk_add_f32 v[82:83], v[82:83], v[178:179]
    v_pk_add_f32 v[84:85], v[84:85], v[180:181]
    v_pk_add_f32 v[86:87], v[86:87], v[182:183]
    v_pk_add_f32 v[88:89], v[88:89], v[184:185]
    v_pk_add_f32 v[90:91], v[90:91], v[186:187]
    v_pk_add_f32 v[92:93], v[92:93], v[188:189]
    v_pk_add_f32 v[94:95], v[94:95], v[190:191]
    v_pk_add_f32 v[96:97], v[96:97], v[192:193]
    v_pk_add_f32 v[98:99], v[98:99], v[194:195]
    v_pk_add_f32 v[100:101], v[100:101], v[196:197]
    v_pk_add_f32 v[102:103], v[102:103], v[198:199]
    v_pk_add_f32 v[104:105], v[104:105], v[200:201]
    v_pk_add_f32 v[106:107], v[106:107], v[202:203]
    v_pk_add_f32 v[108:109], v[108:109], v[204:205]
    v_pk_add_f32 v[110:111], v[110:111], v[206:207]
    v_pk_add_f32 v[112:113], v[112:113], v[208:209]
    v_pk_add_f32 v[114:115], v[114:115], v[210:211]
    v_pk_add_f32 v[116:117], v[116:117], v[212:213]
    v_pk_add_f32 v[118:119], v[118:119], v[214:215]
    v_pk_add_f32 v[120:121], v[120:121], v[216:217]
    v_pk_add_f32 v[122:123], v[122:123], v[218:219]
    v_pk_add_f32 v[124:125], v[124:125], v[220:221]
    v_pk_add_f32 v[126:127], v[126:127], v[222:223]
m_noadd191:
    v_cvt_pk_bf16_f32 v64, v64, v65
    v_cvt_pk_bf16_f32 v65, v66, v67
    v_cvt_pk_bf16_f32 v66, v68, v69
    v_cvt_pk_bf16_f32 v67, v70, v71
    v_cvt_pk_bf16_f32 v96, v96, v97
    v_cvt_pk_bf16_f32 v97, v98, v99
    v_cvt_pk_bf16_f32 v98, v100, v101
    v_cvt_pk_bf16_f32 v99, v102, v103
    s_nop 1
    v_permlane16_swap_b32 v64, v66
    v_permlane16_swap_b32 v65, v67
    v_permlane16_swap_b32 v96, v98
    v_permlane16_swap_b32 v97, v99
    buffer_store_dwordx4 v[64:67], v7, s[28:31], s71 offen offset:0 sc1
    buffer_store_dwordx4 v[96:99], v7, s[28:31], s71 offen offset:64 sc1
    s_add_u32 s71, s71, s72
    v_cvt_pk_bf16_f32 v72, v72, v73
    v_cvt_pk_bf16_f32 v73, v74, v75
    v_cvt_pk_bf16_f32 v74, v76, v77
    v_cvt_pk_bf16_f32 v75, v78, v79
    v_cvt_pk_bf16_f32 v104, v104, v105
    v_cvt_pk_bf16_f32 v105, v106, v107
    v_cvt_pk_bf16_f32 v106, v108, v109
    v_cvt_pk_bf16_f32 v107, v110, v111
    s_nop 1
    v_permlane16_swap_b32 v72, v74
    v_permlane16_swap_b32 v73, v75
    v_permlane16_swap_b32 v104, v106
    v_permlane16_swap_b32 v105, v107
    buffer_store_dwordx4 v[72:75], v7, s[28:31], s71 offen offset:0 sc1
    buffer_store_dwordx4 v[104:107], v7, s[28:31], s71 offen offset:64 sc1
    s_add_u32 s71, s71, s72
    v_cvt_pk_bf16_f32 v80, v80, v81
    v_cvt_pk_bf16_f32 v81, v82, v83
    v_cvt_pk_bf16_f32 v82, v84, v85
    v_cvt_pk_bf16_f32 v83, v86, v87
    v_cvt_pk_bf16_f32 v112, v112, v113
    v_cvt_pk_bf16_f32 v113, v114, v115
    v_cvt_pk_bf16_f32 v114, v116, v117
    v_cvt_pk_bf16_f32 v115, v118, v119
    s_nop 1
    v_permlane16_swap_b32 v80, v82
    v_permlane16_swap_b32 v81, v83
    v_permlane16_swap_b32 v112, v114
    v_permlane16_swap_b32 v113, v115
    buffer_store_dwordx4 v[80:83], v7, s[28:31], s71 offen offset:0 sc1
    buffer_store_dwordx4 v[112:115], v7, s[28:31], s71 offen offset:64 sc1
    s_add_u32 s71, s71, s72
    v_cvt_pk_bf16_f32 v88, v88, v89
    v_cvt_pk_bf16_f32 v89, v90, v91
    v_cvt_pk_bf16_f32 v90, v92, v93
    v_cvt_pk_bf16_f32 v91, v94, v95
    v_cvt_pk_bf16_f32 v120, v120, v121
    v_cvt_pk_bf16_f32 v121, v122, v123
    v_cvt_pk_bf16_f32 v122, v124, v125
    v_cvt_pk_bf16_f32 v123, v126, v127
    s_nop 1
    v_permlane16_swap_b32 v88, v90
    v_permlane16_swap_b32 v89, v91
    v_permlane16_swap_b32 v120, v122
    v_permlane16_swap_b32 v121, v123
    buffer_store_dwordx4 v[88:91], v7, s[28:31], s71 offen offset:0 sc1
    buffer_store_dwordx4 v[120:123], v7, s[28:31], s71 offen offset:64 sc1
    s_add_u32 s71, s71, s72
m_end1:
    s_endpgm
m_stub94:
    v_cmp_lt_f32 vcc, s65, v8
    s_cmp_lg_u32 s64, s67
    s_cbranch_scc1 m_e193
    v_add_f32 v176, v176, v16
    v_mov_b32 v180, v9
    v_add_f32 v188, v188, v16
    v_add_f32 v177, v177, v17
    v_mov_b32 v181, v9
    v_add_f32 v189, v189, v17
    v_add_f32 v178, v178, v18
    v_mov_b32 v182, v9
    v_add_f32 v190, v190, v18
    v_add_f32 v179, v179, v19
    v_mov_b32 v183, v9
    v_add_f32 v191, v191, v19
    s_nop 0
m_e193:
    s_cmp_lg_u32 s64, s68
    s_cbranch_scc1 m_e194
    v_mov_b32 v176, v9
    v_mov_b32 v184, v9
    v_mov_b32 v188, v9
    v_mov_b32 v180, v9
    v_mov_b32 v177, v9
    v_mov_b32 v185, v9
    v_mov_b32 v189, v9
    v_mov_b32 v181, v9
    v_mov_b32 v178, v9
    v_mov_b32 v186, v9
    v_mov_b32 v190, v9
    v_mov_b32 v182, v9
    v_mov_b32 v179, v9
    v_mov_b32 v187, v9
    v_mov_b32 v191, v9
    v_mov_b32 v183, v9
    s_nop 0
m_e194:
    s_cbranch_vccnz m_rc195
m_sp192:
    s_branch m_ret95
m_stub97:
    v_cmp_lt_f32 vcc, s65, v8
    s_cmp_lg_u32 s64, s67
    s_cbranch_scc1 m_e197
    v_add_f32 v176, v176, v16
    v_mov_b32 v180, v9
    v_add_f32 v188, v188, v16
    v_add_f32 v177, v177, v17
    v_mov_b32 v181, v9
    v_add_f32 v189, v189, v17
    v_add_f32 v178, v178, v18
    v_mov_b32 v182, v9
    v_add_f32 v190, v190, v18
    v_add_f32 v179, v179, v19
    v_mov_b32 v183, v9
    v_add_f32 v191, v191, v19
    s_nop 0
m_e197:
    s_cmp_lg_u32 s64, s68
    s_cbranch_scc1 m_e198
    v_mov_b32 v176, v9
    v_mov_b32 v184, v9
    v_mov_b32 v188, v9
    v_mov_b32 v180, v9
    v_mov_b32 v177, v9
    v_mov_b32 v185, v9
    v_mov_b32 v189, v9
    v_mov_b32 v181, v9
    v_mov_b32 v178, v9
    v_mov_b32 v186, v9
    v_mov_b32 v190, v9
    v_mov_b32 v182, v9
    v_mov_b32 v179, v9
    v_mov_b32 v187, v9
    v_mov_b32 v191, v9
    v_mov_b32 v183, v9
    s_nop 0
m_e198:
    s_cbranch_vccnz m_rc199
m_sp196:
    s_branch m_ret98
m_stub115:
    v_cmp_lt_f32 vcc, s65, v8
    s_cmp_lg_u32 s64, s70
    s_cbranch_scc1 m_e201
    v_add_f32 v160, v160, v16
    v_mov_b32 v164, v9
    v_add_f32 v172, v172, v16
    v_add_f32 v161, v161, v17
    v_mov_b32 v165, v9
    v_add_f32 v173, v173, v17
    v_add_f32 v162, v162, v18
    v_mov_b32 v166, v9
    v_add_f32 v174, v174, v18
    v_add_f32 v163, v163, v19
    v_mov_b32 v167, v9
    v_add_f32 v175, v175, v19
    s_nop 0
m_e201:
    s_cmp_lg_u32 s64, s71
    s_cbranch_scc1 m_e202
    v_mov_b32 v160, v9
    v_mov_b32 v168, v9
    v_mov_b32 v172, v9
    v_mov_b32 v164, v9
    v_mov_b32 v161, v9
    v_mov_b32 v169, v9
    v_mov_b32 v173, v9
    v_mov_b32 v165, v9
    v_mov_b32 v162, v9
    v_mov_b32 v170, v9
    v_mov_b32 v174, v9
    v_mov_b32 v166, v9
    v_mov_b32 v163, v9
    v_mov_b32 v171, v9
    v_mov_b32 v175, v9
    v_mov_b32 v167, v9
    s_nop 0
m_e202:
    s_cbranch_vccnz m_rc203
m_sp200:
    s_branch m_ret116
m_stub117:
    v_cmp_lt_f32 vcc, s65, v8
    s_cmp_lg_u32 s64, s70
    s_cbranch_scc1 m_e205
    v_add_f32 v160, v160, v16
    v_mov_b32 v164, v9
    v_add_f32 v172, v172, v16
    v_add_f32 v161, v161, v17
    v_mov_b32 v165, v9
    v_add_f32 v173, v173, v17
    v_add_f32 v162, v162, v18
    v_mov_b32 v166, v9
    v_add_f32 v174, v174, v18
    v_add_f32 v163, v163, v19
    v_mov_b32 v167, v9
    v_add_f32 v175, v175, v19
    s_nop 0
m_e205:
    s_cmp_lg_u32 s64, s71
    s_cbranch_scc1 m_e206
    v_mov_b32 v160, v9
    v_mov_b32 v168, v9
    v_mov_b32 v172, v9
    v_mov_b32 v164, v9
    v_mov_b32 v161, v9
    v_mov_b32 v169, v9
    v_mov_b32 v173, v9
    v_mov_b32 v165, v9
    v_mov_b32 v162, v9
    v_mov_b32 v170, v9
    v_mov_b32 v174, v9
    v_mov_b32 v166, v9
    v_mov_b32 v163, v9
    v_mov_b32 v171, v9
    v_mov_b32 v175, v9
    v_mov_b32 v167, v9
    s_nop 0
m_e206:
    s_cmp_lg_u32 s64, s53
    s_cbranch_scc1 m_e209
    s_cmp_lg_u32 s16, 0
    s_cbranch_scc1 m_np210
    v_mov_b32 v60, s4
    v_mov_b32 v61, s5
    s_add_u32 s90, s101, 117440512
    s_mov_b64 exec, 1
    buffer_store_dwordx2 v[60:61], off, s[8:11], s90 sc1
    s_mov_b64 exec, -1
m_np210:
    s_mov_b32 s101, -1
m_e209:
    s_cmp_gt_u32 s64, 24
    s_cbranch_scc1 m_e207
    s_cmp_lg_u32 s64, 8
    s_cbranch_scc1 m_e211
    s_lshr_b32 s90, s32, 1
    s_lshl_b32 s90, s90, 7
    s_add_u32 s90, s90, 117440600
    v_min_u32 v0, 1, v1
    v_lshlrev_b32 v0, 5, v0
    buffer_load_dwordx2 v[4:5], v0, s[8:11], s90 offen sc1
    s_cmp_eq_u32 s17, -1
    s_cbranch_scc1 m_e207
    s_cmp_lg_u32 s16, 0
    s_cbranch_scc1 m_np212
    v_mov_b32 v60, s4
    v_mov_b32 v61, s5
    s_add_u32 s90, s17, 117440512
    s_mov_b64 exec, 1
    buffer_store_dwordx2 v[60:61], off, s[8:11], s90 sc1
    s_mov_b64 exec, -1
m_np212:
    s_branch m_e207
m_e211:
    s_cmp_lg_u32 s64, 16
    s_cbranch_scc1 m_e213
    s_waitcnt vmcnt(18)
    s_mov_b32 s3, 262144
m_spin214:
    v_cmp_ne_u64 s[76:77], s[4:5], v[4:5]
    s_nop 3
    s_cmp_eq_u64 s[76:77], 0
    s_cbranch_scc1 m_e207
    s_sub_u32 s3, s3, 1
    s_cbranch_scc1 m_e207
    s_sleep 32
    s_lshr_b32 s90, s32, 1
    s_lshl_b32 s90, s90, 7
    s_add_u32 s90, s90, 117440600
    v_min_u32 v0, 1, v1
    v_lshlrev_b32 v0, 5, v0
    buffer_load_dwordx2 v[4:5], v0, s[8:11], s90 offen sc1
    s_waitcnt vmcnt(0)
    s_branch m_spin214
    s_branch m_e207
m_e213:
    s_cmp_lg_u32 s64, 20
    s_cbranch_scc1 m_e215
    buffer_load_dwordx2 v[4:5], v10, s[8:11], 0 offen sc1
    s_mov_b32 s44, s48
    s_mov_b32 s45, s49
    s_mov_b32 s46, 8388608
    s_lshl_b32 s90, s2, 2
    s_add_u32 s90, s90, s16
    s_lshl_b32 s90, s90, 13
    v_lshlrev_b32 v62, 7, v1
    buffer_load_dword v255, v62, s[44:47], s90 offen
    s_branch m_e207
m_e215:
    s_cmp_lg_u32 s64, 24
    s_cbranch_scc1 m_e216
    s_mov_b32 s44, s50
    s_mov_b32 s45, s51
    s_mov_b32 s46, 2097152
    s_lshl_b32 s90, s2, 2
    s_add_u32 s90, s90, s16
    s_lshl_b32 s90, s90, 13
    v_lshlrev_b32 v62, 7, v1
    buffer_load_dword v255, v62, s[44:47], s90 offen
    s_waitcnt vmcnt(18)
    s_mov_b32 s3, 262144
m_spin217:
    v_cmp_ne_u64 s[76:77], s[4:5], v[4:5]
    s_nop 3
    s_cmp_eq_u64 s[76:77], 0
    s_cbranch_scc1 m_e207
    s_sub_u32 s3, s3, 1
    s_cbranch_scc1 m_e207
    s_sleep 32
    buffer_load_dwordx2 v[4:5], v10, s[8:11], 0 offen sc1
    s_waitcnt vmcnt(0)
    s_branch m_spin217
    s_branch m_e207
m_e216:
m_e207:
    s_cbranch_vccnz m_rc218
m_sp204:
    s_branch m_ret118
m_stub121:
    v_cmp_lt_f32 vcc, s65, v8
    s_cmp_lg_u32 s64, s70
    s_cbranch_scc1 m_e220
    v_add_f32 v160, v160, v16
    v_mov_b32 v164, v9
    v_add_f32 v172, v172, v16
    v_add_f32 v161, v161, v17
    v_mov_b32 v165, v9
    v_add_f32 v173, v173, v17
    v_add_f32 v162, v162, v18
    v_mov_b32 v166, v9
    v_add_f32 v174, v174, v18
    v_add_f32 v163, v163, v19
    v_mov_b32 v167, v9
    v_add_f32 v175, v175, v19
    s_nop 0
m_e220:
    s_cmp_lg_u32 s64, s71
    s_cbranch_scc1 m_e221
    v_mov_b32 v160, v9
    v_mov_b32 v168, v9
    v_mov_b32 v172, v9
    v_mov_b32 v164, v9
    v_mov_b32 v161, v9
    v_mov_b32 v169, v9
    v_mov_b32 v173, v9
    v_mov_b32 v165, v9
    v_mov_b32 v162, v9
    v_mov_b32 v170, v9
    v_mov_b32 v174, v9
    v_mov_b32 v166, v9
    v_mov_b32 v163, v9
    v_mov_b32 v171, v9
    v_mov_b32 v175, v9
    v_mov_b32 v167, v9
    s_nop 0
m_e221:
    s_cbranch_vccnz m_rc222
m_sp219:
    s_branch m_ret122
m_stub138:
    v_cmp_lt_f32 vcc, s65, v8
    s_cbranch_vccnz m_rc224
m_sp223:
    s_branch m_ret139
m_rc114:
    s_call_b64 s[74:75], m_rs0488
    s_branch m_sp99
m_rc137:
    s_call_b64 s[74:75], m_rs0287
    s_branch m_sp123
m_rc195:
    s_call_b64 s[74:75], m_rs0488
    s_branch m_sp192
m_rc199:
    s_call_b64 s[74:75], m_rs1490
    s_branch m_sp196
m_rc203:
    s_call_b64 s[74:75], m_rs1490
    s_branch m_sp200
m_rc218:
    s_call_b64 s[74:75], m_rs0287
    s_branch m_sp204
m_rc222:
    s_call_b64 s[74:75], m_rs1289
    s_branch m_sp219
m_rc224:
    s_call_b64 s[74:75], m_rs1289
    s_branch m_sp223
m_rs0287:
    s_nop 15
    v_max3_f32 v48, v64, v65, v66
    v_max3_f32 v48, v48, v67, v68
    v_max3_f32 v48, v48, v69, v70
    v_max3_f32 v48, v48, v71, 0
    v_mov_b32 v49, v48
    s_nop 1
    v_permlane32_swap_b32 v48, v49
    s_nop 1
    v_max_f32 v48, v48, v49
    v_mov_b32 v49, v48
    s_nop 1
    v_permlane16_swap_b32 v48, v49
    s_nop 1
    v_max_f32 v48, v48, v49
    v_exp_f32 v49, -v48
    v_sub_f32 v64, v64, v48
    v_sub_f32 v65, v65, v48
    v_sub_f32 v66, v66, v48
    v_sub_f32 v67, v67, v48
    v_sub_f32 v68, v68, v48
    v_sub_f32 v69, v69, v48
    v_sub_f32 v70, v70, v48
    v_sub_f32 v71, v71, v48
    v_sub_f32 v96, v96, v48
    v_sub_f32 v97, v97, v48
    v_sub_f32 v98, v98, v48
    v_sub_f32 v99, v99, v48
    v_sub_f32 v100, v100, v48
    v_sub_f32 v101, v101, v48
    v_sub_f32 v102, v102, v48
    v_sub_f32 v103, v103, v48
    v_sub_f32 v160, v160, v48
    v_sub_f32 v161, v161, v48
    v_sub_f32 v162, v162, v48
    v_sub_f32 v163, v163, v48
    v_sub_f32 v164, v164, v48
    v_sub_f32 v165, v165, v48
    v_sub_f32 v166, v166, v48
    v_sub_f32 v167, v167, v48
    v_mul_f32 v12, v12, v49
    v_accvgpr_read_b32 v52, a0
    v_accvgpr_read_b32 v53, a1
    v_accvgpr_read_b32 v54, a2
    v_accvgpr_read_b32 v55, a3
    v_accvgpr_read_b32 v56, a4
    v_accvgpr_read_b32 v57, a5
    v_accvgpr_read_b32 v58, a6
    v_accvgpr_read_b32 v59, a7
    v_mul_f32 v52, v52, v49
    v_mul_f32 v53, v53, v49
    v_mul_f32 v54, v54, v49
    v_mul_f32 v55, v55, v49
    v_mul_f32 v56, v56, v49
    v_mul_f32 v57, v57, v49
    v_mul_f32 v58, v58, v49
    v_mul_f32 v59, v59, v49
    v_accvgpr_write_b32 a0, v52
    v_accvgpr_write_b32 a1, v53
    v_accvgpr_write_b32 a2, v54
    v_accvgpr_write_b32 a3, v55
    v_accvgpr_write_b32 a4, v56
    v_accvgpr_write_b32 a5, v57
    v_accvgpr_write_b32 a6, v58
    v_accvgpr_write_b32 a7, v59
    v_accvgpr_read_b32 v52, a8
    v_accvgpr_read_b32 v53, a9
    v_accvgpr_read_b32 v54, a10
    v_accvgpr_read_b32 v55, a11
    v_accvgpr_read_b32 v56, a12
    v_accvgpr_read_b32 v57, a13
    v_accvgpr_read_b32 v58, a14
    v_accvgpr_read_b32 v59, a15
    v_mul_f32 v52, v52, v49
    v_mul_f32 v53, v53, v49
    v_mul_f32 v54, v54, v49
    v_mul_f32 v55, v55, v49
    v_mul_f32 v56, v56, v49
    v_mul_f32 v57, v57, v49
    v_mul_f32 v58, v58, v49
    v_mul_f32 v59, v59, v49
    v_accvgpr_write_b32 a8, v52
    v_accvgpr_write_b32 a9, v53
    v_accvgpr_write_b32 a10, v54
    v_accvgpr_write_b32 a11, v55
    v_accvgpr_write_b32 a12, v56
    v_accvgpr_write_b32 a13, v57
    v_accvgpr_write_b32 a14, v58
    v_accvgpr_write_b32 a15, v59
    v_accvgpr_read_b32 v52, a16
    v_accvgpr_read_b32 v53, a17
    v_accvgpr_read_b32 v54, a18
    v_accvgpr_read_b32 v55, a19
    v_accvgpr_read_b32 v56, a20
    v_accvgpr_read_b32 v57, a21
    v_accvgpr_read_b32 v58, a22
    v_accvgpr_read_b32 v59, a23
    v_mul_f32 v52, v52, v49
    v_mul_f32 v53, v53, v49
    v_mul_f32 v54, v54, v49
    v_mul_f32 v55, v55, v49
    v_mul_f32 v56, v56, v49
    v_mul_f32 v57, v57, v49
    v_mul_f32 v58, v58, v49
    v_mul_f32 v59, v59, v49
    v_accvgpr_write_b32 a16, v52
    v_accvgpr_write_b32 a17, v53
    v_accvgpr_write_b32 a18, v54
    v_accvgpr_write_b32 a19, v55
    v_accvgpr_write_b32 a20, v56
    v_accvgpr_write_b32 a21, v57
    v_accvgpr_write_b32 a22, v58
    v_accvgpr_write_b32 a23, v59
    v_accvgpr_read_b32 v52, a24
    v_accvgpr_read_b32 v53, a25
    v_accvgpr_read_b32 v54, a26
    v_accvgpr_read_b32 v55, a27
    v_accvgpr_read_b32 v56, a28
    v_accvgpr_read_b32 v57, a29
    v_accvgpr_read_b32 v58, a30
    v_accvgpr_read_b32 v59, a31
    v_mul_f32 v52, v52, v49
    v_mul_f32 v53, v53, v49
    v_mul_f32 v54, v54, v49
    v_mul_f32 v55, v55, v49
    v_mul_f32 v56, v56, v49
    v_mul_f32 v57, v57, v49
    v_mul_f32 v58, v58, v49
    v_mul_f32 v59, v59, v49
    v_accvgpr_write_b32 a24, v52
    v_accvgpr_write_b32 a25, v53
    v_accvgpr_write_b32 a26, v54
    v_accvgpr_write_b32 a27, v55
    v_accvgpr_write_b32 a28, v56
    v_accvgpr_write_b32 a29, v57
    v_accvgpr_write_b32 a30, v58
    v_accvgpr_write_b32 a31, v59
    v_exp_f32 v52, v64
    v_exp_f32 v53, v65
    v_exp_f32 v54, v66
    v_exp_f32 v55, v67
    v_exp_f32 v56, v68
    v_exp_f32 v57, v69
    v_exp_f32 v58, v70
    v_exp_f32 v59, v71
    s_nop 0
    v_cvt_pk_bf16_f32 v128, v52, v53
    v_cvt_pk_bf16_f32 v129, v54, v55
    v_cvt_pk_bf16_f32 v130, v56, v57
    v_cvt_pk_bf16_f32 v131, v58, v59
    s_nop 1
    v_mfma_f32_16x16x32_bf16 v[28:31], v[44:47], v[128:131], 0
    v_max3_f32 v48, v72, v73, v74
    v_max3_f32 v48, v48, v75, v76
    v_max3_f32 v48, v48, v77, v78
    v_max3_f32 v48, v48, v79, 0
    v_mov_b32 v49, v48
    s_nop 1
    v_permlane32_swap_b32 v48, v49
    s_nop 1
    v_max_f32 v48, v48, v49
    v_mov_b32 v49, v48
    s_nop 1
    v_permlane16_swap_b32 v48, v49
    s_nop 1
    v_max_f32 v48, v48, v49
    v_exp_f32 v49, -v48
    v_sub_f32 v72, v72, v48
    v_sub_f32 v73, v73, v48
    v_sub_f32 v74, v74, v48
    v_sub_f32 v75, v75, v48
    v_sub_f32 v76, v76, v48
    v_sub_f32 v77, v77, v48
    v_sub_f32 v78, v78, v48
    v_sub_f32 v79, v79, v48
    v_sub_f32 v104, v104, v48
    v_sub_f32 v105, v105, v48
    v_sub_f32 v106, v106, v48
    v_sub_f32 v107, v107, v48
    v_sub_f32 v108, v108, v48
    v_sub_f32 v109, v109, v48
    v_sub_f32 v110, v110, v48
    v_sub_f32 v111, v111, v48
    v_sub_f32 v168, v168, v48
    v_sub_f32 v169, v169, v48
    v_sub_f32 v170, v170, v48
    v_sub_f32 v171, v171, v48
    v_sub_f32 v172, v172, v48
    v_sub_f32 v173, v173, v48
    v_sub_f32 v174, v174, v48
    v_sub_f32 v175, v175, v48
    v_mul_f32 v13, v13, v49
    v_accvgpr_read_b32 v52, a32
    v_accvgpr_read_b32 v53, a33
    v_accvgpr_read_b32 v54, a34
    v_accvgpr_read_b32 v55, a35
    v_accvgpr_read_b32 v56, a36
    v_accvgpr_read_b32 v57, a37
    v_accvgpr_read_b32 v58, a38
    v_accvgpr_read_b32 v59, a39
    v_mul_f32 v52, v52, v49
    v_mul_f32 v53, v53, v49
    v_mul_f32 v54, v54, v49
    v_mul_f32 v55, v55, v49
    v_mul_f32 v56, v56, v49
    v_mul_f32 v57, v57, v49
    v_mul_f32 v58, v58, v49
    v_mul_f32 v59, v59, v49
    v_accvgpr_write_b32 a32, v52
    v_accvgpr_write_b32 a33, v53
    v_accvgpr_write_b32 a34, v54
    v_accvgpr_write_b32 a35, v55
    v_accvgpr_write_b32 a36, v56
    v_accvgpr_write_b32 a37, v57
    v_accvgpr_write_b32 a38, v58
    v_accvgpr_write_b32 a39, v59
    v_accvgpr_read_b32 v52, a40
    v_accvgpr_read_b32 v53, a41
    v_accvgpr_read_b32 v54, a42
    v_accvgpr_read_b32 v55, a43
    v_accvgpr_read_b32 v56, a44
    v_accvgpr_read_b32 v57, a45
    v_accvgpr_read_b32 v58, a46
    v_accvgpr_read_b32 v59, a47
    v_mul_f32 v52, v52, v49
    v_mul_f32 v53, v53, v49
    v_mul_f32 v54, v54, v49
    v_mul_f32 v55, v55, v49
    v_mul_f32 v56, v56, v49
    v_mul_f32 v57, v57, v49
    v_mul_f32 v58, v58, v49
    v_mul_f32 v59, v59, v49
    v_accvgpr_write_b32 a40, v52
    v_accvgpr_write_b32 a41, v53
    v_accvgpr_write_b32 a42, v54
    v_accvgpr_write_b32 a43, v55
    v_accvgpr_write_b32 a44, v56
    v_accvgpr_write_b32 a45, v57
    v_accvgpr_write_b32 a46, v58
    v_accvgpr_write_b32 a47, v59
    v_accvgpr_read_b32 v52, a48
    v_accvgpr_read_b32 v53, a49
    v_accvgpr_read_b32 v54, a50
    v_accvgpr_read_b32 v55, a51
    v_accvgpr_read_b32 v56, a52
    v_accvgpr_read_b32 v57, a53
    v_accvgpr_read_b32 v58, a54
    v_accvgpr_read_b32 v59, a55
    v_mul_f32 v52, v52, v49
    v_mul_f32 v53, v53, v49
    v_mul_f32 v54, v54, v49
    v_mul_f32 v55, v55, v49
    v_mul_f32 v56, v56, v49
    v_mul_f32 v57, v57, v49
    v_mul_f32 v58, v58, v49
    v_mul_f32 v59, v59, v49
    v_accvgpr_write_b32 a48, v52
    v_accvgpr_write_b32 a49, v53
    v_accvgpr_write_b32 a50, v54
    v_accvgpr_write_b32 a51, v55
    v_accvgpr_write_b32 a52, v56
    v_accvgpr_write_b32 a53, v57
    v_accvgpr_write_b32 a54, v58
    v_accvgpr_write_b32 a55, v59
    v_accvgpr_read_b32 v52, a56
    v_accvgpr_read_b32 v53, a57
    v_accvgpr_read_b32 v54, a58
    v_accvgpr_read_b32 v55, a59
    v_accvgpr_read_b32 v56, a60
    v_accvgpr_read_b32 v57, a61
    v_accvgpr_read_b32 v58, a62
    v_accvgpr_read_b32 v59, a63
    v_mul_f32 v52, v52, v49
    v_mul_f32 v53, v53, v49
    v_mul_f32 v54, v54, v49
    v_mul_f32 v55, v55, v49
    v_mul_f32 v56, v56, v49
    v_mul_f32 v57, v57, v49
    v_mul_f32 v58, v58, v49
    v_mul_f32 v59, v59, v49
    v_accvgpr_write_b32 a56, v52
    v_accvgpr_write_b32 a57, v53
    v_accvgpr_write_b32 a58, v54
    v_accvgpr_write_b32 a59, v55
    v_accvgpr_write_b32 a60, v56
    v_accvgpr_write_b32 a61, v57
    v_accvgpr_write_b32 a62, v58
    v_accvgpr_write_b32 a63, v59
    v_exp_f32 v52, v72
    v_exp_f32 v53, v73
    v_exp_f32 v54, v74
    v_exp_f32 v55, v75
    v_exp_f32 v56, v76
    v_exp_f32 v57, v77
    v_exp_f32 v58, v78
    v_exp_f32 v59, v79
    s_nop 0
    v_cvt_pk_bf16_f32 v132, v52, v53
    v_cvt_pk_bf16_f32 v133, v54, v55
    v_cvt_pk_bf16_f32 v134, v56, v57
    v_cvt_pk_bf16_f32 v135, v58, v59
    s_nop 1
    v_mfma_f32_16x16x32_bf16 v[32:35], v[44:47], v[132:135], 0
    s_nop 7
    s_setpc_b64 s[74:75]
m_rs0488:
    s_nop 15
    v_max3_f32 v48, v64, v65, v66
    v_max3_f32 v48, v48, v67, v68
    v_max3_f32 v48, v48, v69, v70
    v_max3_f32 v48, v48, v71, 0
    v_mov_b32 v49, v48
    s_nop 1
    v_permlane32_swap_b32 v48, v49
    s_nop 1
    v_max_f32 v48, v48, v49
    v_mov_b32 v49, v48
    s_nop 1
    v_permlane16_swap_b32 v48, v49
    s_nop 1
    v_max_f32 v48, v48, v49
    v_exp_f32 v49, -v48
    v_sub_f32 v64, v64, v48
    v_sub_f32 v65, v65, v48
    v_sub_f32 v66, v66, v48
    v_sub_f32 v67, v67, v48
    v_sub_f32 v68, v68, v48
    v_sub_f32 v69, v69, v48
    v_sub_f32 v70, v70, v48
    v_sub_f32 v71, v71, v48
    v_sub_f32 v96, v96, v48
    v_sub_f32 v97, v97, v48
    v_sub_f32 v98, v98, v48
    v_sub_f32 v99, v99, v48
    v_sub_f32 v100, v100, v48
    v_sub_f32 v101, v101, v48
    v_sub_f32 v102, v102, v48
    v_sub_f32 v103, v103, v48
    v_sub_f32 v160, v160, v48
    v_sub_f32 v161, v161, v48
    v_sub_f32 v162, v162, v48
    v_sub_f32 v163, v163, v48
    v_sub_f32 v164, v164, v48
    v_sub_f32 v165, v165, v48
    v_sub_f32 v166, v166, v48
    v_sub_f32 v167, v167, v48
    v_mul_f32 v12, v12, v49
    v_accvgpr_read_b32 v52, a0
    v_accvgpr_read_b32 v53, a1
    v_accvgpr_read_b32 v54, a2
    v_accvgpr_read_b32 v55, a3
    v_accvgpr_read_b32 v56, a4
    v_accvgpr_read_b32 v57, a5
    v_accvgpr_read_b32 v58, a6
    v_accvgpr_read_b32 v59, a7
    v_mul_f32 v52, v52, v49
    v_mul_f32 v53, v53, v49
    v_mul_f32 v54, v54, v49
    v_mul_f32 v55, v55, v49
    v_mul_f32 v56, v56, v49
    v_mul_f32 v57, v57, v49
    v_mul_f32 v58, v58, v49
    v_mul_f32 v59, v59, v49
    v_accvgpr_write_b32 a0, v52
    v_accvgpr_write_b32 a1, v53
    v_accvgpr_write_b32 a2, v54
    v_accvgpr_write_b32 a3, v55
    v_accvgpr_write_b32 a4, v56
    v_accvgpr_write_b32 a5, v57
    v_accvgpr_write_b32 a6, v58
    v_accvgpr_write_b32 a7, v59
    v_accvgpr_read_b32 v52, a8
    v_accvgpr_read_b32 v53, a9
    v_accvgpr_read_b32 v54, a10
    v_accvgpr_read_b32 v55, a11
    v_accvgpr_read_b32 v56, a12
    v_accvgpr_read_b32 v57, a13
    v_accvgpr_read_b32 v58, a14
    v_accvgpr_read_b32 v59, a15
    v_mul_f32 v52, v52, v49
    v_mul_f32 v53, v53, v49
    v_mul_f32 v54, v54, v49
    v_mul_f32 v55, v55, v49
    v_mul_f32 v56, v56, v49
    v_mul_f32 v57, v57, v49
    v_mul_f32 v58, v58, v49
    v_mul_f32 v59, v59, v49
    v_accvgpr_write_b32 a8, v52
    v_accvgpr_write_b32 a9, v53
    v_accvgpr_write_b32 a10, v54
    v_accvgpr_write_b32 a11, v55
    v_accvgpr_write_b32 a12, v56
    v_accvgpr_write_b32 a13, v57
    v_accvgpr_write_b32 a14, v58
    v_accvgpr_write_b32 a15, v59
    v_accvgpr_read_b32 v52, a16
    v_accvgpr_read_b32 v53, a17
    v_accvgpr_read_b32 v54, a18
    v_accvgpr_read_b32 v55, a19
    v_accvgpr_read_b32 v56, a20
    v_accvgpr_read_b32 v57, a21
    v_accvgpr_read_b32 v58, a22
    v_accvgpr_read_b32 v59, a23
    v_mul_f32 v52, v52, v49
    v_mul_f32 v53, v53, v49
    v_mul_f32 v54, v54, v49
    v_mul_f32 v55, v55, v49
    v_mul_f32 v56, v56, v49
    v_mul_f32 v57, v57, v49
    v_mul_f32 v58, v58, v49
    v_mul_f32 v59, v59, v49
    v_accvgpr_write_b32 a16, v52
    v_accvgpr_write_b32 a17, v53
    v_accvgpr_write_b32 a18, v54
    v_accvgpr_write_b32 a19, v55
    v_accvgpr_write_b32 a20, v56
    v_accvgpr_write_b32 a21, v57
    v_accvgpr_write_b32 a22, v58
    v_accvgpr_write_b32 a23, v59
    v_accvgpr_read_b32 v52, a24
    v_accvgpr_read_b32 v53, a25
    v_accvgpr_read_b32 v54, a26
    v_accvgpr_read_b32 v55, a27
    v_accvgpr_read_b32 v56, a28
    v_accvgpr_read_b32 v57, a29
    v_accvgpr_read_b32 v58, a30
    v_accvgpr_read_b32 v59, a31
    v_mul_f32 v52, v52, v49
    v_mul_f32 v53, v53, v49
    v_mul_f32 v54, v54, v49
    v_mul_f32 v55, v55, v49
    v_mul_f32 v56, v56, v49
    v_mul_f32 v57, v57, v49
    v_mul_f32 v58, v58, v49
    v_mul_f32 v59, v59, v49
    v_accvgpr_write_b32 a24, v52
    v_accvgpr_write_b32 a25, v53
    v_accvgpr_write_b32 a26, v54
    v_accvgpr_write_b32 a27, v55
    v_accvgpr_write_b32 a28, v56
    v_accvgpr_write_b32 a29, v57
    v_accvgpr_write_b32 a30, v58
    v_accvgpr_write_b32 a31, v59
    v_exp_f32 v52, v64
    v_exp_f32 v53, v65
    v_exp_f32 v54, v66
    v_exp_f32 v55, v67
    v_exp_f32 v56, v68
    v_exp_f32 v57, v69
    v_exp_f32 v58, v70
    v_exp_f32 v59, v71
    s_nop 0
    v_cvt_pk_bf16_f32 v128, v52, v53
    v_cvt_pk_bf16_f32 v129, v54, v55
    v_cvt_pk_bf16_f32 v130, v56, v57
    v_cvt_pk_bf16_f32 v131, v58, v59
    s_nop 1
    v_mfma_f32_16x16x32_bf16 v[28:31], v[44:47], v[128:131], 0
    v_max3_f32 v48, v72, v73, v74
    v_max3_f32 v48, v48, v75, v76
    v_max3_f32 v48, v48, v77, v78
    v_max3_f32 v48, v48, v79, 0
    v_mov_b32 v49, v48
    s_nop 1
    v_permlane32_swap_b32 v48, v49
    s_nop 1
    v_max_f32 v48, v48, v49
    v_mov_b32 v49, v48
    s_nop 1
    v_permlane16_swap_b32 v48, v49
    s_nop 1
    v_max_f32 v48, v48, v49
    v_exp_f32 v49, -v48
    v_sub_f32 v72, v72, v48
    v_sub_f32 v73, v73, v48
    v_sub_f32 v74, v74, v48
    v_sub_f32 v75, v75, v48
    v_sub_f32 v76, v76, v48
    v_sub_f32 v77, v77, v48
    v_sub_f32 v78, v78, v48
    v_sub_f32 v79, v79, v48
    v_sub_f32 v104, v104, v48
    v_sub_f32 v105, v105, v48
    v_sub_f32 v106, v106, v48
    v_sub_f32 v107, v107, v48
    v_sub_f32 v108, v108, v48
    v_sub_f32 v109, v109, v48
    v_sub_f32 v110, v110, v48
    v_sub_f32 v111, v111, v48
    v_sub_f32 v168, v168, v48
    v_sub_f32 v169, v169, v48
    v_sub_f32 v170, v170, v48
    v_sub_f32 v171, v171, v48
    v_sub_f32 v172, v172, v48
    v_sub_f32 v173, v173, v48
    v_sub_f32 v174, v174, v48
    v_sub_f32 v175, v175, v48
    v_mul_f32 v13, v13, v49
    v_accvgpr_read_b32 v52, a32
    v_accvgpr_read_b32 v53, a33
    v_accvgpr_read_b32 v54, a34
    v_accvgpr_read_b32 v55, a35
    v_accvgpr_read_b32 v56, a36
    v_accvgpr_read_b32 v57, a37
    v_accvgpr_read_b32 v58, a38
    v_accvgpr_read_b32 v59, a39
    v_mul_f32 v52, v52, v49
    v_mul_f32 v53, v53, v49
    v_mul_f32 v54, v54, v49
    v_mul_f32 v55, v55, v49
    v_mul_f32 v56, v56, v49
    v_mul_f32 v57, v57, v49
    v_mul_f32 v58, v58, v49
    v_mul_f32 v59, v59, v49
    v_accvgpr_write_b32 a32, v52
    v_accvgpr_write_b32 a33, v53
    v_accvgpr_write_b32 a34, v54
    v_accvgpr_write_b32 a35, v55
    v_accvgpr_write_b32 a36, v56
    v_accvgpr_write_b32 a37, v57
    v_accvgpr_write_b32 a38, v58
    v_accvgpr_write_b32 a39, v59
    v_accvgpr_read_b32 v52, a40
    v_accvgpr_read_b32 v53, a41
    v_accvgpr_read_b32 v54, a42
    v_accvgpr_read_b32 v55, a43
    v_accvgpr_read_b32 v56, a44
    v_accvgpr_read_b32 v57, a45
    v_accvgpr_read_b32 v58, a46
    v_accvgpr_read_b32 v59, a47
    v_mul_f32 v52, v52, v49
    v_mul_f32 v53, v53, v49
    v_mul_f32 v54, v54, v49
    v_mul_f32 v55, v55, v49
    v_mul_f32 v56, v56, v49
    v_mul_f32 v57, v57, v49
    v_mul_f32 v58, v58, v49
    v_mul_f32 v59, v59, v49
    v_accvgpr_write_b32 a40, v52
    v_accvgpr_write_b32 a41, v53
    v_accvgpr_write_b32 a42, v54
    v_accvgpr_write_b32 a43, v55
    v_accvgpr_write_b32 a44, v56
    v_accvgpr_write_b32 a45, v57
    v_accvgpr_write_b32 a46, v58
    v_accvgpr_write_b32 a47, v59
    v_accvgpr_read_b32 v52, a48
    v_accvgpr_read_b32 v53, a49
    v_accvgpr_read_b32 v54, a50
    v_accvgpr_read_b32 v55, a51
    v_accvgpr_read_b32 v56, a52
    v_accvgpr_read_b32 v57, a53
    v_accvgpr_read_b32 v58, a54
    v_accvgpr_read_b32 v59, a55
    v_mul_f32 v52, v52, v49
    v_mul_f32 v53, v53, v49
    v_mul_f32 v54, v54, v49
    v_mul_f32 v55, v55, v49
    v_mul_f32 v56, v56, v49
    v_mul_f32 v57, v57, v49
    v_mul_f32 v58, v58, v49
    v_mul_f32 v59, v59, v49
    v_accvgpr_write_b32 a48, v52
    v_accvgpr_write_b32 a49, v53
    v_accvgpr_write_b32 a50, v54
    v_accvgpr_write_b32 a51, v55
    v_accvgpr_write_b32 a52, v56
    v_accvgpr_write_b32 a53, v57
    v_accvgpr_write_b32 a54, v58
    v_accvgpr_write_b32 a55, v59
    v_accvgpr_read_b32 v52, a56
    v_accvgpr_read_b32 v53, a57
    v_accvgpr_read_b32 v54, a58
    v_accvgpr_read_b32 v55, a59
    v_accvgpr_read_b32 v56, a60
    v_accvgpr_read_b32 v57, a61
    v_accvgpr_read_b32 v58, a62
    v_accvgpr_read_b32 v59, a63
    v_mul_f32 v52, v52, v49
    v_mul_f32 v53, v53, v49
    v_mul_f32 v54, v54, v49
    v_mul_f32 v55, v55, v49
    v_mul_f32 v56, v56, v49
    v_mul_f32 v57, v57, v49
    v_mul_f32 v58, v58, v49
    v_mul_f32 v59, v59, v49
    v_accvgpr_write_b32 a56, v52
    v_accvgpr_write_b32 a57, v53
    v_accvgpr_write_b32 a58, v54
    v_accvgpr_write_b32 a59, v55
    v_accvgpr_write_b32 a60, v56
    v_accvgpr_write_b32 a61, v57
    v_accvgpr_write_b32 a62, v58
    v_accvgpr_write_b32 a63, v59
    v_exp_f32 v52, v72
    v_exp_f32 v53, v73
    v_exp_f32 v54, v74
    v_exp_f32 v55, v75
    v_exp_f32 v56, v76
    v_exp_f32 v57, v77
    v_exp_f32 v58, v78
    v_exp_f32 v59, v79
    s_nop 0
    v_cvt_pk_bf16_f32 v132, v52, v53
    v_cvt_pk_bf16_f32 v133, v54, v55
    v_cvt_pk_bf16_f32 v134, v56, v57
    v_cvt_pk_bf16_f32 v135, v58, v59
    s_nop 1
    v_mfma_f32_16x16x32_bf16 v[32:35], v[44:47], v[132:135], 0
    v_max3_f32 v48, v80, v81, v82
    v_max3_f32 v48, v48, v83, v84
    v_max3_f32 v48, v48, v85, v86
    v_max3_f32 v48, v48, v87, 0
    v_mov_b32 v49, v48
    s_nop 1
    v_permlane32_swap_b32 v48, v49
    s_nop 1
    v_max_f32 v48, v48, v49
    v_mov_b32 v49, v48
    s_nop 1
    v_permlane16_swap_b32 v48, v49
    s_nop 1
    v_max_f32 v48, v48, v49
    v_exp_f32 v49, -v48
    v_sub_f32 v80, v80, v48
    v_sub_f32 v81, v81, v48
    v_sub_f32 v82, v82, v48
    v_sub_f32 v83, v83, v48
    v_sub_f32 v84, v84, v48
    v_sub_f32 v85, v85, v48
    v_sub_f32 v86, v86, v48
    v_sub_f32 v87, v87, v48
    v_sub_f32 v112, v112, v48
    v_sub_f32 v113, v113, v48
    v_sub_f32 v114, v114, v48
    v_sub_f32 v115, v115, v48
    v_sub_f32 v116, v116, v48
    v_sub_f32 v117, v117, v48
    v_sub_f32 v118, v118, v48
    v_sub_f32 v119, v119, v48
    v_sub_f32 v176, v176, v48
    v_sub_f32 v177, v177, v48
    v_sub_f32 v178, v178, v48
    v_sub_f32 v179, v179, v48
    v_sub_f32 v180, v180, v48
    v_sub_f32 v181, v181, v48
    v_sub_f32 v182, v182, v48
    v_sub_f32 v183, v183, v48
    v_mul_f32 v14, v14, v49
    v_accvgpr_read_b32 v52, a64
    v_accvgpr_read_b32 v53, a65
    v_accvgpr_read_b32 v54, a66
    v_accvgpr_read_b32 v55, a67
    v_accvgpr_read_b32 v56, a68
    v_accvgpr_read_b32 v57, a69
    v_accvgpr_read_b32 v58, a70
    v_accvgpr_read_b32 v59, a71
    v_mul_f32 v52, v52, v49
    v_mul_f32 v53, v53, v49
    v_mul_f32 v54, v54, v49
    v_mul_f32 v55, v55, v49
    v_mul_f32 v56, v56, v49
    v_mul_f32 v57, v57, v49
    v_mul_f32 v58, v58, v49
    v_mul_f32 v59, v59, v49
    v_accvgpr_write_b32 a64, v52
    v_accvgpr_write_b32 a65, v53
    v_accvgpr_write_b32 a66, v54
    v_accvgpr_write_b32 a67, v55
    v_accvgpr_write_b32 a68, v56
    v_accvgpr_write_b32 a69, v57
    v_accvgpr_write_b32 a70, v58
    v_accvgpr_write_b32 a71, v59
    v_accvgpr_read_b32 v52, a72
    v_accvgpr_read_b32 v53, a73
    v_accvgpr_read_b32 v54, a74
    v_accvgpr_read_b32 v55, a75
    v_accvgpr_read_b32 v56, a76
    v_accvgpr_read_b32 v57, a77
    v_accvgpr_read_b32 v58, a78
    v_accvgpr_read_b32 v59, a79
    v_mul_f32 v52, v52, v49
    v_mul_f32 v53, v53, v49
    v_mul_f32 v54, v54, v49
    v_mul_f32 v55, v55, v49
    v_mul_f32 v56, v56, v49
    v_mul_f32 v57, v57, v49
    v_mul_f32 v58, v58, v49
    v_mul_f32 v59, v59, v49
    v_accvgpr_write_b32 a72, v52
    v_accvgpr_write_b32 a73, v53
    v_accvgpr_write_b32 a74, v54
    v_accvgpr_write_b32 a75, v55
    v_accvgpr_write_b32 a76, v56
    v_accvgpr_write_b32 a77, v57
    v_accvgpr_write_b32 a78, v58
    v_accvgpr_write_b32 a79, v59
    v_accvgpr_read_b32 v52, a80
    v_accvgpr_read_b32 v53, a81
    v_accvgpr_read_b32 v54, a82
    v_accvgpr_read_b32 v55, a83
    v_accvgpr_read_b32 v56, a84
    v_accvgpr_read_b32 v57, a85
    v_accvgpr_read_b32 v58, a86
    v_accvgpr_read_b32 v59, a87
    v_mul_f32 v52, v52, v49
    v_mul_f32 v53, v53, v49
    v_mul_f32 v54, v54, v49
    v_mul_f32 v55, v55, v49
    v_mul_f32 v56, v56, v49
    v_mul_f32 v57, v57, v49
    v_mul_f32 v58, v58, v49
    v_mul_f32 v59, v59, v49
    v_accvgpr_write_b32 a80, v52
    v_accvgpr_write_b32 a81, v53
    v_accvgpr_write_b32 a82, v54
    v_accvgpr_write_b32 a83, v55
    v_accvgpr_write_b32 a84, v56
    v_accvgpr_write_b32 a85, v57
    v_accvgpr_write_b32 a86, v58
    v_accvgpr_write_b32 a87, v59
    v_accvgpr_read_b32 v52, a88
    v_accvgpr_read_b32 v53, a89
    v_accvgpr_read_b32 v54, a90
    v_accvgpr_read_b32 v55, a91
    v_accvgpr_read_b32 v56, a92
    v_accvgpr_read_b32 v57, a93
    v_accvgpr_read_b32 v58, a94
    v_accvgpr_read_b32 v59, a95
    v_mul_f32 v52, v52, v49
    v_mul_f32 v53, v53, v49
    v_mul_f32 v54, v54, v49
    v_mul_f32 v55, v55, v49
    v_mul_f32 v56, v56, v49
    v_mul_f32 v57, v57, v49
    v_mul_f32 v58, v58, v49
    v_mul_f32 v59, v59, v49
    v_accvgpr_write_b32 a88, v52
    v_accvgpr_write_b32 a89, v53
    v_accvgpr_write_b32 a90, v54
    v_accvgpr_write_b32 a91, v55
    v_accvgpr_write_b32 a92, v56
    v_accvgpr_write_b32 a93, v57
    v_accvgpr_write_b32 a94, v58
    v_accvgpr_write_b32 a95, v59
    v_exp_f32 v52, v80
    v_exp_f32 v53, v81
    v_exp_f32 v54, v82
    v_exp_f32 v55, v83
    v_exp_f32 v56, v84
    v_exp_f32 v57, v85
    v_exp_f32 v58, v86
    v_exp_f32 v59, v87
    s_nop 0
    v_cvt_pk_bf16_f32 v136, v52, v53
    v_cvt_pk_bf16_f32 v137, v54, v55
    v_cvt_pk_bf16_f32 v138, v56, v57
    v_cvt_pk_bf16_f32 v139, v58, v59
    s_nop 1
    v_mfma_f32_16x16x32_bf16 v[36:39], v[44:47], v[136:139], 0
    v_max3_f32 v48, v88, v89, v90
    v_max3_f32 v48, v48, v91, v92
    v_max3_f32 v48, v48, v93, v94
    v_max3_f32 v48, v48, v95, 0
    v_mov_b32 v49, v48
    s_nop 1
    v_permlane32_swap_b32 v48, v49
    s_nop 1
    v_max_f32 v48, v48, v49
    v_mov_b32 v49, v48
    s_nop 1
    v_permlane16_swap_b32 v48, v49
    s_nop 1
    v_max_f32 v48, v48, v49
    v_exp_f32 v49, -v48
    v_sub_f32 v88, v88, v48
    v_sub_f32 v89, v89, v48
    v_sub_f32 v90, v90, v48
    v_sub_f32 v91, v91, v48
    v_sub_f32 v92, v92, v48
    v_sub_f32 v93, v93, v48
    v_sub_f32 v94, v94, v48
    v_sub_f32 v95, v95, v48
    v_sub_f32 v120, v120, v48
    v_sub_f32 v121, v121, v48
    v_sub_f32 v122, v122, v48
    v_sub_f32 v123, v123, v48
    v_sub_f32 v124, v124, v48
    v_sub_f32 v125, v125, v48
    v_sub_f32 v126, v126, v48
    v_sub_f32 v127, v127, v48
    v_sub_f32 v184, v184, v48
    v_sub_f32 v185, v185, v48
    v_sub_f32 v186, v186, v48
    v_sub_f32 v187, v187, v48
    v_sub_f32 v188, v188, v48
    v_sub_f32 v189, v189, v48
    v_sub_f32 v190, v190, v48
    v_sub_f32 v191, v191, v48
    v_mul_f32 v15, v15, v49
    v_accvgpr_read_b32 v52, a96
    v_accvgpr_read_b32 v53, a97
    v_accvgpr_read_b32 v54, a98
    v_accvgpr_read_b32 v55, a99
    v_accvgpr_read_b32 v56, a100
    v_accvgpr_read_b32 v57, a101
    v_accvgpr_read_b32 v58, a102
    v_accvgpr_read_b32 v59, a103
    v_mul_f32 v52, v52, v49
    v_mul_f32 v53, v53, v49
    v_mul_f32 v54, v54, v49
    v_mul_f32 v55, v55, v49
    v_mul_f32 v56, v56, v49
    v_mul_f32 v57, v57, v49
    v_mul_f32 v58, v58, v49
    v_mul_f32 v59, v59, v49
    v_accvgpr_write_b32 a96, v52
    v_accvgpr_write_b32 a97, v53
    v_accvgpr_write_b32 a98, v54
    v_accvgpr_write_b32 a99, v55
    v_accvgpr_write_b32 a100, v56
    v_accvgpr_write_b32 a101, v57
    v_accvgpr_write_b32 a102, v58
    v_accvgpr_write_b32 a103, v59
    v_accvgpr_read_b32 v52, a104
    v_accvgpr_read_b32 v53, a105
    v_accvgpr_read_b32 v54, a106
    v_accvgpr_read_b32 v55, a107
    v_accvgpr_read_b32 v56, a108
    v_accvgpr_read_b32 v57, a109
    v_accvgpr_read_b32 v58, a110
    v_accvgpr_read_b32 v59, a111
    v_mul_f32 v52, v52, v49
    v_mul_f32 v53, v53, v49
    v_mul_f32 v54, v54, v49
    v_mul_f32 v55, v55, v49
    v_mul_f32 v56, v56, v49
    v_mul_f32 v57, v57, v49
    v_mul_f32 v58, v58, v49
    v_mul_f32 v59, v59, v49
    v_accvgpr_write_b32 a104, v52
    v_accvgpr_write_b32 a105, v53
    v_accvgpr_write_b32 a106, v54
    v_accvgpr_write_b32 a107, v55
    v_accvgpr_write_b32 a108, v56
    v_accvgpr_write_b32 a109, v57
    v_accvgpr_write_b32 a110, v58
    v_accvgpr_write_b32 a111, v59
    v_accvgpr_read_b32 v52, a112
    v_accvgpr_read_b32 v53, a113
    v_accvgpr_read_b32 v54, a114
    v_accvgpr_read_b32 v55, a115
    v_accvgpr_read_b32 v56, a116
    v_accvgpr_read_b32 v57, a117
    v_accvgpr_read_b32 v58, a118
    v_accvgpr_read_b32 v59, a119
    v_mul_f32 v52, v52, v49
    v_mul_f32 v53, v53, v49
    v_mul_f32 v54, v54, v49
    v_mul_f32 v55, v55, v49
    v_mul_f32 v56, v56, v49
    v_mul_f32 v57, v57, v49
    v_mul_f32 v58, v58, v49
    v_mul_f32 v59, v59, v49
    v_accvgpr_write_b32 a112, v52
    v_accvgpr_write_b32 a113, v53
    v_accvgpr_write_b32 a114, v54
    v_accvgpr_write_b32 a115, v55
    v_accvgpr_write_b32 a116, v56
    v_accvgpr_write_b32 a117, v57
    v_accvgpr_write_b32 a118, v58
    v_accvgpr_write_b32 a119, v59
    v_accvgpr_read_b32 v52, a120
    v_accvgpr_read_b32 v53, a121
    v_accvgpr_read_b32 v54, a122
    v_accvgpr_read_b32 v55, a123
    v_accvgpr_read_b32 v56, a124
    v_accvgpr_read_b32 v57, a125
    v_accvgpr_read_b32 v58, a126
    v_accvgpr_read_b32 v59, a127
    v_mul_f32 v52, v52, v49
    v_mul_f32 v53, v53, v49
    v_mul_f32 v54, v54, v49
    v_mul_f32 v55, v55, v49
    v_mul_f32 v56, v56, v49
    v_mul_f32 v57, v57, v49
    v_mul_f32 v58, v58, v49
    v_mul_f32 v59, v59, v49
    v_accvgpr_write_b32 a120, v52
    v_accvgpr_write_b32 a121, v53
    v_accvgpr_write_b32 a122, v54
    v_accvgpr_write_b32 a123, v55
    v_accvgpr_write_b32 a124, v56
    v_accvgpr_write_b32 a125, v57
    v_accvgpr_write_b32 a126, v58
    v_accvgpr_write_b32 a127, v59
    v_exp_f32 v52, v88
    v_exp_f32 v53, v89
    v_exp_f32 v54, v90
    v_exp_f32 v55, v91
    v_exp_f32 v56, v92
    v_exp_f32 v57, v93
    v_exp_f32 v58, v94
    v_exp_f32 v59, v95
    s_nop 0
    v_cvt_pk_bf16_f32 v140, v52, v53
    v_cvt_pk_bf16_f32 v141, v54, v55
    v_cvt_pk_bf16_f32 v142, v56, v57
    v_cvt_pk_bf16_f32 v143, v58, v59
    s_nop 1
    v_mfma_f32_16x16x32_bf16 v[40:43], v[44:47], v[140:143], 0
    s_nop 7
    s_setpc_b64 s[74:75]
m_rs1289:
    s_nop 15
    v_max3_f32 v48, v96, v97, v98
    v_max3_f32 v48, v48, v99, v100
    v_max3_f32 v48, v48, v101, v102
    v_max3_f32 v48, v48, v103, 0
    v_mov_b32 v49, v48
    s_nop 1
    v_permlane32_swap_b32 v48, v49
    s_nop 1
    v_max_f32 v48, v48, v49
    v_mov_b32 v49, v48
    s_nop 1
    v_permlane16_swap_b32 v48, v49
    s_nop 1
    v_max_f32 v48, v48, v49
    v_exp_f32 v49, -v48
    v_sub_f32 v96, v96, v48
    v_sub_f32 v97, v97, v48
    v_sub_f32 v98, v98, v48
    v_sub_f32 v99, v99, v48
    v_sub_f32 v100, v100, v48
    v_sub_f32 v101, v101, v48
    v_sub_f32 v102, v102, v48
    v_sub_f32 v103, v103, v48
    v_sub_f32 v64, v64, v48
    v_sub_f32 v65, v65, v48
    v_sub_f32 v66, v66, v48
    v_sub_f32 v67, v67, v48
    v_sub_f32 v68, v68, v48
    v_sub_f32 v69, v69, v48
    v_sub_f32 v70, v70, v48
    v_sub_f32 v71, v71, v48
    v_sub_f32 v160, v160, v48
    v_sub_f32 v161, v161, v48
    v_sub_f32 v162, v162, v48
    v_sub_f32 v163, v163, v48
    v_sub_f32 v164, v164, v48
    v_sub_f32 v165, v165, v48
    v_sub_f32 v166, v166, v48
    v_sub_f32 v167, v167, v48
    v_mul_f32 v12, v12, v49
    v_accvgpr_read_b32 v52, a0
    v_accvgpr_read_b32 v53, a1
    v_accvgpr_read_b32 v54, a2
    v_accvgpr_read_b32 v55, a3
    v_accvgpr_read_b32 v56, a4
    v_accvgpr_read_b32 v57, a5
    v_accvgpr_read_b32 v58, a6
    v_accvgpr_read_b32 v59, a7
    v_mul_f32 v52, v52, v49
    v_mul_f32 v53, v53, v49
    v_mul_f32 v54, v54, v49
    v_mul_f32 v55, v55, v49
    v_mul_f32 v56, v56, v49
    v_mul_f32 v57, v57, v49
    v_mul_f32 v58, v58, v49
    v_mul_f32 v59, v59, v49
    v_accvgpr_write_b32 a0, v52
    v_accvgpr_write_b32 a1, v53
    v_accvgpr_write_b32 a2, v54
    v_accvgpr_write_b32 a3, v55
    v_accvgpr_write_b32 a4, v56
    v_accvgpr_write_b32 a5, v57
    v_accvgpr_write_b32 a6, v58
    v_accvgpr_write_b32 a7, v59
    v_accvgpr_read_b32 v52, a8
    v_accvgpr_read_b32 v53, a9
    v_accvgpr_read_b32 v54, a10
    v_accvgpr_read_b32 v55, a11
    v_accvgpr_read_b32 v56, a12
    v_accvgpr_read_b32 v57, a13
    v_accvgpr_read_b32 v58, a14
    v_accvgpr_read_b32 v59, a15
    v_mul_f32 v52, v52, v49
    v_mul_f32 v53, v53, v49
    v_mul_f32 v54, v54, v49
    v_mul_f32 v55, v55, v49
    v_mul_f32 v56, v56, v49
    v_mul_f32 v57, v57, v49
    v_mul_f32 v58, v58, v49
    v_mul_f32 v59, v59, v49
    v_accvgpr_write_b32 a8, v52
    v_accvgpr_write_b32 a9, v53
    v_accvgpr_write_b32 a10, v54
    v_accvgpr_write_b32 a11, v55
    v_accvgpr_write_b32 a12, v56
    v_accvgpr_write_b32 a13, v57
    v_accvgpr_write_b32 a14, v58
    v_accvgpr_write_b32 a15, v59
    v_accvgpr_read_b32 v52, a16
    v_accvgpr_read_b32 v53, a17
    v_accvgpr_read_b32 v54, a18
    v_accvgpr_read_b32 v55, a19
    v_accvgpr_read_b32 v56, a20
    v_accvgpr_read_b32 v57, a21
    v_accvgpr_read_b32 v58, a22
    v_accvgpr_read_b32 v59, a23
    v_mul_f32 v52, v52, v49
    v_mul_f32 v53, v53, v49
    v_mul_f32 v54, v54, v49
    v_mul_f32 v55, v55, v49
    v_mul_f32 v56, v56, v49
    v_mul_f32 v57, v57, v49
    v_mul_f32 v58, v58, v49
    v_mul_f32 v59, v59, v49
    v_accvgpr_write_b32 a16, v52
    v_accvgpr_write_b32 a17, v53
    v_accvgpr_write_b32 a18, v54
    v_accvgpr_write_b32 a19, v55
    v_accvgpr_write_b32 a20, v56
    v_accvgpr_write_b32 a21, v57
    v_accvgpr_write_b32 a22, v58
    v_accvgpr_write_b32 a23, v59
    v_accvgpr_read_b32 v52, a24
    v_accvgpr_read_b32 v53, a25
    v_accvgpr_read_b32 v54, a26
    v_accvgpr_read_b32 v55, a27
    v_accvgpr_read_b32 v56, a28
    v_accvgpr_read_b32 v57, a29
    v_accvgpr_read_b32 v58, a30
    v_accvgpr_read_b32 v59, a31
    v_mul_f32 v52, v52, v49
    v_mul_f32 v53, v53, v49
    v_mul_f32 v54, v54, v49
    v_mul_f32 v55, v55, v49
    v_mul_f32 v56, v56, v49
    v_mul_f32 v57, v57, v49
    v_mul_f32 v58, v58, v49
    v_mul_f32 v59, v59, v49
    v_accvgpr_write_b32 a24, v52
    v_accvgpr_write_b32 a25, v53
    v_accvgpr_write_b32 a26, v54
    v_accvgpr_write_b32 a27, v55
    v_accvgpr_write_b32 a28, v56
    v_accvgpr_write_b32 a29, v57
    v_accvgpr_write_b32 a30, v58
    v_accvgpr_write_b32 a31, v59
    v_exp_f32 v52, v96
    v_exp_f32 v53, v97
    v_exp_f32 v54, v98
    v_exp_f32 v55, v99
    v_exp_f32 v56, v100
    v_exp_f32 v57, v101
    v_exp_f32 v58, v102
    v_exp_f32 v59, v103
    s_nop 0
    v_cvt_pk_bf16_f32 v144, v52, v53
    v_cvt_pk_bf16_f32 v145, v54, v55
    v_cvt_pk_bf16_f32 v146, v56, v57
    v_cvt_pk_bf16_f32 v147, v58, v59
    s_nop 1
    v_mfma_f32_16x16x32_bf16 v[28:31], v[44:47], v[144:147], 0
    v_max3_f32 v48, v104, v105, v106
    v_max3_f32 v48, v48, v107, v108
    v_max3_f32 v48, v48, v109, v110
    v_max3_f32 v48, v48, v111, 0
    v_mov_b32 v49, v48
    s_nop 1
    v_permlane32_swap_b32 v48, v49
    s_nop 1
    v_max_f32 v48, v48, v49
    v_mov_b32 v49, v48
    s_nop 1
    v_permlane16_swap_b32 v48, v49
    s_nop 1
    v_max_f32 v48, v48, v49
    v_exp_f32 v49, -v48
    v_sub_f32 v104, v104, v48
    v_sub_f32 v105, v105, v48
    v_sub_f32 v106, v106, v48
    v_sub_f32 v107, v107, v48
    v_sub_f32 v108, v108, v48
    v_sub_f32 v109, v109, v48
    v_sub_f32 v110, v110, v48
    v_sub_f32 v111, v111, v48
    v_sub_f32 v72, v72, v48
    v_sub_f32 v73, v73, v48
    v_sub_f32 v74, v74, v48
    v_sub_f32 v75, v75, v48
    v_sub_f32 v76, v76, v48
    v_sub_f32 v77, v77, v48
    v_sub_f32 v78, v78, v48
    v_sub_f32 v79, v79, v48
    v_sub_f32 v168, v168, v48
    v_sub_f32 v169, v169, v48
    v_sub_f32 v170, v170, v48
    v_sub_f32 v171, v171, v48
    v_sub_f32 v172, v172, v48
    v_sub_f32 v173, v173, v48
    v_sub_f32 v174, v174, v48
    v_sub_f32 v175, v175, v48
    v_mul_f32 v13, v13, v49
    v_accvgpr_read_b32 v52, a32
    v_accvgpr_read_b32 v53, a33
    v_accvgpr_read_b32 v54, a34
    v_accvgpr_read_b32 v55, a35
    v_accvgpr_read_b32 v56, a36
    v_accvgpr_read_b32 v57, a37
    v_accvgpr_read_b32 v58, a38
    v_accvgpr_read_b32 v59, a39
    v_mul_f32 v52, v52, v49
    v_mul_f32 v53, v53, v49
    v_mul_f32 v54, v54, v49
    v_mul_f32 v55, v55, v49
    v_mul_f32 v56, v56, v49
    v_mul_f32 v57, v57, v49
    v_mul_f32 v58, v58, v49
    v_mul_f32 v59, v59, v49
    v_accvgpr_write_b32 a32, v52
    v_accvgpr_write_b32 a33, v53
    v_accvgpr_write_b32 a34, v54
    v_accvgpr_write_b32 a35, v55
    v_accvgpr_write_b32 a36, v56
    v_accvgpr_write_b32 a37, v57
    v_accvgpr_write_b32 a38, v58
    v_accvgpr_write_b32 a39, v59
    v_accvgpr_read_b32 v52, a40
    v_accvgpr_read_b32 v53, a41
    v_accvgpr_read_b32 v54, a42
    v_accvgpr_read_b32 v55, a43
    v_accvgpr_read_b32 v56, a44
    v_accvgpr_read_b32 v57, a45
    v_accvgpr_read_b32 v58, a46
    v_accvgpr_read_b32 v59, a47
    v_mul_f32 v52, v52, v49
    v_mul_f32 v53, v53, v49
    v_mul_f32 v54, v54, v49
    v_mul_f32 v55, v55, v49
    v_mul_f32 v56, v56, v49
    v_mul_f32 v57, v57, v49
    v_mul_f32 v58, v58, v49
    v_mul_f32 v59, v59, v49
    v_accvgpr_write_b32 a40, v52
    v_accvgpr_write_b32 a41, v53
    v_accvgpr_write_b32 a42, v54
    v_accvgpr_write_b32 a43, v55
    v_accvgpr_write_b32 a44, v56
    v_accvgpr_write_b32 a45, v57
    v_accvgpr_write_b32 a46, v58
    v_accvgpr_write_b32 a47, v59
    v_accvgpr_read_b32 v52, a48
    v_accvgpr_read_b32 v53, a49
    v_accvgpr_read_b32 v54, a50
    v_accvgpr_read_b32 v55, a51
    v_accvgpr_read_b32 v56, a52
    v_accvgpr_read_b32 v57, a53
    v_accvgpr_read_b32 v58, a54
    v_accvgpr_read_b32 v59, a55
    v_mul_f32 v52, v52, v49
    v_mul_f32 v53, v53, v49
    v_mul_f32 v54, v54, v49
    v_mul_f32 v55, v55, v49
    v_mul_f32 v56, v56, v49
    v_mul_f32 v57, v57, v49
    v_mul_f32 v58, v58, v49
    v_mul_f32 v59, v59, v49
    v_accvgpr_write_b32 a48, v52
    v_accvgpr_write_b32 a49, v53
    v_accvgpr_write_b32 a50, v54
    v_accvgpr_write_b32 a51, v55
    v_accvgpr_write_b32 a52, v56
    v_accvgpr_write_b32 a53, v57
    v_accvgpr_write_b32 a54, v58
    v_accvgpr_write_b32 a55, v59
    v_accvgpr_read_b32 v52, a56
    v_accvgpr_read_b32 v53, a57
    v_accvgpr_read_b32 v54, a58
    v_accvgpr_read_b32 v55, a59
    v_accvgpr_read_b32 v56, a60
    v_accvgpr_read_b32 v57, a61
    v_accvgpr_read_b32 v58, a62
    v_accvgpr_read_b32 v59, a63
    v_mul_f32 v52, v52, v49
    v_mul_f32 v53, v53, v49
    v_mul_f32 v54, v54, v49
    v_mul_f32 v55, v55, v49
    v_mul_f32 v56, v56, v49
    v_mul_f32 v57, v57, v49
    v_mul_f32 v58, v58, v49
    v_mul_f32 v59, v59, v49
    v_accvgpr_write_b32 a56, v52
    v_accvgpr_write_b32 a57, v53
    v_accvgpr_write_b32 a58, v54
    v_accvgpr_write_b32 a59, v55
    v_accvgpr_write_b32 a60, v56
    v_accvgpr_write_b32 a61, v57
    v_accvgpr_write_b32 a62, v58
    v_accvgpr_write_b32 a63, v59
    v_exp_f32 v52, v104
    v_exp_f32 v53, v105
    v_exp_f32 v54, v106
    v_exp_f32 v55, v107
    v_exp_f32 v56, v108
    v_exp_f32 v57, v109
    v_exp_f32 v58, v110
    v_exp_f32 v59, v111
    s_nop 0
    v_cvt_pk_bf16_f32 v148, v52, v53
    v_cvt_pk_bf16_f32 v149, v54, v55
    v_cvt_pk_bf16_f32 v150, v56, v57
    v_cvt_pk_bf16_f32 v151, v58, v59
    s_nop 1
    v_mfma_f32_16x16x32_bf16 v[32:35], v[44:47], v[148:151], 0
    s_nop 7
    s_setpc_b64 s[74:75]
m_rs1490:
    s_nop 15
    v_max3_f32 v48, v96, v97, v98
    v_max3_f32 v48, v48, v99, v100
    v_max3_f32 v48, v48, v101, v102
    v_max3_f32 v48, v48, v103, 0
    v_mov_b32 v49, v48
    s_nop 1
    v_permlane32_swap_b32 v48, v49
    s_nop 1
    v_max_f32 v48, v48, v49
    v_mov_b32 v49, v48
    s_nop 1
    v_permlane16_swap_b32 v48, v49
    s_nop 1
    v_max_f32 v48, v48, v49
    v_exp_f32 v49, -v48
    v_sub_f32 v96, v96, v48
    v_sub_f32 v97, v97, v48
    v_sub_f32 v98, v98, v48
    v_sub_f32 v99, v99, v48
    v_sub_f32 v100, v100, v48
    v_sub_f32 v101, v101, v48
    v_sub_f32 v102, v102, v48
    v_sub_f32 v103, v103, v48
    v_sub_f32 v64, v64, v48
    v_sub_f32 v65, v65, v48
    v_sub_f32 v66, v66, v48
    v_sub_f32 v67, v67, v48
    v_sub_f32 v68, v68, v48
    v_sub_f32 v69, v69, v48
    v_sub_f32 v70, v70, v48
    v_sub_f32 v71, v71, v48
    v_sub_f32 v160, v160, v48
    v_sub_f32 v161, v161, v48
    v_sub_f32 v162, v162, v48
    v_sub_f32 v163, v163, v48
    v_sub_f32 v164, v164, v48
    v_sub_f32 v165, v165, v48
    v_sub_f32 v166, v166, v48
    v_sub_f32 v167, v167, v48
    v_mul_f32 v12, v12, v49
    v_accvgpr_read_b32 v52, a0
    v_accvgpr_read_b32 v53, a1
    v_accvgpr_read_b32 v54, a2
    v_accvgpr_read_b32 v55, a3
    v_accvgpr_read_b32 v56, a4
    v_accvgpr_read_b32 v57, a5
    v_accvgpr_read_b32 v58, a6
    v_accvgpr_read_b32 v59, a7
    v_mul_f32 v52, v52, v49
    v_mul_f32 v53, v53, v49
    v_mul_f32 v54, v54, v49
    v_mul_f32 v55, v55, v49
    v_mul_f32 v56, v56, v49
    v_mul_f32 v57, v57, v49
    v_mul_f32 v58, v58, v49
    v_mul_f32 v59, v59, v49
    v_accvgpr_write_b32 a0, v52
    v_accvgpr_write_b32 a1, v53
    v_accvgpr_write_b32 a2, v54
    v_accvgpr_write_b32 a3, v55
    v_accvgpr_write_b32 a4, v56
    v_accvgpr_write_b32 a5, v57
    v_accvgpr_write_b32 a6, v58
    v_accvgpr_write_b32 a7, v59
    v_accvgpr_read_b32 v52, a8
    v_accvgpr_read_b32 v53, a9
    v_accvgpr_read_b32 v54, a10
    v_accvgpr_read_b32 v55, a11
    v_accvgpr_read_b32 v56, a12
    v_accvgpr_read_b32 v57, a13
    v_accvgpr_read_b32 v58, a14
    v_accvgpr_read_b32 v59, a15
    v_mul_f32 v52, v52, v49
    v_mul_f32 v53, v53, v49
    v_mul_f32 v54, v54, v49
    v_mul_f32 v55, v55, v49
    v_mul_f32 v56, v56, v49
    v_mul_f32 v57, v57, v49
    v_mul_f32 v58, v58, v49
    v_mul_f32 v59, v59, v49
    v_accvgpr_write_b32 a8, v52
    v_accvgpr_write_b32 a9, v53
    v_accvgpr_write_b32 a10, v54
    v_accvgpr_write_b32 a11, v55
    v_accvgpr_write_b32 a12, v56
    v_accvgpr_write_b32 a13, v57
    v_accvgpr_write_b32 a14, v58
    v_accvgpr_write_b32 a15, v59
    v_accvgpr_read_b32 v52, a16
    v_accvgpr_read_b32 v53, a17
    v_accvgpr_read_b32 v54, a18
    v_accvgpr_read_b32 v55, a19
    v_accvgpr_read_b32 v56, a20
    v_accvgpr_read_b32 v57, a21
    v_accvgpr_read_b32 v58, a22
    v_accvgpr_read_b32 v59, a23
    v_mul_f32 v52, v52, v49
    v_mul_f32 v53, v53, v49
    v_mul_f32 v54, v54, v49
    v_mul_f32 v55, v55, v49
    v_mul_f32 v56, v56, v49
    v_mul_f32 v57, v57, v49
    v_mul_f32 v58, v58, v49
    v_mul_f32 v59, v59, v49
    v_accvgpr_write_b32 a16, v52
    v_accvgpr_write_b32 a17, v53
    v_accvgpr_write_b32 a18, v54
    v_accvgpr_write_b32 a19, v55
    v_accvgpr_write_b32 a20, v56
    v_accvgpr_write_b32 a21, v57
    v_accvgpr_write_b32 a22, v58
    v_accvgpr_write_b32 a23, v59
    v_accvgpr_read_b32 v52, a24
    v_accvgpr_read_b32 v53, a25
    v_accvgpr_read_b32 v54, a26
    v_accvgpr_read_b32 v55, a27
    v_accvgpr_read_b32 v56, a28
    v_accvgpr_read_b32 v57, a29
    v_accvgpr_read_b32 v58, a30
    v_accvgpr_read_b32 v59, a31
    v_mul_f32 v52, v52, v49
    v_mul_f32 v53, v53, v49
    v_mul_f32 v54, v54, v49
    v_mul_f32 v55, v55, v49
    v_mul_f32 v56, v56, v49
    v_mul_f32 v57, v57, v49
    v_mul_f32 v58, v58, v49
    v_mul_f32 v59, v59, v49
    v_accvgpr_write_b32 a24, v52
    v_accvgpr_write_b32 a25, v53
    v_accvgpr_write_b32 a26, v54
    v_accvgpr_write_b32 a27, v55
    v_accvgpr_write_b32 a28, v56
    v_accvgpr_write_b32 a29, v57
    v_accvgpr_write_b32 a30, v58
    v_accvgpr_write_b32 a31, v59
    v_exp_f32 v52, v96
    v_exp_f32 v53, v97
    v_exp_f32 v54, v98
    v_exp_f32 v55, v99
    v_exp_f32 v56, v100
    v_exp_f32 v57, v101
    v_exp_f32 v58, v102
    v_exp_f32 v59, v103
    s_nop 0
    v_cvt_pk_bf16_f32 v144, v52, v53
    v_cvt_pk_bf16_f32 v145, v54, v55
    v_cvt_pk_bf16_f32 v146, v56, v57
    v_cvt_pk_bf16_f32 v147, v58, v59
    s_nop 1
    v_mfma_f32_16x16x32_bf16 v[28:31], v[44:47], v[144:147], 0
    v_max3_f32 v48, v104, v105, v106
    v_max3_f32 v48, v48, v107, v108
    v_max3_f32 v48, v48, v109, v110
    v_max3_f32 v48, v48, v111, 0
    v_mov_b32 v49, v48
    s_nop 1
    v_permlane32_swap_b32 v48, v49
    s_nop 1
    v_max_f32 v48, v48, v49
    v_mov_b32 v49, v48
    s_nop 1
    v_permlane16_swap_b32 v48, v49
    s_nop 1
    v_max_f32 v48, v48, v49
    v_exp_f32 v49, -v48
    v_sub_f32 v104, v104, v48
    v_sub_f32 v105, v105, v48
    v_sub_f32 v106, v106, v48
    v_sub_f32 v107, v107, v48
    v_sub_f32 v108, v108, v48
    v_sub_f32 v109, v109, v48
    v_sub_f32 v110, v110, v48
    v_sub_f32 v111, v111, v48
    v_sub_f32 v72, v72, v48
    v_sub_f32 v73, v73, v48
    v_sub_f32 v74, v74, v48
    v_sub_f32 v75, v75, v48
    v_sub_f32 v76, v76, v48
    v_sub_f32 v77, v77, v48
    v_sub_f32 v78, v78, v48
    v_sub_f32 v79, v79, v48
    v_sub_f32 v168, v168, v48
    v_sub_f32 v169, v169, v48
    v_sub_f32 v170, v170, v48
    v_sub_f32 v171, v171, v48
    v_sub_f32 v172, v172, v48
    v_sub_f32 v173, v173, v48
    v_sub_f32 v174, v174, v48
    v_sub_f32 v175, v175, v48
    v_mul_f32 v13, v13, v49
    v_accvgpr_read_b32 v52, a32
    v_accvgpr_read_b32 v53, a33
    v_accvgpr_read_b32 v54, a34
    v_accvgpr_read_b32 v55, a35
    v_accvgpr_read_b32 v56, a36
    v_accvgpr_read_b32 v57, a37
    v_accvgpr_read_b32 v58, a38
    v_accvgpr_read_b32 v59, a39
    v_mul_f32 v52, v52, v49
    v_mul_f32 v53, v53, v49
    v_mul_f32 v54, v54, v49
    v_mul_f32 v55, v55, v49
    v_mul_f32 v56, v56, v49
    v_mul_f32 v57, v57, v49
    v_mul_f32 v58, v58, v49
    v_mul_f32 v59, v59, v49
    v_accvgpr_write_b32 a32, v52
    v_accvgpr_write_b32 a33, v53
    v_accvgpr_write_b32 a34, v54
    v_accvgpr_write_b32 a35, v55
    v_accvgpr_write_b32 a36, v56
    v_accvgpr_write_b32 a37, v57
    v_accvgpr_write_b32 a38, v58
    v_accvgpr_write_b32 a39, v59
    v_accvgpr_read_b32 v52, a40
    v_accvgpr_read_b32 v53, a41
    v_accvgpr_read_b32 v54, a42
    v_accvgpr_read_b32 v55, a43
    v_accvgpr_read_b32 v56, a44
    v_accvgpr_read_b32 v57, a45
    v_accvgpr_read_b32 v58, a46
    v_accvgpr_read_b32 v59, a47
    v_mul_f32 v52, v52, v49
    v_mul_f32 v53, v53, v49
    v_mul_f32 v54, v54, v49
    v_mul_f32 v55, v55, v49
    v_mul_f32 v56, v56, v49
    v_mul_f32 v57, v57, v49
    v_mul_f32 v58, v58, v49
    v_mul_f32 v59, v59, v49
    v_accvgpr_write_b32 a40, v52
    v_accvgpr_write_b32 a41, v53
    v_accvgpr_write_b32 a42, v54
    v_accvgpr_write_b32 a43, v55
    v_accvgpr_write_b32 a44, v56
    v_accvgpr_write_b32 a45, v57
    v_accvgpr_write_b32 a46, v58
    v_accvgpr_write_b32 a47, v59
    v_accvgpr_read_b32 v52, a48
    v_accvgpr_read_b32 v53, a49
    v_accvgpr_read_b32 v54, a50
    v_accvgpr_read_b32 v55, a51
    v_accvgpr_read_b32 v56, a52
    v_accvgpr_read_b32 v57, a53
    v_accvgpr_read_b32 v58, a54
    v_accvgpr_read_b32 v59, a55
    v_mul_f32 v52, v52, v49
    v_mul_f32 v53, v53, v49
    v_mul_f32 v54, v54, v49
    v_mul_f32 v55, v55, v49
    v_mul_f32 v56, v56, v49
    v_mul_f32 v57, v57, v49
    v_mul_f32 v58, v58, v49
    v_mul_f32 v59, v59, v49
    v_accvgpr_write_b32 a48, v52
    v_accvgpr_write_b32 a49, v53
    v_accvgpr_write_b32 a50, v54
    v_accvgpr_write_b32 a51, v55
    v_accvgpr_write_b32 a52, v56
    v_accvgpr_write_b32 a53, v57
    v_accvgpr_write_b32 a54, v58
    v_accvgpr_write_b32 a55, v59
    v_accvgpr_read_b32 v52, a56
    v_accvgpr_read_b32 v53, a57
    v_accvgpr_read_b32 v54, a58
    v_accvgpr_read_b32 v55, a59
    v_accvgpr_read_b32 v56, a60
    v_accvgpr_read_b32 v57, a61
    v_accvgpr_read_b32 v58, a62
    v_accvgpr_read_b32 v59, a63
    v_mul_f32 v52, v52, v49
    v_mul_f32 v53, v53, v49
    v_mul_f32 v54, v54, v49
    v_mul_f32 v55, v55, v49
    v_mul_f32 v56, v56, v49
    v_mul_f32 v57, v57, v49
    v_mul_f32 v58, v58, v49
    v_mul_f32 v59, v59, v49
    v_accvgpr_write_b32 a56, v52
    v_accvgpr_write_b32 a57, v53
    v_accvgpr_write_b32 a58, v54
    v_accvgpr_write_b32 a59, v55
    v_accvgpr_write_b32 a60, v56
    v_accvgpr_write_b32 a61, v57
    v_accvgpr_write_b32 a62, v58
    v_accvgpr_write_b32 a63, v59
    v_exp_f32 v52, v104
    v_exp_f32 v53, v105
    v_exp_f32 v54, v106
    v_exp_f32 v55, v107
    v_exp_f32 v56, v108
    v_exp_f32 v57, v109
    v_exp_f32 v58, v110
    v_exp_f32 v59, v111
    s_nop 0
    v_cvt_pk_bf16_f32 v148, v52, v53
    v_cvt_pk_bf16_f32 v149, v54, v55
    v_cvt_pk_bf16_f32 v150, v56, v57
    v_cvt_pk_bf16_f32 v151, v58, v59
    s_nop 1
    v_mfma_f32_16x16x32_bf16 v[32:35], v[44:47], v[148:151], 0
    v_max3_f32 v48, v112, v113, v114
    v_max3_f32 v48, v48, v115, v116
    v_max3_f32 v48, v48, v117, v118
    v_max3_f32 v48, v48, v119, 0
    v_mov_b32 v49, v48
    s_nop 1
    v_permlane32_swap_b32 v48, v49
    s_nop 1
    v_max_f32 v48, v48, v49
    v_mov_b32 v49, v48
    s_nop 1
    v_permlane16_swap_b32 v48, v49
    s_nop 1
    v_max_f32 v48, v48, v49
    v_exp_f32 v49, -v48
    v_sub_f32 v112, v112, v48
    v_sub_f32 v113, v113, v48
    v_sub_f32 v114, v114, v48
    v_sub_f32 v115, v115, v48
    v_sub_f32 v116, v116, v48
    v_sub_f32 v117, v117, v48
    v_sub_f32 v118, v118, v48
    v_sub_f32 v119, v119, v48
    v_sub_f32 v80, v80, v48
    v_sub_f32 v81, v81, v48
    v_sub_f32 v82, v82, v48
    v_sub_f32 v83, v83, v48
    v_sub_f32 v84, v84, v48
    v_sub_f32 v85, v85, v48
    v_sub_f32 v86, v86, v48
    v_sub_f32 v87, v87, v48
    v_sub_f32 v176, v176, v48
    v_sub_f32 v177, v177, v48
    v_sub_f32 v178, v178, v48
    v_sub_f32 v179, v179, v48
    v_sub_f32 v180, v180, v48
    v_sub_f32 v181, v181, v48
    v_sub_f32 v182, v182, v48
    v_sub_f32 v183, v183, v48
    v_mul_f32 v14, v14, v49
    v_accvgpr_read_b32 v52, a64
    v_accvgpr_read_b32 v53, a65
    v_accvgpr_read_b32 v54, a66
    v_accvgpr_read_b32 v55, a67
    v_accvgpr_read_b32 v56, a68
    v_accvgpr_read_b32 v57, a69
    v_accvgpr_read_b32 v58, a70
    v_accvgpr_read_b32 v59, a71
    v_mul_f32 v52, v52, v49
    v_mul_f32 v53, v53, v49
    v_mul_f32 v54, v54, v49
    v_mul_f32 v55, v55, v49
    v_mul_f32 v56, v56, v49
    v_mul_f32 v57, v57, v49
    v_mul_f32 v58, v58, v49
    v_mul_f32 v59, v59, v49
    v_accvgpr_write_b32 a64, v52
    v_accvgpr_write_b32 a65, v53
    v_accvgpr_write_b32 a66, v54
    v_accvgpr_write_b32 a67, v55
    v_accvgpr_write_b32 a68, v56
    v_accvgpr_write_b32 a69, v57
    v_accvgpr_write_b32 a70, v58
    v_accvgpr_write_b32 a71, v59
    v_accvgpr_read_b32 v52, a72
    v_accvgpr_read_b32 v53, a73
    v_accvgpr_read_b32 v54, a74
    v_accvgpr_read_b32 v55, a75
    v_accvgpr_read_b32 v56, a76
    v_accvgpr_read_b32 v57, a77
    v_accvgpr_read_b32 v58, a78
    v_accvgpr_read_b32 v59, a79
    v_mul_f32 v52, v52, v49
    v_mul_f32 v53, v53, v49
    v_mul_f32 v54, v54, v49
    v_mul_f32 v55, v55, v49
    v_mul_f32 v56, v56, v49
    v_mul_f32 v57, v57, v49
    v_mul_f32 v58, v58, v49
    v_mul_f32 v59, v59, v49
    v_accvgpr_write_b32 a72, v52
    v_accvgpr_write_b32 a73, v53
    v_accvgpr_write_b32 a74, v54
    v_accvgpr_write_b32 a75, v55
    v_accvgpr_write_b32 a76, v56
    v_accvgpr_write_b32 a77, v57
    v_accvgpr_write_b32 a78, v58
    v_accvgpr_write_b32 a79, v59
    v_accvgpr_read_b32 v52, a80
    v_accvgpr_read_b32 v53, a81
    v_accvgpr_read_b32 v54, a82
    v_accvgpr_read_b32 v55, a83
    v_accvgpr_read_b32 v56, a84
    v_accvgpr_read_b32 v57, a85
    v_accvgpr_read_b32 v58, a86
    v_accvgpr_read_b32 v59, a87
    v_mul_f32 v52, v52, v49
    v_mul_f32 v53, v53, v49
    v_mul_f32 v54, v54, v49
    v_mul_f32 v55, v55, v49
    v_mul_f32 v56, v56, v49
    v_mul_f32 v57, v57, v49
    v_mul_f32 v58, v58, v49
    v_mul_f32 v59, v59, v49
    v_accvgpr_write_b32 a80, v52
    v_accvgpr_write_b32 a81, v53
    v_accvgpr_write_b32 a82, v54
    v_accvgpr_write_b32 a83, v55
    v_accvgpr_write_b32 a84, v56
    v_accvgpr_write_b32 a85, v57
    v_accvgpr_write_b32 a86, v58
    v_accvgpr_write_b32 a87, v59
    v_accvgpr_read_b32 v52, a88
    v_accvgpr_read_b32 v53, a89
    v_accvgpr_read_b32 v54, a90
    v_accvgpr_read_b32 v55, a91
    v_accvgpr_read_b32 v56, a92
    v_accvgpr_read_b32 v57, a93
    v_accvgpr_read_b32 v58, a94
    v_accvgpr_read_b32 v59, a95
    v_mul_f32 v52, v52, v49
    v_mul_f32 v53, v53, v49
    v_mul_f32 v54, v54, v49
    v_mul_f32 v55, v55, v49
    v_mul_f32 v56, v56, v49
    v_mul_f32 v57, v57, v49
    v_mul_f32 v58, v58, v49
    v_mul_f32 v59, v59, v49
    v_accvgpr_write_b32 a88, v52
    v_accvgpr_write_b32 a89, v53
    v_accvgpr_write_b32 a90, v54
    v_accvgpr_write_b32 a91, v55
    v_accvgpr_write_b32 a92, v56
    v_accvgpr_write_b32 a93, v57
    v_accvgpr_write_b32 a94, v58
    v_accvgpr_write_b32 a95, v59
    v_exp_f32 v52, v112
    v_exp_f32 v53, v113
    v_exp_f32 v54, v114
    v_exp_f32 v55, v115
    v_exp_f32 v56, v116
    v_exp_f32 v57, v117
    v_exp_f32 v58, v118
    v_exp_f32 v59, v119
    s_nop 0
    v_cvt_pk_bf16_f32 v152, v52, v53
    v_cvt_pk_bf16_f32 v153, v54, v55
    v_cvt_pk_bf16_f32 v154, v56, v57
    v_cvt_pk_bf16_f32 v155, v58, v59
    s_nop 1
    v_mfma_f32_16x16x32_bf16 v[36:39], v[44:47], v[152:155], 0
    v_max3_f32 v48, v120, v121, v122
    v_max3_f32 v48, v48, v123, v124
    v_max3_f32 v48, v48, v125, v126
    v_max3_f32 v48, v48, v127, 0
    v_mov_b32 v49, v48
    s_nop 1
    v_permlane32_swap_b32 v48, v49
    s_nop 1
    v_max_f32 v48, v48, v49
    v_mov_b32 v49, v48
    s_nop 1
    v_permlane16_swap_b32 v48, v49
    s_nop 1
    v_max_f32 v48, v48, v49
    v_exp_f32 v49, -v48
    v_sub_f32 v120, v120, v48
    v_sub_f32 v121, v121, v48
    v_sub_f32 v122, v122, v48
    v_sub_f32 v123, v123, v48
    v_sub_f32 v124, v124, v48
    v_sub_f32 v125, v125, v48
    v_sub_f32 v126, v126, v48
    v_sub_f32 v127, v127, v48
    v_sub_f32 v88, v88, v48
    v_sub_f32 v89, v89, v48
    v_sub_f32 v90, v90, v48
    v_sub_f32 v91, v91, v48
    v_sub_f32 v92, v92, v48
    v_sub_f32 v93, v93, v48
    v_sub_f32 v94, v94, v48
    v_sub_f32 v95, v95, v48
    v_sub_f32 v184, v184, v48
    v_sub_f32 v185, v185, v48
    v_sub_f32 v186, v186, v48
    v_sub_f32 v187, v187, v48
    v_sub_f32 v188, v188, v48
    v_sub_f32 v189, v189, v48
    v_sub_f32 v190, v190, v48
    v_sub_f32 v191, v191, v48
    v_mul_f32 v15, v15, v49
    v_accvgpr_read_b32 v52, a96
    v_accvgpr_read_b32 v53, a97
    v_accvgpr_read_b32 v54, a98
    v_accvgpr_read_b32 v55, a99
    v_accvgpr_read_b32 v56, a100
    v_accvgpr_read_b32 v57, a101
    v_accvgpr_read_b32 v58, a102
    v_accvgpr_read_b32 v59, a103
    v_mul_f32 v52, v52, v49
    v_mul_f32 v53, v53, v49
    v_mul_f32 v54, v54, v49
    v_mul_f32 v55, v55, v49
    v_mul_f32 v56, v56, v49
    v_mul_f32 v57, v57, v49
    v_mul_f32 v58, v58, v49
    v_mul_f32 v59, v59, v49
    v_accvgpr_write_b32 a96, v52
    v_accvgpr_write_b32 a97, v53
    v_accvgpr_write_b32 a98, v54
    v_accvgpr_write_b32 a99, v55
    v_accvgpr_write_b32 a100, v56
    v_accvgpr_write_b32 a101, v57
    v_accvgpr_write_b32 a102, v58
    v_accvgpr_write_b32 a103, v59
    v_accvgpr_read_b32 v52, a104
    v_accvgpr_read_b32 v53, a105
    v_accvgpr_read_b32 v54, a106
    v_accvgpr_read_b32 v55, a107
    v_accvgpr_read_b32 v56, a108
    v_accvgpr_read_b32 v57, a109
    v_accvgpr_read_b32 v58, a110
    v_accvgpr_read_b32 v59, a111
    v_mul_f32 v52, v52, v49
    v_mul_f32 v53, v53, v49
    v_mul_f32 v54, v54, v49
    v_mul_f32 v55, v55, v49
    v_mul_f32 v56, v56, v49
    v_mul_f32 v57, v57, v49
    v_mul_f32 v58, v58, v49
    v_mul_f32 v59, v59, v49
    v_accvgpr_write_b32 a104, v52
    v_accvgpr_write_b32 a105, v53
    v_accvgpr_write_b32 a106, v54
    v_accvgpr_write_b32 a107, v55
    v_accvgpr_write_b32 a108, v56
    v_accvgpr_write_b32 a109, v57
    v_accvgpr_write_b32 a110, v58
    v_accvgpr_write_b32 a111, v59
    v_accvgpr_read_b32 v52, a112
    v_accvgpr_read_b32 v53, a113
    v_accvgpr_read_b32 v54, a114
    v_accvgpr_read_b32 v55, a115
    v_accvgpr_read_b32 v56, a116
    v_accvgpr_read_b32 v57, a117
    v_accvgpr_read_b32 v58, a118
    v_accvgpr_read_b32 v59, a119
    v_mul_f32 v52, v52, v49
    v_mul_f32 v53, v53, v49
    v_mul_f32 v54, v54, v49
    v_mul_f32 v55, v55, v49
    v_mul_f32 v56, v56, v49
    v_mul_f32 v57, v57, v49
    v_mul_f32 v58, v58, v49
    v_mul_f32 v59, v59, v49
    v_accvgpr_write_b32 a112, v52
    v_accvgpr_write_b32 a113, v53
    v_accvgpr_write_b32 a114, v54
    v_accvgpr_write_b32 a115, v55
    v_accvgpr_write_b32 a116, v56
    v_accvgpr_write_b32 a117, v57
    v_accvgpr_write_b32 a118, v58
    v_accvgpr_write_b32 a119, v59
    v_accvgpr_read_b32 v52, a120
    v_accvgpr_read_b32 v53, a121
    v_accvgpr_read_b32 v54, a122
    v_accvgpr_read_b32 v55, a123
    v_accvgpr_read_b32 v56, a124
    v_accvgpr_read_b32 v57, a125
    v_accvgpr_read_b32 v58, a126
    v_accvgpr_read_b32 v59, a127
    v_mul_f32 v52, v52, v49
    v_mul_f32 v53, v53, v49
    v_mul_f32 v54, v54, v49
    v_mul_f32 v55, v55, v49
    v_mul_f32 v56, v56, v49
    v_mul_f32 v57, v57, v49
    v_mul_f32 v58, v58, v49
    v_mul_f32 v59, v59, v49
    v_accvgpr_write_b32 a120, v52
    v_accvgpr_write_b32 a121, v53
    v_accvgpr_write_b32 a122, v54
    v_accvgpr_write_b32 a123, v55
    v_accvgpr_write_b32 a124, v56
    v_accvgpr_write_b32 a125, v57
    v_accvgpr_write_b32 a126, v58
    v_accvgpr_write_b32 a127, v59
    v_exp_f32 v52, v120
    v_exp_f32 v53, v121
    v_exp_f32 v54, v122
    v_exp_f32 v55, v123
    v_exp_f32 v56, v124
    v_exp_f32 v57, v125
    v_exp_f32 v58, v126
    v_exp_f32 v59, v127
    s_nop 0
    v_cvt_pk_bf16_f32 v156, v52, v53
    v_cvt_pk_bf16_f32 v157, v54, v55
    v_cvt_pk_bf16_f32 v158, v56, v57
    v_cvt_pk_bf16_f32 v159, v58, v59
    s_nop 1
    v_mfma_f32_16x16x32_bf16 v[40:43], v[44:47], v[156:159], 0
    s_nop 7
    s_setpc_b64 s[74:75]
m_hook18:
    s_cmp_lg_u32 s16, 0
    s_cbranch_scc1 m_np37
    v_mov_b32 v4, s4
    v_mov_b32 v5, s5
    s_add_u32 s90, s17, 117440512
    s_mov_b64 exec, 1
    buffer_store_dwordx2 v[4:5], off, s[8:11], s90 sc1
    s_mov_b64 exec, -1
m_np37:
    s_mov_b32 s17, -1
    s_branch m_hookr19
m_hook23:
    s_cmp_lg_u32 s16, 0
    s_cbranch_scc1 m_np38
    v_mov_b32 v4, s4
    v_mov_b32 v5, s5
    s_add_u32 s90, s17, 117440512
    s_mov_b64 exec, 1
    buffer_store_dwordx2 v[4:5], off, s[8:11], s90 sc1
    s_mov_b64 exec, -1
m_np38:
    s_mov_b32 s17, -1
    s_branch m_hookr24
m_pf7:
    s_mov_b32 s15, 0x20000
    s_sub_u32 s93, s2, 224
    s_lshl_b32 s93, s93, 2
    s_add_u32 s93, s93, s16
    v_lshlrev_b32 v24, 7, v1
    v_lshrrev_b32 v25, 3, v1
    v_lshlrev_b32 v25, 11, v25
    v_and_b32 v26, 7, v1
    v_lshl_add_u32 v25, v26, 7, v25
    s_lshl_b32 s92, s93, 13
    s_lshl_b32 s93, s93, 14
    s_add_u32 s93, s93, 1024
    s_mov_b32 s12, s26
    s_mov_b32 s13, s27
    s_mov_b32 s14, 6291456
    s_add_u32 s90, s92, 0
    buffer_load_dword v22, v24, s[12:15], s90 offen
    s_add_u32 s90, s92, 1048576
    buffer_load_dword v22, v24, s[12:15], s90 offen
    s_mov_b32 s12, s24
    s_mov_b32 s13, s25
    s_mov_b32 s14, 4194304
    s_add_u32 s90, s92, 0
    buffer_load_dword v22, v24, s[12:15], s90 offen
    s_add_u32 s90, s92, 1048576
    buffer_load_dword v22, v24, s[12:15], s90 offen
    s_add_u32 s90, s92, 2097152
    buffer_load_dword v22, v24, s[12:15], s90 offen
    s_add_u32 s90, s92, 3145728
    buffer_load_dword v22, v24, s[12:15], s90 offen
    s_mov_b32 s12, s34
    s_mov_b32 s13, s35
    s_mov_b32 s14, 8388608
    s_add_u32 s90, s92, 4194304
    buffer_load_dword v22, v24, s[12:15], s90 offen
    s_add_u32 s90, s92, 5242880
    buffer_load_dword v22, v24, s[12:15], s90 offen
    s_mov_b32 s12, s30
    s_mov_b32 s13, s31
    s_mov_b32 s14, 4194304
    s_add_u32 s90, s93, 0
    buffer_load_dword v22, v25, s[12:15], s90 offen
    s_add_u32 s90, s93, 2097152
    buffer_load_dword v22, v25, s[12:15], s90 offen
    s_mov_b32 s12, s26
    s_mov_b32 s13, s27
    s_mov_b32 s14, 6291456
    s_add_u32 s90, s92, 2097152
    buffer_load_dword v22, v24, s[12:15], s90 offen
    s_mov_b32 s12, s34
    s_mov_b32 s13, s35
    s_mov_b32 s14, 8388608
    s_add_u32 s90, s92, 6291456
    buffer_load_dword v22, v24, s[12:15], s90 offen
    s_add_u32 s90, s92, 7340032
    buffer_load_dword v22, v24, s[12:15], s90 offen
    s_mov_b32 s12, s26
    s_mov_b32 s13, s27
    s_mov_b32 s14, 6291456
    s_add_u32 s90, s92, 3145728
    buffer_load_dword v22, v24, s[12:15], s90 offen
    s_add_u32 s90, s92, 4194304
    buffer_load_dword v22, v24, s[12:15], s90 offen
    s_add_u32 s90, s92, 5242880
    buffer_load_dword v22, v24, s[12:15], s90 offen
    s_mov_b32 s12, s32
    s_mov_b32 s13, s33
    s_mov_b32 s14, 2097152
    s_add_u32 s90, s92, 1048576
    buffer_load_dword v22, v24, s[12:15], s90 offen
    s_add_u32 s61, s61, 32768
    s_branch m_nopf6
concat_heads__sliding_local_dilated__compressed_kv_cla__prompt_kernel_end:
.section .rodata,"a"
.p2align 6
.amdhsa_kernel concat_heads__sliding_local_dilated__compressed_kv_cla__prompt_kernel
  .amdhsa_next_free_vgpr 512
  .amdhsa_next_free_sgpr 102
  .amdhsa_accum_offset 256
  .amdhsa_group_segment_fixed_size 0
  .amdhsa_kernarg_size 96
  .amdhsa_user_sgpr_count 2
  .amdhsa_user_sgpr_kernarg_segment_ptr 1
  .amdhsa_system_sgpr_workgroup_id_x 1
.end_amdhsa_kernel
```
